```python
import torch

def _softmax(x, axis=-1):
    return torch.softmax(x, dim=axis)
def _gelu(x):
    return torch.nn.functional.gelu(x, approximate="tanh")
def _silu(x):
    return torch.nn.functional.silu(x)
def _sigmoid(x):
    return torch.sigmoid(x)
def _layernorm(x, axis=-1, eps=1e-5):
    m = x.mean(dim=axis, keepdim=True)
    v = x.var(dim=axis, keepdim=True, unbiased=False)
    return (x - m) / torch.sqrt(v + eps)
def _scatter_add(tgt, idx, src, axis=0):
    return tgt.clone().index_add_(axis, idx, src)
def _segment_sum(src, seg, n):
    out = torch.zeros((n,) + src.shape[1:], dtype=src.dtype)
    return out.index_add_(0, seg, src)
def _pad(x, pw):
    flat = tuple(v for pair in reversed(pw) for v in pair)
    return torch.nn.functional.pad(x, flat)

kernel_name = 'sequential_preLN__compressed_kv_cla__moe_arch_mod__prompt'

def setup_inputs():

    _w = (lambda a: (lambda t: t.to(torch.bfloat16) if t.is_floating_point() else t)(torch.as_tensor(a)))
    def _A_setup():
        B, H, Sq, Sk, D, M = 1, 32, 2048, 2048, 128, 1024
        Dc = 4 * D
        return {
            "x": _w((lambda *s: torch.randn(*s, dtype=torch.bfloat16) * 0.1)(B, Sq, M)),
            "c_kv": _w((lambda *s: torch.randn(*s, dtype=torch.bfloat16) * 1.6)(B, Sk, Dc)),
            "w_q": _w((lambda *s: torch.randn(*s, dtype=torch.bfloat16) * 0.8)(M, H, D) * (M ** -0.5)),
            "w_uk": _w((lambda *s: torch.randn(*s, dtype=torch.bfloat16) * 0.8)(Dc, H, D) * (Dc ** -0.5)),
            "w_uv": _w((lambda *s: torch.randn(*s, dtype=torch.bfloat16) * 1.6)(Dc, H, D) * (Dc ** -0.5)),
            "w_o": _w((lambda *s: torch.randn(*s, dtype=torch.bfloat16) * 1.6)(H, D, M) * ((H * D) ** -0.5)),
        }
    _A_in = _A_setup()

    def _B_setup():
        B, S, D, F, C = 1, 2048, 1024, 3584, 2
        return {
            "x": _w((lambda *s: torch.randn(*s, dtype=torch.bfloat16) * 0.1)(B, S, D)),
            "w_r": _w((lambda *s: torch.randn(*s, dtype=torch.bfloat16) * 0.2)(D)),
            "w_gate": _w((lambda *s: torch.randn(*s, dtype=torch.bfloat16) * 0.2)(D, F)),
            "w_up": _w((lambda *s: torch.randn(*s, dtype=torch.bfloat16) * 0.2)(D, F)),
            "w_down": _w((lambda *s: torch.randn(*s, dtype=torch.bfloat16) * 0.2)(F, D)),
        }
    _B_in = _B_setup()

    return {
        "A_x": _A_in["x"],
        "A_c_kv": _A_in["c_kv"],
        "A_w_q": _A_in["w_q"],
        "A_w_uk": _A_in["w_uk"],
        "A_w_uv": _A_in["w_uv"],
        "A_w_o": _A_in["w_o"],
        "B_x": _B_in["x"],
        "B_w_r": _B_in["w_r"],
        "B_w_gate": _B_in["w_gate"],
        "B_w_up": _B_in["w_up"],
        "B_w_down": _B_in["w_down"],
    }

def reference(A_x, A_c_kv, A_w_q, A_w_uk, A_w_uv, A_w_o, B_x, B_w_r, B_w_gate, B_w_up, B_w_down):
    def _A_ref(x, c_kv, w_q, w_uk, w_uv, w_o):
        B, Sq, M = x.shape[0], x.shape[1], x.shape[2]
        Sk = c_kv.shape[1]
        H, D = w_q.shape[1], w_q.shape[2]
        q = torch.einsum("bqm,mhd->bhqd", x, w_q)
        k = torch.einsum("bkc,chd->bhkd", c_kv, w_uk)
        v = torch.einsum("bkc,chd->bhkd", c_kv, w_uv)
        scores = torch.einsum("bhqd,bhkd->bhqk", q, k) * (D ** -0.5)
        off = Sk - Sq
        qi = torch.arange(Sq)[:, None]
        kj = torch.arange(Sk)[None, :]
        cmask = kj <= (qi + off)
        scores = torch.where(cmask[None, None], scores, -1e9)
        p = _softmax(scores, axis=-1)
        ctx = torch.einsum("bhqk,bhkd->bhqd", p, v)
        return torch.einsum("bhqd,hdm->bqm", ctx, w_o)

    def _B_ref(x, w_r, w_gate, w_up, w_down):
        B, S, D = x.shape
        C = 2
        r = x @ w_r
        idx = torch.argsort(-r, axis=-1)[:, :C]
        idx_e = (lambda x, n, axis: torch.repeat_interleave(x, n, dim=axis))(idx.reshape(B, C, 1), D, axis=2)
        x_sel = (lambda x, i, axis: torch.take_along_dim(x, i, dim=axis))(x, idx_e, axis=1)
        g = _silu(x_sel @ w_gate)
        u = x_sel @ w_up
        y = (g * u) @ w_down
        r_sel = _sigmoid((lambda x, i, axis: torch.take_along_dim(x, i, dim=axis))(r, idx, axis=1))
        y = y * r_sel.reshape(B, C, 1)
        b_off = (torch.arange(B) * S).reshape(B, 1)
        flat_idx = (idx + b_off).reshape(B * C)
        zero = (x * 0.0).reshape(B * S, D)
        upd = _scatter_add(zero, flat_idx, y.reshape(B * C, D), axis=0)
        return x + upd.reshape(B, S, D)

    x = A_x
    h = x + _A_ref(_layernorm(x, axis=-1), A_c_kv, A_w_q, A_w_uk, A_w_uv, A_w_o)
    h2 = h + _B_ref(_layernorm(h, axis=-1), B_w_r, B_w_gate, B_w_up, B_w_down)
    return h2
```

```asm
; @launch kernel=k1_kernel grid=(256,1,1) block=(256,1,1) lds=163840
; @launch kernel=k2_kernel grid=(256,1,1) block=(256,1,1) lds=163840
; @launch kernel=k3_kernel grid=(256,1,1) block=(256,1,1) lds=98304
; @launch kernel=k4_kernel grid=(256,1,1) block=(256,1,1) lds=110848
; @launch kernel=k5_kernel grid=(32,1,1) block=(256,1,1) lds=1024
.amdgcn_target "amdgcn-amd-amdhsa--gfx950"
.text
.globl k1_kernel
.p2align 8
.type k1_kernel,@function
k1_kernel:
    s_cmp_ge_u32 s2, 256
    s_cbranch_scc1 k1_done
    s_load_dwordx4 s[40:43], s[0:1], 0
    s_load_dwordx4 s[44:47], s[0:1], 24
    s_load_dwordx2 s[48:49], s[0:1], 104
    v_lshrrev_b32 v1, 6, v0
    v_and_b32 v2, 63, v0
    v_readfirstlane_b32 s3, v1
    s_and_b32 s4, s2, 7
    s_lshl_b32 s4, s4, 2
    s_lshr_b32 s38, s2, 3
    s_and_b32 s38, s38, 3
    s_add_u32 s4, s4, s38
    s_lshr_b32 s5, s2, 5
    s_waitcnt lgkmcnt(0)
    s_mov_b32 s20, s40
    s_mov_b32 s21, s41
    s_mov_b32 s22, 0x400000
    s_mov_b32 s23, 0x00020000
    s_mov_b32 s8, s42
    s_mov_b32 s9, s43
    s_mov_b32 s10, 0x200000
    s_mov_b32 s11, 0x00020000
    s_cmp_lt_u32 s3, 2
    s_cselect_b32 s50, s44, s46
    s_cselect_b32 s51, s45, s47
    s_mov_b32 s12, s50
    s_mov_b32 s13, s51
    s_mov_b32 s14, 0x400000
    s_mov_b32 s15, 0x00020000
    s_add_u32 s16, s48, 0x400000
    s_addc_u32 s17, s49, 0
    s_mov_b32 s18, 0x2000000
    s_mov_b32 s19, 0x00020000
    s_mov_b32 s24, s48
    s_mov_b32 s25, s49
    s_mov_b32 s26, 0x400000
    s_mov_b32 s27, 0x00020000
    s_add_u32 s28, s48, 0x3800000
    s_addc_u32 s29, s49, 0
    s_mov_b32 s30, 0x6040
    s_mov_b32 s31, 0x00020000
    s_lshl_b32 s38, s2, 3
    s_lshl1_add_u32 s38, s3, s38
    v_lshrrev_b32 v140, 5, v2
    v_add_u32 v140, s38, v140
    v_and_b32 v141, 31, v2
    v_lshlrev_b32 v142, 11, v140
    v_lshl_add_u32 v142, v141, 4, v142
    buffer_load_dwordx4 v[160:163], v142, s[20:23], 0 offen offset:0
    buffer_load_dwordx4 v[164:167], v142, s[20:23], 0 offen offset:512
    buffer_load_dwordx4 v[168:171], v142, s[20:23], 0 offen offset:1024
    buffer_load_dwordx4 v[172:175], v142, s[20:23], 0 offen offset:1536
    v_lshrrev_b32 v143, 5, v140
    v_lshlrev_b32 v144, 16, v143
    v_and_b32 v143, 31, v140
    v_lshl_add_u32 v144, v143, 4, v144
    v_lshl_add_u32 v144, v141, 9, v144
    v_lshrrev_b32 v145, 3, v2
    v_and_b32 v146, 7, v2
    s_lshr_b32 s38, s3, 1
    s_lshl_b32 s38, s38, 5
    s_and_b32 s52, s3, 1
    s_lshl_b32 s53, s52, 3
    s_add_u32 s38, s38, s53
    v_add_u32 v140, s38, v145
    v_lshlrev_b32 v140, 10, v140
    v_lshrrev_b32 v141, 1, v145
    v_xor_b32 v141, v146, v141
    v_lshl_add_u32 v134, v141, 4, v140
    v_xor_b32 v141, 4, v141
    v_lshl_add_u32 v135, v141, 4, v140
    v_add_u32 v135, 16384, v135
    s_lshl_b32 s38, s4, 8
    s_lshl_b32 s53, s52, 7
    s_add_u32 s38, s38, s53
    v_lshlrev_b32 v140, 13, v145
    v_add_u32 v140, s38, v140
    v_bfe_u32 v141, v145, 1, 1
    v_xor_b32 v141, v146, v141
    v_lshl_add_u32 v136, v141, 4, v140
    v_xor_b32 v141, 4, v141
    v_lshl_add_u32 v137, v141, 4, v140
    v_add_u32 v137, 65536, v137
    s_lshl_b32 s34, s3, 11
    s_mul_i32 s35, s3, 24576
    s_add_u32 s35, s35, 65536
    s_lshl_b32 s32, s5, 18
    s_add_u32 s39, s32, 262144
    s_mov_b32 s33, 0
    s_add_u32 m0, s35, 0
    s_mov_b32 s33, 0
    buffer_load_dwordx4 v136, s[12:15], s33 offen lds
    s_add_u32 m0, s35, 1024
    s_nop 0
    buffer_load_dwordx4 v137, s[12:15], s33 offen lds
    s_add_u32 m0, s35, 2048
    s_mov_b32 s33, 131072
    buffer_load_dwordx4 v136, s[12:15], s33 offen lds
    s_add_u32 m0, s35, 3072
    s_nop 0
    buffer_load_dwordx4 v137, s[12:15], s33 offen lds
    s_add_u32 m0, s35, 4096
    s_mov_b32 s33, 262144
    buffer_load_dwordx4 v136, s[12:15], s33 offen lds
    s_add_u32 m0, s35, 5120
    s_nop 0
    buffer_load_dwordx4 v137, s[12:15], s33 offen lds
    s_add_u32 m0, s35, 6144
    s_mov_b32 s33, 393216
    buffer_load_dwordx4 v136, s[12:15], s33 offen lds
    s_add_u32 m0, s35, 7168
    s_nop 0
    buffer_load_dwordx4 v137, s[12:15], s33 offen lds
    s_add_u32 m0, s34, 0
    s_add_u32 s38, s32, 0
    buffer_load_dwordx4 v134, s[8:11], s38 offen lds
    s_add_u32 m0, s34, 1024
    s_nop 0
    buffer_load_dwordx4 v135, s[8:11], s38 offen lds
    s_add_u32 m0, s34, 8192
    s_add_u32 s38, s32, 128
    buffer_load_dwordx4 v134, s[8:11], s38 offen lds
    s_add_u32 m0, s34, 9216
    s_nop 0
    buffer_load_dwordx4 v135, s[8:11], s38 offen lds
    s_add_u32 m0, s35, 8192
    s_mov_b32 s33, 524288
    buffer_load_dwordx4 v136, s[12:15], s33 offen lds
    s_add_u32 m0, s35, 9216
    s_nop 0
    buffer_load_dwordx4 v137, s[12:15], s33 offen lds
    s_add_u32 m0, s35, 10240
    s_mov_b32 s33, 655360
    buffer_load_dwordx4 v136, s[12:15], s33 offen lds
    s_add_u32 m0, s35, 11264
    s_nop 0
    buffer_load_dwordx4 v137, s[12:15], s33 offen lds
    s_add_u32 m0, s35, 12288
    s_mov_b32 s33, 786432
    buffer_load_dwordx4 v136, s[12:15], s33 offen lds
    s_add_u32 m0, s35, 13312
    s_nop 0
    buffer_load_dwordx4 v137, s[12:15], s33 offen lds
    s_add_u32 m0, s35, 14336
    s_mov_b32 s33, 917504
    buffer_load_dwordx4 v136, s[12:15], s33 offen lds
    s_add_u32 m0, s35, 15360
    s_nop 0
    buffer_load_dwordx4 v137, s[12:15], s33 offen lds
    s_add_u32 m0, s34, 16384
    s_add_u32 s38, s32, 256
    buffer_load_dwordx4 v134, s[8:11], s38 offen lds
    s_add_u32 m0, s34, 17408
    s_nop 0
    buffer_load_dwordx4 v135, s[8:11], s38 offen lds
    s_add_u32 m0, s34, 24576
    s_add_u32 s38, s32, 384
    buffer_load_dwordx4 v134, s[8:11], s38 offen lds
    s_add_u32 m0, s34, 25600
    s_nop 0
    buffer_load_dwordx4 v135, s[8:11], s38 offen lds
    s_add_u32 m0, s35, 16384
    s_mov_b32 s33, 1048576
    buffer_load_dwordx4 v136, s[12:15], s33 offen lds
    s_add_u32 m0, s35, 17408
    s_nop 0
    buffer_load_dwordx4 v137, s[12:15], s33 offen lds
    s_add_u32 m0, s35, 18432
    s_mov_b32 s33, 1179648
    buffer_load_dwordx4 v136, s[12:15], s33 offen lds
    s_add_u32 m0, s35, 19456
    s_nop 0
    buffer_load_dwordx4 v137, s[12:15], s33 offen lds
    s_add_u32 m0, s35, 20480
    s_mov_b32 s33, 1310720
    buffer_load_dwordx4 v136, s[12:15], s33 offen lds
    s_add_u32 m0, s35, 21504
    s_nop 0
    buffer_load_dwordx4 v137, s[12:15], s33 offen lds
    s_add_u32 m0, s35, 22528
    s_mov_b32 s33, 1441792
    buffer_load_dwordx4 v136, s[12:15], s33 offen lds
    s_add_u32 m0, s35, 23552
    s_nop 0
    buffer_load_dwordx4 v137, s[12:15], s33 offen lds
    s_add_u32 m0, s34, 32768
    s_add_u32 s38, s32, 512
    buffer_load_dwordx4 v134, s[8:11], s38 offen lds
    s_add_u32 m0, s34, 33792
    s_nop 0
    buffer_load_dwordx4 v135, s[8:11], s38 offen lds
    s_add_u32 m0, s34, 40960
    s_add_u32 s38, s32, 640
    buffer_load_dwordx4 v134, s[8:11], s38 offen lds
    s_add_u32 m0, s34, 41984
    s_nop 0
    buffer_load_dwordx4 v135, s[8:11], s38 offen lds
    s_add_u32 m0, s34, 49152
    s_add_u32 s38, s32, 768
    buffer_load_dwordx4 v134, s[8:11], s38 offen lds
    s_add_u32 m0, s34, 50176
    s_nop 0
    buffer_load_dwordx4 v135, s[8:11], s38 offen lds
    s_add_u32 m0, s34, 57344
    s_add_u32 s38, s32, 896
    buffer_load_dwordx4 v134, s[8:11], s38 offen lds
    s_add_u32 m0, s34, 58368
    s_nop 0
    buffer_load_dwordx4 v135, s[8:11], s38 offen lds
    s_add_u32 s32, s32, 65536
    s_cmp_ge_u32 s32, s39
    s_cselect_b32 s32, 0x40000000, s32
    v_and_b32 v147, 15, v2
    v_lshrrev_b32 v148, 4, v2
    v_lshrrev_b32 v140, 1, v147
    v_xor_b32 v140, v148, v140
    v_lshlrev_b32 v140, 4, v140
    v_lshl_add_u32 v128, v147, 7, v140
    v_xor_b32 v129, 64, v128
    v_lshrrev_b32 v140, 2, v147
    v_lshl_add_u32 v141, v148, 3, v140
    v_lshlrev_b32 v141, 7, v141
    v_add_u32 v141, s35, v141
    v_and_b32 v142, 1, v147
    v_lshl_add_u32 v141, v142, 3, v141
    v_lshrrev_b32 v140, 1, v140
    v_and_b32 v142, 1, v148
    v_lshl_or_b32 v140, v142, 2, v140
    v_and_b32 v142, 2, v147
    v_xor_b32 v140, v140, v142
    v_xor_b32 v142, 0, v140
    v_lshl_add_u32 v130, v142, 4, v141
    v_xor_b32 v142, 1, v140
    v_lshl_add_u32 v131, v142, 4, v141
    v_xor_b32 v142, 4, v140
    v_lshl_add_u32 v132, v142, 4, v141
    v_xor_b32 v142, 5, v140
    v_lshl_add_u32 v133, v142, 4, v141
    s_lshl_b32 s36, s4, 20
    s_lshl_b32 s38, s5, 17
    s_add_u32 s36, s36, s38
    v_and_b32 v140, 1, v148
    v_lshlrev_b32 v140, 9, v140
    v_and_b32 v141, 8, v147
    v_lshl_add_u32 v140, v141, 5, v140
    v_and_b32 v141, 7, v147
    v_lshl_add_u32 v140, v141, 4, v140
    v_lshrrev_b32 v141, 1, v148
    s_cmp_lt_u32 s3, 2
    s_cselect_b32 s53, 10, 12
    s_cselect_b32 s54, 12, 11
    s_cselect_b32 s55, 0, 16384
    s_lshl_b32 s54, s52, s54
    s_add_u32 s54, s54, s55
    v_lshlrev_b32 v141, s53, v141
    v_add3_u32 v138, v140, v141, s54
    s_mul_i32 s38, s2, 100
    v_lshl_add_u32 v140, v0, 2, s38
    v_cmp_gt_u32 vcc, 25, v0
    v_mov_b32 v141, 0
    v_mov_b32 v142, 0x7ffffff0
    v_cndmask_b32 v140, v142, v140, vcc
    buffer_store_dword v141, v140, s[28:31], 0 offen
    s_waitcnt vmcnt(41)
    v_lshlrev_b32 v176, 16, v160
    v_and_b32 v177, 0xffff0000, v160
    v_lshlrev_b32 v178, 16, v161
    v_and_b32 v179, 0xffff0000, v161
    v_lshlrev_b32 v180, 16, v162
    v_and_b32 v181, 0xffff0000, v162
    v_lshlrev_b32 v182, 16, v163
    v_and_b32 v183, 0xffff0000, v163
    v_lshlrev_b32 v184, 16, v164
    v_and_b32 v185, 0xffff0000, v164
    v_lshlrev_b32 v186, 16, v165
    v_and_b32 v187, 0xffff0000, v165
    v_lshlrev_b32 v188, 16, v166
    v_and_b32 v189, 0xffff0000, v166
    v_lshlrev_b32 v190, 16, v167
    v_and_b32 v191, 0xffff0000, v167
    v_lshlrev_b32 v192, 16, v168
    v_and_b32 v193, 0xffff0000, v168
    v_lshlrev_b32 v194, 16, v169
    v_and_b32 v195, 0xffff0000, v169
    v_lshlrev_b32 v196, 16, v170
    v_and_b32 v197, 0xffff0000, v170
    v_lshlrev_b32 v198, 16, v171
    v_and_b32 v199, 0xffff0000, v171
    v_lshlrev_b32 v200, 16, v172
    v_and_b32 v201, 0xffff0000, v172
    v_lshlrev_b32 v202, 16, v173
    v_and_b32 v203, 0xffff0000, v173
    v_lshlrev_b32 v204, 16, v174
    v_and_b32 v205, 0xffff0000, v174
    v_lshlrev_b32 v206, 16, v175
    v_and_b32 v207, 0xffff0000, v175
    v_add_f32 v212, v176, v180
    v_add_f32 v213, v177, v181
    v_add_f32 v214, v178, v182
    v_add_f32 v215, v179, v183
    v_add_f32 v212, v212, v184
    v_add_f32 v213, v213, v185
    v_add_f32 v214, v214, v186
    v_add_f32 v215, v215, v187
    v_add_f32 v212, v212, v188
    v_add_f32 v213, v213, v189
    v_add_f32 v214, v214, v190
    v_add_f32 v215, v215, v191
    v_add_f32 v212, v212, v192
    v_add_f32 v213, v213, v193
    v_add_f32 v214, v214, v194
    v_add_f32 v215, v215, v195
    v_add_f32 v212, v212, v196
    v_add_f32 v213, v213, v197
    v_add_f32 v214, v214, v198
    v_add_f32 v215, v215, v199
    v_add_f32 v212, v212, v200
    v_add_f32 v213, v213, v201
    v_add_f32 v214, v214, v202
    v_add_f32 v215, v215, v203
    v_add_f32 v212, v212, v204
    v_add_f32 v213, v213, v205
    v_add_f32 v214, v214, v206
    v_add_f32 v215, v215, v207
    v_add_f32 v212, v212, v213
    v_add_f32 v214, v214, v215
    v_add_f32 v208, v212, v214
    s_nop 1
    v_add_f32_dpp v208, v208, v208 quad_perm:[1,0,3,2] row_mask:0xf bank_mask:0xf
    s_nop 1
    v_add_f32_dpp v208, v208, v208 quad_perm:[2,3,0,1] row_mask:0xf bank_mask:0xf
    s_nop 1
    v_add_f32_dpp v208, v208, v208 row_half_mirror row_mask:0xf bank_mask:0xf
    s_nop 1
    v_add_f32_dpp v208, v208, v208 row_mirror row_mask:0xf bank_mask:0xf
    s_nop 0
    v_mov_b32 v209, v208
    s_nop 1
    v_permlane16_swap_b32 v208, v209
    s_nop 0
    v_add_f32 v208, v208, v209
    v_mul_f32 v208, 0x3a800000, v208
    v_sub_f32 v216, v176, v208
    v_mul_f32 v212, v216, v216
    v_sub_f32 v217, v177, v208
    v_mul_f32 v213, v217, v217
    v_sub_f32 v218, v178, v208
    v_mul_f32 v214, v218, v218
    v_sub_f32 v219, v179, v208
    v_mul_f32 v215, v219, v219
    v_sub_f32 v216, v180, v208
    v_fmac_f32 v212, v216, v216
    v_sub_f32 v217, v181, v208
    v_fmac_f32 v213, v217, v217
    v_sub_f32 v218, v182, v208
    v_fmac_f32 v214, v218, v218
    v_sub_f32 v219, v183, v208
    v_fmac_f32 v215, v219, v219
    v_sub_f32 v216, v184, v208
    v_fmac_f32 v212, v216, v216
    v_sub_f32 v217, v185, v208
    v_fmac_f32 v213, v217, v217
    v_sub_f32 v218, v186, v208
    v_fmac_f32 v214, v218, v218
    v_sub_f32 v219, v187, v208
    v_fmac_f32 v215, v219, v219
    v_sub_f32 v216, v188, v208
    v_fmac_f32 v212, v216, v216
    v_sub_f32 v217, v189, v208
    v_fmac_f32 v213, v217, v217
    v_sub_f32 v218, v190, v208
    v_fmac_f32 v214, v218, v218
    v_sub_f32 v219, v191, v208
    v_fmac_f32 v215, v219, v219
    v_sub_f32 v216, v192, v208
    v_fmac_f32 v212, v216, v216
    v_sub_f32 v217, v193, v208
    v_fmac_f32 v213, v217, v217
    v_sub_f32 v218, v194, v208
    v_fmac_f32 v214, v218, v218
    v_sub_f32 v219, v195, v208
    v_fmac_f32 v215, v219, v219
    v_sub_f32 v216, v196, v208
    v_fmac_f32 v212, v216, v216
    v_sub_f32 v217, v197, v208
    v_fmac_f32 v213, v217, v217
    v_sub_f32 v218, v198, v208
    v_fmac_f32 v214, v218, v218
    v_sub_f32 v219, v199, v208
    v_fmac_f32 v215, v219, v219
    v_sub_f32 v216, v200, v208
    v_fmac_f32 v212, v216, v216
    v_sub_f32 v217, v201, v208
    v_fmac_f32 v213, v217, v217
    v_sub_f32 v218, v202, v208
    v_fmac_f32 v214, v218, v218
    v_sub_f32 v219, v203, v208
    v_fmac_f32 v215, v219, v219
    v_sub_f32 v216, v204, v208
    v_fmac_f32 v212, v216, v216
    v_sub_f32 v217, v205, v208
    v_fmac_f32 v213, v217, v217
    v_sub_f32 v218, v206, v208
    v_fmac_f32 v214, v218, v218
    v_sub_f32 v219, v207, v208
    v_fmac_f32 v215, v219, v219
    v_add_f32 v212, v212, v213
    v_add_f32 v214, v214, v215
    v_add_f32 v211, v212, v214
    s_nop 1
    v_add_f32_dpp v211, v211, v211 quad_perm:[1,0,3,2] row_mask:0xf bank_mask:0xf
    s_nop 1
    v_add_f32_dpp v211, v211, v211 quad_perm:[2,3,0,1] row_mask:0xf bank_mask:0xf
    s_nop 1
    v_add_f32_dpp v211, v211, v211 row_half_mirror row_mask:0xf bank_mask:0xf
    s_nop 1
    v_add_f32_dpp v211, v211, v211 row_mirror row_mask:0xf bank_mask:0xf
    s_nop 0
    v_mov_b32 v209, v211
    s_nop 1
    v_permlane16_swap_b32 v211, v209
    s_nop 0
    v_add_f32 v211, v211, v209
    v_mul_f32 v211, 0x3a800000, v211
    v_cvt_pk_bf16_f32 v210, v208, v211
    v_and_b32 v211, 0xffff0000, v210
    v_lshlrev_b32 v210, 16, v210
    v_add_f32 v211, 0x3727c5ac, v211
    v_cvt_pk_bf16_f32 v211, v211, v211
    v_lshlrev_b32 v211, 16, v211
    v_sqrt_f32 v211, v211
    s_nop 0
    v_cvt_pk_bf16_f32 v211, v211, v211
    v_lshlrev_b32 v211, 16, v211
    v_rcp_f32 v211, v211
    s_nop 0
    v_sub_f32 v176, v176, v210
    v_sub_f32 v177, v177, v210
    v_cvt_pk_bf16_f32 v177, v176, v177
    v_lshlrev_b32 v176, 16, v177
    v_and_b32 v177, 0xffff0000, v177
    v_mul_f32 v176, v176, v211
    v_mul_f32 v177, v177, v211
    v_cvt_pk_bf16_f32 v160, v176, v177
    v_sub_f32 v178, v178, v210
    v_sub_f32 v179, v179, v210
    v_cvt_pk_bf16_f32 v179, v178, v179
    v_lshlrev_b32 v178, 16, v179
    v_and_b32 v179, 0xffff0000, v179
    v_mul_f32 v178, v178, v211
    v_mul_f32 v179, v179, v211
    v_cvt_pk_bf16_f32 v161, v178, v179
    v_sub_f32 v180, v180, v210
    v_sub_f32 v181, v181, v210
    v_cvt_pk_bf16_f32 v181, v180, v181
    v_lshlrev_b32 v180, 16, v181
    v_and_b32 v181, 0xffff0000, v181
    v_mul_f32 v180, v180, v211
    v_mul_f32 v181, v181, v211
    v_cvt_pk_bf16_f32 v162, v180, v181
    v_sub_f32 v182, v182, v210
    v_sub_f32 v183, v183, v210
    v_cvt_pk_bf16_f32 v183, v182, v183
    v_lshlrev_b32 v182, 16, v183
    v_and_b32 v183, 0xffff0000, v183
    v_mul_f32 v182, v182, v211
    v_mul_f32 v183, v183, v211
    v_cvt_pk_bf16_f32 v163, v182, v183
    v_sub_f32 v184, v184, v210
    v_sub_f32 v185, v185, v210
    v_cvt_pk_bf16_f32 v185, v184, v185
    v_lshlrev_b32 v184, 16, v185
    v_and_b32 v185, 0xffff0000, v185
    v_mul_f32 v184, v184, v211
    v_mul_f32 v185, v185, v211
    v_cvt_pk_bf16_f32 v164, v184, v185
    v_sub_f32 v186, v186, v210
    v_sub_f32 v187, v187, v210
    v_cvt_pk_bf16_f32 v187, v186, v187
    v_lshlrev_b32 v186, 16, v187
    v_and_b32 v187, 0xffff0000, v187
    v_mul_f32 v186, v186, v211
    v_mul_f32 v187, v187, v211
    v_cvt_pk_bf16_f32 v165, v186, v187
    v_sub_f32 v188, v188, v210
    v_sub_f32 v189, v189, v210
    v_cvt_pk_bf16_f32 v189, v188, v189
    v_lshlrev_b32 v188, 16, v189
    v_and_b32 v189, 0xffff0000, v189
    v_mul_f32 v188, v188, v211
    v_mul_f32 v189, v189, v211
    v_cvt_pk_bf16_f32 v166, v188, v189
    v_sub_f32 v190, v190, v210
    v_sub_f32 v191, v191, v210
    v_cvt_pk_bf16_f32 v191, v190, v191
    v_lshlrev_b32 v190, 16, v191
    v_and_b32 v191, 0xffff0000, v191
    v_mul_f32 v190, v190, v211
    v_mul_f32 v191, v191, v211
    v_cvt_pk_bf16_f32 v167, v190, v191
    v_sub_f32 v192, v192, v210
    v_sub_f32 v193, v193, v210
    v_cvt_pk_bf16_f32 v193, v192, v193
    v_lshlrev_b32 v192, 16, v193
    v_and_b32 v193, 0xffff0000, v193
    v_mul_f32 v192, v192, v211
    v_mul_f32 v193, v193, v211
    v_cvt_pk_bf16_f32 v168, v192, v193
    v_sub_f32 v194, v194, v210
    v_sub_f32 v195, v195, v210
    v_cvt_pk_bf16_f32 v195, v194, v195
    v_lshlrev_b32 v194, 16, v195
    v_and_b32 v195, 0xffff0000, v195
    v_mul_f32 v194, v194, v211
    v_mul_f32 v195, v195, v211
    v_cvt_pk_bf16_f32 v169, v194, v195
    v_sub_f32 v196, v196, v210
    v_sub_f32 v197, v197, v210
    v_cvt_pk_bf16_f32 v197, v196, v197
    v_lshlrev_b32 v196, 16, v197
    v_and_b32 v197, 0xffff0000, v197
    v_mul_f32 v196, v196, v211
    v_mul_f32 v197, v197, v211
    v_cvt_pk_bf16_f32 v170, v196, v197
    v_sub_f32 v198, v198, v210
    v_sub_f32 v199, v199, v210
    v_cvt_pk_bf16_f32 v199, v198, v199
    v_lshlrev_b32 v198, 16, v199
    v_and_b32 v199, 0xffff0000, v199
    v_mul_f32 v198, v198, v211
    v_mul_f32 v199, v199, v211
    v_cvt_pk_bf16_f32 v171, v198, v199
    v_sub_f32 v200, v200, v210
    v_sub_f32 v201, v201, v210
    v_cvt_pk_bf16_f32 v201, v200, v201
    v_lshlrev_b32 v200, 16, v201
    v_and_b32 v201, 0xffff0000, v201
    v_mul_f32 v200, v200, v211
    v_mul_f32 v201, v201, v211
    v_cvt_pk_bf16_f32 v172, v200, v201
    v_sub_f32 v202, v202, v210
    v_sub_f32 v203, v203, v210
    v_cvt_pk_bf16_f32 v203, v202, v203
    v_lshlrev_b32 v202, 16, v203
    v_and_b32 v203, 0xffff0000, v203
    v_mul_f32 v202, v202, v211
    v_mul_f32 v203, v203, v211
    v_cvt_pk_bf16_f32 v173, v202, v203
    v_sub_f32 v204, v204, v210
    v_sub_f32 v205, v205, v210
    v_cvt_pk_bf16_f32 v205, v204, v205
    v_lshlrev_b32 v204, 16, v205
    v_and_b32 v205, 0xffff0000, v205
    v_mul_f32 v204, v204, v211
    v_mul_f32 v205, v205, v211
    v_cvt_pk_bf16_f32 v174, v204, v205
    v_sub_f32 v206, v206, v210
    v_sub_f32 v207, v207, v210
    v_cvt_pk_bf16_f32 v207, v206, v207
    v_lshlrev_b32 v206, 16, v207
    v_and_b32 v207, 0xffff0000, v207
    v_mul_f32 v206, v206, v211
    v_mul_f32 v207, v207, v211
    v_cvt_pk_bf16_f32 v175, v206, v207
    s_mov_b32 s38, 0
    buffer_store_dwordx4 v[160:163], v144, s[24:27], s38 offen
    s_mov_b32 s38, 16384
    buffer_store_dwordx4 v[164:167], v144, s[24:27], s38 offen
    s_mov_b32 s38, 32768
    buffer_store_dwordx4 v[168:171], v144, s[24:27], s38 offen
    s_mov_b32 s38, 49152
    buffer_store_dwordx4 v[172:175], v144, s[24:27], s38 offen
    s_waitcnt vmcnt(33)
    s_barrier
    ds_read_b128 v[64:67], v128 offset:0
    ds_read_b128 v[68:71], v128 offset:2048
    ds_read_b128 v[72:75], v128 offset:4096
    ds_read_b128 v[76:79], v128 offset:6144
    ds_read_b64_tr_b16 a[0:1], v130 offset:0
    ds_read_b64_tr_b16 a[2:3], v130 offset:512
    ds_read_b64_tr_b16 a[4:5], v131 offset:0
    ds_read_b64_tr_b16 a[6:7], v131 offset:512
    ds_read_b64_tr_b16 a[8:9], v132 offset:0
    ds_read_b64_tr_b16 a[10:11], v132 offset:512
    ds_read_b64_tr_b16 a[12:13], v133 offset:0
    ds_read_b64_tr_b16 a[14:15], v133 offset:512
    s_cmp_lt_u32 s3, 2
    s_cbranch_scc0 k1_V
k1_K:
    s_waitcnt lgkmcnt(0)
    v_mfma_f32_16x16x32_bf16 v[0:3], a[0:3], v[64:67], 0
    ds_read_b128 v[80:83], v129 offset:0
    ds_read_b128 v[84:87], v129 offset:2048
    v_mfma_f32_16x16x32_bf16 v[4:7], a[4:7], v[64:67], 0
    ds_read_b128 v[88:91], v129 offset:4096
    v_mfma_f32_16x16x32_bf16 v[8:11], a[8:11], v[64:67], 0
    ds_read_b128 v[92:95], v129 offset:6144
    ds_read_b64_tr_b16 a[16:17], v130 offset:4096
    v_mfma_f32_16x16x32_bf16 v[12:15], a[12:15], v[64:67], 0
    ds_read_b64_tr_b16 a[18:19], v130 offset:4608
    v_mfma_f32_16x16x32_bf16 v[16:19], a[0:3], v[68:71], 0
    ds_read_b64_tr_b16 a[20:21], v131 offset:4096
    ds_read_b64_tr_b16 a[22:23], v131 offset:4608
    v_mfma_f32_16x16x32_bf16 v[20:23], a[4:7], v[68:71], 0
    ds_read_b64_tr_b16 a[24:25], v132 offset:4096
    v_mfma_f32_16x16x32_bf16 v[24:27], a[8:11], v[68:71], 0
    ds_read_b64_tr_b16 a[26:27], v132 offset:4608
    ds_read_b64_tr_b16 a[28:29], v133 offset:4096
    v_mfma_f32_16x16x32_bf16 v[28:31], a[12:15], v[68:71], 0
    ds_read_b64_tr_b16 a[30:31], v133 offset:4608
    v_mfma_f32_16x16x32_bf16 v[32:35], a[0:3], v[72:75], 0
    v_mfma_f32_16x16x32_bf16 v[36:39], a[4:7], v[72:75], 0
    v_mfma_f32_16x16x32_bf16 v[40:43], a[8:11], v[72:75], 0
    v_mfma_f32_16x16x32_bf16 v[44:47], a[12:15], v[72:75], 0
    v_mfma_f32_16x16x32_bf16 v[48:51], a[0:3], v[76:79], 0
    v_mfma_f32_16x16x32_bf16 v[52:55], a[4:7], v[76:79], 0
    v_mfma_f32_16x16x32_bf16 v[56:59], a[8:11], v[76:79], 0
    v_mfma_f32_16x16x32_bf16 v[60:63], a[12:15], v[76:79], 0
    s_waitcnt vmcnt(25) lgkmcnt(0)
    v_mfma_f32_16x16x32_bf16 v[0:3], a[16:19], v[80:83], v[0:3]
    ds_read_b128 v[64:67], v128 offset:8192
    ds_read_b128 v[68:71], v128 offset:10240
    v_mfma_f32_16x16x32_bf16 v[4:7], a[20:23], v[80:83], v[4:7]
    ds_read_b128 v[72:75], v128 offset:12288
    v_mfma_f32_16x16x32_bf16 v[8:11], a[24:27], v[80:83], v[8:11]
    ds_read_b128 v[76:79], v128 offset:14336
    ds_read_b64_tr_b16 a[32:33], v130 offset:8192
    v_mfma_f32_16x16x32_bf16 v[12:15], a[28:31], v[80:83], v[12:15]
    ds_read_b64_tr_b16 a[34:35], v130 offset:8704
    v_mfma_f32_16x16x32_bf16 v[16:19], a[16:19], v[84:87], v[16:19]
    ds_read_b64_tr_b16 a[36:37], v131 offset:8192
    ds_read_b64_tr_b16 a[38:39], v131 offset:8704
    s_add_u32 m0, s35, 0
    s_mov_b32 s33, 1572864
    buffer_load_dwordx4 v136, s[12:15], s33 offen lds
    v_mfma_f32_16x16x32_bf16 v[20:23], a[20:23], v[84:87], v[20:23]
    ds_read_b64_tr_b16 a[40:41], v132 offset:8192
    s_add_u32 m0, s35, 1024
    s_nop 0
    buffer_load_dwordx4 v137, s[12:15], s33 offen lds
    v_mfma_f32_16x16x32_bf16 v[24:27], a[24:27], v[84:87], v[24:27]
    ds_read_b64_tr_b16 a[42:43], v132 offset:8704
    ds_read_b64_tr_b16 a[44:45], v133 offset:8192
    s_add_u32 m0, s35, 2048
    s_mov_b32 s33, 1703936
    buffer_load_dwordx4 v136, s[12:15], s33 offen lds
    v_mfma_f32_16x16x32_bf16 v[28:31], a[28:31], v[84:87], v[28:31]
    ds_read_b64_tr_b16 a[46:47], v133 offset:8704
    s_add_u32 m0, s35, 3072
    s_nop 0
    buffer_load_dwordx4 v137, s[12:15], s33 offen lds
    v_mfma_f32_16x16x32_bf16 v[32:35], a[16:19], v[88:91], v[32:35]
    s_add_u32 m0, s35, 4096
    s_mov_b32 s33, 1835008
    buffer_load_dwordx4 v136, s[12:15], s33 offen lds
    v_mfma_f32_16x16x32_bf16 v[36:39], a[20:23], v[88:91], v[36:39]
    s_add_u32 m0, s35, 5120
    s_nop 0
    buffer_load_dwordx4 v137, s[12:15], s33 offen lds
    v_mfma_f32_16x16x32_bf16 v[40:43], a[24:27], v[88:91], v[40:43]
    s_add_u32 m0, s35, 6144
    s_mov_b32 s33, 1966080
    buffer_load_dwordx4 v136, s[12:15], s33 offen lds
    v_mfma_f32_16x16x32_bf16 v[44:47], a[28:31], v[88:91], v[44:47]
    s_add_u32 m0, s35, 7168
    s_nop 0
    buffer_load_dwordx4 v137, s[12:15], s33 offen lds
    v_mfma_f32_16x16x32_bf16 v[48:51], a[16:19], v[92:95], v[48:51]
    v_mfma_f32_16x16x32_bf16 v[52:55], a[20:23], v[92:95], v[52:55]
    v_mfma_f32_16x16x32_bf16 v[56:59], a[24:27], v[92:95], v[56:59]
    v_mfma_f32_16x16x32_bf16 v[60:63], a[28:31], v[92:95], v[60:63]
    s_waitcnt lgkmcnt(0)
    v_mfma_f32_16x16x32_bf16 v[0:3], a[32:35], v[64:67], v[0:3]
    ds_read_b128 v[80:83], v129 offset:8192
    ds_read_b128 v[84:87], v129 offset:10240
    v_mfma_f32_16x16x32_bf16 v[4:7], a[36:39], v[64:67], v[4:7]
    ds_read_b128 v[88:91], v129 offset:12288
    v_mfma_f32_16x16x32_bf16 v[8:11], a[40:43], v[64:67], v[8:11]
    ds_read_b128 v[92:95], v129 offset:14336
    ds_read_b64_tr_b16 a[48:49], v130 offset:12288
    v_mfma_f32_16x16x32_bf16 v[12:15], a[44:47], v[64:67], v[12:15]
    ds_read_b64_tr_b16 a[50:51], v130 offset:12800
    v_mfma_f32_16x16x32_bf16 v[16:19], a[32:35], v[68:71], v[16:19]
    ds_read_b64_tr_b16 a[52:53], v131 offset:12288
    ds_read_b64_tr_b16 a[54:55], v131 offset:12800
    v_mfma_f32_16x16x32_bf16 v[20:23], a[36:39], v[68:71], v[20:23]
    ds_read_b64_tr_b16 a[56:57], v132 offset:12288
    v_mfma_f32_16x16x32_bf16 v[24:27], a[40:43], v[68:71], v[24:27]
    ds_read_b64_tr_b16 a[58:59], v132 offset:12800
    ds_read_b64_tr_b16 a[60:61], v133 offset:12288
    v_mfma_f32_16x16x32_bf16 v[28:31], a[44:47], v[68:71], v[28:31]
    ds_read_b64_tr_b16 a[62:63], v133 offset:12800
    v_mfma_f32_16x16x32_bf16 v[32:35], a[32:35], v[72:75], v[32:35]
    v_mfma_f32_16x16x32_bf16 v[36:39], a[36:39], v[72:75], v[36:39]
    v_mfma_f32_16x16x32_bf16 v[40:43], a[40:43], v[72:75], v[40:43]
    v_mfma_f32_16x16x32_bf16 v[44:47], a[44:47], v[72:75], v[44:47]
    v_mfma_f32_16x16x32_bf16 v[48:51], a[32:35], v[76:79], v[48:51]
    v_mfma_f32_16x16x32_bf16 v[52:55], a[36:39], v[76:79], v[52:55]
    v_mfma_f32_16x16x32_bf16 v[56:59], a[40:43], v[76:79], v[56:59]
    v_mfma_f32_16x16x32_bf16 v[60:63], a[44:47], v[76:79], v[60:63]
    s_waitcnt vmcnt(21) lgkmcnt(0)
    s_barrier
    v_mfma_f32_16x16x32_bf16 v[0:3], a[48:51], v[80:83], v[0:3]
    ds_read_b128 v[64:67], v128 offset:16384
    ds_read_b128 v[68:71], v128 offset:18432
    v_mfma_f32_16x16x32_bf16 v[4:7], a[52:55], v[80:83], v[4:7]
    ds_read_b128 v[72:75], v128 offset:20480
    v_mfma_f32_16x16x32_bf16 v[8:11], a[56:59], v[80:83], v[8:11]
    ds_read_b128 v[76:79], v128 offset:22528
    ds_read_b64_tr_b16 a[64:65], v130 offset:16384
    v_mfma_f32_16x16x32_bf16 v[12:15], a[60:63], v[80:83], v[12:15]
    ds_read_b64_tr_b16 a[66:67], v130 offset:16896
    v_mfma_f32_16x16x32_bf16 v[16:19], a[48:51], v[84:87], v[16:19]
    ds_read_b64_tr_b16 a[68:69], v131 offset:16384
    ds_read_b64_tr_b16 a[70:71], v131 offset:16896
    s_add_u32 m0, s34, 0
    s_add_u32 s38, s32, 0
    buffer_load_dwordx4 v134, s[8:11], s38 offen lds
    v_mfma_f32_16x16x32_bf16 v[20:23], a[52:55], v[84:87], v[20:23]
    ds_read_b64_tr_b16 a[72:73], v132 offset:16384
    s_add_u32 m0, s34, 1024
    s_nop 0
    buffer_load_dwordx4 v135, s[8:11], s38 offen lds
    v_mfma_f32_16x16x32_bf16 v[24:27], a[56:59], v[84:87], v[24:27]
    ds_read_b64_tr_b16 a[74:75], v132 offset:16896
    ds_read_b64_tr_b16 a[76:77], v133 offset:16384
    s_add_u32 m0, s34, 8192
    s_add_u32 s38, s32, 128
    buffer_load_dwordx4 v134, s[8:11], s38 offen lds
    v_mfma_f32_16x16x32_bf16 v[28:31], a[60:63], v[84:87], v[28:31]
    ds_read_b64_tr_b16 a[78:79], v133 offset:16896
    s_add_u32 m0, s34, 9216
    s_nop 0
    buffer_load_dwordx4 v135, s[8:11], s38 offen lds
    v_mfma_f32_16x16x32_bf16 v[32:35], a[48:51], v[88:91], v[32:35]
    s_add_u32 m0, s35, 8192
    s_mov_b32 s33, 2097152
    buffer_load_dwordx4 v136, s[12:15], s33 offen lds
    v_mfma_f32_16x16x32_bf16 v[36:39], a[52:55], v[88:91], v[36:39]
    s_add_u32 m0, s35, 9216
    s_nop 0
    buffer_load_dwordx4 v137, s[12:15], s33 offen lds
    v_mfma_f32_16x16x32_bf16 v[40:43], a[56:59], v[88:91], v[40:43]
    s_add_u32 m0, s35, 10240
    s_mov_b32 s33, 2228224
    buffer_load_dwordx4 v136, s[12:15], s33 offen lds
    v_mfma_f32_16x16x32_bf16 v[44:47], a[60:63], v[88:91], v[44:47]
    s_add_u32 m0, s35, 11264
    s_nop 0
    buffer_load_dwordx4 v137, s[12:15], s33 offen lds
    v_mfma_f32_16x16x32_bf16 v[48:51], a[48:51], v[92:95], v[48:51]
    s_add_u32 m0, s35, 12288
    s_mov_b32 s33, 2359296
    buffer_load_dwordx4 v136, s[12:15], s33 offen lds
    v_mfma_f32_16x16x32_bf16 v[52:55], a[52:55], v[92:95], v[52:55]
    s_add_u32 m0, s35, 13312
    s_nop 0
    buffer_load_dwordx4 v137, s[12:15], s33 offen lds
    v_mfma_f32_16x16x32_bf16 v[56:59], a[56:59], v[92:95], v[56:59]
    s_add_u32 m0, s35, 14336
    s_mov_b32 s33, 2490368
    buffer_load_dwordx4 v136, s[12:15], s33 offen lds
    v_mfma_f32_16x16x32_bf16 v[60:63], a[60:63], v[92:95], v[60:63]
    s_add_u32 m0, s35, 15360
    s_nop 0
    buffer_load_dwordx4 v137, s[12:15], s33 offen lds
    s_waitcnt lgkmcnt(0)
    v_mfma_f32_16x16x32_bf16 v[0:3], a[64:67], v[64:67], v[0:3]
    ds_read_b128 v[80:83], v129 offset:16384
    ds_read_b128 v[84:87], v129 offset:18432
    v_mfma_f32_16x16x32_bf16 v[4:7], a[68:71], v[64:67], v[4:7]
    ds_read_b128 v[88:91], v129 offset:20480
    v_mfma_f32_16x16x32_bf16 v[8:11], a[72:75], v[64:67], v[8:11]
    ds_read_b128 v[92:95], v129 offset:22528
    ds_read_b64_tr_b16 a[80:81], v130 offset:20480
    v_mfma_f32_16x16x32_bf16 v[12:15], a[76:79], v[64:67], v[12:15]
    ds_read_b64_tr_b16 a[82:83], v130 offset:20992
    v_mfma_f32_16x16x32_bf16 v[16:19], a[64:67], v[68:71], v[16:19]
    ds_read_b64_tr_b16 a[84:85], v131 offset:20480
    ds_read_b64_tr_b16 a[86:87], v131 offset:20992
    v_mfma_f32_16x16x32_bf16 v[20:23], a[68:71], v[68:71], v[20:23]
    ds_read_b64_tr_b16 a[88:89], v132 offset:20480
    v_mfma_f32_16x16x32_bf16 v[24:27], a[72:75], v[68:71], v[24:27]
    ds_read_b64_tr_b16 a[90:91], v132 offset:20992
    ds_read_b64_tr_b16 a[92:93], v133 offset:20480
    v_mfma_f32_16x16x32_bf16 v[28:31], a[76:79], v[68:71], v[28:31]
    ds_read_b64_tr_b16 a[94:95], v133 offset:20992
    v_mfma_f32_16x16x32_bf16 v[32:35], a[64:67], v[72:75], v[32:35]
    v_mfma_f32_16x16x32_bf16 v[36:39], a[68:71], v[72:75], v[36:39]
    v_mfma_f32_16x16x32_bf16 v[40:43], a[72:75], v[72:75], v[40:43]
    v_mfma_f32_16x16x32_bf16 v[44:47], a[76:79], v[72:75], v[44:47]
    v_mfma_f32_16x16x32_bf16 v[48:51], a[64:67], v[76:79], v[48:51]
    v_mfma_f32_16x16x32_bf16 v[52:55], a[68:71], v[76:79], v[52:55]
    v_mfma_f32_16x16x32_bf16 v[56:59], a[72:75], v[76:79], v[56:59]
    v_mfma_f32_16x16x32_bf16 v[60:63], a[76:79], v[76:79], v[60:63]
    s_waitcnt vmcnt(12) lgkmcnt(0)
    v_mfma_f32_16x16x32_bf16 v[0:3], a[80:83], v[80:83], v[0:3]
    ds_read_b128 v[64:67], v128 offset:24576
    ds_read_b128 v[68:71], v128 offset:26624
    v_mfma_f32_16x16x32_bf16 v[4:7], a[84:87], v[80:83], v[4:7]
    ds_read_b128 v[72:75], v128 offset:28672
    v_mfma_f32_16x16x32_bf16 v[8:11], a[88:91], v[80:83], v[8:11]
    ds_read_b128 v[76:79], v128 offset:30720
    ds_read_b64_tr_b16 a[96:97], v130 offset:0
    v_mfma_f32_16x16x32_bf16 v[12:15], a[92:95], v[80:83], v[12:15]
    ds_read_b64_tr_b16 a[98:99], v130 offset:512
    v_mfma_f32_16x16x32_bf16 v[16:19], a[80:83], v[84:87], v[16:19]
    ds_read_b64_tr_b16 a[100:101], v131 offset:0
    ds_read_b64_tr_b16 a[102:103], v131 offset:512
    s_add_u32 m0, s35, 16384
    s_mov_b32 s33, 2621440
    buffer_load_dwordx4 v136, s[12:15], s33 offen lds
    v_mfma_f32_16x16x32_bf16 v[20:23], a[84:87], v[84:87], v[20:23]
    ds_read_b64_tr_b16 a[104:105], v132 offset:0
    s_add_u32 m0, s35, 17408
    s_nop 0
    buffer_load_dwordx4 v137, s[12:15], s33 offen lds
    v_mfma_f32_16x16x32_bf16 v[24:27], a[88:91], v[84:87], v[24:27]
    ds_read_b64_tr_b16 a[106:107], v132 offset:512
    ds_read_b64_tr_b16 a[108:109], v133 offset:0
    s_add_u32 m0, s35, 18432
    s_mov_b32 s33, 2752512
    buffer_load_dwordx4 v136, s[12:15], s33 offen lds
    v_mfma_f32_16x16x32_bf16 v[28:31], a[92:95], v[84:87], v[28:31]
    ds_read_b64_tr_b16 a[110:111], v133 offset:512
    s_add_u32 m0, s35, 19456
    s_nop 0
    buffer_load_dwordx4 v137, s[12:15], s33 offen lds
    v_mfma_f32_16x16x32_bf16 v[32:35], a[80:83], v[88:91], v[32:35]
    s_add_u32 m0, s35, 20480
    s_mov_b32 s33, 2883584
    buffer_load_dwordx4 v136, s[12:15], s33 offen lds
    v_mfma_f32_16x16x32_bf16 v[36:39], a[84:87], v[88:91], v[36:39]
    s_add_u32 m0, s35, 21504
    s_nop 0
    buffer_load_dwordx4 v137, s[12:15], s33 offen lds
    v_mfma_f32_16x16x32_bf16 v[40:43], a[88:91], v[88:91], v[40:43]
    s_add_u32 m0, s35, 22528
    s_mov_b32 s33, 3014656
    buffer_load_dwordx4 v136, s[12:15], s33 offen lds
    v_mfma_f32_16x16x32_bf16 v[44:47], a[92:95], v[88:91], v[44:47]
    s_add_u32 m0, s35, 23552
    s_nop 0
    buffer_load_dwordx4 v137, s[12:15], s33 offen lds
    v_mfma_f32_16x16x32_bf16 v[48:51], a[80:83], v[92:95], v[48:51]
    v_mfma_f32_16x16x32_bf16 v[52:55], a[84:87], v[92:95], v[52:55]
    v_mfma_f32_16x16x32_bf16 v[56:59], a[88:91], v[92:95], v[56:59]
    v_mfma_f32_16x16x32_bf16 v[60:63], a[92:95], v[92:95], v[60:63]
    s_waitcnt lgkmcnt(0)
    v_mfma_f32_16x16x32_bf16 v[0:3], a[96:99], v[64:67], v[0:3]
    ds_read_b128 v[80:83], v129 offset:24576
    ds_read_b128 v[84:87], v129 offset:26624
    v_mfma_f32_16x16x32_bf16 v[4:7], a[100:103], v[64:67], v[4:7]
    ds_read_b128 v[88:91], v129 offset:28672
    v_mfma_f32_16x16x32_bf16 v[8:11], a[104:107], v[64:67], v[8:11]
    ds_read_b128 v[92:95], v129 offset:30720
    ds_read_b64_tr_b16 a[112:113], v130 offset:4096
    v_mfma_f32_16x16x32_bf16 v[12:15], a[108:111], v[64:67], v[12:15]
    ds_read_b64_tr_b16 a[114:115], v130 offset:4608
    v_mfma_f32_16x16x32_bf16 v[16:19], a[96:99], v[68:71], v[16:19]
    ds_read_b64_tr_b16 a[116:117], v131 offset:4096
    ds_read_b64_tr_b16 a[118:119], v131 offset:4608
    v_mfma_f32_16x16x32_bf16 v[20:23], a[100:103], v[68:71], v[20:23]
    ds_read_b64_tr_b16 a[120:121], v132 offset:4096
    v_mfma_f32_16x16x32_bf16 v[24:27], a[104:107], v[68:71], v[24:27]
    ds_read_b64_tr_b16 a[122:123], v132 offset:4608
    ds_read_b64_tr_b16 a[124:125], v133 offset:4096
    v_mfma_f32_16x16x32_bf16 v[28:31], a[108:111], v[68:71], v[28:31]
    ds_read_b64_tr_b16 a[126:127], v133 offset:4608
    v_mfma_f32_16x16x32_bf16 v[32:35], a[96:99], v[72:75], v[32:35]
    v_mfma_f32_16x16x32_bf16 v[36:39], a[100:103], v[72:75], v[36:39]
    v_mfma_f32_16x16x32_bf16 v[40:43], a[104:107], v[72:75], v[40:43]
    v_mfma_f32_16x16x32_bf16 v[44:47], a[108:111], v[72:75], v[44:47]
    v_mfma_f32_16x16x32_bf16 v[48:51], a[96:99], v[76:79], v[48:51]
    v_mfma_f32_16x16x32_bf16 v[52:55], a[100:103], v[76:79], v[52:55]
    v_mfma_f32_16x16x32_bf16 v[56:59], a[104:107], v[76:79], v[56:59]
    v_mfma_f32_16x16x32_bf16 v[60:63], a[108:111], v[76:79], v[60:63]
    s_waitcnt vmcnt(8) lgkmcnt(0)
    s_barrier
    v_mfma_f32_16x16x32_bf16 v[0:3], a[112:115], v[80:83], v[0:3]
    ds_read_b128 v[64:67], v128 offset:32768
    ds_read_b128 v[68:71], v128 offset:34816
    v_mfma_f32_16x16x32_bf16 v[4:7], a[116:119], v[80:83], v[4:7]
    ds_read_b128 v[72:75], v128 offset:36864
    v_mfma_f32_16x16x32_bf16 v[8:11], a[120:123], v[80:83], v[8:11]
    ds_read_b128 v[76:79], v128 offset:38912
    ds_read_b64_tr_b16 a[128:129], v130 offset:8192
    v_mfma_f32_16x16x32_bf16 v[12:15], a[124:127], v[80:83], v[12:15]
    ds_read_b64_tr_b16 a[130:131], v130 offset:8704
    v_mfma_f32_16x16x32_bf16 v[16:19], a[112:115], v[84:87], v[16:19]
    ds_read_b64_tr_b16 a[132:133], v131 offset:8192
    ds_read_b64_tr_b16 a[134:135], v131 offset:8704
    s_add_u32 m0, s34, 16384
    s_add_u32 s38, s32, 256
    buffer_load_dwordx4 v134, s[8:11], s38 offen lds
    v_mfma_f32_16x16x32_bf16 v[20:23], a[116:119], v[84:87], v[20:23]
    ds_read_b64_tr_b16 a[136:137], v132 offset:8192
    s_add_u32 m0, s34, 17408
    s_nop 0
    buffer_load_dwordx4 v135, s[8:11], s38 offen lds
    v_mfma_f32_16x16x32_bf16 v[24:27], a[120:123], v[84:87], v[24:27]
    ds_read_b64_tr_b16 a[138:139], v132 offset:8704
    ds_read_b64_tr_b16 a[140:141], v133 offset:8192
    s_add_u32 m0, s34, 24576
    s_add_u32 s38, s32, 384
    buffer_load_dwordx4 v134, s[8:11], s38 offen lds
    v_mfma_f32_16x16x32_bf16 v[28:31], a[124:127], v[84:87], v[28:31]
    ds_read_b64_tr_b16 a[142:143], v133 offset:8704
    s_add_u32 m0, s34, 25600
    s_nop 0
    buffer_load_dwordx4 v135, s[8:11], s38 offen lds
    v_mfma_f32_16x16x32_bf16 v[32:35], a[112:115], v[88:91], v[32:35]
    s_add_u32 m0, s35, 0
    s_mov_b32 s33, 3145728
    buffer_load_dwordx4 v136, s[12:15], s33 offen lds
    v_mfma_f32_16x16x32_bf16 v[36:39], a[116:119], v[88:91], v[36:39]
    s_add_u32 m0, s35, 1024
    s_nop 0
    buffer_load_dwordx4 v137, s[12:15], s33 offen lds
    v_mfma_f32_16x16x32_bf16 v[40:43], a[120:123], v[88:91], v[40:43]
    s_add_u32 m0, s35, 2048
    s_mov_b32 s33, 3276800
    buffer_load_dwordx4 v136, s[12:15], s33 offen lds
    v_mfma_f32_16x16x32_bf16 v[44:47], a[124:127], v[88:91], v[44:47]
    s_add_u32 m0, s35, 3072
    s_nop 0
    buffer_load_dwordx4 v137, s[12:15], s33 offen lds
    v_mfma_f32_16x16x32_bf16 v[48:51], a[112:115], v[92:95], v[48:51]
    s_add_u32 m0, s35, 4096
    s_mov_b32 s33, 3407872
    buffer_load_dwordx4 v136, s[12:15], s33 offen lds
    v_mfma_f32_16x16x32_bf16 v[52:55], a[116:119], v[92:95], v[52:55]
    s_add_u32 m0, s35, 5120
    s_nop 0
    buffer_load_dwordx4 v137, s[12:15], s33 offen lds
    v_mfma_f32_16x16x32_bf16 v[56:59], a[120:123], v[92:95], v[56:59]
    s_add_u32 m0, s35, 6144
    s_mov_b32 s33, 3538944
    buffer_load_dwordx4 v136, s[12:15], s33 offen lds
    v_mfma_f32_16x16x32_bf16 v[60:63], a[124:127], v[92:95], v[60:63]
    s_add_u32 m0, s35, 7168
    s_nop 0
    buffer_load_dwordx4 v137, s[12:15], s33 offen lds
    s_waitcnt lgkmcnt(0)
    v_mfma_f32_16x16x32_bf16 v[0:3], a[128:131], v[64:67], v[0:3]
    ds_read_b128 v[80:83], v129 offset:32768
    ds_read_b128 v[84:87], v129 offset:34816
    v_mfma_f32_16x16x32_bf16 v[4:7], a[132:135], v[64:67], v[4:7]
    ds_read_b128 v[88:91], v129 offset:36864
    v_mfma_f32_16x16x32_bf16 v[8:11], a[136:139], v[64:67], v[8:11]
    ds_read_b128 v[92:95], v129 offset:38912
    ds_read_b64_tr_b16 a[144:145], v130 offset:12288
    v_mfma_f32_16x16x32_bf16 v[12:15], a[140:143], v[64:67], v[12:15]
    ds_read_b64_tr_b16 a[146:147], v130 offset:12800
    v_mfma_f32_16x16x32_bf16 v[16:19], a[128:131], v[68:71], v[16:19]
    ds_read_b64_tr_b16 a[148:149], v131 offset:12288
    ds_read_b64_tr_b16 a[150:151], v131 offset:12800
    v_mfma_f32_16x16x32_bf16 v[20:23], a[132:135], v[68:71], v[20:23]
    ds_read_b64_tr_b16 a[152:153], v132 offset:12288
    v_mfma_f32_16x16x32_bf16 v[24:27], a[136:139], v[68:71], v[24:27]
    ds_read_b64_tr_b16 a[154:155], v132 offset:12800
    ds_read_b64_tr_b16 a[156:157], v133 offset:12288
    v_mfma_f32_16x16x32_bf16 v[28:31], a[140:143], v[68:71], v[28:31]
    ds_read_b64_tr_b16 a[158:159], v133 offset:12800
    v_mfma_f32_16x16x32_bf16 v[32:35], a[128:131], v[72:75], v[32:35]
    v_mfma_f32_16x16x32_bf16 v[36:39], a[132:135], v[72:75], v[36:39]
    v_mfma_f32_16x16x32_bf16 v[40:43], a[136:139], v[72:75], v[40:43]
    v_mfma_f32_16x16x32_bf16 v[44:47], a[140:143], v[72:75], v[44:47]
    v_mfma_f32_16x16x32_bf16 v[48:51], a[128:131], v[76:79], v[48:51]
    v_mfma_f32_16x16x32_bf16 v[52:55], a[132:135], v[76:79], v[52:55]
    v_mfma_f32_16x16x32_bf16 v[56:59], a[136:139], v[76:79], v[56:59]
    v_mfma_f32_16x16x32_bf16 v[60:63], a[140:143], v[76:79], v[60:63]
    s_waitcnt vmcnt(12) lgkmcnt(0)
    v_mfma_f32_16x16x32_bf16 v[0:3], a[144:147], v[80:83], v[0:3]
    ds_read_b128 v[64:67], v128 offset:40960
    ds_read_b128 v[68:71], v128 offset:43008
    v_mfma_f32_16x16x32_bf16 v[4:7], a[148:151], v[80:83], v[4:7]
    ds_read_b128 v[72:75], v128 offset:45056
    v_mfma_f32_16x16x32_bf16 v[8:11], a[152:155], v[80:83], v[8:11]
    ds_read_b128 v[76:79], v128 offset:47104
    ds_read_b64_tr_b16 a[160:161], v130 offset:16384
    v_mfma_f32_16x16x32_bf16 v[12:15], a[156:159], v[80:83], v[12:15]
    ds_read_b64_tr_b16 a[162:163], v130 offset:16896
    v_mfma_f32_16x16x32_bf16 v[16:19], a[144:147], v[84:87], v[16:19]
    ds_read_b64_tr_b16 a[164:165], v131 offset:16384
    ds_read_b64_tr_b16 a[166:167], v131 offset:16896
    s_add_u32 m0, s35, 8192
    s_mov_b32 s33, 3670016
    buffer_load_dwordx4 v136, s[12:15], s33 offen lds
    v_mfma_f32_16x16x32_bf16 v[20:23], a[148:151], v[84:87], v[20:23]
    ds_read_b64_tr_b16 a[168:169], v132 offset:16384
    s_add_u32 m0, s35, 9216
    s_nop 0
    buffer_load_dwordx4 v137, s[12:15], s33 offen lds
    v_mfma_f32_16x16x32_bf16 v[24:27], a[152:155], v[84:87], v[24:27]
    ds_read_b64_tr_b16 a[170:171], v132 offset:16896
    ds_read_b64_tr_b16 a[172:173], v133 offset:16384
    s_add_u32 m0, s35, 10240
    s_mov_b32 s33, 3801088
    buffer_load_dwordx4 v136, s[12:15], s33 offen lds
    v_mfma_f32_16x16x32_bf16 v[28:31], a[156:159], v[84:87], v[28:31]
    ds_read_b64_tr_b16 a[174:175], v133 offset:16896
    s_add_u32 m0, s35, 11264
    s_nop 0
    buffer_load_dwordx4 v137, s[12:15], s33 offen lds
    v_mfma_f32_16x16x32_bf16 v[32:35], a[144:147], v[88:91], v[32:35]
    s_add_u32 m0, s35, 12288
    s_mov_b32 s33, 3932160
    buffer_load_dwordx4 v136, s[12:15], s33 offen lds
    v_mfma_f32_16x16x32_bf16 v[36:39], a[148:151], v[88:91], v[36:39]
    s_add_u32 m0, s35, 13312
    s_nop 0
    buffer_load_dwordx4 v137, s[12:15], s33 offen lds
    v_mfma_f32_16x16x32_bf16 v[40:43], a[152:155], v[88:91], v[40:43]
    s_add_u32 m0, s35, 14336
    s_mov_b32 s33, 4063232
    buffer_load_dwordx4 v136, s[12:15], s33 offen lds
    v_mfma_f32_16x16x32_bf16 v[44:47], a[156:159], v[88:91], v[44:47]
    s_add_u32 m0, s35, 15360
    s_nop 0
    buffer_load_dwordx4 v137, s[12:15], s33 offen lds
    v_mfma_f32_16x16x32_bf16 v[48:51], a[144:147], v[92:95], v[48:51]
    v_mfma_f32_16x16x32_bf16 v[52:55], a[148:151], v[92:95], v[52:55]
    v_mfma_f32_16x16x32_bf16 v[56:59], a[152:155], v[92:95], v[56:59]
    v_mfma_f32_16x16x32_bf16 v[60:63], a[156:159], v[92:95], v[60:63]
    s_waitcnt lgkmcnt(0)
    v_mfma_f32_16x16x32_bf16 v[0:3], a[160:163], v[64:67], v[0:3]
    ds_read_b128 v[80:83], v129 offset:40960
    ds_read_b128 v[84:87], v129 offset:43008
    v_mfma_f32_16x16x32_bf16 v[4:7], a[164:167], v[64:67], v[4:7]
    ds_read_b128 v[88:91], v129 offset:45056
    v_mfma_f32_16x16x32_bf16 v[8:11], a[168:171], v[64:67], v[8:11]
    ds_read_b128 v[92:95], v129 offset:47104
    ds_read_b64_tr_b16 a[176:177], v130 offset:20480
    v_mfma_f32_16x16x32_bf16 v[12:15], a[172:175], v[64:67], v[12:15]
    ds_read_b64_tr_b16 a[178:179], v130 offset:20992
    v_mfma_f32_16x16x32_bf16 v[16:19], a[160:163], v[68:71], v[16:19]
    ds_read_b64_tr_b16 a[180:181], v131 offset:20480
    ds_read_b64_tr_b16 a[182:183], v131 offset:20992
    v_mfma_f32_16x16x32_bf16 v[20:23], a[164:167], v[68:71], v[20:23]
    ds_read_b64_tr_b16 a[184:185], v132 offset:20480
    v_mfma_f32_16x16x32_bf16 v[24:27], a[168:171], v[68:71], v[24:27]
    ds_read_b64_tr_b16 a[186:187], v132 offset:20992
    ds_read_b64_tr_b16 a[188:189], v133 offset:20480
    v_mfma_f32_16x16x32_bf16 v[28:31], a[172:175], v[68:71], v[28:31]
    ds_read_b64_tr_b16 a[190:191], v133 offset:20992
    v_mfma_f32_16x16x32_bf16 v[32:35], a[160:163], v[72:75], v[32:35]
    v_mfma_f32_16x16x32_bf16 v[36:39], a[164:167], v[72:75], v[36:39]
    v_mfma_f32_16x16x32_bf16 v[40:43], a[168:171], v[72:75], v[40:43]
    v_mfma_f32_16x16x32_bf16 v[44:47], a[172:175], v[72:75], v[44:47]
    v_mfma_f32_16x16x32_bf16 v[48:51], a[160:163], v[76:79], v[48:51]
    v_mfma_f32_16x16x32_bf16 v[52:55], a[164:167], v[76:79], v[52:55]
    v_mfma_f32_16x16x32_bf16 v[56:59], a[168:171], v[76:79], v[56:59]
    v_mfma_f32_16x16x32_bf16 v[60:63], a[172:175], v[76:79], v[60:63]
    s_waitcnt vmcnt(8) lgkmcnt(0)
    s_barrier
    v_mfma_f32_16x16x32_bf16 v[0:3], a[176:179], v[80:83], v[0:3]
    ds_read_b128 v[64:67], v128 offset:49152
    ds_read_b128 v[68:71], v128 offset:51200
    v_mfma_f32_16x16x32_bf16 v[4:7], a[180:183], v[80:83], v[4:7]
    ds_read_b128 v[72:75], v128 offset:53248
    v_mfma_f32_16x16x32_bf16 v[8:11], a[184:187], v[80:83], v[8:11]
    ds_read_b128 v[76:79], v128 offset:55296
    ds_read_b64_tr_b16 a[192:193], v130 offset:0
    v_mfma_f32_16x16x32_bf16 v[12:15], a[188:191], v[80:83], v[12:15]
    ds_read_b64_tr_b16 a[194:195], v130 offset:512
    v_mfma_f32_16x16x32_bf16 v[16:19], a[176:179], v[84:87], v[16:19]
    ds_read_b64_tr_b16 a[196:197], v131 offset:0
    ds_read_b64_tr_b16 a[198:199], v131 offset:512
    v_mfma_f32_16x16x32_bf16 v[20:23], a[180:183], v[84:87], v[20:23]
    ds_read_b64_tr_b16 a[200:201], v132 offset:0
    s_add_u32 m0, s34, 32768
    s_add_u32 s38, s32, 512
    buffer_load_dwordx4 v134, s[8:11], s38 offen lds
    v_mfma_f32_16x16x32_bf16 v[24:27], a[184:187], v[84:87], v[24:27]
    ds_read_b64_tr_b16 a[202:203], v132 offset:512
    ds_read_b64_tr_b16 a[204:205], v133 offset:0
    v_mfma_f32_16x16x32_bf16 v[28:31], a[188:191], v[84:87], v[28:31]
    ds_read_b64_tr_b16 a[206:207], v133 offset:512
    s_add_u32 m0, s34, 33792
    s_nop 0
    buffer_load_dwordx4 v135, s[8:11], s38 offen lds
    v_mfma_f32_16x16x32_bf16 v[32:35], a[176:179], v[88:91], v[32:35]
    v_mfma_f32_16x16x32_bf16 v[36:39], a[180:183], v[88:91], v[36:39]
    s_add_u32 m0, s34, 40960
    s_add_u32 s38, s32, 640
    buffer_load_dwordx4 v134, s[8:11], s38 offen lds
    v_mfma_f32_16x16x32_bf16 v[40:43], a[184:187], v[88:91], v[40:43]
    v_mfma_f32_16x16x32_bf16 v[44:47], a[188:191], v[88:91], v[44:47]
    s_add_u32 m0, s34, 41984
    s_nop 0
    buffer_load_dwordx4 v135, s[8:11], s38 offen lds
    v_mfma_f32_16x16x32_bf16 v[48:51], a[176:179], v[92:95], v[48:51]
    v_mfma_f32_16x16x32_bf16 v[52:55], a[180:183], v[92:95], v[52:55]
    v_mfma_f32_16x16x32_bf16 v[56:59], a[184:187], v[92:95], v[56:59]
    v_mfma_f32_16x16x32_bf16 v[60:63], a[188:191], v[92:95], v[60:63]
    s_waitcnt lgkmcnt(0)
    v_mfma_f32_16x16x32_bf16 v[0:3], a[192:195], v[64:67], v[0:3]
    ds_read_b128 v[80:83], v129 offset:49152
    ds_read_b128 v[84:87], v129 offset:51200
    v_mfma_f32_16x16x32_bf16 v[4:7], a[196:199], v[64:67], v[4:7]
    ds_read_b128 v[88:91], v129 offset:53248
    v_mfma_f32_16x16x32_bf16 v[8:11], a[200:203], v[64:67], v[8:11]
    ds_read_b128 v[92:95], v129 offset:55296
    ds_read_b64_tr_b16 a[208:209], v130 offset:4096
    v_mfma_f32_16x16x32_bf16 v[12:15], a[204:207], v[64:67], v[12:15]
    ds_read_b64_tr_b16 a[210:211], v130 offset:4608
    v_mfma_f32_16x16x32_bf16 v[16:19], a[192:195], v[68:71], v[16:19]
    ds_read_b64_tr_b16 a[212:213], v131 offset:4096
    ds_read_b64_tr_b16 a[214:215], v131 offset:4608
    v_mfma_f32_16x16x32_bf16 v[20:23], a[196:199], v[68:71], v[20:23]
    ds_read_b64_tr_b16 a[216:217], v132 offset:4096
    v_mfma_f32_16x16x32_bf16 v[24:27], a[200:203], v[68:71], v[24:27]
    ds_read_b64_tr_b16 a[218:219], v132 offset:4608
    ds_read_b64_tr_b16 a[220:221], v133 offset:4096
    v_mfma_f32_16x16x32_bf16 v[28:31], a[204:207], v[68:71], v[28:31]
    ds_read_b64_tr_b16 a[222:223], v133 offset:4608
    v_mfma_f32_16x16x32_bf16 v[32:35], a[192:195], v[72:75], v[32:35]
    v_mfma_f32_16x16x32_bf16 v[36:39], a[196:199], v[72:75], v[36:39]
    v_mfma_f32_16x16x32_bf16 v[40:43], a[200:203], v[72:75], v[40:43]
    v_mfma_f32_16x16x32_bf16 v[44:47], a[204:207], v[72:75], v[44:47]
    v_mfma_f32_16x16x32_bf16 v[48:51], a[192:195], v[76:79], v[48:51]
    v_mfma_f32_16x16x32_bf16 v[52:55], a[196:199], v[76:79], v[52:55]
    v_mfma_f32_16x16x32_bf16 v[56:59], a[200:203], v[76:79], v[56:59]
    v_mfma_f32_16x16x32_bf16 v[60:63], a[204:207], v[76:79], v[60:63]
    s_waitcnt vmcnt(4) lgkmcnt(0)
    v_mfma_f32_16x16x32_bf16 v[0:3], a[208:211], v[80:83], v[0:3]
    ds_read_b128 v[64:67], v128 offset:57344
    ds_read_b128 v[68:71], v128 offset:59392
    v_mfma_f32_16x16x32_bf16 v[4:7], a[212:215], v[80:83], v[4:7]
    ds_read_b128 v[72:75], v128 offset:61440
    v_mfma_f32_16x16x32_bf16 v[8:11], a[216:219], v[80:83], v[8:11]
    ds_read_b128 v[76:79], v128 offset:63488
    ds_read_b64_tr_b16 a[224:225], v130 offset:8192
    v_mfma_f32_16x16x32_bf16 v[12:15], a[220:223], v[80:83], v[12:15]
    ds_read_b64_tr_b16 a[226:227], v130 offset:8704
    v_mfma_f32_16x16x32_bf16 v[16:19], a[208:211], v[84:87], v[16:19]
    ds_read_b64_tr_b16 a[228:229], v131 offset:8192
    ds_read_b64_tr_b16 a[230:231], v131 offset:8704
    v_mfma_f32_16x16x32_bf16 v[20:23], a[212:215], v[84:87], v[20:23]
    ds_read_b64_tr_b16 a[232:233], v132 offset:8192
    v_mfma_f32_16x16x32_bf16 v[24:27], a[216:219], v[84:87], v[24:27]
    ds_read_b64_tr_b16 a[234:235], v132 offset:8704
    ds_read_b64_tr_b16 a[236:237], v133 offset:8192
    v_mfma_f32_16x16x32_bf16 v[28:31], a[220:223], v[84:87], v[28:31]
    ds_read_b64_tr_b16 a[238:239], v133 offset:8704
    v_mfma_f32_16x16x32_bf16 v[32:35], a[208:211], v[88:91], v[32:35]
    v_mfma_f32_16x16x32_bf16 v[36:39], a[212:215], v[88:91], v[36:39]
    v_mfma_f32_16x16x32_bf16 v[40:43], a[216:219], v[88:91], v[40:43]
    v_mfma_f32_16x16x32_bf16 v[44:47], a[220:223], v[88:91], v[44:47]
    v_mfma_f32_16x16x32_bf16 v[48:51], a[208:211], v[92:95], v[48:51]
    v_mfma_f32_16x16x32_bf16 v[52:55], a[212:215], v[92:95], v[52:55]
    v_mfma_f32_16x16x32_bf16 v[56:59], a[216:219], v[92:95], v[56:59]
    v_mfma_f32_16x16x32_bf16 v[60:63], a[220:223], v[92:95], v[60:63]
    s_waitcnt lgkmcnt(0)
    v_mfma_f32_16x16x32_bf16 v[0:3], a[224:227], v[64:67], v[0:3]
    ds_read_b128 v[80:83], v129 offset:57344
    ds_read_b128 v[84:87], v129 offset:59392
    v_mfma_f32_16x16x32_bf16 v[4:7], a[228:231], v[64:67], v[4:7]
    ds_read_b128 v[88:91], v129 offset:61440
    v_mfma_f32_16x16x32_bf16 v[8:11], a[232:235], v[64:67], v[8:11]
    ds_read_b128 v[92:95], v129 offset:63488
    ds_read_b64_tr_b16 a[240:241], v130 offset:12288
    v_mfma_f32_16x16x32_bf16 v[12:15], a[236:239], v[64:67], v[12:15]
    ds_read_b64_tr_b16 a[242:243], v130 offset:12800
    v_mfma_f32_16x16x32_bf16 v[16:19], a[224:227], v[68:71], v[16:19]
    ds_read_b64_tr_b16 a[244:245], v131 offset:12288
    ds_read_b64_tr_b16 a[246:247], v131 offset:12800
    v_mfma_f32_16x16x32_bf16 v[20:23], a[228:231], v[68:71], v[20:23]
    ds_read_b64_tr_b16 a[248:249], v132 offset:12288
    v_mfma_f32_16x16x32_bf16 v[24:27], a[232:235], v[68:71], v[24:27]
    ds_read_b64_tr_b16 a[250:251], v132 offset:12800
    ds_read_b64_tr_b16 a[252:253], v133 offset:12288
    v_mfma_f32_16x16x32_bf16 v[28:31], a[236:239], v[68:71], v[28:31]
    ds_read_b64_tr_b16 a[254:255], v133 offset:12800
    v_mfma_f32_16x16x32_bf16 v[32:35], a[224:227], v[72:75], v[32:35]
    v_mfma_f32_16x16x32_bf16 v[36:39], a[228:231], v[72:75], v[36:39]
    v_mfma_f32_16x16x32_bf16 v[40:43], a[232:235], v[72:75], v[40:43]
    v_mfma_f32_16x16x32_bf16 v[44:47], a[236:239], v[72:75], v[44:47]
    v_mfma_f32_16x16x32_bf16 v[48:51], a[224:227], v[76:79], v[48:51]
    v_mfma_f32_16x16x32_bf16 v[52:55], a[228:231], v[76:79], v[52:55]
    v_mfma_f32_16x16x32_bf16 v[56:59], a[232:235], v[76:79], v[56:59]
    v_mfma_f32_16x16x32_bf16 v[60:63], a[236:239], v[76:79], v[60:63]
    s_waitcnt vmcnt(40) lgkmcnt(0)
    s_barrier
    v_mfma_f32_16x16x32_bf16 v[0:3], a[240:243], v[80:83], v[0:3]
    ds_read_b128 v[64:67], v128 offset:0
    v_mfma_f32_16x16x32_bf16 v[4:7], a[244:247], v[80:83], v[4:7]
    ds_read_b128 v[68:71], v128 offset:2048
    v_mfma_f32_16x16x32_bf16 v[8:11], a[248:251], v[80:83], v[8:11]
    ds_read_b128 v[72:75], v128 offset:4096
    v_mfma_f32_16x16x32_bf16 v[12:15], a[252:255], v[80:83], v[12:15]
    ds_read_b128 v[76:79], v128 offset:6144
    v_mfma_f32_16x16x32_bf16 v[16:19], a[240:243], v[84:87], v[16:19]
    v_mfma_f32_16x16x32_bf16 v[20:23], a[244:247], v[84:87], v[20:23]
    s_add_u32 m0, s34, 49152
    s_add_u32 s38, s32, 768
    buffer_load_dwordx4 v134, s[8:11], s38 offen lds
    v_mfma_f32_16x16x32_bf16 v[24:27], a[248:251], v[84:87], v[24:27]
    v_mfma_f32_16x16x32_bf16 v[28:31], a[252:255], v[84:87], v[28:31]
    s_add_u32 m0, s34, 50176
    s_nop 0
    buffer_load_dwordx4 v135, s[8:11], s38 offen lds
    v_mfma_f32_16x16x32_bf16 v[32:35], a[240:243], v[88:91], v[32:35]
    v_mfma_f32_16x16x32_bf16 v[36:39], a[244:247], v[88:91], v[36:39]
    s_add_u32 m0, s34, 57344
    s_add_u32 s38, s32, 896
    buffer_load_dwordx4 v134, s[8:11], s38 offen lds
    v_cvt_pk_bf16_f32 v96, v0, v1
    v_cvt_pk_bf16_f32 v97, v2, v3
    v_mfma_f32_16x16x32_bf16 v[40:43], a[248:251], v[88:91], v[40:43]
    v_cvt_pk_bf16_f32 v98, v4, v5
    v_cvt_pk_bf16_f32 v99, v6, v7
    v_mfma_f32_16x16x32_bf16 v[44:47], a[252:255], v[88:91], v[44:47]
    s_add_u32 m0, s34, 58368
    s_nop 0
    buffer_load_dwordx4 v135, s[8:11], s38 offen lds
    s_add_u32 s32, s32, 65536
    s_cmp_ge_u32 s32, s39
    s_cselect_b32 s32, 0x40000000, s32
    v_cvt_pk_bf16_f32 v100, v8, v9
    v_cvt_pk_bf16_f32 v101, v10, v11
    v_mfma_f32_16x16x32_bf16 v[48:51], a[240:243], v[92:95], v[48:51]
    v_cvt_pk_bf16_f32 v102, v12, v13
    v_cvt_pk_bf16_f32 v103, v14, v15
    v_mfma_f32_16x16x32_bf16 v[52:55], a[244:247], v[92:95], v[52:55]
    v_cvt_pk_bf16_f32 v104, v16, v17
    v_cvt_pk_bf16_f32 v105, v18, v19
    v_mfma_f32_16x16x32_bf16 v[56:59], a[248:251], v[92:95], v[56:59]
    v_cvt_pk_bf16_f32 v106, v20, v21
    v_cvt_pk_bf16_f32 v107, v22, v23
    v_mfma_f32_16x16x32_bf16 v[60:63], a[252:255], v[92:95], v[60:63]
    v_cvt_pk_bf16_f32 v108, v24, v25
    v_cvt_pk_bf16_f32 v109, v26, v27
    s_mov_b32 s37, 3
k1_K_loop:
    s_waitcnt lgkmcnt(0)
    v_mfma_f32_16x16x32_bf16 v[0:3], a[0:3], v[64:67], 0
    ds_read_b128 v[80:83], v129 offset:0
    v_cvt_pk_bf16_f32 v110, v28, v29
    v_cvt_pk_bf16_f32 v111, v30, v31
    v_mfma_f32_16x16x32_bf16 v[4:7], a[4:7], v[64:67], 0
    ds_read_b128 v[84:87], v129 offset:2048
    v_cvt_pk_bf16_f32 v112, v32, v33
    v_cvt_pk_bf16_f32 v113, v34, v35
    v_mfma_f32_16x16x32_bf16 v[8:11], a[8:11], v[64:67], 0
    ds_read_b128 v[88:91], v129 offset:4096
    v_cvt_pk_bf16_f32 v114, v36, v37
    v_cvt_pk_bf16_f32 v115, v38, v39
    v_mfma_f32_16x16x32_bf16 v[12:15], a[12:15], v[64:67], 0
    ds_read_b128 v[92:95], v129 offset:6144
    v_cvt_pk_bf16_f32 v116, v40, v41
    v_cvt_pk_bf16_f32 v117, v42, v43
    v_mfma_f32_16x16x32_bf16 v[16:19], a[0:3], v[68:71], 0
    v_cvt_pk_bf16_f32 v118, v44, v45
    v_cvt_pk_bf16_f32 v119, v46, v47
    v_mfma_f32_16x16x32_bf16 v[20:23], a[4:7], v[68:71], 0
    v_cvt_pk_bf16_f32 v120, v48, v49
    v_cvt_pk_bf16_f32 v121, v50, v51
    v_mfma_f32_16x16x32_bf16 v[24:27], a[8:11], v[68:71], 0
    v_cvt_pk_bf16_f32 v122, v52, v53
    v_cvt_pk_bf16_f32 v123, v54, v55
    v_mfma_f32_16x16x32_bf16 v[28:31], a[12:15], v[68:71], 0
    v_cvt_pk_bf16_f32 v124, v56, v57
    v_cvt_pk_bf16_f32 v125, v58, v59
    v_mfma_f32_16x16x32_bf16 v[32:35], a[0:3], v[72:75], 0
    v_cvt_pk_bf16_f32 v126, v60, v61
    v_cvt_pk_bf16_f32 v127, v62, v63
    s_add_u32 s56, s36, 0
    buffer_store_dwordx4 v[96:99], v138, s[16:19], s56 offen offset:0
    v_mfma_f32_16x16x32_bf16 v[36:39], a[4:7], v[72:75], 0
    v_mfma_f32_16x16x32_bf16 v[40:43], a[8:11], v[72:75], 0
    s_add_u32 s56, s36, 0
    buffer_store_dwordx4 v[100:103], v138, s[16:19], s56 offen offset:2048
    v_mfma_f32_16x16x32_bf16 v[44:47], a[12:15], v[72:75], 0
    v_mfma_f32_16x16x32_bf16 v[48:51], a[0:3], v[76:79], 0
    s_add_u32 s56, s36, 0
    buffer_store_dwordx4 v[104:107], v138, s[16:19], s56 offen offset:128
    v_mfma_f32_16x16x32_bf16 v[52:55], a[4:7], v[76:79], 0
    v_mfma_f32_16x16x32_bf16 v[56:59], a[8:11], v[76:79], 0
    s_add_u32 s56, s36, 0
    buffer_store_dwordx4 v[108:111], v138, s[16:19], s56 offen offset:2176
    v_mfma_f32_16x16x32_bf16 v[60:63], a[12:15], v[76:79], 0
    s_waitcnt lgkmcnt(0)
    v_mfma_f32_16x16x32_bf16 v[0:3], a[16:19], v[80:83], v[0:3]
    ds_read_b128 v[64:67], v128 offset:8192
    s_add_u32 s56, s36, 8192
    buffer_store_dwordx4 v[112:115], v138, s[16:19], s56 offen offset:0
    v_mfma_f32_16x16x32_bf16 v[4:7], a[20:23], v[80:83], v[4:7]
    ds_read_b128 v[68:71], v128 offset:10240
    v_mfma_f32_16x16x32_bf16 v[8:11], a[24:27], v[80:83], v[8:11]
    ds_read_b128 v[72:75], v128 offset:12288
    s_add_u32 s56, s36, 8192
    buffer_store_dwordx4 v[116:119], v138, s[16:19], s56 offen offset:2048
    v_mfma_f32_16x16x32_bf16 v[12:15], a[28:31], v[80:83], v[12:15]
    ds_read_b128 v[76:79], v128 offset:14336
    v_mfma_f32_16x16x32_bf16 v[16:19], a[16:19], v[84:87], v[16:19]
    s_add_u32 s56, s36, 8192
    buffer_store_dwordx4 v[120:123], v138, s[16:19], s56 offen offset:128
    v_mfma_f32_16x16x32_bf16 v[20:23], a[20:23], v[84:87], v[20:23]
    v_mfma_f32_16x16x32_bf16 v[24:27], a[24:27], v[84:87], v[24:27]
    s_add_u32 s56, s36, 8192
    buffer_store_dwordx4 v[124:127], v138, s[16:19], s56 offen offset:2176
    v_mfma_f32_16x16x32_bf16 v[28:31], a[28:31], v[84:87], v[28:31]
    v_mfma_f32_16x16x32_bf16 v[32:35], a[16:19], v[88:91], v[32:35]
    v_mfma_f32_16x16x32_bf16 v[36:39], a[20:23], v[88:91], v[36:39]
    v_mfma_f32_16x16x32_bf16 v[40:43], a[24:27], v[88:91], v[40:43]
    v_mfma_f32_16x16x32_bf16 v[44:47], a[28:31], v[88:91], v[44:47]
    v_mfma_f32_16x16x32_bf16 v[48:51], a[16:19], v[92:95], v[48:51]
    v_mfma_f32_16x16x32_bf16 v[52:55], a[20:23], v[92:95], v[52:55]
    v_mfma_f32_16x16x32_bf16 v[56:59], a[24:27], v[92:95], v[56:59]
    v_mfma_f32_16x16x32_bf16 v[60:63], a[28:31], v[92:95], v[60:63]
    s_add_u32 s36, s36, 32768
    s_waitcnt lgkmcnt(0)
    v_mfma_f32_16x16x32_bf16 v[0:3], a[32:35], v[64:67], v[0:3]
    ds_read_b128 v[80:83], v129 offset:8192
    v_mfma_f32_16x16x32_bf16 v[4:7], a[36:39], v[64:67], v[4:7]
    ds_read_b128 v[84:87], v129 offset:10240
    v_mfma_f32_16x16x32_bf16 v[8:11], a[40:43], v[64:67], v[8:11]
    ds_read_b128 v[88:91], v129 offset:12288
    v_mfma_f32_16x16x32_bf16 v[12:15], a[44:47], v[64:67], v[12:15]
    ds_read_b128 v[92:95], v129 offset:14336
    v_mfma_f32_16x16x32_bf16 v[16:19], a[32:35], v[68:71], v[16:19]
    v_mfma_f32_16x16x32_bf16 v[20:23], a[36:39], v[68:71], v[20:23]
    v_mfma_f32_16x16x32_bf16 v[24:27], a[40:43], v[68:71], v[24:27]
    v_mfma_f32_16x16x32_bf16 v[28:31], a[44:47], v[68:71], v[28:31]
    v_mfma_f32_16x16x32_bf16 v[32:35], a[32:35], v[72:75], v[32:35]
    v_mfma_f32_16x16x32_bf16 v[36:39], a[36:39], v[72:75], v[36:39]
    v_mfma_f32_16x16x32_bf16 v[40:43], a[40:43], v[72:75], v[40:43]
    v_mfma_f32_16x16x32_bf16 v[44:47], a[44:47], v[72:75], v[44:47]
    v_mfma_f32_16x16x32_bf16 v[48:51], a[32:35], v[76:79], v[48:51]
    v_mfma_f32_16x16x32_bf16 v[52:55], a[36:39], v[76:79], v[52:55]
    v_mfma_f32_16x16x32_bf16 v[56:59], a[40:43], v[76:79], v[56:59]
    v_mfma_f32_16x16x32_bf16 v[60:63], a[44:47], v[76:79], v[60:63]
    s_waitcnt vmcnt(16) lgkmcnt(0)
    s_barrier
    v_mfma_f32_16x16x32_bf16 v[0:3], a[48:51], v[80:83], v[0:3]
    ds_read_b128 v[64:67], v128 offset:16384
    v_mfma_f32_16x16x32_bf16 v[4:7], a[52:55], v[80:83], v[4:7]
    ds_read_b128 v[68:71], v128 offset:18432
    v_mfma_f32_16x16x32_bf16 v[8:11], a[56:59], v[80:83], v[8:11]
    ds_read_b128 v[72:75], v128 offset:20480
    v_mfma_f32_16x16x32_bf16 v[12:15], a[60:63], v[80:83], v[12:15]
    ds_read_b128 v[76:79], v128 offset:22528
    v_mfma_f32_16x16x32_bf16 v[16:19], a[48:51], v[84:87], v[16:19]
    v_mfma_f32_16x16x32_bf16 v[20:23], a[52:55], v[84:87], v[20:23]
    s_add_u32 m0, s34, 0
    s_add_u32 s38, s32, 0
    buffer_load_dwordx4 v134, s[8:11], s38 offen lds
    v_mfma_f32_16x16x32_bf16 v[24:27], a[56:59], v[84:87], v[24:27]
    v_mfma_f32_16x16x32_bf16 v[28:31], a[60:63], v[84:87], v[28:31]
    s_add_u32 m0, s34, 1024
    s_nop 0
    buffer_load_dwordx4 v135, s[8:11], s38 offen lds
    v_mfma_f32_16x16x32_bf16 v[32:35], a[48:51], v[88:91], v[32:35]
    v_mfma_f32_16x16x32_bf16 v[36:39], a[52:55], v[88:91], v[36:39]
    s_add_u32 m0, s34, 8192
    s_add_u32 s38, s32, 128
    buffer_load_dwordx4 v134, s[8:11], s38 offen lds
    v_mfma_f32_16x16x32_bf16 v[40:43], a[56:59], v[88:91], v[40:43]
    v_mfma_f32_16x16x32_bf16 v[44:47], a[60:63], v[88:91], v[44:47]
    s_add_u32 m0, s34, 9216
    s_nop 0
    buffer_load_dwordx4 v135, s[8:11], s38 offen lds
    v_mfma_f32_16x16x32_bf16 v[48:51], a[48:51], v[92:95], v[48:51]
    v_mfma_f32_16x16x32_bf16 v[52:55], a[52:55], v[92:95], v[52:55]
    v_mfma_f32_16x16x32_bf16 v[56:59], a[56:59], v[92:95], v[56:59]
    v_mfma_f32_16x16x32_bf16 v[60:63], a[60:63], v[92:95], v[60:63]
    s_waitcnt lgkmcnt(0)
    v_mfma_f32_16x16x32_bf16 v[0:3], a[64:67], v[64:67], v[0:3]
    ds_read_b128 v[80:83], v129 offset:16384
    v_mfma_f32_16x16x32_bf16 v[4:7], a[68:71], v[64:67], v[4:7]
    ds_read_b128 v[84:87], v129 offset:18432
    v_mfma_f32_16x16x32_bf16 v[8:11], a[72:75], v[64:67], v[8:11]
    ds_read_b128 v[88:91], v129 offset:20480
    v_mfma_f32_16x16x32_bf16 v[12:15], a[76:79], v[64:67], v[12:15]
    ds_read_b128 v[92:95], v129 offset:22528
    v_mfma_f32_16x16x32_bf16 v[16:19], a[64:67], v[68:71], v[16:19]
    v_mfma_f32_16x16x32_bf16 v[20:23], a[68:71], v[68:71], v[20:23]
    v_mfma_f32_16x16x32_bf16 v[24:27], a[72:75], v[68:71], v[24:27]
    v_mfma_f32_16x16x32_bf16 v[28:31], a[76:79], v[68:71], v[28:31]
    v_mfma_f32_16x16x32_bf16 v[32:35], a[64:67], v[72:75], v[32:35]
    v_mfma_f32_16x16x32_bf16 v[36:39], a[68:71], v[72:75], v[36:39]
    v_mfma_f32_16x16x32_bf16 v[40:43], a[72:75], v[72:75], v[40:43]
    v_mfma_f32_16x16x32_bf16 v[44:47], a[76:79], v[72:75], v[44:47]
    v_mfma_f32_16x16x32_bf16 v[48:51], a[64:67], v[76:79], v[48:51]
    v_mfma_f32_16x16x32_bf16 v[52:55], a[68:71], v[76:79], v[52:55]
    v_mfma_f32_16x16x32_bf16 v[56:59], a[72:75], v[76:79], v[56:59]
    v_mfma_f32_16x16x32_bf16 v[60:63], a[76:79], v[76:79], v[60:63]
    s_waitcnt lgkmcnt(0)
    v_mfma_f32_16x16x32_bf16 v[0:3], a[80:83], v[80:83], v[0:3]
    ds_read_b128 v[64:67], v128 offset:24576
    v_mfma_f32_16x16x32_bf16 v[4:7], a[84:87], v[80:83], v[4:7]
    ds_read_b128 v[68:71], v128 offset:26624
    v_mfma_f32_16x16x32_bf16 v[8:11], a[88:91], v[80:83], v[8:11]
    ds_read_b128 v[72:75], v128 offset:28672
    v_mfma_f32_16x16x32_bf16 v[12:15], a[92:95], v[80:83], v[12:15]
    ds_read_b128 v[76:79], v128 offset:30720
    v_mfma_f32_16x16x32_bf16 v[16:19], a[80:83], v[84:87], v[16:19]
    v_mfma_f32_16x16x32_bf16 v[20:23], a[84:87], v[84:87], v[20:23]
    v_mfma_f32_16x16x32_bf16 v[24:27], a[88:91], v[84:87], v[24:27]
    v_mfma_f32_16x16x32_bf16 v[28:31], a[92:95], v[84:87], v[28:31]
    v_mfma_f32_16x16x32_bf16 v[32:35], a[80:83], v[88:91], v[32:35]
    v_mfma_f32_16x16x32_bf16 v[36:39], a[84:87], v[88:91], v[36:39]
    v_mfma_f32_16x16x32_bf16 v[40:43], a[88:91], v[88:91], v[40:43]
    v_mfma_f32_16x16x32_bf16 v[44:47], a[92:95], v[88:91], v[44:47]
    v_mfma_f32_16x16x32_bf16 v[48:51], a[80:83], v[92:95], v[48:51]
    v_mfma_f32_16x16x32_bf16 v[52:55], a[84:87], v[92:95], v[52:55]
    v_mfma_f32_16x16x32_bf16 v[56:59], a[88:91], v[92:95], v[56:59]
    v_mfma_f32_16x16x32_bf16 v[60:63], a[92:95], v[92:95], v[60:63]
    s_waitcnt lgkmcnt(0)
    v_mfma_f32_16x16x32_bf16 v[0:3], a[96:99], v[64:67], v[0:3]
    ds_read_b128 v[80:83], v129 offset:24576
    v_mfma_f32_16x16x32_bf16 v[4:7], a[100:103], v[64:67], v[4:7]
    ds_read_b128 v[84:87], v129 offset:26624
    v_mfma_f32_16x16x32_bf16 v[8:11], a[104:107], v[64:67], v[8:11]
    ds_read_b128 v[88:91], v129 offset:28672
    v_mfma_f32_16x16x32_bf16 v[12:15], a[108:111], v[64:67], v[12:15]
    ds_read_b128 v[92:95], v129 offset:30720
    v_mfma_f32_16x16x32_bf16 v[16:19], a[96:99], v[68:71], v[16:19]
    v_mfma_f32_16x16x32_bf16 v[20:23], a[100:103], v[68:71], v[20:23]
    v_mfma_f32_16x16x32_bf16 v[24:27], a[104:107], v[68:71], v[24:27]
    v_mfma_f32_16x16x32_bf16 v[28:31], a[108:111], v[68:71], v[28:31]
    v_mfma_f32_16x16x32_bf16 v[32:35], a[96:99], v[72:75], v[32:35]
    v_mfma_f32_16x16x32_bf16 v[36:39], a[100:103], v[72:75], v[36:39]
    v_mfma_f32_16x16x32_bf16 v[40:43], a[104:107], v[72:75], v[40:43]
    v_mfma_f32_16x16x32_bf16 v[44:47], a[108:111], v[72:75], v[44:47]
    v_mfma_f32_16x16x32_bf16 v[48:51], a[96:99], v[76:79], v[48:51]
    v_mfma_f32_16x16x32_bf16 v[52:55], a[100:103], v[76:79], v[52:55]
    v_mfma_f32_16x16x32_bf16 v[56:59], a[104:107], v[76:79], v[56:59]
    v_mfma_f32_16x16x32_bf16 v[60:63], a[108:111], v[76:79], v[60:63]
    s_waitcnt vmcnt(16) lgkmcnt(0)
    s_barrier
    v_mfma_f32_16x16x32_bf16 v[0:3], a[112:115], v[80:83], v[0:3]
    ds_read_b128 v[64:67], v128 offset:32768
    v_mfma_f32_16x16x32_bf16 v[4:7], a[116:119], v[80:83], v[4:7]
    ds_read_b128 v[68:71], v128 offset:34816
    v_mfma_f32_16x16x32_bf16 v[8:11], a[120:123], v[80:83], v[8:11]
    ds_read_b128 v[72:75], v128 offset:36864
    v_mfma_f32_16x16x32_bf16 v[12:15], a[124:127], v[80:83], v[12:15]
    ds_read_b128 v[76:79], v128 offset:38912
    v_mfma_f32_16x16x32_bf16 v[16:19], a[112:115], v[84:87], v[16:19]
    v_mfma_f32_16x16x32_bf16 v[20:23], a[116:119], v[84:87], v[20:23]
    s_add_u32 m0, s34, 16384
    s_add_u32 s38, s32, 256
    buffer_load_dwordx4 v134, s[8:11], s38 offen lds
    v_mfma_f32_16x16x32_bf16 v[24:27], a[120:123], v[84:87], v[24:27]
    v_mfma_f32_16x16x32_bf16 v[28:31], a[124:127], v[84:87], v[28:31]
    s_add_u32 m0, s34, 17408
    s_nop 0
    buffer_load_dwordx4 v135, s[8:11], s38 offen lds
    v_mfma_f32_16x16x32_bf16 v[32:35], a[112:115], v[88:91], v[32:35]
    v_mfma_f32_16x16x32_bf16 v[36:39], a[116:119], v[88:91], v[36:39]
    s_add_u32 m0, s34, 24576
    s_add_u32 s38, s32, 384
    buffer_load_dwordx4 v134, s[8:11], s38 offen lds
    v_mfma_f32_16x16x32_bf16 v[40:43], a[120:123], v[88:91], v[40:43]
    v_mfma_f32_16x16x32_bf16 v[44:47], a[124:127], v[88:91], v[44:47]
    s_add_u32 m0, s34, 25600
    s_nop 0
    buffer_load_dwordx4 v135, s[8:11], s38 offen lds
    v_mfma_f32_16x16x32_bf16 v[48:51], a[112:115], v[92:95], v[48:51]
    v_mfma_f32_16x16x32_bf16 v[52:55], a[116:119], v[92:95], v[52:55]
    v_mfma_f32_16x16x32_bf16 v[56:59], a[120:123], v[92:95], v[56:59]
    v_mfma_f32_16x16x32_bf16 v[60:63], a[124:127], v[92:95], v[60:63]
    s_waitcnt lgkmcnt(0)
    v_mfma_f32_16x16x32_bf16 v[0:3], a[128:131], v[64:67], v[0:3]
    ds_read_b128 v[80:83], v129 offset:32768
    v_mfma_f32_16x16x32_bf16 v[4:7], a[132:135], v[64:67], v[4:7]
    ds_read_b128 v[84:87], v129 offset:34816
    v_mfma_f32_16x16x32_bf16 v[8:11], a[136:139], v[64:67], v[8:11]
    ds_read_b128 v[88:91], v129 offset:36864
    v_mfma_f32_16x16x32_bf16 v[12:15], a[140:143], v[64:67], v[12:15]
    ds_read_b128 v[92:95], v129 offset:38912
    v_mfma_f32_16x16x32_bf16 v[16:19], a[128:131], v[68:71], v[16:19]
    v_mfma_f32_16x16x32_bf16 v[20:23], a[132:135], v[68:71], v[20:23]
    v_mfma_f32_16x16x32_bf16 v[24:27], a[136:139], v[68:71], v[24:27]
    v_mfma_f32_16x16x32_bf16 v[28:31], a[140:143], v[68:71], v[28:31]
    v_mfma_f32_16x16x32_bf16 v[32:35], a[128:131], v[72:75], v[32:35]
    v_mfma_f32_16x16x32_bf16 v[36:39], a[132:135], v[72:75], v[36:39]
    v_mfma_f32_16x16x32_bf16 v[40:43], a[136:139], v[72:75], v[40:43]
    v_mfma_f32_16x16x32_bf16 v[44:47], a[140:143], v[72:75], v[44:47]
    v_mfma_f32_16x16x32_bf16 v[48:51], a[128:131], v[76:79], v[48:51]
    v_mfma_f32_16x16x32_bf16 v[52:55], a[132:135], v[76:79], v[52:55]
    v_mfma_f32_16x16x32_bf16 v[56:59], a[136:139], v[76:79], v[56:59]
    v_mfma_f32_16x16x32_bf16 v[60:63], a[140:143], v[76:79], v[60:63]
    s_waitcnt lgkmcnt(0)
    v_mfma_f32_16x16x32_bf16 v[0:3], a[144:147], v[80:83], v[0:3]
    ds_read_b128 v[64:67], v128 offset:40960
    v_mfma_f32_16x16x32_bf16 v[4:7], a[148:151], v[80:83], v[4:7]
    ds_read_b128 v[68:71], v128 offset:43008
    v_mfma_f32_16x16x32_bf16 v[8:11], a[152:155], v[80:83], v[8:11]
    ds_read_b128 v[72:75], v128 offset:45056
    v_mfma_f32_16x16x32_bf16 v[12:15], a[156:159], v[80:83], v[12:15]
    ds_read_b128 v[76:79], v128 offset:47104
    v_mfma_f32_16x16x32_bf16 v[16:19], a[144:147], v[84:87], v[16:19]
    v_mfma_f32_16x16x32_bf16 v[20:23], a[148:151], v[84:87], v[20:23]
    v_mfma_f32_16x16x32_bf16 v[24:27], a[152:155], v[84:87], v[24:27]
    v_mfma_f32_16x16x32_bf16 v[28:31], a[156:159], v[84:87], v[28:31]
    v_mfma_f32_16x16x32_bf16 v[32:35], a[144:147], v[88:91], v[32:35]
    v_mfma_f32_16x16x32_bf16 v[36:39], a[148:151], v[88:91], v[36:39]
    v_mfma_f32_16x16x32_bf16 v[40:43], a[152:155], v[88:91], v[40:43]
    v_mfma_f32_16x16x32_bf16 v[44:47], a[156:159], v[88:91], v[44:47]
    v_mfma_f32_16x16x32_bf16 v[48:51], a[144:147], v[92:95], v[48:51]
    v_mfma_f32_16x16x32_bf16 v[52:55], a[148:151], v[92:95], v[52:55]
    v_mfma_f32_16x16x32_bf16 v[56:59], a[152:155], v[92:95], v[56:59]
    v_mfma_f32_16x16x32_bf16 v[60:63], a[156:159], v[92:95], v[60:63]
    s_waitcnt lgkmcnt(0)
    v_mfma_f32_16x16x32_bf16 v[0:3], a[160:163], v[64:67], v[0:3]
    ds_read_b128 v[80:83], v129 offset:40960
    v_mfma_f32_16x16x32_bf16 v[4:7], a[164:167], v[64:67], v[4:7]
    ds_read_b128 v[84:87], v129 offset:43008
    v_mfma_f32_16x16x32_bf16 v[8:11], a[168:171], v[64:67], v[8:11]
    ds_read_b128 v[88:91], v129 offset:45056
    v_mfma_f32_16x16x32_bf16 v[12:15], a[172:175], v[64:67], v[12:15]
    ds_read_b128 v[92:95], v129 offset:47104
    v_mfma_f32_16x16x32_bf16 v[16:19], a[160:163], v[68:71], v[16:19]
    v_mfma_f32_16x16x32_bf16 v[20:23], a[164:167], v[68:71], v[20:23]
    v_mfma_f32_16x16x32_bf16 v[24:27], a[168:171], v[68:71], v[24:27]
    v_mfma_f32_16x16x32_bf16 v[28:31], a[172:175], v[68:71], v[28:31]
    v_mfma_f32_16x16x32_bf16 v[32:35], a[160:163], v[72:75], v[32:35]
    v_mfma_f32_16x16x32_bf16 v[36:39], a[164:167], v[72:75], v[36:39]
    v_mfma_f32_16x16x32_bf16 v[40:43], a[168:171], v[72:75], v[40:43]
    v_mfma_f32_16x16x32_bf16 v[44:47], a[172:175], v[72:75], v[44:47]
    v_mfma_f32_16x16x32_bf16 v[48:51], a[160:163], v[76:79], v[48:51]
    v_mfma_f32_16x16x32_bf16 v[52:55], a[164:167], v[76:79], v[52:55]
    v_mfma_f32_16x16x32_bf16 v[56:59], a[168:171], v[76:79], v[56:59]
    v_mfma_f32_16x16x32_bf16 v[60:63], a[172:175], v[76:79], v[60:63]
    s_waitcnt vmcnt(16) lgkmcnt(0)
    s_barrier
    v_mfma_f32_16x16x32_bf16 v[0:3], a[176:179], v[80:83], v[0:3]
    ds_read_b128 v[64:67], v128 offset:49152
    v_mfma_f32_16x16x32_bf16 v[4:7], a[180:183], v[80:83], v[4:7]
    ds_read_b128 v[68:71], v128 offset:51200
    v_mfma_f32_16x16x32_bf16 v[8:11], a[184:187], v[80:83], v[8:11]
    ds_read_b128 v[72:75], v128 offset:53248
    v_mfma_f32_16x16x32_bf16 v[12:15], a[188:191], v[80:83], v[12:15]
    ds_read_b128 v[76:79], v128 offset:55296
    v_mfma_f32_16x16x32_bf16 v[16:19], a[176:179], v[84:87], v[16:19]
    v_mfma_f32_16x16x32_bf16 v[20:23], a[180:183], v[84:87], v[20:23]
    s_add_u32 m0, s34, 32768
    s_add_u32 s38, s32, 512
    buffer_load_dwordx4 v134, s[8:11], s38 offen lds
    v_mfma_f32_16x16x32_bf16 v[24:27], a[184:187], v[84:87], v[24:27]
    v_mfma_f32_16x16x32_bf16 v[28:31], a[188:191], v[84:87], v[28:31]
    s_add_u32 m0, s34, 33792
    s_nop 0
    buffer_load_dwordx4 v135, s[8:11], s38 offen lds
    v_mfma_f32_16x16x32_bf16 v[32:35], a[176:179], v[88:91], v[32:35]
    v_mfma_f32_16x16x32_bf16 v[36:39], a[180:183], v[88:91], v[36:39]
    s_add_u32 m0, s34, 40960
    s_add_u32 s38, s32, 640
    buffer_load_dwordx4 v134, s[8:11], s38 offen lds
    v_mfma_f32_16x16x32_bf16 v[40:43], a[184:187], v[88:91], v[40:43]
    v_mfma_f32_16x16x32_bf16 v[44:47], a[188:191], v[88:91], v[44:47]
    s_add_u32 m0, s34, 41984
    s_nop 0
    buffer_load_dwordx4 v135, s[8:11], s38 offen lds
    v_mfma_f32_16x16x32_bf16 v[48:51], a[176:179], v[92:95], v[48:51]
    v_mfma_f32_16x16x32_bf16 v[52:55], a[180:183], v[92:95], v[52:55]
    v_mfma_f32_16x16x32_bf16 v[56:59], a[184:187], v[92:95], v[56:59]
    v_mfma_f32_16x16x32_bf16 v[60:63], a[188:191], v[92:95], v[60:63]
    s_waitcnt lgkmcnt(0)
    v_mfma_f32_16x16x32_bf16 v[0:3], a[192:195], v[64:67], v[0:3]
    ds_read_b128 v[80:83], v129 offset:49152
    v_mfma_f32_16x16x32_bf16 v[4:7], a[196:199], v[64:67], v[4:7]
    ds_read_b128 v[84:87], v129 offset:51200
    v_mfma_f32_16x16x32_bf16 v[8:11], a[200:203], v[64:67], v[8:11]
    ds_read_b128 v[88:91], v129 offset:53248
    v_mfma_f32_16x16x32_bf16 v[12:15], a[204:207], v[64:67], v[12:15]
    ds_read_b128 v[92:95], v129 offset:55296
    v_mfma_f32_16x16x32_bf16 v[16:19], a[192:195], v[68:71], v[16:19]
    v_mfma_f32_16x16x32_bf16 v[20:23], a[196:199], v[68:71], v[20:23]
    v_mfma_f32_16x16x32_bf16 v[24:27], a[200:203], v[68:71], v[24:27]
    v_mfma_f32_16x16x32_bf16 v[28:31], a[204:207], v[68:71], v[28:31]
    v_mfma_f32_16x16x32_bf16 v[32:35], a[192:195], v[72:75], v[32:35]
    v_mfma_f32_16x16x32_bf16 v[36:39], a[196:199], v[72:75], v[36:39]
    v_mfma_f32_16x16x32_bf16 v[40:43], a[200:203], v[72:75], v[40:43]
    v_mfma_f32_16x16x32_bf16 v[44:47], a[204:207], v[72:75], v[44:47]
    v_mfma_f32_16x16x32_bf16 v[48:51], a[192:195], v[76:79], v[48:51]
    v_mfma_f32_16x16x32_bf16 v[52:55], a[196:199], v[76:79], v[52:55]
    v_mfma_f32_16x16x32_bf16 v[56:59], a[200:203], v[76:79], v[56:59]
    v_mfma_f32_16x16x32_bf16 v[60:63], a[204:207], v[76:79], v[60:63]
    s_waitcnt lgkmcnt(0)
    v_mfma_f32_16x16x32_bf16 v[0:3], a[208:211], v[80:83], v[0:3]
    ds_read_b128 v[64:67], v128 offset:57344
    v_mfma_f32_16x16x32_bf16 v[4:7], a[212:215], v[80:83], v[4:7]
    ds_read_b128 v[68:71], v128 offset:59392
    v_mfma_f32_16x16x32_bf16 v[8:11], a[216:219], v[80:83], v[8:11]
    ds_read_b128 v[72:75], v128 offset:61440
    v_mfma_f32_16x16x32_bf16 v[12:15], a[220:223], v[80:83], v[12:15]
    ds_read_b128 v[76:79], v128 offset:63488
    v_mfma_f32_16x16x32_bf16 v[16:19], a[208:211], v[84:87], v[16:19]
    v_mfma_f32_16x16x32_bf16 v[20:23], a[212:215], v[84:87], v[20:23]
    v_mfma_f32_16x16x32_bf16 v[24:27], a[216:219], v[84:87], v[24:27]
    v_mfma_f32_16x16x32_bf16 v[28:31], a[220:223], v[84:87], v[28:31]
    v_mfma_f32_16x16x32_bf16 v[32:35], a[208:211], v[88:91], v[32:35]
    v_mfma_f32_16x16x32_bf16 v[36:39], a[212:215], v[88:91], v[36:39]
    v_mfma_f32_16x16x32_bf16 v[40:43], a[216:219], v[88:91], v[40:43]
    v_mfma_f32_16x16x32_bf16 v[44:47], a[220:223], v[88:91], v[44:47]
    v_mfma_f32_16x16x32_bf16 v[48:51], a[208:211], v[92:95], v[48:51]
    v_mfma_f32_16x16x32_bf16 v[52:55], a[212:215], v[92:95], v[52:55]
    v_mfma_f32_16x16x32_bf16 v[56:59], a[216:219], v[92:95], v[56:59]
    v_mfma_f32_16x16x32_bf16 v[60:63], a[220:223], v[92:95], v[60:63]
    s_waitcnt lgkmcnt(0)
    v_mfma_f32_16x16x32_bf16 v[0:3], a[224:227], v[64:67], v[0:3]
    ds_read_b128 v[80:83], v129 offset:57344
    v_mfma_f32_16x16x32_bf16 v[4:7], a[228:231], v[64:67], v[4:7]
    ds_read_b128 v[84:87], v129 offset:59392
    v_mfma_f32_16x16x32_bf16 v[8:11], a[232:235], v[64:67], v[8:11]
    ds_read_b128 v[88:91], v129 offset:61440
    v_mfma_f32_16x16x32_bf16 v[12:15], a[236:239], v[64:67], v[12:15]
    ds_read_b128 v[92:95], v129 offset:63488
    v_mfma_f32_16x16x32_bf16 v[16:19], a[224:227], v[68:71], v[16:19]
    v_mfma_f32_16x16x32_bf16 v[20:23], a[228:231], v[68:71], v[20:23]
    v_mfma_f32_16x16x32_bf16 v[24:27], a[232:235], v[68:71], v[24:27]
    v_mfma_f32_16x16x32_bf16 v[28:31], a[236:239], v[68:71], v[28:31]
    v_mfma_f32_16x16x32_bf16 v[32:35], a[224:227], v[72:75], v[32:35]
    v_mfma_f32_16x16x32_bf16 v[36:39], a[228:231], v[72:75], v[36:39]
    v_mfma_f32_16x16x32_bf16 v[40:43], a[232:235], v[72:75], v[40:43]
    v_mfma_f32_16x16x32_bf16 v[44:47], a[236:239], v[72:75], v[44:47]
    v_mfma_f32_16x16x32_bf16 v[48:51], a[224:227], v[76:79], v[48:51]
    v_mfma_f32_16x16x32_bf16 v[52:55], a[228:231], v[76:79], v[52:55]
    v_mfma_f32_16x16x32_bf16 v[56:59], a[232:235], v[76:79], v[56:59]
    v_mfma_f32_16x16x32_bf16 v[60:63], a[236:239], v[76:79], v[60:63]
    s_waitcnt vmcnt(8) lgkmcnt(0)
    s_barrier
    v_mfma_f32_16x16x32_bf16 v[0:3], a[240:243], v[80:83], v[0:3]
    ds_read_b128 v[64:67], v128 offset:0
    v_mfma_f32_16x16x32_bf16 v[4:7], a[244:247], v[80:83], v[4:7]
    ds_read_b128 v[68:71], v128 offset:2048
    v_mfma_f32_16x16x32_bf16 v[8:11], a[248:251], v[80:83], v[8:11]
    ds_read_b128 v[72:75], v128 offset:4096
    v_mfma_f32_16x16x32_bf16 v[12:15], a[252:255], v[80:83], v[12:15]
    ds_read_b128 v[76:79], v128 offset:6144
    v_mfma_f32_16x16x32_bf16 v[16:19], a[240:243], v[84:87], v[16:19]
    v_mfma_f32_16x16x32_bf16 v[20:23], a[244:247], v[84:87], v[20:23]
    s_add_u32 m0, s34, 49152
    s_add_u32 s38, s32, 768
    buffer_load_dwordx4 v134, s[8:11], s38 offen lds
    v_mfma_f32_16x16x32_bf16 v[24:27], a[248:251], v[84:87], v[24:27]
    v_mfma_f32_16x16x32_bf16 v[28:31], a[252:255], v[84:87], v[28:31]
    s_add_u32 m0, s34, 50176
    s_nop 0
    buffer_load_dwordx4 v135, s[8:11], s38 offen lds
    v_mfma_f32_16x16x32_bf16 v[32:35], a[240:243], v[88:91], v[32:35]
    v_mfma_f32_16x16x32_bf16 v[36:39], a[244:247], v[88:91], v[36:39]
    s_add_u32 m0, s34, 57344
    s_add_u32 s38, s32, 896
    buffer_load_dwordx4 v134, s[8:11], s38 offen lds
    v_cvt_pk_bf16_f32 v96, v0, v1
    v_cvt_pk_bf16_f32 v97, v2, v3
    v_mfma_f32_16x16x32_bf16 v[40:43], a[248:251], v[88:91], v[40:43]
    v_cvt_pk_bf16_f32 v98, v4, v5
    v_cvt_pk_bf16_f32 v99, v6, v7
    v_mfma_f32_16x16x32_bf16 v[44:47], a[252:255], v[88:91], v[44:47]
    s_add_u32 m0, s34, 58368
    s_nop 0
    buffer_load_dwordx4 v135, s[8:11], s38 offen lds
    s_add_u32 s32, s32, 65536
    s_cmp_ge_u32 s32, s39
    s_cselect_b32 s32, 0x40000000, s32
    v_cvt_pk_bf16_f32 v100, v8, v9
    v_cvt_pk_bf16_f32 v101, v10, v11
    v_mfma_f32_16x16x32_bf16 v[48:51], a[240:243], v[92:95], v[48:51]
    v_cvt_pk_bf16_f32 v102, v12, v13
    v_cvt_pk_bf16_f32 v103, v14, v15
    v_mfma_f32_16x16x32_bf16 v[52:55], a[244:247], v[92:95], v[52:55]
    v_cvt_pk_bf16_f32 v104, v16, v17
    v_cvt_pk_bf16_f32 v105, v18, v19
    v_mfma_f32_16x16x32_bf16 v[56:59], a[248:251], v[92:95], v[56:59]
    v_cvt_pk_bf16_f32 v106, v20, v21
    v_cvt_pk_bf16_f32 v107, v22, v23
    v_mfma_f32_16x16x32_bf16 v[60:63], a[252:255], v[92:95], v[60:63]
    v_cvt_pk_bf16_f32 v108, v24, v25
    v_cvt_pk_bf16_f32 v109, v26, v27
    s_sub_u32 s37, s37, 1
    s_cmp_lg_u32 s37, 0
    s_cbranch_scc1 k1_K_loop
    s_waitcnt lgkmcnt(0)
    s_nop 7
    v_cvt_pk_bf16_f32 v110, v28, v29
    v_cvt_pk_bf16_f32 v111, v30, v31
    v_cvt_pk_bf16_f32 v112, v32, v33
    v_cvt_pk_bf16_f32 v113, v34, v35
    v_cvt_pk_bf16_f32 v114, v36, v37
    v_cvt_pk_bf16_f32 v115, v38, v39
    v_cvt_pk_bf16_f32 v116, v40, v41
    v_cvt_pk_bf16_f32 v117, v42, v43
    v_cvt_pk_bf16_f32 v118, v44, v45
    v_cvt_pk_bf16_f32 v119, v46, v47
    v_cvt_pk_bf16_f32 v120, v48, v49
    v_cvt_pk_bf16_f32 v121, v50, v51
    v_cvt_pk_bf16_f32 v122, v52, v53
    v_cvt_pk_bf16_f32 v123, v54, v55
    v_cvt_pk_bf16_f32 v124, v56, v57
    v_cvt_pk_bf16_f32 v125, v58, v59
    v_cvt_pk_bf16_f32 v126, v60, v61
    v_cvt_pk_bf16_f32 v127, v62, v63
    s_add_u32 s56, s36, 0
    buffer_store_dwordx4 v[96:99], v138, s[16:19], s56 offen offset:0
    s_add_u32 s56, s36, 0
    buffer_store_dwordx4 v[100:103], v138, s[16:19], s56 offen offset:2048
    s_add_u32 s56, s36, 0
    buffer_store_dwordx4 v[104:107], v138, s[16:19], s56 offen offset:128
    s_add_u32 s56, s36, 0
    buffer_store_dwordx4 v[108:111], v138, s[16:19], s56 offen offset:2176
    s_add_u32 s56, s36, 8192
    buffer_store_dwordx4 v[112:115], v138, s[16:19], s56 offen offset:0
    s_add_u32 s56, s36, 8192
    buffer_store_dwordx4 v[116:119], v138, s[16:19], s56 offen offset:2048
    s_add_u32 s56, s36, 8192
    buffer_store_dwordx4 v[120:123], v138, s[16:19], s56 offen offset:128
    s_add_u32 s56, s36, 8192
    buffer_store_dwordx4 v[124:127], v138, s[16:19], s56 offen offset:2176
    s_endpgm
k1_V:
    s_waitcnt lgkmcnt(0)
    v_mfma_f32_16x16x32_bf16 v[0:3], v[64:67], a[0:3], 0
    ds_read_b128 v[80:83], v129 offset:0
    ds_read_b128 v[84:87], v129 offset:2048
    v_mfma_f32_16x16x32_bf16 v[4:7], v[68:71], a[0:3], 0
    ds_read_b128 v[88:91], v129 offset:4096
    v_mfma_f32_16x16x32_bf16 v[8:11], v[64:67], a[4:7], 0
    ds_read_b128 v[92:95], v129 offset:6144
    ds_read_b64_tr_b16 a[16:17], v130 offset:4096
    v_mfma_f32_16x16x32_bf16 v[12:15], v[68:71], a[4:7], 0
    ds_read_b64_tr_b16 a[18:19], v130 offset:4608
    v_mfma_f32_16x16x32_bf16 v[16:19], v[64:67], a[8:11], 0
    ds_read_b64_tr_b16 a[20:21], v131 offset:4096
    ds_read_b64_tr_b16 a[22:23], v131 offset:4608
    v_mfma_f32_16x16x32_bf16 v[20:23], v[68:71], a[8:11], 0
    ds_read_b64_tr_b16 a[24:25], v132 offset:4096
    v_mfma_f32_16x16x32_bf16 v[24:27], v[64:67], a[12:15], 0
    ds_read_b64_tr_b16 a[26:27], v132 offset:4608
    ds_read_b64_tr_b16 a[28:29], v133 offset:4096
    v_mfma_f32_16x16x32_bf16 v[28:31], v[68:71], a[12:15], 0
    ds_read_b64_tr_b16 a[30:31], v133 offset:4608
    v_mfma_f32_16x16x32_bf16 v[32:35], v[72:75], a[0:3], 0
    v_mfma_f32_16x16x32_bf16 v[36:39], v[76:79], a[0:3], 0
    v_mfma_f32_16x16x32_bf16 v[40:43], v[72:75], a[4:7], 0
    v_mfma_f32_16x16x32_bf16 v[44:47], v[76:79], a[4:7], 0
    v_mfma_f32_16x16x32_bf16 v[48:51], v[72:75], a[8:11], 0
    v_mfma_f32_16x16x32_bf16 v[52:55], v[76:79], a[8:11], 0
    v_mfma_f32_16x16x32_bf16 v[56:59], v[72:75], a[12:15], 0
    v_mfma_f32_16x16x32_bf16 v[60:63], v[76:79], a[12:15], 0
    s_waitcnt vmcnt(25) lgkmcnt(0)
    v_mfma_f32_16x16x32_bf16 v[0:3], v[80:83], a[16:19], v[0:3]
    ds_read_b128 v[64:67], v128 offset:8192
    ds_read_b128 v[68:71], v128 offset:10240
    v_mfma_f32_16x16x32_bf16 v[4:7], v[84:87], a[16:19], v[4:7]
    ds_read_b128 v[72:75], v128 offset:12288
    v_mfma_f32_16x16x32_bf16 v[8:11], v[80:83], a[20:23], v[8:11]
    ds_read_b128 v[76:79], v128 offset:14336
    ds_read_b64_tr_b16 a[32:33], v130 offset:8192
    v_mfma_f32_16x16x32_bf16 v[12:15], v[84:87], a[20:23], v[12:15]
    ds_read_b64_tr_b16 a[34:35], v130 offset:8704
    v_mfma_f32_16x16x32_bf16 v[16:19], v[80:83], a[24:27], v[16:19]
    ds_read_b64_tr_b16 a[36:37], v131 offset:8192
    ds_read_b64_tr_b16 a[38:39], v131 offset:8704
    s_add_u32 m0, s35, 0
    s_mov_b32 s33, 1572864
    buffer_load_dwordx4 v136, s[12:15], s33 offen lds
    v_mfma_f32_16x16x32_bf16 v[20:23], v[84:87], a[24:27], v[20:23]
    ds_read_b64_tr_b16 a[40:41], v132 offset:8192
    s_add_u32 m0, s35, 1024
    s_nop 0
    buffer_load_dwordx4 v137, s[12:15], s33 offen lds
    v_mfma_f32_16x16x32_bf16 v[24:27], v[80:83], a[28:31], v[24:27]
    ds_read_b64_tr_b16 a[42:43], v132 offset:8704
    ds_read_b64_tr_b16 a[44:45], v133 offset:8192
    s_add_u32 m0, s35, 2048
    s_mov_b32 s33, 1703936
    buffer_load_dwordx4 v136, s[12:15], s33 offen lds
    v_mfma_f32_16x16x32_bf16 v[28:31], v[84:87], a[28:31], v[28:31]
    ds_read_b64_tr_b16 a[46:47], v133 offset:8704
    s_add_u32 m0, s35, 3072
    s_nop 0
    buffer_load_dwordx4 v137, s[12:15], s33 offen lds
    v_mfma_f32_16x16x32_bf16 v[32:35], v[88:91], a[16:19], v[32:35]
    s_add_u32 m0, s35, 4096
    s_mov_b32 s33, 1835008
    buffer_load_dwordx4 v136, s[12:15], s33 offen lds
    v_mfma_f32_16x16x32_bf16 v[36:39], v[92:95], a[16:19], v[36:39]
    s_add_u32 m0, s35, 5120
    s_nop 0
    buffer_load_dwordx4 v137, s[12:15], s33 offen lds
    v_mfma_f32_16x16x32_bf16 v[40:43], v[88:91], a[20:23], v[40:43]
    s_add_u32 m0, s35, 6144
    s_mov_b32 s33, 1966080
    buffer_load_dwordx4 v136, s[12:15], s33 offen lds
    v_mfma_f32_16x16x32_bf16 v[44:47], v[92:95], a[20:23], v[44:47]
    s_add_u32 m0, s35, 7168
    s_nop 0
    buffer_load_dwordx4 v137, s[12:15], s33 offen lds
    v_mfma_f32_16x16x32_bf16 v[48:51], v[88:91], a[24:27], v[48:51]
    v_mfma_f32_16x16x32_bf16 v[52:55], v[92:95], a[24:27], v[52:55]
    v_mfma_f32_16x16x32_bf16 v[56:59], v[88:91], a[28:31], v[56:59]
    v_mfma_f32_16x16x32_bf16 v[60:63], v[92:95], a[28:31], v[60:63]
    s_waitcnt lgkmcnt(0)
    v_mfma_f32_16x16x32_bf16 v[0:3], v[64:67], a[32:35], v[0:3]
    ds_read_b128 v[80:83], v129 offset:8192
    ds_read_b128 v[84:87], v129 offset:10240
    v_mfma_f32_16x16x32_bf16 v[4:7], v[68:71], a[32:35], v[4:7]
    ds_read_b128 v[88:91], v129 offset:12288
    v_mfma_f32_16x16x32_bf16 v[8:11], v[64:67], a[36:39], v[8:11]
    ds_read_b128 v[92:95], v129 offset:14336
    ds_read_b64_tr_b16 a[48:49], v130 offset:12288
    v_mfma_f32_16x16x32_bf16 v[12:15], v[68:71], a[36:39], v[12:15]
    ds_read_b64_tr_b16 a[50:51], v130 offset:12800
    v_mfma_f32_16x16x32_bf16 v[16:19], v[64:67], a[40:43], v[16:19]
    ds_read_b64_tr_b16 a[52:53], v131 offset:12288
    ds_read_b64_tr_b16 a[54:55], v131 offset:12800
    v_mfma_f32_16x16x32_bf16 v[20:23], v[68:71], a[40:43], v[20:23]
    ds_read_b64_tr_b16 a[56:57], v132 offset:12288
    v_mfma_f32_16x16x32_bf16 v[24:27], v[64:67], a[44:47], v[24:27]
    ds_read_b64_tr_b16 a[58:59], v132 offset:12800
    ds_read_b64_tr_b16 a[60:61], v133 offset:12288
    v_mfma_f32_16x16x32_bf16 v[28:31], v[68:71], a[44:47], v[28:31]
    ds_read_b64_tr_b16 a[62:63], v133 offset:12800
    v_mfma_f32_16x16x32_bf16 v[32:35], v[72:75], a[32:35], v[32:35]
    v_mfma_f32_16x16x32_bf16 v[36:39], v[76:79], a[32:35], v[36:39]
    v_mfma_f32_16x16x32_bf16 v[40:43], v[72:75], a[36:39], v[40:43]
    v_mfma_f32_16x16x32_bf16 v[44:47], v[76:79], a[36:39], v[44:47]
    v_mfma_f32_16x16x32_bf16 v[48:51], v[72:75], a[40:43], v[48:51]
    v_mfma_f32_16x16x32_bf16 v[52:55], v[76:79], a[40:43], v[52:55]
    v_mfma_f32_16x16x32_bf16 v[56:59], v[72:75], a[44:47], v[56:59]
    v_mfma_f32_16x16x32_bf16 v[60:63], v[76:79], a[44:47], v[60:63]
    s_waitcnt vmcnt(21) lgkmcnt(0)
    s_barrier
    v_mfma_f32_16x16x32_bf16 v[0:3], v[80:83], a[48:51], v[0:3]
    ds_read_b128 v[64:67], v128 offset:16384
    ds_read_b128 v[68:71], v128 offset:18432
    v_mfma_f32_16x16x32_bf16 v[4:7], v[84:87], a[48:51], v[4:7]
    ds_read_b128 v[72:75], v128 offset:20480
    v_mfma_f32_16x16x32_bf16 v[8:11], v[80:83], a[52:55], v[8:11]
    ds_read_b128 v[76:79], v128 offset:22528
    ds_read_b64_tr_b16 a[64:65], v130 offset:16384
    v_mfma_f32_16x16x32_bf16 v[12:15], v[84:87], a[52:55], v[12:15]
    ds_read_b64_tr_b16 a[66:67], v130 offset:16896
    v_mfma_f32_16x16x32_bf16 v[16:19], v[80:83], a[56:59], v[16:19]
    ds_read_b64_tr_b16 a[68:69], v131 offset:16384
    ds_read_b64_tr_b16 a[70:71], v131 offset:16896
    s_add_u32 m0, s34, 0
    s_add_u32 s38, s32, 0
    buffer_load_dwordx4 v134, s[8:11], s38 offen lds
    v_mfma_f32_16x16x32_bf16 v[20:23], v[84:87], a[56:59], v[20:23]
    ds_read_b64_tr_b16 a[72:73], v132 offset:16384
    s_add_u32 m0, s34, 1024
    s_nop 0
    buffer_load_dwordx4 v135, s[8:11], s38 offen lds
    v_mfma_f32_16x16x32_bf16 v[24:27], v[80:83], a[60:63], v[24:27]
    ds_read_b64_tr_b16 a[74:75], v132 offset:16896
    ds_read_b64_tr_b16 a[76:77], v133 offset:16384
    s_add_u32 m0, s34, 8192
    s_add_u32 s38, s32, 128
    buffer_load_dwordx4 v134, s[8:11], s38 offen lds
    v_mfma_f32_16x16x32_bf16 v[28:31], v[84:87], a[60:63], v[28:31]
    ds_read_b64_tr_b16 a[78:79], v133 offset:16896
    s_add_u32 m0, s34, 9216
    s_nop 0
    buffer_load_dwordx4 v135, s[8:11], s38 offen lds
    v_mfma_f32_16x16x32_bf16 v[32:35], v[88:91], a[48:51], v[32:35]
    s_add_u32 m0, s35, 8192
    s_mov_b32 s33, 2097152
    buffer_load_dwordx4 v136, s[12:15], s33 offen lds
    v_mfma_f32_16x16x32_bf16 v[36:39], v[92:95], a[48:51], v[36:39]
    s_add_u32 m0, s35, 9216
    s_nop 0
    buffer_load_dwordx4 v137, s[12:15], s33 offen lds
    v_mfma_f32_16x16x32_bf16 v[40:43], v[88:91], a[52:55], v[40:43]
    s_add_u32 m0, s35, 10240
    s_mov_b32 s33, 2228224
    buffer_load_dwordx4 v136, s[12:15], s33 offen lds
    v_mfma_f32_16x16x32_bf16 v[44:47], v[92:95], a[52:55], v[44:47]
    s_add_u32 m0, s35, 11264
    s_nop 0
    buffer_load_dwordx4 v137, s[12:15], s33 offen lds
    v_mfma_f32_16x16x32_bf16 v[48:51], v[88:91], a[56:59], v[48:51]
    s_add_u32 m0, s35, 12288
    s_mov_b32 s33, 2359296
    buffer_load_dwordx4 v136, s[12:15], s33 offen lds
    v_mfma_f32_16x16x32_bf16 v[52:55], v[92:95], a[56:59], v[52:55]
    s_add_u32 m0, s35, 13312
    s_nop 0
    buffer_load_dwordx4 v137, s[12:15], s33 offen lds
    v_mfma_f32_16x16x32_bf16 v[56:59], v[88:91], a[60:63], v[56:59]
    s_add_u32 m0, s35, 14336
    s_mov_b32 s33, 2490368
    buffer_load_dwordx4 v136, s[12:15], s33 offen lds
    v_mfma_f32_16x16x32_bf16 v[60:63], v[92:95], a[60:63], v[60:63]
    s_add_u32 m0, s35, 15360
    s_nop 0
    buffer_load_dwordx4 v137, s[12:15], s33 offen lds
    s_waitcnt lgkmcnt(0)
    v_mfma_f32_16x16x32_bf16 v[0:3], v[64:67], a[64:67], v[0:3]
    ds_read_b128 v[80:83], v129 offset:16384
    ds_read_b128 v[84:87], v129 offset:18432
    v_mfma_f32_16x16x32_bf16 v[4:7], v[68:71], a[64:67], v[4:7]
    ds_read_b128 v[88:91], v129 offset:20480
    v_mfma_f32_16x16x32_bf16 v[8:11], v[64:67], a[68:71], v[8:11]
    ds_read_b128 v[92:95], v129 offset:22528
    ds_read_b64_tr_b16 a[80:81], v130 offset:20480
    v_mfma_f32_16x16x32_bf16 v[12:15], v[68:71], a[68:71], v[12:15]
    ds_read_b64_tr_b16 a[82:83], v130 offset:20992
    v_mfma_f32_16x16x32_bf16 v[16:19], v[64:67], a[72:75], v[16:19]
    ds_read_b64_tr_b16 a[84:85], v131 offset:20480
    ds_read_b64_tr_b16 a[86:87], v131 offset:20992
    v_mfma_f32_16x16x32_bf16 v[20:23], v[68:71], a[72:75], v[20:23]
    ds_read_b64_tr_b16 a[88:89], v132 offset:20480
    v_mfma_f32_16x16x32_bf16 v[24:27], v[64:67], a[76:79], v[24:27]
    ds_read_b64_tr_b16 a[90:91], v132 offset:20992
    ds_read_b64_tr_b16 a[92:93], v133 offset:20480
    v_mfma_f32_16x16x32_bf16 v[28:31], v[68:71], a[76:79], v[28:31]
    ds_read_b64_tr_b16 a[94:95], v133 offset:20992
    v_mfma_f32_16x16x32_bf16 v[32:35], v[72:75], a[64:67], v[32:35]
    v_mfma_f32_16x16x32_bf16 v[36:39], v[76:79], a[64:67], v[36:39]
    v_mfma_f32_16x16x32_bf16 v[40:43], v[72:75], a[68:71], v[40:43]
    v_mfma_f32_16x16x32_bf16 v[44:47], v[76:79], a[68:71], v[44:47]
    v_mfma_f32_16x16x32_bf16 v[48:51], v[72:75], a[72:75], v[48:51]
    v_mfma_f32_16x16x32_bf16 v[52:55], v[76:79], a[72:75], v[52:55]
    v_mfma_f32_16x16x32_bf16 v[56:59], v[72:75], a[76:79], v[56:59]
    v_mfma_f32_16x16x32_bf16 v[60:63], v[76:79], a[76:79], v[60:63]
    s_waitcnt vmcnt(12) lgkmcnt(0)
    v_mfma_f32_16x16x32_bf16 v[0:3], v[80:83], a[80:83], v[0:3]
    ds_read_b128 v[64:67], v128 offset:24576
    ds_read_b128 v[68:71], v128 offset:26624
    v_mfma_f32_16x16x32_bf16 v[4:7], v[84:87], a[80:83], v[4:7]
    ds_read_b128 v[72:75], v128 offset:28672
    v_mfma_f32_16x16x32_bf16 v[8:11], v[80:83], a[84:87], v[8:11]
    ds_read_b128 v[76:79], v128 offset:30720
    ds_read_b64_tr_b16 a[96:97], v130 offset:0
    v_mfma_f32_16x16x32_bf16 v[12:15], v[84:87], a[84:87], v[12:15]
    ds_read_b64_tr_b16 a[98:99], v130 offset:512
    v_mfma_f32_16x16x32_bf16 v[16:19], v[80:83], a[88:91], v[16:19]
    ds_read_b64_tr_b16 a[100:101], v131 offset:0
    ds_read_b64_tr_b16 a[102:103], v131 offset:512
    s_add_u32 m0, s35, 16384
    s_mov_b32 s33, 2621440
    buffer_load_dwordx4 v136, s[12:15], s33 offen lds
    v_mfma_f32_16x16x32_bf16 v[20:23], v[84:87], a[88:91], v[20:23]
    ds_read_b64_tr_b16 a[104:105], v132 offset:0
    s_add_u32 m0, s35, 17408
    s_nop 0
    buffer_load_dwordx4 v137, s[12:15], s33 offen lds
    v_mfma_f32_16x16x32_bf16 v[24:27], v[80:83], a[92:95], v[24:27]
    ds_read_b64_tr_b16 a[106:107], v132 offset:512
    ds_read_b64_tr_b16 a[108:109], v133 offset:0
    s_add_u32 m0, s35, 18432
    s_mov_b32 s33, 2752512
    buffer_load_dwordx4 v136, s[12:15], s33 offen lds
    v_mfma_f32_16x16x32_bf16 v[28:31], v[84:87], a[92:95], v[28:31]
    ds_read_b64_tr_b16 a[110:111], v133 offset:512
    s_add_u32 m0, s35, 19456
    s_nop 0
    buffer_load_dwordx4 v137, s[12:15], s33 offen lds
    v_mfma_f32_16x16x32_bf16 v[32:35], v[88:91], a[80:83], v[32:35]
    s_add_u32 m0, s35, 20480
    s_mov_b32 s33, 2883584
    buffer_load_dwordx4 v136, s[12:15], s33 offen lds
    v_mfma_f32_16x16x32_bf16 v[36:39], v[92:95], a[80:83], v[36:39]
    s_add_u32 m0, s35, 21504
    s_nop 0
    buffer_load_dwordx4 v137, s[12:15], s33 offen lds
    v_mfma_f32_16x16x32_bf16 v[40:43], v[88:91], a[84:87], v[40:43]
    s_add_u32 m0, s35, 22528
    s_mov_b32 s33, 3014656
    buffer_load_dwordx4 v136, s[12:15], s33 offen lds
    v_mfma_f32_16x16x32_bf16 v[44:47], v[92:95], a[84:87], v[44:47]
    s_add_u32 m0, s35, 23552
    s_nop 0
    buffer_load_dwordx4 v137, s[12:15], s33 offen lds
    v_mfma_f32_16x16x32_bf16 v[48:51], v[88:91], a[88:91], v[48:51]
    v_mfma_f32_16x16x32_bf16 v[52:55], v[92:95], a[88:91], v[52:55]
    v_mfma_f32_16x16x32_bf16 v[56:59], v[88:91], a[92:95], v[56:59]
    v_mfma_f32_16x16x32_bf16 v[60:63], v[92:95], a[92:95], v[60:63]
    s_waitcnt lgkmcnt(0)
    v_mfma_f32_16x16x32_bf16 v[0:3], v[64:67], a[96:99], v[0:3]
    ds_read_b128 v[80:83], v129 offset:24576
    ds_read_b128 v[84:87], v129 offset:26624
    v_mfma_f32_16x16x32_bf16 v[4:7], v[68:71], a[96:99], v[4:7]
    ds_read_b128 v[88:91], v129 offset:28672
    v_mfma_f32_16x16x32_bf16 v[8:11], v[64:67], a[100:103], v[8:11]
    ds_read_b128 v[92:95], v129 offset:30720
    ds_read_b64_tr_b16 a[112:113], v130 offset:4096
    v_mfma_f32_16x16x32_bf16 v[12:15], v[68:71], a[100:103], v[12:15]
    ds_read_b64_tr_b16 a[114:115], v130 offset:4608
    v_mfma_f32_16x16x32_bf16 v[16:19], v[64:67], a[104:107], v[16:19]
    ds_read_b64_tr_b16 a[116:117], v131 offset:4096
    ds_read_b64_tr_b16 a[118:119], v131 offset:4608
    v_mfma_f32_16x16x32_bf16 v[20:23], v[68:71], a[104:107], v[20:23]
    ds_read_b64_tr_b16 a[120:121], v132 offset:4096
    v_mfma_f32_16x16x32_bf16 v[24:27], v[64:67], a[108:111], v[24:27]
    ds_read_b64_tr_b16 a[122:123], v132 offset:4608
    ds_read_b64_tr_b16 a[124:125], v133 offset:4096
    v_mfma_f32_16x16x32_bf16 v[28:31], v[68:71], a[108:111], v[28:31]
    ds_read_b64_tr_b16 a[126:127], v133 offset:4608
    v_mfma_f32_16x16x32_bf16 v[32:35], v[72:75], a[96:99], v[32:35]
    v_mfma_f32_16x16x32_bf16 v[36:39], v[76:79], a[96:99], v[36:39]
    v_mfma_f32_16x16x32_bf16 v[40:43], v[72:75], a[100:103], v[40:43]
    v_mfma_f32_16x16x32_bf16 v[44:47], v[76:79], a[100:103], v[44:47]
    v_mfma_f32_16x16x32_bf16 v[48:51], v[72:75], a[104:107], v[48:51]
    v_mfma_f32_16x16x32_bf16 v[52:55], v[76:79], a[104:107], v[52:55]
    v_mfma_f32_16x16x32_bf16 v[56:59], v[72:75], a[108:111], v[56:59]
    v_mfma_f32_16x16x32_bf16 v[60:63], v[76:79], a[108:111], v[60:63]
    s_waitcnt vmcnt(8) lgkmcnt(0)
    s_barrier
    v_mfma_f32_16x16x32_bf16 v[0:3], v[80:83], a[112:115], v[0:3]
    ds_read_b128 v[64:67], v128 offset:32768
    ds_read_b128 v[68:71], v128 offset:34816
    v_mfma_f32_16x16x32_bf16 v[4:7], v[84:87], a[112:115], v[4:7]
    ds_read_b128 v[72:75], v128 offset:36864
    v_mfma_f32_16x16x32_bf16 v[8:11], v[80:83], a[116:119], v[8:11]
    ds_read_b128 v[76:79], v128 offset:38912
    ds_read_b64_tr_b16 a[128:129], v130 offset:8192
    v_mfma_f32_16x16x32_bf16 v[12:15], v[84:87], a[116:119], v[12:15]
    ds_read_b64_tr_b16 a[130:131], v130 offset:8704
    v_mfma_f32_16x16x32_bf16 v[16:19], v[80:83], a[120:123], v[16:19]
    ds_read_b64_tr_b16 a[132:133], v131 offset:8192
    ds_read_b64_tr_b16 a[134:135], v131 offset:8704
    s_add_u32 m0, s34, 16384
    s_add_u32 s38, s32, 256
    buffer_load_dwordx4 v134, s[8:11], s38 offen lds
    v_mfma_f32_16x16x32_bf16 v[20:23], v[84:87], a[120:123], v[20:23]
    ds_read_b64_tr_b16 a[136:137], v132 offset:8192
    s_add_u32 m0, s34, 17408
    s_nop 0
    buffer_load_dwordx4 v135, s[8:11], s38 offen lds
    v_mfma_f32_16x16x32_bf16 v[24:27], v[80:83], a[124:127], v[24:27]
    ds_read_b64_tr_b16 a[138:139], v132 offset:8704
    ds_read_b64_tr_b16 a[140:141], v133 offset:8192
    s_add_u32 m0, s34, 24576
    s_add_u32 s38, s32, 384
    buffer_load_dwordx4 v134, s[8:11], s38 offen lds
    v_mfma_f32_16x16x32_bf16 v[28:31], v[84:87], a[124:127], v[28:31]
    ds_read_b64_tr_b16 a[142:143], v133 offset:8704
    s_add_u32 m0, s34, 25600
    s_nop 0
    buffer_load_dwordx4 v135, s[8:11], s38 offen lds
    v_mfma_f32_16x16x32_bf16 v[32:35], v[88:91], a[112:115], v[32:35]
    s_add_u32 m0, s35, 0
    s_mov_b32 s33, 3145728
    buffer_load_dwordx4 v136, s[12:15], s33 offen lds
    v_mfma_f32_16x16x32_bf16 v[36:39], v[92:95], a[112:115], v[36:39]
    s_add_u32 m0, s35, 1024
    s_nop 0
    buffer_load_dwordx4 v137, s[12:15], s33 offen lds
    v_mfma_f32_16x16x32_bf16 v[40:43], v[88:91], a[116:119], v[40:43]
    s_add_u32 m0, s35, 2048
    s_mov_b32 s33, 3276800
    buffer_load_dwordx4 v136, s[12:15], s33 offen lds
    v_mfma_f32_16x16x32_bf16 v[44:47], v[92:95], a[116:119], v[44:47]
    s_add_u32 m0, s35, 3072
    s_nop 0
    buffer_load_dwordx4 v137, s[12:15], s33 offen lds
    v_mfma_f32_16x16x32_bf16 v[48:51], v[88:91], a[120:123], v[48:51]
    s_add_u32 m0, s35, 4096
    s_mov_b32 s33, 3407872
    buffer_load_dwordx4 v136, s[12:15], s33 offen lds
    v_mfma_f32_16x16x32_bf16 v[52:55], v[92:95], a[120:123], v[52:55]
    s_add_u32 m0, s35, 5120
    s_nop 0
    buffer_load_dwordx4 v137, s[12:15], s33 offen lds
    v_mfma_f32_16x16x32_bf16 v[56:59], v[88:91], a[124:127], v[56:59]
    s_add_u32 m0, s35, 6144
    s_mov_b32 s33, 3538944
    buffer_load_dwordx4 v136, s[12:15], s33 offen lds
    v_mfma_f32_16x16x32_bf16 v[60:63], v[92:95], a[124:127], v[60:63]
    s_add_u32 m0, s35, 7168
    s_nop 0
    buffer_load_dwordx4 v137, s[12:15], s33 offen lds
    s_waitcnt lgkmcnt(0)
    v_mfma_f32_16x16x32_bf16 v[0:3], v[64:67], a[128:131], v[0:3]
    ds_read_b128 v[80:83], v129 offset:32768
    ds_read_b128 v[84:87], v129 offset:34816
    v_mfma_f32_16x16x32_bf16 v[4:7], v[68:71], a[128:131], v[4:7]
    ds_read_b128 v[88:91], v129 offset:36864
    v_mfma_f32_16x16x32_bf16 v[8:11], v[64:67], a[132:135], v[8:11]
    ds_read_b128 v[92:95], v129 offset:38912
    ds_read_b64_tr_b16 a[144:145], v130 offset:12288
    v_mfma_f32_16x16x32_bf16 v[12:15], v[68:71], a[132:135], v[12:15]
    ds_read_b64_tr_b16 a[146:147], v130 offset:12800
    v_mfma_f32_16x16x32_bf16 v[16:19], v[64:67], a[136:139], v[16:19]
    ds_read_b64_tr_b16 a[148:149], v131 offset:12288
    ds_read_b64_tr_b16 a[150:151], v131 offset:12800
    v_mfma_f32_16x16x32_bf16 v[20:23], v[68:71], a[136:139], v[20:23]
    ds_read_b64_tr_b16 a[152:153], v132 offset:12288
    v_mfma_f32_16x16x32_bf16 v[24:27], v[64:67], a[140:143], v[24:27]
    ds_read_b64_tr_b16 a[154:155], v132 offset:12800
    ds_read_b64_tr_b16 a[156:157], v133 offset:12288
    v_mfma_f32_16x16x32_bf16 v[28:31], v[68:71], a[140:143], v[28:31]
    ds_read_b64_tr_b16 a[158:159], v133 offset:12800
    v_mfma_f32_16x16x32_bf16 v[32:35], v[72:75], a[128:131], v[32:35]
    v_mfma_f32_16x16x32_bf16 v[36:39], v[76:79], a[128:131], v[36:39]
    v_mfma_f32_16x16x32_bf16 v[40:43], v[72:75], a[132:135], v[40:43]
    v_mfma_f32_16x16x32_bf16 v[44:47], v[76:79], a[132:135], v[44:47]
    v_mfma_f32_16x16x32_bf16 v[48:51], v[72:75], a[136:139], v[48:51]
    v_mfma_f32_16x16x32_bf16 v[52:55], v[76:79], a[136:139], v[52:55]
    v_mfma_f32_16x16x32_bf16 v[56:59], v[72:75], a[140:143], v[56:59]
    v_mfma_f32_16x16x32_bf16 v[60:63], v[76:79], a[140:143], v[60:63]
    s_waitcnt vmcnt(12) lgkmcnt(0)
    v_mfma_f32_16x16x32_bf16 v[0:3], v[80:83], a[144:147], v[0:3]
    ds_read_b128 v[64:67], v128 offset:40960
    ds_read_b128 v[68:71], v128 offset:43008
    v_mfma_f32_16x16x32_bf16 v[4:7], v[84:87], a[144:147], v[4:7]
    ds_read_b128 v[72:75], v128 offset:45056
    v_mfma_f32_16x16x32_bf16 v[8:11], v[80:83], a[148:151], v[8:11]
    ds_read_b128 v[76:79], v128 offset:47104
    ds_read_b64_tr_b16 a[160:161], v130 offset:16384
    v_mfma_f32_16x16x32_bf16 v[12:15], v[84:87], a[148:151], v[12:15]
    ds_read_b64_tr_b16 a[162:163], v130 offset:16896
    v_mfma_f32_16x16x32_bf16 v[16:19], v[80:83], a[152:155], v[16:19]
    ds_read_b64_tr_b16 a[164:165], v131 offset:16384
    ds_read_b64_tr_b16 a[166:167], v131 offset:16896
    s_add_u32 m0, s35, 8192
    s_mov_b32 s33, 3670016
    buffer_load_dwordx4 v136, s[12:15], s33 offen lds
    v_mfma_f32_16x16x32_bf16 v[20:23], v[84:87], a[152:155], v[20:23]
    ds_read_b64_tr_b16 a[168:169], v132 offset:16384
    s_add_u32 m0, s35, 9216
    s_nop 0
    buffer_load_dwordx4 v137, s[12:15], s33 offen lds
    v_mfma_f32_16x16x32_bf16 v[24:27], v[80:83], a[156:159], v[24:27]
    ds_read_b64_tr_b16 a[170:171], v132 offset:16896
    ds_read_b64_tr_b16 a[172:173], v133 offset:16384
    s_add_u32 m0, s35, 10240
    s_mov_b32 s33, 3801088
    buffer_load_dwordx4 v136, s[12:15], s33 offen lds
    v_mfma_f32_16x16x32_bf16 v[28:31], v[84:87], a[156:159], v[28:31]
    ds_read_b64_tr_b16 a[174:175], v133 offset:16896
    s_add_u32 m0, s35, 11264
    s_nop 0
    buffer_load_dwordx4 v137, s[12:15], s33 offen lds
    v_mfma_f32_16x16x32_bf16 v[32:35], v[88:91], a[144:147], v[32:35]
    s_add_u32 m0, s35, 12288
    s_mov_b32 s33, 3932160
    buffer_load_dwordx4 v136, s[12:15], s33 offen lds
    v_mfma_f32_16x16x32_bf16 v[36:39], v[92:95], a[144:147], v[36:39]
    s_add_u32 m0, s35, 13312
    s_nop 0
    buffer_load_dwordx4 v137, s[12:15], s33 offen lds
    v_mfma_f32_16x16x32_bf16 v[40:43], v[88:91], a[148:151], v[40:43]
    s_add_u32 m0, s35, 14336
    s_mov_b32 s33, 4063232
    buffer_load_dwordx4 v136, s[12:15], s33 offen lds
    v_mfma_f32_16x16x32_bf16 v[44:47], v[92:95], a[148:151], v[44:47]
    s_add_u32 m0, s35, 15360
    s_nop 0
    buffer_load_dwordx4 v137, s[12:15], s33 offen lds
    v_mfma_f32_16x16x32_bf16 v[48:51], v[88:91], a[152:155], v[48:51]
    v_mfma_f32_16x16x32_bf16 v[52:55], v[92:95], a[152:155], v[52:55]
    v_mfma_f32_16x16x32_bf16 v[56:59], v[88:91], a[156:159], v[56:59]
    v_mfma_f32_16x16x32_bf16 v[60:63], v[92:95], a[156:159], v[60:63]
    s_waitcnt lgkmcnt(0)
    v_mfma_f32_16x16x32_bf16 v[0:3], v[64:67], a[160:163], v[0:3]
    ds_read_b128 v[80:83], v129 offset:40960
    ds_read_b128 v[84:87], v129 offset:43008
    v_mfma_f32_16x16x32_bf16 v[4:7], v[68:71], a[160:163], v[4:7]
    ds_read_b128 v[88:91], v129 offset:45056
    v_mfma_f32_16x16x32_bf16 v[8:11], v[64:67], a[164:167], v[8:11]
    ds_read_b128 v[92:95], v129 offset:47104
    ds_read_b64_tr_b16 a[176:177], v130 offset:20480
    v_mfma_f32_16x16x32_bf16 v[12:15], v[68:71], a[164:167], v[12:15]
    ds_read_b64_tr_b16 a[178:179], v130 offset:20992
    v_mfma_f32_16x16x32_bf16 v[16:19], v[64:67], a[168:171], v[16:19]
    ds_read_b64_tr_b16 a[180:181], v131 offset:20480
    ds_read_b64_tr_b16 a[182:183], v131 offset:20992
    v_mfma_f32_16x16x32_bf16 v[20:23], v[68:71], a[168:171], v[20:23]
    ds_read_b64_tr_b16 a[184:185], v132 offset:20480
    v_mfma_f32_16x16x32_bf16 v[24:27], v[64:67], a[172:175], v[24:27]
    ds_read_b64_tr_b16 a[186:187], v132 offset:20992
    ds_read_b64_tr_b16 a[188:189], v133 offset:20480
    v_mfma_f32_16x16x32_bf16 v[28:31], v[68:71], a[172:175], v[28:31]
    ds_read_b64_tr_b16 a[190:191], v133 offset:20992
    v_mfma_f32_16x16x32_bf16 v[32:35], v[72:75], a[160:163], v[32:35]
    v_mfma_f32_16x16x32_bf16 v[36:39], v[76:79], a[160:163], v[36:39]
    v_mfma_f32_16x16x32_bf16 v[40:43], v[72:75], a[164:167], v[40:43]
    v_mfma_f32_16x16x32_bf16 v[44:47], v[76:79], a[164:167], v[44:47]
    v_mfma_f32_16x16x32_bf16 v[48:51], v[72:75], a[168:171], v[48:51]
    v_mfma_f32_16x16x32_bf16 v[52:55], v[76:79], a[168:171], v[52:55]
    v_mfma_f32_16x16x32_bf16 v[56:59], v[72:75], a[172:175], v[56:59]
    v_mfma_f32_16x16x32_bf16 v[60:63], v[76:79], a[172:175], v[60:63]
    s_waitcnt vmcnt(8) lgkmcnt(0)
    s_barrier
    v_mfma_f32_16x16x32_bf16 v[0:3], v[80:83], a[176:179], v[0:3]
    ds_read_b128 v[64:67], v128 offset:49152
    ds_read_b128 v[68:71], v128 offset:51200
    v_mfma_f32_16x16x32_bf16 v[4:7], v[84:87], a[176:179], v[4:7]
    ds_read_b128 v[72:75], v128 offset:53248
    v_mfma_f32_16x16x32_bf16 v[8:11], v[80:83], a[180:183], v[8:11]
    ds_read_b128 v[76:79], v128 offset:55296
    ds_read_b64_tr_b16 a[192:193], v130 offset:0
    v_mfma_f32_16x16x32_bf16 v[12:15], v[84:87], a[180:183], v[12:15]
    ds_read_b64_tr_b16 a[194:195], v130 offset:512
    v_mfma_f32_16x16x32_bf16 v[16:19], v[80:83], a[184:187], v[16:19]
    ds_read_b64_tr_b16 a[196:197], v131 offset:0
    ds_read_b64_tr_b16 a[198:199], v131 offset:512
    v_mfma_f32_16x16x32_bf16 v[20:23], v[84:87], a[184:187], v[20:23]
    ds_read_b64_tr_b16 a[200:201], v132 offset:0
    s_add_u32 m0, s34, 32768
    s_add_u32 s38, s32, 512
    buffer_load_dwordx4 v134, s[8:11], s38 offen lds
    v_mfma_f32_16x16x32_bf16 v[24:27], v[80:83], a[188:191], v[24:27]
    ds_read_b64_tr_b16 a[202:203], v132 offset:512
    ds_read_b64_tr_b16 a[204:205], v133 offset:0
    v_mfma_f32_16x16x32_bf16 v[28:31], v[84:87], a[188:191], v[28:31]
    ds_read_b64_tr_b16 a[206:207], v133 offset:512
    s_add_u32 m0, s34, 33792
    s_nop 0
    buffer_load_dwordx4 v135, s[8:11], s38 offen lds
    v_mfma_f32_16x16x32_bf16 v[32:35], v[88:91], a[176:179], v[32:35]
    v_mfma_f32_16x16x32_bf16 v[36:39], v[92:95], a[176:179], v[36:39]
    s_add_u32 m0, s34, 40960
    s_add_u32 s38, s32, 640
    buffer_load_dwordx4 v134, s[8:11], s38 offen lds
    v_mfma_f32_16x16x32_bf16 v[40:43], v[88:91], a[180:183], v[40:43]
    v_mfma_f32_16x16x32_bf16 v[44:47], v[92:95], a[180:183], v[44:47]
    s_add_u32 m0, s34, 41984
    s_nop 0
    buffer_load_dwordx4 v135, s[8:11], s38 offen lds
    v_mfma_f32_16x16x32_bf16 v[48:51], v[88:91], a[184:187], v[48:51]
    v_mfma_f32_16x16x32_bf16 v[52:55], v[92:95], a[184:187], v[52:55]
    v_mfma_f32_16x16x32_bf16 v[56:59], v[88:91], a[188:191], v[56:59]
    v_mfma_f32_16x16x32_bf16 v[60:63], v[92:95], a[188:191], v[60:63]
    s_waitcnt lgkmcnt(0)
    v_mfma_f32_16x16x32_bf16 v[0:3], v[64:67], a[192:195], v[0:3]
    ds_read_b128 v[80:83], v129 offset:49152
    ds_read_b128 v[84:87], v129 offset:51200
    v_mfma_f32_16x16x32_bf16 v[4:7], v[68:71], a[192:195], v[4:7]
    ds_read_b128 v[88:91], v129 offset:53248
    v_mfma_f32_16x16x32_bf16 v[8:11], v[64:67], a[196:199], v[8:11]
    ds_read_b128 v[92:95], v129 offset:55296
    ds_read_b64_tr_b16 a[208:209], v130 offset:4096
    v_mfma_f32_16x16x32_bf16 v[12:15], v[68:71], a[196:199], v[12:15]
    ds_read_b64_tr_b16 a[210:211], v130 offset:4608
    v_mfma_f32_16x16x32_bf16 v[16:19], v[64:67], a[200:203], v[16:19]
    ds_read_b64_tr_b16 a[212:213], v131 offset:4096
    ds_read_b64_tr_b16 a[214:215], v131 offset:4608
    v_mfma_f32_16x16x32_bf16 v[20:23], v[68:71], a[200:203], v[20:23]
    ds_read_b64_tr_b16 a[216:217], v132 offset:4096
    v_mfma_f32_16x16x32_bf16 v[24:27], v[64:67], a[204:207], v[24:27]
    ds_read_b64_tr_b16 a[218:219], v132 offset:4608
    ds_read_b64_tr_b16 a[220:221], v133 offset:4096
    v_mfma_f32_16x16x32_bf16 v[28:31], v[68:71], a[204:207], v[28:31]
    ds_read_b64_tr_b16 a[222:223], v133 offset:4608
    v_mfma_f32_16x16x32_bf16 v[32:35], v[72:75], a[192:195], v[32:35]
    v_mfma_f32_16x16x32_bf16 v[36:39], v[76:79], a[192:195], v[36:39]
    v_mfma_f32_16x16x32_bf16 v[40:43], v[72:75], a[196:199], v[40:43]
    v_mfma_f32_16x16x32_bf16 v[44:47], v[76:79], a[196:199], v[44:47]
    v_mfma_f32_16x16x32_bf16 v[48:51], v[72:75], a[200:203], v[48:51]
    v_mfma_f32_16x16x32_bf16 v[52:55], v[76:79], a[200:203], v[52:55]
    v_mfma_f32_16x16x32_bf16 v[56:59], v[72:75], a[204:207], v[56:59]
    v_mfma_f32_16x16x32_bf16 v[60:63], v[76:79], a[204:207], v[60:63]
    s_waitcnt vmcnt(4) lgkmcnt(0)
    v_mfma_f32_16x16x32_bf16 v[0:3], v[80:83], a[208:211], v[0:3]
    ds_read_b128 v[64:67], v128 offset:57344
    ds_read_b128 v[68:71], v128 offset:59392
    v_mfma_f32_16x16x32_bf16 v[4:7], v[84:87], a[208:211], v[4:7]
    ds_read_b128 v[72:75], v128 offset:61440
    v_mfma_f32_16x16x32_bf16 v[8:11], v[80:83], a[212:215], v[8:11]
    ds_read_b128 v[76:79], v128 offset:63488
    ds_read_b64_tr_b16 a[224:225], v130 offset:8192
    v_mfma_f32_16x16x32_bf16 v[12:15], v[84:87], a[212:215], v[12:15]
    ds_read_b64_tr_b16 a[226:227], v130 offset:8704
    v_mfma_f32_16x16x32_bf16 v[16:19], v[80:83], a[216:219], v[16:19]
    ds_read_b64_tr_b16 a[228:229], v131 offset:8192
    ds_read_b64_tr_b16 a[230:231], v131 offset:8704
    v_mfma_f32_16x16x32_bf16 v[20:23], v[84:87], a[216:219], v[20:23]
    ds_read_b64_tr_b16 a[232:233], v132 offset:8192
    v_mfma_f32_16x16x32_bf16 v[24:27], v[80:83], a[220:223], v[24:27]
    ds_read_b64_tr_b16 a[234:235], v132 offset:8704
    ds_read_b64_tr_b16 a[236:237], v133 offset:8192
    v_mfma_f32_16x16x32_bf16 v[28:31], v[84:87], a[220:223], v[28:31]
    ds_read_b64_tr_b16 a[238:239], v133 offset:8704
    v_mfma_f32_16x16x32_bf16 v[32:35], v[88:91], a[208:211], v[32:35]
    v_mfma_f32_16x16x32_bf16 v[36:39], v[92:95], a[208:211], v[36:39]
    v_mfma_f32_16x16x32_bf16 v[40:43], v[88:91], a[212:215], v[40:43]
    v_mfma_f32_16x16x32_bf16 v[44:47], v[92:95], a[212:215], v[44:47]
    v_mfma_f32_16x16x32_bf16 v[48:51], v[88:91], a[216:219], v[48:51]
    v_mfma_f32_16x16x32_bf16 v[52:55], v[92:95], a[216:219], v[52:55]
    v_mfma_f32_16x16x32_bf16 v[56:59], v[88:91], a[220:223], v[56:59]
    v_mfma_f32_16x16x32_bf16 v[60:63], v[92:95], a[220:223], v[60:63]
    s_waitcnt lgkmcnt(0)
    v_mfma_f32_16x16x32_bf16 v[0:3], v[64:67], a[224:227], v[0:3]
    ds_read_b128 v[80:83], v129 offset:57344
    ds_read_b128 v[84:87], v129 offset:59392
    v_mfma_f32_16x16x32_bf16 v[4:7], v[68:71], a[224:227], v[4:7]
    ds_read_b128 v[88:91], v129 offset:61440
    v_mfma_f32_16x16x32_bf16 v[8:11], v[64:67], a[228:231], v[8:11]
    ds_read_b128 v[92:95], v129 offset:63488
    ds_read_b64_tr_b16 a[240:241], v130 offset:12288
    v_mfma_f32_16x16x32_bf16 v[12:15], v[68:71], a[228:231], v[12:15]
    ds_read_b64_tr_b16 a[242:243], v130 offset:12800
    v_mfma_f32_16x16x32_bf16 v[16:19], v[64:67], a[232:235], v[16:19]
    ds_read_b64_tr_b16 a[244:245], v131 offset:12288
    ds_read_b64_tr_b16 a[246:247], v131 offset:12800
    v_mfma_f32_16x16x32_bf16 v[20:23], v[68:71], a[232:235], v[20:23]
    ds_read_b64_tr_b16 a[248:249], v132 offset:12288
    v_mfma_f32_16x16x32_bf16 v[24:27], v[64:67], a[236:239], v[24:27]
    ds_read_b64_tr_b16 a[250:251], v132 offset:12800
    ds_read_b64_tr_b16 a[252:253], v133 offset:12288
    v_mfma_f32_16x16x32_bf16 v[28:31], v[68:71], a[236:239], v[28:31]
    ds_read_b64_tr_b16 a[254:255], v133 offset:12800
    v_mfma_f32_16x16x32_bf16 v[32:35], v[72:75], a[224:227], v[32:35]
    v_mfma_f32_16x16x32_bf16 v[36:39], v[76:79], a[224:227], v[36:39]
    v_mfma_f32_16x16x32_bf16 v[40:43], v[72:75], a[228:231], v[40:43]
    v_mfma_f32_16x16x32_bf16 v[44:47], v[76:79], a[228:231], v[44:47]
    v_mfma_f32_16x16x32_bf16 v[48:51], v[72:75], a[232:235], v[48:51]
    v_mfma_f32_16x16x32_bf16 v[52:55], v[76:79], a[232:235], v[52:55]
    v_mfma_f32_16x16x32_bf16 v[56:59], v[72:75], a[236:239], v[56:59]
    v_mfma_f32_16x16x32_bf16 v[60:63], v[76:79], a[236:239], v[60:63]
    s_waitcnt vmcnt(40) lgkmcnt(0)
    s_barrier
    v_mfma_f32_16x16x32_bf16 v[0:3], v[80:83], a[240:243], v[0:3]
    ds_read_b128 v[64:67], v128 offset:0
    v_mfma_f32_16x16x32_bf16 v[4:7], v[84:87], a[240:243], v[4:7]
    ds_read_b128 v[68:71], v128 offset:2048
    v_mfma_f32_16x16x32_bf16 v[8:11], v[80:83], a[244:247], v[8:11]
    ds_read_b128 v[72:75], v128 offset:4096
    v_mfma_f32_16x16x32_bf16 v[12:15], v[84:87], a[244:247], v[12:15]
    ds_read_b128 v[76:79], v128 offset:6144
    v_mfma_f32_16x16x32_bf16 v[16:19], v[80:83], a[248:251], v[16:19]
    v_mfma_f32_16x16x32_bf16 v[20:23], v[84:87], a[248:251], v[20:23]
    s_add_u32 m0, s34, 49152
    s_add_u32 s38, s32, 768
    buffer_load_dwordx4 v134, s[8:11], s38 offen lds
    v_mfma_f32_16x16x32_bf16 v[24:27], v[80:83], a[252:255], v[24:27]
    v_mfma_f32_16x16x32_bf16 v[28:31], v[84:87], a[252:255], v[28:31]
    s_add_u32 m0, s34, 50176
    s_nop 0
    buffer_load_dwordx4 v135, s[8:11], s38 offen lds
    v_mfma_f32_16x16x32_bf16 v[32:35], v[88:91], a[240:243], v[32:35]
    v_mfma_f32_16x16x32_bf16 v[36:39], v[92:95], a[240:243], v[36:39]
    s_add_u32 m0, s34, 57344
    s_add_u32 s38, s32, 896
    buffer_load_dwordx4 v134, s[8:11], s38 offen lds
    v_cvt_pk_bf16_f32 v96, v0, v1
    v_cvt_pk_bf16_f32 v97, v2, v3
    v_mfma_f32_16x16x32_bf16 v[40:43], v[88:91], a[244:247], v[40:43]
    v_cvt_pk_bf16_f32 v98, v4, v5
    v_cvt_pk_bf16_f32 v99, v6, v7
    v_mfma_f32_16x16x32_bf16 v[44:47], v[92:95], a[244:247], v[44:47]
    s_add_u32 m0, s34, 58368
    s_nop 0
    buffer_load_dwordx4 v135, s[8:11], s38 offen lds
    s_add_u32 s32, s32, 65536
    s_cmp_ge_u32 s32, s39
    s_cselect_b32 s32, 0x40000000, s32
    v_cvt_pk_bf16_f32 v100, v8, v9
    v_cvt_pk_bf16_f32 v101, v10, v11
    v_mfma_f32_16x16x32_bf16 v[48:51], v[88:91], a[248:251], v[48:51]
    v_cvt_pk_bf16_f32 v102, v12, v13
    v_cvt_pk_bf16_f32 v103, v14, v15
    v_mfma_f32_16x16x32_bf16 v[52:55], v[92:95], a[248:251], v[52:55]
    v_cvt_pk_bf16_f32 v104, v16, v17
    v_cvt_pk_bf16_f32 v105, v18, v19
    v_mfma_f32_16x16x32_bf16 v[56:59], v[88:91], a[252:255], v[56:59]
    v_cvt_pk_bf16_f32 v106, v20, v21
    v_cvt_pk_bf16_f32 v107, v22, v23
    v_mfma_f32_16x16x32_bf16 v[60:63], v[92:95], a[252:255], v[60:63]
    v_cvt_pk_bf16_f32 v108, v24, v25
    v_cvt_pk_bf16_f32 v109, v26, v27
    s_mov_b32 s37, 3
k1_V_loop:
    s_waitcnt lgkmcnt(0)
    v_mfma_f32_16x16x32_bf16 v[0:3], v[64:67], a[0:3], 0
    ds_read_b128 v[80:83], v129 offset:0
    v_cvt_pk_bf16_f32 v110, v28, v29
    v_cvt_pk_bf16_f32 v111, v30, v31
    v_mfma_f32_16x16x32_bf16 v[4:7], v[68:71], a[0:3], 0
    ds_read_b128 v[84:87], v129 offset:2048
    v_cvt_pk_bf16_f32 v112, v32, v33
    v_cvt_pk_bf16_f32 v113, v34, v35
    v_mfma_f32_16x16x32_bf16 v[8:11], v[64:67], a[4:7], 0
    ds_read_b128 v[88:91], v129 offset:4096
    v_cvt_pk_bf16_f32 v114, v36, v37
    v_cvt_pk_bf16_f32 v115, v38, v39
    v_mfma_f32_16x16x32_bf16 v[12:15], v[68:71], a[4:7], 0
    ds_read_b128 v[92:95], v129 offset:6144
    v_cvt_pk_bf16_f32 v116, v40, v41
    v_cvt_pk_bf16_f32 v117, v42, v43
    v_mfma_f32_16x16x32_bf16 v[16:19], v[64:67], a[8:11], 0
    v_cvt_pk_bf16_f32 v118, v44, v45
    v_cvt_pk_bf16_f32 v119, v46, v47
    v_mfma_f32_16x16x32_bf16 v[20:23], v[68:71], a[8:11], 0
    v_cvt_pk_bf16_f32 v120, v48, v49
    v_cvt_pk_bf16_f32 v121, v50, v51
    v_mfma_f32_16x16x32_bf16 v[24:27], v[64:67], a[12:15], 0
    v_cvt_pk_bf16_f32 v122, v52, v53
    v_cvt_pk_bf16_f32 v123, v54, v55
    v_mfma_f32_16x16x32_bf16 v[28:31], v[68:71], a[12:15], 0
    v_cvt_pk_bf16_f32 v124, v56, v57
    v_cvt_pk_bf16_f32 v125, v58, v59
    v_mfma_f32_16x16x32_bf16 v[32:35], v[72:75], a[0:3], 0
    v_cvt_pk_bf16_f32 v126, v60, v61
    v_cvt_pk_bf16_f32 v127, v62, v63
    s_add_u32 s56, s36, 0
    buffer_store_dwordx4 v[96:99], v138, s[16:19], s56 offen offset:0
    v_mfma_f32_16x16x32_bf16 v[36:39], v[76:79], a[0:3], 0
    v_mfma_f32_16x16x32_bf16 v[40:43], v[72:75], a[4:7], 0
    s_add_u32 s56, s36, 0
    buffer_store_dwordx4 v[100:103], v138, s[16:19], s56 offen offset:128
    v_mfma_f32_16x16x32_bf16 v[44:47], v[76:79], a[4:7], 0
    v_mfma_f32_16x16x32_bf16 v[48:51], v[72:75], a[8:11], 0
    s_add_u32 s56, s36, 0
    buffer_store_dwordx4 v[104:107], v138, s[16:19], s56 offen offset:1024
    v_mfma_f32_16x16x32_bf16 v[52:55], v[76:79], a[8:11], 0
    v_mfma_f32_16x16x32_bf16 v[56:59], v[72:75], a[12:15], 0
    s_add_u32 s56, s36, 0
    buffer_store_dwordx4 v[108:111], v138, s[16:19], s56 offen offset:1152
    v_mfma_f32_16x16x32_bf16 v[60:63], v[76:79], a[12:15], 0
    s_waitcnt lgkmcnt(0)
    v_mfma_f32_16x16x32_bf16 v[0:3], v[80:83], a[16:19], v[0:3]
    ds_read_b128 v[64:67], v128 offset:8192
    s_add_u32 s56, s36, 8192
    buffer_store_dwordx4 v[112:115], v138, s[16:19], s56 offen offset:0
    v_mfma_f32_16x16x32_bf16 v[4:7], v[84:87], a[16:19], v[4:7]
    ds_read_b128 v[68:71], v128 offset:10240
    v_mfma_f32_16x16x32_bf16 v[8:11], v[80:83], a[20:23], v[8:11]
    ds_read_b128 v[72:75], v128 offset:12288
    s_add_u32 s56, s36, 8192
    buffer_store_dwordx4 v[116:119], v138, s[16:19], s56 offen offset:128
    v_mfma_f32_16x16x32_bf16 v[12:15], v[84:87], a[20:23], v[12:15]
    ds_read_b128 v[76:79], v128 offset:14336
    v_mfma_f32_16x16x32_bf16 v[16:19], v[80:83], a[24:27], v[16:19]
    s_add_u32 s56, s36, 8192
    buffer_store_dwordx4 v[120:123], v138, s[16:19], s56 offen offset:1024
    v_mfma_f32_16x16x32_bf16 v[20:23], v[84:87], a[24:27], v[20:23]
    v_mfma_f32_16x16x32_bf16 v[24:27], v[80:83], a[28:31], v[24:27]
    s_add_u32 s56, s36, 8192
    buffer_store_dwordx4 v[124:127], v138, s[16:19], s56 offen offset:1152
    v_mfma_f32_16x16x32_bf16 v[28:31], v[84:87], a[28:31], v[28:31]
    v_mfma_f32_16x16x32_bf16 v[32:35], v[88:91], a[16:19], v[32:35]
    v_mfma_f32_16x16x32_bf16 v[36:39], v[92:95], a[16:19], v[36:39]
    v_mfma_f32_16x16x32_bf16 v[40:43], v[88:91], a[20:23], v[40:43]
    v_mfma_f32_16x16x32_bf16 v[44:47], v[92:95], a[20:23], v[44:47]
    v_mfma_f32_16x16x32_bf16 v[48:51], v[88:91], a[24:27], v[48:51]
    v_mfma_f32_16x16x32_bf16 v[52:55], v[92:95], a[24:27], v[52:55]
    v_mfma_f32_16x16x32_bf16 v[56:59], v[88:91], a[28:31], v[56:59]
    v_mfma_f32_16x16x32_bf16 v[60:63], v[92:95], a[28:31], v[60:63]
    s_add_u32 s36, s36, 32768
    s_waitcnt lgkmcnt(0)
    v_mfma_f32_16x16x32_bf16 v[0:3], v[64:67], a[32:35], v[0:3]
    ds_read_b128 v[80:83], v129 offset:8192
    v_mfma_f32_16x16x32_bf16 v[4:7], v[68:71], a[32:35], v[4:7]
    ds_read_b128 v[84:87], v129 offset:10240
    v_mfma_f32_16x16x32_bf16 v[8:11], v[64:67], a[36:39], v[8:11]
    ds_read_b128 v[88:91], v129 offset:12288
    v_mfma_f32_16x16x32_bf16 v[12:15], v[68:71], a[36:39], v[12:15]
    ds_read_b128 v[92:95], v129 offset:14336
    v_mfma_f32_16x16x32_bf16 v[16:19], v[64:67], a[40:43], v[16:19]
    v_mfma_f32_16x16x32_bf16 v[20:23], v[68:71], a[40:43], v[20:23]
    v_mfma_f32_16x16x32_bf16 v[24:27], v[64:67], a[44:47], v[24:27]
    v_mfma_f32_16x16x32_bf16 v[28:31], v[68:71], a[44:47], v[28:31]
    v_mfma_f32_16x16x32_bf16 v[32:35], v[72:75], a[32:35], v[32:35]
    v_mfma_f32_16x16x32_bf16 v[36:39], v[76:79], a[32:35], v[36:39]
    v_mfma_f32_16x16x32_bf16 v[40:43], v[72:75], a[36:39], v[40:43]
    v_mfma_f32_16x16x32_bf16 v[44:47], v[76:79], a[36:39], v[44:47]
    v_mfma_f32_16x16x32_bf16 v[48:51], v[72:75], a[40:43], v[48:51]
    v_mfma_f32_16x16x32_bf16 v[52:55], v[76:79], a[40:43], v[52:55]
    v_mfma_f32_16x16x32_bf16 v[56:59], v[72:75], a[44:47], v[56:59]
    v_mfma_f32_16x16x32_bf16 v[60:63], v[76:79], a[44:47], v[60:63]
    s_waitcnt vmcnt(16) lgkmcnt(0)
    s_barrier
    v_mfma_f32_16x16x32_bf16 v[0:3], v[80:83], a[48:51], v[0:3]
    ds_read_b128 v[64:67], v128 offset:16384
    v_mfma_f32_16x16x32_bf16 v[4:7], v[84:87], a[48:51], v[4:7]
    ds_read_b128 v[68:71], v128 offset:18432
    v_mfma_f32_16x16x32_bf16 v[8:11], v[80:83], a[52:55], v[8:11]
    ds_read_b128 v[72:75], v128 offset:20480
    v_mfma_f32_16x16x32_bf16 v[12:15], v[84:87], a[52:55], v[12:15]
    ds_read_b128 v[76:79], v128 offset:22528
    v_mfma_f32_16x16x32_bf16 v[16:19], v[80:83], a[56:59], v[16:19]
    v_mfma_f32_16x16x32_bf16 v[20:23], v[84:87], a[56:59], v[20:23]
    s_add_u32 m0, s34, 0
    s_add_u32 s38, s32, 0
    buffer_load_dwordx4 v134, s[8:11], s38 offen lds
    v_mfma_f32_16x16x32_bf16 v[24:27], v[80:83], a[60:63], v[24:27]
    v_mfma_f32_16x16x32_bf16 v[28:31], v[84:87], a[60:63], v[28:31]
    s_add_u32 m0, s34, 1024
    s_nop 0
    buffer_load_dwordx4 v135, s[8:11], s38 offen lds
    v_mfma_f32_16x16x32_bf16 v[32:35], v[88:91], a[48:51], v[32:35]
    v_mfma_f32_16x16x32_bf16 v[36:39], v[92:95], a[48:51], v[36:39]
    s_add_u32 m0, s34, 8192
    s_add_u32 s38, s32, 128
    buffer_load_dwordx4 v134, s[8:11], s38 offen lds
    v_mfma_f32_16x16x32_bf16 v[40:43], v[88:91], a[52:55], v[40:43]
    v_mfma_f32_16x16x32_bf16 v[44:47], v[92:95], a[52:55], v[44:47]
    s_add_u32 m0, s34, 9216
    s_nop 0
    buffer_load_dwordx4 v135, s[8:11], s38 offen lds
    v_mfma_f32_16x16x32_bf16 v[48:51], v[88:91], a[56:59], v[48:51]
    v_mfma_f32_16x16x32_bf16 v[52:55], v[92:95], a[56:59], v[52:55]
    v_mfma_f32_16x16x32_bf16 v[56:59], v[88:91], a[60:63], v[56:59]
    v_mfma_f32_16x16x32_bf16 v[60:63], v[92:95], a[60:63], v[60:63]
    s_waitcnt lgkmcnt(0)
    v_mfma_f32_16x16x32_bf16 v[0:3], v[64:67], a[64:67], v[0:3]
    ds_read_b128 v[80:83], v129 offset:16384
    v_mfma_f32_16x16x32_bf16 v[4:7], v[68:71], a[64:67], v[4:7]
    ds_read_b128 v[84:87], v129 offset:18432
    v_mfma_f32_16x16x32_bf16 v[8:11], v[64:67], a[68:71], v[8:11]
    ds_read_b128 v[88:91], v129 offset:20480
    v_mfma_f32_16x16x32_bf16 v[12:15], v[68:71], a[68:71], v[12:15]
    ds_read_b128 v[92:95], v129 offset:22528
    v_mfma_f32_16x16x32_bf16 v[16:19], v[64:67], a[72:75], v[16:19]
    v_mfma_f32_16x16x32_bf16 v[20:23], v[68:71], a[72:75], v[20:23]
    v_mfma_f32_16x16x32_bf16 v[24:27], v[64:67], a[76:79], v[24:27]
    v_mfma_f32_16x16x32_bf16 v[28:31], v[68:71], a[76:79], v[28:31]
    v_mfma_f32_16x16x32_bf16 v[32:35], v[72:75], a[64:67], v[32:35]
    v_mfma_f32_16x16x32_bf16 v[36:39], v[76:79], a[64:67], v[36:39]
    v_mfma_f32_16x16x32_bf16 v[40:43], v[72:75], a[68:71], v[40:43]
    v_mfma_f32_16x16x32_bf16 v[44:47], v[76:79], a[68:71], v[44:47]
    v_mfma_f32_16x16x32_bf16 v[48:51], v[72:75], a[72:75], v[48:51]
    v_mfma_f32_16x16x32_bf16 v[52:55], v[76:79], a[72:75], v[52:55]
    v_mfma_f32_16x16x32_bf16 v[56:59], v[72:75], a[76:79], v[56:59]
    v_mfma_f32_16x16x32_bf16 v[60:63], v[76:79], a[76:79], v[60:63]
    s_waitcnt lgkmcnt(0)
    v_mfma_f32_16x16x32_bf16 v[0:3], v[80:83], a[80:83], v[0:3]
    ds_read_b128 v[64:67], v128 offset:24576
    v_mfma_f32_16x16x32_bf16 v[4:7], v[84:87], a[80:83], v[4:7]
    ds_read_b128 v[68:71], v128 offset:26624
    v_mfma_f32_16x16x32_bf16 v[8:11], v[80:83], a[84:87], v[8:11]
    ds_read_b128 v[72:75], v128 offset:28672
    v_mfma_f32_16x16x32_bf16 v[12:15], v[84:87], a[84:87], v[12:15]
    ds_read_b128 v[76:79], v128 offset:30720
    v_mfma_f32_16x16x32_bf16 v[16:19], v[80:83], a[88:91], v[16:19]
    v_mfma_f32_16x16x32_bf16 v[20:23], v[84:87], a[88:91], v[20:23]
    v_mfma_f32_16x16x32_bf16 v[24:27], v[80:83], a[92:95], v[24:27]
    v_mfma_f32_16x16x32_bf16 v[28:31], v[84:87], a[92:95], v[28:31]
    v_mfma_f32_16x16x32_bf16 v[32:35], v[88:91], a[80:83], v[32:35]
    v_mfma_f32_16x16x32_bf16 v[36:39], v[92:95], a[80:83], v[36:39]
    v_mfma_f32_16x16x32_bf16 v[40:43], v[88:91], a[84:87], v[40:43]
    v_mfma_f32_16x16x32_bf16 v[44:47], v[92:95], a[84:87], v[44:47]
    v_mfma_f32_16x16x32_bf16 v[48:51], v[88:91], a[88:91], v[48:51]
    v_mfma_f32_16x16x32_bf16 v[52:55], v[92:95], a[88:91], v[52:55]
    v_mfma_f32_16x16x32_bf16 v[56:59], v[88:91], a[92:95], v[56:59]
    v_mfma_f32_16x16x32_bf16 v[60:63], v[92:95], a[92:95], v[60:63]
    s_waitcnt lgkmcnt(0)
    v_mfma_f32_16x16x32_bf16 v[0:3], v[64:67], a[96:99], v[0:3]
    ds_read_b128 v[80:83], v129 offset:24576
    v_mfma_f32_16x16x32_bf16 v[4:7], v[68:71], a[96:99], v[4:7]
    ds_read_b128 v[84:87], v129 offset:26624
    v_mfma_f32_16x16x32_bf16 v[8:11], v[64:67], a[100:103], v[8:11]
    ds_read_b128 v[88:91], v129 offset:28672
    v_mfma_f32_16x16x32_bf16 v[12:15], v[68:71], a[100:103], v[12:15]
    ds_read_b128 v[92:95], v129 offset:30720
    v_mfma_f32_16x16x32_bf16 v[16:19], v[64:67], a[104:107], v[16:19]
    v_mfma_f32_16x16x32_bf16 v[20:23], v[68:71], a[104:107], v[20:23]
    v_mfma_f32_16x16x32_bf16 v[24:27], v[64:67], a[108:111], v[24:27]
    v_mfma_f32_16x16x32_bf16 v[28:31], v[68:71], a[108:111], v[28:31]
    v_mfma_f32_16x16x32_bf16 v[32:35], v[72:75], a[96:99], v[32:35]
    v_mfma_f32_16x16x32_bf16 v[36:39], v[76:79], a[96:99], v[36:39]
    v_mfma_f32_16x16x32_bf16 v[40:43], v[72:75], a[100:103], v[40:43]
    v_mfma_f32_16x16x32_bf16 v[44:47], v[76:79], a[100:103], v[44:47]
    v_mfma_f32_16x16x32_bf16 v[48:51], v[72:75], a[104:107], v[48:51]
    v_mfma_f32_16x16x32_bf16 v[52:55], v[76:79], a[104:107], v[52:55]
    v_mfma_f32_16x16x32_bf16 v[56:59], v[72:75], a[108:111], v[56:59]
    v_mfma_f32_16x16x32_bf16 v[60:63], v[76:79], a[108:111], v[60:63]
    s_waitcnt vmcnt(16) lgkmcnt(0)
    s_barrier
    v_mfma_f32_16x16x32_bf16 v[0:3], v[80:83], a[112:115], v[0:3]
    ds_read_b128 v[64:67], v128 offset:32768
    v_mfma_f32_16x16x32_bf16 v[4:7], v[84:87], a[112:115], v[4:7]
    ds_read_b128 v[68:71], v128 offset:34816
    v_mfma_f32_16x16x32_bf16 v[8:11], v[80:83], a[116:119], v[8:11]
    ds_read_b128 v[72:75], v128 offset:36864
    v_mfma_f32_16x16x32_bf16 v[12:15], v[84:87], a[116:119], v[12:15]
    ds_read_b128 v[76:79], v128 offset:38912
    v_mfma_f32_16x16x32_bf16 v[16:19], v[80:83], a[120:123], v[16:19]
    v_mfma_f32_16x16x32_bf16 v[20:23], v[84:87], a[120:123], v[20:23]
    s_add_u32 m0, s34, 16384
    s_add_u32 s38, s32, 256
    buffer_load_dwordx4 v134, s[8:11], s38 offen lds
    v_mfma_f32_16x16x32_bf16 v[24:27], v[80:83], a[124:127], v[24:27]
    v_mfma_f32_16x16x32_bf16 v[28:31], v[84:87], a[124:127], v[28:31]
    s_add_u32 m0, s34, 17408
    s_nop 0
    buffer_load_dwordx4 v135, s[8:11], s38 offen lds
    v_mfma_f32_16x16x32_bf16 v[32:35], v[88:91], a[112:115], v[32:35]
    v_mfma_f32_16x16x32_bf16 v[36:39], v[92:95], a[112:115], v[36:39]
    s_add_u32 m0, s34, 24576
    s_add_u32 s38, s32, 384
    buffer_load_dwordx4 v134, s[8:11], s38 offen lds
    v_mfma_f32_16x16x32_bf16 v[40:43], v[88:91], a[116:119], v[40:43]
    v_mfma_f32_16x16x32_bf16 v[44:47], v[92:95], a[116:119], v[44:47]
    s_add_u32 m0, s34, 25600
    s_nop 0
    buffer_load_dwordx4 v135, s[8:11], s38 offen lds
    v_mfma_f32_16x16x32_bf16 v[48:51], v[88:91], a[120:123], v[48:51]
    v_mfma_f32_16x16x32_bf16 v[52:55], v[92:95], a[120:123], v[52:55]
    v_mfma_f32_16x16x32_bf16 v[56:59], v[88:91], a[124:127], v[56:59]
    v_mfma_f32_16x16x32_bf16 v[60:63], v[92:95], a[124:127], v[60:63]
    s_waitcnt lgkmcnt(0)
    v_mfma_f32_16x16x32_bf16 v[0:3], v[64:67], a[128:131], v[0:3]
    ds_read_b128 v[80:83], v129 offset:32768
    v_mfma_f32_16x16x32_bf16 v[4:7], v[68:71], a[128:131], v[4:7]
    ds_read_b128 v[84:87], v129 offset:34816
    v_mfma_f32_16x16x32_bf16 v[8:11], v[64:67], a[132:135], v[8:11]
    ds_read_b128 v[88:91], v129 offset:36864
    v_mfma_f32_16x16x32_bf16 v[12:15], v[68:71], a[132:135], v[12:15]
    ds_read_b128 v[92:95], v129 offset:38912
    v_mfma_f32_16x16x32_bf16 v[16:19], v[64:67], a[136:139], v[16:19]
    v_mfma_f32_16x16x32_bf16 v[20:23], v[68:71], a[136:139], v[20:23]
    v_mfma_f32_16x16x32_bf16 v[24:27], v[64:67], a[140:143], v[24:27]
    v_mfma_f32_16x16x32_bf16 v[28:31], v[68:71], a[140:143], v[28:31]
    v_mfma_f32_16x16x32_bf16 v[32:35], v[72:75], a[128:131], v[32:35]
    v_mfma_f32_16x16x32_bf16 v[36:39], v[76:79], a[128:131], v[36:39]
    v_mfma_f32_16x16x32_bf16 v[40:43], v[72:75], a[132:135], v[40:43]
    v_mfma_f32_16x16x32_bf16 v[44:47], v[76:79], a[132:135], v[44:47]
    v_mfma_f32_16x16x32_bf16 v[48:51], v[72:75], a[136:139], v[48:51]
    v_mfma_f32_16x16x32_bf16 v[52:55], v[76:79], a[136:139], v[52:55]
    v_mfma_f32_16x16x32_bf16 v[56:59], v[72:75], a[140:143], v[56:59]
    v_mfma_f32_16x16x32_bf16 v[60:63], v[76:79], a[140:143], v[60:63]
    s_waitcnt lgkmcnt(0)
    v_mfma_f32_16x16x32_bf16 v[0:3], v[80:83], a[144:147], v[0:3]
    ds_read_b128 v[64:67], v128 offset:40960
    v_mfma_f32_16x16x32_bf16 v[4:7], v[84:87], a[144:147], v[4:7]
    ds_read_b128 v[68:71], v128 offset:43008
    v_mfma_f32_16x16x32_bf16 v[8:11], v[80:83], a[148:151], v[8:11]
    ds_read_b128 v[72:75], v128 offset:45056
    v_mfma_f32_16x16x32_bf16 v[12:15], v[84:87], a[148:151], v[12:15]
    ds_read_b128 v[76:79], v128 offset:47104
    v_mfma_f32_16x16x32_bf16 v[16:19], v[80:83], a[152:155], v[16:19]
    v_mfma_f32_16x16x32_bf16 v[20:23], v[84:87], a[152:155], v[20:23]
    v_mfma_f32_16x16x32_bf16 v[24:27], v[80:83], a[156:159], v[24:27]
    v_mfma_f32_16x16x32_bf16 v[28:31], v[84:87], a[156:159], v[28:31]
    v_mfma_f32_16x16x32_bf16 v[32:35], v[88:91], a[144:147], v[32:35]
    v_mfma_f32_16x16x32_bf16 v[36:39], v[92:95], a[144:147], v[36:39]
    v_mfma_f32_16x16x32_bf16 v[40:43], v[88:91], a[148:151], v[40:43]
    v_mfma_f32_16x16x32_bf16 v[44:47], v[92:95], a[148:151], v[44:47]
    v_mfma_f32_16x16x32_bf16 v[48:51], v[88:91], a[152:155], v[48:51]
    v_mfma_f32_16x16x32_bf16 v[52:55], v[92:95], a[152:155], v[52:55]
    v_mfma_f32_16x16x32_bf16 v[56:59], v[88:91], a[156:159], v[56:59]
    v_mfma_f32_16x16x32_bf16 v[60:63], v[92:95], a[156:159], v[60:63]
    s_waitcnt lgkmcnt(0)
    v_mfma_f32_16x16x32_bf16 v[0:3], v[64:67], a[160:163], v[0:3]
    ds_read_b128 v[80:83], v129 offset:40960
    v_mfma_f32_16x16x32_bf16 v[4:7], v[68:71], a[160:163], v[4:7]
    ds_read_b128 v[84:87], v129 offset:43008
    v_mfma_f32_16x16x32_bf16 v[8:11], v[64:67], a[164:167], v[8:11]
    ds_read_b128 v[88:91], v129 offset:45056
    v_mfma_f32_16x16x32_bf16 v[12:15], v[68:71], a[164:167], v[12:15]
    ds_read_b128 v[92:95], v129 offset:47104
    v_mfma_f32_16x16x32_bf16 v[16:19], v[64:67], a[168:171], v[16:19]
    v_mfma_f32_16x16x32_bf16 v[20:23], v[68:71], a[168:171], v[20:23]
    v_mfma_f32_16x16x32_bf16 v[24:27], v[64:67], a[172:175], v[24:27]
    v_mfma_f32_16x16x32_bf16 v[28:31], v[68:71], a[172:175], v[28:31]
    v_mfma_f32_16x16x32_bf16 v[32:35], v[72:75], a[160:163], v[32:35]
    v_mfma_f32_16x16x32_bf16 v[36:39], v[76:79], a[160:163], v[36:39]
    v_mfma_f32_16x16x32_bf16 v[40:43], v[72:75], a[164:167], v[40:43]
    v_mfma_f32_16x16x32_bf16 v[44:47], v[76:79], a[164:167], v[44:47]
    v_mfma_f32_16x16x32_bf16 v[48:51], v[72:75], a[168:171], v[48:51]
    v_mfma_f32_16x16x32_bf16 v[52:55], v[76:79], a[168:171], v[52:55]
    v_mfma_f32_16x16x32_bf16 v[56:59], v[72:75], a[172:175], v[56:59]
    v_mfma_f32_16x16x32_bf16 v[60:63], v[76:79], a[172:175], v[60:63]
    s_waitcnt vmcnt(16) lgkmcnt(0)
    s_barrier
    v_mfma_f32_16x16x32_bf16 v[0:3], v[80:83], a[176:179], v[0:3]
    ds_read_b128 v[64:67], v128 offset:49152
    v_mfma_f32_16x16x32_bf16 v[4:7], v[84:87], a[176:179], v[4:7]
    ds_read_b128 v[68:71], v128 offset:51200
    v_mfma_f32_16x16x32_bf16 v[8:11], v[80:83], a[180:183], v[8:11]
    ds_read_b128 v[72:75], v128 offset:53248
    v_mfma_f32_16x16x32_bf16 v[12:15], v[84:87], a[180:183], v[12:15]
    ds_read_b128 v[76:79], v128 offset:55296
    v_mfma_f32_16x16x32_bf16 v[16:19], v[80:83], a[184:187], v[16:19]
    v_mfma_f32_16x16x32_bf16 v[20:23], v[84:87], a[184:187], v[20:23]
    s_add_u32 m0, s34, 32768
    s_add_u32 s38, s32, 512
    buffer_load_dwordx4 v134, s[8:11], s38 offen lds
    v_mfma_f32_16x16x32_bf16 v[24:27], v[80:83], a[188:191], v[24:27]
    v_mfma_f32_16x16x32_bf16 v[28:31], v[84:87], a[188:191], v[28:31]
    s_add_u32 m0, s34, 33792
    s_nop 0
    buffer_load_dwordx4 v135, s[8:11], s38 offen lds
    v_mfma_f32_16x16x32_bf16 v[32:35], v[88:91], a[176:179], v[32:35]
    v_mfma_f32_16x16x32_bf16 v[36:39], v[92:95], a[176:179], v[36:39]
    s_add_u32 m0, s34, 40960
    s_add_u32 s38, s32, 640
    buffer_load_dwordx4 v134, s[8:11], s38 offen lds
    v_mfma_f32_16x16x32_bf16 v[40:43], v[88:91], a[180:183], v[40:43]
    v_mfma_f32_16x16x32_bf16 v[44:47], v[92:95], a[180:183], v[44:47]
    s_add_u32 m0, s34, 41984
    s_nop 0
    buffer_load_dwordx4 v135, s[8:11], s38 offen lds
    v_mfma_f32_16x16x32_bf16 v[48:51], v[88:91], a[184:187], v[48:51]
    v_mfma_f32_16x16x32_bf16 v[52:55], v[92:95], a[184:187], v[52:55]
    v_mfma_f32_16x16x32_bf16 v[56:59], v[88:91], a[188:191], v[56:59]
    v_mfma_f32_16x16x32_bf16 v[60:63], v[92:95], a[188:191], v[60:63]
    s_waitcnt lgkmcnt(0)
    v_mfma_f32_16x16x32_bf16 v[0:3], v[64:67], a[192:195], v[0:3]
    ds_read_b128 v[80:83], v129 offset:49152
    v_mfma_f32_16x16x32_bf16 v[4:7], v[68:71], a[192:195], v[4:7]
    ds_read_b128 v[84:87], v129 offset:51200
    v_mfma_f32_16x16x32_bf16 v[8:11], v[64:67], a[196:199], v[8:11]
    ds_read_b128 v[88:91], v129 offset:53248
    v_mfma_f32_16x16x32_bf16 v[12:15], v[68:71], a[196:199], v[12:15]
    ds_read_b128 v[92:95], v129 offset:55296
    v_mfma_f32_16x16x32_bf16 v[16:19], v[64:67], a[200:203], v[16:19]
    v_mfma_f32_16x16x32_bf16 v[20:23], v[68:71], a[200:203], v[20:23]
    v_mfma_f32_16x16x32_bf16 v[24:27], v[64:67], a[204:207], v[24:27]
    v_mfma_f32_16x16x32_bf16 v[28:31], v[68:71], a[204:207], v[28:31]
    v_mfma_f32_16x16x32_bf16 v[32:35], v[72:75], a[192:195], v[32:35]
    v_mfma_f32_16x16x32_bf16 v[36:39], v[76:79], a[192:195], v[36:39]
    v_mfma_f32_16x16x32_bf16 v[40:43], v[72:75], a[196:199], v[40:43]
    v_mfma_f32_16x16x32_bf16 v[44:47], v[76:79], a[196:199], v[44:47]
    v_mfma_f32_16x16x32_bf16 v[48:51], v[72:75], a[200:203], v[48:51]
    v_mfma_f32_16x16x32_bf16 v[52:55], v[76:79], a[200:203], v[52:55]
    v_mfma_f32_16x16x32_bf16 v[56:59], v[72:75], a[204:207], v[56:59]
    v_mfma_f32_16x16x32_bf16 v[60:63], v[76:79], a[204:207], v[60:63]
    s_waitcnt lgkmcnt(0)
    v_mfma_f32_16x16x32_bf16 v[0:3], v[80:83], a[208:211], v[0:3]
    ds_read_b128 v[64:67], v128 offset:57344
    v_mfma_f32_16x16x32_bf16 v[4:7], v[84:87], a[208:211], v[4:7]
    ds_read_b128 v[68:71], v128 offset:59392
    v_mfma_f32_16x16x32_bf16 v[8:11], v[80:83], a[212:215], v[8:11]
    ds_read_b128 v[72:75], v128 offset:61440
    v_mfma_f32_16x16x32_bf16 v[12:15], v[84:87], a[212:215], v[12:15]
    ds_read_b128 v[76:79], v128 offset:63488
    v_mfma_f32_16x16x32_bf16 v[16:19], v[80:83], a[216:219], v[16:19]
    v_mfma_f32_16x16x32_bf16 v[20:23], v[84:87], a[216:219], v[20:23]
    v_mfma_f32_16x16x32_bf16 v[24:27], v[80:83], a[220:223], v[24:27]
    v_mfma_f32_16x16x32_bf16 v[28:31], v[84:87], a[220:223], v[28:31]
    v_mfma_f32_16x16x32_bf16 v[32:35], v[88:91], a[208:211], v[32:35]
    v_mfma_f32_16x16x32_bf16 v[36:39], v[92:95], a[208:211], v[36:39]
    v_mfma_f32_16x16x32_bf16 v[40:43], v[88:91], a[212:215], v[40:43]
    v_mfma_f32_16x16x32_bf16 v[44:47], v[92:95], a[212:215], v[44:47]
    v_mfma_f32_16x16x32_bf16 v[48:51], v[88:91], a[216:219], v[48:51]
    v_mfma_f32_16x16x32_bf16 v[52:55], v[92:95], a[216:219], v[52:55]
    v_mfma_f32_16x16x32_bf16 v[56:59], v[88:91], a[220:223], v[56:59]
    v_mfma_f32_16x16x32_bf16 v[60:63], v[92:95], a[220:223], v[60:63]
    s_waitcnt lgkmcnt(0)
    v_mfma_f32_16x16x32_bf16 v[0:3], v[64:67], a[224:227], v[0:3]
    ds_read_b128 v[80:83], v129 offset:57344
    v_mfma_f32_16x16x32_bf16 v[4:7], v[68:71], a[224:227], v[4:7]
    ds_read_b128 v[84:87], v129 offset:59392
    v_mfma_f32_16x16x32_bf16 v[8:11], v[64:67], a[228:231], v[8:11]
    ds_read_b128 v[88:91], v129 offset:61440
    v_mfma_f32_16x16x32_bf16 v[12:15], v[68:71], a[228:231], v[12:15]
    ds_read_b128 v[92:95], v129 offset:63488
    v_mfma_f32_16x16x32_bf16 v[16:19], v[64:67], a[232:235], v[16:19]
    v_mfma_f32_16x16x32_bf16 v[20:23], v[68:71], a[232:235], v[20:23]
    v_mfma_f32_16x16x32_bf16 v[24:27], v[64:67], a[236:239], v[24:27]
    v_mfma_f32_16x16x32_bf16 v[28:31], v[68:71], a[236:239], v[28:31]
    v_mfma_f32_16x16x32_bf16 v[32:35], v[72:75], a[224:227], v[32:35]
    v_mfma_f32_16x16x32_bf16 v[36:39], v[76:79], a[224:227], v[36:39]
    v_mfma_f32_16x16x32_bf16 v[40:43], v[72:75], a[228:231], v[40:43]
    v_mfma_f32_16x16x32_bf16 v[44:47], v[76:79], a[228:231], v[44:47]
    v_mfma_f32_16x16x32_bf16 v[48:51], v[72:75], a[232:235], v[48:51]
    v_mfma_f32_16x16x32_bf16 v[52:55], v[76:79], a[232:235], v[52:55]
    v_mfma_f32_16x16x32_bf16 v[56:59], v[72:75], a[236:239], v[56:59]
    v_mfma_f32_16x16x32_bf16 v[60:63], v[76:79], a[236:239], v[60:63]
    s_waitcnt vmcnt(8) lgkmcnt(0)
    s_barrier
    v_mfma_f32_16x16x32_bf16 v[0:3], v[80:83], a[240:243], v[0:3]
    ds_read_b128 v[64:67], v128 offset:0
    v_mfma_f32_16x16x32_bf16 v[4:7], v[84:87], a[240:243], v[4:7]
    ds_read_b128 v[68:71], v128 offset:2048
    v_mfma_f32_16x16x32_bf16 v[8:11], v[80:83], a[244:247], v[8:11]
    ds_read_b128 v[72:75], v128 offset:4096
    v_mfma_f32_16x16x32_bf16 v[12:15], v[84:87], a[244:247], v[12:15]
    ds_read_b128 v[76:79], v128 offset:6144
    v_mfma_f32_16x16x32_bf16 v[16:19], v[80:83], a[248:251], v[16:19]
    v_mfma_f32_16x16x32_bf16 v[20:23], v[84:87], a[248:251], v[20:23]
    s_add_u32 m0, s34, 49152
    s_add_u32 s38, s32, 768
    buffer_load_dwordx4 v134, s[8:11], s38 offen lds
    v_mfma_f32_16x16x32_bf16 v[24:27], v[80:83], a[252:255], v[24:27]
    v_mfma_f32_16x16x32_bf16 v[28:31], v[84:87], a[252:255], v[28:31]
    s_add_u32 m0, s34, 50176
    s_nop 0
    buffer_load_dwordx4 v135, s[8:11], s38 offen lds
    v_mfma_f32_16x16x32_bf16 v[32:35], v[88:91], a[240:243], v[32:35]
    v_mfma_f32_16x16x32_bf16 v[36:39], v[92:95], a[240:243], v[36:39]
    s_add_u32 m0, s34, 57344
    s_add_u32 s38, s32, 896
    buffer_load_dwordx4 v134, s[8:11], s38 offen lds
    v_cvt_pk_bf16_f32 v96, v0, v1
    v_cvt_pk_bf16_f32 v97, v2, v3
    v_mfma_f32_16x16x32_bf16 v[40:43], v[88:91], a[244:247], v[40:43]
    v_cvt_pk_bf16_f32 v98, v4, v5
    v_cvt_pk_bf16_f32 v99, v6, v7
    v_mfma_f32_16x16x32_bf16 v[44:47], v[92:95], a[244:247], v[44:47]
    s_add_u32 m0, s34, 58368
    s_nop 0
    buffer_load_dwordx4 v135, s[8:11], s38 offen lds
    s_add_u32 s32, s32, 65536
    s_cmp_ge_u32 s32, s39
    s_cselect_b32 s32, 0x40000000, s32
    v_cvt_pk_bf16_f32 v100, v8, v9
    v_cvt_pk_bf16_f32 v101, v10, v11
    v_mfma_f32_16x16x32_bf16 v[48:51], v[88:91], a[248:251], v[48:51]
    v_cvt_pk_bf16_f32 v102, v12, v13
    v_cvt_pk_bf16_f32 v103, v14, v15
    v_mfma_f32_16x16x32_bf16 v[52:55], v[92:95], a[248:251], v[52:55]
    v_cvt_pk_bf16_f32 v104, v16, v17
    v_cvt_pk_bf16_f32 v105, v18, v19
    v_mfma_f32_16x16x32_bf16 v[56:59], v[88:91], a[252:255], v[56:59]
    v_cvt_pk_bf16_f32 v106, v20, v21
    v_cvt_pk_bf16_f32 v107, v22, v23
    v_mfma_f32_16x16x32_bf16 v[60:63], v[92:95], a[252:255], v[60:63]
    v_cvt_pk_bf16_f32 v108, v24, v25
    v_cvt_pk_bf16_f32 v109, v26, v27
    s_sub_u32 s37, s37, 1
    s_cmp_lg_u32 s37, 0
    s_cbranch_scc1 k1_V_loop
    s_waitcnt lgkmcnt(0)
    s_nop 7
    v_cvt_pk_bf16_f32 v110, v28, v29
    v_cvt_pk_bf16_f32 v111, v30, v31
    v_cvt_pk_bf16_f32 v112, v32, v33
    v_cvt_pk_bf16_f32 v113, v34, v35
    v_cvt_pk_bf16_f32 v114, v36, v37
    v_cvt_pk_bf16_f32 v115, v38, v39
    v_cvt_pk_bf16_f32 v116, v40, v41
    v_cvt_pk_bf16_f32 v117, v42, v43
    v_cvt_pk_bf16_f32 v118, v44, v45
    v_cvt_pk_bf16_f32 v119, v46, v47
    v_cvt_pk_bf16_f32 v120, v48, v49
    v_cvt_pk_bf16_f32 v121, v50, v51
    v_cvt_pk_bf16_f32 v122, v52, v53
    v_cvt_pk_bf16_f32 v123, v54, v55
    v_cvt_pk_bf16_f32 v124, v56, v57
    v_cvt_pk_bf16_f32 v125, v58, v59
    v_cvt_pk_bf16_f32 v126, v60, v61
    v_cvt_pk_bf16_f32 v127, v62, v63
    s_add_u32 s56, s36, 0
    buffer_store_dwordx4 v[96:99], v138, s[16:19], s56 offen offset:0
    s_add_u32 s56, s36, 0
    buffer_store_dwordx4 v[100:103], v138, s[16:19], s56 offen offset:128
    s_add_u32 s56, s36, 0
    buffer_store_dwordx4 v[104:107], v138, s[16:19], s56 offen offset:1024
    s_add_u32 s56, s36, 0
    buffer_store_dwordx4 v[108:111], v138, s[16:19], s56 offen offset:1152
    s_add_u32 s56, s36, 8192
    buffer_store_dwordx4 v[112:115], v138, s[16:19], s56 offen offset:0
    s_add_u32 s56, s36, 8192
    buffer_store_dwordx4 v[116:119], v138, s[16:19], s56 offen offset:128
    s_add_u32 s56, s36, 8192
    buffer_store_dwordx4 v[120:123], v138, s[16:19], s56 offen offset:1024
    s_add_u32 s56, s36, 8192
    buffer_store_dwordx4 v[124:127], v138, s[16:19], s56 offen offset:1152
    s_endpgm
k1_done:
    s_endpgm

.globl k2_kernel
.p2align 8
.type k2_kernel,@function
k2_kernel:
    s_cmp_ge_u32 s2, 256
    s_cbranch_scc1 k2_done
    s_load_dwordx2 s[44:45], s[0:1], 16
    s_load_dwordx2 s[46:47], s[0:1], 104
    v_lshrrev_b32 v1, 6, v0
    v_and_b32 v2, 63, v0
    v_readfirstlane_b32 s3, v1
    s_and_b32 s4, s2, 7
    s_lshl_b32 s4, s4, 2
    s_lshr_b32 s24, s2, 3
    s_and_b32 s24, s24, 3
    s_add_u32 s4, s4, s24
    s_lshr_b32 s5, s2, 5
    s_lshl2_add_u32 s6, s5, s3
    s_waitcnt lgkmcnt(0)
    s_mov_b32 s12, s44
    s_mov_b32 s13, s45
    s_mov_b32 s14, 0x800000
    s_mov_b32 s15, 0x00020000
    s_mov_b32 s8, s46
    s_mov_b32 s9, s47
    s_mov_b32 s10, 0x400000
    s_mov_b32 s11, 0x00020000
    s_add_u32 s16, s46, 0x400000
    s_addc_u32 s17, s47, 0
    s_mov_b32 s18, 0x2000000
    s_mov_b32 s19, 0x00020000
    s_add_u32 s20, s46, 0x2400000
    s_addc_u32 s21, s47, 0
    s_mov_b32 s22, 0x1000000
    s_mov_b32 s23, 0x00020000
    v_lshlrev_b32 v240, 4, v2
    s_lshl_b32 s37, s3, 12
    v_add_u32 v242, s37, v240
    s_lshl_b32 s24, s6, 16
    v_add_u32 v248, s24, v240
    s_sub_u32 s25, 63, s6
    s_lshl_b32 s24, s25, 16
    v_add_u32 v249, s24, v240
    s_lshl_b32 s39, s6, 18
    s_lshl_b32 s40, s25, 18
    s_lshl_b32 s24, s4, 12
    s_add_u32 s39, s39, s24
    s_add_u32 s40, s40, s24
    v_bfe_u32 v3, v2, 2, 2
    v_lshlrev_b32 v3, 13, v3
    v_lshrrev_b32 v4, 4, v2
    v_lshl_add_u32 v3, v4, 6, v3
    v_and_b32 v4, 3, v2
    v_lshl_add_u32 v3, v4, 4, v3
    s_lshl_b32 s24, s4, 8
    s_lshl_b32 s25, s3, 18
    s_add_u32 s24, s24, s25
    v_add_u32 v245, s24, v3
    s_lshl_b32 s31, s3, 13
    s_add_u32 s31, s31, 65536
    s_mov_b32 s27, 0
    s_mov_b32 s43, 0x40000000
    s_lshl_b32 s32, s4, 20
    s_lshl_b32 s24, s5, 16
    s_sub_u32 s33, s32, s24
    s_add_u32 s33, s33, 1048576
    s_mov_b32 s28, 0
    s_mov_b32 s29, 4096
    s_mov_b32 s34, s37
    s_add_u32 m0, s31, 0
    s_add_u32 s24, s27, 0
    buffer_load_dwordx4 v245, s[12:15], s24 offen lds
    s_add_u32 m0, s31, 1024
    s_add_u32 s24, s27, 32768
    buffer_load_dwordx4 v245, s[12:15], s24 offen lds
    s_add_u32 m0, s31, 2048
    s_add_u32 s24, s27, 65536
    buffer_load_dwordx4 v245, s[12:15], s24 offen lds
    s_add_u32 m0, s31, 3072
    s_add_u32 s24, s27, 98304
    buffer_load_dwordx4 v245, s[12:15], s24 offen lds
    s_add_u32 m0, s31, 4096
    s_add_u32 s24, s27, 131072
    buffer_load_dwordx4 v245, s[12:15], s24 offen lds
    s_add_u32 m0, s31, 5120
    s_add_u32 s24, s27, 163840
    buffer_load_dwordx4 v245, s[12:15], s24 offen lds
    s_add_u32 m0, s31, 6144
    s_add_u32 s24, s27, 196608
    buffer_load_dwordx4 v245, s[12:15], s24 offen lds
    s_add_u32 m0, s31, 7168
    s_add_u32 s24, s27, 229376
    buffer_load_dwordx4 v245, s[12:15], s24 offen lds
    s_add_u32 s27, s27, 1048576
    s_add_u32 s31, s31, 32768
    s_cmp_ge_u32 s31, 163840
    s_cselect_b32 s24, 98304, 0
    s_sub_u32 s31, s31, s24
    buffer_load_dwordx4 v[128:131], v248, s[8:11], s28 offen offset:0
    buffer_load_dwordx4 v[132:135], v249, s[8:11], s28 offen offset:0
    buffer_load_dwordx4 v[136:139], v248, s[8:11], s28 offen offset:1024
    buffer_load_dwordx4 v[140:143], v249, s[8:11], s28 offen offset:1024
    buffer_load_dwordx4 v[144:147], v248, s[8:11], s28 offen offset:2048
    buffer_load_dwordx4 v[148:151], v249, s[8:11], s28 offen offset:2048
    buffer_load_dwordx4 v[152:155], v248, s[8:11], s28 offen offset:3072
    buffer_load_dwordx4 v[156:159], v249, s[8:11], s28 offen offset:3072
    buffer_load_dwordx4 v[160:163], v248, s[8:11], s29 offen offset:0
    buffer_load_dwordx4 v[164:167], v249, s[8:11], s29 offen offset:0
    buffer_load_dwordx4 v[168:171], v248, s[8:11], s29 offen offset:1024
    buffer_load_dwordx4 v[172:175], v249, s[8:11], s29 offen offset:1024
    buffer_load_dwordx4 v[176:179], v248, s[8:11], s29 offen offset:2048
    buffer_load_dwordx4 v[180:183], v249, s[8:11], s29 offen offset:2048
    buffer_load_dwordx4 v[184:187], v248, s[8:11], s29 offen offset:3072
    buffer_load_dwordx4 v[188:191], v249, s[8:11], s29 offen offset:3072
    s_add_u32 s28, s28, 8192
    s_add_u32 s29, s29, 8192
    s_add_u32 m0, s31, 0
    s_add_u32 s24, s27, 0
    buffer_load_dwordx4 v245, s[12:15], s24 offen lds
    s_add_u32 m0, s31, 1024
    s_add_u32 s24, s27, 32768
    buffer_load_dwordx4 v245, s[12:15], s24 offen lds
    s_add_u32 m0, s31, 2048
    s_add_u32 s24, s27, 65536
    buffer_load_dwordx4 v245, s[12:15], s24 offen lds
    s_add_u32 m0, s31, 3072
    s_add_u32 s24, s27, 98304
    buffer_load_dwordx4 v245, s[12:15], s24 offen lds
    s_add_u32 m0, s31, 4096
    s_add_u32 s24, s27, 131072
    buffer_load_dwordx4 v245, s[12:15], s24 offen lds
    s_add_u32 m0, s31, 5120
    s_add_u32 s24, s27, 163840
    buffer_load_dwordx4 v245, s[12:15], s24 offen lds
    s_add_u32 m0, s31, 6144
    s_add_u32 s24, s27, 196608
    buffer_load_dwordx4 v245, s[12:15], s24 offen lds
    s_add_u32 m0, s31, 7168
    s_add_u32 s24, s27, 229376
    buffer_load_dwordx4 v245, s[12:15], s24 offen lds
    s_add_u32 s27, s27, 1048576
    s_add_u32 s31, s31, 32768
    s_cmp_ge_u32 s31, 163840
    s_cselect_b32 s24, 98304, 0
    s_sub_u32 s31, s31, s24
    s_cmp_lt_u32 s32, s33
    s_cselect_b32 s41, s32, s43
    s_mov_b32 m0, s34
    s_nop 0
    buffer_load_dwordx4 v242, s[16:19], s41 offen offset:0 lds
    buffer_load_dwordx4 v242, s[16:19], s41 offen offset:1024 lds
    buffer_load_dwordx4 v242, s[16:19], s41 offen offset:2048 lds
    buffer_load_dwordx4 v242, s[16:19], s41 offen offset:3072 lds
    s_add_u32 s32, s32, 32768
    s_add_u32 s34, s34, 32768
    s_cmp_ge_u32 s34, 163840
    s_cselect_b32 s24, 163840, 0
    s_sub_u32 s34, s34, s24
    s_cmp_lt_u32 s32, s33
    s_cselect_b32 s41, s32, s43
    s_mov_b32 m0, s34
    s_nop 0
    buffer_load_dwordx4 v242, s[16:19], s41 offen offset:0 lds
    buffer_load_dwordx4 v242, s[16:19], s41 offen offset:1024 lds
    buffer_load_dwordx4 v242, s[16:19], s41 offen offset:2048 lds
    buffer_load_dwordx4 v242, s[16:19], s41 offen offset:3072 lds
    s_sub_u32 s42, s32, 16384
    s_cmp_lt_u32 s42, s33
    s_cselect_b32 s42, s42, s43
    s_add_u32 m0, s34, 16384
    s_nop 0
    buffer_load_dwordx4 v242, s[16:19], s42 offen offset:0 lds
    buffer_load_dwordx4 v242, s[16:19], s42 offen offset:1024 lds
    buffer_load_dwordx4 v242, s[16:19], s42 offen offset:2048 lds
    buffer_load_dwordx4 v242, s[16:19], s42 offen offset:3072 lds
    s_add_u32 s32, s32, 32768
    s_add_u32 s34, s34, 32768
    s_cmp_ge_u32 s34, 163840
    s_cselect_b32 s24, 163840, 0
    s_sub_u32 s34, s34, s24
    v_lshrrev_b32 v3, 5, v2
    v_lshlrev_b32 v3, 11, v3
    v_bfe_u32 v4, v2, 2, 2
    v_lshl_add_u32 v3, v4, 6, v3
    v_bfe_u32 v4, v2, 4, 1
    v_lshl_add_u32 v3, v4, 5, v3
    v_and_b32 v4, 3, v2
    v_lshl_add_u32 v247, v4, 3, v3
    s_mov_b32 s30, 65536
    v_add_u32 v246, s30, v247
    v_and_b32 v3, 31, v2
    v_lshrrev_b32 v4, 5, v2
    v_lshlrev_b32 v4, 2, v4
    v_sub_u32 v3, v3, v4
    v_cvt_f32_i32 v3, v3
    v_add_f32 v3, 0.5, v3
    v_mul_f32 v243, 0x71800000, v3
    v_bfe_u32 v3, v2, 4, 1
    v_lshlrev_b32 v3, 17, v3
    v_lshrrev_b32 v4, 5, v2
    v_lshl_add_u32 v3, v4, 8, v3
    v_and_b32 v4, 15, v2
    v_lshl_add_u32 v244, v4, 4, v3
    s_mov_b32 s38, 0x47800000
    v_accvgpr_write_b32 a0, 0
    v_accvgpr_write_b32 a1, 0
    v_accvgpr_write_b32 a2, 0
    v_accvgpr_write_b32 a3, 0
    v_accvgpr_write_b32 a4, 0
    v_accvgpr_write_b32 a5, 0
    v_accvgpr_write_b32 a6, 0
    v_accvgpr_write_b32 a7, 0
    v_accvgpr_write_b32 a8, 0
    v_accvgpr_write_b32 a9, 0
    v_accvgpr_write_b32 a10, 0
    v_accvgpr_write_b32 a11, 0
    v_accvgpr_write_b32 a12, 0
    v_accvgpr_write_b32 a13, 0
    v_accvgpr_write_b32 a14, 0
    v_accvgpr_write_b32 a15, 0
    v_accvgpr_write_b32 a16, 0
    v_accvgpr_write_b32 a17, 0
    v_accvgpr_write_b32 a18, 0
    v_accvgpr_write_b32 a19, 0
    v_accvgpr_write_b32 a20, 0
    v_accvgpr_write_b32 a21, 0
    v_accvgpr_write_b32 a22, 0
    v_accvgpr_write_b32 a23, 0
    v_accvgpr_write_b32 a24, 0
    v_accvgpr_write_b32 a25, 0
    v_accvgpr_write_b32 a26, 0
    v_accvgpr_write_b32 a27, 0
    v_accvgpr_write_b32 a28, 0
    v_accvgpr_write_b32 a29, 0
    v_accvgpr_write_b32 a30, 0
    v_accvgpr_write_b32 a31, 0
    v_accvgpr_write_b32 a32, 0
    v_accvgpr_write_b32 a33, 0
    v_accvgpr_write_b32 a34, 0
    v_accvgpr_write_b32 a35, 0
    v_accvgpr_write_b32 a36, 0
    v_accvgpr_write_b32 a37, 0
    v_accvgpr_write_b32 a38, 0
    v_accvgpr_write_b32 a39, 0
    v_accvgpr_write_b32 a40, 0
    v_accvgpr_write_b32 a41, 0
    v_accvgpr_write_b32 a42, 0
    v_accvgpr_write_b32 a43, 0
    v_accvgpr_write_b32 a44, 0
    v_accvgpr_write_b32 a45, 0
    v_accvgpr_write_b32 a46, 0
    v_accvgpr_write_b32 a47, 0
    v_accvgpr_write_b32 a48, 0
    v_accvgpr_write_b32 a49, 0
    v_accvgpr_write_b32 a50, 0
    v_accvgpr_write_b32 a51, 0
    v_accvgpr_write_b32 a52, 0
    v_accvgpr_write_b32 a53, 0
    v_accvgpr_write_b32 a54, 0
    v_accvgpr_write_b32 a55, 0
    v_accvgpr_write_b32 a56, 0
    v_accvgpr_write_b32 a57, 0
    v_accvgpr_write_b32 a58, 0
    v_accvgpr_write_b32 a59, 0
    v_accvgpr_write_b32 a60, 0
    v_accvgpr_write_b32 a61, 0
    v_accvgpr_write_b32 a62, 0
    v_accvgpr_write_b32 a63, 0
    v_accvgpr_write_b32 a64, 0
    v_accvgpr_write_b32 a65, 0
    v_accvgpr_write_b32 a66, 0
    v_accvgpr_write_b32 a67, 0
    v_accvgpr_write_b32 a68, 0
    v_accvgpr_write_b32 a69, 0
    v_accvgpr_write_b32 a70, 0
    v_accvgpr_write_b32 a71, 0
    v_accvgpr_write_b32 a72, 0
    v_accvgpr_write_b32 a73, 0
    v_accvgpr_write_b32 a74, 0
    v_accvgpr_write_b32 a75, 0
    v_accvgpr_write_b32 a76, 0
    v_accvgpr_write_b32 a77, 0
    v_accvgpr_write_b32 a78, 0
    v_accvgpr_write_b32 a79, 0
    v_accvgpr_write_b32 a80, 0
    v_accvgpr_write_b32 a81, 0
    v_accvgpr_write_b32 a82, 0
    v_accvgpr_write_b32 a83, 0
    v_accvgpr_write_b32 a84, 0
    v_accvgpr_write_b32 a85, 0
    v_accvgpr_write_b32 a86, 0
    v_accvgpr_write_b32 a87, 0
    v_accvgpr_write_b32 a88, 0
    v_accvgpr_write_b32 a89, 0
    v_accvgpr_write_b32 a90, 0
    v_accvgpr_write_b32 a91, 0
    v_accvgpr_write_b32 a92, 0
    v_accvgpr_write_b32 a93, 0
    v_accvgpr_write_b32 a94, 0
    v_accvgpr_write_b32 a95, 0
    v_accvgpr_write_b32 a96, 0
    v_accvgpr_write_b32 a97, 0
    v_accvgpr_write_b32 a98, 0
    v_accvgpr_write_b32 a99, 0
    v_accvgpr_write_b32 a100, 0
    v_accvgpr_write_b32 a101, 0
    v_accvgpr_write_b32 a102, 0
    v_accvgpr_write_b32 a103, 0
    v_accvgpr_write_b32 a104, 0
    v_accvgpr_write_b32 a105, 0
    v_accvgpr_write_b32 a106, 0
    v_accvgpr_write_b32 a107, 0
    v_accvgpr_write_b32 a108, 0
    v_accvgpr_write_b32 a109, 0
    v_accvgpr_write_b32 a110, 0
    v_accvgpr_write_b32 a111, 0
    v_accvgpr_write_b32 a112, 0
    v_accvgpr_write_b32 a113, 0
    v_accvgpr_write_b32 a114, 0
    v_accvgpr_write_b32 a115, 0
    v_accvgpr_write_b32 a116, 0
    v_accvgpr_write_b32 a117, 0
    v_accvgpr_write_b32 a118, 0
    v_accvgpr_write_b32 a119, 0
    v_accvgpr_write_b32 a120, 0
    v_accvgpr_write_b32 a121, 0
    v_accvgpr_write_b32 a122, 0
    v_accvgpr_write_b32 a123, 0
    v_accvgpr_write_b32 a124, 0
    v_accvgpr_write_b32 a125, 0
    v_accvgpr_write_b32 a126, 0
    v_accvgpr_write_b32 a127, 0
    v_mov_b32 v0, 0
    v_mov_b32 v1, 0
    v_mov_b32 v2, 0
    v_mov_b32 v3, 0
    v_mov_b32 v4, 0
    v_mov_b32 v5, 0
    v_mov_b32 v6, 0
    v_mov_b32 v7, 0
    v_mov_b32 v8, 0
    v_mov_b32 v9, 0
    v_mov_b32 v10, 0
    v_mov_b32 v11, 0
    v_mov_b32 v12, 0
    v_mov_b32 v13, 0
    v_mov_b32 v14, 0
    v_mov_b32 v15, 0
    v_mov_b32 v16, 0
    v_mov_b32 v17, 0
    v_mov_b32 v18, 0
    v_mov_b32 v19, 0
    v_mov_b32 v20, 0
    v_mov_b32 v21, 0
    v_mov_b32 v22, 0
    v_mov_b32 v23, 0
    v_mov_b32 v24, 0
    v_mov_b32 v25, 0
    v_mov_b32 v26, 0
    v_mov_b32 v27, 0
    v_mov_b32 v28, 0
    v_mov_b32 v29, 0
    v_mov_b32 v30, 0
    v_mov_b32 v31, 0
    v_mov_b32 v32, 0
    v_mov_b32 v33, 0
    v_mov_b32 v34, 0
    v_mov_b32 v35, 0
    v_mov_b32 v36, 0
    v_mov_b32 v37, 0
    v_mov_b32 v38, 0
    v_mov_b32 v39, 0
    v_mov_b32 v40, 0
    v_mov_b32 v41, 0
    v_mov_b32 v42, 0
    v_mov_b32 v43, 0
    v_mov_b32 v44, 0
    v_mov_b32 v45, 0
    v_mov_b32 v46, 0
    v_mov_b32 v47, 0
    v_mov_b32 v48, 0
    v_mov_b32 v49, 0
    v_mov_b32 v50, 0
    v_mov_b32 v51, 0
    v_mov_b32 v52, 0
    v_mov_b32 v53, 0
    v_mov_b32 v54, 0
    v_mov_b32 v55, 0
    v_mov_b32 v56, 0
    v_mov_b32 v57, 0
    v_mov_b32 v58, 0
    v_mov_b32 v59, 0
    v_mov_b32 v60, 0
    v_mov_b32 v61, 0
    v_mov_b32 v62, 0
    v_mov_b32 v63, 0
    v_mov_b32 v64, 0
    v_mov_b32 v65, 0
    v_mov_b32 v66, 0
    v_mov_b32 v67, 0
    v_mov_b32 v68, 0
    v_mov_b32 v69, 0
    v_mov_b32 v70, 0
    v_mov_b32 v71, 0
    v_mov_b32 v72, 0
    v_mov_b32 v73, 0
    v_mov_b32 v74, 0
    v_mov_b32 v75, 0
    v_mov_b32 v76, 0
    v_mov_b32 v77, 0
    v_mov_b32 v78, 0
    v_mov_b32 v79, 0
    v_mov_b32 v80, 0
    v_mov_b32 v81, 0
    v_mov_b32 v82, 0
    v_mov_b32 v83, 0
    v_mov_b32 v84, 0
    v_mov_b32 v85, 0
    v_mov_b32 v86, 0
    v_mov_b32 v87, 0
    v_mov_b32 v88, 0
    v_mov_b32 v89, 0
    v_mov_b32 v90, 0
    v_mov_b32 v91, 0
    v_mov_b32 v92, 0
    v_mov_b32 v93, 0
    v_mov_b32 v94, 0
    v_mov_b32 v95, 0
    v_mov_b32 v96, 0
    v_mov_b32 v97, 0
    v_mov_b32 v98, 0
    v_mov_b32 v99, 0
    v_mov_b32 v100, 0
    v_mov_b32 v101, 0
    v_mov_b32 v102, 0
    v_mov_b32 v103, 0
    v_mov_b32 v104, 0
    v_mov_b32 v105, 0
    v_mov_b32 v106, 0
    v_mov_b32 v107, 0
    v_mov_b32 v108, 0
    v_mov_b32 v109, 0
    v_mov_b32 v110, 0
    v_mov_b32 v111, 0
    v_mov_b32 v112, 0
    v_mov_b32 v113, 0
    v_mov_b32 v114, 0
    v_mov_b32 v115, 0
    v_mov_b32 v116, 0
    v_mov_b32 v117, 0
    v_mov_b32 v118, 0
    v_mov_b32 v119, 0
    v_mov_b32 v120, 0
    v_mov_b32 v121, 0
    v_mov_b32 v122, 0
    v_mov_b32 v123, 0
    v_mov_b32 v124, 0
    v_mov_b32 v125, 0
    v_mov_b32 v126, 0
    v_mov_b32 v127, 0
    s_waitcnt vmcnt(36)
    s_barrier
    ds_read_b64_tr_b16 a[192:193], v246 offset:0
    ds_read_b64_tr_b16 a[194:195], v246 offset:1024
    ds_read_b64_tr_b16 a[196:197], v246 offset:256
    ds_read_b64_tr_b16 a[198:199], v246 offset:1280
    ds_read_b64_tr_b16 a[200:201], v246 offset:512
    ds_read_b64_tr_b16 a[202:203], v246 offset:1536
    ds_read_b64_tr_b16 a[204:205], v246 offset:768
    ds_read_b64_tr_b16 a[206:207], v246 offset:1792
    s_mov_b32 s26, 8
.p2align 3
k2_qp:
    s_waitcnt vmcnt(21) lgkmcnt(0)
    v_mfma_f32_32x32x16_bf16 v[0:15], a[192:195], v[128:131], v[0:15]
    ds_read_b64_tr_b16 a[208:209], v246 offset:4096
    ds_read_b64_tr_b16 a[210:211], v246 offset:5120
    v_mfma_f32_32x32x16_bf16 v[64:79], a[192:195], v[132:135], v[64:79]
    ds_read_b64_tr_b16 a[212:213], v246 offset:4352
    ds_read_b64_tr_b16 a[214:215], v246 offset:5376
    v_mfma_f32_32x32x16_bf16 v[16:31], a[196:199], v[128:131], v[16:31]
    ds_read_b64_tr_b16 a[216:217], v246 offset:4608
    ds_read_b64_tr_b16 a[218:219], v246 offset:5632
    v_mfma_f32_32x32x16_bf16 v[80:95], a[196:199], v[132:135], v[80:95]
    ds_read_b64_tr_b16 a[220:221], v246 offset:4864
    ds_read_b64_tr_b16 a[222:223], v246 offset:5888
    v_mfma_f32_32x32x16_bf16 v[32:47], a[200:203], v[128:131], v[32:47]
    v_mfma_f32_32x32x16_bf16 v[96:111], a[200:203], v[132:135], v[96:111]
    v_mfma_f32_32x32x16_bf16 v[48:63], a[204:207], v[128:131], v[48:63]
    s_add_u32 m0, s31, 0
    s_add_u32 s24, s27, 0
    buffer_load_dwordx4 v245, s[12:15], s24 offen lds
    v_mfma_f32_32x32x16_bf16 v[112:127], a[204:207], v[132:135], v[112:127]
    s_waitcnt vmcnt(19) lgkmcnt(0)
    v_mfma_f32_32x32x16_bf16 v[0:15], a[208:211], v[136:139], v[0:15]
    ds_read_b64_tr_b16 a[192:193], v246 offset:8192
    ds_read_b64_tr_b16 a[194:195], v246 offset:9216
    v_mfma_f32_32x32x16_bf16 v[64:79], a[208:211], v[140:143], v[64:79]
    ds_read_b64_tr_b16 a[196:197], v246 offset:8448
    ds_read_b64_tr_b16 a[198:199], v246 offset:9472
    v_mfma_f32_32x32x16_bf16 v[16:31], a[212:215], v[136:139], v[16:31]
    ds_read_b64_tr_b16 a[200:201], v246 offset:8704
    ds_read_b64_tr_b16 a[202:203], v246 offset:9728
    v_mfma_f32_32x32x16_bf16 v[80:95], a[212:215], v[140:143], v[80:95]
    ds_read_b64_tr_b16 a[204:205], v246 offset:8960
    ds_read_b64_tr_b16 a[206:207], v246 offset:9984
    v_mfma_f32_32x32x16_bf16 v[32:47], a[216:219], v[136:139], v[32:47]
    buffer_load_dwordx4 v[128:131], v248, s[8:11], s28 offen offset:0
    v_mfma_f32_32x32x16_bf16 v[96:111], a[216:219], v[140:143], v[96:111]
    buffer_load_dwordx4 v[132:135], v249, s[8:11], s28 offen offset:0
    v_mfma_f32_32x32x16_bf16 v[48:63], a[220:223], v[136:139], v[48:63]
    s_add_u32 m0, s31, 1024
    s_add_u32 s24, s27, 32768
    buffer_load_dwordx4 v245, s[12:15], s24 offen lds
    v_mfma_f32_32x32x16_bf16 v[112:127], a[220:223], v[140:143], v[112:127]
    s_waitcnt vmcnt(19) lgkmcnt(0)
    v_mfma_f32_32x32x16_bf16 v[0:15], a[192:195], v[144:147], v[0:15]
    ds_read_b64_tr_b16 a[208:209], v246 offset:12288
    ds_read_b64_tr_b16 a[210:211], v246 offset:13312
    v_mfma_f32_32x32x16_bf16 v[64:79], a[192:195], v[148:151], v[64:79]
    ds_read_b64_tr_b16 a[212:213], v246 offset:12544
    ds_read_b64_tr_b16 a[214:215], v246 offset:13568
    v_mfma_f32_32x32x16_bf16 v[16:31], a[196:199], v[144:147], v[16:31]
    ds_read_b64_tr_b16 a[216:217], v246 offset:12800
    ds_read_b64_tr_b16 a[218:219], v246 offset:13824
    v_mfma_f32_32x32x16_bf16 v[80:95], a[196:199], v[148:151], v[80:95]
    ds_read_b64_tr_b16 a[220:221], v246 offset:13056
    ds_read_b64_tr_b16 a[222:223], v246 offset:14080
    v_mfma_f32_32x32x16_bf16 v[32:47], a[200:203], v[144:147], v[32:47]
    buffer_load_dwordx4 v[136:139], v248, s[8:11], s28 offen offset:1024
    v_mfma_f32_32x32x16_bf16 v[96:111], a[200:203], v[148:151], v[96:111]
    buffer_load_dwordx4 v[140:143], v249, s[8:11], s28 offen offset:1024
    v_mfma_f32_32x32x16_bf16 v[48:63], a[204:207], v[144:147], v[48:63]
    s_add_u32 m0, s31, 2048
    s_add_u32 s24, s27, 65536
    buffer_load_dwordx4 v245, s[12:15], s24 offen lds
    v_mfma_f32_32x32x16_bf16 v[112:127], a[204:207], v[148:151], v[112:127]
    s_waitcnt vmcnt(19) lgkmcnt(0)
    v_mfma_f32_32x32x16_bf16 v[0:15], a[208:211], v[152:155], v[0:15]
    ds_read_b64_tr_b16 a[192:193], v246 offset:16384
    ds_read_b64_tr_b16 a[194:195], v246 offset:17408
    v_mfma_f32_32x32x16_bf16 v[64:79], a[208:211], v[156:159], v[64:79]
    ds_read_b64_tr_b16 a[196:197], v246 offset:16640
    ds_read_b64_tr_b16 a[198:199], v246 offset:17664
    v_mfma_f32_32x32x16_bf16 v[16:31], a[212:215], v[152:155], v[16:31]
    ds_read_b64_tr_b16 a[200:201], v246 offset:16896
    ds_read_b64_tr_b16 a[202:203], v246 offset:17920
    v_mfma_f32_32x32x16_bf16 v[80:95], a[212:215], v[156:159], v[80:95]
    ds_read_b64_tr_b16 a[204:205], v246 offset:17152
    ds_read_b64_tr_b16 a[206:207], v246 offset:18176
    v_mfma_f32_32x32x16_bf16 v[32:47], a[216:219], v[152:155], v[32:47]
    buffer_load_dwordx4 v[144:147], v248, s[8:11], s28 offen offset:2048
    v_mfma_f32_32x32x16_bf16 v[96:111], a[216:219], v[156:159], v[96:111]
    buffer_load_dwordx4 v[148:151], v249, s[8:11], s28 offen offset:2048
    v_mfma_f32_32x32x16_bf16 v[48:63], a[220:223], v[152:155], v[48:63]
    s_add_u32 m0, s31, 3072
    s_add_u32 s24, s27, 98304
    buffer_load_dwordx4 v245, s[12:15], s24 offen lds
    v_mfma_f32_32x32x16_bf16 v[112:127], a[220:223], v[156:159], v[112:127]
    s_waitcnt vmcnt(19) lgkmcnt(0)
    v_mfma_f32_32x32x16_bf16 v[0:15], a[192:195], v[160:163], v[0:15]
    ds_read_b64_tr_b16 a[208:209], v246 offset:20480
    ds_read_b64_tr_b16 a[210:211], v246 offset:21504
    v_mfma_f32_32x32x16_bf16 v[64:79], a[192:195], v[164:167], v[64:79]
    ds_read_b64_tr_b16 a[212:213], v246 offset:20736
    ds_read_b64_tr_b16 a[214:215], v246 offset:21760
    v_mfma_f32_32x32x16_bf16 v[16:31], a[196:199], v[160:163], v[16:31]
    ds_read_b64_tr_b16 a[216:217], v246 offset:20992
    ds_read_b64_tr_b16 a[218:219], v246 offset:22016
    v_mfma_f32_32x32x16_bf16 v[80:95], a[196:199], v[164:167], v[80:95]
    ds_read_b64_tr_b16 a[220:221], v246 offset:21248
    ds_read_b64_tr_b16 a[222:223], v246 offset:22272
    v_mfma_f32_32x32x16_bf16 v[32:47], a[200:203], v[160:163], v[32:47]
    buffer_load_dwordx4 v[152:155], v248, s[8:11], s28 offen offset:3072
    v_mfma_f32_32x32x16_bf16 v[96:111], a[200:203], v[164:167], v[96:111]
    buffer_load_dwordx4 v[156:159], v249, s[8:11], s28 offen offset:3072
    v_mfma_f32_32x32x16_bf16 v[48:63], a[204:207], v[160:163], v[48:63]
    s_add_u32 m0, s31, 4096
    s_add_u32 s24, s27, 131072
    buffer_load_dwordx4 v245, s[12:15], s24 offen lds
    v_mfma_f32_32x32x16_bf16 v[112:127], a[204:207], v[164:167], v[112:127]
    s_waitcnt vmcnt(19) lgkmcnt(0)
    v_mfma_f32_32x32x16_bf16 v[0:15], a[208:211], v[168:171], v[0:15]
    ds_read_b64_tr_b16 a[192:193], v246 offset:24576
    ds_read_b64_tr_b16 a[194:195], v246 offset:25600
    v_mfma_f32_32x32x16_bf16 v[64:79], a[208:211], v[172:175], v[64:79]
    ds_read_b64_tr_b16 a[196:197], v246 offset:24832
    ds_read_b64_tr_b16 a[198:199], v246 offset:25856
    v_mfma_f32_32x32x16_bf16 v[16:31], a[212:215], v[168:171], v[16:31]
    ds_read_b64_tr_b16 a[200:201], v246 offset:25088
    ds_read_b64_tr_b16 a[202:203], v246 offset:26112
    v_mfma_f32_32x32x16_bf16 v[80:95], a[212:215], v[172:175], v[80:95]
    ds_read_b64_tr_b16 a[204:205], v246 offset:25344
    ds_read_b64_tr_b16 a[206:207], v246 offset:26368
    v_mfma_f32_32x32x16_bf16 v[32:47], a[216:219], v[168:171], v[32:47]
    buffer_load_dwordx4 v[160:163], v248, s[8:11], s29 offen offset:0
    v_mfma_f32_32x32x16_bf16 v[96:111], a[216:219], v[172:175], v[96:111]
    buffer_load_dwordx4 v[164:167], v249, s[8:11], s29 offen offset:0
    v_mfma_f32_32x32x16_bf16 v[48:63], a[220:223], v[168:171], v[48:63]
    s_add_u32 m0, s31, 5120
    s_add_u32 s24, s27, 163840
    buffer_load_dwordx4 v245, s[12:15], s24 offen lds
    v_mfma_f32_32x32x16_bf16 v[112:127], a[220:223], v[172:175], v[112:127]
    s_waitcnt vmcnt(19) lgkmcnt(0)
    v_mfma_f32_32x32x16_bf16 v[0:15], a[192:195], v[176:179], v[0:15]
    ds_read_b64_tr_b16 a[208:209], v246 offset:28672
    ds_read_b64_tr_b16 a[210:211], v246 offset:29696
    v_mfma_f32_32x32x16_bf16 v[64:79], a[192:195], v[180:183], v[64:79]
    ds_read_b64_tr_b16 a[212:213], v246 offset:28928
    ds_read_b64_tr_b16 a[214:215], v246 offset:29952
    v_mfma_f32_32x32x16_bf16 v[16:31], a[196:199], v[176:179], v[16:31]
    ds_read_b64_tr_b16 a[216:217], v246 offset:29184
    ds_read_b64_tr_b16 a[218:219], v246 offset:30208
    v_mfma_f32_32x32x16_bf16 v[80:95], a[196:199], v[180:183], v[80:95]
    ds_read_b64_tr_b16 a[220:221], v246 offset:29440
    ds_read_b64_tr_b16 a[222:223], v246 offset:30464
    v_mfma_f32_32x32x16_bf16 v[32:47], a[200:203], v[176:179], v[32:47]
    buffer_load_dwordx4 v[168:171], v248, s[8:11], s29 offen offset:1024
    v_mfma_f32_32x32x16_bf16 v[96:111], a[200:203], v[180:183], v[96:111]
    buffer_load_dwordx4 v[172:175], v249, s[8:11], s29 offen offset:1024
    v_mfma_f32_32x32x16_bf16 v[48:63], a[204:207], v[176:179], v[48:63]
    s_add_u32 m0, s31, 6144
    s_add_u32 s24, s27, 196608
    buffer_load_dwordx4 v245, s[12:15], s24 offen lds
    v_mfma_f32_32x32x16_bf16 v[112:127], a[204:207], v[180:183], v[112:127]
    s_waitcnt vmcnt(19) lgkmcnt(0)
    s_barrier
    s_add_u32 s30, s30, 32768
    s_cmp_ge_u32 s30, 163840
    s_cselect_b32 s24, 98304, 0
    s_sub_u32 s30, s30, s24
    v_add_u32 v246, s30, v247
    v_mfma_f32_32x32x16_bf16 v[0:15], a[208:211], v[184:187], v[0:15]
    ds_read_b64_tr_b16 a[192:193], v246 offset:0
    ds_read_b64_tr_b16 a[194:195], v246 offset:1024
    v_mfma_f32_32x32x16_bf16 v[64:79], a[208:211], v[188:191], v[64:79]
    ds_read_b64_tr_b16 a[196:197], v246 offset:256
    ds_read_b64_tr_b16 a[198:199], v246 offset:1280
    v_mfma_f32_32x32x16_bf16 v[16:31], a[212:215], v[184:187], v[16:31]
    ds_read_b64_tr_b16 a[200:201], v246 offset:512
    ds_read_b64_tr_b16 a[202:203], v246 offset:1536
    v_mfma_f32_32x32x16_bf16 v[80:95], a[212:215], v[188:191], v[80:95]
    ds_read_b64_tr_b16 a[204:205], v246 offset:768
    ds_read_b64_tr_b16 a[206:207], v246 offset:1792
    v_mfma_f32_32x32x16_bf16 v[32:47], a[216:219], v[184:187], v[32:47]
    buffer_load_dwordx4 v[176:179], v248, s[8:11], s29 offen offset:2048
    v_mfma_f32_32x32x16_bf16 v[96:111], a[216:219], v[188:191], v[96:111]
    buffer_load_dwordx4 v[180:183], v249, s[8:11], s29 offen offset:2048
    v_mfma_f32_32x32x16_bf16 v[48:63], a[220:223], v[184:187], v[48:63]
    s_add_u32 m0, s31, 7168
    s_add_u32 s24, s27, 229376
    buffer_load_dwordx4 v245, s[12:15], s24 offen lds
    s_add_u32 s27, s27, 1048576
    s_add_u32 s31, s31, 32768
    s_cmp_ge_u32 s31, 163840
    s_cselect_b32 s24, 98304, 0
    s_sub_u32 s31, s31, s24
    v_mfma_f32_32x32x16_bf16 v[112:127], a[220:223], v[188:191], v[112:127]
    buffer_load_dwordx4 v[184:187], v248, s[8:11], s29 offen offset:3072
    buffer_load_dwordx4 v[188:191], v249, s[8:11], s29 offen offset:3072
    s_add_u32 s28, s28, 8192
    s_add_u32 s29, s29, 8192
    s_sub_u32 s26, s26, 1
    s_cmp_lg_u32 s26, 0
    s_cbranch_scc1 k2_qp
    s_waitcnt vmcnt(0) lgkmcnt(0)
    s_barrier
    s_cmp_lt_u32 s32, s33
    s_cselect_b32 s41, s32, s43
    s_mov_b32 m0, s34
    s_nop 0
    buffer_load_dwordx4 v242, s[16:19], s41 offen offset:0 lds
    buffer_load_dwordx4 v242, s[16:19], s41 offen offset:1024 lds
    buffer_load_dwordx4 v242, s[16:19], s41 offen offset:2048 lds
    buffer_load_dwordx4 v242, s[16:19], s41 offen offset:3072 lds
    s_sub_u32 s42, s32, 16384
    s_cmp_lt_u32 s42, s33
    s_cselect_b32 s42, s42, s43
    s_add_u32 m0, s34, 16384
    s_nop 0
    buffer_load_dwordx4 v242, s[16:19], s42 offen offset:0 lds
    buffer_load_dwordx4 v242, s[16:19], s42 offen offset:1024 lds
    buffer_load_dwordx4 v242, s[16:19], s42 offen offset:2048 lds
    buffer_load_dwordx4 v242, s[16:19], s42 offen offset:3072 lds
    s_add_u32 s32, s32, 32768
    s_add_u32 s34, s34, 32768
    s_cmp_ge_u32 s34, 163840
    s_cselect_b32 s24, 163840, 0
    s_sub_u32 s34, s34, s24
    s_cmp_lt_u32 s32, s33
    s_cselect_b32 s41, s32, s43
    s_mov_b32 m0, s34
    s_nop 0
    buffer_load_dwordx4 v242, s[16:19], s41 offen offset:0 lds
    buffer_load_dwordx4 v242, s[16:19], s41 offen offset:1024 lds
    buffer_load_dwordx4 v242, s[16:19], s41 offen offset:2048 lds
    buffer_load_dwordx4 v242, s[16:19], s41 offen offset:3072 lds
    s_sub_u32 s42, s32, 16384
    s_cmp_lt_u32 s42, s33
    s_cselect_b32 s42, s42, s43
    s_add_u32 m0, s34, 16384
    s_nop 0
    buffer_load_dwordx4 v242, s[16:19], s42 offen offset:0 lds
    buffer_load_dwordx4 v242, s[16:19], s42 offen offset:1024 lds
    buffer_load_dwordx4 v242, s[16:19], s42 offen offset:2048 lds
    buffer_load_dwordx4 v242, s[16:19], s42 offen offset:3072 lds
    s_add_u32 s32, s32, 32768
    s_add_u32 s34, s34, 32768
    s_cmp_ge_u32 s34, 163840
    s_cselect_b32 s24, 163840, 0
    s_sub_u32 s34, s34, s24
    v_mov_b32 v241, v240
    s_mov_b32 s35, 0
    s_mov_b32 s25, 0x3e0293ee
    ds_read_b128 a[192:195], v241 offset:0
    ds_read_b128 a[196:199], v241 offset:1024
    ds_read_b128 a[200:203], v241 offset:2048
    ds_read_b128 a[204:207], v241 offset:3072
    ds_read_b128 a[208:211], v241 offset:4096
    ds_read_b128 a[212:215], v241 offset:5120
    ds_read_b128 a[216:219], v241 offset:6144
    ds_read_b128 a[220:223], v241 offset:7168
    ds_read_b128 a[224:227], v241 offset:8192
    ds_read_b128 a[228:231], v241 offset:9216
    ds_read_b128 a[232:235], v241 offset:10240
    ds_read_b128 a[236:239], v241 offset:11264
    ds_read_b128 a[240:243], v241 offset:12288
    ds_read_b128 a[244:247], v241 offset:13312
    ds_read_b128 a[248:251], v241 offset:14336
    v_mul_f32 v0, s25, v0
    v_mul_f32 v1, s25, v1
    v_mul_f32 v2, s25, v2
    v_mul_f32 v3, s25, v3
    v_mul_f32 v4, s25, v4
    v_mul_f32 v5, s25, v5
    v_mul_f32 v6, s25, v6
    v_mul_f32 v7, s25, v7
    v_mul_f32 v8, s25, v8
    v_mul_f32 v9, s25, v9
    v_mul_f32 v10, s25, v10
    v_mul_f32 v11, s25, v11
    v_mul_f32 v12, s25, v12
    v_mul_f32 v13, s25, v13
    v_mul_f32 v14, s25, v14
    v_mul_f32 v15, s25, v15
    v_cvt_pk_bf16_f32 v0, v0, v1
    v_cvt_pk_bf16_f32 v1, v2, v3
    v_cvt_pk_bf16_f32 v2, v4, v5
    v_cvt_pk_bf16_f32 v3, v6, v7
    v_cvt_pk_bf16_f32 v4, v8, v9
    v_cvt_pk_bf16_f32 v5, v10, v11
    v_cvt_pk_bf16_f32 v6, v12, v13
    v_cvt_pk_bf16_f32 v7, v14, v15
    v_accvgpr_write_b32 a128, v0
    v_accvgpr_write_b32 a129, v1
    v_accvgpr_write_b32 a130, v2
    v_accvgpr_write_b32 a131, v3
    v_accvgpr_write_b32 a132, v4
    v_accvgpr_write_b32 a133, v5
    v_accvgpr_write_b32 a134, v6
    v_accvgpr_write_b32 a135, v7
    v_mul_f32 v16, s25, v16
    v_mul_f32 v17, s25, v17
    v_mul_f32 v18, s25, v18
    v_mul_f32 v19, s25, v19
    v_mul_f32 v20, s25, v20
    v_mul_f32 v21, s25, v21
    v_mul_f32 v22, s25, v22
    v_mul_f32 v23, s25, v23
    v_mul_f32 v24, s25, v24
    v_mul_f32 v25, s25, v25
    v_mul_f32 v26, s25, v26
    v_mul_f32 v27, s25, v27
    v_mul_f32 v28, s25, v28
    v_mul_f32 v29, s25, v29
    v_mul_f32 v30, s25, v30
    v_mul_f32 v31, s25, v31
    v_cvt_pk_bf16_f32 v16, v16, v17
    v_cvt_pk_bf16_f32 v17, v18, v19
    v_cvt_pk_bf16_f32 v18, v20, v21
    v_cvt_pk_bf16_f32 v19, v22, v23
    v_cvt_pk_bf16_f32 v20, v24, v25
    v_cvt_pk_bf16_f32 v21, v26, v27
    v_cvt_pk_bf16_f32 v22, v28, v29
    v_cvt_pk_bf16_f32 v23, v30, v31
    v_accvgpr_write_b32 a136, v16
    v_accvgpr_write_b32 a137, v17
    v_accvgpr_write_b32 a138, v18
    v_accvgpr_write_b32 a139, v19
    v_accvgpr_write_b32 a140, v20
    v_accvgpr_write_b32 a141, v21
    v_accvgpr_write_b32 a142, v22
    v_accvgpr_write_b32 a143, v23
    v_mul_f32 v32, s25, v32
    v_mul_f32 v33, s25, v33
    v_mul_f32 v34, s25, v34
    v_mul_f32 v35, s25, v35
    v_mul_f32 v36, s25, v36
    v_mul_f32 v37, s25, v37
    v_mul_f32 v38, s25, v38
    v_mul_f32 v39, s25, v39
    v_mul_f32 v40, s25, v40
    v_mul_f32 v41, s25, v41
    v_mul_f32 v42, s25, v42
    v_mul_f32 v43, s25, v43
    v_mul_f32 v44, s25, v44
    v_mul_f32 v45, s25, v45
    v_mul_f32 v46, s25, v46
    v_mul_f32 v47, s25, v47
    v_cvt_pk_bf16_f32 v32, v32, v33
    v_cvt_pk_bf16_f32 v33, v34, v35
    v_cvt_pk_bf16_f32 v34, v36, v37
    v_cvt_pk_bf16_f32 v35, v38, v39
    v_cvt_pk_bf16_f32 v36, v40, v41
    v_cvt_pk_bf16_f32 v37, v42, v43
    v_cvt_pk_bf16_f32 v38, v44, v45
    v_cvt_pk_bf16_f32 v39, v46, v47
    v_accvgpr_write_b32 a144, v32
    v_accvgpr_write_b32 a145, v33
    v_accvgpr_write_b32 a146, v34
    v_accvgpr_write_b32 a147, v35
    v_accvgpr_write_b32 a148, v36
    v_accvgpr_write_b32 a149, v37
    v_accvgpr_write_b32 a150, v38
    v_accvgpr_write_b32 a151, v39
    v_mul_f32 v48, s25, v48
    v_mul_f32 v49, s25, v49
    v_mul_f32 v50, s25, v50
    v_mul_f32 v51, s25, v51
    v_mul_f32 v52, s25, v52
    v_mul_f32 v53, s25, v53
    v_mul_f32 v54, s25, v54
    v_mul_f32 v55, s25, v55
    v_mul_f32 v56, s25, v56
    v_mul_f32 v57, s25, v57
    v_mul_f32 v58, s25, v58
    v_mul_f32 v59, s25, v59
    v_mul_f32 v60, s25, v60
    v_mul_f32 v61, s25, v61
    v_mul_f32 v62, s25, v62
    v_mul_f32 v63, s25, v63
    v_cvt_pk_bf16_f32 v48, v48, v49
    v_cvt_pk_bf16_f32 v49, v50, v51
    v_cvt_pk_bf16_f32 v50, v52, v53
    v_cvt_pk_bf16_f32 v51, v54, v55
    v_cvt_pk_bf16_f32 v52, v56, v57
    v_cvt_pk_bf16_f32 v53, v58, v59
    v_cvt_pk_bf16_f32 v54, v60, v61
    v_cvt_pk_bf16_f32 v55, v62, v63
    v_accvgpr_write_b32 a152, v48
    v_accvgpr_write_b32 a153, v49
    v_accvgpr_write_b32 a154, v50
    v_accvgpr_write_b32 a155, v51
    v_accvgpr_write_b32 a156, v52
    v_accvgpr_write_b32 a157, v53
    v_accvgpr_write_b32 a158, v54
    v_accvgpr_write_b32 a159, v55
    v_mul_f32 v64, s25, v64
    v_mul_f32 v65, s25, v65
    v_mul_f32 v66, s25, v66
    v_mul_f32 v67, s25, v67
    v_mul_f32 v68, s25, v68
    v_mul_f32 v69, s25, v69
    v_mul_f32 v70, s25, v70
    v_mul_f32 v71, s25, v71
    v_mul_f32 v72, s25, v72
    v_mul_f32 v73, s25, v73
    v_mul_f32 v74, s25, v74
    v_mul_f32 v75, s25, v75
    v_mul_f32 v76, s25, v76
    v_mul_f32 v77, s25, v77
    v_mul_f32 v78, s25, v78
    v_mul_f32 v79, s25, v79
    v_cvt_pk_bf16_f32 v64, v64, v65
    v_cvt_pk_bf16_f32 v65, v66, v67
    v_cvt_pk_bf16_f32 v66, v68, v69
    v_cvt_pk_bf16_f32 v67, v70, v71
    v_cvt_pk_bf16_f32 v68, v72, v73
    v_cvt_pk_bf16_f32 v69, v74, v75
    v_cvt_pk_bf16_f32 v70, v76, v77
    v_cvt_pk_bf16_f32 v71, v78, v79
    v_accvgpr_write_b32 a160, v64
    v_accvgpr_write_b32 a161, v65
    v_accvgpr_write_b32 a162, v66
    v_accvgpr_write_b32 a163, v67
    v_accvgpr_write_b32 a164, v68
    v_accvgpr_write_b32 a165, v69
    v_accvgpr_write_b32 a166, v70
    v_accvgpr_write_b32 a167, v71
    v_mul_f32 v80, s25, v80
    v_mul_f32 v81, s25, v81
    v_mul_f32 v82, s25, v82
    v_mul_f32 v83, s25, v83
    v_mul_f32 v84, s25, v84
    v_mul_f32 v85, s25, v85
    v_mul_f32 v86, s25, v86
    v_mul_f32 v87, s25, v87
    v_mul_f32 v88, s25, v88
    v_mul_f32 v89, s25, v89
    v_mul_f32 v90, s25, v90
    v_mul_f32 v91, s25, v91
    v_mul_f32 v92, s25, v92
    v_mul_f32 v93, s25, v93
    v_mul_f32 v94, s25, v94
    v_mul_f32 v95, s25, v95
    v_cvt_pk_bf16_f32 v80, v80, v81
    v_cvt_pk_bf16_f32 v81, v82, v83
    v_cvt_pk_bf16_f32 v82, v84, v85
    v_cvt_pk_bf16_f32 v83, v86, v87
    v_cvt_pk_bf16_f32 v84, v88, v89
    v_cvt_pk_bf16_f32 v85, v90, v91
    v_cvt_pk_bf16_f32 v86, v92, v93
    v_cvt_pk_bf16_f32 v87, v94, v95
    v_accvgpr_write_b32 a168, v80
    v_accvgpr_write_b32 a169, v81
    v_accvgpr_write_b32 a170, v82
    v_accvgpr_write_b32 a171, v83
    v_accvgpr_write_b32 a172, v84
    v_accvgpr_write_b32 a173, v85
    v_accvgpr_write_b32 a174, v86
    v_accvgpr_write_b32 a175, v87
    v_mul_f32 v96, s25, v96
    v_mul_f32 v97, s25, v97
    v_mul_f32 v98, s25, v98
    v_mul_f32 v99, s25, v99
    v_mul_f32 v100, s25, v100
    v_mul_f32 v101, s25, v101
    v_mul_f32 v102, s25, v102
    v_mul_f32 v103, s25, v103
    v_mul_f32 v104, s25, v104
    v_mul_f32 v105, s25, v105
    v_mul_f32 v106, s25, v106
    v_mul_f32 v107, s25, v107
    v_mul_f32 v108, s25, v108
    v_mul_f32 v109, s25, v109
    v_mul_f32 v110, s25, v110
    v_mul_f32 v111, s25, v111
    v_cvt_pk_bf16_f32 v96, v96, v97
    v_cvt_pk_bf16_f32 v97, v98, v99
    v_cvt_pk_bf16_f32 v98, v100, v101
    v_cvt_pk_bf16_f32 v99, v102, v103
    v_cvt_pk_bf16_f32 v100, v104, v105
    v_cvt_pk_bf16_f32 v101, v106, v107
    v_cvt_pk_bf16_f32 v102, v108, v109
    v_cvt_pk_bf16_f32 v103, v110, v111
    v_accvgpr_write_b32 a176, v96
    v_accvgpr_write_b32 a177, v97
    v_accvgpr_write_b32 a178, v98
    v_accvgpr_write_b32 a179, v99
    v_accvgpr_write_b32 a180, v100
    v_accvgpr_write_b32 a181, v101
    v_accvgpr_write_b32 a182, v102
    v_accvgpr_write_b32 a183, v103
    v_mul_f32 v112, s25, v112
    v_mul_f32 v113, s25, v113
    v_mul_f32 v114, s25, v114
    v_mul_f32 v115, s25, v115
    v_mul_f32 v116, s25, v116
    v_mul_f32 v117, s25, v117
    v_mul_f32 v118, s25, v118
    v_mul_f32 v119, s25, v119
    v_mul_f32 v120, s25, v120
    v_mul_f32 v121, s25, v121
    v_mul_f32 v122, s25, v122
    v_mul_f32 v123, s25, v123
    v_mul_f32 v124, s25, v124
    v_mul_f32 v125, s25, v125
    v_mul_f32 v126, s25, v126
    v_mul_f32 v127, s25, v127
    v_cvt_pk_bf16_f32 v112, v112, v113
    v_cvt_pk_bf16_f32 v113, v114, v115
    v_cvt_pk_bf16_f32 v114, v116, v117
    v_cvt_pk_bf16_f32 v115, v118, v119
    v_cvt_pk_bf16_f32 v116, v120, v121
    v_cvt_pk_bf16_f32 v117, v122, v123
    v_cvt_pk_bf16_f32 v118, v124, v125
    v_cvt_pk_bf16_f32 v119, v126, v127
    v_accvgpr_write_b32 a184, v112
    v_accvgpr_write_b32 a185, v113
    v_accvgpr_write_b32 a186, v114
    v_accvgpr_write_b32 a187, v115
    v_accvgpr_write_b32 a188, v116
    v_accvgpr_write_b32 a189, v117
    v_accvgpr_write_b32 a190, v118
    v_accvgpr_write_b32 a191, v119
    s_waitcnt lgkmcnt(7)
    ds_read_b128 a[252:255], v241 offset:15360
    v_mov_b32 v64, 0
    v_mov_b32 v65, 0
    v_mov_b32 v66, 0
    v_mov_b32 v67, 0
    v_mov_b32 v68, 0
    v_mov_b32 v69, 0
    v_mov_b32 v70, 0
    v_mov_b32 v71, 0
    v_mov_b32 v72, 0
    v_mov_b32 v73, 0
    v_mov_b32 v74, 0
    v_mov_b32 v75, 0
    v_mov_b32 v76, 0
    v_mov_b32 v77, 0
    v_mov_b32 v78, 0
    v_mov_b32 v79, 0
    v_mov_b32 v144, 0
    v_mov_b32 v142, 0
    v_mov_b32 v140, 0
    v_mov_b32 v80, 0
    v_mov_b32 v81, 0
    v_mov_b32 v82, 0
    v_mov_b32 v83, 0
    v_mov_b32 v84, 0
    v_mov_b32 v85, 0
    v_mov_b32 v86, 0
    v_mov_b32 v87, 0
    v_mov_b32 v88, 0
    v_mov_b32 v89, 0
    v_mov_b32 v90, 0
    v_mov_b32 v91, 0
    v_mov_b32 v92, 0
    v_mov_b32 v93, 0
    v_mov_b32 v94, 0
    v_mov_b32 v95, 0
    v_mov_b32 v145, 0
    v_mov_b32 v143, 0
    v_mov_b32 v141, 0
    s_sub_u32 s36, 0, s6
    s_sub_u32 s36, s36, 1
    s_add_u32 s36, s36, 1
    s_cmp_le_u32 s36, 1
    s_cbranch_scc1 k2_fix1
k2_fixr2:
    s_waitcnt lgkmcnt(8)
    v_mfma_f32_32x32x16_bf16 v[0:15], a[192:195], a[128:131], v[64:79]
    v_mfma_f32_32x32x16_bf16 v[16:31], a[192:195], a[160:163], v[80:95]
    v_mfma_f32_32x32x16_bf16 v[0:15], a[196:199], a[132:135], v[0:15]
    v_mfma_f32_32x32x16_bf16 v[16:31], a[196:199], a[164:167], v[16:31]
    v_mfma_f32_32x32x16_bf16 v[0:15], a[200:203], a[136:139], v[0:15]
    v_mfma_f32_32x32x16_bf16 v[16:31], a[200:203], a[168:171], v[16:31]
    v_mfma_f32_32x32x16_bf16 v[0:15], a[204:207], a[140:143], v[0:15]
    v_mfma_f32_32x32x16_bf16 v[16:31], a[204:207], a[172:175], v[16:31]
    v_mfma_f32_32x32x16_bf16 v[0:15], a[208:211], a[144:147], v[0:15]
    v_mfma_f32_32x32x16_bf16 v[16:31], a[208:211], a[176:179], v[16:31]
    v_mfma_f32_32x32x16_bf16 v[0:15], a[212:215], a[148:151], v[0:15]
    v_mfma_f32_32x32x16_bf16 v[16:31], a[212:215], a[180:183], v[16:31]
    v_mfma_f32_32x32x16_bf16 v[0:15], a[216:219], a[152:155], v[0:15]
    v_mfma_f32_32x32x16_bf16 v[16:31], a[216:219], a[184:187], v[16:31]
    v_mfma_f32_32x32x16_bf16 v[0:15], a[220:223], a[156:159], v[0:15]
    v_mfma_f32_32x32x16_bf16 v[16:31], a[220:223], a[188:191], v[16:31]
    s_nop 15
    v_max3_f32 v146, v0, v1, v2
    v_max3_f32 v146, v146, v3, v4
    v_max3_f32 v146, v146, v5, v6
    v_max3_f32 v146, v146, v7, v8
    v_max3_f32 v146, v146, v9, v10
    v_max3_f32 v146, v146, v11, v12
    v_max3_f32 v146, v146, v13, v14
    v_max_f32 v146, v146, v15
    v_mov_b32 v147, v146
    s_nop 1
    v_permlane32_swap_b32 v146, v147
    s_nop 0
    v_max_f32 v146, v146, v147
    v_sub_f32 v144, 0, v146
    v_sub_f32 v0, v0, v146
    v_sub_f32 v64, v64, v146
    v_sub_f32 v1, v1, v146
    v_sub_f32 v65, v65, v146
    v_sub_f32 v2, v2, v146
    v_sub_f32 v66, v66, v146
    v_sub_f32 v3, v3, v146
    v_sub_f32 v67, v67, v146
    v_sub_f32 v4, v4, v146
    v_sub_f32 v68, v68, v146
    v_sub_f32 v5, v5, v146
    v_sub_f32 v69, v69, v146
    v_sub_f32 v6, v6, v146
    v_sub_f32 v70, v70, v146
    v_sub_f32 v7, v7, v146
    v_sub_f32 v71, v71, v146
    v_sub_f32 v8, v8, v146
    v_sub_f32 v72, v72, v146
    v_sub_f32 v9, v9, v146
    v_sub_f32 v73, v73, v146
    v_sub_f32 v10, v10, v146
    v_sub_f32 v74, v74, v146
    v_sub_f32 v11, v11, v146
    v_sub_f32 v75, v75, v146
    v_sub_f32 v12, v12, v146
    v_sub_f32 v76, v76, v146
    v_sub_f32 v13, v13, v146
    v_sub_f32 v77, v77, v146
    v_sub_f32 v14, v14, v146
    v_sub_f32 v78, v78, v146
    v_sub_f32 v15, v15, v146
    v_sub_f32 v79, v79, v146
    v_max3_f32 v146, v16, v17, v18
    v_max3_f32 v146, v146, v19, v20
    v_max3_f32 v146, v146, v21, v22
    v_max3_f32 v146, v146, v23, v24
    v_max3_f32 v146, v146, v25, v26
    v_max3_f32 v146, v146, v27, v28
    v_max3_f32 v146, v146, v29, v30
    v_max_f32 v146, v146, v31
    v_mov_b32 v147, v146
    s_nop 1
    v_permlane32_swap_b32 v146, v147
    s_nop 0
    v_max_f32 v146, v146, v147
    v_sub_f32 v145, 0, v146
    v_sub_f32 v16, v16, v146
    v_sub_f32 v80, v80, v146
    v_sub_f32 v17, v17, v146
    v_sub_f32 v81, v81, v146
    v_sub_f32 v18, v18, v146
    v_sub_f32 v82, v82, v146
    v_sub_f32 v19, v19, v146
    v_sub_f32 v83, v83, v146
    v_sub_f32 v20, v20, v146
    v_sub_f32 v84, v84, v146
    v_sub_f32 v21, v21, v146
    v_sub_f32 v85, v85, v146
    v_sub_f32 v22, v22, v146
    v_sub_f32 v86, v86, v146
    v_sub_f32 v23, v23, v146
    v_sub_f32 v87, v87, v146
    v_sub_f32 v24, v24, v146
    v_sub_f32 v88, v88, v146
    v_sub_f32 v25, v25, v146
    v_sub_f32 v89, v89, v146
    v_sub_f32 v26, v26, v146
    v_sub_f32 v90, v90, v146
    v_sub_f32 v27, v27, v146
    v_sub_f32 v91, v91, v146
    v_sub_f32 v28, v28, v146
    v_sub_f32 v92, v92, v146
    v_sub_f32 v29, v29, v146
    v_sub_f32 v93, v93, v146
    v_sub_f32 v30, v30, v146
    v_sub_f32 v94, v94, v146
    v_sub_f32 v31, v31, v146
    v_sub_f32 v95, v95, v146
    s_waitcnt lgkmcnt(0)
    s_mov_b32 s35, 32768
    v_add_u32 v241, s35, v240
    s_nop 0
    s_add_u32 s36, s36, 1
    s_cmp_le_u32 s36, 1
    s_cbranch_scc1 k2_fix3
k2_fixr4:
    v_mfma_f32_32x32x16_bf16 v[32:47], a[224:227], a[128:131], v[64:79]
    ds_read_b128 a[192:195], v241 offset:0
    v_exp_f32 v136, v0
    v_exp_f32 v137, v1
    v_exp_f32 v130, v2
    v_mfma_f32_32x32x16_bf16 v[48:63], a[224:227], a[160:163], v[80:95]
    v_exp_f32 v131, v3
    v_cvt_pk_bf16_f32 v96, v136, v137
    v_exp_f32 v132, v4
    v_exp_f32 v133, v5
    v_cvt_pk_bf16_f32 v97, v130, v131
    v_add_f32 v136, v136, v130
    v_mfma_f32_32x32x16_bf16 v[32:47], a[228:231], a[132:135], v[32:47]
    ds_read_b128 a[196:199], v241 offset:1024
    v_add_f32 v137, v137, v131
    v_exp_f32 v134, v6
    v_exp_f32 v135, v7
    v_cvt_pk_bf16_f32 v98, v132, v133
    v_mfma_f32_32x32x16_bf16 v[48:63], a[228:231], a[164:167], v[48:63]
    v_add_f32 v136, v136, v132
    v_add_f32 v137, v137, v133
    v_exp_f32 v128, v8
    v_exp_f32 v129, v9
    v_cvt_pk_bf16_f32 v99, v134, v135
    v_add_f32 v136, v136, v134
    v_add_f32 v137, v137, v135
    v_mfma_f32_32x32x16_bf16 v[32:47], a[232:235], a[136:139], v[32:47]
    ds_read_b128 a[200:203], v241 offset:2048
    v_exp_f32 v130, v10
    v_exp_f32 v131, v11
    v_cvt_pk_bf16_f32 v100, v128, v129
    v_add_f32 v136, v136, v128
    v_mfma_f32_32x32x16_bf16 v[48:63], a[232:235], a[168:171], v[48:63]
    v_add_f32 v137, v137, v129
    v_exp_f32 v132, v12
    v_exp_f32 v133, v13
    v_cvt_pk_bf16_f32 v101, v130, v131
    v_add_f32 v136, v136, v130
    v_add_f32 v137, v137, v131
    v_mfma_f32_32x32x16_bf16 v[32:47], a[236:239], a[140:143], v[32:47]
    ds_read_b128 a[204:207], v241 offset:3072
    v_exp_f32 v134, v14
    v_exp_f32 v135, v15
    v_cvt_pk_bf16_f32 v102, v132, v133
    v_add_f32 v136, v136, v132
    v_add_f32 v137, v137, v133
    v_mfma_f32_32x32x16_bf16 v[48:63], a[236:239], a[172:175], v[48:63]
    v_exp_f32 v138, v16
    v_exp_f32 v139, v17
    v_cvt_pk_bf16_f32 v103, v134, v135
    v_add_f32 v136, v136, v134
    v_add_f32 v137, v137, v135
    v_add_f32 v140, v136, v137
    v_mfma_f32_32x32x16_bf16 v[32:47], a[240:243], a[144:147], v[32:47]
    ds_read_b128 a[208:211], v241 offset:4096
    v_exp_f32 v130, v18
    v_exp_f32 v131, v19
    v_cvt_pk_bf16_f32 v104, v138, v139
    v_exp_f32 v132, v20
    v_mfma_f32_32x32x16_bf16 v[48:63], a[240:243], a[176:179], v[48:63]
    v_exp_f32 v133, v21
    v_cvt_pk_bf16_f32 v105, v130, v131
    v_add_f32 v138, v138, v130
    v_add_f32 v139, v139, v131
    v_exp_f32 v134, v22
    v_mfma_f32_32x32x16_bf16 v[32:47], a[244:247], a[148:151], v[32:47]
    ds_read_b128 a[212:215], v241 offset:5120
    v_exp_f32 v135, v23
    v_cvt_pk_bf16_f32 v106, v132, v133
    v_add_f32 v138, v138, v132
    v_add_f32 v139, v139, v133
    v_exp_f32 v128, v24
    v_mfma_f32_32x32x16_bf16 v[48:63], a[244:247], a[180:183], v[48:63]
    v_exp_f32 v129, v25
    v_cvt_pk_bf16_f32 v107, v134, v135
    v_add_f32 v138, v138, v134
    v_add_f32 v139, v139, v135
    v_exp_f32 v130, v26
    v_exp_f32 v131, v27
    v_mfma_f32_32x32x16_bf16 v[32:47], a[248:251], a[152:155], v[32:47]
    ds_read_b128 a[216:219], v241 offset:6144
    v_cvt_pk_bf16_f32 v108, v128, v129
    v_add_f32 v138, v138, v128
    v_add_f32 v139, v139, v129
    v_exp_f32 v132, v28
    v_exp_f32 v133, v29
    v_mfma_f32_32x32x16_bf16 v[48:63], a[248:251], a[184:187], v[48:63]
    v_cvt_pk_bf16_f32 v109, v130, v131
    v_add_f32 v138, v138, v130
    v_add_f32 v139, v139, v131
    v_exp_f32 v134, v30
    v_exp_f32 v135, v31
    v_mfma_f32_32x32x16_bf16 v[32:47], a[252:255], a[156:159], v[32:47]
    ds_read_b128 a[220:223], v241 offset:7168
    v_cvt_pk_bf16_f32 v110, v132, v133
    v_add_f32 v138, v138, v132
    v_add_f32 v139, v139, v133
    v_cvt_pk_bf16_f32 v111, v134, v135
    v_add_f32 v138, v138, v134
    v_add_f32 v139, v139, v135
    v_add_f32 v141, v138, v139
    v_mfma_f32_32x32x16_bf16 v[48:63], a[252:255], a[188:191], v[48:63]
    s_lshl1_add_u32 s26, s5, 1
.p2align 3
k2_p1:
    s_add_u32 s36, s36, 1
    s_cmp_le_u32 s36, 1
    s_cbranch_scc1 k2_fix5
k2_fixr6:
    s_waitcnt lgkmcnt(6)
    v_mfma_f32_32x32x16_bf16 v[0:15], a[192:195], a[128:131], v[64:79]
    ds_read_b128 a[224:227], v241 offset:16384
    v_add_f32 v142, v142, v140
    v_add_f32 v143, v143, v141
    v_exp_f32 v136, v32
    v_mfma_f32_32x32x16_bf16 v[16:31], a[192:195], a[160:163], v[80:95]
    s_cmp_lt_u32 s32, s33
    s_cselect_b32 s41, s32, s43
    s_mov_b32 m0, s34
    s_nop 0
    v_exp_f32 v137, v33
    v_mfma_f32_32x32x16_bf16 v[0:15], a[196:199], a[132:135], v[0:15]
    ds_read_b128 a[228:231], v241 offset:17408
    v_exp_f32 v130, v34
    v_mfma_f32_32x32x16_bf16 v[16:31], a[196:199], a[164:167], v[16:31]
    v_exp_f32 v131, v35
    v_cvt_pk_bf16_f32 v112, v136, v137
    v_exp_f32 v132, v36
    s_waitcnt lgkmcnt(6)
    v_mfma_f32_32x32x16_bf16 v[0:15], a[200:203], a[136:139], v[0:15]
    ds_read_b128 a[232:235], v241 offset:18432
    v_exp_f32 v133, v37
    v_cvt_pk_bf16_f32 v113, v130, v131
    v_mfma_f32_32x32x16_bf16 v[16:31], a[200:203], a[168:171], v[16:31]
    v_add_f32 v136, v136, v130
    v_add_f32 v137, v137, v131
    v_exp_f32 v134, v38
    v_mfma_f32_32x32x16_bf16 v[0:15], a[204:207], a[140:143], v[0:15]
    ds_read_b128 a[236:239], v241 offset:19456
    v_exp_f32 v135, v39
    v_cvt_pk_bf16_f32 v114, v132, v133
    v_add_f32 v136, v136, v132
    v_mfma_f32_32x32x16_bf16 v[16:31], a[204:207], a[172:175], v[16:31]
    buffer_load_dwordx4 v242, s[16:19], s41 offen offset:0 lds
    v_add_f32 v137, v137, v133
    v_exp_f32 v128, v40
    s_waitcnt lgkmcnt(6)
    v_mfma_f32_32x32x16_bf16 v[0:15], a[208:211], a[144:147], v[0:15]
    ds_read_b128 a[240:243], v241 offset:20480
    v_exp_f32 v129, v41
    v_cvt_pk_bf16_f32 v115, v134, v135
    v_add_f32 v136, v136, v134
    v_mfma_f32_32x32x16_bf16 v[16:31], a[208:211], a[176:179], v[16:31]
    v_add_f32 v137, v137, v135
    v_exp_f32 v130, v42
    v_exp_f32 v131, v43
    v_mfma_f32_32x32x16_bf16 v[0:15], a[212:215], a[148:151], v[0:15]
    ds_read_b128 a[244:247], v241 offset:21504
    v_cvt_pk_bf16_f32 v116, v128, v129
    v_add_f32 v136, v136, v128
    v_add_f32 v137, v137, v129
    v_mfma_f32_32x32x16_bf16 v[16:31], a[212:215], a[180:183], v[16:31]
    v_exp_f32 v132, v44
    v_exp_f32 v133, v45
    s_waitcnt lgkmcnt(6)
    v_mfma_f32_32x32x16_bf16 v[0:15], a[216:219], a[152:155], v[0:15]
    ds_read_b128 a[248:251], v241 offset:22528
    v_cvt_pk_bf16_f32 v117, v130, v131
    v_add_f32 v136, v136, v130
    v_add_f32 v137, v137, v131
    v_mfma_f32_32x32x16_bf16 v[16:31], a[216:219], a[184:187], v[16:31]
    buffer_load_dwordx4 v242, s[16:19], s41 offen offset:1024 lds
    v_exp_f32 v134, v46
    v_exp_f32 v135, v47
    v_mfma_f32_32x32x16_bf16 v[0:15], a[220:223], a[156:159], v[0:15]
    ds_read_b128 a[252:255], v241 offset:23552
    v_cvt_pk_bf16_f32 v118, v132, v133
    v_add_f32 v136, v136, v132
    v_add_f32 v137, v137, v133
    v_mfma_f32_32x32x16_bf16 v[16:31], a[220:223], a[188:191], v[16:31]
    v_exp_f32 v138, v48
    v_exp_f32 v139, v49
    s_waitcnt lgkmcnt(6)
    v_mfma_f32_32x32x16_bf16 a[0:15], a[224:227], v[96:99], a[0:15]
    ds_read_b128 a[192:195], v241 offset:8192
    v_cvt_pk_bf16_f32 v119, v134, v135
    v_add_f32 v136, v136, v134
    v_add_f32 v137, v137, v135
    v_add_f32 v140, v136, v137
    v_mfma_f32_32x32x16_bf16 a[64:79], a[224:227], v[104:107], a[64:79]
    v_exp_f32 v130, v50
    v_exp_f32 v131, v51
    v_mfma_f32_32x32x16_bf16 a[16:31], a[228:231], v[96:99], a[16:31]
    ds_read_b128 a[196:199], v241 offset:9216
    v_cvt_pk_bf16_f32 v120, v138, v139
    v_exp_f32 v132, v52
    v_exp_f32 v133, v53
    v_mfma_f32_32x32x16_bf16 a[80:95], a[228:231], v[104:107], a[80:95]
    buffer_load_dwordx4 v242, s[16:19], s41 offen offset:2048 lds
    v_cvt_pk_bf16_f32 v121, v130, v131
    v_add_f32 v138, v138, v130
    s_waitcnt lgkmcnt(6)
    v_mfma_f32_32x32x16_bf16 a[32:47], a[232:235], v[96:99], a[32:47]
    ds_read_b128 a[200:203], v241 offset:10240
    v_add_f32 v139, v139, v131
    v_exp_f32 v134, v54
    v_mfma_f32_32x32x16_bf16 a[96:111], a[232:235], v[104:107], a[96:111]
    v_exp_f32 v135, v55
    v_cvt_pk_bf16_f32 v122, v132, v133
    v_add_f32 v138, v138, v132
    v_add_f32 v139, v139, v133
    v_mfma_f32_32x32x16_bf16 a[48:63], a[236:239], v[96:99], a[48:63]
    ds_read_b128 a[204:207], v241 offset:11264
    v_exp_f32 v128, v56
    v_exp_f32 v129, v57
    v_mfma_f32_32x32x16_bf16 a[112:127], a[236:239], v[104:107], a[112:127]
    v_cvt_pk_bf16_f32 v123, v134, v135
    v_add_f32 v138, v138, v134
    v_add_f32 v139, v139, v135
    s_waitcnt lgkmcnt(6)
    v_mfma_f32_32x32x16_bf16 a[0:15], a[240:243], v[100:103], a[0:15]
    ds_read_b128 a[208:211], v241 offset:12288
    v_exp_f32 v130, v58
    v_exp_f32 v131, v59
    v_mfma_f32_32x32x16_bf16 a[64:79], a[240:243], v[108:111], a[64:79]
    buffer_load_dwordx4 v242, s[16:19], s41 offen offset:3072 lds
    v_cvt_pk_bf16_f32 v124, v128, v129
    v_add_f32 v138, v138, v128
    v_add_f32 v139, v139, v129
    v_mfma_f32_32x32x16_bf16 a[16:31], a[244:247], v[100:103], a[16:31]
    ds_read_b128 a[212:215], v241 offset:13312
    v_exp_f32 v132, v60
    v_exp_f32 v133, v61
    v_cvt_pk_bf16_f32 v125, v130, v131
    v_mfma_f32_32x32x16_bf16 a[80:95], a[244:247], v[108:111], a[80:95]
    v_add_f32 v138, v138, v130
    v_add_f32 v139, v139, v131
    v_exp_f32 v134, v62
    s_waitcnt lgkmcnt(6)
    v_mfma_f32_32x32x16_bf16 a[32:47], a[248:251], v[100:103], a[32:47]
    ds_read_b128 a[216:219], v241 offset:14336
    v_exp_f32 v135, v63
    v_cvt_pk_bf16_f32 v126, v132, v133
    v_mfma_f32_32x32x16_bf16 a[96:111], a[248:251], v[108:111], a[96:111]
    v_add_f32 v138, v138, v132
    v_add_f32 v139, v139, v133
    v_cvt_pk_bf16_f32 v127, v134, v135
    v_add_f32 v138, v138, v134
    v_mfma_f32_32x32x16_bf16 a[48:63], a[252:255], v[100:103], a[48:63]
    ds_read_b128 a[220:223], v241 offset:15360
    v_add_f32 v139, v139, v135
    v_add_f32 v141, v138, v139
    v_max_f32 v146, v140, v141
    v_cmp_lt_f32 vcc, s38, v146
    v_mfma_f32_32x32x16_bf16 a[112:127], a[252:255], v[108:111], a[112:127]
    s_cbranch_vccnz k2_rare8
k2_rr7:
    s_add_u32 s36, s36, 1
    s_cmp_le_u32 s36, 1
    s_cbranch_scc1 k2_fix9
k2_fixr10:
    s_waitcnt lgkmcnt(6)
    v_mfma_f32_32x32x16_bf16 v[32:47], a[192:195], a[128:131], v[64:79]
    ds_read_b128 a[224:227], v241 offset:24576
    v_add_f32 v142, v142, v140
    v_add_f32 v143, v143, v141
    v_exp_f32 v136, v0
    v_mfma_f32_32x32x16_bf16 v[48:63], a[192:195], a[160:163], v[80:95]
    s_sub_u32 s42, s32, 16384
    s_cmp_lt_u32 s42, s33
    s_cselect_b32 s42, s42, s43
    s_add_u32 m0, s34, 16384
    s_nop 0
    v_mfma_f32_32x32x16_bf16 v[32:47], a[196:199], a[132:135], v[32:47]
    ds_read_b128 a[228:231], v241 offset:25600
    v_exp_f32 v137, v1
    v_exp_f32 v130, v2
    v_mfma_f32_32x32x16_bf16 v[48:63], a[196:199], a[164:167], v[48:63]
    v_exp_f32 v131, v3
    v_cvt_pk_bf16_f32 v96, v136, v137
    v_exp_f32 v132, v4
    s_waitcnt lgkmcnt(6)
    v_mfma_f32_32x32x16_bf16 v[32:47], a[200:203], a[136:139], v[32:47]
    ds_read_b128 a[232:235], v241 offset:26624
    v_exp_f32 v133, v5
    v_cvt_pk_bf16_f32 v97, v130, v131
    v_add_f32 v136, v136, v130
    v_mfma_f32_32x32x16_bf16 v[48:63], a[200:203], a[168:171], v[48:63]
    v_add_f32 v137, v137, v131
    v_exp_f32 v134, v6
    v_exp_f32 v135, v7
    v_mfma_f32_32x32x16_bf16 v[32:47], a[204:207], a[140:143], v[32:47]
    ds_read_b128 a[236:239], v241 offset:27648
    buffer_load_dwordx4 v242, s[16:19], s42 offen offset:0 lds
    v_cvt_pk_bf16_f32 v98, v132, v133
    v_add_f32 v136, v136, v132
    v_mfma_f32_32x32x16_bf16 v[48:63], a[204:207], a[172:175], v[48:63]
    v_add_f32 v137, v137, v133
    v_exp_f32 v128, v8
    v_exp_f32 v129, v9
    s_waitcnt lgkmcnt(6)
    v_mfma_f32_32x32x16_bf16 v[32:47], a[208:211], a[144:147], v[32:47]
    ds_read_b128 a[240:243], v241 offset:28672
    v_cvt_pk_bf16_f32 v99, v134, v135
    v_add_f32 v136, v136, v134
    v_add_f32 v137, v137, v135
    v_mfma_f32_32x32x16_bf16 v[48:63], a[208:211], a[176:179], v[48:63]
    v_exp_f32 v130, v10
    v_exp_f32 v131, v11
    v_cvt_pk_bf16_f32 v100, v128, v129
    v_mfma_f32_32x32x16_bf16 v[32:47], a[212:215], a[148:151], v[32:47]
    ds_read_b128 a[244:247], v241 offset:29696
    v_add_f32 v136, v136, v128
    v_add_f32 v137, v137, v129
    v_exp_f32 v132, v12
    v_mfma_f32_32x32x16_bf16 v[48:63], a[212:215], a[180:183], v[48:63]
    buffer_load_dwordx4 v242, s[16:19], s42 offen offset:1024 lds
    v_exp_f32 v133, v13
    v_cvt_pk_bf16_f32 v101, v130, v131
    s_waitcnt lgkmcnt(6)
    v_mfma_f32_32x32x16_bf16 v[32:47], a[216:219], a[152:155], v[32:47]
    ds_read_b128 a[248:251], v241 offset:30720
    v_add_f32 v136, v136, v130
    v_add_f32 v137, v137, v131
    v_exp_f32 v134, v14
    v_mfma_f32_32x32x16_bf16 v[48:63], a[216:219], a[184:187], v[48:63]
    v_exp_f32 v135, v15
    v_cvt_pk_bf16_f32 v102, v132, v133
    v_add_f32 v136, v136, v132
    v_add_f32 v137, v137, v133
    v_mfma_f32_32x32x16_bf16 v[32:47], a[220:223], a[156:159], v[32:47]
    ds_read_b128 a[252:255], v241 offset:31744
    v_exp_f32 v138, v16
    v_exp_f32 v139, v17
    v_mfma_f32_32x32x16_bf16 v[48:63], a[220:223], a[188:191], v[48:63]
    v_cvt_pk_bf16_f32 v103, v134, v135
    v_add_f32 v136, v136, v134
    v_add_f32 v137, v137, v135
    v_add_f32 v140, v136, v137
    s_waitcnt lgkmcnt(6)
    v_mfma_f32_32x32x16_bf16 a[0:15], a[224:227], v[112:115], a[0:15]
    s_waitcnt vmcnt(14)
    s_barrier
    s_add_u32 s35, s35, 32768
    s_cmp_ge_u32 s35, 163840
    s_cselect_b32 s25, 0, s35
    s_mov_b32 s35, s25
    v_add_u32 v241, s35, v240
    ds_read_b128 a[192:195], v241 offset:0
    buffer_load_dwordx4 v242, s[16:19], s42 offen offset:2048 lds
    v_mfma_f32_32x32x16_bf16 a[64:79], a[224:227], v[120:123], a[64:79]
    v_exp_f32 v130, v18
    v_exp_f32 v131, v19
    v_mfma_f32_32x32x16_bf16 a[16:31], a[228:231], v[112:115], a[16:31]
    ds_read_b128 a[196:199], v241 offset:1024
    v_cvt_pk_bf16_f32 v104, v138, v139
    v_exp_f32 v132, v20
    v_exp_f32 v133, v21
    v_mfma_f32_32x32x16_bf16 a[80:95], a[228:231], v[120:123], a[80:95]
    v_cvt_pk_bf16_f32 v105, v130, v131
    v_add_f32 v138, v138, v130
    v_add_f32 v139, v139, v131
    s_waitcnt lgkmcnt(6)
    v_mfma_f32_32x32x16_bf16 a[32:47], a[232:235], v[112:115], a[32:47]
    ds_read_b128 a[200:203], v241 offset:2048
    v_exp_f32 v134, v22
    v_exp_f32 v135, v23
    v_mfma_f32_32x32x16_bf16 a[96:111], a[232:235], v[120:123], a[96:111]
    buffer_load_dwordx4 v242, s[16:19], s42 offen offset:3072 lds
    v_cvt_pk_bf16_f32 v106, v132, v133
    v_add_f32 v138, v138, v132
    v_add_f32 v139, v139, v133
    v_mfma_f32_32x32x16_bf16 a[48:63], a[236:239], v[112:115], a[48:63]
    ds_read_b128 a[204:207], v241 offset:3072
    v_exp_f32 v128, v24
    v_exp_f32 v129, v25
    v_cvt_pk_bf16_f32 v107, v134, v135
    v_mfma_f32_32x32x16_bf16 a[112:127], a[236:239], v[120:123], a[112:127]
    v_add_f32 v138, v138, v134
    v_add_f32 v139, v139, v135
    v_exp_f32 v130, v26
    s_waitcnt lgkmcnt(6)
    v_mfma_f32_32x32x16_bf16 a[0:15], a[240:243], v[116:119], a[0:15]
    ds_read_b128 a[208:211], v241 offset:4096
    v_exp_f32 v131, v27
    v_cvt_pk_bf16_f32 v108, v128, v129
    v_add_f32 v138, v138, v128
    v_mfma_f32_32x32x16_bf16 a[64:79], a[240:243], v[124:127], a[64:79]
    v_add_f32 v139, v139, v129
    v_exp_f32 v132, v28
    v_exp_f32 v133, v29
    v_mfma_f32_32x32x16_bf16 a[16:31], a[244:247], v[116:119], a[16:31]
    ds_read_b128 a[212:215], v241 offset:5120
    s_add_u32 s32, s32, 32768
    s_add_u32 s34, s34, 32768
    s_cmp_ge_u32 s34, 163840
    s_cselect_b32 s24, 163840, 0
    s_sub_u32 s34, s34, s24
    v_mfma_f32_32x32x16_bf16 a[80:95], a[244:247], v[124:127], a[80:95]
    v_cvt_pk_bf16_f32 v109, v130, v131
    v_add_f32 v138, v138, v130
    v_add_f32 v139, v139, v131
    s_waitcnt lgkmcnt(6)
    v_mfma_f32_32x32x16_bf16 a[32:47], a[248:251], v[116:119], a[32:47]
    ds_read_b128 a[216:219], v241 offset:6144
    v_exp_f32 v134, v30
    v_exp_f32 v135, v31
    v_mfma_f32_32x32x16_bf16 a[96:111], a[248:251], v[124:127], a[96:111]
    v_cvt_pk_bf16_f32 v110, v132, v133
    v_add_f32 v138, v138, v132
    v_add_f32 v139, v139, v133
    v_cvt_pk_bf16_f32 v111, v134, v135
    v_add_f32 v138, v138, v134
    v_mfma_f32_32x32x16_bf16 a[48:63], a[252:255], v[116:119], a[48:63]
    ds_read_b128 a[220:223], v241 offset:7168
    v_add_f32 v139, v139, v135
    v_add_f32 v141, v138, v139
    v_max_f32 v146, v140, v141
    v_cmp_lt_f32 vcc, s38, v146
    v_mfma_f32_32x32x16_bf16 a[112:127], a[252:255], v[124:127], a[112:127]
    s_cbranch_vccnz k2_rare12
k2_rr11:
    s_sub_u32 s26, s26, 1
    s_cmp_lg_u32 s26, 0
    s_cbranch_scc1 k2_p1
    s_lshl2_add_u32 s36, s5, s6
    s_sub_u32 s36, s36, 60
    s_add_u32 s36, s36, 1
    s_cmp_le_u32 s36, 1
    s_cbranch_scc1 k2_fix13
k2_fixr14:
    s_waitcnt lgkmcnt(6)
    v_mfma_f32_32x32x16_bf16 v[16:31], a[192:195], a[160:163], v[80:95]
    ds_read_b128 a[224:227], v241 offset:16384
    v_add_f32 v142, v142, v140
    v_add_f32 v143, v143, v141
    v_exp_f32 v136, v32
    v_exp_f32 v137, v33
    v_mfma_f32_32x32x16_bf16 v[16:31], a[196:199], a[164:167], v[16:31]
    ds_read_b128 a[228:231], v241 offset:17408
    s_cmp_lt_u32 s32, s33
    s_cselect_b32 s41, s32, s43
    s_mov_b32 m0, s34
    s_nop 0
    s_waitcnt lgkmcnt(6)
    v_mfma_f32_32x32x16_bf16 v[16:31], a[200:203], a[168:171], v[16:31]
    ds_read_b128 a[232:235], v241 offset:18432
    v_exp_f32 v130, v34
    v_exp_f32 v131, v35
    v_cvt_pk_bf16_f32 v112, v136, v137
    v_mfma_f32_32x32x16_bf16 v[16:31], a[204:207], a[172:175], v[16:31]
    ds_read_b128 a[236:239], v241 offset:19456
    v_exp_f32 v132, v36
    v_exp_f32 v133, v37
    s_waitcnt lgkmcnt(6)
    v_mfma_f32_32x32x16_bf16 v[16:31], a[208:211], a[176:179], v[16:31]
    ds_read_b128 a[240:243], v241 offset:20480
    v_cvt_pk_bf16_f32 v113, v130, v131
    v_add_f32 v136, v136, v130
    v_add_f32 v137, v137, v131
    v_exp_f32 v134, v38
    v_mfma_f32_32x32x16_bf16 v[16:31], a[212:215], a[180:183], v[16:31]
    ds_read_b128 a[244:247], v241 offset:21504
    buffer_load_dwordx4 v242, s[16:19], s41 offen offset:0 lds
    v_exp_f32 v135, v39
    v_cvt_pk_bf16_f32 v114, v132, v133
    s_waitcnt lgkmcnt(6)
    v_mfma_f32_32x32x16_bf16 v[16:31], a[216:219], a[184:187], v[16:31]
    ds_read_b128 a[248:251], v241 offset:22528
    v_add_f32 v136, v136, v132
    v_add_f32 v137, v137, v133
    v_exp_f32 v128, v40
    v_exp_f32 v129, v41
    v_mfma_f32_32x32x16_bf16 v[16:31], a[220:223], a[188:191], v[16:31]
    ds_read_b128 a[252:255], v241 offset:23552
    v_cvt_pk_bf16_f32 v115, v134, v135
    v_add_f32 v136, v136, v134
    v_add_f32 v137, v137, v135
    v_exp_f32 v130, v42
    s_waitcnt lgkmcnt(6)
    v_mfma_f32_32x32x16_bf16 a[0:15], a[224:227], v[96:99], a[0:15]
    ds_read_b128 a[192:195], v241 offset:8192
    v_exp_f32 v131, v43
    v_cvt_pk_bf16_f32 v116, v128, v129
    v_add_f32 v136, v136, v128
    v_mfma_f32_32x32x16_bf16 a[64:79], a[224:227], v[104:107], a[64:79]
    buffer_load_dwordx4 v242, s[16:19], s41 offen offset:1024 lds
    v_add_f32 v137, v137, v129
    v_exp_f32 v132, v44
    v_exp_f32 v133, v45
    v_cvt_pk_bf16_f32 v117, v130, v131
    v_mfma_f32_32x32x16_bf16 a[16:31], a[228:231], v[96:99], a[16:31]
    ds_read_b128 a[196:199], v241 offset:9216
    v_add_f32 v136, v136, v130
    v_add_f32 v137, v137, v131
    v_exp_f32 v134, v46
    v_exp_f32 v135, v47
    v_mfma_f32_32x32x16_bf16 a[80:95], a[228:231], v[104:107], a[80:95]
    v_cvt_pk_bf16_f32 v118, v132, v133
    v_add_f32 v136, v136, v132
    v_add_f32 v137, v137, v133
    v_exp_f32 v138, v48
    s_waitcnt lgkmcnt(6)
    v_mfma_f32_32x32x16_bf16 a[32:47], a[232:235], v[96:99], a[32:47]
    ds_read_b128 a[200:203], v241 offset:10240
    v_exp_f32 v139, v49
    v_cvt_pk_bf16_f32 v119, v134, v135
    v_add_f32 v136, v136, v134
    v_add_f32 v137, v137, v135
    v_mfma_f32_32x32x16_bf16 a[96:111], a[232:235], v[104:107], a[96:111]
    v_add_f32 v140, v136, v137
    v_exp_f32 v130, v50
    v_exp_f32 v131, v51
    v_cvt_pk_bf16_f32 v120, v138, v139
    v_mfma_f32_32x32x16_bf16 a[48:63], a[236:239], v[96:99], a[48:63]
    ds_read_b128 a[204:207], v241 offset:11264
    buffer_load_dwordx4 v242, s[16:19], s41 offen offset:2048 lds
    v_exp_f32 v132, v52
    v_exp_f32 v133, v53
    v_mfma_f32_32x32x16_bf16 a[112:127], a[236:239], v[104:107], a[112:127]
    v_cvt_pk_bf16_f32 v121, v130, v131
    v_add_f32 v138, v138, v130
    v_add_f32 v139, v139, v131
    v_exp_f32 v134, v54
    s_waitcnt lgkmcnt(6)
    v_mfma_f32_32x32x16_bf16 a[0:15], a[240:243], v[100:103], a[0:15]
    ds_read_b128 a[208:211], v241 offset:12288
    v_exp_f32 v135, v55
    v_cvt_pk_bf16_f32 v122, v132, v133
    v_add_f32 v138, v138, v132
    v_add_f32 v139, v139, v133
    v_mfma_f32_32x32x16_bf16 a[64:79], a[240:243], v[108:111], a[64:79]
    v_exp_f32 v128, v56
    v_exp_f32 v129, v57
    v_cvt_pk_bf16_f32 v123, v134, v135
    v_add_f32 v138, v138, v134
    v_add_f32 v139, v139, v135
    v_mfma_f32_32x32x16_bf16 a[16:31], a[244:247], v[100:103], a[16:31]
    ds_read_b128 a[212:215], v241 offset:13312
    buffer_load_dwordx4 v242, s[16:19], s41 offen offset:3072 lds
    v_exp_f32 v130, v58
    v_exp_f32 v131, v59
    v_cvt_pk_bf16_f32 v124, v128, v129
    v_mfma_f32_32x32x16_bf16 a[80:95], a[244:247], v[108:111], a[80:95]
    v_add_f32 v138, v138, v128
    v_add_f32 v139, v139, v129
    v_exp_f32 v132, v60
    s_waitcnt lgkmcnt(6)
    v_mfma_f32_32x32x16_bf16 a[32:47], a[248:251], v[100:103], a[32:47]
    ds_read_b128 a[216:219], v241 offset:14336
    v_exp_f32 v133, v61
    v_cvt_pk_bf16_f32 v125, v130, v131
    v_add_f32 v138, v138, v130
    v_add_f32 v139, v139, v131
    v_exp_f32 v134, v62
    v_mfma_f32_32x32x16_bf16 a[96:111], a[248:251], v[108:111], a[96:111]
    v_exp_f32 v135, v63
    v_cvt_pk_bf16_f32 v126, v132, v133
    v_add_f32 v138, v138, v132
    v_add_f32 v139, v139, v133
    v_cvt_pk_bf16_f32 v127, v134, v135
    v_mfma_f32_32x32x16_bf16 a[48:63], a[252:255], v[100:103], a[48:63]
    ds_read_b128 a[220:223], v241 offset:15360
    v_add_f32 v138, v138, v134
    v_add_f32 v139, v139, v135
    v_add_f32 v141, v138, v139
    v_max_f32 v146, v140, v141
    v_cmp_lt_f32 vcc, s38, v146
    v_mfma_f32_32x32x16_bf16 a[112:127], a[252:255], v[108:111], a[112:127]
    s_cbranch_vccnz k2_rare16
k2_rr15:
    s_add_u32 s36, s36, 1
    s_cmp_le_u32 s36, 1
    s_cbranch_scc1 k2_fix17
k2_fixr18:
    s_waitcnt lgkmcnt(6)
    v_mfma_f32_32x32x16_bf16 v[48:63], a[192:195], a[160:163], v[80:95]
    ds_read_b128 a[224:227], v241 offset:24576
    v_add_f32 v142, v142, v140
    v_add_f32 v143, v143, v141
    v_mfma_f32_32x32x16_bf16 v[48:63], a[196:199], a[164:167], v[48:63]
    ds_read_b128 a[228:231], v241 offset:25600
    s_sub_u32 s42, s32, 16384
    s_cmp_lt_u32 s42, s33
    s_cselect_b32 s42, s42, s43
    s_add_u32 m0, s34, 16384
    s_nop 0
    s_waitcnt lgkmcnt(6)
    v_mfma_f32_32x32x16_bf16 v[48:63], a[200:203], a[168:171], v[48:63]
    ds_read_b128 a[232:235], v241 offset:26624
    v_exp_f32 v138, v16
    v_exp_f32 v139, v17
    v_mfma_f32_32x32x16_bf16 v[48:63], a[204:207], a[172:175], v[48:63]
    ds_read_b128 a[236:239], v241 offset:27648
    v_exp_f32 v130, v18
    s_waitcnt lgkmcnt(6)
    v_mfma_f32_32x32x16_bf16 v[48:63], a[208:211], a[176:179], v[48:63]
    ds_read_b128 a[240:243], v241 offset:28672
    buffer_load_dwordx4 v242, s[16:19], s42 offen offset:0 lds
    v_exp_f32 v131, v19
    v_cvt_pk_bf16_f32 v104, v138, v139
    v_mfma_f32_32x32x16_bf16 v[48:63], a[212:215], a[180:183], v[48:63]
    ds_read_b128 a[244:247], v241 offset:29696
    v_exp_f32 v132, v20
    s_waitcnt lgkmcnt(6)
    v_mfma_f32_32x32x16_bf16 v[48:63], a[216:219], a[184:187], v[48:63]
    ds_read_b128 a[248:251], v241 offset:30720
    v_exp_f32 v133, v21
    v_cvt_pk_bf16_f32 v105, v130, v131
    v_mfma_f32_32x32x16_bf16 v[48:63], a[220:223], a[188:191], v[48:63]
    ds_read_b128 a[252:255], v241 offset:31744
    v_add_f32 v138, v138, v130
    v_add_f32 v139, v139, v131
    s_waitcnt lgkmcnt(6)
    v_mfma_f32_32x32x16_bf16 a[0:15], a[224:227], v[112:115], a[0:15]
    s_waitcnt vmcnt(13)
    s_barrier
    s_add_u32 s35, s35, 32768
    s_cmp_ge_u32 s35, 163840
    s_cselect_b32 s25, 0, s35
    s_mov_b32 s35, s25
    v_add_u32 v241, s35, v240
    ds_read_b128 a[192:195], v241 offset:0
    buffer_load_dwordx4 v242, s[16:19], s42 offen offset:1024 lds
    v_mfma_f32_32x32x16_bf16 a[64:79], a[224:227], v[120:123], a[64:79]
    v_exp_f32 v134, v22
    v_exp_f32 v135, v23
    v_mfma_f32_32x32x16_bf16 a[16:31], a[228:231], v[112:115], a[16:31]
    ds_read_b128 a[196:199], v241 offset:1024
    v_cvt_pk_bf16_f32 v106, v132, v133
    v_add_f32 v138, v138, v132
    v_add_f32 v139, v139, v133
    v_mfma_f32_32x32x16_bf16 a[80:95], a[228:231], v[120:123], a[80:95]
    v_exp_f32 v128, v24
    s_waitcnt lgkmcnt(6)
    v_mfma_f32_32x32x16_bf16 a[32:47], a[232:235], v[112:115], a[32:47]
    ds_read_b128 a[200:203], v241 offset:2048
    buffer_load_dwordx4 v242, s[16:19], s42 offen offset:2048 lds
    v_exp_f32 v129, v25
    v_cvt_pk_bf16_f32 v107, v134, v135
    v_mfma_f32_32x32x16_bf16 a[96:111], a[232:235], v[120:123], a[96:111]
    v_add_f32 v138, v138, v134
    v_add_f32 v139, v139, v135
    v_exp_f32 v130, v26
    v_mfma_f32_32x32x16_bf16 a[48:63], a[236:239], v[112:115], a[48:63]
    ds_read_b128 a[204:207], v241 offset:3072
    v_exp_f32 v131, v27
    v_cvt_pk_bf16_f32 v108, v128, v129
    v_mfma_f32_32x32x16_bf16 a[112:127], a[236:239], v[120:123], a[112:127]
    buffer_load_dwordx4 v242, s[16:19], s42 offen offset:3072 lds
    v_add_f32 v138, v138, v128
    v_add_f32 v139, v139, v129
    s_waitcnt lgkmcnt(6)
    v_mfma_f32_32x32x16_bf16 a[0:15], a[240:243], v[116:119], a[0:15]
    ds_read_b128 a[208:211], v241 offset:4096
    v_exp_f32 v132, v28
    v_exp_f32 v133, v29
    v_mfma_f32_32x32x16_bf16 a[64:79], a[240:243], v[124:127], a[64:79]
    v_cvt_pk_bf16_f32 v109, v130, v131
    v_add_f32 v138, v138, v130
    v_add_f32 v139, v139, v131
    v_mfma_f32_32x32x16_bf16 a[16:31], a[244:247], v[116:119], a[16:31]
    ds_read_b128 a[212:215], v241 offset:5120
    v_exp_f32 v134, v30
    v_mfma_f32_32x32x16_bf16 a[80:95], a[244:247], v[124:127], a[80:95]
    s_add_u32 s32, s32, 32768
    s_add_u32 s34, s34, 32768
    s_cmp_ge_u32 s34, 163840
    s_cselect_b32 s24, 163840, 0
    s_sub_u32 s34, s34, s24
    s_waitcnt lgkmcnt(6)
    v_mfma_f32_32x32x16_bf16 a[32:47], a[248:251], v[116:119], a[32:47]
    ds_read_b128 a[216:219], v241 offset:6144
    v_exp_f32 v135, v31
    v_cvt_pk_bf16_f32 v110, v132, v133
    v_mfma_f32_32x32x16_bf16 a[96:111], a[248:251], v[124:127], a[96:111]
    v_add_f32 v138, v138, v132
    v_add_f32 v139, v139, v133
    v_cvt_pk_bf16_f32 v111, v134, v135
    v_add_f32 v138, v138, v134
    v_mfma_f32_32x32x16_bf16 a[48:63], a[252:255], v[116:119], a[48:63]
    ds_read_b128 a[220:223], v241 offset:7168
    v_add_f32 v139, v139, v135
    v_add_f32 v141, v138, v139
    v_cmp_lt_f32 vcc, s38, v141
    v_mfma_f32_32x32x16_bf16 a[112:127], a[252:255], v[124:127], a[112:127]
    s_cbranch_vccnz k2_rare20
k2_rr19:
    s_nop 7
    v_mov_b32 v146, v142
    s_nop 1
    v_permlane32_swap_b32 v142, v146
    s_nop 0
    v_add_f32 v146, v146, v142
    v_rcp_f32 v146, v146
    s_nop 0
    v_accvgpr_read_b32 v160, a0
    v_accvgpr_read_b32 v161, a1
    v_accvgpr_read_b32 v162, a2
    v_accvgpr_read_b32 v163, a3
    v_accvgpr_read_b32 v164, a4
    v_accvgpr_read_b32 v165, a5
    v_accvgpr_read_b32 v166, a6
    v_accvgpr_read_b32 v167, a7
    v_mul_f32 v160, v160, v146
    v_mul_f32 v161, v161, v146
    v_mul_f32 v162, v162, v146
    v_mul_f32 v163, v163, v146
    v_mul_f32 v164, v164, v146
    v_mul_f32 v165, v165, v146
    v_mul_f32 v166, v166, v146
    v_mul_f32 v167, v167, v146
    v_cvt_pk_bf16_f32 v176, v160, v161
    v_cvt_pk_bf16_f32 v177, v162, v163
    v_cvt_pk_bf16_f32 v178, v164, v165
    v_cvt_pk_bf16_f32 v179, v166, v167
    buffer_store_dwordx4 v[176:179], v244, s[20:23], s39 offen offset:0
    v_accvgpr_read_b32 v168, a8
    v_accvgpr_read_b32 v169, a9
    v_accvgpr_read_b32 v170, a10
    v_accvgpr_read_b32 v171, a11
    v_accvgpr_read_b32 v172, a12
    v_accvgpr_read_b32 v173, a13
    v_accvgpr_read_b32 v174, a14
    v_accvgpr_read_b32 v175, a15
    v_mul_f32 v168, v168, v146
    v_mul_f32 v169, v169, v146
    v_mul_f32 v170, v170, v146
    v_mul_f32 v171, v171, v146
    v_mul_f32 v172, v172, v146
    v_mul_f32 v173, v173, v146
    v_mul_f32 v174, v174, v146
    v_mul_f32 v175, v175, v146
    v_cvt_pk_bf16_f32 v180, v168, v169
    v_cvt_pk_bf16_f32 v181, v170, v171
    v_cvt_pk_bf16_f32 v182, v172, v173
    v_cvt_pk_bf16_f32 v183, v174, v175
    buffer_store_dwordx4 v[180:183], v244, s[20:23], s39 offen offset:512
    v_accvgpr_read_b32 v160, a16
    v_accvgpr_read_b32 v161, a17
    v_accvgpr_read_b32 v162, a18
    v_accvgpr_read_b32 v163, a19
    v_accvgpr_read_b32 v164, a20
    v_accvgpr_read_b32 v165, a21
    v_accvgpr_read_b32 v166, a22
    v_accvgpr_read_b32 v167, a23
    v_mul_f32 v160, v160, v146
    v_mul_f32 v161, v161, v146
    v_mul_f32 v162, v162, v146
    v_mul_f32 v163, v163, v146
    v_mul_f32 v164, v164, v146
    v_mul_f32 v165, v165, v146
    v_mul_f32 v166, v166, v146
    v_mul_f32 v167, v167, v146
    v_cvt_pk_bf16_f32 v184, v160, v161
    v_cvt_pk_bf16_f32 v185, v162, v163
    v_cvt_pk_bf16_f32 v186, v164, v165
    v_cvt_pk_bf16_f32 v187, v166, v167
    buffer_store_dwordx4 v[184:187], v244, s[20:23], s39 offen offset:1024
    v_accvgpr_read_b32 v168, a24
    v_accvgpr_read_b32 v169, a25
    v_accvgpr_read_b32 v170, a26
    v_accvgpr_read_b32 v171, a27
    v_accvgpr_read_b32 v172, a28
    v_accvgpr_read_b32 v173, a29
    v_accvgpr_read_b32 v174, a30
    v_accvgpr_read_b32 v175, a31
    v_mul_f32 v168, v168, v146
    v_mul_f32 v169, v169, v146
    v_mul_f32 v170, v170, v146
    v_mul_f32 v171, v171, v146
    v_mul_f32 v172, v172, v146
    v_mul_f32 v173, v173, v146
    v_mul_f32 v174, v174, v146
    v_mul_f32 v175, v175, v146
    v_cvt_pk_bf16_f32 v188, v168, v169
    v_cvt_pk_bf16_f32 v189, v170, v171
    v_cvt_pk_bf16_f32 v190, v172, v173
    v_cvt_pk_bf16_f32 v191, v174, v175
    buffer_store_dwordx4 v[188:191], v244, s[20:23], s39 offen offset:1536
    v_accvgpr_read_b32 v160, a32
    v_accvgpr_read_b32 v161, a33
    v_accvgpr_read_b32 v162, a34
    v_accvgpr_read_b32 v163, a35
    v_accvgpr_read_b32 v164, a36
    v_accvgpr_read_b32 v165, a37
    v_accvgpr_read_b32 v166, a38
    v_accvgpr_read_b32 v167, a39
    v_mul_f32 v160, v160, v146
    v_mul_f32 v161, v161, v146
    v_mul_f32 v162, v162, v146
    v_mul_f32 v163, v163, v146
    v_mul_f32 v164, v164, v146
    v_mul_f32 v165, v165, v146
    v_mul_f32 v166, v166, v146
    v_mul_f32 v167, v167, v146
    v_cvt_pk_bf16_f32 v176, v160, v161
    v_cvt_pk_bf16_f32 v177, v162, v163
    v_cvt_pk_bf16_f32 v178, v164, v165
    v_cvt_pk_bf16_f32 v179, v166, v167
    buffer_store_dwordx4 v[176:179], v244, s[20:23], s39 offen offset:2048
    v_accvgpr_read_b32 v168, a40
    v_accvgpr_read_b32 v169, a41
    v_accvgpr_read_b32 v170, a42
    v_accvgpr_read_b32 v171, a43
    v_accvgpr_read_b32 v172, a44
    v_accvgpr_read_b32 v173, a45
    v_accvgpr_read_b32 v174, a46
    v_accvgpr_read_b32 v175, a47
    v_mul_f32 v168, v168, v146
    v_mul_f32 v169, v169, v146
    v_mul_f32 v170, v170, v146
    v_mul_f32 v171, v171, v146
    v_mul_f32 v172, v172, v146
    v_mul_f32 v173, v173, v146
    v_mul_f32 v174, v174, v146
    v_mul_f32 v175, v175, v146
    v_cvt_pk_bf16_f32 v180, v168, v169
    v_cvt_pk_bf16_f32 v181, v170, v171
    v_cvt_pk_bf16_f32 v182, v172, v173
    v_cvt_pk_bf16_f32 v183, v174, v175
    buffer_store_dwordx4 v[180:183], v244, s[20:23], s39 offen offset:2560
    v_accvgpr_read_b32 v160, a48
    v_accvgpr_read_b32 v161, a49
    v_accvgpr_read_b32 v162, a50
    v_accvgpr_read_b32 v163, a51
    v_accvgpr_read_b32 v164, a52
    v_accvgpr_read_b32 v165, a53
    v_accvgpr_read_b32 v166, a54
    v_accvgpr_read_b32 v167, a55
    v_mul_f32 v160, v160, v146
    v_mul_f32 v161, v161, v146
    v_mul_f32 v162, v162, v146
    v_mul_f32 v163, v163, v146
    v_mul_f32 v164, v164, v146
    v_mul_f32 v165, v165, v146
    v_mul_f32 v166, v166, v146
    v_mul_f32 v167, v167, v146
    v_cvt_pk_bf16_f32 v184, v160, v161
    v_cvt_pk_bf16_f32 v185, v162, v163
    v_cvt_pk_bf16_f32 v186, v164, v165
    v_cvt_pk_bf16_f32 v187, v166, v167
    buffer_store_dwordx4 v[184:187], v244, s[20:23], s39 offen offset:3072
    v_accvgpr_read_b32 v168, a56
    v_accvgpr_read_b32 v169, a57
    v_accvgpr_read_b32 v170, a58
    v_accvgpr_read_b32 v171, a59
    v_accvgpr_read_b32 v172, a60
    v_accvgpr_read_b32 v173, a61
    v_accvgpr_read_b32 v174, a62
    v_accvgpr_read_b32 v175, a63
    v_mul_f32 v168, v168, v146
    v_mul_f32 v169, v169, v146
    v_mul_f32 v170, v170, v146
    v_mul_f32 v171, v171, v146
    v_mul_f32 v172, v172, v146
    v_mul_f32 v173, v173, v146
    v_mul_f32 v174, v174, v146
    v_mul_f32 v175, v175, v146
    v_cvt_pk_bf16_f32 v188, v168, v169
    v_cvt_pk_bf16_f32 v189, v170, v171
    v_cvt_pk_bf16_f32 v190, v172, v173
    v_cvt_pk_bf16_f32 v191, v174, v175
    buffer_store_dwordx4 v[188:191], v244, s[20:23], s39 offen offset:3584
    s_lshl_b32 s26, s5, 2
    s_sub_u32 s26, 29, s26
.p2align 3
k2_p2:
    s_add_u32 s36, s36, 1
    s_cmp_le_u32 s36, 1
    s_cbranch_scc1 k2_fix21
k2_fixr22:
    s_waitcnt lgkmcnt(6)
    v_mfma_f32_32x32x16_bf16 v[16:31], a[192:195], a[160:163], v[80:95]
    ds_read_b128 a[224:227], v241 offset:16384
    v_add_f32 v143, v143, v141
    v_exp_f32 v138, v48
    v_exp_f32 v139, v49
    v_mfma_f32_32x32x16_bf16 v[16:31], a[196:199], a[164:167], v[16:31]
    ds_read_b128 a[228:231], v241 offset:17408
    s_cmp_lt_u32 s32, s33
    s_cselect_b32 s41, s32, s43
    s_mov_b32 m0, s34
    s_nop 0
    s_waitcnt lgkmcnt(6)
    v_mfma_f32_32x32x16_bf16 v[16:31], a[200:203], a[168:171], v[16:31]
    ds_read_b128 a[232:235], v241 offset:18432
    v_exp_f32 v130, v50
    v_exp_f32 v131, v51
    v_cvt_pk_bf16_f32 v120, v138, v139
    v_mfma_f32_32x32x16_bf16 v[16:31], a[204:207], a[172:175], v[16:31]
    ds_read_b128 a[236:239], v241 offset:19456
    buffer_load_dwordx4 v242, s[16:19], s41 offen offset:0 lds
    v_exp_f32 v132, v52
    s_waitcnt lgkmcnt(6)
    v_mfma_f32_32x32x16_bf16 v[16:31], a[208:211], a[176:179], v[16:31]
    ds_read_b128 a[240:243], v241 offset:20480
    v_exp_f32 v133, v53
    v_cvt_pk_bf16_f32 v121, v130, v131
    v_add_f32 v138, v138, v130
    v_add_f32 v139, v139, v131
    v_mfma_f32_32x32x16_bf16 v[16:31], a[212:215], a[180:183], v[16:31]
    ds_read_b128 a[244:247], v241 offset:21504
    v_exp_f32 v134, v54
    v_exp_f32 v135, v55
    s_waitcnt lgkmcnt(6)
    v_mfma_f32_32x32x16_bf16 v[16:31], a[216:219], a[184:187], v[16:31]
    ds_read_b128 a[248:251], v241 offset:22528
    buffer_load_dwordx4 v242, s[16:19], s41 offen offset:1024 lds
    v_cvt_pk_bf16_f32 v122, v132, v133
    v_add_f32 v138, v138, v132
    v_add_f32 v139, v139, v133
    v_mfma_f32_32x32x16_bf16 v[16:31], a[220:223], a[188:191], v[16:31]
    ds_read_b128 a[252:255], v241 offset:23552
    v_exp_f32 v128, v56
    v_exp_f32 v129, v57
    v_cvt_pk_bf16_f32 v123, v134, v135
    s_waitcnt lgkmcnt(6)
    v_mfma_f32_32x32x16_bf16 a[64:79], a[224:227], v[104:107], a[64:79]
    ds_read_b128 a[192:195], v241 offset:8192
    v_add_f32 v138, v138, v134
    v_add_f32 v139, v139, v135
    v_exp_f32 v130, v58
    v_mfma_f32_32x32x16_bf16 a[80:95], a[228:231], v[104:107], a[80:95]
    ds_read_b128 a[196:199], v241 offset:9216
    buffer_load_dwordx4 v242, s[16:19], s41 offen offset:2048 lds
    v_exp_f32 v131, v59
    v_cvt_pk_bf16_f32 v124, v128, v129
    s_waitcnt lgkmcnt(6)
    v_mfma_f32_32x32x16_bf16 a[96:111], a[232:235], v[104:107], a[96:111]
    ds_read_b128 a[200:203], v241 offset:10240
    v_add_f32 v138, v138, v128
    v_add_f32 v139, v139, v129
    v_exp_f32 v132, v60
    v_mfma_f32_32x32x16_bf16 a[112:127], a[236:239], v[104:107], a[112:127]
    ds_read_b128 a[204:207], v241 offset:11264
    v_exp_f32 v133, v61
    v_cvt_pk_bf16_f32 v125, v130, v131
    v_add_f32 v138, v138, v130
    v_add_f32 v139, v139, v131
    s_waitcnt lgkmcnt(6)
    v_mfma_f32_32x32x16_bf16 a[64:79], a[240:243], v[108:111], a[64:79]
    ds_read_b128 a[208:211], v241 offset:12288
    buffer_load_dwordx4 v242, s[16:19], s41 offen offset:3072 lds
    v_exp_f32 v134, v62
    v_exp_f32 v135, v63
    v_mfma_f32_32x32x16_bf16 a[80:95], a[244:247], v[108:111], a[80:95]
    ds_read_b128 a[212:215], v241 offset:13312
    v_cvt_pk_bf16_f32 v126, v132, v133
    v_add_f32 v138, v138, v132
    v_add_f32 v139, v139, v133
    s_waitcnt lgkmcnt(6)
    v_mfma_f32_32x32x16_bf16 a[96:111], a[248:251], v[108:111], a[96:111]
    ds_read_b128 a[216:219], v241 offset:14336
    v_cvt_pk_bf16_f32 v127, v134, v135
    v_add_f32 v138, v138, v134
    v_add_f32 v139, v139, v135
    v_add_f32 v141, v138, v139
    v_cmp_lt_f32 vcc, s38, v141
    v_mfma_f32_32x32x16_bf16 a[112:127], a[252:255], v[108:111], a[112:127]
    ds_read_b128 a[220:223], v241 offset:15360
    s_cbranch_vccnz k2_rare24
k2_rr23:
    s_add_u32 s36, s36, 1
    s_cmp_le_u32 s36, 1
    s_cbranch_scc1 k2_fix25
k2_fixr26:
    s_waitcnt lgkmcnt(6)
    v_mfma_f32_32x32x16_bf16 v[48:63], a[192:195], a[160:163], v[80:95]
    ds_read_b128 a[224:227], v241 offset:24576
    v_add_f32 v143, v143, v141
    v_exp_f32 v138, v16
    v_exp_f32 v139, v17
    v_mfma_f32_32x32x16_bf16 v[48:63], a[196:199], a[164:167], v[48:63]
    ds_read_b128 a[228:231], v241 offset:25600
    s_sub_u32 s42, s32, 16384
    s_cmp_lt_u32 s42, s33
    s_cselect_b32 s42, s42, s43
    s_add_u32 m0, s34, 16384
    s_nop 0
    s_waitcnt lgkmcnt(6)
    v_mfma_f32_32x32x16_bf16 v[48:63], a[200:203], a[168:171], v[48:63]
    ds_read_b128 a[232:235], v241 offset:26624
    v_exp_f32 v130, v18
    v_exp_f32 v131, v19
    v_cvt_pk_bf16_f32 v104, v138, v139
    v_exp_f32 v132, v20
    v_mfma_f32_32x32x16_bf16 v[48:63], a[204:207], a[172:175], v[48:63]
    ds_read_b128 a[236:239], v241 offset:27648
    buffer_load_dwordx4 v242, s[16:19], s42 offen offset:0 lds
    v_exp_f32 v133, v21
    v_cvt_pk_bf16_f32 v105, v130, v131
    s_waitcnt lgkmcnt(6)
    v_mfma_f32_32x32x16_bf16 v[48:63], a[208:211], a[176:179], v[48:63]
    ds_read_b128 a[240:243], v241 offset:28672
    v_add_f32 v138, v138, v130
    v_add_f32 v139, v139, v131
    v_exp_f32 v134, v22
    v_exp_f32 v135, v23
    v_mfma_f32_32x32x16_bf16 v[48:63], a[212:215], a[180:183], v[48:63]
    ds_read_b128 a[244:247], v241 offset:29696
    buffer_load_dwordx4 v242, s[16:19], s42 offen offset:1024 lds
    v_cvt_pk_bf16_f32 v106, v132, v133
    v_add_f32 v138, v138, v132
    s_waitcnt lgkmcnt(6)
    v_mfma_f32_32x32x16_bf16 v[48:63], a[216:219], a[184:187], v[48:63]
    ds_read_b128 a[248:251], v241 offset:30720
    v_add_f32 v139, v139, v133
    v_exp_f32 v128, v24
    v_exp_f32 v129, v25
    v_cvt_pk_bf16_f32 v107, v134, v135
    v_mfma_f32_32x32x16_bf16 v[48:63], a[220:223], a[188:191], v[48:63]
    ds_read_b128 a[252:255], v241 offset:31744
    v_add_f32 v138, v138, v134
    v_add_f32 v139, v139, v135
    v_exp_f32 v130, v26
    s_waitcnt lgkmcnt(6)
    v_mfma_f32_32x32x16_bf16 a[64:79], a[224:227], v[120:123], a[64:79]
    s_waitcnt vmcnt(14)
    s_barrier
    s_add_u32 s35, s35, 32768
    s_cmp_ge_u32 s35, 163840
    s_cselect_b32 s25, 0, s35
    s_mov_b32 s35, s25
    v_add_u32 v241, s35, v240
    ds_read_b128 a[192:195], v241 offset:0
    buffer_load_dwordx4 v242, s[16:19], s42 offen offset:2048 lds
    v_mfma_f32_32x32x16_bf16 a[80:95], a[228:231], v[120:123], a[80:95]
    ds_read_b128 a[196:199], v241 offset:1024
    v_exp_f32 v131, v27
    v_cvt_pk_bf16_f32 v108, v128, v129
    v_add_f32 v138, v138, v128
    v_add_f32 v139, v139, v129
    s_waitcnt lgkmcnt(6)
    v_mfma_f32_32x32x16_bf16 a[96:111], a[232:235], v[120:123], a[96:111]
    ds_read_b128 a[200:203], v241 offset:2048
    buffer_load_dwordx4 v242, s[16:19], s42 offen offset:3072 lds
    v_exp_f32 v132, v28
    v_exp_f32 v133, v29
    v_mfma_f32_32x32x16_bf16 a[112:127], a[236:239], v[120:123], a[112:127]
    ds_read_b128 a[204:207], v241 offset:3072
    v_cvt_pk_bf16_f32 v109, v130, v131
    v_add_f32 v138, v138, v130
    v_add_f32 v139, v139, v131
    v_exp_f32 v134, v30
    s_waitcnt lgkmcnt(6)
    v_mfma_f32_32x32x16_bf16 a[64:79], a[240:243], v[124:127], a[64:79]
    ds_read_b128 a[208:211], v241 offset:4096
    s_add_u32 s32, s32, 32768
    s_add_u32 s34, s34, 32768
    s_cmp_ge_u32 s34, 163840
    s_cselect_b32 s24, 163840, 0
    s_sub_u32 s34, s34, s24
    v_mfma_f32_32x32x16_bf16 a[80:95], a[244:247], v[124:127], a[80:95]
    ds_read_b128 a[212:215], v241 offset:5120
    v_exp_f32 v135, v31
    v_cvt_pk_bf16_f32 v110, v132, v133
    v_add_f32 v138, v138, v132
    s_waitcnt lgkmcnt(6)
    v_mfma_f32_32x32x16_bf16 a[96:111], a[248:251], v[124:127], a[96:111]
    ds_read_b128 a[216:219], v241 offset:6144
    v_add_f32 v139, v139, v133
    v_cvt_pk_bf16_f32 v111, v134, v135
    v_add_f32 v138, v138, v134
    v_add_f32 v139, v139, v135
    v_add_f32 v141, v138, v139
    v_cmp_lt_f32 vcc, s38, v141
    v_mfma_f32_32x32x16_bf16 a[112:127], a[252:255], v[124:127], a[112:127]
    ds_read_b128 a[220:223], v241 offset:7168
    s_cbranch_vccnz k2_rare28
k2_rr27:
    s_sub_u32 s26, s26, 1
    s_cmp_lg_u32 s26, 0
    s_cbranch_scc1 k2_p2
    s_waitcnt lgkmcnt(0)
    ds_read_b128 a[224:227], v241 offset:16384
    ds_read_b128 a[228:231], v241 offset:17408
    ds_read_b128 a[232:235], v241 offset:18432
    ds_read_b128 a[236:239], v241 offset:19456
    ds_read_b128 a[240:243], v241 offset:20480
    ds_read_b128 a[244:247], v241 offset:21504
    ds_read_b128 a[248:251], v241 offset:22528
    ds_read_b128 a[252:255], v241 offset:23552
    ds_read_b128 a[192:195], v241 offset:24576
    ds_read_b128 a[196:199], v241 offset:25600
    ds_read_b128 a[200:203], v241 offset:26624
    ds_read_b128 a[204:207], v241 offset:27648
    ds_read_b128 a[208:211], v241 offset:28672
    ds_read_b128 a[212:215], v241 offset:29696
    ds_read_b128 a[216:219], v241 offset:30720
    s_waitcnt lgkmcnt(7)
    ds_read_b128 a[220:223], v241 offset:31744
    v_mfma_f32_32x32x16_bf16 a[64:79], a[224:227], v[104:107], a[64:79]
    v_add_f32 v143, v143, v141
    v_exp_f32 v138, v48
    v_exp_f32 v139, v49
    v_exp_f32 v130, v50
    v_exp_f32 v131, v51
    v_mfma_f32_32x32x16_bf16 a[80:95], a[228:231], v[104:107], a[80:95]
    v_cvt_pk_bf16_f32 v120, v138, v139
    v_exp_f32 v132, v52
    v_exp_f32 v133, v53
    v_cvt_pk_bf16_f32 v121, v130, v131
    v_add_f32 v138, v138, v130
    v_mfma_f32_32x32x16_bf16 a[96:111], a[232:235], v[104:107], a[96:111]
    v_add_f32 v139, v139, v131
    v_exp_f32 v134, v54
    v_exp_f32 v135, v55
    v_cvt_pk_bf16_f32 v122, v132, v133
    v_add_f32 v138, v138, v132
    v_add_f32 v139, v139, v133
    v_mfma_f32_32x32x16_bf16 a[112:127], a[236:239], v[104:107], a[112:127]
    v_exp_f32 v128, v56
    v_exp_f32 v129, v57
    v_cvt_pk_bf16_f32 v123, v134, v135
    v_add_f32 v138, v138, v134
    v_add_f32 v139, v139, v135
    v_exp_f32 v130, v58
    v_mfma_f32_32x32x16_bf16 a[64:79], a[240:243], v[108:111], a[64:79]
    v_exp_f32 v131, v59
    v_cvt_pk_bf16_f32 v124, v128, v129
    v_add_f32 v138, v138, v128
    v_add_f32 v139, v139, v129
    v_exp_f32 v132, v60
    v_mfma_f32_32x32x16_bf16 a[80:95], a[244:247], v[108:111], a[80:95]
    v_exp_f32 v133, v61
    v_cvt_pk_bf16_f32 v125, v130, v131
    v_add_f32 v138, v138, v130
    v_add_f32 v139, v139, v131
    v_exp_f32 v134, v62
    v_exp_f32 v135, v63
    v_mfma_f32_32x32x16_bf16 a[96:111], a[248:251], v[108:111], a[96:111]
    v_cvt_pk_bf16_f32 v126, v132, v133
    v_add_f32 v138, v138, v132
    v_add_f32 v139, v139, v133
    v_cvt_pk_bf16_f32 v127, v134, v135
    v_add_f32 v138, v138, v134
    v_add_f32 v139, v139, v135
    v_add_f32 v141, v138, v139
    v_cmp_lt_f32 vcc, s38, v141
    v_mfma_f32_32x32x16_bf16 a[112:127], a[252:255], v[108:111], a[112:127]
    s_cbranch_vccnz k2_rare30
k2_rr29:
    s_waitcnt lgkmcnt(0)
    v_add_f32 v143, v143, v141
    s_nop 0
    v_mfma_f32_32x32x16_bf16 a[64:79], a[192:195], v[120:123], a[64:79]
    v_mfma_f32_32x32x16_bf16 a[80:95], a[196:199], v[120:123], a[80:95]
    v_mfma_f32_32x32x16_bf16 a[96:111], a[200:203], v[120:123], a[96:111]
    v_mfma_f32_32x32x16_bf16 a[112:127], a[204:207], v[120:123], a[112:127]
    v_mfma_f32_32x32x16_bf16 a[64:79], a[208:211], v[124:127], a[64:79]
    v_mfma_f32_32x32x16_bf16 a[80:95], a[212:215], v[124:127], a[80:95]
    v_mfma_f32_32x32x16_bf16 a[96:111], a[216:219], v[124:127], a[96:111]
    v_mfma_f32_32x32x16_bf16 a[112:127], a[220:223], v[124:127], a[112:127]
    s_nop 7
    s_nop 7
    v_mov_b32 v146, v143
    s_nop 1
    v_permlane32_swap_b32 v143, v146
    s_nop 0
    v_add_f32 v146, v146, v143
    v_rcp_f32 v146, v146
    s_nop 0
    v_accvgpr_read_b32 v160, a64
    v_accvgpr_read_b32 v161, a65
    v_accvgpr_read_b32 v162, a66
    v_accvgpr_read_b32 v163, a67
    v_accvgpr_read_b32 v164, a68
    v_accvgpr_read_b32 v165, a69
    v_accvgpr_read_b32 v166, a70
    v_accvgpr_read_b32 v167, a71
    v_mul_f32 v160, v160, v146
    v_mul_f32 v161, v161, v146
    v_mul_f32 v162, v162, v146
    v_mul_f32 v163, v163, v146
    v_mul_f32 v164, v164, v146
    v_mul_f32 v165, v165, v146
    v_mul_f32 v166, v166, v146
    v_mul_f32 v167, v167, v146
    v_cvt_pk_bf16_f32 v176, v160, v161
    v_cvt_pk_bf16_f32 v177, v162, v163
    v_cvt_pk_bf16_f32 v178, v164, v165
    v_cvt_pk_bf16_f32 v179, v166, v167
    buffer_store_dwordx4 v[176:179], v244, s[20:23], s40 offen offset:0
    v_accvgpr_read_b32 v168, a72
    v_accvgpr_read_b32 v169, a73
    v_accvgpr_read_b32 v170, a74
    v_accvgpr_read_b32 v171, a75
    v_accvgpr_read_b32 v172, a76
    v_accvgpr_read_b32 v173, a77
    v_accvgpr_read_b32 v174, a78
    v_accvgpr_read_b32 v175, a79
    v_mul_f32 v168, v168, v146
    v_mul_f32 v169, v169, v146
    v_mul_f32 v170, v170, v146
    v_mul_f32 v171, v171, v146
    v_mul_f32 v172, v172, v146
    v_mul_f32 v173, v173, v146
    v_mul_f32 v174, v174, v146
    v_mul_f32 v175, v175, v146
    v_cvt_pk_bf16_f32 v180, v168, v169
    v_cvt_pk_bf16_f32 v181, v170, v171
    v_cvt_pk_bf16_f32 v182, v172, v173
    v_cvt_pk_bf16_f32 v183, v174, v175
    buffer_store_dwordx4 v[180:183], v244, s[20:23], s40 offen offset:512
    v_accvgpr_read_b32 v160, a80
    v_accvgpr_read_b32 v161, a81
    v_accvgpr_read_b32 v162, a82
    v_accvgpr_read_b32 v163, a83
    v_accvgpr_read_b32 v164, a84
    v_accvgpr_read_b32 v165, a85
    v_accvgpr_read_b32 v166, a86
    v_accvgpr_read_b32 v167, a87
    v_mul_f32 v160, v160, v146
    v_mul_f32 v161, v161, v146
    v_mul_f32 v162, v162, v146
    v_mul_f32 v163, v163, v146
    v_mul_f32 v164, v164, v146
    v_mul_f32 v165, v165, v146
    v_mul_f32 v166, v166, v146
    v_mul_f32 v167, v167, v146
    v_cvt_pk_bf16_f32 v184, v160, v161
    v_cvt_pk_bf16_f32 v185, v162, v163
    v_cvt_pk_bf16_f32 v186, v164, v165
    v_cvt_pk_bf16_f32 v187, v166, v167
    buffer_store_dwordx4 v[184:187], v244, s[20:23], s40 offen offset:1024
    v_accvgpr_read_b32 v168, a88
    v_accvgpr_read_b32 v169, a89
    v_accvgpr_read_b32 v170, a90
    v_accvgpr_read_b32 v171, a91
    v_accvgpr_read_b32 v172, a92
    v_accvgpr_read_b32 v173, a93
    v_accvgpr_read_b32 v174, a94
    v_accvgpr_read_b32 v175, a95
    v_mul_f32 v168, v168, v146
    v_mul_f32 v169, v169, v146
    v_mul_f32 v170, v170, v146
    v_mul_f32 v171, v171, v146
    v_mul_f32 v172, v172, v146
    v_mul_f32 v173, v173, v146
    v_mul_f32 v174, v174, v146
    v_mul_f32 v175, v175, v146
    v_cvt_pk_bf16_f32 v188, v168, v169
    v_cvt_pk_bf16_f32 v189, v170, v171
    v_cvt_pk_bf16_f32 v190, v172, v173
    v_cvt_pk_bf16_f32 v191, v174, v175
    buffer_store_dwordx4 v[188:191], v244, s[20:23], s40 offen offset:1536
    v_accvgpr_read_b32 v160, a96
    v_accvgpr_read_b32 v161, a97
    v_accvgpr_read_b32 v162, a98
    v_accvgpr_read_b32 v163, a99
    v_accvgpr_read_b32 v164, a100
    v_accvgpr_read_b32 v165, a101
    v_accvgpr_read_b32 v166, a102
    v_accvgpr_read_b32 v167, a103
    v_mul_f32 v160, v160, v146
    v_mul_f32 v161, v161, v146
    v_mul_f32 v162, v162, v146
    v_mul_f32 v163, v163, v146
    v_mul_f32 v164, v164, v146
    v_mul_f32 v165, v165, v146
    v_mul_f32 v166, v166, v146
    v_mul_f32 v167, v167, v146
    v_cvt_pk_bf16_f32 v176, v160, v161
    v_cvt_pk_bf16_f32 v177, v162, v163
    v_cvt_pk_bf16_f32 v178, v164, v165
    v_cvt_pk_bf16_f32 v179, v166, v167
    buffer_store_dwordx4 v[176:179], v244, s[20:23], s40 offen offset:2048
    v_accvgpr_read_b32 v168, a104
    v_accvgpr_read_b32 v169, a105
    v_accvgpr_read_b32 v170, a106
    v_accvgpr_read_b32 v171, a107
    v_accvgpr_read_b32 v172, a108
    v_accvgpr_read_b32 v173, a109
    v_accvgpr_read_b32 v174, a110
    v_accvgpr_read_b32 v175, a111
    v_mul_f32 v168, v168, v146
    v_mul_f32 v169, v169, v146
    v_mul_f32 v170, v170, v146
    v_mul_f32 v171, v171, v146
    v_mul_f32 v172, v172, v146
    v_mul_f32 v173, v173, v146
    v_mul_f32 v174, v174, v146
    v_mul_f32 v175, v175, v146
    v_cvt_pk_bf16_f32 v180, v168, v169
    v_cvt_pk_bf16_f32 v181, v170, v171
    v_cvt_pk_bf16_f32 v182, v172, v173
    v_cvt_pk_bf16_f32 v183, v174, v175
    buffer_store_dwordx4 v[180:183], v244, s[20:23], s40 offen offset:2560
    v_accvgpr_read_b32 v160, a112
    v_accvgpr_read_b32 v161, a113
    v_accvgpr_read_b32 v162, a114
    v_accvgpr_read_b32 v163, a115
    v_accvgpr_read_b32 v164, a116
    v_accvgpr_read_b32 v165, a117
    v_accvgpr_read_b32 v166, a118
    v_accvgpr_read_b32 v167, a119
    v_mul_f32 v160, v160, v146
    v_mul_f32 v161, v161, v146
    v_mul_f32 v162, v162, v146
    v_mul_f32 v163, v163, v146
    v_mul_f32 v164, v164, v146
    v_mul_f32 v165, v165, v146
    v_mul_f32 v166, v166, v146
    v_mul_f32 v167, v167, v146
    v_cvt_pk_bf16_f32 v184, v160, v161
    v_cvt_pk_bf16_f32 v185, v162, v163
    v_cvt_pk_bf16_f32 v186, v164, v165
    v_cvt_pk_bf16_f32 v187, v166, v167
    buffer_store_dwordx4 v[184:187], v244, s[20:23], s40 offen offset:3072
    v_accvgpr_read_b32 v168, a120
    v_accvgpr_read_b32 v169, a121
    v_accvgpr_read_b32 v170, a122
    v_accvgpr_read_b32 v171, a123
    v_accvgpr_read_b32 v172, a124
    v_accvgpr_read_b32 v173, a125
    v_accvgpr_read_b32 v174, a126
    v_accvgpr_read_b32 v175, a127
    v_mul_f32 v168, v168, v146
    v_mul_f32 v169, v169, v146
    v_mul_f32 v170, v170, v146
    v_mul_f32 v171, v171, v146
    v_mul_f32 v172, v172, v146
    v_mul_f32 v173, v173, v146
    v_mul_f32 v174, v174, v146
    v_mul_f32 v175, v175, v146
    v_cvt_pk_bf16_f32 v188, v168, v169
    v_cvt_pk_bf16_f32 v189, v170, v171
    v_cvt_pk_bf16_f32 v190, v172, v173
    v_cvt_pk_bf16_f32 v191, v174, v175
    buffer_store_dwordx4 v[188:191], v244, s[20:23], s40 offen offset:3584
k2_done:
    s_endpgm
k2_fix1:
    s_cmp_eq_u32 s36, 0
    s_cselect_b32 s24, 0, 0x74000000
    v_subrev_f32 v146, s24, v243
    v_add_f32 v147, 0, v146
    v_min_f32 v64, v144, v147
    v_add_f32 v148, 0xf1800000, v146
    v_min_f32 v65, v144, v148
    v_add_f32 v147, 0xf2000000, v146
    v_min_f32 v66, v144, v147
    v_add_f32 v148, 0xf2400000, v146
    v_min_f32 v67, v144, v148
    v_add_f32 v147, 0xf3000000, v146
    v_min_f32 v68, v144, v147
    v_add_f32 v148, 0xf3100000, v146
    v_min_f32 v69, v144, v148
    v_add_f32 v147, 0xf3200000, v146
    v_min_f32 v70, v144, v147
    v_add_f32 v148, 0xf3300000, v146
    v_min_f32 v71, v144, v148
    v_add_f32 v147, 0xf3800000, v146
    v_min_f32 v72, v144, v147
    v_add_f32 v148, 0xf3880000, v146
    v_min_f32 v73, v144, v148
    v_add_f32 v147, 0xf3900000, v146
    v_min_f32 v74, v144, v147
    v_add_f32 v148, 0xf3980000, v146
    v_min_f32 v75, v144, v148
    v_add_f32 v147, 0xf3c00000, v146
    v_min_f32 v76, v144, v147
    v_add_f32 v148, 0xf3c80000, v146
    v_min_f32 v77, v144, v148
    v_add_f32 v147, 0xf3d00000, v146
    v_min_f32 v78, v144, v147
    v_add_f32 v148, 0xf3d80000, v146
    v_min_f32 v79, v144, v148
    s_nop 1
    s_branch k2_fixr2
k2_fix3:
    s_cmp_eq_u32 s36, 0
    s_cselect_b32 s24, 0, 0x74000000
    v_subrev_f32 v146, s24, v243
    v_add_f32 v147, 0, v146
    v_min_f32 v64, v144, v147
    v_add_f32 v148, 0xf1800000, v146
    v_min_f32 v65, v144, v148
    v_add_f32 v147, 0xf2000000, v146
    v_min_f32 v66, v144, v147
    v_add_f32 v148, 0xf2400000, v146
    v_min_f32 v67, v144, v148
    v_add_f32 v147, 0xf3000000, v146
    v_min_f32 v68, v144, v147
    v_add_f32 v148, 0xf3100000, v146
    v_min_f32 v69, v144, v148
    v_add_f32 v147, 0xf3200000, v146
    v_min_f32 v70, v144, v147
    v_add_f32 v148, 0xf3300000, v146
    v_min_f32 v71, v144, v148
    v_add_f32 v147, 0xf3800000, v146
    v_min_f32 v72, v144, v147
    v_add_f32 v148, 0xf3880000, v146
    v_min_f32 v73, v144, v148
    v_add_f32 v147, 0xf3900000, v146
    v_min_f32 v74, v144, v147
    v_add_f32 v148, 0xf3980000, v146
    v_min_f32 v75, v144, v148
    v_add_f32 v147, 0xf3c00000, v146
    v_min_f32 v76, v144, v147
    v_add_f32 v148, 0xf3c80000, v146
    v_min_f32 v77, v144, v148
    v_add_f32 v147, 0xf3d00000, v146
    v_min_f32 v78, v144, v147
    v_add_f32 v148, 0xf3d80000, v146
    v_min_f32 v79, v144, v148
    s_nop 1
    s_branch k2_fixr4
k2_fix5:
    s_cmp_eq_u32 s36, 0
    s_cselect_b32 s24, 0, 0x74000000
    v_subrev_f32 v146, s24, v243
    v_add_f32 v147, 0, v146
    v_min_f32 v64, v144, v147
    v_add_f32 v148, 0xf1800000, v146
    v_min_f32 v65, v144, v148
    v_add_f32 v147, 0xf2000000, v146
    v_min_f32 v66, v144, v147
    v_add_f32 v148, 0xf2400000, v146
    v_min_f32 v67, v144, v148
    v_add_f32 v147, 0xf3000000, v146
    v_min_f32 v68, v144, v147
    v_add_f32 v148, 0xf3100000, v146
    v_min_f32 v69, v144, v148
    v_add_f32 v147, 0xf3200000, v146
    v_min_f32 v70, v144, v147
    v_add_f32 v148, 0xf3300000, v146
    v_min_f32 v71, v144, v148
    v_add_f32 v147, 0xf3800000, v146
    v_min_f32 v72, v144, v147
    v_add_f32 v148, 0xf3880000, v146
    v_min_f32 v73, v144, v148
    v_add_f32 v147, 0xf3900000, v146
    v_min_f32 v74, v144, v147
    v_add_f32 v148, 0xf3980000, v146
    v_min_f32 v75, v144, v148
    v_add_f32 v147, 0xf3c00000, v146
    v_min_f32 v76, v144, v147
    v_add_f32 v148, 0xf3c80000, v146
    v_min_f32 v77, v144, v148
    v_add_f32 v147, 0xf3d00000, v146
    v_min_f32 v78, v144, v147
    v_add_f32 v148, 0xf3d80000, v146
    v_min_f32 v79, v144, v148
    s_nop 1
    s_branch k2_fixr6
k2_rare8:
    s_nop 15
    v_max3_f32 v146, v32, v33, v34
    v_max3_f32 v146, v146, v35, v36
    v_max3_f32 v146, v146, v37, v38
    v_max3_f32 v146, v146, v39, v40
    v_max3_f32 v146, v146, v41, v42
    v_max3_f32 v146, v146, v43, v44
    v_max3_f32 v146, v146, v45, v46
    v_max_f32 v146, v146, v47
    v_mov_b32 v147, v146
    s_nop 1
    v_permlane32_swap_b32 v146, v147
    s_nop 0
    v_max_f32 v146, v146, v147
    v_max_f32 v146, 0, v146
    v_sub_f32 v148, 0, v146
    v_exp_f32 v148, v148
    v_sub_f32 v144, v144, v146
    v_sub_f32 v64, v64, v146
    v_sub_f32 v0, v0, v146
    v_sub_f32 v32, v32, v146
    v_sub_f32 v65, v65, v146
    v_sub_f32 v1, v1, v146
    v_sub_f32 v33, v33, v146
    v_sub_f32 v66, v66, v146
    v_sub_f32 v2, v2, v146
    v_sub_f32 v34, v34, v146
    v_sub_f32 v67, v67, v146
    v_sub_f32 v3, v3, v146
    v_sub_f32 v35, v35, v146
    v_sub_f32 v68, v68, v146
    v_sub_f32 v4, v4, v146
    v_sub_f32 v36, v36, v146
    v_sub_f32 v69, v69, v146
    v_sub_f32 v5, v5, v146
    v_sub_f32 v37, v37, v146
    v_sub_f32 v70, v70, v146
    v_sub_f32 v6, v6, v146
    v_sub_f32 v38, v38, v146
    v_sub_f32 v71, v71, v146
    v_sub_f32 v7, v7, v146
    v_sub_f32 v39, v39, v146
    v_sub_f32 v72, v72, v146
    v_sub_f32 v8, v8, v146
    v_sub_f32 v40, v40, v146
    v_sub_f32 v73, v73, v146
    v_sub_f32 v9, v9, v146
    v_sub_f32 v41, v41, v146
    v_sub_f32 v74, v74, v146
    v_sub_f32 v10, v10, v146
    v_sub_f32 v42, v42, v146
    v_sub_f32 v75, v75, v146
    v_sub_f32 v11, v11, v146
    v_sub_f32 v43, v43, v146
    v_sub_f32 v76, v76, v146
    v_sub_f32 v12, v12, v146
    v_sub_f32 v44, v44, v146
    v_sub_f32 v77, v77, v146
    v_sub_f32 v13, v13, v146
    v_sub_f32 v45, v45, v146
    v_sub_f32 v78, v78, v146
    v_sub_f32 v14, v14, v146
    v_sub_f32 v46, v46, v146
    v_sub_f32 v79, v79, v146
    v_sub_f32 v15, v15, v146
    v_sub_f32 v47, v47, v146
    v_mul_f32 v142, v142, v148
    v_accvgpr_read_b32 v150, a0
    v_mul_f32 v150, v150, v148
    v_accvgpr_write_b32 a0, v150
    v_accvgpr_read_b32 v151, a1
    v_mul_f32 v151, v151, v148
    v_accvgpr_write_b32 a1, v151
    v_accvgpr_read_b32 v152, a2
    v_mul_f32 v152, v152, v148
    v_accvgpr_write_b32 a2, v152
    v_accvgpr_read_b32 v153, a3
    v_mul_f32 v153, v153, v148
    v_accvgpr_write_b32 a3, v153
    v_accvgpr_read_b32 v150, a4
    v_mul_f32 v150, v150, v148
    v_accvgpr_write_b32 a4, v150
    v_accvgpr_read_b32 v151, a5
    v_mul_f32 v151, v151, v148
    v_accvgpr_write_b32 a5, v151
    v_accvgpr_read_b32 v152, a6
    v_mul_f32 v152, v152, v148
    v_accvgpr_write_b32 a6, v152
    v_accvgpr_read_b32 v153, a7
    v_mul_f32 v153, v153, v148
    v_accvgpr_write_b32 a7, v153
    v_accvgpr_read_b32 v150, a8
    v_mul_f32 v150, v150, v148
    v_accvgpr_write_b32 a8, v150
    v_accvgpr_read_b32 v151, a9
    v_mul_f32 v151, v151, v148
    v_accvgpr_write_b32 a9, v151
    v_accvgpr_read_b32 v152, a10
    v_mul_f32 v152, v152, v148
    v_accvgpr_write_b32 a10, v152
    v_accvgpr_read_b32 v153, a11
    v_mul_f32 v153, v153, v148
    v_accvgpr_write_b32 a11, v153
    v_accvgpr_read_b32 v150, a12
    v_mul_f32 v150, v150, v148
    v_accvgpr_write_b32 a12, v150
    v_accvgpr_read_b32 v151, a13
    v_mul_f32 v151, v151, v148
    v_accvgpr_write_b32 a13, v151
    v_accvgpr_read_b32 v152, a14
    v_mul_f32 v152, v152, v148
    v_accvgpr_write_b32 a14, v152
    v_accvgpr_read_b32 v153, a15
    v_mul_f32 v153, v153, v148
    v_accvgpr_write_b32 a15, v153
    v_accvgpr_read_b32 v150, a16
    v_mul_f32 v150, v150, v148
    v_accvgpr_write_b32 a16, v150
    v_accvgpr_read_b32 v151, a17
    v_mul_f32 v151, v151, v148
    v_accvgpr_write_b32 a17, v151
    v_accvgpr_read_b32 v152, a18
    v_mul_f32 v152, v152, v148
    v_accvgpr_write_b32 a18, v152
    v_accvgpr_read_b32 v153, a19
    v_mul_f32 v153, v153, v148
    v_accvgpr_write_b32 a19, v153
    v_accvgpr_read_b32 v150, a20
    v_mul_f32 v150, v150, v148
    v_accvgpr_write_b32 a20, v150
    v_accvgpr_read_b32 v151, a21
    v_mul_f32 v151, v151, v148
    v_accvgpr_write_b32 a21, v151
    v_accvgpr_read_b32 v152, a22
    v_mul_f32 v152, v152, v148
    v_accvgpr_write_b32 a22, v152
    v_accvgpr_read_b32 v153, a23
    v_mul_f32 v153, v153, v148
    v_accvgpr_write_b32 a23, v153
    v_accvgpr_read_b32 v150, a24
    v_mul_f32 v150, v150, v148
    v_accvgpr_write_b32 a24, v150
    v_accvgpr_read_b32 v151, a25
    v_mul_f32 v151, v151, v148
    v_accvgpr_write_b32 a25, v151
    v_accvgpr_read_b32 v152, a26
    v_mul_f32 v152, v152, v148
    v_accvgpr_write_b32 a26, v152
    v_accvgpr_read_b32 v153, a27
    v_mul_f32 v153, v153, v148
    v_accvgpr_write_b32 a27, v153
    v_accvgpr_read_b32 v150, a28
    v_mul_f32 v150, v150, v148
    v_accvgpr_write_b32 a28, v150
    v_accvgpr_read_b32 v151, a29
    v_mul_f32 v151, v151, v148
    v_accvgpr_write_b32 a29, v151
    v_accvgpr_read_b32 v152, a30
    v_mul_f32 v152, v152, v148
    v_accvgpr_write_b32 a30, v152
    v_accvgpr_read_b32 v153, a31
    v_mul_f32 v153, v153, v148
    v_accvgpr_write_b32 a31, v153
    v_accvgpr_read_b32 v150, a32
    v_mul_f32 v150, v150, v148
    v_accvgpr_write_b32 a32, v150
    v_accvgpr_read_b32 v151, a33
    v_mul_f32 v151, v151, v148
    v_accvgpr_write_b32 a33, v151
    v_accvgpr_read_b32 v152, a34
    v_mul_f32 v152, v152, v148
    v_accvgpr_write_b32 a34, v152
    v_accvgpr_read_b32 v153, a35
    v_mul_f32 v153, v153, v148
    v_accvgpr_write_b32 a35, v153
    v_accvgpr_read_b32 v150, a36
    v_mul_f32 v150, v150, v148
    v_accvgpr_write_b32 a36, v150
    v_accvgpr_read_b32 v151, a37
    v_mul_f32 v151, v151, v148
    v_accvgpr_write_b32 a37, v151
    v_accvgpr_read_b32 v152, a38
    v_mul_f32 v152, v152, v148
    v_accvgpr_write_b32 a38, v152
    v_accvgpr_read_b32 v153, a39
    v_mul_f32 v153, v153, v148
    v_accvgpr_write_b32 a39, v153
    v_accvgpr_read_b32 v150, a40
    v_mul_f32 v150, v150, v148
    v_accvgpr_write_b32 a40, v150
    v_accvgpr_read_b32 v151, a41
    v_mul_f32 v151, v151, v148
    v_accvgpr_write_b32 a41, v151
    v_accvgpr_read_b32 v152, a42
    v_mul_f32 v152, v152, v148
    v_accvgpr_write_b32 a42, v152
    v_accvgpr_read_b32 v153, a43
    v_mul_f32 v153, v153, v148
    v_accvgpr_write_b32 a43, v153
    v_accvgpr_read_b32 v150, a44
    v_mul_f32 v150, v150, v148
    v_accvgpr_write_b32 a44, v150
    v_accvgpr_read_b32 v151, a45
    v_mul_f32 v151, v151, v148
    v_accvgpr_write_b32 a45, v151
    v_accvgpr_read_b32 v152, a46
    v_mul_f32 v152, v152, v148
    v_accvgpr_write_b32 a46, v152
    v_accvgpr_read_b32 v153, a47
    v_mul_f32 v153, v153, v148
    v_accvgpr_write_b32 a47, v153
    v_accvgpr_read_b32 v150, a48
    v_mul_f32 v150, v150, v148
    v_accvgpr_write_b32 a48, v150
    v_accvgpr_read_b32 v151, a49
    v_mul_f32 v151, v151, v148
    v_accvgpr_write_b32 a49, v151
    v_accvgpr_read_b32 v152, a50
    v_mul_f32 v152, v152, v148
    v_accvgpr_write_b32 a50, v152
    v_accvgpr_read_b32 v153, a51
    v_mul_f32 v153, v153, v148
    v_accvgpr_write_b32 a51, v153
    v_accvgpr_read_b32 v150, a52
    v_mul_f32 v150, v150, v148
    v_accvgpr_write_b32 a52, v150
    v_accvgpr_read_b32 v151, a53
    v_mul_f32 v151, v151, v148
    v_accvgpr_write_b32 a53, v151
    v_accvgpr_read_b32 v152, a54
    v_mul_f32 v152, v152, v148
    v_accvgpr_write_b32 a54, v152
    v_accvgpr_read_b32 v153, a55
    v_mul_f32 v153, v153, v148
    v_accvgpr_write_b32 a55, v153
    v_accvgpr_read_b32 v150, a56
    v_mul_f32 v150, v150, v148
    v_accvgpr_write_b32 a56, v150
    v_accvgpr_read_b32 v151, a57
    v_mul_f32 v151, v151, v148
    v_accvgpr_write_b32 a57, v151
    v_accvgpr_read_b32 v152, a58
    v_mul_f32 v152, v152, v148
    v_accvgpr_write_b32 a58, v152
    v_accvgpr_read_b32 v153, a59
    v_mul_f32 v153, v153, v148
    v_accvgpr_write_b32 a59, v153
    v_accvgpr_read_b32 v150, a60
    v_mul_f32 v150, v150, v148
    v_accvgpr_write_b32 a60, v150
    v_accvgpr_read_b32 v151, a61
    v_mul_f32 v151, v151, v148
    v_accvgpr_write_b32 a61, v151
    v_accvgpr_read_b32 v152, a62
    v_mul_f32 v152, v152, v148
    v_accvgpr_write_b32 a62, v152
    v_accvgpr_read_b32 v153, a63
    v_mul_f32 v153, v153, v148
    v_accvgpr_write_b32 a63, v153
    v_exp_f32 v136, v32
    v_exp_f32 v137, v33
    v_exp_f32 v130, v34
    v_exp_f32 v131, v35
    v_cvt_pk_bf16_f32 v112, v136, v137
    v_exp_f32 v132, v36
    v_exp_f32 v133, v37
    v_cvt_pk_bf16_f32 v113, v130, v131
    v_add_f32 v136, v136, v130
    v_add_f32 v137, v137, v131
    v_exp_f32 v134, v38
    v_exp_f32 v135, v39
    v_cvt_pk_bf16_f32 v114, v132, v133
    v_add_f32 v136, v136, v132
    v_add_f32 v137, v137, v133
    v_exp_f32 v128, v40
    v_exp_f32 v129, v41
    v_cvt_pk_bf16_f32 v115, v134, v135
    v_add_f32 v136, v136, v134
    v_add_f32 v137, v137, v135
    v_exp_f32 v130, v42
    v_exp_f32 v131, v43
    v_cvt_pk_bf16_f32 v116, v128, v129
    v_add_f32 v136, v136, v128
    v_add_f32 v137, v137, v129
    v_exp_f32 v132, v44
    v_exp_f32 v133, v45
    v_cvt_pk_bf16_f32 v117, v130, v131
    v_add_f32 v136, v136, v130
    v_add_f32 v137, v137, v131
    v_exp_f32 v134, v46
    v_exp_f32 v135, v47
    v_cvt_pk_bf16_f32 v118, v132, v133
    v_add_f32 v136, v136, v132
    v_add_f32 v137, v137, v133
    v_cvt_pk_bf16_f32 v119, v134, v135
    v_add_f32 v136, v136, v134
    v_add_f32 v137, v137, v135
    v_add_f32 v140, v136, v137
    v_max3_f32 v146, v48, v49, v50
    v_max3_f32 v146, v146, v51, v52
    v_max3_f32 v146, v146, v53, v54
    v_max3_f32 v146, v146, v55, v56
    v_max3_f32 v146, v146, v57, v58
    v_max3_f32 v146, v146, v59, v60
    v_max3_f32 v146, v146, v61, v62
    v_max_f32 v146, v146, v63
    v_mov_b32 v147, v146
    s_nop 1
    v_permlane32_swap_b32 v146, v147
    s_nop 0
    v_max_f32 v146, v146, v147
    v_max_f32 v146, 0, v146
    v_sub_f32 v148, 0, v146
    v_exp_f32 v148, v148
    v_sub_f32 v145, v145, v146
    v_sub_f32 v80, v80, v146
    v_sub_f32 v16, v16, v146
    v_sub_f32 v48, v48, v146
    v_sub_f32 v81, v81, v146
    v_sub_f32 v17, v17, v146
    v_sub_f32 v49, v49, v146
    v_sub_f32 v82, v82, v146
    v_sub_f32 v18, v18, v146
    v_sub_f32 v50, v50, v146
    v_sub_f32 v83, v83, v146
    v_sub_f32 v19, v19, v146
    v_sub_f32 v51, v51, v146
    v_sub_f32 v84, v84, v146
    v_sub_f32 v20, v20, v146
    v_sub_f32 v52, v52, v146
    v_sub_f32 v85, v85, v146
    v_sub_f32 v21, v21, v146
    v_sub_f32 v53, v53, v146
    v_sub_f32 v86, v86, v146
    v_sub_f32 v22, v22, v146
    v_sub_f32 v54, v54, v146
    v_sub_f32 v87, v87, v146
    v_sub_f32 v23, v23, v146
    v_sub_f32 v55, v55, v146
    v_sub_f32 v88, v88, v146
    v_sub_f32 v24, v24, v146
    v_sub_f32 v56, v56, v146
    v_sub_f32 v89, v89, v146
    v_sub_f32 v25, v25, v146
    v_sub_f32 v57, v57, v146
    v_sub_f32 v90, v90, v146
    v_sub_f32 v26, v26, v146
    v_sub_f32 v58, v58, v146
    v_sub_f32 v91, v91, v146
    v_sub_f32 v27, v27, v146
    v_sub_f32 v59, v59, v146
    v_sub_f32 v92, v92, v146
    v_sub_f32 v28, v28, v146
    v_sub_f32 v60, v60, v146
    v_sub_f32 v93, v93, v146
    v_sub_f32 v29, v29, v146
    v_sub_f32 v61, v61, v146
    v_sub_f32 v94, v94, v146
    v_sub_f32 v30, v30, v146
    v_sub_f32 v62, v62, v146
    v_sub_f32 v95, v95, v146
    v_sub_f32 v31, v31, v146
    v_sub_f32 v63, v63, v146
    v_mul_f32 v143, v143, v148
    v_accvgpr_read_b32 v150, a64
    v_mul_f32 v150, v150, v148
    v_accvgpr_write_b32 a64, v150
    v_accvgpr_read_b32 v151, a65
    v_mul_f32 v151, v151, v148
    v_accvgpr_write_b32 a65, v151
    v_accvgpr_read_b32 v152, a66
    v_mul_f32 v152, v152, v148
    v_accvgpr_write_b32 a66, v152
    v_accvgpr_read_b32 v153, a67
    v_mul_f32 v153, v153, v148
    v_accvgpr_write_b32 a67, v153
    v_accvgpr_read_b32 v150, a68
    v_mul_f32 v150, v150, v148
    v_accvgpr_write_b32 a68, v150
    v_accvgpr_read_b32 v151, a69
    v_mul_f32 v151, v151, v148
    v_accvgpr_write_b32 a69, v151
    v_accvgpr_read_b32 v152, a70
    v_mul_f32 v152, v152, v148
    v_accvgpr_write_b32 a70, v152
    v_accvgpr_read_b32 v153, a71
    v_mul_f32 v153, v153, v148
    v_accvgpr_write_b32 a71, v153
    v_accvgpr_read_b32 v150, a72
    v_mul_f32 v150, v150, v148
    v_accvgpr_write_b32 a72, v150
    v_accvgpr_read_b32 v151, a73
    v_mul_f32 v151, v151, v148
    v_accvgpr_write_b32 a73, v151
    v_accvgpr_read_b32 v152, a74
    v_mul_f32 v152, v152, v148
    v_accvgpr_write_b32 a74, v152
    v_accvgpr_read_b32 v153, a75
    v_mul_f32 v153, v153, v148
    v_accvgpr_write_b32 a75, v153
    v_accvgpr_read_b32 v150, a76
    v_mul_f32 v150, v150, v148
    v_accvgpr_write_b32 a76, v150
    v_accvgpr_read_b32 v151, a77
    v_mul_f32 v151, v151, v148
    v_accvgpr_write_b32 a77, v151
    v_accvgpr_read_b32 v152, a78
    v_mul_f32 v152, v152, v148
    v_accvgpr_write_b32 a78, v152
    v_accvgpr_read_b32 v153, a79
    v_mul_f32 v153, v153, v148
    v_accvgpr_write_b32 a79, v153
    v_accvgpr_read_b32 v150, a80
    v_mul_f32 v150, v150, v148
    v_accvgpr_write_b32 a80, v150
    v_accvgpr_read_b32 v151, a81
    v_mul_f32 v151, v151, v148
    v_accvgpr_write_b32 a81, v151
    v_accvgpr_read_b32 v152, a82
    v_mul_f32 v152, v152, v148
    v_accvgpr_write_b32 a82, v152
    v_accvgpr_read_b32 v153, a83
    v_mul_f32 v153, v153, v148
    v_accvgpr_write_b32 a83, v153
    v_accvgpr_read_b32 v150, a84
    v_mul_f32 v150, v150, v148
    v_accvgpr_write_b32 a84, v150
    v_accvgpr_read_b32 v151, a85
    v_mul_f32 v151, v151, v148
    v_accvgpr_write_b32 a85, v151
    v_accvgpr_read_b32 v152, a86
    v_mul_f32 v152, v152, v148
    v_accvgpr_write_b32 a86, v152
    v_accvgpr_read_b32 v153, a87
    v_mul_f32 v153, v153, v148
    v_accvgpr_write_b32 a87, v153
    v_accvgpr_read_b32 v150, a88
    v_mul_f32 v150, v150, v148
    v_accvgpr_write_b32 a88, v150
    v_accvgpr_read_b32 v151, a89
    v_mul_f32 v151, v151, v148
    v_accvgpr_write_b32 a89, v151
    v_accvgpr_read_b32 v152, a90
    v_mul_f32 v152, v152, v148
    v_accvgpr_write_b32 a90, v152
    v_accvgpr_read_b32 v153, a91
    v_mul_f32 v153, v153, v148
    v_accvgpr_write_b32 a91, v153
    v_accvgpr_read_b32 v150, a92
    v_mul_f32 v150, v150, v148
    v_accvgpr_write_b32 a92, v150
    v_accvgpr_read_b32 v151, a93
    v_mul_f32 v151, v151, v148
    v_accvgpr_write_b32 a93, v151
    v_accvgpr_read_b32 v152, a94
    v_mul_f32 v152, v152, v148
    v_accvgpr_write_b32 a94, v152
    v_accvgpr_read_b32 v153, a95
    v_mul_f32 v153, v153, v148
    v_accvgpr_write_b32 a95, v153
    v_accvgpr_read_b32 v150, a96
    v_mul_f32 v150, v150, v148
    v_accvgpr_write_b32 a96, v150
    v_accvgpr_read_b32 v151, a97
    v_mul_f32 v151, v151, v148
    v_accvgpr_write_b32 a97, v151
    v_accvgpr_read_b32 v152, a98
    v_mul_f32 v152, v152, v148
    v_accvgpr_write_b32 a98, v152
    v_accvgpr_read_b32 v153, a99
    v_mul_f32 v153, v153, v148
    v_accvgpr_write_b32 a99, v153
    v_accvgpr_read_b32 v150, a100
    v_mul_f32 v150, v150, v148
    v_accvgpr_write_b32 a100, v150
    v_accvgpr_read_b32 v151, a101
    v_mul_f32 v151, v151, v148
    v_accvgpr_write_b32 a101, v151
    v_accvgpr_read_b32 v152, a102
    v_mul_f32 v152, v152, v148
    v_accvgpr_write_b32 a102, v152
    v_accvgpr_read_b32 v153, a103
    v_mul_f32 v153, v153, v148
    v_accvgpr_write_b32 a103, v153
    v_accvgpr_read_b32 v150, a104
    v_mul_f32 v150, v150, v148
    v_accvgpr_write_b32 a104, v150
    v_accvgpr_read_b32 v151, a105
    v_mul_f32 v151, v151, v148
    v_accvgpr_write_b32 a105, v151
    v_accvgpr_read_b32 v152, a106
    v_mul_f32 v152, v152, v148
    v_accvgpr_write_b32 a106, v152
    v_accvgpr_read_b32 v153, a107
    v_mul_f32 v153, v153, v148
    v_accvgpr_write_b32 a107, v153
    v_accvgpr_read_b32 v150, a108
    v_mul_f32 v150, v150, v148
    v_accvgpr_write_b32 a108, v150
    v_accvgpr_read_b32 v151, a109
    v_mul_f32 v151, v151, v148
    v_accvgpr_write_b32 a109, v151
    v_accvgpr_read_b32 v152, a110
    v_mul_f32 v152, v152, v148
    v_accvgpr_write_b32 a110, v152
    v_accvgpr_read_b32 v153, a111
    v_mul_f32 v153, v153, v148
    v_accvgpr_write_b32 a111, v153
    v_accvgpr_read_b32 v150, a112
    v_mul_f32 v150, v150, v148
    v_accvgpr_write_b32 a112, v150
    v_accvgpr_read_b32 v151, a113
    v_mul_f32 v151, v151, v148
    v_accvgpr_write_b32 a113, v151
    v_accvgpr_read_b32 v152, a114
    v_mul_f32 v152, v152, v148
    v_accvgpr_write_b32 a114, v152
    v_accvgpr_read_b32 v153, a115
    v_mul_f32 v153, v153, v148
    v_accvgpr_write_b32 a115, v153
    v_accvgpr_read_b32 v150, a116
    v_mul_f32 v150, v150, v148
    v_accvgpr_write_b32 a116, v150
    v_accvgpr_read_b32 v151, a117
    v_mul_f32 v151, v151, v148
    v_accvgpr_write_b32 a117, v151
    v_accvgpr_read_b32 v152, a118
    v_mul_f32 v152, v152, v148
    v_accvgpr_write_b32 a118, v152
    v_accvgpr_read_b32 v153, a119
    v_mul_f32 v153, v153, v148
    v_accvgpr_write_b32 a119, v153
    v_accvgpr_read_b32 v150, a120
    v_mul_f32 v150, v150, v148
    v_accvgpr_write_b32 a120, v150
    v_accvgpr_read_b32 v151, a121
    v_mul_f32 v151, v151, v148
    v_accvgpr_write_b32 a121, v151
    v_accvgpr_read_b32 v152, a122
    v_mul_f32 v152, v152, v148
    v_accvgpr_write_b32 a122, v152
    v_accvgpr_read_b32 v153, a123
    v_mul_f32 v153, v153, v148
    v_accvgpr_write_b32 a123, v153
    v_accvgpr_read_b32 v150, a124
    v_mul_f32 v150, v150, v148
    v_accvgpr_write_b32 a124, v150
    v_accvgpr_read_b32 v151, a125
    v_mul_f32 v151, v151, v148
    v_accvgpr_write_b32 a125, v151
    v_accvgpr_read_b32 v152, a126
    v_mul_f32 v152, v152, v148
    v_accvgpr_write_b32 a126, v152
    v_accvgpr_read_b32 v153, a127
    v_mul_f32 v153, v153, v148
    v_accvgpr_write_b32 a127, v153
    v_exp_f32 v138, v48
    v_exp_f32 v139, v49
    v_exp_f32 v130, v50
    v_exp_f32 v131, v51
    v_cvt_pk_bf16_f32 v120, v138, v139
    v_exp_f32 v132, v52
    v_exp_f32 v133, v53
    v_cvt_pk_bf16_f32 v121, v130, v131
    v_add_f32 v138, v138, v130
    v_add_f32 v139, v139, v131
    v_exp_f32 v134, v54
    v_exp_f32 v135, v55
    v_cvt_pk_bf16_f32 v122, v132, v133
    v_add_f32 v138, v138, v132
    v_add_f32 v139, v139, v133
    v_exp_f32 v128, v56
    v_exp_f32 v129, v57
    v_cvt_pk_bf16_f32 v123, v134, v135
    v_add_f32 v138, v138, v134
    v_add_f32 v139, v139, v135
    v_exp_f32 v130, v58
    v_exp_f32 v131, v59
    v_cvt_pk_bf16_f32 v124, v128, v129
    v_add_f32 v138, v138, v128
    v_add_f32 v139, v139, v129
    v_exp_f32 v132, v60
    v_exp_f32 v133, v61
    v_cvt_pk_bf16_f32 v125, v130, v131
    v_add_f32 v138, v138, v130
    v_add_f32 v139, v139, v131
    v_exp_f32 v134, v62
    v_exp_f32 v135, v63
    v_cvt_pk_bf16_f32 v126, v132, v133
    v_add_f32 v138, v138, v132
    v_add_f32 v139, v139, v133
    v_cvt_pk_bf16_f32 v127, v134, v135
    v_add_f32 v138, v138, v134
    v_add_f32 v139, v139, v135
    v_add_f32 v141, v138, v139
    s_nop 1
    s_branch k2_rr7
k2_fix9:
    s_cmp_eq_u32 s36, 0
    s_cselect_b32 s24, 0, 0x74000000
    v_subrev_f32 v146, s24, v243
    v_add_f32 v147, 0, v146
    v_min_f32 v64, v144, v147
    v_add_f32 v148, 0xf1800000, v146
    v_min_f32 v65, v144, v148
    v_add_f32 v147, 0xf2000000, v146
    v_min_f32 v66, v144, v147
    v_add_f32 v148, 0xf2400000, v146
    v_min_f32 v67, v144, v148
    v_add_f32 v147, 0xf3000000, v146
    v_min_f32 v68, v144, v147
    v_add_f32 v148, 0xf3100000, v146
    v_min_f32 v69, v144, v148
    v_add_f32 v147, 0xf3200000, v146
    v_min_f32 v70, v144, v147
    v_add_f32 v148, 0xf3300000, v146
    v_min_f32 v71, v144, v148
    v_add_f32 v147, 0xf3800000, v146
    v_min_f32 v72, v144, v147
    v_add_f32 v148, 0xf3880000, v146
    v_min_f32 v73, v144, v148
    v_add_f32 v147, 0xf3900000, v146
    v_min_f32 v74, v144, v147
    v_add_f32 v148, 0xf3980000, v146
    v_min_f32 v75, v144, v148
    v_add_f32 v147, 0xf3c00000, v146
    v_min_f32 v76, v144, v147
    v_add_f32 v148, 0xf3c80000, v146
    v_min_f32 v77, v144, v148
    v_add_f32 v147, 0xf3d00000, v146
    v_min_f32 v78, v144, v147
    v_add_f32 v148, 0xf3d80000, v146
    v_min_f32 v79, v144, v148
    s_nop 1
    s_branch k2_fixr10
k2_rare12:
    s_nop 15
    v_max3_f32 v146, v0, v1, v2
    v_max3_f32 v146, v146, v3, v4
    v_max3_f32 v146, v146, v5, v6
    v_max3_f32 v146, v146, v7, v8
    v_max3_f32 v146, v146, v9, v10
    v_max3_f32 v146, v146, v11, v12
    v_max3_f32 v146, v146, v13, v14
    v_max_f32 v146, v146, v15
    v_mov_b32 v147, v146
    s_nop 1
    v_permlane32_swap_b32 v146, v147
    s_nop 0
    v_max_f32 v146, v146, v147
    v_max_f32 v146, 0, v146
    v_sub_f32 v148, 0, v146
    v_exp_f32 v148, v148
    v_sub_f32 v144, v144, v146
    v_sub_f32 v64, v64, v146
    v_sub_f32 v32, v32, v146
    v_sub_f32 v0, v0, v146
    v_sub_f32 v65, v65, v146
    v_sub_f32 v33, v33, v146
    v_sub_f32 v1, v1, v146
    v_sub_f32 v66, v66, v146
    v_sub_f32 v34, v34, v146
    v_sub_f32 v2, v2, v146
    v_sub_f32 v67, v67, v146
    v_sub_f32 v35, v35, v146
    v_sub_f32 v3, v3, v146
    v_sub_f32 v68, v68, v146
    v_sub_f32 v36, v36, v146
    v_sub_f32 v4, v4, v146
    v_sub_f32 v69, v69, v146
    v_sub_f32 v37, v37, v146
    v_sub_f32 v5, v5, v146
    v_sub_f32 v70, v70, v146
    v_sub_f32 v38, v38, v146
    v_sub_f32 v6, v6, v146
    v_sub_f32 v71, v71, v146
    v_sub_f32 v39, v39, v146
    v_sub_f32 v7, v7, v146
    v_sub_f32 v72, v72, v146
    v_sub_f32 v40, v40, v146
    v_sub_f32 v8, v8, v146
    v_sub_f32 v73, v73, v146
    v_sub_f32 v41, v41, v146
    v_sub_f32 v9, v9, v146
    v_sub_f32 v74, v74, v146
    v_sub_f32 v42, v42, v146
    v_sub_f32 v10, v10, v146
    v_sub_f32 v75, v75, v146
    v_sub_f32 v43, v43, v146
    v_sub_f32 v11, v11, v146
    v_sub_f32 v76, v76, v146
    v_sub_f32 v44, v44, v146
    v_sub_f32 v12, v12, v146
    v_sub_f32 v77, v77, v146
    v_sub_f32 v45, v45, v146
    v_sub_f32 v13, v13, v146
    v_sub_f32 v78, v78, v146
    v_sub_f32 v46, v46, v146
    v_sub_f32 v14, v14, v146
    v_sub_f32 v79, v79, v146
    v_sub_f32 v47, v47, v146
    v_sub_f32 v15, v15, v146
    v_mul_f32 v142, v142, v148
    v_accvgpr_read_b32 v150, a0
    v_mul_f32 v150, v150, v148
    v_accvgpr_write_b32 a0, v150
    v_accvgpr_read_b32 v151, a1
    v_mul_f32 v151, v151, v148
    v_accvgpr_write_b32 a1, v151
    v_accvgpr_read_b32 v152, a2
    v_mul_f32 v152, v152, v148
    v_accvgpr_write_b32 a2, v152
    v_accvgpr_read_b32 v153, a3
    v_mul_f32 v153, v153, v148
    v_accvgpr_write_b32 a3, v153
    v_accvgpr_read_b32 v150, a4
    v_mul_f32 v150, v150, v148
    v_accvgpr_write_b32 a4, v150
    v_accvgpr_read_b32 v151, a5
    v_mul_f32 v151, v151, v148
    v_accvgpr_write_b32 a5, v151
    v_accvgpr_read_b32 v152, a6
    v_mul_f32 v152, v152, v148
    v_accvgpr_write_b32 a6, v152
    v_accvgpr_read_b32 v153, a7
    v_mul_f32 v153, v153, v148
    v_accvgpr_write_b32 a7, v153
    v_accvgpr_read_b32 v150, a8
    v_mul_f32 v150, v150, v148
    v_accvgpr_write_b32 a8, v150
    v_accvgpr_read_b32 v151, a9
    v_mul_f32 v151, v151, v148
    v_accvgpr_write_b32 a9, v151
    v_accvgpr_read_b32 v152, a10
    v_mul_f32 v152, v152, v148
    v_accvgpr_write_b32 a10, v152
    v_accvgpr_read_b32 v153, a11
    v_mul_f32 v153, v153, v148
    v_accvgpr_write_b32 a11, v153
    v_accvgpr_read_b32 v150, a12
    v_mul_f32 v150, v150, v148
    v_accvgpr_write_b32 a12, v150
    v_accvgpr_read_b32 v151, a13
    v_mul_f32 v151, v151, v148
    v_accvgpr_write_b32 a13, v151
    v_accvgpr_read_b32 v152, a14
    v_mul_f32 v152, v152, v148
    v_accvgpr_write_b32 a14, v152
    v_accvgpr_read_b32 v153, a15
    v_mul_f32 v153, v153, v148
    v_accvgpr_write_b32 a15, v153
    v_accvgpr_read_b32 v150, a16
    v_mul_f32 v150, v150, v148
    v_accvgpr_write_b32 a16, v150
    v_accvgpr_read_b32 v151, a17
    v_mul_f32 v151, v151, v148
    v_accvgpr_write_b32 a17, v151
    v_accvgpr_read_b32 v152, a18
    v_mul_f32 v152, v152, v148
    v_accvgpr_write_b32 a18, v152
    v_accvgpr_read_b32 v153, a19
    v_mul_f32 v153, v153, v148
    v_accvgpr_write_b32 a19, v153
    v_accvgpr_read_b32 v150, a20
    v_mul_f32 v150, v150, v148
    v_accvgpr_write_b32 a20, v150
    v_accvgpr_read_b32 v151, a21
    v_mul_f32 v151, v151, v148
    v_accvgpr_write_b32 a21, v151
    v_accvgpr_read_b32 v152, a22
    v_mul_f32 v152, v152, v148
    v_accvgpr_write_b32 a22, v152
    v_accvgpr_read_b32 v153, a23
    v_mul_f32 v153, v153, v148
    v_accvgpr_write_b32 a23, v153
    v_accvgpr_read_b32 v150, a24
    v_mul_f32 v150, v150, v148
    v_accvgpr_write_b32 a24, v150
    v_accvgpr_read_b32 v151, a25
    v_mul_f32 v151, v151, v148
    v_accvgpr_write_b32 a25, v151
    v_accvgpr_read_b32 v152, a26
    v_mul_f32 v152, v152, v148
    v_accvgpr_write_b32 a26, v152
    v_accvgpr_read_b32 v153, a27
    v_mul_f32 v153, v153, v148
    v_accvgpr_write_b32 a27, v153
    v_accvgpr_read_b32 v150, a28
    v_mul_f32 v150, v150, v148
    v_accvgpr_write_b32 a28, v150
    v_accvgpr_read_b32 v151, a29
    v_mul_f32 v151, v151, v148
    v_accvgpr_write_b32 a29, v151
    v_accvgpr_read_b32 v152, a30
    v_mul_f32 v152, v152, v148
    v_accvgpr_write_b32 a30, v152
    v_accvgpr_read_b32 v153, a31
    v_mul_f32 v153, v153, v148
    v_accvgpr_write_b32 a31, v153
    v_accvgpr_read_b32 v150, a32
    v_mul_f32 v150, v150, v148
    v_accvgpr_write_b32 a32, v150
    v_accvgpr_read_b32 v151, a33
    v_mul_f32 v151, v151, v148
    v_accvgpr_write_b32 a33, v151
    v_accvgpr_read_b32 v152, a34
    v_mul_f32 v152, v152, v148
    v_accvgpr_write_b32 a34, v152
    v_accvgpr_read_b32 v153, a35
    v_mul_f32 v153, v153, v148
    v_accvgpr_write_b32 a35, v153
    v_accvgpr_read_b32 v150, a36
    v_mul_f32 v150, v150, v148
    v_accvgpr_write_b32 a36, v150
    v_accvgpr_read_b32 v151, a37
    v_mul_f32 v151, v151, v148
    v_accvgpr_write_b32 a37, v151
    v_accvgpr_read_b32 v152, a38
    v_mul_f32 v152, v152, v148
    v_accvgpr_write_b32 a38, v152
    v_accvgpr_read_b32 v153, a39
    v_mul_f32 v153, v153, v148
    v_accvgpr_write_b32 a39, v153
    v_accvgpr_read_b32 v150, a40
    v_mul_f32 v150, v150, v148
    v_accvgpr_write_b32 a40, v150
    v_accvgpr_read_b32 v151, a41
    v_mul_f32 v151, v151, v148
    v_accvgpr_write_b32 a41, v151
    v_accvgpr_read_b32 v152, a42
    v_mul_f32 v152, v152, v148
    v_accvgpr_write_b32 a42, v152
    v_accvgpr_read_b32 v153, a43
    v_mul_f32 v153, v153, v148
    v_accvgpr_write_b32 a43, v153
    v_accvgpr_read_b32 v150, a44
    v_mul_f32 v150, v150, v148
    v_accvgpr_write_b32 a44, v150
    v_accvgpr_read_b32 v151, a45
    v_mul_f32 v151, v151, v148
    v_accvgpr_write_b32 a45, v151
    v_accvgpr_read_b32 v152, a46
    v_mul_f32 v152, v152, v148
    v_accvgpr_write_b32 a46, v152
    v_accvgpr_read_b32 v153, a47
    v_mul_f32 v153, v153, v148
    v_accvgpr_write_b32 a47, v153
    v_accvgpr_read_b32 v150, a48
    v_mul_f32 v150, v150, v148
    v_accvgpr_write_b32 a48, v150
    v_accvgpr_read_b32 v151, a49
    v_mul_f32 v151, v151, v148
    v_accvgpr_write_b32 a49, v151
    v_accvgpr_read_b32 v152, a50
    v_mul_f32 v152, v152, v148
    v_accvgpr_write_b32 a50, v152
    v_accvgpr_read_b32 v153, a51
    v_mul_f32 v153, v153, v148
    v_accvgpr_write_b32 a51, v153
    v_accvgpr_read_b32 v150, a52
    v_mul_f32 v150, v150, v148
    v_accvgpr_write_b32 a52, v150
    v_accvgpr_read_b32 v151, a53
    v_mul_f32 v151, v151, v148
    v_accvgpr_write_b32 a53, v151
    v_accvgpr_read_b32 v152, a54
    v_mul_f32 v152, v152, v148
    v_accvgpr_write_b32 a54, v152
    v_accvgpr_read_b32 v153, a55
    v_mul_f32 v153, v153, v148
    v_accvgpr_write_b32 a55, v153
    v_accvgpr_read_b32 v150, a56
    v_mul_f32 v150, v150, v148
    v_accvgpr_write_b32 a56, v150
    v_accvgpr_read_b32 v151, a57
    v_mul_f32 v151, v151, v148
    v_accvgpr_write_b32 a57, v151
    v_accvgpr_read_b32 v152, a58
    v_mul_f32 v152, v152, v148
    v_accvgpr_write_b32 a58, v152
    v_accvgpr_read_b32 v153, a59
    v_mul_f32 v153, v153, v148
    v_accvgpr_write_b32 a59, v153
    v_accvgpr_read_b32 v150, a60
    v_mul_f32 v150, v150, v148
    v_accvgpr_write_b32 a60, v150
    v_accvgpr_read_b32 v151, a61
    v_mul_f32 v151, v151, v148
    v_accvgpr_write_b32 a61, v151
    v_accvgpr_read_b32 v152, a62
    v_mul_f32 v152, v152, v148
    v_accvgpr_write_b32 a62, v152
    v_accvgpr_read_b32 v153, a63
    v_mul_f32 v153, v153, v148
    v_accvgpr_write_b32 a63, v153
    v_exp_f32 v136, v0
    v_exp_f32 v137, v1
    v_exp_f32 v130, v2
    v_exp_f32 v131, v3
    v_cvt_pk_bf16_f32 v96, v136, v137
    v_exp_f32 v132, v4
    v_exp_f32 v133, v5
    v_cvt_pk_bf16_f32 v97, v130, v131
    v_add_f32 v136, v136, v130
    v_add_f32 v137, v137, v131
    v_exp_f32 v134, v6
    v_exp_f32 v135, v7
    v_cvt_pk_bf16_f32 v98, v132, v133
    v_add_f32 v136, v136, v132
    v_add_f32 v137, v137, v133
    v_exp_f32 v128, v8
    v_exp_f32 v129, v9
    v_cvt_pk_bf16_f32 v99, v134, v135
    v_add_f32 v136, v136, v134
    v_add_f32 v137, v137, v135
    v_exp_f32 v130, v10
    v_exp_f32 v131, v11
    v_cvt_pk_bf16_f32 v100, v128, v129
    v_add_f32 v136, v136, v128
    v_add_f32 v137, v137, v129
    v_exp_f32 v132, v12
    v_exp_f32 v133, v13
    v_cvt_pk_bf16_f32 v101, v130, v131
    v_add_f32 v136, v136, v130
    v_add_f32 v137, v137, v131
    v_exp_f32 v134, v14
    v_exp_f32 v135, v15
    v_cvt_pk_bf16_f32 v102, v132, v133
    v_add_f32 v136, v136, v132
    v_add_f32 v137, v137, v133
    v_cvt_pk_bf16_f32 v103, v134, v135
    v_add_f32 v136, v136, v134
    v_add_f32 v137, v137, v135
    v_add_f32 v140, v136, v137
    v_max3_f32 v146, v16, v17, v18
    v_max3_f32 v146, v146, v19, v20
    v_max3_f32 v146, v146, v21, v22
    v_max3_f32 v146, v146, v23, v24
    v_max3_f32 v146, v146, v25, v26
    v_max3_f32 v146, v146, v27, v28
    v_max3_f32 v146, v146, v29, v30
    v_max_f32 v146, v146, v31
    v_mov_b32 v147, v146
    s_nop 1
    v_permlane32_swap_b32 v146, v147
    s_nop 0
    v_max_f32 v146, v146, v147
    v_max_f32 v146, 0, v146
    v_sub_f32 v148, 0, v146
    v_exp_f32 v148, v148
    v_sub_f32 v145, v145, v146
    v_sub_f32 v80, v80, v146
    v_sub_f32 v48, v48, v146
    v_sub_f32 v16, v16, v146
    v_sub_f32 v81, v81, v146
    v_sub_f32 v49, v49, v146
    v_sub_f32 v17, v17, v146
    v_sub_f32 v82, v82, v146
    v_sub_f32 v50, v50, v146
    v_sub_f32 v18, v18, v146
    v_sub_f32 v83, v83, v146
    v_sub_f32 v51, v51, v146
    v_sub_f32 v19, v19, v146
    v_sub_f32 v84, v84, v146
    v_sub_f32 v52, v52, v146
    v_sub_f32 v20, v20, v146
    v_sub_f32 v85, v85, v146
    v_sub_f32 v53, v53, v146
    v_sub_f32 v21, v21, v146
    v_sub_f32 v86, v86, v146
    v_sub_f32 v54, v54, v146
    v_sub_f32 v22, v22, v146
    v_sub_f32 v87, v87, v146
    v_sub_f32 v55, v55, v146
    v_sub_f32 v23, v23, v146
    v_sub_f32 v88, v88, v146
    v_sub_f32 v56, v56, v146
    v_sub_f32 v24, v24, v146
    v_sub_f32 v89, v89, v146
    v_sub_f32 v57, v57, v146
    v_sub_f32 v25, v25, v146
    v_sub_f32 v90, v90, v146
    v_sub_f32 v58, v58, v146
    v_sub_f32 v26, v26, v146
    v_sub_f32 v91, v91, v146
    v_sub_f32 v59, v59, v146
    v_sub_f32 v27, v27, v146
    v_sub_f32 v92, v92, v146
    v_sub_f32 v60, v60, v146
    v_sub_f32 v28, v28, v146
    v_sub_f32 v93, v93, v146
    v_sub_f32 v61, v61, v146
    v_sub_f32 v29, v29, v146
    v_sub_f32 v94, v94, v146
    v_sub_f32 v62, v62, v146
    v_sub_f32 v30, v30, v146
    v_sub_f32 v95, v95, v146
    v_sub_f32 v63, v63, v146
    v_sub_f32 v31, v31, v146
    v_mul_f32 v143, v143, v148
    v_accvgpr_read_b32 v150, a64
    v_mul_f32 v150, v150, v148
    v_accvgpr_write_b32 a64, v150
    v_accvgpr_read_b32 v151, a65
    v_mul_f32 v151, v151, v148
    v_accvgpr_write_b32 a65, v151
    v_accvgpr_read_b32 v152, a66
    v_mul_f32 v152, v152, v148
    v_accvgpr_write_b32 a66, v152
    v_accvgpr_read_b32 v153, a67
    v_mul_f32 v153, v153, v148
    v_accvgpr_write_b32 a67, v153
    v_accvgpr_read_b32 v150, a68
    v_mul_f32 v150, v150, v148
    v_accvgpr_write_b32 a68, v150
    v_accvgpr_read_b32 v151, a69
    v_mul_f32 v151, v151, v148
    v_accvgpr_write_b32 a69, v151
    v_accvgpr_read_b32 v152, a70
    v_mul_f32 v152, v152, v148
    v_accvgpr_write_b32 a70, v152
    v_accvgpr_read_b32 v153, a71
    v_mul_f32 v153, v153, v148
    v_accvgpr_write_b32 a71, v153
    v_accvgpr_read_b32 v150, a72
    v_mul_f32 v150, v150, v148
    v_accvgpr_write_b32 a72, v150
    v_accvgpr_read_b32 v151, a73
    v_mul_f32 v151, v151, v148
    v_accvgpr_write_b32 a73, v151
    v_accvgpr_read_b32 v152, a74
    v_mul_f32 v152, v152, v148
    v_accvgpr_write_b32 a74, v152
    v_accvgpr_read_b32 v153, a75
    v_mul_f32 v153, v153, v148
    v_accvgpr_write_b32 a75, v153
    v_accvgpr_read_b32 v150, a76
    v_mul_f32 v150, v150, v148
    v_accvgpr_write_b32 a76, v150
    v_accvgpr_read_b32 v151, a77
    v_mul_f32 v151, v151, v148
    v_accvgpr_write_b32 a77, v151
    v_accvgpr_read_b32 v152, a78
    v_mul_f32 v152, v152, v148
    v_accvgpr_write_b32 a78, v152
    v_accvgpr_read_b32 v153, a79
    v_mul_f32 v153, v153, v148
    v_accvgpr_write_b32 a79, v153
    v_accvgpr_read_b32 v150, a80
    v_mul_f32 v150, v150, v148
    v_accvgpr_write_b32 a80, v150
    v_accvgpr_read_b32 v151, a81
    v_mul_f32 v151, v151, v148
    v_accvgpr_write_b32 a81, v151
    v_accvgpr_read_b32 v152, a82
    v_mul_f32 v152, v152, v148
    v_accvgpr_write_b32 a82, v152
    v_accvgpr_read_b32 v153, a83
    v_mul_f32 v153, v153, v148
    v_accvgpr_write_b32 a83, v153
    v_accvgpr_read_b32 v150, a84
    v_mul_f32 v150, v150, v148
    v_accvgpr_write_b32 a84, v150
    v_accvgpr_read_b32 v151, a85
    v_mul_f32 v151, v151, v148
    v_accvgpr_write_b32 a85, v151
    v_accvgpr_read_b32 v152, a86
    v_mul_f32 v152, v152, v148
    v_accvgpr_write_b32 a86, v152
    v_accvgpr_read_b32 v153, a87
    v_mul_f32 v153, v153, v148
    v_accvgpr_write_b32 a87, v153
    v_accvgpr_read_b32 v150, a88
    v_mul_f32 v150, v150, v148
    v_accvgpr_write_b32 a88, v150
    v_accvgpr_read_b32 v151, a89
    v_mul_f32 v151, v151, v148
    v_accvgpr_write_b32 a89, v151
    v_accvgpr_read_b32 v152, a90
    v_mul_f32 v152, v152, v148
    v_accvgpr_write_b32 a90, v152
    v_accvgpr_read_b32 v153, a91
    v_mul_f32 v153, v153, v148
    v_accvgpr_write_b32 a91, v153
    v_accvgpr_read_b32 v150, a92
    v_mul_f32 v150, v150, v148
    v_accvgpr_write_b32 a92, v150
    v_accvgpr_read_b32 v151, a93
    v_mul_f32 v151, v151, v148
    v_accvgpr_write_b32 a93, v151
    v_accvgpr_read_b32 v152, a94
    v_mul_f32 v152, v152, v148
    v_accvgpr_write_b32 a94, v152
    v_accvgpr_read_b32 v153, a95
    v_mul_f32 v153, v153, v148
    v_accvgpr_write_b32 a95, v153
    v_accvgpr_read_b32 v150, a96
    v_mul_f32 v150, v150, v148
    v_accvgpr_write_b32 a96, v150
    v_accvgpr_read_b32 v151, a97
    v_mul_f32 v151, v151, v148
    v_accvgpr_write_b32 a97, v151
    v_accvgpr_read_b32 v152, a98
    v_mul_f32 v152, v152, v148
    v_accvgpr_write_b32 a98, v152
    v_accvgpr_read_b32 v153, a99
    v_mul_f32 v153, v153, v148
    v_accvgpr_write_b32 a99, v153
    v_accvgpr_read_b32 v150, a100
    v_mul_f32 v150, v150, v148
    v_accvgpr_write_b32 a100, v150
    v_accvgpr_read_b32 v151, a101
    v_mul_f32 v151, v151, v148
    v_accvgpr_write_b32 a101, v151
    v_accvgpr_read_b32 v152, a102
    v_mul_f32 v152, v152, v148
    v_accvgpr_write_b32 a102, v152
    v_accvgpr_read_b32 v153, a103
    v_mul_f32 v153, v153, v148
    v_accvgpr_write_b32 a103, v153
    v_accvgpr_read_b32 v150, a104
    v_mul_f32 v150, v150, v148
    v_accvgpr_write_b32 a104, v150
    v_accvgpr_read_b32 v151, a105
    v_mul_f32 v151, v151, v148
    v_accvgpr_write_b32 a105, v151
    v_accvgpr_read_b32 v152, a106
    v_mul_f32 v152, v152, v148
    v_accvgpr_write_b32 a106, v152
    v_accvgpr_read_b32 v153, a107
    v_mul_f32 v153, v153, v148
    v_accvgpr_write_b32 a107, v153
    v_accvgpr_read_b32 v150, a108
    v_mul_f32 v150, v150, v148
    v_accvgpr_write_b32 a108, v150
    v_accvgpr_read_b32 v151, a109
    v_mul_f32 v151, v151, v148
    v_accvgpr_write_b32 a109, v151
    v_accvgpr_read_b32 v152, a110
    v_mul_f32 v152, v152, v148
    v_accvgpr_write_b32 a110, v152
    v_accvgpr_read_b32 v153, a111
    v_mul_f32 v153, v153, v148
    v_accvgpr_write_b32 a111, v153
    v_accvgpr_read_b32 v150, a112
    v_mul_f32 v150, v150, v148
    v_accvgpr_write_b32 a112, v150
    v_accvgpr_read_b32 v151, a113
    v_mul_f32 v151, v151, v148
    v_accvgpr_write_b32 a113, v151
    v_accvgpr_read_b32 v152, a114
    v_mul_f32 v152, v152, v148
    v_accvgpr_write_b32 a114, v152
    v_accvgpr_read_b32 v153, a115
    v_mul_f32 v153, v153, v148
    v_accvgpr_write_b32 a115, v153
    v_accvgpr_read_b32 v150, a116
    v_mul_f32 v150, v150, v148
    v_accvgpr_write_b32 a116, v150
    v_accvgpr_read_b32 v151, a117
    v_mul_f32 v151, v151, v148
    v_accvgpr_write_b32 a117, v151
    v_accvgpr_read_b32 v152, a118
    v_mul_f32 v152, v152, v148
    v_accvgpr_write_b32 a118, v152
    v_accvgpr_read_b32 v153, a119
    v_mul_f32 v153, v153, v148
    v_accvgpr_write_b32 a119, v153
    v_accvgpr_read_b32 v150, a120
    v_mul_f32 v150, v150, v148
    v_accvgpr_write_b32 a120, v150
    v_accvgpr_read_b32 v151, a121
    v_mul_f32 v151, v151, v148
    v_accvgpr_write_b32 a121, v151
    v_accvgpr_read_b32 v152, a122
    v_mul_f32 v152, v152, v148
    v_accvgpr_write_b32 a122, v152
    v_accvgpr_read_b32 v153, a123
    v_mul_f32 v153, v153, v148
    v_accvgpr_write_b32 a123, v153
    v_accvgpr_read_b32 v150, a124
    v_mul_f32 v150, v150, v148
    v_accvgpr_write_b32 a124, v150
    v_accvgpr_read_b32 v151, a125
    v_mul_f32 v151, v151, v148
    v_accvgpr_write_b32 a125, v151
    v_accvgpr_read_b32 v152, a126
    v_mul_f32 v152, v152, v148
    v_accvgpr_write_b32 a126, v152
    v_accvgpr_read_b32 v153, a127
    v_mul_f32 v153, v153, v148
    v_accvgpr_write_b32 a127, v153
    v_exp_f32 v138, v16
    v_exp_f32 v139, v17
    v_exp_f32 v130, v18
    v_exp_f32 v131, v19
    v_cvt_pk_bf16_f32 v104, v138, v139
    v_exp_f32 v132, v20
    v_exp_f32 v133, v21
    v_cvt_pk_bf16_f32 v105, v130, v131
    v_add_f32 v138, v138, v130
    v_add_f32 v139, v139, v131
    v_exp_f32 v134, v22
    v_exp_f32 v135, v23
    v_cvt_pk_bf16_f32 v106, v132, v133
    v_add_f32 v138, v138, v132
    v_add_f32 v139, v139, v133
    v_exp_f32 v128, v24
    v_exp_f32 v129, v25
    v_cvt_pk_bf16_f32 v107, v134, v135
    v_add_f32 v138, v138, v134
    v_add_f32 v139, v139, v135
    v_exp_f32 v130, v26
    v_exp_f32 v131, v27
    v_cvt_pk_bf16_f32 v108, v128, v129
    v_add_f32 v138, v138, v128
    v_add_f32 v139, v139, v129
    v_exp_f32 v132, v28
    v_exp_f32 v133, v29
    v_cvt_pk_bf16_f32 v109, v130, v131
    v_add_f32 v138, v138, v130
    v_add_f32 v139, v139, v131
    v_exp_f32 v134, v30
    v_exp_f32 v135, v31
    v_cvt_pk_bf16_f32 v110, v132, v133
    v_add_f32 v138, v138, v132
    v_add_f32 v139, v139, v133
    v_cvt_pk_bf16_f32 v111, v134, v135
    v_add_f32 v138, v138, v134
    v_add_f32 v139, v139, v135
    v_add_f32 v141, v138, v139
    s_nop 1
    s_branch k2_rr11
k2_fix13:
    s_cmp_eq_u32 s36, 0
    s_cselect_b32 s24, 0, 0x74000000
    v_subrev_f32 v146, s24, v243
    v_add_f32 v147, 0, v146
    v_min_f32 v80, v145, v147
    v_add_f32 v148, 0xf1800000, v146
    v_min_f32 v81, v145, v148
    v_add_f32 v147, 0xf2000000, v146
    v_min_f32 v82, v145, v147
    v_add_f32 v148, 0xf2400000, v146
    v_min_f32 v83, v145, v148
    v_add_f32 v147, 0xf3000000, v146
    v_min_f32 v84, v145, v147
    v_add_f32 v148, 0xf3100000, v146
    v_min_f32 v85, v145, v148
    v_add_f32 v147, 0xf3200000, v146
    v_min_f32 v86, v145, v147
    v_add_f32 v148, 0xf3300000, v146
    v_min_f32 v87, v145, v148
    v_add_f32 v147, 0xf3800000, v146
    v_min_f32 v88, v145, v147
    v_add_f32 v148, 0xf3880000, v146
    v_min_f32 v89, v145, v148
    v_add_f32 v147, 0xf3900000, v146
    v_min_f32 v90, v145, v147
    v_add_f32 v148, 0xf3980000, v146
    v_min_f32 v91, v145, v148
    v_add_f32 v147, 0xf3c00000, v146
    v_min_f32 v92, v145, v147
    v_add_f32 v148, 0xf3c80000, v146
    v_min_f32 v93, v145, v148
    v_add_f32 v147, 0xf3d00000, v146
    v_min_f32 v94, v145, v147
    v_add_f32 v148, 0xf3d80000, v146
    v_min_f32 v95, v145, v148
    s_nop 1
    s_branch k2_fixr14
k2_rare16:
    s_nop 15
    v_max3_f32 v146, v32, v33, v34
    v_max3_f32 v146, v146, v35, v36
    v_max3_f32 v146, v146, v37, v38
    v_max3_f32 v146, v146, v39, v40
    v_max3_f32 v146, v146, v41, v42
    v_max3_f32 v146, v146, v43, v44
    v_max3_f32 v146, v146, v45, v46
    v_max_f32 v146, v146, v47
    v_mov_b32 v147, v146
    s_nop 1
    v_permlane32_swap_b32 v146, v147
    s_nop 0
    v_max_f32 v146, v146, v147
    v_max_f32 v146, 0, v146
    v_sub_f32 v148, 0, v146
    v_exp_f32 v148, v148
    v_sub_f32 v144, v144, v146
    v_sub_f32 v64, v64, v146
    v_sub_f32 v0, v0, v146
    v_sub_f32 v32, v32, v146
    v_sub_f32 v65, v65, v146
    v_sub_f32 v1, v1, v146
    v_sub_f32 v33, v33, v146
    v_sub_f32 v66, v66, v146
    v_sub_f32 v2, v2, v146
    v_sub_f32 v34, v34, v146
    v_sub_f32 v67, v67, v146
    v_sub_f32 v3, v3, v146
    v_sub_f32 v35, v35, v146
    v_sub_f32 v68, v68, v146
    v_sub_f32 v4, v4, v146
    v_sub_f32 v36, v36, v146
    v_sub_f32 v69, v69, v146
    v_sub_f32 v5, v5, v146
    v_sub_f32 v37, v37, v146
    v_sub_f32 v70, v70, v146
    v_sub_f32 v6, v6, v146
    v_sub_f32 v38, v38, v146
    v_sub_f32 v71, v71, v146
    v_sub_f32 v7, v7, v146
    v_sub_f32 v39, v39, v146
    v_sub_f32 v72, v72, v146
    v_sub_f32 v8, v8, v146
    v_sub_f32 v40, v40, v146
    v_sub_f32 v73, v73, v146
    v_sub_f32 v9, v9, v146
    v_sub_f32 v41, v41, v146
    v_sub_f32 v74, v74, v146
    v_sub_f32 v10, v10, v146
    v_sub_f32 v42, v42, v146
    v_sub_f32 v75, v75, v146
    v_sub_f32 v11, v11, v146
    v_sub_f32 v43, v43, v146
    v_sub_f32 v76, v76, v146
    v_sub_f32 v12, v12, v146
    v_sub_f32 v44, v44, v146
    v_sub_f32 v77, v77, v146
    v_sub_f32 v13, v13, v146
    v_sub_f32 v45, v45, v146
    v_sub_f32 v78, v78, v146
    v_sub_f32 v14, v14, v146
    v_sub_f32 v46, v46, v146
    v_sub_f32 v79, v79, v146
    v_sub_f32 v15, v15, v146
    v_sub_f32 v47, v47, v146
    v_mul_f32 v142, v142, v148
    v_accvgpr_read_b32 v150, a0
    v_mul_f32 v150, v150, v148
    v_accvgpr_write_b32 a0, v150
    v_accvgpr_read_b32 v151, a1
    v_mul_f32 v151, v151, v148
    v_accvgpr_write_b32 a1, v151
    v_accvgpr_read_b32 v152, a2
    v_mul_f32 v152, v152, v148
    v_accvgpr_write_b32 a2, v152
    v_accvgpr_read_b32 v153, a3
    v_mul_f32 v153, v153, v148
    v_accvgpr_write_b32 a3, v153
    v_accvgpr_read_b32 v150, a4
    v_mul_f32 v150, v150, v148
    v_accvgpr_write_b32 a4, v150
    v_accvgpr_read_b32 v151, a5
    v_mul_f32 v151, v151, v148
    v_accvgpr_write_b32 a5, v151
    v_accvgpr_read_b32 v152, a6
    v_mul_f32 v152, v152, v148
    v_accvgpr_write_b32 a6, v152
    v_accvgpr_read_b32 v153, a7
    v_mul_f32 v153, v153, v148
    v_accvgpr_write_b32 a7, v153
    v_accvgpr_read_b32 v150, a8
    v_mul_f32 v150, v150, v148
    v_accvgpr_write_b32 a8, v150
    v_accvgpr_read_b32 v151, a9
    v_mul_f32 v151, v151, v148
    v_accvgpr_write_b32 a9, v151
    v_accvgpr_read_b32 v152, a10
    v_mul_f32 v152, v152, v148
    v_accvgpr_write_b32 a10, v152
    v_accvgpr_read_b32 v153, a11
    v_mul_f32 v153, v153, v148
    v_accvgpr_write_b32 a11, v153
    v_accvgpr_read_b32 v150, a12
    v_mul_f32 v150, v150, v148
    v_accvgpr_write_b32 a12, v150
    v_accvgpr_read_b32 v151, a13
    v_mul_f32 v151, v151, v148
    v_accvgpr_write_b32 a13, v151
    v_accvgpr_read_b32 v152, a14
    v_mul_f32 v152, v152, v148
    v_accvgpr_write_b32 a14, v152
    v_accvgpr_read_b32 v153, a15
    v_mul_f32 v153, v153, v148
    v_accvgpr_write_b32 a15, v153
    v_accvgpr_read_b32 v150, a16
    v_mul_f32 v150, v150, v148
    v_accvgpr_write_b32 a16, v150
    v_accvgpr_read_b32 v151, a17
    v_mul_f32 v151, v151, v148
    v_accvgpr_write_b32 a17, v151
    v_accvgpr_read_b32 v152, a18
    v_mul_f32 v152, v152, v148
    v_accvgpr_write_b32 a18, v152
    v_accvgpr_read_b32 v153, a19
    v_mul_f32 v153, v153, v148
    v_accvgpr_write_b32 a19, v153
    v_accvgpr_read_b32 v150, a20
    v_mul_f32 v150, v150, v148
    v_accvgpr_write_b32 a20, v150
    v_accvgpr_read_b32 v151, a21
    v_mul_f32 v151, v151, v148
    v_accvgpr_write_b32 a21, v151
    v_accvgpr_read_b32 v152, a22
    v_mul_f32 v152, v152, v148
    v_accvgpr_write_b32 a22, v152
    v_accvgpr_read_b32 v153, a23
    v_mul_f32 v153, v153, v148
    v_accvgpr_write_b32 a23, v153
    v_accvgpr_read_b32 v150, a24
    v_mul_f32 v150, v150, v148
    v_accvgpr_write_b32 a24, v150
    v_accvgpr_read_b32 v151, a25
    v_mul_f32 v151, v151, v148
    v_accvgpr_write_b32 a25, v151
    v_accvgpr_read_b32 v152, a26
    v_mul_f32 v152, v152, v148
    v_accvgpr_write_b32 a26, v152
    v_accvgpr_read_b32 v153, a27
    v_mul_f32 v153, v153, v148
    v_accvgpr_write_b32 a27, v153
    v_accvgpr_read_b32 v150, a28
    v_mul_f32 v150, v150, v148
    v_accvgpr_write_b32 a28, v150
    v_accvgpr_read_b32 v151, a29
    v_mul_f32 v151, v151, v148
    v_accvgpr_write_b32 a29, v151
    v_accvgpr_read_b32 v152, a30
    v_mul_f32 v152, v152, v148
    v_accvgpr_write_b32 a30, v152
    v_accvgpr_read_b32 v153, a31
    v_mul_f32 v153, v153, v148
    v_accvgpr_write_b32 a31, v153
    v_accvgpr_read_b32 v150, a32
    v_mul_f32 v150, v150, v148
    v_accvgpr_write_b32 a32, v150
    v_accvgpr_read_b32 v151, a33
    v_mul_f32 v151, v151, v148
    v_accvgpr_write_b32 a33, v151
    v_accvgpr_read_b32 v152, a34
    v_mul_f32 v152, v152, v148
    v_accvgpr_write_b32 a34, v152
    v_accvgpr_read_b32 v153, a35
    v_mul_f32 v153, v153, v148
    v_accvgpr_write_b32 a35, v153
    v_accvgpr_read_b32 v150, a36
    v_mul_f32 v150, v150, v148
    v_accvgpr_write_b32 a36, v150
    v_accvgpr_read_b32 v151, a37
    v_mul_f32 v151, v151, v148
    v_accvgpr_write_b32 a37, v151
    v_accvgpr_read_b32 v152, a38
    v_mul_f32 v152, v152, v148
    v_accvgpr_write_b32 a38, v152
    v_accvgpr_read_b32 v153, a39
    v_mul_f32 v153, v153, v148
    v_accvgpr_write_b32 a39, v153
    v_accvgpr_read_b32 v150, a40
    v_mul_f32 v150, v150, v148
    v_accvgpr_write_b32 a40, v150
    v_accvgpr_read_b32 v151, a41
    v_mul_f32 v151, v151, v148
    v_accvgpr_write_b32 a41, v151
    v_accvgpr_read_b32 v152, a42
    v_mul_f32 v152, v152, v148
    v_accvgpr_write_b32 a42, v152
    v_accvgpr_read_b32 v153, a43
    v_mul_f32 v153, v153, v148
    v_accvgpr_write_b32 a43, v153
    v_accvgpr_read_b32 v150, a44
    v_mul_f32 v150, v150, v148
    v_accvgpr_write_b32 a44, v150
    v_accvgpr_read_b32 v151, a45
    v_mul_f32 v151, v151, v148
    v_accvgpr_write_b32 a45, v151
    v_accvgpr_read_b32 v152, a46
    v_mul_f32 v152, v152, v148
    v_accvgpr_write_b32 a46, v152
    v_accvgpr_read_b32 v153, a47
    v_mul_f32 v153, v153, v148
    v_accvgpr_write_b32 a47, v153
    v_accvgpr_read_b32 v150, a48
    v_mul_f32 v150, v150, v148
    v_accvgpr_write_b32 a48, v150
    v_accvgpr_read_b32 v151, a49
    v_mul_f32 v151, v151, v148
    v_accvgpr_write_b32 a49, v151
    v_accvgpr_read_b32 v152, a50
    v_mul_f32 v152, v152, v148
    v_accvgpr_write_b32 a50, v152
    v_accvgpr_read_b32 v153, a51
    v_mul_f32 v153, v153, v148
    v_accvgpr_write_b32 a51, v153
    v_accvgpr_read_b32 v150, a52
    v_mul_f32 v150, v150, v148
    v_accvgpr_write_b32 a52, v150
    v_accvgpr_read_b32 v151, a53
    v_mul_f32 v151, v151, v148
    v_accvgpr_write_b32 a53, v151
    v_accvgpr_read_b32 v152, a54
    v_mul_f32 v152, v152, v148
    v_accvgpr_write_b32 a54, v152
    v_accvgpr_read_b32 v153, a55
    v_mul_f32 v153, v153, v148
    v_accvgpr_write_b32 a55, v153
    v_accvgpr_read_b32 v150, a56
    v_mul_f32 v150, v150, v148
    v_accvgpr_write_b32 a56, v150
    v_accvgpr_read_b32 v151, a57
    v_mul_f32 v151, v151, v148
    v_accvgpr_write_b32 a57, v151
    v_accvgpr_read_b32 v152, a58
    v_mul_f32 v152, v152, v148
    v_accvgpr_write_b32 a58, v152
    v_accvgpr_read_b32 v153, a59
    v_mul_f32 v153, v153, v148
    v_accvgpr_write_b32 a59, v153
    v_accvgpr_read_b32 v150, a60
    v_mul_f32 v150, v150, v148
    v_accvgpr_write_b32 a60, v150
    v_accvgpr_read_b32 v151, a61
    v_mul_f32 v151, v151, v148
    v_accvgpr_write_b32 a61, v151
    v_accvgpr_read_b32 v152, a62
    v_mul_f32 v152, v152, v148
    v_accvgpr_write_b32 a62, v152
    v_accvgpr_read_b32 v153, a63
    v_mul_f32 v153, v153, v148
    v_accvgpr_write_b32 a63, v153
    v_exp_f32 v136, v32
    v_exp_f32 v137, v33
    v_exp_f32 v130, v34
    v_exp_f32 v131, v35
    v_cvt_pk_bf16_f32 v112, v136, v137
    v_exp_f32 v132, v36
    v_exp_f32 v133, v37
    v_cvt_pk_bf16_f32 v113, v130, v131
    v_add_f32 v136, v136, v130
    v_add_f32 v137, v137, v131
    v_exp_f32 v134, v38
    v_exp_f32 v135, v39
    v_cvt_pk_bf16_f32 v114, v132, v133
    v_add_f32 v136, v136, v132
    v_add_f32 v137, v137, v133
    v_exp_f32 v128, v40
    v_exp_f32 v129, v41
    v_cvt_pk_bf16_f32 v115, v134, v135
    v_add_f32 v136, v136, v134
    v_add_f32 v137, v137, v135
    v_exp_f32 v130, v42
    v_exp_f32 v131, v43
    v_cvt_pk_bf16_f32 v116, v128, v129
    v_add_f32 v136, v136, v128
    v_add_f32 v137, v137, v129
    v_exp_f32 v132, v44
    v_exp_f32 v133, v45
    v_cvt_pk_bf16_f32 v117, v130, v131
    v_add_f32 v136, v136, v130
    v_add_f32 v137, v137, v131
    v_exp_f32 v134, v46
    v_exp_f32 v135, v47
    v_cvt_pk_bf16_f32 v118, v132, v133
    v_add_f32 v136, v136, v132
    v_add_f32 v137, v137, v133
    v_cvt_pk_bf16_f32 v119, v134, v135
    v_add_f32 v136, v136, v134
    v_add_f32 v137, v137, v135
    v_add_f32 v140, v136, v137
    v_max3_f32 v146, v48, v49, v50
    v_max3_f32 v146, v146, v51, v52
    v_max3_f32 v146, v146, v53, v54
    v_max3_f32 v146, v146, v55, v56
    v_max3_f32 v146, v146, v57, v58
    v_max3_f32 v146, v146, v59, v60
    v_max3_f32 v146, v146, v61, v62
    v_max_f32 v146, v146, v63
    v_mov_b32 v147, v146
    s_nop 1
    v_permlane32_swap_b32 v146, v147
    s_nop 0
    v_max_f32 v146, v146, v147
    v_max_f32 v146, 0, v146
    v_sub_f32 v148, 0, v146
    v_exp_f32 v148, v148
    v_sub_f32 v145, v145, v146
    v_sub_f32 v80, v80, v146
    v_sub_f32 v16, v16, v146
    v_sub_f32 v48, v48, v146
    v_sub_f32 v81, v81, v146
    v_sub_f32 v17, v17, v146
    v_sub_f32 v49, v49, v146
    v_sub_f32 v82, v82, v146
    v_sub_f32 v18, v18, v146
    v_sub_f32 v50, v50, v146
    v_sub_f32 v83, v83, v146
    v_sub_f32 v19, v19, v146
    v_sub_f32 v51, v51, v146
    v_sub_f32 v84, v84, v146
    v_sub_f32 v20, v20, v146
    v_sub_f32 v52, v52, v146
    v_sub_f32 v85, v85, v146
    v_sub_f32 v21, v21, v146
    v_sub_f32 v53, v53, v146
    v_sub_f32 v86, v86, v146
    v_sub_f32 v22, v22, v146
    v_sub_f32 v54, v54, v146
    v_sub_f32 v87, v87, v146
    v_sub_f32 v23, v23, v146
    v_sub_f32 v55, v55, v146
    v_sub_f32 v88, v88, v146
    v_sub_f32 v24, v24, v146
    v_sub_f32 v56, v56, v146
    v_sub_f32 v89, v89, v146
    v_sub_f32 v25, v25, v146
    v_sub_f32 v57, v57, v146
    v_sub_f32 v90, v90, v146
    v_sub_f32 v26, v26, v146
    v_sub_f32 v58, v58, v146
    v_sub_f32 v91, v91, v146
    v_sub_f32 v27, v27, v146
    v_sub_f32 v59, v59, v146
    v_sub_f32 v92, v92, v146
    v_sub_f32 v28, v28, v146
    v_sub_f32 v60, v60, v146
    v_sub_f32 v93, v93, v146
    v_sub_f32 v29, v29, v146
    v_sub_f32 v61, v61, v146
    v_sub_f32 v94, v94, v146
    v_sub_f32 v30, v30, v146
    v_sub_f32 v62, v62, v146
    v_sub_f32 v95, v95, v146
    v_sub_f32 v31, v31, v146
    v_sub_f32 v63, v63, v146
    v_mul_f32 v143, v143, v148
    v_accvgpr_read_b32 v150, a64
    v_mul_f32 v150, v150, v148
    v_accvgpr_write_b32 a64, v150
    v_accvgpr_read_b32 v151, a65
    v_mul_f32 v151, v151, v148
    v_accvgpr_write_b32 a65, v151
    v_accvgpr_read_b32 v152, a66
    v_mul_f32 v152, v152, v148
    v_accvgpr_write_b32 a66, v152
    v_accvgpr_read_b32 v153, a67
    v_mul_f32 v153, v153, v148
    v_accvgpr_write_b32 a67, v153
    v_accvgpr_read_b32 v150, a68
    v_mul_f32 v150, v150, v148
    v_accvgpr_write_b32 a68, v150
    v_accvgpr_read_b32 v151, a69
    v_mul_f32 v151, v151, v148
    v_accvgpr_write_b32 a69, v151
    v_accvgpr_read_b32 v152, a70
    v_mul_f32 v152, v152, v148
    v_accvgpr_write_b32 a70, v152
    v_accvgpr_read_b32 v153, a71
    v_mul_f32 v153, v153, v148
    v_accvgpr_write_b32 a71, v153
    v_accvgpr_read_b32 v150, a72
    v_mul_f32 v150, v150, v148
    v_accvgpr_write_b32 a72, v150
    v_accvgpr_read_b32 v151, a73
    v_mul_f32 v151, v151, v148
    v_accvgpr_write_b32 a73, v151
    v_accvgpr_read_b32 v152, a74
    v_mul_f32 v152, v152, v148
    v_accvgpr_write_b32 a74, v152
    v_accvgpr_read_b32 v153, a75
    v_mul_f32 v153, v153, v148
    v_accvgpr_write_b32 a75, v153
    v_accvgpr_read_b32 v150, a76
    v_mul_f32 v150, v150, v148
    v_accvgpr_write_b32 a76, v150
    v_accvgpr_read_b32 v151, a77
    v_mul_f32 v151, v151, v148
    v_accvgpr_write_b32 a77, v151
    v_accvgpr_read_b32 v152, a78
    v_mul_f32 v152, v152, v148
    v_accvgpr_write_b32 a78, v152
    v_accvgpr_read_b32 v153, a79
    v_mul_f32 v153, v153, v148
    v_accvgpr_write_b32 a79, v153
    v_accvgpr_read_b32 v150, a80
    v_mul_f32 v150, v150, v148
    v_accvgpr_write_b32 a80, v150
    v_accvgpr_read_b32 v151, a81
    v_mul_f32 v151, v151, v148
    v_accvgpr_write_b32 a81, v151
    v_accvgpr_read_b32 v152, a82
    v_mul_f32 v152, v152, v148
    v_accvgpr_write_b32 a82, v152
    v_accvgpr_read_b32 v153, a83
    v_mul_f32 v153, v153, v148
    v_accvgpr_write_b32 a83, v153
    v_accvgpr_read_b32 v150, a84
    v_mul_f32 v150, v150, v148
    v_accvgpr_write_b32 a84, v150
    v_accvgpr_read_b32 v151, a85
    v_mul_f32 v151, v151, v148
    v_accvgpr_write_b32 a85, v151
    v_accvgpr_read_b32 v152, a86
    v_mul_f32 v152, v152, v148
    v_accvgpr_write_b32 a86, v152
    v_accvgpr_read_b32 v153, a87
    v_mul_f32 v153, v153, v148
    v_accvgpr_write_b32 a87, v153
    v_accvgpr_read_b32 v150, a88
    v_mul_f32 v150, v150, v148
    v_accvgpr_write_b32 a88, v150
    v_accvgpr_read_b32 v151, a89
    v_mul_f32 v151, v151, v148
    v_accvgpr_write_b32 a89, v151
    v_accvgpr_read_b32 v152, a90
    v_mul_f32 v152, v152, v148
    v_accvgpr_write_b32 a90, v152
    v_accvgpr_read_b32 v153, a91
    v_mul_f32 v153, v153, v148
    v_accvgpr_write_b32 a91, v153
    v_accvgpr_read_b32 v150, a92
    v_mul_f32 v150, v150, v148
    v_accvgpr_write_b32 a92, v150
    v_accvgpr_read_b32 v151, a93
    v_mul_f32 v151, v151, v148
    v_accvgpr_write_b32 a93, v151
    v_accvgpr_read_b32 v152, a94
    v_mul_f32 v152, v152, v148
    v_accvgpr_write_b32 a94, v152
    v_accvgpr_read_b32 v153, a95
    v_mul_f32 v153, v153, v148
    v_accvgpr_write_b32 a95, v153
    v_accvgpr_read_b32 v150, a96
    v_mul_f32 v150, v150, v148
    v_accvgpr_write_b32 a96, v150
    v_accvgpr_read_b32 v151, a97
    v_mul_f32 v151, v151, v148
    v_accvgpr_write_b32 a97, v151
    v_accvgpr_read_b32 v152, a98
    v_mul_f32 v152, v152, v148
    v_accvgpr_write_b32 a98, v152
    v_accvgpr_read_b32 v153, a99
    v_mul_f32 v153, v153, v148
    v_accvgpr_write_b32 a99, v153
    v_accvgpr_read_b32 v150, a100
    v_mul_f32 v150, v150, v148
    v_accvgpr_write_b32 a100, v150
    v_accvgpr_read_b32 v151, a101
    v_mul_f32 v151, v151, v148
    v_accvgpr_write_b32 a101, v151
    v_accvgpr_read_b32 v152, a102
    v_mul_f32 v152, v152, v148
    v_accvgpr_write_b32 a102, v152
    v_accvgpr_read_b32 v153, a103
    v_mul_f32 v153, v153, v148
    v_accvgpr_write_b32 a103, v153
    v_accvgpr_read_b32 v150, a104
    v_mul_f32 v150, v150, v148
    v_accvgpr_write_b32 a104, v150
    v_accvgpr_read_b32 v151, a105
    v_mul_f32 v151, v151, v148
    v_accvgpr_write_b32 a105, v151
    v_accvgpr_read_b32 v152, a106
    v_mul_f32 v152, v152, v148
    v_accvgpr_write_b32 a106, v152
    v_accvgpr_read_b32 v153, a107
    v_mul_f32 v153, v153, v148
    v_accvgpr_write_b32 a107, v153
    v_accvgpr_read_b32 v150, a108
    v_mul_f32 v150, v150, v148
    v_accvgpr_write_b32 a108, v150
    v_accvgpr_read_b32 v151, a109
    v_mul_f32 v151, v151, v148
    v_accvgpr_write_b32 a109, v151
    v_accvgpr_read_b32 v152, a110
    v_mul_f32 v152, v152, v148
    v_accvgpr_write_b32 a110, v152
    v_accvgpr_read_b32 v153, a111
    v_mul_f32 v153, v153, v148
    v_accvgpr_write_b32 a111, v153
    v_accvgpr_read_b32 v150, a112
    v_mul_f32 v150, v150, v148
    v_accvgpr_write_b32 a112, v150
    v_accvgpr_read_b32 v151, a113
    v_mul_f32 v151, v151, v148
    v_accvgpr_write_b32 a113, v151
    v_accvgpr_read_b32 v152, a114
    v_mul_f32 v152, v152, v148
    v_accvgpr_write_b32 a114, v152
    v_accvgpr_read_b32 v153, a115
    v_mul_f32 v153, v153, v148
    v_accvgpr_write_b32 a115, v153
    v_accvgpr_read_b32 v150, a116
    v_mul_f32 v150, v150, v148
    v_accvgpr_write_b32 a116, v150
    v_accvgpr_read_b32 v151, a117
    v_mul_f32 v151, v151, v148
    v_accvgpr_write_b32 a117, v151
    v_accvgpr_read_b32 v152, a118
    v_mul_f32 v152, v152, v148
    v_accvgpr_write_b32 a118, v152
    v_accvgpr_read_b32 v153, a119
    v_mul_f32 v153, v153, v148
    v_accvgpr_write_b32 a119, v153
    v_accvgpr_read_b32 v150, a120
    v_mul_f32 v150, v150, v148
    v_accvgpr_write_b32 a120, v150
    v_accvgpr_read_b32 v151, a121
    v_mul_f32 v151, v151, v148
    v_accvgpr_write_b32 a121, v151
    v_accvgpr_read_b32 v152, a122
    v_mul_f32 v152, v152, v148
    v_accvgpr_write_b32 a122, v152
    v_accvgpr_read_b32 v153, a123
    v_mul_f32 v153, v153, v148
    v_accvgpr_write_b32 a123, v153
    v_accvgpr_read_b32 v150, a124
    v_mul_f32 v150, v150, v148
    v_accvgpr_write_b32 a124, v150
    v_accvgpr_read_b32 v151, a125
    v_mul_f32 v151, v151, v148
    v_accvgpr_write_b32 a125, v151
    v_accvgpr_read_b32 v152, a126
    v_mul_f32 v152, v152, v148
    v_accvgpr_write_b32 a126, v152
    v_accvgpr_read_b32 v153, a127
    v_mul_f32 v153, v153, v148
    v_accvgpr_write_b32 a127, v153
    v_exp_f32 v138, v48
    v_exp_f32 v139, v49
    v_exp_f32 v130, v50
    v_exp_f32 v131, v51
    v_cvt_pk_bf16_f32 v120, v138, v139
    v_exp_f32 v132, v52
    v_exp_f32 v133, v53
    v_cvt_pk_bf16_f32 v121, v130, v131
    v_add_f32 v138, v138, v130
    v_add_f32 v139, v139, v131
    v_exp_f32 v134, v54
    v_exp_f32 v135, v55
    v_cvt_pk_bf16_f32 v122, v132, v133
    v_add_f32 v138, v138, v132
    v_add_f32 v139, v139, v133
    v_exp_f32 v128, v56
    v_exp_f32 v129, v57
    v_cvt_pk_bf16_f32 v123, v134, v135
    v_add_f32 v138, v138, v134
    v_add_f32 v139, v139, v135
    v_exp_f32 v130, v58
    v_exp_f32 v131, v59
    v_cvt_pk_bf16_f32 v124, v128, v129
    v_add_f32 v138, v138, v128
    v_add_f32 v139, v139, v129
    v_exp_f32 v132, v60
    v_exp_f32 v133, v61
    v_cvt_pk_bf16_f32 v125, v130, v131
    v_add_f32 v138, v138, v130
    v_add_f32 v139, v139, v131
    v_exp_f32 v134, v62
    v_exp_f32 v135, v63
    v_cvt_pk_bf16_f32 v126, v132, v133
    v_add_f32 v138, v138, v132
    v_add_f32 v139, v139, v133
    v_cvt_pk_bf16_f32 v127, v134, v135
    v_add_f32 v138, v138, v134
    v_add_f32 v139, v139, v135
    v_add_f32 v141, v138, v139
    s_nop 1
    s_branch k2_rr15
k2_fix17:
    s_cmp_eq_u32 s36, 0
    s_cselect_b32 s24, 0, 0x74000000
    v_subrev_f32 v146, s24, v243
    v_add_f32 v147, 0, v146
    v_min_f32 v80, v145, v147
    v_add_f32 v148, 0xf1800000, v146
    v_min_f32 v81, v145, v148
    v_add_f32 v147, 0xf2000000, v146
    v_min_f32 v82, v145, v147
    v_add_f32 v148, 0xf2400000, v146
    v_min_f32 v83, v145, v148
    v_add_f32 v147, 0xf3000000, v146
    v_min_f32 v84, v145, v147
    v_add_f32 v148, 0xf3100000, v146
    v_min_f32 v85, v145, v148
    v_add_f32 v147, 0xf3200000, v146
    v_min_f32 v86, v145, v147
    v_add_f32 v148, 0xf3300000, v146
    v_min_f32 v87, v145, v148
    v_add_f32 v147, 0xf3800000, v146
    v_min_f32 v88, v145, v147
    v_add_f32 v148, 0xf3880000, v146
    v_min_f32 v89, v145, v148
    v_add_f32 v147, 0xf3900000, v146
    v_min_f32 v90, v145, v147
    v_add_f32 v148, 0xf3980000, v146
    v_min_f32 v91, v145, v148
    v_add_f32 v147, 0xf3c00000, v146
    v_min_f32 v92, v145, v147
    v_add_f32 v148, 0xf3c80000, v146
    v_min_f32 v93, v145, v148
    v_add_f32 v147, 0xf3d00000, v146
    v_min_f32 v94, v145, v147
    v_add_f32 v148, 0xf3d80000, v146
    v_min_f32 v95, v145, v148
    s_nop 1
    s_branch k2_fixr18
k2_rare20:
    s_nop 15
    v_max3_f32 v146, v16, v17, v18
    v_max3_f32 v146, v146, v19, v20
    v_max3_f32 v146, v146, v21, v22
    v_max3_f32 v146, v146, v23, v24
    v_max3_f32 v146, v146, v25, v26
    v_max3_f32 v146, v146, v27, v28
    v_max3_f32 v146, v146, v29, v30
    v_max_f32 v146, v146, v31
    v_mov_b32 v147, v146
    s_nop 1
    v_permlane32_swap_b32 v146, v147
    s_nop 0
    v_max_f32 v146, v146, v147
    v_max_f32 v146, 0, v146
    v_sub_f32 v148, 0, v146
    v_exp_f32 v148, v148
    v_sub_f32 v145, v145, v146
    v_sub_f32 v80, v80, v146
    v_sub_f32 v48, v48, v146
    v_sub_f32 v16, v16, v146
    v_sub_f32 v81, v81, v146
    v_sub_f32 v49, v49, v146
    v_sub_f32 v17, v17, v146
    v_sub_f32 v82, v82, v146
    v_sub_f32 v50, v50, v146
    v_sub_f32 v18, v18, v146
    v_sub_f32 v83, v83, v146
    v_sub_f32 v51, v51, v146
    v_sub_f32 v19, v19, v146
    v_sub_f32 v84, v84, v146
    v_sub_f32 v52, v52, v146
    v_sub_f32 v20, v20, v146
    v_sub_f32 v85, v85, v146
    v_sub_f32 v53, v53, v146
    v_sub_f32 v21, v21, v146
    v_sub_f32 v86, v86, v146
    v_sub_f32 v54, v54, v146
    v_sub_f32 v22, v22, v146
    v_sub_f32 v87, v87, v146
    v_sub_f32 v55, v55, v146
    v_sub_f32 v23, v23, v146
    v_sub_f32 v88, v88, v146
    v_sub_f32 v56, v56, v146
    v_sub_f32 v24, v24, v146
    v_sub_f32 v89, v89, v146
    v_sub_f32 v57, v57, v146
    v_sub_f32 v25, v25, v146
    v_sub_f32 v90, v90, v146
    v_sub_f32 v58, v58, v146
    v_sub_f32 v26, v26, v146
    v_sub_f32 v91, v91, v146
    v_sub_f32 v59, v59, v146
    v_sub_f32 v27, v27, v146
    v_sub_f32 v92, v92, v146
    v_sub_f32 v60, v60, v146
    v_sub_f32 v28, v28, v146
    v_sub_f32 v93, v93, v146
    v_sub_f32 v61, v61, v146
    v_sub_f32 v29, v29, v146
    v_sub_f32 v94, v94, v146
    v_sub_f32 v62, v62, v146
    v_sub_f32 v30, v30, v146
    v_sub_f32 v95, v95, v146
    v_sub_f32 v63, v63, v146
    v_sub_f32 v31, v31, v146
    v_mul_f32 v143, v143, v148
    v_accvgpr_read_b32 v150, a64
    v_mul_f32 v150, v150, v148
    v_accvgpr_write_b32 a64, v150
    v_accvgpr_read_b32 v151, a65
    v_mul_f32 v151, v151, v148
    v_accvgpr_write_b32 a65, v151
    v_accvgpr_read_b32 v152, a66
    v_mul_f32 v152, v152, v148
    v_accvgpr_write_b32 a66, v152
    v_accvgpr_read_b32 v153, a67
    v_mul_f32 v153, v153, v148
    v_accvgpr_write_b32 a67, v153
    v_accvgpr_read_b32 v150, a68
    v_mul_f32 v150, v150, v148
    v_accvgpr_write_b32 a68, v150
    v_accvgpr_read_b32 v151, a69
    v_mul_f32 v151, v151, v148
    v_accvgpr_write_b32 a69, v151
    v_accvgpr_read_b32 v152, a70
    v_mul_f32 v152, v152, v148
    v_accvgpr_write_b32 a70, v152
    v_accvgpr_read_b32 v153, a71
    v_mul_f32 v153, v153, v148
    v_accvgpr_write_b32 a71, v153
    v_accvgpr_read_b32 v150, a72
    v_mul_f32 v150, v150, v148
    v_accvgpr_write_b32 a72, v150
    v_accvgpr_read_b32 v151, a73
    v_mul_f32 v151, v151, v148
    v_accvgpr_write_b32 a73, v151
    v_accvgpr_read_b32 v152, a74
    v_mul_f32 v152, v152, v148
    v_accvgpr_write_b32 a74, v152
    v_accvgpr_read_b32 v153, a75
    v_mul_f32 v153, v153, v148
    v_accvgpr_write_b32 a75, v153
    v_accvgpr_read_b32 v150, a76
    v_mul_f32 v150, v150, v148
    v_accvgpr_write_b32 a76, v150
    v_accvgpr_read_b32 v151, a77
    v_mul_f32 v151, v151, v148
    v_accvgpr_write_b32 a77, v151
    v_accvgpr_read_b32 v152, a78
    v_mul_f32 v152, v152, v148
    v_accvgpr_write_b32 a78, v152
    v_accvgpr_read_b32 v153, a79
    v_mul_f32 v153, v153, v148
    v_accvgpr_write_b32 a79, v153
    v_accvgpr_read_b32 v150, a80
    v_mul_f32 v150, v150, v148
    v_accvgpr_write_b32 a80, v150
    v_accvgpr_read_b32 v151, a81
    v_mul_f32 v151, v151, v148
    v_accvgpr_write_b32 a81, v151
    v_accvgpr_read_b32 v152, a82
    v_mul_f32 v152, v152, v148
    v_accvgpr_write_b32 a82, v152
    v_accvgpr_read_b32 v153, a83
    v_mul_f32 v153, v153, v148
    v_accvgpr_write_b32 a83, v153
    v_accvgpr_read_b32 v150, a84
    v_mul_f32 v150, v150, v148
    v_accvgpr_write_b32 a84, v150
    v_accvgpr_read_b32 v151, a85
    v_mul_f32 v151, v151, v148
    v_accvgpr_write_b32 a85, v151
    v_accvgpr_read_b32 v152, a86
    v_mul_f32 v152, v152, v148
    v_accvgpr_write_b32 a86, v152
    v_accvgpr_read_b32 v153, a87
    v_mul_f32 v153, v153, v148
    v_accvgpr_write_b32 a87, v153
    v_accvgpr_read_b32 v150, a88
    v_mul_f32 v150, v150, v148
    v_accvgpr_write_b32 a88, v150
    v_accvgpr_read_b32 v151, a89
    v_mul_f32 v151, v151, v148
    v_accvgpr_write_b32 a89, v151
    v_accvgpr_read_b32 v152, a90
    v_mul_f32 v152, v152, v148
    v_accvgpr_write_b32 a90, v152
    v_accvgpr_read_b32 v153, a91
    v_mul_f32 v153, v153, v148
    v_accvgpr_write_b32 a91, v153
    v_accvgpr_read_b32 v150, a92
    v_mul_f32 v150, v150, v148
    v_accvgpr_write_b32 a92, v150
    v_accvgpr_read_b32 v151, a93
    v_mul_f32 v151, v151, v148
    v_accvgpr_write_b32 a93, v151
    v_accvgpr_read_b32 v152, a94
    v_mul_f32 v152, v152, v148
    v_accvgpr_write_b32 a94, v152
    v_accvgpr_read_b32 v153, a95
    v_mul_f32 v153, v153, v148
    v_accvgpr_write_b32 a95, v153
    v_accvgpr_read_b32 v150, a96
    v_mul_f32 v150, v150, v148
    v_accvgpr_write_b32 a96, v150
    v_accvgpr_read_b32 v151, a97
    v_mul_f32 v151, v151, v148
    v_accvgpr_write_b32 a97, v151
    v_accvgpr_read_b32 v152, a98
    v_mul_f32 v152, v152, v148
    v_accvgpr_write_b32 a98, v152
    v_accvgpr_read_b32 v153, a99
    v_mul_f32 v153, v153, v148
    v_accvgpr_write_b32 a99, v153
    v_accvgpr_read_b32 v150, a100
    v_mul_f32 v150, v150, v148
    v_accvgpr_write_b32 a100, v150
    v_accvgpr_read_b32 v151, a101
    v_mul_f32 v151, v151, v148
    v_accvgpr_write_b32 a101, v151
    v_accvgpr_read_b32 v152, a102
    v_mul_f32 v152, v152, v148
    v_accvgpr_write_b32 a102, v152
    v_accvgpr_read_b32 v153, a103
    v_mul_f32 v153, v153, v148
    v_accvgpr_write_b32 a103, v153
    v_accvgpr_read_b32 v150, a104
    v_mul_f32 v150, v150, v148
    v_accvgpr_write_b32 a104, v150
    v_accvgpr_read_b32 v151, a105
    v_mul_f32 v151, v151, v148
    v_accvgpr_write_b32 a105, v151
    v_accvgpr_read_b32 v152, a106
    v_mul_f32 v152, v152, v148
    v_accvgpr_write_b32 a106, v152
    v_accvgpr_read_b32 v153, a107
    v_mul_f32 v153, v153, v148
    v_accvgpr_write_b32 a107, v153
    v_accvgpr_read_b32 v150, a108
    v_mul_f32 v150, v150, v148
    v_accvgpr_write_b32 a108, v150
    v_accvgpr_read_b32 v151, a109
    v_mul_f32 v151, v151, v148
    v_accvgpr_write_b32 a109, v151
    v_accvgpr_read_b32 v152, a110
    v_mul_f32 v152, v152, v148
    v_accvgpr_write_b32 a110, v152
    v_accvgpr_read_b32 v153, a111
    v_mul_f32 v153, v153, v148
    v_accvgpr_write_b32 a111, v153
    v_accvgpr_read_b32 v150, a112
    v_mul_f32 v150, v150, v148
    v_accvgpr_write_b32 a112, v150
    v_accvgpr_read_b32 v151, a113
    v_mul_f32 v151, v151, v148
    v_accvgpr_write_b32 a113, v151
    v_accvgpr_read_b32 v152, a114
    v_mul_f32 v152, v152, v148
    v_accvgpr_write_b32 a114, v152
    v_accvgpr_read_b32 v153, a115
    v_mul_f32 v153, v153, v148
    v_accvgpr_write_b32 a115, v153
    v_accvgpr_read_b32 v150, a116
    v_mul_f32 v150, v150, v148
    v_accvgpr_write_b32 a116, v150
    v_accvgpr_read_b32 v151, a117
    v_mul_f32 v151, v151, v148
    v_accvgpr_write_b32 a117, v151
    v_accvgpr_read_b32 v152, a118
    v_mul_f32 v152, v152, v148
    v_accvgpr_write_b32 a118, v152
    v_accvgpr_read_b32 v153, a119
    v_mul_f32 v153, v153, v148
    v_accvgpr_write_b32 a119, v153
    v_accvgpr_read_b32 v150, a120
    v_mul_f32 v150, v150, v148
    v_accvgpr_write_b32 a120, v150
    v_accvgpr_read_b32 v151, a121
    v_mul_f32 v151, v151, v148
    v_accvgpr_write_b32 a121, v151
    v_accvgpr_read_b32 v152, a122
    v_mul_f32 v152, v152, v148
    v_accvgpr_write_b32 a122, v152
    v_accvgpr_read_b32 v153, a123
    v_mul_f32 v153, v153, v148
    v_accvgpr_write_b32 a123, v153
    v_accvgpr_read_b32 v150, a124
    v_mul_f32 v150, v150, v148
    v_accvgpr_write_b32 a124, v150
    v_accvgpr_read_b32 v151, a125
    v_mul_f32 v151, v151, v148
    v_accvgpr_write_b32 a125, v151
    v_accvgpr_read_b32 v152, a126
    v_mul_f32 v152, v152, v148
    v_accvgpr_write_b32 a126, v152
    v_accvgpr_read_b32 v153, a127
    v_mul_f32 v153, v153, v148
    v_accvgpr_write_b32 a127, v153
    v_exp_f32 v138, v16
    v_exp_f32 v139, v17
    v_exp_f32 v130, v18
    v_exp_f32 v131, v19
    v_cvt_pk_bf16_f32 v104, v138, v139
    v_exp_f32 v132, v20
    v_exp_f32 v133, v21
    v_cvt_pk_bf16_f32 v105, v130, v131
    v_add_f32 v138, v138, v130
    v_add_f32 v139, v139, v131
    v_exp_f32 v134, v22
    v_exp_f32 v135, v23
    v_cvt_pk_bf16_f32 v106, v132, v133
    v_add_f32 v138, v138, v132
    v_add_f32 v139, v139, v133
    v_exp_f32 v128, v24
    v_exp_f32 v129, v25
    v_cvt_pk_bf16_f32 v107, v134, v135
    v_add_f32 v138, v138, v134
    v_add_f32 v139, v139, v135
    v_exp_f32 v130, v26
    v_exp_f32 v131, v27
    v_cvt_pk_bf16_f32 v108, v128, v129
    v_add_f32 v138, v138, v128
    v_add_f32 v139, v139, v129
    v_exp_f32 v132, v28
    v_exp_f32 v133, v29
    v_cvt_pk_bf16_f32 v109, v130, v131
    v_add_f32 v138, v138, v130
    v_add_f32 v139, v139, v131
    v_exp_f32 v134, v30
    v_exp_f32 v135, v31
    v_cvt_pk_bf16_f32 v110, v132, v133
    v_add_f32 v138, v138, v132
    v_add_f32 v139, v139, v133
    v_cvt_pk_bf16_f32 v111, v134, v135
    v_add_f32 v138, v138, v134
    v_add_f32 v139, v139, v135
    v_add_f32 v141, v138, v139
    s_nop 1
    s_branch k2_rr19
k2_fix21:
    s_cmp_eq_u32 s36, 0
    s_cselect_b32 s24, 0, 0x74000000
    v_subrev_f32 v146, s24, v243
    v_add_f32 v147, 0, v146
    v_min_f32 v80, v145, v147
    v_add_f32 v148, 0xf1800000, v146
    v_min_f32 v81, v145, v148
    v_add_f32 v147, 0xf2000000, v146
    v_min_f32 v82, v145, v147
    v_add_f32 v148, 0xf2400000, v146
    v_min_f32 v83, v145, v148
    v_add_f32 v147, 0xf3000000, v146
    v_min_f32 v84, v145, v147
    v_add_f32 v148, 0xf3100000, v146
    v_min_f32 v85, v145, v148
    v_add_f32 v147, 0xf3200000, v146
    v_min_f32 v86, v145, v147
    v_add_f32 v148, 0xf3300000, v146
    v_min_f32 v87, v145, v148
    v_add_f32 v147, 0xf3800000, v146
    v_min_f32 v88, v145, v147
    v_add_f32 v148, 0xf3880000, v146
    v_min_f32 v89, v145, v148
    v_add_f32 v147, 0xf3900000, v146
    v_min_f32 v90, v145, v147
    v_add_f32 v148, 0xf3980000, v146
    v_min_f32 v91, v145, v148
    v_add_f32 v147, 0xf3c00000, v146
    v_min_f32 v92, v145, v147
    v_add_f32 v148, 0xf3c80000, v146
    v_min_f32 v93, v145, v148
    v_add_f32 v147, 0xf3d00000, v146
    v_min_f32 v94, v145, v147
    v_add_f32 v148, 0xf3d80000, v146
    v_min_f32 v95, v145, v148
    s_nop 1
    s_branch k2_fixr22
k2_rare24:
    s_nop 15
    v_max3_f32 v146, v48, v49, v50
    v_max3_f32 v146, v146, v51, v52
    v_max3_f32 v146, v146, v53, v54
    v_max3_f32 v146, v146, v55, v56
    v_max3_f32 v146, v146, v57, v58
    v_max3_f32 v146, v146, v59, v60
    v_max3_f32 v146, v146, v61, v62
    v_max_f32 v146, v146, v63
    v_mov_b32 v147, v146
    s_nop 1
    v_permlane32_swap_b32 v146, v147
    s_nop 0
    v_max_f32 v146, v146, v147
    v_max_f32 v146, 0, v146
    v_sub_f32 v148, 0, v146
    v_exp_f32 v148, v148
    v_sub_f32 v145, v145, v146
    v_sub_f32 v80, v80, v146
    v_sub_f32 v16, v16, v146
    v_sub_f32 v48, v48, v146
    v_sub_f32 v81, v81, v146
    v_sub_f32 v17, v17, v146
    v_sub_f32 v49, v49, v146
    v_sub_f32 v82, v82, v146
    v_sub_f32 v18, v18, v146
    v_sub_f32 v50, v50, v146
    v_sub_f32 v83, v83, v146
    v_sub_f32 v19, v19, v146
    v_sub_f32 v51, v51, v146
    v_sub_f32 v84, v84, v146
    v_sub_f32 v20, v20, v146
    v_sub_f32 v52, v52, v146
    v_sub_f32 v85, v85, v146
    v_sub_f32 v21, v21, v146
    v_sub_f32 v53, v53, v146
    v_sub_f32 v86, v86, v146
    v_sub_f32 v22, v22, v146
    v_sub_f32 v54, v54, v146
    v_sub_f32 v87, v87, v146
    v_sub_f32 v23, v23, v146
    v_sub_f32 v55, v55, v146
    v_sub_f32 v88, v88, v146
    v_sub_f32 v24, v24, v146
    v_sub_f32 v56, v56, v146
    v_sub_f32 v89, v89, v146
    v_sub_f32 v25, v25, v146
    v_sub_f32 v57, v57, v146
    v_sub_f32 v90, v90, v146
    v_sub_f32 v26, v26, v146
    v_sub_f32 v58, v58, v146
    v_sub_f32 v91, v91, v146
    v_sub_f32 v27, v27, v146
    v_sub_f32 v59, v59, v146
    v_sub_f32 v92, v92, v146
    v_sub_f32 v28, v28, v146
    v_sub_f32 v60, v60, v146
    v_sub_f32 v93, v93, v146
    v_sub_f32 v29, v29, v146
    v_sub_f32 v61, v61, v146
    v_sub_f32 v94, v94, v146
    v_sub_f32 v30, v30, v146
    v_sub_f32 v62, v62, v146
    v_sub_f32 v95, v95, v146
    v_sub_f32 v31, v31, v146
    v_sub_f32 v63, v63, v146
    v_mul_f32 v143, v143, v148
    v_accvgpr_read_b32 v150, a64
    v_mul_f32 v150, v150, v148
    v_accvgpr_write_b32 a64, v150
    v_accvgpr_read_b32 v151, a65
    v_mul_f32 v151, v151, v148
    v_accvgpr_write_b32 a65, v151
    v_accvgpr_read_b32 v152, a66
    v_mul_f32 v152, v152, v148
    v_accvgpr_write_b32 a66, v152
    v_accvgpr_read_b32 v153, a67
    v_mul_f32 v153, v153, v148
    v_accvgpr_write_b32 a67, v153
    v_accvgpr_read_b32 v150, a68
    v_mul_f32 v150, v150, v148
    v_accvgpr_write_b32 a68, v150
    v_accvgpr_read_b32 v151, a69
    v_mul_f32 v151, v151, v148
    v_accvgpr_write_b32 a69, v151
    v_accvgpr_read_b32 v152, a70
    v_mul_f32 v152, v152, v148
    v_accvgpr_write_b32 a70, v152
    v_accvgpr_read_b32 v153, a71
    v_mul_f32 v153, v153, v148
    v_accvgpr_write_b32 a71, v153
    v_accvgpr_read_b32 v150, a72
    v_mul_f32 v150, v150, v148
    v_accvgpr_write_b32 a72, v150
    v_accvgpr_read_b32 v151, a73
    v_mul_f32 v151, v151, v148
    v_accvgpr_write_b32 a73, v151
    v_accvgpr_read_b32 v152, a74
    v_mul_f32 v152, v152, v148
    v_accvgpr_write_b32 a74, v152
    v_accvgpr_read_b32 v153, a75
    v_mul_f32 v153, v153, v148
    v_accvgpr_write_b32 a75, v153
    v_accvgpr_read_b32 v150, a76
    v_mul_f32 v150, v150, v148
    v_accvgpr_write_b32 a76, v150
    v_accvgpr_read_b32 v151, a77
    v_mul_f32 v151, v151, v148
    v_accvgpr_write_b32 a77, v151
    v_accvgpr_read_b32 v152, a78
    v_mul_f32 v152, v152, v148
    v_accvgpr_write_b32 a78, v152
    v_accvgpr_read_b32 v153, a79
    v_mul_f32 v153, v153, v148
    v_accvgpr_write_b32 a79, v153
    v_accvgpr_read_b32 v150, a80
    v_mul_f32 v150, v150, v148
    v_accvgpr_write_b32 a80, v150
    v_accvgpr_read_b32 v151, a81
    v_mul_f32 v151, v151, v148
    v_accvgpr_write_b32 a81, v151
    v_accvgpr_read_b32 v152, a82
    v_mul_f32 v152, v152, v148
    v_accvgpr_write_b32 a82, v152
    v_accvgpr_read_b32 v153, a83
    v_mul_f32 v153, v153, v148
    v_accvgpr_write_b32 a83, v153
    v_accvgpr_read_b32 v150, a84
    v_mul_f32 v150, v150, v148
    v_accvgpr_write_b32 a84, v150
    v_accvgpr_read_b32 v151, a85
    v_mul_f32 v151, v151, v148
    v_accvgpr_write_b32 a85, v151
    v_accvgpr_read_b32 v152, a86
    v_mul_f32 v152, v152, v148
    v_accvgpr_write_b32 a86, v152
    v_accvgpr_read_b32 v153, a87
    v_mul_f32 v153, v153, v148
    v_accvgpr_write_b32 a87, v153
    v_accvgpr_read_b32 v150, a88
    v_mul_f32 v150, v150, v148
    v_accvgpr_write_b32 a88, v150
    v_accvgpr_read_b32 v151, a89
    v_mul_f32 v151, v151, v148
    v_accvgpr_write_b32 a89, v151
    v_accvgpr_read_b32 v152, a90
    v_mul_f32 v152, v152, v148
    v_accvgpr_write_b32 a90, v152
    v_accvgpr_read_b32 v153, a91
    v_mul_f32 v153, v153, v148
    v_accvgpr_write_b32 a91, v153
    v_accvgpr_read_b32 v150, a92
    v_mul_f32 v150, v150, v148
    v_accvgpr_write_b32 a92, v150
    v_accvgpr_read_b32 v151, a93
    v_mul_f32 v151, v151, v148
    v_accvgpr_write_b32 a93, v151
    v_accvgpr_read_b32 v152, a94
    v_mul_f32 v152, v152, v148
    v_accvgpr_write_b32 a94, v152
    v_accvgpr_read_b32 v153, a95
    v_mul_f32 v153, v153, v148
    v_accvgpr_write_b32 a95, v153
    v_accvgpr_read_b32 v150, a96
    v_mul_f32 v150, v150, v148
    v_accvgpr_write_b32 a96, v150
    v_accvgpr_read_b32 v151, a97
    v_mul_f32 v151, v151, v148
    v_accvgpr_write_b32 a97, v151
    v_accvgpr_read_b32 v152, a98
    v_mul_f32 v152, v152, v148
    v_accvgpr_write_b32 a98, v152
    v_accvgpr_read_b32 v153, a99
    v_mul_f32 v153, v153, v148
    v_accvgpr_write_b32 a99, v153
    v_accvgpr_read_b32 v150, a100
    v_mul_f32 v150, v150, v148
    v_accvgpr_write_b32 a100, v150
    v_accvgpr_read_b32 v151, a101
    v_mul_f32 v151, v151, v148
    v_accvgpr_write_b32 a101, v151
    v_accvgpr_read_b32 v152, a102
    v_mul_f32 v152, v152, v148
    v_accvgpr_write_b32 a102, v152
    v_accvgpr_read_b32 v153, a103
    v_mul_f32 v153, v153, v148
    v_accvgpr_write_b32 a103, v153
    v_accvgpr_read_b32 v150, a104
    v_mul_f32 v150, v150, v148
    v_accvgpr_write_b32 a104, v150
    v_accvgpr_read_b32 v151, a105
    v_mul_f32 v151, v151, v148
    v_accvgpr_write_b32 a105, v151
    v_accvgpr_read_b32 v152, a106
    v_mul_f32 v152, v152, v148
    v_accvgpr_write_b32 a106, v152
    v_accvgpr_read_b32 v153, a107
    v_mul_f32 v153, v153, v148
    v_accvgpr_write_b32 a107, v153
    v_accvgpr_read_b32 v150, a108
    v_mul_f32 v150, v150, v148
    v_accvgpr_write_b32 a108, v150
    v_accvgpr_read_b32 v151, a109
    v_mul_f32 v151, v151, v148
    v_accvgpr_write_b32 a109, v151
    v_accvgpr_read_b32 v152, a110
    v_mul_f32 v152, v152, v148
    v_accvgpr_write_b32 a110, v152
    v_accvgpr_read_b32 v153, a111
    v_mul_f32 v153, v153, v148
    v_accvgpr_write_b32 a111, v153
    v_accvgpr_read_b32 v150, a112
    v_mul_f32 v150, v150, v148
    v_accvgpr_write_b32 a112, v150
    v_accvgpr_read_b32 v151, a113
    v_mul_f32 v151, v151, v148
    v_accvgpr_write_b32 a113, v151
    v_accvgpr_read_b32 v152, a114
    v_mul_f32 v152, v152, v148
    v_accvgpr_write_b32 a114, v152
    v_accvgpr_read_b32 v153, a115
    v_mul_f32 v153, v153, v148
    v_accvgpr_write_b32 a115, v153
    v_accvgpr_read_b32 v150, a116
    v_mul_f32 v150, v150, v148
    v_accvgpr_write_b32 a116, v150
    v_accvgpr_read_b32 v151, a117
    v_mul_f32 v151, v151, v148
    v_accvgpr_write_b32 a117, v151
    v_accvgpr_read_b32 v152, a118
    v_mul_f32 v152, v152, v148
    v_accvgpr_write_b32 a118, v152
    v_accvgpr_read_b32 v153, a119
    v_mul_f32 v153, v153, v148
    v_accvgpr_write_b32 a119, v153
    v_accvgpr_read_b32 v150, a120
    v_mul_f32 v150, v150, v148
    v_accvgpr_write_b32 a120, v150
    v_accvgpr_read_b32 v151, a121
    v_mul_f32 v151, v151, v148
    v_accvgpr_write_b32 a121, v151
    v_accvgpr_read_b32 v152, a122
    v_mul_f32 v152, v152, v148
    v_accvgpr_write_b32 a122, v152
    v_accvgpr_read_b32 v153, a123
    v_mul_f32 v153, v153, v148
    v_accvgpr_write_b32 a123, v153
    v_accvgpr_read_b32 v150, a124
    v_mul_f32 v150, v150, v148
    v_accvgpr_write_b32 a124, v150
    v_accvgpr_read_b32 v151, a125
    v_mul_f32 v151, v151, v148
    v_accvgpr_write_b32 a125, v151
    v_accvgpr_read_b32 v152, a126
    v_mul_f32 v152, v152, v148
    v_accvgpr_write_b32 a126, v152
    v_accvgpr_read_b32 v153, a127
    v_mul_f32 v153, v153, v148
    v_accvgpr_write_b32 a127, v153
    v_exp_f32 v138, v48
    v_exp_f32 v139, v49
    v_exp_f32 v130, v50
    v_exp_f32 v131, v51
    v_cvt_pk_bf16_f32 v120, v138, v139
    v_exp_f32 v132, v52
    v_exp_f32 v133, v53
    v_cvt_pk_bf16_f32 v121, v130, v131
    v_add_f32 v138, v138, v130
    v_add_f32 v139, v139, v131
    v_exp_f32 v134, v54
    v_exp_f32 v135, v55
    v_cvt_pk_bf16_f32 v122, v132, v133
    v_add_f32 v138, v138, v132
    v_add_f32 v139, v139, v133
    v_exp_f32 v128, v56
    v_exp_f32 v129, v57
    v_cvt_pk_bf16_f32 v123, v134, v135
    v_add_f32 v138, v138, v134
    v_add_f32 v139, v139, v135
    v_exp_f32 v130, v58
    v_exp_f32 v131, v59
    v_cvt_pk_bf16_f32 v124, v128, v129
    v_add_f32 v138, v138, v128
    v_add_f32 v139, v139, v129
    v_exp_f32 v132, v60
    v_exp_f32 v133, v61
    v_cvt_pk_bf16_f32 v125, v130, v131
    v_add_f32 v138, v138, v130
    v_add_f32 v139, v139, v131
    v_exp_f32 v134, v62
    v_exp_f32 v135, v63
    v_cvt_pk_bf16_f32 v126, v132, v133
    v_add_f32 v138, v138, v132
    v_add_f32 v139, v139, v133
    v_cvt_pk_bf16_f32 v127, v134, v135
    v_add_f32 v138, v138, v134
    v_add_f32 v139, v139, v135
    v_add_f32 v141, v138, v139
    s_nop 1
    s_branch k2_rr23
k2_fix25:
    s_cmp_eq_u32 s36, 0
    s_cselect_b32 s24, 0, 0x74000000
    v_subrev_f32 v146, s24, v243
    v_add_f32 v147, 0, v146
    v_min_f32 v80, v145, v147
    v_add_f32 v148, 0xf1800000, v146
    v_min_f32 v81, v145, v148
    v_add_f32 v147, 0xf2000000, v146
    v_min_f32 v82, v145, v147
    v_add_f32 v148, 0xf2400000, v146
    v_min_f32 v83, v145, v148
    v_add_f32 v147, 0xf3000000, v146
    v_min_f32 v84, v145, v147
    v_add_f32 v148, 0xf3100000, v146
    v_min_f32 v85, v145, v148
    v_add_f32 v147, 0xf3200000, v146
    v_min_f32 v86, v145, v147
    v_add_f32 v148, 0xf3300000, v146
    v_min_f32 v87, v145, v148
    v_add_f32 v147, 0xf3800000, v146
    v_min_f32 v88, v145, v147
    v_add_f32 v148, 0xf3880000, v146
    v_min_f32 v89, v145, v148
    v_add_f32 v147, 0xf3900000, v146
    v_min_f32 v90, v145, v147
    v_add_f32 v148, 0xf3980000, v146
    v_min_f32 v91, v145, v148
    v_add_f32 v147, 0xf3c00000, v146
    v_min_f32 v92, v145, v147
    v_add_f32 v148, 0xf3c80000, v146
    v_min_f32 v93, v145, v148
    v_add_f32 v147, 0xf3d00000, v146
    v_min_f32 v94, v145, v147
    v_add_f32 v148, 0xf3d80000, v146
    v_min_f32 v95, v145, v148
    s_nop 1
    s_branch k2_fixr26
k2_rare28:
    s_nop 15
    v_max3_f32 v146, v16, v17, v18
    v_max3_f32 v146, v146, v19, v20
    v_max3_f32 v146, v146, v21, v22
    v_max3_f32 v146, v146, v23, v24
    v_max3_f32 v146, v146, v25, v26
    v_max3_f32 v146, v146, v27, v28
    v_max3_f32 v146, v146, v29, v30
    v_max_f32 v146, v146, v31
    v_mov_b32 v147, v146
    s_nop 1
    v_permlane32_swap_b32 v146, v147
    s_nop 0
    v_max_f32 v146, v146, v147
    v_max_f32 v146, 0, v146
    v_sub_f32 v148, 0, v146
    v_exp_f32 v148, v148
    v_sub_f32 v145, v145, v146
    v_sub_f32 v80, v80, v146
    v_sub_f32 v48, v48, v146
    v_sub_f32 v16, v16, v146
    v_sub_f32 v81, v81, v146
    v_sub_f32 v49, v49, v146
    v_sub_f32 v17, v17, v146
    v_sub_f32 v82, v82, v146
    v_sub_f32 v50, v50, v146
    v_sub_f32 v18, v18, v146
    v_sub_f32 v83, v83, v146
    v_sub_f32 v51, v51, v146
    v_sub_f32 v19, v19, v146
    v_sub_f32 v84, v84, v146
    v_sub_f32 v52, v52, v146
    v_sub_f32 v20, v20, v146
    v_sub_f32 v85, v85, v146
    v_sub_f32 v53, v53, v146
    v_sub_f32 v21, v21, v146
    v_sub_f32 v86, v86, v146
    v_sub_f32 v54, v54, v146
    v_sub_f32 v22, v22, v146
    v_sub_f32 v87, v87, v146
    v_sub_f32 v55, v55, v146
    v_sub_f32 v23, v23, v146
    v_sub_f32 v88, v88, v146
    v_sub_f32 v56, v56, v146
    v_sub_f32 v24, v24, v146
    v_sub_f32 v89, v89, v146
    v_sub_f32 v57, v57, v146
    v_sub_f32 v25, v25, v146
    v_sub_f32 v90, v90, v146
    v_sub_f32 v58, v58, v146
    v_sub_f32 v26, v26, v146
    v_sub_f32 v91, v91, v146
    v_sub_f32 v59, v59, v146
    v_sub_f32 v27, v27, v146
    v_sub_f32 v92, v92, v146
    v_sub_f32 v60, v60, v146
    v_sub_f32 v28, v28, v146
    v_sub_f32 v93, v93, v146
    v_sub_f32 v61, v61, v146
    v_sub_f32 v29, v29, v146
    v_sub_f32 v94, v94, v146
    v_sub_f32 v62, v62, v146
    v_sub_f32 v30, v30, v146
    v_sub_f32 v95, v95, v146
    v_sub_f32 v63, v63, v146
    v_sub_f32 v31, v31, v146
    v_mul_f32 v143, v143, v148
    v_accvgpr_read_b32 v150, a64
    v_mul_f32 v150, v150, v148
    v_accvgpr_write_b32 a64, v150
    v_accvgpr_read_b32 v151, a65
    v_mul_f32 v151, v151, v148
    v_accvgpr_write_b32 a65, v151
    v_accvgpr_read_b32 v152, a66
    v_mul_f32 v152, v152, v148
    v_accvgpr_write_b32 a66, v152
    v_accvgpr_read_b32 v153, a67
    v_mul_f32 v153, v153, v148
    v_accvgpr_write_b32 a67, v153
    v_accvgpr_read_b32 v150, a68
    v_mul_f32 v150, v150, v148
    v_accvgpr_write_b32 a68, v150
    v_accvgpr_read_b32 v151, a69
    v_mul_f32 v151, v151, v148
    v_accvgpr_write_b32 a69, v151
    v_accvgpr_read_b32 v152, a70
    v_mul_f32 v152, v152, v148
    v_accvgpr_write_b32 a70, v152
    v_accvgpr_read_b32 v153, a71
    v_mul_f32 v153, v153, v148
    v_accvgpr_write_b32 a71, v153
    v_accvgpr_read_b32 v150, a72
    v_mul_f32 v150, v150, v148
    v_accvgpr_write_b32 a72, v150
    v_accvgpr_read_b32 v151, a73
    v_mul_f32 v151, v151, v148
    v_accvgpr_write_b32 a73, v151
    v_accvgpr_read_b32 v152, a74
    v_mul_f32 v152, v152, v148
    v_accvgpr_write_b32 a74, v152
    v_accvgpr_read_b32 v153, a75
    v_mul_f32 v153, v153, v148
    v_accvgpr_write_b32 a75, v153
    v_accvgpr_read_b32 v150, a76
    v_mul_f32 v150, v150, v148
    v_accvgpr_write_b32 a76, v150
    v_accvgpr_read_b32 v151, a77
    v_mul_f32 v151, v151, v148
    v_accvgpr_write_b32 a77, v151
    v_accvgpr_read_b32 v152, a78
    v_mul_f32 v152, v152, v148
    v_accvgpr_write_b32 a78, v152
    v_accvgpr_read_b32 v153, a79
    v_mul_f32 v153, v153, v148
    v_accvgpr_write_b32 a79, v153
    v_accvgpr_read_b32 v150, a80
    v_mul_f32 v150, v150, v148
    v_accvgpr_write_b32 a80, v150
    v_accvgpr_read_b32 v151, a81
    v_mul_f32 v151, v151, v148
    v_accvgpr_write_b32 a81, v151
    v_accvgpr_read_b32 v152, a82
    v_mul_f32 v152, v152, v148
    v_accvgpr_write_b32 a82, v152
    v_accvgpr_read_b32 v153, a83
    v_mul_f32 v153, v153, v148
    v_accvgpr_write_b32 a83, v153
    v_accvgpr_read_b32 v150, a84
    v_mul_f32 v150, v150, v148
    v_accvgpr_write_b32 a84, v150
    v_accvgpr_read_b32 v151, a85
    v_mul_f32 v151, v151, v148
    v_accvgpr_write_b32 a85, v151
    v_accvgpr_read_b32 v152, a86
    v_mul_f32 v152, v152, v148
    v_accvgpr_write_b32 a86, v152
    v_accvgpr_read_b32 v153, a87
    v_mul_f32 v153, v153, v148
    v_accvgpr_write_b32 a87, v153
    v_accvgpr_read_b32 v150, a88
    v_mul_f32 v150, v150, v148
    v_accvgpr_write_b32 a88, v150
    v_accvgpr_read_b32 v151, a89
    v_mul_f32 v151, v151, v148
    v_accvgpr_write_b32 a89, v151
    v_accvgpr_read_b32 v152, a90
    v_mul_f32 v152, v152, v148
    v_accvgpr_write_b32 a90, v152
    v_accvgpr_read_b32 v153, a91
    v_mul_f32 v153, v153, v148
    v_accvgpr_write_b32 a91, v153
    v_accvgpr_read_b32 v150, a92
    v_mul_f32 v150, v150, v148
    v_accvgpr_write_b32 a92, v150
    v_accvgpr_read_b32 v151, a93
    v_mul_f32 v151, v151, v148
    v_accvgpr_write_b32 a93, v151
    v_accvgpr_read_b32 v152, a94
    v_mul_f32 v152, v152, v148
    v_accvgpr_write_b32 a94, v152
    v_accvgpr_read_b32 v153, a95
    v_mul_f32 v153, v153, v148
    v_accvgpr_write_b32 a95, v153
    v_accvgpr_read_b32 v150, a96
    v_mul_f32 v150, v150, v148
    v_accvgpr_write_b32 a96, v150
    v_accvgpr_read_b32 v151, a97
    v_mul_f32 v151, v151, v148
    v_accvgpr_write_b32 a97, v151
    v_accvgpr_read_b32 v152, a98
    v_mul_f32 v152, v152, v148
    v_accvgpr_write_b32 a98, v152
    v_accvgpr_read_b32 v153, a99
    v_mul_f32 v153, v153, v148
    v_accvgpr_write_b32 a99, v153
    v_accvgpr_read_b32 v150, a100
    v_mul_f32 v150, v150, v148
    v_accvgpr_write_b32 a100, v150
    v_accvgpr_read_b32 v151, a101
    v_mul_f32 v151, v151, v148
    v_accvgpr_write_b32 a101, v151
    v_accvgpr_read_b32 v152, a102
    v_mul_f32 v152, v152, v148
    v_accvgpr_write_b32 a102, v152
    v_accvgpr_read_b32 v153, a103
    v_mul_f32 v153, v153, v148
    v_accvgpr_write_b32 a103, v153
    v_accvgpr_read_b32 v150, a104
    v_mul_f32 v150, v150, v148
    v_accvgpr_write_b32 a104, v150
    v_accvgpr_read_b32 v151, a105
    v_mul_f32 v151, v151, v148
    v_accvgpr_write_b32 a105, v151
    v_accvgpr_read_b32 v152, a106
    v_mul_f32 v152, v152, v148
    v_accvgpr_write_b32 a106, v152
    v_accvgpr_read_b32 v153, a107
    v_mul_f32 v153, v153, v148
    v_accvgpr_write_b32 a107, v153
    v_accvgpr_read_b32 v150, a108
    v_mul_f32 v150, v150, v148
    v_accvgpr_write_b32 a108, v150
    v_accvgpr_read_b32 v151, a109
    v_mul_f32 v151, v151, v148
    v_accvgpr_write_b32 a109, v151
    v_accvgpr_read_b32 v152, a110
    v_mul_f32 v152, v152, v148
    v_accvgpr_write_b32 a110, v152
    v_accvgpr_read_b32 v153, a111
    v_mul_f32 v153, v153, v148
    v_accvgpr_write_b32 a111, v153
    v_accvgpr_read_b32 v150, a112
    v_mul_f32 v150, v150, v148
    v_accvgpr_write_b32 a112, v150
    v_accvgpr_read_b32 v151, a113
    v_mul_f32 v151, v151, v148
    v_accvgpr_write_b32 a113, v151
    v_accvgpr_read_b32 v152, a114
    v_mul_f32 v152, v152, v148
    v_accvgpr_write_b32 a114, v152
    v_accvgpr_read_b32 v153, a115
    v_mul_f32 v153, v153, v148
    v_accvgpr_write_b32 a115, v153
    v_accvgpr_read_b32 v150, a116
    v_mul_f32 v150, v150, v148
    v_accvgpr_write_b32 a116, v150
    v_accvgpr_read_b32 v151, a117
    v_mul_f32 v151, v151, v148
    v_accvgpr_write_b32 a117, v151
    v_accvgpr_read_b32 v152, a118
    v_mul_f32 v152, v152, v148
    v_accvgpr_write_b32 a118, v152
    v_accvgpr_read_b32 v153, a119
    v_mul_f32 v153, v153, v148
    v_accvgpr_write_b32 a119, v153
    v_accvgpr_read_b32 v150, a120
    v_mul_f32 v150, v150, v148
    v_accvgpr_write_b32 a120, v150
    v_accvgpr_read_b32 v151, a121
    v_mul_f32 v151, v151, v148
    v_accvgpr_write_b32 a121, v151
    v_accvgpr_read_b32 v152, a122
    v_mul_f32 v152, v152, v148
    v_accvgpr_write_b32 a122, v152
    v_accvgpr_read_b32 v153, a123
    v_mul_f32 v153, v153, v148
    v_accvgpr_write_b32 a123, v153
    v_accvgpr_read_b32 v150, a124
    v_mul_f32 v150, v150, v148
    v_accvgpr_write_b32 a124, v150
    v_accvgpr_read_b32 v151, a125
    v_mul_f32 v151, v151, v148
    v_accvgpr_write_b32 a125, v151
    v_accvgpr_read_b32 v152, a126
    v_mul_f32 v152, v152, v148
    v_accvgpr_write_b32 a126, v152
    v_accvgpr_read_b32 v153, a127
    v_mul_f32 v153, v153, v148
    v_accvgpr_write_b32 a127, v153
    v_exp_f32 v138, v16
    v_exp_f32 v139, v17
    v_exp_f32 v130, v18
    v_exp_f32 v131, v19
    v_cvt_pk_bf16_f32 v104, v138, v139
    v_exp_f32 v132, v20
    v_exp_f32 v133, v21
    v_cvt_pk_bf16_f32 v105, v130, v131
    v_add_f32 v138, v138, v130
    v_add_f32 v139, v139, v131
    v_exp_f32 v134, v22
    v_exp_f32 v135, v23
    v_cvt_pk_bf16_f32 v106, v132, v133
    v_add_f32 v138, v138, v132
    v_add_f32 v139, v139, v133
    v_exp_f32 v128, v24
    v_exp_f32 v129, v25
    v_cvt_pk_bf16_f32 v107, v134, v135
    v_add_f32 v138, v138, v134
    v_add_f32 v139, v139, v135
    v_exp_f32 v130, v26
    v_exp_f32 v131, v27
    v_cvt_pk_bf16_f32 v108, v128, v129
    v_add_f32 v138, v138, v128
    v_add_f32 v139, v139, v129
    v_exp_f32 v132, v28
    v_exp_f32 v133, v29
    v_cvt_pk_bf16_f32 v109, v130, v131
    v_add_f32 v138, v138, v130
    v_add_f32 v139, v139, v131
    v_exp_f32 v134, v30
    v_exp_f32 v135, v31
    v_cvt_pk_bf16_f32 v110, v132, v133
    v_add_f32 v138, v138, v132
    v_add_f32 v139, v139, v133
    v_cvt_pk_bf16_f32 v111, v134, v135
    v_add_f32 v138, v138, v134
    v_add_f32 v139, v139, v135
    v_add_f32 v141, v138, v139
    s_nop 1
    s_branch k2_rr27
k2_rare30:
    s_nop 15
    v_max3_f32 v146, v48, v49, v50
    v_max3_f32 v146, v146, v51, v52
    v_max3_f32 v146, v146, v53, v54
    v_max3_f32 v146, v146, v55, v56
    v_max3_f32 v146, v146, v57, v58
    v_max3_f32 v146, v146, v59, v60
    v_max3_f32 v146, v146, v61, v62
    v_max_f32 v146, v146, v63
    v_mov_b32 v147, v146
    s_nop 1
    v_permlane32_swap_b32 v146, v147
    s_nop 0
    v_max_f32 v146, v146, v147
    v_max_f32 v146, 0, v146
    v_sub_f32 v148, 0, v146
    v_exp_f32 v148, v148
    v_sub_f32 v145, v145, v146
    v_sub_f32 v80, v80, v146
    v_sub_f32 v16, v16, v146
    v_sub_f32 v48, v48, v146
    v_sub_f32 v81, v81, v146
    v_sub_f32 v17, v17, v146
    v_sub_f32 v49, v49, v146
    v_sub_f32 v82, v82, v146
    v_sub_f32 v18, v18, v146
    v_sub_f32 v50, v50, v146
    v_sub_f32 v83, v83, v146
    v_sub_f32 v19, v19, v146
    v_sub_f32 v51, v51, v146
    v_sub_f32 v84, v84, v146
    v_sub_f32 v20, v20, v146
    v_sub_f32 v52, v52, v146
    v_sub_f32 v85, v85, v146
    v_sub_f32 v21, v21, v146
    v_sub_f32 v53, v53, v146
    v_sub_f32 v86, v86, v146
    v_sub_f32 v22, v22, v146
    v_sub_f32 v54, v54, v146
    v_sub_f32 v87, v87, v146
    v_sub_f32 v23, v23, v146
    v_sub_f32 v55, v55, v146
    v_sub_f32 v88, v88, v146
    v_sub_f32 v24, v24, v146
    v_sub_f32 v56, v56, v146
    v_sub_f32 v89, v89, v146
    v_sub_f32 v25, v25, v146
    v_sub_f32 v57, v57, v146
    v_sub_f32 v90, v90, v146
    v_sub_f32 v26, v26, v146
    v_sub_f32 v58, v58, v146
    v_sub_f32 v91, v91, v146
    v_sub_f32 v27, v27, v146
    v_sub_f32 v59, v59, v146
    v_sub_f32 v92, v92, v146
    v_sub_f32 v28, v28, v146
    v_sub_f32 v60, v60, v146
    v_sub_f32 v93, v93, v146
    v_sub_f32 v29, v29, v146
    v_sub_f32 v61, v61, v146
    v_sub_f32 v94, v94, v146
    v_sub_f32 v30, v30, v146
    v_sub_f32 v62, v62, v146
    v_sub_f32 v95, v95, v146
    v_sub_f32 v31, v31, v146
    v_sub_f32 v63, v63, v146
    v_mul_f32 v143, v143, v148
    v_accvgpr_read_b32 v150, a64
    v_mul_f32 v150, v150, v148
    v_accvgpr_write_b32 a64, v150
    v_accvgpr_read_b32 v151, a65
    v_mul_f32 v151, v151, v148
    v_accvgpr_write_b32 a65, v151
    v_accvgpr_read_b32 v152, a66
    v_mul_f32 v152, v152, v148
    v_accvgpr_write_b32 a66, v152
    v_accvgpr_read_b32 v153, a67
    v_mul_f32 v153, v153, v148
    v_accvgpr_write_b32 a67, v153
    v_accvgpr_read_b32 v150, a68
    v_mul_f32 v150, v150, v148
    v_accvgpr_write_b32 a68, v150
    v_accvgpr_read_b32 v151, a69
    v_mul_f32 v151, v151, v148
    v_accvgpr_write_b32 a69, v151
    v_accvgpr_read_b32 v152, a70
    v_mul_f32 v152, v152, v148
    v_accvgpr_write_b32 a70, v152
    v_accvgpr_read_b32 v153, a71
    v_mul_f32 v153, v153, v148
    v_accvgpr_write_b32 a71, v153
    v_accvgpr_read_b32 v150, a72
    v_mul_f32 v150, v150, v148
    v_accvgpr_write_b32 a72, v150
    v_accvgpr_read_b32 v151, a73
    v_mul_f32 v151, v151, v148
    v_accvgpr_write_b32 a73, v151
    v_accvgpr_read_b32 v152, a74
    v_mul_f32 v152, v152, v148
    v_accvgpr_write_b32 a74, v152
    v_accvgpr_read_b32 v153, a75
    v_mul_f32 v153, v153, v148
    v_accvgpr_write_b32 a75, v153
    v_accvgpr_read_b32 v150, a76
    v_mul_f32 v150, v150, v148
    v_accvgpr_write_b32 a76, v150
    v_accvgpr_read_b32 v151, a77
    v_mul_f32 v151, v151, v148
    v_accvgpr_write_b32 a77, v151
    v_accvgpr_read_b32 v152, a78
    v_mul_f32 v152, v152, v148
    v_accvgpr_write_b32 a78, v152
    v_accvgpr_read_b32 v153, a79
    v_mul_f32 v153, v153, v148
    v_accvgpr_write_b32 a79, v153
    v_accvgpr_read_b32 v150, a80
    v_mul_f32 v150, v150, v148
    v_accvgpr_write_b32 a80, v150
    v_accvgpr_read_b32 v151, a81
    v_mul_f32 v151, v151, v148
    v_accvgpr_write_b32 a81, v151
    v_accvgpr_read_b32 v152, a82
    v_mul_f32 v152, v152, v148
    v_accvgpr_write_b32 a82, v152
    v_accvgpr_read_b32 v153, a83
    v_mul_f32 v153, v153, v148
    v_accvgpr_write_b32 a83, v153
    v_accvgpr_read_b32 v150, a84
    v_mul_f32 v150, v150, v148
    v_accvgpr_write_b32 a84, v150
    v_accvgpr_read_b32 v151, a85
    v_mul_f32 v151, v151, v148
    v_accvgpr_write_b32 a85, v151
    v_accvgpr_read_b32 v152, a86
    v_mul_f32 v152, v152, v148
    v_accvgpr_write_b32 a86, v152
    v_accvgpr_read_b32 v153, a87
    v_mul_f32 v153, v153, v148
    v_accvgpr_write_b32 a87, v153
    v_accvgpr_read_b32 v150, a88
    v_mul_f32 v150, v150, v148
    v_accvgpr_write_b32 a88, v150
    v_accvgpr_read_b32 v151, a89
    v_mul_f32 v151, v151, v148
    v_accvgpr_write_b32 a89, v151
    v_accvgpr_read_b32 v152, a90
    v_mul_f32 v152, v152, v148
    v_accvgpr_write_b32 a90, v152
    v_accvgpr_read_b32 v153, a91
    v_mul_f32 v153, v153, v148
    v_accvgpr_write_b32 a91, v153
    v_accvgpr_read_b32 v150, a92
    v_mul_f32 v150, v150, v148
    v_accvgpr_write_b32 a92, v150
    v_accvgpr_read_b32 v151, a93
    v_mul_f32 v151, v151, v148
    v_accvgpr_write_b32 a93, v151
    v_accvgpr_read_b32 v152, a94
    v_mul_f32 v152, v152, v148
    v_accvgpr_write_b32 a94, v152
    v_accvgpr_read_b32 v153, a95
    v_mul_f32 v153, v153, v148
    v_accvgpr_write_b32 a95, v153
    v_accvgpr_read_b32 v150, a96
    v_mul_f32 v150, v150, v148
    v_accvgpr_write_b32 a96, v150
    v_accvgpr_read_b32 v151, a97
    v_mul_f32 v151, v151, v148
    v_accvgpr_write_b32 a97, v151
    v_accvgpr_read_b32 v152, a98
    v_mul_f32 v152, v152, v148
    v_accvgpr_write_b32 a98, v152
    v_accvgpr_read_b32 v153, a99
    v_mul_f32 v153, v153, v148
    v_accvgpr_write_b32 a99, v153
    v_accvgpr_read_b32 v150, a100
    v_mul_f32 v150, v150, v148
    v_accvgpr_write_b32 a100, v150
    v_accvgpr_read_b32 v151, a101
    v_mul_f32 v151, v151, v148
    v_accvgpr_write_b32 a101, v151
    v_accvgpr_read_b32 v152, a102
    v_mul_f32 v152, v152, v148
    v_accvgpr_write_b32 a102, v152
    v_accvgpr_read_b32 v153, a103
    v_mul_f32 v153, v153, v148
    v_accvgpr_write_b32 a103, v153
    v_accvgpr_read_b32 v150, a104
    v_mul_f32 v150, v150, v148
    v_accvgpr_write_b32 a104, v150
    v_accvgpr_read_b32 v151, a105
    v_mul_f32 v151, v151, v148
    v_accvgpr_write_b32 a105, v151
    v_accvgpr_read_b32 v152, a106
    v_mul_f32 v152, v152, v148
    v_accvgpr_write_b32 a106, v152
    v_accvgpr_read_b32 v153, a107
    v_mul_f32 v153, v153, v148
    v_accvgpr_write_b32 a107, v153
    v_accvgpr_read_b32 v150, a108
    v_mul_f32 v150, v150, v148
    v_accvgpr_write_b32 a108, v150
    v_accvgpr_read_b32 v151, a109
    v_mul_f32 v151, v151, v148
    v_accvgpr_write_b32 a109, v151
    v_accvgpr_read_b32 v152, a110
    v_mul_f32 v152, v152, v148
    v_accvgpr_write_b32 a110, v152
    v_accvgpr_read_b32 v153, a111
    v_mul_f32 v153, v153, v148
    v_accvgpr_write_b32 a111, v153
    v_accvgpr_read_b32 v150, a112
    v_mul_f32 v150, v150, v148
    v_accvgpr_write_b32 a112, v150
    v_accvgpr_read_b32 v151, a113
    v_mul_f32 v151, v151, v148
    v_accvgpr_write_b32 a113, v151
    v_accvgpr_read_b32 v152, a114
    v_mul_f32 v152, v152, v148
    v_accvgpr_write_b32 a114, v152
    v_accvgpr_read_b32 v153, a115
    v_mul_f32 v153, v153, v148
    v_accvgpr_write_b32 a115, v153
    v_accvgpr_read_b32 v150, a116
    v_mul_f32 v150, v150, v148
    v_accvgpr_write_b32 a116, v150
    v_accvgpr_read_b32 v151, a117
    v_mul_f32 v151, v151, v148
    v_accvgpr_write_b32 a117, v151
    v_accvgpr_read_b32 v152, a118
    v_mul_f32 v152, v152, v148
    v_accvgpr_write_b32 a118, v152
    v_accvgpr_read_b32 v153, a119
    v_mul_f32 v153, v153, v148
    v_accvgpr_write_b32 a119, v153
    v_accvgpr_read_b32 v150, a120
    v_mul_f32 v150, v150, v148
    v_accvgpr_write_b32 a120, v150
    v_accvgpr_read_b32 v151, a121
    v_mul_f32 v151, v151, v148
    v_accvgpr_write_b32 a121, v151
    v_accvgpr_read_b32 v152, a122
    v_mul_f32 v152, v152, v148
    v_accvgpr_write_b32 a122, v152
    v_accvgpr_read_b32 v153, a123
    v_mul_f32 v153, v153, v148
    v_accvgpr_write_b32 a123, v153
    v_accvgpr_read_b32 v150, a124
    v_mul_f32 v150, v150, v148
    v_accvgpr_write_b32 a124, v150
    v_accvgpr_read_b32 v151, a125
    v_mul_f32 v151, v151, v148
    v_accvgpr_write_b32 a125, v151
    v_accvgpr_read_b32 v152, a126
    v_mul_f32 v152, v152, v148
    v_accvgpr_write_b32 a126, v152
    v_accvgpr_read_b32 v153, a127
    v_mul_f32 v153, v153, v148
    v_accvgpr_write_b32 a127, v153
    v_exp_f32 v138, v48
    v_exp_f32 v139, v49
    v_exp_f32 v130, v50
    v_exp_f32 v131, v51
    v_cvt_pk_bf16_f32 v120, v138, v139
    v_exp_f32 v132, v52
    v_exp_f32 v133, v53
    v_cvt_pk_bf16_f32 v121, v130, v131
    v_add_f32 v138, v138, v130
    v_add_f32 v139, v139, v131
    v_exp_f32 v134, v54
    v_exp_f32 v135, v55
    v_cvt_pk_bf16_f32 v122, v132, v133
    v_add_f32 v138, v138, v132
    v_add_f32 v139, v139, v133
    v_exp_f32 v128, v56
    v_exp_f32 v129, v57
    v_cvt_pk_bf16_f32 v123, v134, v135
    v_add_f32 v138, v138, v134
    v_add_f32 v139, v139, v135
    v_exp_f32 v130, v58
    v_exp_f32 v131, v59
    v_cvt_pk_bf16_f32 v124, v128, v129
    v_add_f32 v138, v138, v128
    v_add_f32 v139, v139, v129
    v_exp_f32 v132, v60
    v_exp_f32 v133, v61
    v_cvt_pk_bf16_f32 v125, v130, v131
    v_add_f32 v138, v138, v130
    v_add_f32 v139, v139, v131
    v_exp_f32 v134, v62
    v_exp_f32 v135, v63
    v_cvt_pk_bf16_f32 v126, v132, v133
    v_add_f32 v138, v138, v132
    v_add_f32 v139, v139, v133
    v_cvt_pk_bf16_f32 v127, v134, v135
    v_add_f32 v138, v138, v134
    v_add_f32 v139, v139, v135
    v_add_f32 v141, v138, v139
    s_nop 1
    s_branch k2_rr29

.globl k3_kernel
.p2align 8
.type k3_kernel,@function
k3_kernel:
    s_cmp_ge_u32 s2, 256
    s_cbranch_scc1 k3_done
    s_load_dwordx2 s[40:41], s[0:1], 0
    s_load_dwordx2 s[42:43], s[0:1], 40
    s_load_dwordx2 s[44:45], s[0:1], 56
    s_load_dwordx2 s[46:47], s[0:1], 104
    v_lshrrev_b32 v1, 6, v0
    v_and_b32 v227, 63, v0
    v_readfirstlane_b32 s3, v1
    s_and_b32 s32, s2, 6
    s_lshl_b32 s4, s32, 1
    s_lshr_b32 s32, s2, 3
    s_and_b32 s33, s32, 3
    s_add_u32 s4, s4, s33
    s_lshr_b32 s5, s32, 2
    s_and_b32 s32, s2, 1
    s_lshl_b32 s32, s32, 3
    s_add_u32 s5, s5, s32
    s_waitcnt lgkmcnt(0)
    s_add_u32 s8, s46, 0x2400000
    s_addc_u32 s9, s47, 0
    s_mov_b32 s10, 0x1000000
    s_mov_b32 s11, 0x00020000
    s_mov_b32 s12, s42
    s_mov_b32 s13, s43
    s_mov_b32 s14, 0x800000
    s_mov_b32 s15, 0x00020000
    s_mov_b32 s16, s40
    s_mov_b32 s17, s41
    s_mov_b32 s18, 0x400000
    s_mov_b32 s19, 0x00020000
    s_add_u32 s20, s46, 0x3400000
    s_addc_u32 s21, s47, 0
    s_mov_b32 s22, 0x400000
    s_mov_b32 s23, 0x00020000
    s_add_u32 s24, s46, 0x3800000
    s_addc_u32 s25, s47, 0
    s_mov_b32 s26, 0x6040
    s_mov_b32 s27, 0x00020000
    s_mov_b32 s28, s44
    s_mov_b32 s29, s45
    s_mov_b32 s30, 0x800
    s_mov_b32 s31, 0x00020000
    v_lshlrev_b32 v213, 4, v227
    s_lshl1_add_u32 s32, s3, 0
    s_and_b32 s32, s32, 7
    s_lshl_b32 s32, s32, 17
    v_add_u32 v200, s32, v213
    s_lshl1_add_u32 s32, s3, 1
    s_and_b32 s32, s32, 7
    s_lshl_b32 s32, s32, 17
    v_add_u32 v201, s32, v213
    s_lshl1_add_u32 s32, s3, 2
    s_and_b32 s32, s32, 7
    s_lshl_b32 s32, s32, 17
    v_add_u32 v202, s32, v213
    s_lshl1_add_u32 s32, s3, 3
    s_and_b32 s32, s32, 7
    s_lshl_b32 s32, s32, 17
    v_add_u32 v203, s32, v213
    s_lshl1_add_u32 s32, s3, 4
    s_and_b32 s32, s32, 7
    s_lshl_b32 s32, s32, 17
    v_add_u32 v204, s32, v213
    s_lshl1_add_u32 s32, s3, 5
    s_and_b32 s32, s32, 7
    s_lshl_b32 s32, s32, 17
    v_add_u32 v205, s32, v213
    s_lshl1_add_u32 s32, s3, 6
    s_and_b32 s32, s32, 7
    s_lshl_b32 s32, s32, 17
    v_add_u32 v206, s32, v213
    s_lshl1_add_u32 s32, s3, 7
    s_and_b32 s32, s32, 7
    s_lshl_b32 s32, s32, 17
    v_add_u32 v207, s32, v213
    s_lshl_b32 s35, s4, 20
    s_lshl_b32 s32, s3, 15
    s_add_u32 s35, s35, s32
    v_lshrrev_b32 v224, 3, v227
    v_and_b32 v225, 6, v224
    v_and_b32 v226, 7, v227
    v_xor_b32 v225, v225, v226
    v_lshlrev_b32 v225, 4, v225
    v_lshl_add_u32 v225, v224, 11, v225
    s_lshl_b32 s32, s5, 7
    v_add_u32 v208, s32, v225
    s_lshl_b32 s36, s3, 21
    s_lshl_b32 s37, s3, 14
    s_add_u32 m0, s37, 0
    s_add_u32 s32, s36, 0
    buffer_load_dwordx4 v208, s[12:15], s32 offen lds
    s_add_u32 m0, s37, 1024
    s_add_u32 s32, s36, 16384
    buffer_load_dwordx4 v208, s[12:15], s32 offen lds
    s_add_u32 m0, s37, 2048
    s_add_u32 s32, s36, 32768
    buffer_load_dwordx4 v208, s[12:15], s32 offen lds
    s_add_u32 m0, s37, 3072
    s_add_u32 s32, s36, 49152
    buffer_load_dwordx4 v208, s[12:15], s32 offen lds
    buffer_load_dwordx4 v[0:3], v200, s[8:11], s35 offen offset:0
    buffer_load_dwordx4 v[4:7], v201, s[8:11], s35 offen offset:0
    buffer_load_dwordx4 v[8:11], v202, s[8:11], s35 offen offset:0
    buffer_load_dwordx4 v[12:15], v203, s[8:11], s35 offen offset:0
    buffer_load_dwordx4 v[16:19], v204, s[8:11], s35 offen offset:0
    buffer_load_dwordx4 v[20:23], v205, s[8:11], s35 offen offset:0
    buffer_load_dwordx4 v[24:27], v206, s[8:11], s35 offen offset:0
    buffer_load_dwordx4 v[28:31], v207, s[8:11], s35 offen offset:0
    s_add_u32 m0, s37, 4096
    s_add_u32 s32, s36, 65536
    buffer_load_dwordx4 v208, s[12:15], s32 offen lds
    s_add_u32 m0, s37, 5120
    s_add_u32 s32, s36, 81920
    buffer_load_dwordx4 v208, s[12:15], s32 offen lds
    s_add_u32 m0, s37, 6144
    s_add_u32 s32, s36, 98304
    buffer_load_dwordx4 v208, s[12:15], s32 offen lds
    s_add_u32 m0, s37, 7168
    s_add_u32 s32, s36, 114688
    buffer_load_dwordx4 v208, s[12:15], s32 offen lds
    buffer_load_dwordx4 v[32:35], v200, s[8:11], s35 offen offset:1024
    buffer_load_dwordx4 v[36:39], v201, s[8:11], s35 offen offset:1024
    buffer_load_dwordx4 v[40:43], v202, s[8:11], s35 offen offset:1024
    buffer_load_dwordx4 v[44:47], v203, s[8:11], s35 offen offset:1024
    buffer_load_dwordx4 v[48:51], v204, s[8:11], s35 offen offset:1024
    buffer_load_dwordx4 v[52:55], v205, s[8:11], s35 offen offset:1024
    buffer_load_dwordx4 v[56:59], v206, s[8:11], s35 offen offset:1024
    buffer_load_dwordx4 v[60:63], v207, s[8:11], s35 offen offset:1024
    s_add_u32 m0, s37, 8192
    s_add_u32 s32, s36, 131072
    buffer_load_dwordx4 v208, s[12:15], s32 offen lds
    s_add_u32 m0, s37, 9216
    s_add_u32 s32, s36, 147456
    buffer_load_dwordx4 v208, s[12:15], s32 offen lds
    s_add_u32 m0, s37, 10240
    s_add_u32 s32, s36, 163840
    buffer_load_dwordx4 v208, s[12:15], s32 offen lds
    s_add_u32 m0, s37, 11264
    s_add_u32 s32, s36, 180224
    buffer_load_dwordx4 v208, s[12:15], s32 offen lds
    buffer_load_dwordx4 v[64:67], v200, s[8:11], s35 offen offset:2048
    buffer_load_dwordx4 v[68:71], v201, s[8:11], s35 offen offset:2048
    buffer_load_dwordx4 v[72:75], v202, s[8:11], s35 offen offset:2048
    buffer_load_dwordx4 v[76:79], v203, s[8:11], s35 offen offset:2048
    buffer_load_dwordx4 v[80:83], v204, s[8:11], s35 offen offset:2048
    buffer_load_dwordx4 v[84:87], v205, s[8:11], s35 offen offset:2048
    buffer_load_dwordx4 v[88:91], v206, s[8:11], s35 offen offset:2048
    buffer_load_dwordx4 v[92:95], v207, s[8:11], s35 offen offset:2048
    s_add_u32 m0, s37, 12288
    s_add_u32 s32, s36, 196608
    buffer_load_dwordx4 v208, s[12:15], s32 offen lds
    s_add_u32 m0, s37, 13312
    s_add_u32 s32, s36, 212992
    buffer_load_dwordx4 v208, s[12:15], s32 offen lds
    s_add_u32 m0, s37, 14336
    s_add_u32 s32, s36, 229376
    buffer_load_dwordx4 v208, s[12:15], s32 offen lds
    s_add_u32 m0, s37, 15360
    s_add_u32 s32, s36, 245760
    buffer_load_dwordx4 v208, s[12:15], s32 offen lds
    buffer_load_dwordx4 v[96:99], v200, s[8:11], s35 offen offset:3072
    buffer_load_dwordx4 v[100:103], v201, s[8:11], s35 offen offset:3072
    buffer_load_dwordx4 v[104:107], v202, s[8:11], s35 offen offset:3072
    buffer_load_dwordx4 v[108:111], v203, s[8:11], s35 offen offset:3072
    buffer_load_dwordx4 v[112:115], v204, s[8:11], s35 offen offset:3072
    buffer_load_dwordx4 v[116:119], v205, s[8:11], s35 offen offset:3072
    buffer_load_dwordx4 v[120:123], v206, s[8:11], s35 offen offset:3072
    buffer_load_dwordx4 v[124:127], v207, s[8:11], s35 offen offset:3072
    s_add_u32 s35, s35, 4096
    s_add_u32 s36, s36, 262144
    v_bfe_u32 v224, v227, 2, 3
    v_lshrrev_b32 v225, 5, v227
    v_lshl_add_u32 v225, v225, 4, v224
    v_lshlrev_b32 v225, 7, v225
    v_add_u32 v225, s37, v225
    v_and_b32 v226, 1, v227
    v_lshl_add_u32 v225, v226, 3, v225
    v_and_b32 v224, 6, v224
    v_bfe_u32 v226, v227, 1, 1
    v_xor_b32 v224, v224, v226
    v_xor_b32 v226, 0, v224
    v_lshl_add_u32 v209, v226, 4, v225
    v_xor_b32 v226, 2, v224
    v_lshl_add_u32 v210, v226, 4, v225
    v_xor_b32 v226, 4, v224
    v_lshl_add_u32 v211, v226, 4, v225
    v_xor_b32 v226, 6, v224
    v_lshl_add_u32 v212, v226, 4, v225
    s_lshl_b32 s32, s4, 7
    s_lshl_b32 s33, s3, 5
    s_add_u32 s32, s32, s33
    v_and_b32 v224, 15, v227
    v_add_u32 v224, s32, v224
    v_lshrrev_b32 v225, 4, v227
    v_lshlrev_b32 v226, 3, v225
    s_lshl_b32 s33, s5, 7
    v_add_u32 v226, s33, v226
    v_lshl_add_u32 v214, v224, 11, v226
    s_mov_b32 s38, 32768
    buffer_load_dwordx2 v[160:161], v214, s[16:19], 0 offen offset:0
    buffer_load_dwordx2 v[162:163], v214, s[16:19], 0 offen offset:32
    buffer_load_dwordx2 v[164:165], v214, s[16:19], 0 offen offset:64
    buffer_load_dwordx2 v[166:167], v214, s[16:19], 0 offen offset:96
    buffer_load_dwordx2 v[168:169], v214, s[16:19], s38 offen offset:0
    buffer_load_dwordx2 v[170:171], v214, s[16:19], s38 offen offset:32
    buffer_load_dwordx2 v[172:173], v214, s[16:19], s38 offen offset:64
    buffer_load_dwordx2 v[174:175], v214, s[16:19], s38 offen offset:96
    buffer_load_dwordx2 v[176:177], v226, s[28:31], 0 offen offset:0
    buffer_load_dwordx2 v[178:179], v226, s[28:31], 0 offen offset:32
    buffer_load_dwordx2 v[180:181], v226, s[28:31], 0 offen offset:64
    buffer_load_dwordx2 v[182:183], v226, s[28:31], 0 offen offset:96
    v_and_b32 v226, 1, v225
    v_lshl_add_u32 v224, v226, 4, v224
    v_lshlrev_b32 v224, 2, v224
    v_lshrrev_b32 v225, 1, v225
    v_lshl_add_u32 v215, v225, 13, v224
    v_lshlrev_b32 v225, 20, v225
    v_add_u32 v225, 16384, v225
    v_add_u32 v216, v225, v224
    s_or_b32 s32, s4, s3
    s_cmp_eq_u32 s32, 0
    s_cselect_b32 s32, 32, 64
    v_cmp_eq_u32 vcc, s32, v227
    v_mov_b32 v225, 24576
    s_nop 0
    v_cndmask_b32 v216, v216, v225, vcc
    s_add_u32 s32, s3, 1
    s_and_b32 s32, s32, 3
    s_mul_i32 s32, s32, 24576
    s_add_u32 s32, s32, 0
    v_add_u32 v217, s32, v213
    s_add_u32 s32, s3, 2
    s_and_b32 s32, s32, 3
    s_mul_i32 s32, s32, 24576
    s_add_u32 s32, s32, 8192
    v_add_u32 v218, s32, v213
    s_add_u32 s32, s3, 3
    s_and_b32 s32, s32, 3
    s_mul_i32 s32, s32, 24576
    s_add_u32 s32, s32, 16384
    v_add_u32 v219, s32, v213
    s_mul_i32 s32, s3, 24576
    v_add_u32 v220, s32, v213
    v_accvgpr_write_b32 a0, 0
    v_accvgpr_write_b32 a1, 0
    v_accvgpr_write_b32 a2, 0
    v_accvgpr_write_b32 a3, 0
    v_accvgpr_write_b32 a4, 0
    v_accvgpr_write_b32 a5, 0
    v_accvgpr_write_b32 a6, 0
    v_accvgpr_write_b32 a7, 0
    v_accvgpr_write_b32 a8, 0
    v_accvgpr_write_b32 a9, 0
    v_accvgpr_write_b32 a10, 0
    v_accvgpr_write_b32 a11, 0
    v_accvgpr_write_b32 a12, 0
    v_accvgpr_write_b32 a13, 0
    v_accvgpr_write_b32 a14, 0
    v_accvgpr_write_b32 a15, 0
    v_accvgpr_write_b32 a16, 0
    v_accvgpr_write_b32 a17, 0
    v_accvgpr_write_b32 a18, 0
    v_accvgpr_write_b32 a19, 0
    v_accvgpr_write_b32 a20, 0
    v_accvgpr_write_b32 a21, 0
    v_accvgpr_write_b32 a22, 0
    v_accvgpr_write_b32 a23, 0
    v_accvgpr_write_b32 a24, 0
    v_accvgpr_write_b32 a25, 0
    v_accvgpr_write_b32 a26, 0
    v_accvgpr_write_b32 a27, 0
    v_accvgpr_write_b32 a28, 0
    v_accvgpr_write_b32 a29, 0
    v_accvgpr_write_b32 a30, 0
    v_accvgpr_write_b32 a31, 0
    v_accvgpr_write_b32 a32, 0
    v_accvgpr_write_b32 a33, 0
    v_accvgpr_write_b32 a34, 0
    v_accvgpr_write_b32 a35, 0
    v_accvgpr_write_b32 a36, 0
    v_accvgpr_write_b32 a37, 0
    v_accvgpr_write_b32 a38, 0
    v_accvgpr_write_b32 a39, 0
    v_accvgpr_write_b32 a40, 0
    v_accvgpr_write_b32 a41, 0
    v_accvgpr_write_b32 a42, 0
    v_accvgpr_write_b32 a43, 0
    v_accvgpr_write_b32 a44, 0
    v_accvgpr_write_b32 a45, 0
    v_accvgpr_write_b32 a46, 0
    v_accvgpr_write_b32 a47, 0
    v_accvgpr_write_b32 a48, 0
    v_accvgpr_write_b32 a49, 0
    v_accvgpr_write_b32 a50, 0
    v_accvgpr_write_b32 a51, 0
    v_accvgpr_write_b32 a52, 0
    v_accvgpr_write_b32 a53, 0
    v_accvgpr_write_b32 a54, 0
    v_accvgpr_write_b32 a55, 0
    v_accvgpr_write_b32 a56, 0
    v_accvgpr_write_b32 a57, 0
    v_accvgpr_write_b32 a58, 0
    v_accvgpr_write_b32 a59, 0
    v_accvgpr_write_b32 a60, 0
    v_accvgpr_write_b32 a61, 0
    v_accvgpr_write_b32 a62, 0
    v_accvgpr_write_b32 a63, 0
    v_accvgpr_write_b32 a64, 0
    v_accvgpr_write_b32 a65, 0
    v_accvgpr_write_b32 a66, 0
    v_accvgpr_write_b32 a67, 0
    v_accvgpr_write_b32 a68, 0
    v_accvgpr_write_b32 a69, 0
    v_accvgpr_write_b32 a70, 0
    v_accvgpr_write_b32 a71, 0
    v_accvgpr_write_b32 a72, 0
    v_accvgpr_write_b32 a73, 0
    v_accvgpr_write_b32 a74, 0
    v_accvgpr_write_b32 a75, 0
    v_accvgpr_write_b32 a76, 0
    v_accvgpr_write_b32 a77, 0
    v_accvgpr_write_b32 a78, 0
    v_accvgpr_write_b32 a79, 0
    v_accvgpr_write_b32 a80, 0
    v_accvgpr_write_b32 a81, 0
    v_accvgpr_write_b32 a82, 0
    v_accvgpr_write_b32 a83, 0
    v_accvgpr_write_b32 a84, 0
    v_accvgpr_write_b32 a85, 0
    v_accvgpr_write_b32 a86, 0
    v_accvgpr_write_b32 a87, 0
    v_accvgpr_write_b32 a88, 0
    v_accvgpr_write_b32 a89, 0
    v_accvgpr_write_b32 a90, 0
    v_accvgpr_write_b32 a91, 0
    v_accvgpr_write_b32 a92, 0
    v_accvgpr_write_b32 a93, 0
    v_accvgpr_write_b32 a94, 0
    v_accvgpr_write_b32 a95, 0
    v_accvgpr_write_b32 a96, 0
    v_accvgpr_write_b32 a97, 0
    v_accvgpr_write_b32 a98, 0
    v_accvgpr_write_b32 a99, 0
    v_accvgpr_write_b32 a100, 0
    v_accvgpr_write_b32 a101, 0
    v_accvgpr_write_b32 a102, 0
    v_accvgpr_write_b32 a103, 0
    v_accvgpr_write_b32 a104, 0
    v_accvgpr_write_b32 a105, 0
    v_accvgpr_write_b32 a106, 0
    v_accvgpr_write_b32 a107, 0
    v_accvgpr_write_b32 a108, 0
    v_accvgpr_write_b32 a109, 0
    v_accvgpr_write_b32 a110, 0
    v_accvgpr_write_b32 a111, 0
    v_accvgpr_write_b32 a112, 0
    v_accvgpr_write_b32 a113, 0
    v_accvgpr_write_b32 a114, 0
    v_accvgpr_write_b32 a115, 0
    v_accvgpr_write_b32 a116, 0
    v_accvgpr_write_b32 a117, 0
    v_accvgpr_write_b32 a118, 0
    v_accvgpr_write_b32 a119, 0
    v_accvgpr_write_b32 a120, 0
    v_accvgpr_write_b32 a121, 0
    v_accvgpr_write_b32 a122, 0
    v_accvgpr_write_b32 a123, 0
    v_accvgpr_write_b32 a124, 0
    v_accvgpr_write_b32 a125, 0
    v_accvgpr_write_b32 a126, 0
    v_accvgpr_write_b32 a127, 0
    s_waitcnt vmcnt(56)
    ds_read_b64_tr_b16 v[128:129], v209 offset:0
    ds_read_b64_tr_b16 v[130:131], v209 offset:1024
    ds_read_b64_tr_b16 v[132:133], v210 offset:0
    ds_read_b64_tr_b16 v[134:135], v210 offset:1024
    ds_read_b64_tr_b16 v[136:137], v211 offset:0
    ds_read_b64_tr_b16 v[138:139], v211 offset:1024
    ds_read_b64_tr_b16 v[140:141], v212 offset:0
    ds_read_b64_tr_b16 v[142:143], v212 offset:1024
    s_mov_b32 s34, 8
.p2align 3
k3_loop:
    s_waitcnt vmcnt(32) lgkmcnt(0)
    v_mfma_f32_16x16x32_bf16 a[0:3], v[128:131], v[0:3], a[0:3]
    s_add_u32 m0, s37, 0
    s_add_u32 s32, s36, 0
    buffer_load_dwordx4 v208, s[12:15], s32 offen lds
    v_mfma_f32_16x16x32_bf16 a[4:7], v[132:135], v[0:3], a[4:7]
    s_add_u32 m0, s37, 1024
    s_add_u32 s32, s36, 16384
    buffer_load_dwordx4 v208, s[12:15], s32 offen lds
    v_mfma_f32_16x16x32_bf16 a[8:11], v[136:139], v[0:3], a[8:11]
    s_add_u32 m0, s37, 2048
    s_add_u32 s32, s36, 32768
    buffer_load_dwordx4 v208, s[12:15], s32 offen lds
    v_mfma_f32_16x16x32_bf16 a[12:15], v[140:143], v[0:3], a[12:15]
    s_add_u32 m0, s37, 3072
    s_add_u32 s32, s36, 49152
    buffer_load_dwordx4 v208, s[12:15], s32 offen lds
    v_mfma_f32_16x16x32_bf16 a[16:19], v[128:131], v[4:7], a[16:19]
    ds_read_b64_tr_b16 v[144:145], v209 offset:4096
    buffer_load_dwordx4 v[0:3], v200, s[8:11], s35 offen offset:0
    v_mfma_f32_16x16x32_bf16 a[20:23], v[132:135], v[4:7], a[20:23]
    ds_read_b64_tr_b16 v[146:147], v209 offset:5120
    v_mfma_f32_16x16x32_bf16 a[24:27], v[136:139], v[4:7], a[24:27]
    ds_read_b64_tr_b16 v[148:149], v210 offset:4096
    v_mfma_f32_16x16x32_bf16 a[28:31], v[140:143], v[4:7], a[28:31]
    ds_read_b64_tr_b16 v[150:151], v210 offset:5120
    v_mfma_f32_16x16x32_bf16 a[32:35], v[128:131], v[8:11], a[32:35]
    ds_read_b64_tr_b16 v[152:153], v211 offset:4096
    buffer_load_dwordx4 v[4:7], v201, s[8:11], s35 offen offset:0
    v_mfma_f32_16x16x32_bf16 a[36:39], v[132:135], v[8:11], a[36:39]
    ds_read_b64_tr_b16 v[154:155], v211 offset:5120
    v_mfma_f32_16x16x32_bf16 a[40:43], v[136:139], v[8:11], a[40:43]
    ds_read_b64_tr_b16 v[156:157], v212 offset:4096
    v_mfma_f32_16x16x32_bf16 a[44:47], v[140:143], v[8:11], a[44:47]
    ds_read_b64_tr_b16 v[158:159], v212 offset:5120
    v_mfma_f32_16x16x32_bf16 a[48:51], v[128:131], v[12:15], a[48:51]
    buffer_load_dwordx4 v[8:11], v202, s[8:11], s35 offen offset:0
    v_mfma_f32_16x16x32_bf16 a[52:55], v[132:135], v[12:15], a[52:55]
    v_mfma_f32_16x16x32_bf16 a[56:59], v[136:139], v[12:15], a[56:59]
    v_mfma_f32_16x16x32_bf16 a[60:63], v[140:143], v[12:15], a[60:63]
    v_mfma_f32_16x16x32_bf16 a[64:67], v[128:131], v[16:19], a[64:67]
    buffer_load_dwordx4 v[12:15], v203, s[8:11], s35 offen offset:0
    v_mfma_f32_16x16x32_bf16 a[68:71], v[132:135], v[16:19], a[68:71]
    v_mfma_f32_16x16x32_bf16 a[72:75], v[136:139], v[16:19], a[72:75]
    v_mfma_f32_16x16x32_bf16 a[76:79], v[140:143], v[16:19], a[76:79]
    v_mfma_f32_16x16x32_bf16 a[80:83], v[128:131], v[20:23], a[80:83]
    buffer_load_dwordx4 v[16:19], v204, s[8:11], s35 offen offset:0
    v_mfma_f32_16x16x32_bf16 a[84:87], v[132:135], v[20:23], a[84:87]
    v_mfma_f32_16x16x32_bf16 a[88:91], v[136:139], v[20:23], a[88:91]
    v_mfma_f32_16x16x32_bf16 a[92:95], v[140:143], v[20:23], a[92:95]
    v_mfma_f32_16x16x32_bf16 a[96:99], v[128:131], v[24:27], a[96:99]
    buffer_load_dwordx4 v[20:23], v205, s[8:11], s35 offen offset:0
    v_mfma_f32_16x16x32_bf16 a[100:103], v[132:135], v[24:27], a[100:103]
    v_mfma_f32_16x16x32_bf16 a[104:107], v[136:139], v[24:27], a[104:107]
    v_mfma_f32_16x16x32_bf16 a[108:111], v[140:143], v[24:27], a[108:111]
    v_mfma_f32_16x16x32_bf16 a[112:115], v[128:131], v[28:31], a[112:115]
    buffer_load_dwordx4 v[24:27], v206, s[8:11], s35 offen offset:0
    v_mfma_f32_16x16x32_bf16 a[116:119], v[132:135], v[28:31], a[116:119]
    v_mfma_f32_16x16x32_bf16 a[120:123], v[136:139], v[28:31], a[120:123]
    v_mfma_f32_16x16x32_bf16 a[124:127], v[140:143], v[28:31], a[124:127]
    buffer_load_dwordx4 v[28:31], v207, s[8:11], s35 offen offset:0
    s_waitcnt vmcnt(32) lgkmcnt(0)
    v_mfma_f32_16x16x32_bf16 a[0:3], v[144:147], v[32:35], a[0:3]
    s_add_u32 m0, s37, 4096
    s_add_u32 s32, s36, 65536
    buffer_load_dwordx4 v208, s[12:15], s32 offen lds
    v_mfma_f32_16x16x32_bf16 a[4:7], v[148:151], v[32:35], a[4:7]
    s_add_u32 m0, s37, 5120
    s_add_u32 s32, s36, 81920
    buffer_load_dwordx4 v208, s[12:15], s32 offen lds
    v_mfma_f32_16x16x32_bf16 a[8:11], v[152:155], v[32:35], a[8:11]
    s_add_u32 m0, s37, 6144
    s_add_u32 s32, s36, 98304
    buffer_load_dwordx4 v208, s[12:15], s32 offen lds
    v_mfma_f32_16x16x32_bf16 a[12:15], v[156:159], v[32:35], a[12:15]
    s_add_u32 m0, s37, 7168
    s_add_u32 s32, s36, 114688
    buffer_load_dwordx4 v208, s[12:15], s32 offen lds
    v_mfma_f32_16x16x32_bf16 a[16:19], v[144:147], v[36:39], a[16:19]
    ds_read_b64_tr_b16 v[128:129], v209 offset:8192
    buffer_load_dwordx4 v[32:35], v200, s[8:11], s35 offen offset:1024
    v_mfma_f32_16x16x32_bf16 a[20:23], v[148:151], v[36:39], a[20:23]
    ds_read_b64_tr_b16 v[130:131], v209 offset:9216
    v_mfma_f32_16x16x32_bf16 a[24:27], v[152:155], v[36:39], a[24:27]
    ds_read_b64_tr_b16 v[132:133], v210 offset:8192
    v_mfma_f32_16x16x32_bf16 a[28:31], v[156:159], v[36:39], a[28:31]
    ds_read_b64_tr_b16 v[134:135], v210 offset:9216
    v_mfma_f32_16x16x32_bf16 a[32:35], v[144:147], v[40:43], a[32:35]
    ds_read_b64_tr_b16 v[136:137], v211 offset:8192
    buffer_load_dwordx4 v[36:39], v201, s[8:11], s35 offen offset:1024
    v_mfma_f32_16x16x32_bf16 a[36:39], v[148:151], v[40:43], a[36:39]
    ds_read_b64_tr_b16 v[138:139], v211 offset:9216
    v_mfma_f32_16x16x32_bf16 a[40:43], v[152:155], v[40:43], a[40:43]
    ds_read_b64_tr_b16 v[140:141], v212 offset:8192
    v_mfma_f32_16x16x32_bf16 a[44:47], v[156:159], v[40:43], a[44:47]
    ds_read_b64_tr_b16 v[142:143], v212 offset:9216
    v_mfma_f32_16x16x32_bf16 a[48:51], v[144:147], v[44:47], a[48:51]
    buffer_load_dwordx4 v[40:43], v202, s[8:11], s35 offen offset:1024
    v_mfma_f32_16x16x32_bf16 a[52:55], v[148:151], v[44:47], a[52:55]
    v_mfma_f32_16x16x32_bf16 a[56:59], v[152:155], v[44:47], a[56:59]
    v_mfma_f32_16x16x32_bf16 a[60:63], v[156:159], v[44:47], a[60:63]
    v_mfma_f32_16x16x32_bf16 a[64:67], v[144:147], v[48:51], a[64:67]
    buffer_load_dwordx4 v[44:47], v203, s[8:11], s35 offen offset:1024
    v_mfma_f32_16x16x32_bf16 a[68:71], v[148:151], v[48:51], a[68:71]
    v_mfma_f32_16x16x32_bf16 a[72:75], v[152:155], v[48:51], a[72:75]
    v_mfma_f32_16x16x32_bf16 a[76:79], v[156:159], v[48:51], a[76:79]
    v_mfma_f32_16x16x32_bf16 a[80:83], v[144:147], v[52:55], a[80:83]
    buffer_load_dwordx4 v[48:51], v204, s[8:11], s35 offen offset:1024
    v_mfma_f32_16x16x32_bf16 a[84:87], v[148:151], v[52:55], a[84:87]
    v_mfma_f32_16x16x32_bf16 a[88:91], v[152:155], v[52:55], a[88:91]
    v_mfma_f32_16x16x32_bf16 a[92:95], v[156:159], v[52:55], a[92:95]
    v_mfma_f32_16x16x32_bf16 a[96:99], v[144:147], v[56:59], a[96:99]
    buffer_load_dwordx4 v[52:55], v205, s[8:11], s35 offen offset:1024
    v_mfma_f32_16x16x32_bf16 a[100:103], v[148:151], v[56:59], a[100:103]
    v_mfma_f32_16x16x32_bf16 a[104:107], v[152:155], v[56:59], a[104:107]
    v_mfma_f32_16x16x32_bf16 a[108:111], v[156:159], v[56:59], a[108:111]
    v_mfma_f32_16x16x32_bf16 a[112:115], v[144:147], v[60:63], a[112:115]
    buffer_load_dwordx4 v[56:59], v206, s[8:11], s35 offen offset:1024
    v_mfma_f32_16x16x32_bf16 a[116:119], v[148:151], v[60:63], a[116:119]
    v_mfma_f32_16x16x32_bf16 a[120:123], v[152:155], v[60:63], a[120:123]
    v_mfma_f32_16x16x32_bf16 a[124:127], v[156:159], v[60:63], a[124:127]
    buffer_load_dwordx4 v[60:63], v207, s[8:11], s35 offen offset:1024
    s_waitcnt vmcnt(32) lgkmcnt(0)
    v_mfma_f32_16x16x32_bf16 a[0:3], v[128:131], v[64:67], a[0:3]
    s_add_u32 m0, s37, 8192
    s_add_u32 s32, s36, 131072
    buffer_load_dwordx4 v208, s[12:15], s32 offen lds
    v_mfma_f32_16x16x32_bf16 a[4:7], v[132:135], v[64:67], a[4:7]
    s_add_u32 m0, s37, 9216
    s_add_u32 s32, s36, 147456
    buffer_load_dwordx4 v208, s[12:15], s32 offen lds
    v_mfma_f32_16x16x32_bf16 a[8:11], v[136:139], v[64:67], a[8:11]
    s_add_u32 m0, s37, 10240
    s_add_u32 s32, s36, 163840
    buffer_load_dwordx4 v208, s[12:15], s32 offen lds
    v_mfma_f32_16x16x32_bf16 a[12:15], v[140:143], v[64:67], a[12:15]
    s_add_u32 m0, s37, 11264
    s_add_u32 s32, s36, 180224
    buffer_load_dwordx4 v208, s[12:15], s32 offen lds
    v_mfma_f32_16x16x32_bf16 a[16:19], v[128:131], v[68:71], a[16:19]
    ds_read_b64_tr_b16 v[144:145], v209 offset:12288
    buffer_load_dwordx4 v[64:67], v200, s[8:11], s35 offen offset:2048
    v_mfma_f32_16x16x32_bf16 a[20:23], v[132:135], v[68:71], a[20:23]
    ds_read_b64_tr_b16 v[146:147], v209 offset:13312
    v_mfma_f32_16x16x32_bf16 a[24:27], v[136:139], v[68:71], a[24:27]
    ds_read_b64_tr_b16 v[148:149], v210 offset:12288
    v_mfma_f32_16x16x32_bf16 a[28:31], v[140:143], v[68:71], a[28:31]
    ds_read_b64_tr_b16 v[150:151], v210 offset:13312
    v_mfma_f32_16x16x32_bf16 a[32:35], v[128:131], v[72:75], a[32:35]
    ds_read_b64_tr_b16 v[152:153], v211 offset:12288
    buffer_load_dwordx4 v[68:71], v201, s[8:11], s35 offen offset:2048
    v_mfma_f32_16x16x32_bf16 a[36:39], v[132:135], v[72:75], a[36:39]
    ds_read_b64_tr_b16 v[154:155], v211 offset:13312
    v_mfma_f32_16x16x32_bf16 a[40:43], v[136:139], v[72:75], a[40:43]
    ds_read_b64_tr_b16 v[156:157], v212 offset:12288
    v_mfma_f32_16x16x32_bf16 a[44:47], v[140:143], v[72:75], a[44:47]
    ds_read_b64_tr_b16 v[158:159], v212 offset:13312
    v_mfma_f32_16x16x32_bf16 a[48:51], v[128:131], v[76:79], a[48:51]
    buffer_load_dwordx4 v[72:75], v202, s[8:11], s35 offen offset:2048
    v_mfma_f32_16x16x32_bf16 a[52:55], v[132:135], v[76:79], a[52:55]
    v_mfma_f32_16x16x32_bf16 a[56:59], v[136:139], v[76:79], a[56:59]
    v_mfma_f32_16x16x32_bf16 a[60:63], v[140:143], v[76:79], a[60:63]
    v_mfma_f32_16x16x32_bf16 a[64:67], v[128:131], v[80:83], a[64:67]
    buffer_load_dwordx4 v[76:79], v203, s[8:11], s35 offen offset:2048
    v_mfma_f32_16x16x32_bf16 a[68:71], v[132:135], v[80:83], a[68:71]
    v_mfma_f32_16x16x32_bf16 a[72:75], v[136:139], v[80:83], a[72:75]
    v_mfma_f32_16x16x32_bf16 a[76:79], v[140:143], v[80:83], a[76:79]
    v_mfma_f32_16x16x32_bf16 a[80:83], v[128:131], v[84:87], a[80:83]
    buffer_load_dwordx4 v[80:83], v204, s[8:11], s35 offen offset:2048
    v_mfma_f32_16x16x32_bf16 a[84:87], v[132:135], v[84:87], a[84:87]
    v_mfma_f32_16x16x32_bf16 a[88:91], v[136:139], v[84:87], a[88:91]
    v_mfma_f32_16x16x32_bf16 a[92:95], v[140:143], v[84:87], a[92:95]
    v_mfma_f32_16x16x32_bf16 a[96:99], v[128:131], v[88:91], a[96:99]
    buffer_load_dwordx4 v[84:87], v205, s[8:11], s35 offen offset:2048
    v_mfma_f32_16x16x32_bf16 a[100:103], v[132:135], v[88:91], a[100:103]
    v_mfma_f32_16x16x32_bf16 a[104:107], v[136:139], v[88:91], a[104:107]
    v_mfma_f32_16x16x32_bf16 a[108:111], v[140:143], v[88:91], a[108:111]
    v_mfma_f32_16x16x32_bf16 a[112:115], v[128:131], v[92:95], a[112:115]
    buffer_load_dwordx4 v[88:91], v206, s[8:11], s35 offen offset:2048
    v_mfma_f32_16x16x32_bf16 a[116:119], v[132:135], v[92:95], a[116:119]
    v_mfma_f32_16x16x32_bf16 a[120:123], v[136:139], v[92:95], a[120:123]
    v_mfma_f32_16x16x32_bf16 a[124:127], v[140:143], v[92:95], a[124:127]
    buffer_load_dwordx4 v[92:95], v207, s[8:11], s35 offen offset:2048
    s_waitcnt vmcnt(32) lgkmcnt(0)
    v_mfma_f32_16x16x32_bf16 a[0:3], v[144:147], v[96:99], a[0:3]
    s_add_u32 m0, s37, 12288
    s_add_u32 s32, s36, 196608
    buffer_load_dwordx4 v208, s[12:15], s32 offen lds
    v_mfma_f32_16x16x32_bf16 a[4:7], v[148:151], v[96:99], a[4:7]
    s_add_u32 m0, s37, 13312
    s_add_u32 s32, s36, 212992
    buffer_load_dwordx4 v208, s[12:15], s32 offen lds
    v_mfma_f32_16x16x32_bf16 a[8:11], v[152:155], v[96:99], a[8:11]
    s_add_u32 m0, s37, 14336
    s_add_u32 s32, s36, 229376
    buffer_load_dwordx4 v208, s[12:15], s32 offen lds
    v_mfma_f32_16x16x32_bf16 a[12:15], v[156:159], v[96:99], a[12:15]
    s_add_u32 m0, s37, 15360
    s_add_u32 s32, s36, 245760
    buffer_load_dwordx4 v208, s[12:15], s32 offen lds
    v_mfma_f32_16x16x32_bf16 a[16:19], v[144:147], v[100:103], a[16:19]
    ds_read_b64_tr_b16 v[128:129], v209 offset:0
    buffer_load_dwordx4 v[96:99], v200, s[8:11], s35 offen offset:3072
    v_mfma_f32_16x16x32_bf16 a[20:23], v[148:151], v[100:103], a[20:23]
    ds_read_b64_tr_b16 v[130:131], v209 offset:1024
    v_mfma_f32_16x16x32_bf16 a[24:27], v[152:155], v[100:103], a[24:27]
    ds_read_b64_tr_b16 v[132:133], v210 offset:0
    v_mfma_f32_16x16x32_bf16 a[28:31], v[156:159], v[100:103], a[28:31]
    ds_read_b64_tr_b16 v[134:135], v210 offset:1024
    v_mfma_f32_16x16x32_bf16 a[32:35], v[144:147], v[104:107], a[32:35]
    ds_read_b64_tr_b16 v[136:137], v211 offset:0
    buffer_load_dwordx4 v[100:103], v201, s[8:11], s35 offen offset:3072
    v_mfma_f32_16x16x32_bf16 a[36:39], v[148:151], v[104:107], a[36:39]
    ds_read_b64_tr_b16 v[138:139], v211 offset:1024
    v_mfma_f32_16x16x32_bf16 a[40:43], v[152:155], v[104:107], a[40:43]
    ds_read_b64_tr_b16 v[140:141], v212 offset:0
    v_mfma_f32_16x16x32_bf16 a[44:47], v[156:159], v[104:107], a[44:47]
    ds_read_b64_tr_b16 v[142:143], v212 offset:1024
    v_mfma_f32_16x16x32_bf16 a[48:51], v[144:147], v[108:111], a[48:51]
    buffer_load_dwordx4 v[104:107], v202, s[8:11], s35 offen offset:3072
    v_mfma_f32_16x16x32_bf16 a[52:55], v[148:151], v[108:111], a[52:55]
    v_mfma_f32_16x16x32_bf16 a[56:59], v[152:155], v[108:111], a[56:59]
    v_mfma_f32_16x16x32_bf16 a[60:63], v[156:159], v[108:111], a[60:63]
    v_mfma_f32_16x16x32_bf16 a[64:67], v[144:147], v[112:115], a[64:67]
    buffer_load_dwordx4 v[108:111], v203, s[8:11], s35 offen offset:3072
    v_mfma_f32_16x16x32_bf16 a[68:71], v[148:151], v[112:115], a[68:71]
    v_mfma_f32_16x16x32_bf16 a[72:75], v[152:155], v[112:115], a[72:75]
    v_mfma_f32_16x16x32_bf16 a[76:79], v[156:159], v[112:115], a[76:79]
    v_mfma_f32_16x16x32_bf16 a[80:83], v[144:147], v[116:119], a[80:83]
    buffer_load_dwordx4 v[112:115], v204, s[8:11], s35 offen offset:3072
    v_mfma_f32_16x16x32_bf16 a[84:87], v[148:151], v[116:119], a[84:87]
    v_mfma_f32_16x16x32_bf16 a[88:91], v[152:155], v[116:119], a[88:91]
    v_mfma_f32_16x16x32_bf16 a[92:95], v[156:159], v[116:119], a[92:95]
    v_mfma_f32_16x16x32_bf16 a[96:99], v[144:147], v[120:123], a[96:99]
    buffer_load_dwordx4 v[116:119], v205, s[8:11], s35 offen offset:3072
    v_mfma_f32_16x16x32_bf16 a[100:103], v[148:151], v[120:123], a[100:103]
    v_mfma_f32_16x16x32_bf16 a[104:107], v[152:155], v[120:123], a[104:107]
    v_mfma_f32_16x16x32_bf16 a[108:111], v[156:159], v[120:123], a[108:111]
    v_mfma_f32_16x16x32_bf16 a[112:115], v[144:147], v[124:127], a[112:115]
    buffer_load_dwordx4 v[120:123], v206, s[8:11], s35 offen offset:3072
    v_mfma_f32_16x16x32_bf16 a[116:119], v[148:151], v[124:127], a[116:119]
    v_mfma_f32_16x16x32_bf16 a[120:123], v[152:155], v[124:127], a[120:123]
    v_mfma_f32_16x16x32_bf16 a[124:127], v[156:159], v[124:127], a[124:127]
    buffer_load_dwordx4 v[124:127], v207, s[8:11], s35 offen offset:3072
    s_add_u32 s35, s35, 4096
    s_add_u32 s36, s36, 262144
    s_cmp_eq_u32 s34, 2
    s_cselect_b32 s35, 0x40000000, s35
    s_cselect_b32 s36, 0x40000000, s36
    s_sub_u32 s34, s34, 1
    s_cmp_lg_u32 s34, 0
    s_cbranch_scc1 k3_loop
    s_waitcnt vmcnt(0) lgkmcnt(0)
    s_barrier
    s_nop 4
    ds_write_b128 v217, a[32:35] offset:0
    ds_write_b128 v217, a[36:39] offset:1024
    ds_write_b128 v217, a[40:43] offset:2048
    ds_write_b128 v217, a[44:47] offset:3072
    ds_write_b128 v217, a[48:51] offset:4096
    ds_write_b128 v217, a[52:55] offset:5120
    ds_write_b128 v217, a[56:59] offset:6144
    ds_write_b128 v217, a[60:63] offset:7168
    ds_write_b128 v218, a[64:67] offset:0
    ds_write_b128 v218, a[68:71] offset:1024
    ds_write_b128 v218, a[72:75] offset:2048
    ds_write_b128 v218, a[76:79] offset:3072
    ds_write_b128 v218, a[80:83] offset:4096
    ds_write_b128 v218, a[84:87] offset:5120
    ds_write_b128 v218, a[88:91] offset:6144
    ds_write_b128 v218, a[92:95] offset:7168
    ds_write_b128 v219, a[96:99] offset:0
    ds_write_b128 v219, a[100:103] offset:1024
    ds_write_b128 v219, a[104:107] offset:2048
    ds_write_b128 v219, a[108:111] offset:3072
    ds_write_b128 v219, a[112:115] offset:4096
    ds_write_b128 v219, a[116:119] offset:5120
    ds_write_b128 v219, a[120:123] offset:6144
    ds_write_b128 v219, a[124:127] offset:7168
    v_accvgpr_read_b32 v96, a0
    v_accvgpr_read_b32 v97, a1
    v_accvgpr_read_b32 v98, a2
    v_accvgpr_read_b32 v99, a3
    v_accvgpr_read_b32 v100, a4
    v_accvgpr_read_b32 v101, a5
    v_accvgpr_read_b32 v102, a6
    v_accvgpr_read_b32 v103, a7
    v_accvgpr_read_b32 v104, a8
    v_accvgpr_read_b32 v105, a9
    v_accvgpr_read_b32 v106, a10
    v_accvgpr_read_b32 v107, a11
    v_accvgpr_read_b32 v108, a12
    v_accvgpr_read_b32 v109, a13
    v_accvgpr_read_b32 v110, a14
    v_accvgpr_read_b32 v111, a15
    v_accvgpr_read_b32 v112, a16
    v_accvgpr_read_b32 v113, a17
    v_accvgpr_read_b32 v114, a18
    v_accvgpr_read_b32 v115, a19
    v_accvgpr_read_b32 v116, a20
    v_accvgpr_read_b32 v117, a21
    v_accvgpr_read_b32 v118, a22
    v_accvgpr_read_b32 v119, a23
    v_accvgpr_read_b32 v120, a24
    v_accvgpr_read_b32 v121, a25
    v_accvgpr_read_b32 v122, a26
    v_accvgpr_read_b32 v123, a27
    v_accvgpr_read_b32 v124, a28
    v_accvgpr_read_b32 v125, a29
    v_accvgpr_read_b32 v126, a30
    v_accvgpr_read_b32 v127, a31
    v_lshlrev_b32 v128, 16, v160
    v_and_b32 v129, 0xffff0000, v160
    v_lshlrev_b32 v130, 16, v161
    v_and_b32 v131, 0xffff0000, v161
    v_lshlrev_b32 v132, 16, v162
    v_and_b32 v133, 0xffff0000, v162
    v_lshlrev_b32 v134, 16, v163
    v_and_b32 v135, 0xffff0000, v163
    v_lshlrev_b32 v136, 16, v164
    v_and_b32 v137, 0xffff0000, v164
    v_lshlrev_b32 v138, 16, v165
    v_and_b32 v139, 0xffff0000, v165
    v_lshlrev_b32 v140, 16, v166
    v_and_b32 v141, 0xffff0000, v166
    v_lshlrev_b32 v142, 16, v167
    v_and_b32 v143, 0xffff0000, v167
    v_lshlrev_b32 v144, 16, v168
    v_and_b32 v145, 0xffff0000, v168
    v_lshlrev_b32 v146, 16, v169
    v_and_b32 v147, 0xffff0000, v169
    v_lshlrev_b32 v148, 16, v170
    v_and_b32 v149, 0xffff0000, v170
    v_lshlrev_b32 v150, 16, v171
    v_and_b32 v151, 0xffff0000, v171
    v_lshlrev_b32 v152, 16, v172
    v_and_b32 v153, 0xffff0000, v172
    v_lshlrev_b32 v154, 16, v173
    v_and_b32 v155, 0xffff0000, v173
    v_lshlrev_b32 v156, 16, v174
    v_and_b32 v157, 0xffff0000, v174
    v_lshlrev_b32 v158, 16, v175
    v_and_b32 v159, 0xffff0000, v175
    v_lshlrev_b32 v184, 16, v176
    v_and_b32 v185, 0xffff0000, v176
    v_lshlrev_b32 v186, 16, v177
    v_and_b32 v187, 0xffff0000, v177
    v_lshlrev_b32 v188, 16, v178
    v_and_b32 v189, 0xffff0000, v178
    v_lshlrev_b32 v190, 16, v179
    v_and_b32 v191, 0xffff0000, v179
    v_lshlrev_b32 v192, 16, v180
    v_and_b32 v193, 0xffff0000, v180
    v_lshlrev_b32 v194, 16, v181
    v_and_b32 v195, 0xffff0000, v181
    v_lshlrev_b32 v196, 16, v182
    v_and_b32 v197, 0xffff0000, v182
    v_lshlrev_b32 v198, 16, v183
    v_and_b32 v199, 0xffff0000, v183
    s_waitcnt lgkmcnt(0)
    s_barrier
    ds_read_b128 v[0:3], v220 offset:0
    ds_read_b128 v[4:7], v220 offset:1024
    ds_read_b128 v[8:11], v220 offset:2048
    ds_read_b128 v[12:15], v220 offset:3072
    ds_read_b128 v[16:19], v220 offset:4096
    ds_read_b128 v[20:23], v220 offset:5120
    ds_read_b128 v[24:27], v220 offset:6144
    ds_read_b128 v[28:31], v220 offset:7168
    ds_read_b128 v[32:35], v220 offset:8192
    ds_read_b128 v[36:39], v220 offset:9216
    ds_read_b128 v[40:43], v220 offset:10240
    ds_read_b128 v[44:47], v220 offset:11264
    ds_read_b128 v[48:51], v220 offset:12288
    s_waitcnt lgkmcnt(12)
    v_add_f32 v96, v96, v0
    v_add_f32 v97, v97, v1
    v_add_f32 v98, v98, v2
    v_add_f32 v99, v99, v3
    ds_read_b128 v[52:55], v220 offset:13312
    s_waitcnt lgkmcnt(12)
    v_add_f32 v100, v100, v4
    v_add_f32 v101, v101, v5
    v_add_f32 v102, v102, v6
    v_add_f32 v103, v103, v7
    ds_read_b128 v[56:59], v220 offset:14336
    s_waitcnt lgkmcnt(12)
    v_add_f32 v104, v104, v8
    v_add_f32 v105, v105, v9
    v_add_f32 v106, v106, v10
    v_add_f32 v107, v107, v11
    ds_read_b128 v[60:63], v220 offset:15360
    s_waitcnt lgkmcnt(12)
    v_add_f32 v108, v108, v12
    v_add_f32 v109, v109, v13
    v_add_f32 v110, v110, v14
    v_add_f32 v111, v111, v15
    ds_read_b128 v[64:67], v220 offset:16384
    s_waitcnt lgkmcnt(12)
    v_add_f32 v112, v112, v16
    v_add_f32 v113, v113, v17
    v_add_f32 v114, v114, v18
    v_add_f32 v115, v115, v19
    ds_read_b128 v[68:71], v220 offset:17408
    s_waitcnt lgkmcnt(12)
    v_add_f32 v116, v116, v20
    v_add_f32 v117, v117, v21
    v_add_f32 v118, v118, v22
    v_add_f32 v119, v119, v23
    ds_read_b128 v[72:75], v220 offset:18432
    s_waitcnt lgkmcnt(12)
    v_add_f32 v120, v120, v24
    v_add_f32 v121, v121, v25
    v_add_f32 v122, v122, v26
    v_add_f32 v123, v123, v27
    ds_read_b128 v[76:79], v220 offset:19456
    s_waitcnt lgkmcnt(12)
    v_add_f32 v124, v124, v28
    v_add_f32 v125, v125, v29
    v_add_f32 v126, v126, v30
    v_add_f32 v127, v127, v31
    ds_read_b128 v[80:83], v220 offset:20480
    s_waitcnt lgkmcnt(12)
    v_add_f32 v96, v96, v32
    v_add_f32 v97, v97, v33
    v_add_f32 v98, v98, v34
    v_add_f32 v99, v99, v35
    ds_read_b128 v[84:87], v220 offset:21504
    s_waitcnt lgkmcnt(12)
    v_add_f32 v100, v100, v36
    v_add_f32 v101, v101, v37
    v_add_f32 v102, v102, v38
    v_add_f32 v103, v103, v39
    ds_read_b128 v[88:91], v220 offset:22528
    s_waitcnt lgkmcnt(12)
    v_add_f32 v104, v104, v40
    v_add_f32 v105, v105, v41
    v_add_f32 v106, v106, v42
    v_add_f32 v107, v107, v43
    ds_read_b128 v[92:95], v220 offset:23552
    s_waitcnt lgkmcnt(12)
    v_add_f32 v108, v108, v44
    v_add_f32 v109, v109, v45
    v_add_f32 v110, v110, v46
    v_add_f32 v111, v111, v47
    s_waitcnt lgkmcnt(11)
    v_add_f32 v112, v112, v48
    v_add_f32 v113, v113, v49
    v_add_f32 v114, v114, v50
    v_add_f32 v115, v115, v51
    s_waitcnt lgkmcnt(10)
    v_add_f32 v116, v116, v52
    v_add_f32 v117, v117, v53
    v_add_f32 v118, v118, v54
    v_add_f32 v119, v119, v55
    s_waitcnt lgkmcnt(9)
    v_add_f32 v120, v120, v56
    v_add_f32 v121, v121, v57
    v_add_f32 v122, v122, v58
    v_add_f32 v123, v123, v59
    s_waitcnt lgkmcnt(8)
    v_add_f32 v124, v124, v60
    v_add_f32 v125, v125, v61
    v_add_f32 v126, v126, v62
    v_add_f32 v127, v127, v63
    s_waitcnt lgkmcnt(7)
    v_add_f32 v96, v96, v64
    v_add_f32 v97, v97, v65
    v_add_f32 v98, v98, v66
    v_add_f32 v99, v99, v67
    s_waitcnt lgkmcnt(6)
    v_add_f32 v100, v100, v68
    v_add_f32 v101, v101, v69
    v_add_f32 v102, v102, v70
    v_add_f32 v103, v103, v71
    s_waitcnt lgkmcnt(5)
    v_add_f32 v104, v104, v72
    v_add_f32 v105, v105, v73
    v_add_f32 v106, v106, v74
    v_add_f32 v107, v107, v75
    s_waitcnt lgkmcnt(4)
    v_add_f32 v108, v108, v76
    v_add_f32 v109, v109, v77
    v_add_f32 v110, v110, v78
    v_add_f32 v111, v111, v79
    s_waitcnt lgkmcnt(3)
    v_add_f32 v112, v112, v80
    v_add_f32 v113, v113, v81
    v_add_f32 v114, v114, v82
    v_add_f32 v115, v115, v83
    s_waitcnt lgkmcnt(2)
    v_add_f32 v116, v116, v84
    v_add_f32 v117, v117, v85
    v_add_f32 v118, v118, v86
    v_add_f32 v119, v119, v87
    s_waitcnt lgkmcnt(1)
    v_add_f32 v120, v120, v88
    v_add_f32 v121, v121, v89
    v_add_f32 v122, v122, v90
    v_add_f32 v123, v123, v91
    s_waitcnt lgkmcnt(0)
    v_add_f32 v124, v124, v92
    v_add_f32 v125, v125, v93
    v_add_f32 v126, v126, v94
    v_add_f32 v127, v127, v95
    v_cvt_pk_bf16_f32 v97, v96, v97
    v_lshlrev_b32 v96, 16, v97
    v_and_b32 v97, 0xffff0000, v97
    v_add_f32 v96, v96, v128
    v_add_f32 v97, v97, v129
    v_cvt_pk_bf16_f32 v0, v96, v97
    v_lshlrev_b32 v96, 16, v0
    v_and_b32 v97, 0xffff0000, v0
    v_add_f32 v32, v96, v97
    v_mul_f32 v33, v96, v96
    v_mul_f32 v34, v96, v184
    v_fmac_f32 v33, v97, v97
    v_fmac_f32 v34, v97, v185
    v_cvt_pk_bf16_f32 v99, v98, v99
    v_lshlrev_b32 v98, 16, v99
    v_and_b32 v99, 0xffff0000, v99
    v_add_f32 v98, v98, v130
    v_add_f32 v99, v99, v131
    v_cvt_pk_bf16_f32 v1, v98, v99
    v_lshlrev_b32 v98, 16, v1
    v_and_b32 v99, 0xffff0000, v1
    v_add_f32 v32, v32, v98
    v_add_f32 v32, v32, v99
    v_fmac_f32 v33, v98, v98
    v_fmac_f32 v34, v98, v186
    v_fmac_f32 v33, v99, v99
    v_fmac_f32 v34, v99, v187
    buffer_store_dwordx2 v[0:1], v214, s[20:23], 0 offen offset:0
    v_cvt_pk_bf16_f32 v101, v100, v101
    v_lshlrev_b32 v100, 16, v101
    v_and_b32 v101, 0xffff0000, v101
    v_add_f32 v100, v100, v132
    v_add_f32 v101, v101, v133
    v_cvt_pk_bf16_f32 v2, v100, v101
    v_lshlrev_b32 v100, 16, v2
    v_and_b32 v101, 0xffff0000, v2
    v_add_f32 v32, v32, v100
    v_add_f32 v32, v32, v101
    v_fmac_f32 v33, v100, v100
    v_fmac_f32 v34, v100, v188
    v_fmac_f32 v33, v101, v101
    v_fmac_f32 v34, v101, v189
    v_cvt_pk_bf16_f32 v103, v102, v103
    v_lshlrev_b32 v102, 16, v103
    v_and_b32 v103, 0xffff0000, v103
    v_add_f32 v102, v102, v134
    v_add_f32 v103, v103, v135
    v_cvt_pk_bf16_f32 v3, v102, v103
    v_lshlrev_b32 v102, 16, v3
    v_and_b32 v103, 0xffff0000, v3
    v_add_f32 v32, v32, v102
    v_add_f32 v32, v32, v103
    v_fmac_f32 v33, v102, v102
    v_fmac_f32 v34, v102, v190
    v_fmac_f32 v33, v103, v103
    v_fmac_f32 v34, v103, v191
    buffer_store_dwordx2 v[2:3], v214, s[20:23], 0 offen offset:32
    v_cvt_pk_bf16_f32 v105, v104, v105
    v_lshlrev_b32 v104, 16, v105
    v_and_b32 v105, 0xffff0000, v105
    v_add_f32 v104, v104, v136
    v_add_f32 v105, v105, v137
    v_cvt_pk_bf16_f32 v4, v104, v105
    v_lshlrev_b32 v104, 16, v4
    v_and_b32 v105, 0xffff0000, v4
    v_add_f32 v32, v32, v104
    v_add_f32 v32, v32, v105
    v_fmac_f32 v33, v104, v104
    v_fmac_f32 v34, v104, v192
    v_fmac_f32 v33, v105, v105
    v_fmac_f32 v34, v105, v193
    v_cvt_pk_bf16_f32 v107, v106, v107
    v_lshlrev_b32 v106, 16, v107
    v_and_b32 v107, 0xffff0000, v107
    v_add_f32 v106, v106, v138
    v_add_f32 v107, v107, v139
    v_cvt_pk_bf16_f32 v5, v106, v107
    v_lshlrev_b32 v106, 16, v5
    v_and_b32 v107, 0xffff0000, v5
    v_add_f32 v32, v32, v106
    v_add_f32 v32, v32, v107
    v_fmac_f32 v33, v106, v106
    v_fmac_f32 v34, v106, v194
    v_fmac_f32 v33, v107, v107
    v_fmac_f32 v34, v107, v195
    buffer_store_dwordx2 v[4:5], v214, s[20:23], 0 offen offset:64
    v_cvt_pk_bf16_f32 v109, v108, v109
    v_lshlrev_b32 v108, 16, v109
    v_and_b32 v109, 0xffff0000, v109
    v_add_f32 v108, v108, v140
    v_add_f32 v109, v109, v141
    v_cvt_pk_bf16_f32 v6, v108, v109
    v_lshlrev_b32 v108, 16, v6
    v_and_b32 v109, 0xffff0000, v6
    v_add_f32 v32, v32, v108
    v_add_f32 v32, v32, v109
    v_fmac_f32 v33, v108, v108
    v_fmac_f32 v34, v108, v196
    v_fmac_f32 v33, v109, v109
    v_fmac_f32 v34, v109, v197
    v_cvt_pk_bf16_f32 v111, v110, v111
    v_lshlrev_b32 v110, 16, v111
    v_and_b32 v111, 0xffff0000, v111
    v_add_f32 v110, v110, v142
    v_add_f32 v111, v111, v143
    v_cvt_pk_bf16_f32 v7, v110, v111
    v_lshlrev_b32 v110, 16, v7
    v_and_b32 v111, 0xffff0000, v7
    v_add_f32 v32, v32, v110
    v_add_f32 v32, v32, v111
    v_fmac_f32 v33, v110, v110
    v_fmac_f32 v34, v110, v198
    v_fmac_f32 v33, v111, v111
    v_fmac_f32 v34, v111, v199
    buffer_store_dwordx2 v[6:7], v214, s[20:23], 0 offen offset:96
    v_cvt_pk_bf16_f32 v113, v112, v113
    v_lshlrev_b32 v112, 16, v113
    v_and_b32 v113, 0xffff0000, v113
    v_add_f32 v112, v112, v144
    v_add_f32 v113, v113, v145
    v_cvt_pk_bf16_f32 v8, v112, v113
    v_lshlrev_b32 v112, 16, v8
    v_and_b32 v113, 0xffff0000, v8
    v_add_f32 v35, v112, v113
    v_mul_f32 v36, v112, v112
    v_mul_f32 v37, v112, v184
    v_fmac_f32 v36, v113, v113
    v_fmac_f32 v37, v113, v185
    v_cvt_pk_bf16_f32 v115, v114, v115
    v_lshlrev_b32 v114, 16, v115
    v_and_b32 v115, 0xffff0000, v115
    v_add_f32 v114, v114, v146
    v_add_f32 v115, v115, v147
    v_cvt_pk_bf16_f32 v9, v114, v115
    v_lshlrev_b32 v114, 16, v9
    v_and_b32 v115, 0xffff0000, v9
    v_add_f32 v35, v35, v114
    v_add_f32 v35, v35, v115
    v_fmac_f32 v36, v114, v114
    v_fmac_f32 v37, v114, v186
    v_fmac_f32 v36, v115, v115
    v_fmac_f32 v37, v115, v187
    buffer_store_dwordx2 v[8:9], v214, s[20:23], s38 offen offset:0
    v_cvt_pk_bf16_f32 v117, v116, v117
    v_lshlrev_b32 v116, 16, v117
    v_and_b32 v117, 0xffff0000, v117
    v_add_f32 v116, v116, v148
    v_add_f32 v117, v117, v149
    v_cvt_pk_bf16_f32 v10, v116, v117
    v_lshlrev_b32 v116, 16, v10
    v_and_b32 v117, 0xffff0000, v10
    v_add_f32 v35, v35, v116
    v_add_f32 v35, v35, v117
    v_fmac_f32 v36, v116, v116
    v_fmac_f32 v37, v116, v188
    v_fmac_f32 v36, v117, v117
    v_fmac_f32 v37, v117, v189
    v_cvt_pk_bf16_f32 v119, v118, v119
    v_lshlrev_b32 v118, 16, v119
    v_and_b32 v119, 0xffff0000, v119
    v_add_f32 v118, v118, v150
    v_add_f32 v119, v119, v151
    v_cvt_pk_bf16_f32 v11, v118, v119
    v_lshlrev_b32 v118, 16, v11
    v_and_b32 v119, 0xffff0000, v11
    v_add_f32 v35, v35, v118
    v_add_f32 v35, v35, v119
    v_fmac_f32 v36, v118, v118
    v_fmac_f32 v37, v118, v190
    v_fmac_f32 v36, v119, v119
    v_fmac_f32 v37, v119, v191
    buffer_store_dwordx2 v[10:11], v214, s[20:23], s38 offen offset:32
    v_cvt_pk_bf16_f32 v121, v120, v121
    v_lshlrev_b32 v120, 16, v121
    v_and_b32 v121, 0xffff0000, v121
    v_add_f32 v120, v120, v152
    v_add_f32 v121, v121, v153
    v_cvt_pk_bf16_f32 v12, v120, v121
    v_lshlrev_b32 v120, 16, v12
    v_and_b32 v121, 0xffff0000, v12
    v_add_f32 v35, v35, v120
    v_add_f32 v35, v35, v121
    v_fmac_f32 v36, v120, v120
    v_fmac_f32 v37, v120, v192
    v_fmac_f32 v36, v121, v121
    v_fmac_f32 v37, v121, v193
    v_cvt_pk_bf16_f32 v123, v122, v123
    v_lshlrev_b32 v122, 16, v123
    v_and_b32 v123, 0xffff0000, v123
    v_add_f32 v122, v122, v154
    v_add_f32 v123, v123, v155
    v_cvt_pk_bf16_f32 v13, v122, v123
    v_lshlrev_b32 v122, 16, v13
    v_and_b32 v123, 0xffff0000, v13
    v_add_f32 v35, v35, v122
    v_add_f32 v35, v35, v123
    v_fmac_f32 v36, v122, v122
    v_fmac_f32 v37, v122, v194
    v_fmac_f32 v36, v123, v123
    v_fmac_f32 v37, v123, v195
    buffer_store_dwordx2 v[12:13], v214, s[20:23], s38 offen offset:64
    v_cvt_pk_bf16_f32 v125, v124, v125
    v_lshlrev_b32 v124, 16, v125
    v_and_b32 v125, 0xffff0000, v125
    v_add_f32 v124, v124, v156
    v_add_f32 v125, v125, v157
    v_cvt_pk_bf16_f32 v14, v124, v125
    v_lshlrev_b32 v124, 16, v14
    v_and_b32 v125, 0xffff0000, v14
    v_add_f32 v35, v35, v124
    v_add_f32 v35, v35, v125
    v_fmac_f32 v36, v124, v124
    v_fmac_f32 v37, v124, v196
    v_fmac_f32 v36, v125, v125
    v_fmac_f32 v37, v125, v197
    v_cvt_pk_bf16_f32 v127, v126, v127
    v_lshlrev_b32 v126, 16, v127
    v_and_b32 v127, 0xffff0000, v127
    v_add_f32 v126, v126, v158
    v_add_f32 v127, v127, v159
    v_cvt_pk_bf16_f32 v15, v126, v127
    v_lshlrev_b32 v126, 16, v15
    v_and_b32 v127, 0xffff0000, v15
    v_add_f32 v35, v35, v126
    v_add_f32 v35, v35, v127
    v_fmac_f32 v36, v126, v126
    v_fmac_f32 v37, v126, v198
    v_fmac_f32 v36, v127, v127
    v_fmac_f32 v37, v127, v199
    buffer_store_dwordx2 v[14:15], v214, s[20:23], s38 offen offset:96
    v_add_f32 v40, v184, v185
    v_add_f32 v40, v40, v186
    v_add_f32 v40, v40, v187
    v_add_f32 v40, v40, v188
    v_add_f32 v40, v40, v189
    v_add_f32 v40, v40, v190
    v_add_f32 v40, v40, v191
    v_add_f32 v40, v40, v192
    v_add_f32 v40, v40, v193
    v_add_f32 v40, v40, v194
    v_add_f32 v40, v40, v195
    v_add_f32 v40, v40, v196
    v_add_f32 v40, v40, v197
    v_add_f32 v40, v40, v198
    v_add_f32 v40, v40, v199
    v_mov_b32 v41, 0
    s_nop 1
    v_permlane32_swap_b32 v32, v33
    v_permlane32_swap_b32 v35, v36
    v_permlane32_swap_b32 v34, v40
    v_permlane32_swap_b32 v37, v41
    s_nop 0
    v_add_f32 v32, v32, v33
    v_add_f32 v35, v35, v36
    v_add_f32 v34, v34, v40
    v_add_f32 v37, v37, v41
    s_nop 1
    v_permlane16_swap_b32 v32, v35
    v_permlane16_swap_b32 v34, v37
    s_nop 0
    v_add_f32 v32, v32, v35
    v_add_f32 v34, v34, v37
    buffer_atomic_add_f32 v32, v215, s[24:27], 0 offen
    buffer_atomic_add_f32 v34, v216, s[24:27], 0 offen
k3_done:
    s_endpgm

.globl k4_kernel
.p2align 8
.type k4_kernel,@function
k4_kernel:
    s_cmp_ge_u32 s2, 256
    s_cbranch_scc1 k4_done
    s_load_dwordx4 s[44:47], s[0:1], 64
    s_load_dwordx4 s[48:51], s[0:1], 80
    s_load_dwordx2 s[52:53], s[0:1], 104
    v_lshrrev_b32 v1, 6, v0
    v_and_b32 v2, 63, v0
    v_readfirstlane_b32 s3, v1
    s_and_b32 s40, s2, 7
    s_mul_i32 s4, s40, 28
    s_lshr_b32 s5, s2, 3
    s_add_u32 s4, s4, s5
    s_waitcnt lgkmcnt(0)
    s_add_u32 s8, s52, 0x3400000
    s_addc_u32 s9, s53, 0
    s_mov_b32 s10, 0x400000
    s_mov_b32 s11, 0x00020000
    s_add_u32 s12, s52, 0x3800000
    s_addc_u32 s13, s53, 0
    s_mov_b32 s14, 0x6040
    s_mov_b32 s15, 0x00020000
    s_mov_b32 s16, s50
    s_mov_b32 s17, s51
    s_mov_b32 s18, 0x400000
    s_mov_b32 s19, 0x00020000
    s_mov_b32 s20, s44
    s_mov_b32 s21, s45
    s_mov_b32 s22, 0x700000
    s_mov_b32 s23, 0x00020000
    s_mov_b32 s24, s46
    s_mov_b32 s25, s47
    s_mov_b32 s26, 0x700000
    s_mov_b32 s27, 0x00020000
    s_mov_b32 s28, s48
    s_mov_b32 s29, s49
    s_mov_b32 s30, 0x700000
    s_mov_b32 s31, 0x00020000
    s_add_u32 s32, s52, 0x3810000
    s_addc_u32 s33, s53, 0
    s_mov_b32 s34, 0x3000
    s_mov_b32 s35, 0x00020000
    s_add_u32 s36, s52, 0x3900000
    s_addc_u32 s37, s53, 0
    s_mov_b32 s38, 0x1c0000
    s_mov_b32 s39, 0x00020000
    s_lshl_b32 s40, s2, 3
    s_lshl1_add_u32 s40, s3, s40
    v_lshrrev_b32 v3, 5, v2
    v_add_u32 v3, s40, v3
    v_and_b32 v4, 31, v2
    v_lshlrev_b32 v54, 11, v3
    v_lshl_add_u32 v54, v4, 4, v54
    v_lshlrev_b32 v3, 2, v3
    s_mov_b32 s41, 8192
    s_mov_b32 s6, 16384
    v_lshlrev_b32 v5, 5, v0
    s_cmp_ge_u32 s5, 28
    s_cbranch_scc1 k4_simple
    buffer_load_dwordx4 v[8:11], v5, s[12:15], 0 offen offset:0
    buffer_load_dwordx4 v[12:15], v5, s[12:15], 0 offen offset:16
    buffer_load_dwordx4 v[16:19], v5, s[12:15], s41 offen offset:0
    buffer_load_dwordx4 v[20:23], v5, s[12:15], s41 offen offset:16
    buffer_load_dwordx4 v[24:27], v5, s[12:15], s6 offen offset:0
    buffer_load_dwordx4 v[28:31], v5, s[12:15], s6 offen offset:16
    v_mov_b32 v6, 24576
    buffer_load_dword v32, v6, s[12:15], 0 offen
    buffer_load_dword v52, v3, s[12:15], 0 offen
    buffer_load_dword v53, v3, s[12:15], s41 offen
    buffer_load_dwordx4 v[36:39], v54, s[8:11], 0 offen offset:0
    buffer_load_dwordx4 v[40:43], v54, s[8:11], 0 offen offset:512
    buffer_load_dwordx4 v[44:47], v54, s[8:11], 0 offen offset:1024
    buffer_load_dwordx4 v[48:51], v54, s[8:11], 0 offen offset:1536
    v_lshrrev_b32 v3, 1, v2
    v_mul_u32_u24 v3, 7168, v3
    v_and_b32 v4, 1, v2
    v_lshl_add_u32 v3, v4, 4, v3
    s_lshl_b32 s40, s4, 5
    v_add_u32 v55, s40, v3
    v_lshrrev_b32 v3, 2, v2
    v_lshlrev_b32 v3, 11, v3
    v_and_b32 v4, 3, v2
    v_lshl_add_u32 v3, v4, 4, v3
    s_lshl_b32 s40, s4, 15
    s_lshl_b32 s7, s3, 9
    s_add_u32 s40, s40, s7
    v_add_u32 v33, s40, v3
    s_lshl_b32 s42, s3, 13
    s_mul_i32 s7, s3, 1835008
    s_add_u32 m0, s42, 0
    s_add_u32 s40, s7, 0
    buffer_load_dwordx4 v55, s[20:23], s40 offen lds
    s_add_u32 m0, s42, 32768
    s_nop 0
    buffer_load_dwordx4 v55, s[24:27], s40 offen lds
    s_add_u32 m0, s42, 1024
    s_add_u32 s40, s7, 229376
    buffer_load_dwordx4 v55, s[20:23], s40 offen lds
    s_add_u32 m0, s42, 33792
    s_nop 0
    buffer_load_dwordx4 v55, s[24:27], s40 offen lds
    s_add_u32 m0, s42, 2048
    s_add_u32 s40, s7, 458752
    buffer_load_dwordx4 v55, s[20:23], s40 offen lds
    s_add_u32 m0, s42, 34816
    s_nop 0
    buffer_load_dwordx4 v55, s[24:27], s40 offen lds
    s_add_u32 m0, s42, 3072
    s_add_u32 s40, s7, 688128
    buffer_load_dwordx4 v55, s[20:23], s40 offen lds
    s_add_u32 m0, s42, 35840
    s_nop 0
    buffer_load_dwordx4 v55, s[24:27], s40 offen lds
    s_add_u32 m0, s42, 4096
    s_add_u32 s40, s7, 917504
    buffer_load_dwordx4 v55, s[20:23], s40 offen lds
    s_add_u32 m0, s42, 36864
    s_nop 0
    buffer_load_dwordx4 v55, s[24:27], s40 offen lds
    s_add_u32 m0, s42, 5120
    s_add_u32 s40, s7, 1146880
    buffer_load_dwordx4 v55, s[20:23], s40 offen lds
    s_add_u32 m0, s42, 37888
    s_nop 0
    buffer_load_dwordx4 v55, s[24:27], s40 offen lds
    s_add_u32 m0, s42, 6144
    s_add_u32 s40, s7, 1376256
    buffer_load_dwordx4 v55, s[20:23], s40 offen lds
    s_add_u32 m0, s42, 38912
    s_nop 0
    buffer_load_dwordx4 v55, s[24:27], s40 offen lds
    s_add_u32 m0, s42, 7168
    s_add_u32 s40, s7, 1605632
    buffer_load_dwordx4 v55, s[20:23], s40 offen lds
    s_add_u32 m0, s42, 39936
    s_nop 0
    buffer_load_dwordx4 v55, s[24:27], s40 offen lds
    s_add_u32 m0, s42, 65536
    s_mov_b32 s40, 0
    buffer_load_dwordx4 v33, s[28:31], s40 offen lds
    s_add_u32 m0, s42, 66560
    s_mov_b32 s40, 64
    buffer_load_dwordx4 v33, s[28:31], s40 offen lds
    s_add_u32 m0, s42, 67584
    s_mov_b32 s40, 128
    buffer_load_dwordx4 v33, s[28:31], s40 offen lds
    s_add_u32 m0, s42, 68608
    s_mov_b32 s40, 192
    buffer_load_dwordx4 v33, s[28:31], s40 offen lds
    s_add_u32 m0, s42, 69632
    s_mov_b32 s40, 256
    buffer_load_dwordx4 v33, s[28:31], s40 offen lds
    s_add_u32 m0, s42, 70656
    s_mov_b32 s40, 320
    buffer_load_dwordx4 v33, s[28:31], s40 offen lds
    s_add_u32 m0, s42, 71680
    s_mov_b32 s40, 384
    buffer_load_dwordx4 v33, s[28:31], s40 offen lds
    s_add_u32 m0, s42, 72704
    s_mov_b32 s40, 448
    buffer_load_dwordx4 v33, s[28:31], s40 offen lds
    s_waitcnt vmcnt(30)
    v_lshlrev_b32 v5, 3, v0
    v_sub_u32 v5, 2047, v5
    v_mul_f32 v8, 0x3a800000, v8
    v_mul_f32 v9, 0x3a800000, v9
    v_mul_f32 v10, 0x3a800000, v10
    v_mul_f32 v11, 0x3a800000, v11
    v_mul_f32 v12, 0x3a800000, v12
    v_mul_f32 v13, 0x3a800000, v13
    v_mul_f32 v14, 0x3a800000, v14
    v_mul_f32 v15, 0x3a800000, v15
    v_mul_f32 v16, 0x3a800000, v16
    v_mul_f32 v17, 0x3a800000, v17
    v_mul_f32 v18, 0x3a800000, v18
    v_mul_f32 v19, 0x3a800000, v19
    v_mul_f32 v20, 0x3a800000, v20
    v_mul_f32 v21, 0x3a800000, v21
    v_mul_f32 v22, 0x3a800000, v22
    v_mul_f32 v23, 0x3a800000, v23
    v_fma_f32 v16, -v8, v8, v16
    v_fma_f32 v17, -v9, v9, v17
    v_fma_f32 v18, -v10, v10, v18
    v_fma_f32 v19, -v11, v11, v19
    v_fma_f32 v20, -v12, v12, v20
    v_fma_f32 v21, -v13, v13, v21
    v_fma_f32 v22, -v14, v14, v22
    v_fma_f32 v23, -v15, v15, v23
    v_max_f32 v16, 0, v16
    v_max_f32 v17, 0, v17
    v_max_f32 v18, 0, v18
    v_max_f32 v19, 0, v19
    v_max_f32 v20, 0, v20
    v_max_f32 v21, 0, v21
    v_max_f32 v22, 0, v22
    v_max_f32 v23, 0, v23
    v_cvt_pk_bf16_f32 v56, v8, v16
    v_cvt_pk_bf16_f32 v57, v9, v17
    v_cvt_pk_bf16_f32 v58, v10, v18
    v_cvt_pk_bf16_f32 v59, v11, v19
    v_cvt_pk_bf16_f32 v60, v12, v20
    v_cvt_pk_bf16_f32 v61, v13, v21
    v_cvt_pk_bf16_f32 v62, v14, v22
    v_cvt_pk_bf16_f32 v63, v15, v23
    v_lshlrev_b32 v8, 16, v56
    v_lshlrev_b32 v9, 16, v57
    v_lshlrev_b32 v10, 16, v58
    v_lshlrev_b32 v11, 16, v59
    v_lshlrev_b32 v12, 16, v60
    v_lshlrev_b32 v13, 16, v61
    v_lshlrev_b32 v14, 16, v62
    v_lshlrev_b32 v15, 16, v63
    v_and_b32 v16, 0xffff0000, v56
    v_and_b32 v17, 0xffff0000, v57
    v_and_b32 v18, 0xffff0000, v58
    v_and_b32 v19, 0xffff0000, v59
    v_and_b32 v20, 0xffff0000, v60
    v_and_b32 v21, 0xffff0000, v61
    v_and_b32 v22, 0xffff0000, v62
    v_and_b32 v23, 0xffff0000, v63
    v_add_f32 v16, 0x3727c5ac, v16
    v_add_f32 v17, 0x3727c5ac, v17
    v_add_f32 v18, 0x3727c5ac, v18
    v_add_f32 v19, 0x3727c5ac, v19
    v_add_f32 v20, 0x3727c5ac, v20
    v_add_f32 v21, 0x3727c5ac, v21
    v_add_f32 v22, 0x3727c5ac, v22
    v_add_f32 v23, 0x3727c5ac, v23
    v_cvt_pk_bf16_f32 v16, v16, v16
    v_cvt_pk_bf16_f32 v17, v17, v17
    v_cvt_pk_bf16_f32 v18, v18, v18
    v_cvt_pk_bf16_f32 v19, v19, v19
    v_cvt_pk_bf16_f32 v20, v20, v20
    v_cvt_pk_bf16_f32 v21, v21, v21
    v_cvt_pk_bf16_f32 v22, v22, v22
    v_cvt_pk_bf16_f32 v23, v23, v23
    v_lshlrev_b32 v16, 16, v16
    v_lshlrev_b32 v17, 16, v17
    v_lshlrev_b32 v18, 16, v18
    v_lshlrev_b32 v19, 16, v19
    v_lshlrev_b32 v20, 16, v20
    v_lshlrev_b32 v21, 16, v21
    v_lshlrev_b32 v22, 16, v22
    v_lshlrev_b32 v23, 16, v23
    v_sqrt_f32 v16, v16
    v_sqrt_f32 v17, v17
    v_sqrt_f32 v18, v18
    v_sqrt_f32 v19, v19
    v_sqrt_f32 v20, v20
    v_sqrt_f32 v21, v21
    v_sqrt_f32 v22, v22
    v_sqrt_f32 v23, v23
    v_cvt_pk_bf16_f32 v16, v16, v16
    v_cvt_pk_bf16_f32 v17, v17, v17
    v_cvt_pk_bf16_f32 v18, v18, v18
    v_cvt_pk_bf16_f32 v19, v19, v19
    v_cvt_pk_bf16_f32 v20, v20, v20
    v_cvt_pk_bf16_f32 v21, v21, v21
    v_cvt_pk_bf16_f32 v22, v22, v22
    v_cvt_pk_bf16_f32 v23, v23, v23
    v_lshlrev_b32 v16, 16, v16
    v_lshlrev_b32 v17, 16, v17
    v_lshlrev_b32 v18, 16, v18
    v_lshlrev_b32 v19, 16, v19
    v_lshlrev_b32 v20, 16, v20
    v_lshlrev_b32 v21, 16, v21
    v_lshlrev_b32 v22, 16, v22
    v_lshlrev_b32 v23, 16, v23
    v_rcp_f32 v16, v16
    v_rcp_f32 v17, v17
    v_rcp_f32 v18, v18
    v_rcp_f32 v19, v19
    v_rcp_f32 v20, v20
    v_rcp_f32 v21, v21
    v_rcp_f32 v22, v22
    v_rcp_f32 v23, v23
    v_fma_f32 v24, -v8, v32, v24
    v_fma_f32 v25, -v9, v32, v25
    v_fma_f32 v26, -v10, v32, v26
    v_fma_f32 v27, -v11, v32, v27
    v_fma_f32 v28, -v12, v32, v28
    v_fma_f32 v29, -v13, v32, v29
    v_fma_f32 v30, -v14, v32, v30
    v_fma_f32 v31, -v15, v32, v31
    v_mul_f32 v24, v24, v16
    v_mul_f32 v25, v25, v17
    v_mul_f32 v26, v26, v18
    v_mul_f32 v27, v27, v19
    v_mul_f32 v28, v28, v20
    v_mul_f32 v29, v29, v21
    v_mul_f32 v30, v30, v22
    v_mul_f32 v31, v31, v23
    v_cvt_pk_bf16_f32 v24, v24, v24
    v_cvt_pk_bf16_f32 v25, v25, v25
    v_cvt_pk_bf16_f32 v26, v26, v26
    v_cvt_pk_bf16_f32 v27, v27, v27
    v_cvt_pk_bf16_f32 v28, v28, v28
    v_cvt_pk_bf16_f32 v29, v29, v29
    v_cvt_pk_bf16_f32 v30, v30, v30
    v_cvt_pk_bf16_f32 v31, v31, v31
    v_ashrrev_i32 v56, 31, v24
    v_ashrrev_i32 v57, 31, v25
    v_ashrrev_i32 v58, 31, v26
    v_ashrrev_i32 v59, 31, v27
    v_ashrrev_i32 v60, 31, v28
    v_ashrrev_i32 v61, 31, v29
    v_ashrrev_i32 v62, 31, v30
    v_ashrrev_i32 v63, 31, v31
    v_or_b32 v56, 0x80000000, v56
    v_or_b32 v57, 0x80000000, v57
    v_or_b32 v58, 0x80000000, v58
    v_or_b32 v59, 0x80000000, v59
    v_or_b32 v60, 0x80000000, v60
    v_or_b32 v61, 0x80000000, v61
    v_or_b32 v62, 0x80000000, v62
    v_or_b32 v63, 0x80000000, v63
    v_xor_b32 v24, v24, v56
    v_xor_b32 v25, v25, v57
    v_xor_b32 v26, v26, v58
    v_xor_b32 v27, v27, v59
    v_xor_b32 v28, v28, v60
    v_xor_b32 v29, v29, v61
    v_xor_b32 v30, v30, v62
    v_xor_b32 v31, v31, v63
    v_and_b32 v24, 0xffff0000, v24
    v_and_b32 v25, 0xffff0000, v25
    v_and_b32 v26, 0xffff0000, v26
    v_and_b32 v27, 0xffff0000, v27
    v_and_b32 v28, 0xffff0000, v28
    v_and_b32 v29, 0xffff0000, v29
    v_and_b32 v30, 0xffff0000, v30
    v_and_b32 v31, 0xffff0000, v31
    v_subrev_u32 v56, 0, v5
    v_subrev_u32 v57, 1, v5
    v_subrev_u32 v58, 2, v5
    v_subrev_u32 v59, 3, v5
    v_subrev_u32 v60, 4, v5
    v_subrev_u32 v61, 5, v5
    v_subrev_u32 v62, 6, v5
    v_subrev_u32 v63, 7, v5
    v_or_b32 v24, v24, v56
    v_or_b32 v25, v25, v57
    v_or_b32 v26, v26, v58
    v_or_b32 v27, v27, v59
    v_or_b32 v28, v28, v60
    v_or_b32 v29, v29, v61
    v_or_b32 v30, v30, v62
    v_or_b32 v31, v31, v63
    v_max_u32 v64, v24, v25
    v_min_u32 v65, v24, v25
    v_med3_u32 v65, v64, v26, v65
    v_max_u32 v64, v64, v26
    v_med3_u32 v65, v64, v27, v65
    v_max_u32 v64, v64, v27
    v_med3_u32 v65, v64, v28, v65
    v_max_u32 v64, v64, v28
    v_med3_u32 v65, v64, v29, v65
    v_max_u32 v64, v64, v29
    v_med3_u32 v65, v64, v30, v65
    v_max_u32 v64, v64, v30
    v_med3_u32 v65, v64, v31, v65
    v_max_u32 v64, v64, v31
    s_nop 1
    v_mov_b32_dpp v66, v64 quad_perm:[1,0,3,2] row_mask:0xf bank_mask:0xf
    v_mov_b32_dpp v67, v65 quad_perm:[1,0,3,2] row_mask:0xf bank_mask:0xf
    v_min_u32 v68, v64, v66
    v_max_u32 v64, v64, v66
    v_max3_u32 v65, v68, v65, v67
    s_nop 1
    v_mov_b32_dpp v66, v64 quad_perm:[2,3,0,1] row_mask:0xf bank_mask:0xf
    v_mov_b32_dpp v67, v65 quad_perm:[2,3,0,1] row_mask:0xf bank_mask:0xf
    v_min_u32 v68, v64, v66
    v_max_u32 v64, v64, v66
    v_max3_u32 v65, v68, v65, v67
    s_nop 1
    v_mov_b32_dpp v66, v64 row_half_mirror row_mask:0xf bank_mask:0xf
    v_mov_b32_dpp v67, v65 row_half_mirror row_mask:0xf bank_mask:0xf
    v_min_u32 v68, v64, v66
    v_max_u32 v64, v64, v66
    v_max3_u32 v65, v68, v65, v67
    s_nop 1
    v_mov_b32_dpp v66, v64 row_mirror row_mask:0xf bank_mask:0xf
    v_mov_b32_dpp v67, v65 row_mirror row_mask:0xf bank_mask:0xf
    v_min_u32 v68, v64, v66
    v_max_u32 v64, v64, v66
    v_max3_u32 v65, v68, v65, v67
    v_mov_b32 v66, v64
    v_mov_b32 v67, v65
    s_nop 1
    v_permlane16_swap_b32 v64, v66
    v_permlane16_swap_b32 v65, v67
    s_nop 0
    v_min_u32 v68, v64, v66
    v_max_u32 v64, v64, v66
    v_max3_u32 v65, v68, v65, v67
    v_mov_b32 v66, v64
    v_mov_b32 v67, v65
    s_nop 1
    v_permlane32_swap_b32 v64, v66
    v_permlane32_swap_b32 v65, v67
    s_nop 0
    v_min_u32 v68, v64, v66
    v_max_u32 v64, v64, v66
    v_max3_u32 v65, v68, v65, v67
    s_lshl_b32 s40, s3, 3
    s_add_u32 s40, s40, 102400
    v_mov_b32 v3, s40
    ds_write_b64 v3, v[64:65]
    v_mov_b32 v3, 102400
    s_waitcnt lgkmcnt(0)
    s_barrier
    ds_read_b128 v[72:75], v3
    ds_read_b128 v[76:79], v3 offset:16
    s_waitcnt lgkmcnt(0)
    v_min_u32 v68, v72, v74
    v_max_u32 v72, v72, v74
    v_max3_u32 v73, v68, v73, v75
    v_min_u32 v68, v76, v78
    v_max_u32 v76, v76, v78
    v_max3_u32 v77, v68, v77, v79
    v_min_u32 v68, v72, v76
    v_max_u32 v72, v72, v76
    v_max3_u32 v73, v68, v73, v77
    s_cmp_lt_u32 s3, 2
    s_cselect_b64 vcc, -1, 0
    v_cndmask_b32 v64, v73, v72, vcc
    v_and_b32 v65, 0xffff, v64
    v_sub_u32 v65, 2047, v65
    v_and_b32 v3, 127, v0
    v_lshlrev_b32 v3, 4, v3
    v_lshl_add_u32 v3, v65, 11, v3
    v_lshlrev_b32 v4, 2, v65
    buffer_load_dwordx4 v[80:83], v3, s[8:11], 0 offen
    buffer_load_dword v84, v4, s[12:15], 0 offen
    buffer_load_dword v85, v4, s[12:15], s41 offen
    s_waitcnt vmcnt(27)
    v_mul_f32 v52, 0x3a800000, v52
    v_mul_f32 v53, 0x3a800000, v53
    v_fma_f32 v53, -v52, v52, v53
    v_max_f32 v53, 0, v53
    v_cvt_pk_bf16_f32 v3, v52, v53
    v_lshlrev_b32 v52, 16, v3
    v_and_b32 v53, 0xffff0000, v3
    v_add_f32 v53, 0x3727c5ac, v53
    v_cvt_pk_bf16_f32 v53, v53, v53
    v_lshlrev_b32 v53, 16, v53
    v_sqrt_f32 v53, v53
    s_nop 0
    v_cvt_pk_bf16_f32 v53, v53, v53
    v_lshlrev_b32 v53, 16, v53
    v_rcp_f32 v53, v53
    s_nop 0
    v_lshlrev_b32 v56, 16, v36
    v_lshlrev_b32 v60, 16, v37
    v_lshlrev_b32 v64, 16, v38
    v_lshlrev_b32 v68, 16, v39
    v_and_b32 v57, 0xffff0000, v36
    v_and_b32 v61, 0xffff0000, v37
    v_and_b32 v65, 0xffff0000, v38
    v_and_b32 v69, 0xffff0000, v39
    v_sub_f32 v56, v56, v52
    v_sub_f32 v60, v60, v52
    v_sub_f32 v64, v64, v52
    v_sub_f32 v68, v68, v52
    v_sub_f32 v57, v57, v52
    v_sub_f32 v61, v61, v52
    v_sub_f32 v65, v65, v52
    v_sub_f32 v69, v69, v52
    v_cvt_pk_bf16_f32 v57, v56, v57
    v_cvt_pk_bf16_f32 v61, v60, v61
    v_cvt_pk_bf16_f32 v65, v64, v65
    v_cvt_pk_bf16_f32 v69, v68, v69
    v_lshlrev_b32 v56, 16, v57
    v_lshlrev_b32 v60, 16, v61
    v_lshlrev_b32 v64, 16, v65
    v_lshlrev_b32 v68, 16, v69
    v_and_b32 v57, 0xffff0000, v57
    v_and_b32 v61, 0xffff0000, v61
    v_and_b32 v65, 0xffff0000, v65
    v_and_b32 v69, 0xffff0000, v69
    v_mul_f32 v56, v56, v53
    v_mul_f32 v60, v60, v53
    v_mul_f32 v64, v64, v53
    v_mul_f32 v68, v68, v53
    v_mul_f32 v57, v57, v53
    v_mul_f32 v61, v61, v53
    v_mul_f32 v65, v65, v53
    v_mul_f32 v69, v69, v53
    v_cvt_pk_bf16_f32 v58, v56, v57
    v_cvt_pk_bf16_f32 v62, v60, v61
    v_cvt_pk_bf16_f32 v66, v64, v65
    v_cvt_pk_bf16_f32 v70, v68, v69
    v_lshlrev_b32 v56, 16, v58
    v_lshlrev_b32 v60, 16, v62
    v_lshlrev_b32 v64, 16, v66
    v_lshlrev_b32 v68, 16, v70
    v_and_b32 v57, 0xffff0000, v58
    v_and_b32 v61, 0xffff0000, v62
    v_and_b32 v65, 0xffff0000, v66
    v_and_b32 v69, 0xffff0000, v70
    v_lshlrev_b32 v58, 16, v36
    v_lshlrev_b32 v62, 16, v37
    v_lshlrev_b32 v66, 16, v38
    v_lshlrev_b32 v70, 16, v39
    v_and_b32 v59, 0xffff0000, v36
    v_and_b32 v63, 0xffff0000, v37
    v_and_b32 v67, 0xffff0000, v38
    v_and_b32 v71, 0xffff0000, v39
    v_add_f32 v56, v56, v58
    v_add_f32 v60, v60, v62
    v_add_f32 v64, v64, v66
    v_add_f32 v68, v68, v70
    v_add_f32 v57, v57, v59
    v_add_f32 v61, v61, v63
    v_add_f32 v65, v65, v67
    v_add_f32 v69, v69, v71
    v_cvt_pk_bf16_f32 v36, v56, v57
    v_cvt_pk_bf16_f32 v37, v60, v61
    v_cvt_pk_bf16_f32 v38, v64, v65
    v_cvt_pk_bf16_f32 v39, v68, v69
    buffer_store_dwordx4 v[36:39], v54, s[16:19], 0 offen offset:0
    v_lshlrev_b32 v56, 16, v40
    v_lshlrev_b32 v60, 16, v41
    v_lshlrev_b32 v64, 16, v42
    v_lshlrev_b32 v68, 16, v43
    v_and_b32 v57, 0xffff0000, v40
    v_and_b32 v61, 0xffff0000, v41
    v_and_b32 v65, 0xffff0000, v42
    v_and_b32 v69, 0xffff0000, v43
    v_sub_f32 v56, v56, v52
    v_sub_f32 v60, v60, v52
    v_sub_f32 v64, v64, v52
    v_sub_f32 v68, v68, v52
    v_sub_f32 v57, v57, v52
    v_sub_f32 v61, v61, v52
    v_sub_f32 v65, v65, v52
    v_sub_f32 v69, v69, v52
    v_cvt_pk_bf16_f32 v57, v56, v57
    v_cvt_pk_bf16_f32 v61, v60, v61
    v_cvt_pk_bf16_f32 v65, v64, v65
    v_cvt_pk_bf16_f32 v69, v68, v69
    v_lshlrev_b32 v56, 16, v57
    v_lshlrev_b32 v60, 16, v61
    v_lshlrev_b32 v64, 16, v65
    v_lshlrev_b32 v68, 16, v69
    v_and_b32 v57, 0xffff0000, v57
    v_and_b32 v61, 0xffff0000, v61
    v_and_b32 v65, 0xffff0000, v65
    v_and_b32 v69, 0xffff0000, v69
    v_mul_f32 v56, v56, v53
    v_mul_f32 v60, v60, v53
    v_mul_f32 v64, v64, v53
    v_mul_f32 v68, v68, v53
    v_mul_f32 v57, v57, v53
    v_mul_f32 v61, v61, v53
    v_mul_f32 v65, v65, v53
    v_mul_f32 v69, v69, v53
    v_cvt_pk_bf16_f32 v58, v56, v57
    v_cvt_pk_bf16_f32 v62, v60, v61
    v_cvt_pk_bf16_f32 v66, v64, v65
    v_cvt_pk_bf16_f32 v70, v68, v69
    v_lshlrev_b32 v56, 16, v58
    v_lshlrev_b32 v60, 16, v62
    v_lshlrev_b32 v64, 16, v66
    v_lshlrev_b32 v68, 16, v70
    v_and_b32 v57, 0xffff0000, v58
    v_and_b32 v61, 0xffff0000, v62
    v_and_b32 v65, 0xffff0000, v66
    v_and_b32 v69, 0xffff0000, v70
    v_lshlrev_b32 v58, 16, v40
    v_lshlrev_b32 v62, 16, v41
    v_lshlrev_b32 v66, 16, v42
    v_lshlrev_b32 v70, 16, v43
    v_and_b32 v59, 0xffff0000, v40
    v_and_b32 v63, 0xffff0000, v41
    v_and_b32 v67, 0xffff0000, v42
    v_and_b32 v71, 0xffff0000, v43
    v_add_f32 v56, v56, v58
    v_add_f32 v60, v60, v62
    v_add_f32 v64, v64, v66
    v_add_f32 v68, v68, v70
    v_add_f32 v57, v57, v59
    v_add_f32 v61, v61, v63
    v_add_f32 v65, v65, v67
    v_add_f32 v69, v69, v71
    v_cvt_pk_bf16_f32 v40, v56, v57
    v_cvt_pk_bf16_f32 v41, v60, v61
    v_cvt_pk_bf16_f32 v42, v64, v65
    v_cvt_pk_bf16_f32 v43, v68, v69
    buffer_store_dwordx4 v[40:43], v54, s[16:19], 0 offen offset:512
    v_lshlrev_b32 v56, 16, v44
    v_lshlrev_b32 v60, 16, v45
    v_lshlrev_b32 v64, 16, v46
    v_lshlrev_b32 v68, 16, v47
    v_and_b32 v57, 0xffff0000, v44
    v_and_b32 v61, 0xffff0000, v45
    v_and_b32 v65, 0xffff0000, v46
    v_and_b32 v69, 0xffff0000, v47
    v_sub_f32 v56, v56, v52
    v_sub_f32 v60, v60, v52
    v_sub_f32 v64, v64, v52
    v_sub_f32 v68, v68, v52
    v_sub_f32 v57, v57, v52
    v_sub_f32 v61, v61, v52
    v_sub_f32 v65, v65, v52
    v_sub_f32 v69, v69, v52
    v_cvt_pk_bf16_f32 v57, v56, v57
    v_cvt_pk_bf16_f32 v61, v60, v61
    v_cvt_pk_bf16_f32 v65, v64, v65
    v_cvt_pk_bf16_f32 v69, v68, v69
    v_lshlrev_b32 v56, 16, v57
    v_lshlrev_b32 v60, 16, v61
    v_lshlrev_b32 v64, 16, v65
    v_lshlrev_b32 v68, 16, v69
    v_and_b32 v57, 0xffff0000, v57
    v_and_b32 v61, 0xffff0000, v61
    v_and_b32 v65, 0xffff0000, v65
    v_and_b32 v69, 0xffff0000, v69
    v_mul_f32 v56, v56, v53
    v_mul_f32 v60, v60, v53
    v_mul_f32 v64, v64, v53
    v_mul_f32 v68, v68, v53
    v_mul_f32 v57, v57, v53
    v_mul_f32 v61, v61, v53
    v_mul_f32 v65, v65, v53
    v_mul_f32 v69, v69, v53
    v_cvt_pk_bf16_f32 v58, v56, v57
    v_cvt_pk_bf16_f32 v62, v60, v61
    v_cvt_pk_bf16_f32 v66, v64, v65
    v_cvt_pk_bf16_f32 v70, v68, v69
    v_lshlrev_b32 v56, 16, v58
    v_lshlrev_b32 v60, 16, v62
    v_lshlrev_b32 v64, 16, v66
    v_lshlrev_b32 v68, 16, v70
    v_and_b32 v57, 0xffff0000, v58
    v_and_b32 v61, 0xffff0000, v62
    v_and_b32 v65, 0xffff0000, v66
    v_and_b32 v69, 0xffff0000, v70
    v_lshlrev_b32 v58, 16, v44
    v_lshlrev_b32 v62, 16, v45
    v_lshlrev_b32 v66, 16, v46
    v_lshlrev_b32 v70, 16, v47
    v_and_b32 v59, 0xffff0000, v44
    v_and_b32 v63, 0xffff0000, v45
    v_and_b32 v67, 0xffff0000, v46
    v_and_b32 v71, 0xffff0000, v47
    v_add_f32 v56, v56, v58
    v_add_f32 v60, v60, v62
    v_add_f32 v64, v64, v66
    v_add_f32 v68, v68, v70
    v_add_f32 v57, v57, v59
    v_add_f32 v61, v61, v63
    v_add_f32 v65, v65, v67
    v_add_f32 v69, v69, v71
    v_cvt_pk_bf16_f32 v44, v56, v57
    v_cvt_pk_bf16_f32 v45, v60, v61
    v_cvt_pk_bf16_f32 v46, v64, v65
    v_cvt_pk_bf16_f32 v47, v68, v69
    buffer_store_dwordx4 v[44:47], v54, s[16:19], 0 offen offset:1024
    v_lshlrev_b32 v56, 16, v48
    v_lshlrev_b32 v60, 16, v49
    v_lshlrev_b32 v64, 16, v50
    v_lshlrev_b32 v68, 16, v51
    v_and_b32 v57, 0xffff0000, v48
    v_and_b32 v61, 0xffff0000, v49
    v_and_b32 v65, 0xffff0000, v50
    v_and_b32 v69, 0xffff0000, v51
    v_sub_f32 v56, v56, v52
    v_sub_f32 v60, v60, v52
    v_sub_f32 v64, v64, v52
    v_sub_f32 v68, v68, v52
    v_sub_f32 v57, v57, v52
    v_sub_f32 v61, v61, v52
    v_sub_f32 v65, v65, v52
    v_sub_f32 v69, v69, v52
    v_cvt_pk_bf16_f32 v57, v56, v57
    v_cvt_pk_bf16_f32 v61, v60, v61
    v_cvt_pk_bf16_f32 v65, v64, v65
    v_cvt_pk_bf16_f32 v69, v68, v69
    v_lshlrev_b32 v56, 16, v57
    v_lshlrev_b32 v60, 16, v61
    v_lshlrev_b32 v64, 16, v65
    v_lshlrev_b32 v68, 16, v69
    v_and_b32 v57, 0xffff0000, v57
    v_and_b32 v61, 0xffff0000, v61
    v_and_b32 v65, 0xffff0000, v65
    v_and_b32 v69, 0xffff0000, v69
    v_mul_f32 v56, v56, v53
    v_mul_f32 v60, v60, v53
    v_mul_f32 v64, v64, v53
    v_mul_f32 v68, v68, v53
    v_mul_f32 v57, v57, v53
    v_mul_f32 v61, v61, v53
    v_mul_f32 v65, v65, v53
    v_mul_f32 v69, v69, v53
    v_cvt_pk_bf16_f32 v58, v56, v57
    v_cvt_pk_bf16_f32 v62, v60, v61
    v_cvt_pk_bf16_f32 v66, v64, v65
    v_cvt_pk_bf16_f32 v70, v68, v69
    v_lshlrev_b32 v56, 16, v58
    v_lshlrev_b32 v60, 16, v62
    v_lshlrev_b32 v64, 16, v66
    v_lshlrev_b32 v68, 16, v70
    v_and_b32 v57, 0xffff0000, v58
    v_and_b32 v61, 0xffff0000, v62
    v_and_b32 v65, 0xffff0000, v66
    v_and_b32 v69, 0xffff0000, v70
    v_lshlrev_b32 v58, 16, v48
    v_lshlrev_b32 v62, 16, v49
    v_lshlrev_b32 v66, 16, v50
    v_lshlrev_b32 v70, 16, v51
    v_and_b32 v59, 0xffff0000, v48
    v_and_b32 v63, 0xffff0000, v49
    v_and_b32 v67, 0xffff0000, v50
    v_and_b32 v71, 0xffff0000, v51
    v_add_f32 v56, v56, v58
    v_add_f32 v60, v60, v62
    v_add_f32 v64, v64, v66
    v_add_f32 v68, v68, v70
    v_add_f32 v57, v57, v59
    v_add_f32 v61, v61, v63
    v_add_f32 v65, v65, v67
    v_add_f32 v69, v69, v71
    v_cvt_pk_bf16_f32 v48, v56, v57
    v_cvt_pk_bf16_f32 v49, v60, v61
    v_cvt_pk_bf16_f32 v50, v64, v65
    v_cvt_pk_bf16_f32 v51, v68, v69
    buffer_store_dwordx4 v[48:51], v54, s[16:19], 0 offen offset:1536
    s_waitcnt vmcnt(4)
    v_mul_f32 v84, 0x3a800000, v84
    v_mul_f32 v85, 0x3a800000, v85
    v_fma_f32 v85, -v84, v84, v85
    v_max_f32 v85, 0, v85
    v_cvt_pk_bf16_f32 v3, v84, v85
    v_lshlrev_b32 v84, 16, v3
    v_and_b32 v85, 0xffff0000, v3
    v_add_f32 v85, 0x3727c5ac, v85
    v_cvt_pk_bf16_f32 v85, v85, v85
    v_lshlrev_b32 v85, 16, v85
    v_sqrt_f32 v85, v85
    s_nop 0
    v_cvt_pk_bf16_f32 v85, v85, v85
    v_lshlrev_b32 v85, 16, v85
    v_rcp_f32 v85, v85
    s_nop 0
    v_lshlrev_b32 v56, 16, v80
    v_lshlrev_b32 v58, 16, v81
    v_lshlrev_b32 v60, 16, v82
    v_lshlrev_b32 v62, 16, v83
    v_and_b32 v57, 0xffff0000, v80
    v_and_b32 v59, 0xffff0000, v81
    v_and_b32 v61, 0xffff0000, v82
    v_and_b32 v63, 0xffff0000, v83
    v_sub_f32 v56, v56, v84
    v_sub_f32 v58, v58, v84
    v_sub_f32 v60, v60, v84
    v_sub_f32 v62, v62, v84
    v_sub_f32 v57, v57, v84
    v_sub_f32 v59, v59, v84
    v_sub_f32 v61, v61, v84
    v_sub_f32 v63, v63, v84
    v_cvt_pk_bf16_f32 v57, v56, v57
    v_cvt_pk_bf16_f32 v59, v58, v59
    v_cvt_pk_bf16_f32 v61, v60, v61
    v_cvt_pk_bf16_f32 v63, v62, v63
    v_lshlrev_b32 v56, 16, v57
    v_lshlrev_b32 v58, 16, v59
    v_lshlrev_b32 v60, 16, v61
    v_lshlrev_b32 v62, 16, v63
    v_and_b32 v57, 0xffff0000, v57
    v_and_b32 v59, 0xffff0000, v59
    v_and_b32 v61, 0xffff0000, v61
    v_and_b32 v63, 0xffff0000, v63
    v_mul_f32 v56, v56, v85
    v_mul_f32 v58, v58, v85
    v_mul_f32 v60, v60, v85
    v_mul_f32 v62, v62, v85
    v_mul_f32 v57, v57, v85
    v_mul_f32 v59, v59, v85
    v_mul_f32 v61, v61, v85
    v_mul_f32 v63, v63, v85
    v_cvt_pk_bf16_f32 v88, v56, v57
    v_cvt_pk_bf16_f32 v89, v58, v59
    v_cvt_pk_bf16_f32 v90, v60, v61
    v_cvt_pk_bf16_f32 v91, v62, v63
    v_lshlrev_b32 v3, 4, v0
    v_add_u32 v4, 98304, v3
    ds_write_b128 v4, v[88:91]
    s_cmp_eq_u32 s2, 0
    s_cselect_b32 s43, 0, 0x40000000
    s_add_u32 s40, s43, 4096
    s_add_u32 s7, s43, 8192
    buffer_store_dwordx4 v[88:91], v3, s[32:35], s40 offen
    buffer_store_dwordx4 v[80:83], v3, s[32:35], s7 offen
    v_mov_b32 v4, 0
    buffer_store_dwordx2 v[72:73], v4, s[32:35], s43 offen
    v_bfe_u32 v3, v2, 2, 3
    v_lshrrev_b32 v4, 5, v2
    v_lshl_add_u32 v3, v4, 4, v3
    v_lshlrev_b32 v3, 5, v3
    v_and_b32 v5, 3, v2
    v_lshl_add_u32 v3, v5, 3, v3
    v_add_u32 v56, s42, v3
    v_lshlrev_b32 v4, 5, v4
    v_bfe_u32 v5, v2, 4, 1
    v_lshl_add_u32 v4, v5, 3, v4
    v_and_b32 v5, 1, v2
    v_lshl_add_u32 v4, v5, 11, v4
    s_lshl_b32 s40, s3, 9
    s_add_u32 s40, s40, 98304
    v_add_u32 v57, s40, v4
    ds_read_b64_tr_b16 v[8:9], v56 offset:0
    ds_read_b64_tr_b16 v[10:11], v56 offset:256
    ds_read_b64_tr_b16 v[12:13], v56 offset:1024
    ds_read_b64_tr_b16 v[14:15], v56 offset:1280
    ds_read_b64_tr_b16 v[16:17], v56 offset:2048
    ds_read_b64_tr_b16 v[18:19], v56 offset:2304
    ds_read_b64_tr_b16 v[20:21], v56 offset:3072
    ds_read_b64_tr_b16 v[22:23], v56 offset:3328
    s_waitcnt lgkmcnt(4)
    ds_read_b64_tr_b16 v[24:25], v56 offset:4096
    ds_read_b64_tr_b16 v[26:27], v56 offset:4352
    ds_read_b64_tr_b16 v[28:29], v56 offset:5120
    ds_read_b64_tr_b16 v[30:31], v56 offset:5376
    ds_read_b64_tr_b16 v[32:33], v56 offset:6144
    ds_read_b64_tr_b16 v[34:35], v56 offset:6400
    ds_read_b64_tr_b16 v[36:37], v56 offset:7168
    ds_read_b64_tr_b16 v[38:39], v56 offset:7424
    s_waitcnt lgkmcnt(4)
    ds_read_b64_tr_b16 v[92:93], v56 offset:32768
    ds_read_b64_tr_b16 v[94:95], v56 offset:33024
    ds_read_b64_tr_b16 v[96:97], v56 offset:33792
    ds_read_b64_tr_b16 v[98:99], v56 offset:34048
    ds_read_b64_tr_b16 v[100:101], v56 offset:34816
    ds_read_b64_tr_b16 v[102:103], v56 offset:35072
    ds_read_b64_tr_b16 v[104:105], v56 offset:35840
    ds_read_b64_tr_b16 v[106:107], v56 offset:36096
    s_waitcnt lgkmcnt(4)
    ds_read_b64_tr_b16 v[108:109], v56 offset:36864
    ds_read_b64_tr_b16 v[110:111], v56 offset:37120
    ds_read_b64_tr_b16 v[112:113], v56 offset:37888
    ds_read_b64_tr_b16 v[114:115], v56 offset:38144
    ds_read_b64_tr_b16 v[116:117], v56 offset:38912
    ds_read_b64_tr_b16 v[118:119], v56 offset:39168
    ds_read_b64_tr_b16 v[120:121], v56 offset:39936
    ds_read_b64_tr_b16 v[122:123], v56 offset:40192
    s_waitcnt lgkmcnt(4)
    s_waitcnt vmcnt(0) lgkmcnt(0)
    s_barrier
    ds_read_b64 v[60:61], v57 offset:0
    ds_read_b64 v[62:63], v57 offset:16
    ds_read_b64 v[64:65], v57 offset:64
    ds_read_b64 v[66:67], v57 offset:80
    ds_read_b64 v[68:69], v57 offset:128
    ds_read_b64 v[70:71], v57 offset:144
    ds_read_b64 v[72:73], v57 offset:192
    ds_read_b64 v[74:75], v57 offset:208
    s_waitcnt lgkmcnt(4)
    ds_read_b64 v[76:77], v57 offset:256
    ds_read_b64 v[78:79], v57 offset:272
    ds_read_b64 v[80:81], v57 offset:320
    ds_read_b64 v[82:83], v57 offset:336
    ds_read_b64 v[84:85], v57 offset:384
    ds_read_b64 v[86:87], v57 offset:400
    ds_read_b64 v[88:89], v57 offset:448
    ds_read_b64 v[90:91], v57 offset:464
    s_waitcnt lgkmcnt(0)
    v_mfma_f32_16x16x32_bf16 v[40:43], v[8:11], v[60:63], 0
    v_mfma_f32_16x16x32_bf16 v[44:47], v[92:95], v[60:63], 0
    v_mfma_f32_16x16x32_bf16 v[40:43], v[12:15], v[64:67], v[40:43]
    v_mfma_f32_16x16x32_bf16 v[44:47], v[96:99], v[64:67], v[44:47]
    v_mfma_f32_16x16x32_bf16 v[40:43], v[16:19], v[68:71], v[40:43]
    v_mfma_f32_16x16x32_bf16 v[44:47], v[100:103], v[68:71], v[44:47]
    v_mfma_f32_16x16x32_bf16 v[40:43], v[20:23], v[72:75], v[40:43]
    v_mfma_f32_16x16x32_bf16 v[44:47], v[104:107], v[72:75], v[44:47]
    v_mfma_f32_16x16x32_bf16 v[40:43], v[24:27], v[76:79], v[40:43]
    v_mfma_f32_16x16x32_bf16 v[44:47], v[108:111], v[76:79], v[44:47]
    v_mfma_f32_16x16x32_bf16 v[40:43], v[28:31], v[80:83], v[40:43]
    v_mfma_f32_16x16x32_bf16 v[44:47], v[112:115], v[80:83], v[44:47]
    v_mfma_f32_16x16x32_bf16 v[40:43], v[32:35], v[84:87], v[40:43]
    v_mfma_f32_16x16x32_bf16 v[44:47], v[116:119], v[84:87], v[44:47]
    v_mfma_f32_16x16x32_bf16 v[40:43], v[36:39], v[88:91], v[40:43]
    v_mfma_f32_16x16x32_bf16 v[44:47], v[120:123], v[88:91], v[44:47]
    v_lshlrev_b32 v3, 4, v0
    v_add_u32 v3, 102464, v3
    v_lshlrev_b32 v4, 4, v2
    v_add_u32 v4, 102464, v4
    v_lshrrev_b32 v5, 2, v2
    v_lshlrev_b32 v5, 6, v5
    v_and_b32 v6, 3, v2
    v_lshl_add_u32 v5, v6, 3, v5
    s_add_u32 s40, s42, 65536
    v_add_u32 v58, s40, v5
    ds_write_b128 v3, v[40:43]
    ds_write_b128 v3, v[44:47] offset:4096
    ds_read_b64_tr_b16 v[8:9], v58 offset:0
    ds_read_b64_tr_b16 v[10:11], v58 offset:32
    ds_read_b64_tr_b16 v[12:13], v58 offset:1024
    ds_read_b64_tr_b16 v[14:15], v58 offset:1056
    ds_read_b64_tr_b16 v[16:17], v58 offset:2048
    ds_read_b64_tr_b16 v[18:19], v58 offset:2080
    ds_read_b64_tr_b16 v[20:21], v58 offset:3072
    ds_read_b64_tr_b16 v[22:23], v58 offset:3104
    ds_read_b64_tr_b16 v[24:25], v58 offset:4096
    ds_read_b64_tr_b16 v[26:27], v58 offset:4128
    ds_read_b64_tr_b16 v[28:29], v58 offset:5120
    ds_read_b64_tr_b16 v[30:31], v58 offset:5152
    s_waitcnt lgkmcnt(0)
    s_barrier
    ds_read_b64_tr_b16 v[32:33], v58 offset:6144
    ds_read_b64_tr_b16 v[34:35], v58 offset:6176
    ds_read_b64_tr_b16 v[36:37], v58 offset:7168
    ds_read_b64_tr_b16 v[38:39], v58 offset:7200
    ds_read_b128 v[60:63], v4 offset:0
    ds_read_b128 v[76:79], v4 offset:4096
    ds_read_b128 v[64:67], v4 offset:1024
    ds_read_b128 v[80:83], v4 offset:5120
    ds_read_b128 v[68:71], v4 offset:2048
    ds_read_b128 v[84:87], v4 offset:6144
    ds_read_b128 v[72:75], v4 offset:3072
    ds_read_b128 v[88:91], v4 offset:7168
    s_waitcnt lgkmcnt(0)
    v_add_f32 v60, v60, v64
    v_add_f32 v61, v61, v65
    v_add_f32 v62, v62, v66
    v_add_f32 v63, v63, v67
    v_add_f32 v68, v68, v72
    v_add_f32 v69, v69, v73
    v_add_f32 v70, v70, v74
    v_add_f32 v71, v71, v75
    v_add_f32 v76, v76, v80
    v_add_f32 v77, v77, v81
    v_add_f32 v78, v78, v82
    v_add_f32 v79, v79, v83
    v_add_f32 v84, v84, v88
    v_add_f32 v85, v85, v89
    v_add_f32 v86, v86, v90
    v_add_f32 v87, v87, v91
    v_add_f32 v60, v60, v68
    v_add_f32 v61, v61, v69
    v_add_f32 v62, v62, v70
    v_add_f32 v63, v63, v71
    v_add_f32 v76, v76, v84
    v_add_f32 v77, v77, v85
    v_add_f32 v78, v78, v86
    v_add_f32 v79, v79, v87
    v_cvt_pk_bf16_f32 v76, v60, v76
    v_cvt_pk_bf16_f32 v77, v61, v77
    v_cvt_pk_bf16_f32 v78, v62, v78
    v_cvt_pk_bf16_f32 v79, v63, v79
    v_lshlrev_b32 v60, 16, v76
    v_lshlrev_b32 v61, 16, v77
    v_lshlrev_b32 v62, 16, v78
    v_lshlrev_b32 v63, 16, v79
    v_and_b32 v76, 0xffff0000, v76
    v_and_b32 v77, 0xffff0000, v77
    v_and_b32 v78, 0xffff0000, v78
    v_and_b32 v79, 0xffff0000, v79
    v_mul_f32 v92, 0xbfb8aa3b, v60
    v_mul_f32 v93, 0xbfb8aa3b, v61
    v_mul_f32 v94, 0xbfb8aa3b, v62
    v_mul_f32 v95, 0xbfb8aa3b, v63
    v_exp_f32 v92, v92
    v_exp_f32 v93, v93
    v_exp_f32 v94, v94
    v_exp_f32 v95, v95
    v_add_f32 v92, 1.0, v92
    v_add_f32 v93, 1.0, v93
    v_add_f32 v94, 1.0, v94
    v_add_f32 v95, 1.0, v95
    v_rcp_f32 v92, v92
    v_rcp_f32 v93, v93
    v_rcp_f32 v94, v94
    v_rcp_f32 v95, v95
    v_mul_f32 v60, v60, v92
    v_mul_f32 v61, v61, v93
    v_mul_f32 v62, v62, v94
    v_mul_f32 v63, v63, v95
    v_cvt_pk_bf16_f32 v60, v60, v60
    v_cvt_pk_bf16_f32 v61, v61, v61
    v_cvt_pk_bf16_f32 v62, v62, v62
    v_cvt_pk_bf16_f32 v63, v63, v63
    v_lshlrev_b32 v60, 16, v60
    v_lshlrev_b32 v61, 16, v61
    v_lshlrev_b32 v62, 16, v62
    v_lshlrev_b32 v63, 16, v63
    v_mul_f32 v60, v60, v76
    v_mul_f32 v61, v61, v77
    v_mul_f32 v62, v62, v78
    v_mul_f32 v63, v63, v79
    v_cvt_pk_bf16_f32 v40, v60, v61
    v_cvt_pk_bf16_f32 v41, v62, v63
    v_and_b32 v3, 15, v2
    v_lshlrev_b32 v4, 12, v3
    v_lshrrev_b32 v5, 4, v2
    v_lshl_add_u32 v4, v5, 4, v4
    v_cmp_gt_u32 vcc, 2, v3
    v_mov_b32 v5, 0x40000000
    s_lshl_b32 s40, s4, 13
    s_lshl_b32 s7, s3, 10
    v_cndmask_b32 v4, v5, v4, vcc
    s_add_u32 s40, s40, s7
    v_mfma_f32_16x16x16_bf16 v[60:63], v[8:9], v[40:41], 0
    v_mfma_f32_16x16x16_bf16 v[64:67], v[10:11], v[40:41], 0
    v_mfma_f32_16x16x16_bf16 v[68:71], v[12:13], v[40:41], 0
    v_mfma_f32_16x16x16_bf16 v[72:75], v[14:15], v[40:41], 0
    v_mfma_f32_16x16x16_bf16 v[76:79], v[16:17], v[40:41], 0
    v_mfma_f32_16x16x16_bf16 v[80:83], v[18:19], v[40:41], 0
    v_mfma_f32_16x16x16_bf16 v[84:87], v[20:21], v[40:41], 0
    v_mfma_f32_16x16x16_bf16 v[88:91], v[22:23], v[40:41], 0
    v_mfma_f32_16x16x16_bf16 v[92:95], v[24:25], v[40:41], 0
    v_mfma_f32_16x16x16_bf16 v[96:99], v[26:27], v[40:41], 0
    v_mfma_f32_16x16x16_bf16 v[100:103], v[28:29], v[40:41], 0
    v_mfma_f32_16x16x16_bf16 v[104:107], v[30:31], v[40:41], 0
    v_mfma_f32_16x16x16_bf16 v[108:111], v[32:33], v[40:41], 0
    v_mfma_f32_16x16x16_bf16 v[112:115], v[34:35], v[40:41], 0
    v_mfma_f32_16x16x16_bf16 v[116:119], v[36:37], v[40:41], 0
    v_mfma_f32_16x16x16_bf16 v[120:123], v[38:39], v[40:41], 0
    s_nop 7
    buffer_store_dwordx4 v[60:63], v4, s[36:39], s40 offen offset:0
    buffer_store_dwordx4 v[64:67], v4, s[36:39], s40 offen offset:64
    buffer_store_dwordx4 v[68:71], v4, s[36:39], s40 offen offset:128
    buffer_store_dwordx4 v[72:75], v4, s[36:39], s40 offen offset:192
    buffer_store_dwordx4 v[76:79], v4, s[36:39], s40 offen offset:256
    buffer_store_dwordx4 v[80:83], v4, s[36:39], s40 offen offset:320
    buffer_store_dwordx4 v[84:87], v4, s[36:39], s40 offen offset:384
    buffer_store_dwordx4 v[88:91], v4, s[36:39], s40 offen offset:448
    buffer_store_dwordx4 v[92:95], v4, s[36:39], s40 offen offset:512
    buffer_store_dwordx4 v[96:99], v4, s[36:39], s40 offen offset:576
    buffer_store_dwordx4 v[100:103], v4, s[36:39], s40 offen offset:640
    buffer_store_dwordx4 v[104:107], v4, s[36:39], s40 offen offset:704
    buffer_store_dwordx4 v[108:111], v4, s[36:39], s40 offen offset:768
    buffer_store_dwordx4 v[112:115], v4, s[36:39], s40 offen offset:832
    buffer_store_dwordx4 v[116:119], v4, s[36:39], s40 offen offset:896
    buffer_store_dwordx4 v[120:123], v4, s[36:39], s40 offen offset:960
    s_endpgm
k4_simple:
    buffer_load_dword v52, v3, s[12:15], 0 offen
    buffer_load_dword v53, v3, s[12:15], s41 offen
    buffer_load_dwordx4 v[36:39], v54, s[8:11], 0 offen offset:0
    buffer_load_dwordx4 v[40:43], v54, s[8:11], 0 offen offset:512
    buffer_load_dwordx4 v[44:47], v54, s[8:11], 0 offen offset:1024
    buffer_load_dwordx4 v[48:51], v54, s[8:11], 0 offen offset:1536
    s_waitcnt vmcnt(0)
    v_mul_f32 v52, 0x3a800000, v52
    v_mul_f32 v53, 0x3a800000, v53
    v_fma_f32 v53, -v52, v52, v53
    v_max_f32 v53, 0, v53
    v_cvt_pk_bf16_f32 v3, v52, v53
    v_lshlrev_b32 v52, 16, v3
    v_and_b32 v53, 0xffff0000, v3
    v_add_f32 v53, 0x3727c5ac, v53
    v_cvt_pk_bf16_f32 v53, v53, v53
    v_lshlrev_b32 v53, 16, v53
    v_sqrt_f32 v53, v53
    s_nop 0
    v_cvt_pk_bf16_f32 v53, v53, v53
    v_lshlrev_b32 v53, 16, v53
    v_rcp_f32 v53, v53
    s_nop 0
    v_lshlrev_b32 v56, 16, v36
    v_lshlrev_b32 v60, 16, v37
    v_lshlrev_b32 v64, 16, v38
    v_lshlrev_b32 v68, 16, v39
    v_and_b32 v57, 0xffff0000, v36
    v_and_b32 v61, 0xffff0000, v37
    v_and_b32 v65, 0xffff0000, v38
    v_and_b32 v69, 0xffff0000, v39
    v_sub_f32 v56, v56, v52
    v_sub_f32 v60, v60, v52
    v_sub_f32 v64, v64, v52
    v_sub_f32 v68, v68, v52
    v_sub_f32 v57, v57, v52
    v_sub_f32 v61, v61, v52
    v_sub_f32 v65, v65, v52
    v_sub_f32 v69, v69, v52
    v_cvt_pk_bf16_f32 v57, v56, v57
    v_cvt_pk_bf16_f32 v61, v60, v61
    v_cvt_pk_bf16_f32 v65, v64, v65
    v_cvt_pk_bf16_f32 v69, v68, v69
    v_lshlrev_b32 v56, 16, v57
    v_lshlrev_b32 v60, 16, v61
    v_lshlrev_b32 v64, 16, v65
    v_lshlrev_b32 v68, 16, v69
    v_and_b32 v57, 0xffff0000, v57
    v_and_b32 v61, 0xffff0000, v61
    v_and_b32 v65, 0xffff0000, v65
    v_and_b32 v69, 0xffff0000, v69
    v_mul_f32 v56, v56, v53
    v_mul_f32 v60, v60, v53
    v_mul_f32 v64, v64, v53
    v_mul_f32 v68, v68, v53
    v_mul_f32 v57, v57, v53
    v_mul_f32 v61, v61, v53
    v_mul_f32 v65, v65, v53
    v_mul_f32 v69, v69, v53
    v_cvt_pk_bf16_f32 v58, v56, v57
    v_cvt_pk_bf16_f32 v62, v60, v61
    v_cvt_pk_bf16_f32 v66, v64, v65
    v_cvt_pk_bf16_f32 v70, v68, v69
    v_lshlrev_b32 v56, 16, v58
    v_lshlrev_b32 v60, 16, v62
    v_lshlrev_b32 v64, 16, v66
    v_lshlrev_b32 v68, 16, v70
    v_and_b32 v57, 0xffff0000, v58
    v_and_b32 v61, 0xffff0000, v62
    v_and_b32 v65, 0xffff0000, v66
    v_and_b32 v69, 0xffff0000, v70
    v_lshlrev_b32 v58, 16, v36
    v_lshlrev_b32 v62, 16, v37
    v_lshlrev_b32 v66, 16, v38
    v_lshlrev_b32 v70, 16, v39
    v_and_b32 v59, 0xffff0000, v36
    v_and_b32 v63, 0xffff0000, v37
    v_and_b32 v67, 0xffff0000, v38
    v_and_b32 v71, 0xffff0000, v39
    v_add_f32 v56, v56, v58
    v_add_f32 v60, v60, v62
    v_add_f32 v64, v64, v66
    v_add_f32 v68, v68, v70
    v_add_f32 v57, v57, v59
    v_add_f32 v61, v61, v63
    v_add_f32 v65, v65, v67
    v_add_f32 v69, v69, v71
    v_cvt_pk_bf16_f32 v36, v56, v57
    v_cvt_pk_bf16_f32 v37, v60, v61
    v_cvt_pk_bf16_f32 v38, v64, v65
    v_cvt_pk_bf16_f32 v39, v68, v69
    buffer_store_dwordx4 v[36:39], v54, s[16:19], 0 offen offset:0
    v_lshlrev_b32 v56, 16, v40
    v_lshlrev_b32 v60, 16, v41
    v_lshlrev_b32 v64, 16, v42
    v_lshlrev_b32 v68, 16, v43
    v_and_b32 v57, 0xffff0000, v40
    v_and_b32 v61, 0xffff0000, v41
    v_and_b32 v65, 0xffff0000, v42
    v_and_b32 v69, 0xffff0000, v43
    v_sub_f32 v56, v56, v52
    v_sub_f32 v60, v60, v52
    v_sub_f32 v64, v64, v52
    v_sub_f32 v68, v68, v52
    v_sub_f32 v57, v57, v52
    v_sub_f32 v61, v61, v52
    v_sub_f32 v65, v65, v52
    v_sub_f32 v69, v69, v52
    v_cvt_pk_bf16_f32 v57, v56, v57
    v_cvt_pk_bf16_f32 v61, v60, v61
    v_cvt_pk_bf16_f32 v65, v64, v65
    v_cvt_pk_bf16_f32 v69, v68, v69
    v_lshlrev_b32 v56, 16, v57
    v_lshlrev_b32 v60, 16, v61
    v_lshlrev_b32 v64, 16, v65
    v_lshlrev_b32 v68, 16, v69
    v_and_b32 v57, 0xffff0000, v57
    v_and_b32 v61, 0xffff0000, v61
    v_and_b32 v65, 0xffff0000, v65
    v_and_b32 v69, 0xffff0000, v69
    v_mul_f32 v56, v56, v53
    v_mul_f32 v60, v60, v53
    v_mul_f32 v64, v64, v53
    v_mul_f32 v68, v68, v53
    v_mul_f32 v57, v57, v53
    v_mul_f32 v61, v61, v53
    v_mul_f32 v65, v65, v53
    v_mul_f32 v69, v69, v53
    v_cvt_pk_bf16_f32 v58, v56, v57
    v_cvt_pk_bf16_f32 v62, v60, v61
    v_cvt_pk_bf16_f32 v66, v64, v65
    v_cvt_pk_bf16_f32 v70, v68, v69
    v_lshlrev_b32 v56, 16, v58
    v_lshlrev_b32 v60, 16, v62
    v_lshlrev_b32 v64, 16, v66
    v_lshlrev_b32 v68, 16, v70
    v_and_b32 v57, 0xffff0000, v58
    v_and_b32 v61, 0xffff0000, v62
    v_and_b32 v65, 0xffff0000, v66
    v_and_b32 v69, 0xffff0000, v70
    v_lshlrev_b32 v58, 16, v40
    v_lshlrev_b32 v62, 16, v41
    v_lshlrev_b32 v66, 16, v42
    v_lshlrev_b32 v70, 16, v43
    v_and_b32 v59, 0xffff0000, v40
    v_and_b32 v63, 0xffff0000, v41
    v_and_b32 v67, 0xffff0000, v42
    v_and_b32 v71, 0xffff0000, v43
    v_add_f32 v56, v56, v58
    v_add_f32 v60, v60, v62
    v_add_f32 v64, v64, v66
    v_add_f32 v68, v68, v70
    v_add_f32 v57, v57, v59
    v_add_f32 v61, v61, v63
    v_add_f32 v65, v65, v67
    v_add_f32 v69, v69, v71
    v_cvt_pk_bf16_f32 v40, v56, v57
    v_cvt_pk_bf16_f32 v41, v60, v61
    v_cvt_pk_bf16_f32 v42, v64, v65
    v_cvt_pk_bf16_f32 v43, v68, v69
    buffer_store_dwordx4 v[40:43], v54, s[16:19], 0 offen offset:512
    v_lshlrev_b32 v56, 16, v44
    v_lshlrev_b32 v60, 16, v45
    v_lshlrev_b32 v64, 16, v46
    v_lshlrev_b32 v68, 16, v47
    v_and_b32 v57, 0xffff0000, v44
    v_and_b32 v61, 0xffff0000, v45
    v_and_b32 v65, 0xffff0000, v46
    v_and_b32 v69, 0xffff0000, v47
    v_sub_f32 v56, v56, v52
    v_sub_f32 v60, v60, v52
    v_sub_f32 v64, v64, v52
    v_sub_f32 v68, v68, v52
    v_sub_f32 v57, v57, v52
    v_sub_f32 v61, v61, v52
    v_sub_f32 v65, v65, v52
    v_sub_f32 v69, v69, v52
    v_cvt_pk_bf16_f32 v57, v56, v57
    v_cvt_pk_bf16_f32 v61, v60, v61
    v_cvt_pk_bf16_f32 v65, v64, v65
    v_cvt_pk_bf16_f32 v69, v68, v69
    v_lshlrev_b32 v56, 16, v57
    v_lshlrev_b32 v60, 16, v61
    v_lshlrev_b32 v64, 16, v65
    v_lshlrev_b32 v68, 16, v69
    v_and_b32 v57, 0xffff0000, v57
    v_and_b32 v61, 0xffff0000, v61
    v_and_b32 v65, 0xffff0000, v65
    v_and_b32 v69, 0xffff0000, v69
    v_mul_f32 v56, v56, v53
    v_mul_f32 v60, v60, v53
    v_mul_f32 v64, v64, v53
    v_mul_f32 v68, v68, v53
    v_mul_f32 v57, v57, v53
    v_mul_f32 v61, v61, v53
    v_mul_f32 v65, v65, v53
    v_mul_f32 v69, v69, v53
    v_cvt_pk_bf16_f32 v58, v56, v57
    v_cvt_pk_bf16_f32 v62, v60, v61
    v_cvt_pk_bf16_f32 v66, v64, v65
    v_cvt_pk_bf16_f32 v70, v68, v69
    v_lshlrev_b32 v56, 16, v58
    v_lshlrev_b32 v60, 16, v62
    v_lshlrev_b32 v64, 16, v66
    v_lshlrev_b32 v68, 16, v70
    v_and_b32 v57, 0xffff0000, v58
    v_and_b32 v61, 0xffff0000, v62
    v_and_b32 v65, 0xffff0000, v66
    v_and_b32 v69, 0xffff0000, v70
    v_lshlrev_b32 v58, 16, v44
    v_lshlrev_b32 v62, 16, v45
    v_lshlrev_b32 v66, 16, v46
    v_lshlrev_b32 v70, 16, v47
    v_and_b32 v59, 0xffff0000, v44
    v_and_b32 v63, 0xffff0000, v45
    v_and_b32 v67, 0xffff0000, v46
    v_and_b32 v71, 0xffff0000, v47
    v_add_f32 v56, v56, v58
    v_add_f32 v60, v60, v62
    v_add_f32 v64, v64, v66
    v_add_f32 v68, v68, v70
    v_add_f32 v57, v57, v59
    v_add_f32 v61, v61, v63
    v_add_f32 v65, v65, v67
    v_add_f32 v69, v69, v71
    v_cvt_pk_bf16_f32 v44, v56, v57
    v_cvt_pk_bf16_f32 v45, v60, v61
    v_cvt_pk_bf16_f32 v46, v64, v65
    v_cvt_pk_bf16_f32 v47, v68, v69
    buffer_store_dwordx4 v[44:47], v54, s[16:19], 0 offen offset:1024
    v_lshlrev_b32 v56, 16, v48
    v_lshlrev_b32 v60, 16, v49
    v_lshlrev_b32 v64, 16, v50
    v_lshlrev_b32 v68, 16, v51
    v_and_b32 v57, 0xffff0000, v48
    v_and_b32 v61, 0xffff0000, v49
    v_and_b32 v65, 0xffff0000, v50
    v_and_b32 v69, 0xffff0000, v51
    v_sub_f32 v56, v56, v52
    v_sub_f32 v60, v60, v52
    v_sub_f32 v64, v64, v52
    v_sub_f32 v68, v68, v52
    v_sub_f32 v57, v57, v52
    v_sub_f32 v61, v61, v52
    v_sub_f32 v65, v65, v52
    v_sub_f32 v69, v69, v52
    v_cvt_pk_bf16_f32 v57, v56, v57
    v_cvt_pk_bf16_f32 v61, v60, v61
    v_cvt_pk_bf16_f32 v65, v64, v65
    v_cvt_pk_bf16_f32 v69, v68, v69
    v_lshlrev_b32 v56, 16, v57
    v_lshlrev_b32 v60, 16, v61
    v_lshlrev_b32 v64, 16, v65
    v_lshlrev_b32 v68, 16, v69
    v_and_b32 v57, 0xffff0000, v57
    v_and_b32 v61, 0xffff0000, v61
    v_and_b32 v65, 0xffff0000, v65
    v_and_b32 v69, 0xffff0000, v69
    v_mul_f32 v56, v56, v53
    v_mul_f32 v60, v60, v53
    v_mul_f32 v64, v64, v53
    v_mul_f32 v68, v68, v53
    v_mul_f32 v57, v57, v53
    v_mul_f32 v61, v61, v53
    v_mul_f32 v65, v65, v53
    v_mul_f32 v69, v69, v53
    v_cvt_pk_bf16_f32 v58, v56, v57
    v_cvt_pk_bf16_f32 v62, v60, v61
    v_cvt_pk_bf16_f32 v66, v64, v65
    v_cvt_pk_bf16_f32 v70, v68, v69
    v_lshlrev_b32 v56, 16, v58
    v_lshlrev_b32 v60, 16, v62
    v_lshlrev_b32 v64, 16, v66
    v_lshlrev_b32 v68, 16, v70
    v_and_b32 v57, 0xffff0000, v58
    v_and_b32 v61, 0xffff0000, v62
    v_and_b32 v65, 0xffff0000, v66
    v_and_b32 v69, 0xffff0000, v70
    v_lshlrev_b32 v58, 16, v48
    v_lshlrev_b32 v62, 16, v49
    v_lshlrev_b32 v66, 16, v50
    v_lshlrev_b32 v70, 16, v51
    v_and_b32 v59, 0xffff0000, v48
    v_and_b32 v63, 0xffff0000, v49
    v_and_b32 v67, 0xffff0000, v50
    v_and_b32 v71, 0xffff0000, v51
    v_add_f32 v56, v56, v58
    v_add_f32 v60, v60, v62
    v_add_f32 v64, v64, v66
    v_add_f32 v68, v68, v70
    v_add_f32 v57, v57, v59
    v_add_f32 v61, v61, v63
    v_add_f32 v65, v65, v67
    v_add_f32 v69, v69, v71
    v_cvt_pk_bf16_f32 v48, v56, v57
    v_cvt_pk_bf16_f32 v49, v60, v61
    v_cvt_pk_bf16_f32 v50, v64, v65
    v_cvt_pk_bf16_f32 v51, v68, v69
    buffer_store_dwordx4 v[48:51], v54, s[16:19], 0 offen offset:1536
k4_done:
    s_endpgm

.globl k5_kernel
.p2align 8
.type k5_kernel,@function
k5_kernel:
    s_cmp_ge_u32 s2, 32
    s_cbranch_scc1 k5_done
    s_load_dwordx2 s[4:5], s[0:1], 88
    s_load_dwordx2 s[6:7], s[0:1], 104
    v_lshrrev_b32 v1, 6, v0
    v_and_b32 v2, 63, v0
    v_readfirstlane_b32 s3, v1
    s_waitcnt lgkmcnt(0)
    s_add_u32 s8, s6, 0x3900000
    s_addc_u32 s9, s7, 0
    s_mov_b32 s10, 0x1c0000
    s_mov_b32 s11, 0x00020000
    s_add_u32 s12, s6, 0x3810000
    s_addc_u32 s13, s7, 0
    s_mov_b32 s14, 0x3000
    s_mov_b32 s15, 0x00020000
    s_mov_b32 s16, s4
    s_mov_b32 s17, s5
    s_mov_b32 s18, 0x400000
    s_mov_b32 s19, 0x00020000
    v_lshrrev_b32 v3, 4, v0
    v_lshlrev_b32 v3, 13, v3
    v_and_b32 v4, 15, v0
    v_lshl_add_u32 v3, v4, 4, v3
    s_lshl_b32 s20, s2, 8
    s_add_u32 s21, s20, 0
    buffer_load_dwordx4 v[16:19], v3, s[8:11], s21 offen
    s_add_u32 s21, s20, 131072
    buffer_load_dwordx4 v[20:23], v3, s[8:11], s21 offen
    s_add_u32 s21, s20, 262144
    buffer_load_dwordx4 v[24:27], v3, s[8:11], s21 offen
    s_add_u32 s21, s20, 393216
    buffer_load_dwordx4 v[28:31], v3, s[8:11], s21 offen
    s_add_u32 s21, s20, 524288
    buffer_load_dwordx4 v[32:35], v3, s[8:11], s21 offen
    s_add_u32 s21, s20, 655360
    buffer_load_dwordx4 v[36:39], v3, s[8:11], s21 offen
    s_add_u32 s21, s20, 786432
    buffer_load_dwordx4 v[40:43], v3, s[8:11], s21 offen
    s_add_u32 s21, s20, 917504
    buffer_load_dwordx4 v[44:47], v3, s[8:11], s21 offen
    s_add_u32 s21, s20, 1048576
    buffer_load_dwordx4 v[48:51], v3, s[8:11], s21 offen
    s_add_u32 s21, s20, 1179648
    buffer_load_dwordx4 v[52:55], v3, s[8:11], s21 offen
    s_add_u32 s21, s20, 1310720
    buffer_load_dwordx4 v[56:59], v3, s[8:11], s21 offen
    s_add_u32 s21, s20, 1441792
    buffer_load_dwordx4 v[60:63], v3, s[8:11], s21 offen
    s_add_u32 s21, s20, 1572864
    buffer_load_dwordx4 v[64:67], v3, s[8:11], s21 offen
    s_add_u32 s21, s20, 1703936
    buffer_load_dwordx4 v[68:71], v3, s[8:11], s21 offen
    v_lshrrev_b32 v5, 4, v2
    v_and_b32 v6, 1, v5
    v_lshrrev_b32 v5, 1, v5
    v_lshl_add_u32 v5, v6, 1, v5
    v_lshl_add_u32 v5, v4, 2, v5
    s_lshl_b32 s22, s2, 6
    v_add_u32 v5, s22, v5
    v_lshlrev_b32 v6, 1, v5
    s_mov_b32 s23, 4096
    s_mov_b32 s24, 8192
    s_lshr_b32 s25, s2, 4
    s_lshl_b32 s25, s25, 2
    v_mov_b32 v7, 0
    buffer_load_ushort v8, v6, s[12:15], s23 offen
    buffer_load_ushort v9, v6, s[12:15], s24 offen
    buffer_load_dword v10, v7, s[12:15], s25 offen
    s_waitcnt vmcnt(15)
    v_add_f32 v16, v16, v20
    v_add_f32 v17, v17, v21
    v_add_f32 v18, v18, v22
    v_add_f32 v19, v19, v23
    s_waitcnt vmcnt(14)
    v_add_f32 v16, v16, v24
    v_add_f32 v17, v17, v25
    v_add_f32 v18, v18, v26
    v_add_f32 v19, v19, v27
    s_waitcnt vmcnt(13)
    v_add_f32 v16, v16, v28
    v_add_f32 v17, v17, v29
    v_add_f32 v18, v18, v30
    v_add_f32 v19, v19, v31
    s_waitcnt vmcnt(12)
    v_add_f32 v16, v16, v32
    v_add_f32 v17, v17, v33
    v_add_f32 v18, v18, v34
    v_add_f32 v19, v19, v35
    s_waitcnt vmcnt(11)
    v_add_f32 v16, v16, v36
    v_add_f32 v17, v17, v37
    v_add_f32 v18, v18, v38
    v_add_f32 v19, v19, v39
    s_waitcnt vmcnt(10)
    v_add_f32 v16, v16, v40
    v_add_f32 v17, v17, v41
    v_add_f32 v18, v18, v42
    v_add_f32 v19, v19, v43
    s_waitcnt vmcnt(9)
    v_add_f32 v16, v16, v44
    v_add_f32 v17, v17, v45
    v_add_f32 v18, v18, v46
    v_add_f32 v19, v19, v47
    s_waitcnt vmcnt(8)
    v_add_f32 v16, v16, v48
    v_add_f32 v17, v17, v49
    v_add_f32 v18, v18, v50
    v_add_f32 v19, v19, v51
    s_waitcnt vmcnt(7)
    v_add_f32 v16, v16, v52
    v_add_f32 v17, v17, v53
    v_add_f32 v18, v18, v54
    v_add_f32 v19, v19, v55
    s_waitcnt vmcnt(6)
    v_add_f32 v16, v16, v56
    v_add_f32 v17, v17, v57
    v_add_f32 v18, v18, v58
    v_add_f32 v19, v19, v59
    s_waitcnt vmcnt(5)
    v_add_f32 v16, v16, v60
    v_add_f32 v17, v17, v61
    v_add_f32 v18, v18, v62
    v_add_f32 v19, v19, v63
    s_waitcnt vmcnt(4)
    v_add_f32 v16, v16, v64
    v_add_f32 v17, v17, v65
    v_add_f32 v18, v18, v66
    v_add_f32 v19, v19, v67
    s_waitcnt vmcnt(3)
    v_add_f32 v16, v16, v68
    v_add_f32 v17, v17, v69
    v_add_f32 v18, v18, v70
    v_add_f32 v19, v19, v71
    s_nop 1
    v_permlane32_swap_b32 v16, v17
    v_permlane32_swap_b32 v18, v19
    s_nop 0
    v_add_f32 v16, v16, v17
    v_add_f32 v18, v18, v19
    s_nop 1
    v_permlane16_swap_b32 v16, v18
    s_nop 0
    v_add_f32 v16, v16, v18
    v_lshlrev_b32 v11, 2, v0
    ds_write_b32 v11, v16
    v_lshlrev_b32 v11, 2, v2
    s_waitcnt lgkmcnt(0)
    s_barrier
    s_cmp_lg_u32 s3, 0
    s_cbranch_scc1 k5_done
    ds_read_b32 v16, v11
    ds_read_b32 v17, v11 offset:256
    ds_read_b32 v18, v11 offset:512
    ds_read_b32 v19, v11 offset:768
    s_waitcnt vmcnt(0)
    v_and_b32 v12, 0xffff0000, v10
    v_not_b32 v13, v12
    v_ashrrev_i32 v13, 31, v13
    v_or_b32 v13, 0x80000000, v13
    v_xor_b32 v12, v12, v13
    v_and_b32 v12, 0xffff0000, v12
    v_mul_f32 v12, 0xbfb8aa3b, v12
    v_exp_f32 v12, v12
    s_nop 0
    v_add_f32 v12, 1.0, v12
    v_rcp_f32 v12, v12
    s_nop 0
    v_cvt_pk_bf16_f32 v12, v12, v12
    v_lshlrev_b32 v12, 16, v12
    v_and_b32 v10, 0xffff, v10
    v_sub_u32 v10, 2047, v10
    v_and_b32 v6, 2047, v6
    v_lshl_add_u32 v6, v10, 11, v6
    v_lshlrev_b32 v8, 16, v8
    v_lshlrev_b32 v9, 16, v9
    s_waitcnt lgkmcnt(0)
    v_add_f32 v16, v16, v17
    v_add_f32 v18, v18, v19
    v_add_f32 v16, v16, v18
    v_cvt_pk_bf16_f32 v16, v16, v16
    v_lshlrev_b32 v16, 16, v16
    v_mul_f32 v16, v16, v12
    v_cvt_pk_bf16_f32 v16, v16, v16
    v_lshlrev_b32 v16, 16, v16
    v_add_f32 v16, v16, v8
    v_cvt_pk_bf16_f32 v16, v16, v16
    v_lshlrev_b32 v16, 16, v16
    v_add_f32 v16, v16, v9
    v_cvt_pk_bf16_f32 v16, v16, v16
    buffer_store_short v16, v6, s[16:19], 0 offen
k5_done:
    s_endpgm

.section .rodata,"a"
.p2align 6
.amdhsa_kernel k1_kernel
  .amdhsa_next_free_vgpr 512
  .amdhsa_next_free_sgpr 102
  .amdhsa_accum_offset 256
  .amdhsa_group_segment_fixed_size 0
  .amdhsa_kernarg_size 112
  .amdhsa_user_sgpr_count 2
  .amdhsa_user_sgpr_kernarg_segment_ptr 1
  .amdhsa_system_sgpr_workgroup_id_x 1
  .amdhsa_float_denorm_mode_32 3
.end_amdhsa_kernel

.p2align 6
.amdhsa_kernel k2_kernel
  .amdhsa_next_free_vgpr 512
  .amdhsa_next_free_sgpr 102
  .amdhsa_accum_offset 256
  .amdhsa_group_segment_fixed_size 0
  .amdhsa_kernarg_size 112
  .amdhsa_user_sgpr_count 2
  .amdhsa_user_sgpr_kernarg_segment_ptr 1
  .amdhsa_system_sgpr_workgroup_id_x 1
  .amdhsa_float_denorm_mode_32 3
.end_amdhsa_kernel

.p2align 6
.amdhsa_kernel k3_kernel
  .amdhsa_next_free_vgpr 512
  .amdhsa_next_free_sgpr 102
  .amdhsa_accum_offset 256
  .amdhsa_group_segment_fixed_size 0
  .amdhsa_kernarg_size 112
  .amdhsa_user_sgpr_count 2
  .amdhsa_user_sgpr_kernarg_segment_ptr 1
  .amdhsa_system_sgpr_workgroup_id_x 1
  .amdhsa_float_denorm_mode_32 3
.end_amdhsa_kernel

.p2align 6
.amdhsa_kernel k4_kernel
  .amdhsa_next_free_vgpr 128
  .amdhsa_next_free_sgpr 102
  .amdhsa_accum_offset 128
  .amdhsa_group_segment_fixed_size 0
  .amdhsa_kernarg_size 112
  .amdhsa_user_sgpr_count 2
  .amdhsa_user_sgpr_kernarg_segment_ptr 1
  .amdhsa_system_sgpr_workgroup_id_x 1
  .amdhsa_float_denorm_mode_32 3
.end_amdhsa_kernel

.p2align 6
.amdhsa_kernel k5_kernel
  .amdhsa_next_free_vgpr 80
  .amdhsa_next_free_sgpr 102
  .amdhsa_accum_offset 80
  .amdhsa_group_segment_fixed_size 0
  .amdhsa_kernarg_size 112
  .amdhsa_user_sgpr_count 2
  .amdhsa_user_sgpr_kernarg_segment_ptr 1
  .amdhsa_system_sgpr_workgroup_id_x 1
  .amdhsa_float_denorm_mode_32 3
.end_amdhsa_kernel
```

```asm
; @launch kernel=ka_kernel grid=(256,1,1) block=(256,1,1) lds=163840
; @launch kernel=k3_kernel grid=(256,1,1) block=(256,1,1) lds=98304
; @launch kernel=k4_kernel grid=(256,1,1) block=(256,1,1) lds=110848
; @launch kernel=k5_kernel grid=(32,1,1) block=(256,1,1) lds=1024
.amdgcn_target "amdgcn-amd-amdhsa--gfx950"
.text
.globl ka_kernel
.p2align 8
.type ka_kernel,@function
ka_kernel:
    s_cmp_ge_u32 s2, 256
    s_cbranch_scc1 ka_done
    s_load_dwordx8 s[64:71], s[0:1], 0
    s_load_dwordx4 s[72:75], s[0:1], 32
    s_load_dwordx4 s[76:79], s[0:1], 64
    s_load_dwordx8 s[80:87], s[0:1], 80
    v_lshrrev_b32 v1, 6, v0
    v_and_b32 v2, 63, v0
    v_readfirstlane_b32 s3, v1
    v_mov_b32 v253, v0
    s_and_b32 s4, s2, 7
    s_lshl_b32 s4, s4, 2
    s_lshr_b32 s24, s2, 3
    s_and_b32 s24, s24, 3
    s_add_u32 s4, s4, s24
    s_lshr_b32 s5, s2, 5
    s_lshl2_add_u32 s6, s5, s3
    s_getpc_b64 s[56:57]
ka_pc:
    s_mov_b32 s58, code_end-ka_pc
    s_mov_b32 s59, 0x00020000
    s_lshr_b32 s24, s2, 3
    s_lshl2_add_u32 s24, s24, s3
    s_lshl_b32 s24, s24, 13
    v_lshlrev_b32 v3, 7, v2
    buffer_load_dword v252, v3, s[56:59], s24 offen
    v_lshrrev_b32 v8, 3, v2
    v_and_b32 v9, 7, v2
    s_lshr_b32 s24, s3, 1
    s_lshl_b32 s24, s24, 5
    s_and_b32 s25, s3, 1
    s_lshl_b32 s26, s25, 3
    s_add_u32 s24, s24, s26
    v_add_u32 v4, s24, v8
    v_lshlrev_b32 v4, 10, v4
    v_lshrrev_b32 v5, 1, v8
    v_xor_b32 v5, v9, v5
    v_lshl_add_u32 v232, v5, 4, v4
    v_xor_b32 v5, 4, v5
    v_lshl_add_u32 v233, v5, 4, v4
    v_add_u32 v233, 15360, v233
    s_lshl_b32 s24, s4, 8
    s_lshl_b32 s26, s25, 7
    s_add_u32 s24, s24, s26
    v_lshlrev_b32 v4, 13, v8
    v_add_u32 v4, s24, v4
    v_bfe_u32 v5, v8, 1, 1
    v_xor_b32 v5, v9, v5
    v_lshl_add_u32 v234, v5, 4, v4
    v_xor_b32 v5, 4, v5
    v_lshl_add_u32 v235, v5, 4, v4
    v_add_u32 v235, 64512, v235
    s_lshl_b32 s34, s3, 11
    s_mul_i32 s35, s3, 24576
    s_add_u32 s35, s35, 65536
    s_lshl_b32 s32, s5, 18
    s_waitcnt lgkmcnt(0)
    s_cmp_lt_u32 s3, 2
    s_cselect_b32 s48, s70, s72
    s_cselect_b32 s49, s71, s73
    s_mov_b32 s50, 0x400000
    s_mov_b32 s51, 0x00020000
    s_mov_b32 s44, s66
    s_mov_b32 s45, s67
    s_mov_b32 s46, 0x200000
    s_mov_b32 s47, 0x00020000
    s_mov_b32 s52, s64
    s_mov_b32 s53, s65
    s_mov_b32 s54, 0x400000
    s_mov_b32 s55, 0x00020000
    s_mov_b32 s12, s68
    s_mov_b32 s13, s69
    s_mov_b32 s14, 0x800000
    s_mov_b32 s15, 0x00020000
    s_add_u32 s16, s86, 0x400000
    s_addc_u32 s17, s87, 0
    s_mov_b32 s18, 0x2000000
    s_mov_b32 s19, 0x00020000
    s_mov_b32 s8, s86
    s_mov_b32 s9, s87
    s_mov_b32 s10, 0x400000
    s_mov_b32 s11, 0x00020000
    s_add_u32 s56, s86, 0x3800000
    s_addc_u32 s57, s87, 0
    s_mov_b32 s58, 0x6040
    s_mov_b32 s59, 0x00020000
    s_add_u32 s20, s86, 0x2400000
    s_addc_u32 s21, s87, 0
    s_mov_b32 s22, 0x1000000
    s_mov_b32 s23, 0x00020000
    s_mov_b32 s88, s84
    s_mov_b32 s89, s85
    s_mov_b32 s90, 0x100
    s_mov_b32 s91, 0x00020000
    s_cmp_eq_u32 s3, 0
    s_cselect_b32 s60, s74, s76
    s_cselect_b32 s61, s75, s77
    s_mov_b32 s62, 0x700000
    s_cselect_b32 s62, 0x800000, s62
    s_cmp_eq_u32 s3, 2
    s_cselect_b32 s60, s78, s60
    s_cselect_b32 s61, s79, s61
    s_cmp_eq_u32 s3, 3
    s_cselect_b32 s60, s80, s60
    s_cselect_b32 s61, s81, s61
    s_mov_b32 s63, 0x00020000
    s_add_u32 s80, s5, 0
    s_and_b32 s80, s80, 7
    s_lshl_b32 s80, s80, 7
    s_add_u32 s80, s80, s32
    s_add_u32 s81, s5, 1
    s_and_b32 s81, s81, 7
    s_lshl_b32 s81, s81, 7
    s_add_u32 s81, s81, s32
    s_add_u32 s82, s5, 2
    s_and_b32 s82, s82, 7
    s_lshl_b32 s82, s82, 7
    s_add_u32 s82, s82, s32
    s_add_u32 s83, s5, 3
    s_and_b32 s83, s83, 7
    s_lshl_b32 s83, s83, 7
    s_add_u32 s83, s83, s32
    s_add_u32 s84, s5, 4
    s_and_b32 s84, s84, 7
    s_lshl_b32 s84, s84, 7
    s_add_u32 s84, s84, s32
    s_add_u32 s85, s5, 5
    s_and_b32 s85, s85, 7
    s_lshl_b32 s85, s85, 7
    s_add_u32 s85, s85, s32
    s_add_u32 s86, s5, 6
    s_and_b32 s86, s86, 7
    s_lshl_b32 s86, s86, 7
    s_add_u32 s86, s86, s32
    s_add_u32 s87, s5, 7
    s_and_b32 s87, s87, 7
    s_lshl_b32 s87, s87, 7
    s_add_u32 s87, s87, s32
    s_add_u32 m0, s35, 0
    s_and_b32 s33, s80, 1023
    s_lshl_b32 s33, s33, 12
    buffer_load_dwordx4 v234, s[48:51], s33 offen lds
    buffer_load_dwordx4 v235, s[48:51], s33 offen offset:1024 lds
    s_add_u32 m0, s35, 2048
    s_add_u32 s33, s33, 131072
    buffer_load_dwordx4 v234, s[48:51], s33 offen lds
    buffer_load_dwordx4 v235, s[48:51], s33 offen offset:1024 lds
    s_add_u32 m0, s35, 4096
    s_add_u32 s33, s33, 131072
    buffer_load_dwordx4 v234, s[48:51], s33 offen lds
    buffer_load_dwordx4 v235, s[48:51], s33 offen offset:1024 lds
    s_add_u32 m0, s35, 6144
    s_add_u32 s33, s33, 131072
    buffer_load_dwordx4 v234, s[48:51], s33 offen lds
    buffer_load_dwordx4 v235, s[48:51], s33 offen offset:1024 lds
    s_add_u32 m0, s34, 0
    s_add_u32 s37, s80, 0
    buffer_load_dwordx4 v232, s[44:47], s37 offen lds
    buffer_load_dwordx4 v233, s[44:47], s37 offen offset:1024 lds
    s_add_u32 m0, s34, 8192
    s_add_u32 s37, s81, 0
    buffer_load_dwordx4 v232, s[44:47], s37 offen lds
    buffer_load_dwordx4 v233, s[44:47], s37 offen offset:1024 lds
    s_add_u32 m0, s35, 8192
    s_and_b32 s33, s81, 1023
    s_lshl_b32 s33, s33, 12
    buffer_load_dwordx4 v234, s[48:51], s33 offen lds
    buffer_load_dwordx4 v235, s[48:51], s33 offen offset:1024 lds
    s_add_u32 m0, s35, 10240
    s_add_u32 s33, s33, 131072
    buffer_load_dwordx4 v234, s[48:51], s33 offen lds
    buffer_load_dwordx4 v235, s[48:51], s33 offen offset:1024 lds
    s_add_u32 m0, s35, 12288
    s_add_u32 s33, s33, 131072
    buffer_load_dwordx4 v234, s[48:51], s33 offen lds
    buffer_load_dwordx4 v235, s[48:51], s33 offen offset:1024 lds
    s_add_u32 m0, s35, 14336
    s_add_u32 s33, s33, 131072
    buffer_load_dwordx4 v234, s[48:51], s33 offen lds
    buffer_load_dwordx4 v235, s[48:51], s33 offen offset:1024 lds
    v_and_b32 v10, 15, v2
    v_lshrrev_b32 v11, 4, v2
    v_lshrrev_b32 v4, 1, v10
    v_xor_b32 v4, v11, v4
    v_lshlrev_b32 v4, 4, v4
    v_lshl_add_u32 v224, v10, 7, v4
    v_xor_b32 v225, 64, v224
    v_add_u32 v226, 98304, v224
    v_add_u32 v227, 98304, v225
    v_lshrrev_b32 v4, 2, v10
    v_lshl_add_u32 v5, v11, 3, v4
    v_lshlrev_b32 v5, 7, v5
    v_add_u32 v5, s35, v5
    v_and_b32 v6, 1, v10
    v_lshl_add_u32 v5, v6, 3, v5
    v_lshrrev_b32 v4, 1, v4
    v_and_b32 v6, 1, v11
    v_lshl_or_b32 v4, v6, 2, v4
    v_and_b32 v6, 2, v10
    v_xor_b32 v4, v4, v6
    v_xor_b32 v6, 0, v4
    v_lshl_add_u32 v228, v6, 4, v5
    v_xor_b32 v6, 1, v4
    v_lshl_add_u32 v229, v6, 4, v5
    v_xor_b32 v6, 4, v4
    v_lshl_add_u32 v230, v6, 4, v5
    v_xor_b32 v6, 5, v4
    v_lshl_add_u32 v231, v6, 4, v5
    s_lshl_b32 s36, s4, 20
    s_lshl_b32 s24, s5, 17
    s_add_u32 s36, s36, s24
    s_and_b32 s24, s3, 1
    s_lshl_b32 s24, s24, 12
    s_and_b32 s26, s3, 2
    s_lshl_b32 s26, s26, 13
    s_add_u32 s36, s36, s24
    s_add_u32 s36, s36, s26
    v_bfe_u32 v4, v2, 3, 1
    v_lshlrev_b32 v4, 10, v4
    v_lshrrev_b32 v5, 5, v2
    v_lshl_add_u32 v4, v5, 8, v4
    v_bfe_u32 v5, v2, 4, 1
    v_lshl_add_u32 v4, v5, 7, v4
    v_lshl_add_u32 v239, v9, 4, v4
    s_lshl_b32 s24, s5, 7
    s_sub_u32 s26, 1792, s24
    s_cmp_lt_u32 s4, 16
    s_cselect_b32 s24, s24, s26
    s_lshl_b32 s26, s4, 3
    s_add_u32 s24, s24, s26
    v_lshrrev_b32 v4, 5, v253
    v_add_u32 v6, s24, v4
    v_and_b32 v5, 31, v2
    v_lshlrev_b32 v6, 11, v6
    v_lshl_add_u32 v236, v5, 4, v6
    v_lshlrev_b32 v4, 4, v4
    v_lshl_add_u32 v4, v5, 7, v4
    v_add_u32 v237, 65536, v4
    s_lshr_b32 s26, s24, 5
    s_lshl_b32 s26, s26, 16
    s_and_b32 s24, s24, 31
    s_lshl_b32 s24, s24, 4
    s_add_u32 s24, s24, s26
    v_lshrrev_b32 v4, 3, v253
    v_lshlrev_b32 v4, 9, v4
    v_lshl_add_u32 v4, v9, 4, v4
    v_add_u32 v238, s24, v4
    v_lshlrev_b32 v240, 4, v2
    s_lshl_b32 s24, s3, 12
    v_add_u32 v242, s24, v240
    s_lshl_b32 s24, s6, 16
    v_add_u32 v248, s24, v240
    s_sub_u32 s25, 63, s6
    s_lshl_b32 s24, s25, 16
    v_add_u32 v249, s24, v240
    v_bfe_u32 v4, v2, 2, 2
    v_lshlrev_b32 v4, 13, v4
    v_lshl_add_u32 v4, v11, 6, v4
    v_and_b32 v5, 3, v2
    v_lshl_add_u32 v4, v5, 4, v4
    s_lshl_b32 s24, s4, 8
    s_lshl_b32 s25, s3, 18
    s_add_u32 s24, s24, s25
    v_add_u32 v245, s24, v4
    s_lshl_b32 s31, s3, 13
    s_add_u32 s31, s31, 65536
    s_lshl_b32 s27, s5, 20
    s_mov_b32 s7, s27
    s_mov_b32 s43, 0x40000000
    s_lshr_b32 s28, s27, 7
    s_add_u32 s29, s28, 4096
    v_lshrrev_b32 v4, 5, v2
    v_lshlrev_b32 v4, 11, v4
    v_bfe_u32 v5, v2, 2, 2
    v_lshl_add_u32 v4, v5, 6, v4
    v_bfe_u32 v5, v2, 4, 1
    v_lshl_add_u32 v4, v5, 5, v4
    v_and_b32 v5, 3, v2
    v_lshl_add_u32 v247, v5, 3, v4
    s_mov_b32 s30, 65536
    v_add_u32 v246, s30, v247
    v_and_b32 v4, 31, v2
    v_lshrrev_b32 v5, 5, v2
    v_lshlrev_b32 v5, 2, v5
    v_sub_u32 v4, v4, v5
    v_cvt_f32_i32 v4, v4
    v_add_f32 v4, 0.5, v4
    v_mul_f32 v243, 0x71800000, v4
    v_bfe_u32 v4, v2, 4, 1
    v_lshlrev_b32 v4, 17, v4
    v_lshrrev_b32 v5, 5, v2
    v_lshl_add_u32 v4, v5, 8, v4
    v_lshl_add_u32 v244, v10, 4, v4
    s_lshl_b32 s100, s2, 15
    s_add_u32 s101, s100, 30720
    v_lshlrev_b32 v251, 7, v2
    v_cmp_gt_u32 vcc, 16, v2
    v_mov_b32 v4, 0x40000000
    v_mov_b32 v255, 1
    v_cndmask_b32 v251, v4, v251, vcc
    v_cmp_eq_u32 vcc, 0, v253
    s_nop 1
    v_cndmask_b32 v250, v4, v253, vcc
    s_waitcnt vmcnt(8)
    s_barrier
    ds_read_b128 v[160:163], v224 offset:0
    ds_read_b128 v[164:167], v224 offset:2048
    ds_read_b128 v[168:171], v224 offset:4096
    ds_read_b128 v[172:175], v224 offset:6144
    ds_read_b64_tr_b16 a[0:1], v228 offset:0
    ds_read_b64_tr_b16 a[2:3], v228 offset:512
    ds_read_b64_tr_b16 a[4:5], v229 offset:0
    ds_read_b64_tr_b16 a[6:7], v229 offset:512
    ds_read_b64_tr_b16 a[8:9], v230 offset:0
    ds_read_b64_tr_b16 a[10:11], v230 offset:512
    ds_read_b64_tr_b16 a[12:13], v231 offset:0
    ds_read_b64_tr_b16 a[14:15], v231 offset:512
    s_cmp_lt_u32 s3, 2
    s_cbranch_scc0 ka_V
    s_waitcnt lgkmcnt(0)
    v_mfma_f32_16x16x32_bf16 v[96:99], a[0:3], v[160:163], 0
    ds_read_b128 v[176:179], v225 offset:0
    ds_read_b128 v[180:183], v225 offset:2048
    v_mfma_f32_16x16x32_bf16 v[100:103], a[4:7], v[160:163], 0
    ds_read_b128 v[184:187], v225 offset:4096
    v_mfma_f32_16x16x32_bf16 v[104:107], a[8:11], v[160:163], 0
    ds_read_b128 v[188:191], v225 offset:6144
    ds_read_b64_tr_b16 a[16:17], v228 offset:4096
    v_mfma_f32_16x16x32_bf16 v[108:111], a[12:15], v[160:163], 0
    ds_read_b64_tr_b16 a[18:19], v228 offset:4608
    v_mfma_f32_16x16x32_bf16 v[112:115], a[0:3], v[164:167], 0
    ds_read_b64_tr_b16 a[20:21], v229 offset:4096
    ds_read_b64_tr_b16 a[22:23], v229 offset:4608
    s_add_u32 m0, s34, 16384
    s_add_u32 s37, s82, 0
    buffer_load_dwordx4 v232, s[44:47], s37 offen lds
    v_mfma_f32_16x16x32_bf16 v[116:119], a[4:7], v[164:167], 0
    ds_read_b64_tr_b16 a[24:25], v230 offset:4096
    buffer_load_dwordx4 v233, s[44:47], s37 offen offset:1024 lds
    v_mfma_f32_16x16x32_bf16 v[120:123], a[8:11], v[164:167], 0
    ds_read_b64_tr_b16 a[26:27], v230 offset:4608
    ds_read_b64_tr_b16 a[28:29], v231 offset:4096
    s_add_u32 m0, s34, 24576
    s_add_u32 s37, s83, 0
    buffer_load_dwordx4 v232, s[44:47], s37 offen lds
    v_mfma_f32_16x16x32_bf16 v[124:127], a[12:15], v[164:167], 0
    ds_read_b64_tr_b16 a[30:31], v231 offset:4608
    buffer_load_dwordx4 v233, s[44:47], s37 offen offset:1024 lds
    v_mfma_f32_16x16x32_bf16 v[128:131], a[0:3], v[168:171], 0
    s_add_u32 m0, s35, 16384
    s_and_b32 s33, s82, 1023
    s_lshl_b32 s33, s33, 12
    buffer_load_dwordx4 v234, s[48:51], s33 offen lds
    v_mfma_f32_16x16x32_bf16 v[132:135], a[4:7], v[168:171], 0
    buffer_load_dwordx4 v235, s[48:51], s33 offen offset:1024 lds
    v_mfma_f32_16x16x32_bf16 v[136:139], a[8:11], v[168:171], 0
    s_add_u32 m0, s35, 18432
    s_add_u32 s33, s33, 131072
    buffer_load_dwordx4 v234, s[48:51], s33 offen lds
    v_mfma_f32_16x16x32_bf16 v[140:143], a[12:15], v[168:171], 0
    buffer_load_dwordx4 v235, s[48:51], s33 offen offset:1024 lds
    v_mfma_f32_16x16x32_bf16 v[144:147], a[0:3], v[172:175], 0
    s_add_u32 m0, s35, 20480
    s_add_u32 s33, s33, 131072
    buffer_load_dwordx4 v234, s[48:51], s33 offen lds
    v_mfma_f32_16x16x32_bf16 v[148:151], a[4:7], v[172:175], 0
    buffer_load_dwordx4 v235, s[48:51], s33 offen offset:1024 lds
    v_mfma_f32_16x16x32_bf16 v[152:155], a[8:11], v[172:175], 0
    s_add_u32 m0, s35, 22528
    s_add_u32 s33, s33, 131072
    buffer_load_dwordx4 v234, s[48:51], s33 offen lds
    v_mfma_f32_16x16x32_bf16 v[156:159], a[12:15], v[172:175], 0
    buffer_load_dwordx4 v235, s[48:51], s33 offen offset:1024 lds
    s_waitcnt vmcnt(12) lgkmcnt(0)
    v_mfma_f32_16x16x32_bf16 v[96:99], a[16:19], v[176:179], v[96:99]
    ds_read_b128 v[160:163], v224 offset:8192
    ds_read_b128 v[164:167], v224 offset:10240
    v_mfma_f32_16x16x32_bf16 v[100:103], a[20:23], v[176:179], v[100:103]
    ds_read_b128 v[168:171], v224 offset:12288
    v_mfma_f32_16x16x32_bf16 v[104:107], a[24:27], v[176:179], v[104:107]
    ds_read_b128 v[172:175], v224 offset:14336
    ds_read_b64_tr_b16 a[32:33], v228 offset:8192
    v_mfma_f32_16x16x32_bf16 v[108:111], a[28:31], v[176:179], v[108:111]
    ds_read_b64_tr_b16 a[34:35], v228 offset:8704
    v_mfma_f32_16x16x32_bf16 v[112:115], a[16:19], v[180:183], v[112:115]
    ds_read_b64_tr_b16 a[36:37], v229 offset:8192
    ds_read_b64_tr_b16 a[38:39], v229 offset:8704
    s_add_u32 m0, s35, 0
    s_and_b32 s33, s83, 1023
    s_lshl_b32 s33, s33, 12
    buffer_load_dwordx4 v234, s[48:51], s33 offen lds
    v_mfma_f32_16x16x32_bf16 v[116:119], a[20:23], v[180:183], v[116:119]
    ds_read_b64_tr_b16 a[40:41], v230 offset:8192
    buffer_load_dwordx4 v235, s[48:51], s33 offen offset:1024 lds
    v_mfma_f32_16x16x32_bf16 v[120:123], a[24:27], v[180:183], v[120:123]
    ds_read_b64_tr_b16 a[42:43], v230 offset:8704
    ds_read_b64_tr_b16 a[44:45], v231 offset:8192
    s_add_u32 m0, s35, 2048
    s_add_u32 s33, s33, 131072
    buffer_load_dwordx4 v234, s[48:51], s33 offen lds
    v_mfma_f32_16x16x32_bf16 v[124:127], a[28:31], v[180:183], v[124:127]
    ds_read_b64_tr_b16 a[46:47], v231 offset:8704
    buffer_load_dwordx4 v235, s[48:51], s33 offen offset:1024 lds
    v_mfma_f32_16x16x32_bf16 v[128:131], a[16:19], v[184:187], v[128:131]
    s_add_u32 m0, s35, 4096
    s_add_u32 s33, s33, 131072
    buffer_load_dwordx4 v234, s[48:51], s33 offen lds
    v_mfma_f32_16x16x32_bf16 v[132:135], a[20:23], v[184:187], v[132:135]
    buffer_load_dwordx4 v235, s[48:51], s33 offen offset:1024 lds
    v_mfma_f32_16x16x32_bf16 v[136:139], a[24:27], v[184:187], v[136:139]
    s_add_u32 m0, s35, 6144
    s_add_u32 s33, s33, 131072
    buffer_load_dwordx4 v234, s[48:51], s33 offen lds
    v_mfma_f32_16x16x32_bf16 v[140:143], a[28:31], v[184:187], v[140:143]
    buffer_load_dwordx4 v235, s[48:51], s33 offen offset:1024 lds
    v_mfma_f32_16x16x32_bf16 v[144:147], a[16:19], v[188:191], v[144:147]
    v_mfma_f32_16x16x32_bf16 v[148:151], a[20:23], v[188:191], v[148:151]
    v_mfma_f32_16x16x32_bf16 v[152:155], a[24:27], v[188:191], v[152:155]
    v_mfma_f32_16x16x32_bf16 v[156:159], a[28:31], v[188:191], v[156:159]
    s_waitcnt lgkmcnt(0)
    v_mfma_f32_16x16x32_bf16 v[96:99], a[32:35], v[160:163], v[96:99]
    ds_read_b128 v[176:179], v225 offset:8192
    ds_read_b128 v[180:183], v225 offset:10240
    v_mfma_f32_16x16x32_bf16 v[100:103], a[36:39], v[160:163], v[100:103]
    ds_read_b128 v[184:187], v225 offset:12288
    v_mfma_f32_16x16x32_bf16 v[104:107], a[40:43], v[160:163], v[104:107]
    ds_read_b128 v[188:191], v225 offset:14336
    ds_read_b64_tr_b16 a[48:49], v228 offset:12288
    v_mfma_f32_16x16x32_bf16 v[108:111], a[44:47], v[160:163], v[108:111]
    ds_read_b64_tr_b16 a[50:51], v228 offset:12800
    v_mfma_f32_16x16x32_bf16 v[112:115], a[32:35], v[164:167], v[112:115]
    ds_read_b64_tr_b16 a[52:53], v229 offset:12288
    ds_read_b64_tr_b16 a[54:55], v229 offset:12800
    v_mfma_f32_16x16x32_bf16 v[116:119], a[36:39], v[164:167], v[116:119]
    ds_read_b64_tr_b16 a[56:57], v230 offset:12288
    s_add_u32 m0, s34, 32768
    s_add_u32 s37, s84, 0
    buffer_load_dwordx4 v232, s[44:47], s37 offen lds
    v_mfma_f32_16x16x32_bf16 v[120:123], a[40:43], v[164:167], v[120:123]
    ds_read_b64_tr_b16 a[58:59], v230 offset:12800
    ds_read_b64_tr_b16 a[60:61], v231 offset:12288
    v_mfma_f32_16x16x32_bf16 v[124:127], a[44:47], v[164:167], v[124:127]
    ds_read_b64_tr_b16 a[62:63], v231 offset:12800
    buffer_load_dwordx4 v233, s[44:47], s37 offen offset:1024 lds
    v_mfma_f32_16x16x32_bf16 v[128:131], a[32:35], v[168:171], v[128:131]
    v_mfma_f32_16x16x32_bf16 v[132:135], a[36:39], v[168:171], v[132:135]
    s_add_u32 m0, s34, 40960
    s_add_u32 s37, s85, 0
    buffer_load_dwordx4 v232, s[44:47], s37 offen lds
    v_mfma_f32_16x16x32_bf16 v[136:139], a[40:43], v[168:171], v[136:139]
    v_mfma_f32_16x16x32_bf16 v[140:143], a[44:47], v[168:171], v[140:143]
    buffer_load_dwordx4 v233, s[44:47], s37 offen offset:1024 lds
    v_mfma_f32_16x16x32_bf16 v[144:147], a[32:35], v[172:175], v[144:147]
    v_mfma_f32_16x16x32_bf16 v[148:151], a[36:39], v[172:175], v[148:151]
    v_mfma_f32_16x16x32_bf16 v[152:155], a[40:43], v[172:175], v[152:155]
    v_mfma_f32_16x16x32_bf16 v[156:159], a[44:47], v[172:175], v[156:159]
    s_waitcnt vmcnt(12) lgkmcnt(0)
    s_barrier
    v_mfma_f32_16x16x32_bf16 v[96:99], a[48:51], v[176:179], v[96:99]
    ds_read_b128 v[160:163], v224 offset:16384
    ds_read_b128 v[164:167], v224 offset:18432
    v_mfma_f32_16x16x32_bf16 v[100:103], a[52:55], v[176:179], v[100:103]
    ds_read_b128 v[168:171], v224 offset:20480
    v_mfma_f32_16x16x32_bf16 v[104:107], a[56:59], v[176:179], v[104:107]
    ds_read_b128 v[172:175], v224 offset:22528
    ds_read_b64_tr_b16 a[64:65], v228 offset:16384
    v_mfma_f32_16x16x32_bf16 v[108:111], a[60:63], v[176:179], v[108:111]
    ds_read_b64_tr_b16 a[66:67], v228 offset:16896
    v_mfma_f32_16x16x32_bf16 v[112:115], a[48:51], v[180:183], v[112:115]
    ds_read_b64_tr_b16 a[68:69], v229 offset:16384
    ds_read_b64_tr_b16 a[70:71], v229 offset:16896
    s_add_u32 m0, s35, 8192
    s_and_b32 s33, s84, 1023
    s_lshl_b32 s33, s33, 12
    buffer_load_dwordx4 v234, s[48:51], s33 offen lds
    v_mfma_f32_16x16x32_bf16 v[116:119], a[52:55], v[180:183], v[116:119]
    ds_read_b64_tr_b16 a[72:73], v230 offset:16384
    buffer_load_dwordx4 v235, s[48:51], s33 offen offset:1024 lds
    v_mfma_f32_16x16x32_bf16 v[120:123], a[56:59], v[180:183], v[120:123]
    ds_read_b64_tr_b16 a[74:75], v230 offset:16896
    ds_read_b64_tr_b16 a[76:77], v231 offset:16384
    s_add_u32 m0, s35, 10240
    s_add_u32 s33, s33, 131072
    buffer_load_dwordx4 v234, s[48:51], s33 offen lds
    v_mfma_f32_16x16x32_bf16 v[124:127], a[60:63], v[180:183], v[124:127]
    ds_read_b64_tr_b16 a[78:79], v231 offset:16896
    buffer_load_dwordx4 v235, s[48:51], s33 offen offset:1024 lds
    v_mfma_f32_16x16x32_bf16 v[128:131], a[48:51], v[184:187], v[128:131]
    s_add_u32 m0, s35, 12288
    s_add_u32 s33, s33, 131072
    buffer_load_dwordx4 v234, s[48:51], s33 offen lds
    v_mfma_f32_16x16x32_bf16 v[132:135], a[52:55], v[184:187], v[132:135]
    buffer_load_dwordx4 v235, s[48:51], s33 offen offset:1024 lds
    v_mfma_f32_16x16x32_bf16 v[136:139], a[56:59], v[184:187], v[136:139]
    s_add_u32 m0, s35, 14336
    s_add_u32 s33, s33, 131072
    buffer_load_dwordx4 v234, s[48:51], s33 offen lds
    v_mfma_f32_16x16x32_bf16 v[140:143], a[60:63], v[184:187], v[140:143]
    buffer_load_dwordx4 v235, s[48:51], s33 offen offset:1024 lds
    v_mfma_f32_16x16x32_bf16 v[144:147], a[48:51], v[188:191], v[144:147]
    v_mfma_f32_16x16x32_bf16 v[148:151], a[52:55], v[188:191], v[148:151]
    v_mfma_f32_16x16x32_bf16 v[152:155], a[56:59], v[188:191], v[152:155]
    v_mfma_f32_16x16x32_bf16 v[156:159], a[60:63], v[188:191], v[156:159]
    s_waitcnt lgkmcnt(0)
    v_mfma_f32_16x16x32_bf16 v[96:99], a[64:67], v[160:163], v[96:99]
    ds_read_b128 v[176:179], v225 offset:16384
    ds_read_b128 v[180:183], v225 offset:18432
    v_mfma_f32_16x16x32_bf16 v[100:103], a[68:71], v[160:163], v[100:103]
    ds_read_b128 v[184:187], v225 offset:20480
    v_mfma_f32_16x16x32_bf16 v[104:107], a[72:75], v[160:163], v[104:107]
    ds_read_b128 v[188:191], v225 offset:22528
    ds_read_b64_tr_b16 a[80:81], v228 offset:20480
    v_mfma_f32_16x16x32_bf16 v[108:111], a[76:79], v[160:163], v[108:111]
    ds_read_b64_tr_b16 a[82:83], v228 offset:20992
    v_mfma_f32_16x16x32_bf16 v[112:115], a[64:67], v[164:167], v[112:115]
    ds_read_b64_tr_b16 a[84:85], v229 offset:20480
    ds_read_b64_tr_b16 a[86:87], v229 offset:20992
    v_mfma_f32_16x16x32_bf16 v[116:119], a[68:71], v[164:167], v[116:119]
    ds_read_b64_tr_b16 a[88:89], v230 offset:20480
    s_add_u32 m0, s34, 49152
    s_add_u32 s37, s86, 0
    buffer_load_dwordx4 v232, s[44:47], s37 offen lds
    v_mfma_f32_16x16x32_bf16 v[120:123], a[72:75], v[164:167], v[120:123]
    ds_read_b64_tr_b16 a[90:91], v230 offset:20992
    ds_read_b64_tr_b16 a[92:93], v231 offset:20480
    v_mfma_f32_16x16x32_bf16 v[124:127], a[76:79], v[164:167], v[124:127]
    ds_read_b64_tr_b16 a[94:95], v231 offset:20992
    buffer_load_dwordx4 v233, s[44:47], s37 offen offset:1024 lds
    v_mfma_f32_16x16x32_bf16 v[128:131], a[64:67], v[168:171], v[128:131]
    v_mfma_f32_16x16x32_bf16 v[132:135], a[68:71], v[168:171], v[132:135]
    s_add_u32 m0, s34, 57344
    s_add_u32 s37, s87, 0
    buffer_load_dwordx4 v232, s[44:47], s37 offen lds
    v_mfma_f32_16x16x32_bf16 v[136:139], a[72:75], v[168:171], v[136:139]
    v_mfma_f32_16x16x32_bf16 v[140:143], a[76:79], v[168:171], v[140:143]
    buffer_load_dwordx4 v233, s[44:47], s37 offen offset:1024 lds
    v_mfma_f32_16x16x32_bf16 v[144:147], a[64:67], v[172:175], v[144:147]
    v_mfma_f32_16x16x32_bf16 v[148:151], a[68:71], v[172:175], v[148:151]
    v_mfma_f32_16x16x32_bf16 v[152:155], a[72:75], v[172:175], v[152:155]
    v_mfma_f32_16x16x32_bf16 v[156:159], a[76:79], v[172:175], v[156:159]
    s_waitcnt vmcnt(16) lgkmcnt(0)
    v_mfma_f32_16x16x32_bf16 v[96:99], a[80:83], v[176:179], v[96:99]
    ds_read_b128 v[160:163], v224 offset:24576
    ds_read_b128 v[164:167], v224 offset:26624
    v_mfma_f32_16x16x32_bf16 v[100:103], a[84:87], v[176:179], v[100:103]
    ds_read_b128 v[168:171], v224 offset:28672
    v_mfma_f32_16x16x32_bf16 v[104:107], a[88:91], v[176:179], v[104:107]
    ds_read_b128 v[172:175], v224 offset:30720
    ds_read_b64_tr_b16 a[96:97], v228 offset:0
    v_mfma_f32_16x16x32_bf16 v[108:111], a[92:95], v[176:179], v[108:111]
    ds_read_b64_tr_b16 a[98:99], v228 offset:512
    v_mfma_f32_16x16x32_bf16 v[112:115], a[80:83], v[180:183], v[112:115]
    ds_read_b64_tr_b16 a[100:101], v229 offset:0
    ds_read_b64_tr_b16 a[102:103], v229 offset:512
    s_add_u32 m0, s35, 16384
    s_and_b32 s33, s85, 1023
    s_lshl_b32 s33, s33, 12
    buffer_load_dwordx4 v234, s[48:51], s33 offen lds
    v_mfma_f32_16x16x32_bf16 v[116:119], a[84:87], v[180:183], v[116:119]
    ds_read_b64_tr_b16 a[104:105], v230 offset:0
    buffer_load_dwordx4 v235, s[48:51], s33 offen offset:1024 lds
    v_mfma_f32_16x16x32_bf16 v[120:123], a[88:91], v[180:183], v[120:123]
    ds_read_b64_tr_b16 a[106:107], v230 offset:512
    ds_read_b64_tr_b16 a[108:109], v231 offset:0
    s_add_u32 m0, s35, 18432
    s_add_u32 s33, s33, 131072
    buffer_load_dwordx4 v234, s[48:51], s33 offen lds
    v_mfma_f32_16x16x32_bf16 v[124:127], a[92:95], v[180:183], v[124:127]
    ds_read_b64_tr_b16 a[110:111], v231 offset:512
    buffer_load_dwordx4 v235, s[48:51], s33 offen offset:1024 lds
    v_mfma_f32_16x16x32_bf16 v[128:131], a[80:83], v[184:187], v[128:131]
    s_add_u32 m0, s35, 20480
    s_add_u32 s33, s33, 131072
    buffer_load_dwordx4 v234, s[48:51], s33 offen lds
    v_mfma_f32_16x16x32_bf16 v[132:135], a[84:87], v[184:187], v[132:135]
    buffer_load_dwordx4 v235, s[48:51], s33 offen offset:1024 lds
    v_mfma_f32_16x16x32_bf16 v[136:139], a[88:91], v[184:187], v[136:139]
    s_add_u32 m0, s35, 22528
    s_add_u32 s33, s33, 131072
    buffer_load_dwordx4 v234, s[48:51], s33 offen lds
    v_mfma_f32_16x16x32_bf16 v[140:143], a[92:95], v[184:187], v[140:143]
    buffer_load_dwordx4 v235, s[48:51], s33 offen offset:1024 lds
    v_mfma_f32_16x16x32_bf16 v[144:147], a[80:83], v[188:191], v[144:147]
    v_mfma_f32_16x16x32_bf16 v[148:151], a[84:87], v[188:191], v[148:151]
    v_mfma_f32_16x16x32_bf16 v[152:155], a[88:91], v[188:191], v[152:155]
    v_mfma_f32_16x16x32_bf16 v[156:159], a[92:95], v[188:191], v[156:159]
    s_waitcnt lgkmcnt(0)
    v_mfma_f32_16x16x32_bf16 v[96:99], a[96:99], v[160:163], v[96:99]
    ds_read_b128 v[176:179], v225 offset:24576
    ds_read_b128 v[180:183], v225 offset:26624
    v_mfma_f32_16x16x32_bf16 v[100:103], a[100:103], v[160:163], v[100:103]
    ds_read_b128 v[184:187], v225 offset:28672
    v_mfma_f32_16x16x32_bf16 v[104:107], a[104:107], v[160:163], v[104:107]
    ds_read_b128 v[188:191], v225 offset:30720
    ds_read_b64_tr_b16 a[112:113], v228 offset:4096
    v_mfma_f32_16x16x32_bf16 v[108:111], a[108:111], v[160:163], v[108:111]
    ds_read_b64_tr_b16 a[114:115], v228 offset:4608
    v_mfma_f32_16x16x32_bf16 v[112:115], a[96:99], v[164:167], v[112:115]
    ds_read_b64_tr_b16 a[116:117], v229 offset:4096
    ds_read_b64_tr_b16 a[118:119], v229 offset:4608
    v_mfma_f32_16x16x32_bf16 v[116:119], a[100:103], v[164:167], v[116:119]
    ds_read_b64_tr_b16 a[120:121], v230 offset:4096
    v_mfma_f32_16x16x32_bf16 v[120:123], a[104:107], v[164:167], v[120:123]
    ds_read_b64_tr_b16 a[122:123], v230 offset:4608
    ds_read_b64_tr_b16 a[124:125], v231 offset:4096
    v_mfma_f32_16x16x32_bf16 v[124:127], a[108:111], v[164:167], v[124:127]
    ds_read_b64_tr_b16 a[126:127], v231 offset:4608
    v_mfma_f32_16x16x32_bf16 v[128:131], a[96:99], v[168:171], v[128:131]
    v_mfma_f32_16x16x32_bf16 v[132:135], a[100:103], v[168:171], v[132:135]
    v_mfma_f32_16x16x32_bf16 v[136:139], a[104:107], v[168:171], v[136:139]
    v_mfma_f32_16x16x32_bf16 v[140:143], a[108:111], v[168:171], v[140:143]
    v_mfma_f32_16x16x32_bf16 v[144:147], a[96:99], v[172:175], v[144:147]
    v_mfma_f32_16x16x32_bf16 v[148:151], a[100:103], v[172:175], v[148:151]
    v_mfma_f32_16x16x32_bf16 v[152:155], a[104:107], v[172:175], v[152:155]
    v_mfma_f32_16x16x32_bf16 v[156:159], a[108:111], v[172:175], v[156:159]
    s_waitcnt vmcnt(12) lgkmcnt(0)
    s_barrier
    v_mfma_f32_16x16x32_bf16 v[96:99], a[112:115], v[176:179], v[96:99]
    ds_read_b128 v[160:163], v224 offset:32768
    ds_read_b128 v[164:167], v224 offset:34816
    v_mfma_f32_16x16x32_bf16 v[100:103], a[116:119], v[176:179], v[100:103]
    ds_read_b128 v[168:171], v224 offset:36864
    v_mfma_f32_16x16x32_bf16 v[104:107], a[120:123], v[176:179], v[104:107]
    ds_read_b128 v[172:175], v224 offset:38912
    ds_read_b64_tr_b16 a[128:129], v228 offset:8192
    v_mfma_f32_16x16x32_bf16 v[108:111], a[124:127], v[176:179], v[108:111]
    ds_read_b64_tr_b16 a[130:131], v228 offset:8704
    v_mfma_f32_16x16x32_bf16 v[112:115], a[112:115], v[180:183], v[112:115]
    ds_read_b64_tr_b16 a[132:133], v229 offset:8192
    ds_read_b64_tr_b16 a[134:135], v229 offset:8704
    s_add_u32 m0, s35, 0
    s_and_b32 s33, s86, 1023
    s_lshl_b32 s33, s33, 12
    buffer_load_dwordx4 v234, s[48:51], s33 offen lds
    v_mfma_f32_16x16x32_bf16 v[116:119], a[116:119], v[180:183], v[116:119]
    ds_read_b64_tr_b16 a[136:137], v230 offset:8192
    buffer_load_dwordx4 v235, s[48:51], s33 offen offset:1024 lds
    v_mfma_f32_16x16x32_bf16 v[120:123], a[120:123], v[180:183], v[120:123]
    ds_read_b64_tr_b16 a[138:139], v230 offset:8704
    ds_read_b64_tr_b16 a[140:141], v231 offset:8192
    s_add_u32 m0, s35, 2048
    s_add_u32 s33, s33, 131072
    buffer_load_dwordx4 v234, s[48:51], s33 offen lds
    v_mfma_f32_16x16x32_bf16 v[124:127], a[124:127], v[180:183], v[124:127]
    ds_read_b64_tr_b16 a[142:143], v231 offset:8704
    buffer_load_dwordx4 v235, s[48:51], s33 offen offset:1024 lds
    v_mfma_f32_16x16x32_bf16 v[128:131], a[112:115], v[184:187], v[128:131]
    s_add_u32 m0, s35, 4096
    s_add_u32 s33, s33, 131072
    buffer_load_dwordx4 v234, s[48:51], s33 offen lds
    v_mfma_f32_16x16x32_bf16 v[132:135], a[116:119], v[184:187], v[132:135]
    buffer_load_dwordx4 v235, s[48:51], s33 offen offset:1024 lds
    v_mfma_f32_16x16x32_bf16 v[136:139], a[120:123], v[184:187], v[136:139]
    s_add_u32 m0, s35, 6144
    s_add_u32 s33, s33, 131072
    buffer_load_dwordx4 v234, s[48:51], s33 offen lds
    v_mfma_f32_16x16x32_bf16 v[140:143], a[124:127], v[184:187], v[140:143]
    buffer_load_dwordx4 v235, s[48:51], s33 offen offset:1024 lds
    v_mfma_f32_16x16x32_bf16 v[144:147], a[112:115], v[188:191], v[144:147]
    v_mfma_f32_16x16x32_bf16 v[148:151], a[116:119], v[188:191], v[148:151]
    v_mfma_f32_16x16x32_bf16 v[152:155], a[120:123], v[188:191], v[152:155]
    v_mfma_f32_16x16x32_bf16 v[156:159], a[124:127], v[188:191], v[156:159]
    s_waitcnt lgkmcnt(0)
    v_mfma_f32_16x16x32_bf16 v[96:99], a[128:131], v[160:163], v[96:99]
    ds_read_b128 v[176:179], v225 offset:32768
    ds_read_b128 v[180:183], v225 offset:34816
    v_mfma_f32_16x16x32_bf16 v[100:103], a[132:135], v[160:163], v[100:103]
    ds_read_b128 v[184:187], v225 offset:36864
    v_mfma_f32_16x16x32_bf16 v[104:107], a[136:139], v[160:163], v[104:107]
    ds_read_b128 v[188:191], v225 offset:38912
    ds_read_b64_tr_b16 a[144:145], v228 offset:12288
    v_mfma_f32_16x16x32_bf16 v[108:111], a[140:143], v[160:163], v[108:111]
    ds_read_b64_tr_b16 a[146:147], v228 offset:12800
    v_mfma_f32_16x16x32_bf16 v[112:115], a[128:131], v[164:167], v[112:115]
    ds_read_b64_tr_b16 a[148:149], v229 offset:12288
    ds_read_b64_tr_b16 a[150:151], v229 offset:12800
    v_mfma_f32_16x16x32_bf16 v[116:119], a[132:135], v[164:167], v[116:119]
    ds_read_b64_tr_b16 a[152:153], v230 offset:12288
    s_add_u32 m0, s34, 0
    s_add_u32 s37, s80, 65536
    buffer_load_dwordx4 v232, s[44:47], s37 offen lds
    v_mfma_f32_16x16x32_bf16 v[120:123], a[136:139], v[164:167], v[120:123]
    ds_read_b64_tr_b16 a[154:155], v230 offset:12800
    ds_read_b64_tr_b16 a[156:157], v231 offset:12288
    v_mfma_f32_16x16x32_bf16 v[124:127], a[140:143], v[164:167], v[124:127]
    ds_read_b64_tr_b16 a[158:159], v231 offset:12800
    buffer_load_dwordx4 v233, s[44:47], s37 offen offset:1024 lds
    v_mfma_f32_16x16x32_bf16 v[128:131], a[128:131], v[168:171], v[128:131]
    v_mfma_f32_16x16x32_bf16 v[132:135], a[132:135], v[168:171], v[132:135]
    s_add_u32 m0, s34, 8192
    s_add_u32 s37, s81, 65536
    buffer_load_dwordx4 v232, s[44:47], s37 offen lds
    v_mfma_f32_16x16x32_bf16 v[136:139], a[136:139], v[168:171], v[136:139]
    v_mfma_f32_16x16x32_bf16 v[140:143], a[140:143], v[168:171], v[140:143]
    buffer_load_dwordx4 v233, s[44:47], s37 offen offset:1024 lds
    v_mfma_f32_16x16x32_bf16 v[144:147], a[128:131], v[172:175], v[144:147]
    v_mfma_f32_16x16x32_bf16 v[148:151], a[132:135], v[172:175], v[148:151]
    v_mfma_f32_16x16x32_bf16 v[152:155], a[136:139], v[172:175], v[152:155]
    v_mfma_f32_16x16x32_bf16 v[156:159], a[140:143], v[172:175], v[156:159]
    s_waitcnt vmcnt(12) lgkmcnt(0)
    v_mfma_f32_16x16x32_bf16 v[96:99], a[144:147], v[176:179], v[96:99]
    ds_read_b128 v[160:163], v224 offset:40960
    ds_read_b128 v[164:167], v224 offset:43008
    v_mfma_f32_16x16x32_bf16 v[100:103], a[148:151], v[176:179], v[100:103]
    ds_read_b128 v[168:171], v224 offset:45056
    v_mfma_f32_16x16x32_bf16 v[104:107], a[152:155], v[176:179], v[104:107]
    ds_read_b128 v[172:175], v224 offset:47104
    ds_read_b64_tr_b16 a[160:161], v228 offset:16384
    v_mfma_f32_16x16x32_bf16 v[108:111], a[156:159], v[176:179], v[108:111]
    ds_read_b64_tr_b16 a[162:163], v228 offset:16896
    v_mfma_f32_16x16x32_bf16 v[112:115], a[144:147], v[180:183], v[112:115]
    ds_read_b64_tr_b16 a[164:165], v229 offset:16384
    ds_read_b64_tr_b16 a[166:167], v229 offset:16896
    s_add_u32 m0, s35, 8192
    s_and_b32 s33, s87, 1023
    s_lshl_b32 s33, s33, 12
    buffer_load_dwordx4 v234, s[48:51], s33 offen lds
    v_mfma_f32_16x16x32_bf16 v[116:119], a[148:151], v[180:183], v[116:119]
    ds_read_b64_tr_b16 a[168:169], v230 offset:16384
    buffer_load_dwordx4 v235, s[48:51], s33 offen offset:1024 lds
    v_mfma_f32_16x16x32_bf16 v[120:123], a[152:155], v[180:183], v[120:123]
    ds_read_b64_tr_b16 a[170:171], v230 offset:16896
    ds_read_b64_tr_b16 a[172:173], v231 offset:16384
    s_add_u32 m0, s35, 10240
    s_add_u32 s33, s33, 131072
    buffer_load_dwordx4 v234, s[48:51], s33 offen lds
    v_mfma_f32_16x16x32_bf16 v[124:127], a[156:159], v[180:183], v[124:127]
    ds_read_b64_tr_b16 a[174:175], v231 offset:16896
    buffer_load_dwordx4 v235, s[48:51], s33 offen offset:1024 lds
    v_mfma_f32_16x16x32_bf16 v[128:131], a[144:147], v[184:187], v[128:131]
    s_add_u32 m0, s35, 12288
    s_add_u32 s33, s33, 131072
    buffer_load_dwordx4 v234, s[48:51], s33 offen lds
    v_mfma_f32_16x16x32_bf16 v[132:135], a[148:151], v[184:187], v[132:135]
    buffer_load_dwordx4 v235, s[48:51], s33 offen offset:1024 lds
    v_mfma_f32_16x16x32_bf16 v[136:139], a[152:155], v[184:187], v[136:139]
    s_add_u32 m0, s35, 14336
    s_add_u32 s33, s33, 131072
    buffer_load_dwordx4 v234, s[48:51], s33 offen lds
    v_mfma_f32_16x16x32_bf16 v[140:143], a[156:159], v[184:187], v[140:143]
    buffer_load_dwordx4 v235, s[48:51], s33 offen offset:1024 lds
    v_mfma_f32_16x16x32_bf16 v[144:147], a[144:147], v[188:191], v[144:147]
    v_mfma_f32_16x16x32_bf16 v[148:151], a[148:151], v[188:191], v[148:151]
    v_mfma_f32_16x16x32_bf16 v[152:155], a[152:155], v[188:191], v[152:155]
    v_mfma_f32_16x16x32_bf16 v[156:159], a[156:159], v[188:191], v[156:159]
    s_waitcnt lgkmcnt(0)
    v_mfma_f32_16x16x32_bf16 v[96:99], a[160:163], v[160:163], v[96:99]
    ds_read_b128 v[176:179], v225 offset:40960
    ds_read_b128 v[180:183], v225 offset:43008
    v_mfma_f32_16x16x32_bf16 v[100:103], a[164:167], v[160:163], v[100:103]
    ds_read_b128 v[184:187], v225 offset:45056
    v_mfma_f32_16x16x32_bf16 v[104:107], a[168:171], v[160:163], v[104:107]
    ds_read_b128 v[188:191], v225 offset:47104
    ds_read_b64_tr_b16 a[176:177], v228 offset:20480
    v_mfma_f32_16x16x32_bf16 v[108:111], a[172:175], v[160:163], v[108:111]
    ds_read_b64_tr_b16 a[178:179], v228 offset:20992
    v_mfma_f32_16x16x32_bf16 v[112:115], a[160:163], v[164:167], v[112:115]
    ds_read_b64_tr_b16 a[180:181], v229 offset:20480
    ds_read_b64_tr_b16 a[182:183], v229 offset:20992
    s_add_u32 m0, s34, 16384
    s_add_u32 s37, s82, 65536
    buffer_load_dwordx4 v232, s[44:47], s37 offen lds
    v_mfma_f32_16x16x32_bf16 v[116:119], a[164:167], v[164:167], v[116:119]
    ds_read_b64_tr_b16 a[184:185], v230 offset:20480
    buffer_load_dwordx4 v233, s[44:47], s37 offen offset:1024 lds
    v_mfma_f32_16x16x32_bf16 v[120:123], a[168:171], v[164:167], v[120:123]
    ds_read_b64_tr_b16 a[186:187], v230 offset:20992
    ds_read_b64_tr_b16 a[188:189], v231 offset:20480
    s_add_u32 m0, s34, 24576
    s_add_u32 s37, s83, 65536
    buffer_load_dwordx4 v232, s[44:47], s37 offen lds
    v_mfma_f32_16x16x32_bf16 v[124:127], a[172:175], v[164:167], v[124:127]
    ds_read_b64_tr_b16 a[190:191], v231 offset:20992
    buffer_load_dwordx4 v233, s[44:47], s37 offen offset:1024 lds
    v_mfma_f32_16x16x32_bf16 v[128:131], a[160:163], v[168:171], v[128:131]
    buffer_load_dwordx4 v[0:3], v236, s[52:55], 0 offen offset:0
    v_mfma_f32_16x16x32_bf16 v[132:135], a[164:167], v[168:171], v[132:135]
    buffer_load_dwordx4 v[4:7], v236, s[52:55], 0 offen offset:512
    v_mfma_f32_16x16x32_bf16 v[136:139], a[168:171], v[168:171], v[136:139]
    buffer_load_dwordx4 v[8:11], v236, s[52:55], 0 offen offset:1024
    v_mfma_f32_16x16x32_bf16 v[140:143], a[172:175], v[168:171], v[140:143]
    buffer_load_dwordx4 v[12:15], v236, s[52:55], 0 offen offset:1536
    v_mfma_f32_16x16x32_bf16 v[144:147], a[160:163], v[172:175], v[144:147]
    v_mfma_f32_16x16x32_bf16 v[148:151], a[164:167], v[172:175], v[148:151]
    v_mfma_f32_16x16x32_bf16 v[152:155], a[168:171], v[172:175], v[152:155]
    v_mfma_f32_16x16x32_bf16 v[156:159], a[172:175], v[172:175], v[156:159]
    s_waitcnt vmcnt(20) lgkmcnt(0)
    s_barrier
    v_mfma_f32_16x16x32_bf16 v[96:99], a[176:179], v[176:179], v[96:99]
    ds_read_b128 v[160:163], v224 offset:49152
    ds_read_b128 v[164:167], v224 offset:51200
    v_mfma_f32_16x16x32_bf16 v[100:103], a[180:183], v[176:179], v[100:103]
    ds_read_b128 v[168:171], v224 offset:53248
    v_mfma_f32_16x16x32_bf16 v[104:107], a[184:187], v[176:179], v[104:107]
    ds_read_b128 v[172:175], v224 offset:55296
    ds_read_b64_tr_b16 a[192:193], v228 offset:0
    v_mfma_f32_16x16x32_bf16 v[108:111], a[188:191], v[176:179], v[108:111]
    ds_read_b64_tr_b16 a[194:195], v228 offset:512
    v_mfma_f32_16x16x32_bf16 v[112:115], a[176:179], v[180:183], v[112:115]
    ds_read_b64_tr_b16 a[196:197], v229 offset:0
    ds_read_b64_tr_b16 a[198:199], v229 offset:512
    v_mfma_f32_16x16x32_bf16 v[116:119], a[180:183], v[180:183], v[116:119]
    ds_read_b64_tr_b16 a[200:201], v230 offset:0
    v_mfma_f32_16x16x32_bf16 v[120:123], a[184:187], v[180:183], v[120:123]
    ds_read_b64_tr_b16 a[202:203], v230 offset:512
    ds_read_b64_tr_b16 a[204:205], v231 offset:0
    v_mfma_f32_16x16x32_bf16 v[124:127], a[188:191], v[180:183], v[124:127]
    ds_read_b64_tr_b16 a[206:207], v231 offset:512
    v_mfma_f32_16x16x32_bf16 v[128:131], a[176:179], v[184:187], v[128:131]
    v_mfma_f32_16x16x32_bf16 v[132:135], a[180:183], v[184:187], v[132:135]
    v_mfma_f32_16x16x32_bf16 v[136:139], a[184:187], v[184:187], v[136:139]
    v_mfma_f32_16x16x32_bf16 v[140:143], a[188:191], v[184:187], v[140:143]
    v_mfma_f32_16x16x32_bf16 v[144:147], a[176:179], v[188:191], v[144:147]
    v_mfma_f32_16x16x32_bf16 v[148:151], a[180:183], v[188:191], v[148:151]
    v_mfma_f32_16x16x32_bf16 v[152:155], a[184:187], v[188:191], v[152:155]
    v_mfma_f32_16x16x32_bf16 v[156:159], a[188:191], v[188:191], v[156:159]
    s_waitcnt lgkmcnt(0)
    v_mfma_f32_16x16x32_bf16 v[96:99], a[192:195], v[160:163], v[96:99]
    ds_read_b128 v[176:179], v225 offset:49152
    ds_read_b128 v[180:183], v225 offset:51200
    v_mfma_f32_16x16x32_bf16 v[100:103], a[196:199], v[160:163], v[100:103]
    ds_read_b128 v[184:187], v225 offset:53248
    v_mfma_f32_16x16x32_bf16 v[104:107], a[200:203], v[160:163], v[104:107]
    ds_read_b128 v[188:191], v225 offset:55296
    ds_read_b64_tr_b16 a[208:209], v228 offset:4096
    v_mfma_f32_16x16x32_bf16 v[108:111], a[204:207], v[160:163], v[108:111]
    ds_read_b64_tr_b16 a[210:211], v228 offset:4608
    v_mfma_f32_16x16x32_bf16 v[112:115], a[192:195], v[164:167], v[112:115]
    ds_read_b64_tr_b16 a[212:213], v229 offset:4096
    ds_read_b64_tr_b16 a[214:215], v229 offset:4608
    v_mfma_f32_16x16x32_bf16 v[116:119], a[196:199], v[164:167], v[116:119]
    ds_read_b64_tr_b16 a[216:217], v230 offset:4096
    s_add_u32 m0, s34, 32768
    s_add_u32 s37, s84, 65536
    buffer_load_dwordx4 v232, s[44:47], s37 offen lds
    v_mfma_f32_16x16x32_bf16 v[120:123], a[200:203], v[164:167], v[120:123]
    ds_read_b64_tr_b16 a[218:219], v230 offset:4608
    ds_read_b64_tr_b16 a[220:221], v231 offset:4096
    v_mfma_f32_16x16x32_bf16 v[124:127], a[204:207], v[164:167], v[124:127]
    ds_read_b64_tr_b16 a[222:223], v231 offset:4608
    buffer_load_dwordx4 v233, s[44:47], s37 offen offset:1024 lds
    v_mfma_f32_16x16x32_bf16 v[128:131], a[192:195], v[168:171], v[128:131]
    v_mfma_f32_16x16x32_bf16 v[132:135], a[196:199], v[168:171], v[132:135]
    s_add_u32 m0, s34, 40960
    s_add_u32 s37, s85, 65536
    buffer_load_dwordx4 v232, s[44:47], s37 offen lds
    v_mfma_f32_16x16x32_bf16 v[136:139], a[200:203], v[168:171], v[136:139]
    v_mfma_f32_16x16x32_bf16 v[140:143], a[204:207], v[168:171], v[140:143]
    buffer_load_dwordx4 v233, s[44:47], s37 offen offset:1024 lds
    v_mfma_f32_16x16x32_bf16 v[144:147], a[192:195], v[172:175], v[144:147]
    v_mfma_f32_16x16x32_bf16 v[148:151], a[196:199], v[172:175], v[148:151]
    v_mfma_f32_16x16x32_bf16 v[152:155], a[200:203], v[172:175], v[152:155]
    v_mfma_f32_16x16x32_bf16 v[156:159], a[204:207], v[172:175], v[156:159]
    s_waitcnt vmcnt(12) lgkmcnt(0)
    v_mfma_f32_16x16x32_bf16 v[96:99], a[208:211], v[176:179], v[96:99]
    ds_read_b128 v[160:163], v224 offset:57344
    ds_read_b128 v[164:167], v224 offset:59392
    v_mfma_f32_16x16x32_bf16 v[100:103], a[212:215], v[176:179], v[100:103]
    ds_read_b128 v[168:171], v224 offset:61440
    v_mfma_f32_16x16x32_bf16 v[104:107], a[216:219], v[176:179], v[104:107]
    ds_read_b128 v[172:175], v224 offset:63488
    ds_read_b64_tr_b16 a[224:225], v228 offset:8192
    v_mfma_f32_16x16x32_bf16 v[108:111], a[220:223], v[176:179], v[108:111]
    ds_read_b64_tr_b16 a[226:227], v228 offset:8704
    v_mfma_f32_16x16x32_bf16 v[112:115], a[208:211], v[180:183], v[112:115]
    ds_read_b64_tr_b16 a[228:229], v229 offset:8192
    ds_read_b64_tr_b16 a[230:231], v229 offset:8704
    v_mfma_f32_16x16x32_bf16 v[116:119], a[212:215], v[180:183], v[116:119]
    ds_read_b64_tr_b16 a[232:233], v230 offset:8192
    v_mfma_f32_16x16x32_bf16 v[120:123], a[216:219], v[180:183], v[120:123]
    ds_read_b64_tr_b16 a[234:235], v230 offset:8704
    ds_read_b64_tr_b16 a[236:237], v231 offset:8192
    v_mfma_f32_16x16x32_bf16 v[124:127], a[220:223], v[180:183], v[124:127]
    ds_read_b64_tr_b16 a[238:239], v231 offset:8704
    v_mfma_f32_16x16x32_bf16 v[128:131], a[208:211], v[184:187], v[128:131]
    v_mfma_f32_16x16x32_bf16 v[132:135], a[212:215], v[184:187], v[132:135]
    v_mfma_f32_16x16x32_bf16 v[136:139], a[216:219], v[184:187], v[136:139]
    v_mfma_f32_16x16x32_bf16 v[140:143], a[220:223], v[184:187], v[140:143]
    v_mfma_f32_16x16x32_bf16 v[144:147], a[208:211], v[188:191], v[144:147]
    v_mfma_f32_16x16x32_bf16 v[148:151], a[212:215], v[188:191], v[148:151]
    v_mfma_f32_16x16x32_bf16 v[152:155], a[216:219], v[188:191], v[152:155]
    v_mfma_f32_16x16x32_bf16 v[156:159], a[220:223], v[188:191], v[156:159]
    s_waitcnt lgkmcnt(0)
    v_mfma_f32_16x16x32_bf16 v[96:99], a[224:227], v[160:163], v[96:99]
    ds_read_b128 v[176:179], v225 offset:57344
    ds_read_b128 v[180:183], v225 offset:59392
    v_mfma_f32_16x16x32_bf16 v[100:103], a[228:231], v[160:163], v[100:103]
    ds_read_b128 v[184:187], v225 offset:61440
    v_mfma_f32_16x16x32_bf16 v[104:107], a[232:235], v[160:163], v[104:107]
    ds_read_b128 v[188:191], v225 offset:63488
    ds_read_b64_tr_b16 a[240:241], v228 offset:12288
    v_mfma_f32_16x16x32_bf16 v[108:111], a[236:239], v[160:163], v[108:111]
    ds_read_b64_tr_b16 a[242:243], v228 offset:12800
    v_mfma_f32_16x16x32_bf16 v[112:115], a[224:227], v[164:167], v[112:115]
    ds_read_b64_tr_b16 a[244:245], v229 offset:12288
    ds_read_b64_tr_b16 a[246:247], v229 offset:12800
    v_mfma_f32_16x16x32_bf16 v[116:119], a[228:231], v[164:167], v[116:119]
    ds_read_b64_tr_b16 a[248:249], v230 offset:12288
    v_mfma_f32_16x16x32_bf16 v[120:123], a[232:235], v[164:167], v[120:123]
    ds_read_b64_tr_b16 a[250:251], v230 offset:12800
    ds_read_b64_tr_b16 a[252:253], v231 offset:12288
    v_mfma_f32_16x16x32_bf16 v[124:127], a[236:239], v[164:167], v[124:127]
    ds_read_b64_tr_b16 a[254:255], v231 offset:12800
    v_mfma_f32_16x16x32_bf16 v[128:131], a[224:227], v[168:171], v[128:131]
    v_mfma_f32_16x16x32_bf16 v[132:135], a[228:231], v[168:171], v[132:135]
    v_mfma_f32_16x16x32_bf16 v[136:139], a[232:235], v[168:171], v[136:139]
    v_mfma_f32_16x16x32_bf16 v[140:143], a[236:239], v[168:171], v[140:143]
    v_mfma_f32_16x16x32_bf16 v[144:147], a[224:227], v[172:175], v[144:147]
    v_mfma_f32_16x16x32_bf16 v[148:151], a[228:231], v[172:175], v[148:151]
    v_mfma_f32_16x16x32_bf16 v[152:155], a[232:235], v[172:175], v[152:155]
    v_mfma_f32_16x16x32_bf16 v[156:159], a[236:239], v[172:175], v[156:159]
    s_waitcnt vmcnt(20) lgkmcnt(0)
    s_barrier
    v_mfma_f32_16x16x32_bf16 v[96:99], a[240:243], v[176:179], v[96:99]
    ds_read_b128 v[160:163], v224 offset:0
    v_mfma_f32_16x16x32_bf16 v[100:103], a[244:247], v[176:179], v[100:103]
    ds_read_b128 v[164:167], v224 offset:2048
    v_mfma_f32_16x16x32_bf16 v[104:107], a[248:251], v[176:179], v[104:107]
    ds_read_b128 v[168:171], v224 offset:4096
    v_mfma_f32_16x16x32_bf16 v[108:111], a[252:255], v[176:179], v[108:111]
    ds_read_b128 v[172:175], v224 offset:6144
    v_mfma_f32_16x16x32_bf16 v[112:115], a[240:243], v[180:183], v[112:115]
    v_mfma_f32_16x16x32_bf16 v[116:119], a[244:247], v[180:183], v[116:119]
    s_add_u32 m0, s34, 49152
    s_add_u32 s37, s86, 65536
    buffer_load_dwordx4 v232, s[44:47], s37 offen lds
    v_mfma_f32_16x16x32_bf16 v[120:123], a[248:251], v[180:183], v[120:123]
    v_mfma_f32_16x16x32_bf16 v[124:127], a[252:255], v[180:183], v[124:127]
    buffer_load_dwordx4 v233, s[44:47], s37 offen offset:1024 lds
    v_mfma_f32_16x16x32_bf16 v[128:131], a[240:243], v[184:187], v[128:131]
    v_mfma_f32_16x16x32_bf16 v[132:135], a[244:247], v[184:187], v[132:135]
    s_add_u32 m0, s34, 57344
    s_add_u32 s37, s87, 65536
    buffer_load_dwordx4 v232, s[44:47], s37 offen lds
    v_cvt_pk_bf16_f32 v64, v96, v97
    v_cvt_pk_bf16_f32 v65, v98, v99
    v_mfma_f32_16x16x32_bf16 v[136:139], a[248:251], v[184:187], v[136:139]
    v_cvt_pk_bf16_f32 v66, v100, v101
    v_cvt_pk_bf16_f32 v67, v102, v103
    v_mfma_f32_16x16x32_bf16 v[140:143], a[252:255], v[184:187], v[140:143]
    buffer_load_dwordx4 v233, s[44:47], s37 offen offset:1024 lds
    v_cvt_pk_bf16_f32 v68, v104, v105
    v_cvt_pk_bf16_f32 v69, v106, v107
    v_mfma_f32_16x16x32_bf16 v[144:147], a[240:243], v[188:191], v[144:147]
    v_cvt_pk_bf16_f32 v70, v108, v109
    v_cvt_pk_bf16_f32 v71, v110, v111
    v_mfma_f32_16x16x32_bf16 v[148:151], a[244:247], v[188:191], v[148:151]
    v_cvt_pk_bf16_f32 v72, v112, v113
    v_cvt_pk_bf16_f32 v73, v114, v115
    v_mfma_f32_16x16x32_bf16 v[152:155], a[248:251], v[188:191], v[152:155]
    v_cvt_pk_bf16_f32 v74, v116, v117
    v_cvt_pk_bf16_f32 v75, v118, v119
    v_mfma_f32_16x16x32_bf16 v[156:159], a[252:255], v[188:191], v[156:159]
    v_cvt_pk_bf16_f32 v76, v120, v121
    v_cvt_pk_bf16_f32 v77, v122, v123
    s_waitcnt lgkmcnt(0)
    v_mfma_f32_16x16x32_bf16 v[96:99], a[0:3], v[160:163], 0
    ds_read_b128 v[176:179], v225 offset:0
    v_cvt_pk_bf16_f32 v78, v124, v125
    v_cvt_pk_bf16_f32 v79, v126, v127
    v_mfma_f32_16x16x32_bf16 v[100:103], a[4:7], v[160:163], 0
    ds_read_b128 v[180:183], v225 offset:2048
    v_cvt_pk_bf16_f32 v80, v128, v129
    v_cvt_pk_bf16_f32 v81, v130, v131
    v_mfma_f32_16x16x32_bf16 v[104:107], a[8:11], v[160:163], 0
    ds_read_b128 v[184:187], v225 offset:4096
    v_cvt_pk_bf16_f32 v82, v132, v133
    v_cvt_pk_bf16_f32 v83, v134, v135
    v_mfma_f32_16x16x32_bf16 v[108:111], a[12:15], v[160:163], 0
    ds_read_b128 v[188:191], v225 offset:6144
    v_cvt_pk_bf16_f32 v84, v136, v137
    v_cvt_pk_bf16_f32 v85, v138, v139
    v_mfma_f32_16x16x32_bf16 v[112:115], a[0:3], v[164:167], 0
    v_cvt_pk_bf16_f32 v86, v140, v141
    v_cvt_pk_bf16_f32 v87, v142, v143
    v_mfma_f32_16x16x32_bf16 v[116:119], a[4:7], v[164:167], 0
    s_add_u32 m0, s34, 98304
    s_add_u32 s37, s80, 131072
    buffer_load_dwordx4 v232, s[44:47], s37 offen lds
    v_cvt_pk_bf16_f32 v88, v144, v145
    v_cvt_pk_bf16_f32 v89, v146, v147
    v_mfma_f32_16x16x32_bf16 v[120:123], a[8:11], v[164:167], 0
    v_cvt_pk_bf16_f32 v90, v148, v149
    v_cvt_pk_bf16_f32 v91, v150, v151
    v_mfma_f32_16x16x32_bf16 v[124:127], a[12:15], v[164:167], 0
    buffer_load_dwordx4 v233, s[44:47], s37 offen offset:1024 lds
    v_cvt_pk_bf16_f32 v92, v152, v153
    v_cvt_pk_bf16_f32 v93, v154, v155
    v_mfma_f32_16x16x32_bf16 v[128:131], a[0:3], v[168:171], 0
    v_cvt_pk_bf16_f32 v94, v156, v157
    v_cvt_pk_bf16_f32 v95, v158, v159
    v_mfma_f32_16x16x32_bf16 v[132:135], a[4:7], v[168:171], 0
    s_add_u32 m0, s34, 106496
    s_add_u32 s37, s81, 131072
    buffer_load_dwordx4 v232, s[44:47], s37 offen lds
    v_mfma_f32_16x16x32_bf16 v[136:139], a[8:11], v[168:171], 0
    s_waitcnt vmcnt(11)
    v_lshlrev_b32 v16, 16, v0
    v_mfma_f32_16x16x32_bf16 v[140:143], a[12:15], v[168:171], 0
    buffer_load_dwordx4 v233, s[44:47], s37 offen offset:1024 lds
    v_and_b32 v17, 0xffff0000, v0
    v_mfma_f32_16x16x32_bf16 v[144:147], a[0:3], v[172:175], 0
    v_lshlrev_b32 v18, 16, v1
    v_and_b32 v19, 0xffff0000, v1
    v_mfma_f32_16x16x32_bf16 v[148:151], a[4:7], v[172:175], 0
    s_add_u32 m0, s34, 114688
    s_add_u32 s37, s82, 131072
    buffer_load_dwordx4 v232, s[44:47], s37 offen lds
    v_mfma_f32_16x16x32_bf16 v[152:155], a[8:11], v[172:175], 0
    v_lshlrev_b32 v20, 16, v2
    v_mfma_f32_16x16x32_bf16 v[156:159], a[12:15], v[172:175], 0
    buffer_load_dwordx4 v233, s[44:47], s37 offen offset:1024 lds
    s_waitcnt lgkmcnt(0)
    v_mfma_f32_16x16x32_bf16 v[96:99], a[16:19], v[176:179], v[96:99]
    ds_read_b128 v[160:163], v224 offset:8192
    v_and_b32 v21, 0xffff0000, v2
    v_mfma_f32_16x16x32_bf16 v[100:103], a[20:23], v[176:179], v[100:103]
    ds_read_b128 v[164:167], v224 offset:10240
    v_lshlrev_b32 v22, 16, v3
    v_mfma_f32_16x16x32_bf16 v[104:107], a[24:27], v[176:179], v[104:107]
    ds_read_b128 v[168:171], v224 offset:12288
    v_and_b32 v23, 0xffff0000, v3
    v_mfma_f32_16x16x32_bf16 v[108:111], a[28:31], v[176:179], v[108:111]
    ds_read_b128 v[172:175], v224 offset:14336
    v_lshlrev_b32 v24, 16, v4
    v_mfma_f32_16x16x32_bf16 v[112:115], a[16:19], v[180:183], v[112:115]
    v_and_b32 v25, 0xffff0000, v4
    v_lshlrev_b32 v26, 16, v5
    v_mfma_f32_16x16x32_bf16 v[116:119], a[20:23], v[180:183], v[116:119]
    s_add_u32 m0, s34, 122880
    s_add_u32 s37, s83, 131072
    buffer_load_dwordx4 v232, s[44:47], s37 offen lds
    v_mfma_f32_16x16x32_bf16 v[120:123], a[24:27], v[180:183], v[120:123]
    v_and_b32 v27, 0xffff0000, v5
    v_lshlrev_b32 v28, 16, v6
    v_mfma_f32_16x16x32_bf16 v[124:127], a[28:31], v[180:183], v[124:127]
    buffer_load_dwordx4 v233, s[44:47], s37 offen offset:1024 lds
    v_and_b32 v29, 0xffff0000, v6
    v_mfma_f32_16x16x32_bf16 v[128:131], a[16:19], v[184:187], v[128:131]
    v_lshlrev_b32 v30, 16, v7
    v_and_b32 v31, 0xffff0000, v7
    v_mfma_f32_16x16x32_bf16 v[132:135], a[20:23], v[184:187], v[132:135]
    s_add_u32 m0, s34, 131072
    s_add_u32 s37, s84, 131072
    buffer_load_dwordx4 v232, s[44:47], s37 offen lds
    v_mfma_f32_16x16x32_bf16 v[136:139], a[24:27], v[184:187], v[136:139]
    v_lshlrev_b32 v32, 16, v8
    v_mfma_f32_16x16x32_bf16 v[140:143], a[28:31], v[184:187], v[140:143]
    buffer_load_dwordx4 v233, s[44:47], s37 offen offset:1024 lds
    v_and_b32 v33, 0xffff0000, v8
    v_mfma_f32_16x16x32_bf16 v[144:147], a[16:19], v[188:191], v[144:147]
    v_lshlrev_b32 v34, 16, v9
    v_and_b32 v35, 0xffff0000, v9
    v_mfma_f32_16x16x32_bf16 v[148:151], a[20:23], v[188:191], v[148:151]
    s_add_u32 m0, s34, 139264
    s_add_u32 s37, s85, 131072
    buffer_load_dwordx4 v232, s[44:47], s37 offen lds
    v_mfma_f32_16x16x32_bf16 v[152:155], a[24:27], v[188:191], v[152:155]
    v_lshlrev_b32 v36, 16, v10
    v_and_b32 v37, 0xffff0000, v10
    v_mfma_f32_16x16x32_bf16 v[156:159], a[28:31], v[188:191], v[156:159]
    buffer_load_dwordx4 v233, s[44:47], s37 offen offset:1024 lds
    s_waitcnt lgkmcnt(0)
    v_mfma_f32_16x16x32_bf16 v[96:99], a[32:35], v[160:163], v[96:99]
    ds_read_b128 v[176:179], v225 offset:8192
    v_lshlrev_b32 v38, 16, v11
    v_mfma_f32_16x16x32_bf16 v[100:103], a[36:39], v[160:163], v[100:103]
    ds_read_b128 v[180:183], v225 offset:10240
    v_and_b32 v39, 0xffff0000, v11
    v_mfma_f32_16x16x32_bf16 v[104:107], a[40:43], v[160:163], v[104:107]
    ds_read_b128 v[184:187], v225 offset:12288
    v_lshlrev_b32 v40, 16, v12
    v_mfma_f32_16x16x32_bf16 v[108:111], a[44:47], v[160:163], v[108:111]
    ds_read_b128 v[188:191], v225 offset:14336
    v_and_b32 v41, 0xffff0000, v12
    v_mfma_f32_16x16x32_bf16 v[112:115], a[32:35], v[164:167], v[112:115]
    v_lshlrev_b32 v42, 16, v13
    v_and_b32 v43, 0xffff0000, v13
    v_mfma_f32_16x16x32_bf16 v[116:119], a[36:39], v[164:167], v[116:119]
    s_add_u32 m0, s34, 147456
    s_add_u32 s37, s86, 131072
    buffer_load_dwordx4 v232, s[44:47], s37 offen lds
    v_mfma_f32_16x16x32_bf16 v[120:123], a[40:43], v[164:167], v[120:123]
    v_lshlrev_b32 v44, 16, v14
    v_and_b32 v45, 0xffff0000, v14
    v_mfma_f32_16x16x32_bf16 v[124:127], a[44:47], v[164:167], v[124:127]
    buffer_load_dwordx4 v233, s[44:47], s37 offen offset:1024 lds
    v_mfma_f32_16x16x32_bf16 v[128:131], a[32:35], v[168:171], v[128:131]
    v_lshlrev_b32 v46, 16, v15
    v_and_b32 v47, 0xffff0000, v15
    v_mfma_f32_16x16x32_bf16 v[132:135], a[36:39], v[168:171], v[132:135]
    s_add_u32 m0, s34, 155648
    s_add_u32 s37, s87, 131072
    buffer_load_dwordx4 v232, s[44:47], s37 offen lds
    v_mfma_f32_16x16x32_bf16 v[136:139], a[40:43], v[168:171], v[136:139]
    v_add_f32 v52, v16, v20
    v_add_f32 v53, v17, v21
    v_mfma_f32_16x16x32_bf16 v[140:143], a[44:47], v[168:171], v[140:143]
    buffer_load_dwordx4 v233, s[44:47], s37 offen offset:1024 lds
    v_add_f32 v54, v18, v22
    v_mfma_f32_16x16x32_bf16 v[144:147], a[32:35], v[172:175], v[144:147]
    v_add_f32 v55, v19, v23
    v_add_f32 v52, v52, v24
    v_mfma_f32_16x16x32_bf16 v[148:151], a[36:39], v[172:175], v[148:151]
    v_add_f32 v53, v53, v25
    v_add_f32 v54, v54, v26
    v_mfma_f32_16x16x32_bf16 v[152:155], a[40:43], v[172:175], v[152:155]
    v_add_f32 v55, v55, v27
    v_add_f32 v52, v52, v28
    v_mfma_f32_16x16x32_bf16 v[156:159], a[44:47], v[172:175], v[156:159]
    s_waitcnt vmcnt(28) lgkmcnt(0)
    s_barrier
    v_mfma_f32_16x16x32_bf16 v[96:99], a[48:51], v[176:179], v[96:99]
    ds_read_b128 v[160:163], v224 offset:16384
    v_add_f32 v53, v53, v29
    v_mfma_f32_16x16x32_bf16 v[100:103], a[52:55], v[176:179], v[100:103]
    ds_read_b128 v[164:167], v224 offset:18432
    v_mfma_f32_16x16x32_bf16 v[104:107], a[56:59], v[176:179], v[104:107]
    ds_read_b128 v[168:171], v224 offset:20480
    v_add_f32 v54, v54, v30
    v_mfma_f32_16x16x32_bf16 v[108:111], a[60:63], v[176:179], v[108:111]
    ds_read_b128 v[172:175], v224 offset:22528
    v_add_f32 v55, v55, v31
    v_mfma_f32_16x16x32_bf16 v[112:115], a[48:51], v[180:183], v[112:115]
    v_add_f32 v52, v52, v32
    v_add_f32 v53, v53, v33
    v_mfma_f32_16x16x32_bf16 v[116:119], a[52:55], v[180:183], v[116:119]
    s_add_u32 m0, s34, 0
    s_add_u32 s37, s80, 196608
    buffer_load_dwordx4 v232, s[44:47], s37 offen lds
    v_mfma_f32_16x16x32_bf16 v[120:123], a[56:59], v[180:183], v[120:123]
    v_add_f32 v54, v54, v34
    v_add_f32 v55, v55, v35
    v_mfma_f32_16x16x32_bf16 v[124:127], a[60:63], v[180:183], v[124:127]
    buffer_load_dwordx4 v233, s[44:47], s37 offen offset:1024 lds
    v_add_f32 v52, v52, v36
    v_mfma_f32_16x16x32_bf16 v[128:131], a[48:51], v[184:187], v[128:131]
    v_add_f32 v53, v53, v37
    v_add_f32 v54, v54, v38
    v_mfma_f32_16x16x32_bf16 v[132:135], a[52:55], v[184:187], v[132:135]
    s_add_u32 m0, s34, 8192
    s_add_u32 s37, s81, 196608
    buffer_load_dwordx4 v232, s[44:47], s37 offen lds
    v_mfma_f32_16x16x32_bf16 v[136:139], a[56:59], v[184:187], v[136:139]
    v_add_f32 v55, v55, v39
    v_add_f32 v52, v52, v40
    v_mfma_f32_16x16x32_bf16 v[140:143], a[60:63], v[184:187], v[140:143]
    buffer_load_dwordx4 v233, s[44:47], s37 offen offset:1024 lds
    v_add_f32 v53, v53, v41
    v_mfma_f32_16x16x32_bf16 v[144:147], a[48:51], v[188:191], v[144:147]
    v_add_f32 v54, v54, v42
    v_mfma_f32_16x16x32_bf16 v[148:151], a[52:55], v[188:191], v[148:151]
    v_add_f32 v55, v55, v43
    v_add_f32 v52, v52, v44
    v_mfma_f32_16x16x32_bf16 v[152:155], a[56:59], v[188:191], v[152:155]
    v_add_f32 v53, v53, v45
    v_add_f32 v54, v54, v46
    v_mfma_f32_16x16x32_bf16 v[156:159], a[60:63], v[188:191], v[156:159]
    v_add_f32 v55, v55, v47
    s_waitcnt lgkmcnt(0)
    v_mfma_f32_16x16x32_bf16 v[96:99], a[64:67], v[160:163], v[96:99]
    ds_read_b128 v[176:179], v225 offset:16384
    v_add_f32 v52, v52, v53
    v_mfma_f32_16x16x32_bf16 v[100:103], a[68:71], v[160:163], v[100:103]
    ds_read_b128 v[180:183], v225 offset:18432
    v_add_f32 v54, v54, v55
    v_mfma_f32_16x16x32_bf16 v[104:107], a[72:75], v[160:163], v[104:107]
    ds_read_b128 v[184:187], v225 offset:20480
    v_add_f32 v48, v52, v54
    v_mfma_f32_16x16x32_bf16 v[108:111], a[76:79], v[160:163], v[108:111]
    ds_read_b128 v[188:191], v225 offset:22528
    s_nop 1
    v_mfma_f32_16x16x32_bf16 v[112:115], a[64:67], v[164:167], v[112:115]
    v_add_f32_dpp v48, v48, v48 quad_perm:[1,0,3,2] row_mask:0xf bank_mask:0xf
    s_nop 1
    v_mfma_f32_16x16x32_bf16 v[116:119], a[68:71], v[164:167], v[116:119]
    v_add_f32_dpp v48, v48, v48 quad_perm:[2,3,0,1] row_mask:0xf bank_mask:0xf
    v_mfma_f32_16x16x32_bf16 v[120:123], a[72:75], v[164:167], v[120:123]
    s_nop 1
    v_add_f32_dpp v48, v48, v48 row_half_mirror row_mask:0xf bank_mask:0xf
    v_mfma_f32_16x16x32_bf16 v[124:127], a[76:79], v[164:167], v[124:127]
    s_nop 1
    v_add_f32_dpp v48, v48, v48 row_mirror row_mask:0xf bank_mask:0xf
    v_mfma_f32_16x16x32_bf16 v[128:131], a[64:67], v[168:171], v[128:131]
    s_nop 0
    v_mov_b32 v49, v48
    v_mfma_f32_16x16x32_bf16 v[132:135], a[68:71], v[168:171], v[132:135]
    s_nop 1
    v_permlane16_swap_b32 v48, v49
    v_mfma_f32_16x16x32_bf16 v[136:139], a[72:75], v[168:171], v[136:139]
    s_nop 0
    v_add_f32 v48, v48, v49
    v_mfma_f32_16x16x32_bf16 v[140:143], a[76:79], v[168:171], v[140:143]
    v_mul_f32 v48, 0x3a800000, v48
    v_sub_f32 v56, v16, v48
    v_mfma_f32_16x16x32_bf16 v[144:147], a[64:67], v[172:175], v[144:147]
    v_mul_f32 v52, v56, v56
    v_mfma_f32_16x16x32_bf16 v[148:151], a[68:71], v[172:175], v[148:151]
    v_sub_f32 v57, v17, v48
    v_mul_f32 v53, v57, v57
    v_mfma_f32_16x16x32_bf16 v[152:155], a[72:75], v[172:175], v[152:155]
    s_add_u32 s38, s36, 0
    buffer_store_dwordx4 v[64:67], v240, s[16:19], s38 offen offset:0 sc1
    v_mfma_f32_16x16x32_bf16 v[156:159], a[76:79], v[172:175], v[156:159]
    v_sub_f32 v58, v18, v48
    s_waitcnt lgkmcnt(0)
    v_mfma_f32_16x16x32_bf16 v[96:99], a[80:83], v[176:179], v[96:99]
    ds_read_b128 v[160:163], v224 offset:24576
    v_mul_f32 v54, v58, v58
    v_mfma_f32_16x16x32_bf16 v[100:103], a[84:87], v[176:179], v[100:103]
    ds_read_b128 v[164:167], v224 offset:26624
    v_sub_f32 v59, v19, v48
    v_mfma_f32_16x16x32_bf16 v[104:107], a[88:91], v[176:179], v[104:107]
    ds_read_b128 v[168:171], v224 offset:28672
    v_mul_f32 v55, v59, v59
    v_mfma_f32_16x16x32_bf16 v[108:111], a[92:95], v[176:179], v[108:111]
    ds_read_b128 v[172:175], v224 offset:30720
    v_sub_f32 v56, v20, v48
    v_mfma_f32_16x16x32_bf16 v[112:115], a[80:83], v[180:183], v[112:115]
    v_fmac_f32 v52, v56, v56
    v_sub_f32 v57, v21, v48
    v_mfma_f32_16x16x32_bf16 v[116:119], a[84:87], v[180:183], v[116:119]
    v_fmac_f32 v53, v57, v57
    v_sub_f32 v58, v22, v48
    v_mfma_f32_16x16x32_bf16 v[120:123], a[88:91], v[180:183], v[120:123]
    v_fmac_f32 v54, v58, v58
    v_mfma_f32_16x16x32_bf16 v[124:127], a[92:95], v[180:183], v[124:127]
    v_sub_f32 v59, v23, v48
    v_fmac_f32 v55, v59, v59
    v_mfma_f32_16x16x32_bf16 v[128:131], a[80:83], v[184:187], v[128:131]
    v_sub_f32 v56, v24, v48
    v_fmac_f32 v52, v56, v56
    v_mfma_f32_16x16x32_bf16 v[132:135], a[84:87], v[184:187], v[132:135]
    v_sub_f32 v57, v25, v48
    v_fmac_f32 v53, v57, v57
    v_mfma_f32_16x16x32_bf16 v[136:139], a[88:91], v[184:187], v[136:139]
    v_sub_f32 v58, v26, v48
    v_fmac_f32 v54, v58, v58
    v_mfma_f32_16x16x32_bf16 v[140:143], a[92:95], v[184:187], v[140:143]
    v_sub_f32 v59, v27, v48
    v_fmac_f32 v55, v59, v59
    v_mfma_f32_16x16x32_bf16 v[144:147], a[80:83], v[188:191], v[144:147]
    v_sub_f32 v56, v28, v48
    v_mfma_f32_16x16x32_bf16 v[148:151], a[84:87], v[188:191], v[148:151]
    v_fmac_f32 v52, v56, v56
    v_sub_f32 v57, v29, v48
    v_mfma_f32_16x16x32_bf16 v[152:155], a[88:91], v[188:191], v[152:155]
    s_add_u32 s38, s36, 0
    buffer_store_dwordx4 v[68:71], v240, s[16:19], s38 offen offset:2048 sc1
    v_mfma_f32_16x16x32_bf16 v[156:159], a[92:95], v[188:191], v[156:159]
    v_fmac_f32 v53, v57, v57
    s_waitcnt lgkmcnt(0)
    v_mfma_f32_16x16x32_bf16 v[96:99], a[96:99], v[160:163], v[96:99]
    ds_read_b128 v[176:179], v225 offset:24576
    v_sub_f32 v58, v30, v48
    v_mfma_f32_16x16x32_bf16 v[100:103], a[100:103], v[160:163], v[100:103]
    ds_read_b128 v[180:183], v225 offset:26624
    v_fmac_f32 v54, v58, v58
    v_mfma_f32_16x16x32_bf16 v[104:107], a[104:107], v[160:163], v[104:107]
    ds_read_b128 v[184:187], v225 offset:28672
    v_sub_f32 v59, v31, v48
    v_mfma_f32_16x16x32_bf16 v[108:111], a[108:111], v[160:163], v[108:111]
    ds_read_b128 v[188:191], v225 offset:30720
    v_fmac_f32 v55, v59, v59
    v_mfma_f32_16x16x32_bf16 v[112:115], a[96:99], v[164:167], v[112:115]
    v_sub_f32 v56, v32, v48
    v_fmac_f32 v52, v56, v56
    v_mfma_f32_16x16x32_bf16 v[116:119], a[100:103], v[164:167], v[116:119]
    v_sub_f32 v57, v33, v48
    v_fmac_f32 v53, v57, v57
    v_mfma_f32_16x16x32_bf16 v[120:123], a[104:107], v[164:167], v[120:123]
    v_sub_f32 v58, v34, v48
    v_fmac_f32 v54, v58, v58
    v_mfma_f32_16x16x32_bf16 v[124:127], a[108:111], v[164:167], v[124:127]
    v_sub_f32 v59, v35, v48
    v_mfma_f32_16x16x32_bf16 v[128:131], a[96:99], v[168:171], v[128:131]
    v_fmac_f32 v55, v59, v59
    v_sub_f32 v56, v36, v48
    v_mfma_f32_16x16x32_bf16 v[132:135], a[100:103], v[168:171], v[132:135]
    v_fmac_f32 v52, v56, v56
    v_sub_f32 v57, v37, v48
    v_mfma_f32_16x16x32_bf16 v[136:139], a[104:107], v[168:171], v[136:139]
    v_fmac_f32 v53, v57, v57
    v_sub_f32 v58, v38, v48
    v_mfma_f32_16x16x32_bf16 v[140:143], a[108:111], v[168:171], v[140:143]
    v_fmac_f32 v54, v58, v58
    v_sub_f32 v59, v39, v48
    v_mfma_f32_16x16x32_bf16 v[144:147], a[96:99], v[172:175], v[144:147]
    v_fmac_f32 v55, v59, v59
    v_sub_f32 v56, v40, v48
    v_mfma_f32_16x16x32_bf16 v[148:151], a[100:103], v[172:175], v[148:151]
    v_fmac_f32 v52, v56, v56
    v_mfma_f32_16x16x32_bf16 v[152:155], a[104:107], v[172:175], v[152:155]
    s_add_u32 s38, s36, 0
    buffer_store_dwordx4 v[72:75], v240, s[16:19], s38 offen offset:1024 sc1
    v_mfma_f32_16x16x32_bf16 v[156:159], a[108:111], v[172:175], v[156:159]
    s_waitcnt vmcnt(27) lgkmcnt(0)
    s_barrier
    v_mfma_f32_16x16x32_bf16 v[96:99], a[112:115], v[176:179], v[96:99]
    ds_read_b128 v[160:163], v224 offset:32768
    v_sub_f32 v57, v41, v48
    v_mfma_f32_16x16x32_bf16 v[100:103], a[116:119], v[176:179], v[100:103]
    ds_read_b128 v[164:167], v224 offset:34816
    v_fmac_f32 v53, v57, v57
    v_mfma_f32_16x16x32_bf16 v[104:107], a[120:123], v[176:179], v[104:107]
    ds_read_b128 v[168:171], v224 offset:36864
    v_sub_f32 v58, v42, v48
    v_mfma_f32_16x16x32_bf16 v[108:111], a[124:127], v[176:179], v[108:111]
    ds_read_b128 v[172:175], v224 offset:38912
    v_fmac_f32 v54, v58, v58
    v_mfma_f32_16x16x32_bf16 v[112:115], a[112:115], v[180:183], v[112:115]
    v_sub_f32 v59, v43, v48
    v_fmac_f32 v55, v59, v59
    v_mfma_f32_16x16x32_bf16 v[116:119], a[116:119], v[180:183], v[116:119]
    s_add_u32 m0, s34, 16384
    s_add_u32 s37, s82, 196608
    buffer_load_dwordx4 v232, s[44:47], s37 offen lds
    v_mfma_f32_16x16x32_bf16 v[120:123], a[120:123], v[180:183], v[120:123]
    v_sub_f32 v56, v44, v48
    v_fmac_f32 v52, v56, v56
    v_mfma_f32_16x16x32_bf16 v[124:127], a[124:127], v[180:183], v[124:127]
    buffer_load_dwordx4 v233, s[44:47], s37 offen offset:1024 lds
    v_sub_f32 v57, v45, v48
    v_mfma_f32_16x16x32_bf16 v[128:131], a[112:115], v[184:187], v[128:131]
    v_fmac_f32 v53, v57, v57
    v_sub_f32 v58, v46, v48
    v_mfma_f32_16x16x32_bf16 v[132:135], a[116:119], v[184:187], v[132:135]
    s_add_u32 m0, s34, 24576
    s_add_u32 s37, s83, 196608
    buffer_load_dwordx4 v232, s[44:47], s37 offen lds
    v_mfma_f32_16x16x32_bf16 v[136:139], a[120:123], v[184:187], v[136:139]
    v_fmac_f32 v54, v58, v58
    v_mfma_f32_16x16x32_bf16 v[140:143], a[124:127], v[184:187], v[140:143]
    buffer_load_dwordx4 v233, s[44:47], s37 offen offset:1024 lds
    v_sub_f32 v59, v47, v48
    v_mfma_f32_16x16x32_bf16 v[144:147], a[112:115], v[188:191], v[144:147]
    v_fmac_f32 v55, v59, v59
    v_add_f32 v52, v52, v53
    v_mfma_f32_16x16x32_bf16 v[148:151], a[116:119], v[188:191], v[148:151]
    v_add_f32 v54, v54, v55
    v_add_f32 v51, v52, v54
    v_mfma_f32_16x16x32_bf16 v[152:155], a[120:123], v[188:191], v[152:155]
    s_nop 1
    v_add_f32_dpp v51, v51, v51 quad_perm:[1,0,3,2] row_mask:0xf bank_mask:0xf
    v_mfma_f32_16x16x32_bf16 v[156:159], a[124:127], v[188:191], v[156:159]
    s_nop 1
    s_waitcnt lgkmcnt(0)
    v_mfma_f32_16x16x32_bf16 v[96:99], a[128:131], v[160:163], v[96:99]
    ds_read_b128 v[176:179], v225 offset:32768
    v_add_f32_dpp v51, v51, v51 quad_perm:[2,3,0,1] row_mask:0xf bank_mask:0xf
    v_mfma_f32_16x16x32_bf16 v[100:103], a[132:135], v[160:163], v[100:103]
    ds_read_b128 v[180:183], v225 offset:34816
    s_nop 1
    v_mfma_f32_16x16x32_bf16 v[104:107], a[136:139], v[160:163], v[104:107]
    ds_read_b128 v[184:187], v225 offset:36864
    v_add_f32_dpp v51, v51, v51 row_half_mirror row_mask:0xf bank_mask:0xf
    v_mfma_f32_16x16x32_bf16 v[108:111], a[140:143], v[160:163], v[108:111]
    ds_read_b128 v[188:191], v225 offset:38912
    s_nop 1
    v_mfma_f32_16x16x32_bf16 v[112:115], a[128:131], v[164:167], v[112:115]
    v_add_f32_dpp v51, v51, v51 row_mirror row_mask:0xf bank_mask:0xf
    v_mfma_f32_16x16x32_bf16 v[116:119], a[132:135], v[164:167], v[116:119]
    s_nop 0
    v_mov_b32 v49, v51
    v_mfma_f32_16x16x32_bf16 v[120:123], a[136:139], v[164:167], v[120:123]
    s_nop 1
    v_permlane16_swap_b32 v51, v49
    v_mfma_f32_16x16x32_bf16 v[124:127], a[140:143], v[164:167], v[124:127]
    s_nop 0
    v_add_f32 v51, v51, v49
    v_mfma_f32_16x16x32_bf16 v[128:131], a[128:131], v[168:171], v[128:131]
    v_mul_f32 v51, 0x3a800000, v51
    v_cvt_pk_bf16_f32 v50, v48, v51
    v_mfma_f32_16x16x32_bf16 v[132:135], a[132:135], v[168:171], v[132:135]
    v_and_b32 v51, 0xffff0000, v50
    v_lshlrev_b32 v50, 16, v50
    v_mfma_f32_16x16x32_bf16 v[136:139], a[136:139], v[168:171], v[136:139]
    v_add_f32 v51, 0x3727c5ac, v51
    v_cvt_pk_bf16_f32 v51, v51, v51
    v_mfma_f32_16x16x32_bf16 v[140:143], a[140:143], v[168:171], v[140:143]
    v_lshlrev_b32 v51, 16, v51
    v_mfma_f32_16x16x32_bf16 v[144:147], a[128:131], v[172:175], v[144:147]
    v_sqrt_f32 v51, v51
    v_mfma_f32_16x16x32_bf16 v[148:151], a[132:135], v[172:175], v[148:151]
    s_nop 0
    v_cvt_pk_bf16_f32 v51, v51, v51
    v_mfma_f32_16x16x32_bf16 v[152:155], a[136:139], v[172:175], v[152:155]
    s_add_u32 s38, s36, 0
    buffer_store_dwordx4 v[76:79], v240, s[16:19], s38 offen offset:3072 sc1
    v_mfma_f32_16x16x32_bf16 v[156:159], a[140:143], v[172:175], v[156:159]
    v_lshlrev_b32 v51, 16, v51
    s_waitcnt lgkmcnt(0)
    v_mfma_f32_16x16x32_bf16 v[96:99], a[144:147], v[176:179], v[96:99]
    ds_read_b128 v[160:163], v224 offset:40960
    v_mfma_f32_16x16x32_bf16 v[100:103], a[148:151], v[176:179], v[100:103]
    ds_read_b128 v[164:167], v224 offset:43008
    v_rcp_f32 v51, v51
    v_mfma_f32_16x16x32_bf16 v[104:107], a[152:155], v[176:179], v[104:107]
    ds_read_b128 v[168:171], v224 offset:45056
    s_nop 0
    v_mfma_f32_16x16x32_bf16 v[108:111], a[156:159], v[176:179], v[108:111]
    ds_read_b128 v[172:175], v224 offset:47104
    v_sub_f32 v16, v16, v50
    v_mfma_f32_16x16x32_bf16 v[112:115], a[144:147], v[180:183], v[112:115]
    v_sub_f32 v17, v17, v50
    v_cvt_pk_bf16_f32 v17, v16, v17
    v_mfma_f32_16x16x32_bf16 v[116:119], a[148:151], v[180:183], v[116:119]
    v_lshlrev_b32 v16, 16, v17
    v_mfma_f32_16x16x32_bf16 v[120:123], a[152:155], v[180:183], v[120:123]
    v_and_b32 v17, 0xffff0000, v17
    v_mul_f32 v16, v16, v51
    v_mfma_f32_16x16x32_bf16 v[124:127], a[156:159], v[180:183], v[124:127]
    v_mul_f32 v17, v17, v51
    v_cvt_pk_bf16_f32 v0, v16, v17
    v_mfma_f32_16x16x32_bf16 v[128:131], a[144:147], v[184:187], v[128:131]
    v_sub_f32 v18, v18, v50
    v_sub_f32 v19, v19, v50
    v_mfma_f32_16x16x32_bf16 v[132:135], a[148:151], v[184:187], v[132:135]
    v_cvt_pk_bf16_f32 v19, v18, v19
    v_lshlrev_b32 v18, 16, v19
    v_mfma_f32_16x16x32_bf16 v[136:139], a[152:155], v[184:187], v[136:139]
    v_and_b32 v19, 0xffff0000, v19
    v_mul_f32 v18, v18, v51
    v_mfma_f32_16x16x32_bf16 v[140:143], a[156:159], v[184:187], v[140:143]
    v_mul_f32 v19, v19, v51
    v_mfma_f32_16x16x32_bf16 v[144:147], a[144:147], v[188:191], v[144:147]
    v_cvt_pk_bf16_f32 v1, v18, v19
    v_sub_f32 v20, v20, v50
    v_mfma_f32_16x16x32_bf16 v[148:151], a[148:151], v[188:191], v[148:151]
    v_sub_f32 v21, v21, v50
    v_cvt_pk_bf16_f32 v21, v20, v21
    v_mfma_f32_16x16x32_bf16 v[152:155], a[152:155], v[188:191], v[152:155]
    s_add_u32 s38, s36, 8192
    buffer_store_dwordx4 v[80:83], v240, s[16:19], s38 offen offset:0 sc1
    v_mfma_f32_16x16x32_bf16 v[156:159], a[156:159], v[188:191], v[156:159]
    v_lshlrev_b32 v20, 16, v21
    s_waitcnt lgkmcnt(0)
    v_mfma_f32_16x16x32_bf16 v[96:99], a[160:163], v[160:163], v[96:99]
    ds_read_b128 v[176:179], v225 offset:40960
    v_and_b32 v21, 0xffff0000, v21
    v_mfma_f32_16x16x32_bf16 v[100:103], a[164:167], v[160:163], v[100:103]
    ds_read_b128 v[180:183], v225 offset:43008
    v_mul_f32 v20, v20, v51
    v_mfma_f32_16x16x32_bf16 v[104:107], a[168:171], v[160:163], v[104:107]
    ds_read_b128 v[184:187], v225 offset:45056
    v_mul_f32 v21, v21, v51
    v_mfma_f32_16x16x32_bf16 v[108:111], a[172:175], v[160:163], v[108:111]
    ds_read_b128 v[188:191], v225 offset:47104
    v_cvt_pk_bf16_f32 v2, v20, v21
    v_mfma_f32_16x16x32_bf16 v[112:115], a[160:163], v[164:167], v[112:115]
    v_sub_f32 v22, v22, v50
    v_sub_f32 v23, v23, v50
    v_mfma_f32_16x16x32_bf16 v[116:119], a[164:167], v[164:167], v[116:119]
    v_cvt_pk_bf16_f32 v23, v22, v23
    v_lshlrev_b32 v22, 16, v23
    v_mfma_f32_16x16x32_bf16 v[120:123], a[168:171], v[164:167], v[120:123]
    v_and_b32 v23, 0xffff0000, v23
    v_mfma_f32_16x16x32_bf16 v[124:127], a[172:175], v[164:167], v[124:127]
    v_mul_f32 v22, v22, v51
    v_mul_f32 v23, v23, v51
    v_mfma_f32_16x16x32_bf16 v[128:131], a[160:163], v[168:171], v[128:131]
    v_cvt_pk_bf16_f32 v3, v22, v23
    ds_write_b128 v237, v[0:3] offset:0
    v_mfma_f32_16x16x32_bf16 v[132:135], a[164:167], v[168:171], v[132:135]
    v_sub_f32 v24, v24, v50
    v_sub_f32 v25, v25, v50
    v_mfma_f32_16x16x32_bf16 v[136:139], a[168:171], v[168:171], v[136:139]
    v_cvt_pk_bf16_f32 v25, v24, v25
    v_lshlrev_b32 v24, 16, v25
    v_mfma_f32_16x16x32_bf16 v[140:143], a[172:175], v[168:171], v[140:143]
    v_and_b32 v25, 0xffff0000, v25
    v_mul_f32 v24, v24, v51
    v_mfma_f32_16x16x32_bf16 v[144:147], a[160:163], v[172:175], v[144:147]
    v_mul_f32 v25, v25, v51
    v_mfma_f32_16x16x32_bf16 v[148:151], a[164:167], v[172:175], v[148:151]
    v_cvt_pk_bf16_f32 v4, v24, v25
    v_sub_f32 v26, v26, v50
    v_mfma_f32_16x16x32_bf16 v[152:155], a[168:171], v[172:175], v[152:155]
    s_add_u32 s38, s36, 8192
    buffer_store_dwordx4 v[84:87], v240, s[16:19], s38 offen offset:2048 sc1
    v_mfma_f32_16x16x32_bf16 v[156:159], a[172:175], v[172:175], v[156:159]
    s_waitcnt vmcnt(30) lgkmcnt(0)
    s_barrier
    v_mfma_f32_16x16x32_bf16 v[96:99], a[176:179], v[176:179], v[96:99]
    ds_read_b128 v[160:163], v224 offset:49152
    v_sub_f32 v27, v27, v50
    v_mfma_f32_16x16x32_bf16 v[100:103], a[180:183], v[176:179], v[100:103]
    ds_read_b128 v[164:167], v224 offset:51200
    v_cvt_pk_bf16_f32 v27, v26, v27
    v_mfma_f32_16x16x32_bf16 v[104:107], a[184:187], v[176:179], v[104:107]
    ds_read_b128 v[168:171], v224 offset:53248
    v_lshlrev_b32 v26, 16, v27
    v_mfma_f32_16x16x32_bf16 v[108:111], a[188:191], v[176:179], v[108:111]
    ds_read_b128 v[172:175], v224 offset:55296
    v_and_b32 v27, 0xffff0000, v27
    v_mfma_f32_16x16x32_bf16 v[112:115], a[176:179], v[180:183], v[112:115]
    v_mul_f32 v26, v26, v51
    v_mul_f32 v27, v27, v51
    v_mfma_f32_16x16x32_bf16 v[116:119], a[180:183], v[180:183], v[116:119]
    s_add_u32 m0, s34, 32768
    s_add_u32 s37, s84, 196608
    buffer_load_dwordx4 v232, s[44:47], s37 offen lds
    v_mfma_f32_16x16x32_bf16 v[120:123], a[184:187], v[180:183], v[120:123]
    v_cvt_pk_bf16_f32 v5, v26, v27
    v_sub_f32 v28, v28, v50
    v_mfma_f32_16x16x32_bf16 v[124:127], a[188:191], v[180:183], v[124:127]
    buffer_load_dwordx4 v233, s[44:47], s37 offen offset:1024 lds
    v_sub_f32 v29, v29, v50
    v_mfma_f32_16x16x32_bf16 v[128:131], a[176:179], v[184:187], v[128:131]
    v_cvt_pk_bf16_f32 v29, v28, v29
    v_mfma_f32_16x16x32_bf16 v[132:135], a[180:183], v[184:187], v[132:135]
    s_add_u32 m0, s34, 40960
    s_add_u32 s37, s85, 196608
    buffer_load_dwordx4 v232, s[44:47], s37 offen lds
    v_mfma_f32_16x16x32_bf16 v[136:139], a[184:187], v[184:187], v[136:139]
    v_lshlrev_b32 v28, 16, v29
    v_and_b32 v29, 0xffff0000, v29
    v_mfma_f32_16x16x32_bf16 v[140:143], a[188:191], v[184:187], v[140:143]
    buffer_load_dwordx4 v233, s[44:47], s37 offen offset:1024 lds
    v_mul_f32 v28, v28, v51
    v_mfma_f32_16x16x32_bf16 v[144:147], a[176:179], v[188:191], v[144:147]
    v_mul_f32 v29, v29, v51
    v_cvt_pk_bf16_f32 v6, v28, v29
    v_mfma_f32_16x16x32_bf16 v[148:151], a[180:183], v[188:191], v[148:151]
    v_sub_f32 v30, v30, v50
    v_sub_f32 v31, v31, v50
    v_mfma_f32_16x16x32_bf16 v[152:155], a[184:187], v[188:191], v[152:155]
    v_cvt_pk_bf16_f32 v31, v30, v31
    v_lshlrev_b32 v30, 16, v31
    v_mfma_f32_16x16x32_bf16 v[156:159], a[188:191], v[188:191], v[156:159]
    v_and_b32 v31, 0xffff0000, v31
    s_waitcnt lgkmcnt(0)
    v_mfma_f32_16x16x32_bf16 v[96:99], a[192:195], v[160:163], v[96:99]
    ds_read_b128 v[176:179], v225 offset:49152
    v_mul_f32 v30, v30, v51
    v_mfma_f32_16x16x32_bf16 v[100:103], a[196:199], v[160:163], v[100:103]
    ds_read_b128 v[180:183], v225 offset:51200
    v_mul_f32 v31, v31, v51
    v_mfma_f32_16x16x32_bf16 v[104:107], a[200:203], v[160:163], v[104:107]
    ds_read_b128 v[184:187], v225 offset:53248
    v_mfma_f32_16x16x32_bf16 v[108:111], a[204:207], v[160:163], v[108:111]
    ds_read_b128 v[188:191], v225 offset:55296
    v_cvt_pk_bf16_f32 v7, v30, v31
    v_mfma_f32_16x16x32_bf16 v[112:115], a[192:195], v[164:167], v[112:115]
    ds_write_b128 v237, v[4:7] offset:4096
    v_sub_f32 v32, v32, v50
    v_mfma_f32_16x16x32_bf16 v[116:119], a[196:199], v[164:167], v[116:119]
    v_sub_f32 v33, v33, v50
    v_cvt_pk_bf16_f32 v33, v32, v33
    v_mfma_f32_16x16x32_bf16 v[120:123], a[200:203], v[164:167], v[120:123]
    v_lshlrev_b32 v32, 16, v33
    v_and_b32 v33, 0xffff0000, v33
    v_mfma_f32_16x16x32_bf16 v[124:127], a[204:207], v[164:167], v[124:127]
    v_mul_f32 v32, v32, v51
    v_mul_f32 v33, v33, v51
    v_mfma_f32_16x16x32_bf16 v[128:131], a[192:195], v[168:171], v[128:131]
    v_cvt_pk_bf16_f32 v8, v32, v33
    v_sub_f32 v34, v34, v50
    v_mfma_f32_16x16x32_bf16 v[132:135], a[196:199], v[168:171], v[132:135]
    v_sub_f32 v35, v35, v50
    v_cvt_pk_bf16_f32 v35, v34, v35
    v_mfma_f32_16x16x32_bf16 v[136:139], a[200:203], v[168:171], v[136:139]
    v_lshlrev_b32 v34, 16, v35
    v_mfma_f32_16x16x32_bf16 v[140:143], a[204:207], v[168:171], v[140:143]
    v_and_b32 v35, 0xffff0000, v35
    v_mul_f32 v34, v34, v51
    v_mfma_f32_16x16x32_bf16 v[144:147], a[192:195], v[172:175], v[144:147]
    v_mul_f32 v35, v35, v51
    v_cvt_pk_bf16_f32 v9, v34, v35
    v_mfma_f32_16x16x32_bf16 v[148:151], a[196:199], v[172:175], v[148:151]
    v_sub_f32 v36, v36, v50
    v_sub_f32 v37, v37, v50
    v_mfma_f32_16x16x32_bf16 v[152:155], a[200:203], v[172:175], v[152:155]
    v_cvt_pk_bf16_f32 v37, v36, v37
    v_lshlrev_b32 v36, 16, v37
    v_mfma_f32_16x16x32_bf16 v[156:159], a[204:207], v[172:175], v[156:159]
    v_and_b32 v37, 0xffff0000, v37
    s_waitcnt lgkmcnt(0)
    v_mfma_f32_16x16x32_bf16 v[96:99], a[208:211], v[176:179], v[96:99]
    ds_read_b128 v[160:163], v224 offset:57344
    v_mul_f32 v36, v36, v51
    v_mfma_f32_16x16x32_bf16 v[100:103], a[212:215], v[176:179], v[100:103]
    ds_read_b128 v[164:167], v224 offset:59392
    v_mul_f32 v37, v37, v51
    v_mfma_f32_16x16x32_bf16 v[104:107], a[216:219], v[176:179], v[104:107]
    ds_read_b128 v[168:171], v224 offset:61440
    v_mfma_f32_16x16x32_bf16 v[108:111], a[220:223], v[176:179], v[108:111]
    ds_read_b128 v[172:175], v224 offset:63488
    v_cvt_pk_bf16_f32 v10, v36, v37
    v_mfma_f32_16x16x32_bf16 v[112:115], a[208:211], v[180:183], v[112:115]
    v_sub_f32 v38, v38, v50
    v_sub_f32 v39, v39, v50
    v_mfma_f32_16x16x32_bf16 v[116:119], a[212:215], v[180:183], v[116:119]
    v_cvt_pk_bf16_f32 v39, v38, v39
    v_lshlrev_b32 v38, 16, v39
    v_mfma_f32_16x16x32_bf16 v[120:123], a[216:219], v[180:183], v[120:123]
    v_and_b32 v39, 0xffff0000, v39
    v_mul_f32 v38, v38, v51
    v_mfma_f32_16x16x32_bf16 v[124:127], a[220:223], v[180:183], v[124:127]
    v_mul_f32 v39, v39, v51
    v_cvt_pk_bf16_f32 v11, v38, v39
    v_mfma_f32_16x16x32_bf16 v[128:131], a[208:211], v[184:187], v[128:131]
    ds_write_b128 v237, v[8:11] offset:8192
    v_sub_f32 v40, v40, v50
    v_mfma_f32_16x16x32_bf16 v[132:135], a[212:215], v[184:187], v[132:135]
    v_sub_f32 v41, v41, v50
    v_mfma_f32_16x16x32_bf16 v[136:139], a[216:219], v[184:187], v[136:139]
    v_cvt_pk_bf16_f32 v41, v40, v41
    v_lshlrev_b32 v40, 16, v41
    v_mfma_f32_16x16x32_bf16 v[140:143], a[220:223], v[184:187], v[140:143]
    v_and_b32 v41, 0xffff0000, v41
    v_mul_f32 v40, v40, v51
    v_mfma_f32_16x16x32_bf16 v[144:147], a[208:211], v[188:191], v[144:147]
    v_mul_f32 v41, v41, v51
    v_cvt_pk_bf16_f32 v12, v40, v41
    v_mfma_f32_16x16x32_bf16 v[148:151], a[212:215], v[188:191], v[148:151]
    v_sub_f32 v42, v42, v50
    v_sub_f32 v43, v43, v50
    v_mfma_f32_16x16x32_bf16 v[152:155], a[216:219], v[188:191], v[152:155]
    s_add_u32 s38, s36, 8192
    buffer_store_dwordx4 v[88:91], v240, s[16:19], s38 offen offset:1024 sc1
    v_mfma_f32_16x16x32_bf16 v[156:159], a[220:223], v[188:191], v[156:159]
    v_cvt_pk_bf16_f32 v43, v42, v43
    s_waitcnt lgkmcnt(0)
    v_mfma_f32_16x16x32_bf16 v[96:99], a[224:227], v[160:163], v[96:99]
    ds_read_b128 v[176:179], v225 offset:57344
    v_lshlrev_b32 v42, 16, v43
    v_mfma_f32_16x16x32_bf16 v[100:103], a[228:231], v[160:163], v[100:103]
    ds_read_b128 v[180:183], v225 offset:59392
    v_and_b32 v43, 0xffff0000, v43
    v_mfma_f32_16x16x32_bf16 v[104:107], a[232:235], v[160:163], v[104:107]
    ds_read_b128 v[184:187], v225 offset:61440
    v_mul_f32 v42, v42, v51
    v_mfma_f32_16x16x32_bf16 v[108:111], a[236:239], v[160:163], v[108:111]
    ds_read_b128 v[188:191], v225 offset:63488
    v_mul_f32 v43, v43, v51
    v_mfma_f32_16x16x32_bf16 v[112:115], a[224:227], v[164:167], v[112:115]
    v_cvt_pk_bf16_f32 v13, v42, v43
    v_mfma_f32_16x16x32_bf16 v[116:119], a[228:231], v[164:167], v[116:119]
    v_sub_f32 v44, v44, v50
    v_sub_f32 v45, v45, v50
    v_mfma_f32_16x16x32_bf16 v[120:123], a[232:235], v[164:167], v[120:123]
    v_cvt_pk_bf16_f32 v45, v44, v45
    v_lshlrev_b32 v44, 16, v45
    v_mfma_f32_16x16x32_bf16 v[124:127], a[236:239], v[164:167], v[124:127]
    v_and_b32 v45, 0xffff0000, v45
    v_mul_f32 v44, v44, v51
    v_mfma_f32_16x16x32_bf16 v[128:131], a[224:227], v[168:171], v[128:131]
    v_mul_f32 v45, v45, v51
    v_cvt_pk_bf16_f32 v14, v44, v45
    v_mfma_f32_16x16x32_bf16 v[132:135], a[228:231], v[168:171], v[132:135]
    v_sub_f32 v46, v46, v50
    v_sub_f32 v47, v47, v50
    v_mfma_f32_16x16x32_bf16 v[136:139], a[232:235], v[168:171], v[136:139]
    v_cvt_pk_bf16_f32 v47, v46, v47
    v_mfma_f32_16x16x32_bf16 v[140:143], a[236:239], v[168:171], v[140:143]
    v_lshlrev_b32 v46, 16, v47
    v_and_b32 v47, 0xffff0000, v47
    v_mfma_f32_16x16x32_bf16 v[144:147], a[224:227], v[172:175], v[144:147]
    v_mul_f32 v46, v46, v51
    v_mul_f32 v47, v47, v51
    v_mfma_f32_16x16x32_bf16 v[148:151], a[228:231], v[172:175], v[148:151]
    v_cvt_pk_bf16_f32 v15, v46, v47
    ds_write_b128 v237, v[12:15] offset:12288
    v_mfma_f32_16x16x32_bf16 v[152:155], a[232:235], v[172:175], v[152:155]
    s_add_u32 s38, s36, 8192
    buffer_store_dwordx4 v[92:95], v240, s[16:19], s38 offen offset:3072 sc1
    v_mfma_f32_16x16x32_bf16 v[156:159], a[236:239], v[172:175], v[156:159]
    s_waitcnt vmcnt(20) lgkmcnt(0)
    s_barrier
    v_mfma_f32_16x16x32_bf16 v[96:99], a[240:243], v[176:179], v[96:99]
    ds_read_b128 v[160:163], v226 offset:0
    v_mfma_f32_16x16x32_bf16 v[100:103], a[244:247], v[176:179], v[100:103]
    ds_read_b128 v[164:167], v226 offset:2048
    v_mfma_f32_16x16x32_bf16 v[104:107], a[248:251], v[176:179], v[104:107]
    ds_read_b128 v[168:171], v226 offset:4096
    v_mfma_f32_16x16x32_bf16 v[108:111], a[252:255], v[176:179], v[108:111]
    ds_read_b128 v[172:175], v226 offset:6144
    v_mfma_f32_16x16x32_bf16 v[112:115], a[240:243], v[180:183], v[112:115]
    v_lshlrev_b32 v237, 4, v253
    v_add_u32 v237, 65536, v237
    ds_read_b128 v[16:19], v237 offset:0
    ds_read_b128 v[20:23], v237 offset:4096
    ds_read_b128 v[24:27], v237 offset:8192
    ds_read_b128 v[28:31], v237 offset:12288
    v_mfma_f32_16x16x32_bf16 v[116:119], a[244:247], v[180:183], v[116:119]
    s_add_u32 m0, s34, 49152
    s_add_u32 s37, s86, 196608
    buffer_load_dwordx4 v232, s[44:47], s37 offen lds
    v_mfma_f32_16x16x32_bf16 v[120:123], a[248:251], v[180:183], v[120:123]
    v_mfma_f32_16x16x32_bf16 v[124:127], a[252:255], v[180:183], v[124:127]
    buffer_load_dwordx4 v233, s[44:47], s37 offen offset:1024 lds
    v_mfma_f32_16x16x32_bf16 v[128:131], a[240:243], v[184:187], v[128:131]
    v_mfma_f32_16x16x32_bf16 v[132:135], a[244:247], v[184:187], v[132:135]
    s_add_u32 m0, s34, 57344
    s_add_u32 s37, s87, 196608
    buffer_load_dwordx4 v232, s[44:47], s37 offen lds
    v_cvt_pk_bf16_f32 v64, v96, v97
    v_cvt_pk_bf16_f32 v65, v98, v99
    v_mfma_f32_16x16x32_bf16 v[136:139], a[248:251], v[184:187], v[136:139]
    v_cvt_pk_bf16_f32 v66, v100, v101
    v_cvt_pk_bf16_f32 v67, v102, v103
    v_mfma_f32_16x16x32_bf16 v[140:143], a[252:255], v[184:187], v[140:143]
    buffer_load_dwordx4 v233, s[44:47], s37 offen offset:1024 lds
    v_cvt_pk_bf16_f32 v68, v104, v105
    v_cvt_pk_bf16_f32 v69, v106, v107
    v_mfma_f32_16x16x32_bf16 v[144:147], a[240:243], v[188:191], v[144:147]
    v_cvt_pk_bf16_f32 v70, v108, v109
    v_cvt_pk_bf16_f32 v71, v110, v111
    v_mfma_f32_16x16x32_bf16 v[148:151], a[244:247], v[188:191], v[148:151]
    v_cvt_pk_bf16_f32 v72, v112, v113
    v_cvt_pk_bf16_f32 v73, v114, v115
    v_mfma_f32_16x16x32_bf16 v[152:155], a[248:251], v[188:191], v[152:155]
    v_cvt_pk_bf16_f32 v74, v116, v117
    v_cvt_pk_bf16_f32 v75, v118, v119
    v_mfma_f32_16x16x32_bf16 v[156:159], a[252:255], v[188:191], v[156:159]
    v_cvt_pk_bf16_f32 v76, v120, v121
    v_cvt_pk_bf16_f32 v77, v122, v123
    s_waitcnt lgkmcnt(0)
    v_mfma_f32_16x16x32_bf16 v[96:99], a[0:3], v[160:163], 0
    ds_read_b128 v[176:179], v227 offset:0
    v_cvt_pk_bf16_f32 v78, v124, v125
    v_cvt_pk_bf16_f32 v79, v126, v127
    v_mfma_f32_16x16x32_bf16 v[100:103], a[4:7], v[160:163], 0
    ds_read_b128 v[180:183], v227 offset:2048
    v_cvt_pk_bf16_f32 v80, v128, v129
    v_cvt_pk_bf16_f32 v81, v130, v131
    v_mfma_f32_16x16x32_bf16 v[104:107], a[8:11], v[160:163], 0
    ds_read_b128 v[184:187], v227 offset:4096
    v_cvt_pk_bf16_f32 v82, v132, v133
    v_cvt_pk_bf16_f32 v83, v134, v135
    v_mfma_f32_16x16x32_bf16 v[108:111], a[12:15], v[160:163], 0
    ds_read_b128 v[188:191], v227 offset:6144
    v_cvt_pk_bf16_f32 v84, v136, v137
    v_cvt_pk_bf16_f32 v85, v138, v139
    v_mfma_f32_16x16x32_bf16 v[112:115], a[0:3], v[164:167], 0
    v_cvt_pk_bf16_f32 v86, v140, v141
    v_cvt_pk_bf16_f32 v87, v142, v143
    v_mfma_f32_16x16x32_bf16 v[116:119], a[4:7], v[164:167], 0
    s_mov_b32 s39, 0
    buffer_store_dwordx4 v[16:19], v238, s[8:11], s39 offen sc1
    v_cvt_pk_bf16_f32 v88, v144, v145
    v_cvt_pk_bf16_f32 v89, v146, v147
    v_mfma_f32_16x16x32_bf16 v[120:123], a[8:11], v[164:167], 0
    v_cvt_pk_bf16_f32 v90, v148, v149
    v_cvt_pk_bf16_f32 v91, v150, v151
    v_mfma_f32_16x16x32_bf16 v[124:127], a[12:15], v[164:167], 0
    s_mov_b32 s39, 16384
    buffer_store_dwordx4 v[20:23], v238, s[8:11], s39 offen sc1
    v_cvt_pk_bf16_f32 v92, v152, v153
    v_cvt_pk_bf16_f32 v93, v154, v155
    v_mfma_f32_16x16x32_bf16 v[128:131], a[0:3], v[168:171], 0
    v_cvt_pk_bf16_f32 v94, v156, v157
    v_cvt_pk_bf16_f32 v95, v158, v159
    v_mfma_f32_16x16x32_bf16 v[132:135], a[4:7], v[168:171], 0
    s_mov_b32 s39, 32768
    buffer_store_dwordx4 v[24:27], v238, s[8:11], s39 offen sc1
    v_mfma_f32_16x16x32_bf16 v[136:139], a[8:11], v[168:171], 0
    v_mfma_f32_16x16x32_bf16 v[140:143], a[12:15], v[168:171], 0
    s_mov_b32 s39, 49152
    buffer_store_dwordx4 v[28:31], v238, s[8:11], s39 offen sc1
    v_mfma_f32_16x16x32_bf16 v[144:147], a[0:3], v[172:175], 0
    v_mfma_f32_16x16x32_bf16 v[148:151], a[4:7], v[172:175], 0
    v_mfma_f32_16x16x32_bf16 v[152:155], a[8:11], v[172:175], 0
    v_mfma_f32_16x16x32_bf16 v[156:159], a[12:15], v[172:175], 0
    s_waitcnt lgkmcnt(0)
    v_mfma_f32_16x16x32_bf16 v[96:99], a[16:19], v[176:179], v[96:99]
    ds_read_b128 v[160:163], v226 offset:8192
    v_mfma_f32_16x16x32_bf16 v[100:103], a[20:23], v[176:179], v[100:103]
    ds_read_b128 v[164:167], v226 offset:10240
    v_mfma_f32_16x16x32_bf16 v[104:107], a[24:27], v[176:179], v[104:107]
    ds_read_b128 v[168:171], v226 offset:12288
    v_mfma_f32_16x16x32_bf16 v[108:111], a[28:31], v[176:179], v[108:111]
    ds_read_b128 v[172:175], v226 offset:14336
    v_mfma_f32_16x16x32_bf16 v[112:115], a[16:19], v[180:183], v[112:115]
    v_mfma_f32_16x16x32_bf16 v[116:119], a[20:23], v[180:183], v[116:119]
    v_mfma_f32_16x16x32_bf16 v[120:123], a[24:27], v[180:183], v[120:123]
    v_mfma_f32_16x16x32_bf16 v[124:127], a[28:31], v[180:183], v[124:127]
    v_mfma_f32_16x16x32_bf16 v[128:131], a[16:19], v[184:187], v[128:131]
    v_mfma_f32_16x16x32_bf16 v[132:135], a[20:23], v[184:187], v[132:135]
    v_mfma_f32_16x16x32_bf16 v[136:139], a[24:27], v[184:187], v[136:139]
    v_mfma_f32_16x16x32_bf16 v[140:143], a[28:31], v[184:187], v[140:143]
    v_mfma_f32_16x16x32_bf16 v[144:147], a[16:19], v[188:191], v[144:147]
    v_mfma_f32_16x16x32_bf16 v[148:151], a[20:23], v[188:191], v[148:151]
    v_mfma_f32_16x16x32_bf16 v[152:155], a[24:27], v[188:191], v[152:155]
    s_add_u32 s38, s36, 32768
    buffer_store_dwordx4 v[64:67], v240, s[16:19], s38 offen offset:0 sc1
    v_mfma_f32_16x16x32_bf16 v[156:159], a[28:31], v[188:191], v[156:159]
    s_waitcnt lgkmcnt(0)
    v_mfma_f32_16x16x32_bf16 v[96:99], a[32:35], v[160:163], v[96:99]
    ds_read_b128 v[176:179], v227 offset:8192
    v_mfma_f32_16x16x32_bf16 v[100:103], a[36:39], v[160:163], v[100:103]
    ds_read_b128 v[180:183], v227 offset:10240
    v_mfma_f32_16x16x32_bf16 v[104:107], a[40:43], v[160:163], v[104:107]
    ds_read_b128 v[184:187], v227 offset:12288
    v_mfma_f32_16x16x32_bf16 v[108:111], a[44:47], v[160:163], v[108:111]
    ds_read_b128 v[188:191], v227 offset:14336
    v_mfma_f32_16x16x32_bf16 v[112:115], a[32:35], v[164:167], v[112:115]
    v_mfma_f32_16x16x32_bf16 v[116:119], a[36:39], v[164:167], v[116:119]
    v_mfma_f32_16x16x32_bf16 v[120:123], a[40:43], v[164:167], v[120:123]
    v_mfma_f32_16x16x32_bf16 v[124:127], a[44:47], v[164:167], v[124:127]
    v_mfma_f32_16x16x32_bf16 v[128:131], a[32:35], v[168:171], v[128:131]
    v_mfma_f32_16x16x32_bf16 v[132:135], a[36:39], v[168:171], v[132:135]
    v_mfma_f32_16x16x32_bf16 v[136:139], a[40:43], v[168:171], v[136:139]
    v_mfma_f32_16x16x32_bf16 v[140:143], a[44:47], v[168:171], v[140:143]
    v_mfma_f32_16x16x32_bf16 v[144:147], a[32:35], v[172:175], v[144:147]
    v_mfma_f32_16x16x32_bf16 v[148:151], a[36:39], v[172:175], v[148:151]
    v_mfma_f32_16x16x32_bf16 v[152:155], a[40:43], v[172:175], v[152:155]
    s_add_u32 s38, s36, 32768
    buffer_store_dwordx4 v[68:71], v240, s[16:19], s38 offen offset:2048 sc1
    v_mfma_f32_16x16x32_bf16 v[156:159], a[44:47], v[172:175], v[156:159]
    s_waitcnt lgkmcnt(0)
    v_mfma_f32_16x16x32_bf16 v[96:99], a[48:51], v[176:179], v[96:99]
    ds_read_b128 v[160:163], v226 offset:16384
    v_mfma_f32_16x16x32_bf16 v[100:103], a[52:55], v[176:179], v[100:103]
    ds_read_b128 v[164:167], v226 offset:18432
    v_mfma_f32_16x16x32_bf16 v[104:107], a[56:59], v[176:179], v[104:107]
    ds_read_b128 v[168:171], v226 offset:20480
    v_mfma_f32_16x16x32_bf16 v[108:111], a[60:63], v[176:179], v[108:111]
    ds_read_b128 v[172:175], v226 offset:22528
    v_mfma_f32_16x16x32_bf16 v[112:115], a[48:51], v[180:183], v[112:115]
    v_mfma_f32_16x16x32_bf16 v[116:119], a[52:55], v[180:183], v[116:119]
    v_mfma_f32_16x16x32_bf16 v[120:123], a[56:59], v[180:183], v[120:123]
    v_mfma_f32_16x16x32_bf16 v[124:127], a[60:63], v[180:183], v[124:127]
    v_mfma_f32_16x16x32_bf16 v[128:131], a[48:51], v[184:187], v[128:131]
    v_mfma_f32_16x16x32_bf16 v[132:135], a[52:55], v[184:187], v[132:135]
    v_mfma_f32_16x16x32_bf16 v[136:139], a[56:59], v[184:187], v[136:139]
    v_mfma_f32_16x16x32_bf16 v[140:143], a[60:63], v[184:187], v[140:143]
    v_mfma_f32_16x16x32_bf16 v[144:147], a[48:51], v[188:191], v[144:147]
    v_mfma_f32_16x16x32_bf16 v[148:151], a[52:55], v[188:191], v[148:151]
    v_mfma_f32_16x16x32_bf16 v[152:155], a[56:59], v[188:191], v[152:155]
    s_add_u32 s38, s36, 32768
    buffer_store_dwordx4 v[72:75], v240, s[16:19], s38 offen offset:1024 sc1
    v_mfma_f32_16x16x32_bf16 v[156:159], a[60:63], v[188:191], v[156:159]
    s_waitcnt lgkmcnt(0)
    v_mfma_f32_16x16x32_bf16 v[96:99], a[64:67], v[160:163], v[96:99]
    ds_read_b128 v[176:179], v227 offset:16384
    v_mfma_f32_16x16x32_bf16 v[100:103], a[68:71], v[160:163], v[100:103]
    ds_read_b128 v[180:183], v227 offset:18432
    v_mfma_f32_16x16x32_bf16 v[104:107], a[72:75], v[160:163], v[104:107]
    ds_read_b128 v[184:187], v227 offset:20480
    v_mfma_f32_16x16x32_bf16 v[108:111], a[76:79], v[160:163], v[108:111]
    ds_read_b128 v[188:191], v227 offset:22528
    v_mfma_f32_16x16x32_bf16 v[112:115], a[64:67], v[164:167], v[112:115]
    v_mfma_f32_16x16x32_bf16 v[116:119], a[68:71], v[164:167], v[116:119]
    v_mfma_f32_16x16x32_bf16 v[120:123], a[72:75], v[164:167], v[120:123]
    v_mfma_f32_16x16x32_bf16 v[124:127], a[76:79], v[164:167], v[124:127]
    v_mfma_f32_16x16x32_bf16 v[128:131], a[64:67], v[168:171], v[128:131]
    v_mfma_f32_16x16x32_bf16 v[132:135], a[68:71], v[168:171], v[132:135]
    v_mfma_f32_16x16x32_bf16 v[136:139], a[72:75], v[168:171], v[136:139]
    v_mfma_f32_16x16x32_bf16 v[140:143], a[76:79], v[168:171], v[140:143]
    v_mfma_f32_16x16x32_bf16 v[144:147], a[64:67], v[172:175], v[144:147]
    v_mfma_f32_16x16x32_bf16 v[148:151], a[68:71], v[172:175], v[148:151]
    v_mfma_f32_16x16x32_bf16 v[152:155], a[72:75], v[172:175], v[152:155]
    s_add_u32 s38, s36, 32768
    buffer_store_dwordx4 v[76:79], v240, s[16:19], s38 offen offset:3072 sc1
    v_mfma_f32_16x16x32_bf16 v[156:159], a[76:79], v[172:175], v[156:159]
    s_waitcnt lgkmcnt(0)
    v_mfma_f32_16x16x32_bf16 v[96:99], a[80:83], v[176:179], v[96:99]
    ds_read_b128 v[160:163], v226 offset:24576
    v_mfma_f32_16x16x32_bf16 v[100:103], a[84:87], v[176:179], v[100:103]
    ds_read_b128 v[164:167], v226 offset:26624
    v_mfma_f32_16x16x32_bf16 v[104:107], a[88:91], v[176:179], v[104:107]
    ds_read_b128 v[168:171], v226 offset:28672
    v_mfma_f32_16x16x32_bf16 v[108:111], a[92:95], v[176:179], v[108:111]
    ds_read_b128 v[172:175], v226 offset:30720
    v_mfma_f32_16x16x32_bf16 v[112:115], a[80:83], v[180:183], v[112:115]
    v_mfma_f32_16x16x32_bf16 v[116:119], a[84:87], v[180:183], v[116:119]
    v_mfma_f32_16x16x32_bf16 v[120:123], a[88:91], v[180:183], v[120:123]
    v_mfma_f32_16x16x32_bf16 v[124:127], a[92:95], v[180:183], v[124:127]
    v_mfma_f32_16x16x32_bf16 v[128:131], a[80:83], v[184:187], v[128:131]
    v_mfma_f32_16x16x32_bf16 v[132:135], a[84:87], v[184:187], v[132:135]
    v_mfma_f32_16x16x32_bf16 v[136:139], a[88:91], v[184:187], v[136:139]
    v_mfma_f32_16x16x32_bf16 v[140:143], a[92:95], v[184:187], v[140:143]
    v_mfma_f32_16x16x32_bf16 v[144:147], a[80:83], v[188:191], v[144:147]
    v_mfma_f32_16x16x32_bf16 v[148:151], a[84:87], v[188:191], v[148:151]
    v_mfma_f32_16x16x32_bf16 v[152:155], a[88:91], v[188:191], v[152:155]
    s_add_u32 s38, s36, 40960
    buffer_store_dwordx4 v[80:83], v240, s[16:19], s38 offen offset:0 sc1
    v_mfma_f32_16x16x32_bf16 v[156:159], a[92:95], v[188:191], v[156:159]
    s_waitcnt lgkmcnt(0)
    v_mfma_f32_16x16x32_bf16 v[96:99], a[96:99], v[160:163], v[96:99]
    ds_read_b128 v[176:179], v227 offset:24576
    v_mfma_f32_16x16x32_bf16 v[100:103], a[100:103], v[160:163], v[100:103]
    ds_read_b128 v[180:183], v227 offset:26624
    v_mfma_f32_16x16x32_bf16 v[104:107], a[104:107], v[160:163], v[104:107]
    ds_read_b128 v[184:187], v227 offset:28672
    v_mfma_f32_16x16x32_bf16 v[108:111], a[108:111], v[160:163], v[108:111]
    ds_read_b128 v[188:191], v227 offset:30720
    v_mfma_f32_16x16x32_bf16 v[112:115], a[96:99], v[164:167], v[112:115]
    v_mfma_f32_16x16x32_bf16 v[116:119], a[100:103], v[164:167], v[116:119]
    v_mfma_f32_16x16x32_bf16 v[120:123], a[104:107], v[164:167], v[120:123]
    v_mfma_f32_16x16x32_bf16 v[124:127], a[108:111], v[164:167], v[124:127]
    v_mfma_f32_16x16x32_bf16 v[128:131], a[96:99], v[168:171], v[128:131]
    v_mfma_f32_16x16x32_bf16 v[132:135], a[100:103], v[168:171], v[132:135]
    v_mfma_f32_16x16x32_bf16 v[136:139], a[104:107], v[168:171], v[136:139]
    v_mfma_f32_16x16x32_bf16 v[140:143], a[108:111], v[168:171], v[140:143]
    v_mfma_f32_16x16x32_bf16 v[144:147], a[96:99], v[172:175], v[144:147]
    v_mfma_f32_16x16x32_bf16 v[148:151], a[100:103], v[172:175], v[148:151]
    v_mfma_f32_16x16x32_bf16 v[152:155], a[104:107], v[172:175], v[152:155]
    s_add_u32 s38, s36, 40960
    buffer_store_dwordx4 v[84:87], v240, s[16:19], s38 offen offset:2048 sc1
    v_mfma_f32_16x16x32_bf16 v[156:159], a[108:111], v[172:175], v[156:159]
    s_waitcnt vmcnt(6) lgkmcnt(0)
    s_barrier
    v_mfma_f32_16x16x32_bf16 v[96:99], a[112:115], v[176:179], v[96:99]
    ds_read_b128 v[160:163], v226 offset:32768
    v_mfma_f32_16x16x32_bf16 v[100:103], a[116:119], v[176:179], v[100:103]
    ds_read_b128 v[164:167], v226 offset:34816
    v_mfma_f32_16x16x32_bf16 v[104:107], a[120:123], v[176:179], v[104:107]
    ds_read_b128 v[168:171], v226 offset:36864
    v_mfma_f32_16x16x32_bf16 v[108:111], a[124:127], v[176:179], v[108:111]
    ds_read_b128 v[172:175], v226 offset:38912
    v_mfma_f32_16x16x32_bf16 v[112:115], a[112:115], v[180:183], v[112:115]
    v_mfma_f32_16x16x32_bf16 v[116:119], a[116:119], v[180:183], v[116:119]
    s_lshl_b32 s39, s5, 2
    buffer_atomic_add v255, v250, s[88:91], s39 offen sc1
    s_cmp_eq_u32 s3, 0
    s_cselect_b32 s39, s39, s43
    v_mfma_f32_16x16x32_bf16 v[120:123], a[120:123], v[180:183], v[120:123]
    v_mfma_f32_16x16x32_bf16 v[124:127], a[124:127], v[180:183], v[124:127]
    v_mfma_f32_16x16x32_bf16 v[128:131], a[112:115], v[184:187], v[128:131]
    v_mfma_f32_16x16x32_bf16 v[132:135], a[116:119], v[184:187], v[132:135]
    v_mfma_f32_16x16x32_bf16 v[136:139], a[120:123], v[184:187], v[136:139]
    v_mfma_f32_16x16x32_bf16 v[140:143], a[124:127], v[184:187], v[140:143]
    v_mfma_f32_16x16x32_bf16 v[144:147], a[112:115], v[188:191], v[144:147]
    v_mfma_f32_16x16x32_bf16 v[148:151], a[116:119], v[188:191], v[148:151]
    v_mfma_f32_16x16x32_bf16 v[152:155], a[120:123], v[188:191], v[152:155]
    v_mfma_f32_16x16x32_bf16 v[156:159], a[124:127], v[188:191], v[156:159]
    s_waitcnt lgkmcnt(0)
    v_mfma_f32_16x16x32_bf16 v[96:99], a[128:131], v[160:163], v[96:99]
    ds_read_b128 v[176:179], v227 offset:32768
    v_mfma_f32_16x16x32_bf16 v[100:103], a[132:135], v[160:163], v[100:103]
    ds_read_b128 v[180:183], v227 offset:34816
    v_mfma_f32_16x16x32_bf16 v[104:107], a[136:139], v[160:163], v[104:107]
    ds_read_b128 v[184:187], v227 offset:36864
    v_mfma_f32_16x16x32_bf16 v[108:111], a[140:143], v[160:163], v[108:111]
    ds_read_b128 v[188:191], v227 offset:38912
    v_mfma_f32_16x16x32_bf16 v[112:115], a[128:131], v[164:167], v[112:115]
    v_mfma_f32_16x16x32_bf16 v[116:119], a[132:135], v[164:167], v[116:119]
    v_mfma_f32_16x16x32_bf16 v[120:123], a[136:139], v[164:167], v[120:123]
    v_mfma_f32_16x16x32_bf16 v[124:127], a[140:143], v[164:167], v[124:127]
    v_mfma_f32_16x16x32_bf16 v[128:131], a[128:131], v[168:171], v[128:131]
    v_mfma_f32_16x16x32_bf16 v[132:135], a[132:135], v[168:171], v[132:135]
    v_mfma_f32_16x16x32_bf16 v[136:139], a[136:139], v[168:171], v[136:139]
    v_mfma_f32_16x16x32_bf16 v[140:143], a[140:143], v[168:171], v[140:143]
    v_mfma_f32_16x16x32_bf16 v[144:147], a[128:131], v[172:175], v[144:147]
    v_mfma_f32_16x16x32_bf16 v[148:151], a[132:135], v[172:175], v[148:151]
    v_mfma_f32_16x16x32_bf16 v[152:155], a[136:139], v[172:175], v[152:155]
    s_add_u32 s38, s36, 40960
    buffer_store_dwordx4 v[88:91], v240, s[16:19], s38 offen offset:1024 sc1
    v_mfma_f32_16x16x32_bf16 v[156:159], a[140:143], v[172:175], v[156:159]
    s_waitcnt lgkmcnt(0)
    v_mfma_f32_16x16x32_bf16 v[96:99], a[144:147], v[176:179], v[96:99]
    ds_read_b128 v[160:163], v226 offset:40960
    v_mfma_f32_16x16x32_bf16 v[100:103], a[148:151], v[176:179], v[100:103]
    ds_read_b128 v[164:167], v226 offset:43008
    v_mfma_f32_16x16x32_bf16 v[104:107], a[152:155], v[176:179], v[104:107]
    ds_read_b128 v[168:171], v226 offset:45056
    v_mfma_f32_16x16x32_bf16 v[108:111], a[156:159], v[176:179], v[108:111]
    ds_read_b128 v[172:175], v226 offset:47104
    v_mfma_f32_16x16x32_bf16 v[112:115], a[144:147], v[180:183], v[112:115]
    v_mfma_f32_16x16x32_bf16 v[116:119], a[148:151], v[180:183], v[116:119]
    s_add_u32 m0, s31, 0
    s_add_u32 s24, s27, 0
    buffer_load_dwordx4 v245, s[12:15], s24 offen lds
    v_mfma_f32_16x16x32_bf16 v[120:123], a[152:155], v[180:183], v[120:123]
    v_mfma_f32_16x16x32_bf16 v[124:127], a[156:159], v[180:183], v[124:127]
    s_add_u32 m0, s31, 1024
    s_add_u32 s24, s27, 32768
    buffer_load_dwordx4 v245, s[12:15], s24 offen lds
    v_mfma_f32_16x16x32_bf16 v[128:131], a[144:147], v[184:187], v[128:131]
    v_mfma_f32_16x16x32_bf16 v[132:135], a[148:151], v[184:187], v[132:135]
    s_add_u32 m0, s31, 2048
    s_add_u32 s24, s27, 65536
    buffer_load_dwordx4 v245, s[12:15], s24 offen lds
    v_mfma_f32_16x16x32_bf16 v[136:139], a[152:155], v[184:187], v[136:139]
    v_mfma_f32_16x16x32_bf16 v[140:143], a[156:159], v[184:187], v[140:143]
    s_add_u32 m0, s31, 3072
    s_add_u32 s24, s27, 98304
    buffer_load_dwordx4 v245, s[12:15], s24 offen lds
    v_mfma_f32_16x16x32_bf16 v[144:147], a[144:147], v[188:191], v[144:147]
    v_mfma_f32_16x16x32_bf16 v[148:151], a[148:151], v[188:191], v[148:151]
    s_add_u32 m0, s31, 4096
    s_add_u32 s24, s27, 131072
    buffer_load_dwordx4 v245, s[12:15], s24 offen lds
    v_mfma_f32_16x16x32_bf16 v[152:155], a[152:155], v[188:191], v[152:155]
    v_mfma_f32_16x16x32_bf16 v[156:159], a[156:159], v[188:191], v[156:159]
    s_waitcnt lgkmcnt(0)
    v_mfma_f32_16x16x32_bf16 v[96:99], a[160:163], v[160:163], v[96:99]
    ds_read_b128 v[176:179], v227 offset:40960
    v_mfma_f32_16x16x32_bf16 v[100:103], a[164:167], v[160:163], v[100:103]
    ds_read_b128 v[180:183], v227 offset:43008
    v_mfma_f32_16x16x32_bf16 v[104:107], a[168:171], v[160:163], v[104:107]
    ds_read_b128 v[184:187], v227 offset:45056
    v_mfma_f32_16x16x32_bf16 v[108:111], a[172:175], v[160:163], v[108:111]
    ds_read_b128 v[188:191], v227 offset:47104
    v_mfma_f32_16x16x32_bf16 v[112:115], a[160:163], v[164:167], v[112:115]
    v_mfma_f32_16x16x32_bf16 v[116:119], a[164:167], v[164:167], v[116:119]
    v_mfma_f32_16x16x32_bf16 v[120:123], a[168:171], v[164:167], v[120:123]
    v_mfma_f32_16x16x32_bf16 v[124:127], a[172:175], v[164:167], v[124:127]
    v_mfma_f32_16x16x32_bf16 v[128:131], a[160:163], v[168:171], v[128:131]
    v_mfma_f32_16x16x32_bf16 v[132:135], a[164:167], v[168:171], v[132:135]
    v_mfma_f32_16x16x32_bf16 v[136:139], a[168:171], v[168:171], v[136:139]
    v_mfma_f32_16x16x32_bf16 v[140:143], a[172:175], v[168:171], v[140:143]
    v_mfma_f32_16x16x32_bf16 v[144:147], a[160:163], v[172:175], v[144:147]
    v_mfma_f32_16x16x32_bf16 v[148:151], a[164:167], v[172:175], v[148:151]
    v_mfma_f32_16x16x32_bf16 v[152:155], a[168:171], v[172:175], v[152:155]
    s_add_u32 s38, s36, 40960
    buffer_store_dwordx4 v[92:95], v240, s[16:19], s38 offen offset:3072 sc1
    v_mfma_f32_16x16x32_bf16 v[156:159], a[172:175], v[172:175], v[156:159]
    s_waitcnt lgkmcnt(0)
    v_mfma_f32_16x16x32_bf16 v[96:99], a[176:179], v[176:179], v[96:99]
    ds_read_b128 v[160:163], v226 offset:49152
    v_mfma_f32_16x16x32_bf16 v[100:103], a[180:183], v[176:179], v[100:103]
    ds_read_b128 v[164:167], v226 offset:51200
    v_mfma_f32_16x16x32_bf16 v[104:107], a[184:187], v[176:179], v[104:107]
    ds_read_b128 v[168:171], v226 offset:53248
    v_mfma_f32_16x16x32_bf16 v[108:111], a[188:191], v[176:179], v[108:111]
    ds_read_b128 v[172:175], v226 offset:55296
    v_mfma_f32_16x16x32_bf16 v[112:115], a[176:179], v[180:183], v[112:115]
    v_mfma_f32_16x16x32_bf16 v[116:119], a[180:183], v[180:183], v[116:119]
    s_add_u32 m0, s31, 5120
    s_add_u32 s24, s27, 163840
    buffer_load_dwordx4 v245, s[12:15], s24 offen lds
    v_mfma_f32_16x16x32_bf16 v[120:123], a[184:187], v[180:183], v[120:123]
    v_mfma_f32_16x16x32_bf16 v[124:127], a[188:191], v[180:183], v[124:127]
    s_add_u32 m0, s31, 6144
    s_add_u32 s24, s27, 196608
    buffer_load_dwordx4 v245, s[12:15], s24 offen lds
    v_mfma_f32_16x16x32_bf16 v[128:131], a[176:179], v[184:187], v[128:131]
    v_mfma_f32_16x16x32_bf16 v[132:135], a[180:183], v[184:187], v[132:135]
    s_add_u32 m0, s31, 7168
    s_add_u32 s24, s27, 229376
    buffer_load_dwordx4 v245, s[12:15], s24 offen lds
    v_mfma_f32_16x16x32_bf16 v[136:139], a[184:187], v[184:187], v[136:139]
    v_mfma_f32_16x16x32_bf16 v[140:143], a[188:191], v[184:187], v[140:143]
    s_add_u32 s27, s27, 1048576
    s_and_b32 s27, s27, 0x407fffff
    s_cmp_eq_u32 s27, s7
    s_cselect_b32 s27, s43, s27
    v_mfma_f32_16x16x32_bf16 v[144:147], a[176:179], v[188:191], v[144:147]
    v_mfma_f32_16x16x32_bf16 v[148:151], a[180:183], v[188:191], v[148:151]
    s_add_u32 s31, s31, 32768
    s_cmp_ge_u32 s31, 163840
    s_cselect_b32 s24, 98304, 0
    s_sub_u32 s31, s31, s24
    v_mfma_f32_16x16x32_bf16 v[152:155], a[184:187], v[188:191], v[152:155]
    v_mfma_f32_16x16x32_bf16 v[156:159], a[188:191], v[188:191], v[156:159]
    s_waitcnt lgkmcnt(0)
    v_mfma_f32_16x16x32_bf16 v[96:99], a[192:195], v[160:163], v[96:99]
    ds_read_b128 v[176:179], v227 offset:49152
    v_mfma_f32_16x16x32_bf16 v[100:103], a[196:199], v[160:163], v[100:103]
    ds_read_b128 v[180:183], v227 offset:51200
    v_mfma_f32_16x16x32_bf16 v[104:107], a[200:203], v[160:163], v[104:107]
    ds_read_b128 v[184:187], v227 offset:53248
    v_mfma_f32_16x16x32_bf16 v[108:111], a[204:207], v[160:163], v[108:111]
    ds_read_b128 v[188:191], v227 offset:55296
    v_mfma_f32_16x16x32_bf16 v[112:115], a[192:195], v[164:167], v[112:115]
    s_mul_i32 s38, s2, 100
    v_mfma_f32_16x16x32_bf16 v[116:119], a[196:199], v[164:167], v[116:119]
    v_mfma_f32_16x16x32_bf16 v[120:123], a[200:203], v[164:167], v[120:123]
    v_lshl_add_u32 v60, v253, 2, s38
    v_mfma_f32_16x16x32_bf16 v[124:127], a[204:207], v[164:167], v[124:127]
    v_cmp_gt_u32 vcc, 25, v253
    v_mfma_f32_16x16x32_bf16 v[128:131], a[192:195], v[168:171], v[128:131]
    v_mov_b32 v61, 0
    v_mfma_f32_16x16x32_bf16 v[132:135], a[196:199], v[168:171], v[132:135]
    v_mfma_f32_16x16x32_bf16 v[136:139], a[200:203], v[168:171], v[136:139]
    v_mov_b32 v62, 0x7ffffff0
    v_mfma_f32_16x16x32_bf16 v[140:143], a[204:207], v[168:171], v[140:143]
    v_cndmask_b32 v60, v62, v60, vcc
    v_mfma_f32_16x16x32_bf16 v[144:147], a[192:195], v[172:175], v[144:147]
    v_mfma_f32_16x16x32_bf16 v[148:151], a[196:199], v[172:175], v[148:151]
    buffer_store_dword v61, v60, s[56:59], 0 offen
    v_mfma_f32_16x16x32_bf16 v[152:155], a[200:203], v[172:175], v[152:155]
    v_mfma_f32_16x16x32_bf16 v[156:159], a[204:207], v[172:175], v[156:159]
    s_waitcnt lgkmcnt(0)
    v_mfma_f32_16x16x32_bf16 v[96:99], a[208:211], v[176:179], v[96:99]
    ds_read_b128 v[160:163], v226 offset:57344
    v_mfma_f32_16x16x32_bf16 v[100:103], a[212:215], v[176:179], v[100:103]
    ds_read_b128 v[164:167], v226 offset:59392
    v_mfma_f32_16x16x32_bf16 v[104:107], a[216:219], v[176:179], v[104:107]
    ds_read_b128 v[168:171], v226 offset:61440
    v_mfma_f32_16x16x32_bf16 v[108:111], a[220:223], v[176:179], v[108:111]
    ds_read_b128 v[172:175], v226 offset:63488
    v_mfma_f32_16x16x32_bf16 v[112:115], a[208:211], v[180:183], v[112:115]
    v_mfma_f32_16x16x32_bf16 v[116:119], a[212:215], v[180:183], v[116:119]
    v_mfma_f32_16x16x32_bf16 v[120:123], a[216:219], v[180:183], v[120:123]
    v_mfma_f32_16x16x32_bf16 v[124:127], a[220:223], v[180:183], v[124:127]
    v_mfma_f32_16x16x32_bf16 v[128:131], a[208:211], v[184:187], v[128:131]
    v_mfma_f32_16x16x32_bf16 v[132:135], a[212:215], v[184:187], v[132:135]
    v_mfma_f32_16x16x32_bf16 v[136:139], a[216:219], v[184:187], v[136:139]
    v_mfma_f32_16x16x32_bf16 v[140:143], a[220:223], v[184:187], v[140:143]
    v_mfma_f32_16x16x32_bf16 v[144:147], a[208:211], v[188:191], v[144:147]
    v_mfma_f32_16x16x32_bf16 v[148:151], a[212:215], v[188:191], v[148:151]
    v_mfma_f32_16x16x32_bf16 v[152:155], a[216:219], v[188:191], v[152:155]
    v_mfma_f32_16x16x32_bf16 v[156:159], a[220:223], v[188:191], v[156:159]
    s_waitcnt lgkmcnt(0)
    v_mfma_f32_16x16x32_bf16 v[96:99], a[224:227], v[160:163], v[96:99]
    ds_read_b128 v[176:179], v227 offset:57344
    v_mfma_f32_16x16x32_bf16 v[100:103], a[228:231], v[160:163], v[100:103]
    ds_read_b128 v[180:183], v227 offset:59392
    v_mfma_f32_16x16x32_bf16 v[104:107], a[232:235], v[160:163], v[104:107]
    ds_read_b128 v[184:187], v227 offset:61440
    v_mfma_f32_16x16x32_bf16 v[108:111], a[236:239], v[160:163], v[108:111]
    ds_read_b128 v[188:191], v227 offset:63488
    v_mfma_f32_16x16x32_bf16 v[112:115], a[224:227], v[164:167], v[112:115]
    v_mfma_f32_16x16x32_bf16 v[116:119], a[228:231], v[164:167], v[116:119]
    v_mfma_f32_16x16x32_bf16 v[120:123], a[232:235], v[164:167], v[120:123]
    v_mfma_f32_16x16x32_bf16 v[124:127], a[236:239], v[164:167], v[124:127]
    v_mfma_f32_16x16x32_bf16 v[128:131], a[224:227], v[168:171], v[128:131]
    v_mfma_f32_16x16x32_bf16 v[132:135], a[228:231], v[168:171], v[132:135]
    v_mfma_f32_16x16x32_bf16 v[136:139], a[232:235], v[168:171], v[136:139]
    v_mfma_f32_16x16x32_bf16 v[140:143], a[236:239], v[168:171], v[140:143]
    v_mfma_f32_16x16x32_bf16 v[144:147], a[224:227], v[172:175], v[144:147]
    v_mfma_f32_16x16x32_bf16 v[148:151], a[228:231], v[172:175], v[148:151]
    v_mfma_f32_16x16x32_bf16 v[152:155], a[232:235], v[172:175], v[152:155]
    v_mfma_f32_16x16x32_bf16 v[156:159], a[236:239], v[172:175], v[156:159]
    s_waitcnt vmcnt(22) lgkmcnt(0)
    s_barrier
    v_mfma_f32_16x16x32_bf16 v[96:99], a[240:243], v[176:179], v[96:99]
    ds_read_b128 v[160:163], v224 offset:0
    v_mfma_f32_16x16x32_bf16 v[100:103], a[244:247], v[176:179], v[100:103]
    ds_read_b128 v[164:167], v224 offset:2048
    v_mfma_f32_16x16x32_bf16 v[104:107], a[248:251], v[176:179], v[104:107]
    ds_read_b128 v[168:171], v224 offset:4096
    v_mfma_f32_16x16x32_bf16 v[108:111], a[252:255], v[176:179], v[108:111]
    ds_read_b128 v[172:175], v224 offset:6144
    v_mfma_f32_16x16x32_bf16 v[112:115], a[240:243], v[180:183], v[112:115]
    v_mfma_f32_16x16x32_bf16 v[116:119], a[244:247], v[180:183], v[116:119]
    v_mfma_f32_16x16x32_bf16 v[120:123], a[248:251], v[180:183], v[120:123]
    v_mfma_f32_16x16x32_bf16 v[124:127], a[252:255], v[180:183], v[124:127]
    v_mfma_f32_16x16x32_bf16 v[128:131], a[240:243], v[184:187], v[128:131]
    v_mfma_f32_16x16x32_bf16 v[132:135], a[244:247], v[184:187], v[132:135]
    v_cvt_pk_bf16_f32 v64, v96, v97
    v_cvt_pk_bf16_f32 v65, v98, v99
    v_mfma_f32_16x16x32_bf16 v[136:139], a[248:251], v[184:187], v[136:139]
    v_cvt_pk_bf16_f32 v66, v100, v101
    v_cvt_pk_bf16_f32 v67, v102, v103
    v_mfma_f32_16x16x32_bf16 v[140:143], a[252:255], v[184:187], v[140:143]
    v_cvt_pk_bf16_f32 v68, v104, v105
    v_cvt_pk_bf16_f32 v69, v106, v107
    v_mfma_f32_16x16x32_bf16 v[144:147], a[240:243], v[188:191], v[144:147]
    v_cvt_pk_bf16_f32 v70, v108, v109
    v_cvt_pk_bf16_f32 v71, v110, v111
    v_mfma_f32_16x16x32_bf16 v[148:151], a[244:247], v[188:191], v[148:151]
    v_cvt_pk_bf16_f32 v72, v112, v113
    v_cvt_pk_bf16_f32 v73, v114, v115
    v_mfma_f32_16x16x32_bf16 v[152:155], a[248:251], v[188:191], v[152:155]
    v_cvt_pk_bf16_f32 v74, v116, v117
    v_cvt_pk_bf16_f32 v75, v118, v119
    v_mfma_f32_16x16x32_bf16 v[156:159], a[252:255], v[188:191], v[156:159]
    v_cvt_pk_bf16_f32 v76, v120, v121
    v_cvt_pk_bf16_f32 v77, v122, v123
    s_waitcnt lgkmcnt(0)
    v_mfma_f32_16x16x32_bf16 v[96:99], a[0:3], v[160:163], 0
    ds_read_b128 v[176:179], v225 offset:0
    v_cvt_pk_bf16_f32 v78, v124, v125
    v_cvt_pk_bf16_f32 v79, v126, v127
    v_mfma_f32_16x16x32_bf16 v[100:103], a[4:7], v[160:163], 0
    ds_read_b128 v[180:183], v225 offset:2048
    v_cvt_pk_bf16_f32 v80, v128, v129
    v_cvt_pk_bf16_f32 v81, v130, v131
    v_mfma_f32_16x16x32_bf16 v[104:107], a[8:11], v[160:163], 0
    ds_read_b128 v[184:187], v225 offset:4096
    v_cvt_pk_bf16_f32 v82, v132, v133
    v_cvt_pk_bf16_f32 v83, v134, v135
    v_mfma_f32_16x16x32_bf16 v[108:111], a[12:15], v[160:163], 0
    ds_read_b128 v[188:191], v225 offset:6144
    v_cvt_pk_bf16_f32 v84, v136, v137
    v_cvt_pk_bf16_f32 v85, v138, v139
    v_mfma_f32_16x16x32_bf16 v[112:115], a[0:3], v[164:167], 0
    v_cvt_pk_bf16_f32 v86, v140, v141
    v_cvt_pk_bf16_f32 v87, v142, v143
    v_mfma_f32_16x16x32_bf16 v[116:119], a[4:7], v[164:167], 0
    v_cvt_pk_bf16_f32 v88, v144, v145
    v_cvt_pk_bf16_f32 v89, v146, v147
    v_mfma_f32_16x16x32_bf16 v[120:123], a[8:11], v[164:167], 0
    v_cvt_pk_bf16_f32 v90, v148, v149
    v_cvt_pk_bf16_f32 v91, v150, v151
    v_mfma_f32_16x16x32_bf16 v[124:127], a[12:15], v[164:167], 0
    v_cvt_pk_bf16_f32 v92, v152, v153
    v_cvt_pk_bf16_f32 v93, v154, v155
    v_mfma_f32_16x16x32_bf16 v[128:131], a[0:3], v[168:171], 0
    v_cvt_pk_bf16_f32 v94, v156, v157
    v_cvt_pk_bf16_f32 v95, v158, v159
    v_mfma_f32_16x16x32_bf16 v[132:135], a[4:7], v[168:171], 0
    v_mfma_f32_16x16x32_bf16 v[136:139], a[8:11], v[168:171], 0
    v_mfma_f32_16x16x32_bf16 v[140:143], a[12:15], v[168:171], 0
    s_add_u32 s38, s36, 65536
    buffer_store_dwordx4 v[64:67], v240, s[16:19], s38 offen offset:0 sc1
    v_mfma_f32_16x16x32_bf16 v[144:147], a[0:3], v[172:175], 0
    v_mfma_f32_16x16x32_bf16 v[148:151], a[4:7], v[172:175], 0
    v_mfma_f32_16x16x32_bf16 v[152:155], a[8:11], v[172:175], 0
    s_add_u32 s38, s36, 65536
    buffer_store_dwordx4 v[68:71], v240, s[16:19], s38 offen offset:2048 sc1
    v_mfma_f32_16x16x32_bf16 v[156:159], a[12:15], v[172:175], 0
    s_waitcnt lgkmcnt(0)
    v_mfma_f32_16x16x32_bf16 v[96:99], a[16:19], v[176:179], v[96:99]
    ds_read_b128 v[160:163], v224 offset:8192
    v_mfma_f32_16x16x32_bf16 v[100:103], a[20:23], v[176:179], v[100:103]
    ds_read_b128 v[164:167], v224 offset:10240
    v_mfma_f32_16x16x32_bf16 v[104:107], a[24:27], v[176:179], v[104:107]
    ds_read_b128 v[168:171], v224 offset:12288
    v_mfma_f32_16x16x32_bf16 v[108:111], a[28:31], v[176:179], v[108:111]
    ds_read_b128 v[172:175], v224 offset:14336
    v_mfma_f32_16x16x32_bf16 v[112:115], a[16:19], v[180:183], v[112:115]
    v_mfma_f32_16x16x32_bf16 v[116:119], a[20:23], v[180:183], v[116:119]
    v_mfma_f32_16x16x32_bf16 v[120:123], a[24:27], v[180:183], v[120:123]
    v_mfma_f32_16x16x32_bf16 v[124:127], a[28:31], v[180:183], v[124:127]
    v_mfma_f32_16x16x32_bf16 v[128:131], a[16:19], v[184:187], v[128:131]
    v_mfma_f32_16x16x32_bf16 v[132:135], a[20:23], v[184:187], v[132:135]
    v_mfma_f32_16x16x32_bf16 v[136:139], a[24:27], v[184:187], v[136:139]
    v_mfma_f32_16x16x32_bf16 v[140:143], a[28:31], v[184:187], v[140:143]
    s_add_u32 s38, s36, 65536
    buffer_store_dwordx4 v[72:75], v240, s[16:19], s38 offen offset:1024 sc1
    v_mfma_f32_16x16x32_bf16 v[144:147], a[16:19], v[188:191], v[144:147]
    v_mfma_f32_16x16x32_bf16 v[148:151], a[20:23], v[188:191], v[148:151]
    v_mfma_f32_16x16x32_bf16 v[152:155], a[24:27], v[188:191], v[152:155]
    s_add_u32 s38, s36, 65536
    buffer_store_dwordx4 v[76:79], v240, s[16:19], s38 offen offset:3072 sc1
    v_mfma_f32_16x16x32_bf16 v[156:159], a[28:31], v[188:191], v[156:159]
    s_waitcnt lgkmcnt(0)
    v_mfma_f32_16x16x32_bf16 v[96:99], a[32:35], v[160:163], v[96:99]
    ds_read_b128 v[176:179], v225 offset:8192
    v_mfma_f32_16x16x32_bf16 v[100:103], a[36:39], v[160:163], v[100:103]
    ds_read_b128 v[180:183], v225 offset:10240
    v_mfma_f32_16x16x32_bf16 v[104:107], a[40:43], v[160:163], v[104:107]
    ds_read_b128 v[184:187], v225 offset:12288
    v_mfma_f32_16x16x32_bf16 v[108:111], a[44:47], v[160:163], v[108:111]
    ds_read_b128 v[188:191], v225 offset:14336
    v_mfma_f32_16x16x32_bf16 v[112:115], a[32:35], v[164:167], v[112:115]
    v_mfma_f32_16x16x32_bf16 v[116:119], a[36:39], v[164:167], v[116:119]
    v_mfma_f32_16x16x32_bf16 v[120:123], a[40:43], v[164:167], v[120:123]
    v_mfma_f32_16x16x32_bf16 v[124:127], a[44:47], v[164:167], v[124:127]
    v_mfma_f32_16x16x32_bf16 v[128:131], a[32:35], v[168:171], v[128:131]
    v_mfma_f32_16x16x32_bf16 v[132:135], a[36:39], v[168:171], v[132:135]
    v_mfma_f32_16x16x32_bf16 v[136:139], a[40:43], v[168:171], v[136:139]
    v_mfma_f32_16x16x32_bf16 v[140:143], a[44:47], v[168:171], v[140:143]
    s_add_u32 s38, s36, 73728
    buffer_store_dwordx4 v[80:83], v240, s[16:19], s38 offen offset:0 sc1
    v_mfma_f32_16x16x32_bf16 v[144:147], a[32:35], v[172:175], v[144:147]
    v_mfma_f32_16x16x32_bf16 v[148:151], a[36:39], v[172:175], v[148:151]
    v_mfma_f32_16x16x32_bf16 v[152:155], a[40:43], v[172:175], v[152:155]
    s_add_u32 s38, s36, 73728
    buffer_store_dwordx4 v[84:87], v240, s[16:19], s38 offen offset:2048 sc1
    v_mfma_f32_16x16x32_bf16 v[156:159], a[44:47], v[172:175], v[156:159]
    s_waitcnt lgkmcnt(0)
    v_mfma_f32_16x16x32_bf16 v[96:99], a[48:51], v[176:179], v[96:99]
    ds_read_b128 v[160:163], v224 offset:16384
    v_mfma_f32_16x16x32_bf16 v[100:103], a[52:55], v[176:179], v[100:103]
    ds_read_b128 v[164:167], v224 offset:18432
    v_mfma_f32_16x16x32_bf16 v[104:107], a[56:59], v[176:179], v[104:107]
    ds_read_b128 v[168:171], v224 offset:20480
    v_mfma_f32_16x16x32_bf16 v[108:111], a[60:63], v[176:179], v[108:111]
    ds_read_b128 v[172:175], v224 offset:22528
    v_mfma_f32_16x16x32_bf16 v[112:115], a[48:51], v[180:183], v[112:115]
    v_mfma_f32_16x16x32_bf16 v[116:119], a[52:55], v[180:183], v[116:119]
    v_mfma_f32_16x16x32_bf16 v[120:123], a[56:59], v[180:183], v[120:123]
    v_mfma_f32_16x16x32_bf16 v[124:127], a[60:63], v[180:183], v[124:127]
    v_mfma_f32_16x16x32_bf16 v[128:131], a[48:51], v[184:187], v[128:131]
    v_mfma_f32_16x16x32_bf16 v[132:135], a[52:55], v[184:187], v[132:135]
    v_mfma_f32_16x16x32_bf16 v[136:139], a[56:59], v[184:187], v[136:139]
    v_mfma_f32_16x16x32_bf16 v[140:143], a[60:63], v[184:187], v[140:143]
    s_add_u32 s38, s36, 73728
    buffer_store_dwordx4 v[88:91], v240, s[16:19], s38 offen offset:1024 sc1
    v_mfma_f32_16x16x32_bf16 v[144:147], a[48:51], v[188:191], v[144:147]
    v_mfma_f32_16x16x32_bf16 v[148:151], a[52:55], v[188:191], v[148:151]
    v_mfma_f32_16x16x32_bf16 v[152:155], a[56:59], v[188:191], v[152:155]
    s_add_u32 s38, s36, 73728
    buffer_store_dwordx4 v[92:95], v240, s[16:19], s38 offen offset:3072 sc1
    v_mfma_f32_16x16x32_bf16 v[156:159], a[60:63], v[188:191], v[156:159]
    s_waitcnt lgkmcnt(0)
    v_mfma_f32_16x16x32_bf16 v[96:99], a[64:67], v[160:163], v[96:99]
    ds_read_b128 v[176:179], v225 offset:16384
    v_mfma_f32_16x16x32_bf16 v[100:103], a[68:71], v[160:163], v[100:103]
    ds_read_b128 v[180:183], v225 offset:18432
    v_mfma_f32_16x16x32_bf16 v[104:107], a[72:75], v[160:163], v[104:107]
    ds_read_b128 v[184:187], v225 offset:20480
    v_mfma_f32_16x16x32_bf16 v[108:111], a[76:79], v[160:163], v[108:111]
    ds_read_b128 v[188:191], v225 offset:22528
    v_mfma_f32_16x16x32_bf16 v[112:115], a[64:67], v[164:167], v[112:115]
    v_mfma_f32_16x16x32_bf16 v[116:119], a[68:71], v[164:167], v[116:119]
    v_mfma_f32_16x16x32_bf16 v[120:123], a[72:75], v[164:167], v[120:123]
    v_mfma_f32_16x16x32_bf16 v[124:127], a[76:79], v[164:167], v[124:127]
    v_mfma_f32_16x16x32_bf16 v[128:131], a[64:67], v[168:171], v[128:131]
    v_mfma_f32_16x16x32_bf16 v[132:135], a[68:71], v[168:171], v[132:135]
    v_mfma_f32_16x16x32_bf16 v[136:139], a[72:75], v[168:171], v[136:139]
    v_mfma_f32_16x16x32_bf16 v[140:143], a[76:79], v[168:171], v[140:143]
    v_mfma_f32_16x16x32_bf16 v[144:147], a[64:67], v[172:175], v[144:147]
    v_mfma_f32_16x16x32_bf16 v[148:151], a[68:71], v[172:175], v[148:151]
    v_mfma_f32_16x16x32_bf16 v[152:155], a[72:75], v[172:175], v[152:155]
    v_mfma_f32_16x16x32_bf16 v[156:159], a[76:79], v[172:175], v[156:159]
    s_waitcnt lgkmcnt(0)
    v_mfma_f32_16x16x32_bf16 v[96:99], a[80:83], v[176:179], v[96:99]
    ds_read_b128 v[160:163], v224 offset:24576
    v_mfma_f32_16x16x32_bf16 v[100:103], a[84:87], v[176:179], v[100:103]
    ds_read_b128 v[164:167], v224 offset:26624
    v_mfma_f32_16x16x32_bf16 v[104:107], a[88:91], v[176:179], v[104:107]
    ds_read_b128 v[168:171], v224 offset:28672
    v_mfma_f32_16x16x32_bf16 v[108:111], a[92:95], v[176:179], v[108:111]
    ds_read_b128 v[172:175], v224 offset:30720
    v_mfma_f32_16x16x32_bf16 v[112:115], a[80:83], v[180:183], v[112:115]
    v_mfma_f32_16x16x32_bf16 v[116:119], a[84:87], v[180:183], v[116:119]
    v_mfma_f32_16x16x32_bf16 v[120:123], a[88:91], v[180:183], v[120:123]
    v_mfma_f32_16x16x32_bf16 v[124:127], a[92:95], v[180:183], v[124:127]
    v_mfma_f32_16x16x32_bf16 v[128:131], a[80:83], v[184:187], v[128:131]
    v_mfma_f32_16x16x32_bf16 v[132:135], a[84:87], v[184:187], v[132:135]
    v_mfma_f32_16x16x32_bf16 v[136:139], a[88:91], v[184:187], v[136:139]
    v_mfma_f32_16x16x32_bf16 v[140:143], a[92:95], v[184:187], v[140:143]
    v_mfma_f32_16x16x32_bf16 v[144:147], a[80:83], v[188:191], v[144:147]
    v_mfma_f32_16x16x32_bf16 v[148:151], a[84:87], v[188:191], v[148:151]
    v_mfma_f32_16x16x32_bf16 v[152:155], a[88:91], v[188:191], v[152:155]
    v_mfma_f32_16x16x32_bf16 v[156:159], a[92:95], v[188:191], v[156:159]
    s_waitcnt lgkmcnt(0)
    v_mfma_f32_16x16x32_bf16 v[96:99], a[96:99], v[160:163], v[96:99]
    ds_read_b128 v[176:179], v225 offset:24576
    v_mfma_f32_16x16x32_bf16 v[100:103], a[100:103], v[160:163], v[100:103]
    ds_read_b128 v[180:183], v225 offset:26624
    v_mfma_f32_16x16x32_bf16 v[104:107], a[104:107], v[160:163], v[104:107]
    ds_read_b128 v[184:187], v225 offset:28672
    v_mfma_f32_16x16x32_bf16 v[108:111], a[108:111], v[160:163], v[108:111]
    ds_read_b128 v[188:191], v225 offset:30720
    v_mfma_f32_16x16x32_bf16 v[112:115], a[96:99], v[164:167], v[112:115]
    v_mfma_f32_16x16x32_bf16 v[116:119], a[100:103], v[164:167], v[116:119]
    buffer_load_dword v254, off, s[88:91], s39 sc1
    v_mfma_f32_16x16x32_bf16 v[120:123], a[104:107], v[164:167], v[120:123]
    v_mfma_f32_16x16x32_bf16 v[124:127], a[108:111], v[164:167], v[124:127]
    v_mfma_f32_16x16x32_bf16 v[128:131], a[96:99], v[168:171], v[128:131]
    v_mfma_f32_16x16x32_bf16 v[132:135], a[100:103], v[168:171], v[132:135]
    v_mfma_f32_16x16x32_bf16 v[136:139], a[104:107], v[168:171], v[136:139]
    v_mfma_f32_16x16x32_bf16 v[140:143], a[108:111], v[168:171], v[140:143]
    v_mfma_f32_16x16x32_bf16 v[144:147], a[96:99], v[172:175], v[144:147]
    v_mfma_f32_16x16x32_bf16 v[148:151], a[100:103], v[172:175], v[148:151]
    v_mfma_f32_16x16x32_bf16 v[152:155], a[104:107], v[172:175], v[152:155]
    v_mfma_f32_16x16x32_bf16 v[156:159], a[108:111], v[172:175], v[156:159]
    s_waitcnt lgkmcnt(0)
    v_mfma_f32_16x16x32_bf16 v[96:99], a[112:115], v[176:179], v[96:99]
    ds_read_b128 v[160:163], v224 offset:32768
    v_mfma_f32_16x16x32_bf16 v[100:103], a[116:119], v[176:179], v[100:103]
    ds_read_b128 v[164:167], v224 offset:34816
    v_mfma_f32_16x16x32_bf16 v[104:107], a[120:123], v[176:179], v[104:107]
    ds_read_b128 v[168:171], v224 offset:36864
    v_mfma_f32_16x16x32_bf16 v[108:111], a[124:127], v[176:179], v[108:111]
    ds_read_b128 v[172:175], v224 offset:38912
    v_mfma_f32_16x16x32_bf16 v[112:115], a[112:115], v[180:183], v[112:115]
    v_mfma_f32_16x16x32_bf16 v[116:119], a[116:119], v[180:183], v[116:119]
    s_add_u32 m0, s31, 0
    s_add_u32 s24, s27, 0
    buffer_load_dwordx4 v245, s[12:15], s24 offen lds
    v_mfma_f32_16x16x32_bf16 v[120:123], a[120:123], v[180:183], v[120:123]
    v_mfma_f32_16x16x32_bf16 v[124:127], a[124:127], v[180:183], v[124:127]
    s_add_u32 m0, s31, 1024
    s_add_u32 s24, s27, 32768
    buffer_load_dwordx4 v245, s[12:15], s24 offen lds
    v_mfma_f32_16x16x32_bf16 v[128:131], a[112:115], v[184:187], v[128:131]
    v_mfma_f32_16x16x32_bf16 v[132:135], a[116:119], v[184:187], v[132:135]
    s_add_u32 m0, s31, 2048
    s_add_u32 s24, s27, 65536
    buffer_load_dwordx4 v245, s[12:15], s24 offen lds
    v_mfma_f32_16x16x32_bf16 v[136:139], a[120:123], v[184:187], v[136:139]
    v_mfma_f32_16x16x32_bf16 v[140:143], a[124:127], v[184:187], v[140:143]
    s_add_u32 m0, s31, 3072
    s_add_u32 s24, s27, 98304
    buffer_load_dwordx4 v245, s[12:15], s24 offen lds
    v_mfma_f32_16x16x32_bf16 v[144:147], a[112:115], v[188:191], v[144:147]
    v_mfma_f32_16x16x32_bf16 v[148:151], a[116:119], v[188:191], v[148:151]
    s_add_u32 m0, s31, 4096
    s_add_u32 s24, s27, 131072
    buffer_load_dwordx4 v245, s[12:15], s24 offen lds
    v_mfma_f32_16x16x32_bf16 v[152:155], a[120:123], v[188:191], v[152:155]
    v_mfma_f32_16x16x32_bf16 v[156:159], a[124:127], v[188:191], v[156:159]
    s_waitcnt lgkmcnt(0)
    v_mfma_f32_16x16x32_bf16 v[96:99], a[128:131], v[160:163], v[96:99]
    ds_read_b128 v[176:179], v225 offset:32768
    v_mfma_f32_16x16x32_bf16 v[100:103], a[132:135], v[160:163], v[100:103]
    ds_read_b128 v[180:183], v225 offset:34816
    v_mfma_f32_16x16x32_bf16 v[104:107], a[136:139], v[160:163], v[104:107]
    ds_read_b128 v[184:187], v225 offset:36864
    v_mfma_f32_16x16x32_bf16 v[108:111], a[140:143], v[160:163], v[108:111]
    ds_read_b128 v[188:191], v225 offset:38912
    v_mfma_f32_16x16x32_bf16 v[112:115], a[128:131], v[164:167], v[112:115]
    v_mfma_f32_16x16x32_bf16 v[116:119], a[132:135], v[164:167], v[116:119]
    v_mfma_f32_16x16x32_bf16 v[120:123], a[136:139], v[164:167], v[120:123]
    v_mfma_f32_16x16x32_bf16 v[124:127], a[140:143], v[164:167], v[124:127]
    v_mfma_f32_16x16x32_bf16 v[128:131], a[128:131], v[168:171], v[128:131]
    v_mfma_f32_16x16x32_bf16 v[132:135], a[132:135], v[168:171], v[132:135]
    v_mfma_f32_16x16x32_bf16 v[136:139], a[136:139], v[168:171], v[136:139]
    v_mfma_f32_16x16x32_bf16 v[140:143], a[140:143], v[168:171], v[140:143]
    v_mfma_f32_16x16x32_bf16 v[144:147], a[128:131], v[172:175], v[144:147]
    v_mfma_f32_16x16x32_bf16 v[148:151], a[132:135], v[172:175], v[148:151]
    v_mfma_f32_16x16x32_bf16 v[152:155], a[136:139], v[172:175], v[152:155]
    v_mfma_f32_16x16x32_bf16 v[156:159], a[140:143], v[172:175], v[156:159]
    s_waitcnt lgkmcnt(0)
    v_mfma_f32_16x16x32_bf16 v[96:99], a[144:147], v[176:179], v[96:99]
    ds_read_b128 v[160:163], v224 offset:40960
    v_mfma_f32_16x16x32_bf16 v[100:103], a[148:151], v[176:179], v[100:103]
    ds_read_b128 v[164:167], v224 offset:43008
    v_mfma_f32_16x16x32_bf16 v[104:107], a[152:155], v[176:179], v[104:107]
    ds_read_b128 v[168:171], v224 offset:45056
    v_mfma_f32_16x16x32_bf16 v[108:111], a[156:159], v[176:179], v[108:111]
    ds_read_b128 v[172:175], v224 offset:47104
    v_mfma_f32_16x16x32_bf16 v[112:115], a[144:147], v[180:183], v[112:115]
    v_mfma_f32_16x16x32_bf16 v[116:119], a[148:151], v[180:183], v[116:119]
    s_add_u32 m0, s31, 5120
    s_add_u32 s24, s27, 163840
    buffer_load_dwordx4 v245, s[12:15], s24 offen lds
    v_mfma_f32_16x16x32_bf16 v[120:123], a[152:155], v[180:183], v[120:123]
    v_mfma_f32_16x16x32_bf16 v[124:127], a[156:159], v[180:183], v[124:127]
    s_add_u32 m0, s31, 6144
    s_add_u32 s24, s27, 196608
    buffer_load_dwordx4 v245, s[12:15], s24 offen lds
    v_mfma_f32_16x16x32_bf16 v[128:131], a[144:147], v[184:187], v[128:131]
    v_mfma_f32_16x16x32_bf16 v[132:135], a[148:151], v[184:187], v[132:135]
    s_add_u32 m0, s31, 7168
    s_add_u32 s24, s27, 229376
    buffer_load_dwordx4 v245, s[12:15], s24 offen lds
    v_mfma_f32_16x16x32_bf16 v[136:139], a[152:155], v[184:187], v[136:139]
    v_mfma_f32_16x16x32_bf16 v[140:143], a[156:159], v[184:187], v[140:143]
    s_add_u32 s27, s27, 1048576
    s_and_b32 s27, s27, 0x407fffff
    s_cmp_eq_u32 s27, s7
    s_cselect_b32 s27, s43, s27
    v_mfma_f32_16x16x32_bf16 v[144:147], a[144:147], v[188:191], v[144:147]
    v_mfma_f32_16x16x32_bf16 v[148:151], a[148:151], v[188:191], v[148:151]
    s_add_u32 s31, s31, 32768
    s_cmp_ge_u32 s31, 163840
    s_cselect_b32 s24, 98304, 0
    s_sub_u32 s31, s31, s24
    v_mfma_f32_16x16x32_bf16 v[152:155], a[152:155], v[188:191], v[152:155]
    v_mfma_f32_16x16x32_bf16 v[156:159], a[156:159], v[188:191], v[156:159]
    s_waitcnt lgkmcnt(0)
    v_mfma_f32_16x16x32_bf16 v[96:99], a[160:163], v[160:163], v[96:99]
    ds_read_b128 v[176:179], v225 offset:40960
    v_mfma_f32_16x16x32_bf16 v[100:103], a[164:167], v[160:163], v[100:103]
    ds_read_b128 v[180:183], v225 offset:43008
    v_mfma_f32_16x16x32_bf16 v[104:107], a[168:171], v[160:163], v[104:107]
    ds_read_b128 v[184:187], v225 offset:45056
    v_mfma_f32_16x16x32_bf16 v[108:111], a[172:175], v[160:163], v[108:111]
    ds_read_b128 v[188:191], v225 offset:47104
    v_mfma_f32_16x16x32_bf16 v[112:115], a[160:163], v[164:167], v[112:115]
    v_mfma_f32_16x16x32_bf16 v[116:119], a[164:167], v[164:167], v[116:119]
    v_mfma_f32_16x16x32_bf16 v[120:123], a[168:171], v[164:167], v[120:123]
    v_mfma_f32_16x16x32_bf16 v[124:127], a[172:175], v[164:167], v[124:127]
    v_mfma_f32_16x16x32_bf16 v[128:131], a[160:163], v[168:171], v[128:131]
    v_mfma_f32_16x16x32_bf16 v[132:135], a[164:167], v[168:171], v[132:135]
    v_mfma_f32_16x16x32_bf16 v[136:139], a[168:171], v[168:171], v[136:139]
    v_mfma_f32_16x16x32_bf16 v[140:143], a[172:175], v[168:171], v[140:143]
    v_mfma_f32_16x16x32_bf16 v[144:147], a[160:163], v[172:175], v[144:147]
    v_mfma_f32_16x16x32_bf16 v[148:151], a[164:167], v[172:175], v[148:151]
    v_mfma_f32_16x16x32_bf16 v[152:155], a[168:171], v[172:175], v[152:155]
    v_mfma_f32_16x16x32_bf16 v[156:159], a[172:175], v[172:175], v[156:159]
    s_waitcnt vmcnt(8)
    v_readfirstlane_b32 s24, v254
    s_lshl_b32 s25, s3, 16
    s_add_u32 s24, s24, s25
    s_cmp_ge_u32 s24, 32
    s_cbranch_scc0 ka_spin31
ka_spinr32:
    s_waitcnt lgkmcnt(0)
    s_barrier
    v_mfma_f32_16x16x32_bf16 v[96:99], a[176:179], v[176:179], v[96:99]
    ds_read_b128 v[160:163], v224 offset:49152
    v_mfma_f32_16x16x32_bf16 v[100:103], a[180:183], v[176:179], v[100:103]
    ds_read_b128 v[164:167], v224 offset:51200
    v_mfma_f32_16x16x32_bf16 v[104:107], a[184:187], v[176:179], v[104:107]
    ds_read_b128 v[168:171], v224 offset:53248
    v_mfma_f32_16x16x32_bf16 v[108:111], a[188:191], v[176:179], v[108:111]
    ds_read_b128 v[172:175], v224 offset:55296
    v_mfma_f32_16x16x32_bf16 v[112:115], a[176:179], v[180:183], v[112:115]
    v_mfma_f32_16x16x32_bf16 v[116:119], a[180:183], v[180:183], v[116:119]
    buffer_load_dwordx4 v[0:3], v248, s[8:11], s28 offen offset:0 sc1
    v_mfma_f32_16x16x32_bf16 v[120:123], a[184:187], v[180:183], v[120:123]
    v_mfma_f32_16x16x32_bf16 v[124:127], a[188:191], v[180:183], v[124:127]
    buffer_load_dwordx4 v[4:7], v249, s[8:11], s28 offen offset:0 sc1
    v_mfma_f32_16x16x32_bf16 v[128:131], a[176:179], v[184:187], v[128:131]
    v_mfma_f32_16x16x32_bf16 v[132:135], a[180:183], v[184:187], v[132:135]
    buffer_load_dwordx4 v[8:11], v248, s[8:11], s28 offen offset:1024 sc1
    v_mfma_f32_16x16x32_bf16 v[136:139], a[184:187], v[184:187], v[136:139]
    v_mfma_f32_16x16x32_bf16 v[140:143], a[188:191], v[184:187], v[140:143]
    buffer_load_dwordx4 v[12:15], v249, s[8:11], s28 offen offset:1024 sc1
    v_mfma_f32_16x16x32_bf16 v[144:147], a[176:179], v[188:191], v[144:147]
    v_mfma_f32_16x16x32_bf16 v[148:151], a[180:183], v[188:191], v[148:151]
    v_mfma_f32_16x16x32_bf16 v[152:155], a[184:187], v[188:191], v[152:155]
    v_mfma_f32_16x16x32_bf16 v[156:159], a[188:191], v[188:191], v[156:159]
    s_waitcnt lgkmcnt(0)
    v_mfma_f32_16x16x32_bf16 v[96:99], a[192:195], v[160:163], v[96:99]
    ds_read_b128 v[176:179], v225 offset:49152
    v_mfma_f32_16x16x32_bf16 v[100:103], a[196:199], v[160:163], v[100:103]
    ds_read_b128 v[180:183], v225 offset:51200
    v_mfma_f32_16x16x32_bf16 v[104:107], a[200:203], v[160:163], v[104:107]
    ds_read_b128 v[184:187], v225 offset:53248
    v_mfma_f32_16x16x32_bf16 v[108:111], a[204:207], v[160:163], v[108:111]
    ds_read_b128 v[188:191], v225 offset:55296
    v_mfma_f32_16x16x32_bf16 v[112:115], a[192:195], v[164:167], v[112:115]
    v_mfma_f32_16x16x32_bf16 v[116:119], a[196:199], v[164:167], v[116:119]
    buffer_load_dwordx4 v[16:19], v248, s[8:11], s28 offen offset:2048 sc1
    v_mfma_f32_16x16x32_bf16 v[120:123], a[200:203], v[164:167], v[120:123]
    v_mfma_f32_16x16x32_bf16 v[124:127], a[204:207], v[164:167], v[124:127]
    buffer_load_dwordx4 v[20:23], v249, s[8:11], s28 offen offset:2048 sc1
    v_mfma_f32_16x16x32_bf16 v[128:131], a[192:195], v[168:171], v[128:131]
    v_mfma_f32_16x16x32_bf16 v[132:135], a[196:199], v[168:171], v[132:135]
    buffer_load_dwordx4 v[24:27], v248, s[8:11], s28 offen offset:3072 sc1
    v_mfma_f32_16x16x32_bf16 v[136:139], a[200:203], v[168:171], v[136:139]
    v_mfma_f32_16x16x32_bf16 v[140:143], a[204:207], v[168:171], v[140:143]
    buffer_load_dwordx4 v[28:31], v249, s[8:11], s28 offen offset:3072 sc1
    v_mfma_f32_16x16x32_bf16 v[144:147], a[192:195], v[172:175], v[144:147]
    v_mfma_f32_16x16x32_bf16 v[148:151], a[196:199], v[172:175], v[148:151]
    v_mfma_f32_16x16x32_bf16 v[152:155], a[200:203], v[172:175], v[152:155]
    v_mfma_f32_16x16x32_bf16 v[156:159], a[204:207], v[172:175], v[156:159]
    s_waitcnt lgkmcnt(0)
    v_mfma_f32_16x16x32_bf16 v[96:99], a[208:211], v[176:179], v[96:99]
    ds_read_b128 v[160:163], v224 offset:57344
    v_mfma_f32_16x16x32_bf16 v[100:103], a[212:215], v[176:179], v[100:103]
    ds_read_b128 v[164:167], v224 offset:59392
    v_mfma_f32_16x16x32_bf16 v[104:107], a[216:219], v[176:179], v[104:107]
    ds_read_b128 v[168:171], v224 offset:61440
    v_mfma_f32_16x16x32_bf16 v[108:111], a[220:223], v[176:179], v[108:111]
    ds_read_b128 v[172:175], v224 offset:63488
    v_mfma_f32_16x16x32_bf16 v[112:115], a[208:211], v[180:183], v[112:115]
    v_mfma_f32_16x16x32_bf16 v[116:119], a[212:215], v[180:183], v[116:119]
    buffer_load_dwordx4 v[32:35], v248, s[8:11], s29 offen offset:0 sc1
    v_mfma_f32_16x16x32_bf16 v[120:123], a[216:219], v[180:183], v[120:123]
    v_mfma_f32_16x16x32_bf16 v[124:127], a[220:223], v[180:183], v[124:127]
    buffer_load_dwordx4 v[36:39], v249, s[8:11], s29 offen offset:0 sc1
    v_mfma_f32_16x16x32_bf16 v[128:131], a[208:211], v[184:187], v[128:131]
    v_mfma_f32_16x16x32_bf16 v[132:135], a[212:215], v[184:187], v[132:135]
    buffer_load_dwordx4 v[40:43], v248, s[8:11], s29 offen offset:1024 sc1
    v_mfma_f32_16x16x32_bf16 v[136:139], a[216:219], v[184:187], v[136:139]
    v_mfma_f32_16x16x32_bf16 v[140:143], a[220:223], v[184:187], v[140:143]
    buffer_load_dwordx4 v[44:47], v249, s[8:11], s29 offen offset:1024 sc1
    v_mfma_f32_16x16x32_bf16 v[144:147], a[208:211], v[188:191], v[144:147]
    v_mfma_f32_16x16x32_bf16 v[148:151], a[212:215], v[188:191], v[148:151]
    v_mfma_f32_16x16x32_bf16 v[152:155], a[216:219], v[188:191], v[152:155]
    v_mfma_f32_16x16x32_bf16 v[156:159], a[220:223], v[188:191], v[156:159]
    s_waitcnt lgkmcnt(0)
    v_mfma_f32_16x16x32_bf16 v[96:99], a[224:227], v[160:163], v[96:99]
    ds_read_b128 v[176:179], v225 offset:57344
    v_mfma_f32_16x16x32_bf16 v[100:103], a[228:231], v[160:163], v[100:103]
    ds_read_b128 v[180:183], v225 offset:59392
    v_mfma_f32_16x16x32_bf16 v[104:107], a[232:235], v[160:163], v[104:107]
    ds_read_b128 v[184:187], v225 offset:61440
    v_mfma_f32_16x16x32_bf16 v[108:111], a[236:239], v[160:163], v[108:111]
    ds_read_b128 v[188:191], v225 offset:63488
    v_mfma_f32_16x16x32_bf16 v[112:115], a[224:227], v[164:167], v[112:115]
    v_mfma_f32_16x16x32_bf16 v[116:119], a[228:231], v[164:167], v[116:119]
    buffer_load_dwordx4 v[48:51], v248, s[8:11], s29 offen offset:2048 sc1
    v_mfma_f32_16x16x32_bf16 v[120:123], a[232:235], v[164:167], v[120:123]
    v_mfma_f32_16x16x32_bf16 v[124:127], a[236:239], v[164:167], v[124:127]
    buffer_load_dwordx4 v[52:55], v249, s[8:11], s29 offen offset:2048 sc1
    v_mfma_f32_16x16x32_bf16 v[128:131], a[224:227], v[168:171], v[128:131]
    v_mfma_f32_16x16x32_bf16 v[132:135], a[228:231], v[168:171], v[132:135]
    buffer_load_dwordx4 v[56:59], v248, s[8:11], s29 offen offset:3072 sc1
    v_mfma_f32_16x16x32_bf16 v[136:139], a[232:235], v[168:171], v[136:139]
    v_mfma_f32_16x16x32_bf16 v[140:143], a[236:239], v[168:171], v[140:143]
    buffer_load_dwordx4 v[60:63], v249, s[8:11], s29 offen offset:3072 sc1
    v_mfma_f32_16x16x32_bf16 v[144:147], a[224:227], v[172:175], v[144:147]
    v_mfma_f32_16x16x32_bf16 v[148:151], a[228:231], v[172:175], v[148:151]
    v_mfma_f32_16x16x32_bf16 v[152:155], a[232:235], v[172:175], v[152:155]
    v_mfma_f32_16x16x32_bf16 v[156:159], a[236:239], v[172:175], v[156:159]
    s_waitcnt vmcnt(34) lgkmcnt(0)
    s_barrier
    v_mfma_f32_16x16x32_bf16 v[96:99], a[240:243], v[176:179], v[96:99]
    ds_read_b64_tr_b16 a[192:193], v246 offset:0
    v_mfma_f32_16x16x32_bf16 v[100:103], a[244:247], v[176:179], v[100:103]
    ds_read_b64_tr_b16 a[194:195], v246 offset:1024
    v_mfma_f32_16x16x32_bf16 v[104:107], a[248:251], v[176:179], v[104:107]
    ds_read_b64_tr_b16 a[196:197], v246 offset:256
    v_mfma_f32_16x16x32_bf16 v[108:111], a[252:255], v[176:179], v[108:111]
    ds_read_b64_tr_b16 a[198:199], v246 offset:1280
    v_mfma_f32_16x16x32_bf16 v[112:115], a[240:243], v[180:183], v[112:115]
    ds_read_b64_tr_b16 a[200:201], v246 offset:512
    v_mfma_f32_16x16x32_bf16 v[116:119], a[244:247], v[180:183], v[116:119]
    ds_read_b64_tr_b16 a[202:203], v246 offset:1536
    s_add_u32 s28, s28, 8192
    s_and_b32 s28, s28, 65535
    s_add_u32 s29, s28, 4096
    v_mfma_f32_16x16x32_bf16 v[120:123], a[248:251], v[180:183], v[120:123]
    ds_read_b64_tr_b16 a[204:205], v246 offset:768
    v_mfma_f32_16x16x32_bf16 v[124:127], a[252:255], v[180:183], v[124:127]
    ds_read_b64_tr_b16 a[206:207], v246 offset:1792
    v_mfma_f32_16x16x32_bf16 v[128:131], a[240:243], v[184:187], v[128:131]
    v_mfma_f32_16x16x32_bf16 v[132:135], a[244:247], v[184:187], v[132:135]
    v_cvt_pk_bf16_f32 v64, v96, v97
    v_cvt_pk_bf16_f32 v65, v98, v99
    v_mfma_f32_16x16x32_bf16 v[136:139], a[248:251], v[184:187], v[136:139]
    v_cvt_pk_bf16_f32 v66, v100, v101
    v_cvt_pk_bf16_f32 v67, v102, v103
    v_mfma_f32_16x16x32_bf16 v[140:143], a[252:255], v[184:187], v[140:143]
    v_cvt_pk_bf16_f32 v68, v104, v105
    v_cvt_pk_bf16_f32 v69, v106, v107
    v_mfma_f32_16x16x32_bf16 v[144:147], a[240:243], v[188:191], v[144:147]
    v_cvt_pk_bf16_f32 v70, v108, v109
    v_cvt_pk_bf16_f32 v71, v110, v111
    v_mfma_f32_16x16x32_bf16 v[148:151], a[244:247], v[188:191], v[148:151]
    v_cvt_pk_bf16_f32 v72, v112, v113
    v_cvt_pk_bf16_f32 v73, v114, v115
    v_mfma_f32_16x16x32_bf16 v[152:155], a[248:251], v[188:191], v[152:155]
    v_cvt_pk_bf16_f32 v74, v116, v117
    v_cvt_pk_bf16_f32 v75, v118, v119
    v_mfma_f32_16x16x32_bf16 v[156:159], a[252:255], v[188:191], v[156:159]
    v_cvt_pk_bf16_f32 v76, v120, v121
    v_cvt_pk_bf16_f32 v77, v122, v123
    s_nop 3
    v_cvt_pk_bf16_f32 v78, v124, v125
    v_cvt_pk_bf16_f32 v79, v126, v127
    v_cvt_pk_bf16_f32 v80, v128, v129
    v_cvt_pk_bf16_f32 v81, v130, v131
    v_cvt_pk_bf16_f32 v82, v132, v133
    v_cvt_pk_bf16_f32 v83, v134, v135
    v_cvt_pk_bf16_f32 v84, v136, v137
    v_cvt_pk_bf16_f32 v85, v138, v139
    v_cvt_pk_bf16_f32 v86, v140, v141
    v_cvt_pk_bf16_f32 v87, v142, v143
    v_cvt_pk_bf16_f32 v88, v144, v145
    v_cvt_pk_bf16_f32 v89, v146, v147
    v_cvt_pk_bf16_f32 v90, v148, v149
    v_cvt_pk_bf16_f32 v91, v150, v151
    v_cvt_pk_bf16_f32 v92, v152, v153
    v_cvt_pk_bf16_f32 v93, v154, v155
    v_cvt_pk_bf16_f32 v94, v156, v157
    v_cvt_pk_bf16_f32 v95, v158, v159
    s_add_u32 s80, s36, 98304
    s_add_u32 s81, s36, 100352
    s_add_u32 s82, s36, 99328
    s_add_u32 s83, s36, 101376
    s_add_u32 s84, s36, 106496
    s_add_u32 s85, s36, 108544
    s_add_u32 s86, s36, 107520
    s_add_u32 s87, s36, 109568
    s_branch ka_Q
ka_V:
    s_waitcnt lgkmcnt(0)
    v_mfma_f32_16x16x32_bf16 v[96:99], v[160:163], a[0:3], 0
    ds_read_b128 v[176:179], v225 offset:0
    ds_read_b128 v[180:183], v225 offset:2048
    v_mfma_f32_16x16x32_bf16 v[100:103], v[164:167], a[0:3], 0
    ds_read_b128 v[184:187], v225 offset:4096
    v_mfma_f32_16x16x32_bf16 v[104:107], v[160:163], a[4:7], 0
    ds_read_b128 v[188:191], v225 offset:6144
    ds_read_b64_tr_b16 a[16:17], v228 offset:4096
    v_mfma_f32_16x16x32_bf16 v[108:111], v[164:167], a[4:7], 0
    ds_read_b64_tr_b16 a[18:19], v228 offset:4608
    v_mfma_f32_16x16x32_bf16 v[112:115], v[160:163], a[8:11], 0
    ds_read_b64_tr_b16 a[20:21], v229 offset:4096
    ds_read_b64_tr_b16 a[22:23], v229 offset:4608
    s_add_u32 m0, s34, 16384
    s_add_u32 s37, s82, 0
    buffer_load_dwordx4 v232, s[44:47], s37 offen lds
    v_mfma_f32_16x16x32_bf16 v[116:119], v[164:167], a[8:11], 0
    ds_read_b64_tr_b16 a[24:25], v230 offset:4096
    buffer_load_dwordx4 v233, s[44:47], s37 offen offset:1024 lds
    v_mfma_f32_16x16x32_bf16 v[120:123], v[160:163], a[12:15], 0
    ds_read_b64_tr_b16 a[26:27], v230 offset:4608
    ds_read_b64_tr_b16 a[28:29], v231 offset:4096
    s_add_u32 m0, s34, 24576
    s_add_u32 s37, s83, 0
    buffer_load_dwordx4 v232, s[44:47], s37 offen lds
    v_mfma_f32_16x16x32_bf16 v[124:127], v[164:167], a[12:15], 0
    ds_read_b64_tr_b16 a[30:31], v231 offset:4608
    buffer_load_dwordx4 v233, s[44:47], s37 offen offset:1024 lds
    v_mfma_f32_16x16x32_bf16 v[128:131], v[168:171], a[0:3], 0
    s_add_u32 m0, s35, 16384
    s_and_b32 s33, s82, 1023
    s_lshl_b32 s33, s33, 12
    buffer_load_dwordx4 v234, s[48:51], s33 offen lds
    v_mfma_f32_16x16x32_bf16 v[132:135], v[172:175], a[0:3], 0
    buffer_load_dwordx4 v235, s[48:51], s33 offen offset:1024 lds
    v_mfma_f32_16x16x32_bf16 v[136:139], v[168:171], a[4:7], 0
    s_add_u32 m0, s35, 18432
    s_add_u32 s33, s33, 131072
    buffer_load_dwordx4 v234, s[48:51], s33 offen lds
    v_mfma_f32_16x16x32_bf16 v[140:143], v[172:175], a[4:7], 0
    buffer_load_dwordx4 v235, s[48:51], s33 offen offset:1024 lds
    v_mfma_f32_16x16x32_bf16 v[144:147], v[168:171], a[8:11], 0
    s_add_u32 m0, s35, 20480
    s_add_u32 s33, s33, 131072
    buffer_load_dwordx4 v234, s[48:51], s33 offen lds
    v_mfma_f32_16x16x32_bf16 v[148:151], v[172:175], a[8:11], 0
    buffer_load_dwordx4 v235, s[48:51], s33 offen offset:1024 lds
    v_mfma_f32_16x16x32_bf16 v[152:155], v[168:171], a[12:15], 0
    s_add_u32 m0, s35, 22528
    s_add_u32 s33, s33, 131072
    buffer_load_dwordx4 v234, s[48:51], s33 offen lds
    v_mfma_f32_16x16x32_bf16 v[156:159], v[172:175], a[12:15], 0
    buffer_load_dwordx4 v235, s[48:51], s33 offen offset:1024 lds
    s_waitcnt vmcnt(12) lgkmcnt(0)
    v_mfma_f32_16x16x32_bf16 v[96:99], v[176:179], a[16:19], v[96:99]
    ds_read_b128 v[160:163], v224 offset:8192
    ds_read_b128 v[164:167], v224 offset:10240
    v_mfma_f32_16x16x32_bf16 v[100:103], v[180:183], a[16:19], v[100:103]
    ds_read_b128 v[168:171], v224 offset:12288
    v_mfma_f32_16x16x32_bf16 v[104:107], v[176:179], a[20:23], v[104:107]
    ds_read_b128 v[172:175], v224 offset:14336
    ds_read_b64_tr_b16 a[32:33], v228 offset:8192
    v_mfma_f32_16x16x32_bf16 v[108:111], v[180:183], a[20:23], v[108:111]
    ds_read_b64_tr_b16 a[34:35], v228 offset:8704
    v_mfma_f32_16x16x32_bf16 v[112:115], v[176:179], a[24:27], v[112:115]
    ds_read_b64_tr_b16 a[36:37], v229 offset:8192
    ds_read_b64_tr_b16 a[38:39], v229 offset:8704
    s_add_u32 m0, s35, 0
    s_and_b32 s33, s83, 1023
    s_lshl_b32 s33, s33, 12
    buffer_load_dwordx4 v234, s[48:51], s33 offen lds
    v_mfma_f32_16x16x32_bf16 v[116:119], v[180:183], a[24:27], v[116:119]
    ds_read_b64_tr_b16 a[40:41], v230 offset:8192
    buffer_load_dwordx4 v235, s[48:51], s33 offen offset:1024 lds
    v_mfma_f32_16x16x32_bf16 v[120:123], v[176:179], a[28:31], v[120:123]
    ds_read_b64_tr_b16 a[42:43], v230 offset:8704
    ds_read_b64_tr_b16 a[44:45], v231 offset:8192
    s_add_u32 m0, s35, 2048
    s_add_u32 s33, s33, 131072
    buffer_load_dwordx4 v234, s[48:51], s33 offen lds
    v_mfma_f32_16x16x32_bf16 v[124:127], v[180:183], a[28:31], v[124:127]
    ds_read_b64_tr_b16 a[46:47], v231 offset:8704
    buffer_load_dwordx4 v235, s[48:51], s33 offen offset:1024 lds
    v_mfma_f32_16x16x32_bf16 v[128:131], v[184:187], a[16:19], v[128:131]
    s_add_u32 m0, s35, 4096
    s_add_u32 s33, s33, 131072
    buffer_load_dwordx4 v234, s[48:51], s33 offen lds
    v_mfma_f32_16x16x32_bf16 v[132:135], v[188:191], a[16:19], v[132:135]
    buffer_load_dwordx4 v235, s[48:51], s33 offen offset:1024 lds
    v_mfma_f32_16x16x32_bf16 v[136:139], v[184:187], a[20:23], v[136:139]
    s_add_u32 m0, s35, 6144
    s_add_u32 s33, s33, 131072
    buffer_load_dwordx4 v234, s[48:51], s33 offen lds
    v_mfma_f32_16x16x32_bf16 v[140:143], v[188:191], a[20:23], v[140:143]
    buffer_load_dwordx4 v235, s[48:51], s33 offen offset:1024 lds
    v_mfma_f32_16x16x32_bf16 v[144:147], v[184:187], a[24:27], v[144:147]
    v_mfma_f32_16x16x32_bf16 v[148:151], v[188:191], a[24:27], v[148:151]
    v_mfma_f32_16x16x32_bf16 v[152:155], v[184:187], a[28:31], v[152:155]
    v_mfma_f32_16x16x32_bf16 v[156:159], v[188:191], a[28:31], v[156:159]
    s_waitcnt lgkmcnt(0)
    v_mfma_f32_16x16x32_bf16 v[96:99], v[160:163], a[32:35], v[96:99]
    ds_read_b128 v[176:179], v225 offset:8192
    ds_read_b128 v[180:183], v225 offset:10240
    v_mfma_f32_16x16x32_bf16 v[100:103], v[164:167], a[32:35], v[100:103]
    ds_read_b128 v[184:187], v225 offset:12288
    v_mfma_f32_16x16x32_bf16 v[104:107], v[160:163], a[36:39], v[104:107]
    ds_read_b128 v[188:191], v225 offset:14336
    ds_read_b64_tr_b16 a[48:49], v228 offset:12288
    v_mfma_f32_16x16x32_bf16 v[108:111], v[164:167], a[36:39], v[108:111]
    ds_read_b64_tr_b16 a[50:51], v228 offset:12800
    v_mfma_f32_16x16x32_bf16 v[112:115], v[160:163], a[40:43], v[112:115]
    ds_read_b64_tr_b16 a[52:53], v229 offset:12288
    ds_read_b64_tr_b16 a[54:55], v229 offset:12800
    v_mfma_f32_16x16x32_bf16 v[116:119], v[164:167], a[40:43], v[116:119]
    ds_read_b64_tr_b16 a[56:57], v230 offset:12288
    s_add_u32 m0, s34, 32768
    s_add_u32 s37, s84, 0
    buffer_load_dwordx4 v232, s[44:47], s37 offen lds
    v_mfma_f32_16x16x32_bf16 v[120:123], v[160:163], a[44:47], v[120:123]
    ds_read_b64_tr_b16 a[58:59], v230 offset:12800
    ds_read_b64_tr_b16 a[60:61], v231 offset:12288
    v_mfma_f32_16x16x32_bf16 v[124:127], v[164:167], a[44:47], v[124:127]
    ds_read_b64_tr_b16 a[62:63], v231 offset:12800
    buffer_load_dwordx4 v233, s[44:47], s37 offen offset:1024 lds
    v_mfma_f32_16x16x32_bf16 v[128:131], v[168:171], a[32:35], v[128:131]
    v_mfma_f32_16x16x32_bf16 v[132:135], v[172:175], a[32:35], v[132:135]
    s_add_u32 m0, s34, 40960
    s_add_u32 s37, s85, 0
    buffer_load_dwordx4 v232, s[44:47], s37 offen lds
    v_mfma_f32_16x16x32_bf16 v[136:139], v[168:171], a[36:39], v[136:139]
    v_mfma_f32_16x16x32_bf16 v[140:143], v[172:175], a[36:39], v[140:143]
    buffer_load_dwordx4 v233, s[44:47], s37 offen offset:1024 lds
    v_mfma_f32_16x16x32_bf16 v[144:147], v[168:171], a[40:43], v[144:147]
    v_mfma_f32_16x16x32_bf16 v[148:151], v[172:175], a[40:43], v[148:151]
    v_mfma_f32_16x16x32_bf16 v[152:155], v[168:171], a[44:47], v[152:155]
    v_mfma_f32_16x16x32_bf16 v[156:159], v[172:175], a[44:47], v[156:159]
    s_waitcnt vmcnt(12) lgkmcnt(0)
    s_barrier
    v_mfma_f32_16x16x32_bf16 v[96:99], v[176:179], a[48:51], v[96:99]
    ds_read_b128 v[160:163], v224 offset:16384
    ds_read_b128 v[164:167], v224 offset:18432
    v_mfma_f32_16x16x32_bf16 v[100:103], v[180:183], a[48:51], v[100:103]
    ds_read_b128 v[168:171], v224 offset:20480
    v_mfma_f32_16x16x32_bf16 v[104:107], v[176:179], a[52:55], v[104:107]
    ds_read_b128 v[172:175], v224 offset:22528
    ds_read_b64_tr_b16 a[64:65], v228 offset:16384
    v_mfma_f32_16x16x32_bf16 v[108:111], v[180:183], a[52:55], v[108:111]
    ds_read_b64_tr_b16 a[66:67], v228 offset:16896
    v_mfma_f32_16x16x32_bf16 v[112:115], v[176:179], a[56:59], v[112:115]
    ds_read_b64_tr_b16 a[68:69], v229 offset:16384
    ds_read_b64_tr_b16 a[70:71], v229 offset:16896
    s_add_u32 m0, s35, 8192
    s_and_b32 s33, s84, 1023
    s_lshl_b32 s33, s33, 12
    buffer_load_dwordx4 v234, s[48:51], s33 offen lds
    v_mfma_f32_16x16x32_bf16 v[116:119], v[180:183], a[56:59], v[116:119]
    ds_read_b64_tr_b16 a[72:73], v230 offset:16384
    buffer_load_dwordx4 v235, s[48:51], s33 offen offset:1024 lds
    v_mfma_f32_16x16x32_bf16 v[120:123], v[176:179], a[60:63], v[120:123]
    ds_read_b64_tr_b16 a[74:75], v230 offset:16896
    ds_read_b64_tr_b16 a[76:77], v231 offset:16384
    s_add_u32 m0, s35, 10240
    s_add_u32 s33, s33, 131072
    buffer_load_dwordx4 v234, s[48:51], s33 offen lds
    v_mfma_f32_16x16x32_bf16 v[124:127], v[180:183], a[60:63], v[124:127]
    ds_read_b64_tr_b16 a[78:79], v231 offset:16896
    buffer_load_dwordx4 v235, s[48:51], s33 offen offset:1024 lds
    v_mfma_f32_16x16x32_bf16 v[128:131], v[184:187], a[48:51], v[128:131]
    s_add_u32 m0, s35, 12288
    s_add_u32 s33, s33, 131072
    buffer_load_dwordx4 v234, s[48:51], s33 offen lds
    v_mfma_f32_16x16x32_bf16 v[132:135], v[188:191], a[48:51], v[132:135]
    buffer_load_dwordx4 v235, s[48:51], s33 offen offset:1024 lds
    v_mfma_f32_16x16x32_bf16 v[136:139], v[184:187], a[52:55], v[136:139]
    s_add_u32 m0, s35, 14336
    s_add_u32 s33, s33, 131072
    buffer_load_dwordx4 v234, s[48:51], s33 offen lds
    v_mfma_f32_16x16x32_bf16 v[140:143], v[188:191], a[52:55], v[140:143]
    buffer_load_dwordx4 v235, s[48:51], s33 offen offset:1024 lds
    v_mfma_f32_16x16x32_bf16 v[144:147], v[184:187], a[56:59], v[144:147]
    v_mfma_f32_16x16x32_bf16 v[148:151], v[188:191], a[56:59], v[148:151]
    v_mfma_f32_16x16x32_bf16 v[152:155], v[184:187], a[60:63], v[152:155]
    v_mfma_f32_16x16x32_bf16 v[156:159], v[188:191], a[60:63], v[156:159]
    s_waitcnt lgkmcnt(0)
    v_mfma_f32_16x16x32_bf16 v[96:99], v[160:163], a[64:67], v[96:99]
    ds_read_b128 v[176:179], v225 offset:16384
    ds_read_b128 v[180:183], v225 offset:18432
    v_mfma_f32_16x16x32_bf16 v[100:103], v[164:167], a[64:67], v[100:103]
    ds_read_b128 v[184:187], v225 offset:20480
    v_mfma_f32_16x16x32_bf16 v[104:107], v[160:163], a[68:71], v[104:107]
    ds_read_b128 v[188:191], v225 offset:22528
    ds_read_b64_tr_b16 a[80:81], v228 offset:20480
    v_mfma_f32_16x16x32_bf16 v[108:111], v[164:167], a[68:71], v[108:111]
    ds_read_b64_tr_b16 a[82:83], v228 offset:20992
    v_mfma_f32_16x16x32_bf16 v[112:115], v[160:163], a[72:75], v[112:115]
    ds_read_b64_tr_b16 a[84:85], v229 offset:20480
    ds_read_b64_tr_b16 a[86:87], v229 offset:20992
    v_mfma_f32_16x16x32_bf16 v[116:119], v[164:167], a[72:75], v[116:119]
    ds_read_b64_tr_b16 a[88:89], v230 offset:20480
    s_add_u32 m0, s34, 49152
    s_add_u32 s37, s86, 0
    buffer_load_dwordx4 v232, s[44:47], s37 offen lds
    v_mfma_f32_16x16x32_bf16 v[120:123], v[160:163], a[76:79], v[120:123]
    ds_read_b64_tr_b16 a[90:91], v230 offset:20992
    ds_read_b64_tr_b16 a[92:93], v231 offset:20480
    v_mfma_f32_16x16x32_bf16 v[124:127], v[164:167], a[76:79], v[124:127]
    ds_read_b64_tr_b16 a[94:95], v231 offset:20992
    buffer_load_dwordx4 v233, s[44:47], s37 offen offset:1024 lds
    v_mfma_f32_16x16x32_bf16 v[128:131], v[168:171], a[64:67], v[128:131]
    v_mfma_f32_16x16x32_bf16 v[132:135], v[172:175], a[64:67], v[132:135]
    s_add_u32 m0, s34, 57344
    s_add_u32 s37, s87, 0
    buffer_load_dwordx4 v232, s[44:47], s37 offen lds
    v_mfma_f32_16x16x32_bf16 v[136:139], v[168:171], a[68:71], v[136:139]
    v_mfma_f32_16x16x32_bf16 v[140:143], v[172:175], a[68:71], v[140:143]
    buffer_load_dwordx4 v233, s[44:47], s37 offen offset:1024 lds
    v_mfma_f32_16x16x32_bf16 v[144:147], v[168:171], a[72:75], v[144:147]
    v_mfma_f32_16x16x32_bf16 v[148:151], v[172:175], a[72:75], v[148:151]
    v_mfma_f32_16x16x32_bf16 v[152:155], v[168:171], a[76:79], v[152:155]
    v_mfma_f32_16x16x32_bf16 v[156:159], v[172:175], a[76:79], v[156:159]
    s_waitcnt vmcnt(16) lgkmcnt(0)
    v_mfma_f32_16x16x32_bf16 v[96:99], v[176:179], a[80:83], v[96:99]
    ds_read_b128 v[160:163], v224 offset:24576
    ds_read_b128 v[164:167], v224 offset:26624
    v_mfma_f32_16x16x32_bf16 v[100:103], v[180:183], a[80:83], v[100:103]
    ds_read_b128 v[168:171], v224 offset:28672
    v_mfma_f32_16x16x32_bf16 v[104:107], v[176:179], a[84:87], v[104:107]
    ds_read_b128 v[172:175], v224 offset:30720
    ds_read_b64_tr_b16 a[96:97], v228 offset:0
    v_mfma_f32_16x16x32_bf16 v[108:111], v[180:183], a[84:87], v[108:111]
    ds_read_b64_tr_b16 a[98:99], v228 offset:512
    v_mfma_f32_16x16x32_bf16 v[112:115], v[176:179], a[88:91], v[112:115]
    ds_read_b64_tr_b16 a[100:101], v229 offset:0
    ds_read_b64_tr_b16 a[102:103], v229 offset:512
    s_add_u32 m0, s35, 16384
    s_and_b32 s33, s85, 1023
    s_lshl_b32 s33, s33, 12
    buffer_load_dwordx4 v234, s[48:51], s33 offen lds
    v_mfma_f32_16x16x32_bf16 v[116:119], v[180:183], a[88:91], v[116:119]
    ds_read_b64_tr_b16 a[104:105], v230 offset:0
    buffer_load_dwordx4 v235, s[48:51], s33 offen offset:1024 lds
    v_mfma_f32_16x16x32_bf16 v[120:123], v[176:179], a[92:95], v[120:123]
    ds_read_b64_tr_b16 a[106:107], v230 offset:512
    ds_read_b64_tr_b16 a[108:109], v231 offset:0
    s_add_u32 m0, s35, 18432
    s_add_u32 s33, s33, 131072
    buffer_load_dwordx4 v234, s[48:51], s33 offen lds
    v_mfma_f32_16x16x32_bf16 v[124:127], v[180:183], a[92:95], v[124:127]
    ds_read_b64_tr_b16 a[110:111], v231 offset:512
    buffer_load_dwordx4 v235, s[48:51], s33 offen offset:1024 lds
    v_mfma_f32_16x16x32_bf16 v[128:131], v[184:187], a[80:83], v[128:131]
    s_add_u32 m0, s35, 20480
    s_add_u32 s33, s33, 131072
    buffer_load_dwordx4 v234, s[48:51], s33 offen lds
    v_mfma_f32_16x16x32_bf16 v[132:135], v[188:191], a[80:83], v[132:135]
    buffer_load_dwordx4 v235, s[48:51], s33 offen offset:1024 lds
    v_mfma_f32_16x16x32_bf16 v[136:139], v[184:187], a[84:87], v[136:139]
    s_add_u32 m0, s35, 22528
    s_add_u32 s33, s33, 131072
    buffer_load_dwordx4 v234, s[48:51], s33 offen lds
    v_mfma_f32_16x16x32_bf16 v[140:143], v[188:191], a[84:87], v[140:143]
    buffer_load_dwordx4 v235, s[48:51], s33 offen offset:1024 lds
    v_mfma_f32_16x16x32_bf16 v[144:147], v[184:187], a[88:91], v[144:147]
    v_mfma_f32_16x16x32_bf16 v[148:151], v[188:191], a[88:91], v[148:151]
    v_mfma_f32_16x16x32_bf16 v[152:155], v[184:187], a[92:95], v[152:155]
    v_mfma_f32_16x16x32_bf16 v[156:159], v[188:191], a[92:95], v[156:159]
    s_waitcnt lgkmcnt(0)
    v_mfma_f32_16x16x32_bf16 v[96:99], v[160:163], a[96:99], v[96:99]
    ds_read_b128 v[176:179], v225 offset:24576
    ds_read_b128 v[180:183], v225 offset:26624
    v_mfma_f32_16x16x32_bf16 v[100:103], v[164:167], a[96:99], v[100:103]
    ds_read_b128 v[184:187], v225 offset:28672
    v_mfma_f32_16x16x32_bf16 v[104:107], v[160:163], a[100:103], v[104:107]
    ds_read_b128 v[188:191], v225 offset:30720
    ds_read_b64_tr_b16 a[112:113], v228 offset:4096
    v_mfma_f32_16x16x32_bf16 v[108:111], v[164:167], a[100:103], v[108:111]
    ds_read_b64_tr_b16 a[114:115], v228 offset:4608
    v_mfma_f32_16x16x32_bf16 v[112:115], v[160:163], a[104:107], v[112:115]
    ds_read_b64_tr_b16 a[116:117], v229 offset:4096
    ds_read_b64_tr_b16 a[118:119], v229 offset:4608
    v_mfma_f32_16x16x32_bf16 v[116:119], v[164:167], a[104:107], v[116:119]
    ds_read_b64_tr_b16 a[120:121], v230 offset:4096
    v_mfma_f32_16x16x32_bf16 v[120:123], v[160:163], a[108:111], v[120:123]
    ds_read_b64_tr_b16 a[122:123], v230 offset:4608
    ds_read_b64_tr_b16 a[124:125], v231 offset:4096
    v_mfma_f32_16x16x32_bf16 v[124:127], v[164:167], a[108:111], v[124:127]
    ds_read_b64_tr_b16 a[126:127], v231 offset:4608
    v_mfma_f32_16x16x32_bf16 v[128:131], v[168:171], a[96:99], v[128:131]
    v_mfma_f32_16x16x32_bf16 v[132:135], v[172:175], a[96:99], v[132:135]
    v_mfma_f32_16x16x32_bf16 v[136:139], v[168:171], a[100:103], v[136:139]
    v_mfma_f32_16x16x32_bf16 v[140:143], v[172:175], a[100:103], v[140:143]
    v_mfma_f32_16x16x32_bf16 v[144:147], v[168:171], a[104:107], v[144:147]
    v_mfma_f32_16x16x32_bf16 v[148:151], v[172:175], a[104:107], v[148:151]
    v_mfma_f32_16x16x32_bf16 v[152:155], v[168:171], a[108:111], v[152:155]
    v_mfma_f32_16x16x32_bf16 v[156:159], v[172:175], a[108:111], v[156:159]
    s_waitcnt vmcnt(12) lgkmcnt(0)
    s_barrier
    v_mfma_f32_16x16x32_bf16 v[96:99], v[176:179], a[112:115], v[96:99]
    ds_read_b128 v[160:163], v224 offset:32768
    ds_read_b128 v[164:167], v224 offset:34816
    v_mfma_f32_16x16x32_bf16 v[100:103], v[180:183], a[112:115], v[100:103]
    ds_read_b128 v[168:171], v224 offset:36864
    v_mfma_f32_16x16x32_bf16 v[104:107], v[176:179], a[116:119], v[104:107]
    ds_read_b128 v[172:175], v224 offset:38912
    ds_read_b64_tr_b16 a[128:129], v228 offset:8192
    v_mfma_f32_16x16x32_bf16 v[108:111], v[180:183], a[116:119], v[108:111]
    ds_read_b64_tr_b16 a[130:131], v228 offset:8704
    v_mfma_f32_16x16x32_bf16 v[112:115], v[176:179], a[120:123], v[112:115]
    ds_read_b64_tr_b16 a[132:133], v229 offset:8192
    ds_read_b64_tr_b16 a[134:135], v229 offset:8704
    s_add_u32 m0, s35, 0
    s_and_b32 s33, s86, 1023
    s_lshl_b32 s33, s33, 12
    buffer_load_dwordx4 v234, s[48:51], s33 offen lds
    v_mfma_f32_16x16x32_bf16 v[116:119], v[180:183], a[120:123], v[116:119]
    ds_read_b64_tr_b16 a[136:137], v230 offset:8192
    buffer_load_dwordx4 v235, s[48:51], s33 offen offset:1024 lds
    v_mfma_f32_16x16x32_bf16 v[120:123], v[176:179], a[124:127], v[120:123]
    ds_read_b64_tr_b16 a[138:139], v230 offset:8704
    ds_read_b64_tr_b16 a[140:141], v231 offset:8192
    s_add_u32 m0, s35, 2048
    s_add_u32 s33, s33, 131072
    buffer_load_dwordx4 v234, s[48:51], s33 offen lds
    v_mfma_f32_16x16x32_bf16 v[124:127], v[180:183], a[124:127], v[124:127]
    ds_read_b64_tr_b16 a[142:143], v231 offset:8704
    buffer_load_dwordx4 v235, s[48:51], s33 offen offset:1024 lds
    v_mfma_f32_16x16x32_bf16 v[128:131], v[184:187], a[112:115], v[128:131]
    s_add_u32 m0, s35, 4096
    s_add_u32 s33, s33, 131072
    buffer_load_dwordx4 v234, s[48:51], s33 offen lds
    v_mfma_f32_16x16x32_bf16 v[132:135], v[188:191], a[112:115], v[132:135]
    buffer_load_dwordx4 v235, s[48:51], s33 offen offset:1024 lds
    v_mfma_f32_16x16x32_bf16 v[136:139], v[184:187], a[116:119], v[136:139]
    s_add_u32 m0, s35, 6144
    s_add_u32 s33, s33, 131072
    buffer_load_dwordx4 v234, s[48:51], s33 offen lds
    v_mfma_f32_16x16x32_bf16 v[140:143], v[188:191], a[116:119], v[140:143]
    buffer_load_dwordx4 v235, s[48:51], s33 offen offset:1024 lds
    v_mfma_f32_16x16x32_bf16 v[144:147], v[184:187], a[120:123], v[144:147]
    v_mfma_f32_16x16x32_bf16 v[148:151], v[188:191], a[120:123], v[148:151]
    v_mfma_f32_16x16x32_bf16 v[152:155], v[184:187], a[124:127], v[152:155]
    v_mfma_f32_16x16x32_bf16 v[156:159], v[188:191], a[124:127], v[156:159]
    s_waitcnt lgkmcnt(0)
    v_mfma_f32_16x16x32_bf16 v[96:99], v[160:163], a[128:131], v[96:99]
    ds_read_b128 v[176:179], v225 offset:32768
    ds_read_b128 v[180:183], v225 offset:34816
    v_mfma_f32_16x16x32_bf16 v[100:103], v[164:167], a[128:131], v[100:103]
    ds_read_b128 v[184:187], v225 offset:36864
    v_mfma_f32_16x16x32_bf16 v[104:107], v[160:163], a[132:135], v[104:107]
    ds_read_b128 v[188:191], v225 offset:38912
    ds_read_b64_tr_b16 a[144:145], v228 offset:12288
    v_mfma_f32_16x16x32_bf16 v[108:111], v[164:167], a[132:135], v[108:111]
    ds_read_b64_tr_b16 a[146:147], v228 offset:12800
    v_mfma_f32_16x16x32_bf16 v[112:115], v[160:163], a[136:139], v[112:115]
    ds_read_b64_tr_b16 a[148:149], v229 offset:12288
    ds_read_b64_tr_b16 a[150:151], v229 offset:12800
    v_mfma_f32_16x16x32_bf16 v[116:119], v[164:167], a[136:139], v[116:119]
    ds_read_b64_tr_b16 a[152:153], v230 offset:12288
    s_add_u32 m0, s34, 0
    s_add_u32 s37, s80, 65536
    buffer_load_dwordx4 v232, s[44:47], s37 offen lds
    v_mfma_f32_16x16x32_bf16 v[120:123], v[160:163], a[140:143], v[120:123]
    ds_read_b64_tr_b16 a[154:155], v230 offset:12800
    ds_read_b64_tr_b16 a[156:157], v231 offset:12288
    v_mfma_f32_16x16x32_bf16 v[124:127], v[164:167], a[140:143], v[124:127]
    ds_read_b64_tr_b16 a[158:159], v231 offset:12800
    buffer_load_dwordx4 v233, s[44:47], s37 offen offset:1024 lds
    v_mfma_f32_16x16x32_bf16 v[128:131], v[168:171], a[128:131], v[128:131]
    v_mfma_f32_16x16x32_bf16 v[132:135], v[172:175], a[128:131], v[132:135]
    s_add_u32 m0, s34, 8192
    s_add_u32 s37, s81, 65536
    buffer_load_dwordx4 v232, s[44:47], s37 offen lds
    v_mfma_f32_16x16x32_bf16 v[136:139], v[168:171], a[132:135], v[136:139]
    v_mfma_f32_16x16x32_bf16 v[140:143], v[172:175], a[132:135], v[140:143]
    buffer_load_dwordx4 v233, s[44:47], s37 offen offset:1024 lds
    v_mfma_f32_16x16x32_bf16 v[144:147], v[168:171], a[136:139], v[144:147]
    v_mfma_f32_16x16x32_bf16 v[148:151], v[172:175], a[136:139], v[148:151]
    v_mfma_f32_16x16x32_bf16 v[152:155], v[168:171], a[140:143], v[152:155]
    v_mfma_f32_16x16x32_bf16 v[156:159], v[172:175], a[140:143], v[156:159]
    s_waitcnt vmcnt(12) lgkmcnt(0)
    v_mfma_f32_16x16x32_bf16 v[96:99], v[176:179], a[144:147], v[96:99]
    ds_read_b128 v[160:163], v224 offset:40960
    ds_read_b128 v[164:167], v224 offset:43008
    v_mfma_f32_16x16x32_bf16 v[100:103], v[180:183], a[144:147], v[100:103]
    ds_read_b128 v[168:171], v224 offset:45056
    v_mfma_f32_16x16x32_bf16 v[104:107], v[176:179], a[148:151], v[104:107]
    ds_read_b128 v[172:175], v224 offset:47104
    ds_read_b64_tr_b16 a[160:161], v228 offset:16384
    v_mfma_f32_16x16x32_bf16 v[108:111], v[180:183], a[148:151], v[108:111]
    ds_read_b64_tr_b16 a[162:163], v228 offset:16896
    v_mfma_f32_16x16x32_bf16 v[112:115], v[176:179], a[152:155], v[112:115]
    ds_read_b64_tr_b16 a[164:165], v229 offset:16384
    ds_read_b64_tr_b16 a[166:167], v229 offset:16896
    s_add_u32 m0, s35, 8192
    s_and_b32 s33, s87, 1023
    s_lshl_b32 s33, s33, 12
    buffer_load_dwordx4 v234, s[48:51], s33 offen lds
    v_mfma_f32_16x16x32_bf16 v[116:119], v[180:183], a[152:155], v[116:119]
    ds_read_b64_tr_b16 a[168:169], v230 offset:16384
    buffer_load_dwordx4 v235, s[48:51], s33 offen offset:1024 lds
    v_mfma_f32_16x16x32_bf16 v[120:123], v[176:179], a[156:159], v[120:123]
    ds_read_b64_tr_b16 a[170:171], v230 offset:16896
    ds_read_b64_tr_b16 a[172:173], v231 offset:16384
    s_add_u32 m0, s35, 10240
    s_add_u32 s33, s33, 131072
    buffer_load_dwordx4 v234, s[48:51], s33 offen lds
    v_mfma_f32_16x16x32_bf16 v[124:127], v[180:183], a[156:159], v[124:127]
    ds_read_b64_tr_b16 a[174:175], v231 offset:16896
    buffer_load_dwordx4 v235, s[48:51], s33 offen offset:1024 lds
    v_mfma_f32_16x16x32_bf16 v[128:131], v[184:187], a[144:147], v[128:131]
    s_add_u32 m0, s35, 12288
    s_add_u32 s33, s33, 131072
    buffer_load_dwordx4 v234, s[48:51], s33 offen lds
    v_mfma_f32_16x16x32_bf16 v[132:135], v[188:191], a[144:147], v[132:135]
    buffer_load_dwordx4 v235, s[48:51], s33 offen offset:1024 lds
    v_mfma_f32_16x16x32_bf16 v[136:139], v[184:187], a[148:151], v[136:139]
    s_add_u32 m0, s35, 14336
    s_add_u32 s33, s33, 131072
    buffer_load_dwordx4 v234, s[48:51], s33 offen lds
    v_mfma_f32_16x16x32_bf16 v[140:143], v[188:191], a[148:151], v[140:143]
    buffer_load_dwordx4 v235, s[48:51], s33 offen offset:1024 lds
    v_mfma_f32_16x16x32_bf16 v[144:147], v[184:187], a[152:155], v[144:147]
    v_mfma_f32_16x16x32_bf16 v[148:151], v[188:191], a[152:155], v[148:151]
    v_mfma_f32_16x16x32_bf16 v[152:155], v[184:187], a[156:159], v[152:155]
    v_mfma_f32_16x16x32_bf16 v[156:159], v[188:191], a[156:159], v[156:159]
    s_waitcnt lgkmcnt(0)
    v_mfma_f32_16x16x32_bf16 v[96:99], v[160:163], a[160:163], v[96:99]
    ds_read_b128 v[176:179], v225 offset:40960
    ds_read_b128 v[180:183], v225 offset:43008
    v_mfma_f32_16x16x32_bf16 v[100:103], v[164:167], a[160:163], v[100:103]
    ds_read_b128 v[184:187], v225 offset:45056
    v_mfma_f32_16x16x32_bf16 v[104:107], v[160:163], a[164:167], v[104:107]
    ds_read_b128 v[188:191], v225 offset:47104
    ds_read_b64_tr_b16 a[176:177], v228 offset:20480
    v_mfma_f32_16x16x32_bf16 v[108:111], v[164:167], a[164:167], v[108:111]
    ds_read_b64_tr_b16 a[178:179], v228 offset:20992
    v_mfma_f32_16x16x32_bf16 v[112:115], v[160:163], a[168:171], v[112:115]
    ds_read_b64_tr_b16 a[180:181], v229 offset:20480
    ds_read_b64_tr_b16 a[182:183], v229 offset:20992
    s_add_u32 m0, s34, 16384
    s_add_u32 s37, s82, 65536
    buffer_load_dwordx4 v232, s[44:47], s37 offen lds
    v_mfma_f32_16x16x32_bf16 v[116:119], v[164:167], a[168:171], v[116:119]
    ds_read_b64_tr_b16 a[184:185], v230 offset:20480
    buffer_load_dwordx4 v233, s[44:47], s37 offen offset:1024 lds
    v_mfma_f32_16x16x32_bf16 v[120:123], v[160:163], a[172:175], v[120:123]
    ds_read_b64_tr_b16 a[186:187], v230 offset:20992
    ds_read_b64_tr_b16 a[188:189], v231 offset:20480
    s_add_u32 m0, s34, 24576
    s_add_u32 s37, s83, 65536
    buffer_load_dwordx4 v232, s[44:47], s37 offen lds
    v_mfma_f32_16x16x32_bf16 v[124:127], v[164:167], a[172:175], v[124:127]
    ds_read_b64_tr_b16 a[190:191], v231 offset:20992
    buffer_load_dwordx4 v233, s[44:47], s37 offen offset:1024 lds
    v_mfma_f32_16x16x32_bf16 v[128:131], v[168:171], a[160:163], v[128:131]
    buffer_load_dwordx4 v[0:3], v236, s[52:55], 0 offen offset:0
    v_mfma_f32_16x16x32_bf16 v[132:135], v[172:175], a[160:163], v[132:135]
    buffer_load_dwordx4 v[4:7], v236, s[52:55], 0 offen offset:512
    v_mfma_f32_16x16x32_bf16 v[136:139], v[168:171], a[164:167], v[136:139]
    buffer_load_dwordx4 v[8:11], v236, s[52:55], 0 offen offset:1024
    v_mfma_f32_16x16x32_bf16 v[140:143], v[172:175], a[164:167], v[140:143]
    buffer_load_dwordx4 v[12:15], v236, s[52:55], 0 offen offset:1536
    v_mfma_f32_16x16x32_bf16 v[144:147], v[168:171], a[168:171], v[144:147]
    v_mfma_f32_16x16x32_bf16 v[148:151], v[172:175], a[168:171], v[148:151]
    v_mfma_f32_16x16x32_bf16 v[152:155], v[168:171], a[172:175], v[152:155]
    v_mfma_f32_16x16x32_bf16 v[156:159], v[172:175], a[172:175], v[156:159]
    s_waitcnt vmcnt(20) lgkmcnt(0)
    s_barrier
    v_mfma_f32_16x16x32_bf16 v[96:99], v[176:179], a[176:179], v[96:99]
    ds_read_b128 v[160:163], v224 offset:49152
    ds_read_b128 v[164:167], v224 offset:51200
    v_mfma_f32_16x16x32_bf16 v[100:103], v[180:183], a[176:179], v[100:103]
    ds_read_b128 v[168:171], v224 offset:53248
    v_mfma_f32_16x16x32_bf16 v[104:107], v[176:179], a[180:183], v[104:107]
    ds_read_b128 v[172:175], v224 offset:55296
    ds_read_b64_tr_b16 a[192:193], v228 offset:0
    v_mfma_f32_16x16x32_bf16 v[108:111], v[180:183], a[180:183], v[108:111]
    ds_read_b64_tr_b16 a[194:195], v228 offset:512
    v_mfma_f32_16x16x32_bf16 v[112:115], v[176:179], a[184:187], v[112:115]
    ds_read_b64_tr_b16 a[196:197], v229 offset:0
    ds_read_b64_tr_b16 a[198:199], v229 offset:512
    v_mfma_f32_16x16x32_bf16 v[116:119], v[180:183], a[184:187], v[116:119]
    ds_read_b64_tr_b16 a[200:201], v230 offset:0
    v_mfma_f32_16x16x32_bf16 v[120:123], v[176:179], a[188:191], v[120:123]
    ds_read_b64_tr_b16 a[202:203], v230 offset:512
    ds_read_b64_tr_b16 a[204:205], v231 offset:0
    v_mfma_f32_16x16x32_bf16 v[124:127], v[180:183], a[188:191], v[124:127]
    ds_read_b64_tr_b16 a[206:207], v231 offset:512
    v_mfma_f32_16x16x32_bf16 v[128:131], v[184:187], a[176:179], v[128:131]
    v_mfma_f32_16x16x32_bf16 v[132:135], v[188:191], a[176:179], v[132:135]
    v_mfma_f32_16x16x32_bf16 v[136:139], v[184:187], a[180:183], v[136:139]
    v_mfma_f32_16x16x32_bf16 v[140:143], v[188:191], a[180:183], v[140:143]
    v_mfma_f32_16x16x32_bf16 v[144:147], v[184:187], a[184:187], v[144:147]
    v_mfma_f32_16x16x32_bf16 v[148:151], v[188:191], a[184:187], v[148:151]
    v_mfma_f32_16x16x32_bf16 v[152:155], v[184:187], a[188:191], v[152:155]
    v_mfma_f32_16x16x32_bf16 v[156:159], v[188:191], a[188:191], v[156:159]
    s_waitcnt lgkmcnt(0)
    v_mfma_f32_16x16x32_bf16 v[96:99], v[160:163], a[192:195], v[96:99]
    ds_read_b128 v[176:179], v225 offset:49152
    ds_read_b128 v[180:183], v225 offset:51200
    v_mfma_f32_16x16x32_bf16 v[100:103], v[164:167], a[192:195], v[100:103]
    ds_read_b128 v[184:187], v225 offset:53248
    v_mfma_f32_16x16x32_bf16 v[104:107], v[160:163], a[196:199], v[104:107]
    ds_read_b128 v[188:191], v225 offset:55296
    ds_read_b64_tr_b16 a[208:209], v228 offset:4096
    v_mfma_f32_16x16x32_bf16 v[108:111], v[164:167], a[196:199], v[108:111]
    ds_read_b64_tr_b16 a[210:211], v228 offset:4608
    v_mfma_f32_16x16x32_bf16 v[112:115], v[160:163], a[200:203], v[112:115]
    ds_read_b64_tr_b16 a[212:213], v229 offset:4096
    ds_read_b64_tr_b16 a[214:215], v229 offset:4608
    v_mfma_f32_16x16x32_bf16 v[116:119], v[164:167], a[200:203], v[116:119]
    ds_read_b64_tr_b16 a[216:217], v230 offset:4096
    s_add_u32 m0, s34, 32768
    s_add_u32 s37, s84, 65536
    buffer_load_dwordx4 v232, s[44:47], s37 offen lds
    v_mfma_f32_16x16x32_bf16 v[120:123], v[160:163], a[204:207], v[120:123]
    ds_read_b64_tr_b16 a[218:219], v230 offset:4608
    ds_read_b64_tr_b16 a[220:221], v231 offset:4096
    v_mfma_f32_16x16x32_bf16 v[124:127], v[164:167], a[204:207], v[124:127]
    ds_read_b64_tr_b16 a[222:223], v231 offset:4608
    buffer_load_dwordx4 v233, s[44:47], s37 offen offset:1024 lds
    v_mfma_f32_16x16x32_bf16 v[128:131], v[168:171], a[192:195], v[128:131]
    v_mfma_f32_16x16x32_bf16 v[132:135], v[172:175], a[192:195], v[132:135]
    s_add_u32 m0, s34, 40960
    s_add_u32 s37, s85, 65536
    buffer_load_dwordx4 v232, s[44:47], s37 offen lds
    v_mfma_f32_16x16x32_bf16 v[136:139], v[168:171], a[196:199], v[136:139]
    v_mfma_f32_16x16x32_bf16 v[140:143], v[172:175], a[196:199], v[140:143]
    buffer_load_dwordx4 v233, s[44:47], s37 offen offset:1024 lds
    v_mfma_f32_16x16x32_bf16 v[144:147], v[168:171], a[200:203], v[144:147]
    v_mfma_f32_16x16x32_bf16 v[148:151], v[172:175], a[200:203], v[148:151]
    v_mfma_f32_16x16x32_bf16 v[152:155], v[168:171], a[204:207], v[152:155]
    v_mfma_f32_16x16x32_bf16 v[156:159], v[172:175], a[204:207], v[156:159]
    s_waitcnt vmcnt(12) lgkmcnt(0)
    v_mfma_f32_16x16x32_bf16 v[96:99], v[176:179], a[208:211], v[96:99]
    ds_read_b128 v[160:163], v224 offset:57344
    ds_read_b128 v[164:167], v224 offset:59392
    v_mfma_f32_16x16x32_bf16 v[100:103], v[180:183], a[208:211], v[100:103]
    ds_read_b128 v[168:171], v224 offset:61440
    v_mfma_f32_16x16x32_bf16 v[104:107], v[176:179], a[212:215], v[104:107]
    ds_read_b128 v[172:175], v224 offset:63488
    ds_read_b64_tr_b16 a[224:225], v228 offset:8192
    v_mfma_f32_16x16x32_bf16 v[108:111], v[180:183], a[212:215], v[108:111]
    ds_read_b64_tr_b16 a[226:227], v228 offset:8704
    v_mfma_f32_16x16x32_bf16 v[112:115], v[176:179], a[216:219], v[112:115]
    ds_read_b64_tr_b16 a[228:229], v229 offset:8192
    ds_read_b64_tr_b16 a[230:231], v229 offset:8704
    v_mfma_f32_16x16x32_bf16 v[116:119], v[180:183], a[216:219], v[116:119]
    ds_read_b64_tr_b16 a[232:233], v230 offset:8192
    v_mfma_f32_16x16x32_bf16 v[120:123], v[176:179], a[220:223], v[120:123]
    ds_read_b64_tr_b16 a[234:235], v230 offset:8704
    ds_read_b64_tr_b16 a[236:237], v231 offset:8192
    v_mfma_f32_16x16x32_bf16 v[124:127], v[180:183], a[220:223], v[124:127]
    ds_read_b64_tr_b16 a[238:239], v231 offset:8704
    v_mfma_f32_16x16x32_bf16 v[128:131], v[184:187], a[208:211], v[128:131]
    v_mfma_f32_16x16x32_bf16 v[132:135], v[188:191], a[208:211], v[132:135]
    v_mfma_f32_16x16x32_bf16 v[136:139], v[184:187], a[212:215], v[136:139]
    v_mfma_f32_16x16x32_bf16 v[140:143], v[188:191], a[212:215], v[140:143]
    v_mfma_f32_16x16x32_bf16 v[144:147], v[184:187], a[216:219], v[144:147]
    v_mfma_f32_16x16x32_bf16 v[148:151], v[188:191], a[216:219], v[148:151]
    v_mfma_f32_16x16x32_bf16 v[152:155], v[184:187], a[220:223], v[152:155]
    v_mfma_f32_16x16x32_bf16 v[156:159], v[188:191], a[220:223], v[156:159]
    s_waitcnt lgkmcnt(0)
    v_mfma_f32_16x16x32_bf16 v[96:99], v[160:163], a[224:227], v[96:99]
    ds_read_b128 v[176:179], v225 offset:57344
    ds_read_b128 v[180:183], v225 offset:59392
    v_mfma_f32_16x16x32_bf16 v[100:103], v[164:167], a[224:227], v[100:103]
    ds_read_b128 v[184:187], v225 offset:61440
    v_mfma_f32_16x16x32_bf16 v[104:107], v[160:163], a[228:231], v[104:107]
    ds_read_b128 v[188:191], v225 offset:63488
    ds_read_b64_tr_b16 a[240:241], v228 offset:12288
    v_mfma_f32_16x16x32_bf16 v[108:111], v[164:167], a[228:231], v[108:111]
    ds_read_b64_tr_b16 a[242:243], v228 offset:12800
    v_mfma_f32_16x16x32_bf16 v[112:115], v[160:163], a[232:235], v[112:115]
    ds_read_b64_tr_b16 a[244:245], v229 offset:12288
    ds_read_b64_tr_b16 a[246:247], v229 offset:12800
    v_mfma_f32_16x16x32_bf16 v[116:119], v[164:167], a[232:235], v[116:119]
    ds_read_b64_tr_b16 a[248:249], v230 offset:12288
    v_mfma_f32_16x16x32_bf16 v[120:123], v[160:163], a[236:239], v[120:123]
    ds_read_b64_tr_b16 a[250:251], v230 offset:12800
    ds_read_b64_tr_b16 a[252:253], v231 offset:12288
    v_mfma_f32_16x16x32_bf16 v[124:127], v[164:167], a[236:239], v[124:127]
    ds_read_b64_tr_b16 a[254:255], v231 offset:12800
    v_mfma_f32_16x16x32_bf16 v[128:131], v[168:171], a[224:227], v[128:131]
    v_mfma_f32_16x16x32_bf16 v[132:135], v[172:175], a[224:227], v[132:135]
    v_mfma_f32_16x16x32_bf16 v[136:139], v[168:171], a[228:231], v[136:139]
    v_mfma_f32_16x16x32_bf16 v[140:143], v[172:175], a[228:231], v[140:143]
    v_mfma_f32_16x16x32_bf16 v[144:147], v[168:171], a[232:235], v[144:147]
    v_mfma_f32_16x16x32_bf16 v[148:151], v[172:175], a[232:235], v[148:151]
    v_mfma_f32_16x16x32_bf16 v[152:155], v[168:171], a[236:239], v[152:155]
    v_mfma_f32_16x16x32_bf16 v[156:159], v[172:175], a[236:239], v[156:159]
    s_waitcnt vmcnt(20) lgkmcnt(0)
    s_barrier
    v_mfma_f32_16x16x32_bf16 v[96:99], v[176:179], a[240:243], v[96:99]
    ds_read_b128 v[160:163], v224 offset:0
    v_mfma_f32_16x16x32_bf16 v[100:103], v[180:183], a[240:243], v[100:103]
    ds_read_b128 v[164:167], v224 offset:2048
    v_mfma_f32_16x16x32_bf16 v[104:107], v[176:179], a[244:247], v[104:107]
    ds_read_b128 v[168:171], v224 offset:4096
    v_mfma_f32_16x16x32_bf16 v[108:111], v[180:183], a[244:247], v[108:111]
    ds_read_b128 v[172:175], v224 offset:6144
    v_mfma_f32_16x16x32_bf16 v[112:115], v[176:179], a[248:251], v[112:115]
    v_mfma_f32_16x16x32_bf16 v[116:119], v[180:183], a[248:251], v[116:119]
    s_add_u32 m0, s34, 49152
    s_add_u32 s37, s86, 65536
    buffer_load_dwordx4 v232, s[44:47], s37 offen lds
    v_mfma_f32_16x16x32_bf16 v[120:123], v[176:179], a[252:255], v[120:123]
    v_mfma_f32_16x16x32_bf16 v[124:127], v[180:183], a[252:255], v[124:127]
    buffer_load_dwordx4 v233, s[44:47], s37 offen offset:1024 lds
    v_mfma_f32_16x16x32_bf16 v[128:131], v[184:187], a[240:243], v[128:131]
    v_mfma_f32_16x16x32_bf16 v[132:135], v[188:191], a[240:243], v[132:135]
    s_add_u32 m0, s34, 57344
    s_add_u32 s37, s87, 65536
    buffer_load_dwordx4 v232, s[44:47], s37 offen lds
    v_cvt_pk_bf16_f32 v64, v96, v97
    v_cvt_pk_bf16_f32 v65, v98, v99
    v_mfma_f32_16x16x32_bf16 v[136:139], v[184:187], a[244:247], v[136:139]
    v_cvt_pk_bf16_f32 v66, v100, v101
    v_cvt_pk_bf16_f32 v67, v102, v103
    v_mfma_f32_16x16x32_bf16 v[140:143], v[188:191], a[244:247], v[140:143]
    buffer_load_dwordx4 v233, s[44:47], s37 offen offset:1024 lds
    v_cvt_pk_bf16_f32 v68, v104, v105
    v_cvt_pk_bf16_f32 v69, v106, v107
    v_mfma_f32_16x16x32_bf16 v[144:147], v[184:187], a[248:251], v[144:147]
    v_cvt_pk_bf16_f32 v70, v108, v109
    v_cvt_pk_bf16_f32 v71, v110, v111
    v_mfma_f32_16x16x32_bf16 v[148:151], v[188:191], a[248:251], v[148:151]
    v_cvt_pk_bf16_f32 v72, v112, v113
    v_cvt_pk_bf16_f32 v73, v114, v115
    v_mfma_f32_16x16x32_bf16 v[152:155], v[184:187], a[252:255], v[152:155]
    v_cvt_pk_bf16_f32 v74, v116, v117
    v_cvt_pk_bf16_f32 v75, v118, v119
    v_mfma_f32_16x16x32_bf16 v[156:159], v[188:191], a[252:255], v[156:159]
    v_cvt_pk_bf16_f32 v76, v120, v121
    v_cvt_pk_bf16_f32 v77, v122, v123
    s_waitcnt lgkmcnt(0)
    v_mfma_f32_16x16x32_bf16 v[96:99], v[160:163], a[0:3], 0
    ds_read_b128 v[176:179], v225 offset:0
    v_cvt_pk_bf16_f32 v78, v124, v125
    v_cvt_pk_bf16_f32 v79, v126, v127
    v_mfma_f32_16x16x32_bf16 v[100:103], v[164:167], a[0:3], 0
    ds_read_b128 v[180:183], v225 offset:2048
    v_cvt_pk_bf16_f32 v80, v128, v129
    v_cvt_pk_bf16_f32 v81, v130, v131
    v_mfma_f32_16x16x32_bf16 v[104:107], v[160:163], a[4:7], 0
    ds_read_b128 v[184:187], v225 offset:4096
    v_cvt_pk_bf16_f32 v82, v132, v133
    v_cvt_pk_bf16_f32 v83, v134, v135
    v_mfma_f32_16x16x32_bf16 v[108:111], v[164:167], a[4:7], 0
    ds_read_b128 v[188:191], v225 offset:6144
    v_cvt_pk_bf16_f32 v84, v136, v137
    v_cvt_pk_bf16_f32 v85, v138, v139
    v_mfma_f32_16x16x32_bf16 v[112:115], v[160:163], a[8:11], 0
    v_cvt_pk_bf16_f32 v86, v140, v141
    v_cvt_pk_bf16_f32 v87, v142, v143
    v_mfma_f32_16x16x32_bf16 v[116:119], v[164:167], a[8:11], 0
    s_add_u32 m0, s34, 98304
    s_add_u32 s37, s80, 131072
    buffer_load_dwordx4 v232, s[44:47], s37 offen lds
    v_cvt_pk_bf16_f32 v88, v144, v145
    v_cvt_pk_bf16_f32 v89, v146, v147
    v_mfma_f32_16x16x32_bf16 v[120:123], v[160:163], a[12:15], 0
    v_cvt_pk_bf16_f32 v90, v148, v149
    v_cvt_pk_bf16_f32 v91, v150, v151
    v_mfma_f32_16x16x32_bf16 v[124:127], v[164:167], a[12:15], 0
    buffer_load_dwordx4 v233, s[44:47], s37 offen offset:1024 lds
    v_cvt_pk_bf16_f32 v92, v152, v153
    v_cvt_pk_bf16_f32 v93, v154, v155
    v_mfma_f32_16x16x32_bf16 v[128:131], v[168:171], a[0:3], 0
    v_cvt_pk_bf16_f32 v94, v156, v157
    v_cvt_pk_bf16_f32 v95, v158, v159
    v_mfma_f32_16x16x32_bf16 v[132:135], v[172:175], a[0:3], 0
    s_add_u32 m0, s34, 106496
    s_add_u32 s37, s81, 131072
    buffer_load_dwordx4 v232, s[44:47], s37 offen lds
    v_mfma_f32_16x16x32_bf16 v[136:139], v[168:171], a[4:7], 0
    s_waitcnt vmcnt(11)
    v_lshlrev_b32 v16, 16, v0
    v_mfma_f32_16x16x32_bf16 v[140:143], v[172:175], a[4:7], 0
    buffer_load_dwordx4 v233, s[44:47], s37 offen offset:1024 lds
    v_and_b32 v17, 0xffff0000, v0
    v_mfma_f32_16x16x32_bf16 v[144:147], v[168:171], a[8:11], 0
    v_lshlrev_b32 v18, 16, v1
    v_and_b32 v19, 0xffff0000, v1
    v_mfma_f32_16x16x32_bf16 v[148:151], v[172:175], a[8:11], 0
    s_add_u32 m0, s34, 114688
    s_add_u32 s37, s82, 131072
    buffer_load_dwordx4 v232, s[44:47], s37 offen lds
    v_mfma_f32_16x16x32_bf16 v[152:155], v[168:171], a[12:15], 0
    v_lshlrev_b32 v20, 16, v2
    v_mfma_f32_16x16x32_bf16 v[156:159], v[172:175], a[12:15], 0
    buffer_load_dwordx4 v233, s[44:47], s37 offen offset:1024 lds
    s_waitcnt lgkmcnt(0)
    v_mfma_f32_16x16x32_bf16 v[96:99], v[176:179], a[16:19], v[96:99]
    ds_read_b128 v[160:163], v224 offset:8192
    v_and_b32 v21, 0xffff0000, v2
    v_mfma_f32_16x16x32_bf16 v[100:103], v[180:183], a[16:19], v[100:103]
    ds_read_b128 v[164:167], v224 offset:10240
    v_lshlrev_b32 v22, 16, v3
    v_mfma_f32_16x16x32_bf16 v[104:107], v[176:179], a[20:23], v[104:107]
    ds_read_b128 v[168:171], v224 offset:12288
    v_and_b32 v23, 0xffff0000, v3
    v_mfma_f32_16x16x32_bf16 v[108:111], v[180:183], a[20:23], v[108:111]
    ds_read_b128 v[172:175], v224 offset:14336
    v_lshlrev_b32 v24, 16, v4
    v_mfma_f32_16x16x32_bf16 v[112:115], v[176:179], a[24:27], v[112:115]
    v_and_b32 v25, 0xffff0000, v4
    v_lshlrev_b32 v26, 16, v5
    v_mfma_f32_16x16x32_bf16 v[116:119], v[180:183], a[24:27], v[116:119]
    s_add_u32 m0, s34, 122880
    s_add_u32 s37, s83, 131072
    buffer_load_dwordx4 v232, s[44:47], s37 offen lds
    v_mfma_f32_16x16x32_bf16 v[120:123], v[176:179], a[28:31], v[120:123]
    v_and_b32 v27, 0xffff0000, v5
    v_lshlrev_b32 v28, 16, v6
    v_mfma_f32_16x16x32_bf16 v[124:127], v[180:183], a[28:31], v[124:127]
    buffer_load_dwordx4 v233, s[44:47], s37 offen offset:1024 lds
    v_and_b32 v29, 0xffff0000, v6
    v_mfma_f32_16x16x32_bf16 v[128:131], v[184:187], a[16:19], v[128:131]
    v_lshlrev_b32 v30, 16, v7
    v_and_b32 v31, 0xffff0000, v7
    v_mfma_f32_16x16x32_bf16 v[132:135], v[188:191], a[16:19], v[132:135]
    s_add_u32 m0, s34, 131072
    s_add_u32 s37, s84, 131072
    buffer_load_dwordx4 v232, s[44:47], s37 offen lds
    v_mfma_f32_16x16x32_bf16 v[136:139], v[184:187], a[20:23], v[136:139]
    v_lshlrev_b32 v32, 16, v8
    v_mfma_f32_16x16x32_bf16 v[140:143], v[188:191], a[20:23], v[140:143]
    buffer_load_dwordx4 v233, s[44:47], s37 offen offset:1024 lds
    v_and_b32 v33, 0xffff0000, v8
    v_mfma_f32_16x16x32_bf16 v[144:147], v[184:187], a[24:27], v[144:147]
    v_lshlrev_b32 v34, 16, v9
    v_and_b32 v35, 0xffff0000, v9
    v_mfma_f32_16x16x32_bf16 v[148:151], v[188:191], a[24:27], v[148:151]
    s_add_u32 m0, s34, 139264
    s_add_u32 s37, s85, 131072
    buffer_load_dwordx4 v232, s[44:47], s37 offen lds
    v_mfma_f32_16x16x32_bf16 v[152:155], v[184:187], a[28:31], v[152:155]
    v_lshlrev_b32 v36, 16, v10
    v_and_b32 v37, 0xffff0000, v10
    v_mfma_f32_16x16x32_bf16 v[156:159], v[188:191], a[28:31], v[156:159]
    buffer_load_dwordx4 v233, s[44:47], s37 offen offset:1024 lds
    s_waitcnt lgkmcnt(0)
    v_mfma_f32_16x16x32_bf16 v[96:99], v[160:163], a[32:35], v[96:99]
    ds_read_b128 v[176:179], v225 offset:8192
    v_lshlrev_b32 v38, 16, v11
    v_mfma_f32_16x16x32_bf16 v[100:103], v[164:167], a[32:35], v[100:103]
    ds_read_b128 v[180:183], v225 offset:10240
    v_and_b32 v39, 0xffff0000, v11
    v_mfma_f32_16x16x32_bf16 v[104:107], v[160:163], a[36:39], v[104:107]
    ds_read_b128 v[184:187], v225 offset:12288
    v_lshlrev_b32 v40, 16, v12
    v_mfma_f32_16x16x32_bf16 v[108:111], v[164:167], a[36:39], v[108:111]
    ds_read_b128 v[188:191], v225 offset:14336
    v_and_b32 v41, 0xffff0000, v12
    v_mfma_f32_16x16x32_bf16 v[112:115], v[160:163], a[40:43], v[112:115]
    v_lshlrev_b32 v42, 16, v13
    v_and_b32 v43, 0xffff0000, v13
    v_mfma_f32_16x16x32_bf16 v[116:119], v[164:167], a[40:43], v[116:119]
    s_add_u32 m0, s34, 147456
    s_add_u32 s37, s86, 131072
    buffer_load_dwordx4 v232, s[44:47], s37 offen lds
    v_mfma_f32_16x16x32_bf16 v[120:123], v[160:163], a[44:47], v[120:123]
    v_lshlrev_b32 v44, 16, v14
    v_and_b32 v45, 0xffff0000, v14
    v_mfma_f32_16x16x32_bf16 v[124:127], v[164:167], a[44:47], v[124:127]
    buffer_load_dwordx4 v233, s[44:47], s37 offen offset:1024 lds
    v_mfma_f32_16x16x32_bf16 v[128:131], v[168:171], a[32:35], v[128:131]
    v_lshlrev_b32 v46, 16, v15
    v_and_b32 v47, 0xffff0000, v15
    v_mfma_f32_16x16x32_bf16 v[132:135], v[172:175], a[32:35], v[132:135]
    s_add_u32 m0, s34, 155648
    s_add_u32 s37, s87, 131072
    buffer_load_dwordx4 v232, s[44:47], s37 offen lds
    v_mfma_f32_16x16x32_bf16 v[136:139], v[168:171], a[36:39], v[136:139]
    v_add_f32 v52, v16, v20
    v_add_f32 v53, v17, v21
    v_mfma_f32_16x16x32_bf16 v[140:143], v[172:175], a[36:39], v[140:143]
    buffer_load_dwordx4 v233, s[44:47], s37 offen offset:1024 lds
    v_add_f32 v54, v18, v22
    v_mfma_f32_16x16x32_bf16 v[144:147], v[168:171], a[40:43], v[144:147]
    v_add_f32 v55, v19, v23
    v_add_f32 v52, v52, v24
    v_mfma_f32_16x16x32_bf16 v[148:151], v[172:175], a[40:43], v[148:151]
    v_add_f32 v53, v53, v25
    v_add_f32 v54, v54, v26
    v_mfma_f32_16x16x32_bf16 v[152:155], v[168:171], a[44:47], v[152:155]
    v_add_f32 v55, v55, v27
    v_add_f32 v52, v52, v28
    v_mfma_f32_16x16x32_bf16 v[156:159], v[172:175], a[44:47], v[156:159]
    s_waitcnt vmcnt(28) lgkmcnt(0)
    s_barrier
    v_mfma_f32_16x16x32_bf16 v[96:99], v[176:179], a[48:51], v[96:99]
    ds_read_b128 v[160:163], v224 offset:16384
    v_add_f32 v53, v53, v29
    v_mfma_f32_16x16x32_bf16 v[100:103], v[180:183], a[48:51], v[100:103]
    ds_read_b128 v[164:167], v224 offset:18432
    v_mfma_f32_16x16x32_bf16 v[104:107], v[176:179], a[52:55], v[104:107]
    ds_read_b128 v[168:171], v224 offset:20480
    v_add_f32 v54, v54, v30
    v_mfma_f32_16x16x32_bf16 v[108:111], v[180:183], a[52:55], v[108:111]
    ds_read_b128 v[172:175], v224 offset:22528
    v_add_f32 v55, v55, v31
    v_mfma_f32_16x16x32_bf16 v[112:115], v[176:179], a[56:59], v[112:115]
    v_add_f32 v52, v52, v32
    v_add_f32 v53, v53, v33
    v_mfma_f32_16x16x32_bf16 v[116:119], v[180:183], a[56:59], v[116:119]
    s_add_u32 m0, s34, 0
    s_add_u32 s37, s80, 196608
    buffer_load_dwordx4 v232, s[44:47], s37 offen lds
    v_mfma_f32_16x16x32_bf16 v[120:123], v[176:179], a[60:63], v[120:123]
    v_add_f32 v54, v54, v34
    v_add_f32 v55, v55, v35
    v_mfma_f32_16x16x32_bf16 v[124:127], v[180:183], a[60:63], v[124:127]
    buffer_load_dwordx4 v233, s[44:47], s37 offen offset:1024 lds
    v_add_f32 v52, v52, v36
    v_mfma_f32_16x16x32_bf16 v[128:131], v[184:187], a[48:51], v[128:131]
    v_add_f32 v53, v53, v37
    v_add_f32 v54, v54, v38
    v_mfma_f32_16x16x32_bf16 v[132:135], v[188:191], a[48:51], v[132:135]
    s_add_u32 m0, s34, 8192
    s_add_u32 s37, s81, 196608
    buffer_load_dwordx4 v232, s[44:47], s37 offen lds
    v_mfma_f32_16x16x32_bf16 v[136:139], v[184:187], a[52:55], v[136:139]
    v_add_f32 v55, v55, v39
    v_add_f32 v52, v52, v40
    v_mfma_f32_16x16x32_bf16 v[140:143], v[188:191], a[52:55], v[140:143]
    buffer_load_dwordx4 v233, s[44:47], s37 offen offset:1024 lds
    v_add_f32 v53, v53, v41
    v_mfma_f32_16x16x32_bf16 v[144:147], v[184:187], a[56:59], v[144:147]
    v_add_f32 v54, v54, v42
    v_mfma_f32_16x16x32_bf16 v[148:151], v[188:191], a[56:59], v[148:151]
    v_add_f32 v55, v55, v43
    v_add_f32 v52, v52, v44
    v_mfma_f32_16x16x32_bf16 v[152:155], v[184:187], a[60:63], v[152:155]
    v_add_f32 v53, v53, v45
    v_add_f32 v54, v54, v46
    v_mfma_f32_16x16x32_bf16 v[156:159], v[188:191], a[60:63], v[156:159]
    v_add_f32 v55, v55, v47
    s_waitcnt lgkmcnt(0)
    v_mfma_f32_16x16x32_bf16 v[96:99], v[160:163], a[64:67], v[96:99]
    ds_read_b128 v[176:179], v225 offset:16384
    v_add_f32 v52, v52, v53
    v_mfma_f32_16x16x32_bf16 v[100:103], v[164:167], a[64:67], v[100:103]
    ds_read_b128 v[180:183], v225 offset:18432
    v_add_f32 v54, v54, v55
    v_mfma_f32_16x16x32_bf16 v[104:107], v[160:163], a[68:71], v[104:107]
    ds_read_b128 v[184:187], v225 offset:20480
    v_add_f32 v48, v52, v54
    v_mfma_f32_16x16x32_bf16 v[108:111], v[164:167], a[68:71], v[108:111]
    ds_read_b128 v[188:191], v225 offset:22528
    s_nop 1
    v_mfma_f32_16x16x32_bf16 v[112:115], v[160:163], a[72:75], v[112:115]
    v_add_f32_dpp v48, v48, v48 quad_perm:[1,0,3,2] row_mask:0xf bank_mask:0xf
    s_nop 1
    v_mfma_f32_16x16x32_bf16 v[116:119], v[164:167], a[72:75], v[116:119]
    v_add_f32_dpp v48, v48, v48 quad_perm:[2,3,0,1] row_mask:0xf bank_mask:0xf
    v_mfma_f32_16x16x32_bf16 v[120:123], v[160:163], a[76:79], v[120:123]
    s_nop 1
    v_add_f32_dpp v48, v48, v48 row_half_mirror row_mask:0xf bank_mask:0xf
    v_mfma_f32_16x16x32_bf16 v[124:127], v[164:167], a[76:79], v[124:127]
    s_nop 1
    v_add_f32_dpp v48, v48, v48 row_mirror row_mask:0xf bank_mask:0xf
    v_mfma_f32_16x16x32_bf16 v[128:131], v[168:171], a[64:67], v[128:131]
    s_nop 0
    v_mov_b32 v49, v48
    v_mfma_f32_16x16x32_bf16 v[132:135], v[172:175], a[64:67], v[132:135]
    s_nop 1
    v_permlane16_swap_b32 v48, v49
    v_mfma_f32_16x16x32_bf16 v[136:139], v[168:171], a[68:71], v[136:139]
    s_nop 0
    v_add_f32 v48, v48, v49
    v_mfma_f32_16x16x32_bf16 v[140:143], v[172:175], a[68:71], v[140:143]
    v_mul_f32 v48, 0x3a800000, v48
    v_sub_f32 v56, v16, v48
    v_mfma_f32_16x16x32_bf16 v[144:147], v[168:171], a[72:75], v[144:147]
    v_mul_f32 v52, v56, v56
    v_mfma_f32_16x16x32_bf16 v[148:151], v[172:175], a[72:75], v[148:151]
    v_sub_f32 v57, v17, v48
    v_mul_f32 v53, v57, v57
    v_mfma_f32_16x16x32_bf16 v[152:155], v[168:171], a[76:79], v[152:155]
    s_add_u32 s38, s36, 0
    buffer_store_dwordx4 v[64:67], v240, s[16:19], s38 offen offset:0 sc1
    v_mfma_f32_16x16x32_bf16 v[156:159], v[172:175], a[76:79], v[156:159]
    v_sub_f32 v58, v18, v48
    s_waitcnt lgkmcnt(0)
    v_mfma_f32_16x16x32_bf16 v[96:99], v[176:179], a[80:83], v[96:99]
    ds_read_b128 v[160:163], v224 offset:24576
    v_mul_f32 v54, v58, v58
    v_mfma_f32_16x16x32_bf16 v[100:103], v[180:183], a[80:83], v[100:103]
    ds_read_b128 v[164:167], v224 offset:26624
    v_sub_f32 v59, v19, v48
    v_mfma_f32_16x16x32_bf16 v[104:107], v[176:179], a[84:87], v[104:107]
    ds_read_b128 v[168:171], v224 offset:28672
    v_mul_f32 v55, v59, v59
    v_mfma_f32_16x16x32_bf16 v[108:111], v[180:183], a[84:87], v[108:111]
    ds_read_b128 v[172:175], v224 offset:30720
    v_sub_f32 v56, v20, v48
    v_mfma_f32_16x16x32_bf16 v[112:115], v[176:179], a[88:91], v[112:115]
    v_fmac_f32 v52, v56, v56
    v_sub_f32 v57, v21, v48
    v_mfma_f32_16x16x32_bf16 v[116:119], v[180:183], a[88:91], v[116:119]
    v_fmac_f32 v53, v57, v57
    v_sub_f32 v58, v22, v48
    v_mfma_f32_16x16x32_bf16 v[120:123], v[176:179], a[92:95], v[120:123]
    v_fmac_f32 v54, v58, v58
    v_mfma_f32_16x16x32_bf16 v[124:127], v[180:183], a[92:95], v[124:127]
    v_sub_f32 v59, v23, v48
    v_fmac_f32 v55, v59, v59
    v_mfma_f32_16x16x32_bf16 v[128:131], v[184:187], a[80:83], v[128:131]
    v_sub_f32 v56, v24, v48
    v_fmac_f32 v52, v56, v56
    v_mfma_f32_16x16x32_bf16 v[132:135], v[188:191], a[80:83], v[132:135]
    v_sub_f32 v57, v25, v48
    v_fmac_f32 v53, v57, v57
    v_mfma_f32_16x16x32_bf16 v[136:139], v[184:187], a[84:87], v[136:139]
    v_sub_f32 v58, v26, v48
    v_fmac_f32 v54, v58, v58
    v_mfma_f32_16x16x32_bf16 v[140:143], v[188:191], a[84:87], v[140:143]
    v_sub_f32 v59, v27, v48
    v_fmac_f32 v55, v59, v59
    v_mfma_f32_16x16x32_bf16 v[144:147], v[184:187], a[88:91], v[144:147]
    v_sub_f32 v56, v28, v48
    v_mfma_f32_16x16x32_bf16 v[148:151], v[188:191], a[88:91], v[148:151]
    v_fmac_f32 v52, v56, v56
    v_sub_f32 v57, v29, v48
    v_mfma_f32_16x16x32_bf16 v[152:155], v[184:187], a[92:95], v[152:155]
    s_add_u32 s38, s36, 0
    buffer_store_dwordx4 v[68:71], v240, s[16:19], s38 offen offset:1024 sc1
    v_mfma_f32_16x16x32_bf16 v[156:159], v[188:191], a[92:95], v[156:159]
    v_fmac_f32 v53, v57, v57
    s_waitcnt lgkmcnt(0)
    v_mfma_f32_16x16x32_bf16 v[96:99], v[160:163], a[96:99], v[96:99]
    ds_read_b128 v[176:179], v225 offset:24576
    v_sub_f32 v58, v30, v48
    v_mfma_f32_16x16x32_bf16 v[100:103], v[164:167], a[96:99], v[100:103]
    ds_read_b128 v[180:183], v225 offset:26624
    v_fmac_f32 v54, v58, v58
    v_mfma_f32_16x16x32_bf16 v[104:107], v[160:163], a[100:103], v[104:107]
    ds_read_b128 v[184:187], v225 offset:28672
    v_sub_f32 v59, v31, v48
    v_mfma_f32_16x16x32_bf16 v[108:111], v[164:167], a[100:103], v[108:111]
    ds_read_b128 v[188:191], v225 offset:30720
    v_fmac_f32 v55, v59, v59
    v_mfma_f32_16x16x32_bf16 v[112:115], v[160:163], a[104:107], v[112:115]
    v_sub_f32 v56, v32, v48
    v_fmac_f32 v52, v56, v56
    v_mfma_f32_16x16x32_bf16 v[116:119], v[164:167], a[104:107], v[116:119]
    v_sub_f32 v57, v33, v48
    v_fmac_f32 v53, v57, v57
    v_mfma_f32_16x16x32_bf16 v[120:123], v[160:163], a[108:111], v[120:123]
    v_sub_f32 v58, v34, v48
    v_fmac_f32 v54, v58, v58
    v_mfma_f32_16x16x32_bf16 v[124:127], v[164:167], a[108:111], v[124:127]
    v_sub_f32 v59, v35, v48
    v_mfma_f32_16x16x32_bf16 v[128:131], v[168:171], a[96:99], v[128:131]
    v_fmac_f32 v55, v59, v59
    v_sub_f32 v56, v36, v48
    v_mfma_f32_16x16x32_bf16 v[132:135], v[172:175], a[96:99], v[132:135]
    v_fmac_f32 v52, v56, v56
    v_sub_f32 v57, v37, v48
    v_mfma_f32_16x16x32_bf16 v[136:139], v[168:171], a[100:103], v[136:139]
    v_fmac_f32 v53, v57, v57
    v_sub_f32 v58, v38, v48
    v_mfma_f32_16x16x32_bf16 v[140:143], v[172:175], a[100:103], v[140:143]
    v_fmac_f32 v54, v58, v58
    v_sub_f32 v59, v39, v48
    v_mfma_f32_16x16x32_bf16 v[144:147], v[168:171], a[104:107], v[144:147]
    v_fmac_f32 v55, v59, v59
    v_sub_f32 v56, v40, v48
    v_mfma_f32_16x16x32_bf16 v[148:151], v[172:175], a[104:107], v[148:151]
    v_fmac_f32 v52, v56, v56
    v_mfma_f32_16x16x32_bf16 v[152:155], v[168:171], a[108:111], v[152:155]
    s_add_u32 s38, s36, 0
    buffer_store_dwordx4 v[72:75], v240, s[16:19], s38 offen offset:2048 sc1
    v_mfma_f32_16x16x32_bf16 v[156:159], v[172:175], a[108:111], v[156:159]
    s_waitcnt vmcnt(27) lgkmcnt(0)
    s_barrier
    v_mfma_f32_16x16x32_bf16 v[96:99], v[176:179], a[112:115], v[96:99]
    ds_read_b128 v[160:163], v224 offset:32768
    v_sub_f32 v57, v41, v48
    v_mfma_f32_16x16x32_bf16 v[100:103], v[180:183], a[112:115], v[100:103]
    ds_read_b128 v[164:167], v224 offset:34816
    v_fmac_f32 v53, v57, v57
    v_mfma_f32_16x16x32_bf16 v[104:107], v[176:179], a[116:119], v[104:107]
    ds_read_b128 v[168:171], v224 offset:36864
    v_sub_f32 v58, v42, v48
    v_mfma_f32_16x16x32_bf16 v[108:111], v[180:183], a[116:119], v[108:111]
    ds_read_b128 v[172:175], v224 offset:38912
    v_fmac_f32 v54, v58, v58
    v_mfma_f32_16x16x32_bf16 v[112:115], v[176:179], a[120:123], v[112:115]
    v_sub_f32 v59, v43, v48
    v_fmac_f32 v55, v59, v59
    v_mfma_f32_16x16x32_bf16 v[116:119], v[180:183], a[120:123], v[116:119]
    s_add_u32 m0, s34, 16384
    s_add_u32 s37, s82, 196608
    buffer_load_dwordx4 v232, s[44:47], s37 offen lds
    v_mfma_f32_16x16x32_bf16 v[120:123], v[176:179], a[124:127], v[120:123]
    v_sub_f32 v56, v44, v48
    v_fmac_f32 v52, v56, v56
    v_mfma_f32_16x16x32_bf16 v[124:127], v[180:183], a[124:127], v[124:127]
    buffer_load_dwordx4 v233, s[44:47], s37 offen offset:1024 lds
    v_sub_f32 v57, v45, v48
    v_mfma_f32_16x16x32_bf16 v[128:131], v[184:187], a[112:115], v[128:131]
    v_fmac_f32 v53, v57, v57
    v_sub_f32 v58, v46, v48
    v_mfma_f32_16x16x32_bf16 v[132:135], v[188:191], a[112:115], v[132:135]
    s_add_u32 m0, s34, 24576
    s_add_u32 s37, s83, 196608
    buffer_load_dwordx4 v232, s[44:47], s37 offen lds
    v_mfma_f32_16x16x32_bf16 v[136:139], v[184:187], a[116:119], v[136:139]
    v_fmac_f32 v54, v58, v58
    v_mfma_f32_16x16x32_bf16 v[140:143], v[188:191], a[116:119], v[140:143]
    buffer_load_dwordx4 v233, s[44:47], s37 offen offset:1024 lds
    v_sub_f32 v59, v47, v48
    v_mfma_f32_16x16x32_bf16 v[144:147], v[184:187], a[120:123], v[144:147]
    v_fmac_f32 v55, v59, v59
    v_add_f32 v52, v52, v53
    v_mfma_f32_16x16x32_bf16 v[148:151], v[188:191], a[120:123], v[148:151]
    v_add_f32 v54, v54, v55
    v_add_f32 v51, v52, v54
    v_mfma_f32_16x16x32_bf16 v[152:155], v[184:187], a[124:127], v[152:155]
    s_nop 1
    v_add_f32_dpp v51, v51, v51 quad_perm:[1,0,3,2] row_mask:0xf bank_mask:0xf
    v_mfma_f32_16x16x32_bf16 v[156:159], v[188:191], a[124:127], v[156:159]
    s_nop 1
    s_waitcnt lgkmcnt(0)
    v_mfma_f32_16x16x32_bf16 v[96:99], v[160:163], a[128:131], v[96:99]
    ds_read_b128 v[176:179], v225 offset:32768
    v_add_f32_dpp v51, v51, v51 quad_perm:[2,3,0,1] row_mask:0xf bank_mask:0xf
    v_mfma_f32_16x16x32_bf16 v[100:103], v[164:167], a[128:131], v[100:103]
    ds_read_b128 v[180:183], v225 offset:34816
    s_nop 1
    v_mfma_f32_16x16x32_bf16 v[104:107], v[160:163], a[132:135], v[104:107]
    ds_read_b128 v[184:187], v225 offset:36864
    v_add_f32_dpp v51, v51, v51 row_half_mirror row_mask:0xf bank_mask:0xf
    v_mfma_f32_16x16x32_bf16 v[108:111], v[164:167], a[132:135], v[108:111]
    ds_read_b128 v[188:191], v225 offset:38912
    s_nop 1
    v_mfma_f32_16x16x32_bf16 v[112:115], v[160:163], a[136:139], v[112:115]
    v_add_f32_dpp v51, v51, v51 row_mirror row_mask:0xf bank_mask:0xf
    v_mfma_f32_16x16x32_bf16 v[116:119], v[164:167], a[136:139], v[116:119]
    s_nop 0
    v_mov_b32 v49, v51
    v_mfma_f32_16x16x32_bf16 v[120:123], v[160:163], a[140:143], v[120:123]
    s_nop 1
    v_permlane16_swap_b32 v51, v49
    v_mfma_f32_16x16x32_bf16 v[124:127], v[164:167], a[140:143], v[124:127]
    s_nop 0
    v_add_f32 v51, v51, v49
    v_mfma_f32_16x16x32_bf16 v[128:131], v[168:171], a[128:131], v[128:131]
    v_mul_f32 v51, 0x3a800000, v51
    v_cvt_pk_bf16_f32 v50, v48, v51
    v_mfma_f32_16x16x32_bf16 v[132:135], v[172:175], a[128:131], v[132:135]
    v_and_b32 v51, 0xffff0000, v50
    v_lshlrev_b32 v50, 16, v50
    v_mfma_f32_16x16x32_bf16 v[136:139], v[168:171], a[132:135], v[136:139]
    v_add_f32 v51, 0x3727c5ac, v51
    v_cvt_pk_bf16_f32 v51, v51, v51
    v_mfma_f32_16x16x32_bf16 v[140:143], v[172:175], a[132:135], v[140:143]
    v_lshlrev_b32 v51, 16, v51
    v_mfma_f32_16x16x32_bf16 v[144:147], v[168:171], a[136:139], v[144:147]
    v_sqrt_f32 v51, v51
    v_mfma_f32_16x16x32_bf16 v[148:151], v[172:175], a[136:139], v[148:151]
    s_nop 0
    v_cvt_pk_bf16_f32 v51, v51, v51
    v_mfma_f32_16x16x32_bf16 v[152:155], v[168:171], a[140:143], v[152:155]
    s_add_u32 s38, s36, 0
    buffer_store_dwordx4 v[76:79], v240, s[16:19], s38 offen offset:3072 sc1
    v_mfma_f32_16x16x32_bf16 v[156:159], v[172:175], a[140:143], v[156:159]
    v_lshlrev_b32 v51, 16, v51
    s_waitcnt lgkmcnt(0)
    v_mfma_f32_16x16x32_bf16 v[96:99], v[176:179], a[144:147], v[96:99]
    ds_read_b128 v[160:163], v224 offset:40960
    v_mfma_f32_16x16x32_bf16 v[100:103], v[180:183], a[144:147], v[100:103]
    ds_read_b128 v[164:167], v224 offset:43008
    v_rcp_f32 v51, v51
    v_mfma_f32_16x16x32_bf16 v[104:107], v[176:179], a[148:151], v[104:107]
    ds_read_b128 v[168:171], v224 offset:45056
    s_nop 0
    v_mfma_f32_16x16x32_bf16 v[108:111], v[180:183], a[148:151], v[108:111]
    ds_read_b128 v[172:175], v224 offset:47104
    v_sub_f32 v16, v16, v50
    v_mfma_f32_16x16x32_bf16 v[112:115], v[176:179], a[152:155], v[112:115]
    v_sub_f32 v17, v17, v50
    v_cvt_pk_bf16_f32 v17, v16, v17
    v_mfma_f32_16x16x32_bf16 v[116:119], v[180:183], a[152:155], v[116:119]
    v_lshlrev_b32 v16, 16, v17
    v_mfma_f32_16x16x32_bf16 v[120:123], v[176:179], a[156:159], v[120:123]
    v_and_b32 v17, 0xffff0000, v17
    v_mul_f32 v16, v16, v51
    v_mfma_f32_16x16x32_bf16 v[124:127], v[180:183], a[156:159], v[124:127]
    v_mul_f32 v17, v17, v51
    v_cvt_pk_bf16_f32 v0, v16, v17
    v_mfma_f32_16x16x32_bf16 v[128:131], v[184:187], a[144:147], v[128:131]
    v_sub_f32 v18, v18, v50
    v_sub_f32 v19, v19, v50
    v_mfma_f32_16x16x32_bf16 v[132:135], v[188:191], a[144:147], v[132:135]
    v_cvt_pk_bf16_f32 v19, v18, v19
    v_lshlrev_b32 v18, 16, v19
    v_mfma_f32_16x16x32_bf16 v[136:139], v[184:187], a[148:151], v[136:139]
    v_and_b32 v19, 0xffff0000, v19
    v_mul_f32 v18, v18, v51
    v_mfma_f32_16x16x32_bf16 v[140:143], v[188:191], a[148:151], v[140:143]
    v_mul_f32 v19, v19, v51
    v_mfma_f32_16x16x32_bf16 v[144:147], v[184:187], a[152:155], v[144:147]
    v_cvt_pk_bf16_f32 v1, v18, v19
    v_sub_f32 v20, v20, v50
    v_mfma_f32_16x16x32_bf16 v[148:151], v[188:191], a[152:155], v[148:151]
    v_sub_f32 v21, v21, v50
    v_cvt_pk_bf16_f32 v21, v20, v21
    v_mfma_f32_16x16x32_bf16 v[152:155], v[184:187], a[156:159], v[152:155]
    s_add_u32 s38, s36, 8192
    buffer_store_dwordx4 v[80:83], v240, s[16:19], s38 offen offset:0 sc1
    v_mfma_f32_16x16x32_bf16 v[156:159], v[188:191], a[156:159], v[156:159]
    v_lshlrev_b32 v20, 16, v21
    s_waitcnt lgkmcnt(0)
    v_mfma_f32_16x16x32_bf16 v[96:99], v[160:163], a[160:163], v[96:99]
    ds_read_b128 v[176:179], v225 offset:40960
    v_and_b32 v21, 0xffff0000, v21
    v_mfma_f32_16x16x32_bf16 v[100:103], v[164:167], a[160:163], v[100:103]
    ds_read_b128 v[180:183], v225 offset:43008
    v_mul_f32 v20, v20, v51
    v_mfma_f32_16x16x32_bf16 v[104:107], v[160:163], a[164:167], v[104:107]
    ds_read_b128 v[184:187], v225 offset:45056
    v_mul_f32 v21, v21, v51
    v_mfma_f32_16x16x32_bf16 v[108:111], v[164:167], a[164:167], v[108:111]
    ds_read_b128 v[188:191], v225 offset:47104
    v_cvt_pk_bf16_f32 v2, v20, v21
    v_mfma_f32_16x16x32_bf16 v[112:115], v[160:163], a[168:171], v[112:115]
    v_sub_f32 v22, v22, v50
    v_sub_f32 v23, v23, v50
    v_mfma_f32_16x16x32_bf16 v[116:119], v[164:167], a[168:171], v[116:119]
    v_cvt_pk_bf16_f32 v23, v22, v23
    v_lshlrev_b32 v22, 16, v23
    v_mfma_f32_16x16x32_bf16 v[120:123], v[160:163], a[172:175], v[120:123]
    v_and_b32 v23, 0xffff0000, v23
    v_mfma_f32_16x16x32_bf16 v[124:127], v[164:167], a[172:175], v[124:127]
    v_mul_f32 v22, v22, v51
    v_mul_f32 v23, v23, v51
    v_mfma_f32_16x16x32_bf16 v[128:131], v[168:171], a[160:163], v[128:131]
    v_cvt_pk_bf16_f32 v3, v22, v23
    ds_write_b128 v237, v[0:3] offset:0
    v_mfma_f32_16x16x32_bf16 v[132:135], v[172:175], a[160:163], v[132:135]
    v_sub_f32 v24, v24, v50
    v_sub_f32 v25, v25, v50
    v_mfma_f32_16x16x32_bf16 v[136:139], v[168:171], a[164:167], v[136:139]
    v_cvt_pk_bf16_f32 v25, v24, v25
    v_lshlrev_b32 v24, 16, v25
    v_mfma_f32_16x16x32_bf16 v[140:143], v[172:175], a[164:167], v[140:143]
    v_and_b32 v25, 0xffff0000, v25
    v_mul_f32 v24, v24, v51
    v_mfma_f32_16x16x32_bf16 v[144:147], v[168:171], a[168:171], v[144:147]
    v_mul_f32 v25, v25, v51
    v_mfma_f32_16x16x32_bf16 v[148:151], v[172:175], a[168:171], v[148:151]
    v_cvt_pk_bf16_f32 v4, v24, v25
    v_sub_f32 v26, v26, v50
    v_mfma_f32_16x16x32_bf16 v[152:155], v[168:171], a[172:175], v[152:155]
    s_add_u32 s38, s36, 8192
    buffer_store_dwordx4 v[84:87], v240, s[16:19], s38 offen offset:1024 sc1
    v_mfma_f32_16x16x32_bf16 v[156:159], v[172:175], a[172:175], v[156:159]
    s_waitcnt vmcnt(30) lgkmcnt(0)
    s_barrier
    v_mfma_f32_16x16x32_bf16 v[96:99], v[176:179], a[176:179], v[96:99]
    ds_read_b128 v[160:163], v224 offset:49152
    v_sub_f32 v27, v27, v50
    v_mfma_f32_16x16x32_bf16 v[100:103], v[180:183], a[176:179], v[100:103]
    ds_read_b128 v[164:167], v224 offset:51200
    v_cvt_pk_bf16_f32 v27, v26, v27
    v_mfma_f32_16x16x32_bf16 v[104:107], v[176:179], a[180:183], v[104:107]
    ds_read_b128 v[168:171], v224 offset:53248
    v_lshlrev_b32 v26, 16, v27
    v_mfma_f32_16x16x32_bf16 v[108:111], v[180:183], a[180:183], v[108:111]
    ds_read_b128 v[172:175], v224 offset:55296
    v_and_b32 v27, 0xffff0000, v27
    v_mfma_f32_16x16x32_bf16 v[112:115], v[176:179], a[184:187], v[112:115]
    v_mul_f32 v26, v26, v51
    v_mul_f32 v27, v27, v51
    v_mfma_f32_16x16x32_bf16 v[116:119], v[180:183], a[184:187], v[116:119]
    s_add_u32 m0, s34, 32768
    s_add_u32 s37, s84, 196608
    buffer_load_dwordx4 v232, s[44:47], s37 offen lds
    v_mfma_f32_16x16x32_bf16 v[120:123], v[176:179], a[188:191], v[120:123]
    v_cvt_pk_bf16_f32 v5, v26, v27
    v_sub_f32 v28, v28, v50
    v_mfma_f32_16x16x32_bf16 v[124:127], v[180:183], a[188:191], v[124:127]
    buffer_load_dwordx4 v233, s[44:47], s37 offen offset:1024 lds
    v_sub_f32 v29, v29, v50
    v_mfma_f32_16x16x32_bf16 v[128:131], v[184:187], a[176:179], v[128:131]
    v_cvt_pk_bf16_f32 v29, v28, v29
    v_mfma_f32_16x16x32_bf16 v[132:135], v[188:191], a[176:179], v[132:135]
    s_add_u32 m0, s34, 40960
    s_add_u32 s37, s85, 196608
    buffer_load_dwordx4 v232, s[44:47], s37 offen lds
    v_mfma_f32_16x16x32_bf16 v[136:139], v[184:187], a[180:183], v[136:139]
    v_lshlrev_b32 v28, 16, v29
    v_and_b32 v29, 0xffff0000, v29
    v_mfma_f32_16x16x32_bf16 v[140:143], v[188:191], a[180:183], v[140:143]
    buffer_load_dwordx4 v233, s[44:47], s37 offen offset:1024 lds
    v_mul_f32 v28, v28, v51
    v_mfma_f32_16x16x32_bf16 v[144:147], v[184:187], a[184:187], v[144:147]
    v_mul_f32 v29, v29, v51
    v_cvt_pk_bf16_f32 v6, v28, v29
    v_mfma_f32_16x16x32_bf16 v[148:151], v[188:191], a[184:187], v[148:151]
    v_sub_f32 v30, v30, v50
    v_sub_f32 v31, v31, v50
    v_mfma_f32_16x16x32_bf16 v[152:155], v[184:187], a[188:191], v[152:155]
    v_cvt_pk_bf16_f32 v31, v30, v31
    v_lshlrev_b32 v30, 16, v31
    v_mfma_f32_16x16x32_bf16 v[156:159], v[188:191], a[188:191], v[156:159]
    v_and_b32 v31, 0xffff0000, v31
    s_waitcnt lgkmcnt(0)
    v_mfma_f32_16x16x32_bf16 v[96:99], v[160:163], a[192:195], v[96:99]
    ds_read_b128 v[176:179], v225 offset:49152
    v_mul_f32 v30, v30, v51
    v_mfma_f32_16x16x32_bf16 v[100:103], v[164:167], a[192:195], v[100:103]
    ds_read_b128 v[180:183], v225 offset:51200
    v_mul_f32 v31, v31, v51
    v_mfma_f32_16x16x32_bf16 v[104:107], v[160:163], a[196:199], v[104:107]
    ds_read_b128 v[184:187], v225 offset:53248
    v_mfma_f32_16x16x32_bf16 v[108:111], v[164:167], a[196:199], v[108:111]
    ds_read_b128 v[188:191], v225 offset:55296
    v_cvt_pk_bf16_f32 v7, v30, v31
    v_mfma_f32_16x16x32_bf16 v[112:115], v[160:163], a[200:203], v[112:115]
    ds_write_b128 v237, v[4:7] offset:4096
    v_sub_f32 v32, v32, v50
    v_mfma_f32_16x16x32_bf16 v[116:119], v[164:167], a[200:203], v[116:119]
    v_sub_f32 v33, v33, v50
    v_cvt_pk_bf16_f32 v33, v32, v33
    v_mfma_f32_16x16x32_bf16 v[120:123], v[160:163], a[204:207], v[120:123]
    v_lshlrev_b32 v32, 16, v33
    v_and_b32 v33, 0xffff0000, v33
    v_mfma_f32_16x16x32_bf16 v[124:127], v[164:167], a[204:207], v[124:127]
    v_mul_f32 v32, v32, v51
    v_mul_f32 v33, v33, v51
    v_mfma_f32_16x16x32_bf16 v[128:131], v[168:171], a[192:195], v[128:131]
    v_cvt_pk_bf16_f32 v8, v32, v33
    v_sub_f32 v34, v34, v50
    v_mfma_f32_16x16x32_bf16 v[132:135], v[172:175], a[192:195], v[132:135]
    v_sub_f32 v35, v35, v50
    v_cvt_pk_bf16_f32 v35, v34, v35
    v_mfma_f32_16x16x32_bf16 v[136:139], v[168:171], a[196:199], v[136:139]
    v_lshlrev_b32 v34, 16, v35
    v_mfma_f32_16x16x32_bf16 v[140:143], v[172:175], a[196:199], v[140:143]
    v_and_b32 v35, 0xffff0000, v35
    v_mul_f32 v34, v34, v51
    v_mfma_f32_16x16x32_bf16 v[144:147], v[168:171], a[200:203], v[144:147]
    v_mul_f32 v35, v35, v51
    v_cvt_pk_bf16_f32 v9, v34, v35
    v_mfma_f32_16x16x32_bf16 v[148:151], v[172:175], a[200:203], v[148:151]
    v_sub_f32 v36, v36, v50
    v_sub_f32 v37, v37, v50
    v_mfma_f32_16x16x32_bf16 v[152:155], v[168:171], a[204:207], v[152:155]
    v_cvt_pk_bf16_f32 v37, v36, v37
    v_lshlrev_b32 v36, 16, v37
    v_mfma_f32_16x16x32_bf16 v[156:159], v[172:175], a[204:207], v[156:159]
    v_and_b32 v37, 0xffff0000, v37
    s_waitcnt lgkmcnt(0)
    v_mfma_f32_16x16x32_bf16 v[96:99], v[176:179], a[208:211], v[96:99]
    ds_read_b128 v[160:163], v224 offset:57344
    v_mul_f32 v36, v36, v51
    v_mfma_f32_16x16x32_bf16 v[100:103], v[180:183], a[208:211], v[100:103]
    ds_read_b128 v[164:167], v224 offset:59392
    v_mul_f32 v37, v37, v51
    v_mfma_f32_16x16x32_bf16 v[104:107], v[176:179], a[212:215], v[104:107]
    ds_read_b128 v[168:171], v224 offset:61440
    v_mfma_f32_16x16x32_bf16 v[108:111], v[180:183], a[212:215], v[108:111]
    ds_read_b128 v[172:175], v224 offset:63488
    v_cvt_pk_bf16_f32 v10, v36, v37
    v_mfma_f32_16x16x32_bf16 v[112:115], v[176:179], a[216:219], v[112:115]
    v_sub_f32 v38, v38, v50
    v_sub_f32 v39, v39, v50
    v_mfma_f32_16x16x32_bf16 v[116:119], v[180:183], a[216:219], v[116:119]
    v_cvt_pk_bf16_f32 v39, v38, v39
    v_lshlrev_b32 v38, 16, v39
    v_mfma_f32_16x16x32_bf16 v[120:123], v[176:179], a[220:223], v[120:123]
    v_and_b32 v39, 0xffff0000, v39
    v_mul_f32 v38, v38, v51
    v_mfma_f32_16x16x32_bf16 v[124:127], v[180:183], a[220:223], v[124:127]
    v_mul_f32 v39, v39, v51
    v_cvt_pk_bf16_f32 v11, v38, v39
    v_mfma_f32_16x16x32_bf16 v[128:131], v[184:187], a[208:211], v[128:131]
    ds_write_b128 v237, v[8:11] offset:8192
    v_sub_f32 v40, v40, v50
    v_mfma_f32_16x16x32_bf16 v[132:135], v[188:191], a[208:211], v[132:135]
    v_sub_f32 v41, v41, v50
    v_mfma_f32_16x16x32_bf16 v[136:139], v[184:187], a[212:215], v[136:139]
    v_cvt_pk_bf16_f32 v41, v40, v41
    v_lshlrev_b32 v40, 16, v41
    v_mfma_f32_16x16x32_bf16 v[140:143], v[188:191], a[212:215], v[140:143]
    v_and_b32 v41, 0xffff0000, v41
    v_mul_f32 v40, v40, v51
    v_mfma_f32_16x16x32_bf16 v[144:147], v[184:187], a[216:219], v[144:147]
    v_mul_f32 v41, v41, v51
    v_cvt_pk_bf16_f32 v12, v40, v41
    v_mfma_f32_16x16x32_bf16 v[148:151], v[188:191], a[216:219], v[148:151]
    v_sub_f32 v42, v42, v50
    v_sub_f32 v43, v43, v50
    v_mfma_f32_16x16x32_bf16 v[152:155], v[184:187], a[220:223], v[152:155]
    s_add_u32 s38, s36, 8192
    buffer_store_dwordx4 v[88:91], v240, s[16:19], s38 offen offset:2048 sc1
    v_mfma_f32_16x16x32_bf16 v[156:159], v[188:191], a[220:223], v[156:159]
    v_cvt_pk_bf16_f32 v43, v42, v43
    s_waitcnt lgkmcnt(0)
    v_mfma_f32_16x16x32_bf16 v[96:99], v[160:163], a[224:227], v[96:99]
    ds_read_b128 v[176:179], v225 offset:57344
    v_lshlrev_b32 v42, 16, v43
    v_mfma_f32_16x16x32_bf16 v[100:103], v[164:167], a[224:227], v[100:103]
    ds_read_b128 v[180:183], v225 offset:59392
    v_and_b32 v43, 0xffff0000, v43
    v_mfma_f32_16x16x32_bf16 v[104:107], v[160:163], a[228:231], v[104:107]
    ds_read_b128 v[184:187], v225 offset:61440
    v_mul_f32 v42, v42, v51
    v_mfma_f32_16x16x32_bf16 v[108:111], v[164:167], a[228:231], v[108:111]
    ds_read_b128 v[188:191], v225 offset:63488
    v_mul_f32 v43, v43, v51
    v_mfma_f32_16x16x32_bf16 v[112:115], v[160:163], a[232:235], v[112:115]
    v_cvt_pk_bf16_f32 v13, v42, v43
    v_mfma_f32_16x16x32_bf16 v[116:119], v[164:167], a[232:235], v[116:119]
    v_sub_f32 v44, v44, v50
    v_sub_f32 v45, v45, v50
    v_mfma_f32_16x16x32_bf16 v[120:123], v[160:163], a[236:239], v[120:123]
    v_cvt_pk_bf16_f32 v45, v44, v45
    v_lshlrev_b32 v44, 16, v45
    v_mfma_f32_16x16x32_bf16 v[124:127], v[164:167], a[236:239], v[124:127]
    v_and_b32 v45, 0xffff0000, v45
    v_mul_f32 v44, v44, v51
    v_mfma_f32_16x16x32_bf16 v[128:131], v[168:171], a[224:227], v[128:131]
    v_mul_f32 v45, v45, v51
    v_cvt_pk_bf16_f32 v14, v44, v45
    v_mfma_f32_16x16x32_bf16 v[132:135], v[172:175], a[224:227], v[132:135]
    v_sub_f32 v46, v46, v50
    v_sub_f32 v47, v47, v50
    v_mfma_f32_16x16x32_bf16 v[136:139], v[168:171], a[228:231], v[136:139]
    v_cvt_pk_bf16_f32 v47, v46, v47
    v_mfma_f32_16x16x32_bf16 v[140:143], v[172:175], a[228:231], v[140:143]
    v_lshlrev_b32 v46, 16, v47
    v_and_b32 v47, 0xffff0000, v47
    v_mfma_f32_16x16x32_bf16 v[144:147], v[168:171], a[232:235], v[144:147]
    v_mul_f32 v46, v46, v51
    v_mul_f32 v47, v47, v51
    v_mfma_f32_16x16x32_bf16 v[148:151], v[172:175], a[232:235], v[148:151]
    v_cvt_pk_bf16_f32 v15, v46, v47
    ds_write_b128 v237, v[12:15] offset:12288
    v_mfma_f32_16x16x32_bf16 v[152:155], v[168:171], a[236:239], v[152:155]
    s_add_u32 s38, s36, 8192
    buffer_store_dwordx4 v[92:95], v240, s[16:19], s38 offen offset:3072 sc1
    v_mfma_f32_16x16x32_bf16 v[156:159], v[172:175], a[236:239], v[156:159]
    s_waitcnt vmcnt(20) lgkmcnt(0)
    s_barrier
    v_mfma_f32_16x16x32_bf16 v[96:99], v[176:179], a[240:243], v[96:99]
    ds_read_b128 v[160:163], v226 offset:0
    v_mfma_f32_16x16x32_bf16 v[100:103], v[180:183], a[240:243], v[100:103]
    ds_read_b128 v[164:167], v226 offset:2048
    v_mfma_f32_16x16x32_bf16 v[104:107], v[176:179], a[244:247], v[104:107]
    ds_read_b128 v[168:171], v226 offset:4096
    v_mfma_f32_16x16x32_bf16 v[108:111], v[180:183], a[244:247], v[108:111]
    ds_read_b128 v[172:175], v226 offset:6144
    v_mfma_f32_16x16x32_bf16 v[112:115], v[176:179], a[248:251], v[112:115]
    v_lshlrev_b32 v237, 4, v253
    v_add_u32 v237, 65536, v237
    ds_read_b128 v[16:19], v237 offset:0
    ds_read_b128 v[20:23], v237 offset:4096
    ds_read_b128 v[24:27], v237 offset:8192
    ds_read_b128 v[28:31], v237 offset:12288
    v_mfma_f32_16x16x32_bf16 v[116:119], v[180:183], a[248:251], v[116:119]
    s_add_u32 m0, s34, 49152
    s_add_u32 s37, s86, 196608
    buffer_load_dwordx4 v232, s[44:47], s37 offen lds
    v_mfma_f32_16x16x32_bf16 v[120:123], v[176:179], a[252:255], v[120:123]
    v_mfma_f32_16x16x32_bf16 v[124:127], v[180:183], a[252:255], v[124:127]
    buffer_load_dwordx4 v233, s[44:47], s37 offen offset:1024 lds
    v_mfma_f32_16x16x32_bf16 v[128:131], v[184:187], a[240:243], v[128:131]
    v_mfma_f32_16x16x32_bf16 v[132:135], v[188:191], a[240:243], v[132:135]
    s_add_u32 m0, s34, 57344
    s_add_u32 s37, s87, 196608
    buffer_load_dwordx4 v232, s[44:47], s37 offen lds
    v_cvt_pk_bf16_f32 v64, v96, v97
    v_cvt_pk_bf16_f32 v65, v98, v99
    v_mfma_f32_16x16x32_bf16 v[136:139], v[184:187], a[244:247], v[136:139]
    v_cvt_pk_bf16_f32 v66, v100, v101
    v_cvt_pk_bf16_f32 v67, v102, v103
    v_mfma_f32_16x16x32_bf16 v[140:143], v[188:191], a[244:247], v[140:143]
    buffer_load_dwordx4 v233, s[44:47], s37 offen offset:1024 lds
    v_cvt_pk_bf16_f32 v68, v104, v105
    v_cvt_pk_bf16_f32 v69, v106, v107
    v_mfma_f32_16x16x32_bf16 v[144:147], v[184:187], a[248:251], v[144:147]
    v_cvt_pk_bf16_f32 v70, v108, v109
    v_cvt_pk_bf16_f32 v71, v110, v111
    v_mfma_f32_16x16x32_bf16 v[148:151], v[188:191], a[248:251], v[148:151]
    v_cvt_pk_bf16_f32 v72, v112, v113
    v_cvt_pk_bf16_f32 v73, v114, v115
    v_mfma_f32_16x16x32_bf16 v[152:155], v[184:187], a[252:255], v[152:155]
    v_cvt_pk_bf16_f32 v74, v116, v117
    v_cvt_pk_bf16_f32 v75, v118, v119
    v_mfma_f32_16x16x32_bf16 v[156:159], v[188:191], a[252:255], v[156:159]
    v_cvt_pk_bf16_f32 v76, v120, v121
    v_cvt_pk_bf16_f32 v77, v122, v123
    s_waitcnt lgkmcnt(0)
    v_mfma_f32_16x16x32_bf16 v[96:99], v[160:163], a[0:3], 0
    ds_read_b128 v[176:179], v227 offset:0
    v_cvt_pk_bf16_f32 v78, v124, v125
    v_cvt_pk_bf16_f32 v79, v126, v127
    v_mfma_f32_16x16x32_bf16 v[100:103], v[164:167], a[0:3], 0
    ds_read_b128 v[180:183], v227 offset:2048
    v_cvt_pk_bf16_f32 v80, v128, v129
    v_cvt_pk_bf16_f32 v81, v130, v131
    v_mfma_f32_16x16x32_bf16 v[104:107], v[160:163], a[4:7], 0
    ds_read_b128 v[184:187], v227 offset:4096
    v_cvt_pk_bf16_f32 v82, v132, v133
    v_cvt_pk_bf16_f32 v83, v134, v135
    v_mfma_f32_16x16x32_bf16 v[108:111], v[164:167], a[4:7], 0
    ds_read_b128 v[188:191], v227 offset:6144
    v_cvt_pk_bf16_f32 v84, v136, v137
    v_cvt_pk_bf16_f32 v85, v138, v139
    v_mfma_f32_16x16x32_bf16 v[112:115], v[160:163], a[8:11], 0
    v_cvt_pk_bf16_f32 v86, v140, v141
    v_cvt_pk_bf16_f32 v87, v142, v143
    v_mfma_f32_16x16x32_bf16 v[116:119], v[164:167], a[8:11], 0
    s_mov_b32 s39, 0
    buffer_store_dwordx4 v[16:19], v238, s[8:11], s39 offen sc1
    v_cvt_pk_bf16_f32 v88, v144, v145
    v_cvt_pk_bf16_f32 v89, v146, v147
    v_mfma_f32_16x16x32_bf16 v[120:123], v[160:163], a[12:15], 0
    v_cvt_pk_bf16_f32 v90, v148, v149
    v_cvt_pk_bf16_f32 v91, v150, v151
    v_mfma_f32_16x16x32_bf16 v[124:127], v[164:167], a[12:15], 0
    s_mov_b32 s39, 16384
    buffer_store_dwordx4 v[20:23], v238, s[8:11], s39 offen sc1
    v_cvt_pk_bf16_f32 v92, v152, v153
    v_cvt_pk_bf16_f32 v93, v154, v155
    v_mfma_f32_16x16x32_bf16 v[128:131], v[168:171], a[0:3], 0
    v_cvt_pk_bf16_f32 v94, v156, v157
    v_cvt_pk_bf16_f32 v95, v158, v159
    v_mfma_f32_16x16x32_bf16 v[132:135], v[172:175], a[0:3], 0
    s_mov_b32 s39, 32768
    buffer_store_dwordx4 v[24:27], v238, s[8:11], s39 offen sc1
    v_mfma_f32_16x16x32_bf16 v[136:139], v[168:171], a[4:7], 0
    v_mfma_f32_16x16x32_bf16 v[140:143], v[172:175], a[4:7], 0
    s_mov_b32 s39, 49152
    buffer_store_dwordx4 v[28:31], v238, s[8:11], s39 offen sc1
    v_mfma_f32_16x16x32_bf16 v[144:147], v[168:171], a[8:11], 0
    v_mfma_f32_16x16x32_bf16 v[148:151], v[172:175], a[8:11], 0
    v_mfma_f32_16x16x32_bf16 v[152:155], v[168:171], a[12:15], 0
    v_mfma_f32_16x16x32_bf16 v[156:159], v[172:175], a[12:15], 0
    s_waitcnt lgkmcnt(0)
    v_mfma_f32_16x16x32_bf16 v[96:99], v[176:179], a[16:19], v[96:99]
    ds_read_b128 v[160:163], v226 offset:8192
    v_mfma_f32_16x16x32_bf16 v[100:103], v[180:183], a[16:19], v[100:103]
    ds_read_b128 v[164:167], v226 offset:10240
    v_mfma_f32_16x16x32_bf16 v[104:107], v[176:179], a[20:23], v[104:107]
    ds_read_b128 v[168:171], v226 offset:12288
    v_mfma_f32_16x16x32_bf16 v[108:111], v[180:183], a[20:23], v[108:111]
    ds_read_b128 v[172:175], v226 offset:14336
    v_mfma_f32_16x16x32_bf16 v[112:115], v[176:179], a[24:27], v[112:115]
    v_mfma_f32_16x16x32_bf16 v[116:119], v[180:183], a[24:27], v[116:119]
    v_mfma_f32_16x16x32_bf16 v[120:123], v[176:179], a[28:31], v[120:123]
    v_mfma_f32_16x16x32_bf16 v[124:127], v[180:183], a[28:31], v[124:127]
    v_mfma_f32_16x16x32_bf16 v[128:131], v[184:187], a[16:19], v[128:131]
    v_mfma_f32_16x16x32_bf16 v[132:135], v[188:191], a[16:19], v[132:135]
    v_mfma_f32_16x16x32_bf16 v[136:139], v[184:187], a[20:23], v[136:139]
    v_mfma_f32_16x16x32_bf16 v[140:143], v[188:191], a[20:23], v[140:143]
    v_mfma_f32_16x16x32_bf16 v[144:147], v[184:187], a[24:27], v[144:147]
    v_mfma_f32_16x16x32_bf16 v[148:151], v[188:191], a[24:27], v[148:151]
    v_mfma_f32_16x16x32_bf16 v[152:155], v[184:187], a[28:31], v[152:155]
    s_add_u32 s38, s36, 32768
    buffer_store_dwordx4 v[64:67], v240, s[16:19], s38 offen offset:0 sc1
    v_mfma_f32_16x16x32_bf16 v[156:159], v[188:191], a[28:31], v[156:159]
    s_waitcnt lgkmcnt(0)
    v_mfma_f32_16x16x32_bf16 v[96:99], v[160:163], a[32:35], v[96:99]
    ds_read_b128 v[176:179], v227 offset:8192
    v_mfma_f32_16x16x32_bf16 v[100:103], v[164:167], a[32:35], v[100:103]
    ds_read_b128 v[180:183], v227 offset:10240
    v_mfma_f32_16x16x32_bf16 v[104:107], v[160:163], a[36:39], v[104:107]
    ds_read_b128 v[184:187], v227 offset:12288
    v_mfma_f32_16x16x32_bf16 v[108:111], v[164:167], a[36:39], v[108:111]
    ds_read_b128 v[188:191], v227 offset:14336
    v_mfma_f32_16x16x32_bf16 v[112:115], v[160:163], a[40:43], v[112:115]
    v_mfma_f32_16x16x32_bf16 v[116:119], v[164:167], a[40:43], v[116:119]
    v_mfma_f32_16x16x32_bf16 v[120:123], v[160:163], a[44:47], v[120:123]
    v_mfma_f32_16x16x32_bf16 v[124:127], v[164:167], a[44:47], v[124:127]
    v_mfma_f32_16x16x32_bf16 v[128:131], v[168:171], a[32:35], v[128:131]
    v_mfma_f32_16x16x32_bf16 v[132:135], v[172:175], a[32:35], v[132:135]
    v_mfma_f32_16x16x32_bf16 v[136:139], v[168:171], a[36:39], v[136:139]
    v_mfma_f32_16x16x32_bf16 v[140:143], v[172:175], a[36:39], v[140:143]
    v_mfma_f32_16x16x32_bf16 v[144:147], v[168:171], a[40:43], v[144:147]
    v_mfma_f32_16x16x32_bf16 v[148:151], v[172:175], a[40:43], v[148:151]
    v_mfma_f32_16x16x32_bf16 v[152:155], v[168:171], a[44:47], v[152:155]
    s_add_u32 s38, s36, 32768
    buffer_store_dwordx4 v[68:71], v240, s[16:19], s38 offen offset:1024 sc1
    v_mfma_f32_16x16x32_bf16 v[156:159], v[172:175], a[44:47], v[156:159]
    s_waitcnt lgkmcnt(0)
    v_mfma_f32_16x16x32_bf16 v[96:99], v[176:179], a[48:51], v[96:99]
    ds_read_b128 v[160:163], v226 offset:16384
    v_mfma_f32_16x16x32_bf16 v[100:103], v[180:183], a[48:51], v[100:103]
    ds_read_b128 v[164:167], v226 offset:18432
    v_mfma_f32_16x16x32_bf16 v[104:107], v[176:179], a[52:55], v[104:107]
    ds_read_b128 v[168:171], v226 offset:20480
    v_mfma_f32_16x16x32_bf16 v[108:111], v[180:183], a[52:55], v[108:111]
    ds_read_b128 v[172:175], v226 offset:22528
    v_mfma_f32_16x16x32_bf16 v[112:115], v[176:179], a[56:59], v[112:115]
    v_mfma_f32_16x16x32_bf16 v[116:119], v[180:183], a[56:59], v[116:119]
    v_mfma_f32_16x16x32_bf16 v[120:123], v[176:179], a[60:63], v[120:123]
    v_mfma_f32_16x16x32_bf16 v[124:127], v[180:183], a[60:63], v[124:127]
    v_mfma_f32_16x16x32_bf16 v[128:131], v[184:187], a[48:51], v[128:131]
    v_mfma_f32_16x16x32_bf16 v[132:135], v[188:191], a[48:51], v[132:135]
    v_mfma_f32_16x16x32_bf16 v[136:139], v[184:187], a[52:55], v[136:139]
    v_mfma_f32_16x16x32_bf16 v[140:143], v[188:191], a[52:55], v[140:143]
    v_mfma_f32_16x16x32_bf16 v[144:147], v[184:187], a[56:59], v[144:147]
    v_mfma_f32_16x16x32_bf16 v[148:151], v[188:191], a[56:59], v[148:151]
    v_mfma_f32_16x16x32_bf16 v[152:155], v[184:187], a[60:63], v[152:155]
    s_add_u32 s38, s36, 32768
    buffer_store_dwordx4 v[72:75], v240, s[16:19], s38 offen offset:2048 sc1
    v_mfma_f32_16x16x32_bf16 v[156:159], v[188:191], a[60:63], v[156:159]
    s_waitcnt lgkmcnt(0)
    v_mfma_f32_16x16x32_bf16 v[96:99], v[160:163], a[64:67], v[96:99]
    ds_read_b128 v[176:179], v227 offset:16384
    v_mfma_f32_16x16x32_bf16 v[100:103], v[164:167], a[64:67], v[100:103]
    ds_read_b128 v[180:183], v227 offset:18432
    v_mfma_f32_16x16x32_bf16 v[104:107], v[160:163], a[68:71], v[104:107]
    ds_read_b128 v[184:187], v227 offset:20480
    v_mfma_f32_16x16x32_bf16 v[108:111], v[164:167], a[68:71], v[108:111]
    ds_read_b128 v[188:191], v227 offset:22528
    v_mfma_f32_16x16x32_bf16 v[112:115], v[160:163], a[72:75], v[112:115]
    v_mfma_f32_16x16x32_bf16 v[116:119], v[164:167], a[72:75], v[116:119]
    v_mfma_f32_16x16x32_bf16 v[120:123], v[160:163], a[76:79], v[120:123]
    v_mfma_f32_16x16x32_bf16 v[124:127], v[164:167], a[76:79], v[124:127]
    v_mfma_f32_16x16x32_bf16 v[128:131], v[168:171], a[64:67], v[128:131]
    v_mfma_f32_16x16x32_bf16 v[132:135], v[172:175], a[64:67], v[132:135]
    v_mfma_f32_16x16x32_bf16 v[136:139], v[168:171], a[68:71], v[136:139]
    v_mfma_f32_16x16x32_bf16 v[140:143], v[172:175], a[68:71], v[140:143]
    v_mfma_f32_16x16x32_bf16 v[144:147], v[168:171], a[72:75], v[144:147]
    v_mfma_f32_16x16x32_bf16 v[148:151], v[172:175], a[72:75], v[148:151]
    v_mfma_f32_16x16x32_bf16 v[152:155], v[168:171], a[76:79], v[152:155]
    s_add_u32 s38, s36, 32768
    buffer_store_dwordx4 v[76:79], v240, s[16:19], s38 offen offset:3072 sc1
    v_mfma_f32_16x16x32_bf16 v[156:159], v[172:175], a[76:79], v[156:159]
    s_waitcnt lgkmcnt(0)
    v_mfma_f32_16x16x32_bf16 v[96:99], v[176:179], a[80:83], v[96:99]
    ds_read_b128 v[160:163], v226 offset:24576
    v_mfma_f32_16x16x32_bf16 v[100:103], v[180:183], a[80:83], v[100:103]
    ds_read_b128 v[164:167], v226 offset:26624
    v_mfma_f32_16x16x32_bf16 v[104:107], v[176:179], a[84:87], v[104:107]
    ds_read_b128 v[168:171], v226 offset:28672
    v_mfma_f32_16x16x32_bf16 v[108:111], v[180:183], a[84:87], v[108:111]
    ds_read_b128 v[172:175], v226 offset:30720
    v_mfma_f32_16x16x32_bf16 v[112:115], v[176:179], a[88:91], v[112:115]
    v_mfma_f32_16x16x32_bf16 v[116:119], v[180:183], a[88:91], v[116:119]
    v_mfma_f32_16x16x32_bf16 v[120:123], v[176:179], a[92:95], v[120:123]
    v_mfma_f32_16x16x32_bf16 v[124:127], v[180:183], a[92:95], v[124:127]
    v_mfma_f32_16x16x32_bf16 v[128:131], v[184:187], a[80:83], v[128:131]
    v_mfma_f32_16x16x32_bf16 v[132:135], v[188:191], a[80:83], v[132:135]
    v_mfma_f32_16x16x32_bf16 v[136:139], v[184:187], a[84:87], v[136:139]
    v_mfma_f32_16x16x32_bf16 v[140:143], v[188:191], a[84:87], v[140:143]
    v_mfma_f32_16x16x32_bf16 v[144:147], v[184:187], a[88:91], v[144:147]
    v_mfma_f32_16x16x32_bf16 v[148:151], v[188:191], a[88:91], v[148:151]
    v_mfma_f32_16x16x32_bf16 v[152:155], v[184:187], a[92:95], v[152:155]
    s_add_u32 s38, s36, 40960
    buffer_store_dwordx4 v[80:83], v240, s[16:19], s38 offen offset:0 sc1
    v_mfma_f32_16x16x32_bf16 v[156:159], v[188:191], a[92:95], v[156:159]
    s_waitcnt lgkmcnt(0)
    v_mfma_f32_16x16x32_bf16 v[96:99], v[160:163], a[96:99], v[96:99]
    ds_read_b128 v[176:179], v227 offset:24576
    v_mfma_f32_16x16x32_bf16 v[100:103], v[164:167], a[96:99], v[100:103]
    ds_read_b128 v[180:183], v227 offset:26624
    v_mfma_f32_16x16x32_bf16 v[104:107], v[160:163], a[100:103], v[104:107]
    ds_read_b128 v[184:187], v227 offset:28672
    v_mfma_f32_16x16x32_bf16 v[108:111], v[164:167], a[100:103], v[108:111]
    ds_read_b128 v[188:191], v227 offset:30720
    v_mfma_f32_16x16x32_bf16 v[112:115], v[160:163], a[104:107], v[112:115]
    v_mfma_f32_16x16x32_bf16 v[116:119], v[164:167], a[104:107], v[116:119]
    v_mfma_f32_16x16x32_bf16 v[120:123], v[160:163], a[108:111], v[120:123]
    v_mfma_f32_16x16x32_bf16 v[124:127], v[164:167], a[108:111], v[124:127]
    v_mfma_f32_16x16x32_bf16 v[128:131], v[168:171], a[96:99], v[128:131]
    v_mfma_f32_16x16x32_bf16 v[132:135], v[172:175], a[96:99], v[132:135]
    v_mfma_f32_16x16x32_bf16 v[136:139], v[168:171], a[100:103], v[136:139]
    v_mfma_f32_16x16x32_bf16 v[140:143], v[172:175], a[100:103], v[140:143]
    v_mfma_f32_16x16x32_bf16 v[144:147], v[168:171], a[104:107], v[144:147]
    v_mfma_f32_16x16x32_bf16 v[148:151], v[172:175], a[104:107], v[148:151]
    v_mfma_f32_16x16x32_bf16 v[152:155], v[168:171], a[108:111], v[152:155]
    s_add_u32 s38, s36, 40960
    buffer_store_dwordx4 v[84:87], v240, s[16:19], s38 offen offset:1024 sc1
    v_mfma_f32_16x16x32_bf16 v[156:159], v[172:175], a[108:111], v[156:159]
    s_waitcnt vmcnt(6) lgkmcnt(0)
    s_barrier
    v_mfma_f32_16x16x32_bf16 v[96:99], v[176:179], a[112:115], v[96:99]
    ds_read_b128 v[160:163], v226 offset:32768
    v_mfma_f32_16x16x32_bf16 v[100:103], v[180:183], a[112:115], v[100:103]
    ds_read_b128 v[164:167], v226 offset:34816
    v_mfma_f32_16x16x32_bf16 v[104:107], v[176:179], a[116:119], v[104:107]
    ds_read_b128 v[168:171], v226 offset:36864
    v_mfma_f32_16x16x32_bf16 v[108:111], v[180:183], a[116:119], v[108:111]
    ds_read_b128 v[172:175], v226 offset:38912
    v_mfma_f32_16x16x32_bf16 v[112:115], v[176:179], a[120:123], v[112:115]
    v_mfma_f32_16x16x32_bf16 v[116:119], v[180:183], a[120:123], v[116:119]
    s_lshl_b32 s39, s5, 2
    buffer_atomic_add v255, v250, s[88:91], s39 offen sc1
    s_cmp_eq_u32 s3, 0
    s_cselect_b32 s39, s39, s43
    v_mfma_f32_16x16x32_bf16 v[120:123], v[176:179], a[124:127], v[120:123]
    v_mfma_f32_16x16x32_bf16 v[124:127], v[180:183], a[124:127], v[124:127]
    v_mfma_f32_16x16x32_bf16 v[128:131], v[184:187], a[112:115], v[128:131]
    v_mfma_f32_16x16x32_bf16 v[132:135], v[188:191], a[112:115], v[132:135]
    v_mfma_f32_16x16x32_bf16 v[136:139], v[184:187], a[116:119], v[136:139]
    v_mfma_f32_16x16x32_bf16 v[140:143], v[188:191], a[116:119], v[140:143]
    v_mfma_f32_16x16x32_bf16 v[144:147], v[184:187], a[120:123], v[144:147]
    v_mfma_f32_16x16x32_bf16 v[148:151], v[188:191], a[120:123], v[148:151]
    v_mfma_f32_16x16x32_bf16 v[152:155], v[184:187], a[124:127], v[152:155]
    v_mfma_f32_16x16x32_bf16 v[156:159], v[188:191], a[124:127], v[156:159]
    s_waitcnt lgkmcnt(0)
    v_mfma_f32_16x16x32_bf16 v[96:99], v[160:163], a[128:131], v[96:99]
    ds_read_b128 v[176:179], v227 offset:32768
    v_mfma_f32_16x16x32_bf16 v[100:103], v[164:167], a[128:131], v[100:103]
    ds_read_b128 v[180:183], v227 offset:34816
    v_mfma_f32_16x16x32_bf16 v[104:107], v[160:163], a[132:135], v[104:107]
    ds_read_b128 v[184:187], v227 offset:36864
    v_mfma_f32_16x16x32_bf16 v[108:111], v[164:167], a[132:135], v[108:111]
    ds_read_b128 v[188:191], v227 offset:38912
    v_mfma_f32_16x16x32_bf16 v[112:115], v[160:163], a[136:139], v[112:115]
    v_mfma_f32_16x16x32_bf16 v[116:119], v[164:167], a[136:139], v[116:119]
    v_mfma_f32_16x16x32_bf16 v[120:123], v[160:163], a[140:143], v[120:123]
    v_mfma_f32_16x16x32_bf16 v[124:127], v[164:167], a[140:143], v[124:127]
    v_mfma_f32_16x16x32_bf16 v[128:131], v[168:171], a[128:131], v[128:131]
    v_mfma_f32_16x16x32_bf16 v[132:135], v[172:175], a[128:131], v[132:135]
    v_mfma_f32_16x16x32_bf16 v[136:139], v[168:171], a[132:135], v[136:139]
    v_mfma_f32_16x16x32_bf16 v[140:143], v[172:175], a[132:135], v[140:143]
    v_mfma_f32_16x16x32_bf16 v[144:147], v[168:171], a[136:139], v[144:147]
    v_mfma_f32_16x16x32_bf16 v[148:151], v[172:175], a[136:139], v[148:151]
    v_mfma_f32_16x16x32_bf16 v[152:155], v[168:171], a[140:143], v[152:155]
    s_add_u32 s38, s36, 40960
    buffer_store_dwordx4 v[88:91], v240, s[16:19], s38 offen offset:2048 sc1
    v_mfma_f32_16x16x32_bf16 v[156:159], v[172:175], a[140:143], v[156:159]
    s_waitcnt lgkmcnt(0)
    v_mfma_f32_16x16x32_bf16 v[96:99], v[176:179], a[144:147], v[96:99]
    ds_read_b128 v[160:163], v226 offset:40960
    v_mfma_f32_16x16x32_bf16 v[100:103], v[180:183], a[144:147], v[100:103]
    ds_read_b128 v[164:167], v226 offset:43008
    v_mfma_f32_16x16x32_bf16 v[104:107], v[176:179], a[148:151], v[104:107]
    ds_read_b128 v[168:171], v226 offset:45056
    v_mfma_f32_16x16x32_bf16 v[108:111], v[180:183], a[148:151], v[108:111]
    ds_read_b128 v[172:175], v226 offset:47104
    v_mfma_f32_16x16x32_bf16 v[112:115], v[176:179], a[152:155], v[112:115]
    v_mfma_f32_16x16x32_bf16 v[116:119], v[180:183], a[152:155], v[116:119]
    s_add_u32 m0, s31, 0
    s_add_u32 s24, s27, 0
    buffer_load_dwordx4 v245, s[12:15], s24 offen lds
    v_mfma_f32_16x16x32_bf16 v[120:123], v[176:179], a[156:159], v[120:123]
    v_mfma_f32_16x16x32_bf16 v[124:127], v[180:183], a[156:159], v[124:127]
    s_add_u32 m0, s31, 1024
    s_add_u32 s24, s27, 32768
    buffer_load_dwordx4 v245, s[12:15], s24 offen lds
    v_mfma_f32_16x16x32_bf16 v[128:131], v[184:187], a[144:147], v[128:131]
    v_mfma_f32_16x16x32_bf16 v[132:135], v[188:191], a[144:147], v[132:135]
    s_add_u32 m0, s31, 2048
    s_add_u32 s24, s27, 65536
    buffer_load_dwordx4 v245, s[12:15], s24 offen lds
    v_mfma_f32_16x16x32_bf16 v[136:139], v[184:187], a[148:151], v[136:139]
    v_mfma_f32_16x16x32_bf16 v[140:143], v[188:191], a[148:151], v[140:143]
    s_add_u32 m0, s31, 3072
    s_add_u32 s24, s27, 98304
    buffer_load_dwordx4 v245, s[12:15], s24 offen lds
    v_mfma_f32_16x16x32_bf16 v[144:147], v[184:187], a[152:155], v[144:147]
    v_mfma_f32_16x16x32_bf16 v[148:151], v[188:191], a[152:155], v[148:151]
    s_add_u32 m0, s31, 4096
    s_add_u32 s24, s27, 131072
    buffer_load_dwordx4 v245, s[12:15], s24 offen lds
    v_mfma_f32_16x16x32_bf16 v[152:155], v[184:187], a[156:159], v[152:155]
    v_mfma_f32_16x16x32_bf16 v[156:159], v[188:191], a[156:159], v[156:159]
    s_waitcnt lgkmcnt(0)
    v_mfma_f32_16x16x32_bf16 v[96:99], v[160:163], a[160:163], v[96:99]
    ds_read_b128 v[176:179], v227 offset:40960
    v_mfma_f32_16x16x32_bf16 v[100:103], v[164:167], a[160:163], v[100:103]
    ds_read_b128 v[180:183], v227 offset:43008
    v_mfma_f32_16x16x32_bf16 v[104:107], v[160:163], a[164:167], v[104:107]
    ds_read_b128 v[184:187], v227 offset:45056
    v_mfma_f32_16x16x32_bf16 v[108:111], v[164:167], a[164:167], v[108:111]
    ds_read_b128 v[188:191], v227 offset:47104
    v_mfma_f32_16x16x32_bf16 v[112:115], v[160:163], a[168:171], v[112:115]
    v_mfma_f32_16x16x32_bf16 v[116:119], v[164:167], a[168:171], v[116:119]
    v_mfma_f32_16x16x32_bf16 v[120:123], v[160:163], a[172:175], v[120:123]
    v_mfma_f32_16x16x32_bf16 v[124:127], v[164:167], a[172:175], v[124:127]
    v_mfma_f32_16x16x32_bf16 v[128:131], v[168:171], a[160:163], v[128:131]
    v_mfma_f32_16x16x32_bf16 v[132:135], v[172:175], a[160:163], v[132:135]
    v_mfma_f32_16x16x32_bf16 v[136:139], v[168:171], a[164:167], v[136:139]
    v_mfma_f32_16x16x32_bf16 v[140:143], v[172:175], a[164:167], v[140:143]
    v_mfma_f32_16x16x32_bf16 v[144:147], v[168:171], a[168:171], v[144:147]
    v_mfma_f32_16x16x32_bf16 v[148:151], v[172:175], a[168:171], v[148:151]
    v_mfma_f32_16x16x32_bf16 v[152:155], v[168:171], a[172:175], v[152:155]
    s_add_u32 s38, s36, 40960
    buffer_store_dwordx4 v[92:95], v240, s[16:19], s38 offen offset:3072 sc1
    v_mfma_f32_16x16x32_bf16 v[156:159], v[172:175], a[172:175], v[156:159]
    s_waitcnt lgkmcnt(0)
    v_mfma_f32_16x16x32_bf16 v[96:99], v[176:179], a[176:179], v[96:99]
    ds_read_b128 v[160:163], v226 offset:49152
    v_mfma_f32_16x16x32_bf16 v[100:103], v[180:183], a[176:179], v[100:103]
    ds_read_b128 v[164:167], v226 offset:51200
    v_mfma_f32_16x16x32_bf16 v[104:107], v[176:179], a[180:183], v[104:107]
    ds_read_b128 v[168:171], v226 offset:53248
    v_mfma_f32_16x16x32_bf16 v[108:111], v[180:183], a[180:183], v[108:111]
    ds_read_b128 v[172:175], v226 offset:55296
    v_mfma_f32_16x16x32_bf16 v[112:115], v[176:179], a[184:187], v[112:115]
    v_mfma_f32_16x16x32_bf16 v[116:119], v[180:183], a[184:187], v[116:119]
    s_add_u32 m0, s31, 5120
    s_add_u32 s24, s27, 163840
    buffer_load_dwordx4 v245, s[12:15], s24 offen lds
    v_mfma_f32_16x16x32_bf16 v[120:123], v[176:179], a[188:191], v[120:123]
    v_mfma_f32_16x16x32_bf16 v[124:127], v[180:183], a[188:191], v[124:127]
    s_add_u32 m0, s31, 6144
    s_add_u32 s24, s27, 196608
    buffer_load_dwordx4 v245, s[12:15], s24 offen lds
    v_mfma_f32_16x16x32_bf16 v[128:131], v[184:187], a[176:179], v[128:131]
    v_mfma_f32_16x16x32_bf16 v[132:135], v[188:191], a[176:179], v[132:135]
    s_add_u32 m0, s31, 7168
    s_add_u32 s24, s27, 229376
    buffer_load_dwordx4 v245, s[12:15], s24 offen lds
    v_mfma_f32_16x16x32_bf16 v[136:139], v[184:187], a[180:183], v[136:139]
    v_mfma_f32_16x16x32_bf16 v[140:143], v[188:191], a[180:183], v[140:143]
    s_add_u32 s27, s27, 1048576
    s_and_b32 s27, s27, 0x407fffff
    s_cmp_eq_u32 s27, s7
    s_cselect_b32 s27, s43, s27
    v_mfma_f32_16x16x32_bf16 v[144:147], v[184:187], a[184:187], v[144:147]
    v_mfma_f32_16x16x32_bf16 v[148:151], v[188:191], a[184:187], v[148:151]
    s_add_u32 s31, s31, 32768
    s_cmp_ge_u32 s31, 163840
    s_cselect_b32 s24, 98304, 0
    s_sub_u32 s31, s31, s24
    v_mfma_f32_16x16x32_bf16 v[152:155], v[184:187], a[188:191], v[152:155]
    v_mfma_f32_16x16x32_bf16 v[156:159], v[188:191], a[188:191], v[156:159]
    s_waitcnt lgkmcnt(0)
    v_mfma_f32_16x16x32_bf16 v[96:99], v[160:163], a[192:195], v[96:99]
    ds_read_b128 v[176:179], v227 offset:49152
    v_mfma_f32_16x16x32_bf16 v[100:103], v[164:167], a[192:195], v[100:103]
    ds_read_b128 v[180:183], v227 offset:51200
    v_mfma_f32_16x16x32_bf16 v[104:107], v[160:163], a[196:199], v[104:107]
    ds_read_b128 v[184:187], v227 offset:53248
    v_mfma_f32_16x16x32_bf16 v[108:111], v[164:167], a[196:199], v[108:111]
    ds_read_b128 v[188:191], v227 offset:55296
    v_mfma_f32_16x16x32_bf16 v[112:115], v[160:163], a[200:203], v[112:115]
    s_mul_i32 s38, s2, 100
    v_mfma_f32_16x16x32_bf16 v[116:119], v[164:167], a[200:203], v[116:119]
    v_mfma_f32_16x16x32_bf16 v[120:123], v[160:163], a[204:207], v[120:123]
    v_lshl_add_u32 v60, v253, 2, s38
    v_mfma_f32_16x16x32_bf16 v[124:127], v[164:167], a[204:207], v[124:127]
    v_cmp_gt_u32 vcc, 25, v253
    v_mfma_f32_16x16x32_bf16 v[128:131], v[168:171], a[192:195], v[128:131]
    v_mov_b32 v61, 0
    v_mfma_f32_16x16x32_bf16 v[132:135], v[172:175], a[192:195], v[132:135]
    v_mfma_f32_16x16x32_bf16 v[136:139], v[168:171], a[196:199], v[136:139]
    v_mov_b32 v62, 0x7ffffff0
    v_mfma_f32_16x16x32_bf16 v[140:143], v[172:175], a[196:199], v[140:143]
    v_cndmask_b32 v60, v62, v60, vcc
    v_mfma_f32_16x16x32_bf16 v[144:147], v[168:171], a[200:203], v[144:147]
    v_mfma_f32_16x16x32_bf16 v[148:151], v[172:175], a[200:203], v[148:151]
    buffer_store_dword v61, v60, s[56:59], 0 offen
    v_mfma_f32_16x16x32_bf16 v[152:155], v[168:171], a[204:207], v[152:155]
    v_mfma_f32_16x16x32_bf16 v[156:159], v[172:175], a[204:207], v[156:159]
    s_waitcnt lgkmcnt(0)
    v_mfma_f32_16x16x32_bf16 v[96:99], v[176:179], a[208:211], v[96:99]
    ds_read_b128 v[160:163], v226 offset:57344
    v_mfma_f32_16x16x32_bf16 v[100:103], v[180:183], a[208:211], v[100:103]
    ds_read_b128 v[164:167], v226 offset:59392
    v_mfma_f32_16x16x32_bf16 v[104:107], v[176:179], a[212:215], v[104:107]
    ds_read_b128 v[168:171], v226 offset:61440
    v_mfma_f32_16x16x32_bf16 v[108:111], v[180:183], a[212:215], v[108:111]
    ds_read_b128 v[172:175], v226 offset:63488
    v_mfma_f32_16x16x32_bf16 v[112:115], v[176:179], a[216:219], v[112:115]
    v_mfma_f32_16x16x32_bf16 v[116:119], v[180:183], a[216:219], v[116:119]
    v_mfma_f32_16x16x32_bf16 v[120:123], v[176:179], a[220:223], v[120:123]
    v_mfma_f32_16x16x32_bf16 v[124:127], v[180:183], a[220:223], v[124:127]
    v_mfma_f32_16x16x32_bf16 v[128:131], v[184:187], a[208:211], v[128:131]
    v_mfma_f32_16x16x32_bf16 v[132:135], v[188:191], a[208:211], v[132:135]
    v_mfma_f32_16x16x32_bf16 v[136:139], v[184:187], a[212:215], v[136:139]
    v_mfma_f32_16x16x32_bf16 v[140:143], v[188:191], a[212:215], v[140:143]
    v_mfma_f32_16x16x32_bf16 v[144:147], v[184:187], a[216:219], v[144:147]
    v_mfma_f32_16x16x32_bf16 v[148:151], v[188:191], a[216:219], v[148:151]
    v_mfma_f32_16x16x32_bf16 v[152:155], v[184:187], a[220:223], v[152:155]
    v_mfma_f32_16x16x32_bf16 v[156:159], v[188:191], a[220:223], v[156:159]
    s_waitcnt lgkmcnt(0)
    v_mfma_f32_16x16x32_bf16 v[96:99], v[160:163], a[224:227], v[96:99]
    ds_read_b128 v[176:179], v227 offset:57344
    v_mfma_f32_16x16x32_bf16 v[100:103], v[164:167], a[224:227], v[100:103]
    ds_read_b128 v[180:183], v227 offset:59392
    v_mfma_f32_16x16x32_bf16 v[104:107], v[160:163], a[228:231], v[104:107]
    ds_read_b128 v[184:187], v227 offset:61440
    v_mfma_f32_16x16x32_bf16 v[108:111], v[164:167], a[228:231], v[108:111]
    ds_read_b128 v[188:191], v227 offset:63488
    v_mfma_f32_16x16x32_bf16 v[112:115], v[160:163], a[232:235], v[112:115]
    v_mfma_f32_16x16x32_bf16 v[116:119], v[164:167], a[232:235], v[116:119]
    v_mfma_f32_16x16x32_bf16 v[120:123], v[160:163], a[236:239], v[120:123]
    v_mfma_f32_16x16x32_bf16 v[124:127], v[164:167], a[236:239], v[124:127]
    v_mfma_f32_16x16x32_bf16 v[128:131], v[168:171], a[224:227], v[128:131]
    v_mfma_f32_16x16x32_bf16 v[132:135], v[172:175], a[224:227], v[132:135]
    v_mfma_f32_16x16x32_bf16 v[136:139], v[168:171], a[228:231], v[136:139]
    v_mfma_f32_16x16x32_bf16 v[140:143], v[172:175], a[228:231], v[140:143]
    v_mfma_f32_16x16x32_bf16 v[144:147], v[168:171], a[232:235], v[144:147]
    v_mfma_f32_16x16x32_bf16 v[148:151], v[172:175], a[232:235], v[148:151]
    v_mfma_f32_16x16x32_bf16 v[152:155], v[168:171], a[236:239], v[152:155]
    v_mfma_f32_16x16x32_bf16 v[156:159], v[172:175], a[236:239], v[156:159]
    s_waitcnt vmcnt(22) lgkmcnt(0)
    s_barrier
    v_mfma_f32_16x16x32_bf16 v[96:99], v[176:179], a[240:243], v[96:99]
    ds_read_b128 v[160:163], v224 offset:0
    v_mfma_f32_16x16x32_bf16 v[100:103], v[180:183], a[240:243], v[100:103]
    ds_read_b128 v[164:167], v224 offset:2048
    v_mfma_f32_16x16x32_bf16 v[104:107], v[176:179], a[244:247], v[104:107]
    ds_read_b128 v[168:171], v224 offset:4096
    v_mfma_f32_16x16x32_bf16 v[108:111], v[180:183], a[244:247], v[108:111]
    ds_read_b128 v[172:175], v224 offset:6144
    v_mfma_f32_16x16x32_bf16 v[112:115], v[176:179], a[248:251], v[112:115]
    v_mfma_f32_16x16x32_bf16 v[116:119], v[180:183], a[248:251], v[116:119]
    v_mfma_f32_16x16x32_bf16 v[120:123], v[176:179], a[252:255], v[120:123]
    v_mfma_f32_16x16x32_bf16 v[124:127], v[180:183], a[252:255], v[124:127]
    v_mfma_f32_16x16x32_bf16 v[128:131], v[184:187], a[240:243], v[128:131]
    v_mfma_f32_16x16x32_bf16 v[132:135], v[188:191], a[240:243], v[132:135]
    v_cvt_pk_bf16_f32 v64, v96, v97
    v_cvt_pk_bf16_f32 v65, v98, v99
    v_mfma_f32_16x16x32_bf16 v[136:139], v[184:187], a[244:247], v[136:139]
    v_cvt_pk_bf16_f32 v66, v100, v101
    v_cvt_pk_bf16_f32 v67, v102, v103
    v_mfma_f32_16x16x32_bf16 v[140:143], v[188:191], a[244:247], v[140:143]
    v_cvt_pk_bf16_f32 v68, v104, v105
    v_cvt_pk_bf16_f32 v69, v106, v107
    v_mfma_f32_16x16x32_bf16 v[144:147], v[184:187], a[248:251], v[144:147]
    v_cvt_pk_bf16_f32 v70, v108, v109
    v_cvt_pk_bf16_f32 v71, v110, v111
    v_mfma_f32_16x16x32_bf16 v[148:151], v[188:191], a[248:251], v[148:151]
    v_cvt_pk_bf16_f32 v72, v112, v113
    v_cvt_pk_bf16_f32 v73, v114, v115
    v_mfma_f32_16x16x32_bf16 v[152:155], v[184:187], a[252:255], v[152:155]
    v_cvt_pk_bf16_f32 v74, v116, v117
    v_cvt_pk_bf16_f32 v75, v118, v119
    v_mfma_f32_16x16x32_bf16 v[156:159], v[188:191], a[252:255], v[156:159]
    v_cvt_pk_bf16_f32 v76, v120, v121
    v_cvt_pk_bf16_f32 v77, v122, v123
    s_waitcnt lgkmcnt(0)
    v_mfma_f32_16x16x32_bf16 v[96:99], v[160:163], a[0:3], 0
    ds_read_b128 v[176:179], v225 offset:0
    v_cvt_pk_bf16_f32 v78, v124, v125
    v_cvt_pk_bf16_f32 v79, v126, v127
    v_mfma_f32_16x16x32_bf16 v[100:103], v[164:167], a[0:3], 0
    ds_read_b128 v[180:183], v225 offset:2048
    v_cvt_pk_bf16_f32 v80, v128, v129
    v_cvt_pk_bf16_f32 v81, v130, v131
    v_mfma_f32_16x16x32_bf16 v[104:107], v[160:163], a[4:7], 0
    ds_read_b128 v[184:187], v225 offset:4096
    v_cvt_pk_bf16_f32 v82, v132, v133
    v_cvt_pk_bf16_f32 v83, v134, v135
    v_mfma_f32_16x16x32_bf16 v[108:111], v[164:167], a[4:7], 0
    ds_read_b128 v[188:191], v225 offset:6144
    v_cvt_pk_bf16_f32 v84, v136, v137
    v_cvt_pk_bf16_f32 v85, v138, v139
    v_mfma_f32_16x16x32_bf16 v[112:115], v[160:163], a[8:11], 0
    v_cvt_pk_bf16_f32 v86, v140, v141
    v_cvt_pk_bf16_f32 v87, v142, v143
    v_mfma_f32_16x16x32_bf16 v[116:119], v[164:167], a[8:11], 0
    v_cvt_pk_bf16_f32 v88, v144, v145
    v_cvt_pk_bf16_f32 v89, v146, v147
    v_mfma_f32_16x16x32_bf16 v[120:123], v[160:163], a[12:15], 0
    v_cvt_pk_bf16_f32 v90, v148, v149
    v_cvt_pk_bf16_f32 v91, v150, v151
    v_mfma_f32_16x16x32_bf16 v[124:127], v[164:167], a[12:15], 0
    v_cvt_pk_bf16_f32 v92, v152, v153
    v_cvt_pk_bf16_f32 v93, v154, v155
    v_mfma_f32_16x16x32_bf16 v[128:131], v[168:171], a[0:3], 0
    v_cvt_pk_bf16_f32 v94, v156, v157
    v_cvt_pk_bf16_f32 v95, v158, v159
    v_mfma_f32_16x16x32_bf16 v[132:135], v[172:175], a[0:3], 0
    v_mfma_f32_16x16x32_bf16 v[136:139], v[168:171], a[4:7], 0
    v_mfma_f32_16x16x32_bf16 v[140:143], v[172:175], a[4:7], 0
    s_add_u32 s38, s36, 65536
    buffer_store_dwordx4 v[64:67], v240, s[16:19], s38 offen offset:0 sc1
    v_mfma_f32_16x16x32_bf16 v[144:147], v[168:171], a[8:11], 0
    v_mfma_f32_16x16x32_bf16 v[148:151], v[172:175], a[8:11], 0
    v_mfma_f32_16x16x32_bf16 v[152:155], v[168:171], a[12:15], 0
    s_add_u32 s38, s36, 65536
    buffer_store_dwordx4 v[68:71], v240, s[16:19], s38 offen offset:1024 sc1
    v_mfma_f32_16x16x32_bf16 v[156:159], v[172:175], a[12:15], 0
    s_waitcnt lgkmcnt(0)
    v_mfma_f32_16x16x32_bf16 v[96:99], v[176:179], a[16:19], v[96:99]
    ds_read_b128 v[160:163], v224 offset:8192
    v_mfma_f32_16x16x32_bf16 v[100:103], v[180:183], a[16:19], v[100:103]
    ds_read_b128 v[164:167], v224 offset:10240
    v_mfma_f32_16x16x32_bf16 v[104:107], v[176:179], a[20:23], v[104:107]
    ds_read_b128 v[168:171], v224 offset:12288
    v_mfma_f32_16x16x32_bf16 v[108:111], v[180:183], a[20:23], v[108:111]
    ds_read_b128 v[172:175], v224 offset:14336
    v_mfma_f32_16x16x32_bf16 v[112:115], v[176:179], a[24:27], v[112:115]
    v_mfma_f32_16x16x32_bf16 v[116:119], v[180:183], a[24:27], v[116:119]
    v_mfma_f32_16x16x32_bf16 v[120:123], v[176:179], a[28:31], v[120:123]
    v_mfma_f32_16x16x32_bf16 v[124:127], v[180:183], a[28:31], v[124:127]
    v_mfma_f32_16x16x32_bf16 v[128:131], v[184:187], a[16:19], v[128:131]
    v_mfma_f32_16x16x32_bf16 v[132:135], v[188:191], a[16:19], v[132:135]
    v_mfma_f32_16x16x32_bf16 v[136:139], v[184:187], a[20:23], v[136:139]
    v_mfma_f32_16x16x32_bf16 v[140:143], v[188:191], a[20:23], v[140:143]
    s_add_u32 s38, s36, 65536
    buffer_store_dwordx4 v[72:75], v240, s[16:19], s38 offen offset:2048 sc1
    v_mfma_f32_16x16x32_bf16 v[144:147], v[184:187], a[24:27], v[144:147]
    v_mfma_f32_16x16x32_bf16 v[148:151], v[188:191], a[24:27], v[148:151]
    v_mfma_f32_16x16x32_bf16 v[152:155], v[184:187], a[28:31], v[152:155]
    s_add_u32 s38, s36, 65536
    buffer_store_dwordx4 v[76:79], v240, s[16:19], s38 offen offset:3072 sc1
    v_mfma_f32_16x16x32_bf16 v[156:159], v[188:191], a[28:31], v[156:159]
    s_waitcnt lgkmcnt(0)
    v_mfma_f32_16x16x32_bf16 v[96:99], v[160:163], a[32:35], v[96:99]
    ds_read_b128 v[176:179], v225 offset:8192
    v_mfma_f32_16x16x32_bf16 v[100:103], v[164:167], a[32:35], v[100:103]
    ds_read_b128 v[180:183], v225 offset:10240
    v_mfma_f32_16x16x32_bf16 v[104:107], v[160:163], a[36:39], v[104:107]
    ds_read_b128 v[184:187], v225 offset:12288
    v_mfma_f32_16x16x32_bf16 v[108:111], v[164:167], a[36:39], v[108:111]
    ds_read_b128 v[188:191], v225 offset:14336
    v_mfma_f32_16x16x32_bf16 v[112:115], v[160:163], a[40:43], v[112:115]
    v_mfma_f32_16x16x32_bf16 v[116:119], v[164:167], a[40:43], v[116:119]
    v_mfma_f32_16x16x32_bf16 v[120:123], v[160:163], a[44:47], v[120:123]
    v_mfma_f32_16x16x32_bf16 v[124:127], v[164:167], a[44:47], v[124:127]
    v_mfma_f32_16x16x32_bf16 v[128:131], v[168:171], a[32:35], v[128:131]
    v_mfma_f32_16x16x32_bf16 v[132:135], v[172:175], a[32:35], v[132:135]
    v_mfma_f32_16x16x32_bf16 v[136:139], v[168:171], a[36:39], v[136:139]
    v_mfma_f32_16x16x32_bf16 v[140:143], v[172:175], a[36:39], v[140:143]
    s_add_u32 s38, s36, 73728
    buffer_store_dwordx4 v[80:83], v240, s[16:19], s38 offen offset:0 sc1
    v_mfma_f32_16x16x32_bf16 v[144:147], v[168:171], a[40:43], v[144:147]
    v_mfma_f32_16x16x32_bf16 v[148:151], v[172:175], a[40:43], v[148:151]
    v_mfma_f32_16x16x32_bf16 v[152:155], v[168:171], a[44:47], v[152:155]
    s_add_u32 s38, s36, 73728
    buffer_store_dwordx4 v[84:87], v240, s[16:19], s38 offen offset:1024 sc1
    v_mfma_f32_16x16x32_bf16 v[156:159], v[172:175], a[44:47], v[156:159]
    s_waitcnt lgkmcnt(0)
    v_mfma_f32_16x16x32_bf16 v[96:99], v[176:179], a[48:51], v[96:99]
    ds_read_b128 v[160:163], v224 offset:16384
    v_mfma_f32_16x16x32_bf16 v[100:103], v[180:183], a[48:51], v[100:103]
    ds_read_b128 v[164:167], v224 offset:18432
    v_mfma_f32_16x16x32_bf16 v[104:107], v[176:179], a[52:55], v[104:107]
    ds_read_b128 v[168:171], v224 offset:20480
    v_mfma_f32_16x16x32_bf16 v[108:111], v[180:183], a[52:55], v[108:111]
    ds_read_b128 v[172:175], v224 offset:22528
    v_mfma_f32_16x16x32_bf16 v[112:115], v[176:179], a[56:59], v[112:115]
    v_mfma_f32_16x16x32_bf16 v[116:119], v[180:183], a[56:59], v[116:119]
    v_mfma_f32_16x16x32_bf16 v[120:123], v[176:179], a[60:63], v[120:123]
    v_mfma_f32_16x16x32_bf16 v[124:127], v[180:183], a[60:63], v[124:127]
    v_mfma_f32_16x16x32_bf16 v[128:131], v[184:187], a[48:51], v[128:131]
    v_mfma_f32_16x16x32_bf16 v[132:135], v[188:191], a[48:51], v[132:135]
    v_mfma_f32_16x16x32_bf16 v[136:139], v[184:187], a[52:55], v[136:139]
    v_mfma_f32_16x16x32_bf16 v[140:143], v[188:191], a[52:55], v[140:143]
    s_add_u32 s38, s36, 73728
    buffer_store_dwordx4 v[88:91], v240, s[16:19], s38 offen offset:2048 sc1
    v_mfma_f32_16x16x32_bf16 v[144:147], v[184:187], a[56:59], v[144:147]
    v_mfma_f32_16x16x32_bf16 v[148:151], v[188:191], a[56:59], v[148:151]
    v_mfma_f32_16x16x32_bf16 v[152:155], v[184:187], a[60:63], v[152:155]
    s_add_u32 s38, s36, 73728
    buffer_store_dwordx4 v[92:95], v240, s[16:19], s38 offen offset:3072 sc1
    v_mfma_f32_16x16x32_bf16 v[156:159], v[188:191], a[60:63], v[156:159]
    s_waitcnt lgkmcnt(0)
    v_mfma_f32_16x16x32_bf16 v[96:99], v[160:163], a[64:67], v[96:99]
    ds_read_b128 v[176:179], v225 offset:16384
    v_mfma_f32_16x16x32_bf16 v[100:103], v[164:167], a[64:67], v[100:103]
    ds_read_b128 v[180:183], v225 offset:18432
    v_mfma_f32_16x16x32_bf16 v[104:107], v[160:163], a[68:71], v[104:107]
    ds_read_b128 v[184:187], v225 offset:20480
    v_mfma_f32_16x16x32_bf16 v[108:111], v[164:167], a[68:71], v[108:111]
    ds_read_b128 v[188:191], v225 offset:22528
    v_mfma_f32_16x16x32_bf16 v[112:115], v[160:163], a[72:75], v[112:115]
    v_mfma_f32_16x16x32_bf16 v[116:119], v[164:167], a[72:75], v[116:119]
    v_mfma_f32_16x16x32_bf16 v[120:123], v[160:163], a[76:79], v[120:123]
    v_mfma_f32_16x16x32_bf16 v[124:127], v[164:167], a[76:79], v[124:127]
    v_mfma_f32_16x16x32_bf16 v[128:131], v[168:171], a[64:67], v[128:131]
    v_mfma_f32_16x16x32_bf16 v[132:135], v[172:175], a[64:67], v[132:135]
    v_mfma_f32_16x16x32_bf16 v[136:139], v[168:171], a[68:71], v[136:139]
    v_mfma_f32_16x16x32_bf16 v[140:143], v[172:175], a[68:71], v[140:143]
    v_mfma_f32_16x16x32_bf16 v[144:147], v[168:171], a[72:75], v[144:147]
    v_mfma_f32_16x16x32_bf16 v[148:151], v[172:175], a[72:75], v[148:151]
    v_mfma_f32_16x16x32_bf16 v[152:155], v[168:171], a[76:79], v[152:155]
    v_mfma_f32_16x16x32_bf16 v[156:159], v[172:175], a[76:79], v[156:159]
    s_waitcnt lgkmcnt(0)
    v_mfma_f32_16x16x32_bf16 v[96:99], v[176:179], a[80:83], v[96:99]
    ds_read_b128 v[160:163], v224 offset:24576
    v_mfma_f32_16x16x32_bf16 v[100:103], v[180:183], a[80:83], v[100:103]
    ds_read_b128 v[164:167], v224 offset:26624
    v_mfma_f32_16x16x32_bf16 v[104:107], v[176:179], a[84:87], v[104:107]
    ds_read_b128 v[168:171], v224 offset:28672
    v_mfma_f32_16x16x32_bf16 v[108:111], v[180:183], a[84:87], v[108:111]
    ds_read_b128 v[172:175], v224 offset:30720
    v_mfma_f32_16x16x32_bf16 v[112:115], v[176:179], a[88:91], v[112:115]
    v_mfma_f32_16x16x32_bf16 v[116:119], v[180:183], a[88:91], v[116:119]
    v_mfma_f32_16x16x32_bf16 v[120:123], v[176:179], a[92:95], v[120:123]
    v_mfma_f32_16x16x32_bf16 v[124:127], v[180:183], a[92:95], v[124:127]
    v_mfma_f32_16x16x32_bf16 v[128:131], v[184:187], a[80:83], v[128:131]
    v_mfma_f32_16x16x32_bf16 v[132:135], v[188:191], a[80:83], v[132:135]
    v_mfma_f32_16x16x32_bf16 v[136:139], v[184:187], a[84:87], v[136:139]
    v_mfma_f32_16x16x32_bf16 v[140:143], v[188:191], a[84:87], v[140:143]
    v_mfma_f32_16x16x32_bf16 v[144:147], v[184:187], a[88:91], v[144:147]
    v_mfma_f32_16x16x32_bf16 v[148:151], v[188:191], a[88:91], v[148:151]
    v_mfma_f32_16x16x32_bf16 v[152:155], v[184:187], a[92:95], v[152:155]
    v_mfma_f32_16x16x32_bf16 v[156:159], v[188:191], a[92:95], v[156:159]
    s_waitcnt lgkmcnt(0)
    v_mfma_f32_16x16x32_bf16 v[96:99], v[160:163], a[96:99], v[96:99]
    ds_read_b128 v[176:179], v225 offset:24576
    v_mfma_f32_16x16x32_bf16 v[100:103], v[164:167], a[96:99], v[100:103]
    ds_read_b128 v[180:183], v225 offset:26624
    v_mfma_f32_16x16x32_bf16 v[104:107], v[160:163], a[100:103], v[104:107]
    ds_read_b128 v[184:187], v225 offset:28672
    v_mfma_f32_16x16x32_bf16 v[108:111], v[164:167], a[100:103], v[108:111]
    ds_read_b128 v[188:191], v225 offset:30720
    v_mfma_f32_16x16x32_bf16 v[112:115], v[160:163], a[104:107], v[112:115]
    v_mfma_f32_16x16x32_bf16 v[116:119], v[164:167], a[104:107], v[116:119]
    buffer_load_dword v254, off, s[88:91], s39 sc1
    v_mfma_f32_16x16x32_bf16 v[120:123], v[160:163], a[108:111], v[120:123]
    v_mfma_f32_16x16x32_bf16 v[124:127], v[164:167], a[108:111], v[124:127]
    v_mfma_f32_16x16x32_bf16 v[128:131], v[168:171], a[96:99], v[128:131]
    v_mfma_f32_16x16x32_bf16 v[132:135], v[172:175], a[96:99], v[132:135]
    v_mfma_f32_16x16x32_bf16 v[136:139], v[168:171], a[100:103], v[136:139]
    v_mfma_f32_16x16x32_bf16 v[140:143], v[172:175], a[100:103], v[140:143]
    v_mfma_f32_16x16x32_bf16 v[144:147], v[168:171], a[104:107], v[144:147]
    v_mfma_f32_16x16x32_bf16 v[148:151], v[172:175], a[104:107], v[148:151]
    v_mfma_f32_16x16x32_bf16 v[152:155], v[168:171], a[108:111], v[152:155]
    v_mfma_f32_16x16x32_bf16 v[156:159], v[172:175], a[108:111], v[156:159]
    s_waitcnt lgkmcnt(0)
    v_mfma_f32_16x16x32_bf16 v[96:99], v[176:179], a[112:115], v[96:99]
    ds_read_b128 v[160:163], v224 offset:32768
    v_mfma_f32_16x16x32_bf16 v[100:103], v[180:183], a[112:115], v[100:103]
    ds_read_b128 v[164:167], v224 offset:34816
    v_mfma_f32_16x16x32_bf16 v[104:107], v[176:179], a[116:119], v[104:107]
    ds_read_b128 v[168:171], v224 offset:36864
    v_mfma_f32_16x16x32_bf16 v[108:111], v[180:183], a[116:119], v[108:111]
    ds_read_b128 v[172:175], v224 offset:38912
    v_mfma_f32_16x16x32_bf16 v[112:115], v[176:179], a[120:123], v[112:115]
    v_mfma_f32_16x16x32_bf16 v[116:119], v[180:183], a[120:123], v[116:119]
    s_add_u32 m0, s31, 0
    s_add_u32 s24, s27, 0
    buffer_load_dwordx4 v245, s[12:15], s24 offen lds
    v_mfma_f32_16x16x32_bf16 v[120:123], v[176:179], a[124:127], v[120:123]
    v_mfma_f32_16x16x32_bf16 v[124:127], v[180:183], a[124:127], v[124:127]
    s_add_u32 m0, s31, 1024
    s_add_u32 s24, s27, 32768
    buffer_load_dwordx4 v245, s[12:15], s24 offen lds
    v_mfma_f32_16x16x32_bf16 v[128:131], v[184:187], a[112:115], v[128:131]
    v_mfma_f32_16x16x32_bf16 v[132:135], v[188:191], a[112:115], v[132:135]
    s_add_u32 m0, s31, 2048
    s_add_u32 s24, s27, 65536
    buffer_load_dwordx4 v245, s[12:15], s24 offen lds
    v_mfma_f32_16x16x32_bf16 v[136:139], v[184:187], a[116:119], v[136:139]
    v_mfma_f32_16x16x32_bf16 v[140:143], v[188:191], a[116:119], v[140:143]
    s_add_u32 m0, s31, 3072
    s_add_u32 s24, s27, 98304
    buffer_load_dwordx4 v245, s[12:15], s24 offen lds
    v_mfma_f32_16x16x32_bf16 v[144:147], v[184:187], a[120:123], v[144:147]
    v_mfma_f32_16x16x32_bf16 v[148:151], v[188:191], a[120:123], v[148:151]
    s_add_u32 m0, s31, 4096
    s_add_u32 s24, s27, 131072
    buffer_load_dwordx4 v245, s[12:15], s24 offen lds
    v_mfma_f32_16x16x32_bf16 v[152:155], v[184:187], a[124:127], v[152:155]
    v_mfma_f32_16x16x32_bf16 v[156:159], v[188:191], a[124:127], v[156:159]
    s_waitcnt lgkmcnt(0)
    v_mfma_f32_16x16x32_bf16 v[96:99], v[160:163], a[128:131], v[96:99]
    ds_read_b128 v[176:179], v225 offset:32768
    v_mfma_f32_16x16x32_bf16 v[100:103], v[164:167], a[128:131], v[100:103]
    ds_read_b128 v[180:183], v225 offset:34816
    v_mfma_f32_16x16x32_bf16 v[104:107], v[160:163], a[132:135], v[104:107]
    ds_read_b128 v[184:187], v225 offset:36864
    v_mfma_f32_16x16x32_bf16 v[108:111], v[164:167], a[132:135], v[108:111]
    ds_read_b128 v[188:191], v225 offset:38912
    v_mfma_f32_16x16x32_bf16 v[112:115], v[160:163], a[136:139], v[112:115]
    v_mfma_f32_16x16x32_bf16 v[116:119], v[164:167], a[136:139], v[116:119]
    v_mfma_f32_16x16x32_bf16 v[120:123], v[160:163], a[140:143], v[120:123]
    v_mfma_f32_16x16x32_bf16 v[124:127], v[164:167], a[140:143], v[124:127]
    v_mfma_f32_16x16x32_bf16 v[128:131], v[168:171], a[128:131], v[128:131]
    v_mfma_f32_16x16x32_bf16 v[132:135], v[172:175], a[128:131], v[132:135]
    v_mfma_f32_16x16x32_bf16 v[136:139], v[168:171], a[132:135], v[136:139]
    v_mfma_f32_16x16x32_bf16 v[140:143], v[172:175], a[132:135], v[140:143]
    v_mfma_f32_16x16x32_bf16 v[144:147], v[168:171], a[136:139], v[144:147]
    v_mfma_f32_16x16x32_bf16 v[148:151], v[172:175], a[136:139], v[148:151]
    v_mfma_f32_16x16x32_bf16 v[152:155], v[168:171], a[140:143], v[152:155]
    v_mfma_f32_16x16x32_bf16 v[156:159], v[172:175], a[140:143], v[156:159]
    s_waitcnt lgkmcnt(0)
    v_mfma_f32_16x16x32_bf16 v[96:99], v[176:179], a[144:147], v[96:99]
    ds_read_b128 v[160:163], v224 offset:40960
    v_mfma_f32_16x16x32_bf16 v[100:103], v[180:183], a[144:147], v[100:103]
    ds_read_b128 v[164:167], v224 offset:43008
    v_mfma_f32_16x16x32_bf16 v[104:107], v[176:179], a[148:151], v[104:107]
    ds_read_b128 v[168:171], v224 offset:45056
    v_mfma_f32_16x16x32_bf16 v[108:111], v[180:183], a[148:151], v[108:111]
    ds_read_b128 v[172:175], v224 offset:47104
    v_mfma_f32_16x16x32_bf16 v[112:115], v[176:179], a[152:155], v[112:115]
    v_mfma_f32_16x16x32_bf16 v[116:119], v[180:183], a[152:155], v[116:119]
    s_add_u32 m0, s31, 5120
    s_add_u32 s24, s27, 163840
    buffer_load_dwordx4 v245, s[12:15], s24 offen lds
    v_mfma_f32_16x16x32_bf16 v[120:123], v[176:179], a[156:159], v[120:123]
    v_mfma_f32_16x16x32_bf16 v[124:127], v[180:183], a[156:159], v[124:127]
    s_add_u32 m0, s31, 6144
    s_add_u32 s24, s27, 196608
    buffer_load_dwordx4 v245, s[12:15], s24 offen lds
    v_mfma_f32_16x16x32_bf16 v[128:131], v[184:187], a[144:147], v[128:131]
    v_mfma_f32_16x16x32_bf16 v[132:135], v[188:191], a[144:147], v[132:135]
    s_add_u32 m0, s31, 7168
    s_add_u32 s24, s27, 229376
    buffer_load_dwordx4 v245, s[12:15], s24 offen lds
    v_mfma_f32_16x16x32_bf16 v[136:139], v[184:187], a[148:151], v[136:139]
    v_mfma_f32_16x16x32_bf16 v[140:143], v[188:191], a[148:151], v[140:143]
    s_add_u32 s27, s27, 1048576
    s_and_b32 s27, s27, 0x407fffff
    s_cmp_eq_u32 s27, s7
    s_cselect_b32 s27, s43, s27
    v_mfma_f32_16x16x32_bf16 v[144:147], v[184:187], a[152:155], v[144:147]
    v_mfma_f32_16x16x32_bf16 v[148:151], v[188:191], a[152:155], v[148:151]
    s_add_u32 s31, s31, 32768
    s_cmp_ge_u32 s31, 163840
    s_cselect_b32 s24, 98304, 0
    s_sub_u32 s31, s31, s24
    v_mfma_f32_16x16x32_bf16 v[152:155], v[184:187], a[156:159], v[152:155]
    v_mfma_f32_16x16x32_bf16 v[156:159], v[188:191], a[156:159], v[156:159]
    s_waitcnt lgkmcnt(0)
    v_mfma_f32_16x16x32_bf16 v[96:99], v[160:163], a[160:163], v[96:99]
    ds_read_b128 v[176:179], v225 offset:40960
    v_mfma_f32_16x16x32_bf16 v[100:103], v[164:167], a[160:163], v[100:103]
    ds_read_b128 v[180:183], v225 offset:43008
    v_mfma_f32_16x16x32_bf16 v[104:107], v[160:163], a[164:167], v[104:107]
    ds_read_b128 v[184:187], v225 offset:45056
    v_mfma_f32_16x16x32_bf16 v[108:111], v[164:167], a[164:167], v[108:111]
    ds_read_b128 v[188:191], v225 offset:47104
    v_mfma_f32_16x16x32_bf16 v[112:115], v[160:163], a[168:171], v[112:115]
    v_mfma_f32_16x16x32_bf16 v[116:119], v[164:167], a[168:171], v[116:119]
    v_mfma_f32_16x16x32_bf16 v[120:123], v[160:163], a[172:175], v[120:123]
    v_mfma_f32_16x16x32_bf16 v[124:127], v[164:167], a[172:175], v[124:127]
    v_mfma_f32_16x16x32_bf16 v[128:131], v[168:171], a[160:163], v[128:131]
    v_mfma_f32_16x16x32_bf16 v[132:135], v[172:175], a[160:163], v[132:135]
    v_mfma_f32_16x16x32_bf16 v[136:139], v[168:171], a[164:167], v[136:139]
    v_mfma_f32_16x16x32_bf16 v[140:143], v[172:175], a[164:167], v[140:143]
    v_mfma_f32_16x16x32_bf16 v[144:147], v[168:171], a[168:171], v[144:147]
    v_mfma_f32_16x16x32_bf16 v[148:151], v[172:175], a[168:171], v[148:151]
    v_mfma_f32_16x16x32_bf16 v[152:155], v[168:171], a[172:175], v[152:155]
    v_mfma_f32_16x16x32_bf16 v[156:159], v[172:175], a[172:175], v[156:159]
    s_waitcnt vmcnt(8)
    v_readfirstlane_b32 s24, v254
    s_lshl_b32 s25, s3, 16
    s_add_u32 s24, s24, s25
    s_cmp_ge_u32 s24, 32
    s_cbranch_scc0 ka_spin33
ka_spinr34:
    s_waitcnt lgkmcnt(0)
    s_barrier
    v_mfma_f32_16x16x32_bf16 v[96:99], v[176:179], a[176:179], v[96:99]
    ds_read_b128 v[160:163], v224 offset:49152
    v_mfma_f32_16x16x32_bf16 v[100:103], v[180:183], a[176:179], v[100:103]
    ds_read_b128 v[164:167], v224 offset:51200
    v_mfma_f32_16x16x32_bf16 v[104:107], v[176:179], a[180:183], v[104:107]
    ds_read_b128 v[168:171], v224 offset:53248
    v_mfma_f32_16x16x32_bf16 v[108:111], v[180:183], a[180:183], v[108:111]
    ds_read_b128 v[172:175], v224 offset:55296
    v_mfma_f32_16x16x32_bf16 v[112:115], v[176:179], a[184:187], v[112:115]
    v_mfma_f32_16x16x32_bf16 v[116:119], v[180:183], a[184:187], v[116:119]
    buffer_load_dwordx4 v[0:3], v248, s[8:11], s28 offen offset:0 sc1
    v_mfma_f32_16x16x32_bf16 v[120:123], v[176:179], a[188:191], v[120:123]
    v_mfma_f32_16x16x32_bf16 v[124:127], v[180:183], a[188:191], v[124:127]
    buffer_load_dwordx4 v[4:7], v249, s[8:11], s28 offen offset:0 sc1
    v_mfma_f32_16x16x32_bf16 v[128:131], v[184:187], a[176:179], v[128:131]
    v_mfma_f32_16x16x32_bf16 v[132:135], v[188:191], a[176:179], v[132:135]
    buffer_load_dwordx4 v[8:11], v248, s[8:11], s28 offen offset:1024 sc1
    v_mfma_f32_16x16x32_bf16 v[136:139], v[184:187], a[180:183], v[136:139]
    v_mfma_f32_16x16x32_bf16 v[140:143], v[188:191], a[180:183], v[140:143]
    buffer_load_dwordx4 v[12:15], v249, s[8:11], s28 offen offset:1024 sc1
    v_mfma_f32_16x16x32_bf16 v[144:147], v[184:187], a[184:187], v[144:147]
    v_mfma_f32_16x16x32_bf16 v[148:151], v[188:191], a[184:187], v[148:151]
    v_mfma_f32_16x16x32_bf16 v[152:155], v[184:187], a[188:191], v[152:155]
    v_mfma_f32_16x16x32_bf16 v[156:159], v[188:191], a[188:191], v[156:159]
    s_waitcnt lgkmcnt(0)
    v_mfma_f32_16x16x32_bf16 v[96:99], v[160:163], a[192:195], v[96:99]
    ds_read_b128 v[176:179], v225 offset:49152
    v_mfma_f32_16x16x32_bf16 v[100:103], v[164:167], a[192:195], v[100:103]
    ds_read_b128 v[180:183], v225 offset:51200
    v_mfma_f32_16x16x32_bf16 v[104:107], v[160:163], a[196:199], v[104:107]
    ds_read_b128 v[184:187], v225 offset:53248
    v_mfma_f32_16x16x32_bf16 v[108:111], v[164:167], a[196:199], v[108:111]
    ds_read_b128 v[188:191], v225 offset:55296
    v_mfma_f32_16x16x32_bf16 v[112:115], v[160:163], a[200:203], v[112:115]
    v_mfma_f32_16x16x32_bf16 v[116:119], v[164:167], a[200:203], v[116:119]
    buffer_load_dwordx4 v[16:19], v248, s[8:11], s28 offen offset:2048 sc1
    v_mfma_f32_16x16x32_bf16 v[120:123], v[160:163], a[204:207], v[120:123]
    v_mfma_f32_16x16x32_bf16 v[124:127], v[164:167], a[204:207], v[124:127]
    buffer_load_dwordx4 v[20:23], v249, s[8:11], s28 offen offset:2048 sc1
    v_mfma_f32_16x16x32_bf16 v[128:131], v[168:171], a[192:195], v[128:131]
    v_mfma_f32_16x16x32_bf16 v[132:135], v[172:175], a[192:195], v[132:135]
    buffer_load_dwordx4 v[24:27], v248, s[8:11], s28 offen offset:3072 sc1
    v_mfma_f32_16x16x32_bf16 v[136:139], v[168:171], a[196:199], v[136:139]
    v_mfma_f32_16x16x32_bf16 v[140:143], v[172:175], a[196:199], v[140:143]
    buffer_load_dwordx4 v[28:31], v249, s[8:11], s28 offen offset:3072 sc1
    v_mfma_f32_16x16x32_bf16 v[144:147], v[168:171], a[200:203], v[144:147]
    v_mfma_f32_16x16x32_bf16 v[148:151], v[172:175], a[200:203], v[148:151]
    v_mfma_f32_16x16x32_bf16 v[152:155], v[168:171], a[204:207], v[152:155]
    v_mfma_f32_16x16x32_bf16 v[156:159], v[172:175], a[204:207], v[156:159]
    s_waitcnt lgkmcnt(0)
    v_mfma_f32_16x16x32_bf16 v[96:99], v[176:179], a[208:211], v[96:99]
    ds_read_b128 v[160:163], v224 offset:57344
    v_mfma_f32_16x16x32_bf16 v[100:103], v[180:183], a[208:211], v[100:103]
    ds_read_b128 v[164:167], v224 offset:59392
    v_mfma_f32_16x16x32_bf16 v[104:107], v[176:179], a[212:215], v[104:107]
    ds_read_b128 v[168:171], v224 offset:61440
    v_mfma_f32_16x16x32_bf16 v[108:111], v[180:183], a[212:215], v[108:111]
    ds_read_b128 v[172:175], v224 offset:63488
    v_mfma_f32_16x16x32_bf16 v[112:115], v[176:179], a[216:219], v[112:115]
    v_mfma_f32_16x16x32_bf16 v[116:119], v[180:183], a[216:219], v[116:119]
    buffer_load_dwordx4 v[32:35], v248, s[8:11], s29 offen offset:0 sc1
    v_mfma_f32_16x16x32_bf16 v[120:123], v[176:179], a[220:223], v[120:123]
    v_mfma_f32_16x16x32_bf16 v[124:127], v[180:183], a[220:223], v[124:127]
    buffer_load_dwordx4 v[36:39], v249, s[8:11], s29 offen offset:0 sc1
    v_mfma_f32_16x16x32_bf16 v[128:131], v[184:187], a[208:211], v[128:131]
    v_mfma_f32_16x16x32_bf16 v[132:135], v[188:191], a[208:211], v[132:135]
    buffer_load_dwordx4 v[40:43], v248, s[8:11], s29 offen offset:1024 sc1
    v_mfma_f32_16x16x32_bf16 v[136:139], v[184:187], a[212:215], v[136:139]
    v_mfma_f32_16x16x32_bf16 v[140:143], v[188:191], a[212:215], v[140:143]
    buffer_load_dwordx4 v[44:47], v249, s[8:11], s29 offen offset:1024 sc1
    v_mfma_f32_16x16x32_bf16 v[144:147], v[184:187], a[216:219], v[144:147]
    v_mfma_f32_16x16x32_bf16 v[148:151], v[188:191], a[216:219], v[148:151]
    v_mfma_f32_16x16x32_bf16 v[152:155], v[184:187], a[220:223], v[152:155]
    v_mfma_f32_16x16x32_bf16 v[156:159], v[188:191], a[220:223], v[156:159]
    s_waitcnt lgkmcnt(0)
    v_mfma_f32_16x16x32_bf16 v[96:99], v[160:163], a[224:227], v[96:99]
    ds_read_b128 v[176:179], v225 offset:57344
    v_mfma_f32_16x16x32_bf16 v[100:103], v[164:167], a[224:227], v[100:103]
    ds_read_b128 v[180:183], v225 offset:59392
    v_mfma_f32_16x16x32_bf16 v[104:107], v[160:163], a[228:231], v[104:107]
    ds_read_b128 v[184:187], v225 offset:61440
    v_mfma_f32_16x16x32_bf16 v[108:111], v[164:167], a[228:231], v[108:111]
    ds_read_b128 v[188:191], v225 offset:63488
    v_mfma_f32_16x16x32_bf16 v[112:115], v[160:163], a[232:235], v[112:115]
    v_mfma_f32_16x16x32_bf16 v[116:119], v[164:167], a[232:235], v[116:119]
    buffer_load_dwordx4 v[48:51], v248, s[8:11], s29 offen offset:2048 sc1
    v_mfma_f32_16x16x32_bf16 v[120:123], v[160:163], a[236:239], v[120:123]
    v_mfma_f32_16x16x32_bf16 v[124:127], v[164:167], a[236:239], v[124:127]
    buffer_load_dwordx4 v[52:55], v249, s[8:11], s29 offen offset:2048 sc1
    v_mfma_f32_16x16x32_bf16 v[128:131], v[168:171], a[224:227], v[128:131]
    v_mfma_f32_16x16x32_bf16 v[132:135], v[172:175], a[224:227], v[132:135]
    buffer_load_dwordx4 v[56:59], v248, s[8:11], s29 offen offset:3072 sc1
    v_mfma_f32_16x16x32_bf16 v[136:139], v[168:171], a[228:231], v[136:139]
    v_mfma_f32_16x16x32_bf16 v[140:143], v[172:175], a[228:231], v[140:143]
    buffer_load_dwordx4 v[60:63], v249, s[8:11], s29 offen offset:3072 sc1
    v_mfma_f32_16x16x32_bf16 v[144:147], v[168:171], a[232:235], v[144:147]
    v_mfma_f32_16x16x32_bf16 v[148:151], v[172:175], a[232:235], v[148:151]
    v_mfma_f32_16x16x32_bf16 v[152:155], v[168:171], a[236:239], v[152:155]
    v_mfma_f32_16x16x32_bf16 v[156:159], v[172:175], a[236:239], v[156:159]
    s_waitcnt vmcnt(34) lgkmcnt(0)
    s_barrier
    v_mfma_f32_16x16x32_bf16 v[96:99], v[176:179], a[240:243], v[96:99]
    ds_read_b64_tr_b16 a[192:193], v246 offset:0
    v_mfma_f32_16x16x32_bf16 v[100:103], v[180:183], a[240:243], v[100:103]
    ds_read_b64_tr_b16 a[194:195], v246 offset:1024
    v_mfma_f32_16x16x32_bf16 v[104:107], v[176:179], a[244:247], v[104:107]
    ds_read_b64_tr_b16 a[196:197], v246 offset:256
    v_mfma_f32_16x16x32_bf16 v[108:111], v[180:183], a[244:247], v[108:111]
    ds_read_b64_tr_b16 a[198:199], v246 offset:1280
    v_mfma_f32_16x16x32_bf16 v[112:115], v[176:179], a[248:251], v[112:115]
    ds_read_b64_tr_b16 a[200:201], v246 offset:512
    v_mfma_f32_16x16x32_bf16 v[116:119], v[180:183], a[248:251], v[116:119]
    ds_read_b64_tr_b16 a[202:203], v246 offset:1536
    s_add_u32 s28, s28, 8192
    s_and_b32 s28, s28, 65535
    s_add_u32 s29, s28, 4096
    v_mfma_f32_16x16x32_bf16 v[120:123], v[176:179], a[252:255], v[120:123]
    ds_read_b64_tr_b16 a[204:205], v246 offset:768
    v_mfma_f32_16x16x32_bf16 v[124:127], v[180:183], a[252:255], v[124:127]
    ds_read_b64_tr_b16 a[206:207], v246 offset:1792
    v_mfma_f32_16x16x32_bf16 v[128:131], v[184:187], a[240:243], v[128:131]
    v_mfma_f32_16x16x32_bf16 v[132:135], v[188:191], a[240:243], v[132:135]
    v_cvt_pk_bf16_f32 v64, v96, v97
    v_cvt_pk_bf16_f32 v65, v98, v99
    v_mfma_f32_16x16x32_bf16 v[136:139], v[184:187], a[244:247], v[136:139]
    v_cvt_pk_bf16_f32 v66, v100, v101
    v_cvt_pk_bf16_f32 v67, v102, v103
    v_mfma_f32_16x16x32_bf16 v[140:143], v[188:191], a[244:247], v[140:143]
    v_cvt_pk_bf16_f32 v68, v104, v105
    v_cvt_pk_bf16_f32 v69, v106, v107
    v_mfma_f32_16x16x32_bf16 v[144:147], v[184:187], a[248:251], v[144:147]
    v_cvt_pk_bf16_f32 v70, v108, v109
    v_cvt_pk_bf16_f32 v71, v110, v111
    v_mfma_f32_16x16x32_bf16 v[148:151], v[188:191], a[248:251], v[148:151]
    v_cvt_pk_bf16_f32 v72, v112, v113
    v_cvt_pk_bf16_f32 v73, v114, v115
    v_mfma_f32_16x16x32_bf16 v[152:155], v[184:187], a[252:255], v[152:155]
    v_cvt_pk_bf16_f32 v74, v116, v117
    v_cvt_pk_bf16_f32 v75, v118, v119
    v_mfma_f32_16x16x32_bf16 v[156:159], v[188:191], a[252:255], v[156:159]
    v_cvt_pk_bf16_f32 v76, v120, v121
    v_cvt_pk_bf16_f32 v77, v122, v123
    s_nop 3
    v_cvt_pk_bf16_f32 v78, v124, v125
    v_cvt_pk_bf16_f32 v79, v126, v127
    v_cvt_pk_bf16_f32 v80, v128, v129
    v_cvt_pk_bf16_f32 v81, v130, v131
    v_cvt_pk_bf16_f32 v82, v132, v133
    v_cvt_pk_bf16_f32 v83, v134, v135
    v_cvt_pk_bf16_f32 v84, v136, v137
    v_cvt_pk_bf16_f32 v85, v138, v139
    v_cvt_pk_bf16_f32 v86, v140, v141
    v_cvt_pk_bf16_f32 v87, v142, v143
    v_cvt_pk_bf16_f32 v88, v144, v145
    v_cvt_pk_bf16_f32 v89, v146, v147
    v_cvt_pk_bf16_f32 v90, v148, v149
    v_cvt_pk_bf16_f32 v91, v150, v151
    v_cvt_pk_bf16_f32 v92, v152, v153
    v_cvt_pk_bf16_f32 v93, v154, v155
    v_cvt_pk_bf16_f32 v94, v156, v157
    v_cvt_pk_bf16_f32 v95, v158, v159
    s_add_u32 s80, s36, 98304
    s_add_u32 s81, s36, 99328
    s_add_u32 s82, s36, 100352
    s_add_u32 s83, s36, 101376
    s_add_u32 s84, s36, 106496
    s_add_u32 s85, s36, 107520
    s_add_u32 s86, s36, 108544
    s_add_u32 s87, s36, 109568
ka_Q:
    s_waitcnt vmcnt(14) lgkmcnt(0)
    v_mfma_f32_32x32x16_bf16 v[96:111], a[192:195], v[0:3], 0
    ds_read_b64_tr_b16 a[208:209], v246 offset:4096
    ds_read_b64_tr_b16 a[210:211], v246 offset:5120
    s_lshl_b32 s97, s4, 2
    s_add_u32 s97, s97, 64
    v_mfma_f32_32x32x16_bf16 v[160:175], a[192:195], v[4:7], 0
    ds_read_b64_tr_b16 a[212:213], v246 offset:4352
    ds_read_b64_tr_b16 a[214:215], v246 offset:5376
    s_cmp_eq_u32 s3, 0
    s_cselect_b32 s35, s97, s43
    s_lshl_b32 s37, s3, 12
    s_mov_b32 s34, s37
    v_mfma_f32_32x32x16_bf16 v[112:127], a[196:199], v[0:3], 0
    ds_read_b64_tr_b16 a[216:217], v246 offset:4608
    ds_read_b64_tr_b16 a[218:219], v246 offset:5632
    s_lshl_b32 s32, s4, 20
    s_lshl_b32 s25, s5, 16
    v_mfma_f32_32x32x16_bf16 v[176:191], a[196:199], v[4:7], 0
    ds_read_b64_tr_b16 a[220:221], v246 offset:4864
    ds_read_b64_tr_b16 a[222:223], v246 offset:5888
    s_sub_u32 s33, s32, s25
    s_add_u32 s33, s33, 1048576
    v_mfma_f32_32x32x16_bf16 v[128:143], a[200:203], v[0:3], 0
    s_lshl_b32 s39, s6, 18
    s_sub_u32 s25, 63, s6
    s_lshl_b32 s40, s25, 18
    s_lshl_b32 s25, s4, 12
    v_mfma_f32_32x32x16_bf16 v[192:207], a[200:203], v[4:7], 0
    s_add_u32 s39, s39, s25
    s_add_u32 s40, s40, s25
    s_mov_b32 s38, 0x47800000
    v_mfma_f32_32x32x16_bf16 v[144:159], a[204:207], v[0:3], 0
    s_add_u32 m0, s31, 0
    s_add_u32 s24, s27, 0
    buffer_load_dwordx4 v245, s[12:15], s24 offen lds
    s_sub_u32 s36, 0, s6
    s_sub_u32 s36, s36, 1
    v_mfma_f32_32x32x16_bf16 v[208:223], a[204:207], v[4:7], 0
    buffer_store_dwordx4 v[64:67], v240, s[16:19], s80 offen sc1
    s_mov_b32 s26, 6
    v_accvgpr_write_b32 a0, 0
    s_waitcnt vmcnt(14) lgkmcnt(0)
    v_mfma_f32_32x32x16_bf16 v[96:111], a[208:211], v[8:11], v[96:111]
    ds_read_b64_tr_b16 a[192:193], v246 offset:8192
    ds_read_b64_tr_b16 a[194:195], v246 offset:9216
    v_accvgpr_write_b32 a1, 0
    v_accvgpr_write_b32 a2, 0
    v_mfma_f32_32x32x16_bf16 v[160:175], a[208:211], v[12:15], v[160:175]
    ds_read_b64_tr_b16 a[196:197], v246 offset:8448
    ds_read_b64_tr_b16 a[198:199], v246 offset:9472
    v_accvgpr_write_b32 a3, 0
    v_accvgpr_write_b32 a4, 0
    v_accvgpr_write_b32 a5, 0
    v_mfma_f32_32x32x16_bf16 v[112:127], a[212:215], v[8:11], v[112:127]
    ds_read_b64_tr_b16 a[200:201], v246 offset:8704
    ds_read_b64_tr_b16 a[202:203], v246 offset:9728
    v_accvgpr_write_b32 a6, 0
    v_accvgpr_write_b32 a7, 0
    v_mfma_f32_32x32x16_bf16 v[176:191], a[212:215], v[12:15], v[176:191]
    ds_read_b64_tr_b16 a[204:205], v246 offset:8960
    ds_read_b64_tr_b16 a[206:207], v246 offset:9984
    v_accvgpr_write_b32 a8, 0
    v_accvgpr_write_b32 a9, 0
    v_mfma_f32_32x32x16_bf16 v[128:143], a[216:219], v[8:11], v[128:143]
    buffer_load_dwordx4 v[0:3], v248, s[8:11], s28 offen offset:0 sc1
    v_accvgpr_write_b32 a10, 0
    v_accvgpr_write_b32 a11, 0
    v_accvgpr_write_b32 a12, 0
    v_mfma_f32_32x32x16_bf16 v[192:207], a[216:219], v[12:15], v[192:207]
    buffer_load_dwordx4 v[4:7], v249, s[8:11], s28 offen offset:0 sc1
    v_accvgpr_write_b32 a13, 0
    v_accvgpr_write_b32 a14, 0
    v_accvgpr_write_b32 a15, 0
    v_mfma_f32_32x32x16_bf16 v[144:159], a[220:223], v[8:11], v[144:159]
    s_add_u32 m0, s31, 1024
    s_add_u32 s24, s27, 32768
    buffer_load_dwordx4 v245, s[12:15], s24 offen lds
    v_accvgpr_write_b32 a16, 0
    v_accvgpr_write_b32 a17, 0
    v_mfma_f32_32x32x16_bf16 v[208:223], a[220:223], v[12:15], v[208:223]
    buffer_store_dwordx4 v[68:71], v240, s[16:19], s81 offen sc1
    v_accvgpr_write_b32 a18, 0
    v_accvgpr_write_b32 a19, 0
    s_waitcnt vmcnt(16) lgkmcnt(0)
    v_mfma_f32_32x32x16_bf16 v[96:111], a[192:195], v[16:19], v[96:111]
    ds_read_b64_tr_b16 a[208:209], v246 offset:12288
    ds_read_b64_tr_b16 a[210:211], v246 offset:13312
    v_accvgpr_write_b32 a20, 0
    v_accvgpr_write_b32 a21, 0
    v_mfma_f32_32x32x16_bf16 v[160:175], a[192:195], v[20:23], v[160:175]
    ds_read_b64_tr_b16 a[212:213], v246 offset:12544
    ds_read_b64_tr_b16 a[214:215], v246 offset:13568
    v_accvgpr_write_b32 a22, 0
    v_accvgpr_write_b32 a23, 0
    v_mfma_f32_32x32x16_bf16 v[112:127], a[196:199], v[16:19], v[112:127]
    ds_read_b64_tr_b16 a[216:217], v246 offset:12800
    ds_read_b64_tr_b16 a[218:219], v246 offset:13824
    v_accvgpr_write_b32 a24, 0
    v_accvgpr_write_b32 a25, 0
    v_accvgpr_write_b32 a26, 0
    v_mfma_f32_32x32x16_bf16 v[176:191], a[196:199], v[20:23], v[176:191]
    ds_read_b64_tr_b16 a[220:221], v246 offset:13056
    ds_read_b64_tr_b16 a[222:223], v246 offset:14080
    v_accvgpr_write_b32 a27, 0
    v_accvgpr_write_b32 a28, 0
    v_mfma_f32_32x32x16_bf16 v[128:143], a[200:203], v[16:19], v[128:143]
    buffer_load_dwordx4 v[8:11], v248, s[8:11], s28 offen offset:1024 sc1
    v_accvgpr_write_b32 a29, 0
    v_accvgpr_write_b32 a30, 0
    v_accvgpr_write_b32 a31, 0
    v_mfma_f32_32x32x16_bf16 v[192:207], a[200:203], v[20:23], v[192:207]
    buffer_load_dwordx4 v[12:15], v249, s[8:11], s28 offen offset:1024 sc1
    v_accvgpr_write_b32 a32, 0
    v_accvgpr_write_b32 a33, 0
    v_accvgpr_write_b32 a34, 0
    v_mfma_f32_32x32x16_bf16 v[144:159], a[204:207], v[16:19], v[144:159]
    s_add_u32 m0, s31, 2048
    s_add_u32 s24, s27, 65536
    buffer_load_dwordx4 v245, s[12:15], s24 offen lds
    v_accvgpr_write_b32 a35, 0
    v_mfma_f32_32x32x16_bf16 v[208:223], a[204:207], v[20:23], v[208:223]
    buffer_store_dwordx4 v[72:75], v240, s[16:19], s82 offen sc1
    v_accvgpr_write_b32 a36, 0
    v_accvgpr_write_b32 a37, 0
    v_accvgpr_write_b32 a38, 0
    s_waitcnt vmcnt(18) lgkmcnt(0)
    v_mfma_f32_32x32x16_bf16 v[96:111], a[208:211], v[24:27], v[96:111]
    ds_read_b64_tr_b16 a[192:193], v246 offset:16384
    ds_read_b64_tr_b16 a[194:195], v246 offset:17408
    v_accvgpr_write_b32 a39, 0
    v_accvgpr_write_b32 a40, 0
    v_mfma_f32_32x32x16_bf16 v[160:175], a[208:211], v[28:31], v[160:175]
    ds_read_b64_tr_b16 a[196:197], v246 offset:16640
    ds_read_b64_tr_b16 a[198:199], v246 offset:17664
    v_accvgpr_write_b32 a41, 0
    v_accvgpr_write_b32 a42, 0
    v_mfma_f32_32x32x16_bf16 v[112:127], a[212:215], v[24:27], v[112:127]
    ds_read_b64_tr_b16 a[200:201], v246 offset:16896
    ds_read_b64_tr_b16 a[202:203], v246 offset:17920
    v_accvgpr_write_b32 a43, 0
    v_accvgpr_write_b32 a44, 0
    v_accvgpr_write_b32 a45, 0
    v_mfma_f32_32x32x16_bf16 v[176:191], a[212:215], v[28:31], v[176:191]
    ds_read_b64_tr_b16 a[204:205], v246 offset:17152
    ds_read_b64_tr_b16 a[206:207], v246 offset:18176
    v_accvgpr_write_b32 a46, 0
    v_accvgpr_write_b32 a47, 0
    v_mfma_f32_32x32x16_bf16 v[128:143], a[216:219], v[24:27], v[128:143]
    buffer_load_dwordx4 v[16:19], v248, s[8:11], s28 offen offset:2048 sc1
    v_accvgpr_write_b32 a48, 0
    v_accvgpr_write_b32 a49, 0
    v_accvgpr_write_b32 a50, 0
    v_mfma_f32_32x32x16_bf16 v[192:207], a[216:219], v[28:31], v[192:207]
    buffer_load_dwordx4 v[20:23], v249, s[8:11], s28 offen offset:2048 sc1
    v_accvgpr_write_b32 a51, 0
    v_accvgpr_write_b32 a52, 0
    v_accvgpr_write_b32 a53, 0
    v_mfma_f32_32x32x16_bf16 v[144:159], a[220:223], v[24:27], v[144:159]
    s_add_u32 m0, s31, 3072
    s_add_u32 s24, s27, 98304
    buffer_load_dwordx4 v245, s[12:15], s24 offen lds
    v_accvgpr_write_b32 a54, 0
    v_mfma_f32_32x32x16_bf16 v[208:223], a[220:223], v[28:31], v[208:223]
    buffer_store_dwordx4 v[76:79], v240, s[16:19], s83 offen sc1
    v_accvgpr_write_b32 a55, 0
    v_accvgpr_write_b32 a56, 0
    v_accvgpr_write_b32 a57, 0
    s_waitcnt vmcnt(20) lgkmcnt(0)
    v_mfma_f32_32x32x16_bf16 v[96:111], a[192:195], v[32:35], v[96:111]
    ds_read_b64_tr_b16 a[208:209], v246 offset:20480
    ds_read_b64_tr_b16 a[210:211], v246 offset:21504
    v_accvgpr_write_b32 a58, 0
    v_accvgpr_write_b32 a59, 0
    v_mfma_f32_32x32x16_bf16 v[160:175], a[192:195], v[36:39], v[160:175]
    ds_read_b64_tr_b16 a[212:213], v246 offset:20736
    ds_read_b64_tr_b16 a[214:215], v246 offset:21760
    v_accvgpr_write_b32 a60, 0
    v_accvgpr_write_b32 a61, 0
    v_mfma_f32_32x32x16_bf16 v[112:127], a[196:199], v[32:35], v[112:127]
    ds_read_b64_tr_b16 a[216:217], v246 offset:20992
    ds_read_b64_tr_b16 a[218:219], v246 offset:22016
    v_accvgpr_write_b32 a62, 0
    v_accvgpr_write_b32 a63, 0
    v_accvgpr_write_b32 a64, 0
    v_mfma_f32_32x32x16_bf16 v[176:191], a[196:199], v[36:39], v[176:191]
    ds_read_b64_tr_b16 a[220:221], v246 offset:21248
    ds_read_b64_tr_b16 a[222:223], v246 offset:22272
    v_accvgpr_write_b32 a65, 0
    v_accvgpr_write_b32 a66, 0
    v_mfma_f32_32x32x16_bf16 v[128:143], a[200:203], v[32:35], v[128:143]
    buffer_load_dwordx4 v[24:27], v248, s[8:11], s28 offen offset:3072 sc1
    v_accvgpr_write_b32 a67, 0
    v_accvgpr_write_b32 a68, 0
    v_accvgpr_write_b32 a69, 0
    v_mfma_f32_32x32x16_bf16 v[192:207], a[200:203], v[36:39], v[192:207]
    buffer_load_dwordx4 v[28:31], v249, s[8:11], s28 offen offset:3072 sc1
    v_accvgpr_write_b32 a70, 0
    v_accvgpr_write_b32 a71, 0
    v_accvgpr_write_b32 a72, 0
    v_mfma_f32_32x32x16_bf16 v[144:159], a[204:207], v[32:35], v[144:159]
    s_add_u32 m0, s31, 4096
    s_add_u32 s24, s27, 131072
    buffer_load_dwordx4 v245, s[12:15], s24 offen lds
    v_accvgpr_write_b32 a73, 0
    v_mfma_f32_32x32x16_bf16 v[208:223], a[204:207], v[36:39], v[208:223]
    buffer_store_dwordx4 v[80:83], v240, s[16:19], s84 offen sc1
    v_accvgpr_write_b32 a74, 0
    v_accvgpr_write_b32 a75, 0
    v_accvgpr_write_b32 a76, 0
    s_waitcnt vmcnt(22) lgkmcnt(0)
    v_mfma_f32_32x32x16_bf16 v[96:111], a[208:211], v[40:43], v[96:111]
    ds_read_b64_tr_b16 a[192:193], v246 offset:24576
    ds_read_b64_tr_b16 a[194:195], v246 offset:25600
    v_accvgpr_write_b32 a77, 0
    v_accvgpr_write_b32 a78, 0
    v_mfma_f32_32x32x16_bf16 v[160:175], a[208:211], v[44:47], v[160:175]
    ds_read_b64_tr_b16 a[196:197], v246 offset:24832
    ds_read_b64_tr_b16 a[198:199], v246 offset:25856
    v_accvgpr_write_b32 a79, 0
    v_accvgpr_write_b32 a80, 0
    v_mfma_f32_32x32x16_bf16 v[112:127], a[212:215], v[40:43], v[112:127]
    ds_read_b64_tr_b16 a[200:201], v246 offset:25088
    ds_read_b64_tr_b16 a[202:203], v246 offset:26112
    v_accvgpr_write_b32 a81, 0
    v_accvgpr_write_b32 a82, 0
    v_mfma_f32_32x32x16_bf16 v[176:191], a[212:215], v[44:47], v[176:191]
    ds_read_b64_tr_b16 a[204:205], v246 offset:25344
    ds_read_b64_tr_b16 a[206:207], v246 offset:26368
    v_accvgpr_write_b32 a83, 0
    v_accvgpr_write_b32 a84, 0
    v_accvgpr_write_b32 a85, 0
    v_mfma_f32_32x32x16_bf16 v[128:143], a[216:219], v[40:43], v[128:143]
    buffer_load_dwordx4 v[32:35], v248, s[8:11], s29 offen offset:0 sc1
    v_accvgpr_write_b32 a86, 0
    v_accvgpr_write_b32 a87, 0
    v_accvgpr_write_b32 a88, 0
    v_mfma_f32_32x32x16_bf16 v[192:207], a[216:219], v[44:47], v[192:207]
    buffer_load_dwordx4 v[36:39], v249, s[8:11], s29 offen offset:0 sc1
    v_accvgpr_write_b32 a89, 0
    v_accvgpr_write_b32 a90, 0
    v_mfma_f32_32x32x16_bf16 v[144:159], a[220:223], v[40:43], v[144:159]
    s_add_u32 m0, s31, 5120
    s_add_u32 s24, s27, 163840
    buffer_load_dwordx4 v245, s[12:15], s24 offen lds
    v_accvgpr_write_b32 a91, 0
    v_accvgpr_write_b32 a92, 0
    v_mfma_f32_32x32x16_bf16 v[208:223], a[220:223], v[44:47], v[208:223]
    buffer_store_dwordx4 v[84:87], v240, s[16:19], s85 offen sc1
    v_accvgpr_write_b32 a93, 0
    v_accvgpr_write_b32 a94, 0
    s_waitcnt vmcnt(24) lgkmcnt(0)
    v_mfma_f32_32x32x16_bf16 v[96:111], a[192:195], v[48:51], v[96:111]
    ds_read_b64_tr_b16 a[208:209], v246 offset:28672
    ds_read_b64_tr_b16 a[210:211], v246 offset:29696
    v_accvgpr_write_b32 a95, 0
    v_accvgpr_write_b32 a96, 0
    v_accvgpr_write_b32 a97, 0
    v_mfma_f32_32x32x16_bf16 v[160:175], a[192:195], v[52:55], v[160:175]
    ds_read_b64_tr_b16 a[212:213], v246 offset:28928
    ds_read_b64_tr_b16 a[214:215], v246 offset:29952
    v_accvgpr_write_b32 a98, 0
    v_accvgpr_write_b32 a99, 0
    v_mfma_f32_32x32x16_bf16 v[112:127], a[196:199], v[48:51], v[112:127]
    ds_read_b64_tr_b16 a[216:217], v246 offset:29184
    ds_read_b64_tr_b16 a[218:219], v246 offset:30208
    v_accvgpr_write_b32 a100, 0
    v_accvgpr_write_b32 a101, 0
    v_mfma_f32_32x32x16_bf16 v[176:191], a[196:199], v[52:55], v[176:191]
    ds_read_b64_tr_b16 a[220:221], v246 offset:29440
    ds_read_b64_tr_b16 a[222:223], v246 offset:30464
    v_accvgpr_write_b32 a102, 0
    v_accvgpr_write_b32 a103, 0
    v_accvgpr_write_b32 a104, 0
    v_mfma_f32_32x32x16_bf16 v[128:143], a[200:203], v[48:51], v[128:143]
    buffer_load_dwordx4 v[40:43], v248, s[8:11], s29 offen offset:1024 sc1
    v_accvgpr_write_b32 a105, 0
    v_accvgpr_write_b32 a106, 0
    v_mfma_f32_32x32x16_bf16 v[192:207], a[200:203], v[52:55], v[192:207]
    buffer_load_dwordx4 v[44:47], v249, s[8:11], s29 offen offset:1024 sc1
    v_accvgpr_write_b32 a107, 0
    v_accvgpr_write_b32 a108, 0
    v_accvgpr_write_b32 a109, 0
    v_mfma_f32_32x32x16_bf16 v[144:159], a[204:207], v[48:51], v[144:159]
    s_add_u32 m0, s31, 6144
    s_add_u32 s24, s27, 196608
    buffer_load_dwordx4 v245, s[12:15], s24 offen lds
    v_accvgpr_write_b32 a110, 0
    v_accvgpr_write_b32 a111, 0
    v_mfma_f32_32x32x16_bf16 v[208:223], a[204:207], v[52:55], v[208:223]
    buffer_store_dwordx4 v[88:91], v240, s[16:19], s86 offen sc1
    s_waitcnt vmcnt(26) lgkmcnt(0)
    s_barrier
    s_add_u32 s30, s30, 32768
    s_cmp_ge_u32 s30, 163840
    s_cselect_b32 s24, 98304, 0
    s_sub_u32 s30, s30, s24
    v_add_u32 v246, s30, v247
    v_mfma_f32_32x32x16_bf16 v[96:111], a[208:211], v[56:59], v[96:111]
    ds_read_b64_tr_b16 a[192:193], v246 offset:0
    ds_read_b64_tr_b16 a[194:195], v246 offset:1024
    v_accvgpr_write_b32 a112, 0
    v_accvgpr_write_b32 a113, 0
    v_mfma_f32_32x32x16_bf16 v[160:175], a[208:211], v[60:63], v[160:175]
    ds_read_b64_tr_b16 a[196:197], v246 offset:256
    ds_read_b64_tr_b16 a[198:199], v246 offset:1280
    v_accvgpr_write_b32 a114, 0
    v_accvgpr_write_b32 a115, 0
    v_accvgpr_write_b32 a116, 0
    v_mfma_f32_32x32x16_bf16 v[112:127], a[212:215], v[56:59], v[112:127]
    ds_read_b64_tr_b16 a[200:201], v246 offset:512
    ds_read_b64_tr_b16 a[202:203], v246 offset:1536
    v_accvgpr_write_b32 a117, 0
    v_accvgpr_write_b32 a118, 0
    v_mfma_f32_32x32x16_bf16 v[176:191], a[212:215], v[60:63], v[176:191]
    ds_read_b64_tr_b16 a[204:205], v246 offset:768
    ds_read_b64_tr_b16 a[206:207], v246 offset:1792
    buffer_store_dwordx4 v[92:95], v240, s[16:19], s87 offen sc1
    v_accvgpr_write_b32 a119, 0
    v_accvgpr_write_b32 a120, 0
    v_mfma_f32_32x32x16_bf16 v[128:143], a[216:219], v[56:59], v[128:143]
    buffer_load_dwordx4 v[48:51], v248, s[8:11], s29 offen offset:2048 sc1
    v_accvgpr_write_b32 a121, 0
    v_accvgpr_write_b32 a122, 0
    v_mfma_f32_32x32x16_bf16 v[192:207], a[216:219], v[60:63], v[192:207]
    buffer_load_dwordx4 v[52:55], v249, s[8:11], s29 offen offset:2048 sc1
    v_accvgpr_write_b32 a123, 0
    v_accvgpr_write_b32 a124, 0
    v_accvgpr_write_b32 a125, 0
    v_mfma_f32_32x32x16_bf16 v[144:159], a[220:223], v[56:59], v[144:159]
    s_add_u32 m0, s31, 7168
    s_add_u32 s24, s27, 229376
    buffer_load_dwordx4 v245, s[12:15], s24 offen lds
    v_accvgpr_write_b32 a126, 0
    v_accvgpr_write_b32 a127, 0
    v_mfma_f32_32x32x16_bf16 v[208:223], a[220:223], v[60:63], v[208:223]
    buffer_load_dwordx4 v[56:59], v248, s[8:11], s29 offen offset:3072 sc1
    buffer_load_dwordx4 v[60:63], v249, s[8:11], s29 offen offset:3072 sc1
    s_add_u32 s28, s28, 8192
    s_and_b32 s28, s28, 65535
    s_add_u32 s29, s28, 4096
    s_add_u32 s27, s27, 1048576
    s_and_b32 s27, s27, 0x407fffff
    s_cmp_eq_u32 s27, s7
    s_cselect_b32 s27, s43, s27
    s_add_u32 s31, s31, 32768
    s_cmp_ge_u32 s31, 163840
    s_cselect_b32 s24, 98304, 0
    s_sub_u32 s31, s31, s24
.p2align 3
ka_qp:
    s_waitcnt vmcnt(22) lgkmcnt(0)
    v_mfma_f32_32x32x16_bf16 v[96:111], a[192:195], v[0:3], v[96:111]
    ds_read_b64_tr_b16 a[208:209], v246 offset:4096
    ds_read_b64_tr_b16 a[210:211], v246 offset:5120
    v_mfma_f32_32x32x16_bf16 v[160:175], a[192:195], v[4:7], v[160:175]
    ds_read_b64_tr_b16 a[212:213], v246 offset:4352
    ds_read_b64_tr_b16 a[214:215], v246 offset:5376
    v_mfma_f32_32x32x16_bf16 v[112:127], a[196:199], v[0:3], v[112:127]
    ds_read_b64_tr_b16 a[216:217], v246 offset:4608
    ds_read_b64_tr_b16 a[218:219], v246 offset:5632
    v_mfma_f32_32x32x16_bf16 v[176:191], a[196:199], v[4:7], v[176:191]
    ds_read_b64_tr_b16 a[220:221], v246 offset:4864
    ds_read_b64_tr_b16 a[222:223], v246 offset:5888
    v_mfma_f32_32x32x16_bf16 v[128:143], a[200:203], v[0:3], v[128:143]
    s_cmp_eq_u32 s26, 1
    s_cselect_b32 s41, s35, s43
    buffer_load_dword v254, off, s[88:91], s41 sc1
    v_mfma_f32_32x32x16_bf16 v[192:207], a[200:203], v[4:7], v[192:207]
    v_mfma_f32_32x32x16_bf16 v[144:159], a[204:207], v[0:3], v[144:159]
    s_add_u32 m0, s31, 0
    s_add_u32 s24, s27, 0
    buffer_load_dwordx4 v245, s[12:15], s24 offen lds
    v_mfma_f32_32x32x16_bf16 v[208:223], a[204:207], v[4:7], v[208:223]
    s_waitcnt vmcnt(21) lgkmcnt(0)
    v_mfma_f32_32x32x16_bf16 v[96:111], a[208:211], v[8:11], v[96:111]
    ds_read_b64_tr_b16 a[192:193], v246 offset:8192
    ds_read_b64_tr_b16 a[194:195], v246 offset:9216
    v_mfma_f32_32x32x16_bf16 v[160:175], a[208:211], v[12:15], v[160:175]
    ds_read_b64_tr_b16 a[196:197], v246 offset:8448
    ds_read_b64_tr_b16 a[198:199], v246 offset:9472
    v_mfma_f32_32x32x16_bf16 v[112:127], a[212:215], v[8:11], v[112:127]
    ds_read_b64_tr_b16 a[200:201], v246 offset:8704
    ds_read_b64_tr_b16 a[202:203], v246 offset:9728
    v_mfma_f32_32x32x16_bf16 v[176:191], a[212:215], v[12:15], v[176:191]
    ds_read_b64_tr_b16 a[204:205], v246 offset:8960
    ds_read_b64_tr_b16 a[206:207], v246 offset:9984
    v_mfma_f32_32x32x16_bf16 v[128:143], a[216:219], v[8:11], v[128:143]
    buffer_load_dwordx4 v[0:3], v248, s[8:11], s28 offen offset:0 sc1
    v_mfma_f32_32x32x16_bf16 v[192:207], a[216:219], v[12:15], v[192:207]
    buffer_load_dwordx4 v[4:7], v249, s[8:11], s28 offen offset:0 sc1
    v_mfma_f32_32x32x16_bf16 v[144:159], a[220:223], v[8:11], v[144:159]
    s_add_u32 m0, s31, 1024
    s_add_u32 s24, s27, 32768
    buffer_load_dwordx4 v245, s[12:15], s24 offen lds
    v_mfma_f32_32x32x16_bf16 v[208:223], a[220:223], v[12:15], v[208:223]
    s_waitcnt vmcnt(21) lgkmcnt(0)
    v_mfma_f32_32x32x16_bf16 v[96:111], a[192:195], v[16:19], v[96:111]
    ds_read_b64_tr_b16 a[208:209], v246 offset:12288
    ds_read_b64_tr_b16 a[210:211], v246 offset:13312
    v_mfma_f32_32x32x16_bf16 v[160:175], a[192:195], v[20:23], v[160:175]
    ds_read_b64_tr_b16 a[212:213], v246 offset:12544
    ds_read_b64_tr_b16 a[214:215], v246 offset:13568
    v_mfma_f32_32x32x16_bf16 v[112:127], a[196:199], v[16:19], v[112:127]
    ds_read_b64_tr_b16 a[216:217], v246 offset:12800
    ds_read_b64_tr_b16 a[218:219], v246 offset:13824
    v_mfma_f32_32x32x16_bf16 v[176:191], a[196:199], v[20:23], v[176:191]
    ds_read_b64_tr_b16 a[220:221], v246 offset:13056
    ds_read_b64_tr_b16 a[222:223], v246 offset:14080
    v_mfma_f32_32x32x16_bf16 v[128:143], a[200:203], v[16:19], v[128:143]
    buffer_load_dwordx4 v[8:11], v248, s[8:11], s28 offen offset:1024 sc1
    v_mfma_f32_32x32x16_bf16 v[192:207], a[200:203], v[20:23], v[192:207]
    buffer_load_dwordx4 v[12:15], v249, s[8:11], s28 offen offset:1024 sc1
    v_mfma_f32_32x32x16_bf16 v[144:159], a[204:207], v[16:19], v[144:159]
    s_add_u32 m0, s31, 2048
    s_add_u32 s24, s27, 65536
    buffer_load_dwordx4 v245, s[12:15], s24 offen lds
    v_mfma_f32_32x32x16_bf16 v[208:223], a[204:207], v[20:23], v[208:223]
    s_waitcnt vmcnt(21) lgkmcnt(0)
    v_mfma_f32_32x32x16_bf16 v[96:111], a[208:211], v[24:27], v[96:111]
    ds_read_b64_tr_b16 a[192:193], v246 offset:16384
    ds_read_b64_tr_b16 a[194:195], v246 offset:17408
    v_mfma_f32_32x32x16_bf16 v[160:175], a[208:211], v[28:31], v[160:175]
    ds_read_b64_tr_b16 a[196:197], v246 offset:16640
    ds_read_b64_tr_b16 a[198:199], v246 offset:17664
    v_mfma_f32_32x32x16_bf16 v[112:127], a[212:215], v[24:27], v[112:127]
    ds_read_b64_tr_b16 a[200:201], v246 offset:16896
    ds_read_b64_tr_b16 a[202:203], v246 offset:17920
    v_mfma_f32_32x32x16_bf16 v[176:191], a[212:215], v[28:31], v[176:191]
    ds_read_b64_tr_b16 a[204:205], v246 offset:17152
    ds_read_b64_tr_b16 a[206:207], v246 offset:18176
    v_mfma_f32_32x32x16_bf16 v[128:143], a[216:219], v[24:27], v[128:143]
    buffer_load_dwordx4 v[16:19], v248, s[8:11], s28 offen offset:2048 sc1
    v_mfma_f32_32x32x16_bf16 v[192:207], a[216:219], v[28:31], v[192:207]
    buffer_load_dwordx4 v[20:23], v249, s[8:11], s28 offen offset:2048 sc1
    v_mfma_f32_32x32x16_bf16 v[144:159], a[220:223], v[24:27], v[144:159]
    s_add_u32 m0, s31, 3072
    s_add_u32 s24, s27, 98304
    buffer_load_dwordx4 v245, s[12:15], s24 offen lds
    v_mfma_f32_32x32x16_bf16 v[208:223], a[220:223], v[28:31], v[208:223]
    s_waitcnt vmcnt(21) lgkmcnt(0)
    v_mfma_f32_32x32x16_bf16 v[96:111], a[192:195], v[32:35], v[96:111]
    ds_read_b64_tr_b16 a[208:209], v246 offset:20480
    ds_read_b64_tr_b16 a[210:211], v246 offset:21504
    v_mfma_f32_32x32x16_bf16 v[160:175], a[192:195], v[36:39], v[160:175]
    ds_read_b64_tr_b16 a[212:213], v246 offset:20736
    ds_read_b64_tr_b16 a[214:215], v246 offset:21760
    v_mfma_f32_32x32x16_bf16 v[112:127], a[196:199], v[32:35], v[112:127]
    ds_read_b64_tr_b16 a[216:217], v246 offset:20992
    ds_read_b64_tr_b16 a[218:219], v246 offset:22016
    v_mfma_f32_32x32x16_bf16 v[176:191], a[196:199], v[36:39], v[176:191]
    ds_read_b64_tr_b16 a[220:221], v246 offset:21248
    ds_read_b64_tr_b16 a[222:223], v246 offset:22272
    v_mfma_f32_32x32x16_bf16 v[128:143], a[200:203], v[32:35], v[128:143]
    buffer_load_dwordx4 v[24:27], v248, s[8:11], s28 offen offset:3072 sc1
    v_mfma_f32_32x32x16_bf16 v[192:207], a[200:203], v[36:39], v[192:207]
    buffer_load_dwordx4 v[28:31], v249, s[8:11], s28 offen offset:3072 sc1
    v_mfma_f32_32x32x16_bf16 v[144:159], a[204:207], v[32:35], v[144:159]
    s_add_u32 m0, s31, 4096
    s_add_u32 s24, s27, 131072
    buffer_load_dwordx4 v245, s[12:15], s24 offen lds
    v_mfma_f32_32x32x16_bf16 v[208:223], a[204:207], v[36:39], v[208:223]
    s_waitcnt vmcnt(21) lgkmcnt(0)
    v_mfma_f32_32x32x16_bf16 v[96:111], a[208:211], v[40:43], v[96:111]
    ds_read_b64_tr_b16 a[192:193], v246 offset:24576
    ds_read_b64_tr_b16 a[194:195], v246 offset:25600
    v_mfma_f32_32x32x16_bf16 v[160:175], a[208:211], v[44:47], v[160:175]
    ds_read_b64_tr_b16 a[196:197], v246 offset:24832
    ds_read_b64_tr_b16 a[198:199], v246 offset:25856
    v_mfma_f32_32x32x16_bf16 v[112:127], a[212:215], v[40:43], v[112:127]
    ds_read_b64_tr_b16 a[200:201], v246 offset:25088
    ds_read_b64_tr_b16 a[202:203], v246 offset:26112
    v_mfma_f32_32x32x16_bf16 v[176:191], a[212:215], v[44:47], v[176:191]
    ds_read_b64_tr_b16 a[204:205], v246 offset:25344
    ds_read_b64_tr_b16 a[206:207], v246 offset:26368
    v_mfma_f32_32x32x16_bf16 v[128:143], a[216:219], v[40:43], v[128:143]
    buffer_load_dwordx4 v[32:35], v248, s[8:11], s29 offen offset:0 sc1
    v_mfma_f32_32x32x16_bf16 v[192:207], a[216:219], v[44:47], v[192:207]
    buffer_load_dwordx4 v[36:39], v249, s[8:11], s29 offen offset:0 sc1
    v_mfma_f32_32x32x16_bf16 v[144:159], a[220:223], v[40:43], v[144:159]
    s_add_u32 m0, s31, 5120
    s_add_u32 s24, s27, 163840
    buffer_load_dwordx4 v245, s[12:15], s24 offen lds
    v_mfma_f32_32x32x16_bf16 v[208:223], a[220:223], v[44:47], v[208:223]
    s_waitcnt vmcnt(20) lgkmcnt(0)
    v_mfma_f32_32x32x16_bf16 v[96:111], a[192:195], v[48:51], v[96:111]
    ds_read_b64_tr_b16 a[208:209], v246 offset:28672
    ds_read_b64_tr_b16 a[210:211], v246 offset:29696
    v_mfma_f32_32x32x16_bf16 v[160:175], a[192:195], v[52:55], v[160:175]
    ds_read_b64_tr_b16 a[212:213], v246 offset:28928
    ds_read_b64_tr_b16 a[214:215], v246 offset:29952
    v_mfma_f32_32x32x16_bf16 v[112:127], a[196:199], v[48:51], v[112:127]
    ds_read_b64_tr_b16 a[216:217], v246 offset:29184
    ds_read_b64_tr_b16 a[218:219], v246 offset:30208
    v_mfma_f32_32x32x16_bf16 v[176:191], a[196:199], v[52:55], v[176:191]
    ds_read_b64_tr_b16 a[220:221], v246 offset:29440
    ds_read_b64_tr_b16 a[222:223], v246 offset:30464
    v_mfma_f32_32x32x16_bf16 v[128:143], a[200:203], v[48:51], v[128:143]
    buffer_load_dwordx4 v[40:43], v248, s[8:11], s29 offen offset:1024 sc1
    v_mfma_f32_32x32x16_bf16 v[192:207], a[200:203], v[52:55], v[192:207]
    buffer_load_dwordx4 v[44:47], v249, s[8:11], s29 offen offset:1024 sc1
    v_mfma_f32_32x32x16_bf16 v[144:159], a[204:207], v[48:51], v[144:159]
    s_add_u32 m0, s31, 6144
    s_add_u32 s24, s27, 196608
    buffer_load_dwordx4 v245, s[12:15], s24 offen lds
    v_mfma_f32_32x32x16_bf16 v[208:223], a[204:207], v[52:55], v[208:223]
    s_cmp_eq_u32 s26, 1
    s_cbranch_scc0 ka_nopk
    s_waitcnt vmcnt(19)
    v_readfirstlane_b32 s24, v254
    s_lshl_b32 s25, s3, 16
    s_add_u32 s24, s24, s25
    s_cmp_ge_u32 s24, 8
    s_cbranch_scc0 ka_spin35
ka_spinr36:
ka_nopk:
    s_waitcnt vmcnt(20) lgkmcnt(0)
    s_barrier
    s_add_u32 s30, s30, 32768
    s_cmp_ge_u32 s30, 163840
    s_cselect_b32 s24, 98304, 0
    s_sub_u32 s30, s30, s24
    v_add_u32 v246, s30, v247
    v_mfma_f32_32x32x16_bf16 v[96:111], a[208:211], v[56:59], v[96:111]
    ds_read_b64_tr_b16 a[192:193], v246 offset:0
    ds_read_b64_tr_b16 a[194:195], v246 offset:1024
    v_mfma_f32_32x32x16_bf16 v[160:175], a[208:211], v[60:63], v[160:175]
    ds_read_b64_tr_b16 a[196:197], v246 offset:256
    ds_read_b64_tr_b16 a[198:199], v246 offset:1280
    v_mfma_f32_32x32x16_bf16 v[112:127], a[212:215], v[56:59], v[112:127]
    ds_read_b64_tr_b16 a[200:201], v246 offset:512
    ds_read_b64_tr_b16 a[202:203], v246 offset:1536
    v_mfma_f32_32x32x16_bf16 v[176:191], a[212:215], v[60:63], v[176:191]
    ds_read_b64_tr_b16 a[204:205], v246 offset:768
    ds_read_b64_tr_b16 a[206:207], v246 offset:1792
    buffer_atomic_add v255, v250, s[88:91], s97 offen sc1
    s_mov_b32 s97, s43
    v_mfma_f32_32x32x16_bf16 v[128:143], a[216:219], v[56:59], v[128:143]
    buffer_load_dwordx4 v[48:51], v248, s[8:11], s29 offen offset:2048 sc1
    v_mfma_f32_32x32x16_bf16 v[192:207], a[216:219], v[60:63], v[192:207]
    buffer_load_dwordx4 v[52:55], v249, s[8:11], s29 offen offset:2048 sc1
    v_mfma_f32_32x32x16_bf16 v[144:159], a[220:223], v[56:59], v[144:159]
    s_add_u32 m0, s31, 7168
    s_add_u32 s24, s27, 229376
    buffer_load_dwordx4 v245, s[12:15], s24 offen lds
    v_mfma_f32_32x32x16_bf16 v[208:223], a[220:223], v[60:63], v[208:223]
    buffer_load_dwordx4 v[56:59], v248, s[8:11], s29 offen offset:3072 sc1
    buffer_load_dwordx4 v[60:63], v249, s[8:11], s29 offen offset:3072 sc1
    s_add_u32 s28, s28, 8192
    s_and_b32 s28, s28, 65535
    s_add_u32 s29, s28, 4096
    s_add_u32 s27, s27, 1048576
    s_and_b32 s27, s27, 0x407fffff
    s_cmp_eq_u32 s27, s7
    s_cselect_b32 s27, s43, s27
    s_add_u32 s31, s31, 32768
    s_cmp_ge_u32 s31, 163840
    s_cselect_b32 s24, 98304, 0
    s_sub_u32 s31, s31, s24
    s_sub_u32 s26, s26, 1
    s_cmp_lg_u32 s26, 0
    s_cbranch_scc1 ka_qp
    s_waitcnt vmcnt(22) lgkmcnt(0)
    v_mfma_f32_32x32x16_bf16 v[96:111], a[192:195], v[0:3], v[96:111]
    ds_read_b64_tr_b16 a[208:209], v246 offset:4096
    ds_read_b64_tr_b16 a[210:211], v246 offset:5120
    v_mfma_f32_32x32x16_bf16 v[160:175], a[192:195], v[4:7], v[160:175]
    ds_read_b64_tr_b16 a[212:213], v246 offset:4352
    ds_read_b64_tr_b16 a[214:215], v246 offset:5376
    s_cmp_lt_u32 s32, s33
    s_cselect_b32 s41, s32, s43
    s_mov_b32 m0, s34
    s_nop 0
    v_mfma_f32_32x32x16_bf16 v[112:127], a[196:199], v[0:3], v[112:127]
    ds_read_b64_tr_b16 a[216:217], v246 offset:4608
    ds_read_b64_tr_b16 a[218:219], v246 offset:5632
    buffer_load_dwordx4 v242, s[16:19], s41 offen offset:0 sc1 lds
    v_mfma_f32_32x32x16_bf16 v[176:191], a[196:199], v[4:7], v[176:191]
    ds_read_b64_tr_b16 a[220:221], v246 offset:4864
    ds_read_b64_tr_b16 a[222:223], v246 offset:5888
    buffer_load_dwordx4 v242, s[16:19], s41 offen offset:1024 sc1 lds
    v_mfma_f32_32x32x16_bf16 v[128:143], a[200:203], v[0:3], v[128:143]
    v_mfma_f32_32x32x16_bf16 v[192:207], a[200:203], v[4:7], v[192:207]
    buffer_load_dwordx4 v242, s[16:19], s41 offen offset:2048 sc1 lds
    v_mfma_f32_32x32x16_bf16 v[144:159], a[204:207], v[0:3], v[144:159]
    buffer_load_dwordx4 v242, s[16:19], s41 offen offset:3072 sc1 lds
    v_mfma_f32_32x32x16_bf16 v[208:223], a[204:207], v[4:7], v[208:223]
    s_waitcnt vmcnt(23) lgkmcnt(0)
    v_mfma_f32_32x32x16_bf16 v[96:111], a[208:211], v[8:11], v[96:111]
    ds_read_b64_tr_b16 a[192:193], v246 offset:8192
    ds_read_b64_tr_b16 a[194:195], v246 offset:9216
    s_add_u32 s32, s32, 32768
    s_add_u32 s34, s34, 32768
    s_cmp_ge_u32 s34, 163840
    s_cselect_b32 s24, 163840, 0
    s_sub_u32 s34, s34, s24
    v_mfma_f32_32x32x16_bf16 v[160:175], a[208:211], v[12:15], v[160:175]
    ds_read_b64_tr_b16 a[196:197], v246 offset:8448
    ds_read_b64_tr_b16 a[198:199], v246 offset:9472
    s_cmp_lt_u32 s32, s33
    s_cselect_b32 s41, s32, s43
    s_mov_b32 m0, s34
    s_nop 0
    v_mfma_f32_32x32x16_bf16 v[112:127], a[212:215], v[8:11], v[112:127]
    ds_read_b64_tr_b16 a[200:201], v246 offset:8704
    ds_read_b64_tr_b16 a[202:203], v246 offset:9728
    v_mfma_f32_32x32x16_bf16 v[176:191], a[212:215], v[12:15], v[176:191]
    ds_read_b64_tr_b16 a[204:205], v246 offset:8960
    ds_read_b64_tr_b16 a[206:207], v246 offset:9984
    buffer_load_dwordx4 v242, s[16:19], s41 offen offset:0 sc1 lds
    v_mfma_f32_32x32x16_bf16 v[128:143], a[216:219], v[8:11], v[128:143]
    buffer_load_dwordx4 v242, s[16:19], s41 offen offset:1024 sc1 lds
    v_mfma_f32_32x32x16_bf16 v[192:207], a[216:219], v[12:15], v[192:207]
    buffer_load_dwordx4 v242, s[16:19], s41 offen offset:2048 sc1 lds
    v_mfma_f32_32x32x16_bf16 v[144:159], a[220:223], v[8:11], v[144:159]
    v_mfma_f32_32x32x16_bf16 v[208:223], a[220:223], v[12:15], v[208:223]
    buffer_load_dwordx4 v242, s[16:19], s41 offen offset:3072 sc1 lds
    s_waitcnt vmcnt(24) lgkmcnt(0)
    v_mfma_f32_32x32x16_bf16 v[96:111], a[192:195], v[16:19], v[96:111]
    ds_read_b64_tr_b16 a[208:209], v246 offset:12288
    ds_read_b64_tr_b16 a[210:211], v246 offset:13312
    s_sub_u32 s42, s32, 16384
    s_cmp_lt_u32 s42, s33
    s_cselect_b32 s42, s42, s43
    s_add_u32 m0, s34, 16384
    s_nop 0
    v_mfma_f32_32x32x16_bf16 v[160:175], a[192:195], v[20:23], v[160:175]
    ds_read_b64_tr_b16 a[212:213], v246 offset:12544
    ds_read_b64_tr_b16 a[214:215], v246 offset:13568
    v_mfma_f32_32x32x16_bf16 v[112:127], a[196:199], v[16:19], v[112:127]
    ds_read_b64_tr_b16 a[216:217], v246 offset:12800
    ds_read_b64_tr_b16 a[218:219], v246 offset:13824
    buffer_load_dwordx4 v242, s[16:19], s42 offen offset:0 sc1 lds
    v_mfma_f32_32x32x16_bf16 v[176:191], a[196:199], v[20:23], v[176:191]
    ds_read_b64_tr_b16 a[220:221], v246 offset:13056
    ds_read_b64_tr_b16 a[222:223], v246 offset:14080
    buffer_load_dwordx4 v242, s[16:19], s42 offen offset:1024 sc1 lds
    v_mfma_f32_32x32x16_bf16 v[128:143], a[200:203], v[16:19], v[128:143]
    v_mfma_f32_32x32x16_bf16 v[192:207], a[200:203], v[20:23], v[192:207]
    buffer_load_dwordx4 v242, s[16:19], s42 offen offset:2048 sc1 lds
    v_mfma_f32_32x32x16_bf16 v[144:159], a[204:207], v[16:19], v[144:159]
    buffer_load_dwordx4 v242, s[16:19], s42 offen offset:3072 sc1 lds
    v_mfma_f32_32x32x16_bf16 v[208:223], a[204:207], v[20:23], v[208:223]
    s_add_u32 s32, s32, 32768
    s_add_u32 s34, s34, 32768
    s_cmp_ge_u32 s34, 163840
    s_cselect_b32 s24, 163840, 0
    s_sub_u32 s34, s34, s24
    s_waitcnt vmcnt(25) lgkmcnt(0)
    v_mfma_f32_32x32x16_bf16 v[96:111], a[208:211], v[24:27], v[96:111]
    ds_read_b64_tr_b16 a[192:193], v246 offset:16384
    ds_read_b64_tr_b16 a[194:195], v246 offset:17408
    v_mfma_f32_32x32x16_bf16 v[160:175], a[208:211], v[28:31], v[160:175]
    ds_read_b64_tr_b16 a[196:197], v246 offset:16640
    ds_read_b64_tr_b16 a[198:199], v246 offset:17664
    s_cmp_lt_u32 s32, s33
    s_cselect_b32 s41, s32, s43
    s_mov_b32 m0, s34
    s_nop 0
    v_mfma_f32_32x32x16_bf16 v[112:127], a[212:215], v[24:27], v[112:127]
    ds_read_b64_tr_b16 a[200:201], v246 offset:16896
    ds_read_b64_tr_b16 a[202:203], v246 offset:17920
    buffer_load_dwordx4 v242, s[16:19], s41 offen offset:0 sc1 lds
    v_mfma_f32_32x32x16_bf16 v[176:191], a[212:215], v[28:31], v[176:191]
    ds_read_b64_tr_b16 a[204:205], v246 offset:17152
    ds_read_b64_tr_b16 a[206:207], v246 offset:18176
    v_mfma_f32_32x32x16_bf16 v[128:143], a[216:219], v[24:27], v[128:143]
    buffer_load_dwordx4 v242, s[16:19], s41 offen offset:1024 sc1 lds
    v_mfma_f32_32x32x16_bf16 v[192:207], a[216:219], v[28:31], v[192:207]
    buffer_load_dwordx4 v242, s[16:19], s41 offen offset:2048 sc1 lds
    v_mfma_f32_32x32x16_bf16 v[144:159], a[220:223], v[24:27], v[144:159]
    v_mov_b32 v241, v239
    v_mov_b32 v64, 0
    v_mfma_f32_32x32x16_bf16 v[208:223], a[220:223], v[28:31], v[208:223]
    buffer_load_dwordx4 v242, s[16:19], s41 offen offset:3072 sc1 lds
    v_mov_b32 v65, 0
    s_waitcnt vmcnt(26) lgkmcnt(0)
    v_mfma_f32_32x32x16_bf16 v[96:111], a[192:195], v[32:35], v[96:111]
    ds_read_b64_tr_b16 a[208:209], v246 offset:20480
    ds_read_b64_tr_b16 a[210:211], v246 offset:21504
    s_sub_u32 s42, s32, 16384
    s_cmp_lt_u32 s42, s33
    s_cselect_b32 s42, s42, s43
    s_add_u32 m0, s34, 16384
    s_nop 0
    v_mfma_f32_32x32x16_bf16 v[160:175], a[192:195], v[36:39], v[160:175]
    ds_read_b64_tr_b16 a[212:213], v246 offset:20736
    ds_read_b64_tr_b16 a[214:215], v246 offset:21760
    buffer_load_dwordx4 v242, s[16:19], s42 offen offset:0 sc1 lds
    v_mov_b32 v66, 0
    v_mfma_f32_32x32x16_bf16 v[112:127], a[196:199], v[32:35], v[112:127]
    ds_read_b64_tr_b16 a[216:217], v246 offset:20992
    ds_read_b64_tr_b16 a[218:219], v246 offset:22016
    v_mov_b32 v67, 0
    v_mov_b32 v68, 0
    v_mfma_f32_32x32x16_bf16 v[176:191], a[196:199], v[36:39], v[176:191]
    ds_read_b64_tr_b16 a[220:221], v246 offset:21248
    ds_read_b64_tr_b16 a[222:223], v246 offset:22272
    buffer_load_dwordx4 v242, s[16:19], s42 offen offset:1024 sc1 lds
    v_mov_b32 v69, 0
    v_mfma_f32_32x32x16_bf16 v[128:143], a[200:203], v[32:35], v[128:143]
    buffer_load_dwordx4 v242, s[16:19], s42 offen offset:2048 sc1 lds
    v_mov_b32 v70, 0
    v_mfma_f32_32x32x16_bf16 v[192:207], a[200:203], v[36:39], v[192:207]
    v_mov_b32 v71, 0
    v_mov_b32 v72, 0
    v_mov_b32 v73, 0
    v_mfma_f32_32x32x16_bf16 v[144:159], a[204:207], v[32:35], v[144:159]
    buffer_load_dwordx4 v242, s[16:19], s42 offen offset:3072 sc1 lds
    v_mov_b32 v74, 0
    v_mfma_f32_32x32x16_bf16 v[208:223], a[204:207], v[36:39], v[208:223]
    s_add_u32 s32, s32, 32768
    s_add_u32 s34, s34, 32768
    s_cmp_ge_u32 s34, 163840
    s_cselect_b32 s24, 163840, 0
    s_sub_u32 s34, s34, s24
    s_waitcnt vmcnt(27) lgkmcnt(0)
    v_mfma_f32_32x32x16_bf16 v[96:111], a[208:211], v[40:43], v[96:111]
    ds_read_b64_tr_b16 a[192:193], v246 offset:24576
    ds_read_b64_tr_b16 a[194:195], v246 offset:25600
    v_mov_b32 v75, 0
    v_mov_b32 v76, 0
    v_mfma_f32_32x32x16_bf16 v[160:175], a[208:211], v[44:47], v[160:175]
    ds_read_b64_tr_b16 a[196:197], v246 offset:24832
    ds_read_b64_tr_b16 a[198:199], v246 offset:25856
    v_mov_b32 v77, 0
    v_mfma_f32_32x32x16_bf16 v[112:127], a[212:215], v[40:43], v[112:127]
    ds_read_b64_tr_b16 a[200:201], v246 offset:25088
    ds_read_b64_tr_b16 a[202:203], v246 offset:26112
    v_mov_b32 v78, 0
    v_mfma_f32_32x32x16_bf16 v[176:191], a[212:215], v[44:47], v[176:191]
    ds_read_b64_tr_b16 a[204:205], v246 offset:25344
    ds_read_b64_tr_b16 a[206:207], v246 offset:26368
    v_mov_b32 v79, 0
    v_mov_b32 v228, 0
    v_mfma_f32_32x32x16_bf16 v[128:143], a[216:219], v[40:43], v[128:143]
    v_mov_b32 v226, 0
    v_mov_b32 v80, 0
    v_mfma_f32_32x32x16_bf16 v[192:207], a[216:219], v[44:47], v[192:207]
    v_mov_b32 v81, 0
    v_mov_b32 v82, 0
    v_mfma_f32_32x32x16_bf16 v[144:159], a[220:223], v[40:43], v[144:159]
    v_mov_b32 v83, 0
    v_mov_b32 v84, 0
    v_mfma_f32_32x32x16_bf16 v[208:223], a[220:223], v[44:47], v[208:223]
    v_mov_b32 v85, 0
    s_waitcnt vmcnt(23) lgkmcnt(0)
    v_mfma_f32_32x32x16_bf16 v[96:111], a[192:195], v[48:51], v[96:111]
    ds_read_b64_tr_b16 a[208:209], v246 offset:28672
    ds_read_b64_tr_b16 a[210:211], v246 offset:29696
    v_mov_b32 v86, 0
    v_mov_b32 v87, 0
    v_mfma_f32_32x32x16_bf16 v[160:175], a[192:195], v[52:55], v[160:175]
    ds_read_b64_tr_b16 a[212:213], v246 offset:28928
    ds_read_b64_tr_b16 a[214:215], v246 offset:29952
    v_mov_b32 v88, 0
    v_mfma_f32_32x32x16_bf16 v[112:127], a[196:199], v[48:51], v[112:127]
    ds_read_b64_tr_b16 a[216:217], v246 offset:29184
    ds_read_b64_tr_b16 a[218:219], v246 offset:30208
    v_mov_b32 v89, 0
    v_mov_b32 v90, 0
    v_mfma_f32_32x32x16_bf16 v[176:191], a[196:199], v[52:55], v[176:191]
    ds_read_b64_tr_b16 a[220:221], v246 offset:29440
    ds_read_b64_tr_b16 a[222:223], v246 offset:30464
    v_mov_b32 v91, 0
    v_mfma_f32_32x32x16_bf16 v[128:143], a[200:203], v[48:51], v[128:143]
    v_mov_b32 v92, 0
    v_mov_b32 v93, 0
    v_mfma_f32_32x32x16_bf16 v[192:207], a[200:203], v[52:55], v[192:207]
    v_mov_b32 v94, 0
    v_mov_b32 v95, 0
    v_mfma_f32_32x32x16_bf16 v[144:159], a[204:207], v[48:51], v[144:159]
    v_mov_b32 v229, 0
    v_mov_b32 v227, 0
    v_mfma_f32_32x32x16_bf16 v[208:223], a[204:207], v[52:55], v[208:223]
    s_waitcnt vmcnt(8) lgkmcnt(0)
    s_barrier
    v_mfma_f32_32x32x16_bf16 v[96:111], a[208:211], v[56:59], v[96:111]
    ds_read_b128 a[192:195], v241 offset:0
    ds_read_b128 a[196:199], v241 offset:512
    s_cmp_lt_u32 s32, s33
    s_cselect_b32 s41, s32, s43
    s_mov_b32 m0, s34
    s_nop 0
    buffer_load_dwordx4 v242, s[16:19], s41 offen offset:0 sc1 lds
    v_mfma_f32_32x32x16_bf16 v[160:175], a[208:211], v[60:63], v[160:175]
    ds_read_b128 a[200:203], v241 offset:2048
    ds_read_b128 a[204:207], v241 offset:2560
    buffer_load_dwordx4 v242, s[16:19], s41 offen offset:1024 sc1 lds
    v_mfma_f32_32x32x16_bf16 v[112:127], a[212:215], v[56:59], v[112:127]
    ds_read_b128 a[224:227], v241 offset:8192
    ds_read_b128 a[228:231], v241 offset:8704
    buffer_load_dwordx4 v242, s[16:19], s41 offen offset:2048 sc1 lds
    buffer_load_dwordx4 v242, s[16:19], s41 offen offset:3072 sc1 lds
    v_mfma_f32_32x32x16_bf16 v[176:191], a[212:215], v[60:63], v[176:191]
    ds_read_b128 a[232:235], v241 offset:10240
    ds_read_b128 a[236:239], v241 offset:10752
    s_sub_u32 s42, s32, 16384
    s_cmp_lt_u32 s42, s33
    s_cselect_b32 s42, s42, s43
    s_add_u32 m0, s34, 16384
    s_nop 0
    v_mfma_f32_32x32x16_bf16 v[128:143], a[216:219], v[56:59], v[128:143]
    ds_read_b128 a[240:243], v241 offset:12288
    ds_read_b128 a[244:247], v241 offset:12800
    buffer_load_dwordx4 v242, s[16:19], s42 offen offset:0 sc1 lds
    v_mfma_f32_32x32x16_bf16 v[192:207], a[216:219], v[60:63], v[192:207]
    ds_read_b128 a[248:251], v241 offset:14336
    ds_read_b128 a[252:255], v241 offset:14848
    buffer_load_dwordx4 v242, s[16:19], s42 offen offset:1024 sc1 lds
    buffer_load_dwordx4 v242, s[16:19], s42 offen offset:2048 sc1 lds
    v_mfma_f32_32x32x16_bf16 v[144:159], a[220:223], v[56:59], v[144:159]
    buffer_load_dwordx4 v242, s[16:19], s42 offen offset:3072 sc1 lds
    v_mfma_f32_32x32x16_bf16 v[208:223], a[220:223], v[60:63], v[208:223]
    s_add_u32 s32, s32, 32768
    s_add_u32 s34, s34, 32768
    s_cmp_ge_u32 s34, 163840
    s_cselect_b32 s24, 163840, 0
    s_sub_u32 s34, s34, s24
    s_mov_b32 s25, 0x3e0293ee
    s_waitcnt lgkmcnt(8)
    ds_read_b128 a[208:211], v241 offset:4096
    ds_read_b128 a[212:215], v241 offset:4608
    ds_read_b128 a[216:219], v241 offset:6144
    ds_read_b128 a[220:223], v241 offset:6656
    s_add_u32 s36, s36, 1
    s_cmp_le_u32 s36, 1
    s_cbranch_scc1 ka_fix1
ka_fixr2:
    v_mul_f32 v96, s25, v96
    v_mul_f32 v97, s25, v97
    v_mul_f32 v98, s25, v98
    v_mul_f32 v99, s25, v99
    v_mul_f32 v100, s25, v100
    v_mul_f32 v101, s25, v101
    v_mul_f32 v102, s25, v102
    v_mul_f32 v103, s25, v103
    v_mul_f32 v104, s25, v104
    v_mul_f32 v105, s25, v105
    v_mul_f32 v106, s25, v106
    v_mul_f32 v107, s25, v107
    v_mul_f32 v108, s25, v108
    v_mul_f32 v109, s25, v109
    v_mul_f32 v110, s25, v110
    v_mul_f32 v111, s25, v111
    v_cvt_pk_bf16_f32 v96, v96, v97
    v_cvt_pk_bf16_f32 v97, v98, v99
    v_cvt_pk_bf16_f32 v98, v100, v101
    v_cvt_pk_bf16_f32 v99, v102, v103
    v_cvt_pk_bf16_f32 v100, v104, v105
    v_cvt_pk_bf16_f32 v101, v106, v107
    v_cvt_pk_bf16_f32 v102, v108, v109
    v_cvt_pk_bf16_f32 v103, v110, v111
    v_accvgpr_write_b32 a128, v96
    v_accvgpr_write_b32 a129, v97
    v_accvgpr_write_b32 a130, v98
    v_accvgpr_write_b32 a131, v99
    v_accvgpr_write_b32 a132, v100
    v_accvgpr_write_b32 a133, v101
    v_accvgpr_write_b32 a134, v102
    v_accvgpr_write_b32 a135, v103
    v_mul_f32 v160, s25, v160
    v_mul_f32 v161, s25, v161
    v_mul_f32 v162, s25, v162
    v_mul_f32 v163, s25, v163
    v_mul_f32 v164, s25, v164
    v_mul_f32 v165, s25, v165
    v_mul_f32 v166, s25, v166
    v_mul_f32 v167, s25, v167
    v_mul_f32 v168, s25, v168
    v_mul_f32 v169, s25, v169
    v_mul_f32 v170, s25, v170
    v_mul_f32 v171, s25, v171
    v_mul_f32 v172, s25, v172
    v_mul_f32 v173, s25, v173
    v_mul_f32 v174, s25, v174
    v_mul_f32 v175, s25, v175
    v_cvt_pk_bf16_f32 v160, v160, v161
    v_cvt_pk_bf16_f32 v161, v162, v163
    v_cvt_pk_bf16_f32 v162, v164, v165
    v_cvt_pk_bf16_f32 v163, v166, v167
    v_cvt_pk_bf16_f32 v164, v168, v169
    v_cvt_pk_bf16_f32 v165, v170, v171
    v_cvt_pk_bf16_f32 v166, v172, v173
    v_cvt_pk_bf16_f32 v167, v174, v175
    v_accvgpr_write_b32 a160, v160
    v_accvgpr_write_b32 a161, v161
    v_accvgpr_write_b32 a162, v162
    v_accvgpr_write_b32 a163, v163
    v_accvgpr_write_b32 a164, v164
    v_accvgpr_write_b32 a165, v165
    v_accvgpr_write_b32 a166, v166
    v_accvgpr_write_b32 a167, v167
    s_nop 1
    v_mfma_f32_32x32x16_bf16 v[0:15], a[192:195], a[128:131], v[64:79]
    v_mul_f32 v112, s25, v112
    v_mul_f32 v113, s25, v113
    v_mul_f32 v114, s25, v114
    v_mul_f32 v115, s25, v115
    v_mul_f32 v116, s25, v116
    v_mul_f32 v117, s25, v117
    v_mfma_f32_32x32x16_bf16 v[16:31], a[192:195], a[160:163], v[80:95]
    v_mul_f32 v118, s25, v118
    v_mul_f32 v119, s25, v119
    v_mul_f32 v120, s25, v120
    v_mul_f32 v121, s25, v121
    v_mul_f32 v122, s25, v122
    v_mul_f32 v123, s25, v123
    v_mfma_f32_32x32x16_bf16 v[0:15], a[196:199], a[132:135], v[0:15]
    v_mul_f32 v124, s25, v124
    v_mul_f32 v125, s25, v125
    v_mul_f32 v126, s25, v126
    v_mul_f32 v127, s25, v127
    v_cvt_pk_bf16_f32 v112, v112, v113
    v_cvt_pk_bf16_f32 v113, v114, v115
    v_mfma_f32_32x32x16_bf16 v[16:31], a[196:199], a[164:167], v[16:31]
    v_cvt_pk_bf16_f32 v114, v116, v117
    v_cvt_pk_bf16_f32 v115, v118, v119
    v_cvt_pk_bf16_f32 v116, v120, v121
    v_cvt_pk_bf16_f32 v117, v122, v123
    v_cvt_pk_bf16_f32 v118, v124, v125
    v_cvt_pk_bf16_f32 v119, v126, v127
    v_accvgpr_write_b32 a136, v112
    v_accvgpr_write_b32 a137, v113
    v_accvgpr_write_b32 a138, v114
    v_accvgpr_write_b32 a139, v115
    v_accvgpr_write_b32 a140, v116
    v_accvgpr_write_b32 a141, v117
    v_accvgpr_write_b32 a142, v118
    v_accvgpr_write_b32 a143, v119
    v_mul_f32 v176, s25, v176
    v_mul_f32 v177, s25, v177
    v_mul_f32 v178, s25, v178
    v_mul_f32 v179, s25, v179
    v_mul_f32 v180, s25, v180
    v_mul_f32 v181, s25, v181
    v_mul_f32 v182, s25, v182
    v_mul_f32 v183, s25, v183
    v_mul_f32 v184, s25, v184
    v_mul_f32 v185, s25, v185
    v_mul_f32 v186, s25, v186
    v_mul_f32 v187, s25, v187
    v_mul_f32 v188, s25, v188
    v_mul_f32 v189, s25, v189
    v_mul_f32 v190, s25, v190
    v_mul_f32 v191, s25, v191
    v_cvt_pk_bf16_f32 v176, v176, v177
    v_cvt_pk_bf16_f32 v177, v178, v179
    v_cvt_pk_bf16_f32 v178, v180, v181
    v_cvt_pk_bf16_f32 v179, v182, v183
    v_cvt_pk_bf16_f32 v180, v184, v185
    v_cvt_pk_bf16_f32 v181, v186, v187
    v_cvt_pk_bf16_f32 v182, v188, v189
    v_cvt_pk_bf16_f32 v183, v190, v191
    v_accvgpr_write_b32 a168, v176
    v_accvgpr_write_b32 a169, v177
    v_accvgpr_write_b32 a170, v178
    v_accvgpr_write_b32 a171, v179
    v_accvgpr_write_b32 a172, v180
    v_accvgpr_write_b32 a173, v181
    v_accvgpr_write_b32 a174, v182
    v_accvgpr_write_b32 a175, v183
    s_nop 1
    v_mfma_f32_32x32x16_bf16 v[0:15], a[200:203], a[136:139], v[0:15]
    v_mul_f32 v128, s25, v128
    v_mul_f32 v129, s25, v129
    v_mul_f32 v130, s25, v130
    v_mul_f32 v131, s25, v131
    v_mul_f32 v132, s25, v132
    v_mul_f32 v133, s25, v133
    v_mfma_f32_32x32x16_bf16 v[16:31], a[200:203], a[168:171], v[16:31]
    v_mul_f32 v134, s25, v134
    v_mul_f32 v135, s25, v135
    v_mul_f32 v136, s25, v136
    v_mul_f32 v137, s25, v137
    v_mul_f32 v138, s25, v138
    v_mul_f32 v139, s25, v139
    v_mfma_f32_32x32x16_bf16 v[0:15], a[204:207], a[140:143], v[0:15]
    v_mul_f32 v140, s25, v140
    v_mul_f32 v141, s25, v141
    v_mul_f32 v142, s25, v142
    v_mul_f32 v143, s25, v143
    v_cvt_pk_bf16_f32 v128, v128, v129
    v_cvt_pk_bf16_f32 v129, v130, v131
    v_mfma_f32_32x32x16_bf16 v[16:31], a[204:207], a[172:175], v[16:31]
    v_cvt_pk_bf16_f32 v130, v132, v133
    v_cvt_pk_bf16_f32 v131, v134, v135
    v_cvt_pk_bf16_f32 v132, v136, v137
    v_cvt_pk_bf16_f32 v133, v138, v139
    v_cvt_pk_bf16_f32 v134, v140, v141
    v_cvt_pk_bf16_f32 v135, v142, v143
    v_accvgpr_write_b32 a144, v128
    v_accvgpr_write_b32 a145, v129
    v_accvgpr_write_b32 a146, v130
    v_accvgpr_write_b32 a147, v131
    v_accvgpr_write_b32 a148, v132
    v_accvgpr_write_b32 a149, v133
    v_accvgpr_write_b32 a150, v134
    v_accvgpr_write_b32 a151, v135
    v_mul_f32 v192, s25, v192
    v_mul_f32 v193, s25, v193
    v_mul_f32 v194, s25, v194
    v_mul_f32 v195, s25, v195
    v_mul_f32 v196, s25, v196
    v_mul_f32 v197, s25, v197
    v_mul_f32 v198, s25, v198
    v_mul_f32 v199, s25, v199
    v_mul_f32 v200, s25, v200
    v_mul_f32 v201, s25, v201
    v_mul_f32 v202, s25, v202
    v_mul_f32 v203, s25, v203
    v_mul_f32 v204, s25, v204
    v_mul_f32 v205, s25, v205
    v_mul_f32 v206, s25, v206
    v_mul_f32 v207, s25, v207
    v_cvt_pk_bf16_f32 v192, v192, v193
    v_cvt_pk_bf16_f32 v193, v194, v195
    v_cvt_pk_bf16_f32 v194, v196, v197
    v_cvt_pk_bf16_f32 v195, v198, v199
    v_cvt_pk_bf16_f32 v196, v200, v201
    v_cvt_pk_bf16_f32 v197, v202, v203
    v_cvt_pk_bf16_f32 v198, v204, v205
    v_cvt_pk_bf16_f32 v199, v206, v207
    v_accvgpr_write_b32 a176, v192
    v_accvgpr_write_b32 a177, v193
    v_accvgpr_write_b32 a178, v194
    v_accvgpr_write_b32 a179, v195
    v_accvgpr_write_b32 a180, v196
    v_accvgpr_write_b32 a181, v197
    v_accvgpr_write_b32 a182, v198
    v_accvgpr_write_b32 a183, v199
    s_nop 1
    s_waitcnt lgkmcnt(0)
    v_mfma_f32_32x32x16_bf16 v[0:15], a[208:211], a[144:147], v[0:15]
    v_mul_f32 v144, s25, v144
    v_mul_f32 v145, s25, v145
    v_mul_f32 v146, s25, v146
    v_mul_f32 v147, s25, v147
    v_mul_f32 v148, s25, v148
    v_mul_f32 v149, s25, v149
    v_mfma_f32_32x32x16_bf16 v[16:31], a[208:211], a[176:179], v[16:31]
    v_mul_f32 v150, s25, v150
    v_mul_f32 v151, s25, v151
    v_mul_f32 v152, s25, v152
    v_mul_f32 v153, s25, v153
    v_mul_f32 v154, s25, v154
    v_mul_f32 v155, s25, v155
    v_mfma_f32_32x32x16_bf16 v[0:15], a[212:215], a[148:151], v[0:15]
    v_mul_f32 v156, s25, v156
    v_mul_f32 v157, s25, v157
    v_mul_f32 v158, s25, v158
    v_mul_f32 v159, s25, v159
    v_cvt_pk_bf16_f32 v144, v144, v145
    v_cvt_pk_bf16_f32 v145, v146, v147
    v_mfma_f32_32x32x16_bf16 v[16:31], a[212:215], a[180:183], v[16:31]
    v_cvt_pk_bf16_f32 v146, v148, v149
    v_cvt_pk_bf16_f32 v147, v150, v151
    v_cvt_pk_bf16_f32 v148, v152, v153
    v_cvt_pk_bf16_f32 v149, v154, v155
    v_cvt_pk_bf16_f32 v150, v156, v157
    v_cvt_pk_bf16_f32 v151, v158, v159
    v_accvgpr_write_b32 a152, v144
    v_accvgpr_write_b32 a153, v145
    v_accvgpr_write_b32 a154, v146
    v_accvgpr_write_b32 a155, v147
    v_accvgpr_write_b32 a156, v148
    v_accvgpr_write_b32 a157, v149
    v_accvgpr_write_b32 a158, v150
    v_accvgpr_write_b32 a159, v151
    v_mul_f32 v208, s25, v208
    v_mul_f32 v209, s25, v209
    v_mul_f32 v210, s25, v210
    v_mul_f32 v211, s25, v211
    v_mul_f32 v212, s25, v212
    v_mul_f32 v213, s25, v213
    v_mul_f32 v214, s25, v214
    v_mul_f32 v215, s25, v215
    v_mul_f32 v216, s25, v216
    v_mul_f32 v217, s25, v217
    v_mul_f32 v218, s25, v218
    v_mul_f32 v219, s25, v219
    v_mul_f32 v220, s25, v220
    v_mul_f32 v221, s25, v221
    v_mul_f32 v222, s25, v222
    v_mul_f32 v223, s25, v223
    v_cvt_pk_bf16_f32 v208, v208, v209
    v_cvt_pk_bf16_f32 v209, v210, v211
    v_cvt_pk_bf16_f32 v210, v212, v213
    v_cvt_pk_bf16_f32 v211, v214, v215
    v_cvt_pk_bf16_f32 v212, v216, v217
    v_cvt_pk_bf16_f32 v213, v218, v219
    v_cvt_pk_bf16_f32 v214, v220, v221
    v_cvt_pk_bf16_f32 v215, v222, v223
    v_accvgpr_write_b32 a184, v208
    v_accvgpr_write_b32 a185, v209
    v_accvgpr_write_b32 a186, v210
    v_accvgpr_write_b32 a187, v211
    v_accvgpr_write_b32 a188, v212
    v_accvgpr_write_b32 a189, v213
    v_accvgpr_write_b32 a190, v214
    v_accvgpr_write_b32 a191, v215
    s_nop 1
    v_mfma_f32_32x32x16_bf16 v[0:15], a[216:219], a[152:155], v[0:15]
    v_mfma_f32_32x32x16_bf16 v[16:31], a[216:219], a[184:187], v[16:31]
    v_mfma_f32_32x32x16_bf16 v[0:15], a[220:223], a[156:159], v[0:15]
    v_mfma_f32_32x32x16_bf16 v[16:31], a[220:223], a[188:191], v[16:31]
    s_nop 11
    v_max3_f32 v230, v0, v1, v2
    v_max3_f32 v232, v16, v17, v18
    v_max3_f32 v230, v230, v3, v4
    v_max3_f32 v232, v232, v19, v20
    v_max3_f32 v230, v230, v5, v6
    v_max3_f32 v232, v232, v21, v22
    v_max3_f32 v230, v230, v7, v8
    v_max3_f32 v232, v232, v23, v24
    v_max3_f32 v230, v230, v9, v10
    v_max3_f32 v232, v232, v25, v26
    v_max3_f32 v230, v230, v11, v12
    v_max3_f32 v232, v232, v27, v28
    v_max3_f32 v230, v230, v13, v14
    v_max3_f32 v232, v232, v29, v30
    v_max_f32 v230, v230, v15
    v_max_f32 v232, v232, v31
    v_mov_b32 v231, v230
    v_mov_b32 v233, v232
    s_nop 1
    s_nop 1
    v_permlane32_swap_b32 v230, v231
    v_permlane32_swap_b32 v232, v233
    s_nop 0
    s_nop 0
    v_max_f32 v230, v230, v231
    v_max_f32 v232, v232, v233
    v_sub_f32 v228, 0, v230
    v_sub_f32 v64, v64, v230
    v_sub_f32 v65, v65, v230
    v_sub_f32 v66, v66, v230
    v_sub_f32 v67, v67, v230
    v_sub_f32 v68, v68, v230
    v_sub_f32 v69, v69, v230
    v_sub_f32 v70, v70, v230
    v_sub_f32 v71, v71, v230
    v_sub_f32 v72, v72, v230
    v_sub_f32 v73, v73, v230
    v_sub_f32 v74, v74, v230
    v_sub_f32 v75, v75, v230
    v_sub_f32 v76, v76, v230
    v_sub_f32 v77, v77, v230
    v_sub_f32 v78, v78, v230
    v_sub_f32 v79, v79, v230
    v_sub_f32 v229, 0, v232
    v_sub_f32 v80, v80, v232
    v_sub_f32 v81, v81, v232
    v_sub_f32 v82, v82, v232
    v_sub_f32 v83, v83, v232
    v_sub_f32 v84, v84, v232
    v_sub_f32 v85, v85, v232
    v_sub_f32 v86, v86, v232
    v_sub_f32 v87, v87, v232
    v_sub_f32 v88, v88, v232
    v_sub_f32 v89, v89, v232
    v_sub_f32 v90, v90, v232
    v_sub_f32 v91, v91, v232
    v_sub_f32 v92, v92, v232
    v_sub_f32 v93, v93, v232
    v_sub_f32 v94, v94, v232
    v_sub_f32 v95, v95, v232
    v_sub_f32 v0, v0, v230
    v_sub_f32 v1, v1, v230
    v_sub_f32 v2, v2, v230
    v_sub_f32 v3, v3, v230
    v_sub_f32 v4, v4, v230
    v_sub_f32 v5, v5, v230
    v_sub_f32 v6, v6, v230
    v_sub_f32 v7, v7, v230
    v_sub_f32 v8, v8, v230
    v_sub_f32 v9, v9, v230
    v_sub_f32 v10, v10, v230
    v_sub_f32 v11, v11, v230
    v_sub_f32 v12, v12, v230
    v_sub_f32 v13, v13, v230
    v_sub_f32 v14, v14, v230
    v_sub_f32 v15, v15, v230
    v_sub_f32 v16, v16, v232
    v_sub_f32 v17, v17, v232
    v_sub_f32 v18, v18, v232
    v_sub_f32 v19, v19, v232
    v_sub_f32 v20, v20, v232
    v_sub_f32 v21, v21, v232
    v_sub_f32 v22, v22, v232
    v_sub_f32 v23, v23, v232
    v_sub_f32 v24, v24, v232
    v_sub_f32 v25, v25, v232
    v_sub_f32 v26, v26, v232
    v_sub_f32 v27, v27, v232
    v_sub_f32 v28, v28, v232
    v_sub_f32 v29, v29, v232
    v_sub_f32 v30, v30, v232
    v_sub_f32 v31, v31, v232
    s_mov_b32 s35, 32768
    v_add_u32 v241, s35, v239
    s_add_u32 s36, s36, 1
    s_cmp_le_u32 s36, 1
    s_cbranch_scc1 ka_fix3
ka_fixr4:
    v_mfma_f32_32x32x16_bf16 v[32:47], a[224:227], a[128:131], v[64:79]
    ds_read_b128 a[192:195], v241 offset:0
    v_exp_f32 v136, v0
    v_exp_f32 v137, v1
    v_exp_f32 v130, v2
    v_mfma_f32_32x32x16_bf16 v[48:63], a[224:227], a[160:163], v[80:95]
    v_exp_f32 v131, v3
    v_cvt_pk_bf16_f32 v96, v136, v137
    v_exp_f32 v132, v4
    v_exp_f32 v133, v5
    v_cvt_pk_bf16_f32 v97, v130, v131
    v_add_f32 v136, v136, v130
    v_mfma_f32_32x32x16_bf16 v[32:47], a[228:231], a[132:135], v[32:47]
    ds_read_b128 a[196:199], v241 offset:512
    v_add_f32 v137, v137, v131
    v_exp_f32 v134, v6
    v_exp_f32 v135, v7
    v_cvt_pk_bf16_f32 v98, v132, v133
    v_mfma_f32_32x32x16_bf16 v[48:63], a[228:231], a[164:167], v[48:63]
    v_add_f32 v136, v136, v132
    v_add_f32 v137, v137, v133
    v_exp_f32 v128, v8
    v_exp_f32 v129, v9
    v_cvt_pk_bf16_f32 v99, v134, v135
    v_add_f32 v136, v136, v134
    v_add_f32 v137, v137, v135
    v_mfma_f32_32x32x16_bf16 v[32:47], a[232:235], a[136:139], v[32:47]
    ds_read_b128 a[200:203], v241 offset:2048
    v_exp_f32 v130, v10
    v_exp_f32 v131, v11
    v_cvt_pk_bf16_f32 v100, v128, v129
    v_add_f32 v136, v136, v128
    v_mfma_f32_32x32x16_bf16 v[48:63], a[232:235], a[168:171], v[48:63]
    v_add_f32 v137, v137, v129
    v_exp_f32 v132, v12
    v_exp_f32 v133, v13
    v_cvt_pk_bf16_f32 v101, v130, v131
    v_add_f32 v136, v136, v130
    v_add_f32 v137, v137, v131
    v_mfma_f32_32x32x16_bf16 v[32:47], a[236:239], a[140:143], v[32:47]
    ds_read_b128 a[204:207], v241 offset:2560
    v_exp_f32 v134, v14
    v_exp_f32 v135, v15
    v_cvt_pk_bf16_f32 v102, v132, v133
    v_add_f32 v136, v136, v132
    v_add_f32 v137, v137, v133
    v_mfma_f32_32x32x16_bf16 v[48:63], a[236:239], a[172:175], v[48:63]
    v_exp_f32 v138, v16
    v_exp_f32 v139, v17
    v_cvt_pk_bf16_f32 v103, v134, v135
    v_add_f32 v136, v136, v134
    v_add_f32 v137, v137, v135
    v_add_f32 v224, v136, v137
    v_mfma_f32_32x32x16_bf16 v[32:47], a[240:243], a[144:147], v[32:47]
    ds_read_b128 a[208:211], v241 offset:4096
    v_exp_f32 v130, v18
    v_exp_f32 v131, v19
    v_cvt_pk_bf16_f32 v104, v138, v139
    v_exp_f32 v132, v20
    v_mfma_f32_32x32x16_bf16 v[48:63], a[240:243], a[176:179], v[48:63]
    v_exp_f32 v133, v21
    v_cvt_pk_bf16_f32 v105, v130, v131
    v_add_f32 v138, v138, v130
    v_add_f32 v139, v139, v131
    v_exp_f32 v134, v22
    v_mfma_f32_32x32x16_bf16 v[32:47], a[244:247], a[148:151], v[32:47]
    ds_read_b128 a[212:215], v241 offset:4608
    v_exp_f32 v135, v23
    v_cvt_pk_bf16_f32 v106, v132, v133
    v_add_f32 v138, v138, v132
    v_add_f32 v139, v139, v133
    v_exp_f32 v128, v24
    v_mfma_f32_32x32x16_bf16 v[48:63], a[244:247], a[180:183], v[48:63]
    v_exp_f32 v129, v25
    v_cvt_pk_bf16_f32 v107, v134, v135
    v_add_f32 v138, v138, v134
    v_add_f32 v139, v139, v135
    v_exp_f32 v130, v26
    v_exp_f32 v131, v27
    v_mfma_f32_32x32x16_bf16 v[32:47], a[248:251], a[152:155], v[32:47]
    ds_read_b128 a[216:219], v241 offset:6144
    v_cvt_pk_bf16_f32 v108, v128, v129
    v_add_f32 v138, v138, v128
    v_add_f32 v139, v139, v129
    v_exp_f32 v132, v28
    v_exp_f32 v133, v29
    v_mfma_f32_32x32x16_bf16 v[48:63], a[248:251], a[184:187], v[48:63]
    v_cvt_pk_bf16_f32 v109, v130, v131
    v_add_f32 v138, v138, v130
    v_add_f32 v139, v139, v131
    v_exp_f32 v134, v30
    v_exp_f32 v135, v31
    v_mfma_f32_32x32x16_bf16 v[32:47], a[252:255], a[156:159], v[32:47]
    ds_read_b128 a[220:223], v241 offset:6656
    v_cvt_pk_bf16_f32 v110, v132, v133
    v_add_f32 v138, v138, v132
    v_add_f32 v139, v139, v133
    v_cvt_pk_bf16_f32 v111, v134, v135
    v_add_f32 v138, v138, v134
    v_add_f32 v139, v139, v135
    v_add_f32 v225, v138, v139
    v_mfma_f32_32x32x16_bf16 v[48:63], a[252:255], a[188:191], v[48:63]
    s_lshl1_add_u32 s26, s5, 1
.p2align 3
ka_p1:
    s_add_u32 s36, s36, 1
    s_cmp_le_u32 s36, 1
    s_cbranch_scc1 ka_fix5
ka_fixr6:
    s_waitcnt lgkmcnt(6)
    v_mfma_f32_32x32x16_bf16 v[0:15], a[192:195], a[128:131], v[64:79]
    ds_read_b128 a[224:227], v241 offset:16384
    v_add_f32 v226, v226, v224
    v_add_f32 v227, v227, v225
    v_exp_f32 v136, v32
    v_mfma_f32_32x32x16_bf16 v[16:31], a[192:195], a[160:163], v[80:95]
    s_cmp_lt_u32 s32, s33
    s_cselect_b32 s41, s32, s43
    s_mov_b32 m0, s34
    s_nop 0
    v_exp_f32 v137, v33
    v_mfma_f32_32x32x16_bf16 v[0:15], a[196:199], a[132:135], v[0:15]
    ds_read_b128 a[228:231], v241 offset:18432
    v_exp_f32 v130, v34
    v_mfma_f32_32x32x16_bf16 v[16:31], a[196:199], a[164:167], v[16:31]
    v_exp_f32 v131, v35
    v_cvt_pk_bf16_f32 v112, v136, v137
    v_exp_f32 v132, v36
    s_waitcnt lgkmcnt(6)
    v_mfma_f32_32x32x16_bf16 v[0:15], a[200:203], a[136:139], v[0:15]
    ds_read_b128 a[232:235], v241 offset:20480
    v_exp_f32 v133, v37
    v_cvt_pk_bf16_f32 v113, v130, v131
    v_mfma_f32_32x32x16_bf16 v[16:31], a[200:203], a[168:171], v[16:31]
    v_add_f32 v136, v136, v130
    v_add_f32 v137, v137, v131
    v_exp_f32 v134, v38
    v_mfma_f32_32x32x16_bf16 v[0:15], a[204:207], a[140:143], v[0:15]
    ds_read_b128 a[236:239], v241 offset:22528
    v_exp_f32 v135, v39
    v_cvt_pk_bf16_f32 v114, v132, v133
    v_add_f32 v136, v136, v132
    v_mfma_f32_32x32x16_bf16 v[16:31], a[204:207], a[172:175], v[16:31]
    buffer_load_dwordx4 v242, s[16:19], s41 offen offset:0 sc1 lds
    v_add_f32 v137, v137, v133
    v_exp_f32 v128, v40
    s_waitcnt lgkmcnt(6)
    v_mfma_f32_32x32x16_bf16 v[0:15], a[208:211], a[144:147], v[0:15]
    ds_read_b128 a[240:243], v241 offset:16896
    v_exp_f32 v129, v41
    v_cvt_pk_bf16_f32 v115, v134, v135
    v_add_f32 v136, v136, v134
    v_mfma_f32_32x32x16_bf16 v[16:31], a[208:211], a[176:179], v[16:31]
    v_add_f32 v137, v137, v135
    v_exp_f32 v130, v42
    v_exp_f32 v131, v43
    v_mfma_f32_32x32x16_bf16 v[0:15], a[212:215], a[148:151], v[0:15]
    ds_read_b128 a[244:247], v241 offset:18944
    v_cvt_pk_bf16_f32 v116, v128, v129
    v_add_f32 v136, v136, v128
    v_add_f32 v137, v137, v129
    v_mfma_f32_32x32x16_bf16 v[16:31], a[212:215], a[180:183], v[16:31]
    v_exp_f32 v132, v44
    v_exp_f32 v133, v45
    s_waitcnt lgkmcnt(6)
    v_mfma_f32_32x32x16_bf16 v[0:15], a[216:219], a[152:155], v[0:15]
    ds_read_b128 a[248:251], v241 offset:20992
    v_cvt_pk_bf16_f32 v117, v130, v131
    v_add_f32 v136, v136, v130
    v_add_f32 v137, v137, v131
    v_mfma_f32_32x32x16_bf16 v[16:31], a[216:219], a[184:187], v[16:31]
    buffer_load_dwordx4 v242, s[16:19], s41 offen offset:1024 sc1 lds
    v_exp_f32 v134, v46
    v_exp_f32 v135, v47
    v_mfma_f32_32x32x16_bf16 v[0:15], a[220:223], a[156:159], v[0:15]
    ds_read_b128 a[252:255], v241 offset:23040
    v_cvt_pk_bf16_f32 v118, v132, v133
    v_add_f32 v136, v136, v132
    v_add_f32 v137, v137, v133
    v_mfma_f32_32x32x16_bf16 v[16:31], a[220:223], a[188:191], v[16:31]
    v_exp_f32 v138, v48
    v_exp_f32 v139, v49
    s_waitcnt lgkmcnt(6)
    v_mfma_f32_32x32x16_bf16 a[0:15], a[224:227], v[96:99], a[0:15]
    ds_read_b128 a[192:195], v241 offset:8192
    v_cvt_pk_bf16_f32 v119, v134, v135
    v_add_f32 v136, v136, v134
    v_add_f32 v137, v137, v135
    v_add_f32 v224, v136, v137
    v_mfma_f32_32x32x16_bf16 a[64:79], a[224:227], v[104:107], a[64:79]
    v_exp_f32 v130, v50
    v_exp_f32 v131, v51
    v_mfma_f32_32x32x16_bf16 a[16:31], a[228:231], v[96:99], a[16:31]
    ds_read_b128 a[196:199], v241 offset:8704
    v_cvt_pk_bf16_f32 v120, v138, v139
    v_exp_f32 v132, v52
    v_exp_f32 v133, v53
    v_mfma_f32_32x32x16_bf16 a[80:95], a[228:231], v[104:107], a[80:95]
    buffer_load_dwordx4 v242, s[16:19], s41 offen offset:2048 sc1 lds
    v_cvt_pk_bf16_f32 v121, v130, v131
    v_add_f32 v138, v138, v130
    s_waitcnt lgkmcnt(6)
    v_mfma_f32_32x32x16_bf16 a[32:47], a[232:235], v[96:99], a[32:47]
    ds_read_b128 a[200:203], v241 offset:10240
    v_add_f32 v139, v139, v131
    v_exp_f32 v134, v54
    v_mfma_f32_32x32x16_bf16 a[96:111], a[232:235], v[104:107], a[96:111]
    v_exp_f32 v135, v55
    v_cvt_pk_bf16_f32 v122, v132, v133
    v_add_f32 v138, v138, v132
    v_add_f32 v139, v139, v133
    v_mfma_f32_32x32x16_bf16 a[48:63], a[236:239], v[96:99], a[48:63]
    ds_read_b128 a[204:207], v241 offset:10752
    v_exp_f32 v128, v56
    v_exp_f32 v129, v57
    v_mfma_f32_32x32x16_bf16 a[112:127], a[236:239], v[104:107], a[112:127]
    v_cvt_pk_bf16_f32 v123, v134, v135
    v_add_f32 v138, v138, v134
    v_add_f32 v139, v139, v135
    s_waitcnt lgkmcnt(6)
    v_mfma_f32_32x32x16_bf16 a[0:15], a[240:243], v[100:103], a[0:15]
    ds_read_b128 a[208:211], v241 offset:12288
    v_exp_f32 v130, v58
    v_exp_f32 v131, v59
    v_mfma_f32_32x32x16_bf16 a[64:79], a[240:243], v[108:111], a[64:79]
    buffer_load_dwordx4 v242, s[16:19], s41 offen offset:3072 sc1 lds
    v_cvt_pk_bf16_f32 v124, v128, v129
    v_add_f32 v138, v138, v128
    v_add_f32 v139, v139, v129
    v_mfma_f32_32x32x16_bf16 a[16:31], a[244:247], v[100:103], a[16:31]
    ds_read_b128 a[212:215], v241 offset:12800
    v_exp_f32 v132, v60
    v_exp_f32 v133, v61
    v_cvt_pk_bf16_f32 v125, v130, v131
    v_mfma_f32_32x32x16_bf16 a[80:95], a[244:247], v[108:111], a[80:95]
    v_add_f32 v138, v138, v130
    v_add_f32 v139, v139, v131
    v_exp_f32 v134, v62
    s_waitcnt lgkmcnt(6)
    v_mfma_f32_32x32x16_bf16 a[32:47], a[248:251], v[100:103], a[32:47]
    ds_read_b128 a[216:219], v241 offset:14336
    v_exp_f32 v135, v63
    v_cvt_pk_bf16_f32 v126, v132, v133
    v_mfma_f32_32x32x16_bf16 a[96:111], a[248:251], v[108:111], a[96:111]
    v_add_f32 v138, v138, v132
    v_add_f32 v139, v139, v133
    v_cvt_pk_bf16_f32 v127, v134, v135
    v_add_f32 v138, v138, v134
    v_mfma_f32_32x32x16_bf16 a[48:63], a[252:255], v[100:103], a[48:63]
    ds_read_b128 a[220:223], v241 offset:14848
    v_add_f32 v139, v139, v135
    v_add_f32 v225, v138, v139
    v_max_f32 v230, v224, v225
    v_cmp_lt_f32 vcc, s38, v230
    v_mfma_f32_32x32x16_bf16 a[112:127], a[252:255], v[108:111], a[112:127]
    s_cbranch_vccnz ka_rare8
ka_rr7:
    s_add_u32 s36, s36, 1
    s_cmp_le_u32 s36, 1
    s_cbranch_scc1 ka_fix9
ka_fixr10:
    s_waitcnt lgkmcnt(6)
    v_mfma_f32_32x32x16_bf16 v[32:47], a[192:195], a[128:131], v[64:79]
    ds_read_b128 a[224:227], v241 offset:24576
    v_add_f32 v226, v226, v224
    v_add_f32 v227, v227, v225
    v_exp_f32 v136, v0
    v_mfma_f32_32x32x16_bf16 v[48:63], a[192:195], a[160:163], v[80:95]
    s_sub_u32 s42, s32, 16384
    s_cmp_lt_u32 s42, s33
    s_cselect_b32 s42, s42, s43
    s_add_u32 m0, s34, 16384
    s_nop 0
    v_mfma_f32_32x32x16_bf16 v[32:47], a[196:199], a[132:135], v[32:47]
    ds_read_b128 a[228:231], v241 offset:26624
    v_exp_f32 v137, v1
    v_exp_f32 v130, v2
    v_mfma_f32_32x32x16_bf16 v[48:63], a[196:199], a[164:167], v[48:63]
    v_exp_f32 v131, v3
    v_cvt_pk_bf16_f32 v96, v136, v137
    v_exp_f32 v132, v4
    s_waitcnt lgkmcnt(6)
    v_mfma_f32_32x32x16_bf16 v[32:47], a[200:203], a[136:139], v[32:47]
    ds_read_b128 a[232:235], v241 offset:28672
    v_exp_f32 v133, v5
    v_cvt_pk_bf16_f32 v97, v130, v131
    v_add_f32 v136, v136, v130
    v_mfma_f32_32x32x16_bf16 v[48:63], a[200:203], a[168:171], v[48:63]
    buffer_load_dwordx4 v242, s[16:19], s42 offen offset:0 sc1 lds
    v_add_f32 v137, v137, v131
    v_exp_f32 v134, v6
    v_exp_f32 v135, v7
    v_mfma_f32_32x32x16_bf16 v[32:47], a[204:207], a[140:143], v[32:47]
    ds_read_b128 a[236:239], v241 offset:30720
    v_cvt_pk_bf16_f32 v98, v132, v133
    v_add_f32 v136, v136, v132
    v_add_f32 v137, v137, v133
    v_mfma_f32_32x32x16_bf16 v[48:63], a[204:207], a[172:175], v[48:63]
    v_exp_f32 v128, v8
    v_exp_f32 v129, v9
    s_waitcnt lgkmcnt(6)
    v_mfma_f32_32x32x16_bf16 v[32:47], a[208:211], a[144:147], v[32:47]
    ds_read_b128 a[240:243], v241 offset:25088
    v_cvt_pk_bf16_f32 v99, v134, v135
    v_add_f32 v136, v136, v134
    v_add_f32 v137, v137, v135
    v_exp_f32 v130, v10
    v_mfma_f32_32x32x16_bf16 v[48:63], a[208:211], a[176:179], v[48:63]
    buffer_load_dwordx4 v242, s[16:19], s42 offen offset:1024 sc1 lds
    v_exp_f32 v131, v11
    v_cvt_pk_bf16_f32 v100, v128, v129
    v_mfma_f32_32x32x16_bf16 v[32:47], a[212:215], a[148:151], v[32:47]
    ds_read_b128 a[244:247], v241 offset:27136
    v_add_f32 v136, v136, v128
    v_add_f32 v137, v137, v129
    v_exp_f32 v132, v12
    v_mfma_f32_32x32x16_bf16 v[48:63], a[212:215], a[180:183], v[48:63]
    v_exp_f32 v133, v13
    v_cvt_pk_bf16_f32 v101, v130, v131
    v_add_f32 v136, v136, v130
    s_waitcnt lgkmcnt(6)
    v_mfma_f32_32x32x16_bf16 v[32:47], a[216:219], a[152:155], v[32:47]
    ds_read_b128 a[248:251], v241 offset:29184
    v_add_f32 v137, v137, v131
    v_exp_f32 v134, v14
    v_exp_f32 v135, v15
    v_mfma_f32_32x32x16_bf16 v[48:63], a[216:219], a[184:187], v[48:63]
    buffer_load_dwordx4 v242, s[16:19], s42 offen offset:2048 sc1 lds
    v_cvt_pk_bf16_f32 v102, v132, v133
    v_add_f32 v136, v136, v132
    v_add_f32 v137, v137, v133
    v_mfma_f32_32x32x16_bf16 v[32:47], a[220:223], a[156:159], v[32:47]
    ds_read_b128 a[252:255], v241 offset:31232
    v_exp_f32 v138, v16
    v_exp_f32 v139, v17
    v_mfma_f32_32x32x16_bf16 v[48:63], a[220:223], a[188:191], v[48:63]
    v_cvt_pk_bf16_f32 v103, v134, v135
    v_add_f32 v136, v136, v134
    v_add_f32 v137, v137, v135
    v_add_f32 v224, v136, v137
    s_waitcnt lgkmcnt(6)
    v_mfma_f32_32x32x16_bf16 a[0:15], a[224:227], v[112:115], a[0:15]
    s_waitcnt vmcnt(15)
    s_barrier
    s_add_u32 s35, s35, 32768
    s_cmp_ge_u32 s35, 163840
    s_cselect_b32 s35, 0, s35
    v_add_u32 v241, s35, v239
    ds_read_b128 a[192:195], v241 offset:0
    v_mfma_f32_32x32x16_bf16 a[64:79], a[224:227], v[120:123], a[64:79]
    v_exp_f32 v130, v18
    v_exp_f32 v131, v19
    v_cvt_pk_bf16_f32 v104, v138, v139
    v_mfma_f32_32x32x16_bf16 a[16:31], a[228:231], v[112:115], a[16:31]
    ds_read_b128 a[196:199], v241 offset:512
    buffer_load_dwordx4 v242, s[16:19], s42 offen offset:3072 sc1 lds
    v_exp_f32 v132, v20
    v_exp_f32 v133, v21
    v_mfma_f32_32x32x16_bf16 a[80:95], a[228:231], v[120:123], a[80:95]
    v_cvt_pk_bf16_f32 v105, v130, v131
    v_add_f32 v138, v138, v130
    v_add_f32 v139, v139, v131
    s_waitcnt lgkmcnt(6)
    v_mfma_f32_32x32x16_bf16 a[32:47], a[232:235], v[112:115], a[32:47]
    ds_read_b128 a[200:203], v241 offset:2048
    v_exp_f32 v134, v22
    v_exp_f32 v135, v23
    v_cvt_pk_bf16_f32 v106, v132, v133
    v_mfma_f32_32x32x16_bf16 a[96:111], a[232:235], v[120:123], a[96:111]
    v_add_f32 v138, v138, v132
    v_add_f32 v139, v139, v133
    v_exp_f32 v128, v24
    v_mfma_f32_32x32x16_bf16 a[48:63], a[236:239], v[112:115], a[48:63]
    ds_read_b128 a[204:207], v241 offset:2560
    s_add_u32 s32, s32, 32768
    s_add_u32 s34, s34, 32768
    s_cmp_ge_u32 s34, 163840
    s_cselect_b32 s24, 163840, 0
    s_sub_u32 s34, s34, s24
    v_mfma_f32_32x32x16_bf16 a[112:127], a[236:239], v[120:123], a[112:127]
    v_exp_f32 v129, v25
    v_cvt_pk_bf16_f32 v107, v134, v135
    v_add_f32 v138, v138, v134
    v_add_f32 v139, v139, v135
    s_waitcnt lgkmcnt(6)
    v_mfma_f32_32x32x16_bf16 a[0:15], a[240:243], v[116:119], a[0:15]
    ds_read_b128 a[208:211], v241 offset:4096
    v_exp_f32 v130, v26
    v_exp_f32 v131, v27
    v_mfma_f32_32x32x16_bf16 a[64:79], a[240:243], v[124:127], a[64:79]
    v_cvt_pk_bf16_f32 v108, v128, v129
    v_add_f32 v138, v138, v128
    v_add_f32 v139, v139, v129
    v_exp_f32 v132, v28
    v_mfma_f32_32x32x16_bf16 a[16:31], a[244:247], v[116:119], a[16:31]
    ds_read_b128 a[212:215], v241 offset:4608
    buffer_load_dword v252, v251, s[60:63], s100 offen
    s_add_u32 s100, s100, 2048
    s_min_u32 s100, s100, s101
    v_exp_f32 v133, v29
    v_mfma_f32_32x32x16_bf16 a[80:95], a[244:247], v[124:127], a[80:95]
    v_cvt_pk_bf16_f32 v109, v130, v131
    v_add_f32 v138, v138, v130
    v_add_f32 v139, v139, v131
    s_waitcnt lgkmcnt(6)
    v_mfma_f32_32x32x16_bf16 a[32:47], a[248:251], v[116:119], a[32:47]
    ds_read_b128 a[216:219], v241 offset:6144
    v_exp_f32 v134, v30
    v_exp_f32 v135, v31
    v_mfma_f32_32x32x16_bf16 a[96:111], a[248:251], v[124:127], a[96:111]
    v_cvt_pk_bf16_f32 v110, v132, v133
    v_add_f32 v138, v138, v132
    v_add_f32 v139, v139, v133
    v_cvt_pk_bf16_f32 v111, v134, v135
    v_add_f32 v138, v138, v134
    v_mfma_f32_32x32x16_bf16 a[48:63], a[252:255], v[116:119], a[48:63]
    ds_read_b128 a[220:223], v241 offset:6656
    v_add_f32 v139, v139, v135
    v_add_f32 v225, v138, v139
    v_max_f32 v230, v224, v225
    v_cmp_lt_f32 vcc, s38, v230
    v_mfma_f32_32x32x16_bf16 a[112:127], a[252:255], v[124:127], a[112:127]
    s_cbranch_vccnz ka_rare12
ka_rr11:
    s_sub_u32 s26, s26, 1
    s_cmp_lg_u32 s26, 0
    s_cbranch_scc1 ka_p1
    s_lshl2_add_u32 s36, s5, s6
    s_sub_u32 s36, s36, 60
    s_add_u32 s36, s36, 1
    s_cmp_le_u32 s36, 1
    s_cbranch_scc1 ka_fix13
ka_fixr14:
    s_waitcnt lgkmcnt(6)
    v_mfma_f32_32x32x16_bf16 v[16:31], a[192:195], a[160:163], v[80:95]
    ds_read_b128 a[224:227], v241 offset:16384
    v_add_f32 v226, v226, v224
    v_add_f32 v227, v227, v225
    v_exp_f32 v136, v32
    v_exp_f32 v137, v33
    v_mfma_f32_32x32x16_bf16 v[16:31], a[196:199], a[164:167], v[16:31]
    ds_read_b128 a[228:231], v241 offset:18432
    s_cmp_lt_u32 s32, s33
    s_cselect_b32 s41, s32, s43
    s_mov_b32 m0, s34
    s_nop 0
    s_waitcnt lgkmcnt(6)
    v_mfma_f32_32x32x16_bf16 v[16:31], a[200:203], a[168:171], v[16:31]
    ds_read_b128 a[232:235], v241 offset:20480
    v_exp_f32 v130, v34
    v_exp_f32 v131, v35
    v_cvt_pk_bf16_f32 v112, v136, v137
    v_mfma_f32_32x32x16_bf16 v[16:31], a[204:207], a[172:175], v[16:31]
    ds_read_b128 a[236:239], v241 offset:22528
    v_exp_f32 v132, v36
    v_exp_f32 v133, v37
    s_waitcnt lgkmcnt(6)
    v_mfma_f32_32x32x16_bf16 v[16:31], a[208:211], a[176:179], v[16:31]
    ds_read_b128 a[240:243], v241 offset:16896
    v_cvt_pk_bf16_f32 v113, v130, v131
    v_add_f32 v136, v136, v130
    v_add_f32 v137, v137, v131
    v_exp_f32 v134, v38
    v_mfma_f32_32x32x16_bf16 v[16:31], a[212:215], a[180:183], v[16:31]
    ds_read_b128 a[244:247], v241 offset:18944
    buffer_load_dwordx4 v242, s[16:19], s41 offen offset:0 sc1 lds
    v_exp_f32 v135, v39
    v_cvt_pk_bf16_f32 v114, v132, v133
    s_waitcnt lgkmcnt(6)
    v_mfma_f32_32x32x16_bf16 v[16:31], a[216:219], a[184:187], v[16:31]
    ds_read_b128 a[248:251], v241 offset:20992
    v_add_f32 v136, v136, v132
    v_add_f32 v137, v137, v133
    v_exp_f32 v128, v40
    v_exp_f32 v129, v41
    v_mfma_f32_32x32x16_bf16 v[16:31], a[220:223], a[188:191], v[16:31]
    ds_read_b128 a[252:255], v241 offset:23040
    v_cvt_pk_bf16_f32 v115, v134, v135
    v_add_f32 v136, v136, v134
    v_add_f32 v137, v137, v135
    v_exp_f32 v130, v42
    s_waitcnt lgkmcnt(6)
    v_mfma_f32_32x32x16_bf16 a[0:15], a[224:227], v[96:99], a[0:15]
    ds_read_b128 a[192:195], v241 offset:8192
    v_exp_f32 v131, v43
    v_cvt_pk_bf16_f32 v116, v128, v129
    v_add_f32 v136, v136, v128
    v_mfma_f32_32x32x16_bf16 a[64:79], a[224:227], v[104:107], a[64:79]
    buffer_load_dwordx4 v242, s[16:19], s41 offen offset:1024 sc1 lds
    v_add_f32 v137, v137, v129
    v_exp_f32 v132, v44
    v_exp_f32 v133, v45
    v_cvt_pk_bf16_f32 v117, v130, v131
    v_mfma_f32_32x32x16_bf16 a[16:31], a[228:231], v[96:99], a[16:31]
    ds_read_b128 a[196:199], v241 offset:8704
    v_add_f32 v136, v136, v130
    v_add_f32 v137, v137, v131
    v_exp_f32 v134, v46
    v_exp_f32 v135, v47
    v_mfma_f32_32x32x16_bf16 a[80:95], a[228:231], v[104:107], a[80:95]
    v_cvt_pk_bf16_f32 v118, v132, v133
    v_add_f32 v136, v136, v132
    v_add_f32 v137, v137, v133
    v_exp_f32 v138, v48
    s_waitcnt lgkmcnt(6)
    v_mfma_f32_32x32x16_bf16 a[32:47], a[232:235], v[96:99], a[32:47]
    ds_read_b128 a[200:203], v241 offset:10240
    v_exp_f32 v139, v49
    v_cvt_pk_bf16_f32 v119, v134, v135
    v_add_f32 v136, v136, v134
    v_add_f32 v137, v137, v135
    v_mfma_f32_32x32x16_bf16 a[96:111], a[232:235], v[104:107], a[96:111]
    v_add_f32 v224, v136, v137
    v_exp_f32 v130, v50
    v_exp_f32 v131, v51
    v_cvt_pk_bf16_f32 v120, v138, v139
    v_mfma_f32_32x32x16_bf16 a[48:63], a[236:239], v[96:99], a[48:63]
    ds_read_b128 a[204:207], v241 offset:10752
    buffer_load_dwordx4 v242, s[16:19], s41 offen offset:2048 sc1 lds
    v_exp_f32 v132, v52
    v_exp_f32 v133, v53
    v_mfma_f32_32x32x16_bf16 a[112:127], a[236:239], v[104:107], a[112:127]
    v_cvt_pk_bf16_f32 v121, v130, v131
    v_add_f32 v138, v138, v130
    v_add_f32 v139, v139, v131
    v_exp_f32 v134, v54
    s_waitcnt lgkmcnt(6)
    v_mfma_f32_32x32x16_bf16 a[0:15], a[240:243], v[100:103], a[0:15]
    ds_read_b128 a[208:211], v241 offset:12288
    v_exp_f32 v135, v55
    v_cvt_pk_bf16_f32 v122, v132, v133
    v_add_f32 v138, v138, v132
    v_add_f32 v139, v139, v133
    v_mfma_f32_32x32x16_bf16 a[64:79], a[240:243], v[108:111], a[64:79]
    v_exp_f32 v128, v56
    v_exp_f32 v129, v57
    v_cvt_pk_bf16_f32 v123, v134, v135
    v_add_f32 v138, v138, v134
    v_add_f32 v139, v139, v135
    v_mfma_f32_32x32x16_bf16 a[16:31], a[244:247], v[100:103], a[16:31]
    ds_read_b128 a[212:215], v241 offset:12800
    buffer_load_dwordx4 v242, s[16:19], s41 offen offset:3072 sc1 lds
    v_exp_f32 v130, v58
    v_exp_f32 v131, v59
    v_cvt_pk_bf16_f32 v124, v128, v129
    v_mfma_f32_32x32x16_bf16 a[80:95], a[244:247], v[108:111], a[80:95]
    v_add_f32 v138, v138, v128
    v_add_f32 v139, v139, v129
    v_exp_f32 v132, v60
    s_waitcnt lgkmcnt(6)
    v_mfma_f32_32x32x16_bf16 a[32:47], a[248:251], v[100:103], a[32:47]
    ds_read_b128 a[216:219], v241 offset:14336
    v_exp_f32 v133, v61
    v_cvt_pk_bf16_f32 v125, v130, v131
    v_add_f32 v138, v138, v130
    v_add_f32 v139, v139, v131
    v_exp_f32 v134, v62
    v_mfma_f32_32x32x16_bf16 a[96:111], a[248:251], v[108:111], a[96:111]
    v_exp_f32 v135, v63
    v_cvt_pk_bf16_f32 v126, v132, v133
    v_add_f32 v138, v138, v132
    v_add_f32 v139, v139, v133
    v_cvt_pk_bf16_f32 v127, v134, v135
    v_mfma_f32_32x32x16_bf16 a[48:63], a[252:255], v[100:103], a[48:63]
    ds_read_b128 a[220:223], v241 offset:14848
    v_add_f32 v138, v138, v134
    v_add_f32 v139, v139, v135
    v_add_f32 v225, v138, v139
    v_max_f32 v230, v224, v225
    v_cmp_lt_f32 vcc, s38, v230
    v_mfma_f32_32x32x16_bf16 a[112:127], a[252:255], v[108:111], a[112:127]
    s_cbranch_vccnz ka_rare16
ka_rr15:
    s_add_u32 s36, s36, 1
    s_cmp_le_u32 s36, 1
    s_cbranch_scc1 ka_fix17
ka_fixr18:
    s_waitcnt lgkmcnt(6)
    v_mfma_f32_32x32x16_bf16 v[48:63], a[192:195], a[160:163], v[80:95]
    ds_read_b128 a[224:227], v241 offset:24576
    v_add_f32 v226, v226, v224
    v_add_f32 v227, v227, v225
    v_exp_f32 v138, v16
    v_mfma_f32_32x32x16_bf16 v[48:63], a[196:199], a[164:167], v[48:63]
    ds_read_b128 a[228:231], v241 offset:26624
    s_sub_u32 s42, s32, 16384
    s_cmp_lt_u32 s42, s33
    s_cselect_b32 s42, s42, s43
    s_add_u32 m0, s34, 16384
    s_nop 0
    s_waitcnt lgkmcnt(6)
    v_mfma_f32_32x32x16_bf16 v[48:63], a[200:203], a[168:171], v[48:63]
    ds_read_b128 a[232:235], v241 offset:28672
    v_exp_f32 v139, v17
    v_mfma_f32_32x32x16_bf16 v[48:63], a[204:207], a[172:175], v[48:63]
    ds_read_b128 a[236:239], v241 offset:30720
    v_exp_f32 v130, v18
    s_waitcnt lgkmcnt(6)
    v_mfma_f32_32x32x16_bf16 v[48:63], a[208:211], a[176:179], v[48:63]
    ds_read_b128 a[240:243], v241 offset:25088
    buffer_load_dwordx4 v242, s[16:19], s42 offen offset:0 sc1 lds
    v_exp_f32 v131, v19
    v_cvt_pk_bf16_f32 v104, v138, v139
    v_mfma_f32_32x32x16_bf16 v[48:63], a[212:215], a[180:183], v[48:63]
    ds_read_b128 a[244:247], v241 offset:27136
    v_exp_f32 v132, v20
    s_waitcnt lgkmcnt(6)
    v_mfma_f32_32x32x16_bf16 v[48:63], a[216:219], a[184:187], v[48:63]
    ds_read_b128 a[248:251], v241 offset:29184
    v_exp_f32 v133, v21
    v_cvt_pk_bf16_f32 v105, v130, v131
    v_add_f32 v138, v138, v130
    v_mfma_f32_32x32x16_bf16 v[48:63], a[220:223], a[188:191], v[48:63]
    ds_read_b128 a[252:255], v241 offset:31232
    buffer_load_dwordx4 v242, s[16:19], s42 offen offset:1024 sc1 lds
    v_add_f32 v139, v139, v131
    s_waitcnt lgkmcnt(6)
    v_mfma_f32_32x32x16_bf16 a[0:15], a[224:227], v[112:115], a[0:15]
    s_waitcnt vmcnt(15)
    s_barrier
    s_add_u32 s35, s35, 32768
    s_cmp_ge_u32 s35, 163840
    s_cselect_b32 s35, 0, s35
    v_add_u32 v241, s35, v239
    ds_read_b128 a[192:195], v241 offset:0
    v_mfma_f32_32x32x16_bf16 a[64:79], a[224:227], v[120:123], a[64:79]
    v_exp_f32 v134, v22
    v_exp_f32 v135, v23
    v_mfma_f32_32x32x16_bf16 a[16:31], a[228:231], v[112:115], a[16:31]
    ds_read_b128 a[196:199], v241 offset:512
    buffer_load_dwordx4 v242, s[16:19], s42 offen offset:2048 sc1 lds
    v_cvt_pk_bf16_f32 v106, v132, v133
    v_add_f32 v138, v138, v132
    v_add_f32 v139, v139, v133
    v_mfma_f32_32x32x16_bf16 a[80:95], a[228:231], v[120:123], a[80:95]
    v_exp_f32 v128, v24
    s_waitcnt lgkmcnt(6)
    v_mfma_f32_32x32x16_bf16 a[32:47], a[232:235], v[112:115], a[32:47]
    ds_read_b128 a[200:203], v241 offset:2048
    v_exp_f32 v129, v25
    v_cvt_pk_bf16_f32 v107, v134, v135
    v_add_f32 v138, v138, v134
    v_mfma_f32_32x32x16_bf16 a[96:111], a[232:235], v[120:123], a[96:111]
    buffer_load_dwordx4 v242, s[16:19], s42 offen offset:3072 sc1 lds
    v_add_f32 v139, v139, v135
    v_exp_f32 v130, v26
    v_mfma_f32_32x32x16_bf16 a[48:63], a[236:239], v[112:115], a[48:63]
    ds_read_b128 a[204:207], v241 offset:2560
    v_exp_f32 v131, v27
    v_cvt_pk_bf16_f32 v108, v128, v129
    v_mfma_f32_32x32x16_bf16 a[112:127], a[236:239], v[120:123], a[112:127]
    v_add_f32 v138, v138, v128
    v_add_f32 v139, v139, v129
    v_exp_f32 v132, v28
    s_waitcnt lgkmcnt(6)
    v_mfma_f32_32x32x16_bf16 a[0:15], a[240:243], v[116:119], a[0:15]
    ds_read_b128 a[208:211], v241 offset:4096
    s_add_u32 s32, s32, 32768
    s_add_u32 s34, s34, 32768
    s_cmp_ge_u32 s34, 163840
    s_cselect_b32 s24, 163840, 0
    s_sub_u32 s34, s34, s24
    v_mfma_f32_32x32x16_bf16 a[64:79], a[240:243], v[124:127], a[64:79]
    v_exp_f32 v133, v29
    v_cvt_pk_bf16_f32 v109, v130, v131
    v_mfma_f32_32x32x16_bf16 a[16:31], a[244:247], v[116:119], a[16:31]
    ds_read_b128 a[212:215], v241 offset:4608
    v_add_f32 v138, v138, v130
    v_add_f32 v139, v139, v131
    v_mfma_f32_32x32x16_bf16 a[80:95], a[244:247], v[124:127], a[80:95]
    buffer_load_dword v252, v251, s[60:63], s100 offen
    s_add_u32 s100, s100, 2048
    s_min_u32 s100, s100, s101
    v_exp_f32 v134, v30
    s_waitcnt lgkmcnt(6)
    v_mfma_f32_32x32x16_bf16 a[32:47], a[248:251], v[116:119], a[32:47]
    ds_read_b128 a[216:219], v241 offset:6144
    v_exp_f32 v135, v31
    v_cvt_pk_bf16_f32 v110, v132, v133
    v_mfma_f32_32x32x16_bf16 a[96:111], a[248:251], v[124:127], a[96:111]
    v_add_f32 v138, v138, v132
    v_add_f32 v139, v139, v133
    v_cvt_pk_bf16_f32 v111, v134, v135
    v_add_f32 v138, v138, v134
    v_mfma_f32_32x32x16_bf16 a[48:63], a[252:255], v[116:119], a[48:63]
    ds_read_b128 a[220:223], v241 offset:6656
    v_add_f32 v139, v139, v135
    v_add_f32 v225, v138, v139
    v_cmp_lt_f32 vcc, s38, v225
    v_mfma_f32_32x32x16_bf16 a[112:127], a[252:255], v[124:127], a[112:127]
    s_cbranch_vccnz ka_rare20
ka_rr19:
    s_nop 7
    v_mov_b32 v230, v226
    s_nop 1
    v_permlane32_swap_b32 v226, v230
    s_nop 0
    v_add_f32 v230, v230, v226
    v_rcp_f32 v230, v230
    s_nop 0
    v_accvgpr_read_b32 v160, a0
    v_accvgpr_read_b32 v161, a1
    v_accvgpr_read_b32 v162, a2
    v_accvgpr_read_b32 v163, a3
    v_accvgpr_read_b32 v164, a4
    v_accvgpr_read_b32 v165, a5
    v_accvgpr_read_b32 v166, a6
    v_accvgpr_read_b32 v167, a7
    v_mul_f32 v160, v160, v230
    v_mul_f32 v161, v161, v230
    v_mul_f32 v162, v162, v230
    v_mul_f32 v163, v163, v230
    v_mul_f32 v164, v164, v230
    v_mul_f32 v165, v165, v230
    v_mul_f32 v166, v166, v230
    v_mul_f32 v167, v167, v230
    v_cvt_pk_bf16_f32 v176, v160, v161
    v_cvt_pk_bf16_f32 v177, v162, v163
    v_cvt_pk_bf16_f32 v178, v164, v165
    v_cvt_pk_bf16_f32 v179, v166, v167
    buffer_store_dwordx4 v[176:179], v244, s[20:23], s39 offen offset:0 sc1
    v_accvgpr_read_b32 v168, a8
    v_accvgpr_read_b32 v169, a9
    v_accvgpr_read_b32 v170, a10
    v_accvgpr_read_b32 v171, a11
    v_accvgpr_read_b32 v172, a12
    v_accvgpr_read_b32 v173, a13
    v_accvgpr_read_b32 v174, a14
    v_accvgpr_read_b32 v175, a15
    v_mul_f32 v168, v168, v230
    v_mul_f32 v169, v169, v230
    v_mul_f32 v170, v170, v230
    v_mul_f32 v171, v171, v230
    v_mul_f32 v172, v172, v230
    v_mul_f32 v173, v173, v230
    v_mul_f32 v174, v174, v230
    v_mul_f32 v175, v175, v230
    v_cvt_pk_bf16_f32 v180, v168, v169
    v_cvt_pk_bf16_f32 v181, v170, v171
    v_cvt_pk_bf16_f32 v182, v172, v173
    v_cvt_pk_bf16_f32 v183, v174, v175
    buffer_store_dwordx4 v[180:183], v244, s[20:23], s39 offen offset:512 sc1
    v_accvgpr_read_b32 v160, a16
    v_accvgpr_read_b32 v161, a17
    v_accvgpr_read_b32 v162, a18
    v_accvgpr_read_b32 v163, a19
    v_accvgpr_read_b32 v164, a20
    v_accvgpr_read_b32 v165, a21
    v_accvgpr_read_b32 v166, a22
    v_accvgpr_read_b32 v167, a23
    v_mul_f32 v160, v160, v230
    v_mul_f32 v161, v161, v230
    v_mul_f32 v162, v162, v230
    v_mul_f32 v163, v163, v230
    v_mul_f32 v164, v164, v230
    v_mul_f32 v165, v165, v230
    v_mul_f32 v166, v166, v230
    v_mul_f32 v167, v167, v230
    v_cvt_pk_bf16_f32 v184, v160, v161
    v_cvt_pk_bf16_f32 v185, v162, v163
    v_cvt_pk_bf16_f32 v186, v164, v165
    v_cvt_pk_bf16_f32 v187, v166, v167
    buffer_store_dwordx4 v[184:187], v244, s[20:23], s39 offen offset:1024 sc1
    v_accvgpr_read_b32 v168, a24
    v_accvgpr_read_b32 v169, a25
    v_accvgpr_read_b32 v170, a26
    v_accvgpr_read_b32 v171, a27
    v_accvgpr_read_b32 v172, a28
    v_accvgpr_read_b32 v173, a29
    v_accvgpr_read_b32 v174, a30
    v_accvgpr_read_b32 v175, a31
    v_mul_f32 v168, v168, v230
    v_mul_f32 v169, v169, v230
    v_mul_f32 v170, v170, v230
    v_mul_f32 v171, v171, v230
    v_mul_f32 v172, v172, v230
    v_mul_f32 v173, v173, v230
    v_mul_f32 v174, v174, v230
    v_mul_f32 v175, v175, v230
    v_cvt_pk_bf16_f32 v188, v168, v169
    v_cvt_pk_bf16_f32 v189, v170, v171
    v_cvt_pk_bf16_f32 v190, v172, v173
    v_cvt_pk_bf16_f32 v191, v174, v175
    buffer_store_dwordx4 v[188:191], v244, s[20:23], s39 offen offset:1536 sc1
    v_accvgpr_read_b32 v160, a32
    v_accvgpr_read_b32 v161, a33
    v_accvgpr_read_b32 v162, a34
    v_accvgpr_read_b32 v163, a35
    v_accvgpr_read_b32 v164, a36
    v_accvgpr_read_b32 v165, a37
    v_accvgpr_read_b32 v166, a38
    v_accvgpr_read_b32 v167, a39
    v_mul_f32 v160, v160, v230
    v_mul_f32 v161, v161, v230
    v_mul_f32 v162, v162, v230
    v_mul_f32 v163, v163, v230
    v_mul_f32 v164, v164, v230
    v_mul_f32 v165, v165, v230
    v_mul_f32 v166, v166, v230
    v_mul_f32 v167, v167, v230
    v_cvt_pk_bf16_f32 v176, v160, v161
    v_cvt_pk_bf16_f32 v177, v162, v163
    v_cvt_pk_bf16_f32 v178, v164, v165
    v_cvt_pk_bf16_f32 v179, v166, v167
    buffer_store_dwordx4 v[176:179], v244, s[20:23], s39 offen offset:2048 sc1
    v_accvgpr_read_b32 v168, a40
    v_accvgpr_read_b32 v169, a41
    v_accvgpr_read_b32 v170, a42
    v_accvgpr_read_b32 v171, a43
    v_accvgpr_read_b32 v172, a44
    v_accvgpr_read_b32 v173, a45
    v_accvgpr_read_b32 v174, a46
    v_accvgpr_read_b32 v175, a47
    v_mul_f32 v168, v168, v230
    v_mul_f32 v169, v169, v230
    v_mul_f32 v170, v170, v230
    v_mul_f32 v171, v171, v230
    v_mul_f32 v172, v172, v230
    v_mul_f32 v173, v173, v230
    v_mul_f32 v174, v174, v230
    v_mul_f32 v175, v175, v230
    v_cvt_pk_bf16_f32 v180, v168, v169
    v_cvt_pk_bf16_f32 v181, v170, v171
    v_cvt_pk_bf16_f32 v182, v172, v173
    v_cvt_pk_bf16_f32 v183, v174, v175
    buffer_store_dwordx4 v[180:183], v244, s[20:23], s39 offen offset:2560 sc1
    v_accvgpr_read_b32 v160, a48
    v_accvgpr_read_b32 v161, a49
    v_accvgpr_read_b32 v162, a50
    v_accvgpr_read_b32 v163, a51
    v_accvgpr_read_b32 v164, a52
    v_accvgpr_read_b32 v165, a53
    v_accvgpr_read_b32 v166, a54
    v_accvgpr_read_b32 v167, a55
    v_mul_f32 v160, v160, v230
    v_mul_f32 v161, v161, v230
    v_mul_f32 v162, v162, v230
    v_mul_f32 v163, v163, v230
    v_mul_f32 v164, v164, v230
    v_mul_f32 v165, v165, v230
    v_mul_f32 v166, v166, v230
    v_mul_f32 v167, v167, v230
    v_cvt_pk_bf16_f32 v184, v160, v161
    v_cvt_pk_bf16_f32 v185, v162, v163
    v_cvt_pk_bf16_f32 v186, v164, v165
    v_cvt_pk_bf16_f32 v187, v166, v167
    buffer_store_dwordx4 v[184:187], v244, s[20:23], s39 offen offset:3072 sc1
    v_accvgpr_read_b32 v168, a56
    v_accvgpr_read_b32 v169, a57
    v_accvgpr_read_b32 v170, a58
    v_accvgpr_read_b32 v171, a59
    v_accvgpr_read_b32 v172, a60
    v_accvgpr_read_b32 v173, a61
    v_accvgpr_read_b32 v174, a62
    v_accvgpr_read_b32 v175, a63
    v_mul_f32 v168, v168, v230
    v_mul_f32 v169, v169, v230
    v_mul_f32 v170, v170, v230
    v_mul_f32 v171, v171, v230
    v_mul_f32 v172, v172, v230
    v_mul_f32 v173, v173, v230
    v_mul_f32 v174, v174, v230
    v_mul_f32 v175, v175, v230
    v_cvt_pk_bf16_f32 v188, v168, v169
    v_cvt_pk_bf16_f32 v189, v170, v171
    v_cvt_pk_bf16_f32 v190, v172, v173
    v_cvt_pk_bf16_f32 v191, v174, v175
    buffer_store_dwordx4 v[188:191], v244, s[20:23], s39 offen offset:3584 sc1
    s_lshl_b32 s26, s5, 2
    s_sub_u32 s26, 29, s26
.p2align 3
ka_p2:
    s_add_u32 s36, s36, 1
    s_cmp_le_u32 s36, 1
    s_cbranch_scc1 ka_fix21
ka_fixr22:
    s_waitcnt lgkmcnt(6)
    v_mfma_f32_32x32x16_bf16 v[16:31], a[192:195], a[160:163], v[80:95]
    ds_read_b128 a[224:227], v241 offset:16384
    v_add_f32 v227, v227, v225
    v_exp_f32 v138, v48
    v_exp_f32 v139, v49
    v_mfma_f32_32x32x16_bf16 v[16:31], a[196:199], a[164:167], v[16:31]
    ds_read_b128 a[228:231], v241 offset:18432
    s_cmp_lt_u32 s32, s33
    s_cselect_b32 s41, s32, s43
    s_mov_b32 m0, s34
    s_nop 0
    s_waitcnt lgkmcnt(6)
    v_mfma_f32_32x32x16_bf16 v[16:31], a[200:203], a[168:171], v[16:31]
    ds_read_b128 a[232:235], v241 offset:20480
    v_exp_f32 v130, v50
    v_exp_f32 v131, v51
    v_cvt_pk_bf16_f32 v120, v138, v139
    v_mfma_f32_32x32x16_bf16 v[16:31], a[204:207], a[172:175], v[16:31]
    ds_read_b128 a[236:239], v241 offset:22528
    buffer_load_dwordx4 v242, s[16:19], s41 offen offset:0 sc1 lds
    v_exp_f32 v132, v52
    s_waitcnt lgkmcnt(6)
    v_mfma_f32_32x32x16_bf16 v[16:31], a[208:211], a[176:179], v[16:31]
    ds_read_b128 a[240:243], v241 offset:16896
    v_exp_f32 v133, v53
    v_cvt_pk_bf16_f32 v121, v130, v131
    v_add_f32 v138, v138, v130
    v_add_f32 v139, v139, v131
    v_mfma_f32_32x32x16_bf16 v[16:31], a[212:215], a[180:183], v[16:31]
    ds_read_b128 a[244:247], v241 offset:18944
    v_exp_f32 v134, v54
    v_exp_f32 v135, v55
    s_waitcnt lgkmcnt(6)
    v_mfma_f32_32x32x16_bf16 v[16:31], a[216:219], a[184:187], v[16:31]
    ds_read_b128 a[248:251], v241 offset:20992
    buffer_load_dwordx4 v242, s[16:19], s41 offen offset:1024 sc1 lds
    v_cvt_pk_bf16_f32 v122, v132, v133
    v_add_f32 v138, v138, v132
    v_add_f32 v139, v139, v133
    v_mfma_f32_32x32x16_bf16 v[16:31], a[220:223], a[188:191], v[16:31]
    ds_read_b128 a[252:255], v241 offset:23040
    v_exp_f32 v128, v56
    v_exp_f32 v129, v57
    v_cvt_pk_bf16_f32 v123, v134, v135
    s_waitcnt lgkmcnt(6)
    v_mfma_f32_32x32x16_bf16 a[64:79], a[224:227], v[104:107], a[64:79]
    ds_read_b128 a[192:195], v241 offset:8192
    v_add_f32 v138, v138, v134
    v_add_f32 v139, v139, v135
    v_exp_f32 v130, v58
    v_mfma_f32_32x32x16_bf16 a[80:95], a[228:231], v[104:107], a[80:95]
    ds_read_b128 a[196:199], v241 offset:8704
    buffer_load_dwordx4 v242, s[16:19], s41 offen offset:2048 sc1 lds
    v_exp_f32 v131, v59
    v_cvt_pk_bf16_f32 v124, v128, v129
    s_waitcnt lgkmcnt(6)
    v_mfma_f32_32x32x16_bf16 a[96:111], a[232:235], v[104:107], a[96:111]
    ds_read_b128 a[200:203], v241 offset:10240
    v_add_f32 v138, v138, v128
    v_add_f32 v139, v139, v129
    v_exp_f32 v132, v60
    v_mfma_f32_32x32x16_bf16 a[112:127], a[236:239], v[104:107], a[112:127]
    ds_read_b128 a[204:207], v241 offset:10752
    v_exp_f32 v133, v61
    v_cvt_pk_bf16_f32 v125, v130, v131
    v_add_f32 v138, v138, v130
    v_add_f32 v139, v139, v131
    s_waitcnt lgkmcnt(6)
    v_mfma_f32_32x32x16_bf16 a[64:79], a[240:243], v[108:111], a[64:79]
    ds_read_b128 a[208:211], v241 offset:12288
    buffer_load_dwordx4 v242, s[16:19], s41 offen offset:3072 sc1 lds
    v_exp_f32 v134, v62
    v_exp_f32 v135, v63
    v_mfma_f32_32x32x16_bf16 a[80:95], a[244:247], v[108:111], a[80:95]
    ds_read_b128 a[212:215], v241 offset:12800
    v_cvt_pk_bf16_f32 v126, v132, v133
    v_add_f32 v138, v138, v132
    v_add_f32 v139, v139, v133
    s_waitcnt lgkmcnt(6)
    v_mfma_f32_32x32x16_bf16 a[96:111], a[248:251], v[108:111], a[96:111]
    ds_read_b128 a[216:219], v241 offset:14336
    v_cvt_pk_bf16_f32 v127, v134, v135
    v_add_f32 v138, v138, v134
    v_add_f32 v139, v139, v135
    v_add_f32 v225, v138, v139
    v_cmp_lt_f32 vcc, s38, v225
    v_mfma_f32_32x32x16_bf16 a[112:127], a[252:255], v[108:111], a[112:127]
    ds_read_b128 a[220:223], v241 offset:14848
    s_cbranch_vccnz ka_rare24
ka_rr23:
    s_add_u32 s36, s36, 1
    s_cmp_le_u32 s36, 1
    s_cbranch_scc1 ka_fix25
ka_fixr26:
    s_waitcnt lgkmcnt(6)
    v_mfma_f32_32x32x16_bf16 v[48:63], a[192:195], a[160:163], v[80:95]
    ds_read_b128 a[224:227], v241 offset:24576
    v_add_f32 v227, v227, v225
    v_exp_f32 v138, v16
    v_exp_f32 v139, v17
    v_mfma_f32_32x32x16_bf16 v[48:63], a[196:199], a[164:167], v[48:63]
    ds_read_b128 a[228:231], v241 offset:26624
    s_sub_u32 s42, s32, 16384
    s_cmp_lt_u32 s42, s33
    s_cselect_b32 s42, s42, s43
    s_add_u32 m0, s34, 16384
    s_nop 0
    s_waitcnt lgkmcnt(6)
    v_mfma_f32_32x32x16_bf16 v[48:63], a[200:203], a[168:171], v[48:63]
    ds_read_b128 a[232:235], v241 offset:28672
    v_exp_f32 v130, v18
    v_exp_f32 v131, v19
    v_cvt_pk_bf16_f32 v104, v138, v139
    v_exp_f32 v132, v20
    v_mfma_f32_32x32x16_bf16 v[48:63], a[204:207], a[172:175], v[48:63]
    ds_read_b128 a[236:239], v241 offset:30720
    buffer_load_dwordx4 v242, s[16:19], s42 offen offset:0 sc1 lds
    v_exp_f32 v133, v21
    v_cvt_pk_bf16_f32 v105, v130, v131
    s_waitcnt lgkmcnt(6)
    v_mfma_f32_32x32x16_bf16 v[48:63], a[208:211], a[176:179], v[48:63]
    ds_read_b128 a[240:243], v241 offset:25088
    v_add_f32 v138, v138, v130
    v_add_f32 v139, v139, v131
    v_exp_f32 v134, v22
    v_exp_f32 v135, v23
    v_mfma_f32_32x32x16_bf16 v[48:63], a[212:215], a[180:183], v[48:63]
    ds_read_b128 a[244:247], v241 offset:27136
    buffer_load_dwordx4 v242, s[16:19], s42 offen offset:1024 sc1 lds
    v_cvt_pk_bf16_f32 v106, v132, v133
    v_add_f32 v138, v138, v132
    v_add_f32 v139, v139, v133
    s_waitcnt lgkmcnt(6)
    v_mfma_f32_32x32x16_bf16 v[48:63], a[216:219], a[184:187], v[48:63]
    ds_read_b128 a[248:251], v241 offset:29184
    v_exp_f32 v128, v24
    v_exp_f32 v129, v25
    v_cvt_pk_bf16_f32 v107, v134, v135
    v_add_f32 v138, v138, v134
    v_add_f32 v139, v139, v135
    v_mfma_f32_32x32x16_bf16 v[48:63], a[220:223], a[188:191], v[48:63]
    ds_read_b128 a[252:255], v241 offset:31232
    buffer_load_dwordx4 v242, s[16:19], s42 offen offset:2048 sc1 lds
    v_exp_f32 v130, v26
    v_exp_f32 v131, v27
    s_waitcnt lgkmcnt(6)
    v_mfma_f32_32x32x16_bf16 a[64:79], a[224:227], v[120:123], a[64:79]
    s_waitcnt vmcnt(17)
    s_barrier
    s_add_u32 s35, s35, 32768
    s_cmp_ge_u32 s35, 163840
    s_cselect_b32 s35, 0, s35
    v_add_u32 v241, s35, v239
    ds_read_b128 a[192:195], v241 offset:0
    v_mfma_f32_32x32x16_bf16 a[80:95], a[228:231], v[120:123], a[80:95]
    ds_read_b128 a[196:199], v241 offset:512
    buffer_load_dwordx4 v242, s[16:19], s42 offen offset:3072 sc1 lds
    v_cvt_pk_bf16_f32 v108, v128, v129
    v_add_f32 v138, v138, v128
    v_add_f32 v139, v139, v129
    s_waitcnt lgkmcnt(6)
    v_mfma_f32_32x32x16_bf16 a[96:111], a[232:235], v[120:123], a[96:111]
    ds_read_b128 a[200:203], v241 offset:2048
    v_exp_f32 v132, v28
    v_exp_f32 v133, v29
    v_cvt_pk_bf16_f32 v109, v130, v131
    v_add_f32 v138, v138, v130
    v_mfma_f32_32x32x16_bf16 a[112:127], a[236:239], v[120:123], a[112:127]
    ds_read_b128 a[204:207], v241 offset:2560
    s_add_u32 s32, s32, 32768
    s_add_u32 s34, s34, 32768
    s_cmp_ge_u32 s34, 163840
    s_cselect_b32 s24, 163840, 0
    s_sub_u32 s34, s34, s24
    s_waitcnt lgkmcnt(6)
    v_mfma_f32_32x32x16_bf16 a[64:79], a[240:243], v[124:127], a[64:79]
    ds_read_b128 a[208:211], v241 offset:4096
    v_add_f32 v139, v139, v131
    v_exp_f32 v134, v30
    v_exp_f32 v135, v31
    v_cvt_pk_bf16_f32 v110, v132, v133
    v_mfma_f32_32x32x16_bf16 a[80:95], a[244:247], v[124:127], a[80:95]
    ds_read_b128 a[212:215], v241 offset:4608
    buffer_load_dword v252, v251, s[60:63], s100 offen
    s_add_u32 s100, s100, 2048
    s_min_u32 s100, s100, s101
    v_add_f32 v138, v138, v132
    s_waitcnt lgkmcnt(6)
    v_mfma_f32_32x32x16_bf16 a[96:111], a[248:251], v[124:127], a[96:111]
    ds_read_b128 a[216:219], v241 offset:6144
    v_add_f32 v139, v139, v133
    v_cvt_pk_bf16_f32 v111, v134, v135
    v_add_f32 v138, v138, v134
    v_add_f32 v139, v139, v135
    v_add_f32 v225, v138, v139
    v_cmp_lt_f32 vcc, s38, v225
    v_mfma_f32_32x32x16_bf16 a[112:127], a[252:255], v[124:127], a[112:127]
    ds_read_b128 a[220:223], v241 offset:6656
    s_cbranch_vccnz ka_rare28
ka_rr27:
    s_sub_u32 s26, s26, 1
    s_cmp_lg_u32 s26, 0
    s_cbranch_scc1 ka_p2
    s_waitcnt lgkmcnt(0)
    ds_read_b128 a[224:227], v241 offset:16384
    ds_read_b128 a[228:231], v241 offset:18432
    ds_read_b128 a[232:235], v241 offset:20480
    ds_read_b128 a[236:239], v241 offset:22528
    ds_read_b128 a[240:243], v241 offset:16896
    ds_read_b128 a[244:247], v241 offset:18944
    ds_read_b128 a[248:251], v241 offset:20992
    ds_read_b128 a[252:255], v241 offset:23040
    ds_read_b128 a[192:195], v241 offset:24576
    ds_read_b128 a[196:199], v241 offset:26624
    ds_read_b128 a[200:203], v241 offset:28672
    ds_read_b128 a[204:207], v241 offset:30720
    ds_read_b128 a[208:211], v241 offset:25088
    ds_read_b128 a[212:215], v241 offset:27136
    ds_read_b128 a[216:219], v241 offset:29184
    s_waitcnt lgkmcnt(7)
    ds_read_b128 a[220:223], v241 offset:31232
    v_mfma_f32_32x32x16_bf16 a[64:79], a[224:227], v[104:107], a[64:79]
    v_add_f32 v227, v227, v225
    v_exp_f32 v138, v48
    v_exp_f32 v139, v49
    v_exp_f32 v130, v50
    v_exp_f32 v131, v51
    v_mfma_f32_32x32x16_bf16 a[80:95], a[228:231], v[104:107], a[80:95]
    v_cvt_pk_bf16_f32 v120, v138, v139
    v_exp_f32 v132, v52
    v_exp_f32 v133, v53
    v_cvt_pk_bf16_f32 v121, v130, v131
    v_add_f32 v138, v138, v130
    v_mfma_f32_32x32x16_bf16 a[96:111], a[232:235], v[104:107], a[96:111]
    v_add_f32 v139, v139, v131
    v_exp_f32 v134, v54
    v_exp_f32 v135, v55
    v_cvt_pk_bf16_f32 v122, v132, v133
    v_add_f32 v138, v138, v132
    v_add_f32 v139, v139, v133
    v_mfma_f32_32x32x16_bf16 a[112:127], a[236:239], v[104:107], a[112:127]
    v_exp_f32 v128, v56
    v_exp_f32 v129, v57
    v_cvt_pk_bf16_f32 v123, v134, v135
    v_add_f32 v138, v138, v134
    v_add_f32 v139, v139, v135
    v_exp_f32 v130, v58
    v_mfma_f32_32x32x16_bf16 a[64:79], a[240:243], v[108:111], a[64:79]
    v_exp_f32 v131, v59
    v_cvt_pk_bf16_f32 v124, v128, v129
    v_add_f32 v138, v138, v128
    v_add_f32 v139, v139, v129
    v_exp_f32 v132, v60
    v_mfma_f32_32x32x16_bf16 a[80:95], a[244:247], v[108:111], a[80:95]
    v_exp_f32 v133, v61
    v_cvt_pk_bf16_f32 v125, v130, v131
    v_add_f32 v138, v138, v130
    v_add_f32 v139, v139, v131
    v_exp_f32 v134, v62
    v_exp_f32 v135, v63
    v_mfma_f32_32x32x16_bf16 a[96:111], a[248:251], v[108:111], a[96:111]
    v_cvt_pk_bf16_f32 v126, v132, v133
    v_add_f32 v138, v138, v132
    v_add_f32 v139, v139, v133
    v_cvt_pk_bf16_f32 v127, v134, v135
    v_add_f32 v138, v138, v134
    v_add_f32 v139, v139, v135
    v_add_f32 v225, v138, v139
    v_cmp_lt_f32 vcc, s38, v225
    v_mfma_f32_32x32x16_bf16 a[112:127], a[252:255], v[108:111], a[112:127]
    s_cbranch_vccnz ka_rare30
ka_rr29:
    s_waitcnt lgkmcnt(0)
    v_add_f32 v227, v227, v225
    s_nop 0
    v_mfma_f32_32x32x16_bf16 a[64:79], a[192:195], v[120:123], a[64:79]
    v_mfma_f32_32x32x16_bf16 a[80:95], a[196:199], v[120:123], a[80:95]
    v_mfma_f32_32x32x16_bf16 a[96:111], a[200:203], v[120:123], a[96:111]
    v_mfma_f32_32x32x16_bf16 a[112:127], a[204:207], v[120:123], a[112:127]
    v_mfma_f32_32x32x16_bf16 a[64:79], a[208:211], v[124:127], a[64:79]
    v_mfma_f32_32x32x16_bf16 a[80:95], a[212:215], v[124:127], a[80:95]
    v_mfma_f32_32x32x16_bf16 a[96:111], a[216:219], v[124:127], a[96:111]
    v_mfma_f32_32x32x16_bf16 a[112:127], a[220:223], v[124:127], a[112:127]
    s_nop 7
    s_nop 7
    v_mov_b32 v230, v227
    s_nop 1
    v_permlane32_swap_b32 v227, v230
    s_nop 0
    v_add_f32 v230, v230, v227
    v_rcp_f32 v230, v230
    s_nop 0
    v_accvgpr_read_b32 v160, a64
    v_accvgpr_read_b32 v161, a65
    v_accvgpr_read_b32 v162, a66
    v_accvgpr_read_b32 v163, a67
    v_accvgpr_read_b32 v164, a68
    v_accvgpr_read_b32 v165, a69
    v_accvgpr_read_b32 v166, a70
    v_accvgpr_read_b32 v167, a71
    v_mul_f32 v160, v160, v230
    v_mul_f32 v161, v161, v230
    v_mul_f32 v162, v162, v230
    v_mul_f32 v163, v163, v230
    v_mul_f32 v164, v164, v230
    v_mul_f32 v165, v165, v230
    v_mul_f32 v166, v166, v230
    v_mul_f32 v167, v167, v230
    v_cvt_pk_bf16_f32 v176, v160, v161
    v_cvt_pk_bf16_f32 v177, v162, v163
    v_cvt_pk_bf16_f32 v178, v164, v165
    v_cvt_pk_bf16_f32 v179, v166, v167
    buffer_store_dwordx4 v[176:179], v244, s[20:23], s40 offen offset:0 sc1
    v_accvgpr_read_b32 v168, a72
    v_accvgpr_read_b32 v169, a73
    v_accvgpr_read_b32 v170, a74
    v_accvgpr_read_b32 v171, a75
    v_accvgpr_read_b32 v172, a76
    v_accvgpr_read_b32 v173, a77
    v_accvgpr_read_b32 v174, a78
    v_accvgpr_read_b32 v175, a79
    v_mul_f32 v168, v168, v230
    v_mul_f32 v169, v169, v230
    v_mul_f32 v170, v170, v230
    v_mul_f32 v171, v171, v230
    v_mul_f32 v172, v172, v230
    v_mul_f32 v173, v173, v230
    v_mul_f32 v174, v174, v230
    v_mul_f32 v175, v175, v230
    v_cvt_pk_bf16_f32 v180, v168, v169
    v_cvt_pk_bf16_f32 v181, v170, v171
    v_cvt_pk_bf16_f32 v182, v172, v173
    v_cvt_pk_bf16_f32 v183, v174, v175
    buffer_store_dwordx4 v[180:183], v244, s[20:23], s40 offen offset:512 sc1
    v_accvgpr_read_b32 v160, a80
    v_accvgpr_read_b32 v161, a81
    v_accvgpr_read_b32 v162, a82
    v_accvgpr_read_b32 v163, a83
    v_accvgpr_read_b32 v164, a84
    v_accvgpr_read_b32 v165, a85
    v_accvgpr_read_b32 v166, a86
    v_accvgpr_read_b32 v167, a87
    v_mul_f32 v160, v160, v230
    v_mul_f32 v161, v161, v230
    v_mul_f32 v162, v162, v230
    v_mul_f32 v163, v163, v230
    v_mul_f32 v164, v164, v230
    v_mul_f32 v165, v165, v230
    v_mul_f32 v166, v166, v230
    v_mul_f32 v167, v167, v230
    v_cvt_pk_bf16_f32 v184, v160, v161
    v_cvt_pk_bf16_f32 v185, v162, v163
    v_cvt_pk_bf16_f32 v186, v164, v165
    v_cvt_pk_bf16_f32 v187, v166, v167
    buffer_store_dwordx4 v[184:187], v244, s[20:23], s40 offen offset:1024 sc1
    v_accvgpr_read_b32 v168, a88
    v_accvgpr_read_b32 v169, a89
    v_accvgpr_read_b32 v170, a90
    v_accvgpr_read_b32 v171, a91
    v_accvgpr_read_b32 v172, a92
    v_accvgpr_read_b32 v173, a93
    v_accvgpr_read_b32 v174, a94
    v_accvgpr_read_b32 v175, a95
    v_mul_f32 v168, v168, v230
    v_mul_f32 v169, v169, v230
    v_mul_f32 v170, v170, v230
    v_mul_f32 v171, v171, v230
    v_mul_f32 v172, v172, v230
    v_mul_f32 v173, v173, v230
    v_mul_f32 v174, v174, v230
    v_mul_f32 v175, v175, v230
    v_cvt_pk_bf16_f32 v188, v168, v169
    v_cvt_pk_bf16_f32 v189, v170, v171
    v_cvt_pk_bf16_f32 v190, v172, v173
    v_cvt_pk_bf16_f32 v191, v174, v175
    buffer_store_dwordx4 v[188:191], v244, s[20:23], s40 offen offset:1536 sc1
    v_accvgpr_read_b32 v160, a96
    v_accvgpr_read_b32 v161, a97
    v_accvgpr_read_b32 v162, a98
    v_accvgpr_read_b32 v163, a99
    v_accvgpr_read_b32 v164, a100
    v_accvgpr_read_b32 v165, a101
    v_accvgpr_read_b32 v166, a102
    v_accvgpr_read_b32 v167, a103
    v_mul_f32 v160, v160, v230
    v_mul_f32 v161, v161, v230
    v_mul_f32 v162, v162, v230
    v_mul_f32 v163, v163, v230
    v_mul_f32 v164, v164, v230
    v_mul_f32 v165, v165, v230
    v_mul_f32 v166, v166, v230
    v_mul_f32 v167, v167, v230
    v_cvt_pk_bf16_f32 v176, v160, v161
    v_cvt_pk_bf16_f32 v177, v162, v163
    v_cvt_pk_bf16_f32 v178, v164, v165
    v_cvt_pk_bf16_f32 v179, v166, v167
    buffer_store_dwordx4 v[176:179], v244, s[20:23], s40 offen offset:2048 sc1
    v_accvgpr_read_b32 v168, a104
    v_accvgpr_read_b32 v169, a105
    v_accvgpr_read_b32 v170, a106
    v_accvgpr_read_b32 v171, a107
    v_accvgpr_read_b32 v172, a108
    v_accvgpr_read_b32 v173, a109
    v_accvgpr_read_b32 v174, a110
    v_accvgpr_read_b32 v175, a111
    v_mul_f32 v168, v168, v230
    v_mul_f32 v169, v169, v230
    v_mul_f32 v170, v170, v230
    v_mul_f32 v171, v171, v230
    v_mul_f32 v172, v172, v230
    v_mul_f32 v173, v173, v230
    v_mul_f32 v174, v174, v230
    v_mul_f32 v175, v175, v230
    v_cvt_pk_bf16_f32 v180, v168, v169
    v_cvt_pk_bf16_f32 v181, v170, v171
    v_cvt_pk_bf16_f32 v182, v172, v173
    v_cvt_pk_bf16_f32 v183, v174, v175
    buffer_store_dwordx4 v[180:183], v244, s[20:23], s40 offen offset:2560 sc1
    v_accvgpr_read_b32 v160, a112
    v_accvgpr_read_b32 v161, a113
    v_accvgpr_read_b32 v162, a114
    v_accvgpr_read_b32 v163, a115
    v_accvgpr_read_b32 v164, a116
    v_accvgpr_read_b32 v165, a117
    v_accvgpr_read_b32 v166, a118
    v_accvgpr_read_b32 v167, a119
    v_mul_f32 v160, v160, v230
    v_mul_f32 v161, v161, v230
    v_mul_f32 v162, v162, v230
    v_mul_f32 v163, v163, v230
    v_mul_f32 v164, v164, v230
    v_mul_f32 v165, v165, v230
    v_mul_f32 v166, v166, v230
    v_mul_f32 v167, v167, v230
    v_cvt_pk_bf16_f32 v184, v160, v161
    v_cvt_pk_bf16_f32 v185, v162, v163
    v_cvt_pk_bf16_f32 v186, v164, v165
    v_cvt_pk_bf16_f32 v187, v166, v167
    buffer_store_dwordx4 v[184:187], v244, s[20:23], s40 offen offset:3072 sc1
    v_accvgpr_read_b32 v168, a120
    v_accvgpr_read_b32 v169, a121
    v_accvgpr_read_b32 v170, a122
    v_accvgpr_read_b32 v171, a123
    v_accvgpr_read_b32 v172, a124
    v_accvgpr_read_b32 v173, a125
    v_accvgpr_read_b32 v174, a126
    v_accvgpr_read_b32 v175, a127
    v_mul_f32 v168, v168, v230
    v_mul_f32 v169, v169, v230
    v_mul_f32 v170, v170, v230
    v_mul_f32 v171, v171, v230
    v_mul_f32 v172, v172, v230
    v_mul_f32 v173, v173, v230
    v_mul_f32 v174, v174, v230
    v_mul_f32 v175, v175, v230
    v_cvt_pk_bf16_f32 v188, v168, v169
    v_cvt_pk_bf16_f32 v189, v170, v171
    v_cvt_pk_bf16_f32 v190, v172, v173
    v_cvt_pk_bf16_f32 v191, v174, v175
    buffer_store_dwordx4 v[188:191], v244, s[20:23], s40 offen offset:3584 sc1
ka_done:
    s_endpgm
ka_fix1:
    s_cmp_eq_u32 s36, 0
    s_cselect_b32 s24, 0, 0x74000000
    v_subrev_f32 v230, s24, v243
    v_add_f32 v231, 0, v230
    v_min_f32 v64, v228, v231
    v_add_f32 v232, 0xf1800000, v230
    v_min_f32 v65, v228, v232
    v_add_f32 v231, 0xf2000000, v230
    v_min_f32 v66, v228, v231
    v_add_f32 v232, 0xf2400000, v230
    v_min_f32 v67, v228, v232
    v_add_f32 v231, 0xf3000000, v230
    v_min_f32 v68, v228, v231
    v_add_f32 v232, 0xf3100000, v230
    v_min_f32 v69, v228, v232
    v_add_f32 v231, 0xf3200000, v230
    v_min_f32 v70, v228, v231
    v_add_f32 v232, 0xf3300000, v230
    v_min_f32 v71, v228, v232
    v_add_f32 v231, 0xf3800000, v230
    v_min_f32 v72, v228, v231
    v_add_f32 v232, 0xf3880000, v230
    v_min_f32 v73, v228, v232
    v_add_f32 v231, 0xf3900000, v230
    v_min_f32 v74, v228, v231
    v_add_f32 v232, 0xf3980000, v230
    v_min_f32 v75, v228, v232
    v_add_f32 v231, 0xf3c00000, v230
    v_min_f32 v76, v228, v231
    v_add_f32 v232, 0xf3c80000, v230
    v_min_f32 v77, v228, v232
    v_add_f32 v231, 0xf3d00000, v230
    v_min_f32 v78, v228, v231
    v_add_f32 v232, 0xf3d80000, v230
    v_min_f32 v79, v228, v232
    s_nop 1
    s_branch ka_fixr2
ka_fix3:
    s_cmp_eq_u32 s36, 0
    s_cselect_b32 s24, 0, 0x74000000
    v_subrev_f32 v230, s24, v243
    v_add_f32 v231, 0, v230
    v_min_f32 v64, v228, v231
    v_add_f32 v232, 0xf1800000, v230
    v_min_f32 v65, v228, v232
    v_add_f32 v231, 0xf2000000, v230
    v_min_f32 v66, v228, v231
    v_add_f32 v232, 0xf2400000, v230
    v_min_f32 v67, v228, v232
    v_add_f32 v231, 0xf3000000, v230
    v_min_f32 v68, v228, v231
    v_add_f32 v232, 0xf3100000, v230
    v_min_f32 v69, v228, v232
    v_add_f32 v231, 0xf3200000, v230
    v_min_f32 v70, v228, v231
    v_add_f32 v232, 0xf3300000, v230
    v_min_f32 v71, v228, v232
    v_add_f32 v231, 0xf3800000, v230
    v_min_f32 v72, v228, v231
    v_add_f32 v232, 0xf3880000, v230
    v_min_f32 v73, v228, v232
    v_add_f32 v231, 0xf3900000, v230
    v_min_f32 v74, v228, v231
    v_add_f32 v232, 0xf3980000, v230
    v_min_f32 v75, v228, v232
    v_add_f32 v231, 0xf3c00000, v230
    v_min_f32 v76, v228, v231
    v_add_f32 v232, 0xf3c80000, v230
    v_min_f32 v77, v228, v232
    v_add_f32 v231, 0xf3d00000, v230
    v_min_f32 v78, v228, v231
    v_add_f32 v232, 0xf3d80000, v230
    v_min_f32 v79, v228, v232
    s_nop 1
    s_branch ka_fixr4
ka_fix5:
    s_cmp_eq_u32 s36, 0
    s_cselect_b32 s24, 0, 0x74000000
    v_subrev_f32 v230, s24, v243
    v_add_f32 v231, 0, v230
    v_min_f32 v64, v228, v231
    v_add_f32 v232, 0xf1800000, v230
    v_min_f32 v65, v228, v232
    v_add_f32 v231, 0xf2000000, v230
    v_min_f32 v66, v228, v231
    v_add_f32 v232, 0xf2400000, v230
    v_min_f32 v67, v228, v232
    v_add_f32 v231, 0xf3000000, v230
    v_min_f32 v68, v228, v231
    v_add_f32 v232, 0xf3100000, v230
    v_min_f32 v69, v228, v232
    v_add_f32 v231, 0xf3200000, v230
    v_min_f32 v70, v228, v231
    v_add_f32 v232, 0xf3300000, v230
    v_min_f32 v71, v228, v232
    v_add_f32 v231, 0xf3800000, v230
    v_min_f32 v72, v228, v231
    v_add_f32 v232, 0xf3880000, v230
    v_min_f32 v73, v228, v232
    v_add_f32 v231, 0xf3900000, v230
    v_min_f32 v74, v228, v231
    v_add_f32 v232, 0xf3980000, v230
    v_min_f32 v75, v228, v232
    v_add_f32 v231, 0xf3c00000, v230
    v_min_f32 v76, v228, v231
    v_add_f32 v232, 0xf3c80000, v230
    v_min_f32 v77, v228, v232
    v_add_f32 v231, 0xf3d00000, v230
    v_min_f32 v78, v228, v231
    v_add_f32 v232, 0xf3d80000, v230
    v_min_f32 v79, v228, v232
    s_nop 1
    s_branch ka_fixr6
ka_rare8:
    s_nop 15
    v_max3_f32 v230, v32, v33, v34
    v_max3_f32 v230, v230, v35, v36
    v_max3_f32 v230, v230, v37, v38
    v_max3_f32 v230, v230, v39, v40
    v_max3_f32 v230, v230, v41, v42
    v_max3_f32 v230, v230, v43, v44
    v_max3_f32 v230, v230, v45, v46
    v_max_f32 v230, v230, v47
    v_mov_b32 v231, v230
    s_nop 1
    v_permlane32_swap_b32 v230, v231
    s_nop 0
    v_max_f32 v230, v230, v231
    v_max_f32 v230, 0, v230
    v_sub_f32 v232, 0, v230
    v_exp_f32 v232, v232
    v_sub_f32 v228, v228, v230
    v_sub_f32 v64, v64, v230
    v_sub_f32 v0, v0, v230
    v_sub_f32 v32, v32, v230
    v_sub_f32 v65, v65, v230
    v_sub_f32 v1, v1, v230
    v_sub_f32 v33, v33, v230
    v_sub_f32 v66, v66, v230
    v_sub_f32 v2, v2, v230
    v_sub_f32 v34, v34, v230
    v_sub_f32 v67, v67, v230
    v_sub_f32 v3, v3, v230
    v_sub_f32 v35, v35, v230
    v_sub_f32 v68, v68, v230
    v_sub_f32 v4, v4, v230
    v_sub_f32 v36, v36, v230
    v_sub_f32 v69, v69, v230
    v_sub_f32 v5, v5, v230
    v_sub_f32 v37, v37, v230
    v_sub_f32 v70, v70, v230
    v_sub_f32 v6, v6, v230
    v_sub_f32 v38, v38, v230
    v_sub_f32 v71, v71, v230
    v_sub_f32 v7, v7, v230
    v_sub_f32 v39, v39, v230
    v_sub_f32 v72, v72, v230
    v_sub_f32 v8, v8, v230
    v_sub_f32 v40, v40, v230
    v_sub_f32 v73, v73, v230
    v_sub_f32 v9, v9, v230
    v_sub_f32 v41, v41, v230
    v_sub_f32 v74, v74, v230
    v_sub_f32 v10, v10, v230
    v_sub_f32 v42, v42, v230
    v_sub_f32 v75, v75, v230
    v_sub_f32 v11, v11, v230
    v_sub_f32 v43, v43, v230
    v_sub_f32 v76, v76, v230
    v_sub_f32 v12, v12, v230
    v_sub_f32 v44, v44, v230
    v_sub_f32 v77, v77, v230
    v_sub_f32 v13, v13, v230
    v_sub_f32 v45, v45, v230
    v_sub_f32 v78, v78, v230
    v_sub_f32 v14, v14, v230
    v_sub_f32 v46, v46, v230
    v_sub_f32 v79, v79, v230
    v_sub_f32 v15, v15, v230
    v_sub_f32 v47, v47, v230
    v_mul_f32 v226, v226, v232
    v_accvgpr_read_b32 v234, a0
    v_mul_f32 v234, v234, v232
    v_accvgpr_write_b32 a0, v234
    v_accvgpr_read_b32 v235, a1
    v_mul_f32 v235, v235, v232
    v_accvgpr_write_b32 a1, v235
    v_accvgpr_read_b32 v236, a2
    v_mul_f32 v236, v236, v232
    v_accvgpr_write_b32 a2, v236
    v_accvgpr_read_b32 v237, a3
    v_mul_f32 v237, v237, v232
    v_accvgpr_write_b32 a3, v237
    v_accvgpr_read_b32 v234, a4
    v_mul_f32 v234, v234, v232
    v_accvgpr_write_b32 a4, v234
    v_accvgpr_read_b32 v235, a5
    v_mul_f32 v235, v235, v232
    v_accvgpr_write_b32 a5, v235
    v_accvgpr_read_b32 v236, a6
    v_mul_f32 v236, v236, v232
    v_accvgpr_write_b32 a6, v236
    v_accvgpr_read_b32 v237, a7
    v_mul_f32 v237, v237, v232
    v_accvgpr_write_b32 a7, v237
    v_accvgpr_read_b32 v234, a8
    v_mul_f32 v234, v234, v232
    v_accvgpr_write_b32 a8, v234
    v_accvgpr_read_b32 v235, a9
    v_mul_f32 v235, v235, v232
    v_accvgpr_write_b32 a9, v235
    v_accvgpr_read_b32 v236, a10
    v_mul_f32 v236, v236, v232
    v_accvgpr_write_b32 a10, v236
    v_accvgpr_read_b32 v237, a11
    v_mul_f32 v237, v237, v232
    v_accvgpr_write_b32 a11, v237
    v_accvgpr_read_b32 v234, a12
    v_mul_f32 v234, v234, v232
    v_accvgpr_write_b32 a12, v234
    v_accvgpr_read_b32 v235, a13
    v_mul_f32 v235, v235, v232
    v_accvgpr_write_b32 a13, v235
    v_accvgpr_read_b32 v236, a14
    v_mul_f32 v236, v236, v232
    v_accvgpr_write_b32 a14, v236
    v_accvgpr_read_b32 v237, a15
    v_mul_f32 v237, v237, v232
    v_accvgpr_write_b32 a15, v237
    v_accvgpr_read_b32 v234, a16
    v_mul_f32 v234, v234, v232
    v_accvgpr_write_b32 a16, v234
    v_accvgpr_read_b32 v235, a17
    v_mul_f32 v235, v235, v232
    v_accvgpr_write_b32 a17, v235
    v_accvgpr_read_b32 v236, a18
    v_mul_f32 v236, v236, v232
    v_accvgpr_write_b32 a18, v236
    v_accvgpr_read_b32 v237, a19
    v_mul_f32 v237, v237, v232
    v_accvgpr_write_b32 a19, v237
    v_accvgpr_read_b32 v234, a20
    v_mul_f32 v234, v234, v232
    v_accvgpr_write_b32 a20, v234
    v_accvgpr_read_b32 v235, a21
    v_mul_f32 v235, v235, v232
    v_accvgpr_write_b32 a21, v235
    v_accvgpr_read_b32 v236, a22
    v_mul_f32 v236, v236, v232
    v_accvgpr_write_b32 a22, v236
    v_accvgpr_read_b32 v237, a23
    v_mul_f32 v237, v237, v232
    v_accvgpr_write_b32 a23, v237
    v_accvgpr_read_b32 v234, a24
    v_mul_f32 v234, v234, v232
    v_accvgpr_write_b32 a24, v234
    v_accvgpr_read_b32 v235, a25
    v_mul_f32 v235, v235, v232
    v_accvgpr_write_b32 a25, v235
    v_accvgpr_read_b32 v236, a26
    v_mul_f32 v236, v236, v232
    v_accvgpr_write_b32 a26, v236
    v_accvgpr_read_b32 v237, a27
    v_mul_f32 v237, v237, v232
    v_accvgpr_write_b32 a27, v237
    v_accvgpr_read_b32 v234, a28
    v_mul_f32 v234, v234, v232
    v_accvgpr_write_b32 a28, v234
    v_accvgpr_read_b32 v235, a29
    v_mul_f32 v235, v235, v232
    v_accvgpr_write_b32 a29, v235
    v_accvgpr_read_b32 v236, a30
    v_mul_f32 v236, v236, v232
    v_accvgpr_write_b32 a30, v236
    v_accvgpr_read_b32 v237, a31
    v_mul_f32 v237, v237, v232
    v_accvgpr_write_b32 a31, v237
    v_accvgpr_read_b32 v234, a32
    v_mul_f32 v234, v234, v232
    v_accvgpr_write_b32 a32, v234
    v_accvgpr_read_b32 v235, a33
    v_mul_f32 v235, v235, v232
    v_accvgpr_write_b32 a33, v235
    v_accvgpr_read_b32 v236, a34
    v_mul_f32 v236, v236, v232
    v_accvgpr_write_b32 a34, v236
    v_accvgpr_read_b32 v237, a35
    v_mul_f32 v237, v237, v232
    v_accvgpr_write_b32 a35, v237
    v_accvgpr_read_b32 v234, a36
    v_mul_f32 v234, v234, v232
    v_accvgpr_write_b32 a36, v234
    v_accvgpr_read_b32 v235, a37
    v_mul_f32 v235, v235, v232
    v_accvgpr_write_b32 a37, v235
    v_accvgpr_read_b32 v236, a38
    v_mul_f32 v236, v236, v232
    v_accvgpr_write_b32 a38, v236
    v_accvgpr_read_b32 v237, a39
    v_mul_f32 v237, v237, v232
    v_accvgpr_write_b32 a39, v237
    v_accvgpr_read_b32 v234, a40
    v_mul_f32 v234, v234, v232
    v_accvgpr_write_b32 a40, v234
    v_accvgpr_read_b32 v235, a41
    v_mul_f32 v235, v235, v232
    v_accvgpr_write_b32 a41, v235
    v_accvgpr_read_b32 v236, a42
    v_mul_f32 v236, v236, v232
    v_accvgpr_write_b32 a42, v236
    v_accvgpr_read_b32 v237, a43
    v_mul_f32 v237, v237, v232
    v_accvgpr_write_b32 a43, v237
    v_accvgpr_read_b32 v234, a44
    v_mul_f32 v234, v234, v232
    v_accvgpr_write_b32 a44, v234
    v_accvgpr_read_b32 v235, a45
    v_mul_f32 v235, v235, v232
    v_accvgpr_write_b32 a45, v235
    v_accvgpr_read_b32 v236, a46
    v_mul_f32 v236, v236, v232
    v_accvgpr_write_b32 a46, v236
    v_accvgpr_read_b32 v237, a47
    v_mul_f32 v237, v237, v232
    v_accvgpr_write_b32 a47, v237
    v_accvgpr_read_b32 v234, a48
    v_mul_f32 v234, v234, v232
    v_accvgpr_write_b32 a48, v234
    v_accvgpr_read_b32 v235, a49
    v_mul_f32 v235, v235, v232
    v_accvgpr_write_b32 a49, v235
    v_accvgpr_read_b32 v236, a50
    v_mul_f32 v236, v236, v232
    v_accvgpr_write_b32 a50, v236
    v_accvgpr_read_b32 v237, a51
    v_mul_f32 v237, v237, v232
    v_accvgpr_write_b32 a51, v237
    v_accvgpr_read_b32 v234, a52
    v_mul_f32 v234, v234, v232
    v_accvgpr_write_b32 a52, v234
    v_accvgpr_read_b32 v235, a53
    v_mul_f32 v235, v235, v232
    v_accvgpr_write_b32 a53, v235
    v_accvgpr_read_b32 v236, a54
    v_mul_f32 v236, v236, v232
    v_accvgpr_write_b32 a54, v236
    v_accvgpr_read_b32 v237, a55
    v_mul_f32 v237, v237, v232
    v_accvgpr_write_b32 a55, v237
    v_accvgpr_read_b32 v234, a56
    v_mul_f32 v234, v234, v232
    v_accvgpr_write_b32 a56, v234
    v_accvgpr_read_b32 v235, a57
    v_mul_f32 v235, v235, v232
    v_accvgpr_write_b32 a57, v235
    v_accvgpr_read_b32 v236, a58
    v_mul_f32 v236, v236, v232
    v_accvgpr_write_b32 a58, v236
    v_accvgpr_read_b32 v237, a59
    v_mul_f32 v237, v237, v232
    v_accvgpr_write_b32 a59, v237
    v_accvgpr_read_b32 v234, a60
    v_mul_f32 v234, v234, v232
    v_accvgpr_write_b32 a60, v234
    v_accvgpr_read_b32 v235, a61
    v_mul_f32 v235, v235, v232
    v_accvgpr_write_b32 a61, v235
    v_accvgpr_read_b32 v236, a62
    v_mul_f32 v236, v236, v232
    v_accvgpr_write_b32 a62, v236
    v_accvgpr_read_b32 v237, a63
    v_mul_f32 v237, v237, v232
    v_accvgpr_write_b32 a63, v237
    v_exp_f32 v136, v32
    v_exp_f32 v137, v33
    v_exp_f32 v130, v34
    v_exp_f32 v131, v35
    v_cvt_pk_bf16_f32 v112, v136, v137
    v_exp_f32 v132, v36
    v_exp_f32 v133, v37
    v_cvt_pk_bf16_f32 v113, v130, v131
    v_add_f32 v136, v136, v130
    v_add_f32 v137, v137, v131
    v_exp_f32 v134, v38
    v_exp_f32 v135, v39
    v_cvt_pk_bf16_f32 v114, v132, v133
    v_add_f32 v136, v136, v132
    v_add_f32 v137, v137, v133
    v_exp_f32 v128, v40
    v_exp_f32 v129, v41
    v_cvt_pk_bf16_f32 v115, v134, v135
    v_add_f32 v136, v136, v134
    v_add_f32 v137, v137, v135
    v_exp_f32 v130, v42
    v_exp_f32 v131, v43
    v_cvt_pk_bf16_f32 v116, v128, v129
    v_add_f32 v136, v136, v128
    v_add_f32 v137, v137, v129
    v_exp_f32 v132, v44
    v_exp_f32 v133, v45
    v_cvt_pk_bf16_f32 v117, v130, v131
    v_add_f32 v136, v136, v130
    v_add_f32 v137, v137, v131
    v_exp_f32 v134, v46
    v_exp_f32 v135, v47
    v_cvt_pk_bf16_f32 v118, v132, v133
    v_add_f32 v136, v136, v132
    v_add_f32 v137, v137, v133
    v_cvt_pk_bf16_f32 v119, v134, v135
    v_add_f32 v136, v136, v134
    v_add_f32 v137, v137, v135
    v_add_f32 v224, v136, v137
    v_max3_f32 v230, v48, v49, v50
    v_max3_f32 v230, v230, v51, v52
    v_max3_f32 v230, v230, v53, v54
    v_max3_f32 v230, v230, v55, v56
    v_max3_f32 v230, v230, v57, v58
    v_max3_f32 v230, v230, v59, v60
    v_max3_f32 v230, v230, v61, v62
    v_max_f32 v230, v230, v63
    v_mov_b32 v231, v230
    s_nop 1
    v_permlane32_swap_b32 v230, v231
    s_nop 0
    v_max_f32 v230, v230, v231
    v_max_f32 v230, 0, v230
    v_sub_f32 v232, 0, v230
    v_exp_f32 v232, v232
    v_sub_f32 v229, v229, v230
    v_sub_f32 v80, v80, v230
    v_sub_f32 v16, v16, v230
    v_sub_f32 v48, v48, v230
    v_sub_f32 v81, v81, v230
    v_sub_f32 v17, v17, v230
    v_sub_f32 v49, v49, v230
    v_sub_f32 v82, v82, v230
    v_sub_f32 v18, v18, v230
    v_sub_f32 v50, v50, v230
    v_sub_f32 v83, v83, v230
    v_sub_f32 v19, v19, v230
    v_sub_f32 v51, v51, v230
    v_sub_f32 v84, v84, v230
    v_sub_f32 v20, v20, v230
    v_sub_f32 v52, v52, v230
    v_sub_f32 v85, v85, v230
    v_sub_f32 v21, v21, v230
    v_sub_f32 v53, v53, v230
    v_sub_f32 v86, v86, v230
    v_sub_f32 v22, v22, v230
    v_sub_f32 v54, v54, v230
    v_sub_f32 v87, v87, v230
    v_sub_f32 v23, v23, v230
    v_sub_f32 v55, v55, v230
    v_sub_f32 v88, v88, v230
    v_sub_f32 v24, v24, v230
    v_sub_f32 v56, v56, v230
    v_sub_f32 v89, v89, v230
    v_sub_f32 v25, v25, v230
    v_sub_f32 v57, v57, v230
    v_sub_f32 v90, v90, v230
    v_sub_f32 v26, v26, v230
    v_sub_f32 v58, v58, v230
    v_sub_f32 v91, v91, v230
    v_sub_f32 v27, v27, v230
    v_sub_f32 v59, v59, v230
    v_sub_f32 v92, v92, v230
    v_sub_f32 v28, v28, v230
    v_sub_f32 v60, v60, v230
    v_sub_f32 v93, v93, v230
    v_sub_f32 v29, v29, v230
    v_sub_f32 v61, v61, v230
    v_sub_f32 v94, v94, v230
    v_sub_f32 v30, v30, v230
    v_sub_f32 v62, v62, v230
    v_sub_f32 v95, v95, v230
    v_sub_f32 v31, v31, v230
    v_sub_f32 v63, v63, v230
    v_mul_f32 v227, v227, v232
    v_accvgpr_read_b32 v234, a64
    v_mul_f32 v234, v234, v232
    v_accvgpr_write_b32 a64, v234
    v_accvgpr_read_b32 v235, a65
    v_mul_f32 v235, v235, v232
    v_accvgpr_write_b32 a65, v235
    v_accvgpr_read_b32 v236, a66
    v_mul_f32 v236, v236, v232
    v_accvgpr_write_b32 a66, v236
    v_accvgpr_read_b32 v237, a67
    v_mul_f32 v237, v237, v232
    v_accvgpr_write_b32 a67, v237
    v_accvgpr_read_b32 v234, a68
    v_mul_f32 v234, v234, v232
    v_accvgpr_write_b32 a68, v234
    v_accvgpr_read_b32 v235, a69
    v_mul_f32 v235, v235, v232
    v_accvgpr_write_b32 a69, v235
    v_accvgpr_read_b32 v236, a70
    v_mul_f32 v236, v236, v232
    v_accvgpr_write_b32 a70, v236
    v_accvgpr_read_b32 v237, a71
    v_mul_f32 v237, v237, v232
    v_accvgpr_write_b32 a71, v237
    v_accvgpr_read_b32 v234, a72
    v_mul_f32 v234, v234, v232
    v_accvgpr_write_b32 a72, v234
    v_accvgpr_read_b32 v235, a73
    v_mul_f32 v235, v235, v232
    v_accvgpr_write_b32 a73, v235
    v_accvgpr_read_b32 v236, a74
    v_mul_f32 v236, v236, v232
    v_accvgpr_write_b32 a74, v236
    v_accvgpr_read_b32 v237, a75
    v_mul_f32 v237, v237, v232
    v_accvgpr_write_b32 a75, v237
    v_accvgpr_read_b32 v234, a76
    v_mul_f32 v234, v234, v232
    v_accvgpr_write_b32 a76, v234
    v_accvgpr_read_b32 v235, a77
    v_mul_f32 v235, v235, v232
    v_accvgpr_write_b32 a77, v235
    v_accvgpr_read_b32 v236, a78
    v_mul_f32 v236, v236, v232
    v_accvgpr_write_b32 a78, v236
    v_accvgpr_read_b32 v237, a79
    v_mul_f32 v237, v237, v232
    v_accvgpr_write_b32 a79, v237
    v_accvgpr_read_b32 v234, a80
    v_mul_f32 v234, v234, v232
    v_accvgpr_write_b32 a80, v234
    v_accvgpr_read_b32 v235, a81
    v_mul_f32 v235, v235, v232
    v_accvgpr_write_b32 a81, v235
    v_accvgpr_read_b32 v236, a82
    v_mul_f32 v236, v236, v232
    v_accvgpr_write_b32 a82, v236
    v_accvgpr_read_b32 v237, a83
    v_mul_f32 v237, v237, v232
    v_accvgpr_write_b32 a83, v237
    v_accvgpr_read_b32 v234, a84
    v_mul_f32 v234, v234, v232
    v_accvgpr_write_b32 a84, v234
    v_accvgpr_read_b32 v235, a85
    v_mul_f32 v235, v235, v232
    v_accvgpr_write_b32 a85, v235
    v_accvgpr_read_b32 v236, a86
    v_mul_f32 v236, v236, v232
    v_accvgpr_write_b32 a86, v236
    v_accvgpr_read_b32 v237, a87
    v_mul_f32 v237, v237, v232
    v_accvgpr_write_b32 a87, v237
    v_accvgpr_read_b32 v234, a88
    v_mul_f32 v234, v234, v232
    v_accvgpr_write_b32 a88, v234
    v_accvgpr_read_b32 v235, a89
    v_mul_f32 v235, v235, v232
    v_accvgpr_write_b32 a89, v235
    v_accvgpr_read_b32 v236, a90
    v_mul_f32 v236, v236, v232
    v_accvgpr_write_b32 a90, v236
    v_accvgpr_read_b32 v237, a91
    v_mul_f32 v237, v237, v232
    v_accvgpr_write_b32 a91, v237
    v_accvgpr_read_b32 v234, a92
    v_mul_f32 v234, v234, v232
    v_accvgpr_write_b32 a92, v234
    v_accvgpr_read_b32 v235, a93
    v_mul_f32 v235, v235, v232
    v_accvgpr_write_b32 a93, v235
    v_accvgpr_read_b32 v236, a94
    v_mul_f32 v236, v236, v232
    v_accvgpr_write_b32 a94, v236
    v_accvgpr_read_b32 v237, a95
    v_mul_f32 v237, v237, v232
    v_accvgpr_write_b32 a95, v237
    v_accvgpr_read_b32 v234, a96
    v_mul_f32 v234, v234, v232
    v_accvgpr_write_b32 a96, v234
    v_accvgpr_read_b32 v235, a97
    v_mul_f32 v235, v235, v232
    v_accvgpr_write_b32 a97, v235
    v_accvgpr_read_b32 v236, a98
    v_mul_f32 v236, v236, v232
    v_accvgpr_write_b32 a98, v236
    v_accvgpr_read_b32 v237, a99
    v_mul_f32 v237, v237, v232
    v_accvgpr_write_b32 a99, v237
    v_accvgpr_read_b32 v234, a100
    v_mul_f32 v234, v234, v232
    v_accvgpr_write_b32 a100, v234
    v_accvgpr_read_b32 v235, a101
    v_mul_f32 v235, v235, v232
    v_accvgpr_write_b32 a101, v235
    v_accvgpr_read_b32 v236, a102
    v_mul_f32 v236, v236, v232
    v_accvgpr_write_b32 a102, v236
    v_accvgpr_read_b32 v237, a103
    v_mul_f32 v237, v237, v232
    v_accvgpr_write_b32 a103, v237
    v_accvgpr_read_b32 v234, a104
    v_mul_f32 v234, v234, v232
    v_accvgpr_write_b32 a104, v234
    v_accvgpr_read_b32 v235, a105
    v_mul_f32 v235, v235, v232
    v_accvgpr_write_b32 a105, v235
    v_accvgpr_read_b32 v236, a106
    v_mul_f32 v236, v236, v232
    v_accvgpr_write_b32 a106, v236
    v_accvgpr_read_b32 v237, a107
    v_mul_f32 v237, v237, v232
    v_accvgpr_write_b32 a107, v237
    v_accvgpr_read_b32 v234, a108
    v_mul_f32 v234, v234, v232
    v_accvgpr_write_b32 a108, v234
    v_accvgpr_read_b32 v235, a109
    v_mul_f32 v235, v235, v232
    v_accvgpr_write_b32 a109, v235
    v_accvgpr_read_b32 v236, a110
    v_mul_f32 v236, v236, v232
    v_accvgpr_write_b32 a110, v236
    v_accvgpr_read_b32 v237, a111
    v_mul_f32 v237, v237, v232
    v_accvgpr_write_b32 a111, v237
    v_accvgpr_read_b32 v234, a112
    v_mul_f32 v234, v234, v232
    v_accvgpr_write_b32 a112, v234
    v_accvgpr_read_b32 v235, a113
    v_mul_f32 v235, v235, v232
    v_accvgpr_write_b32 a113, v235
    v_accvgpr_read_b32 v236, a114
    v_mul_f32 v236, v236, v232
    v_accvgpr_write_b32 a114, v236
    v_accvgpr_read_b32 v237, a115
    v_mul_f32 v237, v237, v232
    v_accvgpr_write_b32 a115, v237
    v_accvgpr_read_b32 v234, a116
    v_mul_f32 v234, v234, v232
    v_accvgpr_write_b32 a116, v234
    v_accvgpr_read_b32 v235, a117
    v_mul_f32 v235, v235, v232
    v_accvgpr_write_b32 a117, v235
    v_accvgpr_read_b32 v236, a118
    v_mul_f32 v236, v236, v232
    v_accvgpr_write_b32 a118, v236
    v_accvgpr_read_b32 v237, a119
    v_mul_f32 v237, v237, v232
    v_accvgpr_write_b32 a119, v237
    v_accvgpr_read_b32 v234, a120
    v_mul_f32 v234, v234, v232
    v_accvgpr_write_b32 a120, v234
    v_accvgpr_read_b32 v235, a121
    v_mul_f32 v235, v235, v232
    v_accvgpr_write_b32 a121, v235
    v_accvgpr_read_b32 v236, a122
    v_mul_f32 v236, v236, v232
    v_accvgpr_write_b32 a122, v236
    v_accvgpr_read_b32 v237, a123
    v_mul_f32 v237, v237, v232
    v_accvgpr_write_b32 a123, v237
    v_accvgpr_read_b32 v234, a124
    v_mul_f32 v234, v234, v232
    v_accvgpr_write_b32 a124, v234
    v_accvgpr_read_b32 v235, a125
    v_mul_f32 v235, v235, v232
    v_accvgpr_write_b32 a125, v235
    v_accvgpr_read_b32 v236, a126
    v_mul_f32 v236, v236, v232
    v_accvgpr_write_b32 a126, v236
    v_accvgpr_read_b32 v237, a127
    v_mul_f32 v237, v237, v232
    v_accvgpr_write_b32 a127, v237
    v_exp_f32 v138, v48
    v_exp_f32 v139, v49
    v_exp_f32 v130, v50
    v_exp_f32 v131, v51
    v_cvt_pk_bf16_f32 v120, v138, v139
    v_exp_f32 v132, v52
    v_exp_f32 v133, v53
    v_cvt_pk_bf16_f32 v121, v130, v131
    v_add_f32 v138, v138, v130
    v_add_f32 v139, v139, v131
    v_exp_f32 v134, v54
    v_exp_f32 v135, v55
    v_cvt_pk_bf16_f32 v122, v132, v133
    v_add_f32 v138, v138, v132
    v_add_f32 v139, v139, v133
    v_exp_f32 v128, v56
    v_exp_f32 v129, v57
    v_cvt_pk_bf16_f32 v123, v134, v135
    v_add_f32 v138, v138, v134
    v_add_f32 v139, v139, v135
    v_exp_f32 v130, v58
    v_exp_f32 v131, v59
    v_cvt_pk_bf16_f32 v124, v128, v129
    v_add_f32 v138, v138, v128
    v_add_f32 v139, v139, v129
    v_exp_f32 v132, v60
    v_exp_f32 v133, v61
    v_cvt_pk_bf16_f32 v125, v130, v131
    v_add_f32 v138, v138, v130
    v_add_f32 v139, v139, v131
    v_exp_f32 v134, v62
    v_exp_f32 v135, v63
    v_cvt_pk_bf16_f32 v126, v132, v133
    v_add_f32 v138, v138, v132
    v_add_f32 v139, v139, v133
    v_cvt_pk_bf16_f32 v127, v134, v135
    v_add_f32 v138, v138, v134
    v_add_f32 v139, v139, v135
    v_add_f32 v225, v138, v139
    s_nop 1
    s_branch ka_rr7
ka_fix9:
    s_cmp_eq_u32 s36, 0
    s_cselect_b32 s24, 0, 0x74000000
    v_subrev_f32 v230, s24, v243
    v_add_f32 v231, 0, v230
    v_min_f32 v64, v228, v231
    v_add_f32 v232, 0xf1800000, v230
    v_min_f32 v65, v228, v232
    v_add_f32 v231, 0xf2000000, v230
    v_min_f32 v66, v228, v231
    v_add_f32 v232, 0xf2400000, v230
    v_min_f32 v67, v228, v232
    v_add_f32 v231, 0xf3000000, v230
    v_min_f32 v68, v228, v231
    v_add_f32 v232, 0xf3100000, v230
    v_min_f32 v69, v228, v232
    v_add_f32 v231, 0xf3200000, v230
    v_min_f32 v70, v228, v231
    v_add_f32 v232, 0xf3300000, v230
    v_min_f32 v71, v228, v232
    v_add_f32 v231, 0xf3800000, v230
    v_min_f32 v72, v228, v231
    v_add_f32 v232, 0xf3880000, v230
    v_min_f32 v73, v228, v232
    v_add_f32 v231, 0xf3900000, v230
    v_min_f32 v74, v228, v231
    v_add_f32 v232, 0xf3980000, v230
    v_min_f32 v75, v228, v232
    v_add_f32 v231, 0xf3c00000, v230
    v_min_f32 v76, v228, v231
    v_add_f32 v232, 0xf3c80000, v230
    v_min_f32 v77, v228, v232
    v_add_f32 v231, 0xf3d00000, v230
    v_min_f32 v78, v228, v231
    v_add_f32 v232, 0xf3d80000, v230
    v_min_f32 v79, v228, v232
    s_nop 1
    s_branch ka_fixr10
ka_rare12:
    s_nop 15
    v_max3_f32 v230, v0, v1, v2
    v_max3_f32 v230, v230, v3, v4
    v_max3_f32 v230, v230, v5, v6
    v_max3_f32 v230, v230, v7, v8
    v_max3_f32 v230, v230, v9, v10
    v_max3_f32 v230, v230, v11, v12
    v_max3_f32 v230, v230, v13, v14
    v_max_f32 v230, v230, v15
    v_mov_b32 v231, v230
    s_nop 1
    v_permlane32_swap_b32 v230, v231
    s_nop 0
    v_max_f32 v230, v230, v231
    v_max_f32 v230, 0, v230
    v_sub_f32 v232, 0, v230
    v_exp_f32 v232, v232
    v_sub_f32 v228, v228, v230
    v_sub_f32 v64, v64, v230
    v_sub_f32 v32, v32, v230
    v_sub_f32 v0, v0, v230
    v_sub_f32 v65, v65, v230
    v_sub_f32 v33, v33, v230
    v_sub_f32 v1, v1, v230
    v_sub_f32 v66, v66, v230
    v_sub_f32 v34, v34, v230
    v_sub_f32 v2, v2, v230
    v_sub_f32 v67, v67, v230
    v_sub_f32 v35, v35, v230
    v_sub_f32 v3, v3, v230
    v_sub_f32 v68, v68, v230
    v_sub_f32 v36, v36, v230
    v_sub_f32 v4, v4, v230
    v_sub_f32 v69, v69, v230
    v_sub_f32 v37, v37, v230
    v_sub_f32 v5, v5, v230
    v_sub_f32 v70, v70, v230
    v_sub_f32 v38, v38, v230
    v_sub_f32 v6, v6, v230
    v_sub_f32 v71, v71, v230
    v_sub_f32 v39, v39, v230
    v_sub_f32 v7, v7, v230
    v_sub_f32 v72, v72, v230
    v_sub_f32 v40, v40, v230
    v_sub_f32 v8, v8, v230
    v_sub_f32 v73, v73, v230
    v_sub_f32 v41, v41, v230
    v_sub_f32 v9, v9, v230
    v_sub_f32 v74, v74, v230
    v_sub_f32 v42, v42, v230
    v_sub_f32 v10, v10, v230
    v_sub_f32 v75, v75, v230
    v_sub_f32 v43, v43, v230
    v_sub_f32 v11, v11, v230
    v_sub_f32 v76, v76, v230
    v_sub_f32 v44, v44, v230
    v_sub_f32 v12, v12, v230
    v_sub_f32 v77, v77, v230
    v_sub_f32 v45, v45, v230
    v_sub_f32 v13, v13, v230
    v_sub_f32 v78, v78, v230
    v_sub_f32 v46, v46, v230
    v_sub_f32 v14, v14, v230
    v_sub_f32 v79, v79, v230
    v_sub_f32 v47, v47, v230
    v_sub_f32 v15, v15, v230
    v_mul_f32 v226, v226, v232
    v_accvgpr_read_b32 v234, a0
    v_mul_f32 v234, v234, v232
    v_accvgpr_write_b32 a0, v234
    v_accvgpr_read_b32 v235, a1
    v_mul_f32 v235, v235, v232
    v_accvgpr_write_b32 a1, v235
    v_accvgpr_read_b32 v236, a2
    v_mul_f32 v236, v236, v232
    v_accvgpr_write_b32 a2, v236
    v_accvgpr_read_b32 v237, a3
    v_mul_f32 v237, v237, v232
    v_accvgpr_write_b32 a3, v237
    v_accvgpr_read_b32 v234, a4
    v_mul_f32 v234, v234, v232
    v_accvgpr_write_b32 a4, v234
    v_accvgpr_read_b32 v235, a5
    v_mul_f32 v235, v235, v232
    v_accvgpr_write_b32 a5, v235
    v_accvgpr_read_b32 v236, a6
    v_mul_f32 v236, v236, v232
    v_accvgpr_write_b32 a6, v236
    v_accvgpr_read_b32 v237, a7
    v_mul_f32 v237, v237, v232
    v_accvgpr_write_b32 a7, v237
    v_accvgpr_read_b32 v234, a8
    v_mul_f32 v234, v234, v232
    v_accvgpr_write_b32 a8, v234
    v_accvgpr_read_b32 v235, a9
    v_mul_f32 v235, v235, v232
    v_accvgpr_write_b32 a9, v235
    v_accvgpr_read_b32 v236, a10
    v_mul_f32 v236, v236, v232
    v_accvgpr_write_b32 a10, v236
    v_accvgpr_read_b32 v237, a11
    v_mul_f32 v237, v237, v232
    v_accvgpr_write_b32 a11, v237
    v_accvgpr_read_b32 v234, a12
    v_mul_f32 v234, v234, v232
    v_accvgpr_write_b32 a12, v234
    v_accvgpr_read_b32 v235, a13
    v_mul_f32 v235, v235, v232
    v_accvgpr_write_b32 a13, v235
    v_accvgpr_read_b32 v236, a14
    v_mul_f32 v236, v236, v232
    v_accvgpr_write_b32 a14, v236
    v_accvgpr_read_b32 v237, a15
    v_mul_f32 v237, v237, v232
    v_accvgpr_write_b32 a15, v237
    v_accvgpr_read_b32 v234, a16
    v_mul_f32 v234, v234, v232
    v_accvgpr_write_b32 a16, v234
    v_accvgpr_read_b32 v235, a17
    v_mul_f32 v235, v235, v232
    v_accvgpr_write_b32 a17, v235
    v_accvgpr_read_b32 v236, a18
    v_mul_f32 v236, v236, v232
    v_accvgpr_write_b32 a18, v236
    v_accvgpr_read_b32 v237, a19
    v_mul_f32 v237, v237, v232
    v_accvgpr_write_b32 a19, v237
    v_accvgpr_read_b32 v234, a20
    v_mul_f32 v234, v234, v232
    v_accvgpr_write_b32 a20, v234
    v_accvgpr_read_b32 v235, a21
    v_mul_f32 v235, v235, v232
    v_accvgpr_write_b32 a21, v235
    v_accvgpr_read_b32 v236, a22
    v_mul_f32 v236, v236, v232
    v_accvgpr_write_b32 a22, v236
    v_accvgpr_read_b32 v237, a23
    v_mul_f32 v237, v237, v232
    v_accvgpr_write_b32 a23, v237
    v_accvgpr_read_b32 v234, a24
    v_mul_f32 v234, v234, v232
    v_accvgpr_write_b32 a24, v234
    v_accvgpr_read_b32 v235, a25
    v_mul_f32 v235, v235, v232
    v_accvgpr_write_b32 a25, v235
    v_accvgpr_read_b32 v236, a26
    v_mul_f32 v236, v236, v232
    v_accvgpr_write_b32 a26, v236
    v_accvgpr_read_b32 v237, a27
    v_mul_f32 v237, v237, v232
    v_accvgpr_write_b32 a27, v237
    v_accvgpr_read_b32 v234, a28
    v_mul_f32 v234, v234, v232
    v_accvgpr_write_b32 a28, v234
    v_accvgpr_read_b32 v235, a29
    v_mul_f32 v235, v235, v232
    v_accvgpr_write_b32 a29, v235
    v_accvgpr_read_b32 v236, a30
    v_mul_f32 v236, v236, v232
    v_accvgpr_write_b32 a30, v236
    v_accvgpr_read_b32 v237, a31
    v_mul_f32 v237, v237, v232
    v_accvgpr_write_b32 a31, v237
    v_accvgpr_read_b32 v234, a32
    v_mul_f32 v234, v234, v232
    v_accvgpr_write_b32 a32, v234
    v_accvgpr_read_b32 v235, a33
    v_mul_f32 v235, v235, v232
    v_accvgpr_write_b32 a33, v235
    v_accvgpr_read_b32 v236, a34
    v_mul_f32 v236, v236, v232
    v_accvgpr_write_b32 a34, v236
    v_accvgpr_read_b32 v237, a35
    v_mul_f32 v237, v237, v232
    v_accvgpr_write_b32 a35, v237
    v_accvgpr_read_b32 v234, a36
    v_mul_f32 v234, v234, v232
    v_accvgpr_write_b32 a36, v234
    v_accvgpr_read_b32 v235, a37
    v_mul_f32 v235, v235, v232
    v_accvgpr_write_b32 a37, v235
    v_accvgpr_read_b32 v236, a38
    v_mul_f32 v236, v236, v232
    v_accvgpr_write_b32 a38, v236
    v_accvgpr_read_b32 v237, a39
    v_mul_f32 v237, v237, v232
    v_accvgpr_write_b32 a39, v237
    v_accvgpr_read_b32 v234, a40
    v_mul_f32 v234, v234, v232
    v_accvgpr_write_b32 a40, v234
    v_accvgpr_read_b32 v235, a41
    v_mul_f32 v235, v235, v232
    v_accvgpr_write_b32 a41, v235
    v_accvgpr_read_b32 v236, a42
    v_mul_f32 v236, v236, v232
    v_accvgpr_write_b32 a42, v236
    v_accvgpr_read_b32 v237, a43
    v_mul_f32 v237, v237, v232
    v_accvgpr_write_b32 a43, v237
    v_accvgpr_read_b32 v234, a44
    v_mul_f32 v234, v234, v232
    v_accvgpr_write_b32 a44, v234
    v_accvgpr_read_b32 v235, a45
    v_mul_f32 v235, v235, v232
    v_accvgpr_write_b32 a45, v235
    v_accvgpr_read_b32 v236, a46
    v_mul_f32 v236, v236, v232
    v_accvgpr_write_b32 a46, v236
    v_accvgpr_read_b32 v237, a47
    v_mul_f32 v237, v237, v232
    v_accvgpr_write_b32 a47, v237
    v_accvgpr_read_b32 v234, a48
    v_mul_f32 v234, v234, v232
    v_accvgpr_write_b32 a48, v234
    v_accvgpr_read_b32 v235, a49
    v_mul_f32 v235, v235, v232
    v_accvgpr_write_b32 a49, v235
    v_accvgpr_read_b32 v236, a50
    v_mul_f32 v236, v236, v232
    v_accvgpr_write_b32 a50, v236
    v_accvgpr_read_b32 v237, a51
    v_mul_f32 v237, v237, v232
    v_accvgpr_write_b32 a51, v237
    v_accvgpr_read_b32 v234, a52
    v_mul_f32 v234, v234, v232
    v_accvgpr_write_b32 a52, v234
    v_accvgpr_read_b32 v235, a53
    v_mul_f32 v235, v235, v232
    v_accvgpr_write_b32 a53, v235
    v_accvgpr_read_b32 v236, a54
    v_mul_f32 v236, v236, v232
    v_accvgpr_write_b32 a54, v236
    v_accvgpr_read_b32 v237, a55
    v_mul_f32 v237, v237, v232
    v_accvgpr_write_b32 a55, v237
    v_accvgpr_read_b32 v234, a56
    v_mul_f32 v234, v234, v232
    v_accvgpr_write_b32 a56, v234
    v_accvgpr_read_b32 v235, a57
    v_mul_f32 v235, v235, v232
    v_accvgpr_write_b32 a57, v235
    v_accvgpr_read_b32 v236, a58
    v_mul_f32 v236, v236, v232
    v_accvgpr_write_b32 a58, v236
    v_accvgpr_read_b32 v237, a59
    v_mul_f32 v237, v237, v232
    v_accvgpr_write_b32 a59, v237
    v_accvgpr_read_b32 v234, a60
    v_mul_f32 v234, v234, v232
    v_accvgpr_write_b32 a60, v234
    v_accvgpr_read_b32 v235, a61
    v_mul_f32 v235, v235, v232
    v_accvgpr_write_b32 a61, v235
    v_accvgpr_read_b32 v236, a62
    v_mul_f32 v236, v236, v232
    v_accvgpr_write_b32 a62, v236
    v_accvgpr_read_b32 v237, a63
    v_mul_f32 v237, v237, v232
    v_accvgpr_write_b32 a63, v237
    v_exp_f32 v136, v0
    v_exp_f32 v137, v1
    v_exp_f32 v130, v2
    v_exp_f32 v131, v3
    v_cvt_pk_bf16_f32 v96, v136, v137
    v_exp_f32 v132, v4
    v_exp_f32 v133, v5
    v_cvt_pk_bf16_f32 v97, v130, v131
    v_add_f32 v136, v136, v130
    v_add_f32 v137, v137, v131
    v_exp_f32 v134, v6
    v_exp_f32 v135, v7
    v_cvt_pk_bf16_f32 v98, v132, v133
    v_add_f32 v136, v136, v132
    v_add_f32 v137, v137, v133
    v_exp_f32 v128, v8
    v_exp_f32 v129, v9
    v_cvt_pk_bf16_f32 v99, v134, v135
    v_add_f32 v136, v136, v134
    v_add_f32 v137, v137, v135
    v_exp_f32 v130, v10
    v_exp_f32 v131, v11
    v_cvt_pk_bf16_f32 v100, v128, v129
    v_add_f32 v136, v136, v128
    v_add_f32 v137, v137, v129
    v_exp_f32 v132, v12
    v_exp_f32 v133, v13
    v_cvt_pk_bf16_f32 v101, v130, v131
    v_add_f32 v136, v136, v130
    v_add_f32 v137, v137, v131
    v_exp_f32 v134, v14
    v_exp_f32 v135, v15
    v_cvt_pk_bf16_f32 v102, v132, v133
    v_add_f32 v136, v136, v132
    v_add_f32 v137, v137, v133
    v_cvt_pk_bf16_f32 v103, v134, v135
    v_add_f32 v136, v136, v134
    v_add_f32 v137, v137, v135
    v_add_f32 v224, v136, v137
    v_max3_f32 v230, v16, v17, v18
    v_max3_f32 v230, v230, v19, v20
    v_max3_f32 v230, v230, v21, v22
    v_max3_f32 v230, v230, v23, v24
    v_max3_f32 v230, v230, v25, v26
    v_max3_f32 v230, v230, v27, v28
    v_max3_f32 v230, v230, v29, v30
    v_max_f32 v230, v230, v31
    v_mov_b32 v231, v230
    s_nop 1
    v_permlane32_swap_b32 v230, v231
    s_nop 0
    v_max_f32 v230, v230, v231
    v_max_f32 v230, 0, v230
    v_sub_f32 v232, 0, v230
    v_exp_f32 v232, v232
    v_sub_f32 v229, v229, v230
    v_sub_f32 v80, v80, v230
    v_sub_f32 v48, v48, v230
    v_sub_f32 v16, v16, v230
    v_sub_f32 v81, v81, v230
    v_sub_f32 v49, v49, v230
    v_sub_f32 v17, v17, v230
    v_sub_f32 v82, v82, v230
    v_sub_f32 v50, v50, v230
    v_sub_f32 v18, v18, v230
    v_sub_f32 v83, v83, v230
    v_sub_f32 v51, v51, v230
    v_sub_f32 v19, v19, v230
    v_sub_f32 v84, v84, v230
    v_sub_f32 v52, v52, v230
    v_sub_f32 v20, v20, v230
    v_sub_f32 v85, v85, v230
    v_sub_f32 v53, v53, v230
    v_sub_f32 v21, v21, v230
    v_sub_f32 v86, v86, v230
    v_sub_f32 v54, v54, v230
    v_sub_f32 v22, v22, v230
    v_sub_f32 v87, v87, v230
    v_sub_f32 v55, v55, v230
    v_sub_f32 v23, v23, v230
    v_sub_f32 v88, v88, v230
    v_sub_f32 v56, v56, v230
    v_sub_f32 v24, v24, v230
    v_sub_f32 v89, v89, v230
    v_sub_f32 v57, v57, v230
    v_sub_f32 v25, v25, v230
    v_sub_f32 v90, v90, v230
    v_sub_f32 v58, v58, v230
    v_sub_f32 v26, v26, v230
    v_sub_f32 v91, v91, v230
    v_sub_f32 v59, v59, v230
    v_sub_f32 v27, v27, v230
    v_sub_f32 v92, v92, v230
    v_sub_f32 v60, v60, v230
    v_sub_f32 v28, v28, v230
    v_sub_f32 v93, v93, v230
    v_sub_f32 v61, v61, v230
    v_sub_f32 v29, v29, v230
    v_sub_f32 v94, v94, v230
    v_sub_f32 v62, v62, v230
    v_sub_f32 v30, v30, v230
    v_sub_f32 v95, v95, v230
    v_sub_f32 v63, v63, v230
    v_sub_f32 v31, v31, v230
    v_mul_f32 v227, v227, v232
    v_accvgpr_read_b32 v234, a64
    v_mul_f32 v234, v234, v232
    v_accvgpr_write_b32 a64, v234
    v_accvgpr_read_b32 v235, a65
    v_mul_f32 v235, v235, v232
    v_accvgpr_write_b32 a65, v235
    v_accvgpr_read_b32 v236, a66
    v_mul_f32 v236, v236, v232
    v_accvgpr_write_b32 a66, v236
    v_accvgpr_read_b32 v237, a67
    v_mul_f32 v237, v237, v232
    v_accvgpr_write_b32 a67, v237
    v_accvgpr_read_b32 v234, a68
    v_mul_f32 v234, v234, v232
    v_accvgpr_write_b32 a68, v234
    v_accvgpr_read_b32 v235, a69
    v_mul_f32 v235, v235, v232
    v_accvgpr_write_b32 a69, v235
    v_accvgpr_read_b32 v236, a70
    v_mul_f32 v236, v236, v232
    v_accvgpr_write_b32 a70, v236
    v_accvgpr_read_b32 v237, a71
    v_mul_f32 v237, v237, v232
    v_accvgpr_write_b32 a71, v237
    v_accvgpr_read_b32 v234, a72
    v_mul_f32 v234, v234, v232
    v_accvgpr_write_b32 a72, v234
    v_accvgpr_read_b32 v235, a73
    v_mul_f32 v235, v235, v232
    v_accvgpr_write_b32 a73, v235
    v_accvgpr_read_b32 v236, a74
    v_mul_f32 v236, v236, v232
    v_accvgpr_write_b32 a74, v236
    v_accvgpr_read_b32 v237, a75
    v_mul_f32 v237, v237, v232
    v_accvgpr_write_b32 a75, v237
    v_accvgpr_read_b32 v234, a76
    v_mul_f32 v234, v234, v232
    v_accvgpr_write_b32 a76, v234
    v_accvgpr_read_b32 v235, a77
    v_mul_f32 v235, v235, v232
    v_accvgpr_write_b32 a77, v235
    v_accvgpr_read_b32 v236, a78
    v_mul_f32 v236, v236, v232
    v_accvgpr_write_b32 a78, v236
    v_accvgpr_read_b32 v237, a79
    v_mul_f32 v237, v237, v232
    v_accvgpr_write_b32 a79, v237
    v_accvgpr_read_b32 v234, a80
    v_mul_f32 v234, v234, v232
    v_accvgpr_write_b32 a80, v234
    v_accvgpr_read_b32 v235, a81
    v_mul_f32 v235, v235, v232
    v_accvgpr_write_b32 a81, v235
    v_accvgpr_read_b32 v236, a82
    v_mul_f32 v236, v236, v232
    v_accvgpr_write_b32 a82, v236
    v_accvgpr_read_b32 v237, a83
    v_mul_f32 v237, v237, v232
    v_accvgpr_write_b32 a83, v237
    v_accvgpr_read_b32 v234, a84
    v_mul_f32 v234, v234, v232
    v_accvgpr_write_b32 a84, v234
    v_accvgpr_read_b32 v235, a85
    v_mul_f32 v235, v235, v232
    v_accvgpr_write_b32 a85, v235
    v_accvgpr_read_b32 v236, a86
    v_mul_f32 v236, v236, v232
    v_accvgpr_write_b32 a86, v236
    v_accvgpr_read_b32 v237, a87
    v_mul_f32 v237, v237, v232
    v_accvgpr_write_b32 a87, v237
    v_accvgpr_read_b32 v234, a88
    v_mul_f32 v234, v234, v232
    v_accvgpr_write_b32 a88, v234
    v_accvgpr_read_b32 v235, a89
    v_mul_f32 v235, v235, v232
    v_accvgpr_write_b32 a89, v235
    v_accvgpr_read_b32 v236, a90
    v_mul_f32 v236, v236, v232
    v_accvgpr_write_b32 a90, v236
    v_accvgpr_read_b32 v237, a91
    v_mul_f32 v237, v237, v232
    v_accvgpr_write_b32 a91, v237
    v_accvgpr_read_b32 v234, a92
    v_mul_f32 v234, v234, v232
    v_accvgpr_write_b32 a92, v234
    v_accvgpr_read_b32 v235, a93
    v_mul_f32 v235, v235, v232
    v_accvgpr_write_b32 a93, v235
    v_accvgpr_read_b32 v236, a94
    v_mul_f32 v236, v236, v232
    v_accvgpr_write_b32 a94, v236
    v_accvgpr_read_b32 v237, a95
    v_mul_f32 v237, v237, v232
    v_accvgpr_write_b32 a95, v237
    v_accvgpr_read_b32 v234, a96
    v_mul_f32 v234, v234, v232
    v_accvgpr_write_b32 a96, v234
    v_accvgpr_read_b32 v235, a97
    v_mul_f32 v235, v235, v232
    v_accvgpr_write_b32 a97, v235
    v_accvgpr_read_b32 v236, a98
    v_mul_f32 v236, v236, v232
    v_accvgpr_write_b32 a98, v236
    v_accvgpr_read_b32 v237, a99
    v_mul_f32 v237, v237, v232
    v_accvgpr_write_b32 a99, v237
    v_accvgpr_read_b32 v234, a100
    v_mul_f32 v234, v234, v232
    v_accvgpr_write_b32 a100, v234
    v_accvgpr_read_b32 v235, a101
    v_mul_f32 v235, v235, v232
    v_accvgpr_write_b32 a101, v235
    v_accvgpr_read_b32 v236, a102
    v_mul_f32 v236, v236, v232
    v_accvgpr_write_b32 a102, v236
    v_accvgpr_read_b32 v237, a103
    v_mul_f32 v237, v237, v232
    v_accvgpr_write_b32 a103, v237
    v_accvgpr_read_b32 v234, a104
    v_mul_f32 v234, v234, v232
    v_accvgpr_write_b32 a104, v234
    v_accvgpr_read_b32 v235, a105
    v_mul_f32 v235, v235, v232
    v_accvgpr_write_b32 a105, v235
    v_accvgpr_read_b32 v236, a106
    v_mul_f32 v236, v236, v232
    v_accvgpr_write_b32 a106, v236
    v_accvgpr_read_b32 v237, a107
    v_mul_f32 v237, v237, v232
    v_accvgpr_write_b32 a107, v237
    v_accvgpr_read_b32 v234, a108
    v_mul_f32 v234, v234, v232
    v_accvgpr_write_b32 a108, v234
    v_accvgpr_read_b32 v235, a109
    v_mul_f32 v235, v235, v232
    v_accvgpr_write_b32 a109, v235
    v_accvgpr_read_b32 v236, a110
    v_mul_f32 v236, v236, v232
    v_accvgpr_write_b32 a110, v236
    v_accvgpr_read_b32 v237, a111
    v_mul_f32 v237, v237, v232
    v_accvgpr_write_b32 a111, v237
    v_accvgpr_read_b32 v234, a112
    v_mul_f32 v234, v234, v232
    v_accvgpr_write_b32 a112, v234
    v_accvgpr_read_b32 v235, a113
    v_mul_f32 v235, v235, v232
    v_accvgpr_write_b32 a113, v235
    v_accvgpr_read_b32 v236, a114
    v_mul_f32 v236, v236, v232
    v_accvgpr_write_b32 a114, v236
    v_accvgpr_read_b32 v237, a115
    v_mul_f32 v237, v237, v232
    v_accvgpr_write_b32 a115, v237
    v_accvgpr_read_b32 v234, a116
    v_mul_f32 v234, v234, v232
    v_accvgpr_write_b32 a116, v234
    v_accvgpr_read_b32 v235, a117
    v_mul_f32 v235, v235, v232
    v_accvgpr_write_b32 a117, v235
    v_accvgpr_read_b32 v236, a118
    v_mul_f32 v236, v236, v232
    v_accvgpr_write_b32 a118, v236
    v_accvgpr_read_b32 v237, a119
    v_mul_f32 v237, v237, v232
    v_accvgpr_write_b32 a119, v237
    v_accvgpr_read_b32 v234, a120
    v_mul_f32 v234, v234, v232
    v_accvgpr_write_b32 a120, v234
    v_accvgpr_read_b32 v235, a121
    v_mul_f32 v235, v235, v232
    v_accvgpr_write_b32 a121, v235
    v_accvgpr_read_b32 v236, a122
    v_mul_f32 v236, v236, v232
    v_accvgpr_write_b32 a122, v236
    v_accvgpr_read_b32 v237, a123
    v_mul_f32 v237, v237, v232
    v_accvgpr_write_b32 a123, v237
    v_accvgpr_read_b32 v234, a124
    v_mul_f32 v234, v234, v232
    v_accvgpr_write_b32 a124, v234
    v_accvgpr_read_b32 v235, a125
    v_mul_f32 v235, v235, v232
    v_accvgpr_write_b32 a125, v235
    v_accvgpr_read_b32 v236, a126
    v_mul_f32 v236, v236, v232
    v_accvgpr_write_b32 a126, v236
    v_accvgpr_read_b32 v237, a127
    v_mul_f32 v237, v237, v232
    v_accvgpr_write_b32 a127, v237
    v_exp_f32 v138, v16
    v_exp_f32 v139, v17
    v_exp_f32 v130, v18
    v_exp_f32 v131, v19
    v_cvt_pk_bf16_f32 v104, v138, v139
    v_exp_f32 v132, v20
    v_exp_f32 v133, v21
    v_cvt_pk_bf16_f32 v105, v130, v131
    v_add_f32 v138, v138, v130
    v_add_f32 v139, v139, v131
    v_exp_f32 v134, v22
    v_exp_f32 v135, v23
    v_cvt_pk_bf16_f32 v106, v132, v133
    v_add_f32 v138, v138, v132
    v_add_f32 v139, v139, v133
    v_exp_f32 v128, v24
    v_exp_f32 v129, v25
    v_cvt_pk_bf16_f32 v107, v134, v135
    v_add_f32 v138, v138, v134
    v_add_f32 v139, v139, v135
    v_exp_f32 v130, v26
    v_exp_f32 v131, v27
    v_cvt_pk_bf16_f32 v108, v128, v129
    v_add_f32 v138, v138, v128
    v_add_f32 v139, v139, v129
    v_exp_f32 v132, v28
    v_exp_f32 v133, v29
    v_cvt_pk_bf16_f32 v109, v130, v131
    v_add_f32 v138, v138, v130
    v_add_f32 v139, v139, v131
    v_exp_f32 v134, v30
    v_exp_f32 v135, v31
    v_cvt_pk_bf16_f32 v110, v132, v133
    v_add_f32 v138, v138, v132
    v_add_f32 v139, v139, v133
    v_cvt_pk_bf16_f32 v111, v134, v135
    v_add_f32 v138, v138, v134
    v_add_f32 v139, v139, v135
    v_add_f32 v225, v138, v139
    s_nop 1
    s_branch ka_rr11
ka_fix13:
    s_cmp_eq_u32 s36, 0
    s_cselect_b32 s24, 0, 0x74000000
    v_subrev_f32 v230, s24, v243
    v_add_f32 v231, 0, v230
    v_min_f32 v80, v229, v231
    v_add_f32 v232, 0xf1800000, v230
    v_min_f32 v81, v229, v232
    v_add_f32 v231, 0xf2000000, v230
    v_min_f32 v82, v229, v231
    v_add_f32 v232, 0xf2400000, v230
    v_min_f32 v83, v229, v232
    v_add_f32 v231, 0xf3000000, v230
    v_min_f32 v84, v229, v231
    v_add_f32 v232, 0xf3100000, v230
    v_min_f32 v85, v229, v232
    v_add_f32 v231, 0xf3200000, v230
    v_min_f32 v86, v229, v231
    v_add_f32 v232, 0xf3300000, v230
    v_min_f32 v87, v229, v232
    v_add_f32 v231, 0xf3800000, v230
    v_min_f32 v88, v229, v231
    v_add_f32 v232, 0xf3880000, v230
    v_min_f32 v89, v229, v232
    v_add_f32 v231, 0xf3900000, v230
    v_min_f32 v90, v229, v231
    v_add_f32 v232, 0xf3980000, v230
    v_min_f32 v91, v229, v232
    v_add_f32 v231, 0xf3c00000, v230
    v_min_f32 v92, v229, v231
    v_add_f32 v232, 0xf3c80000, v230
    v_min_f32 v93, v229, v232
    v_add_f32 v231, 0xf3d00000, v230
    v_min_f32 v94, v229, v231
    v_add_f32 v232, 0xf3d80000, v230
    v_min_f32 v95, v229, v232
    s_nop 1
    s_branch ka_fixr14
ka_rare16:
    s_nop 15
    v_max3_f32 v230, v32, v33, v34
    v_max3_f32 v230, v230, v35, v36
    v_max3_f32 v230, v230, v37, v38
    v_max3_f32 v230, v230, v39, v40
    v_max3_f32 v230, v230, v41, v42
    v_max3_f32 v230, v230, v43, v44
    v_max3_f32 v230, v230, v45, v46
    v_max_f32 v230, v230, v47
    v_mov_b32 v231, v230
    s_nop 1
    v_permlane32_swap_b32 v230, v231
    s_nop 0
    v_max_f32 v230, v230, v231
    v_max_f32 v230, 0, v230
    v_sub_f32 v232, 0, v230
    v_exp_f32 v232, v232
    v_sub_f32 v228, v228, v230
    v_sub_f32 v64, v64, v230
    v_sub_f32 v0, v0, v230
    v_sub_f32 v32, v32, v230
    v_sub_f32 v65, v65, v230
    v_sub_f32 v1, v1, v230
    v_sub_f32 v33, v33, v230
    v_sub_f32 v66, v66, v230
    v_sub_f32 v2, v2, v230
    v_sub_f32 v34, v34, v230
    v_sub_f32 v67, v67, v230
    v_sub_f32 v3, v3, v230
    v_sub_f32 v35, v35, v230
    v_sub_f32 v68, v68, v230
    v_sub_f32 v4, v4, v230
    v_sub_f32 v36, v36, v230
    v_sub_f32 v69, v69, v230
    v_sub_f32 v5, v5, v230
    v_sub_f32 v37, v37, v230
    v_sub_f32 v70, v70, v230
    v_sub_f32 v6, v6, v230
    v_sub_f32 v38, v38, v230
    v_sub_f32 v71, v71, v230
    v_sub_f32 v7, v7, v230
    v_sub_f32 v39, v39, v230
    v_sub_f32 v72, v72, v230
    v_sub_f32 v8, v8, v230
    v_sub_f32 v40, v40, v230
    v_sub_f32 v73, v73, v230
    v_sub_f32 v9, v9, v230
    v_sub_f32 v41, v41, v230
    v_sub_f32 v74, v74, v230
    v_sub_f32 v10, v10, v230
    v_sub_f32 v42, v42, v230
    v_sub_f32 v75, v75, v230
    v_sub_f32 v11, v11, v230
    v_sub_f32 v43, v43, v230
    v_sub_f32 v76, v76, v230
    v_sub_f32 v12, v12, v230
    v_sub_f32 v44, v44, v230
    v_sub_f32 v77, v77, v230
    v_sub_f32 v13, v13, v230
    v_sub_f32 v45, v45, v230
    v_sub_f32 v78, v78, v230
    v_sub_f32 v14, v14, v230
    v_sub_f32 v46, v46, v230
    v_sub_f32 v79, v79, v230
    v_sub_f32 v15, v15, v230
    v_sub_f32 v47, v47, v230
    v_mul_f32 v226, v226, v232
    v_accvgpr_read_b32 v234, a0
    v_mul_f32 v234, v234, v232
    v_accvgpr_write_b32 a0, v234
    v_accvgpr_read_b32 v235, a1
    v_mul_f32 v235, v235, v232
    v_accvgpr_write_b32 a1, v235
    v_accvgpr_read_b32 v236, a2
    v_mul_f32 v236, v236, v232
    v_accvgpr_write_b32 a2, v236
    v_accvgpr_read_b32 v237, a3
    v_mul_f32 v237, v237, v232
    v_accvgpr_write_b32 a3, v237
    v_accvgpr_read_b32 v234, a4
    v_mul_f32 v234, v234, v232
    v_accvgpr_write_b32 a4, v234
    v_accvgpr_read_b32 v235, a5
    v_mul_f32 v235, v235, v232
    v_accvgpr_write_b32 a5, v235
    v_accvgpr_read_b32 v236, a6
    v_mul_f32 v236, v236, v232
    v_accvgpr_write_b32 a6, v236
    v_accvgpr_read_b32 v237, a7
    v_mul_f32 v237, v237, v232
    v_accvgpr_write_b32 a7, v237
    v_accvgpr_read_b32 v234, a8
    v_mul_f32 v234, v234, v232
    v_accvgpr_write_b32 a8, v234
    v_accvgpr_read_b32 v235, a9
    v_mul_f32 v235, v235, v232
    v_accvgpr_write_b32 a9, v235
    v_accvgpr_read_b32 v236, a10
    v_mul_f32 v236, v236, v232
    v_accvgpr_write_b32 a10, v236
    v_accvgpr_read_b32 v237, a11
    v_mul_f32 v237, v237, v232
    v_accvgpr_write_b32 a11, v237
    v_accvgpr_read_b32 v234, a12
    v_mul_f32 v234, v234, v232
    v_accvgpr_write_b32 a12, v234
    v_accvgpr_read_b32 v235, a13
    v_mul_f32 v235, v235, v232
    v_accvgpr_write_b32 a13, v235
    v_accvgpr_read_b32 v236, a14
    v_mul_f32 v236, v236, v232
    v_accvgpr_write_b32 a14, v236
    v_accvgpr_read_b32 v237, a15
    v_mul_f32 v237, v237, v232
    v_accvgpr_write_b32 a15, v237
    v_accvgpr_read_b32 v234, a16
    v_mul_f32 v234, v234, v232
    v_accvgpr_write_b32 a16, v234
    v_accvgpr_read_b32 v235, a17
    v_mul_f32 v235, v235, v232
    v_accvgpr_write_b32 a17, v235
    v_accvgpr_read_b32 v236, a18
    v_mul_f32 v236, v236, v232
    v_accvgpr_write_b32 a18, v236
    v_accvgpr_read_b32 v237, a19
    v_mul_f32 v237, v237, v232
    v_accvgpr_write_b32 a19, v237
    v_accvgpr_read_b32 v234, a20
    v_mul_f32 v234, v234, v232
    v_accvgpr_write_b32 a20, v234
    v_accvgpr_read_b32 v235, a21
    v_mul_f32 v235, v235, v232
    v_accvgpr_write_b32 a21, v235
    v_accvgpr_read_b32 v236, a22
    v_mul_f32 v236, v236, v232
    v_accvgpr_write_b32 a22, v236
    v_accvgpr_read_b32 v237, a23
    v_mul_f32 v237, v237, v232
    v_accvgpr_write_b32 a23, v237
    v_accvgpr_read_b32 v234, a24
    v_mul_f32 v234, v234, v232
    v_accvgpr_write_b32 a24, v234
    v_accvgpr_read_b32 v235, a25
    v_mul_f32 v235, v235, v232
    v_accvgpr_write_b32 a25, v235
    v_accvgpr_read_b32 v236, a26
    v_mul_f32 v236, v236, v232
    v_accvgpr_write_b32 a26, v236
    v_accvgpr_read_b32 v237, a27
    v_mul_f32 v237, v237, v232
    v_accvgpr_write_b32 a27, v237
    v_accvgpr_read_b32 v234, a28
    v_mul_f32 v234, v234, v232
    v_accvgpr_write_b32 a28, v234
    v_accvgpr_read_b32 v235, a29
    v_mul_f32 v235, v235, v232
    v_accvgpr_write_b32 a29, v235
    v_accvgpr_read_b32 v236, a30
    v_mul_f32 v236, v236, v232
    v_accvgpr_write_b32 a30, v236
    v_accvgpr_read_b32 v237, a31
    v_mul_f32 v237, v237, v232
    v_accvgpr_write_b32 a31, v237
    v_accvgpr_read_b32 v234, a32
    v_mul_f32 v234, v234, v232
    v_accvgpr_write_b32 a32, v234
    v_accvgpr_read_b32 v235, a33
    v_mul_f32 v235, v235, v232
    v_accvgpr_write_b32 a33, v235
    v_accvgpr_read_b32 v236, a34
    v_mul_f32 v236, v236, v232
    v_accvgpr_write_b32 a34, v236
    v_accvgpr_read_b32 v237, a35
    v_mul_f32 v237, v237, v232
    v_accvgpr_write_b32 a35, v237
    v_accvgpr_read_b32 v234, a36
    v_mul_f32 v234, v234, v232
    v_accvgpr_write_b32 a36, v234
    v_accvgpr_read_b32 v235, a37
    v_mul_f32 v235, v235, v232
    v_accvgpr_write_b32 a37, v235
    v_accvgpr_read_b32 v236, a38
    v_mul_f32 v236, v236, v232
    v_accvgpr_write_b32 a38, v236
    v_accvgpr_read_b32 v237, a39
    v_mul_f32 v237, v237, v232
    v_accvgpr_write_b32 a39, v237
    v_accvgpr_read_b32 v234, a40
    v_mul_f32 v234, v234, v232
    v_accvgpr_write_b32 a40, v234
    v_accvgpr_read_b32 v235, a41
    v_mul_f32 v235, v235, v232
    v_accvgpr_write_b32 a41, v235
    v_accvgpr_read_b32 v236, a42
    v_mul_f32 v236, v236, v232
    v_accvgpr_write_b32 a42, v236
    v_accvgpr_read_b32 v237, a43
    v_mul_f32 v237, v237, v232
    v_accvgpr_write_b32 a43, v237
    v_accvgpr_read_b32 v234, a44
    v_mul_f32 v234, v234, v232
    v_accvgpr_write_b32 a44, v234
    v_accvgpr_read_b32 v235, a45
    v_mul_f32 v235, v235, v232
    v_accvgpr_write_b32 a45, v235
    v_accvgpr_read_b32 v236, a46
    v_mul_f32 v236, v236, v232
    v_accvgpr_write_b32 a46, v236
    v_accvgpr_read_b32 v237, a47
    v_mul_f32 v237, v237, v232
    v_accvgpr_write_b32 a47, v237
    v_accvgpr_read_b32 v234, a48
    v_mul_f32 v234, v234, v232
    v_accvgpr_write_b32 a48, v234
    v_accvgpr_read_b32 v235, a49
    v_mul_f32 v235, v235, v232
    v_accvgpr_write_b32 a49, v235
    v_accvgpr_read_b32 v236, a50
    v_mul_f32 v236, v236, v232
    v_accvgpr_write_b32 a50, v236
    v_accvgpr_read_b32 v237, a51
    v_mul_f32 v237, v237, v232
    v_accvgpr_write_b32 a51, v237
    v_accvgpr_read_b32 v234, a52
    v_mul_f32 v234, v234, v232
    v_accvgpr_write_b32 a52, v234
    v_accvgpr_read_b32 v235, a53
    v_mul_f32 v235, v235, v232
    v_accvgpr_write_b32 a53, v235
    v_accvgpr_read_b32 v236, a54
    v_mul_f32 v236, v236, v232
    v_accvgpr_write_b32 a54, v236
    v_accvgpr_read_b32 v237, a55
    v_mul_f32 v237, v237, v232
    v_accvgpr_write_b32 a55, v237
    v_accvgpr_read_b32 v234, a56
    v_mul_f32 v234, v234, v232
    v_accvgpr_write_b32 a56, v234
    v_accvgpr_read_b32 v235, a57
    v_mul_f32 v235, v235, v232
    v_accvgpr_write_b32 a57, v235
    v_accvgpr_read_b32 v236, a58
    v_mul_f32 v236, v236, v232
    v_accvgpr_write_b32 a58, v236
    v_accvgpr_read_b32 v237, a59
    v_mul_f32 v237, v237, v232
    v_accvgpr_write_b32 a59, v237
    v_accvgpr_read_b32 v234, a60
    v_mul_f32 v234, v234, v232
    v_accvgpr_write_b32 a60, v234
    v_accvgpr_read_b32 v235, a61
    v_mul_f32 v235, v235, v232
    v_accvgpr_write_b32 a61, v235
    v_accvgpr_read_b32 v236, a62
    v_mul_f32 v236, v236, v232
    v_accvgpr_write_b32 a62, v236
    v_accvgpr_read_b32 v237, a63
    v_mul_f32 v237, v237, v232
    v_accvgpr_write_b32 a63, v237
    v_exp_f32 v136, v32
    v_exp_f32 v137, v33
    v_exp_f32 v130, v34
    v_exp_f32 v131, v35
    v_cvt_pk_bf16_f32 v112, v136, v137
    v_exp_f32 v132, v36
    v_exp_f32 v133, v37
    v_cvt_pk_bf16_f32 v113, v130, v131
    v_add_f32 v136, v136, v130
    v_add_f32 v137, v137, v131
    v_exp_f32 v134, v38
    v_exp_f32 v135, v39
    v_cvt_pk_bf16_f32 v114, v132, v133
    v_add_f32 v136, v136, v132
    v_add_f32 v137, v137, v133
    v_exp_f32 v128, v40
    v_exp_f32 v129, v41
    v_cvt_pk_bf16_f32 v115, v134, v135
    v_add_f32 v136, v136, v134
    v_add_f32 v137, v137, v135
    v_exp_f32 v130, v42
    v_exp_f32 v131, v43
    v_cvt_pk_bf16_f32 v116, v128, v129
    v_add_f32 v136, v136, v128
    v_add_f32 v137, v137, v129
    v_exp_f32 v132, v44
    v_exp_f32 v133, v45
    v_cvt_pk_bf16_f32 v117, v130, v131
    v_add_f32 v136, v136, v130
    v_add_f32 v137, v137, v131
    v_exp_f32 v134, v46
    v_exp_f32 v135, v47
    v_cvt_pk_bf16_f32 v118, v132, v133
    v_add_f32 v136, v136, v132
    v_add_f32 v137, v137, v133
    v_cvt_pk_bf16_f32 v119, v134, v135
    v_add_f32 v136, v136, v134
    v_add_f32 v137, v137, v135
    v_add_f32 v224, v136, v137
    v_max3_f32 v230, v48, v49, v50
    v_max3_f32 v230, v230, v51, v52
    v_max3_f32 v230, v230, v53, v54
    v_max3_f32 v230, v230, v55, v56
    v_max3_f32 v230, v230, v57, v58
    v_max3_f32 v230, v230, v59, v60
    v_max3_f32 v230, v230, v61, v62
    v_max_f32 v230, v230, v63
    v_mov_b32 v231, v230
    s_nop 1
    v_permlane32_swap_b32 v230, v231
    s_nop 0
    v_max_f32 v230, v230, v231
    v_max_f32 v230, 0, v230
    v_sub_f32 v232, 0, v230
    v_exp_f32 v232, v232
    v_sub_f32 v229, v229, v230
    v_sub_f32 v80, v80, v230
    v_sub_f32 v16, v16, v230
    v_sub_f32 v48, v48, v230
    v_sub_f32 v81, v81, v230
    v_sub_f32 v17, v17, v230
    v_sub_f32 v49, v49, v230
    v_sub_f32 v82, v82, v230
    v_sub_f32 v18, v18, v230
    v_sub_f32 v50, v50, v230
    v_sub_f32 v83, v83, v230
    v_sub_f32 v19, v19, v230
    v_sub_f32 v51, v51, v230
    v_sub_f32 v84, v84, v230
    v_sub_f32 v20, v20, v230
    v_sub_f32 v52, v52, v230
    v_sub_f32 v85, v85, v230
    v_sub_f32 v21, v21, v230
    v_sub_f32 v53, v53, v230
    v_sub_f32 v86, v86, v230
    v_sub_f32 v22, v22, v230
    v_sub_f32 v54, v54, v230
    v_sub_f32 v87, v87, v230
    v_sub_f32 v23, v23, v230
    v_sub_f32 v55, v55, v230
    v_sub_f32 v88, v88, v230
    v_sub_f32 v24, v24, v230
    v_sub_f32 v56, v56, v230
    v_sub_f32 v89, v89, v230
    v_sub_f32 v25, v25, v230
    v_sub_f32 v57, v57, v230
    v_sub_f32 v90, v90, v230
    v_sub_f32 v26, v26, v230
    v_sub_f32 v58, v58, v230
    v_sub_f32 v91, v91, v230
    v_sub_f32 v27, v27, v230
    v_sub_f32 v59, v59, v230
    v_sub_f32 v92, v92, v230
    v_sub_f32 v28, v28, v230
    v_sub_f32 v60, v60, v230
    v_sub_f32 v93, v93, v230
    v_sub_f32 v29, v29, v230
    v_sub_f32 v61, v61, v230
    v_sub_f32 v94, v94, v230
    v_sub_f32 v30, v30, v230
    v_sub_f32 v62, v62, v230
    v_sub_f32 v95, v95, v230
    v_sub_f32 v31, v31, v230
    v_sub_f32 v63, v63, v230
    v_mul_f32 v227, v227, v232
    v_accvgpr_read_b32 v234, a64
    v_mul_f32 v234, v234, v232
    v_accvgpr_write_b32 a64, v234
    v_accvgpr_read_b32 v235, a65
    v_mul_f32 v235, v235, v232
    v_accvgpr_write_b32 a65, v235
    v_accvgpr_read_b32 v236, a66
    v_mul_f32 v236, v236, v232
    v_accvgpr_write_b32 a66, v236
    v_accvgpr_read_b32 v237, a67
    v_mul_f32 v237, v237, v232
    v_accvgpr_write_b32 a67, v237
    v_accvgpr_read_b32 v234, a68
    v_mul_f32 v234, v234, v232
    v_accvgpr_write_b32 a68, v234
    v_accvgpr_read_b32 v235, a69
    v_mul_f32 v235, v235, v232
    v_accvgpr_write_b32 a69, v235
    v_accvgpr_read_b32 v236, a70
    v_mul_f32 v236, v236, v232
    v_accvgpr_write_b32 a70, v236
    v_accvgpr_read_b32 v237, a71
    v_mul_f32 v237, v237, v232
    v_accvgpr_write_b32 a71, v237
    v_accvgpr_read_b32 v234, a72
    v_mul_f32 v234, v234, v232
    v_accvgpr_write_b32 a72, v234
    v_accvgpr_read_b32 v235, a73
    v_mul_f32 v235, v235, v232
    v_accvgpr_write_b32 a73, v235
    v_accvgpr_read_b32 v236, a74
    v_mul_f32 v236, v236, v232
    v_accvgpr_write_b32 a74, v236
    v_accvgpr_read_b32 v237, a75
    v_mul_f32 v237, v237, v232
    v_accvgpr_write_b32 a75, v237
    v_accvgpr_read_b32 v234, a76
    v_mul_f32 v234, v234, v232
    v_accvgpr_write_b32 a76, v234
    v_accvgpr_read_b32 v235, a77
    v_mul_f32 v235, v235, v232
    v_accvgpr_write_b32 a77, v235
    v_accvgpr_read_b32 v236, a78
    v_mul_f32 v236, v236, v232
    v_accvgpr_write_b32 a78, v236
    v_accvgpr_read_b32 v237, a79
    v_mul_f32 v237, v237, v232
    v_accvgpr_write_b32 a79, v237
    v_accvgpr_read_b32 v234, a80
    v_mul_f32 v234, v234, v232
    v_accvgpr_write_b32 a80, v234
    v_accvgpr_read_b32 v235, a81
    v_mul_f32 v235, v235, v232
    v_accvgpr_write_b32 a81, v235
    v_accvgpr_read_b32 v236, a82
    v_mul_f32 v236, v236, v232
    v_accvgpr_write_b32 a82, v236
    v_accvgpr_read_b32 v237, a83
    v_mul_f32 v237, v237, v232
    v_accvgpr_write_b32 a83, v237
    v_accvgpr_read_b32 v234, a84
    v_mul_f32 v234, v234, v232
    v_accvgpr_write_b32 a84, v234
    v_accvgpr_read_b32 v235, a85
    v_mul_f32 v235, v235, v232
    v_accvgpr_write_b32 a85, v235
    v_accvgpr_read_b32 v236, a86
    v_mul_f32 v236, v236, v232
    v_accvgpr_write_b32 a86, v236
    v_accvgpr_read_b32 v237, a87
    v_mul_f32 v237, v237, v232
    v_accvgpr_write_b32 a87, v237
    v_accvgpr_read_b32 v234, a88
    v_mul_f32 v234, v234, v232
    v_accvgpr_write_b32 a88, v234
    v_accvgpr_read_b32 v235, a89
    v_mul_f32 v235, v235, v232
    v_accvgpr_write_b32 a89, v235
    v_accvgpr_read_b32 v236, a90
    v_mul_f32 v236, v236, v232
    v_accvgpr_write_b32 a90, v236
    v_accvgpr_read_b32 v237, a91
    v_mul_f32 v237, v237, v232
    v_accvgpr_write_b32 a91, v237
    v_accvgpr_read_b32 v234, a92
    v_mul_f32 v234, v234, v232
    v_accvgpr_write_b32 a92, v234
    v_accvgpr_read_b32 v235, a93
    v_mul_f32 v235, v235, v232
    v_accvgpr_write_b32 a93, v235
    v_accvgpr_read_b32 v236, a94
    v_mul_f32 v236, v236, v232
    v_accvgpr_write_b32 a94, v236
    v_accvgpr_read_b32 v237, a95
    v_mul_f32 v237, v237, v232
    v_accvgpr_write_b32 a95, v237
    v_accvgpr_read_b32 v234, a96
    v_mul_f32 v234, v234, v232
    v_accvgpr_write_b32 a96, v234
    v_accvgpr_read_b32 v235, a97
    v_mul_f32 v235, v235, v232
    v_accvgpr_write_b32 a97, v235
    v_accvgpr_read_b32 v236, a98
    v_mul_f32 v236, v236, v232
    v_accvgpr_write_b32 a98, v236
    v_accvgpr_read_b32 v237, a99
    v_mul_f32 v237, v237, v232
    v_accvgpr_write_b32 a99, v237
    v_accvgpr_read_b32 v234, a100
    v_mul_f32 v234, v234, v232
    v_accvgpr_write_b32 a100, v234
    v_accvgpr_read_b32 v235, a101
    v_mul_f32 v235, v235, v232
    v_accvgpr_write_b32 a101, v235
    v_accvgpr_read_b32 v236, a102
    v_mul_f32 v236, v236, v232
    v_accvgpr_write_b32 a102, v236
    v_accvgpr_read_b32 v237, a103
    v_mul_f32 v237, v237, v232
    v_accvgpr_write_b32 a103, v237
    v_accvgpr_read_b32 v234, a104
    v_mul_f32 v234, v234, v232
    v_accvgpr_write_b32 a104, v234
    v_accvgpr_read_b32 v235, a105
    v_mul_f32 v235, v235, v232
    v_accvgpr_write_b32 a105, v235
    v_accvgpr_read_b32 v236, a106
    v_mul_f32 v236, v236, v232
    v_accvgpr_write_b32 a106, v236
    v_accvgpr_read_b32 v237, a107
    v_mul_f32 v237, v237, v232
    v_accvgpr_write_b32 a107, v237
    v_accvgpr_read_b32 v234, a108
    v_mul_f32 v234, v234, v232
    v_accvgpr_write_b32 a108, v234
    v_accvgpr_read_b32 v235, a109
    v_mul_f32 v235, v235, v232
    v_accvgpr_write_b32 a109, v235
    v_accvgpr_read_b32 v236, a110
    v_mul_f32 v236, v236, v232
    v_accvgpr_write_b32 a110, v236
    v_accvgpr_read_b32 v237, a111
    v_mul_f32 v237, v237, v232
    v_accvgpr_write_b32 a111, v237
    v_accvgpr_read_b32 v234, a112
    v_mul_f32 v234, v234, v232
    v_accvgpr_write_b32 a112, v234
    v_accvgpr_read_b32 v235, a113
    v_mul_f32 v235, v235, v232
    v_accvgpr_write_b32 a113, v235
    v_accvgpr_read_b32 v236, a114
    v_mul_f32 v236, v236, v232
    v_accvgpr_write_b32 a114, v236
    v_accvgpr_read_b32 v237, a115
    v_mul_f32 v237, v237, v232
    v_accvgpr_write_b32 a115, v237
    v_accvgpr_read_b32 v234, a116
    v_mul_f32 v234, v234, v232
    v_accvgpr_write_b32 a116, v234
    v_accvgpr_read_b32 v235, a117
    v_mul_f32 v235, v235, v232
    v_accvgpr_write_b32 a117, v235
    v_accvgpr_read_b32 v236, a118
    v_mul_f32 v236, v236, v232
    v_accvgpr_write_b32 a118, v236
    v_accvgpr_read_b32 v237, a119
    v_mul_f32 v237, v237, v232
    v_accvgpr_write_b32 a119, v237
    v_accvgpr_read_b32 v234, a120
    v_mul_f32 v234, v234, v232
    v_accvgpr_write_b32 a120, v234
    v_accvgpr_read_b32 v235, a121
    v_mul_f32 v235, v235, v232
    v_accvgpr_write_b32 a121, v235
    v_accvgpr_read_b32 v236, a122
    v_mul_f32 v236, v236, v232
    v_accvgpr_write_b32 a122, v236
    v_accvgpr_read_b32 v237, a123
    v_mul_f32 v237, v237, v232
    v_accvgpr_write_b32 a123, v237
    v_accvgpr_read_b32 v234, a124
    v_mul_f32 v234, v234, v232
    v_accvgpr_write_b32 a124, v234
    v_accvgpr_read_b32 v235, a125
    v_mul_f32 v235, v235, v232
    v_accvgpr_write_b32 a125, v235
    v_accvgpr_read_b32 v236, a126
    v_mul_f32 v236, v236, v232
    v_accvgpr_write_b32 a126, v236
    v_accvgpr_read_b32 v237, a127
    v_mul_f32 v237, v237, v232
    v_accvgpr_write_b32 a127, v237
    v_exp_f32 v138, v48
    v_exp_f32 v139, v49
    v_exp_f32 v130, v50
    v_exp_f32 v131, v51
    v_cvt_pk_bf16_f32 v120, v138, v139
    v_exp_f32 v132, v52
    v_exp_f32 v133, v53
    v_cvt_pk_bf16_f32 v121, v130, v131
    v_add_f32 v138, v138, v130
    v_add_f32 v139, v139, v131
    v_exp_f32 v134, v54
    v_exp_f32 v135, v55
    v_cvt_pk_bf16_f32 v122, v132, v133
    v_add_f32 v138, v138, v132
    v_add_f32 v139, v139, v133
    v_exp_f32 v128, v56
    v_exp_f32 v129, v57
    v_cvt_pk_bf16_f32 v123, v134, v135
    v_add_f32 v138, v138, v134
    v_add_f32 v139, v139, v135
    v_exp_f32 v130, v58
    v_exp_f32 v131, v59
    v_cvt_pk_bf16_f32 v124, v128, v129
    v_add_f32 v138, v138, v128
    v_add_f32 v139, v139, v129
    v_exp_f32 v132, v60
    v_exp_f32 v133, v61
    v_cvt_pk_bf16_f32 v125, v130, v131
    v_add_f32 v138, v138, v130
    v_add_f32 v139, v139, v131
    v_exp_f32 v134, v62
    v_exp_f32 v135, v63
    v_cvt_pk_bf16_f32 v126, v132, v133
    v_add_f32 v138, v138, v132
    v_add_f32 v139, v139, v133
    v_cvt_pk_bf16_f32 v127, v134, v135
    v_add_f32 v138, v138, v134
    v_add_f32 v139, v139, v135
    v_add_f32 v225, v138, v139
    s_nop 1
    s_branch ka_rr15
ka_fix17:
    s_cmp_eq_u32 s36, 0
    s_cselect_b32 s24, 0, 0x74000000
    v_subrev_f32 v230, s24, v243
    v_add_f32 v231, 0, v230
    v_min_f32 v80, v229, v231
    v_add_f32 v232, 0xf1800000, v230
    v_min_f32 v81, v229, v232
    v_add_f32 v231, 0xf2000000, v230
    v_min_f32 v82, v229, v231
    v_add_f32 v232, 0xf2400000, v230
    v_min_f32 v83, v229, v232
    v_add_f32 v231, 0xf3000000, v230
    v_min_f32 v84, v229, v231
    v_add_f32 v232, 0xf3100000, v230
    v_min_f32 v85, v229, v232
    v_add_f32 v231, 0xf3200000, v230
    v_min_f32 v86, v229, v231
    v_add_f32 v232, 0xf3300000, v230
    v_min_f32 v87, v229, v232
    v_add_f32 v231, 0xf3800000, v230
    v_min_f32 v88, v229, v231
    v_add_f32 v232, 0xf3880000, v230
    v_min_f32 v89, v229, v232
    v_add_f32 v231, 0xf3900000, v230
    v_min_f32 v90, v229, v231
    v_add_f32 v232, 0xf3980000, v230
    v_min_f32 v91, v229, v232
    v_add_f32 v231, 0xf3c00000, v230
    v_min_f32 v92, v229, v231
    v_add_f32 v232, 0xf3c80000, v230
    v_min_f32 v93, v229, v232
    v_add_f32 v231, 0xf3d00000, v230
    v_min_f32 v94, v229, v231
    v_add_f32 v232, 0xf3d80000, v230
    v_min_f32 v95, v229, v232
    s_nop 1
    s_branch ka_fixr18
ka_rare20:
    s_nop 15
    v_max3_f32 v230, v16, v17, v18
    v_max3_f32 v230, v230, v19, v20
    v_max3_f32 v230, v230, v21, v22
    v_max3_f32 v230, v230, v23, v24
    v_max3_f32 v230, v230, v25, v26
    v_max3_f32 v230, v230, v27, v28
    v_max3_f32 v230, v230, v29, v30
    v_max_f32 v230, v230, v31
    v_mov_b32 v231, v230
    s_nop 1
    v_permlane32_swap_b32 v230, v231
    s_nop 0
    v_max_f32 v230, v230, v231
    v_max_f32 v230, 0, v230
    v_sub_f32 v232, 0, v230
    v_exp_f32 v232, v232
    v_sub_f32 v229, v229, v230
    v_sub_f32 v80, v80, v230
    v_sub_f32 v48, v48, v230
    v_sub_f32 v16, v16, v230
    v_sub_f32 v81, v81, v230
    v_sub_f32 v49, v49, v230
    v_sub_f32 v17, v17, v230
    v_sub_f32 v82, v82, v230
    v_sub_f32 v50, v50, v230
    v_sub_f32 v18, v18, v230
    v_sub_f32 v83, v83, v230
    v_sub_f32 v51, v51, v230
    v_sub_f32 v19, v19, v230
    v_sub_f32 v84, v84, v230
    v_sub_f32 v52, v52, v230
    v_sub_f32 v20, v20, v230
    v_sub_f32 v85, v85, v230
    v_sub_f32 v53, v53, v230
    v_sub_f32 v21, v21, v230
    v_sub_f32 v86, v86, v230
    v_sub_f32 v54, v54, v230
    v_sub_f32 v22, v22, v230
    v_sub_f32 v87, v87, v230
    v_sub_f32 v55, v55, v230
    v_sub_f32 v23, v23, v230
    v_sub_f32 v88, v88, v230
    v_sub_f32 v56, v56, v230
    v_sub_f32 v24, v24, v230
    v_sub_f32 v89, v89, v230
    v_sub_f32 v57, v57, v230
    v_sub_f32 v25, v25, v230
    v_sub_f32 v90, v90, v230
    v_sub_f32 v58, v58, v230
    v_sub_f32 v26, v26, v230
    v_sub_f32 v91, v91, v230
    v_sub_f32 v59, v59, v230
    v_sub_f32 v27, v27, v230
    v_sub_f32 v92, v92, v230
    v_sub_f32 v60, v60, v230
    v_sub_f32 v28, v28, v230
    v_sub_f32 v93, v93, v230
    v_sub_f32 v61, v61, v230
    v_sub_f32 v29, v29, v230
    v_sub_f32 v94, v94, v230
    v_sub_f32 v62, v62, v230
    v_sub_f32 v30, v30, v230
    v_sub_f32 v95, v95, v230
    v_sub_f32 v63, v63, v230
    v_sub_f32 v31, v31, v230
    v_mul_f32 v227, v227, v232
    v_accvgpr_read_b32 v234, a64
    v_mul_f32 v234, v234, v232
    v_accvgpr_write_b32 a64, v234
    v_accvgpr_read_b32 v235, a65
    v_mul_f32 v235, v235, v232
    v_accvgpr_write_b32 a65, v235
    v_accvgpr_read_b32 v236, a66
    v_mul_f32 v236, v236, v232
    v_accvgpr_write_b32 a66, v236
    v_accvgpr_read_b32 v237, a67
    v_mul_f32 v237, v237, v232
    v_accvgpr_write_b32 a67, v237
    v_accvgpr_read_b32 v234, a68
    v_mul_f32 v234, v234, v232
    v_accvgpr_write_b32 a68, v234
    v_accvgpr_read_b32 v235, a69
    v_mul_f32 v235, v235, v232
    v_accvgpr_write_b32 a69, v235
    v_accvgpr_read_b32 v236, a70
    v_mul_f32 v236, v236, v232
    v_accvgpr_write_b32 a70, v236
    v_accvgpr_read_b32 v237, a71
    v_mul_f32 v237, v237, v232
    v_accvgpr_write_b32 a71, v237
    v_accvgpr_read_b32 v234, a72
    v_mul_f32 v234, v234, v232
    v_accvgpr_write_b32 a72, v234
    v_accvgpr_read_b32 v235, a73
    v_mul_f32 v235, v235, v232
    v_accvgpr_write_b32 a73, v235
    v_accvgpr_read_b32 v236, a74
    v_mul_f32 v236, v236, v232
    v_accvgpr_write_b32 a74, v236
    v_accvgpr_read_b32 v237, a75
    v_mul_f32 v237, v237, v232
    v_accvgpr_write_b32 a75, v237
    v_accvgpr_read_b32 v234, a76
    v_mul_f32 v234, v234, v232
    v_accvgpr_write_b32 a76, v234
    v_accvgpr_read_b32 v235, a77
    v_mul_f32 v235, v235, v232
    v_accvgpr_write_b32 a77, v235
    v_accvgpr_read_b32 v236, a78
    v_mul_f32 v236, v236, v232
    v_accvgpr_write_b32 a78, v236
    v_accvgpr_read_b32 v237, a79
    v_mul_f32 v237, v237, v232
    v_accvgpr_write_b32 a79, v237
    v_accvgpr_read_b32 v234, a80
    v_mul_f32 v234, v234, v232
    v_accvgpr_write_b32 a80, v234
    v_accvgpr_read_b32 v235, a81
    v_mul_f32 v235, v235, v232
    v_accvgpr_write_b32 a81, v235
    v_accvgpr_read_b32 v236, a82
    v_mul_f32 v236, v236, v232
    v_accvgpr_write_b32 a82, v236
    v_accvgpr_read_b32 v237, a83
    v_mul_f32 v237, v237, v232
    v_accvgpr_write_b32 a83, v237
    v_accvgpr_read_b32 v234, a84
    v_mul_f32 v234, v234, v232
    v_accvgpr_write_b32 a84, v234
    v_accvgpr_read_b32 v235, a85
    v_mul_f32 v235, v235, v232
    v_accvgpr_write_b32 a85, v235
    v_accvgpr_read_b32 v236, a86
    v_mul_f32 v236, v236, v232
    v_accvgpr_write_b32 a86, v236
    v_accvgpr_read_b32 v237, a87
    v_mul_f32 v237, v237, v232
    v_accvgpr_write_b32 a87, v237
    v_accvgpr_read_b32 v234, a88
    v_mul_f32 v234, v234, v232
    v_accvgpr_write_b32 a88, v234
    v_accvgpr_read_b32 v235, a89
    v_mul_f32 v235, v235, v232
    v_accvgpr_write_b32 a89, v235
    v_accvgpr_read_b32 v236, a90
    v_mul_f32 v236, v236, v232
    v_accvgpr_write_b32 a90, v236
    v_accvgpr_read_b32 v237, a91
    v_mul_f32 v237, v237, v232
    v_accvgpr_write_b32 a91, v237
    v_accvgpr_read_b32 v234, a92
    v_mul_f32 v234, v234, v232
    v_accvgpr_write_b32 a92, v234
    v_accvgpr_read_b32 v235, a93
    v_mul_f32 v235, v235, v232
    v_accvgpr_write_b32 a93, v235
    v_accvgpr_read_b32 v236, a94
    v_mul_f32 v236, v236, v232
    v_accvgpr_write_b32 a94, v236
    v_accvgpr_read_b32 v237, a95
    v_mul_f32 v237, v237, v232
    v_accvgpr_write_b32 a95, v237
    v_accvgpr_read_b32 v234, a96
    v_mul_f32 v234, v234, v232
    v_accvgpr_write_b32 a96, v234
    v_accvgpr_read_b32 v235, a97
    v_mul_f32 v235, v235, v232
    v_accvgpr_write_b32 a97, v235
    v_accvgpr_read_b32 v236, a98
    v_mul_f32 v236, v236, v232
    v_accvgpr_write_b32 a98, v236
    v_accvgpr_read_b32 v237, a99
    v_mul_f32 v237, v237, v232
    v_accvgpr_write_b32 a99, v237
    v_accvgpr_read_b32 v234, a100
    v_mul_f32 v234, v234, v232
    v_accvgpr_write_b32 a100, v234
    v_accvgpr_read_b32 v235, a101
    v_mul_f32 v235, v235, v232
    v_accvgpr_write_b32 a101, v235
    v_accvgpr_read_b32 v236, a102
    v_mul_f32 v236, v236, v232
    v_accvgpr_write_b32 a102, v236
    v_accvgpr_read_b32 v237, a103
    v_mul_f32 v237, v237, v232
    v_accvgpr_write_b32 a103, v237
    v_accvgpr_read_b32 v234, a104
    v_mul_f32 v234, v234, v232
    v_accvgpr_write_b32 a104, v234
    v_accvgpr_read_b32 v235, a105
    v_mul_f32 v235, v235, v232
    v_accvgpr_write_b32 a105, v235
    v_accvgpr_read_b32 v236, a106
    v_mul_f32 v236, v236, v232
    v_accvgpr_write_b32 a106, v236
    v_accvgpr_read_b32 v237, a107
    v_mul_f32 v237, v237, v232
    v_accvgpr_write_b32 a107, v237
    v_accvgpr_read_b32 v234, a108
    v_mul_f32 v234, v234, v232
    v_accvgpr_write_b32 a108, v234
    v_accvgpr_read_b32 v235, a109
    v_mul_f32 v235, v235, v232
    v_accvgpr_write_b32 a109, v235
    v_accvgpr_read_b32 v236, a110
    v_mul_f32 v236, v236, v232
    v_accvgpr_write_b32 a110, v236
    v_accvgpr_read_b32 v237, a111
    v_mul_f32 v237, v237, v232
    v_accvgpr_write_b32 a111, v237
    v_accvgpr_read_b32 v234, a112
    v_mul_f32 v234, v234, v232
    v_accvgpr_write_b32 a112, v234
    v_accvgpr_read_b32 v235, a113
    v_mul_f32 v235, v235, v232
    v_accvgpr_write_b32 a113, v235
    v_accvgpr_read_b32 v236, a114
    v_mul_f32 v236, v236, v232
    v_accvgpr_write_b32 a114, v236
    v_accvgpr_read_b32 v237, a115
    v_mul_f32 v237, v237, v232
    v_accvgpr_write_b32 a115, v237
    v_accvgpr_read_b32 v234, a116
    v_mul_f32 v234, v234, v232
    v_accvgpr_write_b32 a116, v234
    v_accvgpr_read_b32 v235, a117
    v_mul_f32 v235, v235, v232
    v_accvgpr_write_b32 a117, v235
    v_accvgpr_read_b32 v236, a118
    v_mul_f32 v236, v236, v232
    v_accvgpr_write_b32 a118, v236
    v_accvgpr_read_b32 v237, a119
    v_mul_f32 v237, v237, v232
    v_accvgpr_write_b32 a119, v237
    v_accvgpr_read_b32 v234, a120
    v_mul_f32 v234, v234, v232
    v_accvgpr_write_b32 a120, v234
    v_accvgpr_read_b32 v235, a121
    v_mul_f32 v235, v235, v232
    v_accvgpr_write_b32 a121, v235
    v_accvgpr_read_b32 v236, a122
    v_mul_f32 v236, v236, v232
    v_accvgpr_write_b32 a122, v236
    v_accvgpr_read_b32 v237, a123
    v_mul_f32 v237, v237, v232
    v_accvgpr_write_b32 a123, v237
    v_accvgpr_read_b32 v234, a124
    v_mul_f32 v234, v234, v232
    v_accvgpr_write_b32 a124, v234
    v_accvgpr_read_b32 v235, a125
    v_mul_f32 v235, v235, v232
    v_accvgpr_write_b32 a125, v235
    v_accvgpr_read_b32 v236, a126
    v_mul_f32 v236, v236, v232
    v_accvgpr_write_b32 a126, v236
    v_accvgpr_read_b32 v237, a127
    v_mul_f32 v237, v237, v232
    v_accvgpr_write_b32 a127, v237
    v_exp_f32 v138, v16
    v_exp_f32 v139, v17
    v_exp_f32 v130, v18
    v_exp_f32 v131, v19
    v_cvt_pk_bf16_f32 v104, v138, v139
    v_exp_f32 v132, v20
    v_exp_f32 v133, v21
    v_cvt_pk_bf16_f32 v105, v130, v131
    v_add_f32 v138, v138, v130
    v_add_f32 v139, v139, v131
    v_exp_f32 v134, v22
    v_exp_f32 v135, v23
    v_cvt_pk_bf16_f32 v106, v132, v133
    v_add_f32 v138, v138, v132
    v_add_f32 v139, v139, v133
    v_exp_f32 v128, v24
    v_exp_f32 v129, v25
    v_cvt_pk_bf16_f32 v107, v134, v135
    v_add_f32 v138, v138, v134
    v_add_f32 v139, v139, v135
    v_exp_f32 v130, v26
    v_exp_f32 v131, v27
    v_cvt_pk_bf16_f32 v108, v128, v129
    v_add_f32 v138, v138, v128
    v_add_f32 v139, v139, v129
    v_exp_f32 v132, v28
    v_exp_f32 v133, v29
    v_cvt_pk_bf16_f32 v109, v130, v131
    v_add_f32 v138, v138, v130
    v_add_f32 v139, v139, v131
    v_exp_f32 v134, v30
    v_exp_f32 v135, v31
    v_cvt_pk_bf16_f32 v110, v132, v133
    v_add_f32 v138, v138, v132
    v_add_f32 v139, v139, v133
    v_cvt_pk_bf16_f32 v111, v134, v135
    v_add_f32 v138, v138, v134
    v_add_f32 v139, v139, v135
    v_add_f32 v225, v138, v139
    s_nop 1
    s_branch ka_rr19
ka_fix21:
    s_cmp_eq_u32 s36, 0
    s_cselect_b32 s24, 0, 0x74000000
    v_subrev_f32 v230, s24, v243
    v_add_f32 v231, 0, v230
    v_min_f32 v80, v229, v231
    v_add_f32 v232, 0xf1800000, v230
    v_min_f32 v81, v229, v232
    v_add_f32 v231, 0xf2000000, v230
    v_min_f32 v82, v229, v231
    v_add_f32 v232, 0xf2400000, v230
    v_min_f32 v83, v229, v232
    v_add_f32 v231, 0xf3000000, v230
    v_min_f32 v84, v229, v231
    v_add_f32 v232, 0xf3100000, v230
    v_min_f32 v85, v229, v232
    v_add_f32 v231, 0xf3200000, v230
    v_min_f32 v86, v229, v231
    v_add_f32 v232, 0xf3300000, v230
    v_min_f32 v87, v229, v232
    v_add_f32 v231, 0xf3800000, v230
    v_min_f32 v88, v229, v231
    v_add_f32 v232, 0xf3880000, v230
    v_min_f32 v89, v229, v232
    v_add_f32 v231, 0xf3900000, v230
    v_min_f32 v90, v229, v231
    v_add_f32 v232, 0xf3980000, v230
    v_min_f32 v91, v229, v232
    v_add_f32 v231, 0xf3c00000, v230
    v_min_f32 v92, v229, v231
    v_add_f32 v232, 0xf3c80000, v230
    v_min_f32 v93, v229, v232
    v_add_f32 v231, 0xf3d00000, v230
    v_min_f32 v94, v229, v231
    v_add_f32 v232, 0xf3d80000, v230
    v_min_f32 v95, v229, v232
    s_nop 1
    s_branch ka_fixr22
ka_rare24:
    s_nop 15
    v_max3_f32 v230, v48, v49, v50
    v_max3_f32 v230, v230, v51, v52
    v_max3_f32 v230, v230, v53, v54
    v_max3_f32 v230, v230, v55, v56
    v_max3_f32 v230, v230, v57, v58
    v_max3_f32 v230, v230, v59, v60
    v_max3_f32 v230, v230, v61, v62
    v_max_f32 v230, v230, v63
    v_mov_b32 v231, v230
    s_nop 1
    v_permlane32_swap_b32 v230, v231
    s_nop 0
    v_max_f32 v230, v230, v231
    v_max_f32 v230, 0, v230
    v_sub_f32 v232, 0, v230
    v_exp_f32 v232, v232
    v_sub_f32 v229, v229, v230
    v_sub_f32 v80, v80, v230
    v_sub_f32 v16, v16, v230
    v_sub_f32 v48, v48, v230
    v_sub_f32 v81, v81, v230
    v_sub_f32 v17, v17, v230
    v_sub_f32 v49, v49, v230
    v_sub_f32 v82, v82, v230
    v_sub_f32 v18, v18, v230
    v_sub_f32 v50, v50, v230
    v_sub_f32 v83, v83, v230
    v_sub_f32 v19, v19, v230
    v_sub_f32 v51, v51, v230
    v_sub_f32 v84, v84, v230
    v_sub_f32 v20, v20, v230
    v_sub_f32 v52, v52, v230
    v_sub_f32 v85, v85, v230
    v_sub_f32 v21, v21, v230
    v_sub_f32 v53, v53, v230
    v_sub_f32 v86, v86, v230
    v_sub_f32 v22, v22, v230
    v_sub_f32 v54, v54, v230
    v_sub_f32 v87, v87, v230
    v_sub_f32 v23, v23, v230
    v_sub_f32 v55, v55, v230
    v_sub_f32 v88, v88, v230
    v_sub_f32 v24, v24, v230
    v_sub_f32 v56, v56, v230
    v_sub_f32 v89, v89, v230
    v_sub_f32 v25, v25, v230
    v_sub_f32 v57, v57, v230
    v_sub_f32 v90, v90, v230
    v_sub_f32 v26, v26, v230
    v_sub_f32 v58, v58, v230
    v_sub_f32 v91, v91, v230
    v_sub_f32 v27, v27, v230
    v_sub_f32 v59, v59, v230
    v_sub_f32 v92, v92, v230
    v_sub_f32 v28, v28, v230
    v_sub_f32 v60, v60, v230
    v_sub_f32 v93, v93, v230
    v_sub_f32 v29, v29, v230
    v_sub_f32 v61, v61, v230
    v_sub_f32 v94, v94, v230
    v_sub_f32 v30, v30, v230
    v_sub_f32 v62, v62, v230
    v_sub_f32 v95, v95, v230
    v_sub_f32 v31, v31, v230
    v_sub_f32 v63, v63, v230
    v_mul_f32 v227, v227, v232
    v_accvgpr_read_b32 v234, a64
    v_mul_f32 v234, v234, v232
    v_accvgpr_write_b32 a64, v234
    v_accvgpr_read_b32 v235, a65
    v_mul_f32 v235, v235, v232
    v_accvgpr_write_b32 a65, v235
    v_accvgpr_read_b32 v236, a66
    v_mul_f32 v236, v236, v232
    v_accvgpr_write_b32 a66, v236
    v_accvgpr_read_b32 v237, a67
    v_mul_f32 v237, v237, v232
    v_accvgpr_write_b32 a67, v237
    v_accvgpr_read_b32 v234, a68
    v_mul_f32 v234, v234, v232
    v_accvgpr_write_b32 a68, v234
    v_accvgpr_read_b32 v235, a69
    v_mul_f32 v235, v235, v232
    v_accvgpr_write_b32 a69, v235
    v_accvgpr_read_b32 v236, a70
    v_mul_f32 v236, v236, v232
    v_accvgpr_write_b32 a70, v236
    v_accvgpr_read_b32 v237, a71
    v_mul_f32 v237, v237, v232
    v_accvgpr_write_b32 a71, v237
    v_accvgpr_read_b32 v234, a72
    v_mul_f32 v234, v234, v232
    v_accvgpr_write_b32 a72, v234
    v_accvgpr_read_b32 v235, a73
    v_mul_f32 v235, v235, v232
    v_accvgpr_write_b32 a73, v235
    v_accvgpr_read_b32 v236, a74
    v_mul_f32 v236, v236, v232
    v_accvgpr_write_b32 a74, v236
    v_accvgpr_read_b32 v237, a75
    v_mul_f32 v237, v237, v232
    v_accvgpr_write_b32 a75, v237
    v_accvgpr_read_b32 v234, a76
    v_mul_f32 v234, v234, v232
    v_accvgpr_write_b32 a76, v234
    v_accvgpr_read_b32 v235, a77
    v_mul_f32 v235, v235, v232
    v_accvgpr_write_b32 a77, v235
    v_accvgpr_read_b32 v236, a78
    v_mul_f32 v236, v236, v232
    v_accvgpr_write_b32 a78, v236
    v_accvgpr_read_b32 v237, a79
    v_mul_f32 v237, v237, v232
    v_accvgpr_write_b32 a79, v237
    v_accvgpr_read_b32 v234, a80
    v_mul_f32 v234, v234, v232
    v_accvgpr_write_b32 a80, v234
    v_accvgpr_read_b32 v235, a81
    v_mul_f32 v235, v235, v232
    v_accvgpr_write_b32 a81, v235
    v_accvgpr_read_b32 v236, a82
    v_mul_f32 v236, v236, v232
    v_accvgpr_write_b32 a82, v236
    v_accvgpr_read_b32 v237, a83
    v_mul_f32 v237, v237, v232
    v_accvgpr_write_b32 a83, v237
    v_accvgpr_read_b32 v234, a84
    v_mul_f32 v234, v234, v232
    v_accvgpr_write_b32 a84, v234
    v_accvgpr_read_b32 v235, a85
    v_mul_f32 v235, v235, v232
    v_accvgpr_write_b32 a85, v235
    v_accvgpr_read_b32 v236, a86
    v_mul_f32 v236, v236, v232
    v_accvgpr_write_b32 a86, v236
    v_accvgpr_read_b32 v237, a87
    v_mul_f32 v237, v237, v232
    v_accvgpr_write_b32 a87, v237
    v_accvgpr_read_b32 v234, a88
    v_mul_f32 v234, v234, v232
    v_accvgpr_write_b32 a88, v234
    v_accvgpr_read_b32 v235, a89
    v_mul_f32 v235, v235, v232
    v_accvgpr_write_b32 a89, v235
    v_accvgpr_read_b32 v236, a90
    v_mul_f32 v236, v236, v232
    v_accvgpr_write_b32 a90, v236
    v_accvgpr_read_b32 v237, a91
    v_mul_f32 v237, v237, v232
    v_accvgpr_write_b32 a91, v237
    v_accvgpr_read_b32 v234, a92
    v_mul_f32 v234, v234, v232
    v_accvgpr_write_b32 a92, v234
    v_accvgpr_read_b32 v235, a93
    v_mul_f32 v235, v235, v232
    v_accvgpr_write_b32 a93, v235
    v_accvgpr_read_b32 v236, a94
    v_mul_f32 v236, v236, v232
    v_accvgpr_write_b32 a94, v236
    v_accvgpr_read_b32 v237, a95
    v_mul_f32 v237, v237, v232
    v_accvgpr_write_b32 a95, v237
    v_accvgpr_read_b32 v234, a96
    v_mul_f32 v234, v234, v232
    v_accvgpr_write_b32 a96, v234
    v_accvgpr_read_b32 v235, a97
    v_mul_f32 v235, v235, v232
    v_accvgpr_write_b32 a97, v235
    v_accvgpr_read_b32 v236, a98
    v_mul_f32 v236, v236, v232
    v_accvgpr_write_b32 a98, v236
    v_accvgpr_read_b32 v237, a99
    v_mul_f32 v237, v237, v232
    v_accvgpr_write_b32 a99, v237
    v_accvgpr_read_b32 v234, a100
    v_mul_f32 v234, v234, v232
    v_accvgpr_write_b32 a100, v234
    v_accvgpr_read_b32 v235, a101
    v_mul_f32 v235, v235, v232
    v_accvgpr_write_b32 a101, v235
    v_accvgpr_read_b32 v236, a102
    v_mul_f32 v236, v236, v232
    v_accvgpr_write_b32 a102, v236
    v_accvgpr_read_b32 v237, a103
    v_mul_f32 v237, v237, v232
    v_accvgpr_write_b32 a103, v237
    v_accvgpr_read_b32 v234, a104
    v_mul_f32 v234, v234, v232
    v_accvgpr_write_b32 a104, v234
    v_accvgpr_read_b32 v235, a105
    v_mul_f32 v235, v235, v232
    v_accvgpr_write_b32 a105, v235
    v_accvgpr_read_b32 v236, a106
    v_mul_f32 v236, v236, v232
    v_accvgpr_write_b32 a106, v236
    v_accvgpr_read_b32 v237, a107
    v_mul_f32 v237, v237, v232
    v_accvgpr_write_b32 a107, v237
    v_accvgpr_read_b32 v234, a108
    v_mul_f32 v234, v234, v232
    v_accvgpr_write_b32 a108, v234
    v_accvgpr_read_b32 v235, a109
    v_mul_f32 v235, v235, v232
    v_accvgpr_write_b32 a109, v235
    v_accvgpr_read_b32 v236, a110
    v_mul_f32 v236, v236, v232
    v_accvgpr_write_b32 a110, v236
    v_accvgpr_read_b32 v237, a111
    v_mul_f32 v237, v237, v232
    v_accvgpr_write_b32 a111, v237
    v_accvgpr_read_b32 v234, a112
    v_mul_f32 v234, v234, v232
    v_accvgpr_write_b32 a112, v234
    v_accvgpr_read_b32 v235, a113
    v_mul_f32 v235, v235, v232
    v_accvgpr_write_b32 a113, v235
    v_accvgpr_read_b32 v236, a114
    v_mul_f32 v236, v236, v232
    v_accvgpr_write_b32 a114, v236
    v_accvgpr_read_b32 v237, a115
    v_mul_f32 v237, v237, v232
    v_accvgpr_write_b32 a115, v237
    v_accvgpr_read_b32 v234, a116
    v_mul_f32 v234, v234, v232
    v_accvgpr_write_b32 a116, v234
    v_accvgpr_read_b32 v235, a117
    v_mul_f32 v235, v235, v232
    v_accvgpr_write_b32 a117, v235
    v_accvgpr_read_b32 v236, a118
    v_mul_f32 v236, v236, v232
    v_accvgpr_write_b32 a118, v236
    v_accvgpr_read_b32 v237, a119
    v_mul_f32 v237, v237, v232
    v_accvgpr_write_b32 a119, v237
    v_accvgpr_read_b32 v234, a120
    v_mul_f32 v234, v234, v232
    v_accvgpr_write_b32 a120, v234
    v_accvgpr_read_b32 v235, a121
    v_mul_f32 v235, v235, v232
    v_accvgpr_write_b32 a121, v235
    v_accvgpr_read_b32 v236, a122
    v_mul_f32 v236, v236, v232
    v_accvgpr_write_b32 a122, v236
    v_accvgpr_read_b32 v237, a123
    v_mul_f32 v237, v237, v232
    v_accvgpr_write_b32 a123, v237
    v_accvgpr_read_b32 v234, a124
    v_mul_f32 v234, v234, v232
    v_accvgpr_write_b32 a124, v234
    v_accvgpr_read_b32 v235, a125
    v_mul_f32 v235, v235, v232
    v_accvgpr_write_b32 a125, v235
    v_accvgpr_read_b32 v236, a126
    v_mul_f32 v236, v236, v232
    v_accvgpr_write_b32 a126, v236
    v_accvgpr_read_b32 v237, a127
    v_mul_f32 v237, v237, v232
    v_accvgpr_write_b32 a127, v237
    v_exp_f32 v138, v48
    v_exp_f32 v139, v49
    v_exp_f32 v130, v50
    v_exp_f32 v131, v51
    v_cvt_pk_bf16_f32 v120, v138, v139
    v_exp_f32 v132, v52
    v_exp_f32 v133, v53
    v_cvt_pk_bf16_f32 v121, v130, v131
    v_add_f32 v138, v138, v130
    v_add_f32 v139, v139, v131
    v_exp_f32 v134, v54
    v_exp_f32 v135, v55
    v_cvt_pk_bf16_f32 v122, v132, v133
    v_add_f32 v138, v138, v132
    v_add_f32 v139, v139, v133
    v_exp_f32 v128, v56
    v_exp_f32 v129, v57
    v_cvt_pk_bf16_f32 v123, v134, v135
    v_add_f32 v138, v138, v134
    v_add_f32 v139, v139, v135
    v_exp_f32 v130, v58
    v_exp_f32 v131, v59
    v_cvt_pk_bf16_f32 v124, v128, v129
    v_add_f32 v138, v138, v128
    v_add_f32 v139, v139, v129
    v_exp_f32 v132, v60
    v_exp_f32 v133, v61
    v_cvt_pk_bf16_f32 v125, v130, v131
    v_add_f32 v138, v138, v130
    v_add_f32 v139, v139, v131
    v_exp_f32 v134, v62
    v_exp_f32 v135, v63
    v_cvt_pk_bf16_f32 v126, v132, v133
    v_add_f32 v138, v138, v132
    v_add_f32 v139, v139, v133
    v_cvt_pk_bf16_f32 v127, v134, v135
    v_add_f32 v138, v138, v134
    v_add_f32 v139, v139, v135
    v_add_f32 v225, v138, v139
    s_nop 1
    s_branch ka_rr23
ka_fix25:
    s_cmp_eq_u32 s36, 0
    s_cselect_b32 s24, 0, 0x74000000
    v_subrev_f32 v230, s24, v243
    v_add_f32 v231, 0, v230
    v_min_f32 v80, v229, v231
    v_add_f32 v232, 0xf1800000, v230
    v_min_f32 v81, v229, v232
    v_add_f32 v231, 0xf2000000, v230
    v_min_f32 v82, v229, v231
    v_add_f32 v232, 0xf2400000, v230
    v_min_f32 v83, v229, v232
    v_add_f32 v231, 0xf3000000, v230
    v_min_f32 v84, v229, v231
    v_add_f32 v232, 0xf3100000, v230
    v_min_f32 v85, v229, v232
    v_add_f32 v231, 0xf3200000, v230
    v_min_f32 v86, v229, v231
    v_add_f32 v232, 0xf3300000, v230
    v_min_f32 v87, v229, v232
    v_add_f32 v231, 0xf3800000, v230
    v_min_f32 v88, v229, v231
    v_add_f32 v232, 0xf3880000, v230
    v_min_f32 v89, v229, v232
    v_add_f32 v231, 0xf3900000, v230
    v_min_f32 v90, v229, v231
    v_add_f32 v232, 0xf3980000, v230
    v_min_f32 v91, v229, v232
    v_add_f32 v231, 0xf3c00000, v230
    v_min_f32 v92, v229, v231
    v_add_f32 v232, 0xf3c80000, v230
    v_min_f32 v93, v229, v232
    v_add_f32 v231, 0xf3d00000, v230
    v_min_f32 v94, v229, v231
    v_add_f32 v232, 0xf3d80000, v230
    v_min_f32 v95, v229, v232
    s_nop 1
    s_branch ka_fixr26
ka_rare28:
    s_nop 15
    v_max3_f32 v230, v16, v17, v18
    v_max3_f32 v230, v230, v19, v20
    v_max3_f32 v230, v230, v21, v22
    v_max3_f32 v230, v230, v23, v24
    v_max3_f32 v230, v230, v25, v26
    v_max3_f32 v230, v230, v27, v28
    v_max3_f32 v230, v230, v29, v30
    v_max_f32 v230, v230, v31
    v_mov_b32 v231, v230
    s_nop 1
    v_permlane32_swap_b32 v230, v231
    s_nop 0
    v_max_f32 v230, v230, v231
    v_max_f32 v230, 0, v230
    v_sub_f32 v232, 0, v230
    v_exp_f32 v232, v232
    v_sub_f32 v229, v229, v230
    v_sub_f32 v80, v80, v230
    v_sub_f32 v48, v48, v230
    v_sub_f32 v16, v16, v230
    v_sub_f32 v81, v81, v230
    v_sub_f32 v49, v49, v230
    v_sub_f32 v17, v17, v230
    v_sub_f32 v82, v82, v230
    v_sub_f32 v50, v50, v230
    v_sub_f32 v18, v18, v230
    v_sub_f32 v83, v83, v230
    v_sub_f32 v51, v51, v230
    v_sub_f32 v19, v19, v230
    v_sub_f32 v84, v84, v230
    v_sub_f32 v52, v52, v230
    v_sub_f32 v20, v20, v230
    v_sub_f32 v85, v85, v230
    v_sub_f32 v53, v53, v230
    v_sub_f32 v21, v21, v230
    v_sub_f32 v86, v86, v230
    v_sub_f32 v54, v54, v230
    v_sub_f32 v22, v22, v230
    v_sub_f32 v87, v87, v230
    v_sub_f32 v55, v55, v230
    v_sub_f32 v23, v23, v230
    v_sub_f32 v88, v88, v230
    v_sub_f32 v56, v56, v230
    v_sub_f32 v24, v24, v230
    v_sub_f32 v89, v89, v230
    v_sub_f32 v57, v57, v230
    v_sub_f32 v25, v25, v230
    v_sub_f32 v90, v90, v230
    v_sub_f32 v58, v58, v230
    v_sub_f32 v26, v26, v230
    v_sub_f32 v91, v91, v230
    v_sub_f32 v59, v59, v230
    v_sub_f32 v27, v27, v230
    v_sub_f32 v92, v92, v230
    v_sub_f32 v60, v60, v230
    v_sub_f32 v28, v28, v230
    v_sub_f32 v93, v93, v230
    v_sub_f32 v61, v61, v230
    v_sub_f32 v29, v29, v230
    v_sub_f32 v94, v94, v230
    v_sub_f32 v62, v62, v230
    v_sub_f32 v30, v30, v230
    v_sub_f32 v95, v95, v230
    v_sub_f32 v63, v63, v230
    v_sub_f32 v31, v31, v230
    v_mul_f32 v227, v227, v232
    v_accvgpr_read_b32 v234, a64
    v_mul_f32 v234, v234, v232
    v_accvgpr_write_b32 a64, v234
    v_accvgpr_read_b32 v235, a65
    v_mul_f32 v235, v235, v232
    v_accvgpr_write_b32 a65, v235
    v_accvgpr_read_b32 v236, a66
    v_mul_f32 v236, v236, v232
    v_accvgpr_write_b32 a66, v236
    v_accvgpr_read_b32 v237, a67
    v_mul_f32 v237, v237, v232
    v_accvgpr_write_b32 a67, v237
    v_accvgpr_read_b32 v234, a68
    v_mul_f32 v234, v234, v232
    v_accvgpr_write_b32 a68, v234
    v_accvgpr_read_b32 v235, a69
    v_mul_f32 v235, v235, v232
    v_accvgpr_write_b32 a69, v235
    v_accvgpr_read_b32 v236, a70
    v_mul_f32 v236, v236, v232
    v_accvgpr_write_b32 a70, v236
    v_accvgpr_read_b32 v237, a71
    v_mul_f32 v237, v237, v232
    v_accvgpr_write_b32 a71, v237
    v_accvgpr_read_b32 v234, a72
    v_mul_f32 v234, v234, v232
    v_accvgpr_write_b32 a72, v234
    v_accvgpr_read_b32 v235, a73
    v_mul_f32 v235, v235, v232
    v_accvgpr_write_b32 a73, v235
    v_accvgpr_read_b32 v236, a74
    v_mul_f32 v236, v236, v232
    v_accvgpr_write_b32 a74, v236
    v_accvgpr_read_b32 v237, a75
    v_mul_f32 v237, v237, v232
    v_accvgpr_write_b32 a75, v237
    v_accvgpr_read_b32 v234, a76
    v_mul_f32 v234, v234, v232
    v_accvgpr_write_b32 a76, v234
    v_accvgpr_read_b32 v235, a77
    v_mul_f32 v235, v235, v232
    v_accvgpr_write_b32 a77, v235
    v_accvgpr_read_b32 v236, a78
    v_mul_f32 v236, v236, v232
    v_accvgpr_write_b32 a78, v236
    v_accvgpr_read_b32 v237, a79
    v_mul_f32 v237, v237, v232
    v_accvgpr_write_b32 a79, v237
    v_accvgpr_read_b32 v234, a80
    v_mul_f32 v234, v234, v232
    v_accvgpr_write_b32 a80, v234
    v_accvgpr_read_b32 v235, a81
    v_mul_f32 v235, v235, v232
    v_accvgpr_write_b32 a81, v235
    v_accvgpr_read_b32 v236, a82
    v_mul_f32 v236, v236, v232
    v_accvgpr_write_b32 a82, v236
    v_accvgpr_read_b32 v237, a83
    v_mul_f32 v237, v237, v232
    v_accvgpr_write_b32 a83, v237
    v_accvgpr_read_b32 v234, a84
    v_mul_f32 v234, v234, v232
    v_accvgpr_write_b32 a84, v234
    v_accvgpr_read_b32 v235, a85
    v_mul_f32 v235, v235, v232
    v_accvgpr_write_b32 a85, v235
    v_accvgpr_read_b32 v236, a86
    v_mul_f32 v236, v236, v232
    v_accvgpr_write_b32 a86, v236
    v_accvgpr_read_b32 v237, a87
    v_mul_f32 v237, v237, v232
    v_accvgpr_write_b32 a87, v237
    v_accvgpr_read_b32 v234, a88
    v_mul_f32 v234, v234, v232
    v_accvgpr_write_b32 a88, v234
    v_accvgpr_read_b32 v235, a89
    v_mul_f32 v235, v235, v232
    v_accvgpr_write_b32 a89, v235
    v_accvgpr_read_b32 v236, a90
    v_mul_f32 v236, v236, v232
    v_accvgpr_write_b32 a90, v236
    v_accvgpr_read_b32 v237, a91
    v_mul_f32 v237, v237, v232
    v_accvgpr_write_b32 a91, v237
    v_accvgpr_read_b32 v234, a92
    v_mul_f32 v234, v234, v232
    v_accvgpr_write_b32 a92, v234
    v_accvgpr_read_b32 v235, a93
    v_mul_f32 v235, v235, v232
    v_accvgpr_write_b32 a93, v235
    v_accvgpr_read_b32 v236, a94
    v_mul_f32 v236, v236, v232
    v_accvgpr_write_b32 a94, v236
    v_accvgpr_read_b32 v237, a95
    v_mul_f32 v237, v237, v232
    v_accvgpr_write_b32 a95, v237
    v_accvgpr_read_b32 v234, a96
    v_mul_f32 v234, v234, v232
    v_accvgpr_write_b32 a96, v234
    v_accvgpr_read_b32 v235, a97
    v_mul_f32 v235, v235, v232
    v_accvgpr_write_b32 a97, v235
    v_accvgpr_read_b32 v236, a98
    v_mul_f32 v236, v236, v232
    v_accvgpr_write_b32 a98, v236
    v_accvgpr_read_b32 v237, a99
    v_mul_f32 v237, v237, v232
    v_accvgpr_write_b32 a99, v237
    v_accvgpr_read_b32 v234, a100
    v_mul_f32 v234, v234, v232
    v_accvgpr_write_b32 a100, v234
    v_accvgpr_read_b32 v235, a101
    v_mul_f32 v235, v235, v232
    v_accvgpr_write_b32 a101, v235
    v_accvgpr_read_b32 v236, a102
    v_mul_f32 v236, v236, v232
    v_accvgpr_write_b32 a102, v236
    v_accvgpr_read_b32 v237, a103
    v_mul_f32 v237, v237, v232
    v_accvgpr_write_b32 a103, v237
    v_accvgpr_read_b32 v234, a104
    v_mul_f32 v234, v234, v232
    v_accvgpr_write_b32 a104, v234
    v_accvgpr_read_b32 v235, a105
    v_mul_f32 v235, v235, v232
    v_accvgpr_write_b32 a105, v235
    v_accvgpr_read_b32 v236, a106
    v_mul_f32 v236, v236, v232
    v_accvgpr_write_b32 a106, v236
    v_accvgpr_read_b32 v237, a107
    v_mul_f32 v237, v237, v232
    v_accvgpr_write_b32 a107, v237
    v_accvgpr_read_b32 v234, a108
    v_mul_f32 v234, v234, v232
    v_accvgpr_write_b32 a108, v234
    v_accvgpr_read_b32 v235, a109
    v_mul_f32 v235, v235, v232
    v_accvgpr_write_b32 a109, v235
    v_accvgpr_read_b32 v236, a110
    v_mul_f32 v236, v236, v232
    v_accvgpr_write_b32 a110, v236
    v_accvgpr_read_b32 v237, a111
    v_mul_f32 v237, v237, v232
    v_accvgpr_write_b32 a111, v237
    v_accvgpr_read_b32 v234, a112
    v_mul_f32 v234, v234, v232
    v_accvgpr_write_b32 a112, v234
    v_accvgpr_read_b32 v235, a113
    v_mul_f32 v235, v235, v232
    v_accvgpr_write_b32 a113, v235
    v_accvgpr_read_b32 v236, a114
    v_mul_f32 v236, v236, v232
    v_accvgpr_write_b32 a114, v236
    v_accvgpr_read_b32 v237, a115
    v_mul_f32 v237, v237, v232
    v_accvgpr_write_b32 a115, v237
    v_accvgpr_read_b32 v234, a116
    v_mul_f32 v234, v234, v232
    v_accvgpr_write_b32 a116, v234
    v_accvgpr_read_b32 v235, a117
    v_mul_f32 v235, v235, v232
    v_accvgpr_write_b32 a117, v235
    v_accvgpr_read_b32 v236, a118
    v_mul_f32 v236, v236, v232
    v_accvgpr_write_b32 a118, v236
    v_accvgpr_read_b32 v237, a119
    v_mul_f32 v237, v237, v232
    v_accvgpr_write_b32 a119, v237
    v_accvgpr_read_b32 v234, a120
    v_mul_f32 v234, v234, v232
    v_accvgpr_write_b32 a120, v234
    v_accvgpr_read_b32 v235, a121
    v_mul_f32 v235, v235, v232
    v_accvgpr_write_b32 a121, v235
    v_accvgpr_read_b32 v236, a122
    v_mul_f32 v236, v236, v232
    v_accvgpr_write_b32 a122, v236
    v_accvgpr_read_b32 v237, a123
    v_mul_f32 v237, v237, v232
    v_accvgpr_write_b32 a123, v237
    v_accvgpr_read_b32 v234, a124
    v_mul_f32 v234, v234, v232
    v_accvgpr_write_b32 a124, v234
    v_accvgpr_read_b32 v235, a125
    v_mul_f32 v235, v235, v232
    v_accvgpr_write_b32 a125, v235
    v_accvgpr_read_b32 v236, a126
    v_mul_f32 v236, v236, v232
    v_accvgpr_write_b32 a126, v236
    v_accvgpr_read_b32 v237, a127
    v_mul_f32 v237, v237, v232
    v_accvgpr_write_b32 a127, v237
    v_exp_f32 v138, v16
    v_exp_f32 v139, v17
    v_exp_f32 v130, v18
    v_exp_f32 v131, v19
    v_cvt_pk_bf16_f32 v104, v138, v139
    v_exp_f32 v132, v20
    v_exp_f32 v133, v21
    v_cvt_pk_bf16_f32 v105, v130, v131
    v_add_f32 v138, v138, v130
    v_add_f32 v139, v139, v131
    v_exp_f32 v134, v22
    v_exp_f32 v135, v23
    v_cvt_pk_bf16_f32 v106, v132, v133
    v_add_f32 v138, v138, v132
    v_add_f32 v139, v139, v133
    v_exp_f32 v128, v24
    v_exp_f32 v129, v25
    v_cvt_pk_bf16_f32 v107, v134, v135
    v_add_f32 v138, v138, v134
    v_add_f32 v139, v139, v135
    v_exp_f32 v130, v26
    v_exp_f32 v131, v27
    v_cvt_pk_bf16_f32 v108, v128, v129
    v_add_f32 v138, v138, v128
    v_add_f32 v139, v139, v129
    v_exp_f32 v132, v28
    v_exp_f32 v133, v29
    v_cvt_pk_bf16_f32 v109, v130, v131
    v_add_f32 v138, v138, v130
    v_add_f32 v139, v139, v131
    v_exp_f32 v134, v30
    v_exp_f32 v135, v31
    v_cvt_pk_bf16_f32 v110, v132, v133
    v_add_f32 v138, v138, v132
    v_add_f32 v139, v139, v133
    v_cvt_pk_bf16_f32 v111, v134, v135
    v_add_f32 v138, v138, v134
    v_add_f32 v139, v139, v135
    v_add_f32 v225, v138, v139
    s_nop 1
    s_branch ka_rr27
ka_rare30:
    s_nop 15
    v_max3_f32 v230, v48, v49, v50
    v_max3_f32 v230, v230, v51, v52
    v_max3_f32 v230, v230, v53, v54
    v_max3_f32 v230, v230, v55, v56
    v_max3_f32 v230, v230, v57, v58
    v_max3_f32 v230, v230, v59, v60
    v_max3_f32 v230, v230, v61, v62
    v_max_f32 v230, v230, v63
    v_mov_b32 v231, v230
    s_nop 1
    v_permlane32_swap_b32 v230, v231
    s_nop 0
    v_max_f32 v230, v230, v231
    v_max_f32 v230, 0, v230
    v_sub_f32 v232, 0, v230
    v_exp_f32 v232, v232
    v_sub_f32 v229, v229, v230
    v_sub_f32 v80, v80, v230
    v_sub_f32 v16, v16, v230
    v_sub_f32 v48, v48, v230
    v_sub_f32 v81, v81, v230
    v_sub_f32 v17, v17, v230
    v_sub_f32 v49, v49, v230
    v_sub_f32 v82, v82, v230
    v_sub_f32 v18, v18, v230
    v_sub_f32 v50, v50, v230
    v_sub_f32 v83, v83, v230
    v_sub_f32 v19, v19, v230
    v_sub_f32 v51, v51, v230
    v_sub_f32 v84, v84, v230
    v_sub_f32 v20, v20, v230
    v_sub_f32 v52, v52, v230
    v_sub_f32 v85, v85, v230
    v_sub_f32 v21, v21, v230
    v_sub_f32 v53, v53, v230
    v_sub_f32 v86, v86, v230
    v_sub_f32 v22, v22, v230
    v_sub_f32 v54, v54, v230
    v_sub_f32 v87, v87, v230
    v_sub_f32 v23, v23, v230
    v_sub_f32 v55, v55, v230
    v_sub_f32 v88, v88, v230
    v_sub_f32 v24, v24, v230
    v_sub_f32 v56, v56, v230
    v_sub_f32 v89, v89, v230
    v_sub_f32 v25, v25, v230
    v_sub_f32 v57, v57, v230
    v_sub_f32 v90, v90, v230
    v_sub_f32 v26, v26, v230
    v_sub_f32 v58, v58, v230
    v_sub_f32 v91, v91, v230
    v_sub_f32 v27, v27, v230
    v_sub_f32 v59, v59, v230
    v_sub_f32 v92, v92, v230
    v_sub_f32 v28, v28, v230
    v_sub_f32 v60, v60, v230
    v_sub_f32 v93, v93, v230
    v_sub_f32 v29, v29, v230
    v_sub_f32 v61, v61, v230
    v_sub_f32 v94, v94, v230
    v_sub_f32 v30, v30, v230
    v_sub_f32 v62, v62, v230
    v_sub_f32 v95, v95, v230
    v_sub_f32 v31, v31, v230
    v_sub_f32 v63, v63, v230
    v_mul_f32 v227, v227, v232
    v_accvgpr_read_b32 v234, a64
    v_mul_f32 v234, v234, v232
    v_accvgpr_write_b32 a64, v234
    v_accvgpr_read_b32 v235, a65
    v_mul_f32 v235, v235, v232
    v_accvgpr_write_b32 a65, v235
    v_accvgpr_read_b32 v236, a66
    v_mul_f32 v236, v236, v232
    v_accvgpr_write_b32 a66, v236
    v_accvgpr_read_b32 v237, a67
    v_mul_f32 v237, v237, v232
    v_accvgpr_write_b32 a67, v237
    v_accvgpr_read_b32 v234, a68
    v_mul_f32 v234, v234, v232
    v_accvgpr_write_b32 a68, v234
    v_accvgpr_read_b32 v235, a69
    v_mul_f32 v235, v235, v232
    v_accvgpr_write_b32 a69, v235
    v_accvgpr_read_b32 v236, a70
    v_mul_f32 v236, v236, v232
    v_accvgpr_write_b32 a70, v236
    v_accvgpr_read_b32 v237, a71
    v_mul_f32 v237, v237, v232
    v_accvgpr_write_b32 a71, v237
    v_accvgpr_read_b32 v234, a72
    v_mul_f32 v234, v234, v232
    v_accvgpr_write_b32 a72, v234
    v_accvgpr_read_b32 v235, a73
    v_mul_f32 v235, v235, v232
    v_accvgpr_write_b32 a73, v235
    v_accvgpr_read_b32 v236, a74
    v_mul_f32 v236, v236, v232
    v_accvgpr_write_b32 a74, v236
    v_accvgpr_read_b32 v237, a75
    v_mul_f32 v237, v237, v232
    v_accvgpr_write_b32 a75, v237
    v_accvgpr_read_b32 v234, a76
    v_mul_f32 v234, v234, v232
    v_accvgpr_write_b32 a76, v234
    v_accvgpr_read_b32 v235, a77
    v_mul_f32 v235, v235, v232
    v_accvgpr_write_b32 a77, v235
    v_accvgpr_read_b32 v236, a78
    v_mul_f32 v236, v236, v232
    v_accvgpr_write_b32 a78, v236
    v_accvgpr_read_b32 v237, a79
    v_mul_f32 v237, v237, v232
    v_accvgpr_write_b32 a79, v237
    v_accvgpr_read_b32 v234, a80
    v_mul_f32 v234, v234, v232
    v_accvgpr_write_b32 a80, v234
    v_accvgpr_read_b32 v235, a81
    v_mul_f32 v235, v235, v232
    v_accvgpr_write_b32 a81, v235
    v_accvgpr_read_b32 v236, a82
    v_mul_f32 v236, v236, v232
    v_accvgpr_write_b32 a82, v236
    v_accvgpr_read_b32 v237, a83
    v_mul_f32 v237, v237, v232
    v_accvgpr_write_b32 a83, v237
    v_accvgpr_read_b32 v234, a84
    v_mul_f32 v234, v234, v232
    v_accvgpr_write_b32 a84, v234
    v_accvgpr_read_b32 v235, a85
    v_mul_f32 v235, v235, v232
    v_accvgpr_write_b32 a85, v235
    v_accvgpr_read_b32 v236, a86
    v_mul_f32 v236, v236, v232
    v_accvgpr_write_b32 a86, v236
    v_accvgpr_read_b32 v237, a87
    v_mul_f32 v237, v237, v232
    v_accvgpr_write_b32 a87, v237
    v_accvgpr_read_b32 v234, a88
    v_mul_f32 v234, v234, v232
    v_accvgpr_write_b32 a88, v234
    v_accvgpr_read_b32 v235, a89
    v_mul_f32 v235, v235, v232
    v_accvgpr_write_b32 a89, v235
    v_accvgpr_read_b32 v236, a90
    v_mul_f32 v236, v236, v232
    v_accvgpr_write_b32 a90, v236
    v_accvgpr_read_b32 v237, a91
    v_mul_f32 v237, v237, v232
    v_accvgpr_write_b32 a91, v237
    v_accvgpr_read_b32 v234, a92
    v_mul_f32 v234, v234, v232
    v_accvgpr_write_b32 a92, v234
    v_accvgpr_read_b32 v235, a93
    v_mul_f32 v235, v235, v232
    v_accvgpr_write_b32 a93, v235
    v_accvgpr_read_b32 v236, a94
    v_mul_f32 v236, v236, v232
    v_accvgpr_write_b32 a94, v236
    v_accvgpr_read_b32 v237, a95
    v_mul_f32 v237, v237, v232
    v_accvgpr_write_b32 a95, v237
    v_accvgpr_read_b32 v234, a96
    v_mul_f32 v234, v234, v232
    v_accvgpr_write_b32 a96, v234
    v_accvgpr_read_b32 v235, a97
    v_mul_f32 v235, v235, v232
    v_accvgpr_write_b32 a97, v235
    v_accvgpr_read_b32 v236, a98
    v_mul_f32 v236, v236, v232
    v_accvgpr_write_b32 a98, v236
    v_accvgpr_read_b32 v237, a99
    v_mul_f32 v237, v237, v232
    v_accvgpr_write_b32 a99, v237
    v_accvgpr_read_b32 v234, a100
    v_mul_f32 v234, v234, v232
    v_accvgpr_write_b32 a100, v234
    v_accvgpr_read_b32 v235, a101
    v_mul_f32 v235, v235, v232
    v_accvgpr_write_b32 a101, v235
    v_accvgpr_read_b32 v236, a102
    v_mul_f32 v236, v236, v232
    v_accvgpr_write_b32 a102, v236
    v_accvgpr_read_b32 v237, a103
    v_mul_f32 v237, v237, v232
    v_accvgpr_write_b32 a103, v237
    v_accvgpr_read_b32 v234, a104
    v_mul_f32 v234, v234, v232
    v_accvgpr_write_b32 a104, v234
    v_accvgpr_read_b32 v235, a105
    v_mul_f32 v235, v235, v232
    v_accvgpr_write_b32 a105, v235
    v_accvgpr_read_b32 v236, a106
    v_mul_f32 v236, v236, v232
    v_accvgpr_write_b32 a106, v236
    v_accvgpr_read_b32 v237, a107
    v_mul_f32 v237, v237, v232
    v_accvgpr_write_b32 a107, v237
    v_accvgpr_read_b32 v234, a108
    v_mul_f32 v234, v234, v232
    v_accvgpr_write_b32 a108, v234
    v_accvgpr_read_b32 v235, a109
    v_mul_f32 v235, v235, v232
    v_accvgpr_write_b32 a109, v235
    v_accvgpr_read_b32 v236, a110
    v_mul_f32 v236, v236, v232
    v_accvgpr_write_b32 a110, v236
    v_accvgpr_read_b32 v237, a111
    v_mul_f32 v237, v237, v232
    v_accvgpr_write_b32 a111, v237
    v_accvgpr_read_b32 v234, a112
    v_mul_f32 v234, v234, v232
    v_accvgpr_write_b32 a112, v234
    v_accvgpr_read_b32 v235, a113
    v_mul_f32 v235, v235, v232
    v_accvgpr_write_b32 a113, v235
    v_accvgpr_read_b32 v236, a114
    v_mul_f32 v236, v236, v232
    v_accvgpr_write_b32 a114, v236
    v_accvgpr_read_b32 v237, a115
    v_mul_f32 v237, v237, v232
    v_accvgpr_write_b32 a115, v237
    v_accvgpr_read_b32 v234, a116
    v_mul_f32 v234, v234, v232
    v_accvgpr_write_b32 a116, v234
    v_accvgpr_read_b32 v235, a117
    v_mul_f32 v235, v235, v232
    v_accvgpr_write_b32 a117, v235
    v_accvgpr_read_b32 v236, a118
    v_mul_f32 v236, v236, v232
    v_accvgpr_write_b32 a118, v236
    v_accvgpr_read_b32 v237, a119
    v_mul_f32 v237, v237, v232
    v_accvgpr_write_b32 a119, v237
    v_accvgpr_read_b32 v234, a120
    v_mul_f32 v234, v234, v232
    v_accvgpr_write_b32 a120, v234
    v_accvgpr_read_b32 v235, a121
    v_mul_f32 v235, v235, v232
    v_accvgpr_write_b32 a121, v235
    v_accvgpr_read_b32 v236, a122
    v_mul_f32 v236, v236, v232
    v_accvgpr_write_b32 a122, v236
    v_accvgpr_read_b32 v237, a123
    v_mul_f32 v237, v237, v232
    v_accvgpr_write_b32 a123, v237
    v_accvgpr_read_b32 v234, a124
    v_mul_f32 v234, v234, v232
    v_accvgpr_write_b32 a124, v234
    v_accvgpr_read_b32 v235, a125
    v_mul_f32 v235, v235, v232
    v_accvgpr_write_b32 a125, v235
    v_accvgpr_read_b32 v236, a126
    v_mul_f32 v236, v236, v232
    v_accvgpr_write_b32 a126, v236
    v_accvgpr_read_b32 v237, a127
    v_mul_f32 v237, v237, v232
    v_accvgpr_write_b32 a127, v237
    v_exp_f32 v138, v48
    v_exp_f32 v139, v49
    v_exp_f32 v130, v50
    v_exp_f32 v131, v51
    v_cvt_pk_bf16_f32 v120, v138, v139
    v_exp_f32 v132, v52
    v_exp_f32 v133, v53
    v_cvt_pk_bf16_f32 v121, v130, v131
    v_add_f32 v138, v138, v130
    v_add_f32 v139, v139, v131
    v_exp_f32 v134, v54
    v_exp_f32 v135, v55
    v_cvt_pk_bf16_f32 v122, v132, v133
    v_add_f32 v138, v138, v132
    v_add_f32 v139, v139, v133
    v_exp_f32 v128, v56
    v_exp_f32 v129, v57
    v_cvt_pk_bf16_f32 v123, v134, v135
    v_add_f32 v138, v138, v134
    v_add_f32 v139, v139, v135
    v_exp_f32 v130, v58
    v_exp_f32 v131, v59
    v_cvt_pk_bf16_f32 v124, v128, v129
    v_add_f32 v138, v138, v128
    v_add_f32 v139, v139, v129
    v_exp_f32 v132, v60
    v_exp_f32 v133, v61
    v_cvt_pk_bf16_f32 v125, v130, v131
    v_add_f32 v138, v138, v130
    v_add_f32 v139, v139, v131
    v_exp_f32 v134, v62
    v_exp_f32 v135, v63
    v_cvt_pk_bf16_f32 v126, v132, v133
    v_add_f32 v138, v138, v132
    v_add_f32 v139, v139, v133
    v_cvt_pk_bf16_f32 v127, v134, v135
    v_add_f32 v138, v138, v134
    v_add_f32 v139, v139, v135
    v_add_f32 v225, v138, v139
    s_nop 1
    s_branch ka_rr29
ka_spin31:
    s_mov_b32 s25, 0x400000
ka_spin31_l:
    s_sleep 2
    buffer_load_dword v254, off, s[88:91], s39 sc1
    s_waitcnt vmcnt(0)
    v_readfirstlane_b32 s24, v254
    s_sub_u32 s25, s25, 1
    s_cbranch_scc1 ka_spinr32
    s_cmp_ge_u32 s24, 32
    s_cbranch_scc0 ka_spin31_l
    s_branch ka_spinr32
ka_spin33:
    s_mov_b32 s25, 0x400000
ka_spin33_l:
    s_sleep 2
    buffer_load_dword v254, off, s[88:91], s39 sc1
    s_waitcnt vmcnt(0)
    v_readfirstlane_b32 s24, v254
    s_sub_u32 s25, s25, 1
    s_cbranch_scc1 ka_spinr34
    s_cmp_ge_u32 s24, 32
    s_cbranch_scc0 ka_spin33_l
    s_branch ka_spinr34
ka_spin35:
    s_mov_b32 s25, 0x400000
ka_spin35_l:
    s_sleep 2
    buffer_load_dword v254, off, s[88:91], s35 sc1
    s_waitcnt vmcnt(0)
    v_readfirstlane_b32 s24, v254
    s_sub_u32 s25, s25, 1
    s_cbranch_scc1 ka_spinr36
    s_cmp_ge_u32 s24, 8
    s_cbranch_scc0 ka_spin35_l
    s_branch ka_spinr36

.globl k3_kernel
.p2align 8
.type k3_kernel,@function
k3_kernel:
    s_cmp_ge_u32 s2, 256
    s_cbranch_scc1 k3_done
    s_load_dwordx2 s[40:41], s[0:1], 0
    s_load_dwordx2 s[42:43], s[0:1], 40
    s_load_dwordx2 s[44:45], s[0:1], 56
    s_load_dwordx2 s[46:47], s[0:1], 104
    v_lshrrev_b32 v1, 6, v0
    v_and_b32 v227, 63, v0
    v_readfirstlane_b32 s3, v1
    s_and_b32 s32, s2, 6
    s_lshl_b32 s4, s32, 1
    s_lshr_b32 s32, s2, 3
    s_and_b32 s33, s32, 3
    s_add_u32 s4, s4, s33
    s_lshr_b32 s5, s32, 2
    s_and_b32 s32, s2, 1
    s_lshl_b32 s32, s32, 3
    s_add_u32 s5, s5, s32
    s_waitcnt lgkmcnt(0)
    s_add_u32 s8, s46, 0x2400000
    s_addc_u32 s9, s47, 0
    s_mov_b32 s10, 0x1000000
    s_mov_b32 s11, 0x00020000
    s_mov_b32 s12, s42
    s_mov_b32 s13, s43
    s_mov_b32 s14, 0x800000
    s_mov_b32 s15, 0x00020000
    s_mov_b32 s16, s40
    s_mov_b32 s17, s41
    s_mov_b32 s18, 0x400000
    s_mov_b32 s19, 0x00020000
    s_add_u32 s20, s46, 0x3400000
    s_addc_u32 s21, s47, 0
    s_mov_b32 s22, 0x400000
    s_mov_b32 s23, 0x00020000
    s_add_u32 s24, s46, 0x3800000
    s_addc_u32 s25, s47, 0
    s_mov_b32 s26, 0x6040
    s_mov_b32 s27, 0x00020000
    s_mov_b32 s28, s44
    s_mov_b32 s29, s45
    s_mov_b32 s30, 0x800
    s_mov_b32 s31, 0x00020000
    v_lshlrev_b32 v213, 4, v227
    s_lshl1_add_u32 s32, s3, 0
    s_and_b32 s32, s32, 7
    s_lshl_b32 s32, s32, 17
    v_add_u32 v200, s32, v213
    s_lshl1_add_u32 s32, s3, 1
    s_and_b32 s32, s32, 7
    s_lshl_b32 s32, s32, 17
    v_add_u32 v201, s32, v213
    s_lshl1_add_u32 s32, s3, 2
    s_and_b32 s32, s32, 7
    s_lshl_b32 s32, s32, 17
    v_add_u32 v202, s32, v213
    s_lshl1_add_u32 s32, s3, 3
    s_and_b32 s32, s32, 7
    s_lshl_b32 s32, s32, 17
    v_add_u32 v203, s32, v213
    s_lshl1_add_u32 s32, s3, 4
    s_and_b32 s32, s32, 7
    s_lshl_b32 s32, s32, 17
    v_add_u32 v204, s32, v213
    s_lshl1_add_u32 s32, s3, 5
    s_and_b32 s32, s32, 7
    s_lshl_b32 s32, s32, 17
    v_add_u32 v205, s32, v213
    s_lshl1_add_u32 s32, s3, 6
    s_and_b32 s32, s32, 7
    s_lshl_b32 s32, s32, 17
    v_add_u32 v206, s32, v213
    s_lshl1_add_u32 s32, s3, 7
    s_and_b32 s32, s32, 7
    s_lshl_b32 s32, s32, 17
    v_add_u32 v207, s32, v213
    s_lshl_b32 s35, s4, 20
    s_lshl_b32 s32, s3, 15
    s_add_u32 s35, s35, s32
    v_lshrrev_b32 v224, 3, v227
    v_and_b32 v225, 6, v224
    v_and_b32 v226, 7, v227
    v_xor_b32 v225, v225, v226
    v_lshlrev_b32 v225, 4, v225
    v_lshl_add_u32 v225, v224, 11, v225
    s_lshl_b32 s32, s5, 7
    v_add_u32 v208, s32, v225
    s_lshl_b32 s36, s3, 21
    s_lshl_b32 s37, s3, 14
    s_add_u32 m0, s37, 0
    s_add_u32 s32, s36, 0
    buffer_load_dwordx4 v208, s[12:15], s32 offen lds
    s_add_u32 m0, s37, 1024
    s_add_u32 s32, s36, 16384
    buffer_load_dwordx4 v208, s[12:15], s32 offen lds
    s_add_u32 m0, s37, 2048
    s_add_u32 s32, s36, 32768
    buffer_load_dwordx4 v208, s[12:15], s32 offen lds
    s_add_u32 m0, s37, 3072
    s_add_u32 s32, s36, 49152
    buffer_load_dwordx4 v208, s[12:15], s32 offen lds
    buffer_load_dwordx4 v[0:3], v200, s[8:11], s35 offen offset:0
    buffer_load_dwordx4 v[4:7], v201, s[8:11], s35 offen offset:0
    buffer_load_dwordx4 v[8:11], v202, s[8:11], s35 offen offset:0
    buffer_load_dwordx4 v[12:15], v203, s[8:11], s35 offen offset:0
    buffer_load_dwordx4 v[16:19], v204, s[8:11], s35 offen offset:0
    buffer_load_dwordx4 v[20:23], v205, s[8:11], s35 offen offset:0
    buffer_load_dwordx4 v[24:27], v206, s[8:11], s35 offen offset:0
    buffer_load_dwordx4 v[28:31], v207, s[8:11], s35 offen offset:0
    s_add_u32 m0, s37, 4096
    s_add_u32 s32, s36, 65536
    buffer_load_dwordx4 v208, s[12:15], s32 offen lds
    s_add_u32 m0, s37, 5120
    s_add_u32 s32, s36, 81920
    buffer_load_dwordx4 v208, s[12:15], s32 offen lds
    s_add_u32 m0, s37, 6144
    s_add_u32 s32, s36, 98304
    buffer_load_dwordx4 v208, s[12:15], s32 offen lds
    s_add_u32 m0, s37, 7168
    s_add_u32 s32, s36, 114688
    buffer_load_dwordx4 v208, s[12:15], s32 offen lds
    buffer_load_dwordx4 v[32:35], v200, s[8:11], s35 offen offset:1024
    buffer_load_dwordx4 v[36:39], v201, s[8:11], s35 offen offset:1024
    buffer_load_dwordx4 v[40:43], v202, s[8:11], s35 offen offset:1024
    buffer_load_dwordx4 v[44:47], v203, s[8:11], s35 offen offset:1024
    buffer_load_dwordx4 v[48:51], v204, s[8:11], s35 offen offset:1024
    buffer_load_dwordx4 v[52:55], v205, s[8:11], s35 offen offset:1024
    buffer_load_dwordx4 v[56:59], v206, s[8:11], s35 offen offset:1024
    buffer_load_dwordx4 v[60:63], v207, s[8:11], s35 offen offset:1024
    s_add_u32 m0, s37, 8192
    s_add_u32 s32, s36, 131072
    buffer_load_dwordx4 v208, s[12:15], s32 offen lds
    s_add_u32 m0, s37, 9216
    s_add_u32 s32, s36, 147456
    buffer_load_dwordx4 v208, s[12:15], s32 offen lds
    s_add_u32 m0, s37, 10240
    s_add_u32 s32, s36, 163840
    buffer_load_dwordx4 v208, s[12:15], s32 offen lds
    s_add_u32 m0, s37, 11264
    s_add_u32 s32, s36, 180224
    buffer_load_dwordx4 v208, s[12:15], s32 offen lds
    buffer_load_dwordx4 v[64:67], v200, s[8:11], s35 offen offset:2048
    buffer_load_dwordx4 v[68:71], v201, s[8:11], s35 offen offset:2048
    buffer_load_dwordx4 v[72:75], v202, s[8:11], s35 offen offset:2048
    buffer_load_dwordx4 v[76:79], v203, s[8:11], s35 offen offset:2048
    buffer_load_dwordx4 v[80:83], v204, s[8:11], s35 offen offset:2048
    buffer_load_dwordx4 v[84:87], v205, s[8:11], s35 offen offset:2048
    buffer_load_dwordx4 v[88:91], v206, s[8:11], s35 offen offset:2048
    buffer_load_dwordx4 v[92:95], v207, s[8:11], s35 offen offset:2048
    s_add_u32 m0, s37, 12288
    s_add_u32 s32, s36, 196608
    buffer_load_dwordx4 v208, s[12:15], s32 offen lds
    s_add_u32 m0, s37, 13312
    s_add_u32 s32, s36, 212992
    buffer_load_dwordx4 v208, s[12:15], s32 offen lds
    s_add_u32 m0, s37, 14336
    s_add_u32 s32, s36, 229376
    buffer_load_dwordx4 v208, s[12:15], s32 offen lds
    s_add_u32 m0, s37, 15360
    s_add_u32 s32, s36, 245760
    buffer_load_dwordx4 v208, s[12:15], s32 offen lds
    buffer_load_dwordx4 v[96:99], v200, s[8:11], s35 offen offset:3072
    buffer_load_dwordx4 v[100:103], v201, s[8:11], s35 offen offset:3072
    buffer_load_dwordx4 v[104:107], v202, s[8:11], s35 offen offset:3072
    buffer_load_dwordx4 v[108:111], v203, s[8:11], s35 offen offset:3072
    buffer_load_dwordx4 v[112:115], v204, s[8:11], s35 offen offset:3072
    buffer_load_dwordx4 v[116:119], v205, s[8:11], s35 offen offset:3072
    buffer_load_dwordx4 v[120:123], v206, s[8:11], s35 offen offset:3072
    buffer_load_dwordx4 v[124:127], v207, s[8:11], s35 offen offset:3072
    s_add_u32 s35, s35, 4096
    s_add_u32 s36, s36, 262144
    v_bfe_u32 v224, v227, 2, 3
    v_lshrrev_b32 v225, 5, v227
    v_lshl_add_u32 v225, v225, 4, v224
    v_lshlrev_b32 v225, 7, v225
    v_add_u32 v225, s37, v225
    v_and_b32 v226, 1, v227
    v_lshl_add_u32 v225, v226, 3, v225
    v_and_b32 v224, 6, v224
    v_bfe_u32 v226, v227, 1, 1
    v_xor_b32 v224, v224, v226
    v_xor_b32 v226, 0, v224
    v_lshl_add_u32 v209, v226, 4, v225
    v_xor_b32 v226, 2, v224
    v_lshl_add_u32 v210, v226, 4, v225
    v_xor_b32 v226, 4, v224
    v_lshl_add_u32 v211, v226, 4, v225
    v_xor_b32 v226, 6, v224
    v_lshl_add_u32 v212, v226, 4, v225
    s_lshl_b32 s32, s4, 7
    s_lshl_b32 s33, s3, 5
    s_add_u32 s32, s32, s33
    v_and_b32 v224, 15, v227
    v_add_u32 v224, s32, v224
    v_lshrrev_b32 v225, 4, v227
    v_lshlrev_b32 v226, 3, v225
    s_lshl_b32 s33, s5, 7
    v_add_u32 v226, s33, v226
    v_lshl_add_u32 v214, v224, 11, v226
    s_mov_b32 s38, 32768
    buffer_load_dwordx2 v[160:161], v214, s[16:19], 0 offen offset:0
    buffer_load_dwordx2 v[162:163], v214, s[16:19], 0 offen offset:32
    buffer_load_dwordx2 v[164:165], v214, s[16:19], 0 offen offset:64
    buffer_load_dwordx2 v[166:167], v214, s[16:19], 0 offen offset:96
    buffer_load_dwordx2 v[168:169], v214, s[16:19], s38 offen offset:0
    buffer_load_dwordx2 v[170:171], v214, s[16:19], s38 offen offset:32
    buffer_load_dwordx2 v[172:173], v214, s[16:19], s38 offen offset:64
    buffer_load_dwordx2 v[174:175], v214, s[16:19], s38 offen offset:96
    buffer_load_dwordx2 v[176:177], v226, s[28:31], 0 offen offset:0
    buffer_load_dwordx2 v[178:179], v226, s[28:31], 0 offen offset:32
    buffer_load_dwordx2 v[180:181], v226, s[28:31], 0 offen offset:64
    buffer_load_dwordx2 v[182:183], v226, s[28:31], 0 offen offset:96
    v_and_b32 v226, 1, v225
    v_lshl_add_u32 v224, v226, 4, v224
    v_lshlrev_b32 v224, 2, v224
    v_lshrrev_b32 v225, 1, v225
    v_lshl_add_u32 v215, v225, 13, v224
    v_lshlrev_b32 v225, 20, v225
    v_add_u32 v225, 16384, v225
    v_add_u32 v216, v225, v224
    s_or_b32 s32, s4, s3
    s_cmp_eq_u32 s32, 0
    s_cselect_b32 s32, 32, 64
    v_cmp_eq_u32 vcc, s32, v227
    v_mov_b32 v225, 24576
    s_nop 0
    v_cndmask_b32 v216, v216, v225, vcc
    s_add_u32 s32, s3, 1
    s_and_b32 s32, s32, 3
    s_mul_i32 s32, s32, 24576
    s_add_u32 s32, s32, 0
    v_add_u32 v217, s32, v213
    s_add_u32 s32, s3, 2
    s_and_b32 s32, s32, 3
    s_mul_i32 s32, s32, 24576
    s_add_u32 s32, s32, 8192
    v_add_u32 v218, s32, v213
    s_add_u32 s32, s3, 3
    s_and_b32 s32, s32, 3
    s_mul_i32 s32, s32, 24576
    s_add_u32 s32, s32, 16384
    v_add_u32 v219, s32, v213
    s_mul_i32 s32, s3, 24576
    v_add_u32 v220, s32, v213
    v_accvgpr_write_b32 a0, 0
    v_accvgpr_write_b32 a1, 0
    v_accvgpr_write_b32 a2, 0
    v_accvgpr_write_b32 a3, 0
    v_accvgpr_write_b32 a4, 0
    v_accvgpr_write_b32 a5, 0
    v_accvgpr_write_b32 a6, 0
    v_accvgpr_write_b32 a7, 0
    v_accvgpr_write_b32 a8, 0
    v_accvgpr_write_b32 a9, 0
    v_accvgpr_write_b32 a10, 0
    v_accvgpr_write_b32 a11, 0
    v_accvgpr_write_b32 a12, 0
    v_accvgpr_write_b32 a13, 0
    v_accvgpr_write_b32 a14, 0
    v_accvgpr_write_b32 a15, 0
    v_accvgpr_write_b32 a16, 0
    v_accvgpr_write_b32 a17, 0
    v_accvgpr_write_b32 a18, 0
    v_accvgpr_write_b32 a19, 0
    v_accvgpr_write_b32 a20, 0
    v_accvgpr_write_b32 a21, 0
    v_accvgpr_write_b32 a22, 0
    v_accvgpr_write_b32 a23, 0
    v_accvgpr_write_b32 a24, 0
    v_accvgpr_write_b32 a25, 0
    v_accvgpr_write_b32 a26, 0
    v_accvgpr_write_b32 a27, 0
    v_accvgpr_write_b32 a28, 0
    v_accvgpr_write_b32 a29, 0
    v_accvgpr_write_b32 a30, 0
    v_accvgpr_write_b32 a31, 0
    v_accvgpr_write_b32 a32, 0
    v_accvgpr_write_b32 a33, 0
    v_accvgpr_write_b32 a34, 0
    v_accvgpr_write_b32 a35, 0
    v_accvgpr_write_b32 a36, 0
    v_accvgpr_write_b32 a37, 0
    v_accvgpr_write_b32 a38, 0
    v_accvgpr_write_b32 a39, 0
    v_accvgpr_write_b32 a40, 0
    v_accvgpr_write_b32 a41, 0
    v_accvgpr_write_b32 a42, 0
    v_accvgpr_write_b32 a43, 0
    v_accvgpr_write_b32 a44, 0
    v_accvgpr_write_b32 a45, 0
    v_accvgpr_write_b32 a46, 0
    v_accvgpr_write_b32 a47, 0
    v_accvgpr_write_b32 a48, 0
    v_accvgpr_write_b32 a49, 0
    v_accvgpr_write_b32 a50, 0
    v_accvgpr_write_b32 a51, 0
    v_accvgpr_write_b32 a52, 0
    v_accvgpr_write_b32 a53, 0
    v_accvgpr_write_b32 a54, 0
    v_accvgpr_write_b32 a55, 0
    v_accvgpr_write_b32 a56, 0
    v_accvgpr_write_b32 a57, 0
    v_accvgpr_write_b32 a58, 0
    v_accvgpr_write_b32 a59, 0
    v_accvgpr_write_b32 a60, 0
    v_accvgpr_write_b32 a61, 0
    v_accvgpr_write_b32 a62, 0
    v_accvgpr_write_b32 a63, 0
    v_accvgpr_write_b32 a64, 0
    v_accvgpr_write_b32 a65, 0
    v_accvgpr_write_b32 a66, 0
    v_accvgpr_write_b32 a67, 0
    v_accvgpr_write_b32 a68, 0
    v_accvgpr_write_b32 a69, 0
    v_accvgpr_write_b32 a70, 0
    v_accvgpr_write_b32 a71, 0
    v_accvgpr_write_b32 a72, 0
    v_accvgpr_write_b32 a73, 0
    v_accvgpr_write_b32 a74, 0
    v_accvgpr_write_b32 a75, 0
    v_accvgpr_write_b32 a76, 0
    v_accvgpr_write_b32 a77, 0
    v_accvgpr_write_b32 a78, 0
    v_accvgpr_write_b32 a79, 0
    v_accvgpr_write_b32 a80, 0
    v_accvgpr_write_b32 a81, 0
    v_accvgpr_write_b32 a82, 0
    v_accvgpr_write_b32 a83, 0
    v_accvgpr_write_b32 a84, 0
    v_accvgpr_write_b32 a85, 0
    v_accvgpr_write_b32 a86, 0
    v_accvgpr_write_b32 a87, 0
    v_accvgpr_write_b32 a88, 0
    v_accvgpr_write_b32 a89, 0
    v_accvgpr_write_b32 a90, 0
    v_accvgpr_write_b32 a91, 0
    v_accvgpr_write_b32 a92, 0
    v_accvgpr_write_b32 a93, 0
    v_accvgpr_write_b32 a94, 0
    v_accvgpr_write_b32 a95, 0
    v_accvgpr_write_b32 a96, 0
    v_accvgpr_write_b32 a97, 0
    v_accvgpr_write_b32 a98, 0
    v_accvgpr_write_b32 a99, 0
    v_accvgpr_write_b32 a100, 0
    v_accvgpr_write_b32 a101, 0
    v_accvgpr_write_b32 a102, 0
    v_accvgpr_write_b32 a103, 0
    v_accvgpr_write_b32 a104, 0
    v_accvgpr_write_b32 a105, 0
    v_accvgpr_write_b32 a106, 0
    v_accvgpr_write_b32 a107, 0
    v_accvgpr_write_b32 a108, 0
    v_accvgpr_write_b32 a109, 0
    v_accvgpr_write_b32 a110, 0
    v_accvgpr_write_b32 a111, 0
    v_accvgpr_write_b32 a112, 0
    v_accvgpr_write_b32 a113, 0
    v_accvgpr_write_b32 a114, 0
    v_accvgpr_write_b32 a115, 0
    v_accvgpr_write_b32 a116, 0
    v_accvgpr_write_b32 a117, 0
    v_accvgpr_write_b32 a118, 0
    v_accvgpr_write_b32 a119, 0
    v_accvgpr_write_b32 a120, 0
    v_accvgpr_write_b32 a121, 0
    v_accvgpr_write_b32 a122, 0
    v_accvgpr_write_b32 a123, 0
    v_accvgpr_write_b32 a124, 0
    v_accvgpr_write_b32 a125, 0
    v_accvgpr_write_b32 a126, 0
    v_accvgpr_write_b32 a127, 0
    s_waitcnt vmcnt(56)
    ds_read_b64_tr_b16 v[128:129], v209 offset:0
    ds_read_b64_tr_b16 v[130:131], v209 offset:1024
    ds_read_b64_tr_b16 v[132:133], v210 offset:0
    ds_read_b64_tr_b16 v[134:135], v210 offset:1024
    ds_read_b64_tr_b16 v[136:137], v211 offset:0
    ds_read_b64_tr_b16 v[138:139], v211 offset:1024
    ds_read_b64_tr_b16 v[140:141], v212 offset:0
    ds_read_b64_tr_b16 v[142:143], v212 offset:1024
    s_mov_b32 s34, 8
.p2align 3
k3_loop:
    s_waitcnt vmcnt(32) lgkmcnt(0)
    v_mfma_f32_16x16x32_bf16 a[0:3], v[128:131], v[0:3], a[0:3]
    s_add_u32 m0, s37, 0
    s_add_u32 s32, s36, 0
    buffer_load_dwordx4 v208, s[12:15], s32 offen lds
    v_mfma_f32_16x16x32_bf16 a[4:7], v[132:135], v[0:3], a[4:7]
    s_add_u32 m0, s37, 1024
    s_add_u32 s32, s36, 16384
    buffer_load_dwordx4 v208, s[12:15], s32 offen lds
    v_mfma_f32_16x16x32_bf16 a[8:11], v[136:139], v[0:3], a[8:11]
    s_add_u32 m0, s37, 2048
    s_add_u32 s32, s36, 32768
    buffer_load_dwordx4 v208, s[12:15], s32 offen lds
    v_mfma_f32_16x16x32_bf16 a[12:15], v[140:143], v[0:3], a[12:15]
    s_add_u32 m0, s37, 3072
    s_add_u32 s32, s36, 49152
    buffer_load_dwordx4 v208, s[12:15], s32 offen lds
    v_mfma_f32_16x16x32_bf16 a[16:19], v[128:131], v[4:7], a[16:19]
    ds_read_b64_tr_b16 v[144:145], v209 offset:4096
    buffer_load_dwordx4 v[0:3], v200, s[8:11], s35 offen offset:0
    v_mfma_f32_16x16x32_bf16 a[20:23], v[132:135], v[4:7], a[20:23]
    ds_read_b64_tr_b16 v[146:147], v209 offset:5120
    v_mfma_f32_16x16x32_bf16 a[24:27], v[136:139], v[4:7], a[24:27]
    ds_read_b64_tr_b16 v[148:149], v210 offset:4096
    v_mfma_f32_16x16x32_bf16 a[28:31], v[140:143], v[4:7], a[28:31]
    ds_read_b64_tr_b16 v[150:151], v210 offset:5120
    v_mfma_f32_16x16x32_bf16 a[32:35], v[128:131], v[8:11], a[32:35]
    ds_read_b64_tr_b16 v[152:153], v211 offset:4096
    buffer_load_dwordx4 v[4:7], v201, s[8:11], s35 offen offset:0
    v_mfma_f32_16x16x32_bf16 a[36:39], v[132:135], v[8:11], a[36:39]
    ds_read_b64_tr_b16 v[154:155], v211 offset:5120
    v_mfma_f32_16x16x32_bf16 a[40:43], v[136:139], v[8:11], a[40:43]
    ds_read_b64_tr_b16 v[156:157], v212 offset:4096
    v_mfma_f32_16x16x32_bf16 a[44:47], v[140:143], v[8:11], a[44:47]
    ds_read_b64_tr_b16 v[158:159], v212 offset:5120
    v_mfma_f32_16x16x32_bf16 a[48:51], v[128:131], v[12:15], a[48:51]
    buffer_load_dwordx4 v[8:11], v202, s[8:11], s35 offen offset:0
    v_mfma_f32_16x16x32_bf16 a[52:55], v[132:135], v[12:15], a[52:55]
    v_mfma_f32_16x16x32_bf16 a[56:59], v[136:139], v[12:15], a[56:59]
    v_mfma_f32_16x16x32_bf16 a[60:63], v[140:143], v[12:15], a[60:63]
    v_mfma_f32_16x16x32_bf16 a[64:67], v[128:131], v[16:19], a[64:67]
    buffer_load_dwordx4 v[12:15], v203, s[8:11], s35 offen offset:0
    v_mfma_f32_16x16x32_bf16 a[68:71], v[132:135], v[16:19], a[68:71]
    v_mfma_f32_16x16x32_bf16 a[72:75], v[136:139], v[16:19], a[72:75]
    v_mfma_f32_16x16x32_bf16 a[76:79], v[140:143], v[16:19], a[76:79]
    v_mfma_f32_16x16x32_bf16 a[80:83], v[128:131], v[20:23], a[80:83]
    buffer_load_dwordx4 v[16:19], v204, s[8:11], s35 offen offset:0
    v_mfma_f32_16x16x32_bf16 a[84:87], v[132:135], v[20:23], a[84:87]
    v_mfma_f32_16x16x32_bf16 a[88:91], v[136:139], v[20:23], a[88:91]
    v_mfma_f32_16x16x32_bf16 a[92:95], v[140:143], v[20:23], a[92:95]
    v_mfma_f32_16x16x32_bf16 a[96:99], v[128:131], v[24:27], a[96:99]
    buffer_load_dwordx4 v[20:23], v205, s[8:11], s35 offen offset:0
    v_mfma_f32_16x16x32_bf16 a[100:103], v[132:135], v[24:27], a[100:103]
    v_mfma_f32_16x16x32_bf16 a[104:107], v[136:139], v[24:27], a[104:107]
    v_mfma_f32_16x16x32_bf16 a[108:111], v[140:143], v[24:27], a[108:111]
    v_mfma_f32_16x16x32_bf16 a[112:115], v[128:131], v[28:31], a[112:115]
    buffer_load_dwordx4 v[24:27], v206, s[8:11], s35 offen offset:0
    v_mfma_f32_16x16x32_bf16 a[116:119], v[132:135], v[28:31], a[116:119]
    v_mfma_f32_16x16x32_bf16 a[120:123], v[136:139], v[28:31], a[120:123]
    v_mfma_f32_16x16x32_bf16 a[124:127], v[140:143], v[28:31], a[124:127]
    buffer_load_dwordx4 v[28:31], v207, s[8:11], s35 offen offset:0
    s_waitcnt vmcnt(32) lgkmcnt(0)
    v_mfma_f32_16x16x32_bf16 a[0:3], v[144:147], v[32:35], a[0:3]
    s_add_u32 m0, s37, 4096
    s_add_u32 s32, s36, 65536
    buffer_load_dwordx4 v208, s[12:15], s32 offen lds
    v_mfma_f32_16x16x32_bf16 a[4:7], v[148:151], v[32:35], a[4:7]
    s_add_u32 m0, s37, 5120
    s_add_u32 s32, s36, 81920
    buffer_load_dwordx4 v208, s[12:15], s32 offen lds
    v_mfma_f32_16x16x32_bf16 a[8:11], v[152:155], v[32:35], a[8:11]
    s_add_u32 m0, s37, 6144
    s_add_u32 s32, s36, 98304
    buffer_load_dwordx4 v208, s[12:15], s32 offen lds
    v_mfma_f32_16x16x32_bf16 a[12:15], v[156:159], v[32:35], a[12:15]
    s_add_u32 m0, s37, 7168
    s_add_u32 s32, s36, 114688
    buffer_load_dwordx4 v208, s[12:15], s32 offen lds
    v_mfma_f32_16x16x32_bf16 a[16:19], v[144:147], v[36:39], a[16:19]
    ds_read_b64_tr_b16 v[128:129], v209 offset:8192
    buffer_load_dwordx4 v[32:35], v200, s[8:11], s35 offen offset:1024
    v_mfma_f32_16x16x32_bf16 a[20:23], v[148:151], v[36:39], a[20:23]
    ds_read_b64_tr_b16 v[130:131], v209 offset:9216
    v_mfma_f32_16x16x32_bf16 a[24:27], v[152:155], v[36:39], a[24:27]
    ds_read_b64_tr_b16 v[132:133], v210 offset:8192
    v_mfma_f32_16x16x32_bf16 a[28:31], v[156:159], v[36:39], a[28:31]
    ds_read_b64_tr_b16 v[134:135], v210 offset:9216
    v_mfma_f32_16x16x32_bf16 a[32:35], v[144:147], v[40:43], a[32:35]
    ds_read_b64_tr_b16 v[136:137], v211 offset:8192
    buffer_load_dwordx4 v[36:39], v201, s[8:11], s35 offen offset:1024
    v_mfma_f32_16x16x32_bf16 a[36:39], v[148:151], v[40:43], a[36:39]
    ds_read_b64_tr_b16 v[138:139], v211 offset:9216
    v_mfma_f32_16x16x32_bf16 a[40:43], v[152:155], v[40:43], a[40:43]
    ds_read_b64_tr_b16 v[140:141], v212 offset:8192
    v_mfma_f32_16x16x32_bf16 a[44:47], v[156:159], v[40:43], a[44:47]
    ds_read_b64_tr_b16 v[142:143], v212 offset:9216
    v_mfma_f32_16x16x32_bf16 a[48:51], v[144:147], v[44:47], a[48:51]
    buffer_load_dwordx4 v[40:43], v202, s[8:11], s35 offen offset:1024
    v_mfma_f32_16x16x32_bf16 a[52:55], v[148:151], v[44:47], a[52:55]
    v_mfma_f32_16x16x32_bf16 a[56:59], v[152:155], v[44:47], a[56:59]
    v_mfma_f32_16x16x32_bf16 a[60:63], v[156:159], v[44:47], a[60:63]
    v_mfma_f32_16x16x32_bf16 a[64:67], v[144:147], v[48:51], a[64:67]
    buffer_load_dwordx4 v[44:47], v203, s[8:11], s35 offen offset:1024
    v_mfma_f32_16x16x32_bf16 a[68:71], v[148:151], v[48:51], a[68:71]
    v_mfma_f32_16x16x32_bf16 a[72:75], v[152:155], v[48:51], a[72:75]
    v_mfma_f32_16x16x32_bf16 a[76:79], v[156:159], v[48:51], a[76:79]
    v_mfma_f32_16x16x32_bf16 a[80:83], v[144:147], v[52:55], a[80:83]
    buffer_load_dwordx4 v[48:51], v204, s[8:11], s35 offen offset:1024
    v_mfma_f32_16x16x32_bf16 a[84:87], v[148:151], v[52:55], a[84:87]
    v_mfma_f32_16x16x32_bf16 a[88:91], v[152:155], v[52:55], a[88:91]
    v_mfma_f32_16x16x32_bf16 a[92:95], v[156:159], v[52:55], a[92:95]
    v_mfma_f32_16x16x32_bf16 a[96:99], v[144:147], v[56:59], a[96:99]
    buffer_load_dwordx4 v[52:55], v205, s[8:11], s35 offen offset:1024
    v_mfma_f32_16x16x32_bf16 a[100:103], v[148:151], v[56:59], a[100:103]
    v_mfma_f32_16x16x32_bf16 a[104:107], v[152:155], v[56:59], a[104:107]
    v_mfma_f32_16x16x32_bf16 a[108:111], v[156:159], v[56:59], a[108:111]
    v_mfma_f32_16x16x32_bf16 a[112:115], v[144:147], v[60:63], a[112:115]
    buffer_load_dwordx4 v[56:59], v206, s[8:11], s35 offen offset:1024
    v_mfma_f32_16x16x32_bf16 a[116:119], v[148:151], v[60:63], a[116:119]
    v_mfma_f32_16x16x32_bf16 a[120:123], v[152:155], v[60:63], a[120:123]
    v_mfma_f32_16x16x32_bf16 a[124:127], v[156:159], v[60:63], a[124:127]
    buffer_load_dwordx4 v[60:63], v207, s[8:11], s35 offen offset:1024
    s_waitcnt vmcnt(32) lgkmcnt(0)
    v_mfma_f32_16x16x32_bf16 a[0:3], v[128:131], v[64:67], a[0:3]
    s_add_u32 m0, s37, 8192
    s_add_u32 s32, s36, 131072
    buffer_load_dwordx4 v208, s[12:15], s32 offen lds
    v_mfma_f32_16x16x32_bf16 a[4:7], v[132:135], v[64:67], a[4:7]
    s_add_u32 m0, s37, 9216
    s_add_u32 s32, s36, 147456
    buffer_load_dwordx4 v208, s[12:15], s32 offen lds
    v_mfma_f32_16x16x32_bf16 a[8:11], v[136:139], v[64:67], a[8:11]
    s_add_u32 m0, s37, 10240
    s_add_u32 s32, s36, 163840
    buffer_load_dwordx4 v208, s[12:15], s32 offen lds
    v_mfma_f32_16x16x32_bf16 a[12:15], v[140:143], v[64:67], a[12:15]
    s_add_u32 m0, s37, 11264
    s_add_u32 s32, s36, 180224
    buffer_load_dwordx4 v208, s[12:15], s32 offen lds
    v_mfma_f32_16x16x32_bf16 a[16:19], v[128:131], v[68:71], a[16:19]
    ds_read_b64_tr_b16 v[144:145], v209 offset:12288
    buffer_load_dwordx4 v[64:67], v200, s[8:11], s35 offen offset:2048
    v_mfma_f32_16x16x32_bf16 a[20:23], v[132:135], v[68:71], a[20:23]
    ds_read_b64_tr_b16 v[146:147], v209 offset:13312
    v_mfma_f32_16x16x32_bf16 a[24:27], v[136:139], v[68:71], a[24:27]
    ds_read_b64_tr_b16 v[148:149], v210 offset:12288
    v_mfma_f32_16x16x32_bf16 a[28:31], v[140:143], v[68:71], a[28:31]
    ds_read_b64_tr_b16 v[150:151], v210 offset:13312
    v_mfma_f32_16x16x32_bf16 a[32:35], v[128:131], v[72:75], a[32:35]
    ds_read_b64_tr_b16 v[152:153], v211 offset:12288
    buffer_load_dwordx4 v[68:71], v201, s[8:11], s35 offen offset:2048
    v_mfma_f32_16x16x32_bf16 a[36:39], v[132:135], v[72:75], a[36:39]
    ds_read_b64_tr_b16 v[154:155], v211 offset:13312
    v_mfma_f32_16x16x32_bf16 a[40:43], v[136:139], v[72:75], a[40:43]
    ds_read_b64_tr_b16 v[156:157], v212 offset:12288
    v_mfma_f32_16x16x32_bf16 a[44:47], v[140:143], v[72:75], a[44:47]
    ds_read_b64_tr_b16 v[158:159], v212 offset:13312
    v_mfma_f32_16x16x32_bf16 a[48:51], v[128:131], v[76:79], a[48:51]
    buffer_load_dwordx4 v[72:75], v202, s[8:11], s35 offen offset:2048
    v_mfma_f32_16x16x32_bf16 a[52:55], v[132:135], v[76:79], a[52:55]
    v_mfma_f32_16x16x32_bf16 a[56:59], v[136:139], v[76:79], a[56:59]
    v_mfma_f32_16x16x32_bf16 a[60:63], v[140:143], v[76:79], a[60:63]
    v_mfma_f32_16x16x32_bf16 a[64:67], v[128:131], v[80:83], a[64:67]
    buffer_load_dwordx4 v[76:79], v203, s[8:11], s35 offen offset:2048
    v_mfma_f32_16x16x32_bf16 a[68:71], v[132:135], v[80:83], a[68:71]
    v_mfma_f32_16x16x32_bf16 a[72:75], v[136:139], v[80:83], a[72:75]
    v_mfma_f32_16x16x32_bf16 a[76:79], v[140:143], v[80:83], a[76:79]
    v_mfma_f32_16x16x32_bf16 a[80:83], v[128:131], v[84:87], a[80:83]
    buffer_load_dwordx4 v[80:83], v204, s[8:11], s35 offen offset:2048
    v_mfma_f32_16x16x32_bf16 a[84:87], v[132:135], v[84:87], a[84:87]
    v_mfma_f32_16x16x32_bf16 a[88:91], v[136:139], v[84:87], a[88:91]
    v_mfma_f32_16x16x32_bf16 a[92:95], v[140:143], v[84:87], a[92:95]
    v_mfma_f32_16x16x32_bf16 a[96:99], v[128:131], v[88:91], a[96:99]
    buffer_load_dwordx4 v[84:87], v205, s[8:11], s35 offen offset:2048
    v_mfma_f32_16x16x32_bf16 a[100:103], v[132:135], v[88:91], a[100:103]
    v_mfma_f32_16x16x32_bf16 a[104:107], v[136:139], v[88:91], a[104:107]
    v_mfma_f32_16x16x32_bf16 a[108:111], v[140:143], v[88:91], a[108:111]
    v_mfma_f32_16x16x32_bf16 a[112:115], v[128:131], v[92:95], a[112:115]
    buffer_load_dwordx4 v[88:91], v206, s[8:11], s35 offen offset:2048
    v_mfma_f32_16x16x32_bf16 a[116:119], v[132:135], v[92:95], a[116:119]
    v_mfma_f32_16x16x32_bf16 a[120:123], v[136:139], v[92:95], a[120:123]
    v_mfma_f32_16x16x32_bf16 a[124:127], v[140:143], v[92:95], a[124:127]
    buffer_load_dwordx4 v[92:95], v207, s[8:11], s35 offen offset:2048
    s_waitcnt vmcnt(32) lgkmcnt(0)
    v_mfma_f32_16x16x32_bf16 a[0:3], v[144:147], v[96:99], a[0:3]
    s_add_u32 m0, s37, 12288
    s_add_u32 s32, s36, 196608
    buffer_load_dwordx4 v208, s[12:15], s32 offen lds
    v_mfma_f32_16x16x32_bf16 a[4:7], v[148:151], v[96:99], a[4:7]
    s_add_u32 m0, s37, 13312
    s_add_u32 s32, s36, 212992
    buffer_load_dwordx4 v208, s[12:15], s32 offen lds
    v_mfma_f32_16x16x32_bf16 a[8:11], v[152:155], v[96:99], a[8:11]
    s_add_u32 m0, s37, 14336
    s_add_u32 s32, s36, 229376
    buffer_load_dwordx4 v208, s[12:15], s32 offen lds
    v_mfma_f32_16x16x32_bf16 a[12:15], v[156:159], v[96:99], a[12:15]
    s_add_u32 m0, s37, 15360
    s_add_u32 s32, s36, 245760
    buffer_load_dwordx4 v208, s[12:15], s32 offen lds
    v_mfma_f32_16x16x32_bf16 a[16:19], v[144:147], v[100:103], a[16:19]
    ds_read_b64_tr_b16 v[128:129], v209 offset:0
    buffer_load_dwordx4 v[96:99], v200, s[8:11], s35 offen offset:3072
    v_mfma_f32_16x16x32_bf16 a[20:23], v[148:151], v[100:103], a[20:23]
    ds_read_b64_tr_b16 v[130:131], v209 offset:1024
    v_mfma_f32_16x16x32_bf16 a[24:27], v[152:155], v[100:103], a[24:27]
    ds_read_b64_tr_b16 v[132:133], v210 offset:0
    v_mfma_f32_16x16x32_bf16 a[28:31], v[156:159], v[100:103], a[28:31]
    ds_read_b64_tr_b16 v[134:135], v210 offset:1024
    v_mfma_f32_16x16x32_bf16 a[32:35], v[144:147], v[104:107], a[32:35]
    ds_read_b64_tr_b16 v[136:137], v211 offset:0
    buffer_load_dwordx4 v[100:103], v201, s[8:11], s35 offen offset:3072
    v_mfma_f32_16x16x32_bf16 a[36:39], v[148:151], v[104:107], a[36:39]
    ds_read_b64_tr_b16 v[138:139], v211 offset:1024
    v_mfma_f32_16x16x32_bf16 a[40:43], v[152:155], v[104:107], a[40:43]
    ds_read_b64_tr_b16 v[140:141], v212 offset:0
    v_mfma_f32_16x16x32_bf16 a[44:47], v[156:159], v[104:107], a[44:47]
    ds_read_b64_tr_b16 v[142:143], v212 offset:1024
    v_mfma_f32_16x16x32_bf16 a[48:51], v[144:147], v[108:111], a[48:51]
    buffer_load_dwordx4 v[104:107], v202, s[8:11], s35 offen offset:3072
    v_mfma_f32_16x16x32_bf16 a[52:55], v[148:151], v[108:111], a[52:55]
    v_mfma_f32_16x16x32_bf16 a[56:59], v[152:155], v[108:111], a[56:59]
    v_mfma_f32_16x16x32_bf16 a[60:63], v[156:159], v[108:111], a[60:63]
    v_mfma_f32_16x16x32_bf16 a[64:67], v[144:147], v[112:115], a[64:67]
    buffer_load_dwordx4 v[108:111], v203, s[8:11], s35 offen offset:3072
    v_mfma_f32_16x16x32_bf16 a[68:71], v[148:151], v[112:115], a[68:71]
    v_mfma_f32_16x16x32_bf16 a[72:75], v[152:155], v[112:115], a[72:75]
    v_mfma_f32_16x16x32_bf16 a[76:79], v[156:159], v[112:115], a[76:79]
    v_mfma_f32_16x16x32_bf16 a[80:83], v[144:147], v[116:119], a[80:83]
    buffer_load_dwordx4 v[112:115], v204, s[8:11], s35 offen offset:3072
    v_mfma_f32_16x16x32_bf16 a[84:87], v[148:151], v[116:119], a[84:87]
    v_mfma_f32_16x16x32_bf16 a[88:91], v[152:155], v[116:119], a[88:91]
    v_mfma_f32_16x16x32_bf16 a[92:95], v[156:159], v[116:119], a[92:95]
    v_mfma_f32_16x16x32_bf16 a[96:99], v[144:147], v[120:123], a[96:99]
    buffer_load_dwordx4 v[116:119], v205, s[8:11], s35 offen offset:3072
    v_mfma_f32_16x16x32_bf16 a[100:103], v[148:151], v[120:123], a[100:103]
    v_mfma_f32_16x16x32_bf16 a[104:107], v[152:155], v[120:123], a[104:107]
    v_mfma_f32_16x16x32_bf16 a[108:111], v[156:159], v[120:123], a[108:111]
    v_mfma_f32_16x16x32_bf16 a[112:115], v[144:147], v[124:127], a[112:115]
    buffer_load_dwordx4 v[120:123], v206, s[8:11], s35 offen offset:3072
    v_mfma_f32_16x16x32_bf16 a[116:119], v[148:151], v[124:127], a[116:119]
    v_mfma_f32_16x16x32_bf16 a[120:123], v[152:155], v[124:127], a[120:123]
    v_mfma_f32_16x16x32_bf16 a[124:127], v[156:159], v[124:127], a[124:127]
    buffer_load_dwordx4 v[124:127], v207, s[8:11], s35 offen offset:3072
    s_add_u32 s35, s35, 4096
    s_add_u32 s36, s36, 262144
    s_cmp_eq_u32 s34, 2
    s_cselect_b32 s35, 0x40000000, s35
    s_cselect_b32 s36, 0x40000000, s36
    s_sub_u32 s34, s34, 1
    s_cmp_lg_u32 s34, 0
    s_cbranch_scc1 k3_loop
    s_waitcnt vmcnt(0) lgkmcnt(0)
    s_barrier
    s_nop 4
    ds_write_b128 v217, a[32:35] offset:0
    ds_write_b128 v217, a[36:39] offset:1024
    ds_write_b128 v217, a[40:43] offset:2048
    ds_write_b128 v217, a[44:47] offset:3072
    ds_write_b128 v217, a[48:51] offset:4096
    ds_write_b128 v217, a[52:55] offset:5120
    ds_write_b128 v217, a[56:59] offset:6144
    ds_write_b128 v217, a[60:63] offset:7168
    ds_write_b128 v218, a[64:67] offset:0
    ds_write_b128 v218, a[68:71] offset:1024
    ds_write_b128 v218, a[72:75] offset:2048
    ds_write_b128 v218, a[76:79] offset:3072
    ds_write_b128 v218, a[80:83] offset:4096
    ds_write_b128 v218, a[84:87] offset:5120
    ds_write_b128 v218, a[88:91] offset:6144
    ds_write_b128 v218, a[92:95] offset:7168
    ds_write_b128 v219, a[96:99] offset:0
    ds_write_b128 v219, a[100:103] offset:1024
    ds_write_b128 v219, a[104:107] offset:2048
    ds_write_b128 v219, a[108:111] offset:3072
    ds_write_b128 v219, a[112:115] offset:4096
    ds_write_b128 v219, a[116:119] offset:5120
    ds_write_b128 v219, a[120:123] offset:6144
    ds_write_b128 v219, a[124:127] offset:7168
    v_accvgpr_read_b32 v96, a0
    v_accvgpr_read_b32 v97, a1
    v_accvgpr_read_b32 v98, a2
    v_accvgpr_read_b32 v99, a3
    v_accvgpr_read_b32 v100, a4
    v_accvgpr_read_b32 v101, a5
    v_accvgpr_read_b32 v102, a6
    v_accvgpr_read_b32 v103, a7
    v_accvgpr_read_b32 v104, a8
    v_accvgpr_read_b32 v105, a9
    v_accvgpr_read_b32 v106, a10
    v_accvgpr_read_b32 v107, a11
    v_accvgpr_read_b32 v108, a12
    v_accvgpr_read_b32 v109, a13
    v_accvgpr_read_b32 v110, a14
    v_accvgpr_read_b32 v111, a15
    v_accvgpr_read_b32 v112, a16
    v_accvgpr_read_b32 v113, a17
    v_accvgpr_read_b32 v114, a18
    v_accvgpr_read_b32 v115, a19
    v_accvgpr_read_b32 v116, a20
    v_accvgpr_read_b32 v117, a21
    v_accvgpr_read_b32 v118, a22
    v_accvgpr_read_b32 v119, a23
    v_accvgpr_read_b32 v120, a24
    v_accvgpr_read_b32 v121, a25
    v_accvgpr_read_b32 v122, a26
    v_accvgpr_read_b32 v123, a27
    v_accvgpr_read_b32 v124, a28
    v_accvgpr_read_b32 v125, a29
    v_accvgpr_read_b32 v126, a30
    v_accvgpr_read_b32 v127, a31
    v_lshlrev_b32 v128, 16, v160
    v_and_b32 v129, 0xffff0000, v160
    v_lshlrev_b32 v130, 16, v161
    v_and_b32 v131, 0xffff0000, v161
    v_lshlrev_b32 v132, 16, v162
    v_and_b32 v133, 0xffff0000, v162
    v_lshlrev_b32 v134, 16, v163
    v_and_b32 v135, 0xffff0000, v163
    v_lshlrev_b32 v136, 16, v164
    v_and_b32 v137, 0xffff0000, v164
    v_lshlrev_b32 v138, 16, v165
    v_and_b32 v139, 0xffff0000, v165
    v_lshlrev_b32 v140, 16, v166
    v_and_b32 v141, 0xffff0000, v166
    v_lshlrev_b32 v142, 16, v167
    v_and_b32 v143, 0xffff0000, v167
    v_lshlrev_b32 v144, 16, v168
    v_and_b32 v145, 0xffff0000, v168
    v_lshlrev_b32 v146, 16, v169
    v_and_b32 v147, 0xffff0000, v169
    v_lshlrev_b32 v148, 16, v170
    v_and_b32 v149, 0xffff0000, v170
    v_lshlrev_b32 v150, 16, v171
    v_and_b32 v151, 0xffff0000, v171
    v_lshlrev_b32 v152, 16, v172
    v_and_b32 v153, 0xffff0000, v172
    v_lshlrev_b32 v154, 16, v173
    v_and_b32 v155, 0xffff0000, v173
    v_lshlrev_b32 v156, 16, v174
    v_and_b32 v157, 0xffff0000, v174
    v_lshlrev_b32 v158, 16, v175
    v_and_b32 v159, 0xffff0000, v175
    v_lshlrev_b32 v184, 16, v176
    v_and_b32 v185, 0xffff0000, v176
    v_lshlrev_b32 v186, 16, v177
    v_and_b32 v187, 0xffff0000, v177
    v_lshlrev_b32 v188, 16, v178
    v_and_b32 v189, 0xffff0000, v178
    v_lshlrev_b32 v190, 16, v179
    v_and_b32 v191, 0xffff0000, v179
    v_lshlrev_b32 v192, 16, v180
    v_and_b32 v193, 0xffff0000, v180
    v_lshlrev_b32 v194, 16, v181
    v_and_b32 v195, 0xffff0000, v181
    v_lshlrev_b32 v196, 16, v182
    v_and_b32 v197, 0xffff0000, v182
    v_lshlrev_b32 v198, 16, v183
    v_and_b32 v199, 0xffff0000, v183
    s_waitcnt lgkmcnt(0)
    s_barrier
    ds_read_b128 v[0:3], v220 offset:0
    ds_read_b128 v[4:7], v220 offset:1024
    ds_read_b128 v[8:11], v220 offset:2048
    ds_read_b128 v[12:15], v220 offset:3072
    ds_read_b128 v[16:19], v220 offset:4096
    ds_read_b128 v[20:23], v220 offset:5120
    ds_read_b128 v[24:27], v220 offset:6144
    ds_read_b128 v[28:31], v220 offset:7168
    ds_read_b128 v[32:35], v220 offset:8192
    ds_read_b128 v[36:39], v220 offset:9216
    ds_read_b128 v[40:43], v220 offset:10240
    ds_read_b128 v[44:47], v220 offset:11264
    ds_read_b128 v[48:51], v220 offset:12288
    s_waitcnt lgkmcnt(12)
    v_add_f32 v96, v96, v0
    v_add_f32 v97, v97, v1
    v_add_f32 v98, v98, v2
    v_add_f32 v99, v99, v3
    ds_read_b128 v[52:55], v220 offset:13312
    s_waitcnt lgkmcnt(12)
    v_add_f32 v100, v100, v4
    v_add_f32 v101, v101, v5
    v_add_f32 v102, v102, v6
    v_add_f32 v103, v103, v7
    ds_read_b128 v[56:59], v220 offset:14336
    s_waitcnt lgkmcnt(12)
    v_add_f32 v104, v104, v8
    v_add_f32 v105, v105, v9
    v_add_f32 v106, v106, v10
    v_add_f32 v107, v107, v11
    ds_read_b128 v[60:63], v220 offset:15360
    s_waitcnt lgkmcnt(12)
    v_add_f32 v108, v108, v12
    v_add_f32 v109, v109, v13
    v_add_f32 v110, v110, v14
    v_add_f32 v111, v111, v15
    ds_read_b128 v[64:67], v220 offset:16384
    s_waitcnt lgkmcnt(12)
    v_add_f32 v112, v112, v16
    v_add_f32 v113, v113, v17
    v_add_f32 v114, v114, v18
    v_add_f32 v115, v115, v19
    ds_read_b128 v[68:71], v220 offset:17408
    s_waitcnt lgkmcnt(12)
    v_add_f32 v116, v116, v20
    v_add_f32 v117, v117, v21
    v_add_f32 v118, v118, v22
    v_add_f32 v119, v119, v23
    ds_read_b128 v[72:75], v220 offset:18432
    s_waitcnt lgkmcnt(12)
    v_add_f32 v120, v120, v24
    v_add_f32 v121, v121, v25
    v_add_f32 v122, v122, v26
    v_add_f32 v123, v123, v27
    ds_read_b128 v[76:79], v220 offset:19456
    s_waitcnt lgkmcnt(12)
    v_add_f32 v124, v124, v28
    v_add_f32 v125, v125, v29
    v_add_f32 v126, v126, v30
    v_add_f32 v127, v127, v31
    ds_read_b128 v[80:83], v220 offset:20480
    s_waitcnt lgkmcnt(12)
    v_add_f32 v96, v96, v32
    v_add_f32 v97, v97, v33
    v_add_f32 v98, v98, v34
    v_add_f32 v99, v99, v35
    ds_read_b128 v[84:87], v220 offset:21504
    s_waitcnt lgkmcnt(12)
    v_add_f32 v100, v100, v36
    v_add_f32 v101, v101, v37
    v_add_f32 v102, v102, v38
    v_add_f32 v103, v103, v39
    ds_read_b128 v[88:91], v220 offset:22528
    s_waitcnt lgkmcnt(12)
    v_add_f32 v104, v104, v40
    v_add_f32 v105, v105, v41
    v_add_f32 v106, v106, v42
    v_add_f32 v107, v107, v43
    ds_read_b128 v[92:95], v220 offset:23552
    s_waitcnt lgkmcnt(12)
    v_add_f32 v108, v108, v44
    v_add_f32 v109, v109, v45
    v_add_f32 v110, v110, v46
    v_add_f32 v111, v111, v47
    s_waitcnt lgkmcnt(11)
    v_add_f32 v112, v112, v48
    v_add_f32 v113, v113, v49
    v_add_f32 v114, v114, v50
    v_add_f32 v115, v115, v51
    s_waitcnt lgkmcnt(10)
    v_add_f32 v116, v116, v52
    v_add_f32 v117, v117, v53
    v_add_f32 v118, v118, v54
    v_add_f32 v119, v119, v55
    s_waitcnt lgkmcnt(9)
    v_add_f32 v120, v120, v56
    v_add_f32 v121, v121, v57
    v_add_f32 v122, v122, v58
    v_add_f32 v123, v123, v59
    s_waitcnt lgkmcnt(8)
    v_add_f32 v124, v124, v60
    v_add_f32 v125, v125, v61
    v_add_f32 v126, v126, v62
    v_add_f32 v127, v127, v63
    s_waitcnt lgkmcnt(7)
    v_add_f32 v96, v96, v64
    v_add_f32 v97, v97, v65
    v_add_f32 v98, v98, v66
    v_add_f32 v99, v99, v67
    s_waitcnt lgkmcnt(6)
    v_add_f32 v100, v100, v68
    v_add_f32 v101, v101, v69
    v_add_f32 v102, v102, v70
    v_add_f32 v103, v103, v71
    s_waitcnt lgkmcnt(5)
    v_add_f32 v104, v104, v72
    v_add_f32 v105, v105, v73
    v_add_f32 v106, v106, v74
    v_add_f32 v107, v107, v75
    s_waitcnt lgkmcnt(4)
    v_add_f32 v108, v108, v76
    v_add_f32 v109, v109, v77
    v_add_f32 v110, v110, v78
    v_add_f32 v111, v111, v79
    s_waitcnt lgkmcnt(3)
    v_add_f32 v112, v112, v80
    v_add_f32 v113, v113, v81
    v_add_f32 v114, v114, v82
    v_add_f32 v115, v115, v83
    s_waitcnt lgkmcnt(2)
    v_add_f32 v116, v116, v84
    v_add_f32 v117, v117, v85
    v_add_f32 v118, v118, v86
    v_add_f32 v119, v119, v87
    s_waitcnt lgkmcnt(1)
    v_add_f32 v120, v120, v88
    v_add_f32 v121, v121, v89
    v_add_f32 v122, v122, v90
    v_add_f32 v123, v123, v91
    s_waitcnt lgkmcnt(0)
    v_add_f32 v124, v124, v92
    v_add_f32 v125, v125, v93
    v_add_f32 v126, v126, v94
    v_add_f32 v127, v127, v95
    v_cvt_pk_bf16_f32 v97, v96, v97
    v_lshlrev_b32 v96, 16, v97
    v_and_b32 v97, 0xffff0000, v97
    v_add_f32 v96, v96, v128
    v_add_f32 v97, v97, v129
    v_cvt_pk_bf16_f32 v0, v96, v97
    v_lshlrev_b32 v96, 16, v0
    v_and_b32 v97, 0xffff0000, v0
    v_add_f32 v32, v96, v97
    v_mul_f32 v33, v96, v96
    v_mul_f32 v34, v96, v184
    v_fmac_f32 v33, v97, v97
    v_fmac_f32 v34, v97, v185
    v_cvt_pk_bf16_f32 v99, v98, v99
    v_lshlrev_b32 v98, 16, v99
    v_and_b32 v99, 0xffff0000, v99
    v_add_f32 v98, v98, v130
    v_add_f32 v99, v99, v131
    v_cvt_pk_bf16_f32 v1, v98, v99
    v_lshlrev_b32 v98, 16, v1
    v_and_b32 v99, 0xffff0000, v1
    v_add_f32 v32, v32, v98
    v_add_f32 v32, v32, v99
    v_fmac_f32 v33, v98, v98
    v_fmac_f32 v34, v98, v186
    v_fmac_f32 v33, v99, v99
    v_fmac_f32 v34, v99, v187
    buffer_store_dwordx2 v[0:1], v214, s[20:23], 0 offen offset:0
    v_cvt_pk_bf16_f32 v101, v100, v101
    v_lshlrev_b32 v100, 16, v101
    v_and_b32 v101, 0xffff0000, v101
    v_add_f32 v100, v100, v132
    v_add_f32 v101, v101, v133
    v_cvt_pk_bf16_f32 v2, v100, v101
    v_lshlrev_b32 v100, 16, v2
    v_and_b32 v101, 0xffff0000, v2
    v_add_f32 v32, v32, v100
    v_add_f32 v32, v32, v101
    v_fmac_f32 v33, v100, v100
    v_fmac_f32 v34, v100, v188
    v_fmac_f32 v33, v101, v101
    v_fmac_f32 v34, v101, v189
    v_cvt_pk_bf16_f32 v103, v102, v103
    v_lshlrev_b32 v102, 16, v103
    v_and_b32 v103, 0xffff0000, v103
    v_add_f32 v102, v102, v134
    v_add_f32 v103, v103, v135
    v_cvt_pk_bf16_f32 v3, v102, v103
    v_lshlrev_b32 v102, 16, v3
    v_and_b32 v103, 0xffff0000, v3
    v_add_f32 v32, v32, v102
    v_add_f32 v32, v32, v103
    v_fmac_f32 v33, v102, v102
    v_fmac_f32 v34, v102, v190
    v_fmac_f32 v33, v103, v103
    v_fmac_f32 v34, v103, v191
    buffer_store_dwordx2 v[2:3], v214, s[20:23], 0 offen offset:32
    v_cvt_pk_bf16_f32 v105, v104, v105
    v_lshlrev_b32 v104, 16, v105
    v_and_b32 v105, 0xffff0000, v105
    v_add_f32 v104, v104, v136
    v_add_f32 v105, v105, v137
    v_cvt_pk_bf16_f32 v4, v104, v105
    v_lshlrev_b32 v104, 16, v4
    v_and_b32 v105, 0xffff0000, v4
    v_add_f32 v32, v32, v104
    v_add_f32 v32, v32, v105
    v_fmac_f32 v33, v104, v104
    v_fmac_f32 v34, v104, v192
    v_fmac_f32 v33, v105, v105
    v_fmac_f32 v34, v105, v193
    v_cvt_pk_bf16_f32 v107, v106, v107
    v_lshlrev_b32 v106, 16, v107
    v_and_b32 v107, 0xffff0000, v107
    v_add_f32 v106, v106, v138
    v_add_f32 v107, v107, v139
    v_cvt_pk_bf16_f32 v5, v106, v107
    v_lshlrev_b32 v106, 16, v5
    v_and_b32 v107, 0xffff0000, v5
    v_add_f32 v32, v32, v106
    v_add_f32 v32, v32, v107
    v_fmac_f32 v33, v106, v106
    v_fmac_f32 v34, v106, v194
    v_fmac_f32 v33, v107, v107
    v_fmac_f32 v34, v107, v195
    buffer_store_dwordx2 v[4:5], v214, s[20:23], 0 offen offset:64
    v_cvt_pk_bf16_f32 v109, v108, v109
    v_lshlrev_b32 v108, 16, v109
    v_and_b32 v109, 0xffff0000, v109
    v_add_f32 v108, v108, v140
    v_add_f32 v109, v109, v141
    v_cvt_pk_bf16_f32 v6, v108, v109
    v_lshlrev_b32 v108, 16, v6
    v_and_b32 v109, 0xffff0000, v6
    v_add_f32 v32, v32, v108
    v_add_f32 v32, v32, v109
    v_fmac_f32 v33, v108, v108
    v_fmac_f32 v34, v108, v196
    v_fmac_f32 v33, v109, v109
    v_fmac_f32 v34, v109, v197
    v_cvt_pk_bf16_f32 v111, v110, v111
    v_lshlrev_b32 v110, 16, v111
    v_and_b32 v111, 0xffff0000, v111
    v_add_f32 v110, v110, v142
    v_add_f32 v111, v111, v143
    v_cvt_pk_bf16_f32 v7, v110, v111
    v_lshlrev_b32 v110, 16, v7
    v_and_b32 v111, 0xffff0000, v7
    v_add_f32 v32, v32, v110
    v_add_f32 v32, v32, v111
    v_fmac_f32 v33, v110, v110
    v_fmac_f32 v34, v110, v198
    v_fmac_f32 v33, v111, v111
    v_fmac_f32 v34, v111, v199
    buffer_store_dwordx2 v[6:7], v214, s[20:23], 0 offen offset:96
    v_cvt_pk_bf16_f32 v113, v112, v113
    v_lshlrev_b32 v112, 16, v113
    v_and_b32 v113, 0xffff0000, v113
    v_add_f32 v112, v112, v144
    v_add_f32 v113, v113, v145
    v_cvt_pk_bf16_f32 v8, v112, v113
    v_lshlrev_b32 v112, 16, v8
    v_and_b32 v113, 0xffff0000, v8
    v_add_f32 v35, v112, v113
    v_mul_f32 v36, v112, v112
    v_mul_f32 v37, v112, v184
    v_fmac_f32 v36, v113, v113
    v_fmac_f32 v37, v113, v185
    v_cvt_pk_bf16_f32 v115, v114, v115
    v_lshlrev_b32 v114, 16, v115
    v_and_b32 v115, 0xffff0000, v115
    v_add_f32 v114, v114, v146
    v_add_f32 v115, v115, v147
    v_cvt_pk_bf16_f32 v9, v114, v115
    v_lshlrev_b32 v114, 16, v9
    v_and_b32 v115, 0xffff0000, v9
    v_add_f32 v35, v35, v114
    v_add_f32 v35, v35, v115
    v_fmac_f32 v36, v114, v114
    v_fmac_f32 v37, v114, v186
    v_fmac_f32 v36, v115, v115
    v_fmac_f32 v37, v115, v187
    buffer_store_dwordx2 v[8:9], v214, s[20:23], s38 offen offset:0
    v_cvt_pk_bf16_f32 v117, v116, v117
    v_lshlrev_b32 v116, 16, v117
    v_and_b32 v117, 0xffff0000, v117
    v_add_f32 v116, v116, v148
    v_add_f32 v117, v117, v149
    v_cvt_pk_bf16_f32 v10, v116, v117
    v_lshlrev_b32 v116, 16, v10
    v_and_b32 v117, 0xffff0000, v10
    v_add_f32 v35, v35, v116
    v_add_f32 v35, v35, v117
    v_fmac_f32 v36, v116, v116
    v_fmac_f32 v37, v116, v188
    v_fmac_f32 v36, v117, v117
    v_fmac_f32 v37, v117, v189
    v_cvt_pk_bf16_f32 v119, v118, v119
    v_lshlrev_b32 v118, 16, v119
    v_and_b32 v119, 0xffff0000, v119
    v_add_f32 v118, v118, v150
    v_add_f32 v119, v119, v151
    v_cvt_pk_bf16_f32 v11, v118, v119
    v_lshlrev_b32 v118, 16, v11
    v_and_b32 v119, 0xffff0000, v11
    v_add_f32 v35, v35, v118
    v_add_f32 v35, v35, v119
    v_fmac_f32 v36, v118, v118
    v_fmac_f32 v37, v118, v190
    v_fmac_f32 v36, v119, v119
    v_fmac_f32 v37, v119, v191
    buffer_store_dwordx2 v[10:11], v214, s[20:23], s38 offen offset:32
    v_cvt_pk_bf16_f32 v121, v120, v121
    v_lshlrev_b32 v120, 16, v121
    v_and_b32 v121, 0xffff0000, v121
    v_add_f32 v120, v120, v152
    v_add_f32 v121, v121, v153
    v_cvt_pk_bf16_f32 v12, v120, v121
    v_lshlrev_b32 v120, 16, v12
    v_and_b32 v121, 0xffff0000, v12
    v_add_f32 v35, v35, v120
    v_add_f32 v35, v35, v121
    v_fmac_f32 v36, v120, v120
    v_fmac_f32 v37, v120, v192
    v_fmac_f32 v36, v121, v121
    v_fmac_f32 v37, v121, v193
    v_cvt_pk_bf16_f32 v123, v122, v123
    v_lshlrev_b32 v122, 16, v123
    v_and_b32 v123, 0xffff0000, v123
    v_add_f32 v122, v122, v154
    v_add_f32 v123, v123, v155
    v_cvt_pk_bf16_f32 v13, v122, v123
    v_lshlrev_b32 v122, 16, v13
    v_and_b32 v123, 0xffff0000, v13
    v_add_f32 v35, v35, v122
    v_add_f32 v35, v35, v123
    v_fmac_f32 v36, v122, v122
    v_fmac_f32 v37, v122, v194
    v_fmac_f32 v36, v123, v123
    v_fmac_f32 v37, v123, v195
    buffer_store_dwordx2 v[12:13], v214, s[20:23], s38 offen offset:64
    v_cvt_pk_bf16_f32 v125, v124, v125
    v_lshlrev_b32 v124, 16, v125
    v_and_b32 v125, 0xffff0000, v125
    v_add_f32 v124, v124, v156
    v_add_f32 v125, v125, v157
    v_cvt_pk_bf16_f32 v14, v124, v125
    v_lshlrev_b32 v124, 16, v14
    v_and_b32 v125, 0xffff0000, v14
    v_add_f32 v35, v35, v124
    v_add_f32 v35, v35, v125
    v_fmac_f32 v36, v124, v124
    v_fmac_f32 v37, v124, v196
    v_fmac_f32 v36, v125, v125
    v_fmac_f32 v37, v125, v197
    v_cvt_pk_bf16_f32 v127, v126, v127
    v_lshlrev_b32 v126, 16, v127
    v_and_b32 v127, 0xffff0000, v127
    v_add_f32 v126, v126, v158
    v_add_f32 v127, v127, v159
    v_cvt_pk_bf16_f32 v15, v126, v127
    v_lshlrev_b32 v126, 16, v15
    v_and_b32 v127, 0xffff0000, v15
    v_add_f32 v35, v35, v126
    v_add_f32 v35, v35, v127
    v_fmac_f32 v36, v126, v126
    v_fmac_f32 v37, v126, v198
    v_fmac_f32 v36, v127, v127
    v_fmac_f32 v37, v127, v199
    buffer_store_dwordx2 v[14:15], v214, s[20:23], s38 offen offset:96
    v_add_f32 v40, v184, v185
    v_add_f32 v40, v40, v186
    v_add_f32 v40, v40, v187
    v_add_f32 v40, v40, v188
    v_add_f32 v40, v40, v189
    v_add_f32 v40, v40, v190
    v_add_f32 v40, v40, v191
    v_add_f32 v40, v40, v192
    v_add_f32 v40, v40, v193
    v_add_f32 v40, v40, v194
    v_add_f32 v40, v40, v195
    v_add_f32 v40, v40, v196
    v_add_f32 v40, v40, v197
    v_add_f32 v40, v40, v198
    v_add_f32 v40, v40, v199
    v_mov_b32 v41, 0
    s_nop 1
    v_permlane32_swap_b32 v32, v33
    v_permlane32_swap_b32 v35, v36
    v_permlane32_swap_b32 v34, v40
    v_permlane32_swap_b32 v37, v41
    s_nop 0
    v_add_f32 v32, v32, v33
    v_add_f32 v35, v35, v36
    v_add_f32 v34, v34, v40
    v_add_f32 v37, v37, v41
    s_nop 1
    v_permlane16_swap_b32 v32, v35
    v_permlane16_swap_b32 v34, v37
    s_nop 0
    v_add_f32 v32, v32, v35
    v_add_f32 v34, v34, v37
    buffer_atomic_add_f32 v32, v215, s[24:27], 0 offen
    buffer_atomic_add_f32 v34, v216, s[24:27], 0 offen
k3_done:
    s_endpgm

.globl k4_kernel
.p2align 8
.type k4_kernel,@function
k4_kernel:
    s_cmp_ge_u32 s2, 256
    s_cbranch_scc1 k4_done
    s_load_dwordx4 s[44:47], s[0:1], 64
    s_load_dwordx4 s[48:51], s[0:1], 80
    s_load_dwordx2 s[52:53], s[0:1], 104
    v_lshrrev_b32 v1, 6, v0
    v_and_b32 v2, 63, v0
    v_readfirstlane_b32 s3, v1
    s_and_b32 s40, s2, 7
    s_mul_i32 s4, s40, 28
    s_lshr_b32 s5, s2, 3
    s_add_u32 s4, s4, s5
    s_waitcnt lgkmcnt(0)
    s_add_u32 s8, s52, 0x3400000
    s_addc_u32 s9, s53, 0
    s_mov_b32 s10, 0x400000
    s_mov_b32 s11, 0x00020000
    s_add_u32 s12, s52, 0x3800000
    s_addc_u32 s13, s53, 0
    s_mov_b32 s14, 0x6040
    s_mov_b32 s15, 0x00020000
    s_mov_b32 s16, s50
    s_mov_b32 s17, s51
    s_mov_b32 s18, 0x400000
    s_mov_b32 s19, 0x00020000
    s_mov_b32 s20, s44
    s_mov_b32 s21, s45
    s_mov_b32 s22, 0x700000
    s_mov_b32 s23, 0x00020000
    s_mov_b32 s24, s46
    s_mov_b32 s25, s47
    s_mov_b32 s26, 0x700000
    s_mov_b32 s27, 0x00020000
    s_mov_b32 s28, s48
    s_mov_b32 s29, s49
    s_mov_b32 s30, 0x700000
    s_mov_b32 s31, 0x00020000
    s_add_u32 s32, s52, 0x3810000
    s_addc_u32 s33, s53, 0
    s_mov_b32 s34, 0x3000
    s_mov_b32 s35, 0x00020000
    s_add_u32 s36, s52, 0x3900000
    s_addc_u32 s37, s53, 0
    s_mov_b32 s38, 0x1c0000
    s_mov_b32 s39, 0x00020000
    s_lshl_b32 s40, s2, 3
    s_lshl1_add_u32 s40, s3, s40
    v_lshrrev_b32 v3, 5, v2
    v_add_u32 v3, s40, v3
    v_and_b32 v4, 31, v2
    v_lshlrev_b32 v54, 11, v3
    v_lshl_add_u32 v54, v4, 4, v54
    v_lshlrev_b32 v3, 2, v3
    s_mov_b32 s41, 8192
    s_mov_b32 s6, 16384
    v_lshlrev_b32 v5, 5, v0
    s_cmp_ge_u32 s5, 28
    s_cbranch_scc1 k4_simple
    buffer_load_dwordx4 v[8:11], v5, s[12:15], 0 offen offset:0
    buffer_load_dwordx4 v[12:15], v5, s[12:15], 0 offen offset:16
    buffer_load_dwordx4 v[16:19], v5, s[12:15], s41 offen offset:0
    buffer_load_dwordx4 v[20:23], v5, s[12:15], s41 offen offset:16
    buffer_load_dwordx4 v[24:27], v5, s[12:15], s6 offen offset:0
    buffer_load_dwordx4 v[28:31], v5, s[12:15], s6 offen offset:16
    v_mov_b32 v6, 24576
    buffer_load_dword v32, v6, s[12:15], 0 offen
    buffer_load_dword v52, v3, s[12:15], 0 offen
    buffer_load_dword v53, v3, s[12:15], s41 offen
    buffer_load_dwordx4 v[36:39], v54, s[8:11], 0 offen offset:0
    buffer_load_dwordx4 v[40:43], v54, s[8:11], 0 offen offset:512
    buffer_load_dwordx4 v[44:47], v54, s[8:11], 0 offen offset:1024
    buffer_load_dwordx4 v[48:51], v54, s[8:11], 0 offen offset:1536
    v_lshrrev_b32 v3, 1, v2
    v_mul_u32_u24 v3, 7168, v3
    v_and_b32 v4, 1, v2
    v_lshl_add_u32 v3, v4, 4, v3
    s_lshl_b32 s40, s4, 5
    v_add_u32 v55, s40, v3
    v_lshrrev_b32 v3, 2, v2
    v_lshlrev_b32 v3, 11, v3
    v_and_b32 v4, 3, v2
    v_lshl_add_u32 v3, v4, 4, v3
    s_lshl_b32 s40, s4, 15
    s_lshl_b32 s7, s3, 9
    s_add_u32 s40, s40, s7
    v_add_u32 v33, s40, v3
    s_lshl_b32 s42, s3, 13
    s_mul_i32 s7, s3, 1835008
    s_add_u32 m0, s42, 0
    s_add_u32 s40, s7, 0
    buffer_load_dwordx4 v55, s[20:23], s40 offen lds
    s_add_u32 m0, s42, 32768
    s_nop 0
    buffer_load_dwordx4 v55, s[24:27], s40 offen lds
    s_add_u32 m0, s42, 1024
    s_add_u32 s40, s7, 229376
    buffer_load_dwordx4 v55, s[20:23], s40 offen lds
    s_add_u32 m0, s42, 33792
    s_nop 0
    buffer_load_dwordx4 v55, s[24:27], s40 offen lds
    s_add_u32 m0, s42, 2048
    s_add_u32 s40, s7, 458752
    buffer_load_dwordx4 v55, s[20:23], s40 offen lds
    s_add_u32 m0, s42, 34816
    s_nop 0
    buffer_load_dwordx4 v55, s[24:27], s40 offen lds
    s_add_u32 m0, s42, 3072
    s_add_u32 s40, s7, 688128
    buffer_load_dwordx4 v55, s[20:23], s40 offen lds
    s_add_u32 m0, s42, 35840
    s_nop 0
    buffer_load_dwordx4 v55, s[24:27], s40 offen lds
    s_add_u32 m0, s42, 4096
    s_add_u32 s40, s7, 917504
    buffer_load_dwordx4 v55, s[20:23], s40 offen lds
    s_add_u32 m0, s42, 36864
    s_nop 0
    buffer_load_dwordx4 v55, s[24:27], s40 offen lds
    s_add_u32 m0, s42, 5120
    s_add_u32 s40, s7, 1146880
    buffer_load_dwordx4 v55, s[20:23], s40 offen lds
    s_add_u32 m0, s42, 37888
    s_nop 0
    buffer_load_dwordx4 v55, s[24:27], s40 offen lds
    s_add_u32 m0, s42, 6144
    s_add_u32 s40, s7, 1376256
    buffer_load_dwordx4 v55, s[20:23], s40 offen lds
    s_add_u32 m0, s42, 38912
    s_nop 0
    buffer_load_dwordx4 v55, s[24:27], s40 offen lds
    s_add_u32 m0, s42, 7168
    s_add_u32 s40, s7, 1605632
    buffer_load_dwordx4 v55, s[20:23], s40 offen lds
    s_add_u32 m0, s42, 39936
    s_nop 0
    buffer_load_dwordx4 v55, s[24:27], s40 offen lds
    s_add_u32 m0, s42, 65536
    s_mov_b32 s40, 0
    buffer_load_dwordx4 v33, s[28:31], s40 offen lds
    s_add_u32 m0, s42, 66560
    s_mov_b32 s40, 64
    buffer_load_dwordx4 v33, s[28:31], s40 offen lds
    s_add_u32 m0, s42, 67584
    s_mov_b32 s40, 128
    buffer_load_dwordx4 v33, s[28:31], s40 offen lds
    s_add_u32 m0, s42, 68608
    s_mov_b32 s40, 192
    buffer_load_dwordx4 v33, s[28:31], s40 offen lds
    s_add_u32 m0, s42, 69632
    s_mov_b32 s40, 256
    buffer_load_dwordx4 v33, s[28:31], s40 offen lds
    s_add_u32 m0, s42, 70656
    s_mov_b32 s40, 320
    buffer_load_dwordx4 v33, s[28:31], s40 offen lds
    s_add_u32 m0, s42, 71680
    s_mov_b32 s40, 384
    buffer_load_dwordx4 v33, s[28:31], s40 offen lds
    s_add_u32 m0, s42, 72704
    s_mov_b32 s40, 448
    buffer_load_dwordx4 v33, s[28:31], s40 offen lds
    s_waitcnt vmcnt(30)
    v_lshlrev_b32 v5, 3, v0
    v_sub_u32 v5, 2047, v5
    v_mul_f32 v8, 0x3a800000, v8
    v_mul_f32 v9, 0x3a800000, v9
    v_mul_f32 v10, 0x3a800000, v10
    v_mul_f32 v11, 0x3a800000, v11
    v_mul_f32 v12, 0x3a800000, v12
    v_mul_f32 v13, 0x3a800000, v13
    v_mul_f32 v14, 0x3a800000, v14
    v_mul_f32 v15, 0x3a800000, v15
    v_mul_f32 v16, 0x3a800000, v16
    v_mul_f32 v17, 0x3a800000, v17
    v_mul_f32 v18, 0x3a800000, v18
    v_mul_f32 v19, 0x3a800000, v19
    v_mul_f32 v20, 0x3a800000, v20
    v_mul_f32 v21, 0x3a800000, v21
    v_mul_f32 v22, 0x3a800000, v22
    v_mul_f32 v23, 0x3a800000, v23
    v_fma_f32 v16, -v8, v8, v16
    v_fma_f32 v17, -v9, v9, v17
    v_fma_f32 v18, -v10, v10, v18
    v_fma_f32 v19, -v11, v11, v19
    v_fma_f32 v20, -v12, v12, v20
    v_fma_f32 v21, -v13, v13, v21
    v_fma_f32 v22, -v14, v14, v22
    v_fma_f32 v23, -v15, v15, v23
    v_max_f32 v16, 0, v16
    v_max_f32 v17, 0, v17
    v_max_f32 v18, 0, v18
    v_max_f32 v19, 0, v19
    v_max_f32 v20, 0, v20
    v_max_f32 v21, 0, v21
    v_max_f32 v22, 0, v22
    v_max_f32 v23, 0, v23
    v_cvt_pk_bf16_f32 v56, v8, v16
    v_cvt_pk_bf16_f32 v57, v9, v17
    v_cvt_pk_bf16_f32 v58, v10, v18
    v_cvt_pk_bf16_f32 v59, v11, v19
    v_cvt_pk_bf16_f32 v60, v12, v20
    v_cvt_pk_bf16_f32 v61, v13, v21
    v_cvt_pk_bf16_f32 v62, v14, v22
    v_cvt_pk_bf16_f32 v63, v15, v23
    v_lshlrev_b32 v8, 16, v56
    v_lshlrev_b32 v9, 16, v57
    v_lshlrev_b32 v10, 16, v58
    v_lshlrev_b32 v11, 16, v59
    v_lshlrev_b32 v12, 16, v60
    v_lshlrev_b32 v13, 16, v61
    v_lshlrev_b32 v14, 16, v62
    v_lshlrev_b32 v15, 16, v63
    v_and_b32 v16, 0xffff0000, v56
    v_and_b32 v17, 0xffff0000, v57
    v_and_b32 v18, 0xffff0000, v58
    v_and_b32 v19, 0xffff0000, v59
    v_and_b32 v20, 0xffff0000, v60
    v_and_b32 v21, 0xffff0000, v61
    v_and_b32 v22, 0xffff0000, v62
    v_and_b32 v23, 0xffff0000, v63
    v_add_f32 v16, 0x3727c5ac, v16
    v_add_f32 v17, 0x3727c5ac, v17
    v_add_f32 v18, 0x3727c5ac, v18
    v_add_f32 v19, 0x3727c5ac, v19
    v_add_f32 v20, 0x3727c5ac, v20
    v_add_f32 v21, 0x3727c5ac, v21
    v_add_f32 v22, 0x3727c5ac, v22
    v_add_f32 v23, 0x3727c5ac, v23
    v_cvt_pk_bf16_f32 v16, v16, v16
    v_cvt_pk_bf16_f32 v17, v17, v17
    v_cvt_pk_bf16_f32 v18, v18, v18
    v_cvt_pk_bf16_f32 v19, v19, v19
    v_cvt_pk_bf16_f32 v20, v20, v20
    v_cvt_pk_bf16_f32 v21, v21, v21
    v_cvt_pk_bf16_f32 v22, v22, v22
    v_cvt_pk_bf16_f32 v23, v23, v23
    v_lshlrev_b32 v16, 16, v16
    v_lshlrev_b32 v17, 16, v17
    v_lshlrev_b32 v18, 16, v18
    v_lshlrev_b32 v19, 16, v19
    v_lshlrev_b32 v20, 16, v20
    v_lshlrev_b32 v21, 16, v21
    v_lshlrev_b32 v22, 16, v22
    v_lshlrev_b32 v23, 16, v23
    v_sqrt_f32 v16, v16
    v_sqrt_f32 v17, v17
    v_sqrt_f32 v18, v18
    v_sqrt_f32 v19, v19
    v_sqrt_f32 v20, v20
    v_sqrt_f32 v21, v21
    v_sqrt_f32 v22, v22
    v_sqrt_f32 v23, v23
    v_cvt_pk_bf16_f32 v16, v16, v16
    v_cvt_pk_bf16_f32 v17, v17, v17
    v_cvt_pk_bf16_f32 v18, v18, v18
    v_cvt_pk_bf16_f32 v19, v19, v19
    v_cvt_pk_bf16_f32 v20, v20, v20
    v_cvt_pk_bf16_f32 v21, v21, v21
    v_cvt_pk_bf16_f32 v22, v22, v22
    v_cvt_pk_bf16_f32 v23, v23, v23
    v_lshlrev_b32 v16, 16, v16
    v_lshlrev_b32 v17, 16, v17
    v_lshlrev_b32 v18, 16, v18
    v_lshlrev_b32 v19, 16, v19
    v_lshlrev_b32 v20, 16, v20
    v_lshlrev_b32 v21, 16, v21
    v_lshlrev_b32 v22, 16, v22
    v_lshlrev_b32 v23, 16, v23
    v_rcp_f32 v16, v16
    v_rcp_f32 v17, v17
    v_rcp_f32 v18, v18
    v_rcp_f32 v19, v19
    v_rcp_f32 v20, v20
    v_rcp_f32 v21, v21
    v_rcp_f32 v22, v22
    v_rcp_f32 v23, v23
    v_fma_f32 v24, -v8, v32, v24
    v_fma_f32 v25, -v9, v32, v25
    v_fma_f32 v26, -v10, v32, v26
    v_fma_f32 v27, -v11, v32, v27
    v_fma_f32 v28, -v12, v32, v28
    v_fma_f32 v29, -v13, v32, v29
    v_fma_f32 v30, -v14, v32, v30
    v_fma_f32 v31, -v15, v32, v31
    v_mul_f32 v24, v24, v16
    v_mul_f32 v25, v25, v17
    v_mul_f32 v26, v26, v18
    v_mul_f32 v27, v27, v19
    v_mul_f32 v28, v28, v20
    v_mul_f32 v29, v29, v21
    v_mul_f32 v30, v30, v22
    v_mul_f32 v31, v31, v23
    v_cvt_pk_bf16_f32 v24, v24, v24
    v_cvt_pk_bf16_f32 v25, v25, v25
    v_cvt_pk_bf16_f32 v26, v26, v26
    v_cvt_pk_bf16_f32 v27, v27, v27
    v_cvt_pk_bf16_f32 v28, v28, v28
    v_cvt_pk_bf16_f32 v29, v29, v29
    v_cvt_pk_bf16_f32 v30, v30, v30
    v_cvt_pk_bf16_f32 v31, v31, v31
    v_ashrrev_i32 v56, 31, v24
    v_ashrrev_i32 v57, 31, v25
    v_ashrrev_i32 v58, 31, v26
    v_ashrrev_i32 v59, 31, v27
    v_ashrrev_i32 v60, 31, v28
    v_ashrrev_i32 v61, 31, v29
    v_ashrrev_i32 v62, 31, v30
    v_ashrrev_i32 v63, 31, v31
    v_or_b32 v56, 0x80000000, v56
    v_or_b32 v57, 0x80000000, v57
    v_or_b32 v58, 0x80000000, v58
    v_or_b32 v59, 0x80000000, v59
    v_or_b32 v60, 0x80000000, v60
    v_or_b32 v61, 0x80000000, v61
    v_or_b32 v62, 0x80000000, v62
    v_or_b32 v63, 0x80000000, v63
    v_xor_b32 v24, v24, v56
    v_xor_b32 v25, v25, v57
    v_xor_b32 v26, v26, v58
    v_xor_b32 v27, v27, v59
    v_xor_b32 v28, v28, v60
    v_xor_b32 v29, v29, v61
    v_xor_b32 v30, v30, v62
    v_xor_b32 v31, v31, v63
    v_and_b32 v24, 0xffff0000, v24
    v_and_b32 v25, 0xffff0000, v25
    v_and_b32 v26, 0xffff0000, v26
    v_and_b32 v27, 0xffff0000, v27
    v_and_b32 v28, 0xffff0000, v28
    v_and_b32 v29, 0xffff0000, v29
    v_and_b32 v30, 0xffff0000, v30
    v_and_b32 v31, 0xffff0000, v31
    v_subrev_u32 v56, 0, v5
    v_subrev_u32 v57, 1, v5
    v_subrev_u32 v58, 2, v5
    v_subrev_u32 v59, 3, v5
    v_subrev_u32 v60, 4, v5
    v_subrev_u32 v61, 5, v5
    v_subrev_u32 v62, 6, v5
    v_subrev_u32 v63, 7, v5
    v_or_b32 v24, v24, v56
    v_or_b32 v25, v25, v57
    v_or_b32 v26, v26, v58
    v_or_b32 v27, v27, v59
    v_or_b32 v28, v28, v60
    v_or_b32 v29, v29, v61
    v_or_b32 v30, v30, v62
    v_or_b32 v31, v31, v63
    v_max_u32 v64, v24, v25
    v_min_u32 v65, v24, v25
    v_med3_u32 v65, v64, v26, v65
    v_max_u32 v64, v64, v26
    v_med3_u32 v65, v64, v27, v65
    v_max_u32 v64, v64, v27
    v_med3_u32 v65, v64, v28, v65
    v_max_u32 v64, v64, v28
    v_med3_u32 v65, v64, v29, v65
    v_max_u32 v64, v64, v29
    v_med3_u32 v65, v64, v30, v65
    v_max_u32 v64, v64, v30
    v_med3_u32 v65, v64, v31, v65
    v_max_u32 v64, v64, v31
    s_nop 1
    v_mov_b32_dpp v66, v64 quad_perm:[1,0,3,2] row_mask:0xf bank_mask:0xf
    v_mov_b32_dpp v67, v65 quad_perm:[1,0,3,2] row_mask:0xf bank_mask:0xf
    v_min_u32 v68, v64, v66
    v_max_u32 v64, v64, v66
    v_max3_u32 v65, v68, v65, v67
    s_nop 1
    v_mov_b32_dpp v66, v64 quad_perm:[2,3,0,1] row_mask:0xf bank_mask:0xf
    v_mov_b32_dpp v67, v65 quad_perm:[2,3,0,1] row_mask:0xf bank_mask:0xf
    v_min_u32 v68, v64, v66
    v_max_u32 v64, v64, v66
    v_max3_u32 v65, v68, v65, v67
    s_nop 1
    v_mov_b32_dpp v66, v64 row_half_mirror row_mask:0xf bank_mask:0xf
    v_mov_b32_dpp v67, v65 row_half_mirror row_mask:0xf bank_mask:0xf
    v_min_u32 v68, v64, v66
    v_max_u32 v64, v64, v66
    v_max3_u32 v65, v68, v65, v67
    s_nop 1
    v_mov_b32_dpp v66, v64 row_mirror row_mask:0xf bank_mask:0xf
    v_mov_b32_dpp v67, v65 row_mirror row_mask:0xf bank_mask:0xf
    v_min_u32 v68, v64, v66
    v_max_u32 v64, v64, v66
    v_max3_u32 v65, v68, v65, v67
    v_mov_b32 v66, v64
    v_mov_b32 v67, v65
    s_nop 1
    v_permlane16_swap_b32 v64, v66
    v_permlane16_swap_b32 v65, v67
    s_nop 0
    v_min_u32 v68, v64, v66
    v_max_u32 v64, v64, v66
    v_max3_u32 v65, v68, v65, v67
    v_mov_b32 v66, v64
    v_mov_b32 v67, v65
    s_nop 1
    v_permlane32_swap_b32 v64, v66
    v_permlane32_swap_b32 v65, v67
    s_nop 0
    v_min_u32 v68, v64, v66
    v_max_u32 v64, v64, v66
    v_max3_u32 v65, v68, v65, v67
    s_lshl_b32 s40, s3, 3
    s_add_u32 s40, s40, 102400
    v_mov_b32 v3, s40
    ds_write_b64 v3, v[64:65]
    v_mov_b32 v3, 102400
    s_waitcnt lgkmcnt(0)
    s_barrier
    ds_read_b128 v[72:75], v3
    ds_read_b128 v[76:79], v3 offset:16
    s_waitcnt lgkmcnt(0)
    v_min_u32 v68, v72, v74
    v_max_u32 v72, v72, v74
    v_max3_u32 v73, v68, v73, v75
    v_min_u32 v68, v76, v78
    v_max_u32 v76, v76, v78
    v_max3_u32 v77, v68, v77, v79
    v_min_u32 v68, v72, v76
    v_max_u32 v72, v72, v76
    v_max3_u32 v73, v68, v73, v77
    s_cmp_lt_u32 s3, 2
    s_cselect_b64 vcc, -1, 0
    v_cndmask_b32 v64, v73, v72, vcc
    v_and_b32 v65, 0xffff, v64
    v_sub_u32 v65, 2047, v65
    v_and_b32 v3, 127, v0
    v_lshlrev_b32 v3, 4, v3
    v_lshl_add_u32 v3, v65, 11, v3
    v_lshlrev_b32 v4, 2, v65
    buffer_load_dwordx4 v[80:83], v3, s[8:11], 0 offen
    buffer_load_dword v84, v4, s[12:15], 0 offen
    buffer_load_dword v85, v4, s[12:15], s41 offen
    s_waitcnt vmcnt(27)
    v_mul_f32 v52, 0x3a800000, v52
    v_mul_f32 v53, 0x3a800000, v53
    v_fma_f32 v53, -v52, v52, v53
    v_max_f32 v53, 0, v53
    v_cvt_pk_bf16_f32 v3, v52, v53
    v_lshlrev_b32 v52, 16, v3
    v_and_b32 v53, 0xffff0000, v3
    v_add_f32 v53, 0x3727c5ac, v53
    v_cvt_pk_bf16_f32 v53, v53, v53
    v_lshlrev_b32 v53, 16, v53
    v_sqrt_f32 v53, v53
    s_nop 0
    v_cvt_pk_bf16_f32 v53, v53, v53
    v_lshlrev_b32 v53, 16, v53
    v_rcp_f32 v53, v53
    s_nop 0
    v_lshlrev_b32 v56, 16, v36
    v_lshlrev_b32 v60, 16, v37
    v_lshlrev_b32 v64, 16, v38
    v_lshlrev_b32 v68, 16, v39
    v_and_b32 v57, 0xffff0000, v36
    v_and_b32 v61, 0xffff0000, v37
    v_and_b32 v65, 0xffff0000, v38
    v_and_b32 v69, 0xffff0000, v39
    v_sub_f32 v56, v56, v52
    v_sub_f32 v60, v60, v52
    v_sub_f32 v64, v64, v52
    v_sub_f32 v68, v68, v52
    v_sub_f32 v57, v57, v52
    v_sub_f32 v61, v61, v52
    v_sub_f32 v65, v65, v52
    v_sub_f32 v69, v69, v52
    v_cvt_pk_bf16_f32 v57, v56, v57
    v_cvt_pk_bf16_f32 v61, v60, v61
    v_cvt_pk_bf16_f32 v65, v64, v65
    v_cvt_pk_bf16_f32 v69, v68, v69
    v_lshlrev_b32 v56, 16, v57
    v_lshlrev_b32 v60, 16, v61
    v_lshlrev_b32 v64, 16, v65
    v_lshlrev_b32 v68, 16, v69
    v_and_b32 v57, 0xffff0000, v57
    v_and_b32 v61, 0xffff0000, v61
    v_and_b32 v65, 0xffff0000, v65
    v_and_b32 v69, 0xffff0000, v69
    v_mul_f32 v56, v56, v53
    v_mul_f32 v60, v60, v53
    v_mul_f32 v64, v64, v53
    v_mul_f32 v68, v68, v53
    v_mul_f32 v57, v57, v53
    v_mul_f32 v61, v61, v53
    v_mul_f32 v65, v65, v53
    v_mul_f32 v69, v69, v53
    v_cvt_pk_bf16_f32 v58, v56, v57
    v_cvt_pk_bf16_f32 v62, v60, v61
    v_cvt_pk_bf16_f32 v66, v64, v65
    v_cvt_pk_bf16_f32 v70, v68, v69
    v_lshlrev_b32 v56, 16, v58
    v_lshlrev_b32 v60, 16, v62
    v_lshlrev_b32 v64, 16, v66
    v_lshlrev_b32 v68, 16, v70
    v_and_b32 v57, 0xffff0000, v58
    v_and_b32 v61, 0xffff0000, v62
    v_and_b32 v65, 0xffff0000, v66
    v_and_b32 v69, 0xffff0000, v70
    v_lshlrev_b32 v58, 16, v36
    v_lshlrev_b32 v62, 16, v37
    v_lshlrev_b32 v66, 16, v38
    v_lshlrev_b32 v70, 16, v39
    v_and_b32 v59, 0xffff0000, v36
    v_and_b32 v63, 0xffff0000, v37
    v_and_b32 v67, 0xffff0000, v38
    v_and_b32 v71, 0xffff0000, v39
    v_add_f32 v56, v56, v58
    v_add_f32 v60, v60, v62
    v_add_f32 v64, v64, v66
    v_add_f32 v68, v68, v70
    v_add_f32 v57, v57, v59
    v_add_f32 v61, v61, v63
    v_add_f32 v65, v65, v67
    v_add_f32 v69, v69, v71
    v_cvt_pk_bf16_f32 v36, v56, v57
    v_cvt_pk_bf16_f32 v37, v60, v61
    v_cvt_pk_bf16_f32 v38, v64, v65
    v_cvt_pk_bf16_f32 v39, v68, v69
    buffer_store_dwordx4 v[36:39], v54, s[16:19], 0 offen offset:0
    v_lshlrev_b32 v56, 16, v40
    v_lshlrev_b32 v60, 16, v41
    v_lshlrev_b32 v64, 16, v42
    v_lshlrev_b32 v68, 16, v43
    v_and_b32 v57, 0xffff0000, v40
    v_and_b32 v61, 0xffff0000, v41
    v_and_b32 v65, 0xffff0000, v42
    v_and_b32 v69, 0xffff0000, v43
    v_sub_f32 v56, v56, v52
    v_sub_f32 v60, v60, v52
    v_sub_f32 v64, v64, v52
    v_sub_f32 v68, v68, v52
    v_sub_f32 v57, v57, v52
    v_sub_f32 v61, v61, v52
    v_sub_f32 v65, v65, v52
    v_sub_f32 v69, v69, v52
    v_cvt_pk_bf16_f32 v57, v56, v57
    v_cvt_pk_bf16_f32 v61, v60, v61
    v_cvt_pk_bf16_f32 v65, v64, v65
    v_cvt_pk_bf16_f32 v69, v68, v69
    v_lshlrev_b32 v56, 16, v57
    v_lshlrev_b32 v60, 16, v61
    v_lshlrev_b32 v64, 16, v65
    v_lshlrev_b32 v68, 16, v69
    v_and_b32 v57, 0xffff0000, v57
    v_and_b32 v61, 0xffff0000, v61
    v_and_b32 v65, 0xffff0000, v65
    v_and_b32 v69, 0xffff0000, v69
    v_mul_f32 v56, v56, v53
    v_mul_f32 v60, v60, v53
    v_mul_f32 v64, v64, v53
    v_mul_f32 v68, v68, v53
    v_mul_f32 v57, v57, v53
    v_mul_f32 v61, v61, v53
    v_mul_f32 v65, v65, v53
    v_mul_f32 v69, v69, v53
    v_cvt_pk_bf16_f32 v58, v56, v57
    v_cvt_pk_bf16_f32 v62, v60, v61
    v_cvt_pk_bf16_f32 v66, v64, v65
    v_cvt_pk_bf16_f32 v70, v68, v69
    v_lshlrev_b32 v56, 16, v58
    v_lshlrev_b32 v60, 16, v62
    v_lshlrev_b32 v64, 16, v66
    v_lshlrev_b32 v68, 16, v70
    v_and_b32 v57, 0xffff0000, v58
    v_and_b32 v61, 0xffff0000, v62
    v_and_b32 v65, 0xffff0000, v66
    v_and_b32 v69, 0xffff0000, v70
    v_lshlrev_b32 v58, 16, v40
    v_lshlrev_b32 v62, 16, v41
    v_lshlrev_b32 v66, 16, v42
    v_lshlrev_b32 v70, 16, v43
    v_and_b32 v59, 0xffff0000, v40
    v_and_b32 v63, 0xffff0000, v41
    v_and_b32 v67, 0xffff0000, v42
    v_and_b32 v71, 0xffff0000, v43
    v_add_f32 v56, v56, v58
    v_add_f32 v60, v60, v62
    v_add_f32 v64, v64, v66
    v_add_f32 v68, v68, v70
    v_add_f32 v57, v57, v59
    v_add_f32 v61, v61, v63
    v_add_f32 v65, v65, v67
    v_add_f32 v69, v69, v71
    v_cvt_pk_bf16_f32 v40, v56, v57
    v_cvt_pk_bf16_f32 v41, v60, v61
    v_cvt_pk_bf16_f32 v42, v64, v65
    v_cvt_pk_bf16_f32 v43, v68, v69
    buffer_store_dwordx4 v[40:43], v54, s[16:19], 0 offen offset:512
    v_lshlrev_b32 v56, 16, v44
    v_lshlrev_b32 v60, 16, v45
    v_lshlrev_b32 v64, 16, v46
    v_lshlrev_b32 v68, 16, v47
    v_and_b32 v57, 0xffff0000, v44
    v_and_b32 v61, 0xffff0000, v45
    v_and_b32 v65, 0xffff0000, v46
    v_and_b32 v69, 0xffff0000, v47
    v_sub_f32 v56, v56, v52
    v_sub_f32 v60, v60, v52
    v_sub_f32 v64, v64, v52
    v_sub_f32 v68, v68, v52
    v_sub_f32 v57, v57, v52
    v_sub_f32 v61, v61, v52
    v_sub_f32 v65, v65, v52
    v_sub_f32 v69, v69, v52
    v_cvt_pk_bf16_f32 v57, v56, v57
    v_cvt_pk_bf16_f32 v61, v60, v61
    v_cvt_pk_bf16_f32 v65, v64, v65
    v_cvt_pk_bf16_f32 v69, v68, v69
    v_lshlrev_b32 v56, 16, v57
    v_lshlrev_b32 v60, 16, v61
    v_lshlrev_b32 v64, 16, v65
    v_lshlrev_b32 v68, 16, v69
    v_and_b32 v57, 0xffff0000, v57
    v_and_b32 v61, 0xffff0000, v61
    v_and_b32 v65, 0xffff0000, v65
    v_and_b32 v69, 0xffff0000, v69
    v_mul_f32 v56, v56, v53
    v_mul_f32 v60, v60, v53
    v_mul_f32 v64, v64, v53
    v_mul_f32 v68, v68, v53
    v_mul_f32 v57, v57, v53
    v_mul_f32 v61, v61, v53
    v_mul_f32 v65, v65, v53
    v_mul_f32 v69, v69, v53
    v_cvt_pk_bf16_f32 v58, v56, v57
    v_cvt_pk_bf16_f32 v62, v60, v61
    v_cvt_pk_bf16_f32 v66, v64, v65
    v_cvt_pk_bf16_f32 v70, v68, v69
    v_lshlrev_b32 v56, 16, v58
    v_lshlrev_b32 v60, 16, v62
    v_lshlrev_b32 v64, 16, v66
    v_lshlrev_b32 v68, 16, v70
    v_and_b32 v57, 0xffff0000, v58
    v_and_b32 v61, 0xffff0000, v62
    v_and_b32 v65, 0xffff0000, v66
    v_and_b32 v69, 0xffff0000, v70
    v_lshlrev_b32 v58, 16, v44
    v_lshlrev_b32 v62, 16, v45
    v_lshlrev_b32 v66, 16, v46
    v_lshlrev_b32 v70, 16, v47
    v_and_b32 v59, 0xffff0000, v44
    v_and_b32 v63, 0xffff0000, v45
    v_and_b32 v67, 0xffff0000, v46
    v_and_b32 v71, 0xffff0000, v47
    v_add_f32 v56, v56, v58
    v_add_f32 v60, v60, v62
    v_add_f32 v64, v64, v66
    v_add_f32 v68, v68, v70
    v_add_f32 v57, v57, v59
    v_add_f32 v61, v61, v63
    v_add_f32 v65, v65, v67
    v_add_f32 v69, v69, v71
    v_cvt_pk_bf16_f32 v44, v56, v57
    v_cvt_pk_bf16_f32 v45, v60, v61
    v_cvt_pk_bf16_f32 v46, v64, v65
    v_cvt_pk_bf16_f32 v47, v68, v69
    buffer_store_dwordx4 v[44:47], v54, s[16:19], 0 offen offset:1024
    v_lshlrev_b32 v56, 16, v48
    v_lshlrev_b32 v60, 16, v49
    v_lshlrev_b32 v64, 16, v50
    v_lshlrev_b32 v68, 16, v51
    v_and_b32 v57, 0xffff0000, v48
    v_and_b32 v61, 0xffff0000, v49
    v_and_b32 v65, 0xffff0000, v50
    v_and_b32 v69, 0xffff0000, v51
    v_sub_f32 v56, v56, v52
    v_sub_f32 v60, v60, v52
    v_sub_f32 v64, v64, v52
    v_sub_f32 v68, v68, v52
    v_sub_f32 v57, v57, v52
    v_sub_f32 v61, v61, v52
    v_sub_f32 v65, v65, v52
    v_sub_f32 v69, v69, v52
    v_cvt_pk_bf16_f32 v57, v56, v57
    v_cvt_pk_bf16_f32 v61, v60, v61
    v_cvt_pk_bf16_f32 v65, v64, v65
    v_cvt_pk_bf16_f32 v69, v68, v69
    v_lshlrev_b32 v56, 16, v57
    v_lshlrev_b32 v60, 16, v61
    v_lshlrev_b32 v64, 16, v65
    v_lshlrev_b32 v68, 16, v69
    v_and_b32 v57, 0xffff0000, v57
    v_and_b32 v61, 0xffff0000, v61
    v_and_b32 v65, 0xffff0000, v65
    v_and_b32 v69, 0xffff0000, v69
    v_mul_f32 v56, v56, v53
    v_mul_f32 v60, v60, v53
    v_mul_f32 v64, v64, v53
    v_mul_f32 v68, v68, v53
    v_mul_f32 v57, v57, v53
    v_mul_f32 v61, v61, v53
    v_mul_f32 v65, v65, v53
    v_mul_f32 v69, v69, v53
    v_cvt_pk_bf16_f32 v58, v56, v57
    v_cvt_pk_bf16_f32 v62, v60, v61
    v_cvt_pk_bf16_f32 v66, v64, v65
    v_cvt_pk_bf16_f32 v70, v68, v69
    v_lshlrev_b32 v56, 16, v58
    v_lshlrev_b32 v60, 16, v62
    v_lshlrev_b32 v64, 16, v66
    v_lshlrev_b32 v68, 16, v70
    v_and_b32 v57, 0xffff0000, v58
    v_and_b32 v61, 0xffff0000, v62
    v_and_b32 v65, 0xffff0000, v66
    v_and_b32 v69, 0xffff0000, v70
    v_lshlrev_b32 v58, 16, v48
    v_lshlrev_b32 v62, 16, v49
    v_lshlrev_b32 v66, 16, v50
    v_lshlrev_b32 v70, 16, v51
    v_and_b32 v59, 0xffff0000, v48
    v_and_b32 v63, 0xffff0000, v49
    v_and_b32 v67, 0xffff0000, v50
    v_and_b32 v71, 0xffff0000, v51
    v_add_f32 v56, v56, v58
    v_add_f32 v60, v60, v62
    v_add_f32 v64, v64, v66
    v_add_f32 v68, v68, v70
    v_add_f32 v57, v57, v59
    v_add_f32 v61, v61, v63
    v_add_f32 v65, v65, v67
    v_add_f32 v69, v69, v71
    v_cvt_pk_bf16_f32 v48, v56, v57
    v_cvt_pk_bf16_f32 v49, v60, v61
    v_cvt_pk_bf16_f32 v50, v64, v65
    v_cvt_pk_bf16_f32 v51, v68, v69
    buffer_store_dwordx4 v[48:51], v54, s[16:19], 0 offen offset:1536
    s_waitcnt vmcnt(4)
    v_mul_f32 v84, 0x3a800000, v84
    v_mul_f32 v85, 0x3a800000, v85
    v_fma_f32 v85, -v84, v84, v85
    v_max_f32 v85, 0, v85
    v_cvt_pk_bf16_f32 v3, v84, v85
    v_lshlrev_b32 v84, 16, v3
    v_and_b32 v85, 0xffff0000, v3
    v_add_f32 v85, 0x3727c5ac, v85
    v_cvt_pk_bf16_f32 v85, v85, v85
    v_lshlrev_b32 v85, 16, v85
    v_sqrt_f32 v85, v85
    s_nop 0
    v_cvt_pk_bf16_f32 v85, v85, v85
    v_lshlrev_b32 v85, 16, v85
    v_rcp_f32 v85, v85
    s_nop 0
    v_lshlrev_b32 v56, 16, v80
    v_lshlrev_b32 v58, 16, v81
    v_lshlrev_b32 v60, 16, v82
    v_lshlrev_b32 v62, 16, v83
    v_and_b32 v57, 0xffff0000, v80
    v_and_b32 v59, 0xffff0000, v81
    v_and_b32 v61, 0xffff0000, v82
    v_and_b32 v63, 0xffff0000, v83
    v_sub_f32 v56, v56, v84
    v_sub_f32 v58, v58, v84
    v_sub_f32 v60, v60, v84
    v_sub_f32 v62, v62, v84
    v_sub_f32 v57, v57, v84
    v_sub_f32 v59, v59, v84
    v_sub_f32 v61, v61, v84
    v_sub_f32 v63, v63, v84
    v_cvt_pk_bf16_f32 v57, v56, v57
    v_cvt_pk_bf16_f32 v59, v58, v59
    v_cvt_pk_bf16_f32 v61, v60, v61
    v_cvt_pk_bf16_f32 v63, v62, v63
    v_lshlrev_b32 v56, 16, v57
    v_lshlrev_b32 v58, 16, v59
    v_lshlrev_b32 v60, 16, v61
    v_lshlrev_b32 v62, 16, v63
    v_and_b32 v57, 0xffff0000, v57
    v_and_b32 v59, 0xffff0000, v59
    v_and_b32 v61, 0xffff0000, v61
    v_and_b32 v63, 0xffff0000, v63
    v_mul_f32 v56, v56, v85
    v_mul_f32 v58, v58, v85
    v_mul_f32 v60, v60, v85
    v_mul_f32 v62, v62, v85
    v_mul_f32 v57, v57, v85
    v_mul_f32 v59, v59, v85
    v_mul_f32 v61, v61, v85
    v_mul_f32 v63, v63, v85
    v_cvt_pk_bf16_f32 v88, v56, v57
    v_cvt_pk_bf16_f32 v89, v58, v59
    v_cvt_pk_bf16_f32 v90, v60, v61
    v_cvt_pk_bf16_f32 v91, v62, v63
    v_lshlrev_b32 v3, 4, v0
    v_add_u32 v4, 98304, v3
    ds_write_b128 v4, v[88:91]
    s_cmp_eq_u32 s2, 0
    s_cselect_b32 s43, 0, 0x40000000
    s_add_u32 s40, s43, 4096
    s_add_u32 s7, s43, 8192
    buffer_store_dwordx4 v[88:91], v3, s[32:35], s40 offen
    buffer_store_dwordx4 v[80:83], v3, s[32:35], s7 offen
    v_mov_b32 v4, 0
    buffer_store_dwordx2 v[72:73], v4, s[32:35], s43 offen
    v_bfe_u32 v3, v2, 2, 3
    v_lshrrev_b32 v4, 5, v2
    v_lshl_add_u32 v3, v4, 4, v3
    v_lshlrev_b32 v3, 5, v3
    v_and_b32 v5, 3, v2
    v_lshl_add_u32 v3, v5, 3, v3
    v_add_u32 v56, s42, v3
    v_lshlrev_b32 v4, 5, v4
    v_bfe_u32 v5, v2, 4, 1
    v_lshl_add_u32 v4, v5, 3, v4
    v_and_b32 v5, 1, v2
    v_lshl_add_u32 v4, v5, 11, v4
    s_lshl_b32 s40, s3, 9
    s_add_u32 s40, s40, 98304
    v_add_u32 v57, s40, v4
    ds_read_b64_tr_b16 v[8:9], v56 offset:0
    ds_read_b64_tr_b16 v[10:11], v56 offset:256
    ds_read_b64_tr_b16 v[12:13], v56 offset:1024
    ds_read_b64_tr_b16 v[14:15], v56 offset:1280
    ds_read_b64_tr_b16 v[16:17], v56 offset:2048
    ds_read_b64_tr_b16 v[18:19], v56 offset:2304
    ds_read_b64_tr_b16 v[20:21], v56 offset:3072
    ds_read_b64_tr_b16 v[22:23], v56 offset:3328
    s_waitcnt lgkmcnt(4)
    ds_read_b64_tr_b16 v[24:25], v56 offset:4096
    ds_read_b64_tr_b16 v[26:27], v56 offset:4352
    ds_read_b64_tr_b16 v[28:29], v56 offset:5120
    ds_read_b64_tr_b16 v[30:31], v56 offset:5376
    ds_read_b64_tr_b16 v[32:33], v56 offset:6144
    ds_read_b64_tr_b16 v[34:35], v56 offset:6400
    ds_read_b64_tr_b16 v[36:37], v56 offset:7168
    ds_read_b64_tr_b16 v[38:39], v56 offset:7424
    s_waitcnt lgkmcnt(4)
    ds_read_b64_tr_b16 v[92:93], v56 offset:32768
    ds_read_b64_tr_b16 v[94:95], v56 offset:33024
    ds_read_b64_tr_b16 v[96:97], v56 offset:33792
    ds_read_b64_tr_b16 v[98:99], v56 offset:34048
    ds_read_b64_tr_b16 v[100:101], v56 offset:34816
    ds_read_b64_tr_b16 v[102:103], v56 offset:35072
    ds_read_b64_tr_b16 v[104:105], v56 offset:35840
    ds_read_b64_tr_b16 v[106:107], v56 offset:36096
    s_waitcnt lgkmcnt(4)
    ds_read_b64_tr_b16 v[108:109], v56 offset:36864
    ds_read_b64_tr_b16 v[110:111], v56 offset:37120
    ds_read_b64_tr_b16 v[112:113], v56 offset:37888
    ds_read_b64_tr_b16 v[114:115], v56 offset:38144
    ds_read_b64_tr_b16 v[116:117], v56 offset:38912
    ds_read_b64_tr_b16 v[118:119], v56 offset:39168
    ds_read_b64_tr_b16 v[120:121], v56 offset:39936
    ds_read_b64_tr_b16 v[122:123], v56 offset:40192
    s_waitcnt lgkmcnt(4)
    s_waitcnt vmcnt(0) lgkmcnt(0)
    s_barrier
    ds_read_b64 v[60:61], v57 offset:0
    ds_read_b64 v[62:63], v57 offset:16
    ds_read_b64 v[64:65], v57 offset:64
    ds_read_b64 v[66:67], v57 offset:80
    ds_read_b64 v[68:69], v57 offset:128
    ds_read_b64 v[70:71], v57 offset:144
    ds_read_b64 v[72:73], v57 offset:192
    ds_read_b64 v[74:75], v57 offset:208
    s_waitcnt lgkmcnt(4)
    ds_read_b64 v[76:77], v57 offset:256
    ds_read_b64 v[78:79], v57 offset:272
    ds_read_b64 v[80:81], v57 offset:320
    ds_read_b64 v[82:83], v57 offset:336
    ds_read_b64 v[84:85], v57 offset:384
    ds_read_b64 v[86:87], v57 offset:400
    ds_read_b64 v[88:89], v57 offset:448
    ds_read_b64 v[90:91], v57 offset:464
    s_waitcnt lgkmcnt(0)
    v_mfma_f32_16x16x32_bf16 v[40:43], v[8:11], v[60:63], 0
    v_mfma_f32_16x16x32_bf16 v[44:47], v[92:95], v[60:63], 0
    v_mfma_f32_16x16x32_bf16 v[40:43], v[12:15], v[64:67], v[40:43]
    v_mfma_f32_16x16x32_bf16 v[44:47], v[96:99], v[64:67], v[44:47]
    v_mfma_f32_16x16x32_bf16 v[40:43], v[16:19], v[68:71], v[40:43]
    v_mfma_f32_16x16x32_bf16 v[44:47], v[100:103], v[68:71], v[44:47]
    v_mfma_f32_16x16x32_bf16 v[40:43], v[20:23], v[72:75], v[40:43]
    v_mfma_f32_16x16x32_bf16 v[44:47], v[104:107], v[72:75], v[44:47]
    v_mfma_f32_16x16x32_bf16 v[40:43], v[24:27], v[76:79], v[40:43]
    v_mfma_f32_16x16x32_bf16 v[44:47], v[108:111], v[76:79], v[44:47]
    v_mfma_f32_16x16x32_bf16 v[40:43], v[28:31], v[80:83], v[40:43]
    v_mfma_f32_16x16x32_bf16 v[44:47], v[112:115], v[80:83], v[44:47]
    v_mfma_f32_16x16x32_bf16 v[40:43], v[32:35], v[84:87], v[40:43]
    v_mfma_f32_16x16x32_bf16 v[44:47], v[116:119], v[84:87], v[44:47]
    v_mfma_f32_16x16x32_bf16 v[40:43], v[36:39], v[88:91], v[40:43]
    v_mfma_f32_16x16x32_bf16 v[44:47], v[120:123], v[88:91], v[44:47]
    v_lshlrev_b32 v3, 4, v0
    v_add_u32 v3, 102464, v3
    v_lshlrev_b32 v4, 4, v2
    v_add_u32 v4, 102464, v4
    v_lshrrev_b32 v5, 2, v2
    v_lshlrev_b32 v5, 6, v5
    v_and_b32 v6, 3, v2
    v_lshl_add_u32 v5, v6, 3, v5
    s_add_u32 s40, s42, 65536
    v_add_u32 v58, s40, v5
    ds_write_b128 v3, v[40:43]
    ds_write_b128 v3, v[44:47] offset:4096
    ds_read_b64_tr_b16 v[8:9], v58 offset:0
    ds_read_b64_tr_b16 v[10:11], v58 offset:32
    ds_read_b64_tr_b16 v[12:13], v58 offset:1024
    ds_read_b64_tr_b16 v[14:15], v58 offset:1056
    ds_read_b64_tr_b16 v[16:17], v58 offset:2048
    ds_read_b64_tr_b16 v[18:19], v58 offset:2080
    ds_read_b64_tr_b16 v[20:21], v58 offset:3072
    ds_read_b64_tr_b16 v[22:23], v58 offset:3104
    ds_read_b64_tr_b16 v[24:25], v58 offset:4096
    ds_read_b64_tr_b16 v[26:27], v58 offset:4128
    ds_read_b64_tr_b16 v[28:29], v58 offset:5120
    ds_read_b64_tr_b16 v[30:31], v58 offset:5152
    s_waitcnt lgkmcnt(0)
    s_barrier
    ds_read_b64_tr_b16 v[32:33], v58 offset:6144
    ds_read_b64_tr_b16 v[34:35], v58 offset:6176
    ds_read_b64_tr_b16 v[36:37], v58 offset:7168
    ds_read_b64_tr_b16 v[38:39], v58 offset:7200
    ds_read_b128 v[60:63], v4 offset:0
    ds_read_b128 v[76:79], v4 offset:4096
    ds_read_b128 v[64:67], v4 offset:1024
    ds_read_b128 v[80:83], v4 offset:5120
    ds_read_b128 v[68:71], v4 offset:2048
    ds_read_b128 v[84:87], v4 offset:6144
    ds_read_b128 v[72:75], v4 offset:3072
    ds_read_b128 v[88:91], v4 offset:7168
    s_waitcnt lgkmcnt(0)
    v_add_f32 v60, v60, v64
    v_add_f32 v61, v61, v65
    v_add_f32 v62, v62, v66
    v_add_f32 v63, v63, v67
    v_add_f32 v68, v68, v72
    v_add_f32 v69, v69, v73
    v_add_f32 v70, v70, v74
    v_add_f32 v71, v71, v75
    v_add_f32 v76, v76, v80
    v_add_f32 v77, v77, v81
    v_add_f32 v78, v78, v82
    v_add_f32 v79, v79, v83
    v_add_f32 v84, v84, v88
    v_add_f32 v85, v85, v89
    v_add_f32 v86, v86, v90
    v_add_f32 v87, v87, v91
    v_add_f32 v60, v60, v68
    v_add_f32 v61, v61, v69
    v_add_f32 v62, v62, v70
    v_add_f32 v63, v63, v71
    v_add_f32 v76, v76, v84
    v_add_f32 v77, v77, v85
    v_add_f32 v78, v78, v86
    v_add_f32 v79, v79, v87
    v_cvt_pk_bf16_f32 v76, v60, v76
    v_cvt_pk_bf16_f32 v77, v61, v77
    v_cvt_pk_bf16_f32 v78, v62, v78
    v_cvt_pk_bf16_f32 v79, v63, v79
    v_lshlrev_b32 v60, 16, v76
    v_lshlrev_b32 v61, 16, v77
    v_lshlrev_b32 v62, 16, v78
    v_lshlrev_b32 v63, 16, v79
    v_and_b32 v76, 0xffff0000, v76
    v_and_b32 v77, 0xffff0000, v77
    v_and_b32 v78, 0xffff0000, v78
    v_and_b32 v79, 0xffff0000, v79
    v_mul_f32 v92, 0xbfb8aa3b, v60
    v_mul_f32 v93, 0xbfb8aa3b, v61
    v_mul_f32 v94, 0xbfb8aa3b, v62
    v_mul_f32 v95, 0xbfb8aa3b, v63
    v_exp_f32 v92, v92
    v_exp_f32 v93, v93
    v_exp_f32 v94, v94
    v_exp_f32 v95, v95
    v_add_f32 v92, 1.0, v92
    v_add_f32 v93, 1.0, v93
    v_add_f32 v94, 1.0, v94
    v_add_f32 v95, 1.0, v95
    v_rcp_f32 v92, v92
    v_rcp_f32 v93, v93
    v_rcp_f32 v94, v94
    v_rcp_f32 v95, v95
    v_mul_f32 v60, v60, v92
    v_mul_f32 v61, v61, v93
    v_mul_f32 v62, v62, v94
    v_mul_f32 v63, v63, v95
    v_cvt_pk_bf16_f32 v60, v60, v60
    v_cvt_pk_bf16_f32 v61, v61, v61
    v_cvt_pk_bf16_f32 v62, v62, v62
    v_cvt_pk_bf16_f32 v63, v63, v63
    v_lshlrev_b32 v60, 16, v60
    v_lshlrev_b32 v61, 16, v61
    v_lshlrev_b32 v62, 16, v62
    v_lshlrev_b32 v63, 16, v63
    v_mul_f32 v60, v60, v76
    v_mul_f32 v61, v61, v77
    v_mul_f32 v62, v62, v78
    v_mul_f32 v63, v63, v79
    v_cvt_pk_bf16_f32 v40, v60, v61
    v_cvt_pk_bf16_f32 v41, v62, v63
    v_and_b32 v3, 15, v2
    v_lshlrev_b32 v4, 12, v3
    v_lshrrev_b32 v5, 4, v2
    v_lshl_add_u32 v4, v5, 4, v4
    v_cmp_gt_u32 vcc, 2, v3
    v_mov_b32 v5, 0x40000000
    s_lshl_b32 s40, s4, 13
    s_lshl_b32 s7, s3, 10
    v_cndmask_b32 v4, v5, v4, vcc
    s_add_u32 s40, s40, s7
    v_mfma_f32_16x16x16_bf16 v[60:63], v[8:9], v[40:41], 0
    v_mfma_f32_16x16x16_bf16 v[64:67], v[10:11], v[40:41], 0
    v_mfma_f32_16x16x16_bf16 v[68:71], v[12:13], v[40:41], 0
    v_mfma_f32_16x16x16_bf16 v[72:75], v[14:15], v[40:41], 0
    v_mfma_f32_16x16x16_bf16 v[76:79], v[16:17], v[40:41], 0
    v_mfma_f32_16x16x16_bf16 v[80:83], v[18:19], v[40:41], 0
    v_mfma_f32_16x16x16_bf16 v[84:87], v[20:21], v[40:41], 0
    v_mfma_f32_16x16x16_bf16 v[88:91], v[22:23], v[40:41], 0
    v_mfma_f32_16x16x16_bf16 v[92:95], v[24:25], v[40:41], 0
    v_mfma_f32_16x16x16_bf16 v[96:99], v[26:27], v[40:41], 0
    v_mfma_f32_16x16x16_bf16 v[100:103], v[28:29], v[40:41], 0
    v_mfma_f32_16x16x16_bf16 v[104:107], v[30:31], v[40:41], 0
    v_mfma_f32_16x16x16_bf16 v[108:111], v[32:33], v[40:41], 0
    v_mfma_f32_16x16x16_bf16 v[112:115], v[34:35], v[40:41], 0
    v_mfma_f32_16x16x16_bf16 v[116:119], v[36:37], v[40:41], 0
    v_mfma_f32_16x16x16_bf16 v[120:123], v[38:39], v[40:41], 0
    s_nop 7
    buffer_store_dwordx4 v[60:63], v4, s[36:39], s40 offen offset:0
    buffer_store_dwordx4 v[64:67], v4, s[36:39], s40 offen offset:64
    buffer_store_dwordx4 v[68:71], v4, s[36:39], s40 offen offset:128
    buffer_store_dwordx4 v[72:75], v4, s[36:39], s40 offen offset:192
    buffer_store_dwordx4 v[76:79], v4, s[36:39], s40 offen offset:256
    buffer_store_dwordx4 v[80:83], v4, s[36:39], s40 offen offset:320
    buffer_store_dwordx4 v[84:87], v4, s[36:39], s40 offen offset:384
    buffer_store_dwordx4 v[88:91], v4, s[36:39], s40 offen offset:448
    buffer_store_dwordx4 v[92:95], v4, s[36:39], s40 offen offset:512
    buffer_store_dwordx4 v[96:99], v4, s[36:39], s40 offen offset:576
    buffer_store_dwordx4 v[100:103], v4, s[36:39], s40 offen offset:640
    buffer_store_dwordx4 v[104:107], v4, s[36:39], s40 offen offset:704
    buffer_store_dwordx4 v[108:111], v4, s[36:39], s40 offen offset:768
    buffer_store_dwordx4 v[112:115], v4, s[36:39], s40 offen offset:832
    buffer_store_dwordx4 v[116:119], v4, s[36:39], s40 offen offset:896
    buffer_store_dwordx4 v[120:123], v4, s[36:39], s40 offen offset:960
    s_endpgm
k4_simple:
    buffer_load_dword v52, v3, s[12:15], 0 offen
    buffer_load_dword v53, v3, s[12:15], s41 offen
    buffer_load_dwordx4 v[36:39], v54, s[8:11], 0 offen offset:0
    buffer_load_dwordx4 v[40:43], v54, s[8:11], 0 offen offset:512
    buffer_load_dwordx4 v[44:47], v54, s[8:11], 0 offen offset:1024
    buffer_load_dwordx4 v[48:51], v54, s[8:11], 0 offen offset:1536
    s_waitcnt vmcnt(0)
    v_mul_f32 v52, 0x3a800000, v52
    v_mul_f32 v53, 0x3a800000, v53
    v_fma_f32 v53, -v52, v52, v53
    v_max_f32 v53, 0, v53
    v_cvt_pk_bf16_f32 v3, v52, v53
    v_lshlrev_b32 v52, 16, v3
    v_and_b32 v53, 0xffff0000, v3
    v_add_f32 v53, 0x3727c5ac, v53
    v_cvt_pk_bf16_f32 v53, v53, v53
    v_lshlrev_b32 v53, 16, v53
    v_sqrt_f32 v53, v53
    s_nop 0
    v_cvt_pk_bf16_f32 v53, v53, v53
    v_lshlrev_b32 v53, 16, v53
    v_rcp_f32 v53, v53
    s_nop 0
    v_lshlrev_b32 v56, 16, v36
    v_lshlrev_b32 v60, 16, v37
    v_lshlrev_b32 v64, 16, v38
    v_lshlrev_b32 v68, 16, v39
    v_and_b32 v57, 0xffff0000, v36
    v_and_b32 v61, 0xffff0000, v37
    v_and_b32 v65, 0xffff0000, v38
    v_and_b32 v69, 0xffff0000, v39
    v_sub_f32 v56, v56, v52
    v_sub_f32 v60, v60, v52
    v_sub_f32 v64, v64, v52
    v_sub_f32 v68, v68, v52
    v_sub_f32 v57, v57, v52
    v_sub_f32 v61, v61, v52
    v_sub_f32 v65, v65, v52
    v_sub_f32 v69, v69, v52
    v_cvt_pk_bf16_f32 v57, v56, v57
    v_cvt_pk_bf16_f32 v61, v60, v61
    v_cvt_pk_bf16_f32 v65, v64, v65
    v_cvt_pk_bf16_f32 v69, v68, v69
    v_lshlrev_b32 v56, 16, v57
    v_lshlrev_b32 v60, 16, v61
    v_lshlrev_b32 v64, 16, v65
    v_lshlrev_b32 v68, 16, v69
    v_and_b32 v57, 0xffff0000, v57
    v_and_b32 v61, 0xffff0000, v61
    v_and_b32 v65, 0xffff0000, v65
    v_and_b32 v69, 0xffff0000, v69
    v_mul_f32 v56, v56, v53
    v_mul_f32 v60, v60, v53
    v_mul_f32 v64, v64, v53
    v_mul_f32 v68, v68, v53
    v_mul_f32 v57, v57, v53
    v_mul_f32 v61, v61, v53
    v_mul_f32 v65, v65, v53
    v_mul_f32 v69, v69, v53
    v_cvt_pk_bf16_f32 v58, v56, v57
    v_cvt_pk_bf16_f32 v62, v60, v61
    v_cvt_pk_bf16_f32 v66, v64, v65
    v_cvt_pk_bf16_f32 v70, v68, v69
    v_lshlrev_b32 v56, 16, v58
    v_lshlrev_b32 v60, 16, v62
    v_lshlrev_b32 v64, 16, v66
    v_lshlrev_b32 v68, 16, v70
    v_and_b32 v57, 0xffff0000, v58
    v_and_b32 v61, 0xffff0000, v62
    v_and_b32 v65, 0xffff0000, v66
    v_and_b32 v69, 0xffff0000, v70
    v_lshlrev_b32 v58, 16, v36
    v_lshlrev_b32 v62, 16, v37
    v_lshlrev_b32 v66, 16, v38
    v_lshlrev_b32 v70, 16, v39
    v_and_b32 v59, 0xffff0000, v36
    v_and_b32 v63, 0xffff0000, v37
    v_and_b32 v67, 0xffff0000, v38
    v_and_b32 v71, 0xffff0000, v39
    v_add_f32 v56, v56, v58
    v_add_f32 v60, v60, v62
    v_add_f32 v64, v64, v66
    v_add_f32 v68, v68, v70
    v_add_f32 v57, v57, v59
    v_add_f32 v61, v61, v63
    v_add_f32 v65, v65, v67
    v_add_f32 v69, v69, v71
    v_cvt_pk_bf16_f32 v36, v56, v57
    v_cvt_pk_bf16_f32 v37, v60, v61
    v_cvt_pk_bf16_f32 v38, v64, v65
    v_cvt_pk_bf16_f32 v39, v68, v69
    buffer_store_dwordx4 v[36:39], v54, s[16:19], 0 offen offset:0
    v_lshlrev_b32 v56, 16, v40
    v_lshlrev_b32 v60, 16, v41
    v_lshlrev_b32 v64, 16, v42
    v_lshlrev_b32 v68, 16, v43
    v_and_b32 v57, 0xffff0000, v40
    v_and_b32 v61, 0xffff0000, v41
    v_and_b32 v65, 0xffff0000, v42
    v_and_b32 v69, 0xffff0000, v43
    v_sub_f32 v56, v56, v52
    v_sub_f32 v60, v60, v52
    v_sub_f32 v64, v64, v52
    v_sub_f32 v68, v68, v52
    v_sub_f32 v57, v57, v52
    v_sub_f32 v61, v61, v52
    v_sub_f32 v65, v65, v52
    v_sub_f32 v69, v69, v52
    v_cvt_pk_bf16_f32 v57, v56, v57
    v_cvt_pk_bf16_f32 v61, v60, v61
    v_cvt_pk_bf16_f32 v65, v64, v65
    v_cvt_pk_bf16_f32 v69, v68, v69
    v_lshlrev_b32 v56, 16, v57
    v_lshlrev_b32 v60, 16, v61
    v_lshlrev_b32 v64, 16, v65
    v_lshlrev_b32 v68, 16, v69
    v_and_b32 v57, 0xffff0000, v57
    v_and_b32 v61, 0xffff0000, v61
    v_and_b32 v65, 0xffff0000, v65
    v_and_b32 v69, 0xffff0000, v69
    v_mul_f32 v56, v56, v53
    v_mul_f32 v60, v60, v53
    v_mul_f32 v64, v64, v53
    v_mul_f32 v68, v68, v53
    v_mul_f32 v57, v57, v53
    v_mul_f32 v61, v61, v53
    v_mul_f32 v65, v65, v53
    v_mul_f32 v69, v69, v53
    v_cvt_pk_bf16_f32 v58, v56, v57
    v_cvt_pk_bf16_f32 v62, v60, v61
    v_cvt_pk_bf16_f32 v66, v64, v65
    v_cvt_pk_bf16_f32 v70, v68, v69
    v_lshlrev_b32 v56, 16, v58
    v_lshlrev_b32 v60, 16, v62
    v_lshlrev_b32 v64, 16, v66
    v_lshlrev_b32 v68, 16, v70
    v_and_b32 v57, 0xffff0000, v58
    v_and_b32 v61, 0xffff0000, v62
    v_and_b32 v65, 0xffff0000, v66
    v_and_b32 v69, 0xffff0000, v70
    v_lshlrev_b32 v58, 16, v40
    v_lshlrev_b32 v62, 16, v41
    v_lshlrev_b32 v66, 16, v42
    v_lshlrev_b32 v70, 16, v43
    v_and_b32 v59, 0xffff0000, v40
    v_and_b32 v63, 0xffff0000, v41
    v_and_b32 v67, 0xffff0000, v42
    v_and_b32 v71, 0xffff0000, v43
    v_add_f32 v56, v56, v58
    v_add_f32 v60, v60, v62
    v_add_f32 v64, v64, v66
    v_add_f32 v68, v68, v70
    v_add_f32 v57, v57, v59
    v_add_f32 v61, v61, v63
    v_add_f32 v65, v65, v67
    v_add_f32 v69, v69, v71
    v_cvt_pk_bf16_f32 v40, v56, v57
    v_cvt_pk_bf16_f32 v41, v60, v61
    v_cvt_pk_bf16_f32 v42, v64, v65
    v_cvt_pk_bf16_f32 v43, v68, v69
    buffer_store_dwordx4 v[40:43], v54, s[16:19], 0 offen offset:512
    v_lshlrev_b32 v56, 16, v44
    v_lshlrev_b32 v60, 16, v45
    v_lshlrev_b32 v64, 16, v46
    v_lshlrev_b32 v68, 16, v47
    v_and_b32 v57, 0xffff0000, v44
    v_and_b32 v61, 0xffff0000, v45
    v_and_b32 v65, 0xffff0000, v46
    v_and_b32 v69, 0xffff0000, v47
    v_sub_f32 v56, v56, v52
    v_sub_f32 v60, v60, v52
    v_sub_f32 v64, v64, v52
    v_sub_f32 v68, v68, v52
    v_sub_f32 v57, v57, v52
    v_sub_f32 v61, v61, v52
    v_sub_f32 v65, v65, v52
    v_sub_f32 v69, v69, v52
    v_cvt_pk_bf16_f32 v57, v56, v57
    v_cvt_pk_bf16_f32 v61, v60, v61
    v_cvt_pk_bf16_f32 v65, v64, v65
    v_cvt_pk_bf16_f32 v69, v68, v69
    v_lshlrev_b32 v56, 16, v57
    v_lshlrev_b32 v60, 16, v61
    v_lshlrev_b32 v64, 16, v65
    v_lshlrev_b32 v68, 16, v69
    v_and_b32 v57, 0xffff0000, v57
    v_and_b32 v61, 0xffff0000, v61
    v_and_b32 v65, 0xffff0000, v65
    v_and_b32 v69, 0xffff0000, v69
    v_mul_f32 v56, v56, v53
    v_mul_f32 v60, v60, v53
    v_mul_f32 v64, v64, v53
    v_mul_f32 v68, v68, v53
    v_mul_f32 v57, v57, v53
    v_mul_f32 v61, v61, v53
    v_mul_f32 v65, v65, v53
    v_mul_f32 v69, v69, v53
    v_cvt_pk_bf16_f32 v58, v56, v57
    v_cvt_pk_bf16_f32 v62, v60, v61
    v_cvt_pk_bf16_f32 v66, v64, v65
    v_cvt_pk_bf16_f32 v70, v68, v69
    v_lshlrev_b32 v56, 16, v58
    v_lshlrev_b32 v60, 16, v62
    v_lshlrev_b32 v64, 16, v66
    v_lshlrev_b32 v68, 16, v70
    v_and_b32 v57, 0xffff0000, v58
    v_and_b32 v61, 0xffff0000, v62
    v_and_b32 v65, 0xffff0000, v66
    v_and_b32 v69, 0xffff0000, v70
    v_lshlrev_b32 v58, 16, v44
    v_lshlrev_b32 v62, 16, v45
    v_lshlrev_b32 v66, 16, v46
    v_lshlrev_b32 v70, 16, v47
    v_and_b32 v59, 0xffff0000, v44
    v_and_b32 v63, 0xffff0000, v45
    v_and_b32 v67, 0xffff0000, v46
    v_and_b32 v71, 0xffff0000, v47
    v_add_f32 v56, v56, v58
    v_add_f32 v60, v60, v62
    v_add_f32 v64, v64, v66
    v_add_f32 v68, v68, v70
    v_add_f32 v57, v57, v59
    v_add_f32 v61, v61, v63
    v_add_f32 v65, v65, v67
    v_add_f32 v69, v69, v71
    v_cvt_pk_bf16_f32 v44, v56, v57
    v_cvt_pk_bf16_f32 v45, v60, v61
    v_cvt_pk_bf16_f32 v46, v64, v65
    v_cvt_pk_bf16_f32 v47, v68, v69
    buffer_store_dwordx4 v[44:47], v54, s[16:19], 0 offen offset:1024
    v_lshlrev_b32 v56, 16, v48
    v_lshlrev_b32 v60, 16, v49
    v_lshlrev_b32 v64, 16, v50
    v_lshlrev_b32 v68, 16, v51
    v_and_b32 v57, 0xffff0000, v48
    v_and_b32 v61, 0xffff0000, v49
    v_and_b32 v65, 0xffff0000, v50
    v_and_b32 v69, 0xffff0000, v51
    v_sub_f32 v56, v56, v52
    v_sub_f32 v60, v60, v52
    v_sub_f32 v64, v64, v52
    v_sub_f32 v68, v68, v52
    v_sub_f32 v57, v57, v52
    v_sub_f32 v61, v61, v52
    v_sub_f32 v65, v65, v52
    v_sub_f32 v69, v69, v52
    v_cvt_pk_bf16_f32 v57, v56, v57
    v_cvt_pk_bf16_f32 v61, v60, v61
    v_cvt_pk_bf16_f32 v65, v64, v65
    v_cvt_pk_bf16_f32 v69, v68, v69
    v_lshlrev_b32 v56, 16, v57
    v_lshlrev_b32 v60, 16, v61
    v_lshlrev_b32 v64, 16, v65
    v_lshlrev_b32 v68, 16, v69
    v_and_b32 v57, 0xffff0000, v57
    v_and_b32 v61, 0xffff0000, v61
    v_and_b32 v65, 0xffff0000, v65
    v_and_b32 v69, 0xffff0000, v69
    v_mul_f32 v56, v56, v53
    v_mul_f32 v60, v60, v53
    v_mul_f32 v64, v64, v53
    v_mul_f32 v68, v68, v53
    v_mul_f32 v57, v57, v53
    v_mul_f32 v61, v61, v53
    v_mul_f32 v65, v65, v53
    v_mul_f32 v69, v69, v53
    v_cvt_pk_bf16_f32 v58, v56, v57
    v_cvt_pk_bf16_f32 v62, v60, v61
    v_cvt_pk_bf16_f32 v66, v64, v65
    v_cvt_pk_bf16_f32 v70, v68, v69
    v_lshlrev_b32 v56, 16, v58
    v_lshlrev_b32 v60, 16, v62
    v_lshlrev_b32 v64, 16, v66
    v_lshlrev_b32 v68, 16, v70
    v_and_b32 v57, 0xffff0000, v58
    v_and_b32 v61, 0xffff0000, v62
    v_and_b32 v65, 0xffff0000, v66
    v_and_b32 v69, 0xffff0000, v70
    v_lshlrev_b32 v58, 16, v48
    v_lshlrev_b32 v62, 16, v49
    v_lshlrev_b32 v66, 16, v50
    v_lshlrev_b32 v70, 16, v51
    v_and_b32 v59, 0xffff0000, v48
    v_and_b32 v63, 0xffff0000, v49
    v_and_b32 v67, 0xffff0000, v50
    v_and_b32 v71, 0xffff0000, v51
    v_add_f32 v56, v56, v58
    v_add_f32 v60, v60, v62
    v_add_f32 v64, v64, v66
    v_add_f32 v68, v68, v70
    v_add_f32 v57, v57, v59
    v_add_f32 v61, v61, v63
    v_add_f32 v65, v65, v67
    v_add_f32 v69, v69, v71
    v_cvt_pk_bf16_f32 v48, v56, v57
    v_cvt_pk_bf16_f32 v49, v60, v61
    v_cvt_pk_bf16_f32 v50, v64, v65
    v_cvt_pk_bf16_f32 v51, v68, v69
    buffer_store_dwordx4 v[48:51], v54, s[16:19], 0 offen offset:1536
k4_done:
    s_endpgm

.globl k5_kernel
.p2align 8
.type k5_kernel,@function
k5_kernel:
    s_cmp_ge_u32 s2, 32
    s_cbranch_scc1 k5_done
    s_load_dwordx2 s[4:5], s[0:1], 88
    s_load_dwordx2 s[6:7], s[0:1], 104
    v_lshrrev_b32 v1, 6, v0
    v_and_b32 v2, 63, v0
    v_readfirstlane_b32 s3, v1
    s_waitcnt lgkmcnt(0)
    s_add_u32 s8, s6, 0x3900000
    s_addc_u32 s9, s7, 0
    s_mov_b32 s10, 0x1c0000
    s_mov_b32 s11, 0x00020000
    s_add_u32 s12, s6, 0x3810000
    s_addc_u32 s13, s7, 0
    s_mov_b32 s14, 0x3000
    s_mov_b32 s15, 0x00020000
    s_mov_b32 s16, s4
    s_mov_b32 s17, s5
    s_mov_b32 s18, 0x400000
    s_mov_b32 s19, 0x00020000
    v_lshrrev_b32 v3, 4, v0
    v_lshlrev_b32 v3, 13, v3
    v_and_b32 v4, 15, v0
    v_lshl_add_u32 v3, v4, 4, v3
    s_lshl_b32 s20, s2, 8
    s_add_u32 s21, s20, 0
    buffer_load_dwordx4 v[16:19], v3, s[8:11], s21 offen
    s_add_u32 s21, s20, 131072
    buffer_load_dwordx4 v[20:23], v3, s[8:11], s21 offen
    s_add_u32 s21, s20, 262144
    buffer_load_dwordx4 v[24:27], v3, s[8:11], s21 offen
    s_add_u32 s21, s20, 393216
    buffer_load_dwordx4 v[28:31], v3, s[8:11], s21 offen
    s_add_u32 s21, s20, 524288
    buffer_load_dwordx4 v[32:35], v3, s[8:11], s21 offen
    s_add_u32 s21, s20, 655360
    buffer_load_dwordx4 v[36:39], v3, s[8:11], s21 offen
    s_add_u32 s21, s20, 786432
    buffer_load_dwordx4 v[40:43], v3, s[8:11], s21 offen
    s_add_u32 s21, s20, 917504
    buffer_load_dwordx4 v[44:47], v3, s[8:11], s21 offen
    s_add_u32 s21, s20, 1048576
    buffer_load_dwordx4 v[48:51], v3, s[8:11], s21 offen
    s_add_u32 s21, s20, 1179648
    buffer_load_dwordx4 v[52:55], v3, s[8:11], s21 offen
    s_add_u32 s21, s20, 1310720
    buffer_load_dwordx4 v[56:59], v3, s[8:11], s21 offen
    s_add_u32 s21, s20, 1441792
    buffer_load_dwordx4 v[60:63], v3, s[8:11], s21 offen
    s_add_u32 s21, s20, 1572864
    buffer_load_dwordx4 v[64:67], v3, s[8:11], s21 offen
    s_add_u32 s21, s20, 1703936
    buffer_load_dwordx4 v[68:71], v3, s[8:11], s21 offen
    v_lshrrev_b32 v5, 4, v2
    v_and_b32 v6, 1, v5
    v_lshrrev_b32 v5, 1, v5
    v_lshl_add_u32 v5, v6, 1, v5
    v_lshl_add_u32 v5, v4, 2, v5
    s_lshl_b32 s22, s2, 6
    v_add_u32 v5, s22, v5
    v_lshlrev_b32 v6, 1, v5
    s_mov_b32 s23, 4096
    s_mov_b32 s24, 8192
    s_lshr_b32 s25, s2, 4
    s_lshl_b32 s25, s25, 2
    v_mov_b32 v7, 0
    buffer_load_ushort v8, v6, s[12:15], s23 offen
    buffer_load_ushort v9, v6, s[12:15], s24 offen
    buffer_load_dword v10, v7, s[12:15], s25 offen
    s_waitcnt vmcnt(15)
    v_add_f32 v16, v16, v20
    v_add_f32 v17, v17, v21
    v_add_f32 v18, v18, v22
    v_add_f32 v19, v19, v23
    s_waitcnt vmcnt(14)
    v_add_f32 v16, v16, v24
    v_add_f32 v17, v17, v25
    v_add_f32 v18, v18, v26
    v_add_f32 v19, v19, v27
    s_waitcnt vmcnt(13)
    v_add_f32 v16, v16, v28
    v_add_f32 v17, v17, v29
    v_add_f32 v18, v18, v30
    v_add_f32 v19, v19, v31
    s_waitcnt vmcnt(12)
    v_add_f32 v16, v16, v32
    v_add_f32 v17, v17, v33
    v_add_f32 v18, v18, v34
    v_add_f32 v19, v19, v35
    s_waitcnt vmcnt(11)
    v_add_f32 v16, v16, v36
    v_add_f32 v17, v17, v37
    v_add_f32 v18, v18, v38
    v_add_f32 v19, v19, v39
    s_waitcnt vmcnt(10)
    v_add_f32 v16, v16, v40
    v_add_f32 v17, v17, v41
    v_add_f32 v18, v18, v42
    v_add_f32 v19, v19, v43
    s_waitcnt vmcnt(9)
    v_add_f32 v16, v16, v44
    v_add_f32 v17, v17, v45
    v_add_f32 v18, v18, v46
    v_add_f32 v19, v19, v47
    s_waitcnt vmcnt(8)
    v_add_f32 v16, v16, v48
    v_add_f32 v17, v17, v49
    v_add_f32 v18, v18, v50
    v_add_f32 v19, v19, v51
    s_waitcnt vmcnt(7)
    v_add_f32 v16, v16, v52
    v_add_f32 v17, v17, v53
    v_add_f32 v18, v18, v54
    v_add_f32 v19, v19, v55
    s_waitcnt vmcnt(6)
    v_add_f32 v16, v16, v56
    v_add_f32 v17, v17, v57
    v_add_f32 v18, v18, v58
    v_add_f32 v19, v19, v59
    s_waitcnt vmcnt(5)
    v_add_f32 v16, v16, v60
    v_add_f32 v17, v17, v61
    v_add_f32 v18, v18, v62
    v_add_f32 v19, v19, v63
    s_waitcnt vmcnt(4)
    v_add_f32 v16, v16, v64
    v_add_f32 v17, v17, v65
    v_add_f32 v18, v18, v66
    v_add_f32 v19, v19, v67
    s_waitcnt vmcnt(3)
    v_add_f32 v16, v16, v68
    v_add_f32 v17, v17, v69
    v_add_f32 v18, v18, v70
    v_add_f32 v19, v19, v71
    s_nop 1
    v_permlane32_swap_b32 v16, v17
    v_permlane32_swap_b32 v18, v19
    s_nop 0
    v_add_f32 v16, v16, v17
    v_add_f32 v18, v18, v19
    s_nop 1
    v_permlane16_swap_b32 v16, v18
    s_nop 0
    v_add_f32 v16, v16, v18
    v_lshlrev_b32 v11, 2, v0
    ds_write_b32 v11, v16
    v_lshlrev_b32 v11, 2, v2
    s_waitcnt lgkmcnt(0)
    s_barrier
    s_cmp_lg_u32 s3, 0
    s_cbranch_scc1 k5_done
    ds_read_b32 v16, v11
    ds_read_b32 v17, v11 offset:256
    ds_read_b32 v18, v11 offset:512
    ds_read_b32 v19, v11 offset:768
    s_waitcnt vmcnt(0)
    v_and_b32 v12, 0xffff0000, v10
    v_not_b32 v13, v12
    v_ashrrev_i32 v13, 31, v13
    v_or_b32 v13, 0x80000000, v13
    v_xor_b32 v12, v12, v13
    v_and_b32 v12, 0xffff0000, v12
    v_mul_f32 v12, 0xbfb8aa3b, v12
    v_exp_f32 v12, v12
    s_nop 0
    v_add_f32 v12, 1.0, v12
    v_rcp_f32 v12, v12
    s_nop 0
    v_cvt_pk_bf16_f32 v12, v12, v12
    v_lshlrev_b32 v12, 16, v12
    v_and_b32 v10, 0xffff, v10
    v_sub_u32 v10, 2047, v10
    v_and_b32 v6, 2047, v6
    v_lshl_add_u32 v6, v10, 11, v6
    v_lshlrev_b32 v8, 16, v8
    v_lshlrev_b32 v9, 16, v9
    s_waitcnt lgkmcnt(0)
    v_add_f32 v16, v16, v17
    v_add_f32 v18, v18, v19
    v_add_f32 v16, v16, v18
    v_cvt_pk_bf16_f32 v16, v16, v16
    v_lshlrev_b32 v16, 16, v16
    v_mul_f32 v16, v16, v12
    v_cvt_pk_bf16_f32 v16, v16, v16
    v_lshlrev_b32 v16, 16, v16
    v_add_f32 v16, v16, v8
    v_cvt_pk_bf16_f32 v16, v16, v16
    v_lshlrev_b32 v16, 16, v16
    v_add_f32 v16, v16, v9
    v_cvt_pk_bf16_f32 v16, v16, v16
    buffer_store_short v16, v6, s[16:19], 0 offen
k5_done:
    s_endpgm

code_end:
.section .rodata,"a"
.p2align 6
.amdhsa_kernel ka_kernel
  .amdhsa_next_free_vgpr 512
  .amdhsa_next_free_sgpr 102
  .amdhsa_accum_offset 256
  .amdhsa_group_segment_fixed_size 0
  .amdhsa_kernarg_size 112
  .amdhsa_user_sgpr_count 2
  .amdhsa_user_sgpr_kernarg_segment_ptr 1
  .amdhsa_system_sgpr_workgroup_id_x 1
  .amdhsa_float_denorm_mode_32 3
.end_amdhsa_kernel

.p2align 6
.amdhsa_kernel k3_kernel
  .amdhsa_next_free_vgpr 512
  .amdhsa_next_free_sgpr 102
  .amdhsa_accum_offset 256
  .amdhsa_group_segment_fixed_size 0
  .amdhsa_kernarg_size 112
  .amdhsa_user_sgpr_count 2
  .amdhsa_user_sgpr_kernarg_segment_ptr 1
  .amdhsa_system_sgpr_workgroup_id_x 1
  .amdhsa_float_denorm_mode_32 3
.end_amdhsa_kernel

.p2align 6
.amdhsa_kernel k4_kernel
  .amdhsa_next_free_vgpr 128
  .amdhsa_next_free_sgpr 102
  .amdhsa_accum_offset 128
  .amdhsa_group_segment_fixed_size 0
  .amdhsa_kernarg_size 112
  .amdhsa_user_sgpr_count 2
  .amdhsa_user_sgpr_kernarg_segment_ptr 1
  .amdhsa_system_sgpr_workgroup_id_x 1
  .amdhsa_float_denorm_mode_32 3
.end_amdhsa_kernel

.p2align 6
.amdhsa_kernel k5_kernel
  .amdhsa_next_free_vgpr 80
  .amdhsa_next_free_sgpr 102
  .amdhsa_accum_offset 80
  .amdhsa_group_segment_fixed_size 0
  .amdhsa_kernarg_size 112
  .amdhsa_user_sgpr_count 2
  .amdhsa_user_sgpr_kernarg_segment_ptr 1
  .amdhsa_system_sgpr_workgroup_id_x 1
  .amdhsa_float_denorm_mode_32 3
.end_amdhsa_kernel
```

```asm
; @launch kernel=ka_kernel grid=(256,1,1) block=(256,1,1) lds=163840
; @launch kernel=kb_kernel grid=(256,1,1) block=(256,1,1) lds=131072
; @launch kernel=k4_kernel grid=(256,1,1) block=(512,1,1) lds=110848
; @launch kernel=k5_kernel grid=(32,1,1) block=(256,1,1) lds=1024
.amdgcn_target "amdgcn-amd-amdhsa--gfx950"
.text
.globl ka_kernel
.p2align 8
.type ka_kernel,@function
ka_kernel:
    s_cmp_ge_u32 s2, 256
    s_cbranch_scc1 ka_done
    s_load_dwordx8 s[64:71], s[0:1], 0
    s_load_dwordx4 s[72:75], s[0:1], 32
    s_load_dwordx4 s[76:79], s[0:1], 64
    s_load_dwordx8 s[80:87], s[0:1], 80
    v_lshrrev_b32 v1, 6, v0
    v_and_b32 v2, 63, v0
    v_readfirstlane_b32 s3, v1
    v_mov_b32 v253, v0
    s_and_b32 s4, s2, 7
    s_lshl_b32 s4, s4, 2
    s_lshr_b32 s24, s2, 3
    s_and_b32 s24, s24, 3
    s_add_u32 s4, s4, s24
    s_lshr_b32 s5, s2, 5
    s_lshl2_add_u32 s6, s5, s3
    s_getpc_b64 s[56:57]
ka_pc:
    s_mov_b32 s58, code_end-ka_pc
    s_mov_b32 s59, 0x00020000
    s_lshr_b32 s24, s2, 3
    s_lshl2_add_u32 s24, s24, s3
    s_lshl_b32 s24, s24, 13
    v_lshlrev_b32 v3, 7, v2
    buffer_load_dword v252, v3, s[56:59], s24 offen
    v_lshrrev_b32 v8, 3, v2
    v_and_b32 v9, 7, v2
    s_lshr_b32 s24, s3, 1
    s_lshl_b32 s24, s24, 5
    s_and_b32 s25, s3, 1
    s_lshl_b32 s26, s25, 3
    s_add_u32 s24, s24, s26
    v_add_u32 v4, s24, v8
    v_lshlrev_b32 v4, 10, v4
    v_lshrrev_b32 v5, 1, v8
    v_xor_b32 v5, v9, v5
    v_lshl_add_u32 v232, v5, 4, v4
    v_xor_b32 v5, 4, v5
    v_lshl_add_u32 v233, v5, 4, v4
    v_add_u32 v233, 15360, v233
    s_lshl_b32 s24, s4, 8
    s_lshl_b32 s26, s25, 7
    s_add_u32 s24, s24, s26
    v_lshlrev_b32 v4, 13, v8
    v_add_u32 v4, s24, v4
    v_bfe_u32 v5, v8, 1, 1
    v_xor_b32 v5, v9, v5
    v_lshl_add_u32 v234, v5, 4, v4
    v_xor_b32 v5, 4, v5
    v_lshl_add_u32 v235, v5, 4, v4
    v_add_u32 v235, 64512, v235
    s_lshl_b32 s34, s3, 11
    s_mul_i32 s35, s3, 24576
    s_add_u32 s35, s35, 65536
    s_lshl_b32 s32, s5, 18
    s_waitcnt lgkmcnt(0)
    s_cmp_lt_u32 s3, 2
    s_cselect_b32 s48, s70, s72
    s_cselect_b32 s49, s71, s73
    s_mov_b32 s50, 0x400000
    s_mov_b32 s51, 0x00020000
    s_mov_b32 s44, s66
    s_mov_b32 s45, s67
    s_mov_b32 s46, 0x200000
    s_mov_b32 s47, 0x00020000
    s_mov_b32 s52, s64
    s_mov_b32 s53, s65
    s_mov_b32 s54, 0x400000
    s_mov_b32 s55, 0x00020000
    s_mov_b32 s12, s68
    s_mov_b32 s13, s69
    s_mov_b32 s14, 0x800000
    s_mov_b32 s15, 0x00020000
    s_add_u32 s16, s86, 0x400000
    s_addc_u32 s17, s87, 0
    s_mov_b32 s18, 0x2000000
    s_mov_b32 s19, 0x00020000
    s_mov_b32 s8, s86
    s_mov_b32 s9, s87
    s_mov_b32 s10, 0x400000
    s_mov_b32 s11, 0x00020000
    s_add_u32 s56, s86, 0x3800000
    s_addc_u32 s57, s87, 0
    s_mov_b32 s58, 0x6040
    s_mov_b32 s59, 0x00020000
    s_add_u32 s20, s86, 0x2400000
    s_addc_u32 s21, s87, 0
    s_mov_b32 s22, 0x1000000
    s_mov_b32 s23, 0x00020000
    s_mov_b32 s88, s84
    s_mov_b32 s89, s85
    s_mov_b32 s90, 0x100
    s_mov_b32 s91, 0x00020000
    s_cmp_lt_u32 s3, 2
    s_cselect_b32 s60, s74, s80
    s_cselect_b32 s61, s75, s81
    s_mov_b32 s62, 0x700000
    s_cselect_b32 s62, 0x800000, s62
    s_mov_b32 s63, 0x00020000
    s_cselect_b32 s41, s76, s78
    s_cselect_b32 s42, s77, s79
    s_mov_b32 s0, s74
    s_mov_b32 s1, s75
    s_and_b32 s7, s4, 3
    s_lshl1_add_u32 s7, s7, s5
    s_and_b32 s7, s7, 7
    s_add_u32 s80, s7, 0
    s_and_b32 s80, s80, 7
    s_lshl_b32 s80, s80, 7
    s_add_u32 s80, s80, s32
    s_add_u32 s81, s7, 1
    s_and_b32 s81, s81, 7
    s_lshl_b32 s81, s81, 7
    s_add_u32 s81, s81, s32
    s_add_u32 s82, s7, 2
    s_and_b32 s82, s82, 7
    s_lshl_b32 s82, s82, 7
    s_add_u32 s82, s82, s32
    s_add_u32 s83, s7, 3
    s_and_b32 s83, s83, 7
    s_lshl_b32 s83, s83, 7
    s_add_u32 s83, s83, s32
    s_add_u32 s84, s7, 4
    s_and_b32 s84, s84, 7
    s_lshl_b32 s84, s84, 7
    s_add_u32 s84, s84, s32
    s_add_u32 s85, s7, 5
    s_and_b32 s85, s85, 7
    s_lshl_b32 s85, s85, 7
    s_add_u32 s85, s85, s32
    s_add_u32 s86, s7, 6
    s_and_b32 s86, s86, 7
    s_lshl_b32 s86, s86, 7
    s_add_u32 s86, s86, s32
    s_add_u32 s87, s7, 7
    s_and_b32 s87, s87, 7
    s_lshl_b32 s87, s87, 7
    s_add_u32 s87, s87, s32
    s_add_u32 m0, s35, 0
    s_and_b32 s33, s80, 1023
    s_lshl_b32 s33, s33, 12
    buffer_load_dwordx4 v234, s[48:51], s33 offen lds
    buffer_load_dwordx4 v235, s[48:51], s33 offen offset:1024 lds
    s_add_u32 m0, s35, 2048
    s_add_u32 s33, s33, 131072
    buffer_load_dwordx4 v234, s[48:51], s33 offen lds
    buffer_load_dwordx4 v235, s[48:51], s33 offen offset:1024 lds
    s_add_u32 m0, s35, 4096
    s_add_u32 s33, s33, 131072
    buffer_load_dwordx4 v234, s[48:51], s33 offen lds
    buffer_load_dwordx4 v235, s[48:51], s33 offen offset:1024 lds
    s_add_u32 m0, s35, 6144
    s_add_u32 s33, s33, 131072
    buffer_load_dwordx4 v234, s[48:51], s33 offen lds
    buffer_load_dwordx4 v235, s[48:51], s33 offen offset:1024 lds
    s_add_u32 m0, s34, 0
    s_add_u32 s37, s80, 0
    buffer_load_dwordx4 v232, s[44:47], s37 offen lds
    buffer_load_dwordx4 v233, s[44:47], s37 offen offset:1024 lds
    s_add_u32 m0, s34, 8192
    s_add_u32 s37, s81, 0
    buffer_load_dwordx4 v232, s[44:47], s37 offen lds
    buffer_load_dwordx4 v233, s[44:47], s37 offen offset:1024 lds
    s_add_u32 m0, s35, 8192
    s_and_b32 s33, s81, 1023
    s_lshl_b32 s33, s33, 12
    buffer_load_dwordx4 v234, s[48:51], s33 offen lds
    buffer_load_dwordx4 v235, s[48:51], s33 offen offset:1024 lds
    s_add_u32 m0, s35, 10240
    s_add_u32 s33, s33, 131072
    buffer_load_dwordx4 v234, s[48:51], s33 offen lds
    buffer_load_dwordx4 v235, s[48:51], s33 offen offset:1024 lds
    s_add_u32 m0, s35, 12288
    s_add_u32 s33, s33, 131072
    buffer_load_dwordx4 v234, s[48:51], s33 offen lds
    buffer_load_dwordx4 v235, s[48:51], s33 offen offset:1024 lds
    s_add_u32 m0, s35, 14336
    s_add_u32 s33, s33, 131072
    buffer_load_dwordx4 v234, s[48:51], s33 offen lds
    buffer_load_dwordx4 v235, s[48:51], s33 offen offset:1024 lds
    v_and_b32 v10, 15, v2
    v_lshrrev_b32 v11, 4, v2
    v_lshrrev_b32 v4, 1, v10
    v_xor_b32 v4, v11, v4
    v_lshlrev_b32 v4, 4, v4
    v_lshl_add_u32 v224, v10, 7, v4
    v_xor_b32 v225, 64, v224
    v_add_u32 v226, 98304, v224
    v_add_u32 v227, 98304, v225
    v_lshrrev_b32 v4, 2, v10
    v_lshl_add_u32 v5, v11, 3, v4
    v_lshlrev_b32 v5, 7, v5
    v_add_u32 v5, s35, v5
    v_and_b32 v6, 1, v10
    v_lshl_add_u32 v5, v6, 3, v5
    v_lshrrev_b32 v4, 1, v4
    v_and_b32 v6, 1, v11
    v_lshl_or_b32 v4, v6, 2, v4
    v_and_b32 v6, 2, v10
    v_xor_b32 v4, v4, v6
    v_xor_b32 v6, 0, v4
    v_lshl_add_u32 v228, v6, 4, v5
    v_xor_b32 v6, 1, v4
    v_lshl_add_u32 v229, v6, 4, v5
    v_xor_b32 v6, 4, v4
    v_lshl_add_u32 v230, v6, 4, v5
    v_xor_b32 v6, 5, v4
    v_lshl_add_u32 v231, v6, 4, v5
    s_lshl_b32 s36, s4, 20
    s_lshl_b32 s24, s5, 17
    s_add_u32 s36, s36, s24
    s_and_b32 s24, s3, 1
    s_lshl_b32 s24, s24, 12
    s_and_b32 s26, s3, 2
    s_lshl_b32 s26, s26, 13
    s_add_u32 s36, s36, s24
    s_add_u32 s36, s36, s26
    v_bfe_u32 v4, v2, 3, 1
    v_lshlrev_b32 v4, 10, v4
    v_lshrrev_b32 v5, 5, v2
    v_lshl_add_u32 v4, v5, 8, v4
    v_bfe_u32 v5, v2, 4, 1
    v_lshl_add_u32 v4, v5, 7, v4
    v_lshl_add_u32 v239, v9, 4, v4
    s_lshl_b32 s24, s5, 7
    s_sub_u32 s26, 1792, s24
    s_cmp_lt_u32 s4, 16
    s_cselect_b32 s24, s24, s26
    s_lshl_b32 s26, s4, 3
    s_add_u32 s24, s24, s26
    v_lshrrev_b32 v4, 5, v253
    v_add_u32 v6, s24, v4
    v_and_b32 v5, 31, v2
    v_lshlrev_b32 v6, 11, v6
    v_lshl_add_u32 v236, v5, 4, v6
    v_xor_b32 v4, v4, v9
    v_lshlrev_b32 v4, 4, v4
    v_lshl_add_u32 v4, v5, 7, v4
    v_add_u32 v237, 81920, v4
    s_lshr_b32 s26, s24, 5
    s_lshl_b32 s26, s26, 16
    s_and_b32 s24, s24, 31
    s_lshl_b32 s24, s24, 4
    s_add_u32 s24, s24, s26
    v_lshrrev_b32 v4, 3, v253
    v_lshlrev_b32 v4, 9, v4
    v_xor_b32 v5, v9, v8
    v_lshl_add_u32 v4, v5, 4, v4
    v_add_u32 v238, s24, v4
    v_lshlrev_b32 v240, 4, v2
    s_lshl_b32 s24, s3, 12
    v_add_u32 v242, s24, v240
    s_lshl_b32 s24, s6, 16
    v_add_u32 v248, s24, v240
    s_sub_u32 s25, 63, s6
    s_lshl_b32 s24, s25, 16
    v_add_u32 v249, s24, v240
    v_bfe_u32 v4, v2, 2, 2
    v_lshlrev_b32 v4, 13, v4
    v_lshl_add_u32 v4, v11, 6, v4
    v_and_b32 v5, 3, v2
    v_lshl_add_u32 v4, v5, 4, v4
    s_lshl_b32 s24, s4, 8
    s_lshl_b32 s25, s3, 18
    s_add_u32 s24, s24, s25
    v_add_u32 v245, s24, v4
    s_lshl_b32 s31, s3, 13
    s_add_u32 s31, s31, 65536
    s_lshl_b32 s27, s5, 20
    s_mov_b32 s7, s27
    s_mov_b32 s43, 0x40000000
    s_lshr_b32 s28, s27, 7
    s_add_u32 s29, s28, 4096
    v_lshrrev_b32 v4, 5, v2
    v_lshlrev_b32 v4, 11, v4
    v_bfe_u32 v5, v2, 2, 2
    v_lshl_add_u32 v4, v5, 6, v4
    v_bfe_u32 v5, v2, 4, 1
    v_lshl_add_u32 v4, v5, 5, v4
    v_and_b32 v5, 3, v2
    v_lshl_add_u32 v247, v5, 3, v4
    s_mov_b32 s30, 65536
    v_add_u32 v246, s30, v247
    v_and_b32 v4, 31, v2
    v_lshrrev_b32 v5, 5, v2
    v_lshlrev_b32 v5, 2, v5
    v_sub_u32 v4, v4, v5
    v_cvt_f32_i32 v4, v4
    v_add_f32 v4, 0.5, v4
    v_mul_f32 v243, 0x71800000, v4
    v_bfe_u32 v4, v2, 4, 1
    v_lshlrev_b32 v4, 17, v4
    v_lshrrev_b32 v5, 5, v2
    v_lshl_add_u32 v4, v5, 8, v4
    v_lshl_add_u32 v244, v10, 4, v4
    v_lshlrev_b32 v251, 7, v2
    v_cmp_gt_u32 vcc, 16, v2
    v_mov_b32 v4, 0x40000000
    v_mov_b32 v255, 1
    v_cndmask_b32 v251, v4, v251, vcc
    v_cmp_eq_u32 vcc, 0, v253
    s_nop 1
    v_cndmask_b32 v250, v4, v253, vcc
    buffer_load_dwordx4 v[0:3], v236, s[52:55], 0 offen offset:0
    buffer_load_dwordx4 v[4:7], v236, s[52:55], 0 offen offset:512
    buffer_load_dwordx4 v[8:11], v236, s[52:55], 0 offen offset:1024
    buffer_load_dwordx4 v[12:15], v236, s[52:55], 0 offen offset:1536
    s_waitcnt vmcnt(12)
    s_barrier
    ds_read_b128 v[160:163], v224 offset:0
    ds_read_b128 v[164:167], v224 offset:2048
    ds_read_b128 v[168:171], v224 offset:4096
    ds_read_b128 v[172:175], v224 offset:6144
    ds_read_b64_tr_b16 a[0:1], v228 offset:0
    ds_read_b64_tr_b16 a[2:3], v228 offset:512
    ds_read_b64_tr_b16 a[4:5], v229 offset:0
    ds_read_b64_tr_b16 a[6:7], v229 offset:512
    ds_read_b64_tr_b16 a[8:9], v230 offset:0
    ds_read_b64_tr_b16 a[10:11], v230 offset:512
    ds_read_b64_tr_b16 a[12:13], v231 offset:0
    ds_read_b64_tr_b16 a[14:15], v231 offset:512
    s_cmp_lt_u32 s3, 2
    s_cbranch_scc0 ka_V
    s_waitcnt lgkmcnt(0)
    v_mfma_f32_16x16x32_bf16 v[96:99], a[0:3], v[160:163], 0
    ds_read_b128 v[176:179], v225 offset:0
    ds_read_b128 v[180:183], v225 offset:2048
    v_mfma_f32_16x16x32_bf16 v[100:103], a[4:7], v[160:163], 0
    ds_read_b128 v[184:187], v225 offset:4096
    v_mfma_f32_16x16x32_bf16 v[104:107], a[8:11], v[160:163], 0
    ds_read_b128 v[188:191], v225 offset:6144
    ds_read_b64_tr_b16 a[16:17], v228 offset:4096
    v_mfma_f32_16x16x32_bf16 v[108:111], a[12:15], v[160:163], 0
    ds_read_b64_tr_b16 a[18:19], v228 offset:4608
    v_mfma_f32_16x16x32_bf16 v[112:115], a[0:3], v[164:167], 0
    ds_read_b64_tr_b16 a[20:21], v229 offset:4096
    ds_read_b64_tr_b16 a[22:23], v229 offset:4608
    s_add_u32 m0, s34, 16384
    s_add_u32 s37, s82, 0
    buffer_load_dwordx4 v232, s[44:47], s37 offen lds
    v_mfma_f32_16x16x32_bf16 v[116:119], a[4:7], v[164:167], 0
    ds_read_b64_tr_b16 a[24:25], v230 offset:4096
    buffer_load_dwordx4 v233, s[44:47], s37 offen offset:1024 lds
    v_mfma_f32_16x16x32_bf16 v[120:123], a[8:11], v[164:167], 0
    ds_read_b64_tr_b16 a[26:27], v230 offset:4608
    ds_read_b64_tr_b16 a[28:29], v231 offset:4096
    s_add_u32 m0, s34, 24576
    s_add_u32 s37, s83, 0
    buffer_load_dwordx4 v232, s[44:47], s37 offen lds
    v_mfma_f32_16x16x32_bf16 v[124:127], a[12:15], v[164:167], 0
    ds_read_b64_tr_b16 a[30:31], v231 offset:4608
    buffer_load_dwordx4 v233, s[44:47], s37 offen offset:1024 lds
    v_mfma_f32_16x16x32_bf16 v[128:131], a[0:3], v[168:171], 0
    s_add_u32 m0, s35, 16384
    s_and_b32 s33, s82, 1023
    s_lshl_b32 s33, s33, 12
    buffer_load_dwordx4 v234, s[48:51], s33 offen lds
    v_mfma_f32_16x16x32_bf16 v[132:135], a[4:7], v[168:171], 0
    buffer_load_dwordx4 v235, s[48:51], s33 offen offset:1024 lds
    v_mfma_f32_16x16x32_bf16 v[136:139], a[8:11], v[168:171], 0
    s_add_u32 m0, s35, 18432
    s_add_u32 s33, s33, 131072
    buffer_load_dwordx4 v234, s[48:51], s33 offen lds
    v_mfma_f32_16x16x32_bf16 v[140:143], a[12:15], v[168:171], 0
    buffer_load_dwordx4 v235, s[48:51], s33 offen offset:1024 lds
    v_mfma_f32_16x16x32_bf16 v[144:147], a[0:3], v[172:175], 0
    s_add_u32 m0, s35, 20480
    s_add_u32 s33, s33, 131072
    buffer_load_dwordx4 v234, s[48:51], s33 offen lds
    v_mfma_f32_16x16x32_bf16 v[148:151], a[4:7], v[172:175], 0
    buffer_load_dwordx4 v235, s[48:51], s33 offen offset:1024 lds
    v_mfma_f32_16x16x32_bf16 v[152:155], a[8:11], v[172:175], 0
    s_add_u32 m0, s35, 22528
    s_add_u32 s33, s33, 131072
    buffer_load_dwordx4 v234, s[48:51], s33 offen lds
    v_mfma_f32_16x16x32_bf16 v[156:159], a[12:15], v[172:175], 0
    buffer_load_dwordx4 v235, s[48:51], s33 offen offset:1024 lds
    s_waitcnt vmcnt(16) lgkmcnt(0)
    v_mfma_f32_16x16x32_bf16 v[96:99], a[16:19], v[176:179], v[96:99]
    ds_read_b128 v[160:163], v224 offset:8192
    ds_read_b128 v[164:167], v224 offset:10240
    v_mfma_f32_16x16x32_bf16 v[100:103], a[20:23], v[176:179], v[100:103]
    ds_read_b128 v[168:171], v224 offset:12288
    v_mfma_f32_16x16x32_bf16 v[104:107], a[24:27], v[176:179], v[104:107]
    ds_read_b128 v[172:175], v224 offset:14336
    ds_read_b64_tr_b16 a[32:33], v228 offset:8192
    v_mfma_f32_16x16x32_bf16 v[108:111], a[28:31], v[176:179], v[108:111]
    ds_read_b64_tr_b16 a[34:35], v228 offset:8704
    v_mfma_f32_16x16x32_bf16 v[112:115], a[16:19], v[180:183], v[112:115]
    ds_read_b64_tr_b16 a[36:37], v229 offset:8192
    ds_read_b64_tr_b16 a[38:39], v229 offset:8704
    s_add_u32 m0, s35, 0
    s_and_b32 s33, s83, 1023
    s_lshl_b32 s33, s33, 12
    buffer_load_dwordx4 v234, s[48:51], s33 offen lds
    v_mfma_f32_16x16x32_bf16 v[116:119], a[20:23], v[180:183], v[116:119]
    ds_read_b64_tr_b16 a[40:41], v230 offset:8192
    buffer_load_dwordx4 v235, s[48:51], s33 offen offset:1024 lds
    v_mfma_f32_16x16x32_bf16 v[120:123], a[24:27], v[180:183], v[120:123]
    ds_read_b64_tr_b16 a[42:43], v230 offset:8704
    ds_read_b64_tr_b16 a[44:45], v231 offset:8192
    s_add_u32 m0, s35, 2048
    s_add_u32 s33, s33, 131072
    buffer_load_dwordx4 v234, s[48:51], s33 offen lds
    v_mfma_f32_16x16x32_bf16 v[124:127], a[28:31], v[180:183], v[124:127]
    ds_read_b64_tr_b16 a[46:47], v231 offset:8704
    buffer_load_dwordx4 v235, s[48:51], s33 offen offset:1024 lds
    v_mfma_f32_16x16x32_bf16 v[128:131], a[16:19], v[184:187], v[128:131]
    s_add_u32 m0, s35, 4096
    s_add_u32 s33, s33, 131072
    buffer_load_dwordx4 v234, s[48:51], s33 offen lds
    v_mfma_f32_16x16x32_bf16 v[132:135], a[20:23], v[184:187], v[132:135]
    buffer_load_dwordx4 v235, s[48:51], s33 offen offset:1024 lds
    v_mfma_f32_16x16x32_bf16 v[136:139], a[24:27], v[184:187], v[136:139]
    s_add_u32 m0, s35, 6144
    s_add_u32 s33, s33, 131072
    buffer_load_dwordx4 v234, s[48:51], s33 offen lds
    v_mfma_f32_16x16x32_bf16 v[140:143], a[28:31], v[184:187], v[140:143]
    buffer_load_dwordx4 v235, s[48:51], s33 offen offset:1024 lds
    v_mfma_f32_16x16x32_bf16 v[144:147], a[16:19], v[188:191], v[144:147]
    v_mfma_f32_16x16x32_bf16 v[148:151], a[20:23], v[188:191], v[148:151]
    v_mfma_f32_16x16x32_bf16 v[152:155], a[24:27], v[188:191], v[152:155]
    v_mfma_f32_16x16x32_bf16 v[156:159], a[28:31], v[188:191], v[156:159]
    s_waitcnt lgkmcnt(0)
    v_mfma_f32_16x16x32_bf16 v[96:99], a[32:35], v[160:163], v[96:99]
    ds_read_b128 v[176:179], v225 offset:8192
    ds_read_b128 v[180:183], v225 offset:10240
    v_mfma_f32_16x16x32_bf16 v[100:103], a[36:39], v[160:163], v[100:103]
    ds_read_b128 v[184:187], v225 offset:12288
    v_mfma_f32_16x16x32_bf16 v[104:107], a[40:43], v[160:163], v[104:107]
    ds_read_b128 v[188:191], v225 offset:14336
    ds_read_b64_tr_b16 a[48:49], v228 offset:12288
    v_mfma_f32_16x16x32_bf16 v[108:111], a[44:47], v[160:163], v[108:111]
    ds_read_b64_tr_b16 a[50:51], v228 offset:12800
    v_mfma_f32_16x16x32_bf16 v[112:115], a[32:35], v[164:167], v[112:115]
    ds_read_b64_tr_b16 a[52:53], v229 offset:12288
    ds_read_b64_tr_b16 a[54:55], v229 offset:12800
    v_mfma_f32_16x16x32_bf16 v[116:119], a[36:39], v[164:167], v[116:119]
    ds_read_b64_tr_b16 a[56:57], v230 offset:12288
    s_add_u32 m0, s34, 32768
    s_add_u32 s37, s84, 0
    buffer_load_dwordx4 v232, s[44:47], s37 offen lds
    v_mfma_f32_16x16x32_bf16 v[120:123], a[40:43], v[164:167], v[120:123]
    ds_read_b64_tr_b16 a[58:59], v230 offset:12800
    ds_read_b64_tr_b16 a[60:61], v231 offset:12288
    v_mfma_f32_16x16x32_bf16 v[124:127], a[44:47], v[164:167], v[124:127]
    ds_read_b64_tr_b16 a[62:63], v231 offset:12800
    buffer_load_dwordx4 v233, s[44:47], s37 offen offset:1024 lds
    v_mfma_f32_16x16x32_bf16 v[128:131], a[32:35], v[168:171], v[128:131]
    v_mfma_f32_16x16x32_bf16 v[132:135], a[36:39], v[168:171], v[132:135]
    s_add_u32 m0, s34, 40960
    s_add_u32 s37, s85, 0
    buffer_load_dwordx4 v232, s[44:47], s37 offen lds
    v_mfma_f32_16x16x32_bf16 v[136:139], a[40:43], v[168:171], v[136:139]
    v_mfma_f32_16x16x32_bf16 v[140:143], a[44:47], v[168:171], v[140:143]
    buffer_load_dwordx4 v233, s[44:47], s37 offen offset:1024 lds
    v_mfma_f32_16x16x32_bf16 v[144:147], a[32:35], v[172:175], v[144:147]
    v_mfma_f32_16x16x32_bf16 v[148:151], a[36:39], v[172:175], v[148:151]
    v_mfma_f32_16x16x32_bf16 v[152:155], a[40:43], v[172:175], v[152:155]
    v_mfma_f32_16x16x32_bf16 v[156:159], a[44:47], v[172:175], v[156:159]
    s_waitcnt vmcnt(12) lgkmcnt(0)
    s_barrier
    v_mfma_f32_16x16x32_bf16 v[96:99], a[48:51], v[176:179], v[96:99]
    ds_read_b128 v[160:163], v224 offset:16384
    ds_read_b128 v[164:167], v224 offset:18432
    s_waitcnt vmcnt(24)
    v_mfma_f32_16x16x32_bf16 v[100:103], a[52:55], v[176:179], v[100:103]
    ds_read_b128 v[168:171], v224 offset:20480
    v_lshlrev_b32 v16, 16, v0
    v_and_b32 v17, 0xffff0000, v0
    v_mfma_f32_16x16x32_bf16 v[104:107], a[56:59], v[176:179], v[104:107]
    ds_read_b128 v[172:175], v224 offset:22528
    ds_read_b64_tr_b16 a[64:65], v228 offset:16384
    v_lshlrev_b32 v18, 16, v1
    v_mfma_f32_16x16x32_bf16 v[108:111], a[60:63], v[176:179], v[108:111]
    ds_read_b64_tr_b16 a[66:67], v228 offset:16896
    v_and_b32 v19, 0xffff0000, v1
    v_lshlrev_b32 v20, 16, v2
    v_mfma_f32_16x16x32_bf16 v[112:115], a[48:51], v[180:183], v[112:115]
    ds_read_b64_tr_b16 a[68:69], v229 offset:16384
    ds_read_b64_tr_b16 a[70:71], v229 offset:16896
    s_add_u32 m0, s35, 8192
    s_and_b32 s33, s84, 1023
    s_lshl_b32 s33, s33, 12
    buffer_load_dwordx4 v234, s[48:51], s33 offen lds
    v_mfma_f32_16x16x32_bf16 v[116:119], a[52:55], v[180:183], v[116:119]
    ds_read_b64_tr_b16 a[72:73], v230 offset:16384
    buffer_load_dwordx4 v235, s[48:51], s33 offen offset:1024 lds
    v_and_b32 v21, 0xffff0000, v2
    v_mfma_f32_16x16x32_bf16 v[120:123], a[56:59], v[180:183], v[120:123]
    ds_read_b64_tr_b16 a[74:75], v230 offset:16896
    ds_read_b64_tr_b16 a[76:77], v231 offset:16384
    s_add_u32 m0, s35, 10240
    s_add_u32 s33, s33, 131072
    buffer_load_dwordx4 v234, s[48:51], s33 offen lds
    v_mfma_f32_16x16x32_bf16 v[124:127], a[60:63], v[180:183], v[124:127]
    ds_read_b64_tr_b16 a[78:79], v231 offset:16896
    buffer_load_dwordx4 v235, s[48:51], s33 offen offset:1024 lds
    v_lshlrev_b32 v22, 16, v3
    v_and_b32 v23, 0xffff0000, v3
    v_mfma_f32_16x16x32_bf16 v[128:131], a[48:51], v[184:187], v[128:131]
    s_add_u32 m0, s35, 12288
    s_add_u32 s33, s33, 131072
    buffer_load_dwordx4 v234, s[48:51], s33 offen lds
    v_mfma_f32_16x16x32_bf16 v[132:135], a[52:55], v[184:187], v[132:135]
    buffer_load_dwordx4 v235, s[48:51], s33 offen offset:1024 lds
    v_lshlrev_b32 v24, 16, v4
    v_and_b32 v25, 0xffff0000, v4
    v_mfma_f32_16x16x32_bf16 v[136:139], a[56:59], v[184:187], v[136:139]
    s_add_u32 m0, s35, 14336
    s_add_u32 s33, s33, 131072
    buffer_load_dwordx4 v234, s[48:51], s33 offen lds
    v_lshlrev_b32 v26, 16, v5
    v_mfma_f32_16x16x32_bf16 v[140:143], a[60:63], v[184:187], v[140:143]
    buffer_load_dwordx4 v235, s[48:51], s33 offen offset:1024 lds
    v_and_b32 v27, 0xffff0000, v5
    v_lshlrev_b32 v28, 16, v6
    v_mfma_f32_16x16x32_bf16 v[144:147], a[48:51], v[188:191], v[144:147]
    v_and_b32 v29, 0xffff0000, v6
    v_lshlrev_b32 v30, 16, v7
    v_mfma_f32_16x16x32_bf16 v[148:151], a[52:55], v[188:191], v[148:151]
    v_and_b32 v31, 0xffff0000, v7
    v_lshlrev_b32 v32, 16, v8
    v_and_b32 v33, 0xffff0000, v8
    v_mfma_f32_16x16x32_bf16 v[152:155], a[56:59], v[188:191], v[152:155]
    v_lshlrev_b32 v34, 16, v9
    v_and_b32 v35, 0xffff0000, v9
    v_mfma_f32_16x16x32_bf16 v[156:159], a[60:63], v[188:191], v[156:159]
    v_lshlrev_b32 v36, 16, v10
    v_and_b32 v37, 0xffff0000, v10
    s_waitcnt lgkmcnt(0)
    v_mfma_f32_16x16x32_bf16 v[96:99], a[64:67], v[160:163], v[96:99]
    ds_read_b128 v[176:179], v225 offset:16384
    ds_read_b128 v[180:183], v225 offset:18432
    v_lshlrev_b32 v38, 16, v11
    v_mfma_f32_16x16x32_bf16 v[100:103], a[68:71], v[160:163], v[100:103]
    ds_read_b128 v[184:187], v225 offset:20480
    v_and_b32 v39, 0xffff0000, v11
    v_lshlrev_b32 v40, 16, v12
    v_mfma_f32_16x16x32_bf16 v[104:107], a[72:75], v[160:163], v[104:107]
    ds_read_b128 v[188:191], v225 offset:22528
    ds_read_b64_tr_b16 a[80:81], v228 offset:20480
    v_and_b32 v41, 0xffff0000, v12
    v_mfma_f32_16x16x32_bf16 v[108:111], a[76:79], v[160:163], v[108:111]
    ds_read_b64_tr_b16 a[82:83], v228 offset:20992
    v_lshlrev_b32 v42, 16, v13
    v_and_b32 v43, 0xffff0000, v13
    v_mfma_f32_16x16x32_bf16 v[112:115], a[64:67], v[164:167], v[112:115]
    ds_read_b64_tr_b16 a[84:85], v229 offset:20480
    ds_read_b64_tr_b16 a[86:87], v229 offset:20992
    v_lshlrev_b32 v44, 16, v14
    v_mfma_f32_16x16x32_bf16 v[116:119], a[68:71], v[164:167], v[116:119]
    ds_read_b64_tr_b16 a[88:89], v230 offset:20480
    s_add_u32 m0, s34, 49152
    s_add_u32 s37, s86, 0
    buffer_load_dwordx4 v232, s[44:47], s37 offen lds
    v_mfma_f32_16x16x32_bf16 v[120:123], a[72:75], v[164:167], v[120:123]
    ds_read_b64_tr_b16 a[90:91], v230 offset:20992
    ds_read_b64_tr_b16 a[92:93], v231 offset:20480
    v_and_b32 v45, 0xffff0000, v14
    v_mfma_f32_16x16x32_bf16 v[124:127], a[76:79], v[164:167], v[124:127]
    ds_read_b64_tr_b16 a[94:95], v231 offset:20992
    buffer_load_dwordx4 v233, s[44:47], s37 offen offset:1024 lds
    v_lshlrev_b32 v46, 16, v15
    v_and_b32 v47, 0xffff0000, v15
    v_mfma_f32_16x16x32_bf16 v[128:131], a[64:67], v[168:171], v[128:131]
    v_add_f32 v52, v16, v20
    v_add_f32 v53, v17, v21
    v_mfma_f32_16x16x32_bf16 v[132:135], a[68:71], v[168:171], v[132:135]
    s_add_u32 m0, s34, 57344
    s_add_u32 s37, s87, 0
    buffer_load_dwordx4 v232, s[44:47], s37 offen lds
    v_add_f32 v54, v18, v22
    v_mfma_f32_16x16x32_bf16 v[136:139], a[72:75], v[168:171], v[136:139]
    v_add_f32 v55, v19, v23
    v_add_f32 v52, v52, v24
    v_mfma_f32_16x16x32_bf16 v[140:143], a[76:79], v[168:171], v[140:143]
    buffer_load_dwordx4 v233, s[44:47], s37 offen offset:1024 lds
    v_add_f32 v53, v53, v25
    v_add_f32 v54, v54, v26
    v_mfma_f32_16x16x32_bf16 v[144:147], a[64:67], v[172:175], v[144:147]
    v_add_f32 v55, v55, v27
    v_add_f32 v52, v52, v28
    v_add_f32 v53, v53, v29
    v_mfma_f32_16x16x32_bf16 v[148:151], a[68:71], v[172:175], v[148:151]
    v_add_f32 v54, v54, v30
    v_add_f32 v55, v55, v31
    v_mfma_f32_16x16x32_bf16 v[152:155], a[72:75], v[172:175], v[152:155]
    v_add_f32 v52, v52, v32
    v_add_f32 v53, v53, v33
    v_add_f32 v54, v54, v34
    v_mfma_f32_16x16x32_bf16 v[156:159], a[76:79], v[172:175], v[156:159]
    v_add_f32 v55, v55, v35
    s_waitcnt vmcnt(16) lgkmcnt(0)
    v_mfma_f32_16x16x32_bf16 v[96:99], a[80:83], v[176:179], v[96:99]
    ds_read_b128 v[160:163], v224 offset:24576
    ds_read_b128 v[164:167], v224 offset:26624
    v_add_f32 v52, v52, v36
    v_add_f32 v53, v53, v37
    v_mfma_f32_16x16x32_bf16 v[100:103], a[84:87], v[176:179], v[100:103]
    ds_read_b128 v[168:171], v224 offset:28672
    v_add_f32 v54, v54, v38
    v_mfma_f32_16x16x32_bf16 v[104:107], a[88:91], v[176:179], v[104:107]
    ds_read_b128 v[172:175], v224 offset:30720
    ds_read_b64_tr_b16 a[96:97], v228 offset:0
    v_add_f32 v55, v55, v39
    v_add_f32 v52, v52, v40
    v_mfma_f32_16x16x32_bf16 v[108:111], a[92:95], v[176:179], v[108:111]
    ds_read_b64_tr_b16 a[98:99], v228 offset:512
    v_add_f32 v53, v53, v41
    v_add_f32 v54, v54, v42
    v_mfma_f32_16x16x32_bf16 v[112:115], a[80:83], v[180:183], v[112:115]
    ds_read_b64_tr_b16 a[100:101], v229 offset:0
    ds_read_b64_tr_b16 a[102:103], v229 offset:512
    s_add_u32 m0, s35, 16384
    s_and_b32 s33, s85, 1023
    s_lshl_b32 s33, s33, 12
    buffer_load_dwordx4 v234, s[48:51], s33 offen lds
    v_mfma_f32_16x16x32_bf16 v[116:119], a[84:87], v[180:183], v[116:119]
    ds_read_b64_tr_b16 a[104:105], v230 offset:0
    buffer_load_dwordx4 v235, s[48:51], s33 offen offset:1024 lds
    v_add_f32 v55, v55, v43
    v_mfma_f32_16x16x32_bf16 v[120:123], a[88:91], v[180:183], v[120:123]
    ds_read_b64_tr_b16 a[106:107], v230 offset:512
    ds_read_b64_tr_b16 a[108:109], v231 offset:0
    s_add_u32 m0, s35, 18432
    s_add_u32 s33, s33, 131072
    buffer_load_dwordx4 v234, s[48:51], s33 offen lds
    v_mfma_f32_16x16x32_bf16 v[124:127], a[92:95], v[180:183], v[124:127]
    ds_read_b64_tr_b16 a[110:111], v231 offset:512
    buffer_load_dwordx4 v235, s[48:51], s33 offen offset:1024 lds
    v_add_f32 v52, v52, v44
    v_mfma_f32_16x16x32_bf16 v[128:131], a[80:83], v[184:187], v[128:131]
    s_add_u32 m0, s35, 20480
    s_add_u32 s33, s33, 131072
    buffer_load_dwordx4 v234, s[48:51], s33 offen lds
    v_add_f32 v53, v53, v45
    v_mfma_f32_16x16x32_bf16 v[132:135], a[84:87], v[184:187], v[132:135]
    buffer_load_dwordx4 v235, s[48:51], s33 offen offset:1024 lds
    v_add_f32 v54, v54, v46
    v_mfma_f32_16x16x32_bf16 v[136:139], a[88:91], v[184:187], v[136:139]
    s_add_u32 m0, s35, 22528
    s_add_u32 s33, s33, 131072
    buffer_load_dwordx4 v234, s[48:51], s33 offen lds
    v_add_f32 v55, v55, v47
    v_mfma_f32_16x16x32_bf16 v[140:143], a[92:95], v[184:187], v[140:143]
    buffer_load_dwordx4 v235, s[48:51], s33 offen offset:1024 lds
    v_add_f32 v52, v52, v53
    v_add_f32 v54, v54, v55
    v_mfma_f32_16x16x32_bf16 v[144:147], a[80:83], v[188:191], v[144:147]
    v_add_f32 v48, v52, v54
    s_nop 1
    v_mfma_f32_16x16x32_bf16 v[148:151], a[84:87], v[188:191], v[148:151]
    v_add_f32_dpp v48, v48, v48 quad_perm:[1,0,3,2] row_mask:0xf bank_mask:0xf
    s_nop 1
    v_add_f32_dpp v48, v48, v48 quad_perm:[2,3,0,1] row_mask:0xf bank_mask:0xf
    v_mfma_f32_16x16x32_bf16 v[152:155], a[88:91], v[188:191], v[152:155]
    s_nop 1
    v_add_f32_dpp v48, v48, v48 row_half_mirror row_mask:0xf bank_mask:0xf
    v_mfma_f32_16x16x32_bf16 v[156:159], a[92:95], v[188:191], v[156:159]
    s_nop 1
    v_add_f32_dpp v48, v48, v48 row_mirror row_mask:0xf bank_mask:0xf
    s_waitcnt lgkmcnt(0)
    v_mfma_f32_16x16x32_bf16 v[96:99], a[96:99], v[160:163], v[96:99]
    ds_read_b128 v[176:179], v225 offset:24576
    ds_read_b128 v[180:183], v225 offset:26624
    s_nop 0
    v_mfma_f32_16x16x32_bf16 v[100:103], a[100:103], v[160:163], v[100:103]
    ds_read_b128 v[184:187], v225 offset:28672
    v_mov_b32 v49, v48
    s_nop 1
    v_mfma_f32_16x16x32_bf16 v[104:107], a[104:107], v[160:163], v[104:107]
    ds_read_b128 v[188:191], v225 offset:30720
    ds_read_b64_tr_b16 a[112:113], v228 offset:4096
    v_permlane16_swap_b32 v48, v49
    s_nop 0
    v_mfma_f32_16x16x32_bf16 v[108:111], a[108:111], v[160:163], v[108:111]
    ds_read_b64_tr_b16 a[114:115], v228 offset:4608
    v_add_f32 v48, v48, v49
    v_mfma_f32_16x16x32_bf16 v[112:115], a[96:99], v[164:167], v[112:115]
    ds_read_b64_tr_b16 a[116:117], v229 offset:4096
    ds_read_b64_tr_b16 a[118:119], v229 offset:4608
    v_mul_f32 v48, 0x3a800000, v48
    v_sub_f32 v56, v16, v48
    v_mfma_f32_16x16x32_bf16 v[116:119], a[100:103], v[164:167], v[116:119]
    ds_read_b64_tr_b16 a[120:121], v230 offset:4096
    v_mul_f32 v52, v56, v56
    v_mfma_f32_16x16x32_bf16 v[120:123], a[104:107], v[164:167], v[120:123]
    ds_read_b64_tr_b16 a[122:123], v230 offset:4608
    ds_read_b64_tr_b16 a[124:125], v231 offset:4096
    v_sub_f32 v57, v17, v48
    v_mul_f32 v53, v57, v57
    v_mfma_f32_16x16x32_bf16 v[124:127], a[108:111], v[164:167], v[124:127]
    ds_read_b64_tr_b16 a[126:127], v231 offset:4608
    v_sub_f32 v58, v18, v48
    v_mul_f32 v54, v58, v58
    v_mfma_f32_16x16x32_bf16 v[128:131], a[96:99], v[168:171], v[128:131]
    v_sub_f32 v59, v19, v48
    v_mul_f32 v55, v59, v59
    v_mfma_f32_16x16x32_bf16 v[132:135], a[100:103], v[168:171], v[132:135]
    v_sub_f32 v56, v20, v48
    v_fmac_f32 v52, v56, v56
    v_mfma_f32_16x16x32_bf16 v[136:139], a[104:107], v[168:171], v[136:139]
    v_sub_f32 v57, v21, v48
    v_fmac_f32 v53, v57, v57
    v_sub_f32 v58, v22, v48
    v_mfma_f32_16x16x32_bf16 v[140:143], a[108:111], v[168:171], v[140:143]
    v_fmac_f32 v54, v58, v58
    v_sub_f32 v59, v23, v48
    v_mfma_f32_16x16x32_bf16 v[144:147], a[96:99], v[172:175], v[144:147]
    v_fmac_f32 v55, v59, v59
    v_sub_f32 v56, v24, v48
    v_fmac_f32 v52, v56, v56
    v_mfma_f32_16x16x32_bf16 v[148:151], a[100:103], v[172:175], v[148:151]
    v_sub_f32 v57, v25, v48
    v_fmac_f32 v53, v57, v57
    v_mfma_f32_16x16x32_bf16 v[152:155], a[104:107], v[172:175], v[152:155]
    v_sub_f32 v58, v26, v48
    v_fmac_f32 v54, v58, v58
    v_sub_f32 v59, v27, v48
    v_mfma_f32_16x16x32_bf16 v[156:159], a[108:111], v[172:175], v[156:159]
    v_fmac_f32 v55, v59, v59
    s_waitcnt vmcnt(12) lgkmcnt(0)
    s_barrier
    v_mfma_f32_16x16x32_bf16 v[96:99], a[112:115], v[176:179], v[96:99]
    ds_read_b128 v[160:163], v224 offset:32768
    ds_read_b128 v[164:167], v224 offset:34816
    v_sub_f32 v56, v28, v48
    v_mfma_f32_16x16x32_bf16 v[100:103], a[116:119], v[176:179], v[100:103]
    ds_read_b128 v[168:171], v224 offset:36864
    v_fmac_f32 v52, v56, v56
    v_sub_f32 v57, v29, v48
    v_mfma_f32_16x16x32_bf16 v[104:107], a[120:123], v[176:179], v[104:107]
    ds_read_b128 v[172:175], v224 offset:38912
    ds_read_b64_tr_b16 a[128:129], v228 offset:8192
    v_fmac_f32 v53, v57, v57
    v_mfma_f32_16x16x32_bf16 v[108:111], a[124:127], v[176:179], v[108:111]
    ds_read_b64_tr_b16 a[130:131], v228 offset:8704
    v_sub_f32 v58, v30, v48
    v_fmac_f32 v54, v58, v58
    v_mfma_f32_16x16x32_bf16 v[112:115], a[112:115], v[180:183], v[112:115]
    ds_read_b64_tr_b16 a[132:133], v229 offset:8192
    ds_read_b64_tr_b16 a[134:135], v229 offset:8704
    s_add_u32 m0, s35, 0
    s_and_b32 s33, s86, 1023
    s_lshl_b32 s33, s33, 12
    buffer_load_dwordx4 v234, s[48:51], s33 offen lds
    v_mfma_f32_16x16x32_bf16 v[116:119], a[116:119], v[180:183], v[116:119]
    ds_read_b64_tr_b16 a[136:137], v230 offset:8192
    buffer_load_dwordx4 v235, s[48:51], s33 offen offset:1024 lds
    v_sub_f32 v59, v31, v48
    v_mfma_f32_16x16x32_bf16 v[120:123], a[120:123], v[180:183], v[120:123]
    ds_read_b64_tr_b16 a[138:139], v230 offset:8704
    ds_read_b64_tr_b16 a[140:141], v231 offset:8192
    s_add_u32 m0, s35, 2048
    s_add_u32 s33, s33, 131072
    buffer_load_dwordx4 v234, s[48:51], s33 offen lds
    v_mfma_f32_16x16x32_bf16 v[124:127], a[124:127], v[180:183], v[124:127]
    ds_read_b64_tr_b16 a[142:143], v231 offset:8704
    buffer_load_dwordx4 v235, s[48:51], s33 offen offset:1024 lds
    v_fmac_f32 v55, v59, v59
    v_sub_f32 v56, v32, v48
    v_mfma_f32_16x16x32_bf16 v[128:131], a[112:115], v[184:187], v[128:131]
    s_add_u32 m0, s35, 4096
    s_add_u32 s33, s33, 131072
    buffer_load_dwordx4 v234, s[48:51], s33 offen lds
    v_mfma_f32_16x16x32_bf16 v[132:135], a[116:119], v[184:187], v[132:135]
    buffer_load_dwordx4 v235, s[48:51], s33 offen offset:1024 lds
    v_fmac_f32 v52, v56, v56
    v_sub_f32 v57, v33, v48
    v_mfma_f32_16x16x32_bf16 v[136:139], a[120:123], v[184:187], v[136:139]
    s_add_u32 m0, s35, 6144
    s_add_u32 s33, s33, 131072
    buffer_load_dwordx4 v234, s[48:51], s33 offen lds
    v_fmac_f32 v53, v57, v57
    v_mfma_f32_16x16x32_bf16 v[140:143], a[124:127], v[184:187], v[140:143]
    buffer_load_dwordx4 v235, s[48:51], s33 offen offset:1024 lds
    v_sub_f32 v58, v34, v48
    v_fmac_f32 v54, v58, v58
    v_mfma_f32_16x16x32_bf16 v[144:147], a[112:115], v[188:191], v[144:147]
    v_sub_f32 v59, v35, v48
    v_fmac_f32 v55, v59, v59
    v_mfma_f32_16x16x32_bf16 v[148:151], a[116:119], v[188:191], v[148:151]
    v_sub_f32 v56, v36, v48
    v_fmac_f32 v52, v56, v56
    v_sub_f32 v57, v37, v48
    v_mfma_f32_16x16x32_bf16 v[152:155], a[120:123], v[188:191], v[152:155]
    v_fmac_f32 v53, v57, v57
    v_sub_f32 v58, v38, v48
    v_mfma_f32_16x16x32_bf16 v[156:159], a[124:127], v[188:191], v[156:159]
    v_fmac_f32 v54, v58, v58
    v_sub_f32 v59, v39, v48
    s_waitcnt lgkmcnt(0)
    v_mfma_f32_16x16x32_bf16 v[96:99], a[128:131], v[160:163], v[96:99]
    ds_read_b128 v[176:179], v225 offset:32768
    ds_read_b128 v[180:183], v225 offset:34816
    v_fmac_f32 v55, v59, v59
    v_mfma_f32_16x16x32_bf16 v[100:103], a[132:135], v[160:163], v[100:103]
    ds_read_b128 v[184:187], v225 offset:36864
    v_sub_f32 v56, v40, v48
    v_fmac_f32 v52, v56, v56
    v_mfma_f32_16x16x32_bf16 v[104:107], a[136:139], v[160:163], v[104:107]
    ds_read_b128 v[188:191], v225 offset:38912
    ds_read_b64_tr_b16 a[144:145], v228 offset:12288
    v_sub_f32 v57, v41, v48
    v_mfma_f32_16x16x32_bf16 v[108:111], a[140:143], v[160:163], v[108:111]
    ds_read_b64_tr_b16 a[146:147], v228 offset:12800
    v_fmac_f32 v53, v57, v57
    v_sub_f32 v58, v42, v48
    v_mfma_f32_16x16x32_bf16 v[112:115], a[128:131], v[164:167], v[112:115]
    ds_read_b64_tr_b16 a[148:149], v229 offset:12288
    ds_read_b64_tr_b16 a[150:151], v229 offset:12800
    v_fmac_f32 v54, v58, v58
    v_mfma_f32_16x16x32_bf16 v[116:119], a[132:135], v[164:167], v[116:119]
    ds_read_b64_tr_b16 a[152:153], v230 offset:12288
    s_add_u32 m0, s34, 0
    s_add_u32 s37, s80, 65536
    buffer_load_dwordx4 v232, s[44:47], s37 offen lds
    v_mfma_f32_16x16x32_bf16 v[120:123], a[136:139], v[164:167], v[120:123]
    ds_read_b64_tr_b16 a[154:155], v230 offset:12800
    ds_read_b64_tr_b16 a[156:157], v231 offset:12288
    v_sub_f32 v59, v43, v48
    v_fmac_f32 v55, v59, v59
    v_mfma_f32_16x16x32_bf16 v[124:127], a[140:143], v[164:167], v[124:127]
    ds_read_b64_tr_b16 a[158:159], v231 offset:12800
    buffer_load_dwordx4 v233, s[44:47], s37 offen offset:1024 lds
    v_sub_f32 v56, v44, v48
    v_mfma_f32_16x16x32_bf16 v[128:131], a[128:131], v[168:171], v[128:131]
    v_fmac_f32 v52, v56, v56
    v_sub_f32 v57, v45, v48
    v_mfma_f32_16x16x32_bf16 v[132:135], a[132:135], v[168:171], v[132:135]
    s_add_u32 m0, s34, 8192
    s_add_u32 s37, s81, 65536
    buffer_load_dwordx4 v232, s[44:47], s37 offen lds
    v_fmac_f32 v53, v57, v57
    v_mfma_f32_16x16x32_bf16 v[136:139], a[136:139], v[168:171], v[136:139]
    v_sub_f32 v58, v46, v48
    v_fmac_f32 v54, v58, v58
    v_mfma_f32_16x16x32_bf16 v[140:143], a[140:143], v[168:171], v[140:143]
    buffer_load_dwordx4 v233, s[44:47], s37 offen offset:1024 lds
    v_sub_f32 v59, v47, v48
    v_fmac_f32 v55, v59, v59
    v_mfma_f32_16x16x32_bf16 v[144:147], a[128:131], v[172:175], v[144:147]
    v_add_f32 v52, v52, v53
    v_add_f32 v54, v54, v55
    v_add_f32 v51, v52, v54
    v_mfma_f32_16x16x32_bf16 v[148:151], a[132:135], v[172:175], v[148:151]
    s_nop 1
    v_add_f32_dpp v51, v51, v51 quad_perm:[1,0,3,2] row_mask:0xf bank_mask:0xf
    v_mfma_f32_16x16x32_bf16 v[152:155], a[136:139], v[172:175], v[152:155]
    s_nop 1
    v_add_f32_dpp v51, v51, v51 quad_perm:[2,3,0,1] row_mask:0xf bank_mask:0xf
    s_nop 1
    v_mfma_f32_16x16x32_bf16 v[156:159], a[140:143], v[172:175], v[156:159]
    v_add_f32_dpp v51, v51, v51 row_half_mirror row_mask:0xf bank_mask:0xf
    s_waitcnt vmcnt(12) lgkmcnt(0)
    v_mfma_f32_16x16x32_bf16 v[96:99], a[144:147], v[176:179], v[96:99]
    ds_read_b128 v[160:163], v224 offset:40960
    ds_read_b128 v[164:167], v224 offset:43008
    s_nop 1
    v_add_f32_dpp v51, v51, v51 row_mirror row_mask:0xf bank_mask:0xf
    v_mfma_f32_16x16x32_bf16 v[100:103], a[148:151], v[176:179], v[100:103]
    ds_read_b128 v[168:171], v224 offset:45056
    s_nop 0
    v_mov_b32 v49, v51
    v_mfma_f32_16x16x32_bf16 v[104:107], a[152:155], v[176:179], v[104:107]
    ds_read_b128 v[172:175], v224 offset:47104
    ds_read_b64_tr_b16 a[160:161], v228 offset:16384
    s_nop 1
    v_mfma_f32_16x16x32_bf16 v[108:111], a[156:159], v[176:179], v[108:111]
    ds_read_b64_tr_b16 a[162:163], v228 offset:16896
    v_permlane16_swap_b32 v51, v49
    s_nop 0
    v_mfma_f32_16x16x32_bf16 v[112:115], a[144:147], v[180:183], v[112:115]
    ds_read_b64_tr_b16 a[164:165], v229 offset:16384
    ds_read_b64_tr_b16 a[166:167], v229 offset:16896
    s_add_u32 m0, s35, 8192
    s_and_b32 s33, s87, 1023
    s_lshl_b32 s33, s33, 12
    buffer_load_dwordx4 v234, s[48:51], s33 offen lds
    v_mfma_f32_16x16x32_bf16 v[116:119], a[148:151], v[180:183], v[116:119]
    ds_read_b64_tr_b16 a[168:169], v230 offset:16384
    buffer_load_dwordx4 v235, s[48:51], s33 offen offset:1024 lds
    v_add_f32 v51, v51, v49
    v_mfma_f32_16x16x32_bf16 v[120:123], a[152:155], v[180:183], v[120:123]
    ds_read_b64_tr_b16 a[170:171], v230 offset:16896
    ds_read_b64_tr_b16 a[172:173], v231 offset:16384
    s_add_u32 m0, s35, 10240
    s_add_u32 s33, s33, 131072
    buffer_load_dwordx4 v234, s[48:51], s33 offen lds
    v_mfma_f32_16x16x32_bf16 v[124:127], a[156:159], v[180:183], v[124:127]
    ds_read_b64_tr_b16 a[174:175], v231 offset:16896
    buffer_load_dwordx4 v235, s[48:51], s33 offen offset:1024 lds
    v_mul_f32 v51, 0x3a800000, v51
    v_mfma_f32_16x16x32_bf16 v[128:131], a[144:147], v[184:187], v[128:131]
    s_add_u32 m0, s35, 12288
    s_add_u32 s33, s33, 131072
    buffer_load_dwordx4 v234, s[48:51], s33 offen lds
    v_cvt_pk_bf16_f32 v50, v48, v51
    v_mfma_f32_16x16x32_bf16 v[132:135], a[148:151], v[184:187], v[132:135]
    buffer_load_dwordx4 v235, s[48:51], s33 offen offset:1024 lds
    v_and_b32 v51, 0xffff0000, v50
    v_lshlrev_b32 v50, 16, v50
    v_mfma_f32_16x16x32_bf16 v[136:139], a[152:155], v[184:187], v[136:139]
    s_add_u32 m0, s35, 14336
    s_add_u32 s33, s33, 131072
    buffer_load_dwordx4 v234, s[48:51], s33 offen lds
    v_mfma_f32_16x16x32_bf16 v[140:143], a[156:159], v[184:187], v[140:143]
    buffer_load_dwordx4 v235, s[48:51], s33 offen offset:1024 lds
    v_add_f32 v51, 0x3727c5ac, v51
    v_cvt_pk_bf16_f32 v51, v51, v51
    v_mfma_f32_16x16x32_bf16 v[144:147], a[144:147], v[188:191], v[144:147]
    v_lshlrev_b32 v51, 16, v51
    v_sqrt_f32 v51, v51
    v_mfma_f32_16x16x32_bf16 v[148:151], a[148:151], v[188:191], v[148:151]
    s_nop 0
    v_cvt_pk_bf16_f32 v51, v51, v51
    v_mfma_f32_16x16x32_bf16 v[152:155], a[152:155], v[188:191], v[152:155]
    v_lshlrev_b32 v51, 16, v51
    v_rcp_f32 v51, v51
    v_mfma_f32_16x16x32_bf16 v[156:159], a[156:159], v[188:191], v[156:159]
    s_nop 0
    s_waitcnt lgkmcnt(0)
    v_mfma_f32_16x16x32_bf16 v[96:99], a[160:163], v[160:163], v[96:99]
    ds_read_b128 v[176:179], v225 offset:40960
    ds_read_b128 v[180:183], v225 offset:43008
    v_sub_f32 v16, v16, v50
    v_mfma_f32_16x16x32_bf16 v[100:103], a[164:167], v[160:163], v[100:103]
    ds_read_b128 v[184:187], v225 offset:45056
    v_sub_f32 v17, v17, v50
    v_cvt_pk_bf16_f32 v17, v16, v17
    v_mfma_f32_16x16x32_bf16 v[104:107], a[168:171], v[160:163], v[104:107]
    ds_read_b128 v[188:191], v225 offset:47104
    ds_read_b64_tr_b16 a[176:177], v228 offset:20480
    v_lshlrev_b32 v16, 16, v17
    v_and_b32 v17, 0xffff0000, v17
    v_mfma_f32_16x16x32_bf16 v[108:111], a[172:175], v[160:163], v[108:111]
    ds_read_b64_tr_b16 a[178:179], v228 offset:20992
    v_mul_f32 v16, v16, v51
    v_mfma_f32_16x16x32_bf16 v[112:115], a[160:163], v[164:167], v[112:115]
    ds_read_b64_tr_b16 a[180:181], v229 offset:20480
    ds_read_b64_tr_b16 a[182:183], v229 offset:20992
    v_mul_f32 v17, v17, v51
    v_cvt_pk_bf16_f32 v0, v16, v17
    v_mfma_f32_16x16x32_bf16 v[116:119], a[164:167], v[164:167], v[116:119]
    ds_read_b64_tr_b16 a[184:185], v230 offset:20480
    s_add_u32 m0, s34, 16384
    s_add_u32 s37, s82, 65536
    buffer_load_dwordx4 v232, s[44:47], s37 offen lds
    v_mfma_f32_16x16x32_bf16 v[120:123], a[168:171], v[164:167], v[120:123]
    ds_read_b64_tr_b16 a[186:187], v230 offset:20992
    ds_read_b64_tr_b16 a[188:189], v231 offset:20480
    v_sub_f32 v18, v18, v50
    v_mfma_f32_16x16x32_bf16 v[124:127], a[172:175], v[164:167], v[124:127]
    ds_read_b64_tr_b16 a[190:191], v231 offset:20992
    buffer_load_dwordx4 v233, s[44:47], s37 offen offset:1024 lds
    v_sub_f32 v19, v19, v50
    v_mfma_f32_16x16x32_bf16 v[128:131], a[160:163], v[168:171], v[128:131]
    v_cvt_pk_bf16_f32 v19, v18, v19
    v_lshlrev_b32 v18, 16, v19
    v_and_b32 v19, 0xffff0000, v19
    v_mfma_f32_16x16x32_bf16 v[132:135], a[164:167], v[168:171], v[132:135]
    s_add_u32 m0, s34, 24576
    s_add_u32 s37, s83, 65536
    buffer_load_dwordx4 v232, s[44:47], s37 offen lds
    v_mfma_f32_16x16x32_bf16 v[136:139], a[168:171], v[168:171], v[136:139]
    v_mul_f32 v18, v18, v51
    v_mul_f32 v19, v19, v51
    v_cvt_pk_bf16_f32 v1, v18, v19
    v_mfma_f32_16x16x32_bf16 v[140:143], a[172:175], v[168:171], v[140:143]
    buffer_load_dwordx4 v233, s[44:47], s37 offen offset:1024 lds
    v_sub_f32 v20, v20, v50
    v_sub_f32 v21, v21, v50
    v_mfma_f32_16x16x32_bf16 v[144:147], a[160:163], v[172:175], v[144:147]
    v_cvt_pk_bf16_f32 v21, v20, v21
    v_lshlrev_b32 v20, 16, v21
    v_mfma_f32_16x16x32_bf16 v[148:151], a[164:167], v[172:175], v[148:151]
    v_and_b32 v21, 0xffff0000, v21
    v_mul_f32 v20, v20, v51
    v_mfma_f32_16x16x32_bf16 v[152:155], a[168:171], v[172:175], v[152:155]
    v_mul_f32 v21, v21, v51
    v_cvt_pk_bf16_f32 v2, v20, v21
    v_sub_f32 v22, v22, v50
    v_mfma_f32_16x16x32_bf16 v[156:159], a[172:175], v[172:175], v[156:159]
    v_sub_f32 v23, v23, v50
    s_waitcnt vmcnt(16) lgkmcnt(0)
    s_barrier
    v_mfma_f32_16x16x32_bf16 v[96:99], a[176:179], v[176:179], v[96:99]
    ds_read_b128 v[160:163], v224 offset:49152
    ds_read_b128 v[164:167], v224 offset:51200
    v_cvt_pk_bf16_f32 v23, v22, v23
    v_mfma_f32_16x16x32_bf16 v[100:103], a[180:183], v[176:179], v[100:103]
    ds_read_b128 v[168:171], v224 offset:53248
    v_lshlrev_b32 v22, 16, v23
    v_and_b32 v23, 0xffff0000, v23
    v_mfma_f32_16x16x32_bf16 v[104:107], a[184:187], v[176:179], v[104:107]
    ds_read_b128 v[172:175], v224 offset:55296
    ds_read_b64_tr_b16 a[192:193], v228 offset:0
    v_mul_f32 v22, v22, v51
    v_mfma_f32_16x16x32_bf16 v[108:111], a[188:191], v[176:179], v[108:111]
    ds_read_b64_tr_b16 a[194:195], v228 offset:512
    v_mul_f32 v23, v23, v51
    v_cvt_pk_bf16_f32 v3, v22, v23
    v_mfma_f32_16x16x32_bf16 v[112:115], a[176:179], v[180:183], v[112:115]
    ds_read_b64_tr_b16 a[196:197], v229 offset:0
    ds_read_b64_tr_b16 a[198:199], v229 offset:512
    v_sub_f32 v24, v24, v50
    v_sub_f32 v25, v25, v50
    v_mfma_f32_16x16x32_bf16 v[116:119], a[180:183], v[180:183], v[116:119]
    ds_read_b64_tr_b16 a[200:201], v230 offset:0
    v_cvt_pk_bf16_f32 v25, v24, v25
    v_mfma_f32_16x16x32_bf16 v[120:123], a[184:187], v[180:183], v[120:123]
    ds_read_b64_tr_b16 a[202:203], v230 offset:512
    ds_read_b64_tr_b16 a[204:205], v231 offset:0
    v_lshlrev_b32 v24, 16, v25
    v_and_b32 v25, 0xffff0000, v25
    v_mfma_f32_16x16x32_bf16 v[124:127], a[188:191], v[180:183], v[124:127]
    ds_read_b64_tr_b16 a[206:207], v231 offset:512
    v_mul_f32 v24, v24, v51
    v_mul_f32 v25, v25, v51
    v_mfma_f32_16x16x32_bf16 v[128:131], a[176:179], v[184:187], v[128:131]
    v_cvt_pk_bf16_f32 v4, v24, v25
    v_sub_f32 v26, v26, v50
    v_mfma_f32_16x16x32_bf16 v[132:135], a[180:183], v[184:187], v[132:135]
    v_sub_f32 v27, v27, v50
    v_cvt_pk_bf16_f32 v27, v26, v27
    v_mfma_f32_16x16x32_bf16 v[136:139], a[184:187], v[184:187], v[136:139]
    v_lshlrev_b32 v26, 16, v27
    v_and_b32 v27, 0xffff0000, v27
    v_mul_f32 v26, v26, v51
    v_mfma_f32_16x16x32_bf16 v[140:143], a[188:191], v[184:187], v[140:143]
    v_mul_f32 v27, v27, v51
    v_cvt_pk_bf16_f32 v5, v26, v27
    v_mfma_f32_16x16x32_bf16 v[144:147], a[176:179], v[188:191], v[144:147]
    v_sub_f32 v28, v28, v50
    v_sub_f32 v29, v29, v50
    v_cvt_pk_bf16_f32 v29, v28, v29
    v_mfma_f32_16x16x32_bf16 v[148:151], a[180:183], v[188:191], v[148:151]
    v_lshlrev_b32 v28, 16, v29
    v_and_b32 v29, 0xffff0000, v29
    v_mfma_f32_16x16x32_bf16 v[152:155], a[184:187], v[188:191], v[152:155]
    v_mul_f32 v28, v28, v51
    v_mul_f32 v29, v29, v51
    v_cvt_pk_bf16_f32 v6, v28, v29
    v_mfma_f32_16x16x32_bf16 v[156:159], a[188:191], v[188:191], v[156:159]
    v_sub_f32 v30, v30, v50
    v_sub_f32 v31, v31, v50
    s_waitcnt lgkmcnt(0)
    v_mfma_f32_16x16x32_bf16 v[96:99], a[192:195], v[160:163], v[96:99]
    ds_read_b128 v[176:179], v225 offset:49152
    ds_read_b128 v[180:183], v225 offset:51200
    v_cvt_pk_bf16_f32 v31, v30, v31
    v_mfma_f32_16x16x32_bf16 v[100:103], a[196:199], v[160:163], v[100:103]
    ds_read_b128 v[184:187], v225 offset:53248
    v_lshlrev_b32 v30, 16, v31
    v_and_b32 v31, 0xffff0000, v31
    v_mfma_f32_16x16x32_bf16 v[104:107], a[200:203], v[160:163], v[104:107]
    ds_read_b128 v[188:191], v225 offset:55296
    ds_read_b64_tr_b16 a[208:209], v228 offset:4096
    v_mul_f32 v30, v30, v51
    v_mfma_f32_16x16x32_bf16 v[108:111], a[204:207], v[160:163], v[108:111]
    ds_read_b64_tr_b16 a[210:211], v228 offset:4608
    v_mul_f32 v31, v31, v51
    v_cvt_pk_bf16_f32 v7, v30, v31
    v_mfma_f32_16x16x32_bf16 v[112:115], a[192:195], v[164:167], v[112:115]
    ds_read_b64_tr_b16 a[212:213], v229 offset:4096
    ds_read_b64_tr_b16 a[214:215], v229 offset:4608
    v_sub_f32 v32, v32, v50
    v_mfma_f32_16x16x32_bf16 v[116:119], a[196:199], v[164:167], v[116:119]
    ds_read_b64_tr_b16 a[216:217], v230 offset:4096
    s_add_u32 m0, s34, 32768
    s_add_u32 s37, s84, 65536
    buffer_load_dwordx4 v232, s[44:47], s37 offen lds
    v_mfma_f32_16x16x32_bf16 v[120:123], a[200:203], v[164:167], v[120:123]
    ds_read_b64_tr_b16 a[218:219], v230 offset:4608
    ds_read_b64_tr_b16 a[220:221], v231 offset:4096
    v_sub_f32 v33, v33, v50
    v_mfma_f32_16x16x32_bf16 v[124:127], a[204:207], v[164:167], v[124:127]
    ds_read_b64_tr_b16 a[222:223], v231 offset:4608
    buffer_load_dwordx4 v233, s[44:47], s37 offen offset:1024 lds
    v_cvt_pk_bf16_f32 v33, v32, v33
    v_lshlrev_b32 v32, 16, v33
    v_mfma_f32_16x16x32_bf16 v[128:131], a[192:195], v[168:171], v[128:131]
    v_and_b32 v33, 0xffff0000, v33
    v_mul_f32 v32, v32, v51
    v_mfma_f32_16x16x32_bf16 v[132:135], a[196:199], v[168:171], v[132:135]
    s_add_u32 m0, s34, 40960
    s_add_u32 s37, s85, 65536
    buffer_load_dwordx4 v232, s[44:47], s37 offen lds
    v_mul_f32 v33, v33, v51
    v_mfma_f32_16x16x32_bf16 v[136:139], a[200:203], v[168:171], v[136:139]
    v_cvt_pk_bf16_f32 v8, v32, v33
    v_sub_f32 v34, v34, v50
    v_mfma_f32_16x16x32_bf16 v[140:143], a[204:207], v[168:171], v[140:143]
    buffer_load_dwordx4 v233, s[44:47], s37 offen offset:1024 lds
    v_sub_f32 v35, v35, v50
    v_cvt_pk_bf16_f32 v35, v34, v35
    v_mfma_f32_16x16x32_bf16 v[144:147], a[192:195], v[172:175], v[144:147]
    v_lshlrev_b32 v34, 16, v35
    v_and_b32 v35, 0xffff0000, v35
    v_mfma_f32_16x16x32_bf16 v[148:151], a[196:199], v[172:175], v[148:151]
    v_mul_f32 v34, v34, v51
    v_mul_f32 v35, v35, v51
    v_cvt_pk_bf16_f32 v9, v34, v35
    v_mfma_f32_16x16x32_bf16 v[152:155], a[200:203], v[172:175], v[152:155]
    v_sub_f32 v36, v36, v50
    v_sub_f32 v37, v37, v50
    v_mfma_f32_16x16x32_bf16 v[156:159], a[204:207], v[172:175], v[156:159]
    v_cvt_pk_bf16_f32 v37, v36, v37
    v_lshlrev_b32 v36, 16, v37
    s_waitcnt vmcnt(8) lgkmcnt(0)
    v_mfma_f32_16x16x32_bf16 v[96:99], a[208:211], v[176:179], v[96:99]
    ds_read_b128 v[160:163], v224 offset:57344
    ds_read_b128 v[164:167], v224 offset:59392
    v_and_b32 v37, 0xffff0000, v37
    v_mfma_f32_16x16x32_bf16 v[100:103], a[212:215], v[176:179], v[100:103]
    ds_read_b128 v[168:171], v224 offset:61440
    v_mul_f32 v36, v36, v51
    v_mul_f32 v37, v37, v51
    v_mfma_f32_16x16x32_bf16 v[104:107], a[216:219], v[176:179], v[104:107]
    ds_read_b128 v[172:175], v224 offset:63488
    ds_read_b64_tr_b16 a[224:225], v228 offset:8192
    v_cvt_pk_bf16_f32 v10, v36, v37
    v_sub_f32 v38, v38, v50
    v_mfma_f32_16x16x32_bf16 v[108:111], a[220:223], v[176:179], v[108:111]
    ds_read_b64_tr_b16 a[226:227], v228 offset:8704
    v_sub_f32 v39, v39, v50
    v_mfma_f32_16x16x32_bf16 v[112:115], a[208:211], v[180:183], v[112:115]
    ds_read_b64_tr_b16 a[228:229], v229 offset:8192
    ds_read_b64_tr_b16 a[230:231], v229 offset:8704
    v_cvt_pk_bf16_f32 v39, v38, v39
    v_lshlrev_b32 v38, 16, v39
    v_mfma_f32_16x16x32_bf16 v[116:119], a[212:215], v[180:183], v[116:119]
    ds_read_b64_tr_b16 a[232:233], v230 offset:8192
    v_and_b32 v39, 0xffff0000, v39
    v_mfma_f32_16x16x32_bf16 v[120:123], a[216:219], v[180:183], v[120:123]
    ds_read_b64_tr_b16 a[234:235], v230 offset:8704
    ds_read_b64_tr_b16 a[236:237], v231 offset:8192
    v_mul_f32 v38, v38, v51
    v_mul_f32 v39, v39, v51
    v_mfma_f32_16x16x32_bf16 v[124:127], a[220:223], v[180:183], v[124:127]
    ds_read_b64_tr_b16 a[238:239], v231 offset:8704
    v_cvt_pk_bf16_f32 v11, v38, v39
    v_sub_f32 v40, v40, v50
    v_mfma_f32_16x16x32_bf16 v[128:131], a[208:211], v[184:187], v[128:131]
    v_sub_f32 v41, v41, v50
    v_cvt_pk_bf16_f32 v41, v40, v41
    v_mfma_f32_16x16x32_bf16 v[132:135], a[212:215], v[184:187], v[132:135]
    v_lshlrev_b32 v40, 16, v41
    v_and_b32 v41, 0xffff0000, v41
    v_mfma_f32_16x16x32_bf16 v[136:139], a[216:219], v[184:187], v[136:139]
    v_mul_f32 v40, v40, v51
    v_mul_f32 v41, v41, v51
    v_cvt_pk_bf16_f32 v12, v40, v41
    v_mfma_f32_16x16x32_bf16 v[140:143], a[220:223], v[184:187], v[140:143]
    v_sub_f32 v42, v42, v50
    v_sub_f32 v43, v43, v50
    v_mfma_f32_16x16x32_bf16 v[144:147], a[208:211], v[188:191], v[144:147]
    v_cvt_pk_bf16_f32 v43, v42, v43
    v_lshlrev_b32 v42, 16, v43
    v_and_b32 v43, 0xffff0000, v43
    v_mfma_f32_16x16x32_bf16 v[148:151], a[212:215], v[188:191], v[148:151]
    v_mul_f32 v42, v42, v51
    v_mul_f32 v43, v43, v51
    v_mfma_f32_16x16x32_bf16 v[152:155], a[216:219], v[188:191], v[152:155]
    v_cvt_pk_bf16_f32 v13, v42, v43
    v_sub_f32 v44, v44, v50
    v_sub_f32 v45, v45, v50
    v_mfma_f32_16x16x32_bf16 v[156:159], a[220:223], v[188:191], v[156:159]
    v_cvt_pk_bf16_f32 v45, v44, v45
    v_lshlrev_b32 v44, 16, v45
    s_waitcnt lgkmcnt(0)
    v_mfma_f32_16x16x32_bf16 v[96:99], a[224:227], v[160:163], v[96:99]
    ds_read_b128 v[176:179], v225 offset:57344
    ds_read_b128 v[180:183], v225 offset:59392
    v_and_b32 v45, 0xffff0000, v45
    v_mfma_f32_16x16x32_bf16 v[100:103], a[228:231], v[160:163], v[100:103]
    ds_read_b128 v[184:187], v225 offset:61440
    v_mul_f32 v44, v44, v51
    v_mul_f32 v45, v45, v51
    v_mfma_f32_16x16x32_bf16 v[104:107], a[232:235], v[160:163], v[104:107]
    ds_read_b128 v[188:191], v225 offset:63488
    ds_read_b64_tr_b16 a[240:241], v228 offset:12288
    v_cvt_pk_bf16_f32 v14, v44, v45
    v_mfma_f32_16x16x32_bf16 v[108:111], a[236:239], v[160:163], v[108:111]
    ds_read_b64_tr_b16 a[242:243], v228 offset:12800
    v_sub_f32 v46, v46, v50
    v_sub_f32 v47, v47, v50
    v_mfma_f32_16x16x32_bf16 v[112:115], a[224:227], v[164:167], v[112:115]
    ds_read_b64_tr_b16 a[244:245], v229 offset:12288
    ds_read_b64_tr_b16 a[246:247], v229 offset:12800
    v_cvt_pk_bf16_f32 v47, v46, v47
    v_mfma_f32_16x16x32_bf16 v[116:119], a[228:231], v[164:167], v[116:119]
    ds_read_b64_tr_b16 a[248:249], v230 offset:12288
    v_lshlrev_b32 v46, 16, v47
    v_and_b32 v47, 0xffff0000, v47
    v_mfma_f32_16x16x32_bf16 v[120:123], a[232:235], v[164:167], v[120:123]
    ds_read_b64_tr_b16 a[250:251], v230 offset:12800
    ds_read_b64_tr_b16 a[252:253], v231 offset:12288
    v_mul_f32 v46, v46, v51
    v_mfma_f32_16x16x32_bf16 v[124:127], a[236:239], v[164:167], v[124:127]
    ds_read_b64_tr_b16 a[254:255], v231 offset:12800
    v_mul_f32 v47, v47, v51
    v_cvt_pk_bf16_f32 v15, v46, v47
    v_mfma_f32_16x16x32_bf16 v[128:131], a[224:227], v[168:171], v[128:131]
    v_mfma_f32_16x16x32_bf16 v[132:135], a[228:231], v[168:171], v[132:135]
    ds_write_b128 v237, v[0:3] offset:0
    v_mfma_f32_16x16x32_bf16 v[136:139], a[232:235], v[168:171], v[136:139]
    ds_write_b128 v237, v[4:7] offset:4096
    v_mfma_f32_16x16x32_bf16 v[140:143], a[236:239], v[168:171], v[140:143]
    ds_write_b128 v237, v[8:11] offset:24576
    v_mfma_f32_16x16x32_bf16 v[144:147], a[224:227], v[172:175], v[144:147]
    ds_write_b128 v237, v[12:15] offset:28672
    v_mfma_f32_16x16x32_bf16 v[148:151], a[228:231], v[172:175], v[148:151]
    v_mfma_f32_16x16x32_bf16 v[152:155], a[232:235], v[172:175], v[152:155]
    v_mfma_f32_16x16x32_bf16 v[156:159], a[236:239], v[172:175], v[156:159]
    s_waitcnt vmcnt(16) lgkmcnt(0)
    s_barrier
    v_mfma_f32_16x16x32_bf16 v[96:99], a[240:243], v[176:179], v[96:99]
    ds_read_b128 v[160:163], v224 offset:0
    v_mfma_f32_16x16x32_bf16 v[100:103], a[244:247], v[176:179], v[100:103]
    ds_read_b128 v[164:167], v224 offset:2048
    v_mfma_f32_16x16x32_bf16 v[104:107], a[248:251], v[176:179], v[104:107]
    ds_read_b128 v[168:171], v224 offset:4096
    v_mfma_f32_16x16x32_bf16 v[108:111], a[252:255], v[176:179], v[108:111]
    ds_read_b128 v[172:175], v224 offset:6144
    v_mfma_f32_16x16x32_bf16 v[112:115], a[240:243], v[180:183], v[112:115]
    v_lshlrev_b32 v237, 4, v253
    v_add_u32 v237, 81920, v237
    ds_read_b128 v[16:19], v237 offset:0
    ds_read_b128 v[20:23], v237 offset:4096
    ds_read_b128 v[24:27], v237 offset:24576
    ds_read_b128 v[28:31], v237 offset:28672
    v_mfma_f32_16x16x32_bf16 v[116:119], a[244:247], v[180:183], v[116:119]
    s_add_u32 m0, s34, 49152
    s_add_u32 s37, s86, 65536
    buffer_load_dwordx4 v232, s[44:47], s37 offen lds
    v_mfma_f32_16x16x32_bf16 v[120:123], a[248:251], v[180:183], v[120:123]
    v_mfma_f32_16x16x32_bf16 v[124:127], a[252:255], v[180:183], v[124:127]
    buffer_load_dwordx4 v233, s[44:47], s37 offen offset:1024 lds
    v_mfma_f32_16x16x32_bf16 v[128:131], a[240:243], v[184:187], v[128:131]
    v_mfma_f32_16x16x32_bf16 v[132:135], a[244:247], v[184:187], v[132:135]
    s_add_u32 m0, s34, 57344
    s_add_u32 s37, s87, 65536
    buffer_load_dwordx4 v232, s[44:47], s37 offen lds
    v_cvt_pk_bf16_f32 v64, v96, v97
    v_cvt_pk_bf16_f32 v65, v98, v99
    v_mfma_f32_16x16x32_bf16 v[136:139], a[248:251], v[184:187], v[136:139]
    v_cvt_pk_bf16_f32 v66, v100, v101
    v_cvt_pk_bf16_f32 v67, v102, v103
    v_mfma_f32_16x16x32_bf16 v[140:143], a[252:255], v[184:187], v[140:143]
    buffer_load_dwordx4 v233, s[44:47], s37 offen offset:1024 lds
    v_cvt_pk_bf16_f32 v68, v104, v105
    v_cvt_pk_bf16_f32 v69, v106, v107
    v_mfma_f32_16x16x32_bf16 v[144:147], a[240:243], v[188:191], v[144:147]
    v_cvt_pk_bf16_f32 v70, v108, v109
    v_cvt_pk_bf16_f32 v71, v110, v111
    v_mfma_f32_16x16x32_bf16 v[148:151], a[244:247], v[188:191], v[148:151]
    v_cvt_pk_bf16_f32 v72, v112, v113
    v_cvt_pk_bf16_f32 v73, v114, v115
    v_mfma_f32_16x16x32_bf16 v[152:155], a[248:251], v[188:191], v[152:155]
    v_cvt_pk_bf16_f32 v74, v116, v117
    v_cvt_pk_bf16_f32 v75, v118, v119
    v_mfma_f32_16x16x32_bf16 v[156:159], a[252:255], v[188:191], v[156:159]
    v_cvt_pk_bf16_f32 v76, v120, v121
    v_cvt_pk_bf16_f32 v77, v122, v123
    s_waitcnt lgkmcnt(0)
    v_mfma_f32_16x16x32_bf16 v[96:99], a[0:3], v[160:163], 0
    ds_read_b128 v[176:179], v225 offset:0
    v_cvt_pk_bf16_f32 v78, v124, v125
    v_cvt_pk_bf16_f32 v79, v126, v127
    v_mfma_f32_16x16x32_bf16 v[100:103], a[4:7], v[160:163], 0
    ds_read_b128 v[180:183], v225 offset:2048
    v_cvt_pk_bf16_f32 v80, v128, v129
    v_cvt_pk_bf16_f32 v81, v130, v131
    v_mfma_f32_16x16x32_bf16 v[104:107], a[8:11], v[160:163], 0
    ds_read_b128 v[184:187], v225 offset:4096
    v_cvt_pk_bf16_f32 v82, v132, v133
    v_cvt_pk_bf16_f32 v83, v134, v135
    v_mfma_f32_16x16x32_bf16 v[108:111], a[12:15], v[160:163], 0
    ds_read_b128 v[188:191], v225 offset:6144
    v_cvt_pk_bf16_f32 v84, v136, v137
    v_cvt_pk_bf16_f32 v85, v138, v139
    v_mfma_f32_16x16x32_bf16 v[112:115], a[0:3], v[164:167], 0
    v_cvt_pk_bf16_f32 v86, v140, v141
    v_cvt_pk_bf16_f32 v87, v142, v143
    s_mov_b32 s39, 0
    buffer_store_dwordx4 v[16:19], v238, s[8:11], s39 offen sc1
    v_mfma_f32_16x16x32_bf16 v[116:119], a[4:7], v[164:167], 0
    v_cvt_pk_bf16_f32 v88, v144, v145
    v_cvt_pk_bf16_f32 v89, v146, v147
    v_mfma_f32_16x16x32_bf16 v[120:123], a[8:11], v[164:167], 0
    v_cvt_pk_bf16_f32 v90, v148, v149
    v_cvt_pk_bf16_f32 v91, v150, v151
    v_mfma_f32_16x16x32_bf16 v[124:127], a[12:15], v[164:167], 0
    v_cvt_pk_bf16_f32 v92, v152, v153
    v_cvt_pk_bf16_f32 v93, v154, v155
    v_mfma_f32_16x16x32_bf16 v[128:131], a[0:3], v[168:171], 0
    v_cvt_pk_bf16_f32 v94, v156, v157
    v_cvt_pk_bf16_f32 v95, v158, v159
    v_mfma_f32_16x16x32_bf16 v[132:135], a[4:7], v[168:171], 0
    v_mfma_f32_16x16x32_bf16 v[136:139], a[8:11], v[168:171], 0
    v_mfma_f32_16x16x32_bf16 v[140:143], a[12:15], v[168:171], 0
    v_mfma_f32_16x16x32_bf16 v[144:147], a[0:3], v[172:175], 0
    v_mfma_f32_16x16x32_bf16 v[148:151], a[4:7], v[172:175], 0
    v_mfma_f32_16x16x32_bf16 v[152:155], a[8:11], v[172:175], 0
    v_mfma_f32_16x16x32_bf16 v[156:159], a[12:15], v[172:175], 0
    s_waitcnt lgkmcnt(0)
    v_mfma_f32_16x16x32_bf16 v[96:99], a[16:19], v[176:179], v[96:99]
    ds_read_b128 v[160:163], v224 offset:8192
    v_mfma_f32_16x16x32_bf16 v[100:103], a[20:23], v[176:179], v[100:103]
    ds_read_b128 v[164:167], v224 offset:10240
    v_mfma_f32_16x16x32_bf16 v[104:107], a[24:27], v[176:179], v[104:107]
    ds_read_b128 v[168:171], v224 offset:12288
    v_mfma_f32_16x16x32_bf16 v[108:111], a[28:31], v[176:179], v[108:111]
    ds_read_b128 v[172:175], v224 offset:14336
    v_mfma_f32_16x16x32_bf16 v[112:115], a[16:19], v[180:183], v[112:115]
    v_mfma_f32_16x16x32_bf16 v[116:119], a[20:23], v[180:183], v[116:119]
    v_mfma_f32_16x16x32_bf16 v[120:123], a[24:27], v[180:183], v[120:123]
    v_mfma_f32_16x16x32_bf16 v[124:127], a[28:31], v[180:183], v[124:127]
    v_mfma_f32_16x16x32_bf16 v[128:131], a[16:19], v[184:187], v[128:131]
    v_mfma_f32_16x16x32_bf16 v[132:135], a[20:23], v[184:187], v[132:135]
    v_mfma_f32_16x16x32_bf16 v[136:139], a[24:27], v[184:187], v[136:139]
    s_mov_b32 s39, 16384
    buffer_store_dwordx4 v[20:23], v238, s[8:11], s39 offen sc1
    v_mfma_f32_16x16x32_bf16 v[140:143], a[28:31], v[184:187], v[140:143]
    v_mfma_f32_16x16x32_bf16 v[144:147], a[16:19], v[188:191], v[144:147]
    v_mfma_f32_16x16x32_bf16 v[148:151], a[20:23], v[188:191], v[148:151]
    v_mfma_f32_16x16x32_bf16 v[152:155], a[24:27], v[188:191], v[152:155]
    v_mfma_f32_16x16x32_bf16 v[156:159], a[28:31], v[188:191], v[156:159]
    s_waitcnt lgkmcnt(0)
    v_mfma_f32_16x16x32_bf16 v[96:99], a[32:35], v[160:163], v[96:99]
    ds_read_b128 v[176:179], v225 offset:8192
    v_mfma_f32_16x16x32_bf16 v[100:103], a[36:39], v[160:163], v[100:103]
    ds_read_b128 v[180:183], v225 offset:10240
    v_mfma_f32_16x16x32_bf16 v[104:107], a[40:43], v[160:163], v[104:107]
    ds_read_b128 v[184:187], v225 offset:12288
    v_mfma_f32_16x16x32_bf16 v[108:111], a[44:47], v[160:163], v[108:111]
    ds_read_b128 v[188:191], v225 offset:14336
    v_mfma_f32_16x16x32_bf16 v[112:115], a[32:35], v[164:167], v[112:115]
    v_mfma_f32_16x16x32_bf16 v[116:119], a[36:39], v[164:167], v[116:119]
    v_mfma_f32_16x16x32_bf16 v[120:123], a[40:43], v[164:167], v[120:123]
    v_mfma_f32_16x16x32_bf16 v[124:127], a[44:47], v[164:167], v[124:127]
    v_mfma_f32_16x16x32_bf16 v[128:131], a[32:35], v[168:171], v[128:131]
    v_mfma_f32_16x16x32_bf16 v[132:135], a[36:39], v[168:171], v[132:135]
    v_mfma_f32_16x16x32_bf16 v[136:139], a[40:43], v[168:171], v[136:139]
    v_mfma_f32_16x16x32_bf16 v[140:143], a[44:47], v[168:171], v[140:143]
    v_mfma_f32_16x16x32_bf16 v[144:147], a[32:35], v[172:175], v[144:147]
    v_mfma_f32_16x16x32_bf16 v[148:151], a[36:39], v[172:175], v[148:151]
    v_mfma_f32_16x16x32_bf16 v[152:155], a[40:43], v[172:175], v[152:155]
    v_mfma_f32_16x16x32_bf16 v[156:159], a[44:47], v[172:175], v[156:159]
    s_waitcnt vmcnt(6) lgkmcnt(0)
    s_barrier
    v_mfma_f32_16x16x32_bf16 v[96:99], a[48:51], v[176:179], v[96:99]
    ds_read_b128 v[160:163], v224 offset:16384
    s_mov_b32 s39, 32768
    buffer_store_dwordx4 v[24:27], v238, s[8:11], s39 offen sc1
    v_mfma_f32_16x16x32_bf16 v[100:103], a[52:55], v[176:179], v[100:103]
    ds_read_b128 v[164:167], v224 offset:18432
    v_mfma_f32_16x16x32_bf16 v[104:107], a[56:59], v[176:179], v[104:107]
    ds_read_b128 v[168:171], v224 offset:20480
    v_mfma_f32_16x16x32_bf16 v[108:111], a[60:63], v[176:179], v[108:111]
    ds_read_b128 v[172:175], v224 offset:22528
    v_mfma_f32_16x16x32_bf16 v[112:115], a[48:51], v[180:183], v[112:115]
    v_mfma_f32_16x16x32_bf16 v[116:119], a[52:55], v[180:183], v[116:119]
    s_add_u32 m0, s34, 98304
    s_add_u32 s37, s80, 131072
    buffer_load_dwordx4 v232, s[44:47], s37 offen lds
    v_mfma_f32_16x16x32_bf16 v[120:123], a[56:59], v[180:183], v[120:123]
    v_mfma_f32_16x16x32_bf16 v[124:127], a[60:63], v[180:183], v[124:127]
    buffer_load_dwordx4 v233, s[44:47], s37 offen offset:1024 lds
    v_mfma_f32_16x16x32_bf16 v[128:131], a[48:51], v[184:187], v[128:131]
    v_mfma_f32_16x16x32_bf16 v[132:135], a[52:55], v[184:187], v[132:135]
    v_mfma_f32_16x16x32_bf16 v[136:139], a[56:59], v[184:187], v[136:139]
    v_mfma_f32_16x16x32_bf16 v[140:143], a[60:63], v[184:187], v[140:143]
    v_mfma_f32_16x16x32_bf16 v[144:147], a[48:51], v[188:191], v[144:147]
    v_mfma_f32_16x16x32_bf16 v[148:151], a[52:55], v[188:191], v[148:151]
    v_mfma_f32_16x16x32_bf16 v[152:155], a[56:59], v[188:191], v[152:155]
    v_mfma_f32_16x16x32_bf16 v[156:159], a[60:63], v[188:191], v[156:159]
    s_waitcnt lgkmcnt(0)
    v_mfma_f32_16x16x32_bf16 v[96:99], a[64:67], v[160:163], v[96:99]
    ds_read_b128 v[176:179], v225 offset:16384
    v_mfma_f32_16x16x32_bf16 v[100:103], a[68:71], v[160:163], v[100:103]
    ds_read_b128 v[180:183], v225 offset:18432
    v_mfma_f32_16x16x32_bf16 v[104:107], a[72:75], v[160:163], v[104:107]
    ds_read_b128 v[184:187], v225 offset:20480
    v_mfma_f32_16x16x32_bf16 v[108:111], a[76:79], v[160:163], v[108:111]
    ds_read_b128 v[188:191], v225 offset:22528
    v_mfma_f32_16x16x32_bf16 v[112:115], a[64:67], v[164:167], v[112:115]
    v_mfma_f32_16x16x32_bf16 v[116:119], a[68:71], v[164:167], v[116:119]
    s_add_u32 m0, s34, 106496
    s_add_u32 s37, s81, 131072
    buffer_load_dwordx4 v232, s[44:47], s37 offen lds
    v_mfma_f32_16x16x32_bf16 v[120:123], a[72:75], v[164:167], v[120:123]
    s_mov_b32 s39, 49152
    buffer_store_dwordx4 v[28:31], v238, s[8:11], s39 offen sc1
    v_mfma_f32_16x16x32_bf16 v[124:127], a[76:79], v[164:167], v[124:127]
    buffer_load_dwordx4 v233, s[44:47], s37 offen offset:1024 lds
    v_mfma_f32_16x16x32_bf16 v[128:131], a[64:67], v[168:171], v[128:131]
    v_mfma_f32_16x16x32_bf16 v[132:135], a[68:71], v[168:171], v[132:135]
    v_mfma_f32_16x16x32_bf16 v[136:139], a[72:75], v[168:171], v[136:139]
    v_mfma_f32_16x16x32_bf16 v[140:143], a[76:79], v[168:171], v[140:143]
    v_mfma_f32_16x16x32_bf16 v[144:147], a[64:67], v[172:175], v[144:147]
    v_mfma_f32_16x16x32_bf16 v[148:151], a[68:71], v[172:175], v[148:151]
    v_mfma_f32_16x16x32_bf16 v[152:155], a[72:75], v[172:175], v[152:155]
    v_mfma_f32_16x16x32_bf16 v[156:159], a[76:79], v[172:175], v[156:159]
    s_waitcnt lgkmcnt(0)
    v_mfma_f32_16x16x32_bf16 v[96:99], a[80:83], v[176:179], v[96:99]
    ds_read_b128 v[160:163], v224 offset:24576
    v_mfma_f32_16x16x32_bf16 v[100:103], a[84:87], v[176:179], v[100:103]
    ds_read_b128 v[164:167], v224 offset:26624
    v_mfma_f32_16x16x32_bf16 v[104:107], a[88:91], v[176:179], v[104:107]
    ds_read_b128 v[168:171], v224 offset:28672
    v_mfma_f32_16x16x32_bf16 v[108:111], a[92:95], v[176:179], v[108:111]
    ds_read_b128 v[172:175], v224 offset:30720
    v_mfma_f32_16x16x32_bf16 v[112:115], a[80:83], v[180:183], v[112:115]
    v_mfma_f32_16x16x32_bf16 v[116:119], a[84:87], v[180:183], v[116:119]
    v_mfma_f32_16x16x32_bf16 v[120:123], a[88:91], v[180:183], v[120:123]
    v_mfma_f32_16x16x32_bf16 v[124:127], a[92:95], v[180:183], v[124:127]
    v_mfma_f32_16x16x32_bf16 v[128:131], a[80:83], v[184:187], v[128:131]
    v_mfma_f32_16x16x32_bf16 v[132:135], a[84:87], v[184:187], v[132:135]
    v_mfma_f32_16x16x32_bf16 v[136:139], a[88:91], v[184:187], v[136:139]
    v_mfma_f32_16x16x32_bf16 v[140:143], a[92:95], v[184:187], v[140:143]
    v_mfma_f32_16x16x32_bf16 v[144:147], a[80:83], v[188:191], v[144:147]
    s_add_u32 s38, s36, 0
    buffer_store_dwordx4 v[64:67], v240, s[16:19], s38 offen offset:0 sc1
    v_mfma_f32_16x16x32_bf16 v[148:151], a[84:87], v[188:191], v[148:151]
    v_mfma_f32_16x16x32_bf16 v[152:155], a[88:91], v[188:191], v[152:155]
    v_mfma_f32_16x16x32_bf16 v[156:159], a[92:95], v[188:191], v[156:159]
    s_waitcnt lgkmcnt(0)
    v_mfma_f32_16x16x32_bf16 v[96:99], a[96:99], v[160:163], v[96:99]
    ds_read_b128 v[176:179], v225 offset:24576
    v_mfma_f32_16x16x32_bf16 v[100:103], a[100:103], v[160:163], v[100:103]
    ds_read_b128 v[180:183], v225 offset:26624
    v_mfma_f32_16x16x32_bf16 v[104:107], a[104:107], v[160:163], v[104:107]
    ds_read_b128 v[184:187], v225 offset:28672
    v_mfma_f32_16x16x32_bf16 v[108:111], a[108:111], v[160:163], v[108:111]
    ds_read_b128 v[188:191], v225 offset:30720
    v_mfma_f32_16x16x32_bf16 v[112:115], a[96:99], v[164:167], v[112:115]
    v_mfma_f32_16x16x32_bf16 v[116:119], a[100:103], v[164:167], v[116:119]
    s_add_u32 m0, s34, 114688
    s_add_u32 s37, s82, 131072
    buffer_load_dwordx4 v232, s[44:47], s37 offen lds
    v_mfma_f32_16x16x32_bf16 v[120:123], a[104:107], v[164:167], v[120:123]
    v_mfma_f32_16x16x32_bf16 v[124:127], a[108:111], v[164:167], v[124:127]
    buffer_load_dwordx4 v233, s[44:47], s37 offen offset:1024 lds
    v_mfma_f32_16x16x32_bf16 v[128:131], a[96:99], v[168:171], v[128:131]
    v_mfma_f32_16x16x32_bf16 v[132:135], a[100:103], v[168:171], v[132:135]
    v_mfma_f32_16x16x32_bf16 v[136:139], a[104:107], v[168:171], v[136:139]
    v_mfma_f32_16x16x32_bf16 v[140:143], a[108:111], v[168:171], v[140:143]
    v_mfma_f32_16x16x32_bf16 v[144:147], a[96:99], v[172:175], v[144:147]
    v_mfma_f32_16x16x32_bf16 v[148:151], a[100:103], v[172:175], v[148:151]
    v_mfma_f32_16x16x32_bf16 v[152:155], a[104:107], v[172:175], v[152:155]
    v_mfma_f32_16x16x32_bf16 v[156:159], a[108:111], v[172:175], v[156:159]
    s_waitcnt lgkmcnt(0)
    v_mfma_f32_16x16x32_bf16 v[96:99], a[112:115], v[176:179], v[96:99]
    ds_read_b128 v[160:163], v224 offset:32768
    v_mfma_f32_16x16x32_bf16 v[100:103], a[116:119], v[176:179], v[100:103]
    ds_read_b128 v[164:167], v224 offset:34816
    v_mfma_f32_16x16x32_bf16 v[104:107], a[120:123], v[176:179], v[104:107]
    ds_read_b128 v[168:171], v224 offset:36864
    s_add_u32 s38, s36, 0
    buffer_store_dwordx4 v[68:71], v240, s[16:19], s38 offen offset:2048 sc1
    v_mfma_f32_16x16x32_bf16 v[108:111], a[124:127], v[176:179], v[108:111]
    ds_read_b128 v[172:175], v224 offset:38912
    v_mfma_f32_16x16x32_bf16 v[112:115], a[112:115], v[180:183], v[112:115]
    v_mfma_f32_16x16x32_bf16 v[116:119], a[116:119], v[180:183], v[116:119]
    s_add_u32 m0, s34, 122880
    s_add_u32 s37, s83, 131072
    buffer_load_dwordx4 v232, s[44:47], s37 offen lds
    v_mfma_f32_16x16x32_bf16 v[120:123], a[120:123], v[180:183], v[120:123]
    v_mfma_f32_16x16x32_bf16 v[124:127], a[124:127], v[180:183], v[124:127]
    buffer_load_dwordx4 v233, s[44:47], s37 offen offset:1024 lds
    v_mfma_f32_16x16x32_bf16 v[128:131], a[112:115], v[184:187], v[128:131]
    v_mfma_f32_16x16x32_bf16 v[132:135], a[116:119], v[184:187], v[132:135]
    v_mfma_f32_16x16x32_bf16 v[136:139], a[120:123], v[184:187], v[136:139]
    v_mfma_f32_16x16x32_bf16 v[140:143], a[124:127], v[184:187], v[140:143]
    v_mfma_f32_16x16x32_bf16 v[144:147], a[112:115], v[188:191], v[144:147]
    v_mfma_f32_16x16x32_bf16 v[148:151], a[116:119], v[188:191], v[148:151]
    v_mfma_f32_16x16x32_bf16 v[152:155], a[120:123], v[188:191], v[152:155]
    v_mfma_f32_16x16x32_bf16 v[156:159], a[124:127], v[188:191], v[156:159]
    s_waitcnt lgkmcnt(0)
    v_mfma_f32_16x16x32_bf16 v[96:99], a[128:131], v[160:163], v[96:99]
    ds_read_b128 v[176:179], v225 offset:32768
    v_mfma_f32_16x16x32_bf16 v[100:103], a[132:135], v[160:163], v[100:103]
    ds_read_b128 v[180:183], v225 offset:34816
    v_mfma_f32_16x16x32_bf16 v[104:107], a[136:139], v[160:163], v[104:107]
    ds_read_b128 v[184:187], v225 offset:36864
    v_mfma_f32_16x16x32_bf16 v[108:111], a[140:143], v[160:163], v[108:111]
    ds_read_b128 v[188:191], v225 offset:38912
    v_mfma_f32_16x16x32_bf16 v[112:115], a[128:131], v[164:167], v[112:115]
    v_mfma_f32_16x16x32_bf16 v[116:119], a[132:135], v[164:167], v[116:119]
    v_mfma_f32_16x16x32_bf16 v[120:123], a[136:139], v[164:167], v[120:123]
    v_mfma_f32_16x16x32_bf16 v[124:127], a[140:143], v[164:167], v[124:127]
    v_mfma_f32_16x16x32_bf16 v[128:131], a[128:131], v[168:171], v[128:131]
    s_add_u32 s38, s36, 0
    buffer_store_dwordx4 v[72:75], v240, s[16:19], s38 offen offset:1024 sc1
    v_mfma_f32_16x16x32_bf16 v[132:135], a[132:135], v[168:171], v[132:135]
    v_mfma_f32_16x16x32_bf16 v[136:139], a[136:139], v[168:171], v[136:139]
    v_mfma_f32_16x16x32_bf16 v[140:143], a[140:143], v[168:171], v[140:143]
    v_mfma_f32_16x16x32_bf16 v[144:147], a[128:131], v[172:175], v[144:147]
    v_mfma_f32_16x16x32_bf16 v[148:151], a[132:135], v[172:175], v[148:151]
    v_mfma_f32_16x16x32_bf16 v[152:155], a[136:139], v[172:175], v[152:155]
    v_mfma_f32_16x16x32_bf16 v[156:159], a[140:143], v[172:175], v[156:159]
    s_waitcnt lgkmcnt(0)
    v_mfma_f32_16x16x32_bf16 v[96:99], a[144:147], v[176:179], v[96:99]
    ds_read_b128 v[160:163], v224 offset:40960
    v_mfma_f32_16x16x32_bf16 v[100:103], a[148:151], v[176:179], v[100:103]
    ds_read_b128 v[164:167], v224 offset:43008
    v_mfma_f32_16x16x32_bf16 v[104:107], a[152:155], v[176:179], v[104:107]
    ds_read_b128 v[168:171], v224 offset:45056
    v_mfma_f32_16x16x32_bf16 v[108:111], a[156:159], v[176:179], v[108:111]
    ds_read_b128 v[172:175], v224 offset:47104
    v_mfma_f32_16x16x32_bf16 v[112:115], a[144:147], v[180:183], v[112:115]
    v_mfma_f32_16x16x32_bf16 v[116:119], a[148:151], v[180:183], v[116:119]
    s_add_u32 m0, s34, 131072
    s_add_u32 s37, s84, 131072
    buffer_load_dwordx4 v232, s[44:47], s37 offen lds
    v_mfma_f32_16x16x32_bf16 v[120:123], a[152:155], v[180:183], v[120:123]
    v_mfma_f32_16x16x32_bf16 v[124:127], a[156:159], v[180:183], v[124:127]
    buffer_load_dwordx4 v233, s[44:47], s37 offen offset:1024 lds
    v_mfma_f32_16x16x32_bf16 v[128:131], a[144:147], v[184:187], v[128:131]
    v_mfma_f32_16x16x32_bf16 v[132:135], a[148:151], v[184:187], v[132:135]
    v_mfma_f32_16x16x32_bf16 v[136:139], a[152:155], v[184:187], v[136:139]
    v_mfma_f32_16x16x32_bf16 v[140:143], a[156:159], v[184:187], v[140:143]
    v_mfma_f32_16x16x32_bf16 v[144:147], a[144:147], v[188:191], v[144:147]
    v_mfma_f32_16x16x32_bf16 v[148:151], a[148:151], v[188:191], v[148:151]
    v_mfma_f32_16x16x32_bf16 v[152:155], a[152:155], v[188:191], v[152:155]
    s_add_u32 s38, s36, 0
    buffer_store_dwordx4 v[76:79], v240, s[16:19], s38 offen offset:3072 sc1
    v_mfma_f32_16x16x32_bf16 v[156:159], a[156:159], v[188:191], v[156:159]
    s_waitcnt lgkmcnt(0)
    v_mfma_f32_16x16x32_bf16 v[96:99], a[160:163], v[160:163], v[96:99]
    ds_read_b128 v[176:179], v225 offset:40960
    v_mfma_f32_16x16x32_bf16 v[100:103], a[164:167], v[160:163], v[100:103]
    ds_read_b128 v[180:183], v225 offset:43008
    v_mfma_f32_16x16x32_bf16 v[104:107], a[168:171], v[160:163], v[104:107]
    ds_read_b128 v[184:187], v225 offset:45056
    v_mfma_f32_16x16x32_bf16 v[108:111], a[172:175], v[160:163], v[108:111]
    ds_read_b128 v[188:191], v225 offset:47104
    v_mfma_f32_16x16x32_bf16 v[112:115], a[160:163], v[164:167], v[112:115]
    v_mfma_f32_16x16x32_bf16 v[116:119], a[164:167], v[164:167], v[116:119]
    s_add_u32 m0, s34, 139264
    s_add_u32 s37, s85, 131072
    buffer_load_dwordx4 v232, s[44:47], s37 offen lds
    v_mfma_f32_16x16x32_bf16 v[120:123], a[168:171], v[164:167], v[120:123]
    v_mfma_f32_16x16x32_bf16 v[124:127], a[172:175], v[164:167], v[124:127]
    buffer_load_dwordx4 v233, s[44:47], s37 offen offset:1024 lds
    v_mfma_f32_16x16x32_bf16 v[128:131], a[160:163], v[168:171], v[128:131]
    v_mfma_f32_16x16x32_bf16 v[132:135], a[164:167], v[168:171], v[132:135]
    v_mfma_f32_16x16x32_bf16 v[136:139], a[168:171], v[168:171], v[136:139]
    v_mfma_f32_16x16x32_bf16 v[140:143], a[172:175], v[168:171], v[140:143]
    v_mfma_f32_16x16x32_bf16 v[144:147], a[160:163], v[172:175], v[144:147]
    v_mfma_f32_16x16x32_bf16 v[148:151], a[164:167], v[172:175], v[148:151]
    v_mfma_f32_16x16x32_bf16 v[152:155], a[168:171], v[172:175], v[152:155]
    v_mfma_f32_16x16x32_bf16 v[156:159], a[172:175], v[172:175], v[156:159]
    s_waitcnt vmcnt(13) lgkmcnt(0)
    s_barrier
    v_mfma_f32_16x16x32_bf16 v[96:99], a[176:179], v[176:179], v[96:99]
    ds_read_b128 v[160:163], v224 offset:49152
    v_mfma_f32_16x16x32_bf16 v[100:103], a[180:183], v[176:179], v[100:103]
    ds_read_b128 v[164:167], v224 offset:51200
    v_mfma_f32_16x16x32_bf16 v[104:107], a[184:187], v[176:179], v[104:107]
    ds_read_b128 v[168:171], v224 offset:53248
    v_mfma_f32_16x16x32_bf16 v[108:111], a[188:191], v[176:179], v[108:111]
    ds_read_b128 v[172:175], v224 offset:55296
    v_mfma_f32_16x16x32_bf16 v[112:115], a[176:179], v[180:183], v[112:115]
    s_add_u32 s38, s36, 8192
    buffer_store_dwordx4 v[80:83], v240, s[16:19], s38 offen offset:0 sc1
    v_mfma_f32_16x16x32_bf16 v[116:119], a[180:183], v[180:183], v[116:119]
    s_lshl_b32 s39, s5, 2
    buffer_atomic_add v255, v250, s[88:91], s39 offen sc1
    s_cmp_eq_u32 s3, 0
    s_cselect_b32 s39, s39, s43
    v_mfma_f32_16x16x32_bf16 v[120:123], a[184:187], v[180:183], v[120:123]
    v_mfma_f32_16x16x32_bf16 v[124:127], a[188:191], v[180:183], v[124:127]
    v_mfma_f32_16x16x32_bf16 v[128:131], a[176:179], v[184:187], v[128:131]
    v_mfma_f32_16x16x32_bf16 v[132:135], a[180:183], v[184:187], v[132:135]
    v_mfma_f32_16x16x32_bf16 v[136:139], a[184:187], v[184:187], v[136:139]
    v_mfma_f32_16x16x32_bf16 v[140:143], a[188:191], v[184:187], v[140:143]
    v_mfma_f32_16x16x32_bf16 v[144:147], a[176:179], v[188:191], v[144:147]
    v_mfma_f32_16x16x32_bf16 v[148:151], a[180:183], v[188:191], v[148:151]
    v_mfma_f32_16x16x32_bf16 v[152:155], a[184:187], v[188:191], v[152:155]
    v_mfma_f32_16x16x32_bf16 v[156:159], a[188:191], v[188:191], v[156:159]
    s_waitcnt lgkmcnt(0)
    v_mfma_f32_16x16x32_bf16 v[96:99], a[192:195], v[160:163], v[96:99]
    ds_read_b128 v[176:179], v225 offset:49152
    v_mfma_f32_16x16x32_bf16 v[100:103], a[196:199], v[160:163], v[100:103]
    ds_read_b128 v[180:183], v225 offset:51200
    v_mfma_f32_16x16x32_bf16 v[104:107], a[200:203], v[160:163], v[104:107]
    ds_read_b128 v[184:187], v225 offset:53248
    v_mfma_f32_16x16x32_bf16 v[108:111], a[204:207], v[160:163], v[108:111]
    ds_read_b128 v[188:191], v225 offset:55296
    v_mfma_f32_16x16x32_bf16 v[112:115], a[192:195], v[164:167], v[112:115]
    v_mfma_f32_16x16x32_bf16 v[116:119], a[196:199], v[164:167], v[116:119]
    s_add_u32 m0, s34, 147456
    s_add_u32 s37, s86, 131072
    buffer_load_dwordx4 v232, s[44:47], s37 offen lds
    v_mfma_f32_16x16x32_bf16 v[120:123], a[200:203], v[164:167], v[120:123]
    v_mfma_f32_16x16x32_bf16 v[124:127], a[204:207], v[164:167], v[124:127]
    buffer_load_dwordx4 v233, s[44:47], s37 offen offset:1024 lds
    v_mfma_f32_16x16x32_bf16 v[128:131], a[192:195], v[168:171], v[128:131]
    v_mfma_f32_16x16x32_bf16 v[132:135], a[196:199], v[168:171], v[132:135]
    v_mfma_f32_16x16x32_bf16 v[136:139], a[200:203], v[168:171], v[136:139]
    s_add_u32 s38, s36, 8192
    buffer_store_dwordx4 v[84:87], v240, s[16:19], s38 offen offset:2048 sc1
    v_mfma_f32_16x16x32_bf16 v[140:143], a[204:207], v[168:171], v[140:143]
    v_mfma_f32_16x16x32_bf16 v[144:147], a[192:195], v[172:175], v[144:147]
    v_mfma_f32_16x16x32_bf16 v[148:151], a[196:199], v[172:175], v[148:151]
    v_mfma_f32_16x16x32_bf16 v[152:155], a[200:203], v[172:175], v[152:155]
    v_mfma_f32_16x16x32_bf16 v[156:159], a[204:207], v[172:175], v[156:159]
    s_waitcnt lgkmcnt(0)
    v_mfma_f32_16x16x32_bf16 v[96:99], a[208:211], v[176:179], v[96:99]
    ds_read_b128 v[160:163], v224 offset:57344
    v_mfma_f32_16x16x32_bf16 v[100:103], a[212:215], v[176:179], v[100:103]
    ds_read_b128 v[164:167], v224 offset:59392
    v_mfma_f32_16x16x32_bf16 v[104:107], a[216:219], v[176:179], v[104:107]
    ds_read_b128 v[168:171], v224 offset:61440
    v_mfma_f32_16x16x32_bf16 v[108:111], a[220:223], v[176:179], v[108:111]
    ds_read_b128 v[172:175], v224 offset:63488
    v_mfma_f32_16x16x32_bf16 v[112:115], a[208:211], v[180:183], v[112:115]
    v_mfma_f32_16x16x32_bf16 v[116:119], a[212:215], v[180:183], v[116:119]
    s_add_u32 m0, s34, 155648
    s_add_u32 s37, s87, 131072
    buffer_load_dwordx4 v232, s[44:47], s37 offen lds
    v_mfma_f32_16x16x32_bf16 v[120:123], a[216:219], v[180:183], v[120:123]
    v_mfma_f32_16x16x32_bf16 v[124:127], a[220:223], v[180:183], v[124:127]
    buffer_load_dwordx4 v233, s[44:47], s37 offen offset:1024 lds
    v_mfma_f32_16x16x32_bf16 v[128:131], a[208:211], v[184:187], v[128:131]
    v_mfma_f32_16x16x32_bf16 v[132:135], a[212:215], v[184:187], v[132:135]
    v_mfma_f32_16x16x32_bf16 v[136:139], a[216:219], v[184:187], v[136:139]
    v_mfma_f32_16x16x32_bf16 v[140:143], a[220:223], v[184:187], v[140:143]
    v_mfma_f32_16x16x32_bf16 v[144:147], a[208:211], v[188:191], v[144:147]
    v_mfma_f32_16x16x32_bf16 v[148:151], a[212:215], v[188:191], v[148:151]
    v_mfma_f32_16x16x32_bf16 v[152:155], a[216:219], v[188:191], v[152:155]
    v_mfma_f32_16x16x32_bf16 v[156:159], a[220:223], v[188:191], v[156:159]
    s_waitcnt lgkmcnt(0)
    v_mfma_f32_16x16x32_bf16 v[96:99], a[224:227], v[160:163], v[96:99]
    ds_read_b128 v[176:179], v225 offset:57344
    s_add_u32 s38, s36, 8192
    buffer_store_dwordx4 v[88:91], v240, s[16:19], s38 offen offset:1024 sc1
    v_mfma_f32_16x16x32_bf16 v[100:103], a[228:231], v[160:163], v[100:103]
    ds_read_b128 v[180:183], v225 offset:59392
    v_mfma_f32_16x16x32_bf16 v[104:107], a[232:235], v[160:163], v[104:107]
    ds_read_b128 v[184:187], v225 offset:61440
    v_mfma_f32_16x16x32_bf16 v[108:111], a[236:239], v[160:163], v[108:111]
    ds_read_b128 v[188:191], v225 offset:63488
    v_mfma_f32_16x16x32_bf16 v[112:115], a[224:227], v[164:167], v[112:115]
    v_mfma_f32_16x16x32_bf16 v[116:119], a[228:231], v[164:167], v[116:119]
    v_mfma_f32_16x16x32_bf16 v[120:123], a[232:235], v[164:167], v[120:123]
    v_mfma_f32_16x16x32_bf16 v[124:127], a[236:239], v[164:167], v[124:127]
    v_mfma_f32_16x16x32_bf16 v[128:131], a[224:227], v[168:171], v[128:131]
    v_mfma_f32_16x16x32_bf16 v[132:135], a[228:231], v[168:171], v[132:135]
    v_mfma_f32_16x16x32_bf16 v[136:139], a[232:235], v[168:171], v[136:139]
    v_mfma_f32_16x16x32_bf16 v[140:143], a[236:239], v[168:171], v[140:143]
    v_mfma_f32_16x16x32_bf16 v[144:147], a[224:227], v[172:175], v[144:147]
    v_mfma_f32_16x16x32_bf16 v[148:151], a[228:231], v[172:175], v[148:151]
    v_mfma_f32_16x16x32_bf16 v[152:155], a[232:235], v[172:175], v[152:155]
    v_mfma_f32_16x16x32_bf16 v[156:159], a[236:239], v[172:175], v[156:159]
    s_waitcnt vmcnt(14) lgkmcnt(0)
    s_barrier
    v_mfma_f32_16x16x32_bf16 v[96:99], a[240:243], v[176:179], v[96:99]
    ds_read_b128 v[160:163], v226 offset:0
    v_mfma_f32_16x16x32_bf16 v[100:103], a[244:247], v[176:179], v[100:103]
    ds_read_b128 v[164:167], v226 offset:2048
    v_mfma_f32_16x16x32_bf16 v[104:107], a[248:251], v[176:179], v[104:107]
    ds_read_b128 v[168:171], v226 offset:4096
    v_mfma_f32_16x16x32_bf16 v[108:111], a[252:255], v[176:179], v[108:111]
    ds_read_b128 v[172:175], v226 offset:6144
    v_mfma_f32_16x16x32_bf16 v[112:115], a[240:243], v[180:183], v[112:115]
    v_mfma_f32_16x16x32_bf16 v[116:119], a[244:247], v[180:183], v[116:119]
    v_mfma_f32_16x16x32_bf16 v[120:123], a[248:251], v[180:183], v[120:123]
    s_add_u32 s38, s36, 8192
    buffer_store_dwordx4 v[92:95], v240, s[16:19], s38 offen offset:3072 sc1
    v_mfma_f32_16x16x32_bf16 v[124:127], a[252:255], v[180:183], v[124:127]
    v_mfma_f32_16x16x32_bf16 v[128:131], a[240:243], v[184:187], v[128:131]
    v_mfma_f32_16x16x32_bf16 v[132:135], a[244:247], v[184:187], v[132:135]
    v_cvt_pk_bf16_f32 v64, v96, v97
    v_cvt_pk_bf16_f32 v65, v98, v99
    v_mfma_f32_16x16x32_bf16 v[136:139], a[248:251], v[184:187], v[136:139]
    v_cvt_pk_bf16_f32 v66, v100, v101
    v_cvt_pk_bf16_f32 v67, v102, v103
    v_mfma_f32_16x16x32_bf16 v[140:143], a[252:255], v[184:187], v[140:143]
    v_cvt_pk_bf16_f32 v68, v104, v105
    v_cvt_pk_bf16_f32 v69, v106, v107
    v_mfma_f32_16x16x32_bf16 v[144:147], a[240:243], v[188:191], v[144:147]
    v_cvt_pk_bf16_f32 v70, v108, v109
    v_cvt_pk_bf16_f32 v71, v110, v111
    v_mfma_f32_16x16x32_bf16 v[148:151], a[244:247], v[188:191], v[148:151]
    v_cvt_pk_bf16_f32 v72, v112, v113
    v_cvt_pk_bf16_f32 v73, v114, v115
    v_mfma_f32_16x16x32_bf16 v[152:155], a[248:251], v[188:191], v[152:155]
    v_cvt_pk_bf16_f32 v74, v116, v117
    v_cvt_pk_bf16_f32 v75, v118, v119
    v_mfma_f32_16x16x32_bf16 v[156:159], a[252:255], v[188:191], v[156:159]
    v_cvt_pk_bf16_f32 v76, v120, v121
    v_cvt_pk_bf16_f32 v77, v122, v123
    s_waitcnt lgkmcnt(0)
    v_mfma_f32_16x16x32_bf16 v[96:99], a[0:3], v[160:163], 0
    ds_read_b128 v[176:179], v227 offset:0
    v_cvt_pk_bf16_f32 v78, v124, v125
    v_cvt_pk_bf16_f32 v79, v126, v127
    v_mfma_f32_16x16x32_bf16 v[100:103], a[4:7], v[160:163], 0
    ds_read_b128 v[180:183], v227 offset:2048
    v_cvt_pk_bf16_f32 v80, v128, v129
    v_cvt_pk_bf16_f32 v81, v130, v131
    v_mfma_f32_16x16x32_bf16 v[104:107], a[8:11], v[160:163], 0
    ds_read_b128 v[184:187], v227 offset:4096
    v_cvt_pk_bf16_f32 v82, v132, v133
    v_cvt_pk_bf16_f32 v83, v134, v135
    v_mfma_f32_16x16x32_bf16 v[108:111], a[12:15], v[160:163], 0
    ds_read_b128 v[188:191], v227 offset:6144
    v_cvt_pk_bf16_f32 v84, v136, v137
    v_cvt_pk_bf16_f32 v85, v138, v139
    v_mfma_f32_16x16x32_bf16 v[112:115], a[0:3], v[164:167], 0
    v_cvt_pk_bf16_f32 v86, v140, v141
    v_cvt_pk_bf16_f32 v87, v142, v143
    v_mfma_f32_16x16x32_bf16 v[116:119], a[4:7], v[164:167], 0
    s_add_u32 m0, s34, 0
    s_add_u32 s37, s80, 196608
    buffer_load_dwordx4 v232, s[44:47], s37 offen lds
    v_cvt_pk_bf16_f32 v88, v144, v145
    v_cvt_pk_bf16_f32 v89, v146, v147
    v_mfma_f32_16x16x32_bf16 v[120:123], a[8:11], v[164:167], 0
    v_cvt_pk_bf16_f32 v90, v148, v149
    v_cvt_pk_bf16_f32 v91, v150, v151
    v_mfma_f32_16x16x32_bf16 v[124:127], a[12:15], v[164:167], 0
    buffer_load_dwordx4 v233, s[44:47], s37 offen offset:1024 lds
    v_cvt_pk_bf16_f32 v92, v152, v153
    v_cvt_pk_bf16_f32 v93, v154, v155
    v_mfma_f32_16x16x32_bf16 v[128:131], a[0:3], v[168:171], 0
    v_cvt_pk_bf16_f32 v94, v156, v157
    v_cvt_pk_bf16_f32 v95, v158, v159
    v_mfma_f32_16x16x32_bf16 v[132:135], a[4:7], v[168:171], 0
    v_mfma_f32_16x16x32_bf16 v[136:139], a[8:11], v[168:171], 0
    s_add_u32 s38, s36, 32768
    buffer_store_dwordx4 v[64:67], v240, s[16:19], s38 offen offset:0 sc1
    v_mfma_f32_16x16x32_bf16 v[140:143], a[12:15], v[168:171], 0
    v_mfma_f32_16x16x32_bf16 v[144:147], a[0:3], v[172:175], 0
    v_mfma_f32_16x16x32_bf16 v[148:151], a[4:7], v[172:175], 0
    v_mfma_f32_16x16x32_bf16 v[152:155], a[8:11], v[172:175], 0
    v_mfma_f32_16x16x32_bf16 v[156:159], a[12:15], v[172:175], 0
    s_waitcnt lgkmcnt(0)
    v_mfma_f32_16x16x32_bf16 v[96:99], a[16:19], v[176:179], v[96:99]
    ds_read_b128 v[160:163], v226 offset:8192
    v_mfma_f32_16x16x32_bf16 v[100:103], a[20:23], v[176:179], v[100:103]
    ds_read_b128 v[164:167], v226 offset:10240
    v_mfma_f32_16x16x32_bf16 v[104:107], a[24:27], v[176:179], v[104:107]
    ds_read_b128 v[168:171], v226 offset:12288
    v_mfma_f32_16x16x32_bf16 v[108:111], a[28:31], v[176:179], v[108:111]
    ds_read_b128 v[172:175], v226 offset:14336
    v_mfma_f32_16x16x32_bf16 v[112:115], a[16:19], v[180:183], v[112:115]
    v_mfma_f32_16x16x32_bf16 v[116:119], a[20:23], v[180:183], v[116:119]
    s_add_u32 m0, s31, 0
    s_add_u32 s24, s27, 0
    buffer_load_dwordx4 v245, s[12:15], s24 offen lds
    v_mfma_f32_16x16x32_bf16 v[120:123], a[24:27], v[180:183], v[120:123]
    v_mfma_f32_16x16x32_bf16 v[124:127], a[28:31], v[180:183], v[124:127]
    v_mfma_f32_16x16x32_bf16 v[128:131], a[16:19], v[184:187], v[128:131]
    v_mfma_f32_16x16x32_bf16 v[132:135], a[20:23], v[184:187], v[132:135]
    v_mfma_f32_16x16x32_bf16 v[136:139], a[24:27], v[184:187], v[136:139]
    v_mfma_f32_16x16x32_bf16 v[140:143], a[28:31], v[184:187], v[140:143]
    v_mfma_f32_16x16x32_bf16 v[144:147], a[16:19], v[188:191], v[144:147]
    v_mfma_f32_16x16x32_bf16 v[148:151], a[20:23], v[188:191], v[148:151]
    v_mfma_f32_16x16x32_bf16 v[152:155], a[24:27], v[188:191], v[152:155]
    v_mfma_f32_16x16x32_bf16 v[156:159], a[28:31], v[188:191], v[156:159]
    s_waitcnt lgkmcnt(0)
    v_mfma_f32_16x16x32_bf16 v[96:99], a[32:35], v[160:163], v[96:99]
    ds_read_b128 v[176:179], v227 offset:8192
    v_mfma_f32_16x16x32_bf16 v[100:103], a[36:39], v[160:163], v[100:103]
    ds_read_b128 v[180:183], v227 offset:10240
    v_mfma_f32_16x16x32_bf16 v[104:107], a[40:43], v[160:163], v[104:107]
    ds_read_b128 v[184:187], v227 offset:12288
    v_mfma_f32_16x16x32_bf16 v[108:111], a[44:47], v[160:163], v[108:111]
    ds_read_b128 v[188:191], v227 offset:14336
    v_mfma_f32_16x16x32_bf16 v[112:115], a[32:35], v[164:167], v[112:115]
    v_mfma_f32_16x16x32_bf16 v[116:119], a[36:39], v[164:167], v[116:119]
    s_add_u32 m0, s34, 8192
    s_add_u32 s37, s81, 196608
    buffer_load_dwordx4 v232, s[44:47], s37 offen lds
    v_mfma_f32_16x16x32_bf16 v[120:123], a[40:43], v[164:167], v[120:123]
    v_mfma_f32_16x16x32_bf16 v[124:127], a[44:47], v[164:167], v[124:127]
    buffer_load_dwordx4 v233, s[44:47], s37 offen offset:1024 lds
    v_mfma_f32_16x16x32_bf16 v[128:131], a[32:35], v[168:171], v[128:131]
    v_mfma_f32_16x16x32_bf16 v[132:135], a[36:39], v[168:171], v[132:135]
    v_mfma_f32_16x16x32_bf16 v[136:139], a[40:43], v[168:171], v[136:139]
    s_add_u32 s38, s36, 32768
    buffer_store_dwordx4 v[68:71], v240, s[16:19], s38 offen offset:2048 sc1
    v_mfma_f32_16x16x32_bf16 v[140:143], a[44:47], v[168:171], v[140:143]
    v_mfma_f32_16x16x32_bf16 v[144:147], a[32:35], v[172:175], v[144:147]
    v_mfma_f32_16x16x32_bf16 v[148:151], a[36:39], v[172:175], v[148:151]
    v_mfma_f32_16x16x32_bf16 v[152:155], a[40:43], v[172:175], v[152:155]
    v_mfma_f32_16x16x32_bf16 v[156:159], a[44:47], v[172:175], v[156:159]
    s_waitcnt lgkmcnt(0)
    v_mfma_f32_16x16x32_bf16 v[96:99], a[48:51], v[176:179], v[96:99]
    ds_read_b128 v[160:163], v226 offset:16384
    v_mfma_f32_16x16x32_bf16 v[100:103], a[52:55], v[176:179], v[100:103]
    ds_read_b128 v[164:167], v226 offset:18432
    v_mfma_f32_16x16x32_bf16 v[104:107], a[56:59], v[176:179], v[104:107]
    ds_read_b128 v[168:171], v226 offset:20480
    v_mfma_f32_16x16x32_bf16 v[108:111], a[60:63], v[176:179], v[108:111]
    ds_read_b128 v[172:175], v226 offset:22528
    v_mfma_f32_16x16x32_bf16 v[112:115], a[48:51], v[180:183], v[112:115]
    v_mfma_f32_16x16x32_bf16 v[116:119], a[52:55], v[180:183], v[116:119]
    s_add_u32 m0, s31, 1024
    s_add_u32 s24, s27, 32768
    buffer_load_dwordx4 v245, s[12:15], s24 offen lds
    v_mfma_f32_16x16x32_bf16 v[120:123], a[56:59], v[180:183], v[120:123]
    v_mfma_f32_16x16x32_bf16 v[124:127], a[60:63], v[180:183], v[124:127]
    v_mfma_f32_16x16x32_bf16 v[128:131], a[48:51], v[184:187], v[128:131]
    v_mfma_f32_16x16x32_bf16 v[132:135], a[52:55], v[184:187], v[132:135]
    v_mfma_f32_16x16x32_bf16 v[136:139], a[56:59], v[184:187], v[136:139]
    v_mfma_f32_16x16x32_bf16 v[140:143], a[60:63], v[184:187], v[140:143]
    v_mfma_f32_16x16x32_bf16 v[144:147], a[48:51], v[188:191], v[144:147]
    v_mfma_f32_16x16x32_bf16 v[148:151], a[52:55], v[188:191], v[148:151]
    v_mfma_f32_16x16x32_bf16 v[152:155], a[56:59], v[188:191], v[152:155]
    v_mfma_f32_16x16x32_bf16 v[156:159], a[60:63], v[188:191], v[156:159]
    s_waitcnt lgkmcnt(0)
    v_mfma_f32_16x16x32_bf16 v[96:99], a[64:67], v[160:163], v[96:99]
    ds_read_b128 v[176:179], v227 offset:16384
    v_mfma_f32_16x16x32_bf16 v[100:103], a[68:71], v[160:163], v[100:103]
    ds_read_b128 v[180:183], v227 offset:18432
    v_mfma_f32_16x16x32_bf16 v[104:107], a[72:75], v[160:163], v[104:107]
    ds_read_b128 v[184:187], v227 offset:20480
    v_mfma_f32_16x16x32_bf16 v[108:111], a[76:79], v[160:163], v[108:111]
    ds_read_b128 v[188:191], v227 offset:22528
    v_mfma_f32_16x16x32_bf16 v[112:115], a[64:67], v[164:167], v[112:115]
    v_mfma_f32_16x16x32_bf16 v[116:119], a[68:71], v[164:167], v[116:119]
    s_add_u32 m0, s34, 16384
    s_add_u32 s37, s82, 196608
    buffer_load_dwordx4 v232, s[44:47], s37 offen lds
    v_mfma_f32_16x16x32_bf16 v[120:123], a[72:75], v[164:167], v[120:123]
    v_mfma_f32_16x16x32_bf16 v[124:127], a[76:79], v[164:167], v[124:127]
    buffer_load_dwordx4 v233, s[44:47], s37 offen offset:1024 lds
    v_mfma_f32_16x16x32_bf16 v[128:131], a[64:67], v[168:171], v[128:131]
    v_mfma_f32_16x16x32_bf16 v[132:135], a[68:71], v[168:171], v[132:135]
    v_mfma_f32_16x16x32_bf16 v[136:139], a[72:75], v[168:171], v[136:139]
    v_mfma_f32_16x16x32_bf16 v[140:143], a[76:79], v[168:171], v[140:143]
    s_add_u32 s38, s36, 32768
    buffer_store_dwordx4 v[72:75], v240, s[16:19], s38 offen offset:1024 sc1
    v_mfma_f32_16x16x32_bf16 v[144:147], a[64:67], v[172:175], v[144:147]
    v_mfma_f32_16x16x32_bf16 v[148:151], a[68:71], v[172:175], v[148:151]
    v_mfma_f32_16x16x32_bf16 v[152:155], a[72:75], v[172:175], v[152:155]
    v_mfma_f32_16x16x32_bf16 v[156:159], a[76:79], v[172:175], v[156:159]
    s_waitcnt lgkmcnt(0)
    v_mfma_f32_16x16x32_bf16 v[96:99], a[80:83], v[176:179], v[96:99]
    ds_read_b128 v[160:163], v226 offset:24576
    v_mfma_f32_16x16x32_bf16 v[100:103], a[84:87], v[176:179], v[100:103]
    ds_read_b128 v[164:167], v226 offset:26624
    v_mfma_f32_16x16x32_bf16 v[104:107], a[88:91], v[176:179], v[104:107]
    ds_read_b128 v[168:171], v226 offset:28672
    v_mfma_f32_16x16x32_bf16 v[108:111], a[92:95], v[176:179], v[108:111]
    ds_read_b128 v[172:175], v226 offset:30720
    v_mfma_f32_16x16x32_bf16 v[112:115], a[80:83], v[180:183], v[112:115]
    v_mfma_f32_16x16x32_bf16 v[116:119], a[84:87], v[180:183], v[116:119]
    s_add_u32 m0, s31, 2048
    s_add_u32 s24, s27, 65536
    buffer_load_dwordx4 v245, s[12:15], s24 offen lds
    v_mfma_f32_16x16x32_bf16 v[120:123], a[88:91], v[180:183], v[120:123]
    v_mfma_f32_16x16x32_bf16 v[124:127], a[92:95], v[180:183], v[124:127]
    v_mfma_f32_16x16x32_bf16 v[128:131], a[80:83], v[184:187], v[128:131]
    v_mfma_f32_16x16x32_bf16 v[132:135], a[84:87], v[184:187], v[132:135]
    v_mfma_f32_16x16x32_bf16 v[136:139], a[88:91], v[184:187], v[136:139]
    v_mfma_f32_16x16x32_bf16 v[140:143], a[92:95], v[184:187], v[140:143]
    v_mfma_f32_16x16x32_bf16 v[144:147], a[80:83], v[188:191], v[144:147]
    v_mfma_f32_16x16x32_bf16 v[148:151], a[84:87], v[188:191], v[148:151]
    v_mfma_f32_16x16x32_bf16 v[152:155], a[88:91], v[188:191], v[152:155]
    v_mfma_f32_16x16x32_bf16 v[156:159], a[92:95], v[188:191], v[156:159]
    s_waitcnt lgkmcnt(0)
    v_mfma_f32_16x16x32_bf16 v[96:99], a[96:99], v[160:163], v[96:99]
    ds_read_b128 v[176:179], v227 offset:24576
    v_mfma_f32_16x16x32_bf16 v[100:103], a[100:103], v[160:163], v[100:103]
    ds_read_b128 v[180:183], v227 offset:26624
    v_mfma_f32_16x16x32_bf16 v[104:107], a[104:107], v[160:163], v[104:107]
    ds_read_b128 v[184:187], v227 offset:28672
    v_mfma_f32_16x16x32_bf16 v[108:111], a[108:111], v[160:163], v[108:111]
    ds_read_b128 v[188:191], v227 offset:30720
    v_mfma_f32_16x16x32_bf16 v[112:115], a[96:99], v[164:167], v[112:115]
    v_mfma_f32_16x16x32_bf16 v[116:119], a[100:103], v[164:167], v[116:119]
    s_add_u32 m0, s34, 24576
    s_add_u32 s37, s83, 196608
    buffer_load_dwordx4 v232, s[44:47], s37 offen lds
    v_mfma_f32_16x16x32_bf16 v[120:123], a[104:107], v[164:167], v[120:123]
    v_mfma_f32_16x16x32_bf16 v[124:127], a[108:111], v[164:167], v[124:127]
    buffer_load_dwordx4 v233, s[44:47], s37 offen offset:1024 lds
    v_mfma_f32_16x16x32_bf16 v[128:131], a[96:99], v[168:171], v[128:131]
    v_mfma_f32_16x16x32_bf16 v[132:135], a[100:103], v[168:171], v[132:135]
    v_mfma_f32_16x16x32_bf16 v[136:139], a[104:107], v[168:171], v[136:139]
    v_mfma_f32_16x16x32_bf16 v[140:143], a[108:111], v[168:171], v[140:143]
    v_mfma_f32_16x16x32_bf16 v[144:147], a[96:99], v[172:175], v[144:147]
    s_add_u32 s38, s36, 32768
    buffer_store_dwordx4 v[76:79], v240, s[16:19], s38 offen offset:3072 sc1
    v_mfma_f32_16x16x32_bf16 v[148:151], a[100:103], v[172:175], v[148:151]
    v_mfma_f32_16x16x32_bf16 v[152:155], a[104:107], v[172:175], v[152:155]
    v_mfma_f32_16x16x32_bf16 v[156:159], a[108:111], v[172:175], v[156:159]
    s_waitcnt vmcnt(17) lgkmcnt(0)
    s_barrier
    v_mfma_f32_16x16x32_bf16 v[96:99], a[112:115], v[176:179], v[96:99]
    ds_read_b128 v[160:163], v226 offset:32768
    v_mfma_f32_16x16x32_bf16 v[100:103], a[116:119], v[176:179], v[100:103]
    ds_read_b128 v[164:167], v226 offset:34816
    v_mfma_f32_16x16x32_bf16 v[104:107], a[120:123], v[176:179], v[104:107]
    ds_read_b128 v[168:171], v226 offset:36864
    v_mfma_f32_16x16x32_bf16 v[108:111], a[124:127], v[176:179], v[108:111]
    ds_read_b128 v[172:175], v226 offset:38912
    v_mfma_f32_16x16x32_bf16 v[112:115], a[112:115], v[180:183], v[112:115]
    v_mfma_f32_16x16x32_bf16 v[116:119], a[116:119], v[180:183], v[116:119]
    s_add_u32 m0, s31, 3072
    s_add_u32 s24, s27, 98304
    buffer_load_dwordx4 v245, s[12:15], s24 offen lds
    v_mfma_f32_16x16x32_bf16 v[120:123], a[120:123], v[180:183], v[120:123]
    v_mfma_f32_16x16x32_bf16 v[124:127], a[124:127], v[180:183], v[124:127]
    v_mfma_f32_16x16x32_bf16 v[128:131], a[112:115], v[184:187], v[128:131]
    v_mfma_f32_16x16x32_bf16 v[132:135], a[116:119], v[184:187], v[132:135]
    v_mfma_f32_16x16x32_bf16 v[136:139], a[120:123], v[184:187], v[136:139]
    v_mfma_f32_16x16x32_bf16 v[140:143], a[124:127], v[184:187], v[140:143]
    v_mfma_f32_16x16x32_bf16 v[144:147], a[112:115], v[188:191], v[144:147]
    v_mfma_f32_16x16x32_bf16 v[148:151], a[116:119], v[188:191], v[148:151]
    v_mfma_f32_16x16x32_bf16 v[152:155], a[120:123], v[188:191], v[152:155]
    v_mfma_f32_16x16x32_bf16 v[156:159], a[124:127], v[188:191], v[156:159]
    s_waitcnt lgkmcnt(0)
    v_mfma_f32_16x16x32_bf16 v[96:99], a[128:131], v[160:163], v[96:99]
    ds_read_b128 v[176:179], v227 offset:32768
    v_mfma_f32_16x16x32_bf16 v[100:103], a[132:135], v[160:163], v[100:103]
    ds_read_b128 v[180:183], v227 offset:34816
    v_mfma_f32_16x16x32_bf16 v[104:107], a[136:139], v[160:163], v[104:107]
    ds_read_b128 v[184:187], v227 offset:36864
    v_mfma_f32_16x16x32_bf16 v[108:111], a[140:143], v[160:163], v[108:111]
    ds_read_b128 v[188:191], v227 offset:38912
    v_mfma_f32_16x16x32_bf16 v[112:115], a[128:131], v[164:167], v[112:115]
    v_mfma_f32_16x16x32_bf16 v[116:119], a[132:135], v[164:167], v[116:119]
    s_add_u32 m0, s34, 32768
    s_add_u32 s37, s84, 196608
    buffer_load_dwordx4 v232, s[44:47], s37 offen lds
    v_mfma_f32_16x16x32_bf16 v[120:123], a[136:139], v[164:167], v[120:123]
    v_mfma_f32_16x16x32_bf16 v[124:127], a[140:143], v[164:167], v[124:127]
    buffer_load_dwordx4 v233, s[44:47], s37 offen offset:1024 lds
    v_mfma_f32_16x16x32_bf16 v[128:131], a[128:131], v[168:171], v[128:131]
    v_mfma_f32_16x16x32_bf16 v[132:135], a[132:135], v[168:171], v[132:135]
    v_mfma_f32_16x16x32_bf16 v[136:139], a[136:139], v[168:171], v[136:139]
    v_mfma_f32_16x16x32_bf16 v[140:143], a[140:143], v[168:171], v[140:143]
    v_mfma_f32_16x16x32_bf16 v[144:147], a[128:131], v[172:175], v[144:147]
    v_mfma_f32_16x16x32_bf16 v[148:151], a[132:135], v[172:175], v[148:151]
    s_add_u32 s38, s36, 40960
    buffer_store_dwordx4 v[80:83], v240, s[16:19], s38 offen offset:0 sc1
    v_mfma_f32_16x16x32_bf16 v[152:155], a[136:139], v[172:175], v[152:155]
    v_mfma_f32_16x16x32_bf16 v[156:159], a[140:143], v[172:175], v[156:159]
    s_waitcnt lgkmcnt(0)
    v_mfma_f32_16x16x32_bf16 v[96:99], a[144:147], v[176:179], v[96:99]
    ds_read_b128 v[160:163], v226 offset:40960
    v_mfma_f32_16x16x32_bf16 v[100:103], a[148:151], v[176:179], v[100:103]
    ds_read_b128 v[164:167], v226 offset:43008
    v_mfma_f32_16x16x32_bf16 v[104:107], a[152:155], v[176:179], v[104:107]
    ds_read_b128 v[168:171], v226 offset:45056
    v_mfma_f32_16x16x32_bf16 v[108:111], a[156:159], v[176:179], v[108:111]
    ds_read_b128 v[172:175], v226 offset:47104
    v_mfma_f32_16x16x32_bf16 v[112:115], a[144:147], v[180:183], v[112:115]
    v_mfma_f32_16x16x32_bf16 v[116:119], a[148:151], v[180:183], v[116:119]
    s_add_u32 m0, s31, 4096
    s_add_u32 s24, s27, 131072
    buffer_load_dwordx4 v245, s[12:15], s24 offen lds
    v_mfma_f32_16x16x32_bf16 v[120:123], a[152:155], v[180:183], v[120:123]
    v_mfma_f32_16x16x32_bf16 v[124:127], a[156:159], v[180:183], v[124:127]
    v_mfma_f32_16x16x32_bf16 v[128:131], a[144:147], v[184:187], v[128:131]
    v_mfma_f32_16x16x32_bf16 v[132:135], a[148:151], v[184:187], v[132:135]
    v_mfma_f32_16x16x32_bf16 v[136:139], a[152:155], v[184:187], v[136:139]
    v_mfma_f32_16x16x32_bf16 v[140:143], a[156:159], v[184:187], v[140:143]
    v_mfma_f32_16x16x32_bf16 v[144:147], a[144:147], v[188:191], v[144:147]
    v_mfma_f32_16x16x32_bf16 v[148:151], a[148:151], v[188:191], v[148:151]
    v_mfma_f32_16x16x32_bf16 v[152:155], a[152:155], v[188:191], v[152:155]
    v_mfma_f32_16x16x32_bf16 v[156:159], a[156:159], v[188:191], v[156:159]
    s_waitcnt lgkmcnt(0)
    v_mfma_f32_16x16x32_bf16 v[96:99], a[160:163], v[160:163], v[96:99]
    ds_read_b128 v[176:179], v227 offset:40960
    v_mfma_f32_16x16x32_bf16 v[100:103], a[164:167], v[160:163], v[100:103]
    ds_read_b128 v[180:183], v227 offset:43008
    v_mfma_f32_16x16x32_bf16 v[104:107], a[168:171], v[160:163], v[104:107]
    ds_read_b128 v[184:187], v227 offset:45056
    v_mfma_f32_16x16x32_bf16 v[108:111], a[172:175], v[160:163], v[108:111]
    ds_read_b128 v[188:191], v227 offset:47104
    v_mfma_f32_16x16x32_bf16 v[112:115], a[160:163], v[164:167], v[112:115]
    v_mfma_f32_16x16x32_bf16 v[116:119], a[164:167], v[164:167], v[116:119]
    s_add_u32 m0, s34, 40960
    s_add_u32 s37, s85, 196608
    buffer_load_dwordx4 v232, s[44:47], s37 offen lds
    v_mfma_f32_16x16x32_bf16 v[120:123], a[168:171], v[164:167], v[120:123]
    v_mfma_f32_16x16x32_bf16 v[124:127], a[172:175], v[164:167], v[124:127]
    buffer_load_dwordx4 v233, s[44:47], s37 offen offset:1024 lds
    v_mfma_f32_16x16x32_bf16 v[128:131], a[160:163], v[168:171], v[128:131]
    v_mfma_f32_16x16x32_bf16 v[132:135], a[164:167], v[168:171], v[132:135]
    v_mfma_f32_16x16x32_bf16 v[136:139], a[168:171], v[168:171], v[136:139]
    v_mfma_f32_16x16x32_bf16 v[140:143], a[172:175], v[168:171], v[140:143]
    v_mfma_f32_16x16x32_bf16 v[144:147], a[160:163], v[172:175], v[144:147]
    v_mfma_f32_16x16x32_bf16 v[148:151], a[164:167], v[172:175], v[148:151]
    v_mfma_f32_16x16x32_bf16 v[152:155], a[168:171], v[172:175], v[152:155]
    s_add_u32 s38, s36, 40960
    buffer_store_dwordx4 v[84:87], v240, s[16:19], s38 offen offset:2048 sc1
    v_mfma_f32_16x16x32_bf16 v[156:159], a[172:175], v[172:175], v[156:159]
    s_waitcnt lgkmcnt(0)
    v_mfma_f32_16x16x32_bf16 v[96:99], a[176:179], v[176:179], v[96:99]
    ds_read_b128 v[160:163], v226 offset:49152
    v_mfma_f32_16x16x32_bf16 v[100:103], a[180:183], v[176:179], v[100:103]
    ds_read_b128 v[164:167], v226 offset:51200
    v_mfma_f32_16x16x32_bf16 v[104:107], a[184:187], v[176:179], v[104:107]
    ds_read_b128 v[168:171], v226 offset:53248
    v_mfma_f32_16x16x32_bf16 v[108:111], a[188:191], v[176:179], v[108:111]
    ds_read_b128 v[172:175], v226 offset:55296
    v_mfma_f32_16x16x32_bf16 v[112:115], a[176:179], v[180:183], v[112:115]
    v_mfma_f32_16x16x32_bf16 v[116:119], a[180:183], v[180:183], v[116:119]
    s_add_u32 m0, s31, 5120
    s_add_u32 s24, s27, 163840
    buffer_load_dwordx4 v245, s[12:15], s24 offen lds
    v_mfma_f32_16x16x32_bf16 v[120:123], a[184:187], v[180:183], v[120:123]
    v_mfma_f32_16x16x32_bf16 v[124:127], a[188:191], v[180:183], v[124:127]
    v_mfma_f32_16x16x32_bf16 v[128:131], a[176:179], v[184:187], v[128:131]
    v_mfma_f32_16x16x32_bf16 v[132:135], a[180:183], v[184:187], v[132:135]
    v_mfma_f32_16x16x32_bf16 v[136:139], a[184:187], v[184:187], v[136:139]
    v_mfma_f32_16x16x32_bf16 v[140:143], a[188:191], v[184:187], v[140:143]
    v_mfma_f32_16x16x32_bf16 v[144:147], a[176:179], v[188:191], v[144:147]
    v_mfma_f32_16x16x32_bf16 v[148:151], a[180:183], v[188:191], v[148:151]
    v_mfma_f32_16x16x32_bf16 v[152:155], a[184:187], v[188:191], v[152:155]
    v_mfma_f32_16x16x32_bf16 v[156:159], a[188:191], v[188:191], v[156:159]
    s_waitcnt lgkmcnt(0)
    v_mfma_f32_16x16x32_bf16 v[96:99], a[192:195], v[160:163], v[96:99]
    ds_read_b128 v[176:179], v227 offset:49152
    v_mfma_f32_16x16x32_bf16 v[100:103], a[196:199], v[160:163], v[100:103]
    ds_read_b128 v[180:183], v227 offset:51200
    v_mfma_f32_16x16x32_bf16 v[104:107], a[200:203], v[160:163], v[104:107]
    ds_read_b128 v[184:187], v227 offset:53248
    v_mfma_f32_16x16x32_bf16 v[108:111], a[204:207], v[160:163], v[108:111]
    ds_read_b128 v[188:191], v227 offset:55296
    v_mfma_f32_16x16x32_bf16 v[112:115], a[192:195], v[164:167], v[112:115]
    v_mfma_f32_16x16x32_bf16 v[116:119], a[196:199], v[164:167], v[116:119]
    s_add_u32 m0, s34, 49152
    s_add_u32 s37, s86, 196608
    buffer_load_dwordx4 v232, s[44:47], s37 offen lds
    v_mfma_f32_16x16x32_bf16 v[120:123], a[200:203], v[164:167], v[120:123]
    v_mfma_f32_16x16x32_bf16 v[124:127], a[204:207], v[164:167], v[124:127]
    buffer_load_dwordx4 v233, s[44:47], s37 offen offset:1024 lds
    v_mfma_f32_16x16x32_bf16 v[128:131], a[192:195], v[168:171], v[128:131]
    v_mfma_f32_16x16x32_bf16 v[132:135], a[196:199], v[168:171], v[132:135]
    v_mfma_f32_16x16x32_bf16 v[136:139], a[200:203], v[168:171], v[136:139]
    v_mfma_f32_16x16x32_bf16 v[140:143], a[204:207], v[168:171], v[140:143]
    v_mfma_f32_16x16x32_bf16 v[144:147], a[192:195], v[172:175], v[144:147]
    v_mfma_f32_16x16x32_bf16 v[148:151], a[196:199], v[172:175], v[148:151]
    v_mfma_f32_16x16x32_bf16 v[152:155], a[200:203], v[172:175], v[152:155]
    v_mfma_f32_16x16x32_bf16 v[156:159], a[204:207], v[172:175], v[156:159]
    s_add_u32 s38, s36, 40960
    buffer_store_dwordx4 v[88:91], v240, s[16:19], s38 offen offset:1024 sc1
    s_waitcnt lgkmcnt(0)
    v_mfma_f32_16x16x32_bf16 v[96:99], a[208:211], v[176:179], v[96:99]
    ds_read_b128 v[160:163], v226 offset:57344
    v_mfma_f32_16x16x32_bf16 v[100:103], a[212:215], v[176:179], v[100:103]
    ds_read_b128 v[164:167], v226 offset:59392
    v_mfma_f32_16x16x32_bf16 v[104:107], a[216:219], v[176:179], v[104:107]
    ds_read_b128 v[168:171], v226 offset:61440
    v_mfma_f32_16x16x32_bf16 v[108:111], a[220:223], v[176:179], v[108:111]
    ds_read_b128 v[172:175], v226 offset:63488
    v_mfma_f32_16x16x32_bf16 v[112:115], a[208:211], v[180:183], v[112:115]
    v_mfma_f32_16x16x32_bf16 v[116:119], a[212:215], v[180:183], v[116:119]
    s_add_u32 m0, s31, 6144
    s_add_u32 s24, s27, 196608
    buffer_load_dwordx4 v245, s[12:15], s24 offen lds
    v_mfma_f32_16x16x32_bf16 v[120:123], a[216:219], v[180:183], v[120:123]
    v_mfma_f32_16x16x32_bf16 v[124:127], a[220:223], v[180:183], v[124:127]
    v_mfma_f32_16x16x32_bf16 v[128:131], a[208:211], v[184:187], v[128:131]
    v_mfma_f32_16x16x32_bf16 v[132:135], a[212:215], v[184:187], v[132:135]
    v_mfma_f32_16x16x32_bf16 v[136:139], a[216:219], v[184:187], v[136:139]
    v_mfma_f32_16x16x32_bf16 v[140:143], a[220:223], v[184:187], v[140:143]
    v_mfma_f32_16x16x32_bf16 v[144:147], a[208:211], v[188:191], v[144:147]
    v_mfma_f32_16x16x32_bf16 v[148:151], a[212:215], v[188:191], v[148:151]
    v_mfma_f32_16x16x32_bf16 v[152:155], a[216:219], v[188:191], v[152:155]
    v_mfma_f32_16x16x32_bf16 v[156:159], a[220:223], v[188:191], v[156:159]
    s_waitcnt lgkmcnt(0)
    v_mfma_f32_16x16x32_bf16 v[96:99], a[224:227], v[160:163], v[96:99]
    ds_read_b128 v[176:179], v227 offset:57344
    v_mfma_f32_16x16x32_bf16 v[100:103], a[228:231], v[160:163], v[100:103]
    ds_read_b128 v[180:183], v227 offset:59392
    v_mfma_f32_16x16x32_bf16 v[104:107], a[232:235], v[160:163], v[104:107]
    ds_read_b128 v[184:187], v227 offset:61440
    v_mfma_f32_16x16x32_bf16 v[108:111], a[236:239], v[160:163], v[108:111]
    ds_read_b128 v[188:191], v227 offset:63488
    v_mfma_f32_16x16x32_bf16 v[112:115], a[224:227], v[164:167], v[112:115]
    v_mfma_f32_16x16x32_bf16 v[116:119], a[228:231], v[164:167], v[116:119]
    s_add_u32 m0, s34, 57344
    s_add_u32 s37, s87, 196608
    buffer_load_dwordx4 v232, s[44:47], s37 offen lds
    v_mfma_f32_16x16x32_bf16 v[120:123], a[232:235], v[164:167], v[120:123]
    v_mfma_f32_16x16x32_bf16 v[124:127], a[236:239], v[164:167], v[124:127]
    buffer_load_dwordx4 v233, s[44:47], s37 offen offset:1024 lds
    v_mfma_f32_16x16x32_bf16 v[128:131], a[224:227], v[168:171], v[128:131]
    v_mfma_f32_16x16x32_bf16 v[132:135], a[228:231], v[168:171], v[132:135]
    v_mfma_f32_16x16x32_bf16 v[136:139], a[232:235], v[168:171], v[136:139]
    v_mfma_f32_16x16x32_bf16 v[140:143], a[236:239], v[168:171], v[140:143]
    v_mfma_f32_16x16x32_bf16 v[144:147], a[224:227], v[172:175], v[144:147]
    v_mfma_f32_16x16x32_bf16 v[148:151], a[228:231], v[172:175], v[148:151]
    v_mfma_f32_16x16x32_bf16 v[152:155], a[232:235], v[172:175], v[152:155]
    v_mfma_f32_16x16x32_bf16 v[156:159], a[236:239], v[172:175], v[156:159]
    s_waitcnt vmcnt(16) lgkmcnt(0)
    s_barrier
    v_mfma_f32_16x16x32_bf16 v[96:99], a[240:243], v[176:179], v[96:99]
    ds_read_b128 v[160:163], v224 offset:0
    s_add_u32 s38, s36, 40960
    buffer_store_dwordx4 v[92:95], v240, s[16:19], s38 offen offset:3072 sc1
    v_mfma_f32_16x16x32_bf16 v[100:103], a[244:247], v[176:179], v[100:103]
    ds_read_b128 v[164:167], v224 offset:2048
    v_mfma_f32_16x16x32_bf16 v[104:107], a[248:251], v[176:179], v[104:107]
    ds_read_b128 v[168:171], v224 offset:4096
    v_mfma_f32_16x16x32_bf16 v[108:111], a[252:255], v[176:179], v[108:111]
    ds_read_b128 v[172:175], v224 offset:6144
    v_mfma_f32_16x16x32_bf16 v[112:115], a[240:243], v[180:183], v[112:115]
    v_mfma_f32_16x16x32_bf16 v[116:119], a[244:247], v[180:183], v[116:119]
    s_add_u32 m0, s31, 7168
    s_add_u32 s24, s27, 229376
    buffer_load_dwordx4 v245, s[12:15], s24 offen lds
    v_mfma_f32_16x16x32_bf16 v[120:123], a[248:251], v[180:183], v[120:123]
    v_mfma_f32_16x16x32_bf16 v[124:127], a[252:255], v[180:183], v[124:127]
    s_add_u32 s27, s27, 1048576
    s_and_b32 s27, s27, 0x407fffff
    s_cmp_eq_u32 s27, s7
    s_cselect_b32 s27, s43, s27
    v_mfma_f32_16x16x32_bf16 v[128:131], a[240:243], v[184:187], v[128:131]
    v_mfma_f32_16x16x32_bf16 v[132:135], a[244:247], v[184:187], v[132:135]
    s_add_u32 s31, s31, 32768
    s_cmp_ge_u32 s31, 163840
    s_cselect_b32 s24, 98304, 0
    s_sub_u32 s31, s31, s24
    v_cvt_pk_bf16_f32 v64, v96, v97
    v_cvt_pk_bf16_f32 v65, v98, v99
    v_mfma_f32_16x16x32_bf16 v[136:139], a[248:251], v[184:187], v[136:139]
    v_cvt_pk_bf16_f32 v66, v100, v101
    v_cvt_pk_bf16_f32 v67, v102, v103
    v_mfma_f32_16x16x32_bf16 v[140:143], a[252:255], v[184:187], v[140:143]
    v_cvt_pk_bf16_f32 v68, v104, v105
    v_cvt_pk_bf16_f32 v69, v106, v107
    v_mfma_f32_16x16x32_bf16 v[144:147], a[240:243], v[188:191], v[144:147]
    v_cvt_pk_bf16_f32 v70, v108, v109
    v_cvt_pk_bf16_f32 v71, v110, v111
    v_mfma_f32_16x16x32_bf16 v[148:151], a[244:247], v[188:191], v[148:151]
    v_cvt_pk_bf16_f32 v72, v112, v113
    v_cvt_pk_bf16_f32 v73, v114, v115
    v_mfma_f32_16x16x32_bf16 v[152:155], a[248:251], v[188:191], v[152:155]
    v_cvt_pk_bf16_f32 v74, v116, v117
    v_cvt_pk_bf16_f32 v75, v118, v119
    v_mfma_f32_16x16x32_bf16 v[156:159], a[252:255], v[188:191], v[156:159]
    v_cvt_pk_bf16_f32 v76, v120, v121
    v_cvt_pk_bf16_f32 v77, v122, v123
    s_waitcnt lgkmcnt(0)
    v_mfma_f32_16x16x32_bf16 v[96:99], a[0:3], v[160:163], 0
    ds_read_b128 v[176:179], v225 offset:0
    v_cvt_pk_bf16_f32 v78, v124, v125
    v_cvt_pk_bf16_f32 v79, v126, v127
    v_mfma_f32_16x16x32_bf16 v[100:103], a[4:7], v[160:163], 0
    ds_read_b128 v[180:183], v225 offset:2048
    v_cvt_pk_bf16_f32 v80, v128, v129
    v_cvt_pk_bf16_f32 v81, v130, v131
    v_mfma_f32_16x16x32_bf16 v[104:107], a[8:11], v[160:163], 0
    ds_read_b128 v[184:187], v225 offset:4096
    v_cvt_pk_bf16_f32 v82, v132, v133
    v_cvt_pk_bf16_f32 v83, v134, v135
    v_mfma_f32_16x16x32_bf16 v[108:111], a[12:15], v[160:163], 0
    ds_read_b128 v[188:191], v225 offset:6144
    v_cvt_pk_bf16_f32 v84, v136, v137
    v_cvt_pk_bf16_f32 v85, v138, v139
    v_mfma_f32_16x16x32_bf16 v[112:115], a[0:3], v[164:167], 0
    v_cvt_pk_bf16_f32 v86, v140, v141
    v_cvt_pk_bf16_f32 v87, v142, v143
    v_mfma_f32_16x16x32_bf16 v[116:119], a[4:7], v[164:167], 0
    s_add_u32 m0, s31, 0
    s_add_u32 s24, s27, 0
    buffer_load_dwordx4 v245, s[12:15], s24 offen lds
    v_cvt_pk_bf16_f32 v88, v144, v145
    v_cvt_pk_bf16_f32 v89, v146, v147
    v_mfma_f32_16x16x32_bf16 v[120:123], a[8:11], v[164:167], 0
    v_cvt_pk_bf16_f32 v90, v148, v149
    v_cvt_pk_bf16_f32 v91, v150, v151
    v_mfma_f32_16x16x32_bf16 v[124:127], a[12:15], v[164:167], 0
    v_cvt_pk_bf16_f32 v92, v152, v153
    v_cvt_pk_bf16_f32 v93, v154, v155
    v_mfma_f32_16x16x32_bf16 v[128:131], a[0:3], v[168:171], 0
    v_cvt_pk_bf16_f32 v94, v156, v157
    v_cvt_pk_bf16_f32 v95, v158, v159
    v_mfma_f32_16x16x32_bf16 v[132:135], a[4:7], v[168:171], 0
    v_mfma_f32_16x16x32_bf16 v[136:139], a[8:11], v[168:171], 0
    s_add_u32 s38, s36, 65536
    buffer_store_dwordx4 v[64:67], v240, s[16:19], s38 offen offset:0 sc1
    v_mfma_f32_16x16x32_bf16 v[140:143], a[12:15], v[168:171], 0
    v_mfma_f32_16x16x32_bf16 v[144:147], a[0:3], v[172:175], 0
    v_mfma_f32_16x16x32_bf16 v[148:151], a[4:7], v[172:175], 0
    v_mfma_f32_16x16x32_bf16 v[152:155], a[8:11], v[172:175], 0
    v_mfma_f32_16x16x32_bf16 v[156:159], a[12:15], v[172:175], 0
    s_waitcnt lgkmcnt(0)
    v_mfma_f32_16x16x32_bf16 v[96:99], a[16:19], v[176:179], v[96:99]
    ds_read_b128 v[160:163], v224 offset:8192
    v_mfma_f32_16x16x32_bf16 v[100:103], a[20:23], v[176:179], v[100:103]
    ds_read_b128 v[164:167], v224 offset:10240
    v_mfma_f32_16x16x32_bf16 v[104:107], a[24:27], v[176:179], v[104:107]
    ds_read_b128 v[168:171], v224 offset:12288
    v_mfma_f32_16x16x32_bf16 v[108:111], a[28:31], v[176:179], v[108:111]
    ds_read_b128 v[172:175], v224 offset:14336
    v_mfma_f32_16x16x32_bf16 v[112:115], a[16:19], v[180:183], v[112:115]
    v_mfma_f32_16x16x32_bf16 v[116:119], a[20:23], v[180:183], v[116:119]
    s_add_u32 m0, s31, 1024
    s_add_u32 s24, s27, 32768
    buffer_load_dwordx4 v245, s[12:15], s24 offen lds
    v_mfma_f32_16x16x32_bf16 v[120:123], a[24:27], v[180:183], v[120:123]
    v_mfma_f32_16x16x32_bf16 v[124:127], a[28:31], v[180:183], v[124:127]
    v_mfma_f32_16x16x32_bf16 v[128:131], a[16:19], v[184:187], v[128:131]
    v_mfma_f32_16x16x32_bf16 v[132:135], a[20:23], v[184:187], v[132:135]
    v_mfma_f32_16x16x32_bf16 v[136:139], a[24:27], v[184:187], v[136:139]
    v_mfma_f32_16x16x32_bf16 v[140:143], a[28:31], v[184:187], v[140:143]
    v_mfma_f32_16x16x32_bf16 v[144:147], a[16:19], v[188:191], v[144:147]
    v_mfma_f32_16x16x32_bf16 v[148:151], a[20:23], v[188:191], v[148:151]
    v_mfma_f32_16x16x32_bf16 v[152:155], a[24:27], v[188:191], v[152:155]
    v_mfma_f32_16x16x32_bf16 v[156:159], a[28:31], v[188:191], v[156:159]
    s_waitcnt lgkmcnt(0)
    v_mfma_f32_16x16x32_bf16 v[96:99], a[32:35], v[160:163], v[96:99]
    ds_read_b128 v[176:179], v225 offset:8192
    v_mfma_f32_16x16x32_bf16 v[100:103], a[36:39], v[160:163], v[100:103]
    ds_read_b128 v[180:183], v225 offset:10240
    v_mfma_f32_16x16x32_bf16 v[104:107], a[40:43], v[160:163], v[104:107]
    ds_read_b128 v[184:187], v225 offset:12288
    v_mfma_f32_16x16x32_bf16 v[108:111], a[44:47], v[160:163], v[108:111]
    ds_read_b128 v[188:191], v225 offset:14336
    v_mfma_f32_16x16x32_bf16 v[112:115], a[32:35], v[164:167], v[112:115]
    v_mfma_f32_16x16x32_bf16 v[116:119], a[36:39], v[164:167], v[116:119]
    s_add_u32 m0, s31, 2048
    s_add_u32 s24, s27, 65536
    buffer_load_dwordx4 v245, s[12:15], s24 offen lds
    v_mfma_f32_16x16x32_bf16 v[120:123], a[40:43], v[164:167], v[120:123]
    v_mfma_f32_16x16x32_bf16 v[124:127], a[44:47], v[164:167], v[124:127]
    v_mfma_f32_16x16x32_bf16 v[128:131], a[32:35], v[168:171], v[128:131]
    v_mfma_f32_16x16x32_bf16 v[132:135], a[36:39], v[168:171], v[132:135]
    v_mfma_f32_16x16x32_bf16 v[136:139], a[40:43], v[168:171], v[136:139]
    s_add_u32 s38, s36, 65536
    buffer_store_dwordx4 v[68:71], v240, s[16:19], s38 offen offset:2048 sc1
    v_mfma_f32_16x16x32_bf16 v[140:143], a[44:47], v[168:171], v[140:143]
    v_mfma_f32_16x16x32_bf16 v[144:147], a[32:35], v[172:175], v[144:147]
    v_mfma_f32_16x16x32_bf16 v[148:151], a[36:39], v[172:175], v[148:151]
    v_mfma_f32_16x16x32_bf16 v[152:155], a[40:43], v[172:175], v[152:155]
    v_mfma_f32_16x16x32_bf16 v[156:159], a[44:47], v[172:175], v[156:159]
    s_waitcnt lgkmcnt(0)
    v_mfma_f32_16x16x32_bf16 v[96:99], a[48:51], v[176:179], v[96:99]
    ds_read_b128 v[160:163], v224 offset:16384
    v_mfma_f32_16x16x32_bf16 v[100:103], a[52:55], v[176:179], v[100:103]
    ds_read_b128 v[164:167], v224 offset:18432
    v_mfma_f32_16x16x32_bf16 v[104:107], a[56:59], v[176:179], v[104:107]
    ds_read_b128 v[168:171], v224 offset:20480
    v_mfma_f32_16x16x32_bf16 v[108:111], a[60:63], v[176:179], v[108:111]
    ds_read_b128 v[172:175], v224 offset:22528
    v_mfma_f32_16x16x32_bf16 v[112:115], a[48:51], v[180:183], v[112:115]
    v_mfma_f32_16x16x32_bf16 v[116:119], a[52:55], v[180:183], v[116:119]
    s_add_u32 m0, s31, 3072
    s_add_u32 s24, s27, 98304
    buffer_load_dwordx4 v245, s[12:15], s24 offen lds
    v_mfma_f32_16x16x32_bf16 v[120:123], a[56:59], v[180:183], v[120:123]
    v_mfma_f32_16x16x32_bf16 v[124:127], a[60:63], v[180:183], v[124:127]
    v_mfma_f32_16x16x32_bf16 v[128:131], a[48:51], v[184:187], v[128:131]
    v_mfma_f32_16x16x32_bf16 v[132:135], a[52:55], v[184:187], v[132:135]
    v_mfma_f32_16x16x32_bf16 v[136:139], a[56:59], v[184:187], v[136:139]
    v_mfma_f32_16x16x32_bf16 v[140:143], a[60:63], v[184:187], v[140:143]
    v_mfma_f32_16x16x32_bf16 v[144:147], a[48:51], v[188:191], v[144:147]
    v_mfma_f32_16x16x32_bf16 v[148:151], a[52:55], v[188:191], v[148:151]
    v_mfma_f32_16x16x32_bf16 v[152:155], a[56:59], v[188:191], v[152:155]
    v_mfma_f32_16x16x32_bf16 v[156:159], a[60:63], v[188:191], v[156:159]
    s_waitcnt lgkmcnt(0)
    v_mfma_f32_16x16x32_bf16 v[96:99], a[64:67], v[160:163], v[96:99]
    ds_read_b128 v[176:179], v225 offset:16384
    v_mfma_f32_16x16x32_bf16 v[100:103], a[68:71], v[160:163], v[100:103]
    ds_read_b128 v[180:183], v225 offset:18432
    v_mfma_f32_16x16x32_bf16 v[104:107], a[72:75], v[160:163], v[104:107]
    ds_read_b128 v[184:187], v225 offset:20480
    v_mfma_f32_16x16x32_bf16 v[108:111], a[76:79], v[160:163], v[108:111]
    ds_read_b128 v[188:191], v225 offset:22528
    v_mfma_f32_16x16x32_bf16 v[112:115], a[64:67], v[164:167], v[112:115]
    v_mfma_f32_16x16x32_bf16 v[116:119], a[68:71], v[164:167], v[116:119]
    s_add_u32 m0, s31, 4096
    s_add_u32 s24, s27, 131072
    buffer_load_dwordx4 v245, s[12:15], s24 offen lds
    v_mfma_f32_16x16x32_bf16 v[120:123], a[72:75], v[164:167], v[120:123]
    v_mfma_f32_16x16x32_bf16 v[124:127], a[76:79], v[164:167], v[124:127]
    v_mfma_f32_16x16x32_bf16 v[128:131], a[64:67], v[168:171], v[128:131]
    v_mfma_f32_16x16x32_bf16 v[132:135], a[68:71], v[168:171], v[132:135]
    v_mfma_f32_16x16x32_bf16 v[136:139], a[72:75], v[168:171], v[136:139]
    v_mfma_f32_16x16x32_bf16 v[140:143], a[76:79], v[168:171], v[140:143]
    s_add_u32 s38, s36, 65536
    buffer_store_dwordx4 v[72:75], v240, s[16:19], s38 offen offset:1024 sc1
    v_mfma_f32_16x16x32_bf16 v[144:147], a[64:67], v[172:175], v[144:147]
    v_mfma_f32_16x16x32_bf16 v[148:151], a[68:71], v[172:175], v[148:151]
    v_mfma_f32_16x16x32_bf16 v[152:155], a[72:75], v[172:175], v[152:155]
    v_mfma_f32_16x16x32_bf16 v[156:159], a[76:79], v[172:175], v[156:159]
    s_waitcnt lgkmcnt(0)
    v_mfma_f32_16x16x32_bf16 v[96:99], a[80:83], v[176:179], v[96:99]
    ds_read_b128 v[160:163], v224 offset:24576
    v_mfma_f32_16x16x32_bf16 v[100:103], a[84:87], v[176:179], v[100:103]
    ds_read_b128 v[164:167], v224 offset:26624
    v_mfma_f32_16x16x32_bf16 v[104:107], a[88:91], v[176:179], v[104:107]
    ds_read_b128 v[168:171], v224 offset:28672
    v_mfma_f32_16x16x32_bf16 v[108:111], a[92:95], v[176:179], v[108:111]
    ds_read_b128 v[172:175], v224 offset:30720
    v_mfma_f32_16x16x32_bf16 v[112:115], a[80:83], v[180:183], v[112:115]
    v_mfma_f32_16x16x32_bf16 v[116:119], a[84:87], v[180:183], v[116:119]
    s_add_u32 m0, s31, 5120
    s_add_u32 s24, s27, 163840
    buffer_load_dwordx4 v245, s[12:15], s24 offen lds
    v_mfma_f32_16x16x32_bf16 v[120:123], a[88:91], v[180:183], v[120:123]
    v_mfma_f32_16x16x32_bf16 v[124:127], a[92:95], v[180:183], v[124:127]
    v_mfma_f32_16x16x32_bf16 v[128:131], a[80:83], v[184:187], v[128:131]
    v_mfma_f32_16x16x32_bf16 v[132:135], a[84:87], v[184:187], v[132:135]
    v_mfma_f32_16x16x32_bf16 v[136:139], a[88:91], v[184:187], v[136:139]
    v_mfma_f32_16x16x32_bf16 v[140:143], a[92:95], v[184:187], v[140:143]
    v_mfma_f32_16x16x32_bf16 v[144:147], a[80:83], v[188:191], v[144:147]
    v_mfma_f32_16x16x32_bf16 v[148:151], a[84:87], v[188:191], v[148:151]
    v_mfma_f32_16x16x32_bf16 v[152:155], a[88:91], v[188:191], v[152:155]
    v_mfma_f32_16x16x32_bf16 v[156:159], a[92:95], v[188:191], v[156:159]
    s_waitcnt lgkmcnt(0)
    v_mfma_f32_16x16x32_bf16 v[96:99], a[96:99], v[160:163], v[96:99]
    ds_read_b128 v[176:179], v225 offset:24576
    v_mfma_f32_16x16x32_bf16 v[100:103], a[100:103], v[160:163], v[100:103]
    ds_read_b128 v[180:183], v225 offset:26624
    v_mfma_f32_16x16x32_bf16 v[104:107], a[104:107], v[160:163], v[104:107]
    ds_read_b128 v[184:187], v225 offset:28672
    v_mfma_f32_16x16x32_bf16 v[108:111], a[108:111], v[160:163], v[108:111]
    ds_read_b128 v[188:191], v225 offset:30720
    v_mfma_f32_16x16x32_bf16 v[112:115], a[96:99], v[164:167], v[112:115]
    v_mfma_f32_16x16x32_bf16 v[116:119], a[100:103], v[164:167], v[116:119]
    buffer_load_dword v254, off, s[88:91], s39 sc1
    v_mfma_f32_16x16x32_bf16 v[120:123], a[104:107], v[164:167], v[120:123]
    v_mfma_f32_16x16x32_bf16 v[124:127], a[108:111], v[164:167], v[124:127]
    s_add_u32 m0, s31, 6144
    s_add_u32 s24, s27, 196608
    buffer_load_dwordx4 v245, s[12:15], s24 offen lds
    v_mfma_f32_16x16x32_bf16 v[128:131], a[96:99], v[168:171], v[128:131]
    v_mfma_f32_16x16x32_bf16 v[132:135], a[100:103], v[168:171], v[132:135]
    v_mfma_f32_16x16x32_bf16 v[136:139], a[104:107], v[168:171], v[136:139]
    v_mfma_f32_16x16x32_bf16 v[140:143], a[108:111], v[168:171], v[140:143]
    v_mfma_f32_16x16x32_bf16 v[144:147], a[96:99], v[172:175], v[144:147]
    s_add_u32 s38, s36, 65536
    buffer_store_dwordx4 v[76:79], v240, s[16:19], s38 offen offset:3072 sc1
    v_mfma_f32_16x16x32_bf16 v[148:151], a[100:103], v[172:175], v[148:151]
    v_mfma_f32_16x16x32_bf16 v[152:155], a[104:107], v[172:175], v[152:155]
    v_mfma_f32_16x16x32_bf16 v[156:159], a[108:111], v[172:175], v[156:159]
    s_waitcnt vmcnt(14) lgkmcnt(0)
    s_barrier
    v_mfma_f32_16x16x32_bf16 v[96:99], a[112:115], v[176:179], v[96:99]
    ds_read_b128 v[160:163], v224 offset:32768
    v_mfma_f32_16x16x32_bf16 v[100:103], a[116:119], v[176:179], v[100:103]
    ds_read_b128 v[164:167], v224 offset:34816
    v_mfma_f32_16x16x32_bf16 v[104:107], a[120:123], v[176:179], v[104:107]
    ds_read_b128 v[168:171], v224 offset:36864
    v_mfma_f32_16x16x32_bf16 v[108:111], a[124:127], v[176:179], v[108:111]
    ds_read_b128 v[172:175], v224 offset:38912
    v_mfma_f32_16x16x32_bf16 v[112:115], a[112:115], v[180:183], v[112:115]
    v_mfma_f32_16x16x32_bf16 v[116:119], a[116:119], v[180:183], v[116:119]
    s_add_u32 m0, s31, 7168
    s_add_u32 s24, s27, 229376
    buffer_load_dwordx4 v245, s[12:15], s24 offen lds
    v_mfma_f32_16x16x32_bf16 v[120:123], a[120:123], v[180:183], v[120:123]
    v_mfma_f32_16x16x32_bf16 v[124:127], a[124:127], v[180:183], v[124:127]
    s_add_u32 s27, s27, 1048576
    s_and_b32 s27, s27, 0x407fffff
    s_cmp_eq_u32 s27, s7
    s_cselect_b32 s27, s43, s27
    v_mfma_f32_16x16x32_bf16 v[128:131], a[112:115], v[184:187], v[128:131]
    v_mfma_f32_16x16x32_bf16 v[132:135], a[116:119], v[184:187], v[132:135]
    s_add_u32 s31, s31, 32768
    s_cmp_ge_u32 s31, 163840
    s_cselect_b32 s24, 98304, 0
    s_sub_u32 s31, s31, s24
    v_mfma_f32_16x16x32_bf16 v[136:139], a[120:123], v[184:187], v[136:139]
    v_mfma_f32_16x16x32_bf16 v[140:143], a[124:127], v[184:187], v[140:143]
    v_mfma_f32_16x16x32_bf16 v[144:147], a[112:115], v[188:191], v[144:147]
    v_mfma_f32_16x16x32_bf16 v[148:151], a[116:119], v[188:191], v[148:151]
    v_mfma_f32_16x16x32_bf16 v[152:155], a[120:123], v[188:191], v[152:155]
    v_mfma_f32_16x16x32_bf16 v[156:159], a[124:127], v[188:191], v[156:159]
    s_waitcnt lgkmcnt(0)
    v_mfma_f32_16x16x32_bf16 v[96:99], a[128:131], v[160:163], v[96:99]
    ds_read_b128 v[176:179], v225 offset:32768
    v_mfma_f32_16x16x32_bf16 v[100:103], a[132:135], v[160:163], v[100:103]
    ds_read_b128 v[180:183], v225 offset:34816
    v_mfma_f32_16x16x32_bf16 v[104:107], a[136:139], v[160:163], v[104:107]
    ds_read_b128 v[184:187], v225 offset:36864
    v_mfma_f32_16x16x32_bf16 v[108:111], a[140:143], v[160:163], v[108:111]
    ds_read_b128 v[188:191], v225 offset:38912
    v_mfma_f32_16x16x32_bf16 v[112:115], a[128:131], v[164:167], v[112:115]
    s_mul_i32 s37, s2, 100
    v_mfma_f32_16x16x32_bf16 v[116:119], a[132:135], v[164:167], v[116:119]
    v_lshl_add_u32 v60, v253, 2, s37
    v_cmp_gt_u32 vcc, 25, v253
    v_mfma_f32_16x16x32_bf16 v[120:123], a[136:139], v[164:167], v[120:123]
    v_mov_b32 v61, 0
    v_mfma_f32_16x16x32_bf16 v[124:127], a[140:143], v[164:167], v[124:127]
    v_mov_b32 v62, 0x7ffffff0
    v_mfma_f32_16x16x32_bf16 v[128:131], a[128:131], v[168:171], v[128:131]
    v_cndmask_b32 v60, v62, v60, vcc
    buffer_store_dword v61, v60, s[56:59], 0 offen
    v_mfma_f32_16x16x32_bf16 v[132:135], a[132:135], v[168:171], v[132:135]
    s_add_u32 s56, s56, 0x20000
    s_addc_u32 s57, s57, 0
    v_mfma_f32_16x16x32_bf16 v[136:139], a[136:139], v[168:171], v[136:139]
    s_mov_b32 s58, 0x20000
    v_mfma_f32_16x16x32_bf16 v[140:143], a[140:143], v[168:171], v[140:143]
    s_lshl2_add_u32 s37, s2, s3
    s_lshl_b32 s37, s37, 7
    v_mfma_f32_16x16x32_bf16 v[144:147], a[128:131], v[172:175], v[144:147]
    buffer_store_dword v61, off, s[56:59], s37
    v_mfma_f32_16x16x32_bf16 v[148:151], a[132:135], v[172:175], v[148:151]
    s_add_u32 s38, s36, 73728
    buffer_store_dwordx4 v[80:83], v240, s[16:19], s38 offen offset:0 sc1
    v_mfma_f32_16x16x32_bf16 v[152:155], a[136:139], v[172:175], v[152:155]
    v_mfma_f32_16x16x32_bf16 v[156:159], a[140:143], v[172:175], v[156:159]
    s_waitcnt lgkmcnt(0)
    v_mfma_f32_16x16x32_bf16 v[96:99], a[144:147], v[176:179], v[96:99]
    ds_read_b128 v[160:163], v224 offset:40960
    v_mfma_f32_16x16x32_bf16 v[100:103], a[148:151], v[176:179], v[100:103]
    ds_read_b128 v[164:167], v224 offset:43008
    v_mfma_f32_16x16x32_bf16 v[104:107], a[152:155], v[176:179], v[104:107]
    ds_read_b128 v[168:171], v224 offset:45056
    v_mfma_f32_16x16x32_bf16 v[108:111], a[156:159], v[176:179], v[108:111]
    ds_read_b128 v[172:175], v224 offset:47104
    v_mfma_f32_16x16x32_bf16 v[112:115], a[144:147], v[180:183], v[112:115]
    v_mfma_f32_16x16x32_bf16 v[116:119], a[148:151], v[180:183], v[116:119]
    v_mfma_f32_16x16x32_bf16 v[120:123], a[152:155], v[180:183], v[120:123]
    v_mfma_f32_16x16x32_bf16 v[124:127], a[156:159], v[180:183], v[124:127]
    v_mfma_f32_16x16x32_bf16 v[128:131], a[144:147], v[184:187], v[128:131]
    v_mfma_f32_16x16x32_bf16 v[132:135], a[148:151], v[184:187], v[132:135]
    v_mfma_f32_16x16x32_bf16 v[136:139], a[152:155], v[184:187], v[136:139]
    v_mfma_f32_16x16x32_bf16 v[140:143], a[156:159], v[184:187], v[140:143]
    v_mfma_f32_16x16x32_bf16 v[144:147], a[144:147], v[188:191], v[144:147]
    v_mfma_f32_16x16x32_bf16 v[148:151], a[148:151], v[188:191], v[148:151]
    v_mfma_f32_16x16x32_bf16 v[152:155], a[152:155], v[188:191], v[152:155]
    v_mfma_f32_16x16x32_bf16 v[156:159], a[156:159], v[188:191], v[156:159]
    s_waitcnt lgkmcnt(0)
    v_mfma_f32_16x16x32_bf16 v[96:99], a[160:163], v[160:163], v[96:99]
    ds_read_b128 v[176:179], v225 offset:40960
    v_mfma_f32_16x16x32_bf16 v[100:103], a[164:167], v[160:163], v[100:103]
    ds_read_b128 v[180:183], v225 offset:43008
    v_mfma_f32_16x16x32_bf16 v[104:107], a[168:171], v[160:163], v[104:107]
    ds_read_b128 v[184:187], v225 offset:45056
    v_mfma_f32_16x16x32_bf16 v[108:111], a[172:175], v[160:163], v[108:111]
    ds_read_b128 v[188:191], v225 offset:47104
    v_mfma_f32_16x16x32_bf16 v[112:115], a[160:163], v[164:167], v[112:115]
    v_mfma_f32_16x16x32_bf16 v[116:119], a[164:167], v[164:167], v[116:119]
    v_mfma_f32_16x16x32_bf16 v[120:123], a[168:171], v[164:167], v[120:123]
    v_mfma_f32_16x16x32_bf16 v[124:127], a[172:175], v[164:167], v[124:127]
    v_mfma_f32_16x16x32_bf16 v[128:131], a[160:163], v[168:171], v[128:131]
    v_mfma_f32_16x16x32_bf16 v[132:135], a[164:167], v[168:171], v[132:135]
    v_mfma_f32_16x16x32_bf16 v[136:139], a[168:171], v[168:171], v[136:139]
    v_mfma_f32_16x16x32_bf16 v[140:143], a[172:175], v[168:171], v[140:143]
    v_mfma_f32_16x16x32_bf16 v[144:147], a[160:163], v[172:175], v[144:147]
    v_mfma_f32_16x16x32_bf16 v[148:151], a[164:167], v[172:175], v[148:151]
    v_mfma_f32_16x16x32_bf16 v[152:155], a[168:171], v[172:175], v[152:155]
    s_add_u32 s38, s36, 73728
    buffer_store_dwordx4 v[84:87], v240, s[16:19], s38 offen offset:2048 sc1
    v_mfma_f32_16x16x32_bf16 v[156:159], a[172:175], v[172:175], v[156:159]
    s_waitcnt vmcnt(7)
    v_readfirstlane_b32 s24, v254
    s_lshl_b32 s25, s3, 16
    s_add_u32 s24, s24, s25
    s_cmp_ge_u32 s24, 32
    s_cbranch_scc0 ka_spin41
ka_spinr42:
    s_waitcnt lgkmcnt(0)
    s_barrier
    v_mfma_f32_16x16x32_bf16 v[96:99], a[176:179], v[176:179], v[96:99]
    ds_read_b128 v[160:163], v224 offset:49152
    v_mfma_f32_16x16x32_bf16 v[100:103], a[180:183], v[176:179], v[100:103]
    ds_read_b128 v[164:167], v224 offset:51200
    v_mfma_f32_16x16x32_bf16 v[104:107], a[184:187], v[176:179], v[104:107]
    ds_read_b128 v[168:171], v224 offset:53248
    v_mfma_f32_16x16x32_bf16 v[108:111], a[188:191], v[176:179], v[108:111]
    ds_read_b128 v[172:175], v224 offset:55296
    v_mfma_f32_16x16x32_bf16 v[112:115], a[176:179], v[180:183], v[112:115]
    v_mfma_f32_16x16x32_bf16 v[116:119], a[180:183], v[180:183], v[116:119]
    buffer_load_dwordx4 v[0:3], v248, s[8:11], s28 offen offset:0 sc1
    v_mfma_f32_16x16x32_bf16 v[120:123], a[184:187], v[180:183], v[120:123]
    v_mfma_f32_16x16x32_bf16 v[124:127], a[188:191], v[180:183], v[124:127]
    buffer_load_dwordx4 v[4:7], v249, s[8:11], s28 offen offset:0 sc1
    v_mfma_f32_16x16x32_bf16 v[128:131], a[176:179], v[184:187], v[128:131]
    v_mfma_f32_16x16x32_bf16 v[132:135], a[180:183], v[184:187], v[132:135]
    buffer_load_dwordx4 v[8:11], v248, s[8:11], s28 offen offset:1024 sc1
    v_mfma_f32_16x16x32_bf16 v[136:139], a[184:187], v[184:187], v[136:139]
    v_mfma_f32_16x16x32_bf16 v[140:143], a[188:191], v[184:187], v[140:143]
    buffer_load_dwordx4 v[12:15], v249, s[8:11], s28 offen offset:1024 sc1
    v_mfma_f32_16x16x32_bf16 v[144:147], a[176:179], v[188:191], v[144:147]
    v_mfma_f32_16x16x32_bf16 v[148:151], a[180:183], v[188:191], v[148:151]
    v_mfma_f32_16x16x32_bf16 v[152:155], a[184:187], v[188:191], v[152:155]
    v_mfma_f32_16x16x32_bf16 v[156:159], a[188:191], v[188:191], v[156:159]
    s_waitcnt lgkmcnt(0)
    v_mfma_f32_16x16x32_bf16 v[96:99], a[192:195], v[160:163], v[96:99]
    ds_read_b128 v[176:179], v225 offset:49152
    v_mfma_f32_16x16x32_bf16 v[100:103], a[196:199], v[160:163], v[100:103]
    ds_read_b128 v[180:183], v225 offset:51200
    v_mfma_f32_16x16x32_bf16 v[104:107], a[200:203], v[160:163], v[104:107]
    ds_read_b128 v[184:187], v225 offset:53248
    v_mfma_f32_16x16x32_bf16 v[108:111], a[204:207], v[160:163], v[108:111]
    ds_read_b128 v[188:191], v225 offset:55296
    v_mfma_f32_16x16x32_bf16 v[112:115], a[192:195], v[164:167], v[112:115]
    v_mfma_f32_16x16x32_bf16 v[116:119], a[196:199], v[164:167], v[116:119]
    buffer_load_dwordx4 v[16:19], v248, s[8:11], s28 offen offset:2048 sc1
    v_mfma_f32_16x16x32_bf16 v[120:123], a[200:203], v[164:167], v[120:123]
    v_mfma_f32_16x16x32_bf16 v[124:127], a[204:207], v[164:167], v[124:127]
    buffer_load_dwordx4 v[20:23], v249, s[8:11], s28 offen offset:2048 sc1
    v_mfma_f32_16x16x32_bf16 v[128:131], a[192:195], v[168:171], v[128:131]
    v_mfma_f32_16x16x32_bf16 v[132:135], a[196:199], v[168:171], v[132:135]
    buffer_load_dwordx4 v[24:27], v248, s[8:11], s28 offen offset:3072 sc1
    v_mfma_f32_16x16x32_bf16 v[136:139], a[200:203], v[168:171], v[136:139]
    v_mfma_f32_16x16x32_bf16 v[140:143], a[204:207], v[168:171], v[140:143]
    buffer_load_dwordx4 v[28:31], v249, s[8:11], s28 offen offset:3072 sc1
    v_mfma_f32_16x16x32_bf16 v[144:147], a[192:195], v[172:175], v[144:147]
    v_mfma_f32_16x16x32_bf16 v[148:151], a[196:199], v[172:175], v[148:151]
    v_mfma_f32_16x16x32_bf16 v[152:155], a[200:203], v[172:175], v[152:155]
    v_mfma_f32_16x16x32_bf16 v[156:159], a[204:207], v[172:175], v[156:159]
    s_add_u32 s38, s36, 73728
    buffer_store_dwordx4 v[88:91], v240, s[16:19], s38 offen offset:1024 sc1
    s_waitcnt lgkmcnt(0)
    v_mfma_f32_16x16x32_bf16 v[96:99], a[208:211], v[176:179], v[96:99]
    ds_read_b128 v[160:163], v224 offset:57344
    v_mfma_f32_16x16x32_bf16 v[100:103], a[212:215], v[176:179], v[100:103]
    ds_read_b128 v[164:167], v224 offset:59392
    v_mfma_f32_16x16x32_bf16 v[104:107], a[216:219], v[176:179], v[104:107]
    ds_read_b128 v[168:171], v224 offset:61440
    v_mfma_f32_16x16x32_bf16 v[108:111], a[220:223], v[176:179], v[108:111]
    ds_read_b128 v[172:175], v224 offset:63488
    v_mfma_f32_16x16x32_bf16 v[112:115], a[208:211], v[180:183], v[112:115]
    v_mfma_f32_16x16x32_bf16 v[116:119], a[212:215], v[180:183], v[116:119]
    buffer_load_dwordx4 v[32:35], v248, s[8:11], s29 offen offset:0 sc1
    v_mfma_f32_16x16x32_bf16 v[120:123], a[216:219], v[180:183], v[120:123]
    v_mfma_f32_16x16x32_bf16 v[124:127], a[220:223], v[180:183], v[124:127]
    buffer_load_dwordx4 v[36:39], v249, s[8:11], s29 offen offset:0 sc1
    v_mfma_f32_16x16x32_bf16 v[128:131], a[208:211], v[184:187], v[128:131]
    v_mfma_f32_16x16x32_bf16 v[132:135], a[212:215], v[184:187], v[132:135]
    buffer_load_dwordx4 v[40:43], v248, s[8:11], s29 offen offset:1024 sc1
    v_mfma_f32_16x16x32_bf16 v[136:139], a[216:219], v[184:187], v[136:139]
    v_mfma_f32_16x16x32_bf16 v[140:143], a[220:223], v[184:187], v[140:143]
    buffer_load_dwordx4 v[44:47], v249, s[8:11], s29 offen offset:1024 sc1
    v_mfma_f32_16x16x32_bf16 v[144:147], a[208:211], v[188:191], v[144:147]
    v_mfma_f32_16x16x32_bf16 v[148:151], a[212:215], v[188:191], v[148:151]
    v_mfma_f32_16x16x32_bf16 v[152:155], a[216:219], v[188:191], v[152:155]
    v_mfma_f32_16x16x32_bf16 v[156:159], a[220:223], v[188:191], v[156:159]
    s_waitcnt lgkmcnt(0)
    v_mfma_f32_16x16x32_bf16 v[96:99], a[224:227], v[160:163], v[96:99]
    ds_read_b128 v[176:179], v225 offset:57344
    v_mfma_f32_16x16x32_bf16 v[100:103], a[228:231], v[160:163], v[100:103]
    ds_read_b128 v[180:183], v225 offset:59392
    v_mfma_f32_16x16x32_bf16 v[104:107], a[232:235], v[160:163], v[104:107]
    ds_read_b128 v[184:187], v225 offset:61440
    v_mfma_f32_16x16x32_bf16 v[108:111], a[236:239], v[160:163], v[108:111]
    ds_read_b128 v[188:191], v225 offset:63488
    v_mfma_f32_16x16x32_bf16 v[112:115], a[224:227], v[164:167], v[112:115]
    v_mfma_f32_16x16x32_bf16 v[116:119], a[228:231], v[164:167], v[116:119]
    buffer_load_dwordx4 v[48:51], v248, s[8:11], s29 offen offset:2048 sc1
    v_mfma_f32_16x16x32_bf16 v[120:123], a[232:235], v[164:167], v[120:123]
    v_mfma_f32_16x16x32_bf16 v[124:127], a[236:239], v[164:167], v[124:127]
    buffer_load_dwordx4 v[52:55], v249, s[8:11], s29 offen offset:2048 sc1
    v_mfma_f32_16x16x32_bf16 v[128:131], a[224:227], v[168:171], v[128:131]
    v_mfma_f32_16x16x32_bf16 v[132:135], a[228:231], v[168:171], v[132:135]
    buffer_load_dwordx4 v[56:59], v248, s[8:11], s29 offen offset:3072 sc1
    v_mfma_f32_16x16x32_bf16 v[136:139], a[232:235], v[168:171], v[136:139]
    v_mfma_f32_16x16x32_bf16 v[140:143], a[236:239], v[168:171], v[140:143]
    buffer_load_dwordx4 v[60:63], v249, s[8:11], s29 offen offset:3072 sc1
    v_mfma_f32_16x16x32_bf16 v[144:147], a[224:227], v[172:175], v[144:147]
    v_mfma_f32_16x16x32_bf16 v[148:151], a[228:231], v[172:175], v[148:151]
    v_mfma_f32_16x16x32_bf16 v[152:155], a[232:235], v[172:175], v[152:155]
    v_mfma_f32_16x16x32_bf16 v[156:159], a[236:239], v[172:175], v[156:159]
    s_waitcnt vmcnt(34) lgkmcnt(0)
    s_barrier
    v_mfma_f32_16x16x32_bf16 v[96:99], a[240:243], v[176:179], v[96:99]
    ds_read_b64_tr_b16 a[192:193], v246 offset:0
    s_add_u32 s38, s36, 73728
    buffer_store_dwordx4 v[92:95], v240, s[16:19], s38 offen offset:3072 sc1
    v_mfma_f32_16x16x32_bf16 v[100:103], a[244:247], v[176:179], v[100:103]
    ds_read_b64_tr_b16 a[194:195], v246 offset:1024
    v_mfma_f32_16x16x32_bf16 v[104:107], a[248:251], v[176:179], v[104:107]
    ds_read_b64_tr_b16 a[196:197], v246 offset:256
    v_mfma_f32_16x16x32_bf16 v[108:111], a[252:255], v[176:179], v[108:111]
    ds_read_b64_tr_b16 a[198:199], v246 offset:1280
    v_mfma_f32_16x16x32_bf16 v[112:115], a[240:243], v[180:183], v[112:115]
    ds_read_b64_tr_b16 a[200:201], v246 offset:512
    v_mfma_f32_16x16x32_bf16 v[116:119], a[244:247], v[180:183], v[116:119]
    ds_read_b64_tr_b16 a[202:203], v246 offset:1536
    s_add_u32 s28, s28, 8192
    s_and_b32 s28, s28, 65535
    s_add_u32 s29, s28, 4096
    v_mfma_f32_16x16x32_bf16 v[120:123], a[248:251], v[180:183], v[120:123]
    ds_read_b64_tr_b16 a[204:205], v246 offset:768
    v_mfma_f32_16x16x32_bf16 v[124:127], a[252:255], v[180:183], v[124:127]
    ds_read_b64_tr_b16 a[206:207], v246 offset:1792
    v_mfma_f32_16x16x32_bf16 v[128:131], a[240:243], v[184:187], v[128:131]
    v_mfma_f32_16x16x32_bf16 v[132:135], a[244:247], v[184:187], v[132:135]
    v_cvt_pk_bf16_f32 v64, v96, v97
    v_cvt_pk_bf16_f32 v65, v98, v99
    v_mfma_f32_16x16x32_bf16 v[136:139], a[248:251], v[184:187], v[136:139]
    v_cvt_pk_bf16_f32 v66, v100, v101
    v_cvt_pk_bf16_f32 v67, v102, v103
    v_mfma_f32_16x16x32_bf16 v[140:143], a[252:255], v[184:187], v[140:143]
    v_cvt_pk_bf16_f32 v68, v104, v105
    v_cvt_pk_bf16_f32 v69, v106, v107
    v_mfma_f32_16x16x32_bf16 v[144:147], a[240:243], v[188:191], v[144:147]
    v_cvt_pk_bf16_f32 v70, v108, v109
    v_cvt_pk_bf16_f32 v71, v110, v111
    v_mfma_f32_16x16x32_bf16 v[148:151], a[244:247], v[188:191], v[148:151]
    v_cvt_pk_bf16_f32 v72, v112, v113
    v_cvt_pk_bf16_f32 v73, v114, v115
    v_mfma_f32_16x16x32_bf16 v[152:155], a[248:251], v[188:191], v[152:155]
    v_cvt_pk_bf16_f32 v74, v116, v117
    v_cvt_pk_bf16_f32 v75, v118, v119
    v_mfma_f32_16x16x32_bf16 v[156:159], a[252:255], v[188:191], v[156:159]
    v_cvt_pk_bf16_f32 v76, v120, v121
    v_cvt_pk_bf16_f32 v77, v122, v123
    s_nop 3
    v_cvt_pk_bf16_f32 v78, v124, v125
    v_cvt_pk_bf16_f32 v79, v126, v127
    v_cvt_pk_bf16_f32 v80, v128, v129
    v_cvt_pk_bf16_f32 v81, v130, v131
    v_cvt_pk_bf16_f32 v82, v132, v133
    v_cvt_pk_bf16_f32 v83, v134, v135
    v_cvt_pk_bf16_f32 v84, v136, v137
    v_cvt_pk_bf16_f32 v85, v138, v139
    v_cvt_pk_bf16_f32 v86, v140, v141
    v_cvt_pk_bf16_f32 v87, v142, v143
    v_cvt_pk_bf16_f32 v88, v144, v145
    v_cvt_pk_bf16_f32 v89, v146, v147
    v_cvt_pk_bf16_f32 v90, v148, v149
    v_cvt_pk_bf16_f32 v91, v150, v151
    v_cvt_pk_bf16_f32 v92, v152, v153
    v_cvt_pk_bf16_f32 v93, v154, v155
    v_cvt_pk_bf16_f32 v94, v156, v157
    v_cvt_pk_bf16_f32 v95, v158, v159
    s_add_u32 s80, s36, 98304
    s_add_u32 s81, s36, 100352
    s_add_u32 s82, s36, 99328
    s_add_u32 s83, s36, 101376
    s_add_u32 s84, s36, 106496
    s_add_u32 s85, s36, 108544
    s_add_u32 s86, s36, 107520
    s_add_u32 s87, s36, 109568
    s_branch ka_Q
ka_V:
    s_waitcnt lgkmcnt(0)
    v_mfma_f32_16x16x32_bf16 v[96:99], v[160:163], a[0:3], 0
    ds_read_b128 v[176:179], v225 offset:0
    ds_read_b128 v[180:183], v225 offset:2048
    v_mfma_f32_16x16x32_bf16 v[100:103], v[164:167], a[0:3], 0
    ds_read_b128 v[184:187], v225 offset:4096
    v_mfma_f32_16x16x32_bf16 v[104:107], v[160:163], a[4:7], 0
    ds_read_b128 v[188:191], v225 offset:6144
    ds_read_b64_tr_b16 a[16:17], v228 offset:4096
    v_mfma_f32_16x16x32_bf16 v[108:111], v[164:167], a[4:7], 0
    ds_read_b64_tr_b16 a[18:19], v228 offset:4608
    v_mfma_f32_16x16x32_bf16 v[112:115], v[160:163], a[8:11], 0
    ds_read_b64_tr_b16 a[20:21], v229 offset:4096
    ds_read_b64_tr_b16 a[22:23], v229 offset:4608
    s_add_u32 m0, s34, 16384
    s_add_u32 s37, s82, 0
    buffer_load_dwordx4 v232, s[44:47], s37 offen lds
    v_mfma_f32_16x16x32_bf16 v[116:119], v[164:167], a[8:11], 0
    ds_read_b64_tr_b16 a[24:25], v230 offset:4096
    buffer_load_dwordx4 v233, s[44:47], s37 offen offset:1024 lds
    v_mfma_f32_16x16x32_bf16 v[120:123], v[160:163], a[12:15], 0
    ds_read_b64_tr_b16 a[26:27], v230 offset:4608
    ds_read_b64_tr_b16 a[28:29], v231 offset:4096
    s_add_u32 m0, s34, 24576
    s_add_u32 s37, s83, 0
    buffer_load_dwordx4 v232, s[44:47], s37 offen lds
    v_mfma_f32_16x16x32_bf16 v[124:127], v[164:167], a[12:15], 0
    ds_read_b64_tr_b16 a[30:31], v231 offset:4608
    buffer_load_dwordx4 v233, s[44:47], s37 offen offset:1024 lds
    v_mfma_f32_16x16x32_bf16 v[128:131], v[168:171], a[0:3], 0
    s_add_u32 m0, s35, 16384
    s_and_b32 s33, s82, 1023
    s_lshl_b32 s33, s33, 12
    buffer_load_dwordx4 v234, s[48:51], s33 offen lds
    v_mfma_f32_16x16x32_bf16 v[132:135], v[172:175], a[0:3], 0
    buffer_load_dwordx4 v235, s[48:51], s33 offen offset:1024 lds
    v_mfma_f32_16x16x32_bf16 v[136:139], v[168:171], a[4:7], 0
    s_add_u32 m0, s35, 18432
    s_add_u32 s33, s33, 131072
    buffer_load_dwordx4 v234, s[48:51], s33 offen lds
    v_mfma_f32_16x16x32_bf16 v[140:143], v[172:175], a[4:7], 0
    buffer_load_dwordx4 v235, s[48:51], s33 offen offset:1024 lds
    v_mfma_f32_16x16x32_bf16 v[144:147], v[168:171], a[8:11], 0
    s_add_u32 m0, s35, 20480
    s_add_u32 s33, s33, 131072
    buffer_load_dwordx4 v234, s[48:51], s33 offen lds
    v_mfma_f32_16x16x32_bf16 v[148:151], v[172:175], a[8:11], 0
    buffer_load_dwordx4 v235, s[48:51], s33 offen offset:1024 lds
    v_mfma_f32_16x16x32_bf16 v[152:155], v[168:171], a[12:15], 0
    s_add_u32 m0, s35, 22528
    s_add_u32 s33, s33, 131072
    buffer_load_dwordx4 v234, s[48:51], s33 offen lds
    v_mfma_f32_16x16x32_bf16 v[156:159], v[172:175], a[12:15], 0
    buffer_load_dwordx4 v235, s[48:51], s33 offen offset:1024 lds
    s_waitcnt vmcnt(16) lgkmcnt(0)
    v_mfma_f32_16x16x32_bf16 v[96:99], v[176:179], a[16:19], v[96:99]
    ds_read_b128 v[160:163], v224 offset:8192
    ds_read_b128 v[164:167], v224 offset:10240
    v_mfma_f32_16x16x32_bf16 v[100:103], v[180:183], a[16:19], v[100:103]
    ds_read_b128 v[168:171], v224 offset:12288
    v_mfma_f32_16x16x32_bf16 v[104:107], v[176:179], a[20:23], v[104:107]
    ds_read_b128 v[172:175], v224 offset:14336
    ds_read_b64_tr_b16 a[32:33], v228 offset:8192
    v_mfma_f32_16x16x32_bf16 v[108:111], v[180:183], a[20:23], v[108:111]
    ds_read_b64_tr_b16 a[34:35], v228 offset:8704
    v_mfma_f32_16x16x32_bf16 v[112:115], v[176:179], a[24:27], v[112:115]
    ds_read_b64_tr_b16 a[36:37], v229 offset:8192
    ds_read_b64_tr_b16 a[38:39], v229 offset:8704
    s_add_u32 m0, s35, 0
    s_and_b32 s33, s83, 1023
    s_lshl_b32 s33, s33, 12
    buffer_load_dwordx4 v234, s[48:51], s33 offen lds
    v_mfma_f32_16x16x32_bf16 v[116:119], v[180:183], a[24:27], v[116:119]
    ds_read_b64_tr_b16 a[40:41], v230 offset:8192
    buffer_load_dwordx4 v235, s[48:51], s33 offen offset:1024 lds
    v_mfma_f32_16x16x32_bf16 v[120:123], v[176:179], a[28:31], v[120:123]
    ds_read_b64_tr_b16 a[42:43], v230 offset:8704
    ds_read_b64_tr_b16 a[44:45], v231 offset:8192
    s_add_u32 m0, s35, 2048
    s_add_u32 s33, s33, 131072
    buffer_load_dwordx4 v234, s[48:51], s33 offen lds
    v_mfma_f32_16x16x32_bf16 v[124:127], v[180:183], a[28:31], v[124:127]
    ds_read_b64_tr_b16 a[46:47], v231 offset:8704
    buffer_load_dwordx4 v235, s[48:51], s33 offen offset:1024 lds
    v_mfma_f32_16x16x32_bf16 v[128:131], v[184:187], a[16:19], v[128:131]
    s_add_u32 m0, s35, 4096
    s_add_u32 s33, s33, 131072
    buffer_load_dwordx4 v234, s[48:51], s33 offen lds
    v_mfma_f32_16x16x32_bf16 v[132:135], v[188:191], a[16:19], v[132:135]
    buffer_load_dwordx4 v235, s[48:51], s33 offen offset:1024 lds
    v_mfma_f32_16x16x32_bf16 v[136:139], v[184:187], a[20:23], v[136:139]
    s_add_u32 m0, s35, 6144
    s_add_u32 s33, s33, 131072
    buffer_load_dwordx4 v234, s[48:51], s33 offen lds
    v_mfma_f32_16x16x32_bf16 v[140:143], v[188:191], a[20:23], v[140:143]
    buffer_load_dwordx4 v235, s[48:51], s33 offen offset:1024 lds
    v_mfma_f32_16x16x32_bf16 v[144:147], v[184:187], a[24:27], v[144:147]
    v_mfma_f32_16x16x32_bf16 v[148:151], v[188:191], a[24:27], v[148:151]
    v_mfma_f32_16x16x32_bf16 v[152:155], v[184:187], a[28:31], v[152:155]
    v_mfma_f32_16x16x32_bf16 v[156:159], v[188:191], a[28:31], v[156:159]
    s_waitcnt lgkmcnt(0)
    v_mfma_f32_16x16x32_bf16 v[96:99], v[160:163], a[32:35], v[96:99]
    ds_read_b128 v[176:179], v225 offset:8192
    ds_read_b128 v[180:183], v225 offset:10240
    v_mfma_f32_16x16x32_bf16 v[100:103], v[164:167], a[32:35], v[100:103]
    ds_read_b128 v[184:187], v225 offset:12288
    v_mfma_f32_16x16x32_bf16 v[104:107], v[160:163], a[36:39], v[104:107]
    ds_read_b128 v[188:191], v225 offset:14336
    ds_read_b64_tr_b16 a[48:49], v228 offset:12288
    v_mfma_f32_16x16x32_bf16 v[108:111], v[164:167], a[36:39], v[108:111]
    ds_read_b64_tr_b16 a[50:51], v228 offset:12800
    v_mfma_f32_16x16x32_bf16 v[112:115], v[160:163], a[40:43], v[112:115]
    ds_read_b64_tr_b16 a[52:53], v229 offset:12288
    ds_read_b64_tr_b16 a[54:55], v229 offset:12800
    v_mfma_f32_16x16x32_bf16 v[116:119], v[164:167], a[40:43], v[116:119]
    ds_read_b64_tr_b16 a[56:57], v230 offset:12288
    s_add_u32 m0, s34, 32768
    s_add_u32 s37, s84, 0
    buffer_load_dwordx4 v232, s[44:47], s37 offen lds
    v_mfma_f32_16x16x32_bf16 v[120:123], v[160:163], a[44:47], v[120:123]
    ds_read_b64_tr_b16 a[58:59], v230 offset:12800
    ds_read_b64_tr_b16 a[60:61], v231 offset:12288
    v_mfma_f32_16x16x32_bf16 v[124:127], v[164:167], a[44:47], v[124:127]
    ds_read_b64_tr_b16 a[62:63], v231 offset:12800
    buffer_load_dwordx4 v233, s[44:47], s37 offen offset:1024 lds
    v_mfma_f32_16x16x32_bf16 v[128:131], v[168:171], a[32:35], v[128:131]
    v_mfma_f32_16x16x32_bf16 v[132:135], v[172:175], a[32:35], v[132:135]
    s_add_u32 m0, s34, 40960
    s_add_u32 s37, s85, 0
    buffer_load_dwordx4 v232, s[44:47], s37 offen lds
    v_mfma_f32_16x16x32_bf16 v[136:139], v[168:171], a[36:39], v[136:139]
    v_mfma_f32_16x16x32_bf16 v[140:143], v[172:175], a[36:39], v[140:143]
    buffer_load_dwordx4 v233, s[44:47], s37 offen offset:1024 lds
    v_mfma_f32_16x16x32_bf16 v[144:147], v[168:171], a[40:43], v[144:147]
    v_mfma_f32_16x16x32_bf16 v[148:151], v[172:175], a[40:43], v[148:151]
    v_mfma_f32_16x16x32_bf16 v[152:155], v[168:171], a[44:47], v[152:155]
    v_mfma_f32_16x16x32_bf16 v[156:159], v[172:175], a[44:47], v[156:159]
    s_waitcnt vmcnt(12) lgkmcnt(0)
    s_barrier
    v_mfma_f32_16x16x32_bf16 v[96:99], v[176:179], a[48:51], v[96:99]
    ds_read_b128 v[160:163], v224 offset:16384
    ds_read_b128 v[164:167], v224 offset:18432
    s_waitcnt vmcnt(24)
    v_mfma_f32_16x16x32_bf16 v[100:103], v[180:183], a[48:51], v[100:103]
    ds_read_b128 v[168:171], v224 offset:20480
    v_lshlrev_b32 v16, 16, v0
    v_and_b32 v17, 0xffff0000, v0
    v_mfma_f32_16x16x32_bf16 v[104:107], v[176:179], a[52:55], v[104:107]
    ds_read_b128 v[172:175], v224 offset:22528
    ds_read_b64_tr_b16 a[64:65], v228 offset:16384
    v_lshlrev_b32 v18, 16, v1
    v_mfma_f32_16x16x32_bf16 v[108:111], v[180:183], a[52:55], v[108:111]
    ds_read_b64_tr_b16 a[66:67], v228 offset:16896
    v_and_b32 v19, 0xffff0000, v1
    v_lshlrev_b32 v20, 16, v2
    v_mfma_f32_16x16x32_bf16 v[112:115], v[176:179], a[56:59], v[112:115]
    ds_read_b64_tr_b16 a[68:69], v229 offset:16384
    ds_read_b64_tr_b16 a[70:71], v229 offset:16896
    s_add_u32 m0, s35, 8192
    s_and_b32 s33, s84, 1023
    s_lshl_b32 s33, s33, 12
    buffer_load_dwordx4 v234, s[48:51], s33 offen lds
    v_mfma_f32_16x16x32_bf16 v[116:119], v[180:183], a[56:59], v[116:119]
    ds_read_b64_tr_b16 a[72:73], v230 offset:16384
    buffer_load_dwordx4 v235, s[48:51], s33 offen offset:1024 lds
    v_and_b32 v21, 0xffff0000, v2
    v_mfma_f32_16x16x32_bf16 v[120:123], v[176:179], a[60:63], v[120:123]
    ds_read_b64_tr_b16 a[74:75], v230 offset:16896
    ds_read_b64_tr_b16 a[76:77], v231 offset:16384
    s_add_u32 m0, s35, 10240
    s_add_u32 s33, s33, 131072
    buffer_load_dwordx4 v234, s[48:51], s33 offen lds
    v_mfma_f32_16x16x32_bf16 v[124:127], v[180:183], a[60:63], v[124:127]
    ds_read_b64_tr_b16 a[78:79], v231 offset:16896
    buffer_load_dwordx4 v235, s[48:51], s33 offen offset:1024 lds
    v_lshlrev_b32 v22, 16, v3
    v_and_b32 v23, 0xffff0000, v3
    v_mfma_f32_16x16x32_bf16 v[128:131], v[184:187], a[48:51], v[128:131]
    s_add_u32 m0, s35, 12288
    s_add_u32 s33, s33, 131072
    buffer_load_dwordx4 v234, s[48:51], s33 offen lds
    v_mfma_f32_16x16x32_bf16 v[132:135], v[188:191], a[48:51], v[132:135]
    buffer_load_dwordx4 v235, s[48:51], s33 offen offset:1024 lds
    v_lshlrev_b32 v24, 16, v4
    v_and_b32 v25, 0xffff0000, v4
    v_mfma_f32_16x16x32_bf16 v[136:139], v[184:187], a[52:55], v[136:139]
    s_add_u32 m0, s35, 14336
    s_add_u32 s33, s33, 131072
    buffer_load_dwordx4 v234, s[48:51], s33 offen lds
    v_lshlrev_b32 v26, 16, v5
    v_mfma_f32_16x16x32_bf16 v[140:143], v[188:191], a[52:55], v[140:143]
    buffer_load_dwordx4 v235, s[48:51], s33 offen offset:1024 lds
    v_and_b32 v27, 0xffff0000, v5
    v_lshlrev_b32 v28, 16, v6
    v_mfma_f32_16x16x32_bf16 v[144:147], v[184:187], a[56:59], v[144:147]
    v_and_b32 v29, 0xffff0000, v6
    v_lshlrev_b32 v30, 16, v7
    v_mfma_f32_16x16x32_bf16 v[148:151], v[188:191], a[56:59], v[148:151]
    v_and_b32 v31, 0xffff0000, v7
    v_lshlrev_b32 v32, 16, v8
    v_and_b32 v33, 0xffff0000, v8
    v_mfma_f32_16x16x32_bf16 v[152:155], v[184:187], a[60:63], v[152:155]
    v_lshlrev_b32 v34, 16, v9
    v_and_b32 v35, 0xffff0000, v9
    v_mfma_f32_16x16x32_bf16 v[156:159], v[188:191], a[60:63], v[156:159]
    v_lshlrev_b32 v36, 16, v10
    v_and_b32 v37, 0xffff0000, v10
    s_waitcnt lgkmcnt(0)
    v_mfma_f32_16x16x32_bf16 v[96:99], v[160:163], a[64:67], v[96:99]
    ds_read_b128 v[176:179], v225 offset:16384
    ds_read_b128 v[180:183], v225 offset:18432
    v_lshlrev_b32 v38, 16, v11
    v_mfma_f32_16x16x32_bf16 v[100:103], v[164:167], a[64:67], v[100:103]
    ds_read_b128 v[184:187], v225 offset:20480
    v_and_b32 v39, 0xffff0000, v11
    v_lshlrev_b32 v40, 16, v12
    v_mfma_f32_16x16x32_bf16 v[104:107], v[160:163], a[68:71], v[104:107]
    ds_read_b128 v[188:191], v225 offset:22528
    ds_read_b64_tr_b16 a[80:81], v228 offset:20480
    v_and_b32 v41, 0xffff0000, v12
    v_mfma_f32_16x16x32_bf16 v[108:111], v[164:167], a[68:71], v[108:111]
    ds_read_b64_tr_b16 a[82:83], v228 offset:20992
    v_lshlrev_b32 v42, 16, v13
    v_and_b32 v43, 0xffff0000, v13
    v_mfma_f32_16x16x32_bf16 v[112:115], v[160:163], a[72:75], v[112:115]
    ds_read_b64_tr_b16 a[84:85], v229 offset:20480
    ds_read_b64_tr_b16 a[86:87], v229 offset:20992
    v_lshlrev_b32 v44, 16, v14
    v_mfma_f32_16x16x32_bf16 v[116:119], v[164:167], a[72:75], v[116:119]
    ds_read_b64_tr_b16 a[88:89], v230 offset:20480
    s_add_u32 m0, s34, 49152
    s_add_u32 s37, s86, 0
    buffer_load_dwordx4 v232, s[44:47], s37 offen lds
    v_mfma_f32_16x16x32_bf16 v[120:123], v[160:163], a[76:79], v[120:123]
    ds_read_b64_tr_b16 a[90:91], v230 offset:20992
    ds_read_b64_tr_b16 a[92:93], v231 offset:20480
    v_and_b32 v45, 0xffff0000, v14
    v_mfma_f32_16x16x32_bf16 v[124:127], v[164:167], a[76:79], v[124:127]
    ds_read_b64_tr_b16 a[94:95], v231 offset:20992
    buffer_load_dwordx4 v233, s[44:47], s37 offen offset:1024 lds
    v_lshlrev_b32 v46, 16, v15
    v_and_b32 v47, 0xffff0000, v15
    v_mfma_f32_16x16x32_bf16 v[128:131], v[168:171], a[64:67], v[128:131]
    v_add_f32 v52, v16, v20
    v_add_f32 v53, v17, v21
    v_mfma_f32_16x16x32_bf16 v[132:135], v[172:175], a[64:67], v[132:135]
    s_add_u32 m0, s34, 57344
    s_add_u32 s37, s87, 0
    buffer_load_dwordx4 v232, s[44:47], s37 offen lds
    v_add_f32 v54, v18, v22
    v_mfma_f32_16x16x32_bf16 v[136:139], v[168:171], a[68:71], v[136:139]
    v_add_f32 v55, v19, v23
    v_add_f32 v52, v52, v24
    v_mfma_f32_16x16x32_bf16 v[140:143], v[172:175], a[68:71], v[140:143]
    buffer_load_dwordx4 v233, s[44:47], s37 offen offset:1024 lds
    v_add_f32 v53, v53, v25
    v_add_f32 v54, v54, v26
    v_mfma_f32_16x16x32_bf16 v[144:147], v[168:171], a[72:75], v[144:147]
    v_add_f32 v55, v55, v27
    v_add_f32 v52, v52, v28
    v_add_f32 v53, v53, v29
    v_mfma_f32_16x16x32_bf16 v[148:151], v[172:175], a[72:75], v[148:151]
    v_add_f32 v54, v54, v30
    v_add_f32 v55, v55, v31
    v_mfma_f32_16x16x32_bf16 v[152:155], v[168:171], a[76:79], v[152:155]
    v_add_f32 v52, v52, v32
    v_add_f32 v53, v53, v33
    v_add_f32 v54, v54, v34
    v_mfma_f32_16x16x32_bf16 v[156:159], v[172:175], a[76:79], v[156:159]
    v_add_f32 v55, v55, v35
    s_waitcnt vmcnt(16) lgkmcnt(0)
    v_mfma_f32_16x16x32_bf16 v[96:99], v[176:179], a[80:83], v[96:99]
    ds_read_b128 v[160:163], v224 offset:24576
    ds_read_b128 v[164:167], v224 offset:26624
    v_add_f32 v52, v52, v36
    v_add_f32 v53, v53, v37
    v_mfma_f32_16x16x32_bf16 v[100:103], v[180:183], a[80:83], v[100:103]
    ds_read_b128 v[168:171], v224 offset:28672
    v_add_f32 v54, v54, v38
    v_mfma_f32_16x16x32_bf16 v[104:107], v[176:179], a[84:87], v[104:107]
    ds_read_b128 v[172:175], v224 offset:30720
    ds_read_b64_tr_b16 a[96:97], v228 offset:0
    v_add_f32 v55, v55, v39
    v_add_f32 v52, v52, v40
    v_mfma_f32_16x16x32_bf16 v[108:111], v[180:183], a[84:87], v[108:111]
    ds_read_b64_tr_b16 a[98:99], v228 offset:512
    v_add_f32 v53, v53, v41
    v_add_f32 v54, v54, v42
    v_mfma_f32_16x16x32_bf16 v[112:115], v[176:179], a[88:91], v[112:115]
    ds_read_b64_tr_b16 a[100:101], v229 offset:0
    ds_read_b64_tr_b16 a[102:103], v229 offset:512
    s_add_u32 m0, s35, 16384
    s_and_b32 s33, s85, 1023
    s_lshl_b32 s33, s33, 12
    buffer_load_dwordx4 v234, s[48:51], s33 offen lds
    v_mfma_f32_16x16x32_bf16 v[116:119], v[180:183], a[88:91], v[116:119]
    ds_read_b64_tr_b16 a[104:105], v230 offset:0
    buffer_load_dwordx4 v235, s[48:51], s33 offen offset:1024 lds
    v_add_f32 v55, v55, v43
    v_mfma_f32_16x16x32_bf16 v[120:123], v[176:179], a[92:95], v[120:123]
    ds_read_b64_tr_b16 a[106:107], v230 offset:512
    ds_read_b64_tr_b16 a[108:109], v231 offset:0
    s_add_u32 m0, s35, 18432
    s_add_u32 s33, s33, 131072
    buffer_load_dwordx4 v234, s[48:51], s33 offen lds
    v_mfma_f32_16x16x32_bf16 v[124:127], v[180:183], a[92:95], v[124:127]
    ds_read_b64_tr_b16 a[110:111], v231 offset:512
    buffer_load_dwordx4 v235, s[48:51], s33 offen offset:1024 lds
    v_add_f32 v52, v52, v44
    v_mfma_f32_16x16x32_bf16 v[128:131], v[184:187], a[80:83], v[128:131]
    s_add_u32 m0, s35, 20480
    s_add_u32 s33, s33, 131072
    buffer_load_dwordx4 v234, s[48:51], s33 offen lds
    v_add_f32 v53, v53, v45
    v_mfma_f32_16x16x32_bf16 v[132:135], v[188:191], a[80:83], v[132:135]
    buffer_load_dwordx4 v235, s[48:51], s33 offen offset:1024 lds
    v_add_f32 v54, v54, v46
    v_mfma_f32_16x16x32_bf16 v[136:139], v[184:187], a[84:87], v[136:139]
    s_add_u32 m0, s35, 22528
    s_add_u32 s33, s33, 131072
    buffer_load_dwordx4 v234, s[48:51], s33 offen lds
    v_add_f32 v55, v55, v47
    v_mfma_f32_16x16x32_bf16 v[140:143], v[188:191], a[84:87], v[140:143]
    buffer_load_dwordx4 v235, s[48:51], s33 offen offset:1024 lds
    v_add_f32 v52, v52, v53
    v_add_f32 v54, v54, v55
    v_mfma_f32_16x16x32_bf16 v[144:147], v[184:187], a[88:91], v[144:147]
    v_add_f32 v48, v52, v54
    s_nop 1
    v_mfma_f32_16x16x32_bf16 v[148:151], v[188:191], a[88:91], v[148:151]
    v_add_f32_dpp v48, v48, v48 quad_perm:[1,0,3,2] row_mask:0xf bank_mask:0xf
    s_nop 1
    v_add_f32_dpp v48, v48, v48 quad_perm:[2,3,0,1] row_mask:0xf bank_mask:0xf
    v_mfma_f32_16x16x32_bf16 v[152:155], v[184:187], a[92:95], v[152:155]
    s_nop 1
    v_add_f32_dpp v48, v48, v48 row_half_mirror row_mask:0xf bank_mask:0xf
    v_mfma_f32_16x16x32_bf16 v[156:159], v[188:191], a[92:95], v[156:159]
    s_nop 1
    v_add_f32_dpp v48, v48, v48 row_mirror row_mask:0xf bank_mask:0xf
    s_waitcnt lgkmcnt(0)
    v_mfma_f32_16x16x32_bf16 v[96:99], v[160:163], a[96:99], v[96:99]
    ds_read_b128 v[176:179], v225 offset:24576
    ds_read_b128 v[180:183], v225 offset:26624
    s_nop 0
    v_mfma_f32_16x16x32_bf16 v[100:103], v[164:167], a[96:99], v[100:103]
    ds_read_b128 v[184:187], v225 offset:28672
    v_mov_b32 v49, v48
    s_nop 1
    v_mfma_f32_16x16x32_bf16 v[104:107], v[160:163], a[100:103], v[104:107]
    ds_read_b128 v[188:191], v225 offset:30720
    ds_read_b64_tr_b16 a[112:113], v228 offset:4096
    v_permlane16_swap_b32 v48, v49
    s_nop 0
    v_mfma_f32_16x16x32_bf16 v[108:111], v[164:167], a[100:103], v[108:111]
    ds_read_b64_tr_b16 a[114:115], v228 offset:4608
    v_add_f32 v48, v48, v49
    v_mfma_f32_16x16x32_bf16 v[112:115], v[160:163], a[104:107], v[112:115]
    ds_read_b64_tr_b16 a[116:117], v229 offset:4096
    ds_read_b64_tr_b16 a[118:119], v229 offset:4608
    v_mul_f32 v48, 0x3a800000, v48
    v_sub_f32 v56, v16, v48
    v_mfma_f32_16x16x32_bf16 v[116:119], v[164:167], a[104:107], v[116:119]
    ds_read_b64_tr_b16 a[120:121], v230 offset:4096
    v_mul_f32 v52, v56, v56
    v_mfma_f32_16x16x32_bf16 v[120:123], v[160:163], a[108:111], v[120:123]
    ds_read_b64_tr_b16 a[122:123], v230 offset:4608
    ds_read_b64_tr_b16 a[124:125], v231 offset:4096
    v_sub_f32 v57, v17, v48
    v_mul_f32 v53, v57, v57
    v_mfma_f32_16x16x32_bf16 v[124:127], v[164:167], a[108:111], v[124:127]
    ds_read_b64_tr_b16 a[126:127], v231 offset:4608
    v_sub_f32 v58, v18, v48
    v_mul_f32 v54, v58, v58
    v_mfma_f32_16x16x32_bf16 v[128:131], v[168:171], a[96:99], v[128:131]
    v_sub_f32 v59, v19, v48
    v_mul_f32 v55, v59, v59
    v_mfma_f32_16x16x32_bf16 v[132:135], v[172:175], a[96:99], v[132:135]
    v_sub_f32 v56, v20, v48
    v_fmac_f32 v52, v56, v56
    v_mfma_f32_16x16x32_bf16 v[136:139], v[168:171], a[100:103], v[136:139]
    v_sub_f32 v57, v21, v48
    v_fmac_f32 v53, v57, v57
    v_sub_f32 v58, v22, v48
    v_mfma_f32_16x16x32_bf16 v[140:143], v[172:175], a[100:103], v[140:143]
    v_fmac_f32 v54, v58, v58
    v_sub_f32 v59, v23, v48
    v_mfma_f32_16x16x32_bf16 v[144:147], v[168:171], a[104:107], v[144:147]
    v_fmac_f32 v55, v59, v59
    v_sub_f32 v56, v24, v48
    v_fmac_f32 v52, v56, v56
    v_mfma_f32_16x16x32_bf16 v[148:151], v[172:175], a[104:107], v[148:151]
    v_sub_f32 v57, v25, v48
    v_fmac_f32 v53, v57, v57
    v_mfma_f32_16x16x32_bf16 v[152:155], v[168:171], a[108:111], v[152:155]
    v_sub_f32 v58, v26, v48
    v_fmac_f32 v54, v58, v58
    v_sub_f32 v59, v27, v48
    v_mfma_f32_16x16x32_bf16 v[156:159], v[172:175], a[108:111], v[156:159]
    v_fmac_f32 v55, v59, v59
    s_waitcnt vmcnt(12) lgkmcnt(0)
    s_barrier
    v_mfma_f32_16x16x32_bf16 v[96:99], v[176:179], a[112:115], v[96:99]
    ds_read_b128 v[160:163], v224 offset:32768
    ds_read_b128 v[164:167], v224 offset:34816
    v_sub_f32 v56, v28, v48
    v_mfma_f32_16x16x32_bf16 v[100:103], v[180:183], a[112:115], v[100:103]
    ds_read_b128 v[168:171], v224 offset:36864
    v_fmac_f32 v52, v56, v56
    v_sub_f32 v57, v29, v48
    v_mfma_f32_16x16x32_bf16 v[104:107], v[176:179], a[116:119], v[104:107]
    ds_read_b128 v[172:175], v224 offset:38912
    ds_read_b64_tr_b16 a[128:129], v228 offset:8192
    v_fmac_f32 v53, v57, v57
    v_mfma_f32_16x16x32_bf16 v[108:111], v[180:183], a[116:119], v[108:111]
    ds_read_b64_tr_b16 a[130:131], v228 offset:8704
    v_sub_f32 v58, v30, v48
    v_fmac_f32 v54, v58, v58
    v_mfma_f32_16x16x32_bf16 v[112:115], v[176:179], a[120:123], v[112:115]
    ds_read_b64_tr_b16 a[132:133], v229 offset:8192
    ds_read_b64_tr_b16 a[134:135], v229 offset:8704
    s_add_u32 m0, s35, 0
    s_and_b32 s33, s86, 1023
    s_lshl_b32 s33, s33, 12
    buffer_load_dwordx4 v234, s[48:51], s33 offen lds
    v_mfma_f32_16x16x32_bf16 v[116:119], v[180:183], a[120:123], v[116:119]
    ds_read_b64_tr_b16 a[136:137], v230 offset:8192
    buffer_load_dwordx4 v235, s[48:51], s33 offen offset:1024 lds
    v_sub_f32 v59, v31, v48
    v_mfma_f32_16x16x32_bf16 v[120:123], v[176:179], a[124:127], v[120:123]
    ds_read_b64_tr_b16 a[138:139], v230 offset:8704
    ds_read_b64_tr_b16 a[140:141], v231 offset:8192
    s_add_u32 m0, s35, 2048
    s_add_u32 s33, s33, 131072
    buffer_load_dwordx4 v234, s[48:51], s33 offen lds
    v_mfma_f32_16x16x32_bf16 v[124:127], v[180:183], a[124:127], v[124:127]
    ds_read_b64_tr_b16 a[142:143], v231 offset:8704
    buffer_load_dwordx4 v235, s[48:51], s33 offen offset:1024 lds
    v_fmac_f32 v55, v59, v59
    v_sub_f32 v56, v32, v48
    v_mfma_f32_16x16x32_bf16 v[128:131], v[184:187], a[112:115], v[128:131]
    s_add_u32 m0, s35, 4096
    s_add_u32 s33, s33, 131072
    buffer_load_dwordx4 v234, s[48:51], s33 offen lds
    v_mfma_f32_16x16x32_bf16 v[132:135], v[188:191], a[112:115], v[132:135]
    buffer_load_dwordx4 v235, s[48:51], s33 offen offset:1024 lds
    v_fmac_f32 v52, v56, v56
    v_sub_f32 v57, v33, v48
    v_mfma_f32_16x16x32_bf16 v[136:139], v[184:187], a[116:119], v[136:139]
    s_add_u32 m0, s35, 6144
    s_add_u32 s33, s33, 131072
    buffer_load_dwordx4 v234, s[48:51], s33 offen lds
    v_fmac_f32 v53, v57, v57
    v_mfma_f32_16x16x32_bf16 v[140:143], v[188:191], a[116:119], v[140:143]
    buffer_load_dwordx4 v235, s[48:51], s33 offen offset:1024 lds
    v_sub_f32 v58, v34, v48
    v_fmac_f32 v54, v58, v58
    v_mfma_f32_16x16x32_bf16 v[144:147], v[184:187], a[120:123], v[144:147]
    v_sub_f32 v59, v35, v48
    v_fmac_f32 v55, v59, v59
    v_mfma_f32_16x16x32_bf16 v[148:151], v[188:191], a[120:123], v[148:151]
    v_sub_f32 v56, v36, v48
    v_fmac_f32 v52, v56, v56
    v_sub_f32 v57, v37, v48
    v_mfma_f32_16x16x32_bf16 v[152:155], v[184:187], a[124:127], v[152:155]
    v_fmac_f32 v53, v57, v57
    v_sub_f32 v58, v38, v48
    v_mfma_f32_16x16x32_bf16 v[156:159], v[188:191], a[124:127], v[156:159]
    v_fmac_f32 v54, v58, v58
    v_sub_f32 v59, v39, v48
    s_waitcnt lgkmcnt(0)
    v_mfma_f32_16x16x32_bf16 v[96:99], v[160:163], a[128:131], v[96:99]
    ds_read_b128 v[176:179], v225 offset:32768
    ds_read_b128 v[180:183], v225 offset:34816
    v_fmac_f32 v55, v59, v59
    v_mfma_f32_16x16x32_bf16 v[100:103], v[164:167], a[128:131], v[100:103]
    ds_read_b128 v[184:187], v225 offset:36864
    v_sub_f32 v56, v40, v48
    v_fmac_f32 v52, v56, v56
    v_mfma_f32_16x16x32_bf16 v[104:107], v[160:163], a[132:135], v[104:107]
    ds_read_b128 v[188:191], v225 offset:38912
    ds_read_b64_tr_b16 a[144:145], v228 offset:12288
    v_sub_f32 v57, v41, v48
    v_mfma_f32_16x16x32_bf16 v[108:111], v[164:167], a[132:135], v[108:111]
    ds_read_b64_tr_b16 a[146:147], v228 offset:12800
    v_fmac_f32 v53, v57, v57
    v_sub_f32 v58, v42, v48
    v_mfma_f32_16x16x32_bf16 v[112:115], v[160:163], a[136:139], v[112:115]
    ds_read_b64_tr_b16 a[148:149], v229 offset:12288
    ds_read_b64_tr_b16 a[150:151], v229 offset:12800
    v_fmac_f32 v54, v58, v58
    v_mfma_f32_16x16x32_bf16 v[116:119], v[164:167], a[136:139], v[116:119]
    ds_read_b64_tr_b16 a[152:153], v230 offset:12288
    s_add_u32 m0, s34, 0
    s_add_u32 s37, s80, 65536
    buffer_load_dwordx4 v232, s[44:47], s37 offen lds
    v_mfma_f32_16x16x32_bf16 v[120:123], v[160:163], a[140:143], v[120:123]
    ds_read_b64_tr_b16 a[154:155], v230 offset:12800
    ds_read_b64_tr_b16 a[156:157], v231 offset:12288
    v_sub_f32 v59, v43, v48
    v_fmac_f32 v55, v59, v59
    v_mfma_f32_16x16x32_bf16 v[124:127], v[164:167], a[140:143], v[124:127]
    ds_read_b64_tr_b16 a[158:159], v231 offset:12800
    buffer_load_dwordx4 v233, s[44:47], s37 offen offset:1024 lds
    v_sub_f32 v56, v44, v48
    v_mfma_f32_16x16x32_bf16 v[128:131], v[168:171], a[128:131], v[128:131]
    v_fmac_f32 v52, v56, v56
    v_sub_f32 v57, v45, v48
    v_mfma_f32_16x16x32_bf16 v[132:135], v[172:175], a[128:131], v[132:135]
    s_add_u32 m0, s34, 8192
    s_add_u32 s37, s81, 65536
    buffer_load_dwordx4 v232, s[44:47], s37 offen lds
    v_fmac_f32 v53, v57, v57
    v_mfma_f32_16x16x32_bf16 v[136:139], v[168:171], a[132:135], v[136:139]
    v_sub_f32 v58, v46, v48
    v_fmac_f32 v54, v58, v58
    v_mfma_f32_16x16x32_bf16 v[140:143], v[172:175], a[132:135], v[140:143]
    buffer_load_dwordx4 v233, s[44:47], s37 offen offset:1024 lds
    v_sub_f32 v59, v47, v48
    v_fmac_f32 v55, v59, v59
    v_mfma_f32_16x16x32_bf16 v[144:147], v[168:171], a[136:139], v[144:147]
    v_add_f32 v52, v52, v53
    v_add_f32 v54, v54, v55
    v_add_f32 v51, v52, v54
    v_mfma_f32_16x16x32_bf16 v[148:151], v[172:175], a[136:139], v[148:151]
    s_nop 1
    v_add_f32_dpp v51, v51, v51 quad_perm:[1,0,3,2] row_mask:0xf bank_mask:0xf
    v_mfma_f32_16x16x32_bf16 v[152:155], v[168:171], a[140:143], v[152:155]
    s_nop 1
    v_add_f32_dpp v51, v51, v51 quad_perm:[2,3,0,1] row_mask:0xf bank_mask:0xf
    s_nop 1
    v_mfma_f32_16x16x32_bf16 v[156:159], v[172:175], a[140:143], v[156:159]
    v_add_f32_dpp v51, v51, v51 row_half_mirror row_mask:0xf bank_mask:0xf
    s_waitcnt vmcnt(12) lgkmcnt(0)
    v_mfma_f32_16x16x32_bf16 v[96:99], v[176:179], a[144:147], v[96:99]
    ds_read_b128 v[160:163], v224 offset:40960
    ds_read_b128 v[164:167], v224 offset:43008
    s_nop 1
    v_add_f32_dpp v51, v51, v51 row_mirror row_mask:0xf bank_mask:0xf
    v_mfma_f32_16x16x32_bf16 v[100:103], v[180:183], a[144:147], v[100:103]
    ds_read_b128 v[168:171], v224 offset:45056
    s_nop 0
    v_mov_b32 v49, v51
    v_mfma_f32_16x16x32_bf16 v[104:107], v[176:179], a[148:151], v[104:107]
    ds_read_b128 v[172:175], v224 offset:47104
    ds_read_b64_tr_b16 a[160:161], v228 offset:16384
    s_nop 1
    v_mfma_f32_16x16x32_bf16 v[108:111], v[180:183], a[148:151], v[108:111]
    ds_read_b64_tr_b16 a[162:163], v228 offset:16896
    v_permlane16_swap_b32 v51, v49
    s_nop 0
    v_mfma_f32_16x16x32_bf16 v[112:115], v[176:179], a[152:155], v[112:115]
    ds_read_b64_tr_b16 a[164:165], v229 offset:16384
    ds_read_b64_tr_b16 a[166:167], v229 offset:16896
    s_add_u32 m0, s35, 8192
    s_and_b32 s33, s87, 1023
    s_lshl_b32 s33, s33, 12
    buffer_load_dwordx4 v234, s[48:51], s33 offen lds
    v_mfma_f32_16x16x32_bf16 v[116:119], v[180:183], a[152:155], v[116:119]
    ds_read_b64_tr_b16 a[168:169], v230 offset:16384
    buffer_load_dwordx4 v235, s[48:51], s33 offen offset:1024 lds
    v_add_f32 v51, v51, v49
    v_mfma_f32_16x16x32_bf16 v[120:123], v[176:179], a[156:159], v[120:123]
    ds_read_b64_tr_b16 a[170:171], v230 offset:16896
    ds_read_b64_tr_b16 a[172:173], v231 offset:16384
    s_add_u32 m0, s35, 10240
    s_add_u32 s33, s33, 131072
    buffer_load_dwordx4 v234, s[48:51], s33 offen lds
    v_mfma_f32_16x16x32_bf16 v[124:127], v[180:183], a[156:159], v[124:127]
    ds_read_b64_tr_b16 a[174:175], v231 offset:16896
    buffer_load_dwordx4 v235, s[48:51], s33 offen offset:1024 lds
    v_mul_f32 v51, 0x3a800000, v51
    v_mfma_f32_16x16x32_bf16 v[128:131], v[184:187], a[144:147], v[128:131]
    s_add_u32 m0, s35, 12288
    s_add_u32 s33, s33, 131072
    buffer_load_dwordx4 v234, s[48:51], s33 offen lds
    v_cvt_pk_bf16_f32 v50, v48, v51
    v_mfma_f32_16x16x32_bf16 v[132:135], v[188:191], a[144:147], v[132:135]
    buffer_load_dwordx4 v235, s[48:51], s33 offen offset:1024 lds
    v_and_b32 v51, 0xffff0000, v50
    v_lshlrev_b32 v50, 16, v50
    v_mfma_f32_16x16x32_bf16 v[136:139], v[184:187], a[148:151], v[136:139]
    s_add_u32 m0, s35, 14336
    s_add_u32 s33, s33, 131072
    buffer_load_dwordx4 v234, s[48:51], s33 offen lds
    v_mfma_f32_16x16x32_bf16 v[140:143], v[188:191], a[148:151], v[140:143]
    buffer_load_dwordx4 v235, s[48:51], s33 offen offset:1024 lds
    v_add_f32 v51, 0x3727c5ac, v51
    v_cvt_pk_bf16_f32 v51, v51, v51
    v_mfma_f32_16x16x32_bf16 v[144:147], v[184:187], a[152:155], v[144:147]
    v_lshlrev_b32 v51, 16, v51
    v_sqrt_f32 v51, v51
    v_mfma_f32_16x16x32_bf16 v[148:151], v[188:191], a[152:155], v[148:151]
    s_nop 0
    v_cvt_pk_bf16_f32 v51, v51, v51
    v_mfma_f32_16x16x32_bf16 v[152:155], v[184:187], a[156:159], v[152:155]
    v_lshlrev_b32 v51, 16, v51
    v_rcp_f32 v51, v51
    v_mfma_f32_16x16x32_bf16 v[156:159], v[188:191], a[156:159], v[156:159]
    s_nop 0
    s_waitcnt lgkmcnt(0)
    v_mfma_f32_16x16x32_bf16 v[96:99], v[160:163], a[160:163], v[96:99]
    ds_read_b128 v[176:179], v225 offset:40960
    ds_read_b128 v[180:183], v225 offset:43008
    v_sub_f32 v16, v16, v50
    v_mfma_f32_16x16x32_bf16 v[100:103], v[164:167], a[160:163], v[100:103]
    ds_read_b128 v[184:187], v225 offset:45056
    v_sub_f32 v17, v17, v50
    v_cvt_pk_bf16_f32 v17, v16, v17
    v_mfma_f32_16x16x32_bf16 v[104:107], v[160:163], a[164:167], v[104:107]
    ds_read_b128 v[188:191], v225 offset:47104
    ds_read_b64_tr_b16 a[176:177], v228 offset:20480
    v_lshlrev_b32 v16, 16, v17
    v_and_b32 v17, 0xffff0000, v17
    v_mfma_f32_16x16x32_bf16 v[108:111], v[164:167], a[164:167], v[108:111]
    ds_read_b64_tr_b16 a[178:179], v228 offset:20992
    v_mul_f32 v16, v16, v51
    v_mfma_f32_16x16x32_bf16 v[112:115], v[160:163], a[168:171], v[112:115]
    ds_read_b64_tr_b16 a[180:181], v229 offset:20480
    ds_read_b64_tr_b16 a[182:183], v229 offset:20992
    v_mul_f32 v17, v17, v51
    v_cvt_pk_bf16_f32 v0, v16, v17
    v_mfma_f32_16x16x32_bf16 v[116:119], v[164:167], a[168:171], v[116:119]
    ds_read_b64_tr_b16 a[184:185], v230 offset:20480
    s_add_u32 m0, s34, 16384
    s_add_u32 s37, s82, 65536
    buffer_load_dwordx4 v232, s[44:47], s37 offen lds
    v_mfma_f32_16x16x32_bf16 v[120:123], v[160:163], a[172:175], v[120:123]
    ds_read_b64_tr_b16 a[186:187], v230 offset:20992
    ds_read_b64_tr_b16 a[188:189], v231 offset:20480
    v_sub_f32 v18, v18, v50
    v_mfma_f32_16x16x32_bf16 v[124:127], v[164:167], a[172:175], v[124:127]
    ds_read_b64_tr_b16 a[190:191], v231 offset:20992
    buffer_load_dwordx4 v233, s[44:47], s37 offen offset:1024 lds
    v_sub_f32 v19, v19, v50
    v_mfma_f32_16x16x32_bf16 v[128:131], v[168:171], a[160:163], v[128:131]
    v_cvt_pk_bf16_f32 v19, v18, v19
    v_lshlrev_b32 v18, 16, v19
    v_and_b32 v19, 0xffff0000, v19
    v_mfma_f32_16x16x32_bf16 v[132:135], v[172:175], a[160:163], v[132:135]
    s_add_u32 m0, s34, 24576
    s_add_u32 s37, s83, 65536
    buffer_load_dwordx4 v232, s[44:47], s37 offen lds
    v_mfma_f32_16x16x32_bf16 v[136:139], v[168:171], a[164:167], v[136:139]
    v_mul_f32 v18, v18, v51
    v_mul_f32 v19, v19, v51
    v_cvt_pk_bf16_f32 v1, v18, v19
    v_mfma_f32_16x16x32_bf16 v[140:143], v[172:175], a[164:167], v[140:143]
    buffer_load_dwordx4 v233, s[44:47], s37 offen offset:1024 lds
    v_sub_f32 v20, v20, v50
    v_sub_f32 v21, v21, v50
    v_mfma_f32_16x16x32_bf16 v[144:147], v[168:171], a[168:171], v[144:147]
    v_cvt_pk_bf16_f32 v21, v20, v21
    v_lshlrev_b32 v20, 16, v21
    v_mfma_f32_16x16x32_bf16 v[148:151], v[172:175], a[168:171], v[148:151]
    v_and_b32 v21, 0xffff0000, v21
    v_mul_f32 v20, v20, v51
    v_mfma_f32_16x16x32_bf16 v[152:155], v[168:171], a[172:175], v[152:155]
    v_mul_f32 v21, v21, v51
    v_cvt_pk_bf16_f32 v2, v20, v21
    v_sub_f32 v22, v22, v50
    v_mfma_f32_16x16x32_bf16 v[156:159], v[172:175], a[172:175], v[156:159]
    v_sub_f32 v23, v23, v50
    s_waitcnt vmcnt(16) lgkmcnt(0)
    s_barrier
    v_mfma_f32_16x16x32_bf16 v[96:99], v[176:179], a[176:179], v[96:99]
    ds_read_b128 v[160:163], v224 offset:49152
    ds_read_b128 v[164:167], v224 offset:51200
    v_cvt_pk_bf16_f32 v23, v22, v23
    v_mfma_f32_16x16x32_bf16 v[100:103], v[180:183], a[176:179], v[100:103]
    ds_read_b128 v[168:171], v224 offset:53248
    v_lshlrev_b32 v22, 16, v23
    v_and_b32 v23, 0xffff0000, v23
    v_mfma_f32_16x16x32_bf16 v[104:107], v[176:179], a[180:183], v[104:107]
    ds_read_b128 v[172:175], v224 offset:55296
    ds_read_b64_tr_b16 a[192:193], v228 offset:0
    v_mul_f32 v22, v22, v51
    v_mfma_f32_16x16x32_bf16 v[108:111], v[180:183], a[180:183], v[108:111]
    ds_read_b64_tr_b16 a[194:195], v228 offset:512
    v_mul_f32 v23, v23, v51
    v_cvt_pk_bf16_f32 v3, v22, v23
    v_mfma_f32_16x16x32_bf16 v[112:115], v[176:179], a[184:187], v[112:115]
    ds_read_b64_tr_b16 a[196:197], v229 offset:0
    ds_read_b64_tr_b16 a[198:199], v229 offset:512
    v_sub_f32 v24, v24, v50
    v_sub_f32 v25, v25, v50
    v_mfma_f32_16x16x32_bf16 v[116:119], v[180:183], a[184:187], v[116:119]
    ds_read_b64_tr_b16 a[200:201], v230 offset:0
    v_cvt_pk_bf16_f32 v25, v24, v25
    v_mfma_f32_16x16x32_bf16 v[120:123], v[176:179], a[188:191], v[120:123]
    ds_read_b64_tr_b16 a[202:203], v230 offset:512
    ds_read_b64_tr_b16 a[204:205], v231 offset:0
    v_lshlrev_b32 v24, 16, v25
    v_and_b32 v25, 0xffff0000, v25
    v_mfma_f32_16x16x32_bf16 v[124:127], v[180:183], a[188:191], v[124:127]
    ds_read_b64_tr_b16 a[206:207], v231 offset:512
    v_mul_f32 v24, v24, v51
    v_mul_f32 v25, v25, v51
    v_mfma_f32_16x16x32_bf16 v[128:131], v[184:187], a[176:179], v[128:131]
    v_cvt_pk_bf16_f32 v4, v24, v25
    v_sub_f32 v26, v26, v50
    v_mfma_f32_16x16x32_bf16 v[132:135], v[188:191], a[176:179], v[132:135]
    v_sub_f32 v27, v27, v50
    v_cvt_pk_bf16_f32 v27, v26, v27
    v_mfma_f32_16x16x32_bf16 v[136:139], v[184:187], a[180:183], v[136:139]
    v_lshlrev_b32 v26, 16, v27
    v_and_b32 v27, 0xffff0000, v27
    v_mul_f32 v26, v26, v51
    v_mfma_f32_16x16x32_bf16 v[140:143], v[188:191], a[180:183], v[140:143]
    v_mul_f32 v27, v27, v51
    v_cvt_pk_bf16_f32 v5, v26, v27
    v_mfma_f32_16x16x32_bf16 v[144:147], v[184:187], a[184:187], v[144:147]
    v_sub_f32 v28, v28, v50
    v_sub_f32 v29, v29, v50
    v_cvt_pk_bf16_f32 v29, v28, v29
    v_mfma_f32_16x16x32_bf16 v[148:151], v[188:191], a[184:187], v[148:151]
    v_lshlrev_b32 v28, 16, v29
    v_and_b32 v29, 0xffff0000, v29
    v_mfma_f32_16x16x32_bf16 v[152:155], v[184:187], a[188:191], v[152:155]
    v_mul_f32 v28, v28, v51
    v_mul_f32 v29, v29, v51
    v_cvt_pk_bf16_f32 v6, v28, v29
    v_mfma_f32_16x16x32_bf16 v[156:159], v[188:191], a[188:191], v[156:159]
    v_sub_f32 v30, v30, v50
    v_sub_f32 v31, v31, v50
    s_waitcnt lgkmcnt(0)
    v_mfma_f32_16x16x32_bf16 v[96:99], v[160:163], a[192:195], v[96:99]
    ds_read_b128 v[176:179], v225 offset:49152
    ds_read_b128 v[180:183], v225 offset:51200
    v_cvt_pk_bf16_f32 v31, v30, v31
    v_mfma_f32_16x16x32_bf16 v[100:103], v[164:167], a[192:195], v[100:103]
    ds_read_b128 v[184:187], v225 offset:53248
    v_lshlrev_b32 v30, 16, v31
    v_and_b32 v31, 0xffff0000, v31
    v_mfma_f32_16x16x32_bf16 v[104:107], v[160:163], a[196:199], v[104:107]
    ds_read_b128 v[188:191], v225 offset:55296
    ds_read_b64_tr_b16 a[208:209], v228 offset:4096
    v_mul_f32 v30, v30, v51
    v_mfma_f32_16x16x32_bf16 v[108:111], v[164:167], a[196:199], v[108:111]
    ds_read_b64_tr_b16 a[210:211], v228 offset:4608
    v_mul_f32 v31, v31, v51
    v_cvt_pk_bf16_f32 v7, v30, v31
    v_mfma_f32_16x16x32_bf16 v[112:115], v[160:163], a[200:203], v[112:115]
    ds_read_b64_tr_b16 a[212:213], v229 offset:4096
    ds_read_b64_tr_b16 a[214:215], v229 offset:4608
    v_sub_f32 v32, v32, v50
    v_mfma_f32_16x16x32_bf16 v[116:119], v[164:167], a[200:203], v[116:119]
    ds_read_b64_tr_b16 a[216:217], v230 offset:4096
    s_add_u32 m0, s34, 32768
    s_add_u32 s37, s84, 65536
    buffer_load_dwordx4 v232, s[44:47], s37 offen lds
    v_mfma_f32_16x16x32_bf16 v[120:123], v[160:163], a[204:207], v[120:123]
    ds_read_b64_tr_b16 a[218:219], v230 offset:4608
    ds_read_b64_tr_b16 a[220:221], v231 offset:4096
    v_sub_f32 v33, v33, v50
    v_mfma_f32_16x16x32_bf16 v[124:127], v[164:167], a[204:207], v[124:127]
    ds_read_b64_tr_b16 a[222:223], v231 offset:4608
    buffer_load_dwordx4 v233, s[44:47], s37 offen offset:1024 lds
    v_cvt_pk_bf16_f32 v33, v32, v33
    v_lshlrev_b32 v32, 16, v33
    v_mfma_f32_16x16x32_bf16 v[128:131], v[168:171], a[192:195], v[128:131]
    v_and_b32 v33, 0xffff0000, v33
    v_mul_f32 v32, v32, v51
    v_mfma_f32_16x16x32_bf16 v[132:135], v[172:175], a[192:195], v[132:135]
    s_add_u32 m0, s34, 40960
    s_add_u32 s37, s85, 65536
    buffer_load_dwordx4 v232, s[44:47], s37 offen lds
    v_mul_f32 v33, v33, v51
    v_mfma_f32_16x16x32_bf16 v[136:139], v[168:171], a[196:199], v[136:139]
    v_cvt_pk_bf16_f32 v8, v32, v33
    v_sub_f32 v34, v34, v50
    v_mfma_f32_16x16x32_bf16 v[140:143], v[172:175], a[196:199], v[140:143]
    buffer_load_dwordx4 v233, s[44:47], s37 offen offset:1024 lds
    v_sub_f32 v35, v35, v50
    v_cvt_pk_bf16_f32 v35, v34, v35
    v_mfma_f32_16x16x32_bf16 v[144:147], v[168:171], a[200:203], v[144:147]
    v_lshlrev_b32 v34, 16, v35
    v_and_b32 v35, 0xffff0000, v35
    v_mfma_f32_16x16x32_bf16 v[148:151], v[172:175], a[200:203], v[148:151]
    v_mul_f32 v34, v34, v51
    v_mul_f32 v35, v35, v51
    v_cvt_pk_bf16_f32 v9, v34, v35
    v_mfma_f32_16x16x32_bf16 v[152:155], v[168:171], a[204:207], v[152:155]
    v_sub_f32 v36, v36, v50
    v_sub_f32 v37, v37, v50
    v_mfma_f32_16x16x32_bf16 v[156:159], v[172:175], a[204:207], v[156:159]
    v_cvt_pk_bf16_f32 v37, v36, v37
    v_lshlrev_b32 v36, 16, v37
    s_waitcnt vmcnt(8) lgkmcnt(0)
    v_mfma_f32_16x16x32_bf16 v[96:99], v[176:179], a[208:211], v[96:99]
    ds_read_b128 v[160:163], v224 offset:57344
    ds_read_b128 v[164:167], v224 offset:59392
    v_and_b32 v37, 0xffff0000, v37
    v_mfma_f32_16x16x32_bf16 v[100:103], v[180:183], a[208:211], v[100:103]
    ds_read_b128 v[168:171], v224 offset:61440
    v_mul_f32 v36, v36, v51
    v_mul_f32 v37, v37, v51
    v_mfma_f32_16x16x32_bf16 v[104:107], v[176:179], a[212:215], v[104:107]
    ds_read_b128 v[172:175], v224 offset:63488
    ds_read_b64_tr_b16 a[224:225], v228 offset:8192
    v_cvt_pk_bf16_f32 v10, v36, v37
    v_sub_f32 v38, v38, v50
    v_mfma_f32_16x16x32_bf16 v[108:111], v[180:183], a[212:215], v[108:111]
    ds_read_b64_tr_b16 a[226:227], v228 offset:8704
    v_sub_f32 v39, v39, v50
    v_mfma_f32_16x16x32_bf16 v[112:115], v[176:179], a[216:219], v[112:115]
    ds_read_b64_tr_b16 a[228:229], v229 offset:8192
    ds_read_b64_tr_b16 a[230:231], v229 offset:8704
    v_cvt_pk_bf16_f32 v39, v38, v39
    v_lshlrev_b32 v38, 16, v39
    v_mfma_f32_16x16x32_bf16 v[116:119], v[180:183], a[216:219], v[116:119]
    ds_read_b64_tr_b16 a[232:233], v230 offset:8192
    v_and_b32 v39, 0xffff0000, v39
    v_mfma_f32_16x16x32_bf16 v[120:123], v[176:179], a[220:223], v[120:123]
    ds_read_b64_tr_b16 a[234:235], v230 offset:8704
    ds_read_b64_tr_b16 a[236:237], v231 offset:8192
    v_mul_f32 v38, v38, v51
    v_mul_f32 v39, v39, v51
    v_mfma_f32_16x16x32_bf16 v[124:127], v[180:183], a[220:223], v[124:127]
    ds_read_b64_tr_b16 a[238:239], v231 offset:8704
    v_cvt_pk_bf16_f32 v11, v38, v39
    v_sub_f32 v40, v40, v50
    v_mfma_f32_16x16x32_bf16 v[128:131], v[184:187], a[208:211], v[128:131]
    v_sub_f32 v41, v41, v50
    v_cvt_pk_bf16_f32 v41, v40, v41
    v_mfma_f32_16x16x32_bf16 v[132:135], v[188:191], a[208:211], v[132:135]
    v_lshlrev_b32 v40, 16, v41
    v_and_b32 v41, 0xffff0000, v41
    v_mfma_f32_16x16x32_bf16 v[136:139], v[184:187], a[212:215], v[136:139]
    v_mul_f32 v40, v40, v51
    v_mul_f32 v41, v41, v51
    v_cvt_pk_bf16_f32 v12, v40, v41
    v_mfma_f32_16x16x32_bf16 v[140:143], v[188:191], a[212:215], v[140:143]
    v_sub_f32 v42, v42, v50
    v_sub_f32 v43, v43, v50
    v_mfma_f32_16x16x32_bf16 v[144:147], v[184:187], a[216:219], v[144:147]
    v_cvt_pk_bf16_f32 v43, v42, v43
    v_lshlrev_b32 v42, 16, v43
    v_and_b32 v43, 0xffff0000, v43
    v_mfma_f32_16x16x32_bf16 v[148:151], v[188:191], a[216:219], v[148:151]
    v_mul_f32 v42, v42, v51
    v_mul_f32 v43, v43, v51
    v_mfma_f32_16x16x32_bf16 v[152:155], v[184:187], a[220:223], v[152:155]
    v_cvt_pk_bf16_f32 v13, v42, v43
    v_sub_f32 v44, v44, v50
    v_sub_f32 v45, v45, v50
    v_mfma_f32_16x16x32_bf16 v[156:159], v[188:191], a[220:223], v[156:159]
    v_cvt_pk_bf16_f32 v45, v44, v45
    v_lshlrev_b32 v44, 16, v45
    s_waitcnt lgkmcnt(0)
    v_mfma_f32_16x16x32_bf16 v[96:99], v[160:163], a[224:227], v[96:99]
    ds_read_b128 v[176:179], v225 offset:57344
    ds_read_b128 v[180:183], v225 offset:59392
    v_and_b32 v45, 0xffff0000, v45
    v_mfma_f32_16x16x32_bf16 v[100:103], v[164:167], a[224:227], v[100:103]
    ds_read_b128 v[184:187], v225 offset:61440
    v_mul_f32 v44, v44, v51
    v_mul_f32 v45, v45, v51
    v_mfma_f32_16x16x32_bf16 v[104:107], v[160:163], a[228:231], v[104:107]
    ds_read_b128 v[188:191], v225 offset:63488
    ds_read_b64_tr_b16 a[240:241], v228 offset:12288
    v_cvt_pk_bf16_f32 v14, v44, v45
    v_mfma_f32_16x16x32_bf16 v[108:111], v[164:167], a[228:231], v[108:111]
    ds_read_b64_tr_b16 a[242:243], v228 offset:12800
    v_sub_f32 v46, v46, v50
    v_sub_f32 v47, v47, v50
    v_mfma_f32_16x16x32_bf16 v[112:115], v[160:163], a[232:235], v[112:115]
    ds_read_b64_tr_b16 a[244:245], v229 offset:12288
    ds_read_b64_tr_b16 a[246:247], v229 offset:12800
    v_cvt_pk_bf16_f32 v47, v46, v47
    v_mfma_f32_16x16x32_bf16 v[116:119], v[164:167], a[232:235], v[116:119]
    ds_read_b64_tr_b16 a[248:249], v230 offset:12288
    v_lshlrev_b32 v46, 16, v47
    v_and_b32 v47, 0xffff0000, v47
    v_mfma_f32_16x16x32_bf16 v[120:123], v[160:163], a[236:239], v[120:123]
    ds_read_b64_tr_b16 a[250:251], v230 offset:12800
    ds_read_b64_tr_b16 a[252:253], v231 offset:12288
    v_mul_f32 v46, v46, v51
    v_mfma_f32_16x16x32_bf16 v[124:127], v[164:167], a[236:239], v[124:127]
    ds_read_b64_tr_b16 a[254:255], v231 offset:12800
    v_mul_f32 v47, v47, v51
    v_cvt_pk_bf16_f32 v15, v46, v47
    v_mfma_f32_16x16x32_bf16 v[128:131], v[168:171], a[224:227], v[128:131]
    v_mfma_f32_16x16x32_bf16 v[132:135], v[172:175], a[224:227], v[132:135]
    ds_write_b128 v237, v[0:3] offset:0
    v_mfma_f32_16x16x32_bf16 v[136:139], v[168:171], a[228:231], v[136:139]
    ds_write_b128 v237, v[4:7] offset:4096
    v_mfma_f32_16x16x32_bf16 v[140:143], v[172:175], a[228:231], v[140:143]
    ds_write_b128 v237, v[8:11] offset:24576
    v_mfma_f32_16x16x32_bf16 v[144:147], v[168:171], a[232:235], v[144:147]
    ds_write_b128 v237, v[12:15] offset:28672
    v_mfma_f32_16x16x32_bf16 v[148:151], v[172:175], a[232:235], v[148:151]
    v_mfma_f32_16x16x32_bf16 v[152:155], v[168:171], a[236:239], v[152:155]
    v_mfma_f32_16x16x32_bf16 v[156:159], v[172:175], a[236:239], v[156:159]
    s_waitcnt vmcnt(16) lgkmcnt(0)
    s_barrier
    v_mfma_f32_16x16x32_bf16 v[96:99], v[176:179], a[240:243], v[96:99]
    ds_read_b128 v[160:163], v224 offset:0
    v_mfma_f32_16x16x32_bf16 v[100:103], v[180:183], a[240:243], v[100:103]
    ds_read_b128 v[164:167], v224 offset:2048
    v_mfma_f32_16x16x32_bf16 v[104:107], v[176:179], a[244:247], v[104:107]
    ds_read_b128 v[168:171], v224 offset:4096
    v_mfma_f32_16x16x32_bf16 v[108:111], v[180:183], a[244:247], v[108:111]
    ds_read_b128 v[172:175], v224 offset:6144
    v_mfma_f32_16x16x32_bf16 v[112:115], v[176:179], a[248:251], v[112:115]
    v_lshlrev_b32 v237, 4, v253
    v_add_u32 v237, 81920, v237
    ds_read_b128 v[16:19], v237 offset:0
    ds_read_b128 v[20:23], v237 offset:4096
    ds_read_b128 v[24:27], v237 offset:24576
    ds_read_b128 v[28:31], v237 offset:28672
    v_mfma_f32_16x16x32_bf16 v[116:119], v[180:183], a[248:251], v[116:119]
    s_add_u32 m0, s34, 49152
    s_add_u32 s37, s86, 65536
    buffer_load_dwordx4 v232, s[44:47], s37 offen lds
    v_mfma_f32_16x16x32_bf16 v[120:123], v[176:179], a[252:255], v[120:123]
    v_mfma_f32_16x16x32_bf16 v[124:127], v[180:183], a[252:255], v[124:127]
    buffer_load_dwordx4 v233, s[44:47], s37 offen offset:1024 lds
    v_mfma_f32_16x16x32_bf16 v[128:131], v[184:187], a[240:243], v[128:131]
    v_mfma_f32_16x16x32_bf16 v[132:135], v[188:191], a[240:243], v[132:135]
    s_add_u32 m0, s34, 57344
    s_add_u32 s37, s87, 65536
    buffer_load_dwordx4 v232, s[44:47], s37 offen lds
    v_cvt_pk_bf16_f32 v64, v96, v97
    v_cvt_pk_bf16_f32 v65, v98, v99
    v_mfma_f32_16x16x32_bf16 v[136:139], v[184:187], a[244:247], v[136:139]
    v_cvt_pk_bf16_f32 v66, v100, v101
    v_cvt_pk_bf16_f32 v67, v102, v103
    v_mfma_f32_16x16x32_bf16 v[140:143], v[188:191], a[244:247], v[140:143]
    buffer_load_dwordx4 v233, s[44:47], s37 offen offset:1024 lds
    v_cvt_pk_bf16_f32 v68, v104, v105
    v_cvt_pk_bf16_f32 v69, v106, v107
    v_mfma_f32_16x16x32_bf16 v[144:147], v[184:187], a[248:251], v[144:147]
    v_cvt_pk_bf16_f32 v70, v108, v109
    v_cvt_pk_bf16_f32 v71, v110, v111
    v_mfma_f32_16x16x32_bf16 v[148:151], v[188:191], a[248:251], v[148:151]
    v_cvt_pk_bf16_f32 v72, v112, v113
    v_cvt_pk_bf16_f32 v73, v114, v115
    v_mfma_f32_16x16x32_bf16 v[152:155], v[184:187], a[252:255], v[152:155]
    v_cvt_pk_bf16_f32 v74, v116, v117
    v_cvt_pk_bf16_f32 v75, v118, v119
    v_mfma_f32_16x16x32_bf16 v[156:159], v[188:191], a[252:255], v[156:159]
    v_cvt_pk_bf16_f32 v76, v120, v121
    v_cvt_pk_bf16_f32 v77, v122, v123
    s_waitcnt lgkmcnt(0)
    v_mfma_f32_16x16x32_bf16 v[96:99], v[160:163], a[0:3], 0
    ds_read_b128 v[176:179], v225 offset:0
    v_cvt_pk_bf16_f32 v78, v124, v125
    v_cvt_pk_bf16_f32 v79, v126, v127
    v_mfma_f32_16x16x32_bf16 v[100:103], v[164:167], a[0:3], 0
    ds_read_b128 v[180:183], v225 offset:2048
    v_cvt_pk_bf16_f32 v80, v128, v129
    v_cvt_pk_bf16_f32 v81, v130, v131
    v_mfma_f32_16x16x32_bf16 v[104:107], v[160:163], a[4:7], 0
    ds_read_b128 v[184:187], v225 offset:4096
    v_cvt_pk_bf16_f32 v82, v132, v133
    v_cvt_pk_bf16_f32 v83, v134, v135
    v_mfma_f32_16x16x32_bf16 v[108:111], v[164:167], a[4:7], 0
    ds_read_b128 v[188:191], v225 offset:6144
    v_cvt_pk_bf16_f32 v84, v136, v137
    v_cvt_pk_bf16_f32 v85, v138, v139
    v_mfma_f32_16x16x32_bf16 v[112:115], v[160:163], a[8:11], 0
    v_cvt_pk_bf16_f32 v86, v140, v141
    v_cvt_pk_bf16_f32 v87, v142, v143
    s_mov_b32 s39, 0
    buffer_store_dwordx4 v[16:19], v238, s[8:11], s39 offen sc1
    v_mfma_f32_16x16x32_bf16 v[116:119], v[164:167], a[8:11], 0
    v_cvt_pk_bf16_f32 v88, v144, v145
    v_cvt_pk_bf16_f32 v89, v146, v147
    v_mfma_f32_16x16x32_bf16 v[120:123], v[160:163], a[12:15], 0
    v_cvt_pk_bf16_f32 v90, v148, v149
    v_cvt_pk_bf16_f32 v91, v150, v151
    v_mfma_f32_16x16x32_bf16 v[124:127], v[164:167], a[12:15], 0
    v_cvt_pk_bf16_f32 v92, v152, v153
    v_cvt_pk_bf16_f32 v93, v154, v155
    v_mfma_f32_16x16x32_bf16 v[128:131], v[168:171], a[0:3], 0
    v_cvt_pk_bf16_f32 v94, v156, v157
    v_cvt_pk_bf16_f32 v95, v158, v159
    v_mfma_f32_16x16x32_bf16 v[132:135], v[172:175], a[0:3], 0
    v_mfma_f32_16x16x32_bf16 v[136:139], v[168:171], a[4:7], 0
    v_mfma_f32_16x16x32_bf16 v[140:143], v[172:175], a[4:7], 0
    v_mfma_f32_16x16x32_bf16 v[144:147], v[168:171], a[8:11], 0
    v_mfma_f32_16x16x32_bf16 v[148:151], v[172:175], a[8:11], 0
    v_mfma_f32_16x16x32_bf16 v[152:155], v[168:171], a[12:15], 0
    v_mfma_f32_16x16x32_bf16 v[156:159], v[172:175], a[12:15], 0
    s_waitcnt lgkmcnt(0)
    v_mfma_f32_16x16x32_bf16 v[96:99], v[176:179], a[16:19], v[96:99]
    ds_read_b128 v[160:163], v224 offset:8192
    v_mfma_f32_16x16x32_bf16 v[100:103], v[180:183], a[16:19], v[100:103]
    ds_read_b128 v[164:167], v224 offset:10240
    v_mfma_f32_16x16x32_bf16 v[104:107], v[176:179], a[20:23], v[104:107]
    ds_read_b128 v[168:171], v224 offset:12288
    v_mfma_f32_16x16x32_bf16 v[108:111], v[180:183], a[20:23], v[108:111]
    ds_read_b128 v[172:175], v224 offset:14336
    v_mfma_f32_16x16x32_bf16 v[112:115], v[176:179], a[24:27], v[112:115]
    v_mfma_f32_16x16x32_bf16 v[116:119], v[180:183], a[24:27], v[116:119]
    v_mfma_f32_16x16x32_bf16 v[120:123], v[176:179], a[28:31], v[120:123]
    v_mfma_f32_16x16x32_bf16 v[124:127], v[180:183], a[28:31], v[124:127]
    v_mfma_f32_16x16x32_bf16 v[128:131], v[184:187], a[16:19], v[128:131]
    v_mfma_f32_16x16x32_bf16 v[132:135], v[188:191], a[16:19], v[132:135]
    v_mfma_f32_16x16x32_bf16 v[136:139], v[184:187], a[20:23], v[136:139]
    s_mov_b32 s39, 16384
    buffer_store_dwordx4 v[20:23], v238, s[8:11], s39 offen sc1
    v_mfma_f32_16x16x32_bf16 v[140:143], v[188:191], a[20:23], v[140:143]
    v_mfma_f32_16x16x32_bf16 v[144:147], v[184:187], a[24:27], v[144:147]
    v_mfma_f32_16x16x32_bf16 v[148:151], v[188:191], a[24:27], v[148:151]
    v_mfma_f32_16x16x32_bf16 v[152:155], v[184:187], a[28:31], v[152:155]
    v_mfma_f32_16x16x32_bf16 v[156:159], v[188:191], a[28:31], v[156:159]
    s_waitcnt lgkmcnt(0)
    v_mfma_f32_16x16x32_bf16 v[96:99], v[160:163], a[32:35], v[96:99]
    ds_read_b128 v[176:179], v225 offset:8192
    v_mfma_f32_16x16x32_bf16 v[100:103], v[164:167], a[32:35], v[100:103]
    ds_read_b128 v[180:183], v225 offset:10240
    v_mfma_f32_16x16x32_bf16 v[104:107], v[160:163], a[36:39], v[104:107]
    ds_read_b128 v[184:187], v225 offset:12288
    v_mfma_f32_16x16x32_bf16 v[108:111], v[164:167], a[36:39], v[108:111]
    ds_read_b128 v[188:191], v225 offset:14336
    v_mfma_f32_16x16x32_bf16 v[112:115], v[160:163], a[40:43], v[112:115]
    v_mfma_f32_16x16x32_bf16 v[116:119], v[164:167], a[40:43], v[116:119]
    v_mfma_f32_16x16x32_bf16 v[120:123], v[160:163], a[44:47], v[120:123]
    v_mfma_f32_16x16x32_bf16 v[124:127], v[164:167], a[44:47], v[124:127]
    v_mfma_f32_16x16x32_bf16 v[128:131], v[168:171], a[32:35], v[128:131]
    v_mfma_f32_16x16x32_bf16 v[132:135], v[172:175], a[32:35], v[132:135]
    v_mfma_f32_16x16x32_bf16 v[136:139], v[168:171], a[36:39], v[136:139]
    v_mfma_f32_16x16x32_bf16 v[140:143], v[172:175], a[36:39], v[140:143]
    v_mfma_f32_16x16x32_bf16 v[144:147], v[168:171], a[40:43], v[144:147]
    v_mfma_f32_16x16x32_bf16 v[148:151], v[172:175], a[40:43], v[148:151]
    v_mfma_f32_16x16x32_bf16 v[152:155], v[168:171], a[44:47], v[152:155]
    v_mfma_f32_16x16x32_bf16 v[156:159], v[172:175], a[44:47], v[156:159]
    s_waitcnt vmcnt(6) lgkmcnt(0)
    s_barrier
    v_mfma_f32_16x16x32_bf16 v[96:99], v[176:179], a[48:51], v[96:99]
    ds_read_b128 v[160:163], v224 offset:16384
    s_mov_b32 s39, 32768
    buffer_store_dwordx4 v[24:27], v238, s[8:11], s39 offen sc1
    v_mfma_f32_16x16x32_bf16 v[100:103], v[180:183], a[48:51], v[100:103]
    ds_read_b128 v[164:167], v224 offset:18432
    v_mfma_f32_16x16x32_bf16 v[104:107], v[176:179], a[52:55], v[104:107]
    ds_read_b128 v[168:171], v224 offset:20480
    v_mfma_f32_16x16x32_bf16 v[108:111], v[180:183], a[52:55], v[108:111]
    ds_read_b128 v[172:175], v224 offset:22528
    v_mfma_f32_16x16x32_bf16 v[112:115], v[176:179], a[56:59], v[112:115]
    v_mfma_f32_16x16x32_bf16 v[116:119], v[180:183], a[56:59], v[116:119]
    s_add_u32 m0, s34, 98304
    s_add_u32 s37, s80, 131072
    buffer_load_dwordx4 v232, s[44:47], s37 offen lds
    v_mfma_f32_16x16x32_bf16 v[120:123], v[176:179], a[60:63], v[120:123]
    v_mfma_f32_16x16x32_bf16 v[124:127], v[180:183], a[60:63], v[124:127]
    buffer_load_dwordx4 v233, s[44:47], s37 offen offset:1024 lds
    v_mfma_f32_16x16x32_bf16 v[128:131], v[184:187], a[48:51], v[128:131]
    v_mfma_f32_16x16x32_bf16 v[132:135], v[188:191], a[48:51], v[132:135]
    v_mfma_f32_16x16x32_bf16 v[136:139], v[184:187], a[52:55], v[136:139]
    v_mfma_f32_16x16x32_bf16 v[140:143], v[188:191], a[52:55], v[140:143]
    v_mfma_f32_16x16x32_bf16 v[144:147], v[184:187], a[56:59], v[144:147]
    v_mfma_f32_16x16x32_bf16 v[148:151], v[188:191], a[56:59], v[148:151]
    v_mfma_f32_16x16x32_bf16 v[152:155], v[184:187], a[60:63], v[152:155]
    v_mfma_f32_16x16x32_bf16 v[156:159], v[188:191], a[60:63], v[156:159]
    s_waitcnt lgkmcnt(0)
    v_mfma_f32_16x16x32_bf16 v[96:99], v[160:163], a[64:67], v[96:99]
    ds_read_b128 v[176:179], v225 offset:16384
    v_mfma_f32_16x16x32_bf16 v[100:103], v[164:167], a[64:67], v[100:103]
    ds_read_b128 v[180:183], v225 offset:18432
    v_mfma_f32_16x16x32_bf16 v[104:107], v[160:163], a[68:71], v[104:107]
    ds_read_b128 v[184:187], v225 offset:20480
    v_mfma_f32_16x16x32_bf16 v[108:111], v[164:167], a[68:71], v[108:111]
    ds_read_b128 v[188:191], v225 offset:22528
    v_mfma_f32_16x16x32_bf16 v[112:115], v[160:163], a[72:75], v[112:115]
    v_mfma_f32_16x16x32_bf16 v[116:119], v[164:167], a[72:75], v[116:119]
    s_add_u32 m0, s34, 106496
    s_add_u32 s37, s81, 131072
    buffer_load_dwordx4 v232, s[44:47], s37 offen lds
    v_mfma_f32_16x16x32_bf16 v[120:123], v[160:163], a[76:79], v[120:123]
    s_mov_b32 s39, 49152
    buffer_store_dwordx4 v[28:31], v238, s[8:11], s39 offen sc1
    v_mfma_f32_16x16x32_bf16 v[124:127], v[164:167], a[76:79], v[124:127]
    buffer_load_dwordx4 v233, s[44:47], s37 offen offset:1024 lds
    v_mfma_f32_16x16x32_bf16 v[128:131], v[168:171], a[64:67], v[128:131]
    v_mfma_f32_16x16x32_bf16 v[132:135], v[172:175], a[64:67], v[132:135]
    v_mfma_f32_16x16x32_bf16 v[136:139], v[168:171], a[68:71], v[136:139]
    v_mfma_f32_16x16x32_bf16 v[140:143], v[172:175], a[68:71], v[140:143]
    v_mfma_f32_16x16x32_bf16 v[144:147], v[168:171], a[72:75], v[144:147]
    v_mfma_f32_16x16x32_bf16 v[148:151], v[172:175], a[72:75], v[148:151]
    v_mfma_f32_16x16x32_bf16 v[152:155], v[168:171], a[76:79], v[152:155]
    v_mfma_f32_16x16x32_bf16 v[156:159], v[172:175], a[76:79], v[156:159]
    s_waitcnt lgkmcnt(0)
    v_mfma_f32_16x16x32_bf16 v[96:99], v[176:179], a[80:83], v[96:99]
    ds_read_b128 v[160:163], v224 offset:24576
    v_mfma_f32_16x16x32_bf16 v[100:103], v[180:183], a[80:83], v[100:103]
    ds_read_b128 v[164:167], v224 offset:26624
    v_mfma_f32_16x16x32_bf16 v[104:107], v[176:179], a[84:87], v[104:107]
    ds_read_b128 v[168:171], v224 offset:28672
    v_mfma_f32_16x16x32_bf16 v[108:111], v[180:183], a[84:87], v[108:111]
    ds_read_b128 v[172:175], v224 offset:30720
    v_mfma_f32_16x16x32_bf16 v[112:115], v[176:179], a[88:91], v[112:115]
    v_mfma_f32_16x16x32_bf16 v[116:119], v[180:183], a[88:91], v[116:119]
    v_mfma_f32_16x16x32_bf16 v[120:123], v[176:179], a[92:95], v[120:123]
    v_mfma_f32_16x16x32_bf16 v[124:127], v[180:183], a[92:95], v[124:127]
    v_mfma_f32_16x16x32_bf16 v[128:131], v[184:187], a[80:83], v[128:131]
    v_mfma_f32_16x16x32_bf16 v[132:135], v[188:191], a[80:83], v[132:135]
    v_mfma_f32_16x16x32_bf16 v[136:139], v[184:187], a[84:87], v[136:139]
    v_mfma_f32_16x16x32_bf16 v[140:143], v[188:191], a[84:87], v[140:143]
    v_mfma_f32_16x16x32_bf16 v[144:147], v[184:187], a[88:91], v[144:147]
    s_add_u32 s38, s36, 0
    buffer_store_dwordx4 v[64:67], v240, s[16:19], s38 offen offset:0 sc1
    v_mfma_f32_16x16x32_bf16 v[148:151], v[188:191], a[88:91], v[148:151]
    v_mfma_f32_16x16x32_bf16 v[152:155], v[184:187], a[92:95], v[152:155]
    v_mfma_f32_16x16x32_bf16 v[156:159], v[188:191], a[92:95], v[156:159]
    s_waitcnt lgkmcnt(0)
    v_mfma_f32_16x16x32_bf16 v[96:99], v[160:163], a[96:99], v[96:99]
    ds_read_b128 v[176:179], v225 offset:24576
    v_mfma_f32_16x16x32_bf16 v[100:103], v[164:167], a[96:99], v[100:103]
    ds_read_b128 v[180:183], v225 offset:26624
    v_mfma_f32_16x16x32_bf16 v[104:107], v[160:163], a[100:103], v[104:107]
    ds_read_b128 v[184:187], v225 offset:28672
    v_mfma_f32_16x16x32_bf16 v[108:111], v[164:167], a[100:103], v[108:111]
    ds_read_b128 v[188:191], v225 offset:30720
    v_mfma_f32_16x16x32_bf16 v[112:115], v[160:163], a[104:107], v[112:115]
    v_mfma_f32_16x16x32_bf16 v[116:119], v[164:167], a[104:107], v[116:119]
    s_add_u32 m0, s34, 114688
    s_add_u32 s37, s82, 131072
    buffer_load_dwordx4 v232, s[44:47], s37 offen lds
    v_mfma_f32_16x16x32_bf16 v[120:123], v[160:163], a[108:111], v[120:123]
    v_mfma_f32_16x16x32_bf16 v[124:127], v[164:167], a[108:111], v[124:127]
    buffer_load_dwordx4 v233, s[44:47], s37 offen offset:1024 lds
    v_mfma_f32_16x16x32_bf16 v[128:131], v[168:171], a[96:99], v[128:131]
    v_mfma_f32_16x16x32_bf16 v[132:135], v[172:175], a[96:99], v[132:135]
    v_mfma_f32_16x16x32_bf16 v[136:139], v[168:171], a[100:103], v[136:139]
    v_mfma_f32_16x16x32_bf16 v[140:143], v[172:175], a[100:103], v[140:143]
    v_mfma_f32_16x16x32_bf16 v[144:147], v[168:171], a[104:107], v[144:147]
    v_mfma_f32_16x16x32_bf16 v[148:151], v[172:175], a[104:107], v[148:151]
    v_mfma_f32_16x16x32_bf16 v[152:155], v[168:171], a[108:111], v[152:155]
    v_mfma_f32_16x16x32_bf16 v[156:159], v[172:175], a[108:111], v[156:159]
    s_waitcnt lgkmcnt(0)
    v_mfma_f32_16x16x32_bf16 v[96:99], v[176:179], a[112:115], v[96:99]
    ds_read_b128 v[160:163], v224 offset:32768
    v_mfma_f32_16x16x32_bf16 v[100:103], v[180:183], a[112:115], v[100:103]
    ds_read_b128 v[164:167], v224 offset:34816
    v_mfma_f32_16x16x32_bf16 v[104:107], v[176:179], a[116:119], v[104:107]
    ds_read_b128 v[168:171], v224 offset:36864
    s_add_u32 s38, s36, 0
    buffer_store_dwordx4 v[68:71], v240, s[16:19], s38 offen offset:1024 sc1
    v_mfma_f32_16x16x32_bf16 v[108:111], v[180:183], a[116:119], v[108:111]
    ds_read_b128 v[172:175], v224 offset:38912
    v_mfma_f32_16x16x32_bf16 v[112:115], v[176:179], a[120:123], v[112:115]
    v_mfma_f32_16x16x32_bf16 v[116:119], v[180:183], a[120:123], v[116:119]
    s_add_u32 m0, s34, 122880
    s_add_u32 s37, s83, 131072
    buffer_load_dwordx4 v232, s[44:47], s37 offen lds
    v_mfma_f32_16x16x32_bf16 v[120:123], v[176:179], a[124:127], v[120:123]
    v_mfma_f32_16x16x32_bf16 v[124:127], v[180:183], a[124:127], v[124:127]
    buffer_load_dwordx4 v233, s[44:47], s37 offen offset:1024 lds
    v_mfma_f32_16x16x32_bf16 v[128:131], v[184:187], a[112:115], v[128:131]
    v_mfma_f32_16x16x32_bf16 v[132:135], v[188:191], a[112:115], v[132:135]
    v_mfma_f32_16x16x32_bf16 v[136:139], v[184:187], a[116:119], v[136:139]
    v_mfma_f32_16x16x32_bf16 v[140:143], v[188:191], a[116:119], v[140:143]
    v_mfma_f32_16x16x32_bf16 v[144:147], v[184:187], a[120:123], v[144:147]
    v_mfma_f32_16x16x32_bf16 v[148:151], v[188:191], a[120:123], v[148:151]
    v_mfma_f32_16x16x32_bf16 v[152:155], v[184:187], a[124:127], v[152:155]
    v_mfma_f32_16x16x32_bf16 v[156:159], v[188:191], a[124:127], v[156:159]
    s_waitcnt lgkmcnt(0)
    v_mfma_f32_16x16x32_bf16 v[96:99], v[160:163], a[128:131], v[96:99]
    ds_read_b128 v[176:179], v225 offset:32768
    v_mfma_f32_16x16x32_bf16 v[100:103], v[164:167], a[128:131], v[100:103]
    ds_read_b128 v[180:183], v225 offset:34816
    v_mfma_f32_16x16x32_bf16 v[104:107], v[160:163], a[132:135], v[104:107]
    ds_read_b128 v[184:187], v225 offset:36864
    v_mfma_f32_16x16x32_bf16 v[108:111], v[164:167], a[132:135], v[108:111]
    ds_read_b128 v[188:191], v225 offset:38912
    v_mfma_f32_16x16x32_bf16 v[112:115], v[160:163], a[136:139], v[112:115]
    v_mfma_f32_16x16x32_bf16 v[116:119], v[164:167], a[136:139], v[116:119]
    v_mfma_f32_16x16x32_bf16 v[120:123], v[160:163], a[140:143], v[120:123]
    v_mfma_f32_16x16x32_bf16 v[124:127], v[164:167], a[140:143], v[124:127]
    v_mfma_f32_16x16x32_bf16 v[128:131], v[168:171], a[128:131], v[128:131]
    s_add_u32 s38, s36, 0
    buffer_store_dwordx4 v[72:75], v240, s[16:19], s38 offen offset:2048 sc1
    v_mfma_f32_16x16x32_bf16 v[132:135], v[172:175], a[128:131], v[132:135]
    v_mfma_f32_16x16x32_bf16 v[136:139], v[168:171], a[132:135], v[136:139]
    v_mfma_f32_16x16x32_bf16 v[140:143], v[172:175], a[132:135], v[140:143]
    v_mfma_f32_16x16x32_bf16 v[144:147], v[168:171], a[136:139], v[144:147]
    v_mfma_f32_16x16x32_bf16 v[148:151], v[172:175], a[136:139], v[148:151]
    v_mfma_f32_16x16x32_bf16 v[152:155], v[168:171], a[140:143], v[152:155]
    v_mfma_f32_16x16x32_bf16 v[156:159], v[172:175], a[140:143], v[156:159]
    s_waitcnt lgkmcnt(0)
    v_mfma_f32_16x16x32_bf16 v[96:99], v[176:179], a[144:147], v[96:99]
    ds_read_b128 v[160:163], v224 offset:40960
    v_mfma_f32_16x16x32_bf16 v[100:103], v[180:183], a[144:147], v[100:103]
    ds_read_b128 v[164:167], v224 offset:43008
    v_mfma_f32_16x16x32_bf16 v[104:107], v[176:179], a[148:151], v[104:107]
    ds_read_b128 v[168:171], v224 offset:45056
    v_mfma_f32_16x16x32_bf16 v[108:111], v[180:183], a[148:151], v[108:111]
    ds_read_b128 v[172:175], v224 offset:47104
    v_mfma_f32_16x16x32_bf16 v[112:115], v[176:179], a[152:155], v[112:115]
    v_mfma_f32_16x16x32_bf16 v[116:119], v[180:183], a[152:155], v[116:119]
    s_add_u32 m0, s34, 131072
    s_add_u32 s37, s84, 131072
    buffer_load_dwordx4 v232, s[44:47], s37 offen lds
    v_mfma_f32_16x16x32_bf16 v[120:123], v[176:179], a[156:159], v[120:123]
    v_mfma_f32_16x16x32_bf16 v[124:127], v[180:183], a[156:159], v[124:127]
    buffer_load_dwordx4 v233, s[44:47], s37 offen offset:1024 lds
    v_mfma_f32_16x16x32_bf16 v[128:131], v[184:187], a[144:147], v[128:131]
    v_mfma_f32_16x16x32_bf16 v[132:135], v[188:191], a[144:147], v[132:135]
    v_mfma_f32_16x16x32_bf16 v[136:139], v[184:187], a[148:151], v[136:139]
    v_mfma_f32_16x16x32_bf16 v[140:143], v[188:191], a[148:151], v[140:143]
    v_mfma_f32_16x16x32_bf16 v[144:147], v[184:187], a[152:155], v[144:147]
    v_mfma_f32_16x16x32_bf16 v[148:151], v[188:191], a[152:155], v[148:151]
    v_mfma_f32_16x16x32_bf16 v[152:155], v[184:187], a[156:159], v[152:155]
    s_add_u32 s38, s36, 0
    buffer_store_dwordx4 v[76:79], v240, s[16:19], s38 offen offset:3072 sc1
    v_mfma_f32_16x16x32_bf16 v[156:159], v[188:191], a[156:159], v[156:159]
    s_waitcnt lgkmcnt(0)
    v_mfma_f32_16x16x32_bf16 v[96:99], v[160:163], a[160:163], v[96:99]
    ds_read_b128 v[176:179], v225 offset:40960
    v_mfma_f32_16x16x32_bf16 v[100:103], v[164:167], a[160:163], v[100:103]
    ds_read_b128 v[180:183], v225 offset:43008
    v_mfma_f32_16x16x32_bf16 v[104:107], v[160:163], a[164:167], v[104:107]
    ds_read_b128 v[184:187], v225 offset:45056
    v_mfma_f32_16x16x32_bf16 v[108:111], v[164:167], a[164:167], v[108:111]
    ds_read_b128 v[188:191], v225 offset:47104
    v_mfma_f32_16x16x32_bf16 v[112:115], v[160:163], a[168:171], v[112:115]
    v_mfma_f32_16x16x32_bf16 v[116:119], v[164:167], a[168:171], v[116:119]
    s_add_u32 m0, s34, 139264
    s_add_u32 s37, s85, 131072
    buffer_load_dwordx4 v232, s[44:47], s37 offen lds
    v_mfma_f32_16x16x32_bf16 v[120:123], v[160:163], a[172:175], v[120:123]
    v_mfma_f32_16x16x32_bf16 v[124:127], v[164:167], a[172:175], v[124:127]
    buffer_load_dwordx4 v233, s[44:47], s37 offen offset:1024 lds
    v_mfma_f32_16x16x32_bf16 v[128:131], v[168:171], a[160:163], v[128:131]
    v_mfma_f32_16x16x32_bf16 v[132:135], v[172:175], a[160:163], v[132:135]
    v_mfma_f32_16x16x32_bf16 v[136:139], v[168:171], a[164:167], v[136:139]
    v_mfma_f32_16x16x32_bf16 v[140:143], v[172:175], a[164:167], v[140:143]
    v_mfma_f32_16x16x32_bf16 v[144:147], v[168:171], a[168:171], v[144:147]
    v_mfma_f32_16x16x32_bf16 v[148:151], v[172:175], a[168:171], v[148:151]
    v_mfma_f32_16x16x32_bf16 v[152:155], v[168:171], a[172:175], v[152:155]
    v_mfma_f32_16x16x32_bf16 v[156:159], v[172:175], a[172:175], v[156:159]
    s_waitcnt vmcnt(13) lgkmcnt(0)
    s_barrier
    v_mfma_f32_16x16x32_bf16 v[96:99], v[176:179], a[176:179], v[96:99]
    ds_read_b128 v[160:163], v224 offset:49152
    v_mfma_f32_16x16x32_bf16 v[100:103], v[180:183], a[176:179], v[100:103]
    ds_read_b128 v[164:167], v224 offset:51200
    v_mfma_f32_16x16x32_bf16 v[104:107], v[176:179], a[180:183], v[104:107]
    ds_read_b128 v[168:171], v224 offset:53248
    v_mfma_f32_16x16x32_bf16 v[108:111], v[180:183], a[180:183], v[108:111]
    ds_read_b128 v[172:175], v224 offset:55296
    v_mfma_f32_16x16x32_bf16 v[112:115], v[176:179], a[184:187], v[112:115]
    s_add_u32 s38, s36, 8192
    buffer_store_dwordx4 v[80:83], v240, s[16:19], s38 offen offset:0 sc1
    v_mfma_f32_16x16x32_bf16 v[116:119], v[180:183], a[184:187], v[116:119]
    s_lshl_b32 s39, s5, 2
    buffer_atomic_add v255, v250, s[88:91], s39 offen sc1
    s_cmp_eq_u32 s3, 0
    s_cselect_b32 s39, s39, s43
    v_mfma_f32_16x16x32_bf16 v[120:123], v[176:179], a[188:191], v[120:123]
    v_mfma_f32_16x16x32_bf16 v[124:127], v[180:183], a[188:191], v[124:127]
    v_mfma_f32_16x16x32_bf16 v[128:131], v[184:187], a[176:179], v[128:131]
    v_mfma_f32_16x16x32_bf16 v[132:135], v[188:191], a[176:179], v[132:135]
    v_mfma_f32_16x16x32_bf16 v[136:139], v[184:187], a[180:183], v[136:139]
    v_mfma_f32_16x16x32_bf16 v[140:143], v[188:191], a[180:183], v[140:143]
    v_mfma_f32_16x16x32_bf16 v[144:147], v[184:187], a[184:187], v[144:147]
    v_mfma_f32_16x16x32_bf16 v[148:151], v[188:191], a[184:187], v[148:151]
    v_mfma_f32_16x16x32_bf16 v[152:155], v[184:187], a[188:191], v[152:155]
    v_mfma_f32_16x16x32_bf16 v[156:159], v[188:191], a[188:191], v[156:159]
    s_waitcnt lgkmcnt(0)
    v_mfma_f32_16x16x32_bf16 v[96:99], v[160:163], a[192:195], v[96:99]
    ds_read_b128 v[176:179], v225 offset:49152
    v_mfma_f32_16x16x32_bf16 v[100:103], v[164:167], a[192:195], v[100:103]
    ds_read_b128 v[180:183], v225 offset:51200
    v_mfma_f32_16x16x32_bf16 v[104:107], v[160:163], a[196:199], v[104:107]
    ds_read_b128 v[184:187], v225 offset:53248
    v_mfma_f32_16x16x32_bf16 v[108:111], v[164:167], a[196:199], v[108:111]
    ds_read_b128 v[188:191], v225 offset:55296
    v_mfma_f32_16x16x32_bf16 v[112:115], v[160:163], a[200:203], v[112:115]
    v_mfma_f32_16x16x32_bf16 v[116:119], v[164:167], a[200:203], v[116:119]
    s_add_u32 m0, s34, 147456
    s_add_u32 s37, s86, 131072
    buffer_load_dwordx4 v232, s[44:47], s37 offen lds
    v_mfma_f32_16x16x32_bf16 v[120:123], v[160:163], a[204:207], v[120:123]
    v_mfma_f32_16x16x32_bf16 v[124:127], v[164:167], a[204:207], v[124:127]
    buffer_load_dwordx4 v233, s[44:47], s37 offen offset:1024 lds
    v_mfma_f32_16x16x32_bf16 v[128:131], v[168:171], a[192:195], v[128:131]
    v_mfma_f32_16x16x32_bf16 v[132:135], v[172:175], a[192:195], v[132:135]
    v_mfma_f32_16x16x32_bf16 v[136:139], v[168:171], a[196:199], v[136:139]
    s_add_u32 s38, s36, 8192
    buffer_store_dwordx4 v[84:87], v240, s[16:19], s38 offen offset:1024 sc1
    v_mfma_f32_16x16x32_bf16 v[140:143], v[172:175], a[196:199], v[140:143]
    v_mfma_f32_16x16x32_bf16 v[144:147], v[168:171], a[200:203], v[144:147]
    v_mfma_f32_16x16x32_bf16 v[148:151], v[172:175], a[200:203], v[148:151]
    v_mfma_f32_16x16x32_bf16 v[152:155], v[168:171], a[204:207], v[152:155]
    v_mfma_f32_16x16x32_bf16 v[156:159], v[172:175], a[204:207], v[156:159]
    s_waitcnt lgkmcnt(0)
    v_mfma_f32_16x16x32_bf16 v[96:99], v[176:179], a[208:211], v[96:99]
    ds_read_b128 v[160:163], v224 offset:57344
    v_mfma_f32_16x16x32_bf16 v[100:103], v[180:183], a[208:211], v[100:103]
    ds_read_b128 v[164:167], v224 offset:59392
    v_mfma_f32_16x16x32_bf16 v[104:107], v[176:179], a[212:215], v[104:107]
    ds_read_b128 v[168:171], v224 offset:61440
    v_mfma_f32_16x16x32_bf16 v[108:111], v[180:183], a[212:215], v[108:111]
    ds_read_b128 v[172:175], v224 offset:63488
    v_mfma_f32_16x16x32_bf16 v[112:115], v[176:179], a[216:219], v[112:115]
    v_mfma_f32_16x16x32_bf16 v[116:119], v[180:183], a[216:219], v[116:119]
    s_add_u32 m0, s34, 155648
    s_add_u32 s37, s87, 131072
    buffer_load_dwordx4 v232, s[44:47], s37 offen lds
    v_mfma_f32_16x16x32_bf16 v[120:123], v[176:179], a[220:223], v[120:123]
    v_mfma_f32_16x16x32_bf16 v[124:127], v[180:183], a[220:223], v[124:127]
    buffer_load_dwordx4 v233, s[44:47], s37 offen offset:1024 lds
    v_mfma_f32_16x16x32_bf16 v[128:131], v[184:187], a[208:211], v[128:131]
    v_mfma_f32_16x16x32_bf16 v[132:135], v[188:191], a[208:211], v[132:135]
    v_mfma_f32_16x16x32_bf16 v[136:139], v[184:187], a[212:215], v[136:139]
    v_mfma_f32_16x16x32_bf16 v[140:143], v[188:191], a[212:215], v[140:143]
    v_mfma_f32_16x16x32_bf16 v[144:147], v[184:187], a[216:219], v[144:147]
    v_mfma_f32_16x16x32_bf16 v[148:151], v[188:191], a[216:219], v[148:151]
    v_mfma_f32_16x16x32_bf16 v[152:155], v[184:187], a[220:223], v[152:155]
    v_mfma_f32_16x16x32_bf16 v[156:159], v[188:191], a[220:223], v[156:159]
    s_waitcnt lgkmcnt(0)
    v_mfma_f32_16x16x32_bf16 v[96:99], v[160:163], a[224:227], v[96:99]
    ds_read_b128 v[176:179], v225 offset:57344
    s_add_u32 s38, s36, 8192
    buffer_store_dwordx4 v[88:91], v240, s[16:19], s38 offen offset:2048 sc1
    v_mfma_f32_16x16x32_bf16 v[100:103], v[164:167], a[224:227], v[100:103]
    ds_read_b128 v[180:183], v225 offset:59392
    v_mfma_f32_16x16x32_bf16 v[104:107], v[160:163], a[228:231], v[104:107]
    ds_read_b128 v[184:187], v225 offset:61440
    v_mfma_f32_16x16x32_bf16 v[108:111], v[164:167], a[228:231], v[108:111]
    ds_read_b128 v[188:191], v225 offset:63488
    v_mfma_f32_16x16x32_bf16 v[112:115], v[160:163], a[232:235], v[112:115]
    v_mfma_f32_16x16x32_bf16 v[116:119], v[164:167], a[232:235], v[116:119]
    v_mfma_f32_16x16x32_bf16 v[120:123], v[160:163], a[236:239], v[120:123]
    v_mfma_f32_16x16x32_bf16 v[124:127], v[164:167], a[236:239], v[124:127]
    v_mfma_f32_16x16x32_bf16 v[128:131], v[168:171], a[224:227], v[128:131]
    v_mfma_f32_16x16x32_bf16 v[132:135], v[172:175], a[224:227], v[132:135]
    v_mfma_f32_16x16x32_bf16 v[136:139], v[168:171], a[228:231], v[136:139]
    v_mfma_f32_16x16x32_bf16 v[140:143], v[172:175], a[228:231], v[140:143]
    v_mfma_f32_16x16x32_bf16 v[144:147], v[168:171], a[232:235], v[144:147]
    v_mfma_f32_16x16x32_bf16 v[148:151], v[172:175], a[232:235], v[148:151]
    v_mfma_f32_16x16x32_bf16 v[152:155], v[168:171], a[236:239], v[152:155]
    v_mfma_f32_16x16x32_bf16 v[156:159], v[172:175], a[236:239], v[156:159]
    s_waitcnt vmcnt(14) lgkmcnt(0)
    s_barrier
    v_mfma_f32_16x16x32_bf16 v[96:99], v[176:179], a[240:243], v[96:99]
    ds_read_b128 v[160:163], v226 offset:0
    v_mfma_f32_16x16x32_bf16 v[100:103], v[180:183], a[240:243], v[100:103]
    ds_read_b128 v[164:167], v226 offset:2048
    v_mfma_f32_16x16x32_bf16 v[104:107], v[176:179], a[244:247], v[104:107]
    ds_read_b128 v[168:171], v226 offset:4096
    v_mfma_f32_16x16x32_bf16 v[108:111], v[180:183], a[244:247], v[108:111]
    ds_read_b128 v[172:175], v226 offset:6144
    v_mfma_f32_16x16x32_bf16 v[112:115], v[176:179], a[248:251], v[112:115]
    v_mfma_f32_16x16x32_bf16 v[116:119], v[180:183], a[248:251], v[116:119]
    v_mfma_f32_16x16x32_bf16 v[120:123], v[176:179], a[252:255], v[120:123]
    s_add_u32 s38, s36, 8192
    buffer_store_dwordx4 v[92:95], v240, s[16:19], s38 offen offset:3072 sc1
    v_mfma_f32_16x16x32_bf16 v[124:127], v[180:183], a[252:255], v[124:127]
    v_mfma_f32_16x16x32_bf16 v[128:131], v[184:187], a[240:243], v[128:131]
    v_mfma_f32_16x16x32_bf16 v[132:135], v[188:191], a[240:243], v[132:135]
    v_cvt_pk_bf16_f32 v64, v96, v97
    v_cvt_pk_bf16_f32 v65, v98, v99
    v_mfma_f32_16x16x32_bf16 v[136:139], v[184:187], a[244:247], v[136:139]
    v_cvt_pk_bf16_f32 v66, v100, v101
    v_cvt_pk_bf16_f32 v67, v102, v103
    v_mfma_f32_16x16x32_bf16 v[140:143], v[188:191], a[244:247], v[140:143]
    v_cvt_pk_bf16_f32 v68, v104, v105
    v_cvt_pk_bf16_f32 v69, v106, v107
    v_mfma_f32_16x16x32_bf16 v[144:147], v[184:187], a[248:251], v[144:147]
    v_cvt_pk_bf16_f32 v70, v108, v109
    v_cvt_pk_bf16_f32 v71, v110, v111
    v_mfma_f32_16x16x32_bf16 v[148:151], v[188:191], a[248:251], v[148:151]
    v_cvt_pk_bf16_f32 v72, v112, v113
    v_cvt_pk_bf16_f32 v73, v114, v115
    v_mfma_f32_16x16x32_bf16 v[152:155], v[184:187], a[252:255], v[152:155]
    v_cvt_pk_bf16_f32 v74, v116, v117
    v_cvt_pk_bf16_f32 v75, v118, v119
    v_mfma_f32_16x16x32_bf16 v[156:159], v[188:191], a[252:255], v[156:159]
    v_cvt_pk_bf16_f32 v76, v120, v121
    v_cvt_pk_bf16_f32 v77, v122, v123
    s_waitcnt lgkmcnt(0)
    v_mfma_f32_16x16x32_bf16 v[96:99], v[160:163], a[0:3], 0
    ds_read_b128 v[176:179], v227 offset:0
    v_cvt_pk_bf16_f32 v78, v124, v125
    v_cvt_pk_bf16_f32 v79, v126, v127
    v_mfma_f32_16x16x32_bf16 v[100:103], v[164:167], a[0:3], 0
    ds_read_b128 v[180:183], v227 offset:2048
    v_cvt_pk_bf16_f32 v80, v128, v129
    v_cvt_pk_bf16_f32 v81, v130, v131
    v_mfma_f32_16x16x32_bf16 v[104:107], v[160:163], a[4:7], 0
    ds_read_b128 v[184:187], v227 offset:4096
    v_cvt_pk_bf16_f32 v82, v132, v133
    v_cvt_pk_bf16_f32 v83, v134, v135
    v_mfma_f32_16x16x32_bf16 v[108:111], v[164:167], a[4:7], 0
    ds_read_b128 v[188:191], v227 offset:6144
    v_cvt_pk_bf16_f32 v84, v136, v137
    v_cvt_pk_bf16_f32 v85, v138, v139
    v_mfma_f32_16x16x32_bf16 v[112:115], v[160:163], a[8:11], 0
    v_cvt_pk_bf16_f32 v86, v140, v141
    v_cvt_pk_bf16_f32 v87, v142, v143
    v_mfma_f32_16x16x32_bf16 v[116:119], v[164:167], a[8:11], 0
    s_add_u32 m0, s34, 0
    s_add_u32 s37, s80, 196608
    buffer_load_dwordx4 v232, s[44:47], s37 offen lds
    v_cvt_pk_bf16_f32 v88, v144, v145
    v_cvt_pk_bf16_f32 v89, v146, v147
    v_mfma_f32_16x16x32_bf16 v[120:123], v[160:163], a[12:15], 0
    v_cvt_pk_bf16_f32 v90, v148, v149
    v_cvt_pk_bf16_f32 v91, v150, v151
    v_mfma_f32_16x16x32_bf16 v[124:127], v[164:167], a[12:15], 0
    buffer_load_dwordx4 v233, s[44:47], s37 offen offset:1024 lds
    v_cvt_pk_bf16_f32 v92, v152, v153
    v_cvt_pk_bf16_f32 v93, v154, v155
    v_mfma_f32_16x16x32_bf16 v[128:131], v[168:171], a[0:3], 0
    v_cvt_pk_bf16_f32 v94, v156, v157
    v_cvt_pk_bf16_f32 v95, v158, v159
    v_mfma_f32_16x16x32_bf16 v[132:135], v[172:175], a[0:3], 0
    v_mfma_f32_16x16x32_bf16 v[136:139], v[168:171], a[4:7], 0
    s_add_u32 s38, s36, 32768
    buffer_store_dwordx4 v[64:67], v240, s[16:19], s38 offen offset:0 sc1
    v_mfma_f32_16x16x32_bf16 v[140:143], v[172:175], a[4:7], 0
    v_mfma_f32_16x16x32_bf16 v[144:147], v[168:171], a[8:11], 0
    v_mfma_f32_16x16x32_bf16 v[148:151], v[172:175], a[8:11], 0
    v_mfma_f32_16x16x32_bf16 v[152:155], v[168:171], a[12:15], 0
    v_mfma_f32_16x16x32_bf16 v[156:159], v[172:175], a[12:15], 0
    s_waitcnt lgkmcnt(0)
    v_mfma_f32_16x16x32_bf16 v[96:99], v[176:179], a[16:19], v[96:99]
    ds_read_b128 v[160:163], v226 offset:8192
    v_mfma_f32_16x16x32_bf16 v[100:103], v[180:183], a[16:19], v[100:103]
    ds_read_b128 v[164:167], v226 offset:10240
    v_mfma_f32_16x16x32_bf16 v[104:107], v[176:179], a[20:23], v[104:107]
    ds_read_b128 v[168:171], v226 offset:12288
    v_mfma_f32_16x16x32_bf16 v[108:111], v[180:183], a[20:23], v[108:111]
    ds_read_b128 v[172:175], v226 offset:14336
    v_mfma_f32_16x16x32_bf16 v[112:115], v[176:179], a[24:27], v[112:115]
    v_mfma_f32_16x16x32_bf16 v[116:119], v[180:183], a[24:27], v[116:119]
    s_add_u32 m0, s31, 0
    s_add_u32 s24, s27, 0
    buffer_load_dwordx4 v245, s[12:15], s24 offen lds
    v_mfma_f32_16x16x32_bf16 v[120:123], v[176:179], a[28:31], v[120:123]
    v_mfma_f32_16x16x32_bf16 v[124:127], v[180:183], a[28:31], v[124:127]
    v_mfma_f32_16x16x32_bf16 v[128:131], v[184:187], a[16:19], v[128:131]
    v_mfma_f32_16x16x32_bf16 v[132:135], v[188:191], a[16:19], v[132:135]
    v_mfma_f32_16x16x32_bf16 v[136:139], v[184:187], a[20:23], v[136:139]
    v_mfma_f32_16x16x32_bf16 v[140:143], v[188:191], a[20:23], v[140:143]
    v_mfma_f32_16x16x32_bf16 v[144:147], v[184:187], a[24:27], v[144:147]
    v_mfma_f32_16x16x32_bf16 v[148:151], v[188:191], a[24:27], v[148:151]
    v_mfma_f32_16x16x32_bf16 v[152:155], v[184:187], a[28:31], v[152:155]
    v_mfma_f32_16x16x32_bf16 v[156:159], v[188:191], a[28:31], v[156:159]
    s_waitcnt lgkmcnt(0)
    v_mfma_f32_16x16x32_bf16 v[96:99], v[160:163], a[32:35], v[96:99]
    ds_read_b128 v[176:179], v227 offset:8192
    v_mfma_f32_16x16x32_bf16 v[100:103], v[164:167], a[32:35], v[100:103]
    ds_read_b128 v[180:183], v227 offset:10240
    v_mfma_f32_16x16x32_bf16 v[104:107], v[160:163], a[36:39], v[104:107]
    ds_read_b128 v[184:187], v227 offset:12288
    v_mfma_f32_16x16x32_bf16 v[108:111], v[164:167], a[36:39], v[108:111]
    ds_read_b128 v[188:191], v227 offset:14336
    v_mfma_f32_16x16x32_bf16 v[112:115], v[160:163], a[40:43], v[112:115]
    v_mfma_f32_16x16x32_bf16 v[116:119], v[164:167], a[40:43], v[116:119]
    s_add_u32 m0, s34, 8192
    s_add_u32 s37, s81, 196608
    buffer_load_dwordx4 v232, s[44:47], s37 offen lds
    v_mfma_f32_16x16x32_bf16 v[120:123], v[160:163], a[44:47], v[120:123]
    v_mfma_f32_16x16x32_bf16 v[124:127], v[164:167], a[44:47], v[124:127]
    buffer_load_dwordx4 v233, s[44:47], s37 offen offset:1024 lds
    v_mfma_f32_16x16x32_bf16 v[128:131], v[168:171], a[32:35], v[128:131]
    v_mfma_f32_16x16x32_bf16 v[132:135], v[172:175], a[32:35], v[132:135]
    v_mfma_f32_16x16x32_bf16 v[136:139], v[168:171], a[36:39], v[136:139]
    s_add_u32 s38, s36, 32768
    buffer_store_dwordx4 v[68:71], v240, s[16:19], s38 offen offset:1024 sc1
    v_mfma_f32_16x16x32_bf16 v[140:143], v[172:175], a[36:39], v[140:143]
    v_mfma_f32_16x16x32_bf16 v[144:147], v[168:171], a[40:43], v[144:147]
    v_mfma_f32_16x16x32_bf16 v[148:151], v[172:175], a[40:43], v[148:151]
    v_mfma_f32_16x16x32_bf16 v[152:155], v[168:171], a[44:47], v[152:155]
    v_mfma_f32_16x16x32_bf16 v[156:159], v[172:175], a[44:47], v[156:159]
    s_waitcnt lgkmcnt(0)
    v_mfma_f32_16x16x32_bf16 v[96:99], v[176:179], a[48:51], v[96:99]
    ds_read_b128 v[160:163], v226 offset:16384
    v_mfma_f32_16x16x32_bf16 v[100:103], v[180:183], a[48:51], v[100:103]
    ds_read_b128 v[164:167], v226 offset:18432
    v_mfma_f32_16x16x32_bf16 v[104:107], v[176:179], a[52:55], v[104:107]
    ds_read_b128 v[168:171], v226 offset:20480
    v_mfma_f32_16x16x32_bf16 v[108:111], v[180:183], a[52:55], v[108:111]
    ds_read_b128 v[172:175], v226 offset:22528
    v_mfma_f32_16x16x32_bf16 v[112:115], v[176:179], a[56:59], v[112:115]
    v_mfma_f32_16x16x32_bf16 v[116:119], v[180:183], a[56:59], v[116:119]
    s_add_u32 m0, s31, 1024
    s_add_u32 s24, s27, 32768
    buffer_load_dwordx4 v245, s[12:15], s24 offen lds
    v_mfma_f32_16x16x32_bf16 v[120:123], v[176:179], a[60:63], v[120:123]
    v_mfma_f32_16x16x32_bf16 v[124:127], v[180:183], a[60:63], v[124:127]
    v_mfma_f32_16x16x32_bf16 v[128:131], v[184:187], a[48:51], v[128:131]
    v_mfma_f32_16x16x32_bf16 v[132:135], v[188:191], a[48:51], v[132:135]
    v_mfma_f32_16x16x32_bf16 v[136:139], v[184:187], a[52:55], v[136:139]
    v_mfma_f32_16x16x32_bf16 v[140:143], v[188:191], a[52:55], v[140:143]
    v_mfma_f32_16x16x32_bf16 v[144:147], v[184:187], a[56:59], v[144:147]
    v_mfma_f32_16x16x32_bf16 v[148:151], v[188:191], a[56:59], v[148:151]
    v_mfma_f32_16x16x32_bf16 v[152:155], v[184:187], a[60:63], v[152:155]
    v_mfma_f32_16x16x32_bf16 v[156:159], v[188:191], a[60:63], v[156:159]
    s_waitcnt lgkmcnt(0)
    v_mfma_f32_16x16x32_bf16 v[96:99], v[160:163], a[64:67], v[96:99]
    ds_read_b128 v[176:179], v227 offset:16384
    v_mfma_f32_16x16x32_bf16 v[100:103], v[164:167], a[64:67], v[100:103]
    ds_read_b128 v[180:183], v227 offset:18432
    v_mfma_f32_16x16x32_bf16 v[104:107], v[160:163], a[68:71], v[104:107]
    ds_read_b128 v[184:187], v227 offset:20480
    v_mfma_f32_16x16x32_bf16 v[108:111], v[164:167], a[68:71], v[108:111]
    ds_read_b128 v[188:191], v227 offset:22528
    v_mfma_f32_16x16x32_bf16 v[112:115], v[160:163], a[72:75], v[112:115]
    v_mfma_f32_16x16x32_bf16 v[116:119], v[164:167], a[72:75], v[116:119]
    s_add_u32 m0, s34, 16384
    s_add_u32 s37, s82, 196608
    buffer_load_dwordx4 v232, s[44:47], s37 offen lds
    v_mfma_f32_16x16x32_bf16 v[120:123], v[160:163], a[76:79], v[120:123]
    v_mfma_f32_16x16x32_bf16 v[124:127], v[164:167], a[76:79], v[124:127]
    buffer_load_dwordx4 v233, s[44:47], s37 offen offset:1024 lds
    v_mfma_f32_16x16x32_bf16 v[128:131], v[168:171], a[64:67], v[128:131]
    v_mfma_f32_16x16x32_bf16 v[132:135], v[172:175], a[64:67], v[132:135]
    v_mfma_f32_16x16x32_bf16 v[136:139], v[168:171], a[68:71], v[136:139]
    v_mfma_f32_16x16x32_bf16 v[140:143], v[172:175], a[68:71], v[140:143]
    s_add_u32 s38, s36, 32768
    buffer_store_dwordx4 v[72:75], v240, s[16:19], s38 offen offset:2048 sc1
    v_mfma_f32_16x16x32_bf16 v[144:147], v[168:171], a[72:75], v[144:147]
    v_mfma_f32_16x16x32_bf16 v[148:151], v[172:175], a[72:75], v[148:151]
    v_mfma_f32_16x16x32_bf16 v[152:155], v[168:171], a[76:79], v[152:155]
    v_mfma_f32_16x16x32_bf16 v[156:159], v[172:175], a[76:79], v[156:159]
    s_waitcnt lgkmcnt(0)
    v_mfma_f32_16x16x32_bf16 v[96:99], v[176:179], a[80:83], v[96:99]
    ds_read_b128 v[160:163], v226 offset:24576
    v_mfma_f32_16x16x32_bf16 v[100:103], v[180:183], a[80:83], v[100:103]
    ds_read_b128 v[164:167], v226 offset:26624
    v_mfma_f32_16x16x32_bf16 v[104:107], v[176:179], a[84:87], v[104:107]
    ds_read_b128 v[168:171], v226 offset:28672
    v_mfma_f32_16x16x32_bf16 v[108:111], v[180:183], a[84:87], v[108:111]
    ds_read_b128 v[172:175], v226 offset:30720
    v_mfma_f32_16x16x32_bf16 v[112:115], v[176:179], a[88:91], v[112:115]
    v_mfma_f32_16x16x32_bf16 v[116:119], v[180:183], a[88:91], v[116:119]
    s_add_u32 m0, s31, 2048
    s_add_u32 s24, s27, 65536
    buffer_load_dwordx4 v245, s[12:15], s24 offen lds
    v_mfma_f32_16x16x32_bf16 v[120:123], v[176:179], a[92:95], v[120:123]
    v_mfma_f32_16x16x32_bf16 v[124:127], v[180:183], a[92:95], v[124:127]
    v_mfma_f32_16x16x32_bf16 v[128:131], v[184:187], a[80:83], v[128:131]
    v_mfma_f32_16x16x32_bf16 v[132:135], v[188:191], a[80:83], v[132:135]
    v_mfma_f32_16x16x32_bf16 v[136:139], v[184:187], a[84:87], v[136:139]
    v_mfma_f32_16x16x32_bf16 v[140:143], v[188:191], a[84:87], v[140:143]
    v_mfma_f32_16x16x32_bf16 v[144:147], v[184:187], a[88:91], v[144:147]
    v_mfma_f32_16x16x32_bf16 v[148:151], v[188:191], a[88:91], v[148:151]
    v_mfma_f32_16x16x32_bf16 v[152:155], v[184:187], a[92:95], v[152:155]
    v_mfma_f32_16x16x32_bf16 v[156:159], v[188:191], a[92:95], v[156:159]
    s_waitcnt lgkmcnt(0)
    v_mfma_f32_16x16x32_bf16 v[96:99], v[160:163], a[96:99], v[96:99]
    ds_read_b128 v[176:179], v227 offset:24576
    v_mfma_f32_16x16x32_bf16 v[100:103], v[164:167], a[96:99], v[100:103]
    ds_read_b128 v[180:183], v227 offset:26624
    v_mfma_f32_16x16x32_bf16 v[104:107], v[160:163], a[100:103], v[104:107]
    ds_read_b128 v[184:187], v227 offset:28672
    v_mfma_f32_16x16x32_bf16 v[108:111], v[164:167], a[100:103], v[108:111]
    ds_read_b128 v[188:191], v227 offset:30720
    v_mfma_f32_16x16x32_bf16 v[112:115], v[160:163], a[104:107], v[112:115]
    v_mfma_f32_16x16x32_bf16 v[116:119], v[164:167], a[104:107], v[116:119]
    s_add_u32 m0, s34, 24576
    s_add_u32 s37, s83, 196608
    buffer_load_dwordx4 v232, s[44:47], s37 offen lds
    v_mfma_f32_16x16x32_bf16 v[120:123], v[160:163], a[108:111], v[120:123]
    v_mfma_f32_16x16x32_bf16 v[124:127], v[164:167], a[108:111], v[124:127]
    buffer_load_dwordx4 v233, s[44:47], s37 offen offset:1024 lds
    v_mfma_f32_16x16x32_bf16 v[128:131], v[168:171], a[96:99], v[128:131]
    v_mfma_f32_16x16x32_bf16 v[132:135], v[172:175], a[96:99], v[132:135]
    v_mfma_f32_16x16x32_bf16 v[136:139], v[168:171], a[100:103], v[136:139]
    v_mfma_f32_16x16x32_bf16 v[140:143], v[172:175], a[100:103], v[140:143]
    v_mfma_f32_16x16x32_bf16 v[144:147], v[168:171], a[104:107], v[144:147]
    s_add_u32 s38, s36, 32768
    buffer_store_dwordx4 v[76:79], v240, s[16:19], s38 offen offset:3072 sc1
    v_mfma_f32_16x16x32_bf16 v[148:151], v[172:175], a[104:107], v[148:151]
    v_mfma_f32_16x16x32_bf16 v[152:155], v[168:171], a[108:111], v[152:155]
    v_mfma_f32_16x16x32_bf16 v[156:159], v[172:175], a[108:111], v[156:159]
    s_waitcnt vmcnt(17) lgkmcnt(0)
    s_barrier
    v_mfma_f32_16x16x32_bf16 v[96:99], v[176:179], a[112:115], v[96:99]
    ds_read_b128 v[160:163], v226 offset:32768
    v_mfma_f32_16x16x32_bf16 v[100:103], v[180:183], a[112:115], v[100:103]
    ds_read_b128 v[164:167], v226 offset:34816
    v_mfma_f32_16x16x32_bf16 v[104:107], v[176:179], a[116:119], v[104:107]
    ds_read_b128 v[168:171], v226 offset:36864
    v_mfma_f32_16x16x32_bf16 v[108:111], v[180:183], a[116:119], v[108:111]
    ds_read_b128 v[172:175], v226 offset:38912
    v_mfma_f32_16x16x32_bf16 v[112:115], v[176:179], a[120:123], v[112:115]
    v_mfma_f32_16x16x32_bf16 v[116:119], v[180:183], a[120:123], v[116:119]
    s_add_u32 m0, s31, 3072
    s_add_u32 s24, s27, 98304
    buffer_load_dwordx4 v245, s[12:15], s24 offen lds
    v_mfma_f32_16x16x32_bf16 v[120:123], v[176:179], a[124:127], v[120:123]
    v_mfma_f32_16x16x32_bf16 v[124:127], v[180:183], a[124:127], v[124:127]
    v_mfma_f32_16x16x32_bf16 v[128:131], v[184:187], a[112:115], v[128:131]
    v_mfma_f32_16x16x32_bf16 v[132:135], v[188:191], a[112:115], v[132:135]
    v_mfma_f32_16x16x32_bf16 v[136:139], v[184:187], a[116:119], v[136:139]
    v_mfma_f32_16x16x32_bf16 v[140:143], v[188:191], a[116:119], v[140:143]
    v_mfma_f32_16x16x32_bf16 v[144:147], v[184:187], a[120:123], v[144:147]
    v_mfma_f32_16x16x32_bf16 v[148:151], v[188:191], a[120:123], v[148:151]
    v_mfma_f32_16x16x32_bf16 v[152:155], v[184:187], a[124:127], v[152:155]
    v_mfma_f32_16x16x32_bf16 v[156:159], v[188:191], a[124:127], v[156:159]
    s_waitcnt lgkmcnt(0)
    v_mfma_f32_16x16x32_bf16 v[96:99], v[160:163], a[128:131], v[96:99]
    ds_read_b128 v[176:179], v227 offset:32768
    v_mfma_f32_16x16x32_bf16 v[100:103], v[164:167], a[128:131], v[100:103]
    ds_read_b128 v[180:183], v227 offset:34816
    v_mfma_f32_16x16x32_bf16 v[104:107], v[160:163], a[132:135], v[104:107]
    ds_read_b128 v[184:187], v227 offset:36864
    v_mfma_f32_16x16x32_bf16 v[108:111], v[164:167], a[132:135], v[108:111]
    ds_read_b128 v[188:191], v227 offset:38912
    v_mfma_f32_16x16x32_bf16 v[112:115], v[160:163], a[136:139], v[112:115]
    v_mfma_f32_16x16x32_bf16 v[116:119], v[164:167], a[136:139], v[116:119]
    s_add_u32 m0, s34, 32768
    s_add_u32 s37, s84, 196608
    buffer_load_dwordx4 v232, s[44:47], s37 offen lds
    v_mfma_f32_16x16x32_bf16 v[120:123], v[160:163], a[140:143], v[120:123]
    v_mfma_f32_16x16x32_bf16 v[124:127], v[164:167], a[140:143], v[124:127]
    buffer_load_dwordx4 v233, s[44:47], s37 offen offset:1024 lds
    v_mfma_f32_16x16x32_bf16 v[128:131], v[168:171], a[128:131], v[128:131]
    v_mfma_f32_16x16x32_bf16 v[132:135], v[172:175], a[128:131], v[132:135]
    v_mfma_f32_16x16x32_bf16 v[136:139], v[168:171], a[132:135], v[136:139]
    v_mfma_f32_16x16x32_bf16 v[140:143], v[172:175], a[132:135], v[140:143]
    v_mfma_f32_16x16x32_bf16 v[144:147], v[168:171], a[136:139], v[144:147]
    v_mfma_f32_16x16x32_bf16 v[148:151], v[172:175], a[136:139], v[148:151]
    s_add_u32 s38, s36, 40960
    buffer_store_dwordx4 v[80:83], v240, s[16:19], s38 offen offset:0 sc1
    v_mfma_f32_16x16x32_bf16 v[152:155], v[168:171], a[140:143], v[152:155]
    v_mfma_f32_16x16x32_bf16 v[156:159], v[172:175], a[140:143], v[156:159]
    s_waitcnt lgkmcnt(0)
    v_mfma_f32_16x16x32_bf16 v[96:99], v[176:179], a[144:147], v[96:99]
    ds_read_b128 v[160:163], v226 offset:40960
    v_mfma_f32_16x16x32_bf16 v[100:103], v[180:183], a[144:147], v[100:103]
    ds_read_b128 v[164:167], v226 offset:43008
    v_mfma_f32_16x16x32_bf16 v[104:107], v[176:179], a[148:151], v[104:107]
    ds_read_b128 v[168:171], v226 offset:45056
    v_mfma_f32_16x16x32_bf16 v[108:111], v[180:183], a[148:151], v[108:111]
    ds_read_b128 v[172:175], v226 offset:47104
    v_mfma_f32_16x16x32_bf16 v[112:115], v[176:179], a[152:155], v[112:115]
    v_mfma_f32_16x16x32_bf16 v[116:119], v[180:183], a[152:155], v[116:119]
    s_add_u32 m0, s31, 4096
    s_add_u32 s24, s27, 131072
    buffer_load_dwordx4 v245, s[12:15], s24 offen lds
    v_mfma_f32_16x16x32_bf16 v[120:123], v[176:179], a[156:159], v[120:123]
    v_mfma_f32_16x16x32_bf16 v[124:127], v[180:183], a[156:159], v[124:127]
    v_mfma_f32_16x16x32_bf16 v[128:131], v[184:187], a[144:147], v[128:131]
    v_mfma_f32_16x16x32_bf16 v[132:135], v[188:191], a[144:147], v[132:135]
    v_mfma_f32_16x16x32_bf16 v[136:139], v[184:187], a[148:151], v[136:139]
    v_mfma_f32_16x16x32_bf16 v[140:143], v[188:191], a[148:151], v[140:143]
    v_mfma_f32_16x16x32_bf16 v[144:147], v[184:187], a[152:155], v[144:147]
    v_mfma_f32_16x16x32_bf16 v[148:151], v[188:191], a[152:155], v[148:151]
    v_mfma_f32_16x16x32_bf16 v[152:155], v[184:187], a[156:159], v[152:155]
    v_mfma_f32_16x16x32_bf16 v[156:159], v[188:191], a[156:159], v[156:159]
    s_waitcnt lgkmcnt(0)
    v_mfma_f32_16x16x32_bf16 v[96:99], v[160:163], a[160:163], v[96:99]
    ds_read_b128 v[176:179], v227 offset:40960
    v_mfma_f32_16x16x32_bf16 v[100:103], v[164:167], a[160:163], v[100:103]
    ds_read_b128 v[180:183], v227 offset:43008
    v_mfma_f32_16x16x32_bf16 v[104:107], v[160:163], a[164:167], v[104:107]
    ds_read_b128 v[184:187], v227 offset:45056
    v_mfma_f32_16x16x32_bf16 v[108:111], v[164:167], a[164:167], v[108:111]
    ds_read_b128 v[188:191], v227 offset:47104
    v_mfma_f32_16x16x32_bf16 v[112:115], v[160:163], a[168:171], v[112:115]
    v_mfma_f32_16x16x32_bf16 v[116:119], v[164:167], a[168:171], v[116:119]
    s_add_u32 m0, s34, 40960
    s_add_u32 s37, s85, 196608
    buffer_load_dwordx4 v232, s[44:47], s37 offen lds
    v_mfma_f32_16x16x32_bf16 v[120:123], v[160:163], a[172:175], v[120:123]
    v_mfma_f32_16x16x32_bf16 v[124:127], v[164:167], a[172:175], v[124:127]
    buffer_load_dwordx4 v233, s[44:47], s37 offen offset:1024 lds
    v_mfma_f32_16x16x32_bf16 v[128:131], v[168:171], a[160:163], v[128:131]
    v_mfma_f32_16x16x32_bf16 v[132:135], v[172:175], a[160:163], v[132:135]
    v_mfma_f32_16x16x32_bf16 v[136:139], v[168:171], a[164:167], v[136:139]
    v_mfma_f32_16x16x32_bf16 v[140:143], v[172:175], a[164:167], v[140:143]
    v_mfma_f32_16x16x32_bf16 v[144:147], v[168:171], a[168:171], v[144:147]
    v_mfma_f32_16x16x32_bf16 v[148:151], v[172:175], a[168:171], v[148:151]
    v_mfma_f32_16x16x32_bf16 v[152:155], v[168:171], a[172:175], v[152:155]
    s_add_u32 s38, s36, 40960
    buffer_store_dwordx4 v[84:87], v240, s[16:19], s38 offen offset:1024 sc1
    v_mfma_f32_16x16x32_bf16 v[156:159], v[172:175], a[172:175], v[156:159]
    s_waitcnt lgkmcnt(0)
    v_mfma_f32_16x16x32_bf16 v[96:99], v[176:179], a[176:179], v[96:99]
    ds_read_b128 v[160:163], v226 offset:49152
    v_mfma_f32_16x16x32_bf16 v[100:103], v[180:183], a[176:179], v[100:103]
    ds_read_b128 v[164:167], v226 offset:51200
    v_mfma_f32_16x16x32_bf16 v[104:107], v[176:179], a[180:183], v[104:107]
    ds_read_b128 v[168:171], v226 offset:53248
    v_mfma_f32_16x16x32_bf16 v[108:111], v[180:183], a[180:183], v[108:111]
    ds_read_b128 v[172:175], v226 offset:55296
    v_mfma_f32_16x16x32_bf16 v[112:115], v[176:179], a[184:187], v[112:115]
    v_mfma_f32_16x16x32_bf16 v[116:119], v[180:183], a[184:187], v[116:119]
    s_add_u32 m0, s31, 5120
    s_add_u32 s24, s27, 163840
    buffer_load_dwordx4 v245, s[12:15], s24 offen lds
    v_mfma_f32_16x16x32_bf16 v[120:123], v[176:179], a[188:191], v[120:123]
    v_mfma_f32_16x16x32_bf16 v[124:127], v[180:183], a[188:191], v[124:127]
    v_mfma_f32_16x16x32_bf16 v[128:131], v[184:187], a[176:179], v[128:131]
    v_mfma_f32_16x16x32_bf16 v[132:135], v[188:191], a[176:179], v[132:135]
    v_mfma_f32_16x16x32_bf16 v[136:139], v[184:187], a[180:183], v[136:139]
    v_mfma_f32_16x16x32_bf16 v[140:143], v[188:191], a[180:183], v[140:143]
    v_mfma_f32_16x16x32_bf16 v[144:147], v[184:187], a[184:187], v[144:147]
    v_mfma_f32_16x16x32_bf16 v[148:151], v[188:191], a[184:187], v[148:151]
    v_mfma_f32_16x16x32_bf16 v[152:155], v[184:187], a[188:191], v[152:155]
    v_mfma_f32_16x16x32_bf16 v[156:159], v[188:191], a[188:191], v[156:159]
    s_waitcnt lgkmcnt(0)
    v_mfma_f32_16x16x32_bf16 v[96:99], v[160:163], a[192:195], v[96:99]
    ds_read_b128 v[176:179], v227 offset:49152
    v_mfma_f32_16x16x32_bf16 v[100:103], v[164:167], a[192:195], v[100:103]
    ds_read_b128 v[180:183], v227 offset:51200
    v_mfma_f32_16x16x32_bf16 v[104:107], v[160:163], a[196:199], v[104:107]
    ds_read_b128 v[184:187], v227 offset:53248
    v_mfma_f32_16x16x32_bf16 v[108:111], v[164:167], a[196:199], v[108:111]
    ds_read_b128 v[188:191], v227 offset:55296
    v_mfma_f32_16x16x32_bf16 v[112:115], v[160:163], a[200:203], v[112:115]
    v_mfma_f32_16x16x32_bf16 v[116:119], v[164:167], a[200:203], v[116:119]
    s_add_u32 m0, s34, 49152
    s_add_u32 s37, s86, 196608
    buffer_load_dwordx4 v232, s[44:47], s37 offen lds
    v_mfma_f32_16x16x32_bf16 v[120:123], v[160:163], a[204:207], v[120:123]
    v_mfma_f32_16x16x32_bf16 v[124:127], v[164:167], a[204:207], v[124:127]
    buffer_load_dwordx4 v233, s[44:47], s37 offen offset:1024 lds
    v_mfma_f32_16x16x32_bf16 v[128:131], v[168:171], a[192:195], v[128:131]
    v_mfma_f32_16x16x32_bf16 v[132:135], v[172:175], a[192:195], v[132:135]
    v_mfma_f32_16x16x32_bf16 v[136:139], v[168:171], a[196:199], v[136:139]
    v_mfma_f32_16x16x32_bf16 v[140:143], v[172:175], a[196:199], v[140:143]
    v_mfma_f32_16x16x32_bf16 v[144:147], v[168:171], a[200:203], v[144:147]
    v_mfma_f32_16x16x32_bf16 v[148:151], v[172:175], a[200:203], v[148:151]
    v_mfma_f32_16x16x32_bf16 v[152:155], v[168:171], a[204:207], v[152:155]
    v_mfma_f32_16x16x32_bf16 v[156:159], v[172:175], a[204:207], v[156:159]
    s_add_u32 s38, s36, 40960
    buffer_store_dwordx4 v[88:91], v240, s[16:19], s38 offen offset:2048 sc1
    s_waitcnt lgkmcnt(0)
    v_mfma_f32_16x16x32_bf16 v[96:99], v[176:179], a[208:211], v[96:99]
    ds_read_b128 v[160:163], v226 offset:57344
    v_mfma_f32_16x16x32_bf16 v[100:103], v[180:183], a[208:211], v[100:103]
    ds_read_b128 v[164:167], v226 offset:59392
    v_mfma_f32_16x16x32_bf16 v[104:107], v[176:179], a[212:215], v[104:107]
    ds_read_b128 v[168:171], v226 offset:61440
    v_mfma_f32_16x16x32_bf16 v[108:111], v[180:183], a[212:215], v[108:111]
    ds_read_b128 v[172:175], v226 offset:63488
    v_mfma_f32_16x16x32_bf16 v[112:115], v[176:179], a[216:219], v[112:115]
    v_mfma_f32_16x16x32_bf16 v[116:119], v[180:183], a[216:219], v[116:119]
    s_add_u32 m0, s31, 6144
    s_add_u32 s24, s27, 196608
    buffer_load_dwordx4 v245, s[12:15], s24 offen lds
    v_mfma_f32_16x16x32_bf16 v[120:123], v[176:179], a[220:223], v[120:123]
    v_mfma_f32_16x16x32_bf16 v[124:127], v[180:183], a[220:223], v[124:127]
    v_mfma_f32_16x16x32_bf16 v[128:131], v[184:187], a[208:211], v[128:131]
    v_mfma_f32_16x16x32_bf16 v[132:135], v[188:191], a[208:211], v[132:135]
    v_mfma_f32_16x16x32_bf16 v[136:139], v[184:187], a[212:215], v[136:139]
    v_mfma_f32_16x16x32_bf16 v[140:143], v[188:191], a[212:215], v[140:143]
    v_mfma_f32_16x16x32_bf16 v[144:147], v[184:187], a[216:219], v[144:147]
    v_mfma_f32_16x16x32_bf16 v[148:151], v[188:191], a[216:219], v[148:151]
    v_mfma_f32_16x16x32_bf16 v[152:155], v[184:187], a[220:223], v[152:155]
    v_mfma_f32_16x16x32_bf16 v[156:159], v[188:191], a[220:223], v[156:159]
    s_waitcnt lgkmcnt(0)
    v_mfma_f32_16x16x32_bf16 v[96:99], v[160:163], a[224:227], v[96:99]
    ds_read_b128 v[176:179], v227 offset:57344
    v_mfma_f32_16x16x32_bf16 v[100:103], v[164:167], a[224:227], v[100:103]
    ds_read_b128 v[180:183], v227 offset:59392
    v_mfma_f32_16x16x32_bf16 v[104:107], v[160:163], a[228:231], v[104:107]
    ds_read_b128 v[184:187], v227 offset:61440
    v_mfma_f32_16x16x32_bf16 v[108:111], v[164:167], a[228:231], v[108:111]
    ds_read_b128 v[188:191], v227 offset:63488
    v_mfma_f32_16x16x32_bf16 v[112:115], v[160:163], a[232:235], v[112:115]
    v_mfma_f32_16x16x32_bf16 v[116:119], v[164:167], a[232:235], v[116:119]
    s_add_u32 m0, s34, 57344
    s_add_u32 s37, s87, 196608
    buffer_load_dwordx4 v232, s[44:47], s37 offen lds
    v_mfma_f32_16x16x32_bf16 v[120:123], v[160:163], a[236:239], v[120:123]
    v_mfma_f32_16x16x32_bf16 v[124:127], v[164:167], a[236:239], v[124:127]
    buffer_load_dwordx4 v233, s[44:47], s37 offen offset:1024 lds
    v_mfma_f32_16x16x32_bf16 v[128:131], v[168:171], a[224:227], v[128:131]
    v_mfma_f32_16x16x32_bf16 v[132:135], v[172:175], a[224:227], v[132:135]
    v_mfma_f32_16x16x32_bf16 v[136:139], v[168:171], a[228:231], v[136:139]
    v_mfma_f32_16x16x32_bf16 v[140:143], v[172:175], a[228:231], v[140:143]
    v_mfma_f32_16x16x32_bf16 v[144:147], v[168:171], a[232:235], v[144:147]
    v_mfma_f32_16x16x32_bf16 v[148:151], v[172:175], a[232:235], v[148:151]
    v_mfma_f32_16x16x32_bf16 v[152:155], v[168:171], a[236:239], v[152:155]
    v_mfma_f32_16x16x32_bf16 v[156:159], v[172:175], a[236:239], v[156:159]
    s_waitcnt vmcnt(16) lgkmcnt(0)
    s_barrier
    v_mfma_f32_16x16x32_bf16 v[96:99], v[176:179], a[240:243], v[96:99]
    ds_read_b128 v[160:163], v224 offset:0
    s_add_u32 s38, s36, 40960
    buffer_store_dwordx4 v[92:95], v240, s[16:19], s38 offen offset:3072 sc1
    v_mfma_f32_16x16x32_bf16 v[100:103], v[180:183], a[240:243], v[100:103]
    ds_read_b128 v[164:167], v224 offset:2048
    v_mfma_f32_16x16x32_bf16 v[104:107], v[176:179], a[244:247], v[104:107]
    ds_read_b128 v[168:171], v224 offset:4096
    v_mfma_f32_16x16x32_bf16 v[108:111], v[180:183], a[244:247], v[108:111]
    ds_read_b128 v[172:175], v224 offset:6144
    v_mfma_f32_16x16x32_bf16 v[112:115], v[176:179], a[248:251], v[112:115]
    v_mfma_f32_16x16x32_bf16 v[116:119], v[180:183], a[248:251], v[116:119]
    s_add_u32 m0, s31, 7168
    s_add_u32 s24, s27, 229376
    buffer_load_dwordx4 v245, s[12:15], s24 offen lds
    v_mfma_f32_16x16x32_bf16 v[120:123], v[176:179], a[252:255], v[120:123]
    v_mfma_f32_16x16x32_bf16 v[124:127], v[180:183], a[252:255], v[124:127]
    s_add_u32 s27, s27, 1048576
    s_and_b32 s27, s27, 0x407fffff
    s_cmp_eq_u32 s27, s7
    s_cselect_b32 s27, s43, s27
    v_mfma_f32_16x16x32_bf16 v[128:131], v[184:187], a[240:243], v[128:131]
    v_mfma_f32_16x16x32_bf16 v[132:135], v[188:191], a[240:243], v[132:135]
    s_add_u32 s31, s31, 32768
    s_cmp_ge_u32 s31, 163840
    s_cselect_b32 s24, 98304, 0
    s_sub_u32 s31, s31, s24
    v_cvt_pk_bf16_f32 v64, v96, v97
    v_cvt_pk_bf16_f32 v65, v98, v99
    v_mfma_f32_16x16x32_bf16 v[136:139], v[184:187], a[244:247], v[136:139]
    v_cvt_pk_bf16_f32 v66, v100, v101
    v_cvt_pk_bf16_f32 v67, v102, v103
    v_mfma_f32_16x16x32_bf16 v[140:143], v[188:191], a[244:247], v[140:143]
    v_cvt_pk_bf16_f32 v68, v104, v105
    v_cvt_pk_bf16_f32 v69, v106, v107
    v_mfma_f32_16x16x32_bf16 v[144:147], v[184:187], a[248:251], v[144:147]
    v_cvt_pk_bf16_f32 v70, v108, v109
    v_cvt_pk_bf16_f32 v71, v110, v111
    v_mfma_f32_16x16x32_bf16 v[148:151], v[188:191], a[248:251], v[148:151]
    v_cvt_pk_bf16_f32 v72, v112, v113
    v_cvt_pk_bf16_f32 v73, v114, v115
    v_mfma_f32_16x16x32_bf16 v[152:155], v[184:187], a[252:255], v[152:155]
    v_cvt_pk_bf16_f32 v74, v116, v117
    v_cvt_pk_bf16_f32 v75, v118, v119
    v_mfma_f32_16x16x32_bf16 v[156:159], v[188:191], a[252:255], v[156:159]
    v_cvt_pk_bf16_f32 v76, v120, v121
    v_cvt_pk_bf16_f32 v77, v122, v123
    s_waitcnt lgkmcnt(0)
    v_mfma_f32_16x16x32_bf16 v[96:99], v[160:163], a[0:3], 0
    ds_read_b128 v[176:179], v225 offset:0
    v_cvt_pk_bf16_f32 v78, v124, v125
    v_cvt_pk_bf16_f32 v79, v126, v127
    v_mfma_f32_16x16x32_bf16 v[100:103], v[164:167], a[0:3], 0
    ds_read_b128 v[180:183], v225 offset:2048
    v_cvt_pk_bf16_f32 v80, v128, v129
    v_cvt_pk_bf16_f32 v81, v130, v131
    v_mfma_f32_16x16x32_bf16 v[104:107], v[160:163], a[4:7], 0
    ds_read_b128 v[184:187], v225 offset:4096
    v_cvt_pk_bf16_f32 v82, v132, v133
    v_cvt_pk_bf16_f32 v83, v134, v135
    v_mfma_f32_16x16x32_bf16 v[108:111], v[164:167], a[4:7], 0
    ds_read_b128 v[188:191], v225 offset:6144
    v_cvt_pk_bf16_f32 v84, v136, v137
    v_cvt_pk_bf16_f32 v85, v138, v139
    v_mfma_f32_16x16x32_bf16 v[112:115], v[160:163], a[8:11], 0
    v_cvt_pk_bf16_f32 v86, v140, v141
    v_cvt_pk_bf16_f32 v87, v142, v143
    v_mfma_f32_16x16x32_bf16 v[116:119], v[164:167], a[8:11], 0
    s_add_u32 m0, s31, 0
    s_add_u32 s24, s27, 0
    buffer_load_dwordx4 v245, s[12:15], s24 offen lds
    v_cvt_pk_bf16_f32 v88, v144, v145
    v_cvt_pk_bf16_f32 v89, v146, v147
    v_mfma_f32_16x16x32_bf16 v[120:123], v[160:163], a[12:15], 0
    v_cvt_pk_bf16_f32 v90, v148, v149
    v_cvt_pk_bf16_f32 v91, v150, v151
    v_mfma_f32_16x16x32_bf16 v[124:127], v[164:167], a[12:15], 0
    v_cvt_pk_bf16_f32 v92, v152, v153
    v_cvt_pk_bf16_f32 v93, v154, v155
    v_mfma_f32_16x16x32_bf16 v[128:131], v[168:171], a[0:3], 0
    v_cvt_pk_bf16_f32 v94, v156, v157
    v_cvt_pk_bf16_f32 v95, v158, v159
    v_mfma_f32_16x16x32_bf16 v[132:135], v[172:175], a[0:3], 0
    v_mfma_f32_16x16x32_bf16 v[136:139], v[168:171], a[4:7], 0
    s_add_u32 s38, s36, 65536
    buffer_store_dwordx4 v[64:67], v240, s[16:19], s38 offen offset:0 sc1
    v_mfma_f32_16x16x32_bf16 v[140:143], v[172:175], a[4:7], 0
    v_mfma_f32_16x16x32_bf16 v[144:147], v[168:171], a[8:11], 0
    v_mfma_f32_16x16x32_bf16 v[148:151], v[172:175], a[8:11], 0
    v_mfma_f32_16x16x32_bf16 v[152:155], v[168:171], a[12:15], 0
    v_mfma_f32_16x16x32_bf16 v[156:159], v[172:175], a[12:15], 0
    s_waitcnt lgkmcnt(0)
    v_mfma_f32_16x16x32_bf16 v[96:99], v[176:179], a[16:19], v[96:99]
    ds_read_b128 v[160:163], v224 offset:8192
    v_mfma_f32_16x16x32_bf16 v[100:103], v[180:183], a[16:19], v[100:103]
    ds_read_b128 v[164:167], v224 offset:10240
    v_mfma_f32_16x16x32_bf16 v[104:107], v[176:179], a[20:23], v[104:107]
    ds_read_b128 v[168:171], v224 offset:12288
    v_mfma_f32_16x16x32_bf16 v[108:111], v[180:183], a[20:23], v[108:111]
    ds_read_b128 v[172:175], v224 offset:14336
    v_mfma_f32_16x16x32_bf16 v[112:115], v[176:179], a[24:27], v[112:115]
    v_mfma_f32_16x16x32_bf16 v[116:119], v[180:183], a[24:27], v[116:119]
    s_add_u32 m0, s31, 1024
    s_add_u32 s24, s27, 32768
    buffer_load_dwordx4 v245, s[12:15], s24 offen lds
    v_mfma_f32_16x16x32_bf16 v[120:123], v[176:179], a[28:31], v[120:123]
    v_mfma_f32_16x16x32_bf16 v[124:127], v[180:183], a[28:31], v[124:127]
    v_mfma_f32_16x16x32_bf16 v[128:131], v[184:187], a[16:19], v[128:131]
    v_mfma_f32_16x16x32_bf16 v[132:135], v[188:191], a[16:19], v[132:135]
    v_mfma_f32_16x16x32_bf16 v[136:139], v[184:187], a[20:23], v[136:139]
    v_mfma_f32_16x16x32_bf16 v[140:143], v[188:191], a[20:23], v[140:143]
    v_mfma_f32_16x16x32_bf16 v[144:147], v[184:187], a[24:27], v[144:147]
    v_mfma_f32_16x16x32_bf16 v[148:151], v[188:191], a[24:27], v[148:151]
    v_mfma_f32_16x16x32_bf16 v[152:155], v[184:187], a[28:31], v[152:155]
    v_mfma_f32_16x16x32_bf16 v[156:159], v[188:191], a[28:31], v[156:159]
    s_waitcnt lgkmcnt(0)
    v_mfma_f32_16x16x32_bf16 v[96:99], v[160:163], a[32:35], v[96:99]
    ds_read_b128 v[176:179], v225 offset:8192
    v_mfma_f32_16x16x32_bf16 v[100:103], v[164:167], a[32:35], v[100:103]
    ds_read_b128 v[180:183], v225 offset:10240
    v_mfma_f32_16x16x32_bf16 v[104:107], v[160:163], a[36:39], v[104:107]
    ds_read_b128 v[184:187], v225 offset:12288
    v_mfma_f32_16x16x32_bf16 v[108:111], v[164:167], a[36:39], v[108:111]
    ds_read_b128 v[188:191], v225 offset:14336
    v_mfma_f32_16x16x32_bf16 v[112:115], v[160:163], a[40:43], v[112:115]
    v_mfma_f32_16x16x32_bf16 v[116:119], v[164:167], a[40:43], v[116:119]
    s_add_u32 m0, s31, 2048
    s_add_u32 s24, s27, 65536
    buffer_load_dwordx4 v245, s[12:15], s24 offen lds
    v_mfma_f32_16x16x32_bf16 v[120:123], v[160:163], a[44:47], v[120:123]
    v_mfma_f32_16x16x32_bf16 v[124:127], v[164:167], a[44:47], v[124:127]
    v_mfma_f32_16x16x32_bf16 v[128:131], v[168:171], a[32:35], v[128:131]
    v_mfma_f32_16x16x32_bf16 v[132:135], v[172:175], a[32:35], v[132:135]
    v_mfma_f32_16x16x32_bf16 v[136:139], v[168:171], a[36:39], v[136:139]
    s_add_u32 s38, s36, 65536
    buffer_store_dwordx4 v[68:71], v240, s[16:19], s38 offen offset:1024 sc1
    v_mfma_f32_16x16x32_bf16 v[140:143], v[172:175], a[36:39], v[140:143]
    v_mfma_f32_16x16x32_bf16 v[144:147], v[168:171], a[40:43], v[144:147]
    v_mfma_f32_16x16x32_bf16 v[148:151], v[172:175], a[40:43], v[148:151]
    v_mfma_f32_16x16x32_bf16 v[152:155], v[168:171], a[44:47], v[152:155]
    v_mfma_f32_16x16x32_bf16 v[156:159], v[172:175], a[44:47], v[156:159]
    s_waitcnt lgkmcnt(0)
    v_mfma_f32_16x16x32_bf16 v[96:99], v[176:179], a[48:51], v[96:99]
    ds_read_b128 v[160:163], v224 offset:16384
    v_mfma_f32_16x16x32_bf16 v[100:103], v[180:183], a[48:51], v[100:103]
    ds_read_b128 v[164:167], v224 offset:18432
    v_mfma_f32_16x16x32_bf16 v[104:107], v[176:179], a[52:55], v[104:107]
    ds_read_b128 v[168:171], v224 offset:20480
    v_mfma_f32_16x16x32_bf16 v[108:111], v[180:183], a[52:55], v[108:111]
    ds_read_b128 v[172:175], v224 offset:22528
    v_mfma_f32_16x16x32_bf16 v[112:115], v[176:179], a[56:59], v[112:115]
    v_mfma_f32_16x16x32_bf16 v[116:119], v[180:183], a[56:59], v[116:119]
    s_add_u32 m0, s31, 3072
    s_add_u32 s24, s27, 98304
    buffer_load_dwordx4 v245, s[12:15], s24 offen lds
    v_mfma_f32_16x16x32_bf16 v[120:123], v[176:179], a[60:63], v[120:123]
    v_mfma_f32_16x16x32_bf16 v[124:127], v[180:183], a[60:63], v[124:127]
    v_mfma_f32_16x16x32_bf16 v[128:131], v[184:187], a[48:51], v[128:131]
    v_mfma_f32_16x16x32_bf16 v[132:135], v[188:191], a[48:51], v[132:135]
    v_mfma_f32_16x16x32_bf16 v[136:139], v[184:187], a[52:55], v[136:139]
    v_mfma_f32_16x16x32_bf16 v[140:143], v[188:191], a[52:55], v[140:143]
    v_mfma_f32_16x16x32_bf16 v[144:147], v[184:187], a[56:59], v[144:147]
    v_mfma_f32_16x16x32_bf16 v[148:151], v[188:191], a[56:59], v[148:151]
    v_mfma_f32_16x16x32_bf16 v[152:155], v[184:187], a[60:63], v[152:155]
    v_mfma_f32_16x16x32_bf16 v[156:159], v[188:191], a[60:63], v[156:159]
    s_waitcnt lgkmcnt(0)
    v_mfma_f32_16x16x32_bf16 v[96:99], v[160:163], a[64:67], v[96:99]
    ds_read_b128 v[176:179], v225 offset:16384
    v_mfma_f32_16x16x32_bf16 v[100:103], v[164:167], a[64:67], v[100:103]
    ds_read_b128 v[180:183], v225 offset:18432
    v_mfma_f32_16x16x32_bf16 v[104:107], v[160:163], a[68:71], v[104:107]
    ds_read_b128 v[184:187], v225 offset:20480
    v_mfma_f32_16x16x32_bf16 v[108:111], v[164:167], a[68:71], v[108:111]
    ds_read_b128 v[188:191], v225 offset:22528
    v_mfma_f32_16x16x32_bf16 v[112:115], v[160:163], a[72:75], v[112:115]
    v_mfma_f32_16x16x32_bf16 v[116:119], v[164:167], a[72:75], v[116:119]
    s_add_u32 m0, s31, 4096
    s_add_u32 s24, s27, 131072
    buffer_load_dwordx4 v245, s[12:15], s24 offen lds
    v_mfma_f32_16x16x32_bf16 v[120:123], v[160:163], a[76:79], v[120:123]
    v_mfma_f32_16x16x32_bf16 v[124:127], v[164:167], a[76:79], v[124:127]
    v_mfma_f32_16x16x32_bf16 v[128:131], v[168:171], a[64:67], v[128:131]
    v_mfma_f32_16x16x32_bf16 v[132:135], v[172:175], a[64:67], v[132:135]
    v_mfma_f32_16x16x32_bf16 v[136:139], v[168:171], a[68:71], v[136:139]
    v_mfma_f32_16x16x32_bf16 v[140:143], v[172:175], a[68:71], v[140:143]
    s_add_u32 s38, s36, 65536
    buffer_store_dwordx4 v[72:75], v240, s[16:19], s38 offen offset:2048 sc1
    v_mfma_f32_16x16x32_bf16 v[144:147], v[168:171], a[72:75], v[144:147]
    v_mfma_f32_16x16x32_bf16 v[148:151], v[172:175], a[72:75], v[148:151]
    v_mfma_f32_16x16x32_bf16 v[152:155], v[168:171], a[76:79], v[152:155]
    v_mfma_f32_16x16x32_bf16 v[156:159], v[172:175], a[76:79], v[156:159]
    s_waitcnt lgkmcnt(0)
    v_mfma_f32_16x16x32_bf16 v[96:99], v[176:179], a[80:83], v[96:99]
    ds_read_b128 v[160:163], v224 offset:24576
    v_mfma_f32_16x16x32_bf16 v[100:103], v[180:183], a[80:83], v[100:103]
    ds_read_b128 v[164:167], v224 offset:26624
    v_mfma_f32_16x16x32_bf16 v[104:107], v[176:179], a[84:87], v[104:107]
    ds_read_b128 v[168:171], v224 offset:28672
    v_mfma_f32_16x16x32_bf16 v[108:111], v[180:183], a[84:87], v[108:111]
    ds_read_b128 v[172:175], v224 offset:30720
    v_mfma_f32_16x16x32_bf16 v[112:115], v[176:179], a[88:91], v[112:115]
    v_mfma_f32_16x16x32_bf16 v[116:119], v[180:183], a[88:91], v[116:119]
    s_add_u32 m0, s31, 5120
    s_add_u32 s24, s27, 163840
    buffer_load_dwordx4 v245, s[12:15], s24 offen lds
    v_mfma_f32_16x16x32_bf16 v[120:123], v[176:179], a[92:95], v[120:123]
    v_mfma_f32_16x16x32_bf16 v[124:127], v[180:183], a[92:95], v[124:127]
    v_mfma_f32_16x16x32_bf16 v[128:131], v[184:187], a[80:83], v[128:131]
    v_mfma_f32_16x16x32_bf16 v[132:135], v[188:191], a[80:83], v[132:135]
    v_mfma_f32_16x16x32_bf16 v[136:139], v[184:187], a[84:87], v[136:139]
    v_mfma_f32_16x16x32_bf16 v[140:143], v[188:191], a[84:87], v[140:143]
    v_mfma_f32_16x16x32_bf16 v[144:147], v[184:187], a[88:91], v[144:147]
    v_mfma_f32_16x16x32_bf16 v[148:151], v[188:191], a[88:91], v[148:151]
    v_mfma_f32_16x16x32_bf16 v[152:155], v[184:187], a[92:95], v[152:155]
    v_mfma_f32_16x16x32_bf16 v[156:159], v[188:191], a[92:95], v[156:159]
    s_waitcnt lgkmcnt(0)
    v_mfma_f32_16x16x32_bf16 v[96:99], v[160:163], a[96:99], v[96:99]
    ds_read_b128 v[176:179], v225 offset:24576
    v_mfma_f32_16x16x32_bf16 v[100:103], v[164:167], a[96:99], v[100:103]
    ds_read_b128 v[180:183], v225 offset:26624
    v_mfma_f32_16x16x32_bf16 v[104:107], v[160:163], a[100:103], v[104:107]
    ds_read_b128 v[184:187], v225 offset:28672
    v_mfma_f32_16x16x32_bf16 v[108:111], v[164:167], a[100:103], v[108:111]
    ds_read_b128 v[188:191], v225 offset:30720
    v_mfma_f32_16x16x32_bf16 v[112:115], v[160:163], a[104:107], v[112:115]
    v_mfma_f32_16x16x32_bf16 v[116:119], v[164:167], a[104:107], v[116:119]
    buffer_load_dword v254, off, s[88:91], s39 sc1
    v_mfma_f32_16x16x32_bf16 v[120:123], v[160:163], a[108:111], v[120:123]
    v_mfma_f32_16x16x32_bf16 v[124:127], v[164:167], a[108:111], v[124:127]
    s_add_u32 m0, s31, 6144
    s_add_u32 s24, s27, 196608
    buffer_load_dwordx4 v245, s[12:15], s24 offen lds
    v_mfma_f32_16x16x32_bf16 v[128:131], v[168:171], a[96:99], v[128:131]
    v_mfma_f32_16x16x32_bf16 v[132:135], v[172:175], a[96:99], v[132:135]
    v_mfma_f32_16x16x32_bf16 v[136:139], v[168:171], a[100:103], v[136:139]
    v_mfma_f32_16x16x32_bf16 v[140:143], v[172:175], a[100:103], v[140:143]
    v_mfma_f32_16x16x32_bf16 v[144:147], v[168:171], a[104:107], v[144:147]
    s_add_u32 s38, s36, 65536
    buffer_store_dwordx4 v[76:79], v240, s[16:19], s38 offen offset:3072 sc1
    v_mfma_f32_16x16x32_bf16 v[148:151], v[172:175], a[104:107], v[148:151]
    v_mfma_f32_16x16x32_bf16 v[152:155], v[168:171], a[108:111], v[152:155]
    v_mfma_f32_16x16x32_bf16 v[156:159], v[172:175], a[108:111], v[156:159]
    s_waitcnt vmcnt(14) lgkmcnt(0)
    s_barrier
    v_mfma_f32_16x16x32_bf16 v[96:99], v[176:179], a[112:115], v[96:99]
    ds_read_b128 v[160:163], v224 offset:32768
    v_mfma_f32_16x16x32_bf16 v[100:103], v[180:183], a[112:115], v[100:103]
    ds_read_b128 v[164:167], v224 offset:34816
    v_mfma_f32_16x16x32_bf16 v[104:107], v[176:179], a[116:119], v[104:107]
    ds_read_b128 v[168:171], v224 offset:36864
    v_mfma_f32_16x16x32_bf16 v[108:111], v[180:183], a[116:119], v[108:111]
    ds_read_b128 v[172:175], v224 offset:38912
    v_mfma_f32_16x16x32_bf16 v[112:115], v[176:179], a[120:123], v[112:115]
    v_mfma_f32_16x16x32_bf16 v[116:119], v[180:183], a[120:123], v[116:119]
    s_add_u32 m0, s31, 7168
    s_add_u32 s24, s27, 229376
    buffer_load_dwordx4 v245, s[12:15], s24 offen lds
    v_mfma_f32_16x16x32_bf16 v[120:123], v[176:179], a[124:127], v[120:123]
    v_mfma_f32_16x16x32_bf16 v[124:127], v[180:183], a[124:127], v[124:127]
    s_add_u32 s27, s27, 1048576
    s_and_b32 s27, s27, 0x407fffff
    s_cmp_eq_u32 s27, s7
    s_cselect_b32 s27, s43, s27
    v_mfma_f32_16x16x32_bf16 v[128:131], v[184:187], a[112:115], v[128:131]
    v_mfma_f32_16x16x32_bf16 v[132:135], v[188:191], a[112:115], v[132:135]
    s_add_u32 s31, s31, 32768
    s_cmp_ge_u32 s31, 163840
    s_cselect_b32 s24, 98304, 0
    s_sub_u32 s31, s31, s24
    v_mfma_f32_16x16x32_bf16 v[136:139], v[184:187], a[116:119], v[136:139]
    v_mfma_f32_16x16x32_bf16 v[140:143], v[188:191], a[116:119], v[140:143]
    v_mfma_f32_16x16x32_bf16 v[144:147], v[184:187], a[120:123], v[144:147]
    v_mfma_f32_16x16x32_bf16 v[148:151], v[188:191], a[120:123], v[148:151]
    v_mfma_f32_16x16x32_bf16 v[152:155], v[184:187], a[124:127], v[152:155]
    v_mfma_f32_16x16x32_bf16 v[156:159], v[188:191], a[124:127], v[156:159]
    s_waitcnt lgkmcnt(0)
    v_mfma_f32_16x16x32_bf16 v[96:99], v[160:163], a[128:131], v[96:99]
    ds_read_b128 v[176:179], v225 offset:32768
    v_mfma_f32_16x16x32_bf16 v[100:103], v[164:167], a[128:131], v[100:103]
    ds_read_b128 v[180:183], v225 offset:34816
    v_mfma_f32_16x16x32_bf16 v[104:107], v[160:163], a[132:135], v[104:107]
    ds_read_b128 v[184:187], v225 offset:36864
    v_mfma_f32_16x16x32_bf16 v[108:111], v[164:167], a[132:135], v[108:111]
    ds_read_b128 v[188:191], v225 offset:38912
    v_mfma_f32_16x16x32_bf16 v[112:115], v[160:163], a[136:139], v[112:115]
    s_mul_i32 s37, s2, 100
    v_mfma_f32_16x16x32_bf16 v[116:119], v[164:167], a[136:139], v[116:119]
    v_lshl_add_u32 v60, v253, 2, s37
    v_cmp_gt_u32 vcc, 25, v253
    v_mfma_f32_16x16x32_bf16 v[120:123], v[160:163], a[140:143], v[120:123]
    v_mov_b32 v61, 0
    v_mfma_f32_16x16x32_bf16 v[124:127], v[164:167], a[140:143], v[124:127]
    v_mov_b32 v62, 0x7ffffff0
    v_mfma_f32_16x16x32_bf16 v[128:131], v[168:171], a[128:131], v[128:131]
    v_cndmask_b32 v60, v62, v60, vcc
    buffer_store_dword v61, v60, s[56:59], 0 offen
    v_mfma_f32_16x16x32_bf16 v[132:135], v[172:175], a[128:131], v[132:135]
    s_add_u32 s56, s56, 0x20000
    s_addc_u32 s57, s57, 0
    v_mfma_f32_16x16x32_bf16 v[136:139], v[168:171], a[132:135], v[136:139]
    s_mov_b32 s58, 0x20000
    v_mfma_f32_16x16x32_bf16 v[140:143], v[172:175], a[132:135], v[140:143]
    s_lshl2_add_u32 s37, s2, s3
    s_lshl_b32 s37, s37, 7
    v_mfma_f32_16x16x32_bf16 v[144:147], v[168:171], a[136:139], v[144:147]
    buffer_store_dword v61, off, s[56:59], s37
    v_mfma_f32_16x16x32_bf16 v[148:151], v[172:175], a[136:139], v[148:151]
    s_add_u32 s38, s36, 73728
    buffer_store_dwordx4 v[80:83], v240, s[16:19], s38 offen offset:0 sc1
    v_mfma_f32_16x16x32_bf16 v[152:155], v[168:171], a[140:143], v[152:155]
    v_mfma_f32_16x16x32_bf16 v[156:159], v[172:175], a[140:143], v[156:159]
    s_waitcnt lgkmcnt(0)
    v_mfma_f32_16x16x32_bf16 v[96:99], v[176:179], a[144:147], v[96:99]
    ds_read_b128 v[160:163], v224 offset:40960
    v_mfma_f32_16x16x32_bf16 v[100:103], v[180:183], a[144:147], v[100:103]
    ds_read_b128 v[164:167], v224 offset:43008
    v_mfma_f32_16x16x32_bf16 v[104:107], v[176:179], a[148:151], v[104:107]
    ds_read_b128 v[168:171], v224 offset:45056
    v_mfma_f32_16x16x32_bf16 v[108:111], v[180:183], a[148:151], v[108:111]
    ds_read_b128 v[172:175], v224 offset:47104
    v_mfma_f32_16x16x32_bf16 v[112:115], v[176:179], a[152:155], v[112:115]
    v_mfma_f32_16x16x32_bf16 v[116:119], v[180:183], a[152:155], v[116:119]
    v_mfma_f32_16x16x32_bf16 v[120:123], v[176:179], a[156:159], v[120:123]
    v_mfma_f32_16x16x32_bf16 v[124:127], v[180:183], a[156:159], v[124:127]
    v_mfma_f32_16x16x32_bf16 v[128:131], v[184:187], a[144:147], v[128:131]
    v_mfma_f32_16x16x32_bf16 v[132:135], v[188:191], a[144:147], v[132:135]
    v_mfma_f32_16x16x32_bf16 v[136:139], v[184:187], a[148:151], v[136:139]
    v_mfma_f32_16x16x32_bf16 v[140:143], v[188:191], a[148:151], v[140:143]
    v_mfma_f32_16x16x32_bf16 v[144:147], v[184:187], a[152:155], v[144:147]
    v_mfma_f32_16x16x32_bf16 v[148:151], v[188:191], a[152:155], v[148:151]
    v_mfma_f32_16x16x32_bf16 v[152:155], v[184:187], a[156:159], v[152:155]
    v_mfma_f32_16x16x32_bf16 v[156:159], v[188:191], a[156:159], v[156:159]
    s_waitcnt lgkmcnt(0)
    v_mfma_f32_16x16x32_bf16 v[96:99], v[160:163], a[160:163], v[96:99]
    ds_read_b128 v[176:179], v225 offset:40960
    v_mfma_f32_16x16x32_bf16 v[100:103], v[164:167], a[160:163], v[100:103]
    ds_read_b128 v[180:183], v225 offset:43008
    v_mfma_f32_16x16x32_bf16 v[104:107], v[160:163], a[164:167], v[104:107]
    ds_read_b128 v[184:187], v225 offset:45056
    v_mfma_f32_16x16x32_bf16 v[108:111], v[164:167], a[164:167], v[108:111]
    ds_read_b128 v[188:191], v225 offset:47104
    v_mfma_f32_16x16x32_bf16 v[112:115], v[160:163], a[168:171], v[112:115]
    v_mfma_f32_16x16x32_bf16 v[116:119], v[164:167], a[168:171], v[116:119]
    v_mfma_f32_16x16x32_bf16 v[120:123], v[160:163], a[172:175], v[120:123]
    v_mfma_f32_16x16x32_bf16 v[124:127], v[164:167], a[172:175], v[124:127]
    v_mfma_f32_16x16x32_bf16 v[128:131], v[168:171], a[160:163], v[128:131]
    v_mfma_f32_16x16x32_bf16 v[132:135], v[172:175], a[160:163], v[132:135]
    v_mfma_f32_16x16x32_bf16 v[136:139], v[168:171], a[164:167], v[136:139]
    v_mfma_f32_16x16x32_bf16 v[140:143], v[172:175], a[164:167], v[140:143]
    v_mfma_f32_16x16x32_bf16 v[144:147], v[168:171], a[168:171], v[144:147]
    v_mfma_f32_16x16x32_bf16 v[148:151], v[172:175], a[168:171], v[148:151]
    v_mfma_f32_16x16x32_bf16 v[152:155], v[168:171], a[172:175], v[152:155]
    s_add_u32 s38, s36, 73728
    buffer_store_dwordx4 v[84:87], v240, s[16:19], s38 offen offset:1024 sc1
    v_mfma_f32_16x16x32_bf16 v[156:159], v[172:175], a[172:175], v[156:159]
    s_waitcnt vmcnt(7)
    v_readfirstlane_b32 s24, v254
    s_lshl_b32 s25, s3, 16
    s_add_u32 s24, s24, s25
    s_cmp_ge_u32 s24, 32
    s_cbranch_scc0 ka_spin43
ka_spinr44:
    s_waitcnt lgkmcnt(0)
    s_barrier
    v_mfma_f32_16x16x32_bf16 v[96:99], v[176:179], a[176:179], v[96:99]
    ds_read_b128 v[160:163], v224 offset:49152
    v_mfma_f32_16x16x32_bf16 v[100:103], v[180:183], a[176:179], v[100:103]
    ds_read_b128 v[164:167], v224 offset:51200
    v_mfma_f32_16x16x32_bf16 v[104:107], v[176:179], a[180:183], v[104:107]
    ds_read_b128 v[168:171], v224 offset:53248
    v_mfma_f32_16x16x32_bf16 v[108:111], v[180:183], a[180:183], v[108:111]
    ds_read_b128 v[172:175], v224 offset:55296
    v_mfma_f32_16x16x32_bf16 v[112:115], v[176:179], a[184:187], v[112:115]
    v_mfma_f32_16x16x32_bf16 v[116:119], v[180:183], a[184:187], v[116:119]
    buffer_load_dwordx4 v[0:3], v248, s[8:11], s28 offen offset:0 sc1
    v_mfma_f32_16x16x32_bf16 v[120:123], v[176:179], a[188:191], v[120:123]
    v_mfma_f32_16x16x32_bf16 v[124:127], v[180:183], a[188:191], v[124:127]
    buffer_load_dwordx4 v[4:7], v249, s[8:11], s28 offen offset:0 sc1
    v_mfma_f32_16x16x32_bf16 v[128:131], v[184:187], a[176:179], v[128:131]
    v_mfma_f32_16x16x32_bf16 v[132:135], v[188:191], a[176:179], v[132:135]
    buffer_load_dwordx4 v[8:11], v248, s[8:11], s28 offen offset:1024 sc1
    v_mfma_f32_16x16x32_bf16 v[136:139], v[184:187], a[180:183], v[136:139]
    v_mfma_f32_16x16x32_bf16 v[140:143], v[188:191], a[180:183], v[140:143]
    buffer_load_dwordx4 v[12:15], v249, s[8:11], s28 offen offset:1024 sc1
    v_mfma_f32_16x16x32_bf16 v[144:147], v[184:187], a[184:187], v[144:147]
    v_mfma_f32_16x16x32_bf16 v[148:151], v[188:191], a[184:187], v[148:151]
    v_mfma_f32_16x16x32_bf16 v[152:155], v[184:187], a[188:191], v[152:155]
    v_mfma_f32_16x16x32_bf16 v[156:159], v[188:191], a[188:191], v[156:159]
    s_waitcnt lgkmcnt(0)
    v_mfma_f32_16x16x32_bf16 v[96:99], v[160:163], a[192:195], v[96:99]
    ds_read_b128 v[176:179], v225 offset:49152
    v_mfma_f32_16x16x32_bf16 v[100:103], v[164:167], a[192:195], v[100:103]
    ds_read_b128 v[180:183], v225 offset:51200
    v_mfma_f32_16x16x32_bf16 v[104:107], v[160:163], a[196:199], v[104:107]
    ds_read_b128 v[184:187], v225 offset:53248
    v_mfma_f32_16x16x32_bf16 v[108:111], v[164:167], a[196:199], v[108:111]
    ds_read_b128 v[188:191], v225 offset:55296
    v_mfma_f32_16x16x32_bf16 v[112:115], v[160:163], a[200:203], v[112:115]
    v_mfma_f32_16x16x32_bf16 v[116:119], v[164:167], a[200:203], v[116:119]
    buffer_load_dwordx4 v[16:19], v248, s[8:11], s28 offen offset:2048 sc1
    v_mfma_f32_16x16x32_bf16 v[120:123], v[160:163], a[204:207], v[120:123]
    v_mfma_f32_16x16x32_bf16 v[124:127], v[164:167], a[204:207], v[124:127]
    buffer_load_dwordx4 v[20:23], v249, s[8:11], s28 offen offset:2048 sc1
    v_mfma_f32_16x16x32_bf16 v[128:131], v[168:171], a[192:195], v[128:131]
    v_mfma_f32_16x16x32_bf16 v[132:135], v[172:175], a[192:195], v[132:135]
    buffer_load_dwordx4 v[24:27], v248, s[8:11], s28 offen offset:3072 sc1
    v_mfma_f32_16x16x32_bf16 v[136:139], v[168:171], a[196:199], v[136:139]
    v_mfma_f32_16x16x32_bf16 v[140:143], v[172:175], a[196:199], v[140:143]
    buffer_load_dwordx4 v[28:31], v249, s[8:11], s28 offen offset:3072 sc1
    v_mfma_f32_16x16x32_bf16 v[144:147], v[168:171], a[200:203], v[144:147]
    v_mfma_f32_16x16x32_bf16 v[148:151], v[172:175], a[200:203], v[148:151]
    v_mfma_f32_16x16x32_bf16 v[152:155], v[168:171], a[204:207], v[152:155]
    v_mfma_f32_16x16x32_bf16 v[156:159], v[172:175], a[204:207], v[156:159]
    s_add_u32 s38, s36, 73728
    buffer_store_dwordx4 v[88:91], v240, s[16:19], s38 offen offset:2048 sc1
    s_waitcnt lgkmcnt(0)
    v_mfma_f32_16x16x32_bf16 v[96:99], v[176:179], a[208:211], v[96:99]
    ds_read_b128 v[160:163], v224 offset:57344
    v_mfma_f32_16x16x32_bf16 v[100:103], v[180:183], a[208:211], v[100:103]
    ds_read_b128 v[164:167], v224 offset:59392
    v_mfma_f32_16x16x32_bf16 v[104:107], v[176:179], a[212:215], v[104:107]
    ds_read_b128 v[168:171], v224 offset:61440
    v_mfma_f32_16x16x32_bf16 v[108:111], v[180:183], a[212:215], v[108:111]
    ds_read_b128 v[172:175], v224 offset:63488
    v_mfma_f32_16x16x32_bf16 v[112:115], v[176:179], a[216:219], v[112:115]
    v_mfma_f32_16x16x32_bf16 v[116:119], v[180:183], a[216:219], v[116:119]
    buffer_load_dwordx4 v[32:35], v248, s[8:11], s29 offen offset:0 sc1
    v_mfma_f32_16x16x32_bf16 v[120:123], v[176:179], a[220:223], v[120:123]
    v_mfma_f32_16x16x32_bf16 v[124:127], v[180:183], a[220:223], v[124:127]
    buffer_load_dwordx4 v[36:39], v249, s[8:11], s29 offen offset:0 sc1
    v_mfma_f32_16x16x32_bf16 v[128:131], v[184:187], a[208:211], v[128:131]
    v_mfma_f32_16x16x32_bf16 v[132:135], v[188:191], a[208:211], v[132:135]
    buffer_load_dwordx4 v[40:43], v248, s[8:11], s29 offen offset:1024 sc1
    v_mfma_f32_16x16x32_bf16 v[136:139], v[184:187], a[212:215], v[136:139]
    v_mfma_f32_16x16x32_bf16 v[140:143], v[188:191], a[212:215], v[140:143]
    buffer_load_dwordx4 v[44:47], v249, s[8:11], s29 offen offset:1024 sc1
    v_mfma_f32_16x16x32_bf16 v[144:147], v[184:187], a[216:219], v[144:147]
    v_mfma_f32_16x16x32_bf16 v[148:151], v[188:191], a[216:219], v[148:151]
    v_mfma_f32_16x16x32_bf16 v[152:155], v[184:187], a[220:223], v[152:155]
    v_mfma_f32_16x16x32_bf16 v[156:159], v[188:191], a[220:223], v[156:159]
    s_waitcnt lgkmcnt(0)
    v_mfma_f32_16x16x32_bf16 v[96:99], v[160:163], a[224:227], v[96:99]
    ds_read_b128 v[176:179], v225 offset:57344
    v_mfma_f32_16x16x32_bf16 v[100:103], v[164:167], a[224:227], v[100:103]
    ds_read_b128 v[180:183], v225 offset:59392
    v_mfma_f32_16x16x32_bf16 v[104:107], v[160:163], a[228:231], v[104:107]
    ds_read_b128 v[184:187], v225 offset:61440
    v_mfma_f32_16x16x32_bf16 v[108:111], v[164:167], a[228:231], v[108:111]
    ds_read_b128 v[188:191], v225 offset:63488
    v_mfma_f32_16x16x32_bf16 v[112:115], v[160:163], a[232:235], v[112:115]
    v_mfma_f32_16x16x32_bf16 v[116:119], v[164:167], a[232:235], v[116:119]
    buffer_load_dwordx4 v[48:51], v248, s[8:11], s29 offen offset:2048 sc1
    v_mfma_f32_16x16x32_bf16 v[120:123], v[160:163], a[236:239], v[120:123]
    v_mfma_f32_16x16x32_bf16 v[124:127], v[164:167], a[236:239], v[124:127]
    buffer_load_dwordx4 v[52:55], v249, s[8:11], s29 offen offset:2048 sc1
    v_mfma_f32_16x16x32_bf16 v[128:131], v[168:171], a[224:227], v[128:131]
    v_mfma_f32_16x16x32_bf16 v[132:135], v[172:175], a[224:227], v[132:135]
    buffer_load_dwordx4 v[56:59], v248, s[8:11], s29 offen offset:3072 sc1
    v_mfma_f32_16x16x32_bf16 v[136:139], v[168:171], a[228:231], v[136:139]
    v_mfma_f32_16x16x32_bf16 v[140:143], v[172:175], a[228:231], v[140:143]
    buffer_load_dwordx4 v[60:63], v249, s[8:11], s29 offen offset:3072 sc1
    v_mfma_f32_16x16x32_bf16 v[144:147], v[168:171], a[232:235], v[144:147]
    v_mfma_f32_16x16x32_bf16 v[148:151], v[172:175], a[232:235], v[148:151]
    v_mfma_f32_16x16x32_bf16 v[152:155], v[168:171], a[236:239], v[152:155]
    v_mfma_f32_16x16x32_bf16 v[156:159], v[172:175], a[236:239], v[156:159]
    s_waitcnt vmcnt(34) lgkmcnt(0)
    s_barrier
    v_mfma_f32_16x16x32_bf16 v[96:99], v[176:179], a[240:243], v[96:99]
    ds_read_b64_tr_b16 a[192:193], v246 offset:0
    s_add_u32 s38, s36, 73728
    buffer_store_dwordx4 v[92:95], v240, s[16:19], s38 offen offset:3072 sc1
    v_mfma_f32_16x16x32_bf16 v[100:103], v[180:183], a[240:243], v[100:103]
    ds_read_b64_tr_b16 a[194:195], v246 offset:1024
    v_mfma_f32_16x16x32_bf16 v[104:107], v[176:179], a[244:247], v[104:107]
    ds_read_b64_tr_b16 a[196:197], v246 offset:256
    v_mfma_f32_16x16x32_bf16 v[108:111], v[180:183], a[244:247], v[108:111]
    ds_read_b64_tr_b16 a[198:199], v246 offset:1280
    v_mfma_f32_16x16x32_bf16 v[112:115], v[176:179], a[248:251], v[112:115]
    ds_read_b64_tr_b16 a[200:201], v246 offset:512
    v_mfma_f32_16x16x32_bf16 v[116:119], v[180:183], a[248:251], v[116:119]
    ds_read_b64_tr_b16 a[202:203], v246 offset:1536
    s_add_u32 s28, s28, 8192
    s_and_b32 s28, s28, 65535
    s_add_u32 s29, s28, 4096
    v_mfma_f32_16x16x32_bf16 v[120:123], v[176:179], a[252:255], v[120:123]
    ds_read_b64_tr_b16 a[204:205], v246 offset:768
    v_mfma_f32_16x16x32_bf16 v[124:127], v[180:183], a[252:255], v[124:127]
    ds_read_b64_tr_b16 a[206:207], v246 offset:1792
    v_mfma_f32_16x16x32_bf16 v[128:131], v[184:187], a[240:243], v[128:131]
    v_mfma_f32_16x16x32_bf16 v[132:135], v[188:191], a[240:243], v[132:135]
    v_cvt_pk_bf16_f32 v64, v96, v97
    v_cvt_pk_bf16_f32 v65, v98, v99
    v_mfma_f32_16x16x32_bf16 v[136:139], v[184:187], a[244:247], v[136:139]
    v_cvt_pk_bf16_f32 v66, v100, v101
    v_cvt_pk_bf16_f32 v67, v102, v103
    v_mfma_f32_16x16x32_bf16 v[140:143], v[188:191], a[244:247], v[140:143]
    v_cvt_pk_bf16_f32 v68, v104, v105
    v_cvt_pk_bf16_f32 v69, v106, v107
    v_mfma_f32_16x16x32_bf16 v[144:147], v[184:187], a[248:251], v[144:147]
    v_cvt_pk_bf16_f32 v70, v108, v109
    v_cvt_pk_bf16_f32 v71, v110, v111
    v_mfma_f32_16x16x32_bf16 v[148:151], v[188:191], a[248:251], v[148:151]
    v_cvt_pk_bf16_f32 v72, v112, v113
    v_cvt_pk_bf16_f32 v73, v114, v115
    v_mfma_f32_16x16x32_bf16 v[152:155], v[184:187], a[252:255], v[152:155]
    v_cvt_pk_bf16_f32 v74, v116, v117
    v_cvt_pk_bf16_f32 v75, v118, v119
    v_mfma_f32_16x16x32_bf16 v[156:159], v[188:191], a[252:255], v[156:159]
    v_cvt_pk_bf16_f32 v76, v120, v121
    v_cvt_pk_bf16_f32 v77, v122, v123
    s_nop 3
    v_cvt_pk_bf16_f32 v78, v124, v125
    v_cvt_pk_bf16_f32 v79, v126, v127
    v_cvt_pk_bf16_f32 v80, v128, v129
    v_cvt_pk_bf16_f32 v81, v130, v131
    v_cvt_pk_bf16_f32 v82, v132, v133
    v_cvt_pk_bf16_f32 v83, v134, v135
    v_cvt_pk_bf16_f32 v84, v136, v137
    v_cvt_pk_bf16_f32 v85, v138, v139
    v_cvt_pk_bf16_f32 v86, v140, v141
    v_cvt_pk_bf16_f32 v87, v142, v143
    v_cvt_pk_bf16_f32 v88, v144, v145
    v_cvt_pk_bf16_f32 v89, v146, v147
    v_cvt_pk_bf16_f32 v90, v148, v149
    v_cvt_pk_bf16_f32 v91, v150, v151
    v_cvt_pk_bf16_f32 v92, v152, v153
    v_cvt_pk_bf16_f32 v93, v154, v155
    v_cvt_pk_bf16_f32 v94, v156, v157
    v_cvt_pk_bf16_f32 v95, v158, v159
    s_add_u32 s80, s36, 98304
    s_add_u32 s81, s36, 99328
    s_add_u32 s82, s36, 100352
    s_add_u32 s83, s36, 101376
    s_add_u32 s84, s36, 106496
    s_add_u32 s85, s36, 107520
    s_add_u32 s86, s36, 108544
    s_add_u32 s87, s36, 109568
ka_Q:
    s_waitcnt vmcnt(16) lgkmcnt(0)
    v_mfma_f32_32x32x16_bf16 v[96:111], a[192:195], v[0:3], 0
    ds_read_b64_tr_b16 a[208:209], v246 offset:4096
    ds_read_b64_tr_b16 a[210:211], v246 offset:5120
    s_lshl_b32 s97, s4, 2
    s_add_u32 s97, s97, 64
    s_cmp_eq_u32 s3, 0
    s_cselect_b32 s35, s97, s43
    v_mfma_f32_32x32x16_bf16 v[160:175], a[192:195], v[4:7], 0
    ds_read_b64_tr_b16 a[212:213], v246 offset:4352
    ds_read_b64_tr_b16 a[214:215], v246 offset:5376
    s_lshl_b32 s37, s3, 12
    s_mov_b32 s34, s37
    v_mfma_f32_32x32x16_bf16 v[112:127], a[196:199], v[0:3], 0
    ds_read_b64_tr_b16 a[216:217], v246 offset:4608
    ds_read_b64_tr_b16 a[218:219], v246 offset:5632
    s_lshl_b32 s32, s4, 20
    s_lshl_b32 s25, s5, 16
    s_sub_u32 s33, s32, s25
    v_mfma_f32_32x32x16_bf16 v[176:191], a[196:199], v[4:7], 0
    ds_read_b64_tr_b16 a[220:221], v246 offset:4864
    ds_read_b64_tr_b16 a[222:223], v246 offset:5888
    s_add_u32 s33, s33, 1048576
    s_lshl_b32 s39, s6, 18
    s_sub_u32 s25, 63, s6
    v_mfma_f32_32x32x16_bf16 v[128:143], a[200:203], v[0:3], 0
    s_lshl_b32 s40, s25, 18
    s_lshl_b32 s25, s4, 12
    s_add_u32 s39, s39, s25
    v_mfma_f32_32x32x16_bf16 v[192:207], a[200:203], v[4:7], 0
    s_add_u32 s40, s40, s25
    s_mov_b32 s38, 0x47800000
    s_sub_u32 s36, 0, s6
    s_sub_u32 s36, s36, 1
    v_mfma_f32_32x32x16_bf16 v[144:159], a[204:207], v[0:3], 0
    s_add_u32 m0, s31, 0
    s_add_u32 s24, s27, 0
    buffer_load_dwordx4 v245, s[12:15], s24 offen lds
    s_mov_b32 s26, 6
    s_mov_b32 s52, s41
    v_mfma_f32_32x32x16_bf16 v[208:223], a[204:207], v[4:7], 0
    buffer_store_dwordx4 v[64:67], v240, s[16:19], s80 offen sc1
    s_mov_b32 s53, s42
    s_mov_b32 s54, 0x700000
    s_add_u32 s48, s20, 0x1c00000
    s_addc_u32 s49, s21, 0
    s_waitcnt vmcnt(16) lgkmcnt(0)
    v_mfma_f32_32x32x16_bf16 v[96:111], a[208:211], v[8:11], v[96:111]
    ds_read_b64_tr_b16 a[192:193], v246 offset:8192
    ds_read_b64_tr_b16 a[194:195], v246 offset:9216
    s_mov_b32 s50, 0xe00000
    s_and_b32 s25, s3, 1
    s_lshl1_add_u32 s47, s4, s25
    v_mfma_f32_32x32x16_bf16 v[160:175], a[208:211], v[12:15], v[160:175]
    ds_read_b64_tr_b16 a[196:197], v246 offset:8448
    ds_read_b64_tr_b16 a[198:199], v246 offset:9472
    s_mul_i32 s45, s5, s5
    s_lshl_b32 s100, s47, 17
    v_mfma_f32_32x32x16_bf16 v[112:127], a[212:215], v[8:11], v[112:127]
    ds_read_b64_tr_b16 a[200:201], v246 offset:8704
    ds_read_b64_tr_b16 a[202:203], v246 offset:9728
    s_lshl_b32 s25, s45, 11
    s_add_u32 s100, s100, s25
    s_lshl_b32 s46, s47, 9
    v_mfma_f32_32x32x16_bf16 v[176:191], a[212:215], v[12:15], v[176:191]
    ds_read_b64_tr_b16 a[204:205], v246 offset:8960
    ds_read_b64_tr_b16 a[206:207], v246 offset:9984
    s_mul_i32 s44, s47, 114688
    s_add_u32 s47, s44, 7168
    s_lshl_b32 s25, s45, 7
    v_mfma_f32_32x32x16_bf16 v[128:143], a[216:219], v[8:11], v[128:143]
    buffer_load_dwordx4 v[0:3], v248, s[8:11], s28 offen offset:0 sc1
    s_add_u32 s44, s44, s25
    s_lshl_b32 s45, s45, 18
    s_add_u32 s46, s46, s45
    v_mfma_f32_32x32x16_bf16 v[192:207], a[216:219], v[12:15], v[192:207]
    buffer_load_dwordx4 v[4:7], v249, s[8:11], s28 offen offset:0 sc1
    s_lshr_b32 s25, s3, 1
    s_lshl_b32 s25, s25, 15
    s_add_u32 s46, s46, s25
    v_mfma_f32_32x32x16_bf16 v[144:159], a[220:223], v[8:11], v[144:159]
    s_add_u32 m0, s31, 1024
    s_add_u32 s24, s27, 32768
    buffer_load_dwordx4 v245, s[12:15], s24 offen lds
    s_mov_b32 s45, s43
    v_accvgpr_write_b32 a0, 0
    v_mfma_f32_32x32x16_bf16 v[208:223], a[220:223], v[12:15], v[208:223]
    buffer_store_dwordx4 v[68:71], v240, s[16:19], s81 offen sc1
    v_accvgpr_write_b32 a1, 0
    v_accvgpr_write_b32 a2, 0
    v_accvgpr_write_b32 a3, 0
    s_waitcnt vmcnt(18) lgkmcnt(0)
    v_mfma_f32_32x32x16_bf16 v[96:111], a[192:195], v[16:19], v[96:111]
    ds_read_b64_tr_b16 a[208:209], v246 offset:12288
    ds_read_b64_tr_b16 a[210:211], v246 offset:13312
    v_accvgpr_write_b32 a4, 0
    v_accvgpr_write_b32 a5, 0
    v_mfma_f32_32x32x16_bf16 v[160:175], a[192:195], v[20:23], v[160:175]
    ds_read_b64_tr_b16 a[212:213], v246 offset:12544
    ds_read_b64_tr_b16 a[214:215], v246 offset:13568
    v_accvgpr_write_b32 a6, 0
    v_accvgpr_write_b32 a7, 0
    v_accvgpr_write_b32 a8, 0
    v_mfma_f32_32x32x16_bf16 v[112:127], a[196:199], v[16:19], v[112:127]
    ds_read_b64_tr_b16 a[216:217], v246 offset:12800
    ds_read_b64_tr_b16 a[218:219], v246 offset:13824
    v_accvgpr_write_b32 a9, 0
    v_accvgpr_write_b32 a10, 0
    v_accvgpr_write_b32 a11, 0
    v_mfma_f32_32x32x16_bf16 v[176:191], a[196:199], v[20:23], v[176:191]
    ds_read_b64_tr_b16 a[220:221], v246 offset:13056
    ds_read_b64_tr_b16 a[222:223], v246 offset:14080
    v_accvgpr_write_b32 a12, 0
    v_accvgpr_write_b32 a13, 0
    v_mfma_f32_32x32x16_bf16 v[128:143], a[200:203], v[16:19], v[128:143]
    buffer_load_dwordx4 v[8:11], v248, s[8:11], s28 offen offset:1024 sc1
    v_accvgpr_write_b32 a14, 0
    v_accvgpr_write_b32 a15, 0
    v_accvgpr_write_b32 a16, 0
    v_accvgpr_write_b32 a17, 0
    v_mfma_f32_32x32x16_bf16 v[192:207], a[200:203], v[20:23], v[192:207]
    buffer_load_dwordx4 v[12:15], v249, s[8:11], s28 offen offset:1024 sc1
    v_accvgpr_write_b32 a18, 0
    v_accvgpr_write_b32 a19, 0
    v_accvgpr_write_b32 a20, 0
    v_mfma_f32_32x32x16_bf16 v[144:159], a[204:207], v[16:19], v[144:159]
    s_add_u32 m0, s31, 2048
    s_add_u32 s24, s27, 65536
    buffer_load_dwordx4 v245, s[12:15], s24 offen lds
    v_accvgpr_write_b32 a21, 0
    v_accvgpr_write_b32 a22, 0
    v_mfma_f32_32x32x16_bf16 v[208:223], a[204:207], v[20:23], v[208:223]
    buffer_store_dwordx4 v[72:75], v240, s[16:19], s82 offen sc1
    v_accvgpr_write_b32 a23, 0
    v_accvgpr_write_b32 a24, 0
    s_waitcnt vmcnt(20) lgkmcnt(0)
    v_mfma_f32_32x32x16_bf16 v[96:111], a[208:211], v[24:27], v[96:111]
    ds_read_b64_tr_b16 a[192:193], v246 offset:16384
    ds_read_b64_tr_b16 a[194:195], v246 offset:17408
    v_accvgpr_write_b32 a25, 0
    v_accvgpr_write_b32 a26, 0
    v_accvgpr_write_b32 a27, 0
    v_mfma_f32_32x32x16_bf16 v[160:175], a[208:211], v[28:31], v[160:175]
    ds_read_b64_tr_b16 a[196:197], v246 offset:16640
    ds_read_b64_tr_b16 a[198:199], v246 offset:17664
    v_accvgpr_write_b32 a28, 0
    v_accvgpr_write_b32 a29, 0
    v_accvgpr_write_b32 a30, 0
    v_mfma_f32_32x32x16_bf16 v[112:127], a[212:215], v[24:27], v[112:127]
    ds_read_b64_tr_b16 a[200:201], v246 offset:16896
    ds_read_b64_tr_b16 a[202:203], v246 offset:17920
    v_accvgpr_write_b32 a31, 0
    v_accvgpr_write_b32 a32, 0
    v_mfma_f32_32x32x16_bf16 v[176:191], a[212:215], v[28:31], v[176:191]
    ds_read_b64_tr_b16 a[204:205], v246 offset:17152
    ds_read_b64_tr_b16 a[206:207], v246 offset:18176
    v_accvgpr_write_b32 a33, 0
    v_accvgpr_write_b32 a34, 0
    v_accvgpr_write_b32 a35, 0
    v_mfma_f32_32x32x16_bf16 v[128:143], a[216:219], v[24:27], v[128:143]
    buffer_load_dwordx4 v[16:19], v248, s[8:11], s28 offen offset:2048 sc1
    v_accvgpr_write_b32 a36, 0
    v_accvgpr_write_b32 a37, 0
    v_accvgpr_write_b32 a38, 0
    v_mfma_f32_32x32x16_bf16 v[192:207], a[216:219], v[28:31], v[192:207]
    buffer_load_dwordx4 v[20:23], v249, s[8:11], s28 offen offset:2048 sc1
    v_accvgpr_write_b32 a39, 0
    v_accvgpr_write_b32 a40, 0
    v_accvgpr_write_b32 a41, 0
    v_accvgpr_write_b32 a42, 0
    v_mfma_f32_32x32x16_bf16 v[144:159], a[220:223], v[24:27], v[144:159]
    s_add_u32 m0, s31, 3072
    s_add_u32 s24, s27, 98304
    buffer_load_dwordx4 v245, s[12:15], s24 offen lds
    v_accvgpr_write_b32 a43, 0
    v_mfma_f32_32x32x16_bf16 v[208:223], a[220:223], v[28:31], v[208:223]
    buffer_store_dwordx4 v[76:79], v240, s[16:19], s83 offen sc1
    v_accvgpr_write_b32 a44, 0
    v_accvgpr_write_b32 a45, 0
    v_accvgpr_write_b32 a46, 0
    s_waitcnt vmcnt(21) lgkmcnt(0)
    v_mfma_f32_32x32x16_bf16 v[96:111], a[192:195], v[32:35], v[96:111]
    ds_read_b64_tr_b16 a[208:209], v246 offset:20480
    ds_read_b64_tr_b16 a[210:211], v246 offset:21504
    v_accvgpr_write_b32 a47, 0
    v_accvgpr_write_b32 a48, 0
    v_accvgpr_write_b32 a49, 0
    v_mfma_f32_32x32x16_bf16 v[160:175], a[192:195], v[36:39], v[160:175]
    ds_read_b64_tr_b16 a[212:213], v246 offset:20736
    ds_read_b64_tr_b16 a[214:215], v246 offset:21760
    v_accvgpr_write_b32 a50, 0
    v_accvgpr_write_b32 a51, 0
    v_mfma_f32_32x32x16_bf16 v[112:127], a[196:199], v[32:35], v[112:127]
    ds_read_b64_tr_b16 a[216:217], v246 offset:20992
    ds_read_b64_tr_b16 a[218:219], v246 offset:22016
    v_accvgpr_write_b32 a52, 0
    v_accvgpr_write_b32 a53, 0
    v_accvgpr_write_b32 a54, 0
    v_mfma_f32_32x32x16_bf16 v[176:191], a[196:199], v[36:39], v[176:191]
    ds_read_b64_tr_b16 a[220:221], v246 offset:21248
    ds_read_b64_tr_b16 a[222:223], v246 offset:22272
    v_accvgpr_write_b32 a55, 0
    v_accvgpr_write_b32 a56, 0
    v_accvgpr_write_b32 a57, 0
    v_mfma_f32_32x32x16_bf16 v[128:143], a[200:203], v[32:35], v[128:143]
    buffer_load_dwordx4 v[24:27], v248, s[8:11], s28 offen offset:3072 sc1
    v_accvgpr_write_b32 a58, 0
    v_accvgpr_write_b32 a59, 0
    v_accvgpr_write_b32 a60, 0
    v_mfma_f32_32x32x16_bf16 v[192:207], a[200:203], v[36:39], v[192:207]
    buffer_load_dwordx4 v[28:31], v249, s[8:11], s28 offen offset:3072 sc1
    v_accvgpr_write_b32 a61, 0
    v_accvgpr_write_b32 a62, 0
    v_accvgpr_write_b32 a63, 0
    v_mfma_f32_32x32x16_bf16 v[144:159], a[204:207], v[32:35], v[144:159]
    s_add_u32 m0, s31, 4096
    s_add_u32 s24, s27, 131072
    buffer_load_dwordx4 v245, s[12:15], s24 offen lds
    v_accvgpr_write_b32 a64, 0
    v_accvgpr_write_b32 a65, 0
    v_mfma_f32_32x32x16_bf16 v[208:223], a[204:207], v[36:39], v[208:223]
    buffer_store_dwordx4 v[80:83], v240, s[16:19], s84 offen sc1
    v_accvgpr_write_b32 a66, 0
    v_accvgpr_write_b32 a67, 0
    v_accvgpr_write_b32 a68, 0
    s_waitcnt vmcnt(23) lgkmcnt(0)
    v_mfma_f32_32x32x16_bf16 v[96:111], a[208:211], v[40:43], v[96:111]
    ds_read_b64_tr_b16 a[192:193], v246 offset:24576
    ds_read_b64_tr_b16 a[194:195], v246 offset:25600
    v_accvgpr_write_b32 a69, 0
    v_accvgpr_write_b32 a70, 0
    v_mfma_f32_32x32x16_bf16 v[160:175], a[208:211], v[44:47], v[160:175]
    ds_read_b64_tr_b16 a[196:197], v246 offset:24832
    ds_read_b64_tr_b16 a[198:199], v246 offset:25856
    v_accvgpr_write_b32 a71, 0
    v_accvgpr_write_b32 a72, 0
    v_accvgpr_write_b32 a73, 0
    v_mfma_f32_32x32x16_bf16 v[112:127], a[212:215], v[40:43], v[112:127]
    ds_read_b64_tr_b16 a[200:201], v246 offset:25088
    ds_read_b64_tr_b16 a[202:203], v246 offset:26112
    v_accvgpr_write_b32 a74, 0
    v_accvgpr_write_b32 a75, 0
    v_accvgpr_write_b32 a76, 0
    v_mfma_f32_32x32x16_bf16 v[176:191], a[212:215], v[44:47], v[176:191]
    ds_read_b64_tr_b16 a[204:205], v246 offset:25344
    ds_read_b64_tr_b16 a[206:207], v246 offset:26368
    v_accvgpr_write_b32 a77, 0
    v_accvgpr_write_b32 a78, 0
    v_mfma_f32_32x32x16_bf16 v[128:143], a[216:219], v[40:43], v[128:143]
    buffer_load_dwordx4 v[32:35], v248, s[8:11], s29 offen offset:0 sc1
    v_accvgpr_write_b32 a79, 0
    v_accvgpr_write_b32 a80, 0
    v_accvgpr_write_b32 a81, 0
    v_accvgpr_write_b32 a82, 0
    v_mfma_f32_32x32x16_bf16 v[192:207], a[216:219], v[44:47], v[192:207]
    buffer_load_dwordx4 v[36:39], v249, s[8:11], s29 offen offset:0 sc1
    v_accvgpr_write_b32 a83, 0
    v_accvgpr_write_b32 a84, 0
    v_accvgpr_write_b32 a85, 0
    v_mfma_f32_32x32x16_bf16 v[144:159], a[220:223], v[40:43], v[144:159]
    s_add_u32 m0, s31, 5120
    s_add_u32 s24, s27, 163840
    buffer_load_dwordx4 v245, s[12:15], s24 offen lds
    v_accvgpr_write_b32 a86, 0
    v_accvgpr_write_b32 a87, 0
    v_mfma_f32_32x32x16_bf16 v[208:223], a[220:223], v[44:47], v[208:223]
    buffer_store_dwordx4 v[84:87], v240, s[16:19], s85 offen sc1
    v_accvgpr_write_b32 a88, 0
    v_accvgpr_write_b32 a89, 0
    v_accvgpr_write_b32 a90, 0
    s_waitcnt vmcnt(25) lgkmcnt(0)
    v_mfma_f32_32x32x16_bf16 v[96:111], a[192:195], v[48:51], v[96:111]
    ds_read_b64_tr_b16 a[208:209], v246 offset:28672
    ds_read_b64_tr_b16 a[210:211], v246 offset:29696
    v_accvgpr_write_b32 a91, 0
    v_accvgpr_write_b32 a92, 0
    v_mfma_f32_32x32x16_bf16 v[160:175], a[192:195], v[52:55], v[160:175]
    ds_read_b64_tr_b16 a[212:213], v246 offset:28928
    ds_read_b64_tr_b16 a[214:215], v246 offset:29952
    v_accvgpr_write_b32 a93, 0
    v_accvgpr_write_b32 a94, 0
    v_accvgpr_write_b32 a95, 0
    v_mfma_f32_32x32x16_bf16 v[112:127], a[196:199], v[48:51], v[112:127]
    ds_read_b64_tr_b16 a[216:217], v246 offset:29184
    ds_read_b64_tr_b16 a[218:219], v246 offset:30208
    v_accvgpr_write_b32 a96, 0
    v_accvgpr_write_b32 a97, 0
    v_mfma_f32_32x32x16_bf16 v[176:191], a[196:199], v[52:55], v[176:191]
    ds_read_b64_tr_b16 a[220:221], v246 offset:29440
    ds_read_b64_tr_b16 a[222:223], v246 offset:30464
    v_accvgpr_write_b32 a98, 0
    v_accvgpr_write_b32 a99, 0
    v_accvgpr_write_b32 a100, 0
    v_mfma_f32_32x32x16_bf16 v[128:143], a[200:203], v[48:51], v[128:143]
    buffer_load_dwordx4 v[40:43], v248, s[8:11], s29 offen offset:1024 sc1
    v_accvgpr_write_b32 a101, 0
    v_accvgpr_write_b32 a102, 0
    v_accvgpr_write_b32 a103, 0
    v_mfma_f32_32x32x16_bf16 v[192:207], a[200:203], v[52:55], v[192:207]
    buffer_load_dwordx4 v[44:47], v249, s[8:11], s29 offen offset:1024 sc1
    v_accvgpr_write_b32 a104, 0
    v_accvgpr_write_b32 a105, 0
    v_accvgpr_write_b32 a106, 0
    v_accvgpr_write_b32 a107, 0
    v_mfma_f32_32x32x16_bf16 v[144:159], a[204:207], v[48:51], v[144:159]
    s_add_u32 m0, s31, 6144
    s_add_u32 s24, s27, 196608
    buffer_load_dwordx4 v245, s[12:15], s24 offen lds
    v_accvgpr_write_b32 a108, 0
    v_accvgpr_write_b32 a109, 0
    v_mfma_f32_32x32x16_bf16 v[208:223], a[204:207], v[52:55], v[208:223]
    buffer_store_dwordx4 v[88:91], v240, s[16:19], s86 offen sc1
    s_waitcnt vmcnt(27) lgkmcnt(0)
    s_barrier
    s_add_u32 s30, s30, 32768
    s_cmp_ge_u32 s30, 163840
    s_cselect_b32 s24, 98304, 0
    s_sub_u32 s30, s30, s24
    v_add_u32 v246, s30, v247
    v_mfma_f32_32x32x16_bf16 v[96:111], a[208:211], v[56:59], v[96:111]
    ds_read_b64_tr_b16 a[192:193], v246 offset:0
    ds_read_b64_tr_b16 a[194:195], v246 offset:1024
    v_accvgpr_write_b32 a110, 0
    v_accvgpr_write_b32 a111, 0
    v_mfma_f32_32x32x16_bf16 v[160:175], a[208:211], v[60:63], v[160:175]
    ds_read_b64_tr_b16 a[196:197], v246 offset:256
    ds_read_b64_tr_b16 a[198:199], v246 offset:1280
    v_accvgpr_write_b32 a112, 0
    v_accvgpr_write_b32 a113, 0
    v_accvgpr_write_b32 a114, 0
    v_mfma_f32_32x32x16_bf16 v[112:127], a[212:215], v[56:59], v[112:127]
    ds_read_b64_tr_b16 a[200:201], v246 offset:512
    ds_read_b64_tr_b16 a[202:203], v246 offset:1536
    v_accvgpr_write_b32 a115, 0
    v_accvgpr_write_b32 a116, 0
    v_mfma_f32_32x32x16_bf16 v[176:191], a[212:215], v[60:63], v[176:191]
    ds_read_b64_tr_b16 a[204:205], v246 offset:768
    ds_read_b64_tr_b16 a[206:207], v246 offset:1792
    buffer_store_dwordx4 v[92:95], v240, s[16:19], s87 offen sc1
    v_accvgpr_write_b32 a117, 0
    v_accvgpr_write_b32 a118, 0
    v_mfma_f32_32x32x16_bf16 v[128:143], a[216:219], v[56:59], v[128:143]
    buffer_load_dwordx4 v[48:51], v248, s[8:11], s29 offen offset:2048 sc1
    v_accvgpr_write_b32 a119, 0
    v_accvgpr_write_b32 a120, 0
    v_accvgpr_write_b32 a121, 0
    v_accvgpr_write_b32 a122, 0
    v_mfma_f32_32x32x16_bf16 v[192:207], a[216:219], v[60:63], v[192:207]
    buffer_load_dwordx4 v[52:55], v249, s[8:11], s29 offen offset:2048 sc1
    v_accvgpr_write_b32 a123, 0
    v_accvgpr_write_b32 a124, 0
    v_accvgpr_write_b32 a125, 0
    v_mfma_f32_32x32x16_bf16 v[144:159], a[220:223], v[56:59], v[144:159]
    s_add_u32 m0, s31, 7168
    s_add_u32 s24, s27, 229376
    buffer_load_dwordx4 v245, s[12:15], s24 offen lds
    v_accvgpr_write_b32 a126, 0
    v_accvgpr_write_b32 a127, 0
    v_mfma_f32_32x32x16_bf16 v[208:223], a[220:223], v[60:63], v[208:223]
    buffer_load_dwordx4 v[56:59], v248, s[8:11], s29 offen offset:3072 sc1
    buffer_load_dwordx4 v[60:63], v249, s[8:11], s29 offen offset:3072 sc1
    s_add_u32 s28, s28, 8192
    s_and_b32 s28, s28, 65535
    s_add_u32 s29, s28, 4096
    s_add_u32 s27, s27, 1048576
    s_and_b32 s27, s27, 0x407fffff
    s_cmp_eq_u32 s27, s7
    s_cselect_b32 s27, s43, s27
    s_add_u32 s31, s31, 32768
    s_cmp_ge_u32 s31, 163840
    s_cselect_b32 s24, 98304, 0
    s_sub_u32 s31, s31, s24
.p2align 3
ka_qp:
    s_waitcnt vmcnt(22) lgkmcnt(0)
    v_mfma_f32_32x32x16_bf16 v[96:111], a[192:195], v[0:3], v[96:111]
    ds_read_b64_tr_b16 a[208:209], v246 offset:4096
    ds_read_b64_tr_b16 a[210:211], v246 offset:5120
    v_mfma_f32_32x32x16_bf16 v[160:175], a[192:195], v[4:7], v[160:175]
    ds_read_b64_tr_b16 a[212:213], v246 offset:4352
    ds_read_b64_tr_b16 a[214:215], v246 offset:5376
    v_mfma_f32_32x32x16_bf16 v[112:127], a[196:199], v[0:3], v[112:127]
    ds_read_b64_tr_b16 a[216:217], v246 offset:4608
    ds_read_b64_tr_b16 a[218:219], v246 offset:5632
    v_mfma_f32_32x32x16_bf16 v[176:191], a[196:199], v[4:7], v[176:191]
    ds_read_b64_tr_b16 a[220:221], v246 offset:4864
    ds_read_b64_tr_b16 a[222:223], v246 offset:5888
    v_mfma_f32_32x32x16_bf16 v[128:143], a[200:203], v[0:3], v[128:143]
    s_cmp_eq_u32 s26, 1
    s_cselect_b32 s41, s35, s43
    buffer_load_dword v254, off, s[88:91], s41 sc1
    v_mfma_f32_32x32x16_bf16 v[192:207], a[200:203], v[4:7], v[192:207]
    v_mfma_f32_32x32x16_bf16 v[144:159], a[204:207], v[0:3], v[144:159]
    s_add_u32 m0, s31, 0
    s_add_u32 s24, s27, 0
    buffer_load_dwordx4 v245, s[12:15], s24 offen lds
    v_mfma_f32_32x32x16_bf16 v[208:223], a[204:207], v[4:7], v[208:223]
    s_waitcnt vmcnt(21) lgkmcnt(0)
    v_mfma_f32_32x32x16_bf16 v[96:111], a[208:211], v[8:11], v[96:111]
    ds_read_b64_tr_b16 a[192:193], v246 offset:8192
    ds_read_b64_tr_b16 a[194:195], v246 offset:9216
    v_mfma_f32_32x32x16_bf16 v[160:175], a[208:211], v[12:15], v[160:175]
    ds_read_b64_tr_b16 a[196:197], v246 offset:8448
    ds_read_b64_tr_b16 a[198:199], v246 offset:9472
    v_mfma_f32_32x32x16_bf16 v[112:127], a[212:215], v[8:11], v[112:127]
    ds_read_b64_tr_b16 a[200:201], v246 offset:8704
    ds_read_b64_tr_b16 a[202:203], v246 offset:9728
    v_mfma_f32_32x32x16_bf16 v[176:191], a[212:215], v[12:15], v[176:191]
    ds_read_b64_tr_b16 a[204:205], v246 offset:8960
    ds_read_b64_tr_b16 a[206:207], v246 offset:9984
    v_mfma_f32_32x32x16_bf16 v[128:143], a[216:219], v[8:11], v[128:143]
    buffer_load_dwordx4 v[0:3], v248, s[8:11], s28 offen offset:0 sc1
    v_mfma_f32_32x32x16_bf16 v[192:207], a[216:219], v[12:15], v[192:207]
    buffer_load_dwordx4 v[4:7], v249, s[8:11], s28 offen offset:0 sc1
    v_mfma_f32_32x32x16_bf16 v[144:159], a[220:223], v[8:11], v[144:159]
    s_add_u32 m0, s31, 1024
    s_add_u32 s24, s27, 32768
    buffer_load_dwordx4 v245, s[12:15], s24 offen lds
    v_mfma_f32_32x32x16_bf16 v[208:223], a[220:223], v[12:15], v[208:223]
    s_waitcnt vmcnt(21) lgkmcnt(0)
    v_mfma_f32_32x32x16_bf16 v[96:111], a[192:195], v[16:19], v[96:111]
    ds_read_b64_tr_b16 a[208:209], v246 offset:12288
    ds_read_b64_tr_b16 a[210:211], v246 offset:13312
    v_mfma_f32_32x32x16_bf16 v[160:175], a[192:195], v[20:23], v[160:175]
    ds_read_b64_tr_b16 a[212:213], v246 offset:12544
    ds_read_b64_tr_b16 a[214:215], v246 offset:13568
    v_mfma_f32_32x32x16_bf16 v[112:127], a[196:199], v[16:19], v[112:127]
    ds_read_b64_tr_b16 a[216:217], v246 offset:12800
    ds_read_b64_tr_b16 a[218:219], v246 offset:13824
    v_mfma_f32_32x32x16_bf16 v[176:191], a[196:199], v[20:23], v[176:191]
    ds_read_b64_tr_b16 a[220:221], v246 offset:13056
    ds_read_b64_tr_b16 a[222:223], v246 offset:14080
    v_mfma_f32_32x32x16_bf16 v[128:143], a[200:203], v[16:19], v[128:143]
    buffer_load_dwordx4 v[8:11], v248, s[8:11], s28 offen offset:1024 sc1
    v_mfma_f32_32x32x16_bf16 v[192:207], a[200:203], v[20:23], v[192:207]
    buffer_load_dwordx4 v[12:15], v249, s[8:11], s28 offen offset:1024 sc1
    v_mfma_f32_32x32x16_bf16 v[144:159], a[204:207], v[16:19], v[144:159]
    s_add_u32 m0, s31, 2048
    s_add_u32 s24, s27, 65536
    buffer_load_dwordx4 v245, s[12:15], s24 offen lds
    v_mfma_f32_32x32x16_bf16 v[208:223], a[204:207], v[20:23], v[208:223]
    s_waitcnt vmcnt(21) lgkmcnt(0)
    v_mfma_f32_32x32x16_bf16 v[96:111], a[208:211], v[24:27], v[96:111]
    ds_read_b64_tr_b16 a[192:193], v246 offset:16384
    ds_read_b64_tr_b16 a[194:195], v246 offset:17408
    v_mfma_f32_32x32x16_bf16 v[160:175], a[208:211], v[28:31], v[160:175]
    ds_read_b64_tr_b16 a[196:197], v246 offset:16640
    ds_read_b64_tr_b16 a[198:199], v246 offset:17664
    v_mfma_f32_32x32x16_bf16 v[112:127], a[212:215], v[24:27], v[112:127]
    ds_read_b64_tr_b16 a[200:201], v246 offset:16896
    ds_read_b64_tr_b16 a[202:203], v246 offset:17920
    v_mfma_f32_32x32x16_bf16 v[176:191], a[212:215], v[28:31], v[176:191]
    ds_read_b64_tr_b16 a[204:205], v246 offset:17152
    ds_read_b64_tr_b16 a[206:207], v246 offset:18176
    v_mfma_f32_32x32x16_bf16 v[128:143], a[216:219], v[24:27], v[128:143]
    buffer_load_dwordx4 v[16:19], v248, s[8:11], s28 offen offset:2048 sc1
    v_mfma_f32_32x32x16_bf16 v[192:207], a[216:219], v[28:31], v[192:207]
    buffer_load_dwordx4 v[20:23], v249, s[8:11], s28 offen offset:2048 sc1
    v_mfma_f32_32x32x16_bf16 v[144:159], a[220:223], v[24:27], v[144:159]
    s_add_u32 m0, s31, 3072
    s_add_u32 s24, s27, 98304
    buffer_load_dwordx4 v245, s[12:15], s24 offen lds
    v_mfma_f32_32x32x16_bf16 v[208:223], a[220:223], v[28:31], v[208:223]
    s_waitcnt vmcnt(21) lgkmcnt(0)
    v_mfma_f32_32x32x16_bf16 v[96:111], a[192:195], v[32:35], v[96:111]
    ds_read_b64_tr_b16 a[208:209], v246 offset:20480
    ds_read_b64_tr_b16 a[210:211], v246 offset:21504
    v_mfma_f32_32x32x16_bf16 v[160:175], a[192:195], v[36:39], v[160:175]
    ds_read_b64_tr_b16 a[212:213], v246 offset:20736
    ds_read_b64_tr_b16 a[214:215], v246 offset:21760
    v_mfma_f32_32x32x16_bf16 v[112:127], a[196:199], v[32:35], v[112:127]
    ds_read_b64_tr_b16 a[216:217], v246 offset:20992
    ds_read_b64_tr_b16 a[218:219], v246 offset:22016
    v_mfma_f32_32x32x16_bf16 v[176:191], a[196:199], v[36:39], v[176:191]
    ds_read_b64_tr_b16 a[220:221], v246 offset:21248
    ds_read_b64_tr_b16 a[222:223], v246 offset:22272
    v_mfma_f32_32x32x16_bf16 v[128:143], a[200:203], v[32:35], v[128:143]
    buffer_load_dwordx4 v[24:27], v248, s[8:11], s28 offen offset:3072 sc1
    v_mfma_f32_32x32x16_bf16 v[192:207], a[200:203], v[36:39], v[192:207]
    buffer_load_dwordx4 v[28:31], v249, s[8:11], s28 offen offset:3072 sc1
    v_mfma_f32_32x32x16_bf16 v[144:159], a[204:207], v[32:35], v[144:159]
    s_add_u32 m0, s31, 4096
    s_add_u32 s24, s27, 131072
    buffer_load_dwordx4 v245, s[12:15], s24 offen lds
    v_mfma_f32_32x32x16_bf16 v[208:223], a[204:207], v[36:39], v[208:223]
    s_waitcnt vmcnt(21) lgkmcnt(0)
    v_mfma_f32_32x32x16_bf16 v[96:111], a[208:211], v[40:43], v[96:111]
    ds_read_b64_tr_b16 a[192:193], v246 offset:24576
    ds_read_b64_tr_b16 a[194:195], v246 offset:25600
    v_mfma_f32_32x32x16_bf16 v[160:175], a[208:211], v[44:47], v[160:175]
    ds_read_b64_tr_b16 a[196:197], v246 offset:24832
    ds_read_b64_tr_b16 a[198:199], v246 offset:25856
    v_mfma_f32_32x32x16_bf16 v[112:127], a[212:215], v[40:43], v[112:127]
    ds_read_b64_tr_b16 a[200:201], v246 offset:25088
    ds_read_b64_tr_b16 a[202:203], v246 offset:26112
    v_mfma_f32_32x32x16_bf16 v[176:191], a[212:215], v[44:47], v[176:191]
    ds_read_b64_tr_b16 a[204:205], v246 offset:25344
    ds_read_b64_tr_b16 a[206:207], v246 offset:26368
    v_mfma_f32_32x32x16_bf16 v[128:143], a[216:219], v[40:43], v[128:143]
    buffer_load_dwordx4 v[32:35], v248, s[8:11], s29 offen offset:0 sc1
    v_mfma_f32_32x32x16_bf16 v[192:207], a[216:219], v[44:47], v[192:207]
    buffer_load_dwordx4 v[36:39], v249, s[8:11], s29 offen offset:0 sc1
    v_mfma_f32_32x32x16_bf16 v[144:159], a[220:223], v[40:43], v[144:159]
    s_add_u32 m0, s31, 5120
    s_add_u32 s24, s27, 163840
    buffer_load_dwordx4 v245, s[12:15], s24 offen lds
    v_mfma_f32_32x32x16_bf16 v[208:223], a[220:223], v[44:47], v[208:223]
    s_waitcnt vmcnt(20) lgkmcnt(0)
    v_mfma_f32_32x32x16_bf16 v[96:111], a[192:195], v[48:51], v[96:111]
    ds_read_b64_tr_b16 a[208:209], v246 offset:28672
    ds_read_b64_tr_b16 a[210:211], v246 offset:29696
    v_mfma_f32_32x32x16_bf16 v[160:175], a[192:195], v[52:55], v[160:175]
    ds_read_b64_tr_b16 a[212:213], v246 offset:28928
    ds_read_b64_tr_b16 a[214:215], v246 offset:29952
    v_mfma_f32_32x32x16_bf16 v[112:127], a[196:199], v[48:51], v[112:127]
    ds_read_b64_tr_b16 a[216:217], v246 offset:29184
    ds_read_b64_tr_b16 a[218:219], v246 offset:30208
    v_mfma_f32_32x32x16_bf16 v[176:191], a[196:199], v[52:55], v[176:191]
    ds_read_b64_tr_b16 a[220:221], v246 offset:29440
    ds_read_b64_tr_b16 a[222:223], v246 offset:30464
    v_mfma_f32_32x32x16_bf16 v[128:143], a[200:203], v[48:51], v[128:143]
    buffer_load_dwordx4 v[40:43], v248, s[8:11], s29 offen offset:1024 sc1
    v_mfma_f32_32x32x16_bf16 v[192:207], a[200:203], v[52:55], v[192:207]
    buffer_load_dwordx4 v[44:47], v249, s[8:11], s29 offen offset:1024 sc1
    v_mfma_f32_32x32x16_bf16 v[144:159], a[204:207], v[48:51], v[144:159]
    s_add_u32 m0, s31, 6144
    s_add_u32 s24, s27, 196608
    buffer_load_dwordx4 v245, s[12:15], s24 offen lds
    v_mfma_f32_32x32x16_bf16 v[208:223], a[204:207], v[52:55], v[208:223]
    s_cmp_eq_u32 s26, 1
    s_cbranch_scc0 ka_nopk
    s_waitcnt vmcnt(19)
    v_readfirstlane_b32 s24, v254
    s_lshl_b32 s25, s3, 16
    s_add_u32 s24, s24, s25
    s_cmp_ge_u32 s24, 8
    s_cbranch_scc0 ka_spin45
ka_spinr46:
ka_nopk:
    s_waitcnt vmcnt(20) lgkmcnt(0)
    s_barrier
    s_add_u32 s30, s30, 32768
    s_cmp_ge_u32 s30, 163840
    s_cselect_b32 s24, 98304, 0
    s_sub_u32 s30, s30, s24
    v_add_u32 v246, s30, v247
    v_mfma_f32_32x32x16_bf16 v[96:111], a[208:211], v[56:59], v[96:111]
    ds_read_b64_tr_b16 a[192:193], v246 offset:0
    ds_read_b64_tr_b16 a[194:195], v246 offset:1024
    v_mfma_f32_32x32x16_bf16 v[160:175], a[208:211], v[60:63], v[160:175]
    ds_read_b64_tr_b16 a[196:197], v246 offset:256
    ds_read_b64_tr_b16 a[198:199], v246 offset:1280
    v_mfma_f32_32x32x16_bf16 v[112:127], a[212:215], v[56:59], v[112:127]
    ds_read_b64_tr_b16 a[200:201], v246 offset:512
    ds_read_b64_tr_b16 a[202:203], v246 offset:1536
    v_mfma_f32_32x32x16_bf16 v[176:191], a[212:215], v[60:63], v[176:191]
    ds_read_b64_tr_b16 a[204:205], v246 offset:768
    ds_read_b64_tr_b16 a[206:207], v246 offset:1792
    buffer_atomic_add v255, v250, s[88:91], s97 offen sc1
    s_mov_b32 s97, s43
    v_mfma_f32_32x32x16_bf16 v[128:143], a[216:219], v[56:59], v[128:143]
    buffer_load_dwordx4 v[48:51], v248, s[8:11], s29 offen offset:2048 sc1
    v_mfma_f32_32x32x16_bf16 v[192:207], a[216:219], v[60:63], v[192:207]
    buffer_load_dwordx4 v[52:55], v249, s[8:11], s29 offen offset:2048 sc1
    v_mfma_f32_32x32x16_bf16 v[144:159], a[220:223], v[56:59], v[144:159]
    s_add_u32 m0, s31, 7168
    s_add_u32 s24, s27, 229376
    buffer_load_dwordx4 v245, s[12:15], s24 offen lds
    v_mfma_f32_32x32x16_bf16 v[208:223], a[220:223], v[60:63], v[208:223]
    buffer_load_dwordx4 v[56:59], v248, s[8:11], s29 offen offset:3072 sc1
    buffer_load_dwordx4 v[60:63], v249, s[8:11], s29 offen offset:3072 sc1
    s_add_u32 s28, s28, 8192
    s_and_b32 s28, s28, 65535
    s_add_u32 s29, s28, 4096
    s_add_u32 s27, s27, 1048576
    s_and_b32 s27, s27, 0x407fffff
    s_cmp_eq_u32 s27, s7
    s_cselect_b32 s27, s43, s27
    s_add_u32 s31, s31, 32768
    s_cmp_ge_u32 s31, 163840
    s_cselect_b32 s24, 98304, 0
    s_sub_u32 s31, s31, s24
    s_sub_u32 s26, s26, 1
    s_cmp_lg_u32 s26, 0
    s_cbranch_scc1 ka_qp
    s_waitcnt vmcnt(22) lgkmcnt(0)
    v_mfma_f32_32x32x16_bf16 v[96:111], a[192:195], v[0:3], v[96:111]
    ds_read_b64_tr_b16 a[208:209], v246 offset:4096
    ds_read_b64_tr_b16 a[210:211], v246 offset:5120
    v_mfma_f32_32x32x16_bf16 v[160:175], a[192:195], v[4:7], v[160:175]
    ds_read_b64_tr_b16 a[212:213], v246 offset:4352
    ds_read_b64_tr_b16 a[214:215], v246 offset:5376
    s_cmp_lt_u32 s32, s33
    s_cselect_b32 s41, s32, s43
    s_mov_b32 m0, s34
    s_nop 0
    v_mfma_f32_32x32x16_bf16 v[112:127], a[196:199], v[0:3], v[112:127]
    ds_read_b64_tr_b16 a[216:217], v246 offset:4608
    ds_read_b64_tr_b16 a[218:219], v246 offset:5632
    buffer_load_dwordx4 v242, s[16:19], s41 offen offset:0 sc1 lds
    v_mfma_f32_32x32x16_bf16 v[176:191], a[196:199], v[4:7], v[176:191]
    ds_read_b64_tr_b16 a[220:221], v246 offset:4864
    ds_read_b64_tr_b16 a[222:223], v246 offset:5888
    buffer_load_dwordx4 v242, s[16:19], s41 offen offset:1024 sc1 lds
    v_mfma_f32_32x32x16_bf16 v[128:143], a[200:203], v[0:3], v[128:143]
    v_mfma_f32_32x32x16_bf16 v[192:207], a[200:203], v[4:7], v[192:207]
    buffer_load_dwordx4 v242, s[16:19], s41 offen offset:2048 sc1 lds
    v_mfma_f32_32x32x16_bf16 v[144:159], a[204:207], v[0:3], v[144:159]
    buffer_load_dwordx4 v242, s[16:19], s41 offen offset:3072 sc1 lds
    v_mfma_f32_32x32x16_bf16 v[208:223], a[204:207], v[4:7], v[208:223]
    s_waitcnt vmcnt(23) lgkmcnt(0)
    v_mfma_f32_32x32x16_bf16 v[96:111], a[208:211], v[8:11], v[96:111]
    ds_read_b64_tr_b16 a[192:193], v246 offset:8192
    ds_read_b64_tr_b16 a[194:195], v246 offset:9216
    s_add_u32 s32, s32, 32768
    s_add_u32 s34, s34, 32768
    s_cmp_ge_u32 s34, 163840
    s_cselect_b32 s24, 163840, 0
    s_sub_u32 s34, s34, s24
    v_mfma_f32_32x32x16_bf16 v[160:175], a[208:211], v[12:15], v[160:175]
    ds_read_b64_tr_b16 a[196:197], v246 offset:8448
    ds_read_b64_tr_b16 a[198:199], v246 offset:9472
    s_cmp_lt_u32 s32, s33
    s_cselect_b32 s41, s32, s43
    s_mov_b32 m0, s34
    s_nop 0
    v_mfma_f32_32x32x16_bf16 v[112:127], a[212:215], v[8:11], v[112:127]
    ds_read_b64_tr_b16 a[200:201], v246 offset:8704
    ds_read_b64_tr_b16 a[202:203], v246 offset:9728
    v_mfma_f32_32x32x16_bf16 v[176:191], a[212:215], v[12:15], v[176:191]
    ds_read_b64_tr_b16 a[204:205], v246 offset:8960
    ds_read_b64_tr_b16 a[206:207], v246 offset:9984
    buffer_load_dwordx4 v242, s[16:19], s41 offen offset:0 sc1 lds
    v_mfma_f32_32x32x16_bf16 v[128:143], a[216:219], v[8:11], v[128:143]
    buffer_load_dwordx4 v242, s[16:19], s41 offen offset:1024 sc1 lds
    v_mfma_f32_32x32x16_bf16 v[192:207], a[216:219], v[12:15], v[192:207]
    buffer_load_dwordx4 v242, s[16:19], s41 offen offset:2048 sc1 lds
    v_mfma_f32_32x32x16_bf16 v[144:159], a[220:223], v[8:11], v[144:159]
    v_mfma_f32_32x32x16_bf16 v[208:223], a[220:223], v[12:15], v[208:223]
    buffer_load_dwordx4 v242, s[16:19], s41 offen offset:3072 sc1 lds
    s_waitcnt vmcnt(24) lgkmcnt(0)
    v_mfma_f32_32x32x16_bf16 v[96:111], a[192:195], v[16:19], v[96:111]
    ds_read_b64_tr_b16 a[208:209], v246 offset:12288
    ds_read_b64_tr_b16 a[210:211], v246 offset:13312
    s_sub_u32 s42, s32, 16384
    s_cmp_lt_u32 s42, s33
    s_cselect_b32 s42, s42, s43
    s_add_u32 m0, s34, 16384
    s_nop 0
    v_mfma_f32_32x32x16_bf16 v[160:175], a[192:195], v[20:23], v[160:175]
    ds_read_b64_tr_b16 a[212:213], v246 offset:12544
    ds_read_b64_tr_b16 a[214:215], v246 offset:13568
    v_mfma_f32_32x32x16_bf16 v[112:127], a[196:199], v[16:19], v[112:127]
    ds_read_b64_tr_b16 a[216:217], v246 offset:12800
    ds_read_b64_tr_b16 a[218:219], v246 offset:13824
    buffer_load_dwordx4 v242, s[16:19], s42 offen offset:0 sc1 lds
    v_mfma_f32_32x32x16_bf16 v[176:191], a[196:199], v[20:23], v[176:191]
    ds_read_b64_tr_b16 a[220:221], v246 offset:13056
    ds_read_b64_tr_b16 a[222:223], v246 offset:14080
    buffer_load_dwordx4 v242, s[16:19], s42 offen offset:1024 sc1 lds
    v_mfma_f32_32x32x16_bf16 v[128:143], a[200:203], v[16:19], v[128:143]
    v_mfma_f32_32x32x16_bf16 v[192:207], a[200:203], v[20:23], v[192:207]
    buffer_load_dwordx4 v242, s[16:19], s42 offen offset:2048 sc1 lds
    v_mfma_f32_32x32x16_bf16 v[144:159], a[204:207], v[16:19], v[144:159]
    buffer_load_dwordx4 v242, s[16:19], s42 offen offset:3072 sc1 lds
    v_mfma_f32_32x32x16_bf16 v[208:223], a[204:207], v[20:23], v[208:223]
    s_add_u32 s32, s32, 32768
    s_add_u32 s34, s34, 32768
    s_cmp_ge_u32 s34, 163840
    s_cselect_b32 s24, 163840, 0
    s_sub_u32 s34, s34, s24
    s_waitcnt vmcnt(25) lgkmcnt(0)
    v_mfma_f32_32x32x16_bf16 v[96:111], a[208:211], v[24:27], v[96:111]
    ds_read_b64_tr_b16 a[192:193], v246 offset:16384
    ds_read_b64_tr_b16 a[194:195], v246 offset:17408
    v_mfma_f32_32x32x16_bf16 v[160:175], a[208:211], v[28:31], v[160:175]
    ds_read_b64_tr_b16 a[196:197], v246 offset:16640
    ds_read_b64_tr_b16 a[198:199], v246 offset:17664
    s_cmp_lt_u32 s32, s33
    s_cselect_b32 s41, s32, s43
    s_mov_b32 m0, s34
    s_nop 0
    v_mfma_f32_32x32x16_bf16 v[112:127], a[212:215], v[24:27], v[112:127]
    ds_read_b64_tr_b16 a[200:201], v246 offset:16896
    ds_read_b64_tr_b16 a[202:203], v246 offset:17920
    buffer_load_dwordx4 v242, s[16:19], s41 offen offset:0 sc1 lds
    v_mfma_f32_32x32x16_bf16 v[176:191], a[212:215], v[28:31], v[176:191]
    ds_read_b64_tr_b16 a[204:205], v246 offset:17152
    ds_read_b64_tr_b16 a[206:207], v246 offset:18176
    v_mfma_f32_32x32x16_bf16 v[128:143], a[216:219], v[24:27], v[128:143]
    buffer_load_dwordx4 v242, s[16:19], s41 offen offset:1024 sc1 lds
    v_mfma_f32_32x32x16_bf16 v[192:207], a[216:219], v[28:31], v[192:207]
    buffer_load_dwordx4 v242, s[16:19], s41 offen offset:2048 sc1 lds
    v_mfma_f32_32x32x16_bf16 v[144:159], a[220:223], v[24:27], v[144:159]
    v_mov_b32 v241, v239
    v_lshrrev_b32 v230, 7, v240
    v_mul_u32_u24 v253, 7168, v230
    v_mfma_f32_32x32x16_bf16 v[208:223], a[220:223], v[28:31], v[208:223]
    buffer_load_dwordx4 v242, s[16:19], s41 offen offset:3072 sc1 lds
    v_and_b32 v231, 0x70, v240
    s_waitcnt vmcnt(26) lgkmcnt(0)
    v_mfma_f32_32x32x16_bf16 v[96:111], a[192:195], v[32:35], v[96:111]
    ds_read_b64_tr_b16 a[208:209], v246 offset:20480
    ds_read_b64_tr_b16 a[210:211], v246 offset:21504
    s_sub_u32 s42, s32, 16384
    s_cmp_lt_u32 s42, s33
    s_cselect_b32 s42, s42, s43
    s_add_u32 m0, s34, 16384
    s_nop 0
    v_mfma_f32_32x32x16_bf16 v[160:175], a[192:195], v[36:39], v[160:175]
    ds_read_b64_tr_b16 a[212:213], v246 offset:20736
    ds_read_b64_tr_b16 a[214:215], v246 offset:21760
    buffer_load_dwordx4 v242, s[16:19], s42 offen offset:0 sc1 lds
    v_add_u32 v253, v253, v231
    v_mfma_f32_32x32x16_bf16 v[112:127], a[196:199], v[32:35], v[112:127]
    ds_read_b64_tr_b16 a[216:217], v246 offset:20992
    ds_read_b64_tr_b16 a[218:219], v246 offset:22016
    v_lshlrev_b32 v255, 5, v230
    v_and_b32 v230, 16, v240
    v_mfma_f32_32x32x16_bf16 v[176:191], a[196:199], v[36:39], v[176:191]
    ds_read_b64_tr_b16 a[220:221], v246 offset:21248
    ds_read_b64_tr_b16 a[222:223], v246 offset:22272
    buffer_load_dwordx4 v242, s[16:19], s42 offen offset:1024 sc1 lds
    v_add_u32 v255, v255, v230
    v_mfma_f32_32x32x16_bf16 v[128:143], a[200:203], v[32:35], v[128:143]
    buffer_load_dwordx4 v242, s[16:19], s42 offen offset:2048 sc1 lds
    v_lshrrev_b32 v231, 5, v231
    v_lshl_add_u32 v255, v231, 16, v255
    v_mov_b32 v64, 0
    v_mfma_f32_32x32x16_bf16 v[192:207], a[200:203], v[36:39], v[192:207]
    v_mov_b32 v65, 0
    v_mov_b32 v66, 0
    v_mfma_f32_32x32x16_bf16 v[144:159], a[204:207], v[32:35], v[144:159]
    buffer_load_dwordx4 v242, s[16:19], s42 offen offset:3072 sc1 lds
    v_mov_b32 v67, 0
    v_mov_b32 v68, 0
    v_mfma_f32_32x32x16_bf16 v[208:223], a[204:207], v[36:39], v[208:223]
    s_add_u32 s32, s32, 32768
    s_add_u32 s34, s34, 32768
    s_cmp_ge_u32 s34, 163840
    s_cselect_b32 s24, 163840, 0
    s_sub_u32 s34, s34, s24
    s_waitcnt vmcnt(27) lgkmcnt(0)
    v_mfma_f32_32x32x16_bf16 v[96:111], a[208:211], v[40:43], v[96:111]
    ds_read_b64_tr_b16 a[192:193], v246 offset:24576
    ds_read_b64_tr_b16 a[194:195], v246 offset:25600
    v_mov_b32 v69, 0
    v_mov_b32 v70, 0
    v_mfma_f32_32x32x16_bf16 v[160:175], a[208:211], v[44:47], v[160:175]
    ds_read_b64_tr_b16 a[196:197], v246 offset:24832
    ds_read_b64_tr_b16 a[198:199], v246 offset:25856
    v_mov_b32 v71, 0
    v_mov_b32 v72, 0
    v_mfma_f32_32x32x16_bf16 v[112:127], a[212:215], v[40:43], v[112:127]
    ds_read_b64_tr_b16 a[200:201], v246 offset:25088
    ds_read_b64_tr_b16 a[202:203], v246 offset:26112
    v_mov_b32 v73, 0
    v_mfma_f32_32x32x16_bf16 v[176:191], a[212:215], v[44:47], v[176:191]
    ds_read_b64_tr_b16 a[204:205], v246 offset:25344
    ds_read_b64_tr_b16 a[206:207], v246 offset:26368
    v_mov_b32 v74, 0
    v_mov_b32 v75, 0
    v_mfma_f32_32x32x16_bf16 v[128:143], a[216:219], v[40:43], v[128:143]
    v_mov_b32 v76, 0
    v_mov_b32 v77, 0
    v_mfma_f32_32x32x16_bf16 v[192:207], a[216:219], v[44:47], v[192:207]
    v_mov_b32 v78, 0
    v_mov_b32 v79, 0
    v_mov_b32 v228, 0
    v_mfma_f32_32x32x16_bf16 v[144:159], a[220:223], v[40:43], v[144:159]
    v_mov_b32 v226, 0
    v_mov_b32 v80, 0
    v_mov_b32 v81, 0
    v_mfma_f32_32x32x16_bf16 v[208:223], a[220:223], v[44:47], v[208:223]
    v_mov_b32 v82, 0
    v_mov_b32 v83, 0
    s_waitcnt vmcnt(23) lgkmcnt(0)
    v_mfma_f32_32x32x16_bf16 v[96:111], a[192:195], v[48:51], v[96:111]
    ds_read_b64_tr_b16 a[208:209], v246 offset:28672
    ds_read_b64_tr_b16 a[210:211], v246 offset:29696
    v_mov_b32 v84, 0
    v_mfma_f32_32x32x16_bf16 v[160:175], a[192:195], v[52:55], v[160:175]
    ds_read_b64_tr_b16 a[212:213], v246 offset:28928
    ds_read_b64_tr_b16 a[214:215], v246 offset:29952
    v_mov_b32 v85, 0
    v_mov_b32 v86, 0
    v_mfma_f32_32x32x16_bf16 v[112:127], a[196:199], v[48:51], v[112:127]
    ds_read_b64_tr_b16 a[216:217], v246 offset:29184
    ds_read_b64_tr_b16 a[218:219], v246 offset:30208
    v_mov_b32 v87, 0
    v_mov_b32 v88, 0
    v_mfma_f32_32x32x16_bf16 v[176:191], a[196:199], v[52:55], v[176:191]
    ds_read_b64_tr_b16 a[220:221], v246 offset:29440
    ds_read_b64_tr_b16 a[222:223], v246 offset:30464
    v_mov_b32 v89, 0
    v_mfma_f32_32x32x16_bf16 v[128:143], a[200:203], v[48:51], v[128:143]
    v_mov_b32 v90, 0
    v_mov_b32 v91, 0
    v_mov_b32 v92, 0
    v_mfma_f32_32x32x16_bf16 v[192:207], a[200:203], v[52:55], v[192:207]
    v_mov_b32 v93, 0
    v_mov_b32 v94, 0
    v_mfma_f32_32x32x16_bf16 v[144:159], a[204:207], v[48:51], v[144:159]
    v_mov_b32 v95, 0
    v_mov_b32 v229, 0
    v_mov_b32 v227, 0
    v_mfma_f32_32x32x16_bf16 v[208:223], a[204:207], v[52:55], v[208:223]
    s_waitcnt vmcnt(8) lgkmcnt(0)
    s_barrier
    v_mfma_f32_32x32x16_bf16 v[96:111], a[208:211], v[56:59], v[96:111]
    ds_read_b128 a[192:195], v241 offset:0
    ds_read_b128 a[196:199], v241 offset:512
    s_cmp_lt_u32 s32, s33
    s_cselect_b32 s41, s32, s43
    s_mov_b32 m0, s34
    s_nop 0
    buffer_load_dwordx4 v242, s[16:19], s41 offen offset:0 sc1 lds
    v_mfma_f32_32x32x16_bf16 v[160:175], a[208:211], v[60:63], v[160:175]
    ds_read_b128 a[200:203], v241 offset:2048
    ds_read_b128 a[204:207], v241 offset:2560
    buffer_load_dwordx4 v242, s[16:19], s41 offen offset:1024 sc1 lds
    v_mfma_f32_32x32x16_bf16 v[112:127], a[212:215], v[56:59], v[112:127]
    ds_read_b128 a[224:227], v241 offset:8192
    ds_read_b128 a[228:231], v241 offset:8704
    buffer_load_dwordx4 v242, s[16:19], s41 offen offset:2048 sc1 lds
    buffer_load_dwordx4 v242, s[16:19], s41 offen offset:3072 sc1 lds
    v_mfma_f32_32x32x16_bf16 v[176:191], a[212:215], v[60:63], v[176:191]
    ds_read_b128 a[232:235], v241 offset:10240
    ds_read_b128 a[236:239], v241 offset:10752
    s_sub_u32 s42, s32, 16384
    s_cmp_lt_u32 s42, s33
    s_cselect_b32 s42, s42, s43
    s_add_u32 m0, s34, 16384
    s_nop 0
    v_mfma_f32_32x32x16_bf16 v[128:143], a[216:219], v[56:59], v[128:143]
    ds_read_b128 a[240:243], v241 offset:12288
    ds_read_b128 a[244:247], v241 offset:12800
    buffer_load_dwordx4 v242, s[16:19], s42 offen offset:0 sc1 lds
    v_mfma_f32_32x32x16_bf16 v[192:207], a[216:219], v[60:63], v[192:207]
    ds_read_b128 a[248:251], v241 offset:14336
    ds_read_b128 a[252:255], v241 offset:14848
    buffer_load_dwordx4 v242, s[16:19], s42 offen offset:1024 sc1 lds
    buffer_load_dwordx4 v242, s[16:19], s42 offen offset:2048 sc1 lds
    v_mfma_f32_32x32x16_bf16 v[144:159], a[220:223], v[56:59], v[144:159]
    buffer_load_dwordx4 v242, s[16:19], s42 offen offset:3072 sc1 lds
    v_mfma_f32_32x32x16_bf16 v[208:223], a[220:223], v[60:63], v[208:223]
    s_add_u32 s32, s32, 32768
    s_add_u32 s34, s34, 32768
    s_cmp_ge_u32 s34, 163840
    s_cselect_b32 s24, 163840, 0
    s_sub_u32 s34, s34, s24
    s_mov_b32 s25, 0x3e0293ee
    s_waitcnt lgkmcnt(8)
    ds_read_b128 a[208:211], v241 offset:4096
    ds_read_b128 a[212:215], v241 offset:4608
    ds_read_b128 a[216:219], v241 offset:6144
    ds_read_b128 a[220:223], v241 offset:6656
    s_add_u32 s36, s36, 1
    s_cmp_le_u32 s36, 1
    s_cbranch_scc1 ka_fix1
ka_fixr2:
    v_mul_f32 v96, s25, v96
    v_mul_f32 v97, s25, v97
    v_mul_f32 v98, s25, v98
    v_mul_f32 v99, s25, v99
    v_mul_f32 v100, s25, v100
    v_mul_f32 v101, s25, v101
    v_mul_f32 v102, s25, v102
    v_mul_f32 v103, s25, v103
    v_mul_f32 v104, s25, v104
    v_mul_f32 v105, s25, v105
    v_mul_f32 v106, s25, v106
    v_mul_f32 v107, s25, v107
    v_mul_f32 v108, s25, v108
    v_mul_f32 v109, s25, v109
    v_mul_f32 v110, s25, v110
    v_mul_f32 v111, s25, v111
    v_cvt_pk_bf16_f32 v96, v96, v97
    v_cvt_pk_bf16_f32 v97, v98, v99
    v_cvt_pk_bf16_f32 v98, v100, v101
    v_cvt_pk_bf16_f32 v99, v102, v103
    v_cvt_pk_bf16_f32 v100, v104, v105
    v_cvt_pk_bf16_f32 v101, v106, v107
    v_cvt_pk_bf16_f32 v102, v108, v109
    v_cvt_pk_bf16_f32 v103, v110, v111
    v_accvgpr_write_b32 a128, v96
    v_accvgpr_write_b32 a129, v97
    v_accvgpr_write_b32 a130, v98
    v_accvgpr_write_b32 a131, v99
    v_accvgpr_write_b32 a132, v100
    v_accvgpr_write_b32 a133, v101
    v_accvgpr_write_b32 a134, v102
    v_accvgpr_write_b32 a135, v103
    v_mul_f32 v160, s25, v160
    v_mul_f32 v161, s25, v161
    v_mul_f32 v162, s25, v162
    v_mul_f32 v163, s25, v163
    v_mul_f32 v164, s25, v164
    v_mul_f32 v165, s25, v165
    v_mul_f32 v166, s25, v166
    v_mul_f32 v167, s25, v167
    v_mul_f32 v168, s25, v168
    v_mul_f32 v169, s25, v169
    v_mul_f32 v170, s25, v170
    v_mul_f32 v171, s25, v171
    v_mul_f32 v172, s25, v172
    v_mul_f32 v173, s25, v173
    v_mul_f32 v174, s25, v174
    v_mul_f32 v175, s25, v175
    v_cvt_pk_bf16_f32 v160, v160, v161
    v_cvt_pk_bf16_f32 v161, v162, v163
    v_cvt_pk_bf16_f32 v162, v164, v165
    v_cvt_pk_bf16_f32 v163, v166, v167
    v_cvt_pk_bf16_f32 v164, v168, v169
    v_cvt_pk_bf16_f32 v165, v170, v171
    v_cvt_pk_bf16_f32 v166, v172, v173
    v_cvt_pk_bf16_f32 v167, v174, v175
    v_accvgpr_write_b32 a160, v160
    v_accvgpr_write_b32 a161, v161
    v_accvgpr_write_b32 a162, v162
    v_accvgpr_write_b32 a163, v163
    v_accvgpr_write_b32 a164, v164
    v_accvgpr_write_b32 a165, v165
    v_accvgpr_write_b32 a166, v166
    v_accvgpr_write_b32 a167, v167
    s_nop 1
    v_mfma_f32_32x32x16_bf16 v[0:15], a[192:195], a[128:131], v[64:79]
    v_mul_f32 v112, s25, v112
    v_mul_f32 v113, s25, v113
    v_mul_f32 v114, s25, v114
    v_mul_f32 v115, s25, v115
    v_mul_f32 v116, s25, v116
    v_mul_f32 v117, s25, v117
    v_mfma_f32_32x32x16_bf16 v[16:31], a[192:195], a[160:163], v[80:95]
    v_mul_f32 v118, s25, v118
    v_mul_f32 v119, s25, v119
    v_mul_f32 v120, s25, v120
    v_mul_f32 v121, s25, v121
    v_mul_f32 v122, s25, v122
    v_mul_f32 v123, s25, v123
    v_mfma_f32_32x32x16_bf16 v[0:15], a[196:199], a[132:135], v[0:15]
    v_mul_f32 v124, s25, v124
    v_mul_f32 v125, s25, v125
    v_mul_f32 v126, s25, v126
    v_mul_f32 v127, s25, v127
    v_cvt_pk_bf16_f32 v112, v112, v113
    v_cvt_pk_bf16_f32 v113, v114, v115
    v_mfma_f32_32x32x16_bf16 v[16:31], a[196:199], a[164:167], v[16:31]
    v_cvt_pk_bf16_f32 v114, v116, v117
    v_cvt_pk_bf16_f32 v115, v118, v119
    v_cvt_pk_bf16_f32 v116, v120, v121
    v_cvt_pk_bf16_f32 v117, v122, v123
    v_cvt_pk_bf16_f32 v118, v124, v125
    v_cvt_pk_bf16_f32 v119, v126, v127
    v_accvgpr_write_b32 a136, v112
    v_accvgpr_write_b32 a137, v113
    v_accvgpr_write_b32 a138, v114
    v_accvgpr_write_b32 a139, v115
    v_accvgpr_write_b32 a140, v116
    v_accvgpr_write_b32 a141, v117
    v_accvgpr_write_b32 a142, v118
    v_accvgpr_write_b32 a143, v119
    v_mul_f32 v176, s25, v176
    v_mul_f32 v177, s25, v177
    v_mul_f32 v178, s25, v178
    v_mul_f32 v179, s25, v179
    v_mul_f32 v180, s25, v180
    v_mul_f32 v181, s25, v181
    v_mul_f32 v182, s25, v182
    v_mul_f32 v183, s25, v183
    v_mul_f32 v184, s25, v184
    v_mul_f32 v185, s25, v185
    v_mul_f32 v186, s25, v186
    v_mul_f32 v187, s25, v187
    v_mul_f32 v188, s25, v188
    v_mul_f32 v189, s25, v189
    v_mul_f32 v190, s25, v190
    v_mul_f32 v191, s25, v191
    v_cvt_pk_bf16_f32 v176, v176, v177
    v_cvt_pk_bf16_f32 v177, v178, v179
    v_cvt_pk_bf16_f32 v178, v180, v181
    v_cvt_pk_bf16_f32 v179, v182, v183
    v_cvt_pk_bf16_f32 v180, v184, v185
    v_cvt_pk_bf16_f32 v181, v186, v187
    v_cvt_pk_bf16_f32 v182, v188, v189
    v_cvt_pk_bf16_f32 v183, v190, v191
    v_accvgpr_write_b32 a168, v176
    v_accvgpr_write_b32 a169, v177
    v_accvgpr_write_b32 a170, v178
    v_accvgpr_write_b32 a171, v179
    v_accvgpr_write_b32 a172, v180
    v_accvgpr_write_b32 a173, v181
    v_accvgpr_write_b32 a174, v182
    v_accvgpr_write_b32 a175, v183
    s_nop 1
    v_mfma_f32_32x32x16_bf16 v[0:15], a[200:203], a[136:139], v[0:15]
    v_mul_f32 v128, s25, v128
    v_mul_f32 v129, s25, v129
    v_mul_f32 v130, s25, v130
    v_mul_f32 v131, s25, v131
    v_mul_f32 v132, s25, v132
    v_mul_f32 v133, s25, v133
    v_mfma_f32_32x32x16_bf16 v[16:31], a[200:203], a[168:171], v[16:31]
    v_mul_f32 v134, s25, v134
    v_mul_f32 v135, s25, v135
    v_mul_f32 v136, s25, v136
    v_mul_f32 v137, s25, v137
    v_mul_f32 v138, s25, v138
    v_mul_f32 v139, s25, v139
    v_mfma_f32_32x32x16_bf16 v[0:15], a[204:207], a[140:143], v[0:15]
    v_mul_f32 v140, s25, v140
    v_mul_f32 v141, s25, v141
    v_mul_f32 v142, s25, v142
    v_mul_f32 v143, s25, v143
    v_cvt_pk_bf16_f32 v128, v128, v129
    v_cvt_pk_bf16_f32 v129, v130, v131
    v_mfma_f32_32x32x16_bf16 v[16:31], a[204:207], a[172:175], v[16:31]
    v_cvt_pk_bf16_f32 v130, v132, v133
    v_cvt_pk_bf16_f32 v131, v134, v135
    v_cvt_pk_bf16_f32 v132, v136, v137
    v_cvt_pk_bf16_f32 v133, v138, v139
    v_cvt_pk_bf16_f32 v134, v140, v141
    v_cvt_pk_bf16_f32 v135, v142, v143
    v_accvgpr_write_b32 a144, v128
    v_accvgpr_write_b32 a145, v129
    v_accvgpr_write_b32 a146, v130
    v_accvgpr_write_b32 a147, v131
    v_accvgpr_write_b32 a148, v132
    v_accvgpr_write_b32 a149, v133
    v_accvgpr_write_b32 a150, v134
    v_accvgpr_write_b32 a151, v135
    v_mul_f32 v192, s25, v192
    v_mul_f32 v193, s25, v193
    v_mul_f32 v194, s25, v194
    v_mul_f32 v195, s25, v195
    v_mul_f32 v196, s25, v196
    v_mul_f32 v197, s25, v197
    v_mul_f32 v198, s25, v198
    v_mul_f32 v199, s25, v199
    v_mul_f32 v200, s25, v200
    v_mul_f32 v201, s25, v201
    v_mul_f32 v202, s25, v202
    v_mul_f32 v203, s25, v203
    v_mul_f32 v204, s25, v204
    v_mul_f32 v205, s25, v205
    v_mul_f32 v206, s25, v206
    v_mul_f32 v207, s25, v207
    v_cvt_pk_bf16_f32 v192, v192, v193
    v_cvt_pk_bf16_f32 v193, v194, v195
    v_cvt_pk_bf16_f32 v194, v196, v197
    v_cvt_pk_bf16_f32 v195, v198, v199
    v_cvt_pk_bf16_f32 v196, v200, v201
    v_cvt_pk_bf16_f32 v197, v202, v203
    v_cvt_pk_bf16_f32 v198, v204, v205
    v_cvt_pk_bf16_f32 v199, v206, v207
    v_accvgpr_write_b32 a176, v192
    v_accvgpr_write_b32 a177, v193
    v_accvgpr_write_b32 a178, v194
    v_accvgpr_write_b32 a179, v195
    v_accvgpr_write_b32 a180, v196
    v_accvgpr_write_b32 a181, v197
    v_accvgpr_write_b32 a182, v198
    v_accvgpr_write_b32 a183, v199
    s_nop 1
    s_waitcnt lgkmcnt(0)
    v_mfma_f32_32x32x16_bf16 v[0:15], a[208:211], a[144:147], v[0:15]
    v_mul_f32 v144, s25, v144
    v_mul_f32 v145, s25, v145
    v_mul_f32 v146, s25, v146
    v_mul_f32 v147, s25, v147
    v_mul_f32 v148, s25, v148
    v_mul_f32 v149, s25, v149
    v_mfma_f32_32x32x16_bf16 v[16:31], a[208:211], a[176:179], v[16:31]
    v_mul_f32 v150, s25, v150
    v_mul_f32 v151, s25, v151
    v_mul_f32 v152, s25, v152
    v_mul_f32 v153, s25, v153
    v_mul_f32 v154, s25, v154
    v_mul_f32 v155, s25, v155
    v_mfma_f32_32x32x16_bf16 v[0:15], a[212:215], a[148:151], v[0:15]
    v_mul_f32 v156, s25, v156
    v_mul_f32 v157, s25, v157
    v_mul_f32 v158, s25, v158
    v_mul_f32 v159, s25, v159
    v_cvt_pk_bf16_f32 v144, v144, v145
    v_cvt_pk_bf16_f32 v145, v146, v147
    v_mfma_f32_32x32x16_bf16 v[16:31], a[212:215], a[180:183], v[16:31]
    v_cvt_pk_bf16_f32 v146, v148, v149
    v_cvt_pk_bf16_f32 v147, v150, v151
    v_cvt_pk_bf16_f32 v148, v152, v153
    v_cvt_pk_bf16_f32 v149, v154, v155
    v_cvt_pk_bf16_f32 v150, v156, v157
    v_cvt_pk_bf16_f32 v151, v158, v159
    v_accvgpr_write_b32 a152, v144
    v_accvgpr_write_b32 a153, v145
    v_accvgpr_write_b32 a154, v146
    v_accvgpr_write_b32 a155, v147
    v_accvgpr_write_b32 a156, v148
    v_accvgpr_write_b32 a157, v149
    v_accvgpr_write_b32 a158, v150
    v_accvgpr_write_b32 a159, v151
    v_mul_f32 v208, s25, v208
    v_mul_f32 v209, s25, v209
    v_mul_f32 v210, s25, v210
    v_mul_f32 v211, s25, v211
    v_mul_f32 v212, s25, v212
    v_mul_f32 v213, s25, v213
    v_mul_f32 v214, s25, v214
    v_mul_f32 v215, s25, v215
    v_mul_f32 v216, s25, v216
    v_mul_f32 v217, s25, v217
    v_mul_f32 v218, s25, v218
    v_mul_f32 v219, s25, v219
    v_mul_f32 v220, s25, v220
    v_mul_f32 v221, s25, v221
    v_mul_f32 v222, s25, v222
    v_mul_f32 v223, s25, v223
    v_cvt_pk_bf16_f32 v208, v208, v209
    v_cvt_pk_bf16_f32 v209, v210, v211
    v_cvt_pk_bf16_f32 v210, v212, v213
    v_cvt_pk_bf16_f32 v211, v214, v215
    v_cvt_pk_bf16_f32 v212, v216, v217
    v_cvt_pk_bf16_f32 v213, v218, v219
    v_cvt_pk_bf16_f32 v214, v220, v221
    v_cvt_pk_bf16_f32 v215, v222, v223
    v_accvgpr_write_b32 a184, v208
    v_accvgpr_write_b32 a185, v209
    v_accvgpr_write_b32 a186, v210
    v_accvgpr_write_b32 a187, v211
    v_accvgpr_write_b32 a188, v212
    v_accvgpr_write_b32 a189, v213
    v_accvgpr_write_b32 a190, v214
    v_accvgpr_write_b32 a191, v215
    s_nop 1
    v_mfma_f32_32x32x16_bf16 v[0:15], a[216:219], a[152:155], v[0:15]
    v_mfma_f32_32x32x16_bf16 v[16:31], a[216:219], a[184:187], v[16:31]
    v_mfma_f32_32x32x16_bf16 v[0:15], a[220:223], a[156:159], v[0:15]
    v_mfma_f32_32x32x16_bf16 v[16:31], a[220:223], a[188:191], v[16:31]
    s_nop 11
    v_max3_f32 v230, v0, v1, v2
    v_max3_f32 v232, v16, v17, v18
    v_max3_f32 v230, v230, v3, v4
    v_max3_f32 v232, v232, v19, v20
    v_max3_f32 v230, v230, v5, v6
    v_max3_f32 v232, v232, v21, v22
    v_max3_f32 v230, v230, v7, v8
    v_max3_f32 v232, v232, v23, v24
    v_max3_f32 v230, v230, v9, v10
    v_max3_f32 v232, v232, v25, v26
    v_max3_f32 v230, v230, v11, v12
    v_max3_f32 v232, v232, v27, v28
    v_max3_f32 v230, v230, v13, v14
    v_max3_f32 v232, v232, v29, v30
    v_max_f32 v230, v230, v15
    v_max_f32 v232, v232, v31
    v_mov_b32 v231, v230
    v_mov_b32 v233, v232
    s_nop 1
    s_nop 1
    v_permlane32_swap_b32 v230, v231
    v_permlane32_swap_b32 v232, v233
    s_nop 0
    s_nop 0
    v_max_f32 v230, v230, v231
    v_max_f32 v232, v232, v233
    v_sub_f32 v228, 0, v230
    v_sub_f32 v64, v64, v230
    v_sub_f32 v65, v65, v230
    v_sub_f32 v66, v66, v230
    v_sub_f32 v67, v67, v230
    v_sub_f32 v68, v68, v230
    v_sub_f32 v69, v69, v230
    v_sub_f32 v70, v70, v230
    v_sub_f32 v71, v71, v230
    v_sub_f32 v72, v72, v230
    v_sub_f32 v73, v73, v230
    v_sub_f32 v74, v74, v230
    v_sub_f32 v75, v75, v230
    v_sub_f32 v76, v76, v230
    v_sub_f32 v77, v77, v230
    v_sub_f32 v78, v78, v230
    v_sub_f32 v79, v79, v230
    v_sub_f32 v229, 0, v232
    v_sub_f32 v80, v80, v232
    v_sub_f32 v81, v81, v232
    v_sub_f32 v82, v82, v232
    v_sub_f32 v83, v83, v232
    v_sub_f32 v84, v84, v232
    v_sub_f32 v85, v85, v232
    v_sub_f32 v86, v86, v232
    v_sub_f32 v87, v87, v232
    v_sub_f32 v88, v88, v232
    v_sub_f32 v89, v89, v232
    v_sub_f32 v90, v90, v232
    v_sub_f32 v91, v91, v232
    v_sub_f32 v92, v92, v232
    v_sub_f32 v93, v93, v232
    v_sub_f32 v94, v94, v232
    v_sub_f32 v95, v95, v232
    v_sub_f32 v0, v0, v230
    v_sub_f32 v1, v1, v230
    v_sub_f32 v2, v2, v230
    v_sub_f32 v3, v3, v230
    v_sub_f32 v4, v4, v230
    v_sub_f32 v5, v5, v230
    v_sub_f32 v6, v6, v230
    v_sub_f32 v7, v7, v230
    v_sub_f32 v8, v8, v230
    v_sub_f32 v9, v9, v230
    v_sub_f32 v10, v10, v230
    v_sub_f32 v11, v11, v230
    v_sub_f32 v12, v12, v230
    v_sub_f32 v13, v13, v230
    v_sub_f32 v14, v14, v230
    v_sub_f32 v15, v15, v230
    v_sub_f32 v16, v16, v232
    v_sub_f32 v17, v17, v232
    v_sub_f32 v18, v18, v232
    v_sub_f32 v19, v19, v232
    v_sub_f32 v20, v20, v232
    v_sub_f32 v21, v21, v232
    v_sub_f32 v22, v22, v232
    v_sub_f32 v23, v23, v232
    v_sub_f32 v24, v24, v232
    v_sub_f32 v25, v25, v232
    v_sub_f32 v26, v26, v232
    v_sub_f32 v27, v27, v232
    v_sub_f32 v28, v28, v232
    v_sub_f32 v29, v29, v232
    v_sub_f32 v30, v30, v232
    v_sub_f32 v31, v31, v232
    s_mov_b32 s35, 32768
    v_add_u32 v241, s35, v239
    s_add_u32 s36, s36, 1
    s_cmp_le_u32 s36, 1
    s_cbranch_scc1 ka_fix3
ka_fixr4:
    v_mfma_f32_32x32x16_bf16 v[32:47], a[224:227], a[128:131], v[64:79]
    ds_read_b128 a[192:195], v241 offset:0
    v_exp_f32 v136, v0
    v_exp_f32 v137, v1
    v_exp_f32 v130, v2
    v_mfma_f32_32x32x16_bf16 v[48:63], a[224:227], a[160:163], v[80:95]
    v_exp_f32 v131, v3
    v_cvt_pk_bf16_f32 v96, v136, v137
    v_exp_f32 v132, v4
    v_exp_f32 v133, v5
    v_cvt_pk_bf16_f32 v97, v130, v131
    v_add_f32 v136, v136, v130
    v_mfma_f32_32x32x16_bf16 v[32:47], a[228:231], a[132:135], v[32:47]
    ds_read_b128 a[196:199], v241 offset:512
    v_add_f32 v137, v137, v131
    v_exp_f32 v134, v6
    v_exp_f32 v135, v7
    v_cvt_pk_bf16_f32 v98, v132, v133
    v_mfma_f32_32x32x16_bf16 v[48:63], a[228:231], a[164:167], v[48:63]
    v_add_f32 v136, v136, v132
    v_add_f32 v137, v137, v133
    v_exp_f32 v128, v8
    v_exp_f32 v129, v9
    v_cvt_pk_bf16_f32 v99, v134, v135
    v_add_f32 v136, v136, v134
    v_add_f32 v137, v137, v135
    v_mfma_f32_32x32x16_bf16 v[32:47], a[232:235], a[136:139], v[32:47]
    ds_read_b128 a[200:203], v241 offset:2048
    v_exp_f32 v130, v10
    v_exp_f32 v131, v11
    v_cvt_pk_bf16_f32 v100, v128, v129
    v_add_f32 v136, v136, v128
    v_mfma_f32_32x32x16_bf16 v[48:63], a[232:235], a[168:171], v[48:63]
    v_add_f32 v137, v137, v129
    v_exp_f32 v132, v12
    v_exp_f32 v133, v13
    v_cvt_pk_bf16_f32 v101, v130, v131
    v_add_f32 v136, v136, v130
    v_add_f32 v137, v137, v131
    v_mfma_f32_32x32x16_bf16 v[32:47], a[236:239], a[140:143], v[32:47]
    ds_read_b128 a[204:207], v241 offset:2560
    v_exp_f32 v134, v14
    v_exp_f32 v135, v15
    v_cvt_pk_bf16_f32 v102, v132, v133
    v_add_f32 v136, v136, v132
    v_add_f32 v137, v137, v133
    v_mfma_f32_32x32x16_bf16 v[48:63], a[236:239], a[172:175], v[48:63]
    v_exp_f32 v138, v16
    v_exp_f32 v139, v17
    v_cvt_pk_bf16_f32 v103, v134, v135
    v_add_f32 v136, v136, v134
    v_add_f32 v137, v137, v135
    v_add_f32 v224, v136, v137
    v_mfma_f32_32x32x16_bf16 v[32:47], a[240:243], a[144:147], v[32:47]
    ds_read_b128 a[208:211], v241 offset:4096
    v_exp_f32 v130, v18
    v_exp_f32 v131, v19
    v_cvt_pk_bf16_f32 v104, v138, v139
    v_exp_f32 v132, v20
    v_mfma_f32_32x32x16_bf16 v[48:63], a[240:243], a[176:179], v[48:63]
    v_exp_f32 v133, v21
    v_cvt_pk_bf16_f32 v105, v130, v131
    v_add_f32 v138, v138, v130
    v_add_f32 v139, v139, v131
    v_exp_f32 v134, v22
    v_mfma_f32_32x32x16_bf16 v[32:47], a[244:247], a[148:151], v[32:47]
    ds_read_b128 a[212:215], v241 offset:4608
    v_exp_f32 v135, v23
    v_cvt_pk_bf16_f32 v106, v132, v133
    v_add_f32 v138, v138, v132
    v_add_f32 v139, v139, v133
    v_exp_f32 v128, v24
    v_mfma_f32_32x32x16_bf16 v[48:63], a[244:247], a[180:183], v[48:63]
    v_exp_f32 v129, v25
    v_cvt_pk_bf16_f32 v107, v134, v135
    v_add_f32 v138, v138, v134
    v_add_f32 v139, v139, v135
    v_exp_f32 v130, v26
    v_exp_f32 v131, v27
    v_mfma_f32_32x32x16_bf16 v[32:47], a[248:251], a[152:155], v[32:47]
    ds_read_b128 a[216:219], v241 offset:6144
    v_cvt_pk_bf16_f32 v108, v128, v129
    v_add_f32 v138, v138, v128
    v_add_f32 v139, v139, v129
    v_exp_f32 v132, v28
    v_exp_f32 v133, v29
    v_mfma_f32_32x32x16_bf16 v[48:63], a[248:251], a[184:187], v[48:63]
    v_cvt_pk_bf16_f32 v109, v130, v131
    v_add_f32 v138, v138, v130
    v_add_f32 v139, v139, v131
    v_exp_f32 v134, v30
    v_exp_f32 v135, v31
    v_mfma_f32_32x32x16_bf16 v[32:47], a[252:255], a[156:159], v[32:47]
    ds_read_b128 a[220:223], v241 offset:6656
    v_cvt_pk_bf16_f32 v110, v132, v133
    v_add_f32 v138, v138, v132
    v_add_f32 v139, v139, v133
    v_cvt_pk_bf16_f32 v111, v134, v135
    v_add_f32 v138, v138, v134
    v_add_f32 v139, v139, v135
    v_add_f32 v225, v138, v139
    v_mfma_f32_32x32x16_bf16 v[48:63], a[252:255], a[188:191], v[48:63]
    s_lshl1_add_u32 s26, s5, 1
    s_mov_b32 s56, s0
    s_mov_b32 s57, s1
    s_mov_b32 s58, 0x800000
    s_and_b32 s28, s2, 4
    s_lshl_b32 s28, s28, 20
    s_and_b32 s27, s2, 1
    s_lshl_b32 s27, s27, 10
    s_add_u32 s28, s28, s27
    s_lshr_b32 s27, s2, 3
    s_lshl2_add_u32 s27, s27, s3
    s_lshl_b32 s27, s27, 15
    s_add_u32 s28, s28, s27
    s_mov_b32 s27, 4294967271
    v_and_b32 v245, 1024, v251
    v_add_u32 v245, v245, v251
.p2align 3
ka_p1:
    s_add_u32 s36, s36, 1
    s_cmp_le_u32 s36, 1
    s_cbranch_scc1 ka_fix7
ka_fixr8:
    s_waitcnt lgkmcnt(6)
    v_mfma_f32_32x32x16_bf16 v[0:15], a[192:195], a[128:131], v[64:79]
    ds_read_b128 a[224:227], v241 offset:16384
    v_add_f32 v226, v226, v224
    v_add_f32 v227, v227, v225
    v_exp_f32 v136, v32
    v_mfma_f32_32x32x16_bf16 v[16:31], a[192:195], a[160:163], v[80:95]
    s_waitcnt vmcnt(11)
    buffer_store_dwordx4 v[192:195], v255, s[48:51], s45 offen offset:0
    s_cmp_lt_u32 s44, s47
    s_cselect_b32 s101, s44, s43
    buffer_load_dwordx4 v[192:195], v253, s[52:55], s101 offen
    v_mfma_f32_32x32x16_bf16 v[0:15], a[196:199], a[132:135], v[0:15]
    ds_read_b128 a[228:231], v241 offset:18432
    v_exp_f32 v137, v33
    v_exp_f32 v130, v34
    v_mfma_f32_32x32x16_bf16 v[16:31], a[196:199], a[164:167], v[16:31]
    v_exp_f32 v131, v35
    v_cvt_pk_bf16_f32 v112, v136, v137
    v_exp_f32 v132, v36
    s_waitcnt lgkmcnt(6)
    v_mfma_f32_32x32x16_bf16 v[0:15], a[200:203], a[136:139], v[0:15]
    ds_read_b128 a[232:235], v241 offset:20480
    v_exp_f32 v133, v37
    v_cvt_pk_bf16_f32 v113, v130, v131
    v_mfma_f32_32x32x16_bf16 v[16:31], a[200:203], a[168:171], v[16:31]
    s_add_u32 s27, s27, 1
    s_cmp_lt_u32 s27, 8
    s_cbranch_scc1 ka_l2p5
ka_l2r6:
    v_add_f32 v136, v136, v130
    v_add_f32 v137, v137, v131
    v_mfma_f32_32x32x16_bf16 v[0:15], a[204:207], a[140:143], v[0:15]
    ds_read_b128 a[236:239], v241 offset:22528
    v_exp_f32 v134, v38
    v_exp_f32 v135, v39
    v_mfma_f32_32x32x16_bf16 v[16:31], a[204:207], a[172:175], v[16:31]
    v_cvt_pk_bf16_f32 v114, v132, v133
    v_add_f32 v136, v136, v132
    v_add_f32 v137, v137, v133
    s_waitcnt lgkmcnt(6)
    v_mfma_f32_32x32x16_bf16 v[0:15], a[208:211], a[144:147], v[0:15]
    ds_read_b128 a[240:243], v241 offset:16896
    v_exp_f32 v128, v40
    v_exp_f32 v129, v41
    v_cvt_pk_bf16_f32 v115, v134, v135
    v_mfma_f32_32x32x16_bf16 v[16:31], a[208:211], a[176:179], v[16:31]
    s_cmp_lt_u32 s32, s33
    s_cselect_b32 s41, s32, s43
    s_mov_b32 m0, s34
    s_nop 0
    v_add_f32 v136, v136, v134
    v_mfma_f32_32x32x16_bf16 v[0:15], a[212:215], a[148:151], v[0:15]
    ds_read_b128 a[244:247], v241 offset:18944
    v_add_f32 v137, v137, v135
    v_exp_f32 v130, v42
    v_exp_f32 v131, v43
    v_mfma_f32_32x32x16_bf16 v[16:31], a[212:215], a[180:183], v[16:31]
    v_cvt_pk_bf16_f32 v116, v128, v129
    v_add_f32 v136, v136, v128
    v_add_f32 v137, v137, v129
    s_waitcnt lgkmcnt(6)
    v_mfma_f32_32x32x16_bf16 v[0:15], a[216:219], a[152:155], v[0:15]
    ds_read_b128 a[248:251], v241 offset:20992
    v_exp_f32 v132, v44
    v_exp_f32 v133, v45
    v_mfma_f32_32x32x16_bf16 v[16:31], a[216:219], a[184:187], v[16:31]
    buffer_load_dwordx4 v242, s[16:19], s41 offen offset:0 sc1 lds
    v_cvt_pk_bf16_f32 v117, v130, v131
    v_add_f32 v136, v136, v130
    v_add_f32 v137, v137, v131
    v_mfma_f32_32x32x16_bf16 v[0:15], a[220:223], a[156:159], v[0:15]
    ds_read_b128 a[252:255], v241 offset:23040
    v_exp_f32 v134, v46
    v_exp_f32 v135, v47
    v_cvt_pk_bf16_f32 v118, v132, v133
    v_mfma_f32_32x32x16_bf16 v[16:31], a[220:223], a[188:191], v[16:31]
    v_add_f32 v136, v136, v132
    v_add_f32 v137, v137, v133
    v_exp_f32 v138, v48
    s_waitcnt lgkmcnt(6)
    v_mfma_f32_32x32x16_bf16 a[0:15], a[224:227], v[96:99], a[0:15]
    ds_read_b128 a[192:195], v241 offset:8192
    v_exp_f32 v139, v49
    v_cvt_pk_bf16_f32 v119, v134, v135
    v_add_f32 v136, v136, v134
    v_mfma_f32_32x32x16_bf16 a[64:79], a[224:227], v[104:107], a[64:79]
    v_add_f32 v137, v137, v135
    v_add_f32 v224, v136, v137
    v_exp_f32 v130, v50
    v_mfma_f32_32x32x16_bf16 a[16:31], a[228:231], v[96:99], a[16:31]
    ds_read_b128 a[196:199], v241 offset:8704
    buffer_load_dwordx4 v242, s[16:19], s41 offen offset:1024 sc1 lds
    v_exp_f32 v131, v51
    v_cvt_pk_bf16_f32 v120, v138, v139
    v_mfma_f32_32x32x16_bf16 a[80:95], a[228:231], v[104:107], a[80:95]
    v_exp_f32 v132, v52
    v_exp_f32 v133, v53
    s_waitcnt lgkmcnt(6)
    v_mfma_f32_32x32x16_bf16 a[32:47], a[232:235], v[96:99], a[32:47]
    ds_read_b128 a[200:203], v241 offset:10240
    v_cvt_pk_bf16_f32 v121, v130, v131
    v_add_f32 v138, v138, v130
    v_add_f32 v139, v139, v131
    v_exp_f32 v134, v54
    v_mfma_f32_32x32x16_bf16 a[96:111], a[232:235], v[104:107], a[96:111]
    v_exp_f32 v135, v55
    v_cvt_pk_bf16_f32 v122, v132, v133
    v_add_f32 v138, v138, v132
    v_mfma_f32_32x32x16_bf16 a[48:63], a[236:239], v[96:99], a[48:63]
    ds_read_b128 a[204:207], v241 offset:10752
    buffer_load_dwordx4 v242, s[16:19], s41 offen offset:2048 sc1 lds
    v_add_f32 v139, v139, v133
    v_exp_f32 v128, v56
    v_mfma_f32_32x32x16_bf16 a[112:127], a[236:239], v[104:107], a[112:127]
    v_exp_f32 v129, v57
    v_cvt_pk_bf16_f32 v123, v134, v135
    v_add_f32 v138, v138, v134
    s_waitcnt lgkmcnt(6)
    v_mfma_f32_32x32x16_bf16 a[0:15], a[240:243], v[100:103], a[0:15]
    ds_read_b128 a[208:211], v241 offset:12288
    v_add_f32 v139, v139, v135
    v_exp_f32 v130, v58
    v_mfma_f32_32x32x16_bf16 a[64:79], a[240:243], v[108:111], a[64:79]
    v_exp_f32 v131, v59
    v_cvt_pk_bf16_f32 v124, v128, v129
    v_add_f32 v138, v138, v128
    v_add_f32 v139, v139, v129
    v_mfma_f32_32x32x16_bf16 a[16:31], a[244:247], v[100:103], a[16:31]
    ds_read_b128 a[212:215], v241 offset:12800
    buffer_load_dwordx4 v242, s[16:19], s41 offen offset:3072 sc1 lds
    v_exp_f32 v132, v60
    v_exp_f32 v133, v61
    v_mfma_f32_32x32x16_bf16 a[80:95], a[244:247], v[108:111], a[80:95]
    v_cvt_pk_bf16_f32 v125, v130, v131
    v_add_f32 v138, v138, v130
    v_add_f32 v139, v139, v131
    s_waitcnt lgkmcnt(6)
    v_mfma_f32_32x32x16_bf16 a[32:47], a[248:251], v[100:103], a[32:47]
    ds_read_b128 a[216:219], v241 offset:14336
    v_exp_f32 v134, v62
    v_exp_f32 v135, v63
    v_mfma_f32_32x32x16_bf16 a[96:111], a[248:251], v[108:111], a[96:111]
    v_cvt_pk_bf16_f32 v126, v132, v133
    v_add_f32 v138, v138, v132
    v_add_f32 v139, v139, v133
    v_cvt_pk_bf16_f32 v127, v134, v135
    v_add_f32 v138, v138, v134
    v_mfma_f32_32x32x16_bf16 a[48:63], a[252:255], v[100:103], a[48:63]
    ds_read_b128 a[220:223], v241 offset:14848
    v_add_f32 v139, v139, v135
    v_add_f32 v225, v138, v139
    v_max_f32 v230, v224, v225
    v_cmp_lt_f32 vcc, s38, v230
    v_mfma_f32_32x32x16_bf16 a[112:127], a[252:255], v[108:111], a[112:127]
    s_cbranch_vccnz ka_rare10
ka_rr9:
    s_add_u32 s36, s36, 1
    s_cmp_le_u32 s36, 1
    s_cbranch_scc1 ka_fix13
ka_fixr14:
    s_waitcnt lgkmcnt(6)
    v_mfma_f32_32x32x16_bf16 v[32:47], a[192:195], a[128:131], v[64:79]
    ds_read_b128 a[224:227], v241 offset:24576
    v_add_f32 v226, v226, v224
    v_add_f32 v227, v227, v225
    v_exp_f32 v136, v0
    v_mfma_f32_32x32x16_bf16 v[48:63], a[192:195], a[160:163], v[80:95]
    s_waitcnt vmcnt(11)
    buffer_store_dwordx4 v[196:199], v255, s[48:51], s45 offen offset:256
    s_add_u32 s101, s101, 57344
    buffer_load_dwordx4 v[196:199], v253, s[52:55], s101 offen
    v_exp_f32 v137, v1
    v_mfma_f32_32x32x16_bf16 v[32:47], a[196:199], a[132:135], v[32:47]
    ds_read_b128 a[228:231], v241 offset:26624
    v_exp_f32 v130, v2
    v_exp_f32 v131, v3
    v_mfma_f32_32x32x16_bf16 v[48:63], a[196:199], a[164:167], v[48:63]
    v_cvt_pk_bf16_f32 v96, v136, v137
    v_exp_f32 v132, v4
    v_exp_f32 v133, v5
    s_waitcnt lgkmcnt(6)
    v_mfma_f32_32x32x16_bf16 v[32:47], a[200:203], a[136:139], v[32:47]
    ds_read_b128 a[232:235], v241 offset:28672
    s_cmp_lt_u32 s44, s47
    s_cselect_b32 s45, s46, s43
    s_add_u32 s44, s44, 128
    s_add_u32 s46, s46, 262144
    v_cvt_pk_bf16_f32 v97, v130, v131
    v_mfma_f32_32x32x16_bf16 v[48:63], a[200:203], a[168:171], v[48:63]
    v_add_f32 v136, v136, v130
    v_add_f32 v137, v137, v131
    v_exp_f32 v134, v6
    v_mfma_f32_32x32x16_bf16 v[32:47], a[204:207], a[140:143], v[32:47]
    ds_read_b128 a[236:239], v241 offset:30720
    v_exp_f32 v135, v7
    v_cvt_pk_bf16_f32 v98, v132, v133
    v_add_f32 v136, v136, v132
    v_add_f32 v137, v137, v133
    v_mfma_f32_32x32x16_bf16 v[48:63], a[204:207], a[172:175], v[48:63]
    s_sub_u32 s42, s32, 16384
    s_cmp_lt_u32 s42, s33
    s_cselect_b32 s42, s42, s43
    s_add_u32 m0, s34, 16384
    s_nop 0
    s_waitcnt lgkmcnt(6)
    v_mfma_f32_32x32x16_bf16 v[32:47], a[208:211], a[144:147], v[32:47]
    ds_read_b128 a[240:243], v241 offset:25088
    v_exp_f32 v128, v8
    v_exp_f32 v129, v9
    v_cvt_pk_bf16_f32 v99, v134, v135
    v_mfma_f32_32x32x16_bf16 v[48:63], a[208:211], a[176:179], v[48:63]
    v_add_f32 v136, v136, v134
    v_add_f32 v137, v137, v135
    v_exp_f32 v130, v10
    v_mfma_f32_32x32x16_bf16 v[32:47], a[212:215], a[148:151], v[32:47]
    ds_read_b128 a[244:247], v241 offset:27136
    buffer_load_dwordx4 v242, s[16:19], s42 offen offset:0 sc1 lds
    v_exp_f32 v131, v11
    v_cvt_pk_bf16_f32 v100, v128, v129
    v_add_f32 v136, v136, v128
    v_mfma_f32_32x32x16_bf16 v[48:63], a[212:215], a[180:183], v[48:63]
    v_add_f32 v137, v137, v129
    v_exp_f32 v132, v12
    v_exp_f32 v133, v13
    s_waitcnt lgkmcnt(6)
    v_mfma_f32_32x32x16_bf16 v[32:47], a[216:219], a[152:155], v[32:47]
    ds_read_b128 a[248:251], v241 offset:29184
    v_cvt_pk_bf16_f32 v101, v130, v131
    v_add_f32 v136, v136, v130
    v_add_f32 v137, v137, v131
    v_mfma_f32_32x32x16_bf16 v[48:63], a[216:219], a[184:187], v[48:63]
    buffer_load_dwordx4 v242, s[16:19], s42 offen offset:1024 sc1 lds
    v_exp_f32 v134, v14
    v_exp_f32 v135, v15
    v_cvt_pk_bf16_f32 v102, v132, v133
    v_mfma_f32_32x32x16_bf16 v[32:47], a[220:223], a[156:159], v[32:47]
    ds_read_b128 a[252:255], v241 offset:31232
    v_add_f32 v136, v136, v132
    v_add_f32 v137, v137, v133
    v_exp_f32 v138, v16
    v_mfma_f32_32x32x16_bf16 v[48:63], a[220:223], a[188:191], v[48:63]
    v_exp_f32 v139, v17
    v_cvt_pk_bf16_f32 v103, v134, v135
    v_add_f32 v136, v136, v134
    v_add_f32 v137, v137, v135
    s_waitcnt lgkmcnt(6)
    v_mfma_f32_32x32x16_bf16 a[0:15], a[224:227], v[112:115], a[0:15]
    s_waitcnt vmcnt(18)
    s_barrier
    s_add_u32 s35, s35, 32768
    s_cmp_ge_u32 s35, 163840
    s_cselect_b32 s35, 0, s35
    v_add_u32 v241, s35, v239
    ds_read_b128 a[192:195], v241 offset:0
    buffer_load_dwordx4 v242, s[16:19], s42 offen offset:2048 sc1 lds
    v_mfma_f32_32x32x16_bf16 a[64:79], a[224:227], v[120:123], a[64:79]
    v_add_f32 v224, v136, v137
    v_exp_f32 v130, v18
    v_exp_f32 v131, v19
    v_mfma_f32_32x32x16_bf16 a[16:31], a[228:231], v[112:115], a[16:31]
    ds_read_b128 a[196:199], v241 offset:512
    v_cvt_pk_bf16_f32 v104, v138, v139
    v_exp_f32 v132, v20
    v_exp_f32 v133, v21
    v_mfma_f32_32x32x16_bf16 a[80:95], a[228:231], v[120:123], a[80:95]
    buffer_load_dwordx4 v242, s[16:19], s42 offen offset:3072 sc1 lds
    v_cvt_pk_bf16_f32 v105, v130, v131
    v_add_f32 v138, v138, v130
    v_add_f32 v139, v139, v131
    s_waitcnt lgkmcnt(6)
    v_mfma_f32_32x32x16_bf16 a[32:47], a[232:235], v[112:115], a[32:47]
    ds_read_b128 a[200:203], v241 offset:2048
    v_exp_f32 v134, v22
    v_exp_f32 v135, v23
    v_mfma_f32_32x32x16_bf16 a[96:111], a[232:235], v[120:123], a[96:111]
    v_cvt_pk_bf16_f32 v106, v132, v133
    v_add_f32 v138, v138, v132
    v_add_f32 v139, v139, v133
    v_exp_f32 v128, v24
    v_mfma_f32_32x32x16_bf16 a[48:63], a[236:239], v[112:115], a[48:63]
    ds_read_b128 a[204:207], v241 offset:2560
    s_add_u32 s32, s32, 32768
    s_add_u32 s34, s34, 32768
    s_cmp_ge_u32 s34, 163840
    s_cselect_b32 s24, 163840, 0
    s_sub_u32 s34, s34, s24
    v_mfma_f32_32x32x16_bf16 a[112:127], a[236:239], v[120:123], a[112:127]
    v_exp_f32 v129, v25
    v_cvt_pk_bf16_f32 v107, v134, v135
    v_add_f32 v138, v138, v134
    v_add_f32 v139, v139, v135
    s_waitcnt lgkmcnt(6)
    v_mfma_f32_32x32x16_bf16 a[0:15], a[240:243], v[116:119], a[0:15]
    ds_read_b128 a[208:211], v241 offset:4096
    v_exp_f32 v130, v26
    v_exp_f32 v131, v27
    v_mfma_f32_32x32x16_bf16 a[64:79], a[240:243], v[124:127], a[64:79]
    buffer_load_dword v252, v251, s[60:63], s100 offen
    s_add_u32 s100, s100, 2048
    v_cvt_pk_bf16_f32 v108, v128, v129
    v_add_f32 v138, v138, v128
    v_add_f32 v139, v139, v129
    v_mfma_f32_32x32x16_bf16 a[16:31], a[244:247], v[116:119], a[16:31]
    ds_read_b128 a[212:215], v241 offset:4608
    v_exp_f32 v132, v28
    v_exp_f32 v133, v29
    v_cvt_pk_bf16_f32 v109, v130, v131
    v_mfma_f32_32x32x16_bf16 a[80:95], a[244:247], v[124:127], a[80:95]
    v_add_f32 v138, v138, v130
    v_add_f32 v139, v139, v131
    v_exp_f32 v134, v30
    s_waitcnt lgkmcnt(6)
    v_mfma_f32_32x32x16_bf16 a[32:47], a[248:251], v[116:119], a[32:47]
    ds_read_b128 a[216:219], v241 offset:6144
    s_add_u32 s27, s27, 1
    s_cmp_lt_u32 s27, 8
    s_cbranch_scc1 ka_l2p11
ka_l2r12:
    v_exp_f32 v135, v31
    v_mfma_f32_32x32x16_bf16 a[96:111], a[248:251], v[124:127], a[96:111]
    v_cvt_pk_bf16_f32 v110, v132, v133
    v_add_f32 v138, v138, v132
    v_add_f32 v139, v139, v133
    v_cvt_pk_bf16_f32 v111, v134, v135
    v_add_f32 v138, v138, v134
    v_mfma_f32_32x32x16_bf16 a[48:63], a[252:255], v[116:119], a[48:63]
    ds_read_b128 a[220:223], v241 offset:6656
    v_add_f32 v139, v139, v135
    v_add_f32 v225, v138, v139
    v_max_f32 v230, v224, v225
    v_cmp_lt_f32 vcc, s38, v230
    v_mfma_f32_32x32x16_bf16 a[112:127], a[252:255], v[124:127], a[112:127]
    s_cbranch_vccnz ka_rare16
ka_rr15:
    s_sub_u32 s26, s26, 1
    s_cmp_lg_u32 s26, 0
    s_cbranch_scc1 ka_p1
    s_lshl2_add_u32 s36, s5, s6
    s_sub_u32 s36, s36, 60
    s_add_u32 s36, s36, 1
    s_cmp_le_u32 s36, 1
    s_cbranch_scc1 ka_fix19
ka_fixr20:
    s_waitcnt lgkmcnt(6)
    v_mfma_f32_32x32x16_bf16 v[16:31], a[192:195], a[160:163], v[80:95]
    ds_read_b128 a[224:227], v241 offset:16384
    v_add_f32 v226, v226, v224
    v_add_f32 v227, v227, v225
    v_exp_f32 v136, v32
    v_exp_f32 v137, v33
    v_mfma_f32_32x32x16_bf16 v[16:31], a[196:199], a[164:167], v[16:31]
    ds_read_b128 a[228:231], v241 offset:18432
    s_waitcnt vmcnt(11)
    buffer_store_dwordx4 v[192:195], v255, s[48:51], s45 offen offset:0
    v_exp_f32 v130, v34
    s_waitcnt lgkmcnt(6)
    v_mfma_f32_32x32x16_bf16 v[16:31], a[200:203], a[168:171], v[16:31]
    ds_read_b128 a[232:235], v241 offset:20480
    v_exp_f32 v131, v35
    v_cvt_pk_bf16_f32 v112, v136, v137
    v_exp_f32 v132, v36
    v_mfma_f32_32x32x16_bf16 v[16:31], a[204:207], a[172:175], v[16:31]
    ds_read_b128 a[236:239], v241 offset:22528
    v_exp_f32 v133, v37
    v_cvt_pk_bf16_f32 v113, v130, v131
    v_add_f32 v136, v136, v130
    v_add_f32 v137, v137, v131
    s_waitcnt lgkmcnt(6)
    v_mfma_f32_32x32x16_bf16 v[16:31], a[208:211], a[176:179], v[16:31]
    ds_read_b128 a[240:243], v241 offset:16896
    s_add_u32 s27, s27, 1
    s_cmp_lt_u32 s27, 8
    s_cbranch_scc1 ka_l2p17
ka_l2r18:
    v_exp_f32 v134, v38
    v_mfma_f32_32x32x16_bf16 v[16:31], a[212:215], a[180:183], v[16:31]
    ds_read_b128 a[244:247], v241 offset:18944
    v_exp_f32 v135, v39
    v_cvt_pk_bf16_f32 v114, v132, v133
    v_add_f32 v136, v136, v132
    s_waitcnt lgkmcnt(6)
    v_mfma_f32_32x32x16_bf16 v[16:31], a[216:219], a[184:187], v[16:31]
    ds_read_b128 a[248:251], v241 offset:20992
    v_add_f32 v137, v137, v133
    v_exp_f32 v128, v40
    v_exp_f32 v129, v41
    v_mfma_f32_32x32x16_bf16 v[16:31], a[220:223], a[188:191], v[16:31]
    ds_read_b128 a[252:255], v241 offset:23040
    s_cmp_lt_u32 s32, s33
    s_cselect_b32 s41, s32, s43
    s_mov_b32 m0, s34
    s_nop 0
    s_waitcnt lgkmcnt(6)
    v_mfma_f32_32x32x16_bf16 a[0:15], a[224:227], v[96:99], a[0:15]
    ds_read_b128 a[192:195], v241 offset:8192
    v_cvt_pk_bf16_f32 v115, v134, v135
    v_add_f32 v136, v136, v134
    v_add_f32 v137, v137, v135
    v_exp_f32 v130, v42
    v_mfma_f32_32x32x16_bf16 a[64:79], a[224:227], v[104:107], a[64:79]
    v_exp_f32 v131, v43
    v_cvt_pk_bf16_f32 v116, v128, v129
    v_add_f32 v136, v136, v128
    v_add_f32 v137, v137, v129
    v_exp_f32 v132, v44
    v_mfma_f32_32x32x16_bf16 a[16:31], a[228:231], v[96:99], a[16:31]
    ds_read_b128 a[196:199], v241 offset:8704
    buffer_load_dwordx4 v242, s[16:19], s41 offen offset:0 sc1 lds
    v_exp_f32 v133, v45
    v_cvt_pk_bf16_f32 v117, v130, v131
    v_add_f32 v136, v136, v130
    v_add_f32 v137, v137, v131
    v_mfma_f32_32x32x16_bf16 a[80:95], a[228:231], v[104:107], a[80:95]
    v_exp_f32 v134, v46
    v_exp_f32 v135, v47
    v_cvt_pk_bf16_f32 v118, v132, v133
    v_add_f32 v136, v136, v132
    s_waitcnt lgkmcnt(6)
    v_mfma_f32_32x32x16_bf16 a[32:47], a[232:235], v[96:99], a[32:47]
    ds_read_b128 a[200:203], v241 offset:10240
    v_add_f32 v137, v137, v133
    v_exp_f32 v138, v48
    v_exp_f32 v139, v49
    v_cvt_pk_bf16_f32 v119, v134, v135
    v_mfma_f32_32x32x16_bf16 a[96:111], a[232:235], v[104:107], a[96:111]
    buffer_load_dwordx4 v242, s[16:19], s41 offen offset:1024 sc1 lds
    v_add_f32 v136, v136, v134
    v_add_f32 v137, v137, v135
    v_add_f32 v224, v136, v137
    v_exp_f32 v130, v50
    v_mfma_f32_32x32x16_bf16 a[48:63], a[236:239], v[96:99], a[48:63]
    ds_read_b128 a[204:207], v241 offset:10752
    v_exp_f32 v131, v51
    v_cvt_pk_bf16_f32 v120, v138, v139
    v_exp_f32 v132, v52
    v_mfma_f32_32x32x16_bf16 a[112:127], a[236:239], v[104:107], a[112:127]
    v_exp_f32 v133, v53
    v_cvt_pk_bf16_f32 v121, v130, v131
    v_add_f32 v138, v138, v130
    v_add_f32 v139, v139, v131
    v_exp_f32 v134, v54
    s_waitcnt lgkmcnt(6)
    v_mfma_f32_32x32x16_bf16 a[0:15], a[240:243], v[100:103], a[0:15]
    ds_read_b128 a[208:211], v241 offset:12288
    buffer_load_dwordx4 v242, s[16:19], s41 offen offset:2048 sc1 lds
    v_exp_f32 v135, v55
    v_cvt_pk_bf16_f32 v122, v132, v133
    v_add_f32 v138, v138, v132
    v_mfma_f32_32x32x16_bf16 a[64:79], a[240:243], v[108:111], a[64:79]
    v_add_f32 v139, v139, v133
    v_exp_f32 v128, v56
    v_exp_f32 v129, v57
    v_cvt_pk_bf16_f32 v123, v134, v135
    v_add_f32 v138, v138, v134
    v_mfma_f32_32x32x16_bf16 a[16:31], a[244:247], v[100:103], a[16:31]
    ds_read_b128 a[212:215], v241 offset:12800
    v_add_f32 v139, v139, v135
    v_exp_f32 v130, v58
    v_exp_f32 v131, v59
    v_mfma_f32_32x32x16_bf16 a[80:95], a[244:247], v[108:111], a[80:95]
    buffer_load_dwordx4 v242, s[16:19], s41 offen offset:3072 sc1 lds
    v_cvt_pk_bf16_f32 v124, v128, v129
    v_add_f32 v138, v138, v128
    v_add_f32 v139, v139, v129
    v_exp_f32 v132, v60
    s_waitcnt lgkmcnt(6)
    v_mfma_f32_32x32x16_bf16 a[32:47], a[248:251], v[100:103], a[32:47]
    ds_read_b128 a[216:219], v241 offset:14336
    v_exp_f32 v133, v61
    v_cvt_pk_bf16_f32 v125, v130, v131
    v_add_f32 v138, v138, v130
    v_add_f32 v139, v139, v131
    v_mfma_f32_32x32x16_bf16 a[96:111], a[248:251], v[108:111], a[96:111]
    v_exp_f32 v134, v62
    v_exp_f32 v135, v63
    v_cvt_pk_bf16_f32 v126, v132, v133
    v_add_f32 v138, v138, v132
    v_add_f32 v139, v139, v133
    v_mfma_f32_32x32x16_bf16 a[48:63], a[252:255], v[100:103], a[48:63]
    ds_read_b128 a[220:223], v241 offset:14848
    v_cvt_pk_bf16_f32 v127, v134, v135
    v_add_f32 v138, v138, v134
    v_add_f32 v139, v139, v135
    v_add_f32 v225, v138, v139
    v_max_f32 v230, v224, v225
    v_cmp_lt_f32 vcc, s38, v230
    v_mfma_f32_32x32x16_bf16 a[112:127], a[252:255], v[108:111], a[112:127]
    s_cbranch_vccnz ka_rare22
ka_rr21:
    s_add_u32 s36, s36, 1
    s_cmp_le_u32 s36, 1
    s_cbranch_scc1 ka_fix25
ka_fixr26:
    s_waitcnt lgkmcnt(6)
    v_mfma_f32_32x32x16_bf16 v[48:63], a[192:195], a[160:163], v[80:95]
    ds_read_b128 a[224:227], v241 offset:24576
    v_add_f32 v226, v226, v224
    v_add_f32 v227, v227, v225
    v_exp_f32 v138, v16
    v_mfma_f32_32x32x16_bf16 v[48:63], a[196:199], a[164:167], v[48:63]
    ds_read_b128 a[228:231], v241 offset:26624
    s_waitcnt vmcnt(10)
    buffer_store_dwordx4 v[196:199], v255, s[48:51], s45 offen offset:256
    s_waitcnt lgkmcnt(6)
    v_mfma_f32_32x32x16_bf16 v[48:63], a[200:203], a[168:171], v[48:63]
    ds_read_b128 a[232:235], v241 offset:28672
    v_exp_f32 v139, v17
    v_exp_f32 v130, v18
    v_mfma_f32_32x32x16_bf16 v[48:63], a[204:207], a[172:175], v[48:63]
    ds_read_b128 a[236:239], v241 offset:30720
    s_sub_u32 s42, s32, 16384
    s_cmp_lt_u32 s42, s33
    s_cselect_b32 s42, s42, s43
    s_add_u32 m0, s34, 16384
    s_nop 0
    s_waitcnt lgkmcnt(6)
    v_mfma_f32_32x32x16_bf16 v[48:63], a[208:211], a[176:179], v[48:63]
    ds_read_b128 a[240:243], v241 offset:25088
    v_exp_f32 v131, v19
    v_cvt_pk_bf16_f32 v104, v138, v139
    v_mfma_f32_32x32x16_bf16 v[48:63], a[212:215], a[180:183], v[48:63]
    ds_read_b128 a[244:247], v241 offset:27136
    v_exp_f32 v132, v20
    s_waitcnt lgkmcnt(6)
    v_mfma_f32_32x32x16_bf16 v[48:63], a[216:219], a[184:187], v[48:63]
    ds_read_b128 a[248:251], v241 offset:29184
    buffer_load_dwordx4 v242, s[16:19], s42 offen offset:0 sc1 lds
    v_exp_f32 v133, v21
    v_cvt_pk_bf16_f32 v105, v130, v131
    v_mfma_f32_32x32x16_bf16 v[48:63], a[220:223], a[188:191], v[48:63]
    ds_read_b128 a[252:255], v241 offset:31232
    v_add_f32 v138, v138, v130
    v_add_f32 v139, v139, v131
    s_waitcnt lgkmcnt(6)
    v_mfma_f32_32x32x16_bf16 a[0:15], a[224:227], v[112:115], a[0:15]
    s_waitcnt vmcnt(20)
    s_barrier
    s_add_u32 s35, s35, 32768
    s_cmp_ge_u32 s35, 163840
    s_cselect_b32 s35, 0, s35
    v_add_u32 v241, s35, v239
    ds_read_b128 a[192:195], v241 offset:0
    v_mfma_f32_32x32x16_bf16 a[64:79], a[224:227], v[120:123], a[64:79]
    buffer_load_dwordx4 v242, s[16:19], s42 offen offset:1024 sc1 lds
    v_exp_f32 v134, v22
    v_exp_f32 v135, v23
    v_mfma_f32_32x32x16_bf16 a[16:31], a[228:231], v[112:115], a[16:31]
    ds_read_b128 a[196:199], v241 offset:512
    v_cvt_pk_bf16_f32 v106, v132, v133
    v_add_f32 v138, v138, v132
    v_add_f32 v139, v139, v133
    v_mfma_f32_32x32x16_bf16 a[80:95], a[228:231], v[120:123], a[80:95]
    v_exp_f32 v128, v24
    v_exp_f32 v129, v25
    s_waitcnt lgkmcnt(6)
    v_mfma_f32_32x32x16_bf16 a[32:47], a[232:235], v[112:115], a[32:47]
    ds_read_b128 a[200:203], v241 offset:2048
    buffer_load_dwordx4 v242, s[16:19], s42 offen offset:2048 sc1 lds
    v_cvt_pk_bf16_f32 v107, v134, v135
    v_add_f32 v138, v138, v134
    v_mfma_f32_32x32x16_bf16 a[96:111], a[232:235], v[120:123], a[96:111]
    v_add_f32 v139, v139, v135
    v_exp_f32 v130, v26
    v_mfma_f32_32x32x16_bf16 a[48:63], a[236:239], v[112:115], a[48:63]
    ds_read_b128 a[204:207], v241 offset:2560
    buffer_load_dwordx4 v242, s[16:19], s42 offen offset:3072 sc1 lds
    v_exp_f32 v131, v27
    v_cvt_pk_bf16_f32 v108, v128, v129
    v_mfma_f32_32x32x16_bf16 a[112:127], a[236:239], v[120:123], a[112:127]
    v_add_f32 v138, v138, v128
    v_add_f32 v139, v139, v129
    v_exp_f32 v132, v28
    s_waitcnt lgkmcnt(6)
    v_mfma_f32_32x32x16_bf16 a[0:15], a[240:243], v[116:119], a[0:15]
    ds_read_b128 a[208:211], v241 offset:4096
    v_exp_f32 v133, v29
    v_mfma_f32_32x32x16_bf16 a[64:79], a[240:243], v[124:127], a[64:79]
    s_add_u32 s32, s32, 32768
    s_add_u32 s34, s34, 32768
    s_cmp_ge_u32 s34, 163840
    s_cselect_b32 s24, 163840, 0
    s_sub_u32 s34, s34, s24
    v_cvt_pk_bf16_f32 v109, v130, v131
    v_mfma_f32_32x32x16_bf16 a[16:31], a[244:247], v[116:119], a[16:31]
    ds_read_b128 a[212:215], v241 offset:4608
    v_add_f32 v138, v138, v130
    v_add_f32 v139, v139, v131
    v_exp_f32 v134, v30
    v_mfma_f32_32x32x16_bf16 a[80:95], a[244:247], v[124:127], a[80:95]
    v_exp_f32 v135, v31
    s_waitcnt lgkmcnt(6)
    v_mfma_f32_32x32x16_bf16 a[32:47], a[248:251], v[116:119], a[32:47]
    ds_read_b128 a[216:219], v241 offset:6144
    s_add_u32 s27, s27, 1
    s_cmp_lt_u32 s27, 8
    s_cbranch_scc1 ka_l2p23
ka_l2r24:
    v_cvt_pk_bf16_f32 v110, v132, v133
    v_mfma_f32_32x32x16_bf16 a[96:111], a[248:251], v[124:127], a[96:111]
    v_add_f32 v138, v138, v132
    v_add_f32 v139, v139, v133
    v_cvt_pk_bf16_f32 v111, v134, v135
    v_add_f32 v138, v138, v134
    v_mfma_f32_32x32x16_bf16 a[48:63], a[252:255], v[116:119], a[48:63]
    ds_read_b128 a[220:223], v241 offset:6656
    v_add_f32 v139, v139, v135
    v_add_f32 v225, v138, v139
    v_cmp_lt_f32 vcc, s38, v225
    v_mfma_f32_32x32x16_bf16 a[112:127], a[252:255], v[124:127], a[112:127]
    s_cbranch_vccnz ka_rare28
ka_rr27:
    s_nop 7
    v_mov_b32 v230, v226
    s_nop 1
    v_permlane32_swap_b32 v226, v230
    s_nop 0
    v_add_f32 v230, v230, v226
    v_rcp_f32 v230, v230
    s_nop 0
    v_accvgpr_read_b32 v160, a0
    v_accvgpr_read_b32 v161, a1
    v_accvgpr_read_b32 v162, a2
    v_accvgpr_read_b32 v163, a3
    v_accvgpr_read_b32 v164, a4
    v_accvgpr_read_b32 v165, a5
    v_accvgpr_read_b32 v166, a6
    v_accvgpr_read_b32 v167, a7
    v_mul_f32 v160, v160, v230
    v_mul_f32 v161, v161, v230
    v_mul_f32 v162, v162, v230
    v_mul_f32 v163, v163, v230
    v_mul_f32 v164, v164, v230
    v_mul_f32 v165, v165, v230
    v_mul_f32 v166, v166, v230
    v_mul_f32 v167, v167, v230
    v_cvt_pk_bf16_f32 v176, v160, v161
    v_cvt_pk_bf16_f32 v177, v162, v163
    v_cvt_pk_bf16_f32 v178, v164, v165
    v_cvt_pk_bf16_f32 v179, v166, v167
    buffer_store_dwordx4 v[176:179], v244, s[20:23], s39 offen offset:0 sc1
    v_accvgpr_read_b32 v168, a8
    v_accvgpr_read_b32 v169, a9
    v_accvgpr_read_b32 v170, a10
    v_accvgpr_read_b32 v171, a11
    v_accvgpr_read_b32 v172, a12
    v_accvgpr_read_b32 v173, a13
    v_accvgpr_read_b32 v174, a14
    v_accvgpr_read_b32 v175, a15
    v_mul_f32 v168, v168, v230
    v_mul_f32 v169, v169, v230
    v_mul_f32 v170, v170, v230
    v_mul_f32 v171, v171, v230
    v_mul_f32 v172, v172, v230
    v_mul_f32 v173, v173, v230
    v_mul_f32 v174, v174, v230
    v_mul_f32 v175, v175, v230
    v_cvt_pk_bf16_f32 v180, v168, v169
    v_cvt_pk_bf16_f32 v181, v170, v171
    v_cvt_pk_bf16_f32 v182, v172, v173
    v_cvt_pk_bf16_f32 v183, v174, v175
    buffer_store_dwordx4 v[180:183], v244, s[20:23], s39 offen offset:512 sc1
    v_accvgpr_read_b32 v160, a16
    v_accvgpr_read_b32 v161, a17
    v_accvgpr_read_b32 v162, a18
    v_accvgpr_read_b32 v163, a19
    v_accvgpr_read_b32 v164, a20
    v_accvgpr_read_b32 v165, a21
    v_accvgpr_read_b32 v166, a22
    v_accvgpr_read_b32 v167, a23
    v_mul_f32 v160, v160, v230
    v_mul_f32 v161, v161, v230
    v_mul_f32 v162, v162, v230
    v_mul_f32 v163, v163, v230
    v_mul_f32 v164, v164, v230
    v_mul_f32 v165, v165, v230
    v_mul_f32 v166, v166, v230
    v_mul_f32 v167, v167, v230
    v_cvt_pk_bf16_f32 v184, v160, v161
    v_cvt_pk_bf16_f32 v185, v162, v163
    v_cvt_pk_bf16_f32 v186, v164, v165
    v_cvt_pk_bf16_f32 v187, v166, v167
    buffer_store_dwordx4 v[184:187], v244, s[20:23], s39 offen offset:1024 sc1
    v_accvgpr_read_b32 v168, a24
    v_accvgpr_read_b32 v169, a25
    v_accvgpr_read_b32 v170, a26
    v_accvgpr_read_b32 v171, a27
    v_accvgpr_read_b32 v172, a28
    v_accvgpr_read_b32 v173, a29
    v_accvgpr_read_b32 v174, a30
    v_accvgpr_read_b32 v175, a31
    v_mul_f32 v168, v168, v230
    v_mul_f32 v169, v169, v230
    v_mul_f32 v170, v170, v230
    v_mul_f32 v171, v171, v230
    v_mul_f32 v172, v172, v230
    v_mul_f32 v173, v173, v230
    v_mul_f32 v174, v174, v230
    v_mul_f32 v175, v175, v230
    v_cvt_pk_bf16_f32 v188, v168, v169
    v_cvt_pk_bf16_f32 v189, v170, v171
    v_cvt_pk_bf16_f32 v190, v172, v173
    v_cvt_pk_bf16_f32 v191, v174, v175
    buffer_store_dwordx4 v[188:191], v244, s[20:23], s39 offen offset:1536 sc1
    v_accvgpr_read_b32 v160, a32
    v_accvgpr_read_b32 v161, a33
    v_accvgpr_read_b32 v162, a34
    v_accvgpr_read_b32 v163, a35
    v_accvgpr_read_b32 v164, a36
    v_accvgpr_read_b32 v165, a37
    v_accvgpr_read_b32 v166, a38
    v_accvgpr_read_b32 v167, a39
    v_mul_f32 v160, v160, v230
    v_mul_f32 v161, v161, v230
    v_mul_f32 v162, v162, v230
    v_mul_f32 v163, v163, v230
    v_mul_f32 v164, v164, v230
    v_mul_f32 v165, v165, v230
    v_mul_f32 v166, v166, v230
    v_mul_f32 v167, v167, v230
    v_cvt_pk_bf16_f32 v176, v160, v161
    v_cvt_pk_bf16_f32 v177, v162, v163
    v_cvt_pk_bf16_f32 v178, v164, v165
    v_cvt_pk_bf16_f32 v179, v166, v167
    buffer_store_dwordx4 v[176:179], v244, s[20:23], s39 offen offset:2048 sc1
    v_accvgpr_read_b32 v168, a40
    v_accvgpr_read_b32 v169, a41
    v_accvgpr_read_b32 v170, a42
    v_accvgpr_read_b32 v171, a43
    v_accvgpr_read_b32 v172, a44
    v_accvgpr_read_b32 v173, a45
    v_accvgpr_read_b32 v174, a46
    v_accvgpr_read_b32 v175, a47
    v_mul_f32 v168, v168, v230
    v_mul_f32 v169, v169, v230
    v_mul_f32 v170, v170, v230
    v_mul_f32 v171, v171, v230
    v_mul_f32 v172, v172, v230
    v_mul_f32 v173, v173, v230
    v_mul_f32 v174, v174, v230
    v_mul_f32 v175, v175, v230
    v_cvt_pk_bf16_f32 v180, v168, v169
    v_cvt_pk_bf16_f32 v181, v170, v171
    v_cvt_pk_bf16_f32 v182, v172, v173
    v_cvt_pk_bf16_f32 v183, v174, v175
    buffer_store_dwordx4 v[180:183], v244, s[20:23], s39 offen offset:2560 sc1
    v_accvgpr_read_b32 v160, a48
    v_accvgpr_read_b32 v161, a49
    v_accvgpr_read_b32 v162, a50
    v_accvgpr_read_b32 v163, a51
    v_accvgpr_read_b32 v164, a52
    v_accvgpr_read_b32 v165, a53
    v_accvgpr_read_b32 v166, a54
    v_accvgpr_read_b32 v167, a55
    v_mul_f32 v160, v160, v230
    v_mul_f32 v161, v161, v230
    v_mul_f32 v162, v162, v230
    v_mul_f32 v163, v163, v230
    v_mul_f32 v164, v164, v230
    v_mul_f32 v165, v165, v230
    v_mul_f32 v166, v166, v230
    v_mul_f32 v167, v167, v230
    v_cvt_pk_bf16_f32 v184, v160, v161
    v_cvt_pk_bf16_f32 v185, v162, v163
    v_cvt_pk_bf16_f32 v186, v164, v165
    v_cvt_pk_bf16_f32 v187, v166, v167
    buffer_store_dwordx4 v[184:187], v244, s[20:23], s39 offen offset:3072 sc1
    v_accvgpr_read_b32 v168, a56
    v_accvgpr_read_b32 v169, a57
    v_accvgpr_read_b32 v170, a58
    v_accvgpr_read_b32 v171, a59
    v_accvgpr_read_b32 v172, a60
    v_accvgpr_read_b32 v173, a61
    v_accvgpr_read_b32 v174, a62
    v_accvgpr_read_b32 v175, a63
    v_mul_f32 v168, v168, v230
    v_mul_f32 v169, v169, v230
    v_mul_f32 v170, v170, v230
    v_mul_f32 v171, v171, v230
    v_mul_f32 v172, v172, v230
    v_mul_f32 v173, v173, v230
    v_mul_f32 v174, v174, v230
    v_mul_f32 v175, v175, v230
    v_cvt_pk_bf16_f32 v188, v168, v169
    v_cvt_pk_bf16_f32 v189, v170, v171
    v_cvt_pk_bf16_f32 v190, v172, v173
    v_cvt_pk_bf16_f32 v191, v174, v175
    buffer_store_dwordx4 v[188:191], v244, s[20:23], s39 offen offset:3584 sc1
    s_lshl_b32 s26, s5, 2
    s_sub_u32 s26, 29, s26
.p2align 3
ka_p2:
    s_add_u32 s36, s36, 1
    s_cmp_le_u32 s36, 1
    s_cbranch_scc1 ka_fix29
ka_fixr30:
    s_waitcnt lgkmcnt(6)
    v_mfma_f32_32x32x16_bf16 v[16:31], a[192:195], a[160:163], v[80:95]
    ds_read_b128 a[224:227], v241 offset:16384
    v_add_f32 v227, v227, v225
    v_exp_f32 v138, v48
    v_exp_f32 v139, v49
    v_mfma_f32_32x32x16_bf16 v[16:31], a[196:199], a[164:167], v[16:31]
    ds_read_b128 a[228:231], v241 offset:18432
    s_cmp_lt_u32 s32, s33
    s_cselect_b32 s41, s32, s43
    s_mov_b32 m0, s34
    s_nop 0
    s_waitcnt lgkmcnt(6)
    v_mfma_f32_32x32x16_bf16 v[16:31], a[200:203], a[168:171], v[16:31]
    ds_read_b128 a[232:235], v241 offset:20480
    v_exp_f32 v130, v50
    v_exp_f32 v131, v51
    v_cvt_pk_bf16_f32 v120, v138, v139
    v_mfma_f32_32x32x16_bf16 v[16:31], a[204:207], a[172:175], v[16:31]
    ds_read_b128 a[236:239], v241 offset:22528
    buffer_load_dwordx4 v242, s[16:19], s41 offen offset:0 sc1 lds
    v_exp_f32 v132, v52
    s_waitcnt lgkmcnt(6)
    v_mfma_f32_32x32x16_bf16 v[16:31], a[208:211], a[176:179], v[16:31]
    ds_read_b128 a[240:243], v241 offset:16896
    v_exp_f32 v133, v53
    v_cvt_pk_bf16_f32 v121, v130, v131
    v_add_f32 v138, v138, v130
    v_add_f32 v139, v139, v131
    v_mfma_f32_32x32x16_bf16 v[16:31], a[212:215], a[180:183], v[16:31]
    ds_read_b128 a[244:247], v241 offset:18944
    v_exp_f32 v134, v54
    v_exp_f32 v135, v55
    s_waitcnt lgkmcnt(6)
    v_mfma_f32_32x32x16_bf16 v[16:31], a[216:219], a[184:187], v[16:31]
    ds_read_b128 a[248:251], v241 offset:20992
    buffer_load_dwordx4 v242, s[16:19], s41 offen offset:1024 sc1 lds
    v_cvt_pk_bf16_f32 v122, v132, v133
    v_add_f32 v138, v138, v132
    v_add_f32 v139, v139, v133
    v_mfma_f32_32x32x16_bf16 v[16:31], a[220:223], a[188:191], v[16:31]
    ds_read_b128 a[252:255], v241 offset:23040
    v_exp_f32 v128, v56
    v_exp_f32 v129, v57
    v_cvt_pk_bf16_f32 v123, v134, v135
    s_waitcnt lgkmcnt(6)
    v_mfma_f32_32x32x16_bf16 a[64:79], a[224:227], v[104:107], a[64:79]
    ds_read_b128 a[192:195], v241 offset:8192
    v_add_f32 v138, v138, v134
    v_add_f32 v139, v139, v135
    v_exp_f32 v130, v58
    v_mfma_f32_32x32x16_bf16 a[80:95], a[228:231], v[104:107], a[80:95]
    ds_read_b128 a[196:199], v241 offset:8704
    buffer_load_dwordx4 v242, s[16:19], s41 offen offset:2048 sc1 lds
    v_exp_f32 v131, v59
    v_cvt_pk_bf16_f32 v124, v128, v129
    s_waitcnt lgkmcnt(6)
    v_mfma_f32_32x32x16_bf16 a[96:111], a[232:235], v[104:107], a[96:111]
    ds_read_b128 a[200:203], v241 offset:10240
    v_add_f32 v138, v138, v128
    v_add_f32 v139, v139, v129
    v_exp_f32 v132, v60
    v_mfma_f32_32x32x16_bf16 a[112:127], a[236:239], v[104:107], a[112:127]
    ds_read_b128 a[204:207], v241 offset:10752
    v_exp_f32 v133, v61
    v_cvt_pk_bf16_f32 v125, v130, v131
    v_add_f32 v138, v138, v130
    v_add_f32 v139, v139, v131
    s_waitcnt lgkmcnt(6)
    v_mfma_f32_32x32x16_bf16 a[64:79], a[240:243], v[108:111], a[64:79]
    ds_read_b128 a[208:211], v241 offset:12288
    buffer_load_dwordx4 v242, s[16:19], s41 offen offset:3072 sc1 lds
    v_exp_f32 v134, v62
    v_exp_f32 v135, v63
    v_mfma_f32_32x32x16_bf16 a[80:95], a[244:247], v[108:111], a[80:95]
    ds_read_b128 a[212:215], v241 offset:12800
    v_cvt_pk_bf16_f32 v126, v132, v133
    v_add_f32 v138, v138, v132
    v_add_f32 v139, v139, v133
    s_waitcnt lgkmcnt(6)
    v_mfma_f32_32x32x16_bf16 a[96:111], a[248:251], v[108:111], a[96:111]
    ds_read_b128 a[216:219], v241 offset:14336
    v_cvt_pk_bf16_f32 v127, v134, v135
    v_add_f32 v138, v138, v134
    v_add_f32 v139, v139, v135
    v_add_f32 v225, v138, v139
    v_cmp_lt_f32 vcc, s38, v225
    v_mfma_f32_32x32x16_bf16 a[112:127], a[252:255], v[108:111], a[112:127]
    ds_read_b128 a[220:223], v241 offset:14848
    s_cbranch_vccnz ka_rare32
ka_rr31:
    s_add_u32 s36, s36, 1
    s_cmp_le_u32 s36, 1
    s_cbranch_scc1 ka_fix35
ka_fixr36:
    s_waitcnt lgkmcnt(6)
    v_mfma_f32_32x32x16_bf16 v[48:63], a[192:195], a[160:163], v[80:95]
    ds_read_b128 a[224:227], v241 offset:24576
    v_add_f32 v227, v227, v225
    v_exp_f32 v138, v16
    v_exp_f32 v139, v17
    v_exp_f32 v130, v18
    v_mfma_f32_32x32x16_bf16 v[48:63], a[196:199], a[164:167], v[48:63]
    ds_read_b128 a[228:231], v241 offset:26624
    s_sub_u32 s42, s32, 16384
    s_cmp_lt_u32 s42, s33
    s_cselect_b32 s42, s42, s43
    s_add_u32 m0, s34, 16384
    s_nop 0
    s_waitcnt lgkmcnt(6)
    v_mfma_f32_32x32x16_bf16 v[48:63], a[200:203], a[168:171], v[48:63]
    ds_read_b128 a[232:235], v241 offset:28672
    v_exp_f32 v131, v19
    v_cvt_pk_bf16_f32 v104, v138, v139
    v_exp_f32 v132, v20
    v_mfma_f32_32x32x16_bf16 v[48:63], a[204:207], a[172:175], v[48:63]
    ds_read_b128 a[236:239], v241 offset:30720
    buffer_load_dwordx4 v242, s[16:19], s42 offen offset:0 sc1 lds
    v_exp_f32 v133, v21
    v_cvt_pk_bf16_f32 v105, v130, v131
    v_add_f32 v138, v138, v130
    s_waitcnt lgkmcnt(6)
    v_mfma_f32_32x32x16_bf16 v[48:63], a[208:211], a[176:179], v[48:63]
    ds_read_b128 a[240:243], v241 offset:25088
    v_add_f32 v139, v139, v131
    v_exp_f32 v134, v22
    v_exp_f32 v135, v23
    v_cvt_pk_bf16_f32 v106, v132, v133
    v_mfma_f32_32x32x16_bf16 v[48:63], a[212:215], a[180:183], v[48:63]
    ds_read_b128 a[244:247], v241 offset:27136
    buffer_load_dwordx4 v242, s[16:19], s42 offen offset:1024 sc1 lds
    v_add_f32 v138, v138, v132
    v_add_f32 v139, v139, v133
    v_exp_f32 v128, v24
    s_waitcnt lgkmcnt(6)
    v_mfma_f32_32x32x16_bf16 v[48:63], a[216:219], a[184:187], v[48:63]
    ds_read_b128 a[248:251], v241 offset:29184
    v_exp_f32 v129, v25
    v_cvt_pk_bf16_f32 v107, v134, v135
    v_add_f32 v138, v138, v134
    v_add_f32 v139, v139, v135
    v_mfma_f32_32x32x16_bf16 v[48:63], a[220:223], a[188:191], v[48:63]
    ds_read_b128 a[252:255], v241 offset:31232
    buffer_load_dwordx4 v242, s[16:19], s42 offen offset:2048 sc1 lds
    v_exp_f32 v130, v26
    v_exp_f32 v131, v27
    s_waitcnt lgkmcnt(6)
    v_mfma_f32_32x32x16_bf16 a[64:79], a[224:227], v[120:123], a[64:79]
    s_waitcnt vmcnt(15)
    s_barrier
    s_add_u32 s35, s35, 32768
    s_cmp_ge_u32 s35, 163840
    s_cselect_b32 s35, 0, s35
    v_add_u32 v241, s35, v239
    ds_read_b128 a[192:195], v241 offset:0
    v_mfma_f32_32x32x16_bf16 a[80:95], a[228:231], v[120:123], a[80:95]
    ds_read_b128 a[196:199], v241 offset:512
    buffer_load_dwordx4 v242, s[16:19], s42 offen offset:3072 sc1 lds
    v_cvt_pk_bf16_f32 v108, v128, v129
    v_add_f32 v138, v138, v128
    v_add_f32 v139, v139, v129
    s_waitcnt lgkmcnt(6)
    v_mfma_f32_32x32x16_bf16 a[96:111], a[232:235], v[120:123], a[96:111]
    ds_read_b128 a[200:203], v241 offset:2048
    v_exp_f32 v132, v28
    v_exp_f32 v133, v29
    v_cvt_pk_bf16_f32 v109, v130, v131
    v_add_f32 v138, v138, v130
    v_add_f32 v139, v139, v131
    v_mfma_f32_32x32x16_bf16 a[112:127], a[236:239], v[120:123], a[112:127]
    ds_read_b128 a[204:207], v241 offset:2560
    s_add_u32 s32, s32, 32768
    s_add_u32 s34, s34, 32768
    s_cmp_ge_u32 s34, 163840
    s_cselect_b32 s24, 163840, 0
    s_sub_u32 s34, s34, s24
    s_waitcnt lgkmcnt(6)
    v_mfma_f32_32x32x16_bf16 a[64:79], a[240:243], v[124:127], a[64:79]
    ds_read_b128 a[208:211], v241 offset:4096
    v_exp_f32 v134, v30
    v_exp_f32 v135, v31
    v_cvt_pk_bf16_f32 v110, v132, v133
    v_add_f32 v138, v138, v132
    v_mfma_f32_32x32x16_bf16 a[80:95], a[244:247], v[124:127], a[80:95]
    ds_read_b128 a[212:215], v241 offset:4608
    s_add_u32 s27, s27, 1
    s_cmp_lt_u32 s27, 8
    s_cbranch_scc1 ka_l2p33
ka_l2r34:
    s_waitcnt lgkmcnt(6)
    v_mfma_f32_32x32x16_bf16 a[96:111], a[248:251], v[124:127], a[96:111]
    ds_read_b128 a[216:219], v241 offset:6144
    v_add_f32 v139, v139, v133
    v_cvt_pk_bf16_f32 v111, v134, v135
    v_add_f32 v138, v138, v134
    v_add_f32 v139, v139, v135
    v_add_f32 v225, v138, v139
    v_cmp_lt_f32 vcc, s38, v225
    v_mfma_f32_32x32x16_bf16 a[112:127], a[252:255], v[124:127], a[112:127]
    ds_read_b128 a[220:223], v241 offset:6656
    s_cbranch_vccnz ka_rare38
ka_rr37:
    s_sub_u32 s26, s26, 1
    s_cmp_lg_u32 s26, 0
    s_cbranch_scc1 ka_p2
    s_waitcnt lgkmcnt(0)
    ds_read_b128 a[224:227], v241 offset:16384
    ds_read_b128 a[228:231], v241 offset:18432
    ds_read_b128 a[232:235], v241 offset:20480
    ds_read_b128 a[236:239], v241 offset:22528
    ds_read_b128 a[240:243], v241 offset:16896
    ds_read_b128 a[244:247], v241 offset:18944
    ds_read_b128 a[248:251], v241 offset:20992
    ds_read_b128 a[252:255], v241 offset:23040
    ds_read_b128 a[192:195], v241 offset:24576
    ds_read_b128 a[196:199], v241 offset:26624
    ds_read_b128 a[200:203], v241 offset:28672
    ds_read_b128 a[204:207], v241 offset:30720
    ds_read_b128 a[208:211], v241 offset:25088
    ds_read_b128 a[212:215], v241 offset:27136
    ds_read_b128 a[216:219], v241 offset:29184
    s_waitcnt lgkmcnt(7)
    ds_read_b128 a[220:223], v241 offset:31232
    v_mfma_f32_32x32x16_bf16 a[64:79], a[224:227], v[104:107], a[64:79]
    v_add_f32 v227, v227, v225
    v_exp_f32 v138, v48
    v_exp_f32 v139, v49
    v_exp_f32 v130, v50
    v_exp_f32 v131, v51
    v_mfma_f32_32x32x16_bf16 a[80:95], a[228:231], v[104:107], a[80:95]
    v_cvt_pk_bf16_f32 v120, v138, v139
    v_exp_f32 v132, v52
    v_exp_f32 v133, v53
    v_cvt_pk_bf16_f32 v121, v130, v131
    v_add_f32 v138, v138, v130
    v_mfma_f32_32x32x16_bf16 a[96:111], a[232:235], v[104:107], a[96:111]
    v_add_f32 v139, v139, v131
    v_exp_f32 v134, v54
    v_exp_f32 v135, v55
    v_cvt_pk_bf16_f32 v122, v132, v133
    v_add_f32 v138, v138, v132
    v_add_f32 v139, v139, v133
    v_mfma_f32_32x32x16_bf16 a[112:127], a[236:239], v[104:107], a[112:127]
    v_exp_f32 v128, v56
    v_exp_f32 v129, v57
    v_cvt_pk_bf16_f32 v123, v134, v135
    v_add_f32 v138, v138, v134
    v_add_f32 v139, v139, v135
    v_exp_f32 v130, v58
    v_mfma_f32_32x32x16_bf16 a[64:79], a[240:243], v[108:111], a[64:79]
    v_exp_f32 v131, v59
    v_cvt_pk_bf16_f32 v124, v128, v129
    v_add_f32 v138, v138, v128
    v_add_f32 v139, v139, v129
    v_exp_f32 v132, v60
    v_mfma_f32_32x32x16_bf16 a[80:95], a[244:247], v[108:111], a[80:95]
    v_exp_f32 v133, v61
    v_cvt_pk_bf16_f32 v125, v130, v131
    v_add_f32 v138, v138, v130
    v_add_f32 v139, v139, v131
    v_exp_f32 v134, v62
    v_exp_f32 v135, v63
    v_mfma_f32_32x32x16_bf16 a[96:111], a[248:251], v[108:111], a[96:111]
    v_cvt_pk_bf16_f32 v126, v132, v133
    v_add_f32 v138, v138, v132
    v_add_f32 v139, v139, v133
    v_cvt_pk_bf16_f32 v127, v134, v135
    v_add_f32 v138, v138, v134
    v_add_f32 v139, v139, v135
    v_add_f32 v225, v138, v139
    v_cmp_lt_f32 vcc, s38, v225
    v_mfma_f32_32x32x16_bf16 a[112:127], a[252:255], v[108:111], a[112:127]
    s_cbranch_vccnz ka_rare40
ka_rr39:
    s_waitcnt lgkmcnt(0)
    v_add_f32 v227, v227, v225
    s_nop 0
    v_mfma_f32_32x32x16_bf16 a[64:79], a[192:195], v[120:123], a[64:79]
    v_mfma_f32_32x32x16_bf16 a[80:95], a[196:199], v[120:123], a[80:95]
    v_mfma_f32_32x32x16_bf16 a[96:111], a[200:203], v[120:123], a[96:111]
    v_mfma_f32_32x32x16_bf16 a[112:127], a[204:207], v[120:123], a[112:127]
    v_mfma_f32_32x32x16_bf16 a[64:79], a[208:211], v[124:127], a[64:79]
    v_mfma_f32_32x32x16_bf16 a[80:95], a[212:215], v[124:127], a[80:95]
    v_mfma_f32_32x32x16_bf16 a[96:111], a[216:219], v[124:127], a[96:111]
    v_mfma_f32_32x32x16_bf16 a[112:127], a[220:223], v[124:127], a[112:127]
    s_nop 7
    s_nop 7
    v_mov_b32 v230, v227
    s_nop 1
    v_permlane32_swap_b32 v227, v230
    s_nop 0
    v_add_f32 v230, v230, v227
    v_rcp_f32 v230, v230
    s_nop 0
    v_accvgpr_read_b32 v160, a64
    v_accvgpr_read_b32 v161, a65
    v_accvgpr_read_b32 v162, a66
    v_accvgpr_read_b32 v163, a67
    v_accvgpr_read_b32 v164, a68
    v_accvgpr_read_b32 v165, a69
    v_accvgpr_read_b32 v166, a70
    v_accvgpr_read_b32 v167, a71
    v_mul_f32 v160, v160, v230
    v_mul_f32 v161, v161, v230
    v_mul_f32 v162, v162, v230
    v_mul_f32 v163, v163, v230
    v_mul_f32 v164, v164, v230
    v_mul_f32 v165, v165, v230
    v_mul_f32 v166, v166, v230
    v_mul_f32 v167, v167, v230
    v_cvt_pk_bf16_f32 v176, v160, v161
    v_cvt_pk_bf16_f32 v177, v162, v163
    v_cvt_pk_bf16_f32 v178, v164, v165
    v_cvt_pk_bf16_f32 v179, v166, v167
    buffer_store_dwordx4 v[176:179], v244, s[20:23], s40 offen offset:0 sc1
    v_accvgpr_read_b32 v168, a72
    v_accvgpr_read_b32 v169, a73
    v_accvgpr_read_b32 v170, a74
    v_accvgpr_read_b32 v171, a75
    v_accvgpr_read_b32 v172, a76
    v_accvgpr_read_b32 v173, a77
    v_accvgpr_read_b32 v174, a78
    v_accvgpr_read_b32 v175, a79
    v_mul_f32 v168, v168, v230
    v_mul_f32 v169, v169, v230
    v_mul_f32 v170, v170, v230
    v_mul_f32 v171, v171, v230
    v_mul_f32 v172, v172, v230
    v_mul_f32 v173, v173, v230
    v_mul_f32 v174, v174, v230
    v_mul_f32 v175, v175, v230
    v_cvt_pk_bf16_f32 v180, v168, v169
    v_cvt_pk_bf16_f32 v181, v170, v171
    v_cvt_pk_bf16_f32 v182, v172, v173
    v_cvt_pk_bf16_f32 v183, v174, v175
    buffer_store_dwordx4 v[180:183], v244, s[20:23], s40 offen offset:512 sc1
    v_accvgpr_read_b32 v160, a80
    v_accvgpr_read_b32 v161, a81
    v_accvgpr_read_b32 v162, a82
    v_accvgpr_read_b32 v163, a83
    v_accvgpr_read_b32 v164, a84
    v_accvgpr_read_b32 v165, a85
    v_accvgpr_read_b32 v166, a86
    v_accvgpr_read_b32 v167, a87
    v_mul_f32 v160, v160, v230
    v_mul_f32 v161, v161, v230
    v_mul_f32 v162, v162, v230
    v_mul_f32 v163, v163, v230
    v_mul_f32 v164, v164, v230
    v_mul_f32 v165, v165, v230
    v_mul_f32 v166, v166, v230
    v_mul_f32 v167, v167, v230
    v_cvt_pk_bf16_f32 v184, v160, v161
    v_cvt_pk_bf16_f32 v185, v162, v163
    v_cvt_pk_bf16_f32 v186, v164, v165
    v_cvt_pk_bf16_f32 v187, v166, v167
    buffer_store_dwordx4 v[184:187], v244, s[20:23], s40 offen offset:1024 sc1
    v_accvgpr_read_b32 v168, a88
    v_accvgpr_read_b32 v169, a89
    v_accvgpr_read_b32 v170, a90
    v_accvgpr_read_b32 v171, a91
    v_accvgpr_read_b32 v172, a92
    v_accvgpr_read_b32 v173, a93
    v_accvgpr_read_b32 v174, a94
    v_accvgpr_read_b32 v175, a95
    v_mul_f32 v168, v168, v230
    v_mul_f32 v169, v169, v230
    v_mul_f32 v170, v170, v230
    v_mul_f32 v171, v171, v230
    v_mul_f32 v172, v172, v230
    v_mul_f32 v173, v173, v230
    v_mul_f32 v174, v174, v230
    v_mul_f32 v175, v175, v230
    v_cvt_pk_bf16_f32 v188, v168, v169
    v_cvt_pk_bf16_f32 v189, v170, v171
    v_cvt_pk_bf16_f32 v190, v172, v173
    v_cvt_pk_bf16_f32 v191, v174, v175
    buffer_store_dwordx4 v[188:191], v244, s[20:23], s40 offen offset:1536 sc1
    v_accvgpr_read_b32 v160, a96
    v_accvgpr_read_b32 v161, a97
    v_accvgpr_read_b32 v162, a98
    v_accvgpr_read_b32 v163, a99
    v_accvgpr_read_b32 v164, a100
    v_accvgpr_read_b32 v165, a101
    v_accvgpr_read_b32 v166, a102
    v_accvgpr_read_b32 v167, a103
    v_mul_f32 v160, v160, v230
    v_mul_f32 v161, v161, v230
    v_mul_f32 v162, v162, v230
    v_mul_f32 v163, v163, v230
    v_mul_f32 v164, v164, v230
    v_mul_f32 v165, v165, v230
    v_mul_f32 v166, v166, v230
    v_mul_f32 v167, v167, v230
    v_cvt_pk_bf16_f32 v176, v160, v161
    v_cvt_pk_bf16_f32 v177, v162, v163
    v_cvt_pk_bf16_f32 v178, v164, v165
    v_cvt_pk_bf16_f32 v179, v166, v167
    buffer_store_dwordx4 v[176:179], v244, s[20:23], s40 offen offset:2048 sc1
    v_accvgpr_read_b32 v168, a104
    v_accvgpr_read_b32 v169, a105
    v_accvgpr_read_b32 v170, a106
    v_accvgpr_read_b32 v171, a107
    v_accvgpr_read_b32 v172, a108
    v_accvgpr_read_b32 v173, a109
    v_accvgpr_read_b32 v174, a110
    v_accvgpr_read_b32 v175, a111
    v_mul_f32 v168, v168, v230
    v_mul_f32 v169, v169, v230
    v_mul_f32 v170, v170, v230
    v_mul_f32 v171, v171, v230
    v_mul_f32 v172, v172, v230
    v_mul_f32 v173, v173, v230
    v_mul_f32 v174, v174, v230
    v_mul_f32 v175, v175, v230
    v_cvt_pk_bf16_f32 v180, v168, v169
    v_cvt_pk_bf16_f32 v181, v170, v171
    v_cvt_pk_bf16_f32 v182, v172, v173
    v_cvt_pk_bf16_f32 v183, v174, v175
    buffer_store_dwordx4 v[180:183], v244, s[20:23], s40 offen offset:2560 sc1
    v_accvgpr_read_b32 v160, a112
    v_accvgpr_read_b32 v161, a113
    v_accvgpr_read_b32 v162, a114
    v_accvgpr_read_b32 v163, a115
    v_accvgpr_read_b32 v164, a116
    v_accvgpr_read_b32 v165, a117
    v_accvgpr_read_b32 v166, a118
    v_accvgpr_read_b32 v167, a119
    v_mul_f32 v160, v160, v230
    v_mul_f32 v161, v161, v230
    v_mul_f32 v162, v162, v230
    v_mul_f32 v163, v163, v230
    v_mul_f32 v164, v164, v230
    v_mul_f32 v165, v165, v230
    v_mul_f32 v166, v166, v230
    v_mul_f32 v167, v167, v230
    v_cvt_pk_bf16_f32 v184, v160, v161
    v_cvt_pk_bf16_f32 v185, v162, v163
    v_cvt_pk_bf16_f32 v186, v164, v165
    v_cvt_pk_bf16_f32 v187, v166, v167
    buffer_store_dwordx4 v[184:187], v244, s[20:23], s40 offen offset:3072 sc1
    v_accvgpr_read_b32 v168, a120
    v_accvgpr_read_b32 v169, a121
    v_accvgpr_read_b32 v170, a122
    v_accvgpr_read_b32 v171, a123
    v_accvgpr_read_b32 v172, a124
    v_accvgpr_read_b32 v173, a125
    v_accvgpr_read_b32 v174, a126
    v_accvgpr_read_b32 v175, a127
    v_mul_f32 v168, v168, v230
    v_mul_f32 v169, v169, v230
    v_mul_f32 v170, v170, v230
    v_mul_f32 v171, v171, v230
    v_mul_f32 v172, v172, v230
    v_mul_f32 v173, v173, v230
    v_mul_f32 v174, v174, v230
    v_mul_f32 v175, v175, v230
    v_cvt_pk_bf16_f32 v188, v168, v169
    v_cvt_pk_bf16_f32 v189, v170, v171
    v_cvt_pk_bf16_f32 v190, v172, v173
    v_cvt_pk_bf16_f32 v191, v174, v175
    buffer_store_dwordx4 v[188:191], v244, s[20:23], s40 offen offset:3584 sc1
ka_done:
    s_endpgm
ka_fix1:
    s_cmp_eq_u32 s36, 0
    s_cselect_b32 s24, 0, 0x74000000
    v_subrev_f32 v230, s24, v243
    v_add_f32 v231, 0, v230
    v_min_f32 v64, v228, v231
    v_add_f32 v232, 0xf1800000, v230
    v_min_f32 v65, v228, v232
    v_add_f32 v231, 0xf2000000, v230
    v_min_f32 v66, v228, v231
    v_add_f32 v232, 0xf2400000, v230
    v_min_f32 v67, v228, v232
    v_add_f32 v231, 0xf3000000, v230
    v_min_f32 v68, v228, v231
    v_add_f32 v232, 0xf3100000, v230
    v_min_f32 v69, v228, v232
    v_add_f32 v231, 0xf3200000, v230
    v_min_f32 v70, v228, v231
    v_add_f32 v232, 0xf3300000, v230
    v_min_f32 v71, v228, v232
    v_add_f32 v231, 0xf3800000, v230
    v_min_f32 v72, v228, v231
    v_add_f32 v232, 0xf3880000, v230
    v_min_f32 v73, v228, v232
    v_add_f32 v231, 0xf3900000, v230
    v_min_f32 v74, v228, v231
    v_add_f32 v232, 0xf3980000, v230
    v_min_f32 v75, v228, v232
    v_add_f32 v231, 0xf3c00000, v230
    v_min_f32 v76, v228, v231
    v_add_f32 v232, 0xf3c80000, v230
    v_min_f32 v77, v228, v232
    v_add_f32 v231, 0xf3d00000, v230
    v_min_f32 v78, v228, v231
    v_add_f32 v232, 0xf3d80000, v230
    v_min_f32 v79, v228, v232
    s_nop 1
    s_branch ka_fixr2
ka_fix3:
    s_cmp_eq_u32 s36, 0
    s_cselect_b32 s24, 0, 0x74000000
    v_subrev_f32 v230, s24, v243
    v_add_f32 v231, 0, v230
    v_min_f32 v64, v228, v231
    v_add_f32 v232, 0xf1800000, v230
    v_min_f32 v65, v228, v232
    v_add_f32 v231, 0xf2000000, v230
    v_min_f32 v66, v228, v231
    v_add_f32 v232, 0xf2400000, v230
    v_min_f32 v67, v228, v232
    v_add_f32 v231, 0xf3000000, v230
    v_min_f32 v68, v228, v231
    v_add_f32 v232, 0xf3100000, v230
    v_min_f32 v69, v228, v232
    v_add_f32 v231, 0xf3200000, v230
    v_min_f32 v70, v228, v231
    v_add_f32 v232, 0xf3300000, v230
    v_min_f32 v71, v228, v232
    v_add_f32 v231, 0xf3800000, v230
    v_min_f32 v72, v228, v231
    v_add_f32 v232, 0xf3880000, v230
    v_min_f32 v73, v228, v232
    v_add_f32 v231, 0xf3900000, v230
    v_min_f32 v74, v228, v231
    v_add_f32 v232, 0xf3980000, v230
    v_min_f32 v75, v228, v232
    v_add_f32 v231, 0xf3c00000, v230
    v_min_f32 v76, v228, v231
    v_add_f32 v232, 0xf3c80000, v230
    v_min_f32 v77, v228, v232
    v_add_f32 v231, 0xf3d00000, v230
    v_min_f32 v78, v228, v231
    v_add_f32 v232, 0xf3d80000, v230
    v_min_f32 v79, v228, v232
    s_nop 1
    s_branch ka_fixr4
ka_l2p5:
    buffer_load_dword v252, v245, s[56:59], s28 offen
    s_add_u32 s28, s28, 4096
    s_branch ka_l2r6
ka_fix7:
    s_cmp_eq_u32 s36, 0
    s_cselect_b32 s24, 0, 0x74000000
    v_subrev_f32 v230, s24, v243
    v_add_f32 v231, 0, v230
    v_min_f32 v64, v228, v231
    v_add_f32 v232, 0xf1800000, v230
    v_min_f32 v65, v228, v232
    v_add_f32 v231, 0xf2000000, v230
    v_min_f32 v66, v228, v231
    v_add_f32 v232, 0xf2400000, v230
    v_min_f32 v67, v228, v232
    v_add_f32 v231, 0xf3000000, v230
    v_min_f32 v68, v228, v231
    v_add_f32 v232, 0xf3100000, v230
    v_min_f32 v69, v228, v232
    v_add_f32 v231, 0xf3200000, v230
    v_min_f32 v70, v228, v231
    v_add_f32 v232, 0xf3300000, v230
    v_min_f32 v71, v228, v232
    v_add_f32 v231, 0xf3800000, v230
    v_min_f32 v72, v228, v231
    v_add_f32 v232, 0xf3880000, v230
    v_min_f32 v73, v228, v232
    v_add_f32 v231, 0xf3900000, v230
    v_min_f32 v74, v228, v231
    v_add_f32 v232, 0xf3980000, v230
    v_min_f32 v75, v228, v232
    v_add_f32 v231, 0xf3c00000, v230
    v_min_f32 v76, v228, v231
    v_add_f32 v232, 0xf3c80000, v230
    v_min_f32 v77, v228, v232
    v_add_f32 v231, 0xf3d00000, v230
    v_min_f32 v78, v228, v231
    v_add_f32 v232, 0xf3d80000, v230
    v_min_f32 v79, v228, v232
    s_nop 1
    s_branch ka_fixr8
ka_rare10:
    s_nop 15
    v_max3_f32 v230, v32, v33, v34
    v_max3_f32 v230, v230, v35, v36
    v_max3_f32 v230, v230, v37, v38
    v_max3_f32 v230, v230, v39, v40
    v_max3_f32 v230, v230, v41, v42
    v_max3_f32 v230, v230, v43, v44
    v_max3_f32 v230, v230, v45, v46
    v_max_f32 v230, v230, v47
    v_mov_b32 v231, v230
    s_nop 1
    v_permlane32_swap_b32 v230, v231
    s_nop 0
    v_max_f32 v230, v230, v231
    v_max_f32 v230, 0, v230
    v_sub_f32 v232, 0, v230
    v_exp_f32 v232, v232
    v_sub_f32 v228, v228, v230
    v_sub_f32 v64, v64, v230
    v_sub_f32 v0, v0, v230
    v_sub_f32 v32, v32, v230
    v_sub_f32 v65, v65, v230
    v_sub_f32 v1, v1, v230
    v_sub_f32 v33, v33, v230
    v_sub_f32 v66, v66, v230
    v_sub_f32 v2, v2, v230
    v_sub_f32 v34, v34, v230
    v_sub_f32 v67, v67, v230
    v_sub_f32 v3, v3, v230
    v_sub_f32 v35, v35, v230
    v_sub_f32 v68, v68, v230
    v_sub_f32 v4, v4, v230
    v_sub_f32 v36, v36, v230
    v_sub_f32 v69, v69, v230
    v_sub_f32 v5, v5, v230
    v_sub_f32 v37, v37, v230
    v_sub_f32 v70, v70, v230
    v_sub_f32 v6, v6, v230
    v_sub_f32 v38, v38, v230
    v_sub_f32 v71, v71, v230
    v_sub_f32 v7, v7, v230
    v_sub_f32 v39, v39, v230
    v_sub_f32 v72, v72, v230
    v_sub_f32 v8, v8, v230
    v_sub_f32 v40, v40, v230
    v_sub_f32 v73, v73, v230
    v_sub_f32 v9, v9, v230
    v_sub_f32 v41, v41, v230
    v_sub_f32 v74, v74, v230
    v_sub_f32 v10, v10, v230
    v_sub_f32 v42, v42, v230
    v_sub_f32 v75, v75, v230
    v_sub_f32 v11, v11, v230
    v_sub_f32 v43, v43, v230
    v_sub_f32 v76, v76, v230
    v_sub_f32 v12, v12, v230
    v_sub_f32 v44, v44, v230
    v_sub_f32 v77, v77, v230
    v_sub_f32 v13, v13, v230
    v_sub_f32 v45, v45, v230
    v_sub_f32 v78, v78, v230
    v_sub_f32 v14, v14, v230
    v_sub_f32 v46, v46, v230
    v_sub_f32 v79, v79, v230
    v_sub_f32 v15, v15, v230
    v_sub_f32 v47, v47, v230
    v_mul_f32 v226, v226, v232
    v_accvgpr_read_b32 v234, a0
    v_mul_f32 v234, v234, v232
    v_accvgpr_write_b32 a0, v234
    v_accvgpr_read_b32 v235, a1
    v_mul_f32 v235, v235, v232
    v_accvgpr_write_b32 a1, v235
    v_accvgpr_read_b32 v236, a2
    v_mul_f32 v236, v236, v232
    v_accvgpr_write_b32 a2, v236
    v_accvgpr_read_b32 v237, a3
    v_mul_f32 v237, v237, v232
    v_accvgpr_write_b32 a3, v237
    v_accvgpr_read_b32 v234, a4
    v_mul_f32 v234, v234, v232
    v_accvgpr_write_b32 a4, v234
    v_accvgpr_read_b32 v235, a5
    v_mul_f32 v235, v235, v232
    v_accvgpr_write_b32 a5, v235
    v_accvgpr_read_b32 v236, a6
    v_mul_f32 v236, v236, v232
    v_accvgpr_write_b32 a6, v236
    v_accvgpr_read_b32 v237, a7
    v_mul_f32 v237, v237, v232
    v_accvgpr_write_b32 a7, v237
    v_accvgpr_read_b32 v234, a8
    v_mul_f32 v234, v234, v232
    v_accvgpr_write_b32 a8, v234
    v_accvgpr_read_b32 v235, a9
    v_mul_f32 v235, v235, v232
    v_accvgpr_write_b32 a9, v235
    v_accvgpr_read_b32 v236, a10
    v_mul_f32 v236, v236, v232
    v_accvgpr_write_b32 a10, v236
    v_accvgpr_read_b32 v237, a11
    v_mul_f32 v237, v237, v232
    v_accvgpr_write_b32 a11, v237
    v_accvgpr_read_b32 v234, a12
    v_mul_f32 v234, v234, v232
    v_accvgpr_write_b32 a12, v234
    v_accvgpr_read_b32 v235, a13
    v_mul_f32 v235, v235, v232
    v_accvgpr_write_b32 a13, v235
    v_accvgpr_read_b32 v236, a14
    v_mul_f32 v236, v236, v232
    v_accvgpr_write_b32 a14, v236
    v_accvgpr_read_b32 v237, a15
    v_mul_f32 v237, v237, v232
    v_accvgpr_write_b32 a15, v237
    v_accvgpr_read_b32 v234, a16
    v_mul_f32 v234, v234, v232
    v_accvgpr_write_b32 a16, v234
    v_accvgpr_read_b32 v235, a17
    v_mul_f32 v235, v235, v232
    v_accvgpr_write_b32 a17, v235
    v_accvgpr_read_b32 v236, a18
    v_mul_f32 v236, v236, v232
    v_accvgpr_write_b32 a18, v236
    v_accvgpr_read_b32 v237, a19
    v_mul_f32 v237, v237, v232
    v_accvgpr_write_b32 a19, v237
    v_accvgpr_read_b32 v234, a20
    v_mul_f32 v234, v234, v232
    v_accvgpr_write_b32 a20, v234
    v_accvgpr_read_b32 v235, a21
    v_mul_f32 v235, v235, v232
    v_accvgpr_write_b32 a21, v235
    v_accvgpr_read_b32 v236, a22
    v_mul_f32 v236, v236, v232
    v_accvgpr_write_b32 a22, v236
    v_accvgpr_read_b32 v237, a23
    v_mul_f32 v237, v237, v232
    v_accvgpr_write_b32 a23, v237
    v_accvgpr_read_b32 v234, a24
    v_mul_f32 v234, v234, v232
    v_accvgpr_write_b32 a24, v234
    v_accvgpr_read_b32 v235, a25
    v_mul_f32 v235, v235, v232
    v_accvgpr_write_b32 a25, v235
    v_accvgpr_read_b32 v236, a26
    v_mul_f32 v236, v236, v232
    v_accvgpr_write_b32 a26, v236
    v_accvgpr_read_b32 v237, a27
    v_mul_f32 v237, v237, v232
    v_accvgpr_write_b32 a27, v237
    v_accvgpr_read_b32 v234, a28
    v_mul_f32 v234, v234, v232
    v_accvgpr_write_b32 a28, v234
    v_accvgpr_read_b32 v235, a29
    v_mul_f32 v235, v235, v232
    v_accvgpr_write_b32 a29, v235
    v_accvgpr_read_b32 v236, a30
    v_mul_f32 v236, v236, v232
    v_accvgpr_write_b32 a30, v236
    v_accvgpr_read_b32 v237, a31
    v_mul_f32 v237, v237, v232
    v_accvgpr_write_b32 a31, v237
    v_accvgpr_read_b32 v234, a32
    v_mul_f32 v234, v234, v232
    v_accvgpr_write_b32 a32, v234
    v_accvgpr_read_b32 v235, a33
    v_mul_f32 v235, v235, v232
    v_accvgpr_write_b32 a33, v235
    v_accvgpr_read_b32 v236, a34
    v_mul_f32 v236, v236, v232
    v_accvgpr_write_b32 a34, v236
    v_accvgpr_read_b32 v237, a35
    v_mul_f32 v237, v237, v232
    v_accvgpr_write_b32 a35, v237
    v_accvgpr_read_b32 v234, a36
    v_mul_f32 v234, v234, v232
    v_accvgpr_write_b32 a36, v234
    v_accvgpr_read_b32 v235, a37
    v_mul_f32 v235, v235, v232
    v_accvgpr_write_b32 a37, v235
    v_accvgpr_read_b32 v236, a38
    v_mul_f32 v236, v236, v232
    v_accvgpr_write_b32 a38, v236
    v_accvgpr_read_b32 v237, a39
    v_mul_f32 v237, v237, v232
    v_accvgpr_write_b32 a39, v237
    v_accvgpr_read_b32 v234, a40
    v_mul_f32 v234, v234, v232
    v_accvgpr_write_b32 a40, v234
    v_accvgpr_read_b32 v235, a41
    v_mul_f32 v235, v235, v232
    v_accvgpr_write_b32 a41, v235
    v_accvgpr_read_b32 v236, a42
    v_mul_f32 v236, v236, v232
    v_accvgpr_write_b32 a42, v236
    v_accvgpr_read_b32 v237, a43
    v_mul_f32 v237, v237, v232
    v_accvgpr_write_b32 a43, v237
    v_accvgpr_read_b32 v234, a44
    v_mul_f32 v234, v234, v232
    v_accvgpr_write_b32 a44, v234
    v_accvgpr_read_b32 v235, a45
    v_mul_f32 v235, v235, v232
    v_accvgpr_write_b32 a45, v235
    v_accvgpr_read_b32 v236, a46
    v_mul_f32 v236, v236, v232
    v_accvgpr_write_b32 a46, v236
    v_accvgpr_read_b32 v237, a47
    v_mul_f32 v237, v237, v232
    v_accvgpr_write_b32 a47, v237
    v_accvgpr_read_b32 v234, a48
    v_mul_f32 v234, v234, v232
    v_accvgpr_write_b32 a48, v234
    v_accvgpr_read_b32 v235, a49
    v_mul_f32 v235, v235, v232
    v_accvgpr_write_b32 a49, v235
    v_accvgpr_read_b32 v236, a50
    v_mul_f32 v236, v236, v232
    v_accvgpr_write_b32 a50, v236
    v_accvgpr_read_b32 v237, a51
    v_mul_f32 v237, v237, v232
    v_accvgpr_write_b32 a51, v237
    v_accvgpr_read_b32 v234, a52
    v_mul_f32 v234, v234, v232
    v_accvgpr_write_b32 a52, v234
    v_accvgpr_read_b32 v235, a53
    v_mul_f32 v235, v235, v232
    v_accvgpr_write_b32 a53, v235
    v_accvgpr_read_b32 v236, a54
    v_mul_f32 v236, v236, v232
    v_accvgpr_write_b32 a54, v236
    v_accvgpr_read_b32 v237, a55
    v_mul_f32 v237, v237, v232
    v_accvgpr_write_b32 a55, v237
    v_accvgpr_read_b32 v234, a56
    v_mul_f32 v234, v234, v232
    v_accvgpr_write_b32 a56, v234
    v_accvgpr_read_b32 v235, a57
    v_mul_f32 v235, v235, v232
    v_accvgpr_write_b32 a57, v235
    v_accvgpr_read_b32 v236, a58
    v_mul_f32 v236, v236, v232
    v_accvgpr_write_b32 a58, v236
    v_accvgpr_read_b32 v237, a59
    v_mul_f32 v237, v237, v232
    v_accvgpr_write_b32 a59, v237
    v_accvgpr_read_b32 v234, a60
    v_mul_f32 v234, v234, v232
    v_accvgpr_write_b32 a60, v234
    v_accvgpr_read_b32 v235, a61
    v_mul_f32 v235, v235, v232
    v_accvgpr_write_b32 a61, v235
    v_accvgpr_read_b32 v236, a62
    v_mul_f32 v236, v236, v232
    v_accvgpr_write_b32 a62, v236
    v_accvgpr_read_b32 v237, a63
    v_mul_f32 v237, v237, v232
    v_accvgpr_write_b32 a63, v237
    v_exp_f32 v136, v32
    v_exp_f32 v137, v33
    v_exp_f32 v130, v34
    v_exp_f32 v131, v35
    v_cvt_pk_bf16_f32 v112, v136, v137
    v_exp_f32 v132, v36
    v_exp_f32 v133, v37
    v_cvt_pk_bf16_f32 v113, v130, v131
    v_add_f32 v136, v136, v130
    v_add_f32 v137, v137, v131
    v_exp_f32 v134, v38
    v_exp_f32 v135, v39
    v_cvt_pk_bf16_f32 v114, v132, v133
    v_add_f32 v136, v136, v132
    v_add_f32 v137, v137, v133
    v_exp_f32 v128, v40
    v_exp_f32 v129, v41
    v_cvt_pk_bf16_f32 v115, v134, v135
    v_add_f32 v136, v136, v134
    v_add_f32 v137, v137, v135
    v_exp_f32 v130, v42
    v_exp_f32 v131, v43
    v_cvt_pk_bf16_f32 v116, v128, v129
    v_add_f32 v136, v136, v128
    v_add_f32 v137, v137, v129
    v_exp_f32 v132, v44
    v_exp_f32 v133, v45
    v_cvt_pk_bf16_f32 v117, v130, v131
    v_add_f32 v136, v136, v130
    v_add_f32 v137, v137, v131
    v_exp_f32 v134, v46
    v_exp_f32 v135, v47
    v_cvt_pk_bf16_f32 v118, v132, v133
    v_add_f32 v136, v136, v132
    v_add_f32 v137, v137, v133
    v_cvt_pk_bf16_f32 v119, v134, v135
    v_add_f32 v136, v136, v134
    v_add_f32 v137, v137, v135
    v_add_f32 v224, v136, v137
    v_max3_f32 v230, v48, v49, v50
    v_max3_f32 v230, v230, v51, v52
    v_max3_f32 v230, v230, v53, v54
    v_max3_f32 v230, v230, v55, v56
    v_max3_f32 v230, v230, v57, v58
    v_max3_f32 v230, v230, v59, v60
    v_max3_f32 v230, v230, v61, v62
    v_max_f32 v230, v230, v63
    v_mov_b32 v231, v230
    s_nop 1
    v_permlane32_swap_b32 v230, v231
    s_nop 0
    v_max_f32 v230, v230, v231
    v_max_f32 v230, 0, v230
    v_sub_f32 v232, 0, v230
    v_exp_f32 v232, v232
    v_sub_f32 v229, v229, v230
    v_sub_f32 v80, v80, v230
    v_sub_f32 v16, v16, v230
    v_sub_f32 v48, v48, v230
    v_sub_f32 v81, v81, v230
    v_sub_f32 v17, v17, v230
    v_sub_f32 v49, v49, v230
    v_sub_f32 v82, v82, v230
    v_sub_f32 v18, v18, v230
    v_sub_f32 v50, v50, v230
    v_sub_f32 v83, v83, v230
    v_sub_f32 v19, v19, v230
    v_sub_f32 v51, v51, v230
    v_sub_f32 v84, v84, v230
    v_sub_f32 v20, v20, v230
    v_sub_f32 v52, v52, v230
    v_sub_f32 v85, v85, v230
    v_sub_f32 v21, v21, v230
    v_sub_f32 v53, v53, v230
    v_sub_f32 v86, v86, v230
    v_sub_f32 v22, v22, v230
    v_sub_f32 v54, v54, v230
    v_sub_f32 v87, v87, v230
    v_sub_f32 v23, v23, v230
    v_sub_f32 v55, v55, v230
    v_sub_f32 v88, v88, v230
    v_sub_f32 v24, v24, v230
    v_sub_f32 v56, v56, v230
    v_sub_f32 v89, v89, v230
    v_sub_f32 v25, v25, v230
    v_sub_f32 v57, v57, v230
    v_sub_f32 v90, v90, v230
    v_sub_f32 v26, v26, v230
    v_sub_f32 v58, v58, v230
    v_sub_f32 v91, v91, v230
    v_sub_f32 v27, v27, v230
    v_sub_f32 v59, v59, v230
    v_sub_f32 v92, v92, v230
    v_sub_f32 v28, v28, v230
    v_sub_f32 v60, v60, v230
    v_sub_f32 v93, v93, v230
    v_sub_f32 v29, v29, v230
    v_sub_f32 v61, v61, v230
    v_sub_f32 v94, v94, v230
    v_sub_f32 v30, v30, v230
    v_sub_f32 v62, v62, v230
    v_sub_f32 v95, v95, v230
    v_sub_f32 v31, v31, v230
    v_sub_f32 v63, v63, v230
    v_mul_f32 v227, v227, v232
    v_accvgpr_read_b32 v234, a64
    v_mul_f32 v234, v234, v232
    v_accvgpr_write_b32 a64, v234
    v_accvgpr_read_b32 v235, a65
    v_mul_f32 v235, v235, v232
    v_accvgpr_write_b32 a65, v235
    v_accvgpr_read_b32 v236, a66
    v_mul_f32 v236, v236, v232
    v_accvgpr_write_b32 a66, v236
    v_accvgpr_read_b32 v237, a67
    v_mul_f32 v237, v237, v232
    v_accvgpr_write_b32 a67, v237
    v_accvgpr_read_b32 v234, a68
    v_mul_f32 v234, v234, v232
    v_accvgpr_write_b32 a68, v234
    v_accvgpr_read_b32 v235, a69
    v_mul_f32 v235, v235, v232
    v_accvgpr_write_b32 a69, v235
    v_accvgpr_read_b32 v236, a70
    v_mul_f32 v236, v236, v232
    v_accvgpr_write_b32 a70, v236
    v_accvgpr_read_b32 v237, a71
    v_mul_f32 v237, v237, v232
    v_accvgpr_write_b32 a71, v237
    v_accvgpr_read_b32 v234, a72
    v_mul_f32 v234, v234, v232
    v_accvgpr_write_b32 a72, v234
    v_accvgpr_read_b32 v235, a73
    v_mul_f32 v235, v235, v232
    v_accvgpr_write_b32 a73, v235
    v_accvgpr_read_b32 v236, a74
    v_mul_f32 v236, v236, v232
    v_accvgpr_write_b32 a74, v236
    v_accvgpr_read_b32 v237, a75
    v_mul_f32 v237, v237, v232
    v_accvgpr_write_b32 a75, v237
    v_accvgpr_read_b32 v234, a76
    v_mul_f32 v234, v234, v232
    v_accvgpr_write_b32 a76, v234
    v_accvgpr_read_b32 v235, a77
    v_mul_f32 v235, v235, v232
    v_accvgpr_write_b32 a77, v235
    v_accvgpr_read_b32 v236, a78
    v_mul_f32 v236, v236, v232
    v_accvgpr_write_b32 a78, v236
    v_accvgpr_read_b32 v237, a79
    v_mul_f32 v237, v237, v232
    v_accvgpr_write_b32 a79, v237
    v_accvgpr_read_b32 v234, a80
    v_mul_f32 v234, v234, v232
    v_accvgpr_write_b32 a80, v234
    v_accvgpr_read_b32 v235, a81
    v_mul_f32 v235, v235, v232
    v_accvgpr_write_b32 a81, v235
    v_accvgpr_read_b32 v236, a82
    v_mul_f32 v236, v236, v232
    v_accvgpr_write_b32 a82, v236
    v_accvgpr_read_b32 v237, a83
    v_mul_f32 v237, v237, v232
    v_accvgpr_write_b32 a83, v237
    v_accvgpr_read_b32 v234, a84
    v_mul_f32 v234, v234, v232
    v_accvgpr_write_b32 a84, v234
    v_accvgpr_read_b32 v235, a85
    v_mul_f32 v235, v235, v232
    v_accvgpr_write_b32 a85, v235
    v_accvgpr_read_b32 v236, a86
    v_mul_f32 v236, v236, v232
    v_accvgpr_write_b32 a86, v236
    v_accvgpr_read_b32 v237, a87
    v_mul_f32 v237, v237, v232
    v_accvgpr_write_b32 a87, v237
    v_accvgpr_read_b32 v234, a88
    v_mul_f32 v234, v234, v232
    v_accvgpr_write_b32 a88, v234
    v_accvgpr_read_b32 v235, a89
    v_mul_f32 v235, v235, v232
    v_accvgpr_write_b32 a89, v235
    v_accvgpr_read_b32 v236, a90
    v_mul_f32 v236, v236, v232
    v_accvgpr_write_b32 a90, v236
    v_accvgpr_read_b32 v237, a91
    v_mul_f32 v237, v237, v232
    v_accvgpr_write_b32 a91, v237
    v_accvgpr_read_b32 v234, a92
    v_mul_f32 v234, v234, v232
    v_accvgpr_write_b32 a92, v234
    v_accvgpr_read_b32 v235, a93
    v_mul_f32 v235, v235, v232
    v_accvgpr_write_b32 a93, v235
    v_accvgpr_read_b32 v236, a94
    v_mul_f32 v236, v236, v232
    v_accvgpr_write_b32 a94, v236
    v_accvgpr_read_b32 v237, a95
    v_mul_f32 v237, v237, v232
    v_accvgpr_write_b32 a95, v237
    v_accvgpr_read_b32 v234, a96
    v_mul_f32 v234, v234, v232
    v_accvgpr_write_b32 a96, v234
    v_accvgpr_read_b32 v235, a97
    v_mul_f32 v235, v235, v232
    v_accvgpr_write_b32 a97, v235
    v_accvgpr_read_b32 v236, a98
    v_mul_f32 v236, v236, v232
    v_accvgpr_write_b32 a98, v236
    v_accvgpr_read_b32 v237, a99
    v_mul_f32 v237, v237, v232
    v_accvgpr_write_b32 a99, v237
    v_accvgpr_read_b32 v234, a100
    v_mul_f32 v234, v234, v232
    v_accvgpr_write_b32 a100, v234
    v_accvgpr_read_b32 v235, a101
    v_mul_f32 v235, v235, v232
    v_accvgpr_write_b32 a101, v235
    v_accvgpr_read_b32 v236, a102
    v_mul_f32 v236, v236, v232
    v_accvgpr_write_b32 a102, v236
    v_accvgpr_read_b32 v237, a103
    v_mul_f32 v237, v237, v232
    v_accvgpr_write_b32 a103, v237
    v_accvgpr_read_b32 v234, a104
    v_mul_f32 v234, v234, v232
    v_accvgpr_write_b32 a104, v234
    v_accvgpr_read_b32 v235, a105
    v_mul_f32 v235, v235, v232
    v_accvgpr_write_b32 a105, v235
    v_accvgpr_read_b32 v236, a106
    v_mul_f32 v236, v236, v232
    v_accvgpr_write_b32 a106, v236
    v_accvgpr_read_b32 v237, a107
    v_mul_f32 v237, v237, v232
    v_accvgpr_write_b32 a107, v237
    v_accvgpr_read_b32 v234, a108
    v_mul_f32 v234, v234, v232
    v_accvgpr_write_b32 a108, v234
    v_accvgpr_read_b32 v235, a109
    v_mul_f32 v235, v235, v232
    v_accvgpr_write_b32 a109, v235
    v_accvgpr_read_b32 v236, a110
    v_mul_f32 v236, v236, v232
    v_accvgpr_write_b32 a110, v236
    v_accvgpr_read_b32 v237, a111
    v_mul_f32 v237, v237, v232
    v_accvgpr_write_b32 a111, v237
    v_accvgpr_read_b32 v234, a112
    v_mul_f32 v234, v234, v232
    v_accvgpr_write_b32 a112, v234
    v_accvgpr_read_b32 v235, a113
    v_mul_f32 v235, v235, v232
    v_accvgpr_write_b32 a113, v235
    v_accvgpr_read_b32 v236, a114
    v_mul_f32 v236, v236, v232
    v_accvgpr_write_b32 a114, v236
    v_accvgpr_read_b32 v237, a115
    v_mul_f32 v237, v237, v232
    v_accvgpr_write_b32 a115, v237
    v_accvgpr_read_b32 v234, a116
    v_mul_f32 v234, v234, v232
    v_accvgpr_write_b32 a116, v234
    v_accvgpr_read_b32 v235, a117
    v_mul_f32 v235, v235, v232
    v_accvgpr_write_b32 a117, v235
    v_accvgpr_read_b32 v236, a118
    v_mul_f32 v236, v236, v232
    v_accvgpr_write_b32 a118, v236
    v_accvgpr_read_b32 v237, a119
    v_mul_f32 v237, v237, v232
    v_accvgpr_write_b32 a119, v237
    v_accvgpr_read_b32 v234, a120
    v_mul_f32 v234, v234, v232
    v_accvgpr_write_b32 a120, v234
    v_accvgpr_read_b32 v235, a121
    v_mul_f32 v235, v235, v232
    v_accvgpr_write_b32 a121, v235
    v_accvgpr_read_b32 v236, a122
    v_mul_f32 v236, v236, v232
    v_accvgpr_write_b32 a122, v236
    v_accvgpr_read_b32 v237, a123
    v_mul_f32 v237, v237, v232
    v_accvgpr_write_b32 a123, v237
    v_accvgpr_read_b32 v234, a124
    v_mul_f32 v234, v234, v232
    v_accvgpr_write_b32 a124, v234
    v_accvgpr_read_b32 v235, a125
    v_mul_f32 v235, v235, v232
    v_accvgpr_write_b32 a125, v235
    v_accvgpr_read_b32 v236, a126
    v_mul_f32 v236, v236, v232
    v_accvgpr_write_b32 a126, v236
    v_accvgpr_read_b32 v237, a127
    v_mul_f32 v237, v237, v232
    v_accvgpr_write_b32 a127, v237
    v_exp_f32 v138, v48
    v_exp_f32 v139, v49
    v_exp_f32 v130, v50
    v_exp_f32 v131, v51
    v_cvt_pk_bf16_f32 v120, v138, v139
    v_exp_f32 v132, v52
    v_exp_f32 v133, v53
    v_cvt_pk_bf16_f32 v121, v130, v131
    v_add_f32 v138, v138, v130
    v_add_f32 v139, v139, v131
    v_exp_f32 v134, v54
    v_exp_f32 v135, v55
    v_cvt_pk_bf16_f32 v122, v132, v133
    v_add_f32 v138, v138, v132
    v_add_f32 v139, v139, v133
    v_exp_f32 v128, v56
    v_exp_f32 v129, v57
    v_cvt_pk_bf16_f32 v123, v134, v135
    v_add_f32 v138, v138, v134
    v_add_f32 v139, v139, v135
    v_exp_f32 v130, v58
    v_exp_f32 v131, v59
    v_cvt_pk_bf16_f32 v124, v128, v129
    v_add_f32 v138, v138, v128
    v_add_f32 v139, v139, v129
    v_exp_f32 v132, v60
    v_exp_f32 v133, v61
    v_cvt_pk_bf16_f32 v125, v130, v131
    v_add_f32 v138, v138, v130
    v_add_f32 v139, v139, v131
    v_exp_f32 v134, v62
    v_exp_f32 v135, v63
    v_cvt_pk_bf16_f32 v126, v132, v133
    v_add_f32 v138, v138, v132
    v_add_f32 v139, v139, v133
    v_cvt_pk_bf16_f32 v127, v134, v135
    v_add_f32 v138, v138, v134
    v_add_f32 v139, v139, v135
    v_add_f32 v225, v138, v139
    s_nop 1
    s_branch ka_rr9
ka_l2p11:
    buffer_load_dword v252, v245, s[56:59], s28 offen
    s_add_u32 s28, s28, 4096
    s_branch ka_l2r12
ka_fix13:
    s_cmp_eq_u32 s36, 0
    s_cselect_b32 s24, 0, 0x74000000
    v_subrev_f32 v230, s24, v243
    v_add_f32 v231, 0, v230
    v_min_f32 v64, v228, v231
    v_add_f32 v232, 0xf1800000, v230
    v_min_f32 v65, v228, v232
    v_add_f32 v231, 0xf2000000, v230
    v_min_f32 v66, v228, v231
    v_add_f32 v232, 0xf2400000, v230
    v_min_f32 v67, v228, v232
    v_add_f32 v231, 0xf3000000, v230
    v_min_f32 v68, v228, v231
    v_add_f32 v232, 0xf3100000, v230
    v_min_f32 v69, v228, v232
    v_add_f32 v231, 0xf3200000, v230
    v_min_f32 v70, v228, v231
    v_add_f32 v232, 0xf3300000, v230
    v_min_f32 v71, v228, v232
    v_add_f32 v231, 0xf3800000, v230
    v_min_f32 v72, v228, v231
    v_add_f32 v232, 0xf3880000, v230
    v_min_f32 v73, v228, v232
    v_add_f32 v231, 0xf3900000, v230
    v_min_f32 v74, v228, v231
    v_add_f32 v232, 0xf3980000, v230
    v_min_f32 v75, v228, v232
    v_add_f32 v231, 0xf3c00000, v230
    v_min_f32 v76, v228, v231
    v_add_f32 v232, 0xf3c80000, v230
    v_min_f32 v77, v228, v232
    v_add_f32 v231, 0xf3d00000, v230
    v_min_f32 v78, v228, v231
    v_add_f32 v232, 0xf3d80000, v230
    v_min_f32 v79, v228, v232
    s_nop 1
    s_branch ka_fixr14
ka_rare16:
    s_nop 15
    v_max3_f32 v230, v0, v1, v2
    v_max3_f32 v230, v230, v3, v4
    v_max3_f32 v230, v230, v5, v6
    v_max3_f32 v230, v230, v7, v8
    v_max3_f32 v230, v230, v9, v10
    v_max3_f32 v230, v230, v11, v12
    v_max3_f32 v230, v230, v13, v14
    v_max_f32 v230, v230, v15
    v_mov_b32 v231, v230
    s_nop 1
    v_permlane32_swap_b32 v230, v231
    s_nop 0
    v_max_f32 v230, v230, v231
    v_max_f32 v230, 0, v230
    v_sub_f32 v232, 0, v230
    v_exp_f32 v232, v232
    v_sub_f32 v228, v228, v230
    v_sub_f32 v64, v64, v230
    v_sub_f32 v32, v32, v230
    v_sub_f32 v0, v0, v230
    v_sub_f32 v65, v65, v230
    v_sub_f32 v33, v33, v230
    v_sub_f32 v1, v1, v230
    v_sub_f32 v66, v66, v230
    v_sub_f32 v34, v34, v230
    v_sub_f32 v2, v2, v230
    v_sub_f32 v67, v67, v230
    v_sub_f32 v35, v35, v230
    v_sub_f32 v3, v3, v230
    v_sub_f32 v68, v68, v230
    v_sub_f32 v36, v36, v230
    v_sub_f32 v4, v4, v230
    v_sub_f32 v69, v69, v230
    v_sub_f32 v37, v37, v230
    v_sub_f32 v5, v5, v230
    v_sub_f32 v70, v70, v230
    v_sub_f32 v38, v38, v230
    v_sub_f32 v6, v6, v230
    v_sub_f32 v71, v71, v230
    v_sub_f32 v39, v39, v230
    v_sub_f32 v7, v7, v230
    v_sub_f32 v72, v72, v230
    v_sub_f32 v40, v40, v230
    v_sub_f32 v8, v8, v230
    v_sub_f32 v73, v73, v230
    v_sub_f32 v41, v41, v230
    v_sub_f32 v9, v9, v230
    v_sub_f32 v74, v74, v230
    v_sub_f32 v42, v42, v230
    v_sub_f32 v10, v10, v230
    v_sub_f32 v75, v75, v230
    v_sub_f32 v43, v43, v230
    v_sub_f32 v11, v11, v230
    v_sub_f32 v76, v76, v230
    v_sub_f32 v44, v44, v230
    v_sub_f32 v12, v12, v230
    v_sub_f32 v77, v77, v230
    v_sub_f32 v45, v45, v230
    v_sub_f32 v13, v13, v230
    v_sub_f32 v78, v78, v230
    v_sub_f32 v46, v46, v230
    v_sub_f32 v14, v14, v230
    v_sub_f32 v79, v79, v230
    v_sub_f32 v47, v47, v230
    v_sub_f32 v15, v15, v230
    v_mul_f32 v226, v226, v232
    v_accvgpr_read_b32 v234, a0
    v_mul_f32 v234, v234, v232
    v_accvgpr_write_b32 a0, v234
    v_accvgpr_read_b32 v235, a1
    v_mul_f32 v235, v235, v232
    v_accvgpr_write_b32 a1, v235
    v_accvgpr_read_b32 v236, a2
    v_mul_f32 v236, v236, v232
    v_accvgpr_write_b32 a2, v236
    v_accvgpr_read_b32 v237, a3
    v_mul_f32 v237, v237, v232
    v_accvgpr_write_b32 a3, v237
    v_accvgpr_read_b32 v234, a4
    v_mul_f32 v234, v234, v232
    v_accvgpr_write_b32 a4, v234
    v_accvgpr_read_b32 v235, a5
    v_mul_f32 v235, v235, v232
    v_accvgpr_write_b32 a5, v235
    v_accvgpr_read_b32 v236, a6
    v_mul_f32 v236, v236, v232
    v_accvgpr_write_b32 a6, v236
    v_accvgpr_read_b32 v237, a7
    v_mul_f32 v237, v237, v232
    v_accvgpr_write_b32 a7, v237
    v_accvgpr_read_b32 v234, a8
    v_mul_f32 v234, v234, v232
    v_accvgpr_write_b32 a8, v234
    v_accvgpr_read_b32 v235, a9
    v_mul_f32 v235, v235, v232
    v_accvgpr_write_b32 a9, v235
    v_accvgpr_read_b32 v236, a10
    v_mul_f32 v236, v236, v232
    v_accvgpr_write_b32 a10, v236
    v_accvgpr_read_b32 v237, a11
    v_mul_f32 v237, v237, v232
    v_accvgpr_write_b32 a11, v237
    v_accvgpr_read_b32 v234, a12
    v_mul_f32 v234, v234, v232
    v_accvgpr_write_b32 a12, v234
    v_accvgpr_read_b32 v235, a13
    v_mul_f32 v235, v235, v232
    v_accvgpr_write_b32 a13, v235
    v_accvgpr_read_b32 v236, a14
    v_mul_f32 v236, v236, v232
    v_accvgpr_write_b32 a14, v236
    v_accvgpr_read_b32 v237, a15
    v_mul_f32 v237, v237, v232
    v_accvgpr_write_b32 a15, v237
    v_accvgpr_read_b32 v234, a16
    v_mul_f32 v234, v234, v232
    v_accvgpr_write_b32 a16, v234
    v_accvgpr_read_b32 v235, a17
    v_mul_f32 v235, v235, v232
    v_accvgpr_write_b32 a17, v235
    v_accvgpr_read_b32 v236, a18
    v_mul_f32 v236, v236, v232
    v_accvgpr_write_b32 a18, v236
    v_accvgpr_read_b32 v237, a19
    v_mul_f32 v237, v237, v232
    v_accvgpr_write_b32 a19, v237
    v_accvgpr_read_b32 v234, a20
    v_mul_f32 v234, v234, v232
    v_accvgpr_write_b32 a20, v234
    v_accvgpr_read_b32 v235, a21
    v_mul_f32 v235, v235, v232
    v_accvgpr_write_b32 a21, v235
    v_accvgpr_read_b32 v236, a22
    v_mul_f32 v236, v236, v232
    v_accvgpr_write_b32 a22, v236
    v_accvgpr_read_b32 v237, a23
    v_mul_f32 v237, v237, v232
    v_accvgpr_write_b32 a23, v237
    v_accvgpr_read_b32 v234, a24
    v_mul_f32 v234, v234, v232
    v_accvgpr_write_b32 a24, v234
    v_accvgpr_read_b32 v235, a25
    v_mul_f32 v235, v235, v232
    v_accvgpr_write_b32 a25, v235
    v_accvgpr_read_b32 v236, a26
    v_mul_f32 v236, v236, v232
    v_accvgpr_write_b32 a26, v236
    v_accvgpr_read_b32 v237, a27
    v_mul_f32 v237, v237, v232
    v_accvgpr_write_b32 a27, v237
    v_accvgpr_read_b32 v234, a28
    v_mul_f32 v234, v234, v232
    v_accvgpr_write_b32 a28, v234
    v_accvgpr_read_b32 v235, a29
    v_mul_f32 v235, v235, v232
    v_accvgpr_write_b32 a29, v235
    v_accvgpr_read_b32 v236, a30
    v_mul_f32 v236, v236, v232
    v_accvgpr_write_b32 a30, v236
    v_accvgpr_read_b32 v237, a31
    v_mul_f32 v237, v237, v232
    v_accvgpr_write_b32 a31, v237
    v_accvgpr_read_b32 v234, a32
    v_mul_f32 v234, v234, v232
    v_accvgpr_write_b32 a32, v234
    v_accvgpr_read_b32 v235, a33
    v_mul_f32 v235, v235, v232
    v_accvgpr_write_b32 a33, v235
    v_accvgpr_read_b32 v236, a34
    v_mul_f32 v236, v236, v232
    v_accvgpr_write_b32 a34, v236
    v_accvgpr_read_b32 v237, a35
    v_mul_f32 v237, v237, v232
    v_accvgpr_write_b32 a35, v237
    v_accvgpr_read_b32 v234, a36
    v_mul_f32 v234, v234, v232
    v_accvgpr_write_b32 a36, v234
    v_accvgpr_read_b32 v235, a37
    v_mul_f32 v235, v235, v232
    v_accvgpr_write_b32 a37, v235
    v_accvgpr_read_b32 v236, a38
    v_mul_f32 v236, v236, v232
    v_accvgpr_write_b32 a38, v236
    v_accvgpr_read_b32 v237, a39
    v_mul_f32 v237, v237, v232
    v_accvgpr_write_b32 a39, v237
    v_accvgpr_read_b32 v234, a40
    v_mul_f32 v234, v234, v232
    v_accvgpr_write_b32 a40, v234
    v_accvgpr_read_b32 v235, a41
    v_mul_f32 v235, v235, v232
    v_accvgpr_write_b32 a41, v235
    v_accvgpr_read_b32 v236, a42
    v_mul_f32 v236, v236, v232
    v_accvgpr_write_b32 a42, v236
    v_accvgpr_read_b32 v237, a43
    v_mul_f32 v237, v237, v232
    v_accvgpr_write_b32 a43, v237
    v_accvgpr_read_b32 v234, a44
    v_mul_f32 v234, v234, v232
    v_accvgpr_write_b32 a44, v234
    v_accvgpr_read_b32 v235, a45
    v_mul_f32 v235, v235, v232
    v_accvgpr_write_b32 a45, v235
    v_accvgpr_read_b32 v236, a46
    v_mul_f32 v236, v236, v232
    v_accvgpr_write_b32 a46, v236
    v_accvgpr_read_b32 v237, a47
    v_mul_f32 v237, v237, v232
    v_accvgpr_write_b32 a47, v237
    v_accvgpr_read_b32 v234, a48
    v_mul_f32 v234, v234, v232
    v_accvgpr_write_b32 a48, v234
    v_accvgpr_read_b32 v235, a49
    v_mul_f32 v235, v235, v232
    v_accvgpr_write_b32 a49, v235
    v_accvgpr_read_b32 v236, a50
    v_mul_f32 v236, v236, v232
    v_accvgpr_write_b32 a50, v236
    v_accvgpr_read_b32 v237, a51
    v_mul_f32 v237, v237, v232
    v_accvgpr_write_b32 a51, v237
    v_accvgpr_read_b32 v234, a52
    v_mul_f32 v234, v234, v232
    v_accvgpr_write_b32 a52, v234
    v_accvgpr_read_b32 v235, a53
    v_mul_f32 v235, v235, v232
    v_accvgpr_write_b32 a53, v235
    v_accvgpr_read_b32 v236, a54
    v_mul_f32 v236, v236, v232
    v_accvgpr_write_b32 a54, v236
    v_accvgpr_read_b32 v237, a55
    v_mul_f32 v237, v237, v232
    v_accvgpr_write_b32 a55, v237
    v_accvgpr_read_b32 v234, a56
    v_mul_f32 v234, v234, v232
    v_accvgpr_write_b32 a56, v234
    v_accvgpr_read_b32 v235, a57
    v_mul_f32 v235, v235, v232
    v_accvgpr_write_b32 a57, v235
    v_accvgpr_read_b32 v236, a58
    v_mul_f32 v236, v236, v232
    v_accvgpr_write_b32 a58, v236
    v_accvgpr_read_b32 v237, a59
    v_mul_f32 v237, v237, v232
    v_accvgpr_write_b32 a59, v237
    v_accvgpr_read_b32 v234, a60
    v_mul_f32 v234, v234, v232
    v_accvgpr_write_b32 a60, v234
    v_accvgpr_read_b32 v235, a61
    v_mul_f32 v235, v235, v232
    v_accvgpr_write_b32 a61, v235
    v_accvgpr_read_b32 v236, a62
    v_mul_f32 v236, v236, v232
    v_accvgpr_write_b32 a62, v236
    v_accvgpr_read_b32 v237, a63
    v_mul_f32 v237, v237, v232
    v_accvgpr_write_b32 a63, v237
    v_exp_f32 v136, v0
    v_exp_f32 v137, v1
    v_exp_f32 v130, v2
    v_exp_f32 v131, v3
    v_cvt_pk_bf16_f32 v96, v136, v137
    v_exp_f32 v132, v4
    v_exp_f32 v133, v5
    v_cvt_pk_bf16_f32 v97, v130, v131
    v_add_f32 v136, v136, v130
    v_add_f32 v137, v137, v131
    v_exp_f32 v134, v6
    v_exp_f32 v135, v7
    v_cvt_pk_bf16_f32 v98, v132, v133
    v_add_f32 v136, v136, v132
    v_add_f32 v137, v137, v133
    v_exp_f32 v128, v8
    v_exp_f32 v129, v9
    v_cvt_pk_bf16_f32 v99, v134, v135
    v_add_f32 v136, v136, v134
    v_add_f32 v137, v137, v135
    v_exp_f32 v130, v10
    v_exp_f32 v131, v11
    v_cvt_pk_bf16_f32 v100, v128, v129
    v_add_f32 v136, v136, v128
    v_add_f32 v137, v137, v129
    v_exp_f32 v132, v12
    v_exp_f32 v133, v13
    v_cvt_pk_bf16_f32 v101, v130, v131
    v_add_f32 v136, v136, v130
    v_add_f32 v137, v137, v131
    v_exp_f32 v134, v14
    v_exp_f32 v135, v15
    v_cvt_pk_bf16_f32 v102, v132, v133
    v_add_f32 v136, v136, v132
    v_add_f32 v137, v137, v133
    v_cvt_pk_bf16_f32 v103, v134, v135
    v_add_f32 v136, v136, v134
    v_add_f32 v137, v137, v135
    v_add_f32 v224, v136, v137
    v_max3_f32 v230, v16, v17, v18
    v_max3_f32 v230, v230, v19, v20
    v_max3_f32 v230, v230, v21, v22
    v_max3_f32 v230, v230, v23, v24
    v_max3_f32 v230, v230, v25, v26
    v_max3_f32 v230, v230, v27, v28
    v_max3_f32 v230, v230, v29, v30
    v_max_f32 v230, v230, v31
    v_mov_b32 v231, v230
    s_nop 1
    v_permlane32_swap_b32 v230, v231
    s_nop 0
    v_max_f32 v230, v230, v231
    v_max_f32 v230, 0, v230
    v_sub_f32 v232, 0, v230
    v_exp_f32 v232, v232
    v_sub_f32 v229, v229, v230
    v_sub_f32 v80, v80, v230
    v_sub_f32 v48, v48, v230
    v_sub_f32 v16, v16, v230
    v_sub_f32 v81, v81, v230
    v_sub_f32 v49, v49, v230
    v_sub_f32 v17, v17, v230
    v_sub_f32 v82, v82, v230
    v_sub_f32 v50, v50, v230
    v_sub_f32 v18, v18, v230
    v_sub_f32 v83, v83, v230
    v_sub_f32 v51, v51, v230
    v_sub_f32 v19, v19, v230
    v_sub_f32 v84, v84, v230
    v_sub_f32 v52, v52, v230
    v_sub_f32 v20, v20, v230
    v_sub_f32 v85, v85, v230
    v_sub_f32 v53, v53, v230
    v_sub_f32 v21, v21, v230
    v_sub_f32 v86, v86, v230
    v_sub_f32 v54, v54, v230
    v_sub_f32 v22, v22, v230
    v_sub_f32 v87, v87, v230
    v_sub_f32 v55, v55, v230
    v_sub_f32 v23, v23, v230
    v_sub_f32 v88, v88, v230
    v_sub_f32 v56, v56, v230
    v_sub_f32 v24, v24, v230
    v_sub_f32 v89, v89, v230
    v_sub_f32 v57, v57, v230
    v_sub_f32 v25, v25, v230
    v_sub_f32 v90, v90, v230
    v_sub_f32 v58, v58, v230
    v_sub_f32 v26, v26, v230
    v_sub_f32 v91, v91, v230
    v_sub_f32 v59, v59, v230
    v_sub_f32 v27, v27, v230
    v_sub_f32 v92, v92, v230
    v_sub_f32 v60, v60, v230
    v_sub_f32 v28, v28, v230
    v_sub_f32 v93, v93, v230
    v_sub_f32 v61, v61, v230
    v_sub_f32 v29, v29, v230
    v_sub_f32 v94, v94, v230
    v_sub_f32 v62, v62, v230
    v_sub_f32 v30, v30, v230
    v_sub_f32 v95, v95, v230
    v_sub_f32 v63, v63, v230
    v_sub_f32 v31, v31, v230
    v_mul_f32 v227, v227, v232
    v_accvgpr_read_b32 v234, a64
    v_mul_f32 v234, v234, v232
    v_accvgpr_write_b32 a64, v234
    v_accvgpr_read_b32 v235, a65
    v_mul_f32 v235, v235, v232
    v_accvgpr_write_b32 a65, v235
    v_accvgpr_read_b32 v236, a66
    v_mul_f32 v236, v236, v232
    v_accvgpr_write_b32 a66, v236
    v_accvgpr_read_b32 v237, a67
    v_mul_f32 v237, v237, v232
    v_accvgpr_write_b32 a67, v237
    v_accvgpr_read_b32 v234, a68
    v_mul_f32 v234, v234, v232
    v_accvgpr_write_b32 a68, v234
    v_accvgpr_read_b32 v235, a69
    v_mul_f32 v235, v235, v232
    v_accvgpr_write_b32 a69, v235
    v_accvgpr_read_b32 v236, a70
    v_mul_f32 v236, v236, v232
    v_accvgpr_write_b32 a70, v236
    v_accvgpr_read_b32 v237, a71
    v_mul_f32 v237, v237, v232
    v_accvgpr_write_b32 a71, v237
    v_accvgpr_read_b32 v234, a72
    v_mul_f32 v234, v234, v232
    v_accvgpr_write_b32 a72, v234
    v_accvgpr_read_b32 v235, a73
    v_mul_f32 v235, v235, v232
    v_accvgpr_write_b32 a73, v235
    v_accvgpr_read_b32 v236, a74
    v_mul_f32 v236, v236, v232
    v_accvgpr_write_b32 a74, v236
    v_accvgpr_read_b32 v237, a75
    v_mul_f32 v237, v237, v232
    v_accvgpr_write_b32 a75, v237
    v_accvgpr_read_b32 v234, a76
    v_mul_f32 v234, v234, v232
    v_accvgpr_write_b32 a76, v234
    v_accvgpr_read_b32 v235, a77
    v_mul_f32 v235, v235, v232
    v_accvgpr_write_b32 a77, v235
    v_accvgpr_read_b32 v236, a78
    v_mul_f32 v236, v236, v232
    v_accvgpr_write_b32 a78, v236
    v_accvgpr_read_b32 v237, a79
    v_mul_f32 v237, v237, v232
    v_accvgpr_write_b32 a79, v237
    v_accvgpr_read_b32 v234, a80
    v_mul_f32 v234, v234, v232
    v_accvgpr_write_b32 a80, v234
    v_accvgpr_read_b32 v235, a81
    v_mul_f32 v235, v235, v232
    v_accvgpr_write_b32 a81, v235
    v_accvgpr_read_b32 v236, a82
    v_mul_f32 v236, v236, v232
    v_accvgpr_write_b32 a82, v236
    v_accvgpr_read_b32 v237, a83
    v_mul_f32 v237, v237, v232
    v_accvgpr_write_b32 a83, v237
    v_accvgpr_read_b32 v234, a84
    v_mul_f32 v234, v234, v232
    v_accvgpr_write_b32 a84, v234
    v_accvgpr_read_b32 v235, a85
    v_mul_f32 v235, v235, v232
    v_accvgpr_write_b32 a85, v235
    v_accvgpr_read_b32 v236, a86
    v_mul_f32 v236, v236, v232
    v_accvgpr_write_b32 a86, v236
    v_accvgpr_read_b32 v237, a87
    v_mul_f32 v237, v237, v232
    v_accvgpr_write_b32 a87, v237
    v_accvgpr_read_b32 v234, a88
    v_mul_f32 v234, v234, v232
    v_accvgpr_write_b32 a88, v234
    v_accvgpr_read_b32 v235, a89
    v_mul_f32 v235, v235, v232
    v_accvgpr_write_b32 a89, v235
    v_accvgpr_read_b32 v236, a90
    v_mul_f32 v236, v236, v232
    v_accvgpr_write_b32 a90, v236
    v_accvgpr_read_b32 v237, a91
    v_mul_f32 v237, v237, v232
    v_accvgpr_write_b32 a91, v237
    v_accvgpr_read_b32 v234, a92
    v_mul_f32 v234, v234, v232
    v_accvgpr_write_b32 a92, v234
    v_accvgpr_read_b32 v235, a93
    v_mul_f32 v235, v235, v232
    v_accvgpr_write_b32 a93, v235
    v_accvgpr_read_b32 v236, a94
    v_mul_f32 v236, v236, v232
    v_accvgpr_write_b32 a94, v236
    v_accvgpr_read_b32 v237, a95
    v_mul_f32 v237, v237, v232
    v_accvgpr_write_b32 a95, v237
    v_accvgpr_read_b32 v234, a96
    v_mul_f32 v234, v234, v232
    v_accvgpr_write_b32 a96, v234
    v_accvgpr_read_b32 v235, a97
    v_mul_f32 v235, v235, v232
    v_accvgpr_write_b32 a97, v235
    v_accvgpr_read_b32 v236, a98
    v_mul_f32 v236, v236, v232
    v_accvgpr_write_b32 a98, v236
    v_accvgpr_read_b32 v237, a99
    v_mul_f32 v237, v237, v232
    v_accvgpr_write_b32 a99, v237
    v_accvgpr_read_b32 v234, a100
    v_mul_f32 v234, v234, v232
    v_accvgpr_write_b32 a100, v234
    v_accvgpr_read_b32 v235, a101
    v_mul_f32 v235, v235, v232
    v_accvgpr_write_b32 a101, v235
    v_accvgpr_read_b32 v236, a102
    v_mul_f32 v236, v236, v232
    v_accvgpr_write_b32 a102, v236
    v_accvgpr_read_b32 v237, a103
    v_mul_f32 v237, v237, v232
    v_accvgpr_write_b32 a103, v237
    v_accvgpr_read_b32 v234, a104
    v_mul_f32 v234, v234, v232
    v_accvgpr_write_b32 a104, v234
    v_accvgpr_read_b32 v235, a105
    v_mul_f32 v235, v235, v232
    v_accvgpr_write_b32 a105, v235
    v_accvgpr_read_b32 v236, a106
    v_mul_f32 v236, v236, v232
    v_accvgpr_write_b32 a106, v236
    v_accvgpr_read_b32 v237, a107
    v_mul_f32 v237, v237, v232
    v_accvgpr_write_b32 a107, v237
    v_accvgpr_read_b32 v234, a108
    v_mul_f32 v234, v234, v232
    v_accvgpr_write_b32 a108, v234
    v_accvgpr_read_b32 v235, a109
    v_mul_f32 v235, v235, v232
    v_accvgpr_write_b32 a109, v235
    v_accvgpr_read_b32 v236, a110
    v_mul_f32 v236, v236, v232
    v_accvgpr_write_b32 a110, v236
    v_accvgpr_read_b32 v237, a111
    v_mul_f32 v237, v237, v232
    v_accvgpr_write_b32 a111, v237
    v_accvgpr_read_b32 v234, a112
    v_mul_f32 v234, v234, v232
    v_accvgpr_write_b32 a112, v234
    v_accvgpr_read_b32 v235, a113
    v_mul_f32 v235, v235, v232
    v_accvgpr_write_b32 a113, v235
    v_accvgpr_read_b32 v236, a114
    v_mul_f32 v236, v236, v232
    v_accvgpr_write_b32 a114, v236
    v_accvgpr_read_b32 v237, a115
    v_mul_f32 v237, v237, v232
    v_accvgpr_write_b32 a115, v237
    v_accvgpr_read_b32 v234, a116
    v_mul_f32 v234, v234, v232
    v_accvgpr_write_b32 a116, v234
    v_accvgpr_read_b32 v235, a117
    v_mul_f32 v235, v235, v232
    v_accvgpr_write_b32 a117, v235
    v_accvgpr_read_b32 v236, a118
    v_mul_f32 v236, v236, v232
    v_accvgpr_write_b32 a118, v236
    v_accvgpr_read_b32 v237, a119
    v_mul_f32 v237, v237, v232
    v_accvgpr_write_b32 a119, v237
    v_accvgpr_read_b32 v234, a120
    v_mul_f32 v234, v234, v232
    v_accvgpr_write_b32 a120, v234
    v_accvgpr_read_b32 v235, a121
    v_mul_f32 v235, v235, v232
    v_accvgpr_write_b32 a121, v235
    v_accvgpr_read_b32 v236, a122
    v_mul_f32 v236, v236, v232
    v_accvgpr_write_b32 a122, v236
    v_accvgpr_read_b32 v237, a123
    v_mul_f32 v237, v237, v232
    v_accvgpr_write_b32 a123, v237
    v_accvgpr_read_b32 v234, a124
    v_mul_f32 v234, v234, v232
    v_accvgpr_write_b32 a124, v234
    v_accvgpr_read_b32 v235, a125
    v_mul_f32 v235, v235, v232
    v_accvgpr_write_b32 a125, v235
    v_accvgpr_read_b32 v236, a126
    v_mul_f32 v236, v236, v232
    v_accvgpr_write_b32 a126, v236
    v_accvgpr_read_b32 v237, a127
    v_mul_f32 v237, v237, v232
    v_accvgpr_write_b32 a127, v237
    v_exp_f32 v138, v16
    v_exp_f32 v139, v17
    v_exp_f32 v130, v18
    v_exp_f32 v131, v19
    v_cvt_pk_bf16_f32 v104, v138, v139
    v_exp_f32 v132, v20
    v_exp_f32 v133, v21
    v_cvt_pk_bf16_f32 v105, v130, v131
    v_add_f32 v138, v138, v130
    v_add_f32 v139, v139, v131
    v_exp_f32 v134, v22
    v_exp_f32 v135, v23
    v_cvt_pk_bf16_f32 v106, v132, v133
    v_add_f32 v138, v138, v132
    v_add_f32 v139, v139, v133
    v_exp_f32 v128, v24
    v_exp_f32 v129, v25
    v_cvt_pk_bf16_f32 v107, v134, v135
    v_add_f32 v138, v138, v134
    v_add_f32 v139, v139, v135
    v_exp_f32 v130, v26
    v_exp_f32 v131, v27
    v_cvt_pk_bf16_f32 v108, v128, v129
    v_add_f32 v138, v138, v128
    v_add_f32 v139, v139, v129
    v_exp_f32 v132, v28
    v_exp_f32 v133, v29
    v_cvt_pk_bf16_f32 v109, v130, v131
    v_add_f32 v138, v138, v130
    v_add_f32 v139, v139, v131
    v_exp_f32 v134, v30
    v_exp_f32 v135, v31
    v_cvt_pk_bf16_f32 v110, v132, v133
    v_add_f32 v138, v138, v132
    v_add_f32 v139, v139, v133
    v_cvt_pk_bf16_f32 v111, v134, v135
    v_add_f32 v138, v138, v134
    v_add_f32 v139, v139, v135
    v_add_f32 v225, v138, v139
    s_nop 1
    s_branch ka_rr15
ka_l2p17:
    buffer_load_dword v252, v245, s[56:59], s28 offen
    s_add_u32 s28, s28, 4096
    s_branch ka_l2r18
ka_fix19:
    s_cmp_eq_u32 s36, 0
    s_cselect_b32 s24, 0, 0x74000000
    v_subrev_f32 v230, s24, v243
    v_add_f32 v231, 0, v230
    v_min_f32 v80, v229, v231
    v_add_f32 v232, 0xf1800000, v230
    v_min_f32 v81, v229, v232
    v_add_f32 v231, 0xf2000000, v230
    v_min_f32 v82, v229, v231
    v_add_f32 v232, 0xf2400000, v230
    v_min_f32 v83, v229, v232
    v_add_f32 v231, 0xf3000000, v230
    v_min_f32 v84, v229, v231
    v_add_f32 v232, 0xf3100000, v230
    v_min_f32 v85, v229, v232
    v_add_f32 v231, 0xf3200000, v230
    v_min_f32 v86, v229, v231
    v_add_f32 v232, 0xf3300000, v230
    v_min_f32 v87, v229, v232
    v_add_f32 v231, 0xf3800000, v230
    v_min_f32 v88, v229, v231
    v_add_f32 v232, 0xf3880000, v230
    v_min_f32 v89, v229, v232
    v_add_f32 v231, 0xf3900000, v230
    v_min_f32 v90, v229, v231
    v_add_f32 v232, 0xf3980000, v230
    v_min_f32 v91, v229, v232
    v_add_f32 v231, 0xf3c00000, v230
    v_min_f32 v92, v229, v231
    v_add_f32 v232, 0xf3c80000, v230
    v_min_f32 v93, v229, v232
    v_add_f32 v231, 0xf3d00000, v230
    v_min_f32 v94, v229, v231
    v_add_f32 v232, 0xf3d80000, v230
    v_min_f32 v95, v229, v232
    s_nop 1
    s_branch ka_fixr20
ka_rare22:
    s_nop 15
    v_max3_f32 v230, v32, v33, v34
    v_max3_f32 v230, v230, v35, v36
    v_max3_f32 v230, v230, v37, v38
    v_max3_f32 v230, v230, v39, v40
    v_max3_f32 v230, v230, v41, v42
    v_max3_f32 v230, v230, v43, v44
    v_max3_f32 v230, v230, v45, v46
    v_max_f32 v230, v230, v47
    v_mov_b32 v231, v230
    s_nop 1
    v_permlane32_swap_b32 v230, v231
    s_nop 0
    v_max_f32 v230, v230, v231
    v_max_f32 v230, 0, v230
    v_sub_f32 v232, 0, v230
    v_exp_f32 v232, v232
    v_sub_f32 v228, v228, v230
    v_sub_f32 v64, v64, v230
    v_sub_f32 v0, v0, v230
    v_sub_f32 v32, v32, v230
    v_sub_f32 v65, v65, v230
    v_sub_f32 v1, v1, v230
    v_sub_f32 v33, v33, v230
    v_sub_f32 v66, v66, v230
    v_sub_f32 v2, v2, v230
    v_sub_f32 v34, v34, v230
    v_sub_f32 v67, v67, v230
    v_sub_f32 v3, v3, v230
    v_sub_f32 v35, v35, v230
    v_sub_f32 v68, v68, v230
    v_sub_f32 v4, v4, v230
    v_sub_f32 v36, v36, v230
    v_sub_f32 v69, v69, v230
    v_sub_f32 v5, v5, v230
    v_sub_f32 v37, v37, v230
    v_sub_f32 v70, v70, v230
    v_sub_f32 v6, v6, v230
    v_sub_f32 v38, v38, v230
    v_sub_f32 v71, v71, v230
    v_sub_f32 v7, v7, v230
    v_sub_f32 v39, v39, v230
    v_sub_f32 v72, v72, v230
    v_sub_f32 v8, v8, v230
    v_sub_f32 v40, v40, v230
    v_sub_f32 v73, v73, v230
    v_sub_f32 v9, v9, v230
    v_sub_f32 v41, v41, v230
    v_sub_f32 v74, v74, v230
    v_sub_f32 v10, v10, v230
    v_sub_f32 v42, v42, v230
    v_sub_f32 v75, v75, v230
    v_sub_f32 v11, v11, v230
    v_sub_f32 v43, v43, v230
    v_sub_f32 v76, v76, v230
    v_sub_f32 v12, v12, v230
    v_sub_f32 v44, v44, v230
    v_sub_f32 v77, v77, v230
    v_sub_f32 v13, v13, v230
    v_sub_f32 v45, v45, v230
    v_sub_f32 v78, v78, v230
    v_sub_f32 v14, v14, v230
    v_sub_f32 v46, v46, v230
    v_sub_f32 v79, v79, v230
    v_sub_f32 v15, v15, v230
    v_sub_f32 v47, v47, v230
    v_mul_f32 v226, v226, v232
    v_accvgpr_read_b32 v234, a0
    v_mul_f32 v234, v234, v232
    v_accvgpr_write_b32 a0, v234
    v_accvgpr_read_b32 v235, a1
    v_mul_f32 v235, v235, v232
    v_accvgpr_write_b32 a1, v235
    v_accvgpr_read_b32 v236, a2
    v_mul_f32 v236, v236, v232
    v_accvgpr_write_b32 a2, v236
    v_accvgpr_read_b32 v237, a3
    v_mul_f32 v237, v237, v232
    v_accvgpr_write_b32 a3, v237
    v_accvgpr_read_b32 v234, a4
    v_mul_f32 v234, v234, v232
    v_accvgpr_write_b32 a4, v234
    v_accvgpr_read_b32 v235, a5
    v_mul_f32 v235, v235, v232
    v_accvgpr_write_b32 a5, v235
    v_accvgpr_read_b32 v236, a6
    v_mul_f32 v236, v236, v232
    v_accvgpr_write_b32 a6, v236
    v_accvgpr_read_b32 v237, a7
    v_mul_f32 v237, v237, v232
    v_accvgpr_write_b32 a7, v237
    v_accvgpr_read_b32 v234, a8
    v_mul_f32 v234, v234, v232
    v_accvgpr_write_b32 a8, v234
    v_accvgpr_read_b32 v235, a9
    v_mul_f32 v235, v235, v232
    v_accvgpr_write_b32 a9, v235
    v_accvgpr_read_b32 v236, a10
    v_mul_f32 v236, v236, v232
    v_accvgpr_write_b32 a10, v236
    v_accvgpr_read_b32 v237, a11
    v_mul_f32 v237, v237, v232
    v_accvgpr_write_b32 a11, v237
    v_accvgpr_read_b32 v234, a12
    v_mul_f32 v234, v234, v232
    v_accvgpr_write_b32 a12, v234
    v_accvgpr_read_b32 v235, a13
    v_mul_f32 v235, v235, v232
    v_accvgpr_write_b32 a13, v235
    v_accvgpr_read_b32 v236, a14
    v_mul_f32 v236, v236, v232
    v_accvgpr_write_b32 a14, v236
    v_accvgpr_read_b32 v237, a15
    v_mul_f32 v237, v237, v232
    v_accvgpr_write_b32 a15, v237
    v_accvgpr_read_b32 v234, a16
    v_mul_f32 v234, v234, v232
    v_accvgpr_write_b32 a16, v234
    v_accvgpr_read_b32 v235, a17
    v_mul_f32 v235, v235, v232
    v_accvgpr_write_b32 a17, v235
    v_accvgpr_read_b32 v236, a18
    v_mul_f32 v236, v236, v232
    v_accvgpr_write_b32 a18, v236
    v_accvgpr_read_b32 v237, a19
    v_mul_f32 v237, v237, v232
    v_accvgpr_write_b32 a19, v237
    v_accvgpr_read_b32 v234, a20
    v_mul_f32 v234, v234, v232
    v_accvgpr_write_b32 a20, v234
    v_accvgpr_read_b32 v235, a21
    v_mul_f32 v235, v235, v232
    v_accvgpr_write_b32 a21, v235
    v_accvgpr_read_b32 v236, a22
    v_mul_f32 v236, v236, v232
    v_accvgpr_write_b32 a22, v236
    v_accvgpr_read_b32 v237, a23
    v_mul_f32 v237, v237, v232
    v_accvgpr_write_b32 a23, v237
    v_accvgpr_read_b32 v234, a24
    v_mul_f32 v234, v234, v232
    v_accvgpr_write_b32 a24, v234
    v_accvgpr_read_b32 v235, a25
    v_mul_f32 v235, v235, v232
    v_accvgpr_write_b32 a25, v235
    v_accvgpr_read_b32 v236, a26
    v_mul_f32 v236, v236, v232
    v_accvgpr_write_b32 a26, v236
    v_accvgpr_read_b32 v237, a27
    v_mul_f32 v237, v237, v232
    v_accvgpr_write_b32 a27, v237
    v_accvgpr_read_b32 v234, a28
    v_mul_f32 v234, v234, v232
    v_accvgpr_write_b32 a28, v234
    v_accvgpr_read_b32 v235, a29
    v_mul_f32 v235, v235, v232
    v_accvgpr_write_b32 a29, v235
    v_accvgpr_read_b32 v236, a30
    v_mul_f32 v236, v236, v232
    v_accvgpr_write_b32 a30, v236
    v_accvgpr_read_b32 v237, a31
    v_mul_f32 v237, v237, v232
    v_accvgpr_write_b32 a31, v237
    v_accvgpr_read_b32 v234, a32
    v_mul_f32 v234, v234, v232
    v_accvgpr_write_b32 a32, v234
    v_accvgpr_read_b32 v235, a33
    v_mul_f32 v235, v235, v232
    v_accvgpr_write_b32 a33, v235
    v_accvgpr_read_b32 v236, a34
    v_mul_f32 v236, v236, v232
    v_accvgpr_write_b32 a34, v236
    v_accvgpr_read_b32 v237, a35
    v_mul_f32 v237, v237, v232
    v_accvgpr_write_b32 a35, v237
    v_accvgpr_read_b32 v234, a36
    v_mul_f32 v234, v234, v232
    v_accvgpr_write_b32 a36, v234
    v_accvgpr_read_b32 v235, a37
    v_mul_f32 v235, v235, v232
    v_accvgpr_write_b32 a37, v235
    v_accvgpr_read_b32 v236, a38
    v_mul_f32 v236, v236, v232
    v_accvgpr_write_b32 a38, v236
    v_accvgpr_read_b32 v237, a39
    v_mul_f32 v237, v237, v232
    v_accvgpr_write_b32 a39, v237
    v_accvgpr_read_b32 v234, a40
    v_mul_f32 v234, v234, v232
    v_accvgpr_write_b32 a40, v234
    v_accvgpr_read_b32 v235, a41
    v_mul_f32 v235, v235, v232
    v_accvgpr_write_b32 a41, v235
    v_accvgpr_read_b32 v236, a42
    v_mul_f32 v236, v236, v232
    v_accvgpr_write_b32 a42, v236
    v_accvgpr_read_b32 v237, a43
    v_mul_f32 v237, v237, v232
    v_accvgpr_write_b32 a43, v237
    v_accvgpr_read_b32 v234, a44
    v_mul_f32 v234, v234, v232
    v_accvgpr_write_b32 a44, v234
    v_accvgpr_read_b32 v235, a45
    v_mul_f32 v235, v235, v232
    v_accvgpr_write_b32 a45, v235
    v_accvgpr_read_b32 v236, a46
    v_mul_f32 v236, v236, v232
    v_accvgpr_write_b32 a46, v236
    v_accvgpr_read_b32 v237, a47
    v_mul_f32 v237, v237, v232
    v_accvgpr_write_b32 a47, v237
    v_accvgpr_read_b32 v234, a48
    v_mul_f32 v234, v234, v232
    v_accvgpr_write_b32 a48, v234
    v_accvgpr_read_b32 v235, a49
    v_mul_f32 v235, v235, v232
    v_accvgpr_write_b32 a49, v235
    v_accvgpr_read_b32 v236, a50
    v_mul_f32 v236, v236, v232
    v_accvgpr_write_b32 a50, v236
    v_accvgpr_read_b32 v237, a51
    v_mul_f32 v237, v237, v232
    v_accvgpr_write_b32 a51, v237
    v_accvgpr_read_b32 v234, a52
    v_mul_f32 v234, v234, v232
    v_accvgpr_write_b32 a52, v234
    v_accvgpr_read_b32 v235, a53
    v_mul_f32 v235, v235, v232
    v_accvgpr_write_b32 a53, v235
    v_accvgpr_read_b32 v236, a54
    v_mul_f32 v236, v236, v232
    v_accvgpr_write_b32 a54, v236
    v_accvgpr_read_b32 v237, a55
    v_mul_f32 v237, v237, v232
    v_accvgpr_write_b32 a55, v237
    v_accvgpr_read_b32 v234, a56
    v_mul_f32 v234, v234, v232
    v_accvgpr_write_b32 a56, v234
    v_accvgpr_read_b32 v235, a57
    v_mul_f32 v235, v235, v232
    v_accvgpr_write_b32 a57, v235
    v_accvgpr_read_b32 v236, a58
    v_mul_f32 v236, v236, v232
    v_accvgpr_write_b32 a58, v236
    v_accvgpr_read_b32 v237, a59
    v_mul_f32 v237, v237, v232
    v_accvgpr_write_b32 a59, v237
    v_accvgpr_read_b32 v234, a60
    v_mul_f32 v234, v234, v232
    v_accvgpr_write_b32 a60, v234
    v_accvgpr_read_b32 v235, a61
    v_mul_f32 v235, v235, v232
    v_accvgpr_write_b32 a61, v235
    v_accvgpr_read_b32 v236, a62
    v_mul_f32 v236, v236, v232
    v_accvgpr_write_b32 a62, v236
    v_accvgpr_read_b32 v237, a63
    v_mul_f32 v237, v237, v232
    v_accvgpr_write_b32 a63, v237
    v_exp_f32 v136, v32
    v_exp_f32 v137, v33
    v_exp_f32 v130, v34
    v_exp_f32 v131, v35
    v_cvt_pk_bf16_f32 v112, v136, v137
    v_exp_f32 v132, v36
    v_exp_f32 v133, v37
    v_cvt_pk_bf16_f32 v113, v130, v131
    v_add_f32 v136, v136, v130
    v_add_f32 v137, v137, v131
    v_exp_f32 v134, v38
    v_exp_f32 v135, v39
    v_cvt_pk_bf16_f32 v114, v132, v133
    v_add_f32 v136, v136, v132
    v_add_f32 v137, v137, v133
    v_exp_f32 v128, v40
    v_exp_f32 v129, v41
    v_cvt_pk_bf16_f32 v115, v134, v135
    v_add_f32 v136, v136, v134
    v_add_f32 v137, v137, v135
    v_exp_f32 v130, v42
    v_exp_f32 v131, v43
    v_cvt_pk_bf16_f32 v116, v128, v129
    v_add_f32 v136, v136, v128
    v_add_f32 v137, v137, v129
    v_exp_f32 v132, v44
    v_exp_f32 v133, v45
    v_cvt_pk_bf16_f32 v117, v130, v131
    v_add_f32 v136, v136, v130
    v_add_f32 v137, v137, v131
    v_exp_f32 v134, v46
    v_exp_f32 v135, v47
    v_cvt_pk_bf16_f32 v118, v132, v133
    v_add_f32 v136, v136, v132
    v_add_f32 v137, v137, v133
    v_cvt_pk_bf16_f32 v119, v134, v135
    v_add_f32 v136, v136, v134
    v_add_f32 v137, v137, v135
    v_add_f32 v224, v136, v137
    v_max3_f32 v230, v48, v49, v50
    v_max3_f32 v230, v230, v51, v52
    v_max3_f32 v230, v230, v53, v54
    v_max3_f32 v230, v230, v55, v56
    v_max3_f32 v230, v230, v57, v58
    v_max3_f32 v230, v230, v59, v60
    v_max3_f32 v230, v230, v61, v62
    v_max_f32 v230, v230, v63
    v_mov_b32 v231, v230
    s_nop 1
    v_permlane32_swap_b32 v230, v231
    s_nop 0
    v_max_f32 v230, v230, v231
    v_max_f32 v230, 0, v230
    v_sub_f32 v232, 0, v230
    v_exp_f32 v232, v232
    v_sub_f32 v229, v229, v230
    v_sub_f32 v80, v80, v230
    v_sub_f32 v16, v16, v230
    v_sub_f32 v48, v48, v230
    v_sub_f32 v81, v81, v230
    v_sub_f32 v17, v17, v230
    v_sub_f32 v49, v49, v230
    v_sub_f32 v82, v82, v230
    v_sub_f32 v18, v18, v230
    v_sub_f32 v50, v50, v230
    v_sub_f32 v83, v83, v230
    v_sub_f32 v19, v19, v230
    v_sub_f32 v51, v51, v230
    v_sub_f32 v84, v84, v230
    v_sub_f32 v20, v20, v230
    v_sub_f32 v52, v52, v230
    v_sub_f32 v85, v85, v230
    v_sub_f32 v21, v21, v230
    v_sub_f32 v53, v53, v230
    v_sub_f32 v86, v86, v230
    v_sub_f32 v22, v22, v230
    v_sub_f32 v54, v54, v230
    v_sub_f32 v87, v87, v230
    v_sub_f32 v23, v23, v230
    v_sub_f32 v55, v55, v230
    v_sub_f32 v88, v88, v230
    v_sub_f32 v24, v24, v230
    v_sub_f32 v56, v56, v230
    v_sub_f32 v89, v89, v230
    v_sub_f32 v25, v25, v230
    v_sub_f32 v57, v57, v230
    v_sub_f32 v90, v90, v230
    v_sub_f32 v26, v26, v230
    v_sub_f32 v58, v58, v230
    v_sub_f32 v91, v91, v230
    v_sub_f32 v27, v27, v230
    v_sub_f32 v59, v59, v230
    v_sub_f32 v92, v92, v230
    v_sub_f32 v28, v28, v230
    v_sub_f32 v60, v60, v230
    v_sub_f32 v93, v93, v230
    v_sub_f32 v29, v29, v230
    v_sub_f32 v61, v61, v230
    v_sub_f32 v94, v94, v230
    v_sub_f32 v30, v30, v230
    v_sub_f32 v62, v62, v230
    v_sub_f32 v95, v95, v230
    v_sub_f32 v31, v31, v230
    v_sub_f32 v63, v63, v230
    v_mul_f32 v227, v227, v232
    v_accvgpr_read_b32 v234, a64
    v_mul_f32 v234, v234, v232
    v_accvgpr_write_b32 a64, v234
    v_accvgpr_read_b32 v235, a65
    v_mul_f32 v235, v235, v232
    v_accvgpr_write_b32 a65, v235
    v_accvgpr_read_b32 v236, a66
    v_mul_f32 v236, v236, v232
    v_accvgpr_write_b32 a66, v236
    v_accvgpr_read_b32 v237, a67
    v_mul_f32 v237, v237, v232
    v_accvgpr_write_b32 a67, v237
    v_accvgpr_read_b32 v234, a68
    v_mul_f32 v234, v234, v232
    v_accvgpr_write_b32 a68, v234
    v_accvgpr_read_b32 v235, a69
    v_mul_f32 v235, v235, v232
    v_accvgpr_write_b32 a69, v235
    v_accvgpr_read_b32 v236, a70
    v_mul_f32 v236, v236, v232
    v_accvgpr_write_b32 a70, v236
    v_accvgpr_read_b32 v237, a71
    v_mul_f32 v237, v237, v232
    v_accvgpr_write_b32 a71, v237
    v_accvgpr_read_b32 v234, a72
    v_mul_f32 v234, v234, v232
    v_accvgpr_write_b32 a72, v234
    v_accvgpr_read_b32 v235, a73
    v_mul_f32 v235, v235, v232
    v_accvgpr_write_b32 a73, v235
    v_accvgpr_read_b32 v236, a74
    v_mul_f32 v236, v236, v232
    v_accvgpr_write_b32 a74, v236
    v_accvgpr_read_b32 v237, a75
    v_mul_f32 v237, v237, v232
    v_accvgpr_write_b32 a75, v237
    v_accvgpr_read_b32 v234, a76
    v_mul_f32 v234, v234, v232
    v_accvgpr_write_b32 a76, v234
    v_accvgpr_read_b32 v235, a77
    v_mul_f32 v235, v235, v232
    v_accvgpr_write_b32 a77, v235
    v_accvgpr_read_b32 v236, a78
    v_mul_f32 v236, v236, v232
    v_accvgpr_write_b32 a78, v236
    v_accvgpr_read_b32 v237, a79
    v_mul_f32 v237, v237, v232
    v_accvgpr_write_b32 a79, v237
    v_accvgpr_read_b32 v234, a80
    v_mul_f32 v234, v234, v232
    v_accvgpr_write_b32 a80, v234
    v_accvgpr_read_b32 v235, a81
    v_mul_f32 v235, v235, v232
    v_accvgpr_write_b32 a81, v235
    v_accvgpr_read_b32 v236, a82
    v_mul_f32 v236, v236, v232
    v_accvgpr_write_b32 a82, v236
    v_accvgpr_read_b32 v237, a83
    v_mul_f32 v237, v237, v232
    v_accvgpr_write_b32 a83, v237
    v_accvgpr_read_b32 v234, a84
    v_mul_f32 v234, v234, v232
    v_accvgpr_write_b32 a84, v234
    v_accvgpr_read_b32 v235, a85
    v_mul_f32 v235, v235, v232
    v_accvgpr_write_b32 a85, v235
    v_accvgpr_read_b32 v236, a86
    v_mul_f32 v236, v236, v232
    v_accvgpr_write_b32 a86, v236
    v_accvgpr_read_b32 v237, a87
    v_mul_f32 v237, v237, v232
    v_accvgpr_write_b32 a87, v237
    v_accvgpr_read_b32 v234, a88
    v_mul_f32 v234, v234, v232
    v_accvgpr_write_b32 a88, v234
    v_accvgpr_read_b32 v235, a89
    v_mul_f32 v235, v235, v232
    v_accvgpr_write_b32 a89, v235
    v_accvgpr_read_b32 v236, a90
    v_mul_f32 v236, v236, v232
    v_accvgpr_write_b32 a90, v236
    v_accvgpr_read_b32 v237, a91
    v_mul_f32 v237, v237, v232
    v_accvgpr_write_b32 a91, v237
    v_accvgpr_read_b32 v234, a92
    v_mul_f32 v234, v234, v232
    v_accvgpr_write_b32 a92, v234
    v_accvgpr_read_b32 v235, a93
    v_mul_f32 v235, v235, v232
    v_accvgpr_write_b32 a93, v235
    v_accvgpr_read_b32 v236, a94
    v_mul_f32 v236, v236, v232
    v_accvgpr_write_b32 a94, v236
    v_accvgpr_read_b32 v237, a95
    v_mul_f32 v237, v237, v232
    v_accvgpr_write_b32 a95, v237
    v_accvgpr_read_b32 v234, a96
    v_mul_f32 v234, v234, v232
    v_accvgpr_write_b32 a96, v234
    v_accvgpr_read_b32 v235, a97
    v_mul_f32 v235, v235, v232
    v_accvgpr_write_b32 a97, v235
    v_accvgpr_read_b32 v236, a98
    v_mul_f32 v236, v236, v232
    v_accvgpr_write_b32 a98, v236
    v_accvgpr_read_b32 v237, a99
    v_mul_f32 v237, v237, v232
    v_accvgpr_write_b32 a99, v237
    v_accvgpr_read_b32 v234, a100
    v_mul_f32 v234, v234, v232
    v_accvgpr_write_b32 a100, v234
    v_accvgpr_read_b32 v235, a101
    v_mul_f32 v235, v235, v232
    v_accvgpr_write_b32 a101, v235
    v_accvgpr_read_b32 v236, a102
    v_mul_f32 v236, v236, v232
    v_accvgpr_write_b32 a102, v236
    v_accvgpr_read_b32 v237, a103
    v_mul_f32 v237, v237, v232
    v_accvgpr_write_b32 a103, v237
    v_accvgpr_read_b32 v234, a104
    v_mul_f32 v234, v234, v232
    v_accvgpr_write_b32 a104, v234
    v_accvgpr_read_b32 v235, a105
    v_mul_f32 v235, v235, v232
    v_accvgpr_write_b32 a105, v235
    v_accvgpr_read_b32 v236, a106
    v_mul_f32 v236, v236, v232
    v_accvgpr_write_b32 a106, v236
    v_accvgpr_read_b32 v237, a107
    v_mul_f32 v237, v237, v232
    v_accvgpr_write_b32 a107, v237
    v_accvgpr_read_b32 v234, a108
    v_mul_f32 v234, v234, v232
    v_accvgpr_write_b32 a108, v234
    v_accvgpr_read_b32 v235, a109
    v_mul_f32 v235, v235, v232
    v_accvgpr_write_b32 a109, v235
    v_accvgpr_read_b32 v236, a110
    v_mul_f32 v236, v236, v232
    v_accvgpr_write_b32 a110, v236
    v_accvgpr_read_b32 v237, a111
    v_mul_f32 v237, v237, v232
    v_accvgpr_write_b32 a111, v237
    v_accvgpr_read_b32 v234, a112
    v_mul_f32 v234, v234, v232
    v_accvgpr_write_b32 a112, v234
    v_accvgpr_read_b32 v235, a113
    v_mul_f32 v235, v235, v232
    v_accvgpr_write_b32 a113, v235
    v_accvgpr_read_b32 v236, a114
    v_mul_f32 v236, v236, v232
    v_accvgpr_write_b32 a114, v236
    v_accvgpr_read_b32 v237, a115
    v_mul_f32 v237, v237, v232
    v_accvgpr_write_b32 a115, v237
    v_accvgpr_read_b32 v234, a116
    v_mul_f32 v234, v234, v232
    v_accvgpr_write_b32 a116, v234
    v_accvgpr_read_b32 v235, a117
    v_mul_f32 v235, v235, v232
    v_accvgpr_write_b32 a117, v235
    v_accvgpr_read_b32 v236, a118
    v_mul_f32 v236, v236, v232
    v_accvgpr_write_b32 a118, v236
    v_accvgpr_read_b32 v237, a119
    v_mul_f32 v237, v237, v232
    v_accvgpr_write_b32 a119, v237
    v_accvgpr_read_b32 v234, a120
    v_mul_f32 v234, v234, v232
    v_accvgpr_write_b32 a120, v234
    v_accvgpr_read_b32 v235, a121
    v_mul_f32 v235, v235, v232
    v_accvgpr_write_b32 a121, v235
    v_accvgpr_read_b32 v236, a122
    v_mul_f32 v236, v236, v232
    v_accvgpr_write_b32 a122, v236
    v_accvgpr_read_b32 v237, a123
    v_mul_f32 v237, v237, v232
    v_accvgpr_write_b32 a123, v237
    v_accvgpr_read_b32 v234, a124
    v_mul_f32 v234, v234, v232
    v_accvgpr_write_b32 a124, v234
    v_accvgpr_read_b32 v235, a125
    v_mul_f32 v235, v235, v232
    v_accvgpr_write_b32 a125, v235
    v_accvgpr_read_b32 v236, a126
    v_mul_f32 v236, v236, v232
    v_accvgpr_write_b32 a126, v236
    v_accvgpr_read_b32 v237, a127
    v_mul_f32 v237, v237, v232
    v_accvgpr_write_b32 a127, v237
    v_exp_f32 v138, v48
    v_exp_f32 v139, v49
    v_exp_f32 v130, v50
    v_exp_f32 v131, v51
    v_cvt_pk_bf16_f32 v120, v138, v139
    v_exp_f32 v132, v52
    v_exp_f32 v133, v53
    v_cvt_pk_bf16_f32 v121, v130, v131
    v_add_f32 v138, v138, v130
    v_add_f32 v139, v139, v131
    v_exp_f32 v134, v54
    v_exp_f32 v135, v55
    v_cvt_pk_bf16_f32 v122, v132, v133
    v_add_f32 v138, v138, v132
    v_add_f32 v139, v139, v133
    v_exp_f32 v128, v56
    v_exp_f32 v129, v57
    v_cvt_pk_bf16_f32 v123, v134, v135
    v_add_f32 v138, v138, v134
    v_add_f32 v139, v139, v135
    v_exp_f32 v130, v58
    v_exp_f32 v131, v59
    v_cvt_pk_bf16_f32 v124, v128, v129
    v_add_f32 v138, v138, v128
    v_add_f32 v139, v139, v129
    v_exp_f32 v132, v60
    v_exp_f32 v133, v61
    v_cvt_pk_bf16_f32 v125, v130, v131
    v_add_f32 v138, v138, v130
    v_add_f32 v139, v139, v131
    v_exp_f32 v134, v62
    v_exp_f32 v135, v63
    v_cvt_pk_bf16_f32 v126, v132, v133
    v_add_f32 v138, v138, v132
    v_add_f32 v139, v139, v133
    v_cvt_pk_bf16_f32 v127, v134, v135
    v_add_f32 v138, v138, v134
    v_add_f32 v139, v139, v135
    v_add_f32 v225, v138, v139
    s_nop 1
    s_branch ka_rr21
ka_l2p23:
    buffer_load_dword v252, v245, s[56:59], s28 offen
    s_add_u32 s28, s28, 4096
    s_branch ka_l2r24
ka_fix25:
    s_cmp_eq_u32 s36, 0
    s_cselect_b32 s24, 0, 0x74000000
    v_subrev_f32 v230, s24, v243
    v_add_f32 v231, 0, v230
    v_min_f32 v80, v229, v231
    v_add_f32 v232, 0xf1800000, v230
    v_min_f32 v81, v229, v232
    v_add_f32 v231, 0xf2000000, v230
    v_min_f32 v82, v229, v231
    v_add_f32 v232, 0xf2400000, v230
    v_min_f32 v83, v229, v232
    v_add_f32 v231, 0xf3000000, v230
    v_min_f32 v84, v229, v231
    v_add_f32 v232, 0xf3100000, v230
    v_min_f32 v85, v229, v232
    v_add_f32 v231, 0xf3200000, v230
    v_min_f32 v86, v229, v231
    v_add_f32 v232, 0xf3300000, v230
    v_min_f32 v87, v229, v232
    v_add_f32 v231, 0xf3800000, v230
    v_min_f32 v88, v229, v231
    v_add_f32 v232, 0xf3880000, v230
    v_min_f32 v89, v229, v232
    v_add_f32 v231, 0xf3900000, v230
    v_min_f32 v90, v229, v231
    v_add_f32 v232, 0xf3980000, v230
    v_min_f32 v91, v229, v232
    v_add_f32 v231, 0xf3c00000, v230
    v_min_f32 v92, v229, v231
    v_add_f32 v232, 0xf3c80000, v230
    v_min_f32 v93, v229, v232
    v_add_f32 v231, 0xf3d00000, v230
    v_min_f32 v94, v229, v231
    v_add_f32 v232, 0xf3d80000, v230
    v_min_f32 v95, v229, v232
    s_nop 1
    s_branch ka_fixr26
ka_rare28:
    s_nop 15
    v_max3_f32 v230, v16, v17, v18
    v_max3_f32 v230, v230, v19, v20
    v_max3_f32 v230, v230, v21, v22
    v_max3_f32 v230, v230, v23, v24
    v_max3_f32 v230, v230, v25, v26
    v_max3_f32 v230, v230, v27, v28
    v_max3_f32 v230, v230, v29, v30
    v_max_f32 v230, v230, v31
    v_mov_b32 v231, v230
    s_nop 1
    v_permlane32_swap_b32 v230, v231
    s_nop 0
    v_max_f32 v230, v230, v231
    v_max_f32 v230, 0, v230
    v_sub_f32 v232, 0, v230
    v_exp_f32 v232, v232
    v_sub_f32 v229, v229, v230
    v_sub_f32 v80, v80, v230
    v_sub_f32 v48, v48, v230
    v_sub_f32 v16, v16, v230
    v_sub_f32 v81, v81, v230
    v_sub_f32 v49, v49, v230
    v_sub_f32 v17, v17, v230
    v_sub_f32 v82, v82, v230
    v_sub_f32 v50, v50, v230
    v_sub_f32 v18, v18, v230
    v_sub_f32 v83, v83, v230
    v_sub_f32 v51, v51, v230
    v_sub_f32 v19, v19, v230
    v_sub_f32 v84, v84, v230
    v_sub_f32 v52, v52, v230
    v_sub_f32 v20, v20, v230
    v_sub_f32 v85, v85, v230
    v_sub_f32 v53, v53, v230
    v_sub_f32 v21, v21, v230
    v_sub_f32 v86, v86, v230
    v_sub_f32 v54, v54, v230
    v_sub_f32 v22, v22, v230
    v_sub_f32 v87, v87, v230
    v_sub_f32 v55, v55, v230
    v_sub_f32 v23, v23, v230
    v_sub_f32 v88, v88, v230
    v_sub_f32 v56, v56, v230
    v_sub_f32 v24, v24, v230
    v_sub_f32 v89, v89, v230
    v_sub_f32 v57, v57, v230
    v_sub_f32 v25, v25, v230
    v_sub_f32 v90, v90, v230
    v_sub_f32 v58, v58, v230
    v_sub_f32 v26, v26, v230
    v_sub_f32 v91, v91, v230
    v_sub_f32 v59, v59, v230
    v_sub_f32 v27, v27, v230
    v_sub_f32 v92, v92, v230
    v_sub_f32 v60, v60, v230
    v_sub_f32 v28, v28, v230
    v_sub_f32 v93, v93, v230
    v_sub_f32 v61, v61, v230
    v_sub_f32 v29, v29, v230
    v_sub_f32 v94, v94, v230
    v_sub_f32 v62, v62, v230
    v_sub_f32 v30, v30, v230
    v_sub_f32 v95, v95, v230
    v_sub_f32 v63, v63, v230
    v_sub_f32 v31, v31, v230
    v_mul_f32 v227, v227, v232
    v_accvgpr_read_b32 v234, a64
    v_mul_f32 v234, v234, v232
    v_accvgpr_write_b32 a64, v234
    v_accvgpr_read_b32 v235, a65
    v_mul_f32 v235, v235, v232
    v_accvgpr_write_b32 a65, v235
    v_accvgpr_read_b32 v236, a66
    v_mul_f32 v236, v236, v232
    v_accvgpr_write_b32 a66, v236
    v_accvgpr_read_b32 v237, a67
    v_mul_f32 v237, v237, v232
    v_accvgpr_write_b32 a67, v237
    v_accvgpr_read_b32 v234, a68
    v_mul_f32 v234, v234, v232
    v_accvgpr_write_b32 a68, v234
    v_accvgpr_read_b32 v235, a69
    v_mul_f32 v235, v235, v232
    v_accvgpr_write_b32 a69, v235
    v_accvgpr_read_b32 v236, a70
    v_mul_f32 v236, v236, v232
    v_accvgpr_write_b32 a70, v236
    v_accvgpr_read_b32 v237, a71
    v_mul_f32 v237, v237, v232
    v_accvgpr_write_b32 a71, v237
    v_accvgpr_read_b32 v234, a72
    v_mul_f32 v234, v234, v232
    v_accvgpr_write_b32 a72, v234
    v_accvgpr_read_b32 v235, a73
    v_mul_f32 v235, v235, v232
    v_accvgpr_write_b32 a73, v235
    v_accvgpr_read_b32 v236, a74
    v_mul_f32 v236, v236, v232
    v_accvgpr_write_b32 a74, v236
    v_accvgpr_read_b32 v237, a75
    v_mul_f32 v237, v237, v232
    v_accvgpr_write_b32 a75, v237
    v_accvgpr_read_b32 v234, a76
    v_mul_f32 v234, v234, v232
    v_accvgpr_write_b32 a76, v234
    v_accvgpr_read_b32 v235, a77
    v_mul_f32 v235, v235, v232
    v_accvgpr_write_b32 a77, v235
    v_accvgpr_read_b32 v236, a78
    v_mul_f32 v236, v236, v232
    v_accvgpr_write_b32 a78, v236
    v_accvgpr_read_b32 v237, a79
    v_mul_f32 v237, v237, v232
    v_accvgpr_write_b32 a79, v237
    v_accvgpr_read_b32 v234, a80
    v_mul_f32 v234, v234, v232
    v_accvgpr_write_b32 a80, v234
    v_accvgpr_read_b32 v235, a81
    v_mul_f32 v235, v235, v232
    v_accvgpr_write_b32 a81, v235
    v_accvgpr_read_b32 v236, a82
    v_mul_f32 v236, v236, v232
    v_accvgpr_write_b32 a82, v236
    v_accvgpr_read_b32 v237, a83
    v_mul_f32 v237, v237, v232
    v_accvgpr_write_b32 a83, v237
    v_accvgpr_read_b32 v234, a84
    v_mul_f32 v234, v234, v232
    v_accvgpr_write_b32 a84, v234
    v_accvgpr_read_b32 v235, a85
    v_mul_f32 v235, v235, v232
    v_accvgpr_write_b32 a85, v235
    v_accvgpr_read_b32 v236, a86
    v_mul_f32 v236, v236, v232
    v_accvgpr_write_b32 a86, v236
    v_accvgpr_read_b32 v237, a87
    v_mul_f32 v237, v237, v232
    v_accvgpr_write_b32 a87, v237
    v_accvgpr_read_b32 v234, a88
    v_mul_f32 v234, v234, v232
    v_accvgpr_write_b32 a88, v234
    v_accvgpr_read_b32 v235, a89
    v_mul_f32 v235, v235, v232
    v_accvgpr_write_b32 a89, v235
    v_accvgpr_read_b32 v236, a90
    v_mul_f32 v236, v236, v232
    v_accvgpr_write_b32 a90, v236
    v_accvgpr_read_b32 v237, a91
    v_mul_f32 v237, v237, v232
    v_accvgpr_write_b32 a91, v237
    v_accvgpr_read_b32 v234, a92
    v_mul_f32 v234, v234, v232
    v_accvgpr_write_b32 a92, v234
    v_accvgpr_read_b32 v235, a93
    v_mul_f32 v235, v235, v232
    v_accvgpr_write_b32 a93, v235
    v_accvgpr_read_b32 v236, a94
    v_mul_f32 v236, v236, v232
    v_accvgpr_write_b32 a94, v236
    v_accvgpr_read_b32 v237, a95
    v_mul_f32 v237, v237, v232
    v_accvgpr_write_b32 a95, v237
    v_accvgpr_read_b32 v234, a96
    v_mul_f32 v234, v234, v232
    v_accvgpr_write_b32 a96, v234
    v_accvgpr_read_b32 v235, a97
    v_mul_f32 v235, v235, v232
    v_accvgpr_write_b32 a97, v235
    v_accvgpr_read_b32 v236, a98
    v_mul_f32 v236, v236, v232
    v_accvgpr_write_b32 a98, v236
    v_accvgpr_read_b32 v237, a99
    v_mul_f32 v237, v237, v232
    v_accvgpr_write_b32 a99, v237
    v_accvgpr_read_b32 v234, a100
    v_mul_f32 v234, v234, v232
    v_accvgpr_write_b32 a100, v234
    v_accvgpr_read_b32 v235, a101
    v_mul_f32 v235, v235, v232
    v_accvgpr_write_b32 a101, v235
    v_accvgpr_read_b32 v236, a102
    v_mul_f32 v236, v236, v232
    v_accvgpr_write_b32 a102, v236
    v_accvgpr_read_b32 v237, a103
    v_mul_f32 v237, v237, v232
    v_accvgpr_write_b32 a103, v237
    v_accvgpr_read_b32 v234, a104
    v_mul_f32 v234, v234, v232
    v_accvgpr_write_b32 a104, v234
    v_accvgpr_read_b32 v235, a105
    v_mul_f32 v235, v235, v232
    v_accvgpr_write_b32 a105, v235
    v_accvgpr_read_b32 v236, a106
    v_mul_f32 v236, v236, v232
    v_accvgpr_write_b32 a106, v236
    v_accvgpr_read_b32 v237, a107
    v_mul_f32 v237, v237, v232
    v_accvgpr_write_b32 a107, v237
    v_accvgpr_read_b32 v234, a108
    v_mul_f32 v234, v234, v232
    v_accvgpr_write_b32 a108, v234
    v_accvgpr_read_b32 v235, a109
    v_mul_f32 v235, v235, v232
    v_accvgpr_write_b32 a109, v235
    v_accvgpr_read_b32 v236, a110
    v_mul_f32 v236, v236, v232
    v_accvgpr_write_b32 a110, v236
    v_accvgpr_read_b32 v237, a111
    v_mul_f32 v237, v237, v232
    v_accvgpr_write_b32 a111, v237
    v_accvgpr_read_b32 v234, a112
    v_mul_f32 v234, v234, v232
    v_accvgpr_write_b32 a112, v234
    v_accvgpr_read_b32 v235, a113
    v_mul_f32 v235, v235, v232
    v_accvgpr_write_b32 a113, v235
    v_accvgpr_read_b32 v236, a114
    v_mul_f32 v236, v236, v232
    v_accvgpr_write_b32 a114, v236
    v_accvgpr_read_b32 v237, a115
    v_mul_f32 v237, v237, v232
    v_accvgpr_write_b32 a115, v237
    v_accvgpr_read_b32 v234, a116
    v_mul_f32 v234, v234, v232
    v_accvgpr_write_b32 a116, v234
    v_accvgpr_read_b32 v235, a117
    v_mul_f32 v235, v235, v232
    v_accvgpr_write_b32 a117, v235
    v_accvgpr_read_b32 v236, a118
    v_mul_f32 v236, v236, v232
    v_accvgpr_write_b32 a118, v236
    v_accvgpr_read_b32 v237, a119
    v_mul_f32 v237, v237, v232
    v_accvgpr_write_b32 a119, v237
    v_accvgpr_read_b32 v234, a120
    v_mul_f32 v234, v234, v232
    v_accvgpr_write_b32 a120, v234
    v_accvgpr_read_b32 v235, a121
    v_mul_f32 v235, v235, v232
    v_accvgpr_write_b32 a121, v235
    v_accvgpr_read_b32 v236, a122
    v_mul_f32 v236, v236, v232
    v_accvgpr_write_b32 a122, v236
    v_accvgpr_read_b32 v237, a123
    v_mul_f32 v237, v237, v232
    v_accvgpr_write_b32 a123, v237
    v_accvgpr_read_b32 v234, a124
    v_mul_f32 v234, v234, v232
    v_accvgpr_write_b32 a124, v234
    v_accvgpr_read_b32 v235, a125
    v_mul_f32 v235, v235, v232
    v_accvgpr_write_b32 a125, v235
    v_accvgpr_read_b32 v236, a126
    v_mul_f32 v236, v236, v232
    v_accvgpr_write_b32 a126, v236
    v_accvgpr_read_b32 v237, a127
    v_mul_f32 v237, v237, v232
    v_accvgpr_write_b32 a127, v237
    v_exp_f32 v138, v16
    v_exp_f32 v139, v17
    v_exp_f32 v130, v18
    v_exp_f32 v131, v19
    v_cvt_pk_bf16_f32 v104, v138, v139
    v_exp_f32 v132, v20
    v_exp_f32 v133, v21
    v_cvt_pk_bf16_f32 v105, v130, v131
    v_add_f32 v138, v138, v130
    v_add_f32 v139, v139, v131
    v_exp_f32 v134, v22
    v_exp_f32 v135, v23
    v_cvt_pk_bf16_f32 v106, v132, v133
    v_add_f32 v138, v138, v132
    v_add_f32 v139, v139, v133
    v_exp_f32 v128, v24
    v_exp_f32 v129, v25
    v_cvt_pk_bf16_f32 v107, v134, v135
    v_add_f32 v138, v138, v134
    v_add_f32 v139, v139, v135
    v_exp_f32 v130, v26
    v_exp_f32 v131, v27
    v_cvt_pk_bf16_f32 v108, v128, v129
    v_add_f32 v138, v138, v128
    v_add_f32 v139, v139, v129
    v_exp_f32 v132, v28
    v_exp_f32 v133, v29
    v_cvt_pk_bf16_f32 v109, v130, v131
    v_add_f32 v138, v138, v130
    v_add_f32 v139, v139, v131
    v_exp_f32 v134, v30
    v_exp_f32 v135, v31
    v_cvt_pk_bf16_f32 v110, v132, v133
    v_add_f32 v138, v138, v132
    v_add_f32 v139, v139, v133
    v_cvt_pk_bf16_f32 v111, v134, v135
    v_add_f32 v138, v138, v134
    v_add_f32 v139, v139, v135
    v_add_f32 v225, v138, v139
    s_nop 1
    s_branch ka_rr27
ka_fix29:
    s_cmp_eq_u32 s36, 0
    s_cselect_b32 s24, 0, 0x74000000
    v_subrev_f32 v230, s24, v243
    v_add_f32 v231, 0, v230
    v_min_f32 v80, v229, v231
    v_add_f32 v232, 0xf1800000, v230
    v_min_f32 v81, v229, v232
    v_add_f32 v231, 0xf2000000, v230
    v_min_f32 v82, v229, v231
    v_add_f32 v232, 0xf2400000, v230
    v_min_f32 v83, v229, v232
    v_add_f32 v231, 0xf3000000, v230
    v_min_f32 v84, v229, v231
    v_add_f32 v232, 0xf3100000, v230
    v_min_f32 v85, v229, v232
    v_add_f32 v231, 0xf3200000, v230
    v_min_f32 v86, v229, v231
    v_add_f32 v232, 0xf3300000, v230
    v_min_f32 v87, v229, v232
    v_add_f32 v231, 0xf3800000, v230
    v_min_f32 v88, v229, v231
    v_add_f32 v232, 0xf3880000, v230
    v_min_f32 v89, v229, v232
    v_add_f32 v231, 0xf3900000, v230
    v_min_f32 v90, v229, v231
    v_add_f32 v232, 0xf3980000, v230
    v_min_f32 v91, v229, v232
    v_add_f32 v231, 0xf3c00000, v230
    v_min_f32 v92, v229, v231
    v_add_f32 v232, 0xf3c80000, v230
    v_min_f32 v93, v229, v232
    v_add_f32 v231, 0xf3d00000, v230
    v_min_f32 v94, v229, v231
    v_add_f32 v232, 0xf3d80000, v230
    v_min_f32 v95, v229, v232
    s_nop 1
    s_branch ka_fixr30
ka_rare32:
    s_nop 15
    v_max3_f32 v230, v48, v49, v50
    v_max3_f32 v230, v230, v51, v52
    v_max3_f32 v230, v230, v53, v54
    v_max3_f32 v230, v230, v55, v56
    v_max3_f32 v230, v230, v57, v58
    v_max3_f32 v230, v230, v59, v60
    v_max3_f32 v230, v230, v61, v62
    v_max_f32 v230, v230, v63
    v_mov_b32 v231, v230
    s_nop 1
    v_permlane32_swap_b32 v230, v231
    s_nop 0
    v_max_f32 v230, v230, v231
    v_max_f32 v230, 0, v230
    v_sub_f32 v232, 0, v230
    v_exp_f32 v232, v232
    v_sub_f32 v229, v229, v230
    v_sub_f32 v80, v80, v230
    v_sub_f32 v16, v16, v230
    v_sub_f32 v48, v48, v230
    v_sub_f32 v81, v81, v230
    v_sub_f32 v17, v17, v230
    v_sub_f32 v49, v49, v230
    v_sub_f32 v82, v82, v230
    v_sub_f32 v18, v18, v230
    v_sub_f32 v50, v50, v230
    v_sub_f32 v83, v83, v230
    v_sub_f32 v19, v19, v230
    v_sub_f32 v51, v51, v230
    v_sub_f32 v84, v84, v230
    v_sub_f32 v20, v20, v230
    v_sub_f32 v52, v52, v230
    v_sub_f32 v85, v85, v230
    v_sub_f32 v21, v21, v230
    v_sub_f32 v53, v53, v230
    v_sub_f32 v86, v86, v230
    v_sub_f32 v22, v22, v230
    v_sub_f32 v54, v54, v230
    v_sub_f32 v87, v87, v230
    v_sub_f32 v23, v23, v230
    v_sub_f32 v55, v55, v230
    v_sub_f32 v88, v88, v230
    v_sub_f32 v24, v24, v230
    v_sub_f32 v56, v56, v230
    v_sub_f32 v89, v89, v230
    v_sub_f32 v25, v25, v230
    v_sub_f32 v57, v57, v230
    v_sub_f32 v90, v90, v230
    v_sub_f32 v26, v26, v230
    v_sub_f32 v58, v58, v230
    v_sub_f32 v91, v91, v230
    v_sub_f32 v27, v27, v230
    v_sub_f32 v59, v59, v230
    v_sub_f32 v92, v92, v230
    v_sub_f32 v28, v28, v230
    v_sub_f32 v60, v60, v230
    v_sub_f32 v93, v93, v230
    v_sub_f32 v29, v29, v230
    v_sub_f32 v61, v61, v230
    v_sub_f32 v94, v94, v230
    v_sub_f32 v30, v30, v230
    v_sub_f32 v62, v62, v230
    v_sub_f32 v95, v95, v230
    v_sub_f32 v31, v31, v230
    v_sub_f32 v63, v63, v230
    v_mul_f32 v227, v227, v232
    v_accvgpr_read_b32 v234, a64
    v_mul_f32 v234, v234, v232
    v_accvgpr_write_b32 a64, v234
    v_accvgpr_read_b32 v235, a65
    v_mul_f32 v235, v235, v232
    v_accvgpr_write_b32 a65, v235
    v_accvgpr_read_b32 v236, a66
    v_mul_f32 v236, v236, v232
    v_accvgpr_write_b32 a66, v236
    v_accvgpr_read_b32 v237, a67
    v_mul_f32 v237, v237, v232
    v_accvgpr_write_b32 a67, v237
    v_accvgpr_read_b32 v234, a68
    v_mul_f32 v234, v234, v232
    v_accvgpr_write_b32 a68, v234
    v_accvgpr_read_b32 v235, a69
    v_mul_f32 v235, v235, v232
    v_accvgpr_write_b32 a69, v235
    v_accvgpr_read_b32 v236, a70
    v_mul_f32 v236, v236, v232
    v_accvgpr_write_b32 a70, v236
    v_accvgpr_read_b32 v237, a71
    v_mul_f32 v237, v237, v232
    v_accvgpr_write_b32 a71, v237
    v_accvgpr_read_b32 v234, a72
    v_mul_f32 v234, v234, v232
    v_accvgpr_write_b32 a72, v234
    v_accvgpr_read_b32 v235, a73
    v_mul_f32 v235, v235, v232
    v_accvgpr_write_b32 a73, v235
    v_accvgpr_read_b32 v236, a74
    v_mul_f32 v236, v236, v232
    v_accvgpr_write_b32 a74, v236
    v_accvgpr_read_b32 v237, a75
    v_mul_f32 v237, v237, v232
    v_accvgpr_write_b32 a75, v237
    v_accvgpr_read_b32 v234, a76
    v_mul_f32 v234, v234, v232
    v_accvgpr_write_b32 a76, v234
    v_accvgpr_read_b32 v235, a77
    v_mul_f32 v235, v235, v232
    v_accvgpr_write_b32 a77, v235
    v_accvgpr_read_b32 v236, a78
    v_mul_f32 v236, v236, v232
    v_accvgpr_write_b32 a78, v236
    v_accvgpr_read_b32 v237, a79
    v_mul_f32 v237, v237, v232
    v_accvgpr_write_b32 a79, v237
    v_accvgpr_read_b32 v234, a80
    v_mul_f32 v234, v234, v232
    v_accvgpr_write_b32 a80, v234
    v_accvgpr_read_b32 v235, a81
    v_mul_f32 v235, v235, v232
    v_accvgpr_write_b32 a81, v235
    v_accvgpr_read_b32 v236, a82
    v_mul_f32 v236, v236, v232
    v_accvgpr_write_b32 a82, v236
    v_accvgpr_read_b32 v237, a83
    v_mul_f32 v237, v237, v232
    v_accvgpr_write_b32 a83, v237
    v_accvgpr_read_b32 v234, a84
    v_mul_f32 v234, v234, v232
    v_accvgpr_write_b32 a84, v234
    v_accvgpr_read_b32 v235, a85
    v_mul_f32 v235, v235, v232
    v_accvgpr_write_b32 a85, v235
    v_accvgpr_read_b32 v236, a86
    v_mul_f32 v236, v236, v232
    v_accvgpr_write_b32 a86, v236
    v_accvgpr_read_b32 v237, a87
    v_mul_f32 v237, v237, v232
    v_accvgpr_write_b32 a87, v237
    v_accvgpr_read_b32 v234, a88
    v_mul_f32 v234, v234, v232
    v_accvgpr_write_b32 a88, v234
    v_accvgpr_read_b32 v235, a89
    v_mul_f32 v235, v235, v232
    v_accvgpr_write_b32 a89, v235
    v_accvgpr_read_b32 v236, a90
    v_mul_f32 v236, v236, v232
    v_accvgpr_write_b32 a90, v236
    v_accvgpr_read_b32 v237, a91
    v_mul_f32 v237, v237, v232
    v_accvgpr_write_b32 a91, v237
    v_accvgpr_read_b32 v234, a92
    v_mul_f32 v234, v234, v232
    v_accvgpr_write_b32 a92, v234
    v_accvgpr_read_b32 v235, a93
    v_mul_f32 v235, v235, v232
    v_accvgpr_write_b32 a93, v235
    v_accvgpr_read_b32 v236, a94
    v_mul_f32 v236, v236, v232
    v_accvgpr_write_b32 a94, v236
    v_accvgpr_read_b32 v237, a95
    v_mul_f32 v237, v237, v232
    v_accvgpr_write_b32 a95, v237
    v_accvgpr_read_b32 v234, a96
    v_mul_f32 v234, v234, v232
    v_accvgpr_write_b32 a96, v234
    v_accvgpr_read_b32 v235, a97
    v_mul_f32 v235, v235, v232
    v_accvgpr_write_b32 a97, v235
    v_accvgpr_read_b32 v236, a98
    v_mul_f32 v236, v236, v232
    v_accvgpr_write_b32 a98, v236
    v_accvgpr_read_b32 v237, a99
    v_mul_f32 v237, v237, v232
    v_accvgpr_write_b32 a99, v237
    v_accvgpr_read_b32 v234, a100
    v_mul_f32 v234, v234, v232
    v_accvgpr_write_b32 a100, v234
    v_accvgpr_read_b32 v235, a101
    v_mul_f32 v235, v235, v232
    v_accvgpr_write_b32 a101, v235
    v_accvgpr_read_b32 v236, a102
    v_mul_f32 v236, v236, v232
    v_accvgpr_write_b32 a102, v236
    v_accvgpr_read_b32 v237, a103
    v_mul_f32 v237, v237, v232
    v_accvgpr_write_b32 a103, v237
    v_accvgpr_read_b32 v234, a104
    v_mul_f32 v234, v234, v232
    v_accvgpr_write_b32 a104, v234
    v_accvgpr_read_b32 v235, a105
    v_mul_f32 v235, v235, v232
    v_accvgpr_write_b32 a105, v235
    v_accvgpr_read_b32 v236, a106
    v_mul_f32 v236, v236, v232
    v_accvgpr_write_b32 a106, v236
    v_accvgpr_read_b32 v237, a107
    v_mul_f32 v237, v237, v232
    v_accvgpr_write_b32 a107, v237
    v_accvgpr_read_b32 v234, a108
    v_mul_f32 v234, v234, v232
    v_accvgpr_write_b32 a108, v234
    v_accvgpr_read_b32 v235, a109
    v_mul_f32 v235, v235, v232
    v_accvgpr_write_b32 a109, v235
    v_accvgpr_read_b32 v236, a110
    v_mul_f32 v236, v236, v232
    v_accvgpr_write_b32 a110, v236
    v_accvgpr_read_b32 v237, a111
    v_mul_f32 v237, v237, v232
    v_accvgpr_write_b32 a111, v237
    v_accvgpr_read_b32 v234, a112
    v_mul_f32 v234, v234, v232
    v_accvgpr_write_b32 a112, v234
    v_accvgpr_read_b32 v235, a113
    v_mul_f32 v235, v235, v232
    v_accvgpr_write_b32 a113, v235
    v_accvgpr_read_b32 v236, a114
    v_mul_f32 v236, v236, v232
    v_accvgpr_write_b32 a114, v236
    v_accvgpr_read_b32 v237, a115
    v_mul_f32 v237, v237, v232
    v_accvgpr_write_b32 a115, v237
    v_accvgpr_read_b32 v234, a116
    v_mul_f32 v234, v234, v232
    v_accvgpr_write_b32 a116, v234
    v_accvgpr_read_b32 v235, a117
    v_mul_f32 v235, v235, v232
    v_accvgpr_write_b32 a117, v235
    v_accvgpr_read_b32 v236, a118
    v_mul_f32 v236, v236, v232
    v_accvgpr_write_b32 a118, v236
    v_accvgpr_read_b32 v237, a119
    v_mul_f32 v237, v237, v232
    v_accvgpr_write_b32 a119, v237
    v_accvgpr_read_b32 v234, a120
    v_mul_f32 v234, v234, v232
    v_accvgpr_write_b32 a120, v234
    v_accvgpr_read_b32 v235, a121
    v_mul_f32 v235, v235, v232
    v_accvgpr_write_b32 a121, v235
    v_accvgpr_read_b32 v236, a122
    v_mul_f32 v236, v236, v232
    v_accvgpr_write_b32 a122, v236
    v_accvgpr_read_b32 v237, a123
    v_mul_f32 v237, v237, v232
    v_accvgpr_write_b32 a123, v237
    v_accvgpr_read_b32 v234, a124
    v_mul_f32 v234, v234, v232
    v_accvgpr_write_b32 a124, v234
    v_accvgpr_read_b32 v235, a125
    v_mul_f32 v235, v235, v232
    v_accvgpr_write_b32 a125, v235
    v_accvgpr_read_b32 v236, a126
    v_mul_f32 v236, v236, v232
    v_accvgpr_write_b32 a126, v236
    v_accvgpr_read_b32 v237, a127
    v_mul_f32 v237, v237, v232
    v_accvgpr_write_b32 a127, v237
    v_exp_f32 v138, v48
    v_exp_f32 v139, v49
    v_exp_f32 v130, v50
    v_exp_f32 v131, v51
    v_cvt_pk_bf16_f32 v120, v138, v139
    v_exp_f32 v132, v52
    v_exp_f32 v133, v53
    v_cvt_pk_bf16_f32 v121, v130, v131
    v_add_f32 v138, v138, v130
    v_add_f32 v139, v139, v131
    v_exp_f32 v134, v54
    v_exp_f32 v135, v55
    v_cvt_pk_bf16_f32 v122, v132, v133
    v_add_f32 v138, v138, v132
    v_add_f32 v139, v139, v133
    v_exp_f32 v128, v56
    v_exp_f32 v129, v57
    v_cvt_pk_bf16_f32 v123, v134, v135
    v_add_f32 v138, v138, v134
    v_add_f32 v139, v139, v135
    v_exp_f32 v130, v58
    v_exp_f32 v131, v59
    v_cvt_pk_bf16_f32 v124, v128, v129
    v_add_f32 v138, v138, v128
    v_add_f32 v139, v139, v129
    v_exp_f32 v132, v60
    v_exp_f32 v133, v61
    v_cvt_pk_bf16_f32 v125, v130, v131
    v_add_f32 v138, v138, v130
    v_add_f32 v139, v139, v131
    v_exp_f32 v134, v62
    v_exp_f32 v135, v63
    v_cvt_pk_bf16_f32 v126, v132, v133
    v_add_f32 v138, v138, v132
    v_add_f32 v139, v139, v133
    v_cvt_pk_bf16_f32 v127, v134, v135
    v_add_f32 v138, v138, v134
    v_add_f32 v139, v139, v135
    v_add_f32 v225, v138, v139
    s_nop 1
    s_branch ka_rr31
ka_l2p33:
    buffer_load_dword v252, v245, s[56:59], s28 offen
    s_add_u32 s28, s28, 4096
    s_branch ka_l2r34
ka_fix35:
    s_cmp_eq_u32 s36, 0
    s_cselect_b32 s24, 0, 0x74000000
    v_subrev_f32 v230, s24, v243
    v_add_f32 v231, 0, v230
    v_min_f32 v80, v229, v231
    v_add_f32 v232, 0xf1800000, v230
    v_min_f32 v81, v229, v232
    v_add_f32 v231, 0xf2000000, v230
    v_min_f32 v82, v229, v231
    v_add_f32 v232, 0xf2400000, v230
    v_min_f32 v83, v229, v232
    v_add_f32 v231, 0xf3000000, v230
    v_min_f32 v84, v229, v231
    v_add_f32 v232, 0xf3100000, v230
    v_min_f32 v85, v229, v232
    v_add_f32 v231, 0xf3200000, v230
    v_min_f32 v86, v229, v231
    v_add_f32 v232, 0xf3300000, v230
    v_min_f32 v87, v229, v232
    v_add_f32 v231, 0xf3800000, v230
    v_min_f32 v88, v229, v231
    v_add_f32 v232, 0xf3880000, v230
    v_min_f32 v89, v229, v232
    v_add_f32 v231, 0xf3900000, v230
    v_min_f32 v90, v229, v231
    v_add_f32 v232, 0xf3980000, v230
    v_min_f32 v91, v229, v232
    v_add_f32 v231, 0xf3c00000, v230
    v_min_f32 v92, v229, v231
    v_add_f32 v232, 0xf3c80000, v230
    v_min_f32 v93, v229, v232
    v_add_f32 v231, 0xf3d00000, v230
    v_min_f32 v94, v229, v231
    v_add_f32 v232, 0xf3d80000, v230
    v_min_f32 v95, v229, v232
    s_nop 1
    s_branch ka_fixr36
ka_rare38:
    s_nop 15
    v_max3_f32 v230, v16, v17, v18
    v_max3_f32 v230, v230, v19, v20
    v_max3_f32 v230, v230, v21, v22
    v_max3_f32 v230, v230, v23, v24
    v_max3_f32 v230, v230, v25, v26
    v_max3_f32 v230, v230, v27, v28
    v_max3_f32 v230, v230, v29, v30
    v_max_f32 v230, v230, v31
    v_mov_b32 v231, v230
    s_nop 1
    v_permlane32_swap_b32 v230, v231
    s_nop 0
    v_max_f32 v230, v230, v231
    v_max_f32 v230, 0, v230
    v_sub_f32 v232, 0, v230
    v_exp_f32 v232, v232
    v_sub_f32 v229, v229, v230
    v_sub_f32 v80, v80, v230
    v_sub_f32 v48, v48, v230
    v_sub_f32 v16, v16, v230
    v_sub_f32 v81, v81, v230
    v_sub_f32 v49, v49, v230
    v_sub_f32 v17, v17, v230
    v_sub_f32 v82, v82, v230
    v_sub_f32 v50, v50, v230
    v_sub_f32 v18, v18, v230
    v_sub_f32 v83, v83, v230
    v_sub_f32 v51, v51, v230
    v_sub_f32 v19, v19, v230
    v_sub_f32 v84, v84, v230
    v_sub_f32 v52, v52, v230
    v_sub_f32 v20, v20, v230
    v_sub_f32 v85, v85, v230
    v_sub_f32 v53, v53, v230
    v_sub_f32 v21, v21, v230
    v_sub_f32 v86, v86, v230
    v_sub_f32 v54, v54, v230
    v_sub_f32 v22, v22, v230
    v_sub_f32 v87, v87, v230
    v_sub_f32 v55, v55, v230
    v_sub_f32 v23, v23, v230
    v_sub_f32 v88, v88, v230
    v_sub_f32 v56, v56, v230
    v_sub_f32 v24, v24, v230
    v_sub_f32 v89, v89, v230
    v_sub_f32 v57, v57, v230
    v_sub_f32 v25, v25, v230
    v_sub_f32 v90, v90, v230
    v_sub_f32 v58, v58, v230
    v_sub_f32 v26, v26, v230
    v_sub_f32 v91, v91, v230
    v_sub_f32 v59, v59, v230
    v_sub_f32 v27, v27, v230
    v_sub_f32 v92, v92, v230
    v_sub_f32 v60, v60, v230
    v_sub_f32 v28, v28, v230
    v_sub_f32 v93, v93, v230
    v_sub_f32 v61, v61, v230
    v_sub_f32 v29, v29, v230
    v_sub_f32 v94, v94, v230
    v_sub_f32 v62, v62, v230
    v_sub_f32 v30, v30, v230
    v_sub_f32 v95, v95, v230
    v_sub_f32 v63, v63, v230
    v_sub_f32 v31, v31, v230
    v_mul_f32 v227, v227, v232
    v_accvgpr_read_b32 v234, a64
    v_mul_f32 v234, v234, v232
    v_accvgpr_write_b32 a64, v234
    v_accvgpr_read_b32 v235, a65
    v_mul_f32 v235, v235, v232
    v_accvgpr_write_b32 a65, v235
    v_accvgpr_read_b32 v236, a66
    v_mul_f32 v236, v236, v232
    v_accvgpr_write_b32 a66, v236
    v_accvgpr_read_b32 v237, a67
    v_mul_f32 v237, v237, v232
    v_accvgpr_write_b32 a67, v237
    v_accvgpr_read_b32 v234, a68
    v_mul_f32 v234, v234, v232
    v_accvgpr_write_b32 a68, v234
    v_accvgpr_read_b32 v235, a69
    v_mul_f32 v235, v235, v232
    v_accvgpr_write_b32 a69, v235
    v_accvgpr_read_b32 v236, a70
    v_mul_f32 v236, v236, v232
    v_accvgpr_write_b32 a70, v236
    v_accvgpr_read_b32 v237, a71
    v_mul_f32 v237, v237, v232
    v_accvgpr_write_b32 a71, v237
    v_accvgpr_read_b32 v234, a72
    v_mul_f32 v234, v234, v232
    v_accvgpr_write_b32 a72, v234
    v_accvgpr_read_b32 v235, a73
    v_mul_f32 v235, v235, v232
    v_accvgpr_write_b32 a73, v235
    v_accvgpr_read_b32 v236, a74
    v_mul_f32 v236, v236, v232
    v_accvgpr_write_b32 a74, v236
    v_accvgpr_read_b32 v237, a75
    v_mul_f32 v237, v237, v232
    v_accvgpr_write_b32 a75, v237
    v_accvgpr_read_b32 v234, a76
    v_mul_f32 v234, v234, v232
    v_accvgpr_write_b32 a76, v234
    v_accvgpr_read_b32 v235, a77
    v_mul_f32 v235, v235, v232
    v_accvgpr_write_b32 a77, v235
    v_accvgpr_read_b32 v236, a78
    v_mul_f32 v236, v236, v232
    v_accvgpr_write_b32 a78, v236
    v_accvgpr_read_b32 v237, a79
    v_mul_f32 v237, v237, v232
    v_accvgpr_write_b32 a79, v237
    v_accvgpr_read_b32 v234, a80
    v_mul_f32 v234, v234, v232
    v_accvgpr_write_b32 a80, v234
    v_accvgpr_read_b32 v235, a81
    v_mul_f32 v235, v235, v232
    v_accvgpr_write_b32 a81, v235
    v_accvgpr_read_b32 v236, a82
    v_mul_f32 v236, v236, v232
    v_accvgpr_write_b32 a82, v236
    v_accvgpr_read_b32 v237, a83
    v_mul_f32 v237, v237, v232
    v_accvgpr_write_b32 a83, v237
    v_accvgpr_read_b32 v234, a84
    v_mul_f32 v234, v234, v232
    v_accvgpr_write_b32 a84, v234
    v_accvgpr_read_b32 v235, a85
    v_mul_f32 v235, v235, v232
    v_accvgpr_write_b32 a85, v235
    v_accvgpr_read_b32 v236, a86
    v_mul_f32 v236, v236, v232
    v_accvgpr_write_b32 a86, v236
    v_accvgpr_read_b32 v237, a87
    v_mul_f32 v237, v237, v232
    v_accvgpr_write_b32 a87, v237
    v_accvgpr_read_b32 v234, a88
    v_mul_f32 v234, v234, v232
    v_accvgpr_write_b32 a88, v234
    v_accvgpr_read_b32 v235, a89
    v_mul_f32 v235, v235, v232
    v_accvgpr_write_b32 a89, v235
    v_accvgpr_read_b32 v236, a90
    v_mul_f32 v236, v236, v232
    v_accvgpr_write_b32 a90, v236
    v_accvgpr_read_b32 v237, a91
    v_mul_f32 v237, v237, v232
    v_accvgpr_write_b32 a91, v237
    v_accvgpr_read_b32 v234, a92
    v_mul_f32 v234, v234, v232
    v_accvgpr_write_b32 a92, v234
    v_accvgpr_read_b32 v235, a93
    v_mul_f32 v235, v235, v232
    v_accvgpr_write_b32 a93, v235
    v_accvgpr_read_b32 v236, a94
    v_mul_f32 v236, v236, v232
    v_accvgpr_write_b32 a94, v236
    v_accvgpr_read_b32 v237, a95
    v_mul_f32 v237, v237, v232
    v_accvgpr_write_b32 a95, v237
    v_accvgpr_read_b32 v234, a96
    v_mul_f32 v234, v234, v232
    v_accvgpr_write_b32 a96, v234
    v_accvgpr_read_b32 v235, a97
    v_mul_f32 v235, v235, v232
    v_accvgpr_write_b32 a97, v235
    v_accvgpr_read_b32 v236, a98
    v_mul_f32 v236, v236, v232
    v_accvgpr_write_b32 a98, v236
    v_accvgpr_read_b32 v237, a99
    v_mul_f32 v237, v237, v232
    v_accvgpr_write_b32 a99, v237
    v_accvgpr_read_b32 v234, a100
    v_mul_f32 v234, v234, v232
    v_accvgpr_write_b32 a100, v234
    v_accvgpr_read_b32 v235, a101
    v_mul_f32 v235, v235, v232
    v_accvgpr_write_b32 a101, v235
    v_accvgpr_read_b32 v236, a102
    v_mul_f32 v236, v236, v232
    v_accvgpr_write_b32 a102, v236
    v_accvgpr_read_b32 v237, a103
    v_mul_f32 v237, v237, v232
    v_accvgpr_write_b32 a103, v237
    v_accvgpr_read_b32 v234, a104
    v_mul_f32 v234, v234, v232
    v_accvgpr_write_b32 a104, v234
    v_accvgpr_read_b32 v235, a105
    v_mul_f32 v235, v235, v232
    v_accvgpr_write_b32 a105, v235
    v_accvgpr_read_b32 v236, a106
    v_mul_f32 v236, v236, v232
    v_accvgpr_write_b32 a106, v236
    v_accvgpr_read_b32 v237, a107
    v_mul_f32 v237, v237, v232
    v_accvgpr_write_b32 a107, v237
    v_accvgpr_read_b32 v234, a108
    v_mul_f32 v234, v234, v232
    v_accvgpr_write_b32 a108, v234
    v_accvgpr_read_b32 v235, a109
    v_mul_f32 v235, v235, v232
    v_accvgpr_write_b32 a109, v235
    v_accvgpr_read_b32 v236, a110
    v_mul_f32 v236, v236, v232
    v_accvgpr_write_b32 a110, v236
    v_accvgpr_read_b32 v237, a111
    v_mul_f32 v237, v237, v232
    v_accvgpr_write_b32 a111, v237
    v_accvgpr_read_b32 v234, a112
    v_mul_f32 v234, v234, v232
    v_accvgpr_write_b32 a112, v234
    v_accvgpr_read_b32 v235, a113
    v_mul_f32 v235, v235, v232
    v_accvgpr_write_b32 a113, v235
    v_accvgpr_read_b32 v236, a114
    v_mul_f32 v236, v236, v232
    v_accvgpr_write_b32 a114, v236
    v_accvgpr_read_b32 v237, a115
    v_mul_f32 v237, v237, v232
    v_accvgpr_write_b32 a115, v237
    v_accvgpr_read_b32 v234, a116
    v_mul_f32 v234, v234, v232
    v_accvgpr_write_b32 a116, v234
    v_accvgpr_read_b32 v235, a117
    v_mul_f32 v235, v235, v232
    v_accvgpr_write_b32 a117, v235
    v_accvgpr_read_b32 v236, a118
    v_mul_f32 v236, v236, v232
    v_accvgpr_write_b32 a118, v236
    v_accvgpr_read_b32 v237, a119
    v_mul_f32 v237, v237, v232
    v_accvgpr_write_b32 a119, v237
    v_accvgpr_read_b32 v234, a120
    v_mul_f32 v234, v234, v232
    v_accvgpr_write_b32 a120, v234
    v_accvgpr_read_b32 v235, a121
    v_mul_f32 v235, v235, v232
    v_accvgpr_write_b32 a121, v235
    v_accvgpr_read_b32 v236, a122
    v_mul_f32 v236, v236, v232
    v_accvgpr_write_b32 a122, v236
    v_accvgpr_read_b32 v237, a123
    v_mul_f32 v237, v237, v232
    v_accvgpr_write_b32 a123, v237
    v_accvgpr_read_b32 v234, a124
    v_mul_f32 v234, v234, v232
    v_accvgpr_write_b32 a124, v234
    v_accvgpr_read_b32 v235, a125
    v_mul_f32 v235, v235, v232
    v_accvgpr_write_b32 a125, v235
    v_accvgpr_read_b32 v236, a126
    v_mul_f32 v236, v236, v232
    v_accvgpr_write_b32 a126, v236
    v_accvgpr_read_b32 v237, a127
    v_mul_f32 v237, v237, v232
    v_accvgpr_write_b32 a127, v237
    v_exp_f32 v138, v16
    v_exp_f32 v139, v17
    v_exp_f32 v130, v18
    v_exp_f32 v131, v19
    v_cvt_pk_bf16_f32 v104, v138, v139
    v_exp_f32 v132, v20
    v_exp_f32 v133, v21
    v_cvt_pk_bf16_f32 v105, v130, v131
    v_add_f32 v138, v138, v130
    v_add_f32 v139, v139, v131
    v_exp_f32 v134, v22
    v_exp_f32 v135, v23
    v_cvt_pk_bf16_f32 v106, v132, v133
    v_add_f32 v138, v138, v132
    v_add_f32 v139, v139, v133
    v_exp_f32 v128, v24
    v_exp_f32 v129, v25
    v_cvt_pk_bf16_f32 v107, v134, v135
    v_add_f32 v138, v138, v134
    v_add_f32 v139, v139, v135
    v_exp_f32 v130, v26
    v_exp_f32 v131, v27
    v_cvt_pk_bf16_f32 v108, v128, v129
    v_add_f32 v138, v138, v128
    v_add_f32 v139, v139, v129
    v_exp_f32 v132, v28
    v_exp_f32 v133, v29
    v_cvt_pk_bf16_f32 v109, v130, v131
    v_add_f32 v138, v138, v130
    v_add_f32 v139, v139, v131
    v_exp_f32 v134, v30
    v_exp_f32 v135, v31
    v_cvt_pk_bf16_f32 v110, v132, v133
    v_add_f32 v138, v138, v132
    v_add_f32 v139, v139, v133
    v_cvt_pk_bf16_f32 v111, v134, v135
    v_add_f32 v138, v138, v134
    v_add_f32 v139, v139, v135
    v_add_f32 v225, v138, v139
    s_nop 1
    s_branch ka_rr37
ka_rare40:
    s_nop 15
    v_max3_f32 v230, v48, v49, v50
    v_max3_f32 v230, v230, v51, v52
    v_max3_f32 v230, v230, v53, v54
    v_max3_f32 v230, v230, v55, v56
    v_max3_f32 v230, v230, v57, v58
    v_max3_f32 v230, v230, v59, v60
    v_max3_f32 v230, v230, v61, v62
    v_max_f32 v230, v230, v63
    v_mov_b32 v231, v230
    s_nop 1
    v_permlane32_swap_b32 v230, v231
    s_nop 0
    v_max_f32 v230, v230, v231
    v_max_f32 v230, 0, v230
    v_sub_f32 v232, 0, v230
    v_exp_f32 v232, v232
    v_sub_f32 v229, v229, v230
    v_sub_f32 v80, v80, v230
    v_sub_f32 v16, v16, v230
    v_sub_f32 v48, v48, v230
    v_sub_f32 v81, v81, v230
    v_sub_f32 v17, v17, v230
    v_sub_f32 v49, v49, v230
    v_sub_f32 v82, v82, v230
    v_sub_f32 v18, v18, v230
    v_sub_f32 v50, v50, v230
    v_sub_f32 v83, v83, v230
    v_sub_f32 v19, v19, v230
    v_sub_f32 v51, v51, v230
    v_sub_f32 v84, v84, v230
    v_sub_f32 v20, v20, v230
    v_sub_f32 v52, v52, v230
    v_sub_f32 v85, v85, v230
    v_sub_f32 v21, v21, v230
    v_sub_f32 v53, v53, v230
    v_sub_f32 v86, v86, v230
    v_sub_f32 v22, v22, v230
    v_sub_f32 v54, v54, v230
    v_sub_f32 v87, v87, v230
    v_sub_f32 v23, v23, v230
    v_sub_f32 v55, v55, v230
    v_sub_f32 v88, v88, v230
    v_sub_f32 v24, v24, v230
    v_sub_f32 v56, v56, v230
    v_sub_f32 v89, v89, v230
    v_sub_f32 v25, v25, v230
    v_sub_f32 v57, v57, v230
    v_sub_f32 v90, v90, v230
    v_sub_f32 v26, v26, v230
    v_sub_f32 v58, v58, v230
    v_sub_f32 v91, v91, v230
    v_sub_f32 v27, v27, v230
    v_sub_f32 v59, v59, v230
    v_sub_f32 v92, v92, v230
    v_sub_f32 v28, v28, v230
    v_sub_f32 v60, v60, v230
    v_sub_f32 v93, v93, v230
    v_sub_f32 v29, v29, v230
    v_sub_f32 v61, v61, v230
    v_sub_f32 v94, v94, v230
    v_sub_f32 v30, v30, v230
    v_sub_f32 v62, v62, v230
    v_sub_f32 v95, v95, v230
    v_sub_f32 v31, v31, v230
    v_sub_f32 v63, v63, v230
    v_mul_f32 v227, v227, v232
    v_accvgpr_read_b32 v234, a64
    v_mul_f32 v234, v234, v232
    v_accvgpr_write_b32 a64, v234
    v_accvgpr_read_b32 v235, a65
    v_mul_f32 v235, v235, v232
    v_accvgpr_write_b32 a65, v235
    v_accvgpr_read_b32 v236, a66
    v_mul_f32 v236, v236, v232
    v_accvgpr_write_b32 a66, v236
    v_accvgpr_read_b32 v237, a67
    v_mul_f32 v237, v237, v232
    v_accvgpr_write_b32 a67, v237
    v_accvgpr_read_b32 v234, a68
    v_mul_f32 v234, v234, v232
    v_accvgpr_write_b32 a68, v234
    v_accvgpr_read_b32 v235, a69
    v_mul_f32 v235, v235, v232
    v_accvgpr_write_b32 a69, v235
    v_accvgpr_read_b32 v236, a70
    v_mul_f32 v236, v236, v232
    v_accvgpr_write_b32 a70, v236
    v_accvgpr_read_b32 v237, a71
    v_mul_f32 v237, v237, v232
    v_accvgpr_write_b32 a71, v237
    v_accvgpr_read_b32 v234, a72
    v_mul_f32 v234, v234, v232
    v_accvgpr_write_b32 a72, v234
    v_accvgpr_read_b32 v235, a73
    v_mul_f32 v235, v235, v232
    v_accvgpr_write_b32 a73, v235
    v_accvgpr_read_b32 v236, a74
    v_mul_f32 v236, v236, v232
    v_accvgpr_write_b32 a74, v236
    v_accvgpr_read_b32 v237, a75
    v_mul_f32 v237, v237, v232
    v_accvgpr_write_b32 a75, v237
    v_accvgpr_read_b32 v234, a76
    v_mul_f32 v234, v234, v232
    v_accvgpr_write_b32 a76, v234
    v_accvgpr_read_b32 v235, a77
    v_mul_f32 v235, v235, v232
    v_accvgpr_write_b32 a77, v235
    v_accvgpr_read_b32 v236, a78
    v_mul_f32 v236, v236, v232
    v_accvgpr_write_b32 a78, v236
    v_accvgpr_read_b32 v237, a79
    v_mul_f32 v237, v237, v232
    v_accvgpr_write_b32 a79, v237
    v_accvgpr_read_b32 v234, a80
    v_mul_f32 v234, v234, v232
    v_accvgpr_write_b32 a80, v234
    v_accvgpr_read_b32 v235, a81
    v_mul_f32 v235, v235, v232
    v_accvgpr_write_b32 a81, v235
    v_accvgpr_read_b32 v236, a82
    v_mul_f32 v236, v236, v232
    v_accvgpr_write_b32 a82, v236
    v_accvgpr_read_b32 v237, a83
    v_mul_f32 v237, v237, v232
    v_accvgpr_write_b32 a83, v237
    v_accvgpr_read_b32 v234, a84
    v_mul_f32 v234, v234, v232
    v_accvgpr_write_b32 a84, v234
    v_accvgpr_read_b32 v235, a85
    v_mul_f32 v235, v235, v232
    v_accvgpr_write_b32 a85, v235
    v_accvgpr_read_b32 v236, a86
    v_mul_f32 v236, v236, v232
    v_accvgpr_write_b32 a86, v236
    v_accvgpr_read_b32 v237, a87
    v_mul_f32 v237, v237, v232
    v_accvgpr_write_b32 a87, v237
    v_accvgpr_read_b32 v234, a88
    v_mul_f32 v234, v234, v232
    v_accvgpr_write_b32 a88, v234
    v_accvgpr_read_b32 v235, a89
    v_mul_f32 v235, v235, v232
    v_accvgpr_write_b32 a89, v235
    v_accvgpr_read_b32 v236, a90
    v_mul_f32 v236, v236, v232
    v_accvgpr_write_b32 a90, v236
    v_accvgpr_read_b32 v237, a91
    v_mul_f32 v237, v237, v232
    v_accvgpr_write_b32 a91, v237
    v_accvgpr_read_b32 v234, a92
    v_mul_f32 v234, v234, v232
    v_accvgpr_write_b32 a92, v234
    v_accvgpr_read_b32 v235, a93
    v_mul_f32 v235, v235, v232
    v_accvgpr_write_b32 a93, v235
    v_accvgpr_read_b32 v236, a94
    v_mul_f32 v236, v236, v232
    v_accvgpr_write_b32 a94, v236
    v_accvgpr_read_b32 v237, a95
    v_mul_f32 v237, v237, v232
    v_accvgpr_write_b32 a95, v237
    v_accvgpr_read_b32 v234, a96
    v_mul_f32 v234, v234, v232
    v_accvgpr_write_b32 a96, v234
    v_accvgpr_read_b32 v235, a97
    v_mul_f32 v235, v235, v232
    v_accvgpr_write_b32 a97, v235
    v_accvgpr_read_b32 v236, a98
    v_mul_f32 v236, v236, v232
    v_accvgpr_write_b32 a98, v236
    v_accvgpr_read_b32 v237, a99
    v_mul_f32 v237, v237, v232
    v_accvgpr_write_b32 a99, v237
    v_accvgpr_read_b32 v234, a100
    v_mul_f32 v234, v234, v232
    v_accvgpr_write_b32 a100, v234
    v_accvgpr_read_b32 v235, a101
    v_mul_f32 v235, v235, v232
    v_accvgpr_write_b32 a101, v235
    v_accvgpr_read_b32 v236, a102
    v_mul_f32 v236, v236, v232
    v_accvgpr_write_b32 a102, v236
    v_accvgpr_read_b32 v237, a103
    v_mul_f32 v237, v237, v232
    v_accvgpr_write_b32 a103, v237
    v_accvgpr_read_b32 v234, a104
    v_mul_f32 v234, v234, v232
    v_accvgpr_write_b32 a104, v234
    v_accvgpr_read_b32 v235, a105
    v_mul_f32 v235, v235, v232
    v_accvgpr_write_b32 a105, v235
    v_accvgpr_read_b32 v236, a106
    v_mul_f32 v236, v236, v232
    v_accvgpr_write_b32 a106, v236
    v_accvgpr_read_b32 v237, a107
    v_mul_f32 v237, v237, v232
    v_accvgpr_write_b32 a107, v237
    v_accvgpr_read_b32 v234, a108
    v_mul_f32 v234, v234, v232
    v_accvgpr_write_b32 a108, v234
    v_accvgpr_read_b32 v235, a109
    v_mul_f32 v235, v235, v232
    v_accvgpr_write_b32 a109, v235
    v_accvgpr_read_b32 v236, a110
    v_mul_f32 v236, v236, v232
    v_accvgpr_write_b32 a110, v236
    v_accvgpr_read_b32 v237, a111
    v_mul_f32 v237, v237, v232
    v_accvgpr_write_b32 a111, v237
    v_accvgpr_read_b32 v234, a112
    v_mul_f32 v234, v234, v232
    v_accvgpr_write_b32 a112, v234
    v_accvgpr_read_b32 v235, a113
    v_mul_f32 v235, v235, v232
    v_accvgpr_write_b32 a113, v235
    v_accvgpr_read_b32 v236, a114
    v_mul_f32 v236, v236, v232
    v_accvgpr_write_b32 a114, v236
    v_accvgpr_read_b32 v237, a115
    v_mul_f32 v237, v237, v232
    v_accvgpr_write_b32 a115, v237
    v_accvgpr_read_b32 v234, a116
    v_mul_f32 v234, v234, v232
    v_accvgpr_write_b32 a116, v234
    v_accvgpr_read_b32 v235, a117
    v_mul_f32 v235, v235, v232
    v_accvgpr_write_b32 a117, v235
    v_accvgpr_read_b32 v236, a118
    v_mul_f32 v236, v236, v232
    v_accvgpr_write_b32 a118, v236
    v_accvgpr_read_b32 v237, a119
    v_mul_f32 v237, v237, v232
    v_accvgpr_write_b32 a119, v237
    v_accvgpr_read_b32 v234, a120
    v_mul_f32 v234, v234, v232
    v_accvgpr_write_b32 a120, v234
    v_accvgpr_read_b32 v235, a121
    v_mul_f32 v235, v235, v232
    v_accvgpr_write_b32 a121, v235
    v_accvgpr_read_b32 v236, a122
    v_mul_f32 v236, v236, v232
    v_accvgpr_write_b32 a122, v236
    v_accvgpr_read_b32 v237, a123
    v_mul_f32 v237, v237, v232
    v_accvgpr_write_b32 a123, v237
    v_accvgpr_read_b32 v234, a124
    v_mul_f32 v234, v234, v232
    v_accvgpr_write_b32 a124, v234
    v_accvgpr_read_b32 v235, a125
    v_mul_f32 v235, v235, v232
    v_accvgpr_write_b32 a125, v235
    v_accvgpr_read_b32 v236, a126
    v_mul_f32 v236, v236, v232
    v_accvgpr_write_b32 a126, v236
    v_accvgpr_read_b32 v237, a127
    v_mul_f32 v237, v237, v232
    v_accvgpr_write_b32 a127, v237
    v_exp_f32 v138, v48
    v_exp_f32 v139, v49
    v_exp_f32 v130, v50
    v_exp_f32 v131, v51
    v_cvt_pk_bf16_f32 v120, v138, v139
    v_exp_f32 v132, v52
    v_exp_f32 v133, v53
    v_cvt_pk_bf16_f32 v121, v130, v131
    v_add_f32 v138, v138, v130
    v_add_f32 v139, v139, v131
    v_exp_f32 v134, v54
    v_exp_f32 v135, v55
    v_cvt_pk_bf16_f32 v122, v132, v133
    v_add_f32 v138, v138, v132
    v_add_f32 v139, v139, v133
    v_exp_f32 v128, v56
    v_exp_f32 v129, v57
    v_cvt_pk_bf16_f32 v123, v134, v135
    v_add_f32 v138, v138, v134
    v_add_f32 v139, v139, v135
    v_exp_f32 v130, v58
    v_exp_f32 v131, v59
    v_cvt_pk_bf16_f32 v124, v128, v129
    v_add_f32 v138, v138, v128
    v_add_f32 v139, v139, v129
    v_exp_f32 v132, v60
    v_exp_f32 v133, v61
    v_cvt_pk_bf16_f32 v125, v130, v131
    v_add_f32 v138, v138, v130
    v_add_f32 v139, v139, v131
    v_exp_f32 v134, v62
    v_exp_f32 v135, v63
    v_cvt_pk_bf16_f32 v126, v132, v133
    v_add_f32 v138, v138, v132
    v_add_f32 v139, v139, v133
    v_cvt_pk_bf16_f32 v127, v134, v135
    v_add_f32 v138, v138, v134
    v_add_f32 v139, v139, v135
    v_add_f32 v225, v138, v139
    s_nop 1
    s_branch ka_rr39
ka_spin41:
    s_mov_b32 s25, 0x400000
ka_spin41_l:
    s_sleep 2
    buffer_load_dword v254, off, s[88:91], s39 sc1
    s_waitcnt vmcnt(0)
    v_readfirstlane_b32 s24, v254
    s_sub_u32 s25, s25, 1
    s_cbranch_scc1 ka_spinr42
    s_cmp_ge_u32 s24, 32
    s_cbranch_scc0 ka_spin41_l
    s_branch ka_spinr42
ka_spin43:
    s_mov_b32 s25, 0x400000
ka_spin43_l:
    s_sleep 2
    buffer_load_dword v254, off, s[88:91], s39 sc1
    s_waitcnt vmcnt(0)
    v_readfirstlane_b32 s24, v254
    s_sub_u32 s25, s25, 1
    s_cbranch_scc1 ka_spinr44
    s_cmp_ge_u32 s24, 32
    s_cbranch_scc0 ka_spin43_l
    s_branch ka_spinr44
ka_spin45:
    s_mov_b32 s25, 0x400000
ka_spin45_l:
    s_sleep 2
    buffer_load_dword v254, off, s[88:91], s35 sc1
    s_waitcnt vmcnt(0)
    v_readfirstlane_b32 s24, v254
    s_sub_u32 s25, s25, 1
    s_cbranch_scc1 ka_spinr46
    s_cmp_ge_u32 s24, 8
    s_cbranch_scc0 ka_spin45_l
    s_branch ka_spinr46

.globl kb_kernel
.p2align 8
.type kb_kernel,@function
kb_kernel:
    s_cmp_ge_u32 s2, 256
    s_cbranch_scc1 kb_done
    s_load_dwordx2 s[40:41], s[0:1], 0
    s_load_dwordx2 s[42:43], s[0:1], 40
    s_load_dwordx2 s[44:45], s[0:1], 56
    s_load_dwordx2 s[46:47], s[0:1], 104
    s_load_dwordx2 s[52:53], s[0:1], 80
    v_lshrrev_b32 v1, 6, v0
    v_and_b32 v237, 63, v0
    v_readfirstlane_b32 s3, v1
    v_mov_b32 v230, v0
    s_lshr_b32 s32, s2, 3
    s_lshr_b32 s6, s2, 2
    s_and_b32 s6, s6, 1
    s_and_b32 s4, s2, 2
    s_lshl_b32 s4, s4, 2
    s_and_b32 s33, s32, 7
    s_add_u32 s4, s4, s33
    s_and_b32 s5, s2, 1
    s_lshl_b32 s5, s5, 2
    s_lshr_b32 s33, s32, 3
    s_add_u32 s5, s5, s33
    v_lshlrev_b32 v228, 4, v237
    v_lshrrev_b32 v234, 4, v237
    v_and_b32 v235, 15, v237
    v_lshlrev_b32 v236, 1, v234
    v_xor_b32 v235, v235, v236
    v_lshlrev_b32 v234, 11, v234
    s_lshl_b32 s32, s3, 14
    s_lshl_b32 s33, s5, 8
    s_add_u32 s32, s32, s33
    v_add_u32 v234, s32, v234
    v_lshl_add_u32 v224, v235, 4, v234
    v_xor_b32 v235, 8, v235
    v_lshl_add_u32 v225, v235, 4, v234
    v_add_u32 v225, 7168, v225
    s_lshl_b32 s37, s6, 22
    s_lshl_b32 s38, s3, 11
    s_lshl_b32 s32, s3, 18
    v_add_u32 v226, s32, v228
    v_add_u32 v227, 0x20000, v226
    s_lshl_b32 s35, s4, 20
    s_lshl_b32 s32, s6, 16
    s_add_u32 s35, s35, s32
    s_add_u32 s36, s35, 4096
    s_getpc_b64 s[56:57]
kb_pc0:
    s_mov_b32 s58, k4_kernel-kb_pc0
    s_mov_b32 s59, 0x00020000
    v_lshlrev_b32 v234, 7, v230
    buffer_load_dword v239, v234, s[56:59], 0 offen
    s_waitcnt lgkmcnt(0)
    s_add_u32 s8, s46, 0x2400000
    s_addc_u32 s9, s47, 0
    s_mov_b32 s10, 0x1000000
    s_mov_b32 s11, 0x00020000
    s_mov_b32 s12, s42
    s_mov_b32 s13, s43
    s_mov_b32 s14, 0x800000
    s_mov_b32 s15, 0x00020000
    s_mov_b32 s55, 0
    s_mov_b32 s48, 0
    s_mov_b32 s50, 0
    s_mov_b32 s51, s35
    s_add_u32 s35, s51, s50
    s_add_u32 s50, s50, 4096
    s_add_u32 s36, s51, s50
    s_add_u32 s50, s50, 4096
    s_add_u32 s49, s37, s48
    s_add_u32 s48, s48, 262144
    s_add_u32 m0, s38, 0
    s_add_u32 s32, s49, 0
    buffer_load_dwordx4 v224, s[12:15], s32 offen lds
    buffer_load_dwordx4 v225, s[12:15], s32 offen offset:1024 lds
    buffer_load_dwordx4 v[64:67], v226, s[8:11], s35 offen offset:0
    buffer_load_dwordx4 v[68:71], v227, s[8:11], s35 offen offset:0
    s_add_u32 m0, s38, 8192
    s_add_u32 s32, s49, 65536
    buffer_load_dwordx4 v224, s[12:15], s32 offen lds
    buffer_load_dwordx4 v225, s[12:15], s32 offen offset:1024 lds
    buffer_load_dwordx4 v[72:75], v226, s[8:11], s35 offen offset:1024
    buffer_load_dwordx4 v[76:79], v227, s[8:11], s35 offen offset:1024
    s_add_u32 m0, s38, 16384
    s_add_u32 s32, s49, 131072
    buffer_load_dwordx4 v224, s[12:15], s32 offen lds
    buffer_load_dwordx4 v225, s[12:15], s32 offen offset:1024 lds
    buffer_load_dwordx4 v[80:83], v226, s[8:11], s35 offen offset:2048
    buffer_load_dwordx4 v[84:87], v227, s[8:11], s35 offen offset:2048
    s_add_u32 m0, s38, 24576
    s_add_u32 s32, s49, 196608
    buffer_load_dwordx4 v224, s[12:15], s32 offen lds
    buffer_load_dwordx4 v225, s[12:15], s32 offen offset:1024 lds
    buffer_load_dwordx4 v[88:91], v226, s[8:11], s35 offen offset:3072
    buffer_load_dwordx4 v[92:95], v227, s[8:11], s35 offen offset:3072
    s_add_u32 s49, s37, s48
    s_add_u32 s48, s48, 262144
    s_add_u32 m0, s38, 32768
    s_add_u32 s32, s49, 0
    buffer_load_dwordx4 v224, s[12:15], s32 offen lds
    buffer_load_dwordx4 v225, s[12:15], s32 offen offset:1024 lds
    buffer_load_dwordx4 v[96:99], v226, s[8:11], s36 offen offset:0
    buffer_load_dwordx4 v[100:103], v227, s[8:11], s36 offen offset:0
    s_add_u32 m0, s38, 40960
    s_add_u32 s32, s49, 65536
    buffer_load_dwordx4 v224, s[12:15], s32 offen lds
    buffer_load_dwordx4 v225, s[12:15], s32 offen offset:1024 lds
    buffer_load_dwordx4 v[104:107], v226, s[8:11], s36 offen offset:1024
    buffer_load_dwordx4 v[108:111], v227, s[8:11], s36 offen offset:1024
    s_add_u32 m0, s38, 49152
    s_add_u32 s32, s49, 131072
    buffer_load_dwordx4 v224, s[12:15], s32 offen lds
    buffer_load_dwordx4 v225, s[12:15], s32 offen offset:1024 lds
    buffer_load_dwordx4 v[112:115], v226, s[8:11], s36 offen offset:2048
    buffer_load_dwordx4 v[116:119], v227, s[8:11], s36 offen offset:2048
    s_add_u32 m0, s38, 57344
    s_add_u32 s32, s49, 196608
    buffer_load_dwordx4 v224, s[12:15], s32 offen lds
    buffer_load_dwordx4 v225, s[12:15], s32 offen offset:1024 lds
    buffer_load_dwordx4 v[120:123], v226, s[8:11], s36 offen offset:3072
    buffer_load_dwordx4 v[124:127], v227, s[8:11], s36 offen offset:3072
    s_xor_b32 s38, s38, 65536
    s_add_u32 s35, s51, s50
    s_add_u32 s50, s50, 4096
    s_add_u32 s36, s51, s50
    s_add_u32 s50, s50, 4096
    s_add_u32 s49, s37, s48
    s_add_u32 s48, s48, 262144
    s_add_u32 m0, s38, 0
    s_add_u32 s32, s49, 0
    buffer_load_dwordx4 v224, s[12:15], s32 offen lds
    buffer_load_dwordx4 v225, s[12:15], s32 offen offset:1024 lds
    s_add_u32 m0, s38, 8192
    s_add_u32 s32, s49, 65536
    buffer_load_dwordx4 v224, s[12:15], s32 offen lds
    buffer_load_dwordx4 v225, s[12:15], s32 offen offset:1024 lds
    s_add_u32 m0, s38, 16384
    s_add_u32 s32, s49, 131072
    buffer_load_dwordx4 v224, s[12:15], s32 offen lds
    buffer_load_dwordx4 v225, s[12:15], s32 offen offset:1024 lds
    s_add_u32 m0, s38, 24576
    s_add_u32 s32, s49, 196608
    buffer_load_dwordx4 v224, s[12:15], s32 offen lds
    buffer_load_dwordx4 v225, s[12:15], s32 offen offset:1024 lds
    s_mov_b32 s16, s40
    s_mov_b32 s17, s41
    s_mov_b32 s18, 0x400000
    s_mov_b32 s19, 0x00020000
    s_add_u32 s20, s46, 0x3400000
    s_addc_u32 s21, s47, 0
    s_mov_b32 s22, 0x400000
    s_mov_b32 s23, 0x00020000
    s_add_u32 s24, s46, 0x3800000
    s_addc_u32 s25, s47, 0
    s_mov_b32 s26, 0x6040
    s_mov_b32 s27, 0x00020000
    s_mov_b32 s28, s44
    s_mov_b32 s29, s45
    s_mov_b32 s30, 0x800
    s_mov_b32 s31, 0x00020000
    s_add_u32 s56, s46, 0x3820000
    s_addc_u32 s57, s47, 0
    s_mov_b32 s58, 0x20000
    s_mov_b32 s59, 0x00020000
    s_add_u32 s60, s46, 0x5000000
    s_addc_u32 s61, s47, 0
    s_mov_b32 s62, 0x800000
    s_mov_b32 s63, 0x00020000
    v_bfe_u32 v234, v237, 2, 3
    v_lshrrev_b32 v235, 5, v237
    v_lshl_add_u32 v235, v235, 4, v234
    v_lshlrev_b32 v235, 8, v235
    v_and_b32 v236, 1, v237
    v_lshl_add_u32 v235, v236, 3, v235
    v_lshlrev_b32 v234, 1, v234
    v_bfe_u32 v236, v237, 1, 1
    v_or_b32 v234, v234, v236
    s_xor_b32 s32, s6, 1
    s_lshl_b32 s32, s32, 3
    v_xor_b32 v234, s32, v234
    v_xor_b32 v236, 0, v234
    v_lshl_add_u32 v216, v236, 4, v235
    v_xor_b32 v236, 2, v234
    v_lshl_add_u32 v217, v236, 4, v235
    v_xor_b32 v236, 4, v234
    v_lshl_add_u32 v218, v236, 4, v235
    v_xor_b32 v236, 6, v234
    v_lshl_add_u32 v219, v236, 4, v235
    v_xor_b32 v236, 8, v234
    v_lshl_add_u32 v220, v236, 4, v235
    v_xor_b32 v236, 10, v234
    v_lshl_add_u32 v221, v236, 4, v235
    v_xor_b32 v236, 12, v234
    v_lshl_add_u32 v222, v236, 4, v235
    v_xor_b32 v236, 14, v234
    v_lshl_add_u32 v223, v236, 4, v235
    s_lshl_b32 s32, s4, 7
    s_lshl_b32 s33, s3, 5
    s_add_u32 s32, s32, s33
    v_and_b32 v234, 15, v237
    v_add_u32 v234, s32, v234
    v_lshrrev_b32 v235, 4, v237
    v_lshlrev_b32 v236, 3, v235
    s_lshl1_add_u32 s33, s5, s6
    s_lshl_b32 s33, s33, 7
    v_add_u32 v236, s33, v236
    v_lshl_add_u32 v229, v234, 11, v236
    s_mov_b32 s54, 32768
    v_mov_b32 v238, v236
    v_and_b32 v236, 1, v235
    v_lshl_add_u32 v234, v236, 4, v234
    v_lshlrev_b32 v234, 2, v234
    v_lshrrev_b32 v235, 1, v235
    v_lshl_add_u32 v231, v235, 13, v234
    v_lshlrev_b32 v235, 20, v235
    v_add_u32 v235, 16384, v235
    v_add_u32 v232, v235, v234
    s_or_b32 s32, s4, s3
    s_cmp_eq_u32 s32, 0
    s_cselect_b32 s32, 32, 64
    v_cmp_eq_u32 vcc, s32, v237
    v_mov_b32 v235, 24576
    v_mov_b32 v233, 1
    v_cndmask_b32 v232, v232, v235, vcc
    s_lshl2_add_u32 s39, s2, s3
    s_xor_b32 s7, s39, 16
    v_mov_b32 v0, 0
    v_mov_b32 v1, 0
    v_mov_b32 v2, 0
    v_mov_b32 v3, 0
    v_mov_b32 v4, 0
    v_mov_b32 v5, 0
    v_mov_b32 v6, 0
    v_mov_b32 v7, 0
    v_mov_b32 v8, 0
    v_mov_b32 v9, 0
    v_mov_b32 v10, 0
    v_mov_b32 v11, 0
    v_mov_b32 v12, 0
    v_mov_b32 v13, 0
    v_mov_b32 v14, 0
    v_mov_b32 v15, 0
    v_mov_b32 v16, 0
    v_mov_b32 v17, 0
    v_mov_b32 v18, 0
    v_mov_b32 v19, 0
    v_mov_b32 v20, 0
    v_mov_b32 v21, 0
    v_mov_b32 v22, 0
    v_mov_b32 v23, 0
    v_mov_b32 v24, 0
    v_mov_b32 v25, 0
    v_mov_b32 v26, 0
    v_mov_b32 v27, 0
    v_mov_b32 v28, 0
    v_mov_b32 v29, 0
    v_mov_b32 v30, 0
    v_mov_b32 v31, 0
    v_mov_b32 v32, 0
    v_mov_b32 v33, 0
    v_mov_b32 v34, 0
    v_mov_b32 v35, 0
    v_mov_b32 v36, 0
    v_mov_b32 v37, 0
    v_mov_b32 v38, 0
    v_mov_b32 v39, 0
    v_mov_b32 v40, 0
    v_mov_b32 v41, 0
    v_mov_b32 v42, 0
    v_mov_b32 v43, 0
    v_mov_b32 v44, 0
    v_mov_b32 v45, 0
    v_mov_b32 v46, 0
    v_mov_b32 v47, 0
    v_mov_b32 v48, 0
    v_mov_b32 v49, 0
    v_mov_b32 v50, 0
    v_mov_b32 v51, 0
    v_mov_b32 v52, 0
    v_mov_b32 v53, 0
    v_mov_b32 v54, 0
    v_mov_b32 v55, 0
    v_mov_b32 v56, 0
    v_mov_b32 v57, 0
    v_mov_b32 v58, 0
    v_mov_b32 v59, 0
    v_mov_b32 v60, 0
    v_mov_b32 v61, 0
    v_mov_b32 v62, 0
    v_mov_b32 v63, 0
    s_waitcnt vmcnt(26)
    s_barrier
    ds_read_b64_tr_b16 v[128:129], v216 offset:0
    ds_read_b64_tr_b16 v[130:131], v216 offset:2048
    ds_read_b64_tr_b16 v[132:133], v217 offset:0
    ds_read_b64_tr_b16 v[134:135], v217 offset:2048
    ds_read_b64_tr_b16 v[136:137], v218 offset:0
    ds_read_b64_tr_b16 v[138:139], v218 offset:2048
    ds_read_b64_tr_b16 v[140:141], v219 offset:0
    ds_read_b64_tr_b16 v[142:143], v219 offset:2048
    ds_read_b64_tr_b16 v[144:145], v220 offset:0
    ds_read_b64_tr_b16 v[146:147], v220 offset:2048
    ds_read_b64_tr_b16 v[148:149], v221 offset:0
    ds_read_b64_tr_b16 v[150:151], v221 offset:2048
    ds_read_b64_tr_b16 v[152:153], v222 offset:0
    ds_read_b64_tr_b16 v[154:155], v222 offset:2048
    s_waitcnt lgkmcnt(8)
    ds_read_b64_tr_b16 v[156:157], v223 offset:0
    ds_read_b64_tr_b16 v[158:159], v223 offset:2048
    s_mov_b32 s34, 6
.p2align 3
kb_loop:
    s_waitcnt vmcnt(28) lgkmcnt(12)
    v_mfma_f32_16x16x32_bf16 v[0:3], v[128:131], v[64:67], v[0:3]
    ds_read_b64_tr_b16 v[160:161], v216 offset:8192
    v_mfma_f32_16x16x32_bf16 v[4:7], v[128:131], v[68:71], v[4:7]
    ds_read_b64_tr_b16 v[162:163], v216 offset:10240
    v_mfma_f32_16x16x32_bf16 v[8:11], v[132:135], v[64:67], v[8:11]
    ds_read_b64_tr_b16 v[164:165], v217 offset:8192
    v_mfma_f32_16x16x32_bf16 v[12:15], v[132:135], v[68:71], v[12:15]
    ds_read_b64_tr_b16 v[166:167], v217 offset:10240
    s_waitcnt lgkmcnt(12)
    v_mfma_f32_16x16x32_bf16 v[16:19], v[136:139], v[64:67], v[16:19]
    ds_read_b64_tr_b16 v[168:169], v218 offset:8192
    v_mfma_f32_16x16x32_bf16 v[20:23], v[136:139], v[68:71], v[20:23]
    ds_read_b64_tr_b16 v[170:171], v218 offset:10240
    v_mfma_f32_16x16x32_bf16 v[24:27], v[140:143], v[64:67], v[24:27]
    ds_read_b64_tr_b16 v[172:173], v219 offset:8192
    v_mfma_f32_16x16x32_bf16 v[28:31], v[140:143], v[68:71], v[28:31]
    ds_read_b64_tr_b16 v[174:175], v219 offset:10240
    s_waitcnt lgkmcnt(12)
    v_mfma_f32_16x16x32_bf16 v[32:35], v[144:147], v[64:67], v[32:35]
    ds_read_b64_tr_b16 v[176:177], v220 offset:8192
    s_add_u32 s49, s37, s48
    s_add_u32 s48, s48, 262144
    s_add_u32 m0, s38, 32768
    v_mfma_f32_16x16x32_bf16 v[36:39], v[144:147], v[68:71], v[36:39]
    ds_read_b64_tr_b16 v[178:179], v220 offset:10240
    s_add_u32 s32, s49, 0
    v_mfma_f32_16x16x32_bf16 v[40:43], v[148:151], v[64:67], v[40:43]
    ds_read_b64_tr_b16 v[180:181], v221 offset:8192
    buffer_load_dwordx4 v224, s[12:15], s32 offen lds
    v_mfma_f32_16x16x32_bf16 v[44:47], v[148:151], v[68:71], v[44:47]
    ds_read_b64_tr_b16 v[182:183], v221 offset:10240
    s_waitcnt lgkmcnt(12)
    v_mfma_f32_16x16x32_bf16 v[48:51], v[152:155], v[64:67], v[48:51]
    ds_read_b64_tr_b16 v[184:185], v222 offset:8192
    v_mfma_f32_16x16x32_bf16 v[52:55], v[152:155], v[68:71], v[52:55]
    ds_read_b64_tr_b16 v[186:187], v222 offset:10240
    buffer_load_dwordx4 v225, s[12:15], s32 offen offset:1024 lds
    v_mfma_f32_16x16x32_bf16 v[56:59], v[156:159], v[64:67], v[56:59]
    ds_read_b64_tr_b16 v[188:189], v223 offset:8192
    v_mfma_f32_16x16x32_bf16 v[60:63], v[156:159], v[68:71], v[60:63]
    ds_read_b64_tr_b16 v[190:191], v223 offset:10240
    s_waitcnt vmcnt(26) lgkmcnt(12)
    v_mfma_f32_16x16x32_bf16 v[0:3], v[160:163], v[72:75], v[0:3]
    ds_read_b64_tr_b16 v[128:129], v216 offset:16384
    v_mfma_f32_16x16x32_bf16 v[4:7], v[160:163], v[76:79], v[4:7]
    ds_read_b64_tr_b16 v[130:131], v216 offset:18432
    v_mfma_f32_16x16x32_bf16 v[8:11], v[164:167], v[72:75], v[8:11]
    ds_read_b64_tr_b16 v[132:133], v217 offset:16384
    buffer_load_dwordx4 v[64:67], v226, s[8:11], s35 offen offset:0
    v_mfma_f32_16x16x32_bf16 v[12:15], v[164:167], v[76:79], v[12:15]
    ds_read_b64_tr_b16 v[134:135], v217 offset:18432
    s_waitcnt lgkmcnt(12)
    v_mfma_f32_16x16x32_bf16 v[16:19], v[168:171], v[72:75], v[16:19]
    ds_read_b64_tr_b16 v[136:137], v218 offset:16384
    v_mfma_f32_16x16x32_bf16 v[20:23], v[168:171], v[76:79], v[20:23]
    ds_read_b64_tr_b16 v[138:139], v218 offset:18432
    buffer_load_dwordx4 v[68:71], v227, s[8:11], s35 offen offset:0
    v_mfma_f32_16x16x32_bf16 v[24:27], v[172:175], v[72:75], v[24:27]
    ds_read_b64_tr_b16 v[140:141], v219 offset:16384
    v_mfma_f32_16x16x32_bf16 v[28:31], v[172:175], v[76:79], v[28:31]
    ds_read_b64_tr_b16 v[142:143], v219 offset:18432
    s_waitcnt lgkmcnt(12)
    v_mfma_f32_16x16x32_bf16 v[32:35], v[176:179], v[72:75], v[32:35]
    ds_read_b64_tr_b16 v[144:145], v220 offset:16384
    s_add_u32 m0, s38, 40960
    v_mfma_f32_16x16x32_bf16 v[36:39], v[176:179], v[76:79], v[36:39]
    ds_read_b64_tr_b16 v[146:147], v220 offset:18432
    s_add_u32 s32, s49, 65536
    v_mfma_f32_16x16x32_bf16 v[40:43], v[180:183], v[72:75], v[40:43]
    ds_read_b64_tr_b16 v[148:149], v221 offset:16384
    buffer_load_dwordx4 v224, s[12:15], s32 offen lds
    v_mfma_f32_16x16x32_bf16 v[44:47], v[180:183], v[76:79], v[44:47]
    ds_read_b64_tr_b16 v[150:151], v221 offset:18432
    s_waitcnt lgkmcnt(12)
    v_mfma_f32_16x16x32_bf16 v[48:51], v[184:187], v[72:75], v[48:51]
    ds_read_b64_tr_b16 v[152:153], v222 offset:16384
    v_mfma_f32_16x16x32_bf16 v[52:55], v[184:187], v[76:79], v[52:55]
    ds_read_b64_tr_b16 v[154:155], v222 offset:18432
    buffer_load_dwordx4 v225, s[12:15], s32 offen offset:1024 lds
    v_mfma_f32_16x16x32_bf16 v[56:59], v[188:191], v[72:75], v[56:59]
    ds_read_b64_tr_b16 v[156:157], v223 offset:16384
    v_mfma_f32_16x16x32_bf16 v[60:63], v[188:191], v[76:79], v[60:63]
    ds_read_b64_tr_b16 v[158:159], v223 offset:18432
    s_waitcnt vmcnt(24) lgkmcnt(12)
    v_mfma_f32_16x16x32_bf16 v[0:3], v[128:131], v[80:83], v[0:3]
    ds_read_b64_tr_b16 v[160:161], v216 offset:24576
    v_mfma_f32_16x16x32_bf16 v[4:7], v[128:131], v[84:87], v[4:7]
    ds_read_b64_tr_b16 v[162:163], v216 offset:26624
    v_mfma_f32_16x16x32_bf16 v[8:11], v[132:135], v[80:83], v[8:11]
    ds_read_b64_tr_b16 v[164:165], v217 offset:24576
    buffer_load_dwordx4 v[72:75], v226, s[8:11], s35 offen offset:1024
    v_mfma_f32_16x16x32_bf16 v[12:15], v[132:135], v[84:87], v[12:15]
    ds_read_b64_tr_b16 v[166:167], v217 offset:26624
    s_waitcnt lgkmcnt(12)
    v_mfma_f32_16x16x32_bf16 v[16:19], v[136:139], v[80:83], v[16:19]
    ds_read_b64_tr_b16 v[168:169], v218 offset:24576
    v_mfma_f32_16x16x32_bf16 v[20:23], v[136:139], v[84:87], v[20:23]
    ds_read_b64_tr_b16 v[170:171], v218 offset:26624
    buffer_load_dwordx4 v[76:79], v227, s[8:11], s35 offen offset:1024
    v_mfma_f32_16x16x32_bf16 v[24:27], v[140:143], v[80:83], v[24:27]
    ds_read_b64_tr_b16 v[172:173], v219 offset:24576
    v_mfma_f32_16x16x32_bf16 v[28:31], v[140:143], v[84:87], v[28:31]
    ds_read_b64_tr_b16 v[174:175], v219 offset:26624
    s_waitcnt lgkmcnt(12)
    v_mfma_f32_16x16x32_bf16 v[32:35], v[144:147], v[80:83], v[32:35]
    ds_read_b64_tr_b16 v[176:177], v220 offset:24576
    s_add_u32 m0, s38, 49152
    v_mfma_f32_16x16x32_bf16 v[36:39], v[144:147], v[84:87], v[36:39]
    ds_read_b64_tr_b16 v[178:179], v220 offset:26624
    s_add_u32 s32, s49, 131072
    v_mfma_f32_16x16x32_bf16 v[40:43], v[148:151], v[80:83], v[40:43]
    ds_read_b64_tr_b16 v[180:181], v221 offset:24576
    buffer_load_dwordx4 v224, s[12:15], s32 offen lds
    v_mfma_f32_16x16x32_bf16 v[44:47], v[148:151], v[84:87], v[44:47]
    ds_read_b64_tr_b16 v[182:183], v221 offset:26624
    s_waitcnt lgkmcnt(12)
    v_mfma_f32_16x16x32_bf16 v[48:51], v[152:155], v[80:83], v[48:51]
    ds_read_b64_tr_b16 v[184:185], v222 offset:24576
    v_mfma_f32_16x16x32_bf16 v[52:55], v[152:155], v[84:87], v[52:55]
    ds_read_b64_tr_b16 v[186:187], v222 offset:26624
    buffer_load_dwordx4 v225, s[12:15], s32 offen offset:1024 lds
    v_mfma_f32_16x16x32_bf16 v[56:59], v[156:159], v[80:83], v[56:59]
    ds_read_b64_tr_b16 v[188:189], v223 offset:24576
    v_mfma_f32_16x16x32_bf16 v[60:63], v[156:159], v[84:87], v[60:63]
    ds_read_b64_tr_b16 v[190:191], v223 offset:26624
    s_waitcnt vmcnt(26) lgkmcnt(12)
    v_mfma_f32_16x16x32_bf16 v[0:3], v[160:163], v[88:91], v[0:3]
    s_add_u32 m0, s38, 57344
    v_mfma_f32_16x16x32_bf16 v[4:7], v[160:163], v[92:95], v[4:7]
    s_add_u32 s32, s49, 196608
    v_mfma_f32_16x16x32_bf16 v[8:11], v[164:167], v[88:91], v[8:11]
    buffer_load_dwordx4 v224, s[12:15], s32 offen lds
    buffer_load_dwordx4 v[80:83], v226, s[8:11], s35 offen offset:2048
    v_mfma_f32_16x16x32_bf16 v[12:15], v[164:167], v[92:95], v[12:15]
    buffer_load_dwordx4 v225, s[12:15], s32 offen offset:1024 lds
    s_xor_b32 s38, s38, 65536
    s_waitcnt lgkmcnt(8)
    v_mfma_f32_16x16x32_bf16 v[16:19], v[168:171], v[88:91], v[16:19]
    buffer_load_dwordx4 v[84:87], v227, s[8:11], s35 offen offset:2048
    v_mfma_f32_16x16x32_bf16 v[20:23], v[168:171], v[92:95], v[20:23]
    v_mfma_f32_16x16x32_bf16 v[24:27], v[172:175], v[88:91], v[24:27]
    s_waitcnt vmcnt(24) lgkmcnt(0)
    s_barrier
    ds_read_b64_tr_b16 v[128:129], v216 offset:32768
    ds_read_b64_tr_b16 v[130:131], v216 offset:34816
    v_mfma_f32_16x16x32_bf16 v[28:31], v[172:175], v[92:95], v[28:31]
    ds_read_b64_tr_b16 v[132:133], v217 offset:32768
    ds_read_b64_tr_b16 v[134:135], v217 offset:34816
    v_mfma_f32_16x16x32_bf16 v[32:35], v[176:179], v[88:91], v[32:35]
    ds_read_b64_tr_b16 v[136:137], v218 offset:32768
    v_mfma_f32_16x16x32_bf16 v[36:39], v[176:179], v[92:95], v[36:39]
    ds_read_b64_tr_b16 v[138:139], v218 offset:34816
    ds_read_b64_tr_b16 v[140:141], v219 offset:32768
    v_mfma_f32_16x16x32_bf16 v[40:43], v[180:183], v[88:91], v[40:43]
    ds_read_b64_tr_b16 v[142:143], v219 offset:34816
    v_mfma_f32_16x16x32_bf16 v[44:47], v[180:183], v[92:95], v[44:47]
    ds_read_b64_tr_b16 v[144:145], v220 offset:32768
    ds_read_b64_tr_b16 v[146:147], v220 offset:34816
    v_mfma_f32_16x16x32_bf16 v[48:51], v[184:187], v[88:91], v[48:51]
    ds_read_b64_tr_b16 v[148:149], v221 offset:32768
    ds_read_b64_tr_b16 v[150:151], v221 offset:34816
    v_mfma_f32_16x16x32_bf16 v[52:55], v[184:187], v[92:95], v[52:55]
    ds_read_b64_tr_b16 v[152:153], v222 offset:32768
    v_mfma_f32_16x16x32_bf16 v[56:59], v[188:191], v[88:91], v[56:59]
    ds_read_b64_tr_b16 v[154:155], v222 offset:34816
    ds_read_b64_tr_b16 v[156:157], v223 offset:32768
    v_mfma_f32_16x16x32_bf16 v[60:63], v[188:191], v[92:95], v[60:63]
    ds_read_b64_tr_b16 v[158:159], v223 offset:34816
    s_waitcnt vmcnt(26) lgkmcnt(12)
    v_mfma_f32_16x16x32_bf16 v[0:3], v[128:131], v[96:99], v[0:3]
    ds_read_b64_tr_b16 v[160:161], v216 offset:40960
    v_mfma_f32_16x16x32_bf16 v[4:7], v[128:131], v[100:103], v[4:7]
    ds_read_b64_tr_b16 v[162:163], v216 offset:43008
    v_mfma_f32_16x16x32_bf16 v[8:11], v[132:135], v[96:99], v[8:11]
    ds_read_b64_tr_b16 v[164:165], v217 offset:40960
    buffer_load_dwordx4 v[88:91], v226, s[8:11], s35 offen offset:3072
    v_mfma_f32_16x16x32_bf16 v[12:15], v[132:135], v[100:103], v[12:15]
    ds_read_b64_tr_b16 v[166:167], v217 offset:43008
    s_waitcnt lgkmcnt(12)
    v_mfma_f32_16x16x32_bf16 v[16:19], v[136:139], v[96:99], v[16:19]
    ds_read_b64_tr_b16 v[168:169], v218 offset:40960
    v_mfma_f32_16x16x32_bf16 v[20:23], v[136:139], v[100:103], v[20:23]
    ds_read_b64_tr_b16 v[170:171], v218 offset:43008
    buffer_load_dwordx4 v[92:95], v227, s[8:11], s35 offen offset:3072
    v_mfma_f32_16x16x32_bf16 v[24:27], v[140:143], v[96:99], v[24:27]
    ds_read_b64_tr_b16 v[172:173], v219 offset:40960
    v_mfma_f32_16x16x32_bf16 v[28:31], v[140:143], v[100:103], v[28:31]
    ds_read_b64_tr_b16 v[174:175], v219 offset:43008
    s_waitcnt lgkmcnt(12)
    v_mfma_f32_16x16x32_bf16 v[32:35], v[144:147], v[96:99], v[32:35]
    ds_read_b64_tr_b16 v[176:177], v220 offset:40960
    s_add_u32 s49, s37, s48
    s_add_u32 s48, s48, 262144
    s_add_u32 m0, s38, 0
    v_mfma_f32_16x16x32_bf16 v[36:39], v[144:147], v[100:103], v[36:39]
    ds_read_b64_tr_b16 v[178:179], v220 offset:43008
    s_add_u32 s32, s49, 0
    v_mfma_f32_16x16x32_bf16 v[40:43], v[148:151], v[96:99], v[40:43]
    ds_read_b64_tr_b16 v[180:181], v221 offset:40960
    buffer_load_dwordx4 v224, s[12:15], s32 offen lds
    v_mfma_f32_16x16x32_bf16 v[44:47], v[148:151], v[100:103], v[44:47]
    ds_read_b64_tr_b16 v[182:183], v221 offset:43008
    s_waitcnt lgkmcnt(12)
    v_mfma_f32_16x16x32_bf16 v[48:51], v[152:155], v[96:99], v[48:51]
    ds_read_b64_tr_b16 v[184:185], v222 offset:40960
    v_mfma_f32_16x16x32_bf16 v[52:55], v[152:155], v[100:103], v[52:55]
    ds_read_b64_tr_b16 v[186:187], v222 offset:43008
    buffer_load_dwordx4 v225, s[12:15], s32 offen offset:1024 lds
    v_mfma_f32_16x16x32_bf16 v[56:59], v[156:159], v[96:99], v[56:59]
    ds_read_b64_tr_b16 v[188:189], v223 offset:40960
    v_mfma_f32_16x16x32_bf16 v[60:63], v[156:159], v[100:103], v[60:63]
    ds_read_b64_tr_b16 v[190:191], v223 offset:43008
    s_waitcnt vmcnt(26) lgkmcnt(12)
    v_mfma_f32_16x16x32_bf16 v[0:3], v[160:163], v[104:107], v[0:3]
    ds_read_b64_tr_b16 v[128:129], v216 offset:49152
    v_mfma_f32_16x16x32_bf16 v[4:7], v[160:163], v[108:111], v[4:7]
    ds_read_b64_tr_b16 v[130:131], v216 offset:51200
    v_mfma_f32_16x16x32_bf16 v[8:11], v[164:167], v[104:107], v[8:11]
    ds_read_b64_tr_b16 v[132:133], v217 offset:49152
    buffer_load_dwordx4 v[96:99], v226, s[8:11], s36 offen offset:0
    v_mfma_f32_16x16x32_bf16 v[12:15], v[164:167], v[108:111], v[12:15]
    ds_read_b64_tr_b16 v[134:135], v217 offset:51200
    s_waitcnt lgkmcnt(12)
    v_mfma_f32_16x16x32_bf16 v[16:19], v[168:171], v[104:107], v[16:19]
    ds_read_b64_tr_b16 v[136:137], v218 offset:49152
    v_mfma_f32_16x16x32_bf16 v[20:23], v[168:171], v[108:111], v[20:23]
    ds_read_b64_tr_b16 v[138:139], v218 offset:51200
    buffer_load_dwordx4 v[100:103], v227, s[8:11], s36 offen offset:0
    v_mfma_f32_16x16x32_bf16 v[24:27], v[172:175], v[104:107], v[24:27]
    ds_read_b64_tr_b16 v[140:141], v219 offset:49152
    v_mfma_f32_16x16x32_bf16 v[28:31], v[172:175], v[108:111], v[28:31]
    ds_read_b64_tr_b16 v[142:143], v219 offset:51200
    s_waitcnt lgkmcnt(12)
    v_mfma_f32_16x16x32_bf16 v[32:35], v[176:179], v[104:107], v[32:35]
    ds_read_b64_tr_b16 v[144:145], v220 offset:49152
    s_add_u32 m0, s38, 8192
    v_mfma_f32_16x16x32_bf16 v[36:39], v[176:179], v[108:111], v[36:39]
    ds_read_b64_tr_b16 v[146:147], v220 offset:51200
    s_add_u32 s32, s49, 65536
    v_mfma_f32_16x16x32_bf16 v[40:43], v[180:183], v[104:107], v[40:43]
    ds_read_b64_tr_b16 v[148:149], v221 offset:49152
    buffer_load_dwordx4 v224, s[12:15], s32 offen lds
    s_add_u32 s35, s51, s50
    s_add_u32 s50, s50, 4096
    v_mfma_f32_16x16x32_bf16 v[44:47], v[180:183], v[108:111], v[44:47]
    ds_read_b64_tr_b16 v[150:151], v221 offset:51200
    s_waitcnt lgkmcnt(12)
    v_mfma_f32_16x16x32_bf16 v[48:51], v[184:187], v[104:107], v[48:51]
    ds_read_b64_tr_b16 v[152:153], v222 offset:49152
    v_mfma_f32_16x16x32_bf16 v[52:55], v[184:187], v[108:111], v[52:55]
    ds_read_b64_tr_b16 v[154:155], v222 offset:51200
    buffer_load_dwordx4 v225, s[12:15], s32 offen offset:1024 lds
    v_mfma_f32_16x16x32_bf16 v[56:59], v[188:191], v[104:107], v[56:59]
    ds_read_b64_tr_b16 v[156:157], v223 offset:49152
    v_mfma_f32_16x16x32_bf16 v[60:63], v[188:191], v[108:111], v[60:63]
    ds_read_b64_tr_b16 v[158:159], v223 offset:51200
    s_waitcnt vmcnt(24) lgkmcnt(12)
    v_mfma_f32_16x16x32_bf16 v[0:3], v[128:131], v[112:115], v[0:3]
    ds_read_b64_tr_b16 v[160:161], v216 offset:57344
    v_mfma_f32_16x16x32_bf16 v[4:7], v[128:131], v[116:119], v[4:7]
    ds_read_b64_tr_b16 v[162:163], v216 offset:59392
    v_mfma_f32_16x16x32_bf16 v[8:11], v[132:135], v[112:115], v[8:11]
    ds_read_b64_tr_b16 v[164:165], v217 offset:57344
    buffer_load_dwordx4 v[104:107], v226, s[8:11], s36 offen offset:1024
    v_mfma_f32_16x16x32_bf16 v[12:15], v[132:135], v[116:119], v[12:15]
    ds_read_b64_tr_b16 v[166:167], v217 offset:59392
    s_waitcnt lgkmcnt(12)
    v_mfma_f32_16x16x32_bf16 v[16:19], v[136:139], v[112:115], v[16:19]
    ds_read_b64_tr_b16 v[168:169], v218 offset:57344
    v_mfma_f32_16x16x32_bf16 v[20:23], v[136:139], v[116:119], v[20:23]
    ds_read_b64_tr_b16 v[170:171], v218 offset:59392
    buffer_load_dwordx4 v[108:111], v227, s[8:11], s36 offen offset:1024
    v_mfma_f32_16x16x32_bf16 v[24:27], v[140:143], v[112:115], v[24:27]
    ds_read_b64_tr_b16 v[172:173], v219 offset:57344
    v_mfma_f32_16x16x32_bf16 v[28:31], v[140:143], v[116:119], v[28:31]
    ds_read_b64_tr_b16 v[174:175], v219 offset:59392
    s_waitcnt lgkmcnt(12)
    v_mfma_f32_16x16x32_bf16 v[32:35], v[144:147], v[112:115], v[32:35]
    ds_read_b64_tr_b16 v[176:177], v220 offset:57344
    s_add_u32 m0, s38, 16384
    v_mfma_f32_16x16x32_bf16 v[36:39], v[144:147], v[116:119], v[36:39]
    ds_read_b64_tr_b16 v[178:179], v220 offset:59392
    s_add_u32 s32, s49, 131072
    v_mfma_f32_16x16x32_bf16 v[40:43], v[148:151], v[112:115], v[40:43]
    ds_read_b64_tr_b16 v[180:181], v221 offset:57344
    buffer_load_dwordx4 v224, s[12:15], s32 offen lds
    v_mfma_f32_16x16x32_bf16 v[44:47], v[148:151], v[116:119], v[44:47]
    ds_read_b64_tr_b16 v[182:183], v221 offset:59392
    s_waitcnt lgkmcnt(12)
    v_mfma_f32_16x16x32_bf16 v[48:51], v[152:155], v[112:115], v[48:51]
    ds_read_b64_tr_b16 v[184:185], v222 offset:57344
    v_mfma_f32_16x16x32_bf16 v[52:55], v[152:155], v[116:119], v[52:55]
    ds_read_b64_tr_b16 v[186:187], v222 offset:59392
    buffer_load_dwordx4 v225, s[12:15], s32 offen offset:1024 lds
    v_mfma_f32_16x16x32_bf16 v[56:59], v[156:159], v[112:115], v[56:59]
    ds_read_b64_tr_b16 v[188:189], v223 offset:57344
    v_mfma_f32_16x16x32_bf16 v[60:63], v[156:159], v[116:119], v[60:63]
    ds_read_b64_tr_b16 v[190:191], v223 offset:59392
    s_waitcnt vmcnt(26) lgkmcnt(12)
    v_mfma_f32_16x16x32_bf16 v[0:3], v[160:163], v[120:123], v[0:3]
    v_xor_b32 v216, 0x10000, v216
    v_xor_b32 v217, 0x10000, v217
    s_add_u32 m0, s38, 24576
    v_mfma_f32_16x16x32_bf16 v[4:7], v[160:163], v[124:127], v[4:7]
    v_xor_b32 v218, 0x10000, v218
    s_add_u32 s32, s49, 196608
    v_mfma_f32_16x16x32_bf16 v[8:11], v[164:167], v[120:123], v[8:11]
    v_xor_b32 v219, 0x10000, v219
    buffer_load_dwordx4 v224, s[12:15], s32 offen lds
    buffer_load_dwordx4 v[112:115], v226, s[8:11], s36 offen offset:2048
    v_mfma_f32_16x16x32_bf16 v[12:15], v[164:167], v[124:127], v[12:15]
    v_xor_b32 v220, 0x10000, v220
    v_xor_b32 v221, 0x10000, v221
    buffer_load_dwordx4 v225, s[12:15], s32 offen offset:1024 lds
    s_waitcnt lgkmcnt(8)
    v_mfma_f32_16x16x32_bf16 v[16:19], v[168:171], v[120:123], v[16:19]
    v_xor_b32 v222, 0x10000, v222
    buffer_load_dwordx4 v[116:119], v227, s[8:11], s36 offen offset:2048
    v_mfma_f32_16x16x32_bf16 v[20:23], v[168:171], v[124:127], v[20:23]
    v_xor_b32 v223, 0x10000, v223
    v_mfma_f32_16x16x32_bf16 v[24:27], v[172:175], v[120:123], v[24:27]
    s_waitcnt vmcnt(30) lgkmcnt(0)
    s_barrier
    ds_read_b64_tr_b16 v[128:129], v216 offset:0
    ds_read_b64_tr_b16 v[130:131], v216 offset:2048
    v_mfma_f32_16x16x32_bf16 v[28:31], v[172:175], v[124:127], v[28:31]
    ds_read_b64_tr_b16 v[132:133], v217 offset:0
    ds_read_b64_tr_b16 v[134:135], v217 offset:2048
    v_mfma_f32_16x16x32_bf16 v[32:35], v[176:179], v[120:123], v[32:35]
    ds_read_b64_tr_b16 v[136:137], v218 offset:0
    v_mfma_f32_16x16x32_bf16 v[36:39], v[176:179], v[124:127], v[36:39]
    ds_read_b64_tr_b16 v[138:139], v218 offset:2048
    ds_read_b64_tr_b16 v[140:141], v219 offset:0
    v_mfma_f32_16x16x32_bf16 v[40:43], v[180:183], v[120:123], v[40:43]
    ds_read_b64_tr_b16 v[142:143], v219 offset:2048
    v_mfma_f32_16x16x32_bf16 v[44:47], v[180:183], v[124:127], v[44:47]
    ds_read_b64_tr_b16 v[144:145], v220 offset:0
    ds_read_b64_tr_b16 v[146:147], v220 offset:2048
    v_mfma_f32_16x16x32_bf16 v[48:51], v[184:187], v[120:123], v[48:51]
    ds_read_b64_tr_b16 v[148:149], v221 offset:0
    ds_read_b64_tr_b16 v[150:151], v221 offset:2048
    v_mfma_f32_16x16x32_bf16 v[52:55], v[184:187], v[124:127], v[52:55]
    ds_read_b64_tr_b16 v[152:153], v222 offset:0
    v_mfma_f32_16x16x32_bf16 v[56:59], v[188:191], v[120:123], v[56:59]
    ds_read_b64_tr_b16 v[154:155], v222 offset:2048
    ds_read_b64_tr_b16 v[156:157], v223 offset:0
    v_mfma_f32_16x16x32_bf16 v[60:63], v[188:191], v[124:127], v[60:63]
    ds_read_b64_tr_b16 v[158:159], v223 offset:2048
    buffer_load_dwordx4 v[120:123], v226, s[8:11], s36 offen offset:3072
    buffer_load_dwordx4 v[124:127], v227, s[8:11], s36 offen offset:3072
    s_add_u32 s36, s51, s50
    s_add_u32 s50, s50, 4096
    s_sub_u32 s34, s34, 1
    s_cmp_lg_u32 s34, 0
    s_cbranch_scc1 kb_loop
    s_waitcnt vmcnt(28) lgkmcnt(12)
    v_mfma_f32_16x16x32_bf16 v[0:3], v[128:131], v[64:67], v[0:3]
    ds_read_b64_tr_b16 v[160:161], v216 offset:8192
    v_mfma_f32_16x16x32_bf16 v[4:7], v[128:131], v[68:71], v[4:7]
    ds_read_b64_tr_b16 v[162:163], v216 offset:10240
    s_add_u32 s49, s37, s48
    s_add_u32 s48, s48, 262144
    s_add_u32 m0, s38, 32768
    s_add_u32 s32, s49, 0
    buffer_load_dwordx4 v224, s[12:15], s32 offen lds
    v_mfma_f32_16x16x32_bf16 v[8:11], v[132:135], v[64:67], v[8:11]
    ds_read_b64_tr_b16 v[164:165], v217 offset:8192
    buffer_load_dwordx4 a[0:3], v226, s[8:11], s35 offen offset:0
    v_mfma_f32_16x16x32_bf16 v[12:15], v[132:135], v[68:71], v[12:15]
    ds_read_b64_tr_b16 v[166:167], v217 offset:10240
    s_waitcnt lgkmcnt(12)
    v_mfma_f32_16x16x32_bf16 v[16:19], v[136:139], v[64:67], v[16:19]
    ds_read_b64_tr_b16 v[168:169], v218 offset:8192
    v_mfma_f32_16x16x32_bf16 v[20:23], v[136:139], v[68:71], v[20:23]
    ds_read_b64_tr_b16 v[170:171], v218 offset:10240
    buffer_load_dwordx4 v225, s[12:15], s32 offen offset:1024 lds
    v_mfma_f32_16x16x32_bf16 v[24:27], v[140:143], v[64:67], v[24:27]
    ds_read_b64_tr_b16 v[172:173], v219 offset:8192
    buffer_load_dwordx4 a[4:7], v227, s[8:11], s35 offen offset:0
    v_mfma_f32_16x16x32_bf16 v[28:31], v[140:143], v[68:71], v[28:31]
    ds_read_b64_tr_b16 v[174:175], v219 offset:10240
    s_waitcnt vmcnt(28) lgkmcnt(4)
    v_mfma_f32_16x16x32_bf16 v[0:3], v[160:163], v[72:75], v[0:3]
    ds_read_b64_tr_b16 v[128:129], v216 offset:16384
    v_mfma_f32_16x16x32_bf16 v[4:7], v[160:163], v[76:79], v[4:7]
    ds_read_b64_tr_b16 v[130:131], v216 offset:18432
    s_add_u32 m0, s38, 40960
    s_add_u32 s32, s49, 65536
    buffer_load_dwordx4 v224, s[12:15], s32 offen lds
    v_mfma_f32_16x16x32_bf16 v[8:11], v[164:167], v[72:75], v[8:11]
    ds_read_b64_tr_b16 v[132:133], v217 offset:16384
    buffer_load_dwordx4 a[8:11], v226, s[8:11], s35 offen offset:1024
    v_mfma_f32_16x16x32_bf16 v[12:15], v[164:167], v[76:79], v[12:15]
    ds_read_b64_tr_b16 v[134:135], v217 offset:18432
    s_waitcnt lgkmcnt(4)
    v_mfma_f32_16x16x32_bf16 v[16:19], v[168:171], v[72:75], v[16:19]
    ds_read_b64_tr_b16 v[136:137], v218 offset:16384
    v_mfma_f32_16x16x32_bf16 v[20:23], v[168:171], v[76:79], v[20:23]
    ds_read_b64_tr_b16 v[138:139], v218 offset:18432
    buffer_load_dwordx4 v225, s[12:15], s32 offen offset:1024 lds
    v_mfma_f32_16x16x32_bf16 v[24:27], v[172:175], v[72:75], v[24:27]
    ds_read_b64_tr_b16 v[140:141], v219 offset:16384
    buffer_load_dwordx4 a[12:15], v227, s[8:11], s35 offen offset:1024
    v_mfma_f32_16x16x32_bf16 v[28:31], v[172:175], v[76:79], v[28:31]
    ds_read_b64_tr_b16 v[142:143], v219 offset:18432
    s_waitcnt vmcnt(26) lgkmcnt(4)
    v_mfma_f32_16x16x32_bf16 v[0:3], v[128:131], v[80:83], v[0:3]
    ds_read_b64_tr_b16 v[160:161], v216 offset:24576
    v_mfma_f32_16x16x32_bf16 v[4:7], v[128:131], v[84:87], v[4:7]
    ds_read_b64_tr_b16 v[162:163], v216 offset:26624
    s_add_u32 m0, s38, 49152
    s_add_u32 s32, s49, 131072
    buffer_load_dwordx4 v224, s[12:15], s32 offen lds
    v_mfma_f32_16x16x32_bf16 v[8:11], v[132:135], v[80:83], v[8:11]
    ds_read_b64_tr_b16 v[164:165], v217 offset:24576
    buffer_load_dwordx4 a[16:19], v226, s[8:11], s35 offen offset:2048
    v_mfma_f32_16x16x32_bf16 v[12:15], v[132:135], v[84:87], v[12:15]
    ds_read_b64_tr_b16 v[166:167], v217 offset:26624
    s_waitcnt lgkmcnt(4)
    v_mfma_f32_16x16x32_bf16 v[16:19], v[136:139], v[80:83], v[16:19]
    ds_read_b64_tr_b16 v[168:169], v218 offset:24576
    v_mfma_f32_16x16x32_bf16 v[20:23], v[136:139], v[84:87], v[20:23]
    ds_read_b64_tr_b16 v[170:171], v218 offset:26624
    buffer_load_dwordx4 v225, s[12:15], s32 offen offset:1024 lds
    v_mfma_f32_16x16x32_bf16 v[24:27], v[140:143], v[80:83], v[24:27]
    ds_read_b64_tr_b16 v[172:173], v219 offset:24576
    buffer_load_dwordx4 a[20:23], v227, s[8:11], s35 offen offset:2048
    v_mfma_f32_16x16x32_bf16 v[28:31], v[140:143], v[84:87], v[28:31]
    ds_read_b64_tr_b16 v[174:175], v219 offset:26624
    s_waitcnt vmcnt(31)
    s_barrier
    s_waitcnt vmcnt(28) lgkmcnt(4)
    v_mfma_f32_16x16x32_bf16 v[0:3], v[160:163], v[88:91], v[0:3]
    ds_read_b64_tr_b16 v[128:129], v216 offset:32768
    v_mfma_f32_16x16x32_bf16 v[4:7], v[160:163], v[92:95], v[4:7]
    ds_read_b64_tr_b16 v[130:131], v216 offset:34816
    s_add_u32 m0, s38, 57344
    s_add_u32 s32, s49, 196608
    buffer_load_dwordx4 v224, s[12:15], s32 offen lds
    v_mfma_f32_16x16x32_bf16 v[8:11], v[164:167], v[88:91], v[8:11]
    ds_read_b64_tr_b16 v[132:133], v217 offset:32768
    buffer_load_dwordx4 a[24:27], v226, s[8:11], s35 offen offset:3072
    v_mfma_f32_16x16x32_bf16 v[12:15], v[164:167], v[92:95], v[12:15]
    ds_read_b64_tr_b16 v[134:135], v217 offset:34816
    s_waitcnt lgkmcnt(4)
    v_mfma_f32_16x16x32_bf16 v[16:19], v[168:171], v[88:91], v[16:19]
    ds_read_b64_tr_b16 v[136:137], v218 offset:32768
    v_mfma_f32_16x16x32_bf16 v[20:23], v[168:171], v[92:95], v[20:23]
    ds_read_b64_tr_b16 v[138:139], v218 offset:34816
    buffer_load_dwordx4 v225, s[12:15], s32 offen offset:1024 lds
    v_mfma_f32_16x16x32_bf16 v[24:27], v[172:175], v[88:91], v[24:27]
    ds_read_b64_tr_b16 v[140:141], v219 offset:32768
    buffer_load_dwordx4 a[28:31], v227, s[8:11], s35 offen offset:3072
    v_mfma_f32_16x16x32_bf16 v[28:31], v[172:175], v[92:95], v[28:31]
    ds_read_b64_tr_b16 v[142:143], v219 offset:34816
    s_waitcnt vmcnt(28) lgkmcnt(4)
    v_mfma_f32_16x16x32_bf16 v[0:3], v[128:131], v[96:99], v[0:3]
    ds_read_b64_tr_b16 v[160:161], v216 offset:40960
    v_mfma_f32_16x16x32_bf16 v[4:7], v[128:131], v[100:103], v[4:7]
    ds_read_b64_tr_b16 v[162:163], v216 offset:43008
    v_mfma_f32_16x16x32_bf16 v[8:11], v[132:135], v[96:99], v[8:11]
    ds_read_b64_tr_b16 v[164:165], v217 offset:40960
    buffer_load_dwordx4 a[32:35], v226, s[8:11], s36 offen offset:0
    v_mfma_f32_16x16x32_bf16 v[12:15], v[132:135], v[100:103], v[12:15]
    ds_read_b64_tr_b16 v[166:167], v217 offset:43008
    s_waitcnt lgkmcnt(4)
    v_mfma_f32_16x16x32_bf16 v[16:19], v[136:139], v[96:99], v[16:19]
    ds_read_b64_tr_b16 v[168:169], v218 offset:40960
    v_mfma_f32_16x16x32_bf16 v[20:23], v[136:139], v[100:103], v[20:23]
    ds_read_b64_tr_b16 v[170:171], v218 offset:43008
    v_mfma_f32_16x16x32_bf16 v[24:27], v[140:143], v[96:99], v[24:27]
    ds_read_b64_tr_b16 v[172:173], v219 offset:40960
    buffer_load_dwordx4 a[36:39], v227, s[8:11], s36 offen offset:0
    v_mfma_f32_16x16x32_bf16 v[28:31], v[140:143], v[100:103], v[28:31]
    ds_read_b64_tr_b16 v[174:175], v219 offset:43008
    s_waitcnt vmcnt(26) lgkmcnt(4)
    v_mfma_f32_16x16x32_bf16 v[0:3], v[160:163], v[104:107], v[0:3]
    ds_read_b64_tr_b16 v[128:129], v216 offset:49152
    v_mfma_f32_16x16x32_bf16 v[4:7], v[160:163], v[108:111], v[4:7]
    ds_read_b64_tr_b16 v[130:131], v216 offset:51200
    v_mfma_f32_16x16x32_bf16 v[8:11], v[164:167], v[104:107], v[8:11]
    ds_read_b64_tr_b16 v[132:133], v217 offset:49152
    buffer_load_dwordx4 a[40:43], v226, s[8:11], s36 offen offset:1024
    v_mfma_f32_16x16x32_bf16 v[12:15], v[164:167], v[108:111], v[12:15]
    ds_read_b64_tr_b16 v[134:135], v217 offset:51200
    s_waitcnt lgkmcnt(4)
    v_mfma_f32_16x16x32_bf16 v[16:19], v[168:171], v[104:107], v[16:19]
    ds_read_b64_tr_b16 v[136:137], v218 offset:49152
    v_mfma_f32_16x16x32_bf16 v[20:23], v[168:171], v[108:111], v[20:23]
    ds_read_b64_tr_b16 v[138:139], v218 offset:51200
    v_mfma_f32_16x16x32_bf16 v[24:27], v[172:175], v[104:107], v[24:27]
    ds_read_b64_tr_b16 v[140:141], v219 offset:49152
    buffer_load_dwordx4 a[44:47], v227, s[8:11], s36 offen offset:1024
    v_mfma_f32_16x16x32_bf16 v[28:31], v[172:175], v[108:111], v[28:31]
    ds_read_b64_tr_b16 v[142:143], v219 offset:51200
    s_waitcnt vmcnt(22) lgkmcnt(4)
    v_mfma_f32_16x16x32_bf16 v[0:3], v[128:131], v[112:115], v[0:3]
    ds_read_b64_tr_b16 v[160:161], v216 offset:57344
    v_mfma_f32_16x16x32_bf16 v[4:7], v[128:131], v[116:119], v[4:7]
    ds_read_b64_tr_b16 v[162:163], v216 offset:59392
    v_mfma_f32_16x16x32_bf16 v[8:11], v[132:135], v[112:115], v[8:11]
    ds_read_b64_tr_b16 v[164:165], v217 offset:57344
    buffer_load_dwordx4 a[48:51], v226, s[8:11], s36 offen offset:2048
    v_mfma_f32_16x16x32_bf16 v[12:15], v[132:135], v[116:119], v[12:15]
    ds_read_b64_tr_b16 v[166:167], v217 offset:59392
    s_waitcnt lgkmcnt(4)
    v_mfma_f32_16x16x32_bf16 v[16:19], v[136:139], v[112:115], v[16:19]
    ds_read_b64_tr_b16 v[168:169], v218 offset:57344
    v_mfma_f32_16x16x32_bf16 v[20:23], v[136:139], v[116:119], v[20:23]
    ds_read_b64_tr_b16 v[170:171], v218 offset:59392
    v_mfma_f32_16x16x32_bf16 v[24:27], v[140:143], v[112:115], v[24:27]
    ds_read_b64_tr_b16 v[172:173], v219 offset:57344
    buffer_load_dwordx4 a[52:55], v227, s[8:11], s36 offen offset:2048
    v_mfma_f32_16x16x32_bf16 v[28:31], v[140:143], v[116:119], v[28:31]
    ds_read_b64_tr_b16 v[174:175], v219 offset:59392
    s_waitcnt vmcnt(25)
    s_barrier
    s_waitcnt vmcnt(22) lgkmcnt(4)
    v_mfma_f32_16x16x32_bf16 v[0:3], v[160:163], v[120:123], v[0:3]
    v_xor_b32 v216, 0x10000, v216
    ds_read_b64_tr_b16 v[128:129], v216 offset:0
    v_mfma_f32_16x16x32_bf16 v[4:7], v[160:163], v[124:127], v[4:7]
    ds_read_b64_tr_b16 v[130:131], v216 offset:2048
    v_mfma_f32_16x16x32_bf16 v[8:11], v[164:167], v[120:123], v[8:11]
    v_xor_b32 v217, 0x10000, v217
    ds_read_b64_tr_b16 v[132:133], v217 offset:0
    buffer_load_dwordx4 a[56:59], v226, s[8:11], s36 offen offset:3072
    v_mfma_f32_16x16x32_bf16 v[12:15], v[164:167], v[124:127], v[12:15]
    ds_read_b64_tr_b16 v[134:135], v217 offset:2048
    s_waitcnt lgkmcnt(4)
    v_mfma_f32_16x16x32_bf16 v[16:19], v[168:171], v[120:123], v[16:19]
    v_xor_b32 v218, 0x10000, v218
    ds_read_b64_tr_b16 v[136:137], v218 offset:0
    v_mfma_f32_16x16x32_bf16 v[20:23], v[168:171], v[124:127], v[20:23]
    ds_read_b64_tr_b16 v[138:139], v218 offset:2048
    v_mfma_f32_16x16x32_bf16 v[24:27], v[172:175], v[120:123], v[24:27]
    v_xor_b32 v219, 0x10000, v219
    ds_read_b64_tr_b16 v[140:141], v219 offset:0
    buffer_load_dwordx4 a[60:63], v227, s[8:11], s36 offen offset:3072
    v_mfma_f32_16x16x32_bf16 v[28:31], v[172:175], v[124:127], v[28:31]
    ds_read_b64_tr_b16 v[142:143], v219 offset:2048
    s_waitcnt vmcnt(20) lgkmcnt(4)
    v_mfma_f32_16x16x32_bf16 v[0:3], v[128:131], a[0:3], v[0:3]
    ds_read_b64_tr_b16 v[160:161], v216 offset:8192
    v_mfma_f32_16x16x32_bf16 v[4:7], v[128:131], a[4:7], v[4:7]
    ds_read_b64_tr_b16 v[162:163], v216 offset:10240
    v_mfma_f32_16x16x32_bf16 v[8:11], v[132:135], a[0:3], v[8:11]
    ds_read_b64_tr_b16 v[164:165], v217 offset:8192
    buffer_load_dwordx2 v[192:193], v229, s[16:19], 0 offen offset:0
    v_mfma_f32_16x16x32_bf16 v[12:15], v[132:135], a[4:7], v[12:15]
    ds_read_b64_tr_b16 v[166:167], v217 offset:10240
    s_waitcnt lgkmcnt(4)
    v_mfma_f32_16x16x32_bf16 v[16:19], v[136:139], a[0:3], v[16:19]
    ds_read_b64_tr_b16 v[168:169], v218 offset:8192
    v_mfma_f32_16x16x32_bf16 v[20:23], v[136:139], a[4:7], v[20:23]
    ds_read_b64_tr_b16 v[170:171], v218 offset:10240
    v_mfma_f32_16x16x32_bf16 v[24:27], v[140:143], a[0:3], v[24:27]
    ds_read_b64_tr_b16 v[172:173], v219 offset:8192
    buffer_load_dwordx2 v[194:195], v229, s[16:19], 0 offen offset:32
    v_mfma_f32_16x16x32_bf16 v[28:31], v[140:143], a[4:7], v[28:31]
    ds_read_b64_tr_b16 v[174:175], v219 offset:10240
    s_waitcnt vmcnt(18) lgkmcnt(4)
    v_mfma_f32_16x16x32_bf16 v[0:3], v[160:163], a[8:11], v[0:3]
    ds_read_b64_tr_b16 v[128:129], v216 offset:16384
    v_mfma_f32_16x16x32_bf16 v[4:7], v[160:163], a[12:15], v[4:7]
    ds_read_b64_tr_b16 v[130:131], v216 offset:18432
    v_mfma_f32_16x16x32_bf16 v[8:11], v[164:167], a[8:11], v[8:11]
    ds_read_b64_tr_b16 v[132:133], v217 offset:16384
    buffer_load_dwordx2 v[196:197], v229, s[16:19], 0 offen offset:64
    v_mfma_f32_16x16x32_bf16 v[12:15], v[164:167], a[12:15], v[12:15]
    ds_read_b64_tr_b16 v[134:135], v217 offset:18432
    s_waitcnt lgkmcnt(4)
    v_mfma_f32_16x16x32_bf16 v[16:19], v[168:171], a[8:11], v[16:19]
    ds_read_b64_tr_b16 v[136:137], v218 offset:16384
    v_mfma_f32_16x16x32_bf16 v[20:23], v[168:171], a[12:15], v[20:23]
    ds_read_b64_tr_b16 v[138:139], v218 offset:18432
    v_mfma_f32_16x16x32_bf16 v[24:27], v[172:175], a[8:11], v[24:27]
    ds_read_b64_tr_b16 v[140:141], v219 offset:16384
    buffer_load_dwordx2 v[198:199], v229, s[16:19], 0 offen offset:96
    v_mfma_f32_16x16x32_bf16 v[28:31], v[172:175], a[12:15], v[28:31]
    ds_read_b64_tr_b16 v[142:143], v219 offset:18432
    s_waitcnt vmcnt(16) lgkmcnt(4)
    v_mfma_f32_16x16x32_bf16 v[0:3], v[128:131], a[16:19], v[0:3]
    ds_read_b64_tr_b16 v[160:161], v216 offset:24576
    v_mfma_f32_16x16x32_bf16 v[4:7], v[128:131], a[20:23], v[4:7]
    ds_read_b64_tr_b16 v[162:163], v216 offset:26624
    v_mfma_f32_16x16x32_bf16 v[8:11], v[132:135], a[16:19], v[8:11]
    ds_read_b64_tr_b16 v[164:165], v217 offset:24576
    buffer_load_dwordx2 v[200:201], v229, s[16:19], s54 offen offset:0
    v_mfma_f32_16x16x32_bf16 v[12:15], v[132:135], a[20:23], v[12:15]
    ds_read_b64_tr_b16 v[166:167], v217 offset:26624
    s_waitcnt lgkmcnt(4)
    v_mfma_f32_16x16x32_bf16 v[16:19], v[136:139], a[16:19], v[16:19]
    ds_read_b64_tr_b16 v[168:169], v218 offset:24576
    v_mfma_f32_16x16x32_bf16 v[20:23], v[136:139], a[20:23], v[20:23]
    ds_read_b64_tr_b16 v[170:171], v218 offset:26624
    v_mfma_f32_16x16x32_bf16 v[24:27], v[140:143], a[16:19], v[24:27]
    ds_read_b64_tr_b16 v[172:173], v219 offset:24576
    buffer_load_dwordx2 v[202:203], v229, s[16:19], s54 offen offset:32
    v_mfma_f32_16x16x32_bf16 v[28:31], v[140:143], a[20:23], v[28:31]
    ds_read_b64_tr_b16 v[174:175], v219 offset:26624
    s_waitcnt vmcnt(15)
    s_barrier
    s_waitcnt vmcnt(14) lgkmcnt(4)
    v_mfma_f32_16x16x32_bf16 v[0:3], v[160:163], a[24:27], v[0:3]
    ds_read_b64_tr_b16 v[128:129], v216 offset:32768
    v_mfma_f32_16x16x32_bf16 v[4:7], v[160:163], a[28:31], v[4:7]
    ds_read_b64_tr_b16 v[130:131], v216 offset:34816
    v_mfma_f32_16x16x32_bf16 v[8:11], v[164:167], a[24:27], v[8:11]
    ds_read_b64_tr_b16 v[132:133], v217 offset:32768
    buffer_load_dwordx2 v[204:205], v229, s[16:19], s54 offen offset:64
    v_mfma_f32_16x16x32_bf16 v[12:15], v[164:167], a[28:31], v[12:15]
    ds_read_b64_tr_b16 v[134:135], v217 offset:34816
    s_waitcnt lgkmcnt(4)
    v_mfma_f32_16x16x32_bf16 v[16:19], v[168:171], a[24:27], v[16:19]
    ds_read_b64_tr_b16 v[136:137], v218 offset:32768
    v_mfma_f32_16x16x32_bf16 v[20:23], v[168:171], a[28:31], v[20:23]
    ds_read_b64_tr_b16 v[138:139], v218 offset:34816
    v_mfma_f32_16x16x32_bf16 v[24:27], v[172:175], a[24:27], v[24:27]
    ds_read_b64_tr_b16 v[140:141], v219 offset:32768
    buffer_load_dwordx2 v[206:207], v229, s[16:19], s54 offen offset:96
    v_mfma_f32_16x16x32_bf16 v[28:31], v[172:175], a[28:31], v[28:31]
    ds_read_b64_tr_b16 v[142:143], v219 offset:34816
    s_waitcnt vmcnt(14) lgkmcnt(4)
    v_mfma_f32_16x16x32_bf16 v[0:3], v[128:131], a[32:35], v[0:3]
    ds_read_b64_tr_b16 v[160:161], v216 offset:40960
    v_mfma_f32_16x16x32_bf16 v[4:7], v[128:131], a[36:39], v[4:7]
    ds_read_b64_tr_b16 v[162:163], v216 offset:43008
    v_mfma_f32_16x16x32_bf16 v[8:11], v[132:135], a[32:35], v[8:11]
    ds_read_b64_tr_b16 v[164:165], v217 offset:40960
    buffer_load_dwordx2 v[208:209], v238, s[28:31], 0 offen offset:0
    v_mfma_f32_16x16x32_bf16 v[12:15], v[132:135], a[36:39], v[12:15]
    ds_read_b64_tr_b16 v[166:167], v217 offset:43008
    s_waitcnt lgkmcnt(4)
    v_mfma_f32_16x16x32_bf16 v[16:19], v[136:139], a[32:35], v[16:19]
    ds_read_b64_tr_b16 v[168:169], v218 offset:40960
    v_mfma_f32_16x16x32_bf16 v[20:23], v[136:139], a[36:39], v[20:23]
    ds_read_b64_tr_b16 v[170:171], v218 offset:43008
    v_mfma_f32_16x16x32_bf16 v[24:27], v[140:143], a[32:35], v[24:27]
    ds_read_b64_tr_b16 v[172:173], v219 offset:40960
    buffer_load_dwordx2 v[210:211], v238, s[28:31], 0 offen offset:32
    v_mfma_f32_16x16x32_bf16 v[28:31], v[140:143], a[36:39], v[28:31]
    ds_read_b64_tr_b16 v[174:175], v219 offset:43008
    s_waitcnt vmcnt(14) lgkmcnt(4)
    v_mfma_f32_16x16x32_bf16 v[0:3], v[160:163], a[40:43], v[0:3]
    ds_read_b64_tr_b16 v[128:129], v216 offset:49152
    v_mfma_f32_16x16x32_bf16 v[4:7], v[160:163], a[44:47], v[4:7]
    ds_read_b64_tr_b16 v[130:131], v216 offset:51200
    v_mfma_f32_16x16x32_bf16 v[8:11], v[164:167], a[40:43], v[8:11]
    ds_read_b64_tr_b16 v[132:133], v217 offset:49152
    buffer_load_dwordx2 v[212:213], v238, s[28:31], 0 offen offset:64
    v_mfma_f32_16x16x32_bf16 v[12:15], v[164:167], a[44:47], v[12:15]
    ds_read_b64_tr_b16 v[134:135], v217 offset:51200
    s_waitcnt lgkmcnt(4)
    v_mfma_f32_16x16x32_bf16 v[16:19], v[168:171], a[40:43], v[16:19]
    ds_read_b64_tr_b16 v[136:137], v218 offset:49152
    v_mfma_f32_16x16x32_bf16 v[20:23], v[168:171], a[44:47], v[20:23]
    ds_read_b64_tr_b16 v[138:139], v218 offset:51200
    v_mfma_f32_16x16x32_bf16 v[24:27], v[172:175], a[40:43], v[24:27]
    ds_read_b64_tr_b16 v[140:141], v219 offset:49152
    buffer_load_dwordx2 v[214:215], v238, s[28:31], 0 offen offset:96
    v_mfma_f32_16x16x32_bf16 v[28:31], v[172:175], a[44:47], v[28:31]
    ds_read_b64_tr_b16 v[142:143], v219 offset:51200
    s_waitcnt vmcnt(14) lgkmcnt(4)
    v_mfma_f32_16x16x32_bf16 v[0:3], v[128:131], a[48:51], v[0:3]
    ds_read_b64_tr_b16 v[160:161], v216 offset:57344
    v_mfma_f32_16x16x32_bf16 v[4:7], v[128:131], a[52:55], v[4:7]
    ds_read_b64_tr_b16 v[162:163], v216 offset:59392
    v_mfma_f32_16x16x32_bf16 v[8:11], v[132:135], a[48:51], v[8:11]
    ds_read_b64_tr_b16 v[164:165], v217 offset:57344
    v_mfma_f32_16x16x32_bf16 v[12:15], v[132:135], a[52:55], v[12:15]
    ds_read_b64_tr_b16 v[166:167], v217 offset:59392
    s_waitcnt lgkmcnt(4)
    v_mfma_f32_16x16x32_bf16 v[16:19], v[136:139], a[48:51], v[16:19]
    ds_read_b64_tr_b16 v[168:169], v218 offset:57344
    v_mfma_f32_16x16x32_bf16 v[20:23], v[136:139], a[52:55], v[20:23]
    ds_read_b64_tr_b16 v[170:171], v218 offset:59392
    v_mfma_f32_16x16x32_bf16 v[24:27], v[140:143], a[48:51], v[24:27]
    ds_read_b64_tr_b16 v[172:173], v219 offset:57344
    s_getpc_b64 s[40:41]
kb_pc1:
    s_add_u32 s40, s40, k4_kernel-kb_pc1
    s_addc_u32 s41, s41, 0
    v_mfma_f32_16x16x32_bf16 v[28:31], v[140:143], a[52:55], v[28:31]
    ds_read_b64_tr_b16 v[174:175], v219 offset:59392
    s_mov_b32 s42, code_end-k4_kernel
    s_mov_b32 s43, 0x00020000
    v_lshlrev_b32 v234, 7, v230
    s_waitcnt vmcnt(12) lgkmcnt(4)
    v_mfma_f32_16x16x32_bf16 v[0:3], v[160:163], a[56:59], v[0:3]
    ds_read_b64_tr_b16 v[144:145], v220 offset:0
    v_mfma_f32_16x16x32_bf16 v[4:7], v[160:163], a[60:63], v[4:7]
    ds_read_b64_tr_b16 v[146:147], v220 offset:2048
    buffer_load_dword v239, v234, s[40:43], 0 offen
    v_mfma_f32_16x16x32_bf16 v[8:11], v[164:167], a[56:59], v[8:11]
    ds_read_b64_tr_b16 v[148:149], v221 offset:0
    v_mfma_f32_16x16x32_bf16 v[12:15], v[164:167], a[60:63], v[12:15]
    ds_read_b64_tr_b16 v[150:151], v221 offset:2048
    s_waitcnt lgkmcnt(4)
    v_mfma_f32_16x16x32_bf16 v[16:19], v[168:171], a[56:59], v[16:19]
    ds_read_b64_tr_b16 v[152:153], v222 offset:0
    v_mfma_f32_16x16x32_bf16 v[20:23], v[168:171], a[60:63], v[20:23]
    ds_read_b64_tr_b16 v[154:155], v222 offset:2048
    v_mfma_f32_16x16x32_bf16 v[24:27], v[172:175], a[56:59], v[24:27]
    ds_read_b64_tr_b16 v[156:157], v223 offset:0
    v_mfma_f32_16x16x32_bf16 v[28:31], v[172:175], a[60:63], v[28:31]
    ds_read_b64_tr_b16 v[158:159], v223 offset:2048
    s_waitcnt lgkmcnt(4)
    v_mfma_f32_16x16x32_bf16 v[32:35], v[144:147], v[64:67], v[32:35]
    ds_read_b64_tr_b16 v[176:177], v220 offset:8192
    v_mfma_f32_16x16x32_bf16 v[36:39], v[144:147], v[68:71], v[36:39]
    ds_read_b64_tr_b16 v[178:179], v220 offset:10240
    v_mfma_f32_16x16x32_bf16 v[40:43], v[148:151], v[64:67], v[40:43]
    ds_read_b64_tr_b16 v[180:181], v221 offset:8192
    v_mfma_f32_16x16x32_bf16 v[44:47], v[148:151], v[68:71], v[44:47]
    ds_read_b64_tr_b16 v[182:183], v221 offset:10240
    s_waitcnt lgkmcnt(4)
    v_mfma_f32_16x16x32_bf16 v[48:51], v[152:155], v[64:67], v[48:51]
    ds_read_b64_tr_b16 v[184:185], v222 offset:8192
    v_mfma_f32_16x16x32_bf16 v[52:55], v[152:155], v[68:71], v[52:55]
    ds_read_b64_tr_b16 v[186:187], v222 offset:10240
    v_mfma_f32_16x16x32_bf16 v[56:59], v[156:159], v[64:67], v[56:59]
    ds_read_b64_tr_b16 v[188:189], v223 offset:8192
    v_mfma_f32_16x16x32_bf16 v[60:63], v[156:159], v[68:71], v[60:63]
    ds_read_b64_tr_b16 v[190:191], v223 offset:10240
    s_waitcnt lgkmcnt(4)
    v_mfma_f32_16x16x32_bf16 v[32:35], v[176:179], v[72:75], v[32:35]
    ds_read_b64_tr_b16 v[144:145], v220 offset:16384
    s_lshl_b32 s33, s39, 13
    v_mfma_f32_16x16x32_bf16 v[36:39], v[176:179], v[76:79], v[36:39]
    ds_read_b64_tr_b16 v[146:147], v220 offset:18432
    v_mfma_f32_16x16x32_bf16 v[40:43], v[180:183], v[72:75], v[40:43]
    ds_read_b64_tr_b16 v[148:149], v221 offset:16384
    v_cvt_pk_bf16_f32 v0, v0, v1
    v_mfma_f32_16x16x32_bf16 v[44:47], v[180:183], v[76:79], v[44:47]
    ds_read_b64_tr_b16 v[150:151], v221 offset:18432
    s_waitcnt lgkmcnt(4)
    v_mfma_f32_16x16x32_bf16 v[48:51], v[184:187], v[72:75], v[48:51]
    ds_read_b64_tr_b16 v[152:153], v222 offset:16384
    v_mfma_f32_16x16x32_bf16 v[52:55], v[184:187], v[76:79], v[52:55]
    ds_read_b64_tr_b16 v[154:155], v222 offset:18432
    v_cvt_pk_bf16_f32 v1, v2, v3
    v_mfma_f32_16x16x32_bf16 v[56:59], v[188:191], v[72:75], v[56:59]
    ds_read_b64_tr_b16 v[156:157], v223 offset:16384
    v_mfma_f32_16x16x32_bf16 v[60:63], v[188:191], v[76:79], v[60:63]
    ds_read_b64_tr_b16 v[158:159], v223 offset:18432
    s_waitcnt lgkmcnt(4)
    v_mfma_f32_16x16x32_bf16 v[32:35], v[144:147], v[80:83], v[32:35]
    ds_read_b64_tr_b16 v[176:177], v220 offset:24576
    v_cvt_pk_bf16_f32 v2, v4, v5
    v_mfma_f32_16x16x32_bf16 v[36:39], v[144:147], v[84:87], v[36:39]
    ds_read_b64_tr_b16 v[178:179], v220 offset:26624
    v_mfma_f32_16x16x32_bf16 v[40:43], v[148:151], v[80:83], v[40:43]
    ds_read_b64_tr_b16 v[180:181], v221 offset:24576
    v_cvt_pk_bf16_f32 v3, v6, v7
    v_mfma_f32_16x16x32_bf16 v[44:47], v[148:151], v[84:87], v[44:47]
    ds_read_b64_tr_b16 v[182:183], v221 offset:26624
    s_waitcnt lgkmcnt(4)
    v_mfma_f32_16x16x32_bf16 v[48:51], v[152:155], v[80:83], v[48:51]
    ds_read_b64_tr_b16 v[184:185], v222 offset:24576
    v_mfma_f32_16x16x32_bf16 v[52:55], v[152:155], v[84:87], v[52:55]
    ds_read_b64_tr_b16 v[186:187], v222 offset:26624
    buffer_store_dwordx4 v[0:3], v228, s[60:63], s33 offen offset:0 sc1
    v_mfma_f32_16x16x32_bf16 v[56:59], v[156:159], v[80:83], v[56:59]
    ds_read_b64_tr_b16 v[188:189], v223 offset:24576
    v_mfma_f32_16x16x32_bf16 v[60:63], v[156:159], v[84:87], v[60:63]
    ds_read_b64_tr_b16 v[190:191], v223 offset:26624
    s_waitcnt lgkmcnt(4)
    v_mfma_f32_16x16x32_bf16 v[32:35], v[176:179], v[88:91], v[32:35]
    ds_read_b64_tr_b16 v[144:145], v220 offset:32768
    v_cvt_pk_bf16_f32 v4, v8, v9
    v_mfma_f32_16x16x32_bf16 v[36:39], v[176:179], v[92:95], v[36:39]
    ds_read_b64_tr_b16 v[146:147], v220 offset:34816
    v_mfma_f32_16x16x32_bf16 v[40:43], v[180:183], v[88:91], v[40:43]
    ds_read_b64_tr_b16 v[148:149], v221 offset:32768
    v_cvt_pk_bf16_f32 v5, v10, v11
    v_mfma_f32_16x16x32_bf16 v[44:47], v[180:183], v[92:95], v[44:47]
    ds_read_b64_tr_b16 v[150:151], v221 offset:34816
    s_waitcnt lgkmcnt(4)
    v_mfma_f32_16x16x32_bf16 v[48:51], v[184:187], v[88:91], v[48:51]
    ds_read_b64_tr_b16 v[152:153], v222 offset:32768
    v_mfma_f32_16x16x32_bf16 v[52:55], v[184:187], v[92:95], v[52:55]
    ds_read_b64_tr_b16 v[154:155], v222 offset:34816
    v_cvt_pk_bf16_f32 v6, v12, v13
    v_mfma_f32_16x16x32_bf16 v[56:59], v[188:191], v[88:91], v[56:59]
    ds_read_b64_tr_b16 v[156:157], v223 offset:32768
    v_mfma_f32_16x16x32_bf16 v[60:63], v[188:191], v[92:95], v[60:63]
    ds_read_b64_tr_b16 v[158:159], v223 offset:34816
    s_waitcnt lgkmcnt(4)
    v_mfma_f32_16x16x32_bf16 v[32:35], v[144:147], v[96:99], v[32:35]
    ds_read_b64_tr_b16 v[176:177], v220 offset:40960
    v_cvt_pk_bf16_f32 v7, v14, v15
    v_mfma_f32_16x16x32_bf16 v[36:39], v[144:147], v[100:103], v[36:39]
    ds_read_b64_tr_b16 v[178:179], v220 offset:43008
    v_mfma_f32_16x16x32_bf16 v[40:43], v[148:151], v[96:99], v[40:43]
    ds_read_b64_tr_b16 v[180:181], v221 offset:40960
    buffer_store_dwordx4 v[4:7], v228, s[60:63], s33 offen offset:1024 sc1
    v_mfma_f32_16x16x32_bf16 v[44:47], v[148:151], v[100:103], v[44:47]
    ds_read_b64_tr_b16 v[182:183], v221 offset:43008
    s_waitcnt lgkmcnt(4)
    v_mfma_f32_16x16x32_bf16 v[48:51], v[152:155], v[96:99], v[48:51]
    ds_read_b64_tr_b16 v[184:185], v222 offset:40960
    v_mfma_f32_16x16x32_bf16 v[52:55], v[152:155], v[100:103], v[52:55]
    ds_read_b64_tr_b16 v[186:187], v222 offset:43008
    v_cvt_pk_bf16_f32 v8, v16, v17
    v_mfma_f32_16x16x32_bf16 v[56:59], v[156:159], v[96:99], v[56:59]
    ds_read_b64_tr_b16 v[188:189], v223 offset:40960
    v_mfma_f32_16x16x32_bf16 v[60:63], v[156:159], v[100:103], v[60:63]
    ds_read_b64_tr_b16 v[190:191], v223 offset:43008
    s_waitcnt lgkmcnt(4)
    v_mfma_f32_16x16x32_bf16 v[32:35], v[176:179], v[104:107], v[32:35]
    ds_read_b64_tr_b16 v[144:145], v220 offset:49152
    v_cvt_pk_bf16_f32 v9, v18, v19
    v_mfma_f32_16x16x32_bf16 v[36:39], v[176:179], v[108:111], v[36:39]
    ds_read_b64_tr_b16 v[146:147], v220 offset:51200
    v_mfma_f32_16x16x32_bf16 v[40:43], v[180:183], v[104:107], v[40:43]
    ds_read_b64_tr_b16 v[148:149], v221 offset:49152
    v_cvt_pk_bf16_f32 v10, v20, v21
    v_mfma_f32_16x16x32_bf16 v[44:47], v[180:183], v[108:111], v[44:47]
    ds_read_b64_tr_b16 v[150:151], v221 offset:51200
    s_waitcnt lgkmcnt(4)
    v_mfma_f32_16x16x32_bf16 v[48:51], v[184:187], v[104:107], v[48:51]
    ds_read_b64_tr_b16 v[152:153], v222 offset:49152
    v_mfma_f32_16x16x32_bf16 v[52:55], v[184:187], v[108:111], v[52:55]
    ds_read_b64_tr_b16 v[154:155], v222 offset:51200
    v_cvt_pk_bf16_f32 v11, v22, v23
    v_mfma_f32_16x16x32_bf16 v[56:59], v[188:191], v[104:107], v[56:59]
    ds_read_b64_tr_b16 v[156:157], v223 offset:49152
    v_mfma_f32_16x16x32_bf16 v[60:63], v[188:191], v[108:111], v[60:63]
    ds_read_b64_tr_b16 v[158:159], v223 offset:51200
    s_waitcnt lgkmcnt(4)
    v_mfma_f32_16x16x32_bf16 v[32:35], v[144:147], v[112:115], v[32:35]
    ds_read_b64_tr_b16 v[176:177], v220 offset:57344
    buffer_store_dwordx4 v[8:11], v228, s[60:63], s33 offen offset:2048 sc1
    v_mfma_f32_16x16x32_bf16 v[36:39], v[144:147], v[116:119], v[36:39]
    ds_read_b64_tr_b16 v[178:179], v220 offset:59392
    v_mfma_f32_16x16x32_bf16 v[40:43], v[148:151], v[112:115], v[40:43]
    ds_read_b64_tr_b16 v[180:181], v221 offset:57344
    v_cvt_pk_bf16_f32 v12, v24, v25
    v_mfma_f32_16x16x32_bf16 v[44:47], v[148:151], v[116:119], v[44:47]
    ds_read_b64_tr_b16 v[182:183], v221 offset:59392
    s_waitcnt lgkmcnt(4)
    v_mfma_f32_16x16x32_bf16 v[48:51], v[152:155], v[112:115], v[48:51]
    ds_read_b64_tr_b16 v[184:185], v222 offset:57344
    v_mfma_f32_16x16x32_bf16 v[52:55], v[152:155], v[116:119], v[52:55]
    ds_read_b64_tr_b16 v[186:187], v222 offset:59392
    v_cvt_pk_bf16_f32 v13, v26, v27
    v_mfma_f32_16x16x32_bf16 v[56:59], v[156:159], v[112:115], v[56:59]
    ds_read_b64_tr_b16 v[188:189], v223 offset:57344
    v_mfma_f32_16x16x32_bf16 v[60:63], v[156:159], v[116:119], v[60:63]
    ds_read_b64_tr_b16 v[190:191], v223 offset:59392
    s_waitcnt lgkmcnt(4)
    v_mfma_f32_16x16x32_bf16 v[32:35], v[176:179], v[120:123], v[32:35]
    v_xor_b32 v220, 0x10000, v220
    ds_read_b64_tr_b16 v[144:145], v220 offset:0
    v_cvt_pk_bf16_f32 v14, v28, v29
    v_mfma_f32_16x16x32_bf16 v[36:39], v[176:179], v[124:127], v[36:39]
    ds_read_b64_tr_b16 v[146:147], v220 offset:2048
    v_mfma_f32_16x16x32_bf16 v[40:43], v[180:183], v[120:123], v[40:43]
    v_xor_b32 v221, 0x10000, v221
    ds_read_b64_tr_b16 v[148:149], v221 offset:0
    v_cvt_pk_bf16_f32 v15, v30, v31
    v_mfma_f32_16x16x32_bf16 v[44:47], v[180:183], v[124:127], v[44:47]
    ds_read_b64_tr_b16 v[150:151], v221 offset:2048
    s_waitcnt lgkmcnt(4)
    v_mfma_f32_16x16x32_bf16 v[48:51], v[184:187], v[120:123], v[48:51]
    v_xor_b32 v222, 0x10000, v222
    ds_read_b64_tr_b16 v[152:153], v222 offset:0
    v_mfma_f32_16x16x32_bf16 v[52:55], v[184:187], v[124:127], v[52:55]
    ds_read_b64_tr_b16 v[154:155], v222 offset:2048
    buffer_store_dwordx4 v[12:15], v228, s[60:63], s33 offen offset:3072 sc1
    v_mfma_f32_16x16x32_bf16 v[56:59], v[188:191], v[120:123], v[56:59]
    v_xor_b32 v223, 0x10000, v223
    ds_read_b64_tr_b16 v[156:157], v223 offset:0
    v_mfma_f32_16x16x32_bf16 v[60:63], v[188:191], v[124:127], v[60:63]
    ds_read_b64_tr_b16 v[158:159], v223 offset:2048
    s_waitcnt lgkmcnt(4)
    v_mfma_f32_16x16x32_bf16 v[32:35], v[144:147], a[0:3], v[32:35]
    ds_read_b64_tr_b16 v[176:177], v220 offset:8192
    v_mfma_f32_16x16x32_bf16 v[36:39], v[144:147], a[4:7], v[36:39]
    ds_read_b64_tr_b16 v[178:179], v220 offset:10240
    v_mfma_f32_16x16x32_bf16 v[40:43], v[148:151], a[0:3], v[40:43]
    ds_read_b64_tr_b16 v[180:181], v221 offset:8192
    v_mfma_f32_16x16x32_bf16 v[44:47], v[148:151], a[4:7], v[44:47]
    ds_read_b64_tr_b16 v[182:183], v221 offset:10240
    s_waitcnt lgkmcnt(4)
    v_mfma_f32_16x16x32_bf16 v[48:51], v[152:155], a[0:3], v[48:51]
    ds_read_b64_tr_b16 v[184:185], v222 offset:8192
    v_mfma_f32_16x16x32_bf16 v[52:55], v[152:155], a[4:7], v[52:55]
    ds_read_b64_tr_b16 v[186:187], v222 offset:10240
    v_mfma_f32_16x16x32_bf16 v[56:59], v[156:159], a[0:3], v[56:59]
    ds_read_b64_tr_b16 v[188:189], v223 offset:8192
    v_mfma_f32_16x16x32_bf16 v[60:63], v[156:159], a[4:7], v[60:63]
    ds_read_b64_tr_b16 v[190:191], v223 offset:10240
    s_waitcnt lgkmcnt(4)
    v_mfma_f32_16x16x32_bf16 v[32:35], v[176:179], a[8:11], v[32:35]
    ds_read_b64_tr_b16 v[144:145], v220 offset:16384
    v_mfma_f32_16x16x32_bf16 v[36:39], v[176:179], a[12:15], v[36:39]
    ds_read_b64_tr_b16 v[146:147], v220 offset:18432
    v_mfma_f32_16x16x32_bf16 v[40:43], v[180:183], a[8:11], v[40:43]
    ds_read_b64_tr_b16 v[148:149], v221 offset:16384
    v_mfma_f32_16x16x32_bf16 v[44:47], v[180:183], a[12:15], v[44:47]
    ds_read_b64_tr_b16 v[150:151], v221 offset:18432
    s_waitcnt lgkmcnt(4)
    v_mfma_f32_16x16x32_bf16 v[48:51], v[184:187], a[8:11], v[48:51]
    ds_read_b64_tr_b16 v[152:153], v222 offset:16384
    v_mfma_f32_16x16x32_bf16 v[52:55], v[184:187], a[12:15], v[52:55]
    ds_read_b64_tr_b16 v[154:155], v222 offset:18432
    v_mfma_f32_16x16x32_bf16 v[56:59], v[188:191], a[8:11], v[56:59]
    ds_read_b64_tr_b16 v[156:157], v223 offset:16384
    v_mfma_f32_16x16x32_bf16 v[60:63], v[188:191], a[12:15], v[60:63]
    ds_read_b64_tr_b16 v[158:159], v223 offset:18432
    s_waitcnt lgkmcnt(4)
    v_mfma_f32_16x16x32_bf16 v[32:35], v[144:147], a[16:19], v[32:35]
    ds_read_b64_tr_b16 v[176:177], v220 offset:24576
    v_mfma_f32_16x16x32_bf16 v[36:39], v[144:147], a[20:23], v[36:39]
    ds_read_b64_tr_b16 v[178:179], v220 offset:26624
    v_mfma_f32_16x16x32_bf16 v[40:43], v[148:151], a[16:19], v[40:43]
    ds_read_b64_tr_b16 v[180:181], v221 offset:24576
    v_mfma_f32_16x16x32_bf16 v[44:47], v[148:151], a[20:23], v[44:47]
    ds_read_b64_tr_b16 v[182:183], v221 offset:26624
    s_waitcnt lgkmcnt(4)
    v_mfma_f32_16x16x32_bf16 v[48:51], v[152:155], a[16:19], v[48:51]
    ds_read_b64_tr_b16 v[184:185], v222 offset:24576
    v_mfma_f32_16x16x32_bf16 v[52:55], v[152:155], a[20:23], v[52:55]
    ds_read_b64_tr_b16 v[186:187], v222 offset:26624
    v_mfma_f32_16x16x32_bf16 v[56:59], v[156:159], a[16:19], v[56:59]
    ds_read_b64_tr_b16 v[188:189], v223 offset:24576
    v_mfma_f32_16x16x32_bf16 v[60:63], v[156:159], a[20:23], v[60:63]
    ds_read_b64_tr_b16 v[190:191], v223 offset:26624
    s_waitcnt lgkmcnt(4)
    v_mfma_f32_16x16x32_bf16 v[32:35], v[176:179], a[24:27], v[32:35]
    ds_read_b64_tr_b16 v[144:145], v220 offset:32768
    v_mfma_f32_16x16x32_bf16 v[36:39], v[176:179], a[28:31], v[36:39]
    ds_read_b64_tr_b16 v[146:147], v220 offset:34816
    v_mfma_f32_16x16x32_bf16 v[40:43], v[180:183], a[24:27], v[40:43]
    ds_read_b64_tr_b16 v[148:149], v221 offset:32768
    v_mfma_f32_16x16x32_bf16 v[44:47], v[180:183], a[28:31], v[44:47]
    ds_read_b64_tr_b16 v[150:151], v221 offset:34816
    s_waitcnt lgkmcnt(4)
    v_mfma_f32_16x16x32_bf16 v[48:51], v[184:187], a[24:27], v[48:51]
    ds_read_b64_tr_b16 v[152:153], v222 offset:32768
    v_mfma_f32_16x16x32_bf16 v[52:55], v[184:187], a[28:31], v[52:55]
    ds_read_b64_tr_b16 v[154:155], v222 offset:34816
    v_mfma_f32_16x16x32_bf16 v[56:59], v[188:191], a[24:27], v[56:59]
    ds_read_b64_tr_b16 v[156:157], v223 offset:32768
    v_mfma_f32_16x16x32_bf16 v[60:63], v[188:191], a[28:31], v[60:63]
    ds_read_b64_tr_b16 v[158:159], v223 offset:34816
    s_waitcnt lgkmcnt(4)
    v_mfma_f32_16x16x32_bf16 v[32:35], v[144:147], a[32:35], v[32:35]
    ds_read_b64_tr_b16 v[176:177], v220 offset:40960
    v_mfma_f32_16x16x32_bf16 v[36:39], v[144:147], a[36:39], v[36:39]
    ds_read_b64_tr_b16 v[178:179], v220 offset:43008
    v_mfma_f32_16x16x32_bf16 v[40:43], v[148:151], a[32:35], v[40:43]
    ds_read_b64_tr_b16 v[180:181], v221 offset:40960
    v_mfma_f32_16x16x32_bf16 v[44:47], v[148:151], a[36:39], v[44:47]
    ds_read_b64_tr_b16 v[182:183], v221 offset:43008
    s_waitcnt lgkmcnt(4)
    v_mfma_f32_16x16x32_bf16 v[48:51], v[152:155], a[32:35], v[48:51]
    ds_read_b64_tr_b16 v[184:185], v222 offset:40960
    v_mfma_f32_16x16x32_bf16 v[52:55], v[152:155], a[36:39], v[52:55]
    ds_read_b64_tr_b16 v[186:187], v222 offset:43008
    v_mfma_f32_16x16x32_bf16 v[56:59], v[156:159], a[32:35], v[56:59]
    ds_read_b64_tr_b16 v[188:189], v223 offset:40960
    v_mfma_f32_16x16x32_bf16 v[60:63], v[156:159], a[36:39], v[60:63]
    ds_read_b64_tr_b16 v[190:191], v223 offset:43008
    s_waitcnt lgkmcnt(4)
    v_mfma_f32_16x16x32_bf16 v[32:35], v[176:179], a[40:43], v[32:35]
    ds_read_b64_tr_b16 v[144:145], v220 offset:49152
    v_mfma_f32_16x16x32_bf16 v[36:39], v[176:179], a[44:47], v[36:39]
    ds_read_b64_tr_b16 v[146:147], v220 offset:51200
    v_mfma_f32_16x16x32_bf16 v[40:43], v[180:183], a[40:43], v[40:43]
    ds_read_b64_tr_b16 v[148:149], v221 offset:49152
    v_mfma_f32_16x16x32_bf16 v[44:47], v[180:183], a[44:47], v[44:47]
    ds_read_b64_tr_b16 v[150:151], v221 offset:51200
    s_waitcnt lgkmcnt(4)
    v_mfma_f32_16x16x32_bf16 v[48:51], v[184:187], a[40:43], v[48:51]
    ds_read_b64_tr_b16 v[152:153], v222 offset:49152
    v_mfma_f32_16x16x32_bf16 v[52:55], v[184:187], a[44:47], v[52:55]
    ds_read_b64_tr_b16 v[154:155], v222 offset:51200
    v_mfma_f32_16x16x32_bf16 v[56:59], v[188:191], a[40:43], v[56:59]
    ds_read_b64_tr_b16 v[156:157], v223 offset:49152
    v_mfma_f32_16x16x32_bf16 v[60:63], v[188:191], a[44:47], v[60:63]
    ds_read_b64_tr_b16 v[158:159], v223 offset:51200
    s_waitcnt lgkmcnt(4)
    v_mfma_f32_16x16x32_bf16 v[32:35], v[144:147], a[48:51], v[32:35]
    ds_read_b64_tr_b16 v[176:177], v220 offset:57344
    s_waitcnt vmcnt(0)
    s_lshl_b32 s39, s39, 7
    buffer_store_dword v233, off, s[56:59], s39 sc1
    v_mfma_f32_16x16x32_bf16 v[36:39], v[144:147], a[52:55], v[36:39]
    ds_read_b64_tr_b16 v[178:179], v220 offset:59392
    v_mfma_f32_16x16x32_bf16 v[40:43], v[148:151], a[48:51], v[40:43]
    ds_read_b64_tr_b16 v[180:181], v221 offset:57344
    v_mfma_f32_16x16x32_bf16 v[44:47], v[148:151], a[52:55], v[44:47]
    ds_read_b64_tr_b16 v[182:183], v221 offset:59392
    s_waitcnt lgkmcnt(4)
    v_mfma_f32_16x16x32_bf16 v[48:51], v[152:155], a[48:51], v[48:51]
    ds_read_b64_tr_b16 v[184:185], v222 offset:57344
    v_mfma_f32_16x16x32_bf16 v[52:55], v[152:155], a[52:55], v[52:55]
    ds_read_b64_tr_b16 v[186:187], v222 offset:59392
    v_mfma_f32_16x16x32_bf16 v[56:59], v[156:159], a[48:51], v[56:59]
    ds_read_b64_tr_b16 v[188:189], v223 offset:57344
    v_mfma_f32_16x16x32_bf16 v[60:63], v[156:159], a[52:55], v[60:63]
    ds_read_b64_tr_b16 v[190:191], v223 offset:59392
    s_waitcnt lgkmcnt(4)
    v_mfma_f32_16x16x32_bf16 v[32:35], v[176:179], a[56:59], v[32:35]
    v_mfma_f32_16x16x32_bf16 v[36:39], v[176:179], a[60:63], v[36:39]
    v_mfma_f32_16x16x32_bf16 v[40:43], v[180:183], a[56:59], v[40:43]
    v_mfma_f32_16x16x32_bf16 v[44:47], v[180:183], a[60:63], v[44:47]
    s_waitcnt lgkmcnt(0)
    v_mfma_f32_16x16x32_bf16 v[48:51], v[184:187], a[56:59], v[48:51]
    v_mfma_f32_16x16x32_bf16 v[52:55], v[184:187], a[60:63], v[52:55]
    v_mfma_f32_16x16x32_bf16 v[56:59], v[188:191], a[56:59], v[56:59]
    v_mfma_f32_16x16x32_bf16 v[60:63], v[188:191], a[60:63], v[60:63]
    s_lshl_b32 s32, s7, 7
    s_mov_b32 s34, 0x400000
    s_branch kb_spin1
kb_spin:
    s_sleep 4
kb_spin1:
    buffer_load_dword v235, off, s[56:59], s32 sc1
    s_waitcnt vmcnt(0)
    v_readfirstlane_b32 s33, v235
    s_sub_u32 s34, s34, 1
    s_cbranch_scc1 kb_go
    s_cmp_eq_u32 s33, 1
    s_cbranch_scc0 kb_spin
kb_go:
    s_lshl_b32 s7, s7, 13
    buffer_load_dwordx4 v[96:99], v228, s[60:63], s7 offen offset:0 sc1
    buffer_load_dwordx4 v[100:103], v228, s[60:63], s7 offen offset:1024 sc1
    buffer_load_dwordx4 v[104:107], v228, s[60:63], s7 offen offset:2048 sc1
    buffer_load_dwordx4 v[108:111], v228, s[60:63], s7 offen offset:3072 sc1
    v_lshlrev_b32 v128, 16, v192
    v_and_b32 v129, 0xffff0000, v192
    v_lshlrev_b32 v130, 16, v193
    v_and_b32 v131, 0xffff0000, v193
    v_lshlrev_b32 v132, 16, v194
    v_and_b32 v133, 0xffff0000, v194
    v_lshlrev_b32 v134, 16, v195
    v_and_b32 v135, 0xffff0000, v195
    v_lshlrev_b32 v136, 16, v196
    v_and_b32 v137, 0xffff0000, v196
    v_lshlrev_b32 v138, 16, v197
    v_and_b32 v139, 0xffff0000, v197
    v_lshlrev_b32 v140, 16, v198
    v_and_b32 v141, 0xffff0000, v198
    v_lshlrev_b32 v142, 16, v199
    v_and_b32 v143, 0xffff0000, v199
    v_lshlrev_b32 v160, 16, v200
    v_and_b32 v161, 0xffff0000, v200
    v_lshlrev_b32 v162, 16, v201
    v_and_b32 v163, 0xffff0000, v201
    v_lshlrev_b32 v164, 16, v202
    v_and_b32 v165, 0xffff0000, v202
    v_lshlrev_b32 v166, 16, v203
    v_and_b32 v167, 0xffff0000, v203
    v_lshlrev_b32 v168, 16, v204
    v_and_b32 v169, 0xffff0000, v204
    v_lshlrev_b32 v170, 16, v205
    v_and_b32 v171, 0xffff0000, v205
    v_lshlrev_b32 v172, 16, v206
    v_and_b32 v173, 0xffff0000, v206
    v_lshlrev_b32 v174, 16, v207
    v_and_b32 v175, 0xffff0000, v207
    v_lshlrev_b32 v240, 16, v208
    v_and_b32 v241, 0xffff0000, v208
    v_lshlrev_b32 v242, 16, v209
    v_and_b32 v243, 0xffff0000, v209
    v_lshlrev_b32 v244, 16, v210
    v_and_b32 v245, 0xffff0000, v210
    v_lshlrev_b32 v246, 16, v211
    v_and_b32 v247, 0xffff0000, v211
    v_lshlrev_b32 v248, 16, v212
    v_and_b32 v249, 0xffff0000, v212
    v_lshlrev_b32 v250, 16, v213
    v_and_b32 v251, 0xffff0000, v213
    v_lshlrev_b32 v252, 16, v214
    v_and_b32 v253, 0xffff0000, v214
    v_lshlrev_b32 v254, 16, v215
    v_and_b32 v255, 0xffff0000, v215
    v_add_f32 v192, v240, v241
    v_add_f32 v192, v192, v242
    v_add_f32 v192, v192, v243
    v_add_f32 v192, v192, v244
    v_add_f32 v192, v192, v245
    v_add_f32 v192, v192, v246
    v_add_f32 v192, v192, v247
    v_add_f32 v192, v192, v248
    v_add_f32 v192, v192, v249
    v_add_f32 v192, v192, v250
    v_add_f32 v192, v192, v251
    v_add_f32 v192, v192, v252
    v_add_f32 v192, v192, v253
    v_add_f32 v192, v192, v254
    v_add_f32 v192, v192, v255
    s_waitcnt vmcnt(3)
    v_lshlrev_b32 v64, 16, v96
    v_and_b32 v65, 0xffff0000, v96
    v_lshlrev_b32 v66, 16, v97
    v_and_b32 v67, 0xffff0000, v97
    v_pk_add_f32 v[32:33], v[32:33], v[64:65]
    v_pk_add_f32 v[34:35], v[34:35], v[66:67]
    v_cvt_pk_bf16_f32 v33, v32, v33
    v_lshlrev_b32 v32, 16, v33
    v_and_b32 v33, 0xffff0000, v33
    v_pk_add_f32 v[32:33], v[32:33], v[128:129]
    v_cvt_pk_bf16_f32 v0, v32, v33
    v_lshlrev_b32 v32, 16, v0
    v_and_b32 v33, 0xffff0000, v0
    v_add_f32 v16, v32, v33
    v_mul_f32 v17, v32, v32
    v_mul_f32 v18, v32, v240
    v_fmac_f32 v17, v33, v33
    v_fmac_f32 v18, v33, v241
    v_cvt_pk_bf16_f32 v35, v34, v35
    v_lshlrev_b32 v34, 16, v35
    v_and_b32 v35, 0xffff0000, v35
    v_pk_add_f32 v[34:35], v[34:35], v[130:131]
    v_cvt_pk_bf16_f32 v1, v34, v35
    v_lshlrev_b32 v34, 16, v1
    v_and_b32 v35, 0xffff0000, v1
    v_add_f32 v16, v16, v34
    v_add_f32 v16, v16, v35
    v_fmac_f32 v17, v34, v34
    v_fmac_f32 v18, v34, v242
    v_fmac_f32 v17, v35, v35
    v_fmac_f32 v18, v35, v243
    buffer_store_dwordx2 v[0:1], v229, s[20:23], 0 offen offset:0
    s_waitcnt vmcnt(4)
    v_lshlrev_b32 v68, 16, v98
    v_and_b32 v69, 0xffff0000, v98
    v_lshlrev_b32 v70, 16, v99
    v_and_b32 v71, 0xffff0000, v99
    v_pk_add_f32 v[36:37], v[36:37], v[68:69]
    v_pk_add_f32 v[38:39], v[38:39], v[70:71]
    v_cvt_pk_bf16_f32 v37, v36, v37
    v_lshlrev_b32 v36, 16, v37
    v_and_b32 v37, 0xffff0000, v37
    v_pk_add_f32 v[36:37], v[36:37], v[160:161]
    v_cvt_pk_bf16_f32 v8, v36, v37
    v_lshlrev_b32 v36, 16, v8
    v_and_b32 v37, 0xffff0000, v8
    v_add_f32 v19, v36, v37
    v_mul_f32 v20, v36, v36
    v_mul_f32 v21, v36, v240
    v_fmac_f32 v20, v37, v37
    v_fmac_f32 v21, v37, v241
    v_cvt_pk_bf16_f32 v39, v38, v39
    v_lshlrev_b32 v38, 16, v39
    v_and_b32 v39, 0xffff0000, v39
    v_pk_add_f32 v[38:39], v[38:39], v[162:163]
    v_cvt_pk_bf16_f32 v9, v38, v39
    v_lshlrev_b32 v38, 16, v9
    v_and_b32 v39, 0xffff0000, v9
    v_add_f32 v19, v19, v38
    v_add_f32 v19, v19, v39
    v_fmac_f32 v20, v38, v38
    v_fmac_f32 v21, v38, v242
    v_fmac_f32 v20, v39, v39
    v_fmac_f32 v21, v39, v243
    buffer_store_dwordx2 v[8:9], v229, s[20:23], s54 offen offset:0
    s_waitcnt vmcnt(4)
    v_lshlrev_b32 v72, 16, v100
    v_and_b32 v73, 0xffff0000, v100
    v_lshlrev_b32 v74, 16, v101
    v_and_b32 v75, 0xffff0000, v101
    v_pk_add_f32 v[40:41], v[40:41], v[72:73]
    v_pk_add_f32 v[42:43], v[42:43], v[74:75]
    v_cvt_pk_bf16_f32 v41, v40, v41
    v_lshlrev_b32 v40, 16, v41
    v_and_b32 v41, 0xffff0000, v41
    v_pk_add_f32 v[40:41], v[40:41], v[132:133]
    v_cvt_pk_bf16_f32 v2, v40, v41
    v_lshlrev_b32 v40, 16, v2
    v_and_b32 v41, 0xffff0000, v2
    v_add_f32 v16, v16, v40
    v_add_f32 v16, v16, v41
    v_fmac_f32 v17, v40, v40
    v_fmac_f32 v18, v40, v244
    v_fmac_f32 v17, v41, v41
    v_fmac_f32 v18, v41, v245
    v_cvt_pk_bf16_f32 v43, v42, v43
    v_lshlrev_b32 v42, 16, v43
    v_and_b32 v43, 0xffff0000, v43
    v_pk_add_f32 v[42:43], v[42:43], v[134:135]
    v_cvt_pk_bf16_f32 v3, v42, v43
    v_lshlrev_b32 v42, 16, v3
    v_and_b32 v43, 0xffff0000, v3
    v_add_f32 v16, v16, v42
    v_add_f32 v16, v16, v43
    v_fmac_f32 v17, v42, v42
    v_fmac_f32 v18, v42, v246
    v_fmac_f32 v17, v43, v43
    v_fmac_f32 v18, v43, v247
    buffer_store_dwordx2 v[2:3], v229, s[20:23], 0 offen offset:32
    s_waitcnt vmcnt(5)
    v_lshlrev_b32 v76, 16, v102
    v_and_b32 v77, 0xffff0000, v102
    v_lshlrev_b32 v78, 16, v103
    v_and_b32 v79, 0xffff0000, v103
    v_pk_add_f32 v[44:45], v[44:45], v[76:77]
    v_pk_add_f32 v[46:47], v[46:47], v[78:79]
    v_cvt_pk_bf16_f32 v45, v44, v45
    v_lshlrev_b32 v44, 16, v45
    v_and_b32 v45, 0xffff0000, v45
    v_pk_add_f32 v[44:45], v[44:45], v[164:165]
    v_cvt_pk_bf16_f32 v10, v44, v45
    v_lshlrev_b32 v44, 16, v10
    v_and_b32 v45, 0xffff0000, v10
    v_add_f32 v19, v19, v44
    v_add_f32 v19, v19, v45
    v_fmac_f32 v20, v44, v44
    v_fmac_f32 v21, v44, v244
    v_fmac_f32 v20, v45, v45
    v_fmac_f32 v21, v45, v245
    v_cvt_pk_bf16_f32 v47, v46, v47
    v_lshlrev_b32 v46, 16, v47
    v_and_b32 v47, 0xffff0000, v47
    v_pk_add_f32 v[46:47], v[46:47], v[166:167]
    v_cvt_pk_bf16_f32 v11, v46, v47
    v_lshlrev_b32 v46, 16, v11
    v_and_b32 v47, 0xffff0000, v11
    v_add_f32 v19, v19, v46
    v_add_f32 v19, v19, v47
    v_fmac_f32 v20, v46, v46
    v_fmac_f32 v21, v46, v246
    v_fmac_f32 v20, v47, v47
    v_fmac_f32 v21, v47, v247
    buffer_store_dwordx2 v[10:11], v229, s[20:23], s54 offen offset:32
    s_waitcnt vmcnt(5)
    v_lshlrev_b32 v80, 16, v104
    v_and_b32 v81, 0xffff0000, v104
    v_lshlrev_b32 v82, 16, v105
    v_and_b32 v83, 0xffff0000, v105
    v_pk_add_f32 v[48:49], v[48:49], v[80:81]
    v_pk_add_f32 v[50:51], v[50:51], v[82:83]
    v_cvt_pk_bf16_f32 v49, v48, v49
    v_lshlrev_b32 v48, 16, v49
    v_and_b32 v49, 0xffff0000, v49
    v_pk_add_f32 v[48:49], v[48:49], v[136:137]
    v_cvt_pk_bf16_f32 v4, v48, v49
    v_lshlrev_b32 v48, 16, v4
    v_and_b32 v49, 0xffff0000, v4
    v_add_f32 v16, v16, v48
    v_add_f32 v16, v16, v49
    v_fmac_f32 v17, v48, v48
    v_fmac_f32 v18, v48, v248
    v_fmac_f32 v17, v49, v49
    v_fmac_f32 v18, v49, v249
    v_cvt_pk_bf16_f32 v51, v50, v51
    v_lshlrev_b32 v50, 16, v51
    v_and_b32 v51, 0xffff0000, v51
    v_pk_add_f32 v[50:51], v[50:51], v[138:139]
    v_cvt_pk_bf16_f32 v5, v50, v51
    v_lshlrev_b32 v50, 16, v5
    v_and_b32 v51, 0xffff0000, v5
    v_add_f32 v16, v16, v50
    v_add_f32 v16, v16, v51
    v_fmac_f32 v17, v50, v50
    v_fmac_f32 v18, v50, v250
    v_fmac_f32 v17, v51, v51
    v_fmac_f32 v18, v51, v251
    buffer_store_dwordx2 v[4:5], v229, s[20:23], 0 offen offset:64
    s_waitcnt vmcnt(6)
    v_lshlrev_b32 v84, 16, v106
    v_and_b32 v85, 0xffff0000, v106
    v_lshlrev_b32 v86, 16, v107
    v_and_b32 v87, 0xffff0000, v107
    v_pk_add_f32 v[52:53], v[52:53], v[84:85]
    v_pk_add_f32 v[54:55], v[54:55], v[86:87]
    v_cvt_pk_bf16_f32 v53, v52, v53
    v_lshlrev_b32 v52, 16, v53
    v_and_b32 v53, 0xffff0000, v53
    v_pk_add_f32 v[52:53], v[52:53], v[168:169]
    v_cvt_pk_bf16_f32 v12, v52, v53
    v_lshlrev_b32 v52, 16, v12
    v_and_b32 v53, 0xffff0000, v12
    v_add_f32 v19, v19, v52
    v_add_f32 v19, v19, v53
    v_fmac_f32 v20, v52, v52
    v_fmac_f32 v21, v52, v248
    v_fmac_f32 v20, v53, v53
    v_fmac_f32 v21, v53, v249
    v_cvt_pk_bf16_f32 v55, v54, v55
    v_lshlrev_b32 v54, 16, v55
    v_and_b32 v55, 0xffff0000, v55
    v_pk_add_f32 v[54:55], v[54:55], v[170:171]
    v_cvt_pk_bf16_f32 v13, v54, v55
    v_lshlrev_b32 v54, 16, v13
    v_and_b32 v55, 0xffff0000, v13
    v_add_f32 v19, v19, v54
    v_add_f32 v19, v19, v55
    v_fmac_f32 v20, v54, v54
    v_fmac_f32 v21, v54, v250
    v_fmac_f32 v20, v55, v55
    v_fmac_f32 v21, v55, v251
    buffer_store_dwordx2 v[12:13], v229, s[20:23], s54 offen offset:64
    s_waitcnt vmcnt(6)
    v_lshlrev_b32 v88, 16, v108
    v_and_b32 v89, 0xffff0000, v108
    v_lshlrev_b32 v90, 16, v109
    v_and_b32 v91, 0xffff0000, v109
    v_pk_add_f32 v[56:57], v[56:57], v[88:89]
    v_pk_add_f32 v[58:59], v[58:59], v[90:91]
    v_cvt_pk_bf16_f32 v57, v56, v57
    v_lshlrev_b32 v56, 16, v57
    v_and_b32 v57, 0xffff0000, v57
    v_pk_add_f32 v[56:57], v[56:57], v[140:141]
    v_cvt_pk_bf16_f32 v6, v56, v57
    v_lshlrev_b32 v56, 16, v6
    v_and_b32 v57, 0xffff0000, v6
    v_add_f32 v16, v16, v56
    v_add_f32 v16, v16, v57
    v_fmac_f32 v17, v56, v56
    v_fmac_f32 v18, v56, v252
    v_fmac_f32 v17, v57, v57
    v_fmac_f32 v18, v57, v253
    v_cvt_pk_bf16_f32 v59, v58, v59
    v_lshlrev_b32 v58, 16, v59
    v_and_b32 v59, 0xffff0000, v59
    v_pk_add_f32 v[58:59], v[58:59], v[142:143]
    v_cvt_pk_bf16_f32 v7, v58, v59
    v_lshlrev_b32 v58, 16, v7
    v_and_b32 v59, 0xffff0000, v7
    v_add_f32 v16, v16, v58
    v_add_f32 v16, v16, v59
    v_fmac_f32 v17, v58, v58
    v_fmac_f32 v18, v58, v254
    v_fmac_f32 v17, v59, v59
    v_fmac_f32 v18, v59, v255
    buffer_store_dwordx2 v[6:7], v229, s[20:23], 0 offen offset:96
    s_waitcnt vmcnt(7)
    v_lshlrev_b32 v92, 16, v110
    v_and_b32 v93, 0xffff0000, v110
    v_lshlrev_b32 v94, 16, v111
    v_and_b32 v95, 0xffff0000, v111
    v_pk_add_f32 v[60:61], v[60:61], v[92:93]
    v_pk_add_f32 v[62:63], v[62:63], v[94:95]
    v_cvt_pk_bf16_f32 v61, v60, v61
    v_lshlrev_b32 v60, 16, v61
    v_and_b32 v61, 0xffff0000, v61
    v_pk_add_f32 v[60:61], v[60:61], v[172:173]
    v_cvt_pk_bf16_f32 v14, v60, v61
    v_lshlrev_b32 v60, 16, v14
    v_and_b32 v61, 0xffff0000, v14
    v_add_f32 v19, v19, v60
    v_add_f32 v19, v19, v61
    v_fmac_f32 v20, v60, v60
    v_fmac_f32 v21, v60, v252
    v_fmac_f32 v20, v61, v61
    v_fmac_f32 v21, v61, v253
    v_cvt_pk_bf16_f32 v63, v62, v63
    v_lshlrev_b32 v62, 16, v63
    v_and_b32 v63, 0xffff0000, v63
    v_pk_add_f32 v[62:63], v[62:63], v[174:175]
    v_cvt_pk_bf16_f32 v15, v62, v63
    v_lshlrev_b32 v62, 16, v15
    v_and_b32 v63, 0xffff0000, v15
    v_add_f32 v19, v19, v62
    v_add_f32 v19, v19, v63
    v_fmac_f32 v20, v62, v62
    v_fmac_f32 v21, v62, v254
    v_fmac_f32 v20, v63, v63
    v_fmac_f32 v21, v63, v255
    buffer_store_dwordx2 v[14:15], v229, s[20:23], s54 offen offset:96
    v_mov_b32 v24, 0
    s_nop 1
    v_permlane32_swap_b32 v16, v17
    v_permlane32_swap_b32 v19, v20
    v_permlane32_swap_b32 v18, v192
    v_permlane32_swap_b32 v21, v24
    s_nop 0
    v_add_f32 v16, v16, v17
    v_add_f32 v19, v19, v20
    v_add_f32 v18, v18, v192
    v_add_f32 v21, v21, v24
    s_nop 1
    v_permlane16_swap_b32 v16, v19
    v_permlane16_swap_b32 v18, v21
    s_nop 0
    v_add_f32 v16, v16, v19
    v_add_f32 v18, v18, v21
    buffer_atomic_add_f32 v16, v231, s[24:27], 0 offen
    buffer_atomic_add_f32 v18, v232, s[24:27], 0 offen
kb_done:
    s_endpgm

.globl k4_kernel
.p2align 8
.type k4_kernel,@function
k4_kernel:
    s_cmp_ge_u32 s2, 256
    s_cbranch_scc1 k4_done
    s_load_dwordx4 s[44:47], s[0:1], 64
    s_load_dwordx4 s[48:51], s[0:1], 80
    s_load_dwordx2 s[52:53], s[0:1], 104
    v_lshrrev_b32 v1, 6, v0
    v_and_b32 v2, 63, v0
    v_readfirstlane_b32 s54, v1
    s_and_b32 s40, s2, 7
    s_mul_i32 s4, s40, 28
    s_lshr_b32 s5, s2, 3
    s_add_u32 s4, s4, s5
    s_and_b32 s3, s54, 3
    s_lshl_b32 s42, s3, 13
    s_mov_b32 s41, 8192
    s_mov_b32 s6, 16384
    s_waitcnt lgkmcnt(0)
    s_add_u32 s8, s52, 0x3400000
    s_addc_u32 s9, s53, 0
    s_mov_b32 s10, 0x400000
    s_mov_b32 s11, 0x00020000
    s_add_u32 s12, s52, 0x3800000
    s_addc_u32 s13, s53, 0
    s_mov_b32 s14, 0x6040
    s_mov_b32 s15, 0x00020000
    s_cmp_lt_u32 s54, 4
    s_cbranch_scc1 k4_main
    s_lshl_b32 s40, s2, 3
    s_lshl1_add_u32 s40, s3, s40
    v_lshrrev_b32 v3, 5, v2
    v_add_u32 v3, s40, v3
    v_and_b32 v4, 31, v2
    v_lshlrev_b32 v54, 11, v3
    v_lshl_add_u32 v54, v4, 4, v54
    v_lshlrev_b32 v3, 2, v3
    buffer_load_dword v52, v3, s[12:15], 0 offen
    buffer_load_dword v53, v3, s[12:15], s41 offen
    buffer_load_dwordx4 v[36:39], v54, s[8:11], 0 offen offset:0
    buffer_load_dwordx4 v[40:43], v54, s[8:11], 0 offen offset:512
    buffer_load_dwordx4 v[44:47], v54, s[8:11], 0 offen offset:1024
    buffer_load_dwordx4 v[48:51], v54, s[8:11], 0 offen offset:1536
    s_mov_b32 s16, s50
    s_mov_b32 s17, s51
    s_mov_b32 s18, 0x400000
    s_mov_b32 s19, 0x00020000
    s_add_u32 s20, s52, 0x4000000
    s_addc_u32 s21, s53, 0
    s_mov_b32 s22, 0xe00000
    s_mov_b32 s23, 0x00020000
    s_mov_b32 s28, s48
    s_mov_b32 s29, s49
    s_mov_b32 s30, 0x700000
    s_mov_b32 s31, 0x00020000
    s_cmp_ge_u32 s5, 28
    s_cbranch_scc1 k4_simple
    s_barrier
    v_lshlrev_b32 v55, 4, v2
    v_lshrrev_b32 v3, 3, v2
    v_lshlrev_b32 v3, 11, v3
    v_and_b32 v4, 7, v2
    v_lshl_add_u32 v3, v4, 4, v3
    s_lshl_b32 s40, s4, 15
    s_lshl_b32 s7, s3, 9
    s_add_u32 s40, s40, s7
    v_add_u32 v33, s40, v3
    s_lshl_b32 s7, s4, 16
    s_add_u32 s7, s7, s42
    s_add_u32 m0, s42, 0
    s_add_u32 s40, s7, 0
    buffer_load_dwordx4 v55, s[20:23], s40 offen offset:0 lds
    buffer_load_dwordx4 v55, s[20:23], s40 offen offset:1024 lds
    buffer_load_dwordx4 v55, s[20:23], s40 offen offset:2048 lds
    buffer_load_dwordx4 v55, s[20:23], s40 offen offset:3072 lds
    s_add_u32 m0, s42, 32768
    s_add_u32 s40, s7, 32768
    buffer_load_dwordx4 v55, s[20:23], s40 offen offset:0 lds
    buffer_load_dwordx4 v55, s[20:23], s40 offen offset:1024 lds
    buffer_load_dwordx4 v55, s[20:23], s40 offen offset:2048 lds
    buffer_load_dwordx4 v55, s[20:23], s40 offen offset:3072 lds
    s_add_u32 m0, s42, 4096
    s_add_u32 s40, s7, 4096
    buffer_load_dwordx4 v55, s[20:23], s40 offen offset:0 lds
    buffer_load_dwordx4 v55, s[20:23], s40 offen offset:1024 lds
    buffer_load_dwordx4 v55, s[20:23], s40 offen offset:2048 lds
    buffer_load_dwordx4 v55, s[20:23], s40 offen offset:3072 lds
    s_add_u32 m0, s42, 36864
    s_add_u32 s40, s7, 36864
    buffer_load_dwordx4 v55, s[20:23], s40 offen offset:0 lds
    buffer_load_dwordx4 v55, s[20:23], s40 offen offset:1024 lds
    buffer_load_dwordx4 v55, s[20:23], s40 offen offset:2048 lds
    buffer_load_dwordx4 v55, s[20:23], s40 offen offset:3072 lds
    s_add_u32 m0, s42, 65536
    s_mov_b32 s40, 0
    buffer_load_dwordx4 v33, s[28:31], s40 offen lds
    s_add_u32 m0, s42, 66560
    s_mov_b32 s40, 16384
    buffer_load_dwordx4 v33, s[28:31], s40 offen lds
    s_add_u32 m0, s42, 67584
    s_mov_b32 s40, 128
    buffer_load_dwordx4 v33, s[28:31], s40 offen lds
    s_add_u32 m0, s42, 68608
    s_mov_b32 s40, 16512
    buffer_load_dwordx4 v33, s[28:31], s40 offen lds
    s_add_u32 m0, s42, 69632
    s_mov_b32 s40, 256
    buffer_load_dwordx4 v33, s[28:31], s40 offen lds
    s_add_u32 m0, s42, 70656
    s_mov_b32 s40, 16640
    buffer_load_dwordx4 v33, s[28:31], s40 offen lds
    s_add_u32 m0, s42, 71680
    s_mov_b32 s40, 384
    buffer_load_dwordx4 v33, s[28:31], s40 offen lds
    s_add_u32 m0, s42, 72704
    s_mov_b32 s40, 16768
    buffer_load_dwordx4 v33, s[28:31], s40 offen lds
    s_waitcnt vmcnt(0)
    s_barrier
    s_barrier
    s_waitcnt vmcnt(24)
    v_mul_f32 v52, 0x3a800000, v52
    v_mul_f32 v53, 0x3a800000, v53
    v_fma_f32 v53, -v52, v52, v53
    v_max_f32 v53, 0, v53
    v_cvt_pk_bf16_f32 v3, v52, v53
    v_lshlrev_b32 v52, 16, v3
    v_and_b32 v53, 0xffff0000, v3
    v_add_f32 v53, 0x3727c5ac, v53
    v_cvt_pk_bf16_f32 v53, v53, v53
    v_lshlrev_b32 v53, 16, v53
    v_sqrt_f32 v53, v53
    s_nop 0
    v_cvt_pk_bf16_f32 v53, v53, v53
    v_lshlrev_b32 v53, 16, v53
    v_rcp_f32 v53, v53
    s_nop 0
    v_lshlrev_b32 v56, 16, v36
    v_lshlrev_b32 v60, 16, v37
    v_lshlrev_b32 v64, 16, v38
    v_lshlrev_b32 v68, 16, v39
    v_and_b32 v57, 0xffff0000, v36
    v_and_b32 v61, 0xffff0000, v37
    v_and_b32 v65, 0xffff0000, v38
    v_and_b32 v69, 0xffff0000, v39
    v_sub_f32 v56, v56, v52
    v_sub_f32 v60, v60, v52
    v_sub_f32 v64, v64, v52
    v_sub_f32 v68, v68, v52
    v_sub_f32 v57, v57, v52
    v_sub_f32 v61, v61, v52
    v_sub_f32 v65, v65, v52
    v_sub_f32 v69, v69, v52
    v_cvt_pk_bf16_f32 v57, v56, v57
    v_cvt_pk_bf16_f32 v61, v60, v61
    v_cvt_pk_bf16_f32 v65, v64, v65
    v_cvt_pk_bf16_f32 v69, v68, v69
    v_lshlrev_b32 v56, 16, v57
    v_lshlrev_b32 v60, 16, v61
    v_lshlrev_b32 v64, 16, v65
    v_lshlrev_b32 v68, 16, v69
    v_and_b32 v57, 0xffff0000, v57
    v_and_b32 v61, 0xffff0000, v61
    v_and_b32 v65, 0xffff0000, v65
    v_and_b32 v69, 0xffff0000, v69
    v_mul_f32 v56, v56, v53
    v_mul_f32 v60, v60, v53
    v_mul_f32 v64, v64, v53
    v_mul_f32 v68, v68, v53
    v_mul_f32 v57, v57, v53
    v_mul_f32 v61, v61, v53
    v_mul_f32 v65, v65, v53
    v_mul_f32 v69, v69, v53
    v_cvt_pk_bf16_f32 v58, v56, v57
    v_cvt_pk_bf16_f32 v62, v60, v61
    v_cvt_pk_bf16_f32 v66, v64, v65
    v_cvt_pk_bf16_f32 v70, v68, v69
    v_lshlrev_b32 v56, 16, v58
    v_lshlrev_b32 v60, 16, v62
    v_lshlrev_b32 v64, 16, v66
    v_lshlrev_b32 v68, 16, v70
    v_and_b32 v57, 0xffff0000, v58
    v_and_b32 v61, 0xffff0000, v62
    v_and_b32 v65, 0xffff0000, v66
    v_and_b32 v69, 0xffff0000, v70
    v_lshlrev_b32 v58, 16, v36
    v_lshlrev_b32 v62, 16, v37
    v_lshlrev_b32 v66, 16, v38
    v_lshlrev_b32 v70, 16, v39
    v_and_b32 v59, 0xffff0000, v36
    v_and_b32 v63, 0xffff0000, v37
    v_and_b32 v67, 0xffff0000, v38
    v_and_b32 v71, 0xffff0000, v39
    v_add_f32 v56, v56, v58
    v_add_f32 v60, v60, v62
    v_add_f32 v64, v64, v66
    v_add_f32 v68, v68, v70
    v_add_f32 v57, v57, v59
    v_add_f32 v61, v61, v63
    v_add_f32 v65, v65, v67
    v_add_f32 v69, v69, v71
    v_cvt_pk_bf16_f32 v36, v56, v57
    v_cvt_pk_bf16_f32 v37, v60, v61
    v_cvt_pk_bf16_f32 v38, v64, v65
    v_cvt_pk_bf16_f32 v39, v68, v69
    buffer_store_dwordx4 v[36:39], v54, s[16:19], 0 offen offset:0
    v_lshlrev_b32 v56, 16, v40
    v_lshlrev_b32 v60, 16, v41
    v_lshlrev_b32 v64, 16, v42
    v_lshlrev_b32 v68, 16, v43
    v_and_b32 v57, 0xffff0000, v40
    v_and_b32 v61, 0xffff0000, v41
    v_and_b32 v65, 0xffff0000, v42
    v_and_b32 v69, 0xffff0000, v43
    v_sub_f32 v56, v56, v52
    v_sub_f32 v60, v60, v52
    v_sub_f32 v64, v64, v52
    v_sub_f32 v68, v68, v52
    v_sub_f32 v57, v57, v52
    v_sub_f32 v61, v61, v52
    v_sub_f32 v65, v65, v52
    v_sub_f32 v69, v69, v52
    v_cvt_pk_bf16_f32 v57, v56, v57
    v_cvt_pk_bf16_f32 v61, v60, v61
    v_cvt_pk_bf16_f32 v65, v64, v65
    v_cvt_pk_bf16_f32 v69, v68, v69
    v_lshlrev_b32 v56, 16, v57
    v_lshlrev_b32 v60, 16, v61
    v_lshlrev_b32 v64, 16, v65
    v_lshlrev_b32 v68, 16, v69
    v_and_b32 v57, 0xffff0000, v57
    v_and_b32 v61, 0xffff0000, v61
    v_and_b32 v65, 0xffff0000, v65
    v_and_b32 v69, 0xffff0000, v69
    v_mul_f32 v56, v56, v53
    v_mul_f32 v60, v60, v53
    v_mul_f32 v64, v64, v53
    v_mul_f32 v68, v68, v53
    v_mul_f32 v57, v57, v53
    v_mul_f32 v61, v61, v53
    v_mul_f32 v65, v65, v53
    v_mul_f32 v69, v69, v53
    v_cvt_pk_bf16_f32 v58, v56, v57
    v_cvt_pk_bf16_f32 v62, v60, v61
    v_cvt_pk_bf16_f32 v66, v64, v65
    v_cvt_pk_bf16_f32 v70, v68, v69
    v_lshlrev_b32 v56, 16, v58
    v_lshlrev_b32 v60, 16, v62
    v_lshlrev_b32 v64, 16, v66
    v_lshlrev_b32 v68, 16, v70
    v_and_b32 v57, 0xffff0000, v58
    v_and_b32 v61, 0xffff0000, v62
    v_and_b32 v65, 0xffff0000, v66
    v_and_b32 v69, 0xffff0000, v70
    v_lshlrev_b32 v58, 16, v40
    v_lshlrev_b32 v62, 16, v41
    v_lshlrev_b32 v66, 16, v42
    v_lshlrev_b32 v70, 16, v43
    v_and_b32 v59, 0xffff0000, v40
    v_and_b32 v63, 0xffff0000, v41
    v_and_b32 v67, 0xffff0000, v42
    v_and_b32 v71, 0xffff0000, v43
    v_add_f32 v56, v56, v58
    v_add_f32 v60, v60, v62
    v_add_f32 v64, v64, v66
    v_add_f32 v68, v68, v70
    v_add_f32 v57, v57, v59
    v_add_f32 v61, v61, v63
    v_add_f32 v65, v65, v67
    v_add_f32 v69, v69, v71
    v_cvt_pk_bf16_f32 v40, v56, v57
    v_cvt_pk_bf16_f32 v41, v60, v61
    v_cvt_pk_bf16_f32 v42, v64, v65
    v_cvt_pk_bf16_f32 v43, v68, v69
    buffer_store_dwordx4 v[40:43], v54, s[16:19], 0 offen offset:512
    v_lshlrev_b32 v56, 16, v44
    v_lshlrev_b32 v60, 16, v45
    v_lshlrev_b32 v64, 16, v46
    v_lshlrev_b32 v68, 16, v47
    v_and_b32 v57, 0xffff0000, v44
    v_and_b32 v61, 0xffff0000, v45
    v_and_b32 v65, 0xffff0000, v46
    v_and_b32 v69, 0xffff0000, v47
    v_sub_f32 v56, v56, v52
    v_sub_f32 v60, v60, v52
    v_sub_f32 v64, v64, v52
    v_sub_f32 v68, v68, v52
    v_sub_f32 v57, v57, v52
    v_sub_f32 v61, v61, v52
    v_sub_f32 v65, v65, v52
    v_sub_f32 v69, v69, v52
    v_cvt_pk_bf16_f32 v57, v56, v57
    v_cvt_pk_bf16_f32 v61, v60, v61
    v_cvt_pk_bf16_f32 v65, v64, v65
    v_cvt_pk_bf16_f32 v69, v68, v69
    v_lshlrev_b32 v56, 16, v57
    v_lshlrev_b32 v60, 16, v61
    v_lshlrev_b32 v64, 16, v65
    v_lshlrev_b32 v68, 16, v69
    v_and_b32 v57, 0xffff0000, v57
    v_and_b32 v61, 0xffff0000, v61
    v_and_b32 v65, 0xffff0000, v65
    v_and_b32 v69, 0xffff0000, v69
    v_mul_f32 v56, v56, v53
    v_mul_f32 v60, v60, v53
    v_mul_f32 v64, v64, v53
    v_mul_f32 v68, v68, v53
    v_mul_f32 v57, v57, v53
    v_mul_f32 v61, v61, v53
    v_mul_f32 v65, v65, v53
    v_mul_f32 v69, v69, v53
    v_cvt_pk_bf16_f32 v58, v56, v57
    v_cvt_pk_bf16_f32 v62, v60, v61
    v_cvt_pk_bf16_f32 v66, v64, v65
    v_cvt_pk_bf16_f32 v70, v68, v69
    v_lshlrev_b32 v56, 16, v58
    v_lshlrev_b32 v60, 16, v62
    v_lshlrev_b32 v64, 16, v66
    v_lshlrev_b32 v68, 16, v70
    v_and_b32 v57, 0xffff0000, v58
    v_and_b32 v61, 0xffff0000, v62
    v_and_b32 v65, 0xffff0000, v66
    v_and_b32 v69, 0xffff0000, v70
    v_lshlrev_b32 v58, 16, v44
    v_lshlrev_b32 v62, 16, v45
    v_lshlrev_b32 v66, 16, v46
    v_lshlrev_b32 v70, 16, v47
    v_and_b32 v59, 0xffff0000, v44
    v_and_b32 v63, 0xffff0000, v45
    v_and_b32 v67, 0xffff0000, v46
    v_and_b32 v71, 0xffff0000, v47
    v_add_f32 v56, v56, v58
    v_add_f32 v60, v60, v62
    v_add_f32 v64, v64, v66
    v_add_f32 v68, v68, v70
    v_add_f32 v57, v57, v59
    v_add_f32 v61, v61, v63
    v_add_f32 v65, v65, v67
    v_add_f32 v69, v69, v71
    v_cvt_pk_bf16_f32 v44, v56, v57
    v_cvt_pk_bf16_f32 v45, v60, v61
    v_cvt_pk_bf16_f32 v46, v64, v65
    v_cvt_pk_bf16_f32 v47, v68, v69
    buffer_store_dwordx4 v[44:47], v54, s[16:19], 0 offen offset:1024
    v_lshlrev_b32 v56, 16, v48
    v_lshlrev_b32 v60, 16, v49
    v_lshlrev_b32 v64, 16, v50
    v_lshlrev_b32 v68, 16, v51
    v_and_b32 v57, 0xffff0000, v48
    v_and_b32 v61, 0xffff0000, v49
    v_and_b32 v65, 0xffff0000, v50
    v_and_b32 v69, 0xffff0000, v51
    v_sub_f32 v56, v56, v52
    v_sub_f32 v60, v60, v52
    v_sub_f32 v64, v64, v52
    v_sub_f32 v68, v68, v52
    v_sub_f32 v57, v57, v52
    v_sub_f32 v61, v61, v52
    v_sub_f32 v65, v65, v52
    v_sub_f32 v69, v69, v52
    v_cvt_pk_bf16_f32 v57, v56, v57
    v_cvt_pk_bf16_f32 v61, v60, v61
    v_cvt_pk_bf16_f32 v65, v64, v65
    v_cvt_pk_bf16_f32 v69, v68, v69
    v_lshlrev_b32 v56, 16, v57
    v_lshlrev_b32 v60, 16, v61
    v_lshlrev_b32 v64, 16, v65
    v_lshlrev_b32 v68, 16, v69
    v_and_b32 v57, 0xffff0000, v57
    v_and_b32 v61, 0xffff0000, v61
    v_and_b32 v65, 0xffff0000, v65
    v_and_b32 v69, 0xffff0000, v69
    v_mul_f32 v56, v56, v53
    v_mul_f32 v60, v60, v53
    v_mul_f32 v64, v64, v53
    v_mul_f32 v68, v68, v53
    v_mul_f32 v57, v57, v53
    v_mul_f32 v61, v61, v53
    v_mul_f32 v65, v65, v53
    v_mul_f32 v69, v69, v53
    v_cvt_pk_bf16_f32 v58, v56, v57
    v_cvt_pk_bf16_f32 v62, v60, v61
    v_cvt_pk_bf16_f32 v66, v64, v65
    v_cvt_pk_bf16_f32 v70, v68, v69
    v_lshlrev_b32 v56, 16, v58
    v_lshlrev_b32 v60, 16, v62
    v_lshlrev_b32 v64, 16, v66
    v_lshlrev_b32 v68, 16, v70
    v_and_b32 v57, 0xffff0000, v58
    v_and_b32 v61, 0xffff0000, v62
    v_and_b32 v65, 0xffff0000, v66
    v_and_b32 v69, 0xffff0000, v70
    v_lshlrev_b32 v58, 16, v48
    v_lshlrev_b32 v62, 16, v49
    v_lshlrev_b32 v66, 16, v50
    v_lshlrev_b32 v70, 16, v51
    v_and_b32 v59, 0xffff0000, v48
    v_and_b32 v63, 0xffff0000, v49
    v_and_b32 v67, 0xffff0000, v50
    v_and_b32 v71, 0xffff0000, v51
    v_add_f32 v56, v56, v58
    v_add_f32 v60, v60, v62
    v_add_f32 v64, v64, v66
    v_add_f32 v68, v68, v70
    v_add_f32 v57, v57, v59
    v_add_f32 v61, v61, v63
    v_add_f32 v65, v65, v67
    v_add_f32 v69, v69, v71
    v_cvt_pk_bf16_f32 v48, v56, v57
    v_cvt_pk_bf16_f32 v49, v60, v61
    v_cvt_pk_bf16_f32 v50, v64, v65
    v_cvt_pk_bf16_f32 v51, v68, v69
    buffer_store_dwordx4 v[48:51], v54, s[16:19], 0 offen offset:1536
    s_endpgm
k4_simple:
    s_waitcnt vmcnt(0)
    v_mul_f32 v52, 0x3a800000, v52
    v_mul_f32 v53, 0x3a800000, v53
    v_fma_f32 v53, -v52, v52, v53
    v_max_f32 v53, 0, v53
    v_cvt_pk_bf16_f32 v3, v52, v53
    v_lshlrev_b32 v52, 16, v3
    v_and_b32 v53, 0xffff0000, v3
    v_add_f32 v53, 0x3727c5ac, v53
    v_cvt_pk_bf16_f32 v53, v53, v53
    v_lshlrev_b32 v53, 16, v53
    v_sqrt_f32 v53, v53
    s_nop 0
    v_cvt_pk_bf16_f32 v53, v53, v53
    v_lshlrev_b32 v53, 16, v53
    v_rcp_f32 v53, v53
    s_nop 0
    v_lshlrev_b32 v56, 16, v36
    v_lshlrev_b32 v60, 16, v37
    v_lshlrev_b32 v64, 16, v38
    v_lshlrev_b32 v68, 16, v39
    v_and_b32 v57, 0xffff0000, v36
    v_and_b32 v61, 0xffff0000, v37
    v_and_b32 v65, 0xffff0000, v38
    v_and_b32 v69, 0xffff0000, v39
    v_sub_f32 v56, v56, v52
    v_sub_f32 v60, v60, v52
    v_sub_f32 v64, v64, v52
    v_sub_f32 v68, v68, v52
    v_sub_f32 v57, v57, v52
    v_sub_f32 v61, v61, v52
    v_sub_f32 v65, v65, v52
    v_sub_f32 v69, v69, v52
    v_cvt_pk_bf16_f32 v57, v56, v57
    v_cvt_pk_bf16_f32 v61, v60, v61
    v_cvt_pk_bf16_f32 v65, v64, v65
    v_cvt_pk_bf16_f32 v69, v68, v69
    v_lshlrev_b32 v56, 16, v57
    v_lshlrev_b32 v60, 16, v61
    v_lshlrev_b32 v64, 16, v65
    v_lshlrev_b32 v68, 16, v69
    v_and_b32 v57, 0xffff0000, v57
    v_and_b32 v61, 0xffff0000, v61
    v_and_b32 v65, 0xffff0000, v65
    v_and_b32 v69, 0xffff0000, v69
    v_mul_f32 v56, v56, v53
    v_mul_f32 v60, v60, v53
    v_mul_f32 v64, v64, v53
    v_mul_f32 v68, v68, v53
    v_mul_f32 v57, v57, v53
    v_mul_f32 v61, v61, v53
    v_mul_f32 v65, v65, v53
    v_mul_f32 v69, v69, v53
    v_cvt_pk_bf16_f32 v58, v56, v57
    v_cvt_pk_bf16_f32 v62, v60, v61
    v_cvt_pk_bf16_f32 v66, v64, v65
    v_cvt_pk_bf16_f32 v70, v68, v69
    v_lshlrev_b32 v56, 16, v58
    v_lshlrev_b32 v60, 16, v62
    v_lshlrev_b32 v64, 16, v66
    v_lshlrev_b32 v68, 16, v70
    v_and_b32 v57, 0xffff0000, v58
    v_and_b32 v61, 0xffff0000, v62
    v_and_b32 v65, 0xffff0000, v66
    v_and_b32 v69, 0xffff0000, v70
    v_lshlrev_b32 v58, 16, v36
    v_lshlrev_b32 v62, 16, v37
    v_lshlrev_b32 v66, 16, v38
    v_lshlrev_b32 v70, 16, v39
    v_and_b32 v59, 0xffff0000, v36
    v_and_b32 v63, 0xffff0000, v37
    v_and_b32 v67, 0xffff0000, v38
    v_and_b32 v71, 0xffff0000, v39
    v_add_f32 v56, v56, v58
    v_add_f32 v60, v60, v62
    v_add_f32 v64, v64, v66
    v_add_f32 v68, v68, v70
    v_add_f32 v57, v57, v59
    v_add_f32 v61, v61, v63
    v_add_f32 v65, v65, v67
    v_add_f32 v69, v69, v71
    v_cvt_pk_bf16_f32 v36, v56, v57
    v_cvt_pk_bf16_f32 v37, v60, v61
    v_cvt_pk_bf16_f32 v38, v64, v65
    v_cvt_pk_bf16_f32 v39, v68, v69
    buffer_store_dwordx4 v[36:39], v54, s[16:19], 0 offen offset:0
    v_lshlrev_b32 v56, 16, v40
    v_lshlrev_b32 v60, 16, v41
    v_lshlrev_b32 v64, 16, v42
    v_lshlrev_b32 v68, 16, v43
    v_and_b32 v57, 0xffff0000, v40
    v_and_b32 v61, 0xffff0000, v41
    v_and_b32 v65, 0xffff0000, v42
    v_and_b32 v69, 0xffff0000, v43
    v_sub_f32 v56, v56, v52
    v_sub_f32 v60, v60, v52
    v_sub_f32 v64, v64, v52
    v_sub_f32 v68, v68, v52
    v_sub_f32 v57, v57, v52
    v_sub_f32 v61, v61, v52
    v_sub_f32 v65, v65, v52
    v_sub_f32 v69, v69, v52
    v_cvt_pk_bf16_f32 v57, v56, v57
    v_cvt_pk_bf16_f32 v61, v60, v61
    v_cvt_pk_bf16_f32 v65, v64, v65
    v_cvt_pk_bf16_f32 v69, v68, v69
    v_lshlrev_b32 v56, 16, v57
    v_lshlrev_b32 v60, 16, v61
    v_lshlrev_b32 v64, 16, v65
    v_lshlrev_b32 v68, 16, v69
    v_and_b32 v57, 0xffff0000, v57
    v_and_b32 v61, 0xffff0000, v61
    v_and_b32 v65, 0xffff0000, v65
    v_and_b32 v69, 0xffff0000, v69
    v_mul_f32 v56, v56, v53
    v_mul_f32 v60, v60, v53
    v_mul_f32 v64, v64, v53
    v_mul_f32 v68, v68, v53
    v_mul_f32 v57, v57, v53
    v_mul_f32 v61, v61, v53
    v_mul_f32 v65, v65, v53
    v_mul_f32 v69, v69, v53
    v_cvt_pk_bf16_f32 v58, v56, v57
    v_cvt_pk_bf16_f32 v62, v60, v61
    v_cvt_pk_bf16_f32 v66, v64, v65
    v_cvt_pk_bf16_f32 v70, v68, v69
    v_lshlrev_b32 v56, 16, v58
    v_lshlrev_b32 v60, 16, v62
    v_lshlrev_b32 v64, 16, v66
    v_lshlrev_b32 v68, 16, v70
    v_and_b32 v57, 0xffff0000, v58
    v_and_b32 v61, 0xffff0000, v62
    v_and_b32 v65, 0xffff0000, v66
    v_and_b32 v69, 0xffff0000, v70
    v_lshlrev_b32 v58, 16, v40
    v_lshlrev_b32 v62, 16, v41
    v_lshlrev_b32 v66, 16, v42
    v_lshlrev_b32 v70, 16, v43
    v_and_b32 v59, 0xffff0000, v40
    v_and_b32 v63, 0xffff0000, v41
    v_and_b32 v67, 0xffff0000, v42
    v_and_b32 v71, 0xffff0000, v43
    v_add_f32 v56, v56, v58
    v_add_f32 v60, v60, v62
    v_add_f32 v64, v64, v66
    v_add_f32 v68, v68, v70
    v_add_f32 v57, v57, v59
    v_add_f32 v61, v61, v63
    v_add_f32 v65, v65, v67
    v_add_f32 v69, v69, v71
    v_cvt_pk_bf16_f32 v40, v56, v57
    v_cvt_pk_bf16_f32 v41, v60, v61
    v_cvt_pk_bf16_f32 v42, v64, v65
    v_cvt_pk_bf16_f32 v43, v68, v69
    buffer_store_dwordx4 v[40:43], v54, s[16:19], 0 offen offset:512
    v_lshlrev_b32 v56, 16, v44
    v_lshlrev_b32 v60, 16, v45
    v_lshlrev_b32 v64, 16, v46
    v_lshlrev_b32 v68, 16, v47
    v_and_b32 v57, 0xffff0000, v44
    v_and_b32 v61, 0xffff0000, v45
    v_and_b32 v65, 0xffff0000, v46
    v_and_b32 v69, 0xffff0000, v47
    v_sub_f32 v56, v56, v52
    v_sub_f32 v60, v60, v52
    v_sub_f32 v64, v64, v52
    v_sub_f32 v68, v68, v52
    v_sub_f32 v57, v57, v52
    v_sub_f32 v61, v61, v52
    v_sub_f32 v65, v65, v52
    v_sub_f32 v69, v69, v52
    v_cvt_pk_bf16_f32 v57, v56, v57
    v_cvt_pk_bf16_f32 v61, v60, v61
    v_cvt_pk_bf16_f32 v65, v64, v65
    v_cvt_pk_bf16_f32 v69, v68, v69
    v_lshlrev_b32 v56, 16, v57
    v_lshlrev_b32 v60, 16, v61
    v_lshlrev_b32 v64, 16, v65
    v_lshlrev_b32 v68, 16, v69
    v_and_b32 v57, 0xffff0000, v57
    v_and_b32 v61, 0xffff0000, v61
    v_and_b32 v65, 0xffff0000, v65
    v_and_b32 v69, 0xffff0000, v69
    v_mul_f32 v56, v56, v53
    v_mul_f32 v60, v60, v53
    v_mul_f32 v64, v64, v53
    v_mul_f32 v68, v68, v53
    v_mul_f32 v57, v57, v53
    v_mul_f32 v61, v61, v53
    v_mul_f32 v65, v65, v53
    v_mul_f32 v69, v69, v53
    v_cvt_pk_bf16_f32 v58, v56, v57
    v_cvt_pk_bf16_f32 v62, v60, v61
    v_cvt_pk_bf16_f32 v66, v64, v65
    v_cvt_pk_bf16_f32 v70, v68, v69
    v_lshlrev_b32 v56, 16, v58
    v_lshlrev_b32 v60, 16, v62
    v_lshlrev_b32 v64, 16, v66
    v_lshlrev_b32 v68, 16, v70
    v_and_b32 v57, 0xffff0000, v58
    v_and_b32 v61, 0xffff0000, v62
    v_and_b32 v65, 0xffff0000, v66
    v_and_b32 v69, 0xffff0000, v70
    v_lshlrev_b32 v58, 16, v44
    v_lshlrev_b32 v62, 16, v45
    v_lshlrev_b32 v66, 16, v46
    v_lshlrev_b32 v70, 16, v47
    v_and_b32 v59, 0xffff0000, v44
    v_and_b32 v63, 0xffff0000, v45
    v_and_b32 v67, 0xffff0000, v46
    v_and_b32 v71, 0xffff0000, v47
    v_add_f32 v56, v56, v58
    v_add_f32 v60, v60, v62
    v_add_f32 v64, v64, v66
    v_add_f32 v68, v68, v70
    v_add_f32 v57, v57, v59
    v_add_f32 v61, v61, v63
    v_add_f32 v65, v65, v67
    v_add_f32 v69, v69, v71
    v_cvt_pk_bf16_f32 v44, v56, v57
    v_cvt_pk_bf16_f32 v45, v60, v61
    v_cvt_pk_bf16_f32 v46, v64, v65
    v_cvt_pk_bf16_f32 v47, v68, v69
    buffer_store_dwordx4 v[44:47], v54, s[16:19], 0 offen offset:1024
    v_lshlrev_b32 v56, 16, v48
    v_lshlrev_b32 v60, 16, v49
    v_lshlrev_b32 v64, 16, v50
    v_lshlrev_b32 v68, 16, v51
    v_and_b32 v57, 0xffff0000, v48
    v_and_b32 v61, 0xffff0000, v49
    v_and_b32 v65, 0xffff0000, v50
    v_and_b32 v69, 0xffff0000, v51
    v_sub_f32 v56, v56, v52
    v_sub_f32 v60, v60, v52
    v_sub_f32 v64, v64, v52
    v_sub_f32 v68, v68, v52
    v_sub_f32 v57, v57, v52
    v_sub_f32 v61, v61, v52
    v_sub_f32 v65, v65, v52
    v_sub_f32 v69, v69, v52
    v_cvt_pk_bf16_f32 v57, v56, v57
    v_cvt_pk_bf16_f32 v61, v60, v61
    v_cvt_pk_bf16_f32 v65, v64, v65
    v_cvt_pk_bf16_f32 v69, v68, v69
    v_lshlrev_b32 v56, 16, v57
    v_lshlrev_b32 v60, 16, v61
    v_lshlrev_b32 v64, 16, v65
    v_lshlrev_b32 v68, 16, v69
    v_and_b32 v57, 0xffff0000, v57
    v_and_b32 v61, 0xffff0000, v61
    v_and_b32 v65, 0xffff0000, v65
    v_and_b32 v69, 0xffff0000, v69
    v_mul_f32 v56, v56, v53
    v_mul_f32 v60, v60, v53
    v_mul_f32 v64, v64, v53
    v_mul_f32 v68, v68, v53
    v_mul_f32 v57, v57, v53
    v_mul_f32 v61, v61, v53
    v_mul_f32 v65, v65, v53
    v_mul_f32 v69, v69, v53
    v_cvt_pk_bf16_f32 v58, v56, v57
    v_cvt_pk_bf16_f32 v62, v60, v61
    v_cvt_pk_bf16_f32 v66, v64, v65
    v_cvt_pk_bf16_f32 v70, v68, v69
    v_lshlrev_b32 v56, 16, v58
    v_lshlrev_b32 v60, 16, v62
    v_lshlrev_b32 v64, 16, v66
    v_lshlrev_b32 v68, 16, v70
    v_and_b32 v57, 0xffff0000, v58
    v_and_b32 v61, 0xffff0000, v62
    v_and_b32 v65, 0xffff0000, v66
    v_and_b32 v69, 0xffff0000, v70
    v_lshlrev_b32 v58, 16, v48
    v_lshlrev_b32 v62, 16, v49
    v_lshlrev_b32 v66, 16, v50
    v_lshlrev_b32 v70, 16, v51
    v_and_b32 v59, 0xffff0000, v48
    v_and_b32 v63, 0xffff0000, v49
    v_and_b32 v67, 0xffff0000, v50
    v_and_b32 v71, 0xffff0000, v51
    v_add_f32 v56, v56, v58
    v_add_f32 v60, v60, v62
    v_add_f32 v64, v64, v66
    v_add_f32 v68, v68, v70
    v_add_f32 v57, v57, v59
    v_add_f32 v61, v61, v63
    v_add_f32 v65, v65, v67
    v_add_f32 v69, v69, v71
    v_cvt_pk_bf16_f32 v48, v56, v57
    v_cvt_pk_bf16_f32 v49, v60, v61
    v_cvt_pk_bf16_f32 v50, v64, v65
    v_cvt_pk_bf16_f32 v51, v68, v69
    buffer_store_dwordx4 v[48:51], v54, s[16:19], 0 offen offset:1536
    s_endpgm
k4_main:
    s_cmp_ge_u32 s5, 28
    s_cbranch_scc1 k4_done
    v_lshlrev_b32 v5, 5, v0
    buffer_load_dwordx4 v[8:11], v5, s[12:15], 0 offen offset:0
    buffer_load_dwordx4 v[12:15], v5, s[12:15], 0 offen offset:16
    buffer_load_dwordx4 v[16:19], v5, s[12:15], s41 offen offset:0
    buffer_load_dwordx4 v[20:23], v5, s[12:15], s41 offen offset:16
    buffer_load_dwordx4 v[24:27], v5, s[12:15], s6 offen offset:0
    buffer_load_dwordx4 v[28:31], v5, s[12:15], s6 offen offset:16
    v_mov_b32 v6, 24576
    buffer_load_dword v32, v6, s[12:15], 0 offen
    v_mov_b32 v60, 0
    v_mov_b32 v61, 0
    s_lshl_b32 s40, s3, 3
    s_add_u32 s40, s40, 102400
    v_mov_b32 v3, s40
    ds_write_b64 v3, v[60:61]
    s_waitcnt lgkmcnt(0)
    s_barrier
    s_add_u32 s32, s52, 0x3810000
    s_addc_u32 s33, s53, 0
    s_mov_b32 s34, 0x3000
    s_mov_b32 s35, 0x00020000
    s_add_u32 s36, s52, 0x3900000
    s_addc_u32 s37, s53, 0
    s_mov_b32 s38, 0x1c0000
    s_mov_b32 s39, 0x00020000
    v_bfe_u32 v3, v2, 2, 3
    v_lshrrev_b32 v4, 5, v2
    v_lshl_add_u32 v3, v4, 4, v3
    v_lshlrev_b32 v3, 5, v3
    v_and_b32 v5, 3, v2
    v_lshl_add_u32 v3, v5, 3, v3
    v_add_u32 v40, s42, v3
    v_lshlrev_b32 v4, 5, v4
    v_bfe_u32 v5, v2, 4, 1
    v_lshl_add_u32 v4, v5, 3, v4
    v_and_b32 v5, 1, v2
    v_lshl_add_u32 v4, v5, 11, v4
    s_lshl_b32 s40, s3, 9
    s_add_u32 s40, s40, 98304
    v_add_u32 v41, s40, v4
    v_lshlrev_b32 v47, 4, v0
    v_add_u32 v43, 102464, v47
    v_add_u32 v46, 98304, v47
    v_lshlrev_b32 v4, 4, v2
    v_add_u32 v44, 102464, v4
    v_lshrrev_b32 v5, 2, v2
    v_lshlrev_b32 v5, 7, v5
    v_and_b32 v6, 3, v2
    v_lshl_add_u32 v5, v6, 3, v5
    s_add_u32 s40, s42, 65536
    v_add_u32 v42, s40, v5
    v_and_b32 v3, 15, v2
    v_lshlrev_b32 v4, 12, v3
    v_lshrrev_b32 v5, 4, v2
    v_lshl_add_u32 v4, v5, 4, v4
    v_cmp_gt_u32 vcc, 2, v3
    v_mov_b32 v5, 0x40000000
    s_lshl_b32 s55, s4, 13
    s_lshl_b32 s7, s3, 10
    v_cndmask_b32 v45, v5, v4, vcc
    s_add_u32 s55, s55, s7
    s_cmp_eq_u32 s2, 0
    s_cselect_b32 s43, 0, 0x40000000
    s_add_u32 s56, s43, 4096
    s_add_u32 s57, s43, 8192
    v_lshlrev_b32 v5, 3, v0
    v_sub_u32 v5, 2047, v5
    s_waitcnt vmcnt(0)
    v_mul_f32 v8, 0x3a800000, v8
    v_mul_f32 v9, 0x3a800000, v9
    v_mul_f32 v10, 0x3a800000, v10
    v_mul_f32 v11, 0x3a800000, v11
    v_mul_f32 v12, 0x3a800000, v12
    v_mul_f32 v13, 0x3a800000, v13
    v_mul_f32 v14, 0x3a800000, v14
    v_mul_f32 v15, 0x3a800000, v15
    v_mul_f32 v16, 0x3a800000, v16
    v_mul_f32 v17, 0x3a800000, v17
    v_mul_f32 v18, 0x3a800000, v18
    v_mul_f32 v19, 0x3a800000, v19
    v_mul_f32 v20, 0x3a800000, v20
    v_mul_f32 v21, 0x3a800000, v21
    v_mul_f32 v22, 0x3a800000, v22
    v_mul_f32 v23, 0x3a800000, v23
    v_fma_f32 v16, -v8, v8, v16
    v_fma_f32 v17, -v9, v9, v17
    v_fma_f32 v18, -v10, v10, v18
    v_fma_f32 v19, -v11, v11, v19
    v_fma_f32 v20, -v12, v12, v20
    v_fma_f32 v21, -v13, v13, v21
    v_fma_f32 v22, -v14, v14, v22
    v_fma_f32 v23, -v15, v15, v23
    v_max_f32 v16, 0, v16
    v_max_f32 v17, 0, v17
    v_max_f32 v18, 0, v18
    v_max_f32 v19, 0, v19
    v_max_f32 v20, 0, v20
    v_max_f32 v21, 0, v21
    v_max_f32 v22, 0, v22
    v_max_f32 v23, 0, v23
    v_cvt_pk_bf16_f32 v56, v8, v16
    v_cvt_pk_bf16_f32 v57, v9, v17
    v_cvt_pk_bf16_f32 v58, v10, v18
    v_cvt_pk_bf16_f32 v59, v11, v19
    v_cvt_pk_bf16_f32 v60, v12, v20
    v_cvt_pk_bf16_f32 v61, v13, v21
    v_cvt_pk_bf16_f32 v62, v14, v22
    v_cvt_pk_bf16_f32 v63, v15, v23
    v_lshlrev_b32 v8, 16, v56
    v_lshlrev_b32 v9, 16, v57
    v_lshlrev_b32 v10, 16, v58
    v_lshlrev_b32 v11, 16, v59
    v_lshlrev_b32 v12, 16, v60
    v_lshlrev_b32 v13, 16, v61
    v_lshlrev_b32 v14, 16, v62
    v_lshlrev_b32 v15, 16, v63
    v_and_b32 v16, 0xffff0000, v56
    v_and_b32 v17, 0xffff0000, v57
    v_and_b32 v18, 0xffff0000, v58
    v_and_b32 v19, 0xffff0000, v59
    v_and_b32 v20, 0xffff0000, v60
    v_and_b32 v21, 0xffff0000, v61
    v_and_b32 v22, 0xffff0000, v62
    v_and_b32 v23, 0xffff0000, v63
    v_add_f32 v16, 0x3727c5ac, v16
    v_add_f32 v17, 0x3727c5ac, v17
    v_add_f32 v18, 0x3727c5ac, v18
    v_add_f32 v19, 0x3727c5ac, v19
    v_add_f32 v20, 0x3727c5ac, v20
    v_add_f32 v21, 0x3727c5ac, v21
    v_add_f32 v22, 0x3727c5ac, v22
    v_add_f32 v23, 0x3727c5ac, v23
    v_cvt_pk_bf16_f32 v16, v16, v16
    v_cvt_pk_bf16_f32 v17, v17, v17
    v_cvt_pk_bf16_f32 v18, v18, v18
    v_cvt_pk_bf16_f32 v19, v19, v19
    v_cvt_pk_bf16_f32 v20, v20, v20
    v_cvt_pk_bf16_f32 v21, v21, v21
    v_cvt_pk_bf16_f32 v22, v22, v22
    v_cvt_pk_bf16_f32 v23, v23, v23
    v_lshlrev_b32 v16, 16, v16
    v_lshlrev_b32 v17, 16, v17
    v_lshlrev_b32 v18, 16, v18
    v_lshlrev_b32 v19, 16, v19
    v_lshlrev_b32 v20, 16, v20
    v_lshlrev_b32 v21, 16, v21
    v_lshlrev_b32 v22, 16, v22
    v_lshlrev_b32 v23, 16, v23
    v_sqrt_f32 v16, v16
    v_sqrt_f32 v17, v17
    v_sqrt_f32 v18, v18
    v_sqrt_f32 v19, v19
    v_sqrt_f32 v20, v20
    v_sqrt_f32 v21, v21
    v_sqrt_f32 v22, v22
    v_sqrt_f32 v23, v23
    v_cvt_pk_bf16_f32 v16, v16, v16
    v_cvt_pk_bf16_f32 v17, v17, v17
    v_cvt_pk_bf16_f32 v18, v18, v18
    v_cvt_pk_bf16_f32 v19, v19, v19
    v_cvt_pk_bf16_f32 v20, v20, v20
    v_cvt_pk_bf16_f32 v21, v21, v21
    v_cvt_pk_bf16_f32 v22, v22, v22
    v_cvt_pk_bf16_f32 v23, v23, v23
    v_lshlrev_b32 v16, 16, v16
    v_lshlrev_b32 v17, 16, v17
    v_lshlrev_b32 v18, 16, v18
    v_lshlrev_b32 v19, 16, v19
    v_lshlrev_b32 v20, 16, v20
    v_lshlrev_b32 v21, 16, v21
    v_lshlrev_b32 v22, 16, v22
    v_lshlrev_b32 v23, 16, v23
    v_rcp_f32 v16, v16
    v_rcp_f32 v17, v17
    v_rcp_f32 v18, v18
    v_rcp_f32 v19, v19
    v_rcp_f32 v20, v20
    v_rcp_f32 v21, v21
    v_rcp_f32 v22, v22
    v_rcp_f32 v23, v23
    v_fma_f32 v24, -v8, v32, v24
    v_fma_f32 v25, -v9, v32, v25
    v_fma_f32 v26, -v10, v32, v26
    v_fma_f32 v27, -v11, v32, v27
    v_fma_f32 v28, -v12, v32, v28
    v_fma_f32 v29, -v13, v32, v29
    v_fma_f32 v30, -v14, v32, v30
    v_fma_f32 v31, -v15, v32, v31
    v_mul_f32 v24, v24, v16
    v_mul_f32 v25, v25, v17
    v_mul_f32 v26, v26, v18
    v_mul_f32 v27, v27, v19
    v_mul_f32 v28, v28, v20
    v_mul_f32 v29, v29, v21
    v_mul_f32 v30, v30, v22
    v_mul_f32 v31, v31, v23
    v_cvt_pk_bf16_f32 v24, v24, v24
    v_cvt_pk_bf16_f32 v25, v25, v25
    v_cvt_pk_bf16_f32 v26, v26, v26
    v_cvt_pk_bf16_f32 v27, v27, v27
    v_cvt_pk_bf16_f32 v28, v28, v28
    v_cvt_pk_bf16_f32 v29, v29, v29
    v_cvt_pk_bf16_f32 v30, v30, v30
    v_cvt_pk_bf16_f32 v31, v31, v31
    v_ashrrev_i32 v56, 31, v24
    v_ashrrev_i32 v57, 31, v25
    v_ashrrev_i32 v58, 31, v26
    v_ashrrev_i32 v59, 31, v27
    v_ashrrev_i32 v60, 31, v28
    v_ashrrev_i32 v61, 31, v29
    v_ashrrev_i32 v62, 31, v30
    v_ashrrev_i32 v63, 31, v31
    v_or_b32 v56, 0x80000000, v56
    v_or_b32 v57, 0x80000000, v57
    v_or_b32 v58, 0x80000000, v58
    v_or_b32 v59, 0x80000000, v59
    v_or_b32 v60, 0x80000000, v60
    v_or_b32 v61, 0x80000000, v61
    v_or_b32 v62, 0x80000000, v62
    v_or_b32 v63, 0x80000000, v63
    v_xor_b32 v24, v24, v56
    v_xor_b32 v25, v25, v57
    v_xor_b32 v26, v26, v58
    v_xor_b32 v27, v27, v59
    v_xor_b32 v28, v28, v60
    v_xor_b32 v29, v29, v61
    v_xor_b32 v30, v30, v62
    v_xor_b32 v31, v31, v63
    v_and_b32 v24, 0xffff0000, v24
    v_and_b32 v25, 0xffff0000, v25
    v_and_b32 v26, 0xffff0000, v26
    v_and_b32 v27, 0xffff0000, v27
    v_and_b32 v28, 0xffff0000, v28
    v_and_b32 v29, 0xffff0000, v29
    v_and_b32 v30, 0xffff0000, v30
    v_and_b32 v31, 0xffff0000, v31
    v_subrev_u32 v56, 0, v5
    v_subrev_u32 v57, 1, v5
    v_subrev_u32 v58, 2, v5
    v_subrev_u32 v59, 3, v5
    v_subrev_u32 v60, 4, v5
    v_subrev_u32 v61, 5, v5
    v_subrev_u32 v62, 6, v5
    v_subrev_u32 v63, 7, v5
    v_or_b32 v24, v24, v56
    v_or_b32 v25, v25, v57
    v_or_b32 v26, v26, v58
    v_or_b32 v27, v27, v59
    v_or_b32 v28, v28, v60
    v_or_b32 v29, v29, v61
    v_or_b32 v30, v30, v62
    v_or_b32 v31, v31, v63
    v_max_u32 v64, v24, v25
    v_min_u32 v65, v24, v25
    v_med3_u32 v65, v64, v26, v65
    v_max_u32 v64, v64, v26
    v_med3_u32 v65, v64, v27, v65
    v_max_u32 v64, v64, v27
    v_med3_u32 v65, v64, v28, v65
    v_max_u32 v64, v64, v28
    v_med3_u32 v65, v64, v29, v65
    v_max_u32 v64, v64, v29
    v_med3_u32 v65, v64, v30, v65
    v_max_u32 v64, v64, v30
    v_med3_u32 v65, v64, v31, v65
    v_max_u32 v64, v64, v31
    s_nop 1
    v_mov_b32_dpp v66, v64 quad_perm:[1,0,3,2] row_mask:0xf bank_mask:0xf
    v_mov_b32_dpp v67, v65 quad_perm:[1,0,3,2] row_mask:0xf bank_mask:0xf
    v_min_u32 v68, v64, v66
    v_max_u32 v64, v64, v66
    v_max3_u32 v65, v68, v65, v67
    s_nop 1
    v_mov_b32_dpp v66, v64 quad_perm:[2,3,0,1] row_mask:0xf bank_mask:0xf
    v_mov_b32_dpp v67, v65 quad_perm:[2,3,0,1] row_mask:0xf bank_mask:0xf
    v_min_u32 v68, v64, v66
    v_max_u32 v64, v64, v66
    v_max3_u32 v65, v68, v65, v67
    s_nop 1
    v_mov_b32_dpp v66, v64 row_half_mirror row_mask:0xf bank_mask:0xf
    v_mov_b32_dpp v67, v65 row_half_mirror row_mask:0xf bank_mask:0xf
    v_min_u32 v68, v64, v66
    v_max_u32 v64, v64, v66
    v_max3_u32 v65, v68, v65, v67
    s_nop 1
    v_mov_b32_dpp v66, v64 row_mirror row_mask:0xf bank_mask:0xf
    v_mov_b32_dpp v67, v65 row_mirror row_mask:0xf bank_mask:0xf
    v_min_u32 v68, v64, v66
    v_max_u32 v64, v64, v66
    v_max3_u32 v65, v68, v65, v67
    v_mov_b32 v66, v64
    v_mov_b32 v67, v65
    s_nop 1
    v_permlane16_swap_b32 v64, v66
    v_permlane16_swap_b32 v65, v67
    s_nop 0
    v_min_u32 v68, v64, v66
    v_max_u32 v64, v64, v66
    v_max3_u32 v65, v68, v65, v67
    v_mov_b32 v66, v64
    v_mov_b32 v67, v65
    s_nop 1
    v_permlane32_swap_b32 v64, v66
    v_permlane32_swap_b32 v65, v67
    s_nop 0
    v_min_u32 v68, v64, v66
    v_max_u32 v64, v64, v66
    v_max3_u32 v65, v68, v65, v67
    s_lshl_b32 s40, s3, 3
    s_add_u32 s40, s40, 102400
    v_mov_b32 v3, s40
    ds_write_b64 v3, v[64:65]
    v_mov_b32 v3, 102400
k4_x:
    ds_read_b128 v[72:75], v3
    ds_read_b128 v[76:79], v3 offset:16
    s_waitcnt lgkmcnt(0)
    v_min3_u32 v68, v72, v74, v76
    v_min_u32 v68, v68, v78
    v_cmp_eq_u32 vcc, 0, v68
    s_cbranch_vccnz k4_x
    v_min_u32 v68, v72, v74
    v_max_u32 v72, v72, v74
    v_max3_u32 v73, v68, v73, v75
    v_min_u32 v68, v76, v78
    v_max_u32 v76, v76, v78
    v_max3_u32 v77, v68, v77, v79
    v_min_u32 v68, v72, v76
    v_max_u32 v72, v72, v76
    v_max3_u32 v73, v68, v73, v77
    s_cmp_lt_u32 s3, 2
    s_cselect_b64 vcc, -1, 0
    v_cndmask_b32 v64, v73, v72, vcc
    v_and_b32 v65, 0xffff, v64
    v_sub_u32 v65, 2047, v65
    v_and_b32 v3, 2047, v47
    v_lshl_add_u32 v3, v65, 11, v3
    v_lshlrev_b32 v4, 2, v65
    buffer_load_dword v84, v4, s[12:15], 0 offen
    buffer_load_dword v85, v4, s[12:15], s41 offen
    buffer_load_dwordx4 v[80:83], v3, s[8:11], 0 offen
    s_waitcnt vmcnt(1)
    v_mul_f32 v84, 0x3a800000, v84
    v_mul_f32 v85, 0x3a800000, v85
    v_fma_f32 v85, -v84, v84, v85
    v_max_f32 v85, 0, v85
    v_cvt_pk_bf16_f32 v3, v84, v85
    v_lshlrev_b32 v84, 16, v3
    v_and_b32 v85, 0xffff0000, v3
    v_add_f32 v85, 0x3727c5ac, v85
    v_cvt_pk_bf16_f32 v85, v85, v85
    v_lshlrev_b32 v85, 16, v85
    v_sqrt_f32 v85, v85
    s_nop 0
    v_cvt_pk_bf16_f32 v85, v85, v85
    v_lshlrev_b32 v85, 16, v85
    v_rcp_f32 v85, v85
    s_nop 0
    s_waitcnt vmcnt(0)
    v_lshlrev_b32 v56, 16, v80
    v_lshlrev_b32 v58, 16, v81
    v_lshlrev_b32 v60, 16, v82
    v_lshlrev_b32 v62, 16, v83
    v_and_b32 v57, 0xffff0000, v80
    v_and_b32 v59, 0xffff0000, v81
    v_and_b32 v61, 0xffff0000, v82
    v_and_b32 v63, 0xffff0000, v83
    v_sub_f32 v56, v56, v84
    v_sub_f32 v58, v58, v84
    v_sub_f32 v60, v60, v84
    v_sub_f32 v62, v62, v84
    v_sub_f32 v57, v57, v84
    v_sub_f32 v59, v59, v84
    v_sub_f32 v61, v61, v84
    v_sub_f32 v63, v63, v84
    v_cvt_pk_bf16_f32 v57, v56, v57
    v_cvt_pk_bf16_f32 v59, v58, v59
    v_cvt_pk_bf16_f32 v61, v60, v61
    v_cvt_pk_bf16_f32 v63, v62, v63
    v_lshlrev_b32 v56, 16, v57
    v_lshlrev_b32 v58, 16, v59
    v_lshlrev_b32 v60, 16, v61
    v_lshlrev_b32 v62, 16, v63
    v_and_b32 v57, 0xffff0000, v57
    v_and_b32 v59, 0xffff0000, v59
    v_and_b32 v61, 0xffff0000, v61
    v_and_b32 v63, 0xffff0000, v63
    v_mul_f32 v56, v56, v85
    v_mul_f32 v58, v58, v85
    v_mul_f32 v60, v60, v85
    v_mul_f32 v62, v62, v85
    v_mul_f32 v57, v57, v85
    v_mul_f32 v59, v59, v85
    v_mul_f32 v61, v61, v85
    v_mul_f32 v63, v63, v85
    v_cvt_pk_bf16_f32 v88, v56, v57
    v_cvt_pk_bf16_f32 v89, v58, v59
    v_cvt_pk_bf16_f32 v90, v60, v61
    v_cvt_pk_bf16_f32 v91, v62, v63
    ds_write_b128 v46, v[88:91]
    buffer_store_dwordx4 v[88:91], v47, s[32:35], s56 offen
    buffer_store_dwordx4 v[80:83], v47, s[32:35], s57 offen
    buffer_store_dwordx2 v[72:73], off, s[32:35], s43
    s_waitcnt lgkmcnt(0)
    s_barrier
    ds_read_b64 v[56:57], v41 offset:0
    ds_read_b64 v[58:59], v41 offset:16
    ds_read_b64_tr_b16 v[8:9], v40 offset:0
    ds_read_b64_tr_b16 v[10:11], v40 offset:256
    ds_read_b64_tr_b16 v[92:93], v40 offset:32768
    ds_read_b64_tr_b16 v[94:95], v40 offset:33024
    ds_read_b64 v[60:61], v41 offset:64
    ds_read_b64 v[62:63], v41 offset:80
    ds_read_b64_tr_b16 v[12:13], v40 offset:1024
    ds_read_b64_tr_b16 v[14:15], v40 offset:1280
    ds_read_b64_tr_b16 v[96:97], v40 offset:33792
    ds_read_b64_tr_b16 v[98:99], v40 offset:34048
    s_waitcnt lgkmcnt(6)
    ds_read_b64 v[64:65], v41 offset:128
    ds_read_b64 v[66:67], v41 offset:144
    ds_read_b64_tr_b16 v[16:17], v40 offset:2048
    ds_read_b64_tr_b16 v[18:19], v40 offset:2304
    ds_read_b64_tr_b16 v[100:101], v40 offset:34816
    ds_read_b64_tr_b16 v[102:103], v40 offset:35072
    v_mfma_f32_16x16x32_bf16 v[48:51], v[8:11], v[56:59], 0
    v_mfma_f32_16x16x32_bf16 v[52:55], v[92:95], v[56:59], 0
    s_waitcnt lgkmcnt(6)
    ds_read_b64 v[68:69], v41 offset:192
    ds_read_b64 v[70:71], v41 offset:208
    ds_read_b64_tr_b16 v[20:21], v40 offset:3072
    ds_read_b64_tr_b16 v[22:23], v40 offset:3328
    ds_read_b64_tr_b16 v[104:105], v40 offset:35840
    ds_read_b64_tr_b16 v[106:107], v40 offset:36096
    v_mfma_f32_16x16x32_bf16 v[48:51], v[12:15], v[60:63], v[48:51]
    v_mfma_f32_16x16x32_bf16 v[52:55], v[96:99], v[60:63], v[52:55]
    s_waitcnt lgkmcnt(6)
    ds_read_b64 v[72:73], v41 offset:256
    ds_read_b64 v[74:75], v41 offset:272
    ds_read_b64_tr_b16 v[24:25], v40 offset:4096
    ds_read_b64_tr_b16 v[26:27], v40 offset:4352
    ds_read_b64_tr_b16 v[108:109], v40 offset:36864
    ds_read_b64_tr_b16 v[110:111], v40 offset:37120
    v_mfma_f32_16x16x32_bf16 v[48:51], v[16:19], v[64:67], v[48:51]
    v_mfma_f32_16x16x32_bf16 v[52:55], v[100:103], v[64:67], v[52:55]
    s_waitcnt lgkmcnt(6)
    ds_read_b64 v[76:77], v41 offset:320
    ds_read_b64 v[78:79], v41 offset:336
    ds_read_b64_tr_b16 v[28:29], v40 offset:5120
    ds_read_b64_tr_b16 v[30:31], v40 offset:5376
    ds_read_b64_tr_b16 v[112:113], v40 offset:37888
    ds_read_b64_tr_b16 v[114:115], v40 offset:38144
    v_mfma_f32_16x16x32_bf16 v[48:51], v[20:23], v[68:71], v[48:51]
    v_mfma_f32_16x16x32_bf16 v[52:55], v[104:107], v[68:71], v[52:55]
    s_waitcnt lgkmcnt(6)
    ds_read_b64 v[80:81], v41 offset:384
    ds_read_b64 v[82:83], v41 offset:400
    ds_read_b64_tr_b16 v[32:33], v40 offset:6144
    ds_read_b64_tr_b16 v[34:35], v40 offset:6400
    ds_read_b64_tr_b16 v[116:117], v40 offset:38912
    ds_read_b64_tr_b16 v[118:119], v40 offset:39168
    v_mfma_f32_16x16x32_bf16 v[48:51], v[24:27], v[72:75], v[48:51]
    v_mfma_f32_16x16x32_bf16 v[52:55], v[108:111], v[72:75], v[52:55]
    s_waitcnt lgkmcnt(6)
    ds_read_b64 v[84:85], v41 offset:448
    ds_read_b64 v[86:87], v41 offset:464
    ds_read_b64_tr_b16 v[36:37], v40 offset:7168
    ds_read_b64_tr_b16 v[38:39], v40 offset:7424
    ds_read_b64_tr_b16 v[120:121], v40 offset:39936
    ds_read_b64_tr_b16 v[122:123], v40 offset:40192
    v_mfma_f32_16x16x32_bf16 v[48:51], v[28:31], v[76:79], v[48:51]
    v_mfma_f32_16x16x32_bf16 v[52:55], v[112:115], v[76:79], v[52:55]
    s_waitcnt lgkmcnt(6)
    v_mfma_f32_16x16x32_bf16 v[48:51], v[32:35], v[80:83], v[48:51]
    v_mfma_f32_16x16x32_bf16 v[52:55], v[116:119], v[80:83], v[52:55]
    s_waitcnt lgkmcnt(0)
    v_mfma_f32_16x16x32_bf16 v[48:51], v[36:39], v[84:87], v[48:51]
    v_mfma_f32_16x16x32_bf16 v[52:55], v[120:123], v[84:87], v[52:55]
    ds_read_b64_tr_b16 v[8:9], v42 offset:0
    ds_read_b64_tr_b16 v[10:11], v42 offset:32
    ds_read_b64_tr_b16 v[12:13], v42 offset:64
    ds_read_b64_tr_b16 v[14:15], v42 offset:96
    ds_read_b64_tr_b16 v[16:17], v42 offset:2048
    ds_read_b64_tr_b16 v[18:19], v42 offset:2080
    ds_read_b64_tr_b16 v[20:21], v42 offset:2112
    ds_read_b64_tr_b16 v[22:23], v42 offset:2144
    ds_write_b128 v43, v[48:51]
    ds_write_b128 v43, v[52:55] offset:4096
    s_waitcnt lgkmcnt(0)
    s_barrier
    ds_read_b128 v[60:63], v44 offset:0
    ds_read_b128 v[76:79], v44 offset:4096
    ds_read_b128 v[64:67], v44 offset:1024
    ds_read_b128 v[80:83], v44 offset:5120
    ds_read_b128 v[68:71], v44 offset:2048
    ds_read_b128 v[84:87], v44 offset:6144
    ds_read_b128 v[72:75], v44 offset:3072
    ds_read_b128 v[88:91], v44 offset:7168
    ds_read_b64_tr_b16 v[24:25], v42 offset:4096
    ds_read_b64_tr_b16 v[26:27], v42 offset:4128
    ds_read_b64_tr_b16 v[28:29], v42 offset:4160
    ds_read_b64_tr_b16 v[30:31], v42 offset:4192
    ds_read_b64_tr_b16 v[32:33], v42 offset:6144
    ds_read_b64_tr_b16 v[34:35], v42 offset:6176
    s_waitcnt lgkmcnt(6)
    ds_read_b64_tr_b16 v[36:37], v42 offset:6208
    ds_read_b64_tr_b16 v[38:39], v42 offset:6240
    v_add_f32 v60, v60, v64
    v_add_f32 v61, v61, v65
    v_add_f32 v62, v62, v66
    v_add_f32 v63, v63, v67
    v_add_f32 v68, v68, v72
    v_add_f32 v69, v69, v73
    v_add_f32 v70, v70, v74
    v_add_f32 v71, v71, v75
    v_add_f32 v76, v76, v80
    v_add_f32 v77, v77, v81
    v_add_f32 v78, v78, v82
    v_add_f32 v79, v79, v83
    v_add_f32 v84, v84, v88
    v_add_f32 v85, v85, v89
    v_add_f32 v86, v86, v90
    v_add_f32 v87, v87, v91
    v_add_f32 v60, v60, v68
    v_add_f32 v61, v61, v69
    v_add_f32 v62, v62, v70
    v_add_f32 v63, v63, v71
    v_add_f32 v76, v76, v84
    v_add_f32 v77, v77, v85
    v_add_f32 v78, v78, v86
    v_add_f32 v79, v79, v87
    v_cvt_pk_bf16_f32 v76, v60, v76
    v_cvt_pk_bf16_f32 v77, v61, v77
    v_cvt_pk_bf16_f32 v78, v62, v78
    v_cvt_pk_bf16_f32 v79, v63, v79
    v_lshlrev_b32 v60, 16, v76
    v_lshlrev_b32 v61, 16, v77
    v_lshlrev_b32 v62, 16, v78
    v_lshlrev_b32 v63, 16, v79
    v_and_b32 v76, 0xffff0000, v76
    v_and_b32 v77, 0xffff0000, v77
    v_and_b32 v78, 0xffff0000, v78
    v_and_b32 v79, 0xffff0000, v79
    v_mul_f32 v92, 0xbfb8aa3b, v60
    v_mul_f32 v93, 0xbfb8aa3b, v61
    v_mul_f32 v94, 0xbfb8aa3b, v62
    v_mul_f32 v95, 0xbfb8aa3b, v63
    v_exp_f32 v92, v92
    v_exp_f32 v93, v93
    v_exp_f32 v94, v94
    v_exp_f32 v95, v95
    v_add_f32 v92, 1.0, v92
    v_add_f32 v93, 1.0, v93
    v_add_f32 v94, 1.0, v94
    v_add_f32 v95, 1.0, v95
    v_rcp_f32 v92, v92
    v_rcp_f32 v93, v93
    v_rcp_f32 v94, v94
    v_rcp_f32 v95, v95
    v_mul_f32 v60, v60, v92
    v_mul_f32 v61, v61, v93
    v_mul_f32 v62, v62, v94
    v_mul_f32 v63, v63, v95
    v_cvt_pk_bf16_f32 v60, v60, v60
    v_cvt_pk_bf16_f32 v61, v61, v61
    v_cvt_pk_bf16_f32 v62, v62, v62
    v_cvt_pk_bf16_f32 v63, v63, v63
    v_lshlrev_b32 v60, 16, v60
    v_lshlrev_b32 v61, 16, v61
    v_lshlrev_b32 v62, 16, v62
    v_lshlrev_b32 v63, 16, v63
    v_mul_f32 v60, v60, v76
    v_mul_f32 v61, v61, v77
    v_mul_f32 v62, v62, v78
    v_mul_f32 v63, v63, v79
    v_cvt_pk_bf16_f32 v48, v60, v61
    v_cvt_pk_bf16_f32 v49, v62, v63
    s_waitcnt lgkmcnt(0)
    s_nop 0
    v_mfma_f32_16x16x16_bf16 v[60:63], v[8:9], v[48:49], 0
    v_mfma_f32_16x16x16_bf16 v[64:67], v[10:11], v[48:49], 0
    v_mfma_f32_16x16x16_bf16 v[68:71], v[12:13], v[48:49], 0
    v_mfma_f32_16x16x16_bf16 v[72:75], v[14:15], v[48:49], 0
    v_mfma_f32_16x16x16_bf16 v[76:79], v[16:17], v[48:49], 0
    v_mfma_f32_16x16x16_bf16 v[80:83], v[18:19], v[48:49], 0
    v_mfma_f32_16x16x16_bf16 v[84:87], v[20:21], v[48:49], 0
    v_mfma_f32_16x16x16_bf16 v[88:91], v[22:23], v[48:49], 0
    v_mfma_f32_16x16x16_bf16 v[92:95], v[24:25], v[48:49], 0
    buffer_store_dwordx4 v[60:63], v45, s[36:39], s55 offen offset:0
    v_mfma_f32_16x16x16_bf16 v[96:99], v[26:27], v[48:49], 0
    buffer_store_dwordx4 v[64:67], v45, s[36:39], s55 offen offset:64
    v_mfma_f32_16x16x16_bf16 v[100:103], v[28:29], v[48:49], 0
    buffer_store_dwordx4 v[68:71], v45, s[36:39], s55 offen offset:128
    v_mfma_f32_16x16x16_bf16 v[104:107], v[30:31], v[48:49], 0
    buffer_store_dwordx4 v[72:75], v45, s[36:39], s55 offen offset:192
    v_mfma_f32_16x16x16_bf16 v[108:111], v[32:33], v[48:49], 0
    buffer_store_dwordx4 v[76:79], v45, s[36:39], s55 offen offset:256
    v_mfma_f32_16x16x16_bf16 v[112:115], v[34:35], v[48:49], 0
    buffer_store_dwordx4 v[80:83], v45, s[36:39], s55 offen offset:320
    v_mfma_f32_16x16x16_bf16 v[116:119], v[36:37], v[48:49], 0
    buffer_store_dwordx4 v[84:87], v45, s[36:39], s55 offen offset:384
    v_mfma_f32_16x16x16_bf16 v[120:123], v[38:39], v[48:49], 0
    buffer_store_dwordx4 v[88:91], v45, s[36:39], s55 offen offset:448
    buffer_store_dwordx4 v[92:95], v45, s[36:39], s55 offen offset:512
    buffer_store_dwordx4 v[96:99], v45, s[36:39], s55 offen offset:576
    buffer_store_dwordx4 v[100:103], v45, s[36:39], s55 offen offset:640
    buffer_store_dwordx4 v[104:107], v45, s[36:39], s55 offen offset:704
    buffer_store_dwordx4 v[108:111], v45, s[36:39], s55 offen offset:768
    buffer_store_dwordx4 v[112:115], v45, s[36:39], s55 offen offset:832
    buffer_store_dwordx4 v[116:119], v45, s[36:39], s55 offen offset:896
    buffer_store_dwordx4 v[120:123], v45, s[36:39], s55 offen offset:960
k4_done:
    s_endpgm

.globl k5_kernel
.p2align 8
.type k5_kernel,@function
k5_kernel:
    s_cmp_ge_u32 s2, 32
    s_cbranch_scc1 k5_done
    s_load_dwordx2 s[4:5], s[0:1], 88
    s_load_dwordx2 s[6:7], s[0:1], 104
    v_lshrrev_b32 v1, 6, v0
    v_and_b32 v2, 63, v0
    v_readfirstlane_b32 s3, v1
    s_waitcnt lgkmcnt(0)
    s_add_u32 s8, s6, 0x3900000
    s_addc_u32 s9, s7, 0
    s_mov_b32 s10, 0x1c0000
    s_mov_b32 s11, 0x00020000
    s_add_u32 s12, s6, 0x3810000
    s_addc_u32 s13, s7, 0
    s_mov_b32 s14, 0x3000
    s_mov_b32 s15, 0x00020000
    s_mov_b32 s16, s4
    s_mov_b32 s17, s5
    s_mov_b32 s18, 0x400000
    s_mov_b32 s19, 0x00020000
    v_lshrrev_b32 v3, 4, v0
    v_lshlrev_b32 v3, 13, v3
    v_and_b32 v4, 15, v0
    v_lshl_add_u32 v3, v4, 4, v3
    s_lshl_b32 s20, s2, 8
    s_add_u32 s21, s20, 0
    buffer_load_dwordx4 v[16:19], v3, s[8:11], s21 offen
    s_add_u32 s21, s20, 131072
    buffer_load_dwordx4 v[20:23], v3, s[8:11], s21 offen
    s_add_u32 s21, s20, 262144
    buffer_load_dwordx4 v[24:27], v3, s[8:11], s21 offen
    s_add_u32 s21, s20, 393216
    buffer_load_dwordx4 v[28:31], v3, s[8:11], s21 offen
    s_add_u32 s21, s20, 524288
    buffer_load_dwordx4 v[32:35], v3, s[8:11], s21 offen
    s_add_u32 s21, s20, 655360
    buffer_load_dwordx4 v[36:39], v3, s[8:11], s21 offen
    s_add_u32 s21, s20, 786432
    buffer_load_dwordx4 v[40:43], v3, s[8:11], s21 offen
    s_add_u32 s21, s20, 917504
    buffer_load_dwordx4 v[44:47], v3, s[8:11], s21 offen
    s_add_u32 s21, s20, 1048576
    buffer_load_dwordx4 v[48:51], v3, s[8:11], s21 offen
    s_add_u32 s21, s20, 1179648
    buffer_load_dwordx4 v[52:55], v3, s[8:11], s21 offen
    s_add_u32 s21, s20, 1310720
    buffer_load_dwordx4 v[56:59], v3, s[8:11], s21 offen
    s_add_u32 s21, s20, 1441792
    buffer_load_dwordx4 v[60:63], v3, s[8:11], s21 offen
    s_add_u32 s21, s20, 1572864
    buffer_load_dwordx4 v[64:67], v3, s[8:11], s21 offen
    s_add_u32 s21, s20, 1703936
    buffer_load_dwordx4 v[68:71], v3, s[8:11], s21 offen
    v_lshrrev_b32 v5, 4, v2
    v_and_b32 v6, 1, v5
    v_lshrrev_b32 v5, 1, v5
    v_lshl_add_u32 v5, v6, 1, v5
    v_lshl_add_u32 v5, v4, 2, v5
    s_lshl_b32 s22, s2, 6
    v_add_u32 v5, s22, v5
    v_lshlrev_b32 v6, 1, v5
    s_mov_b32 s23, 4096
    s_mov_b32 s24, 8192
    s_lshr_b32 s25, s2, 4
    s_lshl_b32 s25, s25, 2
    v_mov_b32 v7, 0
    buffer_load_ushort v8, v6, s[12:15], s23 offen
    buffer_load_ushort v9, v6, s[12:15], s24 offen
    buffer_load_dword v10, v7, s[12:15], s25 offen
    s_waitcnt vmcnt(15)
    v_add_f32 v16, v16, v20
    v_add_f32 v17, v17, v21
    v_add_f32 v18, v18, v22
    v_add_f32 v19, v19, v23
    s_waitcnt vmcnt(14)
    v_add_f32 v16, v16, v24
    v_add_f32 v17, v17, v25
    v_add_f32 v18, v18, v26
    v_add_f32 v19, v19, v27
    s_waitcnt vmcnt(13)
    v_add_f32 v16, v16, v28
    v_add_f32 v17, v17, v29
    v_add_f32 v18, v18, v30
    v_add_f32 v19, v19, v31
    s_waitcnt vmcnt(12)
    v_add_f32 v16, v16, v32
    v_add_f32 v17, v17, v33
    v_add_f32 v18, v18, v34
    v_add_f32 v19, v19, v35
    s_waitcnt vmcnt(11)
    v_add_f32 v16, v16, v36
    v_add_f32 v17, v17, v37
    v_add_f32 v18, v18, v38
    v_add_f32 v19, v19, v39
    s_waitcnt vmcnt(10)
    v_add_f32 v16, v16, v40
    v_add_f32 v17, v17, v41
    v_add_f32 v18, v18, v42
    v_add_f32 v19, v19, v43
    s_waitcnt vmcnt(9)
    v_add_f32 v16, v16, v44
    v_add_f32 v17, v17, v45
    v_add_f32 v18, v18, v46
    v_add_f32 v19, v19, v47
    s_waitcnt vmcnt(8)
    v_add_f32 v16, v16, v48
    v_add_f32 v17, v17, v49
    v_add_f32 v18, v18, v50
    v_add_f32 v19, v19, v51
    s_waitcnt vmcnt(7)
    v_add_f32 v16, v16, v52
    v_add_f32 v17, v17, v53
    v_add_f32 v18, v18, v54
    v_add_f32 v19, v19, v55
    s_waitcnt vmcnt(6)
    v_add_f32 v16, v16, v56
    v_add_f32 v17, v17, v57
    v_add_f32 v18, v18, v58
    v_add_f32 v19, v19, v59
    s_waitcnt vmcnt(5)
    v_add_f32 v16, v16, v60
    v_add_f32 v17, v17, v61
    v_add_f32 v18, v18, v62
    v_add_f32 v19, v19, v63
    s_waitcnt vmcnt(4)
    v_add_f32 v16, v16, v64
    v_add_f32 v17, v17, v65
    v_add_f32 v18, v18, v66
    v_add_f32 v19, v19, v67
    s_waitcnt vmcnt(3)
    v_add_f32 v16, v16, v68
    v_add_f32 v17, v17, v69
    v_add_f32 v18, v18, v70
    v_add_f32 v19, v19, v71
    s_nop 1
    v_permlane32_swap_b32 v16, v17
    v_permlane32_swap_b32 v18, v19
    s_nop 0
    v_add_f32 v16, v16, v17
    v_add_f32 v18, v18, v19
    s_nop 1
    v_permlane16_swap_b32 v16, v18
    s_nop 0
    v_add_f32 v16, v16, v18
    v_lshlrev_b32 v11, 2, v0
    ds_write_b32 v11, v16
    v_lshlrev_b32 v11, 2, v2
    s_waitcnt lgkmcnt(0)
    s_barrier
    s_cmp_lg_u32 s3, 0
    s_cbranch_scc1 k5_done
    ds_read_b32 v16, v11
    ds_read_b32 v17, v11 offset:256
    ds_read_b32 v18, v11 offset:512
    ds_read_b32 v19, v11 offset:768
    s_waitcnt vmcnt(0)
    v_and_b32 v12, 0xffff0000, v10
    v_not_b32 v13, v12
    v_ashrrev_i32 v13, 31, v13
    v_or_b32 v13, 0x80000000, v13
    v_xor_b32 v12, v12, v13
    v_and_b32 v12, 0xffff0000, v12
    v_mul_f32 v12, 0xbfb8aa3b, v12
    v_exp_f32 v12, v12
    s_nop 0
    v_add_f32 v12, 1.0, v12
    v_rcp_f32 v12, v12
    s_nop 0
    v_cvt_pk_bf16_f32 v12, v12, v12
    v_lshlrev_b32 v12, 16, v12
    v_and_b32 v10, 0xffff, v10
    v_sub_u32 v10, 2047, v10
    v_and_b32 v6, 2047, v6
    v_lshl_add_u32 v6, v10, 11, v6
    v_lshlrev_b32 v8, 16, v8
    v_lshlrev_b32 v9, 16, v9
    s_waitcnt lgkmcnt(0)
    v_add_f32 v16, v16, v17
    v_add_f32 v18, v18, v19
    v_add_f32 v16, v16, v18
    v_cvt_pk_bf16_f32 v16, v16, v16
    v_lshlrev_b32 v16, 16, v16
    v_mul_f32 v16, v16, v12
    v_cvt_pk_bf16_f32 v16, v16, v16
    v_lshlrev_b32 v16, 16, v16
    v_add_f32 v16, v16, v8
    v_cvt_pk_bf16_f32 v16, v16, v16
    v_lshlrev_b32 v16, 16, v16
    v_add_f32 v16, v16, v9
    v_cvt_pk_bf16_f32 v16, v16, v16
    buffer_store_short v16, v6, s[16:19], 0 offen
k5_done:
    s_endpgm

code_end:
.section .rodata,"a"
.p2align 6
.amdhsa_kernel ka_kernel
  .amdhsa_next_free_vgpr 512
  .amdhsa_next_free_sgpr 102
  .amdhsa_accum_offset 256
  .amdhsa_group_segment_fixed_size 0
  .amdhsa_kernarg_size 112
  .amdhsa_user_sgpr_count 2
  .amdhsa_user_sgpr_kernarg_segment_ptr 1
  .amdhsa_system_sgpr_workgroup_id_x 1
  .amdhsa_float_denorm_mode_32 3
.end_amdhsa_kernel

.p2align 6
.amdhsa_kernel kb_kernel
  .amdhsa_next_free_vgpr 320
  .amdhsa_next_free_sgpr 102
  .amdhsa_accum_offset 256
  .amdhsa_group_segment_fixed_size 0
  .amdhsa_kernarg_size 112
  .amdhsa_user_sgpr_count 2
  .amdhsa_user_sgpr_kernarg_segment_ptr 1
  .amdhsa_system_sgpr_workgroup_id_x 1
  .amdhsa_float_denorm_mode_32 3
.end_amdhsa_kernel

.p2align 6
.amdhsa_kernel k4_kernel
  .amdhsa_next_free_vgpr 128
  .amdhsa_next_free_sgpr 102
  .amdhsa_accum_offset 128
  .amdhsa_group_segment_fixed_size 0
  .amdhsa_kernarg_size 112
  .amdhsa_user_sgpr_count 2
  .amdhsa_user_sgpr_kernarg_segment_ptr 1
  .amdhsa_system_sgpr_workgroup_id_x 1
  .amdhsa_float_denorm_mode_32 3
.end_amdhsa_kernel

.p2align 6
.amdhsa_kernel k5_kernel
  .amdhsa_next_free_vgpr 80
  .amdhsa_next_free_sgpr 102
  .amdhsa_accum_offset 80
  .amdhsa_group_segment_fixed_size 0
  .amdhsa_kernarg_size 112
  .amdhsa_user_sgpr_count 2
  .amdhsa_user_sgpr_kernarg_segment_ptr 1
  .amdhsa_system_sgpr_workgroup_id_x 1
  .amdhsa_float_denorm_mode_32 3
.end_amdhsa_kernel
```

```asm
; @launch grid=(256,1,1) block=(256,1,1) lds=163840
.amdgcn_target "amdgcn-amd-amdhsa--gfx950"
.text
.globl sequential_preLN__compressed_kv_cla__moe_arch_mod__prompt_kernel
.p2align 8
.type sequential_preLN__compressed_kv_cla__moe_arch_mod__prompt_kernel,@function
sequential_preLN__compressed_kv_cla__moe_arch_mod__prompt_kernel:
    s_cmp_ge_u32 s2, 256
    s_cbranch_scc1 ka_done
    s_load_dwordx8 s[64:71], s[0:1], 0
    s_load_dwordx4 s[72:75], s[0:1], 32
    s_load_dwordx4 s[76:79], s[0:1], 64
    s_load_dwordx8 s[80:87], s[0:1], 80
    v_lshrrev_b32 v1, 6, v0
    v_and_b32 v2, 63, v0
    v_readfirstlane_b32 s3, v1
    v_mov_b32 v253, v0
    s_and_b32 s4, s2, 7
    s_lshl_b32 s4, s4, 2
    s_lshr_b32 s24, s2, 3
    s_and_b32 s24, s24, 3
    s_add_u32 s4, s4, s24
    s_lshr_b32 s5, s2, 5
    s_lshl2_add_u32 s6, s5, s3
    s_getpc_b64 s[56:57]
ka_pc:
    s_mov_b32 s58, code_end-ka_pc
    s_mov_b32 s59, 0x00020000
    s_lshr_b32 s24, s2, 3
    s_lshl2_add_u32 s24, s24, s3
    s_lshl_b32 s24, s24, 13
    v_lshlrev_b32 v3, 7, v2
    buffer_load_dword v252, v3, s[56:59], s24 offen
    v_mov_b32 v192, v2
    v_lshrrev_b32 v198, 3, v192
    v_and_b32 v199, 7, v192
    s_lshr_b32 s24, s3, 1
    s_lshl_b32 s24, s24, 5
    s_and_b32 s25, s3, 1
    s_lshl_b32 s26, s25, 3
    s_add_u32 s24, s24, s26
    v_add_u32 v194, s24, v198
    v_lshlrev_b32 v194, 10, v194
    v_lshrrev_b32 v195, 1, v198
    v_xor_b32 v195, v199, v195
    v_lshl_add_u32 v232, v195, 4, v194
    v_xor_b32 v195, 4, v195
    v_lshl_add_u32 v233, v195, 4, v194
    v_add_u32 v233, 15360, v233
    s_lshl_b32 s24, s4, 8
    s_lshl_b32 s26, s25, 7
    s_add_u32 s24, s24, s26
    v_lshlrev_b32 v194, 13, v198
    v_add_u32 v194, s24, v194
    v_bfe_u32 v195, v198, 1, 1
    v_xor_b32 v195, v199, v195
    v_lshl_add_u32 v234, v195, 4, v194
    v_xor_b32 v195, 4, v195
    v_lshl_add_u32 v235, v195, 4, v194
    v_add_u32 v235, 64512, v235
    s_lshl_b32 s34, s3, 11
    s_mul_i32 s35, s3, 24576
    s_add_u32 s35, s35, 65536
    s_lshl_b32 s32, s5, 18
    s_lshl_b32 s24, s5, 7
    s_sub_u32 s26, 1792, s24
    s_cmp_lt_u32 s4, 16
    s_cselect_b32 s24, s24, s26
    s_lshl_b32 s26, s4, 3
    s_add_u32 s24, s24, s26
    v_lshrrev_b32 v194, 5, v253
    v_add_u32 v196, s24, v194
    v_and_b32 v195, 31, v192
    v_lshlrev_b32 v196, 11, v196
    v_lshl_add_u32 v236, v195, 4, v196
    v_xor_b32 v194, v194, v199
    v_lshlrev_b32 v194, 4, v194
    v_lshl_add_u32 v194, v195, 7, v194
    v_add_u32 v237, 81920, v194
    s_lshr_b32 s26, s24, 5
    s_lshl_b32 s26, s26, 16
    s_and_b32 s24, s24, 31
    s_lshl_b32 s24, s24, 4
    s_add_u32 s24, s24, s26
    v_lshrrev_b32 v194, 3, v253
    v_lshlrev_b32 v194, 9, v194
    v_xor_b32 v195, v199, v198
    v_lshl_add_u32 v194, v195, 4, v194
    v_add_u32 v238, s24, v194
    s_waitcnt lgkmcnt(0)
    s_cmp_lt_u32 s3, 2
    s_cselect_b32 s48, s70, s72
    s_cselect_b32 s49, s71, s73
    s_mov_b32 s50, 0x400000
    s_mov_b32 s51, 0x00020000
    s_mov_b32 s44, s66
    s_mov_b32 s45, s67
    s_mov_b32 s46, 0x200000
    s_mov_b32 s47, 0x00020000
    s_mov_b32 s52, s64
    s_mov_b32 s53, s65
    s_mov_b32 s54, 0x400000
    s_mov_b32 s55, 0x00020000
    s_mov_b32 s12, s68
    s_mov_b32 s13, s69
    s_mov_b32 s14, 0x800000
    s_mov_b32 s15, 0x00020000
    s_add_u32 s16, s86, 0x5c00000
    s_addc_u32 s17, s87, 0
    s_mov_b32 s18, 0x2140000
    s_mov_b32 s19, 0x00020000
    s_mov_b32 s8, s86
    s_mov_b32 s9, s87
    s_mov_b32 s10, 0x400000
    s_mov_b32 s11, 0x00020000
    s_add_u32 s56, s86, 0x3800000
    s_addc_u32 s57, s87, 0
    s_mov_b32 s58, 0x6040
    s_mov_b32 s59, 0x00020000
    s_add_u32 s20, s86, 0x2400000
    s_addc_u32 s21, s87, 0
    s_mov_b32 s22, 0x1000000
    s_mov_b32 s23, 0x00020000
    s_mov_b32 s88, s84
    s_mov_b32 s89, s85
    s_mov_b32 s90, 0x100
    s_mov_b32 s91, 0x00020000
    s_cmp_lt_u32 s3, 2
    s_cselect_b32 s60, s74, s80
    s_cselect_b32 s61, s75, s81
    s_mov_b32 s62, 0x700000
    s_cselect_b32 s62, 0x800000, s62
    s_mov_b32 s63, 0x00020000
    s_cselect_b32 s41, s76, s78
    s_cselect_b32 s42, s77, s79
    s_and_b32 s7, s4, 3
    s_lshl1_add_u32 s7, s7, s5
    s_and_b32 s7, s7, 7
    s_add_u32 s80, s7, 0
    s_and_b32 s80, s80, 7
    s_lshl_b32 s80, s80, 7
    s_add_u32 s80, s80, s32
    s_add_u32 s81, s7, 1
    s_and_b32 s81, s81, 7
    s_lshl_b32 s81, s81, 7
    s_add_u32 s81, s81, s32
    s_add_u32 s82, s7, 2
    s_and_b32 s82, s82, 7
    s_lshl_b32 s82, s82, 7
    s_add_u32 s82, s82, s32
    s_add_u32 s83, s7, 3
    s_and_b32 s83, s83, 7
    s_lshl_b32 s83, s83, 7
    s_add_u32 s83, s83, s32
    s_add_u32 s84, s7, 4
    s_and_b32 s84, s84, 7
    s_lshl_b32 s84, s84, 7
    s_add_u32 s84, s84, s32
    s_add_u32 s85, s7, 5
    s_and_b32 s85, s85, 7
    s_lshl_b32 s85, s85, 7
    s_add_u32 s85, s85, s32
    s_add_u32 s86, s7, 6
    s_and_b32 s86, s86, 7
    s_lshl_b32 s86, s86, 7
    s_add_u32 s86, s86, s32
    s_add_u32 s87, s7, 7
    s_and_b32 s87, s87, 7
    s_lshl_b32 s87, s87, 7
    s_add_u32 s87, s87, s32
    s_add_u32 m0, s35, 0
    s_and_b32 s33, s80, 1023
    s_lshl_b32 s33, s33, 12
    buffer_load_dwordx4 v234, s[48:51], s33 offen lds
    buffer_load_dwordx4 v235, s[48:51], s33 offen offset:1024 lds
    s_add_u32 m0, s35, 2048
    s_add_u32 s33, s33, 131072
    buffer_load_dwordx4 v234, s[48:51], s33 offen lds
    buffer_load_dwordx4 v235, s[48:51], s33 offen offset:1024 lds
    s_add_u32 m0, s35, 4096
    s_add_u32 s33, s33, 131072
    buffer_load_dwordx4 v234, s[48:51], s33 offen lds
    buffer_load_dwordx4 v235, s[48:51], s33 offen offset:1024 lds
    s_add_u32 m0, s35, 6144
    s_add_u32 s33, s33, 131072
    buffer_load_dwordx4 v234, s[48:51], s33 offen lds
    buffer_load_dwordx4 v235, s[48:51], s33 offen offset:1024 lds
    s_add_u32 m0, s34, 0
    s_add_u32 s37, s80, 0
    buffer_load_dwordx4 v232, s[44:47], s37 offen lds
    buffer_load_dwordx4 v233, s[44:47], s37 offen offset:1024 lds
    s_add_u32 m0, s34, 8192
    s_add_u32 s37, s81, 0
    buffer_load_dwordx4 v232, s[44:47], s37 offen lds
    buffer_load_dwordx4 v233, s[44:47], s37 offen offset:1024 lds
    s_add_u32 m0, s35, 8192
    s_and_b32 s33, s81, 1023
    s_lshl_b32 s33, s33, 12
    buffer_load_dwordx4 v234, s[48:51], s33 offen lds
    buffer_load_dwordx4 v235, s[48:51], s33 offen offset:1024 lds
    s_add_u32 m0, s35, 10240
    s_add_u32 s33, s33, 131072
    buffer_load_dwordx4 v234, s[48:51], s33 offen lds
    buffer_load_dwordx4 v235, s[48:51], s33 offen offset:1024 lds
    s_add_u32 m0, s35, 12288
    s_add_u32 s33, s33, 131072
    buffer_load_dwordx4 v234, s[48:51], s33 offen lds
    buffer_load_dwordx4 v235, s[48:51], s33 offen offset:1024 lds
    s_add_u32 m0, s35, 14336
    s_add_u32 s33, s33, 131072
    buffer_load_dwordx4 v234, s[48:51], s33 offen lds
    buffer_load_dwordx4 v235, s[48:51], s33 offen offset:1024 lds
    v_and_b32 v200, 15, v192
    v_lshrrev_b32 v201, 4, v192
    v_lshrrev_b32 v194, 1, v200
    v_xor_b32 v194, v201, v194
    v_lshlrev_b32 v194, 4, v194
    v_lshl_add_u32 v224, v200, 7, v194
    v_xor_b32 v225, 64, v224
    v_add_u32 v226, 98304, v224
    v_add_u32 v227, 98304, v225
    v_lshrrev_b32 v194, 2, v200
    v_lshl_add_u32 v195, v201, 3, v194
    v_lshlrev_b32 v195, 7, v195
    v_add_u32 v195, s35, v195
    v_and_b32 v196, 1, v200
    v_lshl_add_u32 v195, v196, 3, v195
    v_lshrrev_b32 v194, 1, v194
    v_and_b32 v196, 1, v201
    v_lshl_or_b32 v194, v196, 2, v194
    v_and_b32 v196, 2, v200
    v_xor_b32 v194, v194, v196
    v_xor_b32 v196, 0, v194
    v_lshl_add_u32 v228, v196, 4, v195
    v_xor_b32 v196, 1, v194
    v_lshl_add_u32 v229, v196, 4, v195
    v_xor_b32 v196, 4, v194
    v_lshl_add_u32 v230, v196, 4, v195
    v_xor_b32 v196, 5, v194
    v_lshl_add_u32 v231, v196, 4, v195
    s_mul_i32 s36, s4, 1089536
    s_mul_i32 s24, s5, 136192
    s_add_u32 s36, s36, s24
    s_and_b32 s24, s3, 1
    s_lshl_b32 s24, s24, 12
    s_and_b32 s26, s3, 2
    s_lshl_b32 s26, s26, 13
    s_add_u32 s36, s36, s24
    s_add_u32 s36, s36, s26
    v_bfe_u32 v194, v192, 3, 1
    v_lshlrev_b32 v194, 10, v194
    v_lshrrev_b32 v195, 5, v192
    v_lshl_add_u32 v194, v195, 8, v194
    v_bfe_u32 v195, v192, 4, 1
    v_lshl_add_u32 v194, v195, 7, v194
    v_lshl_add_u32 v239, v199, 4, v194
    v_lshlrev_b32 v240, 4, v192
    s_lshl_b32 s24, s3, 12
    v_add_u32 v242, s24, v240
    s_lshl_b32 s24, s6, 16
    v_add_u32 v248, s24, v240
    s_sub_u32 s25, 63, s6
    s_lshl_b32 s24, s25, 16
    v_add_u32 v249, s24, v240
    v_bfe_u32 v194, v192, 2, 2
    v_lshlrev_b32 v194, 13, v194
    v_lshl_add_u32 v194, v201, 6, v194
    v_and_b32 v195, 3, v192
    v_lshl_add_u32 v194, v195, 4, v194
    s_lshl_b32 s24, s4, 8
    s_lshl_b32 s25, s3, 18
    s_add_u32 s24, s24, s25
    v_add_u32 v245, s24, v194
    s_lshl_b32 s31, s3, 13
    s_add_u32 s31, s31, 65536
    s_lshl_b32 s27, s5, 20
    s_mov_b32 s7, s27
    s_mov_b32 s43, 0x40000000
    s_lshr_b32 s28, s27, 7
    s_add_u32 s29, s28, 4096
    s_nop 0
    v_lshrrev_b32 v194, 5, v192
    v_lshlrev_b32 v194, 11, v194
    v_bfe_u32 v195, v192, 2, 2
    v_lshl_add_u32 v194, v195, 6, v194
    v_bfe_u32 v195, v192, 4, 1
    v_lshl_add_u32 v194, v195, 5, v194
    v_and_b32 v195, 3, v192
    v_lshl_add_u32 v247, v195, 3, v194
    s_mov_b32 s30, 65536
    v_add_u32 v246, s30, v247
    v_and_b32 v194, 31, v192
    v_lshrrev_b32 v195, 5, v192
    v_lshlrev_b32 v195, 2, v195
    v_sub_u32 v194, v194, v195
    v_cvt_f32_i32 v194, v194
    v_add_f32 v194, 0.5, v194
    v_mul_f32 v243, 0x71800000, v194
    v_bfe_u32 v194, v192, 4, 1
    v_lshlrev_b32 v194, 17, v194
    v_lshrrev_b32 v195, 5, v192
    v_lshl_add_u32 v194, v195, 8, v194
    v_lshl_add_u32 v244, v200, 4, v194
    v_lshlrev_b32 v251, 7, v192
    v_cmp_gt_u32 vcc, 16, v192
    v_mov_b32 v194, 0x40000000
    v_mov_b32 v255, 1
    v_cndmask_b32 v251, v194, v251, vcc
    v_cmp_eq_u32 vcc, 0, v253
    s_nop 1
    v_cndmask_b32 v250, v194, v253, vcc
    buffer_load_dwordx4 v[0:3], v236, s[52:55], 0 offen offset:0
    buffer_load_dwordx4 v[4:7], v236, s[52:55], 0 offen offset:512
    buffer_load_dwordx4 v[8:11], v236, s[52:55], 0 offen offset:1024
    buffer_load_dwordx4 v[12:15], v236, s[52:55], 0 offen offset:1536
    s_waitcnt vmcnt(12)
    s_barrier
    ds_read_b128 v[160:163], v224 offset:0
    ds_read_b128 v[164:167], v224 offset:2048
    ds_read_b128 v[168:171], v224 offset:4096
    ds_read_b128 v[172:175], v224 offset:6144
    ds_read_b64_tr_b16 a[0:1], v228 offset:0
    ds_read_b64_tr_b16 a[2:3], v228 offset:512
    ds_read_b64_tr_b16 a[4:5], v229 offset:0
    ds_read_b64_tr_b16 a[6:7], v229 offset:512
    ds_read_b64_tr_b16 a[8:9], v230 offset:0
    ds_read_b64_tr_b16 a[10:11], v230 offset:512
    ds_read_b64_tr_b16 a[12:13], v231 offset:0
    ds_read_b64_tr_b16 a[14:15], v231 offset:512
    s_cmp_lt_u32 s3, 2
    s_cbranch_scc0 ka_V
    s_waitcnt lgkmcnt(0)
    v_mfma_f32_16x16x32_bf16 v[96:99], a[0:3], v[160:163], 0
    ds_read_b128 v[176:179], v225 offset:0
    ds_read_b128 v[180:183], v225 offset:2048
    v_mfma_f32_16x16x32_bf16 v[100:103], a[4:7], v[160:163], 0
    ds_read_b128 v[184:187], v225 offset:4096
    v_mfma_f32_16x16x32_bf16 v[104:107], a[8:11], v[160:163], 0
    ds_read_b128 v[188:191], v225 offset:6144
    ds_read_b64_tr_b16 a[16:17], v228 offset:4096
    v_mfma_f32_16x16x32_bf16 v[108:111], a[12:15], v[160:163], 0
    ds_read_b64_tr_b16 a[18:19], v228 offset:4608
    v_mfma_f32_16x16x32_bf16 v[112:115], a[0:3], v[164:167], 0
    ds_read_b64_tr_b16 a[20:21], v229 offset:4096
    ds_read_b64_tr_b16 a[22:23], v229 offset:4608
    s_add_u32 m0, s34, 16384
    s_add_u32 s37, s82, 0
    buffer_load_dwordx4 v232, s[44:47], s37 offen lds
    v_mfma_f32_16x16x32_bf16 v[116:119], a[4:7], v[164:167], 0
    ds_read_b64_tr_b16 a[24:25], v230 offset:4096
    buffer_load_dwordx4 v233, s[44:47], s37 offen offset:1024 lds
    v_mfma_f32_16x16x32_bf16 v[120:123], a[8:11], v[164:167], 0
    ds_read_b64_tr_b16 a[26:27], v230 offset:4608
    ds_read_b64_tr_b16 a[28:29], v231 offset:4096
    s_add_u32 m0, s34, 24576
    s_add_u32 s37, s83, 0
    buffer_load_dwordx4 v232, s[44:47], s37 offen lds
    v_mfma_f32_16x16x32_bf16 v[124:127], a[12:15], v[164:167], 0
    ds_read_b64_tr_b16 a[30:31], v231 offset:4608
    buffer_load_dwordx4 v233, s[44:47], s37 offen offset:1024 lds
    v_mfma_f32_16x16x32_bf16 v[128:131], a[0:3], v[168:171], 0
    s_add_u32 m0, s35, 16384
    s_and_b32 s33, s82, 1023
    s_lshl_b32 s33, s33, 12
    buffer_load_dwordx4 v234, s[48:51], s33 offen lds
    v_mfma_f32_16x16x32_bf16 v[132:135], a[4:7], v[168:171], 0
    buffer_load_dwordx4 v235, s[48:51], s33 offen offset:1024 lds
    v_mfma_f32_16x16x32_bf16 v[136:139], a[8:11], v[168:171], 0
    s_add_u32 m0, s35, 18432
    s_add_u32 s33, s33, 131072
    buffer_load_dwordx4 v234, s[48:51], s33 offen lds
    v_mfma_f32_16x16x32_bf16 v[140:143], a[12:15], v[168:171], 0
    buffer_load_dwordx4 v235, s[48:51], s33 offen offset:1024 lds
    v_mfma_f32_16x16x32_bf16 v[144:147], a[0:3], v[172:175], 0
    s_add_u32 m0, s35, 20480
    s_add_u32 s33, s33, 131072
    buffer_load_dwordx4 v234, s[48:51], s33 offen lds
    v_mfma_f32_16x16x32_bf16 v[148:151], a[4:7], v[172:175], 0
    buffer_load_dwordx4 v235, s[48:51], s33 offen offset:1024 lds
    v_mfma_f32_16x16x32_bf16 v[152:155], a[8:11], v[172:175], 0
    s_add_u32 m0, s35, 22528
    s_add_u32 s33, s33, 131072
    buffer_load_dwordx4 v234, s[48:51], s33 offen lds
    v_mfma_f32_16x16x32_bf16 v[156:159], a[12:15], v[172:175], 0
    buffer_load_dwordx4 v235, s[48:51], s33 offen offset:1024 lds
    s_waitcnt vmcnt(16) lgkmcnt(0)
    v_mfma_f32_16x16x32_bf16 v[96:99], a[16:19], v[176:179], v[96:99]
    ds_read_b128 v[160:163], v224 offset:8192
    ds_read_b128 v[164:167], v224 offset:10240
    v_mfma_f32_16x16x32_bf16 v[100:103], a[20:23], v[176:179], v[100:103]
    ds_read_b128 v[168:171], v224 offset:12288
    v_mfma_f32_16x16x32_bf16 v[104:107], a[24:27], v[176:179], v[104:107]
    ds_read_b128 v[172:175], v224 offset:14336
    ds_read_b64_tr_b16 a[32:33], v228 offset:8192
    v_mfma_f32_16x16x32_bf16 v[108:111], a[28:31], v[176:179], v[108:111]
    ds_read_b64_tr_b16 a[34:35], v228 offset:8704
    v_mfma_f32_16x16x32_bf16 v[112:115], a[16:19], v[180:183], v[112:115]
    ds_read_b64_tr_b16 a[36:37], v229 offset:8192
    ds_read_b64_tr_b16 a[38:39], v229 offset:8704
    s_add_u32 m0, s35, 0
    s_and_b32 s33, s83, 1023
    s_lshl_b32 s33, s33, 12
    buffer_load_dwordx4 v234, s[48:51], s33 offen lds
    v_mfma_f32_16x16x32_bf16 v[116:119], a[20:23], v[180:183], v[116:119]
    ds_read_b64_tr_b16 a[40:41], v230 offset:8192
    buffer_load_dwordx4 v235, s[48:51], s33 offen offset:1024 lds
    v_mfma_f32_16x16x32_bf16 v[120:123], a[24:27], v[180:183], v[120:123]
    ds_read_b64_tr_b16 a[42:43], v230 offset:8704
    ds_read_b64_tr_b16 a[44:45], v231 offset:8192
    s_add_u32 m0, s35, 2048
    s_add_u32 s33, s33, 131072
    buffer_load_dwordx4 v234, s[48:51], s33 offen lds
    v_mfma_f32_16x16x32_bf16 v[124:127], a[28:31], v[180:183], v[124:127]
    ds_read_b64_tr_b16 a[46:47], v231 offset:8704
    buffer_load_dwordx4 v235, s[48:51], s33 offen offset:1024 lds
    v_mfma_f32_16x16x32_bf16 v[128:131], a[16:19], v[184:187], v[128:131]
    s_add_u32 m0, s35, 4096
    s_add_u32 s33, s33, 131072
    buffer_load_dwordx4 v234, s[48:51], s33 offen lds
    v_mfma_f32_16x16x32_bf16 v[132:135], a[20:23], v[184:187], v[132:135]
    buffer_load_dwordx4 v235, s[48:51], s33 offen offset:1024 lds
    v_mfma_f32_16x16x32_bf16 v[136:139], a[24:27], v[184:187], v[136:139]
    s_add_u32 m0, s35, 6144
    s_add_u32 s33, s33, 131072
    buffer_load_dwordx4 v234, s[48:51], s33 offen lds
    v_mfma_f32_16x16x32_bf16 v[140:143], a[28:31], v[184:187], v[140:143]
    buffer_load_dwordx4 v235, s[48:51], s33 offen offset:1024 lds
    v_mfma_f32_16x16x32_bf16 v[144:147], a[16:19], v[188:191], v[144:147]
    v_mfma_f32_16x16x32_bf16 v[148:151], a[20:23], v[188:191], v[148:151]
    v_mfma_f32_16x16x32_bf16 v[152:155], a[24:27], v[188:191], v[152:155]
    v_mfma_f32_16x16x32_bf16 v[156:159], a[28:31], v[188:191], v[156:159]
    s_waitcnt lgkmcnt(0)
    v_mfma_f32_16x16x32_bf16 v[96:99], a[32:35], v[160:163], v[96:99]
    ds_read_b128 v[176:179], v225 offset:8192
    ds_read_b128 v[180:183], v225 offset:10240
    v_mfma_f32_16x16x32_bf16 v[100:103], a[36:39], v[160:163], v[100:103]
    ds_read_b128 v[184:187], v225 offset:12288
    v_mfma_f32_16x16x32_bf16 v[104:107], a[40:43], v[160:163], v[104:107]
    ds_read_b128 v[188:191], v225 offset:14336
    ds_read_b64_tr_b16 a[48:49], v228 offset:12288
    v_mfma_f32_16x16x32_bf16 v[108:111], a[44:47], v[160:163], v[108:111]
    ds_read_b64_tr_b16 a[50:51], v228 offset:12800
    v_mfma_f32_16x16x32_bf16 v[112:115], a[32:35], v[164:167], v[112:115]
    ds_read_b64_tr_b16 a[52:53], v229 offset:12288
    ds_read_b64_tr_b16 a[54:55], v229 offset:12800
    v_mfma_f32_16x16x32_bf16 v[116:119], a[36:39], v[164:167], v[116:119]
    ds_read_b64_tr_b16 a[56:57], v230 offset:12288
    s_add_u32 m0, s34, 32768
    s_add_u32 s37, s84, 0
    buffer_load_dwordx4 v232, s[44:47], s37 offen lds
    v_mfma_f32_16x16x32_bf16 v[120:123], a[40:43], v[164:167], v[120:123]
    ds_read_b64_tr_b16 a[58:59], v230 offset:12800
    ds_read_b64_tr_b16 a[60:61], v231 offset:12288
    v_mfma_f32_16x16x32_bf16 v[124:127], a[44:47], v[164:167], v[124:127]
    ds_read_b64_tr_b16 a[62:63], v231 offset:12800
    buffer_load_dwordx4 v233, s[44:47], s37 offen offset:1024 lds
    v_mfma_f32_16x16x32_bf16 v[128:131], a[32:35], v[168:171], v[128:131]
    v_mfma_f32_16x16x32_bf16 v[132:135], a[36:39], v[168:171], v[132:135]
    s_add_u32 m0, s34, 40960
    s_add_u32 s37, s85, 0
    buffer_load_dwordx4 v232, s[44:47], s37 offen lds
    v_mfma_f32_16x16x32_bf16 v[136:139], a[40:43], v[168:171], v[136:139]
    v_mfma_f32_16x16x32_bf16 v[140:143], a[44:47], v[168:171], v[140:143]
    buffer_load_dwordx4 v233, s[44:47], s37 offen offset:1024 lds
    v_mfma_f32_16x16x32_bf16 v[144:147], a[32:35], v[172:175], v[144:147]
    v_mfma_f32_16x16x32_bf16 v[148:151], a[36:39], v[172:175], v[148:151]
    v_mfma_f32_16x16x32_bf16 v[152:155], a[40:43], v[172:175], v[152:155]
    v_mfma_f32_16x16x32_bf16 v[156:159], a[44:47], v[172:175], v[156:159]
    s_waitcnt vmcnt(12) lgkmcnt(0)
    s_barrier
    v_mfma_f32_16x16x32_bf16 v[96:99], a[48:51], v[176:179], v[96:99]
    ds_read_b128 v[160:163], v224 offset:16384
    ds_read_b128 v[164:167], v224 offset:18432
    s_waitcnt vmcnt(24)
    v_mfma_f32_16x16x32_bf16 v[100:103], a[52:55], v[176:179], v[100:103]
    ds_read_b128 v[168:171], v224 offset:20480
    v_lshlrev_b32 v16, 16, v0
    v_and_b32 v17, 0xffff0000, v0
    v_mfma_f32_16x16x32_bf16 v[104:107], a[56:59], v[176:179], v[104:107]
    ds_read_b128 v[172:175], v224 offset:22528
    ds_read_b64_tr_b16 a[64:65], v228 offset:16384
    v_lshlrev_b32 v18, 16, v1
    v_mfma_f32_16x16x32_bf16 v[108:111], a[60:63], v[176:179], v[108:111]
    ds_read_b64_tr_b16 a[66:67], v228 offset:16896
    v_and_b32 v19, 0xffff0000, v1
    v_lshlrev_b32 v20, 16, v2
    v_mfma_f32_16x16x32_bf16 v[112:115], a[48:51], v[180:183], v[112:115]
    ds_read_b64_tr_b16 a[68:69], v229 offset:16384
    ds_read_b64_tr_b16 a[70:71], v229 offset:16896
    s_add_u32 m0, s35, 8192
    s_and_b32 s33, s84, 1023
    s_lshl_b32 s33, s33, 12
    buffer_load_dwordx4 v234, s[48:51], s33 offen lds
    v_mfma_f32_16x16x32_bf16 v[116:119], a[52:55], v[180:183], v[116:119]
    ds_read_b64_tr_b16 a[72:73], v230 offset:16384
    buffer_load_dwordx4 v235, s[48:51], s33 offen offset:1024 lds
    v_and_b32 v21, 0xffff0000, v2
    v_lshlrev_b32 v22, 16, v3
    v_mfma_f32_16x16x32_bf16 v[120:123], a[56:59], v[180:183], v[120:123]
    ds_read_b64_tr_b16 a[74:75], v230 offset:16896
    ds_read_b64_tr_b16 a[76:77], v231 offset:16384
    s_add_u32 m0, s35, 10240
    s_add_u32 s33, s33, 131072
    buffer_load_dwordx4 v234, s[48:51], s33 offen lds
    v_mfma_f32_16x16x32_bf16 v[124:127], a[60:63], v[180:183], v[124:127]
    ds_read_b64_tr_b16 a[78:79], v231 offset:16896
    buffer_load_dwordx4 v235, s[48:51], s33 offen offset:1024 lds
    v_and_b32 v23, 0xffff0000, v3
    v_mfma_f32_16x16x32_bf16 v[128:131], a[48:51], v[184:187], v[128:131]
    s_add_u32 m0, s35, 12288
    s_add_u32 s33, s33, 131072
    buffer_load_dwordx4 v234, s[48:51], s33 offen lds
    v_mfma_f32_16x16x32_bf16 v[132:135], a[52:55], v[184:187], v[132:135]
    buffer_load_dwordx4 v235, s[48:51], s33 offen offset:1024 lds
    v_lshlrev_b32 v24, 16, v4
    v_and_b32 v25, 0xffff0000, v4
    v_mfma_f32_16x16x32_bf16 v[136:139], a[56:59], v[184:187], v[136:139]
    s_add_u32 m0, s35, 14336
    s_add_u32 s33, s33, 131072
    buffer_load_dwordx4 v234, s[48:51], s33 offen lds
    v_lshlrev_b32 v26, 16, v5
    v_mfma_f32_16x16x32_bf16 v[140:143], a[60:63], v[184:187], v[140:143]
    buffer_load_dwordx4 v235, s[48:51], s33 offen offset:1024 lds
    v_and_b32 v27, 0xffff0000, v5
    v_lshlrev_b32 v28, 16, v6
    v_mfma_f32_16x16x32_bf16 v[144:147], a[48:51], v[188:191], v[144:147]
    v_and_b32 v29, 0xffff0000, v6
    v_lshlrev_b32 v30, 16, v7
    v_mfma_f32_16x16x32_bf16 v[148:151], a[52:55], v[188:191], v[148:151]
    v_and_b32 v31, 0xffff0000, v7
    v_lshlrev_b32 v32, 16, v8
    v_and_b32 v33, 0xffff0000, v8
    v_mfma_f32_16x16x32_bf16 v[152:155], a[56:59], v[188:191], v[152:155]
    v_lshlrev_b32 v34, 16, v9
    v_and_b32 v35, 0xffff0000, v9
    v_mfma_f32_16x16x32_bf16 v[156:159], a[60:63], v[188:191], v[156:159]
    v_lshlrev_b32 v36, 16, v10
    v_and_b32 v37, 0xffff0000, v10
    s_waitcnt lgkmcnt(0)
    v_mfma_f32_16x16x32_bf16 v[96:99], a[64:67], v[160:163], v[96:99]
    ds_read_b128 v[176:179], v225 offset:16384
    ds_read_b128 v[180:183], v225 offset:18432
    v_lshlrev_b32 v38, 16, v11
    v_and_b32 v39, 0xffff0000, v11
    v_mfma_f32_16x16x32_bf16 v[100:103], a[68:71], v[160:163], v[100:103]
    ds_read_b128 v[184:187], v225 offset:20480
    v_lshlrev_b32 v40, 16, v12
    v_and_b32 v41, 0xffff0000, v12
    v_mfma_f32_16x16x32_bf16 v[104:107], a[72:75], v[160:163], v[104:107]
    ds_read_b128 v[188:191], v225 offset:22528
    ds_read_b64_tr_b16 a[80:81], v228 offset:20480
    v_lshlrev_b32 v42, 16, v13
    v_mfma_f32_16x16x32_bf16 v[108:111], a[76:79], v[160:163], v[108:111]
    ds_read_b64_tr_b16 a[82:83], v228 offset:20992
    v_and_b32 v43, 0xffff0000, v13
    v_lshlrev_b32 v44, 16, v14
    v_mfma_f32_16x16x32_bf16 v[112:115], a[64:67], v[164:167], v[112:115]
    ds_read_b64_tr_b16 a[84:85], v229 offset:20480
    ds_read_b64_tr_b16 a[86:87], v229 offset:20992
    v_and_b32 v45, 0xffff0000, v14
    v_mfma_f32_16x16x32_bf16 v[116:119], a[68:71], v[164:167], v[116:119]
    ds_read_b64_tr_b16 a[88:89], v230 offset:20480
    s_add_u32 m0, s34, 49152
    s_add_u32 s37, s86, 0
    buffer_load_dwordx4 v232, s[44:47], s37 offen lds
    v_mfma_f32_16x16x32_bf16 v[120:123], a[72:75], v[164:167], v[120:123]
    ds_read_b64_tr_b16 a[90:91], v230 offset:20992
    ds_read_b64_tr_b16 a[92:93], v231 offset:20480
    v_lshlrev_b32 v46, 16, v15
    v_mfma_f32_16x16x32_bf16 v[124:127], a[76:79], v[164:167], v[124:127]
    ds_read_b64_tr_b16 a[94:95], v231 offset:20992
    buffer_load_dwordx4 v233, s[44:47], s37 offen offset:1024 lds
    v_and_b32 v47, 0xffff0000, v15
    v_mfma_f32_16x16x32_bf16 v[128:131], a[64:67], v[168:171], v[128:131]
    v_add_f32 v52, v16, v20
    v_add_f32 v53, v17, v21
    v_add_f32 v54, v18, v22
    v_mfma_f32_16x16x32_bf16 v[132:135], a[68:71], v[168:171], v[132:135]
    s_add_u32 m0, s34, 57344
    s_add_u32 s37, s87, 0
    buffer_load_dwordx4 v232, s[44:47], s37 offen lds
    v_add_f32 v55, v19, v23
    v_mfma_f32_16x16x32_bf16 v[136:139], a[72:75], v[168:171], v[136:139]
    v_add_f32 v52, v52, v24
    v_add_f32 v53, v53, v25
    v_mfma_f32_16x16x32_bf16 v[140:143], a[76:79], v[168:171], v[140:143]
    buffer_load_dwordx4 v233, s[44:47], s37 offen offset:1024 lds
    v_add_f32 v54, v54, v26
    v_add_f32 v55, v55, v27
    v_mfma_f32_16x16x32_bf16 v[144:147], a[64:67], v[172:175], v[144:147]
    v_add_f32 v52, v52, v28
    v_add_f32 v53, v53, v29
    v_add_f32 v54, v54, v30
    v_mfma_f32_16x16x32_bf16 v[148:151], a[68:71], v[172:175], v[148:151]
    v_add_f32 v55, v55, v31
    v_add_f32 v52, v52, v32
    v_mfma_f32_16x16x32_bf16 v[152:155], a[72:75], v[172:175], v[152:155]
    v_add_f32 v53, v53, v33
    v_add_f32 v54, v54, v34
    v_add_f32 v55, v55, v35
    v_mfma_f32_16x16x32_bf16 v[156:159], a[76:79], v[172:175], v[156:159]
    v_add_f32 v52, v52, v36
    v_add_f32 v53, v53, v37
    s_waitcnt vmcnt(16) lgkmcnt(0)
    v_mfma_f32_16x16x32_bf16 v[96:99], a[80:83], v[176:179], v[96:99]
    ds_read_b128 v[160:163], v224 offset:24576
    ds_read_b128 v[164:167], v224 offset:26624
    v_add_f32 v54, v54, v38
    v_mfma_f32_16x16x32_bf16 v[100:103], a[84:87], v[176:179], v[100:103]
    ds_read_b128 v[168:171], v224 offset:28672
    v_add_f32 v55, v55, v39
    v_add_f32 v52, v52, v40
    v_mfma_f32_16x16x32_bf16 v[104:107], a[88:91], v[176:179], v[104:107]
    ds_read_b128 v[172:175], v224 offset:30720
    ds_read_b64_tr_b16 a[96:97], v228 offset:0
    v_add_f32 v53, v53, v41
    v_mfma_f32_16x16x32_bf16 v[108:111], a[92:95], v[176:179], v[108:111]
    ds_read_b64_tr_b16 a[98:99], v228 offset:512
    v_add_f32 v54, v54, v42
    v_add_f32 v55, v55, v43
    v_mfma_f32_16x16x32_bf16 v[112:115], a[80:83], v[180:183], v[112:115]
    ds_read_b64_tr_b16 a[100:101], v229 offset:0
    ds_read_b64_tr_b16 a[102:103], v229 offset:512
    s_add_u32 m0, s35, 16384
    s_and_b32 s33, s85, 1023
    s_lshl_b32 s33, s33, 12
    buffer_load_dwordx4 v234, s[48:51], s33 offen lds
    v_mfma_f32_16x16x32_bf16 v[116:119], a[84:87], v[180:183], v[116:119]
    ds_read_b64_tr_b16 a[104:105], v230 offset:0
    buffer_load_dwordx4 v235, s[48:51], s33 offen offset:1024 lds
    v_add_f32 v52, v52, v44
    v_mfma_f32_16x16x32_bf16 v[120:123], a[88:91], v[180:183], v[120:123]
    ds_read_b64_tr_b16 a[106:107], v230 offset:512
    ds_read_b64_tr_b16 a[108:109], v231 offset:0
    s_add_u32 m0, s35, 18432
    s_add_u32 s33, s33, 131072
    buffer_load_dwordx4 v234, s[48:51], s33 offen lds
    v_mfma_f32_16x16x32_bf16 v[124:127], a[92:95], v[180:183], v[124:127]
    ds_read_b64_tr_b16 a[110:111], v231 offset:512
    buffer_load_dwordx4 v235, s[48:51], s33 offen offset:1024 lds
    v_add_f32 v53, v53, v45
    v_mfma_f32_16x16x32_bf16 v[128:131], a[80:83], v[184:187], v[128:131]
    s_add_u32 m0, s35, 20480
    s_add_u32 s33, s33, 131072
    buffer_load_dwordx4 v234, s[48:51], s33 offen lds
    v_add_f32 v54, v54, v46
    v_mfma_f32_16x16x32_bf16 v[132:135], a[84:87], v[184:187], v[132:135]
    buffer_load_dwordx4 v235, s[48:51], s33 offen offset:1024 lds
    v_add_f32 v55, v55, v47
    v_add_f32 v52, v52, v53
    v_mfma_f32_16x16x32_bf16 v[136:139], a[88:91], v[184:187], v[136:139]
    s_add_u32 m0, s35, 22528
    s_add_u32 s33, s33, 131072
    buffer_load_dwordx4 v234, s[48:51], s33 offen lds
    v_mfma_f32_16x16x32_bf16 v[140:143], a[92:95], v[184:187], v[140:143]
    buffer_load_dwordx4 v235, s[48:51], s33 offen offset:1024 lds
    v_add_f32 v54, v54, v55
    v_add_f32 v48, v52, v54
    v_mfma_f32_16x16x32_bf16 v[144:147], a[80:83], v[188:191], v[144:147]
    s_nop 1
    v_add_f32_dpp v48, v48, v48 quad_perm:[1,0,3,2] row_mask:0xf bank_mask:0xf
    s_nop 1
    v_mfma_f32_16x16x32_bf16 v[148:151], a[84:87], v[188:191], v[148:151]
    v_add_f32_dpp v48, v48, v48 quad_perm:[2,3,0,1] row_mask:0xf bank_mask:0xf
    s_nop 1
    v_mfma_f32_16x16x32_bf16 v[152:155], a[88:91], v[188:191], v[152:155]
    v_add_f32_dpp v48, v48, v48 row_half_mirror row_mask:0xf bank_mask:0xf
    s_nop 1
    v_add_f32_dpp v48, v48, v48 row_mirror row_mask:0xf bank_mask:0xf
    v_mfma_f32_16x16x32_bf16 v[156:159], a[92:95], v[188:191], v[156:159]
    s_nop 0
    v_mov_b32 v49, v48
    s_waitcnt lgkmcnt(0)
    v_mfma_f32_16x16x32_bf16 v[96:99], a[96:99], v[160:163], v[96:99]
    ds_read_b128 v[176:179], v225 offset:24576
    ds_read_b128 v[180:183], v225 offset:26624
    s_nop 1
    v_mfma_f32_16x16x32_bf16 v[100:103], a[100:103], v[160:163], v[100:103]
    ds_read_b128 v[184:187], v225 offset:28672
    v_permlane16_swap_b32 v48, v49
    s_nop 0
    v_mfma_f32_16x16x32_bf16 v[104:107], a[104:107], v[160:163], v[104:107]
    ds_read_b128 v[188:191], v225 offset:30720
    ds_read_b64_tr_b16 a[112:113], v228 offset:4096
    v_add_f32 v48, v48, v49
    v_mfma_f32_16x16x32_bf16 v[108:111], a[108:111], v[160:163], v[108:111]
    ds_read_b64_tr_b16 a[114:115], v228 offset:4608
    v_mul_f32 v48, 0x3a800000, v48
    v_sub_f32 v56, v16, v48
    v_mfma_f32_16x16x32_bf16 v[112:115], a[96:99], v[164:167], v[112:115]
    ds_read_b64_tr_b16 a[116:117], v229 offset:4096
    ds_read_b64_tr_b16 a[118:119], v229 offset:4608
    v_mul_f32 v52, v56, v56
    v_mfma_f32_16x16x32_bf16 v[116:119], a[100:103], v[164:167], v[116:119]
    ds_read_b64_tr_b16 a[120:121], v230 offset:4096
    v_sub_f32 v57, v17, v48
    v_mul_f32 v53, v57, v57
    v_mfma_f32_16x16x32_bf16 v[120:123], a[104:107], v[164:167], v[120:123]
    ds_read_b64_tr_b16 a[122:123], v230 offset:4608
    ds_read_b64_tr_b16 a[124:125], v231 offset:4096
    v_sub_f32 v58, v18, v48
    v_mul_f32 v54, v58, v58
    v_mfma_f32_16x16x32_bf16 v[124:127], a[108:111], v[164:167], v[124:127]
    ds_read_b64_tr_b16 a[126:127], v231 offset:4608
    v_sub_f32 v59, v19, v48
    v_mfma_f32_16x16x32_bf16 v[128:131], a[96:99], v[168:171], v[128:131]
    v_mul_f32 v55, v59, v59
    v_sub_f32 v56, v20, v48
    v_fmac_f32 v52, v56, v56
    v_mfma_f32_16x16x32_bf16 v[132:135], a[100:103], v[168:171], v[132:135]
    v_sub_f32 v57, v21, v48
    v_fmac_f32 v53, v57, v57
    v_sub_f32 v58, v22, v48
    v_mfma_f32_16x16x32_bf16 v[136:139], a[104:107], v[168:171], v[136:139]
    v_fmac_f32 v54, v58, v58
    v_sub_f32 v59, v23, v48
    v_mfma_f32_16x16x32_bf16 v[140:143], a[108:111], v[168:171], v[140:143]
    v_fmac_f32 v55, v59, v59
    v_sub_f32 v56, v24, v48
    v_fmac_f32 v52, v56, v56
    v_mfma_f32_16x16x32_bf16 v[144:147], a[96:99], v[172:175], v[144:147]
    v_sub_f32 v57, v25, v48
    v_fmac_f32 v53, v57, v57
    v_mfma_f32_16x16x32_bf16 v[148:151], a[100:103], v[172:175], v[148:151]
    v_sub_f32 v58, v26, v48
    v_fmac_f32 v54, v58, v58
    v_sub_f32 v59, v27, v48
    v_mfma_f32_16x16x32_bf16 v[152:155], a[104:107], v[172:175], v[152:155]
    v_fmac_f32 v55, v59, v59
    v_sub_f32 v56, v28, v48
    v_mfma_f32_16x16x32_bf16 v[156:159], a[108:111], v[172:175], v[156:159]
    v_fmac_f32 v52, v56, v56
    s_waitcnt vmcnt(12) lgkmcnt(0)
    s_barrier
    v_mfma_f32_16x16x32_bf16 v[96:99], a[112:115], v[176:179], v[96:99]
    ds_read_b128 v[160:163], v224 offset:32768
    ds_read_b128 v[164:167], v224 offset:34816
    v_sub_f32 v57, v29, v48
    v_fmac_f32 v53, v57, v57
    v_mfma_f32_16x16x32_bf16 v[100:103], a[116:119], v[176:179], v[100:103]
    ds_read_b128 v[168:171], v224 offset:36864
    v_sub_f32 v58, v30, v48
    v_fmac_f32 v54, v58, v58
    v_mfma_f32_16x16x32_bf16 v[104:107], a[120:123], v[176:179], v[104:107]
    ds_read_b128 v[172:175], v224 offset:38912
    ds_read_b64_tr_b16 a[128:129], v228 offset:8192
    v_sub_f32 v59, v31, v48
    v_mfma_f32_16x16x32_bf16 v[108:111], a[124:127], v[176:179], v[108:111]
    ds_read_b64_tr_b16 a[130:131], v228 offset:8704
    v_fmac_f32 v55, v59, v59
    v_sub_f32 v56, v32, v48
    v_mfma_f32_16x16x32_bf16 v[112:115], a[112:115], v[180:183], v[112:115]
    ds_read_b64_tr_b16 a[132:133], v229 offset:8192
    ds_read_b64_tr_b16 a[134:135], v229 offset:8704
    s_add_u32 m0, s35, 0
    s_and_b32 s33, s86, 1023
    s_lshl_b32 s33, s33, 12
    buffer_load_dwordx4 v234, s[48:51], s33 offen lds
    v_mfma_f32_16x16x32_bf16 v[116:119], a[116:119], v[180:183], v[116:119]
    ds_read_b64_tr_b16 a[136:137], v230 offset:8192
    buffer_load_dwordx4 v235, s[48:51], s33 offen offset:1024 lds
    v_fmac_f32 v52, v56, v56
    v_mfma_f32_16x16x32_bf16 v[120:123], a[120:123], v[180:183], v[120:123]
    ds_read_b64_tr_b16 a[138:139], v230 offset:8704
    ds_read_b64_tr_b16 a[140:141], v231 offset:8192
    s_add_u32 m0, s35, 2048
    s_add_u32 s33, s33, 131072
    buffer_load_dwordx4 v234, s[48:51], s33 offen lds
    v_mfma_f32_16x16x32_bf16 v[124:127], a[124:127], v[180:183], v[124:127]
    ds_read_b64_tr_b16 a[142:143], v231 offset:8704
    buffer_load_dwordx4 v235, s[48:51], s33 offen offset:1024 lds
    v_sub_f32 v57, v33, v48
    v_mfma_f32_16x16x32_bf16 v[128:131], a[112:115], v[184:187], v[128:131]
    s_add_u32 m0, s35, 4096
    s_add_u32 s33, s33, 131072
    buffer_load_dwordx4 v234, s[48:51], s33 offen lds
    v_fmac_f32 v53, v57, v57
    v_mfma_f32_16x16x32_bf16 v[132:135], a[116:119], v[184:187], v[132:135]
    buffer_load_dwordx4 v235, s[48:51], s33 offen offset:1024 lds
    v_sub_f32 v58, v34, v48
    v_fmac_f32 v54, v58, v58
    v_mfma_f32_16x16x32_bf16 v[136:139], a[120:123], v[184:187], v[136:139]
    s_add_u32 m0, s35, 6144
    s_add_u32 s33, s33, 131072
    buffer_load_dwordx4 v234, s[48:51], s33 offen lds
    v_mfma_f32_16x16x32_bf16 v[140:143], a[124:127], v[184:187], v[140:143]
    buffer_load_dwordx4 v235, s[48:51], s33 offen offset:1024 lds
    v_sub_f32 v59, v35, v48
    v_fmac_f32 v55, v59, v59
    v_mfma_f32_16x16x32_bf16 v[144:147], a[112:115], v[188:191], v[144:147]
    v_sub_f32 v56, v36, v48
    v_fmac_f32 v52, v56, v56
    v_sub_f32 v57, v37, v48
    v_mfma_f32_16x16x32_bf16 v[148:151], a[116:119], v[188:191], v[148:151]
    v_fmac_f32 v53, v57, v57
    v_sub_f32 v58, v38, v48
    v_mfma_f32_16x16x32_bf16 v[152:155], a[120:123], v[188:191], v[152:155]
    v_fmac_f32 v54, v58, v58
    v_sub_f32 v59, v39, v48
    v_fmac_f32 v55, v59, v59
    v_mfma_f32_16x16x32_bf16 v[156:159], a[124:127], v[188:191], v[156:159]
    v_sub_f32 v56, v40, v48
    v_fmac_f32 v52, v56, v56
    s_waitcnt lgkmcnt(0)
    v_mfma_f32_16x16x32_bf16 v[96:99], a[128:131], v[160:163], v[96:99]
    ds_read_b128 v[176:179], v225 offset:32768
    ds_read_b128 v[180:183], v225 offset:34816
    v_sub_f32 v57, v41, v48
    v_mfma_f32_16x16x32_bf16 v[100:103], a[132:135], v[160:163], v[100:103]
    ds_read_b128 v[184:187], v225 offset:36864
    v_fmac_f32 v53, v57, v57
    v_sub_f32 v58, v42, v48
    v_mfma_f32_16x16x32_bf16 v[104:107], a[136:139], v[160:163], v[104:107]
    ds_read_b128 v[188:191], v225 offset:38912
    ds_read_b64_tr_b16 a[144:145], v228 offset:12288
    v_fmac_f32 v54, v58, v58
    v_mfma_f32_16x16x32_bf16 v[108:111], a[140:143], v[160:163], v[108:111]
    ds_read_b64_tr_b16 a[146:147], v228 offset:12800
    v_sub_f32 v59, v43, v48
    v_fmac_f32 v55, v59, v59
    v_mfma_f32_16x16x32_bf16 v[112:115], a[128:131], v[164:167], v[112:115]
    ds_read_b64_tr_b16 a[148:149], v229 offset:12288
    ds_read_b64_tr_b16 a[150:151], v229 offset:12800
    v_sub_f32 v56, v44, v48
    v_mfma_f32_16x16x32_bf16 v[116:119], a[132:135], v[164:167], v[116:119]
    ds_read_b64_tr_b16 a[152:153], v230 offset:12288
    s_add_u32 m0, s34, 0
    s_add_u32 s37, s80, 65536
    buffer_load_dwordx4 v232, s[44:47], s37 offen lds
    v_mfma_f32_16x16x32_bf16 v[120:123], a[136:139], v[164:167], v[120:123]
    ds_read_b64_tr_b16 a[154:155], v230 offset:12800
    ds_read_b64_tr_b16 a[156:157], v231 offset:12288
    v_fmac_f32 v52, v56, v56
    v_sub_f32 v57, v45, v48
    v_mfma_f32_16x16x32_bf16 v[124:127], a[140:143], v[164:167], v[124:127]
    ds_read_b64_tr_b16 a[158:159], v231 offset:12800
    buffer_load_dwordx4 v233, s[44:47], s37 offen offset:1024 lds
    v_fmac_f32 v53, v57, v57
    v_mfma_f32_16x16x32_bf16 v[128:131], a[128:131], v[168:171], v[128:131]
    v_sub_f32 v58, v46, v48
    v_fmac_f32 v54, v58, v58
    v_mfma_f32_16x16x32_bf16 v[132:135], a[132:135], v[168:171], v[132:135]
    s_add_u32 m0, s34, 8192
    s_add_u32 s37, s81, 65536
    buffer_load_dwordx4 v232, s[44:47], s37 offen lds
    v_sub_f32 v59, v47, v48
    v_mfma_f32_16x16x32_bf16 v[136:139], a[136:139], v[168:171], v[136:139]
    v_fmac_f32 v55, v59, v59
    v_add_f32 v52, v52, v53
    v_add_f32 v54, v54, v55
    v_mfma_f32_16x16x32_bf16 v[140:143], a[140:143], v[168:171], v[140:143]
    buffer_load_dwordx4 v233, s[44:47], s37 offen offset:1024 lds
    v_add_f32 v51, v52, v54
    v_mfma_f32_16x16x32_bf16 v[144:147], a[128:131], v[172:175], v[144:147]
    s_nop 1
    v_add_f32_dpp v51, v51, v51 quad_perm:[1,0,3,2] row_mask:0xf bank_mask:0xf
    s_nop 1
    v_mfma_f32_16x16x32_bf16 v[148:151], a[132:135], v[172:175], v[148:151]
    v_add_f32_dpp v51, v51, v51 quad_perm:[2,3,0,1] row_mask:0xf bank_mask:0xf
    s_nop 1
    v_add_f32_dpp v51, v51, v51 row_half_mirror row_mask:0xf bank_mask:0xf
    v_mfma_f32_16x16x32_bf16 v[152:155], a[136:139], v[172:175], v[152:155]
    s_nop 1
    v_add_f32_dpp v51, v51, v51 row_mirror row_mask:0xf bank_mask:0xf
    v_mfma_f32_16x16x32_bf16 v[156:159], a[140:143], v[172:175], v[156:159]
    s_nop 0
    v_mov_b32 v49, v51
    s_waitcnt vmcnt(12) lgkmcnt(0)
    v_mfma_f32_16x16x32_bf16 v[96:99], a[144:147], v[176:179], v[96:99]
    ds_read_b128 v[160:163], v224 offset:40960
    ds_read_b128 v[164:167], v224 offset:43008
    s_nop 1
    v_mfma_f32_16x16x32_bf16 v[100:103], a[148:151], v[176:179], v[100:103]
    ds_read_b128 v[168:171], v224 offset:45056
    v_permlane16_swap_b32 v51, v49
    s_nop 0
    v_mfma_f32_16x16x32_bf16 v[104:107], a[152:155], v[176:179], v[104:107]
    ds_read_b128 v[172:175], v224 offset:47104
    ds_read_b64_tr_b16 a[160:161], v228 offset:16384
    v_add_f32 v51, v51, v49
    v_mfma_f32_16x16x32_bf16 v[108:111], a[156:159], v[176:179], v[108:111]
    ds_read_b64_tr_b16 a[162:163], v228 offset:16896
    v_mul_f32 v51, 0x3a800000, v51
    v_cvt_pk_bf16_f32 v50, v48, v51
    v_mfma_f32_16x16x32_bf16 v[112:115], a[144:147], v[180:183], v[112:115]
    ds_read_b64_tr_b16 a[164:165], v229 offset:16384
    ds_read_b64_tr_b16 a[166:167], v229 offset:16896
    s_add_u32 m0, s35, 8192
    s_and_b32 s33, s87, 1023
    s_lshl_b32 s33, s33, 12
    buffer_load_dwordx4 v234, s[48:51], s33 offen lds
    v_mfma_f32_16x16x32_bf16 v[116:119], a[148:151], v[180:183], v[116:119]
    ds_read_b64_tr_b16 a[168:169], v230 offset:16384
    buffer_load_dwordx4 v235, s[48:51], s33 offen offset:1024 lds
    v_and_b32 v51, 0xffff0000, v50
    v_mfma_f32_16x16x32_bf16 v[120:123], a[152:155], v[180:183], v[120:123]
    ds_read_b64_tr_b16 a[170:171], v230 offset:16896
    ds_read_b64_tr_b16 a[172:173], v231 offset:16384
    s_add_u32 m0, s35, 10240
    s_add_u32 s33, s33, 131072
    buffer_load_dwordx4 v234, s[48:51], s33 offen lds
    v_mfma_f32_16x16x32_bf16 v[124:127], a[156:159], v[180:183], v[124:127]
    ds_read_b64_tr_b16 a[174:175], v231 offset:16896
    buffer_load_dwordx4 v235, s[48:51], s33 offen offset:1024 lds
    v_lshlrev_b32 v50, 16, v50
    v_add_f32 v51, 0x3727c5ac, v51
    v_mfma_f32_16x16x32_bf16 v[128:131], a[144:147], v[184:187], v[128:131]
    s_add_u32 m0, s35, 12288
    s_add_u32 s33, s33, 131072
    buffer_load_dwordx4 v234, s[48:51], s33 offen lds
    v_mfma_f32_16x16x32_bf16 v[132:135], a[148:151], v[184:187], v[132:135]
    buffer_load_dwordx4 v235, s[48:51], s33 offen offset:1024 lds
    v_cvt_pk_bf16_f32 v51, v51, v51
    v_lshlrev_b32 v51, 16, v51
    v_mfma_f32_16x16x32_bf16 v[136:139], a[152:155], v[184:187], v[136:139]
    s_add_u32 m0, s35, 14336
    s_add_u32 s33, s33, 131072
    buffer_load_dwordx4 v234, s[48:51], s33 offen lds
    v_mfma_f32_16x16x32_bf16 v[140:143], a[156:159], v[184:187], v[140:143]
    buffer_load_dwordx4 v235, s[48:51], s33 offen offset:1024 lds
    v_sqrt_f32 v51, v51
    s_nop 0
    v_mfma_f32_16x16x32_bf16 v[144:147], a[144:147], v[188:191], v[144:147]
    v_cvt_pk_bf16_f32 v51, v51, v51
    v_lshlrev_b32 v51, 16, v51
    v_mfma_f32_16x16x32_bf16 v[148:151], a[148:151], v[188:191], v[148:151]
    v_rcp_f32 v51, v51
    s_nop 0
    v_mfma_f32_16x16x32_bf16 v[152:155], a[152:155], v[188:191], v[152:155]
    v_sub_f32 v16, v16, v50
    v_sub_f32 v17, v17, v50
    v_mfma_f32_16x16x32_bf16 v[156:159], a[156:159], v[188:191], v[156:159]
    v_cvt_pk_bf16_f32 v17, v16, v17
    v_lshlrev_b32 v16, 16, v17
    s_waitcnt lgkmcnt(0)
    v_mfma_f32_16x16x32_bf16 v[96:99], a[160:163], v[160:163], v[96:99]
    ds_read_b128 v[176:179], v225 offset:40960
    ds_read_b128 v[180:183], v225 offset:43008
    v_and_b32 v17, 0xffff0000, v17
    v_mul_f32 v16, v16, v51
    v_mfma_f32_16x16x32_bf16 v[100:103], a[164:167], v[160:163], v[100:103]
    ds_read_b128 v[184:187], v225 offset:45056
    v_mul_f32 v17, v17, v51
    v_mfma_f32_16x16x32_bf16 v[104:107], a[168:171], v[160:163], v[104:107]
    ds_read_b128 v[188:191], v225 offset:47104
    ds_read_b64_tr_b16 a[176:177], v228 offset:20480
    v_cvt_pk_bf16_f32 v0, v16, v17
    v_sub_f32 v18, v18, v50
    v_mfma_f32_16x16x32_bf16 v[108:111], a[172:175], v[160:163], v[108:111]
    ds_read_b64_tr_b16 a[178:179], v228 offset:20992
    v_sub_f32 v19, v19, v50
    v_cvt_pk_bf16_f32 v19, v18, v19
    v_mfma_f32_16x16x32_bf16 v[112:115], a[160:163], v[164:167], v[112:115]
    ds_read_b64_tr_b16 a[180:181], v229 offset:20480
    ds_read_b64_tr_b16 a[182:183], v229 offset:20992
    s_add_u32 m0, s34, 16384
    s_add_u32 s37, s82, 65536
    buffer_load_dwordx4 v232, s[44:47], s37 offen lds
    v_mfma_f32_16x16x32_bf16 v[116:119], a[164:167], v[164:167], v[116:119]
    ds_read_b64_tr_b16 a[184:185], v230 offset:20480
    buffer_load_dwordx4 v233, s[44:47], s37 offen offset:1024 lds
    v_lshlrev_b32 v18, 16, v19
    v_mfma_f32_16x16x32_bf16 v[120:123], a[168:171], v[164:167], v[120:123]
    ds_read_b64_tr_b16 a[186:187], v230 offset:20992
    ds_read_b64_tr_b16 a[188:189], v231 offset:20480
    s_add_u32 m0, s34, 24576
    s_add_u32 s37, s83, 65536
    buffer_load_dwordx4 v232, s[44:47], s37 offen lds
    v_mfma_f32_16x16x32_bf16 v[124:127], a[172:175], v[164:167], v[124:127]
    ds_read_b64_tr_b16 a[190:191], v231 offset:20992
    buffer_load_dwordx4 v233, s[44:47], s37 offen offset:1024 lds
    v_and_b32 v19, 0xffff0000, v19
    v_mfma_f32_16x16x32_bf16 v[128:131], a[160:163], v[168:171], v[128:131]
    s_lshl2_add_u32 s26, s4, s3
    s_lshl_b32 s26, s26, 10
    s_add_u32 s26, s26, s32
    s_add_u32 s26, s26, 131072
    v_mfma_f32_16x16x32_bf16 v[132:135], a[164:167], v[168:171], v[132:135]
    v_and_b32 v194, 0x40000380, v251
    buffer_load_dword v252, v194, s[44:47], s26 offen
    v_mul_f32 v18, v18, v51
    v_mfma_f32_16x16x32_bf16 v[136:139], a[168:171], v[168:171], v[136:139]
    v_lshrrev_b32 v195, 1, v253
    v_lshlrev_b32 v195, 13, v195
    v_and_b32 v196, 1, v253
    v_lshl_add_u32 v195, v196, 7, v195
    v_mfma_f32_16x16x32_bf16 v[140:143], a[172:175], v[168:171], v[140:143]
    s_lshl_b32 s25, s4, 8
    s_add_u32 s25, s25, s27
    buffer_load_dword v252, v195, s[12:15], s25 offen
    v_mul_f32 v19, v19, v51
    v_mfma_f32_16x16x32_bf16 v[144:147], a[160:163], v[172:175], v[144:147]
    v_cvt_pk_bf16_f32 v1, v18, v19
    v_sub_f32 v20, v20, v50
    v_sub_f32 v21, v21, v50
    v_mfma_f32_16x16x32_bf16 v[148:151], a[164:167], v[172:175], v[148:151]
    v_cvt_pk_bf16_f32 v21, v20, v21
    v_lshlrev_b32 v20, 16, v21
    v_mfma_f32_16x16x32_bf16 v[152:155], a[168:171], v[172:175], v[152:155]
    v_and_b32 v21, 0xffff0000, v21
    v_mul_f32 v20, v20, v51
    v_mul_f32 v21, v21, v51
    v_mfma_f32_16x16x32_bf16 v[156:159], a[172:175], v[172:175], v[156:159]
    v_cvt_pk_bf16_f32 v2, v20, v21
    s_waitcnt vmcnt(18) lgkmcnt(0)
    s_barrier
    v_mfma_f32_16x16x32_bf16 v[96:99], a[176:179], v[176:179], v[96:99]
    ds_read_b128 v[160:163], v224 offset:49152
    ds_read_b128 v[164:167], v224 offset:51200
    v_sub_f32 v22, v22, v50
    v_mfma_f32_16x16x32_bf16 v[100:103], a[180:183], v[176:179], v[100:103]
    ds_read_b128 v[168:171], v224 offset:53248
    v_sub_f32 v23, v23, v50
    v_cvt_pk_bf16_f32 v23, v22, v23
    v_mfma_f32_16x16x32_bf16 v[104:107], a[184:187], v[176:179], v[104:107]
    ds_read_b128 v[172:175], v224 offset:55296
    ds_read_b64_tr_b16 a[192:193], v228 offset:0
    v_lshlrev_b32 v22, 16, v23
    v_mfma_f32_16x16x32_bf16 v[108:111], a[188:191], v[176:179], v[108:111]
    ds_read_b64_tr_b16 a[194:195], v228 offset:512
    v_and_b32 v23, 0xffff0000, v23
    v_mul_f32 v22, v22, v51
    v_mfma_f32_16x16x32_bf16 v[112:115], a[176:179], v[180:183], v[112:115]
    ds_read_b64_tr_b16 a[196:197], v229 offset:0
    ds_read_b64_tr_b16 a[198:199], v229 offset:512
    v_mul_f32 v23, v23, v51
    v_mfma_f32_16x16x32_bf16 v[116:119], a[180:183], v[180:183], v[116:119]
    ds_read_b64_tr_b16 a[200:201], v230 offset:0
    v_cvt_pk_bf16_f32 v3, v22, v23
    v_sub_f32 v24, v24, v50
    v_mfma_f32_16x16x32_bf16 v[120:123], a[184:187], v[180:183], v[120:123]
    ds_read_b64_tr_b16 a[202:203], v230 offset:512
    ds_read_b64_tr_b16 a[204:205], v231 offset:0
    v_sub_f32 v25, v25, v50
    v_cvt_pk_bf16_f32 v25, v24, v25
    v_mfma_f32_16x16x32_bf16 v[124:127], a[188:191], v[180:183], v[124:127]
    ds_read_b64_tr_b16 a[206:207], v231 offset:512
    v_lshlrev_b32 v24, 16, v25
    v_mfma_f32_16x16x32_bf16 v[128:131], a[176:179], v[184:187], v[128:131]
    v_and_b32 v25, 0xffff0000, v25
    v_mul_f32 v24, v24, v51
    v_mul_f32 v25, v25, v51
    v_mfma_f32_16x16x32_bf16 v[132:135], a[180:183], v[184:187], v[132:135]
    v_cvt_pk_bf16_f32 v4, v24, v25
    v_sub_f32 v26, v26, v50
    v_sub_f32 v27, v27, v50
    v_mfma_f32_16x16x32_bf16 v[136:139], a[184:187], v[184:187], v[136:139]
    v_cvt_pk_bf16_f32 v27, v26, v27
    v_lshlrev_b32 v26, 16, v27
    v_mfma_f32_16x16x32_bf16 v[140:143], a[188:191], v[184:187], v[140:143]
    v_and_b32 v27, 0xffff0000, v27
    v_mul_f32 v26, v26, v51
    v_mul_f32 v27, v27, v51
    v_mfma_f32_16x16x32_bf16 v[144:147], a[176:179], v[188:191], v[144:147]
    v_cvt_pk_bf16_f32 v5, v26, v27
    v_sub_f32 v28, v28, v50
    v_mfma_f32_16x16x32_bf16 v[148:151], a[180:183], v[188:191], v[148:151]
    v_sub_f32 v29, v29, v50
    v_cvt_pk_bf16_f32 v29, v28, v29
    v_lshlrev_b32 v28, 16, v29
    v_mfma_f32_16x16x32_bf16 v[152:155], a[184:187], v[188:191], v[152:155]
    v_and_b32 v29, 0xffff0000, v29
    v_mul_f32 v28, v28, v51
    v_mfma_f32_16x16x32_bf16 v[156:159], a[188:191], v[188:191], v[156:159]
    v_mul_f32 v29, v29, v51
    v_cvt_pk_bf16_f32 v6, v28, v29
    s_waitcnt lgkmcnt(0)
    v_mfma_f32_16x16x32_bf16 v[96:99], a[192:195], v[160:163], v[96:99]
    ds_read_b128 v[176:179], v225 offset:49152
    ds_read_b128 v[180:183], v225 offset:51200
    v_sub_f32 v30, v30, v50
    v_mfma_f32_16x16x32_bf16 v[100:103], a[196:199], v[160:163], v[100:103]
    ds_read_b128 v[184:187], v225 offset:53248
    v_sub_f32 v31, v31, v50
    v_cvt_pk_bf16_f32 v31, v30, v31
    v_mfma_f32_16x16x32_bf16 v[104:107], a[200:203], v[160:163], v[104:107]
    ds_read_b128 v[188:191], v225 offset:55296
    ds_read_b64_tr_b16 a[208:209], v228 offset:4096
    v_lshlrev_b32 v30, 16, v31
    v_mfma_f32_16x16x32_bf16 v[108:111], a[204:207], v[160:163], v[108:111]
    ds_read_b64_tr_b16 a[210:211], v228 offset:4608
    v_and_b32 v31, 0xffff0000, v31
    v_mul_f32 v30, v30, v51
    v_mfma_f32_16x16x32_bf16 v[112:115], a[192:195], v[164:167], v[112:115]
    ds_read_b64_tr_b16 a[212:213], v229 offset:4096
    ds_read_b64_tr_b16 a[214:215], v229 offset:4608
    v_mul_f32 v31, v31, v51
    v_cvt_pk_bf16_f32 v7, v30, v31
    v_mfma_f32_16x16x32_bf16 v[116:119], a[196:199], v[164:167], v[116:119]
    ds_read_b64_tr_b16 a[216:217], v230 offset:4096
    s_add_u32 m0, s34, 32768
    s_add_u32 s37, s84, 65536
    buffer_load_dwordx4 v232, s[44:47], s37 offen lds
    v_mfma_f32_16x16x32_bf16 v[120:123], a[200:203], v[164:167], v[120:123]
    ds_read_b64_tr_b16 a[218:219], v230 offset:4608
    ds_read_b64_tr_b16 a[220:221], v231 offset:4096
    v_sub_f32 v32, v32, v50
    v_mfma_f32_16x16x32_bf16 v[124:127], a[204:207], v[164:167], v[124:127]
    ds_read_b64_tr_b16 a[222:223], v231 offset:4608
    buffer_load_dwordx4 v233, s[44:47], s37 offen offset:1024 lds
    v_sub_f32 v33, v33, v50
    v_mfma_f32_16x16x32_bf16 v[128:131], a[192:195], v[168:171], v[128:131]
    v_cvt_pk_bf16_f32 v33, v32, v33
    v_lshlrev_b32 v32, 16, v33
    v_and_b32 v33, 0xffff0000, v33
    v_mfma_f32_16x16x32_bf16 v[132:135], a[196:199], v[168:171], v[132:135]
    s_add_u32 m0, s34, 40960
    s_add_u32 s37, s85, 65536
    buffer_load_dwordx4 v232, s[44:47], s37 offen lds
    v_mfma_f32_16x16x32_bf16 v[136:139], a[200:203], v[168:171], v[136:139]
    v_mul_f32 v32, v32, v51
    v_mul_f32 v33, v33, v51
    v_cvt_pk_bf16_f32 v8, v32, v33
    v_mfma_f32_16x16x32_bf16 v[140:143], a[204:207], v[168:171], v[140:143]
    buffer_load_dwordx4 v233, s[44:47], s37 offen offset:1024 lds
    v_sub_f32 v34, v34, v50
    v_sub_f32 v35, v35, v50
    v_mfma_f32_16x16x32_bf16 v[144:147], a[192:195], v[172:175], v[144:147]
    v_cvt_pk_bf16_f32 v35, v34, v35
    v_lshlrev_b32 v34, 16, v35
    v_mfma_f32_16x16x32_bf16 v[148:151], a[196:199], v[172:175], v[148:151]
    v_and_b32 v35, 0xffff0000, v35
    v_mul_f32 v34, v34, v51
    v_mul_f32 v35, v35, v51
    v_mfma_f32_16x16x32_bf16 v[152:155], a[200:203], v[172:175], v[152:155]
    v_cvt_pk_bf16_f32 v9, v34, v35
    v_sub_f32 v36, v36, v50
    v_mfma_f32_16x16x32_bf16 v[156:159], a[204:207], v[172:175], v[156:159]
    v_sub_f32 v37, v37, v50
    v_cvt_pk_bf16_f32 v37, v36, v37
    s_waitcnt vmcnt(10) lgkmcnt(0)
    v_mfma_f32_16x16x32_bf16 v[96:99], a[208:211], v[176:179], v[96:99]
    ds_read_b128 v[160:163], v224 offset:57344
    ds_read_b128 v[164:167], v224 offset:59392
    v_lshlrev_b32 v36, 16, v37
    v_mfma_f32_16x16x32_bf16 v[100:103], a[212:215], v[176:179], v[100:103]
    ds_read_b128 v[168:171], v224 offset:61440
    v_and_b32 v37, 0xffff0000, v37
    v_mul_f32 v36, v36, v51
    v_mfma_f32_16x16x32_bf16 v[104:107], a[216:219], v[176:179], v[104:107]
    ds_read_b128 v[172:175], v224 offset:63488
    ds_read_b64_tr_b16 a[224:225], v228 offset:8192
    v_mul_f32 v37, v37, v51
    v_cvt_pk_bf16_f32 v10, v36, v37
    v_mfma_f32_16x16x32_bf16 v[108:111], a[220:223], v[176:179], v[108:111]
    ds_read_b64_tr_b16 a[226:227], v228 offset:8704
    v_sub_f32 v38, v38, v50
    v_mfma_f32_16x16x32_bf16 v[112:115], a[208:211], v[180:183], v[112:115]
    ds_read_b64_tr_b16 a[228:229], v229 offset:8192
    ds_read_b64_tr_b16 a[230:231], v229 offset:8704
    v_sub_f32 v39, v39, v50
    v_cvt_pk_bf16_f32 v39, v38, v39
    v_mfma_f32_16x16x32_bf16 v[116:119], a[212:215], v[180:183], v[116:119]
    ds_read_b64_tr_b16 a[232:233], v230 offset:8192
    v_lshlrev_b32 v38, 16, v39
    v_and_b32 v39, 0xffff0000, v39
    v_mfma_f32_16x16x32_bf16 v[120:123], a[216:219], v[180:183], v[120:123]
    ds_read_b64_tr_b16 a[234:235], v230 offset:8704
    ds_read_b64_tr_b16 a[236:237], v231 offset:8192
    v_mul_f32 v38, v38, v51
    v_mfma_f32_16x16x32_bf16 v[124:127], a[220:223], v[180:183], v[124:127]
    ds_read_b64_tr_b16 a[238:239], v231 offset:8704
    v_mul_f32 v39, v39, v51
    v_cvt_pk_bf16_f32 v11, v38, v39
    v_mfma_f32_16x16x32_bf16 v[128:131], a[208:211], v[184:187], v[128:131]
    v_sub_f32 v40, v40, v50
    v_sub_f32 v41, v41, v50
    v_mfma_f32_16x16x32_bf16 v[132:135], a[212:215], v[184:187], v[132:135]
    v_cvt_pk_bf16_f32 v41, v40, v41
    v_lshlrev_b32 v40, 16, v41
    v_and_b32 v41, 0xffff0000, v41
    v_mfma_f32_16x16x32_bf16 v[136:139], a[216:219], v[184:187], v[136:139]
    v_mul_f32 v40, v40, v51
    v_mul_f32 v41, v41, v51
    v_mfma_f32_16x16x32_bf16 v[140:143], a[220:223], v[184:187], v[140:143]
    v_cvt_pk_bf16_f32 v12, v40, v41
    v_sub_f32 v42, v42, v50
    v_sub_f32 v43, v43, v50
    v_mfma_f32_16x16x32_bf16 v[144:147], a[208:211], v[188:191], v[144:147]
    v_cvt_pk_bf16_f32 v43, v42, v43
    v_lshlrev_b32 v42, 16, v43
    v_mfma_f32_16x16x32_bf16 v[148:151], a[212:215], v[188:191], v[148:151]
    v_and_b32 v43, 0xffff0000, v43
    v_mul_f32 v42, v42, v51
    v_mul_f32 v43, v43, v51
    v_mfma_f32_16x16x32_bf16 v[152:155], a[216:219], v[188:191], v[152:155]
    v_cvt_pk_bf16_f32 v13, v42, v43
    v_sub_f32 v44, v44, v50
    v_mfma_f32_16x16x32_bf16 v[156:159], a[220:223], v[188:191], v[156:159]
    v_sub_f32 v45, v45, v50
    v_cvt_pk_bf16_f32 v45, v44, v45
    s_waitcnt lgkmcnt(0)
    v_mfma_f32_16x16x32_bf16 v[96:99], a[224:227], v[160:163], v[96:99]
    ds_read_b128 v[176:179], v225 offset:57344
    ds_read_b128 v[180:183], v225 offset:59392
    v_lshlrev_b32 v44, 16, v45
    v_and_b32 v45, 0xffff0000, v45
    v_mfma_f32_16x16x32_bf16 v[100:103], a[228:231], v[160:163], v[100:103]
    ds_read_b128 v[184:187], v225 offset:61440
    v_mul_f32 v44, v44, v51
    v_mul_f32 v45, v45, v51
    v_mfma_f32_16x16x32_bf16 v[104:107], a[232:235], v[160:163], v[104:107]
    ds_read_b128 v[188:191], v225 offset:63488
    ds_read_b64_tr_b16 a[240:241], v228 offset:12288
    v_cvt_pk_bf16_f32 v14, v44, v45
    v_mfma_f32_16x16x32_bf16 v[108:111], a[236:239], v[160:163], v[108:111]
    ds_read_b64_tr_b16 a[242:243], v228 offset:12800
    v_sub_f32 v46, v46, v50
    v_sub_f32 v47, v47, v50
    v_mfma_f32_16x16x32_bf16 v[112:115], a[224:227], v[164:167], v[112:115]
    ds_read_b64_tr_b16 a[244:245], v229 offset:12288
    ds_read_b64_tr_b16 a[246:247], v229 offset:12800
    v_cvt_pk_bf16_f32 v47, v46, v47
    v_mfma_f32_16x16x32_bf16 v[116:119], a[228:231], v[164:167], v[116:119]
    ds_read_b64_tr_b16 a[248:249], v230 offset:12288
    v_lshlrev_b32 v46, 16, v47
    v_and_b32 v47, 0xffff0000, v47
    v_mfma_f32_16x16x32_bf16 v[120:123], a[232:235], v[164:167], v[120:123]
    ds_read_b64_tr_b16 a[250:251], v230 offset:12800
    ds_read_b64_tr_b16 a[252:253], v231 offset:12288
    v_mul_f32 v46, v46, v51
    v_mfma_f32_16x16x32_bf16 v[124:127], a[236:239], v[164:167], v[124:127]
    ds_read_b64_tr_b16 a[254:255], v231 offset:12800
    v_mul_f32 v47, v47, v51
    v_cvt_pk_bf16_f32 v15, v46, v47
    v_mfma_f32_16x16x32_bf16 v[128:131], a[224:227], v[168:171], v[128:131]
    v_mfma_f32_16x16x32_bf16 v[132:135], a[228:231], v[168:171], v[132:135]
    ds_write_b128 v237, v[0:3] offset:0
    v_mfma_f32_16x16x32_bf16 v[136:139], a[232:235], v[168:171], v[136:139]
    ds_write_b128 v237, v[4:7] offset:4096
    v_mfma_f32_16x16x32_bf16 v[140:143], a[236:239], v[168:171], v[140:143]
    ds_write_b128 v237, v[8:11] offset:24576
    v_mfma_f32_16x16x32_bf16 v[144:147], a[224:227], v[172:175], v[144:147]
    ds_write_b128 v237, v[12:15] offset:28672
    v_mfma_f32_16x16x32_bf16 v[148:151], a[228:231], v[172:175], v[148:151]
    v_mfma_f32_16x16x32_bf16 v[152:155], a[232:235], v[172:175], v[152:155]
    v_mfma_f32_16x16x32_bf16 v[156:159], a[236:239], v[172:175], v[156:159]
    s_waitcnt vmcnt(18) lgkmcnt(0)
    s_barrier
    v_mfma_f32_16x16x32_bf16 v[96:99], a[240:243], v[176:179], v[96:99]
    ds_read_b128 v[160:163], v224 offset:0
    v_mfma_f32_16x16x32_bf16 v[100:103], a[244:247], v[176:179], v[100:103]
    ds_read_b128 v[164:167], v224 offset:2048
    v_mfma_f32_16x16x32_bf16 v[104:107], a[248:251], v[176:179], v[104:107]
    ds_read_b128 v[168:171], v224 offset:4096
    v_mfma_f32_16x16x32_bf16 v[108:111], a[252:255], v[176:179], v[108:111]
    ds_read_b128 v[172:175], v224 offset:6144
    v_mfma_f32_16x16x32_bf16 v[112:115], a[240:243], v[180:183], v[112:115]
    v_lshlrev_b32 v237, 4, v253
    v_add_u32 v237, 81920, v237
    ds_read_b128 v[16:19], v237 offset:0
    ds_read_b128 v[20:23], v237 offset:4096
    ds_read_b128 v[24:27], v237 offset:24576
    ds_read_b128 v[28:31], v237 offset:28672
    v_mfma_f32_16x16x32_bf16 v[116:119], a[244:247], v[180:183], v[116:119]
    s_add_u32 m0, s34, 49152
    s_add_u32 s37, s86, 65536
    buffer_load_dwordx4 v232, s[44:47], s37 offen lds
    v_mfma_f32_16x16x32_bf16 v[120:123], a[248:251], v[180:183], v[120:123]
    v_mfma_f32_16x16x32_bf16 v[124:127], a[252:255], v[180:183], v[124:127]
    buffer_load_dwordx4 v233, s[44:47], s37 offen offset:1024 lds
    v_mfma_f32_16x16x32_bf16 v[128:131], a[240:243], v[184:187], v[128:131]
    v_mfma_f32_16x16x32_bf16 v[132:135], a[244:247], v[184:187], v[132:135]
    s_add_u32 m0, s34, 57344
    s_add_u32 s37, s87, 65536
    buffer_load_dwordx4 v232, s[44:47], s37 offen lds
    v_cvt_pk_bf16_f32 v64, v96, v97
    v_cvt_pk_bf16_f32 v65, v98, v99
    v_mfma_f32_16x16x32_bf16 v[136:139], a[248:251], v[184:187], v[136:139]
    v_cvt_pk_bf16_f32 v66, v100, v101
    v_cvt_pk_bf16_f32 v67, v102, v103
    v_mfma_f32_16x16x32_bf16 v[140:143], a[252:255], v[184:187], v[140:143]
    buffer_load_dwordx4 v233, s[44:47], s37 offen offset:1024 lds
    v_cvt_pk_bf16_f32 v68, v104, v105
    v_cvt_pk_bf16_f32 v69, v106, v107
    v_mfma_f32_16x16x32_bf16 v[144:147], a[240:243], v[188:191], v[144:147]
    v_cvt_pk_bf16_f32 v70, v108, v109
    v_cvt_pk_bf16_f32 v71, v110, v111
    v_mfma_f32_16x16x32_bf16 v[148:151], a[244:247], v[188:191], v[148:151]
    v_cvt_pk_bf16_f32 v72, v112, v113
    v_cvt_pk_bf16_f32 v73, v114, v115
    v_mfma_f32_16x16x32_bf16 v[152:155], a[248:251], v[188:191], v[152:155]
    v_cvt_pk_bf16_f32 v74, v116, v117
    v_cvt_pk_bf16_f32 v75, v118, v119
    v_mfma_f32_16x16x32_bf16 v[156:159], a[252:255], v[188:191], v[156:159]
    v_cvt_pk_bf16_f32 v76, v120, v121
    v_cvt_pk_bf16_f32 v77, v122, v123
    s_waitcnt lgkmcnt(0)
    v_mfma_f32_16x16x32_bf16 v[96:99], a[0:3], v[160:163], 0
    ds_read_b128 v[176:179], v225 offset:0
    v_cvt_pk_bf16_f32 v78, v124, v125
    v_cvt_pk_bf16_f32 v79, v126, v127
    v_mfma_f32_16x16x32_bf16 v[100:103], a[4:7], v[160:163], 0
    ds_read_b128 v[180:183], v225 offset:2048
    v_cvt_pk_bf16_f32 v80, v128, v129
    v_cvt_pk_bf16_f32 v81, v130, v131
    v_mfma_f32_16x16x32_bf16 v[104:107], a[8:11], v[160:163], 0
    ds_read_b128 v[184:187], v225 offset:4096
    v_cvt_pk_bf16_f32 v82, v132, v133
    v_cvt_pk_bf16_f32 v83, v134, v135
    v_mfma_f32_16x16x32_bf16 v[108:111], a[12:15], v[160:163], 0
    ds_read_b128 v[188:191], v225 offset:6144
    v_cvt_pk_bf16_f32 v84, v136, v137
    v_cvt_pk_bf16_f32 v85, v138, v139
    v_mfma_f32_16x16x32_bf16 v[112:115], a[0:3], v[164:167], 0
    v_cvt_pk_bf16_f32 v86, v140, v141
    v_cvt_pk_bf16_f32 v87, v142, v143
    s_mov_b32 s39, 0
    buffer_store_dwordx4 v[16:19], v238, s[8:11], s39 offen sc1
    v_mfma_f32_16x16x32_bf16 v[116:119], a[4:7], v[164:167], 0
    v_cvt_pk_bf16_f32 v88, v144, v145
    v_cvt_pk_bf16_f32 v89, v146, v147
    v_mfma_f32_16x16x32_bf16 v[120:123], a[8:11], v[164:167], 0
    v_cvt_pk_bf16_f32 v90, v148, v149
    v_cvt_pk_bf16_f32 v91, v150, v151
    v_mfma_f32_16x16x32_bf16 v[124:127], a[12:15], v[164:167], 0
    v_cvt_pk_bf16_f32 v92, v152, v153
    v_cvt_pk_bf16_f32 v93, v154, v155
    v_mfma_f32_16x16x32_bf16 v[128:131], a[0:3], v[168:171], 0
    v_cvt_pk_bf16_f32 v94, v156, v157
    v_cvt_pk_bf16_f32 v95, v158, v159
    v_mfma_f32_16x16x32_bf16 v[132:135], a[4:7], v[168:171], 0
    v_mfma_f32_16x16x32_bf16 v[136:139], a[8:11], v[168:171], 0
    v_mfma_f32_16x16x32_bf16 v[140:143], a[12:15], v[168:171], 0
    v_mfma_f32_16x16x32_bf16 v[144:147], a[0:3], v[172:175], 0
    v_mfma_f32_16x16x32_bf16 v[148:151], a[4:7], v[172:175], 0
    v_mfma_f32_16x16x32_bf16 v[152:155], a[8:11], v[172:175], 0
    v_mfma_f32_16x16x32_bf16 v[156:159], a[12:15], v[172:175], 0
    s_waitcnt lgkmcnt(0)
    v_mfma_f32_16x16x32_bf16 v[96:99], a[16:19], v[176:179], v[96:99]
    ds_read_b128 v[160:163], v224 offset:8192
    v_mfma_f32_16x16x32_bf16 v[100:103], a[20:23], v[176:179], v[100:103]
    ds_read_b128 v[164:167], v224 offset:10240
    v_mfma_f32_16x16x32_bf16 v[104:107], a[24:27], v[176:179], v[104:107]
    ds_read_b128 v[168:171], v224 offset:12288
    v_mfma_f32_16x16x32_bf16 v[108:111], a[28:31], v[176:179], v[108:111]
    ds_read_b128 v[172:175], v224 offset:14336
    v_mfma_f32_16x16x32_bf16 v[112:115], a[16:19], v[180:183], v[112:115]
    v_mfma_f32_16x16x32_bf16 v[116:119], a[20:23], v[180:183], v[116:119]
    v_mfma_f32_16x16x32_bf16 v[120:123], a[24:27], v[180:183], v[120:123]
    v_mfma_f32_16x16x32_bf16 v[124:127], a[28:31], v[180:183], v[124:127]
    v_mfma_f32_16x16x32_bf16 v[128:131], a[16:19], v[184:187], v[128:131]
    v_mfma_f32_16x16x32_bf16 v[132:135], a[20:23], v[184:187], v[132:135]
    v_mfma_f32_16x16x32_bf16 v[136:139], a[24:27], v[184:187], v[136:139]
    s_mov_b32 s39, 16384
    buffer_store_dwordx4 v[20:23], v238, s[8:11], s39 offen sc1
    v_mfma_f32_16x16x32_bf16 v[140:143], a[28:31], v[184:187], v[140:143]
    v_mfma_f32_16x16x32_bf16 v[144:147], a[16:19], v[188:191], v[144:147]
    v_mfma_f32_16x16x32_bf16 v[148:151], a[20:23], v[188:191], v[148:151]
    v_mfma_f32_16x16x32_bf16 v[152:155], a[24:27], v[188:191], v[152:155]
    v_mfma_f32_16x16x32_bf16 v[156:159], a[28:31], v[188:191], v[156:159]
    s_waitcnt lgkmcnt(0)
    v_mfma_f32_16x16x32_bf16 v[96:99], a[32:35], v[160:163], v[96:99]
    ds_read_b128 v[176:179], v225 offset:8192
    v_mfma_f32_16x16x32_bf16 v[100:103], a[36:39], v[160:163], v[100:103]
    ds_read_b128 v[180:183], v225 offset:10240
    v_mfma_f32_16x16x32_bf16 v[104:107], a[40:43], v[160:163], v[104:107]
    ds_read_b128 v[184:187], v225 offset:12288
    v_mfma_f32_16x16x32_bf16 v[108:111], a[44:47], v[160:163], v[108:111]
    ds_read_b128 v[188:191], v225 offset:14336
    v_mfma_f32_16x16x32_bf16 v[112:115], a[32:35], v[164:167], v[112:115]
    s_mul_i32 s37, s2, 100
    v_mfma_f32_16x16x32_bf16 v[116:119], a[36:39], v[164:167], v[116:119]
    v_lshl_add_u32 v60, v253, 2, s37
    v_cmp_gt_u32 vcc, 25, v253
    v_mfma_f32_16x16x32_bf16 v[120:123], a[40:43], v[164:167], v[120:123]
    v_mov_b32 v61, 0
    v_mfma_f32_16x16x32_bf16 v[124:127], a[44:47], v[164:167], v[124:127]
    v_mov_b32 v62, 0x7ffffff0
    v_cndmask_b32 v60, v62, v60, vcc
    v_mfma_f32_16x16x32_bf16 v[128:131], a[32:35], v[168:171], v[128:131]
    buffer_store_dword v61, v60, s[56:59], 0 offen sc1
    v_mfma_f32_16x16x32_bf16 v[132:135], a[36:39], v[168:171], v[132:135]
    s_add_u32 s56, s56, 0x20000
    s_addc_u32 s57, s57, 0
    v_mfma_f32_16x16x32_bf16 v[136:139], a[40:43], v[168:171], v[136:139]
    s_mov_b32 s58, 0x23000
    s_lshl2_add_u32 s37, s2, s3
    v_mfma_f32_16x16x32_bf16 v[140:143], a[44:47], v[168:171], v[140:143]
    s_lshl_b32 s37, s37, 7
    v_mfma_f32_16x16x32_bf16 v[144:147], a[32:35], v[172:175], v[144:147]
    buffer_store_dword v61, off, s[56:59], s37 sc1
    s_add_u32 s37, s37, 0x20000
    v_mfma_f32_16x16x32_bf16 v[148:151], a[36:39], v[172:175], v[148:151]
    buffer_store_dword v61, off, s[56:59], s37 sc1
    v_mfma_f32_16x16x32_bf16 v[152:155], a[40:43], v[172:175], v[152:155]
    v_mfma_f32_16x16x32_bf16 v[156:159], a[44:47], v[172:175], v[156:159]
    s_waitcnt vmcnt(9) lgkmcnt(0)
    s_barrier
    v_mfma_f32_16x16x32_bf16 v[96:99], a[48:51], v[176:179], v[96:99]
    ds_read_b128 v[160:163], v224 offset:16384
    s_mov_b32 s39, 32768
    buffer_store_dwordx4 v[24:27], v238, s[8:11], s39 offen sc1
    v_mfma_f32_16x16x32_bf16 v[100:103], a[52:55], v[176:179], v[100:103]
    ds_read_b128 v[164:167], v224 offset:18432
    v_mfma_f32_16x16x32_bf16 v[104:107], a[56:59], v[176:179], v[104:107]
    ds_read_b128 v[168:171], v224 offset:20480
    v_mfma_f32_16x16x32_bf16 v[108:111], a[60:63], v[176:179], v[108:111]
    ds_read_b128 v[172:175], v224 offset:22528
    v_mfma_f32_16x16x32_bf16 v[112:115], a[48:51], v[180:183], v[112:115]
    v_mfma_f32_16x16x32_bf16 v[116:119], a[52:55], v[180:183], v[116:119]
    s_add_u32 m0, s34, 98304
    s_add_u32 s37, s80, 131072
    buffer_load_dwordx4 v232, s[44:47], s37 offen lds
    v_mfma_f32_16x16x32_bf16 v[120:123], a[56:59], v[180:183], v[120:123]
    v_mfma_f32_16x16x32_bf16 v[124:127], a[60:63], v[180:183], v[124:127]
    buffer_load_dwordx4 v233, s[44:47], s37 offen offset:1024 lds
    v_mfma_f32_16x16x32_bf16 v[128:131], a[48:51], v[184:187], v[128:131]
    v_mfma_f32_16x16x32_bf16 v[132:135], a[52:55], v[184:187], v[132:135]
    v_mfma_f32_16x16x32_bf16 v[136:139], a[56:59], v[184:187], v[136:139]
    v_mfma_f32_16x16x32_bf16 v[140:143], a[60:63], v[184:187], v[140:143]
    v_mfma_f32_16x16x32_bf16 v[144:147], a[48:51], v[188:191], v[144:147]
    v_mfma_f32_16x16x32_bf16 v[148:151], a[52:55], v[188:191], v[148:151]
    v_mfma_f32_16x16x32_bf16 v[152:155], a[56:59], v[188:191], v[152:155]
    v_mfma_f32_16x16x32_bf16 v[156:159], a[60:63], v[188:191], v[156:159]
    s_waitcnt lgkmcnt(0)
    v_mfma_f32_16x16x32_bf16 v[96:99], a[64:67], v[160:163], v[96:99]
    ds_read_b128 v[176:179], v225 offset:16384
    v_mfma_f32_16x16x32_bf16 v[100:103], a[68:71], v[160:163], v[100:103]
    ds_read_b128 v[180:183], v225 offset:18432
    v_mfma_f32_16x16x32_bf16 v[104:107], a[72:75], v[160:163], v[104:107]
    ds_read_b128 v[184:187], v225 offset:20480
    v_mfma_f32_16x16x32_bf16 v[108:111], a[76:79], v[160:163], v[108:111]
    ds_read_b128 v[188:191], v225 offset:22528
    v_mfma_f32_16x16x32_bf16 v[112:115], a[64:67], v[164:167], v[112:115]
    v_mfma_f32_16x16x32_bf16 v[116:119], a[68:71], v[164:167], v[116:119]
    s_add_u32 m0, s34, 106496
    s_add_u32 s37, s81, 131072
    buffer_load_dwordx4 v232, s[44:47], s37 offen lds
    v_mfma_f32_16x16x32_bf16 v[120:123], a[72:75], v[164:167], v[120:123]
    s_mov_b32 s39, 49152
    buffer_store_dwordx4 v[28:31], v238, s[8:11], s39 offen sc1
    v_mfma_f32_16x16x32_bf16 v[124:127], a[76:79], v[164:167], v[124:127]
    buffer_load_dwordx4 v233, s[44:47], s37 offen offset:1024 lds
    v_mfma_f32_16x16x32_bf16 v[128:131], a[64:67], v[168:171], v[128:131]
    v_mfma_f32_16x16x32_bf16 v[132:135], a[68:71], v[168:171], v[132:135]
    v_mfma_f32_16x16x32_bf16 v[136:139], a[72:75], v[168:171], v[136:139]
    v_mfma_f32_16x16x32_bf16 v[140:143], a[76:79], v[168:171], v[140:143]
    v_mfma_f32_16x16x32_bf16 v[144:147], a[64:67], v[172:175], v[144:147]
    v_mfma_f32_16x16x32_bf16 v[148:151], a[68:71], v[172:175], v[148:151]
    v_mfma_f32_16x16x32_bf16 v[152:155], a[72:75], v[172:175], v[152:155]
    v_mfma_f32_16x16x32_bf16 v[156:159], a[76:79], v[172:175], v[156:159]
    s_waitcnt lgkmcnt(0)
    v_mfma_f32_16x16x32_bf16 v[96:99], a[80:83], v[176:179], v[96:99]
    ds_read_b128 v[160:163], v224 offset:24576
    v_mfma_f32_16x16x32_bf16 v[100:103], a[84:87], v[176:179], v[100:103]
    ds_read_b128 v[164:167], v224 offset:26624
    v_mfma_f32_16x16x32_bf16 v[104:107], a[88:91], v[176:179], v[104:107]
    ds_read_b128 v[168:171], v224 offset:28672
    v_mfma_f32_16x16x32_bf16 v[108:111], a[92:95], v[176:179], v[108:111]
    ds_read_b128 v[172:175], v224 offset:30720
    v_mfma_f32_16x16x32_bf16 v[112:115], a[80:83], v[180:183], v[112:115]
    v_mfma_f32_16x16x32_bf16 v[116:119], a[84:87], v[180:183], v[116:119]
    v_mfma_f32_16x16x32_bf16 v[120:123], a[88:91], v[180:183], v[120:123]
    v_mfma_f32_16x16x32_bf16 v[124:127], a[92:95], v[180:183], v[124:127]
    v_mfma_f32_16x16x32_bf16 v[128:131], a[80:83], v[184:187], v[128:131]
    v_mfma_f32_16x16x32_bf16 v[132:135], a[84:87], v[184:187], v[132:135]
    v_mfma_f32_16x16x32_bf16 v[136:139], a[88:91], v[184:187], v[136:139]
    v_mfma_f32_16x16x32_bf16 v[140:143], a[92:95], v[184:187], v[140:143]
    v_mfma_f32_16x16x32_bf16 v[144:147], a[80:83], v[188:191], v[144:147]
    s_add_u32 s38, s36, 0
    buffer_store_dwordx4 v[64:67], v240, s[16:19], s38 offen offset:0 sc1
    v_mfma_f32_16x16x32_bf16 v[148:151], a[84:87], v[188:191], v[148:151]
    v_mfma_f32_16x16x32_bf16 v[152:155], a[88:91], v[188:191], v[152:155]
    v_mfma_f32_16x16x32_bf16 v[156:159], a[92:95], v[188:191], v[156:159]
    s_waitcnt lgkmcnt(0)
    v_mfma_f32_16x16x32_bf16 v[96:99], a[96:99], v[160:163], v[96:99]
    ds_read_b128 v[176:179], v225 offset:24576
    v_mfma_f32_16x16x32_bf16 v[100:103], a[100:103], v[160:163], v[100:103]
    ds_read_b128 v[180:183], v225 offset:26624
    v_mfma_f32_16x16x32_bf16 v[104:107], a[104:107], v[160:163], v[104:107]
    ds_read_b128 v[184:187], v225 offset:28672
    v_mfma_f32_16x16x32_bf16 v[108:111], a[108:111], v[160:163], v[108:111]
    ds_read_b128 v[188:191], v225 offset:30720
    v_mfma_f32_16x16x32_bf16 v[112:115], a[96:99], v[164:167], v[112:115]
    v_mfma_f32_16x16x32_bf16 v[116:119], a[100:103], v[164:167], v[116:119]
    s_add_u32 m0, s34, 114688
    s_add_u32 s37, s82, 131072
    buffer_load_dwordx4 v232, s[44:47], s37 offen lds
    v_mfma_f32_16x16x32_bf16 v[120:123], a[104:107], v[164:167], v[120:123]
    v_mfma_f32_16x16x32_bf16 v[124:127], a[108:111], v[164:167], v[124:127]
    buffer_load_dwordx4 v233, s[44:47], s37 offen offset:1024 lds
    v_mfma_f32_16x16x32_bf16 v[128:131], a[96:99], v[168:171], v[128:131]
    v_mfma_f32_16x16x32_bf16 v[132:135], a[100:103], v[168:171], v[132:135]
    v_mfma_f32_16x16x32_bf16 v[136:139], a[104:107], v[168:171], v[136:139]
    v_mfma_f32_16x16x32_bf16 v[140:143], a[108:111], v[168:171], v[140:143]
    v_mfma_f32_16x16x32_bf16 v[144:147], a[96:99], v[172:175], v[144:147]
    v_mfma_f32_16x16x32_bf16 v[148:151], a[100:103], v[172:175], v[148:151]
    v_mfma_f32_16x16x32_bf16 v[152:155], a[104:107], v[172:175], v[152:155]
    v_mfma_f32_16x16x32_bf16 v[156:159], a[108:111], v[172:175], v[156:159]
    s_waitcnt lgkmcnt(0)
    v_mfma_f32_16x16x32_bf16 v[96:99], a[112:115], v[176:179], v[96:99]
    ds_read_b128 v[160:163], v224 offset:32768
    v_mfma_f32_16x16x32_bf16 v[100:103], a[116:119], v[176:179], v[100:103]
    ds_read_b128 v[164:167], v224 offset:34816
    v_mfma_f32_16x16x32_bf16 v[104:107], a[120:123], v[176:179], v[104:107]
    ds_read_b128 v[168:171], v224 offset:36864
    s_add_u32 s38, s36, 0
    buffer_store_dwordx4 v[68:71], v240, s[16:19], s38 offen offset:2048 sc1
    v_mfma_f32_16x16x32_bf16 v[108:111], a[124:127], v[176:179], v[108:111]
    ds_read_b128 v[172:175], v224 offset:38912
    v_mfma_f32_16x16x32_bf16 v[112:115], a[112:115], v[180:183], v[112:115]
    v_mfma_f32_16x16x32_bf16 v[116:119], a[116:119], v[180:183], v[116:119]
    s_add_u32 m0, s34, 122880
    s_add_u32 s37, s83, 131072
    buffer_load_dwordx4 v232, s[44:47], s37 offen lds
    v_mfma_f32_16x16x32_bf16 v[120:123], a[120:123], v[180:183], v[120:123]
    v_mfma_f32_16x16x32_bf16 v[124:127], a[124:127], v[180:183], v[124:127]
    buffer_load_dwordx4 v233, s[44:47], s37 offen offset:1024 lds
    v_mfma_f32_16x16x32_bf16 v[128:131], a[112:115], v[184:187], v[128:131]
    v_mfma_f32_16x16x32_bf16 v[132:135], a[116:119], v[184:187], v[132:135]
    v_mfma_f32_16x16x32_bf16 v[136:139], a[120:123], v[184:187], v[136:139]
    v_mfma_f32_16x16x32_bf16 v[140:143], a[124:127], v[184:187], v[140:143]
    v_mfma_f32_16x16x32_bf16 v[144:147], a[112:115], v[188:191], v[144:147]
    v_mfma_f32_16x16x32_bf16 v[148:151], a[116:119], v[188:191], v[148:151]
    v_mfma_f32_16x16x32_bf16 v[152:155], a[120:123], v[188:191], v[152:155]
    v_mfma_f32_16x16x32_bf16 v[156:159], a[124:127], v[188:191], v[156:159]
    s_waitcnt lgkmcnt(0)
    v_mfma_f32_16x16x32_bf16 v[96:99], a[128:131], v[160:163], v[96:99]
    ds_read_b128 v[176:179], v225 offset:32768
    v_mfma_f32_16x16x32_bf16 v[100:103], a[132:135], v[160:163], v[100:103]
    ds_read_b128 v[180:183], v225 offset:34816
    v_mfma_f32_16x16x32_bf16 v[104:107], a[136:139], v[160:163], v[104:107]
    ds_read_b128 v[184:187], v225 offset:36864
    v_mfma_f32_16x16x32_bf16 v[108:111], a[140:143], v[160:163], v[108:111]
    ds_read_b128 v[188:191], v225 offset:38912
    v_mfma_f32_16x16x32_bf16 v[112:115], a[128:131], v[164:167], v[112:115]
    v_mfma_f32_16x16x32_bf16 v[116:119], a[132:135], v[164:167], v[116:119]
    v_mfma_f32_16x16x32_bf16 v[120:123], a[136:139], v[164:167], v[120:123]
    v_mfma_f32_16x16x32_bf16 v[124:127], a[140:143], v[164:167], v[124:127]
    v_mfma_f32_16x16x32_bf16 v[128:131], a[128:131], v[168:171], v[128:131]
    s_add_u32 s38, s36, 0
    buffer_store_dwordx4 v[72:75], v240, s[16:19], s38 offen offset:1024 sc1
    v_mfma_f32_16x16x32_bf16 v[132:135], a[132:135], v[168:171], v[132:135]
    v_mfma_f32_16x16x32_bf16 v[136:139], a[136:139], v[168:171], v[136:139]
    v_mfma_f32_16x16x32_bf16 v[140:143], a[140:143], v[168:171], v[140:143]
    v_mfma_f32_16x16x32_bf16 v[144:147], a[128:131], v[172:175], v[144:147]
    v_mfma_f32_16x16x32_bf16 v[148:151], a[132:135], v[172:175], v[148:151]
    v_mfma_f32_16x16x32_bf16 v[152:155], a[136:139], v[172:175], v[152:155]
    v_mfma_f32_16x16x32_bf16 v[156:159], a[140:143], v[172:175], v[156:159]
    s_waitcnt lgkmcnt(0)
    v_mfma_f32_16x16x32_bf16 v[96:99], a[144:147], v[176:179], v[96:99]
    ds_read_b128 v[160:163], v224 offset:40960
    v_mfma_f32_16x16x32_bf16 v[100:103], a[148:151], v[176:179], v[100:103]
    ds_read_b128 v[164:167], v224 offset:43008
    v_mfma_f32_16x16x32_bf16 v[104:107], a[152:155], v[176:179], v[104:107]
    ds_read_b128 v[168:171], v224 offset:45056
    v_mfma_f32_16x16x32_bf16 v[108:111], a[156:159], v[176:179], v[108:111]
    ds_read_b128 v[172:175], v224 offset:47104
    v_mfma_f32_16x16x32_bf16 v[112:115], a[144:147], v[180:183], v[112:115]
    v_mfma_f32_16x16x32_bf16 v[116:119], a[148:151], v[180:183], v[116:119]
    s_add_u32 m0, s34, 131072
    s_add_u32 s37, s84, 131072
    buffer_load_dwordx4 v232, s[44:47], s37 offen lds
    v_mfma_f32_16x16x32_bf16 v[120:123], a[152:155], v[180:183], v[120:123]
    v_mfma_f32_16x16x32_bf16 v[124:127], a[156:159], v[180:183], v[124:127]
    buffer_load_dwordx4 v233, s[44:47], s37 offen offset:1024 lds
    v_mfma_f32_16x16x32_bf16 v[128:131], a[144:147], v[184:187], v[128:131]
    v_mfma_f32_16x16x32_bf16 v[132:135], a[148:151], v[184:187], v[132:135]
    v_mfma_f32_16x16x32_bf16 v[136:139], a[152:155], v[184:187], v[136:139]
    v_mfma_f32_16x16x32_bf16 v[140:143], a[156:159], v[184:187], v[140:143]
    v_mfma_f32_16x16x32_bf16 v[144:147], a[144:147], v[188:191], v[144:147]
    v_mfma_f32_16x16x32_bf16 v[148:151], a[148:151], v[188:191], v[148:151]
    v_mfma_f32_16x16x32_bf16 v[152:155], a[152:155], v[188:191], v[152:155]
    s_add_u32 s38, s36, 0
    buffer_store_dwordx4 v[76:79], v240, s[16:19], s38 offen offset:3072 sc1
    v_mfma_f32_16x16x32_bf16 v[156:159], a[156:159], v[188:191], v[156:159]
    s_waitcnt lgkmcnt(0)
    v_mfma_f32_16x16x32_bf16 v[96:99], a[160:163], v[160:163], v[96:99]
    ds_read_b128 v[176:179], v225 offset:40960
    v_mfma_f32_16x16x32_bf16 v[100:103], a[164:167], v[160:163], v[100:103]
    ds_read_b128 v[180:183], v225 offset:43008
    v_mfma_f32_16x16x32_bf16 v[104:107], a[168:171], v[160:163], v[104:107]
    ds_read_b128 v[184:187], v225 offset:45056
    v_mfma_f32_16x16x32_bf16 v[108:111], a[172:175], v[160:163], v[108:111]
    ds_read_b128 v[188:191], v225 offset:47104
    v_mfma_f32_16x16x32_bf16 v[112:115], a[160:163], v[164:167], v[112:115]
    v_mfma_f32_16x16x32_bf16 v[116:119], a[164:167], v[164:167], v[116:119]
    s_add_u32 m0, s34, 139264
    s_add_u32 s37, s85, 131072
    buffer_load_dwordx4 v232, s[44:47], s37 offen lds
    v_mfma_f32_16x16x32_bf16 v[120:123], a[168:171], v[164:167], v[120:123]
    v_mfma_f32_16x16x32_bf16 v[124:127], a[172:175], v[164:167], v[124:127]
    buffer_load_dwordx4 v233, s[44:47], s37 offen offset:1024 lds
    v_mfma_f32_16x16x32_bf16 v[128:131], a[160:163], v[168:171], v[128:131]
    v_mfma_f32_16x16x32_bf16 v[132:135], a[164:167], v[168:171], v[132:135]
    v_mfma_f32_16x16x32_bf16 v[136:139], a[168:171], v[168:171], v[136:139]
    v_mfma_f32_16x16x32_bf16 v[140:143], a[172:175], v[168:171], v[140:143]
    v_mfma_f32_16x16x32_bf16 v[144:147], a[160:163], v[172:175], v[144:147]
    v_mfma_f32_16x16x32_bf16 v[148:151], a[164:167], v[172:175], v[148:151]
    v_mfma_f32_16x16x32_bf16 v[152:155], a[168:171], v[172:175], v[152:155]
    v_mfma_f32_16x16x32_bf16 v[156:159], a[172:175], v[172:175], v[156:159]
    s_waitcnt vmcnt(13) lgkmcnt(0)
    s_barrier
    v_mfma_f32_16x16x32_bf16 v[96:99], a[176:179], v[176:179], v[96:99]
    ds_read_b128 v[160:163], v224 offset:49152
    v_mfma_f32_16x16x32_bf16 v[100:103], a[180:183], v[176:179], v[100:103]
    ds_read_b128 v[164:167], v224 offset:51200
    v_mfma_f32_16x16x32_bf16 v[104:107], a[184:187], v[176:179], v[104:107]
    ds_read_b128 v[168:171], v224 offset:53248
    v_mfma_f32_16x16x32_bf16 v[108:111], a[188:191], v[176:179], v[108:111]
    ds_read_b128 v[172:175], v224 offset:55296
    v_mfma_f32_16x16x32_bf16 v[112:115], a[176:179], v[180:183], v[112:115]
    s_add_u32 s38, s36, 8192
    buffer_store_dwordx4 v[80:83], v240, s[16:19], s38 offen offset:0 sc1
    v_mfma_f32_16x16x32_bf16 v[116:119], a[180:183], v[180:183], v[116:119]
    s_lshl_b32 s39, s5, 2
    buffer_atomic_add v255, v250, s[88:91], s39 offen sc1
    s_cmp_eq_u32 s3, 0
    s_cselect_b32 s39, s39, s43
    v_mfma_f32_16x16x32_bf16 v[120:123], a[184:187], v[180:183], v[120:123]
    v_mfma_f32_16x16x32_bf16 v[124:127], a[188:191], v[180:183], v[124:127]
    v_mfma_f32_16x16x32_bf16 v[128:131], a[176:179], v[184:187], v[128:131]
    v_mfma_f32_16x16x32_bf16 v[132:135], a[180:183], v[184:187], v[132:135]
    v_mfma_f32_16x16x32_bf16 v[136:139], a[184:187], v[184:187], v[136:139]
    v_mfma_f32_16x16x32_bf16 v[140:143], a[188:191], v[184:187], v[140:143]
    v_mfma_f32_16x16x32_bf16 v[144:147], a[176:179], v[188:191], v[144:147]
    v_mfma_f32_16x16x32_bf16 v[148:151], a[180:183], v[188:191], v[148:151]
    v_mfma_f32_16x16x32_bf16 v[152:155], a[184:187], v[188:191], v[152:155]
    v_mfma_f32_16x16x32_bf16 v[156:159], a[188:191], v[188:191], v[156:159]
    s_waitcnt lgkmcnt(0)
    v_mfma_f32_16x16x32_bf16 v[96:99], a[192:195], v[160:163], v[96:99]
    ds_read_b128 v[176:179], v225 offset:49152
    v_mfma_f32_16x16x32_bf16 v[100:103], a[196:199], v[160:163], v[100:103]
    ds_read_b128 v[180:183], v225 offset:51200
    v_mfma_f32_16x16x32_bf16 v[104:107], a[200:203], v[160:163], v[104:107]
    ds_read_b128 v[184:187], v225 offset:53248
    v_mfma_f32_16x16x32_bf16 v[108:111], a[204:207], v[160:163], v[108:111]
    ds_read_b128 v[188:191], v225 offset:55296
    v_mfma_f32_16x16x32_bf16 v[112:115], a[192:195], v[164:167], v[112:115]
    v_mfma_f32_16x16x32_bf16 v[116:119], a[196:199], v[164:167], v[116:119]
    s_add_u32 m0, s34, 147456
    s_add_u32 s37, s86, 131072
    buffer_load_dwordx4 v232, s[44:47], s37 offen lds
    v_mfma_f32_16x16x32_bf16 v[120:123], a[200:203], v[164:167], v[120:123]
    v_mfma_f32_16x16x32_bf16 v[124:127], a[204:207], v[164:167], v[124:127]
    buffer_load_dwordx4 v233, s[44:47], s37 offen offset:1024 lds
    v_mfma_f32_16x16x32_bf16 v[128:131], a[192:195], v[168:171], v[128:131]
    v_mfma_f32_16x16x32_bf16 v[132:135], a[196:199], v[168:171], v[132:135]
    v_mfma_f32_16x16x32_bf16 v[136:139], a[200:203], v[168:171], v[136:139]
    s_add_u32 s38, s36, 8192
    buffer_store_dwordx4 v[84:87], v240, s[16:19], s38 offen offset:2048 sc1
    v_mfma_f32_16x16x32_bf16 v[140:143], a[204:207], v[168:171], v[140:143]
    v_mfma_f32_16x16x32_bf16 v[144:147], a[192:195], v[172:175], v[144:147]
    v_mfma_f32_16x16x32_bf16 v[148:151], a[196:199], v[172:175], v[148:151]
    v_mfma_f32_16x16x32_bf16 v[152:155], a[200:203], v[172:175], v[152:155]
    v_mfma_f32_16x16x32_bf16 v[156:159], a[204:207], v[172:175], v[156:159]
    s_waitcnt lgkmcnt(0)
    v_mfma_f32_16x16x32_bf16 v[96:99], a[208:211], v[176:179], v[96:99]
    ds_read_b128 v[160:163], v224 offset:57344
    v_mfma_f32_16x16x32_bf16 v[100:103], a[212:215], v[176:179], v[100:103]
    ds_read_b128 v[164:167], v224 offset:59392
    v_mfma_f32_16x16x32_bf16 v[104:107], a[216:219], v[176:179], v[104:107]
    ds_read_b128 v[168:171], v224 offset:61440
    v_mfma_f32_16x16x32_bf16 v[108:111], a[220:223], v[176:179], v[108:111]
    ds_read_b128 v[172:175], v224 offset:63488
    v_mfma_f32_16x16x32_bf16 v[112:115], a[208:211], v[180:183], v[112:115]
    v_mfma_f32_16x16x32_bf16 v[116:119], a[212:215], v[180:183], v[116:119]
    s_add_u32 m0, s34, 155648
    s_add_u32 s37, s87, 131072
    buffer_load_dwordx4 v232, s[44:47], s37 offen lds
    v_mfma_f32_16x16x32_bf16 v[120:123], a[216:219], v[180:183], v[120:123]
    v_mfma_f32_16x16x32_bf16 v[124:127], a[220:223], v[180:183], v[124:127]
    buffer_load_dwordx4 v233, s[44:47], s37 offen offset:1024 lds
    v_mfma_f32_16x16x32_bf16 v[128:131], a[208:211], v[184:187], v[128:131]
    v_mfma_f32_16x16x32_bf16 v[132:135], a[212:215], v[184:187], v[132:135]
    v_mfma_f32_16x16x32_bf16 v[136:139], a[216:219], v[184:187], v[136:139]
    v_mfma_f32_16x16x32_bf16 v[140:143], a[220:223], v[184:187], v[140:143]
    v_mfma_f32_16x16x32_bf16 v[144:147], a[208:211], v[188:191], v[144:147]
    v_mfma_f32_16x16x32_bf16 v[148:151], a[212:215], v[188:191], v[148:151]
    v_mfma_f32_16x16x32_bf16 v[152:155], a[216:219], v[188:191], v[152:155]
    v_mfma_f32_16x16x32_bf16 v[156:159], a[220:223], v[188:191], v[156:159]
    s_waitcnt lgkmcnt(0)
    v_mfma_f32_16x16x32_bf16 v[96:99], a[224:227], v[160:163], v[96:99]
    ds_read_b128 v[176:179], v225 offset:57344
    s_add_u32 s38, s36, 8192
    buffer_store_dwordx4 v[88:91], v240, s[16:19], s38 offen offset:1024 sc1
    v_mfma_f32_16x16x32_bf16 v[100:103], a[228:231], v[160:163], v[100:103]
    ds_read_b128 v[180:183], v225 offset:59392
    v_mfma_f32_16x16x32_bf16 v[104:107], a[232:235], v[160:163], v[104:107]
    ds_read_b128 v[184:187], v225 offset:61440
    v_mfma_f32_16x16x32_bf16 v[108:111], a[236:239], v[160:163], v[108:111]
    ds_read_b128 v[188:191], v225 offset:63488
    v_mfma_f32_16x16x32_bf16 v[112:115], a[224:227], v[164:167], v[112:115]
    v_mfma_f32_16x16x32_bf16 v[116:119], a[228:231], v[164:167], v[116:119]
    v_mfma_f32_16x16x32_bf16 v[120:123], a[232:235], v[164:167], v[120:123]
    v_mfma_f32_16x16x32_bf16 v[124:127], a[236:239], v[164:167], v[124:127]
    v_mfma_f32_16x16x32_bf16 v[128:131], a[224:227], v[168:171], v[128:131]
    v_mfma_f32_16x16x32_bf16 v[132:135], a[228:231], v[168:171], v[132:135]
    v_mfma_f32_16x16x32_bf16 v[136:139], a[232:235], v[168:171], v[136:139]
    v_mfma_f32_16x16x32_bf16 v[140:143], a[236:239], v[168:171], v[140:143]
    v_mfma_f32_16x16x32_bf16 v[144:147], a[224:227], v[172:175], v[144:147]
    v_mfma_f32_16x16x32_bf16 v[148:151], a[228:231], v[172:175], v[148:151]
    v_mfma_f32_16x16x32_bf16 v[152:155], a[232:235], v[172:175], v[152:155]
    v_mfma_f32_16x16x32_bf16 v[156:159], a[236:239], v[172:175], v[156:159]
    s_waitcnt vmcnt(14) lgkmcnt(0)
    s_barrier
    v_mfma_f32_16x16x32_bf16 v[96:99], a[240:243], v[176:179], v[96:99]
    ds_read_b128 v[160:163], v226 offset:0
    v_mfma_f32_16x16x32_bf16 v[100:103], a[244:247], v[176:179], v[100:103]
    ds_read_b128 v[164:167], v226 offset:2048
    v_mfma_f32_16x16x32_bf16 v[104:107], a[248:251], v[176:179], v[104:107]
    ds_read_b128 v[168:171], v226 offset:4096
    v_mfma_f32_16x16x32_bf16 v[108:111], a[252:255], v[176:179], v[108:111]
    ds_read_b128 v[172:175], v226 offset:6144
    v_mfma_f32_16x16x32_bf16 v[112:115], a[240:243], v[180:183], v[112:115]
    v_mfma_f32_16x16x32_bf16 v[116:119], a[244:247], v[180:183], v[116:119]
    v_mfma_f32_16x16x32_bf16 v[120:123], a[248:251], v[180:183], v[120:123]
    s_add_u32 s38, s36, 8192
    buffer_store_dwordx4 v[92:95], v240, s[16:19], s38 offen offset:3072 sc1
    v_mfma_f32_16x16x32_bf16 v[124:127], a[252:255], v[180:183], v[124:127]
    v_mfma_f32_16x16x32_bf16 v[128:131], a[240:243], v[184:187], v[128:131]
    v_mfma_f32_16x16x32_bf16 v[132:135], a[244:247], v[184:187], v[132:135]
    v_cvt_pk_bf16_f32 v64, v96, v97
    v_cvt_pk_bf16_f32 v65, v98, v99
    v_mfma_f32_16x16x32_bf16 v[136:139], a[248:251], v[184:187], v[136:139]
    v_cvt_pk_bf16_f32 v66, v100, v101
    v_cvt_pk_bf16_f32 v67, v102, v103
    v_mfma_f32_16x16x32_bf16 v[140:143], a[252:255], v[184:187], v[140:143]
    v_cvt_pk_bf16_f32 v68, v104, v105
    v_cvt_pk_bf16_f32 v69, v106, v107
    v_mfma_f32_16x16x32_bf16 v[144:147], a[240:243], v[188:191], v[144:147]
    v_cvt_pk_bf16_f32 v70, v108, v109
    v_cvt_pk_bf16_f32 v71, v110, v111
    v_mfma_f32_16x16x32_bf16 v[148:151], a[244:247], v[188:191], v[148:151]
    v_cvt_pk_bf16_f32 v72, v112, v113
    v_cvt_pk_bf16_f32 v73, v114, v115
    v_mfma_f32_16x16x32_bf16 v[152:155], a[248:251], v[188:191], v[152:155]
    v_cvt_pk_bf16_f32 v74, v116, v117
    v_cvt_pk_bf16_f32 v75, v118, v119
    v_mfma_f32_16x16x32_bf16 v[156:159], a[252:255], v[188:191], v[156:159]
    v_cvt_pk_bf16_f32 v76, v120, v121
    v_cvt_pk_bf16_f32 v77, v122, v123
    s_waitcnt lgkmcnt(0)
    v_mfma_f32_16x16x32_bf16 v[96:99], a[0:3], v[160:163], 0
    ds_read_b128 v[176:179], v227 offset:0
    v_cvt_pk_bf16_f32 v78, v124, v125
    v_cvt_pk_bf16_f32 v79, v126, v127
    v_mfma_f32_16x16x32_bf16 v[100:103], a[4:7], v[160:163], 0
    ds_read_b128 v[180:183], v227 offset:2048
    v_cvt_pk_bf16_f32 v80, v128, v129
    v_cvt_pk_bf16_f32 v81, v130, v131
    v_mfma_f32_16x16x32_bf16 v[104:107], a[8:11], v[160:163], 0
    ds_read_b128 v[184:187], v227 offset:4096
    v_cvt_pk_bf16_f32 v82, v132, v133
    v_cvt_pk_bf16_f32 v83, v134, v135
    v_mfma_f32_16x16x32_bf16 v[108:111], a[12:15], v[160:163], 0
    ds_read_b128 v[188:191], v227 offset:6144
    v_cvt_pk_bf16_f32 v84, v136, v137
    v_cvt_pk_bf16_f32 v85, v138, v139
    v_mfma_f32_16x16x32_bf16 v[112:115], a[0:3], v[164:167], 0
    v_cvt_pk_bf16_f32 v86, v140, v141
    v_cvt_pk_bf16_f32 v87, v142, v143
    v_mfma_f32_16x16x32_bf16 v[116:119], a[4:7], v[164:167], 0
    s_add_u32 m0, s34, 0
    s_add_u32 s37, s80, 196608
    buffer_load_dwordx4 v232, s[44:47], s37 offen lds
    v_cvt_pk_bf16_f32 v88, v144, v145
    v_cvt_pk_bf16_f32 v89, v146, v147
    v_mfma_f32_16x16x32_bf16 v[120:123], a[8:11], v[164:167], 0
    v_cvt_pk_bf16_f32 v90, v148, v149
    v_cvt_pk_bf16_f32 v91, v150, v151
    v_mfma_f32_16x16x32_bf16 v[124:127], a[12:15], v[164:167], 0
    buffer_load_dwordx4 v233, s[44:47], s37 offen offset:1024 lds
    v_cvt_pk_bf16_f32 v92, v152, v153
    v_cvt_pk_bf16_f32 v93, v154, v155
    v_mfma_f32_16x16x32_bf16 v[128:131], a[0:3], v[168:171], 0
    v_cvt_pk_bf16_f32 v94, v156, v157
    v_cvt_pk_bf16_f32 v95, v158, v159
    v_mfma_f32_16x16x32_bf16 v[132:135], a[4:7], v[168:171], 0
    v_mfma_f32_16x16x32_bf16 v[136:139], a[8:11], v[168:171], 0
    s_add_u32 s38, s36, 32768
    buffer_store_dwordx4 v[64:67], v240, s[16:19], s38 offen offset:1280 sc1
    v_mfma_f32_16x16x32_bf16 v[140:143], a[12:15], v[168:171], 0
    v_mfma_f32_16x16x32_bf16 v[144:147], a[0:3], v[172:175], 0
    v_mfma_f32_16x16x32_bf16 v[148:151], a[4:7], v[172:175], 0
    v_mfma_f32_16x16x32_bf16 v[152:155], a[8:11], v[172:175], 0
    v_mfma_f32_16x16x32_bf16 v[156:159], a[12:15], v[172:175], 0
    s_waitcnt lgkmcnt(0)
    v_mfma_f32_16x16x32_bf16 v[96:99], a[16:19], v[176:179], v[96:99]
    ds_read_b128 v[160:163], v226 offset:8192
    v_mfma_f32_16x16x32_bf16 v[100:103], a[20:23], v[176:179], v[100:103]
    ds_read_b128 v[164:167], v226 offset:10240
    v_mfma_f32_16x16x32_bf16 v[104:107], a[24:27], v[176:179], v[104:107]
    ds_read_b128 v[168:171], v226 offset:12288
    v_mfma_f32_16x16x32_bf16 v[108:111], a[28:31], v[176:179], v[108:111]
    ds_read_b128 v[172:175], v226 offset:14336
    v_mfma_f32_16x16x32_bf16 v[112:115], a[16:19], v[180:183], v[112:115]
    v_mfma_f32_16x16x32_bf16 v[116:119], a[20:23], v[180:183], v[116:119]
    s_add_u32 m0, s31, 0
    s_add_u32 s24, s27, 0
    buffer_load_dwordx4 v245, s[12:15], s24 offen lds
    v_mfma_f32_16x16x32_bf16 v[120:123], a[24:27], v[180:183], v[120:123]
    v_mfma_f32_16x16x32_bf16 v[124:127], a[28:31], v[180:183], v[124:127]
    v_mfma_f32_16x16x32_bf16 v[128:131], a[16:19], v[184:187], v[128:131]
    v_mfma_f32_16x16x32_bf16 v[132:135], a[20:23], v[184:187], v[132:135]
    v_mfma_f32_16x16x32_bf16 v[136:139], a[24:27], v[184:187], v[136:139]
    v_mfma_f32_16x16x32_bf16 v[140:143], a[28:31], v[184:187], v[140:143]
    v_mfma_f32_16x16x32_bf16 v[144:147], a[16:19], v[188:191], v[144:147]
    v_mfma_f32_16x16x32_bf16 v[148:151], a[20:23], v[188:191], v[148:151]
    v_mfma_f32_16x16x32_bf16 v[152:155], a[24:27], v[188:191], v[152:155]
    v_mfma_f32_16x16x32_bf16 v[156:159], a[28:31], v[188:191], v[156:159]
    s_waitcnt lgkmcnt(0)
    v_mfma_f32_16x16x32_bf16 v[96:99], a[32:35], v[160:163], v[96:99]
    ds_read_b128 v[176:179], v227 offset:8192
    v_mfma_f32_16x16x32_bf16 v[100:103], a[36:39], v[160:163], v[100:103]
    ds_read_b128 v[180:183], v227 offset:10240
    v_mfma_f32_16x16x32_bf16 v[104:107], a[40:43], v[160:163], v[104:107]
    ds_read_b128 v[184:187], v227 offset:12288
    v_mfma_f32_16x16x32_bf16 v[108:111], a[44:47], v[160:163], v[108:111]
    ds_read_b128 v[188:191], v227 offset:14336
    v_mfma_f32_16x16x32_bf16 v[112:115], a[32:35], v[164:167], v[112:115]
    v_mfma_f32_16x16x32_bf16 v[116:119], a[36:39], v[164:167], v[116:119]
    s_add_u32 m0, s34, 8192
    s_add_u32 s37, s81, 196608
    buffer_load_dwordx4 v232, s[44:47], s37 offen lds
    v_mfma_f32_16x16x32_bf16 v[120:123], a[40:43], v[164:167], v[120:123]
    v_mfma_f32_16x16x32_bf16 v[124:127], a[44:47], v[164:167], v[124:127]
    buffer_load_dwordx4 v233, s[44:47], s37 offen offset:1024 lds
    v_mfma_f32_16x16x32_bf16 v[128:131], a[32:35], v[168:171], v[128:131]
    v_mfma_f32_16x16x32_bf16 v[132:135], a[36:39], v[168:171], v[132:135]
    v_mfma_f32_16x16x32_bf16 v[136:139], a[40:43], v[168:171], v[136:139]
    s_add_u32 s38, s36, 32768
    buffer_store_dwordx4 v[68:71], v240, s[16:19], s38 offen offset:3328 sc1
    v_mfma_f32_16x16x32_bf16 v[140:143], a[44:47], v[168:171], v[140:143]
    v_mfma_f32_16x16x32_bf16 v[144:147], a[32:35], v[172:175], v[144:147]
    v_mfma_f32_16x16x32_bf16 v[148:151], a[36:39], v[172:175], v[148:151]
    v_mfma_f32_16x16x32_bf16 v[152:155], a[40:43], v[172:175], v[152:155]
    v_mfma_f32_16x16x32_bf16 v[156:159], a[44:47], v[172:175], v[156:159]
    s_waitcnt lgkmcnt(0)
    v_mfma_f32_16x16x32_bf16 v[96:99], a[48:51], v[176:179], v[96:99]
    ds_read_b128 v[160:163], v226 offset:16384
    v_mfma_f32_16x16x32_bf16 v[100:103], a[52:55], v[176:179], v[100:103]
    ds_read_b128 v[164:167], v226 offset:18432
    v_mfma_f32_16x16x32_bf16 v[104:107], a[56:59], v[176:179], v[104:107]
    ds_read_b128 v[168:171], v226 offset:20480
    v_mfma_f32_16x16x32_bf16 v[108:111], a[60:63], v[176:179], v[108:111]
    ds_read_b128 v[172:175], v226 offset:22528
    v_mfma_f32_16x16x32_bf16 v[112:115], a[48:51], v[180:183], v[112:115]
    v_mfma_f32_16x16x32_bf16 v[116:119], a[52:55], v[180:183], v[116:119]
    s_add_u32 m0, s31, 1024
    s_add_u32 s24, s27, 32768
    buffer_load_dwordx4 v245, s[12:15], s24 offen lds
    v_mfma_f32_16x16x32_bf16 v[120:123], a[56:59], v[180:183], v[120:123]
    v_mfma_f32_16x16x32_bf16 v[124:127], a[60:63], v[180:183], v[124:127]
    v_mfma_f32_16x16x32_bf16 v[128:131], a[48:51], v[184:187], v[128:131]
    v_mfma_f32_16x16x32_bf16 v[132:135], a[52:55], v[184:187], v[132:135]
    v_mfma_f32_16x16x32_bf16 v[136:139], a[56:59], v[184:187], v[136:139]
    v_mfma_f32_16x16x32_bf16 v[140:143], a[60:63], v[184:187], v[140:143]
    v_mfma_f32_16x16x32_bf16 v[144:147], a[48:51], v[188:191], v[144:147]
    v_mfma_f32_16x16x32_bf16 v[148:151], a[52:55], v[188:191], v[148:151]
    v_mfma_f32_16x16x32_bf16 v[152:155], a[56:59], v[188:191], v[152:155]
    v_mfma_f32_16x16x32_bf16 v[156:159], a[60:63], v[188:191], v[156:159]
    s_waitcnt lgkmcnt(0)
    v_mfma_f32_16x16x32_bf16 v[96:99], a[64:67], v[160:163], v[96:99]
    ds_read_b128 v[176:179], v227 offset:16384
    v_mfma_f32_16x16x32_bf16 v[100:103], a[68:71], v[160:163], v[100:103]
    ds_read_b128 v[180:183], v227 offset:18432
    v_mfma_f32_16x16x32_bf16 v[104:107], a[72:75], v[160:163], v[104:107]
    ds_read_b128 v[184:187], v227 offset:20480
    v_mfma_f32_16x16x32_bf16 v[108:111], a[76:79], v[160:163], v[108:111]
    ds_read_b128 v[188:191], v227 offset:22528
    v_mfma_f32_16x16x32_bf16 v[112:115], a[64:67], v[164:167], v[112:115]
    v_mfma_f32_16x16x32_bf16 v[116:119], a[68:71], v[164:167], v[116:119]
    s_add_u32 m0, s34, 16384
    s_add_u32 s37, s82, 196608
    buffer_load_dwordx4 v232, s[44:47], s37 offen lds
    v_mfma_f32_16x16x32_bf16 v[120:123], a[72:75], v[164:167], v[120:123]
    v_mfma_f32_16x16x32_bf16 v[124:127], a[76:79], v[164:167], v[124:127]
    buffer_load_dwordx4 v233, s[44:47], s37 offen offset:1024 lds
    v_mfma_f32_16x16x32_bf16 v[128:131], a[64:67], v[168:171], v[128:131]
    v_mfma_f32_16x16x32_bf16 v[132:135], a[68:71], v[168:171], v[132:135]
    v_mfma_f32_16x16x32_bf16 v[136:139], a[72:75], v[168:171], v[136:139]
    v_mfma_f32_16x16x32_bf16 v[140:143], a[76:79], v[168:171], v[140:143]
    s_add_u32 s38, s36, 32768
    buffer_store_dwordx4 v[72:75], v240, s[16:19], s38 offen offset:2304 sc1
    v_mfma_f32_16x16x32_bf16 v[144:147], a[64:67], v[172:175], v[144:147]
    v_mfma_f32_16x16x32_bf16 v[148:151], a[68:71], v[172:175], v[148:151]
    v_mfma_f32_16x16x32_bf16 v[152:155], a[72:75], v[172:175], v[152:155]
    v_mfma_f32_16x16x32_bf16 v[156:159], a[76:79], v[172:175], v[156:159]
    s_waitcnt lgkmcnt(0)
    v_mfma_f32_16x16x32_bf16 v[96:99], a[80:83], v[176:179], v[96:99]
    ds_read_b128 v[160:163], v226 offset:24576
    v_mfma_f32_16x16x32_bf16 v[100:103], a[84:87], v[176:179], v[100:103]
    ds_read_b128 v[164:167], v226 offset:26624
    v_mfma_f32_16x16x32_bf16 v[104:107], a[88:91], v[176:179], v[104:107]
    ds_read_b128 v[168:171], v226 offset:28672
    v_mfma_f32_16x16x32_bf16 v[108:111], a[92:95], v[176:179], v[108:111]
    ds_read_b128 v[172:175], v226 offset:30720
    v_mfma_f32_16x16x32_bf16 v[112:115], a[80:83], v[180:183], v[112:115]
    v_mfma_f32_16x16x32_bf16 v[116:119], a[84:87], v[180:183], v[116:119]
    s_add_u32 m0, s31, 2048
    s_add_u32 s24, s27, 65536
    buffer_load_dwordx4 v245, s[12:15], s24 offen lds
    v_mfma_f32_16x16x32_bf16 v[120:123], a[88:91], v[180:183], v[120:123]
    v_mfma_f32_16x16x32_bf16 v[124:127], a[92:95], v[180:183], v[124:127]
    v_mfma_f32_16x16x32_bf16 v[128:131], a[80:83], v[184:187], v[128:131]
    v_mfma_f32_16x16x32_bf16 v[132:135], a[84:87], v[184:187], v[132:135]
    v_mfma_f32_16x16x32_bf16 v[136:139], a[88:91], v[184:187], v[136:139]
    v_mfma_f32_16x16x32_bf16 v[140:143], a[92:95], v[184:187], v[140:143]
    v_mfma_f32_16x16x32_bf16 v[144:147], a[80:83], v[188:191], v[144:147]
    v_mfma_f32_16x16x32_bf16 v[148:151], a[84:87], v[188:191], v[148:151]
    v_mfma_f32_16x16x32_bf16 v[152:155], a[88:91], v[188:191], v[152:155]
    v_mfma_f32_16x16x32_bf16 v[156:159], a[92:95], v[188:191], v[156:159]
    s_waitcnt lgkmcnt(0)
    v_mfma_f32_16x16x32_bf16 v[96:99], a[96:99], v[160:163], v[96:99]
    ds_read_b128 v[176:179], v227 offset:24576
    v_mfma_f32_16x16x32_bf16 v[100:103], a[100:103], v[160:163], v[100:103]
    ds_read_b128 v[180:183], v227 offset:26624
    v_mfma_f32_16x16x32_bf16 v[104:107], a[104:107], v[160:163], v[104:107]
    ds_read_b128 v[184:187], v227 offset:28672
    v_mfma_f32_16x16x32_bf16 v[108:111], a[108:111], v[160:163], v[108:111]
    ds_read_b128 v[188:191], v227 offset:30720
    v_mfma_f32_16x16x32_bf16 v[112:115], a[96:99], v[164:167], v[112:115]
    v_mfma_f32_16x16x32_bf16 v[116:119], a[100:103], v[164:167], v[116:119]
    s_add_u32 m0, s34, 24576
    s_add_u32 s37, s83, 196608
    buffer_load_dwordx4 v232, s[44:47], s37 offen lds
    v_mfma_f32_16x16x32_bf16 v[120:123], a[104:107], v[164:167], v[120:123]
    v_mfma_f32_16x16x32_bf16 v[124:127], a[108:111], v[164:167], v[124:127]
    buffer_load_dwordx4 v233, s[44:47], s37 offen offset:1024 lds
    v_mfma_f32_16x16x32_bf16 v[128:131], a[96:99], v[168:171], v[128:131]
    v_mfma_f32_16x16x32_bf16 v[132:135], a[100:103], v[168:171], v[132:135]
    v_mfma_f32_16x16x32_bf16 v[136:139], a[104:107], v[168:171], v[136:139]
    v_mfma_f32_16x16x32_bf16 v[140:143], a[108:111], v[168:171], v[140:143]
    v_mfma_f32_16x16x32_bf16 v[144:147], a[96:99], v[172:175], v[144:147]
    s_add_u32 s38, s36, 36864
    buffer_store_dwordx4 v[76:79], v240, s[16:19], s38 offen offset:256 sc1
    v_mfma_f32_16x16x32_bf16 v[148:151], a[100:103], v[172:175], v[148:151]
    v_mfma_f32_16x16x32_bf16 v[152:155], a[104:107], v[172:175], v[152:155]
    v_mfma_f32_16x16x32_bf16 v[156:159], a[108:111], v[172:175], v[156:159]
    s_waitcnt vmcnt(17) lgkmcnt(0)
    s_barrier
    v_mfma_f32_16x16x32_bf16 v[96:99], a[112:115], v[176:179], v[96:99]
    ds_read_b128 v[160:163], v226 offset:32768
    v_mfma_f32_16x16x32_bf16 v[100:103], a[116:119], v[176:179], v[100:103]
    ds_read_b128 v[164:167], v226 offset:34816
    v_mfma_f32_16x16x32_bf16 v[104:107], a[120:123], v[176:179], v[104:107]
    ds_read_b128 v[168:171], v226 offset:36864
    v_mfma_f32_16x16x32_bf16 v[108:111], a[124:127], v[176:179], v[108:111]
    ds_read_b128 v[172:175], v226 offset:38912
    v_mfma_f32_16x16x32_bf16 v[112:115], a[112:115], v[180:183], v[112:115]
    v_mfma_f32_16x16x32_bf16 v[116:119], a[116:119], v[180:183], v[116:119]
    s_add_u32 m0, s31, 3072
    s_add_u32 s24, s27, 98304
    buffer_load_dwordx4 v245, s[12:15], s24 offen lds
    v_mfma_f32_16x16x32_bf16 v[120:123], a[120:123], v[180:183], v[120:123]
    v_mfma_f32_16x16x32_bf16 v[124:127], a[124:127], v[180:183], v[124:127]
    v_mfma_f32_16x16x32_bf16 v[128:131], a[112:115], v[184:187], v[128:131]
    v_mfma_f32_16x16x32_bf16 v[132:135], a[116:119], v[184:187], v[132:135]
    v_mfma_f32_16x16x32_bf16 v[136:139], a[120:123], v[184:187], v[136:139]
    v_mfma_f32_16x16x32_bf16 v[140:143], a[124:127], v[184:187], v[140:143]
    v_mfma_f32_16x16x32_bf16 v[144:147], a[112:115], v[188:191], v[144:147]
    v_mfma_f32_16x16x32_bf16 v[148:151], a[116:119], v[188:191], v[148:151]
    v_mfma_f32_16x16x32_bf16 v[152:155], a[120:123], v[188:191], v[152:155]
    v_mfma_f32_16x16x32_bf16 v[156:159], a[124:127], v[188:191], v[156:159]
    s_waitcnt lgkmcnt(0)
    v_mfma_f32_16x16x32_bf16 v[96:99], a[128:131], v[160:163], v[96:99]
    ds_read_b128 v[176:179], v227 offset:32768
    v_mfma_f32_16x16x32_bf16 v[100:103], a[132:135], v[160:163], v[100:103]
    ds_read_b128 v[180:183], v227 offset:34816
    v_mfma_f32_16x16x32_bf16 v[104:107], a[136:139], v[160:163], v[104:107]
    ds_read_b128 v[184:187], v227 offset:36864
    v_mfma_f32_16x16x32_bf16 v[108:111], a[140:143], v[160:163], v[108:111]
    ds_read_b128 v[188:191], v227 offset:38912
    v_mfma_f32_16x16x32_bf16 v[112:115], a[128:131], v[164:167], v[112:115]
    v_mfma_f32_16x16x32_bf16 v[116:119], a[132:135], v[164:167], v[116:119]
    s_add_u32 m0, s34, 32768
    s_add_u32 s37, s84, 196608
    buffer_load_dwordx4 v232, s[44:47], s37 offen lds
    v_mfma_f32_16x16x32_bf16 v[120:123], a[136:139], v[164:167], v[120:123]
    v_mfma_f32_16x16x32_bf16 v[124:127], a[140:143], v[164:167], v[124:127]
    buffer_load_dwordx4 v233, s[44:47], s37 offen offset:1024 lds
    v_mfma_f32_16x16x32_bf16 v[128:131], a[128:131], v[168:171], v[128:131]
    v_mfma_f32_16x16x32_bf16 v[132:135], a[132:135], v[168:171], v[132:135]
    v_mfma_f32_16x16x32_bf16 v[136:139], a[136:139], v[168:171], v[136:139]
    v_mfma_f32_16x16x32_bf16 v[140:143], a[140:143], v[168:171], v[140:143]
    v_mfma_f32_16x16x32_bf16 v[144:147], a[128:131], v[172:175], v[144:147]
    v_mfma_f32_16x16x32_bf16 v[148:151], a[132:135], v[172:175], v[148:151]
    s_add_u32 s38, s36, 40960
    buffer_store_dwordx4 v[80:83], v240, s[16:19], s38 offen offset:1280 sc1
    v_mfma_f32_16x16x32_bf16 v[152:155], a[136:139], v[172:175], v[152:155]
    v_mfma_f32_16x16x32_bf16 v[156:159], a[140:143], v[172:175], v[156:159]
    s_waitcnt lgkmcnt(0)
    v_mfma_f32_16x16x32_bf16 v[96:99], a[144:147], v[176:179], v[96:99]
    ds_read_b128 v[160:163], v226 offset:40960
    v_mfma_f32_16x16x32_bf16 v[100:103], a[148:151], v[176:179], v[100:103]
    ds_read_b128 v[164:167], v226 offset:43008
    v_mfma_f32_16x16x32_bf16 v[104:107], a[152:155], v[176:179], v[104:107]
    ds_read_b128 v[168:171], v226 offset:45056
    v_mfma_f32_16x16x32_bf16 v[108:111], a[156:159], v[176:179], v[108:111]
    ds_read_b128 v[172:175], v226 offset:47104
    v_mfma_f32_16x16x32_bf16 v[112:115], a[144:147], v[180:183], v[112:115]
    v_mfma_f32_16x16x32_bf16 v[116:119], a[148:151], v[180:183], v[116:119]
    s_add_u32 m0, s31, 4096
    s_add_u32 s24, s27, 131072
    buffer_load_dwordx4 v245, s[12:15], s24 offen lds
    v_mfma_f32_16x16x32_bf16 v[120:123], a[152:155], v[180:183], v[120:123]
    v_mfma_f32_16x16x32_bf16 v[124:127], a[156:159], v[180:183], v[124:127]
    v_mfma_f32_16x16x32_bf16 v[128:131], a[144:147], v[184:187], v[128:131]
    v_mfma_f32_16x16x32_bf16 v[132:135], a[148:151], v[184:187], v[132:135]
    v_mfma_f32_16x16x32_bf16 v[136:139], a[152:155], v[184:187], v[136:139]
    v_mfma_f32_16x16x32_bf16 v[140:143], a[156:159], v[184:187], v[140:143]
    v_mfma_f32_16x16x32_bf16 v[144:147], a[144:147], v[188:191], v[144:147]
    v_mfma_f32_16x16x32_bf16 v[148:151], a[148:151], v[188:191], v[148:151]
    v_mfma_f32_16x16x32_bf16 v[152:155], a[152:155], v[188:191], v[152:155]
    v_mfma_f32_16x16x32_bf16 v[156:159], a[156:159], v[188:191], v[156:159]
    s_waitcnt lgkmcnt(0)
    v_mfma_f32_16x16x32_bf16 v[96:99], a[160:163], v[160:163], v[96:99]
    ds_read_b128 v[176:179], v227 offset:40960
    v_mfma_f32_16x16x32_bf16 v[100:103], a[164:167], v[160:163], v[100:103]
    ds_read_b128 v[180:183], v227 offset:43008
    v_mfma_f32_16x16x32_bf16 v[104:107], a[168:171], v[160:163], v[104:107]
    ds_read_b128 v[184:187], v227 offset:45056
    v_mfma_f32_16x16x32_bf16 v[108:111], a[172:175], v[160:163], v[108:111]
    ds_read_b128 v[188:191], v227 offset:47104
    v_mfma_f32_16x16x32_bf16 v[112:115], a[160:163], v[164:167], v[112:115]
    v_mfma_f32_16x16x32_bf16 v[116:119], a[164:167], v[164:167], v[116:119]
    s_add_u32 m0, s34, 40960
    s_add_u32 s37, s85, 196608
    buffer_load_dwordx4 v232, s[44:47], s37 offen lds
    v_mfma_f32_16x16x32_bf16 v[120:123], a[168:171], v[164:167], v[120:123]
    v_mfma_f32_16x16x32_bf16 v[124:127], a[172:175], v[164:167], v[124:127]
    buffer_load_dwordx4 v233, s[44:47], s37 offen offset:1024 lds
    v_mfma_f32_16x16x32_bf16 v[128:131], a[160:163], v[168:171], v[128:131]
    v_mfma_f32_16x16x32_bf16 v[132:135], a[164:167], v[168:171], v[132:135]
    v_mfma_f32_16x16x32_bf16 v[136:139], a[168:171], v[168:171], v[136:139]
    v_mfma_f32_16x16x32_bf16 v[140:143], a[172:175], v[168:171], v[140:143]
    v_mfma_f32_16x16x32_bf16 v[144:147], a[160:163], v[172:175], v[144:147]
    v_mfma_f32_16x16x32_bf16 v[148:151], a[164:167], v[172:175], v[148:151]
    v_mfma_f32_16x16x32_bf16 v[152:155], a[168:171], v[172:175], v[152:155]
    s_add_u32 s38, s36, 40960
    buffer_store_dwordx4 v[84:87], v240, s[16:19], s38 offen offset:3328 sc1
    v_mfma_f32_16x16x32_bf16 v[156:159], a[172:175], v[172:175], v[156:159]
    s_waitcnt lgkmcnt(0)
    v_mfma_f32_16x16x32_bf16 v[96:99], a[176:179], v[176:179], v[96:99]
    ds_read_b128 v[160:163], v226 offset:49152
    v_mfma_f32_16x16x32_bf16 v[100:103], a[180:183], v[176:179], v[100:103]
    ds_read_b128 v[164:167], v226 offset:51200
    v_mfma_f32_16x16x32_bf16 v[104:107], a[184:187], v[176:179], v[104:107]
    ds_read_b128 v[168:171], v226 offset:53248
    v_mfma_f32_16x16x32_bf16 v[108:111], a[188:191], v[176:179], v[108:111]
    ds_read_b128 v[172:175], v226 offset:55296
    v_mfma_f32_16x16x32_bf16 v[112:115], a[176:179], v[180:183], v[112:115]
    v_mfma_f32_16x16x32_bf16 v[116:119], a[180:183], v[180:183], v[116:119]
    s_add_u32 m0, s31, 5120
    s_add_u32 s24, s27, 163840
    buffer_load_dwordx4 v245, s[12:15], s24 offen lds
    v_mfma_f32_16x16x32_bf16 v[120:123], a[184:187], v[180:183], v[120:123]
    v_mfma_f32_16x16x32_bf16 v[124:127], a[188:191], v[180:183], v[124:127]
    v_mfma_f32_16x16x32_bf16 v[128:131], a[176:179], v[184:187], v[128:131]
    v_mfma_f32_16x16x32_bf16 v[132:135], a[180:183], v[184:187], v[132:135]
    v_mfma_f32_16x16x32_bf16 v[136:139], a[184:187], v[184:187], v[136:139]
    v_mfma_f32_16x16x32_bf16 v[140:143], a[188:191], v[184:187], v[140:143]
    v_mfma_f32_16x16x32_bf16 v[144:147], a[176:179], v[188:191], v[144:147]
    v_mfma_f32_16x16x32_bf16 v[148:151], a[180:183], v[188:191], v[148:151]
    v_mfma_f32_16x16x32_bf16 v[152:155], a[184:187], v[188:191], v[152:155]
    v_mfma_f32_16x16x32_bf16 v[156:159], a[188:191], v[188:191], v[156:159]
    s_waitcnt lgkmcnt(0)
    v_mfma_f32_16x16x32_bf16 v[96:99], a[192:195], v[160:163], v[96:99]
    ds_read_b128 v[176:179], v227 offset:49152
    v_mfma_f32_16x16x32_bf16 v[100:103], a[196:199], v[160:163], v[100:103]
    ds_read_b128 v[180:183], v227 offset:51200
    v_mfma_f32_16x16x32_bf16 v[104:107], a[200:203], v[160:163], v[104:107]
    ds_read_b128 v[184:187], v227 offset:53248
    v_mfma_f32_16x16x32_bf16 v[108:111], a[204:207], v[160:163], v[108:111]
    ds_read_b128 v[188:191], v227 offset:55296
    v_mfma_f32_16x16x32_bf16 v[112:115], a[192:195], v[164:167], v[112:115]
    v_mfma_f32_16x16x32_bf16 v[116:119], a[196:199], v[164:167], v[116:119]
    s_add_u32 m0, s34, 49152
    s_add_u32 s37, s86, 196608
    buffer_load_dwordx4 v232, s[44:47], s37 offen lds
    v_mfma_f32_16x16x32_bf16 v[120:123], a[200:203], v[164:167], v[120:123]
    v_mfma_f32_16x16x32_bf16 v[124:127], a[204:207], v[164:167], v[124:127]
    buffer_load_dwordx4 v233, s[44:47], s37 offen offset:1024 lds
    v_mfma_f32_16x16x32_bf16 v[128:131], a[192:195], v[168:171], v[128:131]
    v_mfma_f32_16x16x32_bf16 v[132:135], a[196:199], v[168:171], v[132:135]
    v_mfma_f32_16x16x32_bf16 v[136:139], a[200:203], v[168:171], v[136:139]
    v_mfma_f32_16x16x32_bf16 v[140:143], a[204:207], v[168:171], v[140:143]
    v_mfma_f32_16x16x32_bf16 v[144:147], a[192:195], v[172:175], v[144:147]
    v_mfma_f32_16x16x32_bf16 v[148:151], a[196:199], v[172:175], v[148:151]
    v_mfma_f32_16x16x32_bf16 v[152:155], a[200:203], v[172:175], v[152:155]
    v_mfma_f32_16x16x32_bf16 v[156:159], a[204:207], v[172:175], v[156:159]
    s_add_u32 s38, s36, 40960
    buffer_store_dwordx4 v[88:91], v240, s[16:19], s38 offen offset:2304 sc1
    s_waitcnt lgkmcnt(0)
    v_mfma_f32_16x16x32_bf16 v[96:99], a[208:211], v[176:179], v[96:99]
    ds_read_b128 v[160:163], v226 offset:57344
    v_mfma_f32_16x16x32_bf16 v[100:103], a[212:215], v[176:179], v[100:103]
    ds_read_b128 v[164:167], v226 offset:59392
    v_mfma_f32_16x16x32_bf16 v[104:107], a[216:219], v[176:179], v[104:107]
    ds_read_b128 v[168:171], v226 offset:61440
    v_mfma_f32_16x16x32_bf16 v[108:111], a[220:223], v[176:179], v[108:111]
    ds_read_b128 v[172:175], v226 offset:63488
    v_mfma_f32_16x16x32_bf16 v[112:115], a[208:211], v[180:183], v[112:115]
    v_mfma_f32_16x16x32_bf16 v[116:119], a[212:215], v[180:183], v[116:119]
    s_add_u32 m0, s31, 6144
    s_add_u32 s24, s27, 196608
    buffer_load_dwordx4 v245, s[12:15], s24 offen lds
    v_mfma_f32_16x16x32_bf16 v[120:123], a[216:219], v[180:183], v[120:123]
    v_mfma_f32_16x16x32_bf16 v[124:127], a[220:223], v[180:183], v[124:127]
    v_mfma_f32_16x16x32_bf16 v[128:131], a[208:211], v[184:187], v[128:131]
    v_mfma_f32_16x16x32_bf16 v[132:135], a[212:215], v[184:187], v[132:135]
    v_mfma_f32_16x16x32_bf16 v[136:139], a[216:219], v[184:187], v[136:139]
    v_mfma_f32_16x16x32_bf16 v[140:143], a[220:223], v[184:187], v[140:143]
    v_mfma_f32_16x16x32_bf16 v[144:147], a[208:211], v[188:191], v[144:147]
    v_mfma_f32_16x16x32_bf16 v[148:151], a[212:215], v[188:191], v[148:151]
    v_mfma_f32_16x16x32_bf16 v[152:155], a[216:219], v[188:191], v[152:155]
    v_mfma_f32_16x16x32_bf16 v[156:159], a[220:223], v[188:191], v[156:159]
    s_waitcnt lgkmcnt(0)
    v_mfma_f32_16x16x32_bf16 v[96:99], a[224:227], v[160:163], v[96:99]
    ds_read_b128 v[176:179], v227 offset:57344
    v_mfma_f32_16x16x32_bf16 v[100:103], a[228:231], v[160:163], v[100:103]
    ds_read_b128 v[180:183], v227 offset:59392
    v_mfma_f32_16x16x32_bf16 v[104:107], a[232:235], v[160:163], v[104:107]
    ds_read_b128 v[184:187], v227 offset:61440
    v_mfma_f32_16x16x32_bf16 v[108:111], a[236:239], v[160:163], v[108:111]
    ds_read_b128 v[188:191], v227 offset:63488
    v_mfma_f32_16x16x32_bf16 v[112:115], a[224:227], v[164:167], v[112:115]
    v_mfma_f32_16x16x32_bf16 v[116:119], a[228:231], v[164:167], v[116:119]
    s_add_u32 m0, s34, 57344
    s_add_u32 s37, s87, 196608
    buffer_load_dwordx4 v232, s[44:47], s37 offen lds
    v_mfma_f32_16x16x32_bf16 v[120:123], a[232:235], v[164:167], v[120:123]
    v_mfma_f32_16x16x32_bf16 v[124:127], a[236:239], v[164:167], v[124:127]
    buffer_load_dwordx4 v233, s[44:47], s37 offen offset:1024 lds
    v_mfma_f32_16x16x32_bf16 v[128:131], a[224:227], v[168:171], v[128:131]
    v_mfma_f32_16x16x32_bf16 v[132:135], a[228:231], v[168:171], v[132:135]
    v_mfma_f32_16x16x32_bf16 v[136:139], a[232:235], v[168:171], v[136:139]
    v_mfma_f32_16x16x32_bf16 v[140:143], a[236:239], v[168:171], v[140:143]
    v_mfma_f32_16x16x32_bf16 v[144:147], a[224:227], v[172:175], v[144:147]
    v_mfma_f32_16x16x32_bf16 v[148:151], a[228:231], v[172:175], v[148:151]
    v_mfma_f32_16x16x32_bf16 v[152:155], a[232:235], v[172:175], v[152:155]
    v_mfma_f32_16x16x32_bf16 v[156:159], a[236:239], v[172:175], v[156:159]
    s_waitcnt vmcnt(16) lgkmcnt(0)
    s_barrier
    v_mfma_f32_16x16x32_bf16 v[96:99], a[240:243], v[176:179], v[96:99]
    ds_read_b128 v[160:163], v224 offset:0
    s_add_u32 s38, s36, 45056
    buffer_store_dwordx4 v[92:95], v240, s[16:19], s38 offen offset:256 sc1
    v_mfma_f32_16x16x32_bf16 v[100:103], a[244:247], v[176:179], v[100:103]
    ds_read_b128 v[164:167], v224 offset:2048
    v_mfma_f32_16x16x32_bf16 v[104:107], a[248:251], v[176:179], v[104:107]
    ds_read_b128 v[168:171], v224 offset:4096
    v_mfma_f32_16x16x32_bf16 v[108:111], a[252:255], v[176:179], v[108:111]
    ds_read_b128 v[172:175], v224 offset:6144
    v_mfma_f32_16x16x32_bf16 v[112:115], a[240:243], v[180:183], v[112:115]
    v_mfma_f32_16x16x32_bf16 v[116:119], a[244:247], v[180:183], v[116:119]
    s_add_u32 m0, s31, 7168
    s_add_u32 s24, s27, 229376
    buffer_load_dwordx4 v245, s[12:15], s24 offen lds
    v_mfma_f32_16x16x32_bf16 v[120:123], a[248:251], v[180:183], v[120:123]
    v_mfma_f32_16x16x32_bf16 v[124:127], a[252:255], v[180:183], v[124:127]
    s_add_u32 s27, s27, 1048576
    s_and_b32 s27, s27, 0x407fffff
    s_cmp_eq_u32 s27, s7
    s_cselect_b32 s27, s43, s27
    v_mfma_f32_16x16x32_bf16 v[128:131], a[240:243], v[184:187], v[128:131]
    v_mfma_f32_16x16x32_bf16 v[132:135], a[244:247], v[184:187], v[132:135]
    s_add_u32 s31, s31, 32768
    s_cmp_ge_u32 s31, 163840
    s_cselect_b32 s24, 98304, 0
    s_sub_u32 s31, s31, s24
    v_cvt_pk_bf16_f32 v64, v96, v97
    v_cvt_pk_bf16_f32 v65, v98, v99
    v_mfma_f32_16x16x32_bf16 v[136:139], a[248:251], v[184:187], v[136:139]
    v_cvt_pk_bf16_f32 v66, v100, v101
    v_cvt_pk_bf16_f32 v67, v102, v103
    v_mfma_f32_16x16x32_bf16 v[140:143], a[252:255], v[184:187], v[140:143]
    v_cvt_pk_bf16_f32 v68, v104, v105
    v_cvt_pk_bf16_f32 v69, v106, v107
    v_mfma_f32_16x16x32_bf16 v[144:147], a[240:243], v[188:191], v[144:147]
    v_cvt_pk_bf16_f32 v70, v108, v109
    v_cvt_pk_bf16_f32 v71, v110, v111
    v_mfma_f32_16x16x32_bf16 v[148:151], a[244:247], v[188:191], v[148:151]
    v_cvt_pk_bf16_f32 v72, v112, v113
    v_cvt_pk_bf16_f32 v73, v114, v115
    v_mfma_f32_16x16x32_bf16 v[152:155], a[248:251], v[188:191], v[152:155]
    v_cvt_pk_bf16_f32 v74, v116, v117
    v_cvt_pk_bf16_f32 v75, v118, v119
    v_mfma_f32_16x16x32_bf16 v[156:159], a[252:255], v[188:191], v[156:159]
    v_cvt_pk_bf16_f32 v76, v120, v121
    v_cvt_pk_bf16_f32 v77, v122, v123
    s_waitcnt lgkmcnt(0)
    v_mfma_f32_16x16x32_bf16 v[96:99], a[0:3], v[160:163], 0
    ds_read_b128 v[176:179], v225 offset:0
    v_cvt_pk_bf16_f32 v78, v124, v125
    v_cvt_pk_bf16_f32 v79, v126, v127
    v_mfma_f32_16x16x32_bf16 v[100:103], a[4:7], v[160:163], 0
    ds_read_b128 v[180:183], v225 offset:2048
    v_cvt_pk_bf16_f32 v80, v128, v129
    v_cvt_pk_bf16_f32 v81, v130, v131
    v_mfma_f32_16x16x32_bf16 v[104:107], a[8:11], v[160:163], 0
    ds_read_b128 v[184:187], v225 offset:4096
    v_cvt_pk_bf16_f32 v82, v132, v133
    v_cvt_pk_bf16_f32 v83, v134, v135
    v_mfma_f32_16x16x32_bf16 v[108:111], a[12:15], v[160:163], 0
    ds_read_b128 v[188:191], v225 offset:6144
    v_cvt_pk_bf16_f32 v84, v136, v137
    v_cvt_pk_bf16_f32 v85, v138, v139
    v_mfma_f32_16x16x32_bf16 v[112:115], a[0:3], v[164:167], 0
    v_cvt_pk_bf16_f32 v86, v140, v141
    v_cvt_pk_bf16_f32 v87, v142, v143
    v_mfma_f32_16x16x32_bf16 v[116:119], a[4:7], v[164:167], 0
    s_add_u32 m0, s31, 0
    s_add_u32 s24, s27, 0
    buffer_load_dwordx4 v245, s[12:15], s24 offen lds
    v_cvt_pk_bf16_f32 v88, v144, v145
    v_cvt_pk_bf16_f32 v89, v146, v147
    v_mfma_f32_16x16x32_bf16 v[120:123], a[8:11], v[164:167], 0
    v_cvt_pk_bf16_f32 v90, v148, v149
    v_cvt_pk_bf16_f32 v91, v150, v151
    v_mfma_f32_16x16x32_bf16 v[124:127], a[12:15], v[164:167], 0
    v_cvt_pk_bf16_f32 v92, v152, v153
    v_cvt_pk_bf16_f32 v93, v154, v155
    v_mfma_f32_16x16x32_bf16 v[128:131], a[0:3], v[168:171], 0
    v_cvt_pk_bf16_f32 v94, v156, v157
    v_cvt_pk_bf16_f32 v95, v158, v159
    v_mfma_f32_16x16x32_bf16 v[132:135], a[4:7], v[168:171], 0
    v_mfma_f32_16x16x32_bf16 v[136:139], a[8:11], v[168:171], 0
    s_add_u32 s38, s36, 65536
    buffer_store_dwordx4 v[64:67], v240, s[16:19], s38 offen offset:2560 sc1
    v_mfma_f32_16x16x32_bf16 v[140:143], a[12:15], v[168:171], 0
    v_mfma_f32_16x16x32_bf16 v[144:147], a[0:3], v[172:175], 0
    v_mfma_f32_16x16x32_bf16 v[148:151], a[4:7], v[172:175], 0
    v_mfma_f32_16x16x32_bf16 v[152:155], a[8:11], v[172:175], 0
    v_mfma_f32_16x16x32_bf16 v[156:159], a[12:15], v[172:175], 0
    s_waitcnt lgkmcnt(0)
    v_mfma_f32_16x16x32_bf16 v[96:99], a[16:19], v[176:179], v[96:99]
    ds_read_b128 v[160:163], v224 offset:8192
    v_mfma_f32_16x16x32_bf16 v[100:103], a[20:23], v[176:179], v[100:103]
    ds_read_b128 v[164:167], v224 offset:10240
    v_mfma_f32_16x16x32_bf16 v[104:107], a[24:27], v[176:179], v[104:107]
    ds_read_b128 v[168:171], v224 offset:12288
    v_mfma_f32_16x16x32_bf16 v[108:111], a[28:31], v[176:179], v[108:111]
    ds_read_b128 v[172:175], v224 offset:14336
    v_mfma_f32_16x16x32_bf16 v[112:115], a[16:19], v[180:183], v[112:115]
    v_mfma_f32_16x16x32_bf16 v[116:119], a[20:23], v[180:183], v[116:119]
    s_add_u32 m0, s31, 1024
    s_add_u32 s24, s27, 32768
    buffer_load_dwordx4 v245, s[12:15], s24 offen lds
    v_mfma_f32_16x16x32_bf16 v[120:123], a[24:27], v[180:183], v[120:123]
    v_mfma_f32_16x16x32_bf16 v[124:127], a[28:31], v[180:183], v[124:127]
    v_mfma_f32_16x16x32_bf16 v[128:131], a[16:19], v[184:187], v[128:131]
    v_mfma_f32_16x16x32_bf16 v[132:135], a[20:23], v[184:187], v[132:135]
    v_mfma_f32_16x16x32_bf16 v[136:139], a[24:27], v[184:187], v[136:139]
    v_mfma_f32_16x16x32_bf16 v[140:143], a[28:31], v[184:187], v[140:143]
    v_mfma_f32_16x16x32_bf16 v[144:147], a[16:19], v[188:191], v[144:147]
    v_mfma_f32_16x16x32_bf16 v[148:151], a[20:23], v[188:191], v[148:151]
    v_mfma_f32_16x16x32_bf16 v[152:155], a[24:27], v[188:191], v[152:155]
    v_mfma_f32_16x16x32_bf16 v[156:159], a[28:31], v[188:191], v[156:159]
    s_waitcnt lgkmcnt(0)
    v_mfma_f32_16x16x32_bf16 v[96:99], a[32:35], v[160:163], v[96:99]
    ds_read_b128 v[176:179], v225 offset:8192
    v_mfma_f32_16x16x32_bf16 v[100:103], a[36:39], v[160:163], v[100:103]
    ds_read_b128 v[180:183], v225 offset:10240
    v_mfma_f32_16x16x32_bf16 v[104:107], a[40:43], v[160:163], v[104:107]
    ds_read_b128 v[184:187], v225 offset:12288
    v_mfma_f32_16x16x32_bf16 v[108:111], a[44:47], v[160:163], v[108:111]
    ds_read_b128 v[188:191], v225 offset:14336
    v_mfma_f32_16x16x32_bf16 v[112:115], a[32:35], v[164:167], v[112:115]
    v_mfma_f32_16x16x32_bf16 v[116:119], a[36:39], v[164:167], v[116:119]
    s_add_u32 m0, s31, 2048
    s_add_u32 s24, s27, 65536
    buffer_load_dwordx4 v245, s[12:15], s24 offen lds
    v_mfma_f32_16x16x32_bf16 v[120:123], a[40:43], v[164:167], v[120:123]
    v_mfma_f32_16x16x32_bf16 v[124:127], a[44:47], v[164:167], v[124:127]
    v_mfma_f32_16x16x32_bf16 v[128:131], a[32:35], v[168:171], v[128:131]
    v_mfma_f32_16x16x32_bf16 v[132:135], a[36:39], v[168:171], v[132:135]
    v_mfma_f32_16x16x32_bf16 v[136:139], a[40:43], v[168:171], v[136:139]
    s_add_u32 s38, s36, 69632
    buffer_store_dwordx4 v[68:71], v240, s[16:19], s38 offen offset:512 sc1
    v_mfma_f32_16x16x32_bf16 v[140:143], a[44:47], v[168:171], v[140:143]
    v_mfma_f32_16x16x32_bf16 v[144:147], a[32:35], v[172:175], v[144:147]
    v_mfma_f32_16x16x32_bf16 v[148:151], a[36:39], v[172:175], v[148:151]
    v_mfma_f32_16x16x32_bf16 v[152:155], a[40:43], v[172:175], v[152:155]
    v_mfma_f32_16x16x32_bf16 v[156:159], a[44:47], v[172:175], v[156:159]
    s_waitcnt lgkmcnt(0)
    v_mfma_f32_16x16x32_bf16 v[96:99], a[48:51], v[176:179], v[96:99]
    ds_read_b128 v[160:163], v224 offset:16384
    v_mfma_f32_16x16x32_bf16 v[100:103], a[52:55], v[176:179], v[100:103]
    ds_read_b128 v[164:167], v224 offset:18432
    v_mfma_f32_16x16x32_bf16 v[104:107], a[56:59], v[176:179], v[104:107]
    ds_read_b128 v[168:171], v224 offset:20480
    v_mfma_f32_16x16x32_bf16 v[108:111], a[60:63], v[176:179], v[108:111]
    ds_read_b128 v[172:175], v224 offset:22528
    v_mfma_f32_16x16x32_bf16 v[112:115], a[48:51], v[180:183], v[112:115]
    v_mfma_f32_16x16x32_bf16 v[116:119], a[52:55], v[180:183], v[116:119]
    s_add_u32 m0, s31, 3072
    s_add_u32 s24, s27, 98304
    buffer_load_dwordx4 v245, s[12:15], s24 offen lds
    v_mfma_f32_16x16x32_bf16 v[120:123], a[56:59], v[180:183], v[120:123]
    v_mfma_f32_16x16x32_bf16 v[124:127], a[60:63], v[180:183], v[124:127]
    v_mfma_f32_16x16x32_bf16 v[128:131], a[48:51], v[184:187], v[128:131]
    v_mfma_f32_16x16x32_bf16 v[132:135], a[52:55], v[184:187], v[132:135]
    v_mfma_f32_16x16x32_bf16 v[136:139], a[56:59], v[184:187], v[136:139]
    v_mfma_f32_16x16x32_bf16 v[140:143], a[60:63], v[184:187], v[140:143]
    v_mfma_f32_16x16x32_bf16 v[144:147], a[48:51], v[188:191], v[144:147]
    v_mfma_f32_16x16x32_bf16 v[148:151], a[52:55], v[188:191], v[148:151]
    v_mfma_f32_16x16x32_bf16 v[152:155], a[56:59], v[188:191], v[152:155]
    v_mfma_f32_16x16x32_bf16 v[156:159], a[60:63], v[188:191], v[156:159]
    s_waitcnt lgkmcnt(0)
    v_mfma_f32_16x16x32_bf16 v[96:99], a[64:67], v[160:163], v[96:99]
    ds_read_b128 v[176:179], v225 offset:16384
    v_mfma_f32_16x16x32_bf16 v[100:103], a[68:71], v[160:163], v[100:103]
    ds_read_b128 v[180:183], v225 offset:18432
    v_mfma_f32_16x16x32_bf16 v[104:107], a[72:75], v[160:163], v[104:107]
    ds_read_b128 v[184:187], v225 offset:20480
    v_mfma_f32_16x16x32_bf16 v[108:111], a[76:79], v[160:163], v[108:111]
    ds_read_b128 v[188:191], v225 offset:22528
    v_mfma_f32_16x16x32_bf16 v[112:115], a[64:67], v[164:167], v[112:115]
    v_mfma_f32_16x16x32_bf16 v[116:119], a[68:71], v[164:167], v[116:119]
    s_add_u32 m0, s31, 4096
    s_add_u32 s24, s27, 131072
    buffer_load_dwordx4 v245, s[12:15], s24 offen lds
    v_mfma_f32_16x16x32_bf16 v[120:123], a[72:75], v[164:167], v[120:123]
    v_mfma_f32_16x16x32_bf16 v[124:127], a[76:79], v[164:167], v[124:127]
    v_mfma_f32_16x16x32_bf16 v[128:131], a[64:67], v[168:171], v[128:131]
    v_mfma_f32_16x16x32_bf16 v[132:135], a[68:71], v[168:171], v[132:135]
    v_mfma_f32_16x16x32_bf16 v[136:139], a[72:75], v[168:171], v[136:139]
    v_mfma_f32_16x16x32_bf16 v[140:143], a[76:79], v[168:171], v[140:143]
    s_add_u32 s38, s36, 65536
    buffer_store_dwordx4 v[72:75], v240, s[16:19], s38 offen offset:3584 sc1
    v_mfma_f32_16x16x32_bf16 v[144:147], a[64:67], v[172:175], v[144:147]
    v_mfma_f32_16x16x32_bf16 v[148:151], a[68:71], v[172:175], v[148:151]
    v_mfma_f32_16x16x32_bf16 v[152:155], a[72:75], v[172:175], v[152:155]
    v_mfma_f32_16x16x32_bf16 v[156:159], a[76:79], v[172:175], v[156:159]
    s_waitcnt lgkmcnt(0)
    v_mfma_f32_16x16x32_bf16 v[96:99], a[80:83], v[176:179], v[96:99]
    ds_read_b128 v[160:163], v224 offset:24576
    v_mfma_f32_16x16x32_bf16 v[100:103], a[84:87], v[176:179], v[100:103]
    ds_read_b128 v[164:167], v224 offset:26624
    v_mfma_f32_16x16x32_bf16 v[104:107], a[88:91], v[176:179], v[104:107]
    ds_read_b128 v[168:171], v224 offset:28672
    v_mfma_f32_16x16x32_bf16 v[108:111], a[92:95], v[176:179], v[108:111]
    ds_read_b128 v[172:175], v224 offset:30720
    v_mfma_f32_16x16x32_bf16 v[112:115], a[80:83], v[180:183], v[112:115]
    v_mfma_f32_16x16x32_bf16 v[116:119], a[84:87], v[180:183], v[116:119]
    s_add_u32 m0, s31, 5120
    s_add_u32 s24, s27, 163840
    buffer_load_dwordx4 v245, s[12:15], s24 offen lds
    v_mfma_f32_16x16x32_bf16 v[120:123], a[88:91], v[180:183], v[120:123]
    v_mfma_f32_16x16x32_bf16 v[124:127], a[92:95], v[180:183], v[124:127]
    v_mfma_f32_16x16x32_bf16 v[128:131], a[80:83], v[184:187], v[128:131]
    v_mfma_f32_16x16x32_bf16 v[132:135], a[84:87], v[184:187], v[132:135]
    v_mfma_f32_16x16x32_bf16 v[136:139], a[88:91], v[184:187], v[136:139]
    v_mfma_f32_16x16x32_bf16 v[140:143], a[92:95], v[184:187], v[140:143]
    v_mfma_f32_16x16x32_bf16 v[144:147], a[80:83], v[188:191], v[144:147]
    v_mfma_f32_16x16x32_bf16 v[148:151], a[84:87], v[188:191], v[148:151]
    v_mfma_f32_16x16x32_bf16 v[152:155], a[88:91], v[188:191], v[152:155]
    v_mfma_f32_16x16x32_bf16 v[156:159], a[92:95], v[188:191], v[156:159]
    s_waitcnt lgkmcnt(0)
    v_mfma_f32_16x16x32_bf16 v[96:99], a[96:99], v[160:163], v[96:99]
    ds_read_b128 v[176:179], v225 offset:24576
    v_mfma_f32_16x16x32_bf16 v[100:103], a[100:103], v[160:163], v[100:103]
    ds_read_b128 v[180:183], v225 offset:26624
    v_mfma_f32_16x16x32_bf16 v[104:107], a[104:107], v[160:163], v[104:107]
    ds_read_b128 v[184:187], v225 offset:28672
    v_mfma_f32_16x16x32_bf16 v[108:111], a[108:111], v[160:163], v[108:111]
    ds_read_b128 v[188:191], v225 offset:30720
    v_mfma_f32_16x16x32_bf16 v[112:115], a[96:99], v[164:167], v[112:115]
    v_mfma_f32_16x16x32_bf16 v[116:119], a[100:103], v[164:167], v[116:119]
    buffer_load_dword v254, off, s[88:91], s39 sc1
    v_mfma_f32_16x16x32_bf16 v[120:123], a[104:107], v[164:167], v[120:123]
    v_mfma_f32_16x16x32_bf16 v[124:127], a[108:111], v[164:167], v[124:127]
    s_add_u32 m0, s31, 6144
    s_add_u32 s24, s27, 196608
    buffer_load_dwordx4 v245, s[12:15], s24 offen lds
    v_mfma_f32_16x16x32_bf16 v[128:131], a[96:99], v[168:171], v[128:131]
    v_mfma_f32_16x16x32_bf16 v[132:135], a[100:103], v[168:171], v[132:135]
    v_mfma_f32_16x16x32_bf16 v[136:139], a[104:107], v[168:171], v[136:139]
    v_mfma_f32_16x16x32_bf16 v[140:143], a[108:111], v[168:171], v[140:143]
    v_mfma_f32_16x16x32_bf16 v[144:147], a[96:99], v[172:175], v[144:147]
    s_add_u32 s38, s36, 69632
    buffer_store_dwordx4 v[76:79], v240, s[16:19], s38 offen offset:1536 sc1
    v_mfma_f32_16x16x32_bf16 v[148:151], a[100:103], v[172:175], v[148:151]
    v_mfma_f32_16x16x32_bf16 v[152:155], a[104:107], v[172:175], v[152:155]
    v_mfma_f32_16x16x32_bf16 v[156:159], a[108:111], v[172:175], v[156:159]
    s_waitcnt vmcnt(14) lgkmcnt(0)
    s_barrier
    v_mfma_f32_16x16x32_bf16 v[96:99], a[112:115], v[176:179], v[96:99]
    ds_read_b128 v[160:163], v224 offset:32768
    v_mfma_f32_16x16x32_bf16 v[100:103], a[116:119], v[176:179], v[100:103]
    ds_read_b128 v[164:167], v224 offset:34816
    v_mfma_f32_16x16x32_bf16 v[104:107], a[120:123], v[176:179], v[104:107]
    ds_read_b128 v[168:171], v224 offset:36864
    v_mfma_f32_16x16x32_bf16 v[108:111], a[124:127], v[176:179], v[108:111]
    ds_read_b128 v[172:175], v224 offset:38912
    v_mfma_f32_16x16x32_bf16 v[112:115], a[112:115], v[180:183], v[112:115]
    v_mfma_f32_16x16x32_bf16 v[116:119], a[116:119], v[180:183], v[116:119]
    s_add_u32 m0, s31, 7168
    s_add_u32 s24, s27, 229376
    buffer_load_dwordx4 v245, s[12:15], s24 offen lds
    v_mfma_f32_16x16x32_bf16 v[120:123], a[120:123], v[180:183], v[120:123]
    v_mfma_f32_16x16x32_bf16 v[124:127], a[124:127], v[180:183], v[124:127]
    s_add_u32 s27, s27, 1048576
    s_and_b32 s27, s27, 0x407fffff
    s_cmp_eq_u32 s27, s7
    s_cselect_b32 s27, s43, s27
    v_mfma_f32_16x16x32_bf16 v[128:131], a[112:115], v[184:187], v[128:131]
    v_mfma_f32_16x16x32_bf16 v[132:135], a[116:119], v[184:187], v[132:135]
    s_add_u32 s31, s31, 32768
    s_cmp_ge_u32 s31, 163840
    s_cselect_b32 s24, 98304, 0
    s_sub_u32 s31, s31, s24
    v_mfma_f32_16x16x32_bf16 v[136:139], a[120:123], v[184:187], v[136:139]
    v_mfma_f32_16x16x32_bf16 v[140:143], a[124:127], v[184:187], v[140:143]
    v_mfma_f32_16x16x32_bf16 v[144:147], a[112:115], v[188:191], v[144:147]
    v_mfma_f32_16x16x32_bf16 v[148:151], a[116:119], v[188:191], v[148:151]
    v_mfma_f32_16x16x32_bf16 v[152:155], a[120:123], v[188:191], v[152:155]
    v_mfma_f32_16x16x32_bf16 v[156:159], a[124:127], v[188:191], v[156:159]
    s_waitcnt lgkmcnt(0)
    v_mfma_f32_16x16x32_bf16 v[96:99], a[128:131], v[160:163], v[96:99]
    ds_read_b128 v[176:179], v225 offset:32768
    v_mfma_f32_16x16x32_bf16 v[100:103], a[132:135], v[160:163], v[100:103]
    ds_read_b128 v[180:183], v225 offset:34816
    v_mfma_f32_16x16x32_bf16 v[104:107], a[136:139], v[160:163], v[104:107]
    ds_read_b128 v[184:187], v225 offset:36864
    v_mfma_f32_16x16x32_bf16 v[108:111], a[140:143], v[160:163], v[108:111]
    ds_read_b128 v[188:191], v225 offset:38912
    v_mfma_f32_16x16x32_bf16 v[112:115], a[128:131], v[164:167], v[112:115]
    v_mfma_f32_16x16x32_bf16 v[116:119], a[132:135], v[164:167], v[116:119]
    v_mfma_f32_16x16x32_bf16 v[120:123], a[136:139], v[164:167], v[120:123]
    v_mfma_f32_16x16x32_bf16 v[124:127], a[140:143], v[164:167], v[124:127]
    v_mfma_f32_16x16x32_bf16 v[128:131], a[128:131], v[168:171], v[128:131]
    v_mfma_f32_16x16x32_bf16 v[132:135], a[132:135], v[168:171], v[132:135]
    v_mfma_f32_16x16x32_bf16 v[136:139], a[136:139], v[168:171], v[136:139]
    v_mfma_f32_16x16x32_bf16 v[140:143], a[140:143], v[168:171], v[140:143]
    v_mfma_f32_16x16x32_bf16 v[144:147], a[128:131], v[172:175], v[144:147]
    v_mfma_f32_16x16x32_bf16 v[148:151], a[132:135], v[172:175], v[148:151]
    s_add_u32 s38, s36, 73728
    buffer_store_dwordx4 v[80:83], v240, s[16:19], s38 offen offset:2560 sc1
    v_mfma_f32_16x16x32_bf16 v[152:155], a[136:139], v[172:175], v[152:155]
    v_mfma_f32_16x16x32_bf16 v[156:159], a[140:143], v[172:175], v[156:159]
    s_waitcnt lgkmcnt(0)
    v_mfma_f32_16x16x32_bf16 v[96:99], a[144:147], v[176:179], v[96:99]
    ds_read_b128 v[160:163], v224 offset:40960
    v_mfma_f32_16x16x32_bf16 v[100:103], a[148:151], v[176:179], v[100:103]
    ds_read_b128 v[164:167], v224 offset:43008
    v_mfma_f32_16x16x32_bf16 v[104:107], a[152:155], v[176:179], v[104:107]
    ds_read_b128 v[168:171], v224 offset:45056
    v_mfma_f32_16x16x32_bf16 v[108:111], a[156:159], v[176:179], v[108:111]
    ds_read_b128 v[172:175], v224 offset:47104
    v_mfma_f32_16x16x32_bf16 v[112:115], a[144:147], v[180:183], v[112:115]
    v_mfma_f32_16x16x32_bf16 v[116:119], a[148:151], v[180:183], v[116:119]
    v_mfma_f32_16x16x32_bf16 v[120:123], a[152:155], v[180:183], v[120:123]
    v_mfma_f32_16x16x32_bf16 v[124:127], a[156:159], v[180:183], v[124:127]
    v_mfma_f32_16x16x32_bf16 v[128:131], a[144:147], v[184:187], v[128:131]
    v_mfma_f32_16x16x32_bf16 v[132:135], a[148:151], v[184:187], v[132:135]
    v_mfma_f32_16x16x32_bf16 v[136:139], a[152:155], v[184:187], v[136:139]
    v_mfma_f32_16x16x32_bf16 v[140:143], a[156:159], v[184:187], v[140:143]
    v_mfma_f32_16x16x32_bf16 v[144:147], a[144:147], v[188:191], v[144:147]
    v_mfma_f32_16x16x32_bf16 v[148:151], a[148:151], v[188:191], v[148:151]
    v_mfma_f32_16x16x32_bf16 v[152:155], a[152:155], v[188:191], v[152:155]
    v_mfma_f32_16x16x32_bf16 v[156:159], a[156:159], v[188:191], v[156:159]
    s_waitcnt lgkmcnt(0)
    v_mfma_f32_16x16x32_bf16 v[96:99], a[160:163], v[160:163], v[96:99]
    ds_read_b128 v[176:179], v225 offset:40960
    v_mfma_f32_16x16x32_bf16 v[100:103], a[164:167], v[160:163], v[100:103]
    ds_read_b128 v[180:183], v225 offset:43008
    v_mfma_f32_16x16x32_bf16 v[104:107], a[168:171], v[160:163], v[104:107]
    ds_read_b128 v[184:187], v225 offset:45056
    v_mfma_f32_16x16x32_bf16 v[108:111], a[172:175], v[160:163], v[108:111]
    ds_read_b128 v[188:191], v225 offset:47104
    v_mfma_f32_16x16x32_bf16 v[112:115], a[160:163], v[164:167], v[112:115]
    v_mfma_f32_16x16x32_bf16 v[116:119], a[164:167], v[164:167], v[116:119]
    v_mfma_f32_16x16x32_bf16 v[120:123], a[168:171], v[164:167], v[120:123]
    v_mfma_f32_16x16x32_bf16 v[124:127], a[172:175], v[164:167], v[124:127]
    v_mfma_f32_16x16x32_bf16 v[128:131], a[160:163], v[168:171], v[128:131]
    v_mfma_f32_16x16x32_bf16 v[132:135], a[164:167], v[168:171], v[132:135]
    v_mfma_f32_16x16x32_bf16 v[136:139], a[168:171], v[168:171], v[136:139]
    v_mfma_f32_16x16x32_bf16 v[140:143], a[172:175], v[168:171], v[140:143]
    v_mfma_f32_16x16x32_bf16 v[144:147], a[160:163], v[172:175], v[144:147]
    v_mfma_f32_16x16x32_bf16 v[148:151], a[164:167], v[172:175], v[148:151]
    v_mfma_f32_16x16x32_bf16 v[152:155], a[168:171], v[172:175], v[152:155]
    s_add_u32 s38, s36, 77824
    buffer_store_dwordx4 v[84:87], v240, s[16:19], s38 offen offset:512 sc1
    v_mfma_f32_16x16x32_bf16 v[156:159], a[172:175], v[172:175], v[156:159]
    s_waitcnt vmcnt(5)
    v_readfirstlane_b32 s24, v254
    s_lshl_b32 s25, s3, 16
    s_add_u32 s24, s24, s25
    s_cmp_ge_u32 s24, 32
    s_cbranch_scc0 kf_spin41
kf_spinr42:
    s_waitcnt lgkmcnt(0)
    s_barrier
    v_mfma_f32_16x16x32_bf16 v[96:99], a[176:179], v[176:179], v[96:99]
    ds_read_b128 v[160:163], v224 offset:49152
    v_mfma_f32_16x16x32_bf16 v[100:103], a[180:183], v[176:179], v[100:103]
    ds_read_b128 v[164:167], v224 offset:51200
    v_mfma_f32_16x16x32_bf16 v[104:107], a[184:187], v[176:179], v[104:107]
    ds_read_b128 v[168:171], v224 offset:53248
    v_mfma_f32_16x16x32_bf16 v[108:111], a[188:191], v[176:179], v[108:111]
    ds_read_b128 v[172:175], v224 offset:55296
    v_mfma_f32_16x16x32_bf16 v[112:115], a[176:179], v[180:183], v[112:115]
    v_mfma_f32_16x16x32_bf16 v[116:119], a[180:183], v[180:183], v[116:119]
    buffer_load_dwordx4 v[0:3], v248, s[8:11], s28 offen offset:0 sc1
    v_mfma_f32_16x16x32_bf16 v[120:123], a[184:187], v[180:183], v[120:123]
    v_mfma_f32_16x16x32_bf16 v[124:127], a[188:191], v[180:183], v[124:127]
    buffer_load_dwordx4 v[4:7], v249, s[8:11], s28 offen offset:0 sc1
    v_mfma_f32_16x16x32_bf16 v[128:131], a[176:179], v[184:187], v[128:131]
    v_mfma_f32_16x16x32_bf16 v[132:135], a[180:183], v[184:187], v[132:135]
    buffer_load_dwordx4 v[8:11], v248, s[8:11], s28 offen offset:1024 sc1
    v_mfma_f32_16x16x32_bf16 v[136:139], a[184:187], v[184:187], v[136:139]
    v_mfma_f32_16x16x32_bf16 v[140:143], a[188:191], v[184:187], v[140:143]
    buffer_load_dwordx4 v[12:15], v249, s[8:11], s28 offen offset:1024 sc1
    v_mfma_f32_16x16x32_bf16 v[144:147], a[176:179], v[188:191], v[144:147]
    v_mfma_f32_16x16x32_bf16 v[148:151], a[180:183], v[188:191], v[148:151]
    v_mfma_f32_16x16x32_bf16 v[152:155], a[184:187], v[188:191], v[152:155]
    v_mfma_f32_16x16x32_bf16 v[156:159], a[188:191], v[188:191], v[156:159]
    s_waitcnt lgkmcnt(0)
    v_mfma_f32_16x16x32_bf16 v[96:99], a[192:195], v[160:163], v[96:99]
    ds_read_b128 v[176:179], v225 offset:49152
    v_mfma_f32_16x16x32_bf16 v[100:103], a[196:199], v[160:163], v[100:103]
    ds_read_b128 v[180:183], v225 offset:51200
    v_mfma_f32_16x16x32_bf16 v[104:107], a[200:203], v[160:163], v[104:107]
    ds_read_b128 v[184:187], v225 offset:53248
    v_mfma_f32_16x16x32_bf16 v[108:111], a[204:207], v[160:163], v[108:111]
    ds_read_b128 v[188:191], v225 offset:55296
    v_mfma_f32_16x16x32_bf16 v[112:115], a[192:195], v[164:167], v[112:115]
    v_mfma_f32_16x16x32_bf16 v[116:119], a[196:199], v[164:167], v[116:119]
    buffer_load_dwordx4 v[16:19], v248, s[8:11], s28 offen offset:2048 sc1
    v_mfma_f32_16x16x32_bf16 v[120:123], a[200:203], v[164:167], v[120:123]
    v_mfma_f32_16x16x32_bf16 v[124:127], a[204:207], v[164:167], v[124:127]
    buffer_load_dwordx4 v[20:23], v249, s[8:11], s28 offen offset:2048 sc1
    v_mfma_f32_16x16x32_bf16 v[128:131], a[192:195], v[168:171], v[128:131]
    v_mfma_f32_16x16x32_bf16 v[132:135], a[196:199], v[168:171], v[132:135]
    buffer_load_dwordx4 v[24:27], v248, s[8:11], s28 offen offset:3072 sc1
    v_mfma_f32_16x16x32_bf16 v[136:139], a[200:203], v[168:171], v[136:139]
    v_mfma_f32_16x16x32_bf16 v[140:143], a[204:207], v[168:171], v[140:143]
    buffer_load_dwordx4 v[28:31], v249, s[8:11], s28 offen offset:3072 sc1
    v_mfma_f32_16x16x32_bf16 v[144:147], a[192:195], v[172:175], v[144:147]
    v_mfma_f32_16x16x32_bf16 v[148:151], a[196:199], v[172:175], v[148:151]
    v_mfma_f32_16x16x32_bf16 v[152:155], a[200:203], v[172:175], v[152:155]
    v_mfma_f32_16x16x32_bf16 v[156:159], a[204:207], v[172:175], v[156:159]
    s_add_u32 s38, s36, 73728
    buffer_store_dwordx4 v[88:91], v240, s[16:19], s38 offen offset:3584 sc1
    s_waitcnt lgkmcnt(0)
    v_mfma_f32_16x16x32_bf16 v[96:99], a[208:211], v[176:179], v[96:99]
    ds_read_b128 v[160:163], v224 offset:57344
    v_mfma_f32_16x16x32_bf16 v[100:103], a[212:215], v[176:179], v[100:103]
    ds_read_b128 v[164:167], v224 offset:59392
    v_mfma_f32_16x16x32_bf16 v[104:107], a[216:219], v[176:179], v[104:107]
    ds_read_b128 v[168:171], v224 offset:61440
    v_mfma_f32_16x16x32_bf16 v[108:111], a[220:223], v[176:179], v[108:111]
    ds_read_b128 v[172:175], v224 offset:63488
    v_mfma_f32_16x16x32_bf16 v[112:115], a[208:211], v[180:183], v[112:115]
    v_mfma_f32_16x16x32_bf16 v[116:119], a[212:215], v[180:183], v[116:119]
    buffer_load_dwordx4 v[32:35], v248, s[8:11], s29 offen offset:0 sc1
    v_mfma_f32_16x16x32_bf16 v[120:123], a[216:219], v[180:183], v[120:123]
    v_mfma_f32_16x16x32_bf16 v[124:127], a[220:223], v[180:183], v[124:127]
    buffer_load_dwordx4 v[36:39], v249, s[8:11], s29 offen offset:0 sc1
    v_mfma_f32_16x16x32_bf16 v[128:131], a[208:211], v[184:187], v[128:131]
    v_mfma_f32_16x16x32_bf16 v[132:135], a[212:215], v[184:187], v[132:135]
    buffer_load_dwordx4 v[40:43], v248, s[8:11], s29 offen offset:1024 sc1
    v_mfma_f32_16x16x32_bf16 v[136:139], a[216:219], v[184:187], v[136:139]
    v_mfma_f32_16x16x32_bf16 v[140:143], a[220:223], v[184:187], v[140:143]
    buffer_load_dwordx4 v[44:47], v249, s[8:11], s29 offen offset:1024 sc1
    v_mfma_f32_16x16x32_bf16 v[144:147], a[208:211], v[188:191], v[144:147]
    v_mfma_f32_16x16x32_bf16 v[148:151], a[212:215], v[188:191], v[148:151]
    v_mfma_f32_16x16x32_bf16 v[152:155], a[216:219], v[188:191], v[152:155]
    v_mfma_f32_16x16x32_bf16 v[156:159], a[220:223], v[188:191], v[156:159]
    s_waitcnt lgkmcnt(0)
    v_mfma_f32_16x16x32_bf16 v[96:99], a[224:227], v[160:163], v[96:99]
    ds_read_b128 v[176:179], v225 offset:57344
    v_mfma_f32_16x16x32_bf16 v[100:103], a[228:231], v[160:163], v[100:103]
    ds_read_b128 v[180:183], v225 offset:59392
    v_mfma_f32_16x16x32_bf16 v[104:107], a[232:235], v[160:163], v[104:107]
    ds_read_b128 v[184:187], v225 offset:61440
    v_mfma_f32_16x16x32_bf16 v[108:111], a[236:239], v[160:163], v[108:111]
    ds_read_b128 v[188:191], v225 offset:63488
    v_mfma_f32_16x16x32_bf16 v[112:115], a[224:227], v[164:167], v[112:115]
    v_mfma_f32_16x16x32_bf16 v[116:119], a[228:231], v[164:167], v[116:119]
    buffer_load_dwordx4 v[48:51], v248, s[8:11], s29 offen offset:2048 sc1
    v_mfma_f32_16x16x32_bf16 v[120:123], a[232:235], v[164:167], v[120:123]
    v_mfma_f32_16x16x32_bf16 v[124:127], a[236:239], v[164:167], v[124:127]
    buffer_load_dwordx4 v[52:55], v249, s[8:11], s29 offen offset:2048 sc1
    v_mfma_f32_16x16x32_bf16 v[128:131], a[224:227], v[168:171], v[128:131]
    v_mfma_f32_16x16x32_bf16 v[132:135], a[228:231], v[168:171], v[132:135]
    buffer_load_dwordx4 v[56:59], v248, s[8:11], s29 offen offset:3072 sc1
    v_mfma_f32_16x16x32_bf16 v[136:139], a[232:235], v[168:171], v[136:139]
    v_mfma_f32_16x16x32_bf16 v[140:143], a[236:239], v[168:171], v[140:143]
    buffer_load_dwordx4 v[60:63], v249, s[8:11], s29 offen offset:3072 sc1
    v_mfma_f32_16x16x32_bf16 v[144:147], a[224:227], v[172:175], v[144:147]
    v_mfma_f32_16x16x32_bf16 v[148:151], a[228:231], v[172:175], v[148:151]
    v_mfma_f32_16x16x32_bf16 v[152:155], a[232:235], v[172:175], v[152:155]
    v_mfma_f32_16x16x32_bf16 v[156:159], a[236:239], v[172:175], v[156:159]
    s_waitcnt vmcnt(32) lgkmcnt(0)
    s_barrier
    v_mfma_f32_16x16x32_bf16 v[96:99], a[240:243], v[176:179], v[96:99]
    ds_read_b64_tr_b16 a[192:193], v246 offset:0
    s_add_u32 s38, s36, 77824
    buffer_store_dwordx4 v[92:95], v240, s[16:19], s38 offen offset:1536 sc1
    v_mfma_f32_16x16x32_bf16 v[100:103], a[244:247], v[176:179], v[100:103]
    ds_read_b64_tr_b16 a[194:195], v246 offset:1024
    v_mfma_f32_16x16x32_bf16 v[104:107], a[248:251], v[176:179], v[104:107]
    ds_read_b64_tr_b16 a[196:197], v246 offset:256
    v_mfma_f32_16x16x32_bf16 v[108:111], a[252:255], v[176:179], v[108:111]
    ds_read_b64_tr_b16 a[198:199], v246 offset:1280
    v_mfma_f32_16x16x32_bf16 v[112:115], a[240:243], v[180:183], v[112:115]
    ds_read_b64_tr_b16 a[200:201], v246 offset:512
    v_mfma_f32_16x16x32_bf16 v[116:119], a[244:247], v[180:183], v[116:119]
    ds_read_b64_tr_b16 a[202:203], v246 offset:1536
    s_add_u32 s28, s28, 8192
    s_and_b32 s28, s28, 65535
    s_add_u32 s29, s28, 4096
    v_mfma_f32_16x16x32_bf16 v[120:123], a[248:251], v[180:183], v[120:123]
    ds_read_b64_tr_b16 a[204:205], v246 offset:768
    v_mfma_f32_16x16x32_bf16 v[124:127], a[252:255], v[180:183], v[124:127]
    ds_read_b64_tr_b16 a[206:207], v246 offset:1792
    v_mfma_f32_16x16x32_bf16 v[128:131], a[240:243], v[184:187], v[128:131]
    v_mfma_f32_16x16x32_bf16 v[132:135], a[244:247], v[184:187], v[132:135]
    v_cvt_pk_bf16_f32 v64, v96, v97
    v_cvt_pk_bf16_f32 v65, v98, v99
    v_mfma_f32_16x16x32_bf16 v[136:139], a[248:251], v[184:187], v[136:139]
    v_cvt_pk_bf16_f32 v66, v100, v101
    v_cvt_pk_bf16_f32 v67, v102, v103
    v_mfma_f32_16x16x32_bf16 v[140:143], a[252:255], v[184:187], v[140:143]
    v_cvt_pk_bf16_f32 v68, v104, v105
    v_cvt_pk_bf16_f32 v69, v106, v107
    v_mfma_f32_16x16x32_bf16 v[144:147], a[240:243], v[188:191], v[144:147]
    v_cvt_pk_bf16_f32 v70, v108, v109
    v_cvt_pk_bf16_f32 v71, v110, v111
    v_mfma_f32_16x16x32_bf16 v[148:151], a[244:247], v[188:191], v[148:151]
    v_cvt_pk_bf16_f32 v72, v112, v113
    v_cvt_pk_bf16_f32 v73, v114, v115
    v_mfma_f32_16x16x32_bf16 v[152:155], a[248:251], v[188:191], v[152:155]
    v_cvt_pk_bf16_f32 v74, v116, v117
    v_cvt_pk_bf16_f32 v75, v118, v119
    v_mfma_f32_16x16x32_bf16 v[156:159], a[252:255], v[188:191], v[156:159]
    v_cvt_pk_bf16_f32 v76, v120, v121
    v_cvt_pk_bf16_f32 v77, v122, v123
    s_nop 3
    v_cvt_pk_bf16_f32 v78, v124, v125
    v_cvt_pk_bf16_f32 v79, v126, v127
    v_cvt_pk_bf16_f32 v80, v128, v129
    v_cvt_pk_bf16_f32 v81, v130, v131
    v_cvt_pk_bf16_f32 v82, v132, v133
    v_cvt_pk_bf16_f32 v83, v134, v135
    v_cvt_pk_bf16_f32 v84, v136, v137
    v_cvt_pk_bf16_f32 v85, v138, v139
    v_cvt_pk_bf16_f32 v86, v140, v141
    v_cvt_pk_bf16_f32 v87, v142, v143
    v_cvt_pk_bf16_f32 v88, v144, v145
    v_cvt_pk_bf16_f32 v89, v146, v147
    v_cvt_pk_bf16_f32 v90, v148, v149
    v_cvt_pk_bf16_f32 v91, v150, v151
    v_cvt_pk_bf16_f32 v92, v152, v153
    v_cvt_pk_bf16_f32 v93, v154, v155
    v_cvt_pk_bf16_f32 v94, v156, v157
    v_cvt_pk_bf16_f32 v95, v158, v159
    s_add_u32 s80, s36, 102144
    s_add_u32 s81, s36, 104192
    s_add_u32 s82, s36, 103168
    s_add_u32 s83, s36, 105216
    s_add_u32 s84, s36, 110336
    s_add_u32 s85, s36, 112384
    s_add_u32 s86, s36, 111360
    s_add_u32 s87, s36, 113408
    s_branch ka_Q
ka_V:
    s_waitcnt lgkmcnt(0)
    v_mfma_f32_16x16x32_bf16 v[96:99], v[160:163], a[0:3], 0
    ds_read_b128 v[176:179], v225 offset:0
    ds_read_b128 v[180:183], v225 offset:2048
    v_mfma_f32_16x16x32_bf16 v[100:103], v[164:167], a[0:3], 0
    ds_read_b128 v[184:187], v225 offset:4096
    v_mfma_f32_16x16x32_bf16 v[104:107], v[160:163], a[4:7], 0
    ds_read_b128 v[188:191], v225 offset:6144
    ds_read_b64_tr_b16 a[16:17], v228 offset:4096
    v_mfma_f32_16x16x32_bf16 v[108:111], v[164:167], a[4:7], 0
    ds_read_b64_tr_b16 a[18:19], v228 offset:4608
    v_mfma_f32_16x16x32_bf16 v[112:115], v[160:163], a[8:11], 0
    ds_read_b64_tr_b16 a[20:21], v229 offset:4096
    ds_read_b64_tr_b16 a[22:23], v229 offset:4608
    s_add_u32 m0, s34, 16384
    s_add_u32 s37, s82, 0
    buffer_load_dwordx4 v232, s[44:47], s37 offen lds
    v_mfma_f32_16x16x32_bf16 v[116:119], v[164:167], a[8:11], 0
    ds_read_b64_tr_b16 a[24:25], v230 offset:4096
    buffer_load_dwordx4 v233, s[44:47], s37 offen offset:1024 lds
    v_mfma_f32_16x16x32_bf16 v[120:123], v[160:163], a[12:15], 0
    ds_read_b64_tr_b16 a[26:27], v230 offset:4608
    ds_read_b64_tr_b16 a[28:29], v231 offset:4096
    s_add_u32 m0, s34, 24576
    s_add_u32 s37, s83, 0
    buffer_load_dwordx4 v232, s[44:47], s37 offen lds
    v_mfma_f32_16x16x32_bf16 v[124:127], v[164:167], a[12:15], 0
    ds_read_b64_tr_b16 a[30:31], v231 offset:4608
    buffer_load_dwordx4 v233, s[44:47], s37 offen offset:1024 lds
    v_mfma_f32_16x16x32_bf16 v[128:131], v[168:171], a[0:3], 0
    s_add_u32 m0, s35, 16384
    s_and_b32 s33, s82, 1023
    s_lshl_b32 s33, s33, 12
    buffer_load_dwordx4 v234, s[48:51], s33 offen lds
    v_mfma_f32_16x16x32_bf16 v[132:135], v[172:175], a[0:3], 0
    buffer_load_dwordx4 v235, s[48:51], s33 offen offset:1024 lds
    v_mfma_f32_16x16x32_bf16 v[136:139], v[168:171], a[4:7], 0
    s_add_u32 m0, s35, 18432
    s_add_u32 s33, s33, 131072
    buffer_load_dwordx4 v234, s[48:51], s33 offen lds
    v_mfma_f32_16x16x32_bf16 v[140:143], v[172:175], a[4:7], 0
    buffer_load_dwordx4 v235, s[48:51], s33 offen offset:1024 lds
    v_mfma_f32_16x16x32_bf16 v[144:147], v[168:171], a[8:11], 0
    s_add_u32 m0, s35, 20480
    s_add_u32 s33, s33, 131072
    buffer_load_dwordx4 v234, s[48:51], s33 offen lds
    v_mfma_f32_16x16x32_bf16 v[148:151], v[172:175], a[8:11], 0
    buffer_load_dwordx4 v235, s[48:51], s33 offen offset:1024 lds
    v_mfma_f32_16x16x32_bf16 v[152:155], v[168:171], a[12:15], 0
    s_add_u32 m0, s35, 22528
    s_add_u32 s33, s33, 131072
    buffer_load_dwordx4 v234, s[48:51], s33 offen lds
    v_mfma_f32_16x16x32_bf16 v[156:159], v[172:175], a[12:15], 0
    buffer_load_dwordx4 v235, s[48:51], s33 offen offset:1024 lds
    s_waitcnt vmcnt(16) lgkmcnt(0)
    v_mfma_f32_16x16x32_bf16 v[96:99], v[176:179], a[16:19], v[96:99]
    ds_read_b128 v[160:163], v224 offset:8192
    ds_read_b128 v[164:167], v224 offset:10240
    v_mfma_f32_16x16x32_bf16 v[100:103], v[180:183], a[16:19], v[100:103]
    ds_read_b128 v[168:171], v224 offset:12288
    v_mfma_f32_16x16x32_bf16 v[104:107], v[176:179], a[20:23], v[104:107]
    ds_read_b128 v[172:175], v224 offset:14336
    ds_read_b64_tr_b16 a[32:33], v228 offset:8192
    v_mfma_f32_16x16x32_bf16 v[108:111], v[180:183], a[20:23], v[108:111]
    ds_read_b64_tr_b16 a[34:35], v228 offset:8704
    v_mfma_f32_16x16x32_bf16 v[112:115], v[176:179], a[24:27], v[112:115]
    ds_read_b64_tr_b16 a[36:37], v229 offset:8192
    ds_read_b64_tr_b16 a[38:39], v229 offset:8704
    s_add_u32 m0, s35, 0
    s_and_b32 s33, s83, 1023
    s_lshl_b32 s33, s33, 12
    buffer_load_dwordx4 v234, s[48:51], s33 offen lds
    v_mfma_f32_16x16x32_bf16 v[116:119], v[180:183], a[24:27], v[116:119]
    ds_read_b64_tr_b16 a[40:41], v230 offset:8192
    buffer_load_dwordx4 v235, s[48:51], s33 offen offset:1024 lds
    v_mfma_f32_16x16x32_bf16 v[120:123], v[176:179], a[28:31], v[120:123]
    ds_read_b64_tr_b16 a[42:43], v230 offset:8704
    ds_read_b64_tr_b16 a[44:45], v231 offset:8192
    s_add_u32 m0, s35, 2048
    s_add_u32 s33, s33, 131072
    buffer_load_dwordx4 v234, s[48:51], s33 offen lds
    v_mfma_f32_16x16x32_bf16 v[124:127], v[180:183], a[28:31], v[124:127]
    ds_read_b64_tr_b16 a[46:47], v231 offset:8704
    buffer_load_dwordx4 v235, s[48:51], s33 offen offset:1024 lds
    v_mfma_f32_16x16x32_bf16 v[128:131], v[184:187], a[16:19], v[128:131]
    s_add_u32 m0, s35, 4096
    s_add_u32 s33, s33, 131072
    buffer_load_dwordx4 v234, s[48:51], s33 offen lds
    v_mfma_f32_16x16x32_bf16 v[132:135], v[188:191], a[16:19], v[132:135]
    buffer_load_dwordx4 v235, s[48:51], s33 offen offset:1024 lds
    v_mfma_f32_16x16x32_bf16 v[136:139], v[184:187], a[20:23], v[136:139]
    s_add_u32 m0, s35, 6144
    s_add_u32 s33, s33, 131072
    buffer_load_dwordx4 v234, s[48:51], s33 offen lds
    v_mfma_f32_16x16x32_bf16 v[140:143], v[188:191], a[20:23], v[140:143]
    buffer_load_dwordx4 v235, s[48:51], s33 offen offset:1024 lds
    v_mfma_f32_16x16x32_bf16 v[144:147], v[184:187], a[24:27], v[144:147]
    v_mfma_f32_16x16x32_bf16 v[148:151], v[188:191], a[24:27], v[148:151]
    v_mfma_f32_16x16x32_bf16 v[152:155], v[184:187], a[28:31], v[152:155]
    v_mfma_f32_16x16x32_bf16 v[156:159], v[188:191], a[28:31], v[156:159]
    s_waitcnt lgkmcnt(0)
    v_mfma_f32_16x16x32_bf16 v[96:99], v[160:163], a[32:35], v[96:99]
    ds_read_b128 v[176:179], v225 offset:8192
    ds_read_b128 v[180:183], v225 offset:10240
    v_mfma_f32_16x16x32_bf16 v[100:103], v[164:167], a[32:35], v[100:103]
    ds_read_b128 v[184:187], v225 offset:12288
    v_mfma_f32_16x16x32_bf16 v[104:107], v[160:163], a[36:39], v[104:107]
    ds_read_b128 v[188:191], v225 offset:14336
    ds_read_b64_tr_b16 a[48:49], v228 offset:12288
    v_mfma_f32_16x16x32_bf16 v[108:111], v[164:167], a[36:39], v[108:111]
    ds_read_b64_tr_b16 a[50:51], v228 offset:12800
    v_mfma_f32_16x16x32_bf16 v[112:115], v[160:163], a[40:43], v[112:115]
    ds_read_b64_tr_b16 a[52:53], v229 offset:12288
    ds_read_b64_tr_b16 a[54:55], v229 offset:12800
    v_mfma_f32_16x16x32_bf16 v[116:119], v[164:167], a[40:43], v[116:119]
    ds_read_b64_tr_b16 a[56:57], v230 offset:12288
    s_add_u32 m0, s34, 32768
    s_add_u32 s37, s84, 0
    buffer_load_dwordx4 v232, s[44:47], s37 offen lds
    v_mfma_f32_16x16x32_bf16 v[120:123], v[160:163], a[44:47], v[120:123]
    ds_read_b64_tr_b16 a[58:59], v230 offset:12800
    ds_read_b64_tr_b16 a[60:61], v231 offset:12288
    v_mfma_f32_16x16x32_bf16 v[124:127], v[164:167], a[44:47], v[124:127]
    ds_read_b64_tr_b16 a[62:63], v231 offset:12800
    buffer_load_dwordx4 v233, s[44:47], s37 offen offset:1024 lds
    v_mfma_f32_16x16x32_bf16 v[128:131], v[168:171], a[32:35], v[128:131]
    v_mfma_f32_16x16x32_bf16 v[132:135], v[172:175], a[32:35], v[132:135]
    s_add_u32 m0, s34, 40960
    s_add_u32 s37, s85, 0
    buffer_load_dwordx4 v232, s[44:47], s37 offen lds
    v_mfma_f32_16x16x32_bf16 v[136:139], v[168:171], a[36:39], v[136:139]
    v_mfma_f32_16x16x32_bf16 v[140:143], v[172:175], a[36:39], v[140:143]
    buffer_load_dwordx4 v233, s[44:47], s37 offen offset:1024 lds
    v_mfma_f32_16x16x32_bf16 v[144:147], v[168:171], a[40:43], v[144:147]
    v_mfma_f32_16x16x32_bf16 v[148:151], v[172:175], a[40:43], v[148:151]
    v_mfma_f32_16x16x32_bf16 v[152:155], v[168:171], a[44:47], v[152:155]
    v_mfma_f32_16x16x32_bf16 v[156:159], v[172:175], a[44:47], v[156:159]
    s_waitcnt vmcnt(12) lgkmcnt(0)
    s_barrier
    v_mfma_f32_16x16x32_bf16 v[96:99], v[176:179], a[48:51], v[96:99]
    ds_read_b128 v[160:163], v224 offset:16384
    ds_read_b128 v[164:167], v224 offset:18432
    s_waitcnt vmcnt(24)
    v_mfma_f32_16x16x32_bf16 v[100:103], v[180:183], a[48:51], v[100:103]
    ds_read_b128 v[168:171], v224 offset:20480
    v_lshlrev_b32 v16, 16, v0
    v_and_b32 v17, 0xffff0000, v0
    v_mfma_f32_16x16x32_bf16 v[104:107], v[176:179], a[52:55], v[104:107]
    ds_read_b128 v[172:175], v224 offset:22528
    ds_read_b64_tr_b16 a[64:65], v228 offset:16384
    v_lshlrev_b32 v18, 16, v1
    v_mfma_f32_16x16x32_bf16 v[108:111], v[180:183], a[52:55], v[108:111]
    ds_read_b64_tr_b16 a[66:67], v228 offset:16896
    v_and_b32 v19, 0xffff0000, v1
    v_lshlrev_b32 v20, 16, v2
    v_mfma_f32_16x16x32_bf16 v[112:115], v[176:179], a[56:59], v[112:115]
    ds_read_b64_tr_b16 a[68:69], v229 offset:16384
    ds_read_b64_tr_b16 a[70:71], v229 offset:16896
    s_add_u32 m0, s35, 8192
    s_and_b32 s33, s84, 1023
    s_lshl_b32 s33, s33, 12
    buffer_load_dwordx4 v234, s[48:51], s33 offen lds
    v_mfma_f32_16x16x32_bf16 v[116:119], v[180:183], a[56:59], v[116:119]
    ds_read_b64_tr_b16 a[72:73], v230 offset:16384
    buffer_load_dwordx4 v235, s[48:51], s33 offen offset:1024 lds
    v_and_b32 v21, 0xffff0000, v2
    v_lshlrev_b32 v22, 16, v3
    v_mfma_f32_16x16x32_bf16 v[120:123], v[176:179], a[60:63], v[120:123]
    ds_read_b64_tr_b16 a[74:75], v230 offset:16896
    ds_read_b64_tr_b16 a[76:77], v231 offset:16384
    s_add_u32 m0, s35, 10240
    s_add_u32 s33, s33, 131072
    buffer_load_dwordx4 v234, s[48:51], s33 offen lds
    v_mfma_f32_16x16x32_bf16 v[124:127], v[180:183], a[60:63], v[124:127]
    ds_read_b64_tr_b16 a[78:79], v231 offset:16896
    buffer_load_dwordx4 v235, s[48:51], s33 offen offset:1024 lds
    v_and_b32 v23, 0xffff0000, v3
    v_mfma_f32_16x16x32_bf16 v[128:131], v[184:187], a[48:51], v[128:131]
    s_add_u32 m0, s35, 12288
    s_add_u32 s33, s33, 131072
    buffer_load_dwordx4 v234, s[48:51], s33 offen lds
    v_mfma_f32_16x16x32_bf16 v[132:135], v[188:191], a[48:51], v[132:135]
    buffer_load_dwordx4 v235, s[48:51], s33 offen offset:1024 lds
    v_lshlrev_b32 v24, 16, v4
    v_and_b32 v25, 0xffff0000, v4
    v_mfma_f32_16x16x32_bf16 v[136:139], v[184:187], a[52:55], v[136:139]
    s_add_u32 m0, s35, 14336
    s_add_u32 s33, s33, 131072
    buffer_load_dwordx4 v234, s[48:51], s33 offen lds
    v_lshlrev_b32 v26, 16, v5
    v_mfma_f32_16x16x32_bf16 v[140:143], v[188:191], a[52:55], v[140:143]
    buffer_load_dwordx4 v235, s[48:51], s33 offen offset:1024 lds
    v_and_b32 v27, 0xffff0000, v5
    v_lshlrev_b32 v28, 16, v6
    v_mfma_f32_16x16x32_bf16 v[144:147], v[184:187], a[56:59], v[144:147]
    v_and_b32 v29, 0xffff0000, v6
    v_lshlrev_b32 v30, 16, v7
    v_mfma_f32_16x16x32_bf16 v[148:151], v[188:191], a[56:59], v[148:151]
    v_and_b32 v31, 0xffff0000, v7
    v_lshlrev_b32 v32, 16, v8
    v_and_b32 v33, 0xffff0000, v8
    v_mfma_f32_16x16x32_bf16 v[152:155], v[184:187], a[60:63], v[152:155]
    v_lshlrev_b32 v34, 16, v9
    v_and_b32 v35, 0xffff0000, v9
    v_mfma_f32_16x16x32_bf16 v[156:159], v[188:191], a[60:63], v[156:159]
    v_lshlrev_b32 v36, 16, v10
    v_and_b32 v37, 0xffff0000, v10
    s_waitcnt lgkmcnt(0)
    v_mfma_f32_16x16x32_bf16 v[96:99], v[160:163], a[64:67], v[96:99]
    ds_read_b128 v[176:179], v225 offset:16384
    ds_read_b128 v[180:183], v225 offset:18432
    v_lshlrev_b32 v38, 16, v11
    v_and_b32 v39, 0xffff0000, v11
    v_mfma_f32_16x16x32_bf16 v[100:103], v[164:167], a[64:67], v[100:103]
    ds_read_b128 v[184:187], v225 offset:20480
    v_lshlrev_b32 v40, 16, v12
    v_and_b32 v41, 0xffff0000, v12
    v_mfma_f32_16x16x32_bf16 v[104:107], v[160:163], a[68:71], v[104:107]
    ds_read_b128 v[188:191], v225 offset:22528
    ds_read_b64_tr_b16 a[80:81], v228 offset:20480
    v_lshlrev_b32 v42, 16, v13
    v_mfma_f32_16x16x32_bf16 v[108:111], v[164:167], a[68:71], v[108:111]
    ds_read_b64_tr_b16 a[82:83], v228 offset:20992
    v_and_b32 v43, 0xffff0000, v13
    v_lshlrev_b32 v44, 16, v14
    v_mfma_f32_16x16x32_bf16 v[112:115], v[160:163], a[72:75], v[112:115]
    ds_read_b64_tr_b16 a[84:85], v229 offset:20480
    ds_read_b64_tr_b16 a[86:87], v229 offset:20992
    v_and_b32 v45, 0xffff0000, v14
    v_mfma_f32_16x16x32_bf16 v[116:119], v[164:167], a[72:75], v[116:119]
    ds_read_b64_tr_b16 a[88:89], v230 offset:20480
    s_add_u32 m0, s34, 49152
    s_add_u32 s37, s86, 0
    buffer_load_dwordx4 v232, s[44:47], s37 offen lds
    v_mfma_f32_16x16x32_bf16 v[120:123], v[160:163], a[76:79], v[120:123]
    ds_read_b64_tr_b16 a[90:91], v230 offset:20992
    ds_read_b64_tr_b16 a[92:93], v231 offset:20480
    v_lshlrev_b32 v46, 16, v15
    v_mfma_f32_16x16x32_bf16 v[124:127], v[164:167], a[76:79], v[124:127]
    ds_read_b64_tr_b16 a[94:95], v231 offset:20992
    buffer_load_dwordx4 v233, s[44:47], s37 offen offset:1024 lds
    v_and_b32 v47, 0xffff0000, v15
    v_mfma_f32_16x16x32_bf16 v[128:131], v[168:171], a[64:67], v[128:131]
    v_add_f32 v52, v16, v20
    v_add_f32 v53, v17, v21
    v_add_f32 v54, v18, v22
    v_mfma_f32_16x16x32_bf16 v[132:135], v[172:175], a[64:67], v[132:135]
    s_add_u32 m0, s34, 57344
    s_add_u32 s37, s87, 0
    buffer_load_dwordx4 v232, s[44:47], s37 offen lds
    v_add_f32 v55, v19, v23
    v_mfma_f32_16x16x32_bf16 v[136:139], v[168:171], a[68:71], v[136:139]
    v_add_f32 v52, v52, v24
    v_add_f32 v53, v53, v25
    v_mfma_f32_16x16x32_bf16 v[140:143], v[172:175], a[68:71], v[140:143]
    buffer_load_dwordx4 v233, s[44:47], s37 offen offset:1024 lds
    v_add_f32 v54, v54, v26
    v_add_f32 v55, v55, v27
    v_mfma_f32_16x16x32_bf16 v[144:147], v[168:171], a[72:75], v[144:147]
    v_add_f32 v52, v52, v28
    v_add_f32 v53, v53, v29
    v_add_f32 v54, v54, v30
    v_mfma_f32_16x16x32_bf16 v[148:151], v[172:175], a[72:75], v[148:151]
    v_add_f32 v55, v55, v31
    v_add_f32 v52, v52, v32
    v_mfma_f32_16x16x32_bf16 v[152:155], v[168:171], a[76:79], v[152:155]
    v_add_f32 v53, v53, v33
    v_add_f32 v54, v54, v34
    v_add_f32 v55, v55, v35
    v_mfma_f32_16x16x32_bf16 v[156:159], v[172:175], a[76:79], v[156:159]
    v_add_f32 v52, v52, v36
    v_add_f32 v53, v53, v37
    s_waitcnt vmcnt(16) lgkmcnt(0)
    v_mfma_f32_16x16x32_bf16 v[96:99], v[176:179], a[80:83], v[96:99]
    ds_read_b128 v[160:163], v224 offset:24576
    ds_read_b128 v[164:167], v224 offset:26624
    v_add_f32 v54, v54, v38
    v_mfma_f32_16x16x32_bf16 v[100:103], v[180:183], a[80:83], v[100:103]
    ds_read_b128 v[168:171], v224 offset:28672
    v_add_f32 v55, v55, v39
    v_add_f32 v52, v52, v40
    v_mfma_f32_16x16x32_bf16 v[104:107], v[176:179], a[84:87], v[104:107]
    ds_read_b128 v[172:175], v224 offset:30720
    ds_read_b64_tr_b16 a[96:97], v228 offset:0
    v_add_f32 v53, v53, v41
    v_mfma_f32_16x16x32_bf16 v[108:111], v[180:183], a[84:87], v[108:111]
    ds_read_b64_tr_b16 a[98:99], v228 offset:512
    v_add_f32 v54, v54, v42
    v_add_f32 v55, v55, v43
    v_mfma_f32_16x16x32_bf16 v[112:115], v[176:179], a[88:91], v[112:115]
    ds_read_b64_tr_b16 a[100:101], v229 offset:0
    ds_read_b64_tr_b16 a[102:103], v229 offset:512
    s_add_u32 m0, s35, 16384
    s_and_b32 s33, s85, 1023
    s_lshl_b32 s33, s33, 12
    buffer_load_dwordx4 v234, s[48:51], s33 offen lds
    v_mfma_f32_16x16x32_bf16 v[116:119], v[180:183], a[88:91], v[116:119]
    ds_read_b64_tr_b16 a[104:105], v230 offset:0
    buffer_load_dwordx4 v235, s[48:51], s33 offen offset:1024 lds
    v_add_f32 v52, v52, v44
    v_mfma_f32_16x16x32_bf16 v[120:123], v[176:179], a[92:95], v[120:123]
    ds_read_b64_tr_b16 a[106:107], v230 offset:512
    ds_read_b64_tr_b16 a[108:109], v231 offset:0
    s_add_u32 m0, s35, 18432
    s_add_u32 s33, s33, 131072
    buffer_load_dwordx4 v234, s[48:51], s33 offen lds
    v_mfma_f32_16x16x32_bf16 v[124:127], v[180:183], a[92:95], v[124:127]
    ds_read_b64_tr_b16 a[110:111], v231 offset:512
    buffer_load_dwordx4 v235, s[48:51], s33 offen offset:1024 lds
    v_add_f32 v53, v53, v45
    v_mfma_f32_16x16x32_bf16 v[128:131], v[184:187], a[80:83], v[128:131]
    s_add_u32 m0, s35, 20480
    s_add_u32 s33, s33, 131072
    buffer_load_dwordx4 v234, s[48:51], s33 offen lds
    v_add_f32 v54, v54, v46
    v_mfma_f32_16x16x32_bf16 v[132:135], v[188:191], a[80:83], v[132:135]
    buffer_load_dwordx4 v235, s[48:51], s33 offen offset:1024 lds
    v_add_f32 v55, v55, v47
    v_add_f32 v52, v52, v53
    v_mfma_f32_16x16x32_bf16 v[136:139], v[184:187], a[84:87], v[136:139]
    s_add_u32 m0, s35, 22528
    s_add_u32 s33, s33, 131072
    buffer_load_dwordx4 v234, s[48:51], s33 offen lds
    v_mfma_f32_16x16x32_bf16 v[140:143], v[188:191], a[84:87], v[140:143]
    buffer_load_dwordx4 v235, s[48:51], s33 offen offset:1024 lds
    v_add_f32 v54, v54, v55
    v_add_f32 v48, v52, v54
    v_mfma_f32_16x16x32_bf16 v[144:147], v[184:187], a[88:91], v[144:147]
    s_nop 1
    v_add_f32_dpp v48, v48, v48 quad_perm:[1,0,3,2] row_mask:0xf bank_mask:0xf
    s_nop 1
    v_mfma_f32_16x16x32_bf16 v[148:151], v[188:191], a[88:91], v[148:151]
    v_add_f32_dpp v48, v48, v48 quad_perm:[2,3,0,1] row_mask:0xf bank_mask:0xf
    s_nop 1
    v_mfma_f32_16x16x32_bf16 v[152:155], v[184:187], a[92:95], v[152:155]
    v_add_f32_dpp v48, v48, v48 row_half_mirror row_mask:0xf bank_mask:0xf
    s_nop 1
    v_add_f32_dpp v48, v48, v48 row_mirror row_mask:0xf bank_mask:0xf
    v_mfma_f32_16x16x32_bf16 v[156:159], v[188:191], a[92:95], v[156:159]
    s_nop 0
    v_mov_b32 v49, v48
    s_waitcnt lgkmcnt(0)
    v_mfma_f32_16x16x32_bf16 v[96:99], v[160:163], a[96:99], v[96:99]
    ds_read_b128 v[176:179], v225 offset:24576
    ds_read_b128 v[180:183], v225 offset:26624
    s_nop 1
    v_mfma_f32_16x16x32_bf16 v[100:103], v[164:167], a[96:99], v[100:103]
    ds_read_b128 v[184:187], v225 offset:28672
    v_permlane16_swap_b32 v48, v49
    s_nop 0
    v_mfma_f32_16x16x32_bf16 v[104:107], v[160:163], a[100:103], v[104:107]
    ds_read_b128 v[188:191], v225 offset:30720
    ds_read_b64_tr_b16 a[112:113], v228 offset:4096
    v_add_f32 v48, v48, v49
    v_mfma_f32_16x16x32_bf16 v[108:111], v[164:167], a[100:103], v[108:111]
    ds_read_b64_tr_b16 a[114:115], v228 offset:4608
    v_mul_f32 v48, 0x3a800000, v48
    v_sub_f32 v56, v16, v48
    v_mfma_f32_16x16x32_bf16 v[112:115], v[160:163], a[104:107], v[112:115]
    ds_read_b64_tr_b16 a[116:117], v229 offset:4096
    ds_read_b64_tr_b16 a[118:119], v229 offset:4608
    v_mul_f32 v52, v56, v56
    v_mfma_f32_16x16x32_bf16 v[116:119], v[164:167], a[104:107], v[116:119]
    ds_read_b64_tr_b16 a[120:121], v230 offset:4096
    v_sub_f32 v57, v17, v48
    v_mul_f32 v53, v57, v57
    v_mfma_f32_16x16x32_bf16 v[120:123], v[160:163], a[108:111], v[120:123]
    ds_read_b64_tr_b16 a[122:123], v230 offset:4608
    ds_read_b64_tr_b16 a[124:125], v231 offset:4096
    v_sub_f32 v58, v18, v48
    v_mul_f32 v54, v58, v58
    v_mfma_f32_16x16x32_bf16 v[124:127], v[164:167], a[108:111], v[124:127]
    ds_read_b64_tr_b16 a[126:127], v231 offset:4608
    v_sub_f32 v59, v19, v48
    v_mfma_f32_16x16x32_bf16 v[128:131], v[168:171], a[96:99], v[128:131]
    v_mul_f32 v55, v59, v59
    v_sub_f32 v56, v20, v48
    v_fmac_f32 v52, v56, v56
    v_mfma_f32_16x16x32_bf16 v[132:135], v[172:175], a[96:99], v[132:135]
    v_sub_f32 v57, v21, v48
    v_fmac_f32 v53, v57, v57
    v_sub_f32 v58, v22, v48
    v_mfma_f32_16x16x32_bf16 v[136:139], v[168:171], a[100:103], v[136:139]
    v_fmac_f32 v54, v58, v58
    v_sub_f32 v59, v23, v48
    v_mfma_f32_16x16x32_bf16 v[140:143], v[172:175], a[100:103], v[140:143]
    v_fmac_f32 v55, v59, v59
    v_sub_f32 v56, v24, v48
    v_fmac_f32 v52, v56, v56
    v_mfma_f32_16x16x32_bf16 v[144:147], v[168:171], a[104:107], v[144:147]
    v_sub_f32 v57, v25, v48
    v_fmac_f32 v53, v57, v57
    v_mfma_f32_16x16x32_bf16 v[148:151], v[172:175], a[104:107], v[148:151]
    v_sub_f32 v58, v26, v48
    v_fmac_f32 v54, v58, v58
    v_sub_f32 v59, v27, v48
    v_mfma_f32_16x16x32_bf16 v[152:155], v[168:171], a[108:111], v[152:155]
    v_fmac_f32 v55, v59, v59
    v_sub_f32 v56, v28, v48
    v_mfma_f32_16x16x32_bf16 v[156:159], v[172:175], a[108:111], v[156:159]
    v_fmac_f32 v52, v56, v56
    s_waitcnt vmcnt(12) lgkmcnt(0)
    s_barrier
    v_mfma_f32_16x16x32_bf16 v[96:99], v[176:179], a[112:115], v[96:99]
    ds_read_b128 v[160:163], v224 offset:32768
    ds_read_b128 v[164:167], v224 offset:34816
    v_sub_f32 v57, v29, v48
    v_fmac_f32 v53, v57, v57
    v_mfma_f32_16x16x32_bf16 v[100:103], v[180:183], a[112:115], v[100:103]
    ds_read_b128 v[168:171], v224 offset:36864
    v_sub_f32 v58, v30, v48
    v_fmac_f32 v54, v58, v58
    v_mfma_f32_16x16x32_bf16 v[104:107], v[176:179], a[116:119], v[104:107]
    ds_read_b128 v[172:175], v224 offset:38912
    ds_read_b64_tr_b16 a[128:129], v228 offset:8192
    v_sub_f32 v59, v31, v48
    v_mfma_f32_16x16x32_bf16 v[108:111], v[180:183], a[116:119], v[108:111]
    ds_read_b64_tr_b16 a[130:131], v228 offset:8704
    v_fmac_f32 v55, v59, v59
    v_sub_f32 v56, v32, v48
    v_mfma_f32_16x16x32_bf16 v[112:115], v[176:179], a[120:123], v[112:115]
    ds_read_b64_tr_b16 a[132:133], v229 offset:8192
    ds_read_b64_tr_b16 a[134:135], v229 offset:8704
    s_add_u32 m0, s35, 0
    s_and_b32 s33, s86, 1023
    s_lshl_b32 s33, s33, 12
    buffer_load_dwordx4 v234, s[48:51], s33 offen lds
    v_mfma_f32_16x16x32_bf16 v[116:119], v[180:183], a[120:123], v[116:119]
    ds_read_b64_tr_b16 a[136:137], v230 offset:8192
    buffer_load_dwordx4 v235, s[48:51], s33 offen offset:1024 lds
    v_fmac_f32 v52, v56, v56
    v_mfma_f32_16x16x32_bf16 v[120:123], v[176:179], a[124:127], v[120:123]
    ds_read_b64_tr_b16 a[138:139], v230 offset:8704
    ds_read_b64_tr_b16 a[140:141], v231 offset:8192
    s_add_u32 m0, s35, 2048
    s_add_u32 s33, s33, 131072
    buffer_load_dwordx4 v234, s[48:51], s33 offen lds
    v_mfma_f32_16x16x32_bf16 v[124:127], v[180:183], a[124:127], v[124:127]
    ds_read_b64_tr_b16 a[142:143], v231 offset:8704
    buffer_load_dwordx4 v235, s[48:51], s33 offen offset:1024 lds
    v_sub_f32 v57, v33, v48
    v_mfma_f32_16x16x32_bf16 v[128:131], v[184:187], a[112:115], v[128:131]
    s_add_u32 m0, s35, 4096
    s_add_u32 s33, s33, 131072
    buffer_load_dwordx4 v234, s[48:51], s33 offen lds
    v_fmac_f32 v53, v57, v57
    v_mfma_f32_16x16x32_bf16 v[132:135], v[188:191], a[112:115], v[132:135]
    buffer_load_dwordx4 v235, s[48:51], s33 offen offset:1024 lds
    v_sub_f32 v58, v34, v48
    v_fmac_f32 v54, v58, v58
    v_mfma_f32_16x16x32_bf16 v[136:139], v[184:187], a[116:119], v[136:139]
    s_add_u32 m0, s35, 6144
    s_add_u32 s33, s33, 131072
    buffer_load_dwordx4 v234, s[48:51], s33 offen lds
    v_mfma_f32_16x16x32_bf16 v[140:143], v[188:191], a[116:119], v[140:143]
    buffer_load_dwordx4 v235, s[48:51], s33 offen offset:1024 lds
    v_sub_f32 v59, v35, v48
    v_fmac_f32 v55, v59, v59
    v_mfma_f32_16x16x32_bf16 v[144:147], v[184:187], a[120:123], v[144:147]
    v_sub_f32 v56, v36, v48
    v_fmac_f32 v52, v56, v56
    v_sub_f32 v57, v37, v48
    v_mfma_f32_16x16x32_bf16 v[148:151], v[188:191], a[120:123], v[148:151]
    v_fmac_f32 v53, v57, v57
    v_sub_f32 v58, v38, v48
    v_mfma_f32_16x16x32_bf16 v[152:155], v[184:187], a[124:127], v[152:155]
    v_fmac_f32 v54, v58, v58
    v_sub_f32 v59, v39, v48
    v_fmac_f32 v55, v59, v59
    v_mfma_f32_16x16x32_bf16 v[156:159], v[188:191], a[124:127], v[156:159]
    v_sub_f32 v56, v40, v48
    v_fmac_f32 v52, v56, v56
    s_waitcnt lgkmcnt(0)
    v_mfma_f32_16x16x32_bf16 v[96:99], v[160:163], a[128:131], v[96:99]
    ds_read_b128 v[176:179], v225 offset:32768
    ds_read_b128 v[180:183], v225 offset:34816
    v_sub_f32 v57, v41, v48
    v_mfma_f32_16x16x32_bf16 v[100:103], v[164:167], a[128:131], v[100:103]
    ds_read_b128 v[184:187], v225 offset:36864
    v_fmac_f32 v53, v57, v57
    v_sub_f32 v58, v42, v48
    v_mfma_f32_16x16x32_bf16 v[104:107], v[160:163], a[132:135], v[104:107]
    ds_read_b128 v[188:191], v225 offset:38912
    ds_read_b64_tr_b16 a[144:145], v228 offset:12288
    v_fmac_f32 v54, v58, v58
    v_mfma_f32_16x16x32_bf16 v[108:111], v[164:167], a[132:135], v[108:111]
    ds_read_b64_tr_b16 a[146:147], v228 offset:12800
    v_sub_f32 v59, v43, v48
    v_fmac_f32 v55, v59, v59
    v_mfma_f32_16x16x32_bf16 v[112:115], v[160:163], a[136:139], v[112:115]
    ds_read_b64_tr_b16 a[148:149], v229 offset:12288
    ds_read_b64_tr_b16 a[150:151], v229 offset:12800
    v_sub_f32 v56, v44, v48
    v_mfma_f32_16x16x32_bf16 v[116:119], v[164:167], a[136:139], v[116:119]
    ds_read_b64_tr_b16 a[152:153], v230 offset:12288
    s_add_u32 m0, s34, 0
    s_add_u32 s37, s80, 65536
    buffer_load_dwordx4 v232, s[44:47], s37 offen lds
    v_mfma_f32_16x16x32_bf16 v[120:123], v[160:163], a[140:143], v[120:123]
    ds_read_b64_tr_b16 a[154:155], v230 offset:12800
    ds_read_b64_tr_b16 a[156:157], v231 offset:12288
    v_fmac_f32 v52, v56, v56
    v_sub_f32 v57, v45, v48
    v_mfma_f32_16x16x32_bf16 v[124:127], v[164:167], a[140:143], v[124:127]
    ds_read_b64_tr_b16 a[158:159], v231 offset:12800
    buffer_load_dwordx4 v233, s[44:47], s37 offen offset:1024 lds
    v_fmac_f32 v53, v57, v57
    v_mfma_f32_16x16x32_bf16 v[128:131], v[168:171], a[128:131], v[128:131]
    v_sub_f32 v58, v46, v48
    v_fmac_f32 v54, v58, v58
    v_mfma_f32_16x16x32_bf16 v[132:135], v[172:175], a[128:131], v[132:135]
    s_add_u32 m0, s34, 8192
    s_add_u32 s37, s81, 65536
    buffer_load_dwordx4 v232, s[44:47], s37 offen lds
    v_sub_f32 v59, v47, v48
    v_mfma_f32_16x16x32_bf16 v[136:139], v[168:171], a[132:135], v[136:139]
    v_fmac_f32 v55, v59, v59
    v_add_f32 v52, v52, v53
    v_add_f32 v54, v54, v55
    v_mfma_f32_16x16x32_bf16 v[140:143], v[172:175], a[132:135], v[140:143]
    buffer_load_dwordx4 v233, s[44:47], s37 offen offset:1024 lds
    v_add_f32 v51, v52, v54
    v_mfma_f32_16x16x32_bf16 v[144:147], v[168:171], a[136:139], v[144:147]
    s_nop 1
    v_add_f32_dpp v51, v51, v51 quad_perm:[1,0,3,2] row_mask:0xf bank_mask:0xf
    s_nop 1
    v_mfma_f32_16x16x32_bf16 v[148:151], v[172:175], a[136:139], v[148:151]
    v_add_f32_dpp v51, v51, v51 quad_perm:[2,3,0,1] row_mask:0xf bank_mask:0xf
    s_nop 1
    v_add_f32_dpp v51, v51, v51 row_half_mirror row_mask:0xf bank_mask:0xf
    v_mfma_f32_16x16x32_bf16 v[152:155], v[168:171], a[140:143], v[152:155]
    s_nop 1
    v_add_f32_dpp v51, v51, v51 row_mirror row_mask:0xf bank_mask:0xf
    v_mfma_f32_16x16x32_bf16 v[156:159], v[172:175], a[140:143], v[156:159]
    s_nop 0
    v_mov_b32 v49, v51
    s_waitcnt vmcnt(12) lgkmcnt(0)
    v_mfma_f32_16x16x32_bf16 v[96:99], v[176:179], a[144:147], v[96:99]
    ds_read_b128 v[160:163], v224 offset:40960
    ds_read_b128 v[164:167], v224 offset:43008
    s_nop 1
    v_mfma_f32_16x16x32_bf16 v[100:103], v[180:183], a[144:147], v[100:103]
    ds_read_b128 v[168:171], v224 offset:45056
    v_permlane16_swap_b32 v51, v49
    s_nop 0
    v_mfma_f32_16x16x32_bf16 v[104:107], v[176:179], a[148:151], v[104:107]
    ds_read_b128 v[172:175], v224 offset:47104
    ds_read_b64_tr_b16 a[160:161], v228 offset:16384
    v_add_f32 v51, v51, v49
    v_mfma_f32_16x16x32_bf16 v[108:111], v[180:183], a[148:151], v[108:111]
    ds_read_b64_tr_b16 a[162:163], v228 offset:16896
    v_mul_f32 v51, 0x3a800000, v51
    v_cvt_pk_bf16_f32 v50, v48, v51
    v_mfma_f32_16x16x32_bf16 v[112:115], v[176:179], a[152:155], v[112:115]
    ds_read_b64_tr_b16 a[164:165], v229 offset:16384
    ds_read_b64_tr_b16 a[166:167], v229 offset:16896
    s_add_u32 m0, s35, 8192
    s_and_b32 s33, s87, 1023
    s_lshl_b32 s33, s33, 12
    buffer_load_dwordx4 v234, s[48:51], s33 offen lds
    v_mfma_f32_16x16x32_bf16 v[116:119], v[180:183], a[152:155], v[116:119]
    ds_read_b64_tr_b16 a[168:169], v230 offset:16384
    buffer_load_dwordx4 v235, s[48:51], s33 offen offset:1024 lds
    v_and_b32 v51, 0xffff0000, v50
    v_mfma_f32_16x16x32_bf16 v[120:123], v[176:179], a[156:159], v[120:123]
    ds_read_b64_tr_b16 a[170:171], v230 offset:16896
    ds_read_b64_tr_b16 a[172:173], v231 offset:16384
    s_add_u32 m0, s35, 10240
    s_add_u32 s33, s33, 131072
    buffer_load_dwordx4 v234, s[48:51], s33 offen lds
    v_mfma_f32_16x16x32_bf16 v[124:127], v[180:183], a[156:159], v[124:127]
    ds_read_b64_tr_b16 a[174:175], v231 offset:16896
    buffer_load_dwordx4 v235, s[48:51], s33 offen offset:1024 lds
    v_lshlrev_b32 v50, 16, v50
    v_add_f32 v51, 0x3727c5ac, v51
    v_mfma_f32_16x16x32_bf16 v[128:131], v[184:187], a[144:147], v[128:131]
    s_add_u32 m0, s35, 12288
    s_add_u32 s33, s33, 131072
    buffer_load_dwordx4 v234, s[48:51], s33 offen lds
    v_mfma_f32_16x16x32_bf16 v[132:135], v[188:191], a[144:147], v[132:135]
    buffer_load_dwordx4 v235, s[48:51], s33 offen offset:1024 lds
    v_cvt_pk_bf16_f32 v51, v51, v51
    v_lshlrev_b32 v51, 16, v51
    v_mfma_f32_16x16x32_bf16 v[136:139], v[184:187], a[148:151], v[136:139]
    s_add_u32 m0, s35, 14336
    s_add_u32 s33, s33, 131072
    buffer_load_dwordx4 v234, s[48:51], s33 offen lds
    v_mfma_f32_16x16x32_bf16 v[140:143], v[188:191], a[148:151], v[140:143]
    buffer_load_dwordx4 v235, s[48:51], s33 offen offset:1024 lds
    v_sqrt_f32 v51, v51
    s_nop 0
    v_mfma_f32_16x16x32_bf16 v[144:147], v[184:187], a[152:155], v[144:147]
    v_cvt_pk_bf16_f32 v51, v51, v51
    v_lshlrev_b32 v51, 16, v51
    v_mfma_f32_16x16x32_bf16 v[148:151], v[188:191], a[152:155], v[148:151]
    v_rcp_f32 v51, v51
    s_nop 0
    v_mfma_f32_16x16x32_bf16 v[152:155], v[184:187], a[156:159], v[152:155]
    v_sub_f32 v16, v16, v50
    v_sub_f32 v17, v17, v50
    v_mfma_f32_16x16x32_bf16 v[156:159], v[188:191], a[156:159], v[156:159]
    v_cvt_pk_bf16_f32 v17, v16, v17
    v_lshlrev_b32 v16, 16, v17
    s_waitcnt lgkmcnt(0)
    v_mfma_f32_16x16x32_bf16 v[96:99], v[160:163], a[160:163], v[96:99]
    ds_read_b128 v[176:179], v225 offset:40960
    ds_read_b128 v[180:183], v225 offset:43008
    v_and_b32 v17, 0xffff0000, v17
    v_mul_f32 v16, v16, v51
    v_mfma_f32_16x16x32_bf16 v[100:103], v[164:167], a[160:163], v[100:103]
    ds_read_b128 v[184:187], v225 offset:45056
    v_mul_f32 v17, v17, v51
    v_mfma_f32_16x16x32_bf16 v[104:107], v[160:163], a[164:167], v[104:107]
    ds_read_b128 v[188:191], v225 offset:47104
    ds_read_b64_tr_b16 a[176:177], v228 offset:20480
    v_cvt_pk_bf16_f32 v0, v16, v17
    v_sub_f32 v18, v18, v50
    v_mfma_f32_16x16x32_bf16 v[108:111], v[164:167], a[164:167], v[108:111]
    ds_read_b64_tr_b16 a[178:179], v228 offset:20992
    v_sub_f32 v19, v19, v50
    v_cvt_pk_bf16_f32 v19, v18, v19
    v_mfma_f32_16x16x32_bf16 v[112:115], v[160:163], a[168:171], v[112:115]
    ds_read_b64_tr_b16 a[180:181], v229 offset:20480
    ds_read_b64_tr_b16 a[182:183], v229 offset:20992
    s_add_u32 m0, s34, 16384
    s_add_u32 s37, s82, 65536
    buffer_load_dwordx4 v232, s[44:47], s37 offen lds
    v_mfma_f32_16x16x32_bf16 v[116:119], v[164:167], a[168:171], v[116:119]
    ds_read_b64_tr_b16 a[184:185], v230 offset:20480
    buffer_load_dwordx4 v233, s[44:47], s37 offen offset:1024 lds
    v_lshlrev_b32 v18, 16, v19
    v_mfma_f32_16x16x32_bf16 v[120:123], v[160:163], a[172:175], v[120:123]
    ds_read_b64_tr_b16 a[186:187], v230 offset:20992
    ds_read_b64_tr_b16 a[188:189], v231 offset:20480
    s_add_u32 m0, s34, 24576
    s_add_u32 s37, s83, 65536
    buffer_load_dwordx4 v232, s[44:47], s37 offen lds
    v_mfma_f32_16x16x32_bf16 v[124:127], v[164:167], a[172:175], v[124:127]
    ds_read_b64_tr_b16 a[190:191], v231 offset:20992
    buffer_load_dwordx4 v233, s[44:47], s37 offen offset:1024 lds
    v_and_b32 v19, 0xffff0000, v19
    v_mfma_f32_16x16x32_bf16 v[128:131], v[168:171], a[160:163], v[128:131]
    s_lshl2_add_u32 s26, s4, s3
    s_lshl_b32 s26, s26, 10
    s_add_u32 s26, s26, s32
    s_add_u32 s26, s26, 131072
    v_mfma_f32_16x16x32_bf16 v[132:135], v[172:175], a[160:163], v[132:135]
    v_and_b32 v194, 0x40000380, v251
    buffer_load_dword v252, v194, s[44:47], s26 offen
    v_mul_f32 v18, v18, v51
    v_mfma_f32_16x16x32_bf16 v[136:139], v[168:171], a[164:167], v[136:139]
    v_lshrrev_b32 v195, 1, v253
    v_lshlrev_b32 v195, 13, v195
    v_and_b32 v196, 1, v253
    v_lshl_add_u32 v195, v196, 7, v195
    v_mfma_f32_16x16x32_bf16 v[140:143], v[172:175], a[164:167], v[140:143]
    s_lshl_b32 s25, s4, 8
    s_add_u32 s25, s25, s27
    buffer_load_dword v252, v195, s[12:15], s25 offen
    v_mul_f32 v19, v19, v51
    v_mfma_f32_16x16x32_bf16 v[144:147], v[168:171], a[168:171], v[144:147]
    v_cvt_pk_bf16_f32 v1, v18, v19
    v_sub_f32 v20, v20, v50
    v_sub_f32 v21, v21, v50
    v_mfma_f32_16x16x32_bf16 v[148:151], v[172:175], a[168:171], v[148:151]
    v_cvt_pk_bf16_f32 v21, v20, v21
    v_lshlrev_b32 v20, 16, v21
    v_mfma_f32_16x16x32_bf16 v[152:155], v[168:171], a[172:175], v[152:155]
    v_and_b32 v21, 0xffff0000, v21
    v_mul_f32 v20, v20, v51
    v_mul_f32 v21, v21, v51
    v_mfma_f32_16x16x32_bf16 v[156:159], v[172:175], a[172:175], v[156:159]
    v_cvt_pk_bf16_f32 v2, v20, v21
    s_waitcnt vmcnt(18) lgkmcnt(0)
    s_barrier
    v_mfma_f32_16x16x32_bf16 v[96:99], v[176:179], a[176:179], v[96:99]
    ds_read_b128 v[160:163], v224 offset:49152
    ds_read_b128 v[164:167], v224 offset:51200
    v_sub_f32 v22, v22, v50
    v_mfma_f32_16x16x32_bf16 v[100:103], v[180:183], a[176:179], v[100:103]
    ds_read_b128 v[168:171], v224 offset:53248
    v_sub_f32 v23, v23, v50
    v_cvt_pk_bf16_f32 v23, v22, v23
    v_mfma_f32_16x16x32_bf16 v[104:107], v[176:179], a[180:183], v[104:107]
    ds_read_b128 v[172:175], v224 offset:55296
    ds_read_b64_tr_b16 a[192:193], v228 offset:0
    v_lshlrev_b32 v22, 16, v23
    v_mfma_f32_16x16x32_bf16 v[108:111], v[180:183], a[180:183], v[108:111]
    ds_read_b64_tr_b16 a[194:195], v228 offset:512
    v_and_b32 v23, 0xffff0000, v23
    v_mul_f32 v22, v22, v51
    v_mfma_f32_16x16x32_bf16 v[112:115], v[176:179], a[184:187], v[112:115]
    ds_read_b64_tr_b16 a[196:197], v229 offset:0
    ds_read_b64_tr_b16 a[198:199], v229 offset:512
    v_mul_f32 v23, v23, v51
    v_mfma_f32_16x16x32_bf16 v[116:119], v[180:183], a[184:187], v[116:119]
    ds_read_b64_tr_b16 a[200:201], v230 offset:0
    v_cvt_pk_bf16_f32 v3, v22, v23
    v_sub_f32 v24, v24, v50
    v_mfma_f32_16x16x32_bf16 v[120:123], v[176:179], a[188:191], v[120:123]
    ds_read_b64_tr_b16 a[202:203], v230 offset:512
    ds_read_b64_tr_b16 a[204:205], v231 offset:0
    v_sub_f32 v25, v25, v50
    v_cvt_pk_bf16_f32 v25, v24, v25
    v_mfma_f32_16x16x32_bf16 v[124:127], v[180:183], a[188:191], v[124:127]
    ds_read_b64_tr_b16 a[206:207], v231 offset:512
    v_lshlrev_b32 v24, 16, v25
    v_mfma_f32_16x16x32_bf16 v[128:131], v[184:187], a[176:179], v[128:131]
    v_and_b32 v25, 0xffff0000, v25
    v_mul_f32 v24, v24, v51
    v_mul_f32 v25, v25, v51
    v_mfma_f32_16x16x32_bf16 v[132:135], v[188:191], a[176:179], v[132:135]
    v_cvt_pk_bf16_f32 v4, v24, v25
    v_sub_f32 v26, v26, v50
    v_sub_f32 v27, v27, v50
    v_mfma_f32_16x16x32_bf16 v[136:139], v[184:187], a[180:183], v[136:139]
    v_cvt_pk_bf16_f32 v27, v26, v27
    v_lshlrev_b32 v26, 16, v27
    v_mfma_f32_16x16x32_bf16 v[140:143], v[188:191], a[180:183], v[140:143]
    v_and_b32 v27, 0xffff0000, v27
    v_mul_f32 v26, v26, v51
    v_mul_f32 v27, v27, v51
    v_mfma_f32_16x16x32_bf16 v[144:147], v[184:187], a[184:187], v[144:147]
    v_cvt_pk_bf16_f32 v5, v26, v27
    v_sub_f32 v28, v28, v50
    v_mfma_f32_16x16x32_bf16 v[148:151], v[188:191], a[184:187], v[148:151]
    v_sub_f32 v29, v29, v50
    v_cvt_pk_bf16_f32 v29, v28, v29
    v_lshlrev_b32 v28, 16, v29
    v_mfma_f32_16x16x32_bf16 v[152:155], v[184:187], a[188:191], v[152:155]
    v_and_b32 v29, 0xffff0000, v29
    v_mul_f32 v28, v28, v51
    v_mfma_f32_16x16x32_bf16 v[156:159], v[188:191], a[188:191], v[156:159]
    v_mul_f32 v29, v29, v51
    v_cvt_pk_bf16_f32 v6, v28, v29
    s_waitcnt lgkmcnt(0)
    v_mfma_f32_16x16x32_bf16 v[96:99], v[160:163], a[192:195], v[96:99]
    ds_read_b128 v[176:179], v225 offset:49152
    ds_read_b128 v[180:183], v225 offset:51200
    v_sub_f32 v30, v30, v50
    v_mfma_f32_16x16x32_bf16 v[100:103], v[164:167], a[192:195], v[100:103]
    ds_read_b128 v[184:187], v225 offset:53248
    v_sub_f32 v31, v31, v50
    v_cvt_pk_bf16_f32 v31, v30, v31
    v_mfma_f32_16x16x32_bf16 v[104:107], v[160:163], a[196:199], v[104:107]
    ds_read_b128 v[188:191], v225 offset:55296
    ds_read_b64_tr_b16 a[208:209], v228 offset:4096
    v_lshlrev_b32 v30, 16, v31
    v_mfma_f32_16x16x32_bf16 v[108:111], v[164:167], a[196:199], v[108:111]
    ds_read_b64_tr_b16 a[210:211], v228 offset:4608
    v_and_b32 v31, 0xffff0000, v31
    v_mul_f32 v30, v30, v51
    v_mfma_f32_16x16x32_bf16 v[112:115], v[160:163], a[200:203], v[112:115]
    ds_read_b64_tr_b16 a[212:213], v229 offset:4096
    ds_read_b64_tr_b16 a[214:215], v229 offset:4608
    v_mul_f32 v31, v31, v51
    v_cvt_pk_bf16_f32 v7, v30, v31
    v_mfma_f32_16x16x32_bf16 v[116:119], v[164:167], a[200:203], v[116:119]
    ds_read_b64_tr_b16 a[216:217], v230 offset:4096
    s_add_u32 m0, s34, 32768
    s_add_u32 s37, s84, 65536
    buffer_load_dwordx4 v232, s[44:47], s37 offen lds
    v_mfma_f32_16x16x32_bf16 v[120:123], v[160:163], a[204:207], v[120:123]
    ds_read_b64_tr_b16 a[218:219], v230 offset:4608
    ds_read_b64_tr_b16 a[220:221], v231 offset:4096
    v_sub_f32 v32, v32, v50
    v_mfma_f32_16x16x32_bf16 v[124:127], v[164:167], a[204:207], v[124:127]
    ds_read_b64_tr_b16 a[222:223], v231 offset:4608
    buffer_load_dwordx4 v233, s[44:47], s37 offen offset:1024 lds
    v_sub_f32 v33, v33, v50
    v_mfma_f32_16x16x32_bf16 v[128:131], v[168:171], a[192:195], v[128:131]
    v_cvt_pk_bf16_f32 v33, v32, v33
    v_lshlrev_b32 v32, 16, v33
    v_and_b32 v33, 0xffff0000, v33
    v_mfma_f32_16x16x32_bf16 v[132:135], v[172:175], a[192:195], v[132:135]
    s_add_u32 m0, s34, 40960
    s_add_u32 s37, s85, 65536
    buffer_load_dwordx4 v232, s[44:47], s37 offen lds
    v_mfma_f32_16x16x32_bf16 v[136:139], v[168:171], a[196:199], v[136:139]
    v_mul_f32 v32, v32, v51
    v_mul_f32 v33, v33, v51
    v_cvt_pk_bf16_f32 v8, v32, v33
    v_mfma_f32_16x16x32_bf16 v[140:143], v[172:175], a[196:199], v[140:143]
    buffer_load_dwordx4 v233, s[44:47], s37 offen offset:1024 lds
    v_sub_f32 v34, v34, v50
    v_sub_f32 v35, v35, v50
    v_mfma_f32_16x16x32_bf16 v[144:147], v[168:171], a[200:203], v[144:147]
    v_cvt_pk_bf16_f32 v35, v34, v35
    v_lshlrev_b32 v34, 16, v35
    v_mfma_f32_16x16x32_bf16 v[148:151], v[172:175], a[200:203], v[148:151]
    v_and_b32 v35, 0xffff0000, v35
    v_mul_f32 v34, v34, v51
    v_mul_f32 v35, v35, v51
    v_mfma_f32_16x16x32_bf16 v[152:155], v[168:171], a[204:207], v[152:155]
    v_cvt_pk_bf16_f32 v9, v34, v35
    v_sub_f32 v36, v36, v50
    v_mfma_f32_16x16x32_bf16 v[156:159], v[172:175], a[204:207], v[156:159]
    v_sub_f32 v37, v37, v50
    v_cvt_pk_bf16_f32 v37, v36, v37
    s_waitcnt vmcnt(10) lgkmcnt(0)
    v_mfma_f32_16x16x32_bf16 v[96:99], v[176:179], a[208:211], v[96:99]
    ds_read_b128 v[160:163], v224 offset:57344
    ds_read_b128 v[164:167], v224 offset:59392
    v_lshlrev_b32 v36, 16, v37
    v_mfma_f32_16x16x32_bf16 v[100:103], v[180:183], a[208:211], v[100:103]
    ds_read_b128 v[168:171], v224 offset:61440
    v_and_b32 v37, 0xffff0000, v37
    v_mul_f32 v36, v36, v51
    v_mfma_f32_16x16x32_bf16 v[104:107], v[176:179], a[212:215], v[104:107]
    ds_read_b128 v[172:175], v224 offset:63488
    ds_read_b64_tr_b16 a[224:225], v228 offset:8192
    v_mul_f32 v37, v37, v51
    v_cvt_pk_bf16_f32 v10, v36, v37
    v_mfma_f32_16x16x32_bf16 v[108:111], v[180:183], a[212:215], v[108:111]
    ds_read_b64_tr_b16 a[226:227], v228 offset:8704
    v_sub_f32 v38, v38, v50
    v_mfma_f32_16x16x32_bf16 v[112:115], v[176:179], a[216:219], v[112:115]
    ds_read_b64_tr_b16 a[228:229], v229 offset:8192
    ds_read_b64_tr_b16 a[230:231], v229 offset:8704
    v_sub_f32 v39, v39, v50
    v_cvt_pk_bf16_f32 v39, v38, v39
    v_mfma_f32_16x16x32_bf16 v[116:119], v[180:183], a[216:219], v[116:119]
    ds_read_b64_tr_b16 a[232:233], v230 offset:8192
    v_lshlrev_b32 v38, 16, v39
    v_and_b32 v39, 0xffff0000, v39
    v_mfma_f32_16x16x32_bf16 v[120:123], v[176:179], a[220:223], v[120:123]
    ds_read_b64_tr_b16 a[234:235], v230 offset:8704
    ds_read_b64_tr_b16 a[236:237], v231 offset:8192
    v_mul_f32 v38, v38, v51
    v_mfma_f32_16x16x32_bf16 v[124:127], v[180:183], a[220:223], v[124:127]
    ds_read_b64_tr_b16 a[238:239], v231 offset:8704
    v_mul_f32 v39, v39, v51
    v_cvt_pk_bf16_f32 v11, v38, v39
    v_mfma_f32_16x16x32_bf16 v[128:131], v[184:187], a[208:211], v[128:131]
    v_sub_f32 v40, v40, v50
    v_sub_f32 v41, v41, v50
    v_mfma_f32_16x16x32_bf16 v[132:135], v[188:191], a[208:211], v[132:135]
    v_cvt_pk_bf16_f32 v41, v40, v41
    v_lshlrev_b32 v40, 16, v41
    v_and_b32 v41, 0xffff0000, v41
    v_mfma_f32_16x16x32_bf16 v[136:139], v[184:187], a[212:215], v[136:139]
    v_mul_f32 v40, v40, v51
    v_mul_f32 v41, v41, v51
    v_mfma_f32_16x16x32_bf16 v[140:143], v[188:191], a[212:215], v[140:143]
    v_cvt_pk_bf16_f32 v12, v40, v41
    v_sub_f32 v42, v42, v50
    v_sub_f32 v43, v43, v50
    v_mfma_f32_16x16x32_bf16 v[144:147], v[184:187], a[216:219], v[144:147]
    v_cvt_pk_bf16_f32 v43, v42, v43
    v_lshlrev_b32 v42, 16, v43
    v_mfma_f32_16x16x32_bf16 v[148:151], v[188:191], a[216:219], v[148:151]
    v_and_b32 v43, 0xffff0000, v43
    v_mul_f32 v42, v42, v51
    v_mul_f32 v43, v43, v51
    v_mfma_f32_16x16x32_bf16 v[152:155], v[184:187], a[220:223], v[152:155]
    v_cvt_pk_bf16_f32 v13, v42, v43
    v_sub_f32 v44, v44, v50
    v_mfma_f32_16x16x32_bf16 v[156:159], v[188:191], a[220:223], v[156:159]
    v_sub_f32 v45, v45, v50
    v_cvt_pk_bf16_f32 v45, v44, v45
    s_waitcnt lgkmcnt(0)
    v_mfma_f32_16x16x32_bf16 v[96:99], v[160:163], a[224:227], v[96:99]
    ds_read_b128 v[176:179], v225 offset:57344
    ds_read_b128 v[180:183], v225 offset:59392
    v_lshlrev_b32 v44, 16, v45
    v_and_b32 v45, 0xffff0000, v45
    v_mfma_f32_16x16x32_bf16 v[100:103], v[164:167], a[224:227], v[100:103]
    ds_read_b128 v[184:187], v225 offset:61440
    v_mul_f32 v44, v44, v51
    v_mul_f32 v45, v45, v51
    v_mfma_f32_16x16x32_bf16 v[104:107], v[160:163], a[228:231], v[104:107]
    ds_read_b128 v[188:191], v225 offset:63488
    ds_read_b64_tr_b16 a[240:241], v228 offset:12288
    v_cvt_pk_bf16_f32 v14, v44, v45
    v_mfma_f32_16x16x32_bf16 v[108:111], v[164:167], a[228:231], v[108:111]
    ds_read_b64_tr_b16 a[242:243], v228 offset:12800
    v_sub_f32 v46, v46, v50
    v_sub_f32 v47, v47, v50
    v_mfma_f32_16x16x32_bf16 v[112:115], v[160:163], a[232:235], v[112:115]
    ds_read_b64_tr_b16 a[244:245], v229 offset:12288
    ds_read_b64_tr_b16 a[246:247], v229 offset:12800
    v_cvt_pk_bf16_f32 v47, v46, v47
    v_mfma_f32_16x16x32_bf16 v[116:119], v[164:167], a[232:235], v[116:119]
    ds_read_b64_tr_b16 a[248:249], v230 offset:12288
    v_lshlrev_b32 v46, 16, v47
    v_and_b32 v47, 0xffff0000, v47
    v_mfma_f32_16x16x32_bf16 v[120:123], v[160:163], a[236:239], v[120:123]
    ds_read_b64_tr_b16 a[250:251], v230 offset:12800
    ds_read_b64_tr_b16 a[252:253], v231 offset:12288
    v_mul_f32 v46, v46, v51
    v_mfma_f32_16x16x32_bf16 v[124:127], v[164:167], a[236:239], v[124:127]
    ds_read_b64_tr_b16 a[254:255], v231 offset:12800
    v_mul_f32 v47, v47, v51
    v_cvt_pk_bf16_f32 v15, v46, v47
    v_mfma_f32_16x16x32_bf16 v[128:131], v[168:171], a[224:227], v[128:131]
    v_mfma_f32_16x16x32_bf16 v[132:135], v[172:175], a[224:227], v[132:135]
    ds_write_b128 v237, v[0:3] offset:0
    v_mfma_f32_16x16x32_bf16 v[136:139], v[168:171], a[228:231], v[136:139]
    ds_write_b128 v237, v[4:7] offset:4096
    v_mfma_f32_16x16x32_bf16 v[140:143], v[172:175], a[228:231], v[140:143]
    ds_write_b128 v237, v[8:11] offset:24576
    v_mfma_f32_16x16x32_bf16 v[144:147], v[168:171], a[232:235], v[144:147]
    ds_write_b128 v237, v[12:15] offset:28672
    v_mfma_f32_16x16x32_bf16 v[148:151], v[172:175], a[232:235], v[148:151]
    v_mfma_f32_16x16x32_bf16 v[152:155], v[168:171], a[236:239], v[152:155]
    v_mfma_f32_16x16x32_bf16 v[156:159], v[172:175], a[236:239], v[156:159]
    s_waitcnt vmcnt(18) lgkmcnt(0)
    s_barrier
    v_mfma_f32_16x16x32_bf16 v[96:99], v[176:179], a[240:243], v[96:99]
    ds_read_b128 v[160:163], v224 offset:0
    v_mfma_f32_16x16x32_bf16 v[100:103], v[180:183], a[240:243], v[100:103]
    ds_read_b128 v[164:167], v224 offset:2048
    v_mfma_f32_16x16x32_bf16 v[104:107], v[176:179], a[244:247], v[104:107]
    ds_read_b128 v[168:171], v224 offset:4096
    v_mfma_f32_16x16x32_bf16 v[108:111], v[180:183], a[244:247], v[108:111]
    ds_read_b128 v[172:175], v224 offset:6144
    v_mfma_f32_16x16x32_bf16 v[112:115], v[176:179], a[248:251], v[112:115]
    v_lshlrev_b32 v237, 4, v253
    v_add_u32 v237, 81920, v237
    ds_read_b128 v[16:19], v237 offset:0
    ds_read_b128 v[20:23], v237 offset:4096
    ds_read_b128 v[24:27], v237 offset:24576
    ds_read_b128 v[28:31], v237 offset:28672
    v_mfma_f32_16x16x32_bf16 v[116:119], v[180:183], a[248:251], v[116:119]
    s_add_u32 m0, s34, 49152
    s_add_u32 s37, s86, 65536
    buffer_load_dwordx4 v232, s[44:47], s37 offen lds
    v_mfma_f32_16x16x32_bf16 v[120:123], v[176:179], a[252:255], v[120:123]
    v_mfma_f32_16x16x32_bf16 v[124:127], v[180:183], a[252:255], v[124:127]
    buffer_load_dwordx4 v233, s[44:47], s37 offen offset:1024 lds
    v_mfma_f32_16x16x32_bf16 v[128:131], v[184:187], a[240:243], v[128:131]
    v_mfma_f32_16x16x32_bf16 v[132:135], v[188:191], a[240:243], v[132:135]
    s_add_u32 m0, s34, 57344
    s_add_u32 s37, s87, 65536
    buffer_load_dwordx4 v232, s[44:47], s37 offen lds
    v_cvt_pk_bf16_f32 v64, v96, v97
    v_cvt_pk_bf16_f32 v65, v98, v99
    v_mfma_f32_16x16x32_bf16 v[136:139], v[184:187], a[244:247], v[136:139]
    v_cvt_pk_bf16_f32 v66, v100, v101
    v_cvt_pk_bf16_f32 v67, v102, v103
    v_mfma_f32_16x16x32_bf16 v[140:143], v[188:191], a[244:247], v[140:143]
    buffer_load_dwordx4 v233, s[44:47], s37 offen offset:1024 lds
    v_cvt_pk_bf16_f32 v68, v104, v105
    v_cvt_pk_bf16_f32 v69, v106, v107
    v_mfma_f32_16x16x32_bf16 v[144:147], v[184:187], a[248:251], v[144:147]
    v_cvt_pk_bf16_f32 v70, v108, v109
    v_cvt_pk_bf16_f32 v71, v110, v111
    v_mfma_f32_16x16x32_bf16 v[148:151], v[188:191], a[248:251], v[148:151]
    v_cvt_pk_bf16_f32 v72, v112, v113
    v_cvt_pk_bf16_f32 v73, v114, v115
    v_mfma_f32_16x16x32_bf16 v[152:155], v[184:187], a[252:255], v[152:155]
    v_cvt_pk_bf16_f32 v74, v116, v117
    v_cvt_pk_bf16_f32 v75, v118, v119
    v_mfma_f32_16x16x32_bf16 v[156:159], v[188:191], a[252:255], v[156:159]
    v_cvt_pk_bf16_f32 v76, v120, v121
    v_cvt_pk_bf16_f32 v77, v122, v123
    s_waitcnt lgkmcnt(0)
    v_mfma_f32_16x16x32_bf16 v[96:99], v[160:163], a[0:3], 0
    ds_read_b128 v[176:179], v225 offset:0
    v_cvt_pk_bf16_f32 v78, v124, v125
    v_cvt_pk_bf16_f32 v79, v126, v127
    v_mfma_f32_16x16x32_bf16 v[100:103], v[164:167], a[0:3], 0
    ds_read_b128 v[180:183], v225 offset:2048
    v_cvt_pk_bf16_f32 v80, v128, v129
    v_cvt_pk_bf16_f32 v81, v130, v131
    v_mfma_f32_16x16x32_bf16 v[104:107], v[160:163], a[4:7], 0
    ds_read_b128 v[184:187], v225 offset:4096
    v_cvt_pk_bf16_f32 v82, v132, v133
    v_cvt_pk_bf16_f32 v83, v134, v135
    v_mfma_f32_16x16x32_bf16 v[108:111], v[164:167], a[4:7], 0
    ds_read_b128 v[188:191], v225 offset:6144
    v_cvt_pk_bf16_f32 v84, v136, v137
    v_cvt_pk_bf16_f32 v85, v138, v139
    v_mfma_f32_16x16x32_bf16 v[112:115], v[160:163], a[8:11], 0
    v_cvt_pk_bf16_f32 v86, v140, v141
    v_cvt_pk_bf16_f32 v87, v142, v143
    s_mov_b32 s39, 0
    buffer_store_dwordx4 v[16:19], v238, s[8:11], s39 offen sc1
    v_mfma_f32_16x16x32_bf16 v[116:119], v[164:167], a[8:11], 0
    v_cvt_pk_bf16_f32 v88, v144, v145
    v_cvt_pk_bf16_f32 v89, v146, v147
    v_mfma_f32_16x16x32_bf16 v[120:123], v[160:163], a[12:15], 0
    v_cvt_pk_bf16_f32 v90, v148, v149
    v_cvt_pk_bf16_f32 v91, v150, v151
    v_mfma_f32_16x16x32_bf16 v[124:127], v[164:167], a[12:15], 0
    v_cvt_pk_bf16_f32 v92, v152, v153
    v_cvt_pk_bf16_f32 v93, v154, v155
    v_mfma_f32_16x16x32_bf16 v[128:131], v[168:171], a[0:3], 0
    v_cvt_pk_bf16_f32 v94, v156, v157
    v_cvt_pk_bf16_f32 v95, v158, v159
    v_mfma_f32_16x16x32_bf16 v[132:135], v[172:175], a[0:3], 0
    v_mfma_f32_16x16x32_bf16 v[136:139], v[168:171], a[4:7], 0
    v_mfma_f32_16x16x32_bf16 v[140:143], v[172:175], a[4:7], 0
    v_mfma_f32_16x16x32_bf16 v[144:147], v[168:171], a[8:11], 0
    v_mfma_f32_16x16x32_bf16 v[148:151], v[172:175], a[8:11], 0
    v_mfma_f32_16x16x32_bf16 v[152:155], v[168:171], a[12:15], 0
    v_mfma_f32_16x16x32_bf16 v[156:159], v[172:175], a[12:15], 0
    s_waitcnt lgkmcnt(0)
    v_mfma_f32_16x16x32_bf16 v[96:99], v[176:179], a[16:19], v[96:99]
    ds_read_b128 v[160:163], v224 offset:8192
    v_mfma_f32_16x16x32_bf16 v[100:103], v[180:183], a[16:19], v[100:103]
    ds_read_b128 v[164:167], v224 offset:10240
    v_mfma_f32_16x16x32_bf16 v[104:107], v[176:179], a[20:23], v[104:107]
    ds_read_b128 v[168:171], v224 offset:12288
    v_mfma_f32_16x16x32_bf16 v[108:111], v[180:183], a[20:23], v[108:111]
    ds_read_b128 v[172:175], v224 offset:14336
    v_mfma_f32_16x16x32_bf16 v[112:115], v[176:179], a[24:27], v[112:115]
    v_mfma_f32_16x16x32_bf16 v[116:119], v[180:183], a[24:27], v[116:119]
    v_mfma_f32_16x16x32_bf16 v[120:123], v[176:179], a[28:31], v[120:123]
    v_mfma_f32_16x16x32_bf16 v[124:127], v[180:183], a[28:31], v[124:127]
    v_mfma_f32_16x16x32_bf16 v[128:131], v[184:187], a[16:19], v[128:131]
    v_mfma_f32_16x16x32_bf16 v[132:135], v[188:191], a[16:19], v[132:135]
    v_mfma_f32_16x16x32_bf16 v[136:139], v[184:187], a[20:23], v[136:139]
    s_mov_b32 s39, 16384
    buffer_store_dwordx4 v[20:23], v238, s[8:11], s39 offen sc1
    v_mfma_f32_16x16x32_bf16 v[140:143], v[188:191], a[20:23], v[140:143]
    v_mfma_f32_16x16x32_bf16 v[144:147], v[184:187], a[24:27], v[144:147]
    v_mfma_f32_16x16x32_bf16 v[148:151], v[188:191], a[24:27], v[148:151]
    v_mfma_f32_16x16x32_bf16 v[152:155], v[184:187], a[28:31], v[152:155]
    v_mfma_f32_16x16x32_bf16 v[156:159], v[188:191], a[28:31], v[156:159]
    s_waitcnt lgkmcnt(0)
    v_mfma_f32_16x16x32_bf16 v[96:99], v[160:163], a[32:35], v[96:99]
    ds_read_b128 v[176:179], v225 offset:8192
    v_mfma_f32_16x16x32_bf16 v[100:103], v[164:167], a[32:35], v[100:103]
    ds_read_b128 v[180:183], v225 offset:10240
    v_mfma_f32_16x16x32_bf16 v[104:107], v[160:163], a[36:39], v[104:107]
    ds_read_b128 v[184:187], v225 offset:12288
    v_mfma_f32_16x16x32_bf16 v[108:111], v[164:167], a[36:39], v[108:111]
    ds_read_b128 v[188:191], v225 offset:14336
    v_mfma_f32_16x16x32_bf16 v[112:115], v[160:163], a[40:43], v[112:115]
    s_mul_i32 s37, s2, 100
    v_mfma_f32_16x16x32_bf16 v[116:119], v[164:167], a[40:43], v[116:119]
    v_lshl_add_u32 v60, v253, 2, s37
    v_cmp_gt_u32 vcc, 25, v253
    v_mfma_f32_16x16x32_bf16 v[120:123], v[160:163], a[44:47], v[120:123]
    v_mov_b32 v61, 0
    v_mfma_f32_16x16x32_bf16 v[124:127], v[164:167], a[44:47], v[124:127]
    v_mov_b32 v62, 0x7ffffff0
    v_cndmask_b32 v60, v62, v60, vcc
    v_mfma_f32_16x16x32_bf16 v[128:131], v[168:171], a[32:35], v[128:131]
    buffer_store_dword v61, v60, s[56:59], 0 offen sc1
    v_mfma_f32_16x16x32_bf16 v[132:135], v[172:175], a[32:35], v[132:135]
    s_add_u32 s56, s56, 0x20000
    s_addc_u32 s57, s57, 0
    v_mfma_f32_16x16x32_bf16 v[136:139], v[168:171], a[36:39], v[136:139]
    s_mov_b32 s58, 0x23000
    s_lshl2_add_u32 s37, s2, s3
    v_mfma_f32_16x16x32_bf16 v[140:143], v[172:175], a[36:39], v[140:143]
    s_lshl_b32 s37, s37, 7
    v_mfma_f32_16x16x32_bf16 v[144:147], v[168:171], a[40:43], v[144:147]
    buffer_store_dword v61, off, s[56:59], s37 sc1
    s_add_u32 s37, s37, 0x20000
    v_mfma_f32_16x16x32_bf16 v[148:151], v[172:175], a[40:43], v[148:151]
    buffer_store_dword v61, off, s[56:59], s37 sc1
    v_mfma_f32_16x16x32_bf16 v[152:155], v[168:171], a[44:47], v[152:155]
    v_mfma_f32_16x16x32_bf16 v[156:159], v[172:175], a[44:47], v[156:159]
    s_waitcnt vmcnt(9) lgkmcnt(0)
    s_barrier
    v_mfma_f32_16x16x32_bf16 v[96:99], v[176:179], a[48:51], v[96:99]
    ds_read_b128 v[160:163], v224 offset:16384
    s_mov_b32 s39, 32768
    buffer_store_dwordx4 v[24:27], v238, s[8:11], s39 offen sc1
    v_mfma_f32_16x16x32_bf16 v[100:103], v[180:183], a[48:51], v[100:103]
    ds_read_b128 v[164:167], v224 offset:18432
    v_mfma_f32_16x16x32_bf16 v[104:107], v[176:179], a[52:55], v[104:107]
    ds_read_b128 v[168:171], v224 offset:20480
    v_mfma_f32_16x16x32_bf16 v[108:111], v[180:183], a[52:55], v[108:111]
    ds_read_b128 v[172:175], v224 offset:22528
    v_mfma_f32_16x16x32_bf16 v[112:115], v[176:179], a[56:59], v[112:115]
    v_mfma_f32_16x16x32_bf16 v[116:119], v[180:183], a[56:59], v[116:119]
    s_add_u32 m0, s34, 98304
    s_add_u32 s37, s80, 131072
    buffer_load_dwordx4 v232, s[44:47], s37 offen lds
    v_mfma_f32_16x16x32_bf16 v[120:123], v[176:179], a[60:63], v[120:123]
    v_mfma_f32_16x16x32_bf16 v[124:127], v[180:183], a[60:63], v[124:127]
    buffer_load_dwordx4 v233, s[44:47], s37 offen offset:1024 lds
    v_mfma_f32_16x16x32_bf16 v[128:131], v[184:187], a[48:51], v[128:131]
    v_mfma_f32_16x16x32_bf16 v[132:135], v[188:191], a[48:51], v[132:135]
    v_mfma_f32_16x16x32_bf16 v[136:139], v[184:187], a[52:55], v[136:139]
    v_mfma_f32_16x16x32_bf16 v[140:143], v[188:191], a[52:55], v[140:143]
    v_mfma_f32_16x16x32_bf16 v[144:147], v[184:187], a[56:59], v[144:147]
    v_mfma_f32_16x16x32_bf16 v[148:151], v[188:191], a[56:59], v[148:151]
    v_mfma_f32_16x16x32_bf16 v[152:155], v[184:187], a[60:63], v[152:155]
    v_mfma_f32_16x16x32_bf16 v[156:159], v[188:191], a[60:63], v[156:159]
    s_waitcnt lgkmcnt(0)
    v_mfma_f32_16x16x32_bf16 v[96:99], v[160:163], a[64:67], v[96:99]
    ds_read_b128 v[176:179], v225 offset:16384
    v_mfma_f32_16x16x32_bf16 v[100:103], v[164:167], a[64:67], v[100:103]
    ds_read_b128 v[180:183], v225 offset:18432
    v_mfma_f32_16x16x32_bf16 v[104:107], v[160:163], a[68:71], v[104:107]
    ds_read_b128 v[184:187], v225 offset:20480
    v_mfma_f32_16x16x32_bf16 v[108:111], v[164:167], a[68:71], v[108:111]
    ds_read_b128 v[188:191], v225 offset:22528
    v_mfma_f32_16x16x32_bf16 v[112:115], v[160:163], a[72:75], v[112:115]
    v_mfma_f32_16x16x32_bf16 v[116:119], v[164:167], a[72:75], v[116:119]
    s_add_u32 m0, s34, 106496
    s_add_u32 s37, s81, 131072
    buffer_load_dwordx4 v232, s[44:47], s37 offen lds
    v_mfma_f32_16x16x32_bf16 v[120:123], v[160:163], a[76:79], v[120:123]
    s_mov_b32 s39, 49152
    buffer_store_dwordx4 v[28:31], v238, s[8:11], s39 offen sc1
    v_mfma_f32_16x16x32_bf16 v[124:127], v[164:167], a[76:79], v[124:127]
    buffer_load_dwordx4 v233, s[44:47], s37 offen offset:1024 lds
    v_mfma_f32_16x16x32_bf16 v[128:131], v[168:171], a[64:67], v[128:131]
    v_mfma_f32_16x16x32_bf16 v[132:135], v[172:175], a[64:67], v[132:135]
    v_mfma_f32_16x16x32_bf16 v[136:139], v[168:171], a[68:71], v[136:139]
    v_mfma_f32_16x16x32_bf16 v[140:143], v[172:175], a[68:71], v[140:143]
    v_mfma_f32_16x16x32_bf16 v[144:147], v[168:171], a[72:75], v[144:147]
    v_mfma_f32_16x16x32_bf16 v[148:151], v[172:175], a[72:75], v[148:151]
    v_mfma_f32_16x16x32_bf16 v[152:155], v[168:171], a[76:79], v[152:155]
    v_mfma_f32_16x16x32_bf16 v[156:159], v[172:175], a[76:79], v[156:159]
    s_waitcnt lgkmcnt(0)
    v_mfma_f32_16x16x32_bf16 v[96:99], v[176:179], a[80:83], v[96:99]
    ds_read_b128 v[160:163], v224 offset:24576
    v_mfma_f32_16x16x32_bf16 v[100:103], v[180:183], a[80:83], v[100:103]
    ds_read_b128 v[164:167], v224 offset:26624
    v_mfma_f32_16x16x32_bf16 v[104:107], v[176:179], a[84:87], v[104:107]
    ds_read_b128 v[168:171], v224 offset:28672
    v_mfma_f32_16x16x32_bf16 v[108:111], v[180:183], a[84:87], v[108:111]
    ds_read_b128 v[172:175], v224 offset:30720
    v_mfma_f32_16x16x32_bf16 v[112:115], v[176:179], a[88:91], v[112:115]
    v_mfma_f32_16x16x32_bf16 v[116:119], v[180:183], a[88:91], v[116:119]
    v_mfma_f32_16x16x32_bf16 v[120:123], v[176:179], a[92:95], v[120:123]
    v_mfma_f32_16x16x32_bf16 v[124:127], v[180:183], a[92:95], v[124:127]
    v_mfma_f32_16x16x32_bf16 v[128:131], v[184:187], a[80:83], v[128:131]
    v_mfma_f32_16x16x32_bf16 v[132:135], v[188:191], a[80:83], v[132:135]
    v_mfma_f32_16x16x32_bf16 v[136:139], v[184:187], a[84:87], v[136:139]
    v_mfma_f32_16x16x32_bf16 v[140:143], v[188:191], a[84:87], v[140:143]
    v_mfma_f32_16x16x32_bf16 v[144:147], v[184:187], a[88:91], v[144:147]
    s_add_u32 s38, s36, 0
    buffer_store_dwordx4 v[64:67], v240, s[16:19], s38 offen offset:0 sc1
    v_mfma_f32_16x16x32_bf16 v[148:151], v[188:191], a[88:91], v[148:151]
    v_mfma_f32_16x16x32_bf16 v[152:155], v[184:187], a[92:95], v[152:155]
    v_mfma_f32_16x16x32_bf16 v[156:159], v[188:191], a[92:95], v[156:159]
    s_waitcnt lgkmcnt(0)
    v_mfma_f32_16x16x32_bf16 v[96:99], v[160:163], a[96:99], v[96:99]
    ds_read_b128 v[176:179], v225 offset:24576
    v_mfma_f32_16x16x32_bf16 v[100:103], v[164:167], a[96:99], v[100:103]
    ds_read_b128 v[180:183], v225 offset:26624
    v_mfma_f32_16x16x32_bf16 v[104:107], v[160:163], a[100:103], v[104:107]
    ds_read_b128 v[184:187], v225 offset:28672
    v_mfma_f32_16x16x32_bf16 v[108:111], v[164:167], a[100:103], v[108:111]
    ds_read_b128 v[188:191], v225 offset:30720
    v_mfma_f32_16x16x32_bf16 v[112:115], v[160:163], a[104:107], v[112:115]
    v_mfma_f32_16x16x32_bf16 v[116:119], v[164:167], a[104:107], v[116:119]
    s_add_u32 m0, s34, 114688
    s_add_u32 s37, s82, 131072
    buffer_load_dwordx4 v232, s[44:47], s37 offen lds
    v_mfma_f32_16x16x32_bf16 v[120:123], v[160:163], a[108:111], v[120:123]
    v_mfma_f32_16x16x32_bf16 v[124:127], v[164:167], a[108:111], v[124:127]
    buffer_load_dwordx4 v233, s[44:47], s37 offen offset:1024 lds
    v_mfma_f32_16x16x32_bf16 v[128:131], v[168:171], a[96:99], v[128:131]
    v_mfma_f32_16x16x32_bf16 v[132:135], v[172:175], a[96:99], v[132:135]
    v_mfma_f32_16x16x32_bf16 v[136:139], v[168:171], a[100:103], v[136:139]
    v_mfma_f32_16x16x32_bf16 v[140:143], v[172:175], a[100:103], v[140:143]
    v_mfma_f32_16x16x32_bf16 v[144:147], v[168:171], a[104:107], v[144:147]
    v_mfma_f32_16x16x32_bf16 v[148:151], v[172:175], a[104:107], v[148:151]
    v_mfma_f32_16x16x32_bf16 v[152:155], v[168:171], a[108:111], v[152:155]
    v_mfma_f32_16x16x32_bf16 v[156:159], v[172:175], a[108:111], v[156:159]
    s_waitcnt lgkmcnt(0)
    v_mfma_f32_16x16x32_bf16 v[96:99], v[176:179], a[112:115], v[96:99]
    ds_read_b128 v[160:163], v224 offset:32768
    v_mfma_f32_16x16x32_bf16 v[100:103], v[180:183], a[112:115], v[100:103]
    ds_read_b128 v[164:167], v224 offset:34816
    v_mfma_f32_16x16x32_bf16 v[104:107], v[176:179], a[116:119], v[104:107]
    ds_read_b128 v[168:171], v224 offset:36864
    s_add_u32 s38, s36, 0
    buffer_store_dwordx4 v[68:71], v240, s[16:19], s38 offen offset:1024 sc1
    v_mfma_f32_16x16x32_bf16 v[108:111], v[180:183], a[116:119], v[108:111]
    ds_read_b128 v[172:175], v224 offset:38912
    v_mfma_f32_16x16x32_bf16 v[112:115], v[176:179], a[120:123], v[112:115]
    v_mfma_f32_16x16x32_bf16 v[116:119], v[180:183], a[120:123], v[116:119]
    s_add_u32 m0, s34, 122880
    s_add_u32 s37, s83, 131072
    buffer_load_dwordx4 v232, s[44:47], s37 offen lds
    v_mfma_f32_16x16x32_bf16 v[120:123], v[176:179], a[124:127], v[120:123]
    v_mfma_f32_16x16x32_bf16 v[124:127], v[180:183], a[124:127], v[124:127]
    buffer_load_dwordx4 v233, s[44:47], s37 offen offset:1024 lds
    v_mfma_f32_16x16x32_bf16 v[128:131], v[184:187], a[112:115], v[128:131]
    v_mfma_f32_16x16x32_bf16 v[132:135], v[188:191], a[112:115], v[132:135]
    v_mfma_f32_16x16x32_bf16 v[136:139], v[184:187], a[116:119], v[136:139]
    v_mfma_f32_16x16x32_bf16 v[140:143], v[188:191], a[116:119], v[140:143]
    v_mfma_f32_16x16x32_bf16 v[144:147], v[184:187], a[120:123], v[144:147]
    v_mfma_f32_16x16x32_bf16 v[148:151], v[188:191], a[120:123], v[148:151]
    v_mfma_f32_16x16x32_bf16 v[152:155], v[184:187], a[124:127], v[152:155]
    v_mfma_f32_16x16x32_bf16 v[156:159], v[188:191], a[124:127], v[156:159]
    s_waitcnt lgkmcnt(0)
    v_mfma_f32_16x16x32_bf16 v[96:99], v[160:163], a[128:131], v[96:99]
    ds_read_b128 v[176:179], v225 offset:32768
    v_mfma_f32_16x16x32_bf16 v[100:103], v[164:167], a[128:131], v[100:103]
    ds_read_b128 v[180:183], v225 offset:34816
    v_mfma_f32_16x16x32_bf16 v[104:107], v[160:163], a[132:135], v[104:107]
    ds_read_b128 v[184:187], v225 offset:36864
    v_mfma_f32_16x16x32_bf16 v[108:111], v[164:167], a[132:135], v[108:111]
    ds_read_b128 v[188:191], v225 offset:38912
    v_mfma_f32_16x16x32_bf16 v[112:115], v[160:163], a[136:139], v[112:115]
    v_mfma_f32_16x16x32_bf16 v[116:119], v[164:167], a[136:139], v[116:119]
    v_mfma_f32_16x16x32_bf16 v[120:123], v[160:163], a[140:143], v[120:123]
    v_mfma_f32_16x16x32_bf16 v[124:127], v[164:167], a[140:143], v[124:127]
    v_mfma_f32_16x16x32_bf16 v[128:131], v[168:171], a[128:131], v[128:131]
    s_add_u32 s38, s36, 0
    buffer_store_dwordx4 v[72:75], v240, s[16:19], s38 offen offset:2048 sc1
    v_mfma_f32_16x16x32_bf16 v[132:135], v[172:175], a[128:131], v[132:135]
    v_mfma_f32_16x16x32_bf16 v[136:139], v[168:171], a[132:135], v[136:139]
    v_mfma_f32_16x16x32_bf16 v[140:143], v[172:175], a[132:135], v[140:143]
    v_mfma_f32_16x16x32_bf16 v[144:147], v[168:171], a[136:139], v[144:147]
    v_mfma_f32_16x16x32_bf16 v[148:151], v[172:175], a[136:139], v[148:151]
    v_mfma_f32_16x16x32_bf16 v[152:155], v[168:171], a[140:143], v[152:155]
    v_mfma_f32_16x16x32_bf16 v[156:159], v[172:175], a[140:143], v[156:159]
    s_waitcnt lgkmcnt(0)
    v_mfma_f32_16x16x32_bf16 v[96:99], v[176:179], a[144:147], v[96:99]
    ds_read_b128 v[160:163], v224 offset:40960
    v_mfma_f32_16x16x32_bf16 v[100:103], v[180:183], a[144:147], v[100:103]
    ds_read_b128 v[164:167], v224 offset:43008
    v_mfma_f32_16x16x32_bf16 v[104:107], v[176:179], a[148:151], v[104:107]
    ds_read_b128 v[168:171], v224 offset:45056
    v_mfma_f32_16x16x32_bf16 v[108:111], v[180:183], a[148:151], v[108:111]
    ds_read_b128 v[172:175], v224 offset:47104
    v_mfma_f32_16x16x32_bf16 v[112:115], v[176:179], a[152:155], v[112:115]
    v_mfma_f32_16x16x32_bf16 v[116:119], v[180:183], a[152:155], v[116:119]
    s_add_u32 m0, s34, 131072
    s_add_u32 s37, s84, 131072
    buffer_load_dwordx4 v232, s[44:47], s37 offen lds
    v_mfma_f32_16x16x32_bf16 v[120:123], v[176:179], a[156:159], v[120:123]
    v_mfma_f32_16x16x32_bf16 v[124:127], v[180:183], a[156:159], v[124:127]
    buffer_load_dwordx4 v233, s[44:47], s37 offen offset:1024 lds
    v_mfma_f32_16x16x32_bf16 v[128:131], v[184:187], a[144:147], v[128:131]
    v_mfma_f32_16x16x32_bf16 v[132:135], v[188:191], a[144:147], v[132:135]
    v_mfma_f32_16x16x32_bf16 v[136:139], v[184:187], a[148:151], v[136:139]
    v_mfma_f32_16x16x32_bf16 v[140:143], v[188:191], a[148:151], v[140:143]
    v_mfma_f32_16x16x32_bf16 v[144:147], v[184:187], a[152:155], v[144:147]
    v_mfma_f32_16x16x32_bf16 v[148:151], v[188:191], a[152:155], v[148:151]
    v_mfma_f32_16x16x32_bf16 v[152:155], v[184:187], a[156:159], v[152:155]
    s_add_u32 s38, s36, 0
    buffer_store_dwordx4 v[76:79], v240, s[16:19], s38 offen offset:3072 sc1
    v_mfma_f32_16x16x32_bf16 v[156:159], v[188:191], a[156:159], v[156:159]
    s_waitcnt lgkmcnt(0)
    v_mfma_f32_16x16x32_bf16 v[96:99], v[160:163], a[160:163], v[96:99]
    ds_read_b128 v[176:179], v225 offset:40960
    v_mfma_f32_16x16x32_bf16 v[100:103], v[164:167], a[160:163], v[100:103]
    ds_read_b128 v[180:183], v225 offset:43008
    v_mfma_f32_16x16x32_bf16 v[104:107], v[160:163], a[164:167], v[104:107]
    ds_read_b128 v[184:187], v225 offset:45056
    v_mfma_f32_16x16x32_bf16 v[108:111], v[164:167], a[164:167], v[108:111]
    ds_read_b128 v[188:191], v225 offset:47104
    v_mfma_f32_16x16x32_bf16 v[112:115], v[160:163], a[168:171], v[112:115]
    v_mfma_f32_16x16x32_bf16 v[116:119], v[164:167], a[168:171], v[116:119]
    s_add_u32 m0, s34, 139264
    s_add_u32 s37, s85, 131072
    buffer_load_dwordx4 v232, s[44:47], s37 offen lds
    v_mfma_f32_16x16x32_bf16 v[120:123], v[160:163], a[172:175], v[120:123]
    v_mfma_f32_16x16x32_bf16 v[124:127], v[164:167], a[172:175], v[124:127]
    buffer_load_dwordx4 v233, s[44:47], s37 offen offset:1024 lds
    v_mfma_f32_16x16x32_bf16 v[128:131], v[168:171], a[160:163], v[128:131]
    v_mfma_f32_16x16x32_bf16 v[132:135], v[172:175], a[160:163], v[132:135]
    v_mfma_f32_16x16x32_bf16 v[136:139], v[168:171], a[164:167], v[136:139]
    v_mfma_f32_16x16x32_bf16 v[140:143], v[172:175], a[164:167], v[140:143]
    v_mfma_f32_16x16x32_bf16 v[144:147], v[168:171], a[168:171], v[144:147]
    v_mfma_f32_16x16x32_bf16 v[148:151], v[172:175], a[168:171], v[148:151]
    v_mfma_f32_16x16x32_bf16 v[152:155], v[168:171], a[172:175], v[152:155]
    v_mfma_f32_16x16x32_bf16 v[156:159], v[172:175], a[172:175], v[156:159]
    s_waitcnt vmcnt(13) lgkmcnt(0)
    s_barrier
    v_mfma_f32_16x16x32_bf16 v[96:99], v[176:179], a[176:179], v[96:99]
    ds_read_b128 v[160:163], v224 offset:49152
    v_mfma_f32_16x16x32_bf16 v[100:103], v[180:183], a[176:179], v[100:103]
    ds_read_b128 v[164:167], v224 offset:51200
    v_mfma_f32_16x16x32_bf16 v[104:107], v[176:179], a[180:183], v[104:107]
    ds_read_b128 v[168:171], v224 offset:53248
    v_mfma_f32_16x16x32_bf16 v[108:111], v[180:183], a[180:183], v[108:111]
    ds_read_b128 v[172:175], v224 offset:55296
    v_mfma_f32_16x16x32_bf16 v[112:115], v[176:179], a[184:187], v[112:115]
    s_add_u32 s38, s36, 8192
    buffer_store_dwordx4 v[80:83], v240, s[16:19], s38 offen offset:0 sc1
    v_mfma_f32_16x16x32_bf16 v[116:119], v[180:183], a[184:187], v[116:119]
    s_lshl_b32 s39, s5, 2
    buffer_atomic_add v255, v250, s[88:91], s39 offen sc1
    s_cmp_eq_u32 s3, 0
    s_cselect_b32 s39, s39, s43
    v_mfma_f32_16x16x32_bf16 v[120:123], v[176:179], a[188:191], v[120:123]
    v_mfma_f32_16x16x32_bf16 v[124:127], v[180:183], a[188:191], v[124:127]
    v_mfma_f32_16x16x32_bf16 v[128:131], v[184:187], a[176:179], v[128:131]
    v_mfma_f32_16x16x32_bf16 v[132:135], v[188:191], a[176:179], v[132:135]
    v_mfma_f32_16x16x32_bf16 v[136:139], v[184:187], a[180:183], v[136:139]
    v_mfma_f32_16x16x32_bf16 v[140:143], v[188:191], a[180:183], v[140:143]
    v_mfma_f32_16x16x32_bf16 v[144:147], v[184:187], a[184:187], v[144:147]
    v_mfma_f32_16x16x32_bf16 v[148:151], v[188:191], a[184:187], v[148:151]
    v_mfma_f32_16x16x32_bf16 v[152:155], v[184:187], a[188:191], v[152:155]
    v_mfma_f32_16x16x32_bf16 v[156:159], v[188:191], a[188:191], v[156:159]
    s_waitcnt lgkmcnt(0)
    v_mfma_f32_16x16x32_bf16 v[96:99], v[160:163], a[192:195], v[96:99]
    ds_read_b128 v[176:179], v225 offset:49152
    v_mfma_f32_16x16x32_bf16 v[100:103], v[164:167], a[192:195], v[100:103]
    ds_read_b128 v[180:183], v225 offset:51200
    v_mfma_f32_16x16x32_bf16 v[104:107], v[160:163], a[196:199], v[104:107]
    ds_read_b128 v[184:187], v225 offset:53248
    v_mfma_f32_16x16x32_bf16 v[108:111], v[164:167], a[196:199], v[108:111]
    ds_read_b128 v[188:191], v225 offset:55296
    v_mfma_f32_16x16x32_bf16 v[112:115], v[160:163], a[200:203], v[112:115]
    v_mfma_f32_16x16x32_bf16 v[116:119], v[164:167], a[200:203], v[116:119]
    s_add_u32 m0, s34, 147456
    s_add_u32 s37, s86, 131072
    buffer_load_dwordx4 v232, s[44:47], s37 offen lds
    v_mfma_f32_16x16x32_bf16 v[120:123], v[160:163], a[204:207], v[120:123]
    v_mfma_f32_16x16x32_bf16 v[124:127], v[164:167], a[204:207], v[124:127]
    buffer_load_dwordx4 v233, s[44:47], s37 offen offset:1024 lds
    v_mfma_f32_16x16x32_bf16 v[128:131], v[168:171], a[192:195], v[128:131]
    v_mfma_f32_16x16x32_bf16 v[132:135], v[172:175], a[192:195], v[132:135]
    v_mfma_f32_16x16x32_bf16 v[136:139], v[168:171], a[196:199], v[136:139]
    s_add_u32 s38, s36, 8192
    buffer_store_dwordx4 v[84:87], v240, s[16:19], s38 offen offset:1024 sc1
    v_mfma_f32_16x16x32_bf16 v[140:143], v[172:175], a[196:199], v[140:143]
    v_mfma_f32_16x16x32_bf16 v[144:147], v[168:171], a[200:203], v[144:147]
    v_mfma_f32_16x16x32_bf16 v[148:151], v[172:175], a[200:203], v[148:151]
    v_mfma_f32_16x16x32_bf16 v[152:155], v[168:171], a[204:207], v[152:155]
    v_mfma_f32_16x16x32_bf16 v[156:159], v[172:175], a[204:207], v[156:159]
    s_waitcnt lgkmcnt(0)
    v_mfma_f32_16x16x32_bf16 v[96:99], v[176:179], a[208:211], v[96:99]
    ds_read_b128 v[160:163], v224 offset:57344
    v_mfma_f32_16x16x32_bf16 v[100:103], v[180:183], a[208:211], v[100:103]
    ds_read_b128 v[164:167], v224 offset:59392
    v_mfma_f32_16x16x32_bf16 v[104:107], v[176:179], a[212:215], v[104:107]
    ds_read_b128 v[168:171], v224 offset:61440
    v_mfma_f32_16x16x32_bf16 v[108:111], v[180:183], a[212:215], v[108:111]
    ds_read_b128 v[172:175], v224 offset:63488
    v_mfma_f32_16x16x32_bf16 v[112:115], v[176:179], a[216:219], v[112:115]
    v_mfma_f32_16x16x32_bf16 v[116:119], v[180:183], a[216:219], v[116:119]
    s_add_u32 m0, s34, 155648
    s_add_u32 s37, s87, 131072
    buffer_load_dwordx4 v232, s[44:47], s37 offen lds
    v_mfma_f32_16x16x32_bf16 v[120:123], v[176:179], a[220:223], v[120:123]
    v_mfma_f32_16x16x32_bf16 v[124:127], v[180:183], a[220:223], v[124:127]
    buffer_load_dwordx4 v233, s[44:47], s37 offen offset:1024 lds
    v_mfma_f32_16x16x32_bf16 v[128:131], v[184:187], a[208:211], v[128:131]
    v_mfma_f32_16x16x32_bf16 v[132:135], v[188:191], a[208:211], v[132:135]
    v_mfma_f32_16x16x32_bf16 v[136:139], v[184:187], a[212:215], v[136:139]
    v_mfma_f32_16x16x32_bf16 v[140:143], v[188:191], a[212:215], v[140:143]
    v_mfma_f32_16x16x32_bf16 v[144:147], v[184:187], a[216:219], v[144:147]
    v_mfma_f32_16x16x32_bf16 v[148:151], v[188:191], a[216:219], v[148:151]
    v_mfma_f32_16x16x32_bf16 v[152:155], v[184:187], a[220:223], v[152:155]
    v_mfma_f32_16x16x32_bf16 v[156:159], v[188:191], a[220:223], v[156:159]
    s_waitcnt lgkmcnt(0)
    v_mfma_f32_16x16x32_bf16 v[96:99], v[160:163], a[224:227], v[96:99]
    ds_read_b128 v[176:179], v225 offset:57344
    s_add_u32 s38, s36, 8192
    buffer_store_dwordx4 v[88:91], v240, s[16:19], s38 offen offset:2048 sc1
    v_mfma_f32_16x16x32_bf16 v[100:103], v[164:167], a[224:227], v[100:103]
    ds_read_b128 v[180:183], v225 offset:59392
    v_mfma_f32_16x16x32_bf16 v[104:107], v[160:163], a[228:231], v[104:107]
    ds_read_b128 v[184:187], v225 offset:61440
    v_mfma_f32_16x16x32_bf16 v[108:111], v[164:167], a[228:231], v[108:111]
    ds_read_b128 v[188:191], v225 offset:63488
    v_mfma_f32_16x16x32_bf16 v[112:115], v[160:163], a[232:235], v[112:115]
    v_mfma_f32_16x16x32_bf16 v[116:119], v[164:167], a[232:235], v[116:119]
    v_mfma_f32_16x16x32_bf16 v[120:123], v[160:163], a[236:239], v[120:123]
    v_mfma_f32_16x16x32_bf16 v[124:127], v[164:167], a[236:239], v[124:127]
    v_mfma_f32_16x16x32_bf16 v[128:131], v[168:171], a[224:227], v[128:131]
    v_mfma_f32_16x16x32_bf16 v[132:135], v[172:175], a[224:227], v[132:135]
    v_mfma_f32_16x16x32_bf16 v[136:139], v[168:171], a[228:231], v[136:139]
    v_mfma_f32_16x16x32_bf16 v[140:143], v[172:175], a[228:231], v[140:143]
    v_mfma_f32_16x16x32_bf16 v[144:147], v[168:171], a[232:235], v[144:147]
    v_mfma_f32_16x16x32_bf16 v[148:151], v[172:175], a[232:235], v[148:151]
    v_mfma_f32_16x16x32_bf16 v[152:155], v[168:171], a[236:239], v[152:155]
    v_mfma_f32_16x16x32_bf16 v[156:159], v[172:175], a[236:239], v[156:159]
    s_waitcnt vmcnt(14) lgkmcnt(0)
    s_barrier
    v_mfma_f32_16x16x32_bf16 v[96:99], v[176:179], a[240:243], v[96:99]
    ds_read_b128 v[160:163], v226 offset:0
    v_mfma_f32_16x16x32_bf16 v[100:103], v[180:183], a[240:243], v[100:103]
    ds_read_b128 v[164:167], v226 offset:2048
    v_mfma_f32_16x16x32_bf16 v[104:107], v[176:179], a[244:247], v[104:107]
    ds_read_b128 v[168:171], v226 offset:4096
    v_mfma_f32_16x16x32_bf16 v[108:111], v[180:183], a[244:247], v[108:111]
    ds_read_b128 v[172:175], v226 offset:6144
    v_mfma_f32_16x16x32_bf16 v[112:115], v[176:179], a[248:251], v[112:115]
    v_mfma_f32_16x16x32_bf16 v[116:119], v[180:183], a[248:251], v[116:119]
    v_mfma_f32_16x16x32_bf16 v[120:123], v[176:179], a[252:255], v[120:123]
    s_add_u32 s38, s36, 8192
    buffer_store_dwordx4 v[92:95], v240, s[16:19], s38 offen offset:3072 sc1
    v_mfma_f32_16x16x32_bf16 v[124:127], v[180:183], a[252:255], v[124:127]
    v_mfma_f32_16x16x32_bf16 v[128:131], v[184:187], a[240:243], v[128:131]
    v_mfma_f32_16x16x32_bf16 v[132:135], v[188:191], a[240:243], v[132:135]
    v_cvt_pk_bf16_f32 v64, v96, v97
    v_cvt_pk_bf16_f32 v65, v98, v99
    v_mfma_f32_16x16x32_bf16 v[136:139], v[184:187], a[244:247], v[136:139]
    v_cvt_pk_bf16_f32 v66, v100, v101
    v_cvt_pk_bf16_f32 v67, v102, v103
    v_mfma_f32_16x16x32_bf16 v[140:143], v[188:191], a[244:247], v[140:143]
    v_cvt_pk_bf16_f32 v68, v104, v105
    v_cvt_pk_bf16_f32 v69, v106, v107
    v_mfma_f32_16x16x32_bf16 v[144:147], v[184:187], a[248:251], v[144:147]
    v_cvt_pk_bf16_f32 v70, v108, v109
    v_cvt_pk_bf16_f32 v71, v110, v111
    v_mfma_f32_16x16x32_bf16 v[148:151], v[188:191], a[248:251], v[148:151]
    v_cvt_pk_bf16_f32 v72, v112, v113
    v_cvt_pk_bf16_f32 v73, v114, v115
    v_mfma_f32_16x16x32_bf16 v[152:155], v[184:187], a[252:255], v[152:155]
    v_cvt_pk_bf16_f32 v74, v116, v117
    v_cvt_pk_bf16_f32 v75, v118, v119
    v_mfma_f32_16x16x32_bf16 v[156:159], v[188:191], a[252:255], v[156:159]
    v_cvt_pk_bf16_f32 v76, v120, v121
    v_cvt_pk_bf16_f32 v77, v122, v123
    s_waitcnt lgkmcnt(0)
    v_mfma_f32_16x16x32_bf16 v[96:99], v[160:163], a[0:3], 0
    ds_read_b128 v[176:179], v227 offset:0
    v_cvt_pk_bf16_f32 v78, v124, v125
    v_cvt_pk_bf16_f32 v79, v126, v127
    v_mfma_f32_16x16x32_bf16 v[100:103], v[164:167], a[0:3], 0
    ds_read_b128 v[180:183], v227 offset:2048
    v_cvt_pk_bf16_f32 v80, v128, v129
    v_cvt_pk_bf16_f32 v81, v130, v131
    v_mfma_f32_16x16x32_bf16 v[104:107], v[160:163], a[4:7], 0
    ds_read_b128 v[184:187], v227 offset:4096
    v_cvt_pk_bf16_f32 v82, v132, v133
    v_cvt_pk_bf16_f32 v83, v134, v135
    v_mfma_f32_16x16x32_bf16 v[108:111], v[164:167], a[4:7], 0
    ds_read_b128 v[188:191], v227 offset:6144
    v_cvt_pk_bf16_f32 v84, v136, v137
    v_cvt_pk_bf16_f32 v85, v138, v139
    v_mfma_f32_16x16x32_bf16 v[112:115], v[160:163], a[8:11], 0
    v_cvt_pk_bf16_f32 v86, v140, v141
    v_cvt_pk_bf16_f32 v87, v142, v143
    v_mfma_f32_16x16x32_bf16 v[116:119], v[164:167], a[8:11], 0
    s_add_u32 m0, s34, 0
    s_add_u32 s37, s80, 196608
    buffer_load_dwordx4 v232, s[44:47], s37 offen lds
    v_cvt_pk_bf16_f32 v88, v144, v145
    v_cvt_pk_bf16_f32 v89, v146, v147
    v_mfma_f32_16x16x32_bf16 v[120:123], v[160:163], a[12:15], 0
    v_cvt_pk_bf16_f32 v90, v148, v149
    v_cvt_pk_bf16_f32 v91, v150, v151
    v_mfma_f32_16x16x32_bf16 v[124:127], v[164:167], a[12:15], 0
    buffer_load_dwordx4 v233, s[44:47], s37 offen offset:1024 lds
    v_cvt_pk_bf16_f32 v92, v152, v153
    v_cvt_pk_bf16_f32 v93, v154, v155
    v_mfma_f32_16x16x32_bf16 v[128:131], v[168:171], a[0:3], 0
    v_cvt_pk_bf16_f32 v94, v156, v157
    v_cvt_pk_bf16_f32 v95, v158, v159
    v_mfma_f32_16x16x32_bf16 v[132:135], v[172:175], a[0:3], 0
    v_mfma_f32_16x16x32_bf16 v[136:139], v[168:171], a[4:7], 0
    s_add_u32 s38, s36, 32768
    buffer_store_dwordx4 v[64:67], v240, s[16:19], s38 offen offset:1280 sc1
    v_mfma_f32_16x16x32_bf16 v[140:143], v[172:175], a[4:7], 0
    v_mfma_f32_16x16x32_bf16 v[144:147], v[168:171], a[8:11], 0
    v_mfma_f32_16x16x32_bf16 v[148:151], v[172:175], a[8:11], 0
    v_mfma_f32_16x16x32_bf16 v[152:155], v[168:171], a[12:15], 0
    v_mfma_f32_16x16x32_bf16 v[156:159], v[172:175], a[12:15], 0
    s_waitcnt lgkmcnt(0)
    v_mfma_f32_16x16x32_bf16 v[96:99], v[176:179], a[16:19], v[96:99]
    ds_read_b128 v[160:163], v226 offset:8192
    v_mfma_f32_16x16x32_bf16 v[100:103], v[180:183], a[16:19], v[100:103]
    ds_read_b128 v[164:167], v226 offset:10240
    v_mfma_f32_16x16x32_bf16 v[104:107], v[176:179], a[20:23], v[104:107]
    ds_read_b128 v[168:171], v226 offset:12288
    v_mfma_f32_16x16x32_bf16 v[108:111], v[180:183], a[20:23], v[108:111]
    ds_read_b128 v[172:175], v226 offset:14336
    v_mfma_f32_16x16x32_bf16 v[112:115], v[176:179], a[24:27], v[112:115]
    v_mfma_f32_16x16x32_bf16 v[116:119], v[180:183], a[24:27], v[116:119]
    s_add_u32 m0, s31, 0
    s_add_u32 s24, s27, 0
    buffer_load_dwordx4 v245, s[12:15], s24 offen lds
    v_mfma_f32_16x16x32_bf16 v[120:123], v[176:179], a[28:31], v[120:123]
    v_mfma_f32_16x16x32_bf16 v[124:127], v[180:183], a[28:31], v[124:127]
    v_mfma_f32_16x16x32_bf16 v[128:131], v[184:187], a[16:19], v[128:131]
    v_mfma_f32_16x16x32_bf16 v[132:135], v[188:191], a[16:19], v[132:135]
    v_mfma_f32_16x16x32_bf16 v[136:139], v[184:187], a[20:23], v[136:139]
    v_mfma_f32_16x16x32_bf16 v[140:143], v[188:191], a[20:23], v[140:143]
    v_mfma_f32_16x16x32_bf16 v[144:147], v[184:187], a[24:27], v[144:147]
    v_mfma_f32_16x16x32_bf16 v[148:151], v[188:191], a[24:27], v[148:151]
    v_mfma_f32_16x16x32_bf16 v[152:155], v[184:187], a[28:31], v[152:155]
    v_mfma_f32_16x16x32_bf16 v[156:159], v[188:191], a[28:31], v[156:159]
    s_waitcnt lgkmcnt(0)
    v_mfma_f32_16x16x32_bf16 v[96:99], v[160:163], a[32:35], v[96:99]
    ds_read_b128 v[176:179], v227 offset:8192
    v_mfma_f32_16x16x32_bf16 v[100:103], v[164:167], a[32:35], v[100:103]
    ds_read_b128 v[180:183], v227 offset:10240
    v_mfma_f32_16x16x32_bf16 v[104:107], v[160:163], a[36:39], v[104:107]
    ds_read_b128 v[184:187], v227 offset:12288
    v_mfma_f32_16x16x32_bf16 v[108:111], v[164:167], a[36:39], v[108:111]
    ds_read_b128 v[188:191], v227 offset:14336
    v_mfma_f32_16x16x32_bf16 v[112:115], v[160:163], a[40:43], v[112:115]
    v_mfma_f32_16x16x32_bf16 v[116:119], v[164:167], a[40:43], v[116:119]
    s_add_u32 m0, s34, 8192
    s_add_u32 s37, s81, 196608
    buffer_load_dwordx4 v232, s[44:47], s37 offen lds
    v_mfma_f32_16x16x32_bf16 v[120:123], v[160:163], a[44:47], v[120:123]
    v_mfma_f32_16x16x32_bf16 v[124:127], v[164:167], a[44:47], v[124:127]
    buffer_load_dwordx4 v233, s[44:47], s37 offen offset:1024 lds
    v_mfma_f32_16x16x32_bf16 v[128:131], v[168:171], a[32:35], v[128:131]
    v_mfma_f32_16x16x32_bf16 v[132:135], v[172:175], a[32:35], v[132:135]
    v_mfma_f32_16x16x32_bf16 v[136:139], v[168:171], a[36:39], v[136:139]
    s_add_u32 s38, s36, 32768
    buffer_store_dwordx4 v[68:71], v240, s[16:19], s38 offen offset:2304 sc1
    v_mfma_f32_16x16x32_bf16 v[140:143], v[172:175], a[36:39], v[140:143]
    v_mfma_f32_16x16x32_bf16 v[144:147], v[168:171], a[40:43], v[144:147]
    v_mfma_f32_16x16x32_bf16 v[148:151], v[172:175], a[40:43], v[148:151]
    v_mfma_f32_16x16x32_bf16 v[152:155], v[168:171], a[44:47], v[152:155]
    v_mfma_f32_16x16x32_bf16 v[156:159], v[172:175], a[44:47], v[156:159]
    s_waitcnt lgkmcnt(0)
    v_mfma_f32_16x16x32_bf16 v[96:99], v[176:179], a[48:51], v[96:99]
    ds_read_b128 v[160:163], v226 offset:16384
    v_mfma_f32_16x16x32_bf16 v[100:103], v[180:183], a[48:51], v[100:103]
    ds_read_b128 v[164:167], v226 offset:18432
    v_mfma_f32_16x16x32_bf16 v[104:107], v[176:179], a[52:55], v[104:107]
    ds_read_b128 v[168:171], v226 offset:20480
    v_mfma_f32_16x16x32_bf16 v[108:111], v[180:183], a[52:55], v[108:111]
    ds_read_b128 v[172:175], v226 offset:22528
    v_mfma_f32_16x16x32_bf16 v[112:115], v[176:179], a[56:59], v[112:115]
    v_mfma_f32_16x16x32_bf16 v[116:119], v[180:183], a[56:59], v[116:119]
    s_add_u32 m0, s31, 1024
    s_add_u32 s24, s27, 32768
    buffer_load_dwordx4 v245, s[12:15], s24 offen lds
    v_mfma_f32_16x16x32_bf16 v[120:123], v[176:179], a[60:63], v[120:123]
    v_mfma_f32_16x16x32_bf16 v[124:127], v[180:183], a[60:63], v[124:127]
    v_mfma_f32_16x16x32_bf16 v[128:131], v[184:187], a[48:51], v[128:131]
    v_mfma_f32_16x16x32_bf16 v[132:135], v[188:191], a[48:51], v[132:135]
    v_mfma_f32_16x16x32_bf16 v[136:139], v[184:187], a[52:55], v[136:139]
    v_mfma_f32_16x16x32_bf16 v[140:143], v[188:191], a[52:55], v[140:143]
    v_mfma_f32_16x16x32_bf16 v[144:147], v[184:187], a[56:59], v[144:147]
    v_mfma_f32_16x16x32_bf16 v[148:151], v[188:191], a[56:59], v[148:151]
    v_mfma_f32_16x16x32_bf16 v[152:155], v[184:187], a[60:63], v[152:155]
    v_mfma_f32_16x16x32_bf16 v[156:159], v[188:191], a[60:63], v[156:159]
    s_waitcnt lgkmcnt(0)
    v_mfma_f32_16x16x32_bf16 v[96:99], v[160:163], a[64:67], v[96:99]
    ds_read_b128 v[176:179], v227 offset:16384
    v_mfma_f32_16x16x32_bf16 v[100:103], v[164:167], a[64:67], v[100:103]
    ds_read_b128 v[180:183], v227 offset:18432
    v_mfma_f32_16x16x32_bf16 v[104:107], v[160:163], a[68:71], v[104:107]
    ds_read_b128 v[184:187], v227 offset:20480
    v_mfma_f32_16x16x32_bf16 v[108:111], v[164:167], a[68:71], v[108:111]
    ds_read_b128 v[188:191], v227 offset:22528
    v_mfma_f32_16x16x32_bf16 v[112:115], v[160:163], a[72:75], v[112:115]
    v_mfma_f32_16x16x32_bf16 v[116:119], v[164:167], a[72:75], v[116:119]
    s_add_u32 m0, s34, 16384
    s_add_u32 s37, s82, 196608
    buffer_load_dwordx4 v232, s[44:47], s37 offen lds
    v_mfma_f32_16x16x32_bf16 v[120:123], v[160:163], a[76:79], v[120:123]
    v_mfma_f32_16x16x32_bf16 v[124:127], v[164:167], a[76:79], v[124:127]
    buffer_load_dwordx4 v233, s[44:47], s37 offen offset:1024 lds
    v_mfma_f32_16x16x32_bf16 v[128:131], v[168:171], a[64:67], v[128:131]
    v_mfma_f32_16x16x32_bf16 v[132:135], v[172:175], a[64:67], v[132:135]
    v_mfma_f32_16x16x32_bf16 v[136:139], v[168:171], a[68:71], v[136:139]
    v_mfma_f32_16x16x32_bf16 v[140:143], v[172:175], a[68:71], v[140:143]
    s_add_u32 s38, s36, 32768
    buffer_store_dwordx4 v[72:75], v240, s[16:19], s38 offen offset:3328 sc1
    v_mfma_f32_16x16x32_bf16 v[144:147], v[168:171], a[72:75], v[144:147]
    v_mfma_f32_16x16x32_bf16 v[148:151], v[172:175], a[72:75], v[148:151]
    v_mfma_f32_16x16x32_bf16 v[152:155], v[168:171], a[76:79], v[152:155]
    v_mfma_f32_16x16x32_bf16 v[156:159], v[172:175], a[76:79], v[156:159]
    s_waitcnt lgkmcnt(0)
    v_mfma_f32_16x16x32_bf16 v[96:99], v[176:179], a[80:83], v[96:99]
    ds_read_b128 v[160:163], v226 offset:24576
    v_mfma_f32_16x16x32_bf16 v[100:103], v[180:183], a[80:83], v[100:103]
    ds_read_b128 v[164:167], v226 offset:26624
    v_mfma_f32_16x16x32_bf16 v[104:107], v[176:179], a[84:87], v[104:107]
    ds_read_b128 v[168:171], v226 offset:28672
    v_mfma_f32_16x16x32_bf16 v[108:111], v[180:183], a[84:87], v[108:111]
    ds_read_b128 v[172:175], v226 offset:30720
    v_mfma_f32_16x16x32_bf16 v[112:115], v[176:179], a[88:91], v[112:115]
    v_mfma_f32_16x16x32_bf16 v[116:119], v[180:183], a[88:91], v[116:119]
    s_add_u32 m0, s31, 2048
    s_add_u32 s24, s27, 65536
    buffer_load_dwordx4 v245, s[12:15], s24 offen lds
    v_mfma_f32_16x16x32_bf16 v[120:123], v[176:179], a[92:95], v[120:123]
    v_mfma_f32_16x16x32_bf16 v[124:127], v[180:183], a[92:95], v[124:127]
    v_mfma_f32_16x16x32_bf16 v[128:131], v[184:187], a[80:83], v[128:131]
    v_mfma_f32_16x16x32_bf16 v[132:135], v[188:191], a[80:83], v[132:135]
    v_mfma_f32_16x16x32_bf16 v[136:139], v[184:187], a[84:87], v[136:139]
    v_mfma_f32_16x16x32_bf16 v[140:143], v[188:191], a[84:87], v[140:143]
    v_mfma_f32_16x16x32_bf16 v[144:147], v[184:187], a[88:91], v[144:147]
    v_mfma_f32_16x16x32_bf16 v[148:151], v[188:191], a[88:91], v[148:151]
    v_mfma_f32_16x16x32_bf16 v[152:155], v[184:187], a[92:95], v[152:155]
    v_mfma_f32_16x16x32_bf16 v[156:159], v[188:191], a[92:95], v[156:159]
    s_waitcnt lgkmcnt(0)
    v_mfma_f32_16x16x32_bf16 v[96:99], v[160:163], a[96:99], v[96:99]
    ds_read_b128 v[176:179], v227 offset:24576
    v_mfma_f32_16x16x32_bf16 v[100:103], v[164:167], a[96:99], v[100:103]
    ds_read_b128 v[180:183], v227 offset:26624
    v_mfma_f32_16x16x32_bf16 v[104:107], v[160:163], a[100:103], v[104:107]
    ds_read_b128 v[184:187], v227 offset:28672
    v_mfma_f32_16x16x32_bf16 v[108:111], v[164:167], a[100:103], v[108:111]
    ds_read_b128 v[188:191], v227 offset:30720
    v_mfma_f32_16x16x32_bf16 v[112:115], v[160:163], a[104:107], v[112:115]
    v_mfma_f32_16x16x32_bf16 v[116:119], v[164:167], a[104:107], v[116:119]
    s_add_u32 m0, s34, 24576
    s_add_u32 s37, s83, 196608
    buffer_load_dwordx4 v232, s[44:47], s37 offen lds
    v_mfma_f32_16x16x32_bf16 v[120:123], v[160:163], a[108:111], v[120:123]
    v_mfma_f32_16x16x32_bf16 v[124:127], v[164:167], a[108:111], v[124:127]
    buffer_load_dwordx4 v233, s[44:47], s37 offen offset:1024 lds
    v_mfma_f32_16x16x32_bf16 v[128:131], v[168:171], a[96:99], v[128:131]
    v_mfma_f32_16x16x32_bf16 v[132:135], v[172:175], a[96:99], v[132:135]
    v_mfma_f32_16x16x32_bf16 v[136:139], v[168:171], a[100:103], v[136:139]
    v_mfma_f32_16x16x32_bf16 v[140:143], v[172:175], a[100:103], v[140:143]
    v_mfma_f32_16x16x32_bf16 v[144:147], v[168:171], a[104:107], v[144:147]
    s_add_u32 s38, s36, 36864
    buffer_store_dwordx4 v[76:79], v240, s[16:19], s38 offen offset:256 sc1
    v_mfma_f32_16x16x32_bf16 v[148:151], v[172:175], a[104:107], v[148:151]
    v_mfma_f32_16x16x32_bf16 v[152:155], v[168:171], a[108:111], v[152:155]
    v_mfma_f32_16x16x32_bf16 v[156:159], v[172:175], a[108:111], v[156:159]
    s_waitcnt vmcnt(17) lgkmcnt(0)
    s_barrier
    v_mfma_f32_16x16x32_bf16 v[96:99], v[176:179], a[112:115], v[96:99]
    ds_read_b128 v[160:163], v226 offset:32768
    v_mfma_f32_16x16x32_bf16 v[100:103], v[180:183], a[112:115], v[100:103]
    ds_read_b128 v[164:167], v226 offset:34816
    v_mfma_f32_16x16x32_bf16 v[104:107], v[176:179], a[116:119], v[104:107]
    ds_read_b128 v[168:171], v226 offset:36864
    v_mfma_f32_16x16x32_bf16 v[108:111], v[180:183], a[116:119], v[108:111]
    ds_read_b128 v[172:175], v226 offset:38912
    v_mfma_f32_16x16x32_bf16 v[112:115], v[176:179], a[120:123], v[112:115]
    v_mfma_f32_16x16x32_bf16 v[116:119], v[180:183], a[120:123], v[116:119]
    s_add_u32 m0, s31, 3072
    s_add_u32 s24, s27, 98304
    buffer_load_dwordx4 v245, s[12:15], s24 offen lds
    v_mfma_f32_16x16x32_bf16 v[120:123], v[176:179], a[124:127], v[120:123]
    v_mfma_f32_16x16x32_bf16 v[124:127], v[180:183], a[124:127], v[124:127]
    v_mfma_f32_16x16x32_bf16 v[128:131], v[184:187], a[112:115], v[128:131]
    v_mfma_f32_16x16x32_bf16 v[132:135], v[188:191], a[112:115], v[132:135]
    v_mfma_f32_16x16x32_bf16 v[136:139], v[184:187], a[116:119], v[136:139]
    v_mfma_f32_16x16x32_bf16 v[140:143], v[188:191], a[116:119], v[140:143]
    v_mfma_f32_16x16x32_bf16 v[144:147], v[184:187], a[120:123], v[144:147]
    v_mfma_f32_16x16x32_bf16 v[148:151], v[188:191], a[120:123], v[148:151]
    v_mfma_f32_16x16x32_bf16 v[152:155], v[184:187], a[124:127], v[152:155]
    v_mfma_f32_16x16x32_bf16 v[156:159], v[188:191], a[124:127], v[156:159]
    s_waitcnt lgkmcnt(0)
    v_mfma_f32_16x16x32_bf16 v[96:99], v[160:163], a[128:131], v[96:99]
    ds_read_b128 v[176:179], v227 offset:32768
    v_mfma_f32_16x16x32_bf16 v[100:103], v[164:167], a[128:131], v[100:103]
    ds_read_b128 v[180:183], v227 offset:34816
    v_mfma_f32_16x16x32_bf16 v[104:107], v[160:163], a[132:135], v[104:107]
    ds_read_b128 v[184:187], v227 offset:36864
    v_mfma_f32_16x16x32_bf16 v[108:111], v[164:167], a[132:135], v[108:111]
    ds_read_b128 v[188:191], v227 offset:38912
    v_mfma_f32_16x16x32_bf16 v[112:115], v[160:163], a[136:139], v[112:115]
    v_mfma_f32_16x16x32_bf16 v[116:119], v[164:167], a[136:139], v[116:119]
    s_add_u32 m0, s34, 32768
    s_add_u32 s37, s84, 196608
    buffer_load_dwordx4 v232, s[44:47], s37 offen lds
    v_mfma_f32_16x16x32_bf16 v[120:123], v[160:163], a[140:143], v[120:123]
    v_mfma_f32_16x16x32_bf16 v[124:127], v[164:167], a[140:143], v[124:127]
    buffer_load_dwordx4 v233, s[44:47], s37 offen offset:1024 lds
    v_mfma_f32_16x16x32_bf16 v[128:131], v[168:171], a[128:131], v[128:131]
    v_mfma_f32_16x16x32_bf16 v[132:135], v[172:175], a[128:131], v[132:135]
    v_mfma_f32_16x16x32_bf16 v[136:139], v[168:171], a[132:135], v[136:139]
    v_mfma_f32_16x16x32_bf16 v[140:143], v[172:175], a[132:135], v[140:143]
    v_mfma_f32_16x16x32_bf16 v[144:147], v[168:171], a[136:139], v[144:147]
    v_mfma_f32_16x16x32_bf16 v[148:151], v[172:175], a[136:139], v[148:151]
    s_add_u32 s38, s36, 40960
    buffer_store_dwordx4 v[80:83], v240, s[16:19], s38 offen offset:1280 sc1
    v_mfma_f32_16x16x32_bf16 v[152:155], v[168:171], a[140:143], v[152:155]
    v_mfma_f32_16x16x32_bf16 v[156:159], v[172:175], a[140:143], v[156:159]
    s_waitcnt lgkmcnt(0)
    v_mfma_f32_16x16x32_bf16 v[96:99], v[176:179], a[144:147], v[96:99]
    ds_read_b128 v[160:163], v226 offset:40960
    v_mfma_f32_16x16x32_bf16 v[100:103], v[180:183], a[144:147], v[100:103]
    ds_read_b128 v[164:167], v226 offset:43008
    v_mfma_f32_16x16x32_bf16 v[104:107], v[176:179], a[148:151], v[104:107]
    ds_read_b128 v[168:171], v226 offset:45056
    v_mfma_f32_16x16x32_bf16 v[108:111], v[180:183], a[148:151], v[108:111]
    ds_read_b128 v[172:175], v226 offset:47104
    v_mfma_f32_16x16x32_bf16 v[112:115], v[176:179], a[152:155], v[112:115]
    v_mfma_f32_16x16x32_bf16 v[116:119], v[180:183], a[152:155], v[116:119]
    s_add_u32 m0, s31, 4096
    s_add_u32 s24, s27, 131072
    buffer_load_dwordx4 v245, s[12:15], s24 offen lds
    v_mfma_f32_16x16x32_bf16 v[120:123], v[176:179], a[156:159], v[120:123]
    v_mfma_f32_16x16x32_bf16 v[124:127], v[180:183], a[156:159], v[124:127]
    v_mfma_f32_16x16x32_bf16 v[128:131], v[184:187], a[144:147], v[128:131]
    v_mfma_f32_16x16x32_bf16 v[132:135], v[188:191], a[144:147], v[132:135]
    v_mfma_f32_16x16x32_bf16 v[136:139], v[184:187], a[148:151], v[136:139]
    v_mfma_f32_16x16x32_bf16 v[140:143], v[188:191], a[148:151], v[140:143]
    v_mfma_f32_16x16x32_bf16 v[144:147], v[184:187], a[152:155], v[144:147]
    v_mfma_f32_16x16x32_bf16 v[148:151], v[188:191], a[152:155], v[148:151]
    v_mfma_f32_16x16x32_bf16 v[152:155], v[184:187], a[156:159], v[152:155]
    v_mfma_f32_16x16x32_bf16 v[156:159], v[188:191], a[156:159], v[156:159]
    s_waitcnt lgkmcnt(0)
    v_mfma_f32_16x16x32_bf16 v[96:99], v[160:163], a[160:163], v[96:99]
    ds_read_b128 v[176:179], v227 offset:40960
    v_mfma_f32_16x16x32_bf16 v[100:103], v[164:167], a[160:163], v[100:103]
    ds_read_b128 v[180:183], v227 offset:43008
    v_mfma_f32_16x16x32_bf16 v[104:107], v[160:163], a[164:167], v[104:107]
    ds_read_b128 v[184:187], v227 offset:45056
    v_mfma_f32_16x16x32_bf16 v[108:111], v[164:167], a[164:167], v[108:111]
    ds_read_b128 v[188:191], v227 offset:47104
    v_mfma_f32_16x16x32_bf16 v[112:115], v[160:163], a[168:171], v[112:115]
    v_mfma_f32_16x16x32_bf16 v[116:119], v[164:167], a[168:171], v[116:119]
    s_add_u32 m0, s34, 40960
    s_add_u32 s37, s85, 196608
    buffer_load_dwordx4 v232, s[44:47], s37 offen lds
    v_mfma_f32_16x16x32_bf16 v[120:123], v[160:163], a[172:175], v[120:123]
    v_mfma_f32_16x16x32_bf16 v[124:127], v[164:167], a[172:175], v[124:127]
    buffer_load_dwordx4 v233, s[44:47], s37 offen offset:1024 lds
    v_mfma_f32_16x16x32_bf16 v[128:131], v[168:171], a[160:163], v[128:131]
    v_mfma_f32_16x16x32_bf16 v[132:135], v[172:175], a[160:163], v[132:135]
    v_mfma_f32_16x16x32_bf16 v[136:139], v[168:171], a[164:167], v[136:139]
    v_mfma_f32_16x16x32_bf16 v[140:143], v[172:175], a[164:167], v[140:143]
    v_mfma_f32_16x16x32_bf16 v[144:147], v[168:171], a[168:171], v[144:147]
    v_mfma_f32_16x16x32_bf16 v[148:151], v[172:175], a[168:171], v[148:151]
    v_mfma_f32_16x16x32_bf16 v[152:155], v[168:171], a[172:175], v[152:155]
    s_add_u32 s38, s36, 40960
    buffer_store_dwordx4 v[84:87], v240, s[16:19], s38 offen offset:2304 sc1
    v_mfma_f32_16x16x32_bf16 v[156:159], v[172:175], a[172:175], v[156:159]
    s_waitcnt lgkmcnt(0)
    v_mfma_f32_16x16x32_bf16 v[96:99], v[176:179], a[176:179], v[96:99]
    ds_read_b128 v[160:163], v226 offset:49152
    v_mfma_f32_16x16x32_bf16 v[100:103], v[180:183], a[176:179], v[100:103]
    ds_read_b128 v[164:167], v226 offset:51200
    v_mfma_f32_16x16x32_bf16 v[104:107], v[176:179], a[180:183], v[104:107]
    ds_read_b128 v[168:171], v226 offset:53248
    v_mfma_f32_16x16x32_bf16 v[108:111], v[180:183], a[180:183], v[108:111]
    ds_read_b128 v[172:175], v226 offset:55296
    v_mfma_f32_16x16x32_bf16 v[112:115], v[176:179], a[184:187], v[112:115]
    v_mfma_f32_16x16x32_bf16 v[116:119], v[180:183], a[184:187], v[116:119]
    s_add_u32 m0, s31, 5120
    s_add_u32 s24, s27, 163840
    buffer_load_dwordx4 v245, s[12:15], s24 offen lds
    v_mfma_f32_16x16x32_bf16 v[120:123], v[176:179], a[188:191], v[120:123]
    v_mfma_f32_16x16x32_bf16 v[124:127], v[180:183], a[188:191], v[124:127]
    v_mfma_f32_16x16x32_bf16 v[128:131], v[184:187], a[176:179], v[128:131]
    v_mfma_f32_16x16x32_bf16 v[132:135], v[188:191], a[176:179], v[132:135]
    v_mfma_f32_16x16x32_bf16 v[136:139], v[184:187], a[180:183], v[136:139]
    v_mfma_f32_16x16x32_bf16 v[140:143], v[188:191], a[180:183], v[140:143]
    v_mfma_f32_16x16x32_bf16 v[144:147], v[184:187], a[184:187], v[144:147]
    v_mfma_f32_16x16x32_bf16 v[148:151], v[188:191], a[184:187], v[148:151]
    v_mfma_f32_16x16x32_bf16 v[152:155], v[184:187], a[188:191], v[152:155]
    v_mfma_f32_16x16x32_bf16 v[156:159], v[188:191], a[188:191], v[156:159]
    s_waitcnt lgkmcnt(0)
    v_mfma_f32_16x16x32_bf16 v[96:99], v[160:163], a[192:195], v[96:99]
    ds_read_b128 v[176:179], v227 offset:49152
    v_mfma_f32_16x16x32_bf16 v[100:103], v[164:167], a[192:195], v[100:103]
    ds_read_b128 v[180:183], v227 offset:51200
    v_mfma_f32_16x16x32_bf16 v[104:107], v[160:163], a[196:199], v[104:107]
    ds_read_b128 v[184:187], v227 offset:53248
    v_mfma_f32_16x16x32_bf16 v[108:111], v[164:167], a[196:199], v[108:111]
    ds_read_b128 v[188:191], v227 offset:55296
    v_mfma_f32_16x16x32_bf16 v[112:115], v[160:163], a[200:203], v[112:115]
    v_mfma_f32_16x16x32_bf16 v[116:119], v[164:167], a[200:203], v[116:119]
    s_add_u32 m0, s34, 49152
    s_add_u32 s37, s86, 196608
    buffer_load_dwordx4 v232, s[44:47], s37 offen lds
    v_mfma_f32_16x16x32_bf16 v[120:123], v[160:163], a[204:207], v[120:123]
    v_mfma_f32_16x16x32_bf16 v[124:127], v[164:167], a[204:207], v[124:127]
    buffer_load_dwordx4 v233, s[44:47], s37 offen offset:1024 lds
    v_mfma_f32_16x16x32_bf16 v[128:131], v[168:171], a[192:195], v[128:131]
    v_mfma_f32_16x16x32_bf16 v[132:135], v[172:175], a[192:195], v[132:135]
    v_mfma_f32_16x16x32_bf16 v[136:139], v[168:171], a[196:199], v[136:139]
    v_mfma_f32_16x16x32_bf16 v[140:143], v[172:175], a[196:199], v[140:143]
    v_mfma_f32_16x16x32_bf16 v[144:147], v[168:171], a[200:203], v[144:147]
    v_mfma_f32_16x16x32_bf16 v[148:151], v[172:175], a[200:203], v[148:151]
    v_mfma_f32_16x16x32_bf16 v[152:155], v[168:171], a[204:207], v[152:155]
    v_mfma_f32_16x16x32_bf16 v[156:159], v[172:175], a[204:207], v[156:159]
    s_add_u32 s38, s36, 40960
    buffer_store_dwordx4 v[88:91], v240, s[16:19], s38 offen offset:3328 sc1
    s_waitcnt lgkmcnt(0)
    v_mfma_f32_16x16x32_bf16 v[96:99], v[176:179], a[208:211], v[96:99]
    ds_read_b128 v[160:163], v226 offset:57344
    v_mfma_f32_16x16x32_bf16 v[100:103], v[180:183], a[208:211], v[100:103]
    ds_read_b128 v[164:167], v226 offset:59392
    v_mfma_f32_16x16x32_bf16 v[104:107], v[176:179], a[212:215], v[104:107]
    ds_read_b128 v[168:171], v226 offset:61440
    v_mfma_f32_16x16x32_bf16 v[108:111], v[180:183], a[212:215], v[108:111]
    ds_read_b128 v[172:175], v226 offset:63488
    v_mfma_f32_16x16x32_bf16 v[112:115], v[176:179], a[216:219], v[112:115]
    v_mfma_f32_16x16x32_bf16 v[116:119], v[180:183], a[216:219], v[116:119]
    s_add_u32 m0, s31, 6144
    s_add_u32 s24, s27, 196608
    buffer_load_dwordx4 v245, s[12:15], s24 offen lds
    v_mfma_f32_16x16x32_bf16 v[120:123], v[176:179], a[220:223], v[120:123]
    v_mfma_f32_16x16x32_bf16 v[124:127], v[180:183], a[220:223], v[124:127]
    v_mfma_f32_16x16x32_bf16 v[128:131], v[184:187], a[208:211], v[128:131]
    v_mfma_f32_16x16x32_bf16 v[132:135], v[188:191], a[208:211], v[132:135]
    v_mfma_f32_16x16x32_bf16 v[136:139], v[184:187], a[212:215], v[136:139]
    v_mfma_f32_16x16x32_bf16 v[140:143], v[188:191], a[212:215], v[140:143]
    v_mfma_f32_16x16x32_bf16 v[144:147], v[184:187], a[216:219], v[144:147]
    v_mfma_f32_16x16x32_bf16 v[148:151], v[188:191], a[216:219], v[148:151]
    v_mfma_f32_16x16x32_bf16 v[152:155], v[184:187], a[220:223], v[152:155]
    v_mfma_f32_16x16x32_bf16 v[156:159], v[188:191], a[220:223], v[156:159]
    s_waitcnt lgkmcnt(0)
    v_mfma_f32_16x16x32_bf16 v[96:99], v[160:163], a[224:227], v[96:99]
    ds_read_b128 v[176:179], v227 offset:57344
    v_mfma_f32_16x16x32_bf16 v[100:103], v[164:167], a[224:227], v[100:103]
    ds_read_b128 v[180:183], v227 offset:59392
    v_mfma_f32_16x16x32_bf16 v[104:107], v[160:163], a[228:231], v[104:107]
    ds_read_b128 v[184:187], v227 offset:61440
    v_mfma_f32_16x16x32_bf16 v[108:111], v[164:167], a[228:231], v[108:111]
    ds_read_b128 v[188:191], v227 offset:63488
    v_mfma_f32_16x16x32_bf16 v[112:115], v[160:163], a[232:235], v[112:115]
    v_mfma_f32_16x16x32_bf16 v[116:119], v[164:167], a[232:235], v[116:119]
    s_add_u32 m0, s34, 57344
    s_add_u32 s37, s87, 196608
    buffer_load_dwordx4 v232, s[44:47], s37 offen lds
    v_mfma_f32_16x16x32_bf16 v[120:123], v[160:163], a[236:239], v[120:123]
    v_mfma_f32_16x16x32_bf16 v[124:127], v[164:167], a[236:239], v[124:127]
    buffer_load_dwordx4 v233, s[44:47], s37 offen offset:1024 lds
    v_mfma_f32_16x16x32_bf16 v[128:131], v[168:171], a[224:227], v[128:131]
    v_mfma_f32_16x16x32_bf16 v[132:135], v[172:175], a[224:227], v[132:135]
    v_mfma_f32_16x16x32_bf16 v[136:139], v[168:171], a[228:231], v[136:139]
    v_mfma_f32_16x16x32_bf16 v[140:143], v[172:175], a[228:231], v[140:143]
    v_mfma_f32_16x16x32_bf16 v[144:147], v[168:171], a[232:235], v[144:147]
    v_mfma_f32_16x16x32_bf16 v[148:151], v[172:175], a[232:235], v[148:151]
    v_mfma_f32_16x16x32_bf16 v[152:155], v[168:171], a[236:239], v[152:155]
    v_mfma_f32_16x16x32_bf16 v[156:159], v[172:175], a[236:239], v[156:159]
    s_waitcnt vmcnt(16) lgkmcnt(0)
    s_barrier
    v_mfma_f32_16x16x32_bf16 v[96:99], v[176:179], a[240:243], v[96:99]
    ds_read_b128 v[160:163], v224 offset:0
    s_add_u32 s38, s36, 45056
    buffer_store_dwordx4 v[92:95], v240, s[16:19], s38 offen offset:256 sc1
    v_mfma_f32_16x16x32_bf16 v[100:103], v[180:183], a[240:243], v[100:103]
    ds_read_b128 v[164:167], v224 offset:2048
    v_mfma_f32_16x16x32_bf16 v[104:107], v[176:179], a[244:247], v[104:107]
    ds_read_b128 v[168:171], v224 offset:4096
    v_mfma_f32_16x16x32_bf16 v[108:111], v[180:183], a[244:247], v[108:111]
    ds_read_b128 v[172:175], v224 offset:6144
    v_mfma_f32_16x16x32_bf16 v[112:115], v[176:179], a[248:251], v[112:115]
    v_mfma_f32_16x16x32_bf16 v[116:119], v[180:183], a[248:251], v[116:119]
    s_add_u32 m0, s31, 7168
    s_add_u32 s24, s27, 229376
    buffer_load_dwordx4 v245, s[12:15], s24 offen lds
    v_mfma_f32_16x16x32_bf16 v[120:123], v[176:179], a[252:255], v[120:123]
    v_mfma_f32_16x16x32_bf16 v[124:127], v[180:183], a[252:255], v[124:127]
    s_add_u32 s27, s27, 1048576
    s_and_b32 s27, s27, 0x407fffff
    s_cmp_eq_u32 s27, s7
    s_cselect_b32 s27, s43, s27
    v_mfma_f32_16x16x32_bf16 v[128:131], v[184:187], a[240:243], v[128:131]
    v_mfma_f32_16x16x32_bf16 v[132:135], v[188:191], a[240:243], v[132:135]
    s_add_u32 s31, s31, 32768
    s_cmp_ge_u32 s31, 163840
    s_cselect_b32 s24, 98304, 0
    s_sub_u32 s31, s31, s24
    v_cvt_pk_bf16_f32 v64, v96, v97
    v_cvt_pk_bf16_f32 v65, v98, v99
    v_mfma_f32_16x16x32_bf16 v[136:139], v[184:187], a[244:247], v[136:139]
    v_cvt_pk_bf16_f32 v66, v100, v101
    v_cvt_pk_bf16_f32 v67, v102, v103
    v_mfma_f32_16x16x32_bf16 v[140:143], v[188:191], a[244:247], v[140:143]
    v_cvt_pk_bf16_f32 v68, v104, v105
    v_cvt_pk_bf16_f32 v69, v106, v107
    v_mfma_f32_16x16x32_bf16 v[144:147], v[184:187], a[248:251], v[144:147]
    v_cvt_pk_bf16_f32 v70, v108, v109
    v_cvt_pk_bf16_f32 v71, v110, v111
    v_mfma_f32_16x16x32_bf16 v[148:151], v[188:191], a[248:251], v[148:151]
    v_cvt_pk_bf16_f32 v72, v112, v113
    v_cvt_pk_bf16_f32 v73, v114, v115
    v_mfma_f32_16x16x32_bf16 v[152:155], v[184:187], a[252:255], v[152:155]
    v_cvt_pk_bf16_f32 v74, v116, v117
    v_cvt_pk_bf16_f32 v75, v118, v119
    v_mfma_f32_16x16x32_bf16 v[156:159], v[188:191], a[252:255], v[156:159]
    v_cvt_pk_bf16_f32 v76, v120, v121
    v_cvt_pk_bf16_f32 v77, v122, v123
    s_waitcnt lgkmcnt(0)
    v_mfma_f32_16x16x32_bf16 v[96:99], v[160:163], a[0:3], 0
    ds_read_b128 v[176:179], v225 offset:0
    v_cvt_pk_bf16_f32 v78, v124, v125
    v_cvt_pk_bf16_f32 v79, v126, v127
    v_mfma_f32_16x16x32_bf16 v[100:103], v[164:167], a[0:3], 0
    ds_read_b128 v[180:183], v225 offset:2048
    v_cvt_pk_bf16_f32 v80, v128, v129
    v_cvt_pk_bf16_f32 v81, v130, v131
    v_mfma_f32_16x16x32_bf16 v[104:107], v[160:163], a[4:7], 0
    ds_read_b128 v[184:187], v225 offset:4096
    v_cvt_pk_bf16_f32 v82, v132, v133
    v_cvt_pk_bf16_f32 v83, v134, v135
    v_mfma_f32_16x16x32_bf16 v[108:111], v[164:167], a[4:7], 0
    ds_read_b128 v[188:191], v225 offset:6144
    v_cvt_pk_bf16_f32 v84, v136, v137
    v_cvt_pk_bf16_f32 v85, v138, v139
    v_mfma_f32_16x16x32_bf16 v[112:115], v[160:163], a[8:11], 0
    v_cvt_pk_bf16_f32 v86, v140, v141
    v_cvt_pk_bf16_f32 v87, v142, v143
    v_mfma_f32_16x16x32_bf16 v[116:119], v[164:167], a[8:11], 0
    s_add_u32 m0, s31, 0
    s_add_u32 s24, s27, 0
    buffer_load_dwordx4 v245, s[12:15], s24 offen lds
    v_cvt_pk_bf16_f32 v88, v144, v145
    v_cvt_pk_bf16_f32 v89, v146, v147
    v_mfma_f32_16x16x32_bf16 v[120:123], v[160:163], a[12:15], 0
    v_cvt_pk_bf16_f32 v90, v148, v149
    v_cvt_pk_bf16_f32 v91, v150, v151
    v_mfma_f32_16x16x32_bf16 v[124:127], v[164:167], a[12:15], 0
    v_cvt_pk_bf16_f32 v92, v152, v153
    v_cvt_pk_bf16_f32 v93, v154, v155
    v_mfma_f32_16x16x32_bf16 v[128:131], v[168:171], a[0:3], 0
    v_cvt_pk_bf16_f32 v94, v156, v157
    v_cvt_pk_bf16_f32 v95, v158, v159
    v_mfma_f32_16x16x32_bf16 v[132:135], v[172:175], a[0:3], 0
    v_mfma_f32_16x16x32_bf16 v[136:139], v[168:171], a[4:7], 0
    s_add_u32 s38, s36, 65536
    buffer_store_dwordx4 v[64:67], v240, s[16:19], s38 offen offset:2560 sc1
    v_mfma_f32_16x16x32_bf16 v[140:143], v[172:175], a[4:7], 0
    v_mfma_f32_16x16x32_bf16 v[144:147], v[168:171], a[8:11], 0
    v_mfma_f32_16x16x32_bf16 v[148:151], v[172:175], a[8:11], 0
    v_mfma_f32_16x16x32_bf16 v[152:155], v[168:171], a[12:15], 0
    v_mfma_f32_16x16x32_bf16 v[156:159], v[172:175], a[12:15], 0
    s_waitcnt lgkmcnt(0)
    v_mfma_f32_16x16x32_bf16 v[96:99], v[176:179], a[16:19], v[96:99]
    ds_read_b128 v[160:163], v224 offset:8192
    v_mfma_f32_16x16x32_bf16 v[100:103], v[180:183], a[16:19], v[100:103]
    ds_read_b128 v[164:167], v224 offset:10240
    v_mfma_f32_16x16x32_bf16 v[104:107], v[176:179], a[20:23], v[104:107]
    ds_read_b128 v[168:171], v224 offset:12288
    v_mfma_f32_16x16x32_bf16 v[108:111], v[180:183], a[20:23], v[108:111]
    ds_read_b128 v[172:175], v224 offset:14336
    v_mfma_f32_16x16x32_bf16 v[112:115], v[176:179], a[24:27], v[112:115]
    v_mfma_f32_16x16x32_bf16 v[116:119], v[180:183], a[24:27], v[116:119]
    s_add_u32 m0, s31, 1024
    s_add_u32 s24, s27, 32768
    buffer_load_dwordx4 v245, s[12:15], s24 offen lds
    v_mfma_f32_16x16x32_bf16 v[120:123], v[176:179], a[28:31], v[120:123]
    v_mfma_f32_16x16x32_bf16 v[124:127], v[180:183], a[28:31], v[124:127]
    v_mfma_f32_16x16x32_bf16 v[128:131], v[184:187], a[16:19], v[128:131]
    v_mfma_f32_16x16x32_bf16 v[132:135], v[188:191], a[16:19], v[132:135]
    v_mfma_f32_16x16x32_bf16 v[136:139], v[184:187], a[20:23], v[136:139]
    v_mfma_f32_16x16x32_bf16 v[140:143], v[188:191], a[20:23], v[140:143]
    v_mfma_f32_16x16x32_bf16 v[144:147], v[184:187], a[24:27], v[144:147]
    v_mfma_f32_16x16x32_bf16 v[148:151], v[188:191], a[24:27], v[148:151]
    v_mfma_f32_16x16x32_bf16 v[152:155], v[184:187], a[28:31], v[152:155]
    v_mfma_f32_16x16x32_bf16 v[156:159], v[188:191], a[28:31], v[156:159]
    s_waitcnt lgkmcnt(0)
    v_mfma_f32_16x16x32_bf16 v[96:99], v[160:163], a[32:35], v[96:99]
    ds_read_b128 v[176:179], v225 offset:8192
    v_mfma_f32_16x16x32_bf16 v[100:103], v[164:167], a[32:35], v[100:103]
    ds_read_b128 v[180:183], v225 offset:10240
    v_mfma_f32_16x16x32_bf16 v[104:107], v[160:163], a[36:39], v[104:107]
    ds_read_b128 v[184:187], v225 offset:12288
    v_mfma_f32_16x16x32_bf16 v[108:111], v[164:167], a[36:39], v[108:111]
    ds_read_b128 v[188:191], v225 offset:14336
    v_mfma_f32_16x16x32_bf16 v[112:115], v[160:163], a[40:43], v[112:115]
    v_mfma_f32_16x16x32_bf16 v[116:119], v[164:167], a[40:43], v[116:119]
    s_add_u32 m0, s31, 2048
    s_add_u32 s24, s27, 65536
    buffer_load_dwordx4 v245, s[12:15], s24 offen lds
    v_mfma_f32_16x16x32_bf16 v[120:123], v[160:163], a[44:47], v[120:123]
    v_mfma_f32_16x16x32_bf16 v[124:127], v[164:167], a[44:47], v[124:127]
    v_mfma_f32_16x16x32_bf16 v[128:131], v[168:171], a[32:35], v[128:131]
    v_mfma_f32_16x16x32_bf16 v[132:135], v[172:175], a[32:35], v[132:135]
    v_mfma_f32_16x16x32_bf16 v[136:139], v[168:171], a[36:39], v[136:139]
    s_add_u32 s38, s36, 65536
    buffer_store_dwordx4 v[68:71], v240, s[16:19], s38 offen offset:3584 sc1
    v_mfma_f32_16x16x32_bf16 v[140:143], v[172:175], a[36:39], v[140:143]
    v_mfma_f32_16x16x32_bf16 v[144:147], v[168:171], a[40:43], v[144:147]
    v_mfma_f32_16x16x32_bf16 v[148:151], v[172:175], a[40:43], v[148:151]
    v_mfma_f32_16x16x32_bf16 v[152:155], v[168:171], a[44:47], v[152:155]
    v_mfma_f32_16x16x32_bf16 v[156:159], v[172:175], a[44:47], v[156:159]
    s_waitcnt lgkmcnt(0)
    v_mfma_f32_16x16x32_bf16 v[96:99], v[176:179], a[48:51], v[96:99]
    ds_read_b128 v[160:163], v224 offset:16384
    v_mfma_f32_16x16x32_bf16 v[100:103], v[180:183], a[48:51], v[100:103]
    ds_read_b128 v[164:167], v224 offset:18432
    v_mfma_f32_16x16x32_bf16 v[104:107], v[176:179], a[52:55], v[104:107]
    ds_read_b128 v[168:171], v224 offset:20480
    v_mfma_f32_16x16x32_bf16 v[108:111], v[180:183], a[52:55], v[108:111]
    ds_read_b128 v[172:175], v224 offset:22528
    v_mfma_f32_16x16x32_bf16 v[112:115], v[176:179], a[56:59], v[112:115]
    v_mfma_f32_16x16x32_bf16 v[116:119], v[180:183], a[56:59], v[116:119]
    s_add_u32 m0, s31, 3072
    s_add_u32 s24, s27, 98304
    buffer_load_dwordx4 v245, s[12:15], s24 offen lds
    v_mfma_f32_16x16x32_bf16 v[120:123], v[176:179], a[60:63], v[120:123]
    v_mfma_f32_16x16x32_bf16 v[124:127], v[180:183], a[60:63], v[124:127]
    v_mfma_f32_16x16x32_bf16 v[128:131], v[184:187], a[48:51], v[128:131]
    v_mfma_f32_16x16x32_bf16 v[132:135], v[188:191], a[48:51], v[132:135]
    v_mfma_f32_16x16x32_bf16 v[136:139], v[184:187], a[52:55], v[136:139]
    v_mfma_f32_16x16x32_bf16 v[140:143], v[188:191], a[52:55], v[140:143]
    v_mfma_f32_16x16x32_bf16 v[144:147], v[184:187], a[56:59], v[144:147]
    v_mfma_f32_16x16x32_bf16 v[148:151], v[188:191], a[56:59], v[148:151]
    v_mfma_f32_16x16x32_bf16 v[152:155], v[184:187], a[60:63], v[152:155]
    v_mfma_f32_16x16x32_bf16 v[156:159], v[188:191], a[60:63], v[156:159]
    s_waitcnt lgkmcnt(0)
    v_mfma_f32_16x16x32_bf16 v[96:99], v[160:163], a[64:67], v[96:99]
    ds_read_b128 v[176:179], v225 offset:16384
    v_mfma_f32_16x16x32_bf16 v[100:103], v[164:167], a[64:67], v[100:103]
    ds_read_b128 v[180:183], v225 offset:18432
    v_mfma_f32_16x16x32_bf16 v[104:107], v[160:163], a[68:71], v[104:107]
    ds_read_b128 v[184:187], v225 offset:20480
    v_mfma_f32_16x16x32_bf16 v[108:111], v[164:167], a[68:71], v[108:111]
    ds_read_b128 v[188:191], v225 offset:22528
    v_mfma_f32_16x16x32_bf16 v[112:115], v[160:163], a[72:75], v[112:115]
    v_mfma_f32_16x16x32_bf16 v[116:119], v[164:167], a[72:75], v[116:119]
    s_add_u32 m0, s31, 4096
    s_add_u32 s24, s27, 131072
    buffer_load_dwordx4 v245, s[12:15], s24 offen lds
    v_mfma_f32_16x16x32_bf16 v[120:123], v[160:163], a[76:79], v[120:123]
    v_mfma_f32_16x16x32_bf16 v[124:127], v[164:167], a[76:79], v[124:127]
    v_mfma_f32_16x16x32_bf16 v[128:131], v[168:171], a[64:67], v[128:131]
    v_mfma_f32_16x16x32_bf16 v[132:135], v[172:175], a[64:67], v[132:135]
    v_mfma_f32_16x16x32_bf16 v[136:139], v[168:171], a[68:71], v[136:139]
    v_mfma_f32_16x16x32_bf16 v[140:143], v[172:175], a[68:71], v[140:143]
    s_add_u32 s38, s36, 69632
    buffer_store_dwordx4 v[72:75], v240, s[16:19], s38 offen offset:512 sc1
    v_mfma_f32_16x16x32_bf16 v[144:147], v[168:171], a[72:75], v[144:147]
    v_mfma_f32_16x16x32_bf16 v[148:151], v[172:175], a[72:75], v[148:151]
    v_mfma_f32_16x16x32_bf16 v[152:155], v[168:171], a[76:79], v[152:155]
    v_mfma_f32_16x16x32_bf16 v[156:159], v[172:175], a[76:79], v[156:159]
    s_waitcnt lgkmcnt(0)
    v_mfma_f32_16x16x32_bf16 v[96:99], v[176:179], a[80:83], v[96:99]
    ds_read_b128 v[160:163], v224 offset:24576
    v_mfma_f32_16x16x32_bf16 v[100:103], v[180:183], a[80:83], v[100:103]
    ds_read_b128 v[164:167], v224 offset:26624
    v_mfma_f32_16x16x32_bf16 v[104:107], v[176:179], a[84:87], v[104:107]
    ds_read_b128 v[168:171], v224 offset:28672
    v_mfma_f32_16x16x32_bf16 v[108:111], v[180:183], a[84:87], v[108:111]
    ds_read_b128 v[172:175], v224 offset:30720
    v_mfma_f32_16x16x32_bf16 v[112:115], v[176:179], a[88:91], v[112:115]
    v_mfma_f32_16x16x32_bf16 v[116:119], v[180:183], a[88:91], v[116:119]
    s_add_u32 m0, s31, 5120
    s_add_u32 s24, s27, 163840
    buffer_load_dwordx4 v245, s[12:15], s24 offen lds
    v_mfma_f32_16x16x32_bf16 v[120:123], v[176:179], a[92:95], v[120:123]
    v_mfma_f32_16x16x32_bf16 v[124:127], v[180:183], a[92:95], v[124:127]
    v_mfma_f32_16x16x32_bf16 v[128:131], v[184:187], a[80:83], v[128:131]
    v_mfma_f32_16x16x32_bf16 v[132:135], v[188:191], a[80:83], v[132:135]
    v_mfma_f32_16x16x32_bf16 v[136:139], v[184:187], a[84:87], v[136:139]
    v_mfma_f32_16x16x32_bf16 v[140:143], v[188:191], a[84:87], v[140:143]
    v_mfma_f32_16x16x32_bf16 v[144:147], v[184:187], a[88:91], v[144:147]
    v_mfma_f32_16x16x32_bf16 v[148:151], v[188:191], a[88:91], v[148:151]
    v_mfma_f32_16x16x32_bf16 v[152:155], v[184:187], a[92:95], v[152:155]
    v_mfma_f32_16x16x32_bf16 v[156:159], v[188:191], a[92:95], v[156:159]
    s_waitcnt lgkmcnt(0)
    v_mfma_f32_16x16x32_bf16 v[96:99], v[160:163], a[96:99], v[96:99]
    ds_read_b128 v[176:179], v225 offset:24576
    v_mfma_f32_16x16x32_bf16 v[100:103], v[164:167], a[96:99], v[100:103]
    ds_read_b128 v[180:183], v225 offset:26624
    v_mfma_f32_16x16x32_bf16 v[104:107], v[160:163], a[100:103], v[104:107]
    ds_read_b128 v[184:187], v225 offset:28672
    v_mfma_f32_16x16x32_bf16 v[108:111], v[164:167], a[100:103], v[108:111]
    ds_read_b128 v[188:191], v225 offset:30720
    v_mfma_f32_16x16x32_bf16 v[112:115], v[160:163], a[104:107], v[112:115]
    v_mfma_f32_16x16x32_bf16 v[116:119], v[164:167], a[104:107], v[116:119]
    buffer_load_dword v254, off, s[88:91], s39 sc1
    v_mfma_f32_16x16x32_bf16 v[120:123], v[160:163], a[108:111], v[120:123]
    v_mfma_f32_16x16x32_bf16 v[124:127], v[164:167], a[108:111], v[124:127]
    s_add_u32 m0, s31, 6144
    s_add_u32 s24, s27, 196608
    buffer_load_dwordx4 v245, s[12:15], s24 offen lds
    v_mfma_f32_16x16x32_bf16 v[128:131], v[168:171], a[96:99], v[128:131]
    v_mfma_f32_16x16x32_bf16 v[132:135], v[172:175], a[96:99], v[132:135]
    v_mfma_f32_16x16x32_bf16 v[136:139], v[168:171], a[100:103], v[136:139]
    v_mfma_f32_16x16x32_bf16 v[140:143], v[172:175], a[100:103], v[140:143]
    v_mfma_f32_16x16x32_bf16 v[144:147], v[168:171], a[104:107], v[144:147]
    s_add_u32 s38, s36, 69632
    buffer_store_dwordx4 v[76:79], v240, s[16:19], s38 offen offset:1536 sc1
    v_mfma_f32_16x16x32_bf16 v[148:151], v[172:175], a[104:107], v[148:151]
    v_mfma_f32_16x16x32_bf16 v[152:155], v[168:171], a[108:111], v[152:155]
    v_mfma_f32_16x16x32_bf16 v[156:159], v[172:175], a[108:111], v[156:159]
    s_waitcnt vmcnt(14) lgkmcnt(0)
    s_barrier
    v_mfma_f32_16x16x32_bf16 v[96:99], v[176:179], a[112:115], v[96:99]
    ds_read_b128 v[160:163], v224 offset:32768
    v_mfma_f32_16x16x32_bf16 v[100:103], v[180:183], a[112:115], v[100:103]
    ds_read_b128 v[164:167], v224 offset:34816
    v_mfma_f32_16x16x32_bf16 v[104:107], v[176:179], a[116:119], v[104:107]
    ds_read_b128 v[168:171], v224 offset:36864
    v_mfma_f32_16x16x32_bf16 v[108:111], v[180:183], a[116:119], v[108:111]
    ds_read_b128 v[172:175], v224 offset:38912
    v_mfma_f32_16x16x32_bf16 v[112:115], v[176:179], a[120:123], v[112:115]
    v_mfma_f32_16x16x32_bf16 v[116:119], v[180:183], a[120:123], v[116:119]
    s_add_u32 m0, s31, 7168
    s_add_u32 s24, s27, 229376
    buffer_load_dwordx4 v245, s[12:15], s24 offen lds
    v_mfma_f32_16x16x32_bf16 v[120:123], v[176:179], a[124:127], v[120:123]
    v_mfma_f32_16x16x32_bf16 v[124:127], v[180:183], a[124:127], v[124:127]
    s_add_u32 s27, s27, 1048576
    s_and_b32 s27, s27, 0x407fffff
    s_cmp_eq_u32 s27, s7
    s_cselect_b32 s27, s43, s27
    v_mfma_f32_16x16x32_bf16 v[128:131], v[184:187], a[112:115], v[128:131]
    v_mfma_f32_16x16x32_bf16 v[132:135], v[188:191], a[112:115], v[132:135]
    s_add_u32 s31, s31, 32768
    s_cmp_ge_u32 s31, 163840
    s_cselect_b32 s24, 98304, 0
    s_sub_u32 s31, s31, s24
    v_mfma_f32_16x16x32_bf16 v[136:139], v[184:187], a[116:119], v[136:139]
    v_mfma_f32_16x16x32_bf16 v[140:143], v[188:191], a[116:119], v[140:143]
    v_mfma_f32_16x16x32_bf16 v[144:147], v[184:187], a[120:123], v[144:147]
    v_mfma_f32_16x16x32_bf16 v[148:151], v[188:191], a[120:123], v[148:151]
    v_mfma_f32_16x16x32_bf16 v[152:155], v[184:187], a[124:127], v[152:155]
    v_mfma_f32_16x16x32_bf16 v[156:159], v[188:191], a[124:127], v[156:159]
    s_waitcnt lgkmcnt(0)
    v_mfma_f32_16x16x32_bf16 v[96:99], v[160:163], a[128:131], v[96:99]
    ds_read_b128 v[176:179], v225 offset:32768
    v_mfma_f32_16x16x32_bf16 v[100:103], v[164:167], a[128:131], v[100:103]
    ds_read_b128 v[180:183], v225 offset:34816
    v_mfma_f32_16x16x32_bf16 v[104:107], v[160:163], a[132:135], v[104:107]
    ds_read_b128 v[184:187], v225 offset:36864
    v_mfma_f32_16x16x32_bf16 v[108:111], v[164:167], a[132:135], v[108:111]
    ds_read_b128 v[188:191], v225 offset:38912
    v_mfma_f32_16x16x32_bf16 v[112:115], v[160:163], a[136:139], v[112:115]
    v_mfma_f32_16x16x32_bf16 v[116:119], v[164:167], a[136:139], v[116:119]
    v_mfma_f32_16x16x32_bf16 v[120:123], v[160:163], a[140:143], v[120:123]
    v_mfma_f32_16x16x32_bf16 v[124:127], v[164:167], a[140:143], v[124:127]
    v_mfma_f32_16x16x32_bf16 v[128:131], v[168:171], a[128:131], v[128:131]
    v_mfma_f32_16x16x32_bf16 v[132:135], v[172:175], a[128:131], v[132:135]
    v_mfma_f32_16x16x32_bf16 v[136:139], v[168:171], a[132:135], v[136:139]
    v_mfma_f32_16x16x32_bf16 v[140:143], v[172:175], a[132:135], v[140:143]
    v_mfma_f32_16x16x32_bf16 v[144:147], v[168:171], a[136:139], v[144:147]
    v_mfma_f32_16x16x32_bf16 v[148:151], v[172:175], a[136:139], v[148:151]
    s_add_u32 s38, s36, 73728
    buffer_store_dwordx4 v[80:83], v240, s[16:19], s38 offen offset:2560 sc1
    v_mfma_f32_16x16x32_bf16 v[152:155], v[168:171], a[140:143], v[152:155]
    v_mfma_f32_16x16x32_bf16 v[156:159], v[172:175], a[140:143], v[156:159]
    s_waitcnt lgkmcnt(0)
    v_mfma_f32_16x16x32_bf16 v[96:99], v[176:179], a[144:147], v[96:99]
    ds_read_b128 v[160:163], v224 offset:40960
    v_mfma_f32_16x16x32_bf16 v[100:103], v[180:183], a[144:147], v[100:103]
    ds_read_b128 v[164:167], v224 offset:43008
    v_mfma_f32_16x16x32_bf16 v[104:107], v[176:179], a[148:151], v[104:107]
    ds_read_b128 v[168:171], v224 offset:45056
    v_mfma_f32_16x16x32_bf16 v[108:111], v[180:183], a[148:151], v[108:111]
    ds_read_b128 v[172:175], v224 offset:47104
    v_mfma_f32_16x16x32_bf16 v[112:115], v[176:179], a[152:155], v[112:115]
    v_mfma_f32_16x16x32_bf16 v[116:119], v[180:183], a[152:155], v[116:119]
    v_mfma_f32_16x16x32_bf16 v[120:123], v[176:179], a[156:159], v[120:123]
    v_mfma_f32_16x16x32_bf16 v[124:127], v[180:183], a[156:159], v[124:127]
    v_mfma_f32_16x16x32_bf16 v[128:131], v[184:187], a[144:147], v[128:131]
    v_mfma_f32_16x16x32_bf16 v[132:135], v[188:191], a[144:147], v[132:135]
    v_mfma_f32_16x16x32_bf16 v[136:139], v[184:187], a[148:151], v[136:139]
    v_mfma_f32_16x16x32_bf16 v[140:143], v[188:191], a[148:151], v[140:143]
    v_mfma_f32_16x16x32_bf16 v[144:147], v[184:187], a[152:155], v[144:147]
    v_mfma_f32_16x16x32_bf16 v[148:151], v[188:191], a[152:155], v[148:151]
    v_mfma_f32_16x16x32_bf16 v[152:155], v[184:187], a[156:159], v[152:155]
    v_mfma_f32_16x16x32_bf16 v[156:159], v[188:191], a[156:159], v[156:159]
    s_waitcnt lgkmcnt(0)
    v_mfma_f32_16x16x32_bf16 v[96:99], v[160:163], a[160:163], v[96:99]
    ds_read_b128 v[176:179], v225 offset:40960
    v_mfma_f32_16x16x32_bf16 v[100:103], v[164:167], a[160:163], v[100:103]
    ds_read_b128 v[180:183], v225 offset:43008
    v_mfma_f32_16x16x32_bf16 v[104:107], v[160:163], a[164:167], v[104:107]
    ds_read_b128 v[184:187], v225 offset:45056
    v_mfma_f32_16x16x32_bf16 v[108:111], v[164:167], a[164:167], v[108:111]
    ds_read_b128 v[188:191], v225 offset:47104
    v_mfma_f32_16x16x32_bf16 v[112:115], v[160:163], a[168:171], v[112:115]
    v_mfma_f32_16x16x32_bf16 v[116:119], v[164:167], a[168:171], v[116:119]
    v_mfma_f32_16x16x32_bf16 v[120:123], v[160:163], a[172:175], v[120:123]
    v_mfma_f32_16x16x32_bf16 v[124:127], v[164:167], a[172:175], v[124:127]
    v_mfma_f32_16x16x32_bf16 v[128:131], v[168:171], a[160:163], v[128:131]
    v_mfma_f32_16x16x32_bf16 v[132:135], v[172:175], a[160:163], v[132:135]
    v_mfma_f32_16x16x32_bf16 v[136:139], v[168:171], a[164:167], v[136:139]
    v_mfma_f32_16x16x32_bf16 v[140:143], v[172:175], a[164:167], v[140:143]
    v_mfma_f32_16x16x32_bf16 v[144:147], v[168:171], a[168:171], v[144:147]
    v_mfma_f32_16x16x32_bf16 v[148:151], v[172:175], a[168:171], v[148:151]
    v_mfma_f32_16x16x32_bf16 v[152:155], v[168:171], a[172:175], v[152:155]
    s_add_u32 s38, s36, 73728
    buffer_store_dwordx4 v[84:87], v240, s[16:19], s38 offen offset:3584 sc1
    v_mfma_f32_16x16x32_bf16 v[156:159], v[172:175], a[172:175], v[156:159]
    s_waitcnt vmcnt(5)
    v_readfirstlane_b32 s24, v254
    s_lshl_b32 s25, s3, 16
    s_add_u32 s24, s24, s25
    s_cmp_ge_u32 s24, 32
    s_cbranch_scc0 kf_spin43
kf_spinr44:
    s_waitcnt lgkmcnt(0)
    s_barrier
    v_mfma_f32_16x16x32_bf16 v[96:99], v[176:179], a[176:179], v[96:99]
    ds_read_b128 v[160:163], v224 offset:49152
    v_mfma_f32_16x16x32_bf16 v[100:103], v[180:183], a[176:179], v[100:103]
    ds_read_b128 v[164:167], v224 offset:51200
    v_mfma_f32_16x16x32_bf16 v[104:107], v[176:179], a[180:183], v[104:107]
    ds_read_b128 v[168:171], v224 offset:53248
    v_mfma_f32_16x16x32_bf16 v[108:111], v[180:183], a[180:183], v[108:111]
    ds_read_b128 v[172:175], v224 offset:55296
    v_mfma_f32_16x16x32_bf16 v[112:115], v[176:179], a[184:187], v[112:115]
    v_mfma_f32_16x16x32_bf16 v[116:119], v[180:183], a[184:187], v[116:119]
    buffer_load_dwordx4 v[0:3], v248, s[8:11], s28 offen offset:0 sc1
    v_mfma_f32_16x16x32_bf16 v[120:123], v[176:179], a[188:191], v[120:123]
    v_mfma_f32_16x16x32_bf16 v[124:127], v[180:183], a[188:191], v[124:127]
    buffer_load_dwordx4 v[4:7], v249, s[8:11], s28 offen offset:0 sc1
    v_mfma_f32_16x16x32_bf16 v[128:131], v[184:187], a[176:179], v[128:131]
    v_mfma_f32_16x16x32_bf16 v[132:135], v[188:191], a[176:179], v[132:135]
    buffer_load_dwordx4 v[8:11], v248, s[8:11], s28 offen offset:1024 sc1
    v_mfma_f32_16x16x32_bf16 v[136:139], v[184:187], a[180:183], v[136:139]
    v_mfma_f32_16x16x32_bf16 v[140:143], v[188:191], a[180:183], v[140:143]
    buffer_load_dwordx4 v[12:15], v249, s[8:11], s28 offen offset:1024 sc1
    v_mfma_f32_16x16x32_bf16 v[144:147], v[184:187], a[184:187], v[144:147]
    v_mfma_f32_16x16x32_bf16 v[148:151], v[188:191], a[184:187], v[148:151]
    v_mfma_f32_16x16x32_bf16 v[152:155], v[184:187], a[188:191], v[152:155]
    v_mfma_f32_16x16x32_bf16 v[156:159], v[188:191], a[188:191], v[156:159]
    s_waitcnt lgkmcnt(0)
    v_mfma_f32_16x16x32_bf16 v[96:99], v[160:163], a[192:195], v[96:99]
    ds_read_b128 v[176:179], v225 offset:49152
    v_mfma_f32_16x16x32_bf16 v[100:103], v[164:167], a[192:195], v[100:103]
    ds_read_b128 v[180:183], v225 offset:51200
    v_mfma_f32_16x16x32_bf16 v[104:107], v[160:163], a[196:199], v[104:107]
    ds_read_b128 v[184:187], v225 offset:53248
    v_mfma_f32_16x16x32_bf16 v[108:111], v[164:167], a[196:199], v[108:111]
    ds_read_b128 v[188:191], v225 offset:55296
    v_mfma_f32_16x16x32_bf16 v[112:115], v[160:163], a[200:203], v[112:115]
    v_mfma_f32_16x16x32_bf16 v[116:119], v[164:167], a[200:203], v[116:119]
    buffer_load_dwordx4 v[16:19], v248, s[8:11], s28 offen offset:2048 sc1
    v_mfma_f32_16x16x32_bf16 v[120:123], v[160:163], a[204:207], v[120:123]
    v_mfma_f32_16x16x32_bf16 v[124:127], v[164:167], a[204:207], v[124:127]
    buffer_load_dwordx4 v[20:23], v249, s[8:11], s28 offen offset:2048 sc1
    v_mfma_f32_16x16x32_bf16 v[128:131], v[168:171], a[192:195], v[128:131]
    v_mfma_f32_16x16x32_bf16 v[132:135], v[172:175], a[192:195], v[132:135]
    buffer_load_dwordx4 v[24:27], v248, s[8:11], s28 offen offset:3072 sc1
    v_mfma_f32_16x16x32_bf16 v[136:139], v[168:171], a[196:199], v[136:139]
    v_mfma_f32_16x16x32_bf16 v[140:143], v[172:175], a[196:199], v[140:143]
    buffer_load_dwordx4 v[28:31], v249, s[8:11], s28 offen offset:3072 sc1
    v_mfma_f32_16x16x32_bf16 v[144:147], v[168:171], a[200:203], v[144:147]
    v_mfma_f32_16x16x32_bf16 v[148:151], v[172:175], a[200:203], v[148:151]
    v_mfma_f32_16x16x32_bf16 v[152:155], v[168:171], a[204:207], v[152:155]
    v_mfma_f32_16x16x32_bf16 v[156:159], v[172:175], a[204:207], v[156:159]
    s_add_u32 s38, s36, 77824
    buffer_store_dwordx4 v[88:91], v240, s[16:19], s38 offen offset:512 sc1
    s_waitcnt lgkmcnt(0)
    v_mfma_f32_16x16x32_bf16 v[96:99], v[176:179], a[208:211], v[96:99]
    ds_read_b128 v[160:163], v224 offset:57344
    v_mfma_f32_16x16x32_bf16 v[100:103], v[180:183], a[208:211], v[100:103]
    ds_read_b128 v[164:167], v224 offset:59392
    v_mfma_f32_16x16x32_bf16 v[104:107], v[176:179], a[212:215], v[104:107]
    ds_read_b128 v[168:171], v224 offset:61440
    v_mfma_f32_16x16x32_bf16 v[108:111], v[180:183], a[212:215], v[108:111]
    ds_read_b128 v[172:175], v224 offset:63488
    v_mfma_f32_16x16x32_bf16 v[112:115], v[176:179], a[216:219], v[112:115]
    v_mfma_f32_16x16x32_bf16 v[116:119], v[180:183], a[216:219], v[116:119]
    buffer_load_dwordx4 v[32:35], v248, s[8:11], s29 offen offset:0 sc1
    v_mfma_f32_16x16x32_bf16 v[120:123], v[176:179], a[220:223], v[120:123]
    v_mfma_f32_16x16x32_bf16 v[124:127], v[180:183], a[220:223], v[124:127]
    buffer_load_dwordx4 v[36:39], v249, s[8:11], s29 offen offset:0 sc1
    v_mfma_f32_16x16x32_bf16 v[128:131], v[184:187], a[208:211], v[128:131]
    v_mfma_f32_16x16x32_bf16 v[132:135], v[188:191], a[208:211], v[132:135]
    buffer_load_dwordx4 v[40:43], v248, s[8:11], s29 offen offset:1024 sc1
    v_mfma_f32_16x16x32_bf16 v[136:139], v[184:187], a[212:215], v[136:139]
    v_mfma_f32_16x16x32_bf16 v[140:143], v[188:191], a[212:215], v[140:143]
    buffer_load_dwordx4 v[44:47], v249, s[8:11], s29 offen offset:1024 sc1
    v_mfma_f32_16x16x32_bf16 v[144:147], v[184:187], a[216:219], v[144:147]
    v_mfma_f32_16x16x32_bf16 v[148:151], v[188:191], a[216:219], v[148:151]
    v_mfma_f32_16x16x32_bf16 v[152:155], v[184:187], a[220:223], v[152:155]
    v_mfma_f32_16x16x32_bf16 v[156:159], v[188:191], a[220:223], v[156:159]
    s_waitcnt lgkmcnt(0)
    v_mfma_f32_16x16x32_bf16 v[96:99], v[160:163], a[224:227], v[96:99]
    ds_read_b128 v[176:179], v225 offset:57344
    v_mfma_f32_16x16x32_bf16 v[100:103], v[164:167], a[224:227], v[100:103]
    ds_read_b128 v[180:183], v225 offset:59392
    v_mfma_f32_16x16x32_bf16 v[104:107], v[160:163], a[228:231], v[104:107]
    ds_read_b128 v[184:187], v225 offset:61440
    v_mfma_f32_16x16x32_bf16 v[108:111], v[164:167], a[228:231], v[108:111]
    ds_read_b128 v[188:191], v225 offset:63488
    v_mfma_f32_16x16x32_bf16 v[112:115], v[160:163], a[232:235], v[112:115]
    v_mfma_f32_16x16x32_bf16 v[116:119], v[164:167], a[232:235], v[116:119]
    buffer_load_dwordx4 v[48:51], v248, s[8:11], s29 offen offset:2048 sc1
    v_mfma_f32_16x16x32_bf16 v[120:123], v[160:163], a[236:239], v[120:123]
    v_mfma_f32_16x16x32_bf16 v[124:127], v[164:167], a[236:239], v[124:127]
    buffer_load_dwordx4 v[52:55], v249, s[8:11], s29 offen offset:2048 sc1
    v_mfma_f32_16x16x32_bf16 v[128:131], v[168:171], a[224:227], v[128:131]
    v_mfma_f32_16x16x32_bf16 v[132:135], v[172:175], a[224:227], v[132:135]
    buffer_load_dwordx4 v[56:59], v248, s[8:11], s29 offen offset:3072 sc1
    v_mfma_f32_16x16x32_bf16 v[136:139], v[168:171], a[228:231], v[136:139]
    v_mfma_f32_16x16x32_bf16 v[140:143], v[172:175], a[228:231], v[140:143]
    buffer_load_dwordx4 v[60:63], v249, s[8:11], s29 offen offset:3072 sc1
    v_mfma_f32_16x16x32_bf16 v[144:147], v[168:171], a[232:235], v[144:147]
    v_mfma_f32_16x16x32_bf16 v[148:151], v[172:175], a[232:235], v[148:151]
    v_mfma_f32_16x16x32_bf16 v[152:155], v[168:171], a[236:239], v[152:155]
    v_mfma_f32_16x16x32_bf16 v[156:159], v[172:175], a[236:239], v[156:159]
    s_waitcnt vmcnt(32) lgkmcnt(0)
    s_barrier
    v_mfma_f32_16x16x32_bf16 v[96:99], v[176:179], a[240:243], v[96:99]
    ds_read_b64_tr_b16 a[192:193], v246 offset:0
    s_add_u32 s38, s36, 77824
    buffer_store_dwordx4 v[92:95], v240, s[16:19], s38 offen offset:1536 sc1
    v_mfma_f32_16x16x32_bf16 v[100:103], v[180:183], a[240:243], v[100:103]
    ds_read_b64_tr_b16 a[194:195], v246 offset:1024
    v_mfma_f32_16x16x32_bf16 v[104:107], v[176:179], a[244:247], v[104:107]
    ds_read_b64_tr_b16 a[196:197], v246 offset:256
    v_mfma_f32_16x16x32_bf16 v[108:111], v[180:183], a[244:247], v[108:111]
    ds_read_b64_tr_b16 a[198:199], v246 offset:1280
    v_mfma_f32_16x16x32_bf16 v[112:115], v[176:179], a[248:251], v[112:115]
    ds_read_b64_tr_b16 a[200:201], v246 offset:512
    v_mfma_f32_16x16x32_bf16 v[116:119], v[180:183], a[248:251], v[116:119]
    ds_read_b64_tr_b16 a[202:203], v246 offset:1536
    s_add_u32 s28, s28, 8192
    s_and_b32 s28, s28, 65535
    s_add_u32 s29, s28, 4096
    v_mfma_f32_16x16x32_bf16 v[120:123], v[176:179], a[252:255], v[120:123]
    ds_read_b64_tr_b16 a[204:205], v246 offset:768
    v_mfma_f32_16x16x32_bf16 v[124:127], v[180:183], a[252:255], v[124:127]
    ds_read_b64_tr_b16 a[206:207], v246 offset:1792
    v_mfma_f32_16x16x32_bf16 v[128:131], v[184:187], a[240:243], v[128:131]
    v_mfma_f32_16x16x32_bf16 v[132:135], v[188:191], a[240:243], v[132:135]
    v_cvt_pk_bf16_f32 v64, v96, v97
    v_cvt_pk_bf16_f32 v65, v98, v99
    v_mfma_f32_16x16x32_bf16 v[136:139], v[184:187], a[244:247], v[136:139]
    v_cvt_pk_bf16_f32 v66, v100, v101
    v_cvt_pk_bf16_f32 v67, v102, v103
    v_mfma_f32_16x16x32_bf16 v[140:143], v[188:191], a[244:247], v[140:143]
    v_cvt_pk_bf16_f32 v68, v104, v105
    v_cvt_pk_bf16_f32 v69, v106, v107
    v_mfma_f32_16x16x32_bf16 v[144:147], v[184:187], a[248:251], v[144:147]
    v_cvt_pk_bf16_f32 v70, v108, v109
    v_cvt_pk_bf16_f32 v71, v110, v111
    v_mfma_f32_16x16x32_bf16 v[148:151], v[188:191], a[248:251], v[148:151]
    v_cvt_pk_bf16_f32 v72, v112, v113
    v_cvt_pk_bf16_f32 v73, v114, v115
    v_mfma_f32_16x16x32_bf16 v[152:155], v[184:187], a[252:255], v[152:155]
    v_cvt_pk_bf16_f32 v74, v116, v117
    v_cvt_pk_bf16_f32 v75, v118, v119
    v_mfma_f32_16x16x32_bf16 v[156:159], v[188:191], a[252:255], v[156:159]
    v_cvt_pk_bf16_f32 v76, v120, v121
    v_cvt_pk_bf16_f32 v77, v122, v123
    s_nop 3
    v_cvt_pk_bf16_f32 v78, v124, v125
    v_cvt_pk_bf16_f32 v79, v126, v127
    v_cvt_pk_bf16_f32 v80, v128, v129
    v_cvt_pk_bf16_f32 v81, v130, v131
    v_cvt_pk_bf16_f32 v82, v132, v133
    v_cvt_pk_bf16_f32 v83, v134, v135
    v_cvt_pk_bf16_f32 v84, v136, v137
    v_cvt_pk_bf16_f32 v85, v138, v139
    v_cvt_pk_bf16_f32 v86, v140, v141
    v_cvt_pk_bf16_f32 v87, v142, v143
    v_cvt_pk_bf16_f32 v88, v144, v145
    v_cvt_pk_bf16_f32 v89, v146, v147
    v_cvt_pk_bf16_f32 v90, v148, v149
    v_cvt_pk_bf16_f32 v91, v150, v151
    v_cvt_pk_bf16_f32 v92, v152, v153
    v_cvt_pk_bf16_f32 v93, v154, v155
    v_cvt_pk_bf16_f32 v94, v156, v157
    v_cvt_pk_bf16_f32 v95, v158, v159
    s_add_u32 s80, s36, 102144
    s_add_u32 s81, s36, 103168
    s_add_u32 s82, s36, 104192
    s_add_u32 s83, s36, 105216
    s_add_u32 s84, s36, 110336
    s_add_u32 s85, s36, 111360
    s_add_u32 s86, s36, 112384
    s_add_u32 s87, s36, 113408
ka_Q:
    s_waitcnt vmcnt(16) lgkmcnt(0)
    v_mfma_f32_32x32x16_bf16 v[96:111], a[192:195], v[0:3], 0
    ds_read_b64_tr_b16 a[208:209], v246 offset:4096
    ds_read_b64_tr_b16 a[210:211], v246 offset:5120
    s_lshl_b32 s97, s4, 2
    s_add_u32 s97, s97, 64
    s_cmp_eq_u32 s3, 0
    s_cselect_b32 s35, s97, s43
    v_mfma_f32_32x32x16_bf16 v[160:175], a[192:195], v[4:7], 0
    ds_read_b64_tr_b16 a[212:213], v246 offset:4352
    ds_read_b64_tr_b16 a[214:215], v246 offset:5376
    s_lshl_b32 s37, s3, 12
    s_mov_b32 s34, s37
    v_mfma_f32_32x32x16_bf16 v[112:127], a[196:199], v[0:3], 0
    ds_read_b64_tr_b16 a[216:217], v246 offset:4608
    ds_read_b64_tr_b16 a[218:219], v246 offset:5632
    s_mul_i32 s32, s4, 1089536
    s_mov_b32 s33, 0
    s_lshl_b32 s39, s6, 18
    v_mfma_f32_32x32x16_bf16 v[176:191], a[196:199], v[4:7], 0
    ds_read_b64_tr_b16 a[220:221], v246 offset:4864
    ds_read_b64_tr_b16 a[222:223], v246 offset:5888
    s_sub_u32 s25, 63, s6
    s_lshl_b32 s40, s25, 18
    v_mfma_f32_32x32x16_bf16 v[128:143], a[200:203], v[0:3], 0
    s_lshl_b32 s25, s4, 12
    s_add_u32 s39, s39, s25
    s_add_u32 s40, s40, s25
    s_mov_b32 s38, 0x47800000
    v_mfma_f32_32x32x16_bf16 v[192:207], a[200:203], v[4:7], 0
    s_mov_b32 s36, s6
    s_mov_b32 s26, 6
    s_mov_b32 s52, s41
    s_mov_b32 s53, s42
    v_mfma_f32_32x32x16_bf16 v[144:159], a[204:207], v[0:3], 0
    s_add_u32 m0, s31, 0
    s_add_u32 s24, s27, 0
    buffer_load_dwordx4 v245, s[12:15], s24 offen lds
    s_mov_b32 s54, 0x700000
    s_add_u32 s48, s20, 0x1c00000
    s_addc_u32 s49, s21, 0
    v_mfma_f32_32x32x16_bf16 v[208:223], a[204:207], v[4:7], 0
    buffer_store_dwordx4 v[64:67], v240, s[16:19], s80 offen sc1
    s_mov_b32 s50, 0xe00000
    s_and_b32 s25, s3, 1
    s_lshl1_add_u32 s47, s4, s25
    s_waitcnt vmcnt(16) lgkmcnt(0)
    v_mfma_f32_32x32x16_bf16 v[96:111], a[208:211], v[8:11], v[96:111]
    ds_read_b64_tr_b16 a[192:193], v246 offset:8192
    ds_read_b64_tr_b16 a[194:195], v246 offset:9216
    s_mul_i32 s45, s5, s5
    s_lshl_b32 s100, s47, 17
    v_mfma_f32_32x32x16_bf16 v[160:175], a[208:211], v[12:15], v[160:175]
    ds_read_b64_tr_b16 a[196:197], v246 offset:8448
    ds_read_b64_tr_b16 a[198:199], v246 offset:9472
    s_lshl_b32 s25, s45, 11
    s_add_u32 s100, s100, s25
    s_lshl_b32 s46, s47, 9
    v_mfma_f32_32x32x16_bf16 v[112:127], a[212:215], v[8:11], v[112:127]
    ds_read_b64_tr_b16 a[200:201], v246 offset:8704
    ds_read_b64_tr_b16 a[202:203], v246 offset:9728
    s_mul_i32 s44, s47, 114688
    s_add_u32 s47, s44, 7168
    v_mfma_f32_32x32x16_bf16 v[176:191], a[212:215], v[12:15], v[176:191]
    ds_read_b64_tr_b16 a[204:205], v246 offset:8960
    ds_read_b64_tr_b16 a[206:207], v246 offset:9984
    s_lshl_b32 s25, s45, 7
    s_add_u32 s44, s44, s25
    s_lshl_b32 s45, s45, 18
    v_mfma_f32_32x32x16_bf16 v[128:143], a[216:219], v[8:11], v[128:143]
    buffer_load_dwordx4 v[0:3], v248, s[8:11], s28 offen offset:0 sc1
    s_add_u32 s46, s46, s45
    s_lshr_b32 s25, s3, 1
    s_lshl_b32 s25, s25, 15
    v_mfma_f32_32x32x16_bf16 v[192:207], a[216:219], v[12:15], v[192:207]
    buffer_load_dwordx4 v[4:7], v249, s[8:11], s28 offen offset:0 sc1
    s_add_u32 s46, s46, s25
    s_mov_b32 s45, s43
    v_accvgpr_write_b32 a0, 0
    v_accvgpr_write_b32 a1, 0
    v_mfma_f32_32x32x16_bf16 v[144:159], a[220:223], v[8:11], v[144:159]
    s_add_u32 m0, s31, 1024
    s_add_u32 s24, s27, 32768
    buffer_load_dwordx4 v245, s[12:15], s24 offen lds
    v_accvgpr_write_b32 a2, 0
    v_accvgpr_write_b32 a3, 0
    v_mfma_f32_32x32x16_bf16 v[208:223], a[220:223], v[12:15], v[208:223]
    buffer_store_dwordx4 v[68:71], v240, s[16:19], s81 offen sc1
    v_accvgpr_write_b32 a4, 0
    v_accvgpr_write_b32 a5, 0
    s_waitcnt vmcnt(18) lgkmcnt(0)
    v_mfma_f32_32x32x16_bf16 v[96:111], a[192:195], v[16:19], v[96:111]
    ds_read_b64_tr_b16 a[208:209], v246 offset:12288
    ds_read_b64_tr_b16 a[210:211], v246 offset:13312
    s_load_dwordx2 s[56:57], s[0:1], 40
    v_accvgpr_write_b32 a6, 0
    v_accvgpr_write_b32 a7, 0
    v_mfma_f32_32x32x16_bf16 v[160:175], a[192:195], v[20:23], v[160:175]
    ds_read_b64_tr_b16 a[212:213], v246 offset:12544
    ds_read_b64_tr_b16 a[214:215], v246 offset:13568
    v_accvgpr_write_b32 a8, 0
    v_accvgpr_write_b32 a9, 0
    v_accvgpr_write_b32 a10, 0
    v_mfma_f32_32x32x16_bf16 v[112:127], a[196:199], v[16:19], v[112:127]
    ds_read_b64_tr_b16 a[216:217], v246 offset:12800
    ds_read_b64_tr_b16 a[218:219], v246 offset:13824
    v_accvgpr_write_b32 a11, 0
    v_accvgpr_write_b32 a12, 0
    v_mfma_f32_32x32x16_bf16 v[176:191], a[196:199], v[20:23], v[176:191]
    ds_read_b64_tr_b16 a[220:221], v246 offset:13056
    ds_read_b64_tr_b16 a[222:223], v246 offset:14080
    v_accvgpr_write_b32 a13, 0
    v_accvgpr_write_b32 a14, 0
    v_accvgpr_write_b32 a15, 0
    v_mfma_f32_32x32x16_bf16 v[128:143], a[200:203], v[16:19], v[128:143]
    buffer_load_dwordx4 v[8:11], v248, s[8:11], s28 offen offset:1024 sc1
    v_accvgpr_write_b32 a16, 0
    v_accvgpr_write_b32 a17, 0
    v_accvgpr_write_b32 a18, 0
    v_mfma_f32_32x32x16_bf16 v[192:207], a[200:203], v[20:23], v[192:207]
    buffer_load_dwordx4 v[12:15], v249, s[8:11], s28 offen offset:1024 sc1
    v_accvgpr_write_b32 a19, 0
    v_accvgpr_write_b32 a20, 0
    v_accvgpr_write_b32 a21, 0
    v_mfma_f32_32x32x16_bf16 v[144:159], a[204:207], v[16:19], v[144:159]
    s_add_u32 m0, s31, 2048
    s_add_u32 s24, s27, 65536
    buffer_load_dwordx4 v245, s[12:15], s24 offen lds
    v_accvgpr_write_b32 a22, 0
    v_accvgpr_write_b32 a23, 0
    v_mfma_f32_32x32x16_bf16 v[208:223], a[204:207], v[20:23], v[208:223]
    buffer_store_dwordx4 v[72:75], v240, s[16:19], s82 offen sc1
    v_accvgpr_write_b32 a24, 0
    v_accvgpr_write_b32 a25, 0
    v_accvgpr_write_b32 a26, 0
    s_waitcnt vmcnt(20) lgkmcnt(0)
    v_mfma_f32_32x32x16_bf16 v[96:111], a[208:211], v[24:27], v[96:111]
    ds_read_b64_tr_b16 a[192:193], v246 offset:16384
    ds_read_b64_tr_b16 a[194:195], v246 offset:17408
    v_accvgpr_write_b32 a27, 0
    v_accvgpr_write_b32 a28, 0
    v_mfma_f32_32x32x16_bf16 v[160:175], a[208:211], v[28:31], v[160:175]
    ds_read_b64_tr_b16 a[196:197], v246 offset:16640
    ds_read_b64_tr_b16 a[198:199], v246 offset:17664
    v_accvgpr_write_b32 a29, 0
    v_accvgpr_write_b32 a30, 0
    v_accvgpr_write_b32 a31, 0
    v_mfma_f32_32x32x16_bf16 v[112:127], a[212:215], v[24:27], v[112:127]
    ds_read_b64_tr_b16 a[200:201], v246 offset:16896
    ds_read_b64_tr_b16 a[202:203], v246 offset:17920
    v_accvgpr_write_b32 a32, 0
    v_accvgpr_write_b32 a33, 0
    v_accvgpr_write_b32 a34, 0
    v_mfma_f32_32x32x16_bf16 v[176:191], a[212:215], v[28:31], v[176:191]
    ds_read_b64_tr_b16 a[204:205], v246 offset:17152
    ds_read_b64_tr_b16 a[206:207], v246 offset:18176
    v_accvgpr_write_b32 a35, 0
    v_accvgpr_write_b32 a36, 0
    v_mfma_f32_32x32x16_bf16 v[128:143], a[216:219], v[24:27], v[128:143]
    buffer_load_dwordx4 v[16:19], v248, s[8:11], s28 offen offset:2048 sc1
    v_accvgpr_write_b32 a37, 0
    v_accvgpr_write_b32 a38, 0
    v_accvgpr_write_b32 a39, 0
    v_mfma_f32_32x32x16_bf16 v[192:207], a[216:219], v[28:31], v[192:207]
    buffer_load_dwordx4 v[20:23], v249, s[8:11], s28 offen offset:2048 sc1
    v_accvgpr_write_b32 a40, 0
    v_accvgpr_write_b32 a41, 0
    v_accvgpr_write_b32 a42, 0
    v_accvgpr_write_b32 a43, 0
    v_mfma_f32_32x32x16_bf16 v[144:159], a[220:223], v[24:27], v[144:159]
    s_add_u32 m0, s31, 3072
    s_add_u32 s24, s27, 98304
    buffer_load_dwordx4 v245, s[12:15], s24 offen lds
    v_accvgpr_write_b32 a44, 0
    v_accvgpr_write_b32 a45, 0
    v_mfma_f32_32x32x16_bf16 v[208:223], a[220:223], v[28:31], v[208:223]
    buffer_store_dwordx4 v[76:79], v240, s[16:19], s83 offen sc1
    v_accvgpr_write_b32 a46, 0
    v_accvgpr_write_b32 a47, 0
    s_waitcnt vmcnt(21) lgkmcnt(0)
    v_mfma_f32_32x32x16_bf16 v[96:111], a[192:195], v[32:35], v[96:111]
    ds_read_b64_tr_b16 a[208:209], v246 offset:20480
    ds_read_b64_tr_b16 a[210:211], v246 offset:21504
    v_accvgpr_write_b32 a48, 0
    v_accvgpr_write_b32 a49, 0
    v_accvgpr_write_b32 a50, 0
    v_mfma_f32_32x32x16_bf16 v[160:175], a[192:195], v[36:39], v[160:175]
    ds_read_b64_tr_b16 a[212:213], v246 offset:20736
    ds_read_b64_tr_b16 a[214:215], v246 offset:21760
    v_accvgpr_write_b32 a51, 0
    v_accvgpr_write_b32 a52, 0
    v_mfma_f32_32x32x16_bf16 v[112:127], a[196:199], v[32:35], v[112:127]
    ds_read_b64_tr_b16 a[216:217], v246 offset:20992
    ds_read_b64_tr_b16 a[218:219], v246 offset:22016
    v_accvgpr_write_b32 a53, 0
    v_accvgpr_write_b32 a54, 0
    v_accvgpr_write_b32 a55, 0
    v_mfma_f32_32x32x16_bf16 v[176:191], a[196:199], v[36:39], v[176:191]
    ds_read_b64_tr_b16 a[220:221], v246 offset:21248
    ds_read_b64_tr_b16 a[222:223], v246 offset:22272
    v_accvgpr_write_b32 a56, 0
    v_accvgpr_write_b32 a57, 0
    v_accvgpr_write_b32 a58, 0
    v_mfma_f32_32x32x16_bf16 v[128:143], a[200:203], v[32:35], v[128:143]
    buffer_load_dwordx4 v[24:27], v248, s[8:11], s28 offen offset:3072 sc1
    v_accvgpr_write_b32 a59, 0
    v_accvgpr_write_b32 a60, 0
    v_accvgpr_write_b32 a61, 0
    v_mfma_f32_32x32x16_bf16 v[192:207], a[200:203], v[36:39], v[192:207]
    buffer_load_dwordx4 v[28:31], v249, s[8:11], s28 offen offset:3072 sc1
    v_accvgpr_write_b32 a62, 0
    v_accvgpr_write_b32 a63, 0
    v_accvgpr_write_b32 a64, 0
    v_mfma_f32_32x32x16_bf16 v[144:159], a[204:207], v[32:35], v[144:159]
    s_add_u32 m0, s31, 4096
    s_add_u32 s24, s27, 131072
    buffer_load_dwordx4 v245, s[12:15], s24 offen lds
    v_accvgpr_write_b32 a65, 0
    v_accvgpr_write_b32 a66, 0
    v_mfma_f32_32x32x16_bf16 v[208:223], a[204:207], v[36:39], v[208:223]
    buffer_store_dwordx4 v[80:83], v240, s[16:19], s84 offen sc1
    v_accvgpr_write_b32 a67, 0
    v_accvgpr_write_b32 a68, 0
    v_accvgpr_write_b32 a69, 0
    s_waitcnt vmcnt(23) lgkmcnt(0)
    v_mfma_f32_32x32x16_bf16 v[96:111], a[208:211], v[40:43], v[96:111]
    ds_read_b64_tr_b16 a[192:193], v246 offset:24576
    ds_read_b64_tr_b16 a[194:195], v246 offset:25600
    v_accvgpr_write_b32 a70, 0
    v_accvgpr_write_b32 a71, 0
    v_mfma_f32_32x32x16_bf16 v[160:175], a[208:211], v[44:47], v[160:175]
    ds_read_b64_tr_b16 a[196:197], v246 offset:24832
    ds_read_b64_tr_b16 a[198:199], v246 offset:25856
    v_accvgpr_write_b32 a72, 0
    v_accvgpr_write_b32 a73, 0
    v_accvgpr_write_b32 a74, 0
    v_mfma_f32_32x32x16_bf16 v[112:127], a[212:215], v[40:43], v[112:127]
    ds_read_b64_tr_b16 a[200:201], v246 offset:25088
    ds_read_b64_tr_b16 a[202:203], v246 offset:26112
    v_accvgpr_write_b32 a75, 0
    v_accvgpr_write_b32 a76, 0
    v_mfma_f32_32x32x16_bf16 v[176:191], a[212:215], v[44:47], v[176:191]
    ds_read_b64_tr_b16 a[204:205], v246 offset:25344
    ds_read_b64_tr_b16 a[206:207], v246 offset:26368
    v_accvgpr_write_b32 a77, 0
    v_accvgpr_write_b32 a78, 0
    v_accvgpr_write_b32 a79, 0
    v_mfma_f32_32x32x16_bf16 v[128:143], a[216:219], v[40:43], v[128:143]
    buffer_load_dwordx4 v[32:35], v248, s[8:11], s29 offen offset:0 sc1
    v_accvgpr_write_b32 a80, 0
    v_accvgpr_write_b32 a81, 0
    v_accvgpr_write_b32 a82, 0
    v_mfma_f32_32x32x16_bf16 v[192:207], a[216:219], v[44:47], v[192:207]
    buffer_load_dwordx4 v[36:39], v249, s[8:11], s29 offen offset:0 sc1
    v_accvgpr_write_b32 a83, 0
    v_accvgpr_write_b32 a84, 0
    v_accvgpr_write_b32 a85, 0
    v_accvgpr_write_b32 a86, 0
    v_mfma_f32_32x32x16_bf16 v[144:159], a[220:223], v[40:43], v[144:159]
    s_add_u32 m0, s31, 5120
    s_add_u32 s24, s27, 163840
    buffer_load_dwordx4 v245, s[12:15], s24 offen lds
    v_accvgpr_write_b32 a87, 0
    v_mfma_f32_32x32x16_bf16 v[208:223], a[220:223], v[44:47], v[208:223]
    buffer_store_dwordx4 v[84:87], v240, s[16:19], s85 offen sc1
    v_accvgpr_write_b32 a88, 0
    v_accvgpr_write_b32 a89, 0
    v_accvgpr_write_b32 a90, 0
    s_waitcnt vmcnt(25) lgkmcnt(0)
    v_mfma_f32_32x32x16_bf16 v[96:111], a[192:195], v[48:51], v[96:111]
    ds_read_b64_tr_b16 a[208:209], v246 offset:28672
    ds_read_b64_tr_b16 a[210:211], v246 offset:29696
    v_accvgpr_write_b32 a91, 0
    v_accvgpr_write_b32 a92, 0
    v_accvgpr_write_b32 a93, 0
    v_mfma_f32_32x32x16_bf16 v[160:175], a[192:195], v[52:55], v[160:175]
    ds_read_b64_tr_b16 a[212:213], v246 offset:28928
    ds_read_b64_tr_b16 a[214:215], v246 offset:29952
    v_accvgpr_write_b32 a94, 0
    v_accvgpr_write_b32 a95, 0
    v_mfma_f32_32x32x16_bf16 v[112:127], a[196:199], v[48:51], v[112:127]
    ds_read_b64_tr_b16 a[216:217], v246 offset:29184
    ds_read_b64_tr_b16 a[218:219], v246 offset:30208
    v_accvgpr_write_b32 a96, 0
    v_accvgpr_write_b32 a97, 0
    v_accvgpr_write_b32 a98, 0
    v_mfma_f32_32x32x16_bf16 v[176:191], a[196:199], v[52:55], v[176:191]
    ds_read_b64_tr_b16 a[220:221], v246 offset:29440
    ds_read_b64_tr_b16 a[222:223], v246 offset:30464
    v_accvgpr_write_b32 a99, 0
    v_accvgpr_write_b32 a100, 0
    v_mfma_f32_32x32x16_bf16 v[128:143], a[200:203], v[48:51], v[128:143]
    buffer_load_dwordx4 v[40:43], v248, s[8:11], s29 offen offset:1024 sc1
    v_accvgpr_write_b32 a101, 0
    v_accvgpr_write_b32 a102, 0
    v_accvgpr_write_b32 a103, 0
    v_accvgpr_write_b32 a104, 0
    v_mfma_f32_32x32x16_bf16 v[192:207], a[200:203], v[52:55], v[192:207]
    buffer_load_dwordx4 v[44:47], v249, s[8:11], s29 offen offset:1024 sc1
    v_accvgpr_write_b32 a105, 0
    v_accvgpr_write_b32 a106, 0
    v_accvgpr_write_b32 a107, 0
    v_mfma_f32_32x32x16_bf16 v[144:159], a[204:207], v[48:51], v[144:159]
    s_add_u32 m0, s31, 6144
    s_add_u32 s24, s27, 196608
    buffer_load_dwordx4 v245, s[12:15], s24 offen lds
    v_accvgpr_write_b32 a108, 0
    v_accvgpr_write_b32 a109, 0
    v_mfma_f32_32x32x16_bf16 v[208:223], a[204:207], v[52:55], v[208:223]
    buffer_store_dwordx4 v[88:91], v240, s[16:19], s86 offen sc1
    s_waitcnt vmcnt(27) lgkmcnt(0)
    s_barrier
    s_add_u32 s30, s30, 32768
    s_cmp_ge_u32 s30, 163840
    s_cselect_b32 s24, 98304, 0
    s_sub_u32 s30, s30, s24
    v_add_u32 v246, s30, v247
    v_mfma_f32_32x32x16_bf16 v[96:111], a[208:211], v[56:59], v[96:111]
    ds_read_b64_tr_b16 a[192:193], v246 offset:0
    ds_read_b64_tr_b16 a[194:195], v246 offset:1024
    v_accvgpr_write_b32 a110, 0
    v_accvgpr_write_b32 a111, 0
    v_mfma_f32_32x32x16_bf16 v[160:175], a[208:211], v[60:63], v[160:175]
    ds_read_b64_tr_b16 a[196:197], v246 offset:256
    ds_read_b64_tr_b16 a[198:199], v246 offset:1280
    v_accvgpr_write_b32 a112, 0
    v_accvgpr_write_b32 a113, 0
    v_accvgpr_write_b32 a114, 0
    v_mfma_f32_32x32x16_bf16 v[112:127], a[212:215], v[56:59], v[112:127]
    ds_read_b64_tr_b16 a[200:201], v246 offset:512
    ds_read_b64_tr_b16 a[202:203], v246 offset:1536
    v_accvgpr_write_b32 a115, 0
    v_accvgpr_write_b32 a116, 0
    v_accvgpr_write_b32 a117, 0
    v_mfma_f32_32x32x16_bf16 v[176:191], a[212:215], v[60:63], v[176:191]
    ds_read_b64_tr_b16 a[204:205], v246 offset:768
    ds_read_b64_tr_b16 a[206:207], v246 offset:1792
    buffer_store_dwordx4 v[92:95], v240, s[16:19], s87 offen sc1
    v_accvgpr_write_b32 a118, 0
    v_accvgpr_write_b32 a119, 0
    v_mfma_f32_32x32x16_bf16 v[128:143], a[216:219], v[56:59], v[128:143]
    buffer_load_dwordx4 v[48:51], v248, s[8:11], s29 offen offset:2048 sc1
    v_accvgpr_write_b32 a120, 0
    v_accvgpr_write_b32 a121, 0
    v_accvgpr_write_b32 a122, 0
    v_mfma_f32_32x32x16_bf16 v[192:207], a[216:219], v[60:63], v[192:207]
    buffer_load_dwordx4 v[52:55], v249, s[8:11], s29 offen offset:2048 sc1
    v_accvgpr_write_b32 a123, 0
    v_accvgpr_write_b32 a124, 0
    v_accvgpr_write_b32 a125, 0
    v_mfma_f32_32x32x16_bf16 v[144:159], a[220:223], v[56:59], v[144:159]
    s_add_u32 m0, s31, 7168
    s_add_u32 s24, s27, 229376
    buffer_load_dwordx4 v245, s[12:15], s24 offen lds
    v_accvgpr_write_b32 a126, 0
    v_accvgpr_write_b32 a127, 0
    v_mfma_f32_32x32x16_bf16 v[208:223], a[220:223], v[60:63], v[208:223]
    buffer_load_dwordx4 v[56:59], v248, s[8:11], s29 offen offset:3072 sc1
    buffer_load_dwordx4 v[60:63], v249, s[8:11], s29 offen offset:3072 sc1
    s_add_u32 s28, s28, 8192
    s_and_b32 s28, s28, 65535
    s_add_u32 s29, s28, 4096
    s_add_u32 s27, s27, 1048576
    s_and_b32 s27, s27, 0x407fffff
    s_cmp_eq_u32 s27, s7
    s_cselect_b32 s27, s43, s27
    s_add_u32 s31, s31, 32768
    s_cmp_ge_u32 s31, 163840
    s_cselect_b32 s24, 98304, 0
    s_sub_u32 s31, s31, s24
.p2align 3
ka_qp:
    s_waitcnt vmcnt(22) lgkmcnt(0)
    v_mfma_f32_32x32x16_bf16 v[96:111], a[192:195], v[0:3], v[96:111]
    ds_read_b64_tr_b16 a[208:209], v246 offset:4096
    ds_read_b64_tr_b16 a[210:211], v246 offset:5120
    v_mfma_f32_32x32x16_bf16 v[160:175], a[192:195], v[4:7], v[160:175]
    ds_read_b64_tr_b16 a[212:213], v246 offset:4352
    ds_read_b64_tr_b16 a[214:215], v246 offset:5376
    v_mfma_f32_32x32x16_bf16 v[112:127], a[196:199], v[0:3], v[112:127]
    ds_read_b64_tr_b16 a[216:217], v246 offset:4608
    ds_read_b64_tr_b16 a[218:219], v246 offset:5632
    v_mfma_f32_32x32x16_bf16 v[176:191], a[196:199], v[4:7], v[176:191]
    ds_read_b64_tr_b16 a[220:221], v246 offset:4864
    ds_read_b64_tr_b16 a[222:223], v246 offset:5888
    v_mfma_f32_32x32x16_bf16 v[128:143], a[200:203], v[0:3], v[128:143]
    s_cmp_eq_u32 s26, 1
    s_cselect_b32 s41, s35, s43
    buffer_load_dword v254, off, s[88:91], s41 sc1
    v_mfma_f32_32x32x16_bf16 v[192:207], a[200:203], v[4:7], v[192:207]
    v_mfma_f32_32x32x16_bf16 v[144:159], a[204:207], v[0:3], v[144:159]
    s_add_u32 m0, s31, 0
    s_add_u32 s24, s27, 0
    buffer_load_dwordx4 v245, s[12:15], s24 offen lds
    v_mfma_f32_32x32x16_bf16 v[208:223], a[204:207], v[4:7], v[208:223]
    s_waitcnt vmcnt(21) lgkmcnt(0)
    v_mfma_f32_32x32x16_bf16 v[96:111], a[208:211], v[8:11], v[96:111]
    ds_read_b64_tr_b16 a[192:193], v246 offset:8192
    ds_read_b64_tr_b16 a[194:195], v246 offset:9216
    v_mfma_f32_32x32x16_bf16 v[160:175], a[208:211], v[12:15], v[160:175]
    ds_read_b64_tr_b16 a[196:197], v246 offset:8448
    ds_read_b64_tr_b16 a[198:199], v246 offset:9472
    v_mfma_f32_32x32x16_bf16 v[112:127], a[212:215], v[8:11], v[112:127]
    ds_read_b64_tr_b16 a[200:201], v246 offset:8704
    ds_read_b64_tr_b16 a[202:203], v246 offset:9728
    v_mfma_f32_32x32x16_bf16 v[176:191], a[212:215], v[12:15], v[176:191]
    ds_read_b64_tr_b16 a[204:205], v246 offset:8960
    ds_read_b64_tr_b16 a[206:207], v246 offset:9984
    v_mfma_f32_32x32x16_bf16 v[128:143], a[216:219], v[8:11], v[128:143]
    buffer_load_dwordx4 v[0:3], v248, s[8:11], s28 offen offset:0 sc1
    v_mfma_f32_32x32x16_bf16 v[192:207], a[216:219], v[12:15], v[192:207]
    buffer_load_dwordx4 v[4:7], v249, s[8:11], s28 offen offset:0 sc1
    v_mfma_f32_32x32x16_bf16 v[144:159], a[220:223], v[8:11], v[144:159]
    s_add_u32 m0, s31, 1024
    s_add_u32 s24, s27, 32768
    buffer_load_dwordx4 v245, s[12:15], s24 offen lds
    v_mfma_f32_32x32x16_bf16 v[208:223], a[220:223], v[12:15], v[208:223]
    s_waitcnt vmcnt(21) lgkmcnt(0)
    v_mfma_f32_32x32x16_bf16 v[96:111], a[192:195], v[16:19], v[96:111]
    ds_read_b64_tr_b16 a[208:209], v246 offset:12288
    ds_read_b64_tr_b16 a[210:211], v246 offset:13312
    v_mfma_f32_32x32x16_bf16 v[160:175], a[192:195], v[20:23], v[160:175]
    ds_read_b64_tr_b16 a[212:213], v246 offset:12544
    ds_read_b64_tr_b16 a[214:215], v246 offset:13568
    v_mfma_f32_32x32x16_bf16 v[112:127], a[196:199], v[16:19], v[112:127]
    ds_read_b64_tr_b16 a[216:217], v246 offset:12800
    ds_read_b64_tr_b16 a[218:219], v246 offset:13824
    v_mfma_f32_32x32x16_bf16 v[176:191], a[196:199], v[20:23], v[176:191]
    ds_read_b64_tr_b16 a[220:221], v246 offset:13056
    ds_read_b64_tr_b16 a[222:223], v246 offset:14080
    v_mfma_f32_32x32x16_bf16 v[128:143], a[200:203], v[16:19], v[128:143]
    buffer_load_dwordx4 v[8:11], v248, s[8:11], s28 offen offset:1024 sc1
    v_mfma_f32_32x32x16_bf16 v[192:207], a[200:203], v[20:23], v[192:207]
    buffer_load_dwordx4 v[12:15], v249, s[8:11], s28 offen offset:1024 sc1
    v_mfma_f32_32x32x16_bf16 v[144:159], a[204:207], v[16:19], v[144:159]
    s_add_u32 m0, s31, 2048
    s_add_u32 s24, s27, 65536
    buffer_load_dwordx4 v245, s[12:15], s24 offen lds
    v_mfma_f32_32x32x16_bf16 v[208:223], a[204:207], v[20:23], v[208:223]
    s_waitcnt vmcnt(21) lgkmcnt(0)
    v_mfma_f32_32x32x16_bf16 v[96:111], a[208:211], v[24:27], v[96:111]
    ds_read_b64_tr_b16 a[192:193], v246 offset:16384
    ds_read_b64_tr_b16 a[194:195], v246 offset:17408
    v_mfma_f32_32x32x16_bf16 v[160:175], a[208:211], v[28:31], v[160:175]
    ds_read_b64_tr_b16 a[196:197], v246 offset:16640
    ds_read_b64_tr_b16 a[198:199], v246 offset:17664
    v_mfma_f32_32x32x16_bf16 v[112:127], a[212:215], v[24:27], v[112:127]
    ds_read_b64_tr_b16 a[200:201], v246 offset:16896
    ds_read_b64_tr_b16 a[202:203], v246 offset:17920
    v_mfma_f32_32x32x16_bf16 v[176:191], a[212:215], v[28:31], v[176:191]
    ds_read_b64_tr_b16 a[204:205], v246 offset:17152
    ds_read_b64_tr_b16 a[206:207], v246 offset:18176
    v_mfma_f32_32x32x16_bf16 v[128:143], a[216:219], v[24:27], v[128:143]
    buffer_load_dwordx4 v[16:19], v248, s[8:11], s28 offen offset:2048 sc1
    v_mfma_f32_32x32x16_bf16 v[192:207], a[216:219], v[28:31], v[192:207]
    buffer_load_dwordx4 v[20:23], v249, s[8:11], s28 offen offset:2048 sc1
    v_mfma_f32_32x32x16_bf16 v[144:159], a[220:223], v[24:27], v[144:159]
    s_add_u32 m0, s31, 3072
    s_add_u32 s24, s27, 98304
    buffer_load_dwordx4 v245, s[12:15], s24 offen lds
    v_mfma_f32_32x32x16_bf16 v[208:223], a[220:223], v[28:31], v[208:223]
    s_waitcnt vmcnt(21) lgkmcnt(0)
    v_mfma_f32_32x32x16_bf16 v[96:111], a[192:195], v[32:35], v[96:111]
    ds_read_b64_tr_b16 a[208:209], v246 offset:20480
    ds_read_b64_tr_b16 a[210:211], v246 offset:21504
    v_mfma_f32_32x32x16_bf16 v[160:175], a[192:195], v[36:39], v[160:175]
    ds_read_b64_tr_b16 a[212:213], v246 offset:20736
    ds_read_b64_tr_b16 a[214:215], v246 offset:21760
    v_mfma_f32_32x32x16_bf16 v[112:127], a[196:199], v[32:35], v[112:127]
    ds_read_b64_tr_b16 a[216:217], v246 offset:20992
    ds_read_b64_tr_b16 a[218:219], v246 offset:22016
    v_mfma_f32_32x32x16_bf16 v[176:191], a[196:199], v[36:39], v[176:191]
    ds_read_b64_tr_b16 a[220:221], v246 offset:21248
    ds_read_b64_tr_b16 a[222:223], v246 offset:22272
    v_mfma_f32_32x32x16_bf16 v[128:143], a[200:203], v[32:35], v[128:143]
    buffer_load_dwordx4 v[24:27], v248, s[8:11], s28 offen offset:3072 sc1
    v_mfma_f32_32x32x16_bf16 v[192:207], a[200:203], v[36:39], v[192:207]
    buffer_load_dwordx4 v[28:31], v249, s[8:11], s28 offen offset:3072 sc1
    v_mfma_f32_32x32x16_bf16 v[144:159], a[204:207], v[32:35], v[144:159]
    s_add_u32 m0, s31, 4096
    s_add_u32 s24, s27, 131072
    buffer_load_dwordx4 v245, s[12:15], s24 offen lds
    v_mfma_f32_32x32x16_bf16 v[208:223], a[204:207], v[36:39], v[208:223]
    s_waitcnt vmcnt(21) lgkmcnt(0)
    v_mfma_f32_32x32x16_bf16 v[96:111], a[208:211], v[40:43], v[96:111]
    ds_read_b64_tr_b16 a[192:193], v246 offset:24576
    ds_read_b64_tr_b16 a[194:195], v246 offset:25600
    v_mfma_f32_32x32x16_bf16 v[160:175], a[208:211], v[44:47], v[160:175]
    ds_read_b64_tr_b16 a[196:197], v246 offset:24832
    ds_read_b64_tr_b16 a[198:199], v246 offset:25856
    v_mfma_f32_32x32x16_bf16 v[112:127], a[212:215], v[40:43], v[112:127]
    ds_read_b64_tr_b16 a[200:201], v246 offset:25088
    ds_read_b64_tr_b16 a[202:203], v246 offset:26112
    v_mfma_f32_32x32x16_bf16 v[176:191], a[212:215], v[44:47], v[176:191]
    ds_read_b64_tr_b16 a[204:205], v246 offset:25344
    ds_read_b64_tr_b16 a[206:207], v246 offset:26368
    v_mfma_f32_32x32x16_bf16 v[128:143], a[216:219], v[40:43], v[128:143]
    buffer_load_dwordx4 v[32:35], v248, s[8:11], s29 offen offset:0 sc1
    v_mfma_f32_32x32x16_bf16 v[192:207], a[216:219], v[44:47], v[192:207]
    buffer_load_dwordx4 v[36:39], v249, s[8:11], s29 offen offset:0 sc1
    v_mfma_f32_32x32x16_bf16 v[144:159], a[220:223], v[40:43], v[144:159]
    s_add_u32 m0, s31, 5120
    s_add_u32 s24, s27, 163840
    buffer_load_dwordx4 v245, s[12:15], s24 offen lds
    v_mfma_f32_32x32x16_bf16 v[208:223], a[220:223], v[44:47], v[208:223]
    s_waitcnt vmcnt(20) lgkmcnt(0)
    v_mfma_f32_32x32x16_bf16 v[96:111], a[192:195], v[48:51], v[96:111]
    ds_read_b64_tr_b16 a[208:209], v246 offset:28672
    ds_read_b64_tr_b16 a[210:211], v246 offset:29696
    v_mfma_f32_32x32x16_bf16 v[160:175], a[192:195], v[52:55], v[160:175]
    ds_read_b64_tr_b16 a[212:213], v246 offset:28928
    ds_read_b64_tr_b16 a[214:215], v246 offset:29952
    v_mfma_f32_32x32x16_bf16 v[112:127], a[196:199], v[48:51], v[112:127]
    ds_read_b64_tr_b16 a[216:217], v246 offset:29184
    ds_read_b64_tr_b16 a[218:219], v246 offset:30208
    v_mfma_f32_32x32x16_bf16 v[176:191], a[196:199], v[52:55], v[176:191]
    ds_read_b64_tr_b16 a[220:221], v246 offset:29440
    ds_read_b64_tr_b16 a[222:223], v246 offset:30464
    v_mfma_f32_32x32x16_bf16 v[128:143], a[200:203], v[48:51], v[128:143]
    buffer_load_dwordx4 v[40:43], v248, s[8:11], s29 offen offset:1024 sc1
    v_mfma_f32_32x32x16_bf16 v[192:207], a[200:203], v[52:55], v[192:207]
    buffer_load_dwordx4 v[44:47], v249, s[8:11], s29 offen offset:1024 sc1
    v_mfma_f32_32x32x16_bf16 v[144:159], a[204:207], v[48:51], v[144:159]
    s_add_u32 m0, s31, 6144
    s_add_u32 s24, s27, 196608
    buffer_load_dwordx4 v245, s[12:15], s24 offen lds
    v_mfma_f32_32x32x16_bf16 v[208:223], a[204:207], v[52:55], v[208:223]
    s_cmp_eq_u32 s26, 1
    s_cbranch_scc0 ka_nopk
    s_waitcnt vmcnt(19)
    v_readfirstlane_b32 s24, v254
    s_lshl_b32 s25, s3, 16
    s_add_u32 s24, s24, s25
    s_cmp_ge_u32 s24, 8
    s_cbranch_scc0 kf_spin45
kf_spinr46:
ka_nopk:
    s_waitcnt vmcnt(20) lgkmcnt(0)
    s_barrier
    s_add_u32 s30, s30, 32768
    s_cmp_ge_u32 s30, 163840
    s_cselect_b32 s24, 98304, 0
    s_sub_u32 s30, s30, s24
    v_add_u32 v246, s30, v247
    v_mfma_f32_32x32x16_bf16 v[96:111], a[208:211], v[56:59], v[96:111]
    ds_read_b64_tr_b16 a[192:193], v246 offset:0
    ds_read_b64_tr_b16 a[194:195], v246 offset:1024
    v_mfma_f32_32x32x16_bf16 v[160:175], a[208:211], v[60:63], v[160:175]
    ds_read_b64_tr_b16 a[196:197], v246 offset:256
    ds_read_b64_tr_b16 a[198:199], v246 offset:1280
    v_mfma_f32_32x32x16_bf16 v[112:127], a[212:215], v[56:59], v[112:127]
    ds_read_b64_tr_b16 a[200:201], v246 offset:512
    ds_read_b64_tr_b16 a[202:203], v246 offset:1536
    v_mfma_f32_32x32x16_bf16 v[176:191], a[212:215], v[60:63], v[176:191]
    ds_read_b64_tr_b16 a[204:205], v246 offset:768
    ds_read_b64_tr_b16 a[206:207], v246 offset:1792
    buffer_atomic_add v255, v250, s[88:91], s97 offen sc1
    s_mov_b32 s97, s43
    v_mfma_f32_32x32x16_bf16 v[128:143], a[216:219], v[56:59], v[128:143]
    buffer_load_dwordx4 v[48:51], v248, s[8:11], s29 offen offset:2048 sc1
    v_mfma_f32_32x32x16_bf16 v[192:207], a[216:219], v[60:63], v[192:207]
    buffer_load_dwordx4 v[52:55], v249, s[8:11], s29 offen offset:2048 sc1
    v_mfma_f32_32x32x16_bf16 v[144:159], a[220:223], v[56:59], v[144:159]
    s_add_u32 m0, s31, 7168
    s_add_u32 s24, s27, 229376
    buffer_load_dwordx4 v245, s[12:15], s24 offen lds
    v_mfma_f32_32x32x16_bf16 v[208:223], a[220:223], v[60:63], v[208:223]
    buffer_load_dwordx4 v[56:59], v248, s[8:11], s29 offen offset:3072 sc1
    buffer_load_dwordx4 v[60:63], v249, s[8:11], s29 offen offset:3072 sc1
    s_add_u32 s28, s28, 8192
    s_and_b32 s28, s28, 65535
    s_add_u32 s29, s28, 4096
    s_add_u32 s27, s27, 1048576
    s_and_b32 s27, s27, 0x407fffff
    s_cmp_eq_u32 s27, s7
    s_cselect_b32 s27, s43, s27
    s_add_u32 s31, s31, 32768
    s_cmp_ge_u32 s31, 163840
    s_cselect_b32 s24, 98304, 0
    s_sub_u32 s31, s31, s24
    s_sub_u32 s26, s26, 1
    s_cmp_lg_u32 s26, 0
    s_cbranch_scc1 ka_qp
    s_waitcnt vmcnt(22) lgkmcnt(0)
    v_mfma_f32_32x32x16_bf16 v[96:111], a[192:195], v[0:3], v[96:111]
    ds_read_b64_tr_b16 a[208:209], v246 offset:4096
    ds_read_b64_tr_b16 a[210:211], v246 offset:5120
    s_sub_u32 s42, s32, 17664
    v_mfma_f32_32x32x16_bf16 v[160:175], a[192:195], v[4:7], v[160:175]
    ds_read_b64_tr_b16 a[212:213], v246 offset:4352
    ds_read_b64_tr_b16 a[214:215], v246 offset:5376
    s_mov_b32 m0, s34
    s_add_u32 s41, s42, 17664
    v_mfma_f32_32x32x16_bf16 v[112:127], a[196:199], v[0:3], v[112:127]
    ds_read_b64_tr_b16 a[216:217], v246 offset:4608
    ds_read_b64_tr_b16 a[218:219], v246 offset:5632
    buffer_load_dwordx4 v242, s[16:19], s41 offen offset:0 sc1 lds
    v_mfma_f32_32x32x16_bf16 v[176:191], a[196:199], v[4:7], v[176:191]
    ds_read_b64_tr_b16 a[220:221], v246 offset:4864
    ds_read_b64_tr_b16 a[222:223], v246 offset:5888
    v_mfma_f32_32x32x16_bf16 v[128:143], a[200:203], v[0:3], v[128:143]
    buffer_load_dwordx4 v242, s[16:19], s41 offen offset:1024 sc1 lds
    v_mfma_f32_32x32x16_bf16 v[192:207], a[200:203], v[4:7], v[192:207]
    buffer_load_dwordx4 v242, s[16:19], s41 offen offset:2048 sc1 lds
    v_mfma_f32_32x32x16_bf16 v[144:159], a[204:207], v[0:3], v[144:159]
    v_mfma_f32_32x32x16_bf16 v[208:223], a[204:207], v[4:7], v[208:223]
    buffer_load_dwordx4 v242, s[16:19], s41 offen offset:3072 sc1 lds
    s_waitcnt vmcnt(23) lgkmcnt(0)
    v_mfma_f32_32x32x16_bf16 v[96:111], a[208:211], v[8:11], v[96:111]
    ds_read_b64_tr_b16 a[192:193], v246 offset:8192
    ds_read_b64_tr_b16 a[194:195], v246 offset:9216
    s_add_u32 s34, s34, 32768
    s_cmp_ge_u32 s34, 163840
    s_cselect_b32 s34, s37, s34
    s_add_u32 s42, s42, 34048
    v_mfma_f32_32x32x16_bf16 v[160:175], a[208:211], v[12:15], v[160:175]
    ds_read_b64_tr_b16 a[196:197], v246 offset:8448
    ds_read_b64_tr_b16 a[198:199], v246 offset:9472
    v_mfma_f32_32x32x16_bf16 v[112:127], a[212:215], v[8:11], v[112:127]
    ds_read_b64_tr_b16 a[200:201], v246 offset:8704
    ds_read_b64_tr_b16 a[202:203], v246 offset:9728
    s_mov_b32 m0, s34
    s_add_u32 s41, s42, 17664
    v_mfma_f32_32x32x16_bf16 v[176:191], a[212:215], v[12:15], v[176:191]
    ds_read_b64_tr_b16 a[204:205], v246 offset:8960
    ds_read_b64_tr_b16 a[206:207], v246 offset:9984
    buffer_load_dwordx4 v242, s[16:19], s41 offen offset:0 sc1 lds
    v_mfma_f32_32x32x16_bf16 v[128:143], a[216:219], v[8:11], v[128:143]
    v_mfma_f32_32x32x16_bf16 v[192:207], a[216:219], v[12:15], v[192:207]
    buffer_load_dwordx4 v242, s[16:19], s41 offen offset:1024 sc1 lds
    v_mfma_f32_32x32x16_bf16 v[144:159], a[220:223], v[8:11], v[144:159]
    buffer_load_dwordx4 v242, s[16:19], s41 offen offset:2048 sc1 lds
    v_mfma_f32_32x32x16_bf16 v[208:223], a[220:223], v[12:15], v[208:223]
    s_waitcnt vmcnt(23) lgkmcnt(0)
    v_mfma_f32_32x32x16_bf16 v[96:111], a[192:195], v[16:19], v[96:111]
    ds_read_b64_tr_b16 a[208:209], v246 offset:12288
    ds_read_b64_tr_b16 a[210:211], v246 offset:13312
    buffer_load_dwordx4 v242, s[16:19], s41 offen offset:3072 sc1 lds
    v_mfma_f32_32x32x16_bf16 v[160:175], a[192:195], v[20:23], v[160:175]
    ds_read_b64_tr_b16 a[212:213], v246 offset:12544
    ds_read_b64_tr_b16 a[214:215], v246 offset:13568
    s_add_u32 m0, s34, 16384
    s_add_u32 s34, s34, 32768
    s_cmp_ge_u32 s34, 163840
    s_cselect_b32 s34, s37, s34
    v_mfma_f32_32x32x16_bf16 v[112:127], a[196:199], v[16:19], v[112:127]
    ds_read_b64_tr_b16 a[216:217], v246 offset:12800
    ds_read_b64_tr_b16 a[218:219], v246 offset:13824
    v_mfma_f32_32x32x16_bf16 v[176:191], a[196:199], v[20:23], v[176:191]
    ds_read_b64_tr_b16 a[220:221], v246 offset:13056
    ds_read_b64_tr_b16 a[222:223], v246 offset:14080
    buffer_load_dwordx4 v242, s[16:19], s42 offen offset:0 sc1 lds
    v_mfma_f32_32x32x16_bf16 v[128:143], a[200:203], v[16:19], v[128:143]
    v_mfma_f32_32x32x16_bf16 v[192:207], a[200:203], v[20:23], v[192:207]
    buffer_load_dwordx4 v242, s[16:19], s42 offen offset:1024 sc1 lds
    v_mfma_f32_32x32x16_bf16 v[144:159], a[204:207], v[16:19], v[144:159]
    buffer_load_dwordx4 v242, s[16:19], s42 offen offset:2048 sc1 lds
    v_mfma_f32_32x32x16_bf16 v[208:223], a[204:207], v[20:23], v[208:223]
    s_waitcnt vmcnt(24) lgkmcnt(0)
    v_mfma_f32_32x32x16_bf16 v[96:111], a[208:211], v[24:27], v[96:111]
    ds_read_b64_tr_b16 a[192:193], v246 offset:16384
    ds_read_b64_tr_b16 a[194:195], v246 offset:17408
    buffer_load_dwordx4 v242, s[16:19], s42 offen offset:3072 sc1 lds
    s_add_u32 s42, s42, 34048
    v_mfma_f32_32x32x16_bf16 v[160:175], a[208:211], v[28:31], v[160:175]
    ds_read_b64_tr_b16 a[196:197], v246 offset:16640
    ds_read_b64_tr_b16 a[198:199], v246 offset:17664
    s_mov_b32 m0, s34
    s_add_u32 s41, s42, 17664
    v_mfma_f32_32x32x16_bf16 v[112:127], a[212:215], v[24:27], v[112:127]
    ds_read_b64_tr_b16 a[200:201], v246 offset:16896
    ds_read_b64_tr_b16 a[202:203], v246 offset:17920
    v_mfma_f32_32x32x16_bf16 v[176:191], a[212:215], v[28:31], v[176:191]
    ds_read_b64_tr_b16 a[204:205], v246 offset:17152
    ds_read_b64_tr_b16 a[206:207], v246 offset:18176
    buffer_load_dwordx4 v242, s[16:19], s41 offen offset:0 sc1 lds
    v_mfma_f32_32x32x16_bf16 v[128:143], a[216:219], v[24:27], v[128:143]
    buffer_load_dwordx4 v242, s[16:19], s41 offen offset:1024 sc1 lds
    v_mfma_f32_32x32x16_bf16 v[192:207], a[216:219], v[28:31], v[192:207]
    v_mfma_f32_32x32x16_bf16 v[144:159], a[220:223], v[24:27], v[144:159]
    buffer_load_dwordx4 v242, s[16:19], s41 offen offset:2048 sc1 lds
    v_mov_b32 v241, v239
    v_lshrrev_b32 v230, 7, v240
    v_mfma_f32_32x32x16_bf16 v[208:223], a[220:223], v[28:31], v[208:223]
    buffer_load_dwordx4 v242, s[16:19], s41 offen offset:3072 sc1 lds
    v_mul_u32_u24 v253, 7168, v230
    v_and_b32 v231, 0x70, v240
    s_waitcnt vmcnt(26) lgkmcnt(0)
    v_mfma_f32_32x32x16_bf16 v[96:111], a[192:195], v[32:35], v[96:111]
    ds_read_b64_tr_b16 a[208:209], v246 offset:20480
    ds_read_b64_tr_b16 a[210:211], v246 offset:21504
    v_add_u32 v253, v253, v231
    v_mfma_f32_32x32x16_bf16 v[160:175], a[192:195], v[36:39], v[160:175]
    ds_read_b64_tr_b16 a[212:213], v246 offset:20736
    ds_read_b64_tr_b16 a[214:215], v246 offset:21760
    s_add_u32 m0, s34, 16384
    s_add_u32 s34, s34, 32768
    s_cmp_ge_u32 s34, 163840
    s_cselect_b32 s34, s37, s34
    v_mfma_f32_32x32x16_bf16 v[112:127], a[196:199], v[32:35], v[112:127]
    ds_read_b64_tr_b16 a[216:217], v246 offset:20992
    ds_read_b64_tr_b16 a[218:219], v246 offset:22016
    buffer_load_dwordx4 v242, s[16:19], s42 offen offset:0 sc1 lds
    v_lshlrev_b32 v255, 5, v230
    v_and_b32 v230, 16, v240
    v_mfma_f32_32x32x16_bf16 v[176:191], a[196:199], v[36:39], v[176:191]
    ds_read_b64_tr_b16 a[220:221], v246 offset:21248
    ds_read_b64_tr_b16 a[222:223], v246 offset:22272
    v_add_u32 v255, v255, v230
    v_mfma_f32_32x32x16_bf16 v[128:143], a[200:203], v[32:35], v[128:143]
    buffer_load_dwordx4 v242, s[16:19], s42 offen offset:1024 sc1 lds
    v_lshrrev_b32 v231, 5, v231
    v_lshl_add_u32 v255, v231, 16, v255
    v_mfma_f32_32x32x16_bf16 v[192:207], a[200:203], v[36:39], v[192:207]
    buffer_load_dwordx4 v242, s[16:19], s42 offen offset:2048 sc1 lds
    v_mov_b32 v64, 0
    v_mov_b32 v65, 0
    v_mfma_f32_32x32x16_bf16 v[144:159], a[204:207], v[32:35], v[144:159]
    v_mov_b32 v66, 0
    v_mov_b32 v67, 0
    v_mov_b32 v68, 0
    v_mfma_f32_32x32x16_bf16 v[208:223], a[204:207], v[36:39], v[208:223]
    buffer_load_dwordx4 v242, s[16:19], s42 offen offset:3072 sc1 lds
    s_add_u32 s42, s42, 34048
    v_mov_b32 v69, 0
    s_waitcnt vmcnt(27) lgkmcnt(0)
    v_mfma_f32_32x32x16_bf16 v[96:111], a[208:211], v[40:43], v[96:111]
    ds_read_b64_tr_b16 a[192:193], v246 offset:24576
    ds_read_b64_tr_b16 a[194:195], v246 offset:25600
    v_mov_b32 v70, 0
    v_mov_b32 v71, 0
    v_mfma_f32_32x32x16_bf16 v[160:175], a[208:211], v[44:47], v[160:175]
    ds_read_b64_tr_b16 a[196:197], v246 offset:24832
    ds_read_b64_tr_b16 a[198:199], v246 offset:25856
    v_mov_b32 v72, 0
    v_mfma_f32_32x32x16_bf16 v[112:127], a[212:215], v[40:43], v[112:127]
    ds_read_b64_tr_b16 a[200:201], v246 offset:25088
    ds_read_b64_tr_b16 a[202:203], v246 offset:26112
    v_mov_b32 v73, 0
    v_mov_b32 v74, 0
    v_mfma_f32_32x32x16_bf16 v[176:191], a[212:215], v[44:47], v[176:191]
    ds_read_b64_tr_b16 a[204:205], v246 offset:25344
    ds_read_b64_tr_b16 a[206:207], v246 offset:26368
    v_mov_b32 v75, 0
    v_mov_b32 v76, 0
    v_mfma_f32_32x32x16_bf16 v[128:143], a[216:219], v[40:43], v[128:143]
    v_mov_b32 v77, 0
    v_mov_b32 v78, 0
    v_mfma_f32_32x32x16_bf16 v[192:207], a[216:219], v[44:47], v[192:207]
    v_mov_b32 v79, 0
    v_mov_b32 v228, 0
    v_mov_b32 v226, 0
    v_mfma_f32_32x32x16_bf16 v[144:159], a[220:223], v[40:43], v[144:159]
    v_mov_b32 v80, 0
    v_mov_b32 v81, 0
    v_mfma_f32_32x32x16_bf16 v[208:223], a[220:223], v[44:47], v[208:223]
    v_mov_b32 v82, 0
    v_mov_b32 v83, 0
    s_waitcnt vmcnt(23) lgkmcnt(0)
    v_mfma_f32_32x32x16_bf16 v[96:111], a[192:195], v[48:51], v[96:111]
    ds_read_b64_tr_b16 a[208:209], v246 offset:28672
    ds_read_b64_tr_b16 a[210:211], v246 offset:29696
    v_mov_b32 v84, 0
    v_mov_b32 v85, 0
    v_mfma_f32_32x32x16_bf16 v[160:175], a[192:195], v[52:55], v[160:175]
    ds_read_b64_tr_b16 a[212:213], v246 offset:28928
    ds_read_b64_tr_b16 a[214:215], v246 offset:29952
    v_mov_b32 v86, 0
    v_mfma_f32_32x32x16_bf16 v[112:127], a[196:199], v[48:51], v[112:127]
    ds_read_b64_tr_b16 a[216:217], v246 offset:29184
    ds_read_b64_tr_b16 a[218:219], v246 offset:30208
    v_mov_b32 v87, 0
    v_mov_b32 v88, 0
    v_mfma_f32_32x32x16_bf16 v[176:191], a[196:199], v[52:55], v[176:191]
    ds_read_b64_tr_b16 a[220:221], v246 offset:29440
    ds_read_b64_tr_b16 a[222:223], v246 offset:30464
    v_mov_b32 v89, 0
    v_mov_b32 v90, 0
    v_mfma_f32_32x32x16_bf16 v[128:143], a[200:203], v[48:51], v[128:143]
    v_mov_b32 v91, 0
    v_mov_b32 v92, 0
    v_mfma_f32_32x32x16_bf16 v[192:207], a[200:203], v[52:55], v[192:207]
    v_mov_b32 v93, 0
    v_mov_b32 v94, 0
    v_mov_b32 v95, 0
    v_mfma_f32_32x32x16_bf16 v[144:159], a[204:207], v[48:51], v[144:159]
    v_mov_b32 v229, 0
    v_mov_b32 v227, 0
    v_mfma_f32_32x32x16_bf16 v[208:223], a[204:207], v[52:55], v[208:223]
    s_waitcnt vmcnt(8) lgkmcnt(0)
    s_barrier
    v_mfma_f32_32x32x16_bf16 v[96:111], a[208:211], v[56:59], v[96:111]
    ds_read_b128 a[192:195], v241 offset:0
    ds_read_b128 a[196:199], v241 offset:512
    s_mov_b32 m0, s34
    s_add_u32 s41, s42, 17664
    buffer_load_dwordx4 v242, s[16:19], s41 offen offset:0 sc1 lds
    v_mfma_f32_32x32x16_bf16 v[160:175], a[208:211], v[60:63], v[160:175]
    ds_read_b128 a[200:203], v241 offset:2048
    ds_read_b128 a[204:207], v241 offset:2560
    buffer_load_dwordx4 v242, s[16:19], s41 offen offset:1024 sc1 lds
    v_mfma_f32_32x32x16_bf16 v[112:127], a[212:215], v[56:59], v[112:127]
    ds_read_b128 a[224:227], v241 offset:8192
    ds_read_b128 a[228:231], v241 offset:8704
    buffer_load_dwordx4 v242, s[16:19], s41 offen offset:2048 sc1 lds
    v_mfma_f32_32x32x16_bf16 v[176:191], a[212:215], v[60:63], v[176:191]
    ds_read_b128 a[232:235], v241 offset:10240
    ds_read_b128 a[236:239], v241 offset:10752
    buffer_load_dwordx4 v242, s[16:19], s41 offen offset:3072 sc1 lds
    v_mfma_f32_32x32x16_bf16 v[128:143], a[216:219], v[56:59], v[128:143]
    ds_read_b128 a[240:243], v241 offset:12288
    ds_read_b128 a[244:247], v241 offset:12800
    s_add_u32 m0, s34, 16384
    s_add_u32 s34, s34, 32768
    s_cmp_ge_u32 s34, 163840
    s_cselect_b32 s34, s37, s34
    buffer_load_dwordx4 v242, s[16:19], s42 offen offset:0 sc1 lds
    v_mfma_f32_32x32x16_bf16 v[192:207], a[216:219], v[60:63], v[192:207]
    ds_read_b128 a[248:251], v241 offset:14336
    ds_read_b128 a[252:255], v241 offset:14848
    buffer_load_dwordx4 v242, s[16:19], s42 offen offset:1024 sc1 lds
    v_mfma_f32_32x32x16_bf16 v[144:159], a[220:223], v[56:59], v[144:159]
    buffer_load_dwordx4 v242, s[16:19], s42 offen offset:2048 sc1 lds
    v_mfma_f32_32x32x16_bf16 v[208:223], a[220:223], v[60:63], v[208:223]
    buffer_load_dwordx4 v242, s[16:19], s42 offen offset:3072 sc1 lds
    s_add_u32 s42, s42, 34048
    s_mov_b32 s25, 0x3e0293ee
    s_waitcnt lgkmcnt(8)
    ds_read_b128 a[208:211], v241 offset:4096
    ds_read_b128 a[212:215], v241 offset:4608
    ds_read_b128 a[216:219], v241 offset:6144
    ds_read_b128 a[220:223], v241 offset:6656
    s_sub_u32 s36, s36, 1
    s_cbranch_scc1 kf_fix1
kf_fixr2:
    v_mul_f32 v96, s25, v96
    v_mul_f32 v97, s25, v97
    v_mul_f32 v98, s25, v98
    v_mul_f32 v99, s25, v99
    v_mul_f32 v100, s25, v100
    v_mul_f32 v101, s25, v101
    v_mul_f32 v102, s25, v102
    v_mul_f32 v103, s25, v103
    v_mul_f32 v104, s25, v104
    v_mul_f32 v105, s25, v105
    v_mul_f32 v106, s25, v106
    v_mul_f32 v107, s25, v107
    v_mul_f32 v108, s25, v108
    v_mul_f32 v109, s25, v109
    v_mul_f32 v110, s25, v110
    v_mul_f32 v111, s25, v111
    v_cvt_pk_bf16_f32 v96, v96, v97
    v_cvt_pk_bf16_f32 v97, v98, v99
    v_cvt_pk_bf16_f32 v98, v100, v101
    v_cvt_pk_bf16_f32 v99, v102, v103
    v_cvt_pk_bf16_f32 v100, v104, v105
    v_cvt_pk_bf16_f32 v101, v106, v107
    v_cvt_pk_bf16_f32 v102, v108, v109
    v_cvt_pk_bf16_f32 v103, v110, v111
    v_accvgpr_write_b32 a128, v96
    v_accvgpr_write_b32 a129, v97
    v_accvgpr_write_b32 a130, v98
    v_accvgpr_write_b32 a131, v99
    v_accvgpr_write_b32 a132, v100
    v_accvgpr_write_b32 a133, v101
    v_accvgpr_write_b32 a134, v102
    v_accvgpr_write_b32 a135, v103
    v_mul_f32 v160, s25, v160
    v_mul_f32 v161, s25, v161
    v_mul_f32 v162, s25, v162
    v_mul_f32 v163, s25, v163
    v_mul_f32 v164, s25, v164
    v_mul_f32 v165, s25, v165
    v_mul_f32 v166, s25, v166
    v_mul_f32 v167, s25, v167
    v_mul_f32 v168, s25, v168
    v_mul_f32 v169, s25, v169
    v_mul_f32 v170, s25, v170
    v_mul_f32 v171, s25, v171
    v_mul_f32 v172, s25, v172
    v_mul_f32 v173, s25, v173
    v_mul_f32 v174, s25, v174
    v_mul_f32 v175, s25, v175
    v_cvt_pk_bf16_f32 v160, v160, v161
    v_cvt_pk_bf16_f32 v161, v162, v163
    v_cvt_pk_bf16_f32 v162, v164, v165
    v_cvt_pk_bf16_f32 v163, v166, v167
    v_cvt_pk_bf16_f32 v164, v168, v169
    v_cvt_pk_bf16_f32 v165, v170, v171
    v_cvt_pk_bf16_f32 v166, v172, v173
    v_cvt_pk_bf16_f32 v167, v174, v175
    v_accvgpr_write_b32 a160, v160
    v_accvgpr_write_b32 a161, v161
    v_accvgpr_write_b32 a162, v162
    v_accvgpr_write_b32 a163, v163
    v_accvgpr_write_b32 a164, v164
    v_accvgpr_write_b32 a165, v165
    v_accvgpr_write_b32 a166, v166
    v_accvgpr_write_b32 a167, v167
    s_nop 1
    v_mfma_f32_32x32x16_bf16 v[0:15], a[192:195], a[128:131], v[64:79]
    v_mul_f32 v112, s25, v112
    v_mul_f32 v113, s25, v113
    v_mul_f32 v114, s25, v114
    v_mul_f32 v115, s25, v115
    v_mul_f32 v116, s25, v116
    v_mul_f32 v117, s25, v117
    v_mfma_f32_32x32x16_bf16 v[16:31], a[192:195], a[160:163], v[80:95]
    v_mul_f32 v118, s25, v118
    v_mul_f32 v119, s25, v119
    v_mul_f32 v120, s25, v120
    v_mul_f32 v121, s25, v121
    v_mul_f32 v122, s25, v122
    v_mul_f32 v123, s25, v123
    v_mfma_f32_32x32x16_bf16 v[0:15], a[196:199], a[132:135], v[0:15]
    v_mul_f32 v124, s25, v124
    v_mul_f32 v125, s25, v125
    v_mul_f32 v126, s25, v126
    v_mul_f32 v127, s25, v127
    v_cvt_pk_bf16_f32 v112, v112, v113
    v_cvt_pk_bf16_f32 v113, v114, v115
    v_mfma_f32_32x32x16_bf16 v[16:31], a[196:199], a[164:167], v[16:31]
    v_cvt_pk_bf16_f32 v114, v116, v117
    v_cvt_pk_bf16_f32 v115, v118, v119
    v_cvt_pk_bf16_f32 v116, v120, v121
    v_cvt_pk_bf16_f32 v117, v122, v123
    v_cvt_pk_bf16_f32 v118, v124, v125
    v_cvt_pk_bf16_f32 v119, v126, v127
    v_accvgpr_write_b32 a136, v112
    v_accvgpr_write_b32 a137, v113
    v_accvgpr_write_b32 a138, v114
    v_accvgpr_write_b32 a139, v115
    v_accvgpr_write_b32 a140, v116
    v_accvgpr_write_b32 a141, v117
    v_accvgpr_write_b32 a142, v118
    v_accvgpr_write_b32 a143, v119
    v_mul_f32 v176, s25, v176
    v_mul_f32 v177, s25, v177
    v_mul_f32 v178, s25, v178
    v_mul_f32 v179, s25, v179
    v_mul_f32 v180, s25, v180
    v_mul_f32 v181, s25, v181
    v_mul_f32 v182, s25, v182
    v_mul_f32 v183, s25, v183
    v_mul_f32 v184, s25, v184
    v_mul_f32 v185, s25, v185
    v_mul_f32 v186, s25, v186
    v_mul_f32 v187, s25, v187
    v_mul_f32 v188, s25, v188
    v_mul_f32 v189, s25, v189
    v_mul_f32 v190, s25, v190
    v_mul_f32 v191, s25, v191
    v_cvt_pk_bf16_f32 v176, v176, v177
    v_cvt_pk_bf16_f32 v177, v178, v179
    v_cvt_pk_bf16_f32 v178, v180, v181
    v_cvt_pk_bf16_f32 v179, v182, v183
    v_cvt_pk_bf16_f32 v180, v184, v185
    v_cvt_pk_bf16_f32 v181, v186, v187
    v_cvt_pk_bf16_f32 v182, v188, v189
    v_cvt_pk_bf16_f32 v183, v190, v191
    v_accvgpr_write_b32 a168, v176
    v_accvgpr_write_b32 a169, v177
    v_accvgpr_write_b32 a170, v178
    v_accvgpr_write_b32 a171, v179
    v_accvgpr_write_b32 a172, v180
    v_accvgpr_write_b32 a173, v181
    v_accvgpr_write_b32 a174, v182
    v_accvgpr_write_b32 a175, v183
    s_nop 1
    v_mfma_f32_32x32x16_bf16 v[0:15], a[200:203], a[136:139], v[0:15]
    v_mul_f32 v128, s25, v128
    v_mul_f32 v129, s25, v129
    v_mul_f32 v130, s25, v130
    v_mul_f32 v131, s25, v131
    v_mul_f32 v132, s25, v132
    v_mul_f32 v133, s25, v133
    v_mfma_f32_32x32x16_bf16 v[16:31], a[200:203], a[168:171], v[16:31]
    v_mul_f32 v134, s25, v134
    v_mul_f32 v135, s25, v135
    v_mul_f32 v136, s25, v136
    v_mul_f32 v137, s25, v137
    v_mul_f32 v138, s25, v138
    v_mul_f32 v139, s25, v139
    v_mfma_f32_32x32x16_bf16 v[0:15], a[204:207], a[140:143], v[0:15]
    v_mul_f32 v140, s25, v140
    v_mul_f32 v141, s25, v141
    v_mul_f32 v142, s25, v142
    v_mul_f32 v143, s25, v143
    v_cvt_pk_bf16_f32 v128, v128, v129
    v_cvt_pk_bf16_f32 v129, v130, v131
    v_mfma_f32_32x32x16_bf16 v[16:31], a[204:207], a[172:175], v[16:31]
    v_cvt_pk_bf16_f32 v130, v132, v133
    v_cvt_pk_bf16_f32 v131, v134, v135
    v_cvt_pk_bf16_f32 v132, v136, v137
    v_cvt_pk_bf16_f32 v133, v138, v139
    v_cvt_pk_bf16_f32 v134, v140, v141
    v_cvt_pk_bf16_f32 v135, v142, v143
    v_accvgpr_write_b32 a144, v128
    v_accvgpr_write_b32 a145, v129
    v_accvgpr_write_b32 a146, v130
    v_accvgpr_write_b32 a147, v131
    v_accvgpr_write_b32 a148, v132
    v_accvgpr_write_b32 a149, v133
    v_accvgpr_write_b32 a150, v134
    v_accvgpr_write_b32 a151, v135
    v_mul_f32 v192, s25, v192
    v_mul_f32 v193, s25, v193
    v_mul_f32 v194, s25, v194
    v_mul_f32 v195, s25, v195
    v_mul_f32 v196, s25, v196
    v_mul_f32 v197, s25, v197
    v_mul_f32 v198, s25, v198
    v_mul_f32 v199, s25, v199
    v_mul_f32 v200, s25, v200
    v_mul_f32 v201, s25, v201
    v_mul_f32 v202, s25, v202
    v_mul_f32 v203, s25, v203
    v_mul_f32 v204, s25, v204
    v_mul_f32 v205, s25, v205
    v_mul_f32 v206, s25, v206
    v_mul_f32 v207, s25, v207
    v_cvt_pk_bf16_f32 v192, v192, v193
    v_cvt_pk_bf16_f32 v193, v194, v195
    v_cvt_pk_bf16_f32 v194, v196, v197
    v_cvt_pk_bf16_f32 v195, v198, v199
    v_cvt_pk_bf16_f32 v196, v200, v201
    v_cvt_pk_bf16_f32 v197, v202, v203
    v_cvt_pk_bf16_f32 v198, v204, v205
    v_cvt_pk_bf16_f32 v199, v206, v207
    v_accvgpr_write_b32 a176, v192
    v_accvgpr_write_b32 a177, v193
    v_accvgpr_write_b32 a178, v194
    v_accvgpr_write_b32 a179, v195
    v_accvgpr_write_b32 a180, v196
    v_accvgpr_write_b32 a181, v197
    v_accvgpr_write_b32 a182, v198
    v_accvgpr_write_b32 a183, v199
    s_nop 1
    s_waitcnt lgkmcnt(0)
    v_mfma_f32_32x32x16_bf16 v[0:15], a[208:211], a[144:147], v[0:15]
    v_mul_f32 v144, s25, v144
    v_mul_f32 v145, s25, v145
    v_mul_f32 v146, s25, v146
    v_mul_f32 v147, s25, v147
    v_mul_f32 v148, s25, v148
    v_mul_f32 v149, s25, v149
    v_mfma_f32_32x32x16_bf16 v[16:31], a[208:211], a[176:179], v[16:31]
    v_mul_f32 v150, s25, v150
    v_mul_f32 v151, s25, v151
    v_mul_f32 v152, s25, v152
    v_mul_f32 v153, s25, v153
    v_mul_f32 v154, s25, v154
    v_mul_f32 v155, s25, v155
    v_mfma_f32_32x32x16_bf16 v[0:15], a[212:215], a[148:151], v[0:15]
    v_mul_f32 v156, s25, v156
    v_mul_f32 v157, s25, v157
    v_mul_f32 v158, s25, v158
    v_mul_f32 v159, s25, v159
    v_cvt_pk_bf16_f32 v144, v144, v145
    v_cvt_pk_bf16_f32 v145, v146, v147
    v_mfma_f32_32x32x16_bf16 v[16:31], a[212:215], a[180:183], v[16:31]
    v_cvt_pk_bf16_f32 v146, v148, v149
    v_cvt_pk_bf16_f32 v147, v150, v151
    v_cvt_pk_bf16_f32 v148, v152, v153
    v_cvt_pk_bf16_f32 v149, v154, v155
    v_cvt_pk_bf16_f32 v150, v156, v157
    v_cvt_pk_bf16_f32 v151, v158, v159
    v_accvgpr_write_b32 a152, v144
    v_accvgpr_write_b32 a153, v145
    v_accvgpr_write_b32 a154, v146
    v_accvgpr_write_b32 a155, v147
    v_accvgpr_write_b32 a156, v148
    v_accvgpr_write_b32 a157, v149
    v_accvgpr_write_b32 a158, v150
    v_accvgpr_write_b32 a159, v151
    v_mul_f32 v208, s25, v208
    v_mul_f32 v209, s25, v209
    v_mul_f32 v210, s25, v210
    v_mul_f32 v211, s25, v211
    v_mul_f32 v212, s25, v212
    v_mul_f32 v213, s25, v213
    v_mul_f32 v214, s25, v214
    v_mul_f32 v215, s25, v215
    v_mul_f32 v216, s25, v216
    v_mul_f32 v217, s25, v217
    v_mul_f32 v218, s25, v218
    v_mul_f32 v219, s25, v219
    v_mul_f32 v220, s25, v220
    v_mul_f32 v221, s25, v221
    v_mul_f32 v222, s25, v222
    v_mul_f32 v223, s25, v223
    v_cvt_pk_bf16_f32 v208, v208, v209
    v_cvt_pk_bf16_f32 v209, v210, v211
    v_cvt_pk_bf16_f32 v210, v212, v213
    v_cvt_pk_bf16_f32 v211, v214, v215
    v_cvt_pk_bf16_f32 v212, v216, v217
    v_cvt_pk_bf16_f32 v213, v218, v219
    v_cvt_pk_bf16_f32 v214, v220, v221
    v_cvt_pk_bf16_f32 v215, v222, v223
    v_accvgpr_write_b32 a184, v208
    v_accvgpr_write_b32 a185, v209
    v_accvgpr_write_b32 a186, v210
    v_accvgpr_write_b32 a187, v211
    v_accvgpr_write_b32 a188, v212
    v_accvgpr_write_b32 a189, v213
    v_accvgpr_write_b32 a190, v214
    v_accvgpr_write_b32 a191, v215
    s_nop 1
    v_mfma_f32_32x32x16_bf16 v[0:15], a[216:219], a[152:155], v[0:15]
    v_mfma_f32_32x32x16_bf16 v[16:31], a[216:219], a[184:187], v[16:31]
    v_mfma_f32_32x32x16_bf16 v[0:15], a[220:223], a[156:159], v[0:15]
    v_mfma_f32_32x32x16_bf16 v[16:31], a[220:223], a[188:191], v[16:31]
    s_nop 11
    v_max3_f32 v230, v0, v1, v2
    v_max3_f32 v232, v16, v17, v18
    v_max3_f32 v230, v230, v3, v4
    v_max3_f32 v232, v232, v19, v20
    v_max3_f32 v230, v230, v5, v6
    v_max3_f32 v232, v232, v21, v22
    v_max3_f32 v230, v230, v7, v8
    v_max3_f32 v232, v232, v23, v24
    v_max3_f32 v230, v230, v9, v10
    v_max3_f32 v232, v232, v25, v26
    v_max3_f32 v230, v230, v11, v12
    v_max3_f32 v232, v232, v27, v28
    v_max3_f32 v230, v230, v13, v14
    v_max3_f32 v232, v232, v29, v30
    v_max_f32 v230, v230, v15
    v_max_f32 v232, v232, v31
    v_mov_b32 v231, v230
    v_mov_b32 v233, v232
    s_nop 1
    s_nop 1
    v_permlane32_swap_b32 v230, v231
    v_permlane32_swap_b32 v232, v233
    s_nop 0
    s_nop 0
    v_max_f32 v230, v230, v231
    v_max_f32 v232, v232, v233
    v_sub_f32 v228, 0, v230
    v_sub_f32 v64, v64, v230
    v_sub_f32 v65, v65, v230
    v_sub_f32 v66, v66, v230
    v_sub_f32 v67, v67, v230
    v_sub_f32 v68, v68, v230
    v_sub_f32 v69, v69, v230
    v_sub_f32 v70, v70, v230
    v_sub_f32 v71, v71, v230
    v_sub_f32 v72, v72, v230
    v_sub_f32 v73, v73, v230
    v_sub_f32 v74, v74, v230
    v_sub_f32 v75, v75, v230
    v_sub_f32 v76, v76, v230
    v_sub_f32 v77, v77, v230
    v_sub_f32 v78, v78, v230
    v_sub_f32 v79, v79, v230
    v_sub_f32 v229, 0, v232
    v_sub_f32 v80, v80, v232
    v_sub_f32 v81, v81, v232
    v_sub_f32 v82, v82, v232
    v_sub_f32 v83, v83, v232
    v_sub_f32 v84, v84, v232
    v_sub_f32 v85, v85, v232
    v_sub_f32 v86, v86, v232
    v_sub_f32 v87, v87, v232
    v_sub_f32 v88, v88, v232
    v_sub_f32 v89, v89, v232
    v_sub_f32 v90, v90, v232
    v_sub_f32 v91, v91, v232
    v_sub_f32 v92, v92, v232
    v_sub_f32 v93, v93, v232
    v_sub_f32 v94, v94, v232
    v_sub_f32 v95, v95, v232
    v_sub_f32 v0, v0, v230
    v_sub_f32 v1, v1, v230
    v_sub_f32 v2, v2, v230
    v_sub_f32 v3, v3, v230
    v_sub_f32 v4, v4, v230
    v_sub_f32 v5, v5, v230
    v_sub_f32 v6, v6, v230
    v_sub_f32 v7, v7, v230
    v_sub_f32 v8, v8, v230
    v_sub_f32 v9, v9, v230
    v_sub_f32 v10, v10, v230
    v_sub_f32 v11, v11, v230
    v_sub_f32 v12, v12, v230
    v_sub_f32 v13, v13, v230
    v_sub_f32 v14, v14, v230
    v_sub_f32 v15, v15, v230
    v_sub_f32 v16, v16, v232
    v_sub_f32 v17, v17, v232
    v_sub_f32 v18, v18, v232
    v_sub_f32 v19, v19, v232
    v_sub_f32 v20, v20, v232
    v_sub_f32 v21, v21, v232
    v_sub_f32 v22, v22, v232
    v_sub_f32 v23, v23, v232
    v_sub_f32 v24, v24, v232
    v_sub_f32 v25, v25, v232
    v_sub_f32 v26, v26, v232
    v_sub_f32 v27, v27, v232
    v_sub_f32 v28, v28, v232
    v_sub_f32 v29, v29, v232
    v_sub_f32 v30, v30, v232
    v_sub_f32 v31, v31, v232
    s_mov_b32 s35, 32768
    v_add_u32 v241, s35, v239
    s_sub_u32 s36, s36, 1
    s_cbranch_scc1 kf_fix3
kf_fixr4:
    v_mfma_f32_32x32x16_bf16 v[32:47], a[224:227], a[128:131], v[64:79]
    ds_read_b128 a[192:195], v241 offset:0
    v_exp_f32 v136, v0
    v_exp_f32 v137, v1
    v_exp_f32 v130, v2
    v_mfma_f32_32x32x16_bf16 v[48:63], a[224:227], a[160:163], v[80:95]
    v_exp_f32 v131, v3
    v_cvt_pk_bf16_f32 v96, v136, v137
    v_exp_f32 v132, v4
    v_exp_f32 v133, v5
    v_cvt_pk_bf16_f32 v97, v130, v131
    v_add_f32 v136, v136, v130
    v_mfma_f32_32x32x16_bf16 v[32:47], a[228:231], a[132:135], v[32:47]
    ds_read_b128 a[196:199], v241 offset:512
    v_add_f32 v137, v137, v131
    v_exp_f32 v134, v6
    v_exp_f32 v135, v7
    v_cvt_pk_bf16_f32 v98, v132, v133
    v_mfma_f32_32x32x16_bf16 v[48:63], a[228:231], a[164:167], v[48:63]
    v_add_f32 v136, v136, v132
    v_add_f32 v137, v137, v133
    v_exp_f32 v128, v8
    v_exp_f32 v129, v9
    v_cvt_pk_bf16_f32 v99, v134, v135
    v_add_f32 v136, v136, v134
    v_add_f32 v137, v137, v135
    v_mfma_f32_32x32x16_bf16 v[32:47], a[232:235], a[136:139], v[32:47]
    ds_read_b128 a[200:203], v241 offset:2048
    v_exp_f32 v130, v10
    v_exp_f32 v131, v11
    v_cvt_pk_bf16_f32 v100, v128, v129
    v_add_f32 v136, v136, v128
    v_mfma_f32_32x32x16_bf16 v[48:63], a[232:235], a[168:171], v[48:63]
    v_add_f32 v137, v137, v129
    v_exp_f32 v132, v12
    v_exp_f32 v133, v13
    v_cvt_pk_bf16_f32 v101, v130, v131
    v_add_f32 v136, v136, v130
    v_add_f32 v137, v137, v131
    v_mfma_f32_32x32x16_bf16 v[32:47], a[236:239], a[140:143], v[32:47]
    ds_read_b128 a[204:207], v241 offset:2560
    v_exp_f32 v134, v14
    v_exp_f32 v135, v15
    v_cvt_pk_bf16_f32 v102, v132, v133
    v_add_f32 v136, v136, v132
    v_add_f32 v137, v137, v133
    v_mfma_f32_32x32x16_bf16 v[48:63], a[236:239], a[172:175], v[48:63]
    v_exp_f32 v138, v16
    v_exp_f32 v139, v17
    v_cvt_pk_bf16_f32 v103, v134, v135
    v_add_f32 v136, v136, v134
    v_add_f32 v137, v137, v135
    v_add_f32 v224, v136, v137
    v_mfma_f32_32x32x16_bf16 v[32:47], a[240:243], a[144:147], v[32:47]
    ds_read_b128 a[208:211], v241 offset:4096
    v_exp_f32 v130, v18
    v_exp_f32 v131, v19
    v_cvt_pk_bf16_f32 v104, v138, v139
    v_exp_f32 v132, v20
    v_mfma_f32_32x32x16_bf16 v[48:63], a[240:243], a[176:179], v[48:63]
    v_exp_f32 v133, v21
    v_cvt_pk_bf16_f32 v105, v130, v131
    v_add_f32 v138, v138, v130
    v_add_f32 v139, v139, v131
    v_exp_f32 v134, v22
    v_mfma_f32_32x32x16_bf16 v[32:47], a[244:247], a[148:151], v[32:47]
    ds_read_b128 a[212:215], v241 offset:4608
    v_exp_f32 v135, v23
    v_cvt_pk_bf16_f32 v106, v132, v133
    v_add_f32 v138, v138, v132
    v_add_f32 v139, v139, v133
    v_exp_f32 v128, v24
    v_mfma_f32_32x32x16_bf16 v[48:63], a[244:247], a[180:183], v[48:63]
    v_exp_f32 v129, v25
    v_cvt_pk_bf16_f32 v107, v134, v135
    v_add_f32 v138, v138, v134
    v_add_f32 v139, v139, v135
    v_exp_f32 v130, v26
    v_exp_f32 v131, v27
    v_mfma_f32_32x32x16_bf16 v[32:47], a[248:251], a[152:155], v[32:47]
    ds_read_b128 a[216:219], v241 offset:6144
    v_cvt_pk_bf16_f32 v108, v128, v129
    v_add_f32 v138, v138, v128
    v_add_f32 v139, v139, v129
    v_exp_f32 v132, v28
    v_exp_f32 v133, v29
    v_mfma_f32_32x32x16_bf16 v[48:63], a[248:251], a[184:187], v[48:63]
    v_cvt_pk_bf16_f32 v109, v130, v131
    v_add_f32 v138, v138, v130
    v_add_f32 v139, v139, v131
    v_exp_f32 v134, v30
    v_exp_f32 v135, v31
    v_mfma_f32_32x32x16_bf16 v[32:47], a[252:255], a[156:159], v[32:47]
    ds_read_b128 a[220:223], v241 offset:6656
    v_cvt_pk_bf16_f32 v110, v132, v133
    v_add_f32 v138, v138, v132
    v_add_f32 v139, v139, v133
    v_cvt_pk_bf16_f32 v111, v134, v135
    v_add_f32 v138, v138, v134
    v_add_f32 v139, v139, v135
    v_add_f32 v225, v138, v139
    v_mfma_f32_32x32x16_bf16 v[48:63], a[252:255], a[188:191], v[48:63]
    ds_read_b128 a[224:227], v241 offset:16384
    ds_read_b128 a[228:231], v241 offset:18432
    ds_read_b128 a[232:235], v241 offset:20480
    ds_read_b128 a[236:239], v241 offset:22528
    s_lshl_b32 s26, s5, 1
    s_mov_b32 s58, 0x800000
    s_and_b32 s28, s2, 4
    s_lshl_b32 s28, s28, 20
    s_and_b32 s27, s2, 1
    s_lshl_b32 s27, s27, 10
    s_add_u32 s28, s28, s27
    s_lshr_b32 s27, s2, 3
    s_lshl2_add_u32 s27, s27, s3
    s_lshl_b32 s27, s27, 15
    s_add_u32 s28, s28, s27
    s_mov_b32 s27, 24
    v_and_b32 v245, 1024, v251
    v_add_u32 v245, v245, v251
.p2align 3
ka_p1:
    s_sub_u32 s36, s36, 1
    s_cbranch_scc1 kf_fix7
kf_fixr8:
    s_waitcnt lgkmcnt(8)
    v_mfma_f32_32x32x16_bf16 v[0:15], a[192:195], a[128:131], v[64:79]
    ds_read_b128 a[240:243], v241 offset:16896
    v_add_f32 v226, v226, v224
    v_add_f32 v227, v227, v225
    v_exp_f32 v136, v32
    v_mfma_f32_32x32x16_bf16 v[16:31], a[192:195], a[160:163], v[80:95]
    s_waitcnt vmcnt(11)
    buffer_store_dwordx4 v[192:195], v255, s[48:51], s45 offen offset:0 sc1
    s_cmp_lt_u32 s44, s47
    s_cselect_b32 s101, s44, s43
    buffer_load_dwordx4 v[192:195], v253, s[52:55], s101 offen
    v_mfma_f32_32x32x16_bf16 v[0:15], a[196:199], a[132:135], v[0:15]
    ds_read_b128 a[244:247], v241 offset:18944
    v_exp_f32 v137, v33
    v_exp_f32 v130, v34
    v_mfma_f32_32x32x16_bf16 v[16:31], a[196:199], a[164:167], v[16:31]
    v_exp_f32 v131, v35
    v_cvt_pk_bf16_f32 v112, v136, v137
    v_exp_f32 v132, v36
    v_mfma_f32_32x32x16_bf16 v[0:15], a[200:203], a[136:139], v[0:15]
    ds_read_b128 a[248:251], v241 offset:20992
    v_exp_f32 v133, v37
    v_cvt_pk_bf16_f32 v113, v130, v131
    v_mfma_f32_32x32x16_bf16 v[16:31], a[200:203], a[168:171], v[16:31]
    s_sub_u32 s27, s27, 1
    s_cbranch_scc1 kf_l2p5
kf_l2r6:
    v_add_f32 v136, v136, v130
    v_add_f32 v137, v137, v131
    v_mfma_f32_32x32x16_bf16 v[0:15], a[204:207], a[140:143], v[0:15]
    ds_read_b128 a[252:255], v241 offset:23040
    v_exp_f32 v134, v38
    v_exp_f32 v135, v39
    v_mfma_f32_32x32x16_bf16 v[16:31], a[204:207], a[172:175], v[16:31]
    v_cvt_pk_bf16_f32 v114, v132, v133
    v_add_f32 v136, v136, v132
    v_add_f32 v137, v137, v133
    v_exp_f32 v128, v40
    s_waitcnt lgkmcnt(8)
    v_mfma_f32_32x32x16_bf16 v[0:15], a[208:211], a[144:147], v[0:15]
    ds_read_b128 a[192:195], v241 offset:8192
    v_exp_f32 v129, v41
    v_cvt_pk_bf16_f32 v115, v134, v135
    v_mfma_f32_32x32x16_bf16 v[16:31], a[208:211], a[176:179], v[16:31]
    s_mov_b32 m0, s34
    s_add_u32 s41, s42, 17664
    v_add_f32 v136, v136, v134
    v_add_f32 v137, v137, v135
    v_mfma_f32_32x32x16_bf16 v[0:15], a[212:215], a[148:151], v[0:15]
    ds_read_b128 a[196:199], v241 offset:8704
    v_exp_f32 v130, v42
    v_exp_f32 v131, v43
    v_cvt_pk_bf16_f32 v116, v128, v129
    v_mfma_f32_32x32x16_bf16 v[16:31], a[212:215], a[180:183], v[16:31]
    v_add_f32 v136, v136, v128
    v_add_f32 v137, v137, v129
    v_exp_f32 v132, v44
    v_mfma_f32_32x32x16_bf16 v[0:15], a[216:219], a[152:155], v[0:15]
    ds_read_b128 a[200:203], v241 offset:10240
    v_exp_f32 v133, v45
    v_cvt_pk_bf16_f32 v117, v130, v131
    v_add_f32 v136, v136, v130
    v_mfma_f32_32x32x16_bf16 v[16:31], a[216:219], a[184:187], v[16:31]
    buffer_load_dwordx4 v242, s[16:19], s41 offen offset:0 sc1 lds
    v_add_f32 v137, v137, v131
    v_exp_f32 v134, v46
    v_mfma_f32_32x32x16_bf16 v[0:15], a[220:223], a[156:159], v[0:15]
    ds_read_b128 a[204:207], v241 offset:10752
    v_exp_f32 v135, v47
    v_cvt_pk_bf16_f32 v118, v132, v133
    v_add_f32 v136, v136, v132
    v_mfma_f32_32x32x16_bf16 v[16:31], a[220:223], a[188:191], v[16:31]
    v_add_f32 v137, v137, v133
    v_exp_f32 v138, v48
    s_waitcnt lgkmcnt(8)
    v_mfma_f32_32x32x16_bf16 a[0:15], a[224:227], v[96:99], a[0:15]
    ds_read_b128 a[208:211], v241 offset:12288
    v_exp_f32 v139, v49
    v_cvt_pk_bf16_f32 v119, v134, v135
    v_add_f32 v136, v136, v134
    v_add_f32 v137, v137, v135
    v_mfma_f32_32x32x16_bf16 a[64:79], a[224:227], v[104:107], a[64:79]
    v_add_f32 v224, v136, v137
    v_exp_f32 v130, v50
    v_exp_f32 v131, v51
    v_mfma_f32_32x32x16_bf16 a[16:31], a[228:231], v[96:99], a[16:31]
    ds_read_b128 a[212:215], v241 offset:12800
    buffer_load_dwordx4 v242, s[16:19], s41 offen offset:1024 sc1 lds
    v_cvt_pk_bf16_f32 v120, v138, v139
    v_exp_f32 v132, v52
    v_mfma_f32_32x32x16_bf16 a[80:95], a[228:231], v[104:107], a[80:95]
    v_exp_f32 v133, v53
    v_cvt_pk_bf16_f32 v121, v130, v131
    v_add_f32 v138, v138, v130
    v_mfma_f32_32x32x16_bf16 a[32:47], a[232:235], v[96:99], a[32:47]
    ds_read_b128 a[216:219], v241 offset:14336
    v_add_f32 v139, v139, v131
    v_exp_f32 v134, v54
    v_mfma_f32_32x32x16_bf16 a[96:111], a[232:235], v[104:107], a[96:111]
    v_exp_f32 v135, v55
    v_cvt_pk_bf16_f32 v122, v132, v133
    v_add_f32 v138, v138, v132
    v_add_f32 v139, v139, v133
    v_mfma_f32_32x32x16_bf16 a[48:63], a[236:239], v[96:99], a[48:63]
    ds_read_b128 a[220:223], v241 offset:14848
    buffer_load_dwordx4 v242, s[16:19], s41 offen offset:2048 sc1 lds
    v_exp_f32 v128, v56
    v_mfma_f32_32x32x16_bf16 a[112:127], a[236:239], v[104:107], a[112:127]
    v_exp_f32 v129, v57
    v_cvt_pk_bf16_f32 v123, v134, v135
    v_add_f32 v138, v138, v134
    s_waitcnt lgkmcnt(8)
    v_mfma_f32_32x32x16_bf16 a[0:15], a[240:243], v[100:103], a[0:15]
    ds_read_b128 a[224:227], v241 offset:24576
    v_add_f32 v139, v139, v135
    v_exp_f32 v130, v58
    v_exp_f32 v131, v59
    v_mfma_f32_32x32x16_bf16 a[64:79], a[240:243], v[108:111], a[64:79]
    v_cvt_pk_bf16_f32 v124, v128, v129
    v_add_f32 v138, v138, v128
    v_add_f32 v139, v139, v129
    v_mfma_f32_32x32x16_bf16 a[16:31], a[244:247], v[100:103], a[16:31]
    ds_read_b128 a[228:231], v241 offset:26624
    buffer_load_dwordx4 v242, s[16:19], s41 offen offset:3072 sc1 lds
    v_exp_f32 v132, v60
    v_exp_f32 v133, v61
    v_mfma_f32_32x32x16_bf16 a[80:95], a[244:247], v[108:111], a[80:95]
    v_cvt_pk_bf16_f32 v125, v130, v131
    v_add_f32 v138, v138, v130
    v_add_f32 v139, v139, v131
    v_exp_f32 v134, v62
    v_mfma_f32_32x32x16_bf16 a[32:47], a[248:251], v[100:103], a[32:47]
    ds_read_b128 a[232:235], v241 offset:28672
    v_exp_f32 v135, v63
    v_cvt_pk_bf16_f32 v126, v132, v133
    v_mfma_f32_32x32x16_bf16 a[96:111], a[248:251], v[108:111], a[96:111]
    v_add_f32 v138, v138, v132
    v_add_f32 v139, v139, v133
    v_cvt_pk_bf16_f32 v127, v134, v135
    v_add_f32 v138, v138, v134
    v_mfma_f32_32x32x16_bf16 a[48:63], a[252:255], v[100:103], a[48:63]
    ds_read_b128 a[236:239], v241 offset:30720
    v_add_f32 v139, v139, v135
    v_add_f32 v225, v138, v139
    v_max_f32 v230, v224, v225
    v_cmp_lt_f32 vcc, s38, v230
    v_mfma_f32_32x32x16_bf16 a[112:127], a[252:255], v[108:111], a[112:127]
    s_cbranch_vccnz kf_rare10
kf_rr9:
    s_sub_u32 s36, s36, 1
    s_cbranch_scc1 kf_fix13
kf_fixr14:
    s_waitcnt lgkmcnt(8)
    v_mfma_f32_32x32x16_bf16 v[32:47], a[192:195], a[128:131], v[64:79]
    ds_read_b128 a[240:243], v241 offset:25088
    v_add_f32 v226, v226, v224
    v_add_f32 v227, v227, v225
    v_exp_f32 v136, v0
    v_mfma_f32_32x32x16_bf16 v[48:63], a[192:195], a[160:163], v[80:95]
    s_waitcnt vmcnt(11)
    buffer_store_dwordx4 v[196:199], v255, s[48:51], s45 offen offset:256 sc1
    s_add_u32 s101, s101, 57344
    buffer_load_dwordx4 v[196:199], v253, s[52:55], s101 offen
    v_exp_f32 v137, v1
    v_mfma_f32_32x32x16_bf16 v[32:47], a[196:199], a[132:135], v[32:47]
    ds_read_b128 a[244:247], v241 offset:27136
    v_exp_f32 v130, v2
    v_exp_f32 v131, v3
    v_mfma_f32_32x32x16_bf16 v[48:63], a[196:199], a[164:167], v[48:63]
    v_cvt_pk_bf16_f32 v96, v136, v137
    v_exp_f32 v132, v4
    v_exp_f32 v133, v5
    v_mfma_f32_32x32x16_bf16 v[32:47], a[200:203], a[136:139], v[32:47]
    ds_read_b128 a[248:251], v241 offset:29184
    s_cmp_lt_u32 s44, s47
    s_cselect_b32 s45, s46, s43
    s_add_u32 s44, s44, 128
    s_add_u32 s46, s46, 262144
    v_mfma_f32_32x32x16_bf16 v[48:63], a[200:203], a[168:171], v[48:63]
    v_cvt_pk_bf16_f32 v97, v130, v131
    v_add_f32 v136, v136, v130
    v_add_f32 v137, v137, v131
    v_exp_f32 v134, v6
    v_mfma_f32_32x32x16_bf16 v[32:47], a[204:207], a[140:143], v[32:47]
    ds_read_b128 a[252:255], v241 offset:31232
    v_exp_f32 v135, v7
    v_cvt_pk_bf16_f32 v98, v132, v133
    v_add_f32 v136, v136, v132
    v_mfma_f32_32x32x16_bf16 v[48:63], a[204:207], a[172:175], v[48:63]
    s_add_u32 m0, s34, 16384
    s_add_u32 s34, s34, 32768
    s_cmp_ge_u32 s34, 163840
    s_cselect_b32 s34, s37, s34
    v_add_f32 v137, v137, v133
    s_waitcnt lgkmcnt(8)
    v_mfma_f32_32x32x16_bf16 v[32:47], a[208:211], a[144:147], v[32:47]
    s_waitcnt vmcnt(16)
    s_barrier
    s_add_u32 s35, s35, 32768
    s_cmp_ge_u32 s35, 163840
    s_cselect_b32 s35, 0, s35
    v_add_u32 v241, s35, v239
    ds_read_b128 a[192:195], v241 offset:0
    v_mfma_f32_32x32x16_bf16 v[48:63], a[208:211], a[176:179], v[48:63]
    v_exp_f32 v128, v8
    v_exp_f32 v129, v9
    v_cvt_pk_bf16_f32 v99, v134, v135
    v_mfma_f32_32x32x16_bf16 v[32:47], a[212:215], a[148:151], v[32:47]
    ds_read_b128 a[196:199], v241 offset:512
    v_add_f32 v136, v136, v134
    v_add_f32 v137, v137, v135
    v_exp_f32 v130, v10
    v_mfma_f32_32x32x16_bf16 v[48:63], a[212:215], a[180:183], v[48:63]
    buffer_load_dwordx4 v242, s[16:19], s42 offen offset:0 sc1 lds
    v_exp_f32 v131, v11
    v_cvt_pk_bf16_f32 v100, v128, v129
    v_add_f32 v136, v136, v128
    v_mfma_f32_32x32x16_bf16 v[32:47], a[216:219], a[152:155], v[32:47]
    ds_read_b128 a[200:203], v241 offset:2048
    v_add_f32 v137, v137, v129
    v_exp_f32 v132, v12
    v_exp_f32 v133, v13
    v_mfma_f32_32x32x16_bf16 v[48:63], a[216:219], a[184:187], v[48:63]
    v_cvt_pk_bf16_f32 v101, v130, v131
    v_add_f32 v136, v136, v130
    v_add_f32 v137, v137, v131
    v_exp_f32 v134, v14
    v_mfma_f32_32x32x16_bf16 v[32:47], a[220:223], a[156:159], v[32:47]
    ds_read_b128 a[204:207], v241 offset:2560
    buffer_load_dwordx4 v242, s[16:19], s42 offen offset:1024 sc1 lds
    v_exp_f32 v135, v15
    v_mfma_f32_32x32x16_bf16 v[48:63], a[220:223], a[188:191], v[48:63]
    v_cvt_pk_bf16_f32 v102, v132, v133
    v_add_f32 v136, v136, v132
    v_add_f32 v137, v137, v133
    v_exp_f32 v138, v16
    s_waitcnt lgkmcnt(8)
    v_mfma_f32_32x32x16_bf16 a[0:15], a[224:227], v[112:115], a[0:15]
    ds_read_b128 a[208:211], v241 offset:4096
    v_exp_f32 v139, v17
    v_cvt_pk_bf16_f32 v103, v134, v135
    v_add_f32 v136, v136, v134
    v_mfma_f32_32x32x16_bf16 a[64:79], a[224:227], v[120:123], a[64:79]
    buffer_load_dwordx4 v242, s[16:19], s42 offen offset:2048 sc1 lds
    v_add_f32 v137, v137, v135
    v_add_f32 v224, v136, v137
    v_exp_f32 v130, v18
    v_mfma_f32_32x32x16_bf16 a[16:31], a[228:231], v[112:115], a[16:31]
    ds_read_b128 a[212:215], v241 offset:4608
    v_exp_f32 v131, v19
    v_cvt_pk_bf16_f32 v104, v138, v139
    v_mfma_f32_32x32x16_bf16 a[80:95], a[228:231], v[120:123], a[80:95]
    v_exp_f32 v132, v20
    v_exp_f32 v133, v21
    v_cvt_pk_bf16_f32 v105, v130, v131
    v_add_f32 v138, v138, v130
    v_mfma_f32_32x32x16_bf16 a[32:47], a[232:235], v[112:115], a[32:47]
    ds_read_b128 a[216:219], v241 offset:6144
    v_add_f32 v139, v139, v131
    v_exp_f32 v134, v22
    v_mfma_f32_32x32x16_bf16 a[96:111], a[232:235], v[120:123], a[96:111]
    buffer_load_dwordx4 v242, s[16:19], s42 offen offset:3072 sc1 lds
    s_add_u32 s42, s42, 34048
    v_exp_f32 v135, v23
    v_cvt_pk_bf16_f32 v106, v132, v133
    v_add_f32 v138, v138, v132
    v_mfma_f32_32x32x16_bf16 a[48:63], a[236:239], v[112:115], a[48:63]
    ds_read_b128 a[220:223], v241 offset:6656
    v_add_f32 v139, v139, v133
    v_exp_f32 v128, v24
    v_exp_f32 v129, v25
    v_mfma_f32_32x32x16_bf16 a[112:127], a[236:239], v[120:123], a[112:127]
    v_cvt_pk_bf16_f32 v107, v134, v135
    v_add_f32 v138, v138, v134
    v_add_f32 v139, v139, v135
    s_waitcnt lgkmcnt(8)
    v_mfma_f32_32x32x16_bf16 a[0:15], a[240:243], v[116:119], a[0:15]
    ds_read_b128 a[224:227], v241 offset:16384
    buffer_load_dword v252, v251, s[60:63], s100 offen
    s_add_u32 s100, s100, 2048
    v_exp_f32 v130, v26
    v_mfma_f32_32x32x16_bf16 a[64:79], a[240:243], v[124:127], a[64:79]
    v_exp_f32 v131, v27
    v_cvt_pk_bf16_f32 v108, v128, v129
    v_add_f32 v138, v138, v128
    v_add_f32 v139, v139, v129
    v_mfma_f32_32x32x16_bf16 a[16:31], a[244:247], v[116:119], a[16:31]
    ds_read_b128 a[228:231], v241 offset:18432
    v_exp_f32 v132, v28
    v_exp_f32 v133, v29
    v_cvt_pk_bf16_f32 v109, v130, v131
    v_mfma_f32_32x32x16_bf16 a[80:95], a[244:247], v[124:127], a[80:95]
    s_sub_u32 s27, s27, 1
    s_cbranch_scc1 kf_l2p11
kf_l2r12:
    v_add_f32 v138, v138, v130
    v_add_f32 v139, v139, v131
    v_mfma_f32_32x32x16_bf16 a[32:47], a[248:251], v[116:119], a[32:47]
    ds_read_b128 a[232:235], v241 offset:20480
    v_exp_f32 v134, v30
    v_exp_f32 v135, v31
    v_mfma_f32_32x32x16_bf16 a[96:111], a[248:251], v[124:127], a[96:111]
    v_cvt_pk_bf16_f32 v110, v132, v133
    v_add_f32 v138, v138, v132
    v_add_f32 v139, v139, v133
    v_cvt_pk_bf16_f32 v111, v134, v135
    v_add_f32 v138, v138, v134
    v_mfma_f32_32x32x16_bf16 a[48:63], a[252:255], v[116:119], a[48:63]
    ds_read_b128 a[236:239], v241 offset:22528
    v_add_f32 v139, v139, v135
    v_add_f32 v225, v138, v139
    v_max_f32 v230, v224, v225
    v_cmp_lt_f32 vcc, s38, v230
    v_mfma_f32_32x32x16_bf16 a[112:127], a[252:255], v[124:127], a[112:127]
    s_cbranch_vccnz kf_rare16
kf_rr15:
    s_sub_u32 s26, s26, 1
    s_cbranch_scc0 ka_p1
    s_lshl2_add_u32 s36, s5, s6
    s_sub_u32 s36, 59, s36
    s_mov_b32 s33, 0
    s_sub_u32 s36, s36, 1
    s_cbranch_scc1 kf_fix19
kf_fixr20:
    s_waitcnt lgkmcnt(8)
    v_mfma_f32_32x32x16_bf16 v[16:31], a[192:195], a[160:163], v[80:95]
    ds_read_b128 a[240:243], v241 offset:16896
    v_add_f32 v226, v226, v224
    v_add_f32 v227, v227, v225
    v_exp_f32 v136, v32
    v_exp_f32 v137, v33
    v_mfma_f32_32x32x16_bf16 v[16:31], a[196:199], a[164:167], v[16:31]
    ds_read_b128 a[244:247], v241 offset:18944
    s_waitcnt vmcnt(11)
    buffer_store_dwordx4 v[192:195], v255, s[48:51], s45 offen offset:0 sc1
    v_exp_f32 v130, v34
    v_mfma_f32_32x32x16_bf16 v[16:31], a[200:203], a[168:171], v[16:31]
    ds_read_b128 a[248:251], v241 offset:20992
    v_exp_f32 v131, v35
    v_cvt_pk_bf16_f32 v112, v136, v137
    v_exp_f32 v132, v36
    v_mfma_f32_32x32x16_bf16 v[16:31], a[204:207], a[172:175], v[16:31]
    ds_read_b128 a[252:255], v241 offset:23040
    v_exp_f32 v133, v37
    v_cvt_pk_bf16_f32 v113, v130, v131
    v_add_f32 v136, v136, v130
    v_add_f32 v137, v137, v131
    s_waitcnt lgkmcnt(8)
    v_mfma_f32_32x32x16_bf16 v[16:31], a[208:211], a[176:179], v[16:31]
    ds_read_b128 a[192:195], v241 offset:8192
    s_sub_u32 s27, s27, 1
    s_cbranch_scc1 kf_l2p17
kf_l2r18:
    v_exp_f32 v134, v38
    v_mfma_f32_32x32x16_bf16 v[16:31], a[212:215], a[180:183], v[16:31]
    ds_read_b128 a[196:199], v241 offset:8704
    v_exp_f32 v135, v39
    v_cvt_pk_bf16_f32 v114, v132, v133
    v_add_f32 v136, v136, v132
    v_add_f32 v137, v137, v133
    v_mfma_f32_32x32x16_bf16 v[16:31], a[216:219], a[184:187], v[16:31]
    ds_read_b128 a[200:203], v241 offset:10240
    v_exp_f32 v128, v40
    v_exp_f32 v129, v41
    v_cvt_pk_bf16_f32 v115, v134, v135
    v_add_f32 v136, v136, v134
    v_mfma_f32_32x32x16_bf16 v[16:31], a[220:223], a[188:191], v[16:31]
    ds_read_b128 a[204:207], v241 offset:10752
    s_mov_b32 m0, s34
    s_add_u32 s41, s42, 17664
    v_add_f32 v137, v137, v135
    s_waitcnt lgkmcnt(8)
    v_mfma_f32_32x32x16_bf16 a[0:15], a[224:227], v[96:99], a[0:15]
    ds_read_b128 a[208:211], v241 offset:12288
    v_exp_f32 v130, v42
    v_exp_f32 v131, v43
    v_cvt_pk_bf16_f32 v116, v128, v129
    v_add_f32 v136, v136, v128
    v_mfma_f32_32x32x16_bf16 a[64:79], a[224:227], v[104:107], a[64:79]
    v_add_f32 v137, v137, v129
    v_exp_f32 v132, v44
    v_exp_f32 v133, v45
    v_cvt_pk_bf16_f32 v117, v130, v131
    v_mfma_f32_32x32x16_bf16 a[16:31], a[228:231], v[96:99], a[16:31]
    ds_read_b128 a[212:215], v241 offset:12800
    buffer_load_dwordx4 v242, s[16:19], s41 offen offset:0 sc1 lds
    v_add_f32 v136, v136, v130
    v_add_f32 v137, v137, v131
    v_exp_f32 v134, v46
    v_mfma_f32_32x32x16_bf16 a[80:95], a[228:231], v[104:107], a[80:95]
    v_exp_f32 v135, v47
    v_cvt_pk_bf16_f32 v118, v132, v133
    v_add_f32 v136, v136, v132
    v_add_f32 v137, v137, v133
    v_exp_f32 v138, v48
    v_mfma_f32_32x32x16_bf16 a[32:47], a[232:235], v[96:99], a[32:47]
    ds_read_b128 a[216:219], v241 offset:14336
    v_exp_f32 v139, v49
    v_cvt_pk_bf16_f32 v119, v134, v135
    v_add_f32 v136, v136, v134
    v_add_f32 v137, v137, v135
    v_mfma_f32_32x32x16_bf16 a[96:111], a[232:235], v[104:107], a[96:111]
    buffer_load_dwordx4 v242, s[16:19], s41 offen offset:1024 sc1 lds
    v_add_f32 v224, v136, v137
    v_exp_f32 v130, v50
    v_exp_f32 v131, v51
    v_mfma_f32_32x32x16_bf16 a[48:63], a[236:239], v[96:99], a[48:63]
    ds_read_b128 a[220:223], v241 offset:14848
    v_cvt_pk_bf16_f32 v120, v138, v139
    v_exp_f32 v132, v52
    v_exp_f32 v133, v53
    v_cvt_pk_bf16_f32 v121, v130, v131
    v_mfma_f32_32x32x16_bf16 a[112:127], a[236:239], v[104:107], a[112:127]
    v_add_f32 v138, v138, v130
    v_add_f32 v139, v139, v131
    v_exp_f32 v134, v54
    v_exp_f32 v135, v55
    s_waitcnt lgkmcnt(8)
    v_mfma_f32_32x32x16_bf16 a[0:15], a[240:243], v[100:103], a[0:15]
    ds_read_b128 a[224:227], v241 offset:24576
    buffer_load_dwordx4 v242, s[16:19], s41 offen offset:2048 sc1 lds
    v_cvt_pk_bf16_f32 v122, v132, v133
    v_add_f32 v138, v138, v132
    v_add_f32 v139, v139, v133
    v_mfma_f32_32x32x16_bf16 a[64:79], a[240:243], v[108:111], a[64:79]
    v_exp_f32 v128, v56
    v_exp_f32 v129, v57
    v_cvt_pk_bf16_f32 v123, v134, v135
    v_add_f32 v138, v138, v134
    v_add_f32 v139, v139, v135
    v_mfma_f32_32x32x16_bf16 a[16:31], a[244:247], v[100:103], a[16:31]
    ds_read_b128 a[228:231], v241 offset:26624
    v_exp_f32 v130, v58
    v_exp_f32 v131, v59
    v_cvt_pk_bf16_f32 v124, v128, v129
    v_mfma_f32_32x32x16_bf16 a[80:95], a[244:247], v[108:111], a[80:95]
    buffer_load_dwordx4 v242, s[16:19], s41 offen offset:3072 sc1 lds
    v_add_f32 v138, v138, v128
    v_add_f32 v139, v139, v129
    v_exp_f32 v132, v60
    v_exp_f32 v133, v61
    v_mfma_f32_32x32x16_bf16 a[32:47], a[248:251], v[100:103], a[32:47]
    ds_read_b128 a[232:235], v241 offset:28672
    v_cvt_pk_bf16_f32 v125, v130, v131
    v_add_f32 v138, v138, v130
    v_add_f32 v139, v139, v131
    v_exp_f32 v134, v62
    v_mfma_f32_32x32x16_bf16 a[96:111], a[248:251], v[108:111], a[96:111]
    v_exp_f32 v135, v63
    v_cvt_pk_bf16_f32 v126, v132, v133
    v_add_f32 v138, v138, v132
    v_add_f32 v139, v139, v133
    v_cvt_pk_bf16_f32 v127, v134, v135
    v_mfma_f32_32x32x16_bf16 a[48:63], a[252:255], v[100:103], a[48:63]
    ds_read_b128 a[236:239], v241 offset:30720
    v_add_f32 v138, v138, v134
    v_add_f32 v139, v139, v135
    v_add_f32 v225, v138, v139
    v_max_f32 v230, v224, v225
    v_cmp_lt_f32 vcc, s38, v230
    v_mfma_f32_32x32x16_bf16 a[112:127], a[252:255], v[108:111], a[112:127]
    s_cbranch_vccnz kf_rare22
kf_rr21:
    s_sub_u32 s36, s36, 1
    s_cbranch_scc1 kf_fix25
kf_fixr26:
    s_waitcnt lgkmcnt(8)
    v_mfma_f32_32x32x16_bf16 v[48:63], a[192:195], a[160:163], v[80:95]
    ds_read_b128 a[240:243], v241 offset:25088
    v_add_f32 v226, v226, v224
    v_add_f32 v227, v227, v225
    v_mfma_f32_32x32x16_bf16 v[48:63], a[196:199], a[164:167], v[48:63]
    ds_read_b128 a[244:247], v241 offset:27136
    s_waitcnt vmcnt(10)
    buffer_store_dwordx4 v[196:199], v255, s[48:51], s45 offen offset:256 sc1
    v_exp_f32 v138, v16
    v_mfma_f32_32x32x16_bf16 v[48:63], a[200:203], a[168:171], v[48:63]
    ds_read_b128 a[248:251], v241 offset:29184
    v_exp_f32 v139, v17
    v_exp_f32 v130, v18
    v_mfma_f32_32x32x16_bf16 v[48:63], a[204:207], a[172:175], v[48:63]
    ds_read_b128 a[252:255], v241 offset:31232
    v_exp_f32 v131, v19
    s_waitcnt lgkmcnt(8)
    v_mfma_f32_32x32x16_bf16 v[48:63], a[208:211], a[176:179], v[48:63]
    s_waitcnt vmcnt(19)
    s_barrier
    s_add_u32 s35, s35, 32768
    s_cmp_ge_u32 s35, 163840
    s_cselect_b32 s35, 0, s35
    v_add_u32 v241, s35, v239
    ds_read_b128 a[192:195], v241 offset:0
    s_add_u32 m0, s34, 16384
    s_add_u32 s34, s34, 32768
    s_cmp_ge_u32 s34, 163840
    s_cselect_b32 s34, s37, s34
    v_mfma_f32_32x32x16_bf16 v[48:63], a[212:215], a[180:183], v[48:63]
    ds_read_b128 a[196:199], v241 offset:512
    v_cvt_pk_bf16_f32 v104, v138, v139
    v_exp_f32 v132, v20
    v_mfma_f32_32x32x16_bf16 v[48:63], a[216:219], a[184:187], v[48:63]
    ds_read_b128 a[200:203], v241 offset:2048
    v_exp_f32 v133, v21
    v_mfma_f32_32x32x16_bf16 v[48:63], a[220:223], a[188:191], v[48:63]
    ds_read_b128 a[204:207], v241 offset:2560
    buffer_load_dwordx4 v242, s[16:19], s42 offen offset:0 sc1 lds
    v_cvt_pk_bf16_f32 v105, v130, v131
    v_add_f32 v138, v138, v130
    s_waitcnt lgkmcnt(8)
    v_mfma_f32_32x32x16_bf16 a[0:15], a[224:227], v[112:115], a[0:15]
    ds_read_b128 a[208:211], v241 offset:4096
    v_add_f32 v139, v139, v131
    v_exp_f32 v134, v22
    v_mfma_f32_32x32x16_bf16 a[64:79], a[224:227], v[120:123], a[64:79]
    v_exp_f32 v135, v23
    v_cvt_pk_bf16_f32 v106, v132, v133
    v_mfma_f32_32x32x16_bf16 a[16:31], a[228:231], v[112:115], a[16:31]
    ds_read_b128 a[212:215], v241 offset:4608
    buffer_load_dwordx4 v242, s[16:19], s42 offen offset:1024 sc1 lds
    v_add_f32 v138, v138, v132
    v_add_f32 v139, v139, v133
    v_mfma_f32_32x32x16_bf16 a[80:95], a[228:231], v[120:123], a[80:95]
    v_exp_f32 v128, v24
    v_exp_f32 v129, v25
    v_mfma_f32_32x32x16_bf16 a[32:47], a[232:235], v[112:115], a[32:47]
    ds_read_b128 a[216:219], v241 offset:6144
    v_cvt_pk_bf16_f32 v107, v134, v135
    v_add_f32 v138, v138, v134
    v_mfma_f32_32x32x16_bf16 a[96:111], a[232:235], v[120:123], a[96:111]
    buffer_load_dwordx4 v242, s[16:19], s42 offen offset:2048 sc1 lds
    v_add_f32 v139, v139, v135
    v_exp_f32 v130, v26
    v_mfma_f32_32x32x16_bf16 a[48:63], a[236:239], v[112:115], a[48:63]
    ds_read_b128 a[220:223], v241 offset:6656
    v_exp_f32 v131, v27
    v_cvt_pk_bf16_f32 v108, v128, v129
    v_mfma_f32_32x32x16_bf16 a[112:127], a[236:239], v[120:123], a[112:127]
    v_add_f32 v138, v138, v128
    v_add_f32 v139, v139, v129
    s_waitcnt lgkmcnt(8)
    v_mfma_f32_32x32x16_bf16 a[0:15], a[240:243], v[116:119], a[0:15]
    ds_read_b128 a[224:227], v241 offset:16384
    buffer_load_dwordx4 v242, s[16:19], s42 offen offset:3072 sc1 lds
    s_add_u32 s42, s42, 34048
    v_exp_f32 v132, v28
    v_mfma_f32_32x32x16_bf16 a[64:79], a[240:243], v[124:127], a[64:79]
    v_exp_f32 v133, v29
    v_cvt_pk_bf16_f32 v109, v130, v131
    v_add_f32 v138, v138, v130
    v_mfma_f32_32x32x16_bf16 a[16:31], a[244:247], v[116:119], a[16:31]
    ds_read_b128 a[228:231], v241 offset:18432
    v_add_f32 v139, v139, v131
    v_exp_f32 v134, v30
    v_mfma_f32_32x32x16_bf16 a[80:95], a[244:247], v[124:127], a[80:95]
    s_sub_u32 s27, s27, 1
    s_cbranch_scc1 kf_l2p23
kf_l2r24:
    v_exp_f32 v135, v31
    v_mfma_f32_32x32x16_bf16 a[32:47], a[248:251], v[116:119], a[32:47]
    ds_read_b128 a[232:235], v241 offset:20480
    v_cvt_pk_bf16_f32 v110, v132, v133
    v_add_f32 v138, v138, v132
    v_mfma_f32_32x32x16_bf16 a[96:111], a[248:251], v[124:127], a[96:111]
    v_add_f32 v139, v139, v133
    v_cvt_pk_bf16_f32 v111, v134, v135
    v_add_f32 v138, v138, v134
    v_mfma_f32_32x32x16_bf16 a[48:63], a[252:255], v[116:119], a[48:63]
    ds_read_b128 a[236:239], v241 offset:22528
    v_add_f32 v139, v139, v135
    v_add_f32 v225, v138, v139
    v_cmp_lt_f32 vcc, s38, v225
    v_mfma_f32_32x32x16_bf16 a[112:127], a[252:255], v[124:127], a[112:127]
    s_cbranch_vccnz kf_rare28
kf_rr27:
    s_nop 7
    v_mov_b32 v230, v226
    s_nop 1
    v_permlane32_swap_b32 v226, v230
    s_nop 0
    v_add_f32 v230, v230, v226
    v_rcp_f32 v230, v230
    s_nop 0
    v_accvgpr_read_b32 v160, a0
    v_accvgpr_read_b32 v161, a1
    v_accvgpr_read_b32 v162, a2
    v_accvgpr_read_b32 v163, a3
    v_accvgpr_read_b32 v164, a4
    v_accvgpr_read_b32 v165, a5
    v_accvgpr_read_b32 v166, a6
    v_accvgpr_read_b32 v167, a7
    v_mul_f32 v160, v160, v230
    v_mul_f32 v161, v161, v230
    v_mul_f32 v162, v162, v230
    v_mul_f32 v163, v163, v230
    v_mul_f32 v164, v164, v230
    v_mul_f32 v165, v165, v230
    v_mul_f32 v166, v166, v230
    v_mul_f32 v167, v167, v230
    v_cvt_pk_bf16_f32 v176, v160, v161
    v_cvt_pk_bf16_f32 v177, v162, v163
    v_cvt_pk_bf16_f32 v178, v164, v165
    v_cvt_pk_bf16_f32 v179, v166, v167
    buffer_store_dwordx4 v[176:179], v244, s[20:23], s39 offen offset:0 sc1
    v_accvgpr_read_b32 v168, a8
    v_accvgpr_read_b32 v169, a9
    v_accvgpr_read_b32 v170, a10
    v_accvgpr_read_b32 v171, a11
    v_accvgpr_read_b32 v172, a12
    v_accvgpr_read_b32 v173, a13
    v_accvgpr_read_b32 v174, a14
    v_accvgpr_read_b32 v175, a15
    v_mul_f32 v168, v168, v230
    v_mul_f32 v169, v169, v230
    v_mul_f32 v170, v170, v230
    v_mul_f32 v171, v171, v230
    v_mul_f32 v172, v172, v230
    v_mul_f32 v173, v173, v230
    v_mul_f32 v174, v174, v230
    v_mul_f32 v175, v175, v230
    v_cvt_pk_bf16_f32 v180, v168, v169
    v_cvt_pk_bf16_f32 v181, v170, v171
    v_cvt_pk_bf16_f32 v182, v172, v173
    v_cvt_pk_bf16_f32 v183, v174, v175
    buffer_store_dwordx4 v[180:183], v244, s[20:23], s39 offen offset:512 sc1
    v_accvgpr_read_b32 v160, a16
    v_accvgpr_read_b32 v161, a17
    v_accvgpr_read_b32 v162, a18
    v_accvgpr_read_b32 v163, a19
    v_accvgpr_read_b32 v164, a20
    v_accvgpr_read_b32 v165, a21
    v_accvgpr_read_b32 v166, a22
    v_accvgpr_read_b32 v167, a23
    v_mul_f32 v160, v160, v230
    v_mul_f32 v161, v161, v230
    v_mul_f32 v162, v162, v230
    v_mul_f32 v163, v163, v230
    v_mul_f32 v164, v164, v230
    v_mul_f32 v165, v165, v230
    v_mul_f32 v166, v166, v230
    v_mul_f32 v167, v167, v230
    v_cvt_pk_bf16_f32 v184, v160, v161
    v_cvt_pk_bf16_f32 v185, v162, v163
    v_cvt_pk_bf16_f32 v186, v164, v165
    v_cvt_pk_bf16_f32 v187, v166, v167
    buffer_store_dwordx4 v[184:187], v244, s[20:23], s39 offen offset:1024 sc1
    v_accvgpr_read_b32 v168, a24
    v_accvgpr_read_b32 v169, a25
    v_accvgpr_read_b32 v170, a26
    v_accvgpr_read_b32 v171, a27
    v_accvgpr_read_b32 v172, a28
    v_accvgpr_read_b32 v173, a29
    v_accvgpr_read_b32 v174, a30
    v_accvgpr_read_b32 v175, a31
    v_mul_f32 v168, v168, v230
    v_mul_f32 v169, v169, v230
    v_mul_f32 v170, v170, v230
    v_mul_f32 v171, v171, v230
    v_mul_f32 v172, v172, v230
    v_mul_f32 v173, v173, v230
    v_mul_f32 v174, v174, v230
    v_mul_f32 v175, v175, v230
    v_cvt_pk_bf16_f32 v188, v168, v169
    v_cvt_pk_bf16_f32 v189, v170, v171
    v_cvt_pk_bf16_f32 v190, v172, v173
    v_cvt_pk_bf16_f32 v191, v174, v175
    buffer_store_dwordx4 v[188:191], v244, s[20:23], s39 offen offset:1536 sc1
    v_accvgpr_read_b32 v160, a32
    v_accvgpr_read_b32 v161, a33
    v_accvgpr_read_b32 v162, a34
    v_accvgpr_read_b32 v163, a35
    v_accvgpr_read_b32 v164, a36
    v_accvgpr_read_b32 v165, a37
    v_accvgpr_read_b32 v166, a38
    v_accvgpr_read_b32 v167, a39
    v_mul_f32 v160, v160, v230
    v_mul_f32 v161, v161, v230
    v_mul_f32 v162, v162, v230
    v_mul_f32 v163, v163, v230
    v_mul_f32 v164, v164, v230
    v_mul_f32 v165, v165, v230
    v_mul_f32 v166, v166, v230
    v_mul_f32 v167, v167, v230
    v_cvt_pk_bf16_f32 v176, v160, v161
    v_cvt_pk_bf16_f32 v177, v162, v163
    v_cvt_pk_bf16_f32 v178, v164, v165
    v_cvt_pk_bf16_f32 v179, v166, v167
    buffer_store_dwordx4 v[176:179], v244, s[20:23], s39 offen offset:2048 sc1
    v_accvgpr_read_b32 v168, a40
    v_accvgpr_read_b32 v169, a41
    v_accvgpr_read_b32 v170, a42
    v_accvgpr_read_b32 v171, a43
    v_accvgpr_read_b32 v172, a44
    v_accvgpr_read_b32 v173, a45
    v_accvgpr_read_b32 v174, a46
    v_accvgpr_read_b32 v175, a47
    v_mul_f32 v168, v168, v230
    v_mul_f32 v169, v169, v230
    v_mul_f32 v170, v170, v230
    v_mul_f32 v171, v171, v230
    v_mul_f32 v172, v172, v230
    v_mul_f32 v173, v173, v230
    v_mul_f32 v174, v174, v230
    v_mul_f32 v175, v175, v230
    v_cvt_pk_bf16_f32 v180, v168, v169
    v_cvt_pk_bf16_f32 v181, v170, v171
    v_cvt_pk_bf16_f32 v182, v172, v173
    v_cvt_pk_bf16_f32 v183, v174, v175
    buffer_store_dwordx4 v[180:183], v244, s[20:23], s39 offen offset:2560 sc1
    v_accvgpr_read_b32 v160, a48
    v_accvgpr_read_b32 v161, a49
    v_accvgpr_read_b32 v162, a50
    v_accvgpr_read_b32 v163, a51
    v_accvgpr_read_b32 v164, a52
    v_accvgpr_read_b32 v165, a53
    v_accvgpr_read_b32 v166, a54
    v_accvgpr_read_b32 v167, a55
    v_mul_f32 v160, v160, v230
    v_mul_f32 v161, v161, v230
    v_mul_f32 v162, v162, v230
    v_mul_f32 v163, v163, v230
    v_mul_f32 v164, v164, v230
    v_mul_f32 v165, v165, v230
    v_mul_f32 v166, v166, v230
    v_mul_f32 v167, v167, v230
    v_cvt_pk_bf16_f32 v184, v160, v161
    v_cvt_pk_bf16_f32 v185, v162, v163
    v_cvt_pk_bf16_f32 v186, v164, v165
    v_cvt_pk_bf16_f32 v187, v166, v167
    buffer_store_dwordx4 v[184:187], v244, s[20:23], s39 offen offset:3072 sc1
    v_accvgpr_read_b32 v168, a56
    v_accvgpr_read_b32 v169, a57
    v_accvgpr_read_b32 v170, a58
    v_accvgpr_read_b32 v171, a59
    v_accvgpr_read_b32 v172, a60
    v_accvgpr_read_b32 v173, a61
    v_accvgpr_read_b32 v174, a62
    v_accvgpr_read_b32 v175, a63
    v_mul_f32 v168, v168, v230
    v_mul_f32 v169, v169, v230
    v_mul_f32 v170, v170, v230
    v_mul_f32 v171, v171, v230
    v_mul_f32 v172, v172, v230
    v_mul_f32 v173, v173, v230
    v_mul_f32 v174, v174, v230
    v_mul_f32 v175, v175, v230
    v_cvt_pk_bf16_f32 v188, v168, v169
    v_cvt_pk_bf16_f32 v189, v170, v171
    v_cvt_pk_bf16_f32 v190, v172, v173
    v_cvt_pk_bf16_f32 v191, v174, v175
    buffer_store_dwordx4 v[188:191], v244, s[20:23], s39 offen offset:3584 sc1
    s_lshl_b32 s26, s5, 2
    s_sub_u32 s26, 28, s26
.p2align 3
ka_p2:
    s_sub_u32 s36, s36, 1
    s_cbranch_scc1 kf_fix29
kf_fixr30:
    s_waitcnt lgkmcnt(8)
    v_mfma_f32_32x32x16_bf16 v[16:31], a[192:195], a[160:163], v[80:95]
    ds_read_b128 a[240:243], v241 offset:16896
    v_add_f32 v227, v227, v225
    v_exp_f32 v138, v48
    v_exp_f32 v139, v49
    v_mfma_f32_32x32x16_bf16 v[16:31], a[196:199], a[164:167], v[16:31]
    ds_read_b128 a[244:247], v241 offset:18944
    s_mov_b32 m0, s34
    s_add_u32 s41, s42, 17664
    v_exp_f32 v130, v50
    v_mfma_f32_32x32x16_bf16 v[16:31], a[200:203], a[168:171], v[16:31]
    ds_read_b128 a[248:251], v241 offset:20992
    v_exp_f32 v131, v51
    v_cvt_pk_bf16_f32 v120, v138, v139
    v_exp_f32 v132, v52
    v_mfma_f32_32x32x16_bf16 v[16:31], a[204:207], a[172:175], v[16:31]
    ds_read_b128 a[252:255], v241 offset:23040
    buffer_load_dwordx4 v242, s[16:19], s41 offen offset:0 sc1 lds
    v_exp_f32 v133, v53
    s_waitcnt lgkmcnt(8)
    v_mfma_f32_32x32x16_bf16 v[16:31], a[208:211], a[176:179], v[16:31]
    ds_read_b128 a[192:195], v241 offset:8192
    v_cvt_pk_bf16_f32 v121, v130, v131
    v_add_f32 v138, v138, v130
    v_add_f32 v139, v139, v131
    v_exp_f32 v134, v54
    v_mfma_f32_32x32x16_bf16 v[16:31], a[212:215], a[180:183], v[16:31]
    ds_read_b128 a[196:199], v241 offset:8704
    v_exp_f32 v135, v55
    v_cvt_pk_bf16_f32 v122, v132, v133
    v_mfma_f32_32x32x16_bf16 v[16:31], a[216:219], a[184:187], v[16:31]
    ds_read_b128 a[200:203], v241 offset:10240
    buffer_load_dwordx4 v242, s[16:19], s41 offen offset:1024 sc1 lds
    v_add_f32 v138, v138, v132
    v_add_f32 v139, v139, v133
    v_exp_f32 v128, v56
    v_mfma_f32_32x32x16_bf16 v[16:31], a[220:223], a[188:191], v[16:31]
    ds_read_b128 a[204:207], v241 offset:10752
    v_exp_f32 v129, v57
    v_cvt_pk_bf16_f32 v123, v134, v135
    s_waitcnt lgkmcnt(8)
    v_mfma_f32_32x32x16_bf16 a[64:79], a[224:227], v[104:107], a[64:79]
    ds_read_b128 a[208:211], v241 offset:12288
    v_add_f32 v138, v138, v134
    v_add_f32 v139, v139, v135
    v_exp_f32 v130, v58
    v_mfma_f32_32x32x16_bf16 a[80:95], a[228:231], v[104:107], a[80:95]
    ds_read_b128 a[212:215], v241 offset:12800
    buffer_load_dwordx4 v242, s[16:19], s41 offen offset:2048 sc1 lds
    v_exp_f32 v131, v59
    v_cvt_pk_bf16_f32 v124, v128, v129
    v_add_f32 v138, v138, v128
    v_mfma_f32_32x32x16_bf16 a[96:111], a[232:235], v[104:107], a[96:111]
    ds_read_b128 a[216:219], v241 offset:14336
    v_add_f32 v139, v139, v129
    v_exp_f32 v132, v60
    v_exp_f32 v133, v61
    v_mfma_f32_32x32x16_bf16 a[112:127], a[236:239], v[104:107], a[112:127]
    ds_read_b128 a[220:223], v241 offset:14848
    v_cvt_pk_bf16_f32 v125, v130, v131
    v_add_f32 v138, v138, v130
    v_add_f32 v139, v139, v131
    s_waitcnt lgkmcnt(8)
    v_mfma_f32_32x32x16_bf16 a[64:79], a[240:243], v[108:111], a[64:79]
    ds_read_b128 a[224:227], v241 offset:24576
    buffer_load_dwordx4 v242, s[16:19], s41 offen offset:3072 sc1 lds
    v_exp_f32 v134, v62
    v_exp_f32 v135, v63
    v_mfma_f32_32x32x16_bf16 a[80:95], a[244:247], v[108:111], a[80:95]
    ds_read_b128 a[228:231], v241 offset:26624
    v_cvt_pk_bf16_f32 v126, v132, v133
    v_add_f32 v138, v138, v132
    v_add_f32 v139, v139, v133
    v_cvt_pk_bf16_f32 v127, v134, v135
    v_mfma_f32_32x32x16_bf16 a[96:111], a[248:251], v[108:111], a[96:111]
    ds_read_b128 a[232:235], v241 offset:28672
    v_add_f32 v138, v138, v134
    v_add_f32 v139, v139, v135
    v_add_f32 v225, v138, v139
    v_cmp_lt_f32 vcc, s38, v225
    v_mfma_f32_32x32x16_bf16 a[112:127], a[252:255], v[108:111], a[112:127]
    ds_read_b128 a[236:239], v241 offset:30720
    s_cbranch_vccnz kf_rare32
kf_rr31:
    s_sub_u32 s36, s36, 1
    s_cbranch_scc1 kf_fix35
kf_fixr36:
    s_waitcnt lgkmcnt(8)
    v_mfma_f32_32x32x16_bf16 v[48:63], a[192:195], a[160:163], v[80:95]
    ds_read_b128 a[240:243], v241 offset:25088
    v_add_f32 v227, v227, v225
    v_exp_f32 v138, v16
    v_exp_f32 v139, v17
    v_mfma_f32_32x32x16_bf16 v[48:63], a[196:199], a[164:167], v[48:63]
    ds_read_b128 a[244:247], v241 offset:27136
    s_add_u32 m0, s34, 16384
    s_add_u32 s34, s34, 32768
    s_cmp_ge_u32 s34, 163840
    s_cselect_b32 s34, s37, s34
    v_exp_f32 v130, v18
    v_mfma_f32_32x32x16_bf16 v[48:63], a[200:203], a[168:171], v[48:63]
    ds_read_b128 a[248:251], v241 offset:29184
    v_exp_f32 v131, v19
    v_cvt_pk_bf16_f32 v104, v138, v139
    v_exp_f32 v132, v20
    v_mfma_f32_32x32x16_bf16 v[48:63], a[204:207], a[172:175], v[48:63]
    ds_read_b128 a[252:255], v241 offset:31232
    buffer_load_dwordx4 v242, s[16:19], s42 offen offset:0 sc1 lds
    v_exp_f32 v133, v21
    v_cvt_pk_bf16_f32 v105, v130, v131
    s_waitcnt lgkmcnt(8)
    v_mfma_f32_32x32x16_bf16 v[48:63], a[208:211], a[176:179], v[48:63]
    s_waitcnt vmcnt(13)
    s_barrier
    s_add_u32 s35, s35, 32768
    s_cmp_ge_u32 s35, 163840
    s_cselect_b32 s35, 0, s35
    v_add_u32 v241, s35, v239
    ds_read_b128 a[192:195], v241 offset:0
    v_mfma_f32_32x32x16_bf16 v[48:63], a[212:215], a[180:183], v[48:63]
    ds_read_b128 a[196:199], v241 offset:512
    buffer_load_dwordx4 v242, s[16:19], s42 offen offset:1024 sc1 lds
    v_add_f32 v138, v138, v130
    v_add_f32 v139, v139, v131
    v_exp_f32 v134, v22
    v_mfma_f32_32x32x16_bf16 v[48:63], a[216:219], a[184:187], v[48:63]
    ds_read_b128 a[200:203], v241 offset:2048
    v_exp_f32 v135, v23
    v_cvt_pk_bf16_f32 v106, v132, v133
    v_add_f32 v138, v138, v132
    v_add_f32 v139, v139, v133
    v_mfma_f32_32x32x16_bf16 v[48:63], a[220:223], a[188:191], v[48:63]
    ds_read_b128 a[204:207], v241 offset:2560
    v_exp_f32 v128, v24
    v_exp_f32 v129, v25
    s_waitcnt lgkmcnt(8)
    v_mfma_f32_32x32x16_bf16 a[64:79], a[224:227], v[120:123], a[64:79]
    ds_read_b128 a[208:211], v241 offset:4096
    buffer_load_dwordx4 v242, s[16:19], s42 offen offset:2048 sc1 lds
    v_cvt_pk_bf16_f32 v107, v134, v135
    v_add_f32 v138, v138, v134
    v_add_f32 v139, v139, v135
    v_exp_f32 v130, v26
    v_mfma_f32_32x32x16_bf16 a[80:95], a[228:231], v[120:123], a[80:95]
    ds_read_b128 a[212:215], v241 offset:4608
    v_exp_f32 v131, v27
    v_cvt_pk_bf16_f32 v108, v128, v129
    v_add_f32 v138, v138, v128
    v_mfma_f32_32x32x16_bf16 a[96:111], a[232:235], v[120:123], a[96:111]
    ds_read_b128 a[216:219], v241 offset:6144
    buffer_load_dwordx4 v242, s[16:19], s42 offen offset:3072 sc1 lds
    s_add_u32 s42, s42, 34048
    v_add_f32 v139, v139, v129
    v_exp_f32 v132, v28
    v_mfma_f32_32x32x16_bf16 a[112:127], a[236:239], v[120:123], a[112:127]
    ds_read_b128 a[220:223], v241 offset:6656
    v_exp_f32 v133, v29
    v_cvt_pk_bf16_f32 v109, v130, v131
    v_add_f32 v138, v138, v130
    v_add_f32 v139, v139, v131
    s_waitcnt lgkmcnt(8)
    v_mfma_f32_32x32x16_bf16 a[64:79], a[240:243], v[124:127], a[64:79]
    ds_read_b128 a[224:227], v241 offset:16384
    s_sub_u32 s27, s27, 1
    s_cbranch_scc1 kf_l2p33
kf_l2r34:
    v_exp_f32 v134, v30
    v_mfma_f32_32x32x16_bf16 a[80:95], a[244:247], v[124:127], a[80:95]
    ds_read_b128 a[228:231], v241 offset:18432
    v_exp_f32 v135, v31
    v_cvt_pk_bf16_f32 v110, v132, v133
    v_add_f32 v138, v138, v132
    v_add_f32 v139, v139, v133
    v_mfma_f32_32x32x16_bf16 a[96:111], a[248:251], v[124:127], a[96:111]
    ds_read_b128 a[232:235], v241 offset:20480
    v_cvt_pk_bf16_f32 v111, v134, v135
    v_add_f32 v138, v138, v134
    v_add_f32 v139, v139, v135
    v_add_f32 v225, v138, v139
    v_cmp_lt_f32 vcc, s38, v225
    v_mfma_f32_32x32x16_bf16 a[112:127], a[252:255], v[124:127], a[112:127]
    ds_read_b128 a[236:239], v241 offset:22528
    s_cbranch_vccnz kf_rare38
kf_rr37:
    s_sub_u32 s26, s26, 1
    s_cbranch_scc0 ka_p2
    s_waitcnt lgkmcnt(0)
    ds_read_b128 a[224:227], v241 offset:16384
    ds_read_b128 a[228:231], v241 offset:18432
    ds_read_b128 a[232:235], v241 offset:20480
    ds_read_b128 a[236:239], v241 offset:22528
    ds_read_b128 a[240:243], v241 offset:16896
    ds_read_b128 a[244:247], v241 offset:18944
    ds_read_b128 a[248:251], v241 offset:20992
    ds_read_b128 a[252:255], v241 offset:23040
    ds_read_b128 a[192:195], v241 offset:24576
    ds_read_b128 a[196:199], v241 offset:26624
    ds_read_b128 a[200:203], v241 offset:28672
    ds_read_b128 a[204:207], v241 offset:30720
    ds_read_b128 a[208:211], v241 offset:25088
    ds_read_b128 a[212:215], v241 offset:27136
    ds_read_b128 a[216:219], v241 offset:29184
    s_waitcnt lgkmcnt(7)
    ds_read_b128 a[220:223], v241 offset:31232
    v_mfma_f32_32x32x16_bf16 a[64:79], a[224:227], v[104:107], a[64:79]
    v_add_f32 v227, v227, v225
    v_exp_f32 v138, v48
    v_exp_f32 v139, v49
    v_exp_f32 v130, v50
    v_exp_f32 v131, v51
    v_mfma_f32_32x32x16_bf16 a[80:95], a[228:231], v[104:107], a[80:95]
    v_cvt_pk_bf16_f32 v120, v138, v139
    v_exp_f32 v132, v52
    v_exp_f32 v133, v53
    v_cvt_pk_bf16_f32 v121, v130, v131
    v_add_f32 v138, v138, v130
    v_mfma_f32_32x32x16_bf16 a[96:111], a[232:235], v[104:107], a[96:111]
    v_add_f32 v139, v139, v131
    v_exp_f32 v134, v54
    v_exp_f32 v135, v55
    v_cvt_pk_bf16_f32 v122, v132, v133
    v_add_f32 v138, v138, v132
    v_add_f32 v139, v139, v133
    v_mfma_f32_32x32x16_bf16 a[112:127], a[236:239], v[104:107], a[112:127]
    v_exp_f32 v128, v56
    v_exp_f32 v129, v57
    v_cvt_pk_bf16_f32 v123, v134, v135
    v_add_f32 v138, v138, v134
    v_add_f32 v139, v139, v135
    v_exp_f32 v130, v58
    v_mfma_f32_32x32x16_bf16 a[64:79], a[240:243], v[108:111], a[64:79]
    v_exp_f32 v131, v59
    v_cvt_pk_bf16_f32 v124, v128, v129
    v_add_f32 v138, v138, v128
    v_add_f32 v139, v139, v129
    v_exp_f32 v132, v60
    v_mfma_f32_32x32x16_bf16 a[80:95], a[244:247], v[108:111], a[80:95]
    v_exp_f32 v133, v61
    v_cvt_pk_bf16_f32 v125, v130, v131
    v_add_f32 v138, v138, v130
    v_add_f32 v139, v139, v131
    v_exp_f32 v134, v62
    v_exp_f32 v135, v63
    v_mfma_f32_32x32x16_bf16 a[96:111], a[248:251], v[108:111], a[96:111]
    v_cvt_pk_bf16_f32 v126, v132, v133
    v_add_f32 v138, v138, v132
    v_add_f32 v139, v139, v133
    v_cvt_pk_bf16_f32 v127, v134, v135
    v_add_f32 v138, v138, v134
    v_add_f32 v139, v139, v135
    v_add_f32 v225, v138, v139
    v_cmp_lt_f32 vcc, s38, v225
    v_mfma_f32_32x32x16_bf16 a[112:127], a[252:255], v[108:111], a[112:127]
    s_cbranch_vccnz kf_rare40
kf_rr39:
    s_waitcnt lgkmcnt(0)
    v_add_f32 v227, v227, v225
    s_nop 0
    v_mfma_f32_32x32x16_bf16 a[64:79], a[192:195], v[120:123], a[64:79]
    v_mfma_f32_32x32x16_bf16 a[80:95], a[196:199], v[120:123], a[80:95]
    v_mfma_f32_32x32x16_bf16 a[96:111], a[200:203], v[120:123], a[96:111]
    v_mfma_f32_32x32x16_bf16 a[112:127], a[204:207], v[120:123], a[112:127]
    v_mfma_f32_32x32x16_bf16 a[64:79], a[208:211], v[124:127], a[64:79]
    v_mfma_f32_32x32x16_bf16 a[80:95], a[212:215], v[124:127], a[80:95]
    v_mfma_f32_32x32x16_bf16 a[96:111], a[216:219], v[124:127], a[96:111]
    v_mfma_f32_32x32x16_bf16 a[112:127], a[220:223], v[124:127], a[112:127]
    s_nop 7
    s_nop 7
    v_mov_b32 v230, v227
    s_nop 1
    v_permlane32_swap_b32 v227, v230
    s_nop 0
    v_add_f32 v230, v230, v227
    v_rcp_f32 v230, v230
    s_nop 0
    v_accvgpr_read_b32 v160, a64
    v_accvgpr_read_b32 v161, a65
    v_accvgpr_read_b32 v162, a66
    v_accvgpr_read_b32 v163, a67
    v_accvgpr_read_b32 v164, a68
    v_accvgpr_read_b32 v165, a69
    v_accvgpr_read_b32 v166, a70
    v_accvgpr_read_b32 v167, a71
    v_mul_f32 v160, v160, v230
    v_mul_f32 v161, v161, v230
    v_mul_f32 v162, v162, v230
    v_mul_f32 v163, v163, v230
    v_mul_f32 v164, v164, v230
    v_mul_f32 v165, v165, v230
    v_mul_f32 v166, v166, v230
    v_mul_f32 v167, v167, v230
    v_cvt_pk_bf16_f32 v176, v160, v161
    v_cvt_pk_bf16_f32 v177, v162, v163
    v_cvt_pk_bf16_f32 v178, v164, v165
    v_cvt_pk_bf16_f32 v179, v166, v167
    buffer_store_dwordx4 v[176:179], v244, s[20:23], s40 offen offset:0 sc1
    v_accvgpr_read_b32 v168, a72
    v_accvgpr_read_b32 v169, a73
    v_accvgpr_read_b32 v170, a74
    v_accvgpr_read_b32 v171, a75
    v_accvgpr_read_b32 v172, a76
    v_accvgpr_read_b32 v173, a77
    v_accvgpr_read_b32 v174, a78
    v_accvgpr_read_b32 v175, a79
    v_mul_f32 v168, v168, v230
    v_mul_f32 v169, v169, v230
    v_mul_f32 v170, v170, v230
    v_mul_f32 v171, v171, v230
    v_mul_f32 v172, v172, v230
    v_mul_f32 v173, v173, v230
    v_mul_f32 v174, v174, v230
    v_mul_f32 v175, v175, v230
    v_cvt_pk_bf16_f32 v180, v168, v169
    v_cvt_pk_bf16_f32 v181, v170, v171
    v_cvt_pk_bf16_f32 v182, v172, v173
    v_cvt_pk_bf16_f32 v183, v174, v175
    buffer_store_dwordx4 v[180:183], v244, s[20:23], s40 offen offset:512 sc1
    v_accvgpr_read_b32 v160, a80
    v_accvgpr_read_b32 v161, a81
    v_accvgpr_read_b32 v162, a82
    v_accvgpr_read_b32 v163, a83
    v_accvgpr_read_b32 v164, a84
    v_accvgpr_read_b32 v165, a85
    v_accvgpr_read_b32 v166, a86
    v_accvgpr_read_b32 v167, a87
    v_mul_f32 v160, v160, v230
    v_mul_f32 v161, v161, v230
    v_mul_f32 v162, v162, v230
    v_mul_f32 v163, v163, v230
    v_mul_f32 v164, v164, v230
    v_mul_f32 v165, v165, v230
    v_mul_f32 v166, v166, v230
    v_mul_f32 v167, v167, v230
    v_cvt_pk_bf16_f32 v184, v160, v161
    v_cvt_pk_bf16_f32 v185, v162, v163
    v_cvt_pk_bf16_f32 v186, v164, v165
    v_cvt_pk_bf16_f32 v187, v166, v167
    buffer_store_dwordx4 v[184:187], v244, s[20:23], s40 offen offset:1024 sc1
    v_accvgpr_read_b32 v168, a88
    v_accvgpr_read_b32 v169, a89
    v_accvgpr_read_b32 v170, a90
    v_accvgpr_read_b32 v171, a91
    v_accvgpr_read_b32 v172, a92
    v_accvgpr_read_b32 v173, a93
    v_accvgpr_read_b32 v174, a94
    v_accvgpr_read_b32 v175, a95
    v_mul_f32 v168, v168, v230
    v_mul_f32 v169, v169, v230
    v_mul_f32 v170, v170, v230
    v_mul_f32 v171, v171, v230
    v_mul_f32 v172, v172, v230
    v_mul_f32 v173, v173, v230
    v_mul_f32 v174, v174, v230
    v_mul_f32 v175, v175, v230
    v_cvt_pk_bf16_f32 v188, v168, v169
    v_cvt_pk_bf16_f32 v189, v170, v171
    v_cvt_pk_bf16_f32 v190, v172, v173
    v_cvt_pk_bf16_f32 v191, v174, v175
    buffer_store_dwordx4 v[188:191], v244, s[20:23], s40 offen offset:1536 sc1
    v_accvgpr_read_b32 v160, a96
    v_accvgpr_read_b32 v161, a97
    v_accvgpr_read_b32 v162, a98
    v_accvgpr_read_b32 v163, a99
    v_accvgpr_read_b32 v164, a100
    v_accvgpr_read_b32 v165, a101
    v_accvgpr_read_b32 v166, a102
    v_accvgpr_read_b32 v167, a103
    v_mul_f32 v160, v160, v230
    v_mul_f32 v161, v161, v230
    v_mul_f32 v162, v162, v230
    v_mul_f32 v163, v163, v230
    v_mul_f32 v164, v164, v230
    v_mul_f32 v165, v165, v230
    v_mul_f32 v166, v166, v230
    v_mul_f32 v167, v167, v230
    v_cvt_pk_bf16_f32 v176, v160, v161
    v_cvt_pk_bf16_f32 v177, v162, v163
    v_cvt_pk_bf16_f32 v178, v164, v165
    v_cvt_pk_bf16_f32 v179, v166, v167
    buffer_store_dwordx4 v[176:179], v244, s[20:23], s40 offen offset:2048 sc1
    v_accvgpr_read_b32 v168, a104
    v_accvgpr_read_b32 v169, a105
    v_accvgpr_read_b32 v170, a106
    v_accvgpr_read_b32 v171, a107
    v_accvgpr_read_b32 v172, a108
    v_accvgpr_read_b32 v173, a109
    v_accvgpr_read_b32 v174, a110
    v_accvgpr_read_b32 v175, a111
    v_mul_f32 v168, v168, v230
    v_mul_f32 v169, v169, v230
    v_mul_f32 v170, v170, v230
    v_mul_f32 v171, v171, v230
    v_mul_f32 v172, v172, v230
    v_mul_f32 v173, v173, v230
    v_mul_f32 v174, v174, v230
    v_mul_f32 v175, v175, v230
    v_cvt_pk_bf16_f32 v180, v168, v169
    v_cvt_pk_bf16_f32 v181, v170, v171
    v_cvt_pk_bf16_f32 v182, v172, v173
    v_cvt_pk_bf16_f32 v183, v174, v175
    buffer_store_dwordx4 v[180:183], v244, s[20:23], s40 offen offset:2560 sc1
    v_accvgpr_read_b32 v160, a112
    v_accvgpr_read_b32 v161, a113
    v_accvgpr_read_b32 v162, a114
    v_accvgpr_read_b32 v163, a115
    v_accvgpr_read_b32 v164, a116
    v_accvgpr_read_b32 v165, a117
    v_accvgpr_read_b32 v166, a118
    v_accvgpr_read_b32 v167, a119
    v_mul_f32 v160, v160, v230
    v_mul_f32 v161, v161, v230
    v_mul_f32 v162, v162, v230
    v_mul_f32 v163, v163, v230
    v_mul_f32 v164, v164, v230
    v_mul_f32 v165, v165, v230
    v_mul_f32 v166, v166, v230
    v_mul_f32 v167, v167, v230
    v_cvt_pk_bf16_f32 v184, v160, v161
    v_cvt_pk_bf16_f32 v185, v162, v163
    v_cvt_pk_bf16_f32 v186, v164, v165
    v_cvt_pk_bf16_f32 v187, v166, v167
    buffer_store_dwordx4 v[184:187], v244, s[20:23], s40 offen offset:3072 sc1
    v_accvgpr_read_b32 v168, a120
    v_accvgpr_read_b32 v169, a121
    v_accvgpr_read_b32 v170, a122
    v_accvgpr_read_b32 v171, a123
    v_accvgpr_read_b32 v172, a124
    v_accvgpr_read_b32 v173, a125
    v_accvgpr_read_b32 v174, a126
    v_accvgpr_read_b32 v175, a127
    v_mul_f32 v168, v168, v230
    v_mul_f32 v169, v169, v230
    v_mul_f32 v170, v170, v230
    v_mul_f32 v171, v171, v230
    v_mul_f32 v172, v172, v230
    v_mul_f32 v173, v173, v230
    v_mul_f32 v174, v174, v230
    v_mul_f32 v175, v175, v230
    v_cvt_pk_bf16_f32 v188, v168, v169
    v_cvt_pk_bf16_f32 v189, v170, v171
    v_cvt_pk_bf16_f32 v190, v172, v173
    v_cvt_pk_bf16_f32 v191, v174, v175
    buffer_store_dwordx4 v[188:191], v244, s[20:23], s40 offen offset:3584 sc1
    s_load_dwordx2 s[40:41], s[0:1], 0
    s_load_dwordx2 s[42:43], s[0:1], 40
    s_load_dwordx2 s[44:45], s[0:1], 56
    s_load_dwordx2 s[46:47], s[0:1], 104
    s_load_dwordx4 s[60:63], s[0:1], 80
    v_mbcnt_lo_u32_b32 v237, -1, 0
    v_mbcnt_hi_u32_b32 v237, -1, v237
    s_lshl_b32 s32, s3, 6
    v_add_u32 v230, s32, v237
    s_lshr_b32 s53, s2, 3
    s_lshr_b32 s6, s2, 2
    s_and_b32 s6, s6, 1
    s_and_b32 s4, s2, 2
    s_lshl_b32 s4, s4, 2
    s_and_b32 s33, s53, 7
    s_add_u32 s4, s4, s33
    s_and_b32 s5, s2, 1
    s_lshl_b32 s5, s5, 2
    s_lshr_b32 s33, s53, 3
    s_add_u32 s5, s5, s33
    v_lshlrev_b32 v228, 4, v237
    v_lshrrev_b32 v234, 4, v237
    v_and_b32 v235, 15, v237
    v_lshlrev_b32 v236, 1, v234
    v_xor_b32 v235, v235, v236
    v_lshlrev_b32 v234, 11, v234
    s_lshl_b32 s32, s3, 14
    s_lshl_b32 s33, s5, 8
    s_add_u32 s32, s32, s33
    v_add_u32 v234, s32, v234
    v_lshl_add_u32 v224, v235, 4, v234
    v_xor_b32 v235, 8, v235
    v_lshl_add_u32 v225, v235, 4, v234
    v_add_u32 v225, 7168, v225
    s_lshl_b32 s37, s6, 22
    s_lshl_b32 s38, s3, 11
    s_lshl_b32 s32, s3, 18
    v_add_u32 v226, s32, v228
    v_add_u32 v227, 0x20000, v226
    s_lshl_b32 s35, s4, 20
    s_lshl_b32 s32, s6, 16
    s_add_u32 s35, s35, s32
    s_add_u32 s35, s35, 0x2400000
    s_add_u32 s36, s35, 4096
    s_getpc_b64 s[56:57]
kc_pc0:
    s_mov_b32 s58, kc_end-kc_pc0
    s_mov_b32 s59, 0x00020000
    v_lshlrev_b32 v234, 7, v230
    buffer_load_dword v241, v234, s[56:59], 0 offen
    s_waitcnt lgkmcnt(0)
    s_mov_b32 s8, s46
    s_mov_b32 s9, s47
    s_mov_b32 s10, 0x10000000
    s_mov_b32 s11, 0x00020000
    s_mov_b32 s12, s42
    s_mov_b32 s13, s43
    s_mov_b32 s14, 0x800000
    s_mov_b32 s15, 0x00020000
    s_mov_b32 s16, s40
    s_mov_b32 s17, s41
    s_mov_b32 s18, 0x400000
    s_mov_b32 s19, 0x00020000
    s_mov_b32 s20, s44
    s_mov_b32 s21, s45
    s_mov_b32 s22, 0x800
    s_mov_b32 s23, 0x00020000
    s_mov_b32 s24, s60
    s_mov_b32 s25, s61
    s_mov_b32 s26, 0x700000
    s_mov_b32 s27, 0x00020000
    s_mov_b32 s28, s62
    s_mov_b32 s29, s63
    s_mov_b32 s30, 0x400000
    s_mov_b32 s31, 0x00020000
    v_bfe_u32 v234, v237, 2, 3
    v_lshrrev_b32 v235, 5, v237
    v_lshl_add_u32 v235, v235, 4, v234
    v_lshlrev_b32 v235, 8, v235
    v_and_b32 v236, 1, v237
    v_lshl_add_u32 v235, v236, 3, v235
    v_lshlrev_b32 v234, 1, v234
    v_bfe_u32 v236, v237, 1, 1
    v_or_b32 v234, v234, v236
    s_xor_b32 s32, s6, 1
    s_lshl_b32 s32, s32, 3
    v_xor_b32 v234, s32, v234
    v_xor_b32 v236, 0, v234
    v_lshl_add_u32 v216, v236, 4, v235
    v_xor_b32 v236, 2, v234
    v_lshl_add_u32 v217, v236, 4, v235
    v_xor_b32 v236, 4, v234
    v_lshl_add_u32 v218, v236, 4, v235
    v_xor_b32 v236, 6, v234
    v_lshl_add_u32 v219, v236, 4, v235
    v_xor_b32 v236, 8, v234
    v_lshl_add_u32 v220, v236, 4, v235
    v_xor_b32 v236, 10, v234
    v_lshl_add_u32 v221, v236, 4, v235
    v_xor_b32 v236, 12, v234
    v_lshl_add_u32 v222, v236, 4, v235
    v_xor_b32 v236, 14, v234
    v_lshl_add_u32 v223, v236, 4, v235
    s_lshl_b32 s32, s4, 7
    s_lshl_b32 s33, s3, 5
    s_add_u32 s32, s32, s33
    v_lshrrev_b32 v234, 3, v237
    v_add_u32 v242, s32, v234
    v_and_b32 v235, 7, v237
    s_lshl1_add_u32 s33, s5, s6
    s_lshl_b32 s33, s33, 7
    v_lshl_add_u32 v240, v235, 4, s33
    v_lshl_add_u32 v229, v242, 11, v240
    s_mul_i32 s32, s3, 4608
    s_add_u32 s32, s32, 131072
    v_mul_u32_u24 v234, 144, v234
    v_lshl_add_u32 v234, v235, 4, v234
    v_add_u32 v239, s32, v234
    v_and_b32 v234, 15, v237
    v_mul_u32_u24 v234, 144, v234
    v_lshrrev_b32 v236, 4, v237
    v_lshl_add_u32 v234, v236, 3, v234
    v_add_u32 v238, s32, v234
    v_and_b32 v234, 3, v237
    v_lshl_add_u32 v234, v234, 3, v242
    v_lshlrev_b32 v234, 2, v234
    v_lshrrev_b32 v235, 2, v235
    v_lshl_add_u32 v231, v235, 13, v234
    v_lshlrev_b32 v235, 30, v235
    v_add_u32 v235, 16384, v235
    v_add_u32 v232, v235, v234
    s_or_b32 s32, s4, s3
    s_cmp_eq_u32 s32, 0
    s_cselect_b32 s32, 4, 64
    v_cmp_eq_u32 vcc, s32, v237
    v_mov_b32 v235, 24576
    v_mov_b32 v233, 1
    v_cndmask_b32 v232, v232, v235, vcc
    v_and_b32 v234, 1, v237
    v_cmp_ne_u32 s[60:61], 0, v234
    v_and_b32 v234, 2, v237
    v_cmp_ne_u32 s[62:63], 0, v234
    v_and_b32 v234, 4, v237
    v_cmp_ne_u32 s[40:41], 0, v234
    v_cmp_eq_u32 vcc, 0, v237
    v_mov_b32 v235, 0x40000000
    s_nop 0
    v_cndmask_b32 v243, v235, v237, vcc
    s_lshl2_add_u32 s39, s2, s3
    s_xor_b32 s7, s39, 16
    s_mov_b32 s48, 0x3800000
    s_mov_b32 s49, 0x3802000
    s_mov_b32 s50, 0x3804000
    s_and_b32 s52, s2, 7
    s_mul_i32 s54, s52, 28
    s_add_u32 s54, s54, s53
    v_lshrrev_b32 v234, 3, v237
    v_lshlrev_b32 v234, 11, v234
    v_and_b32 v235, 7, v237
    v_lshl_add_u32 v244, v235, 4, v234
    s_lshl_b32 s55, s54, 16
    s_lshl_b32 s32, s3, 13
    s_add_u32 s55, s55, s32
    s_add_u32 s55, s55, 0x4000000
    s_lshl_b32 s51, s54, 15
    s_lshl_b32 s32, s3, 9
    s_add_u32 s51, s51, s32
    s_cmp_ge_u32 s53, 28
    s_cselect_b32 s55, 0x40000000, s55
    s_cselect_b32 s51, 0x40000000, s51
    s_waitcnt vmcnt(0)
    s_barrier
    s_cmp_lg_u32 s3, 0
    s_cbranch_scc1 kc_a0
    s_lshl_b32 s32, s52, 7
    s_add_u32 s32, s32, 0x3841000
    v_mov_b32 v235, 1
    buffer_atomic_add v235, v243, s[8:11], s32 offen sc0 sc1
    v_lshlrev_b32 v234, 7, v237
    v_cmp_gt_u32 vcc, 8, v237
    v_mov_b32 v236, 0x40000000
    s_mov_b32 s34, 0x3841400
    v_cndmask_b32 v234, v236, v234, vcc
    s_waitcnt vmcnt(0)
    v_readfirstlane_b32 s36, v235
    s_cmp_lg_u32 s36, 31
    s_cbranch_scc1 kc_a0
    buffer_atomic_add v233, v234, s[8:11], s34 offen sc1
kc_a0:
    s_add_u32 m0, s38, 0
    s_add_u32 s32, s37, 0
    buffer_load_dwordx4 v224, s[12:15], s32 offen lds
    buffer_load_dwordx4 v225, s[12:15], s32 offen offset:1024 lds
    s_add_u32 m0, s38, 8192
    s_add_u32 s32, s37, 65536
    buffer_load_dwordx4 v224, s[12:15], s32 offen lds
    buffer_load_dwordx4 v225, s[12:15], s32 offen offset:1024 lds
    s_add_u32 m0, s38, 16384
    s_add_u32 s32, s37, 131072
    buffer_load_dwordx4 v224, s[12:15], s32 offen lds
    buffer_load_dwordx4 v225, s[12:15], s32 offen offset:1024 lds
    s_add_u32 m0, s38, 24576
    s_add_u32 s32, s37, 196608
    buffer_load_dwordx4 v224, s[12:15], s32 offen lds
    buffer_load_dwordx4 v225, s[12:15], s32 offen offset:1024 lds
    s_add_u32 m0, s38, 32768
    s_add_u32 s32, s37, 262144
    buffer_load_dwordx4 v224, s[12:15], s32 offen lds
    buffer_load_dwordx4 v225, s[12:15], s32 offen offset:1024 lds
    s_add_u32 m0, s38, 40960
    s_add_u32 s32, s37, 327680
    buffer_load_dwordx4 v224, s[12:15], s32 offen lds
    buffer_load_dwordx4 v225, s[12:15], s32 offen offset:1024 lds
    s_add_u32 m0, s38, 49152
    s_add_u32 s32, s37, 393216
    buffer_load_dwordx4 v224, s[12:15], s32 offen lds
    buffer_load_dwordx4 v225, s[12:15], s32 offen offset:1024 lds
    s_add_u32 m0, s38, 57344
    s_add_u32 s32, s37, 458752
    buffer_load_dwordx4 v224, s[12:15], s32 offen lds
    buffer_load_dwordx4 v225, s[12:15], s32 offen offset:1024 lds
    s_add_u32 s37, s37, 524288
    s_xor_b32 s38, s38, 65536
    s_add_u32 m0, s38, 0
    s_add_u32 s32, s37, 0
    buffer_load_dwordx4 v224, s[12:15], s32 offen lds
    buffer_load_dwordx4 v225, s[12:15], s32 offen offset:1024 lds
    s_add_u32 m0, s38, 8192
    s_add_u32 s32, s37, 65536
    buffer_load_dwordx4 v224, s[12:15], s32 offen lds
    buffer_load_dwordx4 v225, s[12:15], s32 offen offset:1024 lds
    s_add_u32 m0, s38, 16384
    s_add_u32 s32, s37, 131072
    buffer_load_dwordx4 v224, s[12:15], s32 offen lds
    buffer_load_dwordx4 v225, s[12:15], s32 offen offset:1024 lds
    s_add_u32 m0, s38, 24576
    s_add_u32 s32, s37, 196608
    buffer_load_dwordx4 v224, s[12:15], s32 offen lds
    buffer_load_dwordx4 v225, s[12:15], s32 offen offset:1024 lds
    s_add_u32 s33, s51, 0
    buffer_load_dwordx4 a[128:131], v244, s[24:27], s33 offen offset:0
    s_add_u32 s33, s51, 16384
    buffer_load_dwordx4 a[132:135], v244, s[24:27], s33 offen offset:0
    s_add_u32 s33, s51, 0
    buffer_load_dwordx4 a[136:139], v244, s[24:27], s33 offen offset:128
    s_add_u32 s33, s51, 16384
    buffer_load_dwordx4 a[140:143], v244, s[24:27], s33 offen offset:128
    s_add_u32 s33, s51, 0
    buffer_load_dwordx4 a[144:147], v244, s[24:27], s33 offen offset:256
    s_add_u32 s33, s51, 16384
    buffer_load_dwordx4 a[148:151], v244, s[24:27], s33 offen offset:256
    s_add_u32 s33, s51, 0
    buffer_load_dwordx4 a[152:155], v244, s[24:27], s33 offen offset:384
    s_add_u32 s33, s51, 16384
    buffer_load_dwordx4 a[156:159], v244, s[24:27], s33 offen offset:384
    s_cmp_lg_u32 s3, 0
    s_cbranch_scc1 kc_b02
    s_lshl_b32 s32, s52, 7
    s_add_u32 s32, s32, 0x3841400
    s_mov_b32 s34, 0x400000
    s_branch kc_b01
kc_b00:
    s_sleep 2
kc_b01:
    buffer_load_dword v235, off, s[8:11], s32 sc1
    s_waitcnt vmcnt(0)
    v_cmp_ne_u32 vcc, 8, v235
    s_sub_u32 s34, s34, 1
    s_cbranch_scc1 kc_b02
    s_cbranch_vccnz kc_b00
kc_b02:
    s_barrier
    s_add_u32 s36, s35, 4096
    buffer_load_dwordx4 v[64:67], v226, s[8:11], s35 offen offset:0 sc1
    buffer_load_dwordx4 v[68:71], v227, s[8:11], s35 offen offset:0 sc1
    buffer_load_dwordx4 v[72:75], v226, s[8:11], s35 offen offset:1024 sc1
    buffer_load_dwordx4 v[76:79], v227, s[8:11], s35 offen offset:1024 sc1
    buffer_load_dwordx4 v[80:83], v226, s[8:11], s35 offen offset:2048 sc1
    buffer_load_dwordx4 v[84:87], v227, s[8:11], s35 offen offset:2048 sc1
    buffer_load_dwordx4 v[88:91], v226, s[8:11], s35 offen offset:3072 sc1
    buffer_load_dwordx4 v[92:95], v227, s[8:11], s35 offen offset:3072 sc1
    buffer_load_dwordx4 v[96:99], v226, s[8:11], s36 offen offset:0 sc1
    buffer_load_dwordx4 v[100:103], v227, s[8:11], s36 offen offset:0 sc1
    buffer_load_dwordx4 v[104:107], v226, s[8:11], s36 offen offset:1024 sc1
    buffer_load_dwordx4 v[108:111], v227, s[8:11], s36 offen offset:1024 sc1
    buffer_load_dwordx4 v[112:115], v226, s[8:11], s36 offen offset:2048 sc1
    buffer_load_dwordx4 v[116:119], v227, s[8:11], s36 offen offset:2048 sc1
    buffer_load_dwordx4 v[120:123], v226, s[8:11], s36 offen offset:3072 sc1
    buffer_load_dwordx4 v[124:127], v227, s[8:11], s36 offen offset:3072 sc1
    s_add_u32 s35, s35, 8192
    s_add_u32 s36, s36, 8192
    s_waitcnt vmcnt(41)
    s_barrier
    ds_read_b64_tr_b16 v[128:129], v216 offset:0
    ds_read_b64_tr_b16 v[130:131], v216 offset:2048
    ds_read_b64_tr_b16 v[132:133], v217 offset:0
    ds_read_b64_tr_b16 v[134:135], v217 offset:2048
    ds_read_b64_tr_b16 v[136:137], v218 offset:0
    ds_read_b64_tr_b16 v[138:139], v218 offset:2048
    ds_read_b64_tr_b16 v[140:141], v219 offset:0
    ds_read_b64_tr_b16 v[142:143], v219 offset:2048
    ds_read_b64_tr_b16 v[144:145], v220 offset:0
    ds_read_b64_tr_b16 v[146:147], v220 offset:2048
    ds_read_b64_tr_b16 v[148:149], v221 offset:0
    ds_read_b64_tr_b16 v[150:151], v221 offset:2048
    ds_read_b64_tr_b16 v[152:153], v222 offset:0
    ds_read_b64_tr_b16 v[154:155], v222 offset:2048
    s_waitcnt lgkmcnt(8)
    ds_read_b64_tr_b16 v[156:157], v223 offset:0
    ds_read_b64_tr_b16 v[158:159], v223 offset:2048
    s_mov_b32 s34, 4
    s_waitcnt vmcnt(14) lgkmcnt(12)
    v_mfma_f32_16x16x32_bf16 v[0:3], v[128:131], v[64:67], 0
    ds_read_b64_tr_b16 v[160:161], v216 offset:8192
    v_mfma_f32_16x16x32_bf16 v[4:7], v[128:131], v[68:71], 0
    ds_read_b64_tr_b16 v[162:163], v216 offset:10240
    v_mfma_f32_16x16x32_bf16 v[8:11], v[132:135], v[64:67], 0
    ds_read_b64_tr_b16 v[164:165], v217 offset:8192
    v_mfma_f32_16x16x32_bf16 v[12:15], v[132:135], v[68:71], 0
    ds_read_b64_tr_b16 v[166:167], v217 offset:10240
    s_waitcnt lgkmcnt(12)
    v_mfma_f32_16x16x32_bf16 v[16:19], v[136:139], v[64:67], 0
    ds_read_b64_tr_b16 v[168:169], v218 offset:8192
    v_mfma_f32_16x16x32_bf16 v[20:23], v[136:139], v[68:71], 0
    ds_read_b64_tr_b16 v[170:171], v218 offset:10240
    v_mfma_f32_16x16x32_bf16 v[24:27], v[140:143], v[64:67], 0
    ds_read_b64_tr_b16 v[172:173], v219 offset:8192
    v_mfma_f32_16x16x32_bf16 v[28:31], v[140:143], v[68:71], 0
    ds_read_b64_tr_b16 v[174:175], v219 offset:10240
    s_add_u32 s33, s55, 0
    buffer_load_dwordx4 a[64:67], v228, s[8:11], s33 offen offset:0 sc1
    s_waitcnt lgkmcnt(12)
    v_mfma_f32_16x16x32_bf16 v[32:35], v[144:147], v[64:67], 0
    ds_read_b64_tr_b16 v[176:177], v220 offset:8192
    s_add_u32 m0, s38, 32768
    v_mfma_f32_16x16x32_bf16 v[36:39], v[144:147], v[68:71], 0
    ds_read_b64_tr_b16 v[178:179], v220 offset:10240
    s_add_u32 s32, s37, 262144
    v_mfma_f32_16x16x32_bf16 v[40:43], v[148:151], v[64:67], 0
    ds_read_b64_tr_b16 v[180:181], v221 offset:8192
    buffer_load_dwordx4 v224, s[12:15], s32 offen lds
    v_mfma_f32_16x16x32_bf16 v[44:47], v[148:151], v[68:71], 0
    ds_read_b64_tr_b16 v[182:183], v221 offset:10240
    s_waitcnt lgkmcnt(12)
    v_mfma_f32_16x16x32_bf16 v[48:51], v[152:155], v[64:67], 0
    ds_read_b64_tr_b16 v[184:185], v222 offset:8192
    buffer_load_dwordx4 a[68:71], v228, s[8:11], s33 offen offset:1024 sc1
    v_mfma_f32_16x16x32_bf16 v[52:55], v[152:155], v[68:71], 0
    ds_read_b64_tr_b16 v[186:187], v222 offset:10240
    buffer_load_dwordx4 v225, s[12:15], s32 offen offset:1024 lds
    v_mfma_f32_16x16x32_bf16 v[56:59], v[156:159], v[64:67], 0
    ds_read_b64_tr_b16 v[188:189], v223 offset:8192
    v_mfma_f32_16x16x32_bf16 v[60:63], v[156:159], v[68:71], 0
    ds_read_b64_tr_b16 v[190:191], v223 offset:10240
    s_waitcnt vmcnt(16) lgkmcnt(12)
    v_mfma_f32_16x16x32_bf16 v[0:3], v[160:163], v[72:75], v[0:3]
    ds_read_b64_tr_b16 v[128:129], v216 offset:16384
    v_mfma_f32_16x16x32_bf16 v[4:7], v[160:163], v[76:79], v[4:7]
    ds_read_b64_tr_b16 v[130:131], v216 offset:18432
    v_mfma_f32_16x16x32_bf16 v[8:11], v[164:167], v[72:75], v[8:11]
    ds_read_b64_tr_b16 v[132:133], v217 offset:16384
    buffer_load_dwordx4 v[64:67], v226, s[8:11], s35 offen offset:0 sc1
    v_mfma_f32_16x16x32_bf16 v[12:15], v[164:167], v[76:79], v[12:15]
    ds_read_b64_tr_b16 v[134:135], v217 offset:18432
    s_waitcnt lgkmcnt(12)
    v_mfma_f32_16x16x32_bf16 v[16:19], v[168:171], v[72:75], v[16:19]
    ds_read_b64_tr_b16 v[136:137], v218 offset:16384
    v_mfma_f32_16x16x32_bf16 v[20:23], v[168:171], v[76:79], v[20:23]
    ds_read_b64_tr_b16 v[138:139], v218 offset:18432
    buffer_load_dwordx4 v[68:71], v227, s[8:11], s35 offen offset:0 sc1
    v_mfma_f32_16x16x32_bf16 v[24:27], v[172:175], v[72:75], v[24:27]
    ds_read_b64_tr_b16 v[140:141], v219 offset:16384
    v_mfma_f32_16x16x32_bf16 v[28:31], v[172:175], v[76:79], v[28:31]
    ds_read_b64_tr_b16 v[142:143], v219 offset:18432
    buffer_load_dwordx4 a[72:75], v228, s[8:11], s33 offen offset:2048 sc1
    s_waitcnt lgkmcnt(12)
    v_mfma_f32_16x16x32_bf16 v[32:35], v[176:179], v[72:75], v[32:35]
    ds_read_b64_tr_b16 v[144:145], v220 offset:16384
    s_add_u32 m0, s38, 40960
    v_mfma_f32_16x16x32_bf16 v[36:39], v[176:179], v[76:79], v[36:39]
    ds_read_b64_tr_b16 v[146:147], v220 offset:18432
    s_add_u32 s32, s37, 327680
    v_mfma_f32_16x16x32_bf16 v[40:43], v[180:183], v[72:75], v[40:43]
    ds_read_b64_tr_b16 v[148:149], v221 offset:16384
    buffer_load_dwordx4 v224, s[12:15], s32 offen lds
    v_mfma_f32_16x16x32_bf16 v[44:47], v[180:183], v[76:79], v[44:47]
    ds_read_b64_tr_b16 v[150:151], v221 offset:18432
    s_waitcnt lgkmcnt(12)
    v_mfma_f32_16x16x32_bf16 v[48:51], v[184:187], v[72:75], v[48:51]
    ds_read_b64_tr_b16 v[152:153], v222 offset:16384
    buffer_load_dwordx4 a[76:79], v228, s[8:11], s33 offen offset:3072 sc1
    v_mfma_f32_16x16x32_bf16 v[52:55], v[184:187], v[76:79], v[52:55]
    ds_read_b64_tr_b16 v[154:155], v222 offset:18432
    buffer_load_dwordx4 v225, s[12:15], s32 offen offset:1024 lds
    v_mfma_f32_16x16x32_bf16 v[56:59], v[188:191], v[72:75], v[56:59]
    ds_read_b64_tr_b16 v[156:157], v223 offset:16384
    v_mfma_f32_16x16x32_bf16 v[60:63], v[188:191], v[76:79], v[60:63]
    ds_read_b64_tr_b16 v[158:159], v223 offset:18432
    s_waitcnt vmcnt(20) lgkmcnt(12)
    v_mfma_f32_16x16x32_bf16 v[0:3], v[128:131], v[80:83], v[0:3]
    ds_read_b64_tr_b16 v[160:161], v216 offset:24576
    v_mfma_f32_16x16x32_bf16 v[4:7], v[128:131], v[84:87], v[4:7]
    ds_read_b64_tr_b16 v[162:163], v216 offset:26624
    v_mfma_f32_16x16x32_bf16 v[8:11], v[132:135], v[80:83], v[8:11]
    ds_read_b64_tr_b16 v[164:165], v217 offset:24576
    buffer_load_dwordx4 v[72:75], v226, s[8:11], s35 offen offset:1024 sc1
    v_mfma_f32_16x16x32_bf16 v[12:15], v[132:135], v[84:87], v[12:15]
    ds_read_b64_tr_b16 v[166:167], v217 offset:26624
    s_waitcnt lgkmcnt(12)
    v_mfma_f32_16x16x32_bf16 v[16:19], v[136:139], v[80:83], v[16:19]
    ds_read_b64_tr_b16 v[168:169], v218 offset:24576
    v_mfma_f32_16x16x32_bf16 v[20:23], v[136:139], v[84:87], v[20:23]
    ds_read_b64_tr_b16 v[170:171], v218 offset:26624
    buffer_load_dwordx4 v[76:79], v227, s[8:11], s35 offen offset:1024 sc1
    v_mfma_f32_16x16x32_bf16 v[24:27], v[140:143], v[80:83], v[24:27]
    ds_read_b64_tr_b16 v[172:173], v219 offset:24576
    v_mfma_f32_16x16x32_bf16 v[28:31], v[140:143], v[84:87], v[28:31]
    ds_read_b64_tr_b16 v[174:175], v219 offset:26624
    s_add_u32 s33, s55, 4096
    buffer_load_dwordx4 a[80:83], v228, s[8:11], s33 offen offset:0 sc1
    s_waitcnt lgkmcnt(12)
    v_mfma_f32_16x16x32_bf16 v[32:35], v[144:147], v[80:83], v[32:35]
    ds_read_b64_tr_b16 v[176:177], v220 offset:24576
    s_add_u32 m0, s38, 49152
    v_mfma_f32_16x16x32_bf16 v[36:39], v[144:147], v[84:87], v[36:39]
    ds_read_b64_tr_b16 v[178:179], v220 offset:26624
    s_add_u32 s32, s37, 393216
    v_mfma_f32_16x16x32_bf16 v[40:43], v[148:151], v[80:83], v[40:43]
    ds_read_b64_tr_b16 v[180:181], v221 offset:24576
    buffer_load_dwordx4 v224, s[12:15], s32 offen lds
    v_mfma_f32_16x16x32_bf16 v[44:47], v[148:151], v[84:87], v[44:47]
    ds_read_b64_tr_b16 v[182:183], v221 offset:26624
    s_waitcnt lgkmcnt(12)
    v_mfma_f32_16x16x32_bf16 v[48:51], v[152:155], v[80:83], v[48:51]
    ds_read_b64_tr_b16 v[184:185], v222 offset:24576
    buffer_load_dwordx4 a[84:87], v228, s[8:11], s33 offen offset:1024 sc1
    v_mfma_f32_16x16x32_bf16 v[52:55], v[152:155], v[84:87], v[52:55]
    ds_read_b64_tr_b16 v[186:187], v222 offset:26624
    buffer_load_dwordx4 v225, s[12:15], s32 offen offset:1024 lds
    v_mfma_f32_16x16x32_bf16 v[56:59], v[156:159], v[80:83], v[56:59]
    ds_read_b64_tr_b16 v[188:189], v223 offset:24576
    v_mfma_f32_16x16x32_bf16 v[60:63], v[156:159], v[84:87], v[60:63]
    ds_read_b64_tr_b16 v[190:191], v223 offset:26624
    s_waitcnt vmcnt(24) lgkmcnt(12)
    v_mfma_f32_16x16x32_bf16 v[0:3], v[160:163], v[88:91], v[0:3]
    s_add_u32 m0, s38, 57344
    v_mfma_f32_16x16x32_bf16 v[4:7], v[160:163], v[92:95], v[4:7]
    s_add_u32 s32, s37, 458752
    v_mfma_f32_16x16x32_bf16 v[8:11], v[164:167], v[88:91], v[8:11]
    buffer_load_dwordx4 v224, s[12:15], s32 offen lds
    buffer_load_dwordx4 v[80:83], v226, s[8:11], s35 offen offset:2048 sc1
    v_mfma_f32_16x16x32_bf16 v[12:15], v[164:167], v[92:95], v[12:15]
    buffer_load_dwordx4 v225, s[12:15], s32 offen offset:1024 lds
    s_add_u32 s37, s37, 524288
    s_xor_b32 s38, s38, 65536
    s_waitcnt lgkmcnt(8)
    v_mfma_f32_16x16x32_bf16 v[16:19], v[168:171], v[88:91], v[16:19]
    buffer_load_dwordx4 v[84:87], v227, s[8:11], s35 offen offset:2048 sc1
    v_mfma_f32_16x16x32_bf16 v[20:23], v[168:171], v[92:95], v[20:23]
    v_mfma_f32_16x16x32_bf16 v[24:27], v[172:175], v[88:91], v[24:27]
    s_waitcnt vmcnt(53) lgkmcnt(0)
    s_barrier
    ds_read_b64_tr_b16 v[128:129], v216 offset:32768
    ds_read_b64_tr_b16 v[130:131], v216 offset:34816
    v_mfma_f32_16x16x32_bf16 v[28:31], v[172:175], v[92:95], v[28:31]
    ds_read_b64_tr_b16 v[132:133], v217 offset:32768
    ds_read_b64_tr_b16 v[134:135], v217 offset:34816
    buffer_load_dwordx4 a[88:91], v228, s[8:11], s33 offen offset:2048 sc1
    v_mfma_f32_16x16x32_bf16 v[32:35], v[176:179], v[88:91], v[32:35]
    ds_read_b64_tr_b16 v[136:137], v218 offset:32768
    v_mfma_f32_16x16x32_bf16 v[36:39], v[176:179], v[92:95], v[36:39]
    ds_read_b64_tr_b16 v[138:139], v218 offset:34816
    ds_read_b64_tr_b16 v[140:141], v219 offset:32768
    v_mfma_f32_16x16x32_bf16 v[40:43], v[180:183], v[88:91], v[40:43]
    ds_read_b64_tr_b16 v[142:143], v219 offset:34816
    v_mfma_f32_16x16x32_bf16 v[44:47], v[180:183], v[92:95], v[44:47]
    ds_read_b64_tr_b16 v[144:145], v220 offset:32768
    ds_read_b64_tr_b16 v[146:147], v220 offset:34816
    v_mfma_f32_16x16x32_bf16 v[48:51], v[184:187], v[88:91], v[48:51]
    ds_read_b64_tr_b16 v[148:149], v221 offset:32768
    ds_read_b64_tr_b16 v[150:151], v221 offset:34816
    buffer_load_dwordx4 a[92:95], v228, s[8:11], s33 offen offset:3072 sc1
    v_mfma_f32_16x16x32_bf16 v[52:55], v[184:187], v[92:95], v[52:55]
    ds_read_b64_tr_b16 v[152:153], v222 offset:32768
    v_mfma_f32_16x16x32_bf16 v[56:59], v[188:191], v[88:91], v[56:59]
    ds_read_b64_tr_b16 v[154:155], v222 offset:34816
    ds_read_b64_tr_b16 v[156:157], v223 offset:32768
    v_mfma_f32_16x16x32_bf16 v[60:63], v[188:191], v[92:95], v[60:63]
    ds_read_b64_tr_b16 v[158:159], v223 offset:34816
    s_waitcnt vmcnt(28) lgkmcnt(12)
    v_mfma_f32_16x16x32_bf16 v[0:3], v[128:131], v[96:99], v[0:3]
    ds_read_b64_tr_b16 v[160:161], v216 offset:40960
    v_mfma_f32_16x16x32_bf16 v[4:7], v[128:131], v[100:103], v[4:7]
    ds_read_b64_tr_b16 v[162:163], v216 offset:43008
    v_mfma_f32_16x16x32_bf16 v[8:11], v[132:135], v[96:99], v[8:11]
    ds_read_b64_tr_b16 v[164:165], v217 offset:40960
    buffer_load_dwordx4 v[88:91], v226, s[8:11], s35 offen offset:3072 sc1
    v_mfma_f32_16x16x32_bf16 v[12:15], v[132:135], v[100:103], v[12:15]
    ds_read_b64_tr_b16 v[166:167], v217 offset:43008
    s_waitcnt lgkmcnt(12)
    v_mfma_f32_16x16x32_bf16 v[16:19], v[136:139], v[96:99], v[16:19]
    ds_read_b64_tr_b16 v[168:169], v218 offset:40960
    v_mfma_f32_16x16x32_bf16 v[20:23], v[136:139], v[100:103], v[20:23]
    ds_read_b64_tr_b16 v[170:171], v218 offset:43008
    buffer_load_dwordx4 v[92:95], v227, s[8:11], s35 offen offset:3072 sc1
    v_mfma_f32_16x16x32_bf16 v[24:27], v[140:143], v[96:99], v[24:27]
    ds_read_b64_tr_b16 v[172:173], v219 offset:40960
    v_mfma_f32_16x16x32_bf16 v[28:31], v[140:143], v[100:103], v[28:31]
    ds_read_b64_tr_b16 v[174:175], v219 offset:43008
    s_add_u32 s33, s55, 32768
    buffer_load_dwordx4 a[96:99], v228, s[8:11], s33 offen offset:0 sc1
    s_waitcnt lgkmcnt(12)
    v_mfma_f32_16x16x32_bf16 v[32:35], v[144:147], v[96:99], v[32:35]
    ds_read_b64_tr_b16 v[176:177], v220 offset:40960
    s_add_u32 m0, s38, 0
    v_mfma_f32_16x16x32_bf16 v[36:39], v[144:147], v[100:103], v[36:39]
    ds_read_b64_tr_b16 v[178:179], v220 offset:43008
    s_add_u32 s32, s37, 0
    v_mfma_f32_16x16x32_bf16 v[40:43], v[148:151], v[96:99], v[40:43]
    ds_read_b64_tr_b16 v[180:181], v221 offset:40960
    buffer_load_dwordx4 v224, s[12:15], s32 offen lds
    v_mfma_f32_16x16x32_bf16 v[44:47], v[148:151], v[100:103], v[44:47]
    ds_read_b64_tr_b16 v[182:183], v221 offset:43008
    s_waitcnt lgkmcnt(12)
    v_mfma_f32_16x16x32_bf16 v[48:51], v[152:155], v[96:99], v[48:51]
    ds_read_b64_tr_b16 v[184:185], v222 offset:40960
    buffer_load_dwordx4 a[100:103], v228, s[8:11], s33 offen offset:1024 sc1
    v_mfma_f32_16x16x32_bf16 v[52:55], v[152:155], v[100:103], v[52:55]
    ds_read_b64_tr_b16 v[186:187], v222 offset:43008
    buffer_load_dwordx4 v225, s[12:15], s32 offen offset:1024 lds
    v_mfma_f32_16x16x32_bf16 v[56:59], v[156:159], v[96:99], v[56:59]
    ds_read_b64_tr_b16 v[188:189], v223 offset:40960
    v_mfma_f32_16x16x32_bf16 v[60:63], v[156:159], v[100:103], v[60:63]
    ds_read_b64_tr_b16 v[190:191], v223 offset:43008
    s_waitcnt vmcnt(32) lgkmcnt(12)
    v_mfma_f32_16x16x32_bf16 v[0:3], v[160:163], v[104:107], v[0:3]
    ds_read_b64_tr_b16 v[128:129], v216 offset:49152
    v_mfma_f32_16x16x32_bf16 v[4:7], v[160:163], v[108:111], v[4:7]
    ds_read_b64_tr_b16 v[130:131], v216 offset:51200
    v_mfma_f32_16x16x32_bf16 v[8:11], v[164:167], v[104:107], v[8:11]
    ds_read_b64_tr_b16 v[132:133], v217 offset:49152
    buffer_load_dwordx4 v[96:99], v226, s[8:11], s36 offen offset:0 sc1
    v_mfma_f32_16x16x32_bf16 v[12:15], v[164:167], v[108:111], v[12:15]
    ds_read_b64_tr_b16 v[134:135], v217 offset:51200
    s_waitcnt lgkmcnt(12)
    v_mfma_f32_16x16x32_bf16 v[16:19], v[168:171], v[104:107], v[16:19]
    ds_read_b64_tr_b16 v[136:137], v218 offset:49152
    v_mfma_f32_16x16x32_bf16 v[20:23], v[168:171], v[108:111], v[20:23]
    ds_read_b64_tr_b16 v[138:139], v218 offset:51200
    buffer_load_dwordx4 v[100:103], v227, s[8:11], s36 offen offset:0 sc1
    v_mfma_f32_16x16x32_bf16 v[24:27], v[172:175], v[104:107], v[24:27]
    ds_read_b64_tr_b16 v[140:141], v219 offset:49152
    v_mfma_f32_16x16x32_bf16 v[28:31], v[172:175], v[108:111], v[28:31]
    ds_read_b64_tr_b16 v[142:143], v219 offset:51200
    buffer_load_dwordx4 a[104:107], v228, s[8:11], s33 offen offset:2048 sc1
    s_waitcnt lgkmcnt(12)
    v_mfma_f32_16x16x32_bf16 v[32:35], v[176:179], v[104:107], v[32:35]
    ds_read_b64_tr_b16 v[144:145], v220 offset:49152
    s_add_u32 m0, s38, 8192
    v_mfma_f32_16x16x32_bf16 v[36:39], v[176:179], v[108:111], v[36:39]
    ds_read_b64_tr_b16 v[146:147], v220 offset:51200
    s_add_u32 s32, s37, 65536
    v_mfma_f32_16x16x32_bf16 v[40:43], v[180:183], v[104:107], v[40:43]
    ds_read_b64_tr_b16 v[148:149], v221 offset:49152
    buffer_load_dwordx4 v224, s[12:15], s32 offen lds
    s_add_u32 s35, s35, 8192
    v_mfma_f32_16x16x32_bf16 v[44:47], v[180:183], v[108:111], v[44:47]
    ds_read_b64_tr_b16 v[150:151], v221 offset:51200
    s_waitcnt lgkmcnt(12)
    v_mfma_f32_16x16x32_bf16 v[48:51], v[184:187], v[104:107], v[48:51]
    ds_read_b64_tr_b16 v[152:153], v222 offset:49152
    buffer_load_dwordx4 a[108:111], v228, s[8:11], s33 offen offset:3072 sc1
    v_mfma_f32_16x16x32_bf16 v[52:55], v[184:187], v[108:111], v[52:55]
    ds_read_b64_tr_b16 v[154:155], v222 offset:51200
    buffer_load_dwordx4 v225, s[12:15], s32 offen offset:1024 lds
    v_mfma_f32_16x16x32_bf16 v[56:59], v[188:191], v[104:107], v[56:59]
    ds_read_b64_tr_b16 v[156:157], v223 offset:49152
    v_mfma_f32_16x16x32_bf16 v[60:63], v[188:191], v[108:111], v[60:63]
    ds_read_b64_tr_b16 v[158:159], v223 offset:51200
    s_waitcnt vmcnt(36) lgkmcnt(12)
    v_mfma_f32_16x16x32_bf16 v[0:3], v[128:131], v[112:115], v[0:3]
    ds_read_b64_tr_b16 v[160:161], v216 offset:57344
    v_mfma_f32_16x16x32_bf16 v[4:7], v[128:131], v[116:119], v[4:7]
    ds_read_b64_tr_b16 v[162:163], v216 offset:59392
    v_mfma_f32_16x16x32_bf16 v[8:11], v[132:135], v[112:115], v[8:11]
    ds_read_b64_tr_b16 v[164:165], v217 offset:57344
    buffer_load_dwordx4 v[104:107], v226, s[8:11], s36 offen offset:1024 sc1
    v_mfma_f32_16x16x32_bf16 v[12:15], v[132:135], v[116:119], v[12:15]
    ds_read_b64_tr_b16 v[166:167], v217 offset:59392
    s_waitcnt lgkmcnt(12)
    v_mfma_f32_16x16x32_bf16 v[16:19], v[136:139], v[112:115], v[16:19]
    ds_read_b64_tr_b16 v[168:169], v218 offset:57344
    v_mfma_f32_16x16x32_bf16 v[20:23], v[136:139], v[116:119], v[20:23]
    ds_read_b64_tr_b16 v[170:171], v218 offset:59392
    buffer_load_dwordx4 v[108:111], v227, s[8:11], s36 offen offset:1024 sc1
    v_mfma_f32_16x16x32_bf16 v[24:27], v[140:143], v[112:115], v[24:27]
    ds_read_b64_tr_b16 v[172:173], v219 offset:57344
    v_mfma_f32_16x16x32_bf16 v[28:31], v[140:143], v[116:119], v[28:31]
    ds_read_b64_tr_b16 v[174:175], v219 offset:59392
    s_add_u32 s33, s55, 36864
    buffer_load_dwordx4 a[112:115], v228, s[8:11], s33 offen offset:0 sc1
    s_waitcnt lgkmcnt(12)
    v_mfma_f32_16x16x32_bf16 v[32:35], v[144:147], v[112:115], v[32:35]
    ds_read_b64_tr_b16 v[176:177], v220 offset:57344
    s_add_u32 m0, s38, 16384
    v_mfma_f32_16x16x32_bf16 v[36:39], v[144:147], v[116:119], v[36:39]
    ds_read_b64_tr_b16 v[178:179], v220 offset:59392
    s_add_u32 s32, s37, 131072
    v_mfma_f32_16x16x32_bf16 v[40:43], v[148:151], v[112:115], v[40:43]
    ds_read_b64_tr_b16 v[180:181], v221 offset:57344
    buffer_load_dwordx4 v224, s[12:15], s32 offen lds
    v_mfma_f32_16x16x32_bf16 v[44:47], v[148:151], v[116:119], v[44:47]
    ds_read_b64_tr_b16 v[182:183], v221 offset:59392
    s_waitcnt lgkmcnt(12)
    v_mfma_f32_16x16x32_bf16 v[48:51], v[152:155], v[112:115], v[48:51]
    ds_read_b64_tr_b16 v[184:185], v222 offset:57344
    buffer_load_dwordx4 a[116:119], v228, s[8:11], s33 offen offset:1024 sc1
    v_mfma_f32_16x16x32_bf16 v[52:55], v[152:155], v[116:119], v[52:55]
    ds_read_b64_tr_b16 v[186:187], v222 offset:59392
    buffer_load_dwordx4 v225, s[12:15], s32 offen offset:1024 lds
    v_mfma_f32_16x16x32_bf16 v[56:59], v[156:159], v[112:115], v[56:59]
    ds_read_b64_tr_b16 v[188:189], v223 offset:57344
    v_mfma_f32_16x16x32_bf16 v[60:63], v[156:159], v[116:119], v[60:63]
    ds_read_b64_tr_b16 v[190:191], v223 offset:59392
    s_waitcnt vmcnt(40) lgkmcnt(12)
    v_mfma_f32_16x16x32_bf16 v[0:3], v[160:163], v[120:123], v[0:3]
    v_xor_b32 v216, 0x10000, v216
    v_xor_b32 v217, 0x10000, v217
    s_add_u32 m0, s38, 24576
    v_mfma_f32_16x16x32_bf16 v[4:7], v[160:163], v[124:127], v[4:7]
    v_xor_b32 v218, 0x10000, v218
    s_add_u32 s32, s37, 196608
    v_mfma_f32_16x16x32_bf16 v[8:11], v[164:167], v[120:123], v[8:11]
    v_xor_b32 v219, 0x10000, v219
    buffer_load_dwordx4 v224, s[12:15], s32 offen lds
    buffer_load_dwordx4 v[112:115], v226, s[8:11], s36 offen offset:2048 sc1
    v_mfma_f32_16x16x32_bf16 v[12:15], v[164:167], v[124:127], v[12:15]
    v_xor_b32 v220, 0x10000, v220
    v_xor_b32 v221, 0x10000, v221
    buffer_load_dwordx4 v225, s[12:15], s32 offen offset:1024 lds
    s_waitcnt lgkmcnt(8)
    v_mfma_f32_16x16x32_bf16 v[16:19], v[168:171], v[120:123], v[16:19]
    v_xor_b32 v222, 0x10000, v222
    buffer_load_dwordx4 v[116:119], v227, s[8:11], s36 offen offset:2048 sc1
    v_mfma_f32_16x16x32_bf16 v[20:23], v[168:171], v[124:127], v[20:23]
    v_xor_b32 v223, 0x10000, v223
    v_mfma_f32_16x16x32_bf16 v[24:27], v[172:175], v[120:123], v[24:27]
    s_waitcnt vmcnt(63) lgkmcnt(0)
    s_barrier
    ds_read_b64_tr_b16 v[128:129], v216 offset:0
    ds_read_b64_tr_b16 v[130:131], v216 offset:2048
    v_mfma_f32_16x16x32_bf16 v[28:31], v[172:175], v[124:127], v[28:31]
    ds_read_b64_tr_b16 v[132:133], v217 offset:0
    ds_read_b64_tr_b16 v[134:135], v217 offset:2048
    buffer_load_dwordx4 a[120:123], v228, s[8:11], s33 offen offset:2048 sc1
    v_mfma_f32_16x16x32_bf16 v[32:35], v[176:179], v[120:123], v[32:35]
    ds_read_b64_tr_b16 v[136:137], v218 offset:0
    v_mfma_f32_16x16x32_bf16 v[36:39], v[176:179], v[124:127], v[36:39]
    ds_read_b64_tr_b16 v[138:139], v218 offset:2048
    ds_read_b64_tr_b16 v[140:141], v219 offset:0
    v_mfma_f32_16x16x32_bf16 v[40:43], v[180:183], v[120:123], v[40:43]
    ds_read_b64_tr_b16 v[142:143], v219 offset:2048
    v_mfma_f32_16x16x32_bf16 v[44:47], v[180:183], v[124:127], v[44:47]
    ds_read_b64_tr_b16 v[144:145], v220 offset:0
    ds_read_b64_tr_b16 v[146:147], v220 offset:2048
    v_mfma_f32_16x16x32_bf16 v[48:51], v[184:187], v[120:123], v[48:51]
    ds_read_b64_tr_b16 v[148:149], v221 offset:0
    ds_read_b64_tr_b16 v[150:151], v221 offset:2048
    buffer_load_dwordx4 a[124:127], v228, s[8:11], s33 offen offset:3072 sc1
    v_mfma_f32_16x16x32_bf16 v[52:55], v[184:187], v[124:127], v[52:55]
    ds_read_b64_tr_b16 v[152:153], v222 offset:0
    v_mfma_f32_16x16x32_bf16 v[56:59], v[188:191], v[120:123], v[56:59]
    ds_read_b64_tr_b16 v[154:155], v222 offset:2048
    ds_read_b64_tr_b16 v[156:157], v223 offset:0
    v_mfma_f32_16x16x32_bf16 v[60:63], v[188:191], v[124:127], v[60:63]
    ds_read_b64_tr_b16 v[158:159], v223 offset:2048
    buffer_load_dwordx4 v[120:123], v226, s[8:11], s36 offen offset:3072 sc1
    buffer_load_dwordx4 v[124:127], v227, s[8:11], s36 offen offset:3072 sc1
    s_add_u32 s36, s36, 8192
.p2align 3
kc_loop:
    s_waitcnt vmcnt(28) lgkmcnt(12)
    v_mfma_f32_16x16x32_bf16 v[0:3], v[128:131], v[64:67], v[0:3]
    ds_read_b64_tr_b16 v[160:161], v216 offset:8192
    v_mfma_f32_16x16x32_bf16 v[4:7], v[128:131], v[68:71], v[4:7]
    ds_read_b64_tr_b16 v[162:163], v216 offset:10240
    v_mfma_f32_16x16x32_bf16 v[8:11], v[132:135], v[64:67], v[8:11]
    ds_read_b64_tr_b16 v[164:165], v217 offset:8192
    v_mfma_f32_16x16x32_bf16 v[12:15], v[132:135], v[68:71], v[12:15]
    ds_read_b64_tr_b16 v[166:167], v217 offset:10240
    s_waitcnt lgkmcnt(12)
    v_mfma_f32_16x16x32_bf16 v[16:19], v[136:139], v[64:67], v[16:19]
    ds_read_b64_tr_b16 v[168:169], v218 offset:8192
    v_mfma_f32_16x16x32_bf16 v[20:23], v[136:139], v[68:71], v[20:23]
    ds_read_b64_tr_b16 v[170:171], v218 offset:10240
    v_mfma_f32_16x16x32_bf16 v[24:27], v[140:143], v[64:67], v[24:27]
    ds_read_b64_tr_b16 v[172:173], v219 offset:8192
    v_mfma_f32_16x16x32_bf16 v[28:31], v[140:143], v[68:71], v[28:31]
    ds_read_b64_tr_b16 v[174:175], v219 offset:10240
    s_waitcnt lgkmcnt(12)
    v_mfma_f32_16x16x32_bf16 v[32:35], v[144:147], v[64:67], v[32:35]
    ds_read_b64_tr_b16 v[176:177], v220 offset:8192
    s_add_u32 m0, s38, 32768
    v_mfma_f32_16x16x32_bf16 v[36:39], v[144:147], v[68:71], v[36:39]
    ds_read_b64_tr_b16 v[178:179], v220 offset:10240
    s_add_u32 s32, s37, 262144
    v_mfma_f32_16x16x32_bf16 v[40:43], v[148:151], v[64:67], v[40:43]
    ds_read_b64_tr_b16 v[180:181], v221 offset:8192
    buffer_load_dwordx4 v224, s[12:15], s32 offen lds
    v_mfma_f32_16x16x32_bf16 v[44:47], v[148:151], v[68:71], v[44:47]
    ds_read_b64_tr_b16 v[182:183], v221 offset:10240
    s_waitcnt lgkmcnt(12)
    v_mfma_f32_16x16x32_bf16 v[48:51], v[152:155], v[64:67], v[48:51]
    ds_read_b64_tr_b16 v[184:185], v222 offset:8192
    v_mfma_f32_16x16x32_bf16 v[52:55], v[152:155], v[68:71], v[52:55]
    ds_read_b64_tr_b16 v[186:187], v222 offset:10240
    buffer_load_dwordx4 v225, s[12:15], s32 offen offset:1024 lds
    v_mfma_f32_16x16x32_bf16 v[56:59], v[156:159], v[64:67], v[56:59]
    ds_read_b64_tr_b16 v[188:189], v223 offset:8192
    v_mfma_f32_16x16x32_bf16 v[60:63], v[156:159], v[68:71], v[60:63]
    ds_read_b64_tr_b16 v[190:191], v223 offset:10240
    s_waitcnt vmcnt(26) lgkmcnt(12)
    v_mfma_f32_16x16x32_bf16 v[0:3], v[160:163], v[72:75], v[0:3]
    ds_read_b64_tr_b16 v[128:129], v216 offset:16384
    v_mfma_f32_16x16x32_bf16 v[4:7], v[160:163], v[76:79], v[4:7]
    ds_read_b64_tr_b16 v[130:131], v216 offset:18432
    v_mfma_f32_16x16x32_bf16 v[8:11], v[164:167], v[72:75], v[8:11]
    ds_read_b64_tr_b16 v[132:133], v217 offset:16384
    buffer_load_dwordx4 v[64:67], v226, s[8:11], s35 offen offset:0 sc1
    v_mfma_f32_16x16x32_bf16 v[12:15], v[164:167], v[76:79], v[12:15]
    ds_read_b64_tr_b16 v[134:135], v217 offset:18432
    s_waitcnt lgkmcnt(12)
    v_mfma_f32_16x16x32_bf16 v[16:19], v[168:171], v[72:75], v[16:19]
    ds_read_b64_tr_b16 v[136:137], v218 offset:16384
    v_mfma_f32_16x16x32_bf16 v[20:23], v[168:171], v[76:79], v[20:23]
    ds_read_b64_tr_b16 v[138:139], v218 offset:18432
    buffer_load_dwordx4 v[68:71], v227, s[8:11], s35 offen offset:0 sc1
    v_mfma_f32_16x16x32_bf16 v[24:27], v[172:175], v[72:75], v[24:27]
    ds_read_b64_tr_b16 v[140:141], v219 offset:16384
    v_mfma_f32_16x16x32_bf16 v[28:31], v[172:175], v[76:79], v[28:31]
    ds_read_b64_tr_b16 v[142:143], v219 offset:18432
    s_waitcnt lgkmcnt(12)
    v_mfma_f32_16x16x32_bf16 v[32:35], v[176:179], v[72:75], v[32:35]
    ds_read_b64_tr_b16 v[144:145], v220 offset:16384
    s_add_u32 m0, s38, 40960
    v_mfma_f32_16x16x32_bf16 v[36:39], v[176:179], v[76:79], v[36:39]
    ds_read_b64_tr_b16 v[146:147], v220 offset:18432
    s_add_u32 s32, s37, 327680
    v_mfma_f32_16x16x32_bf16 v[40:43], v[180:183], v[72:75], v[40:43]
    ds_read_b64_tr_b16 v[148:149], v221 offset:16384
    buffer_load_dwordx4 v224, s[12:15], s32 offen lds
    v_mfma_f32_16x16x32_bf16 v[44:47], v[180:183], v[76:79], v[44:47]
    ds_read_b64_tr_b16 v[150:151], v221 offset:18432
    s_waitcnt lgkmcnt(12)
    v_mfma_f32_16x16x32_bf16 v[48:51], v[184:187], v[72:75], v[48:51]
    ds_read_b64_tr_b16 v[152:153], v222 offset:16384
    v_mfma_f32_16x16x32_bf16 v[52:55], v[184:187], v[76:79], v[52:55]
    ds_read_b64_tr_b16 v[154:155], v222 offset:18432
    buffer_load_dwordx4 v225, s[12:15], s32 offen offset:1024 lds
    v_mfma_f32_16x16x32_bf16 v[56:59], v[188:191], v[72:75], v[56:59]
    ds_read_b64_tr_b16 v[156:157], v223 offset:16384
    v_mfma_f32_16x16x32_bf16 v[60:63], v[188:191], v[76:79], v[60:63]
    ds_read_b64_tr_b16 v[158:159], v223 offset:18432
    s_waitcnt vmcnt(24) lgkmcnt(12)
    v_mfma_f32_16x16x32_bf16 v[0:3], v[128:131], v[80:83], v[0:3]
    ds_read_b64_tr_b16 v[160:161], v216 offset:24576
    v_mfma_f32_16x16x32_bf16 v[4:7], v[128:131], v[84:87], v[4:7]
    ds_read_b64_tr_b16 v[162:163], v216 offset:26624
    v_mfma_f32_16x16x32_bf16 v[8:11], v[132:135], v[80:83], v[8:11]
    ds_read_b64_tr_b16 v[164:165], v217 offset:24576
    buffer_load_dwordx4 v[72:75], v226, s[8:11], s35 offen offset:1024 sc1
    v_mfma_f32_16x16x32_bf16 v[12:15], v[132:135], v[84:87], v[12:15]
    ds_read_b64_tr_b16 v[166:167], v217 offset:26624
    s_waitcnt lgkmcnt(12)
    v_mfma_f32_16x16x32_bf16 v[16:19], v[136:139], v[80:83], v[16:19]
    ds_read_b64_tr_b16 v[168:169], v218 offset:24576
    v_mfma_f32_16x16x32_bf16 v[20:23], v[136:139], v[84:87], v[20:23]
    ds_read_b64_tr_b16 v[170:171], v218 offset:26624
    buffer_load_dwordx4 v[76:79], v227, s[8:11], s35 offen offset:1024 sc1
    v_mfma_f32_16x16x32_bf16 v[24:27], v[140:143], v[80:83], v[24:27]
    ds_read_b64_tr_b16 v[172:173], v219 offset:24576
    v_mfma_f32_16x16x32_bf16 v[28:31], v[140:143], v[84:87], v[28:31]
    ds_read_b64_tr_b16 v[174:175], v219 offset:26624
    s_waitcnt lgkmcnt(12)
    v_mfma_f32_16x16x32_bf16 v[32:35], v[144:147], v[80:83], v[32:35]
    ds_read_b64_tr_b16 v[176:177], v220 offset:24576
    s_add_u32 m0, s38, 49152
    v_mfma_f32_16x16x32_bf16 v[36:39], v[144:147], v[84:87], v[36:39]
    ds_read_b64_tr_b16 v[178:179], v220 offset:26624
    s_add_u32 s32, s37, 393216
    v_mfma_f32_16x16x32_bf16 v[40:43], v[148:151], v[80:83], v[40:43]
    ds_read_b64_tr_b16 v[180:181], v221 offset:24576
    buffer_load_dwordx4 v224, s[12:15], s32 offen lds
    v_mfma_f32_16x16x32_bf16 v[44:47], v[148:151], v[84:87], v[44:47]
    ds_read_b64_tr_b16 v[182:183], v221 offset:26624
    s_waitcnt lgkmcnt(12)
    v_mfma_f32_16x16x32_bf16 v[48:51], v[152:155], v[80:83], v[48:51]
    ds_read_b64_tr_b16 v[184:185], v222 offset:24576
    v_mfma_f32_16x16x32_bf16 v[52:55], v[152:155], v[84:87], v[52:55]
    ds_read_b64_tr_b16 v[186:187], v222 offset:26624
    buffer_load_dwordx4 v225, s[12:15], s32 offen offset:1024 lds
    v_mfma_f32_16x16x32_bf16 v[56:59], v[156:159], v[80:83], v[56:59]
    ds_read_b64_tr_b16 v[188:189], v223 offset:24576
    v_mfma_f32_16x16x32_bf16 v[60:63], v[156:159], v[84:87], v[60:63]
    ds_read_b64_tr_b16 v[190:191], v223 offset:26624
    s_waitcnt vmcnt(26) lgkmcnt(12)
    v_mfma_f32_16x16x32_bf16 v[0:3], v[160:163], v[88:91], v[0:3]
    s_add_u32 m0, s38, 57344
    v_mfma_f32_16x16x32_bf16 v[4:7], v[160:163], v[92:95], v[4:7]
    s_add_u32 s32, s37, 458752
    v_mfma_f32_16x16x32_bf16 v[8:11], v[164:167], v[88:91], v[8:11]
    buffer_load_dwordx4 v224, s[12:15], s32 offen lds
    buffer_load_dwordx4 v[80:83], v226, s[8:11], s35 offen offset:2048 sc1
    v_mfma_f32_16x16x32_bf16 v[12:15], v[164:167], v[92:95], v[12:15]
    buffer_load_dwordx4 v225, s[12:15], s32 offen offset:1024 lds
    s_add_u32 s37, s37, 524288
    s_xor_b32 s38, s38, 65536
    s_waitcnt lgkmcnt(8)
    v_mfma_f32_16x16x32_bf16 v[16:19], v[168:171], v[88:91], v[16:19]
    buffer_load_dwordx4 v[84:87], v227, s[8:11], s35 offen offset:2048 sc1
    v_mfma_f32_16x16x32_bf16 v[20:23], v[168:171], v[92:95], v[20:23]
    v_mfma_f32_16x16x32_bf16 v[24:27], v[172:175], v[88:91], v[24:27]
    s_waitcnt vmcnt(33) lgkmcnt(0)
    s_barrier
    ds_read_b64_tr_b16 v[128:129], v216 offset:32768
    ds_read_b64_tr_b16 v[130:131], v216 offset:34816
    v_mfma_f32_16x16x32_bf16 v[28:31], v[172:175], v[92:95], v[28:31]
    ds_read_b64_tr_b16 v[132:133], v217 offset:32768
    ds_read_b64_tr_b16 v[134:135], v217 offset:34816
    v_mfma_f32_16x16x32_bf16 v[32:35], v[176:179], v[88:91], v[32:35]
    ds_read_b64_tr_b16 v[136:137], v218 offset:32768
    v_mfma_f32_16x16x32_bf16 v[36:39], v[176:179], v[92:95], v[36:39]
    ds_read_b64_tr_b16 v[138:139], v218 offset:34816
    ds_read_b64_tr_b16 v[140:141], v219 offset:32768
    v_mfma_f32_16x16x32_bf16 v[40:43], v[180:183], v[88:91], v[40:43]
    ds_read_b64_tr_b16 v[142:143], v219 offset:34816
    v_mfma_f32_16x16x32_bf16 v[44:47], v[180:183], v[92:95], v[44:47]
    ds_read_b64_tr_b16 v[144:145], v220 offset:32768
    ds_read_b64_tr_b16 v[146:147], v220 offset:34816
    v_mfma_f32_16x16x32_bf16 v[48:51], v[184:187], v[88:91], v[48:51]
    ds_read_b64_tr_b16 v[148:149], v221 offset:32768
    ds_read_b64_tr_b16 v[150:151], v221 offset:34816
    v_mfma_f32_16x16x32_bf16 v[52:55], v[184:187], v[92:95], v[52:55]
    ds_read_b64_tr_b16 v[152:153], v222 offset:32768
    v_mfma_f32_16x16x32_bf16 v[56:59], v[188:191], v[88:91], v[56:59]
    ds_read_b64_tr_b16 v[154:155], v222 offset:34816
    ds_read_b64_tr_b16 v[156:157], v223 offset:32768
    v_mfma_f32_16x16x32_bf16 v[60:63], v[188:191], v[92:95], v[60:63]
    ds_read_b64_tr_b16 v[158:159], v223 offset:34816
    s_waitcnt vmcnt(26) lgkmcnt(12)
    v_mfma_f32_16x16x32_bf16 v[0:3], v[128:131], v[96:99], v[0:3]
    ds_read_b64_tr_b16 v[160:161], v216 offset:40960
    v_mfma_f32_16x16x32_bf16 v[4:7], v[128:131], v[100:103], v[4:7]
    ds_read_b64_tr_b16 v[162:163], v216 offset:43008
    v_mfma_f32_16x16x32_bf16 v[8:11], v[132:135], v[96:99], v[8:11]
    ds_read_b64_tr_b16 v[164:165], v217 offset:40960
    buffer_load_dwordx4 v[88:91], v226, s[8:11], s35 offen offset:3072 sc1
    v_mfma_f32_16x16x32_bf16 v[12:15], v[132:135], v[100:103], v[12:15]
    ds_read_b64_tr_b16 v[166:167], v217 offset:43008
    s_waitcnt lgkmcnt(12)
    v_mfma_f32_16x16x32_bf16 v[16:19], v[136:139], v[96:99], v[16:19]
    ds_read_b64_tr_b16 v[168:169], v218 offset:40960
    v_mfma_f32_16x16x32_bf16 v[20:23], v[136:139], v[100:103], v[20:23]
    ds_read_b64_tr_b16 v[170:171], v218 offset:43008
    buffer_load_dwordx4 v[92:95], v227, s[8:11], s35 offen offset:3072 sc1
    v_mfma_f32_16x16x32_bf16 v[24:27], v[140:143], v[96:99], v[24:27]
    ds_read_b64_tr_b16 v[172:173], v219 offset:40960
    v_mfma_f32_16x16x32_bf16 v[28:31], v[140:143], v[100:103], v[28:31]
    ds_read_b64_tr_b16 v[174:175], v219 offset:43008
    s_waitcnt lgkmcnt(12)
    v_mfma_f32_16x16x32_bf16 v[32:35], v[144:147], v[96:99], v[32:35]
    ds_read_b64_tr_b16 v[176:177], v220 offset:40960
    s_add_u32 m0, s38, 0
    v_mfma_f32_16x16x32_bf16 v[36:39], v[144:147], v[100:103], v[36:39]
    ds_read_b64_tr_b16 v[178:179], v220 offset:43008
    s_add_u32 s32, s37, 0
    v_mfma_f32_16x16x32_bf16 v[40:43], v[148:151], v[96:99], v[40:43]
    ds_read_b64_tr_b16 v[180:181], v221 offset:40960
    buffer_load_dwordx4 v224, s[12:15], s32 offen lds
    v_mfma_f32_16x16x32_bf16 v[44:47], v[148:151], v[100:103], v[44:47]
    ds_read_b64_tr_b16 v[182:183], v221 offset:43008
    s_waitcnt lgkmcnt(12)
    v_mfma_f32_16x16x32_bf16 v[48:51], v[152:155], v[96:99], v[48:51]
    ds_read_b64_tr_b16 v[184:185], v222 offset:40960
    v_mfma_f32_16x16x32_bf16 v[52:55], v[152:155], v[100:103], v[52:55]
    ds_read_b64_tr_b16 v[186:187], v222 offset:43008
    buffer_load_dwordx4 v225, s[12:15], s32 offen offset:1024 lds
    v_mfma_f32_16x16x32_bf16 v[56:59], v[156:159], v[96:99], v[56:59]
    ds_read_b64_tr_b16 v[188:189], v223 offset:40960
    v_mfma_f32_16x16x32_bf16 v[60:63], v[156:159], v[100:103], v[60:63]
    ds_read_b64_tr_b16 v[190:191], v223 offset:43008
    s_waitcnt vmcnt(26) lgkmcnt(12)
    v_mfma_f32_16x16x32_bf16 v[0:3], v[160:163], v[104:107], v[0:3]
    ds_read_b64_tr_b16 v[128:129], v216 offset:49152
    v_mfma_f32_16x16x32_bf16 v[4:7], v[160:163], v[108:111], v[4:7]
    ds_read_b64_tr_b16 v[130:131], v216 offset:51200
    v_mfma_f32_16x16x32_bf16 v[8:11], v[164:167], v[104:107], v[8:11]
    ds_read_b64_tr_b16 v[132:133], v217 offset:49152
    buffer_load_dwordx4 v[96:99], v226, s[8:11], s36 offen offset:0 sc1
    v_mfma_f32_16x16x32_bf16 v[12:15], v[164:167], v[108:111], v[12:15]
    ds_read_b64_tr_b16 v[134:135], v217 offset:51200
    s_waitcnt lgkmcnt(12)
    v_mfma_f32_16x16x32_bf16 v[16:19], v[168:171], v[104:107], v[16:19]
    ds_read_b64_tr_b16 v[136:137], v218 offset:49152
    v_mfma_f32_16x16x32_bf16 v[20:23], v[168:171], v[108:111], v[20:23]
    ds_read_b64_tr_b16 v[138:139], v218 offset:51200
    buffer_load_dwordx4 v[100:103], v227, s[8:11], s36 offen offset:0 sc1
    v_mfma_f32_16x16x32_bf16 v[24:27], v[172:175], v[104:107], v[24:27]
    ds_read_b64_tr_b16 v[140:141], v219 offset:49152
    v_mfma_f32_16x16x32_bf16 v[28:31], v[172:175], v[108:111], v[28:31]
    ds_read_b64_tr_b16 v[142:143], v219 offset:51200
    s_waitcnt lgkmcnt(12)
    v_mfma_f32_16x16x32_bf16 v[32:35], v[176:179], v[104:107], v[32:35]
    ds_read_b64_tr_b16 v[144:145], v220 offset:49152
    s_add_u32 m0, s38, 8192
    v_mfma_f32_16x16x32_bf16 v[36:39], v[176:179], v[108:111], v[36:39]
    ds_read_b64_tr_b16 v[146:147], v220 offset:51200
    s_add_u32 s32, s37, 65536
    v_mfma_f32_16x16x32_bf16 v[40:43], v[180:183], v[104:107], v[40:43]
    ds_read_b64_tr_b16 v[148:149], v221 offset:49152
    buffer_load_dwordx4 v224, s[12:15], s32 offen lds
    s_add_u32 s35, s35, 8192
    v_mfma_f32_16x16x32_bf16 v[44:47], v[180:183], v[108:111], v[44:47]
    ds_read_b64_tr_b16 v[150:151], v221 offset:51200
    s_waitcnt lgkmcnt(12)
    v_mfma_f32_16x16x32_bf16 v[48:51], v[184:187], v[104:107], v[48:51]
    ds_read_b64_tr_b16 v[152:153], v222 offset:49152
    v_mfma_f32_16x16x32_bf16 v[52:55], v[184:187], v[108:111], v[52:55]
    ds_read_b64_tr_b16 v[154:155], v222 offset:51200
    buffer_load_dwordx4 v225, s[12:15], s32 offen offset:1024 lds
    v_mfma_f32_16x16x32_bf16 v[56:59], v[188:191], v[104:107], v[56:59]
    ds_read_b64_tr_b16 v[156:157], v223 offset:49152
    v_mfma_f32_16x16x32_bf16 v[60:63], v[188:191], v[108:111], v[60:63]
    ds_read_b64_tr_b16 v[158:159], v223 offset:51200
    s_waitcnt vmcnt(24) lgkmcnt(12)
    v_mfma_f32_16x16x32_bf16 v[0:3], v[128:131], v[112:115], v[0:3]
    ds_read_b64_tr_b16 v[160:161], v216 offset:57344
    v_mfma_f32_16x16x32_bf16 v[4:7], v[128:131], v[116:119], v[4:7]
    ds_read_b64_tr_b16 v[162:163], v216 offset:59392
    v_mfma_f32_16x16x32_bf16 v[8:11], v[132:135], v[112:115], v[8:11]
    ds_read_b64_tr_b16 v[164:165], v217 offset:57344
    buffer_load_dwordx4 v[104:107], v226, s[8:11], s36 offen offset:1024 sc1
    v_mfma_f32_16x16x32_bf16 v[12:15], v[132:135], v[116:119], v[12:15]
    ds_read_b64_tr_b16 v[166:167], v217 offset:59392
    s_waitcnt lgkmcnt(12)
    v_mfma_f32_16x16x32_bf16 v[16:19], v[136:139], v[112:115], v[16:19]
    ds_read_b64_tr_b16 v[168:169], v218 offset:57344
    v_mfma_f32_16x16x32_bf16 v[20:23], v[136:139], v[116:119], v[20:23]
    ds_read_b64_tr_b16 v[170:171], v218 offset:59392
    buffer_load_dwordx4 v[108:111], v227, s[8:11], s36 offen offset:1024 sc1
    v_mfma_f32_16x16x32_bf16 v[24:27], v[140:143], v[112:115], v[24:27]
    ds_read_b64_tr_b16 v[172:173], v219 offset:57344
    v_mfma_f32_16x16x32_bf16 v[28:31], v[140:143], v[116:119], v[28:31]
    ds_read_b64_tr_b16 v[174:175], v219 offset:59392
    s_waitcnt lgkmcnt(12)
    v_mfma_f32_16x16x32_bf16 v[32:35], v[144:147], v[112:115], v[32:35]
    ds_read_b64_tr_b16 v[176:177], v220 offset:57344
    s_add_u32 m0, s38, 16384
    v_mfma_f32_16x16x32_bf16 v[36:39], v[144:147], v[116:119], v[36:39]
    ds_read_b64_tr_b16 v[178:179], v220 offset:59392
    s_add_u32 s32, s37, 131072
    v_mfma_f32_16x16x32_bf16 v[40:43], v[148:151], v[112:115], v[40:43]
    ds_read_b64_tr_b16 v[180:181], v221 offset:57344
    buffer_load_dwordx4 v224, s[12:15], s32 offen lds
    v_mfma_f32_16x16x32_bf16 v[44:47], v[148:151], v[116:119], v[44:47]
    ds_read_b64_tr_b16 v[182:183], v221 offset:59392
    s_waitcnt lgkmcnt(12)
    v_mfma_f32_16x16x32_bf16 v[48:51], v[152:155], v[112:115], v[48:51]
    ds_read_b64_tr_b16 v[184:185], v222 offset:57344
    v_mfma_f32_16x16x32_bf16 v[52:55], v[152:155], v[116:119], v[52:55]
    ds_read_b64_tr_b16 v[186:187], v222 offset:59392
    buffer_load_dwordx4 v225, s[12:15], s32 offen offset:1024 lds
    v_mfma_f32_16x16x32_bf16 v[56:59], v[156:159], v[112:115], v[56:59]
    ds_read_b64_tr_b16 v[188:189], v223 offset:57344
    v_mfma_f32_16x16x32_bf16 v[60:63], v[156:159], v[116:119], v[60:63]
    ds_read_b64_tr_b16 v[190:191], v223 offset:59392
    s_waitcnt vmcnt(26) lgkmcnt(12)
    v_mfma_f32_16x16x32_bf16 v[0:3], v[160:163], v[120:123], v[0:3]
    v_xor_b32 v216, 0x10000, v216
    v_xor_b32 v217, 0x10000, v217
    s_add_u32 m0, s38, 24576
    v_mfma_f32_16x16x32_bf16 v[4:7], v[160:163], v[124:127], v[4:7]
    v_xor_b32 v218, 0x10000, v218
    s_add_u32 s32, s37, 196608
    v_mfma_f32_16x16x32_bf16 v[8:11], v[164:167], v[120:123], v[8:11]
    v_xor_b32 v219, 0x10000, v219
    buffer_load_dwordx4 v224, s[12:15], s32 offen lds
    buffer_load_dwordx4 v[112:115], v226, s[8:11], s36 offen offset:2048 sc1
    v_mfma_f32_16x16x32_bf16 v[12:15], v[164:167], v[124:127], v[12:15]
    v_xor_b32 v220, 0x10000, v220
    v_xor_b32 v221, 0x10000, v221
    buffer_load_dwordx4 v225, s[12:15], s32 offen offset:1024 lds
    s_waitcnt lgkmcnt(8)
    v_mfma_f32_16x16x32_bf16 v[16:19], v[168:171], v[120:123], v[16:19]
    v_xor_b32 v222, 0x10000, v222
    buffer_load_dwordx4 v[116:119], v227, s[8:11], s36 offen offset:2048 sc1
    v_mfma_f32_16x16x32_bf16 v[20:23], v[168:171], v[124:127], v[20:23]
    v_xor_b32 v223, 0x10000, v223
    v_mfma_f32_16x16x32_bf16 v[24:27], v[172:175], v[120:123], v[24:27]
    s_waitcnt vmcnt(33) lgkmcnt(0)
    s_barrier
    ds_read_b64_tr_b16 v[128:129], v216 offset:0
    ds_read_b64_tr_b16 v[130:131], v216 offset:2048
    v_mfma_f32_16x16x32_bf16 v[28:31], v[172:175], v[124:127], v[28:31]
    ds_read_b64_tr_b16 v[132:133], v217 offset:0
    ds_read_b64_tr_b16 v[134:135], v217 offset:2048
    v_mfma_f32_16x16x32_bf16 v[32:35], v[176:179], v[120:123], v[32:35]
    ds_read_b64_tr_b16 v[136:137], v218 offset:0
    v_mfma_f32_16x16x32_bf16 v[36:39], v[176:179], v[124:127], v[36:39]
    ds_read_b64_tr_b16 v[138:139], v218 offset:2048
    ds_read_b64_tr_b16 v[140:141], v219 offset:0
    v_mfma_f32_16x16x32_bf16 v[40:43], v[180:183], v[120:123], v[40:43]
    ds_read_b64_tr_b16 v[142:143], v219 offset:2048
    v_mfma_f32_16x16x32_bf16 v[44:47], v[180:183], v[124:127], v[44:47]
    ds_read_b64_tr_b16 v[144:145], v220 offset:0
    ds_read_b64_tr_b16 v[146:147], v220 offset:2048
    v_mfma_f32_16x16x32_bf16 v[48:51], v[184:187], v[120:123], v[48:51]
    ds_read_b64_tr_b16 v[148:149], v221 offset:0
    ds_read_b64_tr_b16 v[150:151], v221 offset:2048
    v_mfma_f32_16x16x32_bf16 v[52:55], v[184:187], v[124:127], v[52:55]
    ds_read_b64_tr_b16 v[152:153], v222 offset:0
    v_mfma_f32_16x16x32_bf16 v[56:59], v[188:191], v[120:123], v[56:59]
    ds_read_b64_tr_b16 v[154:155], v222 offset:2048
    ds_read_b64_tr_b16 v[156:157], v223 offset:0
    v_mfma_f32_16x16x32_bf16 v[60:63], v[188:191], v[124:127], v[60:63]
    ds_read_b64_tr_b16 v[158:159], v223 offset:2048
    buffer_load_dwordx4 v[120:123], v226, s[8:11], s36 offen offset:3072 sc1
    buffer_load_dwordx4 v[124:127], v227, s[8:11], s36 offen offset:3072 sc1
    s_add_u32 s36, s36, 8192
    s_sub_u32 s34, s34, 1
    s_cbranch_scc0 kc_loop
    s_waitcnt vmcnt(28) lgkmcnt(12)
    v_mfma_f32_16x16x32_bf16 v[0:3], v[128:131], v[64:67], v[0:3]
    ds_read_b64_tr_b16 v[160:161], v216 offset:8192
    v_mfma_f32_16x16x32_bf16 v[4:7], v[128:131], v[68:71], v[4:7]
    ds_read_b64_tr_b16 v[162:163], v216 offset:10240
    s_add_u32 m0, s38, 32768
    s_add_u32 s32, s37, 262144
    buffer_load_dwordx4 v224, s[12:15], s32 offen lds
    v_mfma_f32_16x16x32_bf16 v[8:11], v[132:135], v[64:67], v[8:11]
    ds_read_b64_tr_b16 v[164:165], v217 offset:8192
    buffer_load_dwordx4 a[0:3], v226, s[8:11], s35 offen offset:0 sc1
    v_mfma_f32_16x16x32_bf16 v[12:15], v[132:135], v[68:71], v[12:15]
    ds_read_b64_tr_b16 v[166:167], v217 offset:10240
    s_waitcnt lgkmcnt(12)
    v_mfma_f32_16x16x32_bf16 v[16:19], v[136:139], v[64:67], v[16:19]
    ds_read_b64_tr_b16 v[168:169], v218 offset:8192
    v_mfma_f32_16x16x32_bf16 v[20:23], v[136:139], v[68:71], v[20:23]
    ds_read_b64_tr_b16 v[170:171], v218 offset:10240
    buffer_load_dwordx4 v225, s[12:15], s32 offen offset:1024 lds
    v_mfma_f32_16x16x32_bf16 v[24:27], v[140:143], v[64:67], v[24:27]
    ds_read_b64_tr_b16 v[172:173], v219 offset:8192
    buffer_load_dwordx4 a[4:7], v227, s[8:11], s35 offen offset:0 sc1
    v_mfma_f32_16x16x32_bf16 v[28:31], v[140:143], v[68:71], v[28:31]
    ds_read_b64_tr_b16 v[174:175], v219 offset:10240
    s_waitcnt vmcnt(28) lgkmcnt(4)
    v_mfma_f32_16x16x32_bf16 v[0:3], v[160:163], v[72:75], v[0:3]
    ds_read_b64_tr_b16 v[128:129], v216 offset:16384
    v_mfma_f32_16x16x32_bf16 v[4:7], v[160:163], v[76:79], v[4:7]
    ds_read_b64_tr_b16 v[130:131], v216 offset:18432
    s_add_u32 m0, s38, 40960
    s_add_u32 s32, s37, 327680
    buffer_load_dwordx4 v224, s[12:15], s32 offen lds
    v_mfma_f32_16x16x32_bf16 v[8:11], v[164:167], v[72:75], v[8:11]
    ds_read_b64_tr_b16 v[132:133], v217 offset:16384
    buffer_load_dwordx4 a[8:11], v226, s[8:11], s35 offen offset:1024 sc1
    v_mfma_f32_16x16x32_bf16 v[12:15], v[164:167], v[76:79], v[12:15]
    ds_read_b64_tr_b16 v[134:135], v217 offset:18432
    s_waitcnt lgkmcnt(4)
    v_mfma_f32_16x16x32_bf16 v[16:19], v[168:171], v[72:75], v[16:19]
    ds_read_b64_tr_b16 v[136:137], v218 offset:16384
    v_mfma_f32_16x16x32_bf16 v[20:23], v[168:171], v[76:79], v[20:23]
    ds_read_b64_tr_b16 v[138:139], v218 offset:18432
    buffer_load_dwordx4 v225, s[12:15], s32 offen offset:1024 lds
    v_mfma_f32_16x16x32_bf16 v[24:27], v[172:175], v[72:75], v[24:27]
    ds_read_b64_tr_b16 v[140:141], v219 offset:16384
    buffer_load_dwordx4 a[12:15], v227, s[8:11], s35 offen offset:1024 sc1
    v_mfma_f32_16x16x32_bf16 v[28:31], v[172:175], v[76:79], v[28:31]
    ds_read_b64_tr_b16 v[142:143], v219 offset:18432
    s_waitcnt vmcnt(26) lgkmcnt(4)
    v_mfma_f32_16x16x32_bf16 v[0:3], v[128:131], v[80:83], v[0:3]
    ds_read_b64_tr_b16 v[160:161], v216 offset:24576
    v_mfma_f32_16x16x32_bf16 v[4:7], v[128:131], v[84:87], v[4:7]
    ds_read_b64_tr_b16 v[162:163], v216 offset:26624
    s_add_u32 m0, s38, 49152
    s_add_u32 s32, s37, 393216
    buffer_load_dwordx4 v224, s[12:15], s32 offen lds
    v_mfma_f32_16x16x32_bf16 v[8:11], v[132:135], v[80:83], v[8:11]
    ds_read_b64_tr_b16 v[164:165], v217 offset:24576
    buffer_load_dwordx4 a[16:19], v226, s[8:11], s35 offen offset:2048 sc1
    v_mfma_f32_16x16x32_bf16 v[12:15], v[132:135], v[84:87], v[12:15]
    ds_read_b64_tr_b16 v[166:167], v217 offset:26624
    s_waitcnt lgkmcnt(4)
    v_mfma_f32_16x16x32_bf16 v[16:19], v[136:139], v[80:83], v[16:19]
    ds_read_b64_tr_b16 v[168:169], v218 offset:24576
    v_mfma_f32_16x16x32_bf16 v[20:23], v[136:139], v[84:87], v[20:23]
    ds_read_b64_tr_b16 v[170:171], v218 offset:26624
    buffer_load_dwordx4 v225, s[12:15], s32 offen offset:1024 lds
    v_mfma_f32_16x16x32_bf16 v[24:27], v[140:143], v[80:83], v[24:27]
    ds_read_b64_tr_b16 v[172:173], v219 offset:24576
    buffer_load_dwordx4 a[20:23], v227, s[8:11], s35 offen offset:2048 sc1
    v_mfma_f32_16x16x32_bf16 v[28:31], v[140:143], v[84:87], v[28:31]
    ds_read_b64_tr_b16 v[174:175], v219 offset:26624
    s_waitcnt vmcnt(31)
    s_barrier
    s_waitcnt vmcnt(28) lgkmcnt(4)
    v_mfma_f32_16x16x32_bf16 v[0:3], v[160:163], v[88:91], v[0:3]
    ds_read_b64_tr_b16 v[128:129], v216 offset:32768
    v_mfma_f32_16x16x32_bf16 v[4:7], v[160:163], v[92:95], v[4:7]
    ds_read_b64_tr_b16 v[130:131], v216 offset:34816
    s_add_u32 m0, s38, 57344
    s_add_u32 s32, s37, 458752
    buffer_load_dwordx4 v224, s[12:15], s32 offen lds
    v_mfma_f32_16x16x32_bf16 v[8:11], v[164:167], v[88:91], v[8:11]
    ds_read_b64_tr_b16 v[132:133], v217 offset:32768
    buffer_load_dwordx4 a[24:27], v226, s[8:11], s35 offen offset:3072 sc1
    v_mfma_f32_16x16x32_bf16 v[12:15], v[164:167], v[92:95], v[12:15]
    ds_read_b64_tr_b16 v[134:135], v217 offset:34816
    s_waitcnt lgkmcnt(4)
    v_mfma_f32_16x16x32_bf16 v[16:19], v[168:171], v[88:91], v[16:19]
    ds_read_b64_tr_b16 v[136:137], v218 offset:32768
    v_mfma_f32_16x16x32_bf16 v[20:23], v[168:171], v[92:95], v[20:23]
    ds_read_b64_tr_b16 v[138:139], v218 offset:34816
    buffer_load_dwordx4 v225, s[12:15], s32 offen offset:1024 lds
    v_mfma_f32_16x16x32_bf16 v[24:27], v[172:175], v[88:91], v[24:27]
    ds_read_b64_tr_b16 v[140:141], v219 offset:32768
    buffer_load_dwordx4 a[28:31], v227, s[8:11], s35 offen offset:3072 sc1
    v_mfma_f32_16x16x32_bf16 v[28:31], v[172:175], v[92:95], v[28:31]
    ds_read_b64_tr_b16 v[142:143], v219 offset:34816
    s_waitcnt vmcnt(28) lgkmcnt(4)
    v_mfma_f32_16x16x32_bf16 v[0:3], v[128:131], v[96:99], v[0:3]
    ds_read_b64_tr_b16 v[160:161], v216 offset:40960
    v_mfma_f32_16x16x32_bf16 v[4:7], v[128:131], v[100:103], v[4:7]
    ds_read_b64_tr_b16 v[162:163], v216 offset:43008
    v_mfma_f32_16x16x32_bf16 v[8:11], v[132:135], v[96:99], v[8:11]
    ds_read_b64_tr_b16 v[164:165], v217 offset:40960
    buffer_load_dwordx4 a[32:35], v226, s[8:11], s36 offen offset:0 sc1
    v_mfma_f32_16x16x32_bf16 v[12:15], v[132:135], v[100:103], v[12:15]
    ds_read_b64_tr_b16 v[166:167], v217 offset:43008
    s_waitcnt lgkmcnt(4)
    v_mfma_f32_16x16x32_bf16 v[16:19], v[136:139], v[96:99], v[16:19]
    ds_read_b64_tr_b16 v[168:169], v218 offset:40960
    v_mfma_f32_16x16x32_bf16 v[20:23], v[136:139], v[100:103], v[20:23]
    ds_read_b64_tr_b16 v[170:171], v218 offset:43008
    v_mfma_f32_16x16x32_bf16 v[24:27], v[140:143], v[96:99], v[24:27]
    ds_read_b64_tr_b16 v[172:173], v219 offset:40960
    buffer_load_dwordx4 a[36:39], v227, s[8:11], s36 offen offset:0 sc1
    v_mfma_f32_16x16x32_bf16 v[28:31], v[140:143], v[100:103], v[28:31]
    ds_read_b64_tr_b16 v[174:175], v219 offset:43008
    s_waitcnt vmcnt(26) lgkmcnt(4)
    v_mfma_f32_16x16x32_bf16 v[0:3], v[160:163], v[104:107], v[0:3]
    ds_read_b64_tr_b16 v[128:129], v216 offset:49152
    v_mfma_f32_16x16x32_bf16 v[4:7], v[160:163], v[108:111], v[4:7]
    ds_read_b64_tr_b16 v[130:131], v216 offset:51200
    v_mfma_f32_16x16x32_bf16 v[8:11], v[164:167], v[104:107], v[8:11]
    ds_read_b64_tr_b16 v[132:133], v217 offset:49152
    buffer_load_dwordx4 a[40:43], v226, s[8:11], s36 offen offset:1024 sc1
    v_mfma_f32_16x16x32_bf16 v[12:15], v[164:167], v[108:111], v[12:15]
    ds_read_b64_tr_b16 v[134:135], v217 offset:51200
    s_waitcnt lgkmcnt(4)
    v_mfma_f32_16x16x32_bf16 v[16:19], v[168:171], v[104:107], v[16:19]
    ds_read_b64_tr_b16 v[136:137], v218 offset:49152
    v_mfma_f32_16x16x32_bf16 v[20:23], v[168:171], v[108:111], v[20:23]
    ds_read_b64_tr_b16 v[138:139], v218 offset:51200
    v_mfma_f32_16x16x32_bf16 v[24:27], v[172:175], v[104:107], v[24:27]
    ds_read_b64_tr_b16 v[140:141], v219 offset:49152
    buffer_load_dwordx4 a[44:47], v227, s[8:11], s36 offen offset:1024 sc1
    v_mfma_f32_16x16x32_bf16 v[28:31], v[172:175], v[108:111], v[28:31]
    ds_read_b64_tr_b16 v[142:143], v219 offset:51200
    s_waitcnt vmcnt(22) lgkmcnt(4)
    v_mfma_f32_16x16x32_bf16 v[0:3], v[128:131], v[112:115], v[0:3]
    ds_read_b64_tr_b16 v[160:161], v216 offset:57344
    v_mfma_f32_16x16x32_bf16 v[4:7], v[128:131], v[116:119], v[4:7]
    ds_read_b64_tr_b16 v[162:163], v216 offset:59392
    v_mfma_f32_16x16x32_bf16 v[8:11], v[132:135], v[112:115], v[8:11]
    ds_read_b64_tr_b16 v[164:165], v217 offset:57344
    buffer_load_dwordx4 a[48:51], v226, s[8:11], s36 offen offset:2048 sc1
    v_mfma_f32_16x16x32_bf16 v[12:15], v[132:135], v[116:119], v[12:15]
    ds_read_b64_tr_b16 v[166:167], v217 offset:59392
    s_waitcnt lgkmcnt(4)
    v_mfma_f32_16x16x32_bf16 v[16:19], v[136:139], v[112:115], v[16:19]
    ds_read_b64_tr_b16 v[168:169], v218 offset:57344
    v_mfma_f32_16x16x32_bf16 v[20:23], v[136:139], v[116:119], v[20:23]
    ds_read_b64_tr_b16 v[170:171], v218 offset:59392
    v_mfma_f32_16x16x32_bf16 v[24:27], v[140:143], v[112:115], v[24:27]
    ds_read_b64_tr_b16 v[172:173], v219 offset:57344
    buffer_load_dwordx4 a[52:55], v227, s[8:11], s36 offen offset:2048 sc1
    v_mfma_f32_16x16x32_bf16 v[28:31], v[140:143], v[116:119], v[28:31]
    ds_read_b64_tr_b16 v[174:175], v219 offset:59392
    s_waitcnt vmcnt(25)
    s_barrier
    s_waitcnt vmcnt(22) lgkmcnt(4)
    v_mfma_f32_16x16x32_bf16 v[0:3], v[160:163], v[120:123], v[0:3]
    v_xor_b32 v216, 0x10000, v216
    ds_read_b64_tr_b16 v[128:129], v216 offset:0
    v_mfma_f32_16x16x32_bf16 v[4:7], v[160:163], v[124:127], v[4:7]
    ds_read_b64_tr_b16 v[130:131], v216 offset:2048
    v_mfma_f32_16x16x32_bf16 v[8:11], v[164:167], v[120:123], v[8:11]
    v_xor_b32 v217, 0x10000, v217
    ds_read_b64_tr_b16 v[132:133], v217 offset:0
    buffer_load_dwordx4 a[56:59], v226, s[8:11], s36 offen offset:3072 sc1
    v_mfma_f32_16x16x32_bf16 v[12:15], v[164:167], v[124:127], v[12:15]
    ds_read_b64_tr_b16 v[134:135], v217 offset:2048
    s_waitcnt lgkmcnt(4)
    v_mfma_f32_16x16x32_bf16 v[16:19], v[168:171], v[120:123], v[16:19]
    v_xor_b32 v218, 0x10000, v218
    ds_read_b64_tr_b16 v[136:137], v218 offset:0
    v_mfma_f32_16x16x32_bf16 v[20:23], v[168:171], v[124:127], v[20:23]
    ds_read_b64_tr_b16 v[138:139], v218 offset:2048
    v_mfma_f32_16x16x32_bf16 v[24:27], v[172:175], v[120:123], v[24:27]
    v_xor_b32 v219, 0x10000, v219
    ds_read_b64_tr_b16 v[140:141], v219 offset:0
    buffer_load_dwordx4 a[60:63], v227, s[8:11], s36 offen offset:3072 sc1
    v_mfma_f32_16x16x32_bf16 v[28:31], v[172:175], v[124:127], v[28:31]
    ds_read_b64_tr_b16 v[142:143], v219 offset:2048
    s_waitcnt vmcnt(20) lgkmcnt(4)
    v_mfma_f32_16x16x32_bf16 v[0:3], v[128:131], a[0:3], v[0:3]
    ds_read_b64_tr_b16 v[160:161], v216 offset:8192
    v_mfma_f32_16x16x32_bf16 v[4:7], v[128:131], a[4:7], v[4:7]
    ds_read_b64_tr_b16 v[162:163], v216 offset:10240
    v_mfma_f32_16x16x32_bf16 v[8:11], v[132:135], a[0:3], v[8:11]
    ds_read_b64_tr_b16 v[164:165], v217 offset:8192
    s_mov_b32 s32, 0
    buffer_load_dwordx4 v[192:195], v229, s[16:19], s32 offen
    v_mfma_f32_16x16x32_bf16 v[12:15], v[132:135], a[4:7], v[12:15]
    ds_read_b64_tr_b16 v[166:167], v217 offset:10240
    s_waitcnt lgkmcnt(4)
    v_mfma_f32_16x16x32_bf16 v[16:19], v[136:139], a[0:3], v[16:19]
    ds_read_b64_tr_b16 v[168:169], v218 offset:8192
    v_mfma_f32_16x16x32_bf16 v[20:23], v[136:139], a[4:7], v[20:23]
    ds_read_b64_tr_b16 v[170:171], v218 offset:10240
    v_mfma_f32_16x16x32_bf16 v[24:27], v[140:143], a[0:3], v[24:27]
    ds_read_b64_tr_b16 v[172:173], v219 offset:8192
    v_mfma_f32_16x16x32_bf16 v[28:31], v[140:143], a[4:7], v[28:31]
    ds_read_b64_tr_b16 v[174:175], v219 offset:10240
    s_waitcnt vmcnt(17) lgkmcnt(4)
    v_mfma_f32_16x16x32_bf16 v[0:3], v[160:163], a[8:11], v[0:3]
    ds_read_b64_tr_b16 v[128:129], v216 offset:16384
    v_mfma_f32_16x16x32_bf16 v[4:7], v[160:163], a[12:15], v[4:7]
    ds_read_b64_tr_b16 v[130:131], v216 offset:18432
    v_mfma_f32_16x16x32_bf16 v[8:11], v[164:167], a[8:11], v[8:11]
    ds_read_b64_tr_b16 v[132:133], v217 offset:16384
    s_mov_b32 s32, 16384
    buffer_load_dwordx4 v[196:199], v229, s[16:19], s32 offen
    v_mfma_f32_16x16x32_bf16 v[12:15], v[164:167], a[12:15], v[12:15]
    ds_read_b64_tr_b16 v[134:135], v217 offset:18432
    s_waitcnt lgkmcnt(4)
    v_mfma_f32_16x16x32_bf16 v[16:19], v[168:171], a[8:11], v[16:19]
    ds_read_b64_tr_b16 v[136:137], v218 offset:16384
    v_mfma_f32_16x16x32_bf16 v[20:23], v[168:171], a[12:15], v[20:23]
    ds_read_b64_tr_b16 v[138:139], v218 offset:18432
    v_mfma_f32_16x16x32_bf16 v[24:27], v[172:175], a[8:11], v[24:27]
    ds_read_b64_tr_b16 v[140:141], v219 offset:16384
    v_mfma_f32_16x16x32_bf16 v[28:31], v[172:175], a[12:15], v[28:31]
    ds_read_b64_tr_b16 v[142:143], v219 offset:18432
    s_waitcnt vmcnt(14) lgkmcnt(4)
    v_mfma_f32_16x16x32_bf16 v[0:3], v[128:131], a[16:19], v[0:3]
    ds_read_b64_tr_b16 v[160:161], v216 offset:24576
    v_mfma_f32_16x16x32_bf16 v[4:7], v[128:131], a[20:23], v[4:7]
    ds_read_b64_tr_b16 v[162:163], v216 offset:26624
    v_mfma_f32_16x16x32_bf16 v[8:11], v[132:135], a[16:19], v[8:11]
    ds_read_b64_tr_b16 v[164:165], v217 offset:24576
    s_mov_b32 s32, 32768
    buffer_load_dwordx4 v[200:203], v229, s[16:19], s32 offen
    v_mfma_f32_16x16x32_bf16 v[12:15], v[132:135], a[20:23], v[12:15]
    ds_read_b64_tr_b16 v[166:167], v217 offset:26624
    s_waitcnt lgkmcnt(4)
    v_mfma_f32_16x16x32_bf16 v[16:19], v[136:139], a[16:19], v[16:19]
    ds_read_b64_tr_b16 v[168:169], v218 offset:24576
    v_mfma_f32_16x16x32_bf16 v[20:23], v[136:139], a[20:23], v[20:23]
    ds_read_b64_tr_b16 v[170:171], v218 offset:26624
    v_mfma_f32_16x16x32_bf16 v[24:27], v[140:143], a[16:19], v[24:27]
    ds_read_b64_tr_b16 v[172:173], v219 offset:24576
    v_mfma_f32_16x16x32_bf16 v[28:31], v[140:143], a[20:23], v[28:31]
    ds_read_b64_tr_b16 v[174:175], v219 offset:26624
    s_waitcnt vmcnt(12)
    s_barrier
    s_waitcnt vmcnt(11) lgkmcnt(4)
    v_mfma_f32_16x16x32_bf16 v[0:3], v[160:163], a[24:27], v[0:3]
    ds_read_b64_tr_b16 v[128:129], v216 offset:32768
    v_mfma_f32_16x16x32_bf16 v[4:7], v[160:163], a[28:31], v[4:7]
    ds_read_b64_tr_b16 v[130:131], v216 offset:34816
    v_mfma_f32_16x16x32_bf16 v[8:11], v[164:167], a[24:27], v[8:11]
    ds_read_b64_tr_b16 v[132:133], v217 offset:32768
    s_mov_b32 s32, 49152
    buffer_load_dwordx4 v[204:207], v229, s[16:19], s32 offen
    v_mfma_f32_16x16x32_bf16 v[12:15], v[164:167], a[28:31], v[12:15]
    ds_read_b64_tr_b16 v[134:135], v217 offset:34816
    s_waitcnt lgkmcnt(4)
    v_mfma_f32_16x16x32_bf16 v[16:19], v[168:171], a[24:27], v[16:19]
    ds_read_b64_tr_b16 v[136:137], v218 offset:32768
    v_mfma_f32_16x16x32_bf16 v[20:23], v[168:171], a[28:31], v[20:23]
    ds_read_b64_tr_b16 v[138:139], v218 offset:34816
    v_mfma_f32_16x16x32_bf16 v[24:27], v[172:175], a[24:27], v[24:27]
    ds_read_b64_tr_b16 v[140:141], v219 offset:32768
    v_mfma_f32_16x16x32_bf16 v[28:31], v[172:175], a[28:31], v[28:31]
    ds_read_b64_tr_b16 v[142:143], v219 offset:34816
    s_waitcnt vmcnt(10) lgkmcnt(4)
    v_mfma_f32_16x16x32_bf16 v[0:3], v[128:131], a[32:35], v[0:3]
    ds_read_b64_tr_b16 v[160:161], v216 offset:40960
    v_mfma_f32_16x16x32_bf16 v[4:7], v[128:131], a[36:39], v[4:7]
    ds_read_b64_tr_b16 v[162:163], v216 offset:43008
    v_mfma_f32_16x16x32_bf16 v[8:11], v[132:135], a[32:35], v[8:11]
    ds_read_b64_tr_b16 v[164:165], v217 offset:40960
    v_mfma_f32_16x16x32_bf16 v[12:15], v[132:135], a[36:39], v[12:15]
    ds_read_b64_tr_b16 v[166:167], v217 offset:43008
    s_waitcnt lgkmcnt(4)
    v_mfma_f32_16x16x32_bf16 v[16:19], v[136:139], a[32:35], v[16:19]
    ds_read_b64_tr_b16 v[168:169], v218 offset:40960
    buffer_load_dwordx4 v[208:211], v240, s[20:23], 0 offen
    v_mfma_f32_16x16x32_bf16 v[20:23], v[136:139], a[36:39], v[20:23]
    ds_read_b64_tr_b16 v[170:171], v218 offset:43008
    v_mfma_f32_16x16x32_bf16 v[24:27], v[140:143], a[32:35], v[24:27]
    ds_read_b64_tr_b16 v[172:173], v219 offset:40960
    v_mfma_f32_16x16x32_bf16 v[28:31], v[140:143], a[36:39], v[28:31]
    ds_read_b64_tr_b16 v[174:175], v219 offset:43008
    s_waitcnt vmcnt(9) lgkmcnt(4)
    v_mfma_f32_16x16x32_bf16 v[0:3], v[160:163], a[40:43], v[0:3]
    ds_read_b64_tr_b16 v[128:129], v216 offset:49152
    v_mfma_f32_16x16x32_bf16 v[4:7], v[160:163], a[44:47], v[4:7]
    ds_read_b64_tr_b16 v[130:131], v216 offset:51200
    v_mfma_f32_16x16x32_bf16 v[8:11], v[164:167], a[40:43], v[8:11]
    ds_read_b64_tr_b16 v[132:133], v217 offset:49152
    v_mfma_f32_16x16x32_bf16 v[12:15], v[164:167], a[44:47], v[12:15]
    ds_read_b64_tr_b16 v[134:135], v217 offset:51200
    s_waitcnt lgkmcnt(4)
    v_mfma_f32_16x16x32_bf16 v[16:19], v[168:171], a[40:43], v[16:19]
    ds_read_b64_tr_b16 v[136:137], v218 offset:49152
    s_mov_b32 s32, kc_tail-kc_pc0
    v_lshlrev_b32 v234, 7, v230
    buffer_load_dword v241, v234, s[56:59], s32 offen
    v_mfma_f32_16x16x32_bf16 v[20:23], v[168:171], a[44:47], v[20:23]
    ds_read_b64_tr_b16 v[138:139], v218 offset:51200
    v_mfma_f32_16x16x32_bf16 v[24:27], v[172:175], a[40:43], v[24:27]
    ds_read_b64_tr_b16 v[140:141], v219 offset:49152
    v_mfma_f32_16x16x32_bf16 v[28:31], v[172:175], a[44:47], v[28:31]
    ds_read_b64_tr_b16 v[142:143], v219 offset:51200
    s_waitcnt vmcnt(8) lgkmcnt(4)
    v_mfma_f32_16x16x32_bf16 v[0:3], v[128:131], a[48:51], v[0:3]
    ds_read_b64_tr_b16 v[160:161], v216 offset:57344
    v_mfma_f32_16x16x32_bf16 v[4:7], v[128:131], a[52:55], v[4:7]
    ds_read_b64_tr_b16 v[162:163], v216 offset:59392
    v_mfma_f32_16x16x32_bf16 v[8:11], v[132:135], a[48:51], v[8:11]
    ds_read_b64_tr_b16 v[164:165], v217 offset:57344
    v_mfma_f32_16x16x32_bf16 v[12:15], v[132:135], a[52:55], v[12:15]
    ds_read_b64_tr_b16 v[166:167], v217 offset:59392
    s_waitcnt lgkmcnt(4)
    v_mfma_f32_16x16x32_bf16 v[16:19], v[136:139], a[48:51], v[16:19]
    ds_read_b64_tr_b16 v[168:169], v218 offset:57344
    v_mfma_f32_16x16x32_bf16 v[20:23], v[136:139], a[52:55], v[20:23]
    ds_read_b64_tr_b16 v[170:171], v218 offset:59392
    v_mfma_f32_16x16x32_bf16 v[24:27], v[140:143], a[48:51], v[24:27]
    ds_read_b64_tr_b16 v[172:173], v219 offset:57344
    v_mfma_f32_16x16x32_bf16 v[28:31], v[140:143], a[52:55], v[28:31]
    ds_read_b64_tr_b16 v[174:175], v219 offset:59392
    s_waitcnt vmcnt(6) lgkmcnt(4)
    v_mfma_f32_16x16x32_bf16 v[0:3], v[160:163], a[56:59], v[0:3]
    ds_read_b64_tr_b16 v[144:145], v220 offset:0
    v_mfma_f32_16x16x32_bf16 v[4:7], v[160:163], a[60:63], v[4:7]
    ds_read_b64_tr_b16 v[146:147], v220 offset:2048
    v_mfma_f32_16x16x32_bf16 v[8:11], v[164:167], a[56:59], v[8:11]
    ds_read_b64_tr_b16 v[148:149], v221 offset:0
    v_mfma_f32_16x16x32_bf16 v[12:15], v[164:167], a[60:63], v[12:15]
    ds_read_b64_tr_b16 v[150:151], v221 offset:2048
    s_waitcnt lgkmcnt(4)
    v_mfma_f32_16x16x32_bf16 v[16:19], v[168:171], a[56:59], v[16:19]
    ds_read_b64_tr_b16 v[152:153], v222 offset:0
    v_mfma_f32_16x16x32_bf16 v[20:23], v[168:171], a[60:63], v[20:23]
    ds_read_b64_tr_b16 v[154:155], v222 offset:2048
    v_mfma_f32_16x16x32_bf16 v[24:27], v[172:175], a[56:59], v[24:27]
    ds_read_b64_tr_b16 v[156:157], v223 offset:0
    v_mfma_f32_16x16x32_bf16 v[28:31], v[172:175], a[60:63], v[28:31]
    ds_read_b64_tr_b16 v[158:159], v223 offset:2048
    s_waitcnt lgkmcnt(4)
    v_mfma_f32_16x16x32_bf16 v[32:35], v[144:147], v[64:67], v[32:35]
    ds_read_b64_tr_b16 v[176:177], v220 offset:8192
    v_mfma_f32_16x16x32_bf16 v[36:39], v[144:147], v[68:71], v[36:39]
    ds_read_b64_tr_b16 v[178:179], v220 offset:10240
    v_mfma_f32_16x16x32_bf16 v[40:43], v[148:151], v[64:67], v[40:43]
    ds_read_b64_tr_b16 v[180:181], v221 offset:8192
    v_mfma_f32_16x16x32_bf16 v[44:47], v[148:151], v[68:71], v[44:47]
    ds_read_b64_tr_b16 v[182:183], v221 offset:10240
    s_waitcnt lgkmcnt(4)
    v_mfma_f32_16x16x32_bf16 v[48:51], v[152:155], v[64:67], v[48:51]
    ds_read_b64_tr_b16 v[184:185], v222 offset:8192
    v_mfma_f32_16x16x32_bf16 v[52:55], v[152:155], v[68:71], v[52:55]
    ds_read_b64_tr_b16 v[186:187], v222 offset:10240
    v_mfma_f32_16x16x32_bf16 v[56:59], v[156:159], v[64:67], v[56:59]
    ds_read_b64_tr_b16 v[188:189], v223 offset:8192
    v_mfma_f32_16x16x32_bf16 v[60:63], v[156:159], v[68:71], v[60:63]
    ds_read_b64_tr_b16 v[190:191], v223 offset:10240
    s_waitcnt lgkmcnt(4)
    v_mfma_f32_16x16x32_bf16 v[32:35], v[176:179], v[72:75], v[32:35]
    ds_read_b64_tr_b16 v[144:145], v220 offset:16384
    s_lshl_b32 s33, s39, 12
    v_mfma_f32_16x16x32_bf16 v[36:39], v[176:179], v[76:79], v[36:39]
    ds_read_b64_tr_b16 v[146:147], v220 offset:18432
    v_mfma_f32_16x16x32_bf16 v[40:43], v[180:183], v[72:75], v[40:43]
    ds_read_b64_tr_b16 v[148:149], v221 offset:16384
    s_add_u32 s33, s33, 0x5000000
    v_mfma_f32_16x16x32_bf16 v[44:47], v[180:183], v[76:79], v[44:47]
    ds_read_b64_tr_b16 v[150:151], v221 offset:18432
    s_waitcnt lgkmcnt(4)
    v_mfma_f32_16x16x32_bf16 v[48:51], v[184:187], v[72:75], v[48:51]
    ds_read_b64_tr_b16 v[152:153], v222 offset:16384
    v_mfma_f32_16x16x32_bf16 v[52:55], v[184:187], v[76:79], v[52:55]
    ds_read_b64_tr_b16 v[154:155], v222 offset:18432
    v_cvt_pk_bf16_f32 v0, v0, v1
    v_mfma_f32_16x16x32_bf16 v[56:59], v[188:191], v[72:75], v[56:59]
    ds_read_b64_tr_b16 v[156:157], v223 offset:16384
    v_mfma_f32_16x16x32_bf16 v[60:63], v[188:191], v[76:79], v[60:63]
    ds_read_b64_tr_b16 v[158:159], v223 offset:18432
    v_cvt_pk_bf16_f32 v1, v2, v3
    s_waitcnt lgkmcnt(4)
    v_mfma_f32_16x16x32_bf16 v[32:35], v[144:147], v[80:83], v[32:35]
    ds_read_b64_tr_b16 v[176:177], v220 offset:24576
    v_mfma_f32_16x16x32_bf16 v[36:39], v[144:147], v[84:87], v[36:39]
    ds_read_b64_tr_b16 v[178:179], v220 offset:26624
    v_mfma_f32_16x16x32_bf16 v[40:43], v[148:151], v[80:83], v[40:43]
    ds_read_b64_tr_b16 v[180:181], v221 offset:24576
    v_cvt_pk_bf16_f32 v2, v4, v5
    v_mfma_f32_16x16x32_bf16 v[44:47], v[148:151], v[84:87], v[44:47]
    ds_read_b64_tr_b16 v[182:183], v221 offset:26624
    s_waitcnt lgkmcnt(4)
    v_mfma_f32_16x16x32_bf16 v[48:51], v[152:155], v[80:83], v[48:51]
    ds_read_b64_tr_b16 v[184:185], v222 offset:24576
    v_cvt_pk_bf16_f32 v3, v6, v7
    v_mfma_f32_16x16x32_bf16 v[52:55], v[152:155], v[84:87], v[52:55]
    ds_read_b64_tr_b16 v[186:187], v222 offset:26624
    v_mfma_f32_16x16x32_bf16 v[56:59], v[156:159], v[80:83], v[56:59]
    ds_read_b64_tr_b16 v[188:189], v223 offset:24576
    v_mfma_f32_16x16x32_bf16 v[60:63], v[156:159], v[84:87], v[60:63]
    ds_read_b64_tr_b16 v[190:191], v223 offset:26624
    buffer_store_dwordx4 v[0:3], v228, s[8:11], s33 offen offset:0 sc1
    s_waitcnt lgkmcnt(4)
    v_mfma_f32_16x16x32_bf16 v[32:35], v[176:179], v[88:91], v[32:35]
    ds_read_b64_tr_b16 v[144:145], v220 offset:32768
    v_mfma_f32_16x16x32_bf16 v[36:39], v[176:179], v[92:95], v[36:39]
    ds_read_b64_tr_b16 v[146:147], v220 offset:34816
    v_cvt_pk_bf16_f32 v4, v8, v9
    v_mfma_f32_16x16x32_bf16 v[40:43], v[180:183], v[88:91], v[40:43]
    ds_read_b64_tr_b16 v[148:149], v221 offset:32768
    v_mfma_f32_16x16x32_bf16 v[44:47], v[180:183], v[92:95], v[44:47]
    ds_read_b64_tr_b16 v[150:151], v221 offset:34816
    s_waitcnt lgkmcnt(4)
    v_mfma_f32_16x16x32_bf16 v[48:51], v[184:187], v[88:91], v[48:51]
    ds_read_b64_tr_b16 v[152:153], v222 offset:32768
    v_cvt_pk_bf16_f32 v5, v10, v11
    v_mfma_f32_16x16x32_bf16 v[52:55], v[184:187], v[92:95], v[52:55]
    ds_read_b64_tr_b16 v[154:155], v222 offset:34816
    v_mfma_f32_16x16x32_bf16 v[56:59], v[188:191], v[88:91], v[56:59]
    ds_read_b64_tr_b16 v[156:157], v223 offset:32768
    v_cvt_pk_bf16_f32 v6, v12, v13
    v_mfma_f32_16x16x32_bf16 v[60:63], v[188:191], v[92:95], v[60:63]
    ds_read_b64_tr_b16 v[158:159], v223 offset:34816
    s_waitcnt lgkmcnt(4)
    v_mfma_f32_16x16x32_bf16 v[32:35], v[144:147], v[96:99], v[32:35]
    ds_read_b64_tr_b16 v[176:177], v220 offset:40960
    v_mfma_f32_16x16x32_bf16 v[36:39], v[144:147], v[100:103], v[36:39]
    ds_read_b64_tr_b16 v[178:179], v220 offset:43008
    v_cvt_pk_bf16_f32 v7, v14, v15
    v_mfma_f32_16x16x32_bf16 v[40:43], v[148:151], v[96:99], v[40:43]
    ds_read_b64_tr_b16 v[180:181], v221 offset:40960
    v_mfma_f32_16x16x32_bf16 v[44:47], v[148:151], v[100:103], v[44:47]
    ds_read_b64_tr_b16 v[182:183], v221 offset:43008
    s_waitcnt lgkmcnt(4)
    v_mfma_f32_16x16x32_bf16 v[48:51], v[152:155], v[96:99], v[48:51]
    ds_read_b64_tr_b16 v[184:185], v222 offset:40960
    buffer_store_dwordx4 v[4:7], v228, s[8:11], s33 offen offset:1024 sc1
    v_mfma_f32_16x16x32_bf16 v[52:55], v[152:155], v[100:103], v[52:55]
    ds_read_b64_tr_b16 v[186:187], v222 offset:43008
    v_mfma_f32_16x16x32_bf16 v[56:59], v[156:159], v[96:99], v[56:59]
    ds_read_b64_tr_b16 v[188:189], v223 offset:40960
    v_cvt_pk_bf16_f32 v8, v16, v17
    v_mfma_f32_16x16x32_bf16 v[60:63], v[156:159], v[100:103], v[60:63]
    ds_read_b64_tr_b16 v[190:191], v223 offset:43008
    s_waitcnt lgkmcnt(4)
    v_mfma_f32_16x16x32_bf16 v[32:35], v[176:179], v[104:107], v[32:35]
    ds_read_b64_tr_b16 v[144:145], v220 offset:49152
    v_mfma_f32_16x16x32_bf16 v[36:39], v[176:179], v[108:111], v[36:39]
    ds_read_b64_tr_b16 v[146:147], v220 offset:51200
    v_cvt_pk_bf16_f32 v9, v18, v19
    v_mfma_f32_16x16x32_bf16 v[40:43], v[180:183], v[104:107], v[40:43]
    ds_read_b64_tr_b16 v[148:149], v221 offset:49152
    v_mfma_f32_16x16x32_bf16 v[44:47], v[180:183], v[108:111], v[44:47]
    ds_read_b64_tr_b16 v[150:151], v221 offset:51200
    v_cvt_pk_bf16_f32 v10, v20, v21
    s_waitcnt lgkmcnt(4)
    v_mfma_f32_16x16x32_bf16 v[48:51], v[184:187], v[104:107], v[48:51]
    ds_read_b64_tr_b16 v[152:153], v222 offset:49152
    v_mfma_f32_16x16x32_bf16 v[52:55], v[184:187], v[108:111], v[52:55]
    ds_read_b64_tr_b16 v[154:155], v222 offset:51200
    v_mfma_f32_16x16x32_bf16 v[56:59], v[188:191], v[104:107], v[56:59]
    ds_read_b64_tr_b16 v[156:157], v223 offset:49152
    v_cvt_pk_bf16_f32 v11, v22, v23
    v_mfma_f32_16x16x32_bf16 v[60:63], v[188:191], v[108:111], v[60:63]
    ds_read_b64_tr_b16 v[158:159], v223 offset:51200
    s_waitcnt lgkmcnt(4)
    v_mfma_f32_16x16x32_bf16 v[32:35], v[144:147], v[112:115], v[32:35]
    ds_read_b64_tr_b16 v[176:177], v220 offset:57344
    buffer_store_dwordx4 v[8:11], v228, s[8:11], s33 offen offset:2048 sc1
    v_mfma_f32_16x16x32_bf16 v[36:39], v[144:147], v[116:119], v[36:39]
    ds_read_b64_tr_b16 v[178:179], v220 offset:59392
    v_mfma_f32_16x16x32_bf16 v[40:43], v[148:151], v[112:115], v[40:43]
    ds_read_b64_tr_b16 v[180:181], v221 offset:57344
    v_mfma_f32_16x16x32_bf16 v[44:47], v[148:151], v[116:119], v[44:47]
    ds_read_b64_tr_b16 v[182:183], v221 offset:59392
    v_cvt_pk_bf16_f32 v12, v24, v25
    s_waitcnt lgkmcnt(4)
    v_mfma_f32_16x16x32_bf16 v[48:51], v[152:155], v[112:115], v[48:51]
    ds_read_b64_tr_b16 v[184:185], v222 offset:57344
    v_mfma_f32_16x16x32_bf16 v[52:55], v[152:155], v[116:119], v[52:55]
    ds_read_b64_tr_b16 v[186:187], v222 offset:59392
    v_cvt_pk_bf16_f32 v13, v26, v27
    v_mfma_f32_16x16x32_bf16 v[56:59], v[156:159], v[112:115], v[56:59]
    ds_read_b64_tr_b16 v[188:189], v223 offset:57344
    v_mfma_f32_16x16x32_bf16 v[60:63], v[156:159], v[116:119], v[60:63]
    ds_read_b64_tr_b16 v[190:191], v223 offset:59392
    s_waitcnt lgkmcnt(4)
    v_mfma_f32_16x16x32_bf16 v[32:35], v[176:179], v[120:123], v[32:35]
    v_xor_b32 v220, 0x10000, v220
    ds_read_b64_tr_b16 v[144:145], v220 offset:0
    v_cvt_pk_bf16_f32 v14, v28, v29
    v_mfma_f32_16x16x32_bf16 v[36:39], v[176:179], v[124:127], v[36:39]
    ds_read_b64_tr_b16 v[146:147], v220 offset:2048
    v_mfma_f32_16x16x32_bf16 v[40:43], v[180:183], v[120:123], v[40:43]
    v_xor_b32 v221, 0x10000, v221
    ds_read_b64_tr_b16 v[148:149], v221 offset:0
    v_cvt_pk_bf16_f32 v15, v30, v31
    v_mfma_f32_16x16x32_bf16 v[44:47], v[180:183], v[124:127], v[44:47]
    ds_read_b64_tr_b16 v[150:151], v221 offset:2048
    s_waitcnt lgkmcnt(4)
    v_mfma_f32_16x16x32_bf16 v[48:51], v[184:187], v[120:123], v[48:51]
    v_xor_b32 v222, 0x10000, v222
    ds_read_b64_tr_b16 v[152:153], v222 offset:0
    v_mfma_f32_16x16x32_bf16 v[52:55], v[184:187], v[124:127], v[52:55]
    ds_read_b64_tr_b16 v[154:155], v222 offset:2048
    buffer_store_dwordx4 v[12:15], v228, s[8:11], s33 offen offset:3072 sc1
    v_mfma_f32_16x16x32_bf16 v[56:59], v[188:191], v[120:123], v[56:59]
    v_xor_b32 v223, 0x10000, v223
    ds_read_b64_tr_b16 v[156:157], v223 offset:0
    v_mfma_f32_16x16x32_bf16 v[60:63], v[188:191], v[124:127], v[60:63]
    ds_read_b64_tr_b16 v[158:159], v223 offset:2048
    s_waitcnt lgkmcnt(4)
    v_mfma_f32_16x16x32_bf16 v[32:35], v[144:147], a[0:3], v[32:35]
    ds_read_b64_tr_b16 v[176:177], v220 offset:8192
    v_mfma_f32_16x16x32_bf16 v[36:39], v[144:147], a[4:7], v[36:39]
    ds_read_b64_tr_b16 v[178:179], v220 offset:10240
    v_mfma_f32_16x16x32_bf16 v[40:43], v[148:151], a[0:3], v[40:43]
    ds_read_b64_tr_b16 v[180:181], v221 offset:8192
    v_mfma_f32_16x16x32_bf16 v[44:47], v[148:151], a[4:7], v[44:47]
    ds_read_b64_tr_b16 v[182:183], v221 offset:10240
    s_waitcnt lgkmcnt(4)
    v_mfma_f32_16x16x32_bf16 v[48:51], v[152:155], a[0:3], v[48:51]
    ds_read_b64_tr_b16 v[184:185], v222 offset:8192
    v_mfma_f32_16x16x32_bf16 v[52:55], v[152:155], a[4:7], v[52:55]
    ds_read_b64_tr_b16 v[186:187], v222 offset:10240
    v_mfma_f32_16x16x32_bf16 v[56:59], v[156:159], a[0:3], v[56:59]
    ds_read_b64_tr_b16 v[188:189], v223 offset:8192
    v_mfma_f32_16x16x32_bf16 v[60:63], v[156:159], a[4:7], v[60:63]
    ds_read_b64_tr_b16 v[190:191], v223 offset:10240
    s_waitcnt lgkmcnt(4)
    v_mfma_f32_16x16x32_bf16 v[32:35], v[176:179], a[8:11], v[32:35]
    ds_read_b64_tr_b16 v[144:145], v220 offset:16384
    v_mfma_f32_16x16x32_bf16 v[36:39], v[176:179], a[12:15], v[36:39]
    ds_read_b64_tr_b16 v[146:147], v220 offset:18432
    v_mfma_f32_16x16x32_bf16 v[40:43], v[180:183], a[8:11], v[40:43]
    ds_read_b64_tr_b16 v[148:149], v221 offset:16384
    v_mfma_f32_16x16x32_bf16 v[44:47], v[180:183], a[12:15], v[44:47]
    ds_read_b64_tr_b16 v[150:151], v221 offset:18432
    s_waitcnt lgkmcnt(4)
    v_mfma_f32_16x16x32_bf16 v[48:51], v[184:187], a[8:11], v[48:51]
    ds_read_b64_tr_b16 v[152:153], v222 offset:16384
    v_mfma_f32_16x16x32_bf16 v[52:55], v[184:187], a[12:15], v[52:55]
    ds_read_b64_tr_b16 v[154:155], v222 offset:18432
    v_mfma_f32_16x16x32_bf16 v[56:59], v[188:191], a[8:11], v[56:59]
    ds_read_b64_tr_b16 v[156:157], v223 offset:16384
    v_mfma_f32_16x16x32_bf16 v[60:63], v[188:191], a[12:15], v[60:63]
    ds_read_b64_tr_b16 v[158:159], v223 offset:18432
    s_waitcnt lgkmcnt(4)
    v_mfma_f32_16x16x32_bf16 v[32:35], v[144:147], a[16:19], v[32:35]
    ds_read_b64_tr_b16 v[176:177], v220 offset:24576
    v_mfma_f32_16x16x32_bf16 v[36:39], v[144:147], a[20:23], v[36:39]
    ds_read_b64_tr_b16 v[178:179], v220 offset:26624
    v_mfma_f32_16x16x32_bf16 v[40:43], v[148:151], a[16:19], v[40:43]
    ds_read_b64_tr_b16 v[180:181], v221 offset:24576
    v_mfma_f32_16x16x32_bf16 v[44:47], v[148:151], a[20:23], v[44:47]
    ds_read_b64_tr_b16 v[182:183], v221 offset:26624
    s_waitcnt lgkmcnt(4)
    v_mfma_f32_16x16x32_bf16 v[48:51], v[152:155], a[16:19], v[48:51]
    ds_read_b64_tr_b16 v[184:185], v222 offset:24576
    v_mfma_f32_16x16x32_bf16 v[52:55], v[152:155], a[20:23], v[52:55]
    ds_read_b64_tr_b16 v[186:187], v222 offset:26624
    v_mfma_f32_16x16x32_bf16 v[56:59], v[156:159], a[16:19], v[56:59]
    ds_read_b64_tr_b16 v[188:189], v223 offset:24576
    v_mfma_f32_16x16x32_bf16 v[60:63], v[156:159], a[20:23], v[60:63]
    ds_read_b64_tr_b16 v[190:191], v223 offset:26624
    s_waitcnt lgkmcnt(4)
    v_mfma_f32_16x16x32_bf16 v[32:35], v[176:179], a[24:27], v[32:35]
    ds_read_b64_tr_b16 v[144:145], v220 offset:32768
    v_mfma_f32_16x16x32_bf16 v[36:39], v[176:179], a[28:31], v[36:39]
    ds_read_b64_tr_b16 v[146:147], v220 offset:34816
    v_mfma_f32_16x16x32_bf16 v[40:43], v[180:183], a[24:27], v[40:43]
    ds_read_b64_tr_b16 v[148:149], v221 offset:32768
    v_mfma_f32_16x16x32_bf16 v[44:47], v[180:183], a[28:31], v[44:47]
    ds_read_b64_tr_b16 v[150:151], v221 offset:34816
    s_waitcnt lgkmcnt(4)
    v_mfma_f32_16x16x32_bf16 v[48:51], v[184:187], a[24:27], v[48:51]
    ds_read_b64_tr_b16 v[152:153], v222 offset:32768
    v_mfma_f32_16x16x32_bf16 v[52:55], v[184:187], a[28:31], v[52:55]
    ds_read_b64_tr_b16 v[154:155], v222 offset:34816
    v_mfma_f32_16x16x32_bf16 v[56:59], v[188:191], a[24:27], v[56:59]
    ds_read_b64_tr_b16 v[156:157], v223 offset:32768
    v_mfma_f32_16x16x32_bf16 v[60:63], v[188:191], a[28:31], v[60:63]
    ds_read_b64_tr_b16 v[158:159], v223 offset:34816
    s_waitcnt lgkmcnt(4)
    v_mfma_f32_16x16x32_bf16 v[32:35], v[144:147], a[32:35], v[32:35]
    ds_read_b64_tr_b16 v[176:177], v220 offset:40960
    v_mfma_f32_16x16x32_bf16 v[36:39], v[144:147], a[36:39], v[36:39]
    ds_read_b64_tr_b16 v[178:179], v220 offset:43008
    v_mfma_f32_16x16x32_bf16 v[40:43], v[148:151], a[32:35], v[40:43]
    ds_read_b64_tr_b16 v[180:181], v221 offset:40960
    v_mfma_f32_16x16x32_bf16 v[44:47], v[148:151], a[36:39], v[44:47]
    ds_read_b64_tr_b16 v[182:183], v221 offset:43008
    s_waitcnt lgkmcnt(4)
    v_mfma_f32_16x16x32_bf16 v[48:51], v[152:155], a[32:35], v[48:51]
    ds_read_b64_tr_b16 v[184:185], v222 offset:40960
    v_mfma_f32_16x16x32_bf16 v[52:55], v[152:155], a[36:39], v[52:55]
    ds_read_b64_tr_b16 v[186:187], v222 offset:43008
    v_mfma_f32_16x16x32_bf16 v[56:59], v[156:159], a[32:35], v[56:59]
    ds_read_b64_tr_b16 v[188:189], v223 offset:40960
    v_mfma_f32_16x16x32_bf16 v[60:63], v[156:159], a[36:39], v[60:63]
    ds_read_b64_tr_b16 v[190:191], v223 offset:43008
    s_waitcnt lgkmcnt(4)
    v_mfma_f32_16x16x32_bf16 v[32:35], v[176:179], a[40:43], v[32:35]
    ds_read_b64_tr_b16 v[144:145], v220 offset:49152
    v_mfma_f32_16x16x32_bf16 v[36:39], v[176:179], a[44:47], v[36:39]
    ds_read_b64_tr_b16 v[146:147], v220 offset:51200
    v_mfma_f32_16x16x32_bf16 v[40:43], v[180:183], a[40:43], v[40:43]
    ds_read_b64_tr_b16 v[148:149], v221 offset:49152
    v_mfma_f32_16x16x32_bf16 v[44:47], v[180:183], a[44:47], v[44:47]
    ds_read_b64_tr_b16 v[150:151], v221 offset:51200
    s_waitcnt lgkmcnt(4)
    v_mfma_f32_16x16x32_bf16 v[48:51], v[184:187], a[40:43], v[48:51]
    ds_read_b64_tr_b16 v[152:153], v222 offset:49152
    v_mfma_f32_16x16x32_bf16 v[52:55], v[184:187], a[44:47], v[52:55]
    ds_read_b64_tr_b16 v[154:155], v222 offset:51200
    v_mfma_f32_16x16x32_bf16 v[56:59], v[188:191], a[40:43], v[56:59]
    ds_read_b64_tr_b16 v[156:157], v223 offset:49152
    v_mfma_f32_16x16x32_bf16 v[60:63], v[188:191], a[44:47], v[60:63]
    ds_read_b64_tr_b16 v[158:159], v223 offset:51200
    s_waitcnt lgkmcnt(4)
    v_mfma_f32_16x16x32_bf16 v[32:35], v[144:147], a[48:51], v[32:35]
    ds_read_b64_tr_b16 v[176:177], v220 offset:57344
    s_waitcnt vmcnt(0)
    s_lshl_b32 s39, s39, 7
    s_add_u32 s39, s39, 0x3820000
    buffer_store_dword v233, off, s[8:11], s39 sc1
    v_mfma_f32_16x16x32_bf16 v[36:39], v[144:147], a[52:55], v[36:39]
    ds_read_b64_tr_b16 v[178:179], v220 offset:59392
    v_mfma_f32_16x16x32_bf16 v[40:43], v[148:151], a[48:51], v[40:43]
    ds_read_b64_tr_b16 v[180:181], v221 offset:57344
    v_mfma_f32_16x16x32_bf16 v[44:47], v[148:151], a[52:55], v[44:47]
    ds_read_b64_tr_b16 v[182:183], v221 offset:59392
    s_waitcnt lgkmcnt(4)
    v_mfma_f32_16x16x32_bf16 v[48:51], v[152:155], a[48:51], v[48:51]
    ds_read_b64_tr_b16 v[184:185], v222 offset:57344
    v_mfma_f32_16x16x32_bf16 v[52:55], v[152:155], a[52:55], v[52:55]
    ds_read_b64_tr_b16 v[186:187], v222 offset:59392
    v_mfma_f32_16x16x32_bf16 v[56:59], v[156:159], a[48:51], v[56:59]
    ds_read_b64_tr_b16 v[188:189], v223 offset:57344
    v_mfma_f32_16x16x32_bf16 v[60:63], v[156:159], a[52:55], v[60:63]
    ds_read_b64_tr_b16 v[190:191], v223 offset:59392
    s_waitcnt lgkmcnt(4)
    v_mfma_f32_16x16x32_bf16 v[32:35], v[176:179], a[56:59], v[32:35]
    v_mfma_f32_16x16x32_bf16 v[36:39], v[176:179], a[60:63], v[36:39]
    v_mfma_f32_16x16x32_bf16 v[40:43], v[180:183], a[56:59], v[40:43]
    v_mfma_f32_16x16x32_bf16 v[44:47], v[180:183], a[60:63], v[44:47]
    s_waitcnt lgkmcnt(0)
    v_mfma_f32_16x16x32_bf16 v[48:51], v[184:187], a[56:59], v[48:51]
    v_mfma_f32_16x16x32_bf16 v[52:55], v[184:187], a[60:63], v[52:55]
    v_mfma_f32_16x16x32_bf16 v[56:59], v[188:191], a[56:59], v[56:59]
    v_mfma_f32_16x16x32_bf16 v[60:63], v[188:191], a[60:63], v[60:63]
kc_tail:
    s_barrier
    s_lshl_b32 s32, s7, 7
    s_add_u32 s32, s32, 0x3820000
    s_mov_b32 s34, 0x400000
    s_branch kc_sx1
kc_sx0:
    s_sleep 4
kc_sx1:
    buffer_load_dword v235, off, s[8:11], s32 sc1
    s_waitcnt vmcnt(0)
    v_cmp_ne_u32 vcc, 1, v235
    s_sub_u32 s34, s34, 1
    s_cbranch_scc1 kc_sx2
    s_cbranch_vccnz kc_sx0
kc_sx2:
    s_lshl_b32 s7, s7, 12
    s_add_u32 s7, s7, 0x5000000
    buffer_load_dwordx4 v[96:99], v228, s[8:11], s7 offen offset:0 sc1
    buffer_load_dwordx4 v[100:103], v228, s[8:11], s7 offen offset:1024 sc1
    buffer_load_dwordx4 v[104:107], v228, s[8:11], s7 offen offset:2048 sc1
    buffer_load_dwordx4 v[108:111], v228, s[8:11], s7 offen offset:3072 sc1
    v_lshlrev_b32 v128, 16, v192
    v_and_b32 v129, 0xffff0000, v192
    v_lshlrev_b32 v130, 16, v193
    v_and_b32 v131, 0xffff0000, v193
    v_lshlrev_b32 v132, 16, v194
    v_and_b32 v133, 0xffff0000, v194
    v_lshlrev_b32 v134, 16, v195
    v_and_b32 v135, 0xffff0000, v195
    v_lshlrev_b32 v136, 16, v196
    v_and_b32 v137, 0xffff0000, v196
    v_lshlrev_b32 v138, 16, v197
    v_and_b32 v139, 0xffff0000, v197
    v_lshlrev_b32 v140, 16, v198
    v_and_b32 v141, 0xffff0000, v198
    v_lshlrev_b32 v142, 16, v199
    v_and_b32 v143, 0xffff0000, v199
    v_lshlrev_b32 v144, 16, v200
    v_and_b32 v145, 0xffff0000, v200
    v_lshlrev_b32 v146, 16, v201
    v_and_b32 v147, 0xffff0000, v201
    v_lshlrev_b32 v148, 16, v202
    v_and_b32 v149, 0xffff0000, v202
    v_lshlrev_b32 v150, 16, v203
    v_and_b32 v151, 0xffff0000, v203
    v_lshlrev_b32 v152, 16, v204
    v_and_b32 v153, 0xffff0000, v204
    v_lshlrev_b32 v154, 16, v205
    v_and_b32 v155, 0xffff0000, v205
    v_lshlrev_b32 v156, 16, v206
    v_and_b32 v157, 0xffff0000, v206
    v_lshlrev_b32 v158, 16, v207
    v_and_b32 v159, 0xffff0000, v207
    v_lshlrev_b32 v112, 16, v208
    v_and_b32 v113, 0xffff0000, v208
    v_lshlrev_b32 v114, 16, v209
    v_and_b32 v115, 0xffff0000, v209
    v_lshlrev_b32 v116, 16, v210
    v_and_b32 v117, 0xffff0000, v210
    v_lshlrev_b32 v118, 16, v211
    v_and_b32 v119, 0xffff0000, v211
    v_pk_add_f32 v[120:121], v[112:113], v[114:115]
    v_pk_add_f32 v[122:123], v[116:117], v[118:119]
    v_pk_add_f32 v[120:121], v[120:121], v[122:123]
    v_add_f32 v196, v120, v121
    s_waitcnt vmcnt(3)
    v_lshlrev_b32 v64, 16, v96
    v_and_b32 v65, 0xffff0000, v96
    v_lshlrev_b32 v66, 16, v97
    v_and_b32 v67, 0xffff0000, v97
    v_pk_add_f32 v[32:33], v[32:33], v[64:65]
    v_pk_add_f32 v[34:35], v[34:35], v[66:67]
    v_cvt_pk_bf16_f32 v0, v32, v33
    v_cvt_pk_bf16_f32 v1, v34, v35
    ds_write_b64 v238, v[0:1] offset:0
    v_lshlrev_b32 v68, 16, v98
    v_and_b32 v69, 0xffff0000, v98
    v_lshlrev_b32 v70, 16, v99
    v_and_b32 v71, 0xffff0000, v99
    v_pk_add_f32 v[36:37], v[36:37], v[68:69]
    v_pk_add_f32 v[38:39], v[38:39], v[70:71]
    v_cvt_pk_bf16_f32 v2, v36, v37
    v_cvt_pk_bf16_f32 v3, v38, v39
    ds_write_b64 v238, v[2:3] offset:2304
    s_waitcnt vmcnt(2)
    v_lshlrev_b32 v72, 16, v100
    v_and_b32 v73, 0xffff0000, v100
    v_lshlrev_b32 v74, 16, v101
    v_and_b32 v75, 0xffff0000, v101
    v_pk_add_f32 v[40:41], v[40:41], v[72:73]
    v_pk_add_f32 v[42:43], v[42:43], v[74:75]
    v_cvt_pk_bf16_f32 v4, v40, v41
    v_cvt_pk_bf16_f32 v5, v42, v43
    ds_write_b64 v238, v[4:5] offset:32
    v_lshlrev_b32 v76, 16, v102
    v_and_b32 v77, 0xffff0000, v102
    v_lshlrev_b32 v78, 16, v103
    v_and_b32 v79, 0xffff0000, v103
    v_pk_add_f32 v[44:45], v[44:45], v[76:77]
    v_pk_add_f32 v[46:47], v[46:47], v[78:79]
    v_cvt_pk_bf16_f32 v6, v44, v45
    v_cvt_pk_bf16_f32 v7, v46, v47
    ds_write_b64 v238, v[6:7] offset:2336
    s_waitcnt vmcnt(1)
    v_lshlrev_b32 v80, 16, v104
    v_and_b32 v81, 0xffff0000, v104
    v_lshlrev_b32 v82, 16, v105
    v_and_b32 v83, 0xffff0000, v105
    v_pk_add_f32 v[48:49], v[48:49], v[80:81]
    v_pk_add_f32 v[50:51], v[50:51], v[82:83]
    v_cvt_pk_bf16_f32 v8, v48, v49
    v_cvt_pk_bf16_f32 v9, v50, v51
    ds_write_b64 v238, v[8:9] offset:64
    v_lshlrev_b32 v84, 16, v106
    v_and_b32 v85, 0xffff0000, v106
    v_lshlrev_b32 v86, 16, v107
    v_and_b32 v87, 0xffff0000, v107
    v_pk_add_f32 v[52:53], v[52:53], v[84:85]
    v_pk_add_f32 v[54:55], v[54:55], v[86:87]
    v_cvt_pk_bf16_f32 v10, v52, v53
    v_cvt_pk_bf16_f32 v11, v54, v55
    ds_write_b64 v238, v[10:11] offset:2368
    s_waitcnt vmcnt(0)
    v_lshlrev_b32 v88, 16, v108
    v_and_b32 v89, 0xffff0000, v108
    v_lshlrev_b32 v90, 16, v109
    v_and_b32 v91, 0xffff0000, v109
    v_pk_add_f32 v[56:57], v[56:57], v[88:89]
    v_pk_add_f32 v[58:59], v[58:59], v[90:91]
    v_cvt_pk_bf16_f32 v12, v56, v57
    v_cvt_pk_bf16_f32 v13, v58, v59
    ds_write_b64 v238, v[12:13] offset:96
    v_lshlrev_b32 v92, 16, v110
    v_and_b32 v93, 0xffff0000, v110
    v_lshlrev_b32 v94, 16, v111
    v_and_b32 v95, 0xffff0000, v111
    v_pk_add_f32 v[60:61], v[60:61], v[92:93]
    v_pk_add_f32 v[62:63], v[62:63], v[94:95]
    v_cvt_pk_bf16_f32 v14, v60, v61
    v_cvt_pk_bf16_f32 v15, v62, v63
    ds_write_b64 v238, v[14:15] offset:2400
    s_waitcnt lgkmcnt(0)
    ds_read_b128 v[16:19], v239 offset:0
    ds_read_b128 v[20:23], v239 offset:1152
    ds_read_b128 v[24:27], v239 offset:2304
    ds_read_b128 v[28:31], v239 offset:3456
    s_waitcnt lgkmcnt(3)
    v_lshlrev_b32 v64, 16, v16
    v_lshlrev_b32 v66, 16, v17
    v_lshlrev_b32 v68, 16, v18
    v_lshlrev_b32 v70, 16, v19
    v_and_b32 v65, 0xffff0000, v16
    v_and_b32 v67, 0xffff0000, v17
    v_and_b32 v69, 0xffff0000, v18
    v_and_b32 v71, 0xffff0000, v19
    v_pk_add_f32 v[64:65], v[64:65], v[128:129]
    v_pk_add_f32 v[66:67], v[66:67], v[130:131]
    v_pk_add_f32 v[68:69], v[68:69], v[132:133]
    v_pk_add_f32 v[70:71], v[70:71], v[134:135]
    v_cvt_pk_bf16_f32 v16, v64, v65
    v_cvt_pk_bf16_f32 v17, v66, v67
    v_cvt_pk_bf16_f32 v18, v68, v69
    v_cvt_pk_bf16_f32 v19, v70, v71
    v_lshlrev_b32 v64, 16, v16
    v_lshlrev_b32 v66, 16, v17
    v_lshlrev_b32 v68, 16, v18
    v_lshlrev_b32 v70, 16, v19
    v_and_b32 v65, 0xffff0000, v16
    v_and_b32 v67, 0xffff0000, v17
    v_and_b32 v69, 0xffff0000, v18
    v_and_b32 v71, 0xffff0000, v19
    s_mov_b32 s32, 0x3400000
    buffer_store_dwordx4 v[16:19], v229, s[8:11], s32 offen sc1
    v_pk_add_f32 v[160:161], v[64:65], v[66:67]
    v_pk_mul_f32 v[162:163], v[64:65], v[64:65]
    v_pk_mul_f32 v[164:165], v[64:65], v[112:113]
    v_pk_fma_f32 v[162:163], v[66:67], v[66:67], v[162:163]
    v_pk_fma_f32 v[164:165], v[66:67], v[114:115], v[164:165]
    v_pk_add_f32 v[160:161], v[160:161], v[68:69]
    v_pk_fma_f32 v[162:163], v[68:69], v[68:69], v[162:163]
    v_pk_fma_f32 v[164:165], v[68:69], v[116:117], v[164:165]
    v_pk_add_f32 v[160:161], v[160:161], v[70:71]
    v_pk_fma_f32 v[162:163], v[70:71], v[70:71], v[162:163]
    v_pk_fma_f32 v[164:165], v[70:71], v[118:119], v[164:165]
    v_add_f32 v184, v160, v161
    v_add_f32 v185, v162, v163
    v_add_f32 v186, v164, v165
    s_waitcnt lgkmcnt(2)
    v_lshlrev_b32 v72, 16, v20
    v_lshlrev_b32 v74, 16, v21
    v_lshlrev_b32 v76, 16, v22
    v_lshlrev_b32 v78, 16, v23
    v_and_b32 v73, 0xffff0000, v20
    v_and_b32 v75, 0xffff0000, v21
    v_and_b32 v77, 0xffff0000, v22
    v_and_b32 v79, 0xffff0000, v23
    v_pk_add_f32 v[72:73], v[72:73], v[136:137]
    v_pk_add_f32 v[74:75], v[74:75], v[138:139]
    v_pk_add_f32 v[76:77], v[76:77], v[140:141]
    v_pk_add_f32 v[78:79], v[78:79], v[142:143]
    v_cvt_pk_bf16_f32 v20, v72, v73
    v_cvt_pk_bf16_f32 v21, v74, v75
    v_cvt_pk_bf16_f32 v22, v76, v77
    v_cvt_pk_bf16_f32 v23, v78, v79
    v_lshlrev_b32 v72, 16, v20
    v_lshlrev_b32 v74, 16, v21
    v_lshlrev_b32 v76, 16, v22
    v_lshlrev_b32 v78, 16, v23
    v_and_b32 v73, 0xffff0000, v20
    v_and_b32 v75, 0xffff0000, v21
    v_and_b32 v77, 0xffff0000, v22
    v_and_b32 v79, 0xffff0000, v23
    s_mov_b32 s32, 0x3404000
    buffer_store_dwordx4 v[20:23], v229, s[8:11], s32 offen sc1
    v_pk_add_f32 v[166:167], v[72:73], v[74:75]
    v_pk_mul_f32 v[168:169], v[72:73], v[72:73]
    v_pk_mul_f32 v[170:171], v[72:73], v[112:113]
    v_pk_fma_f32 v[168:169], v[74:75], v[74:75], v[168:169]
    v_pk_fma_f32 v[170:171], v[74:75], v[114:115], v[170:171]
    v_pk_add_f32 v[166:167], v[166:167], v[76:77]
    v_pk_fma_f32 v[168:169], v[76:77], v[76:77], v[168:169]
    v_pk_fma_f32 v[170:171], v[76:77], v[116:117], v[170:171]
    v_pk_add_f32 v[166:167], v[166:167], v[78:79]
    v_pk_fma_f32 v[168:169], v[78:79], v[78:79], v[168:169]
    v_pk_fma_f32 v[170:171], v[78:79], v[118:119], v[170:171]
    v_add_f32 v187, v166, v167
    v_add_f32 v188, v168, v169
    v_add_f32 v189, v170, v171
    s_waitcnt lgkmcnt(1)
    v_lshlrev_b32 v80, 16, v24
    v_lshlrev_b32 v82, 16, v25
    v_lshlrev_b32 v84, 16, v26
    v_lshlrev_b32 v86, 16, v27
    v_and_b32 v81, 0xffff0000, v24
    v_and_b32 v83, 0xffff0000, v25
    v_and_b32 v85, 0xffff0000, v26
    v_and_b32 v87, 0xffff0000, v27
    v_pk_add_f32 v[80:81], v[80:81], v[144:145]
    v_pk_add_f32 v[82:83], v[82:83], v[146:147]
    v_pk_add_f32 v[84:85], v[84:85], v[148:149]
    v_pk_add_f32 v[86:87], v[86:87], v[150:151]
    v_cvt_pk_bf16_f32 v24, v80, v81
    v_cvt_pk_bf16_f32 v25, v82, v83
    v_cvt_pk_bf16_f32 v26, v84, v85
    v_cvt_pk_bf16_f32 v27, v86, v87
    v_lshlrev_b32 v80, 16, v24
    v_lshlrev_b32 v82, 16, v25
    v_lshlrev_b32 v84, 16, v26
    v_lshlrev_b32 v86, 16, v27
    v_and_b32 v81, 0xffff0000, v24
    v_and_b32 v83, 0xffff0000, v25
    v_and_b32 v85, 0xffff0000, v26
    v_and_b32 v87, 0xffff0000, v27
    s_mov_b32 s32, 0x3408000
    buffer_store_dwordx4 v[24:27], v229, s[8:11], s32 offen sc1
    v_pk_add_f32 v[172:173], v[80:81], v[82:83]
    v_pk_mul_f32 v[174:175], v[80:81], v[80:81]
    v_pk_mul_f32 v[176:177], v[80:81], v[112:113]
    v_pk_fma_f32 v[174:175], v[82:83], v[82:83], v[174:175]
    v_pk_fma_f32 v[176:177], v[82:83], v[114:115], v[176:177]
    v_pk_add_f32 v[172:173], v[172:173], v[84:85]
    v_pk_fma_f32 v[174:175], v[84:85], v[84:85], v[174:175]
    v_pk_fma_f32 v[176:177], v[84:85], v[116:117], v[176:177]
    v_pk_add_f32 v[172:173], v[172:173], v[86:87]
    v_pk_fma_f32 v[174:175], v[86:87], v[86:87], v[174:175]
    v_pk_fma_f32 v[176:177], v[86:87], v[118:119], v[176:177]
    v_add_f32 v190, v172, v173
    v_add_f32 v191, v174, v175
    v_add_f32 v192, v176, v177
    s_waitcnt lgkmcnt(0)
    v_lshlrev_b32 v88, 16, v28
    v_lshlrev_b32 v90, 16, v29
    v_lshlrev_b32 v92, 16, v30
    v_lshlrev_b32 v94, 16, v31
    v_and_b32 v89, 0xffff0000, v28
    v_and_b32 v91, 0xffff0000, v29
    v_and_b32 v93, 0xffff0000, v30
    v_and_b32 v95, 0xffff0000, v31
    v_pk_add_f32 v[88:89], v[88:89], v[152:153]
    v_pk_add_f32 v[90:91], v[90:91], v[154:155]
    v_pk_add_f32 v[92:93], v[92:93], v[156:157]
    v_pk_add_f32 v[94:95], v[94:95], v[158:159]
    v_cvt_pk_bf16_f32 v28, v88, v89
    v_cvt_pk_bf16_f32 v29, v90, v91
    v_cvt_pk_bf16_f32 v30, v92, v93
    v_cvt_pk_bf16_f32 v31, v94, v95
    v_lshlrev_b32 v88, 16, v28
    v_lshlrev_b32 v90, 16, v29
    v_lshlrev_b32 v92, 16, v30
    v_lshlrev_b32 v94, 16, v31
    v_and_b32 v89, 0xffff0000, v28
    v_and_b32 v91, 0xffff0000, v29
    v_and_b32 v93, 0xffff0000, v30
    v_and_b32 v95, 0xffff0000, v31
    s_mov_b32 s32, 0x340c000
    buffer_store_dwordx4 v[28:31], v229, s[8:11], s32 offen sc1
    v_pk_add_f32 v[178:179], v[88:89], v[90:91]
    v_pk_mul_f32 v[180:181], v[88:89], v[88:89]
    v_pk_mul_f32 v[182:183], v[88:89], v[112:113]
    v_pk_fma_f32 v[180:181], v[90:91], v[90:91], v[180:181]
    v_pk_fma_f32 v[182:183], v[90:91], v[114:115], v[182:183]
    v_pk_add_f32 v[178:179], v[178:179], v[92:93]
    v_pk_fma_f32 v[180:181], v[92:93], v[92:93], v[180:181]
    v_pk_fma_f32 v[182:183], v[92:93], v[116:117], v[182:183]
    v_pk_add_f32 v[178:179], v[178:179], v[94:95]
    v_pk_fma_f32 v[180:181], v[94:95], v[94:95], v[180:181]
    v_pk_fma_f32 v[182:183], v[94:95], v[118:119], v[182:183]
    v_add_f32 v193, v178, v179
    v_add_f32 v194, v180, v181
    v_add_f32 v195, v182, v183
    v_add_f32_dpp v196, v196, v196 quad_perm:[1,0,3,2] row_mask:0xf bank_mask:0xf
    v_add_f32_dpp v184, v184, v184 quad_perm:[1,0,3,2] row_mask:0xf bank_mask:0xf
    v_add_f32_dpp v185, v185, v185 quad_perm:[1,0,3,2] row_mask:0xf bank_mask:0xf
    v_add_f32_dpp v186, v186, v186 quad_perm:[1,0,3,2] row_mask:0xf bank_mask:0xf
    v_add_f32_dpp v187, v187, v187 quad_perm:[1,0,3,2] row_mask:0xf bank_mask:0xf
    v_add_f32_dpp v188, v188, v188 quad_perm:[1,0,3,2] row_mask:0xf bank_mask:0xf
    v_add_f32_dpp v189, v189, v189 quad_perm:[1,0,3,2] row_mask:0xf bank_mask:0xf
    v_add_f32_dpp v190, v190, v190 quad_perm:[1,0,3,2] row_mask:0xf bank_mask:0xf
    v_add_f32_dpp v191, v191, v191 quad_perm:[1,0,3,2] row_mask:0xf bank_mask:0xf
    v_add_f32_dpp v192, v192, v192 quad_perm:[1,0,3,2] row_mask:0xf bank_mask:0xf
    v_add_f32_dpp v193, v193, v193 quad_perm:[1,0,3,2] row_mask:0xf bank_mask:0xf
    v_add_f32_dpp v194, v194, v194 quad_perm:[1,0,3,2] row_mask:0xf bank_mask:0xf
    v_add_f32_dpp v195, v195, v195 quad_perm:[1,0,3,2] row_mask:0xf bank_mask:0xf
    v_add_f32_dpp v196, v196, v196 quad_perm:[2,3,0,1] row_mask:0xf bank_mask:0xf
    v_add_f32_dpp v184, v184, v184 quad_perm:[2,3,0,1] row_mask:0xf bank_mask:0xf
    v_add_f32_dpp v185, v185, v185 quad_perm:[2,3,0,1] row_mask:0xf bank_mask:0xf
    v_add_f32_dpp v186, v186, v186 quad_perm:[2,3,0,1] row_mask:0xf bank_mask:0xf
    v_add_f32_dpp v187, v187, v187 quad_perm:[2,3,0,1] row_mask:0xf bank_mask:0xf
    v_add_f32_dpp v188, v188, v188 quad_perm:[2,3,0,1] row_mask:0xf bank_mask:0xf
    v_add_f32_dpp v189, v189, v189 quad_perm:[2,3,0,1] row_mask:0xf bank_mask:0xf
    v_add_f32_dpp v190, v190, v190 quad_perm:[2,3,0,1] row_mask:0xf bank_mask:0xf
    v_add_f32_dpp v191, v191, v191 quad_perm:[2,3,0,1] row_mask:0xf bank_mask:0xf
    v_add_f32_dpp v192, v192, v192 quad_perm:[2,3,0,1] row_mask:0xf bank_mask:0xf
    v_add_f32_dpp v193, v193, v193 quad_perm:[2,3,0,1] row_mask:0xf bank_mask:0xf
    v_add_f32_dpp v194, v194, v194 quad_perm:[2,3,0,1] row_mask:0xf bank_mask:0xf
    v_add_f32_dpp v195, v195, v195 quad_perm:[2,3,0,1] row_mask:0xf bank_mask:0xf
    v_add_f32_dpp v196, v196, v196 row_half_mirror row_mask:0xf bank_mask:0xf
    v_add_f32_dpp v184, v184, v184 row_half_mirror row_mask:0xf bank_mask:0xf
    v_add_f32_dpp v185, v185, v185 row_half_mirror row_mask:0xf bank_mask:0xf
    v_add_f32_dpp v186, v186, v186 row_half_mirror row_mask:0xf bank_mask:0xf
    v_add_f32_dpp v187, v187, v187 row_half_mirror row_mask:0xf bank_mask:0xf
    v_add_f32_dpp v188, v188, v188 row_half_mirror row_mask:0xf bank_mask:0xf
    v_add_f32_dpp v189, v189, v189 row_half_mirror row_mask:0xf bank_mask:0xf
    v_add_f32_dpp v190, v190, v190 row_half_mirror row_mask:0xf bank_mask:0xf
    v_add_f32_dpp v191, v191, v191 row_half_mirror row_mask:0xf bank_mask:0xf
    v_add_f32_dpp v192, v192, v192 row_half_mirror row_mask:0xf bank_mask:0xf
    v_add_f32_dpp v193, v193, v193 row_half_mirror row_mask:0xf bank_mask:0xf
    v_add_f32_dpp v194, v194, v194 row_half_mirror row_mask:0xf bank_mask:0xf
    v_add_f32_dpp v195, v195, v195 row_half_mirror row_mask:0xf bank_mask:0xf
    v_cndmask_b32 v184, v184, v187, s[60:61]
    v_cndmask_b32 v190, v190, v193, s[60:61]
    v_cndmask_b32 v185, v185, v188, s[60:61]
    v_cndmask_b32 v191, v191, v194, s[60:61]
    v_cndmask_b32 v186, v186, v189, s[60:61]
    v_cndmask_b32 v192, v192, v195, s[60:61]
    v_cndmask_b32 v184, v184, v190, s[62:63]
    v_cndmask_b32 v185, v185, v191, s[62:63]
    v_cndmask_b32 v186, v186, v192, s[62:63]
    v_cndmask_b32 v184, v184, v185, s[40:41]
    v_cndmask_b32 v186, v186, v196, s[40:41]
    buffer_atomic_add_f32 v184, v231, s[8:11], s48 offen
    buffer_atomic_add_f32 v186, v232, s[8:11], s48 offen
    s_lshl_b32 s32, s3, 13
    v_add_u32 v234, s32, v228
    v_add_u32 v235, 65536, v234
    ds_write_b128 v234, a[64:67] offset:0
    ds_write_b128 v234, a[68:71] offset:1024
    ds_write_b128 v234, a[72:75] offset:2048
    ds_write_b128 v234, a[76:79] offset:3072
    ds_write_b128 v234, a[80:83] offset:4096
    ds_write_b128 v234, a[84:87] offset:5120
    ds_write_b128 v234, a[88:91] offset:6144
    ds_write_b128 v234, a[92:95] offset:7168
    s_waitcnt lgkmcnt(4)
    ds_write_b128 v234, a[96:99] offset:32768
    ds_write_b128 v234, a[100:103] offset:33792
    ds_write_b128 v234, a[104:107] offset:34816
    ds_write_b128 v234, a[108:111] offset:35840
    ds_write_b128 v234, a[112:115] offset:36864
    ds_write_b128 v234, a[116:119] offset:37888
    ds_write_b128 v234, a[120:123] offset:38912
    ds_write_b128 v234, a[124:127] offset:39936
    s_waitcnt lgkmcnt(4)
    ds_write_b128 v235, a[128:131] offset:0
    ds_write_b128 v235, a[132:135] offset:1024
    ds_write_b128 v235, a[136:139] offset:2048
    ds_write_b128 v235, a[140:143] offset:3072
    ds_write_b128 v235, a[144:147] offset:4096
    ds_write_b128 v235, a[148:151] offset:5120
    ds_write_b128 v235, a[152:155] offset:6144
    ds_write_b128 v235, a[156:159] offset:7168
    s_waitcnt lgkmcnt(4)
    s_lshl_b32 s35, s3, 13
    v_bfe_u32 v234, v237, 2, 3
    v_lshrrev_b32 v235, 5, v237
    v_lshl_add_u32 v234, v235, 4, v234
    v_lshlrev_b32 v234, 5, v234
    v_and_b32 v236, 3, v237
    v_lshl_add_u32 v234, v236, 3, v234
    v_add_u32 v217, s35, v234
    v_lshlrev_b32 v235, 5, v235
    v_bfe_u32 v236, v237, 4, 1
    v_lshl_add_u32 v235, v236, 3, v235
    v_and_b32 v236, 1, v237
    v_lshl_add_u32 v235, v236, 11, v235
    s_lshl_b32 s32, s3, 9
    s_add_u32 s32, s32, 98304
    v_add_u32 v218, s32, v235
    v_lshlrev_b32 v234, 4, v230
    v_add_u32 v220, 106752, v234
    v_add_u32 v221, 106752, v228
    v_lshrrev_b32 v236, 2, v237
    v_lshlrev_b32 v236, 7, v236
    v_and_b32 v234, 3, v237
    v_lshl_add_u32 v236, v234, 3, v236
    s_add_u32 s32, s35, 65536
    v_add_u32 v219, s32, v236
    s_lshl_b32 s32, s3, 12
    s_add_u32 s32, s32, 114944
    v_and_b32 v234, 15, v237
    v_min_u32 v234, 2, v234
    v_lshlrev_b32 v234, 10, v234
    v_lshrrev_b32 v235, 4, v237
    v_lshl_add_u32 v234, v235, 4, v234
    v_add_u32 v222, s32, v234
    v_add_u32 v223, s32, v228
    s_cmp_eq_u32 s3, 0
    s_cbranch_scc1 kc_ch
    s_waitcnt vmcnt(0)
    s_barrier
    s_waitcnt lgkmcnt(0)
    s_branch kc_com
kc_ch:
    s_waitcnt vmcnt(0)
    s_barrier
    s_lshl_b32 s32, s52, 7
    s_add_u32 s32, s32, 0x3840000
    v_mov_b32 v235, 1
    buffer_atomic_add v235, v243, s[8:11], s32 offen sc0 sc1
    v_lshlrev_b32 v234, 7, v237
    v_cmp_gt_u32 vcc, 8, v237
    v_mov_b32 v236, 0x40000000
    s_mov_b32 s34, 0x3840400
    v_cndmask_b32 v234, v236, v234, vcc
    s_waitcnt vmcnt(0)
    v_readfirstlane_b32 s36, v235
    s_cmp_lg_u32 s36, 31
    s_cbranch_scc1 kc_a1
    buffer_atomic_add v233, v234, s[8:11], s34 offen sc1
kc_a1:
    v_mov_b32 v130, 0x3a800000
    v_mov_b32 v131, 0x3a800000
    v_mov_b32 v132, 0x3727c5ac
    v_mov_b32 v133, 0x3727c5ac
    s_mov_b32 s33, 0xfffff800
    s_lshl_b32 s32, s52, 7
    s_add_u32 s32, s32, 0x3840400
    s_mov_b32 s34, 0x400000
    s_branch kc_b11
kc_b10:
    s_sleep 2
kc_b11:
    buffer_load_dword v235, off, s[8:11], s32 sc1
    s_waitcnt vmcnt(0)
    v_cmp_ne_u32 vcc, 8, v235
    s_sub_u32 s34, s34, 1
    s_cbranch_scc1 kc_b12
    s_cbranch_vccnz kc_b10
kc_b12:
    s_add_u32 s32, s48, 24576
    buffer_load_dword v128, off, s[8:11], s32 sc1
    buffer_load_dwordx4 v[32:35], v228, s[8:11], s48 offen offset:0 sc1
    buffer_load_dwordx4 v[64:67], v228, s[8:11], s49 offen offset:0 sc1
    buffer_load_dwordx4 v[96:99], v228, s[8:11], s50 offen offset:0 sc1
    buffer_load_dwordx4 v[36:39], v228, s[8:11], s48 offen offset:1024 sc1
    buffer_load_dwordx4 v[68:71], v228, s[8:11], s49 offen offset:1024 sc1
    buffer_load_dwordx4 v[100:103], v228, s[8:11], s50 offen offset:1024 sc1
    buffer_load_dwordx4 v[40:43], v228, s[8:11], s48 offen offset:2048 sc1
    buffer_load_dwordx4 v[72:75], v228, s[8:11], s49 offen offset:2048 sc1
    buffer_load_dwordx4 v[104:107], v228, s[8:11], s50 offen offset:2048 sc1
    buffer_load_dwordx4 v[44:47], v228, s[8:11], s48 offen offset:3072 sc1
    buffer_load_dwordx4 v[76:79], v228, s[8:11], s49 offen offset:3072 sc1
    buffer_load_dwordx4 v[108:111], v228, s[8:11], s50 offen offset:3072 sc1
    s_add_u32 s48, s48, 4096
    buffer_load_dwordx4 v[48:51], v228, s[8:11], s48 offen offset:0 sc1
    s_add_u32 s49, s49, 4096
    buffer_load_dwordx4 v[80:83], v228, s[8:11], s49 offen offset:0 sc1
    s_add_u32 s50, s50, 4096
    buffer_load_dwordx4 v[112:115], v228, s[8:11], s50 offen offset:0 sc1
    buffer_load_dwordx4 v[52:55], v228, s[8:11], s48 offen offset:1024 sc1
    buffer_load_dwordx4 v[84:87], v228, s[8:11], s49 offen offset:1024 sc1
    buffer_load_dwordx4 v[116:119], v228, s[8:11], s50 offen offset:1024 sc1
    buffer_load_dwordx4 v[56:59], v228, s[8:11], s48 offen offset:2048 sc1
    buffer_load_dwordx4 v[88:91], v228, s[8:11], s49 offen offset:2048 sc1
    buffer_load_dwordx4 v[120:123], v228, s[8:11], s50 offen offset:2048 sc1
    buffer_load_dwordx4 v[60:63], v228, s[8:11], s48 offen offset:3072 sc1
    buffer_load_dwordx4 v[92:95], v228, s[8:11], s49 offen offset:3072 sc1
    buffer_load_dwordx4 v[124:127], v228, s[8:11], s50 offen offset:3072 sc1
    s_sub_u32 s48, s48, 4096
    s_sub_u32 s49, s49, 4096
    s_sub_u32 s50, s50, 4096
    s_waitcnt vmcnt(21)
    v_mov_b32 v129, v128
    v_pk_mul_f32 v[32:33], v[32:33], v[130:131]
    v_pk_mul_f32 v[34:35], v[34:35], v[130:131]
    v_pk_fma_f32 v[64:65], v[64:65], v[130:131], v[132:133]
    v_pk_fma_f32 v[66:67], v[66:67], v[130:131], v[132:133]
    v_pk_fma_f32 v[64:65], v[32:33], v[32:33], v[64:65] neg_lo:[1,0,0] neg_hi:[1,0,0]
    v_pk_fma_f32 v[66:67], v[34:35], v[34:35], v[66:67] neg_lo:[1,0,0] neg_hi:[1,0,0]
    v_pk_fma_f32 v[96:97], v[32:33], v[128:129], v[96:97] neg_lo:[1,0,0] neg_hi:[1,0,0]
    v_pk_fma_f32 v[98:99], v[34:35], v[128:129], v[98:99] neg_lo:[1,0,0] neg_hi:[1,0,0]
    v_max_f32 v64, v64, v132
    v_max_f32 v66, v66, v132
    v_max_f32 v65, v65, v132
    v_max_f32 v67, v67, v132
    v_rsq_f32 v64, v64
    v_rsq_f32 v66, v66
    v_rsq_f32 v65, v65
    v_rsq_f32 v67, v67
    v_pk_mul_f32 v[96:97], v[96:97], v[64:65]
    v_pk_mul_f32 v[98:99], v[98:99], v[66:67]
    v_and_or_b32 v96, v96, s33, 0
    v_and_or_b32 v98, v98, s33, 2
    v_and_or_b32 v97, v97, s33, 1
    v_and_or_b32 v99, v99, s33, 3
    v_max_f32 v136, v96, v97
    v_min_f32 v137, v96, v97
    v_med3_f32 v137, v136, v98, v137
    v_max_f32 v136, v136, v98
    v_med3_f32 v137, v136, v99, v137
    v_max_f32 v136, v136, v99
    s_waitcnt vmcnt(18)
    v_pk_mul_f32 v[36:37], v[36:37], v[130:131]
    v_pk_mul_f32 v[38:39], v[38:39], v[130:131]
    v_pk_fma_f32 v[68:69], v[68:69], v[130:131], v[132:133]
    v_pk_fma_f32 v[70:71], v[70:71], v[130:131], v[132:133]
    v_pk_fma_f32 v[68:69], v[36:37], v[36:37], v[68:69] neg_lo:[1,0,0] neg_hi:[1,0,0]
    v_pk_fma_f32 v[70:71], v[38:39], v[38:39], v[70:71] neg_lo:[1,0,0] neg_hi:[1,0,0]
    v_pk_fma_f32 v[100:101], v[36:37], v[128:129], v[100:101] neg_lo:[1,0,0] neg_hi:[1,0,0]
    v_pk_fma_f32 v[102:103], v[38:39], v[128:129], v[102:103] neg_lo:[1,0,0] neg_hi:[1,0,0]
    v_max_f32 v68, v68, v132
    v_max_f32 v70, v70, v132
    v_max_f32 v69, v69, v132
    v_max_f32 v71, v71, v132
    v_rsq_f32 v68, v68
    v_rsq_f32 v70, v70
    v_rsq_f32 v69, v69
    v_rsq_f32 v71, v71
    v_pk_mul_f32 v[100:101], v[100:101], v[68:69]
    v_pk_mul_f32 v[102:103], v[102:103], v[70:71]
    v_and_or_b32 v100, v100, s33, 4
    v_and_or_b32 v102, v102, s33, 6
    v_and_or_b32 v101, v101, s33, 5
    v_and_or_b32 v103, v103, s33, 7
    v_med3_f32 v137, v136, v100, v137
    v_max_f32 v136, v136, v100
    v_med3_f32 v137, v136, v101, v137
    v_max_f32 v136, v136, v101
    v_med3_f32 v137, v136, v102, v137
    v_max_f32 v136, v136, v102
    v_med3_f32 v137, v136, v103, v137
    v_max_f32 v136, v136, v103
    s_waitcnt vmcnt(15)
    v_pk_mul_f32 v[40:41], v[40:41], v[130:131]
    v_pk_mul_f32 v[42:43], v[42:43], v[130:131]
    v_pk_fma_f32 v[72:73], v[72:73], v[130:131], v[132:133]
    v_pk_fma_f32 v[74:75], v[74:75], v[130:131], v[132:133]
    v_pk_fma_f32 v[72:73], v[40:41], v[40:41], v[72:73] neg_lo:[1,0,0] neg_hi:[1,0,0]
    v_pk_fma_f32 v[74:75], v[42:43], v[42:43], v[74:75] neg_lo:[1,0,0] neg_hi:[1,0,0]
    v_pk_fma_f32 v[104:105], v[40:41], v[128:129], v[104:105] neg_lo:[1,0,0] neg_hi:[1,0,0]
    v_pk_fma_f32 v[106:107], v[42:43], v[128:129], v[106:107] neg_lo:[1,0,0] neg_hi:[1,0,0]
    v_max_f32 v72, v72, v132
    v_max_f32 v74, v74, v132
    v_max_f32 v73, v73, v132
    v_max_f32 v75, v75, v132
    v_rsq_f32 v72, v72
    v_rsq_f32 v74, v74
    v_rsq_f32 v73, v73
    v_rsq_f32 v75, v75
    v_pk_mul_f32 v[104:105], v[104:105], v[72:73]
    v_pk_mul_f32 v[106:107], v[106:107], v[74:75]
    v_and_or_b32 v104, v104, s33, 8
    v_and_or_b32 v106, v106, s33, 10
    v_and_or_b32 v105, v105, s33, 9
    v_and_or_b32 v107, v107, s33, 11
    v_med3_f32 v137, v136, v104, v137
    v_max_f32 v136, v136, v104
    v_med3_f32 v137, v136, v105, v137
    v_max_f32 v136, v136, v105
    v_med3_f32 v137, v136, v106, v137
    v_max_f32 v136, v136, v106
    v_med3_f32 v137, v136, v107, v137
    v_max_f32 v136, v136, v107
    s_waitcnt vmcnt(12)
    v_pk_mul_f32 v[44:45], v[44:45], v[130:131]
    v_pk_mul_f32 v[46:47], v[46:47], v[130:131]
    v_pk_fma_f32 v[76:77], v[76:77], v[130:131], v[132:133]
    v_pk_fma_f32 v[78:79], v[78:79], v[130:131], v[132:133]
    v_pk_fma_f32 v[76:77], v[44:45], v[44:45], v[76:77] neg_lo:[1,0,0] neg_hi:[1,0,0]
    v_pk_fma_f32 v[78:79], v[46:47], v[46:47], v[78:79] neg_lo:[1,0,0] neg_hi:[1,0,0]
    v_pk_fma_f32 v[108:109], v[44:45], v[128:129], v[108:109] neg_lo:[1,0,0] neg_hi:[1,0,0]
    v_pk_fma_f32 v[110:111], v[46:47], v[128:129], v[110:111] neg_lo:[1,0,0] neg_hi:[1,0,0]
    v_max_f32 v76, v76, v132
    v_max_f32 v78, v78, v132
    v_max_f32 v77, v77, v132
    v_max_f32 v79, v79, v132
    v_rsq_f32 v76, v76
    v_rsq_f32 v78, v78
    v_rsq_f32 v77, v77
    v_rsq_f32 v79, v79
    v_pk_mul_f32 v[108:109], v[108:109], v[76:77]
    v_pk_mul_f32 v[110:111], v[110:111], v[78:79]
    v_and_or_b32 v108, v108, s33, 12
    v_and_or_b32 v110, v110, s33, 14
    v_and_or_b32 v109, v109, s33, 13
    v_and_or_b32 v111, v111, s33, 15
    v_med3_f32 v137, v136, v108, v137
    v_max_f32 v136, v136, v108
    v_med3_f32 v137, v136, v109, v137
    v_max_f32 v136, v136, v109
    v_med3_f32 v137, v136, v110, v137
    v_max_f32 v136, v136, v110
    v_med3_f32 v137, v136, v111, v137
    v_max_f32 v136, v136, v111
    s_waitcnt vmcnt(9)
    v_pk_mul_f32 v[48:49], v[48:49], v[130:131]
    v_pk_mul_f32 v[50:51], v[50:51], v[130:131]
    v_pk_fma_f32 v[80:81], v[80:81], v[130:131], v[132:133]
    v_pk_fma_f32 v[82:83], v[82:83], v[130:131], v[132:133]
    v_pk_fma_f32 v[80:81], v[48:49], v[48:49], v[80:81] neg_lo:[1,0,0] neg_hi:[1,0,0]
    v_pk_fma_f32 v[82:83], v[50:51], v[50:51], v[82:83] neg_lo:[1,0,0] neg_hi:[1,0,0]
    v_pk_fma_f32 v[112:113], v[48:49], v[128:129], v[112:113] neg_lo:[1,0,0] neg_hi:[1,0,0]
    v_pk_fma_f32 v[114:115], v[50:51], v[128:129], v[114:115] neg_lo:[1,0,0] neg_hi:[1,0,0]
    v_max_f32 v80, v80, v132
    v_max_f32 v82, v82, v132
    v_max_f32 v81, v81, v132
    v_max_f32 v83, v83, v132
    v_rsq_f32 v80, v80
    v_rsq_f32 v82, v82
    v_rsq_f32 v81, v81
    v_rsq_f32 v83, v83
    v_pk_mul_f32 v[112:113], v[112:113], v[80:81]
    v_pk_mul_f32 v[114:115], v[114:115], v[82:83]
    v_and_or_b32 v112, v112, s33, 16
    v_and_or_b32 v114, v114, s33, 18
    v_and_or_b32 v113, v113, s33, 17
    v_and_or_b32 v115, v115, s33, 19
    v_med3_f32 v137, v136, v112, v137
    v_max_f32 v136, v136, v112
    v_med3_f32 v137, v136, v113, v137
    v_max_f32 v136, v136, v113
    v_med3_f32 v137, v136, v114, v137
    v_max_f32 v136, v136, v114
    v_med3_f32 v137, v136, v115, v137
    v_max_f32 v136, v136, v115
    s_waitcnt vmcnt(6)
    v_pk_mul_f32 v[52:53], v[52:53], v[130:131]
    v_pk_mul_f32 v[54:55], v[54:55], v[130:131]
    v_pk_fma_f32 v[84:85], v[84:85], v[130:131], v[132:133]
    v_pk_fma_f32 v[86:87], v[86:87], v[130:131], v[132:133]
    v_pk_fma_f32 v[84:85], v[52:53], v[52:53], v[84:85] neg_lo:[1,0,0] neg_hi:[1,0,0]
    v_pk_fma_f32 v[86:87], v[54:55], v[54:55], v[86:87] neg_lo:[1,0,0] neg_hi:[1,0,0]
    v_pk_fma_f32 v[116:117], v[52:53], v[128:129], v[116:117] neg_lo:[1,0,0] neg_hi:[1,0,0]
    v_pk_fma_f32 v[118:119], v[54:55], v[128:129], v[118:119] neg_lo:[1,0,0] neg_hi:[1,0,0]
    v_max_f32 v84, v84, v132
    v_max_f32 v86, v86, v132
    v_max_f32 v85, v85, v132
    v_max_f32 v87, v87, v132
    v_rsq_f32 v84, v84
    v_rsq_f32 v86, v86
    v_rsq_f32 v85, v85
    v_rsq_f32 v87, v87
    v_pk_mul_f32 v[116:117], v[116:117], v[84:85]
    v_pk_mul_f32 v[118:119], v[118:119], v[86:87]
    v_and_or_b32 v116, v116, s33, 20
    v_and_or_b32 v118, v118, s33, 22
    v_and_or_b32 v117, v117, s33, 21
    v_and_or_b32 v119, v119, s33, 23
    v_med3_f32 v137, v136, v116, v137
    v_max_f32 v136, v136, v116
    v_med3_f32 v137, v136, v117, v137
    v_max_f32 v136, v136, v117
    v_med3_f32 v137, v136, v118, v137
    v_max_f32 v136, v136, v118
    v_med3_f32 v137, v136, v119, v137
    v_max_f32 v136, v136, v119
    s_waitcnt vmcnt(3)
    v_pk_mul_f32 v[56:57], v[56:57], v[130:131]
    v_pk_mul_f32 v[58:59], v[58:59], v[130:131]
    v_pk_fma_f32 v[88:89], v[88:89], v[130:131], v[132:133]
    v_pk_fma_f32 v[90:91], v[90:91], v[130:131], v[132:133]
    v_pk_fma_f32 v[88:89], v[56:57], v[56:57], v[88:89] neg_lo:[1,0,0] neg_hi:[1,0,0]
    v_pk_fma_f32 v[90:91], v[58:59], v[58:59], v[90:91] neg_lo:[1,0,0] neg_hi:[1,0,0]
    v_pk_fma_f32 v[120:121], v[56:57], v[128:129], v[120:121] neg_lo:[1,0,0] neg_hi:[1,0,0]
    v_pk_fma_f32 v[122:123], v[58:59], v[128:129], v[122:123] neg_lo:[1,0,0] neg_hi:[1,0,0]
    v_max_f32 v88, v88, v132
    v_max_f32 v90, v90, v132
    v_max_f32 v89, v89, v132
    v_max_f32 v91, v91, v132
    v_rsq_f32 v88, v88
    v_rsq_f32 v90, v90
    v_rsq_f32 v89, v89
    v_rsq_f32 v91, v91
    v_pk_mul_f32 v[120:121], v[120:121], v[88:89]
    v_pk_mul_f32 v[122:123], v[122:123], v[90:91]
    v_and_or_b32 v120, v120, s33, 24
    v_and_or_b32 v122, v122, s33, 26
    v_and_or_b32 v121, v121, s33, 25
    v_and_or_b32 v123, v123, s33, 27
    v_med3_f32 v137, v136, v120, v137
    v_max_f32 v136, v136, v120
    v_med3_f32 v137, v136, v121, v137
    v_max_f32 v136, v136, v121
    v_med3_f32 v137, v136, v122, v137
    v_max_f32 v136, v136, v122
    v_med3_f32 v137, v136, v123, v137
    v_max_f32 v136, v136, v123
    s_waitcnt vmcnt(0)
    v_pk_mul_f32 v[60:61], v[60:61], v[130:131]
    v_pk_mul_f32 v[62:63], v[62:63], v[130:131]
    v_pk_fma_f32 v[92:93], v[92:93], v[130:131], v[132:133]
    v_pk_fma_f32 v[94:95], v[94:95], v[130:131], v[132:133]
    v_pk_fma_f32 v[92:93], v[60:61], v[60:61], v[92:93] neg_lo:[1,0,0] neg_hi:[1,0,0]
    v_pk_fma_f32 v[94:95], v[62:63], v[62:63], v[94:95] neg_lo:[1,0,0] neg_hi:[1,0,0]
    v_pk_fma_f32 v[124:125], v[60:61], v[128:129], v[124:125] neg_lo:[1,0,0] neg_hi:[1,0,0]
    v_pk_fma_f32 v[126:127], v[62:63], v[128:129], v[126:127] neg_lo:[1,0,0] neg_hi:[1,0,0]
    v_max_f32 v92, v92, v132
    v_max_f32 v94, v94, v132
    v_max_f32 v93, v93, v132
    v_max_f32 v95, v95, v132
    v_rsq_f32 v92, v92
    v_rsq_f32 v94, v94
    v_rsq_f32 v93, v93
    v_rsq_f32 v95, v95
    v_pk_mul_f32 v[124:125], v[124:125], v[92:93]
    v_pk_mul_f32 v[126:127], v[126:127], v[94:95]
    v_and_or_b32 v124, v124, s33, 28
    v_and_or_b32 v126, v126, s33, 30
    v_and_or_b32 v125, v125, s33, 29
    v_and_or_b32 v127, v127, s33, 31
    v_med3_f32 v137, v136, v124, v137
    v_max_f32 v136, v136, v124
    v_med3_f32 v137, v136, v125, v137
    v_max_f32 v136, v136, v125
    v_med3_f32 v137, v136, v126, v137
    v_max_f32 v136, v136, v126
    v_med3_f32 v137, v136, v127, v137
    v_max_f32 v136, v136, v127
    v_lshl_or_b32 v136, v237, 5, v136
    v_lshl_or_b32 v137, v237, 5, v137
    s_nop 1
    v_mov_b32_dpp v138, v136 quad_perm:[1,0,3,2] row_mask:0xf bank_mask:0xf
    v_mov_b32_dpp v139, v137 quad_perm:[1,0,3,2] row_mask:0xf bank_mask:0xf
    v_min_f32 v140, v136, v138
    v_max_f32 v136, v136, v138
    v_max3_f32 v137, v140, v137, v139
    s_nop 1
    v_mov_b32_dpp v138, v136 quad_perm:[2,3,0,1] row_mask:0xf bank_mask:0xf
    v_mov_b32_dpp v139, v137 quad_perm:[2,3,0,1] row_mask:0xf bank_mask:0xf
    v_min_f32 v140, v136, v138
    v_max_f32 v136, v136, v138
    v_max3_f32 v137, v140, v137, v139
    s_nop 1
    v_mov_b32_dpp v138, v136 row_half_mirror row_mask:0xf bank_mask:0xf
    v_mov_b32_dpp v139, v137 row_half_mirror row_mask:0xf bank_mask:0xf
    v_min_f32 v140, v136, v138
    v_max_f32 v136, v136, v138
    v_max3_f32 v137, v140, v137, v139
    s_nop 1
    v_mov_b32_dpp v138, v136 row_mirror row_mask:0xf bank_mask:0xf
    v_mov_b32_dpp v139, v137 row_mirror row_mask:0xf bank_mask:0xf
    v_min_f32 v140, v136, v138
    v_max_f32 v136, v136, v138
    v_max3_f32 v137, v140, v137, v139
    v_mov_b32 v138, v136
    v_mov_b32 v139, v137
    s_nop 1
    v_permlane16_swap_b32 v136, v138
    v_permlane16_swap_b32 v137, v139
    s_nop 0
    v_min_f32 v140, v136, v138
    v_max_f32 v136, v136, v138
    v_max3_f32 v137, v140, v137, v139
    v_mov_b32 v138, v136
    v_mov_b32 v139, v137
    s_nop 1
    v_permlane32_swap_b32 v136, v138
    v_permlane32_swap_b32 v137, v139
    s_nop 0
    v_min_f32 v140, v136, v138
    v_max_f32 v136, v136, v138
    v_max3_f32 v137, v140, v137, v139
    v_cmp_gt_u32 vcc, 32, v237
    v_and_b32 v236, 31, v237
    s_nop 0
    v_cndmask_b32 v136, v137, v136, vcc
    v_bfe_u32 v234, v136, 5, 6
    v_bfe_u32 v235, v136, 2, 3
    v_and_b32 v142, 3, v136
    v_lshl_add_u32 v142, v234, 2, v142
    v_lshl_add_u32 v142, v235, 8, v142
    v_lshlrev_b32 v234, 2, v142
    v_lshlrev_b32 v235, 11, v142
    v_lshl_add_u32 v235, v236, 4, v235
    s_mov_b32 s32, 0x3400000
    buffer_load_dword v144, v234, s[8:11], s48 offen sc1
    buffer_load_dword v145, v234, s[8:11], s49 offen sc1
    buffer_load_dword v146, v234, s[8:11], s50 offen sc1
    buffer_load_dwordx4 v[32:35], v235, s[8:11], s32 offen offset:0 sc1
    buffer_load_dwordx4 v[36:39], v235, s[8:11], s32 offen offset:512 sc1
    buffer_load_dwordx4 v[40:43], v235, s[8:11], s32 offen offset:1024 sc1
    buffer_load_dwordx4 v[44:47], v235, s[8:11], s32 offen offset:1536 sc1
    v_lshrrev_b32 v234, 5, v237
    v_lshlrev_b32 v235, 11, v234
    v_lshl_add_u32 v235, v236, 4, v235
    v_add_u32 v235, 98304, v235
    v_lshlrev_b32 v234, 3, v234
    v_add_u32 v234, 106496, v234
    s_waitcnt vmcnt(4)
    v_mul_f32 v144, 0x3a800000, v144
    v_mul_f32 v145, 0x3a800000, v145
    v_fma_f32 v145, -v144, v144, v145
    v_max_f32 v145, 0, v145
    v_cvt_pk_bf16_f32 v140, v144, v145
    v_lshlrev_b32 v144, 16, v140
    v_and_b32 v145, 0xffff0000, v140
    v_add_f32 v145, 0x3727c5ac, v145
    v_cvt_pk_bf16_f32 v145, v145, v145
    v_lshlrev_b32 v145, 16, v145
    v_sqrt_f32 v145, v145
    s_nop 0
    v_cvt_pk_bf16_f32 v145, v145, v145
    v_lshlrev_b32 v145, 16, v145
    v_rcp_f32 v145, v145
    s_nop 0
    v_fma_f32 v143, -v144, v128, v146
    v_mul_f32 v143, v143, v145
    v_cvt_pk_bf16_f32 v143, v143, v143
    v_lshlrev_b32 v143, 16, v143
    v_mul_f32 v143, 0xbfb8aa3b, v143
    v_exp_f32 v143, v143
    s_nop 0
    v_add_f32 v143, 1.0, v143
    v_rcp_f32 v143, v143
    s_nop 0
    v_cvt_pk_bf16_f32 v143, v143, v143
    v_lshlrev_b32 v143, 16, v143
    ds_write_b64 v234, v[142:143]
    s_waitcnt vmcnt(3)
    v_lshlrev_b32 v64, 16, v32
    v_lshlrev_b32 v66, 16, v33
    v_lshlrev_b32 v68, 16, v34
    v_lshlrev_b32 v70, 16, v35
    v_and_b32 v65, 0xffff0000, v32
    v_and_b32 v67, 0xffff0000, v33
    v_and_b32 v69, 0xffff0000, v34
    v_and_b32 v71, 0xffff0000, v35
    v_sub_f32 v64, v64, v144
    v_sub_f32 v66, v66, v144
    v_sub_f32 v68, v68, v144
    v_sub_f32 v70, v70, v144
    v_sub_f32 v65, v65, v144
    v_sub_f32 v67, v67, v144
    v_sub_f32 v69, v69, v144
    v_sub_f32 v71, v71, v144
    v_cvt_pk_bf16_f32 v65, v64, v65
    v_cvt_pk_bf16_f32 v67, v66, v67
    v_cvt_pk_bf16_f32 v69, v68, v69
    v_cvt_pk_bf16_f32 v71, v70, v71
    v_lshlrev_b32 v64, 16, v65
    v_lshlrev_b32 v66, 16, v67
    v_lshlrev_b32 v68, 16, v69
    v_lshlrev_b32 v70, 16, v71
    v_and_b32 v65, 0xffff0000, v65
    v_and_b32 v67, 0xffff0000, v67
    v_and_b32 v69, 0xffff0000, v69
    v_and_b32 v71, 0xffff0000, v71
    v_mul_f32 v64, v64, v145
    v_mul_f32 v66, v66, v145
    v_mul_f32 v68, v68, v145
    v_mul_f32 v70, v70, v145
    v_mul_f32 v65, v65, v145
    v_mul_f32 v67, v67, v145
    v_mul_f32 v69, v69, v145
    v_mul_f32 v71, v71, v145
    v_cvt_pk_bf16_f32 v48, v64, v65
    v_cvt_pk_bf16_f32 v49, v66, v67
    v_cvt_pk_bf16_f32 v50, v68, v69
    v_cvt_pk_bf16_f32 v51, v70, v71
    ds_write_b128 v235, v[48:51] offset:0
    ds_write_b128 v235, v[32:35] offset:4096
    s_waitcnt vmcnt(2)
    v_lshlrev_b32 v64, 16, v36
    v_lshlrev_b32 v66, 16, v37
    v_lshlrev_b32 v68, 16, v38
    v_lshlrev_b32 v70, 16, v39
    v_and_b32 v65, 0xffff0000, v36
    v_and_b32 v67, 0xffff0000, v37
    v_and_b32 v69, 0xffff0000, v38
    v_and_b32 v71, 0xffff0000, v39
    v_sub_f32 v64, v64, v144
    v_sub_f32 v66, v66, v144
    v_sub_f32 v68, v68, v144
    v_sub_f32 v70, v70, v144
    v_sub_f32 v65, v65, v144
    v_sub_f32 v67, v67, v144
    v_sub_f32 v69, v69, v144
    v_sub_f32 v71, v71, v144
    v_cvt_pk_bf16_f32 v65, v64, v65
    v_cvt_pk_bf16_f32 v67, v66, v67
    v_cvt_pk_bf16_f32 v69, v68, v69
    v_cvt_pk_bf16_f32 v71, v70, v71
    v_lshlrev_b32 v64, 16, v65
    v_lshlrev_b32 v66, 16, v67
    v_lshlrev_b32 v68, 16, v69
    v_lshlrev_b32 v70, 16, v71
    v_and_b32 v65, 0xffff0000, v65
    v_and_b32 v67, 0xffff0000, v67
    v_and_b32 v69, 0xffff0000, v69
    v_and_b32 v71, 0xffff0000, v71
    v_mul_f32 v64, v64, v145
    v_mul_f32 v66, v66, v145
    v_mul_f32 v68, v68, v145
    v_mul_f32 v70, v70, v145
    v_mul_f32 v65, v65, v145
    v_mul_f32 v67, v67, v145
    v_mul_f32 v69, v69, v145
    v_mul_f32 v71, v71, v145
    v_cvt_pk_bf16_f32 v52, v64, v65
    v_cvt_pk_bf16_f32 v53, v66, v67
    v_cvt_pk_bf16_f32 v54, v68, v69
    v_cvt_pk_bf16_f32 v55, v70, v71
    ds_write_b128 v235, v[52:55] offset:512
    ds_write_b128 v235, v[36:39] offset:4608
    s_waitcnt vmcnt(1)
    v_lshlrev_b32 v64, 16, v40
    v_lshlrev_b32 v66, 16, v41
    v_lshlrev_b32 v68, 16, v42
    v_lshlrev_b32 v70, 16, v43
    v_and_b32 v65, 0xffff0000, v40
    v_and_b32 v67, 0xffff0000, v41
    v_and_b32 v69, 0xffff0000, v42
    v_and_b32 v71, 0xffff0000, v43
    v_sub_f32 v64, v64, v144
    v_sub_f32 v66, v66, v144
    v_sub_f32 v68, v68, v144
    v_sub_f32 v70, v70, v144
    v_sub_f32 v65, v65, v144
    v_sub_f32 v67, v67, v144
    v_sub_f32 v69, v69, v144
    v_sub_f32 v71, v71, v144
    v_cvt_pk_bf16_f32 v65, v64, v65
    v_cvt_pk_bf16_f32 v67, v66, v67
    v_cvt_pk_bf16_f32 v69, v68, v69
    v_cvt_pk_bf16_f32 v71, v70, v71
    v_lshlrev_b32 v64, 16, v65
    v_lshlrev_b32 v66, 16, v67
    v_lshlrev_b32 v68, 16, v69
    v_lshlrev_b32 v70, 16, v71
    v_and_b32 v65, 0xffff0000, v65
    v_and_b32 v67, 0xffff0000, v67
    v_and_b32 v69, 0xffff0000, v69
    v_and_b32 v71, 0xffff0000, v71
    v_mul_f32 v64, v64, v145
    v_mul_f32 v66, v66, v145
    v_mul_f32 v68, v68, v145
    v_mul_f32 v70, v70, v145
    v_mul_f32 v65, v65, v145
    v_mul_f32 v67, v67, v145
    v_mul_f32 v69, v69, v145
    v_mul_f32 v71, v71, v145
    v_cvt_pk_bf16_f32 v56, v64, v65
    v_cvt_pk_bf16_f32 v57, v66, v67
    v_cvt_pk_bf16_f32 v58, v68, v69
    v_cvt_pk_bf16_f32 v59, v70, v71
    ds_write_b128 v235, v[56:59] offset:1024
    ds_write_b128 v235, v[40:43] offset:5120
    s_waitcnt vmcnt(0)
    v_lshlrev_b32 v64, 16, v44
    v_lshlrev_b32 v66, 16, v45
    v_lshlrev_b32 v68, 16, v46
    v_lshlrev_b32 v70, 16, v47
    v_and_b32 v65, 0xffff0000, v44
    v_and_b32 v67, 0xffff0000, v45
    v_and_b32 v69, 0xffff0000, v46
    v_and_b32 v71, 0xffff0000, v47
    v_sub_f32 v64, v64, v144
    v_sub_f32 v66, v66, v144
    v_sub_f32 v68, v68, v144
    v_sub_f32 v70, v70, v144
    v_sub_f32 v65, v65, v144
    v_sub_f32 v67, v67, v144
    v_sub_f32 v69, v69, v144
    v_sub_f32 v71, v71, v144
    v_cvt_pk_bf16_f32 v65, v64, v65
    v_cvt_pk_bf16_f32 v67, v66, v67
    v_cvt_pk_bf16_f32 v69, v68, v69
    v_cvt_pk_bf16_f32 v71, v70, v71
    v_lshlrev_b32 v64, 16, v65
    v_lshlrev_b32 v66, 16, v67
    v_lshlrev_b32 v68, 16, v69
    v_lshlrev_b32 v70, 16, v71
    v_and_b32 v65, 0xffff0000, v65
    v_and_b32 v67, 0xffff0000, v67
    v_and_b32 v69, 0xffff0000, v69
    v_and_b32 v71, 0xffff0000, v71
    v_mul_f32 v64, v64, v145
    v_mul_f32 v66, v66, v145
    v_mul_f32 v68, v68, v145
    v_mul_f32 v70, v70, v145
    v_mul_f32 v65, v65, v145
    v_mul_f32 v67, v67, v145
    v_mul_f32 v69, v69, v145
    v_mul_f32 v71, v71, v145
    v_cvt_pk_bf16_f32 v60, v64, v65
    v_cvt_pk_bf16_f32 v61, v66, v67
    v_cvt_pk_bf16_f32 v62, v68, v69
    v_cvt_pk_bf16_f32 v63, v70, v71
    ds_write_b128 v235, v[60:63] offset:1536
    ds_write_b128 v235, v[44:47] offset:5632
    s_waitcnt lgkmcnt(0)
kc_com:
    s_barrier
    v_lshlrev_b32 v234, 2, v242
    v_mov_b32 v235, 106496
    ds_read_b128 v[8:11], v235
    buffer_load_dword v0, v234, s[8:11], s48 offen offset:0 sc1
    buffer_load_dword v4, v234, s[8:11], s49 offen offset:0 sc1
    buffer_load_dword v1, v234, s[8:11], s48 offen offset:32 sc1
    buffer_load_dword v5, v234, s[8:11], s49 offen offset:32 sc1
    buffer_load_dword v2, v234, s[8:11], s48 offen offset:64 sc1
    buffer_load_dword v6, v234, s[8:11], s49 offen offset:64 sc1
    buffer_load_dword v3, v234, s[8:11], s48 offen offset:96 sc1
    buffer_load_dword v7, v234, s[8:11], s49 offen offset:96 sc1
    s_cmp_ge_u32 s53, 28
    s_cbranch_scc1 kc_red
    ds_read_b64 v[96:97], v218 offset:0
    ds_read_b64 v[98:99], v218 offset:16
    ds_read_b64_tr_b16 v[32:33], v217 offset:0
    ds_read_b64_tr_b16 v[34:35], v217 offset:256
    ds_read_b64_tr_b16 v[64:65], v217 offset:32768
    ds_read_b64_tr_b16 v[66:67], v217 offset:33024
    ds_read_b64 v[100:101], v218 offset:64
    ds_read_b64 v[102:103], v218 offset:80
    ds_read_b64_tr_b16 v[36:37], v217 offset:1024
    ds_read_b64_tr_b16 v[38:39], v217 offset:1280
    ds_read_b64_tr_b16 v[68:69], v217 offset:33792
    ds_read_b64_tr_b16 v[70:71], v217 offset:34048
    s_waitcnt lgkmcnt(6)
    ds_read_b64 v[104:105], v218 offset:128
    ds_read_b64 v[106:107], v218 offset:144
    ds_read_b64_tr_b16 v[40:41], v217 offset:2048
    ds_read_b64_tr_b16 v[42:43], v217 offset:2304
    ds_read_b64_tr_b16 v[72:73], v217 offset:34816
    ds_read_b64_tr_b16 v[74:75], v217 offset:35072
    v_mfma_f32_16x16x32_bf16 v[128:131], v[32:35], v[96:99], 0
    v_mfma_f32_16x16x32_bf16 v[132:135], v[64:67], v[96:99], 0
    s_waitcnt lgkmcnt(6)
    ds_read_b64 v[108:109], v218 offset:192
    ds_read_b64 v[110:111], v218 offset:208
    ds_read_b64_tr_b16 v[44:45], v217 offset:3072
    ds_read_b64_tr_b16 v[46:47], v217 offset:3328
    ds_read_b64_tr_b16 v[76:77], v217 offset:35840
    ds_read_b64_tr_b16 v[78:79], v217 offset:36096
    v_mfma_f32_16x16x32_bf16 v[128:131], v[36:39], v[100:103], v[128:131]
    v_mfma_f32_16x16x32_bf16 v[132:135], v[68:71], v[100:103], v[132:135]
    s_waitcnt lgkmcnt(6)
    ds_read_b64 v[112:113], v218 offset:256
    ds_read_b64 v[114:115], v218 offset:272
    ds_read_b64_tr_b16 v[48:49], v217 offset:4096
    ds_read_b64_tr_b16 v[50:51], v217 offset:4352
    ds_read_b64_tr_b16 v[80:81], v217 offset:36864
    ds_read_b64_tr_b16 v[82:83], v217 offset:37120
    v_mfma_f32_16x16x32_bf16 v[128:131], v[40:43], v[104:107], v[128:131]
    v_mfma_f32_16x16x32_bf16 v[132:135], v[72:75], v[104:107], v[132:135]
    s_waitcnt lgkmcnt(6)
    ds_read_b64 v[116:117], v218 offset:320
    ds_read_b64 v[118:119], v218 offset:336
    ds_read_b64_tr_b16 v[52:53], v217 offset:5120
    ds_read_b64_tr_b16 v[54:55], v217 offset:5376
    ds_read_b64_tr_b16 v[84:85], v217 offset:37888
    ds_read_b64_tr_b16 v[86:87], v217 offset:38144
    v_mfma_f32_16x16x32_bf16 v[128:131], v[44:47], v[108:111], v[128:131]
    v_mfma_f32_16x16x32_bf16 v[132:135], v[76:79], v[108:111], v[132:135]
    s_waitcnt lgkmcnt(6)
    ds_read_b64 v[120:121], v218 offset:384
    ds_read_b64 v[122:123], v218 offset:400
    ds_read_b64_tr_b16 v[56:57], v217 offset:6144
    ds_read_b64_tr_b16 v[58:59], v217 offset:6400
    ds_read_b64_tr_b16 v[88:89], v217 offset:38912
    ds_read_b64_tr_b16 v[90:91], v217 offset:39168
    v_mfma_f32_16x16x32_bf16 v[128:131], v[48:51], v[112:115], v[128:131]
    v_mfma_f32_16x16x32_bf16 v[132:135], v[80:83], v[112:115], v[132:135]
    s_waitcnt lgkmcnt(6)
    ds_read_b64 v[124:125], v218 offset:448
    ds_read_b64 v[126:127], v218 offset:464
    ds_read_b64_tr_b16 v[60:61], v217 offset:7168
    ds_read_b64_tr_b16 v[62:63], v217 offset:7424
    ds_read_b64_tr_b16 v[92:93], v217 offset:39936
    ds_read_b64_tr_b16 v[94:95], v217 offset:40192
    v_mfma_f32_16x16x32_bf16 v[128:131], v[52:55], v[116:119], v[128:131]
    v_mfma_f32_16x16x32_bf16 v[132:135], v[84:87], v[116:119], v[132:135]
    s_waitcnt lgkmcnt(6)
    v_mfma_f32_16x16x32_bf16 v[128:131], v[56:59], v[120:123], v[128:131]
    v_mfma_f32_16x16x32_bf16 v[132:135], v[88:91], v[120:123], v[132:135]
    s_waitcnt lgkmcnt(0)
    v_mfma_f32_16x16x32_bf16 v[128:131], v[60:63], v[124:127], v[128:131]
    v_mfma_f32_16x16x32_bf16 v[132:135], v[92:95], v[124:127], v[132:135]
    ds_read_b64_tr_b16 v[164:165], v219 offset:0
    ds_read_b64_tr_b16 v[166:167], v219 offset:32
    ds_read_b64_tr_b16 v[168:169], v219 offset:64
    ds_read_b64_tr_b16 v[170:171], v219 offset:96
    ds_read_b64_tr_b16 v[172:173], v219 offset:2048
    ds_read_b64_tr_b16 v[174:175], v219 offset:2080
    ds_read_b64_tr_b16 v[176:177], v219 offset:2112
    ds_read_b64_tr_b16 v[178:179], v219 offset:2144
    ds_write_b128 v220, v[128:131]
    ds_write_b128 v220, v[132:135] offset:4096
    s_waitcnt lgkmcnt(0)
    s_barrier
    ds_read_b128 v[32:35], v221 offset:0
    ds_read_b128 v[48:51], v221 offset:4096
    ds_read_b128 v[36:39], v221 offset:1024
    ds_read_b128 v[52:55], v221 offset:5120
    ds_read_b128 v[40:43], v221 offset:2048
    ds_read_b128 v[56:59], v221 offset:6144
    ds_read_b128 v[44:47], v221 offset:3072
    ds_read_b128 v[60:63], v221 offset:7168
    ds_read_b64_tr_b16 v[180:181], v219 offset:4096
    ds_read_b64_tr_b16 v[182:183], v219 offset:4128
    ds_read_b64_tr_b16 v[184:185], v219 offset:4160
    ds_read_b64_tr_b16 v[186:187], v219 offset:4192
    ds_read_b64_tr_b16 v[188:189], v219 offset:6144
    ds_read_b64_tr_b16 v[190:191], v219 offset:6176
    s_waitcnt lgkmcnt(6)
    ds_read_b64_tr_b16 v[192:193], v219 offset:6208
    ds_read_b64_tr_b16 v[194:195], v219 offset:6240
    v_add_f32 v32, v32, v36
    v_add_f32 v33, v33, v37
    v_add_f32 v34, v34, v38
    v_add_f32 v35, v35, v39
    v_add_f32 v40, v40, v44
    v_add_f32 v41, v41, v45
    v_add_f32 v42, v42, v46
    v_add_f32 v43, v43, v47
    v_add_f32 v48, v48, v52
    v_add_f32 v49, v49, v53
    v_add_f32 v50, v50, v54
    v_add_f32 v51, v51, v55
    v_add_f32 v56, v56, v60
    v_add_f32 v57, v57, v61
    v_add_f32 v58, v58, v62
    v_add_f32 v59, v59, v63
    v_add_f32 v32, v32, v40
    v_add_f32 v33, v33, v41
    v_add_f32 v34, v34, v42
    v_add_f32 v35, v35, v43
    v_add_f32 v48, v48, v56
    v_add_f32 v49, v49, v57
    v_add_f32 v50, v50, v58
    v_add_f32 v51, v51, v59
    v_cvt_pk_bf16_f32 v48, v32, v48
    v_cvt_pk_bf16_f32 v49, v33, v49
    v_cvt_pk_bf16_f32 v50, v34, v50
    v_cvt_pk_bf16_f32 v51, v35, v51
    v_lshlrev_b32 v32, 16, v48
    v_lshlrev_b32 v33, 16, v49
    v_lshlrev_b32 v34, 16, v50
    v_lshlrev_b32 v35, 16, v51
    v_and_b32 v48, 0xffff0000, v48
    v_and_b32 v49, 0xffff0000, v49
    v_and_b32 v50, 0xffff0000, v50
    v_and_b32 v51, 0xffff0000, v51
    v_mul_f32 v136, 0xbfb8aa3b, v32
    v_mul_f32 v137, 0xbfb8aa3b, v33
    v_mul_f32 v138, 0xbfb8aa3b, v34
    v_mul_f32 v139, 0xbfb8aa3b, v35
    v_exp_f32 v136, v136
    v_exp_f32 v137, v137
    v_exp_f32 v138, v138
    v_exp_f32 v139, v139
    v_add_f32 v136, 1.0, v136
    v_add_f32 v137, 1.0, v137
    v_add_f32 v138, 1.0, v138
    v_add_f32 v139, 1.0, v139
    v_rcp_f32 v136, v136
    v_rcp_f32 v137, v137
    v_rcp_f32 v138, v138
    v_rcp_f32 v139, v139
    v_mul_f32 v32, v32, v136
    v_mul_f32 v33, v33, v137
    v_mul_f32 v34, v34, v138
    v_mul_f32 v35, v35, v139
    v_cvt_pk_bf16_f32 v32, v32, v32
    v_cvt_pk_bf16_f32 v33, v33, v33
    v_cvt_pk_bf16_f32 v34, v34, v34
    v_cvt_pk_bf16_f32 v35, v35, v35
    v_lshlrev_b32 v32, 16, v32
    v_lshlrev_b32 v33, 16, v33
    v_lshlrev_b32 v34, 16, v34
    v_lshlrev_b32 v35, 16, v35
    v_mul_f32 v32, v32, v48
    v_mul_f32 v33, v33, v49
    v_mul_f32 v34, v34, v50
    v_mul_f32 v35, v35, v51
    v_cvt_pk_bf16_f32 v128, v32, v33
    v_cvt_pk_bf16_f32 v129, v34, v35
    s_waitcnt lgkmcnt(0)
    s_nop 0
    v_mfma_f32_16x16x16_bf16 v[64:67], v[164:165], v[128:129], 0
    v_mfma_f32_16x16x16_bf16 v[68:71], v[166:167], v[128:129], 0
    v_mfma_f32_16x16x16_bf16 v[72:75], v[168:169], v[128:129], 0
    v_mfma_f32_16x16x16_bf16 v[76:79], v[170:171], v[128:129], 0
    v_mfma_f32_16x16x16_bf16 v[80:83], v[172:173], v[128:129], 0
    v_mfma_f32_16x16x16_bf16 v[84:87], v[174:175], v[128:129], 0
    v_mfma_f32_16x16x16_bf16 v[88:91], v[176:177], v[128:129], 0
    v_mfma_f32_16x16x16_bf16 v[92:95], v[178:179], v[128:129], 0
    v_mfma_f32_16x16x16_bf16 v[96:99], v[180:181], v[128:129], 0
    ds_write_b128 v222, v[64:67] offset:0
    v_mfma_f32_16x16x16_bf16 v[100:103], v[182:183], v[128:129], 0
    ds_write_b128 v222, v[68:71] offset:64
    v_mfma_f32_16x16x16_bf16 v[104:107], v[184:185], v[128:129], 0
    ds_write_b128 v222, v[72:75] offset:128
    v_mfma_f32_16x16x16_bf16 v[108:111], v[186:187], v[128:129], 0
    ds_write_b128 v222, v[76:79] offset:192
    v_mfma_f32_16x16x16_bf16 v[112:115], v[188:189], v[128:129], 0
    ds_write_b128 v222, v[80:83] offset:256
    v_mfma_f32_16x16x16_bf16 v[116:119], v[190:191], v[128:129], 0
    ds_write_b128 v222, v[84:87] offset:320
    v_mfma_f32_16x16x16_bf16 v[120:123], v[192:193], v[128:129], 0
    ds_write_b128 v222, v[88:91] offset:384
    v_mfma_f32_16x16x16_bf16 v[124:127], v[194:195], v[128:129], 0
    ds_write_b128 v222, v[92:95] offset:448
    s_waitcnt lgkmcnt(4)
    ds_write_b128 v222, v[96:99] offset:512
    ds_write_b128 v222, v[100:103] offset:576
    ds_write_b128 v222, v[104:107] offset:640
    ds_write_b128 v222, v[108:111] offset:704
    ds_write_b128 v222, v[112:115] offset:768
    ds_write_b128 v222, v[116:119] offset:832
    ds_write_b128 v222, v[120:123] offset:896
    ds_write_b128 v222, v[124:127] offset:960
    s_lshl_b32 s32, s54, 13
    s_lshl_b32 s33, s3, 10
    s_add_u32 s32, s32, s33
    s_add_u32 s32, s32, 0x3900000
    s_add_u32 s33, s32, 4096
    s_waitcnt lgkmcnt(0)
    ds_read_b128 v[32:35], v223
    ds_read_b128 v[36:39], v223 offset:1024
    s_waitcnt lgkmcnt(1)
    buffer_store_dwordx4 v[32:35], v228, s[8:11], s32 offen sc1
    s_waitcnt lgkmcnt(0)
    buffer_store_dwordx4 v[36:39], v228, s[8:11], s33 offen sc1
    s_waitcnt vmcnt(2)
    v_mul_f32 v0, 0x3a800000, v0
    v_mul_f32 v1, 0x3a800000, v1
    v_mul_f32 v2, 0x3a800000, v2
    v_mul_f32 v3, 0x3a800000, v3
    v_mul_f32 v4, 0x3a800000, v4
    v_mul_f32 v5, 0x3a800000, v5
    v_mul_f32 v6, 0x3a800000, v6
    v_mul_f32 v7, 0x3a800000, v7
    v_fma_f32 v4, -v0, v0, v4
    v_fma_f32 v5, -v1, v1, v5
    v_fma_f32 v6, -v2, v2, v6
    v_fma_f32 v7, -v3, v3, v7
    v_max_f32 v4, 0, v4
    v_max_f32 v5, 0, v5
    v_max_f32 v6, 0, v6
    v_max_f32 v7, 0, v7
    v_cvt_pk_bf16_f32 v12, v0, v4
    v_cvt_pk_bf16_f32 v13, v1, v5
    v_cvt_pk_bf16_f32 v14, v2, v6
    v_cvt_pk_bf16_f32 v15, v3, v7
    v_lshlrev_b32 v0, 16, v12
    v_lshlrev_b32 v1, 16, v13
    v_lshlrev_b32 v2, 16, v14
    v_lshlrev_b32 v3, 16, v15
    v_and_b32 v4, 0xffff0000, v12
    v_and_b32 v5, 0xffff0000, v13
    v_and_b32 v6, 0xffff0000, v14
    v_and_b32 v7, 0xffff0000, v15
    v_add_f32 v4, 0x3727c5ac, v4
    v_add_f32 v5, 0x3727c5ac, v5
    v_add_f32 v6, 0x3727c5ac, v6
    v_add_f32 v7, 0x3727c5ac, v7
    v_cvt_pk_bf16_f32 v4, v4, v4
    v_cvt_pk_bf16_f32 v5, v5, v5
    v_cvt_pk_bf16_f32 v6, v6, v6
    v_cvt_pk_bf16_f32 v7, v7, v7
    v_lshlrev_b32 v4, 16, v4
    v_lshlrev_b32 v5, 16, v5
    v_lshlrev_b32 v6, 16, v6
    v_lshlrev_b32 v7, 16, v7
    v_sqrt_f32 v4, v4
    v_sqrt_f32 v5, v5
    v_sqrt_f32 v6, v6
    v_sqrt_f32 v7, v7
    v_cvt_pk_bf16_f32 v4, v4, v4
    v_cvt_pk_bf16_f32 v5, v5, v5
    v_cvt_pk_bf16_f32 v6, v6, v6
    v_cvt_pk_bf16_f32 v7, v7, v7
    v_lshlrev_b32 v4, 16, v4
    v_lshlrev_b32 v5, 16, v5
    v_lshlrev_b32 v6, 16, v6
    v_lshlrev_b32 v7, 16, v7
    v_rcp_f32 v4, v4
    v_rcp_f32 v5, v5
    v_rcp_f32 v6, v6
    v_rcp_f32 v7, v7
    v_lshlrev_b32 v144, 16, v16
    v_lshlrev_b32 v148, 16, v17
    v_lshlrev_b32 v152, 16, v18
    v_lshlrev_b32 v156, 16, v19
    v_and_b32 v145, 0xffff0000, v16
    v_and_b32 v149, 0xffff0000, v17
    v_and_b32 v153, 0xffff0000, v18
    v_and_b32 v157, 0xffff0000, v19
    v_sub_f32 v144, v144, v0
    v_sub_f32 v148, v148, v0
    v_sub_f32 v152, v152, v0
    v_sub_f32 v156, v156, v0
    v_sub_f32 v145, v145, v0
    v_sub_f32 v149, v149, v0
    v_sub_f32 v153, v153, v0
    v_sub_f32 v157, v157, v0
    v_cvt_pk_bf16_f32 v145, v144, v145
    v_cvt_pk_bf16_f32 v149, v148, v149
    v_cvt_pk_bf16_f32 v153, v152, v153
    v_cvt_pk_bf16_f32 v157, v156, v157
    v_lshlrev_b32 v144, 16, v145
    v_lshlrev_b32 v148, 16, v149
    v_lshlrev_b32 v152, 16, v153
    v_lshlrev_b32 v156, 16, v157
    v_and_b32 v145, 0xffff0000, v145
    v_and_b32 v149, 0xffff0000, v149
    v_and_b32 v153, 0xffff0000, v153
    v_and_b32 v157, 0xffff0000, v157
    v_mul_f32 v144, v144, v4
    v_mul_f32 v148, v148, v4
    v_mul_f32 v152, v152, v4
    v_mul_f32 v156, v156, v4
    v_mul_f32 v145, v145, v4
    v_mul_f32 v149, v149, v4
    v_mul_f32 v153, v153, v4
    v_mul_f32 v157, v157, v4
    v_cvt_pk_bf16_f32 v146, v144, v145
    v_cvt_pk_bf16_f32 v150, v148, v149
    v_cvt_pk_bf16_f32 v154, v152, v153
    v_cvt_pk_bf16_f32 v158, v156, v157
    v_lshlrev_b32 v144, 16, v146
    v_lshlrev_b32 v148, 16, v150
    v_lshlrev_b32 v152, 16, v154
    v_lshlrev_b32 v156, 16, v158
    v_and_b32 v145, 0xffff0000, v146
    v_and_b32 v149, 0xffff0000, v150
    v_and_b32 v153, 0xffff0000, v154
    v_and_b32 v157, 0xffff0000, v158
    v_lshlrev_b32 v146, 16, v16
    v_lshlrev_b32 v150, 16, v17
    v_lshlrev_b32 v154, 16, v18
    v_lshlrev_b32 v158, 16, v19
    v_and_b32 v147, 0xffff0000, v16
    v_and_b32 v151, 0xffff0000, v17
    v_and_b32 v155, 0xffff0000, v18
    v_and_b32 v159, 0xffff0000, v19
    v_pk_add_f32 v[144:145], v[144:145], v[146:147]
    v_pk_add_f32 v[148:149], v[148:149], v[150:151]
    v_pk_add_f32 v[152:153], v[152:153], v[154:155]
    v_pk_add_f32 v[156:157], v[156:157], v[158:159]
    v_cvt_pk_bf16_f32 v16, v144, v145
    v_cvt_pk_bf16_f32 v17, v148, v149
    v_cvt_pk_bf16_f32 v18, v152, v153
    v_cvt_pk_bf16_f32 v19, v156, v157
    v_add_u32 v160, 0, v242
    v_cmp_eq_u32 vcc, v160, v8
    v_cmp_eq_u32 s[60:61], v160, v10
    v_mov_b32 v161, 0x40000000
    s_or_b64 vcc, vcc, s[60:61]
    v_cndmask_b32 v12, v229, v161, vcc
    v_lshlrev_b32 v144, 16, v20
    v_lshlrev_b32 v148, 16, v21
    v_lshlrev_b32 v152, 16, v22
    v_lshlrev_b32 v156, 16, v23
    v_and_b32 v145, 0xffff0000, v20
    v_and_b32 v149, 0xffff0000, v21
    v_and_b32 v153, 0xffff0000, v22
    v_and_b32 v157, 0xffff0000, v23
    v_sub_f32 v144, v144, v1
    v_sub_f32 v148, v148, v1
    v_sub_f32 v152, v152, v1
    v_sub_f32 v156, v156, v1
    v_sub_f32 v145, v145, v1
    v_sub_f32 v149, v149, v1
    v_sub_f32 v153, v153, v1
    v_sub_f32 v157, v157, v1
    v_cvt_pk_bf16_f32 v145, v144, v145
    v_cvt_pk_bf16_f32 v149, v148, v149
    v_cvt_pk_bf16_f32 v153, v152, v153
    v_cvt_pk_bf16_f32 v157, v156, v157
    v_lshlrev_b32 v144, 16, v145
    v_lshlrev_b32 v148, 16, v149
    v_lshlrev_b32 v152, 16, v153
    v_lshlrev_b32 v156, 16, v157
    v_and_b32 v145, 0xffff0000, v145
    v_and_b32 v149, 0xffff0000, v149
    v_and_b32 v153, 0xffff0000, v153
    v_and_b32 v157, 0xffff0000, v157
    v_mul_f32 v144, v144, v5
    v_mul_f32 v148, v148, v5
    v_mul_f32 v152, v152, v5
    v_mul_f32 v156, v156, v5
    v_mul_f32 v145, v145, v5
    v_mul_f32 v149, v149, v5
    v_mul_f32 v153, v153, v5
    v_mul_f32 v157, v157, v5
    v_cvt_pk_bf16_f32 v146, v144, v145
    v_cvt_pk_bf16_f32 v150, v148, v149
    v_cvt_pk_bf16_f32 v154, v152, v153
    v_cvt_pk_bf16_f32 v158, v156, v157
    v_lshlrev_b32 v144, 16, v146
    v_lshlrev_b32 v148, 16, v150
    v_lshlrev_b32 v152, 16, v154
    v_lshlrev_b32 v156, 16, v158
    v_and_b32 v145, 0xffff0000, v146
    v_and_b32 v149, 0xffff0000, v150
    v_and_b32 v153, 0xffff0000, v154
    v_and_b32 v157, 0xffff0000, v158
    v_lshlrev_b32 v146, 16, v20
    v_lshlrev_b32 v150, 16, v21
    v_lshlrev_b32 v154, 16, v22
    v_lshlrev_b32 v158, 16, v23
    v_and_b32 v147, 0xffff0000, v20
    v_and_b32 v151, 0xffff0000, v21
    v_and_b32 v155, 0xffff0000, v22
    v_and_b32 v159, 0xffff0000, v23
    v_pk_add_f32 v[144:145], v[144:145], v[146:147]
    v_pk_add_f32 v[148:149], v[148:149], v[150:151]
    v_pk_add_f32 v[152:153], v[152:153], v[154:155]
    v_pk_add_f32 v[156:157], v[156:157], v[158:159]
    v_cvt_pk_bf16_f32 v20, v144, v145
    v_cvt_pk_bf16_f32 v21, v148, v149
    v_cvt_pk_bf16_f32 v22, v152, v153
    v_cvt_pk_bf16_f32 v23, v156, v157
    v_add_u32 v160, 8, v242
    v_cmp_eq_u32 vcc, v160, v8
    v_cmp_eq_u32 s[60:61], v160, v10
    v_mov_b32 v161, 0x40000000
    s_or_b64 vcc, vcc, s[60:61]
    v_cndmask_b32 v13, v229, v161, vcc
    v_lshlrev_b32 v144, 16, v24
    v_lshlrev_b32 v148, 16, v25
    v_lshlrev_b32 v152, 16, v26
    v_lshlrev_b32 v156, 16, v27
    v_and_b32 v145, 0xffff0000, v24
    v_and_b32 v149, 0xffff0000, v25
    v_and_b32 v153, 0xffff0000, v26
    v_and_b32 v157, 0xffff0000, v27
    v_sub_f32 v144, v144, v2
    v_sub_f32 v148, v148, v2
    v_sub_f32 v152, v152, v2
    v_sub_f32 v156, v156, v2
    v_sub_f32 v145, v145, v2
    v_sub_f32 v149, v149, v2
    v_sub_f32 v153, v153, v2
    v_sub_f32 v157, v157, v2
    v_cvt_pk_bf16_f32 v145, v144, v145
    v_cvt_pk_bf16_f32 v149, v148, v149
    v_cvt_pk_bf16_f32 v153, v152, v153
    v_cvt_pk_bf16_f32 v157, v156, v157
    v_lshlrev_b32 v144, 16, v145
    v_lshlrev_b32 v148, 16, v149
    v_lshlrev_b32 v152, 16, v153
    v_lshlrev_b32 v156, 16, v157
    v_and_b32 v145, 0xffff0000, v145
    v_and_b32 v149, 0xffff0000, v149
    v_and_b32 v153, 0xffff0000, v153
    v_and_b32 v157, 0xffff0000, v157
    v_mul_f32 v144, v144, v6
    v_mul_f32 v148, v148, v6
    v_mul_f32 v152, v152, v6
    v_mul_f32 v156, v156, v6
    v_mul_f32 v145, v145, v6
    v_mul_f32 v149, v149, v6
    v_mul_f32 v153, v153, v6
    v_mul_f32 v157, v157, v6
    v_cvt_pk_bf16_f32 v146, v144, v145
    v_cvt_pk_bf16_f32 v150, v148, v149
    v_cvt_pk_bf16_f32 v154, v152, v153
    v_cvt_pk_bf16_f32 v158, v156, v157
    v_lshlrev_b32 v144, 16, v146
    v_lshlrev_b32 v148, 16, v150
    v_lshlrev_b32 v152, 16, v154
    v_lshlrev_b32 v156, 16, v158
    v_and_b32 v145, 0xffff0000, v146
    v_and_b32 v149, 0xffff0000, v150
    v_and_b32 v153, 0xffff0000, v154
    v_and_b32 v157, 0xffff0000, v158
    v_lshlrev_b32 v146, 16, v24
    v_lshlrev_b32 v150, 16, v25
    v_lshlrev_b32 v154, 16, v26
    v_lshlrev_b32 v158, 16, v27
    v_and_b32 v147, 0xffff0000, v24
    v_and_b32 v151, 0xffff0000, v25
    v_and_b32 v155, 0xffff0000, v26
    v_and_b32 v159, 0xffff0000, v27
    v_pk_add_f32 v[144:145], v[144:145], v[146:147]
    v_pk_add_f32 v[148:149], v[148:149], v[150:151]
    v_pk_add_f32 v[152:153], v[152:153], v[154:155]
    v_pk_add_f32 v[156:157], v[156:157], v[158:159]
    v_cvt_pk_bf16_f32 v24, v144, v145
    v_cvt_pk_bf16_f32 v25, v148, v149
    v_cvt_pk_bf16_f32 v26, v152, v153
    v_cvt_pk_bf16_f32 v27, v156, v157
    v_add_u32 v160, 16, v242
    v_cmp_eq_u32 vcc, v160, v8
    v_cmp_eq_u32 s[60:61], v160, v10
    v_mov_b32 v161, 0x40000000
    s_or_b64 vcc, vcc, s[60:61]
    v_cndmask_b32 v14, v229, v161, vcc
    v_lshlrev_b32 v144, 16, v28
    v_lshlrev_b32 v148, 16, v29
    v_lshlrev_b32 v152, 16, v30
    v_lshlrev_b32 v156, 16, v31
    v_and_b32 v145, 0xffff0000, v28
    v_and_b32 v149, 0xffff0000, v29
    v_and_b32 v153, 0xffff0000, v30
    v_and_b32 v157, 0xffff0000, v31
    v_sub_f32 v144, v144, v3
    v_sub_f32 v148, v148, v3
    v_sub_f32 v152, v152, v3
    v_sub_f32 v156, v156, v3
    v_sub_f32 v145, v145, v3
    v_sub_f32 v149, v149, v3
    v_sub_f32 v153, v153, v3
    v_sub_f32 v157, v157, v3
    v_cvt_pk_bf16_f32 v145, v144, v145
    v_cvt_pk_bf16_f32 v149, v148, v149
    v_cvt_pk_bf16_f32 v153, v152, v153
    v_cvt_pk_bf16_f32 v157, v156, v157
    v_lshlrev_b32 v144, 16, v145
    v_lshlrev_b32 v148, 16, v149
    v_lshlrev_b32 v152, 16, v153
    v_lshlrev_b32 v156, 16, v157
    v_and_b32 v145, 0xffff0000, v145
    v_and_b32 v149, 0xffff0000, v149
    v_and_b32 v153, 0xffff0000, v153
    v_and_b32 v157, 0xffff0000, v157
    v_mul_f32 v144, v144, v7
    v_mul_f32 v148, v148, v7
    v_mul_f32 v152, v152, v7
    v_mul_f32 v156, v156, v7
    v_mul_f32 v145, v145, v7
    v_mul_f32 v149, v149, v7
    v_mul_f32 v153, v153, v7
    v_mul_f32 v157, v157, v7
    v_cvt_pk_bf16_f32 v146, v144, v145
    v_cvt_pk_bf16_f32 v150, v148, v149
    v_cvt_pk_bf16_f32 v154, v152, v153
    v_cvt_pk_bf16_f32 v158, v156, v157
    v_lshlrev_b32 v144, 16, v146
    v_lshlrev_b32 v148, 16, v150
    v_lshlrev_b32 v152, 16, v154
    v_lshlrev_b32 v156, 16, v158
    v_and_b32 v145, 0xffff0000, v146
    v_and_b32 v149, 0xffff0000, v150
    v_and_b32 v153, 0xffff0000, v154
    v_and_b32 v157, 0xffff0000, v158
    v_lshlrev_b32 v146, 16, v28
    v_lshlrev_b32 v150, 16, v29
    v_lshlrev_b32 v154, 16, v30
    v_lshlrev_b32 v158, 16, v31
    v_and_b32 v147, 0xffff0000, v28
    v_and_b32 v151, 0xffff0000, v29
    v_and_b32 v155, 0xffff0000, v30
    v_and_b32 v159, 0xffff0000, v31
    v_pk_add_f32 v[144:145], v[144:145], v[146:147]
    v_pk_add_f32 v[148:149], v[148:149], v[150:151]
    v_pk_add_f32 v[152:153], v[152:153], v[154:155]
    v_pk_add_f32 v[156:157], v[156:157], v[158:159]
    v_cvt_pk_bf16_f32 v28, v144, v145
    v_cvt_pk_bf16_f32 v29, v148, v149
    v_cvt_pk_bf16_f32 v30, v152, v153
    v_cvt_pk_bf16_f32 v31, v156, v157
    v_add_u32 v160, 24, v242
    v_cmp_eq_u32 vcc, v160, v8
    v_cmp_eq_u32 s[60:61], v160, v10
    v_mov_b32 v161, 0x40000000
    s_or_b64 vcc, vcc, s[60:61]
    v_cndmask_b32 v15, v229, v161, vcc
    s_waitcnt vmcnt(0)
    s_barrier
    s_cmp_lg_u32 s3, 0
    s_cbranch_scc1 kc_a2
    s_lshl_b32 s32, s52, 7
    s_add_u32 s32, s32, 0x3840800
    v_mov_b32 v235, 1
    buffer_atomic_add v235, v243, s[8:11], s32 offen sc0 sc1
    v_lshlrev_b32 v234, 7, v237
    v_cmp_gt_u32 vcc, 8, v237
    v_mov_b32 v236, 0x40000000
    s_mov_b32 s34, 0x3840c00
    v_cndmask_b32 v234, v236, v234, vcc
    s_waitcnt vmcnt(0)
    v_readfirstlane_b32 s36, v235
    s_cmp_lg_u32 s36, 27
    s_cbranch_scc1 kc_a2
    buffer_atomic_add v233, v234, s[8:11], s34 offen sc1
kc_a2:
    s_mov_b32 s32, 0
    buffer_store_dwordx4 v[16:19], v12, s[28:31], s32 offen
    s_mov_b32 s32, 16384
    buffer_store_dwordx4 v[20:23], v13, s[28:31], s32 offen
    s_mov_b32 s32, 32768
    buffer_store_dwordx4 v[24:27], v14, s[28:31], s32 offen
    s_mov_b32 s32, 49152
    buffer_store_dwordx4 v[28:31], v15, s[28:31], s32 offen
    s_branch kc_fin
kc_red:
    s_waitcnt lgkmcnt(0)
    s_waitcnt vmcnt(0)
    v_mul_f32 v0, 0x3a800000, v0
    v_mul_f32 v1, 0x3a800000, v1
    v_mul_f32 v2, 0x3a800000, v2
    v_mul_f32 v3, 0x3a800000, v3
    v_mul_f32 v4, 0x3a800000, v4
    v_mul_f32 v5, 0x3a800000, v5
    v_mul_f32 v6, 0x3a800000, v6
    v_mul_f32 v7, 0x3a800000, v7
    v_fma_f32 v4, -v0, v0, v4
    v_fma_f32 v5, -v1, v1, v5
    v_fma_f32 v6, -v2, v2, v6
    v_fma_f32 v7, -v3, v3, v7
    v_max_f32 v4, 0, v4
    v_max_f32 v5, 0, v5
    v_max_f32 v6, 0, v6
    v_max_f32 v7, 0, v7
    v_cvt_pk_bf16_f32 v12, v0, v4
    v_cvt_pk_bf16_f32 v13, v1, v5
    v_cvt_pk_bf16_f32 v14, v2, v6
    v_cvt_pk_bf16_f32 v15, v3, v7
    v_lshlrev_b32 v0, 16, v12
    v_lshlrev_b32 v1, 16, v13
    v_lshlrev_b32 v2, 16, v14
    v_lshlrev_b32 v3, 16, v15
    v_and_b32 v4, 0xffff0000, v12
    v_and_b32 v5, 0xffff0000, v13
    v_and_b32 v6, 0xffff0000, v14
    v_and_b32 v7, 0xffff0000, v15
    v_add_f32 v4, 0x3727c5ac, v4
    v_add_f32 v5, 0x3727c5ac, v5
    v_add_f32 v6, 0x3727c5ac, v6
    v_add_f32 v7, 0x3727c5ac, v7
    v_cvt_pk_bf16_f32 v4, v4, v4
    v_cvt_pk_bf16_f32 v5, v5, v5
    v_cvt_pk_bf16_f32 v6, v6, v6
    v_cvt_pk_bf16_f32 v7, v7, v7
    v_lshlrev_b32 v4, 16, v4
    v_lshlrev_b32 v5, 16, v5
    v_lshlrev_b32 v6, 16, v6
    v_lshlrev_b32 v7, 16, v7
    v_sqrt_f32 v4, v4
    v_sqrt_f32 v5, v5
    v_sqrt_f32 v6, v6
    v_sqrt_f32 v7, v7
    v_cvt_pk_bf16_f32 v4, v4, v4
    v_cvt_pk_bf16_f32 v5, v5, v5
    v_cvt_pk_bf16_f32 v6, v6, v6
    v_cvt_pk_bf16_f32 v7, v7, v7
    v_lshlrev_b32 v4, 16, v4
    v_lshlrev_b32 v5, 16, v5
    v_lshlrev_b32 v6, 16, v6
    v_lshlrev_b32 v7, 16, v7
    v_rcp_f32 v4, v4
    v_rcp_f32 v5, v5
    v_rcp_f32 v6, v6
    v_rcp_f32 v7, v7
    v_lshlrev_b32 v144, 16, v16
    v_lshlrev_b32 v148, 16, v17
    v_lshlrev_b32 v152, 16, v18
    v_lshlrev_b32 v156, 16, v19
    v_and_b32 v145, 0xffff0000, v16
    v_and_b32 v149, 0xffff0000, v17
    v_and_b32 v153, 0xffff0000, v18
    v_and_b32 v157, 0xffff0000, v19
    v_sub_f32 v144, v144, v0
    v_sub_f32 v148, v148, v0
    v_sub_f32 v152, v152, v0
    v_sub_f32 v156, v156, v0
    v_sub_f32 v145, v145, v0
    v_sub_f32 v149, v149, v0
    v_sub_f32 v153, v153, v0
    v_sub_f32 v157, v157, v0
    v_cvt_pk_bf16_f32 v145, v144, v145
    v_cvt_pk_bf16_f32 v149, v148, v149
    v_cvt_pk_bf16_f32 v153, v152, v153
    v_cvt_pk_bf16_f32 v157, v156, v157
    v_lshlrev_b32 v144, 16, v145
    v_lshlrev_b32 v148, 16, v149
    v_lshlrev_b32 v152, 16, v153
    v_lshlrev_b32 v156, 16, v157
    v_and_b32 v145, 0xffff0000, v145
    v_and_b32 v149, 0xffff0000, v149
    v_and_b32 v153, 0xffff0000, v153
    v_and_b32 v157, 0xffff0000, v157
    v_mul_f32 v144, v144, v4
    v_mul_f32 v148, v148, v4
    v_mul_f32 v152, v152, v4
    v_mul_f32 v156, v156, v4
    v_mul_f32 v145, v145, v4
    v_mul_f32 v149, v149, v4
    v_mul_f32 v153, v153, v4
    v_mul_f32 v157, v157, v4
    v_cvt_pk_bf16_f32 v146, v144, v145
    v_cvt_pk_bf16_f32 v150, v148, v149
    v_cvt_pk_bf16_f32 v154, v152, v153
    v_cvt_pk_bf16_f32 v158, v156, v157
    v_lshlrev_b32 v144, 16, v146
    v_lshlrev_b32 v148, 16, v150
    v_lshlrev_b32 v152, 16, v154
    v_lshlrev_b32 v156, 16, v158
    v_and_b32 v145, 0xffff0000, v146
    v_and_b32 v149, 0xffff0000, v150
    v_and_b32 v153, 0xffff0000, v154
    v_and_b32 v157, 0xffff0000, v158
    v_lshlrev_b32 v146, 16, v16
    v_lshlrev_b32 v150, 16, v17
    v_lshlrev_b32 v154, 16, v18
    v_lshlrev_b32 v158, 16, v19
    v_and_b32 v147, 0xffff0000, v16
    v_and_b32 v151, 0xffff0000, v17
    v_and_b32 v155, 0xffff0000, v18
    v_and_b32 v159, 0xffff0000, v19
    v_pk_add_f32 v[144:145], v[144:145], v[146:147]
    v_pk_add_f32 v[148:149], v[148:149], v[150:151]
    v_pk_add_f32 v[152:153], v[152:153], v[154:155]
    v_pk_add_f32 v[156:157], v[156:157], v[158:159]
    v_cvt_pk_bf16_f32 v16, v144, v145
    v_cvt_pk_bf16_f32 v17, v148, v149
    v_cvt_pk_bf16_f32 v18, v152, v153
    v_cvt_pk_bf16_f32 v19, v156, v157
    v_add_u32 v160, 0, v242
    v_cmp_eq_u32 vcc, v160, v8
    v_cmp_eq_u32 s[60:61], v160, v10
    v_mov_b32 v161, 0x40000000
    s_or_b64 vcc, vcc, s[60:61]
    v_cndmask_b32 v12, v229, v161, vcc
    v_lshlrev_b32 v144, 16, v20
    v_lshlrev_b32 v148, 16, v21
    v_lshlrev_b32 v152, 16, v22
    v_lshlrev_b32 v156, 16, v23
    v_and_b32 v145, 0xffff0000, v20
    v_and_b32 v149, 0xffff0000, v21
    v_and_b32 v153, 0xffff0000, v22
    v_and_b32 v157, 0xffff0000, v23
    v_sub_f32 v144, v144, v1
    v_sub_f32 v148, v148, v1
    v_sub_f32 v152, v152, v1
    v_sub_f32 v156, v156, v1
    v_sub_f32 v145, v145, v1
    v_sub_f32 v149, v149, v1
    v_sub_f32 v153, v153, v1
    v_sub_f32 v157, v157, v1
    v_cvt_pk_bf16_f32 v145, v144, v145
    v_cvt_pk_bf16_f32 v149, v148, v149
    v_cvt_pk_bf16_f32 v153, v152, v153
    v_cvt_pk_bf16_f32 v157, v156, v157
    v_lshlrev_b32 v144, 16, v145
    v_lshlrev_b32 v148, 16, v149
    v_lshlrev_b32 v152, 16, v153
    v_lshlrev_b32 v156, 16, v157
    v_and_b32 v145, 0xffff0000, v145
    v_and_b32 v149, 0xffff0000, v149
    v_and_b32 v153, 0xffff0000, v153
    v_and_b32 v157, 0xffff0000, v157
    v_mul_f32 v144, v144, v5
    v_mul_f32 v148, v148, v5
    v_mul_f32 v152, v152, v5
    v_mul_f32 v156, v156, v5
    v_mul_f32 v145, v145, v5
    v_mul_f32 v149, v149, v5
    v_mul_f32 v153, v153, v5
    v_mul_f32 v157, v157, v5
    v_cvt_pk_bf16_f32 v146, v144, v145
    v_cvt_pk_bf16_f32 v150, v148, v149
    v_cvt_pk_bf16_f32 v154, v152, v153
    v_cvt_pk_bf16_f32 v158, v156, v157
    v_lshlrev_b32 v144, 16, v146
    v_lshlrev_b32 v148, 16, v150
    v_lshlrev_b32 v152, 16, v154
    v_lshlrev_b32 v156, 16, v158
    v_and_b32 v145, 0xffff0000, v146
    v_and_b32 v149, 0xffff0000, v150
    v_and_b32 v153, 0xffff0000, v154
    v_and_b32 v157, 0xffff0000, v158
    v_lshlrev_b32 v146, 16, v20
    v_lshlrev_b32 v150, 16, v21
    v_lshlrev_b32 v154, 16, v22
    v_lshlrev_b32 v158, 16, v23
    v_and_b32 v147, 0xffff0000, v20
    v_and_b32 v151, 0xffff0000, v21
    v_and_b32 v155, 0xffff0000, v22
    v_and_b32 v159, 0xffff0000, v23
    v_pk_add_f32 v[144:145], v[144:145], v[146:147]
    v_pk_add_f32 v[148:149], v[148:149], v[150:151]
    v_pk_add_f32 v[152:153], v[152:153], v[154:155]
    v_pk_add_f32 v[156:157], v[156:157], v[158:159]
    v_cvt_pk_bf16_f32 v20, v144, v145
    v_cvt_pk_bf16_f32 v21, v148, v149
    v_cvt_pk_bf16_f32 v22, v152, v153
    v_cvt_pk_bf16_f32 v23, v156, v157
    v_add_u32 v160, 8, v242
    v_cmp_eq_u32 vcc, v160, v8
    v_cmp_eq_u32 s[60:61], v160, v10
    v_mov_b32 v161, 0x40000000
    s_or_b64 vcc, vcc, s[60:61]
    v_cndmask_b32 v13, v229, v161, vcc
    v_lshlrev_b32 v144, 16, v24
    v_lshlrev_b32 v148, 16, v25
    v_lshlrev_b32 v152, 16, v26
    v_lshlrev_b32 v156, 16, v27
    v_and_b32 v145, 0xffff0000, v24
    v_and_b32 v149, 0xffff0000, v25
    v_and_b32 v153, 0xffff0000, v26
    v_and_b32 v157, 0xffff0000, v27
    v_sub_f32 v144, v144, v2
    v_sub_f32 v148, v148, v2
    v_sub_f32 v152, v152, v2
    v_sub_f32 v156, v156, v2
    v_sub_f32 v145, v145, v2
    v_sub_f32 v149, v149, v2
    v_sub_f32 v153, v153, v2
    v_sub_f32 v157, v157, v2
    v_cvt_pk_bf16_f32 v145, v144, v145
    v_cvt_pk_bf16_f32 v149, v148, v149
    v_cvt_pk_bf16_f32 v153, v152, v153
    v_cvt_pk_bf16_f32 v157, v156, v157
    v_lshlrev_b32 v144, 16, v145
    v_lshlrev_b32 v148, 16, v149
    v_lshlrev_b32 v152, 16, v153
    v_lshlrev_b32 v156, 16, v157
    v_and_b32 v145, 0xffff0000, v145
    v_and_b32 v149, 0xffff0000, v149
    v_and_b32 v153, 0xffff0000, v153
    v_and_b32 v157, 0xffff0000, v157
    v_mul_f32 v144, v144, v6
    v_mul_f32 v148, v148, v6
    v_mul_f32 v152, v152, v6
    v_mul_f32 v156, v156, v6
    v_mul_f32 v145, v145, v6
    v_mul_f32 v149, v149, v6
    v_mul_f32 v153, v153, v6
    v_mul_f32 v157, v157, v6
    v_cvt_pk_bf16_f32 v146, v144, v145
    v_cvt_pk_bf16_f32 v150, v148, v149
    v_cvt_pk_bf16_f32 v154, v152, v153
    v_cvt_pk_bf16_f32 v158, v156, v157
    v_lshlrev_b32 v144, 16, v146
    v_lshlrev_b32 v148, 16, v150
    v_lshlrev_b32 v152, 16, v154
    v_lshlrev_b32 v156, 16, v158
    v_and_b32 v145, 0xffff0000, v146
    v_and_b32 v149, 0xffff0000, v150
    v_and_b32 v153, 0xffff0000, v154
    v_and_b32 v157, 0xffff0000, v158
    v_lshlrev_b32 v146, 16, v24
    v_lshlrev_b32 v150, 16, v25
    v_lshlrev_b32 v154, 16, v26
    v_lshlrev_b32 v158, 16, v27
    v_and_b32 v147, 0xffff0000, v24
    v_and_b32 v151, 0xffff0000, v25
    v_and_b32 v155, 0xffff0000, v26
    v_and_b32 v159, 0xffff0000, v27
    v_pk_add_f32 v[144:145], v[144:145], v[146:147]
    v_pk_add_f32 v[148:149], v[148:149], v[150:151]
    v_pk_add_f32 v[152:153], v[152:153], v[154:155]
    v_pk_add_f32 v[156:157], v[156:157], v[158:159]
    v_cvt_pk_bf16_f32 v24, v144, v145
    v_cvt_pk_bf16_f32 v25, v148, v149
    v_cvt_pk_bf16_f32 v26, v152, v153
    v_cvt_pk_bf16_f32 v27, v156, v157
    v_add_u32 v160, 16, v242
    v_cmp_eq_u32 vcc, v160, v8
    v_cmp_eq_u32 s[60:61], v160, v10
    v_mov_b32 v161, 0x40000000
    s_or_b64 vcc, vcc, s[60:61]
    v_cndmask_b32 v14, v229, v161, vcc
    v_lshlrev_b32 v144, 16, v28
    v_lshlrev_b32 v148, 16, v29
    v_lshlrev_b32 v152, 16, v30
    v_lshlrev_b32 v156, 16, v31
    v_and_b32 v145, 0xffff0000, v28
    v_and_b32 v149, 0xffff0000, v29
    v_and_b32 v153, 0xffff0000, v30
    v_and_b32 v157, 0xffff0000, v31
    v_sub_f32 v144, v144, v3
    v_sub_f32 v148, v148, v3
    v_sub_f32 v152, v152, v3
    v_sub_f32 v156, v156, v3
    v_sub_f32 v145, v145, v3
    v_sub_f32 v149, v149, v3
    v_sub_f32 v153, v153, v3
    v_sub_f32 v157, v157, v3
    v_cvt_pk_bf16_f32 v145, v144, v145
    v_cvt_pk_bf16_f32 v149, v148, v149
    v_cvt_pk_bf16_f32 v153, v152, v153
    v_cvt_pk_bf16_f32 v157, v156, v157
    v_lshlrev_b32 v144, 16, v145
    v_lshlrev_b32 v148, 16, v149
    v_lshlrev_b32 v152, 16, v153
    v_lshlrev_b32 v156, 16, v157
    v_and_b32 v145, 0xffff0000, v145
    v_and_b32 v149, 0xffff0000, v149
    v_and_b32 v153, 0xffff0000, v153
    v_and_b32 v157, 0xffff0000, v157
    v_mul_f32 v144, v144, v7
    v_mul_f32 v148, v148, v7
    v_mul_f32 v152, v152, v7
    v_mul_f32 v156, v156, v7
    v_mul_f32 v145, v145, v7
    v_mul_f32 v149, v149, v7
    v_mul_f32 v153, v153, v7
    v_mul_f32 v157, v157, v7
    v_cvt_pk_bf16_f32 v146, v144, v145
    v_cvt_pk_bf16_f32 v150, v148, v149
    v_cvt_pk_bf16_f32 v154, v152, v153
    v_cvt_pk_bf16_f32 v158, v156, v157
    v_lshlrev_b32 v144, 16, v146
    v_lshlrev_b32 v148, 16, v150
    v_lshlrev_b32 v152, 16, v154
    v_lshlrev_b32 v156, 16, v158
    v_and_b32 v145, 0xffff0000, v146
    v_and_b32 v149, 0xffff0000, v150
    v_and_b32 v153, 0xffff0000, v154
    v_and_b32 v157, 0xffff0000, v158
    v_lshlrev_b32 v146, 16, v28
    v_lshlrev_b32 v150, 16, v29
    v_lshlrev_b32 v154, 16, v30
    v_lshlrev_b32 v158, 16, v31
    v_and_b32 v147, 0xffff0000, v28
    v_and_b32 v151, 0xffff0000, v29
    v_and_b32 v155, 0xffff0000, v30
    v_and_b32 v159, 0xffff0000, v31
    v_pk_add_f32 v[144:145], v[144:145], v[146:147]
    v_pk_add_f32 v[148:149], v[148:149], v[150:151]
    v_pk_add_f32 v[152:153], v[152:153], v[154:155]
    v_pk_add_f32 v[156:157], v[156:157], v[158:159]
    v_cvt_pk_bf16_f32 v28, v144, v145
    v_cvt_pk_bf16_f32 v29, v148, v149
    v_cvt_pk_bf16_f32 v30, v152, v153
    v_cvt_pk_bf16_f32 v31, v156, v157
    v_add_u32 v160, 24, v242
    v_cmp_eq_u32 vcc, v160, v8
    v_cmp_eq_u32 s[60:61], v160, v10
    v_mov_b32 v161, 0x40000000
    s_or_b64 vcc, vcc, s[60:61]
    v_cndmask_b32 v15, v229, v161, vcc
    s_mov_b32 s32, 0
    buffer_store_dwordx4 v[16:19], v12, s[28:31], s32 offen
    s_mov_b32 s32, 16384
    buffer_store_dwordx4 v[20:23], v13, s[28:31], s32 offen
    s_mov_b32 s32, 32768
    buffer_store_dwordx4 v[24:27], v14, s[28:31], s32 offen
    s_mov_b32 s32, 49152
    buffer_store_dwordx4 v[28:31], v15, s[28:31], s32 offen
    s_sub_u32 s54, s2, 224
    v_lshrrev_b32 v234, 4, v230
    v_lshlrev_b32 v234, 13, v234
    v_and_b32 v235, 15, v237
    v_lshl_add_u32 v217, v235, 4, v234
    s_lshl_b32 s35, s54, 8
    s_add_u32 s35, s35, 0x3900000
    v_bfe_u32 v234, v237, 4, 1
    v_lshrrev_b32 v236, 5, v237
    v_lshl_add_u32 v234, v234, 1, v236
    v_lshl_add_u32 v234, v235, 2, v234
    s_lshl_b32 s32, s54, 6
    v_add_u32 v234, s32, v234
    v_lshlrev_b32 v218, 1, v234
    v_add_u32 v234, 98304, v218
    ds_read_u16 v100, v234
    ds_read_u16 v101, v234 offset:4096
    s_cmp_lt_u32 s54, 16
    s_cselect_b64 vcc, -1, 0
    v_cndmask_b32 v102, v10, v8, vcc
    v_cndmask_b32 v103, v11, v9, vcc
    v_and_b32 v218, 2047, v218
    v_lshl_add_u32 v218, v102, 11, v218
    v_lshlrev_b32 v220, 2, v230
    v_add_u32 v220, 106752, v220
    v_lshlrev_b32 v221, 2, v237
    v_add_u32 v221, 106752, v221
    s_cmp_lg_u32 s3, 0
    s_cbranch_scc1 kc_b22
    s_lshl_b32 s32, s52, 7
    s_add_u32 s32, s32, 0x3840c00
    s_mov_b32 s34, 0x400000
    s_branch kc_b21
kc_b20:
    s_sleep 2
kc_b21:
    buffer_load_dword v235, off, s[8:11], s32 sc1
    s_waitcnt vmcnt(0)
    v_cmp_ne_u32 vcc, 8, v235
    s_sub_u32 s34, s34, 1
    s_cbranch_scc1 kc_b22
    s_cbranch_vccnz kc_b20
kc_b22:
    s_barrier
    s_add_u32 s32, s35, 0
    buffer_load_dwordx4 v[32:35], v217, s[8:11], s32 offen sc1
    s_add_u32 s32, s35, 131072
    buffer_load_dwordx4 v[36:39], v217, s[8:11], s32 offen sc1
    s_add_u32 s32, s35, 262144
    buffer_load_dwordx4 v[40:43], v217, s[8:11], s32 offen sc1
    s_add_u32 s32, s35, 393216
    buffer_load_dwordx4 v[44:47], v217, s[8:11], s32 offen sc1
    s_add_u32 s32, s35, 524288
    buffer_load_dwordx4 v[48:51], v217, s[8:11], s32 offen sc1
    s_add_u32 s32, s35, 655360
    buffer_load_dwordx4 v[52:55], v217, s[8:11], s32 offen sc1
    s_add_u32 s32, s35, 786432
    buffer_load_dwordx4 v[56:59], v217, s[8:11], s32 offen sc1
    s_add_u32 s32, s35, 917504
    buffer_load_dwordx4 v[60:63], v217, s[8:11], s32 offen sc1
    s_add_u32 s32, s35, 1048576
    buffer_load_dwordx4 v[64:67], v217, s[8:11], s32 offen sc1
    s_add_u32 s32, s35, 1179648
    buffer_load_dwordx4 v[68:71], v217, s[8:11], s32 offen sc1
    s_add_u32 s32, s35, 1310720
    buffer_load_dwordx4 v[72:75], v217, s[8:11], s32 offen sc1
    s_add_u32 s32, s35, 1441792
    buffer_load_dwordx4 v[76:79], v217, s[8:11], s32 offen sc1
    s_add_u32 s32, s35, 1572864
    buffer_load_dwordx4 v[80:83], v217, s[8:11], s32 offen sc1
    s_add_u32 s32, s35, 1703936
    buffer_load_dwordx4 v[84:87], v217, s[8:11], s32 offen sc1
    s_waitcnt vmcnt(12)
    v_pk_add_f32 v[32:33], v[32:33], v[36:37]
    v_pk_add_f32 v[34:35], v[34:35], v[38:39]
    s_waitcnt vmcnt(11)
    v_pk_add_f32 v[32:33], v[32:33], v[40:41]
    v_pk_add_f32 v[34:35], v[34:35], v[42:43]
    s_waitcnt vmcnt(10)
    v_pk_add_f32 v[32:33], v[32:33], v[44:45]
    v_pk_add_f32 v[34:35], v[34:35], v[46:47]
    s_waitcnt vmcnt(9)
    v_pk_add_f32 v[32:33], v[32:33], v[48:49]
    v_pk_add_f32 v[34:35], v[34:35], v[50:51]
    s_waitcnt vmcnt(8)
    v_pk_add_f32 v[32:33], v[32:33], v[52:53]
    v_pk_add_f32 v[34:35], v[34:35], v[54:55]
    s_waitcnt vmcnt(7)
    v_pk_add_f32 v[32:33], v[32:33], v[56:57]
    v_pk_add_f32 v[34:35], v[34:35], v[58:59]
    s_waitcnt vmcnt(6)
    v_pk_add_f32 v[32:33], v[32:33], v[60:61]
    v_pk_add_f32 v[34:35], v[34:35], v[62:63]
    s_waitcnt vmcnt(5)
    v_pk_add_f32 v[32:33], v[32:33], v[64:65]
    v_pk_add_f32 v[34:35], v[34:35], v[66:67]
    s_waitcnt vmcnt(4)
    v_pk_add_f32 v[32:33], v[32:33], v[68:69]
    v_pk_add_f32 v[34:35], v[34:35], v[70:71]
    s_waitcnt vmcnt(3)
    v_pk_add_f32 v[32:33], v[32:33], v[72:73]
    v_pk_add_f32 v[34:35], v[34:35], v[74:75]
    s_waitcnt vmcnt(2)
    v_pk_add_f32 v[32:33], v[32:33], v[76:77]
    v_pk_add_f32 v[34:35], v[34:35], v[78:79]
    s_waitcnt vmcnt(1)
    v_pk_add_f32 v[32:33], v[32:33], v[80:81]
    v_pk_add_f32 v[34:35], v[34:35], v[82:83]
    s_waitcnt vmcnt(0)
    v_pk_add_f32 v[32:33], v[32:33], v[84:85]
    v_pk_add_f32 v[34:35], v[34:35], v[86:87]
    s_nop 1
    v_permlane32_swap_b32 v32, v33
    v_permlane32_swap_b32 v34, v35
    s_nop 0
    v_add_f32 v32, v32, v33
    v_add_f32 v34, v34, v35
    s_nop 1
    v_permlane16_swap_b32 v32, v34
    s_nop 0
    v_add_f32 v32, v32, v34
    ds_write_b32 v220, v32
    s_waitcnt lgkmcnt(0)
    s_barrier
    s_cmp_lg_u32 s3, 0
    s_cbranch_scc1 kc_fin
    ds_read_b32 v32, v221
    ds_read_b32 v33, v221 offset:256
    ds_read_b32 v34, v221 offset:512
    ds_read_b32 v35, v221 offset:768
    v_lshlrev_b32 v100, 16, v100
    v_lshlrev_b32 v101, 16, v101
    s_waitcnt lgkmcnt(0)
    v_add_f32 v32, v32, v33
    v_add_f32 v34, v34, v35
    v_add_f32 v32, v32, v34
    v_cvt_pk_bf16_f32 v32, v32, v32
    v_lshlrev_b32 v32, 16, v32
    v_mul_f32 v32, v32, v103
    v_cvt_pk_bf16_f32 v32, v32, v32
    v_lshlrev_b32 v32, 16, v32
    v_add_f32 v32, v32, v100
    v_cvt_pk_bf16_f32 v32, v32, v32
    v_lshlrev_b32 v32, 16, v32
    v_add_f32 v32, v32, v101
    v_cvt_pk_bf16_f32 v32, v32, v32
    buffer_store_short v32, v218, s[28:31], 0 offen
kc_fin:
    s_endpgm
kc_end:
ka_done:
    s_endpgm
kf_fix1:
    s_cmp_eq_u32 s33, 0
    s_cselect_b32 s24, 0, 0x74000000
    s_cselect_b32 s36, 0, 0x1000
    s_mov_b32 s33, 1
    v_subrev_f32 v230, s24, v243
    v_add_f32 v231, 0, v230
    v_min_f32 v64, v228, v231
    v_add_f32 v232, 0xf1800000, v230
    v_min_f32 v65, v228, v232
    v_add_f32 v231, 0xf2000000, v230
    v_min_f32 v66, v228, v231
    v_add_f32 v232, 0xf2400000, v230
    v_min_f32 v67, v228, v232
    v_add_f32 v231, 0xf3000000, v230
    v_min_f32 v68, v228, v231
    v_add_f32 v232, 0xf3100000, v230
    v_min_f32 v69, v228, v232
    v_add_f32 v231, 0xf3200000, v230
    v_min_f32 v70, v228, v231
    v_add_f32 v232, 0xf3300000, v230
    v_min_f32 v71, v228, v232
    v_add_f32 v231, 0xf3800000, v230
    v_min_f32 v72, v228, v231
    v_add_f32 v232, 0xf3880000, v230
    v_min_f32 v73, v228, v232
    v_add_f32 v231, 0xf3900000, v230
    v_min_f32 v74, v228, v231
    v_add_f32 v232, 0xf3980000, v230
    v_min_f32 v75, v228, v232
    v_add_f32 v231, 0xf3c00000, v230
    v_min_f32 v76, v228, v231
    v_add_f32 v232, 0xf3c80000, v230
    v_min_f32 v77, v228, v232
    v_add_f32 v231, 0xf3d00000, v230
    v_min_f32 v78, v228, v231
    v_add_f32 v232, 0xf3d80000, v230
    v_min_f32 v79, v228, v232
    s_nop 1
    s_branch kf_fixr2
kf_fix3:
    s_cmp_eq_u32 s33, 0
    s_cselect_b32 s24, 0, 0x74000000
    s_cselect_b32 s36, 0, 0x1000
    s_mov_b32 s33, 1
    v_subrev_f32 v230, s24, v243
    v_add_f32 v231, 0, v230
    v_min_f32 v64, v228, v231
    v_add_f32 v232, 0xf1800000, v230
    v_min_f32 v65, v228, v232
    v_add_f32 v231, 0xf2000000, v230
    v_min_f32 v66, v228, v231
    v_add_f32 v232, 0xf2400000, v230
    v_min_f32 v67, v228, v232
    v_add_f32 v231, 0xf3000000, v230
    v_min_f32 v68, v228, v231
    v_add_f32 v232, 0xf3100000, v230
    v_min_f32 v69, v228, v232
    v_add_f32 v231, 0xf3200000, v230
    v_min_f32 v70, v228, v231
    v_add_f32 v232, 0xf3300000, v230
    v_min_f32 v71, v228, v232
    v_add_f32 v231, 0xf3800000, v230
    v_min_f32 v72, v228, v231
    v_add_f32 v232, 0xf3880000, v230
    v_min_f32 v73, v228, v232
    v_add_f32 v231, 0xf3900000, v230
    v_min_f32 v74, v228, v231
    v_add_f32 v232, 0xf3980000, v230
    v_min_f32 v75, v228, v232
    v_add_f32 v231, 0xf3c00000, v230
    v_min_f32 v76, v228, v231
    v_add_f32 v232, 0xf3c80000, v230
    v_min_f32 v77, v228, v232
    v_add_f32 v231, 0xf3d00000, v230
    v_min_f32 v78, v228, v231
    v_add_f32 v232, 0xf3d80000, v230
    v_min_f32 v79, v228, v232
    s_nop 1
    s_branch kf_fixr4
kf_l2p5:
    buffer_load_dword v252, v245, s[56:59], s28 offen
    s_add_u32 s28, s28, 4096
    s_and_b32 s27, s28, 0x7000
    s_cselect_b32 s27, 0, 0x1000
    s_branch kf_l2r6
kf_fix7:
    s_cmp_eq_u32 s33, 0
    s_cselect_b32 s24, 0, 0x74000000
    s_cselect_b32 s36, 0, 0x1000
    s_mov_b32 s33, 1
    v_subrev_f32 v230, s24, v243
    v_add_f32 v231, 0, v230
    v_min_f32 v64, v228, v231
    v_add_f32 v232, 0xf1800000, v230
    v_min_f32 v65, v228, v232
    v_add_f32 v231, 0xf2000000, v230
    v_min_f32 v66, v228, v231
    v_add_f32 v232, 0xf2400000, v230
    v_min_f32 v67, v228, v232
    v_add_f32 v231, 0xf3000000, v230
    v_min_f32 v68, v228, v231
    v_add_f32 v232, 0xf3100000, v230
    v_min_f32 v69, v228, v232
    v_add_f32 v231, 0xf3200000, v230
    v_min_f32 v70, v228, v231
    v_add_f32 v232, 0xf3300000, v230
    v_min_f32 v71, v228, v232
    v_add_f32 v231, 0xf3800000, v230
    v_min_f32 v72, v228, v231
    v_add_f32 v232, 0xf3880000, v230
    v_min_f32 v73, v228, v232
    v_add_f32 v231, 0xf3900000, v230
    v_min_f32 v74, v228, v231
    v_add_f32 v232, 0xf3980000, v230
    v_min_f32 v75, v228, v232
    v_add_f32 v231, 0xf3c00000, v230
    v_min_f32 v76, v228, v231
    v_add_f32 v232, 0xf3c80000, v230
    v_min_f32 v77, v228, v232
    v_add_f32 v231, 0xf3d00000, v230
    v_min_f32 v78, v228, v231
    v_add_f32 v232, 0xf3d80000, v230
    v_min_f32 v79, v228, v232
    s_nop 1
    s_branch kf_fixr8
kf_rare10:
    s_nop 15
    v_max3_f32 v230, v32, v33, v34
    v_max3_f32 v230, v230, v35, v36
    v_max3_f32 v230, v230, v37, v38
    v_max3_f32 v230, v230, v39, v40
    v_max3_f32 v230, v230, v41, v42
    v_max3_f32 v230, v230, v43, v44
    v_max3_f32 v230, v230, v45, v46
    v_max_f32 v230, v230, v47
    v_mov_b32 v231, v230
    s_nop 1
    v_permlane32_swap_b32 v230, v231
    s_nop 0
    v_max_f32 v230, v230, v231
    v_max_f32 v230, 0, v230
    v_sub_f32 v232, 0, v230
    v_exp_f32 v232, v232
    v_sub_f32 v228, v228, v230
    v_sub_f32 v64, v64, v230
    v_sub_f32 v0, v0, v230
    v_sub_f32 v32, v32, v230
    v_sub_f32 v65, v65, v230
    v_sub_f32 v1, v1, v230
    v_sub_f32 v33, v33, v230
    v_sub_f32 v66, v66, v230
    v_sub_f32 v2, v2, v230
    v_sub_f32 v34, v34, v230
    v_sub_f32 v67, v67, v230
    v_sub_f32 v3, v3, v230
    v_sub_f32 v35, v35, v230
    v_sub_f32 v68, v68, v230
    v_sub_f32 v4, v4, v230
    v_sub_f32 v36, v36, v230
    v_sub_f32 v69, v69, v230
    v_sub_f32 v5, v5, v230
    v_sub_f32 v37, v37, v230
    v_sub_f32 v70, v70, v230
    v_sub_f32 v6, v6, v230
    v_sub_f32 v38, v38, v230
    v_sub_f32 v71, v71, v230
    v_sub_f32 v7, v7, v230
    v_sub_f32 v39, v39, v230
    v_sub_f32 v72, v72, v230
    v_sub_f32 v8, v8, v230
    v_sub_f32 v40, v40, v230
    v_sub_f32 v73, v73, v230
    v_sub_f32 v9, v9, v230
    v_sub_f32 v41, v41, v230
    v_sub_f32 v74, v74, v230
    v_sub_f32 v10, v10, v230
    v_sub_f32 v42, v42, v230
    v_sub_f32 v75, v75, v230
    v_sub_f32 v11, v11, v230
    v_sub_f32 v43, v43, v230
    v_sub_f32 v76, v76, v230
    v_sub_f32 v12, v12, v230
    v_sub_f32 v44, v44, v230
    v_sub_f32 v77, v77, v230
    v_sub_f32 v13, v13, v230
    v_sub_f32 v45, v45, v230
    v_sub_f32 v78, v78, v230
    v_sub_f32 v14, v14, v230
    v_sub_f32 v46, v46, v230
    v_sub_f32 v79, v79, v230
    v_sub_f32 v15, v15, v230
    v_sub_f32 v47, v47, v230
    v_mul_f32 v226, v226, v232
    v_accvgpr_read_b32 v234, a0
    v_mul_f32 v234, v234, v232
    v_accvgpr_write_b32 a0, v234
    v_accvgpr_read_b32 v235, a1
    v_mul_f32 v235, v235, v232
    v_accvgpr_write_b32 a1, v235
    v_accvgpr_read_b32 v236, a2
    v_mul_f32 v236, v236, v232
    v_accvgpr_write_b32 a2, v236
    v_accvgpr_read_b32 v237, a3
    v_mul_f32 v237, v237, v232
    v_accvgpr_write_b32 a3, v237
    v_accvgpr_read_b32 v234, a4
    v_mul_f32 v234, v234, v232
    v_accvgpr_write_b32 a4, v234
    v_accvgpr_read_b32 v235, a5
    v_mul_f32 v235, v235, v232
    v_accvgpr_write_b32 a5, v235
    v_accvgpr_read_b32 v236, a6
    v_mul_f32 v236, v236, v232
    v_accvgpr_write_b32 a6, v236
    v_accvgpr_read_b32 v237, a7
    v_mul_f32 v237, v237, v232
    v_accvgpr_write_b32 a7, v237
    v_accvgpr_read_b32 v234, a8
    v_mul_f32 v234, v234, v232
    v_accvgpr_write_b32 a8, v234
    v_accvgpr_read_b32 v235, a9
    v_mul_f32 v235, v235, v232
    v_accvgpr_write_b32 a9, v235
    v_accvgpr_read_b32 v236, a10
    v_mul_f32 v236, v236, v232
    v_accvgpr_write_b32 a10, v236
    v_accvgpr_read_b32 v237, a11
    v_mul_f32 v237, v237, v232
    v_accvgpr_write_b32 a11, v237
    v_accvgpr_read_b32 v234, a12
    v_mul_f32 v234, v234, v232
    v_accvgpr_write_b32 a12, v234
    v_accvgpr_read_b32 v235, a13
    v_mul_f32 v235, v235, v232
    v_accvgpr_write_b32 a13, v235
    v_accvgpr_read_b32 v236, a14
    v_mul_f32 v236, v236, v232
    v_accvgpr_write_b32 a14, v236
    v_accvgpr_read_b32 v237, a15
    v_mul_f32 v237, v237, v232
    v_accvgpr_write_b32 a15, v237
    v_accvgpr_read_b32 v234, a16
    v_mul_f32 v234, v234, v232
    v_accvgpr_write_b32 a16, v234
    v_accvgpr_read_b32 v235, a17
    v_mul_f32 v235, v235, v232
    v_accvgpr_write_b32 a17, v235
    v_accvgpr_read_b32 v236, a18
    v_mul_f32 v236, v236, v232
    v_accvgpr_write_b32 a18, v236
    v_accvgpr_read_b32 v237, a19
    v_mul_f32 v237, v237, v232
    v_accvgpr_write_b32 a19, v237
    v_accvgpr_read_b32 v234, a20
    v_mul_f32 v234, v234, v232
    v_accvgpr_write_b32 a20, v234
    v_accvgpr_read_b32 v235, a21
    v_mul_f32 v235, v235, v232
    v_accvgpr_write_b32 a21, v235
    v_accvgpr_read_b32 v236, a22
    v_mul_f32 v236, v236, v232
    v_accvgpr_write_b32 a22, v236
    v_accvgpr_read_b32 v237, a23
    v_mul_f32 v237, v237, v232
    v_accvgpr_write_b32 a23, v237
    v_accvgpr_read_b32 v234, a24
    v_mul_f32 v234, v234, v232
    v_accvgpr_write_b32 a24, v234
    v_accvgpr_read_b32 v235, a25
    v_mul_f32 v235, v235, v232
    v_accvgpr_write_b32 a25, v235
    v_accvgpr_read_b32 v236, a26
    v_mul_f32 v236, v236, v232
    v_accvgpr_write_b32 a26, v236
    v_accvgpr_read_b32 v237, a27
    v_mul_f32 v237, v237, v232
    v_accvgpr_write_b32 a27, v237
    v_accvgpr_read_b32 v234, a28
    v_mul_f32 v234, v234, v232
    v_accvgpr_write_b32 a28, v234
    v_accvgpr_read_b32 v235, a29
    v_mul_f32 v235, v235, v232
    v_accvgpr_write_b32 a29, v235
    v_accvgpr_read_b32 v236, a30
    v_mul_f32 v236, v236, v232
    v_accvgpr_write_b32 a30, v236
    v_accvgpr_read_b32 v237, a31
    v_mul_f32 v237, v237, v232
    v_accvgpr_write_b32 a31, v237
    v_accvgpr_read_b32 v234, a32
    v_mul_f32 v234, v234, v232
    v_accvgpr_write_b32 a32, v234
    v_accvgpr_read_b32 v235, a33
    v_mul_f32 v235, v235, v232
    v_accvgpr_write_b32 a33, v235
    v_accvgpr_read_b32 v236, a34
    v_mul_f32 v236, v236, v232
    v_accvgpr_write_b32 a34, v236
    v_accvgpr_read_b32 v237, a35
    v_mul_f32 v237, v237, v232
    v_accvgpr_write_b32 a35, v237
    v_accvgpr_read_b32 v234, a36
    v_mul_f32 v234, v234, v232
    v_accvgpr_write_b32 a36, v234
    v_accvgpr_read_b32 v235, a37
    v_mul_f32 v235, v235, v232
    v_accvgpr_write_b32 a37, v235
    v_accvgpr_read_b32 v236, a38
    v_mul_f32 v236, v236, v232
    v_accvgpr_write_b32 a38, v236
    v_accvgpr_read_b32 v237, a39
    v_mul_f32 v237, v237, v232
    v_accvgpr_write_b32 a39, v237
    v_accvgpr_read_b32 v234, a40
    v_mul_f32 v234, v234, v232
    v_accvgpr_write_b32 a40, v234
    v_accvgpr_read_b32 v235, a41
    v_mul_f32 v235, v235, v232
    v_accvgpr_write_b32 a41, v235
    v_accvgpr_read_b32 v236, a42
    v_mul_f32 v236, v236, v232
    v_accvgpr_write_b32 a42, v236
    v_accvgpr_read_b32 v237, a43
    v_mul_f32 v237, v237, v232
    v_accvgpr_write_b32 a43, v237
    v_accvgpr_read_b32 v234, a44
    v_mul_f32 v234, v234, v232
    v_accvgpr_write_b32 a44, v234
    v_accvgpr_read_b32 v235, a45
    v_mul_f32 v235, v235, v232
    v_accvgpr_write_b32 a45, v235
    v_accvgpr_read_b32 v236, a46
    v_mul_f32 v236, v236, v232
    v_accvgpr_write_b32 a46, v236
    v_accvgpr_read_b32 v237, a47
    v_mul_f32 v237, v237, v232
    v_accvgpr_write_b32 a47, v237
    v_accvgpr_read_b32 v234, a48
    v_mul_f32 v234, v234, v232
    v_accvgpr_write_b32 a48, v234
    v_accvgpr_read_b32 v235, a49
    v_mul_f32 v235, v235, v232
    v_accvgpr_write_b32 a49, v235
    v_accvgpr_read_b32 v236, a50
    v_mul_f32 v236, v236, v232
    v_accvgpr_write_b32 a50, v236
    v_accvgpr_read_b32 v237, a51
    v_mul_f32 v237, v237, v232
    v_accvgpr_write_b32 a51, v237
    v_accvgpr_read_b32 v234, a52
    v_mul_f32 v234, v234, v232
    v_accvgpr_write_b32 a52, v234
    v_accvgpr_read_b32 v235, a53
    v_mul_f32 v235, v235, v232
    v_accvgpr_write_b32 a53, v235
    v_accvgpr_read_b32 v236, a54
    v_mul_f32 v236, v236, v232
    v_accvgpr_write_b32 a54, v236
    v_accvgpr_read_b32 v237, a55
    v_mul_f32 v237, v237, v232
    v_accvgpr_write_b32 a55, v237
    v_accvgpr_read_b32 v234, a56
    v_mul_f32 v234, v234, v232
    v_accvgpr_write_b32 a56, v234
    v_accvgpr_read_b32 v235, a57
    v_mul_f32 v235, v235, v232
    v_accvgpr_write_b32 a57, v235
    v_accvgpr_read_b32 v236, a58
    v_mul_f32 v236, v236, v232
    v_accvgpr_write_b32 a58, v236
    v_accvgpr_read_b32 v237, a59
    v_mul_f32 v237, v237, v232
    v_accvgpr_write_b32 a59, v237
    v_accvgpr_read_b32 v234, a60
    v_mul_f32 v234, v234, v232
    v_accvgpr_write_b32 a60, v234
    v_accvgpr_read_b32 v235, a61
    v_mul_f32 v235, v235, v232
    v_accvgpr_write_b32 a61, v235
    v_accvgpr_read_b32 v236, a62
    v_mul_f32 v236, v236, v232
    v_accvgpr_write_b32 a62, v236
    v_accvgpr_read_b32 v237, a63
    v_mul_f32 v237, v237, v232
    v_accvgpr_write_b32 a63, v237
    v_exp_f32 v136, v32
    v_exp_f32 v137, v33
    v_exp_f32 v130, v34
    v_exp_f32 v131, v35
    v_cvt_pk_bf16_f32 v112, v136, v137
    v_exp_f32 v132, v36
    v_exp_f32 v133, v37
    v_cvt_pk_bf16_f32 v113, v130, v131
    v_add_f32 v136, v136, v130
    v_add_f32 v137, v137, v131
    v_exp_f32 v134, v38
    v_exp_f32 v135, v39
    v_cvt_pk_bf16_f32 v114, v132, v133
    v_add_f32 v136, v136, v132
    v_add_f32 v137, v137, v133
    v_exp_f32 v128, v40
    v_exp_f32 v129, v41
    v_cvt_pk_bf16_f32 v115, v134, v135
    v_add_f32 v136, v136, v134
    v_add_f32 v137, v137, v135
    v_exp_f32 v130, v42
    v_exp_f32 v131, v43
    v_cvt_pk_bf16_f32 v116, v128, v129
    v_add_f32 v136, v136, v128
    v_add_f32 v137, v137, v129
    v_exp_f32 v132, v44
    v_exp_f32 v133, v45
    v_cvt_pk_bf16_f32 v117, v130, v131
    v_add_f32 v136, v136, v130
    v_add_f32 v137, v137, v131
    v_exp_f32 v134, v46
    v_exp_f32 v135, v47
    v_cvt_pk_bf16_f32 v118, v132, v133
    v_add_f32 v136, v136, v132
    v_add_f32 v137, v137, v133
    v_cvt_pk_bf16_f32 v119, v134, v135
    v_add_f32 v136, v136, v134
    v_add_f32 v137, v137, v135
    v_add_f32 v224, v136, v137
    v_max3_f32 v230, v48, v49, v50
    v_max3_f32 v230, v230, v51, v52
    v_max3_f32 v230, v230, v53, v54
    v_max3_f32 v230, v230, v55, v56
    v_max3_f32 v230, v230, v57, v58
    v_max3_f32 v230, v230, v59, v60
    v_max3_f32 v230, v230, v61, v62
    v_max_f32 v230, v230, v63
    v_mov_b32 v231, v230
    s_nop 1
    v_permlane32_swap_b32 v230, v231
    s_nop 0
    v_max_f32 v230, v230, v231
    v_max_f32 v230, 0, v230
    v_sub_f32 v232, 0, v230
    v_exp_f32 v232, v232
    v_sub_f32 v229, v229, v230
    v_sub_f32 v80, v80, v230
    v_sub_f32 v16, v16, v230
    v_sub_f32 v48, v48, v230
    v_sub_f32 v81, v81, v230
    v_sub_f32 v17, v17, v230
    v_sub_f32 v49, v49, v230
    v_sub_f32 v82, v82, v230
    v_sub_f32 v18, v18, v230
    v_sub_f32 v50, v50, v230
    v_sub_f32 v83, v83, v230
    v_sub_f32 v19, v19, v230
    v_sub_f32 v51, v51, v230
    v_sub_f32 v84, v84, v230
    v_sub_f32 v20, v20, v230
    v_sub_f32 v52, v52, v230
    v_sub_f32 v85, v85, v230
    v_sub_f32 v21, v21, v230
    v_sub_f32 v53, v53, v230
    v_sub_f32 v86, v86, v230
    v_sub_f32 v22, v22, v230
    v_sub_f32 v54, v54, v230
    v_sub_f32 v87, v87, v230
    v_sub_f32 v23, v23, v230
    v_sub_f32 v55, v55, v230
    v_sub_f32 v88, v88, v230
    v_sub_f32 v24, v24, v230
    v_sub_f32 v56, v56, v230
    v_sub_f32 v89, v89, v230
    v_sub_f32 v25, v25, v230
    v_sub_f32 v57, v57, v230
    v_sub_f32 v90, v90, v230
    v_sub_f32 v26, v26, v230
    v_sub_f32 v58, v58, v230
    v_sub_f32 v91, v91, v230
    v_sub_f32 v27, v27, v230
    v_sub_f32 v59, v59, v230
    v_sub_f32 v92, v92, v230
    v_sub_f32 v28, v28, v230
    v_sub_f32 v60, v60, v230
    v_sub_f32 v93, v93, v230
    v_sub_f32 v29, v29, v230
    v_sub_f32 v61, v61, v230
    v_sub_f32 v94, v94, v230
    v_sub_f32 v30, v30, v230
    v_sub_f32 v62, v62, v230
    v_sub_f32 v95, v95, v230
    v_sub_f32 v31, v31, v230
    v_sub_f32 v63, v63, v230
    v_mul_f32 v227, v227, v232
    v_accvgpr_read_b32 v234, a64
    v_mul_f32 v234, v234, v232
    v_accvgpr_write_b32 a64, v234
    v_accvgpr_read_b32 v235, a65
    v_mul_f32 v235, v235, v232
    v_accvgpr_write_b32 a65, v235
    v_accvgpr_read_b32 v236, a66
    v_mul_f32 v236, v236, v232
    v_accvgpr_write_b32 a66, v236
    v_accvgpr_read_b32 v237, a67
    v_mul_f32 v237, v237, v232
    v_accvgpr_write_b32 a67, v237
    v_accvgpr_read_b32 v234, a68
    v_mul_f32 v234, v234, v232
    v_accvgpr_write_b32 a68, v234
    v_accvgpr_read_b32 v235, a69
    v_mul_f32 v235, v235, v232
    v_accvgpr_write_b32 a69, v235
    v_accvgpr_read_b32 v236, a70
    v_mul_f32 v236, v236, v232
    v_accvgpr_write_b32 a70, v236
    v_accvgpr_read_b32 v237, a71
    v_mul_f32 v237, v237, v232
    v_accvgpr_write_b32 a71, v237
    v_accvgpr_read_b32 v234, a72
    v_mul_f32 v234, v234, v232
    v_accvgpr_write_b32 a72, v234
    v_accvgpr_read_b32 v235, a73
    v_mul_f32 v235, v235, v232
    v_accvgpr_write_b32 a73, v235
    v_accvgpr_read_b32 v236, a74
    v_mul_f32 v236, v236, v232
    v_accvgpr_write_b32 a74, v236
    v_accvgpr_read_b32 v237, a75
    v_mul_f32 v237, v237, v232
    v_accvgpr_write_b32 a75, v237
    v_accvgpr_read_b32 v234, a76
    v_mul_f32 v234, v234, v232
    v_accvgpr_write_b32 a76, v234
    v_accvgpr_read_b32 v235, a77
    v_mul_f32 v235, v235, v232
    v_accvgpr_write_b32 a77, v235
    v_accvgpr_read_b32 v236, a78
    v_mul_f32 v236, v236, v232
    v_accvgpr_write_b32 a78, v236
    v_accvgpr_read_b32 v237, a79
    v_mul_f32 v237, v237, v232
    v_accvgpr_write_b32 a79, v237
    v_accvgpr_read_b32 v234, a80
    v_mul_f32 v234, v234, v232
    v_accvgpr_write_b32 a80, v234
    v_accvgpr_read_b32 v235, a81
    v_mul_f32 v235, v235, v232
    v_accvgpr_write_b32 a81, v235
    v_accvgpr_read_b32 v236, a82
    v_mul_f32 v236, v236, v232
    v_accvgpr_write_b32 a82, v236
    v_accvgpr_read_b32 v237, a83
    v_mul_f32 v237, v237, v232
    v_accvgpr_write_b32 a83, v237
    v_accvgpr_read_b32 v234, a84
    v_mul_f32 v234, v234, v232
    v_accvgpr_write_b32 a84, v234
    v_accvgpr_read_b32 v235, a85
    v_mul_f32 v235, v235, v232
    v_accvgpr_write_b32 a85, v235
    v_accvgpr_read_b32 v236, a86
    v_mul_f32 v236, v236, v232
    v_accvgpr_write_b32 a86, v236
    v_accvgpr_read_b32 v237, a87
    v_mul_f32 v237, v237, v232
    v_accvgpr_write_b32 a87, v237
    v_accvgpr_read_b32 v234, a88
    v_mul_f32 v234, v234, v232
    v_accvgpr_write_b32 a88, v234
    v_accvgpr_read_b32 v235, a89
    v_mul_f32 v235, v235, v232
    v_accvgpr_write_b32 a89, v235
    v_accvgpr_read_b32 v236, a90
    v_mul_f32 v236, v236, v232
    v_accvgpr_write_b32 a90, v236
    v_accvgpr_read_b32 v237, a91
    v_mul_f32 v237, v237, v232
    v_accvgpr_write_b32 a91, v237
    v_accvgpr_read_b32 v234, a92
    v_mul_f32 v234, v234, v232
    v_accvgpr_write_b32 a92, v234
    v_accvgpr_read_b32 v235, a93
    v_mul_f32 v235, v235, v232
    v_accvgpr_write_b32 a93, v235
    v_accvgpr_read_b32 v236, a94
    v_mul_f32 v236, v236, v232
    v_accvgpr_write_b32 a94, v236
    v_accvgpr_read_b32 v237, a95
    v_mul_f32 v237, v237, v232
    v_accvgpr_write_b32 a95, v237
    v_accvgpr_read_b32 v234, a96
    v_mul_f32 v234, v234, v232
    v_accvgpr_write_b32 a96, v234
    v_accvgpr_read_b32 v235, a97
    v_mul_f32 v235, v235, v232
    v_accvgpr_write_b32 a97, v235
    v_accvgpr_read_b32 v236, a98
    v_mul_f32 v236, v236, v232
    v_accvgpr_write_b32 a98, v236
    v_accvgpr_read_b32 v237, a99
    v_mul_f32 v237, v237, v232
    v_accvgpr_write_b32 a99, v237
    v_accvgpr_read_b32 v234, a100
    v_mul_f32 v234, v234, v232
    v_accvgpr_write_b32 a100, v234
    v_accvgpr_read_b32 v235, a101
    v_mul_f32 v235, v235, v232
    v_accvgpr_write_b32 a101, v235
    v_accvgpr_read_b32 v236, a102
    v_mul_f32 v236, v236, v232
    v_accvgpr_write_b32 a102, v236
    v_accvgpr_read_b32 v237, a103
    v_mul_f32 v237, v237, v232
    v_accvgpr_write_b32 a103, v237
    v_accvgpr_read_b32 v234, a104
    v_mul_f32 v234, v234, v232
    v_accvgpr_write_b32 a104, v234
    v_accvgpr_read_b32 v235, a105
    v_mul_f32 v235, v235, v232
    v_accvgpr_write_b32 a105, v235
    v_accvgpr_read_b32 v236, a106
    v_mul_f32 v236, v236, v232
    v_accvgpr_write_b32 a106, v236
    v_accvgpr_read_b32 v237, a107
    v_mul_f32 v237, v237, v232
    v_accvgpr_write_b32 a107, v237
    v_accvgpr_read_b32 v234, a108
    v_mul_f32 v234, v234, v232
    v_accvgpr_write_b32 a108, v234
    v_accvgpr_read_b32 v235, a109
    v_mul_f32 v235, v235, v232
    v_accvgpr_write_b32 a109, v235
    v_accvgpr_read_b32 v236, a110
    v_mul_f32 v236, v236, v232
    v_accvgpr_write_b32 a110, v236
    v_accvgpr_read_b32 v237, a111
    v_mul_f32 v237, v237, v232
    v_accvgpr_write_b32 a111, v237
    v_accvgpr_read_b32 v234, a112
    v_mul_f32 v234, v234, v232
    v_accvgpr_write_b32 a112, v234
    v_accvgpr_read_b32 v235, a113
    v_mul_f32 v235, v235, v232
    v_accvgpr_write_b32 a113, v235
    v_accvgpr_read_b32 v236, a114
    v_mul_f32 v236, v236, v232
    v_accvgpr_write_b32 a114, v236
    v_accvgpr_read_b32 v237, a115
    v_mul_f32 v237, v237, v232
    v_accvgpr_write_b32 a115, v237
    v_accvgpr_read_b32 v234, a116
    v_mul_f32 v234, v234, v232
    v_accvgpr_write_b32 a116, v234
    v_accvgpr_read_b32 v235, a117
    v_mul_f32 v235, v235, v232
    v_accvgpr_write_b32 a117, v235
    v_accvgpr_read_b32 v236, a118
    v_mul_f32 v236, v236, v232
    v_accvgpr_write_b32 a118, v236
    v_accvgpr_read_b32 v237, a119
    v_mul_f32 v237, v237, v232
    v_accvgpr_write_b32 a119, v237
    v_accvgpr_read_b32 v234, a120
    v_mul_f32 v234, v234, v232
    v_accvgpr_write_b32 a120, v234
    v_accvgpr_read_b32 v235, a121
    v_mul_f32 v235, v235, v232
    v_accvgpr_write_b32 a121, v235
    v_accvgpr_read_b32 v236, a122
    v_mul_f32 v236, v236, v232
    v_accvgpr_write_b32 a122, v236
    v_accvgpr_read_b32 v237, a123
    v_mul_f32 v237, v237, v232
    v_accvgpr_write_b32 a123, v237
    v_accvgpr_read_b32 v234, a124
    v_mul_f32 v234, v234, v232
    v_accvgpr_write_b32 a124, v234
    v_accvgpr_read_b32 v235, a125
    v_mul_f32 v235, v235, v232
    v_accvgpr_write_b32 a125, v235
    v_accvgpr_read_b32 v236, a126
    v_mul_f32 v236, v236, v232
    v_accvgpr_write_b32 a126, v236
    v_accvgpr_read_b32 v237, a127
    v_mul_f32 v237, v237, v232
    v_accvgpr_write_b32 a127, v237
    v_exp_f32 v138, v48
    v_exp_f32 v139, v49
    v_exp_f32 v130, v50
    v_exp_f32 v131, v51
    v_cvt_pk_bf16_f32 v120, v138, v139
    v_exp_f32 v132, v52
    v_exp_f32 v133, v53
    v_cvt_pk_bf16_f32 v121, v130, v131
    v_add_f32 v138, v138, v130
    v_add_f32 v139, v139, v131
    v_exp_f32 v134, v54
    v_exp_f32 v135, v55
    v_cvt_pk_bf16_f32 v122, v132, v133
    v_add_f32 v138, v138, v132
    v_add_f32 v139, v139, v133
    v_exp_f32 v128, v56
    v_exp_f32 v129, v57
    v_cvt_pk_bf16_f32 v123, v134, v135
    v_add_f32 v138, v138, v134
    v_add_f32 v139, v139, v135
    v_exp_f32 v130, v58
    v_exp_f32 v131, v59
    v_cvt_pk_bf16_f32 v124, v128, v129
    v_add_f32 v138, v138, v128
    v_add_f32 v139, v139, v129
    v_exp_f32 v132, v60
    v_exp_f32 v133, v61
    v_cvt_pk_bf16_f32 v125, v130, v131
    v_add_f32 v138, v138, v130
    v_add_f32 v139, v139, v131
    v_exp_f32 v134, v62
    v_exp_f32 v135, v63
    v_cvt_pk_bf16_f32 v126, v132, v133
    v_add_f32 v138, v138, v132
    v_add_f32 v139, v139, v133
    v_cvt_pk_bf16_f32 v127, v134, v135
    v_add_f32 v138, v138, v134
    v_add_f32 v139, v139, v135
    v_add_f32 v225, v138, v139
    s_nop 1
    s_branch kf_rr9
kf_l2p11:
    buffer_load_dword v252, v245, s[56:59], s28 offen
    s_add_u32 s28, s28, 4096
    s_and_b32 s27, s28, 0x7000
    s_cselect_b32 s27, 0, 0x1000
    s_branch kf_l2r12
kf_fix13:
    s_cmp_eq_u32 s33, 0
    s_cselect_b32 s24, 0, 0x74000000
    s_cselect_b32 s36, 0, 0x1000
    s_mov_b32 s33, 1
    v_subrev_f32 v230, s24, v243
    v_add_f32 v231, 0, v230
    v_min_f32 v64, v228, v231
    v_add_f32 v232, 0xf1800000, v230
    v_min_f32 v65, v228, v232
    v_add_f32 v231, 0xf2000000, v230
    v_min_f32 v66, v228, v231
    v_add_f32 v232, 0xf2400000, v230
    v_min_f32 v67, v228, v232
    v_add_f32 v231, 0xf3000000, v230
    v_min_f32 v68, v228, v231
    v_add_f32 v232, 0xf3100000, v230
    v_min_f32 v69, v228, v232
    v_add_f32 v231, 0xf3200000, v230
    v_min_f32 v70, v228, v231
    v_add_f32 v232, 0xf3300000, v230
    v_min_f32 v71, v228, v232
    v_add_f32 v231, 0xf3800000, v230
    v_min_f32 v72, v228, v231
    v_add_f32 v232, 0xf3880000, v230
    v_min_f32 v73, v228, v232
    v_add_f32 v231, 0xf3900000, v230
    v_min_f32 v74, v228, v231
    v_add_f32 v232, 0xf3980000, v230
    v_min_f32 v75, v228, v232
    v_add_f32 v231, 0xf3c00000, v230
    v_min_f32 v76, v228, v231
    v_add_f32 v232, 0xf3c80000, v230
    v_min_f32 v77, v228, v232
    v_add_f32 v231, 0xf3d00000, v230
    v_min_f32 v78, v228, v231
    v_add_f32 v232, 0xf3d80000, v230
    v_min_f32 v79, v228, v232
    s_nop 1
    s_branch kf_fixr14
kf_rare16:
    s_nop 15
    v_max3_f32 v230, v0, v1, v2
    v_max3_f32 v230, v230, v3, v4
    v_max3_f32 v230, v230, v5, v6
    v_max3_f32 v230, v230, v7, v8
    v_max3_f32 v230, v230, v9, v10
    v_max3_f32 v230, v230, v11, v12
    v_max3_f32 v230, v230, v13, v14
    v_max_f32 v230, v230, v15
    v_mov_b32 v231, v230
    s_nop 1
    v_permlane32_swap_b32 v230, v231
    s_nop 0
    v_max_f32 v230, v230, v231
    v_max_f32 v230, 0, v230
    v_sub_f32 v232, 0, v230
    v_exp_f32 v232, v232
    v_sub_f32 v228, v228, v230
    v_sub_f32 v64, v64, v230
    v_sub_f32 v32, v32, v230
    v_sub_f32 v0, v0, v230
    v_sub_f32 v65, v65, v230
    v_sub_f32 v33, v33, v230
    v_sub_f32 v1, v1, v230
    v_sub_f32 v66, v66, v230
    v_sub_f32 v34, v34, v230
    v_sub_f32 v2, v2, v230
    v_sub_f32 v67, v67, v230
    v_sub_f32 v35, v35, v230
    v_sub_f32 v3, v3, v230
    v_sub_f32 v68, v68, v230
    v_sub_f32 v36, v36, v230
    v_sub_f32 v4, v4, v230
    v_sub_f32 v69, v69, v230
    v_sub_f32 v37, v37, v230
    v_sub_f32 v5, v5, v230
    v_sub_f32 v70, v70, v230
    v_sub_f32 v38, v38, v230
    v_sub_f32 v6, v6, v230
    v_sub_f32 v71, v71, v230
    v_sub_f32 v39, v39, v230
    v_sub_f32 v7, v7, v230
    v_sub_f32 v72, v72, v230
    v_sub_f32 v40, v40, v230
    v_sub_f32 v8, v8, v230
    v_sub_f32 v73, v73, v230
    v_sub_f32 v41, v41, v230
    v_sub_f32 v9, v9, v230
    v_sub_f32 v74, v74, v230
    v_sub_f32 v42, v42, v230
    v_sub_f32 v10, v10, v230
    v_sub_f32 v75, v75, v230
    v_sub_f32 v43, v43, v230
    v_sub_f32 v11, v11, v230
    v_sub_f32 v76, v76, v230
    v_sub_f32 v44, v44, v230
    v_sub_f32 v12, v12, v230
    v_sub_f32 v77, v77, v230
    v_sub_f32 v45, v45, v230
    v_sub_f32 v13, v13, v230
    v_sub_f32 v78, v78, v230
    v_sub_f32 v46, v46, v230
    v_sub_f32 v14, v14, v230
    v_sub_f32 v79, v79, v230
    v_sub_f32 v47, v47, v230
    v_sub_f32 v15, v15, v230
    v_mul_f32 v226, v226, v232
    v_accvgpr_read_b32 v234, a0
    v_mul_f32 v234, v234, v232
    v_accvgpr_write_b32 a0, v234
    v_accvgpr_read_b32 v235, a1
    v_mul_f32 v235, v235, v232
    v_accvgpr_write_b32 a1, v235
    v_accvgpr_read_b32 v236, a2
    v_mul_f32 v236, v236, v232
    v_accvgpr_write_b32 a2, v236
    v_accvgpr_read_b32 v237, a3
    v_mul_f32 v237, v237, v232
    v_accvgpr_write_b32 a3, v237
    v_accvgpr_read_b32 v234, a4
    v_mul_f32 v234, v234, v232
    v_accvgpr_write_b32 a4, v234
    v_accvgpr_read_b32 v235, a5
    v_mul_f32 v235, v235, v232
    v_accvgpr_write_b32 a5, v235
    v_accvgpr_read_b32 v236, a6
    v_mul_f32 v236, v236, v232
    v_accvgpr_write_b32 a6, v236
    v_accvgpr_read_b32 v237, a7
    v_mul_f32 v237, v237, v232
    v_accvgpr_write_b32 a7, v237
    v_accvgpr_read_b32 v234, a8
    v_mul_f32 v234, v234, v232
    v_accvgpr_write_b32 a8, v234
    v_accvgpr_read_b32 v235, a9
    v_mul_f32 v235, v235, v232
    v_accvgpr_write_b32 a9, v235
    v_accvgpr_read_b32 v236, a10
    v_mul_f32 v236, v236, v232
    v_accvgpr_write_b32 a10, v236
    v_accvgpr_read_b32 v237, a11
    v_mul_f32 v237, v237, v232
    v_accvgpr_write_b32 a11, v237
    v_accvgpr_read_b32 v234, a12
    v_mul_f32 v234, v234, v232
    v_accvgpr_write_b32 a12, v234
    v_accvgpr_read_b32 v235, a13
    v_mul_f32 v235, v235, v232
    v_accvgpr_write_b32 a13, v235
    v_accvgpr_read_b32 v236, a14
    v_mul_f32 v236, v236, v232
    v_accvgpr_write_b32 a14, v236
    v_accvgpr_read_b32 v237, a15
    v_mul_f32 v237, v237, v232
    v_accvgpr_write_b32 a15, v237
    v_accvgpr_read_b32 v234, a16
    v_mul_f32 v234, v234, v232
    v_accvgpr_write_b32 a16, v234
    v_accvgpr_read_b32 v235, a17
    v_mul_f32 v235, v235, v232
    v_accvgpr_write_b32 a17, v235
    v_accvgpr_read_b32 v236, a18
    v_mul_f32 v236, v236, v232
    v_accvgpr_write_b32 a18, v236
    v_accvgpr_read_b32 v237, a19
    v_mul_f32 v237, v237, v232
    v_accvgpr_write_b32 a19, v237
    v_accvgpr_read_b32 v234, a20
    v_mul_f32 v234, v234, v232
    v_accvgpr_write_b32 a20, v234
    v_accvgpr_read_b32 v235, a21
    v_mul_f32 v235, v235, v232
    v_accvgpr_write_b32 a21, v235
    v_accvgpr_read_b32 v236, a22
    v_mul_f32 v236, v236, v232
    v_accvgpr_write_b32 a22, v236
    v_accvgpr_read_b32 v237, a23
    v_mul_f32 v237, v237, v232
    v_accvgpr_write_b32 a23, v237
    v_accvgpr_read_b32 v234, a24
    v_mul_f32 v234, v234, v232
    v_accvgpr_write_b32 a24, v234
    v_accvgpr_read_b32 v235, a25
    v_mul_f32 v235, v235, v232
    v_accvgpr_write_b32 a25, v235
    v_accvgpr_read_b32 v236, a26
    v_mul_f32 v236, v236, v232
    v_accvgpr_write_b32 a26, v236
    v_accvgpr_read_b32 v237, a27
    v_mul_f32 v237, v237, v232
    v_accvgpr_write_b32 a27, v237
    v_accvgpr_read_b32 v234, a28
    v_mul_f32 v234, v234, v232
    v_accvgpr_write_b32 a28, v234
    v_accvgpr_read_b32 v235, a29
    v_mul_f32 v235, v235, v232
    v_accvgpr_write_b32 a29, v235
    v_accvgpr_read_b32 v236, a30
    v_mul_f32 v236, v236, v232
    v_accvgpr_write_b32 a30, v236
    v_accvgpr_read_b32 v237, a31
    v_mul_f32 v237, v237, v232
    v_accvgpr_write_b32 a31, v237
    v_accvgpr_read_b32 v234, a32
    v_mul_f32 v234, v234, v232
    v_accvgpr_write_b32 a32, v234
    v_accvgpr_read_b32 v235, a33
    v_mul_f32 v235, v235, v232
    v_accvgpr_write_b32 a33, v235
    v_accvgpr_read_b32 v236, a34
    v_mul_f32 v236, v236, v232
    v_accvgpr_write_b32 a34, v236
    v_accvgpr_read_b32 v237, a35
    v_mul_f32 v237, v237, v232
    v_accvgpr_write_b32 a35, v237
    v_accvgpr_read_b32 v234, a36
    v_mul_f32 v234, v234, v232
    v_accvgpr_write_b32 a36, v234
    v_accvgpr_read_b32 v235, a37
    v_mul_f32 v235, v235, v232
    v_accvgpr_write_b32 a37, v235
    v_accvgpr_read_b32 v236, a38
    v_mul_f32 v236, v236, v232
    v_accvgpr_write_b32 a38, v236
    v_accvgpr_read_b32 v237, a39
    v_mul_f32 v237, v237, v232
    v_accvgpr_write_b32 a39, v237
    v_accvgpr_read_b32 v234, a40
    v_mul_f32 v234, v234, v232
    v_accvgpr_write_b32 a40, v234
    v_accvgpr_read_b32 v235, a41
    v_mul_f32 v235, v235, v232
    v_accvgpr_write_b32 a41, v235
    v_accvgpr_read_b32 v236, a42
    v_mul_f32 v236, v236, v232
    v_accvgpr_write_b32 a42, v236
    v_accvgpr_read_b32 v237, a43
    v_mul_f32 v237, v237, v232
    v_accvgpr_write_b32 a43, v237
    v_accvgpr_read_b32 v234, a44
    v_mul_f32 v234, v234, v232
    v_accvgpr_write_b32 a44, v234
    v_accvgpr_read_b32 v235, a45
    v_mul_f32 v235, v235, v232
    v_accvgpr_write_b32 a45, v235
    v_accvgpr_read_b32 v236, a46
    v_mul_f32 v236, v236, v232
    v_accvgpr_write_b32 a46, v236
    v_accvgpr_read_b32 v237, a47
    v_mul_f32 v237, v237, v232
    v_accvgpr_write_b32 a47, v237
    v_accvgpr_read_b32 v234, a48
    v_mul_f32 v234, v234, v232
    v_accvgpr_write_b32 a48, v234
    v_accvgpr_read_b32 v235, a49
    v_mul_f32 v235, v235, v232
    v_accvgpr_write_b32 a49, v235
    v_accvgpr_read_b32 v236, a50
    v_mul_f32 v236, v236, v232
    v_accvgpr_write_b32 a50, v236
    v_accvgpr_read_b32 v237, a51
    v_mul_f32 v237, v237, v232
    v_accvgpr_write_b32 a51, v237
    v_accvgpr_read_b32 v234, a52
    v_mul_f32 v234, v234, v232
    v_accvgpr_write_b32 a52, v234
    v_accvgpr_read_b32 v235, a53
    v_mul_f32 v235, v235, v232
    v_accvgpr_write_b32 a53, v235
    v_accvgpr_read_b32 v236, a54
    v_mul_f32 v236, v236, v232
    v_accvgpr_write_b32 a54, v236
    v_accvgpr_read_b32 v237, a55
    v_mul_f32 v237, v237, v232
    v_accvgpr_write_b32 a55, v237
    v_accvgpr_read_b32 v234, a56
    v_mul_f32 v234, v234, v232
    v_accvgpr_write_b32 a56, v234
    v_accvgpr_read_b32 v235, a57
    v_mul_f32 v235, v235, v232
    v_accvgpr_write_b32 a57, v235
    v_accvgpr_read_b32 v236, a58
    v_mul_f32 v236, v236, v232
    v_accvgpr_write_b32 a58, v236
    v_accvgpr_read_b32 v237, a59
    v_mul_f32 v237, v237, v232
    v_accvgpr_write_b32 a59, v237
    v_accvgpr_read_b32 v234, a60
    v_mul_f32 v234, v234, v232
    v_accvgpr_write_b32 a60, v234
    v_accvgpr_read_b32 v235, a61
    v_mul_f32 v235, v235, v232
    v_accvgpr_write_b32 a61, v235
    v_accvgpr_read_b32 v236, a62
    v_mul_f32 v236, v236, v232
    v_accvgpr_write_b32 a62, v236
    v_accvgpr_read_b32 v237, a63
    v_mul_f32 v237, v237, v232
    v_accvgpr_write_b32 a63, v237
    v_exp_f32 v136, v0
    v_exp_f32 v137, v1
    v_exp_f32 v130, v2
    v_exp_f32 v131, v3
    v_cvt_pk_bf16_f32 v96, v136, v137
    v_exp_f32 v132, v4
    v_exp_f32 v133, v5
    v_cvt_pk_bf16_f32 v97, v130, v131
    v_add_f32 v136, v136, v130
    v_add_f32 v137, v137, v131
    v_exp_f32 v134, v6
    v_exp_f32 v135, v7
    v_cvt_pk_bf16_f32 v98, v132, v133
    v_add_f32 v136, v136, v132
    v_add_f32 v137, v137, v133
    v_exp_f32 v128, v8
    v_exp_f32 v129, v9
    v_cvt_pk_bf16_f32 v99, v134, v135
    v_add_f32 v136, v136, v134
    v_add_f32 v137, v137, v135
    v_exp_f32 v130, v10
    v_exp_f32 v131, v11
    v_cvt_pk_bf16_f32 v100, v128, v129
    v_add_f32 v136, v136, v128
    v_add_f32 v137, v137, v129
    v_exp_f32 v132, v12
    v_exp_f32 v133, v13
    v_cvt_pk_bf16_f32 v101, v130, v131
    v_add_f32 v136, v136, v130
    v_add_f32 v137, v137, v131
    v_exp_f32 v134, v14
    v_exp_f32 v135, v15
    v_cvt_pk_bf16_f32 v102, v132, v133
    v_add_f32 v136, v136, v132
    v_add_f32 v137, v137, v133
    v_cvt_pk_bf16_f32 v103, v134, v135
    v_add_f32 v136, v136, v134
    v_add_f32 v137, v137, v135
    v_add_f32 v224, v136, v137
    v_max3_f32 v230, v16, v17, v18
    v_max3_f32 v230, v230, v19, v20
    v_max3_f32 v230, v230, v21, v22
    v_max3_f32 v230, v230, v23, v24
    v_max3_f32 v230, v230, v25, v26
    v_max3_f32 v230, v230, v27, v28
    v_max3_f32 v230, v230, v29, v30
    v_max_f32 v230, v230, v31
    v_mov_b32 v231, v230
    s_nop 1
    v_permlane32_swap_b32 v230, v231
    s_nop 0
    v_max_f32 v230, v230, v231
    v_max_f32 v230, 0, v230
    v_sub_f32 v232, 0, v230
    v_exp_f32 v232, v232
    v_sub_f32 v229, v229, v230
    v_sub_f32 v80, v80, v230
    v_sub_f32 v48, v48, v230
    v_sub_f32 v16, v16, v230
    v_sub_f32 v81, v81, v230
    v_sub_f32 v49, v49, v230
    v_sub_f32 v17, v17, v230
    v_sub_f32 v82, v82, v230
    v_sub_f32 v50, v50, v230
    v_sub_f32 v18, v18, v230
    v_sub_f32 v83, v83, v230
    v_sub_f32 v51, v51, v230
    v_sub_f32 v19, v19, v230
    v_sub_f32 v84, v84, v230
    v_sub_f32 v52, v52, v230
    v_sub_f32 v20, v20, v230
    v_sub_f32 v85, v85, v230
    v_sub_f32 v53, v53, v230
    v_sub_f32 v21, v21, v230
    v_sub_f32 v86, v86, v230
    v_sub_f32 v54, v54, v230
    v_sub_f32 v22, v22, v230
    v_sub_f32 v87, v87, v230
    v_sub_f32 v55, v55, v230
    v_sub_f32 v23, v23, v230
    v_sub_f32 v88, v88, v230
    v_sub_f32 v56, v56, v230
    v_sub_f32 v24, v24, v230
    v_sub_f32 v89, v89, v230
    v_sub_f32 v57, v57, v230
    v_sub_f32 v25, v25, v230
    v_sub_f32 v90, v90, v230
    v_sub_f32 v58, v58, v230
    v_sub_f32 v26, v26, v230
    v_sub_f32 v91, v91, v230
    v_sub_f32 v59, v59, v230
    v_sub_f32 v27, v27, v230
    v_sub_f32 v92, v92, v230
    v_sub_f32 v60, v60, v230
    v_sub_f32 v28, v28, v230
    v_sub_f32 v93, v93, v230
    v_sub_f32 v61, v61, v230
    v_sub_f32 v29, v29, v230
    v_sub_f32 v94, v94, v230
    v_sub_f32 v62, v62, v230
    v_sub_f32 v30, v30, v230
    v_sub_f32 v95, v95, v230
    v_sub_f32 v63, v63, v230
    v_sub_f32 v31, v31, v230
    v_mul_f32 v227, v227, v232
    v_accvgpr_read_b32 v234, a64
    v_mul_f32 v234, v234, v232
    v_accvgpr_write_b32 a64, v234
    v_accvgpr_read_b32 v235, a65
    v_mul_f32 v235, v235, v232
    v_accvgpr_write_b32 a65, v235
    v_accvgpr_read_b32 v236, a66
    v_mul_f32 v236, v236, v232
    v_accvgpr_write_b32 a66, v236
    v_accvgpr_read_b32 v237, a67
    v_mul_f32 v237, v237, v232
    v_accvgpr_write_b32 a67, v237
    v_accvgpr_read_b32 v234, a68
    v_mul_f32 v234, v234, v232
    v_accvgpr_write_b32 a68, v234
    v_accvgpr_read_b32 v235, a69
    v_mul_f32 v235, v235, v232
    v_accvgpr_write_b32 a69, v235
    v_accvgpr_read_b32 v236, a70
    v_mul_f32 v236, v236, v232
    v_accvgpr_write_b32 a70, v236
    v_accvgpr_read_b32 v237, a71
    v_mul_f32 v237, v237, v232
    v_accvgpr_write_b32 a71, v237
    v_accvgpr_read_b32 v234, a72
    v_mul_f32 v234, v234, v232
    v_accvgpr_write_b32 a72, v234
    v_accvgpr_read_b32 v235, a73
    v_mul_f32 v235, v235, v232
    v_accvgpr_write_b32 a73, v235
    v_accvgpr_read_b32 v236, a74
    v_mul_f32 v236, v236, v232
    v_accvgpr_write_b32 a74, v236
    v_accvgpr_read_b32 v237, a75
    v_mul_f32 v237, v237, v232
    v_accvgpr_write_b32 a75, v237
    v_accvgpr_read_b32 v234, a76
    v_mul_f32 v234, v234, v232
    v_accvgpr_write_b32 a76, v234
    v_accvgpr_read_b32 v235, a77
    v_mul_f32 v235, v235, v232
    v_accvgpr_write_b32 a77, v235
    v_accvgpr_read_b32 v236, a78
    v_mul_f32 v236, v236, v232
    v_accvgpr_write_b32 a78, v236
    v_accvgpr_read_b32 v237, a79
    v_mul_f32 v237, v237, v232
    v_accvgpr_write_b32 a79, v237
    v_accvgpr_read_b32 v234, a80
    v_mul_f32 v234, v234, v232
    v_accvgpr_write_b32 a80, v234
    v_accvgpr_read_b32 v235, a81
    v_mul_f32 v235, v235, v232
    v_accvgpr_write_b32 a81, v235
    v_accvgpr_read_b32 v236, a82
    v_mul_f32 v236, v236, v232
    v_accvgpr_write_b32 a82, v236
    v_accvgpr_read_b32 v237, a83
    v_mul_f32 v237, v237, v232
    v_accvgpr_write_b32 a83, v237
    v_accvgpr_read_b32 v234, a84
    v_mul_f32 v234, v234, v232
    v_accvgpr_write_b32 a84, v234
    v_accvgpr_read_b32 v235, a85
    v_mul_f32 v235, v235, v232
    v_accvgpr_write_b32 a85, v235
    v_accvgpr_read_b32 v236, a86
    v_mul_f32 v236, v236, v232
    v_accvgpr_write_b32 a86, v236
    v_accvgpr_read_b32 v237, a87
    v_mul_f32 v237, v237, v232
    v_accvgpr_write_b32 a87, v237
    v_accvgpr_read_b32 v234, a88
    v_mul_f32 v234, v234, v232
    v_accvgpr_write_b32 a88, v234
    v_accvgpr_read_b32 v235, a89
    v_mul_f32 v235, v235, v232
    v_accvgpr_write_b32 a89, v235
    v_accvgpr_read_b32 v236, a90
    v_mul_f32 v236, v236, v232
    v_accvgpr_write_b32 a90, v236
    v_accvgpr_read_b32 v237, a91
    v_mul_f32 v237, v237, v232
    v_accvgpr_write_b32 a91, v237
    v_accvgpr_read_b32 v234, a92
    v_mul_f32 v234, v234, v232
    v_accvgpr_write_b32 a92, v234
    v_accvgpr_read_b32 v235, a93
    v_mul_f32 v235, v235, v232
    v_accvgpr_write_b32 a93, v235
    v_accvgpr_read_b32 v236, a94
    v_mul_f32 v236, v236, v232
    v_accvgpr_write_b32 a94, v236
    v_accvgpr_read_b32 v237, a95
    v_mul_f32 v237, v237, v232
    v_accvgpr_write_b32 a95, v237
    v_accvgpr_read_b32 v234, a96
    v_mul_f32 v234, v234, v232
    v_accvgpr_write_b32 a96, v234
    v_accvgpr_read_b32 v235, a97
    v_mul_f32 v235, v235, v232
    v_accvgpr_write_b32 a97, v235
    v_accvgpr_read_b32 v236, a98
    v_mul_f32 v236, v236, v232
    v_accvgpr_write_b32 a98, v236
    v_accvgpr_read_b32 v237, a99
    v_mul_f32 v237, v237, v232
    v_accvgpr_write_b32 a99, v237
    v_accvgpr_read_b32 v234, a100
    v_mul_f32 v234, v234, v232
    v_accvgpr_write_b32 a100, v234
    v_accvgpr_read_b32 v235, a101
    v_mul_f32 v235, v235, v232
    v_accvgpr_write_b32 a101, v235
    v_accvgpr_read_b32 v236, a102
    v_mul_f32 v236, v236, v232
    v_accvgpr_write_b32 a102, v236
    v_accvgpr_read_b32 v237, a103
    v_mul_f32 v237, v237, v232
    v_accvgpr_write_b32 a103, v237
    v_accvgpr_read_b32 v234, a104
    v_mul_f32 v234, v234, v232
    v_accvgpr_write_b32 a104, v234
    v_accvgpr_read_b32 v235, a105
    v_mul_f32 v235, v235, v232
    v_accvgpr_write_b32 a105, v235
    v_accvgpr_read_b32 v236, a106
    v_mul_f32 v236, v236, v232
    v_accvgpr_write_b32 a106, v236
    v_accvgpr_read_b32 v237, a107
    v_mul_f32 v237, v237, v232
    v_accvgpr_write_b32 a107, v237
    v_accvgpr_read_b32 v234, a108
    v_mul_f32 v234, v234, v232
    v_accvgpr_write_b32 a108, v234
    v_accvgpr_read_b32 v235, a109
    v_mul_f32 v235, v235, v232
    v_accvgpr_write_b32 a109, v235
    v_accvgpr_read_b32 v236, a110
    v_mul_f32 v236, v236, v232
    v_accvgpr_write_b32 a110, v236
    v_accvgpr_read_b32 v237, a111
    v_mul_f32 v237, v237, v232
    v_accvgpr_write_b32 a111, v237
    v_accvgpr_read_b32 v234, a112
    v_mul_f32 v234, v234, v232
    v_accvgpr_write_b32 a112, v234
    v_accvgpr_read_b32 v235, a113
    v_mul_f32 v235, v235, v232
    v_accvgpr_write_b32 a113, v235
    v_accvgpr_read_b32 v236, a114
    v_mul_f32 v236, v236, v232
    v_accvgpr_write_b32 a114, v236
    v_accvgpr_read_b32 v237, a115
    v_mul_f32 v237, v237, v232
    v_accvgpr_write_b32 a115, v237
    v_accvgpr_read_b32 v234, a116
    v_mul_f32 v234, v234, v232
    v_accvgpr_write_b32 a116, v234
    v_accvgpr_read_b32 v235, a117
    v_mul_f32 v235, v235, v232
    v_accvgpr_write_b32 a117, v235
    v_accvgpr_read_b32 v236, a118
    v_mul_f32 v236, v236, v232
    v_accvgpr_write_b32 a118, v236
    v_accvgpr_read_b32 v237, a119
    v_mul_f32 v237, v237, v232
    v_accvgpr_write_b32 a119, v237
    v_accvgpr_read_b32 v234, a120
    v_mul_f32 v234, v234, v232
    v_accvgpr_write_b32 a120, v234
    v_accvgpr_read_b32 v235, a121
    v_mul_f32 v235, v235, v232
    v_accvgpr_write_b32 a121, v235
    v_accvgpr_read_b32 v236, a122
    v_mul_f32 v236, v236, v232
    v_accvgpr_write_b32 a122, v236
    v_accvgpr_read_b32 v237, a123
    v_mul_f32 v237, v237, v232
    v_accvgpr_write_b32 a123, v237
    v_accvgpr_read_b32 v234, a124
    v_mul_f32 v234, v234, v232
    v_accvgpr_write_b32 a124, v234
    v_accvgpr_read_b32 v235, a125
    v_mul_f32 v235, v235, v232
    v_accvgpr_write_b32 a125, v235
    v_accvgpr_read_b32 v236, a126
    v_mul_f32 v236, v236, v232
    v_accvgpr_write_b32 a126, v236
    v_accvgpr_read_b32 v237, a127
    v_mul_f32 v237, v237, v232
    v_accvgpr_write_b32 a127, v237
    v_exp_f32 v138, v16
    v_exp_f32 v139, v17
    v_exp_f32 v130, v18
    v_exp_f32 v131, v19
    v_cvt_pk_bf16_f32 v104, v138, v139
    v_exp_f32 v132, v20
    v_exp_f32 v133, v21
    v_cvt_pk_bf16_f32 v105, v130, v131
    v_add_f32 v138, v138, v130
    v_add_f32 v139, v139, v131
    v_exp_f32 v134, v22
    v_exp_f32 v135, v23
    v_cvt_pk_bf16_f32 v106, v132, v133
    v_add_f32 v138, v138, v132
    v_add_f32 v139, v139, v133
    v_exp_f32 v128, v24
    v_exp_f32 v129, v25
    v_cvt_pk_bf16_f32 v107, v134, v135
    v_add_f32 v138, v138, v134
    v_add_f32 v139, v139, v135
    v_exp_f32 v130, v26
    v_exp_f32 v131, v27
    v_cvt_pk_bf16_f32 v108, v128, v129
    v_add_f32 v138, v138, v128
    v_add_f32 v139, v139, v129
    v_exp_f32 v132, v28
    v_exp_f32 v133, v29
    v_cvt_pk_bf16_f32 v109, v130, v131
    v_add_f32 v138, v138, v130
    v_add_f32 v139, v139, v131
    v_exp_f32 v134, v30
    v_exp_f32 v135, v31
    v_cvt_pk_bf16_f32 v110, v132, v133
    v_add_f32 v138, v138, v132
    v_add_f32 v139, v139, v133
    v_cvt_pk_bf16_f32 v111, v134, v135
    v_add_f32 v138, v138, v134
    v_add_f32 v139, v139, v135
    v_add_f32 v225, v138, v139
    s_nop 1
    s_branch kf_rr15
kf_l2p17:
    buffer_load_dword v252, v245, s[56:59], s28 offen
    s_add_u32 s28, s28, 4096
    s_and_b32 s27, s28, 0x7000
    s_cselect_b32 s27, 0, 0x1000
    s_branch kf_l2r18
kf_fix19:
    s_cmp_eq_u32 s33, 0
    s_cselect_b32 s24, 0, 0x74000000
    s_cselect_b32 s36, 0, 0x1000
    s_mov_b32 s33, 1
    v_subrev_f32 v230, s24, v243
    v_add_f32 v231, 0, v230
    v_min_f32 v80, v229, v231
    v_add_f32 v232, 0xf1800000, v230
    v_min_f32 v81, v229, v232
    v_add_f32 v231, 0xf2000000, v230
    v_min_f32 v82, v229, v231
    v_add_f32 v232, 0xf2400000, v230
    v_min_f32 v83, v229, v232
    v_add_f32 v231, 0xf3000000, v230
    v_min_f32 v84, v229, v231
    v_add_f32 v232, 0xf3100000, v230
    v_min_f32 v85, v229, v232
    v_add_f32 v231, 0xf3200000, v230
    v_min_f32 v86, v229, v231
    v_add_f32 v232, 0xf3300000, v230
    v_min_f32 v87, v229, v232
    v_add_f32 v231, 0xf3800000, v230
    v_min_f32 v88, v229, v231
    v_add_f32 v232, 0xf3880000, v230
    v_min_f32 v89, v229, v232
    v_add_f32 v231, 0xf3900000, v230
    v_min_f32 v90, v229, v231
    v_add_f32 v232, 0xf3980000, v230
    v_min_f32 v91, v229, v232
    v_add_f32 v231, 0xf3c00000, v230
    v_min_f32 v92, v229, v231
    v_add_f32 v232, 0xf3c80000, v230
    v_min_f32 v93, v229, v232
    v_add_f32 v231, 0xf3d00000, v230
    v_min_f32 v94, v229, v231
    v_add_f32 v232, 0xf3d80000, v230
    v_min_f32 v95, v229, v232
    s_nop 1
    s_branch kf_fixr20
kf_rare22:
    s_nop 15
    v_max3_f32 v230, v32, v33, v34
    v_max3_f32 v230, v230, v35, v36
    v_max3_f32 v230, v230, v37, v38
    v_max3_f32 v230, v230, v39, v40
    v_max3_f32 v230, v230, v41, v42
    v_max3_f32 v230, v230, v43, v44
    v_max3_f32 v230, v230, v45, v46
    v_max_f32 v230, v230, v47
    v_mov_b32 v231, v230
    s_nop 1
    v_permlane32_swap_b32 v230, v231
    s_nop 0
    v_max_f32 v230, v230, v231
    v_max_f32 v230, 0, v230
    v_sub_f32 v232, 0, v230
    v_exp_f32 v232, v232
    v_sub_f32 v228, v228, v230
    v_sub_f32 v64, v64, v230
    v_sub_f32 v0, v0, v230
    v_sub_f32 v32, v32, v230
    v_sub_f32 v65, v65, v230
    v_sub_f32 v1, v1, v230
    v_sub_f32 v33, v33, v230
    v_sub_f32 v66, v66, v230
    v_sub_f32 v2, v2, v230
    v_sub_f32 v34, v34, v230
    v_sub_f32 v67, v67, v230
    v_sub_f32 v3, v3, v230
    v_sub_f32 v35, v35, v230
    v_sub_f32 v68, v68, v230
    v_sub_f32 v4, v4, v230
    v_sub_f32 v36, v36, v230
    v_sub_f32 v69, v69, v230
    v_sub_f32 v5, v5, v230
    v_sub_f32 v37, v37, v230
    v_sub_f32 v70, v70, v230
    v_sub_f32 v6, v6, v230
    v_sub_f32 v38, v38, v230
    v_sub_f32 v71, v71, v230
    v_sub_f32 v7, v7, v230
    v_sub_f32 v39, v39, v230
    v_sub_f32 v72, v72, v230
    v_sub_f32 v8, v8, v230
    v_sub_f32 v40, v40, v230
    v_sub_f32 v73, v73, v230
    v_sub_f32 v9, v9, v230
    v_sub_f32 v41, v41, v230
    v_sub_f32 v74, v74, v230
    v_sub_f32 v10, v10, v230
    v_sub_f32 v42, v42, v230
    v_sub_f32 v75, v75, v230
    v_sub_f32 v11, v11, v230
    v_sub_f32 v43, v43, v230
    v_sub_f32 v76, v76, v230
    v_sub_f32 v12, v12, v230
    v_sub_f32 v44, v44, v230
    v_sub_f32 v77, v77, v230
    v_sub_f32 v13, v13, v230
    v_sub_f32 v45, v45, v230
    v_sub_f32 v78, v78, v230
    v_sub_f32 v14, v14, v230
    v_sub_f32 v46, v46, v230
    v_sub_f32 v79, v79, v230
    v_sub_f32 v15, v15, v230
    v_sub_f32 v47, v47, v230
    v_mul_f32 v226, v226, v232
    v_accvgpr_read_b32 v234, a0
    v_mul_f32 v234, v234, v232
    v_accvgpr_write_b32 a0, v234
    v_accvgpr_read_b32 v235, a1
    v_mul_f32 v235, v235, v232
    v_accvgpr_write_b32 a1, v235
    v_accvgpr_read_b32 v236, a2
    v_mul_f32 v236, v236, v232
    v_accvgpr_write_b32 a2, v236
    v_accvgpr_read_b32 v237, a3
    v_mul_f32 v237, v237, v232
    v_accvgpr_write_b32 a3, v237
    v_accvgpr_read_b32 v234, a4
    v_mul_f32 v234, v234, v232
    v_accvgpr_write_b32 a4, v234
    v_accvgpr_read_b32 v235, a5
    v_mul_f32 v235, v235, v232
    v_accvgpr_write_b32 a5, v235
    v_accvgpr_read_b32 v236, a6
    v_mul_f32 v236, v236, v232
    v_accvgpr_write_b32 a6, v236
    v_accvgpr_read_b32 v237, a7
    v_mul_f32 v237, v237, v232
    v_accvgpr_write_b32 a7, v237
    v_accvgpr_read_b32 v234, a8
    v_mul_f32 v234, v234, v232
    v_accvgpr_write_b32 a8, v234
    v_accvgpr_read_b32 v235, a9
    v_mul_f32 v235, v235, v232
    v_accvgpr_write_b32 a9, v235
    v_accvgpr_read_b32 v236, a10
    v_mul_f32 v236, v236, v232
    v_accvgpr_write_b32 a10, v236
    v_accvgpr_read_b32 v237, a11
    v_mul_f32 v237, v237, v232
    v_accvgpr_write_b32 a11, v237
    v_accvgpr_read_b32 v234, a12
    v_mul_f32 v234, v234, v232
    v_accvgpr_write_b32 a12, v234
    v_accvgpr_read_b32 v235, a13
    v_mul_f32 v235, v235, v232
    v_accvgpr_write_b32 a13, v235
    v_accvgpr_read_b32 v236, a14
    v_mul_f32 v236, v236, v232
    v_accvgpr_write_b32 a14, v236
    v_accvgpr_read_b32 v237, a15
    v_mul_f32 v237, v237, v232
    v_accvgpr_write_b32 a15, v237
    v_accvgpr_read_b32 v234, a16
    v_mul_f32 v234, v234, v232
    v_accvgpr_write_b32 a16, v234
    v_accvgpr_read_b32 v235, a17
    v_mul_f32 v235, v235, v232
    v_accvgpr_write_b32 a17, v235
    v_accvgpr_read_b32 v236, a18
    v_mul_f32 v236, v236, v232
    v_accvgpr_write_b32 a18, v236
    v_accvgpr_read_b32 v237, a19
    v_mul_f32 v237, v237, v232
    v_accvgpr_write_b32 a19, v237
    v_accvgpr_read_b32 v234, a20
    v_mul_f32 v234, v234, v232
    v_accvgpr_write_b32 a20, v234
    v_accvgpr_read_b32 v235, a21
    v_mul_f32 v235, v235, v232
    v_accvgpr_write_b32 a21, v235
    v_accvgpr_read_b32 v236, a22
    v_mul_f32 v236, v236, v232
    v_accvgpr_write_b32 a22, v236
    v_accvgpr_read_b32 v237, a23
    v_mul_f32 v237, v237, v232
    v_accvgpr_write_b32 a23, v237
    v_accvgpr_read_b32 v234, a24
    v_mul_f32 v234, v234, v232
    v_accvgpr_write_b32 a24, v234
    v_accvgpr_read_b32 v235, a25
    v_mul_f32 v235, v235, v232
    v_accvgpr_write_b32 a25, v235
    v_accvgpr_read_b32 v236, a26
    v_mul_f32 v236, v236, v232
    v_accvgpr_write_b32 a26, v236
    v_accvgpr_read_b32 v237, a27
    v_mul_f32 v237, v237, v232
    v_accvgpr_write_b32 a27, v237
    v_accvgpr_read_b32 v234, a28
    v_mul_f32 v234, v234, v232
    v_accvgpr_write_b32 a28, v234
    v_accvgpr_read_b32 v235, a29
    v_mul_f32 v235, v235, v232
    v_accvgpr_write_b32 a29, v235
    v_accvgpr_read_b32 v236, a30
    v_mul_f32 v236, v236, v232
    v_accvgpr_write_b32 a30, v236
    v_accvgpr_read_b32 v237, a31
    v_mul_f32 v237, v237, v232
    v_accvgpr_write_b32 a31, v237
    v_accvgpr_read_b32 v234, a32
    v_mul_f32 v234, v234, v232
    v_accvgpr_write_b32 a32, v234
    v_accvgpr_read_b32 v235, a33
    v_mul_f32 v235, v235, v232
    v_accvgpr_write_b32 a33, v235
    v_accvgpr_read_b32 v236, a34
    v_mul_f32 v236, v236, v232
    v_accvgpr_write_b32 a34, v236
    v_accvgpr_read_b32 v237, a35
    v_mul_f32 v237, v237, v232
    v_accvgpr_write_b32 a35, v237
    v_accvgpr_read_b32 v234, a36
    v_mul_f32 v234, v234, v232
    v_accvgpr_write_b32 a36, v234
    v_accvgpr_read_b32 v235, a37
    v_mul_f32 v235, v235, v232
    v_accvgpr_write_b32 a37, v235
    v_accvgpr_read_b32 v236, a38
    v_mul_f32 v236, v236, v232
    v_accvgpr_write_b32 a38, v236
    v_accvgpr_read_b32 v237, a39
    v_mul_f32 v237, v237, v232
    v_accvgpr_write_b32 a39, v237
    v_accvgpr_read_b32 v234, a40
    v_mul_f32 v234, v234, v232
    v_accvgpr_write_b32 a40, v234
    v_accvgpr_read_b32 v235, a41
    v_mul_f32 v235, v235, v232
    v_accvgpr_write_b32 a41, v235
    v_accvgpr_read_b32 v236, a42
    v_mul_f32 v236, v236, v232
    v_accvgpr_write_b32 a42, v236
    v_accvgpr_read_b32 v237, a43
    v_mul_f32 v237, v237, v232
    v_accvgpr_write_b32 a43, v237
    v_accvgpr_read_b32 v234, a44
    v_mul_f32 v234, v234, v232
    v_accvgpr_write_b32 a44, v234
    v_accvgpr_read_b32 v235, a45
    v_mul_f32 v235, v235, v232
    v_accvgpr_write_b32 a45, v235
    v_accvgpr_read_b32 v236, a46
    v_mul_f32 v236, v236, v232
    v_accvgpr_write_b32 a46, v236
    v_accvgpr_read_b32 v237, a47
    v_mul_f32 v237, v237, v232
    v_accvgpr_write_b32 a47, v237
    v_accvgpr_read_b32 v234, a48
    v_mul_f32 v234, v234, v232
    v_accvgpr_write_b32 a48, v234
    v_accvgpr_read_b32 v235, a49
    v_mul_f32 v235, v235, v232
    v_accvgpr_write_b32 a49, v235
    v_accvgpr_read_b32 v236, a50
    v_mul_f32 v236, v236, v232
    v_accvgpr_write_b32 a50, v236
    v_accvgpr_read_b32 v237, a51
    v_mul_f32 v237, v237, v232
    v_accvgpr_write_b32 a51, v237
    v_accvgpr_read_b32 v234, a52
    v_mul_f32 v234, v234, v232
    v_accvgpr_write_b32 a52, v234
    v_accvgpr_read_b32 v235, a53
    v_mul_f32 v235, v235, v232
    v_accvgpr_write_b32 a53, v235
    v_accvgpr_read_b32 v236, a54
    v_mul_f32 v236, v236, v232
    v_accvgpr_write_b32 a54, v236
    v_accvgpr_read_b32 v237, a55
    v_mul_f32 v237, v237, v232
    v_accvgpr_write_b32 a55, v237
    v_accvgpr_read_b32 v234, a56
    v_mul_f32 v234, v234, v232
    v_accvgpr_write_b32 a56, v234
    v_accvgpr_read_b32 v235, a57
    v_mul_f32 v235, v235, v232
    v_accvgpr_write_b32 a57, v235
    v_accvgpr_read_b32 v236, a58
    v_mul_f32 v236, v236, v232
    v_accvgpr_write_b32 a58, v236
    v_accvgpr_read_b32 v237, a59
    v_mul_f32 v237, v237, v232
    v_accvgpr_write_b32 a59, v237
    v_accvgpr_read_b32 v234, a60
    v_mul_f32 v234, v234, v232
    v_accvgpr_write_b32 a60, v234
    v_accvgpr_read_b32 v235, a61
    v_mul_f32 v235, v235, v232
    v_accvgpr_write_b32 a61, v235
    v_accvgpr_read_b32 v236, a62
    v_mul_f32 v236, v236, v232
    v_accvgpr_write_b32 a62, v236
    v_accvgpr_read_b32 v237, a63
    v_mul_f32 v237, v237, v232
    v_accvgpr_write_b32 a63, v237
    v_exp_f32 v136, v32
    v_exp_f32 v137, v33
    v_exp_f32 v130, v34
    v_exp_f32 v131, v35
    v_cvt_pk_bf16_f32 v112, v136, v137
    v_exp_f32 v132, v36
    v_exp_f32 v133, v37
    v_cvt_pk_bf16_f32 v113, v130, v131
    v_add_f32 v136, v136, v130
    v_add_f32 v137, v137, v131
    v_exp_f32 v134, v38
    v_exp_f32 v135, v39
    v_cvt_pk_bf16_f32 v114, v132, v133
    v_add_f32 v136, v136, v132
    v_add_f32 v137, v137, v133
    v_exp_f32 v128, v40
    v_exp_f32 v129, v41
    v_cvt_pk_bf16_f32 v115, v134, v135
    v_add_f32 v136, v136, v134
    v_add_f32 v137, v137, v135
    v_exp_f32 v130, v42
    v_exp_f32 v131, v43
    v_cvt_pk_bf16_f32 v116, v128, v129
    v_add_f32 v136, v136, v128
    v_add_f32 v137, v137, v129
    v_exp_f32 v132, v44
    v_exp_f32 v133, v45
    v_cvt_pk_bf16_f32 v117, v130, v131
    v_add_f32 v136, v136, v130
    v_add_f32 v137, v137, v131
    v_exp_f32 v134, v46
    v_exp_f32 v135, v47
    v_cvt_pk_bf16_f32 v118, v132, v133
    v_add_f32 v136, v136, v132
    v_add_f32 v137, v137, v133
    v_cvt_pk_bf16_f32 v119, v134, v135
    v_add_f32 v136, v136, v134
    v_add_f32 v137, v137, v135
    v_add_f32 v224, v136, v137
    v_max3_f32 v230, v48, v49, v50
    v_max3_f32 v230, v230, v51, v52
    v_max3_f32 v230, v230, v53, v54
    v_max3_f32 v230, v230, v55, v56
    v_max3_f32 v230, v230, v57, v58
    v_max3_f32 v230, v230, v59, v60
    v_max3_f32 v230, v230, v61, v62
    v_max_f32 v230, v230, v63
    v_mov_b32 v231, v230
    s_nop 1
    v_permlane32_swap_b32 v230, v231
    s_nop 0
    v_max_f32 v230, v230, v231
    v_max_f32 v230, 0, v230
    v_sub_f32 v232, 0, v230
    v_exp_f32 v232, v232
    v_sub_f32 v229, v229, v230
    v_sub_f32 v80, v80, v230
    v_sub_f32 v16, v16, v230
    v_sub_f32 v48, v48, v230
    v_sub_f32 v81, v81, v230
    v_sub_f32 v17, v17, v230
    v_sub_f32 v49, v49, v230
    v_sub_f32 v82, v82, v230
    v_sub_f32 v18, v18, v230
    v_sub_f32 v50, v50, v230
    v_sub_f32 v83, v83, v230
    v_sub_f32 v19, v19, v230
    v_sub_f32 v51, v51, v230
    v_sub_f32 v84, v84, v230
    v_sub_f32 v20, v20, v230
    v_sub_f32 v52, v52, v230
    v_sub_f32 v85, v85, v230
    v_sub_f32 v21, v21, v230
    v_sub_f32 v53, v53, v230
    v_sub_f32 v86, v86, v230
    v_sub_f32 v22, v22, v230
    v_sub_f32 v54, v54, v230
    v_sub_f32 v87, v87, v230
    v_sub_f32 v23, v23, v230
    v_sub_f32 v55, v55, v230
    v_sub_f32 v88, v88, v230
    v_sub_f32 v24, v24, v230
    v_sub_f32 v56, v56, v230
    v_sub_f32 v89, v89, v230
    v_sub_f32 v25, v25, v230
    v_sub_f32 v57, v57, v230
    v_sub_f32 v90, v90, v230
    v_sub_f32 v26, v26, v230
    v_sub_f32 v58, v58, v230
    v_sub_f32 v91, v91, v230
    v_sub_f32 v27, v27, v230
    v_sub_f32 v59, v59, v230
    v_sub_f32 v92, v92, v230
    v_sub_f32 v28, v28, v230
    v_sub_f32 v60, v60, v230
    v_sub_f32 v93, v93, v230
    v_sub_f32 v29, v29, v230
    v_sub_f32 v61, v61, v230
    v_sub_f32 v94, v94, v230
    v_sub_f32 v30, v30, v230
    v_sub_f32 v62, v62, v230
    v_sub_f32 v95, v95, v230
    v_sub_f32 v31, v31, v230
    v_sub_f32 v63, v63, v230
    v_mul_f32 v227, v227, v232
    v_accvgpr_read_b32 v234, a64
    v_mul_f32 v234, v234, v232
    v_accvgpr_write_b32 a64, v234
    v_accvgpr_read_b32 v235, a65
    v_mul_f32 v235, v235, v232
    v_accvgpr_write_b32 a65, v235
    v_accvgpr_read_b32 v236, a66
    v_mul_f32 v236, v236, v232
    v_accvgpr_write_b32 a66, v236
    v_accvgpr_read_b32 v237, a67
    v_mul_f32 v237, v237, v232
    v_accvgpr_write_b32 a67, v237
    v_accvgpr_read_b32 v234, a68
    v_mul_f32 v234, v234, v232
    v_accvgpr_write_b32 a68, v234
    v_accvgpr_read_b32 v235, a69
    v_mul_f32 v235, v235, v232
    v_accvgpr_write_b32 a69, v235
    v_accvgpr_read_b32 v236, a70
    v_mul_f32 v236, v236, v232
    v_accvgpr_write_b32 a70, v236
    v_accvgpr_read_b32 v237, a71
    v_mul_f32 v237, v237, v232
    v_accvgpr_write_b32 a71, v237
    v_accvgpr_read_b32 v234, a72
    v_mul_f32 v234, v234, v232
    v_accvgpr_write_b32 a72, v234
    v_accvgpr_read_b32 v235, a73
    v_mul_f32 v235, v235, v232
    v_accvgpr_write_b32 a73, v235
    v_accvgpr_read_b32 v236, a74
    v_mul_f32 v236, v236, v232
    v_accvgpr_write_b32 a74, v236
    v_accvgpr_read_b32 v237, a75
    v_mul_f32 v237, v237, v232
    v_accvgpr_write_b32 a75, v237
    v_accvgpr_read_b32 v234, a76
    v_mul_f32 v234, v234, v232
    v_accvgpr_write_b32 a76, v234
    v_accvgpr_read_b32 v235, a77
    v_mul_f32 v235, v235, v232
    v_accvgpr_write_b32 a77, v235
    v_accvgpr_read_b32 v236, a78
    v_mul_f32 v236, v236, v232
    v_accvgpr_write_b32 a78, v236
    v_accvgpr_read_b32 v237, a79
    v_mul_f32 v237, v237, v232
    v_accvgpr_write_b32 a79, v237
    v_accvgpr_read_b32 v234, a80
    v_mul_f32 v234, v234, v232
    v_accvgpr_write_b32 a80, v234
    v_accvgpr_read_b32 v235, a81
    v_mul_f32 v235, v235, v232
    v_accvgpr_write_b32 a81, v235
    v_accvgpr_read_b32 v236, a82
    v_mul_f32 v236, v236, v232
    v_accvgpr_write_b32 a82, v236
    v_accvgpr_read_b32 v237, a83
    v_mul_f32 v237, v237, v232
    v_accvgpr_write_b32 a83, v237
    v_accvgpr_read_b32 v234, a84
    v_mul_f32 v234, v234, v232
    v_accvgpr_write_b32 a84, v234
    v_accvgpr_read_b32 v235, a85
    v_mul_f32 v235, v235, v232
    v_accvgpr_write_b32 a85, v235
    v_accvgpr_read_b32 v236, a86
    v_mul_f32 v236, v236, v232
    v_accvgpr_write_b32 a86, v236
    v_accvgpr_read_b32 v237, a87
    v_mul_f32 v237, v237, v232
    v_accvgpr_write_b32 a87, v237
    v_accvgpr_read_b32 v234, a88
    v_mul_f32 v234, v234, v232
    v_accvgpr_write_b32 a88, v234
    v_accvgpr_read_b32 v235, a89
    v_mul_f32 v235, v235, v232
    v_accvgpr_write_b32 a89, v235
    v_accvgpr_read_b32 v236, a90
    v_mul_f32 v236, v236, v232
    v_accvgpr_write_b32 a90, v236
    v_accvgpr_read_b32 v237, a91
    v_mul_f32 v237, v237, v232
    v_accvgpr_write_b32 a91, v237
    v_accvgpr_read_b32 v234, a92
    v_mul_f32 v234, v234, v232
    v_accvgpr_write_b32 a92, v234
    v_accvgpr_read_b32 v235, a93
    v_mul_f32 v235, v235, v232
    v_accvgpr_write_b32 a93, v235
    v_accvgpr_read_b32 v236, a94
    v_mul_f32 v236, v236, v232
    v_accvgpr_write_b32 a94, v236
    v_accvgpr_read_b32 v237, a95
    v_mul_f32 v237, v237, v232
    v_accvgpr_write_b32 a95, v237
    v_accvgpr_read_b32 v234, a96
    v_mul_f32 v234, v234, v232
    v_accvgpr_write_b32 a96, v234
    v_accvgpr_read_b32 v235, a97
    v_mul_f32 v235, v235, v232
    v_accvgpr_write_b32 a97, v235
    v_accvgpr_read_b32 v236, a98
    v_mul_f32 v236, v236, v232
    v_accvgpr_write_b32 a98, v236
    v_accvgpr_read_b32 v237, a99
    v_mul_f32 v237, v237, v232
    v_accvgpr_write_b32 a99, v237
    v_accvgpr_read_b32 v234, a100
    v_mul_f32 v234, v234, v232
    v_accvgpr_write_b32 a100, v234
    v_accvgpr_read_b32 v235, a101
    v_mul_f32 v235, v235, v232
    v_accvgpr_write_b32 a101, v235
    v_accvgpr_read_b32 v236, a102
    v_mul_f32 v236, v236, v232
    v_accvgpr_write_b32 a102, v236
    v_accvgpr_read_b32 v237, a103
    v_mul_f32 v237, v237, v232
    v_accvgpr_write_b32 a103, v237
    v_accvgpr_read_b32 v234, a104
    v_mul_f32 v234, v234, v232
    v_accvgpr_write_b32 a104, v234
    v_accvgpr_read_b32 v235, a105
    v_mul_f32 v235, v235, v232
    v_accvgpr_write_b32 a105, v235
    v_accvgpr_read_b32 v236, a106
    v_mul_f32 v236, v236, v232
    v_accvgpr_write_b32 a106, v236
    v_accvgpr_read_b32 v237, a107
    v_mul_f32 v237, v237, v232
    v_accvgpr_write_b32 a107, v237
    v_accvgpr_read_b32 v234, a108
    v_mul_f32 v234, v234, v232
    v_accvgpr_write_b32 a108, v234
    v_accvgpr_read_b32 v235, a109
    v_mul_f32 v235, v235, v232
    v_accvgpr_write_b32 a109, v235
    v_accvgpr_read_b32 v236, a110
    v_mul_f32 v236, v236, v232
    v_accvgpr_write_b32 a110, v236
    v_accvgpr_read_b32 v237, a111
    v_mul_f32 v237, v237, v232
    v_accvgpr_write_b32 a111, v237
    v_accvgpr_read_b32 v234, a112
    v_mul_f32 v234, v234, v232
    v_accvgpr_write_b32 a112, v234
    v_accvgpr_read_b32 v235, a113
    v_mul_f32 v235, v235, v232
    v_accvgpr_write_b32 a113, v235
    v_accvgpr_read_b32 v236, a114
    v_mul_f32 v236, v236, v232
    v_accvgpr_write_b32 a114, v236
    v_accvgpr_read_b32 v237, a115
    v_mul_f32 v237, v237, v232
    v_accvgpr_write_b32 a115, v237
    v_accvgpr_read_b32 v234, a116
    v_mul_f32 v234, v234, v232
    v_accvgpr_write_b32 a116, v234
    v_accvgpr_read_b32 v235, a117
    v_mul_f32 v235, v235, v232
    v_accvgpr_write_b32 a117, v235
    v_accvgpr_read_b32 v236, a118
    v_mul_f32 v236, v236, v232
    v_accvgpr_write_b32 a118, v236
    v_accvgpr_read_b32 v237, a119
    v_mul_f32 v237, v237, v232
    v_accvgpr_write_b32 a119, v237
    v_accvgpr_read_b32 v234, a120
    v_mul_f32 v234, v234, v232
    v_accvgpr_write_b32 a120, v234
    v_accvgpr_read_b32 v235, a121
    v_mul_f32 v235, v235, v232
    v_accvgpr_write_b32 a121, v235
    v_accvgpr_read_b32 v236, a122
    v_mul_f32 v236, v236, v232
    v_accvgpr_write_b32 a122, v236
    v_accvgpr_read_b32 v237, a123
    v_mul_f32 v237, v237, v232
    v_accvgpr_write_b32 a123, v237
    v_accvgpr_read_b32 v234, a124
    v_mul_f32 v234, v234, v232
    v_accvgpr_write_b32 a124, v234
    v_accvgpr_read_b32 v235, a125
    v_mul_f32 v235, v235, v232
    v_accvgpr_write_b32 a125, v235
    v_accvgpr_read_b32 v236, a126
    v_mul_f32 v236, v236, v232
    v_accvgpr_write_b32 a126, v236
    v_accvgpr_read_b32 v237, a127
    v_mul_f32 v237, v237, v232
    v_accvgpr_write_b32 a127, v237
    v_exp_f32 v138, v48
    v_exp_f32 v139, v49
    v_exp_f32 v130, v50
    v_exp_f32 v131, v51
    v_cvt_pk_bf16_f32 v120, v138, v139
    v_exp_f32 v132, v52
    v_exp_f32 v133, v53
    v_cvt_pk_bf16_f32 v121, v130, v131
    v_add_f32 v138, v138, v130
    v_add_f32 v139, v139, v131
    v_exp_f32 v134, v54
    v_exp_f32 v135, v55
    v_cvt_pk_bf16_f32 v122, v132, v133
    v_add_f32 v138, v138, v132
    v_add_f32 v139, v139, v133
    v_exp_f32 v128, v56
    v_exp_f32 v129, v57
    v_cvt_pk_bf16_f32 v123, v134, v135
    v_add_f32 v138, v138, v134
    v_add_f32 v139, v139, v135
    v_exp_f32 v130, v58
    v_exp_f32 v131, v59
    v_cvt_pk_bf16_f32 v124, v128, v129
    v_add_f32 v138, v138, v128
    v_add_f32 v139, v139, v129
    v_exp_f32 v132, v60
    v_exp_f32 v133, v61
    v_cvt_pk_bf16_f32 v125, v130, v131
    v_add_f32 v138, v138, v130
    v_add_f32 v139, v139, v131
    v_exp_f32 v134, v62
    v_exp_f32 v135, v63
    v_cvt_pk_bf16_f32 v126, v132, v133
    v_add_f32 v138, v138, v132
    v_add_f32 v139, v139, v133
    v_cvt_pk_bf16_f32 v127, v134, v135
    v_add_f32 v138, v138, v134
    v_add_f32 v139, v139, v135
    v_add_f32 v225, v138, v139
    s_nop 1
    s_branch kf_rr21
kf_l2p23:
    buffer_load_dword v252, v245, s[56:59], s28 offen
    s_add_u32 s28, s28, 4096
    s_and_b32 s27, s28, 0x7000
    s_cselect_b32 s27, 0, 0x1000
    s_branch kf_l2r24
kf_fix25:
    s_cmp_eq_u32 s33, 0
    s_cselect_b32 s24, 0, 0x74000000
    s_cselect_b32 s36, 0, 0x1000
    s_mov_b32 s33, 1
    v_subrev_f32 v230, s24, v243
    v_add_f32 v231, 0, v230
    v_min_f32 v80, v229, v231
    v_add_f32 v232, 0xf1800000, v230
    v_min_f32 v81, v229, v232
    v_add_f32 v231, 0xf2000000, v230
    v_min_f32 v82, v229, v231
    v_add_f32 v232, 0xf2400000, v230
    v_min_f32 v83, v229, v232
    v_add_f32 v231, 0xf3000000, v230
    v_min_f32 v84, v229, v231
    v_add_f32 v232, 0xf3100000, v230
    v_min_f32 v85, v229, v232
    v_add_f32 v231, 0xf3200000, v230
    v_min_f32 v86, v229, v231
    v_add_f32 v232, 0xf3300000, v230
    v_min_f32 v87, v229, v232
    v_add_f32 v231, 0xf3800000, v230
    v_min_f32 v88, v229, v231
    v_add_f32 v232, 0xf3880000, v230
    v_min_f32 v89, v229, v232
    v_add_f32 v231, 0xf3900000, v230
    v_min_f32 v90, v229, v231
    v_add_f32 v232, 0xf3980000, v230
    v_min_f32 v91, v229, v232
    v_add_f32 v231, 0xf3c00000, v230
    v_min_f32 v92, v229, v231
    v_add_f32 v232, 0xf3c80000, v230
    v_min_f32 v93, v229, v232
    v_add_f32 v231, 0xf3d00000, v230
    v_min_f32 v94, v229, v231
    v_add_f32 v232, 0xf3d80000, v230
    v_min_f32 v95, v229, v232
    s_nop 1
    s_branch kf_fixr26
kf_rare28:
    s_nop 15
    v_max3_f32 v230, v16, v17, v18
    v_max3_f32 v230, v230, v19, v20
    v_max3_f32 v230, v230, v21, v22
    v_max3_f32 v230, v230, v23, v24
    v_max3_f32 v230, v230, v25, v26
    v_max3_f32 v230, v230, v27, v28
    v_max3_f32 v230, v230, v29, v30
    v_max_f32 v230, v230, v31
    v_mov_b32 v231, v230
    s_nop 1
    v_permlane32_swap_b32 v230, v231
    s_nop 0
    v_max_f32 v230, v230, v231
    v_max_f32 v230, 0, v230
    v_sub_f32 v232, 0, v230
    v_exp_f32 v232, v232
    v_sub_f32 v229, v229, v230
    v_sub_f32 v80, v80, v230
    v_sub_f32 v48, v48, v230
    v_sub_f32 v16, v16, v230
    v_sub_f32 v81, v81, v230
    v_sub_f32 v49, v49, v230
    v_sub_f32 v17, v17, v230
    v_sub_f32 v82, v82, v230
    v_sub_f32 v50, v50, v230
    v_sub_f32 v18, v18, v230
    v_sub_f32 v83, v83, v230
    v_sub_f32 v51, v51, v230
    v_sub_f32 v19, v19, v230
    v_sub_f32 v84, v84, v230
    v_sub_f32 v52, v52, v230
    v_sub_f32 v20, v20, v230
    v_sub_f32 v85, v85, v230
    v_sub_f32 v53, v53, v230
    v_sub_f32 v21, v21, v230
    v_sub_f32 v86, v86, v230
    v_sub_f32 v54, v54, v230
    v_sub_f32 v22, v22, v230
    v_sub_f32 v87, v87, v230
    v_sub_f32 v55, v55, v230
    v_sub_f32 v23, v23, v230
    v_sub_f32 v88, v88, v230
    v_sub_f32 v56, v56, v230
    v_sub_f32 v24, v24, v230
    v_sub_f32 v89, v89, v230
    v_sub_f32 v57, v57, v230
    v_sub_f32 v25, v25, v230
    v_sub_f32 v90, v90, v230
    v_sub_f32 v58, v58, v230
    v_sub_f32 v26, v26, v230
    v_sub_f32 v91, v91, v230
    v_sub_f32 v59, v59, v230
    v_sub_f32 v27, v27, v230
    v_sub_f32 v92, v92, v230
    v_sub_f32 v60, v60, v230
    v_sub_f32 v28, v28, v230
    v_sub_f32 v93, v93, v230
    v_sub_f32 v61, v61, v230
    v_sub_f32 v29, v29, v230
    v_sub_f32 v94, v94, v230
    v_sub_f32 v62, v62, v230
    v_sub_f32 v30, v30, v230
    v_sub_f32 v95, v95, v230
    v_sub_f32 v63, v63, v230
    v_sub_f32 v31, v31, v230
    v_mul_f32 v227, v227, v232
    v_accvgpr_read_b32 v234, a64
    v_mul_f32 v234, v234, v232
    v_accvgpr_write_b32 a64, v234
    v_accvgpr_read_b32 v235, a65
    v_mul_f32 v235, v235, v232
    v_accvgpr_write_b32 a65, v235
    v_accvgpr_read_b32 v236, a66
    v_mul_f32 v236, v236, v232
    v_accvgpr_write_b32 a66, v236
    v_accvgpr_read_b32 v237, a67
    v_mul_f32 v237, v237, v232
    v_accvgpr_write_b32 a67, v237
    v_accvgpr_read_b32 v234, a68
    v_mul_f32 v234, v234, v232
    v_accvgpr_write_b32 a68, v234
    v_accvgpr_read_b32 v235, a69
    v_mul_f32 v235, v235, v232
    v_accvgpr_write_b32 a69, v235
    v_accvgpr_read_b32 v236, a70
    v_mul_f32 v236, v236, v232
    v_accvgpr_write_b32 a70, v236
    v_accvgpr_read_b32 v237, a71
    v_mul_f32 v237, v237, v232
    v_accvgpr_write_b32 a71, v237
    v_accvgpr_read_b32 v234, a72
    v_mul_f32 v234, v234, v232
    v_accvgpr_write_b32 a72, v234
    v_accvgpr_read_b32 v235, a73
    v_mul_f32 v235, v235, v232
    v_accvgpr_write_b32 a73, v235
    v_accvgpr_read_b32 v236, a74
    v_mul_f32 v236, v236, v232
    v_accvgpr_write_b32 a74, v236
    v_accvgpr_read_b32 v237, a75
    v_mul_f32 v237, v237, v232
    v_accvgpr_write_b32 a75, v237
    v_accvgpr_read_b32 v234, a76
    v_mul_f32 v234, v234, v232
    v_accvgpr_write_b32 a76, v234
    v_accvgpr_read_b32 v235, a77
    v_mul_f32 v235, v235, v232
    v_accvgpr_write_b32 a77, v235
    v_accvgpr_read_b32 v236, a78
    v_mul_f32 v236, v236, v232
    v_accvgpr_write_b32 a78, v236
    v_accvgpr_read_b32 v237, a79
    v_mul_f32 v237, v237, v232
    v_accvgpr_write_b32 a79, v237
    v_accvgpr_read_b32 v234, a80
    v_mul_f32 v234, v234, v232
    v_accvgpr_write_b32 a80, v234
    v_accvgpr_read_b32 v235, a81
    v_mul_f32 v235, v235, v232
    v_accvgpr_write_b32 a81, v235
    v_accvgpr_read_b32 v236, a82
    v_mul_f32 v236, v236, v232
    v_accvgpr_write_b32 a82, v236
    v_accvgpr_read_b32 v237, a83
    v_mul_f32 v237, v237, v232
    v_accvgpr_write_b32 a83, v237
    v_accvgpr_read_b32 v234, a84
    v_mul_f32 v234, v234, v232
    v_accvgpr_write_b32 a84, v234
    v_accvgpr_read_b32 v235, a85
    v_mul_f32 v235, v235, v232
    v_accvgpr_write_b32 a85, v235
    v_accvgpr_read_b32 v236, a86
    v_mul_f32 v236, v236, v232
    v_accvgpr_write_b32 a86, v236
    v_accvgpr_read_b32 v237, a87
    v_mul_f32 v237, v237, v232
    v_accvgpr_write_b32 a87, v237
    v_accvgpr_read_b32 v234, a88
    v_mul_f32 v234, v234, v232
    v_accvgpr_write_b32 a88, v234
    v_accvgpr_read_b32 v235, a89
    v_mul_f32 v235, v235, v232
    v_accvgpr_write_b32 a89, v235
    v_accvgpr_read_b32 v236, a90
    v_mul_f32 v236, v236, v232
    v_accvgpr_write_b32 a90, v236
    v_accvgpr_read_b32 v237, a91
    v_mul_f32 v237, v237, v232
    v_accvgpr_write_b32 a91, v237
    v_accvgpr_read_b32 v234, a92
    v_mul_f32 v234, v234, v232
    v_accvgpr_write_b32 a92, v234
    v_accvgpr_read_b32 v235, a93
    v_mul_f32 v235, v235, v232
    v_accvgpr_write_b32 a93, v235
    v_accvgpr_read_b32 v236, a94
    v_mul_f32 v236, v236, v232
    v_accvgpr_write_b32 a94, v236
    v_accvgpr_read_b32 v237, a95
    v_mul_f32 v237, v237, v232
    v_accvgpr_write_b32 a95, v237
    v_accvgpr_read_b32 v234, a96
    v_mul_f32 v234, v234, v232
    v_accvgpr_write_b32 a96, v234
    v_accvgpr_read_b32 v235, a97
    v_mul_f32 v235, v235, v232
    v_accvgpr_write_b32 a97, v235
    v_accvgpr_read_b32 v236, a98
    v_mul_f32 v236, v236, v232
    v_accvgpr_write_b32 a98, v236
    v_accvgpr_read_b32 v237, a99
    v_mul_f32 v237, v237, v232
    v_accvgpr_write_b32 a99, v237
    v_accvgpr_read_b32 v234, a100
    v_mul_f32 v234, v234, v232
    v_accvgpr_write_b32 a100, v234
    v_accvgpr_read_b32 v235, a101
    v_mul_f32 v235, v235, v232
    v_accvgpr_write_b32 a101, v235
    v_accvgpr_read_b32 v236, a102
    v_mul_f32 v236, v236, v232
    v_accvgpr_write_b32 a102, v236
    v_accvgpr_read_b32 v237, a103
    v_mul_f32 v237, v237, v232
    v_accvgpr_write_b32 a103, v237
    v_accvgpr_read_b32 v234, a104
    v_mul_f32 v234, v234, v232
    v_accvgpr_write_b32 a104, v234
    v_accvgpr_read_b32 v235, a105
    v_mul_f32 v235, v235, v232
    v_accvgpr_write_b32 a105, v235
    v_accvgpr_read_b32 v236, a106
    v_mul_f32 v236, v236, v232
    v_accvgpr_write_b32 a106, v236
    v_accvgpr_read_b32 v237, a107
    v_mul_f32 v237, v237, v232
    v_accvgpr_write_b32 a107, v237
    v_accvgpr_read_b32 v234, a108
    v_mul_f32 v234, v234, v232
    v_accvgpr_write_b32 a108, v234
    v_accvgpr_read_b32 v235, a109
    v_mul_f32 v235, v235, v232
    v_accvgpr_write_b32 a109, v235
    v_accvgpr_read_b32 v236, a110
    v_mul_f32 v236, v236, v232
    v_accvgpr_write_b32 a110, v236
    v_accvgpr_read_b32 v237, a111
    v_mul_f32 v237, v237, v232
    v_accvgpr_write_b32 a111, v237
    v_accvgpr_read_b32 v234, a112
    v_mul_f32 v234, v234, v232
    v_accvgpr_write_b32 a112, v234
    v_accvgpr_read_b32 v235, a113
    v_mul_f32 v235, v235, v232
    v_accvgpr_write_b32 a113, v235
    v_accvgpr_read_b32 v236, a114
    v_mul_f32 v236, v236, v232
    v_accvgpr_write_b32 a114, v236
    v_accvgpr_read_b32 v237, a115
    v_mul_f32 v237, v237, v232
    v_accvgpr_write_b32 a115, v237
    v_accvgpr_read_b32 v234, a116
    v_mul_f32 v234, v234, v232
    v_accvgpr_write_b32 a116, v234
    v_accvgpr_read_b32 v235, a117
    v_mul_f32 v235, v235, v232
    v_accvgpr_write_b32 a117, v235
    v_accvgpr_read_b32 v236, a118
    v_mul_f32 v236, v236, v232
    v_accvgpr_write_b32 a118, v236
    v_accvgpr_read_b32 v237, a119
    v_mul_f32 v237, v237, v232
    v_accvgpr_write_b32 a119, v237
    v_accvgpr_read_b32 v234, a120
    v_mul_f32 v234, v234, v232
    v_accvgpr_write_b32 a120, v234
    v_accvgpr_read_b32 v235, a121
    v_mul_f32 v235, v235, v232
    v_accvgpr_write_b32 a121, v235
    v_accvgpr_read_b32 v236, a122
    v_mul_f32 v236, v236, v232
    v_accvgpr_write_b32 a122, v236
    v_accvgpr_read_b32 v237, a123
    v_mul_f32 v237, v237, v232
    v_accvgpr_write_b32 a123, v237
    v_accvgpr_read_b32 v234, a124
    v_mul_f32 v234, v234, v232
    v_accvgpr_write_b32 a124, v234
    v_accvgpr_read_b32 v235, a125
    v_mul_f32 v235, v235, v232
    v_accvgpr_write_b32 a125, v235
    v_accvgpr_read_b32 v236, a126
    v_mul_f32 v236, v236, v232
    v_accvgpr_write_b32 a126, v236
    v_accvgpr_read_b32 v237, a127
    v_mul_f32 v237, v237, v232
    v_accvgpr_write_b32 a127, v237
    v_exp_f32 v138, v16
    v_exp_f32 v139, v17
    v_exp_f32 v130, v18
    v_exp_f32 v131, v19
    v_cvt_pk_bf16_f32 v104, v138, v139
    v_exp_f32 v132, v20
    v_exp_f32 v133, v21
    v_cvt_pk_bf16_f32 v105, v130, v131
    v_add_f32 v138, v138, v130
    v_add_f32 v139, v139, v131
    v_exp_f32 v134, v22
    v_exp_f32 v135, v23
    v_cvt_pk_bf16_f32 v106, v132, v133
    v_add_f32 v138, v138, v132
    v_add_f32 v139, v139, v133
    v_exp_f32 v128, v24
    v_exp_f32 v129, v25
    v_cvt_pk_bf16_f32 v107, v134, v135
    v_add_f32 v138, v138, v134
    v_add_f32 v139, v139, v135
    v_exp_f32 v130, v26
    v_exp_f32 v131, v27
    v_cvt_pk_bf16_f32 v108, v128, v129
    v_add_f32 v138, v138, v128
    v_add_f32 v139, v139, v129
    v_exp_f32 v132, v28
    v_exp_f32 v133, v29
    v_cvt_pk_bf16_f32 v109, v130, v131
    v_add_f32 v138, v138, v130
    v_add_f32 v139, v139, v131
    v_exp_f32 v134, v30
    v_exp_f32 v135, v31
    v_cvt_pk_bf16_f32 v110, v132, v133
    v_add_f32 v138, v138, v132
    v_add_f32 v139, v139, v133
    v_cvt_pk_bf16_f32 v111, v134, v135
    v_add_f32 v138, v138, v134
    v_add_f32 v139, v139, v135
    v_add_f32 v225, v138, v139
    s_nop 1
    s_branch kf_rr27
kf_fix29:
    s_cmp_eq_u32 s33, 0
    s_cselect_b32 s24, 0, 0x74000000
    s_cselect_b32 s36, 0, 0x1000
    s_mov_b32 s33, 1
    v_subrev_f32 v230, s24, v243
    v_add_f32 v231, 0, v230
    v_min_f32 v80, v229, v231
    v_add_f32 v232, 0xf1800000, v230
    v_min_f32 v81, v229, v232
    v_add_f32 v231, 0xf2000000, v230
    v_min_f32 v82, v229, v231
    v_add_f32 v232, 0xf2400000, v230
    v_min_f32 v83, v229, v232
    v_add_f32 v231, 0xf3000000, v230
    v_min_f32 v84, v229, v231
    v_add_f32 v232, 0xf3100000, v230
    v_min_f32 v85, v229, v232
    v_add_f32 v231, 0xf3200000, v230
    v_min_f32 v86, v229, v231
    v_add_f32 v232, 0xf3300000, v230
    v_min_f32 v87, v229, v232
    v_add_f32 v231, 0xf3800000, v230
    v_min_f32 v88, v229, v231
    v_add_f32 v232, 0xf3880000, v230
    v_min_f32 v89, v229, v232
    v_add_f32 v231, 0xf3900000, v230
    v_min_f32 v90, v229, v231
    v_add_f32 v232, 0xf3980000, v230
    v_min_f32 v91, v229, v232
    v_add_f32 v231, 0xf3c00000, v230
    v_min_f32 v92, v229, v231
    v_add_f32 v232, 0xf3c80000, v230
    v_min_f32 v93, v229, v232
    v_add_f32 v231, 0xf3d00000, v230
    v_min_f32 v94, v229, v231
    v_add_f32 v232, 0xf3d80000, v230
    v_min_f32 v95, v229, v232
    s_nop 1
    s_branch kf_fixr30
kf_rare32:
    s_nop 15
    v_max3_f32 v230, v48, v49, v50
    v_max3_f32 v230, v230, v51, v52
    v_max3_f32 v230, v230, v53, v54
    v_max3_f32 v230, v230, v55, v56
    v_max3_f32 v230, v230, v57, v58
    v_max3_f32 v230, v230, v59, v60
    v_max3_f32 v230, v230, v61, v62
    v_max_f32 v230, v230, v63
    v_mov_b32 v231, v230
    s_nop 1
    v_permlane32_swap_b32 v230, v231
    s_nop 0
    v_max_f32 v230, v230, v231
    v_max_f32 v230, 0, v230
    v_sub_f32 v232, 0, v230
    v_exp_f32 v232, v232
    v_sub_f32 v229, v229, v230
    v_sub_f32 v80, v80, v230
    v_sub_f32 v16, v16, v230
    v_sub_f32 v48, v48, v230
    v_sub_f32 v81, v81, v230
    v_sub_f32 v17, v17, v230
    v_sub_f32 v49, v49, v230
    v_sub_f32 v82, v82, v230
    v_sub_f32 v18, v18, v230
    v_sub_f32 v50, v50, v230
    v_sub_f32 v83, v83, v230
    v_sub_f32 v19, v19, v230
    v_sub_f32 v51, v51, v230
    v_sub_f32 v84, v84, v230
    v_sub_f32 v20, v20, v230
    v_sub_f32 v52, v52, v230
    v_sub_f32 v85, v85, v230
    v_sub_f32 v21, v21, v230
    v_sub_f32 v53, v53, v230
    v_sub_f32 v86, v86, v230
    v_sub_f32 v22, v22, v230
    v_sub_f32 v54, v54, v230
    v_sub_f32 v87, v87, v230
    v_sub_f32 v23, v23, v230
    v_sub_f32 v55, v55, v230
    v_sub_f32 v88, v88, v230
    v_sub_f32 v24, v24, v230
    v_sub_f32 v56, v56, v230
    v_sub_f32 v89, v89, v230
    v_sub_f32 v25, v25, v230
    v_sub_f32 v57, v57, v230
    v_sub_f32 v90, v90, v230
    v_sub_f32 v26, v26, v230
    v_sub_f32 v58, v58, v230
    v_sub_f32 v91, v91, v230
    v_sub_f32 v27, v27, v230
    v_sub_f32 v59, v59, v230
    v_sub_f32 v92, v92, v230
    v_sub_f32 v28, v28, v230
    v_sub_f32 v60, v60, v230
    v_sub_f32 v93, v93, v230
    v_sub_f32 v29, v29, v230
    v_sub_f32 v61, v61, v230
    v_sub_f32 v94, v94, v230
    v_sub_f32 v30, v30, v230
    v_sub_f32 v62, v62, v230
    v_sub_f32 v95, v95, v230
    v_sub_f32 v31, v31, v230
    v_sub_f32 v63, v63, v230
    v_mul_f32 v227, v227, v232
    v_accvgpr_read_b32 v234, a64
    v_mul_f32 v234, v234, v232
    v_accvgpr_write_b32 a64, v234
    v_accvgpr_read_b32 v235, a65
    v_mul_f32 v235, v235, v232
    v_accvgpr_write_b32 a65, v235
    v_accvgpr_read_b32 v236, a66
    v_mul_f32 v236, v236, v232
    v_accvgpr_write_b32 a66, v236
    v_accvgpr_read_b32 v237, a67
    v_mul_f32 v237, v237, v232
    v_accvgpr_write_b32 a67, v237
    v_accvgpr_read_b32 v234, a68
    v_mul_f32 v234, v234, v232
    v_accvgpr_write_b32 a68, v234
    v_accvgpr_read_b32 v235, a69
    v_mul_f32 v235, v235, v232
    v_accvgpr_write_b32 a69, v235
    v_accvgpr_read_b32 v236, a70
    v_mul_f32 v236, v236, v232
    v_accvgpr_write_b32 a70, v236
    v_accvgpr_read_b32 v237, a71
    v_mul_f32 v237, v237, v232
    v_accvgpr_write_b32 a71, v237
    v_accvgpr_read_b32 v234, a72
    v_mul_f32 v234, v234, v232
    v_accvgpr_write_b32 a72, v234
    v_accvgpr_read_b32 v235, a73
    v_mul_f32 v235, v235, v232
    v_accvgpr_write_b32 a73, v235
    v_accvgpr_read_b32 v236, a74
    v_mul_f32 v236, v236, v232
    v_accvgpr_write_b32 a74, v236
    v_accvgpr_read_b32 v237, a75
    v_mul_f32 v237, v237, v232
    v_accvgpr_write_b32 a75, v237
    v_accvgpr_read_b32 v234, a76
    v_mul_f32 v234, v234, v232
    v_accvgpr_write_b32 a76, v234
    v_accvgpr_read_b32 v235, a77
    v_mul_f32 v235, v235, v232
    v_accvgpr_write_b32 a77, v235
    v_accvgpr_read_b32 v236, a78
    v_mul_f32 v236, v236, v232
    v_accvgpr_write_b32 a78, v236
    v_accvgpr_read_b32 v237, a79
    v_mul_f32 v237, v237, v232
    v_accvgpr_write_b32 a79, v237
    v_accvgpr_read_b32 v234, a80
    v_mul_f32 v234, v234, v232
    v_accvgpr_write_b32 a80, v234
    v_accvgpr_read_b32 v235, a81
    v_mul_f32 v235, v235, v232
    v_accvgpr_write_b32 a81, v235
    v_accvgpr_read_b32 v236, a82
    v_mul_f32 v236, v236, v232
    v_accvgpr_write_b32 a82, v236
    v_accvgpr_read_b32 v237, a83
    v_mul_f32 v237, v237, v232
    v_accvgpr_write_b32 a83, v237
    v_accvgpr_read_b32 v234, a84
    v_mul_f32 v234, v234, v232
    v_accvgpr_write_b32 a84, v234
    v_accvgpr_read_b32 v235, a85
    v_mul_f32 v235, v235, v232
    v_accvgpr_write_b32 a85, v235
    v_accvgpr_read_b32 v236, a86
    v_mul_f32 v236, v236, v232
    v_accvgpr_write_b32 a86, v236
    v_accvgpr_read_b32 v237, a87
    v_mul_f32 v237, v237, v232
    v_accvgpr_write_b32 a87, v237
    v_accvgpr_read_b32 v234, a88
    v_mul_f32 v234, v234, v232
    v_accvgpr_write_b32 a88, v234
    v_accvgpr_read_b32 v235, a89
    v_mul_f32 v235, v235, v232
    v_accvgpr_write_b32 a89, v235
    v_accvgpr_read_b32 v236, a90
    v_mul_f32 v236, v236, v232
    v_accvgpr_write_b32 a90, v236
    v_accvgpr_read_b32 v237, a91
    v_mul_f32 v237, v237, v232
    v_accvgpr_write_b32 a91, v237
    v_accvgpr_read_b32 v234, a92
    v_mul_f32 v234, v234, v232
    v_accvgpr_write_b32 a92, v234
    v_accvgpr_read_b32 v235, a93
    v_mul_f32 v235, v235, v232
    v_accvgpr_write_b32 a93, v235
    v_accvgpr_read_b32 v236, a94
    v_mul_f32 v236, v236, v232
    v_accvgpr_write_b32 a94, v236
    v_accvgpr_read_b32 v237, a95
    v_mul_f32 v237, v237, v232
    v_accvgpr_write_b32 a95, v237
    v_accvgpr_read_b32 v234, a96
    v_mul_f32 v234, v234, v232
    v_accvgpr_write_b32 a96, v234
    v_accvgpr_read_b32 v235, a97
    v_mul_f32 v235, v235, v232
    v_accvgpr_write_b32 a97, v235
    v_accvgpr_read_b32 v236, a98
    v_mul_f32 v236, v236, v232
    v_accvgpr_write_b32 a98, v236
    v_accvgpr_read_b32 v237, a99
    v_mul_f32 v237, v237, v232
    v_accvgpr_write_b32 a99, v237
    v_accvgpr_read_b32 v234, a100
    v_mul_f32 v234, v234, v232
    v_accvgpr_write_b32 a100, v234
    v_accvgpr_read_b32 v235, a101
    v_mul_f32 v235, v235, v232
    v_accvgpr_write_b32 a101, v235
    v_accvgpr_read_b32 v236, a102
    v_mul_f32 v236, v236, v232
    v_accvgpr_write_b32 a102, v236
    v_accvgpr_read_b32 v237, a103
    v_mul_f32 v237, v237, v232
    v_accvgpr_write_b32 a103, v237
    v_accvgpr_read_b32 v234, a104
    v_mul_f32 v234, v234, v232
    v_accvgpr_write_b32 a104, v234
    v_accvgpr_read_b32 v235, a105
    v_mul_f32 v235, v235, v232
    v_accvgpr_write_b32 a105, v235
    v_accvgpr_read_b32 v236, a106
    v_mul_f32 v236, v236, v232
    v_accvgpr_write_b32 a106, v236
    v_accvgpr_read_b32 v237, a107
    v_mul_f32 v237, v237, v232
    v_accvgpr_write_b32 a107, v237
    v_accvgpr_read_b32 v234, a108
    v_mul_f32 v234, v234, v232
    v_accvgpr_write_b32 a108, v234
    v_accvgpr_read_b32 v235, a109
    v_mul_f32 v235, v235, v232
    v_accvgpr_write_b32 a109, v235
    v_accvgpr_read_b32 v236, a110
    v_mul_f32 v236, v236, v232
    v_accvgpr_write_b32 a110, v236
    v_accvgpr_read_b32 v237, a111
    v_mul_f32 v237, v237, v232
    v_accvgpr_write_b32 a111, v237
    v_accvgpr_read_b32 v234, a112
    v_mul_f32 v234, v234, v232
    v_accvgpr_write_b32 a112, v234
    v_accvgpr_read_b32 v235, a113
    v_mul_f32 v235, v235, v232
    v_accvgpr_write_b32 a113, v235
    v_accvgpr_read_b32 v236, a114
    v_mul_f32 v236, v236, v232
    v_accvgpr_write_b32 a114, v236
    v_accvgpr_read_b32 v237, a115
    v_mul_f32 v237, v237, v232
    v_accvgpr_write_b32 a115, v237
    v_accvgpr_read_b32 v234, a116
    v_mul_f32 v234, v234, v232
    v_accvgpr_write_b32 a116, v234
    v_accvgpr_read_b32 v235, a117
    v_mul_f32 v235, v235, v232
    v_accvgpr_write_b32 a117, v235
    v_accvgpr_read_b32 v236, a118
    v_mul_f32 v236, v236, v232
    v_accvgpr_write_b32 a118, v236
    v_accvgpr_read_b32 v237, a119
    v_mul_f32 v237, v237, v232
    v_accvgpr_write_b32 a119, v237
    v_accvgpr_read_b32 v234, a120
    v_mul_f32 v234, v234, v232
    v_accvgpr_write_b32 a120, v234
    v_accvgpr_read_b32 v235, a121
    v_mul_f32 v235, v235, v232
    v_accvgpr_write_b32 a121, v235
    v_accvgpr_read_b32 v236, a122
    v_mul_f32 v236, v236, v232
    v_accvgpr_write_b32 a122, v236
    v_accvgpr_read_b32 v237, a123
    v_mul_f32 v237, v237, v232
    v_accvgpr_write_b32 a123, v237
    v_accvgpr_read_b32 v234, a124
    v_mul_f32 v234, v234, v232
    v_accvgpr_write_b32 a124, v234
    v_accvgpr_read_b32 v235, a125
    v_mul_f32 v235, v235, v232
    v_accvgpr_write_b32 a125, v235
    v_accvgpr_read_b32 v236, a126
    v_mul_f32 v236, v236, v232
    v_accvgpr_write_b32 a126, v236
    v_accvgpr_read_b32 v237, a127
    v_mul_f32 v237, v237, v232
    v_accvgpr_write_b32 a127, v237
    v_exp_f32 v138, v48
    v_exp_f32 v139, v49
    v_exp_f32 v130, v50
    v_exp_f32 v131, v51
    v_cvt_pk_bf16_f32 v120, v138, v139
    v_exp_f32 v132, v52
    v_exp_f32 v133, v53
    v_cvt_pk_bf16_f32 v121, v130, v131
    v_add_f32 v138, v138, v130
    v_add_f32 v139, v139, v131
    v_exp_f32 v134, v54
    v_exp_f32 v135, v55
    v_cvt_pk_bf16_f32 v122, v132, v133
    v_add_f32 v138, v138, v132
    v_add_f32 v139, v139, v133
    v_exp_f32 v128, v56
    v_exp_f32 v129, v57
    v_cvt_pk_bf16_f32 v123, v134, v135
    v_add_f32 v138, v138, v134
    v_add_f32 v139, v139, v135
    v_exp_f32 v130, v58
    v_exp_f32 v131, v59
    v_cvt_pk_bf16_f32 v124, v128, v129
    v_add_f32 v138, v138, v128
    v_add_f32 v139, v139, v129
    v_exp_f32 v132, v60
    v_exp_f32 v133, v61
    v_cvt_pk_bf16_f32 v125, v130, v131
    v_add_f32 v138, v138, v130
    v_add_f32 v139, v139, v131
    v_exp_f32 v134, v62
    v_exp_f32 v135, v63
    v_cvt_pk_bf16_f32 v126, v132, v133
    v_add_f32 v138, v138, v132
    v_add_f32 v139, v139, v133
    v_cvt_pk_bf16_f32 v127, v134, v135
    v_add_f32 v138, v138, v134
    v_add_f32 v139, v139, v135
    v_add_f32 v225, v138, v139
    s_nop 1
    s_branch kf_rr31
kf_l2p33:
    buffer_load_dword v252, v245, s[56:59], s28 offen
    s_add_u32 s28, s28, 4096
    s_and_b32 s27, s28, 0x7000
    s_cselect_b32 s27, 0, 0x1000
    s_branch kf_l2r34
kf_fix35:
    s_cmp_eq_u32 s33, 0
    s_cselect_b32 s24, 0, 0x74000000
    s_cselect_b32 s36, 0, 0x1000
    s_mov_b32 s33, 1
    v_subrev_f32 v230, s24, v243
    v_add_f32 v231, 0, v230
    v_min_f32 v80, v229, v231
    v_add_f32 v232, 0xf1800000, v230
    v_min_f32 v81, v229, v232
    v_add_f32 v231, 0xf2000000, v230
    v_min_f32 v82, v229, v231
    v_add_f32 v232, 0xf2400000, v230
    v_min_f32 v83, v229, v232
    v_add_f32 v231, 0xf3000000, v230
    v_min_f32 v84, v229, v231
    v_add_f32 v232, 0xf3100000, v230
    v_min_f32 v85, v229, v232
    v_add_f32 v231, 0xf3200000, v230
    v_min_f32 v86, v229, v231
    v_add_f32 v232, 0xf3300000, v230
    v_min_f32 v87, v229, v232
    v_add_f32 v231, 0xf3800000, v230
    v_min_f32 v88, v229, v231
    v_add_f32 v232, 0xf3880000, v230
    v_min_f32 v89, v229, v232
    v_add_f32 v231, 0xf3900000, v230
    v_min_f32 v90, v229, v231
    v_add_f32 v232, 0xf3980000, v230
    v_min_f32 v91, v229, v232
    v_add_f32 v231, 0xf3c00000, v230
    v_min_f32 v92, v229, v231
    v_add_f32 v232, 0xf3c80000, v230
    v_min_f32 v93, v229, v232
    v_add_f32 v231, 0xf3d00000, v230
    v_min_f32 v94, v229, v231
    v_add_f32 v232, 0xf3d80000, v230
    v_min_f32 v95, v229, v232
    s_nop 1
    s_branch kf_fixr36
kf_rare38:
    s_nop 15
    v_max3_f32 v230, v16, v17, v18
    v_max3_f32 v230, v230, v19, v20
    v_max3_f32 v230, v230, v21, v22
    v_max3_f32 v230, v230, v23, v24
    v_max3_f32 v230, v230, v25, v26
    v_max3_f32 v230, v230, v27, v28
    v_max3_f32 v230, v230, v29, v30
    v_max_f32 v230, v230, v31
    v_mov_b32 v231, v230
    s_nop 1
    v_permlane32_swap_b32 v230, v231
    s_nop 0
    v_max_f32 v230, v230, v231
    v_max_f32 v230, 0, v230
    v_sub_f32 v232, 0, v230
    v_exp_f32 v232, v232
    v_sub_f32 v229, v229, v230
    v_sub_f32 v80, v80, v230
    v_sub_f32 v48, v48, v230
    v_sub_f32 v16, v16, v230
    v_sub_f32 v81, v81, v230
    v_sub_f32 v49, v49, v230
    v_sub_f32 v17, v17, v230
    v_sub_f32 v82, v82, v230
    v_sub_f32 v50, v50, v230
    v_sub_f32 v18, v18, v230
    v_sub_f32 v83, v83, v230
    v_sub_f32 v51, v51, v230
    v_sub_f32 v19, v19, v230
    v_sub_f32 v84, v84, v230
    v_sub_f32 v52, v52, v230
    v_sub_f32 v20, v20, v230
    v_sub_f32 v85, v85, v230
    v_sub_f32 v53, v53, v230
    v_sub_f32 v21, v21, v230
    v_sub_f32 v86, v86, v230
    v_sub_f32 v54, v54, v230
    v_sub_f32 v22, v22, v230
    v_sub_f32 v87, v87, v230
    v_sub_f32 v55, v55, v230
    v_sub_f32 v23, v23, v230
    v_sub_f32 v88, v88, v230
    v_sub_f32 v56, v56, v230
    v_sub_f32 v24, v24, v230
    v_sub_f32 v89, v89, v230
    v_sub_f32 v57, v57, v230
    v_sub_f32 v25, v25, v230
    v_sub_f32 v90, v90, v230
    v_sub_f32 v58, v58, v230
    v_sub_f32 v26, v26, v230
    v_sub_f32 v91, v91, v230
    v_sub_f32 v59, v59, v230
    v_sub_f32 v27, v27, v230
    v_sub_f32 v92, v92, v230
    v_sub_f32 v60, v60, v230
    v_sub_f32 v28, v28, v230
    v_sub_f32 v93, v93, v230
    v_sub_f32 v61, v61, v230
    v_sub_f32 v29, v29, v230
    v_sub_f32 v94, v94, v230
    v_sub_f32 v62, v62, v230
    v_sub_f32 v30, v30, v230
    v_sub_f32 v95, v95, v230
    v_sub_f32 v63, v63, v230
    v_sub_f32 v31, v31, v230
    v_mul_f32 v227, v227, v232
    v_accvgpr_read_b32 v234, a64
    v_mul_f32 v234, v234, v232
    v_accvgpr_write_b32 a64, v234
    v_accvgpr_read_b32 v235, a65
    v_mul_f32 v235, v235, v232
    v_accvgpr_write_b32 a65, v235
    v_accvgpr_read_b32 v236, a66
    v_mul_f32 v236, v236, v232
    v_accvgpr_write_b32 a66, v236
    v_accvgpr_read_b32 v237, a67
    v_mul_f32 v237, v237, v232
    v_accvgpr_write_b32 a67, v237
    v_accvgpr_read_b32 v234, a68
    v_mul_f32 v234, v234, v232
    v_accvgpr_write_b32 a68, v234
    v_accvgpr_read_b32 v235, a69
    v_mul_f32 v235, v235, v232
    v_accvgpr_write_b32 a69, v235
    v_accvgpr_read_b32 v236, a70
    v_mul_f32 v236, v236, v232
    v_accvgpr_write_b32 a70, v236
    v_accvgpr_read_b32 v237, a71
    v_mul_f32 v237, v237, v232
    v_accvgpr_write_b32 a71, v237
    v_accvgpr_read_b32 v234, a72
    v_mul_f32 v234, v234, v232
    v_accvgpr_write_b32 a72, v234
    v_accvgpr_read_b32 v235, a73
    v_mul_f32 v235, v235, v232
    v_accvgpr_write_b32 a73, v235
    v_accvgpr_read_b32 v236, a74
    v_mul_f32 v236, v236, v232
    v_accvgpr_write_b32 a74, v236
    v_accvgpr_read_b32 v237, a75
    v_mul_f32 v237, v237, v232
    v_accvgpr_write_b32 a75, v237
    v_accvgpr_read_b32 v234, a76
    v_mul_f32 v234, v234, v232
    v_accvgpr_write_b32 a76, v234
    v_accvgpr_read_b32 v235, a77
    v_mul_f32 v235, v235, v232
    v_accvgpr_write_b32 a77, v235
    v_accvgpr_read_b32 v236, a78
    v_mul_f32 v236, v236, v232
    v_accvgpr_write_b32 a78, v236
    v_accvgpr_read_b32 v237, a79
    v_mul_f32 v237, v237, v232
    v_accvgpr_write_b32 a79, v237
    v_accvgpr_read_b32 v234, a80
    v_mul_f32 v234, v234, v232
    v_accvgpr_write_b32 a80, v234
    v_accvgpr_read_b32 v235, a81
    v_mul_f32 v235, v235, v232
    v_accvgpr_write_b32 a81, v235
    v_accvgpr_read_b32 v236, a82
    v_mul_f32 v236, v236, v232
    v_accvgpr_write_b32 a82, v236
    v_accvgpr_read_b32 v237, a83
    v_mul_f32 v237, v237, v232
    v_accvgpr_write_b32 a83, v237
    v_accvgpr_read_b32 v234, a84
    v_mul_f32 v234, v234, v232
    v_accvgpr_write_b32 a84, v234
    v_accvgpr_read_b32 v235, a85
    v_mul_f32 v235, v235, v232
    v_accvgpr_write_b32 a85, v235
    v_accvgpr_read_b32 v236, a86
    v_mul_f32 v236, v236, v232
    v_accvgpr_write_b32 a86, v236
    v_accvgpr_read_b32 v237, a87
    v_mul_f32 v237, v237, v232
    v_accvgpr_write_b32 a87, v237
    v_accvgpr_read_b32 v234, a88
    v_mul_f32 v234, v234, v232
    v_accvgpr_write_b32 a88, v234
    v_accvgpr_read_b32 v235, a89
    v_mul_f32 v235, v235, v232
    v_accvgpr_write_b32 a89, v235
    v_accvgpr_read_b32 v236, a90
    v_mul_f32 v236, v236, v232
    v_accvgpr_write_b32 a90, v236
    v_accvgpr_read_b32 v237, a91
    v_mul_f32 v237, v237, v232
    v_accvgpr_write_b32 a91, v237
    v_accvgpr_read_b32 v234, a92
    v_mul_f32 v234, v234, v232
    v_accvgpr_write_b32 a92, v234
    v_accvgpr_read_b32 v235, a93
    v_mul_f32 v235, v235, v232
    v_accvgpr_write_b32 a93, v235
    v_accvgpr_read_b32 v236, a94
    v_mul_f32 v236, v236, v232
    v_accvgpr_write_b32 a94, v236
    v_accvgpr_read_b32 v237, a95
    v_mul_f32 v237, v237, v232
    v_accvgpr_write_b32 a95, v237
    v_accvgpr_read_b32 v234, a96
    v_mul_f32 v234, v234, v232
    v_accvgpr_write_b32 a96, v234
    v_accvgpr_read_b32 v235, a97
    v_mul_f32 v235, v235, v232
    v_accvgpr_write_b32 a97, v235
    v_accvgpr_read_b32 v236, a98
    v_mul_f32 v236, v236, v232
    v_accvgpr_write_b32 a98, v236
    v_accvgpr_read_b32 v237, a99
    v_mul_f32 v237, v237, v232
    v_accvgpr_write_b32 a99, v237
    v_accvgpr_read_b32 v234, a100
    v_mul_f32 v234, v234, v232
    v_accvgpr_write_b32 a100, v234
    v_accvgpr_read_b32 v235, a101
    v_mul_f32 v235, v235, v232
    v_accvgpr_write_b32 a101, v235
    v_accvgpr_read_b32 v236, a102
    v_mul_f32 v236, v236, v232
    v_accvgpr_write_b32 a102, v236
    v_accvgpr_read_b32 v237, a103
    v_mul_f32 v237, v237, v232
    v_accvgpr_write_b32 a103, v237
    v_accvgpr_read_b32 v234, a104
    v_mul_f32 v234, v234, v232
    v_accvgpr_write_b32 a104, v234
    v_accvgpr_read_b32 v235, a105
    v_mul_f32 v235, v235, v232
    v_accvgpr_write_b32 a105, v235
    v_accvgpr_read_b32 v236, a106
    v_mul_f32 v236, v236, v232
    v_accvgpr_write_b32 a106, v236
    v_accvgpr_read_b32 v237, a107
    v_mul_f32 v237, v237, v232
    v_accvgpr_write_b32 a107, v237
    v_accvgpr_read_b32 v234, a108
    v_mul_f32 v234, v234, v232
    v_accvgpr_write_b32 a108, v234
    v_accvgpr_read_b32 v235, a109
    v_mul_f32 v235, v235, v232
    v_accvgpr_write_b32 a109, v235
    v_accvgpr_read_b32 v236, a110
    v_mul_f32 v236, v236, v232
    v_accvgpr_write_b32 a110, v236
    v_accvgpr_read_b32 v237, a111
    v_mul_f32 v237, v237, v232
    v_accvgpr_write_b32 a111, v237
    v_accvgpr_read_b32 v234, a112
    v_mul_f32 v234, v234, v232
    v_accvgpr_write_b32 a112, v234
    v_accvgpr_read_b32 v235, a113
    v_mul_f32 v235, v235, v232
    v_accvgpr_write_b32 a113, v235
    v_accvgpr_read_b32 v236, a114
    v_mul_f32 v236, v236, v232
    v_accvgpr_write_b32 a114, v236
    v_accvgpr_read_b32 v237, a115
    v_mul_f32 v237, v237, v232
    v_accvgpr_write_b32 a115, v237
    v_accvgpr_read_b32 v234, a116
    v_mul_f32 v234, v234, v232
    v_accvgpr_write_b32 a116, v234
    v_accvgpr_read_b32 v235, a117
    v_mul_f32 v235, v235, v232
    v_accvgpr_write_b32 a117, v235
    v_accvgpr_read_b32 v236, a118
    v_mul_f32 v236, v236, v232
    v_accvgpr_write_b32 a118, v236
    v_accvgpr_read_b32 v237, a119
    v_mul_f32 v237, v237, v232
    v_accvgpr_write_b32 a119, v237
    v_accvgpr_read_b32 v234, a120
    v_mul_f32 v234, v234, v232
    v_accvgpr_write_b32 a120, v234
    v_accvgpr_read_b32 v235, a121
    v_mul_f32 v235, v235, v232
    v_accvgpr_write_b32 a121, v235
    v_accvgpr_read_b32 v236, a122
    v_mul_f32 v236, v236, v232
    v_accvgpr_write_b32 a122, v236
    v_accvgpr_read_b32 v237, a123
    v_mul_f32 v237, v237, v232
    v_accvgpr_write_b32 a123, v237
    v_accvgpr_read_b32 v234, a124
    v_mul_f32 v234, v234, v232
    v_accvgpr_write_b32 a124, v234
    v_accvgpr_read_b32 v235, a125
    v_mul_f32 v235, v235, v232
    v_accvgpr_write_b32 a125, v235
    v_accvgpr_read_b32 v236, a126
    v_mul_f32 v236, v236, v232
    v_accvgpr_write_b32 a126, v236
    v_accvgpr_read_b32 v237, a127
    v_mul_f32 v237, v237, v232
    v_accvgpr_write_b32 a127, v237
    v_exp_f32 v138, v16
    v_exp_f32 v139, v17
    v_exp_f32 v130, v18
    v_exp_f32 v131, v19
    v_cvt_pk_bf16_f32 v104, v138, v139
    v_exp_f32 v132, v20
    v_exp_f32 v133, v21
    v_cvt_pk_bf16_f32 v105, v130, v131
    v_add_f32 v138, v138, v130
    v_add_f32 v139, v139, v131
    v_exp_f32 v134, v22
    v_exp_f32 v135, v23
    v_cvt_pk_bf16_f32 v106, v132, v133
    v_add_f32 v138, v138, v132
    v_add_f32 v139, v139, v133
    v_exp_f32 v128, v24
    v_exp_f32 v129, v25
    v_cvt_pk_bf16_f32 v107, v134, v135
    v_add_f32 v138, v138, v134
    v_add_f32 v139, v139, v135
    v_exp_f32 v130, v26
    v_exp_f32 v131, v27
    v_cvt_pk_bf16_f32 v108, v128, v129
    v_add_f32 v138, v138, v128
    v_add_f32 v139, v139, v129
    v_exp_f32 v132, v28
    v_exp_f32 v133, v29
    v_cvt_pk_bf16_f32 v109, v130, v131
    v_add_f32 v138, v138, v130
    v_add_f32 v139, v139, v131
    v_exp_f32 v134, v30
    v_exp_f32 v135, v31
    v_cvt_pk_bf16_f32 v110, v132, v133
    v_add_f32 v138, v138, v132
    v_add_f32 v139, v139, v133
    v_cvt_pk_bf16_f32 v111, v134, v135
    v_add_f32 v138, v138, v134
    v_add_f32 v139, v139, v135
    v_add_f32 v225, v138, v139
    s_nop 1
    s_branch kf_rr37
kf_rare40:
    s_nop 15
    v_max3_f32 v230, v48, v49, v50
    v_max3_f32 v230, v230, v51, v52
    v_max3_f32 v230, v230, v53, v54
    v_max3_f32 v230, v230, v55, v56
    v_max3_f32 v230, v230, v57, v58
    v_max3_f32 v230, v230, v59, v60
    v_max3_f32 v230, v230, v61, v62
    v_max_f32 v230, v230, v63
    v_mov_b32 v231, v230
    s_nop 1
    v_permlane32_swap_b32 v230, v231
    s_nop 0
    v_max_f32 v230, v230, v231
    v_max_f32 v230, 0, v230
    v_sub_f32 v232, 0, v230
    v_exp_f32 v232, v232
    v_sub_f32 v229, v229, v230
    v_sub_f32 v80, v80, v230
    v_sub_f32 v16, v16, v230
    v_sub_f32 v48, v48, v230
    v_sub_f32 v81, v81, v230
    v_sub_f32 v17, v17, v230
    v_sub_f32 v49, v49, v230
    v_sub_f32 v82, v82, v230
    v_sub_f32 v18, v18, v230
    v_sub_f32 v50, v50, v230
    v_sub_f32 v83, v83, v230
    v_sub_f32 v19, v19, v230
    v_sub_f32 v51, v51, v230
    v_sub_f32 v84, v84, v230
    v_sub_f32 v20, v20, v230
    v_sub_f32 v52, v52, v230
    v_sub_f32 v85, v85, v230
    v_sub_f32 v21, v21, v230
    v_sub_f32 v53, v53, v230
    v_sub_f32 v86, v86, v230
    v_sub_f32 v22, v22, v230
    v_sub_f32 v54, v54, v230
    v_sub_f32 v87, v87, v230
    v_sub_f32 v23, v23, v230
    v_sub_f32 v55, v55, v230
    v_sub_f32 v88, v88, v230
    v_sub_f32 v24, v24, v230
    v_sub_f32 v56, v56, v230
    v_sub_f32 v89, v89, v230
    v_sub_f32 v25, v25, v230
    v_sub_f32 v57, v57, v230
    v_sub_f32 v90, v90, v230
    v_sub_f32 v26, v26, v230
    v_sub_f32 v58, v58, v230
    v_sub_f32 v91, v91, v230
    v_sub_f32 v27, v27, v230
    v_sub_f32 v59, v59, v230
    v_sub_f32 v92, v92, v230
    v_sub_f32 v28, v28, v230
    v_sub_f32 v60, v60, v230
    v_sub_f32 v93, v93, v230
    v_sub_f32 v29, v29, v230
    v_sub_f32 v61, v61, v230
    v_sub_f32 v94, v94, v230
    v_sub_f32 v30, v30, v230
    v_sub_f32 v62, v62, v230
    v_sub_f32 v95, v95, v230
    v_sub_f32 v31, v31, v230
    v_sub_f32 v63, v63, v230
    v_mul_f32 v227, v227, v232
    v_accvgpr_read_b32 v234, a64
    v_mul_f32 v234, v234, v232
    v_accvgpr_write_b32 a64, v234
    v_accvgpr_read_b32 v235, a65
    v_mul_f32 v235, v235, v232
    v_accvgpr_write_b32 a65, v235
    v_accvgpr_read_b32 v236, a66
    v_mul_f32 v236, v236, v232
    v_accvgpr_write_b32 a66, v236
    v_accvgpr_read_b32 v237, a67
    v_mul_f32 v237, v237, v232
    v_accvgpr_write_b32 a67, v237
    v_accvgpr_read_b32 v234, a68
    v_mul_f32 v234, v234, v232
    v_accvgpr_write_b32 a68, v234
    v_accvgpr_read_b32 v235, a69
    v_mul_f32 v235, v235, v232
    v_accvgpr_write_b32 a69, v235
    v_accvgpr_read_b32 v236, a70
    v_mul_f32 v236, v236, v232
    v_accvgpr_write_b32 a70, v236
    v_accvgpr_read_b32 v237, a71
    v_mul_f32 v237, v237, v232
    v_accvgpr_write_b32 a71, v237
    v_accvgpr_read_b32 v234, a72
    v_mul_f32 v234, v234, v232
    v_accvgpr_write_b32 a72, v234
    v_accvgpr_read_b32 v235, a73
    v_mul_f32 v235, v235, v232
    v_accvgpr_write_b32 a73, v235
    v_accvgpr_read_b32 v236, a74
    v_mul_f32 v236, v236, v232
    v_accvgpr_write_b32 a74, v236
    v_accvgpr_read_b32 v237, a75
    v_mul_f32 v237, v237, v232
    v_accvgpr_write_b32 a75, v237
    v_accvgpr_read_b32 v234, a76
    v_mul_f32 v234, v234, v232
    v_accvgpr_write_b32 a76, v234
    v_accvgpr_read_b32 v235, a77
    v_mul_f32 v235, v235, v232
    v_accvgpr_write_b32 a77, v235
    v_accvgpr_read_b32 v236, a78
    v_mul_f32 v236, v236, v232
    v_accvgpr_write_b32 a78, v236
    v_accvgpr_read_b32 v237, a79
    v_mul_f32 v237, v237, v232
    v_accvgpr_write_b32 a79, v237
    v_accvgpr_read_b32 v234, a80
    v_mul_f32 v234, v234, v232
    v_accvgpr_write_b32 a80, v234
    v_accvgpr_read_b32 v235, a81
    v_mul_f32 v235, v235, v232
    v_accvgpr_write_b32 a81, v235
    v_accvgpr_read_b32 v236, a82
    v_mul_f32 v236, v236, v232
    v_accvgpr_write_b32 a82, v236
    v_accvgpr_read_b32 v237, a83
    v_mul_f32 v237, v237, v232
    v_accvgpr_write_b32 a83, v237
    v_accvgpr_read_b32 v234, a84
    v_mul_f32 v234, v234, v232
    v_accvgpr_write_b32 a84, v234
    v_accvgpr_read_b32 v235, a85
    v_mul_f32 v235, v235, v232
    v_accvgpr_write_b32 a85, v235
    v_accvgpr_read_b32 v236, a86
    v_mul_f32 v236, v236, v232
    v_accvgpr_write_b32 a86, v236
    v_accvgpr_read_b32 v237, a87
    v_mul_f32 v237, v237, v232
    v_accvgpr_write_b32 a87, v237
    v_accvgpr_read_b32 v234, a88
    v_mul_f32 v234, v234, v232
    v_accvgpr_write_b32 a88, v234
    v_accvgpr_read_b32 v235, a89
    v_mul_f32 v235, v235, v232
    v_accvgpr_write_b32 a89, v235
    v_accvgpr_read_b32 v236, a90
    v_mul_f32 v236, v236, v232
    v_accvgpr_write_b32 a90, v236
    v_accvgpr_read_b32 v237, a91
    v_mul_f32 v237, v237, v232
    v_accvgpr_write_b32 a91, v237
    v_accvgpr_read_b32 v234, a92
    v_mul_f32 v234, v234, v232
    v_accvgpr_write_b32 a92, v234
    v_accvgpr_read_b32 v235, a93
    v_mul_f32 v235, v235, v232
    v_accvgpr_write_b32 a93, v235
    v_accvgpr_read_b32 v236, a94
    v_mul_f32 v236, v236, v232
    v_accvgpr_write_b32 a94, v236
    v_accvgpr_read_b32 v237, a95
    v_mul_f32 v237, v237, v232
    v_accvgpr_write_b32 a95, v237
    v_accvgpr_read_b32 v234, a96
    v_mul_f32 v234, v234, v232
    v_accvgpr_write_b32 a96, v234
    v_accvgpr_read_b32 v235, a97
    v_mul_f32 v235, v235, v232
    v_accvgpr_write_b32 a97, v235
    v_accvgpr_read_b32 v236, a98
    v_mul_f32 v236, v236, v232
    v_accvgpr_write_b32 a98, v236
    v_accvgpr_read_b32 v237, a99
    v_mul_f32 v237, v237, v232
    v_accvgpr_write_b32 a99, v237
    v_accvgpr_read_b32 v234, a100
    v_mul_f32 v234, v234, v232
    v_accvgpr_write_b32 a100, v234
    v_accvgpr_read_b32 v235, a101
    v_mul_f32 v235, v235, v232
    v_accvgpr_write_b32 a101, v235
    v_accvgpr_read_b32 v236, a102
    v_mul_f32 v236, v236, v232
    v_accvgpr_write_b32 a102, v236
    v_accvgpr_read_b32 v237, a103
    v_mul_f32 v237, v237, v232
    v_accvgpr_write_b32 a103, v237
    v_accvgpr_read_b32 v234, a104
    v_mul_f32 v234, v234, v232
    v_accvgpr_write_b32 a104, v234
    v_accvgpr_read_b32 v235, a105
    v_mul_f32 v235, v235, v232
    v_accvgpr_write_b32 a105, v235
    v_accvgpr_read_b32 v236, a106
    v_mul_f32 v236, v236, v232
    v_accvgpr_write_b32 a106, v236
    v_accvgpr_read_b32 v237, a107
    v_mul_f32 v237, v237, v232
    v_accvgpr_write_b32 a107, v237
    v_accvgpr_read_b32 v234, a108
    v_mul_f32 v234, v234, v232
    v_accvgpr_write_b32 a108, v234
    v_accvgpr_read_b32 v235, a109
    v_mul_f32 v235, v235, v232
    v_accvgpr_write_b32 a109, v235
    v_accvgpr_read_b32 v236, a110
    v_mul_f32 v236, v236, v232
    v_accvgpr_write_b32 a110, v236
    v_accvgpr_read_b32 v237, a111
    v_mul_f32 v237, v237, v232
    v_accvgpr_write_b32 a111, v237
    v_accvgpr_read_b32 v234, a112
    v_mul_f32 v234, v234, v232
    v_accvgpr_write_b32 a112, v234
    v_accvgpr_read_b32 v235, a113
    v_mul_f32 v235, v235, v232
    v_accvgpr_write_b32 a113, v235
    v_accvgpr_read_b32 v236, a114
    v_mul_f32 v236, v236, v232
    v_accvgpr_write_b32 a114, v236
    v_accvgpr_read_b32 v237, a115
    v_mul_f32 v237, v237, v232
    v_accvgpr_write_b32 a115, v237
    v_accvgpr_read_b32 v234, a116
    v_mul_f32 v234, v234, v232
    v_accvgpr_write_b32 a116, v234
    v_accvgpr_read_b32 v235, a117
    v_mul_f32 v235, v235, v232
    v_accvgpr_write_b32 a117, v235
    v_accvgpr_read_b32 v236, a118
    v_mul_f32 v236, v236, v232
    v_accvgpr_write_b32 a118, v236
    v_accvgpr_read_b32 v237, a119
    v_mul_f32 v237, v237, v232
    v_accvgpr_write_b32 a119, v237
    v_accvgpr_read_b32 v234, a120
    v_mul_f32 v234, v234, v232
    v_accvgpr_write_b32 a120, v234
    v_accvgpr_read_b32 v235, a121
    v_mul_f32 v235, v235, v232
    v_accvgpr_write_b32 a121, v235
    v_accvgpr_read_b32 v236, a122
    v_mul_f32 v236, v236, v232
    v_accvgpr_write_b32 a122, v236
    v_accvgpr_read_b32 v237, a123
    v_mul_f32 v237, v237, v232
    v_accvgpr_write_b32 a123, v237
    v_accvgpr_read_b32 v234, a124
    v_mul_f32 v234, v234, v232
    v_accvgpr_write_b32 a124, v234
    v_accvgpr_read_b32 v235, a125
    v_mul_f32 v235, v235, v232
    v_accvgpr_write_b32 a125, v235
    v_accvgpr_read_b32 v236, a126
    v_mul_f32 v236, v236, v232
    v_accvgpr_write_b32 a126, v236
    v_accvgpr_read_b32 v237, a127
    v_mul_f32 v237, v237, v232
    v_accvgpr_write_b32 a127, v237
    v_exp_f32 v138, v48
    v_exp_f32 v139, v49
    v_exp_f32 v130, v50
    v_exp_f32 v131, v51
    v_cvt_pk_bf16_f32 v120, v138, v139
    v_exp_f32 v132, v52
    v_exp_f32 v133, v53
    v_cvt_pk_bf16_f32 v121, v130, v131
    v_add_f32 v138, v138, v130
    v_add_f32 v139, v139, v131
    v_exp_f32 v134, v54
    v_exp_f32 v135, v55
    v_cvt_pk_bf16_f32 v122, v132, v133
    v_add_f32 v138, v138, v132
    v_add_f32 v139, v139, v133
    v_exp_f32 v128, v56
    v_exp_f32 v129, v57
    v_cvt_pk_bf16_f32 v123, v134, v135
    v_add_f32 v138, v138, v134
    v_add_f32 v139, v139, v135
    v_exp_f32 v130, v58
    v_exp_f32 v131, v59
    v_cvt_pk_bf16_f32 v124, v128, v129
    v_add_f32 v138, v138, v128
    v_add_f32 v139, v139, v129
    v_exp_f32 v132, v60
    v_exp_f32 v133, v61
    v_cvt_pk_bf16_f32 v125, v130, v131
    v_add_f32 v138, v138, v130
    v_add_f32 v139, v139, v131
    v_exp_f32 v134, v62
    v_exp_f32 v135, v63
    v_cvt_pk_bf16_f32 v126, v132, v133
    v_add_f32 v138, v138, v132
    v_add_f32 v139, v139, v133
    v_cvt_pk_bf16_f32 v127, v134, v135
    v_add_f32 v138, v138, v134
    v_add_f32 v139, v139, v135
    v_add_f32 v225, v138, v139
    s_nop 1
    s_branch kf_rr39
kf_spin41:
    s_mov_b32 s25, 0x400000
kf_spin41_l:
    s_sleep 2
    buffer_load_dword v254, off, s[88:91], s39 sc1
    s_waitcnt vmcnt(0)
    v_readfirstlane_b32 s24, v254
    s_sub_u32 s25, s25, 1
    s_cbranch_scc1 kf_spinr42
    s_cmp_ge_u32 s24, 32
    s_cbranch_scc0 kf_spin41_l
    s_branch kf_spinr42
kf_spin43:
    s_mov_b32 s25, 0x400000
kf_spin43_l:
    s_sleep 2
    buffer_load_dword v254, off, s[88:91], s39 sc1
    s_waitcnt vmcnt(0)
    v_readfirstlane_b32 s24, v254
    s_sub_u32 s25, s25, 1
    s_cbranch_scc1 kf_spinr44
    s_cmp_ge_u32 s24, 32
    s_cbranch_scc0 kf_spin43_l
    s_branch kf_spinr44
kf_spin45:
    s_mov_b32 s25, 0x400000
kf_spin45_l:
    s_sleep 2
    buffer_load_dword v254, off, s[88:91], s35 sc1
    s_waitcnt vmcnt(0)
    v_readfirstlane_b32 s24, v254
    s_sub_u32 s25, s25, 1
    s_cbranch_scc1 kf_spinr46
    s_cmp_ge_u32 s24, 8
    s_cbranch_scc0 kf_spin45_l
    s_branch kf_spinr46

code_end:
.section .rodata,"a"
.p2align 6
.amdhsa_kernel sequential_preLN__compressed_kv_cla__moe_arch_mod__prompt_kernel
  .amdhsa_next_free_vgpr 512
  .amdhsa_next_free_sgpr 102
  .amdhsa_accum_offset 256
  .amdhsa_group_segment_fixed_size 0
  .amdhsa_kernarg_size 112
  .amdhsa_user_sgpr_count 2
  .amdhsa_user_sgpr_kernarg_segment_ptr 1
  .amdhsa_system_sgpr_workgroup_id_x 1
  .amdhsa_float_denorm_mode_32 3
.end_amdhsa_kernel
```

```asm
; @launch grid=(256,1,1) block=(256,1,1) lds=163840
.amdgcn_target "amdgcn-amd-amdhsa--gfx950"
.text
.globl sequential_preLN__compressed_kv_cla__moe_arch_mod__prompt_kernel
.p2align 8
.type sequential_preLN__compressed_kv_cla__moe_arch_mod__prompt_kernel,@function
sequential_preLN__compressed_kv_cla__moe_arch_mod__prompt_kernel:
    s_cmp_ge_u32 s2, 256
    s_cbranch_scc1 ka_done
    s_load_dwordx8 s[64:71], s[0:1], 0
    s_load_dwordx4 s[72:75], s[0:1], 32
    s_load_dwordx4 s[76:79], s[0:1], 64
    s_load_dwordx8 s[8:15], s[0:1], 80
    v_lshrrev_b32 v1, 6, v0
    v_and_b32 v2, 63, v0
    v_readfirstlane_b32 s3, v1
    v_mov_b32 v253, v0
    s_and_b32 s4, s2, 7
    s_lshl_b32 s4, s4, 2
    s_lshr_b32 s24, s2, 3
    s_and_b32 s24, s24, 3
    s_add_u32 s4, s4, s24
    s_lshr_b32 s5, s2, 5
    s_lshl2_add_u32 s6, s5, s3
    s_getpc_b64 s[56:57]
ka_pc:
    s_mov_b32 s58, code_end-ka_pc
    s_mov_b32 s59, 0x00020000
    s_lshr_b32 s24, s2, 3
    s_lshl2_add_u32 s24, s24, s3
    s_lshl_b32 s24, s24, 13
    v_lshlrev_b32 v3, 7, v2
    buffer_load_dword v252, v3, s[56:59], s24 offen
    v_mov_b32 v192, v2
    v_lshrrev_b32 v198, 3, v192
    v_and_b32 v199, 7, v192
    s_lshr_b32 s24, s3, 1
    s_lshl_b32 s24, s24, 5
    s_and_b32 s25, s3, 1
    s_lshl_b32 s26, s25, 3
    s_add_u32 s24, s24, s26
    v_add_u32 v194, s24, v198
    v_lshlrev_b32 v194, 10, v194
    v_lshrrev_b32 v195, 1, v198
    v_xor_b32 v195, v199, v195
    v_lshl_add_u32 v232, v195, 4, v194
    v_xor_b32 v195, 4, v195
    v_lshl_add_u32 v233, v195, 4, v194
    v_add_u32 v233, 15360, v233
    s_lshl_b32 s24, s4, 8
    s_lshl_b32 s26, s25, 7
    s_add_u32 s24, s24, s26
    v_lshlrev_b32 v194, 13, v198
    v_add_u32 v194, s24, v194
    v_bfe_u32 v195, v198, 1, 1
    v_xor_b32 v195, v199, v195
    v_lshl_add_u32 v234, v195, 4, v194
    v_xor_b32 v195, 4, v195
    v_lshl_add_u32 v235, v195, 4, v194
    v_add_u32 v235, 64512, v235
    s_lshl_b32 s34, s3, 11
    s_mul_i32 s35, s3, 24576
    s_add_u32 s35, s35, 65536
    s_lshl_b32 s32, s5, 18
    s_and_b32 s7, s4, 3
    s_lshl1_add_u32 s7, s7, s5
    s_add_u32 s80, s7, 0
    s_and_b32 s80, s80, 7
    s_lshl_b32 s80, s80, 7
    s_add_u32 s80, s80, s32
    s_add_u32 s81, s7, 1
    s_and_b32 s81, s81, 7
    s_lshl_b32 s81, s81, 7
    s_add_u32 s81, s81, s32
    s_add_u32 s82, s7, 2
    s_and_b32 s82, s82, 7
    s_lshl_b32 s82, s82, 7
    s_add_u32 s82, s82, s32
    s_add_u32 s83, s7, 3
    s_and_b32 s83, s83, 7
    s_lshl_b32 s83, s83, 7
    s_add_u32 s83, s83, s32
    s_add_u32 s84, s7, 4
    s_and_b32 s84, s84, 7
    s_lshl_b32 s84, s84, 7
    s_add_u32 s84, s84, s32
    s_add_u32 s85, s7, 5
    s_and_b32 s85, s85, 7
    s_lshl_b32 s85, s85, 7
    s_add_u32 s85, s85, s32
    s_add_u32 s86, s7, 6
    s_and_b32 s86, s86, 7
    s_lshl_b32 s86, s86, 7
    s_add_u32 s86, s86, s32
    s_add_u32 s87, s7, 7
    s_and_b32 s87, s87, 7
    s_lshl_b32 s87, s87, 7
    s_add_u32 s87, s87, s32
    s_waitcnt lgkmcnt(0)
    s_cmp_lt_u32 s3, 2
    s_cselect_b32 s48, s70, s72
    s_cselect_b32 s49, s71, s73
    s_mov_b32 s50, 0x400000
    s_mov_b32 s51, 0x00020000
    s_mov_b32 s44, s66
    s_mov_b32 s45, s67
    s_mov_b32 s46, 0x200000
    s_mov_b32 s47, 0x00020000
    s_add_u32 m0, s35, 0
    s_and_b32 s33, s80, 1023
    s_lshl_b32 s33, s33, 12
    buffer_load_dwordx4 v234, s[48:51], s33 offen lds
    buffer_load_dwordx4 v235, s[48:51], s33 offen offset:1024 lds
    s_add_u32 m0, s35, 2048
    s_add_u32 s33, s33, 131072
    buffer_load_dwordx4 v234, s[48:51], s33 offen lds
    buffer_load_dwordx4 v235, s[48:51], s33 offen offset:1024 lds
    s_add_u32 m0, s35, 4096
    s_add_u32 s33, s33, 131072
    buffer_load_dwordx4 v234, s[48:51], s33 offen lds
    buffer_load_dwordx4 v235, s[48:51], s33 offen offset:1024 lds
    s_add_u32 m0, s35, 6144
    s_add_u32 s33, s33, 131072
    buffer_load_dwordx4 v234, s[48:51], s33 offen lds
    buffer_load_dwordx4 v235, s[48:51], s33 offen offset:1024 lds
    s_add_u32 m0, s34, 0
    s_add_u32 s37, s80, 0
    buffer_load_dwordx4 v232, s[44:47], s37 offen lds
    buffer_load_dwordx4 v233, s[44:47], s37 offen offset:1024 lds
    s_add_u32 m0, s34, 8192
    s_add_u32 s37, s80, 65536
    buffer_load_dwordx4 v232, s[44:47], s37 offen lds
    buffer_load_dwordx4 v233, s[44:47], s37 offen offset:1024 lds
    s_mov_b32 s52, s64
    s_mov_b32 s53, s65
    s_mov_b32 s54, 0x400000
    s_mov_b32 s55, 0x00020000
    s_add_u32 s16, s14, 0x5c00000
    s_addc_u32 s17, s15, 0
    s_mov_b32 s18, 0x2140000
    s_mov_b32 s19, 0x00020000
    s_add_u32 s56, s14, 0x3800000
    s_addc_u32 s57, s15, 0
    s_mov_b32 s58, 0x6040
    s_mov_b32 s59, 0x00020000
    s_add_u32 s20, s14, 0x2400000
    s_addc_u32 s21, s15, 0
    s_mov_b32 s22, 0x1000000
    s_mov_b32 s23, 0x00020000
    s_mov_b32 s88, s12
    s_mov_b32 s89, s13
    s_mov_b32 s90, 0x100
    s_mov_b32 s91, 0x00020000
    s_cmp_lt_u32 s3, 2
    s_cselect_b32 s60, s74, s8
    s_cselect_b32 s61, s75, s9
    s_mov_b32 s62, 0x700000
    s_cselect_b32 s62, 0x800000, s62
    s_mov_b32 s63, 0x00020000
    s_cselect_b32 s41, s76, s78
    s_cselect_b32 s42, s77, s79
    s_mov_b32 s8, s14
    s_mov_b32 s9, s15
    s_mov_b32 s10, 0x400000
    s_mov_b32 s11, 0x00020000
    s_mov_b32 s12, s68
    s_mov_b32 s13, s69
    s_mov_b32 s14, 0x800000
    s_mov_b32 s15, 0x00020000
    s_cmp_eq_u32 s2, 0
    s_mov_b32 s97, 0x40000000
    s_cselect_b32 s97, 0xa0000, s97
    s_mov_b32 s58, 0xa4000
    v_lshlrev_b32 v194, 7, v253
    v_mov_b32 v195, 0
    buffer_store_dword v195, v194, s[56:59], s97 offen sc1
    s_cselect_b32 s97, 0, 0x40000000
    s_mov_b32 s58, 0x6040
    s_add_u32 m0, s35, 8192
    s_and_b32 s33, s81, 1023
    s_lshl_b32 s33, s33, 12
    buffer_load_dwordx4 v234, s[48:51], s33 offen lds
    buffer_load_dwordx4 v235, s[48:51], s33 offen offset:1024 lds
    s_add_u32 m0, s35, 10240
    s_add_u32 s33, s33, 131072
    buffer_load_dwordx4 v234, s[48:51], s33 offen lds
    buffer_load_dwordx4 v235, s[48:51], s33 offen offset:1024 lds
    s_add_u32 m0, s35, 12288
    s_add_u32 s33, s33, 131072
    buffer_load_dwordx4 v234, s[48:51], s33 offen lds
    buffer_load_dwordx4 v235, s[48:51], s33 offen offset:1024 lds
    s_add_u32 m0, s35, 14336
    s_add_u32 s33, s33, 131072
    buffer_load_dwordx4 v234, s[48:51], s33 offen lds
    buffer_load_dwordx4 v235, s[48:51], s33 offen offset:1024 lds
    s_add_u32 m0, s34, 16384
    s_add_u32 s37, s81, 0
    buffer_load_dwordx4 v232, s[44:47], s37 offen lds
    buffer_load_dwordx4 v233, s[44:47], s37 offen offset:1024 lds
    s_add_u32 m0, s34, 24576
    s_add_u32 s37, s81, 65536
    buffer_load_dwordx4 v232, s[44:47], s37 offen lds
    buffer_load_dwordx4 v233, s[44:47], s37 offen offset:1024 lds
    v_and_b32 v200, 15, v192
    v_lshrrev_b32 v201, 4, v192
    v_lshrrev_b32 v194, 1, v200
    v_xor_b32 v194, v201, v194
    v_lshlrev_b32 v194, 4, v194
    v_lshl_add_u32 v224, v200, 7, v194
    v_xor_b32 v225, 64, v224
    v_lshrrev_b32 v194, 2, v200
    v_lshl_add_u32 v195, v201, 3, v194
    v_lshlrev_b32 v195, 7, v195
    v_add_u32 v195, s35, v195
    v_and_b32 v196, 1, v200
    v_lshl_add_u32 v195, v196, 3, v195
    v_lshrrev_b32 v194, 1, v194
    v_and_b32 v196, 1, v201
    v_lshl_or_b32 v194, v196, 2, v194
    v_and_b32 v196, 2, v200
    v_xor_b32 v194, v194, v196
    v_xor_b32 v196, 0, v194
    v_lshl_add_u32 v228, v196, 4, v195
    v_xor_b32 v196, 1, v194
    v_lshl_add_u32 v229, v196, 4, v195
    v_xor_b32 v196, 4, v194
    v_lshl_add_u32 v230, v196, 4, v195
    v_xor_b32 v196, 5, v194
    v_lshl_add_u32 v231, v196, 4, v195
    s_mul_i32 s36, s4, 1089536
    s_mul_i32 s24, s5, 136192
    s_add_u32 s36, s36, s24
    s_and_b32 s24, s3, 1
    s_lshl_b32 s24, s24, 12
    s_and_b32 s26, s3, 2
    s_lshl_b32 s26, s26, 13
    s_add_u32 s36, s36, s24
    s_add_u32 s36, s36, s26
    v_bfe_u32 v194, v192, 3, 1
    v_lshlrev_b32 v194, 10, v194
    v_lshrrev_b32 v195, 5, v192
    v_lshl_add_u32 v194, v195, 8, v194
    v_bfe_u32 v195, v192, 4, 1
    v_lshl_add_u32 v194, v195, 7, v194
    v_lshl_add_u32 v239, v199, 4, v194
    s_lshl_b32 s24, s5, 7
    s_sub_u32 s26, 1792, s24
    s_cmp_lt_u32 s4, 16
    s_cselect_b32 s24, s24, s26
    s_lshl_b32 s26, s4, 3
    s_add_u32 s24, s24, s26
    v_lshrrev_b32 v194, 5, v253
    v_add_u32 v196, s24, v194
    v_and_b32 v195, 31, v192
    v_lshlrev_b32 v196, 11, v196
    v_lshl_add_u32 v236, v195, 4, v196
    v_xor_b32 v194, v194, v199
    v_lshlrev_b32 v194, 4, v194
    v_lshl_add_u32 v194, v195, 7, v194
    v_add_u32 v237, 81920, v194
    s_lshr_b32 s26, s24, 4
    s_lshl_b32 s26, s26, 15
    s_and_b32 s24, s24, 15
    s_lshl_b32 s24, s24, 4
    s_add_u32 s24, s24, s26
    v_lshrrev_b32 v194, 3, v253
    v_lshlrev_b32 v194, 8, v194
    v_xor_b32 v195, v199, v198
    v_lshl_add_u32 v194, v195, 4, v194
    v_add_u32 v238, s24, v194
    v_lshlrev_b32 v240, 4, v192
    s_lshl_b32 s24, s3, 12
    v_add_u32 v242, s24, v240
    s_lshl_b32 s24, s6, 16
    v_add_u32 v248, s24, v240
    s_sub_u32 s25, 63, s6
    s_lshl_b32 s24, s25, 16
    v_add_u32 v249, s24, v240
    v_bfe_u32 v194, v192, 2, 2
    v_lshlrev_b32 v194, 13, v194
    v_lshl_add_u32 v194, v201, 6, v194
    v_and_b32 v195, 3, v192
    v_lshl_add_u32 v194, v195, 4, v194
    s_lshl_b32 s24, s4, 8
    s_lshl_b32 s25, s3, 18
    s_add_u32 s24, s24, s25
    v_add_u32 v245, s24, v194
    s_lshl_b32 s31, s3, 13
    s_add_u32 s31, s31, 65536
    s_lshl_b32 s27, s5, 20
    s_mov_b32 s7, s27
    s_mov_b32 s43, 0x40000000
    s_lshr_b32 s28, s27, 8
    s_add_u32 s29, s28, 32768
    s_nop 0
    v_lshlrev_b32 v194, 11, v201
    v_bfe_u32 v195, v192, 2, 2
    v_lshl_add_u32 v194, v195, 6, v194
    v_bfe_u32 v195, v192, 4, 1
    v_lshl_add_u32 v194, v195, 5, v194
    v_and_b32 v195, 1, v192
    v_lshl_add_u32 v194, v195, 4, v194
    v_bfe_u32 v195, v192, 1, 1
    v_lshl_add_u32 v247, v195, 3, v194
    s_mov_b32 s30, 65536
    v_add_u32 v246, s30, v247
    v_and_b32 v194, 31, v192
    v_lshrrev_b32 v195, 5, v192
    v_lshlrev_b32 v195, 2, v195
    v_sub_u32 v194, v194, v195
    v_cvt_f32_i32 v194, v194
    v_add_f32 v194, 0.5, v194
    v_mul_f32 v243, 0x71800000, v194
    v_bfe_u32 v194, v192, 4, 1
    v_lshlrev_b32 v194, 17, v194
    v_lshrrev_b32 v195, 5, v192
    v_lshl_add_u32 v194, v195, 8, v194
    v_lshl_add_u32 v244, v200, 4, v194
    v_lshlrev_b32 v251, 7, v192
    v_cmp_gt_u32 vcc, 16, v192
    v_mov_b32 v194, 0x40000000
    v_mov_b32 v255, 1
    v_cndmask_b32 v251, v194, v251, vcc
    v_cmp_eq_u32 vcc, 0, v253
    s_nop 1
    v_cndmask_b32 v250, v194, v253, vcc
    s_waitcnt vmcnt(12)
    s_barrier
    ds_read_b128 v[64:67], v224 offset:0
    ds_read_b128 v[68:71], v224 offset:2048
    ds_read_b128 v[72:75], v224 offset:4096
    ds_read_b128 v[76:79], v224 offset:6144
    ds_read_b64_tr_b16 a[0:1], v228 offset:0
    ds_read_b64_tr_b16 a[2:3], v228 offset:512
    ds_read_b64_tr_b16 a[4:5], v229 offset:0
    ds_read_b64_tr_b16 a[6:7], v229 offset:512
    ds_read_b64_tr_b16 a[8:9], v230 offset:0
    ds_read_b64_tr_b16 a[10:11], v230 offset:512
    ds_read_b64_tr_b16 a[12:13], v231 offset:0
    ds_read_b64_tr_b16 a[14:15], v231 offset:512
    buffer_store_dword v255, v250, s[88:91], s97 offen sc1
    s_cmp_eq_u32 s3, 0
    s_cselect_b32 s97, 0, s43
    s_cmp_lt_u32 s3, 2
    s_cbranch_scc0 ka_V
    s_waitcnt lgkmcnt(0)
    v_mfma_f32_16x16x32_bf16 v[96:99], a[0:3], v[64:67], 0
    ds_read_b128 v[80:83], v224 offset:8192
    v_mfma_f32_16x16x32_bf16 v[100:103], a[4:7], v[64:67], 0
    ds_read_b128 v[84:87], v224 offset:10240
    v_mfma_f32_16x16x32_bf16 v[104:107], a[8:11], v[64:67], 0
    ds_read_b128 v[88:91], v224 offset:12288
    v_mfma_f32_16x16x32_bf16 v[108:111], a[12:15], v[64:67], 0
    ds_read_b128 v[92:95], v224 offset:14336
    v_mfma_f32_16x16x32_bf16 v[112:115], a[0:3], v[68:71], 0
    ds_read_b64_tr_b16 a[16:17], v228 offset:4096
    v_mfma_f32_16x16x32_bf16 v[116:119], a[4:7], v[68:71], 0
    ds_read_b64_tr_b16 a[18:19], v228 offset:4608
    v_mfma_f32_16x16x32_bf16 v[120:123], a[8:11], v[68:71], 0
    ds_read_b64_tr_b16 a[20:21], v229 offset:4096
    v_mfma_f32_16x16x32_bf16 v[124:127], a[12:15], v[68:71], 0
    ds_read_b64_tr_b16 a[22:23], v229 offset:4608
    v_mfma_f32_16x16x32_bf16 v[128:131], a[0:3], v[72:75], 0
    s_add_u32 m0, s35, 16384
    s_and_b32 s33, s82, 1023
    s_lshl_b32 s33, s33, 12
    buffer_load_dwordx4 v234, s[48:51], s33 offen lds
    v_mfma_f32_16x16x32_bf16 v[132:135], a[4:7], v[72:75], 0
    buffer_load_dwordx4 v235, s[48:51], s33 offen offset:1024 lds
    v_mfma_f32_16x16x32_bf16 v[136:139], a[8:11], v[72:75], 0
    s_add_u32 m0, s35, 18432
    s_add_u32 s33, s33, 131072
    buffer_load_dwordx4 v234, s[48:51], s33 offen lds
    v_mfma_f32_16x16x32_bf16 v[140:143], a[12:15], v[72:75], 0
    v_mfma_f32_16x16x32_bf16 v[144:147], a[0:3], v[76:79], 0
    buffer_load_dwordx4 v235, s[48:51], s33 offen offset:1024 lds
    v_mfma_f32_16x16x32_bf16 v[148:151], a[4:7], v[76:79], 0
    buffer_load_dwordx4 v[0:3], v236, s[52:55], 0 offen offset:0
    v_mfma_f32_16x16x32_bf16 v[152:155], a[8:11], v[76:79], 0
    buffer_load_dwordx4 v[4:7], v236, s[52:55], 0 offen offset:512
    v_mfma_f32_16x16x32_bf16 v[156:159], a[12:15], v[76:79], 0
    s_waitcnt lgkmcnt(0)
    v_mfma_f32_16x16x32_bf16 v[160:163], a[0:3], v[80:83], 0
    ds_read_b128 v[64:67], v225 offset:0
    v_mfma_f32_16x16x32_bf16 v[164:167], a[4:7], v[80:83], 0
    ds_read_b128 v[68:71], v225 offset:2048
    v_mfma_f32_16x16x32_bf16 v[168:171], a[8:11], v[80:83], 0
    ds_read_b128 v[72:75], v225 offset:4096
    v_mfma_f32_16x16x32_bf16 v[172:175], a[12:15], v[80:83], 0
    ds_read_b128 v[76:79], v225 offset:6144
    v_mfma_f32_16x16x32_bf16 v[176:179], a[0:3], v[84:87], 0
    ds_read_b64_tr_b16 a[24:25], v230 offset:4096
    v_mfma_f32_16x16x32_bf16 v[180:183], a[4:7], v[84:87], 0
    ds_read_b64_tr_b16 a[26:27], v230 offset:4608
    v_mfma_f32_16x16x32_bf16 v[184:187], a[8:11], v[84:87], 0
    ds_read_b64_tr_b16 a[28:29], v231 offset:4096
    v_mfma_f32_16x16x32_bf16 v[188:191], a[12:15], v[84:87], 0
    ds_read_b64_tr_b16 a[30:31], v231 offset:4608
    v_mfma_f32_16x16x32_bf16 v[192:195], a[0:3], v[88:91], 0
    s_add_u32 m0, s35, 20480
    s_add_u32 s33, s33, 131072
    buffer_load_dwordx4 v234, s[48:51], s33 offen lds
    v_mfma_f32_16x16x32_bf16 v[196:199], a[4:7], v[88:91], 0
    buffer_load_dwordx4 v235, s[48:51], s33 offen offset:1024 lds
    v_mfma_f32_16x16x32_bf16 v[200:203], a[8:11], v[88:91], 0
    s_add_u32 m0, s35, 22528
    s_add_u32 s33, s33, 131072
    buffer_load_dwordx4 v234, s[48:51], s33 offen lds
    v_mfma_f32_16x16x32_bf16 v[204:207], a[12:15], v[88:91], 0
    v_mfma_f32_16x16x32_bf16 v[208:211], a[0:3], v[92:95], 0
    buffer_load_dwordx4 v235, s[48:51], s33 offen offset:1024 lds
    v_mfma_f32_16x16x32_bf16 v[212:215], a[4:7], v[92:95], 0
    buffer_load_dwordx4 v[8:11], v236, s[52:55], 0 offen offset:1024
    v_mfma_f32_16x16x32_bf16 v[216:219], a[8:11], v[92:95], 0
    buffer_load_dwordx4 v[12:15], v236, s[52:55], 0 offen offset:1536
    v_mfma_f32_16x16x32_bf16 v[220:223], a[12:15], v[92:95], 0
    s_waitcnt vmcnt(17) lgkmcnt(0)
    v_mfma_f32_16x16x32_bf16 v[96:99], a[16:19], v[64:67], v[96:99]
    ds_read_b128 v[80:83], v225 offset:8192
    v_mfma_f32_16x16x32_bf16 v[100:103], a[20:23], v[64:67], v[100:103]
    ds_read_b128 v[84:87], v225 offset:10240
    v_mfma_f32_16x16x32_bf16 v[104:107], a[24:27], v[64:67], v[104:107]
    ds_read_b128 v[88:91], v225 offset:12288
    v_mfma_f32_16x16x32_bf16 v[108:111], a[28:31], v[64:67], v[108:111]
    ds_read_b128 v[92:95], v225 offset:14336
    v_mfma_f32_16x16x32_bf16 v[112:115], a[16:19], v[68:71], v[112:115]
    ds_read_b64_tr_b16 a[32:33], v228 offset:8192
    v_mfma_f32_16x16x32_bf16 v[116:119], a[20:23], v[68:71], v[116:119]
    ds_read_b64_tr_b16 a[34:35], v228 offset:8704
    v_mfma_f32_16x16x32_bf16 v[120:123], a[24:27], v[68:71], v[120:123]
    ds_read_b64_tr_b16 a[36:37], v229 offset:8192
    v_mfma_f32_16x16x32_bf16 v[124:127], a[28:31], v[68:71], v[124:127]
    ds_read_b64_tr_b16 a[38:39], v229 offset:8704
    v_mfma_f32_16x16x32_bf16 v[128:131], a[16:19], v[72:75], v[128:131]
    s_add_u32 m0, s34, 32768
    s_add_u32 s37, s82, 0
    buffer_load_dwordx4 v232, s[44:47], s37 offen lds
    v_mfma_f32_16x16x32_bf16 v[132:135], a[20:23], v[72:75], v[132:135]
    buffer_load_dwordx4 v233, s[44:47], s37 offen offset:1024 lds
    v_mfma_f32_16x16x32_bf16 v[136:139], a[24:27], v[72:75], v[136:139]
    s_add_u32 m0, s34, 40960
    s_add_u32 s37, s82, 65536
    buffer_load_dwordx4 v232, s[44:47], s37 offen lds
    v_mfma_f32_16x16x32_bf16 v[140:143], a[28:31], v[72:75], v[140:143]
    buffer_load_dwordx4 v233, s[44:47], s37 offen offset:1024 lds
    v_mfma_f32_16x16x32_bf16 v[144:147], a[16:19], v[76:79], v[144:147]
    s_add_u32 m0, s35, 0
    s_and_b32 s33, s83, 1023
    s_lshl_b32 s33, s33, 12
    buffer_load_dwordx4 v234, s[48:51], s33 offen lds
    v_mfma_f32_16x16x32_bf16 v[148:151], a[20:23], v[76:79], v[148:151]
    buffer_load_dwordx4 v235, s[48:51], s33 offen offset:1024 lds
    v_mfma_f32_16x16x32_bf16 v[152:155], a[24:27], v[76:79], v[152:155]
    s_add_u32 m0, s35, 2048
    s_add_u32 s33, s33, 131072
    buffer_load_dwordx4 v234, s[48:51], s33 offen lds
    v_mfma_f32_16x16x32_bf16 v[156:159], a[28:31], v[76:79], v[156:159]
    buffer_load_dwordx4 v235, s[48:51], s33 offen offset:1024 lds
    s_waitcnt vmcnt(21) lgkmcnt(0)
    s_barrier
    v_mfma_f32_16x16x32_bf16 v[160:163], a[16:19], v[80:83], v[160:163]
    ds_read_b128 v[64:67], v224 offset:16384
    v_mfma_f32_16x16x32_bf16 v[164:167], a[20:23], v[80:83], v[164:167]
    ds_read_b128 v[68:71], v224 offset:18432
    v_mfma_f32_16x16x32_bf16 v[168:171], a[24:27], v[80:83], v[168:171]
    ds_read_b128 v[72:75], v224 offset:20480
    v_mfma_f32_16x16x32_bf16 v[172:175], a[28:31], v[80:83], v[172:175]
    ds_read_b128 v[76:79], v224 offset:22528
    v_mfma_f32_16x16x32_bf16 v[176:179], a[16:19], v[84:87], v[176:179]
    ds_read_b64_tr_b16 a[40:41], v230 offset:8192
    v_mfma_f32_16x16x32_bf16 v[180:183], a[20:23], v[84:87], v[180:183]
    ds_read_b64_tr_b16 a[42:43], v230 offset:8704
    v_mfma_f32_16x16x32_bf16 v[184:187], a[24:27], v[84:87], v[184:187]
    ds_read_b64_tr_b16 a[44:45], v231 offset:8192
    v_mfma_f32_16x16x32_bf16 v[188:191], a[28:31], v[84:87], v[188:191]
    ds_read_b64_tr_b16 a[46:47], v231 offset:8704
    v_mfma_f32_16x16x32_bf16 v[192:195], a[16:19], v[88:91], v[192:195]
    s_add_u32 m0, s34, 49152
    s_add_u32 s37, s83, 0
    buffer_load_dwordx4 v232, s[44:47], s37 offen lds
    v_mfma_f32_16x16x32_bf16 v[196:199], a[20:23], v[88:91], v[196:199]
    buffer_load_dwordx4 v233, s[44:47], s37 offen offset:1024 lds
    v_mfma_f32_16x16x32_bf16 v[200:203], a[24:27], v[88:91], v[200:203]
    s_add_u32 m0, s34, 57344
    s_add_u32 s37, s83, 65536
    buffer_load_dwordx4 v232, s[44:47], s37 offen lds
    v_mfma_f32_16x16x32_bf16 v[204:207], a[28:31], v[88:91], v[204:207]
    v_mfma_f32_16x16x32_bf16 v[208:211], a[16:19], v[92:95], v[208:211]
    buffer_load_dwordx4 v233, s[44:47], s37 offen offset:1024 lds
    v_mfma_f32_16x16x32_bf16 v[212:215], a[20:23], v[92:95], v[212:215]
    s_add_u32 m0, s34, 0
    s_add_u32 s37, s84, 0
    buffer_load_dwordx4 v232, s[44:47], s37 offen lds
    v_mfma_f32_16x16x32_bf16 v[216:219], a[24:27], v[92:95], v[216:219]
    buffer_load_dwordx4 v233, s[44:47], s37 offen offset:1024 lds
    v_mfma_f32_16x16x32_bf16 v[220:223], a[28:31], v[92:95], v[220:223]
    s_waitcnt lgkmcnt(0)
    v_mfma_f32_16x16x32_bf16 v[96:99], a[32:35], v[64:67], v[96:99]
    ds_read_b128 v[80:83], v224 offset:24576
    v_mfma_f32_16x16x32_bf16 v[100:103], a[36:39], v[64:67], v[100:103]
    ds_read_b128 v[84:87], v224 offset:26624
    v_mfma_f32_16x16x32_bf16 v[104:107], a[40:43], v[64:67], v[104:107]
    ds_read_b128 v[88:91], v224 offset:28672
    v_mfma_f32_16x16x32_bf16 v[108:111], a[44:47], v[64:67], v[108:111]
    ds_read_b128 v[92:95], v224 offset:30720
    v_mfma_f32_16x16x32_bf16 v[112:115], a[32:35], v[68:71], v[112:115]
    ds_read_b64_tr_b16 a[48:49], v228 offset:12288
    v_mfma_f32_16x16x32_bf16 v[116:119], a[36:39], v[68:71], v[116:119]
    ds_read_b64_tr_b16 a[50:51], v228 offset:12800
    v_mfma_f32_16x16x32_bf16 v[120:123], a[40:43], v[68:71], v[120:123]
    ds_read_b64_tr_b16 a[52:53], v229 offset:12288
    v_mfma_f32_16x16x32_bf16 v[124:127], a[44:47], v[68:71], v[124:127]
    ds_read_b64_tr_b16 a[54:55], v229 offset:12800
    v_mfma_f32_16x16x32_bf16 v[128:131], a[32:35], v[72:75], v[128:131]
    s_add_u32 m0, s35, 4096
    s_add_u32 s33, s33, 131072
    buffer_load_dwordx4 v234, s[48:51], s33 offen lds
    v_mfma_f32_16x16x32_bf16 v[132:135], a[36:39], v[72:75], v[132:135]
    v_mfma_f32_16x16x32_bf16 v[136:139], a[40:43], v[72:75], v[136:139]
    buffer_load_dwordx4 v235, s[48:51], s33 offen offset:1024 lds
    v_mfma_f32_16x16x32_bf16 v[140:143], a[44:47], v[72:75], v[140:143]
    v_mfma_f32_16x16x32_bf16 v[144:147], a[32:35], v[76:79], v[144:147]
    s_add_u32 m0, s35, 6144
    s_add_u32 s33, s33, 131072
    buffer_load_dwordx4 v234, s[48:51], s33 offen lds
    v_mfma_f32_16x16x32_bf16 v[148:151], a[36:39], v[76:79], v[148:151]
    v_mfma_f32_16x16x32_bf16 v[152:155], a[40:43], v[76:79], v[152:155]
    buffer_load_dwordx4 v235, s[48:51], s33 offen offset:1024 lds
    v_mfma_f32_16x16x32_bf16 v[156:159], a[44:47], v[76:79], v[156:159]
    s_waitcnt lgkmcnt(0)
    v_mfma_f32_16x16x32_bf16 v[160:163], a[32:35], v[80:83], v[160:163]
    ds_read_b128 v[64:67], v225 offset:16384
    v_mfma_f32_16x16x32_bf16 v[164:167], a[36:39], v[80:83], v[164:167]
    ds_read_b128 v[68:71], v225 offset:18432
    v_mfma_f32_16x16x32_bf16 v[168:171], a[40:43], v[80:83], v[168:171]
    ds_read_b128 v[72:75], v225 offset:20480
    v_mfma_f32_16x16x32_bf16 v[172:175], a[44:47], v[80:83], v[172:175]
    ds_read_b128 v[76:79], v225 offset:22528
    v_mfma_f32_16x16x32_bf16 v[176:179], a[32:35], v[84:87], v[176:179]
    ds_read_b64_tr_b16 a[56:57], v230 offset:12288
    v_mfma_f32_16x16x32_bf16 v[180:183], a[36:39], v[84:87], v[180:183]
    ds_read_b64_tr_b16 a[58:59], v230 offset:12800
    v_mfma_f32_16x16x32_bf16 v[184:187], a[40:43], v[84:87], v[184:187]
    ds_read_b64_tr_b16 a[60:61], v231 offset:12288
    v_mfma_f32_16x16x32_bf16 v[188:191], a[44:47], v[84:87], v[188:191]
    ds_read_b64_tr_b16 a[62:63], v231 offset:12800
    v_mfma_f32_16x16x32_bf16 v[192:195], a[32:35], v[88:91], v[192:195]
    s_add_u32 m0, s34, 8192
    s_add_u32 s37, s84, 65536
    buffer_load_dwordx4 v232, s[44:47], s37 offen lds
    v_mfma_f32_16x16x32_bf16 v[196:199], a[36:39], v[88:91], v[196:199]
    v_mfma_f32_16x16x32_bf16 v[200:203], a[40:43], v[88:91], v[200:203]
    v_mfma_f32_16x16x32_bf16 v[204:207], a[44:47], v[88:91], v[204:207]
    v_mfma_f32_16x16x32_bf16 v[208:211], a[32:35], v[92:95], v[208:211]
    buffer_load_dwordx4 v233, s[44:47], s37 offen offset:1024 lds
    v_mfma_f32_16x16x32_bf16 v[212:215], a[36:39], v[92:95], v[212:215]
    v_mfma_f32_16x16x32_bf16 v[216:219], a[40:43], v[92:95], v[216:219]
    v_mfma_f32_16x16x32_bf16 v[220:223], a[44:47], v[92:95], v[220:223]
    s_waitcnt vmcnt(22) lgkmcnt(0)
    v_mfma_f32_16x16x32_bf16 v[96:99], a[48:51], v[64:67], v[96:99]
    ds_read_b128 v[80:83], v225 offset:24576
    v_mfma_f32_16x16x32_bf16 v[100:103], a[52:55], v[64:67], v[100:103]
    ds_read_b128 v[84:87], v225 offset:26624
    v_mfma_f32_16x16x32_bf16 v[104:107], a[56:59], v[64:67], v[104:107]
    ds_read_b128 v[88:91], v225 offset:28672
    v_mfma_f32_16x16x32_bf16 v[108:111], a[60:63], v[64:67], v[108:111]
    ds_read_b128 v[92:95], v225 offset:30720
    v_mfma_f32_16x16x32_bf16 v[112:115], a[48:51], v[68:71], v[112:115]
    ds_read_b64_tr_b16 a[64:65], v228 offset:16384
    v_mfma_f32_16x16x32_bf16 v[116:119], a[52:55], v[68:71], v[116:119]
    ds_read_b64_tr_b16 a[66:67], v228 offset:16896
    v_mfma_f32_16x16x32_bf16 v[120:123], a[56:59], v[68:71], v[120:123]
    ds_read_b64_tr_b16 a[68:69], v229 offset:16384
    v_mfma_f32_16x16x32_bf16 v[124:127], a[60:63], v[68:71], v[124:127]
    ds_read_b64_tr_b16 a[70:71], v229 offset:16896
    v_mfma_f32_16x16x32_bf16 v[128:131], a[48:51], v[72:75], v[128:131]
    s_add_u32 m0, s35, 8192
    s_and_b32 s33, s84, 1023
    s_lshl_b32 s33, s33, 12
    buffer_load_dwordx4 v234, s[48:51], s33 offen lds
    v_mfma_f32_16x16x32_bf16 v[132:135], a[52:55], v[72:75], v[132:135]
    v_mfma_f32_16x16x32_bf16 v[136:139], a[56:59], v[72:75], v[136:139]
    buffer_load_dwordx4 v235, s[48:51], s33 offen offset:1024 lds
    v_mfma_f32_16x16x32_bf16 v[140:143], a[60:63], v[72:75], v[140:143]
    v_mfma_f32_16x16x32_bf16 v[144:147], a[48:51], v[76:79], v[144:147]
    s_add_u32 m0, s35, 10240
    s_add_u32 s33, s33, 131072
    buffer_load_dwordx4 v234, s[48:51], s33 offen lds
    v_mfma_f32_16x16x32_bf16 v[148:151], a[52:55], v[76:79], v[148:151]
    v_mfma_f32_16x16x32_bf16 v[152:155], a[56:59], v[76:79], v[152:155]
    buffer_load_dwordx4 v235, s[48:51], s33 offen offset:1024 lds
    v_mfma_f32_16x16x32_bf16 v[156:159], a[60:63], v[76:79], v[156:159]
    s_waitcnt vmcnt(20) lgkmcnt(0)
    s_barrier
    v_mfma_f32_16x16x32_bf16 v[160:163], a[48:51], v[80:83], v[160:163]
    ds_read_b128 v[64:67], v224 offset:32768
    v_mfma_f32_16x16x32_bf16 v[164:167], a[52:55], v[80:83], v[164:167]
    ds_read_b128 v[68:71], v224 offset:34816
    v_mfma_f32_16x16x32_bf16 v[168:171], a[56:59], v[80:83], v[168:171]
    ds_read_b128 v[72:75], v224 offset:36864
    v_mfma_f32_16x16x32_bf16 v[172:175], a[60:63], v[80:83], v[172:175]
    ds_read_b128 v[76:79], v224 offset:38912
    v_mfma_f32_16x16x32_bf16 v[176:179], a[48:51], v[84:87], v[176:179]
    ds_read_b64_tr_b16 a[72:73], v230 offset:16384
    v_mfma_f32_16x16x32_bf16 v[180:183], a[52:55], v[84:87], v[180:183]
    ds_read_b64_tr_b16 a[74:75], v230 offset:16896
    v_mfma_f32_16x16x32_bf16 v[184:187], a[56:59], v[84:87], v[184:187]
    ds_read_b64_tr_b16 a[76:77], v231 offset:16384
    v_mfma_f32_16x16x32_bf16 v[188:191], a[60:63], v[84:87], v[188:191]
    ds_read_b64_tr_b16 a[78:79], v231 offset:16896
    v_mfma_f32_16x16x32_bf16 v[192:195], a[48:51], v[88:91], v[192:195]
    s_add_u32 m0, s34, 16384
    s_add_u32 s37, s85, 0
    buffer_load_dwordx4 v232, s[44:47], s37 offen lds
    v_mfma_f32_16x16x32_bf16 v[196:199], a[52:55], v[88:91], v[196:199]
    v_mfma_f32_16x16x32_bf16 v[200:203], a[56:59], v[88:91], v[200:203]
    v_mfma_f32_16x16x32_bf16 v[204:207], a[60:63], v[88:91], v[204:207]
    v_mfma_f32_16x16x32_bf16 v[208:211], a[48:51], v[92:95], v[208:211]
    buffer_load_dwordx4 v233, s[44:47], s37 offen offset:1024 lds
    v_mfma_f32_16x16x32_bf16 v[212:215], a[52:55], v[92:95], v[212:215]
    v_mfma_f32_16x16x32_bf16 v[216:219], a[56:59], v[92:95], v[216:219]
    v_mfma_f32_16x16x32_bf16 v[220:223], a[60:63], v[92:95], v[220:223]
    s_waitcnt lgkmcnt(0)
    v_mfma_f32_16x16x32_bf16 v[96:99], a[64:67], v[64:67], v[96:99]
    ds_read_b128 v[80:83], v224 offset:40960
    s_waitcnt vmcnt(26)
    v_mfma_f32_16x16x32_bf16 v[100:103], a[68:71], v[64:67], v[100:103]
    ds_read_b128 v[84:87], v224 offset:43008
    v_lshlrev_b32 v16, 16, v0
    v_mfma_f32_16x16x32_bf16 v[104:107], a[72:75], v[64:67], v[104:107]
    ds_read_b128 v[88:91], v224 offset:45056
    v_and_b32 v17, 0xffff0000, v0
    v_mfma_f32_16x16x32_bf16 v[108:111], a[76:79], v[64:67], v[108:111]
    ds_read_b128 v[92:95], v224 offset:47104
    v_lshlrev_b32 v18, 16, v1
    v_mfma_f32_16x16x32_bf16 v[112:115], a[64:67], v[68:71], v[112:115]
    ds_read_b64_tr_b16 a[80:81], v228 offset:20480
    v_and_b32 v19, 0xffff0000, v1
    v_mfma_f32_16x16x32_bf16 v[116:119], a[68:71], v[68:71], v[116:119]
    ds_read_b64_tr_b16 a[82:83], v228 offset:20992
    v_lshlrev_b32 v20, 16, v2
    v_mfma_f32_16x16x32_bf16 v[120:123], a[72:75], v[68:71], v[120:123]
    ds_read_b64_tr_b16 a[84:85], v229 offset:20480
    v_and_b32 v21, 0xffff0000, v2
    v_mfma_f32_16x16x32_bf16 v[124:127], a[76:79], v[68:71], v[124:127]
    ds_read_b64_tr_b16 a[86:87], v229 offset:20992
    v_lshlrev_b32 v22, 16, v3
    v_mfma_f32_16x16x32_bf16 v[128:131], a[64:67], v[72:75], v[128:131]
    s_add_u32 m0, s35, 12288
    s_add_u32 s33, s33, 131072
    buffer_load_dwordx4 v234, s[48:51], s33 offen lds
    v_mfma_f32_16x16x32_bf16 v[132:135], a[68:71], v[72:75], v[132:135]
    v_and_b32 v23, 0xffff0000, v3
    v_lshlrev_b32 v24, 16, v4
    v_mfma_f32_16x16x32_bf16 v[136:139], a[72:75], v[72:75], v[136:139]
    buffer_load_dwordx4 v235, s[48:51], s33 offen offset:1024 lds
    v_and_b32 v25, 0xffff0000, v4
    v_mfma_f32_16x16x32_bf16 v[140:143], a[76:79], v[72:75], v[140:143]
    v_lshlrev_b32 v26, 16, v5
    v_and_b32 v27, 0xffff0000, v5
    v_mfma_f32_16x16x32_bf16 v[144:147], a[64:67], v[76:79], v[144:147]
    s_add_u32 m0, s35, 14336
    s_add_u32 s33, s33, 131072
    buffer_load_dwordx4 v234, s[48:51], s33 offen lds
    v_mfma_f32_16x16x32_bf16 v[148:151], a[68:71], v[76:79], v[148:151]
    v_lshlrev_b32 v28, 16, v6
    v_and_b32 v29, 0xffff0000, v6
    v_mfma_f32_16x16x32_bf16 v[152:155], a[72:75], v[76:79], v[152:155]
    buffer_load_dwordx4 v235, s[48:51], s33 offen offset:1024 lds
    v_lshlrev_b32 v30, 16, v7
    v_mfma_f32_16x16x32_bf16 v[156:159], a[76:79], v[76:79], v[156:159]
    v_and_b32 v31, 0xffff0000, v7
    s_waitcnt lgkmcnt(0)
    v_mfma_f32_16x16x32_bf16 v[160:163], a[64:67], v[80:83], v[160:163]
    ds_read_b128 v[64:67], v225 offset:32768
    v_lshlrev_b32 v32, 16, v8
    v_mfma_f32_16x16x32_bf16 v[164:167], a[68:71], v[80:83], v[164:167]
    ds_read_b128 v[68:71], v225 offset:34816
    v_and_b32 v33, 0xffff0000, v8
    v_mfma_f32_16x16x32_bf16 v[168:171], a[72:75], v[80:83], v[168:171]
    ds_read_b128 v[72:75], v225 offset:36864
    v_lshlrev_b32 v34, 16, v9
    v_mfma_f32_16x16x32_bf16 v[172:175], a[76:79], v[80:83], v[172:175]
    ds_read_b128 v[76:79], v225 offset:38912
    v_and_b32 v35, 0xffff0000, v9
    v_mfma_f32_16x16x32_bf16 v[176:179], a[64:67], v[84:87], v[176:179]
    ds_read_b64_tr_b16 a[88:89], v230 offset:20480
    v_lshlrev_b32 v36, 16, v10
    v_mfma_f32_16x16x32_bf16 v[180:183], a[68:71], v[84:87], v[180:183]
    ds_read_b64_tr_b16 a[90:91], v230 offset:20992
    v_and_b32 v37, 0xffff0000, v10
    v_mfma_f32_16x16x32_bf16 v[184:187], a[72:75], v[84:87], v[184:187]
    ds_read_b64_tr_b16 a[92:93], v231 offset:20480
    v_lshlrev_b32 v38, 16, v11
    v_mfma_f32_16x16x32_bf16 v[188:191], a[76:79], v[84:87], v[188:191]
    ds_read_b64_tr_b16 a[94:95], v231 offset:20992
    v_and_b32 v39, 0xffff0000, v11
    v_mfma_f32_16x16x32_bf16 v[192:195], a[64:67], v[88:91], v[192:195]
    s_add_u32 m0, s34, 24576
    s_add_u32 s37, s85, 65536
    buffer_load_dwordx4 v232, s[44:47], s37 offen lds
    v_mfma_f32_16x16x32_bf16 v[196:199], a[68:71], v[88:91], v[196:199]
    v_lshlrev_b32 v40, 16, v12
    v_and_b32 v41, 0xffff0000, v12
    v_mfma_f32_16x16x32_bf16 v[200:203], a[72:75], v[88:91], v[200:203]
    v_lshlrev_b32 v42, 16, v13
    v_and_b32 v43, 0xffff0000, v13
    v_mfma_f32_16x16x32_bf16 v[204:207], a[76:79], v[88:91], v[204:207]
    v_lshlrev_b32 v44, 16, v14
    v_and_b32 v45, 0xffff0000, v14
    v_mfma_f32_16x16x32_bf16 v[208:211], a[64:67], v[92:95], v[208:211]
    buffer_load_dwordx4 v233, s[44:47], s37 offen offset:1024 lds
    v_lshlrev_b32 v46, 16, v15
    v_mfma_f32_16x16x32_bf16 v[212:215], a[68:71], v[92:95], v[212:215]
    v_and_b32 v47, 0xffff0000, v15
    v_add_f32 v52, v16, v20
    v_mfma_f32_16x16x32_bf16 v[216:219], a[72:75], v[92:95], v[216:219]
    v_add_f32 v53, v17, v21
    v_add_f32 v54, v18, v22
    v_mfma_f32_16x16x32_bf16 v[220:223], a[76:79], v[92:95], v[220:223]
    v_add_f32 v55, v19, v23
    s_waitcnt vmcnt(14) lgkmcnt(0)
    v_mfma_f32_16x16x32_bf16 v[96:99], a[80:83], v[64:67], v[96:99]
    ds_read_b128 v[80:83], v225 offset:40960
    v_add_f32 v52, v52, v24
    v_mfma_f32_16x16x32_bf16 v[100:103], a[84:87], v[64:67], v[100:103]
    ds_read_b128 v[84:87], v225 offset:43008
    v_add_f32 v53, v53, v25
    v_mfma_f32_16x16x32_bf16 v[104:107], a[88:91], v[64:67], v[104:107]
    ds_read_b128 v[88:91], v225 offset:45056
    v_add_f32 v54, v54, v26
    v_mfma_f32_16x16x32_bf16 v[108:111], a[92:95], v[64:67], v[108:111]
    ds_read_b128 v[92:95], v225 offset:47104
    v_add_f32 v55, v55, v27
    v_mfma_f32_16x16x32_bf16 v[112:115], a[80:83], v[68:71], v[112:115]
    ds_read_b64_tr_b16 a[96:97], v228 offset:0
    v_add_f32 v52, v52, v28
    v_mfma_f32_16x16x32_bf16 v[116:119], a[84:87], v[68:71], v[116:119]
    ds_read_b64_tr_b16 a[98:99], v228 offset:512
    v_add_f32 v53, v53, v29
    v_mfma_f32_16x16x32_bf16 v[120:123], a[88:91], v[68:71], v[120:123]
    ds_read_b64_tr_b16 a[100:101], v229 offset:0
    v_add_f32 v54, v54, v30
    v_mfma_f32_16x16x32_bf16 v[124:127], a[92:95], v[68:71], v[124:127]
    ds_read_b64_tr_b16 a[102:103], v229 offset:512
    v_add_f32 v55, v55, v31
    v_mfma_f32_16x16x32_bf16 v[128:131], a[80:83], v[72:75], v[128:131]
    s_add_u32 m0, s35, 16384
    s_and_b32 s33, s85, 1023
    s_lshl_b32 s33, s33, 12
    buffer_load_dwordx4 v234, s[48:51], s33 offen lds
    v_mfma_f32_16x16x32_bf16 v[132:135], a[84:87], v[72:75], v[132:135]
    buffer_load_dwordx4 v235, s[48:51], s33 offen offset:1024 lds
    v_add_f32 v52, v52, v32
    v_mfma_f32_16x16x32_bf16 v[136:139], a[88:91], v[72:75], v[136:139]
    s_add_u32 m0, s35, 18432
    s_add_u32 s33, s33, 131072
    buffer_load_dwordx4 v234, s[48:51], s33 offen lds
    v_mfma_f32_16x16x32_bf16 v[140:143], a[92:95], v[72:75], v[140:143]
    v_add_f32 v53, v53, v33
    v_add_f32 v54, v54, v34
    v_mfma_f32_16x16x32_bf16 v[144:147], a[80:83], v[76:79], v[144:147]
    buffer_load_dwordx4 v235, s[48:51], s33 offen offset:1024 lds
    v_add_f32 v55, v55, v35
    v_mfma_f32_16x16x32_bf16 v[148:151], a[84:87], v[76:79], v[148:151]
    s_lshl2_add_u32 s26, s4, s3
    s_lshl_b32 s26, s26, 10
    s_add_u32 s26, s26, s32
    s_add_u32 s26, s26, 131072
    v_mfma_f32_16x16x32_bf16 v[152:155], a[88:91], v[76:79], v[152:155]
    v_and_b32 v226, 0x40000380, v251
    buffer_load_dword v241, v226, s[44:47], s26 offen
    v_mfma_f32_16x16x32_bf16 v[156:159], a[92:95], v[76:79], v[156:159]
    s_waitcnt vmcnt(25) lgkmcnt(0)
    s_barrier
    v_mfma_f32_16x16x32_bf16 v[160:163], a[80:83], v[80:83], v[160:163]
    ds_read_b128 v[64:67], v224 offset:49152
    v_add_f32 v52, v52, v36
    v_add_f32 v53, v53, v37
    v_mfma_f32_16x16x32_bf16 v[164:167], a[84:87], v[80:83], v[164:167]
    ds_read_b128 v[68:71], v224 offset:51200
    v_add_f32 v54, v54, v38
    v_mfma_f32_16x16x32_bf16 v[168:171], a[88:91], v[80:83], v[168:171]
    ds_read_b128 v[72:75], v224 offset:53248
    v_add_f32 v55, v55, v39
    v_mfma_f32_16x16x32_bf16 v[172:175], a[92:95], v[80:83], v[172:175]
    ds_read_b128 v[76:79], v224 offset:55296
    v_add_f32 v52, v52, v40
    v_mfma_f32_16x16x32_bf16 v[176:179], a[80:83], v[84:87], v[176:179]
    ds_read_b64_tr_b16 a[104:105], v230 offset:0
    v_add_f32 v53, v53, v41
    v_mfma_f32_16x16x32_bf16 v[180:183], a[84:87], v[84:87], v[180:183]
    ds_read_b64_tr_b16 a[106:107], v230 offset:512
    v_add_f32 v54, v54, v42
    v_mfma_f32_16x16x32_bf16 v[184:187], a[88:91], v[84:87], v[184:187]
    ds_read_b64_tr_b16 a[108:109], v231 offset:0
    v_add_f32 v55, v55, v43
    v_mfma_f32_16x16x32_bf16 v[188:191], a[92:95], v[84:87], v[188:191]
    ds_read_b64_tr_b16 a[110:111], v231 offset:512
    v_add_f32 v52, v52, v44
    v_mfma_f32_16x16x32_bf16 v[192:195], a[80:83], v[88:91], v[192:195]
    s_add_u32 m0, s34, 32768
    s_add_u32 s37, s86, 0
    buffer_load_dwordx4 v232, s[44:47], s37 offen lds
    v_mfma_f32_16x16x32_bf16 v[196:199], a[84:87], v[88:91], v[196:199]
    v_add_f32 v53, v53, v45
    v_add_f32 v54, v54, v46
    v_mfma_f32_16x16x32_bf16 v[200:203], a[88:91], v[88:91], v[200:203]
    v_add_f32 v55, v55, v47
    v_add_f32 v52, v52, v53
    v_mfma_f32_16x16x32_bf16 v[204:207], a[92:95], v[88:91], v[204:207]
    v_add_f32 v54, v54, v55
    v_add_f32 v48, v52, v54
    v_mfma_f32_16x16x32_bf16 v[208:211], a[80:83], v[92:95], v[208:211]
    buffer_load_dwordx4 v233, s[44:47], s37 offen offset:1024 lds
    s_nop 1
    v_mfma_f32_16x16x32_bf16 v[212:215], a[84:87], v[92:95], v[212:215]
    v_add_f32_dpp v48, v48, v48 quad_perm:[1,0,3,2] row_mask:0xf bank_mask:0xf
    s_nop 1
    v_mfma_f32_16x16x32_bf16 v[216:219], a[88:91], v[92:95], v[216:219]
    v_add_f32_dpp v48, v48, v48 quad_perm:[2,3,0,1] row_mask:0xf bank_mask:0xf
    s_nop 1
    v_mfma_f32_16x16x32_bf16 v[220:223], a[92:95], v[92:95], v[220:223]
    v_add_f32_dpp v48, v48, v48 row_half_mirror row_mask:0xf bank_mask:0xf
    s_waitcnt lgkmcnt(0)
    v_mfma_f32_16x16x32_bf16 v[96:99], a[96:99], v[64:67], v[96:99]
    ds_read_b128 v[80:83], v224 offset:57344
    s_nop 1
    v_mfma_f32_16x16x32_bf16 v[100:103], a[100:103], v[64:67], v[100:103]
    ds_read_b128 v[84:87], v224 offset:59392
    v_add_f32_dpp v48, v48, v48 row_mirror row_mask:0xf bank_mask:0xf
    v_mfma_f32_16x16x32_bf16 v[104:107], a[104:107], v[64:67], v[104:107]
    ds_read_b128 v[88:91], v224 offset:61440
    s_nop 0
    v_mfma_f32_16x16x32_bf16 v[108:111], a[108:111], v[64:67], v[108:111]
    ds_read_b128 v[92:95], v224 offset:63488
    v_mov_b32 v49, v48
    v_mfma_f32_16x16x32_bf16 v[112:115], a[96:99], v[68:71], v[112:115]
    ds_read_b64_tr_b16 a[112:113], v228 offset:4096
    s_nop 1
    v_mfma_f32_16x16x32_bf16 v[116:119], a[100:103], v[68:71], v[116:119]
    ds_read_b64_tr_b16 a[114:115], v228 offset:4608
    v_permlane16_swap_b32 v48, v49
    v_mfma_f32_16x16x32_bf16 v[120:123], a[104:107], v[68:71], v[120:123]
    ds_read_b64_tr_b16 a[116:117], v229 offset:4096
    s_nop 0
    v_mfma_f32_16x16x32_bf16 v[124:127], a[108:111], v[68:71], v[124:127]
    ds_read_b64_tr_b16 a[118:119], v229 offset:4608
    v_add_f32 v48, v48, v49
    v_mfma_f32_16x16x32_bf16 v[128:131], a[96:99], v[72:75], v[128:131]
    s_add_u32 m0, s35, 20480
    s_add_u32 s33, s33, 131072
    buffer_load_dwordx4 v234, s[48:51], s33 offen lds
    v_mfma_f32_16x16x32_bf16 v[132:135], a[100:103], v[72:75], v[132:135]
    buffer_load_dwordx4 v235, s[48:51], s33 offen offset:1024 lds
    v_mul_f32 v48, 0x3a800000, v48
    v_mfma_f32_16x16x32_bf16 v[136:139], a[104:107], v[72:75], v[136:139]
    v_sub_f32 v56, v16, v48
    v_mul_f32 v52, v56, v56
    v_mfma_f32_16x16x32_bf16 v[140:143], a[108:111], v[72:75], v[140:143]
    s_add_u32 m0, s35, 22528
    s_add_u32 s33, s33, 131072
    buffer_load_dwordx4 v234, s[48:51], s33 offen lds
    v_mfma_f32_16x16x32_bf16 v[144:147], a[96:99], v[76:79], v[144:147]
    buffer_load_dwordx4 v235, s[48:51], s33 offen offset:1024 lds
    v_sub_f32 v57, v17, v48
    v_mfma_f32_16x16x32_bf16 v[148:151], a[100:103], v[76:79], v[148:151]
    v_mul_f32 v53, v57, v57
    v_sub_f32 v58, v18, v48
    v_mfma_f32_16x16x32_bf16 v[152:155], a[104:107], v[76:79], v[152:155]
    v_lshlrev_b32 v226, 7, v253
    s_lshl_b32 s25, s2, 15
    buffer_load_dword v241, v226, s[12:15], s25 offen
    v_mfma_f32_16x16x32_bf16 v[156:159], a[108:111], v[76:79], v[156:159]
    v_mul_f32 v54, v58, v58
    s_waitcnt lgkmcnt(0)
    v_mfma_f32_16x16x32_bf16 v[160:163], a[96:99], v[80:83], v[160:163]
    ds_read_b128 v[64:67], v225 offset:49152
    v_sub_f32 v59, v19, v48
    v_mfma_f32_16x16x32_bf16 v[164:167], a[100:103], v[80:83], v[164:167]
    ds_read_b128 v[68:71], v225 offset:51200
    v_mul_f32 v55, v59, v59
    v_mfma_f32_16x16x32_bf16 v[168:171], a[104:107], v[80:83], v[168:171]
    ds_read_b128 v[72:75], v225 offset:53248
    v_sub_f32 v56, v20, v48
    v_mfma_f32_16x16x32_bf16 v[172:175], a[108:111], v[80:83], v[172:175]
    ds_read_b128 v[76:79], v225 offset:55296
    v_fmac_f32 v52, v56, v56
    v_mfma_f32_16x16x32_bf16 v[176:179], a[96:99], v[84:87], v[176:179]
    ds_read_b64_tr_b16 a[120:121], v230 offset:4096
    v_sub_f32 v57, v21, v48
    v_mfma_f32_16x16x32_bf16 v[180:183], a[100:103], v[84:87], v[180:183]
    ds_read_b64_tr_b16 a[122:123], v230 offset:4608
    v_fmac_f32 v53, v57, v57
    v_mfma_f32_16x16x32_bf16 v[184:187], a[104:107], v[84:87], v[184:187]
    ds_read_b64_tr_b16 a[124:125], v231 offset:4096
    v_sub_f32 v58, v22, v48
    v_mfma_f32_16x16x32_bf16 v[188:191], a[108:111], v[84:87], v[188:191]
    ds_read_b64_tr_b16 a[126:127], v231 offset:4608
    v_fmac_f32 v54, v58, v58
    v_mfma_f32_16x16x32_bf16 v[192:195], a[96:99], v[88:91], v[192:195]
    s_add_u32 m0, s34, 40960
    s_add_u32 s37, s86, 65536
    buffer_load_dwordx4 v232, s[44:47], s37 offen lds
    v_mfma_f32_16x16x32_bf16 v[196:199], a[100:103], v[88:91], v[196:199]
    v_sub_f32 v59, v23, v48
    v_fmac_f32 v55, v59, v59
    v_mfma_f32_16x16x32_bf16 v[200:203], a[104:107], v[88:91], v[200:203]
    v_sub_f32 v56, v24, v48
    v_fmac_f32 v52, v56, v56
    v_mfma_f32_16x16x32_bf16 v[204:207], a[108:111], v[88:91], v[204:207]
    v_sub_f32 v57, v25, v48
    v_fmac_f32 v53, v57, v57
    v_mfma_f32_16x16x32_bf16 v[208:211], a[96:99], v[92:95], v[208:211]
    buffer_load_dwordx4 v233, s[44:47], s37 offen offset:1024 lds
    v_sub_f32 v58, v26, v48
    v_mfma_f32_16x16x32_bf16 v[212:215], a[100:103], v[92:95], v[212:215]
    v_fmac_f32 v54, v58, v58
    v_sub_f32 v59, v27, v48
    v_mfma_f32_16x16x32_bf16 v[216:219], a[104:107], v[92:95], v[216:219]
    v_fmac_f32 v55, v59, v59
    v_sub_f32 v56, v28, v48
    v_mfma_f32_16x16x32_bf16 v[220:223], a[108:111], v[92:95], v[220:223]
    v_fmac_f32 v52, v56, v56
    s_waitcnt vmcnt(16) lgkmcnt(0)
    v_mfma_f32_16x16x32_bf16 v[96:99], a[112:115], v[64:67], v[96:99]
    ds_read_b128 v[80:83], v225 offset:57344
    v_sub_f32 v57, v29, v48
    v_mfma_f32_16x16x32_bf16 v[100:103], a[116:119], v[64:67], v[100:103]
    ds_read_b128 v[84:87], v225 offset:59392
    v_fmac_f32 v53, v57, v57
    v_mfma_f32_16x16x32_bf16 v[104:107], a[120:123], v[64:67], v[104:107]
    ds_read_b128 v[88:91], v225 offset:61440
    v_sub_f32 v58, v30, v48
    v_mfma_f32_16x16x32_bf16 v[108:111], a[124:127], v[64:67], v[108:111]
    ds_read_b128 v[92:95], v225 offset:63488
    v_fmac_f32 v54, v58, v58
    v_mfma_f32_16x16x32_bf16 v[112:115], a[112:115], v[68:71], v[112:115]
    ds_read_b64_tr_b16 a[128:129], v228 offset:8192
    v_sub_f32 v59, v31, v48
    v_mfma_f32_16x16x32_bf16 v[116:119], a[116:119], v[68:71], v[116:119]
    ds_read_b64_tr_b16 a[130:131], v228 offset:8704
    v_fmac_f32 v55, v59, v59
    v_mfma_f32_16x16x32_bf16 v[120:123], a[120:123], v[68:71], v[120:123]
    ds_read_b64_tr_b16 a[132:133], v229 offset:8192
    v_sub_f32 v56, v32, v48
    v_mfma_f32_16x16x32_bf16 v[124:127], a[124:127], v[68:71], v[124:127]
    ds_read_b64_tr_b16 a[134:135], v229 offset:8704
    v_fmac_f32 v52, v56, v56
    v_mfma_f32_16x16x32_bf16 v[128:131], a[112:115], v[72:75], v[128:131]
    s_add_u32 m0, s35, 0
    s_and_b32 s33, s86, 1023
    s_lshl_b32 s33, s33, 12
    buffer_load_dwordx4 v234, s[48:51], s33 offen lds
    v_mfma_f32_16x16x32_bf16 v[132:135], a[116:119], v[72:75], v[132:135]
    v_sub_f32 v57, v33, v48
    v_fmac_f32 v53, v57, v57
    v_mfma_f32_16x16x32_bf16 v[136:139], a[120:123], v[72:75], v[136:139]
    buffer_load_dwordx4 v235, s[48:51], s33 offen offset:1024 lds
    v_sub_f32 v58, v34, v48
    v_mfma_f32_16x16x32_bf16 v[140:143], a[124:127], v[72:75], v[140:143]
    v_fmac_f32 v54, v58, v58
    v_sub_f32 v59, v35, v48
    v_mfma_f32_16x16x32_bf16 v[144:147], a[112:115], v[76:79], v[144:147]
    s_add_u32 m0, s35, 2048
    s_add_u32 s33, s33, 131072
    buffer_load_dwordx4 v234, s[48:51], s33 offen lds
    v_mfma_f32_16x16x32_bf16 v[148:151], a[116:119], v[76:79], v[148:151]
    v_fmac_f32 v55, v59, v59
    v_sub_f32 v56, v36, v48
    v_mfma_f32_16x16x32_bf16 v[152:155], a[120:123], v[76:79], v[152:155]
    buffer_load_dwordx4 v235, s[48:51], s33 offen offset:1024 lds
    v_fmac_f32 v52, v56, v56
    v_mfma_f32_16x16x32_bf16 v[156:159], a[124:127], v[76:79], v[156:159]
    s_waitcnt vmcnt(30) lgkmcnt(0)
    s_barrier
    v_mfma_f32_16x16x32_bf16 v[160:163], a[112:115], v[80:83], v[160:163]
    ds_read_b128 v[64:67], v224 offset:0
    v_sub_f32 v57, v37, v48
    v_mfma_f32_16x16x32_bf16 v[164:167], a[116:119], v[80:83], v[164:167]
    ds_read_b128 v[68:71], v224 offset:2048
    v_fmac_f32 v53, v57, v57
    v_mfma_f32_16x16x32_bf16 v[168:171], a[120:123], v[80:83], v[168:171]
    ds_read_b128 v[72:75], v224 offset:4096
    v_sub_f32 v58, v38, v48
    v_mfma_f32_16x16x32_bf16 v[172:175], a[124:127], v[80:83], v[172:175]
    ds_read_b128 v[76:79], v224 offset:6144
    v_fmac_f32 v54, v58, v58
    v_mfma_f32_16x16x32_bf16 v[176:179], a[112:115], v[84:87], v[176:179]
    ds_read_b64_tr_b16 a[136:137], v230 offset:8192
    v_sub_f32 v59, v39, v48
    v_mfma_f32_16x16x32_bf16 v[180:183], a[116:119], v[84:87], v[180:183]
    ds_read_b64_tr_b16 a[138:139], v230 offset:8704
    v_fmac_f32 v55, v59, v59
    v_mfma_f32_16x16x32_bf16 v[184:187], a[120:123], v[84:87], v[184:187]
    ds_read_b64_tr_b16 a[140:141], v231 offset:8192
    v_sub_f32 v56, v40, v48
    v_mfma_f32_16x16x32_bf16 v[188:191], a[124:127], v[84:87], v[188:191]
    ds_read_b64_tr_b16 a[142:143], v231 offset:8704
    v_fmac_f32 v52, v56, v56
    v_mfma_f32_16x16x32_bf16 v[192:195], a[112:115], v[88:91], v[192:195]
    s_add_u32 m0, s34, 49152
    s_add_u32 s37, s87, 0
    buffer_load_dwordx4 v232, s[44:47], s37 offen lds
    v_mfma_f32_16x16x32_bf16 v[196:199], a[116:119], v[88:91], v[196:199]
    v_sub_f32 v57, v41, v48
    v_fmac_f32 v53, v57, v57
    v_mfma_f32_16x16x32_bf16 v[200:203], a[120:123], v[88:91], v[200:203]
    v_sub_f32 v58, v42, v48
    v_fmac_f32 v54, v58, v58
    v_mfma_f32_16x16x32_bf16 v[204:207], a[124:127], v[88:91], v[204:207]
    v_sub_f32 v59, v43, v48
    v_fmac_f32 v55, v59, v59
    v_mfma_f32_16x16x32_bf16 v[208:211], a[112:115], v[92:95], v[208:211]
    buffer_load_dwordx4 v233, s[44:47], s37 offen offset:1024 lds
    v_sub_f32 v56, v44, v48
    v_mfma_f32_16x16x32_bf16 v[212:215], a[116:119], v[92:95], v[212:215]
    v_fmac_f32 v52, v56, v56
    v_sub_f32 v57, v45, v48
    v_mfma_f32_16x16x32_bf16 v[216:219], a[120:123], v[92:95], v[216:219]
    v_fmac_f32 v53, v57, v57
    v_sub_f32 v58, v46, v48
    v_mfma_f32_16x16x32_bf16 v[220:223], a[124:127], v[92:95], v[220:223]
    v_fmac_f32 v54, v58, v58
    s_waitcnt lgkmcnt(0)
    v_mfma_f32_16x16x32_bf16 v[96:99], a[128:131], v[64:67], v[96:99]
    ds_read_b128 v[80:83], v224 offset:8192
    v_sub_f32 v59, v47, v48
    v_mfma_f32_16x16x32_bf16 v[100:103], a[132:135], v[64:67], v[100:103]
    ds_read_b128 v[84:87], v224 offset:10240
    v_fmac_f32 v55, v59, v59
    v_mfma_f32_16x16x32_bf16 v[104:107], a[136:139], v[64:67], v[104:107]
    ds_read_b128 v[88:91], v224 offset:12288
    v_add_f32 v52, v52, v53
    v_mfma_f32_16x16x32_bf16 v[108:111], a[140:143], v[64:67], v[108:111]
    ds_read_b128 v[92:95], v224 offset:14336
    v_add_f32 v54, v54, v55
    v_mfma_f32_16x16x32_bf16 v[112:115], a[128:131], v[68:71], v[112:115]
    ds_read_b64_tr_b16 a[144:145], v228 offset:12288
    v_add_f32 v51, v52, v54
    v_mfma_f32_16x16x32_bf16 v[116:119], a[132:135], v[68:71], v[116:119]
    ds_read_b64_tr_b16 a[146:147], v228 offset:12800
    s_nop 1
    v_mfma_f32_16x16x32_bf16 v[120:123], a[136:139], v[68:71], v[120:123]
    ds_read_b64_tr_b16 a[148:149], v229 offset:12288
    v_add_f32_dpp v51, v51, v51 quad_perm:[1,0,3,2] row_mask:0xf bank_mask:0xf
    v_mfma_f32_16x16x32_bf16 v[124:127], a[140:143], v[68:71], v[124:127]
    ds_read_b64_tr_b16 a[150:151], v229 offset:12800
    s_nop 1
    v_mfma_f32_16x16x32_bf16 v[128:131], a[128:131], v[72:75], v[128:131]
    s_add_u32 m0, s35, 4096
    s_add_u32 s33, s33, 131072
    buffer_load_dwordx4 v234, s[48:51], s33 offen lds
    v_mfma_f32_16x16x32_bf16 v[132:135], a[132:135], v[72:75], v[132:135]
    v_add_f32_dpp v51, v51, v51 quad_perm:[2,3,0,1] row_mask:0xf bank_mask:0xf
    s_nop 1
    v_add_f32_dpp v51, v51, v51 row_half_mirror row_mask:0xf bank_mask:0xf
    v_mfma_f32_16x16x32_bf16 v[136:139], a[136:139], v[72:75], v[136:139]
    buffer_load_dwordx4 v235, s[48:51], s33 offen offset:1024 lds
    s_nop 1
    v_mfma_f32_16x16x32_bf16 v[140:143], a[140:143], v[72:75], v[140:143]
    v_add_f32_dpp v51, v51, v51 row_mirror row_mask:0xf bank_mask:0xf
    s_nop 0
    v_mfma_f32_16x16x32_bf16 v[144:147], a[128:131], v[76:79], v[144:147]
    s_add_u32 m0, s35, 6144
    s_add_u32 s33, s33, 131072
    buffer_load_dwordx4 v234, s[48:51], s33 offen lds
    v_mfma_f32_16x16x32_bf16 v[148:151], a[132:135], v[76:79], v[148:151]
    v_mov_b32 v49, v51
    s_nop 1
    v_mfma_f32_16x16x32_bf16 v[152:155], a[136:139], v[76:79], v[152:155]
    buffer_load_dwordx4 v235, s[48:51], s33 offen offset:1024 lds
    v_permlane16_swap_b32 v51, v49
    v_mfma_f32_16x16x32_bf16 v[156:159], a[140:143], v[76:79], v[156:159]
    s_nop 0
    s_waitcnt lgkmcnt(0)
    v_mfma_f32_16x16x32_bf16 v[160:163], a[128:131], v[80:83], v[160:163]
    ds_read_b128 v[64:67], v225 offset:0
    v_add_f32 v51, v51, v49
    v_mfma_f32_16x16x32_bf16 v[164:167], a[132:135], v[80:83], v[164:167]
    ds_read_b128 v[68:71], v225 offset:2048
    v_mul_f32 v51, 0x3a800000, v51
    v_mfma_f32_16x16x32_bf16 v[168:171], a[136:139], v[80:83], v[168:171]
    ds_read_b128 v[72:75], v225 offset:4096
    v_cvt_pk_bf16_f32 v50, v48, v51
    v_mfma_f32_16x16x32_bf16 v[172:175], a[140:143], v[80:83], v[172:175]
    ds_read_b128 v[76:79], v225 offset:6144
    v_and_b32 v51, 0xffff0000, v50
    v_mfma_f32_16x16x32_bf16 v[176:179], a[128:131], v[84:87], v[176:179]
    ds_read_b64_tr_b16 a[152:153], v230 offset:12288
    v_lshlrev_b32 v50, 16, v50
    v_mfma_f32_16x16x32_bf16 v[180:183], a[132:135], v[84:87], v[180:183]
    ds_read_b64_tr_b16 a[154:155], v230 offset:12800
    v_add_f32 v51, 0x3727c5ac, v51
    v_mfma_f32_16x16x32_bf16 v[184:187], a[136:139], v[84:87], v[184:187]
    ds_read_b64_tr_b16 a[156:157], v231 offset:12288
    v_cvt_pk_bf16_f32 v51, v51, v51
    v_mfma_f32_16x16x32_bf16 v[188:191], a[140:143], v[84:87], v[188:191]
    ds_read_b64_tr_b16 a[158:159], v231 offset:12800
    v_lshlrev_b32 v51, 16, v51
    v_mfma_f32_16x16x32_bf16 v[192:195], a[128:131], v[88:91], v[192:195]
    s_add_u32 m0, s34, 57344
    s_add_u32 s37, s87, 65536
    buffer_load_dwordx4 v232, s[44:47], s37 offen lds
    v_mfma_f32_16x16x32_bf16 v[196:199], a[132:135], v[88:91], v[196:199]
    v_sqrt_f32 v51, v51
    v_mfma_f32_16x16x32_bf16 v[200:203], a[136:139], v[88:91], v[200:203]
    s_nop 0
    v_cvt_pk_bf16_f32 v51, v51, v51
    v_mfma_f32_16x16x32_bf16 v[204:207], a[140:143], v[88:91], v[204:207]
    v_lshlrev_b32 v51, 16, v51
    v_mfma_f32_16x16x32_bf16 v[208:211], a[128:131], v[92:95], v[208:211]
    buffer_load_dwordx4 v233, s[44:47], s37 offen offset:1024 lds
    v_rcp_f32 v51, v51
    v_mfma_f32_16x16x32_bf16 v[212:215], a[132:135], v[92:95], v[212:215]
    s_nop 0
    v_sub_f32 v16, v16, v50
    v_mfma_f32_16x16x32_bf16 v[216:219], a[136:139], v[92:95], v[216:219]
    v_sub_f32 v17, v17, v50
    v_cvt_pk_bf16_f32 v17, v16, v17
    v_mfma_f32_16x16x32_bf16 v[220:223], a[140:143], v[92:95], v[220:223]
    v_lshlrev_b32 v16, 16, v17
    s_waitcnt vmcnt(15) lgkmcnt(0)
    v_mfma_f32_16x16x32_bf16 v[96:99], a[144:147], v[64:67], v[96:99]
    ds_read_b128 v[80:83], v225 offset:8192
    v_and_b32 v17, 0xffff0000, v17
    v_mfma_f32_16x16x32_bf16 v[100:103], a[148:151], v[64:67], v[100:103]
    ds_read_b128 v[84:87], v225 offset:10240
    v_mul_f32 v16, v16, v51
    v_mfma_f32_16x16x32_bf16 v[104:107], a[152:155], v[64:67], v[104:107]
    ds_read_b128 v[88:91], v225 offset:12288
    v_mul_f32 v17, v17, v51
    v_mfma_f32_16x16x32_bf16 v[108:111], a[156:159], v[64:67], v[108:111]
    ds_read_b128 v[92:95], v225 offset:14336
    v_cvt_pk_bf16_f32 v0, v16, v17
    v_mfma_f32_16x16x32_bf16 v[112:115], a[144:147], v[68:71], v[112:115]
    ds_read_b64_tr_b16 a[160:161], v228 offset:16384
    v_sub_f32 v18, v18, v50
    v_mfma_f32_16x16x32_bf16 v[116:119], a[148:151], v[68:71], v[116:119]
    ds_read_b64_tr_b16 a[162:163], v228 offset:16896
    v_sub_f32 v19, v19, v50
    v_mfma_f32_16x16x32_bf16 v[120:123], a[152:155], v[68:71], v[120:123]
    ds_read_b64_tr_b16 a[164:165], v229 offset:16384
    v_cvt_pk_bf16_f32 v19, v18, v19
    v_mfma_f32_16x16x32_bf16 v[124:127], a[156:159], v[68:71], v[124:127]
    ds_read_b64_tr_b16 a[166:167], v229 offset:16896
    v_lshlrev_b32 v18, 16, v19
    v_mfma_f32_16x16x32_bf16 v[128:131], a[144:147], v[72:75], v[128:131]
    s_add_u32 m0, s35, 8192
    s_and_b32 s33, s87, 1023
    s_lshl_b32 s33, s33, 12
    buffer_load_dwordx4 v234, s[48:51], s33 offen lds
    v_mfma_f32_16x16x32_bf16 v[132:135], a[148:151], v[72:75], v[132:135]
    v_and_b32 v19, 0xffff0000, v19
    v_mul_f32 v18, v18, v51
    v_mfma_f32_16x16x32_bf16 v[136:139], a[152:155], v[72:75], v[136:139]
    buffer_load_dwordx4 v235, s[48:51], s33 offen offset:1024 lds
    v_mul_f32 v19, v19, v51
    v_mfma_f32_16x16x32_bf16 v[140:143], a[156:159], v[72:75], v[140:143]
    v_cvt_pk_bf16_f32 v1, v18, v19
    v_sub_f32 v20, v20, v50
    v_mfma_f32_16x16x32_bf16 v[144:147], a[144:147], v[76:79], v[144:147]
    s_add_u32 m0, s35, 10240
    s_add_u32 s33, s33, 131072
    buffer_load_dwordx4 v234, s[48:51], s33 offen lds
    v_mfma_f32_16x16x32_bf16 v[148:151], a[148:151], v[76:79], v[148:151]
    v_sub_f32 v21, v21, v50
    v_cvt_pk_bf16_f32 v21, v20, v21
    v_mfma_f32_16x16x32_bf16 v[152:155], a[152:155], v[76:79], v[152:155]
    buffer_load_dwordx4 v235, s[48:51], s33 offen offset:1024 lds
    v_lshlrev_b32 v20, 16, v21
    v_mfma_f32_16x16x32_bf16 v[156:159], a[156:159], v[76:79], v[156:159]
    s_waitcnt vmcnt(30) lgkmcnt(0)
    s_barrier
    v_mfma_f32_16x16x32_bf16 v[160:163], a[144:147], v[80:83], v[160:163]
    ds_read_b128 v[64:67], v224 offset:16384
    v_and_b32 v21, 0xffff0000, v21
    v_mfma_f32_16x16x32_bf16 v[164:167], a[148:151], v[80:83], v[164:167]
    ds_read_b128 v[68:71], v224 offset:18432
    v_mul_f32 v20, v20, v51
    v_mfma_f32_16x16x32_bf16 v[168:171], a[152:155], v[80:83], v[168:171]
    ds_read_b128 v[72:75], v224 offset:20480
    v_mul_f32 v21, v21, v51
    v_mfma_f32_16x16x32_bf16 v[172:175], a[156:159], v[80:83], v[172:175]
    ds_read_b128 v[76:79], v224 offset:22528
    v_cvt_pk_bf16_f32 v2, v20, v21
    v_mfma_f32_16x16x32_bf16 v[176:179], a[144:147], v[84:87], v[176:179]
    ds_read_b64_tr_b16 a[168:169], v230 offset:16384
    v_sub_f32 v22, v22, v50
    v_mfma_f32_16x16x32_bf16 v[180:183], a[148:151], v[84:87], v[180:183]
    ds_read_b64_tr_b16 a[170:171], v230 offset:16896
    v_sub_f32 v23, v23, v50
    v_mfma_f32_16x16x32_bf16 v[184:187], a[152:155], v[84:87], v[184:187]
    ds_read_b64_tr_b16 a[172:173], v231 offset:16384
    v_cvt_pk_bf16_f32 v23, v22, v23
    v_mfma_f32_16x16x32_bf16 v[188:191], a[156:159], v[84:87], v[188:191]
    ds_read_b64_tr_b16 a[174:175], v231 offset:16896
    v_lshlrev_b32 v22, 16, v23
    v_mfma_f32_16x16x32_bf16 v[192:195], a[144:147], v[88:91], v[192:195]
    s_add_u32 m0, s34, 0
    s_add_u32 s37, s80, 131072
    buffer_load_dwordx4 v232, s[44:47], s37 offen lds
    v_mfma_f32_16x16x32_bf16 v[196:199], a[148:151], v[88:91], v[196:199]
    v_and_b32 v23, 0xffff0000, v23
    v_mul_f32 v22, v22, v51
    v_mfma_f32_16x16x32_bf16 v[200:203], a[152:155], v[88:91], v[200:203]
    v_mul_f32 v23, v23, v51
    v_cvt_pk_bf16_f32 v3, v22, v23
    v_mfma_f32_16x16x32_bf16 v[204:207], a[156:159], v[88:91], v[204:207]
    v_sub_f32 v24, v24, v50
    v_sub_f32 v25, v25, v50
    v_mfma_f32_16x16x32_bf16 v[208:211], a[144:147], v[92:95], v[208:211]
    buffer_load_dwordx4 v233, s[44:47], s37 offen offset:1024 lds
    v_cvt_pk_bf16_f32 v25, v24, v25
    v_mfma_f32_16x16x32_bf16 v[212:215], a[148:151], v[92:95], v[212:215]
    v_lshlrev_b32 v24, 16, v25
    v_and_b32 v25, 0xffff0000, v25
    v_mfma_f32_16x16x32_bf16 v[216:219], a[152:155], v[92:95], v[216:219]
    v_mul_f32 v24, v24, v51
    v_mul_f32 v25, v25, v51
    v_mfma_f32_16x16x32_bf16 v[220:223], a[156:159], v[92:95], v[220:223]
    v_cvt_pk_bf16_f32 v4, v24, v25
    s_waitcnt lgkmcnt(0)
    v_mfma_f32_16x16x32_bf16 v[96:99], a[160:163], v[64:67], v[96:99]
    ds_read_b128 v[80:83], v224 offset:24576
    v_sub_f32 v26, v26, v50
    v_mfma_f32_16x16x32_bf16 v[100:103], a[164:167], v[64:67], v[100:103]
    ds_read_b128 v[84:87], v224 offset:26624
    v_sub_f32 v27, v27, v50
    v_mfma_f32_16x16x32_bf16 v[104:107], a[168:171], v[64:67], v[104:107]
    ds_read_b128 v[88:91], v224 offset:28672
    v_cvt_pk_bf16_f32 v27, v26, v27
    v_mfma_f32_16x16x32_bf16 v[108:111], a[172:175], v[64:67], v[108:111]
    ds_read_b128 v[92:95], v224 offset:30720
    v_lshlrev_b32 v26, 16, v27
    v_mfma_f32_16x16x32_bf16 v[112:115], a[160:163], v[68:71], v[112:115]
    ds_read_b64_tr_b16 a[176:177], v228 offset:20480
    v_and_b32 v27, 0xffff0000, v27
    v_mfma_f32_16x16x32_bf16 v[116:119], a[164:167], v[68:71], v[116:119]
    ds_read_b64_tr_b16 a[178:179], v228 offset:20992
    v_mul_f32 v26, v26, v51
    v_mfma_f32_16x16x32_bf16 v[120:123], a[168:171], v[68:71], v[120:123]
    ds_read_b64_tr_b16 a[180:181], v229 offset:20480
    v_mul_f32 v27, v27, v51
    v_mfma_f32_16x16x32_bf16 v[124:127], a[172:175], v[68:71], v[124:127]
    ds_read_b64_tr_b16 a[182:183], v229 offset:20992
    v_cvt_pk_bf16_f32 v5, v26, v27
    v_mfma_f32_16x16x32_bf16 v[128:131], a[160:163], v[72:75], v[128:131]
    s_add_u32 m0, s35, 12288
    s_add_u32 s33, s33, 131072
    buffer_load_dwordx4 v234, s[48:51], s33 offen lds
    v_mfma_f32_16x16x32_bf16 v[132:135], a[164:167], v[72:75], v[132:135]
    v_sub_f32 v28, v28, v50
    v_sub_f32 v29, v29, v50
    v_mfma_f32_16x16x32_bf16 v[136:139], a[168:171], v[72:75], v[136:139]
    buffer_load_dwordx4 v235, s[48:51], s33 offen offset:1024 lds
    v_cvt_pk_bf16_f32 v29, v28, v29
    v_mfma_f32_16x16x32_bf16 v[140:143], a[172:175], v[72:75], v[140:143]
    v_lshlrev_b32 v28, 16, v29
    v_and_b32 v29, 0xffff0000, v29
    v_mfma_f32_16x16x32_bf16 v[144:147], a[160:163], v[76:79], v[144:147]
    s_add_u32 m0, s35, 14336
    s_add_u32 s33, s33, 131072
    buffer_load_dwordx4 v234, s[48:51], s33 offen lds
    v_mfma_f32_16x16x32_bf16 v[148:151], a[164:167], v[76:79], v[148:151]
    v_mul_f32 v28, v28, v51
    v_mul_f32 v29, v29, v51
    v_mfma_f32_16x16x32_bf16 v[152:155], a[168:171], v[76:79], v[152:155]
    buffer_load_dwordx4 v235, s[48:51], s33 offen offset:1024 lds
    v_cvt_pk_bf16_f32 v6, v28, v29
    v_mfma_f32_16x16x32_bf16 v[156:159], a[172:175], v[76:79], v[156:159]
    v_sub_f32 v30, v30, v50
    s_waitcnt lgkmcnt(0)
    v_mfma_f32_16x16x32_bf16 v[160:163], a[160:163], v[80:83], v[160:163]
    ds_read_b128 v[64:67], v225 offset:16384
    v_sub_f32 v31, v31, v50
    v_mfma_f32_16x16x32_bf16 v[164:167], a[164:167], v[80:83], v[164:167]
    ds_read_b128 v[68:71], v225 offset:18432
    v_cvt_pk_bf16_f32 v31, v30, v31
    v_mfma_f32_16x16x32_bf16 v[168:171], a[168:171], v[80:83], v[168:171]
    ds_read_b128 v[72:75], v225 offset:20480
    v_lshlrev_b32 v30, 16, v31
    v_mfma_f32_16x16x32_bf16 v[172:175], a[172:175], v[80:83], v[172:175]
    ds_read_b128 v[76:79], v225 offset:22528
    v_and_b32 v31, 0xffff0000, v31
    v_mfma_f32_16x16x32_bf16 v[176:179], a[160:163], v[84:87], v[176:179]
    ds_read_b64_tr_b16 a[184:185], v230 offset:20480
    v_mul_f32 v30, v30, v51
    v_mfma_f32_16x16x32_bf16 v[180:183], a[164:167], v[84:87], v[180:183]
    ds_read_b64_tr_b16 a[186:187], v230 offset:20992
    v_mul_f32 v31, v31, v51
    v_mfma_f32_16x16x32_bf16 v[184:187], a[168:171], v[84:87], v[184:187]
    ds_read_b64_tr_b16 a[188:189], v231 offset:20480
    v_cvt_pk_bf16_f32 v7, v30, v31
    v_mfma_f32_16x16x32_bf16 v[188:191], a[172:175], v[84:87], v[188:191]
    ds_read_b64_tr_b16 a[190:191], v231 offset:20992
    v_sub_f32 v32, v32, v50
    v_mfma_f32_16x16x32_bf16 v[192:195], a[160:163], v[88:91], v[192:195]
    s_add_u32 m0, s34, 8192
    s_add_u32 s37, s81, 131072
    buffer_load_dwordx4 v232, s[44:47], s37 offen lds
    v_mfma_f32_16x16x32_bf16 v[196:199], a[164:167], v[88:91], v[196:199]
    v_sub_f32 v33, v33, v50
    v_cvt_pk_bf16_f32 v33, v32, v33
    v_mfma_f32_16x16x32_bf16 v[200:203], a[168:171], v[88:91], v[200:203]
    v_lshlrev_b32 v32, 16, v33
    v_and_b32 v33, 0xffff0000, v33
    v_mfma_f32_16x16x32_bf16 v[204:207], a[172:175], v[88:91], v[204:207]
    v_mul_f32 v32, v32, v51
    v_mul_f32 v33, v33, v51
    v_mfma_f32_16x16x32_bf16 v[208:211], a[160:163], v[92:95], v[208:211]
    buffer_load_dwordx4 v233, s[44:47], s37 offen offset:1024 lds
    v_cvt_pk_bf16_f32 v8, v32, v33
    v_mfma_f32_16x16x32_bf16 v[212:215], a[164:167], v[92:95], v[212:215]
    v_sub_f32 v34, v34, v50
    v_sub_f32 v35, v35, v50
    v_mfma_f32_16x16x32_bf16 v[216:219], a[168:171], v[92:95], v[216:219]
    v_cvt_pk_bf16_f32 v35, v34, v35
    v_lshlrev_b32 v34, 16, v35
    v_mfma_f32_16x16x32_bf16 v[220:223], a[172:175], v[92:95], v[220:223]
    v_and_b32 v35, 0xffff0000, v35
    v_mul_f32 v34, v34, v51
    s_waitcnt vmcnt(14) lgkmcnt(0)
    v_mfma_f32_16x16x32_bf16 v[96:99], a[176:179], v[64:67], v[96:99]
    ds_read_b128 v[80:83], v225 offset:24576
    v_mul_f32 v35, v35, v51
    v_mfma_f32_16x16x32_bf16 v[100:103], a[180:183], v[64:67], v[100:103]
    ds_read_b128 v[84:87], v225 offset:26624
    v_cvt_pk_bf16_f32 v9, v34, v35
    v_mfma_f32_16x16x32_bf16 v[104:107], a[184:187], v[64:67], v[104:107]
    ds_read_b128 v[88:91], v225 offset:28672
    v_sub_f32 v36, v36, v50
    v_mfma_f32_16x16x32_bf16 v[108:111], a[188:191], v[64:67], v[108:111]
    ds_read_b128 v[92:95], v225 offset:30720
    v_sub_f32 v37, v37, v50
    v_mfma_f32_16x16x32_bf16 v[112:115], a[176:179], v[68:71], v[112:115]
    ds_read_b64_tr_b16 a[192:193], v228 offset:0
    v_cvt_pk_bf16_f32 v37, v36, v37
    v_mfma_f32_16x16x32_bf16 v[116:119], a[180:183], v[68:71], v[116:119]
    ds_read_b64_tr_b16 a[194:195], v228 offset:512
    v_lshlrev_b32 v36, 16, v37
    v_mfma_f32_16x16x32_bf16 v[120:123], a[184:187], v[68:71], v[120:123]
    ds_read_b64_tr_b16 a[196:197], v229 offset:0
    v_and_b32 v37, 0xffff0000, v37
    v_mfma_f32_16x16x32_bf16 v[124:127], a[188:191], v[68:71], v[124:127]
    ds_read_b64_tr_b16 a[198:199], v229 offset:512
    v_mul_f32 v36, v36, v51
    v_mfma_f32_16x16x32_bf16 v[128:131], a[176:179], v[72:75], v[128:131]
    v_mul_f32 v37, v37, v51
    v_cvt_pk_bf16_f32 v10, v36, v37
    v_mfma_f32_16x16x32_bf16 v[132:135], a[180:183], v[72:75], v[132:135]
    v_sub_f32 v38, v38, v50
    v_sub_f32 v39, v39, v50
    v_mfma_f32_16x16x32_bf16 v[136:139], a[184:187], v[72:75], v[136:139]
    v_cvt_pk_bf16_f32 v39, v38, v39
    v_lshlrev_b32 v38, 16, v39
    v_mfma_f32_16x16x32_bf16 v[140:143], a[188:191], v[72:75], v[140:143]
    v_and_b32 v39, 0xffff0000, v39
    v_mul_f32 v38, v38, v51
    v_mfma_f32_16x16x32_bf16 v[144:147], a[176:179], v[76:79], v[144:147]
    v_mul_f32 v39, v39, v51
    v_cvt_pk_bf16_f32 v11, v38, v39
    v_mfma_f32_16x16x32_bf16 v[148:151], a[180:183], v[76:79], v[148:151]
    v_sub_f32 v40, v40, v50
    v_sub_f32 v41, v41, v50
    v_mfma_f32_16x16x32_bf16 v[152:155], a[184:187], v[76:79], v[152:155]
    v_cvt_pk_bf16_f32 v41, v40, v41
    v_lshlrev_b32 v40, 16, v41
    v_mfma_f32_16x16x32_bf16 v[156:159], a[188:191], v[76:79], v[156:159]
    s_waitcnt vmcnt(24) lgkmcnt(0)
    s_barrier
    v_mfma_f32_16x16x32_bf16 v[160:163], a[176:179], v[80:83], v[160:163]
    ds_read_b128 v[64:67], v224 offset:32768
    v_and_b32 v41, 0xffff0000, v41
    v_mfma_f32_16x16x32_bf16 v[164:167], a[180:183], v[80:83], v[164:167]
    ds_read_b128 v[68:71], v224 offset:34816
    v_mul_f32 v40, v40, v51
    v_mfma_f32_16x16x32_bf16 v[168:171], a[184:187], v[80:83], v[168:171]
    ds_read_b128 v[72:75], v224 offset:36864
    v_mul_f32 v41, v41, v51
    v_mfma_f32_16x16x32_bf16 v[172:175], a[188:191], v[80:83], v[172:175]
    ds_read_b128 v[76:79], v224 offset:38912
    v_cvt_pk_bf16_f32 v12, v40, v41
    v_mfma_f32_16x16x32_bf16 v[176:179], a[176:179], v[84:87], v[176:179]
    ds_read_b64_tr_b16 a[200:201], v230 offset:0
    v_sub_f32 v42, v42, v50
    v_mfma_f32_16x16x32_bf16 v[180:183], a[180:183], v[84:87], v[180:183]
    ds_read_b64_tr_b16 a[202:203], v230 offset:512
    v_sub_f32 v43, v43, v50
    v_mfma_f32_16x16x32_bf16 v[184:187], a[184:187], v[84:87], v[184:187]
    ds_read_b64_tr_b16 a[204:205], v231 offset:0
    v_cvt_pk_bf16_f32 v43, v42, v43
    v_mfma_f32_16x16x32_bf16 v[188:191], a[188:191], v[84:87], v[188:191]
    ds_read_b64_tr_b16 a[206:207], v231 offset:512
    v_lshlrev_b32 v42, 16, v43
    v_mfma_f32_16x16x32_bf16 v[192:195], a[176:179], v[88:91], v[192:195]
    s_add_u32 m0, s34, 16384
    s_add_u32 s37, s82, 131072
    buffer_load_dwordx4 v232, s[44:47], s37 offen lds
    v_mfma_f32_16x16x32_bf16 v[196:199], a[180:183], v[88:91], v[196:199]
    v_and_b32 v43, 0xffff0000, v43
    v_mul_f32 v42, v42, v51
    v_mfma_f32_16x16x32_bf16 v[200:203], a[184:187], v[88:91], v[200:203]
    v_mul_f32 v43, v43, v51
    v_cvt_pk_bf16_f32 v13, v42, v43
    v_mfma_f32_16x16x32_bf16 v[204:207], a[188:191], v[88:91], v[204:207]
    v_sub_f32 v44, v44, v50
    v_sub_f32 v45, v45, v50
    v_mfma_f32_16x16x32_bf16 v[208:211], a[176:179], v[92:95], v[208:211]
    buffer_load_dwordx4 v233, s[44:47], s37 offen offset:1024 lds
    v_cvt_pk_bf16_f32 v45, v44, v45
    v_mfma_f32_16x16x32_bf16 v[212:215], a[180:183], v[92:95], v[212:215]
    v_lshlrev_b32 v44, 16, v45
    v_and_b32 v45, 0xffff0000, v45
    v_mfma_f32_16x16x32_bf16 v[216:219], a[184:187], v[92:95], v[216:219]
    v_mul_f32 v44, v44, v51
    v_mul_f32 v45, v45, v51
    v_mfma_f32_16x16x32_bf16 v[220:223], a[188:191], v[92:95], v[220:223]
    v_cvt_pk_bf16_f32 v14, v44, v45
    s_waitcnt lgkmcnt(0)
    v_mfma_f32_16x16x32_bf16 v[96:99], a[192:195], v[64:67], v[96:99]
    ds_read_b128 v[80:83], v224 offset:40960
    v_sub_f32 v46, v46, v50
    v_mfma_f32_16x16x32_bf16 v[100:103], a[196:199], v[64:67], v[100:103]
    ds_read_b128 v[84:87], v224 offset:43008
    v_sub_f32 v47, v47, v50
    v_mfma_f32_16x16x32_bf16 v[104:107], a[200:203], v[64:67], v[104:107]
    ds_read_b128 v[88:91], v224 offset:45056
    v_cvt_pk_bf16_f32 v47, v46, v47
    v_mfma_f32_16x16x32_bf16 v[108:111], a[204:207], v[64:67], v[108:111]
    ds_read_b128 v[92:95], v224 offset:47104
    v_lshlrev_b32 v46, 16, v47
    v_mfma_f32_16x16x32_bf16 v[112:115], a[192:195], v[68:71], v[112:115]
    ds_read_b64_tr_b16 a[208:209], v228 offset:4096
    v_and_b32 v47, 0xffff0000, v47
    v_mfma_f32_16x16x32_bf16 v[116:119], a[196:199], v[68:71], v[116:119]
    ds_read_b64_tr_b16 a[210:211], v228 offset:4608
    v_mul_f32 v46, v46, v51
    v_mfma_f32_16x16x32_bf16 v[120:123], a[200:203], v[68:71], v[120:123]
    ds_read_b64_tr_b16 a[212:213], v229 offset:4096
    v_mul_f32 v47, v47, v51
    v_mfma_f32_16x16x32_bf16 v[124:127], a[204:207], v[68:71], v[124:127]
    ds_read_b64_tr_b16 a[214:215], v229 offset:4608
    v_cvt_pk_bf16_f32 v15, v46, v47
    v_mfma_f32_16x16x32_bf16 v[128:131], a[192:195], v[72:75], v[128:131]
    v_mfma_f32_16x16x32_bf16 v[132:135], a[196:199], v[72:75], v[132:135]
    ds_write_b128 v237, v[0:3] offset:0
    v_mfma_f32_16x16x32_bf16 v[136:139], a[200:203], v[72:75], v[136:139]
    ds_write_b128 v237, v[4:7] offset:4096
    v_mfma_f32_16x16x32_bf16 v[140:143], a[204:207], v[72:75], v[140:143]
    ds_write_b128 v237, v[8:11] offset:24576
    v_mfma_f32_16x16x32_bf16 v[144:147], a[192:195], v[76:79], v[144:147]
    ds_write_b128 v237, v[12:15] offset:28672
    v_mfma_f32_16x16x32_bf16 v[148:151], a[196:199], v[76:79], v[148:151]
    v_mfma_f32_16x16x32_bf16 v[152:155], a[200:203], v[76:79], v[152:155]
    v_mfma_f32_16x16x32_bf16 v[156:159], a[204:207], v[76:79], v[156:159]
    s_waitcnt lgkmcnt(0)
    v_mfma_f32_16x16x32_bf16 v[160:163], a[192:195], v[80:83], v[160:163]
    ds_read_b128 v[64:67], v225 offset:32768
    v_mfma_f32_16x16x32_bf16 v[164:167], a[196:199], v[80:83], v[164:167]
    ds_read_b128 v[68:71], v225 offset:34816
    v_mfma_f32_16x16x32_bf16 v[168:171], a[200:203], v[80:83], v[168:171]
    ds_read_b128 v[72:75], v225 offset:36864
    v_mfma_f32_16x16x32_bf16 v[172:175], a[204:207], v[80:83], v[172:175]
    ds_read_b128 v[76:79], v225 offset:38912
    v_mfma_f32_16x16x32_bf16 v[176:179], a[192:195], v[84:87], v[176:179]
    ds_read_b64_tr_b16 a[216:217], v230 offset:4096
    v_mfma_f32_16x16x32_bf16 v[180:183], a[196:199], v[84:87], v[180:183]
    ds_read_b64_tr_b16 a[218:219], v230 offset:4608
    v_mfma_f32_16x16x32_bf16 v[184:187], a[200:203], v[84:87], v[184:187]
    ds_read_b64_tr_b16 a[220:221], v231 offset:4096
    v_mfma_f32_16x16x32_bf16 v[188:191], a[204:207], v[84:87], v[188:191]
    ds_read_b64_tr_b16 a[222:223], v231 offset:4608
    v_mfma_f32_16x16x32_bf16 v[192:195], a[192:195], v[88:91], v[192:195]
    s_add_u32 m0, s34, 24576
    s_add_u32 s37, s83, 131072
    buffer_load_dwordx4 v232, s[44:47], s37 offen lds
    v_mfma_f32_16x16x32_bf16 v[196:199], a[196:199], v[88:91], v[196:199]
    v_mfma_f32_16x16x32_bf16 v[200:203], a[200:203], v[88:91], v[200:203]
    buffer_load_dwordx4 v233, s[44:47], s37 offen offset:1024 lds
    v_mfma_f32_16x16x32_bf16 v[204:207], a[204:207], v[88:91], v[204:207]
    v_mfma_f32_16x16x32_bf16 v[208:211], a[192:195], v[92:95], v[208:211]
    v_mfma_f32_16x16x32_bf16 v[212:215], a[196:199], v[92:95], v[212:215]
    buffer_load_dword v254, off, s[88:91], s97 sc1
    v_mfma_f32_16x16x32_bf16 v[216:219], a[200:203], v[92:95], v[216:219]
    v_mfma_f32_16x16x32_bf16 v[220:223], a[204:207], v[92:95], v[220:223]
    s_waitcnt vmcnt(7) lgkmcnt(0)
    v_mfma_f32_16x16x32_bf16 v[96:99], a[208:211], v[64:67], v[96:99]
    ds_read_b128 v[80:83], v225 offset:40960
    v_mfma_f32_16x16x32_bf16 v[100:103], a[212:215], v[64:67], v[100:103]
    ds_read_b128 v[84:87], v225 offset:43008
    s_mul_i32 s38, s2, 100
    v_mfma_f32_16x16x32_bf16 v[104:107], a[216:219], v[64:67], v[104:107]
    ds_read_b128 v[88:91], v225 offset:45056
    v_mfma_f32_16x16x32_bf16 v[108:111], a[220:223], v[64:67], v[108:111]
    ds_read_b128 v[92:95], v225 offset:47104
    v_mfma_f32_16x16x32_bf16 v[112:115], a[208:211], v[68:71], v[112:115]
    ds_read_b64_tr_b16 a[224:225], v228 offset:8192
    v_lshl_add_u32 v60, v253, 2, s38
    v_mfma_f32_16x16x32_bf16 v[116:119], a[212:215], v[68:71], v[116:119]
    ds_read_b64_tr_b16 a[226:227], v228 offset:8704
    v_mfma_f32_16x16x32_bf16 v[120:123], a[216:219], v[68:71], v[120:123]
    ds_read_b64_tr_b16 a[228:229], v229 offset:8192
    v_mfma_f32_16x16x32_bf16 v[124:127], a[220:223], v[68:71], v[124:127]
    ds_read_b64_tr_b16 a[230:231], v229 offset:8704
    v_cmp_gt_u32 vcc, 25, v253
    v_mfma_f32_16x16x32_bf16 v[128:131], a[208:211], v[72:75], v[128:131]
    v_mov_b32 v61, 0
    v_mfma_f32_16x16x32_bf16 v[132:135], a[212:215], v[72:75], v[132:135]
    v_mfma_f32_16x16x32_bf16 v[136:139], a[216:219], v[72:75], v[136:139]
    v_mov_b32 v62, 0x7ffffff0
    v_mfma_f32_16x16x32_bf16 v[140:143], a[220:223], v[72:75], v[140:143]
    v_cndmask_b32 v60, v62, v60, vcc
    v_mfma_f32_16x16x32_bf16 v[144:147], a[208:211], v[76:79], v[144:147]
    v_mfma_f32_16x16x32_bf16 v[148:151], a[212:215], v[76:79], v[148:151]
    buffer_store_dword v61, v60, s[56:59], 0 offen sc1
    v_mfma_f32_16x16x32_bf16 v[152:155], a[216:219], v[76:79], v[152:155]
    v_mfma_f32_16x16x32_bf16 v[156:159], a[220:223], v[76:79], v[156:159]
    s_waitcnt vmcnt(18) lgkmcnt(0)
    s_barrier
    v_mfma_f32_16x16x32_bf16 v[160:163], a[208:211], v[80:83], v[160:163]
    ds_read_b128 v[64:67], v224 offset:49152
    v_mfma_f32_16x16x32_bf16 v[164:167], a[212:215], v[80:83], v[164:167]
    ds_read_b128 v[68:71], v224 offset:51200
    v_mfma_f32_16x16x32_bf16 v[168:171], a[216:219], v[80:83], v[168:171]
    ds_read_b128 v[72:75], v224 offset:53248
    v_mfma_f32_16x16x32_bf16 v[172:175], a[220:223], v[80:83], v[172:175]
    ds_read_b128 v[76:79], v224 offset:55296
    v_mfma_f32_16x16x32_bf16 v[176:179], a[208:211], v[84:87], v[176:179]
    ds_read_b64_tr_b16 a[232:233], v230 offset:8192
    v_mfma_f32_16x16x32_bf16 v[180:183], a[212:215], v[84:87], v[180:183]
    ds_read_b64_tr_b16 a[234:235], v230 offset:8704
    v_mfma_f32_16x16x32_bf16 v[184:187], a[216:219], v[84:87], v[184:187]
    ds_read_b64_tr_b16 a[236:237], v231 offset:8192
    v_mfma_f32_16x16x32_bf16 v[188:191], a[220:223], v[84:87], v[188:191]
    ds_read_b64_tr_b16 a[238:239], v231 offset:8704
    v_mfma_f32_16x16x32_bf16 v[192:195], a[208:211], v[88:91], v[192:195]
    v_lshlrev_b32 v237, 4, v253
    v_add_u32 v237, 81920, v237
    ds_read_b128 v[16:19], v237 offset:0
    ds_read_b128 v[20:23], v237 offset:4096
    ds_read_b128 v[24:27], v237 offset:24576
    ds_read_b128 v[28:31], v237 offset:28672
    s_add_u32 m0, s34, 32768
    s_add_u32 s37, s84, 131072
    buffer_load_dwordx4 v232, s[44:47], s37 offen lds
    v_mfma_f32_16x16x32_bf16 v[196:199], a[212:215], v[88:91], v[196:199]
    v_mfma_f32_16x16x32_bf16 v[200:203], a[216:219], v[88:91], v[200:203]
    v_mfma_f32_16x16x32_bf16 v[204:207], a[220:223], v[88:91], v[204:207]
    v_mfma_f32_16x16x32_bf16 v[208:211], a[208:211], v[92:95], v[208:211]
    buffer_load_dwordx4 v233, s[44:47], s37 offen offset:1024 lds
    v_mfma_f32_16x16x32_bf16 v[212:215], a[212:215], v[92:95], v[212:215]
    v_mfma_f32_16x16x32_bf16 v[216:219], a[216:219], v[92:95], v[216:219]
    v_mfma_f32_16x16x32_bf16 v[220:223], a[220:223], v[92:95], v[220:223]
    s_waitcnt lgkmcnt(0)
    v_mfma_f32_16x16x32_bf16 v[96:99], a[224:227], v[64:67], v[96:99]
    ds_read_b128 v[80:83], v224 offset:57344
    v_mfma_f32_16x16x32_bf16 v[100:103], a[228:231], v[64:67], v[100:103]
    ds_read_b128 v[84:87], v224 offset:59392
    v_mfma_f32_16x16x32_bf16 v[104:107], a[232:235], v[64:67], v[104:107]
    ds_read_b128 v[88:91], v224 offset:61440
    v_mfma_f32_16x16x32_bf16 v[108:111], a[236:239], v[64:67], v[108:111]
    ds_read_b128 v[92:95], v224 offset:63488
    v_mfma_f32_16x16x32_bf16 v[112:115], a[224:227], v[68:71], v[112:115]
    ds_read_b64_tr_b16 a[240:241], v228 offset:12288
    v_mfma_f32_16x16x32_bf16 v[116:119], a[228:231], v[68:71], v[116:119]
    ds_read_b64_tr_b16 a[242:243], v228 offset:12800
    s_mov_b32 s39, 0
    buffer_store_dwordx4 v[16:19], v238, s[8:11], s39 offen sc1
    v_mfma_f32_16x16x32_bf16 v[120:123], a[232:235], v[68:71], v[120:123]
    ds_read_b64_tr_b16 a[244:245], v229 offset:12288
    v_mfma_f32_16x16x32_bf16 v[124:127], a[236:239], v[68:71], v[124:127]
    ds_read_b64_tr_b16 a[246:247], v229 offset:12800
    v_mfma_f32_16x16x32_bf16 v[128:131], a[224:227], v[72:75], v[128:131]
    v_mfma_f32_16x16x32_bf16 v[132:135], a[228:231], v[72:75], v[132:135]
    v_mfma_f32_16x16x32_bf16 v[136:139], a[232:235], v[72:75], v[136:139]
    v_mfma_f32_16x16x32_bf16 v[140:143], a[236:239], v[72:75], v[140:143]
    v_mfma_f32_16x16x32_bf16 v[144:147], a[224:227], v[76:79], v[144:147]
    v_mfma_f32_16x16x32_bf16 v[148:151], a[228:231], v[76:79], v[148:151]
    s_mov_b32 s39, 8192
    buffer_store_dwordx4 v[20:23], v238, s[8:11], s39 offen sc1
    v_mfma_f32_16x16x32_bf16 v[152:155], a[232:235], v[76:79], v[152:155]
    v_mfma_f32_16x16x32_bf16 v[156:159], a[236:239], v[76:79], v[156:159]
    s_waitcnt lgkmcnt(0)
    v_mfma_f32_16x16x32_bf16 v[160:163], a[224:227], v[80:83], v[160:163]
    ds_read_b128 v[64:67], v225 offset:49152
    v_mfma_f32_16x16x32_bf16 v[164:167], a[228:231], v[80:83], v[164:167]
    ds_read_b128 v[68:71], v225 offset:51200
    v_mfma_f32_16x16x32_bf16 v[168:171], a[232:235], v[80:83], v[168:171]
    ds_read_b128 v[72:75], v225 offset:53248
    v_mfma_f32_16x16x32_bf16 v[172:175], a[236:239], v[80:83], v[172:175]
    ds_read_b128 v[76:79], v225 offset:55296
    v_mfma_f32_16x16x32_bf16 v[176:179], a[224:227], v[84:87], v[176:179]
    ds_read_b64_tr_b16 a[248:249], v230 offset:12288
    v_mfma_f32_16x16x32_bf16 v[180:183], a[228:231], v[84:87], v[180:183]
    ds_read_b64_tr_b16 a[250:251], v230 offset:12800
    s_mov_b32 s39, 16384
    buffer_store_dwordx4 v[24:27], v238, s[8:11], s39 offen sc1
    v_mfma_f32_16x16x32_bf16 v[184:187], a[232:235], v[84:87], v[184:187]
    ds_read_b64_tr_b16 a[252:253], v231 offset:12288
    v_mfma_f32_16x16x32_bf16 v[188:191], a[236:239], v[84:87], v[188:191]
    ds_read_b64_tr_b16 a[254:255], v231 offset:12800
    v_mfma_f32_16x16x32_bf16 v[192:195], a[224:227], v[88:91], v[192:195]
    s_add_u32 m0, s34, 40960
    s_add_u32 s37, s85, 131072
    buffer_load_dwordx4 v232, s[44:47], s37 offen lds
    v_mfma_f32_16x16x32_bf16 v[196:199], a[228:231], v[88:91], v[196:199]
    v_mfma_f32_16x16x32_bf16 v[200:203], a[232:235], v[88:91], v[200:203]
    v_mfma_f32_16x16x32_bf16 v[204:207], a[236:239], v[88:91], v[204:207]
    v_mfma_f32_16x16x32_bf16 v[208:211], a[224:227], v[92:95], v[208:211]
    buffer_load_dwordx4 v233, s[44:47], s37 offen offset:1024 lds
    v_mfma_f32_16x16x32_bf16 v[212:215], a[228:231], v[92:95], v[212:215]
    s_mov_b32 s39, 24576
    buffer_store_dwordx4 v[28:31], v238, s[8:11], s39 offen sc1
    v_mfma_f32_16x16x32_bf16 v[216:219], a[232:235], v[92:95], v[216:219]
    v_mfma_f32_16x16x32_bf16 v[220:223], a[236:239], v[92:95], v[220:223]
    s_waitcnt lgkmcnt(0)
    v_mfma_f32_16x16x32_bf16 v[96:99], a[240:243], v[64:67], v[96:99]
    ds_read_b128 v[80:83], v225 offset:57344
    v_mfma_f32_16x16x32_bf16 v[100:103], a[244:247], v[64:67], v[100:103]
    ds_read_b128 v[84:87], v225 offset:59392
    v_mfma_f32_16x16x32_bf16 v[104:107], a[248:251], v[64:67], v[104:107]
    ds_read_b128 v[88:91], v225 offset:61440
    v_mfma_f32_16x16x32_bf16 v[108:111], a[252:255], v[64:67], v[108:111]
    ds_read_b128 v[92:95], v225 offset:63488
    v_mfma_f32_16x16x32_bf16 v[112:115], a[240:243], v[68:71], v[112:115]
    v_mfma_f32_16x16x32_bf16 v[116:119], a[244:247], v[68:71], v[116:119]
    v_mfma_f32_16x16x32_bf16 v[120:123], a[248:251], v[68:71], v[120:123]
    v_mfma_f32_16x16x32_bf16 v[124:127], a[252:255], v[68:71], v[124:127]
    v_mfma_f32_16x16x32_bf16 v[128:131], a[240:243], v[72:75], v[128:131]
    v_mfma_f32_16x16x32_bf16 v[132:135], a[244:247], v[72:75], v[132:135]
    v_cvt_pk_bf16_f32 v0, v96, v97
    v_cvt_pk_bf16_f32 v1, v98, v99
    v_mfma_f32_16x16x32_bf16 v[136:139], a[248:251], v[72:75], v[136:139]
    v_cvt_pk_bf16_f32 v2, v100, v101
    v_cvt_pk_bf16_f32 v3, v102, v103
    v_mfma_f32_16x16x32_bf16 v[140:143], a[252:255], v[72:75], v[140:143]
    v_cvt_pk_bf16_f32 v4, v104, v105
    v_cvt_pk_bf16_f32 v5, v106, v107
    v_mfma_f32_16x16x32_bf16 v[144:147], a[240:243], v[76:79], v[144:147]
    v_cvt_pk_bf16_f32 v6, v108, v109
    v_cvt_pk_bf16_f32 v7, v110, v111
    v_mfma_f32_16x16x32_bf16 v[148:151], a[244:247], v[76:79], v[148:151]
    v_cvt_pk_bf16_f32 v8, v112, v113
    v_cvt_pk_bf16_f32 v9, v114, v115
    v_mfma_f32_16x16x32_bf16 v[152:155], a[248:251], v[76:79], v[152:155]
    v_cvt_pk_bf16_f32 v10, v116, v117
    v_cvt_pk_bf16_f32 v11, v118, v119
    v_mfma_f32_16x16x32_bf16 v[156:159], a[252:255], v[76:79], v[156:159]
    v_cvt_pk_bf16_f32 v12, v120, v121
    v_cvt_pk_bf16_f32 v13, v122, v123
    s_waitcnt vmcnt(14) lgkmcnt(0)
    s_barrier
    v_mfma_f32_16x16x32_bf16 v[160:163], a[240:243], v[80:83], v[160:163]
    ds_read_b128 v[64:67], v224 offset:0
    v_cvt_pk_bf16_f32 v14, v124, v125
    v_cvt_pk_bf16_f32 v15, v126, v127
    v_mfma_f32_16x16x32_bf16 v[164:167], a[244:247], v[80:83], v[164:167]
    ds_read_b128 v[68:71], v224 offset:2048
    v_cvt_pk_bf16_f32 v16, v128, v129
    v_cvt_pk_bf16_f32 v17, v130, v131
    v_mfma_f32_16x16x32_bf16 v[168:171], a[248:251], v[80:83], v[168:171]
    ds_read_b128 v[72:75], v224 offset:4096
    v_cvt_pk_bf16_f32 v18, v132, v133
    v_cvt_pk_bf16_f32 v19, v134, v135
    v_mfma_f32_16x16x32_bf16 v[172:175], a[252:255], v[80:83], v[172:175]
    ds_read_b128 v[76:79], v224 offset:6144
    v_cvt_pk_bf16_f32 v20, v136, v137
    v_cvt_pk_bf16_f32 v21, v138, v139
    v_mfma_f32_16x16x32_bf16 v[176:179], a[240:243], v[84:87], v[176:179]
    v_cvt_pk_bf16_f32 v22, v140, v141
    v_cvt_pk_bf16_f32 v23, v142, v143
    v_mfma_f32_16x16x32_bf16 v[180:183], a[244:247], v[84:87], v[180:183]
    v_cvt_pk_bf16_f32 v24, v144, v145
    v_cvt_pk_bf16_f32 v25, v146, v147
    v_mfma_f32_16x16x32_bf16 v[184:187], a[248:251], v[84:87], v[184:187]
    v_cvt_pk_bf16_f32 v26, v148, v149
    v_cvt_pk_bf16_f32 v27, v150, v151
    v_mfma_f32_16x16x32_bf16 v[188:191], a[252:255], v[84:87], v[188:191]
    v_cvt_pk_bf16_f32 v28, v152, v153
    v_cvt_pk_bf16_f32 v29, v154, v155
    v_mfma_f32_16x16x32_bf16 v[192:195], a[240:243], v[88:91], v[192:195]
    s_add_u32 m0, s34, 49152
    s_add_u32 s37, s86, 131072
    buffer_load_dwordx4 v232, s[44:47], s37 offen lds
    v_cvt_pk_bf16_f32 v30, v156, v157
    v_cvt_pk_bf16_f32 v31, v158, v159
    v_mfma_f32_16x16x32_bf16 v[196:199], a[244:247], v[88:91], v[196:199]
    v_cvt_pk_bf16_f32 v32, v160, v161
    v_cvt_pk_bf16_f32 v33, v162, v163
    v_mfma_f32_16x16x32_bf16 v[200:203], a[248:251], v[88:91], v[200:203]
    v_cvt_pk_bf16_f32 v34, v164, v165
    v_cvt_pk_bf16_f32 v35, v166, v167
    v_mfma_f32_16x16x32_bf16 v[204:207], a[252:255], v[88:91], v[204:207]
    v_cvt_pk_bf16_f32 v36, v168, v169
    v_cvt_pk_bf16_f32 v37, v170, v171
    v_mfma_f32_16x16x32_bf16 v[208:211], a[240:243], v[92:95], v[208:211]
    buffer_load_dwordx4 v233, s[44:47], s37 offen offset:1024 lds
    v_cvt_pk_bf16_f32 v38, v172, v173
    v_cvt_pk_bf16_f32 v39, v174, v175
    v_mfma_f32_16x16x32_bf16 v[212:215], a[244:247], v[92:95], v[212:215]
    v_cvt_pk_bf16_f32 v40, v176, v177
    v_cvt_pk_bf16_f32 v41, v178, v179
    v_mfma_f32_16x16x32_bf16 v[216:219], a[248:251], v[92:95], v[216:219]
    v_cvt_pk_bf16_f32 v42, v180, v181
    v_cvt_pk_bf16_f32 v43, v182, v183
    v_mfma_f32_16x16x32_bf16 v[220:223], a[252:255], v[92:95], v[220:223]
    v_cvt_pk_bf16_f32 v44, v184, v185
    v_cvt_pk_bf16_f32 v45, v186, v187
    s_waitcnt lgkmcnt(0)
    v_mfma_f32_16x16x32_bf16 v[96:99], a[0:3], v[64:67], 0
    ds_read_b128 v[80:83], v225 offset:0
    v_cvt_pk_bf16_f32 v46, v188, v189
    v_cvt_pk_bf16_f32 v47, v190, v191
    v_mfma_f32_16x16x32_bf16 v[100:103], a[4:7], v[64:67], 0
    ds_read_b128 v[84:87], v225 offset:2048
    v_cvt_pk_bf16_f32 v48, v192, v193
    v_cvt_pk_bf16_f32 v49, v194, v195
    v_mfma_f32_16x16x32_bf16 v[104:107], a[8:11], v[64:67], 0
    ds_read_b128 v[88:91], v225 offset:4096
    v_cvt_pk_bf16_f32 v50, v196, v197
    v_cvt_pk_bf16_f32 v51, v198, v199
    v_mfma_f32_16x16x32_bf16 v[108:111], a[12:15], v[64:67], 0
    ds_read_b128 v[92:95], v225 offset:6144
    v_cvt_pk_bf16_f32 v52, v200, v201
    v_cvt_pk_bf16_f32 v53, v202, v203
    v_mfma_f32_16x16x32_bf16 v[112:115], a[0:3], v[68:71], 0
    v_cvt_pk_bf16_f32 v54, v204, v205
    v_cvt_pk_bf16_f32 v55, v206, v207
    s_add_u32 s38, s36, 0
    buffer_store_dwordx4 v[0:3], v240, s[16:19], s38 offen offset:0 sc1
    v_mfma_f32_16x16x32_bf16 v[116:119], a[4:7], v[68:71], 0
    v_cvt_pk_bf16_f32 v56, v208, v209
    v_cvt_pk_bf16_f32 v57, v210, v211
    v_mfma_f32_16x16x32_bf16 v[120:123], a[8:11], v[68:71], 0
    v_cvt_pk_bf16_f32 v58, v212, v213
    v_cvt_pk_bf16_f32 v59, v214, v215
    v_mfma_f32_16x16x32_bf16 v[124:127], a[12:15], v[68:71], 0
    v_cvt_pk_bf16_f32 v60, v216, v217
    v_cvt_pk_bf16_f32 v61, v218, v219
    v_mfma_f32_16x16x32_bf16 v[128:131], a[0:3], v[72:75], 0
    v_xor_b32 v237, 32, v245
    v_xor_b32 v238, 32, v246
    v_cvt_pk_bf16_f32 v62, v220, v221
    v_cvt_pk_bf16_f32 v63, v222, v223
    v_mfma_f32_16x16x32_bf16 v[132:135], a[4:7], v[72:75], 0
    v_mfma_f32_16x16x32_bf16 v[136:139], a[8:11], v[72:75], 0
    v_mfma_f32_16x16x32_bf16 v[140:143], a[12:15], v[72:75], 0
    v_mfma_f32_16x16x32_bf16 v[144:147], a[0:3], v[76:79], 0
    v_mfma_f32_16x16x32_bf16 v[148:151], a[4:7], v[76:79], 0
    v_mfma_f32_16x16x32_bf16 v[152:155], a[8:11], v[76:79], 0
    v_mfma_f32_16x16x32_bf16 v[156:159], a[12:15], v[76:79], 0
    s_waitcnt lgkmcnt(0)
    v_mfma_f32_16x16x32_bf16 v[96:99], a[16:19], v[80:83], v[96:99]
    ds_read_b128 v[64:67], v224 offset:8192
    v_mfma_f32_16x16x32_bf16 v[100:103], a[20:23], v[80:83], v[100:103]
    ds_read_b128 v[68:71], v224 offset:10240
    v_mfma_f32_16x16x32_bf16 v[104:107], a[24:27], v[80:83], v[104:107]
    ds_read_b128 v[72:75], v224 offset:12288
    v_mfma_f32_16x16x32_bf16 v[108:111], a[28:31], v[80:83], v[108:111]
    ds_read_b128 v[76:79], v224 offset:14336
    v_mfma_f32_16x16x32_bf16 v[112:115], a[16:19], v[84:87], v[112:115]
    v_mfma_f32_16x16x32_bf16 v[116:119], a[20:23], v[84:87], v[116:119]
    v_mfma_f32_16x16x32_bf16 v[120:123], a[24:27], v[84:87], v[120:123]
    v_mfma_f32_16x16x32_bf16 v[124:127], a[28:31], v[84:87], v[124:127]
    v_mfma_f32_16x16x32_bf16 v[128:131], a[16:19], v[88:91], v[128:131]
    s_add_u32 m0, s34, 57344
    s_add_u32 s37, s87, 131072
    buffer_load_dwordx4 v232, s[44:47], s37 offen lds
    v_mfma_f32_16x16x32_bf16 v[132:135], a[20:23], v[88:91], v[132:135]
    s_add_u32 s38, s36, 0
    buffer_store_dwordx4 v[4:7], v240, s[16:19], s38 offen offset:2048 sc1
    v_mfma_f32_16x16x32_bf16 v[136:139], a[24:27], v[88:91], v[136:139]
    v_mfma_f32_16x16x32_bf16 v[140:143], a[28:31], v[88:91], v[140:143]
    v_mfma_f32_16x16x32_bf16 v[144:147], a[16:19], v[92:95], v[144:147]
    buffer_load_dwordx4 v233, s[44:47], s37 offen offset:1024 lds
    v_mfma_f32_16x16x32_bf16 v[148:151], a[20:23], v[92:95], v[148:151]
    v_mfma_f32_16x16x32_bf16 v[152:155], a[24:27], v[92:95], v[152:155]
    v_mfma_f32_16x16x32_bf16 v[156:159], a[28:31], v[92:95], v[156:159]
    s_waitcnt lgkmcnt(0)
    v_mfma_f32_16x16x32_bf16 v[96:99], a[32:35], v[64:67], v[96:99]
    ds_read_b128 v[80:83], v225 offset:8192
    v_mfma_f32_16x16x32_bf16 v[100:103], a[36:39], v[64:67], v[100:103]
    ds_read_b128 v[84:87], v225 offset:10240
    v_mfma_f32_16x16x32_bf16 v[104:107], a[40:43], v[64:67], v[104:107]
    ds_read_b128 v[88:91], v225 offset:12288
    v_mfma_f32_16x16x32_bf16 v[108:111], a[44:47], v[64:67], v[108:111]
    ds_read_b128 v[92:95], v225 offset:14336
    v_mfma_f32_16x16x32_bf16 v[112:115], a[32:35], v[68:71], v[112:115]
    v_mfma_f32_16x16x32_bf16 v[116:119], a[36:39], v[68:71], v[116:119]
    v_mfma_f32_16x16x32_bf16 v[120:123], a[40:43], v[68:71], v[120:123]
    v_mfma_f32_16x16x32_bf16 v[124:127], a[44:47], v[68:71], v[124:127]
    v_mfma_f32_16x16x32_bf16 v[128:131], a[32:35], v[72:75], v[128:131]
    s_waitcnt vmcnt(15)
    v_readfirstlane_b32 s24, v254
    s_lshl_b32 s25, s3, 16
    s_add_u32 s24, s24, s25
    s_cmp_ge_u32 s24, 1
    s_cbranch_scc0 kf_spin41
kf_spinr42:
    v_mfma_f32_16x16x32_bf16 v[132:135], a[36:39], v[72:75], v[132:135]
    v_mfma_f32_16x16x32_bf16 v[136:139], a[40:43], v[72:75], v[136:139]
    v_mfma_f32_16x16x32_bf16 v[140:143], a[44:47], v[72:75], v[140:143]
    v_mfma_f32_16x16x32_bf16 v[144:147], a[32:35], v[76:79], v[144:147]
    s_add_u32 s88, s20, 0x14a0000
    s_addc_u32 s89, s21, 0
    s_mov_b32 s90, 16384
    v_mfma_f32_16x16x32_bf16 v[148:151], a[36:39], v[76:79], v[148:151]
    v_mfma_f32_16x16x32_bf16 v[152:155], a[40:43], v[76:79], v[152:155]
    v_mfma_f32_16x16x32_bf16 v[156:159], a[44:47], v[76:79], v[156:159]
    s_add_u32 s38, s36, 0
    buffer_store_dwordx4 v[8:11], v240, s[16:19], s38 offen offset:1024 sc1
    s_waitcnt vmcnt(7) lgkmcnt(0)
    s_barrier
    v_mfma_f32_16x16x32_bf16 v[96:99], a[48:51], v[80:83], v[96:99]
    ds_read_b128 v[64:67], v224 offset:16384
    v_mfma_f32_16x16x32_bf16 v[100:103], a[52:55], v[80:83], v[100:103]
    ds_read_b128 v[68:71], v224 offset:18432
    v_mfma_f32_16x16x32_bf16 v[104:107], a[56:59], v[80:83], v[104:107]
    ds_read_b128 v[72:75], v224 offset:20480
    v_mfma_f32_16x16x32_bf16 v[108:111], a[60:63], v[80:83], v[108:111]
    ds_read_b128 v[76:79], v224 offset:22528
    v_mfma_f32_16x16x32_bf16 v[112:115], a[48:51], v[84:87], v[112:115]
    v_mfma_f32_16x16x32_bf16 v[116:119], a[52:55], v[84:87], v[116:119]
    v_mfma_f32_16x16x32_bf16 v[120:123], a[56:59], v[84:87], v[120:123]
    v_mfma_f32_16x16x32_bf16 v[124:127], a[60:63], v[84:87], v[124:127]
    v_mfma_f32_16x16x32_bf16 v[128:131], a[48:51], v[88:91], v[128:131]
    s_add_u32 m0, s34, 0
    s_add_u32 s37, s80, 196608
    buffer_load_dwordx4 v232, s[44:47], s37 offen lds
    v_mfma_f32_16x16x32_bf16 v[132:135], a[52:55], v[88:91], v[132:135]
    v_mfma_f32_16x16x32_bf16 v[136:139], a[56:59], v[88:91], v[136:139]
    buffer_load_dwordx4 v233, s[44:47], s37 offen offset:1024 lds
    v_mfma_f32_16x16x32_bf16 v[140:143], a[60:63], v[88:91], v[140:143]
    v_mfma_f32_16x16x32_bf16 v[144:147], a[48:51], v[92:95], v[144:147]
    v_mfma_f32_16x16x32_bf16 v[148:151], a[52:55], v[92:95], v[148:151]
    s_lshl_b32 s39, s5, 7
    s_add_u32 s39, s39, 8192
    buffer_atomic_add v255, v250, s[88:91], s39 offen sc1
    s_cmp_eq_u32 s3, 0
    s_cselect_b32 s39, s39, s43
    v_mfma_f32_16x16x32_bf16 v[152:155], a[56:59], v[92:95], v[152:155]
    v_mfma_f32_16x16x32_bf16 v[156:159], a[60:63], v[92:95], v[156:159]
    s_waitcnt lgkmcnt(0)
    v_mfma_f32_16x16x32_bf16 v[96:99], a[64:67], v[64:67], v[96:99]
    ds_read_b128 v[80:83], v225 offset:16384
    v_mfma_f32_16x16x32_bf16 v[100:103], a[68:71], v[64:67], v[100:103]
    ds_read_b128 v[84:87], v225 offset:18432
    v_mfma_f32_16x16x32_bf16 v[104:107], a[72:75], v[64:67], v[104:107]
    ds_read_b128 v[88:91], v225 offset:20480
    v_mfma_f32_16x16x32_bf16 v[108:111], a[76:79], v[64:67], v[108:111]
    ds_read_b128 v[92:95], v225 offset:22528
    v_mfma_f32_16x16x32_bf16 v[112:115], a[64:67], v[68:71], v[112:115]
    s_add_u32 s38, s36, 0
    buffer_store_dwordx4 v[12:15], v240, s[16:19], s38 offen offset:3072 sc1
    v_mfma_f32_16x16x32_bf16 v[116:119], a[68:71], v[68:71], v[116:119]
    v_mfma_f32_16x16x32_bf16 v[120:123], a[72:75], v[68:71], v[120:123]
    v_mfma_f32_16x16x32_bf16 v[124:127], a[76:79], v[68:71], v[124:127]
    v_mfma_f32_16x16x32_bf16 v[128:131], a[64:67], v[72:75], v[128:131]
    s_add_u32 m0, s31, 0
    s_add_u32 s24, s27, 0
    buffer_load_dwordx4 v245, s[12:15], s24 offen lds
    v_mfma_f32_16x16x32_bf16 v[132:135], a[68:71], v[72:75], v[132:135]
    v_mfma_f32_16x16x32_bf16 v[136:139], a[72:75], v[72:75], v[136:139]
    v_mfma_f32_16x16x32_bf16 v[140:143], a[76:79], v[72:75], v[140:143]
    v_mfma_f32_16x16x32_bf16 v[144:147], a[64:67], v[76:79], v[144:147]
    v_mfma_f32_16x16x32_bf16 v[148:151], a[68:71], v[76:79], v[148:151]
    v_mfma_f32_16x16x32_bf16 v[152:155], a[72:75], v[76:79], v[152:155]
    v_mfma_f32_16x16x32_bf16 v[156:159], a[76:79], v[76:79], v[156:159]
    s_waitcnt lgkmcnt(0)
    v_mfma_f32_16x16x32_bf16 v[96:99], a[80:83], v[80:83], v[96:99]
    ds_read_b128 v[64:67], v224 offset:24576
    v_mfma_f32_16x16x32_bf16 v[100:103], a[84:87], v[80:83], v[100:103]
    ds_read_b128 v[68:71], v224 offset:26624
    v_mfma_f32_16x16x32_bf16 v[104:107], a[88:91], v[80:83], v[104:107]
    ds_read_b128 v[72:75], v224 offset:28672
    v_mfma_f32_16x16x32_bf16 v[108:111], a[92:95], v[80:83], v[108:111]
    ds_read_b128 v[76:79], v224 offset:30720
    v_mfma_f32_16x16x32_bf16 v[112:115], a[80:83], v[84:87], v[112:115]
    v_mfma_f32_16x16x32_bf16 v[116:119], a[84:87], v[84:87], v[116:119]
    v_mfma_f32_16x16x32_bf16 v[120:123], a[88:91], v[84:87], v[120:123]
    v_mfma_f32_16x16x32_bf16 v[124:127], a[92:95], v[84:87], v[124:127]
    v_mfma_f32_16x16x32_bf16 v[128:131], a[80:83], v[88:91], v[128:131]
    s_add_u32 m0, s34, 8192
    s_add_u32 s37, s81, 196608
    buffer_load_dwordx4 v232, s[44:47], s37 offen lds
    v_mfma_f32_16x16x32_bf16 v[132:135], a[84:87], v[88:91], v[132:135]
    v_mfma_f32_16x16x32_bf16 v[136:139], a[88:91], v[88:91], v[136:139]
    buffer_load_dwordx4 v233, s[44:47], s37 offen offset:1024 lds
    s_add_u32 s38, s36, 8192
    buffer_store_dwordx4 v[16:19], v240, s[16:19], s38 offen offset:0 sc1
    v_mfma_f32_16x16x32_bf16 v[140:143], a[92:95], v[88:91], v[140:143]
    v_mfma_f32_16x16x32_bf16 v[144:147], a[80:83], v[92:95], v[144:147]
    v_mfma_f32_16x16x32_bf16 v[148:151], a[84:87], v[92:95], v[148:151]
    s_add_u32 m0, s31, 1024
    s_add_u32 s24, s27, 32768
    buffer_load_dwordx4 v245, s[12:15], s24 offen lds
    v_mfma_f32_16x16x32_bf16 v[152:155], a[88:91], v[92:95], v[152:155]
    v_mfma_f32_16x16x32_bf16 v[156:159], a[92:95], v[92:95], v[156:159]
    s_waitcnt lgkmcnt(0)
    v_mfma_f32_16x16x32_bf16 v[96:99], a[96:99], v[64:67], v[96:99]
    ds_read_b128 v[80:83], v225 offset:24576
    v_mfma_f32_16x16x32_bf16 v[100:103], a[100:103], v[64:67], v[100:103]
    ds_read_b128 v[84:87], v225 offset:26624
    v_mfma_f32_16x16x32_bf16 v[104:107], a[104:107], v[64:67], v[104:107]
    ds_read_b128 v[88:91], v225 offset:28672
    v_mfma_f32_16x16x32_bf16 v[108:111], a[108:111], v[64:67], v[108:111]
    ds_read_b128 v[92:95], v225 offset:30720
    v_mfma_f32_16x16x32_bf16 v[112:115], a[96:99], v[68:71], v[112:115]
    v_mfma_f32_16x16x32_bf16 v[116:119], a[100:103], v[68:71], v[116:119]
    v_mfma_f32_16x16x32_bf16 v[120:123], a[104:107], v[68:71], v[120:123]
    v_mfma_f32_16x16x32_bf16 v[124:127], a[108:111], v[68:71], v[124:127]
    v_mfma_f32_16x16x32_bf16 v[128:131], a[96:99], v[72:75], v[128:131]
    s_add_u32 m0, s31, 2048
    s_add_u32 s24, s27, 65536
    buffer_load_dwordx4 v237, s[12:15], s24 offen lds
    v_mfma_f32_16x16x32_bf16 v[132:135], a[100:103], v[72:75], v[132:135]
    v_mfma_f32_16x16x32_bf16 v[136:139], a[104:107], v[72:75], v[136:139]
    v_mfma_f32_16x16x32_bf16 v[140:143], a[108:111], v[72:75], v[140:143]
    v_mfma_f32_16x16x32_bf16 v[144:147], a[96:99], v[76:79], v[144:147]
    v_mfma_f32_16x16x32_bf16 v[148:151], a[100:103], v[76:79], v[148:151]
    v_mfma_f32_16x16x32_bf16 v[152:155], a[104:107], v[76:79], v[152:155]
    v_mfma_f32_16x16x32_bf16 v[156:159], a[108:111], v[76:79], v[156:159]
    s_add_u32 s38, s36, 8192
    buffer_store_dwordx4 v[20:23], v240, s[16:19], s38 offen offset:2048 sc1
    s_waitcnt vmcnt(19) lgkmcnt(0)
    s_barrier
    v_mfma_f32_16x16x32_bf16 v[96:99], a[112:115], v[80:83], v[96:99]
    ds_read_b128 v[64:67], v224 offset:32768
    v_mfma_f32_16x16x32_bf16 v[100:103], a[116:119], v[80:83], v[100:103]
    ds_read_b128 v[68:71], v224 offset:34816
    v_mfma_f32_16x16x32_bf16 v[104:107], a[120:123], v[80:83], v[104:107]
    ds_read_b128 v[72:75], v224 offset:36864
    v_mfma_f32_16x16x32_bf16 v[108:111], a[124:127], v[80:83], v[108:111]
    ds_read_b128 v[76:79], v224 offset:38912
    v_mfma_f32_16x16x32_bf16 v[112:115], a[112:115], v[84:87], v[112:115]
    v_mfma_f32_16x16x32_bf16 v[116:119], a[116:119], v[84:87], v[116:119]
    v_mfma_f32_16x16x32_bf16 v[120:123], a[120:123], v[84:87], v[120:123]
    v_mfma_f32_16x16x32_bf16 v[124:127], a[124:127], v[84:87], v[124:127]
    v_mfma_f32_16x16x32_bf16 v[128:131], a[112:115], v[88:91], v[128:131]
    s_add_u32 m0, s34, 16384
    s_add_u32 s37, s82, 196608
    buffer_load_dwordx4 v232, s[44:47], s37 offen lds
    v_mfma_f32_16x16x32_bf16 v[132:135], a[116:119], v[88:91], v[132:135]
    v_mfma_f32_16x16x32_bf16 v[136:139], a[120:123], v[88:91], v[136:139]
    buffer_load_dwordx4 v233, s[44:47], s37 offen offset:1024 lds
    v_mfma_f32_16x16x32_bf16 v[140:143], a[124:127], v[88:91], v[140:143]
    v_mfma_f32_16x16x32_bf16 v[144:147], a[112:115], v[92:95], v[144:147]
    v_mfma_f32_16x16x32_bf16 v[148:151], a[116:119], v[92:95], v[148:151]
    s_add_u32 m0, s31, 3072
    s_add_u32 s24, s27, 98304
    buffer_load_dwordx4 v237, s[12:15], s24 offen lds
    v_mfma_f32_16x16x32_bf16 v[152:155], a[120:123], v[92:95], v[152:155]
    v_mfma_f32_16x16x32_bf16 v[156:159], a[124:127], v[92:95], v[156:159]
    s_waitcnt lgkmcnt(0)
    v_mfma_f32_16x16x32_bf16 v[96:99], a[128:131], v[64:67], v[96:99]
    ds_read_b128 v[80:83], v225 offset:32768
    v_mfma_f32_16x16x32_bf16 v[100:103], a[132:135], v[64:67], v[100:103]
    ds_read_b128 v[84:87], v225 offset:34816
    v_mfma_f32_16x16x32_bf16 v[104:107], a[136:139], v[64:67], v[104:107]
    ds_read_b128 v[88:91], v225 offset:36864
    v_mfma_f32_16x16x32_bf16 v[108:111], a[140:143], v[64:67], v[108:111]
    ds_read_b128 v[92:95], v225 offset:38912
    v_mfma_f32_16x16x32_bf16 v[112:115], a[128:131], v[68:71], v[112:115]
    v_mfma_f32_16x16x32_bf16 v[116:119], a[132:135], v[68:71], v[116:119]
    s_add_u32 s38, s36, 8192
    buffer_store_dwordx4 v[24:27], v240, s[16:19], s38 offen offset:1024 sc1
    v_mfma_f32_16x16x32_bf16 v[120:123], a[136:139], v[68:71], v[120:123]
    v_mfma_f32_16x16x32_bf16 v[124:127], a[140:143], v[68:71], v[124:127]
    v_mfma_f32_16x16x32_bf16 v[128:131], a[128:131], v[72:75], v[128:131]
    s_add_u32 m0, s31, 4096
    s_add_u32 s24, s27, 131072
    buffer_load_dwordx4 v245, s[12:15], s24 offen lds
    v_mfma_f32_16x16x32_bf16 v[132:135], a[132:135], v[72:75], v[132:135]
    v_mfma_f32_16x16x32_bf16 v[136:139], a[136:139], v[72:75], v[136:139]
    v_mfma_f32_16x16x32_bf16 v[140:143], a[140:143], v[72:75], v[140:143]
    v_mfma_f32_16x16x32_bf16 v[144:147], a[128:131], v[76:79], v[144:147]
    v_mfma_f32_16x16x32_bf16 v[148:151], a[132:135], v[76:79], v[148:151]
    v_mfma_f32_16x16x32_bf16 v[152:155], a[136:139], v[76:79], v[152:155]
    v_mfma_f32_16x16x32_bf16 v[156:159], a[140:143], v[76:79], v[156:159]
    s_waitcnt lgkmcnt(0)
    v_mfma_f32_16x16x32_bf16 v[96:99], a[144:147], v[80:83], v[96:99]
    ds_read_b128 v[64:67], v224 offset:40960
    v_mfma_f32_16x16x32_bf16 v[100:103], a[148:151], v[80:83], v[100:103]
    ds_read_b128 v[68:71], v224 offset:43008
    v_mfma_f32_16x16x32_bf16 v[104:107], a[152:155], v[80:83], v[104:107]
    ds_read_b128 v[72:75], v224 offset:45056
    v_mfma_f32_16x16x32_bf16 v[108:111], a[156:159], v[80:83], v[108:111]
    ds_read_b128 v[76:79], v224 offset:47104
    v_mfma_f32_16x16x32_bf16 v[112:115], a[144:147], v[84:87], v[112:115]
    v_mfma_f32_16x16x32_bf16 v[116:119], a[148:151], v[84:87], v[116:119]
    v_mfma_f32_16x16x32_bf16 v[120:123], a[152:155], v[84:87], v[120:123]
    v_mfma_f32_16x16x32_bf16 v[124:127], a[156:159], v[84:87], v[124:127]
    v_mfma_f32_16x16x32_bf16 v[128:131], a[144:147], v[88:91], v[128:131]
    s_add_u32 m0, s34, 24576
    s_add_u32 s37, s83, 196608
    buffer_load_dwordx4 v232, s[44:47], s37 offen lds
    v_mfma_f32_16x16x32_bf16 v[132:135], a[148:151], v[88:91], v[132:135]
    v_mfma_f32_16x16x32_bf16 v[136:139], a[152:155], v[88:91], v[136:139]
    buffer_load_dwordx4 v233, s[44:47], s37 offen offset:1024 lds
    s_add_u32 s38, s36, 8192
    buffer_store_dwordx4 v[28:31], v240, s[16:19], s38 offen offset:3072 sc1
    v_mfma_f32_16x16x32_bf16 v[140:143], a[156:159], v[88:91], v[140:143]
    v_mfma_f32_16x16x32_bf16 v[144:147], a[144:147], v[92:95], v[144:147]
    v_mfma_f32_16x16x32_bf16 v[148:151], a[148:151], v[92:95], v[148:151]
    s_add_u32 m0, s31, 5120
    s_add_u32 s24, s27, 163840
    buffer_load_dwordx4 v245, s[12:15], s24 offen lds
    v_mfma_f32_16x16x32_bf16 v[152:155], a[152:155], v[92:95], v[152:155]
    v_mfma_f32_16x16x32_bf16 v[156:159], a[156:159], v[92:95], v[156:159]
    s_waitcnt lgkmcnt(0)
    v_mfma_f32_16x16x32_bf16 v[96:99], a[160:163], v[64:67], v[96:99]
    ds_read_b128 v[80:83], v225 offset:40960
    v_mfma_f32_16x16x32_bf16 v[100:103], a[164:167], v[64:67], v[100:103]
    ds_read_b128 v[84:87], v225 offset:43008
    v_mfma_f32_16x16x32_bf16 v[104:107], a[168:171], v[64:67], v[104:107]
    ds_read_b128 v[88:91], v225 offset:45056
    v_mfma_f32_16x16x32_bf16 v[108:111], a[172:175], v[64:67], v[108:111]
    ds_read_b128 v[92:95], v225 offset:47104
    v_mfma_f32_16x16x32_bf16 v[112:115], a[160:163], v[68:71], v[112:115]
    v_mfma_f32_16x16x32_bf16 v[116:119], a[164:167], v[68:71], v[116:119]
    v_mfma_f32_16x16x32_bf16 v[120:123], a[168:171], v[68:71], v[120:123]
    v_mfma_f32_16x16x32_bf16 v[124:127], a[172:175], v[68:71], v[124:127]
    v_mfma_f32_16x16x32_bf16 v[128:131], a[160:163], v[72:75], v[128:131]
    s_add_u32 m0, s31, 6144
    s_add_u32 s24, s27, 196608
    buffer_load_dwordx4 v237, s[12:15], s24 offen lds
    v_mfma_f32_16x16x32_bf16 v[132:135], a[164:167], v[72:75], v[132:135]
    v_mfma_f32_16x16x32_bf16 v[136:139], a[168:171], v[72:75], v[136:139]
    v_mfma_f32_16x16x32_bf16 v[140:143], a[172:175], v[72:75], v[140:143]
    v_mfma_f32_16x16x32_bf16 v[144:147], a[160:163], v[76:79], v[144:147]
    v_mfma_f32_16x16x32_bf16 v[148:151], a[164:167], v[76:79], v[148:151]
    v_mfma_f32_16x16x32_bf16 v[152:155], a[168:171], v[76:79], v[152:155]
    v_mfma_f32_16x16x32_bf16 v[156:159], a[172:175], v[76:79], v[156:159]
    s_waitcnt vmcnt(22) lgkmcnt(0)
    s_barrier
    v_mfma_f32_16x16x32_bf16 v[96:99], a[176:179], v[80:83], v[96:99]
    ds_read_b128 v[64:67], v224 offset:49152
    s_add_u32 s38, s36, 32768
    buffer_store_dwordx4 v[32:35], v240, s[16:19], s38 offen offset:1280 sc1
    v_mfma_f32_16x16x32_bf16 v[100:103], a[180:183], v[80:83], v[100:103]
    ds_read_b128 v[68:71], v224 offset:51200
    v_mfma_f32_16x16x32_bf16 v[104:107], a[184:187], v[80:83], v[104:107]
    ds_read_b128 v[72:75], v224 offset:53248
    v_mfma_f32_16x16x32_bf16 v[108:111], a[188:191], v[80:83], v[108:111]
    ds_read_b128 v[76:79], v224 offset:55296
    v_mfma_f32_16x16x32_bf16 v[112:115], a[176:179], v[84:87], v[112:115]
    v_mfma_f32_16x16x32_bf16 v[116:119], a[180:183], v[84:87], v[116:119]
    v_mfma_f32_16x16x32_bf16 v[120:123], a[184:187], v[84:87], v[120:123]
    v_mfma_f32_16x16x32_bf16 v[124:127], a[188:191], v[84:87], v[124:127]
    v_mfma_f32_16x16x32_bf16 v[128:131], a[176:179], v[88:91], v[128:131]
    s_add_u32 m0, s34, 32768
    s_add_u32 s37, s84, 196608
    buffer_load_dwordx4 v232, s[44:47], s37 offen lds
    v_mfma_f32_16x16x32_bf16 v[132:135], a[180:183], v[88:91], v[132:135]
    buffer_load_dwordx4 v233, s[44:47], s37 offen offset:1024 lds
    v_mfma_f32_16x16x32_bf16 v[136:139], a[184:187], v[88:91], v[136:139]
    v_mfma_f32_16x16x32_bf16 v[140:143], a[188:191], v[88:91], v[140:143]
    s_add_u32 m0, s31, 7168
    s_add_u32 s24, s27, 229376
    buffer_load_dwordx4 v237, s[12:15], s24 offen lds
    v_mfma_f32_16x16x32_bf16 v[144:147], a[176:179], v[92:95], v[144:147]
    s_add_u32 s27, s27, 1048576
    s_and_b32 s27, s27, 0x407fffff
    s_cmp_eq_u32 s27, s7
    s_cselect_b32 s27, s43, s27
    v_mfma_f32_16x16x32_bf16 v[148:151], a[180:183], v[92:95], v[148:151]
    v_mfma_f32_16x16x32_bf16 v[152:155], a[184:187], v[92:95], v[152:155]
    s_add_u32 s31, s31, 32768
    s_cmp_ge_u32 s31, 163840
    s_cselect_b32 s24, 98304, 0
    s_sub_u32 s31, s31, s24
    v_mfma_f32_16x16x32_bf16 v[156:159], a[188:191], v[92:95], v[156:159]
    s_waitcnt lgkmcnt(0)
    v_mfma_f32_16x16x32_bf16 v[96:99], a[192:195], v[64:67], v[96:99]
    ds_read_b128 v[80:83], v225 offset:49152
    v_mfma_f32_16x16x32_bf16 v[100:103], a[196:199], v[64:67], v[100:103]
    ds_read_b128 v[84:87], v225 offset:51200
    v_mfma_f32_16x16x32_bf16 v[104:107], a[200:203], v[64:67], v[104:107]
    ds_read_b128 v[88:91], v225 offset:53248
    v_mfma_f32_16x16x32_bf16 v[108:111], a[204:207], v[64:67], v[108:111]
    ds_read_b128 v[92:95], v225 offset:55296
    v_mfma_f32_16x16x32_bf16 v[112:115], a[192:195], v[68:71], v[112:115]
    v_mfma_f32_16x16x32_bf16 v[116:119], a[196:199], v[68:71], v[116:119]
    v_mfma_f32_16x16x32_bf16 v[120:123], a[200:203], v[68:71], v[120:123]
    s_add_u32 s38, s36, 32768
    buffer_store_dwordx4 v[36:39], v240, s[16:19], s38 offen offset:3328 sc1
    v_mfma_f32_16x16x32_bf16 v[124:127], a[204:207], v[68:71], v[124:127]
    v_mfma_f32_16x16x32_bf16 v[128:131], a[192:195], v[72:75], v[128:131]
    v_mfma_f32_16x16x32_bf16 v[132:135], a[196:199], v[72:75], v[132:135]
    v_mfma_f32_16x16x32_bf16 v[136:139], a[200:203], v[72:75], v[136:139]
    v_mfma_f32_16x16x32_bf16 v[140:143], a[204:207], v[72:75], v[140:143]
    v_mfma_f32_16x16x32_bf16 v[144:147], a[192:195], v[76:79], v[144:147]
    v_mfma_f32_16x16x32_bf16 v[148:151], a[196:199], v[76:79], v[148:151]
    v_mfma_f32_16x16x32_bf16 v[152:155], a[200:203], v[76:79], v[152:155]
    v_mfma_f32_16x16x32_bf16 v[156:159], a[204:207], v[76:79], v[156:159]
    s_waitcnt lgkmcnt(0)
    v_mfma_f32_16x16x32_bf16 v[96:99], a[208:211], v[80:83], v[96:99]
    ds_read_b128 v[64:67], v224 offset:57344
    v_mfma_f32_16x16x32_bf16 v[100:103], a[212:215], v[80:83], v[100:103]
    ds_read_b128 v[68:71], v224 offset:59392
    v_mfma_f32_16x16x32_bf16 v[104:107], a[216:219], v[80:83], v[104:107]
    ds_read_b128 v[72:75], v224 offset:61440
    v_mfma_f32_16x16x32_bf16 v[108:111], a[220:223], v[80:83], v[108:111]
    ds_read_b128 v[76:79], v224 offset:63488
    v_mfma_f32_16x16x32_bf16 v[112:115], a[208:211], v[84:87], v[112:115]
    v_mfma_f32_16x16x32_bf16 v[116:119], a[212:215], v[84:87], v[116:119]
    v_mfma_f32_16x16x32_bf16 v[120:123], a[216:219], v[84:87], v[120:123]
    v_mfma_f32_16x16x32_bf16 v[124:127], a[220:223], v[84:87], v[124:127]
    v_mfma_f32_16x16x32_bf16 v[128:131], a[208:211], v[88:91], v[128:131]
    s_add_u32 m0, s34, 40960
    s_add_u32 s37, s85, 196608
    buffer_load_dwordx4 v232, s[44:47], s37 offen lds
    v_mfma_f32_16x16x32_bf16 v[132:135], a[212:215], v[88:91], v[132:135]
    v_mfma_f32_16x16x32_bf16 v[136:139], a[216:219], v[88:91], v[136:139]
    v_mfma_f32_16x16x32_bf16 v[140:143], a[220:223], v[88:91], v[140:143]
    s_add_u32 s38, s36, 32768
    buffer_store_dwordx4 v[40:43], v240, s[16:19], s38 offen offset:2304 sc1
    v_mfma_f32_16x16x32_bf16 v[144:147], a[208:211], v[92:95], v[144:147]
    buffer_load_dwordx4 v233, s[44:47], s37 offen offset:1024 lds
    v_mfma_f32_16x16x32_bf16 v[148:151], a[212:215], v[92:95], v[148:151]
    v_mfma_f32_16x16x32_bf16 v[152:155], a[216:219], v[92:95], v[152:155]
    v_mfma_f32_16x16x32_bf16 v[156:159], a[220:223], v[92:95], v[156:159]
    s_waitcnt lgkmcnt(0)
    v_mfma_f32_16x16x32_bf16 v[96:99], a[224:227], v[64:67], v[96:99]
    ds_read_b128 v[80:83], v225 offset:57344
    v_mfma_f32_16x16x32_bf16 v[100:103], a[228:231], v[64:67], v[100:103]
    ds_read_b128 v[84:87], v225 offset:59392
    v_mfma_f32_16x16x32_bf16 v[104:107], a[232:235], v[64:67], v[104:107]
    ds_read_b128 v[88:91], v225 offset:61440
    v_mfma_f32_16x16x32_bf16 v[108:111], a[236:239], v[64:67], v[108:111]
    ds_read_b128 v[92:95], v225 offset:63488
    v_mfma_f32_16x16x32_bf16 v[112:115], a[224:227], v[68:71], v[112:115]
    v_mfma_f32_16x16x32_bf16 v[116:119], a[228:231], v[68:71], v[116:119]
    v_mfma_f32_16x16x32_bf16 v[120:123], a[232:235], v[68:71], v[120:123]
    v_mfma_f32_16x16x32_bf16 v[124:127], a[236:239], v[68:71], v[124:127]
    v_mfma_f32_16x16x32_bf16 v[128:131], a[224:227], v[72:75], v[128:131]
    s_add_u32 m0, s31, 0
    s_add_u32 s24, s27, 0
    buffer_load_dwordx4 v245, s[12:15], s24 offen lds
    v_mfma_f32_16x16x32_bf16 v[132:135], a[228:231], v[72:75], v[132:135]
    v_mfma_f32_16x16x32_bf16 v[136:139], a[232:235], v[72:75], v[136:139]
    v_mfma_f32_16x16x32_bf16 v[140:143], a[236:239], v[72:75], v[140:143]
    v_mfma_f32_16x16x32_bf16 v[144:147], a[224:227], v[76:79], v[144:147]
    v_mfma_f32_16x16x32_bf16 v[148:151], a[228:231], v[76:79], v[148:151]
    v_mfma_f32_16x16x32_bf16 v[152:155], a[232:235], v[76:79], v[152:155]
    v_mfma_f32_16x16x32_bf16 v[156:159], a[236:239], v[76:79], v[156:159]
    s_waitcnt vmcnt(23) lgkmcnt(0)
    s_barrier
    v_mfma_f32_16x16x32_bf16 v[96:99], a[240:243], v[80:83], v[96:99]
    ds_read_b128 v[64:67], v224 offset:0
    v_mfma_f32_16x16x32_bf16 v[100:103], a[244:247], v[80:83], v[100:103]
    ds_read_b128 v[68:71], v224 offset:2048
    s_add_u32 s38, s36, 36864
    buffer_store_dwordx4 v[44:47], v240, s[16:19], s38 offen offset:256 sc1
    v_mfma_f32_16x16x32_bf16 v[104:107], a[248:251], v[80:83], v[104:107]
    ds_read_b128 v[72:75], v224 offset:4096
    v_mfma_f32_16x16x32_bf16 v[108:111], a[252:255], v[80:83], v[108:111]
    ds_read_b128 v[76:79], v224 offset:6144
    v_mfma_f32_16x16x32_bf16 v[112:115], a[240:243], v[84:87], v[112:115]
    v_mfma_f32_16x16x32_bf16 v[116:119], a[244:247], v[84:87], v[116:119]
    v_mfma_f32_16x16x32_bf16 v[120:123], a[248:251], v[84:87], v[120:123]
    v_mfma_f32_16x16x32_bf16 v[124:127], a[252:255], v[84:87], v[124:127]
    v_mfma_f32_16x16x32_bf16 v[128:131], a[240:243], v[88:91], v[128:131]
    s_add_u32 m0, s34, 49152
    s_add_u32 s37, s86, 196608
    buffer_load_dwordx4 v232, s[44:47], s37 offen lds
    v_mfma_f32_16x16x32_bf16 v[132:135], a[244:247], v[88:91], v[132:135]
    v_mfma_f32_16x16x32_bf16 v[136:139], a[248:251], v[88:91], v[136:139]
    buffer_load_dwordx4 v233, s[44:47], s37 offen offset:1024 lds
    v_mfma_f32_16x16x32_bf16 v[140:143], a[252:255], v[88:91], v[140:143]
    v_mfma_f32_16x16x32_bf16 v[144:147], a[240:243], v[92:95], v[144:147]
    v_mfma_f32_16x16x32_bf16 v[148:151], a[244:247], v[92:95], v[148:151]
    s_add_u32 m0, s31, 1024
    s_add_u32 s24, s27, 32768
    buffer_load_dwordx4 v245, s[12:15], s24 offen lds
    v_mfma_f32_16x16x32_bf16 v[152:155], a[248:251], v[92:95], v[152:155]
    v_mfma_f32_16x16x32_bf16 v[156:159], a[252:255], v[92:95], v[156:159]
    s_waitcnt lgkmcnt(0)
    v_mfma_f32_16x16x32_bf16 v[160:163], a[0:3], v[64:67], 0
    ds_read_b128 v[80:83], v225 offset:0
    v_mfma_f32_16x16x32_bf16 v[164:167], a[4:7], v[64:67], 0
    ds_read_b128 v[84:87], v225 offset:2048
    v_mfma_f32_16x16x32_bf16 v[168:171], a[8:11], v[64:67], 0
    ds_read_b128 v[88:91], v225 offset:4096
    v_mfma_f32_16x16x32_bf16 v[172:175], a[12:15], v[64:67], 0
    ds_read_b128 v[92:95], v225 offset:6144
    v_mfma_f32_16x16x32_bf16 v[176:179], a[0:3], v[68:71], 0
    v_cvt_pk_bf16_f32 v0, v96, v97
    v_cvt_pk_bf16_f32 v1, v98, v99
    v_mfma_f32_16x16x32_bf16 v[180:183], a[4:7], v[68:71], 0
    v_mfma_f32_16x16x32_bf16 v[184:187], a[8:11], v[68:71], 0
    v_cvt_pk_bf16_f32 v2, v100, v101
    v_cvt_pk_bf16_f32 v3, v102, v103
    s_add_u32 s38, s36, 40960
    buffer_store_dwordx4 v[48:51], v240, s[16:19], s38 offen offset:1280 sc1
    v_mfma_f32_16x16x32_bf16 v[188:191], a[12:15], v[68:71], 0
    v_mfma_f32_16x16x32_bf16 v[192:195], a[0:3], v[72:75], 0
    s_add_u32 m0, s31, 2048
    s_add_u32 s24, s27, 65536
    buffer_load_dwordx4 v237, s[12:15], s24 offen lds
    v_cvt_pk_bf16_f32 v4, v104, v105
    v_cvt_pk_bf16_f32 v5, v106, v107
    v_mfma_f32_16x16x32_bf16 v[196:199], a[4:7], v[72:75], 0
    v_mfma_f32_16x16x32_bf16 v[200:203], a[8:11], v[72:75], 0
    v_cvt_pk_bf16_f32 v6, v108, v109
    v_cvt_pk_bf16_f32 v7, v110, v111
    v_mfma_f32_16x16x32_bf16 v[204:207], a[12:15], v[72:75], 0
    v_mfma_f32_16x16x32_bf16 v[208:211], a[0:3], v[76:79], 0
    v_cvt_pk_bf16_f32 v8, v112, v113
    v_cvt_pk_bf16_f32 v9, v114, v115
    v_mfma_f32_16x16x32_bf16 v[212:215], a[4:7], v[76:79], 0
    v_mfma_f32_16x16x32_bf16 v[216:219], a[8:11], v[76:79], 0
    v_cvt_pk_bf16_f32 v10, v116, v117
    v_cvt_pk_bf16_f32 v11, v118, v119
    v_mfma_f32_16x16x32_bf16 v[220:223], a[12:15], v[76:79], 0
    s_waitcnt lgkmcnt(0)
    v_mfma_f32_16x16x32_bf16 v[160:163], a[16:19], v[80:83], v[160:163]
    ds_read_b128 v[64:67], v224 offset:8192
    v_cvt_pk_bf16_f32 v12, v120, v121
    v_cvt_pk_bf16_f32 v13, v122, v123
    v_mfma_f32_16x16x32_bf16 v[164:167], a[20:23], v[80:83], v[164:167]
    ds_read_b128 v[68:71], v224 offset:10240
    v_mfma_f32_16x16x32_bf16 v[168:171], a[24:27], v[80:83], v[168:171]
    ds_read_b128 v[72:75], v224 offset:12288
    v_cvt_pk_bf16_f32 v14, v124, v125
    v_cvt_pk_bf16_f32 v15, v126, v127
    v_mfma_f32_16x16x32_bf16 v[172:175], a[28:31], v[80:83], v[172:175]
    ds_read_b128 v[76:79], v224 offset:14336
    v_mfma_f32_16x16x32_bf16 v[176:179], a[16:19], v[84:87], v[176:179]
    v_cvt_pk_bf16_f32 v16, v128, v129
    v_cvt_pk_bf16_f32 v17, v130, v131
    v_mfma_f32_16x16x32_bf16 v[180:183], a[20:23], v[84:87], v[180:183]
    v_mfma_f32_16x16x32_bf16 v[184:187], a[24:27], v[84:87], v[184:187]
    v_cvt_pk_bf16_f32 v18, v132, v133
    v_cvt_pk_bf16_f32 v19, v134, v135
    v_mfma_f32_16x16x32_bf16 v[188:191], a[28:31], v[84:87], v[188:191]
    v_mfma_f32_16x16x32_bf16 v[192:195], a[16:19], v[88:91], v[192:195]
    s_add_u32 m0, s34, 57344
    s_add_u32 s37, s87, 196608
    buffer_load_dwordx4 v232, s[44:47], s37 offen lds
    v_cvt_pk_bf16_f32 v20, v136, v137
    v_cvt_pk_bf16_f32 v21, v138, v139
    v_mfma_f32_16x16x32_bf16 v[196:199], a[20:23], v[88:91], v[196:199]
    v_mfma_f32_16x16x32_bf16 v[200:203], a[24:27], v[88:91], v[200:203]
    buffer_load_dwordx4 v233, s[44:47], s37 offen offset:1024 lds
    v_cvt_pk_bf16_f32 v22, v140, v141
    v_cvt_pk_bf16_f32 v23, v142, v143
    v_mfma_f32_16x16x32_bf16 v[204:207], a[28:31], v[88:91], v[204:207]
    v_mfma_f32_16x16x32_bf16 v[208:211], a[16:19], v[92:95], v[208:211]
    v_cvt_pk_bf16_f32 v24, v144, v145
    v_cvt_pk_bf16_f32 v25, v146, v147
    s_add_u32 s38, s36, 40960
    buffer_store_dwordx4 v[52:55], v240, s[16:19], s38 offen offset:3328 sc1
    v_mfma_f32_16x16x32_bf16 v[212:215], a[20:23], v[92:95], v[212:215]
    s_add_u32 m0, s31, 3072
    s_add_u32 s24, s27, 98304
    buffer_load_dwordx4 v237, s[12:15], s24 offen lds
    v_mfma_f32_16x16x32_bf16 v[216:219], a[24:27], v[92:95], v[216:219]
    v_cvt_pk_bf16_f32 v26, v148, v149
    v_cvt_pk_bf16_f32 v27, v150, v151
    v_mfma_f32_16x16x32_bf16 v[220:223], a[28:31], v[92:95], v[220:223]
    s_waitcnt lgkmcnt(0)
    v_mfma_f32_16x16x32_bf16 v[160:163], a[32:35], v[64:67], v[160:163]
    ds_read_b128 v[80:83], v225 offset:8192
    v_cvt_pk_bf16_f32 v28, v152, v153
    v_cvt_pk_bf16_f32 v29, v154, v155
    v_mfma_f32_16x16x32_bf16 v[164:167], a[36:39], v[64:67], v[164:167]
    ds_read_b128 v[84:87], v225 offset:10240
    v_mfma_f32_16x16x32_bf16 v[168:171], a[40:43], v[64:67], v[168:171]
    ds_read_b128 v[88:91], v225 offset:12288
    v_cvt_pk_bf16_f32 v30, v156, v157
    v_cvt_pk_bf16_f32 v31, v158, v159
    v_mfma_f32_16x16x32_bf16 v[172:175], a[44:47], v[64:67], v[172:175]
    ds_read_b128 v[92:95], v225 offset:14336
    v_mfma_f32_16x16x32_bf16 v[176:179], a[32:35], v[68:71], v[176:179]
    v_mfma_f32_16x16x32_bf16 v[180:183], a[36:39], v[68:71], v[180:183]
    v_mfma_f32_16x16x32_bf16 v[184:187], a[40:43], v[68:71], v[184:187]
    v_mfma_f32_16x16x32_bf16 v[188:191], a[44:47], v[68:71], v[188:191]
    v_mfma_f32_16x16x32_bf16 v[192:195], a[32:35], v[72:75], v[192:195]
    s_add_u32 m0, s31, 4096
    s_add_u32 s24, s27, 131072
    buffer_load_dwordx4 v245, s[12:15], s24 offen lds
    v_mfma_f32_16x16x32_bf16 v[196:199], a[36:39], v[72:75], v[196:199]
    v_mfma_f32_16x16x32_bf16 v[200:203], a[40:43], v[72:75], v[200:203]
    v_mfma_f32_16x16x32_bf16 v[204:207], a[44:47], v[72:75], v[204:207]
    v_mfma_f32_16x16x32_bf16 v[208:211], a[32:35], v[76:79], v[208:211]
    v_mfma_f32_16x16x32_bf16 v[212:215], a[36:39], v[76:79], v[212:215]
    v_mfma_f32_16x16x32_bf16 v[216:219], a[40:43], v[76:79], v[216:219]
    v_mfma_f32_16x16x32_bf16 v[220:223], a[44:47], v[76:79], v[220:223]
    s_waitcnt vmcnt(23) lgkmcnt(0)
    s_barrier
    v_mfma_f32_16x16x32_bf16 v[160:163], a[48:51], v[80:83], v[160:163]
    ds_read_b128 v[64:67], v224 offset:16384
    v_mfma_f32_16x16x32_bf16 v[164:167], a[52:55], v[80:83], v[164:167]
    ds_read_b128 v[68:71], v224 offset:18432
    s_add_u32 s38, s36, 40960
    buffer_store_dwordx4 v[56:59], v240, s[16:19], s38 offen offset:2304 sc1
    v_mfma_f32_16x16x32_bf16 v[168:171], a[56:59], v[80:83], v[168:171]
    ds_read_b128 v[72:75], v224 offset:20480
    v_mfma_f32_16x16x32_bf16 v[172:175], a[60:63], v[80:83], v[172:175]
    ds_read_b128 v[76:79], v224 offset:22528
    v_mfma_f32_16x16x32_bf16 v[176:179], a[48:51], v[84:87], v[176:179]
    v_mfma_f32_16x16x32_bf16 v[180:183], a[52:55], v[84:87], v[180:183]
    v_mfma_f32_16x16x32_bf16 v[184:187], a[56:59], v[84:87], v[184:187]
    v_mfma_f32_16x16x32_bf16 v[188:191], a[60:63], v[84:87], v[188:191]
    v_mfma_f32_16x16x32_bf16 v[192:195], a[48:51], v[88:91], v[192:195]
    s_add_u32 m0, s31, 5120
    s_add_u32 s24, s27, 163840
    buffer_load_dwordx4 v245, s[12:15], s24 offen lds
    v_mfma_f32_16x16x32_bf16 v[196:199], a[52:55], v[88:91], v[196:199]
    v_mfma_f32_16x16x32_bf16 v[200:203], a[56:59], v[88:91], v[200:203]
    v_mfma_f32_16x16x32_bf16 v[204:207], a[60:63], v[88:91], v[204:207]
    v_mfma_f32_16x16x32_bf16 v[208:211], a[48:51], v[92:95], v[208:211]
    v_mfma_f32_16x16x32_bf16 v[212:215], a[52:55], v[92:95], v[212:215]
    v_mfma_f32_16x16x32_bf16 v[216:219], a[56:59], v[92:95], v[216:219]
    v_mfma_f32_16x16x32_bf16 v[220:223], a[60:63], v[92:95], v[220:223]
    s_waitcnt lgkmcnt(0)
    v_mfma_f32_16x16x32_bf16 v[160:163], a[64:67], v[64:67], v[160:163]
    ds_read_b128 v[80:83], v225 offset:16384
    v_mfma_f32_16x16x32_bf16 v[164:167], a[68:71], v[64:67], v[164:167]
    ds_read_b128 v[84:87], v225 offset:18432
    v_mfma_f32_16x16x32_bf16 v[168:171], a[72:75], v[64:67], v[168:171]
    ds_read_b128 v[88:91], v225 offset:20480
    v_mfma_f32_16x16x32_bf16 v[172:175], a[76:79], v[64:67], v[172:175]
    ds_read_b128 v[92:95], v225 offset:22528
    v_mfma_f32_16x16x32_bf16 v[176:179], a[64:67], v[68:71], v[176:179]
    v_mfma_f32_16x16x32_bf16 v[180:183], a[68:71], v[68:71], v[180:183]
    v_mfma_f32_16x16x32_bf16 v[184:187], a[72:75], v[68:71], v[184:187]
    v_mfma_f32_16x16x32_bf16 v[188:191], a[76:79], v[68:71], v[188:191]
    s_add_u32 s38, s36, 45056
    buffer_store_dwordx4 v[60:63], v240, s[16:19], s38 offen offset:256 sc1
    v_mfma_f32_16x16x32_bf16 v[192:195], a[64:67], v[72:75], v[192:195]
    s_add_u32 m0, s31, 6144
    s_add_u32 s24, s27, 196608
    buffer_load_dwordx4 v237, s[12:15], s24 offen lds
    v_mfma_f32_16x16x32_bf16 v[196:199], a[68:71], v[72:75], v[196:199]
    v_mfma_f32_16x16x32_bf16 v[200:203], a[72:75], v[72:75], v[200:203]
    v_mfma_f32_16x16x32_bf16 v[204:207], a[76:79], v[72:75], v[204:207]
    v_mfma_f32_16x16x32_bf16 v[208:211], a[64:67], v[76:79], v[208:211]
    v_mfma_f32_16x16x32_bf16 v[212:215], a[68:71], v[76:79], v[212:215]
    v_mfma_f32_16x16x32_bf16 v[216:219], a[72:75], v[76:79], v[216:219]
    v_mfma_f32_16x16x32_bf16 v[220:223], a[76:79], v[76:79], v[220:223]
    s_waitcnt lgkmcnt(0)
    v_mfma_f32_16x16x32_bf16 v[160:163], a[80:83], v[80:83], v[160:163]
    ds_read_b128 v[64:67], v224 offset:24576
    v_mfma_f32_16x16x32_bf16 v[164:167], a[84:87], v[80:83], v[164:167]
    ds_read_b128 v[68:71], v224 offset:26624
    v_mfma_f32_16x16x32_bf16 v[168:171], a[88:91], v[80:83], v[168:171]
    ds_read_b128 v[72:75], v224 offset:28672
    v_mfma_f32_16x16x32_bf16 v[172:175], a[92:95], v[80:83], v[172:175]
    ds_read_b128 v[76:79], v224 offset:30720
    v_mfma_f32_16x16x32_bf16 v[176:179], a[80:83], v[84:87], v[176:179]
    v_mfma_f32_16x16x32_bf16 v[180:183], a[84:87], v[84:87], v[180:183]
    v_mfma_f32_16x16x32_bf16 v[184:187], a[88:91], v[84:87], v[184:187]
    v_mfma_f32_16x16x32_bf16 v[188:191], a[92:95], v[84:87], v[188:191]
    v_mfma_f32_16x16x32_bf16 v[192:195], a[80:83], v[88:91], v[192:195]
    s_add_u32 m0, s31, 7168
    s_add_u32 s24, s27, 229376
    buffer_load_dwordx4 v237, s[12:15], s24 offen lds
    v_mfma_f32_16x16x32_bf16 v[196:199], a[84:87], v[88:91], v[196:199]
    v_mfma_f32_16x16x32_bf16 v[200:203], a[88:91], v[88:91], v[200:203]
    s_add_u32 s27, s27, 1048576
    s_and_b32 s27, s27, 0x407fffff
    s_cmp_eq_u32 s27, s7
    s_cselect_b32 s27, s43, s27
    v_mfma_f32_16x16x32_bf16 v[204:207], a[92:95], v[88:91], v[204:207]
    v_mfma_f32_16x16x32_bf16 v[208:211], a[80:83], v[92:95], v[208:211]
    v_mfma_f32_16x16x32_bf16 v[212:215], a[84:87], v[92:95], v[212:215]
    s_add_u32 s31, s31, 32768
    s_cmp_ge_u32 s31, 163840
    s_cselect_b32 s24, 98304, 0
    s_sub_u32 s31, s31, s24
    s_add_u32 s38, s36, 65536
    buffer_store_dwordx4 v[0:3], v240, s[16:19], s38 offen offset:2560 sc1
    v_mfma_f32_16x16x32_bf16 v[216:219], a[88:91], v[92:95], v[216:219]
    v_mfma_f32_16x16x32_bf16 v[220:223], a[92:95], v[92:95], v[220:223]
    s_waitcnt lgkmcnt(0)
    v_mfma_f32_16x16x32_bf16 v[160:163], a[96:99], v[64:67], v[160:163]
    ds_read_b128 v[80:83], v225 offset:24576
    v_mfma_f32_16x16x32_bf16 v[164:167], a[100:103], v[64:67], v[164:167]
    ds_read_b128 v[84:87], v225 offset:26624
    v_mfma_f32_16x16x32_bf16 v[168:171], a[104:107], v[64:67], v[168:171]
    ds_read_b128 v[88:91], v225 offset:28672
    v_mfma_f32_16x16x32_bf16 v[172:175], a[108:111], v[64:67], v[172:175]
    ds_read_b128 v[92:95], v225 offset:30720
    v_mfma_f32_16x16x32_bf16 v[176:179], a[96:99], v[68:71], v[176:179]
    v_mfma_f32_16x16x32_bf16 v[180:183], a[100:103], v[68:71], v[180:183]
    v_mfma_f32_16x16x32_bf16 v[184:187], a[104:107], v[68:71], v[184:187]
    v_mfma_f32_16x16x32_bf16 v[188:191], a[108:111], v[68:71], v[188:191]
    v_mfma_f32_16x16x32_bf16 v[192:195], a[96:99], v[72:75], v[192:195]
    v_mfma_f32_16x16x32_bf16 v[196:199], a[100:103], v[72:75], v[196:199]
    v_mfma_f32_16x16x32_bf16 v[200:203], a[104:107], v[72:75], v[200:203]
    v_mfma_f32_16x16x32_bf16 v[204:207], a[108:111], v[72:75], v[204:207]
    v_mfma_f32_16x16x32_bf16 v[208:211], a[96:99], v[76:79], v[208:211]
    v_mfma_f32_16x16x32_bf16 v[212:215], a[100:103], v[76:79], v[212:215]
    v_mfma_f32_16x16x32_bf16 v[216:219], a[104:107], v[76:79], v[216:219]
    v_mfma_f32_16x16x32_bf16 v[220:223], a[108:111], v[76:79], v[220:223]
    s_waitcnt vmcnt(9) lgkmcnt(0)
    s_barrier
    v_mfma_f32_16x16x32_bf16 v[160:163], a[112:115], v[80:83], v[160:163]
    ds_read_b128 v[64:67], v224 offset:32768
    v_mfma_f32_16x16x32_bf16 v[164:167], a[116:119], v[80:83], v[164:167]
    ds_read_b128 v[68:71], v224 offset:34816
    v_mfma_f32_16x16x32_bf16 v[168:171], a[120:123], v[80:83], v[168:171]
    ds_read_b128 v[72:75], v224 offset:36864
    s_add_u32 s38, s36, 69632
    buffer_store_dwordx4 v[4:7], v240, s[16:19], s38 offen offset:512 sc1
    v_mfma_f32_16x16x32_bf16 v[172:175], a[124:127], v[80:83], v[172:175]
    ds_read_b128 v[76:79], v224 offset:38912
    v_mfma_f32_16x16x32_bf16 v[176:179], a[112:115], v[84:87], v[176:179]
    v_mfma_f32_16x16x32_bf16 v[180:183], a[116:119], v[84:87], v[180:183]
    v_mfma_f32_16x16x32_bf16 v[184:187], a[120:123], v[84:87], v[184:187]
    v_mfma_f32_16x16x32_bf16 v[188:191], a[124:127], v[84:87], v[188:191]
    v_mfma_f32_16x16x32_bf16 v[192:195], a[112:115], v[88:91], v[192:195]
    v_mfma_f32_16x16x32_bf16 v[196:199], a[116:119], v[88:91], v[196:199]
    v_mfma_f32_16x16x32_bf16 v[200:203], a[120:123], v[88:91], v[200:203]
    v_mfma_f32_16x16x32_bf16 v[204:207], a[124:127], v[88:91], v[204:207]
    v_mfma_f32_16x16x32_bf16 v[208:211], a[112:115], v[92:95], v[208:211]
    v_mfma_f32_16x16x32_bf16 v[212:215], a[116:119], v[92:95], v[212:215]
    v_mfma_f32_16x16x32_bf16 v[216:219], a[120:123], v[92:95], v[216:219]
    v_mfma_f32_16x16x32_bf16 v[220:223], a[124:127], v[92:95], v[220:223]
    s_waitcnt lgkmcnt(0)
    v_mfma_f32_16x16x32_bf16 v[160:163], a[128:131], v[64:67], v[160:163]
    ds_read_b128 v[80:83], v225 offset:32768
    v_mfma_f32_16x16x32_bf16 v[164:167], a[132:135], v[64:67], v[164:167]
    ds_read_b128 v[84:87], v225 offset:34816
    v_mfma_f32_16x16x32_bf16 v[168:171], a[136:139], v[64:67], v[168:171]
    ds_read_b128 v[88:91], v225 offset:36864
    v_mfma_f32_16x16x32_bf16 v[172:175], a[140:143], v[64:67], v[172:175]
    ds_read_b128 v[92:95], v225 offset:38912
    v_mfma_f32_16x16x32_bf16 v[176:179], a[128:131], v[68:71], v[176:179]
    v_mfma_f32_16x16x32_bf16 v[180:183], a[132:135], v[68:71], v[180:183]
    v_mfma_f32_16x16x32_bf16 v[184:187], a[136:139], v[68:71], v[184:187]
    v_mfma_f32_16x16x32_bf16 v[188:191], a[140:143], v[68:71], v[188:191]
    v_mfma_f32_16x16x32_bf16 v[192:195], a[128:131], v[72:75], v[192:195]
    buffer_load_dword v254, off, s[88:91], s39 sc1
    s_add_u32 s38, s36, 65536
    buffer_store_dwordx4 v[8:11], v240, s[16:19], s38 offen offset:3584 sc1
    v_mfma_f32_16x16x32_bf16 v[196:199], a[132:135], v[72:75], v[196:199]
    v_mfma_f32_16x16x32_bf16 v[200:203], a[136:139], v[72:75], v[200:203]
    v_mfma_f32_16x16x32_bf16 v[204:207], a[140:143], v[72:75], v[204:207]
    v_mfma_f32_16x16x32_bf16 v[208:211], a[128:131], v[76:79], v[208:211]
    v_mfma_f32_16x16x32_bf16 v[212:215], a[132:135], v[76:79], v[212:215]
    v_mfma_f32_16x16x32_bf16 v[216:219], a[136:139], v[76:79], v[216:219]
    v_mfma_f32_16x16x32_bf16 v[220:223], a[140:143], v[76:79], v[220:223]
    s_waitcnt lgkmcnt(0)
    v_mfma_f32_16x16x32_bf16 v[160:163], a[144:147], v[80:83], v[160:163]
    ds_read_b128 v[64:67], v224 offset:40960
    v_mfma_f32_16x16x32_bf16 v[164:167], a[148:151], v[80:83], v[164:167]
    ds_read_b128 v[68:71], v224 offset:43008
    v_mfma_f32_16x16x32_bf16 v[168:171], a[152:155], v[80:83], v[168:171]
    ds_read_b128 v[72:75], v224 offset:45056
    v_mfma_f32_16x16x32_bf16 v[172:175], a[156:159], v[80:83], v[172:175]
    ds_read_b128 v[76:79], v224 offset:47104
    v_mfma_f32_16x16x32_bf16 v[176:179], a[144:147], v[84:87], v[176:179]
    v_mfma_f32_16x16x32_bf16 v[180:183], a[148:151], v[84:87], v[180:183]
    v_mfma_f32_16x16x32_bf16 v[184:187], a[152:155], v[84:87], v[184:187]
    v_mfma_f32_16x16x32_bf16 v[188:191], a[156:159], v[84:87], v[188:191]
    v_mfma_f32_16x16x32_bf16 v[192:195], a[144:147], v[88:91], v[192:195]
    v_mfma_f32_16x16x32_bf16 v[196:199], a[148:151], v[88:91], v[196:199]
    v_mfma_f32_16x16x32_bf16 v[200:203], a[152:155], v[88:91], v[200:203]
    v_mfma_f32_16x16x32_bf16 v[204:207], a[156:159], v[88:91], v[204:207]
    v_mfma_f32_16x16x32_bf16 v[208:211], a[144:147], v[92:95], v[208:211]
    v_mfma_f32_16x16x32_bf16 v[212:215], a[148:151], v[92:95], v[212:215]
    s_add_u32 s38, s36, 69632
    buffer_store_dwordx4 v[12:15], v240, s[16:19], s38 offen offset:1536 sc1
    v_mfma_f32_16x16x32_bf16 v[216:219], a[152:155], v[92:95], v[216:219]
    v_mfma_f32_16x16x32_bf16 v[220:223], a[156:159], v[92:95], v[220:223]
    s_waitcnt lgkmcnt(0)
    v_mfma_f32_16x16x32_bf16 v[160:163], a[160:163], v[64:67], v[160:163]
    ds_read_b128 v[80:83], v225 offset:40960
    v_mfma_f32_16x16x32_bf16 v[164:167], a[164:167], v[64:67], v[164:167]
    ds_read_b128 v[84:87], v225 offset:43008
    v_mfma_f32_16x16x32_bf16 v[168:171], a[168:171], v[64:67], v[168:171]
    ds_read_b128 v[88:91], v225 offset:45056
    v_mfma_f32_16x16x32_bf16 v[172:175], a[172:175], v[64:67], v[172:175]
    ds_read_b128 v[92:95], v225 offset:47104
    v_mfma_f32_16x16x32_bf16 v[176:179], a[160:163], v[68:71], v[176:179]
    v_mfma_f32_16x16x32_bf16 v[180:183], a[164:167], v[68:71], v[180:183]
    v_mfma_f32_16x16x32_bf16 v[184:187], a[168:171], v[68:71], v[184:187]
    v_mfma_f32_16x16x32_bf16 v[188:191], a[172:175], v[68:71], v[188:191]
    v_mfma_f32_16x16x32_bf16 v[192:195], a[160:163], v[72:75], v[192:195]
    v_mfma_f32_16x16x32_bf16 v[196:199], a[164:167], v[72:75], v[196:199]
    v_mfma_f32_16x16x32_bf16 v[200:203], a[168:171], v[72:75], v[200:203]
    v_mfma_f32_16x16x32_bf16 v[204:207], a[172:175], v[72:75], v[204:207]
    v_mfma_f32_16x16x32_bf16 v[208:211], a[160:163], v[76:79], v[208:211]
    v_mfma_f32_16x16x32_bf16 v[212:215], a[164:167], v[76:79], v[212:215]
    v_mfma_f32_16x16x32_bf16 v[216:219], a[168:171], v[76:79], v[216:219]
    v_mfma_f32_16x16x32_bf16 v[220:223], a[172:175], v[76:79], v[220:223]
    s_waitcnt lgkmcnt(0)
    v_mfma_f32_16x16x32_bf16 v[160:163], a[176:179], v[80:83], v[160:163]
    ds_read_b128 v[64:67], v224 offset:49152
    v_mfma_f32_16x16x32_bf16 v[164:167], a[180:183], v[80:83], v[164:167]
    ds_read_b128 v[68:71], v224 offset:51200
    v_mfma_f32_16x16x32_bf16 v[168:171], a[184:187], v[80:83], v[168:171]
    ds_read_b128 v[72:75], v224 offset:53248
    v_mfma_f32_16x16x32_bf16 v[172:175], a[188:191], v[80:83], v[172:175]
    ds_read_b128 v[76:79], v224 offset:55296
    s_add_u32 s38, s36, 73728
    buffer_store_dwordx4 v[16:19], v240, s[16:19], s38 offen offset:2560 sc1
    v_mfma_f32_16x16x32_bf16 v[176:179], a[176:179], v[84:87], v[176:179]
    v_mfma_f32_16x16x32_bf16 v[180:183], a[180:183], v[84:87], v[180:183]
    v_mfma_f32_16x16x32_bf16 v[184:187], a[184:187], v[84:87], v[184:187]
    v_mfma_f32_16x16x32_bf16 v[188:191], a[188:191], v[84:87], v[188:191]
    v_mfma_f32_16x16x32_bf16 v[192:195], a[176:179], v[88:91], v[192:195]
    v_mfma_f32_16x16x32_bf16 v[196:199], a[180:183], v[88:91], v[196:199]
    v_mfma_f32_16x16x32_bf16 v[200:203], a[184:187], v[88:91], v[200:203]
    v_mfma_f32_16x16x32_bf16 v[204:207], a[188:191], v[88:91], v[204:207]
    v_mfma_f32_16x16x32_bf16 v[208:211], a[176:179], v[92:95], v[208:211]
    v_mfma_f32_16x16x32_bf16 v[212:215], a[180:183], v[92:95], v[212:215]
    v_mfma_f32_16x16x32_bf16 v[216:219], a[184:187], v[92:95], v[216:219]
    v_mfma_f32_16x16x32_bf16 v[220:223], a[188:191], v[92:95], v[220:223]
    s_waitcnt vmcnt(3)
    v_readfirstlane_b32 s24, v254
    s_lshl_b32 s25, s3, 16
    s_add_u32 s24, s24, s25
    s_cmp_ge_u32 s24, 32
    s_cbranch_scc0 kf_spin43
kf_spinr44:
    s_waitcnt lgkmcnt(0)
    s_barrier
    v_mfma_f32_16x16x32_bf16 v[160:163], a[192:195], v[64:67], v[160:163]
    ds_read_b128 v[80:83], v225 offset:49152
    v_mfma_f32_16x16x32_bf16 v[164:167], a[196:199], v[64:67], v[164:167]
    ds_read_b128 v[84:87], v225 offset:51200
    v_mfma_f32_16x16x32_bf16 v[168:171], a[200:203], v[64:67], v[168:171]
    ds_read_b128 v[88:91], v225 offset:53248
    v_mfma_f32_16x16x32_bf16 v[172:175], a[204:207], v[64:67], v[172:175]
    ds_read_b128 v[92:95], v225 offset:55296
    v_mfma_f32_16x16x32_bf16 v[176:179], a[192:195], v[68:71], v[176:179]
    v_mfma_f32_16x16x32_bf16 v[180:183], a[196:199], v[68:71], v[180:183]
    v_mfma_f32_16x16x32_bf16 v[184:187], a[200:203], v[68:71], v[184:187]
    v_mfma_f32_16x16x32_bf16 v[188:191], a[204:207], v[68:71], v[188:191]
    v_mfma_f32_16x16x32_bf16 v[192:195], a[192:195], v[72:75], v[192:195]
    buffer_load_dwordx4 a[128:131], v248, s[8:11], s28 offen offset:0 sc1
    s_add_u32 s38, s36, 77824
    buffer_store_dwordx4 v[20:23], v240, s[16:19], s38 offen offset:512 sc1
    v_mfma_f32_16x16x32_bf16 v[196:199], a[196:199], v[72:75], v[196:199]
    v_mfma_f32_16x16x32_bf16 v[200:203], a[200:203], v[72:75], v[200:203]
    buffer_load_dwordx4 a[132:135], v248, s[8:11], s29 offen offset:0 sc1
    v_mfma_f32_16x16x32_bf16 v[204:207], a[204:207], v[72:75], v[204:207]
    v_mfma_f32_16x16x32_bf16 v[208:211], a[192:195], v[76:79], v[208:211]
    v_mfma_f32_16x16x32_bf16 v[212:215], a[196:199], v[76:79], v[212:215]
    buffer_load_dwordx4 a[136:139], v249, s[8:11], s28 offen offset:0 sc1
    v_mfma_f32_16x16x32_bf16 v[216:219], a[200:203], v[76:79], v[216:219]
    v_mfma_f32_16x16x32_bf16 v[220:223], a[204:207], v[76:79], v[220:223]
    s_waitcnt lgkmcnt(0)
    v_mfma_f32_16x16x32_bf16 v[160:163], a[208:211], v[80:83], v[160:163]
    ds_read_b128 v[64:67], v224 offset:57344
    v_mfma_f32_16x16x32_bf16 v[164:167], a[212:215], v[80:83], v[164:167]
    ds_read_b128 v[68:71], v224 offset:59392
    v_mfma_f32_16x16x32_bf16 v[168:171], a[216:219], v[80:83], v[168:171]
    ds_read_b128 v[72:75], v224 offset:61440
    v_mfma_f32_16x16x32_bf16 v[172:175], a[220:223], v[80:83], v[172:175]
    ds_read_b128 v[76:79], v224 offset:63488
    v_mfma_f32_16x16x32_bf16 v[176:179], a[208:211], v[84:87], v[176:179]
    v_mfma_f32_16x16x32_bf16 v[180:183], a[212:215], v[84:87], v[180:183]
    v_mfma_f32_16x16x32_bf16 v[184:187], a[216:219], v[84:87], v[184:187]
    v_mfma_f32_16x16x32_bf16 v[188:191], a[220:223], v[84:87], v[188:191]
    v_mfma_f32_16x16x32_bf16 v[192:195], a[208:211], v[88:91], v[192:195]
    buffer_load_dwordx4 a[140:143], v249, s[8:11], s29 offen offset:0 sc1
    v_mfma_f32_16x16x32_bf16 v[196:199], a[212:215], v[88:91], v[196:199]
    v_mfma_f32_16x16x32_bf16 v[200:203], a[216:219], v[88:91], v[200:203]
    buffer_load_dwordx4 a[144:147], v248, s[8:11], s28 offen offset:1024 sc1
    v_mfma_f32_16x16x32_bf16 v[204:207], a[220:223], v[88:91], v[204:207]
    v_mfma_f32_16x16x32_bf16 v[208:211], a[208:211], v[92:95], v[208:211]
    v_mfma_f32_16x16x32_bf16 v[212:215], a[212:215], v[92:95], v[212:215]
    buffer_load_dwordx4 a[148:151], v248, s[8:11], s29 offen offset:1024 sc1
    v_mfma_f32_16x16x32_bf16 v[216:219], a[216:219], v[92:95], v[216:219]
    s_add_u32 s38, s36, 73728
    buffer_store_dwordx4 v[24:27], v240, s[16:19], s38 offen offset:3584 sc1
    v_mfma_f32_16x16x32_bf16 v[220:223], a[220:223], v[92:95], v[220:223]
    s_waitcnt lgkmcnt(0)
    v_mfma_f32_16x16x32_bf16 v[160:163], a[224:227], v[64:67], v[160:163]
    ds_read_b128 v[80:83], v225 offset:57344
    v_mfma_f32_16x16x32_bf16 v[164:167], a[228:231], v[64:67], v[164:167]
    ds_read_b128 v[84:87], v225 offset:59392
    v_mfma_f32_16x16x32_bf16 v[168:171], a[232:235], v[64:67], v[168:171]
    ds_read_b128 v[88:91], v225 offset:61440
    v_mfma_f32_16x16x32_bf16 v[172:175], a[236:239], v[64:67], v[172:175]
    ds_read_b128 v[92:95], v225 offset:63488
    v_mfma_f32_16x16x32_bf16 v[176:179], a[224:227], v[68:71], v[176:179]
    v_mfma_f32_16x16x32_bf16 v[180:183], a[228:231], v[68:71], v[180:183]
    v_mfma_f32_16x16x32_bf16 v[184:187], a[232:235], v[68:71], v[184:187]
    v_mfma_f32_16x16x32_bf16 v[188:191], a[236:239], v[68:71], v[188:191]
    v_mfma_f32_16x16x32_bf16 v[192:195], a[224:227], v[72:75], v[192:195]
    buffer_load_dwordx4 a[152:155], v249, s[8:11], s28 offen offset:1024 sc1
    v_mfma_f32_16x16x32_bf16 v[196:199], a[228:231], v[72:75], v[196:199]
    v_mfma_f32_16x16x32_bf16 v[200:203], a[232:235], v[72:75], v[200:203]
    buffer_load_dwordx4 a[156:159], v249, s[8:11], s29 offen offset:1024 sc1
    v_mfma_f32_16x16x32_bf16 v[204:207], a[236:239], v[72:75], v[204:207]
    v_mfma_f32_16x16x32_bf16 v[208:211], a[224:227], v[76:79], v[208:211]
    v_mfma_f32_16x16x32_bf16 v[212:215], a[228:231], v[76:79], v[212:215]
    buffer_load_dwordx4 a[160:163], v248, s[8:11], s28 offen offset:2048 sc1
    v_mfma_f32_16x16x32_bf16 v[216:219], a[232:235], v[76:79], v[216:219]
    v_mfma_f32_16x16x32_bf16 v[220:223], a[236:239], v[76:79], v[220:223]
    s_waitcnt vmcnt(38) lgkmcnt(0)
    s_barrier
    v_mfma_f32_16x16x32_bf16 v[160:163], a[240:243], v[80:83], v[160:163]
    ds_read_b64_tr_b16 a[192:193], v246 offset:0
    v_mfma_f32_16x16x32_bf16 v[164:167], a[244:247], v[80:83], v[164:167]
    ds_read_b64_tr_b16 a[194:195], v246 offset:1024
    v_mfma_f32_16x16x32_bf16 v[168:171], a[248:251], v[80:83], v[168:171]
    ds_read_b64_tr_b16 a[196:197], v238 offset:0
    v_mfma_f32_16x16x32_bf16 v[172:175], a[252:255], v[80:83], v[172:175]
    ds_read_b64_tr_b16 a[198:199], v238 offset:1024
    v_mfma_f32_16x16x32_bf16 v[176:179], a[240:243], v[84:87], v[176:179]
    ds_read_b64_tr_b16 a[200:201], v246 offset:256
    s_add_u32 s38, s36, 77824
    buffer_store_dwordx4 v[28:31], v240, s[16:19], s38 offen offset:1536 sc1
    v_mfma_f32_16x16x32_bf16 v[180:183], a[244:247], v[84:87], v[180:183]
    ds_read_b64_tr_b16 a[202:203], v246 offset:1280
    v_mfma_f32_16x16x32_bf16 v[184:187], a[248:251], v[84:87], v[184:187]
    ds_read_b64_tr_b16 a[204:205], v238 offset:256
    v_mfma_f32_16x16x32_bf16 v[188:191], a[252:255], v[84:87], v[188:191]
    ds_read_b64_tr_b16 a[206:207], v238 offset:1280
    v_mfma_f32_16x16x32_bf16 v[192:195], a[240:243], v[88:91], v[192:195]
    buffer_load_dwordx4 a[164:167], v248, s[8:11], s29 offen offset:2048 sc1
    v_mfma_f32_16x16x32_bf16 v[196:199], a[244:247], v[88:91], v[196:199]
    v_cvt_pk_bf16_f32 v32, v160, v161
    v_cvt_pk_bf16_f32 v33, v162, v163
    v_mfma_f32_16x16x32_bf16 v[200:203], a[248:251], v[88:91], v[200:203]
    buffer_load_dwordx4 a[168:171], v249, s[8:11], s28 offen offset:2048 sc1
    v_cvt_pk_bf16_f32 v34, v164, v165
    v_cvt_pk_bf16_f32 v35, v166, v167
    v_mfma_f32_16x16x32_bf16 v[204:207], a[252:255], v[88:91], v[204:207]
    v_cvt_pk_bf16_f32 v36, v168, v169
    v_cvt_pk_bf16_f32 v37, v170, v171
    v_mfma_f32_16x16x32_bf16 v[208:211], a[240:243], v[92:95], v[208:211]
    v_cvt_pk_bf16_f32 v38, v172, v173
    v_cvt_pk_bf16_f32 v39, v174, v175
    v_mfma_f32_16x16x32_bf16 v[212:215], a[244:247], v[92:95], v[212:215]
    buffer_load_dwordx4 a[172:175], v249, s[8:11], s29 offen offset:2048 sc1
    v_cvt_pk_bf16_f32 v40, v176, v177
    v_cvt_pk_bf16_f32 v41, v178, v179
    v_mfma_f32_16x16x32_bf16 v[216:219], a[248:251], v[92:95], v[216:219]
    v_cvt_pk_bf16_f32 v42, v180, v181
    v_cvt_pk_bf16_f32 v43, v182, v183
    v_mfma_f32_16x16x32_bf16 v[220:223], a[252:255], v[92:95], v[220:223]
    v_cvt_pk_bf16_f32 v44, v184, v185
    v_cvt_pk_bf16_f32 v45, v186, v187
    s_nop 3
    v_cvt_pk_bf16_f32 v46, v188, v189
    v_cvt_pk_bf16_f32 v47, v190, v191
    v_cvt_pk_bf16_f32 v48, v192, v193
    v_cvt_pk_bf16_f32 v49, v194, v195
    v_cvt_pk_bf16_f32 v50, v196, v197
    v_cvt_pk_bf16_f32 v51, v198, v199
    v_cvt_pk_bf16_f32 v52, v200, v201
    v_cvt_pk_bf16_f32 v53, v202, v203
    v_cvt_pk_bf16_f32 v54, v204, v205
    v_cvt_pk_bf16_f32 v55, v206, v207
    v_cvt_pk_bf16_f32 v56, v208, v209
    v_cvt_pk_bf16_f32 v57, v210, v211
    v_cvt_pk_bf16_f32 v58, v212, v213
    v_cvt_pk_bf16_f32 v59, v214, v215
    v_cvt_pk_bf16_f32 v60, v216, v217
    v_cvt_pk_bf16_f32 v61, v218, v219
    v_cvt_pk_bf16_f32 v62, v220, v221
    v_cvt_pk_bf16_f32 v63, v222, v223
    s_add_u32 s80, s36, 102144
    s_add_u32 s81, s36, 104192
    s_add_u32 s82, s36, 103168
    s_add_u32 s83, s36, 105216
    s_add_u32 s84, s36, 110336
    s_add_u32 s85, s36, 112384
    s_add_u32 s86, s36, 111360
    s_add_u32 s87, s36, 113408
    s_branch ka_Q
ka_V:
    s_waitcnt lgkmcnt(0)
    v_mfma_f32_16x16x32_bf16 v[96:99], v[64:67], a[0:3], 0
    ds_read_b128 v[80:83], v224 offset:8192
    v_mfma_f32_16x16x32_bf16 v[100:103], v[68:71], a[0:3], 0
    ds_read_b128 v[84:87], v224 offset:10240
    v_mfma_f32_16x16x32_bf16 v[104:107], v[64:67], a[4:7], 0
    ds_read_b128 v[88:91], v224 offset:12288
    v_mfma_f32_16x16x32_bf16 v[108:111], v[68:71], a[4:7], 0
    ds_read_b128 v[92:95], v224 offset:14336
    v_mfma_f32_16x16x32_bf16 v[112:115], v[64:67], a[8:11], 0
    ds_read_b64_tr_b16 a[16:17], v228 offset:4096
    v_mfma_f32_16x16x32_bf16 v[116:119], v[68:71], a[8:11], 0
    ds_read_b64_tr_b16 a[18:19], v228 offset:4608
    v_mfma_f32_16x16x32_bf16 v[120:123], v[64:67], a[12:15], 0
    ds_read_b64_tr_b16 a[20:21], v229 offset:4096
    v_mfma_f32_16x16x32_bf16 v[124:127], v[68:71], a[12:15], 0
    ds_read_b64_tr_b16 a[22:23], v229 offset:4608
    v_mfma_f32_16x16x32_bf16 v[128:131], v[72:75], a[0:3], 0
    s_add_u32 m0, s35, 16384
    s_and_b32 s33, s82, 1023
    s_lshl_b32 s33, s33, 12
    buffer_load_dwordx4 v234, s[48:51], s33 offen lds
    v_mfma_f32_16x16x32_bf16 v[132:135], v[76:79], a[0:3], 0
    buffer_load_dwordx4 v235, s[48:51], s33 offen offset:1024 lds
    v_mfma_f32_16x16x32_bf16 v[136:139], v[72:75], a[4:7], 0
    s_add_u32 m0, s35, 18432
    s_add_u32 s33, s33, 131072
    buffer_load_dwordx4 v234, s[48:51], s33 offen lds
    v_mfma_f32_16x16x32_bf16 v[140:143], v[76:79], a[4:7], 0
    v_mfma_f32_16x16x32_bf16 v[144:147], v[72:75], a[8:11], 0
    buffer_load_dwordx4 v235, s[48:51], s33 offen offset:1024 lds
    v_mfma_f32_16x16x32_bf16 v[148:151], v[76:79], a[8:11], 0
    buffer_load_dwordx4 v[0:3], v236, s[52:55], 0 offen offset:0
    v_mfma_f32_16x16x32_bf16 v[152:155], v[72:75], a[12:15], 0
    buffer_load_dwordx4 v[4:7], v236, s[52:55], 0 offen offset:512
    v_mfma_f32_16x16x32_bf16 v[156:159], v[76:79], a[12:15], 0
    s_waitcnt lgkmcnt(0)
    v_mfma_f32_16x16x32_bf16 v[160:163], v[80:83], a[0:3], 0
    ds_read_b128 v[64:67], v225 offset:0
    v_mfma_f32_16x16x32_bf16 v[164:167], v[84:87], a[0:3], 0
    ds_read_b128 v[68:71], v225 offset:2048
    v_mfma_f32_16x16x32_bf16 v[168:171], v[80:83], a[4:7], 0
    ds_read_b128 v[72:75], v225 offset:4096
    v_mfma_f32_16x16x32_bf16 v[172:175], v[84:87], a[4:7], 0
    ds_read_b128 v[76:79], v225 offset:6144
    v_mfma_f32_16x16x32_bf16 v[176:179], v[80:83], a[8:11], 0
    ds_read_b64_tr_b16 a[24:25], v230 offset:4096
    v_mfma_f32_16x16x32_bf16 v[180:183], v[84:87], a[8:11], 0
    ds_read_b64_tr_b16 a[26:27], v230 offset:4608
    v_mfma_f32_16x16x32_bf16 v[184:187], v[80:83], a[12:15], 0
    ds_read_b64_tr_b16 a[28:29], v231 offset:4096
    v_mfma_f32_16x16x32_bf16 v[188:191], v[84:87], a[12:15], 0
    ds_read_b64_tr_b16 a[30:31], v231 offset:4608
    v_mfma_f32_16x16x32_bf16 v[192:195], v[88:91], a[0:3], 0
    s_add_u32 m0, s35, 20480
    s_add_u32 s33, s33, 131072
    buffer_load_dwordx4 v234, s[48:51], s33 offen lds
    v_mfma_f32_16x16x32_bf16 v[196:199], v[92:95], a[0:3], 0
    buffer_load_dwordx4 v235, s[48:51], s33 offen offset:1024 lds
    v_mfma_f32_16x16x32_bf16 v[200:203], v[88:91], a[4:7], 0
    s_add_u32 m0, s35, 22528
    s_add_u32 s33, s33, 131072
    buffer_load_dwordx4 v234, s[48:51], s33 offen lds
    v_mfma_f32_16x16x32_bf16 v[204:207], v[92:95], a[4:7], 0
    v_mfma_f32_16x16x32_bf16 v[208:211], v[88:91], a[8:11], 0
    buffer_load_dwordx4 v235, s[48:51], s33 offen offset:1024 lds
    v_mfma_f32_16x16x32_bf16 v[212:215], v[92:95], a[8:11], 0
    buffer_load_dwordx4 v[8:11], v236, s[52:55], 0 offen offset:1024
    v_mfma_f32_16x16x32_bf16 v[216:219], v[88:91], a[12:15], 0
    buffer_load_dwordx4 v[12:15], v236, s[52:55], 0 offen offset:1536
    v_mfma_f32_16x16x32_bf16 v[220:223], v[92:95], a[12:15], 0
    s_waitcnt vmcnt(17) lgkmcnt(0)
    v_mfma_f32_16x16x32_bf16 v[96:99], v[64:67], a[16:19], v[96:99]
    ds_read_b128 v[80:83], v225 offset:8192
    v_mfma_f32_16x16x32_bf16 v[100:103], v[68:71], a[16:19], v[100:103]
    ds_read_b128 v[84:87], v225 offset:10240
    v_mfma_f32_16x16x32_bf16 v[104:107], v[64:67], a[20:23], v[104:107]
    ds_read_b128 v[88:91], v225 offset:12288
    v_mfma_f32_16x16x32_bf16 v[108:111], v[68:71], a[20:23], v[108:111]
    ds_read_b128 v[92:95], v225 offset:14336
    v_mfma_f32_16x16x32_bf16 v[112:115], v[64:67], a[24:27], v[112:115]
    ds_read_b64_tr_b16 a[32:33], v228 offset:8192
    v_mfma_f32_16x16x32_bf16 v[116:119], v[68:71], a[24:27], v[116:119]
    ds_read_b64_tr_b16 a[34:35], v228 offset:8704
    v_mfma_f32_16x16x32_bf16 v[120:123], v[64:67], a[28:31], v[120:123]
    ds_read_b64_tr_b16 a[36:37], v229 offset:8192
    v_mfma_f32_16x16x32_bf16 v[124:127], v[68:71], a[28:31], v[124:127]
    ds_read_b64_tr_b16 a[38:39], v229 offset:8704
    v_mfma_f32_16x16x32_bf16 v[128:131], v[72:75], a[16:19], v[128:131]
    s_add_u32 m0, s34, 32768
    s_add_u32 s37, s82, 0
    buffer_load_dwordx4 v232, s[44:47], s37 offen lds
    v_mfma_f32_16x16x32_bf16 v[132:135], v[76:79], a[16:19], v[132:135]
    buffer_load_dwordx4 v233, s[44:47], s37 offen offset:1024 lds
    v_mfma_f32_16x16x32_bf16 v[136:139], v[72:75], a[20:23], v[136:139]
    s_add_u32 m0, s34, 40960
    s_add_u32 s37, s82, 65536
    buffer_load_dwordx4 v232, s[44:47], s37 offen lds
    v_mfma_f32_16x16x32_bf16 v[140:143], v[76:79], a[20:23], v[140:143]
    buffer_load_dwordx4 v233, s[44:47], s37 offen offset:1024 lds
    v_mfma_f32_16x16x32_bf16 v[144:147], v[72:75], a[24:27], v[144:147]
    s_add_u32 m0, s35, 0
    s_and_b32 s33, s83, 1023
    s_lshl_b32 s33, s33, 12
    buffer_load_dwordx4 v234, s[48:51], s33 offen lds
    v_mfma_f32_16x16x32_bf16 v[148:151], v[76:79], a[24:27], v[148:151]
    buffer_load_dwordx4 v235, s[48:51], s33 offen offset:1024 lds
    v_mfma_f32_16x16x32_bf16 v[152:155], v[72:75], a[28:31], v[152:155]
    s_add_u32 m0, s35, 2048
    s_add_u32 s33, s33, 131072
    buffer_load_dwordx4 v234, s[48:51], s33 offen lds
    v_mfma_f32_16x16x32_bf16 v[156:159], v[76:79], a[28:31], v[156:159]
    buffer_load_dwordx4 v235, s[48:51], s33 offen offset:1024 lds
    s_waitcnt vmcnt(21) lgkmcnt(0)
    s_barrier
    v_mfma_f32_16x16x32_bf16 v[160:163], v[80:83], a[16:19], v[160:163]
    ds_read_b128 v[64:67], v224 offset:16384
    v_mfma_f32_16x16x32_bf16 v[164:167], v[84:87], a[16:19], v[164:167]
    ds_read_b128 v[68:71], v224 offset:18432
    v_mfma_f32_16x16x32_bf16 v[168:171], v[80:83], a[20:23], v[168:171]
    ds_read_b128 v[72:75], v224 offset:20480
    v_mfma_f32_16x16x32_bf16 v[172:175], v[84:87], a[20:23], v[172:175]
    ds_read_b128 v[76:79], v224 offset:22528
    v_mfma_f32_16x16x32_bf16 v[176:179], v[80:83], a[24:27], v[176:179]
    ds_read_b64_tr_b16 a[40:41], v230 offset:8192
    v_mfma_f32_16x16x32_bf16 v[180:183], v[84:87], a[24:27], v[180:183]
    ds_read_b64_tr_b16 a[42:43], v230 offset:8704
    v_mfma_f32_16x16x32_bf16 v[184:187], v[80:83], a[28:31], v[184:187]
    ds_read_b64_tr_b16 a[44:45], v231 offset:8192
    v_mfma_f32_16x16x32_bf16 v[188:191], v[84:87], a[28:31], v[188:191]
    ds_read_b64_tr_b16 a[46:47], v231 offset:8704
    v_mfma_f32_16x16x32_bf16 v[192:195], v[88:91], a[16:19], v[192:195]
    s_add_u32 m0, s34, 49152
    s_add_u32 s37, s83, 0
    buffer_load_dwordx4 v232, s[44:47], s37 offen lds
    v_mfma_f32_16x16x32_bf16 v[196:199], v[92:95], a[16:19], v[196:199]
    buffer_load_dwordx4 v233, s[44:47], s37 offen offset:1024 lds
    v_mfma_f32_16x16x32_bf16 v[200:203], v[88:91], a[20:23], v[200:203]
    s_add_u32 m0, s34, 57344
    s_add_u32 s37, s83, 65536
    buffer_load_dwordx4 v232, s[44:47], s37 offen lds
    v_mfma_f32_16x16x32_bf16 v[204:207], v[92:95], a[20:23], v[204:207]
    v_mfma_f32_16x16x32_bf16 v[208:211], v[88:91], a[24:27], v[208:211]
    buffer_load_dwordx4 v233, s[44:47], s37 offen offset:1024 lds
    v_mfma_f32_16x16x32_bf16 v[212:215], v[92:95], a[24:27], v[212:215]
    s_add_u32 m0, s34, 0
    s_add_u32 s37, s84, 0
    buffer_load_dwordx4 v232, s[44:47], s37 offen lds
    v_mfma_f32_16x16x32_bf16 v[216:219], v[88:91], a[28:31], v[216:219]
    buffer_load_dwordx4 v233, s[44:47], s37 offen offset:1024 lds
    v_mfma_f32_16x16x32_bf16 v[220:223], v[92:95], a[28:31], v[220:223]
    s_waitcnt lgkmcnt(0)
    v_mfma_f32_16x16x32_bf16 v[96:99], v[64:67], a[32:35], v[96:99]
    ds_read_b128 v[80:83], v224 offset:24576
    v_mfma_f32_16x16x32_bf16 v[100:103], v[68:71], a[32:35], v[100:103]
    ds_read_b128 v[84:87], v224 offset:26624
    v_mfma_f32_16x16x32_bf16 v[104:107], v[64:67], a[36:39], v[104:107]
    ds_read_b128 v[88:91], v224 offset:28672
    v_mfma_f32_16x16x32_bf16 v[108:111], v[68:71], a[36:39], v[108:111]
    ds_read_b128 v[92:95], v224 offset:30720
    v_mfma_f32_16x16x32_bf16 v[112:115], v[64:67], a[40:43], v[112:115]
    ds_read_b64_tr_b16 a[48:49], v228 offset:12288
    v_mfma_f32_16x16x32_bf16 v[116:119], v[68:71], a[40:43], v[116:119]
    ds_read_b64_tr_b16 a[50:51], v228 offset:12800
    v_mfma_f32_16x16x32_bf16 v[120:123], v[64:67], a[44:47], v[120:123]
    ds_read_b64_tr_b16 a[52:53], v229 offset:12288
    v_mfma_f32_16x16x32_bf16 v[124:127], v[68:71], a[44:47], v[124:127]
    ds_read_b64_tr_b16 a[54:55], v229 offset:12800
    v_mfma_f32_16x16x32_bf16 v[128:131], v[72:75], a[32:35], v[128:131]
    s_add_u32 m0, s35, 4096
    s_add_u32 s33, s33, 131072
    buffer_load_dwordx4 v234, s[48:51], s33 offen lds
    v_mfma_f32_16x16x32_bf16 v[132:135], v[76:79], a[32:35], v[132:135]
    v_mfma_f32_16x16x32_bf16 v[136:139], v[72:75], a[36:39], v[136:139]
    buffer_load_dwordx4 v235, s[48:51], s33 offen offset:1024 lds
    v_mfma_f32_16x16x32_bf16 v[140:143], v[76:79], a[36:39], v[140:143]
    v_mfma_f32_16x16x32_bf16 v[144:147], v[72:75], a[40:43], v[144:147]
    s_add_u32 m0, s35, 6144
    s_add_u32 s33, s33, 131072
    buffer_load_dwordx4 v234, s[48:51], s33 offen lds
    v_mfma_f32_16x16x32_bf16 v[148:151], v[76:79], a[40:43], v[148:151]
    v_mfma_f32_16x16x32_bf16 v[152:155], v[72:75], a[44:47], v[152:155]
    buffer_load_dwordx4 v235, s[48:51], s33 offen offset:1024 lds
    v_mfma_f32_16x16x32_bf16 v[156:159], v[76:79], a[44:47], v[156:159]
    s_waitcnt lgkmcnt(0)
    v_mfma_f32_16x16x32_bf16 v[160:163], v[80:83], a[32:35], v[160:163]
    ds_read_b128 v[64:67], v225 offset:16384
    v_mfma_f32_16x16x32_bf16 v[164:167], v[84:87], a[32:35], v[164:167]
    ds_read_b128 v[68:71], v225 offset:18432
    v_mfma_f32_16x16x32_bf16 v[168:171], v[80:83], a[36:39], v[168:171]
    ds_read_b128 v[72:75], v225 offset:20480
    v_mfma_f32_16x16x32_bf16 v[172:175], v[84:87], a[36:39], v[172:175]
    ds_read_b128 v[76:79], v225 offset:22528
    v_mfma_f32_16x16x32_bf16 v[176:179], v[80:83], a[40:43], v[176:179]
    ds_read_b64_tr_b16 a[56:57], v230 offset:12288
    v_mfma_f32_16x16x32_bf16 v[180:183], v[84:87], a[40:43], v[180:183]
    ds_read_b64_tr_b16 a[58:59], v230 offset:12800
    v_mfma_f32_16x16x32_bf16 v[184:187], v[80:83], a[44:47], v[184:187]
    ds_read_b64_tr_b16 a[60:61], v231 offset:12288
    v_mfma_f32_16x16x32_bf16 v[188:191], v[84:87], a[44:47], v[188:191]
    ds_read_b64_tr_b16 a[62:63], v231 offset:12800
    v_mfma_f32_16x16x32_bf16 v[192:195], v[88:91], a[32:35], v[192:195]
    s_add_u32 m0, s34, 8192
    s_add_u32 s37, s84, 65536
    buffer_load_dwordx4 v232, s[44:47], s37 offen lds
    v_mfma_f32_16x16x32_bf16 v[196:199], v[92:95], a[32:35], v[196:199]
    v_mfma_f32_16x16x32_bf16 v[200:203], v[88:91], a[36:39], v[200:203]
    v_mfma_f32_16x16x32_bf16 v[204:207], v[92:95], a[36:39], v[204:207]
    v_mfma_f32_16x16x32_bf16 v[208:211], v[88:91], a[40:43], v[208:211]
    buffer_load_dwordx4 v233, s[44:47], s37 offen offset:1024 lds
    v_mfma_f32_16x16x32_bf16 v[212:215], v[92:95], a[40:43], v[212:215]
    v_mfma_f32_16x16x32_bf16 v[216:219], v[88:91], a[44:47], v[216:219]
    v_mfma_f32_16x16x32_bf16 v[220:223], v[92:95], a[44:47], v[220:223]
    s_waitcnt vmcnt(22) lgkmcnt(0)
    v_mfma_f32_16x16x32_bf16 v[96:99], v[64:67], a[48:51], v[96:99]
    ds_read_b128 v[80:83], v225 offset:24576
    v_mfma_f32_16x16x32_bf16 v[100:103], v[68:71], a[48:51], v[100:103]
    ds_read_b128 v[84:87], v225 offset:26624
    v_mfma_f32_16x16x32_bf16 v[104:107], v[64:67], a[52:55], v[104:107]
    ds_read_b128 v[88:91], v225 offset:28672
    v_mfma_f32_16x16x32_bf16 v[108:111], v[68:71], a[52:55], v[108:111]
    ds_read_b128 v[92:95], v225 offset:30720
    v_mfma_f32_16x16x32_bf16 v[112:115], v[64:67], a[56:59], v[112:115]
    ds_read_b64_tr_b16 a[64:65], v228 offset:16384
    v_mfma_f32_16x16x32_bf16 v[116:119], v[68:71], a[56:59], v[116:119]
    ds_read_b64_tr_b16 a[66:67], v228 offset:16896
    v_mfma_f32_16x16x32_bf16 v[120:123], v[64:67], a[60:63], v[120:123]
    ds_read_b64_tr_b16 a[68:69], v229 offset:16384
    v_mfma_f32_16x16x32_bf16 v[124:127], v[68:71], a[60:63], v[124:127]
    ds_read_b64_tr_b16 a[70:71], v229 offset:16896
    v_mfma_f32_16x16x32_bf16 v[128:131], v[72:75], a[48:51], v[128:131]
    s_add_u32 m0, s35, 8192
    s_and_b32 s33, s84, 1023
    s_lshl_b32 s33, s33, 12
    buffer_load_dwordx4 v234, s[48:51], s33 offen lds
    v_mfma_f32_16x16x32_bf16 v[132:135], v[76:79], a[48:51], v[132:135]
    v_mfma_f32_16x16x32_bf16 v[136:139], v[72:75], a[52:55], v[136:139]
    buffer_load_dwordx4 v235, s[48:51], s33 offen offset:1024 lds
    v_mfma_f32_16x16x32_bf16 v[140:143], v[76:79], a[52:55], v[140:143]
    v_mfma_f32_16x16x32_bf16 v[144:147], v[72:75], a[56:59], v[144:147]
    s_add_u32 m0, s35, 10240
    s_add_u32 s33, s33, 131072
    buffer_load_dwordx4 v234, s[48:51], s33 offen lds
    v_mfma_f32_16x16x32_bf16 v[148:151], v[76:79], a[56:59], v[148:151]
    v_mfma_f32_16x16x32_bf16 v[152:155], v[72:75], a[60:63], v[152:155]
    buffer_load_dwordx4 v235, s[48:51], s33 offen offset:1024 lds
    v_mfma_f32_16x16x32_bf16 v[156:159], v[76:79], a[60:63], v[156:159]
    s_waitcnt vmcnt(20) lgkmcnt(0)
    s_barrier
    v_mfma_f32_16x16x32_bf16 v[160:163], v[80:83], a[48:51], v[160:163]
    ds_read_b128 v[64:67], v224 offset:32768
    v_mfma_f32_16x16x32_bf16 v[164:167], v[84:87], a[48:51], v[164:167]
    ds_read_b128 v[68:71], v224 offset:34816
    v_mfma_f32_16x16x32_bf16 v[168:171], v[80:83], a[52:55], v[168:171]
    ds_read_b128 v[72:75], v224 offset:36864
    v_mfma_f32_16x16x32_bf16 v[172:175], v[84:87], a[52:55], v[172:175]
    ds_read_b128 v[76:79], v224 offset:38912
    v_mfma_f32_16x16x32_bf16 v[176:179], v[80:83], a[56:59], v[176:179]
    ds_read_b64_tr_b16 a[72:73], v230 offset:16384
    v_mfma_f32_16x16x32_bf16 v[180:183], v[84:87], a[56:59], v[180:183]
    ds_read_b64_tr_b16 a[74:75], v230 offset:16896
    v_mfma_f32_16x16x32_bf16 v[184:187], v[80:83], a[60:63], v[184:187]
    ds_read_b64_tr_b16 a[76:77], v231 offset:16384
    v_mfma_f32_16x16x32_bf16 v[188:191], v[84:87], a[60:63], v[188:191]
    ds_read_b64_tr_b16 a[78:79], v231 offset:16896
    v_mfma_f32_16x16x32_bf16 v[192:195], v[88:91], a[48:51], v[192:195]
    s_add_u32 m0, s34, 16384
    s_add_u32 s37, s85, 0
    buffer_load_dwordx4 v232, s[44:47], s37 offen lds
    v_mfma_f32_16x16x32_bf16 v[196:199], v[92:95], a[48:51], v[196:199]
    v_mfma_f32_16x16x32_bf16 v[200:203], v[88:91], a[52:55], v[200:203]
    v_mfma_f32_16x16x32_bf16 v[204:207], v[92:95], a[52:55], v[204:207]
    v_mfma_f32_16x16x32_bf16 v[208:211], v[88:91], a[56:59], v[208:211]
    buffer_load_dwordx4 v233, s[44:47], s37 offen offset:1024 lds
    v_mfma_f32_16x16x32_bf16 v[212:215], v[92:95], a[56:59], v[212:215]
    v_mfma_f32_16x16x32_bf16 v[216:219], v[88:91], a[60:63], v[216:219]
    v_mfma_f32_16x16x32_bf16 v[220:223], v[92:95], a[60:63], v[220:223]
    s_waitcnt lgkmcnt(0)
    v_mfma_f32_16x16x32_bf16 v[96:99], v[64:67], a[64:67], v[96:99]
    ds_read_b128 v[80:83], v224 offset:40960
    s_waitcnt vmcnt(26)
    v_mfma_f32_16x16x32_bf16 v[100:103], v[68:71], a[64:67], v[100:103]
    ds_read_b128 v[84:87], v224 offset:43008
    v_lshlrev_b32 v16, 16, v0
    v_mfma_f32_16x16x32_bf16 v[104:107], v[64:67], a[68:71], v[104:107]
    ds_read_b128 v[88:91], v224 offset:45056
    v_and_b32 v17, 0xffff0000, v0
    v_mfma_f32_16x16x32_bf16 v[108:111], v[68:71], a[68:71], v[108:111]
    ds_read_b128 v[92:95], v224 offset:47104
    v_lshlrev_b32 v18, 16, v1
    v_mfma_f32_16x16x32_bf16 v[112:115], v[64:67], a[72:75], v[112:115]
    ds_read_b64_tr_b16 a[80:81], v228 offset:20480
    v_and_b32 v19, 0xffff0000, v1
    v_mfma_f32_16x16x32_bf16 v[116:119], v[68:71], a[72:75], v[116:119]
    ds_read_b64_tr_b16 a[82:83], v228 offset:20992
    v_lshlrev_b32 v20, 16, v2
    v_mfma_f32_16x16x32_bf16 v[120:123], v[64:67], a[76:79], v[120:123]
    ds_read_b64_tr_b16 a[84:85], v229 offset:20480
    v_and_b32 v21, 0xffff0000, v2
    v_mfma_f32_16x16x32_bf16 v[124:127], v[68:71], a[76:79], v[124:127]
    ds_read_b64_tr_b16 a[86:87], v229 offset:20992
    v_lshlrev_b32 v22, 16, v3
    v_mfma_f32_16x16x32_bf16 v[128:131], v[72:75], a[64:67], v[128:131]
    s_add_u32 m0, s35, 12288
    s_add_u32 s33, s33, 131072
    buffer_load_dwordx4 v234, s[48:51], s33 offen lds
    v_mfma_f32_16x16x32_bf16 v[132:135], v[76:79], a[64:67], v[132:135]
    v_and_b32 v23, 0xffff0000, v3
    v_lshlrev_b32 v24, 16, v4
    v_mfma_f32_16x16x32_bf16 v[136:139], v[72:75], a[68:71], v[136:139]
    buffer_load_dwordx4 v235, s[48:51], s33 offen offset:1024 lds
    v_and_b32 v25, 0xffff0000, v4
    v_mfma_f32_16x16x32_bf16 v[140:143], v[76:79], a[68:71], v[140:143]
    v_lshlrev_b32 v26, 16, v5
    v_and_b32 v27, 0xffff0000, v5
    v_mfma_f32_16x16x32_bf16 v[144:147], v[72:75], a[72:75], v[144:147]
    s_add_u32 m0, s35, 14336
    s_add_u32 s33, s33, 131072
    buffer_load_dwordx4 v234, s[48:51], s33 offen lds
    v_mfma_f32_16x16x32_bf16 v[148:151], v[76:79], a[72:75], v[148:151]
    v_lshlrev_b32 v28, 16, v6
    v_and_b32 v29, 0xffff0000, v6
    v_mfma_f32_16x16x32_bf16 v[152:155], v[72:75], a[76:79], v[152:155]
    buffer_load_dwordx4 v235, s[48:51], s33 offen offset:1024 lds
    v_lshlrev_b32 v30, 16, v7
    v_mfma_f32_16x16x32_bf16 v[156:159], v[76:79], a[76:79], v[156:159]
    v_and_b32 v31, 0xffff0000, v7
    s_waitcnt lgkmcnt(0)
    v_mfma_f32_16x16x32_bf16 v[160:163], v[80:83], a[64:67], v[160:163]
    ds_read_b128 v[64:67], v225 offset:32768
    v_lshlrev_b32 v32, 16, v8
    v_mfma_f32_16x16x32_bf16 v[164:167], v[84:87], a[64:67], v[164:167]
    ds_read_b128 v[68:71], v225 offset:34816
    v_and_b32 v33, 0xffff0000, v8
    v_mfma_f32_16x16x32_bf16 v[168:171], v[80:83], a[68:71], v[168:171]
    ds_read_b128 v[72:75], v225 offset:36864
    v_lshlrev_b32 v34, 16, v9
    v_mfma_f32_16x16x32_bf16 v[172:175], v[84:87], a[68:71], v[172:175]
    ds_read_b128 v[76:79], v225 offset:38912
    v_and_b32 v35, 0xffff0000, v9
    v_mfma_f32_16x16x32_bf16 v[176:179], v[80:83], a[72:75], v[176:179]
    ds_read_b64_tr_b16 a[88:89], v230 offset:20480
    v_lshlrev_b32 v36, 16, v10
    v_mfma_f32_16x16x32_bf16 v[180:183], v[84:87], a[72:75], v[180:183]
    ds_read_b64_tr_b16 a[90:91], v230 offset:20992
    v_and_b32 v37, 0xffff0000, v10
    v_mfma_f32_16x16x32_bf16 v[184:187], v[80:83], a[76:79], v[184:187]
    ds_read_b64_tr_b16 a[92:93], v231 offset:20480
    v_lshlrev_b32 v38, 16, v11
    v_mfma_f32_16x16x32_bf16 v[188:191], v[84:87], a[76:79], v[188:191]
    ds_read_b64_tr_b16 a[94:95], v231 offset:20992
    v_and_b32 v39, 0xffff0000, v11
    v_mfma_f32_16x16x32_bf16 v[192:195], v[88:91], a[64:67], v[192:195]
    s_add_u32 m0, s34, 24576
    s_add_u32 s37, s85, 65536
    buffer_load_dwordx4 v232, s[44:47], s37 offen lds
    v_mfma_f32_16x16x32_bf16 v[196:199], v[92:95], a[64:67], v[196:199]
    v_lshlrev_b32 v40, 16, v12
    v_and_b32 v41, 0xffff0000, v12
    v_mfma_f32_16x16x32_bf16 v[200:203], v[88:91], a[68:71], v[200:203]
    v_lshlrev_b32 v42, 16, v13
    v_and_b32 v43, 0xffff0000, v13
    v_mfma_f32_16x16x32_bf16 v[204:207], v[92:95], a[68:71], v[204:207]
    v_lshlrev_b32 v44, 16, v14
    v_and_b32 v45, 0xffff0000, v14
    v_mfma_f32_16x16x32_bf16 v[208:211], v[88:91], a[72:75], v[208:211]
    buffer_load_dwordx4 v233, s[44:47], s37 offen offset:1024 lds
    v_lshlrev_b32 v46, 16, v15
    v_mfma_f32_16x16x32_bf16 v[212:215], v[92:95], a[72:75], v[212:215]
    v_and_b32 v47, 0xffff0000, v15
    v_add_f32 v52, v16, v20
    v_mfma_f32_16x16x32_bf16 v[216:219], v[88:91], a[76:79], v[216:219]
    v_add_f32 v53, v17, v21
    v_add_f32 v54, v18, v22
    v_mfma_f32_16x16x32_bf16 v[220:223], v[92:95], a[76:79], v[220:223]
    v_add_f32 v55, v19, v23
    s_waitcnt vmcnt(14) lgkmcnt(0)
    v_mfma_f32_16x16x32_bf16 v[96:99], v[64:67], a[80:83], v[96:99]
    ds_read_b128 v[80:83], v225 offset:40960
    v_add_f32 v52, v52, v24
    v_mfma_f32_16x16x32_bf16 v[100:103], v[68:71], a[80:83], v[100:103]
    ds_read_b128 v[84:87], v225 offset:43008
    v_add_f32 v53, v53, v25
    v_mfma_f32_16x16x32_bf16 v[104:107], v[64:67], a[84:87], v[104:107]
    ds_read_b128 v[88:91], v225 offset:45056
    v_add_f32 v54, v54, v26
    v_mfma_f32_16x16x32_bf16 v[108:111], v[68:71], a[84:87], v[108:111]
    ds_read_b128 v[92:95], v225 offset:47104
    v_add_f32 v55, v55, v27
    v_mfma_f32_16x16x32_bf16 v[112:115], v[64:67], a[88:91], v[112:115]
    ds_read_b64_tr_b16 a[96:97], v228 offset:0
    v_add_f32 v52, v52, v28
    v_mfma_f32_16x16x32_bf16 v[116:119], v[68:71], a[88:91], v[116:119]
    ds_read_b64_tr_b16 a[98:99], v228 offset:512
    v_add_f32 v53, v53, v29
    v_mfma_f32_16x16x32_bf16 v[120:123], v[64:67], a[92:95], v[120:123]
    ds_read_b64_tr_b16 a[100:101], v229 offset:0
    v_add_f32 v54, v54, v30
    v_mfma_f32_16x16x32_bf16 v[124:127], v[68:71], a[92:95], v[124:127]
    ds_read_b64_tr_b16 a[102:103], v229 offset:512
    v_add_f32 v55, v55, v31
    v_mfma_f32_16x16x32_bf16 v[128:131], v[72:75], a[80:83], v[128:131]
    s_add_u32 m0, s35, 16384
    s_and_b32 s33, s85, 1023
    s_lshl_b32 s33, s33, 12
    buffer_load_dwordx4 v234, s[48:51], s33 offen lds
    v_mfma_f32_16x16x32_bf16 v[132:135], v[76:79], a[80:83], v[132:135]
    buffer_load_dwordx4 v235, s[48:51], s33 offen offset:1024 lds
    v_add_f32 v52, v52, v32
    v_mfma_f32_16x16x32_bf16 v[136:139], v[72:75], a[84:87], v[136:139]
    s_add_u32 m0, s35, 18432
    s_add_u32 s33, s33, 131072
    buffer_load_dwordx4 v234, s[48:51], s33 offen lds
    v_mfma_f32_16x16x32_bf16 v[140:143], v[76:79], a[84:87], v[140:143]
    v_add_f32 v53, v53, v33
    v_add_f32 v54, v54, v34
    v_mfma_f32_16x16x32_bf16 v[144:147], v[72:75], a[88:91], v[144:147]
    buffer_load_dwordx4 v235, s[48:51], s33 offen offset:1024 lds
    v_add_f32 v55, v55, v35
    v_mfma_f32_16x16x32_bf16 v[148:151], v[76:79], a[88:91], v[148:151]
    s_lshl2_add_u32 s26, s4, s3
    s_lshl_b32 s26, s26, 10
    s_add_u32 s26, s26, s32
    s_add_u32 s26, s26, 131072
    v_mfma_f32_16x16x32_bf16 v[152:155], v[72:75], a[92:95], v[152:155]
    v_and_b32 v226, 0x40000380, v251
    buffer_load_dword v241, v226, s[44:47], s26 offen
    v_mfma_f32_16x16x32_bf16 v[156:159], v[76:79], a[92:95], v[156:159]
    s_waitcnt vmcnt(25) lgkmcnt(0)
    s_barrier
    v_mfma_f32_16x16x32_bf16 v[160:163], v[80:83], a[80:83], v[160:163]
    ds_read_b128 v[64:67], v224 offset:49152
    v_add_f32 v52, v52, v36
    v_add_f32 v53, v53, v37
    v_mfma_f32_16x16x32_bf16 v[164:167], v[84:87], a[80:83], v[164:167]
    ds_read_b128 v[68:71], v224 offset:51200
    v_add_f32 v54, v54, v38
    v_mfma_f32_16x16x32_bf16 v[168:171], v[80:83], a[84:87], v[168:171]
    ds_read_b128 v[72:75], v224 offset:53248
    v_add_f32 v55, v55, v39
    v_mfma_f32_16x16x32_bf16 v[172:175], v[84:87], a[84:87], v[172:175]
    ds_read_b128 v[76:79], v224 offset:55296
    v_add_f32 v52, v52, v40
    v_mfma_f32_16x16x32_bf16 v[176:179], v[80:83], a[88:91], v[176:179]
    ds_read_b64_tr_b16 a[104:105], v230 offset:0
    v_add_f32 v53, v53, v41
    v_mfma_f32_16x16x32_bf16 v[180:183], v[84:87], a[88:91], v[180:183]
    ds_read_b64_tr_b16 a[106:107], v230 offset:512
    v_add_f32 v54, v54, v42
    v_mfma_f32_16x16x32_bf16 v[184:187], v[80:83], a[92:95], v[184:187]
    ds_read_b64_tr_b16 a[108:109], v231 offset:0
    v_add_f32 v55, v55, v43
    v_mfma_f32_16x16x32_bf16 v[188:191], v[84:87], a[92:95], v[188:191]
    ds_read_b64_tr_b16 a[110:111], v231 offset:512
    v_add_f32 v52, v52, v44
    v_mfma_f32_16x16x32_bf16 v[192:195], v[88:91], a[80:83], v[192:195]
    s_add_u32 m0, s34, 32768
    s_add_u32 s37, s86, 0
    buffer_load_dwordx4 v232, s[44:47], s37 offen lds
    v_mfma_f32_16x16x32_bf16 v[196:199], v[92:95], a[80:83], v[196:199]
    v_add_f32 v53, v53, v45
    v_add_f32 v54, v54, v46
    v_mfma_f32_16x16x32_bf16 v[200:203], v[88:91], a[84:87], v[200:203]
    v_add_f32 v55, v55, v47
    v_add_f32 v52, v52, v53
    v_mfma_f32_16x16x32_bf16 v[204:207], v[92:95], a[84:87], v[204:207]
    v_add_f32 v54, v54, v55
    v_add_f32 v48, v52, v54
    v_mfma_f32_16x16x32_bf16 v[208:211], v[88:91], a[88:91], v[208:211]
    buffer_load_dwordx4 v233, s[44:47], s37 offen offset:1024 lds
    s_nop 1
    v_mfma_f32_16x16x32_bf16 v[212:215], v[92:95], a[88:91], v[212:215]
    v_add_f32_dpp v48, v48, v48 quad_perm:[1,0,3,2] row_mask:0xf bank_mask:0xf
    s_nop 1
    v_mfma_f32_16x16x32_bf16 v[216:219], v[88:91], a[92:95], v[216:219]
    v_add_f32_dpp v48, v48, v48 quad_perm:[2,3,0,1] row_mask:0xf bank_mask:0xf
    s_nop 1
    v_mfma_f32_16x16x32_bf16 v[220:223], v[92:95], a[92:95], v[220:223]
    v_add_f32_dpp v48, v48, v48 row_half_mirror row_mask:0xf bank_mask:0xf
    s_waitcnt lgkmcnt(0)
    v_mfma_f32_16x16x32_bf16 v[96:99], v[64:67], a[96:99], v[96:99]
    ds_read_b128 v[80:83], v224 offset:57344
    s_nop 1
    v_mfma_f32_16x16x32_bf16 v[100:103], v[68:71], a[96:99], v[100:103]
    ds_read_b128 v[84:87], v224 offset:59392
    v_add_f32_dpp v48, v48, v48 row_mirror row_mask:0xf bank_mask:0xf
    v_mfma_f32_16x16x32_bf16 v[104:107], v[64:67], a[100:103], v[104:107]
    ds_read_b128 v[88:91], v224 offset:61440
    s_nop 0
    v_mfma_f32_16x16x32_bf16 v[108:111], v[68:71], a[100:103], v[108:111]
    ds_read_b128 v[92:95], v224 offset:63488
    v_mov_b32 v49, v48
    v_mfma_f32_16x16x32_bf16 v[112:115], v[64:67], a[104:107], v[112:115]
    ds_read_b64_tr_b16 a[112:113], v228 offset:4096
    s_nop 1
    v_mfma_f32_16x16x32_bf16 v[116:119], v[68:71], a[104:107], v[116:119]
    ds_read_b64_tr_b16 a[114:115], v228 offset:4608
    v_permlane16_swap_b32 v48, v49
    v_mfma_f32_16x16x32_bf16 v[120:123], v[64:67], a[108:111], v[120:123]
    ds_read_b64_tr_b16 a[116:117], v229 offset:4096
    s_nop 0
    v_mfma_f32_16x16x32_bf16 v[124:127], v[68:71], a[108:111], v[124:127]
    ds_read_b64_tr_b16 a[118:119], v229 offset:4608
    v_add_f32 v48, v48, v49
    v_mfma_f32_16x16x32_bf16 v[128:131], v[72:75], a[96:99], v[128:131]
    s_add_u32 m0, s35, 20480
    s_add_u32 s33, s33, 131072
    buffer_load_dwordx4 v234, s[48:51], s33 offen lds
    v_mfma_f32_16x16x32_bf16 v[132:135], v[76:79], a[96:99], v[132:135]
    buffer_load_dwordx4 v235, s[48:51], s33 offen offset:1024 lds
    v_mul_f32 v48, 0x3a800000, v48
    v_mfma_f32_16x16x32_bf16 v[136:139], v[72:75], a[100:103], v[136:139]
    v_sub_f32 v56, v16, v48
    v_mul_f32 v52, v56, v56
    v_mfma_f32_16x16x32_bf16 v[140:143], v[76:79], a[100:103], v[140:143]
    s_add_u32 m0, s35, 22528
    s_add_u32 s33, s33, 131072
    buffer_load_dwordx4 v234, s[48:51], s33 offen lds
    v_mfma_f32_16x16x32_bf16 v[144:147], v[72:75], a[104:107], v[144:147]
    buffer_load_dwordx4 v235, s[48:51], s33 offen offset:1024 lds
    v_sub_f32 v57, v17, v48
    v_mfma_f32_16x16x32_bf16 v[148:151], v[76:79], a[104:107], v[148:151]
    v_mul_f32 v53, v57, v57
    v_sub_f32 v58, v18, v48
    v_mfma_f32_16x16x32_bf16 v[152:155], v[72:75], a[108:111], v[152:155]
    v_lshlrev_b32 v226, 7, v253
    s_lshl_b32 s25, s2, 15
    buffer_load_dword v241, v226, s[12:15], s25 offen
    v_mfma_f32_16x16x32_bf16 v[156:159], v[76:79], a[108:111], v[156:159]
    v_mul_f32 v54, v58, v58
    s_waitcnt lgkmcnt(0)
    v_mfma_f32_16x16x32_bf16 v[160:163], v[80:83], a[96:99], v[160:163]
    ds_read_b128 v[64:67], v225 offset:49152
    v_sub_f32 v59, v19, v48
    v_mfma_f32_16x16x32_bf16 v[164:167], v[84:87], a[96:99], v[164:167]
    ds_read_b128 v[68:71], v225 offset:51200
    v_mul_f32 v55, v59, v59
    v_mfma_f32_16x16x32_bf16 v[168:171], v[80:83], a[100:103], v[168:171]
    ds_read_b128 v[72:75], v225 offset:53248
    v_sub_f32 v56, v20, v48
    v_mfma_f32_16x16x32_bf16 v[172:175], v[84:87], a[100:103], v[172:175]
    ds_read_b128 v[76:79], v225 offset:55296
    v_fmac_f32 v52, v56, v56
    v_mfma_f32_16x16x32_bf16 v[176:179], v[80:83], a[104:107], v[176:179]
    ds_read_b64_tr_b16 a[120:121], v230 offset:4096
    v_sub_f32 v57, v21, v48
    v_mfma_f32_16x16x32_bf16 v[180:183], v[84:87], a[104:107], v[180:183]
    ds_read_b64_tr_b16 a[122:123], v230 offset:4608
    v_fmac_f32 v53, v57, v57
    v_mfma_f32_16x16x32_bf16 v[184:187], v[80:83], a[108:111], v[184:187]
    ds_read_b64_tr_b16 a[124:125], v231 offset:4096
    v_sub_f32 v58, v22, v48
    v_mfma_f32_16x16x32_bf16 v[188:191], v[84:87], a[108:111], v[188:191]
    ds_read_b64_tr_b16 a[126:127], v231 offset:4608
    v_fmac_f32 v54, v58, v58
    v_mfma_f32_16x16x32_bf16 v[192:195], v[88:91], a[96:99], v[192:195]
    s_add_u32 m0, s34, 40960
    s_add_u32 s37, s86, 65536
    buffer_load_dwordx4 v232, s[44:47], s37 offen lds
    v_mfma_f32_16x16x32_bf16 v[196:199], v[92:95], a[96:99], v[196:199]
    v_sub_f32 v59, v23, v48
    v_fmac_f32 v55, v59, v59
    v_mfma_f32_16x16x32_bf16 v[200:203], v[88:91], a[100:103], v[200:203]
    v_sub_f32 v56, v24, v48
    v_fmac_f32 v52, v56, v56
    v_mfma_f32_16x16x32_bf16 v[204:207], v[92:95], a[100:103], v[204:207]
    v_sub_f32 v57, v25, v48
    v_fmac_f32 v53, v57, v57
    v_mfma_f32_16x16x32_bf16 v[208:211], v[88:91], a[104:107], v[208:211]
    buffer_load_dwordx4 v233, s[44:47], s37 offen offset:1024 lds
    v_sub_f32 v58, v26, v48
    v_mfma_f32_16x16x32_bf16 v[212:215], v[92:95], a[104:107], v[212:215]
    v_fmac_f32 v54, v58, v58
    v_sub_f32 v59, v27, v48
    v_mfma_f32_16x16x32_bf16 v[216:219], v[88:91], a[108:111], v[216:219]
    v_fmac_f32 v55, v59, v59
    v_sub_f32 v56, v28, v48
    v_mfma_f32_16x16x32_bf16 v[220:223], v[92:95], a[108:111], v[220:223]
    v_fmac_f32 v52, v56, v56
    s_waitcnt vmcnt(16) lgkmcnt(0)
    v_mfma_f32_16x16x32_bf16 v[96:99], v[64:67], a[112:115], v[96:99]
    ds_read_b128 v[80:83], v225 offset:57344
    v_sub_f32 v57, v29, v48
    v_mfma_f32_16x16x32_bf16 v[100:103], v[68:71], a[112:115], v[100:103]
    ds_read_b128 v[84:87], v225 offset:59392
    v_fmac_f32 v53, v57, v57
    v_mfma_f32_16x16x32_bf16 v[104:107], v[64:67], a[116:119], v[104:107]
    ds_read_b128 v[88:91], v225 offset:61440
    v_sub_f32 v58, v30, v48
    v_mfma_f32_16x16x32_bf16 v[108:111], v[68:71], a[116:119], v[108:111]
    ds_read_b128 v[92:95], v225 offset:63488
    v_fmac_f32 v54, v58, v58
    v_mfma_f32_16x16x32_bf16 v[112:115], v[64:67], a[120:123], v[112:115]
    ds_read_b64_tr_b16 a[128:129], v228 offset:8192
    v_sub_f32 v59, v31, v48
    v_mfma_f32_16x16x32_bf16 v[116:119], v[68:71], a[120:123], v[116:119]
    ds_read_b64_tr_b16 a[130:131], v228 offset:8704
    v_fmac_f32 v55, v59, v59
    v_mfma_f32_16x16x32_bf16 v[120:123], v[64:67], a[124:127], v[120:123]
    ds_read_b64_tr_b16 a[132:133], v229 offset:8192
    v_sub_f32 v56, v32, v48
    v_mfma_f32_16x16x32_bf16 v[124:127], v[68:71], a[124:127], v[124:127]
    ds_read_b64_tr_b16 a[134:135], v229 offset:8704
    v_fmac_f32 v52, v56, v56
    v_mfma_f32_16x16x32_bf16 v[128:131], v[72:75], a[112:115], v[128:131]
    s_add_u32 m0, s35, 0
    s_and_b32 s33, s86, 1023
    s_lshl_b32 s33, s33, 12
    buffer_load_dwordx4 v234, s[48:51], s33 offen lds
    v_mfma_f32_16x16x32_bf16 v[132:135], v[76:79], a[112:115], v[132:135]
    v_sub_f32 v57, v33, v48
    v_fmac_f32 v53, v57, v57
    v_mfma_f32_16x16x32_bf16 v[136:139], v[72:75], a[116:119], v[136:139]
    buffer_load_dwordx4 v235, s[48:51], s33 offen offset:1024 lds
    v_sub_f32 v58, v34, v48
    v_mfma_f32_16x16x32_bf16 v[140:143], v[76:79], a[116:119], v[140:143]
    v_fmac_f32 v54, v58, v58
    v_sub_f32 v59, v35, v48
    v_mfma_f32_16x16x32_bf16 v[144:147], v[72:75], a[120:123], v[144:147]
    s_add_u32 m0, s35, 2048
    s_add_u32 s33, s33, 131072
    buffer_load_dwordx4 v234, s[48:51], s33 offen lds
    v_mfma_f32_16x16x32_bf16 v[148:151], v[76:79], a[120:123], v[148:151]
    v_fmac_f32 v55, v59, v59
    v_sub_f32 v56, v36, v48
    v_mfma_f32_16x16x32_bf16 v[152:155], v[72:75], a[124:127], v[152:155]
    buffer_load_dwordx4 v235, s[48:51], s33 offen offset:1024 lds
    v_fmac_f32 v52, v56, v56
    v_mfma_f32_16x16x32_bf16 v[156:159], v[76:79], a[124:127], v[156:159]
    s_waitcnt vmcnt(30) lgkmcnt(0)
    s_barrier
    v_mfma_f32_16x16x32_bf16 v[160:163], v[80:83], a[112:115], v[160:163]
    ds_read_b128 v[64:67], v224 offset:0
    v_sub_f32 v57, v37, v48
    v_mfma_f32_16x16x32_bf16 v[164:167], v[84:87], a[112:115], v[164:167]
    ds_read_b128 v[68:71], v224 offset:2048
    v_fmac_f32 v53, v57, v57
    v_mfma_f32_16x16x32_bf16 v[168:171], v[80:83], a[116:119], v[168:171]
    ds_read_b128 v[72:75], v224 offset:4096
    v_sub_f32 v58, v38, v48
    v_mfma_f32_16x16x32_bf16 v[172:175], v[84:87], a[116:119], v[172:175]
    ds_read_b128 v[76:79], v224 offset:6144
    v_fmac_f32 v54, v58, v58
    v_mfma_f32_16x16x32_bf16 v[176:179], v[80:83], a[120:123], v[176:179]
    ds_read_b64_tr_b16 a[136:137], v230 offset:8192
    v_sub_f32 v59, v39, v48
    v_mfma_f32_16x16x32_bf16 v[180:183], v[84:87], a[120:123], v[180:183]
    ds_read_b64_tr_b16 a[138:139], v230 offset:8704
    v_fmac_f32 v55, v59, v59
    v_mfma_f32_16x16x32_bf16 v[184:187], v[80:83], a[124:127], v[184:187]
    ds_read_b64_tr_b16 a[140:141], v231 offset:8192
    v_sub_f32 v56, v40, v48
    v_mfma_f32_16x16x32_bf16 v[188:191], v[84:87], a[124:127], v[188:191]
    ds_read_b64_tr_b16 a[142:143], v231 offset:8704
    v_fmac_f32 v52, v56, v56
    v_mfma_f32_16x16x32_bf16 v[192:195], v[88:91], a[112:115], v[192:195]
    s_add_u32 m0, s34, 49152
    s_add_u32 s37, s87, 0
    buffer_load_dwordx4 v232, s[44:47], s37 offen lds
    v_mfma_f32_16x16x32_bf16 v[196:199], v[92:95], a[112:115], v[196:199]
    v_sub_f32 v57, v41, v48
    v_fmac_f32 v53, v57, v57
    v_mfma_f32_16x16x32_bf16 v[200:203], v[88:91], a[116:119], v[200:203]
    v_sub_f32 v58, v42, v48
    v_fmac_f32 v54, v58, v58
    v_mfma_f32_16x16x32_bf16 v[204:207], v[92:95], a[116:119], v[204:207]
    v_sub_f32 v59, v43, v48
    v_fmac_f32 v55, v59, v59
    v_mfma_f32_16x16x32_bf16 v[208:211], v[88:91], a[120:123], v[208:211]
    buffer_load_dwordx4 v233, s[44:47], s37 offen offset:1024 lds
    v_sub_f32 v56, v44, v48
    v_mfma_f32_16x16x32_bf16 v[212:215], v[92:95], a[120:123], v[212:215]
    v_fmac_f32 v52, v56, v56
    v_sub_f32 v57, v45, v48
    v_mfma_f32_16x16x32_bf16 v[216:219], v[88:91], a[124:127], v[216:219]
    v_fmac_f32 v53, v57, v57
    v_sub_f32 v58, v46, v48
    v_mfma_f32_16x16x32_bf16 v[220:223], v[92:95], a[124:127], v[220:223]
    v_fmac_f32 v54, v58, v58
    s_waitcnt lgkmcnt(0)
    v_mfma_f32_16x16x32_bf16 v[96:99], v[64:67], a[128:131], v[96:99]
    ds_read_b128 v[80:83], v224 offset:8192
    v_sub_f32 v59, v47, v48
    v_mfma_f32_16x16x32_bf16 v[100:103], v[68:71], a[128:131], v[100:103]
    ds_read_b128 v[84:87], v224 offset:10240
    v_fmac_f32 v55, v59, v59
    v_mfma_f32_16x16x32_bf16 v[104:107], v[64:67], a[132:135], v[104:107]
    ds_read_b128 v[88:91], v224 offset:12288
    v_add_f32 v52, v52, v53
    v_mfma_f32_16x16x32_bf16 v[108:111], v[68:71], a[132:135], v[108:111]
    ds_read_b128 v[92:95], v224 offset:14336
    v_add_f32 v54, v54, v55
    v_mfma_f32_16x16x32_bf16 v[112:115], v[64:67], a[136:139], v[112:115]
    ds_read_b64_tr_b16 a[144:145], v228 offset:12288
    v_add_f32 v51, v52, v54
    v_mfma_f32_16x16x32_bf16 v[116:119], v[68:71], a[136:139], v[116:119]
    ds_read_b64_tr_b16 a[146:147], v228 offset:12800
    s_nop 1
    v_mfma_f32_16x16x32_bf16 v[120:123], v[64:67], a[140:143], v[120:123]
    ds_read_b64_tr_b16 a[148:149], v229 offset:12288
    v_add_f32_dpp v51, v51, v51 quad_perm:[1,0,3,2] row_mask:0xf bank_mask:0xf
    v_mfma_f32_16x16x32_bf16 v[124:127], v[68:71], a[140:143], v[124:127]
    ds_read_b64_tr_b16 a[150:151], v229 offset:12800
    s_nop 1
    v_mfma_f32_16x16x32_bf16 v[128:131], v[72:75], a[128:131], v[128:131]
    s_add_u32 m0, s35, 4096
    s_add_u32 s33, s33, 131072
    buffer_load_dwordx4 v234, s[48:51], s33 offen lds
    v_mfma_f32_16x16x32_bf16 v[132:135], v[76:79], a[128:131], v[132:135]
    v_add_f32_dpp v51, v51, v51 quad_perm:[2,3,0,1] row_mask:0xf bank_mask:0xf
    s_nop 1
    v_add_f32_dpp v51, v51, v51 row_half_mirror row_mask:0xf bank_mask:0xf
    v_mfma_f32_16x16x32_bf16 v[136:139], v[72:75], a[132:135], v[136:139]
    buffer_load_dwordx4 v235, s[48:51], s33 offen offset:1024 lds
    s_nop 1
    v_mfma_f32_16x16x32_bf16 v[140:143], v[76:79], a[132:135], v[140:143]
    v_add_f32_dpp v51, v51, v51 row_mirror row_mask:0xf bank_mask:0xf
    s_nop 0
    v_mfma_f32_16x16x32_bf16 v[144:147], v[72:75], a[136:139], v[144:147]
    s_add_u32 m0, s35, 6144
    s_add_u32 s33, s33, 131072
    buffer_load_dwordx4 v234, s[48:51], s33 offen lds
    v_mfma_f32_16x16x32_bf16 v[148:151], v[76:79], a[136:139], v[148:151]
    v_mov_b32 v49, v51
    s_nop 1
    v_mfma_f32_16x16x32_bf16 v[152:155], v[72:75], a[140:143], v[152:155]
    buffer_load_dwordx4 v235, s[48:51], s33 offen offset:1024 lds
    v_permlane16_swap_b32 v51, v49
    v_mfma_f32_16x16x32_bf16 v[156:159], v[76:79], a[140:143], v[156:159]
    s_nop 0
    s_waitcnt lgkmcnt(0)
    v_mfma_f32_16x16x32_bf16 v[160:163], v[80:83], a[128:131], v[160:163]
    ds_read_b128 v[64:67], v225 offset:0
    v_add_f32 v51, v51, v49
    v_mfma_f32_16x16x32_bf16 v[164:167], v[84:87], a[128:131], v[164:167]
    ds_read_b128 v[68:71], v225 offset:2048
    v_mul_f32 v51, 0x3a800000, v51
    v_mfma_f32_16x16x32_bf16 v[168:171], v[80:83], a[132:135], v[168:171]
    ds_read_b128 v[72:75], v225 offset:4096
    v_cvt_pk_bf16_f32 v50, v48, v51
    v_mfma_f32_16x16x32_bf16 v[172:175], v[84:87], a[132:135], v[172:175]
    ds_read_b128 v[76:79], v225 offset:6144
    v_and_b32 v51, 0xffff0000, v50
    v_mfma_f32_16x16x32_bf16 v[176:179], v[80:83], a[136:139], v[176:179]
    ds_read_b64_tr_b16 a[152:153], v230 offset:12288
    v_lshlrev_b32 v50, 16, v50
    v_mfma_f32_16x16x32_bf16 v[180:183], v[84:87], a[136:139], v[180:183]
    ds_read_b64_tr_b16 a[154:155], v230 offset:12800
    v_add_f32 v51, 0x3727c5ac, v51
    v_mfma_f32_16x16x32_bf16 v[184:187], v[80:83], a[140:143], v[184:187]
    ds_read_b64_tr_b16 a[156:157], v231 offset:12288
    v_cvt_pk_bf16_f32 v51, v51, v51
    v_mfma_f32_16x16x32_bf16 v[188:191], v[84:87], a[140:143], v[188:191]
    ds_read_b64_tr_b16 a[158:159], v231 offset:12800
    v_lshlrev_b32 v51, 16, v51
    v_mfma_f32_16x16x32_bf16 v[192:195], v[88:91], a[128:131], v[192:195]
    s_add_u32 m0, s34, 57344
    s_add_u32 s37, s87, 65536
    buffer_load_dwordx4 v232, s[44:47], s37 offen lds
    v_mfma_f32_16x16x32_bf16 v[196:199], v[92:95], a[128:131], v[196:199]
    v_sqrt_f32 v51, v51
    v_mfma_f32_16x16x32_bf16 v[200:203], v[88:91], a[132:135], v[200:203]
    s_nop 0
    v_cvt_pk_bf16_f32 v51, v51, v51
    v_mfma_f32_16x16x32_bf16 v[204:207], v[92:95], a[132:135], v[204:207]
    v_lshlrev_b32 v51, 16, v51
    v_mfma_f32_16x16x32_bf16 v[208:211], v[88:91], a[136:139], v[208:211]
    buffer_load_dwordx4 v233, s[44:47], s37 offen offset:1024 lds
    v_rcp_f32 v51, v51
    v_mfma_f32_16x16x32_bf16 v[212:215], v[92:95], a[136:139], v[212:215]
    s_nop 0
    v_sub_f32 v16, v16, v50
    v_mfma_f32_16x16x32_bf16 v[216:219], v[88:91], a[140:143], v[216:219]
    v_sub_f32 v17, v17, v50
    v_cvt_pk_bf16_f32 v17, v16, v17
    v_mfma_f32_16x16x32_bf16 v[220:223], v[92:95], a[140:143], v[220:223]
    v_lshlrev_b32 v16, 16, v17
    s_waitcnt vmcnt(15) lgkmcnt(0)
    v_mfma_f32_16x16x32_bf16 v[96:99], v[64:67], a[144:147], v[96:99]
    ds_read_b128 v[80:83], v225 offset:8192
    v_and_b32 v17, 0xffff0000, v17
    v_mfma_f32_16x16x32_bf16 v[100:103], v[68:71], a[144:147], v[100:103]
    ds_read_b128 v[84:87], v225 offset:10240
    v_mul_f32 v16, v16, v51
    v_mfma_f32_16x16x32_bf16 v[104:107], v[64:67], a[148:151], v[104:107]
    ds_read_b128 v[88:91], v225 offset:12288
    v_mul_f32 v17, v17, v51
    v_mfma_f32_16x16x32_bf16 v[108:111], v[68:71], a[148:151], v[108:111]
    ds_read_b128 v[92:95], v225 offset:14336
    v_cvt_pk_bf16_f32 v0, v16, v17
    v_mfma_f32_16x16x32_bf16 v[112:115], v[64:67], a[152:155], v[112:115]
    ds_read_b64_tr_b16 a[160:161], v228 offset:16384
    v_sub_f32 v18, v18, v50
    v_mfma_f32_16x16x32_bf16 v[116:119], v[68:71], a[152:155], v[116:119]
    ds_read_b64_tr_b16 a[162:163], v228 offset:16896
    v_sub_f32 v19, v19, v50
    v_mfma_f32_16x16x32_bf16 v[120:123], v[64:67], a[156:159], v[120:123]
    ds_read_b64_tr_b16 a[164:165], v229 offset:16384
    v_cvt_pk_bf16_f32 v19, v18, v19
    v_mfma_f32_16x16x32_bf16 v[124:127], v[68:71], a[156:159], v[124:127]
    ds_read_b64_tr_b16 a[166:167], v229 offset:16896
    v_lshlrev_b32 v18, 16, v19
    v_mfma_f32_16x16x32_bf16 v[128:131], v[72:75], a[144:147], v[128:131]
    s_add_u32 m0, s35, 8192
    s_and_b32 s33, s87, 1023
    s_lshl_b32 s33, s33, 12
    buffer_load_dwordx4 v234, s[48:51], s33 offen lds
    v_mfma_f32_16x16x32_bf16 v[132:135], v[76:79], a[144:147], v[132:135]
    v_and_b32 v19, 0xffff0000, v19
    v_mul_f32 v18, v18, v51
    v_mfma_f32_16x16x32_bf16 v[136:139], v[72:75], a[148:151], v[136:139]
    buffer_load_dwordx4 v235, s[48:51], s33 offen offset:1024 lds
    v_mul_f32 v19, v19, v51
    v_mfma_f32_16x16x32_bf16 v[140:143], v[76:79], a[148:151], v[140:143]
    v_cvt_pk_bf16_f32 v1, v18, v19
    v_sub_f32 v20, v20, v50
    v_mfma_f32_16x16x32_bf16 v[144:147], v[72:75], a[152:155], v[144:147]
    s_add_u32 m0, s35, 10240
    s_add_u32 s33, s33, 131072
    buffer_load_dwordx4 v234, s[48:51], s33 offen lds
    v_mfma_f32_16x16x32_bf16 v[148:151], v[76:79], a[152:155], v[148:151]
    v_sub_f32 v21, v21, v50
    v_cvt_pk_bf16_f32 v21, v20, v21
    v_mfma_f32_16x16x32_bf16 v[152:155], v[72:75], a[156:159], v[152:155]
    buffer_load_dwordx4 v235, s[48:51], s33 offen offset:1024 lds
    v_lshlrev_b32 v20, 16, v21
    v_mfma_f32_16x16x32_bf16 v[156:159], v[76:79], a[156:159], v[156:159]
    s_waitcnt vmcnt(30) lgkmcnt(0)
    s_barrier
    v_mfma_f32_16x16x32_bf16 v[160:163], v[80:83], a[144:147], v[160:163]
    ds_read_b128 v[64:67], v224 offset:16384
    v_and_b32 v21, 0xffff0000, v21
    v_mfma_f32_16x16x32_bf16 v[164:167], v[84:87], a[144:147], v[164:167]
    ds_read_b128 v[68:71], v224 offset:18432
    v_mul_f32 v20, v20, v51
    v_mfma_f32_16x16x32_bf16 v[168:171], v[80:83], a[148:151], v[168:171]
    ds_read_b128 v[72:75], v224 offset:20480
    v_mul_f32 v21, v21, v51
    v_mfma_f32_16x16x32_bf16 v[172:175], v[84:87], a[148:151], v[172:175]
    ds_read_b128 v[76:79], v224 offset:22528
    v_cvt_pk_bf16_f32 v2, v20, v21
    v_mfma_f32_16x16x32_bf16 v[176:179], v[80:83], a[152:155], v[176:179]
    ds_read_b64_tr_b16 a[168:169], v230 offset:16384
    v_sub_f32 v22, v22, v50
    v_mfma_f32_16x16x32_bf16 v[180:183], v[84:87], a[152:155], v[180:183]
    ds_read_b64_tr_b16 a[170:171], v230 offset:16896
    v_sub_f32 v23, v23, v50
    v_mfma_f32_16x16x32_bf16 v[184:187], v[80:83], a[156:159], v[184:187]
    ds_read_b64_tr_b16 a[172:173], v231 offset:16384
    v_cvt_pk_bf16_f32 v23, v22, v23
    v_mfma_f32_16x16x32_bf16 v[188:191], v[84:87], a[156:159], v[188:191]
    ds_read_b64_tr_b16 a[174:175], v231 offset:16896
    v_lshlrev_b32 v22, 16, v23
    v_mfma_f32_16x16x32_bf16 v[192:195], v[88:91], a[144:147], v[192:195]
    s_add_u32 m0, s34, 0
    s_add_u32 s37, s80, 131072
    buffer_load_dwordx4 v232, s[44:47], s37 offen lds
    v_mfma_f32_16x16x32_bf16 v[196:199], v[92:95], a[144:147], v[196:199]
    v_and_b32 v23, 0xffff0000, v23
    v_mul_f32 v22, v22, v51
    v_mfma_f32_16x16x32_bf16 v[200:203], v[88:91], a[148:151], v[200:203]
    v_mul_f32 v23, v23, v51
    v_cvt_pk_bf16_f32 v3, v22, v23
    v_mfma_f32_16x16x32_bf16 v[204:207], v[92:95], a[148:151], v[204:207]
    v_sub_f32 v24, v24, v50
    v_sub_f32 v25, v25, v50
    v_mfma_f32_16x16x32_bf16 v[208:211], v[88:91], a[152:155], v[208:211]
    buffer_load_dwordx4 v233, s[44:47], s37 offen offset:1024 lds
    v_cvt_pk_bf16_f32 v25, v24, v25
    v_mfma_f32_16x16x32_bf16 v[212:215], v[92:95], a[152:155], v[212:215]
    v_lshlrev_b32 v24, 16, v25
    v_and_b32 v25, 0xffff0000, v25
    v_mfma_f32_16x16x32_bf16 v[216:219], v[88:91], a[156:159], v[216:219]
    v_mul_f32 v24, v24, v51
    v_mul_f32 v25, v25, v51
    v_mfma_f32_16x16x32_bf16 v[220:223], v[92:95], a[156:159], v[220:223]
    v_cvt_pk_bf16_f32 v4, v24, v25
    s_waitcnt lgkmcnt(0)
    v_mfma_f32_16x16x32_bf16 v[96:99], v[64:67], a[160:163], v[96:99]
    ds_read_b128 v[80:83], v224 offset:24576
    v_sub_f32 v26, v26, v50
    v_mfma_f32_16x16x32_bf16 v[100:103], v[68:71], a[160:163], v[100:103]
    ds_read_b128 v[84:87], v224 offset:26624
    v_sub_f32 v27, v27, v50
    v_mfma_f32_16x16x32_bf16 v[104:107], v[64:67], a[164:167], v[104:107]
    ds_read_b128 v[88:91], v224 offset:28672
    v_cvt_pk_bf16_f32 v27, v26, v27
    v_mfma_f32_16x16x32_bf16 v[108:111], v[68:71], a[164:167], v[108:111]
    ds_read_b128 v[92:95], v224 offset:30720
    v_lshlrev_b32 v26, 16, v27
    v_mfma_f32_16x16x32_bf16 v[112:115], v[64:67], a[168:171], v[112:115]
    ds_read_b64_tr_b16 a[176:177], v228 offset:20480
    v_and_b32 v27, 0xffff0000, v27
    v_mfma_f32_16x16x32_bf16 v[116:119], v[68:71], a[168:171], v[116:119]
    ds_read_b64_tr_b16 a[178:179], v228 offset:20992
    v_mul_f32 v26, v26, v51
    v_mfma_f32_16x16x32_bf16 v[120:123], v[64:67], a[172:175], v[120:123]
    ds_read_b64_tr_b16 a[180:181], v229 offset:20480
    v_mul_f32 v27, v27, v51
    v_mfma_f32_16x16x32_bf16 v[124:127], v[68:71], a[172:175], v[124:127]
    ds_read_b64_tr_b16 a[182:183], v229 offset:20992
    v_cvt_pk_bf16_f32 v5, v26, v27
    v_mfma_f32_16x16x32_bf16 v[128:131], v[72:75], a[160:163], v[128:131]
    s_add_u32 m0, s35, 12288
    s_add_u32 s33, s33, 131072
    buffer_load_dwordx4 v234, s[48:51], s33 offen lds
    v_mfma_f32_16x16x32_bf16 v[132:135], v[76:79], a[160:163], v[132:135]
    v_sub_f32 v28, v28, v50
    v_sub_f32 v29, v29, v50
    v_mfma_f32_16x16x32_bf16 v[136:139], v[72:75], a[164:167], v[136:139]
    buffer_load_dwordx4 v235, s[48:51], s33 offen offset:1024 lds
    v_cvt_pk_bf16_f32 v29, v28, v29
    v_mfma_f32_16x16x32_bf16 v[140:143], v[76:79], a[164:167], v[140:143]
    v_lshlrev_b32 v28, 16, v29
    v_and_b32 v29, 0xffff0000, v29
    v_mfma_f32_16x16x32_bf16 v[144:147], v[72:75], a[168:171], v[144:147]
    s_add_u32 m0, s35, 14336
    s_add_u32 s33, s33, 131072
    buffer_load_dwordx4 v234, s[48:51], s33 offen lds
    v_mfma_f32_16x16x32_bf16 v[148:151], v[76:79], a[168:171], v[148:151]
    v_mul_f32 v28, v28, v51
    v_mul_f32 v29, v29, v51
    v_mfma_f32_16x16x32_bf16 v[152:155], v[72:75], a[172:175], v[152:155]
    buffer_load_dwordx4 v235, s[48:51], s33 offen offset:1024 lds
    v_cvt_pk_bf16_f32 v6, v28, v29
    v_mfma_f32_16x16x32_bf16 v[156:159], v[76:79], a[172:175], v[156:159]
    v_sub_f32 v30, v30, v50
    s_waitcnt lgkmcnt(0)
    v_mfma_f32_16x16x32_bf16 v[160:163], v[80:83], a[160:163], v[160:163]
    ds_read_b128 v[64:67], v225 offset:16384
    v_sub_f32 v31, v31, v50
    v_mfma_f32_16x16x32_bf16 v[164:167], v[84:87], a[160:163], v[164:167]
    ds_read_b128 v[68:71], v225 offset:18432
    v_cvt_pk_bf16_f32 v31, v30, v31
    v_mfma_f32_16x16x32_bf16 v[168:171], v[80:83], a[164:167], v[168:171]
    ds_read_b128 v[72:75], v225 offset:20480
    v_lshlrev_b32 v30, 16, v31
    v_mfma_f32_16x16x32_bf16 v[172:175], v[84:87], a[164:167], v[172:175]
    ds_read_b128 v[76:79], v225 offset:22528
    v_and_b32 v31, 0xffff0000, v31
    v_mfma_f32_16x16x32_bf16 v[176:179], v[80:83], a[168:171], v[176:179]
    ds_read_b64_tr_b16 a[184:185], v230 offset:20480
    v_mul_f32 v30, v30, v51
    v_mfma_f32_16x16x32_bf16 v[180:183], v[84:87], a[168:171], v[180:183]
    ds_read_b64_tr_b16 a[186:187], v230 offset:20992
    v_mul_f32 v31, v31, v51
    v_mfma_f32_16x16x32_bf16 v[184:187], v[80:83], a[172:175], v[184:187]
    ds_read_b64_tr_b16 a[188:189], v231 offset:20480
    v_cvt_pk_bf16_f32 v7, v30, v31
    v_mfma_f32_16x16x32_bf16 v[188:191], v[84:87], a[172:175], v[188:191]
    ds_read_b64_tr_b16 a[190:191], v231 offset:20992
    v_sub_f32 v32, v32, v50
    v_mfma_f32_16x16x32_bf16 v[192:195], v[88:91], a[160:163], v[192:195]
    s_add_u32 m0, s34, 8192
    s_add_u32 s37, s81, 131072
    buffer_load_dwordx4 v232, s[44:47], s37 offen lds
    v_mfma_f32_16x16x32_bf16 v[196:199], v[92:95], a[160:163], v[196:199]
    v_sub_f32 v33, v33, v50
    v_cvt_pk_bf16_f32 v33, v32, v33
    v_mfma_f32_16x16x32_bf16 v[200:203], v[88:91], a[164:167], v[200:203]
    v_lshlrev_b32 v32, 16, v33
    v_and_b32 v33, 0xffff0000, v33
    v_mfma_f32_16x16x32_bf16 v[204:207], v[92:95], a[164:167], v[204:207]
    v_mul_f32 v32, v32, v51
    v_mul_f32 v33, v33, v51
    v_mfma_f32_16x16x32_bf16 v[208:211], v[88:91], a[168:171], v[208:211]
    buffer_load_dwordx4 v233, s[44:47], s37 offen offset:1024 lds
    v_cvt_pk_bf16_f32 v8, v32, v33
    v_mfma_f32_16x16x32_bf16 v[212:215], v[92:95], a[168:171], v[212:215]
    v_sub_f32 v34, v34, v50
    v_sub_f32 v35, v35, v50
    v_mfma_f32_16x16x32_bf16 v[216:219], v[88:91], a[172:175], v[216:219]
    v_cvt_pk_bf16_f32 v35, v34, v35
    v_lshlrev_b32 v34, 16, v35
    v_mfma_f32_16x16x32_bf16 v[220:223], v[92:95], a[172:175], v[220:223]
    v_and_b32 v35, 0xffff0000, v35
    v_mul_f32 v34, v34, v51
    s_waitcnt vmcnt(14) lgkmcnt(0)
    v_mfma_f32_16x16x32_bf16 v[96:99], v[64:67], a[176:179], v[96:99]
    ds_read_b128 v[80:83], v225 offset:24576
    v_mul_f32 v35, v35, v51
    v_mfma_f32_16x16x32_bf16 v[100:103], v[68:71], a[176:179], v[100:103]
    ds_read_b128 v[84:87], v225 offset:26624
    v_cvt_pk_bf16_f32 v9, v34, v35
    v_mfma_f32_16x16x32_bf16 v[104:107], v[64:67], a[180:183], v[104:107]
    ds_read_b128 v[88:91], v225 offset:28672
    v_sub_f32 v36, v36, v50
    v_mfma_f32_16x16x32_bf16 v[108:111], v[68:71], a[180:183], v[108:111]
    ds_read_b128 v[92:95], v225 offset:30720
    v_sub_f32 v37, v37, v50
    v_mfma_f32_16x16x32_bf16 v[112:115], v[64:67], a[184:187], v[112:115]
    ds_read_b64_tr_b16 a[192:193], v228 offset:0
    v_cvt_pk_bf16_f32 v37, v36, v37
    v_mfma_f32_16x16x32_bf16 v[116:119], v[68:71], a[184:187], v[116:119]
    ds_read_b64_tr_b16 a[194:195], v228 offset:512
    v_lshlrev_b32 v36, 16, v37
    v_mfma_f32_16x16x32_bf16 v[120:123], v[64:67], a[188:191], v[120:123]
    ds_read_b64_tr_b16 a[196:197], v229 offset:0
    v_and_b32 v37, 0xffff0000, v37
    v_mfma_f32_16x16x32_bf16 v[124:127], v[68:71], a[188:191], v[124:127]
    ds_read_b64_tr_b16 a[198:199], v229 offset:512
    v_mul_f32 v36, v36, v51
    v_mfma_f32_16x16x32_bf16 v[128:131], v[72:75], a[176:179], v[128:131]
    v_mul_f32 v37, v37, v51
    v_cvt_pk_bf16_f32 v10, v36, v37
    v_mfma_f32_16x16x32_bf16 v[132:135], v[76:79], a[176:179], v[132:135]
    v_sub_f32 v38, v38, v50
    v_sub_f32 v39, v39, v50
    v_mfma_f32_16x16x32_bf16 v[136:139], v[72:75], a[180:183], v[136:139]
    v_cvt_pk_bf16_f32 v39, v38, v39
    v_lshlrev_b32 v38, 16, v39
    v_mfma_f32_16x16x32_bf16 v[140:143], v[76:79], a[180:183], v[140:143]
    v_and_b32 v39, 0xffff0000, v39
    v_mul_f32 v38, v38, v51
    v_mfma_f32_16x16x32_bf16 v[144:147], v[72:75], a[184:187], v[144:147]
    v_mul_f32 v39, v39, v51
    v_cvt_pk_bf16_f32 v11, v38, v39
    v_mfma_f32_16x16x32_bf16 v[148:151], v[76:79], a[184:187], v[148:151]
    v_sub_f32 v40, v40, v50
    v_sub_f32 v41, v41, v50
    v_mfma_f32_16x16x32_bf16 v[152:155], v[72:75], a[188:191], v[152:155]
    v_cvt_pk_bf16_f32 v41, v40, v41
    v_lshlrev_b32 v40, 16, v41
    v_mfma_f32_16x16x32_bf16 v[156:159], v[76:79], a[188:191], v[156:159]
    s_waitcnt vmcnt(24) lgkmcnt(0)
    s_barrier
    v_mfma_f32_16x16x32_bf16 v[160:163], v[80:83], a[176:179], v[160:163]
    ds_read_b128 v[64:67], v224 offset:32768
    v_and_b32 v41, 0xffff0000, v41
    v_mfma_f32_16x16x32_bf16 v[164:167], v[84:87], a[176:179], v[164:167]
    ds_read_b128 v[68:71], v224 offset:34816
    v_mul_f32 v40, v40, v51
    v_mfma_f32_16x16x32_bf16 v[168:171], v[80:83], a[180:183], v[168:171]
    ds_read_b128 v[72:75], v224 offset:36864
    v_mul_f32 v41, v41, v51
    v_mfma_f32_16x16x32_bf16 v[172:175], v[84:87], a[180:183], v[172:175]
    ds_read_b128 v[76:79], v224 offset:38912
    v_cvt_pk_bf16_f32 v12, v40, v41
    v_mfma_f32_16x16x32_bf16 v[176:179], v[80:83], a[184:187], v[176:179]
    ds_read_b64_tr_b16 a[200:201], v230 offset:0
    v_sub_f32 v42, v42, v50
    v_mfma_f32_16x16x32_bf16 v[180:183], v[84:87], a[184:187], v[180:183]
    ds_read_b64_tr_b16 a[202:203], v230 offset:512
    v_sub_f32 v43, v43, v50
    v_mfma_f32_16x16x32_bf16 v[184:187], v[80:83], a[188:191], v[184:187]
    ds_read_b64_tr_b16 a[204:205], v231 offset:0
    v_cvt_pk_bf16_f32 v43, v42, v43
    v_mfma_f32_16x16x32_bf16 v[188:191], v[84:87], a[188:191], v[188:191]
    ds_read_b64_tr_b16 a[206:207], v231 offset:512
    v_lshlrev_b32 v42, 16, v43
    v_mfma_f32_16x16x32_bf16 v[192:195], v[88:91], a[176:179], v[192:195]
    s_add_u32 m0, s34, 16384
    s_add_u32 s37, s82, 131072
    buffer_load_dwordx4 v232, s[44:47], s37 offen lds
    v_mfma_f32_16x16x32_bf16 v[196:199], v[92:95], a[176:179], v[196:199]
    v_and_b32 v43, 0xffff0000, v43
    v_mul_f32 v42, v42, v51
    v_mfma_f32_16x16x32_bf16 v[200:203], v[88:91], a[180:183], v[200:203]
    v_mul_f32 v43, v43, v51
    v_cvt_pk_bf16_f32 v13, v42, v43
    v_mfma_f32_16x16x32_bf16 v[204:207], v[92:95], a[180:183], v[204:207]
    v_sub_f32 v44, v44, v50
    v_sub_f32 v45, v45, v50
    v_mfma_f32_16x16x32_bf16 v[208:211], v[88:91], a[184:187], v[208:211]
    buffer_load_dwordx4 v233, s[44:47], s37 offen offset:1024 lds
    v_cvt_pk_bf16_f32 v45, v44, v45
    v_mfma_f32_16x16x32_bf16 v[212:215], v[92:95], a[184:187], v[212:215]
    v_lshlrev_b32 v44, 16, v45
    v_and_b32 v45, 0xffff0000, v45
    v_mfma_f32_16x16x32_bf16 v[216:219], v[88:91], a[188:191], v[216:219]
    v_mul_f32 v44, v44, v51
    v_mul_f32 v45, v45, v51
    v_mfma_f32_16x16x32_bf16 v[220:223], v[92:95], a[188:191], v[220:223]
    v_cvt_pk_bf16_f32 v14, v44, v45
    s_waitcnt lgkmcnt(0)
    v_mfma_f32_16x16x32_bf16 v[96:99], v[64:67], a[192:195], v[96:99]
    ds_read_b128 v[80:83], v224 offset:40960
    v_sub_f32 v46, v46, v50
    v_mfma_f32_16x16x32_bf16 v[100:103], v[68:71], a[192:195], v[100:103]
    ds_read_b128 v[84:87], v224 offset:43008
    v_sub_f32 v47, v47, v50
    v_mfma_f32_16x16x32_bf16 v[104:107], v[64:67], a[196:199], v[104:107]
    ds_read_b128 v[88:91], v224 offset:45056
    v_cvt_pk_bf16_f32 v47, v46, v47
    v_mfma_f32_16x16x32_bf16 v[108:111], v[68:71], a[196:199], v[108:111]
    ds_read_b128 v[92:95], v224 offset:47104
    v_lshlrev_b32 v46, 16, v47
    v_mfma_f32_16x16x32_bf16 v[112:115], v[64:67], a[200:203], v[112:115]
    ds_read_b64_tr_b16 a[208:209], v228 offset:4096
    v_and_b32 v47, 0xffff0000, v47
    v_mfma_f32_16x16x32_bf16 v[116:119], v[68:71], a[200:203], v[116:119]
    ds_read_b64_tr_b16 a[210:211], v228 offset:4608
    v_mul_f32 v46, v46, v51
    v_mfma_f32_16x16x32_bf16 v[120:123], v[64:67], a[204:207], v[120:123]
    ds_read_b64_tr_b16 a[212:213], v229 offset:4096
    v_mul_f32 v47, v47, v51
    v_mfma_f32_16x16x32_bf16 v[124:127], v[68:71], a[204:207], v[124:127]
    ds_read_b64_tr_b16 a[214:215], v229 offset:4608
    v_cvt_pk_bf16_f32 v15, v46, v47
    v_mfma_f32_16x16x32_bf16 v[128:131], v[72:75], a[192:195], v[128:131]
    v_mfma_f32_16x16x32_bf16 v[132:135], v[76:79], a[192:195], v[132:135]
    ds_write_b128 v237, v[0:3] offset:0
    v_mfma_f32_16x16x32_bf16 v[136:139], v[72:75], a[196:199], v[136:139]
    ds_write_b128 v237, v[4:7] offset:4096
    v_mfma_f32_16x16x32_bf16 v[140:143], v[76:79], a[196:199], v[140:143]
    ds_write_b128 v237, v[8:11] offset:24576
    v_mfma_f32_16x16x32_bf16 v[144:147], v[72:75], a[200:203], v[144:147]
    ds_write_b128 v237, v[12:15] offset:28672
    v_mfma_f32_16x16x32_bf16 v[148:151], v[76:79], a[200:203], v[148:151]
    v_mfma_f32_16x16x32_bf16 v[152:155], v[72:75], a[204:207], v[152:155]
    v_mfma_f32_16x16x32_bf16 v[156:159], v[76:79], a[204:207], v[156:159]
    s_waitcnt lgkmcnt(0)
    v_mfma_f32_16x16x32_bf16 v[160:163], v[80:83], a[192:195], v[160:163]
    ds_read_b128 v[64:67], v225 offset:32768
    v_mfma_f32_16x16x32_bf16 v[164:167], v[84:87], a[192:195], v[164:167]
    ds_read_b128 v[68:71], v225 offset:34816
    v_mfma_f32_16x16x32_bf16 v[168:171], v[80:83], a[196:199], v[168:171]
    ds_read_b128 v[72:75], v225 offset:36864
    v_mfma_f32_16x16x32_bf16 v[172:175], v[84:87], a[196:199], v[172:175]
    ds_read_b128 v[76:79], v225 offset:38912
    v_mfma_f32_16x16x32_bf16 v[176:179], v[80:83], a[200:203], v[176:179]
    ds_read_b64_tr_b16 a[216:217], v230 offset:4096
    v_mfma_f32_16x16x32_bf16 v[180:183], v[84:87], a[200:203], v[180:183]
    ds_read_b64_tr_b16 a[218:219], v230 offset:4608
    v_mfma_f32_16x16x32_bf16 v[184:187], v[80:83], a[204:207], v[184:187]
    ds_read_b64_tr_b16 a[220:221], v231 offset:4096
    v_mfma_f32_16x16x32_bf16 v[188:191], v[84:87], a[204:207], v[188:191]
    ds_read_b64_tr_b16 a[222:223], v231 offset:4608
    v_mfma_f32_16x16x32_bf16 v[192:195], v[88:91], a[192:195], v[192:195]
    s_add_u32 m0, s34, 24576
    s_add_u32 s37, s83, 131072
    buffer_load_dwordx4 v232, s[44:47], s37 offen lds
    v_mfma_f32_16x16x32_bf16 v[196:199], v[92:95], a[192:195], v[196:199]
    v_mfma_f32_16x16x32_bf16 v[200:203], v[88:91], a[196:199], v[200:203]
    buffer_load_dwordx4 v233, s[44:47], s37 offen offset:1024 lds
    v_mfma_f32_16x16x32_bf16 v[204:207], v[92:95], a[196:199], v[204:207]
    v_mfma_f32_16x16x32_bf16 v[208:211], v[88:91], a[200:203], v[208:211]
    v_mfma_f32_16x16x32_bf16 v[212:215], v[92:95], a[200:203], v[212:215]
    buffer_load_dword v254, off, s[88:91], s97 sc1
    v_mfma_f32_16x16x32_bf16 v[216:219], v[88:91], a[204:207], v[216:219]
    v_mfma_f32_16x16x32_bf16 v[220:223], v[92:95], a[204:207], v[220:223]
    s_waitcnt vmcnt(7) lgkmcnt(0)
    v_mfma_f32_16x16x32_bf16 v[96:99], v[64:67], a[208:211], v[96:99]
    ds_read_b128 v[80:83], v225 offset:40960
    v_mfma_f32_16x16x32_bf16 v[100:103], v[68:71], a[208:211], v[100:103]
    ds_read_b128 v[84:87], v225 offset:43008
    s_mul_i32 s38, s2, 100
    v_mfma_f32_16x16x32_bf16 v[104:107], v[64:67], a[212:215], v[104:107]
    ds_read_b128 v[88:91], v225 offset:45056
    v_mfma_f32_16x16x32_bf16 v[108:111], v[68:71], a[212:215], v[108:111]
    ds_read_b128 v[92:95], v225 offset:47104
    v_mfma_f32_16x16x32_bf16 v[112:115], v[64:67], a[216:219], v[112:115]
    ds_read_b64_tr_b16 a[224:225], v228 offset:8192
    v_lshl_add_u32 v60, v253, 2, s38
    v_mfma_f32_16x16x32_bf16 v[116:119], v[68:71], a[216:219], v[116:119]
    ds_read_b64_tr_b16 a[226:227], v228 offset:8704
    v_mfma_f32_16x16x32_bf16 v[120:123], v[64:67], a[220:223], v[120:123]
    ds_read_b64_tr_b16 a[228:229], v229 offset:8192
    v_mfma_f32_16x16x32_bf16 v[124:127], v[68:71], a[220:223], v[124:127]
    ds_read_b64_tr_b16 a[230:231], v229 offset:8704
    v_cmp_gt_u32 vcc, 25, v253
    v_mfma_f32_16x16x32_bf16 v[128:131], v[72:75], a[208:211], v[128:131]
    v_mov_b32 v61, 0
    v_mfma_f32_16x16x32_bf16 v[132:135], v[76:79], a[208:211], v[132:135]
    v_mfma_f32_16x16x32_bf16 v[136:139], v[72:75], a[212:215], v[136:139]
    v_mov_b32 v62, 0x7ffffff0
    v_mfma_f32_16x16x32_bf16 v[140:143], v[76:79], a[212:215], v[140:143]
    v_cndmask_b32 v60, v62, v60, vcc
    v_mfma_f32_16x16x32_bf16 v[144:147], v[72:75], a[216:219], v[144:147]
    v_mfma_f32_16x16x32_bf16 v[148:151], v[76:79], a[216:219], v[148:151]
    buffer_store_dword v61, v60, s[56:59], 0 offen sc1
    v_mfma_f32_16x16x32_bf16 v[152:155], v[72:75], a[220:223], v[152:155]
    v_mfma_f32_16x16x32_bf16 v[156:159], v[76:79], a[220:223], v[156:159]
    s_waitcnt vmcnt(18) lgkmcnt(0)
    s_barrier
    v_mfma_f32_16x16x32_bf16 v[160:163], v[80:83], a[208:211], v[160:163]
    ds_read_b128 v[64:67], v224 offset:49152
    v_mfma_f32_16x16x32_bf16 v[164:167], v[84:87], a[208:211], v[164:167]
    ds_read_b128 v[68:71], v224 offset:51200
    v_mfma_f32_16x16x32_bf16 v[168:171], v[80:83], a[212:215], v[168:171]
    ds_read_b128 v[72:75], v224 offset:53248
    v_mfma_f32_16x16x32_bf16 v[172:175], v[84:87], a[212:215], v[172:175]
    ds_read_b128 v[76:79], v224 offset:55296
    v_mfma_f32_16x16x32_bf16 v[176:179], v[80:83], a[216:219], v[176:179]
    ds_read_b64_tr_b16 a[232:233], v230 offset:8192
    v_mfma_f32_16x16x32_bf16 v[180:183], v[84:87], a[216:219], v[180:183]
    ds_read_b64_tr_b16 a[234:235], v230 offset:8704
    v_mfma_f32_16x16x32_bf16 v[184:187], v[80:83], a[220:223], v[184:187]
    ds_read_b64_tr_b16 a[236:237], v231 offset:8192
    v_mfma_f32_16x16x32_bf16 v[188:191], v[84:87], a[220:223], v[188:191]
    ds_read_b64_tr_b16 a[238:239], v231 offset:8704
    v_mfma_f32_16x16x32_bf16 v[192:195], v[88:91], a[208:211], v[192:195]
    v_lshlrev_b32 v237, 4, v253
    v_add_u32 v237, 81920, v237
    ds_read_b128 v[16:19], v237 offset:0
    ds_read_b128 v[20:23], v237 offset:4096
    ds_read_b128 v[24:27], v237 offset:24576
    ds_read_b128 v[28:31], v237 offset:28672
    s_add_u32 m0, s34, 32768
    s_add_u32 s37, s84, 131072
    buffer_load_dwordx4 v232, s[44:47], s37 offen lds
    v_mfma_f32_16x16x32_bf16 v[196:199], v[92:95], a[208:211], v[196:199]
    v_mfma_f32_16x16x32_bf16 v[200:203], v[88:91], a[212:215], v[200:203]
    v_mfma_f32_16x16x32_bf16 v[204:207], v[92:95], a[212:215], v[204:207]
    v_mfma_f32_16x16x32_bf16 v[208:211], v[88:91], a[216:219], v[208:211]
    buffer_load_dwordx4 v233, s[44:47], s37 offen offset:1024 lds
    v_mfma_f32_16x16x32_bf16 v[212:215], v[92:95], a[216:219], v[212:215]
    v_mfma_f32_16x16x32_bf16 v[216:219], v[88:91], a[220:223], v[216:219]
    v_mfma_f32_16x16x32_bf16 v[220:223], v[92:95], a[220:223], v[220:223]
    s_waitcnt lgkmcnt(0)
    v_mfma_f32_16x16x32_bf16 v[96:99], v[64:67], a[224:227], v[96:99]
    ds_read_b128 v[80:83], v224 offset:57344
    v_mfma_f32_16x16x32_bf16 v[100:103], v[68:71], a[224:227], v[100:103]
    ds_read_b128 v[84:87], v224 offset:59392
    v_mfma_f32_16x16x32_bf16 v[104:107], v[64:67], a[228:231], v[104:107]
    ds_read_b128 v[88:91], v224 offset:61440
    v_mfma_f32_16x16x32_bf16 v[108:111], v[68:71], a[228:231], v[108:111]
    ds_read_b128 v[92:95], v224 offset:63488
    v_mfma_f32_16x16x32_bf16 v[112:115], v[64:67], a[232:235], v[112:115]
    ds_read_b64_tr_b16 a[240:241], v228 offset:12288
    v_mfma_f32_16x16x32_bf16 v[116:119], v[68:71], a[232:235], v[116:119]
    ds_read_b64_tr_b16 a[242:243], v228 offset:12800
    s_mov_b32 s39, 0
    buffer_store_dwordx4 v[16:19], v238, s[8:11], s39 offen sc1
    v_mfma_f32_16x16x32_bf16 v[120:123], v[64:67], a[236:239], v[120:123]
    ds_read_b64_tr_b16 a[244:245], v229 offset:12288
    v_mfma_f32_16x16x32_bf16 v[124:127], v[68:71], a[236:239], v[124:127]
    ds_read_b64_tr_b16 a[246:247], v229 offset:12800
    v_mfma_f32_16x16x32_bf16 v[128:131], v[72:75], a[224:227], v[128:131]
    v_mfma_f32_16x16x32_bf16 v[132:135], v[76:79], a[224:227], v[132:135]
    v_mfma_f32_16x16x32_bf16 v[136:139], v[72:75], a[228:231], v[136:139]
    v_mfma_f32_16x16x32_bf16 v[140:143], v[76:79], a[228:231], v[140:143]
    v_mfma_f32_16x16x32_bf16 v[144:147], v[72:75], a[232:235], v[144:147]
    v_mfma_f32_16x16x32_bf16 v[148:151], v[76:79], a[232:235], v[148:151]
    s_mov_b32 s39, 8192
    buffer_store_dwordx4 v[20:23], v238, s[8:11], s39 offen sc1
    v_mfma_f32_16x16x32_bf16 v[152:155], v[72:75], a[236:239], v[152:155]
    v_mfma_f32_16x16x32_bf16 v[156:159], v[76:79], a[236:239], v[156:159]
    s_waitcnt lgkmcnt(0)
    v_mfma_f32_16x16x32_bf16 v[160:163], v[80:83], a[224:227], v[160:163]
    ds_read_b128 v[64:67], v225 offset:49152
    v_mfma_f32_16x16x32_bf16 v[164:167], v[84:87], a[224:227], v[164:167]
    ds_read_b128 v[68:71], v225 offset:51200
    v_mfma_f32_16x16x32_bf16 v[168:171], v[80:83], a[228:231], v[168:171]
    ds_read_b128 v[72:75], v225 offset:53248
    v_mfma_f32_16x16x32_bf16 v[172:175], v[84:87], a[228:231], v[172:175]
    ds_read_b128 v[76:79], v225 offset:55296
    v_mfma_f32_16x16x32_bf16 v[176:179], v[80:83], a[232:235], v[176:179]
    ds_read_b64_tr_b16 a[248:249], v230 offset:12288
    v_mfma_f32_16x16x32_bf16 v[180:183], v[84:87], a[232:235], v[180:183]
    ds_read_b64_tr_b16 a[250:251], v230 offset:12800
    s_mov_b32 s39, 16384
    buffer_store_dwordx4 v[24:27], v238, s[8:11], s39 offen sc1
    v_mfma_f32_16x16x32_bf16 v[184:187], v[80:83], a[236:239], v[184:187]
    ds_read_b64_tr_b16 a[252:253], v231 offset:12288
    v_mfma_f32_16x16x32_bf16 v[188:191], v[84:87], a[236:239], v[188:191]
    ds_read_b64_tr_b16 a[254:255], v231 offset:12800
    v_mfma_f32_16x16x32_bf16 v[192:195], v[88:91], a[224:227], v[192:195]
    s_add_u32 m0, s34, 40960
    s_add_u32 s37, s85, 131072
    buffer_load_dwordx4 v232, s[44:47], s37 offen lds
    v_mfma_f32_16x16x32_bf16 v[196:199], v[92:95], a[224:227], v[196:199]
    v_mfma_f32_16x16x32_bf16 v[200:203], v[88:91], a[228:231], v[200:203]
    v_mfma_f32_16x16x32_bf16 v[204:207], v[92:95], a[228:231], v[204:207]
    v_mfma_f32_16x16x32_bf16 v[208:211], v[88:91], a[232:235], v[208:211]
    buffer_load_dwordx4 v233, s[44:47], s37 offen offset:1024 lds
    v_mfma_f32_16x16x32_bf16 v[212:215], v[92:95], a[232:235], v[212:215]
    s_mov_b32 s39, 24576
    buffer_store_dwordx4 v[28:31], v238, s[8:11], s39 offen sc1
    v_mfma_f32_16x16x32_bf16 v[216:219], v[88:91], a[236:239], v[216:219]
    v_mfma_f32_16x16x32_bf16 v[220:223], v[92:95], a[236:239], v[220:223]
    s_waitcnt lgkmcnt(0)
    v_mfma_f32_16x16x32_bf16 v[96:99], v[64:67], a[240:243], v[96:99]
    ds_read_b128 v[80:83], v225 offset:57344
    v_mfma_f32_16x16x32_bf16 v[100:103], v[68:71], a[240:243], v[100:103]
    ds_read_b128 v[84:87], v225 offset:59392
    v_mfma_f32_16x16x32_bf16 v[104:107], v[64:67], a[244:247], v[104:107]
    ds_read_b128 v[88:91], v225 offset:61440
    v_mfma_f32_16x16x32_bf16 v[108:111], v[68:71], a[244:247], v[108:111]
    ds_read_b128 v[92:95], v225 offset:63488
    v_mfma_f32_16x16x32_bf16 v[112:115], v[64:67], a[248:251], v[112:115]
    v_mfma_f32_16x16x32_bf16 v[116:119], v[68:71], a[248:251], v[116:119]
    v_mfma_f32_16x16x32_bf16 v[120:123], v[64:67], a[252:255], v[120:123]
    v_mfma_f32_16x16x32_bf16 v[124:127], v[68:71], a[252:255], v[124:127]
    v_mfma_f32_16x16x32_bf16 v[128:131], v[72:75], a[240:243], v[128:131]
    v_mfma_f32_16x16x32_bf16 v[132:135], v[76:79], a[240:243], v[132:135]
    v_cvt_pk_bf16_f32 v0, v96, v97
    v_cvt_pk_bf16_f32 v1, v98, v99
    v_mfma_f32_16x16x32_bf16 v[136:139], v[72:75], a[244:247], v[136:139]
    v_cvt_pk_bf16_f32 v2, v100, v101
    v_cvt_pk_bf16_f32 v3, v102, v103
    v_mfma_f32_16x16x32_bf16 v[140:143], v[76:79], a[244:247], v[140:143]
    v_cvt_pk_bf16_f32 v4, v104, v105
    v_cvt_pk_bf16_f32 v5, v106, v107
    v_mfma_f32_16x16x32_bf16 v[144:147], v[72:75], a[248:251], v[144:147]
    v_cvt_pk_bf16_f32 v6, v108, v109
    v_cvt_pk_bf16_f32 v7, v110, v111
    v_mfma_f32_16x16x32_bf16 v[148:151], v[76:79], a[248:251], v[148:151]
    v_cvt_pk_bf16_f32 v8, v112, v113
    v_cvt_pk_bf16_f32 v9, v114, v115
    v_mfma_f32_16x16x32_bf16 v[152:155], v[72:75], a[252:255], v[152:155]
    v_cvt_pk_bf16_f32 v10, v116, v117
    v_cvt_pk_bf16_f32 v11, v118, v119
    v_mfma_f32_16x16x32_bf16 v[156:159], v[76:79], a[252:255], v[156:159]
    v_cvt_pk_bf16_f32 v12, v120, v121
    v_cvt_pk_bf16_f32 v13, v122, v123
    s_waitcnt vmcnt(14) lgkmcnt(0)
    s_barrier
    v_mfma_f32_16x16x32_bf16 v[160:163], v[80:83], a[240:243], v[160:163]
    ds_read_b128 v[64:67], v224 offset:0
    v_cvt_pk_bf16_f32 v14, v124, v125
    v_cvt_pk_bf16_f32 v15, v126, v127
    v_mfma_f32_16x16x32_bf16 v[164:167], v[84:87], a[240:243], v[164:167]
    ds_read_b128 v[68:71], v224 offset:2048
    v_cvt_pk_bf16_f32 v16, v128, v129
    v_cvt_pk_bf16_f32 v17, v130, v131
    v_mfma_f32_16x16x32_bf16 v[168:171], v[80:83], a[244:247], v[168:171]
    ds_read_b128 v[72:75], v224 offset:4096
    v_cvt_pk_bf16_f32 v18, v132, v133
    v_cvt_pk_bf16_f32 v19, v134, v135
    v_mfma_f32_16x16x32_bf16 v[172:175], v[84:87], a[244:247], v[172:175]
    ds_read_b128 v[76:79], v224 offset:6144
    v_cvt_pk_bf16_f32 v20, v136, v137
    v_cvt_pk_bf16_f32 v21, v138, v139
    v_mfma_f32_16x16x32_bf16 v[176:179], v[80:83], a[248:251], v[176:179]
    v_cvt_pk_bf16_f32 v22, v140, v141
    v_cvt_pk_bf16_f32 v23, v142, v143
    v_mfma_f32_16x16x32_bf16 v[180:183], v[84:87], a[248:251], v[180:183]
    v_cvt_pk_bf16_f32 v24, v144, v145
    v_cvt_pk_bf16_f32 v25, v146, v147
    v_mfma_f32_16x16x32_bf16 v[184:187], v[80:83], a[252:255], v[184:187]
    v_cvt_pk_bf16_f32 v26, v148, v149
    v_cvt_pk_bf16_f32 v27, v150, v151
    v_mfma_f32_16x16x32_bf16 v[188:191], v[84:87], a[252:255], v[188:191]
    v_cvt_pk_bf16_f32 v28, v152, v153
    v_cvt_pk_bf16_f32 v29, v154, v155
    v_mfma_f32_16x16x32_bf16 v[192:195], v[88:91], a[240:243], v[192:195]
    s_add_u32 m0, s34, 49152
    s_add_u32 s37, s86, 131072
    buffer_load_dwordx4 v232, s[44:47], s37 offen lds
    v_cvt_pk_bf16_f32 v30, v156, v157
    v_cvt_pk_bf16_f32 v31, v158, v159
    v_mfma_f32_16x16x32_bf16 v[196:199], v[92:95], a[240:243], v[196:199]
    v_cvt_pk_bf16_f32 v32, v160, v161
    v_cvt_pk_bf16_f32 v33, v162, v163
    v_mfma_f32_16x16x32_bf16 v[200:203], v[88:91], a[244:247], v[200:203]
    v_cvt_pk_bf16_f32 v34, v164, v165
    v_cvt_pk_bf16_f32 v35, v166, v167
    v_mfma_f32_16x16x32_bf16 v[204:207], v[92:95], a[244:247], v[204:207]
    v_cvt_pk_bf16_f32 v36, v168, v169
    v_cvt_pk_bf16_f32 v37, v170, v171
    v_mfma_f32_16x16x32_bf16 v[208:211], v[88:91], a[248:251], v[208:211]
    buffer_load_dwordx4 v233, s[44:47], s37 offen offset:1024 lds
    v_cvt_pk_bf16_f32 v38, v172, v173
    v_cvt_pk_bf16_f32 v39, v174, v175
    v_mfma_f32_16x16x32_bf16 v[212:215], v[92:95], a[248:251], v[212:215]
    v_cvt_pk_bf16_f32 v40, v176, v177
    v_cvt_pk_bf16_f32 v41, v178, v179
    v_mfma_f32_16x16x32_bf16 v[216:219], v[88:91], a[252:255], v[216:219]
    v_cvt_pk_bf16_f32 v42, v180, v181
    v_cvt_pk_bf16_f32 v43, v182, v183
    v_mfma_f32_16x16x32_bf16 v[220:223], v[92:95], a[252:255], v[220:223]
    v_cvt_pk_bf16_f32 v44, v184, v185
    v_cvt_pk_bf16_f32 v45, v186, v187
    s_waitcnt lgkmcnt(0)
    v_mfma_f32_16x16x32_bf16 v[96:99], v[64:67], a[0:3], 0
    ds_read_b128 v[80:83], v225 offset:0
    v_cvt_pk_bf16_f32 v46, v188, v189
    v_cvt_pk_bf16_f32 v47, v190, v191
    v_mfma_f32_16x16x32_bf16 v[100:103], v[68:71], a[0:3], 0
    ds_read_b128 v[84:87], v225 offset:2048
    v_cvt_pk_bf16_f32 v48, v192, v193
    v_cvt_pk_bf16_f32 v49, v194, v195
    v_mfma_f32_16x16x32_bf16 v[104:107], v[64:67], a[4:7], 0
    ds_read_b128 v[88:91], v225 offset:4096
    v_cvt_pk_bf16_f32 v50, v196, v197
    v_cvt_pk_bf16_f32 v51, v198, v199
    v_mfma_f32_16x16x32_bf16 v[108:111], v[68:71], a[4:7], 0
    ds_read_b128 v[92:95], v225 offset:6144
    v_cvt_pk_bf16_f32 v52, v200, v201
    v_cvt_pk_bf16_f32 v53, v202, v203
    v_mfma_f32_16x16x32_bf16 v[112:115], v[64:67], a[8:11], 0
    v_cvt_pk_bf16_f32 v54, v204, v205
    v_cvt_pk_bf16_f32 v55, v206, v207
    s_add_u32 s38, s36, 0
    buffer_store_dwordx4 v[0:3], v240, s[16:19], s38 offen offset:0 sc1
    v_mfma_f32_16x16x32_bf16 v[116:119], v[68:71], a[8:11], 0
    v_cvt_pk_bf16_f32 v56, v208, v209
    v_cvt_pk_bf16_f32 v57, v210, v211
    v_mfma_f32_16x16x32_bf16 v[120:123], v[64:67], a[12:15], 0
    v_cvt_pk_bf16_f32 v58, v212, v213
    v_cvt_pk_bf16_f32 v59, v214, v215
    v_mfma_f32_16x16x32_bf16 v[124:127], v[68:71], a[12:15], 0
    v_cvt_pk_bf16_f32 v60, v216, v217
    v_cvt_pk_bf16_f32 v61, v218, v219
    v_mfma_f32_16x16x32_bf16 v[128:131], v[72:75], a[0:3], 0
    v_xor_b32 v237, 32, v245
    v_xor_b32 v238, 32, v246
    v_cvt_pk_bf16_f32 v62, v220, v221
    v_cvt_pk_bf16_f32 v63, v222, v223
    v_mfma_f32_16x16x32_bf16 v[132:135], v[76:79], a[0:3], 0
    v_mfma_f32_16x16x32_bf16 v[136:139], v[72:75], a[4:7], 0
    v_mfma_f32_16x16x32_bf16 v[140:143], v[76:79], a[4:7], 0
    v_mfma_f32_16x16x32_bf16 v[144:147], v[72:75], a[8:11], 0
    v_mfma_f32_16x16x32_bf16 v[148:151], v[76:79], a[8:11], 0
    v_mfma_f32_16x16x32_bf16 v[152:155], v[72:75], a[12:15], 0
    v_mfma_f32_16x16x32_bf16 v[156:159], v[76:79], a[12:15], 0
    s_waitcnt lgkmcnt(0)
    v_mfma_f32_16x16x32_bf16 v[96:99], v[80:83], a[16:19], v[96:99]
    ds_read_b128 v[64:67], v224 offset:8192
    v_mfma_f32_16x16x32_bf16 v[100:103], v[84:87], a[16:19], v[100:103]
    ds_read_b128 v[68:71], v224 offset:10240
    v_mfma_f32_16x16x32_bf16 v[104:107], v[80:83], a[20:23], v[104:107]
    ds_read_b128 v[72:75], v224 offset:12288
    v_mfma_f32_16x16x32_bf16 v[108:111], v[84:87], a[20:23], v[108:111]
    ds_read_b128 v[76:79], v224 offset:14336
    v_mfma_f32_16x16x32_bf16 v[112:115], v[80:83], a[24:27], v[112:115]
    v_mfma_f32_16x16x32_bf16 v[116:119], v[84:87], a[24:27], v[116:119]
    v_mfma_f32_16x16x32_bf16 v[120:123], v[80:83], a[28:31], v[120:123]
    v_mfma_f32_16x16x32_bf16 v[124:127], v[84:87], a[28:31], v[124:127]
    v_mfma_f32_16x16x32_bf16 v[128:131], v[88:91], a[16:19], v[128:131]
    s_add_u32 m0, s34, 57344
    s_add_u32 s37, s87, 131072
    buffer_load_dwordx4 v232, s[44:47], s37 offen lds
    v_mfma_f32_16x16x32_bf16 v[132:135], v[92:95], a[16:19], v[132:135]
    s_add_u32 s38, s36, 0
    buffer_store_dwordx4 v[4:7], v240, s[16:19], s38 offen offset:1024 sc1
    v_mfma_f32_16x16x32_bf16 v[136:139], v[88:91], a[20:23], v[136:139]
    v_mfma_f32_16x16x32_bf16 v[140:143], v[92:95], a[20:23], v[140:143]
    v_mfma_f32_16x16x32_bf16 v[144:147], v[88:91], a[24:27], v[144:147]
    buffer_load_dwordx4 v233, s[44:47], s37 offen offset:1024 lds
    v_mfma_f32_16x16x32_bf16 v[148:151], v[92:95], a[24:27], v[148:151]
    v_mfma_f32_16x16x32_bf16 v[152:155], v[88:91], a[28:31], v[152:155]
    v_mfma_f32_16x16x32_bf16 v[156:159], v[92:95], a[28:31], v[156:159]
    s_waitcnt lgkmcnt(0)
    v_mfma_f32_16x16x32_bf16 v[96:99], v[64:67], a[32:35], v[96:99]
    ds_read_b128 v[80:83], v225 offset:8192
    v_mfma_f32_16x16x32_bf16 v[100:103], v[68:71], a[32:35], v[100:103]
    ds_read_b128 v[84:87], v225 offset:10240
    v_mfma_f32_16x16x32_bf16 v[104:107], v[64:67], a[36:39], v[104:107]
    ds_read_b128 v[88:91], v225 offset:12288
    v_mfma_f32_16x16x32_bf16 v[108:111], v[68:71], a[36:39], v[108:111]
    ds_read_b128 v[92:95], v225 offset:14336
    v_mfma_f32_16x16x32_bf16 v[112:115], v[64:67], a[40:43], v[112:115]
    v_mfma_f32_16x16x32_bf16 v[116:119], v[68:71], a[40:43], v[116:119]
    v_mfma_f32_16x16x32_bf16 v[120:123], v[64:67], a[44:47], v[120:123]
    v_mfma_f32_16x16x32_bf16 v[124:127], v[68:71], a[44:47], v[124:127]
    v_mfma_f32_16x16x32_bf16 v[128:131], v[72:75], a[32:35], v[128:131]
    s_waitcnt vmcnt(15)
    v_readfirstlane_b32 s24, v254
    s_lshl_b32 s25, s3, 16
    s_add_u32 s24, s24, s25
    s_cmp_ge_u32 s24, 1
    s_cbranch_scc0 kf_spin45
kf_spinr46:
    v_mfma_f32_16x16x32_bf16 v[132:135], v[76:79], a[32:35], v[132:135]
    v_mfma_f32_16x16x32_bf16 v[136:139], v[72:75], a[36:39], v[136:139]
    v_mfma_f32_16x16x32_bf16 v[140:143], v[76:79], a[36:39], v[140:143]
    v_mfma_f32_16x16x32_bf16 v[144:147], v[72:75], a[40:43], v[144:147]
    s_add_u32 s88, s20, 0x14a0000
    s_addc_u32 s89, s21, 0
    s_mov_b32 s90, 16384
    v_mfma_f32_16x16x32_bf16 v[148:151], v[76:79], a[40:43], v[148:151]
    v_mfma_f32_16x16x32_bf16 v[152:155], v[72:75], a[44:47], v[152:155]
    v_mfma_f32_16x16x32_bf16 v[156:159], v[76:79], a[44:47], v[156:159]
    s_add_u32 s38, s36, 0
    buffer_store_dwordx4 v[8:11], v240, s[16:19], s38 offen offset:2048 sc1
    s_waitcnt vmcnt(7) lgkmcnt(0)
    s_barrier
    v_mfma_f32_16x16x32_bf16 v[96:99], v[80:83], a[48:51], v[96:99]
    ds_read_b128 v[64:67], v224 offset:16384
    v_mfma_f32_16x16x32_bf16 v[100:103], v[84:87], a[48:51], v[100:103]
    ds_read_b128 v[68:71], v224 offset:18432
    v_mfma_f32_16x16x32_bf16 v[104:107], v[80:83], a[52:55], v[104:107]
    ds_read_b128 v[72:75], v224 offset:20480
    v_mfma_f32_16x16x32_bf16 v[108:111], v[84:87], a[52:55], v[108:111]
    ds_read_b128 v[76:79], v224 offset:22528
    v_mfma_f32_16x16x32_bf16 v[112:115], v[80:83], a[56:59], v[112:115]
    v_mfma_f32_16x16x32_bf16 v[116:119], v[84:87], a[56:59], v[116:119]
    v_mfma_f32_16x16x32_bf16 v[120:123], v[80:83], a[60:63], v[120:123]
    v_mfma_f32_16x16x32_bf16 v[124:127], v[84:87], a[60:63], v[124:127]
    v_mfma_f32_16x16x32_bf16 v[128:131], v[88:91], a[48:51], v[128:131]
    s_add_u32 m0, s34, 0
    s_add_u32 s37, s80, 196608
    buffer_load_dwordx4 v232, s[44:47], s37 offen lds
    v_mfma_f32_16x16x32_bf16 v[132:135], v[92:95], a[48:51], v[132:135]
    v_mfma_f32_16x16x32_bf16 v[136:139], v[88:91], a[52:55], v[136:139]
    buffer_load_dwordx4 v233, s[44:47], s37 offen offset:1024 lds
    v_mfma_f32_16x16x32_bf16 v[140:143], v[92:95], a[52:55], v[140:143]
    v_mfma_f32_16x16x32_bf16 v[144:147], v[88:91], a[56:59], v[144:147]
    v_mfma_f32_16x16x32_bf16 v[148:151], v[92:95], a[56:59], v[148:151]
    s_lshl_b32 s39, s5, 7
    s_add_u32 s39, s39, 8192
    buffer_atomic_add v255, v250, s[88:91], s39 offen sc1
    s_cmp_eq_u32 s3, 0
    s_cselect_b32 s39, s39, s43
    v_mfma_f32_16x16x32_bf16 v[152:155], v[88:91], a[60:63], v[152:155]
    v_mfma_f32_16x16x32_bf16 v[156:159], v[92:95], a[60:63], v[156:159]
    s_waitcnt lgkmcnt(0)
    v_mfma_f32_16x16x32_bf16 v[96:99], v[64:67], a[64:67], v[96:99]
    ds_read_b128 v[80:83], v225 offset:16384
    v_mfma_f32_16x16x32_bf16 v[100:103], v[68:71], a[64:67], v[100:103]
    ds_read_b128 v[84:87], v225 offset:18432
    v_mfma_f32_16x16x32_bf16 v[104:107], v[64:67], a[68:71], v[104:107]
    ds_read_b128 v[88:91], v225 offset:20480
    v_mfma_f32_16x16x32_bf16 v[108:111], v[68:71], a[68:71], v[108:111]
    ds_read_b128 v[92:95], v225 offset:22528
    v_mfma_f32_16x16x32_bf16 v[112:115], v[64:67], a[72:75], v[112:115]
    s_add_u32 s38, s36, 0
    buffer_store_dwordx4 v[12:15], v240, s[16:19], s38 offen offset:3072 sc1
    v_mfma_f32_16x16x32_bf16 v[116:119], v[68:71], a[72:75], v[116:119]
    v_mfma_f32_16x16x32_bf16 v[120:123], v[64:67], a[76:79], v[120:123]
    v_mfma_f32_16x16x32_bf16 v[124:127], v[68:71], a[76:79], v[124:127]
    v_mfma_f32_16x16x32_bf16 v[128:131], v[72:75], a[64:67], v[128:131]
    s_add_u32 m0, s31, 0
    s_add_u32 s24, s27, 0
    buffer_load_dwordx4 v245, s[12:15], s24 offen lds
    v_mfma_f32_16x16x32_bf16 v[132:135], v[76:79], a[64:67], v[132:135]
    v_mfma_f32_16x16x32_bf16 v[136:139], v[72:75], a[68:71], v[136:139]
    v_mfma_f32_16x16x32_bf16 v[140:143], v[76:79], a[68:71], v[140:143]
    v_mfma_f32_16x16x32_bf16 v[144:147], v[72:75], a[72:75], v[144:147]
    v_mfma_f32_16x16x32_bf16 v[148:151], v[76:79], a[72:75], v[148:151]
    v_mfma_f32_16x16x32_bf16 v[152:155], v[72:75], a[76:79], v[152:155]
    v_mfma_f32_16x16x32_bf16 v[156:159], v[76:79], a[76:79], v[156:159]
    s_waitcnt lgkmcnt(0)
    v_mfma_f32_16x16x32_bf16 v[96:99], v[80:83], a[80:83], v[96:99]
    ds_read_b128 v[64:67], v224 offset:24576
    v_mfma_f32_16x16x32_bf16 v[100:103], v[84:87], a[80:83], v[100:103]
    ds_read_b128 v[68:71], v224 offset:26624
    v_mfma_f32_16x16x32_bf16 v[104:107], v[80:83], a[84:87], v[104:107]
    ds_read_b128 v[72:75], v224 offset:28672
    v_mfma_f32_16x16x32_bf16 v[108:111], v[84:87], a[84:87], v[108:111]
    ds_read_b128 v[76:79], v224 offset:30720
    v_mfma_f32_16x16x32_bf16 v[112:115], v[80:83], a[88:91], v[112:115]
    v_mfma_f32_16x16x32_bf16 v[116:119], v[84:87], a[88:91], v[116:119]
    v_mfma_f32_16x16x32_bf16 v[120:123], v[80:83], a[92:95], v[120:123]
    v_mfma_f32_16x16x32_bf16 v[124:127], v[84:87], a[92:95], v[124:127]
    v_mfma_f32_16x16x32_bf16 v[128:131], v[88:91], a[80:83], v[128:131]
    s_add_u32 m0, s34, 8192
    s_add_u32 s37, s81, 196608
    buffer_load_dwordx4 v232, s[44:47], s37 offen lds
    v_mfma_f32_16x16x32_bf16 v[132:135], v[92:95], a[80:83], v[132:135]
    v_mfma_f32_16x16x32_bf16 v[136:139], v[88:91], a[84:87], v[136:139]
    buffer_load_dwordx4 v233, s[44:47], s37 offen offset:1024 lds
    s_add_u32 s38, s36, 8192
    buffer_store_dwordx4 v[16:19], v240, s[16:19], s38 offen offset:0 sc1
    v_mfma_f32_16x16x32_bf16 v[140:143], v[92:95], a[84:87], v[140:143]
    v_mfma_f32_16x16x32_bf16 v[144:147], v[88:91], a[88:91], v[144:147]
    v_mfma_f32_16x16x32_bf16 v[148:151], v[92:95], a[88:91], v[148:151]
    s_add_u32 m0, s31, 1024
    s_add_u32 s24, s27, 32768
    buffer_load_dwordx4 v245, s[12:15], s24 offen lds
    v_mfma_f32_16x16x32_bf16 v[152:155], v[88:91], a[92:95], v[152:155]
    v_mfma_f32_16x16x32_bf16 v[156:159], v[92:95], a[92:95], v[156:159]
    s_waitcnt lgkmcnt(0)
    v_mfma_f32_16x16x32_bf16 v[96:99], v[64:67], a[96:99], v[96:99]
    ds_read_b128 v[80:83], v225 offset:24576
    v_mfma_f32_16x16x32_bf16 v[100:103], v[68:71], a[96:99], v[100:103]
    ds_read_b128 v[84:87], v225 offset:26624
    v_mfma_f32_16x16x32_bf16 v[104:107], v[64:67], a[100:103], v[104:107]
    ds_read_b128 v[88:91], v225 offset:28672
    v_mfma_f32_16x16x32_bf16 v[108:111], v[68:71], a[100:103], v[108:111]
    ds_read_b128 v[92:95], v225 offset:30720
    v_mfma_f32_16x16x32_bf16 v[112:115], v[64:67], a[104:107], v[112:115]
    v_mfma_f32_16x16x32_bf16 v[116:119], v[68:71], a[104:107], v[116:119]
    v_mfma_f32_16x16x32_bf16 v[120:123], v[64:67], a[108:111], v[120:123]
    v_mfma_f32_16x16x32_bf16 v[124:127], v[68:71], a[108:111], v[124:127]
    v_mfma_f32_16x16x32_bf16 v[128:131], v[72:75], a[96:99], v[128:131]
    s_add_u32 m0, s31, 2048
    s_add_u32 s24, s27, 65536
    buffer_load_dwordx4 v237, s[12:15], s24 offen lds
    v_mfma_f32_16x16x32_bf16 v[132:135], v[76:79], a[96:99], v[132:135]
    v_mfma_f32_16x16x32_bf16 v[136:139], v[72:75], a[100:103], v[136:139]
    v_mfma_f32_16x16x32_bf16 v[140:143], v[76:79], a[100:103], v[140:143]
    v_mfma_f32_16x16x32_bf16 v[144:147], v[72:75], a[104:107], v[144:147]
    v_mfma_f32_16x16x32_bf16 v[148:151], v[76:79], a[104:107], v[148:151]
    v_mfma_f32_16x16x32_bf16 v[152:155], v[72:75], a[108:111], v[152:155]
    v_mfma_f32_16x16x32_bf16 v[156:159], v[76:79], a[108:111], v[156:159]
    s_add_u32 s38, s36, 8192
    buffer_store_dwordx4 v[20:23], v240, s[16:19], s38 offen offset:1024 sc1
    s_waitcnt vmcnt(19) lgkmcnt(0)
    s_barrier
    v_mfma_f32_16x16x32_bf16 v[96:99], v[80:83], a[112:115], v[96:99]
    ds_read_b128 v[64:67], v224 offset:32768
    v_mfma_f32_16x16x32_bf16 v[100:103], v[84:87], a[112:115], v[100:103]
    ds_read_b128 v[68:71], v224 offset:34816
    v_mfma_f32_16x16x32_bf16 v[104:107], v[80:83], a[116:119], v[104:107]
    ds_read_b128 v[72:75], v224 offset:36864
    v_mfma_f32_16x16x32_bf16 v[108:111], v[84:87], a[116:119], v[108:111]
    ds_read_b128 v[76:79], v224 offset:38912
    v_mfma_f32_16x16x32_bf16 v[112:115], v[80:83], a[120:123], v[112:115]
    v_mfma_f32_16x16x32_bf16 v[116:119], v[84:87], a[120:123], v[116:119]
    v_mfma_f32_16x16x32_bf16 v[120:123], v[80:83], a[124:127], v[120:123]
    v_mfma_f32_16x16x32_bf16 v[124:127], v[84:87], a[124:127], v[124:127]
    v_mfma_f32_16x16x32_bf16 v[128:131], v[88:91], a[112:115], v[128:131]
    s_add_u32 m0, s34, 16384
    s_add_u32 s37, s82, 196608
    buffer_load_dwordx4 v232, s[44:47], s37 offen lds
    v_mfma_f32_16x16x32_bf16 v[132:135], v[92:95], a[112:115], v[132:135]
    v_mfma_f32_16x16x32_bf16 v[136:139], v[88:91], a[116:119], v[136:139]
    buffer_load_dwordx4 v233, s[44:47], s37 offen offset:1024 lds
    v_mfma_f32_16x16x32_bf16 v[140:143], v[92:95], a[116:119], v[140:143]
    v_mfma_f32_16x16x32_bf16 v[144:147], v[88:91], a[120:123], v[144:147]
    v_mfma_f32_16x16x32_bf16 v[148:151], v[92:95], a[120:123], v[148:151]
    s_add_u32 m0, s31, 3072
    s_add_u32 s24, s27, 98304
    buffer_load_dwordx4 v237, s[12:15], s24 offen lds
    v_mfma_f32_16x16x32_bf16 v[152:155], v[88:91], a[124:127], v[152:155]
    v_mfma_f32_16x16x32_bf16 v[156:159], v[92:95], a[124:127], v[156:159]
    s_waitcnt lgkmcnt(0)
    v_mfma_f32_16x16x32_bf16 v[96:99], v[64:67], a[128:131], v[96:99]
    ds_read_b128 v[80:83], v225 offset:32768
    v_mfma_f32_16x16x32_bf16 v[100:103], v[68:71], a[128:131], v[100:103]
    ds_read_b128 v[84:87], v225 offset:34816
    v_mfma_f32_16x16x32_bf16 v[104:107], v[64:67], a[132:135], v[104:107]
    ds_read_b128 v[88:91], v225 offset:36864
    v_mfma_f32_16x16x32_bf16 v[108:111], v[68:71], a[132:135], v[108:111]
    ds_read_b128 v[92:95], v225 offset:38912
    v_mfma_f32_16x16x32_bf16 v[112:115], v[64:67], a[136:139], v[112:115]
    v_mfma_f32_16x16x32_bf16 v[116:119], v[68:71], a[136:139], v[116:119]
    s_add_u32 s38, s36, 8192
    buffer_store_dwordx4 v[24:27], v240, s[16:19], s38 offen offset:2048 sc1
    v_mfma_f32_16x16x32_bf16 v[120:123], v[64:67], a[140:143], v[120:123]
    v_mfma_f32_16x16x32_bf16 v[124:127], v[68:71], a[140:143], v[124:127]
    v_mfma_f32_16x16x32_bf16 v[128:131], v[72:75], a[128:131], v[128:131]
    s_add_u32 m0, s31, 4096
    s_add_u32 s24, s27, 131072
    buffer_load_dwordx4 v245, s[12:15], s24 offen lds
    v_mfma_f32_16x16x32_bf16 v[132:135], v[76:79], a[128:131], v[132:135]
    v_mfma_f32_16x16x32_bf16 v[136:139], v[72:75], a[132:135], v[136:139]
    v_mfma_f32_16x16x32_bf16 v[140:143], v[76:79], a[132:135], v[140:143]
    v_mfma_f32_16x16x32_bf16 v[144:147], v[72:75], a[136:139], v[144:147]
    v_mfma_f32_16x16x32_bf16 v[148:151], v[76:79], a[136:139], v[148:151]
    v_mfma_f32_16x16x32_bf16 v[152:155], v[72:75], a[140:143], v[152:155]
    v_mfma_f32_16x16x32_bf16 v[156:159], v[76:79], a[140:143], v[156:159]
    s_waitcnt lgkmcnt(0)
    v_mfma_f32_16x16x32_bf16 v[96:99], v[80:83], a[144:147], v[96:99]
    ds_read_b128 v[64:67], v224 offset:40960
    v_mfma_f32_16x16x32_bf16 v[100:103], v[84:87], a[144:147], v[100:103]
    ds_read_b128 v[68:71], v224 offset:43008
    v_mfma_f32_16x16x32_bf16 v[104:107], v[80:83], a[148:151], v[104:107]
    ds_read_b128 v[72:75], v224 offset:45056
    v_mfma_f32_16x16x32_bf16 v[108:111], v[84:87], a[148:151], v[108:111]
    ds_read_b128 v[76:79], v224 offset:47104
    v_mfma_f32_16x16x32_bf16 v[112:115], v[80:83], a[152:155], v[112:115]
    v_mfma_f32_16x16x32_bf16 v[116:119], v[84:87], a[152:155], v[116:119]
    v_mfma_f32_16x16x32_bf16 v[120:123], v[80:83], a[156:159], v[120:123]
    v_mfma_f32_16x16x32_bf16 v[124:127], v[84:87], a[156:159], v[124:127]
    v_mfma_f32_16x16x32_bf16 v[128:131], v[88:91], a[144:147], v[128:131]
    s_add_u32 m0, s34, 24576
    s_add_u32 s37, s83, 196608
    buffer_load_dwordx4 v232, s[44:47], s37 offen lds
    v_mfma_f32_16x16x32_bf16 v[132:135], v[92:95], a[144:147], v[132:135]
    v_mfma_f32_16x16x32_bf16 v[136:139], v[88:91], a[148:151], v[136:139]
    buffer_load_dwordx4 v233, s[44:47], s37 offen offset:1024 lds
    s_add_u32 s38, s36, 8192
    buffer_store_dwordx4 v[28:31], v240, s[16:19], s38 offen offset:3072 sc1
    v_mfma_f32_16x16x32_bf16 v[140:143], v[92:95], a[148:151], v[140:143]
    v_mfma_f32_16x16x32_bf16 v[144:147], v[88:91], a[152:155], v[144:147]
    v_mfma_f32_16x16x32_bf16 v[148:151], v[92:95], a[152:155], v[148:151]
    s_add_u32 m0, s31, 5120
    s_add_u32 s24, s27, 163840
    buffer_load_dwordx4 v245, s[12:15], s24 offen lds
    v_mfma_f32_16x16x32_bf16 v[152:155], v[88:91], a[156:159], v[152:155]
    v_mfma_f32_16x16x32_bf16 v[156:159], v[92:95], a[156:159], v[156:159]
    s_waitcnt lgkmcnt(0)
    v_mfma_f32_16x16x32_bf16 v[96:99], v[64:67], a[160:163], v[96:99]
    ds_read_b128 v[80:83], v225 offset:40960
    v_mfma_f32_16x16x32_bf16 v[100:103], v[68:71], a[160:163], v[100:103]
    ds_read_b128 v[84:87], v225 offset:43008
    v_mfma_f32_16x16x32_bf16 v[104:107], v[64:67], a[164:167], v[104:107]
    ds_read_b128 v[88:91], v225 offset:45056
    v_mfma_f32_16x16x32_bf16 v[108:111], v[68:71], a[164:167], v[108:111]
    ds_read_b128 v[92:95], v225 offset:47104
    v_mfma_f32_16x16x32_bf16 v[112:115], v[64:67], a[168:171], v[112:115]
    v_mfma_f32_16x16x32_bf16 v[116:119], v[68:71], a[168:171], v[116:119]
    v_mfma_f32_16x16x32_bf16 v[120:123], v[64:67], a[172:175], v[120:123]
    v_mfma_f32_16x16x32_bf16 v[124:127], v[68:71], a[172:175], v[124:127]
    v_mfma_f32_16x16x32_bf16 v[128:131], v[72:75], a[160:163], v[128:131]
    s_add_u32 m0, s31, 6144
    s_add_u32 s24, s27, 196608
    buffer_load_dwordx4 v237, s[12:15], s24 offen lds
    v_mfma_f32_16x16x32_bf16 v[132:135], v[76:79], a[160:163], v[132:135]
    v_mfma_f32_16x16x32_bf16 v[136:139], v[72:75], a[164:167], v[136:139]
    v_mfma_f32_16x16x32_bf16 v[140:143], v[76:79], a[164:167], v[140:143]
    v_mfma_f32_16x16x32_bf16 v[144:147], v[72:75], a[168:171], v[144:147]
    v_mfma_f32_16x16x32_bf16 v[148:151], v[76:79], a[168:171], v[148:151]
    v_mfma_f32_16x16x32_bf16 v[152:155], v[72:75], a[172:175], v[152:155]
    v_mfma_f32_16x16x32_bf16 v[156:159], v[76:79], a[172:175], v[156:159]
    s_waitcnt vmcnt(22) lgkmcnt(0)
    s_barrier
    v_mfma_f32_16x16x32_bf16 v[96:99], v[80:83], a[176:179], v[96:99]
    ds_read_b128 v[64:67], v224 offset:49152
    s_add_u32 s38, s36, 32768
    buffer_store_dwordx4 v[32:35], v240, s[16:19], s38 offen offset:1280 sc1
    v_mfma_f32_16x16x32_bf16 v[100:103], v[84:87], a[176:179], v[100:103]
    ds_read_b128 v[68:71], v224 offset:51200
    v_mfma_f32_16x16x32_bf16 v[104:107], v[80:83], a[180:183], v[104:107]
    ds_read_b128 v[72:75], v224 offset:53248
    v_mfma_f32_16x16x32_bf16 v[108:111], v[84:87], a[180:183], v[108:111]
    ds_read_b128 v[76:79], v224 offset:55296
    v_mfma_f32_16x16x32_bf16 v[112:115], v[80:83], a[184:187], v[112:115]
    v_mfma_f32_16x16x32_bf16 v[116:119], v[84:87], a[184:187], v[116:119]
    v_mfma_f32_16x16x32_bf16 v[120:123], v[80:83], a[188:191], v[120:123]
    v_mfma_f32_16x16x32_bf16 v[124:127], v[84:87], a[188:191], v[124:127]
    v_mfma_f32_16x16x32_bf16 v[128:131], v[88:91], a[176:179], v[128:131]
    s_add_u32 m0, s34, 32768
    s_add_u32 s37, s84, 196608
    buffer_load_dwordx4 v232, s[44:47], s37 offen lds
    v_mfma_f32_16x16x32_bf16 v[132:135], v[92:95], a[176:179], v[132:135]
    buffer_load_dwordx4 v233, s[44:47], s37 offen offset:1024 lds
    v_mfma_f32_16x16x32_bf16 v[136:139], v[88:91], a[180:183], v[136:139]
    v_mfma_f32_16x16x32_bf16 v[140:143], v[92:95], a[180:183], v[140:143]
    s_add_u32 m0, s31, 7168
    s_add_u32 s24, s27, 229376
    buffer_load_dwordx4 v237, s[12:15], s24 offen lds
    v_mfma_f32_16x16x32_bf16 v[144:147], v[88:91], a[184:187], v[144:147]
    s_add_u32 s27, s27, 1048576
    s_and_b32 s27, s27, 0x407fffff
    s_cmp_eq_u32 s27, s7
    s_cselect_b32 s27, s43, s27
    v_mfma_f32_16x16x32_bf16 v[148:151], v[92:95], a[184:187], v[148:151]
    v_mfma_f32_16x16x32_bf16 v[152:155], v[88:91], a[188:191], v[152:155]
    s_add_u32 s31, s31, 32768
    s_cmp_ge_u32 s31, 163840
    s_cselect_b32 s24, 98304, 0
    s_sub_u32 s31, s31, s24
    v_mfma_f32_16x16x32_bf16 v[156:159], v[92:95], a[188:191], v[156:159]
    s_waitcnt lgkmcnt(0)
    v_mfma_f32_16x16x32_bf16 v[96:99], v[64:67], a[192:195], v[96:99]
    ds_read_b128 v[80:83], v225 offset:49152
    v_mfma_f32_16x16x32_bf16 v[100:103], v[68:71], a[192:195], v[100:103]
    ds_read_b128 v[84:87], v225 offset:51200
    v_mfma_f32_16x16x32_bf16 v[104:107], v[64:67], a[196:199], v[104:107]
    ds_read_b128 v[88:91], v225 offset:53248
    v_mfma_f32_16x16x32_bf16 v[108:111], v[68:71], a[196:199], v[108:111]
    ds_read_b128 v[92:95], v225 offset:55296
    v_mfma_f32_16x16x32_bf16 v[112:115], v[64:67], a[200:203], v[112:115]
    v_mfma_f32_16x16x32_bf16 v[116:119], v[68:71], a[200:203], v[116:119]
    v_mfma_f32_16x16x32_bf16 v[120:123], v[64:67], a[204:207], v[120:123]
    s_add_u32 s38, s36, 32768
    buffer_store_dwordx4 v[36:39], v240, s[16:19], s38 offen offset:2304 sc1
    v_mfma_f32_16x16x32_bf16 v[124:127], v[68:71], a[204:207], v[124:127]
    v_mfma_f32_16x16x32_bf16 v[128:131], v[72:75], a[192:195], v[128:131]
    v_mfma_f32_16x16x32_bf16 v[132:135], v[76:79], a[192:195], v[132:135]
    v_mfma_f32_16x16x32_bf16 v[136:139], v[72:75], a[196:199], v[136:139]
    v_mfma_f32_16x16x32_bf16 v[140:143], v[76:79], a[196:199], v[140:143]
    v_mfma_f32_16x16x32_bf16 v[144:147], v[72:75], a[200:203], v[144:147]
    v_mfma_f32_16x16x32_bf16 v[148:151], v[76:79], a[200:203], v[148:151]
    v_mfma_f32_16x16x32_bf16 v[152:155], v[72:75], a[204:207], v[152:155]
    v_mfma_f32_16x16x32_bf16 v[156:159], v[76:79], a[204:207], v[156:159]
    s_waitcnt lgkmcnt(0)
    v_mfma_f32_16x16x32_bf16 v[96:99], v[80:83], a[208:211], v[96:99]
    ds_read_b128 v[64:67], v224 offset:57344
    v_mfma_f32_16x16x32_bf16 v[100:103], v[84:87], a[208:211], v[100:103]
    ds_read_b128 v[68:71], v224 offset:59392
    v_mfma_f32_16x16x32_bf16 v[104:107], v[80:83], a[212:215], v[104:107]
    ds_read_b128 v[72:75], v224 offset:61440
    v_mfma_f32_16x16x32_bf16 v[108:111], v[84:87], a[212:215], v[108:111]
    ds_read_b128 v[76:79], v224 offset:63488
    v_mfma_f32_16x16x32_bf16 v[112:115], v[80:83], a[216:219], v[112:115]
    v_mfma_f32_16x16x32_bf16 v[116:119], v[84:87], a[216:219], v[116:119]
    v_mfma_f32_16x16x32_bf16 v[120:123], v[80:83], a[220:223], v[120:123]
    v_mfma_f32_16x16x32_bf16 v[124:127], v[84:87], a[220:223], v[124:127]
    v_mfma_f32_16x16x32_bf16 v[128:131], v[88:91], a[208:211], v[128:131]
    s_add_u32 m0, s34, 40960
    s_add_u32 s37, s85, 196608
    buffer_load_dwordx4 v232, s[44:47], s37 offen lds
    v_mfma_f32_16x16x32_bf16 v[132:135], v[92:95], a[208:211], v[132:135]
    v_mfma_f32_16x16x32_bf16 v[136:139], v[88:91], a[212:215], v[136:139]
    v_mfma_f32_16x16x32_bf16 v[140:143], v[92:95], a[212:215], v[140:143]
    s_add_u32 s38, s36, 32768
    buffer_store_dwordx4 v[40:43], v240, s[16:19], s38 offen offset:3328 sc1
    v_mfma_f32_16x16x32_bf16 v[144:147], v[88:91], a[216:219], v[144:147]
    buffer_load_dwordx4 v233, s[44:47], s37 offen offset:1024 lds
    v_mfma_f32_16x16x32_bf16 v[148:151], v[92:95], a[216:219], v[148:151]
    v_mfma_f32_16x16x32_bf16 v[152:155], v[88:91], a[220:223], v[152:155]
    v_mfma_f32_16x16x32_bf16 v[156:159], v[92:95], a[220:223], v[156:159]
    s_waitcnt lgkmcnt(0)
    v_mfma_f32_16x16x32_bf16 v[96:99], v[64:67], a[224:227], v[96:99]
    ds_read_b128 v[80:83], v225 offset:57344
    v_mfma_f32_16x16x32_bf16 v[100:103], v[68:71], a[224:227], v[100:103]
    ds_read_b128 v[84:87], v225 offset:59392
    v_mfma_f32_16x16x32_bf16 v[104:107], v[64:67], a[228:231], v[104:107]
    ds_read_b128 v[88:91], v225 offset:61440
    v_mfma_f32_16x16x32_bf16 v[108:111], v[68:71], a[228:231], v[108:111]
    ds_read_b128 v[92:95], v225 offset:63488
    v_mfma_f32_16x16x32_bf16 v[112:115], v[64:67], a[232:235], v[112:115]
    v_mfma_f32_16x16x32_bf16 v[116:119], v[68:71], a[232:235], v[116:119]
    v_mfma_f32_16x16x32_bf16 v[120:123], v[64:67], a[236:239], v[120:123]
    v_mfma_f32_16x16x32_bf16 v[124:127], v[68:71], a[236:239], v[124:127]
    v_mfma_f32_16x16x32_bf16 v[128:131], v[72:75], a[224:227], v[128:131]
    s_add_u32 m0, s31, 0
    s_add_u32 s24, s27, 0
    buffer_load_dwordx4 v245, s[12:15], s24 offen lds
    v_mfma_f32_16x16x32_bf16 v[132:135], v[76:79], a[224:227], v[132:135]
    v_mfma_f32_16x16x32_bf16 v[136:139], v[72:75], a[228:231], v[136:139]
    v_mfma_f32_16x16x32_bf16 v[140:143], v[76:79], a[228:231], v[140:143]
    v_mfma_f32_16x16x32_bf16 v[144:147], v[72:75], a[232:235], v[144:147]
    v_mfma_f32_16x16x32_bf16 v[148:151], v[76:79], a[232:235], v[148:151]
    v_mfma_f32_16x16x32_bf16 v[152:155], v[72:75], a[236:239], v[152:155]
    v_mfma_f32_16x16x32_bf16 v[156:159], v[76:79], a[236:239], v[156:159]
    s_waitcnt vmcnt(23) lgkmcnt(0)
    s_barrier
    v_mfma_f32_16x16x32_bf16 v[96:99], v[80:83], a[240:243], v[96:99]
    ds_read_b128 v[64:67], v224 offset:0
    v_mfma_f32_16x16x32_bf16 v[100:103], v[84:87], a[240:243], v[100:103]
    ds_read_b128 v[68:71], v224 offset:2048
    s_add_u32 s38, s36, 36864
    buffer_store_dwordx4 v[44:47], v240, s[16:19], s38 offen offset:256 sc1
    v_mfma_f32_16x16x32_bf16 v[104:107], v[80:83], a[244:247], v[104:107]
    ds_read_b128 v[72:75], v224 offset:4096
    v_mfma_f32_16x16x32_bf16 v[108:111], v[84:87], a[244:247], v[108:111]
    ds_read_b128 v[76:79], v224 offset:6144
    v_mfma_f32_16x16x32_bf16 v[112:115], v[80:83], a[248:251], v[112:115]
    v_mfma_f32_16x16x32_bf16 v[116:119], v[84:87], a[248:251], v[116:119]
    v_mfma_f32_16x16x32_bf16 v[120:123], v[80:83], a[252:255], v[120:123]
    v_mfma_f32_16x16x32_bf16 v[124:127], v[84:87], a[252:255], v[124:127]
    v_mfma_f32_16x16x32_bf16 v[128:131], v[88:91], a[240:243], v[128:131]
    s_add_u32 m0, s34, 49152
    s_add_u32 s37, s86, 196608
    buffer_load_dwordx4 v232, s[44:47], s37 offen lds
    v_mfma_f32_16x16x32_bf16 v[132:135], v[92:95], a[240:243], v[132:135]
    v_mfma_f32_16x16x32_bf16 v[136:139], v[88:91], a[244:247], v[136:139]
    buffer_load_dwordx4 v233, s[44:47], s37 offen offset:1024 lds
    v_mfma_f32_16x16x32_bf16 v[140:143], v[92:95], a[244:247], v[140:143]
    v_mfma_f32_16x16x32_bf16 v[144:147], v[88:91], a[248:251], v[144:147]
    v_mfma_f32_16x16x32_bf16 v[148:151], v[92:95], a[248:251], v[148:151]
    s_add_u32 m0, s31, 1024
    s_add_u32 s24, s27, 32768
    buffer_load_dwordx4 v245, s[12:15], s24 offen lds
    v_mfma_f32_16x16x32_bf16 v[152:155], v[88:91], a[252:255], v[152:155]
    v_mfma_f32_16x16x32_bf16 v[156:159], v[92:95], a[252:255], v[156:159]
    s_waitcnt lgkmcnt(0)
    v_mfma_f32_16x16x32_bf16 v[160:163], v[64:67], a[0:3], 0
    ds_read_b128 v[80:83], v225 offset:0
    v_mfma_f32_16x16x32_bf16 v[164:167], v[68:71], a[0:3], 0
    ds_read_b128 v[84:87], v225 offset:2048
    v_mfma_f32_16x16x32_bf16 v[168:171], v[64:67], a[4:7], 0
    ds_read_b128 v[88:91], v225 offset:4096
    v_mfma_f32_16x16x32_bf16 v[172:175], v[68:71], a[4:7], 0
    ds_read_b128 v[92:95], v225 offset:6144
    v_mfma_f32_16x16x32_bf16 v[176:179], v[64:67], a[8:11], 0
    v_cvt_pk_bf16_f32 v0, v96, v97
    v_cvt_pk_bf16_f32 v1, v98, v99
    v_mfma_f32_16x16x32_bf16 v[180:183], v[68:71], a[8:11], 0
    v_mfma_f32_16x16x32_bf16 v[184:187], v[64:67], a[12:15], 0
    v_cvt_pk_bf16_f32 v2, v100, v101
    v_cvt_pk_bf16_f32 v3, v102, v103
    s_add_u32 s38, s36, 40960
    buffer_store_dwordx4 v[48:51], v240, s[16:19], s38 offen offset:1280 sc1
    v_mfma_f32_16x16x32_bf16 v[188:191], v[68:71], a[12:15], 0
    v_mfma_f32_16x16x32_bf16 v[192:195], v[72:75], a[0:3], 0
    s_add_u32 m0, s31, 2048
    s_add_u32 s24, s27, 65536
    buffer_load_dwordx4 v237, s[12:15], s24 offen lds
    v_cvt_pk_bf16_f32 v4, v104, v105
    v_cvt_pk_bf16_f32 v5, v106, v107
    v_mfma_f32_16x16x32_bf16 v[196:199], v[76:79], a[0:3], 0
    v_mfma_f32_16x16x32_bf16 v[200:203], v[72:75], a[4:7], 0
    v_cvt_pk_bf16_f32 v6, v108, v109
    v_cvt_pk_bf16_f32 v7, v110, v111
    v_mfma_f32_16x16x32_bf16 v[204:207], v[76:79], a[4:7], 0
    v_mfma_f32_16x16x32_bf16 v[208:211], v[72:75], a[8:11], 0
    v_cvt_pk_bf16_f32 v8, v112, v113
    v_cvt_pk_bf16_f32 v9, v114, v115
    v_mfma_f32_16x16x32_bf16 v[212:215], v[76:79], a[8:11], 0
    v_mfma_f32_16x16x32_bf16 v[216:219], v[72:75], a[12:15], 0
    v_cvt_pk_bf16_f32 v10, v116, v117
    v_cvt_pk_bf16_f32 v11, v118, v119
    v_mfma_f32_16x16x32_bf16 v[220:223], v[76:79], a[12:15], 0
    s_waitcnt lgkmcnt(0)
    v_mfma_f32_16x16x32_bf16 v[160:163], v[80:83], a[16:19], v[160:163]
    ds_read_b128 v[64:67], v224 offset:8192
    v_cvt_pk_bf16_f32 v12, v120, v121
    v_cvt_pk_bf16_f32 v13, v122, v123
    v_mfma_f32_16x16x32_bf16 v[164:167], v[84:87], a[16:19], v[164:167]
    ds_read_b128 v[68:71], v224 offset:10240
    v_mfma_f32_16x16x32_bf16 v[168:171], v[80:83], a[20:23], v[168:171]
    ds_read_b128 v[72:75], v224 offset:12288
    v_cvt_pk_bf16_f32 v14, v124, v125
    v_cvt_pk_bf16_f32 v15, v126, v127
    v_mfma_f32_16x16x32_bf16 v[172:175], v[84:87], a[20:23], v[172:175]
    ds_read_b128 v[76:79], v224 offset:14336
    v_mfma_f32_16x16x32_bf16 v[176:179], v[80:83], a[24:27], v[176:179]
    v_cvt_pk_bf16_f32 v16, v128, v129
    v_cvt_pk_bf16_f32 v17, v130, v131
    v_mfma_f32_16x16x32_bf16 v[180:183], v[84:87], a[24:27], v[180:183]
    v_mfma_f32_16x16x32_bf16 v[184:187], v[80:83], a[28:31], v[184:187]
    v_cvt_pk_bf16_f32 v18, v132, v133
    v_cvt_pk_bf16_f32 v19, v134, v135
    v_mfma_f32_16x16x32_bf16 v[188:191], v[84:87], a[28:31], v[188:191]
    v_mfma_f32_16x16x32_bf16 v[192:195], v[88:91], a[16:19], v[192:195]
    s_add_u32 m0, s34, 57344
    s_add_u32 s37, s87, 196608
    buffer_load_dwordx4 v232, s[44:47], s37 offen lds
    v_cvt_pk_bf16_f32 v20, v136, v137
    v_cvt_pk_bf16_f32 v21, v138, v139
    v_mfma_f32_16x16x32_bf16 v[196:199], v[92:95], a[16:19], v[196:199]
    v_mfma_f32_16x16x32_bf16 v[200:203], v[88:91], a[20:23], v[200:203]
    buffer_load_dwordx4 v233, s[44:47], s37 offen offset:1024 lds
    v_cvt_pk_bf16_f32 v22, v140, v141
    v_cvt_pk_bf16_f32 v23, v142, v143
    v_mfma_f32_16x16x32_bf16 v[204:207], v[92:95], a[20:23], v[204:207]
    v_mfma_f32_16x16x32_bf16 v[208:211], v[88:91], a[24:27], v[208:211]
    v_cvt_pk_bf16_f32 v24, v144, v145
    v_cvt_pk_bf16_f32 v25, v146, v147
    s_add_u32 s38, s36, 40960
    buffer_store_dwordx4 v[52:55], v240, s[16:19], s38 offen offset:2304 sc1
    v_mfma_f32_16x16x32_bf16 v[212:215], v[92:95], a[24:27], v[212:215]
    s_add_u32 m0, s31, 3072
    s_add_u32 s24, s27, 98304
    buffer_load_dwordx4 v237, s[12:15], s24 offen lds
    v_mfma_f32_16x16x32_bf16 v[216:219], v[88:91], a[28:31], v[216:219]
    v_cvt_pk_bf16_f32 v26, v148, v149
    v_cvt_pk_bf16_f32 v27, v150, v151
    v_mfma_f32_16x16x32_bf16 v[220:223], v[92:95], a[28:31], v[220:223]
    s_waitcnt lgkmcnt(0)
    v_mfma_f32_16x16x32_bf16 v[160:163], v[64:67], a[32:35], v[160:163]
    ds_read_b128 v[80:83], v225 offset:8192
    v_cvt_pk_bf16_f32 v28, v152, v153
    v_cvt_pk_bf16_f32 v29, v154, v155
    v_mfma_f32_16x16x32_bf16 v[164:167], v[68:71], a[32:35], v[164:167]
    ds_read_b128 v[84:87], v225 offset:10240
    v_mfma_f32_16x16x32_bf16 v[168:171], v[64:67], a[36:39], v[168:171]
    ds_read_b128 v[88:91], v225 offset:12288
    v_cvt_pk_bf16_f32 v30, v156, v157
    v_cvt_pk_bf16_f32 v31, v158, v159
    v_mfma_f32_16x16x32_bf16 v[172:175], v[68:71], a[36:39], v[172:175]
    ds_read_b128 v[92:95], v225 offset:14336
    v_mfma_f32_16x16x32_bf16 v[176:179], v[64:67], a[40:43], v[176:179]
    v_mfma_f32_16x16x32_bf16 v[180:183], v[68:71], a[40:43], v[180:183]
    v_mfma_f32_16x16x32_bf16 v[184:187], v[64:67], a[44:47], v[184:187]
    v_mfma_f32_16x16x32_bf16 v[188:191], v[68:71], a[44:47], v[188:191]
    v_mfma_f32_16x16x32_bf16 v[192:195], v[72:75], a[32:35], v[192:195]
    s_add_u32 m0, s31, 4096
    s_add_u32 s24, s27, 131072
    buffer_load_dwordx4 v245, s[12:15], s24 offen lds
    v_mfma_f32_16x16x32_bf16 v[196:199], v[76:79], a[32:35], v[196:199]
    v_mfma_f32_16x16x32_bf16 v[200:203], v[72:75], a[36:39], v[200:203]
    v_mfma_f32_16x16x32_bf16 v[204:207], v[76:79], a[36:39], v[204:207]
    v_mfma_f32_16x16x32_bf16 v[208:211], v[72:75], a[40:43], v[208:211]
    v_mfma_f32_16x16x32_bf16 v[212:215], v[76:79], a[40:43], v[212:215]
    v_mfma_f32_16x16x32_bf16 v[216:219], v[72:75], a[44:47], v[216:219]
    v_mfma_f32_16x16x32_bf16 v[220:223], v[76:79], a[44:47], v[220:223]
    s_waitcnt vmcnt(23) lgkmcnt(0)
    s_barrier
    v_mfma_f32_16x16x32_bf16 v[160:163], v[80:83], a[48:51], v[160:163]
    ds_read_b128 v[64:67], v224 offset:16384
    v_mfma_f32_16x16x32_bf16 v[164:167], v[84:87], a[48:51], v[164:167]
    ds_read_b128 v[68:71], v224 offset:18432
    s_add_u32 s38, s36, 40960
    buffer_store_dwordx4 v[56:59], v240, s[16:19], s38 offen offset:3328 sc1
    v_mfma_f32_16x16x32_bf16 v[168:171], v[80:83], a[52:55], v[168:171]
    ds_read_b128 v[72:75], v224 offset:20480
    v_mfma_f32_16x16x32_bf16 v[172:175], v[84:87], a[52:55], v[172:175]
    ds_read_b128 v[76:79], v224 offset:22528
    v_mfma_f32_16x16x32_bf16 v[176:179], v[80:83], a[56:59], v[176:179]
    v_mfma_f32_16x16x32_bf16 v[180:183], v[84:87], a[56:59], v[180:183]
    v_mfma_f32_16x16x32_bf16 v[184:187], v[80:83], a[60:63], v[184:187]
    v_mfma_f32_16x16x32_bf16 v[188:191], v[84:87], a[60:63], v[188:191]
    v_mfma_f32_16x16x32_bf16 v[192:195], v[88:91], a[48:51], v[192:195]
    s_add_u32 m0, s31, 5120
    s_add_u32 s24, s27, 163840
    buffer_load_dwordx4 v245, s[12:15], s24 offen lds
    v_mfma_f32_16x16x32_bf16 v[196:199], v[92:95], a[48:51], v[196:199]
    v_mfma_f32_16x16x32_bf16 v[200:203], v[88:91], a[52:55], v[200:203]
    v_mfma_f32_16x16x32_bf16 v[204:207], v[92:95], a[52:55], v[204:207]
    v_mfma_f32_16x16x32_bf16 v[208:211], v[88:91], a[56:59], v[208:211]
    v_mfma_f32_16x16x32_bf16 v[212:215], v[92:95], a[56:59], v[212:215]
    v_mfma_f32_16x16x32_bf16 v[216:219], v[88:91], a[60:63], v[216:219]
    v_mfma_f32_16x16x32_bf16 v[220:223], v[92:95], a[60:63], v[220:223]
    s_waitcnt lgkmcnt(0)
    v_mfma_f32_16x16x32_bf16 v[160:163], v[64:67], a[64:67], v[160:163]
    ds_read_b128 v[80:83], v225 offset:16384
    v_mfma_f32_16x16x32_bf16 v[164:167], v[68:71], a[64:67], v[164:167]
    ds_read_b128 v[84:87], v225 offset:18432
    v_mfma_f32_16x16x32_bf16 v[168:171], v[64:67], a[68:71], v[168:171]
    ds_read_b128 v[88:91], v225 offset:20480
    v_mfma_f32_16x16x32_bf16 v[172:175], v[68:71], a[68:71], v[172:175]
    ds_read_b128 v[92:95], v225 offset:22528
    v_mfma_f32_16x16x32_bf16 v[176:179], v[64:67], a[72:75], v[176:179]
    v_mfma_f32_16x16x32_bf16 v[180:183], v[68:71], a[72:75], v[180:183]
    v_mfma_f32_16x16x32_bf16 v[184:187], v[64:67], a[76:79], v[184:187]
    v_mfma_f32_16x16x32_bf16 v[188:191], v[68:71], a[76:79], v[188:191]
    s_add_u32 s38, s36, 45056
    buffer_store_dwordx4 v[60:63], v240, s[16:19], s38 offen offset:256 sc1
    v_mfma_f32_16x16x32_bf16 v[192:195], v[72:75], a[64:67], v[192:195]
    s_add_u32 m0, s31, 6144
    s_add_u32 s24, s27, 196608
    buffer_load_dwordx4 v237, s[12:15], s24 offen lds
    v_mfma_f32_16x16x32_bf16 v[196:199], v[76:79], a[64:67], v[196:199]
    v_mfma_f32_16x16x32_bf16 v[200:203], v[72:75], a[68:71], v[200:203]
    v_mfma_f32_16x16x32_bf16 v[204:207], v[76:79], a[68:71], v[204:207]
    v_mfma_f32_16x16x32_bf16 v[208:211], v[72:75], a[72:75], v[208:211]
    v_mfma_f32_16x16x32_bf16 v[212:215], v[76:79], a[72:75], v[212:215]
    v_mfma_f32_16x16x32_bf16 v[216:219], v[72:75], a[76:79], v[216:219]
    v_mfma_f32_16x16x32_bf16 v[220:223], v[76:79], a[76:79], v[220:223]
    s_waitcnt lgkmcnt(0)
    v_mfma_f32_16x16x32_bf16 v[160:163], v[80:83], a[80:83], v[160:163]
    ds_read_b128 v[64:67], v224 offset:24576
    v_mfma_f32_16x16x32_bf16 v[164:167], v[84:87], a[80:83], v[164:167]
    ds_read_b128 v[68:71], v224 offset:26624
    v_mfma_f32_16x16x32_bf16 v[168:171], v[80:83], a[84:87], v[168:171]
    ds_read_b128 v[72:75], v224 offset:28672
    v_mfma_f32_16x16x32_bf16 v[172:175], v[84:87], a[84:87], v[172:175]
    ds_read_b128 v[76:79], v224 offset:30720
    v_mfma_f32_16x16x32_bf16 v[176:179], v[80:83], a[88:91], v[176:179]
    v_mfma_f32_16x16x32_bf16 v[180:183], v[84:87], a[88:91], v[180:183]
    v_mfma_f32_16x16x32_bf16 v[184:187], v[80:83], a[92:95], v[184:187]
    v_mfma_f32_16x16x32_bf16 v[188:191], v[84:87], a[92:95], v[188:191]
    v_mfma_f32_16x16x32_bf16 v[192:195], v[88:91], a[80:83], v[192:195]
    s_add_u32 m0, s31, 7168
    s_add_u32 s24, s27, 229376
    buffer_load_dwordx4 v237, s[12:15], s24 offen lds
    v_mfma_f32_16x16x32_bf16 v[196:199], v[92:95], a[80:83], v[196:199]
    v_mfma_f32_16x16x32_bf16 v[200:203], v[88:91], a[84:87], v[200:203]
    s_add_u32 s27, s27, 1048576
    s_and_b32 s27, s27, 0x407fffff
    s_cmp_eq_u32 s27, s7
    s_cselect_b32 s27, s43, s27
    v_mfma_f32_16x16x32_bf16 v[204:207], v[92:95], a[84:87], v[204:207]
    v_mfma_f32_16x16x32_bf16 v[208:211], v[88:91], a[88:91], v[208:211]
    v_mfma_f32_16x16x32_bf16 v[212:215], v[92:95], a[88:91], v[212:215]
    s_add_u32 s31, s31, 32768
    s_cmp_ge_u32 s31, 163840
    s_cselect_b32 s24, 98304, 0
    s_sub_u32 s31, s31, s24
    s_add_u32 s38, s36, 65536
    buffer_store_dwordx4 v[0:3], v240, s[16:19], s38 offen offset:2560 sc1
    v_mfma_f32_16x16x32_bf16 v[216:219], v[88:91], a[92:95], v[216:219]
    v_mfma_f32_16x16x32_bf16 v[220:223], v[92:95], a[92:95], v[220:223]
    s_waitcnt lgkmcnt(0)
    v_mfma_f32_16x16x32_bf16 v[160:163], v[64:67], a[96:99], v[160:163]
    ds_read_b128 v[80:83], v225 offset:24576
    v_mfma_f32_16x16x32_bf16 v[164:167], v[68:71], a[96:99], v[164:167]
    ds_read_b128 v[84:87], v225 offset:26624
    v_mfma_f32_16x16x32_bf16 v[168:171], v[64:67], a[100:103], v[168:171]
    ds_read_b128 v[88:91], v225 offset:28672
    v_mfma_f32_16x16x32_bf16 v[172:175], v[68:71], a[100:103], v[172:175]
    ds_read_b128 v[92:95], v225 offset:30720
    v_mfma_f32_16x16x32_bf16 v[176:179], v[64:67], a[104:107], v[176:179]
    v_mfma_f32_16x16x32_bf16 v[180:183], v[68:71], a[104:107], v[180:183]
    v_mfma_f32_16x16x32_bf16 v[184:187], v[64:67], a[108:111], v[184:187]
    v_mfma_f32_16x16x32_bf16 v[188:191], v[68:71], a[108:111], v[188:191]
    v_mfma_f32_16x16x32_bf16 v[192:195], v[72:75], a[96:99], v[192:195]
    v_mfma_f32_16x16x32_bf16 v[196:199], v[76:79], a[96:99], v[196:199]
    v_mfma_f32_16x16x32_bf16 v[200:203], v[72:75], a[100:103], v[200:203]
    v_mfma_f32_16x16x32_bf16 v[204:207], v[76:79], a[100:103], v[204:207]
    v_mfma_f32_16x16x32_bf16 v[208:211], v[72:75], a[104:107], v[208:211]
    v_mfma_f32_16x16x32_bf16 v[212:215], v[76:79], a[104:107], v[212:215]
    v_mfma_f32_16x16x32_bf16 v[216:219], v[72:75], a[108:111], v[216:219]
    v_mfma_f32_16x16x32_bf16 v[220:223], v[76:79], a[108:111], v[220:223]
    s_waitcnt vmcnt(9) lgkmcnt(0)
    s_barrier
    v_mfma_f32_16x16x32_bf16 v[160:163], v[80:83], a[112:115], v[160:163]
    ds_read_b128 v[64:67], v224 offset:32768
    v_mfma_f32_16x16x32_bf16 v[164:167], v[84:87], a[112:115], v[164:167]
    ds_read_b128 v[68:71], v224 offset:34816
    v_mfma_f32_16x16x32_bf16 v[168:171], v[80:83], a[116:119], v[168:171]
    ds_read_b128 v[72:75], v224 offset:36864
    s_add_u32 s38, s36, 65536
    buffer_store_dwordx4 v[4:7], v240, s[16:19], s38 offen offset:3584 sc1
    v_mfma_f32_16x16x32_bf16 v[172:175], v[84:87], a[116:119], v[172:175]
    ds_read_b128 v[76:79], v224 offset:38912
    v_mfma_f32_16x16x32_bf16 v[176:179], v[80:83], a[120:123], v[176:179]
    v_mfma_f32_16x16x32_bf16 v[180:183], v[84:87], a[120:123], v[180:183]
    v_mfma_f32_16x16x32_bf16 v[184:187], v[80:83], a[124:127], v[184:187]
    v_mfma_f32_16x16x32_bf16 v[188:191], v[84:87], a[124:127], v[188:191]
    v_mfma_f32_16x16x32_bf16 v[192:195], v[88:91], a[112:115], v[192:195]
    v_mfma_f32_16x16x32_bf16 v[196:199], v[92:95], a[112:115], v[196:199]
    v_mfma_f32_16x16x32_bf16 v[200:203], v[88:91], a[116:119], v[200:203]
    v_mfma_f32_16x16x32_bf16 v[204:207], v[92:95], a[116:119], v[204:207]
    v_mfma_f32_16x16x32_bf16 v[208:211], v[88:91], a[120:123], v[208:211]
    v_mfma_f32_16x16x32_bf16 v[212:215], v[92:95], a[120:123], v[212:215]
    v_mfma_f32_16x16x32_bf16 v[216:219], v[88:91], a[124:127], v[216:219]
    v_mfma_f32_16x16x32_bf16 v[220:223], v[92:95], a[124:127], v[220:223]
    s_waitcnt lgkmcnt(0)
    v_mfma_f32_16x16x32_bf16 v[160:163], v[64:67], a[128:131], v[160:163]
    ds_read_b128 v[80:83], v225 offset:32768
    v_mfma_f32_16x16x32_bf16 v[164:167], v[68:71], a[128:131], v[164:167]
    ds_read_b128 v[84:87], v225 offset:34816
    v_mfma_f32_16x16x32_bf16 v[168:171], v[64:67], a[132:135], v[168:171]
    ds_read_b128 v[88:91], v225 offset:36864
    v_mfma_f32_16x16x32_bf16 v[172:175], v[68:71], a[132:135], v[172:175]
    ds_read_b128 v[92:95], v225 offset:38912
    v_mfma_f32_16x16x32_bf16 v[176:179], v[64:67], a[136:139], v[176:179]
    v_mfma_f32_16x16x32_bf16 v[180:183], v[68:71], a[136:139], v[180:183]
    v_mfma_f32_16x16x32_bf16 v[184:187], v[64:67], a[140:143], v[184:187]
    v_mfma_f32_16x16x32_bf16 v[188:191], v[68:71], a[140:143], v[188:191]
    v_mfma_f32_16x16x32_bf16 v[192:195], v[72:75], a[128:131], v[192:195]
    buffer_load_dword v254, off, s[88:91], s39 sc1
    s_add_u32 s38, s36, 69632
    buffer_store_dwordx4 v[8:11], v240, s[16:19], s38 offen offset:512 sc1
    v_mfma_f32_16x16x32_bf16 v[196:199], v[76:79], a[128:131], v[196:199]
    v_mfma_f32_16x16x32_bf16 v[200:203], v[72:75], a[132:135], v[200:203]
    v_mfma_f32_16x16x32_bf16 v[204:207], v[76:79], a[132:135], v[204:207]
    v_mfma_f32_16x16x32_bf16 v[208:211], v[72:75], a[136:139], v[208:211]
    v_mfma_f32_16x16x32_bf16 v[212:215], v[76:79], a[136:139], v[212:215]
    v_mfma_f32_16x16x32_bf16 v[216:219], v[72:75], a[140:143], v[216:219]
    v_mfma_f32_16x16x32_bf16 v[220:223], v[76:79], a[140:143], v[220:223]
    s_waitcnt lgkmcnt(0)
    v_mfma_f32_16x16x32_bf16 v[160:163], v[80:83], a[144:147], v[160:163]
    ds_read_b128 v[64:67], v224 offset:40960
    v_mfma_f32_16x16x32_bf16 v[164:167], v[84:87], a[144:147], v[164:167]
    ds_read_b128 v[68:71], v224 offset:43008
    v_mfma_f32_16x16x32_bf16 v[168:171], v[80:83], a[148:151], v[168:171]
    ds_read_b128 v[72:75], v224 offset:45056
    v_mfma_f32_16x16x32_bf16 v[172:175], v[84:87], a[148:151], v[172:175]
    ds_read_b128 v[76:79], v224 offset:47104
    v_mfma_f32_16x16x32_bf16 v[176:179], v[80:83], a[152:155], v[176:179]
    v_mfma_f32_16x16x32_bf16 v[180:183], v[84:87], a[152:155], v[180:183]
    v_mfma_f32_16x16x32_bf16 v[184:187], v[80:83], a[156:159], v[184:187]
    v_mfma_f32_16x16x32_bf16 v[188:191], v[84:87], a[156:159], v[188:191]
    v_mfma_f32_16x16x32_bf16 v[192:195], v[88:91], a[144:147], v[192:195]
    v_mfma_f32_16x16x32_bf16 v[196:199], v[92:95], a[144:147], v[196:199]
    v_mfma_f32_16x16x32_bf16 v[200:203], v[88:91], a[148:151], v[200:203]
    v_mfma_f32_16x16x32_bf16 v[204:207], v[92:95], a[148:151], v[204:207]
    v_mfma_f32_16x16x32_bf16 v[208:211], v[88:91], a[152:155], v[208:211]
    v_mfma_f32_16x16x32_bf16 v[212:215], v[92:95], a[152:155], v[212:215]
    s_add_u32 s38, s36, 69632
    buffer_store_dwordx4 v[12:15], v240, s[16:19], s38 offen offset:1536 sc1
    v_mfma_f32_16x16x32_bf16 v[216:219], v[88:91], a[156:159], v[216:219]
    v_mfma_f32_16x16x32_bf16 v[220:223], v[92:95], a[156:159], v[220:223]
    s_waitcnt lgkmcnt(0)
    v_mfma_f32_16x16x32_bf16 v[160:163], v[64:67], a[160:163], v[160:163]
    ds_read_b128 v[80:83], v225 offset:40960
    v_mfma_f32_16x16x32_bf16 v[164:167], v[68:71], a[160:163], v[164:167]
    ds_read_b128 v[84:87], v225 offset:43008
    v_mfma_f32_16x16x32_bf16 v[168:171], v[64:67], a[164:167], v[168:171]
    ds_read_b128 v[88:91], v225 offset:45056
    v_mfma_f32_16x16x32_bf16 v[172:175], v[68:71], a[164:167], v[172:175]
    ds_read_b128 v[92:95], v225 offset:47104
    v_mfma_f32_16x16x32_bf16 v[176:179], v[64:67], a[168:171], v[176:179]
    v_mfma_f32_16x16x32_bf16 v[180:183], v[68:71], a[168:171], v[180:183]
    v_mfma_f32_16x16x32_bf16 v[184:187], v[64:67], a[172:175], v[184:187]
    v_mfma_f32_16x16x32_bf16 v[188:191], v[68:71], a[172:175], v[188:191]
    v_mfma_f32_16x16x32_bf16 v[192:195], v[72:75], a[160:163], v[192:195]
    v_mfma_f32_16x16x32_bf16 v[196:199], v[76:79], a[160:163], v[196:199]
    v_mfma_f32_16x16x32_bf16 v[200:203], v[72:75], a[164:167], v[200:203]
    v_mfma_f32_16x16x32_bf16 v[204:207], v[76:79], a[164:167], v[204:207]
    v_mfma_f32_16x16x32_bf16 v[208:211], v[72:75], a[168:171], v[208:211]
    v_mfma_f32_16x16x32_bf16 v[212:215], v[76:79], a[168:171], v[212:215]
    v_mfma_f32_16x16x32_bf16 v[216:219], v[72:75], a[172:175], v[216:219]
    v_mfma_f32_16x16x32_bf16 v[220:223], v[76:79], a[172:175], v[220:223]
    s_waitcnt lgkmcnt(0)
    v_mfma_f32_16x16x32_bf16 v[160:163], v[80:83], a[176:179], v[160:163]
    ds_read_b128 v[64:67], v224 offset:49152
    v_mfma_f32_16x16x32_bf16 v[164:167], v[84:87], a[176:179], v[164:167]
    ds_read_b128 v[68:71], v224 offset:51200
    v_mfma_f32_16x16x32_bf16 v[168:171], v[80:83], a[180:183], v[168:171]
    ds_read_b128 v[72:75], v224 offset:53248
    v_mfma_f32_16x16x32_bf16 v[172:175], v[84:87], a[180:183], v[172:175]
    ds_read_b128 v[76:79], v224 offset:55296
    s_add_u32 s38, s36, 73728
    buffer_store_dwordx4 v[16:19], v240, s[16:19], s38 offen offset:2560 sc1
    v_mfma_f32_16x16x32_bf16 v[176:179], v[80:83], a[184:187], v[176:179]
    v_mfma_f32_16x16x32_bf16 v[180:183], v[84:87], a[184:187], v[180:183]
    v_mfma_f32_16x16x32_bf16 v[184:187], v[80:83], a[188:191], v[184:187]
    v_mfma_f32_16x16x32_bf16 v[188:191], v[84:87], a[188:191], v[188:191]
    v_mfma_f32_16x16x32_bf16 v[192:195], v[88:91], a[176:179], v[192:195]
    v_mfma_f32_16x16x32_bf16 v[196:199], v[92:95], a[176:179], v[196:199]
    v_mfma_f32_16x16x32_bf16 v[200:203], v[88:91], a[180:183], v[200:203]
    v_mfma_f32_16x16x32_bf16 v[204:207], v[92:95], a[180:183], v[204:207]
    v_mfma_f32_16x16x32_bf16 v[208:211], v[88:91], a[184:187], v[208:211]
    v_mfma_f32_16x16x32_bf16 v[212:215], v[92:95], a[184:187], v[212:215]
    v_mfma_f32_16x16x32_bf16 v[216:219], v[88:91], a[188:191], v[216:219]
    v_mfma_f32_16x16x32_bf16 v[220:223], v[92:95], a[188:191], v[220:223]
    s_waitcnt vmcnt(3)
    v_readfirstlane_b32 s24, v254
    s_lshl_b32 s25, s3, 16
    s_add_u32 s24, s24, s25
    s_cmp_ge_u32 s24, 32
    s_cbranch_scc0 kf_spin47
kf_spinr48:
    s_waitcnt lgkmcnt(0)
    s_barrier
    v_mfma_f32_16x16x32_bf16 v[160:163], v[64:67], a[192:195], v[160:163]
    ds_read_b128 v[80:83], v225 offset:49152
    v_mfma_f32_16x16x32_bf16 v[164:167], v[68:71], a[192:195], v[164:167]
    ds_read_b128 v[84:87], v225 offset:51200
    v_mfma_f32_16x16x32_bf16 v[168:171], v[64:67], a[196:199], v[168:171]
    ds_read_b128 v[88:91], v225 offset:53248
    v_mfma_f32_16x16x32_bf16 v[172:175], v[68:71], a[196:199], v[172:175]
    ds_read_b128 v[92:95], v225 offset:55296
    v_mfma_f32_16x16x32_bf16 v[176:179], v[64:67], a[200:203], v[176:179]
    v_mfma_f32_16x16x32_bf16 v[180:183], v[68:71], a[200:203], v[180:183]
    v_mfma_f32_16x16x32_bf16 v[184:187], v[64:67], a[204:207], v[184:187]
    v_mfma_f32_16x16x32_bf16 v[188:191], v[68:71], a[204:207], v[188:191]
    v_mfma_f32_16x16x32_bf16 v[192:195], v[72:75], a[192:195], v[192:195]
    buffer_load_dwordx4 a[128:131], v248, s[8:11], s28 offen offset:0 sc1
    s_add_u32 s38, s36, 73728
    buffer_store_dwordx4 v[20:23], v240, s[16:19], s38 offen offset:3584 sc1
    v_mfma_f32_16x16x32_bf16 v[196:199], v[76:79], a[192:195], v[196:199]
    v_mfma_f32_16x16x32_bf16 v[200:203], v[72:75], a[196:199], v[200:203]
    buffer_load_dwordx4 a[132:135], v248, s[8:11], s29 offen offset:0 sc1
    v_mfma_f32_16x16x32_bf16 v[204:207], v[76:79], a[196:199], v[204:207]
    v_mfma_f32_16x16x32_bf16 v[208:211], v[72:75], a[200:203], v[208:211]
    v_mfma_f32_16x16x32_bf16 v[212:215], v[76:79], a[200:203], v[212:215]
    buffer_load_dwordx4 a[136:139], v249, s[8:11], s28 offen offset:0 sc1
    v_mfma_f32_16x16x32_bf16 v[216:219], v[72:75], a[204:207], v[216:219]
    v_mfma_f32_16x16x32_bf16 v[220:223], v[76:79], a[204:207], v[220:223]
    s_waitcnt lgkmcnt(0)
    v_mfma_f32_16x16x32_bf16 v[160:163], v[80:83], a[208:211], v[160:163]
    ds_read_b128 v[64:67], v224 offset:57344
    v_mfma_f32_16x16x32_bf16 v[164:167], v[84:87], a[208:211], v[164:167]
    ds_read_b128 v[68:71], v224 offset:59392
    v_mfma_f32_16x16x32_bf16 v[168:171], v[80:83], a[212:215], v[168:171]
    ds_read_b128 v[72:75], v224 offset:61440
    v_mfma_f32_16x16x32_bf16 v[172:175], v[84:87], a[212:215], v[172:175]
    ds_read_b128 v[76:79], v224 offset:63488
    v_mfma_f32_16x16x32_bf16 v[176:179], v[80:83], a[216:219], v[176:179]
    v_mfma_f32_16x16x32_bf16 v[180:183], v[84:87], a[216:219], v[180:183]
    v_mfma_f32_16x16x32_bf16 v[184:187], v[80:83], a[220:223], v[184:187]
    v_mfma_f32_16x16x32_bf16 v[188:191], v[84:87], a[220:223], v[188:191]
    v_mfma_f32_16x16x32_bf16 v[192:195], v[88:91], a[208:211], v[192:195]
    buffer_load_dwordx4 a[140:143], v249, s[8:11], s29 offen offset:0 sc1
    v_mfma_f32_16x16x32_bf16 v[196:199], v[92:95], a[208:211], v[196:199]
    v_mfma_f32_16x16x32_bf16 v[200:203], v[88:91], a[212:215], v[200:203]
    buffer_load_dwordx4 a[144:147], v248, s[8:11], s28 offen offset:1024 sc1
    v_mfma_f32_16x16x32_bf16 v[204:207], v[92:95], a[212:215], v[204:207]
    v_mfma_f32_16x16x32_bf16 v[208:211], v[88:91], a[216:219], v[208:211]
    v_mfma_f32_16x16x32_bf16 v[212:215], v[92:95], a[216:219], v[212:215]
    buffer_load_dwordx4 a[148:151], v248, s[8:11], s29 offen offset:1024 sc1
    v_mfma_f32_16x16x32_bf16 v[216:219], v[88:91], a[220:223], v[216:219]
    s_add_u32 s38, s36, 77824
    buffer_store_dwordx4 v[24:27], v240, s[16:19], s38 offen offset:512 sc1
    v_mfma_f32_16x16x32_bf16 v[220:223], v[92:95], a[220:223], v[220:223]
    s_waitcnt lgkmcnt(0)
    v_mfma_f32_16x16x32_bf16 v[160:163], v[64:67], a[224:227], v[160:163]
    ds_read_b128 v[80:83], v225 offset:57344
    v_mfma_f32_16x16x32_bf16 v[164:167], v[68:71], a[224:227], v[164:167]
    ds_read_b128 v[84:87], v225 offset:59392
    v_mfma_f32_16x16x32_bf16 v[168:171], v[64:67], a[228:231], v[168:171]
    ds_read_b128 v[88:91], v225 offset:61440
    v_mfma_f32_16x16x32_bf16 v[172:175], v[68:71], a[228:231], v[172:175]
    ds_read_b128 v[92:95], v225 offset:63488
    v_mfma_f32_16x16x32_bf16 v[176:179], v[64:67], a[232:235], v[176:179]
    v_mfma_f32_16x16x32_bf16 v[180:183], v[68:71], a[232:235], v[180:183]
    v_mfma_f32_16x16x32_bf16 v[184:187], v[64:67], a[236:239], v[184:187]
    v_mfma_f32_16x16x32_bf16 v[188:191], v[68:71], a[236:239], v[188:191]
    v_mfma_f32_16x16x32_bf16 v[192:195], v[72:75], a[224:227], v[192:195]
    buffer_load_dwordx4 a[152:155], v249, s[8:11], s28 offen offset:1024 sc1
    v_mfma_f32_16x16x32_bf16 v[196:199], v[76:79], a[224:227], v[196:199]
    v_mfma_f32_16x16x32_bf16 v[200:203], v[72:75], a[228:231], v[200:203]
    buffer_load_dwordx4 a[156:159], v249, s[8:11], s29 offen offset:1024 sc1
    v_mfma_f32_16x16x32_bf16 v[204:207], v[76:79], a[228:231], v[204:207]
    v_mfma_f32_16x16x32_bf16 v[208:211], v[72:75], a[232:235], v[208:211]
    v_mfma_f32_16x16x32_bf16 v[212:215], v[76:79], a[232:235], v[212:215]
    buffer_load_dwordx4 a[160:163], v248, s[8:11], s28 offen offset:2048 sc1
    v_mfma_f32_16x16x32_bf16 v[216:219], v[72:75], a[236:239], v[216:219]
    v_mfma_f32_16x16x32_bf16 v[220:223], v[76:79], a[236:239], v[220:223]
    s_waitcnt vmcnt(38) lgkmcnt(0)
    s_barrier
    v_mfma_f32_16x16x32_bf16 v[160:163], v[80:83], a[240:243], v[160:163]
    ds_read_b64_tr_b16 a[192:193], v246 offset:0
    v_mfma_f32_16x16x32_bf16 v[164:167], v[84:87], a[240:243], v[164:167]
    ds_read_b64_tr_b16 a[194:195], v246 offset:1024
    v_mfma_f32_16x16x32_bf16 v[168:171], v[80:83], a[244:247], v[168:171]
    ds_read_b64_tr_b16 a[196:197], v238 offset:0
    v_mfma_f32_16x16x32_bf16 v[172:175], v[84:87], a[244:247], v[172:175]
    ds_read_b64_tr_b16 a[198:199], v238 offset:1024
    v_mfma_f32_16x16x32_bf16 v[176:179], v[80:83], a[248:251], v[176:179]
    ds_read_b64_tr_b16 a[200:201], v246 offset:256
    s_add_u32 s38, s36, 77824
    buffer_store_dwordx4 v[28:31], v240, s[16:19], s38 offen offset:1536 sc1
    v_mfma_f32_16x16x32_bf16 v[180:183], v[84:87], a[248:251], v[180:183]
    ds_read_b64_tr_b16 a[202:203], v246 offset:1280
    v_mfma_f32_16x16x32_bf16 v[184:187], v[80:83], a[252:255], v[184:187]
    ds_read_b64_tr_b16 a[204:205], v238 offset:256
    v_mfma_f32_16x16x32_bf16 v[188:191], v[84:87], a[252:255], v[188:191]
    ds_read_b64_tr_b16 a[206:207], v238 offset:1280
    v_mfma_f32_16x16x32_bf16 v[192:195], v[88:91], a[240:243], v[192:195]
    buffer_load_dwordx4 a[164:167], v248, s[8:11], s29 offen offset:2048 sc1
    v_mfma_f32_16x16x32_bf16 v[196:199], v[92:95], a[240:243], v[196:199]
    v_cvt_pk_bf16_f32 v32, v160, v161
    v_cvt_pk_bf16_f32 v33, v162, v163
    v_mfma_f32_16x16x32_bf16 v[200:203], v[88:91], a[244:247], v[200:203]
    buffer_load_dwordx4 a[168:171], v249, s[8:11], s28 offen offset:2048 sc1
    v_cvt_pk_bf16_f32 v34, v164, v165
    v_cvt_pk_bf16_f32 v35, v166, v167
    v_mfma_f32_16x16x32_bf16 v[204:207], v[92:95], a[244:247], v[204:207]
    v_cvt_pk_bf16_f32 v36, v168, v169
    v_cvt_pk_bf16_f32 v37, v170, v171
    v_mfma_f32_16x16x32_bf16 v[208:211], v[88:91], a[248:251], v[208:211]
    v_cvt_pk_bf16_f32 v38, v172, v173
    v_cvt_pk_bf16_f32 v39, v174, v175
    v_mfma_f32_16x16x32_bf16 v[212:215], v[92:95], a[248:251], v[212:215]
    buffer_load_dwordx4 a[172:175], v249, s[8:11], s29 offen offset:2048 sc1
    v_cvt_pk_bf16_f32 v40, v176, v177
    v_cvt_pk_bf16_f32 v41, v178, v179
    v_mfma_f32_16x16x32_bf16 v[216:219], v[88:91], a[252:255], v[216:219]
    v_cvt_pk_bf16_f32 v42, v180, v181
    v_cvt_pk_bf16_f32 v43, v182, v183
    v_mfma_f32_16x16x32_bf16 v[220:223], v[92:95], a[252:255], v[220:223]
    v_cvt_pk_bf16_f32 v44, v184, v185
    v_cvt_pk_bf16_f32 v45, v186, v187
    s_nop 3
    v_cvt_pk_bf16_f32 v46, v188, v189
    v_cvt_pk_bf16_f32 v47, v190, v191
    v_cvt_pk_bf16_f32 v48, v192, v193
    v_cvt_pk_bf16_f32 v49, v194, v195
    v_cvt_pk_bf16_f32 v50, v196, v197
    v_cvt_pk_bf16_f32 v51, v198, v199
    v_cvt_pk_bf16_f32 v52, v200, v201
    v_cvt_pk_bf16_f32 v53, v202, v203
    v_cvt_pk_bf16_f32 v54, v204, v205
    v_cvt_pk_bf16_f32 v55, v206, v207
    v_cvt_pk_bf16_f32 v56, v208, v209
    v_cvt_pk_bf16_f32 v57, v210, v211
    v_cvt_pk_bf16_f32 v58, v212, v213
    v_cvt_pk_bf16_f32 v59, v214, v215
    v_cvt_pk_bf16_f32 v60, v216, v217
    v_cvt_pk_bf16_f32 v61, v218, v219
    v_cvt_pk_bf16_f32 v62, v220, v221
    v_cvt_pk_bf16_f32 v63, v222, v223
    s_add_u32 s80, s36, 102144
    s_add_u32 s81, s36, 103168
    s_add_u32 s82, s36, 104192
    s_add_u32 s83, s36, 105216
    s_add_u32 s84, s36, 110336
    s_add_u32 s85, s36, 111360
    s_add_u32 s86, s36, 112384
    s_add_u32 s87, s36, 113408
ka_Q:
    s_waitcnt vmcnt(10) lgkmcnt(0)
    v_mfma_f32_16x16x32_bf16 v[96:99], a[192:195], a[128:131], 0
    ds_read_b64_tr_b16 a[208:209], v246 offset:512
    s_lshl_b32 s97, s4, 7
    v_mfma_f32_16x16x32_bf16 v[100:103], a[192:195], a[132:135], 0
    ds_read_b64_tr_b16 a[210:211], v246 offset:1536
    s_add_u32 s97, s97, 12288
    s_cmp_eq_u32 s3, 0
    s_cselect_b32 s35, s97, s43
    v_mfma_f32_16x16x32_bf16 v[104:107], a[192:195], a[136:139], 0
    ds_read_b64_tr_b16 a[212:213], v238 offset:512
    s_lshl_b32 s37, s3, 12
    v_mfma_f32_16x16x32_bf16 v[108:111], a[192:195], a[140:143], 0
    ds_read_b64_tr_b16 a[214:215], v238 offset:1536
    s_mov_b32 s34, s37
    v_mfma_f32_16x16x32_bf16 v[112:115], a[196:199], a[128:131], 0
    ds_read_b64_tr_b16 a[216:217], v246 offset:768
    s_mul_i32 s32, s4, 1089536
    s_mov_b32 s33, 0
    v_mfma_f32_16x16x32_bf16 v[116:119], a[196:199], a[132:135], 0
    ds_read_b64_tr_b16 a[218:219], v246 offset:1792
    s_lshl_b32 s39, s6, 18
    v_mfma_f32_16x16x32_bf16 v[120:123], a[196:199], a[136:139], 0
    ds_read_b64_tr_b16 a[220:221], v238 offset:768
    s_sub_u32 s25, 63, s6
    v_mfma_f32_16x16x32_bf16 v[124:127], a[196:199], a[140:143], 0
    ds_read_b64_tr_b16 a[222:223], v238 offset:1792
    s_lshl_b32 s40, s25, 18
    s_lshl_b32 s25, s4, 12
    v_mfma_f32_16x16x32_bf16 v[128:131], a[200:203], a[128:131], 0
    buffer_load_dwordx4 a[176:179], v248, s[8:11], s28 offen offset:3072 sc1
    s_add_u32 s39, s39, s25
    v_mfma_f32_16x16x32_bf16 v[132:135], a[200:203], a[132:135], 0
    s_add_u32 s40, s40, s25
    s_mov_b32 s38, 0x47800000
    v_mfma_f32_16x16x32_bf16 v[136:139], a[200:203], a[136:139], 0
    buffer_load_dwordx4 a[180:183], v248, s[8:11], s29 offen offset:3072 sc1
    s_mov_b32 s36, s6
    v_mfma_f32_16x16x32_bf16 v[140:143], a[200:203], a[140:143], 0
    s_add_u32 m0, s31, 0
    s_add_u32 s24, s27, 0
    s_mov_b32 s26, 6
    v_mfma_f32_16x16x32_bf16 v[144:147], a[204:207], a[128:131], 0
    buffer_load_dwordx4 v245, s[12:15], s24 offen lds
    s_mov_b32 s52, s41
    v_mfma_f32_16x16x32_bf16 v[148:151], a[204:207], a[132:135], 0
    s_mov_b32 s53, s42
    s_mov_b32 s54, 0x700000
    v_mfma_f32_16x16x32_bf16 v[152:155], a[204:207], a[136:139], 0
    buffer_store_dwordx4 v[32:35], v240, s[16:19], s80 offen sc1
    s_add_u32 s48, s20, 0x1c00000
    s_addc_u32 s49, s21, 0
    s_mov_b32 s50, 0xe00000
    v_mfma_f32_16x16x32_bf16 v[156:159], a[204:207], a[140:143], 0
    s_and_b32 s25, s3, 1
    s_waitcnt lgkmcnt(0)
    v_mfma_f32_16x16x32_bf16 v[160:163], a[208:211], a[128:131], 0
    ds_read_b64_tr_b16 a[192:193], v246 offset:8192
    s_lshl1_add_u32 s47, s4, s25
    v_mfma_f32_16x16x32_bf16 v[164:167], a[208:211], a[132:135], 0
    ds_read_b64_tr_b16 a[194:195], v246 offset:9216
    s_mul_i32 s45, s5, s5
    s_lshl_b32 s100, s47, 17
    v_mfma_f32_16x16x32_bf16 v[168:171], a[208:211], a[136:139], 0
    ds_read_b64_tr_b16 a[196:197], v238 offset:8192
    s_lshl_b32 s25, s45, 11
    v_mfma_f32_16x16x32_bf16 v[172:175], a[208:211], a[140:143], 0
    ds_read_b64_tr_b16 a[198:199], v238 offset:9216
    s_add_u32 s100, s100, s25
    v_mfma_f32_16x16x32_bf16 v[176:179], a[212:215], a[128:131], 0
    ds_read_b64_tr_b16 a[200:201], v246 offset:8448
    s_lshl_b32 s46, s47, 9
    s_mul_i32 s44, s47, 114688
    v_mfma_f32_16x16x32_bf16 v[180:183], a[212:215], a[132:135], 0
    ds_read_b64_tr_b16 a[202:203], v246 offset:9472
    s_add_u32 s47, s44, 7168
    v_mfma_f32_16x16x32_bf16 v[184:187], a[212:215], a[136:139], 0
    ds_read_b64_tr_b16 a[204:205], v238 offset:8448
    s_lshl_b32 s25, s45, 7
    v_mfma_f32_16x16x32_bf16 v[188:191], a[212:215], a[140:143], 0
    ds_read_b64_tr_b16 a[206:207], v238 offset:9472
    s_add_u32 s44, s44, s25
    s_lshl_b32 s45, s45, 18
    v_mfma_f32_16x16x32_bf16 v[192:195], a[216:219], a[128:131], 0
    buffer_load_dwordx4 a[184:187], v249, s[8:11], s28 offen offset:3072 sc1
    s_add_u32 s46, s46, s45
    v_mfma_f32_16x16x32_bf16 v[196:199], a[216:219], a[132:135], 0
    s_lshr_b32 s25, s3, 1
    s_lshl_b32 s25, s25, 15
    v_mfma_f32_16x16x32_bf16 v[200:203], a[216:219], a[136:139], 0
    buffer_load_dwordx4 a[188:191], v249, s[8:11], s29 offen offset:3072 sc1
    s_add_u32 s46, s46, s25
    v_mfma_f32_16x16x32_bf16 v[204:207], a[216:219], a[140:143], 0
    s_add_u32 m0, s31, 1024
    s_add_u32 s24, s27, 32768
    s_mov_b32 s45, s43
    v_mfma_f32_16x16x32_bf16 v[208:211], a[220:223], a[128:131], 0
    buffer_load_dwordx4 v245, s[12:15], s24 offen lds
    v_accvgpr_write_b32 a0, 0
    v_mfma_f32_16x16x32_bf16 v[212:215], a[220:223], a[132:135], 0
    v_accvgpr_write_b32 a1, 0
    v_accvgpr_write_b32 a2, 0
    v_accvgpr_write_b32 a3, 0
    v_mfma_f32_16x16x32_bf16 v[216:219], a[220:223], a[136:139], 0
    s_add_u32 s28, s28, 4096
    s_and_b32 s28, s28, 32767
    buffer_store_dwordx4 v[36:39], v240, s[16:19], s81 offen sc1
    v_mfma_f32_16x16x32_bf16 v[220:223], a[220:223], a[140:143], 0
    s_add_u32 s29, s28, 32768
    s_waitcnt vmcnt(13) lgkmcnt(0)
    v_mfma_f32_16x16x32_bf16 v[96:99], a[192:195], a[144:147], v[96:99]
    ds_read_b64_tr_b16 a[208:209], v246 offset:8704
    s_load_dwordx2 s[56:57], s[0:1], 40
    v_accvgpr_write_b32 a4, 0
    v_mfma_f32_16x16x32_bf16 v[100:103], a[192:195], a[148:151], v[100:103]
    ds_read_b64_tr_b16 a[210:211], v246 offset:9728
    v_accvgpr_write_b32 a5, 0
    v_mfma_f32_16x16x32_bf16 v[104:107], a[192:195], a[152:155], v[104:107]
    ds_read_b64_tr_b16 a[212:213], v238 offset:8704
    v_accvgpr_write_b32 a6, 0
    v_accvgpr_write_b32 a7, 0
    v_mfma_f32_16x16x32_bf16 v[108:111], a[192:195], a[156:159], v[108:111]
    ds_read_b64_tr_b16 a[214:215], v238 offset:9728
    v_accvgpr_write_b32 a8, 0
    v_mfma_f32_16x16x32_bf16 v[112:115], a[196:199], a[144:147], v[112:115]
    ds_read_b64_tr_b16 a[216:217], v246 offset:8960
    v_accvgpr_write_b32 a9, 0
    v_mfma_f32_16x16x32_bf16 v[116:119], a[196:199], a[148:151], v[116:119]
    ds_read_b64_tr_b16 a[218:219], v246 offset:9984
    v_accvgpr_write_b32 a10, 0
    v_accvgpr_write_b32 a11, 0
    v_mfma_f32_16x16x32_bf16 v[120:123], a[196:199], a[152:155], v[120:123]
    ds_read_b64_tr_b16 a[220:221], v238 offset:8960
    v_accvgpr_write_b32 a12, 0
    v_mfma_f32_16x16x32_bf16 v[124:127], a[196:199], a[156:159], v[124:127]
    ds_read_b64_tr_b16 a[222:223], v238 offset:9984
    v_accvgpr_write_b32 a13, 0
    v_mfma_f32_16x16x32_bf16 v[128:131], a[200:203], a[144:147], v[128:131]
    buffer_load_dwordx4 a[128:131], v248, s[8:11], s28 offen offset:0 sc1
    v_accvgpr_write_b32 a14, 0
    v_accvgpr_write_b32 a15, 0
    v_mfma_f32_16x16x32_bf16 v[132:135], a[200:203], a[148:151], v[132:135]
    v_accvgpr_write_b32 a16, 0
    v_accvgpr_write_b32 a17, 0
    v_mfma_f32_16x16x32_bf16 v[136:139], a[200:203], a[152:155], v[136:139]
    buffer_load_dwordx4 a[132:135], v248, s[8:11], s29 offen offset:0 sc1
    v_accvgpr_write_b32 a18, 0
    v_mfma_f32_16x16x32_bf16 v[140:143], a[200:203], a[156:159], v[140:143]
    s_add_u32 m0, s31, 2048
    s_add_u32 s24, s27, 65536
    v_accvgpr_write_b32 a19, 0
    v_mfma_f32_16x16x32_bf16 v[144:147], a[204:207], a[144:147], v[144:147]
    buffer_load_dwordx4 v237, s[12:15], s24 offen lds
    v_accvgpr_write_b32 a20, 0
    v_mfma_f32_16x16x32_bf16 v[148:151], a[204:207], a[148:151], v[148:151]
    v_accvgpr_write_b32 a21, 0
    v_accvgpr_write_b32 a22, 0
    v_mfma_f32_16x16x32_bf16 v[152:155], a[204:207], a[152:155], v[152:155]
    buffer_store_dwordx4 v[40:43], v240, s[16:19], s82 offen sc1
    v_accvgpr_write_b32 a23, 0
    v_mfma_f32_16x16x32_bf16 v[156:159], a[204:207], a[156:159], v[156:159]
    v_accvgpr_write_b32 a24, 0
    v_accvgpr_write_b32 a25, 0
    s_waitcnt lgkmcnt(0)
    v_mfma_f32_16x16x32_bf16 v[160:163], a[208:211], a[144:147], v[160:163]
    ds_read_b64_tr_b16 a[192:193], v246 offset:16384
    v_accvgpr_write_b32 a26, 0
    v_mfma_f32_16x16x32_bf16 v[164:167], a[208:211], a[148:151], v[164:167]
    ds_read_b64_tr_b16 a[194:195], v246 offset:17408
    v_accvgpr_write_b32 a27, 0
    v_mfma_f32_16x16x32_bf16 v[168:171], a[208:211], a[152:155], v[168:171]
    ds_read_b64_tr_b16 a[196:197], v238 offset:16384
    v_accvgpr_write_b32 a28, 0
    v_accvgpr_write_b32 a29, 0
    v_mfma_f32_16x16x32_bf16 v[172:175], a[208:211], a[156:159], v[172:175]
    ds_read_b64_tr_b16 a[198:199], v238 offset:17408
    v_accvgpr_write_b32 a30, 0
    v_mfma_f32_16x16x32_bf16 v[176:179], a[212:215], a[144:147], v[176:179]
    ds_read_b64_tr_b16 a[200:201], v246 offset:16640
    v_accvgpr_write_b32 a31, 0
    v_mfma_f32_16x16x32_bf16 v[180:183], a[212:215], a[148:151], v[180:183]
    ds_read_b64_tr_b16 a[202:203], v246 offset:17664
    v_accvgpr_write_b32 a32, 0
    v_accvgpr_write_b32 a33, 0
    v_mfma_f32_16x16x32_bf16 v[184:187], a[212:215], a[152:155], v[184:187]
    ds_read_b64_tr_b16 a[204:205], v238 offset:16640
    v_accvgpr_write_b32 a34, 0
    v_mfma_f32_16x16x32_bf16 v[188:191], a[212:215], a[156:159], v[188:191]
    ds_read_b64_tr_b16 a[206:207], v238 offset:17664
    v_accvgpr_write_b32 a35, 0
    v_mfma_f32_16x16x32_bf16 v[192:195], a[216:219], a[144:147], v[192:195]
    buffer_load_dwordx4 a[136:139], v249, s[8:11], s28 offen offset:0 sc1
    v_accvgpr_write_b32 a36, 0
    v_accvgpr_write_b32 a37, 0
    v_mfma_f32_16x16x32_bf16 v[196:199], a[216:219], a[148:151], v[196:199]
    v_accvgpr_write_b32 a38, 0
    v_accvgpr_write_b32 a39, 0
    v_mfma_f32_16x16x32_bf16 v[200:203], a[216:219], a[152:155], v[200:203]
    buffer_load_dwordx4 a[140:143], v249, s[8:11], s29 offen offset:0 sc1
    v_accvgpr_write_b32 a40, 0
    v_mfma_f32_16x16x32_bf16 v[204:207], a[216:219], a[156:159], v[204:207]
    s_add_u32 m0, s31, 3072
    s_add_u32 s24, s27, 98304
    v_accvgpr_write_b32 a41, 0
    v_mfma_f32_16x16x32_bf16 v[208:211], a[220:223], a[144:147], v[208:211]
    buffer_load_dwordx4 v237, s[12:15], s24 offen lds
    v_accvgpr_write_b32 a42, 0
    v_mfma_f32_16x16x32_bf16 v[212:215], a[220:223], a[148:151], v[212:215]
    v_accvgpr_write_b32 a43, 0
    v_accvgpr_write_b32 a44, 0
    v_mfma_f32_16x16x32_bf16 v[216:219], a[220:223], a[152:155], v[216:219]
    buffer_store_dwordx4 v[44:47], v240, s[16:19], s83 offen sc1
    v_accvgpr_write_b32 a45, 0
    v_mfma_f32_16x16x32_bf16 v[220:223], a[220:223], a[156:159], v[220:223]
    v_accvgpr_write_b32 a46, 0
    v_accvgpr_write_b32 a47, 0
    s_waitcnt vmcnt(16) lgkmcnt(0)
    v_mfma_f32_16x16x32_bf16 v[96:99], a[192:195], a[160:163], v[96:99]
    ds_read_b64_tr_b16 a[208:209], v246 offset:16896
    v_accvgpr_write_b32 a48, 0
    v_mfma_f32_16x16x32_bf16 v[100:103], a[192:195], a[164:167], v[100:103]
    ds_read_b64_tr_b16 a[210:211], v246 offset:17920
    v_accvgpr_write_b32 a49, 0
    v_mfma_f32_16x16x32_bf16 v[104:107], a[192:195], a[168:171], v[104:107]
    ds_read_b64_tr_b16 a[212:213], v238 offset:16896
    v_accvgpr_write_b32 a50, 0
    v_accvgpr_write_b32 a51, 0
    v_mfma_f32_16x16x32_bf16 v[108:111], a[192:195], a[172:175], v[108:111]
    ds_read_b64_tr_b16 a[214:215], v238 offset:17920
    v_accvgpr_write_b32 a52, 0
    v_mfma_f32_16x16x32_bf16 v[112:115], a[196:199], a[160:163], v[112:115]
    ds_read_b64_tr_b16 a[216:217], v246 offset:17152
    v_accvgpr_write_b32 a53, 0
    v_mfma_f32_16x16x32_bf16 v[116:119], a[196:199], a[164:167], v[116:119]
    ds_read_b64_tr_b16 a[218:219], v246 offset:18176
    v_accvgpr_write_b32 a54, 0
    v_accvgpr_write_b32 a55, 0
    v_mfma_f32_16x16x32_bf16 v[120:123], a[196:199], a[168:171], v[120:123]
    ds_read_b64_tr_b16 a[220:221], v238 offset:17152
    v_accvgpr_write_b32 a56, 0
    v_mfma_f32_16x16x32_bf16 v[124:127], a[196:199], a[172:175], v[124:127]
    ds_read_b64_tr_b16 a[222:223], v238 offset:18176
    v_accvgpr_write_b32 a57, 0
    v_mfma_f32_16x16x32_bf16 v[128:131], a[200:203], a[160:163], v[128:131]
    buffer_load_dwordx4 a[144:147], v248, s[8:11], s28 offen offset:1024 sc1
    v_accvgpr_write_b32 a58, 0
    v_accvgpr_write_b32 a59, 0
    v_mfma_f32_16x16x32_bf16 v[132:135], a[200:203], a[164:167], v[132:135]
    v_accvgpr_write_b32 a60, 0
    v_accvgpr_write_b32 a61, 0
    v_mfma_f32_16x16x32_bf16 v[136:139], a[200:203], a[168:171], v[136:139]
    buffer_load_dwordx4 a[148:151], v248, s[8:11], s29 offen offset:1024 sc1
    v_accvgpr_write_b32 a62, 0
    v_mfma_f32_16x16x32_bf16 v[140:143], a[200:203], a[172:175], v[140:143]
    s_add_u32 m0, s31, 4096
    s_add_u32 s24, s27, 131072
    v_accvgpr_write_b32 a63, 0
    v_mfma_f32_16x16x32_bf16 v[144:147], a[204:207], a[160:163], v[144:147]
    buffer_load_dwordx4 v245, s[12:15], s24 offen lds
    v_accvgpr_write_b32 a64, 0
    v_mfma_f32_16x16x32_bf16 v[148:151], a[204:207], a[164:167], v[148:151]
    v_accvgpr_write_b32 a65, 0
    v_accvgpr_write_b32 a66, 0
    v_mfma_f32_16x16x32_bf16 v[152:155], a[204:207], a[168:171], v[152:155]
    buffer_store_dwordx4 v[48:51], v240, s[16:19], s84 offen sc1
    v_accvgpr_write_b32 a67, 0
    v_mfma_f32_16x16x32_bf16 v[156:159], a[204:207], a[172:175], v[156:159]
    v_accvgpr_write_b32 a68, 0
    v_accvgpr_write_b32 a69, 0
    s_waitcnt lgkmcnt(0)
    v_mfma_f32_16x16x32_bf16 v[160:163], a[208:211], a[160:163], v[160:163]
    ds_read_b64_tr_b16 a[192:193], v246 offset:24576
    v_accvgpr_write_b32 a70, 0
    v_mfma_f32_16x16x32_bf16 v[164:167], a[208:211], a[164:167], v[164:167]
    ds_read_b64_tr_b16 a[194:195], v246 offset:25600
    v_accvgpr_write_b32 a71, 0
    v_mfma_f32_16x16x32_bf16 v[168:171], a[208:211], a[168:171], v[168:171]
    ds_read_b64_tr_b16 a[196:197], v238 offset:24576
    v_accvgpr_write_b32 a72, 0
    v_accvgpr_write_b32 a73, 0
    v_mfma_f32_16x16x32_bf16 v[172:175], a[208:211], a[172:175], v[172:175]
    ds_read_b64_tr_b16 a[198:199], v238 offset:25600
    v_accvgpr_write_b32 a74, 0
    v_mfma_f32_16x16x32_bf16 v[176:179], a[212:215], a[160:163], v[176:179]
    ds_read_b64_tr_b16 a[200:201], v246 offset:24832
    v_accvgpr_write_b32 a75, 0
    v_mfma_f32_16x16x32_bf16 v[180:183], a[212:215], a[164:167], v[180:183]
    ds_read_b64_tr_b16 a[202:203], v246 offset:25856
    v_accvgpr_write_b32 a76, 0
    v_accvgpr_write_b32 a77, 0
    v_mfma_f32_16x16x32_bf16 v[184:187], a[212:215], a[168:171], v[184:187]
    ds_read_b64_tr_b16 a[204:205], v238 offset:24832
    v_accvgpr_write_b32 a78, 0
    v_mfma_f32_16x16x32_bf16 v[188:191], a[212:215], a[172:175], v[188:191]
    ds_read_b64_tr_b16 a[206:207], v238 offset:25856
    v_accvgpr_write_b32 a79, 0
    v_mfma_f32_16x16x32_bf16 v[192:195], a[216:219], a[160:163], v[192:195]
    buffer_load_dwordx4 a[152:155], v249, s[8:11], s28 offen offset:1024 sc1
    v_accvgpr_write_b32 a80, 0
    v_accvgpr_write_b32 a81, 0
    v_mfma_f32_16x16x32_bf16 v[196:199], a[216:219], a[164:167], v[196:199]
    v_accvgpr_write_b32 a82, 0
    v_accvgpr_write_b32 a83, 0
    v_mfma_f32_16x16x32_bf16 v[200:203], a[216:219], a[168:171], v[200:203]
    buffer_load_dwordx4 a[156:159], v249, s[8:11], s29 offen offset:1024 sc1
    v_accvgpr_write_b32 a84, 0
    v_mfma_f32_16x16x32_bf16 v[204:207], a[216:219], a[172:175], v[204:207]
    s_add_u32 m0, s31, 5120
    s_add_u32 s24, s27, 163840
    v_accvgpr_write_b32 a85, 0
    v_mfma_f32_16x16x32_bf16 v[208:211], a[220:223], a[160:163], v[208:211]
    buffer_load_dwordx4 v245, s[12:15], s24 offen lds
    v_accvgpr_write_b32 a86, 0
    v_mfma_f32_16x16x32_bf16 v[212:215], a[220:223], a[164:167], v[212:215]
    v_accvgpr_write_b32 a87, 0
    v_accvgpr_write_b32 a88, 0
    v_mfma_f32_16x16x32_bf16 v[216:219], a[220:223], a[168:171], v[216:219]
    s_add_u32 s30, s30, 32768
    buffer_store_dwordx4 v[52:55], v240, s[16:19], s85 offen sc1
    v_accvgpr_write_b32 a89, 0
    v_mfma_f32_16x16x32_bf16 v[220:223], a[220:223], a[172:175], v[220:223]
    s_cmp_ge_u32 s30, 163840
    s_cselect_b32 s30, 65536, s30
    s_waitcnt vmcnt(18) lgkmcnt(0)
    v_mfma_f32_16x16x32_bf16 v[96:99], a[192:195], a[176:179], v[96:99]
    ds_read_b64_tr_b16 a[208:209], v246 offset:25088
    v_accvgpr_write_b32 a90, 0
    v_mfma_f32_16x16x32_bf16 v[100:103], a[192:195], a[180:183], v[100:103]
    ds_read_b64_tr_b16 a[210:211], v246 offset:26112
    v_accvgpr_write_b32 a91, 0
    v_accvgpr_write_b32 a92, 0
    v_mfma_f32_16x16x32_bf16 v[104:107], a[192:195], a[184:187], v[104:107]
    ds_read_b64_tr_b16 a[212:213], v238 offset:25088
    v_accvgpr_write_b32 a93, 0
    v_mfma_f32_16x16x32_bf16 v[108:111], a[192:195], a[188:191], v[108:111]
    ds_read_b64_tr_b16 a[214:215], v238 offset:26112
    v_accvgpr_write_b32 a94, 0
    v_mfma_f32_16x16x32_bf16 v[112:115], a[196:199], a[176:179], v[112:115]
    ds_read_b64_tr_b16 a[216:217], v246 offset:25344
    v_accvgpr_write_b32 a95, 0
    v_accvgpr_write_b32 a96, 0
    v_mfma_f32_16x16x32_bf16 v[116:119], a[196:199], a[180:183], v[116:119]
    ds_read_b64_tr_b16 a[218:219], v246 offset:26368
    v_accvgpr_write_b32 a97, 0
    v_mfma_f32_16x16x32_bf16 v[120:123], a[196:199], a[184:187], v[120:123]
    ds_read_b64_tr_b16 a[220:221], v238 offset:25344
    v_accvgpr_write_b32 a98, 0
    v_mfma_f32_16x16x32_bf16 v[124:127], a[196:199], a[188:191], v[124:127]
    ds_read_b64_tr_b16 a[222:223], v238 offset:26368
    v_accvgpr_write_b32 a99, 0
    v_accvgpr_write_b32 a100, 0
    v_mfma_f32_16x16x32_bf16 v[128:131], a[200:203], a[176:179], v[128:131]
    buffer_load_dwordx4 a[160:163], v248, s[8:11], s28 offen offset:2048 sc1
    v_accvgpr_write_b32 a101, 0
    v_mfma_f32_16x16x32_bf16 v[132:135], a[200:203], a[180:183], v[132:135]
    v_accvgpr_write_b32 a102, 0
    v_accvgpr_write_b32 a103, 0
    v_mfma_f32_16x16x32_bf16 v[136:139], a[200:203], a[184:187], v[136:139]
    buffer_load_dwordx4 a[164:167], v248, s[8:11], s29 offen offset:2048 sc1
    v_accvgpr_write_b32 a104, 0
    v_mfma_f32_16x16x32_bf16 v[140:143], a[200:203], a[188:191], v[140:143]
    s_add_u32 m0, s31, 6144
    s_add_u32 s24, s27, 196608
    v_accvgpr_write_b32 a105, 0
    v_mfma_f32_16x16x32_bf16 v[144:147], a[204:207], a[176:179], v[144:147]
    buffer_load_dwordx4 v237, s[12:15], s24 offen lds
    v_accvgpr_write_b32 a106, 0
    v_mfma_f32_16x16x32_bf16 v[148:151], a[204:207], a[180:183], v[148:151]
    v_accvgpr_write_b32 a107, 0
    v_accvgpr_write_b32 a108, 0
    v_mfma_f32_16x16x32_bf16 v[152:155], a[204:207], a[184:187], v[152:155]
    buffer_store_dwordx4 v[56:59], v240, s[16:19], s86 offen sc1
    v_accvgpr_write_b32 a109, 0
    v_accvgpr_write_b32 a110, 0
    v_mfma_f32_16x16x32_bf16 v[156:159], a[204:207], a[188:191], v[156:159]
    s_waitcnt vmcnt(49) lgkmcnt(0)
    s_barrier
    v_add_u32 v246, s30, v247
    v_mfma_f32_16x16x32_bf16 v[160:163], a[208:211], a[176:179], v[160:163]
    v_xor_b32 v238, 32, v246
    ds_read_b64_tr_b16 a[192:193], v246 offset:0
    v_mfma_f32_16x16x32_bf16 v[164:167], a[208:211], a[180:183], v[164:167]
    ds_read_b64_tr_b16 a[194:195], v246 offset:1024
    v_accvgpr_write_b32 a111, 0
    v_accvgpr_write_b32 a112, 0
    v_mfma_f32_16x16x32_bf16 v[168:171], a[208:211], a[184:187], v[168:171]
    ds_read_b64_tr_b16 a[196:197], v238 offset:0
    v_accvgpr_write_b32 a113, 0
    v_mfma_f32_16x16x32_bf16 v[172:175], a[208:211], a[188:191], v[172:175]
    ds_read_b64_tr_b16 a[198:199], v238 offset:1024
    v_accvgpr_write_b32 a114, 0
    v_mfma_f32_16x16x32_bf16 v[176:179], a[212:215], a[176:179], v[176:179]
    ds_read_b64_tr_b16 a[200:201], v246 offset:256
    v_accvgpr_write_b32 a115, 0
    v_accvgpr_write_b32 a116, 0
    v_mfma_f32_16x16x32_bf16 v[180:183], a[212:215], a[180:183], v[180:183]
    ds_read_b64_tr_b16 a[202:203], v246 offset:1280
    v_accvgpr_write_b32 a117, 0
    v_mfma_f32_16x16x32_bf16 v[184:187], a[212:215], a[184:187], v[184:187]
    ds_read_b64_tr_b16 a[204:205], v238 offset:256
    buffer_store_dwordx4 v[60:63], v240, s[16:19], s87 offen sc1
    v_accvgpr_write_b32 a118, 0
    v_mfma_f32_16x16x32_bf16 v[188:191], a[212:215], a[188:191], v[188:191]
    ds_read_b64_tr_b16 a[206:207], v238 offset:1280
    v_accvgpr_write_b32 a119, 0
    v_mfma_f32_16x16x32_bf16 v[192:195], a[216:219], a[176:179], v[192:195]
    buffer_load_dwordx4 a[168:171], v249, s[8:11], s28 offen offset:2048 sc1
    v_accvgpr_write_b32 a120, 0
    v_mfma_f32_16x16x32_bf16 v[196:199], a[216:219], a[180:183], v[196:199]
    v_accvgpr_write_b32 a121, 0
    v_accvgpr_write_b32 a122, 0
    v_mfma_f32_16x16x32_bf16 v[200:203], a[216:219], a[184:187], v[200:203]
    buffer_load_dwordx4 a[172:175], v249, s[8:11], s29 offen offset:2048 sc1
    v_accvgpr_write_b32 a123, 0
    v_accvgpr_write_b32 a124, 0
    v_mfma_f32_16x16x32_bf16 v[204:207], a[216:219], a[188:191], v[204:207]
    s_add_u32 m0, s31, 7168
    s_add_u32 s24, s27, 229376
    v_mfma_f32_16x16x32_bf16 v[208:211], a[220:223], a[176:179], v[208:211]
    buffer_load_dwordx4 v237, s[12:15], s24 offen lds
    v_accvgpr_write_b32 a125, 0
    v_accvgpr_write_b32 a126, 0
    v_mfma_f32_16x16x32_bf16 v[212:215], a[220:223], a[180:183], v[212:215]
    s_add_u32 s27, s27, 1048576
    s_and_b32 s27, s27, 0x407fffff
    v_mfma_f32_16x16x32_bf16 v[216:219], a[220:223], a[184:187], v[216:219]
    s_cmp_eq_u32 s27, s7
    s_cselect_b32 s27, s43, s27
    v_accvgpr_write_b32 a127, 0
    v_mfma_f32_16x16x32_bf16 v[220:223], a[220:223], a[188:191], v[220:223]
    s_add_u32 s31, s31, 32768
    s_cmp_ge_u32 s31, 163840
    s_cselect_b32 s24, 98304, 0
    s_sub_u32 s31, s31, s24
.p2align 3
ka_qp:
    s_waitcnt vmcnt(14) lgkmcnt(0)
    v_mfma_f32_16x16x32_bf16 v[96:99], a[192:195], a[128:131], v[96:99]
    ds_read_b64_tr_b16 a[208:209], v246 offset:512
    v_mfma_f32_16x16x32_bf16 v[100:103], a[192:195], a[132:135], v[100:103]
    ds_read_b64_tr_b16 a[210:211], v246 offset:1536
    v_mfma_f32_16x16x32_bf16 v[104:107], a[192:195], a[136:139], v[104:107]
    ds_read_b64_tr_b16 a[212:213], v238 offset:512
    v_mfma_f32_16x16x32_bf16 v[108:111], a[192:195], a[140:143], v[108:111]
    ds_read_b64_tr_b16 a[214:215], v238 offset:1536
    v_mfma_f32_16x16x32_bf16 v[112:115], a[196:199], a[128:131], v[112:115]
    ds_read_b64_tr_b16 a[216:217], v246 offset:768
    v_mfma_f32_16x16x32_bf16 v[116:119], a[196:199], a[132:135], v[116:119]
    ds_read_b64_tr_b16 a[218:219], v246 offset:1792
    v_mfma_f32_16x16x32_bf16 v[120:123], a[196:199], a[136:139], v[120:123]
    ds_read_b64_tr_b16 a[220:221], v238 offset:768
    v_mfma_f32_16x16x32_bf16 v[124:127], a[196:199], a[140:143], v[124:127]
    ds_read_b64_tr_b16 a[222:223], v238 offset:1792
    v_mfma_f32_16x16x32_bf16 v[128:131], a[200:203], a[128:131], v[128:131]
    buffer_load_dwordx4 a[176:179], v248, s[8:11], s28 offen offset:3072 sc1
    s_cmp_eq_u32 s26, 1
    s_cselect_b32 s41, s35, s43
    buffer_load_dword v254, off, s[88:91], s41 sc1
    v_mfma_f32_16x16x32_bf16 v[132:135], a[200:203], a[132:135], v[132:135]
    v_mfma_f32_16x16x32_bf16 v[136:139], a[200:203], a[136:139], v[136:139]
    buffer_load_dwordx4 a[180:183], v248, s[8:11], s29 offen offset:3072 sc1
    v_mfma_f32_16x16x32_bf16 v[140:143], a[200:203], a[140:143], v[140:143]
    s_add_u32 m0, s31, 0
    s_add_u32 s24, s27, 0
    v_mfma_f32_16x16x32_bf16 v[144:147], a[204:207], a[128:131], v[144:147]
    buffer_load_dwordx4 v245, s[12:15], s24 offen lds
    v_mfma_f32_16x16x32_bf16 v[148:151], a[204:207], a[132:135], v[148:151]
    v_mfma_f32_16x16x32_bf16 v[152:155], a[204:207], a[136:139], v[152:155]
    v_mfma_f32_16x16x32_bf16 v[156:159], a[204:207], a[140:143], v[156:159]
    s_waitcnt lgkmcnt(0)
    v_mfma_f32_16x16x32_bf16 v[160:163], a[208:211], a[128:131], v[160:163]
    ds_read_b64_tr_b16 a[192:193], v246 offset:8192
    v_mfma_f32_16x16x32_bf16 v[164:167], a[208:211], a[132:135], v[164:167]
    ds_read_b64_tr_b16 a[194:195], v246 offset:9216
    v_mfma_f32_16x16x32_bf16 v[168:171], a[208:211], a[136:139], v[168:171]
    ds_read_b64_tr_b16 a[196:197], v238 offset:8192
    v_mfma_f32_16x16x32_bf16 v[172:175], a[208:211], a[140:143], v[172:175]
    ds_read_b64_tr_b16 a[198:199], v238 offset:9216
    v_mfma_f32_16x16x32_bf16 v[176:179], a[212:215], a[128:131], v[176:179]
    ds_read_b64_tr_b16 a[200:201], v246 offset:8448
    v_mfma_f32_16x16x32_bf16 v[180:183], a[212:215], a[132:135], v[180:183]
    ds_read_b64_tr_b16 a[202:203], v246 offset:9472
    v_mfma_f32_16x16x32_bf16 v[184:187], a[212:215], a[136:139], v[184:187]
    ds_read_b64_tr_b16 a[204:205], v238 offset:8448
    v_mfma_f32_16x16x32_bf16 v[188:191], a[212:215], a[140:143], v[188:191]
    ds_read_b64_tr_b16 a[206:207], v238 offset:9472
    v_mfma_f32_16x16x32_bf16 v[192:195], a[216:219], a[128:131], v[192:195]
    buffer_load_dwordx4 a[184:187], v249, s[8:11], s28 offen offset:3072 sc1
    v_mfma_f32_16x16x32_bf16 v[196:199], a[216:219], a[132:135], v[196:199]
    v_mfma_f32_16x16x32_bf16 v[200:203], a[216:219], a[136:139], v[200:203]
    buffer_load_dwordx4 a[188:191], v249, s[8:11], s29 offen offset:3072 sc1
    v_mfma_f32_16x16x32_bf16 v[204:207], a[216:219], a[140:143], v[204:207]
    s_add_u32 m0, s31, 1024
    s_add_u32 s24, s27, 32768
    v_mfma_f32_16x16x32_bf16 v[208:211], a[220:223], a[128:131], v[208:211]
    buffer_load_dwordx4 v245, s[12:15], s24 offen lds
    v_mfma_f32_16x16x32_bf16 v[212:215], a[220:223], a[132:135], v[212:215]
    v_mfma_f32_16x16x32_bf16 v[216:219], a[220:223], a[136:139], v[216:219]
    s_add_u32 s28, s28, 4096
    s_and_b32 s28, s28, 32767
    v_mfma_f32_16x16x32_bf16 v[220:223], a[220:223], a[140:143], v[220:223]
    s_add_u32 s29, s28, 32768
    s_waitcnt vmcnt(15) lgkmcnt(0)
    v_mfma_f32_16x16x32_bf16 v[96:99], a[192:195], a[144:147], v[96:99]
    ds_read_b64_tr_b16 a[208:209], v246 offset:8704
    v_mfma_f32_16x16x32_bf16 v[100:103], a[192:195], a[148:151], v[100:103]
    ds_read_b64_tr_b16 a[210:211], v246 offset:9728
    v_mfma_f32_16x16x32_bf16 v[104:107], a[192:195], a[152:155], v[104:107]
    ds_read_b64_tr_b16 a[212:213], v238 offset:8704
    v_mfma_f32_16x16x32_bf16 v[108:111], a[192:195], a[156:159], v[108:111]
    ds_read_b64_tr_b16 a[214:215], v238 offset:9728
    v_mfma_f32_16x16x32_bf16 v[112:115], a[196:199], a[144:147], v[112:115]
    ds_read_b64_tr_b16 a[216:217], v246 offset:8960
    v_mfma_f32_16x16x32_bf16 v[116:119], a[196:199], a[148:151], v[116:119]
    ds_read_b64_tr_b16 a[218:219], v246 offset:9984
    v_mfma_f32_16x16x32_bf16 v[120:123], a[196:199], a[152:155], v[120:123]
    ds_read_b64_tr_b16 a[220:221], v238 offset:8960
    v_mfma_f32_16x16x32_bf16 v[124:127], a[196:199], a[156:159], v[124:127]
    ds_read_b64_tr_b16 a[222:223], v238 offset:9984
    v_mfma_f32_16x16x32_bf16 v[128:131], a[200:203], a[144:147], v[128:131]
    buffer_load_dwordx4 a[128:131], v248, s[8:11], s28 offen offset:0 sc1
    v_mfma_f32_16x16x32_bf16 v[132:135], a[200:203], a[148:151], v[132:135]
    v_mfma_f32_16x16x32_bf16 v[136:139], a[200:203], a[152:155], v[136:139]
    buffer_load_dwordx4 a[132:135], v248, s[8:11], s29 offen offset:0 sc1
    v_mfma_f32_16x16x32_bf16 v[140:143], a[200:203], a[156:159], v[140:143]
    s_add_u32 m0, s31, 2048
    s_add_u32 s24, s27, 65536
    v_mfma_f32_16x16x32_bf16 v[144:147], a[204:207], a[144:147], v[144:147]
    buffer_load_dwordx4 v237, s[12:15], s24 offen lds
    v_mfma_f32_16x16x32_bf16 v[148:151], a[204:207], a[148:151], v[148:151]
    v_mfma_f32_16x16x32_bf16 v[152:155], a[204:207], a[152:155], v[152:155]
    v_mfma_f32_16x16x32_bf16 v[156:159], a[204:207], a[156:159], v[156:159]
    s_waitcnt lgkmcnt(0)
    v_mfma_f32_16x16x32_bf16 v[160:163], a[208:211], a[144:147], v[160:163]
    ds_read_b64_tr_b16 a[192:193], v246 offset:16384
    v_mfma_f32_16x16x32_bf16 v[164:167], a[208:211], a[148:151], v[164:167]
    ds_read_b64_tr_b16 a[194:195], v246 offset:17408
    v_mfma_f32_16x16x32_bf16 v[168:171], a[208:211], a[152:155], v[168:171]
    ds_read_b64_tr_b16 a[196:197], v238 offset:16384
    v_mfma_f32_16x16x32_bf16 v[172:175], a[208:211], a[156:159], v[172:175]
    ds_read_b64_tr_b16 a[198:199], v238 offset:17408
    v_mfma_f32_16x16x32_bf16 v[176:179], a[212:215], a[144:147], v[176:179]
    ds_read_b64_tr_b16 a[200:201], v246 offset:16640
    v_mfma_f32_16x16x32_bf16 v[180:183], a[212:215], a[148:151], v[180:183]
    ds_read_b64_tr_b16 a[202:203], v246 offset:17664
    v_mfma_f32_16x16x32_bf16 v[184:187], a[212:215], a[152:155], v[184:187]
    ds_read_b64_tr_b16 a[204:205], v238 offset:16640
    v_mfma_f32_16x16x32_bf16 v[188:191], a[212:215], a[156:159], v[188:191]
    ds_read_b64_tr_b16 a[206:207], v238 offset:17664
    v_mfma_f32_16x16x32_bf16 v[192:195], a[216:219], a[144:147], v[192:195]
    buffer_load_dwordx4 a[136:139], v249, s[8:11], s28 offen offset:0 sc1
    v_mfma_f32_16x16x32_bf16 v[196:199], a[216:219], a[148:151], v[196:199]
    v_mfma_f32_16x16x32_bf16 v[200:203], a[216:219], a[152:155], v[200:203]
    buffer_load_dwordx4 a[140:143], v249, s[8:11], s29 offen offset:0 sc1
    v_mfma_f32_16x16x32_bf16 v[204:207], a[216:219], a[156:159], v[204:207]
    s_add_u32 m0, s31, 3072
    s_add_u32 s24, s27, 98304
    v_mfma_f32_16x16x32_bf16 v[208:211], a[220:223], a[144:147], v[208:211]
    buffer_load_dwordx4 v237, s[12:15], s24 offen lds
    v_mfma_f32_16x16x32_bf16 v[212:215], a[220:223], a[148:151], v[212:215]
    v_mfma_f32_16x16x32_bf16 v[216:219], a[220:223], a[152:155], v[216:219]
    v_mfma_f32_16x16x32_bf16 v[220:223], a[220:223], a[156:159], v[220:223]
    s_waitcnt vmcnt(14) lgkmcnt(0)
    v_mfma_f32_16x16x32_bf16 v[96:99], a[192:195], a[160:163], v[96:99]
    ds_read_b64_tr_b16 a[208:209], v246 offset:16896
    v_mfma_f32_16x16x32_bf16 v[100:103], a[192:195], a[164:167], v[100:103]
    ds_read_b64_tr_b16 a[210:211], v246 offset:17920
    v_mfma_f32_16x16x32_bf16 v[104:107], a[192:195], a[168:171], v[104:107]
    ds_read_b64_tr_b16 a[212:213], v238 offset:16896
    v_mfma_f32_16x16x32_bf16 v[108:111], a[192:195], a[172:175], v[108:111]
    ds_read_b64_tr_b16 a[214:215], v238 offset:17920
    v_mfma_f32_16x16x32_bf16 v[112:115], a[196:199], a[160:163], v[112:115]
    ds_read_b64_tr_b16 a[216:217], v246 offset:17152
    v_mfma_f32_16x16x32_bf16 v[116:119], a[196:199], a[164:167], v[116:119]
    ds_read_b64_tr_b16 a[218:219], v246 offset:18176
    v_mfma_f32_16x16x32_bf16 v[120:123], a[196:199], a[168:171], v[120:123]
    ds_read_b64_tr_b16 a[220:221], v238 offset:17152
    v_mfma_f32_16x16x32_bf16 v[124:127], a[196:199], a[172:175], v[124:127]
    ds_read_b64_tr_b16 a[222:223], v238 offset:18176
    v_mfma_f32_16x16x32_bf16 v[128:131], a[200:203], a[160:163], v[128:131]
    buffer_load_dwordx4 a[144:147], v248, s[8:11], s28 offen offset:1024 sc1
    v_mfma_f32_16x16x32_bf16 v[132:135], a[200:203], a[164:167], v[132:135]
    v_mfma_f32_16x16x32_bf16 v[136:139], a[200:203], a[168:171], v[136:139]
    buffer_load_dwordx4 a[148:151], v248, s[8:11], s29 offen offset:1024 sc1
    v_mfma_f32_16x16x32_bf16 v[140:143], a[200:203], a[172:175], v[140:143]
    s_add_u32 m0, s31, 4096
    s_add_u32 s24, s27, 131072
    v_mfma_f32_16x16x32_bf16 v[144:147], a[204:207], a[160:163], v[144:147]
    buffer_load_dwordx4 v245, s[12:15], s24 offen lds
    v_mfma_f32_16x16x32_bf16 v[148:151], a[204:207], a[164:167], v[148:151]
    v_mfma_f32_16x16x32_bf16 v[152:155], a[204:207], a[168:171], v[152:155]
    v_mfma_f32_16x16x32_bf16 v[156:159], a[204:207], a[172:175], v[156:159]
    s_waitcnt lgkmcnt(0)
    v_mfma_f32_16x16x32_bf16 v[160:163], a[208:211], a[160:163], v[160:163]
    ds_read_b64_tr_b16 a[192:193], v246 offset:24576
    v_mfma_f32_16x16x32_bf16 v[164:167], a[208:211], a[164:167], v[164:167]
    ds_read_b64_tr_b16 a[194:195], v246 offset:25600
    v_mfma_f32_16x16x32_bf16 v[168:171], a[208:211], a[168:171], v[168:171]
    ds_read_b64_tr_b16 a[196:197], v238 offset:24576
    v_mfma_f32_16x16x32_bf16 v[172:175], a[208:211], a[172:175], v[172:175]
    ds_read_b64_tr_b16 a[198:199], v238 offset:25600
    v_mfma_f32_16x16x32_bf16 v[176:179], a[212:215], a[160:163], v[176:179]
    ds_read_b64_tr_b16 a[200:201], v246 offset:24832
    v_mfma_f32_16x16x32_bf16 v[180:183], a[212:215], a[164:167], v[180:183]
    ds_read_b64_tr_b16 a[202:203], v246 offset:25856
    v_mfma_f32_16x16x32_bf16 v[184:187], a[212:215], a[168:171], v[184:187]
    ds_read_b64_tr_b16 a[204:205], v238 offset:24832
    v_mfma_f32_16x16x32_bf16 v[188:191], a[212:215], a[172:175], v[188:191]
    ds_read_b64_tr_b16 a[206:207], v238 offset:25856
    v_mfma_f32_16x16x32_bf16 v[192:195], a[216:219], a[160:163], v[192:195]
    buffer_load_dwordx4 a[152:155], v249, s[8:11], s28 offen offset:1024 sc1
    v_mfma_f32_16x16x32_bf16 v[196:199], a[216:219], a[164:167], v[196:199]
    v_mfma_f32_16x16x32_bf16 v[200:203], a[216:219], a[168:171], v[200:203]
    buffer_load_dwordx4 a[156:159], v249, s[8:11], s29 offen offset:1024 sc1
    v_mfma_f32_16x16x32_bf16 v[204:207], a[216:219], a[172:175], v[204:207]
    s_add_u32 m0, s31, 5120
    s_add_u32 s24, s27, 163840
    v_mfma_f32_16x16x32_bf16 v[208:211], a[220:223], a[160:163], v[208:211]
    buffer_load_dwordx4 v245, s[12:15], s24 offen lds
    v_mfma_f32_16x16x32_bf16 v[212:215], a[220:223], a[164:167], v[212:215]
    v_mfma_f32_16x16x32_bf16 v[216:219], a[220:223], a[168:171], v[216:219]
    s_add_u32 s30, s30, 32768
    v_mfma_f32_16x16x32_bf16 v[220:223], a[220:223], a[172:175], v[220:223]
    s_cmp_ge_u32 s30, 163840
    s_cselect_b32 s30, 65536, s30
    s_waitcnt vmcnt(13) lgkmcnt(0)
    v_mfma_f32_16x16x32_bf16 v[96:99], a[192:195], a[176:179], v[96:99]
    ds_read_b64_tr_b16 a[208:209], v246 offset:25088
    v_mfma_f32_16x16x32_bf16 v[100:103], a[192:195], a[180:183], v[100:103]
    ds_read_b64_tr_b16 a[210:211], v246 offset:26112
    v_mfma_f32_16x16x32_bf16 v[104:107], a[192:195], a[184:187], v[104:107]
    ds_read_b64_tr_b16 a[212:213], v238 offset:25088
    v_mfma_f32_16x16x32_bf16 v[108:111], a[192:195], a[188:191], v[108:111]
    ds_read_b64_tr_b16 a[214:215], v238 offset:26112
    v_mfma_f32_16x16x32_bf16 v[112:115], a[196:199], a[176:179], v[112:115]
    ds_read_b64_tr_b16 a[216:217], v246 offset:25344
    v_mfma_f32_16x16x32_bf16 v[116:119], a[196:199], a[180:183], v[116:119]
    ds_read_b64_tr_b16 a[218:219], v246 offset:26368
    v_mfma_f32_16x16x32_bf16 v[120:123], a[196:199], a[184:187], v[120:123]
    ds_read_b64_tr_b16 a[220:221], v238 offset:25344
    v_mfma_f32_16x16x32_bf16 v[124:127], a[196:199], a[188:191], v[124:127]
    ds_read_b64_tr_b16 a[222:223], v238 offset:26368
    v_mfma_f32_16x16x32_bf16 v[128:131], a[200:203], a[176:179], v[128:131]
    buffer_load_dwordx4 a[160:163], v248, s[8:11], s28 offen offset:2048 sc1
    v_mfma_f32_16x16x32_bf16 v[132:135], a[200:203], a[180:183], v[132:135]
    v_mfma_f32_16x16x32_bf16 v[136:139], a[200:203], a[184:187], v[136:139]
    buffer_load_dwordx4 a[164:167], v248, s[8:11], s29 offen offset:2048 sc1
    v_mfma_f32_16x16x32_bf16 v[140:143], a[200:203], a[188:191], v[140:143]
    s_add_u32 m0, s31, 6144
    s_add_u32 s24, s27, 196608
    v_mfma_f32_16x16x32_bf16 v[144:147], a[204:207], a[176:179], v[144:147]
    buffer_load_dwordx4 v237, s[12:15], s24 offen lds
    v_mfma_f32_16x16x32_bf16 v[148:151], a[204:207], a[180:183], v[148:151]
    v_mfma_f32_16x16x32_bf16 v[152:155], a[204:207], a[184:187], v[152:155]
    s_cmp_eq_u32 s26, 1
    s_cbranch_scc0 ka_nopk
    s_waitcnt vmcnt(20)
    v_readfirstlane_b32 s24, v254
    s_lshl_b32 s25, s3, 16
    s_add_u32 s24, s24, s25
    s_cmp_ge_u32 s24, 8
    s_cbranch_scc0 kf_spin49
kf_spinr50:
ka_nopk:
    v_mfma_f32_16x16x32_bf16 v[156:159], a[204:207], a[188:191], v[156:159]
    s_waitcnt vmcnt(22) lgkmcnt(0)
    s_barrier
    v_add_u32 v246, s30, v247
    v_mfma_f32_16x16x32_bf16 v[160:163], a[208:211], a[176:179], v[160:163]
    v_xor_b32 v238, 32, v246
    ds_read_b64_tr_b16 a[192:193], v246 offset:0
    v_mfma_f32_16x16x32_bf16 v[164:167], a[208:211], a[180:183], v[164:167]
    ds_read_b64_tr_b16 a[194:195], v246 offset:1024
    v_mfma_f32_16x16x32_bf16 v[168:171], a[208:211], a[184:187], v[168:171]
    ds_read_b64_tr_b16 a[196:197], v238 offset:0
    v_mfma_f32_16x16x32_bf16 v[172:175], a[208:211], a[188:191], v[172:175]
    ds_read_b64_tr_b16 a[198:199], v238 offset:1024
    v_mfma_f32_16x16x32_bf16 v[176:179], a[212:215], a[176:179], v[176:179]
    ds_read_b64_tr_b16 a[200:201], v246 offset:256
    v_mfma_f32_16x16x32_bf16 v[180:183], a[212:215], a[180:183], v[180:183]
    ds_read_b64_tr_b16 a[202:203], v246 offset:1280
    v_mfma_f32_16x16x32_bf16 v[184:187], a[212:215], a[184:187], v[184:187]
    ds_read_b64_tr_b16 a[204:205], v238 offset:256
    buffer_atomic_add v255, v250, s[88:91], s97 offen sc1
    s_mov_b32 s97, s43
    v_mfma_f32_16x16x32_bf16 v[188:191], a[212:215], a[188:191], v[188:191]
    ds_read_b64_tr_b16 a[206:207], v238 offset:1280
    v_mfma_f32_16x16x32_bf16 v[192:195], a[216:219], a[176:179], v[192:195]
    buffer_load_dwordx4 a[168:171], v249, s[8:11], s28 offen offset:2048 sc1
    v_mfma_f32_16x16x32_bf16 v[196:199], a[216:219], a[180:183], v[196:199]
    v_mfma_f32_16x16x32_bf16 v[200:203], a[216:219], a[184:187], v[200:203]
    buffer_load_dwordx4 a[172:175], v249, s[8:11], s29 offen offset:2048 sc1
    v_mfma_f32_16x16x32_bf16 v[204:207], a[216:219], a[188:191], v[204:207]
    s_add_u32 m0, s31, 7168
    s_add_u32 s24, s27, 229376
    v_mfma_f32_16x16x32_bf16 v[208:211], a[220:223], a[176:179], v[208:211]
    buffer_load_dwordx4 v237, s[12:15], s24 offen lds
    v_mfma_f32_16x16x32_bf16 v[212:215], a[220:223], a[180:183], v[212:215]
    s_add_u32 s27, s27, 1048576
    s_and_b32 s27, s27, 0x407fffff
    v_mfma_f32_16x16x32_bf16 v[216:219], a[220:223], a[184:187], v[216:219]
    s_cmp_eq_u32 s27, s7
    s_cselect_b32 s27, s43, s27
    v_mfma_f32_16x16x32_bf16 v[220:223], a[220:223], a[188:191], v[220:223]
    s_add_u32 s31, s31, 32768
    s_cmp_ge_u32 s31, 163840
    s_cselect_b32 s24, 98304, 0
    s_sub_u32 s31, s31, s24
    s_sub_u32 s26, s26, 1
    s_cmp_lg_u32 s26, 0
    s_cbranch_scc1 ka_qp
    s_waitcnt vmcnt(14) lgkmcnt(0)
    v_mfma_f32_16x16x32_bf16 v[96:99], a[192:195], a[128:131], v[96:99]
    ds_read_b64_tr_b16 a[208:209], v246 offset:512
    s_sub_u32 s42, s32, 17664
    v_mfma_f32_16x16x32_bf16 v[100:103], a[192:195], a[132:135], v[100:103]
    ds_read_b64_tr_b16 a[210:211], v246 offset:1536
    v_mfma_f32_16x16x32_bf16 v[104:107], a[192:195], a[136:139], v[104:107]
    ds_read_b64_tr_b16 a[212:213], v238 offset:512
    s_mov_b32 m0, s34
    s_add_u32 s41, s42, 17664
    v_mfma_f32_16x16x32_bf16 v[108:111], a[192:195], a[140:143], v[108:111]
    ds_read_b64_tr_b16 a[214:215], v238 offset:1536
    v_mfma_f32_16x16x32_bf16 v[112:115], a[196:199], a[128:131], v[112:115]
    ds_read_b64_tr_b16 a[216:217], v246 offset:768
    v_mfma_f32_16x16x32_bf16 v[116:119], a[196:199], a[132:135], v[116:119]
    ds_read_b64_tr_b16 a[218:219], v246 offset:1792
    buffer_load_dwordx4 v242, s[16:19], s41 offen offset:0 sc1 lds
    v_mfma_f32_16x16x32_bf16 v[120:123], a[196:199], a[136:139], v[120:123]
    ds_read_b64_tr_b16 a[220:221], v238 offset:768
    v_mfma_f32_16x16x32_bf16 v[124:127], a[196:199], a[140:143], v[124:127]
    ds_read_b64_tr_b16 a[222:223], v238 offset:1792
    v_mfma_f32_16x16x32_bf16 v[128:131], a[200:203], a[128:131], v[128:131]
    buffer_load_dwordx4 a[176:179], v248, s[8:11], s28 offen offset:3072 sc1
    buffer_load_dwordx4 v242, s[16:19], s41 offen offset:1024 sc1 lds
    v_mfma_f32_16x16x32_bf16 v[132:135], a[200:203], a[132:135], v[132:135]
    v_mfma_f32_16x16x32_bf16 v[136:139], a[200:203], a[136:139], v[136:139]
    buffer_load_dwordx4 a[180:183], v248, s[8:11], s29 offen offset:3072 sc1
    v_mfma_f32_16x16x32_bf16 v[140:143], a[200:203], a[140:143], v[140:143]
    buffer_load_dwordx4 v242, s[16:19], s41 offen offset:2048 sc1 lds
    v_mfma_f32_16x16x32_bf16 v[144:147], a[204:207], a[128:131], v[144:147]
    v_mfma_f32_16x16x32_bf16 v[148:151], a[204:207], a[132:135], v[148:151]
    v_mfma_f32_16x16x32_bf16 v[152:155], a[204:207], a[136:139], v[152:155]
    buffer_load_dwordx4 v242, s[16:19], s41 offen offset:3072 sc1 lds
    v_mfma_f32_16x16x32_bf16 v[156:159], a[204:207], a[140:143], v[156:159]
    s_waitcnt lgkmcnt(0)
    v_mfma_f32_16x16x32_bf16 v[160:163], a[208:211], a[128:131], v[160:163]
    ds_read_b64_tr_b16 a[192:193], v246 offset:8192
    v_mfma_f32_16x16x32_bf16 v[164:167], a[208:211], a[132:135], v[164:167]
    ds_read_b64_tr_b16 a[194:195], v246 offset:9216
    v_mfma_f32_16x16x32_bf16 v[168:171], a[208:211], a[136:139], v[168:171]
    ds_read_b64_tr_b16 a[196:197], v238 offset:8192
    s_add_u32 s34, s34, 32768
    s_cmp_ge_u32 s34, 163840
    s_cselect_b32 s34, s37, s34
    s_add_u32 s42, s42, 34048
    v_mfma_f32_16x16x32_bf16 v[172:175], a[208:211], a[140:143], v[172:175]
    ds_read_b64_tr_b16 a[198:199], v238 offset:9216
    v_mfma_f32_16x16x32_bf16 v[176:179], a[212:215], a[128:131], v[176:179]
    ds_read_b64_tr_b16 a[200:201], v246 offset:8448
    v_mfma_f32_16x16x32_bf16 v[180:183], a[212:215], a[132:135], v[180:183]
    ds_read_b64_tr_b16 a[202:203], v246 offset:9472
    s_mov_b32 m0, s34
    s_add_u32 s41, s42, 17664
    v_mfma_f32_16x16x32_bf16 v[184:187], a[212:215], a[136:139], v[184:187]
    ds_read_b64_tr_b16 a[204:205], v238 offset:8448
    v_mfma_f32_16x16x32_bf16 v[188:191], a[212:215], a[140:143], v[188:191]
    ds_read_b64_tr_b16 a[206:207], v238 offset:9472
    v_mfma_f32_16x16x32_bf16 v[192:195], a[216:219], a[128:131], v[192:195]
    buffer_load_dwordx4 a[184:187], v249, s[8:11], s28 offen offset:3072 sc1
    buffer_load_dwordx4 v242, s[16:19], s41 offen offset:0 sc1 lds
    v_mfma_f32_16x16x32_bf16 v[196:199], a[216:219], a[132:135], v[196:199]
    v_mfma_f32_16x16x32_bf16 v[200:203], a[216:219], a[136:139], v[200:203]
    buffer_load_dwordx4 a[188:191], v249, s[8:11], s29 offen offset:3072 sc1
    v_mfma_f32_16x16x32_bf16 v[204:207], a[216:219], a[140:143], v[204:207]
    buffer_load_dwordx4 v242, s[16:19], s41 offen offset:1024 sc1 lds
    v_mfma_f32_16x16x32_bf16 v[208:211], a[220:223], a[128:131], v[208:211]
    v_mfma_f32_16x16x32_bf16 v[212:215], a[220:223], a[132:135], v[212:215]
    v_mfma_f32_16x16x32_bf16 v[216:219], a[220:223], a[136:139], v[216:219]
    s_add_u32 s28, s28, 4096
    s_and_b32 s28, s28, 32767
    v_mfma_f32_16x16x32_bf16 v[220:223], a[220:223], a[140:143], v[220:223]
    s_add_u32 s29, s28, 32768
    buffer_load_dwordx4 v242, s[16:19], s41 offen offset:2048 sc1 lds
    s_waitcnt vmcnt(19) lgkmcnt(0)
    v_mfma_f32_16x16x32_bf16 v[96:99], a[192:195], a[144:147], v[96:99]
    ds_read_b64_tr_b16 a[208:209], v246 offset:8704
    v_mfma_f32_16x16x32_bf16 v[100:103], a[192:195], a[148:151], v[100:103]
    ds_read_b64_tr_b16 a[210:211], v246 offset:9728
    v_mfma_f32_16x16x32_bf16 v[104:107], a[192:195], a[152:155], v[104:107]
    ds_read_b64_tr_b16 a[212:213], v238 offset:8704
    buffer_load_dwordx4 v242, s[16:19], s41 offen offset:3072 sc1 lds
    v_mfma_f32_16x16x32_bf16 v[108:111], a[192:195], a[156:159], v[108:111]
    ds_read_b64_tr_b16 a[214:215], v238 offset:9728
    v_mfma_f32_16x16x32_bf16 v[112:115], a[196:199], a[144:147], v[112:115]
    ds_read_b64_tr_b16 a[216:217], v246 offset:8960
    v_mfma_f32_16x16x32_bf16 v[116:119], a[196:199], a[148:151], v[116:119]
    ds_read_b64_tr_b16 a[218:219], v246 offset:9984
    s_add_u32 m0, s34, 16384
    s_add_u32 s34, s34, 32768
    s_cmp_ge_u32 s34, 163840
    s_cselect_b32 s34, s37, s34
    v_mfma_f32_16x16x32_bf16 v[120:123], a[196:199], a[152:155], v[120:123]
    ds_read_b64_tr_b16 a[220:221], v238 offset:8960
    v_mfma_f32_16x16x32_bf16 v[124:127], a[196:199], a[156:159], v[124:127]
    ds_read_b64_tr_b16 a[222:223], v238 offset:9984
    v_mfma_f32_16x16x32_bf16 v[128:131], a[200:203], a[144:147], v[128:131]
    buffer_load_dwordx4 v242, s[16:19], s42 offen offset:0 sc1 lds
    v_mov_b32 v241, v239
    v_mfma_f32_16x16x32_bf16 v[132:135], a[200:203], a[148:151], v[132:135]
    v_lshrrev_b32 v230, 7, v240
    v_mfma_f32_16x16x32_bf16 v[136:139], a[200:203], a[152:155], v[136:139]
    v_mul_u32_u24 v253, 7168, v230
    v_mfma_f32_16x16x32_bf16 v[140:143], a[200:203], a[156:159], v[140:143]
    v_and_b32 v231, 0x70, v240
    v_mfma_f32_16x16x32_bf16 v[144:147], a[204:207], a[144:147], v[144:147]
    buffer_load_dwordx4 v242, s[16:19], s42 offen offset:1024 sc1 lds
    v_mfma_f32_16x16x32_bf16 v[148:151], a[204:207], a[148:151], v[148:151]
    v_add_u32 v253, v253, v231
    v_mfma_f32_16x16x32_bf16 v[152:155], a[204:207], a[152:155], v[152:155]
    v_lshlrev_b32 v255, 5, v230
    v_mfma_f32_16x16x32_bf16 v[156:159], a[204:207], a[156:159], v[156:159]
    buffer_load_dwordx4 v242, s[16:19], s42 offen offset:2048 sc1 lds
    s_waitcnt lgkmcnt(0)
    v_mfma_f32_16x16x32_bf16 v[160:163], a[208:211], a[144:147], v[160:163]
    ds_read_b64_tr_b16 a[192:193], v246 offset:16384
    v_and_b32 v230, 16, v240
    v_mfma_f32_16x16x32_bf16 v[164:167], a[208:211], a[148:151], v[164:167]
    ds_read_b64_tr_b16 a[194:195], v246 offset:17408
    v_mfma_f32_16x16x32_bf16 v[168:171], a[208:211], a[152:155], v[168:171]
    ds_read_b64_tr_b16 a[196:197], v238 offset:16384
    buffer_load_dwordx4 v242, s[16:19], s42 offen offset:3072 sc1 lds
    s_add_u32 s42, s42, 34048
    v_mfma_f32_16x16x32_bf16 v[172:175], a[208:211], a[156:159], v[172:175]
    ds_read_b64_tr_b16 a[198:199], v238 offset:17408
    v_add_u32 v255, v255, v230
    v_mfma_f32_16x16x32_bf16 v[176:179], a[212:215], a[144:147], v[176:179]
    ds_read_b64_tr_b16 a[200:201], v246 offset:16640
    v_mfma_f32_16x16x32_bf16 v[180:183], a[212:215], a[148:151], v[180:183]
    ds_read_b64_tr_b16 a[202:203], v246 offset:17664
    s_mov_b32 m0, s34
    s_add_u32 s41, s42, 17664
    v_mfma_f32_16x16x32_bf16 v[184:187], a[212:215], a[152:155], v[184:187]
    ds_read_b64_tr_b16 a[204:205], v238 offset:16640
    v_lshrrev_b32 v231, 5, v231
    v_mfma_f32_16x16x32_bf16 v[188:191], a[212:215], a[156:159], v[188:191]
    ds_read_b64_tr_b16 a[206:207], v238 offset:17664
    v_mfma_f32_16x16x32_bf16 v[192:195], a[216:219], a[144:147], v[192:195]
    buffer_load_dwordx4 v242, s[16:19], s41 offen offset:0 sc1 lds
    v_lshl_add_u32 v255, v231, 16, v255
    v_mfma_f32_16x16x32_bf16 v[196:199], a[216:219], a[148:151], v[196:199]
    v_mov_b32 v64, 0
    v_mfma_f32_16x16x32_bf16 v[200:203], a[216:219], a[152:155], v[200:203]
    v_mov_b32 v65, 0
    v_mfma_f32_16x16x32_bf16 v[204:207], a[216:219], a[156:159], v[204:207]
    v_mov_b32 v66, 0
    v_mfma_f32_16x16x32_bf16 v[208:211], a[220:223], a[144:147], v[208:211]
    buffer_load_dwordx4 v242, s[16:19], s41 offen offset:1024 sc1 lds
    v_mfma_f32_16x16x32_bf16 v[212:215], a[220:223], a[148:151], v[212:215]
    v_mov_b32 v67, 0
    v_mfma_f32_16x16x32_bf16 v[216:219], a[220:223], a[152:155], v[216:219]
    v_mov_b32 v68, 0
    v_mfma_f32_16x16x32_bf16 v[220:223], a[220:223], a[156:159], v[220:223]
    buffer_load_dwordx4 v242, s[16:19], s41 offen offset:2048 sc1 lds
    s_waitcnt vmcnt(20) lgkmcnt(0)
    v_mfma_f32_16x16x32_bf16 v[96:99], a[192:195], a[160:163], v[96:99]
    ds_read_b64_tr_b16 a[208:209], v246 offset:16896
    v_mov_b32 v69, 0
    v_mfma_f32_16x16x32_bf16 v[100:103], a[192:195], a[164:167], v[100:103]
    ds_read_b64_tr_b16 a[210:211], v246 offset:17920
    v_mfma_f32_16x16x32_bf16 v[104:107], a[192:195], a[168:171], v[104:107]
    ds_read_b64_tr_b16 a[212:213], v238 offset:16896
    buffer_load_dwordx4 v242, s[16:19], s41 offen offset:3072 sc1 lds
    v_mfma_f32_16x16x32_bf16 v[108:111], a[192:195], a[172:175], v[108:111]
    ds_read_b64_tr_b16 a[214:215], v238 offset:17920
    v_mov_b32 v70, 0
    v_mfma_f32_16x16x32_bf16 v[112:115], a[196:199], a[160:163], v[112:115]
    ds_read_b64_tr_b16 a[216:217], v246 offset:17152
    v_mfma_f32_16x16x32_bf16 v[116:119], a[196:199], a[164:167], v[116:119]
    ds_read_b64_tr_b16 a[218:219], v246 offset:18176
    s_add_u32 m0, s34, 16384
    s_add_u32 s34, s34, 32768
    s_cmp_ge_u32 s34, 163840
    s_cselect_b32 s34, s37, s34
    v_mfma_f32_16x16x32_bf16 v[120:123], a[196:199], a[168:171], v[120:123]
    ds_read_b64_tr_b16 a[220:221], v238 offset:17152
    v_mov_b32 v71, 0
    v_mfma_f32_16x16x32_bf16 v[124:127], a[196:199], a[172:175], v[124:127]
    ds_read_b64_tr_b16 a[222:223], v238 offset:18176
    v_mfma_f32_16x16x32_bf16 v[128:131], a[200:203], a[160:163], v[128:131]
    v_mov_b32 v72, 0
    v_mfma_f32_16x16x32_bf16 v[132:135], a[200:203], a[164:167], v[132:135]
    buffer_load_dwordx4 v242, s[16:19], s42 offen offset:0 sc1 lds
    v_mov_b32 v73, 0
    v_mfma_f32_16x16x32_bf16 v[136:139], a[200:203], a[168:171], v[136:139]
    v_mov_b32 v74, 0
    v_mfma_f32_16x16x32_bf16 v[140:143], a[200:203], a[172:175], v[140:143]
    v_mov_b32 v75, 0
    v_mfma_f32_16x16x32_bf16 v[144:147], a[204:207], a[160:163], v[144:147]
    buffer_load_dwordx4 v242, s[16:19], s42 offen offset:1024 sc1 lds
    v_mfma_f32_16x16x32_bf16 v[148:151], a[204:207], a[164:167], v[148:151]
    v_mov_b32 v76, 0
    v_mfma_f32_16x16x32_bf16 v[152:155], a[204:207], a[168:171], v[152:155]
    v_mov_b32 v77, 0
    v_mfma_f32_16x16x32_bf16 v[156:159], a[204:207], a[172:175], v[156:159]
    buffer_load_dwordx4 v242, s[16:19], s42 offen offset:2048 sc1 lds
    s_waitcnt lgkmcnt(0)
    v_mfma_f32_16x16x32_bf16 v[160:163], a[208:211], a[160:163], v[160:163]
    ds_read_b64_tr_b16 a[192:193], v246 offset:24576
    v_mov_b32 v78, 0
    v_mfma_f32_16x16x32_bf16 v[164:167], a[208:211], a[164:167], v[164:167]
    ds_read_b64_tr_b16 a[194:195], v246 offset:25600
    v_mfma_f32_16x16x32_bf16 v[168:171], a[208:211], a[168:171], v[168:171]
    ds_read_b64_tr_b16 a[196:197], v238 offset:24576
    buffer_load_dwordx4 v242, s[16:19], s42 offen offset:3072 sc1 lds
    s_add_u32 s42, s42, 34048
    v_mfma_f32_16x16x32_bf16 v[172:175], a[208:211], a[172:175], v[172:175]
    ds_read_b64_tr_b16 a[198:199], v238 offset:25600
    v_mov_b32 v79, 0
    v_mfma_f32_16x16x32_bf16 v[176:179], a[212:215], a[160:163], v[176:179]
    ds_read_b64_tr_b16 a[200:201], v246 offset:24832
    v_mfma_f32_16x16x32_bf16 v[180:183], a[212:215], a[164:167], v[180:183]
    ds_read_b64_tr_b16 a[202:203], v246 offset:25856
    v_mov_b32 v228, 0
    v_mfma_f32_16x16x32_bf16 v[184:187], a[212:215], a[168:171], v[184:187]
    ds_read_b64_tr_b16 a[204:205], v238 offset:24832
    v_mfma_f32_16x16x32_bf16 v[188:191], a[212:215], a[172:175], v[188:191]
    ds_read_b64_tr_b16 a[206:207], v238 offset:25856
    v_mov_b32 v226, 0
    v_mfma_f32_16x16x32_bf16 v[192:195], a[216:219], a[160:163], v[192:195]
    v_mov_b32 v80, 0
    v_mfma_f32_16x16x32_bf16 v[196:199], a[216:219], a[164:167], v[196:199]
    v_mov_b32 v81, 0
    v_mfma_f32_16x16x32_bf16 v[200:203], a[216:219], a[168:171], v[200:203]
    v_mov_b32 v82, 0
    v_mfma_f32_16x16x32_bf16 v[204:207], a[216:219], a[172:175], v[204:207]
    v_mov_b32 v83, 0
    v_mfma_f32_16x16x32_bf16 v[208:211], a[220:223], a[160:163], v[208:211]
    v_mov_b32 v84, 0
    v_mfma_f32_16x16x32_bf16 v[212:215], a[220:223], a[164:167], v[212:215]
    v_mov_b32 v85, 0
    v_mfma_f32_16x16x32_bf16 v[216:219], a[220:223], a[168:171], v[216:219]
    v_mov_b32 v86, 0
    v_mfma_f32_16x16x32_bf16 v[220:223], a[220:223], a[172:175], v[220:223]
    s_waitcnt vmcnt(15) lgkmcnt(0)
    v_mfma_f32_16x16x32_bf16 v[96:99], a[192:195], a[176:179], v[96:99]
    ds_read_b64_tr_b16 a[208:209], v246 offset:25088
    v_mov_b32 v87, 0
    v_mfma_f32_16x16x32_bf16 v[100:103], a[192:195], a[180:183], v[100:103]
    ds_read_b64_tr_b16 a[210:211], v246 offset:26112
    v_mfma_f32_16x16x32_bf16 v[104:107], a[192:195], a[184:187], v[104:107]
    ds_read_b64_tr_b16 a[212:213], v238 offset:25088
    v_mov_b32 v88, 0
    v_mfma_f32_16x16x32_bf16 v[108:111], a[192:195], a[188:191], v[108:111]
    ds_read_b64_tr_b16 a[214:215], v238 offset:26112
    v_mfma_f32_16x16x32_bf16 v[112:115], a[196:199], a[176:179], v[112:115]
    ds_read_b64_tr_b16 a[216:217], v246 offset:25344
    v_mov_b32 v89, 0
    v_mfma_f32_16x16x32_bf16 v[116:119], a[196:199], a[180:183], v[116:119]
    ds_read_b64_tr_b16 a[218:219], v246 offset:26368
    v_mfma_f32_16x16x32_bf16 v[120:123], a[196:199], a[184:187], v[120:123]
    ds_read_b64_tr_b16 a[220:221], v238 offset:25344
    v_mov_b32 v90, 0
    v_mfma_f32_16x16x32_bf16 v[124:127], a[196:199], a[188:191], v[124:127]
    ds_read_b64_tr_b16 a[222:223], v238 offset:26368
    v_mfma_f32_16x16x32_bf16 v[128:131], a[200:203], a[176:179], v[128:131]
    v_mov_b32 v91, 0
    v_mfma_f32_16x16x32_bf16 v[132:135], a[200:203], a[180:183], v[132:135]
    v_mov_b32 v92, 0
    v_mfma_f32_16x16x32_bf16 v[136:139], a[200:203], a[184:187], v[136:139]
    v_mov_b32 v93, 0
    v_mfma_f32_16x16x32_bf16 v[140:143], a[200:203], a[188:191], v[140:143]
    v_mov_b32 v94, 0
    v_mfma_f32_16x16x32_bf16 v[144:147], a[204:207], a[176:179], v[144:147]
    v_mov_b32 v95, 0
    v_mfma_f32_16x16x32_bf16 v[148:151], a[204:207], a[180:183], v[148:151]
    v_mov_b32 v229, 0
    v_mfma_f32_16x16x32_bf16 v[152:155], a[204:207], a[184:187], v[152:155]
    v_mov_b32 v227, 0
    v_mfma_f32_16x16x32_bf16 v[156:159], a[204:207], a[188:191], v[156:159]
    s_waitcnt vmcnt(8) lgkmcnt(0)
    s_barrier
    v_mfma_f32_16x16x32_bf16 v[160:163], a[208:211], a[176:179], v[160:163]
    ds_read_b128 a[192:195], v241 offset:0
    s_mov_b32 m0, s34
    s_add_u32 s41, s42, 17664
    v_mfma_f32_16x16x32_bf16 v[164:167], a[208:211], a[180:183], v[164:167]
    ds_read_b128 a[196:199], v241 offset:512
    buffer_load_dwordx4 v242, s[16:19], s41 offen offset:0 sc1 lds
    v_mfma_f32_16x16x32_bf16 v[168:171], a[208:211], a[184:187], v[168:171]
    ds_read_b128 a[200:203], v241 offset:2048
    v_mfma_f32_16x16x32_bf16 v[172:175], a[208:211], a[188:191], v[172:175]
    ds_read_b128 a[204:207], v241 offset:2560
    buffer_load_dwordx4 v242, s[16:19], s41 offen offset:1024 sc1 lds
    v_mfma_f32_16x16x32_bf16 v[176:179], a[212:215], a[176:179], v[176:179]
    ds_read_b128 a[224:227], v241 offset:8192
    buffer_load_dwordx4 v242, s[16:19], s41 offen offset:2048 sc1 lds
    v_mfma_f32_16x16x32_bf16 v[180:183], a[212:215], a[180:183], v[180:183]
    ds_read_b128 a[228:231], v241 offset:8704
    v_mfma_f32_16x16x32_bf16 v[184:187], a[212:215], a[184:187], v[184:187]
    ds_read_b128 a[232:235], v241 offset:10240
    buffer_load_dwordx4 v242, s[16:19], s41 offen offset:3072 sc1 lds
    v_mfma_f32_16x16x32_bf16 v[188:191], a[212:215], a[188:191], v[188:191]
    ds_read_b128 a[236:239], v241 offset:10752
    v_mfma_f32_16x16x32_bf16 v[192:195], a[216:219], a[176:179], v[192:195]
    ds_read_b128 a[240:243], v241 offset:12288
    s_add_u32 m0, s34, 16384
    s_add_u32 s34, s34, 32768
    s_cmp_ge_u32 s34, 163840
    s_cselect_b32 s34, s37, s34
    v_mfma_f32_16x16x32_bf16 v[196:199], a[216:219], a[180:183], v[196:199]
    ds_read_b128 a[244:247], v241 offset:12800
    buffer_load_dwordx4 v242, s[16:19], s42 offen offset:0 sc1 lds
    v_mfma_f32_16x16x32_bf16 v[200:203], a[216:219], a[184:187], v[200:203]
    ds_read_b128 a[248:251], v241 offset:14336
    v_mfma_f32_16x16x32_bf16 v[204:207], a[216:219], a[188:191], v[204:207]
    ds_read_b128 a[252:255], v241 offset:14848
    buffer_load_dwordx4 v242, s[16:19], s42 offen offset:1024 sc1 lds
    v_mfma_f32_16x16x32_bf16 v[208:211], a[220:223], a[176:179], v[208:211]
    buffer_load_dwordx4 v242, s[16:19], s42 offen offset:2048 sc1 lds
    v_mfma_f32_16x16x32_bf16 v[212:215], a[220:223], a[180:183], v[212:215]
    v_mfma_f32_16x16x32_bf16 v[216:219], a[220:223], a[184:187], v[216:219]
    buffer_load_dwordx4 v242, s[16:19], s42 offen offset:3072 sc1 lds
    s_add_u32 s42, s42, 34048
    v_mfma_f32_16x16x32_bf16 v[220:223], a[220:223], a[188:191], v[220:223]
    s_mov_b32 s25, 0x3e0293ee
    s_waitcnt lgkmcnt(8)
    ds_read_b128 a[208:211], v241 offset:4096
    ds_read_b128 a[212:215], v241 offset:4608
    ds_read_b128 a[216:219], v241 offset:6144
    ds_read_b128 a[220:223], v241 offset:6656
    s_sub_u32 s36, s36, 1
    s_cbranch_scc1 kf_fix1
kf_fixr2:
    v_mul_f32 v96, s25, v96
    v_mul_f32 v97, s25, v97
    v_mul_f32 v98, s25, v98
    v_mul_f32 v99, s25, v99
    v_mul_f32 v100, s25, v100
    v_mul_f32 v101, s25, v101
    v_mul_f32 v102, s25, v102
    v_mul_f32 v103, s25, v103
    v_mul_f32 v104, s25, v104
    v_mul_f32 v105, s25, v105
    v_mul_f32 v106, s25, v106
    v_mul_f32 v107, s25, v107
    v_mul_f32 v108, s25, v108
    v_mul_f32 v109, s25, v109
    v_mul_f32 v110, s25, v110
    v_mul_f32 v111, s25, v111
    v_cvt_pk_bf16_f32 v96, v96, v97
    v_cvt_pk_bf16_f32 v97, v98, v99
    v_cvt_pk_bf16_f32 v100, v100, v101
    v_cvt_pk_bf16_f32 v101, v102, v103
    v_cvt_pk_bf16_f32 v104, v104, v105
    v_cvt_pk_bf16_f32 v105, v106, v107
    v_cvt_pk_bf16_f32 v108, v108, v109
    v_cvt_pk_bf16_f32 v109, v110, v111
    v_permlane16_swap_b32 v96, v100
    v_permlane16_swap_b32 v97, v101
    v_permlane16_swap_b32 v104, v108
    v_permlane16_swap_b32 v105, v109
    v_accvgpr_write_b32 a128, v96
    v_accvgpr_write_b32 a129, v97
    v_accvgpr_write_b32 a130, v100
    v_accvgpr_write_b32 a131, v101
    v_accvgpr_write_b32 a160, v104
    v_accvgpr_write_b32 a161, v105
    v_accvgpr_write_b32 a162, v108
    v_accvgpr_write_b32 a163, v109
    v_mul_f32 v112, s25, v112
    v_mul_f32 v113, s25, v113
    v_mul_f32 v114, s25, v114
    v_mul_f32 v115, s25, v115
    v_mul_f32 v116, s25, v116
    v_mul_f32 v117, s25, v117
    v_mul_f32 v118, s25, v118
    v_mul_f32 v119, s25, v119
    v_mul_f32 v120, s25, v120
    v_mul_f32 v121, s25, v121
    v_mul_f32 v122, s25, v122
    v_mul_f32 v123, s25, v123
    v_mul_f32 v124, s25, v124
    v_mul_f32 v125, s25, v125
    v_mul_f32 v126, s25, v126
    v_mul_f32 v127, s25, v127
    v_cvt_pk_bf16_f32 v112, v112, v113
    v_cvt_pk_bf16_f32 v113, v114, v115
    v_cvt_pk_bf16_f32 v116, v116, v117
    v_cvt_pk_bf16_f32 v117, v118, v119
    v_cvt_pk_bf16_f32 v120, v120, v121
    v_cvt_pk_bf16_f32 v121, v122, v123
    v_cvt_pk_bf16_f32 v124, v124, v125
    v_cvt_pk_bf16_f32 v125, v126, v127
    v_permlane16_swap_b32 v112, v116
    v_permlane16_swap_b32 v113, v117
    v_permlane16_swap_b32 v120, v124
    v_permlane16_swap_b32 v121, v125
    v_accvgpr_write_b32 a132, v112
    v_accvgpr_write_b32 a133, v113
    v_accvgpr_write_b32 a134, v116
    v_accvgpr_write_b32 a135, v117
    v_accvgpr_write_b32 a164, v120
    v_accvgpr_write_b32 a165, v121
    v_accvgpr_write_b32 a166, v124
    v_accvgpr_write_b32 a167, v125
    s_nop 1
    v_mfma_f32_32x32x16_bf16 v[0:15], a[192:195], a[128:131], v[64:79]
    v_mul_f32 v128, s25, v128
    v_mul_f32 v129, s25, v129
    v_mul_f32 v130, s25, v130
    v_mul_f32 v131, s25, v131
    v_mul_f32 v132, s25, v132
    v_mul_f32 v133, s25, v133
    v_mfma_f32_32x32x16_bf16 v[16:31], a[192:195], a[160:163], v[80:95]
    v_mul_f32 v134, s25, v134
    v_mul_f32 v135, s25, v135
    v_mul_f32 v136, s25, v136
    v_mul_f32 v137, s25, v137
    v_mul_f32 v138, s25, v138
    v_mul_f32 v139, s25, v139
    v_mfma_f32_32x32x16_bf16 v[0:15], a[196:199], a[132:135], v[0:15]
    v_mul_f32 v140, s25, v140
    v_mul_f32 v141, s25, v141
    v_mul_f32 v142, s25, v142
    v_mul_f32 v143, s25, v143
    v_cvt_pk_bf16_f32 v128, v128, v129
    v_cvt_pk_bf16_f32 v129, v130, v131
    v_mfma_f32_32x32x16_bf16 v[16:31], a[196:199], a[164:167], v[16:31]
    v_cvt_pk_bf16_f32 v132, v132, v133
    v_cvt_pk_bf16_f32 v133, v134, v135
    v_cvt_pk_bf16_f32 v136, v136, v137
    v_cvt_pk_bf16_f32 v137, v138, v139
    v_cvt_pk_bf16_f32 v140, v140, v141
    v_cvt_pk_bf16_f32 v141, v142, v143
    v_permlane16_swap_b32 v128, v132
    v_permlane16_swap_b32 v129, v133
    v_permlane16_swap_b32 v136, v140
    v_permlane16_swap_b32 v137, v141
    v_accvgpr_write_b32 a136, v128
    v_accvgpr_write_b32 a137, v129
    v_accvgpr_write_b32 a138, v132
    v_accvgpr_write_b32 a139, v133
    v_accvgpr_write_b32 a168, v136
    v_accvgpr_write_b32 a169, v137
    v_accvgpr_write_b32 a170, v140
    v_accvgpr_write_b32 a171, v141
    v_mul_f32 v144, s25, v144
    v_mul_f32 v145, s25, v145
    v_mul_f32 v146, s25, v146
    v_mul_f32 v147, s25, v147
    v_mul_f32 v148, s25, v148
    v_mul_f32 v149, s25, v149
    v_mul_f32 v150, s25, v150
    v_mul_f32 v151, s25, v151
    v_mul_f32 v152, s25, v152
    v_mul_f32 v153, s25, v153
    v_mul_f32 v154, s25, v154
    v_mul_f32 v155, s25, v155
    v_mul_f32 v156, s25, v156
    v_mul_f32 v157, s25, v157
    v_mul_f32 v158, s25, v158
    v_mul_f32 v159, s25, v159
    v_cvt_pk_bf16_f32 v144, v144, v145
    v_cvt_pk_bf16_f32 v145, v146, v147
    v_cvt_pk_bf16_f32 v148, v148, v149
    v_cvt_pk_bf16_f32 v149, v150, v151
    v_cvt_pk_bf16_f32 v152, v152, v153
    v_cvt_pk_bf16_f32 v153, v154, v155
    v_cvt_pk_bf16_f32 v156, v156, v157
    v_cvt_pk_bf16_f32 v157, v158, v159
    v_permlane16_swap_b32 v144, v148
    v_permlane16_swap_b32 v145, v149
    v_permlane16_swap_b32 v152, v156
    v_permlane16_swap_b32 v153, v157
    v_accvgpr_write_b32 a140, v144
    v_accvgpr_write_b32 a141, v145
    v_accvgpr_write_b32 a142, v148
    v_accvgpr_write_b32 a143, v149
    v_accvgpr_write_b32 a172, v152
    v_accvgpr_write_b32 a173, v153
    v_accvgpr_write_b32 a174, v156
    v_accvgpr_write_b32 a175, v157
    s_nop 1
    v_mfma_f32_32x32x16_bf16 v[0:15], a[200:203], a[136:139], v[0:15]
    v_mul_f32 v160, s25, v160
    v_mul_f32 v161, s25, v161
    v_mul_f32 v162, s25, v162
    v_mul_f32 v163, s25, v163
    v_mul_f32 v164, s25, v164
    v_mul_f32 v165, s25, v165
    v_mfma_f32_32x32x16_bf16 v[16:31], a[200:203], a[168:171], v[16:31]
    v_mul_f32 v166, s25, v166
    v_mul_f32 v167, s25, v167
    v_mul_f32 v168, s25, v168
    v_mul_f32 v169, s25, v169
    v_mul_f32 v170, s25, v170
    v_mul_f32 v171, s25, v171
    v_mfma_f32_32x32x16_bf16 v[0:15], a[204:207], a[140:143], v[0:15]
    v_mul_f32 v172, s25, v172
    v_mul_f32 v173, s25, v173
    v_mul_f32 v174, s25, v174
    v_mul_f32 v175, s25, v175
    v_cvt_pk_bf16_f32 v160, v160, v161
    v_cvt_pk_bf16_f32 v161, v162, v163
    v_mfma_f32_32x32x16_bf16 v[16:31], a[204:207], a[172:175], v[16:31]
    v_cvt_pk_bf16_f32 v164, v164, v165
    v_cvt_pk_bf16_f32 v165, v166, v167
    v_cvt_pk_bf16_f32 v168, v168, v169
    v_cvt_pk_bf16_f32 v169, v170, v171
    v_cvt_pk_bf16_f32 v172, v172, v173
    v_cvt_pk_bf16_f32 v173, v174, v175
    v_permlane16_swap_b32 v160, v164
    v_permlane16_swap_b32 v161, v165
    v_permlane16_swap_b32 v168, v172
    v_permlane16_swap_b32 v169, v173
    v_accvgpr_write_b32 a144, v160
    v_accvgpr_write_b32 a145, v161
    v_accvgpr_write_b32 a146, v164
    v_accvgpr_write_b32 a147, v165
    v_accvgpr_write_b32 a176, v168
    v_accvgpr_write_b32 a177, v169
    v_accvgpr_write_b32 a178, v172
    v_accvgpr_write_b32 a179, v173
    v_mul_f32 v176, s25, v176
    v_mul_f32 v177, s25, v177
    v_mul_f32 v178, s25, v178
    v_mul_f32 v179, s25, v179
    v_mul_f32 v180, s25, v180
    v_mul_f32 v181, s25, v181
    v_mul_f32 v182, s25, v182
    v_mul_f32 v183, s25, v183
    v_mul_f32 v184, s25, v184
    v_mul_f32 v185, s25, v185
    v_mul_f32 v186, s25, v186
    v_mul_f32 v187, s25, v187
    v_mul_f32 v188, s25, v188
    v_mul_f32 v189, s25, v189
    v_mul_f32 v190, s25, v190
    v_mul_f32 v191, s25, v191
    v_cvt_pk_bf16_f32 v176, v176, v177
    v_cvt_pk_bf16_f32 v177, v178, v179
    v_cvt_pk_bf16_f32 v180, v180, v181
    v_cvt_pk_bf16_f32 v181, v182, v183
    v_cvt_pk_bf16_f32 v184, v184, v185
    v_cvt_pk_bf16_f32 v185, v186, v187
    v_cvt_pk_bf16_f32 v188, v188, v189
    v_cvt_pk_bf16_f32 v189, v190, v191
    v_permlane16_swap_b32 v176, v180
    v_permlane16_swap_b32 v177, v181
    v_permlane16_swap_b32 v184, v188
    v_permlane16_swap_b32 v185, v189
    v_accvgpr_write_b32 a148, v176
    v_accvgpr_write_b32 a149, v177
    v_accvgpr_write_b32 a150, v180
    v_accvgpr_write_b32 a151, v181
    v_accvgpr_write_b32 a180, v184
    v_accvgpr_write_b32 a181, v185
    v_accvgpr_write_b32 a182, v188
    v_accvgpr_write_b32 a183, v189
    s_nop 1
    s_waitcnt lgkmcnt(0)
    v_mfma_f32_32x32x16_bf16 v[0:15], a[208:211], a[144:147], v[0:15]
    v_mul_f32 v192, s25, v192
    v_mul_f32 v193, s25, v193
    v_mul_f32 v194, s25, v194
    v_mul_f32 v195, s25, v195
    v_mul_f32 v196, s25, v196
    v_mul_f32 v197, s25, v197
    v_mfma_f32_32x32x16_bf16 v[16:31], a[208:211], a[176:179], v[16:31]
    v_mul_f32 v198, s25, v198
    v_mul_f32 v199, s25, v199
    v_mul_f32 v200, s25, v200
    v_mul_f32 v201, s25, v201
    v_mul_f32 v202, s25, v202
    v_mul_f32 v203, s25, v203
    v_mfma_f32_32x32x16_bf16 v[0:15], a[212:215], a[148:151], v[0:15]
    v_mul_f32 v204, s25, v204
    v_mul_f32 v205, s25, v205
    v_mul_f32 v206, s25, v206
    v_mul_f32 v207, s25, v207
    v_cvt_pk_bf16_f32 v192, v192, v193
    v_cvt_pk_bf16_f32 v193, v194, v195
    v_mfma_f32_32x32x16_bf16 v[16:31], a[212:215], a[180:183], v[16:31]
    v_cvt_pk_bf16_f32 v196, v196, v197
    v_cvt_pk_bf16_f32 v197, v198, v199
    v_cvt_pk_bf16_f32 v200, v200, v201
    v_cvt_pk_bf16_f32 v201, v202, v203
    v_cvt_pk_bf16_f32 v204, v204, v205
    v_cvt_pk_bf16_f32 v205, v206, v207
    v_permlane16_swap_b32 v192, v196
    v_permlane16_swap_b32 v193, v197
    v_permlane16_swap_b32 v200, v204
    v_permlane16_swap_b32 v201, v205
    v_accvgpr_write_b32 a152, v192
    v_accvgpr_write_b32 a153, v193
    v_accvgpr_write_b32 a154, v196
    v_accvgpr_write_b32 a155, v197
    v_accvgpr_write_b32 a184, v200
    v_accvgpr_write_b32 a185, v201
    v_accvgpr_write_b32 a186, v204
    v_accvgpr_write_b32 a187, v205
    v_mul_f32 v208, s25, v208
    v_mul_f32 v209, s25, v209
    v_mul_f32 v210, s25, v210
    v_mul_f32 v211, s25, v211
    v_mul_f32 v212, s25, v212
    v_mul_f32 v213, s25, v213
    v_mul_f32 v214, s25, v214
    v_mul_f32 v215, s25, v215
    v_mul_f32 v216, s25, v216
    v_mul_f32 v217, s25, v217
    v_mul_f32 v218, s25, v218
    v_mul_f32 v219, s25, v219
    v_mul_f32 v220, s25, v220
    v_mul_f32 v221, s25, v221
    v_mul_f32 v222, s25, v222
    v_mul_f32 v223, s25, v223
    v_cvt_pk_bf16_f32 v208, v208, v209
    v_cvt_pk_bf16_f32 v209, v210, v211
    v_cvt_pk_bf16_f32 v212, v212, v213
    v_cvt_pk_bf16_f32 v213, v214, v215
    v_cvt_pk_bf16_f32 v216, v216, v217
    v_cvt_pk_bf16_f32 v217, v218, v219
    v_cvt_pk_bf16_f32 v220, v220, v221
    v_cvt_pk_bf16_f32 v221, v222, v223
    v_permlane16_swap_b32 v208, v212
    v_permlane16_swap_b32 v209, v213
    v_permlane16_swap_b32 v216, v220
    v_permlane16_swap_b32 v217, v221
    v_accvgpr_write_b32 a156, v208
    v_accvgpr_write_b32 a157, v209
    v_accvgpr_write_b32 a158, v212
    v_accvgpr_write_b32 a159, v213
    v_accvgpr_write_b32 a188, v216
    v_accvgpr_write_b32 a189, v217
    v_accvgpr_write_b32 a190, v220
    v_accvgpr_write_b32 a191, v221
    s_nop 1
    v_mfma_f32_32x32x16_bf16 v[0:15], a[216:219], a[152:155], v[0:15]
    v_mfma_f32_32x32x16_bf16 v[16:31], a[216:219], a[184:187], v[16:31]
    v_mfma_f32_32x32x16_bf16 v[0:15], a[220:223], a[156:159], v[0:15]
    v_mfma_f32_32x32x16_bf16 v[16:31], a[220:223], a[188:191], v[16:31]
    s_nop 11
    v_max3_f32 v230, v0, v1, v2
    v_max3_f32 v232, v16, v17, v18
    v_max3_f32 v230, v230, v3, v4
    v_max3_f32 v232, v232, v19, v20
    v_max3_f32 v230, v230, v5, v6
    v_max3_f32 v232, v232, v21, v22
    v_max3_f32 v230, v230, v7, v8
    v_max3_f32 v232, v232, v23, v24
    v_max3_f32 v230, v230, v9, v10
    v_max3_f32 v232, v232, v25, v26
    v_max3_f32 v230, v230, v11, v12
    v_max3_f32 v232, v232, v27, v28
    v_max3_f32 v230, v230, v13, v14
    v_max3_f32 v232, v232, v29, v30
    v_max_f32 v230, v230, v15
    v_max_f32 v232, v232, v31
    v_mov_b32 v231, v230
    v_mov_b32 v233, v232
    s_nop 1
    s_nop 1
    v_permlane32_swap_b32 v230, v231
    v_permlane32_swap_b32 v232, v233
    s_nop 0
    s_nop 0
    v_max_f32 v230, v230, v231
    v_max_f32 v232, v232, v233
    v_sub_f32 v228, 0, v230
    v_sub_f32 v64, v64, v230
    v_sub_f32 v65, v65, v230
    v_sub_f32 v66, v66, v230
    v_sub_f32 v67, v67, v230
    v_sub_f32 v68, v68, v230
    v_sub_f32 v69, v69, v230
    v_sub_f32 v70, v70, v230
    v_sub_f32 v71, v71, v230
    v_sub_f32 v72, v72, v230
    v_sub_f32 v73, v73, v230
    v_sub_f32 v74, v74, v230
    v_sub_f32 v75, v75, v230
    v_sub_f32 v76, v76, v230
    v_sub_f32 v77, v77, v230
    v_sub_f32 v78, v78, v230
    v_sub_f32 v79, v79, v230
    v_sub_f32 v229, 0, v232
    v_sub_f32 v80, v80, v232
    v_sub_f32 v81, v81, v232
    v_sub_f32 v82, v82, v232
    v_sub_f32 v83, v83, v232
    v_sub_f32 v84, v84, v232
    v_sub_f32 v85, v85, v232
    v_sub_f32 v86, v86, v232
    v_sub_f32 v87, v87, v232
    v_sub_f32 v88, v88, v232
    v_sub_f32 v89, v89, v232
    v_sub_f32 v90, v90, v232
    v_sub_f32 v91, v91, v232
    v_sub_f32 v92, v92, v232
    v_sub_f32 v93, v93, v232
    v_sub_f32 v94, v94, v232
    v_sub_f32 v95, v95, v232
    v_sub_f32 v0, v0, v230
    v_sub_f32 v1, v1, v230
    v_sub_f32 v2, v2, v230
    v_sub_f32 v3, v3, v230
    v_sub_f32 v4, v4, v230
    v_sub_f32 v5, v5, v230
    v_sub_f32 v6, v6, v230
    v_sub_f32 v7, v7, v230
    v_sub_f32 v8, v8, v230
    v_sub_f32 v9, v9, v230
    v_sub_f32 v10, v10, v230
    v_sub_f32 v11, v11, v230
    v_sub_f32 v12, v12, v230
    v_sub_f32 v13, v13, v230
    v_sub_f32 v14, v14, v230
    v_sub_f32 v15, v15, v230
    v_sub_f32 v16, v16, v232
    v_sub_f32 v17, v17, v232
    v_sub_f32 v18, v18, v232
    v_sub_f32 v19, v19, v232
    v_sub_f32 v20, v20, v232
    v_sub_f32 v21, v21, v232
    v_sub_f32 v22, v22, v232
    v_sub_f32 v23, v23, v232
    v_sub_f32 v24, v24, v232
    v_sub_f32 v25, v25, v232
    v_sub_f32 v26, v26, v232
    v_sub_f32 v27, v27, v232
    v_sub_f32 v28, v28, v232
    v_sub_f32 v29, v29, v232
    v_sub_f32 v30, v30, v232
    v_sub_f32 v31, v31, v232
    s_mov_b32 s35, 32768
    v_add_u32 v241, s35, v239
    s_sub_u32 s36, s36, 1
    s_cbranch_scc1 kf_fix3
kf_fixr4:
    v_mfma_f32_32x32x16_bf16 v[32:47], a[224:227], a[128:131], v[64:79]
    ds_read_b128 a[192:195], v241 offset:0
    v_exp_f32 v136, v0
    v_exp_f32 v137, v1
    v_exp_f32 v130, v2
    v_mfma_f32_32x32x16_bf16 v[48:63], a[224:227], a[160:163], v[80:95]
    v_exp_f32 v131, v3
    v_cvt_pk_bf16_f32 v96, v136, v137
    v_exp_f32 v132, v4
    v_exp_f32 v133, v5
    v_cvt_pk_bf16_f32 v97, v130, v131
    v_add_f32 v136, v136, v130
    v_mfma_f32_32x32x16_bf16 v[32:47], a[228:231], a[132:135], v[32:47]
    ds_read_b128 a[196:199], v241 offset:512
    v_add_f32 v137, v137, v131
    v_exp_f32 v134, v6
    v_exp_f32 v135, v7
    v_cvt_pk_bf16_f32 v98, v132, v133
    v_mfma_f32_32x32x16_bf16 v[48:63], a[228:231], a[164:167], v[48:63]
    v_add_f32 v136, v136, v132
    v_add_f32 v137, v137, v133
    v_exp_f32 v128, v8
    v_exp_f32 v129, v9
    v_cvt_pk_bf16_f32 v99, v134, v135
    v_add_f32 v136, v136, v134
    v_add_f32 v137, v137, v135
    v_mfma_f32_32x32x16_bf16 v[32:47], a[232:235], a[136:139], v[32:47]
    ds_read_b128 a[200:203], v241 offset:2048
    v_exp_f32 v130, v10
    v_exp_f32 v131, v11
    v_cvt_pk_bf16_f32 v100, v128, v129
    v_add_f32 v136, v136, v128
    v_mfma_f32_32x32x16_bf16 v[48:63], a[232:235], a[168:171], v[48:63]
    v_add_f32 v137, v137, v129
    v_exp_f32 v132, v12
    v_exp_f32 v133, v13
    v_cvt_pk_bf16_f32 v101, v130, v131
    v_add_f32 v136, v136, v130
    v_add_f32 v137, v137, v131
    v_mfma_f32_32x32x16_bf16 v[32:47], a[236:239], a[140:143], v[32:47]
    ds_read_b128 a[204:207], v241 offset:2560
    v_exp_f32 v134, v14
    v_exp_f32 v135, v15
    v_cvt_pk_bf16_f32 v102, v132, v133
    v_add_f32 v136, v136, v132
    v_add_f32 v137, v137, v133
    v_mfma_f32_32x32x16_bf16 v[48:63], a[236:239], a[172:175], v[48:63]
    v_exp_f32 v138, v16
    v_exp_f32 v139, v17
    v_cvt_pk_bf16_f32 v103, v134, v135
    v_add_f32 v136, v136, v134
    v_add_f32 v137, v137, v135
    v_add_f32 v224, v136, v137
    v_mfma_f32_32x32x16_bf16 v[32:47], a[240:243], a[144:147], v[32:47]
    ds_read_b128 a[208:211], v241 offset:4096
    v_exp_f32 v130, v18
    v_exp_f32 v131, v19
    v_cvt_pk_bf16_f32 v104, v138, v139
    v_exp_f32 v132, v20
    v_mfma_f32_32x32x16_bf16 v[48:63], a[240:243], a[176:179], v[48:63]
    v_exp_f32 v133, v21
    v_cvt_pk_bf16_f32 v105, v130, v131
    v_add_f32 v138, v138, v130
    v_add_f32 v139, v139, v131
    v_exp_f32 v134, v22
    v_mfma_f32_32x32x16_bf16 v[32:47], a[244:247], a[148:151], v[32:47]
    ds_read_b128 a[212:215], v241 offset:4608
    v_exp_f32 v135, v23
    v_cvt_pk_bf16_f32 v106, v132, v133
    v_add_f32 v138, v138, v132
    v_add_f32 v139, v139, v133
    v_exp_f32 v128, v24
    v_mfma_f32_32x32x16_bf16 v[48:63], a[244:247], a[180:183], v[48:63]
    v_exp_f32 v129, v25
    v_cvt_pk_bf16_f32 v107, v134, v135
    v_add_f32 v138, v138, v134
    v_add_f32 v139, v139, v135
    v_exp_f32 v130, v26
    v_exp_f32 v131, v27
    v_mfma_f32_32x32x16_bf16 v[32:47], a[248:251], a[152:155], v[32:47]
    ds_read_b128 a[216:219], v241 offset:6144
    v_cvt_pk_bf16_f32 v108, v128, v129
    v_add_f32 v138, v138, v128
    v_add_f32 v139, v139, v129
    v_exp_f32 v132, v28
    v_exp_f32 v133, v29
    v_mfma_f32_32x32x16_bf16 v[48:63], a[248:251], a[184:187], v[48:63]
    v_cvt_pk_bf16_f32 v109, v130, v131
    v_add_f32 v138, v138, v130
    v_add_f32 v139, v139, v131
    v_exp_f32 v134, v30
    v_exp_f32 v135, v31
    v_mfma_f32_32x32x16_bf16 v[32:47], a[252:255], a[156:159], v[32:47]
    ds_read_b128 a[220:223], v241 offset:6656
    v_cvt_pk_bf16_f32 v110, v132, v133
    v_add_f32 v138, v138, v132
    v_add_f32 v139, v139, v133
    v_cvt_pk_bf16_f32 v111, v134, v135
    v_add_f32 v138, v138, v134
    v_add_f32 v139, v139, v135
    v_add_f32 v225, v138, v139
    v_mfma_f32_32x32x16_bf16 v[48:63], a[252:255], a[188:191], v[48:63]
    ds_read_b128 a[224:227], v241 offset:16384
    ds_read_b128 a[228:231], v241 offset:18432
    ds_read_b128 a[232:235], v241 offset:20480
    ds_read_b128 a[236:239], v241 offset:22528
    s_lshl_b32 s26, s5, 1
    s_mov_b32 s58, 0x800000
    s_and_b32 s28, s2, 6
    s_lshl_b32 s28, s28, 20
    s_lshr_b32 s27, s2, 3
    s_lshl2_add_u32 s27, s27, s3
    s_lshl_b32 s27, s27, 14
    s_add_u32 s28, s28, s27
    s_mov_b32 s27, 20
    s_add_u32 s8, s20, 0x2c00000
    s_addc_u32 s9, s21, 0
    s_mov_b32 s10, 0xc00000
    s_lshl2_add_u32 s29, s2, s3
    s_mul_i32 s29, s29, 12288
    s_add_u32 s30, s29, 12288
    v_mov_b32 v200, -1
    v_mov_b32 v201, -1
    v_mov_b32 v202, -1
    v_mov_b32 v203, -1
.p2align 3
ka_p1:
    s_sub_u32 s36, s36, 1
    s_cbranch_scc1 kf_fix7
kf_fixr8:
    s_waitcnt lgkmcnt(8)
    v_mfma_f32_32x32x16_bf16 v[0:15], a[192:195], a[128:131], v[64:79]
    ds_read_b128 a[240:243], v241 offset:16896
    v_add_f32 v226, v226, v224
    v_add_f32 v227, v227, v225
    v_exp_f32 v136, v32
    v_mfma_f32_32x32x16_bf16 v[16:31], a[192:195], a[160:163], v[80:95]
    s_waitcnt vmcnt(11)
    buffer_store_dwordx4 v[192:195], v255, s[48:51], s45 offen offset:0 sc1
    s_cmp_lt_u32 s44, s47
    s_cselect_b32 s101, s44, s43
    buffer_load_dwordx4 v[192:195], v253, s[52:55], s101 offen
    v_mfma_f32_32x32x16_bf16 v[0:15], a[196:199], a[132:135], v[0:15]
    ds_read_b128 a[244:247], v241 offset:18944
    v_exp_f32 v137, v33
    v_exp_f32 v130, v34
    v_mfma_f32_32x32x16_bf16 v[16:31], a[196:199], a[164:167], v[16:31]
    v_exp_f32 v131, v35
    v_cvt_pk_bf16_f32 v112, v136, v137
    v_exp_f32 v132, v36
    v_mfma_f32_32x32x16_bf16 v[0:15], a[200:203], a[136:139], v[0:15]
    ds_read_b128 a[248:251], v241 offset:20992
    v_exp_f32 v133, v37
    v_cvt_pk_bf16_f32 v113, v130, v131
    v_mfma_f32_32x32x16_bf16 v[16:31], a[200:203], a[168:171], v[16:31]
    s_sub_u32 s27, s27, 1
    s_cbranch_scc1 kf_l2p5
kf_l2r6:
    v_add_f32 v136, v136, v130
    v_add_f32 v137, v137, v131
    v_mfma_f32_32x32x16_bf16 v[0:15], a[204:207], a[140:143], v[0:15]
    ds_read_b128 a[252:255], v241 offset:23040
    v_exp_f32 v134, v38
    v_exp_f32 v135, v39
    v_mfma_f32_32x32x16_bf16 v[16:31], a[204:207], a[172:175], v[16:31]
    v_cvt_pk_bf16_f32 v114, v132, v133
    v_add_f32 v136, v136, v132
    v_add_f32 v137, v137, v133
    v_exp_f32 v128, v40
    s_waitcnt lgkmcnt(8)
    v_mfma_f32_32x32x16_bf16 v[0:15], a[208:211], a[144:147], v[0:15]
    ds_read_b128 a[192:195], v241 offset:8192
    v_exp_f32 v129, v41
    v_cvt_pk_bf16_f32 v115, v134, v135
    v_mfma_f32_32x32x16_bf16 v[16:31], a[208:211], a[176:179], v[16:31]
    s_mov_b32 m0, s34
    s_add_u32 s41, s42, 17664
    v_add_f32 v136, v136, v134
    v_add_f32 v137, v137, v135
    v_mfma_f32_32x32x16_bf16 v[0:15], a[212:215], a[148:151], v[0:15]
    ds_read_b128 a[196:199], v241 offset:8704
    v_exp_f32 v130, v42
    v_exp_f32 v131, v43
    v_cvt_pk_bf16_f32 v116, v128, v129
    v_mfma_f32_32x32x16_bf16 v[16:31], a[212:215], a[180:183], v[16:31]
    v_add_f32 v136, v136, v128
    v_add_f32 v137, v137, v129
    v_exp_f32 v132, v44
    v_mfma_f32_32x32x16_bf16 v[0:15], a[216:219], a[152:155], v[0:15]
    ds_read_b128 a[200:203], v241 offset:10240
    v_exp_f32 v133, v45
    v_cvt_pk_bf16_f32 v117, v130, v131
    v_add_f32 v136, v136, v130
    v_mfma_f32_32x32x16_bf16 v[16:31], a[216:219], a[184:187], v[16:31]
    buffer_load_dwordx4 v242, s[16:19], s41 offen offset:0 sc1 lds
    v_add_f32 v137, v137, v131
    v_exp_f32 v134, v46
    v_mfma_f32_32x32x16_bf16 v[0:15], a[220:223], a[156:159], v[0:15]
    ds_read_b128 a[204:207], v241 offset:10752
    v_exp_f32 v135, v47
    v_cvt_pk_bf16_f32 v118, v132, v133
    v_add_f32 v136, v136, v132
    v_mfma_f32_32x32x16_bf16 v[16:31], a[220:223], a[188:191], v[16:31]
    v_add_f32 v137, v137, v133
    v_exp_f32 v138, v48
    s_waitcnt lgkmcnt(8)
    v_mfma_f32_32x32x16_bf16 a[0:15], a[224:227], v[96:99], a[0:15]
    ds_read_b128 a[208:211], v241 offset:12288
    v_exp_f32 v139, v49
    v_cvt_pk_bf16_f32 v119, v134, v135
    v_add_f32 v136, v136, v134
    v_add_f32 v137, v137, v135
    v_mfma_f32_32x32x16_bf16 a[64:79], a[224:227], v[104:107], a[64:79]
    v_add_f32 v224, v136, v137
    v_exp_f32 v130, v50
    v_exp_f32 v131, v51
    v_mfma_f32_32x32x16_bf16 a[16:31], a[228:231], v[96:99], a[16:31]
    ds_read_b128 a[212:215], v241 offset:12800
    buffer_load_dwordx4 v242, s[16:19], s41 offen offset:1024 sc1 lds
    v_cvt_pk_bf16_f32 v120, v138, v139
    v_exp_f32 v132, v52
    v_mfma_f32_32x32x16_bf16 a[80:95], a[228:231], v[104:107], a[80:95]
    v_exp_f32 v133, v53
    v_cvt_pk_bf16_f32 v121, v130, v131
    v_add_f32 v138, v138, v130
    v_mfma_f32_32x32x16_bf16 a[32:47], a[232:235], v[96:99], a[32:47]
    ds_read_b128 a[216:219], v241 offset:14336
    v_add_f32 v139, v139, v131
    v_exp_f32 v134, v54
    v_mfma_f32_32x32x16_bf16 a[96:111], a[232:235], v[104:107], a[96:111]
    v_exp_f32 v135, v55
    v_cvt_pk_bf16_f32 v122, v132, v133
    v_add_f32 v138, v138, v132
    v_add_f32 v139, v139, v133
    v_mfma_f32_32x32x16_bf16 a[48:63], a[236:239], v[96:99], a[48:63]
    ds_read_b128 a[220:223], v241 offset:14848
    buffer_load_dwordx4 v242, s[16:19], s41 offen offset:2048 sc1 lds
    v_exp_f32 v128, v56
    v_mfma_f32_32x32x16_bf16 a[112:127], a[236:239], v[104:107], a[112:127]
    v_exp_f32 v129, v57
    v_cvt_pk_bf16_f32 v123, v134, v135
    v_add_f32 v138, v138, v134
    s_waitcnt lgkmcnt(8)
    v_mfma_f32_32x32x16_bf16 a[0:15], a[240:243], v[100:103], a[0:15]
    ds_read_b128 a[224:227], v241 offset:24576
    v_add_f32 v139, v139, v135
    v_exp_f32 v130, v58
    v_exp_f32 v131, v59
    v_mfma_f32_32x32x16_bf16 a[64:79], a[240:243], v[108:111], a[64:79]
    v_cvt_pk_bf16_f32 v124, v128, v129
    v_add_f32 v138, v138, v128
    v_add_f32 v139, v139, v129
    v_mfma_f32_32x32x16_bf16 a[16:31], a[244:247], v[100:103], a[16:31]
    ds_read_b128 a[228:231], v241 offset:26624
    buffer_load_dwordx4 v242, s[16:19], s41 offen offset:3072 sc1 lds
    v_exp_f32 v132, v60
    v_exp_f32 v133, v61
    v_mfma_f32_32x32x16_bf16 a[80:95], a[244:247], v[108:111], a[80:95]
    v_cvt_pk_bf16_f32 v125, v130, v131
    v_add_f32 v138, v138, v130
    v_add_f32 v139, v139, v131
    v_exp_f32 v134, v62
    v_mfma_f32_32x32x16_bf16 a[32:47], a[248:251], v[100:103], a[32:47]
    ds_read_b128 a[232:235], v241 offset:28672
    v_exp_f32 v135, v63
    v_cvt_pk_bf16_f32 v126, v132, v133
    v_mfma_f32_32x32x16_bf16 a[96:111], a[248:251], v[108:111], a[96:111]
    v_add_f32 v138, v138, v132
    v_add_f32 v139, v139, v133
    v_cvt_pk_bf16_f32 v127, v134, v135
    v_add_f32 v138, v138, v134
    v_mfma_f32_32x32x16_bf16 a[48:63], a[252:255], v[100:103], a[48:63]
    ds_read_b128 a[236:239], v241 offset:30720
    v_add_f32 v139, v139, v135
    v_add_f32 v225, v138, v139
    v_max_f32 v230, v224, v225
    v_cmp_lt_f32 vcc, s38, v230
    v_mfma_f32_32x32x16_bf16 a[112:127], a[252:255], v[108:111], a[112:127]
    s_cbranch_vccnz kf_rare10
kf_rr9:
    s_sub_u32 s36, s36, 1
    s_cbranch_scc1 kf_fix13
kf_fixr14:
    s_waitcnt lgkmcnt(8)
    v_mfma_f32_32x32x16_bf16 v[32:47], a[192:195], a[128:131], v[64:79]
    ds_read_b128 a[240:243], v241 offset:25088
    v_add_f32 v226, v226, v224
    v_add_f32 v227, v227, v225
    v_exp_f32 v136, v0
    v_mfma_f32_32x32x16_bf16 v[48:63], a[192:195], a[160:163], v[80:95]
    s_waitcnt vmcnt(11)
    buffer_store_dwordx4 v[196:199], v255, s[48:51], s45 offen offset:256 sc1
    s_add_u32 s101, s101, 57344
    buffer_load_dwordx4 v[196:199], v253, s[52:55], s101 offen
    v_exp_f32 v137, v1
    v_mfma_f32_32x32x16_bf16 v[32:47], a[196:199], a[132:135], v[32:47]
    ds_read_b128 a[244:247], v241 offset:27136
    v_exp_f32 v130, v2
    v_exp_f32 v131, v3
    v_mfma_f32_32x32x16_bf16 v[48:63], a[196:199], a[164:167], v[48:63]
    v_cvt_pk_bf16_f32 v96, v136, v137
    v_exp_f32 v132, v4
    v_exp_f32 v133, v5
    v_mfma_f32_32x32x16_bf16 v[32:47], a[200:203], a[136:139], v[32:47]
    ds_read_b128 a[248:251], v241 offset:29184
    s_cmp_lt_u32 s44, s47
    s_cselect_b32 s45, s46, s43
    s_add_u32 s44, s44, 128
    s_add_u32 s46, s46, 262144
    v_mfma_f32_32x32x16_bf16 v[48:63], a[200:203], a[168:171], v[48:63]
    v_cvt_pk_bf16_f32 v97, v130, v131
    v_add_f32 v136, v136, v130
    v_add_f32 v137, v137, v131
    v_exp_f32 v134, v6
    v_mfma_f32_32x32x16_bf16 v[32:47], a[204:207], a[140:143], v[32:47]
    ds_read_b128 a[252:255], v241 offset:31232
    v_exp_f32 v135, v7
    v_cvt_pk_bf16_f32 v98, v132, v133
    v_add_f32 v136, v136, v132
    v_mfma_f32_32x32x16_bf16 v[48:63], a[204:207], a[172:175], v[48:63]
    s_add_u32 m0, s34, 16384
    s_add_u32 s34, s34, 32768
    s_cmp_ge_u32 s34, 163840
    s_cselect_b32 s34, s37, s34
    v_add_f32 v137, v137, v133
    s_waitcnt lgkmcnt(8)
    v_mfma_f32_32x32x16_bf16 v[32:47], a[208:211], a[144:147], v[32:47]
    s_waitcnt vmcnt(16)
    s_barrier
    s_add_u32 s35, s35, 32768
    s_cmp_ge_u32 s35, 163840
    s_cselect_b32 s35, 0, s35
    v_add_u32 v241, s35, v239
    ds_read_b128 a[192:195], v241 offset:0
    v_mfma_f32_32x32x16_bf16 v[48:63], a[208:211], a[176:179], v[48:63]
    v_exp_f32 v128, v8
    v_exp_f32 v129, v9
    v_cvt_pk_bf16_f32 v99, v134, v135
    v_mfma_f32_32x32x16_bf16 v[32:47], a[212:215], a[148:151], v[32:47]
    ds_read_b128 a[196:199], v241 offset:512
    v_add_f32 v136, v136, v134
    v_add_f32 v137, v137, v135
    v_exp_f32 v130, v10
    v_mfma_f32_32x32x16_bf16 v[48:63], a[212:215], a[180:183], v[48:63]
    buffer_load_dwordx4 v242, s[16:19], s42 offen offset:0 sc1 lds
    v_exp_f32 v131, v11
    v_cvt_pk_bf16_f32 v100, v128, v129
    v_add_f32 v136, v136, v128
    v_mfma_f32_32x32x16_bf16 v[32:47], a[216:219], a[152:155], v[32:47]
    ds_read_b128 a[200:203], v241 offset:2048
    v_add_f32 v137, v137, v129
    v_exp_f32 v132, v12
    v_exp_f32 v133, v13
    v_mfma_f32_32x32x16_bf16 v[48:63], a[216:219], a[184:187], v[48:63]
    v_cvt_pk_bf16_f32 v101, v130, v131
    v_add_f32 v136, v136, v130
    v_add_f32 v137, v137, v131
    v_exp_f32 v134, v14
    v_mfma_f32_32x32x16_bf16 v[32:47], a[220:223], a[156:159], v[32:47]
    ds_read_b128 a[204:207], v241 offset:2560
    buffer_load_dwordx4 v242, s[16:19], s42 offen offset:1024 sc1 lds
    v_exp_f32 v135, v15
    v_mfma_f32_32x32x16_bf16 v[48:63], a[220:223], a[188:191], v[48:63]
    v_cvt_pk_bf16_f32 v102, v132, v133
    v_add_f32 v136, v136, v132
    v_add_f32 v137, v137, v133
    v_exp_f32 v138, v16
    s_waitcnt lgkmcnt(8)
    v_mfma_f32_32x32x16_bf16 a[0:15], a[224:227], v[112:115], a[0:15]
    ds_read_b128 a[208:211], v241 offset:4096
    v_exp_f32 v139, v17
    v_cvt_pk_bf16_f32 v103, v134, v135
    v_add_f32 v136, v136, v134
    v_mfma_f32_32x32x16_bf16 a[64:79], a[224:227], v[120:123], a[64:79]
    buffer_load_dwordx4 v242, s[16:19], s42 offen offset:2048 sc1 lds
    v_add_f32 v137, v137, v135
    v_add_f32 v224, v136, v137
    v_exp_f32 v130, v18
    v_mfma_f32_32x32x16_bf16 a[16:31], a[228:231], v[112:115], a[16:31]
    ds_read_b128 a[212:215], v241 offset:4608
    v_exp_f32 v131, v19
    v_cvt_pk_bf16_f32 v104, v138, v139
    v_mfma_f32_32x32x16_bf16 a[80:95], a[228:231], v[120:123], a[80:95]
    v_exp_f32 v132, v20
    v_exp_f32 v133, v21
    v_cvt_pk_bf16_f32 v105, v130, v131
    v_add_f32 v138, v138, v130
    v_mfma_f32_32x32x16_bf16 a[32:47], a[232:235], v[112:115], a[32:47]
    ds_read_b128 a[216:219], v241 offset:6144
    v_add_f32 v139, v139, v131
    v_exp_f32 v134, v22
    v_mfma_f32_32x32x16_bf16 a[96:111], a[232:235], v[120:123], a[96:111]
    buffer_load_dwordx4 v242, s[16:19], s42 offen offset:3072 sc1 lds
    s_add_u32 s42, s42, 34048
    v_exp_f32 v135, v23
    v_cvt_pk_bf16_f32 v106, v132, v133
    v_add_f32 v138, v138, v132
    v_mfma_f32_32x32x16_bf16 a[48:63], a[236:239], v[112:115], a[48:63]
    ds_read_b128 a[220:223], v241 offset:6656
    v_add_f32 v139, v139, v133
    v_exp_f32 v128, v24
    v_exp_f32 v129, v25
    v_mfma_f32_32x32x16_bf16 a[112:127], a[236:239], v[120:123], a[112:127]
    v_cvt_pk_bf16_f32 v107, v134, v135
    v_add_f32 v138, v138, v134
    v_add_f32 v139, v139, v135
    s_waitcnt lgkmcnt(8)
    v_mfma_f32_32x32x16_bf16 a[0:15], a[240:243], v[116:119], a[0:15]
    ds_read_b128 a[224:227], v241 offset:16384
    buffer_load_dword v252, v251, s[60:63], s100 offen
    s_add_u32 s100, s100, 2048
    v_exp_f32 v130, v26
    v_mfma_f32_32x32x16_bf16 a[64:79], a[240:243], v[124:127], a[64:79]
    v_exp_f32 v131, v27
    v_cvt_pk_bf16_f32 v108, v128, v129
    v_add_f32 v138, v138, v128
    v_add_f32 v139, v139, v129
    v_mfma_f32_32x32x16_bf16 a[16:31], a[244:247], v[116:119], a[16:31]
    ds_read_b128 a[228:231], v241 offset:18432
    v_exp_f32 v132, v28
    v_exp_f32 v133, v29
    v_cvt_pk_bf16_f32 v109, v130, v131
    v_mfma_f32_32x32x16_bf16 a[80:95], a[244:247], v[124:127], a[80:95]
    s_sub_u32 s27, s27, 1
    s_cbranch_scc1 kf_l2p11
kf_l2r12:
    v_add_f32 v138, v138, v130
    v_add_f32 v139, v139, v131
    v_mfma_f32_32x32x16_bf16 a[32:47], a[248:251], v[116:119], a[32:47]
    ds_read_b128 a[232:235], v241 offset:20480
    v_exp_f32 v134, v30
    v_exp_f32 v135, v31
    v_mfma_f32_32x32x16_bf16 a[96:111], a[248:251], v[124:127], a[96:111]
    v_cvt_pk_bf16_f32 v110, v132, v133
    v_add_f32 v138, v138, v132
    v_add_f32 v139, v139, v133
    v_cvt_pk_bf16_f32 v111, v134, v135
    v_add_f32 v138, v138, v134
    v_mfma_f32_32x32x16_bf16 a[48:63], a[252:255], v[116:119], a[48:63]
    ds_read_b128 a[236:239], v241 offset:22528
    v_add_f32 v139, v139, v135
    v_add_f32 v225, v138, v139
    v_max_f32 v230, v224, v225
    v_cmp_lt_f32 vcc, s38, v230
    v_mfma_f32_32x32x16_bf16 a[112:127], a[252:255], v[124:127], a[112:127]
    s_cbranch_vccnz kf_rare16
kf_rr15:
    s_sub_u32 s26, s26, 1
    s_cbranch_scc0 ka_p1
    s_lshl2_add_u32 s36, s5, s6
    s_sub_u32 s36, 59, s36
    s_mov_b32 s33, 0
    s_sub_u32 s36, s36, 1
    s_cbranch_scc1 kf_fix19
kf_fixr20:
    s_waitcnt lgkmcnt(8)
    v_mfma_f32_32x32x16_bf16 v[16:31], a[192:195], a[160:163], v[80:95]
    ds_read_b128 a[240:243], v241 offset:16896
    v_add_f32 v226, v226, v224
    v_add_f32 v227, v227, v225
    v_exp_f32 v136, v32
    v_exp_f32 v137, v33
    v_mfma_f32_32x32x16_bf16 v[16:31], a[196:199], a[164:167], v[16:31]
    ds_read_b128 a[244:247], v241 offset:18944
    s_waitcnt vmcnt(11)
    buffer_store_dwordx4 v[192:195], v255, s[48:51], s45 offen offset:0 sc1
    v_exp_f32 v130, v34
    v_mfma_f32_32x32x16_bf16 v[16:31], a[200:203], a[168:171], v[16:31]
    ds_read_b128 a[248:251], v241 offset:20992
    v_exp_f32 v131, v35
    v_cvt_pk_bf16_f32 v112, v136, v137
    v_exp_f32 v132, v36
    v_mfma_f32_32x32x16_bf16 v[16:31], a[204:207], a[172:175], v[16:31]
    ds_read_b128 a[252:255], v241 offset:23040
    v_exp_f32 v133, v37
    v_cvt_pk_bf16_f32 v113, v130, v131
    v_add_f32 v136, v136, v130
    v_add_f32 v137, v137, v131
    s_waitcnt lgkmcnt(8)
    v_mfma_f32_32x32x16_bf16 v[16:31], a[208:211], a[176:179], v[16:31]
    ds_read_b128 a[192:195], v241 offset:8192
    s_sub_u32 s27, s27, 1
    s_cbranch_scc1 kf_l2p17
kf_l2r18:
    v_exp_f32 v134, v38
    v_mfma_f32_32x32x16_bf16 v[16:31], a[212:215], a[180:183], v[16:31]
    ds_read_b128 a[196:199], v241 offset:8704
    v_exp_f32 v135, v39
    v_cvt_pk_bf16_f32 v114, v132, v133
    v_add_f32 v136, v136, v132
    v_add_f32 v137, v137, v133
    v_mfma_f32_32x32x16_bf16 v[16:31], a[216:219], a[184:187], v[16:31]
    ds_read_b128 a[200:203], v241 offset:10240
    v_exp_f32 v128, v40
    v_exp_f32 v129, v41
    v_cvt_pk_bf16_f32 v115, v134, v135
    v_add_f32 v136, v136, v134
    v_mfma_f32_32x32x16_bf16 v[16:31], a[220:223], a[188:191], v[16:31]
    ds_read_b128 a[204:207], v241 offset:10752
    s_mov_b32 m0, s34
    s_add_u32 s41, s42, 17664
    v_add_f32 v137, v137, v135
    s_waitcnt lgkmcnt(8)
    v_mfma_f32_32x32x16_bf16 a[0:15], a[224:227], v[96:99], a[0:15]
    ds_read_b128 a[208:211], v241 offset:12288
    v_exp_f32 v130, v42
    v_exp_f32 v131, v43
    v_cvt_pk_bf16_f32 v116, v128, v129
    v_add_f32 v136, v136, v128
    v_mfma_f32_32x32x16_bf16 a[64:79], a[224:227], v[104:107], a[64:79]
    v_add_f32 v137, v137, v129
    v_exp_f32 v132, v44
    v_exp_f32 v133, v45
    v_cvt_pk_bf16_f32 v117, v130, v131
    v_mfma_f32_32x32x16_bf16 a[16:31], a[228:231], v[96:99], a[16:31]
    ds_read_b128 a[212:215], v241 offset:12800
    buffer_load_dwordx4 v242, s[16:19], s41 offen offset:0 sc1 lds
    v_add_f32 v136, v136, v130
    v_add_f32 v137, v137, v131
    v_exp_f32 v134, v46
    v_mfma_f32_32x32x16_bf16 a[80:95], a[228:231], v[104:107], a[80:95]
    v_exp_f32 v135, v47
    v_cvt_pk_bf16_f32 v118, v132, v133
    v_add_f32 v136, v136, v132
    v_add_f32 v137, v137, v133
    v_exp_f32 v138, v48
    v_mfma_f32_32x32x16_bf16 a[32:47], a[232:235], v[96:99], a[32:47]
    ds_read_b128 a[216:219], v241 offset:14336
    v_exp_f32 v139, v49
    v_cvt_pk_bf16_f32 v119, v134, v135
    v_add_f32 v136, v136, v134
    v_add_f32 v137, v137, v135
    v_mfma_f32_32x32x16_bf16 a[96:111], a[232:235], v[104:107], a[96:111]
    buffer_load_dwordx4 v242, s[16:19], s41 offen offset:1024 sc1 lds
    v_add_f32 v224, v136, v137
    v_exp_f32 v130, v50
    v_exp_f32 v131, v51
    v_mfma_f32_32x32x16_bf16 a[48:63], a[236:239], v[96:99], a[48:63]
    ds_read_b128 a[220:223], v241 offset:14848
    v_cvt_pk_bf16_f32 v120, v138, v139
    v_exp_f32 v132, v52
    v_exp_f32 v133, v53
    v_cvt_pk_bf16_f32 v121, v130, v131
    v_mfma_f32_32x32x16_bf16 a[112:127], a[236:239], v[104:107], a[112:127]
    v_add_f32 v138, v138, v130
    v_add_f32 v139, v139, v131
    v_exp_f32 v134, v54
    v_exp_f32 v135, v55
    s_waitcnt lgkmcnt(8)
    v_mfma_f32_32x32x16_bf16 a[0:15], a[240:243], v[100:103], a[0:15]
    ds_read_b128 a[224:227], v241 offset:24576
    buffer_load_dwordx4 v242, s[16:19], s41 offen offset:2048 sc1 lds
    v_cvt_pk_bf16_f32 v122, v132, v133
    v_add_f32 v138, v138, v132
    v_add_f32 v139, v139, v133
    v_mfma_f32_32x32x16_bf16 a[64:79], a[240:243], v[108:111], a[64:79]
    v_exp_f32 v128, v56
    v_exp_f32 v129, v57
    v_cvt_pk_bf16_f32 v123, v134, v135
    v_add_f32 v138, v138, v134
    v_add_f32 v139, v139, v135
    v_mfma_f32_32x32x16_bf16 a[16:31], a[244:247], v[100:103], a[16:31]
    ds_read_b128 a[228:231], v241 offset:26624
    v_exp_f32 v130, v58
    v_exp_f32 v131, v59
    v_cvt_pk_bf16_f32 v124, v128, v129
    v_mfma_f32_32x32x16_bf16 a[80:95], a[244:247], v[108:111], a[80:95]
    buffer_load_dwordx4 v242, s[16:19], s41 offen offset:3072 sc1 lds
    v_add_f32 v138, v138, v128
    v_add_f32 v139, v139, v129
    v_exp_f32 v132, v60
    v_exp_f32 v133, v61
    v_mfma_f32_32x32x16_bf16 a[32:47], a[248:251], v[100:103], a[32:47]
    ds_read_b128 a[232:235], v241 offset:28672
    v_cvt_pk_bf16_f32 v125, v130, v131
    v_add_f32 v138, v138, v130
    v_add_f32 v139, v139, v131
    v_exp_f32 v134, v62
    v_mfma_f32_32x32x16_bf16 a[96:111], a[248:251], v[108:111], a[96:111]
    v_exp_f32 v135, v63
    v_cvt_pk_bf16_f32 v126, v132, v133
    v_add_f32 v138, v138, v132
    v_add_f32 v139, v139, v133
    v_cvt_pk_bf16_f32 v127, v134, v135
    v_mfma_f32_32x32x16_bf16 a[48:63], a[252:255], v[100:103], a[48:63]
    ds_read_b128 a[236:239], v241 offset:30720
    v_add_f32 v138, v138, v134
    v_add_f32 v139, v139, v135
    v_add_f32 v225, v138, v139
    v_max_f32 v230, v224, v225
    v_cmp_lt_f32 vcc, s38, v230
    v_mfma_f32_32x32x16_bf16 a[112:127], a[252:255], v[108:111], a[112:127]
    s_cbranch_vccnz kf_rare22
kf_rr21:
    s_sub_u32 s36, s36, 1
    s_cbranch_scc1 kf_fix25
kf_fixr26:
    s_waitcnt lgkmcnt(8)
    v_mfma_f32_32x32x16_bf16 v[48:63], a[192:195], a[160:163], v[80:95]
    ds_read_b128 a[240:243], v241 offset:25088
    v_add_f32 v226, v226, v224
    v_add_f32 v227, v227, v225
    v_mfma_f32_32x32x16_bf16 v[48:63], a[196:199], a[164:167], v[48:63]
    ds_read_b128 a[244:247], v241 offset:27136
    s_waitcnt vmcnt(10)
    buffer_store_dwordx4 v[196:199], v255, s[48:51], s45 offen offset:256 sc1
    v_exp_f32 v138, v16
    v_mfma_f32_32x32x16_bf16 v[48:63], a[200:203], a[168:171], v[48:63]
    ds_read_b128 a[248:251], v241 offset:29184
    v_exp_f32 v139, v17
    v_exp_f32 v130, v18
    v_mfma_f32_32x32x16_bf16 v[48:63], a[204:207], a[172:175], v[48:63]
    ds_read_b128 a[252:255], v241 offset:31232
    v_exp_f32 v131, v19
    s_waitcnt lgkmcnt(8)
    v_mfma_f32_32x32x16_bf16 v[48:63], a[208:211], a[176:179], v[48:63]
    s_waitcnt vmcnt(19)
    s_barrier
    s_add_u32 s35, s35, 32768
    s_cmp_ge_u32 s35, 163840
    s_cselect_b32 s35, 0, s35
    v_add_u32 v241, s35, v239
    ds_read_b128 a[192:195], v241 offset:0
    s_add_u32 m0, s34, 16384
    s_add_u32 s34, s34, 32768
    s_cmp_ge_u32 s34, 163840
    s_cselect_b32 s34, s37, s34
    v_mfma_f32_32x32x16_bf16 v[48:63], a[212:215], a[180:183], v[48:63]
    ds_read_b128 a[196:199], v241 offset:512
    v_cvt_pk_bf16_f32 v104, v138, v139
    v_exp_f32 v132, v20
    v_mfma_f32_32x32x16_bf16 v[48:63], a[216:219], a[184:187], v[48:63]
    ds_read_b128 a[200:203], v241 offset:2048
    v_exp_f32 v133, v21
    v_mfma_f32_32x32x16_bf16 v[48:63], a[220:223], a[188:191], v[48:63]
    ds_read_b128 a[204:207], v241 offset:2560
    buffer_load_dwordx4 v242, s[16:19], s42 offen offset:0 sc1 lds
    v_cvt_pk_bf16_f32 v105, v130, v131
    v_add_f32 v138, v138, v130
    s_waitcnt lgkmcnt(8)
    v_mfma_f32_32x32x16_bf16 a[0:15], a[224:227], v[112:115], a[0:15]
    ds_read_b128 a[208:211], v241 offset:4096
    v_add_f32 v139, v139, v131
    v_exp_f32 v134, v22
    v_mfma_f32_32x32x16_bf16 a[64:79], a[224:227], v[120:123], a[64:79]
    v_exp_f32 v135, v23
    v_cvt_pk_bf16_f32 v106, v132, v133
    v_mfma_f32_32x32x16_bf16 a[16:31], a[228:231], v[112:115], a[16:31]
    ds_read_b128 a[212:215], v241 offset:4608
    buffer_load_dwordx4 v242, s[16:19], s42 offen offset:1024 sc1 lds
    v_add_f32 v138, v138, v132
    v_add_f32 v139, v139, v133
    v_mfma_f32_32x32x16_bf16 a[80:95], a[228:231], v[120:123], a[80:95]
    v_exp_f32 v128, v24
    v_exp_f32 v129, v25
    v_mfma_f32_32x32x16_bf16 a[32:47], a[232:235], v[112:115], a[32:47]
    ds_read_b128 a[216:219], v241 offset:6144
    v_cvt_pk_bf16_f32 v107, v134, v135
    v_add_f32 v138, v138, v134
    v_mfma_f32_32x32x16_bf16 a[96:111], a[232:235], v[120:123], a[96:111]
    buffer_load_dwordx4 v242, s[16:19], s42 offen offset:2048 sc1 lds
    v_add_f32 v139, v139, v135
    v_exp_f32 v130, v26
    v_mfma_f32_32x32x16_bf16 a[48:63], a[236:239], v[112:115], a[48:63]
    ds_read_b128 a[220:223], v241 offset:6656
    v_exp_f32 v131, v27
    v_cvt_pk_bf16_f32 v108, v128, v129
    v_mfma_f32_32x32x16_bf16 a[112:127], a[236:239], v[120:123], a[112:127]
    v_add_f32 v138, v138, v128
    v_add_f32 v139, v139, v129
    s_waitcnt lgkmcnt(8)
    v_mfma_f32_32x32x16_bf16 a[0:15], a[240:243], v[116:119], a[0:15]
    ds_read_b128 a[224:227], v241 offset:16384
    buffer_load_dwordx4 v242, s[16:19], s42 offen offset:3072 sc1 lds
    s_add_u32 s42, s42, 34048
    v_exp_f32 v132, v28
    v_mfma_f32_32x32x16_bf16 a[64:79], a[240:243], v[124:127], a[64:79]
    v_exp_f32 v133, v29
    v_cvt_pk_bf16_f32 v109, v130, v131
    v_add_f32 v138, v138, v130
    v_mfma_f32_32x32x16_bf16 a[16:31], a[244:247], v[116:119], a[16:31]
    ds_read_b128 a[228:231], v241 offset:18432
    v_add_f32 v139, v139, v131
    v_exp_f32 v134, v30
    v_mfma_f32_32x32x16_bf16 a[80:95], a[244:247], v[124:127], a[80:95]
    s_sub_u32 s27, s27, 1
    s_cbranch_scc1 kf_l2p23
kf_l2r24:
    v_exp_f32 v135, v31
    v_mfma_f32_32x32x16_bf16 a[32:47], a[248:251], v[116:119], a[32:47]
    ds_read_b128 a[232:235], v241 offset:20480
    v_cvt_pk_bf16_f32 v110, v132, v133
    v_add_f32 v138, v138, v132
    v_mfma_f32_32x32x16_bf16 a[96:111], a[248:251], v[124:127], a[96:111]
    v_add_f32 v139, v139, v133
    v_cvt_pk_bf16_f32 v111, v134, v135
    v_add_f32 v138, v138, v134
    v_mfma_f32_32x32x16_bf16 a[48:63], a[252:255], v[116:119], a[48:63]
    ds_read_b128 a[236:239], v241 offset:22528
    v_add_f32 v139, v139, v135
    v_add_f32 v225, v138, v139
    v_cmp_lt_f32 vcc, s38, v225
    v_mfma_f32_32x32x16_bf16 a[112:127], a[252:255], v[124:127], a[112:127]
    s_cbranch_vccnz kf_rare28
kf_rr27:
    s_nop 7
    v_mov_b32 v230, v226
    s_nop 1
    v_permlane32_swap_b32 v226, v230
    s_nop 0
    v_add_f32 v230, v230, v226
    v_rcp_f32 v230, v230
    s_nop 0
    v_accvgpr_read_b32 v160, a0
    v_accvgpr_read_b32 v161, a1
    v_accvgpr_read_b32 v162, a2
    v_accvgpr_read_b32 v163, a3
    v_accvgpr_read_b32 v164, a4
    v_accvgpr_read_b32 v165, a5
    v_accvgpr_read_b32 v166, a6
    v_accvgpr_read_b32 v167, a7
    v_mul_f32 v160, v160, v230
    v_mul_f32 v161, v161, v230
    v_mul_f32 v162, v162, v230
    v_mul_f32 v163, v163, v230
    v_mul_f32 v164, v164, v230
    v_mul_f32 v165, v165, v230
    v_mul_f32 v166, v166, v230
    v_mul_f32 v167, v167, v230
    v_cvt_pk_bf16_f32 v176, v160, v161
    v_cvt_pk_bf16_f32 v177, v162, v163
    v_cvt_pk_bf16_f32 v178, v164, v165
    v_cvt_pk_bf16_f32 v179, v166, v167
    buffer_store_dwordx4 v[176:179], v244, s[20:23], s39 offen offset:0 sc1
    v_accvgpr_read_b32 v168, a8
    v_accvgpr_read_b32 v169, a9
    v_accvgpr_read_b32 v170, a10
    v_accvgpr_read_b32 v171, a11
    v_accvgpr_read_b32 v172, a12
    v_accvgpr_read_b32 v173, a13
    v_accvgpr_read_b32 v174, a14
    v_accvgpr_read_b32 v175, a15
    v_mul_f32 v168, v168, v230
    v_mul_f32 v169, v169, v230
    v_mul_f32 v170, v170, v230
    v_mul_f32 v171, v171, v230
    v_mul_f32 v172, v172, v230
    v_mul_f32 v173, v173, v230
    v_mul_f32 v174, v174, v230
    v_mul_f32 v175, v175, v230
    v_cvt_pk_bf16_f32 v180, v168, v169
    v_cvt_pk_bf16_f32 v181, v170, v171
    v_cvt_pk_bf16_f32 v182, v172, v173
    v_cvt_pk_bf16_f32 v183, v174, v175
    buffer_store_dwordx4 v[180:183], v244, s[20:23], s39 offen offset:512 sc1
    v_accvgpr_read_b32 v160, a16
    v_accvgpr_read_b32 v161, a17
    v_accvgpr_read_b32 v162, a18
    v_accvgpr_read_b32 v163, a19
    v_accvgpr_read_b32 v164, a20
    v_accvgpr_read_b32 v165, a21
    v_accvgpr_read_b32 v166, a22
    v_accvgpr_read_b32 v167, a23
    v_mul_f32 v160, v160, v230
    v_mul_f32 v161, v161, v230
    v_mul_f32 v162, v162, v230
    v_mul_f32 v163, v163, v230
    v_mul_f32 v164, v164, v230
    v_mul_f32 v165, v165, v230
    v_mul_f32 v166, v166, v230
    v_mul_f32 v167, v167, v230
    v_cvt_pk_bf16_f32 v184, v160, v161
    v_cvt_pk_bf16_f32 v185, v162, v163
    v_cvt_pk_bf16_f32 v186, v164, v165
    v_cvt_pk_bf16_f32 v187, v166, v167
    buffer_store_dwordx4 v[184:187], v244, s[20:23], s39 offen offset:1024 sc1
    v_accvgpr_read_b32 v168, a24
    v_accvgpr_read_b32 v169, a25
    v_accvgpr_read_b32 v170, a26
    v_accvgpr_read_b32 v171, a27
    v_accvgpr_read_b32 v172, a28
    v_accvgpr_read_b32 v173, a29
    v_accvgpr_read_b32 v174, a30
    v_accvgpr_read_b32 v175, a31
    v_mul_f32 v168, v168, v230
    v_mul_f32 v169, v169, v230
    v_mul_f32 v170, v170, v230
    v_mul_f32 v171, v171, v230
    v_mul_f32 v172, v172, v230
    v_mul_f32 v173, v173, v230
    v_mul_f32 v174, v174, v230
    v_mul_f32 v175, v175, v230
    v_cvt_pk_bf16_f32 v188, v168, v169
    v_cvt_pk_bf16_f32 v189, v170, v171
    v_cvt_pk_bf16_f32 v190, v172, v173
    v_cvt_pk_bf16_f32 v191, v174, v175
    buffer_store_dwordx4 v[188:191], v244, s[20:23], s39 offen offset:1536 sc1
    v_accvgpr_read_b32 v160, a32
    v_accvgpr_read_b32 v161, a33
    v_accvgpr_read_b32 v162, a34
    v_accvgpr_read_b32 v163, a35
    v_accvgpr_read_b32 v164, a36
    v_accvgpr_read_b32 v165, a37
    v_accvgpr_read_b32 v166, a38
    v_accvgpr_read_b32 v167, a39
    v_mul_f32 v160, v160, v230
    v_mul_f32 v161, v161, v230
    v_mul_f32 v162, v162, v230
    v_mul_f32 v163, v163, v230
    v_mul_f32 v164, v164, v230
    v_mul_f32 v165, v165, v230
    v_mul_f32 v166, v166, v230
    v_mul_f32 v167, v167, v230
    v_cvt_pk_bf16_f32 v176, v160, v161
    v_cvt_pk_bf16_f32 v177, v162, v163
    v_cvt_pk_bf16_f32 v178, v164, v165
    v_cvt_pk_bf16_f32 v179, v166, v167
    buffer_store_dwordx4 v[176:179], v244, s[20:23], s39 offen offset:2048 sc1
    v_accvgpr_read_b32 v168, a40
    v_accvgpr_read_b32 v169, a41
    v_accvgpr_read_b32 v170, a42
    v_accvgpr_read_b32 v171, a43
    v_accvgpr_read_b32 v172, a44
    v_accvgpr_read_b32 v173, a45
    v_accvgpr_read_b32 v174, a46
    v_accvgpr_read_b32 v175, a47
    v_mul_f32 v168, v168, v230
    v_mul_f32 v169, v169, v230
    v_mul_f32 v170, v170, v230
    v_mul_f32 v171, v171, v230
    v_mul_f32 v172, v172, v230
    v_mul_f32 v173, v173, v230
    v_mul_f32 v174, v174, v230
    v_mul_f32 v175, v175, v230
    v_cvt_pk_bf16_f32 v180, v168, v169
    v_cvt_pk_bf16_f32 v181, v170, v171
    v_cvt_pk_bf16_f32 v182, v172, v173
    v_cvt_pk_bf16_f32 v183, v174, v175
    buffer_store_dwordx4 v[180:183], v244, s[20:23], s39 offen offset:2560 sc1
    v_accvgpr_read_b32 v160, a48
    v_accvgpr_read_b32 v161, a49
    v_accvgpr_read_b32 v162, a50
    v_accvgpr_read_b32 v163, a51
    v_accvgpr_read_b32 v164, a52
    v_accvgpr_read_b32 v165, a53
    v_accvgpr_read_b32 v166, a54
    v_accvgpr_read_b32 v167, a55
    v_mul_f32 v160, v160, v230
    v_mul_f32 v161, v161, v230
    v_mul_f32 v162, v162, v230
    v_mul_f32 v163, v163, v230
    v_mul_f32 v164, v164, v230
    v_mul_f32 v165, v165, v230
    v_mul_f32 v166, v166, v230
    v_mul_f32 v167, v167, v230
    v_cvt_pk_bf16_f32 v184, v160, v161
    v_cvt_pk_bf16_f32 v185, v162, v163
    v_cvt_pk_bf16_f32 v186, v164, v165
    v_cvt_pk_bf16_f32 v187, v166, v167
    buffer_store_dwordx4 v[184:187], v244, s[20:23], s39 offen offset:3072 sc1
    v_accvgpr_read_b32 v168, a56
    v_accvgpr_read_b32 v169, a57
    v_accvgpr_read_b32 v170, a58
    v_accvgpr_read_b32 v171, a59
    v_accvgpr_read_b32 v172, a60
    v_accvgpr_read_b32 v173, a61
    v_accvgpr_read_b32 v174, a62
    v_accvgpr_read_b32 v175, a63
    v_mul_f32 v168, v168, v230
    v_mul_f32 v169, v169, v230
    v_mul_f32 v170, v170, v230
    v_mul_f32 v171, v171, v230
    v_mul_f32 v172, v172, v230
    v_mul_f32 v173, v173, v230
    v_mul_f32 v174, v174, v230
    v_mul_f32 v175, v175, v230
    v_cvt_pk_bf16_f32 v188, v168, v169
    v_cvt_pk_bf16_f32 v189, v170, v171
    v_cvt_pk_bf16_f32 v190, v172, v173
    v_cvt_pk_bf16_f32 v191, v174, v175
    buffer_store_dwordx4 v[188:191], v244, s[20:23], s39 offen offset:3584 sc1
    s_lshl_b32 s26, s5, 2
    s_sub_u32 s26, 28, s26
.p2align 3
ka_p2:
    s_sub_u32 s36, s36, 1
    s_cbranch_scc1 kf_fix29
kf_fixr30:
    s_waitcnt lgkmcnt(8)
    v_mfma_f32_32x32x16_bf16 v[16:31], a[192:195], a[160:163], v[80:95]
    ds_read_b128 a[240:243], v241 offset:16896
    v_add_f32 v227, v227, v225
    v_exp_f32 v138, v48
    v_exp_f32 v139, v49
    v_mfma_f32_32x32x16_bf16 v[16:31], a[196:199], a[164:167], v[16:31]
    ds_read_b128 a[244:247], v241 offset:18944
    s_mov_b32 m0, s34
    s_add_u32 s41, s42, 17664
    v_exp_f32 v130, v50
    v_mfma_f32_32x32x16_bf16 v[16:31], a[200:203], a[168:171], v[16:31]
    ds_read_b128 a[248:251], v241 offset:20992
    v_exp_f32 v131, v51
    v_cvt_pk_bf16_f32 v120, v138, v139
    v_exp_f32 v132, v52
    v_mfma_f32_32x32x16_bf16 v[16:31], a[204:207], a[172:175], v[16:31]
    ds_read_b128 a[252:255], v241 offset:23040
    buffer_load_dwordx4 v242, s[16:19], s41 offen offset:0 sc1 lds
    v_exp_f32 v133, v53
    s_waitcnt lgkmcnt(8)
    v_mfma_f32_32x32x16_bf16 v[16:31], a[208:211], a[176:179], v[16:31]
    ds_read_b128 a[192:195], v241 offset:8192
    v_cvt_pk_bf16_f32 v121, v130, v131
    v_add_f32 v138, v138, v130
    v_add_f32 v139, v139, v131
    v_exp_f32 v134, v54
    v_mfma_f32_32x32x16_bf16 v[16:31], a[212:215], a[180:183], v[16:31]
    ds_read_b128 a[196:199], v241 offset:8704
    v_exp_f32 v135, v55
    v_cvt_pk_bf16_f32 v122, v132, v133
    v_mfma_f32_32x32x16_bf16 v[16:31], a[216:219], a[184:187], v[16:31]
    ds_read_b128 a[200:203], v241 offset:10240
    buffer_load_dwordx4 v242, s[16:19], s41 offen offset:1024 sc1 lds
    v_add_f32 v138, v138, v132
    v_add_f32 v139, v139, v133
    v_exp_f32 v128, v56
    v_mfma_f32_32x32x16_bf16 v[16:31], a[220:223], a[188:191], v[16:31]
    ds_read_b128 a[204:207], v241 offset:10752
    v_exp_f32 v129, v57
    v_cvt_pk_bf16_f32 v123, v134, v135
    s_waitcnt lgkmcnt(8)
    v_mfma_f32_32x32x16_bf16 a[64:79], a[224:227], v[104:107], a[64:79]
    ds_read_b128 a[208:211], v241 offset:12288
    v_add_f32 v138, v138, v134
    v_add_f32 v139, v139, v135
    v_exp_f32 v130, v58
    v_mfma_f32_32x32x16_bf16 a[80:95], a[228:231], v[104:107], a[80:95]
    ds_read_b128 a[212:215], v241 offset:12800
    buffer_load_dwordx4 v242, s[16:19], s41 offen offset:2048 sc1 lds
    v_exp_f32 v131, v59
    v_cvt_pk_bf16_f32 v124, v128, v129
    v_add_f32 v138, v138, v128
    v_mfma_f32_32x32x16_bf16 a[96:111], a[232:235], v[104:107], a[96:111]
    ds_read_b128 a[216:219], v241 offset:14336
    v_add_f32 v139, v139, v129
    v_exp_f32 v132, v60
    v_exp_f32 v133, v61
    v_mfma_f32_32x32x16_bf16 a[112:127], a[236:239], v[104:107], a[112:127]
    ds_read_b128 a[220:223], v241 offset:14848
    v_cvt_pk_bf16_f32 v125, v130, v131
    v_add_f32 v138, v138, v130
    v_add_f32 v139, v139, v131
    s_waitcnt lgkmcnt(8)
    v_mfma_f32_32x32x16_bf16 a[64:79], a[240:243], v[108:111], a[64:79]
    ds_read_b128 a[224:227], v241 offset:24576
    buffer_load_dwordx4 v242, s[16:19], s41 offen offset:3072 sc1 lds
    v_exp_f32 v134, v62
    v_exp_f32 v135, v63
    v_mfma_f32_32x32x16_bf16 a[80:95], a[244:247], v[108:111], a[80:95]
    ds_read_b128 a[228:231], v241 offset:26624
    v_cvt_pk_bf16_f32 v126, v132, v133
    v_add_f32 v138, v138, v132
    v_add_f32 v139, v139, v133
    v_cvt_pk_bf16_f32 v127, v134, v135
    v_mfma_f32_32x32x16_bf16 a[96:111], a[248:251], v[108:111], a[96:111]
    ds_read_b128 a[232:235], v241 offset:28672
    v_add_f32 v138, v138, v134
    v_add_f32 v139, v139, v135
    v_add_f32 v225, v138, v139
    v_cmp_lt_f32 vcc, s38, v225
    v_mfma_f32_32x32x16_bf16 a[112:127], a[252:255], v[108:111], a[112:127]
    ds_read_b128 a[236:239], v241 offset:30720
    s_cbranch_vccnz kf_rare32
kf_rr31:
    s_sub_u32 s36, s36, 1
    s_cbranch_scc1 kf_fix35
kf_fixr36:
    s_waitcnt lgkmcnt(8)
    v_mfma_f32_32x32x16_bf16 v[48:63], a[192:195], a[160:163], v[80:95]
    ds_read_b128 a[240:243], v241 offset:25088
    v_add_f32 v227, v227, v225
    v_exp_f32 v138, v16
    v_exp_f32 v139, v17
    v_mfma_f32_32x32x16_bf16 v[48:63], a[196:199], a[164:167], v[48:63]
    ds_read_b128 a[244:247], v241 offset:27136
    s_add_u32 m0, s34, 16384
    s_add_u32 s34, s34, 32768
    s_cmp_ge_u32 s34, 163840
    s_cselect_b32 s34, s37, s34
    v_exp_f32 v130, v18
    v_mfma_f32_32x32x16_bf16 v[48:63], a[200:203], a[168:171], v[48:63]
    ds_read_b128 a[248:251], v241 offset:29184
    v_exp_f32 v131, v19
    v_cvt_pk_bf16_f32 v104, v138, v139
    v_exp_f32 v132, v20
    v_mfma_f32_32x32x16_bf16 v[48:63], a[204:207], a[172:175], v[48:63]
    ds_read_b128 a[252:255], v241 offset:31232
    buffer_load_dwordx4 v242, s[16:19], s42 offen offset:0 sc1 lds
    v_exp_f32 v133, v21
    v_cvt_pk_bf16_f32 v105, v130, v131
    s_waitcnt lgkmcnt(8)
    v_mfma_f32_32x32x16_bf16 v[48:63], a[208:211], a[176:179], v[48:63]
    s_waitcnt vmcnt(13)
    s_barrier
    s_add_u32 s35, s35, 32768
    s_cmp_ge_u32 s35, 163840
    s_cselect_b32 s35, 0, s35
    v_add_u32 v241, s35, v239
    ds_read_b128 a[192:195], v241 offset:0
    v_mfma_f32_32x32x16_bf16 v[48:63], a[212:215], a[180:183], v[48:63]
    ds_read_b128 a[196:199], v241 offset:512
    buffer_load_dwordx4 v242, s[16:19], s42 offen offset:1024 sc1 lds
    v_add_f32 v138, v138, v130
    v_add_f32 v139, v139, v131
    v_exp_f32 v134, v22
    v_mfma_f32_32x32x16_bf16 v[48:63], a[216:219], a[184:187], v[48:63]
    ds_read_b128 a[200:203], v241 offset:2048
    v_exp_f32 v135, v23
    v_cvt_pk_bf16_f32 v106, v132, v133
    v_add_f32 v138, v138, v132
    v_add_f32 v139, v139, v133
    v_mfma_f32_32x32x16_bf16 v[48:63], a[220:223], a[188:191], v[48:63]
    ds_read_b128 a[204:207], v241 offset:2560
    v_exp_f32 v128, v24
    v_exp_f32 v129, v25
    s_waitcnt lgkmcnt(8)
    v_mfma_f32_32x32x16_bf16 a[64:79], a[224:227], v[120:123], a[64:79]
    ds_read_b128 a[208:211], v241 offset:4096
    buffer_load_dwordx4 v242, s[16:19], s42 offen offset:2048 sc1 lds
    v_cvt_pk_bf16_f32 v107, v134, v135
    v_add_f32 v138, v138, v134
    v_add_f32 v139, v139, v135
    v_exp_f32 v130, v26
    v_mfma_f32_32x32x16_bf16 a[80:95], a[228:231], v[120:123], a[80:95]
    ds_read_b128 a[212:215], v241 offset:4608
    v_exp_f32 v131, v27
    v_cvt_pk_bf16_f32 v108, v128, v129
    v_add_f32 v138, v138, v128
    v_mfma_f32_32x32x16_bf16 a[96:111], a[232:235], v[120:123], a[96:111]
    ds_read_b128 a[216:219], v241 offset:6144
    buffer_load_dwordx4 v242, s[16:19], s42 offen offset:3072 sc1 lds
    s_add_u32 s42, s42, 34048
    v_add_f32 v139, v139, v129
    v_exp_f32 v132, v28
    v_mfma_f32_32x32x16_bf16 a[112:127], a[236:239], v[120:123], a[112:127]
    ds_read_b128 a[220:223], v241 offset:6656
    v_exp_f32 v133, v29
    v_cvt_pk_bf16_f32 v109, v130, v131
    v_add_f32 v138, v138, v130
    v_add_f32 v139, v139, v131
    s_waitcnt lgkmcnt(8)
    v_mfma_f32_32x32x16_bf16 a[64:79], a[240:243], v[124:127], a[64:79]
    ds_read_b128 a[224:227], v241 offset:16384
    s_sub_u32 s27, s27, 1
    s_cbranch_scc1 kf_l2p33
kf_l2r34:
    v_exp_f32 v134, v30
    v_mfma_f32_32x32x16_bf16 a[80:95], a[244:247], v[124:127], a[80:95]
    ds_read_b128 a[228:231], v241 offset:18432
    v_exp_f32 v135, v31
    v_cvt_pk_bf16_f32 v110, v132, v133
    v_add_f32 v138, v138, v132
    v_add_f32 v139, v139, v133
    v_mfma_f32_32x32x16_bf16 a[96:111], a[248:251], v[124:127], a[96:111]
    ds_read_b128 a[232:235], v241 offset:20480
    v_cvt_pk_bf16_f32 v111, v134, v135
    v_add_f32 v138, v138, v134
    v_add_f32 v139, v139, v135
    v_add_f32 v225, v138, v139
    v_cmp_lt_f32 vcc, s38, v225
    v_mfma_f32_32x32x16_bf16 a[112:127], a[252:255], v[124:127], a[112:127]
    ds_read_b128 a[236:239], v241 offset:22528
    s_cbranch_vccnz kf_rare38
kf_rr37:
    s_sub_u32 s26, s26, 1
    s_cbranch_scc0 ka_p2
    s_waitcnt lgkmcnt(0)
    ds_read_b128 a[224:227], v241 offset:16384
    ds_read_b128 a[228:231], v241 offset:18432
    ds_read_b128 a[232:235], v241 offset:20480
    ds_read_b128 a[236:239], v241 offset:22528
    ds_read_b128 a[240:243], v241 offset:16896
    ds_read_b128 a[244:247], v241 offset:18944
    ds_read_b128 a[248:251], v241 offset:20992
    ds_read_b128 a[252:255], v241 offset:23040
    ds_read_b128 a[192:195], v241 offset:24576
    ds_read_b128 a[196:199], v241 offset:26624
    ds_read_b128 a[200:203], v241 offset:28672
    ds_read_b128 a[204:207], v241 offset:30720
    ds_read_b128 a[208:211], v241 offset:25088
    ds_read_b128 a[212:215], v241 offset:27136
    ds_read_b128 a[216:219], v241 offset:29184
    s_waitcnt lgkmcnt(7)
    ds_read_b128 a[220:223], v241 offset:31232
    v_mfma_f32_32x32x16_bf16 a[64:79], a[224:227], v[104:107], a[64:79]
    v_add_f32 v227, v227, v225
    v_exp_f32 v138, v48
    v_exp_f32 v139, v49
    v_exp_f32 v130, v50
    v_exp_f32 v131, v51
    v_mfma_f32_32x32x16_bf16 a[80:95], a[228:231], v[104:107], a[80:95]
    v_cvt_pk_bf16_f32 v120, v138, v139
    v_exp_f32 v132, v52
    v_exp_f32 v133, v53
    v_cvt_pk_bf16_f32 v121, v130, v131
    v_add_f32 v138, v138, v130
    v_mfma_f32_32x32x16_bf16 a[96:111], a[232:235], v[104:107], a[96:111]
    v_add_f32 v139, v139, v131
    v_exp_f32 v134, v54
    v_exp_f32 v135, v55
    v_cvt_pk_bf16_f32 v122, v132, v133
    v_add_f32 v138, v138, v132
    v_add_f32 v139, v139, v133
    v_mfma_f32_32x32x16_bf16 a[112:127], a[236:239], v[104:107], a[112:127]
    v_exp_f32 v128, v56
    v_exp_f32 v129, v57
    v_cvt_pk_bf16_f32 v123, v134, v135
    v_add_f32 v138, v138, v134
    v_add_f32 v139, v139, v135
    v_exp_f32 v130, v58
    v_mfma_f32_32x32x16_bf16 a[64:79], a[240:243], v[108:111], a[64:79]
    v_exp_f32 v131, v59
    v_cvt_pk_bf16_f32 v124, v128, v129
    v_add_f32 v138, v138, v128
    v_add_f32 v139, v139, v129
    v_exp_f32 v132, v60
    v_mfma_f32_32x32x16_bf16 a[80:95], a[244:247], v[108:111], a[80:95]
    v_exp_f32 v133, v61
    v_cvt_pk_bf16_f32 v125, v130, v131
    v_add_f32 v138, v138, v130
    v_add_f32 v139, v139, v131
    v_exp_f32 v134, v62
    v_exp_f32 v135, v63
    v_mfma_f32_32x32x16_bf16 a[96:111], a[248:251], v[108:111], a[96:111]
    v_cvt_pk_bf16_f32 v126, v132, v133
    v_add_f32 v138, v138, v132
    v_add_f32 v139, v139, v133
    v_cvt_pk_bf16_f32 v127, v134, v135
    v_add_f32 v138, v138, v134
    v_add_f32 v139, v139, v135
    v_add_f32 v225, v138, v139
    v_cmp_lt_f32 vcc, s38, v225
    v_mfma_f32_32x32x16_bf16 a[112:127], a[252:255], v[108:111], a[112:127]
    s_cbranch_vccnz kf_rare40
kf_rr39:
    s_waitcnt lgkmcnt(0)
    v_add_f32 v227, v227, v225
    s_nop 0
    v_mfma_f32_32x32x16_bf16 a[64:79], a[192:195], v[120:123], a[64:79]
    v_mfma_f32_32x32x16_bf16 a[80:95], a[196:199], v[120:123], a[80:95]
    v_mfma_f32_32x32x16_bf16 a[96:111], a[200:203], v[120:123], a[96:111]
    v_mfma_f32_32x32x16_bf16 a[112:127], a[204:207], v[120:123], a[112:127]
    v_mfma_f32_32x32x16_bf16 a[64:79], a[208:211], v[124:127], a[64:79]
    v_mfma_f32_32x32x16_bf16 a[80:95], a[212:215], v[124:127], a[80:95]
    v_mfma_f32_32x32x16_bf16 a[96:111], a[216:219], v[124:127], a[96:111]
    v_mfma_f32_32x32x16_bf16 a[112:127], a[220:223], v[124:127], a[112:127]
    s_nop 7
    s_nop 7
    v_mov_b32 v230, v227
    s_nop 1
    v_permlane32_swap_b32 v227, v230
    s_nop 0
    v_add_f32 v230, v230, v227
    v_rcp_f32 v230, v230
    s_nop 0
    v_accvgpr_read_b32 v160, a64
    v_accvgpr_read_b32 v161, a65
    v_accvgpr_read_b32 v162, a66
    v_accvgpr_read_b32 v163, a67
    v_accvgpr_read_b32 v164, a68
    v_accvgpr_read_b32 v165, a69
    v_accvgpr_read_b32 v166, a70
    v_accvgpr_read_b32 v167, a71
    v_mul_f32 v160, v160, v230
    v_mul_f32 v161, v161, v230
    v_mul_f32 v162, v162, v230
    v_mul_f32 v163, v163, v230
    v_mul_f32 v164, v164, v230
    v_mul_f32 v165, v165, v230
    v_mul_f32 v166, v166, v230
    v_mul_f32 v167, v167, v230
    v_cvt_pk_bf16_f32 v176, v160, v161
    v_cvt_pk_bf16_f32 v177, v162, v163
    v_cvt_pk_bf16_f32 v178, v164, v165
    v_cvt_pk_bf16_f32 v179, v166, v167
    buffer_store_dwordx4 v[176:179], v244, s[20:23], s40 offen offset:0 sc1
    v_accvgpr_read_b32 v168, a72
    v_accvgpr_read_b32 v169, a73
    v_accvgpr_read_b32 v170, a74
    v_accvgpr_read_b32 v171, a75
    v_accvgpr_read_b32 v172, a76
    v_accvgpr_read_b32 v173, a77
    v_accvgpr_read_b32 v174, a78
    v_accvgpr_read_b32 v175, a79
    v_mul_f32 v168, v168, v230
    v_mul_f32 v169, v169, v230
    v_mul_f32 v170, v170, v230
    v_mul_f32 v171, v171, v230
    v_mul_f32 v172, v172, v230
    v_mul_f32 v173, v173, v230
    v_mul_f32 v174, v174, v230
    v_mul_f32 v175, v175, v230
    v_cvt_pk_bf16_f32 v180, v168, v169
    v_cvt_pk_bf16_f32 v181, v170, v171
    v_cvt_pk_bf16_f32 v182, v172, v173
    v_cvt_pk_bf16_f32 v183, v174, v175
    buffer_store_dwordx4 v[180:183], v244, s[20:23], s40 offen offset:512 sc1
    v_accvgpr_read_b32 v160, a80
    v_accvgpr_read_b32 v161, a81
    v_accvgpr_read_b32 v162, a82
    v_accvgpr_read_b32 v163, a83
    v_accvgpr_read_b32 v164, a84
    v_accvgpr_read_b32 v165, a85
    v_accvgpr_read_b32 v166, a86
    v_accvgpr_read_b32 v167, a87
    v_mul_f32 v160, v160, v230
    v_mul_f32 v161, v161, v230
    v_mul_f32 v162, v162, v230
    v_mul_f32 v163, v163, v230
    v_mul_f32 v164, v164, v230
    v_mul_f32 v165, v165, v230
    v_mul_f32 v166, v166, v230
    v_mul_f32 v167, v167, v230
    v_cvt_pk_bf16_f32 v184, v160, v161
    v_cvt_pk_bf16_f32 v185, v162, v163
    v_cvt_pk_bf16_f32 v186, v164, v165
    v_cvt_pk_bf16_f32 v187, v166, v167
    buffer_store_dwordx4 v[184:187], v244, s[20:23], s40 offen offset:1024 sc1
    v_accvgpr_read_b32 v168, a88
    v_accvgpr_read_b32 v169, a89
    v_accvgpr_read_b32 v170, a90
    v_accvgpr_read_b32 v171, a91
    v_accvgpr_read_b32 v172, a92
    v_accvgpr_read_b32 v173, a93
    v_accvgpr_read_b32 v174, a94
    v_accvgpr_read_b32 v175, a95
    v_mul_f32 v168, v168, v230
    v_mul_f32 v169, v169, v230
    v_mul_f32 v170, v170, v230
    v_mul_f32 v171, v171, v230
    v_mul_f32 v172, v172, v230
    v_mul_f32 v173, v173, v230
    v_mul_f32 v174, v174, v230
    v_mul_f32 v175, v175, v230
    v_cvt_pk_bf16_f32 v188, v168, v169
    v_cvt_pk_bf16_f32 v189, v170, v171
    v_cvt_pk_bf16_f32 v190, v172, v173
    v_cvt_pk_bf16_f32 v191, v174, v175
    buffer_store_dwordx4 v[188:191], v244, s[20:23], s40 offen offset:1536 sc1
    v_accvgpr_read_b32 v160, a96
    v_accvgpr_read_b32 v161, a97
    v_accvgpr_read_b32 v162, a98
    v_accvgpr_read_b32 v163, a99
    v_accvgpr_read_b32 v164, a100
    v_accvgpr_read_b32 v165, a101
    v_accvgpr_read_b32 v166, a102
    v_accvgpr_read_b32 v167, a103
    v_mul_f32 v160, v160, v230
    v_mul_f32 v161, v161, v230
    v_mul_f32 v162, v162, v230
    v_mul_f32 v163, v163, v230
    v_mul_f32 v164, v164, v230
    v_mul_f32 v165, v165, v230
    v_mul_f32 v166, v166, v230
    v_mul_f32 v167, v167, v230
    v_cvt_pk_bf16_f32 v176, v160, v161
    v_cvt_pk_bf16_f32 v177, v162, v163
    v_cvt_pk_bf16_f32 v178, v164, v165
    v_cvt_pk_bf16_f32 v179, v166, v167
    buffer_store_dwordx4 v[176:179], v244, s[20:23], s40 offen offset:2048 sc1
    v_accvgpr_read_b32 v168, a104
    v_accvgpr_read_b32 v169, a105
    v_accvgpr_read_b32 v170, a106
    v_accvgpr_read_b32 v171, a107
    v_accvgpr_read_b32 v172, a108
    v_accvgpr_read_b32 v173, a109
    v_accvgpr_read_b32 v174, a110
    v_accvgpr_read_b32 v175, a111
    v_mul_f32 v168, v168, v230
    v_mul_f32 v169, v169, v230
    v_mul_f32 v170, v170, v230
    v_mul_f32 v171, v171, v230
    v_mul_f32 v172, v172, v230
    v_mul_f32 v173, v173, v230
    v_mul_f32 v174, v174, v230
    v_mul_f32 v175, v175, v230
    v_cvt_pk_bf16_f32 v180, v168, v169
    v_cvt_pk_bf16_f32 v181, v170, v171
    v_cvt_pk_bf16_f32 v182, v172, v173
    v_cvt_pk_bf16_f32 v183, v174, v175
    buffer_store_dwordx4 v[180:183], v244, s[20:23], s40 offen offset:2560 sc1
    v_accvgpr_read_b32 v160, a112
    v_accvgpr_read_b32 v161, a113
    v_accvgpr_read_b32 v162, a114
    v_accvgpr_read_b32 v163, a115
    v_accvgpr_read_b32 v164, a116
    v_accvgpr_read_b32 v165, a117
    v_accvgpr_read_b32 v166, a118
    v_accvgpr_read_b32 v167, a119
    v_mul_f32 v160, v160, v230
    v_mul_f32 v161, v161, v230
    v_mul_f32 v162, v162, v230
    v_mul_f32 v163, v163, v230
    v_mul_f32 v164, v164, v230
    v_mul_f32 v165, v165, v230
    v_mul_f32 v166, v166, v230
    v_mul_f32 v167, v167, v230
    v_cvt_pk_bf16_f32 v184, v160, v161
    v_cvt_pk_bf16_f32 v185, v162, v163
    v_cvt_pk_bf16_f32 v186, v164, v165
    v_cvt_pk_bf16_f32 v187, v166, v167
    buffer_store_dwordx4 v[184:187], v244, s[20:23], s40 offen offset:3072 sc1
    v_accvgpr_read_b32 v168, a120
    v_accvgpr_read_b32 v169, a121
    v_accvgpr_read_b32 v170, a122
    v_accvgpr_read_b32 v171, a123
    v_accvgpr_read_b32 v172, a124
    v_accvgpr_read_b32 v173, a125
    v_accvgpr_read_b32 v174, a126
    v_accvgpr_read_b32 v175, a127
    v_mul_f32 v168, v168, v230
    v_mul_f32 v169, v169, v230
    v_mul_f32 v170, v170, v230
    v_mul_f32 v171, v171, v230
    v_mul_f32 v172, v172, v230
    v_mul_f32 v173, v173, v230
    v_mul_f32 v174, v174, v230
    v_mul_f32 v175, v175, v230
    v_cvt_pk_bf16_f32 v188, v168, v169
    v_cvt_pk_bf16_f32 v189, v170, v171
    v_cvt_pk_bf16_f32 v190, v172, v173
    v_cvt_pk_bf16_f32 v191, v174, v175
    buffer_store_dwordx4 v[188:191], v244, s[20:23], s40 offen offset:3584 sc1
    s_load_dwordx2 s[40:41], s[0:1], 0
    s_load_dwordx2 s[42:43], s[0:1], 40
    s_load_dwordx2 s[44:45], s[0:1], 56
    s_load_dwordx2 s[46:47], s[0:1], 104
    s_load_dwordx4 s[60:63], s[0:1], 80
    v_mbcnt_lo_u32_b32 v237, -1, 0
    v_mbcnt_hi_u32_b32 v237, -1, v237
    s_lshl_b32 s32, s3, 6
    v_add_u32 v230, s32, v237
    s_lshr_b32 s53, s2, 3
    s_lshr_b32 s6, s2, 1
    s_and_b32 s6, s6, 3
    s_and_b32 s4, s2, 1
    s_lshl_b32 s4, s4, 2
    s_and_b32 s33, s53, 3
    s_add_u32 s4, s4, s33
    s_lshr_b32 s5, s53, 2
    v_lshlrev_b32 v228, 4, v237
    v_lshrrev_b32 v234, 4, v237
    v_and_b32 v235, 15, v237
    v_lshlrev_b32 v236, 1, v234
    v_xor_b32 v235, v235, v236
    v_lshlrev_b32 v234, 11, v234
    s_lshl_b32 s32, s3, 14
    s_lshl_b32 s33, s5, 8
    s_add_u32 s32, s32, s33
    v_add_u32 v234, s32, v234
    v_lshl_add_u32 v224, v235, 4, v234
    v_xor_b32 v235, 8, v235
    v_lshl_add_u32 v225, v235, 4, v234
    v_add_u32 v225, 7168, v225
    s_lshl_b32 s37, s6, 21
    s_lshl_b32 s38, s3, 11
    s_and_b32 s32, s6, 2
    s_lshl2_add_u32 s32, s3, s32
    s_lshl_b32 s32, s32, 17
    v_add_u32 v226, s32, v228
    v_add_u32 v227, 0x20000, v226
    v_xor_b32 v245, 0x40000, v226
    v_xor_b32 v246, 0x40000, v227
    s_lshl_b32 s35, s4, 21
    s_lshl_b32 s32, s6, 15
    s_add_u32 s35, s35, s32
    s_add_u32 s35, s35, 0x2400000
    s_getpc_b64 s[56:57]
kc_pc0:
    s_mov_b32 s58, kc_end-kc_pc0
    s_mov_b32 s59, 0x00020000
    v_lshlrev_b32 v234, 7, v230
    buffer_load_dword v241, v234, s[56:59], 0 offen
    s_waitcnt lgkmcnt(0)
    s_mov_b32 s8, s46
    s_mov_b32 s9, s47
    s_mov_b32 s10, 0x10000000
    s_mov_b32 s11, 0x00020000
    s_mov_b32 s12, s42
    s_mov_b32 s13, s43
    s_mov_b32 s14, 0x800000
    s_mov_b32 s15, 0x00020000
    s_mov_b32 s16, s40
    s_mov_b32 s17, s41
    s_mov_b32 s18, 0x400000
    s_mov_b32 s19, 0x00020000
    s_mov_b32 s20, s44
    s_mov_b32 s21, s45
    s_mov_b32 s22, 0x800
    s_mov_b32 s23, 0x00020000
    s_mov_b32 s24, s60
    s_mov_b32 s25, s61
    s_mov_b32 s26, 0x700000
    s_mov_b32 s27, 0x00020000
    s_mov_b32 s28, s62
    s_mov_b32 s29, s63
    s_mov_b32 s30, 0x400000
    s_mov_b32 s31, 0x00020000
    s_lshr_b32 s44, s6, 1
    s_and_b32 s6, s6, 1
    v_bfe_u32 v234, v237, 2, 3
    v_lshrrev_b32 v235, 5, v237
    v_lshl_add_u32 v235, v235, 4, v234
    v_lshlrev_b32 v235, 8, v235
    v_and_b32 v236, 1, v237
    v_lshl_add_u32 v235, v236, 3, v235
    v_lshlrev_b32 v234, 1, v234
    v_bfe_u32 v236, v237, 1, 1
    v_or_b32 v234, v234, v236
    s_lshl_b32 s32, s6, 3
    v_xor_b32 v234, s32, v234
    v_xor_b32 v236, 0, v234
    v_lshl_add_u32 v216, v236, 4, v235
    v_xor_b32 v236, 2, v234
    v_lshl_add_u32 v217, v236, 4, v235
    v_xor_b32 v236, 4, v234
    v_lshl_add_u32 v218, v236, 4, v235
    v_xor_b32 v236, 6, v234
    v_lshl_add_u32 v219, v236, 4, v235
    v_xor_b32 v236, 8, v234
    v_lshl_add_u32 v220, v236, 4, v235
    v_xor_b32 v236, 10, v234
    v_lshl_add_u32 v221, v236, 4, v235
    v_xor_b32 v236, 12, v234
    v_lshl_add_u32 v222, v236, 4, v235
    v_xor_b32 v236, 14, v234
    v_lshl_add_u32 v223, v236, 4, v235
    s_lshl2_add_u32 s32, s4, s3
    s_lshl1_add_u32 s32, s32, s44
    s_lshl_b32 s44, s32, 5
    v_lshrrev_b32 v234, 3, v237
    v_add_u32 v242, s44, v234
    v_and_b32 v235, 7, v237
    s_lshl1_add_u32 s33, s5, s6
    s_lshl_b32 s33, s33, 7
    v_lshl_add_u32 v240, v235, 4, s33
    v_lshl_add_u32 v229, v242, 11, v240
    s_mul_i32 s32, s3, 4608
    s_add_u32 s32, s32, 131072
    v_mul_u32_u24 v234, 144, v234
    v_lshl_add_u32 v234, v235, 4, v234
    v_add_u32 v239, s32, v234
    v_and_b32 v234, 15, v237
    v_mul_u32_u24 v234, 144, v234
    v_lshrrev_b32 v236, 4, v237
    v_lshl_add_u32 v234, v236, 3, v234
    v_add_u32 v238, s32, v234
    v_and_b32 v234, 3, v237
    v_lshl_add_u32 v234, v234, 3, v242
    v_lshlrev_b32 v234, 2, v234
    v_lshrrev_b32 v235, 2, v235
    v_lshl_add_u32 v231, v235, 13, v234
    v_lshlrev_b32 v235, 30, v235
    v_add_u32 v235, 16384, v235
    v_add_u32 v232, v235, v234
    s_cmp_eq_u32 s44, 0
    s_cselect_b32 s32, 4, 64
    v_cmp_eq_u32 vcc, s32, v237
    v_mov_b32 v235, 24576
    v_mov_b32 v233, 1
    v_cndmask_b32 v232, v232, v235, vcc
    v_and_b32 v234, 1, v237
    v_cmp_ne_u32 s[60:61], 0, v234
    v_and_b32 v234, 2, v237
    v_cmp_ne_u32 s[62:63], 0, v234
    v_and_b32 v234, 4, v237
    v_cmp_ne_u32 s[40:41], 0, v234
    v_cmp_eq_u32 vcc, 0, v237
    v_mov_b32 v235, 0x40000000
    s_nop 0
    v_cndmask_b32 v243, v235, v237, vcc
    s_lshl2_add_u32 s39, s2, s3
    s_mov_b32 s48, 0x3800000
    s_mov_b32 s49, 0x3802000
    s_mov_b32 s50, 0x3804000
    s_and_b32 s52, s2, 7
    s_mul_i32 s54, s52, 28
    s_add_u32 s54, s54, s53
    v_lshrrev_b32 v234, 3, v237
    v_lshlrev_b32 v234, 11, v234
    v_and_b32 v235, 7, v237
    v_lshl_add_u32 v244, v235, 4, v234
    s_lshl_b32 s55, s54, 16
    s_lshl_b32 s32, s3, 13
    s_add_u32 s55, s55, s32
    s_add_u32 s55, s55, 0x4000000
    s_lshl_b32 s51, s54, 15
    s_lshl_b32 s32, s3, 9
    s_add_u32 s51, s51, s32
    s_cmp_ge_u32 s53, 28
    s_cselect_b32 s55, 0x40000000, s55
    s_cselect_b32 s51, 0x40000000, s51
    s_waitcnt vmcnt(0)
    s_barrier
    s_cmp_lg_u32 s3, 0
    s_cbranch_scc1 kc_a0
    s_lshl_b32 s32, s52, 7
    s_add_u32 s32, s32, 0x38a1000
    v_mov_b32 v235, 1
    buffer_atomic_add v235, v243, s[8:11], s32 offen sc0 sc1
    v_lshlrev_b32 v234, 7, v237
    v_cmp_gt_u32 vcc, 8, v237
    v_mov_b32 v236, 0x40000000
    s_mov_b32 s34, 0x38a1400
    v_cndmask_b32 v234, v236, v234, vcc
    s_waitcnt vmcnt(0)
    v_readfirstlane_b32 s36, v235
    s_cmp_lg_u32 s36, 31
    s_cbranch_scc1 kc_a0
    buffer_atomic_add v233, v234, s[8:11], s34 offen sc1
kc_a0:
    s_add_u32 m0, s38, 0
    s_add_u32 s32, s37, 0
    buffer_load_dwordx4 v224, s[12:15], s32 offen lds
    buffer_load_dwordx4 v225, s[12:15], s32 offen offset:1024 lds
    s_add_u32 m0, s38, 8192
    s_add_u32 s32, s37, 65536
    buffer_load_dwordx4 v224, s[12:15], s32 offen lds
    buffer_load_dwordx4 v225, s[12:15], s32 offen offset:1024 lds
    s_add_u32 m0, s38, 16384
    s_add_u32 s32, s37, 131072
    buffer_load_dwordx4 v224, s[12:15], s32 offen lds
    buffer_load_dwordx4 v225, s[12:15], s32 offen offset:1024 lds
    s_add_u32 m0, s38, 24576
    s_add_u32 s32, s37, 196608
    buffer_load_dwordx4 v224, s[12:15], s32 offen lds
    buffer_load_dwordx4 v225, s[12:15], s32 offen offset:1024 lds
    s_add_u32 m0, s38, 32768
    s_add_u32 s32, s37, 262144
    buffer_load_dwordx4 v224, s[12:15], s32 offen lds
    buffer_load_dwordx4 v225, s[12:15], s32 offen offset:1024 lds
    s_add_u32 m0, s38, 40960
    s_add_u32 s32, s37, 327680
    buffer_load_dwordx4 v224, s[12:15], s32 offen lds
    buffer_load_dwordx4 v225, s[12:15], s32 offen offset:1024 lds
    s_add_u32 m0, s38, 49152
    s_add_u32 s32, s37, 393216
    buffer_load_dwordx4 v224, s[12:15], s32 offen lds
    buffer_load_dwordx4 v225, s[12:15], s32 offen offset:1024 lds
    s_add_u32 m0, s38, 57344
    s_add_u32 s32, s37, 458752
    buffer_load_dwordx4 v224, s[12:15], s32 offen lds
    buffer_load_dwordx4 v225, s[12:15], s32 offen offset:1024 lds
    s_add_u32 m0, s38, 65536
    s_add_u32 s32, s37, 524288
    buffer_load_dwordx4 v224, s[12:15], s32 offen lds
    buffer_load_dwordx4 v225, s[12:15], s32 offen offset:1024 lds
    s_add_u32 m0, s38, 73728
    s_add_u32 s32, s37, 589824
    buffer_load_dwordx4 v224, s[12:15], s32 offen lds
    buffer_load_dwordx4 v225, s[12:15], s32 offen offset:1024 lds
    s_add_u32 m0, s38, 81920
    s_add_u32 s32, s37, 655360
    buffer_load_dwordx4 v224, s[12:15], s32 offen lds
    buffer_load_dwordx4 v225, s[12:15], s32 offen offset:1024 lds
    s_add_u32 m0, s38, 90112
    s_add_u32 s32, s37, 720896
    buffer_load_dwordx4 v224, s[12:15], s32 offen lds
    buffer_load_dwordx4 v225, s[12:15], s32 offen offset:1024 lds
    s_add_u32 m0, s38, 98304
    s_add_u32 s32, s37, 786432
    buffer_load_dwordx4 v224, s[12:15], s32 offen lds
    buffer_load_dwordx4 v225, s[12:15], s32 offen offset:1024 lds
    s_add_u32 m0, s38, 106496
    s_add_u32 s32, s37, 851968
    buffer_load_dwordx4 v224, s[12:15], s32 offen lds
    buffer_load_dwordx4 v225, s[12:15], s32 offen offset:1024 lds
    s_add_u32 m0, s38, 114688
    s_add_u32 s32, s37, 917504
    buffer_load_dwordx4 v224, s[12:15], s32 offen lds
    buffer_load_dwordx4 v225, s[12:15], s32 offen offset:1024 lds
    s_add_u32 m0, s38, 122880
    s_add_u32 s32, s37, 983040
    buffer_load_dwordx4 v224, s[12:15], s32 offen lds
    buffer_load_dwordx4 v225, s[12:15], s32 offen offset:1024 lds
    s_add_u32 s33, s51, 0
    buffer_load_dwordx4 a[192:195], v244, s[24:27], s33 offen offset:0
    s_add_u32 s33, s51, 16384
    buffer_load_dwordx4 a[196:199], v244, s[24:27], s33 offen offset:0
    s_add_u32 s33, s51, 0
    buffer_load_dwordx4 a[200:203], v244, s[24:27], s33 offen offset:128
    s_add_u32 s33, s51, 16384
    buffer_load_dwordx4 a[204:207], v244, s[24:27], s33 offen offset:128
    s_add_u32 s33, s51, 0
    buffer_load_dwordx4 a[208:211], v244, s[24:27], s33 offen offset:256
    s_add_u32 s33, s51, 16384
    buffer_load_dwordx4 a[212:215], v244, s[24:27], s33 offen offset:256
    s_add_u32 s33, s51, 0
    buffer_load_dwordx4 a[216:219], v244, s[24:27], s33 offen offset:384
    s_add_u32 s33, s51, 16384
    buffer_load_dwordx4 a[220:223], v244, s[24:27], s33 offen offset:384
    s_cmp_lg_u32 s3, 0
    s_cbranch_scc1 kc_b02
    s_lshl_b32 s32, s52, 7
    s_add_u32 s32, s32, 0x38a1400
    s_mov_b32 s34, 0x400000
    s_branch kc_b01
kc_b00:
    s_sleep 2
kc_b01:
    buffer_load_dword v235, off, s[8:11], s32 sc1
    s_waitcnt vmcnt(0)
    v_cmp_ne_u32 vcc, 8, v235
    s_sub_u32 s34, s34, 1
    s_cbranch_scc1 kc_b02
    s_cbranch_vccnz kc_b00
kc_b02:
    s_waitcnt vmcnt(9)
    s_barrier
    buffer_load_dwordx4 a[0:3], v226, s[8:11], s35 offen offset:0 sc1
    buffer_load_dwordx4 a[4:7], v227, s[8:11], s35 offen offset:0 sc1
    buffer_load_dwordx4 a[8:11], v245, s[8:11], s35 offen offset:0 sc1
    buffer_load_dwordx4 a[12:15], v246, s[8:11], s35 offen offset:0 sc1
    buffer_load_dwordx4 a[16:19], v226, s[8:11], s35 offen offset:1024 sc1
    buffer_load_dwordx4 a[20:23], v227, s[8:11], s35 offen offset:1024 sc1
    buffer_load_dwordx4 a[24:27], v245, s[8:11], s35 offen offset:1024 sc1
    buffer_load_dwordx4 a[28:31], v246, s[8:11], s35 offen offset:1024 sc1
    buffer_load_dwordx4 a[32:35], v226, s[8:11], s35 offen offset:2048 sc1
    buffer_load_dwordx4 a[36:39], v227, s[8:11], s35 offen offset:2048 sc1
    buffer_load_dwordx4 a[40:43], v245, s[8:11], s35 offen offset:2048 sc1
    buffer_load_dwordx4 a[44:47], v246, s[8:11], s35 offen offset:2048 sc1
    buffer_load_dwordx4 a[48:51], v226, s[8:11], s35 offen offset:3072 sc1
    buffer_load_dwordx4 a[52:55], v227, s[8:11], s35 offen offset:3072 sc1
    buffer_load_dwordx4 a[56:59], v245, s[8:11], s35 offen offset:3072 sc1
    buffer_load_dwordx4 a[60:63], v246, s[8:11], s35 offen offset:3072 sc1
    ds_read_b64_tr_b16 v[128:129], v216 offset:0
    ds_read_b64_tr_b16 v[130:131], v216 offset:2048
    ds_read_b64_tr_b16 v[132:133], v217 offset:0
    ds_read_b64_tr_b16 v[134:135], v217 offset:2048
    ds_read_b64_tr_b16 v[136:137], v218 offset:0
    ds_read_b64_tr_b16 v[138:139], v218 offset:2048
    ds_read_b64_tr_b16 v[140:141], v219 offset:0
    ds_read_b64_tr_b16 v[142:143], v219 offset:2048
    s_waitcnt vmcnt(12) lgkmcnt(0)
    v_mfma_f32_16x16x32_bf16 v[32:35], v[128:131], a[0:3], 0
    ds_read_b64_tr_b16 v[144:145], v220 offset:0
    v_mfma_f32_16x16x32_bf16 v[36:39], v[128:131], a[4:7], 0
    ds_read_b64_tr_b16 v[146:147], v220 offset:2048
    v_mfma_f32_16x16x32_bf16 v[64:67], v[128:131], a[8:11], 0
    ds_read_b64_tr_b16 v[148:149], v221 offset:0
    v_mfma_f32_16x16x32_bf16 v[68:71], v[128:131], a[12:15], 0
    ds_read_b64_tr_b16 v[150:151], v221 offset:2048
    v_mfma_f32_16x16x32_bf16 v[40:43], v[132:135], a[0:3], 0
    ds_read_b64_tr_b16 v[152:153], v222 offset:0
    v_mfma_f32_16x16x32_bf16 v[44:47], v[132:135], a[4:7], 0
    ds_read_b64_tr_b16 v[154:155], v222 offset:2048
    v_mfma_f32_16x16x32_bf16 v[72:75], v[132:135], a[8:11], 0
    ds_read_b64_tr_b16 v[156:157], v223 offset:0
    v_mfma_f32_16x16x32_bf16 v[76:79], v[132:135], a[12:15], 0
    ds_read_b64_tr_b16 v[158:159], v223 offset:2048
    v_mfma_f32_16x16x32_bf16 v[48:51], v[136:139], a[0:3], 0
    s_add_u32 s35, s35, 4096
    buffer_load_dwordx4 a[64:67], v226, s[8:11], s35 offen offset:0 sc1
    v_mfma_f32_16x16x32_bf16 v[52:55], v[136:139], a[4:7], 0
    v_mfma_f32_16x16x32_bf16 v[80:83], v[136:139], a[8:11], 0
    v_mfma_f32_16x16x32_bf16 v[84:87], v[136:139], a[12:15], 0
    buffer_load_dwordx4 a[68:71], v227, s[8:11], s35 offen offset:0 sc1
    v_mfma_f32_16x16x32_bf16 v[56:59], v[140:143], a[0:3], 0
    v_mfma_f32_16x16x32_bf16 v[60:63], v[140:143], a[4:7], 0
    v_mfma_f32_16x16x32_bf16 v[88:91], v[140:143], a[8:11], 0
    v_mfma_f32_16x16x32_bf16 v[92:95], v[140:143], a[12:15], 0
    s_waitcnt lgkmcnt(0)
    v_mfma_f32_16x16x32_bf16 v[0:3], v[144:147], a[0:3], 0
    ds_read_b64_tr_b16 v[128:129], v216 offset:8192
    v_mfma_f32_16x16x32_bf16 v[4:7], v[144:147], a[4:7], 0
    ds_read_b64_tr_b16 v[130:131], v216 offset:10240
    v_mfma_f32_16x16x32_bf16 v[96:99], v[144:147], a[8:11], 0
    ds_read_b64_tr_b16 v[132:133], v217 offset:8192
    v_mfma_f32_16x16x32_bf16 v[100:103], v[144:147], a[12:15], 0
    ds_read_b64_tr_b16 v[134:135], v217 offset:10240
    v_mfma_f32_16x16x32_bf16 v[8:11], v[148:151], a[0:3], 0
    ds_read_b64_tr_b16 v[136:137], v218 offset:8192
    v_mfma_f32_16x16x32_bf16 v[12:15], v[148:151], a[4:7], 0
    ds_read_b64_tr_b16 v[138:139], v218 offset:10240
    v_mfma_f32_16x16x32_bf16 v[104:107], v[148:151], a[8:11], 0
    ds_read_b64_tr_b16 v[140:141], v219 offset:8192
    v_mfma_f32_16x16x32_bf16 v[108:111], v[148:151], a[12:15], 0
    ds_read_b64_tr_b16 v[142:143], v219 offset:10240
    v_mfma_f32_16x16x32_bf16 v[16:19], v[152:155], a[0:3], 0
    buffer_load_dwordx4 a[72:75], v245, s[8:11], s35 offen offset:0 sc1
    v_mfma_f32_16x16x32_bf16 v[20:23], v[152:155], a[4:7], 0
    v_mfma_f32_16x16x32_bf16 v[112:115], v[152:155], a[8:11], 0
    v_mfma_f32_16x16x32_bf16 v[116:119], v[152:155], a[12:15], 0
    v_mfma_f32_16x16x32_bf16 v[24:27], v[156:159], a[0:3], 0
    buffer_load_dwordx4 a[76:79], v246, s[8:11], s35 offen offset:0 sc1
    v_mfma_f32_16x16x32_bf16 v[28:31], v[156:159], a[4:7], 0
    v_mfma_f32_16x16x32_bf16 v[120:123], v[156:159], a[8:11], 0
    v_mfma_f32_16x16x32_bf16 v[124:127], v[156:159], a[12:15], 0
    buffer_load_dwordx4 a[80:83], v226, s[8:11], s35 offen offset:1024 sc1
    s_waitcnt vmcnt(13) lgkmcnt(0)
    v_mfma_f32_16x16x32_bf16 v[32:35], v[128:131], a[16:19], v[32:35]
    ds_read_b64_tr_b16 v[144:145], v220 offset:8192
    v_mfma_f32_16x16x32_bf16 v[36:39], v[128:131], a[20:23], v[36:39]
    ds_read_b64_tr_b16 v[146:147], v220 offset:10240
    v_mfma_f32_16x16x32_bf16 v[64:67], v[128:131], a[24:27], v[64:67]
    ds_read_b64_tr_b16 v[148:149], v221 offset:8192
    v_mfma_f32_16x16x32_bf16 v[68:71], v[128:131], a[28:31], v[68:71]
    ds_read_b64_tr_b16 v[150:151], v221 offset:10240
    v_mfma_f32_16x16x32_bf16 v[40:43], v[132:135], a[16:19], v[40:43]
    ds_read_b64_tr_b16 v[152:153], v222 offset:8192
    v_mfma_f32_16x16x32_bf16 v[44:47], v[132:135], a[20:23], v[44:47]
    ds_read_b64_tr_b16 v[154:155], v222 offset:10240
    v_mfma_f32_16x16x32_bf16 v[72:75], v[132:135], a[24:27], v[72:75]
    ds_read_b64_tr_b16 v[156:157], v223 offset:8192
    v_mfma_f32_16x16x32_bf16 v[76:79], v[132:135], a[28:31], v[76:79]
    ds_read_b64_tr_b16 v[158:159], v223 offset:10240
    v_mfma_f32_16x16x32_bf16 v[48:51], v[136:139], a[16:19], v[48:51]
    buffer_load_dwordx4 a[84:87], v227, s[8:11], s35 offen offset:1024 sc1
    v_mfma_f32_16x16x32_bf16 v[52:55], v[136:139], a[20:23], v[52:55]
    v_mfma_f32_16x16x32_bf16 v[80:83], v[136:139], a[24:27], v[80:83]
    v_mfma_f32_16x16x32_bf16 v[84:87], v[136:139], a[28:31], v[84:87]
    buffer_load_dwordx4 a[88:91], v245, s[8:11], s35 offen offset:1024 sc1
    v_mfma_f32_16x16x32_bf16 v[56:59], v[140:143], a[16:19], v[56:59]
    v_mfma_f32_16x16x32_bf16 v[60:63], v[140:143], a[20:23], v[60:63]
    v_mfma_f32_16x16x32_bf16 v[88:91], v[140:143], a[24:27], v[88:91]
    v_mfma_f32_16x16x32_bf16 v[92:95], v[140:143], a[28:31], v[92:95]
    s_waitcnt lgkmcnt(0)
    v_mfma_f32_16x16x32_bf16 v[0:3], v[144:147], a[16:19], v[0:3]
    ds_read_b64_tr_b16 v[128:129], v216 offset:16384
    v_mfma_f32_16x16x32_bf16 v[4:7], v[144:147], a[20:23], v[4:7]
    ds_read_b64_tr_b16 v[130:131], v216 offset:18432
    v_mfma_f32_16x16x32_bf16 v[96:99], v[144:147], a[24:27], v[96:99]
    ds_read_b64_tr_b16 v[132:133], v217 offset:16384
    v_mfma_f32_16x16x32_bf16 v[100:103], v[144:147], a[28:31], v[100:103]
    ds_read_b64_tr_b16 v[134:135], v217 offset:18432
    v_mfma_f32_16x16x32_bf16 v[8:11], v[148:151], a[16:19], v[8:11]
    ds_read_b64_tr_b16 v[136:137], v218 offset:16384
    v_mfma_f32_16x16x32_bf16 v[12:15], v[148:151], a[20:23], v[12:15]
    ds_read_b64_tr_b16 v[138:139], v218 offset:18432
    v_mfma_f32_16x16x32_bf16 v[104:107], v[148:151], a[24:27], v[104:107]
    ds_read_b64_tr_b16 v[140:141], v219 offset:16384
    v_mfma_f32_16x16x32_bf16 v[108:111], v[148:151], a[28:31], v[108:111]
    ds_read_b64_tr_b16 v[142:143], v219 offset:18432
    v_mfma_f32_16x16x32_bf16 v[16:19], v[152:155], a[16:19], v[16:19]
    buffer_load_dwordx4 a[92:95], v246, s[8:11], s35 offen offset:1024 sc1
    v_mfma_f32_16x16x32_bf16 v[20:23], v[152:155], a[20:23], v[20:23]
    v_mfma_f32_16x16x32_bf16 v[112:115], v[152:155], a[24:27], v[112:115]
    v_mfma_f32_16x16x32_bf16 v[116:119], v[152:155], a[28:31], v[116:119]
    v_mfma_f32_16x16x32_bf16 v[24:27], v[156:159], a[16:19], v[24:27]
    buffer_load_dwordx4 a[96:99], v226, s[8:11], s35 offen offset:2048 sc1
    v_mfma_f32_16x16x32_bf16 v[28:31], v[156:159], a[20:23], v[28:31]
    v_mfma_f32_16x16x32_bf16 v[120:123], v[156:159], a[24:27], v[120:123]
    v_mfma_f32_16x16x32_bf16 v[124:127], v[156:159], a[28:31], v[124:127]
    s_waitcnt vmcnt(13) lgkmcnt(0)
    v_mfma_f32_16x16x32_bf16 v[32:35], v[128:131], a[32:35], v[32:35]
    ds_read_b64_tr_b16 v[144:145], v220 offset:16384
    v_mfma_f32_16x16x32_bf16 v[36:39], v[128:131], a[36:39], v[36:39]
    ds_read_b64_tr_b16 v[146:147], v220 offset:18432
    v_mfma_f32_16x16x32_bf16 v[64:67], v[128:131], a[40:43], v[64:67]
    ds_read_b64_tr_b16 v[148:149], v221 offset:16384
    v_mfma_f32_16x16x32_bf16 v[68:71], v[128:131], a[44:47], v[68:71]
    ds_read_b64_tr_b16 v[150:151], v221 offset:18432
    v_mfma_f32_16x16x32_bf16 v[40:43], v[132:135], a[32:35], v[40:43]
    ds_read_b64_tr_b16 v[152:153], v222 offset:16384
    v_mfma_f32_16x16x32_bf16 v[44:47], v[132:135], a[36:39], v[44:47]
    ds_read_b64_tr_b16 v[154:155], v222 offset:18432
    v_mfma_f32_16x16x32_bf16 v[72:75], v[132:135], a[40:43], v[72:75]
    ds_read_b64_tr_b16 v[156:157], v223 offset:16384
    v_mfma_f32_16x16x32_bf16 v[76:79], v[132:135], a[44:47], v[76:79]
    ds_read_b64_tr_b16 v[158:159], v223 offset:18432
    v_mfma_f32_16x16x32_bf16 v[48:51], v[136:139], a[32:35], v[48:51]
    buffer_load_dwordx4 a[100:103], v227, s[8:11], s35 offen offset:2048 sc1
    v_mfma_f32_16x16x32_bf16 v[52:55], v[136:139], a[36:39], v[52:55]
    v_mfma_f32_16x16x32_bf16 v[80:83], v[136:139], a[40:43], v[80:83]
    v_mfma_f32_16x16x32_bf16 v[84:87], v[136:139], a[44:47], v[84:87]
    buffer_load_dwordx4 a[104:107], v245, s[8:11], s35 offen offset:2048 sc1
    v_mfma_f32_16x16x32_bf16 v[56:59], v[140:143], a[32:35], v[56:59]
    v_mfma_f32_16x16x32_bf16 v[60:63], v[140:143], a[36:39], v[60:63]
    v_mfma_f32_16x16x32_bf16 v[88:91], v[140:143], a[40:43], v[88:91]
    v_mfma_f32_16x16x32_bf16 v[92:95], v[140:143], a[44:47], v[92:95]
    s_waitcnt lgkmcnt(0)
    v_mfma_f32_16x16x32_bf16 v[0:3], v[144:147], a[32:35], v[0:3]
    ds_read_b64_tr_b16 v[128:129], v216 offset:24576
    v_mfma_f32_16x16x32_bf16 v[4:7], v[144:147], a[36:39], v[4:7]
    ds_read_b64_tr_b16 v[130:131], v216 offset:26624
    v_mfma_f32_16x16x32_bf16 v[96:99], v[144:147], a[40:43], v[96:99]
    ds_read_b64_tr_b16 v[132:133], v217 offset:24576
    v_mfma_f32_16x16x32_bf16 v[100:103], v[144:147], a[44:47], v[100:103]
    ds_read_b64_tr_b16 v[134:135], v217 offset:26624
    v_mfma_f32_16x16x32_bf16 v[8:11], v[148:151], a[32:35], v[8:11]
    ds_read_b64_tr_b16 v[136:137], v218 offset:24576
    v_mfma_f32_16x16x32_bf16 v[12:15], v[148:151], a[36:39], v[12:15]
    ds_read_b64_tr_b16 v[138:139], v218 offset:26624
    v_mfma_f32_16x16x32_bf16 v[104:107], v[148:151], a[40:43], v[104:107]
    ds_read_b64_tr_b16 v[140:141], v219 offset:24576
    v_mfma_f32_16x16x32_bf16 v[108:111], v[148:151], a[44:47], v[108:111]
    ds_read_b64_tr_b16 v[142:143], v219 offset:26624
    v_mfma_f32_16x16x32_bf16 v[16:19], v[152:155], a[32:35], v[16:19]
    buffer_load_dwordx4 a[108:111], v246, s[8:11], s35 offen offset:2048 sc1
    v_mfma_f32_16x16x32_bf16 v[20:23], v[152:155], a[36:39], v[20:23]
    v_mfma_f32_16x16x32_bf16 v[112:115], v[152:155], a[40:43], v[112:115]
    v_mfma_f32_16x16x32_bf16 v[116:119], v[152:155], a[44:47], v[116:119]
    v_mfma_f32_16x16x32_bf16 v[24:27], v[156:159], a[32:35], v[24:27]
    buffer_load_dwordx4 a[112:115], v226, s[8:11], s35 offen offset:3072 sc1
    v_mfma_f32_16x16x32_bf16 v[28:31], v[156:159], a[36:39], v[28:31]
    v_mfma_f32_16x16x32_bf16 v[120:123], v[156:159], a[40:43], v[120:123]
    v_mfma_f32_16x16x32_bf16 v[124:127], v[156:159], a[44:47], v[124:127]
    buffer_load_dwordx4 a[116:119], v227, s[8:11], s35 offen offset:3072 sc1
    s_waitcnt vmcnt(14) lgkmcnt(0)
    v_mfma_f32_16x16x32_bf16 v[32:35], v[128:131], a[48:51], v[32:35]
    ds_read_b64_tr_b16 v[144:145], v220 offset:24576
    v_mfma_f32_16x16x32_bf16 v[36:39], v[128:131], a[52:55], v[36:39]
    ds_read_b64_tr_b16 v[146:147], v220 offset:26624
    v_mfma_f32_16x16x32_bf16 v[64:67], v[128:131], a[56:59], v[64:67]
    ds_read_b64_tr_b16 v[148:149], v221 offset:24576
    v_mfma_f32_16x16x32_bf16 v[68:71], v[128:131], a[60:63], v[68:71]
    ds_read_b64_tr_b16 v[150:151], v221 offset:26624
    v_mfma_f32_16x16x32_bf16 v[40:43], v[132:135], a[48:51], v[40:43]
    ds_read_b64_tr_b16 v[152:153], v222 offset:24576
    v_mfma_f32_16x16x32_bf16 v[44:47], v[132:135], a[52:55], v[44:47]
    ds_read_b64_tr_b16 v[154:155], v222 offset:26624
    v_mfma_f32_16x16x32_bf16 v[72:75], v[132:135], a[56:59], v[72:75]
    ds_read_b64_tr_b16 v[156:157], v223 offset:24576
    v_mfma_f32_16x16x32_bf16 v[76:79], v[132:135], a[60:63], v[76:79]
    ds_read_b64_tr_b16 v[158:159], v223 offset:26624
    v_mfma_f32_16x16x32_bf16 v[48:51], v[136:139], a[48:51], v[48:51]
    buffer_load_dwordx4 a[120:123], v245, s[8:11], s35 offen offset:3072 sc1
    v_mfma_f32_16x16x32_bf16 v[52:55], v[136:139], a[52:55], v[52:55]
    v_mfma_f32_16x16x32_bf16 v[80:83], v[136:139], a[56:59], v[80:83]
    v_mfma_f32_16x16x32_bf16 v[84:87], v[136:139], a[60:63], v[84:87]
    buffer_load_dwordx4 a[124:127], v246, s[8:11], s35 offen offset:3072 sc1
    v_mfma_f32_16x16x32_bf16 v[56:59], v[140:143], a[48:51], v[56:59]
    v_mfma_f32_16x16x32_bf16 v[60:63], v[140:143], a[52:55], v[60:63]
    v_mfma_f32_16x16x32_bf16 v[88:91], v[140:143], a[56:59], v[88:91]
    v_mfma_f32_16x16x32_bf16 v[92:95], v[140:143], a[60:63], v[92:95]
    s_waitcnt lgkmcnt(0)
    s_barrier
    v_mfma_f32_16x16x32_bf16 v[0:3], v[144:147], a[48:51], v[0:3]
    ds_read_b64_tr_b16 v[128:129], v216 offset:32768
    v_mfma_f32_16x16x32_bf16 v[4:7], v[144:147], a[52:55], v[4:7]
    ds_read_b64_tr_b16 v[130:131], v216 offset:34816
    v_mfma_f32_16x16x32_bf16 v[96:99], v[144:147], a[56:59], v[96:99]
    ds_read_b64_tr_b16 v[132:133], v217 offset:32768
    v_mfma_f32_16x16x32_bf16 v[100:103], v[144:147], a[60:63], v[100:103]
    ds_read_b64_tr_b16 v[134:135], v217 offset:34816
    v_mfma_f32_16x16x32_bf16 v[8:11], v[148:151], a[48:51], v[8:11]
    ds_read_b64_tr_b16 v[136:137], v218 offset:32768
    v_mfma_f32_16x16x32_bf16 v[12:15], v[148:151], a[52:55], v[12:15]
    ds_read_b64_tr_b16 v[138:139], v218 offset:34816
    v_mfma_f32_16x16x32_bf16 v[104:107], v[148:151], a[56:59], v[104:107]
    ds_read_b64_tr_b16 v[140:141], v219 offset:32768
    v_mfma_f32_16x16x32_bf16 v[108:111], v[148:151], a[60:63], v[108:111]
    ds_read_b64_tr_b16 v[142:143], v219 offset:34816
    v_mfma_f32_16x16x32_bf16 v[16:19], v[152:155], a[48:51], v[16:19]
    s_add_u32 s35, s35, 4096
    buffer_load_dwordx4 a[0:3], v226, s[8:11], s35 offen offset:0 sc1
    v_mfma_f32_16x16x32_bf16 v[20:23], v[152:155], a[52:55], v[20:23]
    v_mfma_f32_16x16x32_bf16 v[112:115], v[152:155], a[56:59], v[112:115]
    v_mfma_f32_16x16x32_bf16 v[116:119], v[152:155], a[60:63], v[116:119]
    v_mfma_f32_16x16x32_bf16 v[24:27], v[156:159], a[48:51], v[24:27]
    buffer_load_dwordx4 a[4:7], v227, s[8:11], s35 offen offset:0 sc1
    v_mfma_f32_16x16x32_bf16 v[28:31], v[156:159], a[52:55], v[28:31]
    v_mfma_f32_16x16x32_bf16 v[120:123], v[156:159], a[56:59], v[120:123]
    v_mfma_f32_16x16x32_bf16 v[124:127], v[156:159], a[60:63], v[124:127]
    s_waitcnt vmcnt(14) lgkmcnt(0)
    v_mfma_f32_16x16x32_bf16 v[32:35], v[128:131], a[64:67], v[32:35]
    ds_read_b64_tr_b16 v[144:145], v220 offset:32768
    v_mfma_f32_16x16x32_bf16 v[36:39], v[128:131], a[68:71], v[36:39]
    ds_read_b64_tr_b16 v[146:147], v220 offset:34816
    v_mfma_f32_16x16x32_bf16 v[64:67], v[128:131], a[72:75], v[64:67]
    ds_read_b64_tr_b16 v[148:149], v221 offset:32768
    v_mfma_f32_16x16x32_bf16 v[68:71], v[128:131], a[76:79], v[68:71]
    ds_read_b64_tr_b16 v[150:151], v221 offset:34816
    v_mfma_f32_16x16x32_bf16 v[40:43], v[132:135], a[64:67], v[40:43]
    ds_read_b64_tr_b16 v[152:153], v222 offset:32768
    v_mfma_f32_16x16x32_bf16 v[44:47], v[132:135], a[68:71], v[44:47]
    ds_read_b64_tr_b16 v[154:155], v222 offset:34816
    v_mfma_f32_16x16x32_bf16 v[72:75], v[132:135], a[72:75], v[72:75]
    ds_read_b64_tr_b16 v[156:157], v223 offset:32768
    v_mfma_f32_16x16x32_bf16 v[76:79], v[132:135], a[76:79], v[76:79]
    ds_read_b64_tr_b16 v[158:159], v223 offset:34816
    v_mfma_f32_16x16x32_bf16 v[48:51], v[136:139], a[64:67], v[48:51]
    buffer_load_dwordx4 a[8:11], v245, s[8:11], s35 offen offset:0 sc1
    v_mfma_f32_16x16x32_bf16 v[52:55], v[136:139], a[68:71], v[52:55]
    s_add_u32 m0, s38, 0
    s_add_u32 s32, s37, 1048576
    v_mfma_f32_16x16x32_bf16 v[80:83], v[136:139], a[72:75], v[80:83]
    buffer_load_dwordx4 v224, s[12:15], s32 offen lds
    v_mfma_f32_16x16x32_bf16 v[84:87], v[136:139], a[76:79], v[84:87]
    buffer_load_dwordx4 a[12:15], v246, s[8:11], s35 offen offset:0 sc1
    v_mfma_f32_16x16x32_bf16 v[56:59], v[140:143], a[64:67], v[56:59]
    v_mfma_f32_16x16x32_bf16 v[60:63], v[140:143], a[68:71], v[60:63]
    buffer_load_dwordx4 v225, s[12:15], s32 offen offset:1024 lds
    v_mfma_f32_16x16x32_bf16 v[88:91], v[140:143], a[72:75], v[88:91]
    v_mfma_f32_16x16x32_bf16 v[92:95], v[140:143], a[76:79], v[92:95]
    s_waitcnt lgkmcnt(0)
    v_mfma_f32_16x16x32_bf16 v[0:3], v[144:147], a[64:67], v[0:3]
    ds_read_b64_tr_b16 v[128:129], v216 offset:40960
    v_mfma_f32_16x16x32_bf16 v[4:7], v[144:147], a[68:71], v[4:7]
    ds_read_b64_tr_b16 v[130:131], v216 offset:43008
    v_mfma_f32_16x16x32_bf16 v[96:99], v[144:147], a[72:75], v[96:99]
    ds_read_b64_tr_b16 v[132:133], v217 offset:40960
    v_mfma_f32_16x16x32_bf16 v[100:103], v[144:147], a[76:79], v[100:103]
    ds_read_b64_tr_b16 v[134:135], v217 offset:43008
    v_mfma_f32_16x16x32_bf16 v[8:11], v[148:151], a[64:67], v[8:11]
    ds_read_b64_tr_b16 v[136:137], v218 offset:40960
    v_mfma_f32_16x16x32_bf16 v[12:15], v[148:151], a[68:71], v[12:15]
    ds_read_b64_tr_b16 v[138:139], v218 offset:43008
    v_mfma_f32_16x16x32_bf16 v[104:107], v[148:151], a[72:75], v[104:107]
    ds_read_b64_tr_b16 v[140:141], v219 offset:40960
    v_mfma_f32_16x16x32_bf16 v[108:111], v[148:151], a[76:79], v[108:111]
    ds_read_b64_tr_b16 v[142:143], v219 offset:43008
    v_mfma_f32_16x16x32_bf16 v[16:19], v[152:155], a[64:67], v[16:19]
    buffer_load_dwordx4 a[16:19], v226, s[8:11], s35 offen offset:1024 sc1
    v_mfma_f32_16x16x32_bf16 v[20:23], v[152:155], a[68:71], v[20:23]
    v_mfma_f32_16x16x32_bf16 v[112:115], v[152:155], a[72:75], v[112:115]
    v_mfma_f32_16x16x32_bf16 v[116:119], v[152:155], a[76:79], v[116:119]
    v_mfma_f32_16x16x32_bf16 v[24:27], v[156:159], a[64:67], v[24:27]
    buffer_load_dwordx4 a[20:23], v227, s[8:11], s35 offen offset:1024 sc1
    v_mfma_f32_16x16x32_bf16 v[28:31], v[156:159], a[68:71], v[28:31]
    v_mfma_f32_16x16x32_bf16 v[120:123], v[156:159], a[72:75], v[120:123]
    v_mfma_f32_16x16x32_bf16 v[124:127], v[156:159], a[76:79], v[124:127]
    buffer_load_dwordx4 a[24:27], v245, s[8:11], s35 offen offset:1024 sc1
    s_waitcnt vmcnt(17) lgkmcnt(0)
    v_mfma_f32_16x16x32_bf16 v[32:35], v[128:131], a[80:83], v[32:35]
    ds_read_b64_tr_b16 v[144:145], v220 offset:40960
    v_mfma_f32_16x16x32_bf16 v[36:39], v[128:131], a[84:87], v[36:39]
    ds_read_b64_tr_b16 v[146:147], v220 offset:43008
    v_mfma_f32_16x16x32_bf16 v[64:67], v[128:131], a[88:91], v[64:67]
    ds_read_b64_tr_b16 v[148:149], v221 offset:40960
    v_mfma_f32_16x16x32_bf16 v[68:71], v[128:131], a[92:95], v[68:71]
    ds_read_b64_tr_b16 v[150:151], v221 offset:43008
    v_mfma_f32_16x16x32_bf16 v[40:43], v[132:135], a[80:83], v[40:43]
    ds_read_b64_tr_b16 v[152:153], v222 offset:40960
    v_mfma_f32_16x16x32_bf16 v[44:47], v[132:135], a[84:87], v[44:47]
    ds_read_b64_tr_b16 v[154:155], v222 offset:43008
    v_mfma_f32_16x16x32_bf16 v[72:75], v[132:135], a[88:91], v[72:75]
    ds_read_b64_tr_b16 v[156:157], v223 offset:40960
    v_mfma_f32_16x16x32_bf16 v[76:79], v[132:135], a[92:95], v[76:79]
    ds_read_b64_tr_b16 v[158:159], v223 offset:43008
    v_mfma_f32_16x16x32_bf16 v[48:51], v[136:139], a[80:83], v[48:51]
    buffer_load_dwordx4 a[28:31], v246, s[8:11], s35 offen offset:1024 sc1
    v_mfma_f32_16x16x32_bf16 v[52:55], v[136:139], a[84:87], v[52:55]
    s_add_u32 m0, s38, 8192
    s_add_u32 s32, s37, 1114112
    v_mfma_f32_16x16x32_bf16 v[80:83], v[136:139], a[88:91], v[80:83]
    buffer_load_dwordx4 v224, s[12:15], s32 offen lds
    v_mfma_f32_16x16x32_bf16 v[84:87], v[136:139], a[92:95], v[84:87]
    buffer_load_dwordx4 a[32:35], v226, s[8:11], s35 offen offset:2048 sc1
    v_mfma_f32_16x16x32_bf16 v[56:59], v[140:143], a[80:83], v[56:59]
    v_mfma_f32_16x16x32_bf16 v[60:63], v[140:143], a[84:87], v[60:63]
    buffer_load_dwordx4 v225, s[12:15], s32 offen offset:1024 lds
    v_mfma_f32_16x16x32_bf16 v[88:91], v[140:143], a[88:91], v[88:91]
    v_mfma_f32_16x16x32_bf16 v[92:95], v[140:143], a[92:95], v[92:95]
    s_waitcnt lgkmcnt(0)
    v_mfma_f32_16x16x32_bf16 v[0:3], v[144:147], a[80:83], v[0:3]
    ds_read_b64_tr_b16 v[128:129], v216 offset:49152
    v_mfma_f32_16x16x32_bf16 v[4:7], v[144:147], a[84:87], v[4:7]
    ds_read_b64_tr_b16 v[130:131], v216 offset:51200
    v_mfma_f32_16x16x32_bf16 v[96:99], v[144:147], a[88:91], v[96:99]
    ds_read_b64_tr_b16 v[132:133], v217 offset:49152
    v_mfma_f32_16x16x32_bf16 v[100:103], v[144:147], a[92:95], v[100:103]
    ds_read_b64_tr_b16 v[134:135], v217 offset:51200
    v_mfma_f32_16x16x32_bf16 v[8:11], v[148:151], a[80:83], v[8:11]
    ds_read_b64_tr_b16 v[136:137], v218 offset:49152
    v_mfma_f32_16x16x32_bf16 v[12:15], v[148:151], a[84:87], v[12:15]
    ds_read_b64_tr_b16 v[138:139], v218 offset:51200
    v_mfma_f32_16x16x32_bf16 v[104:107], v[148:151], a[88:91], v[104:107]
    ds_read_b64_tr_b16 v[140:141], v219 offset:49152
    v_mfma_f32_16x16x32_bf16 v[108:111], v[148:151], a[92:95], v[108:111]
    ds_read_b64_tr_b16 v[142:143], v219 offset:51200
    v_mfma_f32_16x16x32_bf16 v[16:19], v[152:155], a[80:83], v[16:19]
    buffer_load_dwordx4 a[36:39], v227, s[8:11], s35 offen offset:2048 sc1
    v_mfma_f32_16x16x32_bf16 v[20:23], v[152:155], a[84:87], v[20:23]
    v_mfma_f32_16x16x32_bf16 v[112:115], v[152:155], a[88:91], v[112:115]
    v_mfma_f32_16x16x32_bf16 v[116:119], v[152:155], a[92:95], v[116:119]
    v_mfma_f32_16x16x32_bf16 v[24:27], v[156:159], a[80:83], v[24:27]
    buffer_load_dwordx4 a[40:43], v245, s[8:11], s35 offen offset:2048 sc1
    v_mfma_f32_16x16x32_bf16 v[28:31], v[156:159], a[84:87], v[28:31]
    v_mfma_f32_16x16x32_bf16 v[120:123], v[156:159], a[88:91], v[120:123]
    v_mfma_f32_16x16x32_bf16 v[124:127], v[156:159], a[92:95], v[124:127]
    s_waitcnt vmcnt(19) lgkmcnt(0)
    v_mfma_f32_16x16x32_bf16 v[32:35], v[128:131], a[96:99], v[32:35]
    ds_read_b64_tr_b16 v[144:145], v220 offset:49152
    v_mfma_f32_16x16x32_bf16 v[36:39], v[128:131], a[100:103], v[36:39]
    ds_read_b64_tr_b16 v[146:147], v220 offset:51200
    v_mfma_f32_16x16x32_bf16 v[64:67], v[128:131], a[104:107], v[64:67]
    ds_read_b64_tr_b16 v[148:149], v221 offset:49152
    v_mfma_f32_16x16x32_bf16 v[68:71], v[128:131], a[108:111], v[68:71]
    ds_read_b64_tr_b16 v[150:151], v221 offset:51200
    v_mfma_f32_16x16x32_bf16 v[40:43], v[132:135], a[96:99], v[40:43]
    ds_read_b64_tr_b16 v[152:153], v222 offset:49152
    v_mfma_f32_16x16x32_bf16 v[44:47], v[132:135], a[100:103], v[44:47]
    ds_read_b64_tr_b16 v[154:155], v222 offset:51200
    v_mfma_f32_16x16x32_bf16 v[72:75], v[132:135], a[104:107], v[72:75]
    ds_read_b64_tr_b16 v[156:157], v223 offset:49152
    v_mfma_f32_16x16x32_bf16 v[76:79], v[132:135], a[108:111], v[76:79]
    ds_read_b64_tr_b16 v[158:159], v223 offset:51200
    v_mfma_f32_16x16x32_bf16 v[48:51], v[136:139], a[96:99], v[48:51]
    buffer_load_dwordx4 a[44:47], v246, s[8:11], s35 offen offset:2048 sc1
    v_mfma_f32_16x16x32_bf16 v[52:55], v[136:139], a[100:103], v[52:55]
    s_add_u32 m0, s38, 16384
    s_add_u32 s32, s37, 1179648
    v_mfma_f32_16x16x32_bf16 v[80:83], v[136:139], a[104:107], v[80:83]
    buffer_load_dwordx4 v224, s[12:15], s32 offen lds
    v_mfma_f32_16x16x32_bf16 v[84:87], v[136:139], a[108:111], v[84:87]
    buffer_load_dwordx4 a[48:51], v226, s[8:11], s35 offen offset:3072 sc1
    v_mfma_f32_16x16x32_bf16 v[56:59], v[140:143], a[96:99], v[56:59]
    v_mfma_f32_16x16x32_bf16 v[60:63], v[140:143], a[100:103], v[60:63]
    buffer_load_dwordx4 v225, s[12:15], s32 offen offset:1024 lds
    v_mfma_f32_16x16x32_bf16 v[88:91], v[140:143], a[104:107], v[88:91]
    v_mfma_f32_16x16x32_bf16 v[92:95], v[140:143], a[108:111], v[92:95]
    s_waitcnt lgkmcnt(0)
    v_mfma_f32_16x16x32_bf16 v[0:3], v[144:147], a[96:99], v[0:3]
    ds_read_b64_tr_b16 v[128:129], v216 offset:57344
    v_mfma_f32_16x16x32_bf16 v[4:7], v[144:147], a[100:103], v[4:7]
    ds_read_b64_tr_b16 v[130:131], v216 offset:59392
    v_mfma_f32_16x16x32_bf16 v[96:99], v[144:147], a[104:107], v[96:99]
    ds_read_b64_tr_b16 v[132:133], v217 offset:57344
    v_mfma_f32_16x16x32_bf16 v[100:103], v[144:147], a[108:111], v[100:103]
    ds_read_b64_tr_b16 v[134:135], v217 offset:59392
    v_mfma_f32_16x16x32_bf16 v[8:11], v[148:151], a[96:99], v[8:11]
    ds_read_b64_tr_b16 v[136:137], v218 offset:57344
    v_mfma_f32_16x16x32_bf16 v[12:15], v[148:151], a[100:103], v[12:15]
    ds_read_b64_tr_b16 v[138:139], v218 offset:59392
    v_mfma_f32_16x16x32_bf16 v[104:107], v[148:151], a[104:107], v[104:107]
    ds_read_b64_tr_b16 v[140:141], v219 offset:57344
    v_mfma_f32_16x16x32_bf16 v[108:111], v[148:151], a[108:111], v[108:111]
    ds_read_b64_tr_b16 v[142:143], v219 offset:59392
    v_mfma_f32_16x16x32_bf16 v[16:19], v[152:155], a[96:99], v[16:19]
    buffer_load_dwordx4 a[52:55], v227, s[8:11], s35 offen offset:3072 sc1
    v_mfma_f32_16x16x32_bf16 v[20:23], v[152:155], a[100:103], v[20:23]
    v_mfma_f32_16x16x32_bf16 v[112:115], v[152:155], a[104:107], v[112:115]
    v_mfma_f32_16x16x32_bf16 v[116:119], v[152:155], a[108:111], v[116:119]
    v_mfma_f32_16x16x32_bf16 v[24:27], v[156:159], a[96:99], v[24:27]
    buffer_load_dwordx4 a[56:59], v245, s[8:11], s35 offen offset:3072 sc1
    v_mfma_f32_16x16x32_bf16 v[28:31], v[156:159], a[100:103], v[28:31]
    v_mfma_f32_16x16x32_bf16 v[120:123], v[156:159], a[104:107], v[120:123]
    v_mfma_f32_16x16x32_bf16 v[124:127], v[156:159], a[108:111], v[124:127]
    buffer_load_dwordx4 a[60:63], v246, s[8:11], s35 offen offset:3072 sc1
    s_waitcnt vmcnt(22) lgkmcnt(0)
    v_mfma_f32_16x16x32_bf16 v[32:35], v[128:131], a[112:115], v[32:35]
    ds_read_b64_tr_b16 v[144:145], v220 offset:57344
    v_mfma_f32_16x16x32_bf16 v[36:39], v[128:131], a[116:119], v[36:39]
    ds_read_b64_tr_b16 v[146:147], v220 offset:59392
    v_mfma_f32_16x16x32_bf16 v[64:67], v[128:131], a[120:123], v[64:67]
    ds_read_b64_tr_b16 v[148:149], v221 offset:57344
    v_mfma_f32_16x16x32_bf16 v[68:71], v[128:131], a[124:127], v[68:71]
    ds_read_b64_tr_b16 v[150:151], v221 offset:59392
    v_mfma_f32_16x16x32_bf16 v[40:43], v[132:135], a[112:115], v[40:43]
    ds_read_b64_tr_b16 v[152:153], v222 offset:57344
    v_mfma_f32_16x16x32_bf16 v[44:47], v[132:135], a[116:119], v[44:47]
    ds_read_b64_tr_b16 v[154:155], v222 offset:59392
    v_mfma_f32_16x16x32_bf16 v[72:75], v[132:135], a[120:123], v[72:75]
    ds_read_b64_tr_b16 v[156:157], v223 offset:57344
    v_mfma_f32_16x16x32_bf16 v[76:79], v[132:135], a[124:127], v[76:79]
    ds_read_b64_tr_b16 v[158:159], v223 offset:59392
    v_mfma_f32_16x16x32_bf16 v[48:51], v[136:139], a[112:115], v[48:51]
    s_add_u32 s35, s35, 4096
    buffer_load_dwordx4 a[64:67], v226, s[8:11], s35 offen offset:0 sc1
    v_mfma_f32_16x16x32_bf16 v[52:55], v[136:139], a[116:119], v[52:55]
    s_add_u32 m0, s38, 24576
    s_add_u32 s32, s37, 1245184
    v_mfma_f32_16x16x32_bf16 v[80:83], v[136:139], a[120:123], v[80:83]
    buffer_load_dwordx4 v224, s[12:15], s32 offen lds
    v_mfma_f32_16x16x32_bf16 v[84:87], v[136:139], a[124:127], v[84:87]
    buffer_load_dwordx4 a[68:71], v227, s[8:11], s35 offen offset:0 sc1
    v_mfma_f32_16x16x32_bf16 v[56:59], v[140:143], a[112:115], v[56:59]
    v_mfma_f32_16x16x32_bf16 v[60:63], v[140:143], a[116:119], v[60:63]
    buffer_load_dwordx4 v225, s[12:15], s32 offen offset:1024 lds
    v_mfma_f32_16x16x32_bf16 v[88:91], v[140:143], a[120:123], v[88:91]
    v_mfma_f32_16x16x32_bf16 v[92:95], v[140:143], a[124:127], v[92:95]
    s_waitcnt lgkmcnt(0)
    s_barrier
    v_mfma_f32_16x16x32_bf16 v[0:3], v[144:147], a[112:115], v[0:3]
    v_xor_b32 v216, 0x10000, v216
    ds_read_b64_tr_b16 v[128:129], v216 offset:0
    v_mfma_f32_16x16x32_bf16 v[4:7], v[144:147], a[116:119], v[4:7]
    ds_read_b64_tr_b16 v[130:131], v216 offset:2048
    v_mfma_f32_16x16x32_bf16 v[96:99], v[144:147], a[120:123], v[96:99]
    v_xor_b32 v217, 0x10000, v217
    ds_read_b64_tr_b16 v[132:133], v217 offset:0
    v_mfma_f32_16x16x32_bf16 v[100:103], v[144:147], a[124:127], v[100:103]
    ds_read_b64_tr_b16 v[134:135], v217 offset:2048
    v_mfma_f32_16x16x32_bf16 v[8:11], v[148:151], a[112:115], v[8:11]
    v_xor_b32 v218, 0x10000, v218
    ds_read_b64_tr_b16 v[136:137], v218 offset:0
    v_mfma_f32_16x16x32_bf16 v[12:15], v[148:151], a[116:119], v[12:15]
    ds_read_b64_tr_b16 v[138:139], v218 offset:2048
    v_mfma_f32_16x16x32_bf16 v[104:107], v[148:151], a[120:123], v[104:107]
    v_xor_b32 v219, 0x10000, v219
    ds_read_b64_tr_b16 v[140:141], v219 offset:0
    v_mfma_f32_16x16x32_bf16 v[108:111], v[148:151], a[124:127], v[108:111]
    ds_read_b64_tr_b16 v[142:143], v219 offset:2048
    v_mfma_f32_16x16x32_bf16 v[16:19], v[152:155], a[112:115], v[16:19]
    buffer_load_dwordx4 a[72:75], v245, s[8:11], s35 offen offset:0 sc1
    v_mfma_f32_16x16x32_bf16 v[20:23], v[152:155], a[116:119], v[20:23]
    v_mfma_f32_16x16x32_bf16 v[112:115], v[152:155], a[120:123], v[112:115]
    v_mfma_f32_16x16x32_bf16 v[116:119], v[152:155], a[124:127], v[116:119]
    v_mfma_f32_16x16x32_bf16 v[24:27], v[156:159], a[112:115], v[24:27]
    buffer_load_dwordx4 a[76:79], v246, s[8:11], s35 offen offset:0 sc1
    v_mfma_f32_16x16x32_bf16 v[28:31], v[156:159], a[116:119], v[28:31]
    v_mfma_f32_16x16x32_bf16 v[120:123], v[156:159], a[120:123], v[120:123]
    v_mfma_f32_16x16x32_bf16 v[124:127], v[156:159], a[124:127], v[124:127]
    s_waitcnt vmcnt(23) lgkmcnt(0)
    v_mfma_f32_16x16x32_bf16 v[32:35], v[128:131], a[0:3], v[32:35]
    v_xor_b32 v220, 0x10000, v220
    ds_read_b64_tr_b16 v[144:145], v220 offset:0
    v_mfma_f32_16x16x32_bf16 v[36:39], v[128:131], a[4:7], v[36:39]
    ds_read_b64_tr_b16 v[146:147], v220 offset:2048
    v_mfma_f32_16x16x32_bf16 v[64:67], v[128:131], a[8:11], v[64:67]
    v_xor_b32 v221, 0x10000, v221
    ds_read_b64_tr_b16 v[148:149], v221 offset:0
    v_mfma_f32_16x16x32_bf16 v[68:71], v[128:131], a[12:15], v[68:71]
    ds_read_b64_tr_b16 v[150:151], v221 offset:2048
    v_mfma_f32_16x16x32_bf16 v[40:43], v[132:135], a[0:3], v[40:43]
    v_xor_b32 v222, 0x10000, v222
    ds_read_b64_tr_b16 v[152:153], v222 offset:0
    v_mfma_f32_16x16x32_bf16 v[44:47], v[132:135], a[4:7], v[44:47]
    ds_read_b64_tr_b16 v[154:155], v222 offset:2048
    v_mfma_f32_16x16x32_bf16 v[72:75], v[132:135], a[8:11], v[72:75]
    v_xor_b32 v223, 0x10000, v223
    ds_read_b64_tr_b16 v[156:157], v223 offset:0
    v_mfma_f32_16x16x32_bf16 v[76:79], v[132:135], a[12:15], v[76:79]
    ds_read_b64_tr_b16 v[158:159], v223 offset:2048
    v_mfma_f32_16x16x32_bf16 v[48:51], v[136:139], a[0:3], v[48:51]
    buffer_load_dwordx4 a[80:83], v226, s[8:11], s35 offen offset:1024 sc1
    v_mfma_f32_16x16x32_bf16 v[52:55], v[136:139], a[4:7], v[52:55]
    s_add_u32 m0, s38, 32768
    s_add_u32 s32, s37, 1310720
    v_mfma_f32_16x16x32_bf16 v[80:83], v[136:139], a[8:11], v[80:83]
    buffer_load_dwordx4 v224, s[12:15], s32 offen lds
    v_mfma_f32_16x16x32_bf16 v[84:87], v[136:139], a[12:15], v[84:87]
    buffer_load_dwordx4 a[84:87], v227, s[8:11], s35 offen offset:1024 sc1
    v_mfma_f32_16x16x32_bf16 v[56:59], v[140:143], a[0:3], v[56:59]
    v_mfma_f32_16x16x32_bf16 v[60:63], v[140:143], a[4:7], v[60:63]
    buffer_load_dwordx4 v225, s[12:15], s32 offen offset:1024 lds
    v_mfma_f32_16x16x32_bf16 v[88:91], v[140:143], a[8:11], v[88:91]
    v_mfma_f32_16x16x32_bf16 v[92:95], v[140:143], a[12:15], v[92:95]
    s_waitcnt lgkmcnt(0)
    v_mfma_f32_16x16x32_bf16 v[0:3], v[144:147], a[0:3], v[0:3]
    ds_read_b64_tr_b16 v[128:129], v216 offset:8192
    v_mfma_f32_16x16x32_bf16 v[4:7], v[144:147], a[4:7], v[4:7]
    ds_read_b64_tr_b16 v[130:131], v216 offset:10240
    v_mfma_f32_16x16x32_bf16 v[96:99], v[144:147], a[8:11], v[96:99]
    ds_read_b64_tr_b16 v[132:133], v217 offset:8192
    v_mfma_f32_16x16x32_bf16 v[100:103], v[144:147], a[12:15], v[100:103]
    ds_read_b64_tr_b16 v[134:135], v217 offset:10240
    v_mfma_f32_16x16x32_bf16 v[8:11], v[148:151], a[0:3], v[8:11]
    ds_read_b64_tr_b16 v[136:137], v218 offset:8192
    v_mfma_f32_16x16x32_bf16 v[12:15], v[148:151], a[4:7], v[12:15]
    ds_read_b64_tr_b16 v[138:139], v218 offset:10240
    v_mfma_f32_16x16x32_bf16 v[104:107], v[148:151], a[8:11], v[104:107]
    ds_read_b64_tr_b16 v[140:141], v219 offset:8192
    v_mfma_f32_16x16x32_bf16 v[108:111], v[148:151], a[12:15], v[108:111]
    ds_read_b64_tr_b16 v[142:143], v219 offset:10240
    v_mfma_f32_16x16x32_bf16 v[16:19], v[152:155], a[0:3], v[16:19]
    buffer_load_dwordx4 a[88:91], v245, s[8:11], s35 offen offset:1024 sc1
    v_mfma_f32_16x16x32_bf16 v[20:23], v[152:155], a[4:7], v[20:23]
    v_mfma_f32_16x16x32_bf16 v[112:115], v[152:155], a[8:11], v[112:115]
    v_mfma_f32_16x16x32_bf16 v[116:119], v[152:155], a[12:15], v[116:119]
    v_mfma_f32_16x16x32_bf16 v[24:27], v[156:159], a[0:3], v[24:27]
    buffer_load_dwordx4 a[92:95], v246, s[8:11], s35 offen offset:1024 sc1
    v_mfma_f32_16x16x32_bf16 v[28:31], v[156:159], a[4:7], v[28:31]
    v_mfma_f32_16x16x32_bf16 v[120:123], v[156:159], a[8:11], v[120:123]
    v_mfma_f32_16x16x32_bf16 v[124:127], v[156:159], a[12:15], v[124:127]
    buffer_load_dwordx4 a[96:99], v226, s[8:11], s35 offen offset:2048 sc1
    s_waitcnt vmcnt(25) lgkmcnt(0)
    v_mfma_f32_16x16x32_bf16 v[32:35], v[128:131], a[16:19], v[32:35]
    ds_read_b64_tr_b16 v[144:145], v220 offset:8192
    v_mfma_f32_16x16x32_bf16 v[36:39], v[128:131], a[20:23], v[36:39]
    ds_read_b64_tr_b16 v[146:147], v220 offset:10240
    v_mfma_f32_16x16x32_bf16 v[64:67], v[128:131], a[24:27], v[64:67]
    ds_read_b64_tr_b16 v[148:149], v221 offset:8192
    v_mfma_f32_16x16x32_bf16 v[68:71], v[128:131], a[28:31], v[68:71]
    ds_read_b64_tr_b16 v[150:151], v221 offset:10240
    v_mfma_f32_16x16x32_bf16 v[40:43], v[132:135], a[16:19], v[40:43]
    ds_read_b64_tr_b16 v[152:153], v222 offset:8192
    v_mfma_f32_16x16x32_bf16 v[44:47], v[132:135], a[20:23], v[44:47]
    ds_read_b64_tr_b16 v[154:155], v222 offset:10240
    v_mfma_f32_16x16x32_bf16 v[72:75], v[132:135], a[24:27], v[72:75]
    ds_read_b64_tr_b16 v[156:157], v223 offset:8192
    v_mfma_f32_16x16x32_bf16 v[76:79], v[132:135], a[28:31], v[76:79]
    ds_read_b64_tr_b16 v[158:159], v223 offset:10240
    v_mfma_f32_16x16x32_bf16 v[48:51], v[136:139], a[16:19], v[48:51]
    buffer_load_dwordx4 a[100:103], v227, s[8:11], s35 offen offset:2048 sc1
    v_mfma_f32_16x16x32_bf16 v[52:55], v[136:139], a[20:23], v[52:55]
    s_add_u32 m0, s38, 40960
    s_add_u32 s32, s37, 1376256
    v_mfma_f32_16x16x32_bf16 v[80:83], v[136:139], a[24:27], v[80:83]
    buffer_load_dwordx4 v224, s[12:15], s32 offen lds
    v_mfma_f32_16x16x32_bf16 v[84:87], v[136:139], a[28:31], v[84:87]
    buffer_load_dwordx4 a[104:107], v245, s[8:11], s35 offen offset:2048 sc1
    v_mfma_f32_16x16x32_bf16 v[56:59], v[140:143], a[16:19], v[56:59]
    v_mfma_f32_16x16x32_bf16 v[60:63], v[140:143], a[20:23], v[60:63]
    buffer_load_dwordx4 v225, s[12:15], s32 offen offset:1024 lds
    v_mfma_f32_16x16x32_bf16 v[88:91], v[140:143], a[24:27], v[88:91]
    v_mfma_f32_16x16x32_bf16 v[92:95], v[140:143], a[28:31], v[92:95]
    s_waitcnt lgkmcnt(0)
    v_mfma_f32_16x16x32_bf16 v[0:3], v[144:147], a[16:19], v[0:3]
    ds_read_b64_tr_b16 v[128:129], v216 offset:16384
    v_mfma_f32_16x16x32_bf16 v[4:7], v[144:147], a[20:23], v[4:7]
    ds_read_b64_tr_b16 v[130:131], v216 offset:18432
    v_mfma_f32_16x16x32_bf16 v[96:99], v[144:147], a[24:27], v[96:99]
    ds_read_b64_tr_b16 v[132:133], v217 offset:16384
    v_mfma_f32_16x16x32_bf16 v[100:103], v[144:147], a[28:31], v[100:103]
    ds_read_b64_tr_b16 v[134:135], v217 offset:18432
    v_mfma_f32_16x16x32_bf16 v[8:11], v[148:151], a[16:19], v[8:11]
    ds_read_b64_tr_b16 v[136:137], v218 offset:16384
    v_mfma_f32_16x16x32_bf16 v[12:15], v[148:151], a[20:23], v[12:15]
    ds_read_b64_tr_b16 v[138:139], v218 offset:18432
    v_mfma_f32_16x16x32_bf16 v[104:107], v[148:151], a[24:27], v[104:107]
    ds_read_b64_tr_b16 v[140:141], v219 offset:16384
    v_mfma_f32_16x16x32_bf16 v[108:111], v[148:151], a[28:31], v[108:111]
    ds_read_b64_tr_b16 v[142:143], v219 offset:18432
    v_mfma_f32_16x16x32_bf16 v[16:19], v[152:155], a[16:19], v[16:19]
    buffer_load_dwordx4 a[108:111], v246, s[8:11], s35 offen offset:2048 sc1
    v_mfma_f32_16x16x32_bf16 v[20:23], v[152:155], a[20:23], v[20:23]
    v_mfma_f32_16x16x32_bf16 v[112:115], v[152:155], a[24:27], v[112:115]
    v_mfma_f32_16x16x32_bf16 v[116:119], v[152:155], a[28:31], v[116:119]
    v_mfma_f32_16x16x32_bf16 v[24:27], v[156:159], a[16:19], v[24:27]
    buffer_load_dwordx4 a[112:115], v226, s[8:11], s35 offen offset:3072 sc1
    v_mfma_f32_16x16x32_bf16 v[28:31], v[156:159], a[20:23], v[28:31]
    v_mfma_f32_16x16x32_bf16 v[120:123], v[156:159], a[24:27], v[120:123]
    v_mfma_f32_16x16x32_bf16 v[124:127], v[156:159], a[28:31], v[124:127]
    s_waitcnt vmcnt(25) lgkmcnt(0)
    v_mfma_f32_16x16x32_bf16 v[32:35], v[128:131], a[32:35], v[32:35]
    ds_read_b64_tr_b16 v[144:145], v220 offset:16384
    v_mfma_f32_16x16x32_bf16 v[36:39], v[128:131], a[36:39], v[36:39]
    ds_read_b64_tr_b16 v[146:147], v220 offset:18432
    v_mfma_f32_16x16x32_bf16 v[64:67], v[128:131], a[40:43], v[64:67]
    ds_read_b64_tr_b16 v[148:149], v221 offset:16384
    v_mfma_f32_16x16x32_bf16 v[68:71], v[128:131], a[44:47], v[68:71]
    ds_read_b64_tr_b16 v[150:151], v221 offset:18432
    v_mfma_f32_16x16x32_bf16 v[40:43], v[132:135], a[32:35], v[40:43]
    ds_read_b64_tr_b16 v[152:153], v222 offset:16384
    v_mfma_f32_16x16x32_bf16 v[44:47], v[132:135], a[36:39], v[44:47]
    ds_read_b64_tr_b16 v[154:155], v222 offset:18432
    v_mfma_f32_16x16x32_bf16 v[72:75], v[132:135], a[40:43], v[72:75]
    ds_read_b64_tr_b16 v[156:157], v223 offset:16384
    v_mfma_f32_16x16x32_bf16 v[76:79], v[132:135], a[44:47], v[76:79]
    ds_read_b64_tr_b16 v[158:159], v223 offset:18432
    v_mfma_f32_16x16x32_bf16 v[48:51], v[136:139], a[32:35], v[48:51]
    buffer_load_dwordx4 a[116:119], v227, s[8:11], s35 offen offset:3072 sc1
    v_mfma_f32_16x16x32_bf16 v[52:55], v[136:139], a[36:39], v[52:55]
    s_add_u32 m0, s38, 49152
    s_add_u32 s32, s37, 1441792
    v_mfma_f32_16x16x32_bf16 v[80:83], v[136:139], a[40:43], v[80:83]
    buffer_load_dwordx4 v224, s[12:15], s32 offen lds
    v_mfma_f32_16x16x32_bf16 v[84:87], v[136:139], a[44:47], v[84:87]
    buffer_load_dwordx4 a[120:123], v245, s[8:11], s35 offen offset:3072 sc1
    v_mfma_f32_16x16x32_bf16 v[56:59], v[140:143], a[32:35], v[56:59]
    v_mfma_f32_16x16x32_bf16 v[60:63], v[140:143], a[36:39], v[60:63]
    buffer_load_dwordx4 v225, s[12:15], s32 offen offset:1024 lds
    v_mfma_f32_16x16x32_bf16 v[88:91], v[140:143], a[40:43], v[88:91]
    s_add_u32 s33, s55, 0
    buffer_load_dwordx4 a[128:131], v228, s[8:11], s33 offen offset:0 sc1
    v_mfma_f32_16x16x32_bf16 v[92:95], v[140:143], a[44:47], v[92:95]
    s_waitcnt lgkmcnt(0)
    v_mfma_f32_16x16x32_bf16 v[0:3], v[144:147], a[32:35], v[0:3]
    ds_read_b64_tr_b16 v[128:129], v216 offset:24576
    v_mfma_f32_16x16x32_bf16 v[4:7], v[144:147], a[36:39], v[4:7]
    ds_read_b64_tr_b16 v[130:131], v216 offset:26624
    v_mfma_f32_16x16x32_bf16 v[96:99], v[144:147], a[40:43], v[96:99]
    ds_read_b64_tr_b16 v[132:133], v217 offset:24576
    v_mfma_f32_16x16x32_bf16 v[100:103], v[144:147], a[44:47], v[100:103]
    ds_read_b64_tr_b16 v[134:135], v217 offset:26624
    v_mfma_f32_16x16x32_bf16 v[8:11], v[148:151], a[32:35], v[8:11]
    ds_read_b64_tr_b16 v[136:137], v218 offset:24576
    v_mfma_f32_16x16x32_bf16 v[12:15], v[148:151], a[36:39], v[12:15]
    ds_read_b64_tr_b16 v[138:139], v218 offset:26624
    v_mfma_f32_16x16x32_bf16 v[104:107], v[148:151], a[40:43], v[104:107]
    ds_read_b64_tr_b16 v[140:141], v219 offset:24576
    v_mfma_f32_16x16x32_bf16 v[108:111], v[148:151], a[44:47], v[108:111]
    ds_read_b64_tr_b16 v[142:143], v219 offset:26624
    v_mfma_f32_16x16x32_bf16 v[16:19], v[152:155], a[32:35], v[16:19]
    buffer_load_dwordx4 a[124:127], v246, s[8:11], s35 offen offset:3072 sc1
    v_mfma_f32_16x16x32_bf16 v[20:23], v[152:155], a[36:39], v[20:23]
    v_mfma_f32_16x16x32_bf16 v[112:115], v[152:155], a[40:43], v[112:115]
    v_mfma_f32_16x16x32_bf16 v[116:119], v[152:155], a[44:47], v[116:119]
    v_mfma_f32_16x16x32_bf16 v[24:27], v[156:159], a[32:35], v[24:27]
    s_add_u32 s35, s35, 4096
    buffer_load_dwordx4 a[0:3], v226, s[8:11], s35 offen offset:0 sc1
    v_mfma_f32_16x16x32_bf16 v[28:31], v[156:159], a[36:39], v[28:31]
    v_mfma_f32_16x16x32_bf16 v[120:123], v[156:159], a[40:43], v[120:123]
    buffer_load_dwordx4 a[132:135], v228, s[8:11], s33 offen offset:1024 sc1
    v_mfma_f32_16x16x32_bf16 v[124:127], v[156:159], a[44:47], v[124:127]
    buffer_load_dwordx4 a[4:7], v227, s[8:11], s35 offen offset:0 sc1
    s_waitcnt vmcnt(28) lgkmcnt(0)
    v_mfma_f32_16x16x32_bf16 v[32:35], v[128:131], a[48:51], v[32:35]
    ds_read_b64_tr_b16 v[144:145], v220 offset:24576
    v_mfma_f32_16x16x32_bf16 v[36:39], v[128:131], a[52:55], v[36:39]
    ds_read_b64_tr_b16 v[146:147], v220 offset:26624
    v_mfma_f32_16x16x32_bf16 v[64:67], v[128:131], a[56:59], v[64:67]
    ds_read_b64_tr_b16 v[148:149], v221 offset:24576
    v_mfma_f32_16x16x32_bf16 v[68:71], v[128:131], a[60:63], v[68:71]
    ds_read_b64_tr_b16 v[150:151], v221 offset:26624
    v_mfma_f32_16x16x32_bf16 v[40:43], v[132:135], a[48:51], v[40:43]
    ds_read_b64_tr_b16 v[152:153], v222 offset:24576
    v_mfma_f32_16x16x32_bf16 v[44:47], v[132:135], a[52:55], v[44:47]
    ds_read_b64_tr_b16 v[154:155], v222 offset:26624
    v_mfma_f32_16x16x32_bf16 v[72:75], v[132:135], a[56:59], v[72:75]
    ds_read_b64_tr_b16 v[156:157], v223 offset:24576
    v_mfma_f32_16x16x32_bf16 v[76:79], v[132:135], a[60:63], v[76:79]
    ds_read_b64_tr_b16 v[158:159], v223 offset:26624
    v_mfma_f32_16x16x32_bf16 v[48:51], v[136:139], a[48:51], v[48:51]
    buffer_load_dwordx4 a[8:11], v245, s[8:11], s35 offen offset:0 sc1
    v_mfma_f32_16x16x32_bf16 v[52:55], v[136:139], a[52:55], v[52:55]
    s_add_u32 m0, s38, 57344
    s_add_u32 s32, s37, 1507328
    v_mfma_f32_16x16x32_bf16 v[80:83], v[136:139], a[56:59], v[80:83]
    buffer_load_dwordx4 v224, s[12:15], s32 offen lds
    v_mfma_f32_16x16x32_bf16 v[84:87], v[136:139], a[60:63], v[84:87]
    buffer_load_dwordx4 a[12:15], v246, s[8:11], s35 offen offset:0 sc1
    v_mfma_f32_16x16x32_bf16 v[56:59], v[140:143], a[48:51], v[56:59]
    v_mfma_f32_16x16x32_bf16 v[60:63], v[140:143], a[52:55], v[60:63]
    buffer_load_dwordx4 v225, s[12:15], s32 offen offset:1024 lds
    v_mfma_f32_16x16x32_bf16 v[88:91], v[140:143], a[56:59], v[88:91]
    buffer_load_dwordx4 a[136:139], v228, s[8:11], s33 offen offset:2048 sc1
    v_mfma_f32_16x16x32_bf16 v[92:95], v[140:143], a[60:63], v[92:95]
    s_waitcnt lgkmcnt(0)
    s_barrier
    v_mfma_f32_16x16x32_bf16 v[0:3], v[144:147], a[48:51], v[0:3]
    ds_read_b64_tr_b16 v[128:129], v216 offset:32768
    v_mfma_f32_16x16x32_bf16 v[4:7], v[144:147], a[52:55], v[4:7]
    ds_read_b64_tr_b16 v[130:131], v216 offset:34816
    v_mfma_f32_16x16x32_bf16 v[96:99], v[144:147], a[56:59], v[96:99]
    ds_read_b64_tr_b16 v[132:133], v217 offset:32768
    v_mfma_f32_16x16x32_bf16 v[100:103], v[144:147], a[60:63], v[100:103]
    ds_read_b64_tr_b16 v[134:135], v217 offset:34816
    v_mfma_f32_16x16x32_bf16 v[8:11], v[148:151], a[48:51], v[8:11]
    ds_read_b64_tr_b16 v[136:137], v218 offset:32768
    v_mfma_f32_16x16x32_bf16 v[12:15], v[148:151], a[52:55], v[12:15]
    ds_read_b64_tr_b16 v[138:139], v218 offset:34816
    v_mfma_f32_16x16x32_bf16 v[104:107], v[148:151], a[56:59], v[104:107]
    ds_read_b64_tr_b16 v[140:141], v219 offset:32768
    v_mfma_f32_16x16x32_bf16 v[108:111], v[148:151], a[60:63], v[108:111]
    ds_read_b64_tr_b16 v[142:143], v219 offset:34816
    v_mfma_f32_16x16x32_bf16 v[16:19], v[152:155], a[48:51], v[16:19]
    buffer_load_dwordx4 a[16:19], v226, s[8:11], s35 offen offset:1024 sc1
    v_mfma_f32_16x16x32_bf16 v[20:23], v[152:155], a[52:55], v[20:23]
    v_mfma_f32_16x16x32_bf16 v[112:115], v[152:155], a[56:59], v[112:115]
    v_mfma_f32_16x16x32_bf16 v[116:119], v[152:155], a[60:63], v[116:119]
    v_mfma_f32_16x16x32_bf16 v[24:27], v[156:159], a[48:51], v[24:27]
    buffer_load_dwordx4 a[20:23], v227, s[8:11], s35 offen offset:1024 sc1
    v_mfma_f32_16x16x32_bf16 v[28:31], v[156:159], a[52:55], v[28:31]
    v_mfma_f32_16x16x32_bf16 v[120:123], v[156:159], a[56:59], v[120:123]
    buffer_load_dwordx4 a[140:143], v228, s[8:11], s33 offen offset:3072 sc1
    v_mfma_f32_16x16x32_bf16 v[124:127], v[156:159], a[60:63], v[124:127]
    s_waitcnt vmcnt(30) lgkmcnt(0)
    v_mfma_f32_16x16x32_bf16 v[32:35], v[128:131], a[64:67], v[32:35]
    ds_read_b64_tr_b16 v[144:145], v220 offset:32768
    v_mfma_f32_16x16x32_bf16 v[36:39], v[128:131], a[68:71], v[36:39]
    ds_read_b64_tr_b16 v[146:147], v220 offset:34816
    v_mfma_f32_16x16x32_bf16 v[64:67], v[128:131], a[72:75], v[64:67]
    ds_read_b64_tr_b16 v[148:149], v221 offset:32768
    v_mfma_f32_16x16x32_bf16 v[68:71], v[128:131], a[76:79], v[68:71]
    ds_read_b64_tr_b16 v[150:151], v221 offset:34816
    v_mfma_f32_16x16x32_bf16 v[40:43], v[132:135], a[64:67], v[40:43]
    ds_read_b64_tr_b16 v[152:153], v222 offset:32768
    v_mfma_f32_16x16x32_bf16 v[44:47], v[132:135], a[68:71], v[44:47]
    ds_read_b64_tr_b16 v[154:155], v222 offset:34816
    v_mfma_f32_16x16x32_bf16 v[72:75], v[132:135], a[72:75], v[72:75]
    ds_read_b64_tr_b16 v[156:157], v223 offset:32768
    v_mfma_f32_16x16x32_bf16 v[76:79], v[132:135], a[76:79], v[76:79]
    ds_read_b64_tr_b16 v[158:159], v223 offset:34816
    v_mfma_f32_16x16x32_bf16 v[48:51], v[136:139], a[64:67], v[48:51]
    buffer_load_dwordx4 a[24:27], v245, s[8:11], s35 offen offset:1024 sc1
    v_mfma_f32_16x16x32_bf16 v[52:55], v[136:139], a[68:71], v[52:55]
    s_add_u32 m0, s38, 65536
    s_add_u32 s32, s37, 1572864
    v_mfma_f32_16x16x32_bf16 v[80:83], v[136:139], a[72:75], v[80:83]
    buffer_load_dwordx4 v224, s[12:15], s32 offen lds
    v_mfma_f32_16x16x32_bf16 v[84:87], v[136:139], a[76:79], v[84:87]
    buffer_load_dwordx4 a[28:31], v246, s[8:11], s35 offen offset:1024 sc1
    v_mfma_f32_16x16x32_bf16 v[56:59], v[140:143], a[64:67], v[56:59]
    v_mfma_f32_16x16x32_bf16 v[60:63], v[140:143], a[68:71], v[60:63]
    buffer_load_dwordx4 v225, s[12:15], s32 offen offset:1024 lds
    v_mfma_f32_16x16x32_bf16 v[88:91], v[140:143], a[72:75], v[88:91]
    s_add_u32 s33, s55, 4096
    buffer_load_dwordx4 a[144:147], v228, s[8:11], s33 offen offset:0 sc1
    v_mfma_f32_16x16x32_bf16 v[92:95], v[140:143], a[76:79], v[92:95]
    s_waitcnt lgkmcnt(0)
    v_mfma_f32_16x16x32_bf16 v[0:3], v[144:147], a[64:67], v[0:3]
    ds_read_b64_tr_b16 v[128:129], v216 offset:40960
    v_mfma_f32_16x16x32_bf16 v[4:7], v[144:147], a[68:71], v[4:7]
    ds_read_b64_tr_b16 v[130:131], v216 offset:43008
    v_mfma_f32_16x16x32_bf16 v[96:99], v[144:147], a[72:75], v[96:99]
    ds_read_b64_tr_b16 v[132:133], v217 offset:40960
    v_mfma_f32_16x16x32_bf16 v[100:103], v[144:147], a[76:79], v[100:103]
    ds_read_b64_tr_b16 v[134:135], v217 offset:43008
    v_mfma_f32_16x16x32_bf16 v[8:11], v[148:151], a[64:67], v[8:11]
    ds_read_b64_tr_b16 v[136:137], v218 offset:40960
    v_mfma_f32_16x16x32_bf16 v[12:15], v[148:151], a[68:71], v[12:15]
    ds_read_b64_tr_b16 v[138:139], v218 offset:43008
    v_mfma_f32_16x16x32_bf16 v[104:107], v[148:151], a[72:75], v[104:107]
    ds_read_b64_tr_b16 v[140:141], v219 offset:40960
    v_mfma_f32_16x16x32_bf16 v[108:111], v[148:151], a[76:79], v[108:111]
    ds_read_b64_tr_b16 v[142:143], v219 offset:43008
    v_mfma_f32_16x16x32_bf16 v[16:19], v[152:155], a[64:67], v[16:19]
    buffer_load_dwordx4 a[32:35], v226, s[8:11], s35 offen offset:2048 sc1
    v_mfma_f32_16x16x32_bf16 v[20:23], v[152:155], a[68:71], v[20:23]
    v_mfma_f32_16x16x32_bf16 v[112:115], v[152:155], a[72:75], v[112:115]
    v_mfma_f32_16x16x32_bf16 v[116:119], v[152:155], a[76:79], v[116:119]
    v_mfma_f32_16x16x32_bf16 v[24:27], v[156:159], a[64:67], v[24:27]
    buffer_load_dwordx4 a[36:39], v227, s[8:11], s35 offen offset:2048 sc1
    v_mfma_f32_16x16x32_bf16 v[28:31], v[156:159], a[68:71], v[28:31]
    v_mfma_f32_16x16x32_bf16 v[120:123], v[156:159], a[72:75], v[120:123]
    buffer_load_dwordx4 a[148:151], v228, s[8:11], s33 offen offset:1024 sc1
    v_mfma_f32_16x16x32_bf16 v[124:127], v[156:159], a[76:79], v[124:127]
    buffer_load_dwordx4 a[40:43], v245, s[8:11], s35 offen offset:2048 sc1
    s_waitcnt vmcnt(33) lgkmcnt(0)
    v_mfma_f32_16x16x32_bf16 v[32:35], v[128:131], a[80:83], v[32:35]
    ds_read_b64_tr_b16 v[144:145], v220 offset:40960
    v_mfma_f32_16x16x32_bf16 v[36:39], v[128:131], a[84:87], v[36:39]
    ds_read_b64_tr_b16 v[146:147], v220 offset:43008
    v_mfma_f32_16x16x32_bf16 v[64:67], v[128:131], a[88:91], v[64:67]
    ds_read_b64_tr_b16 v[148:149], v221 offset:40960
    v_mfma_f32_16x16x32_bf16 v[68:71], v[128:131], a[92:95], v[68:71]
    ds_read_b64_tr_b16 v[150:151], v221 offset:43008
    v_mfma_f32_16x16x32_bf16 v[40:43], v[132:135], a[80:83], v[40:43]
    ds_read_b64_tr_b16 v[152:153], v222 offset:40960
    v_mfma_f32_16x16x32_bf16 v[44:47], v[132:135], a[84:87], v[44:47]
    ds_read_b64_tr_b16 v[154:155], v222 offset:43008
    v_mfma_f32_16x16x32_bf16 v[72:75], v[132:135], a[88:91], v[72:75]
    ds_read_b64_tr_b16 v[156:157], v223 offset:40960
    v_mfma_f32_16x16x32_bf16 v[76:79], v[132:135], a[92:95], v[76:79]
    ds_read_b64_tr_b16 v[158:159], v223 offset:43008
    v_mfma_f32_16x16x32_bf16 v[48:51], v[136:139], a[80:83], v[48:51]
    buffer_load_dwordx4 a[44:47], v246, s[8:11], s35 offen offset:2048 sc1
    v_mfma_f32_16x16x32_bf16 v[52:55], v[136:139], a[84:87], v[52:55]
    s_add_u32 m0, s38, 73728
    s_add_u32 s32, s37, 1638400
    v_mfma_f32_16x16x32_bf16 v[80:83], v[136:139], a[88:91], v[80:83]
    buffer_load_dwordx4 v224, s[12:15], s32 offen lds
    v_mfma_f32_16x16x32_bf16 v[84:87], v[136:139], a[92:95], v[84:87]
    buffer_load_dwordx4 a[48:51], v226, s[8:11], s35 offen offset:3072 sc1
    v_mfma_f32_16x16x32_bf16 v[56:59], v[140:143], a[80:83], v[56:59]
    v_mfma_f32_16x16x32_bf16 v[60:63], v[140:143], a[84:87], v[60:63]
    buffer_load_dwordx4 v225, s[12:15], s32 offen offset:1024 lds
    v_mfma_f32_16x16x32_bf16 v[88:91], v[140:143], a[88:91], v[88:91]
    buffer_load_dwordx4 a[152:155], v228, s[8:11], s33 offen offset:2048 sc1
    v_mfma_f32_16x16x32_bf16 v[92:95], v[140:143], a[92:95], v[92:95]
    s_waitcnt lgkmcnt(0)
    v_mfma_f32_16x16x32_bf16 v[0:3], v[144:147], a[80:83], v[0:3]
    ds_read_b64_tr_b16 v[128:129], v216 offset:49152
    v_mfma_f32_16x16x32_bf16 v[4:7], v[144:147], a[84:87], v[4:7]
    ds_read_b64_tr_b16 v[130:131], v216 offset:51200
    v_mfma_f32_16x16x32_bf16 v[96:99], v[144:147], a[88:91], v[96:99]
    ds_read_b64_tr_b16 v[132:133], v217 offset:49152
    v_mfma_f32_16x16x32_bf16 v[100:103], v[144:147], a[92:95], v[100:103]
    ds_read_b64_tr_b16 v[134:135], v217 offset:51200
    v_mfma_f32_16x16x32_bf16 v[8:11], v[148:151], a[80:83], v[8:11]
    ds_read_b64_tr_b16 v[136:137], v218 offset:49152
    v_mfma_f32_16x16x32_bf16 v[12:15], v[148:151], a[84:87], v[12:15]
    ds_read_b64_tr_b16 v[138:139], v218 offset:51200
    v_mfma_f32_16x16x32_bf16 v[104:107], v[148:151], a[88:91], v[104:107]
    ds_read_b64_tr_b16 v[140:141], v219 offset:49152
    v_mfma_f32_16x16x32_bf16 v[108:111], v[148:151], a[92:95], v[108:111]
    ds_read_b64_tr_b16 v[142:143], v219 offset:51200
    v_mfma_f32_16x16x32_bf16 v[16:19], v[152:155], a[80:83], v[16:19]
    buffer_load_dwordx4 a[52:55], v227, s[8:11], s35 offen offset:3072 sc1
    v_mfma_f32_16x16x32_bf16 v[20:23], v[152:155], a[84:87], v[20:23]
    v_mfma_f32_16x16x32_bf16 v[112:115], v[152:155], a[88:91], v[112:115]
    v_mfma_f32_16x16x32_bf16 v[116:119], v[152:155], a[92:95], v[116:119]
    v_mfma_f32_16x16x32_bf16 v[24:27], v[156:159], a[80:83], v[24:27]
    buffer_load_dwordx4 a[56:59], v245, s[8:11], s35 offen offset:3072 sc1
    v_mfma_f32_16x16x32_bf16 v[28:31], v[156:159], a[84:87], v[28:31]
    v_mfma_f32_16x16x32_bf16 v[120:123], v[156:159], a[88:91], v[120:123]
    buffer_load_dwordx4 a[156:159], v228, s[8:11], s33 offen offset:3072 sc1
    v_mfma_f32_16x16x32_bf16 v[124:127], v[156:159], a[92:95], v[124:127]
    s_waitcnt vmcnt(35) lgkmcnt(0)
    v_mfma_f32_16x16x32_bf16 v[32:35], v[128:131], a[96:99], v[32:35]
    ds_read_b64_tr_b16 v[144:145], v220 offset:49152
    v_mfma_f32_16x16x32_bf16 v[36:39], v[128:131], a[100:103], v[36:39]
    ds_read_b64_tr_b16 v[146:147], v220 offset:51200
    v_mfma_f32_16x16x32_bf16 v[64:67], v[128:131], a[104:107], v[64:67]
    ds_read_b64_tr_b16 v[148:149], v221 offset:49152
    v_mfma_f32_16x16x32_bf16 v[68:71], v[128:131], a[108:111], v[68:71]
    ds_read_b64_tr_b16 v[150:151], v221 offset:51200
    v_mfma_f32_16x16x32_bf16 v[40:43], v[132:135], a[96:99], v[40:43]
    ds_read_b64_tr_b16 v[152:153], v222 offset:49152
    v_mfma_f32_16x16x32_bf16 v[44:47], v[132:135], a[100:103], v[44:47]
    ds_read_b64_tr_b16 v[154:155], v222 offset:51200
    v_mfma_f32_16x16x32_bf16 v[72:75], v[132:135], a[104:107], v[72:75]
    ds_read_b64_tr_b16 v[156:157], v223 offset:49152
    v_mfma_f32_16x16x32_bf16 v[76:79], v[132:135], a[108:111], v[76:79]
    ds_read_b64_tr_b16 v[158:159], v223 offset:51200
    v_mfma_f32_16x16x32_bf16 v[48:51], v[136:139], a[96:99], v[48:51]
    buffer_load_dwordx4 a[60:63], v246, s[8:11], s35 offen offset:3072 sc1
    v_mfma_f32_16x16x32_bf16 v[52:55], v[136:139], a[100:103], v[52:55]
    s_add_u32 m0, s38, 81920
    s_add_u32 s32, s37, 1703936
    v_mfma_f32_16x16x32_bf16 v[80:83], v[136:139], a[104:107], v[80:83]
    buffer_load_dwordx4 v224, s[12:15], s32 offen lds
    v_mfma_f32_16x16x32_bf16 v[84:87], v[136:139], a[108:111], v[84:87]
    s_add_u32 s35, s35, 4096
    buffer_load_dwordx4 a[64:67], v226, s[8:11], s35 offen offset:0 sc1
    v_mfma_f32_16x16x32_bf16 v[56:59], v[140:143], a[96:99], v[56:59]
    v_mfma_f32_16x16x32_bf16 v[60:63], v[140:143], a[100:103], v[60:63]
    buffer_load_dwordx4 v225, s[12:15], s32 offen offset:1024 lds
    v_mfma_f32_16x16x32_bf16 v[88:91], v[140:143], a[104:107], v[88:91]
    s_add_u32 s33, s55, 32768
    buffer_load_dwordx4 a[160:163], v228, s[8:11], s33 offen offset:0 sc1
    v_mfma_f32_16x16x32_bf16 v[92:95], v[140:143], a[108:111], v[92:95]
    s_waitcnt lgkmcnt(0)
    v_mfma_f32_16x16x32_bf16 v[0:3], v[144:147], a[96:99], v[0:3]
    ds_read_b64_tr_b16 v[128:129], v216 offset:57344
    v_mfma_f32_16x16x32_bf16 v[4:7], v[144:147], a[100:103], v[4:7]
    ds_read_b64_tr_b16 v[130:131], v216 offset:59392
    v_mfma_f32_16x16x32_bf16 v[96:99], v[144:147], a[104:107], v[96:99]
    ds_read_b64_tr_b16 v[132:133], v217 offset:57344
    v_mfma_f32_16x16x32_bf16 v[100:103], v[144:147], a[108:111], v[100:103]
    ds_read_b64_tr_b16 v[134:135], v217 offset:59392
    v_mfma_f32_16x16x32_bf16 v[8:11], v[148:151], a[96:99], v[8:11]
    ds_read_b64_tr_b16 v[136:137], v218 offset:57344
    v_mfma_f32_16x16x32_bf16 v[12:15], v[148:151], a[100:103], v[12:15]
    ds_read_b64_tr_b16 v[138:139], v218 offset:59392
    v_mfma_f32_16x16x32_bf16 v[104:107], v[148:151], a[104:107], v[104:107]
    ds_read_b64_tr_b16 v[140:141], v219 offset:57344
    v_mfma_f32_16x16x32_bf16 v[108:111], v[148:151], a[108:111], v[108:111]
    ds_read_b64_tr_b16 v[142:143], v219 offset:59392
    v_mfma_f32_16x16x32_bf16 v[16:19], v[152:155], a[96:99], v[16:19]
    buffer_load_dwordx4 a[68:71], v227, s[8:11], s35 offen offset:0 sc1
    v_mfma_f32_16x16x32_bf16 v[20:23], v[152:155], a[100:103], v[20:23]
    v_mfma_f32_16x16x32_bf16 v[112:115], v[152:155], a[104:107], v[112:115]
    v_mfma_f32_16x16x32_bf16 v[116:119], v[152:155], a[108:111], v[116:119]
    v_mfma_f32_16x16x32_bf16 v[24:27], v[156:159], a[96:99], v[24:27]
    buffer_load_dwordx4 a[72:75], v245, s[8:11], s35 offen offset:0 sc1
    v_mfma_f32_16x16x32_bf16 v[28:31], v[156:159], a[100:103], v[28:31]
    v_mfma_f32_16x16x32_bf16 v[120:123], v[156:159], a[104:107], v[120:123]
    buffer_load_dwordx4 a[164:167], v228, s[8:11], s33 offen offset:1024 sc1
    v_mfma_f32_16x16x32_bf16 v[124:127], v[156:159], a[108:111], v[124:127]
    buffer_load_dwordx4 a[76:79], v246, s[8:11], s35 offen offset:0 sc1
    s_waitcnt vmcnt(37) lgkmcnt(0)
    v_mfma_f32_16x16x32_bf16 v[32:35], v[128:131], a[112:115], v[32:35]
    ds_read_b64_tr_b16 v[144:145], v220 offset:57344
    v_mfma_f32_16x16x32_bf16 v[36:39], v[128:131], a[116:119], v[36:39]
    ds_read_b64_tr_b16 v[146:147], v220 offset:59392
    v_mfma_f32_16x16x32_bf16 v[64:67], v[128:131], a[120:123], v[64:67]
    ds_read_b64_tr_b16 v[148:149], v221 offset:57344
    v_mfma_f32_16x16x32_bf16 v[68:71], v[128:131], a[124:127], v[68:71]
    ds_read_b64_tr_b16 v[150:151], v221 offset:59392
    v_mfma_f32_16x16x32_bf16 v[40:43], v[132:135], a[112:115], v[40:43]
    ds_read_b64_tr_b16 v[152:153], v222 offset:57344
    v_mfma_f32_16x16x32_bf16 v[44:47], v[132:135], a[116:119], v[44:47]
    ds_read_b64_tr_b16 v[154:155], v222 offset:59392
    v_mfma_f32_16x16x32_bf16 v[72:75], v[132:135], a[120:123], v[72:75]
    ds_read_b64_tr_b16 v[156:157], v223 offset:57344
    v_mfma_f32_16x16x32_bf16 v[76:79], v[132:135], a[124:127], v[76:79]
    ds_read_b64_tr_b16 v[158:159], v223 offset:59392
    v_mfma_f32_16x16x32_bf16 v[48:51], v[136:139], a[112:115], v[48:51]
    buffer_load_dwordx4 a[80:83], v226, s[8:11], s35 offen offset:1024 sc1
    v_mfma_f32_16x16x32_bf16 v[52:55], v[136:139], a[116:119], v[52:55]
    s_add_u32 m0, s38, 90112
    s_add_u32 s32, s37, 1769472
    v_mfma_f32_16x16x32_bf16 v[80:83], v[136:139], a[120:123], v[80:83]
    buffer_load_dwordx4 v224, s[12:15], s32 offen lds
    v_mfma_f32_16x16x32_bf16 v[84:87], v[136:139], a[124:127], v[84:87]
    buffer_load_dwordx4 a[84:87], v227, s[8:11], s35 offen offset:1024 sc1
    v_mfma_f32_16x16x32_bf16 v[56:59], v[140:143], a[112:115], v[56:59]
    v_mfma_f32_16x16x32_bf16 v[60:63], v[140:143], a[116:119], v[60:63]
    buffer_load_dwordx4 v225, s[12:15], s32 offen offset:1024 lds
    v_mfma_f32_16x16x32_bf16 v[88:91], v[140:143], a[120:123], v[88:91]
    buffer_load_dwordx4 a[168:171], v228, s[8:11], s33 offen offset:2048 sc1
    v_mfma_f32_16x16x32_bf16 v[92:95], v[140:143], a[124:127], v[92:95]
    s_waitcnt vmcnt(63) lgkmcnt(0)
    s_barrier
    v_mfma_f32_16x16x32_bf16 v[0:3], v[144:147], a[112:115], v[0:3]
    v_xor_b32 v216, 0x10000, v216
    ds_read_b64_tr_b16 v[128:129], v216 offset:0
    v_mfma_f32_16x16x32_bf16 v[4:7], v[144:147], a[116:119], v[4:7]
    ds_read_b64_tr_b16 v[130:131], v216 offset:2048
    v_mfma_f32_16x16x32_bf16 v[96:99], v[144:147], a[120:123], v[96:99]
    v_xor_b32 v217, 0x10000, v217
    ds_read_b64_tr_b16 v[132:133], v217 offset:0
    v_mfma_f32_16x16x32_bf16 v[100:103], v[144:147], a[124:127], v[100:103]
    ds_read_b64_tr_b16 v[134:135], v217 offset:2048
    v_mfma_f32_16x16x32_bf16 v[8:11], v[148:151], a[112:115], v[8:11]
    v_xor_b32 v218, 0x10000, v218
    ds_read_b64_tr_b16 v[136:137], v218 offset:0
    v_mfma_f32_16x16x32_bf16 v[12:15], v[148:151], a[116:119], v[12:15]
    ds_read_b64_tr_b16 v[138:139], v218 offset:2048
    v_mfma_f32_16x16x32_bf16 v[104:107], v[148:151], a[120:123], v[104:107]
    v_xor_b32 v219, 0x10000, v219
    ds_read_b64_tr_b16 v[140:141], v219 offset:0
    v_mfma_f32_16x16x32_bf16 v[108:111], v[148:151], a[124:127], v[108:111]
    ds_read_b64_tr_b16 v[142:143], v219 offset:2048
    v_mfma_f32_16x16x32_bf16 v[16:19], v[152:155], a[112:115], v[16:19]
    buffer_load_dwordx4 a[88:91], v245, s[8:11], s35 offen offset:1024 sc1
    v_mfma_f32_16x16x32_bf16 v[20:23], v[152:155], a[116:119], v[20:23]
    v_mfma_f32_16x16x32_bf16 v[112:115], v[152:155], a[120:123], v[112:115]
    v_mfma_f32_16x16x32_bf16 v[116:119], v[152:155], a[124:127], v[116:119]
    v_mfma_f32_16x16x32_bf16 v[24:27], v[156:159], a[112:115], v[24:27]
    buffer_load_dwordx4 a[92:95], v246, s[8:11], s35 offen offset:1024 sc1
    v_mfma_f32_16x16x32_bf16 v[28:31], v[156:159], a[116:119], v[28:31]
    v_mfma_f32_16x16x32_bf16 v[120:123], v[156:159], a[120:123], v[120:123]
    buffer_load_dwordx4 a[172:175], v228, s[8:11], s33 offen offset:3072 sc1
    v_mfma_f32_16x16x32_bf16 v[124:127], v[156:159], a[124:127], v[124:127]
    s_waitcnt vmcnt(39) lgkmcnt(0)
    v_mfma_f32_16x16x32_bf16 v[32:35], v[128:131], a[0:3], v[32:35]
    v_xor_b32 v220, 0x10000, v220
    ds_read_b64_tr_b16 v[144:145], v220 offset:0
    v_mfma_f32_16x16x32_bf16 v[36:39], v[128:131], a[4:7], v[36:39]
    ds_read_b64_tr_b16 v[146:147], v220 offset:2048
    v_mfma_f32_16x16x32_bf16 v[64:67], v[128:131], a[8:11], v[64:67]
    v_xor_b32 v221, 0x10000, v221
    ds_read_b64_tr_b16 v[148:149], v221 offset:0
    v_mfma_f32_16x16x32_bf16 v[68:71], v[128:131], a[12:15], v[68:71]
    ds_read_b64_tr_b16 v[150:151], v221 offset:2048
    v_mfma_f32_16x16x32_bf16 v[40:43], v[132:135], a[0:3], v[40:43]
    v_xor_b32 v222, 0x10000, v222
    ds_read_b64_tr_b16 v[152:153], v222 offset:0
    v_mfma_f32_16x16x32_bf16 v[44:47], v[132:135], a[4:7], v[44:47]
    ds_read_b64_tr_b16 v[154:155], v222 offset:2048
    v_mfma_f32_16x16x32_bf16 v[72:75], v[132:135], a[8:11], v[72:75]
    v_xor_b32 v223, 0x10000, v223
    ds_read_b64_tr_b16 v[156:157], v223 offset:0
    v_mfma_f32_16x16x32_bf16 v[76:79], v[132:135], a[12:15], v[76:79]
    ds_read_b64_tr_b16 v[158:159], v223 offset:2048
    v_mfma_f32_16x16x32_bf16 v[48:51], v[136:139], a[0:3], v[48:51]
    buffer_load_dwordx4 a[96:99], v226, s[8:11], s35 offen offset:2048 sc1
    v_mfma_f32_16x16x32_bf16 v[52:55], v[136:139], a[4:7], v[52:55]
    s_add_u32 m0, s38, 98304
    s_add_u32 s32, s37, 1835008
    v_mfma_f32_16x16x32_bf16 v[80:83], v[136:139], a[8:11], v[80:83]
    buffer_load_dwordx4 v224, s[12:15], s32 offen lds
    v_mfma_f32_16x16x32_bf16 v[84:87], v[136:139], a[12:15], v[84:87]
    buffer_load_dwordx4 a[100:103], v227, s[8:11], s35 offen offset:2048 sc1
    v_mfma_f32_16x16x32_bf16 v[56:59], v[140:143], a[0:3], v[56:59]
    v_mfma_f32_16x16x32_bf16 v[60:63], v[140:143], a[4:7], v[60:63]
    buffer_load_dwordx4 v225, s[12:15], s32 offen offset:1024 lds
    v_mfma_f32_16x16x32_bf16 v[88:91], v[140:143], a[8:11], v[88:91]
    s_add_u32 s33, s55, 36864
    buffer_load_dwordx4 a[176:179], v228, s[8:11], s33 offen offset:0 sc1
    v_mfma_f32_16x16x32_bf16 v[92:95], v[140:143], a[12:15], v[92:95]
    s_waitcnt lgkmcnt(0)
    v_mfma_f32_16x16x32_bf16 v[0:3], v[144:147], a[0:3], v[0:3]
    ds_read_b64_tr_b16 v[128:129], v216 offset:8192
    v_mfma_f32_16x16x32_bf16 v[4:7], v[144:147], a[4:7], v[4:7]
    ds_read_b64_tr_b16 v[130:131], v216 offset:10240
    v_mfma_f32_16x16x32_bf16 v[96:99], v[144:147], a[8:11], v[96:99]
    ds_read_b64_tr_b16 v[132:133], v217 offset:8192
    v_mfma_f32_16x16x32_bf16 v[100:103], v[144:147], a[12:15], v[100:103]
    ds_read_b64_tr_b16 v[134:135], v217 offset:10240
    v_mfma_f32_16x16x32_bf16 v[8:11], v[148:151], a[0:3], v[8:11]
    ds_read_b64_tr_b16 v[136:137], v218 offset:8192
    v_mfma_f32_16x16x32_bf16 v[12:15], v[148:151], a[4:7], v[12:15]
    ds_read_b64_tr_b16 v[138:139], v218 offset:10240
    v_mfma_f32_16x16x32_bf16 v[104:107], v[148:151], a[8:11], v[104:107]
    ds_read_b64_tr_b16 v[140:141], v219 offset:8192
    v_mfma_f32_16x16x32_bf16 v[108:111], v[148:151], a[12:15], v[108:111]
    ds_read_b64_tr_b16 v[142:143], v219 offset:10240
    v_mfma_f32_16x16x32_bf16 v[16:19], v[152:155], a[0:3], v[16:19]
    buffer_load_dwordx4 a[104:107], v245, s[8:11], s35 offen offset:2048 sc1
    v_mfma_f32_16x16x32_bf16 v[20:23], v[152:155], a[4:7], v[20:23]
    v_mfma_f32_16x16x32_bf16 v[112:115], v[152:155], a[8:11], v[112:115]
    v_mfma_f32_16x16x32_bf16 v[116:119], v[152:155], a[12:15], v[116:119]
    v_mfma_f32_16x16x32_bf16 v[24:27], v[156:159], a[0:3], v[24:27]
    buffer_load_dwordx4 a[108:111], v246, s[8:11], s35 offen offset:2048 sc1
    v_mfma_f32_16x16x32_bf16 v[28:31], v[156:159], a[4:7], v[28:31]
    v_mfma_f32_16x16x32_bf16 v[120:123], v[156:159], a[8:11], v[120:123]
    buffer_load_dwordx4 a[180:183], v228, s[8:11], s33 offen offset:1024 sc1
    v_mfma_f32_16x16x32_bf16 v[124:127], v[156:159], a[12:15], v[124:127]
    buffer_load_dwordx4 a[112:115], v226, s[8:11], s35 offen offset:3072 sc1
    s_waitcnt vmcnt(40) lgkmcnt(0)
    v_mfma_f32_16x16x32_bf16 v[32:35], v[128:131], a[16:19], v[32:35]
    ds_read_b64_tr_b16 v[144:145], v220 offset:8192
    v_mfma_f32_16x16x32_bf16 v[36:39], v[128:131], a[20:23], v[36:39]
    ds_read_b64_tr_b16 v[146:147], v220 offset:10240
    v_mfma_f32_16x16x32_bf16 v[64:67], v[128:131], a[24:27], v[64:67]
    ds_read_b64_tr_b16 v[148:149], v221 offset:8192
    v_mfma_f32_16x16x32_bf16 v[68:71], v[128:131], a[28:31], v[68:71]
    ds_read_b64_tr_b16 v[150:151], v221 offset:10240
    v_mfma_f32_16x16x32_bf16 v[40:43], v[132:135], a[16:19], v[40:43]
    ds_read_b64_tr_b16 v[152:153], v222 offset:8192
    v_mfma_f32_16x16x32_bf16 v[44:47], v[132:135], a[20:23], v[44:47]
    ds_read_b64_tr_b16 v[154:155], v222 offset:10240
    v_mfma_f32_16x16x32_bf16 v[72:75], v[132:135], a[24:27], v[72:75]
    ds_read_b64_tr_b16 v[156:157], v223 offset:8192
    v_mfma_f32_16x16x32_bf16 v[76:79], v[132:135], a[28:31], v[76:79]
    ds_read_b64_tr_b16 v[158:159], v223 offset:10240
    v_mfma_f32_16x16x32_bf16 v[48:51], v[136:139], a[16:19], v[48:51]
    buffer_load_dwordx4 a[116:119], v227, s[8:11], s35 offen offset:3072 sc1
    v_mfma_f32_16x16x32_bf16 v[52:55], v[136:139], a[20:23], v[52:55]
    s_add_u32 m0, s38, 106496
    s_add_u32 s32, s37, 1900544
    v_mfma_f32_16x16x32_bf16 v[80:83], v[136:139], a[24:27], v[80:83]
    buffer_load_dwordx4 v224, s[12:15], s32 offen lds
    v_mfma_f32_16x16x32_bf16 v[84:87], v[136:139], a[28:31], v[84:87]
    buffer_load_dwordx4 a[120:123], v245, s[8:11], s35 offen offset:3072 sc1
    v_mfma_f32_16x16x32_bf16 v[56:59], v[140:143], a[16:19], v[56:59]
    v_mfma_f32_16x16x32_bf16 v[60:63], v[140:143], a[20:23], v[60:63]
    buffer_load_dwordx4 v225, s[12:15], s32 offen offset:1024 lds
    v_mfma_f32_16x16x32_bf16 v[88:91], v[140:143], a[24:27], v[88:91]
    buffer_load_dwordx4 a[184:187], v228, s[8:11], s33 offen offset:2048 sc1
    v_mfma_f32_16x16x32_bf16 v[92:95], v[140:143], a[28:31], v[92:95]
    s_waitcnt lgkmcnt(0)
    v_mfma_f32_16x16x32_bf16 v[0:3], v[144:147], a[16:19], v[0:3]
    ds_read_b64_tr_b16 v[128:129], v216 offset:16384
    v_mfma_f32_16x16x32_bf16 v[4:7], v[144:147], a[20:23], v[4:7]
    ds_read_b64_tr_b16 v[130:131], v216 offset:18432
    v_mfma_f32_16x16x32_bf16 v[96:99], v[144:147], a[24:27], v[96:99]
    ds_read_b64_tr_b16 v[132:133], v217 offset:16384
    v_mfma_f32_16x16x32_bf16 v[100:103], v[144:147], a[28:31], v[100:103]
    ds_read_b64_tr_b16 v[134:135], v217 offset:18432
    v_mfma_f32_16x16x32_bf16 v[8:11], v[148:151], a[16:19], v[8:11]
    ds_read_b64_tr_b16 v[136:137], v218 offset:16384
    v_mfma_f32_16x16x32_bf16 v[12:15], v[148:151], a[20:23], v[12:15]
    ds_read_b64_tr_b16 v[138:139], v218 offset:18432
    v_mfma_f32_16x16x32_bf16 v[104:107], v[148:151], a[24:27], v[104:107]
    ds_read_b64_tr_b16 v[140:141], v219 offset:16384
    v_mfma_f32_16x16x32_bf16 v[108:111], v[148:151], a[28:31], v[108:111]
    ds_read_b64_tr_b16 v[142:143], v219 offset:18432
    v_mfma_f32_16x16x32_bf16 v[16:19], v[152:155], a[16:19], v[16:19]
    buffer_load_dwordx4 a[124:127], v246, s[8:11], s35 offen offset:3072 sc1
    v_mfma_f32_16x16x32_bf16 v[20:23], v[152:155], a[20:23], v[20:23]
    v_mfma_f32_16x16x32_bf16 v[112:115], v[152:155], a[24:27], v[112:115]
    v_mfma_f32_16x16x32_bf16 v[116:119], v[152:155], a[28:31], v[116:119]
    v_mfma_f32_16x16x32_bf16 v[24:27], v[156:159], a[16:19], v[24:27]
    s_add_u32 s35, s35, 4096
    buffer_load_dwordx4 a[0:3], v226, s[8:11], s35 offen offset:0 sc1
    v_mfma_f32_16x16x32_bf16 v[28:31], v[156:159], a[20:23], v[28:31]
    v_mfma_f32_16x16x32_bf16 v[120:123], v[156:159], a[24:27], v[120:123]
    buffer_load_dwordx4 a[188:191], v228, s[8:11], s33 offen offset:3072 sc1
    v_mfma_f32_16x16x32_bf16 v[124:127], v[156:159], a[28:31], v[124:127]
    s_waitcnt vmcnt(41) lgkmcnt(0)
    v_mfma_f32_16x16x32_bf16 v[32:35], v[128:131], a[32:35], v[32:35]
    ds_read_b64_tr_b16 v[144:145], v220 offset:16384
    v_mfma_f32_16x16x32_bf16 v[36:39], v[128:131], a[36:39], v[36:39]
    ds_read_b64_tr_b16 v[146:147], v220 offset:18432
    v_mfma_f32_16x16x32_bf16 v[64:67], v[128:131], a[40:43], v[64:67]
    ds_read_b64_tr_b16 v[148:149], v221 offset:16384
    v_mfma_f32_16x16x32_bf16 v[68:71], v[128:131], a[44:47], v[68:71]
    ds_read_b64_tr_b16 v[150:151], v221 offset:18432
    v_mfma_f32_16x16x32_bf16 v[40:43], v[132:135], a[32:35], v[40:43]
    ds_read_b64_tr_b16 v[152:153], v222 offset:16384
    v_mfma_f32_16x16x32_bf16 v[44:47], v[132:135], a[36:39], v[44:47]
    ds_read_b64_tr_b16 v[154:155], v222 offset:18432
    v_mfma_f32_16x16x32_bf16 v[72:75], v[132:135], a[40:43], v[72:75]
    ds_read_b64_tr_b16 v[156:157], v223 offset:16384
    v_mfma_f32_16x16x32_bf16 v[76:79], v[132:135], a[44:47], v[76:79]
    ds_read_b64_tr_b16 v[158:159], v223 offset:18432
    v_mfma_f32_16x16x32_bf16 v[48:51], v[136:139], a[32:35], v[48:51]
    buffer_load_dwordx4 a[4:7], v227, s[8:11], s35 offen offset:0 sc1
    v_mfma_f32_16x16x32_bf16 v[52:55], v[136:139], a[36:39], v[52:55]
    s_add_u32 m0, s38, 114688
    s_add_u32 s32, s37, 1966080
    v_mfma_f32_16x16x32_bf16 v[80:83], v[136:139], a[40:43], v[80:83]
    buffer_load_dwordx4 v224, s[12:15], s32 offen lds
    v_mfma_f32_16x16x32_bf16 v[84:87], v[136:139], a[44:47], v[84:87]
    buffer_load_dwordx4 a[8:11], v245, s[8:11], s35 offen offset:0 sc1
    v_mfma_f32_16x16x32_bf16 v[56:59], v[140:143], a[32:35], v[56:59]
    v_mfma_f32_16x16x32_bf16 v[60:63], v[140:143], a[36:39], v[60:63]
    buffer_load_dwordx4 v225, s[12:15], s32 offen offset:1024 lds
    v_mfma_f32_16x16x32_bf16 v[88:91], v[140:143], a[40:43], v[88:91]
    v_mfma_f32_16x16x32_bf16 v[92:95], v[140:143], a[44:47], v[92:95]
    s_waitcnt lgkmcnt(0)
    v_mfma_f32_16x16x32_bf16 v[0:3], v[144:147], a[32:35], v[0:3]
    ds_read_b64_tr_b16 v[128:129], v216 offset:24576
    v_mfma_f32_16x16x32_bf16 v[4:7], v[144:147], a[36:39], v[4:7]
    ds_read_b64_tr_b16 v[130:131], v216 offset:26624
    v_mfma_f32_16x16x32_bf16 v[96:99], v[144:147], a[40:43], v[96:99]
    ds_read_b64_tr_b16 v[132:133], v217 offset:24576
    v_mfma_f32_16x16x32_bf16 v[100:103], v[144:147], a[44:47], v[100:103]
    ds_read_b64_tr_b16 v[134:135], v217 offset:26624
    v_mfma_f32_16x16x32_bf16 v[8:11], v[148:151], a[32:35], v[8:11]
    ds_read_b64_tr_b16 v[136:137], v218 offset:24576
    v_mfma_f32_16x16x32_bf16 v[12:15], v[148:151], a[36:39], v[12:15]
    ds_read_b64_tr_b16 v[138:139], v218 offset:26624
    v_mfma_f32_16x16x32_bf16 v[104:107], v[148:151], a[40:43], v[104:107]
    ds_read_b64_tr_b16 v[140:141], v219 offset:24576
    v_mfma_f32_16x16x32_bf16 v[108:111], v[148:151], a[44:47], v[108:111]
    ds_read_b64_tr_b16 v[142:143], v219 offset:26624
    v_mfma_f32_16x16x32_bf16 v[16:19], v[152:155], a[32:35], v[16:19]
    buffer_load_dwordx4 a[12:15], v246, s[8:11], s35 offen offset:0 sc1
    v_mfma_f32_16x16x32_bf16 v[20:23], v[152:155], a[36:39], v[20:23]
    v_mfma_f32_16x16x32_bf16 v[112:115], v[152:155], a[40:43], v[112:115]
    v_mfma_f32_16x16x32_bf16 v[116:119], v[152:155], a[44:47], v[116:119]
    v_mfma_f32_16x16x32_bf16 v[24:27], v[156:159], a[32:35], v[24:27]
    buffer_load_dwordx4 a[16:19], v226, s[8:11], s35 offen offset:1024 sc1
    v_mfma_f32_16x16x32_bf16 v[28:31], v[156:159], a[36:39], v[28:31]
    v_mfma_f32_16x16x32_bf16 v[120:123], v[156:159], a[40:43], v[120:123]
    v_mfma_f32_16x16x32_bf16 v[124:127], v[156:159], a[44:47], v[124:127]
    buffer_load_dwordx4 a[20:23], v227, s[8:11], s35 offen offset:1024 sc1
    s_waitcnt vmcnt(40) lgkmcnt(0)
    v_mfma_f32_16x16x32_bf16 v[32:35], v[128:131], a[48:51], v[32:35]
    ds_read_b64_tr_b16 v[144:145], v220 offset:24576
    v_mfma_f32_16x16x32_bf16 v[36:39], v[128:131], a[52:55], v[36:39]
    ds_read_b64_tr_b16 v[146:147], v220 offset:26624
    v_mfma_f32_16x16x32_bf16 v[64:67], v[128:131], a[56:59], v[64:67]
    ds_read_b64_tr_b16 v[148:149], v221 offset:24576
    v_mfma_f32_16x16x32_bf16 v[68:71], v[128:131], a[60:63], v[68:71]
    ds_read_b64_tr_b16 v[150:151], v221 offset:26624
    v_mfma_f32_16x16x32_bf16 v[40:43], v[132:135], a[48:51], v[40:43]
    ds_read_b64_tr_b16 v[152:153], v222 offset:24576
    v_mfma_f32_16x16x32_bf16 v[44:47], v[132:135], a[52:55], v[44:47]
    ds_read_b64_tr_b16 v[154:155], v222 offset:26624
    v_mfma_f32_16x16x32_bf16 v[72:75], v[132:135], a[56:59], v[72:75]
    ds_read_b64_tr_b16 v[156:157], v223 offset:24576
    v_mfma_f32_16x16x32_bf16 v[76:79], v[132:135], a[60:63], v[76:79]
    ds_read_b64_tr_b16 v[158:159], v223 offset:26624
    v_mfma_f32_16x16x32_bf16 v[48:51], v[136:139], a[48:51], v[48:51]
    buffer_load_dwordx4 a[24:27], v245, s[8:11], s35 offen offset:1024 sc1
    v_mfma_f32_16x16x32_bf16 v[52:55], v[136:139], a[52:55], v[52:55]
    s_add_u32 m0, s38, 122880
    s_add_u32 s32, s37, 2031616
    v_mfma_f32_16x16x32_bf16 v[80:83], v[136:139], a[56:59], v[80:83]
    buffer_load_dwordx4 v224, s[12:15], s32 offen lds
    v_mfma_f32_16x16x32_bf16 v[84:87], v[136:139], a[60:63], v[84:87]
    buffer_load_dwordx4 a[28:31], v246, s[8:11], s35 offen offset:1024 sc1
    v_mfma_f32_16x16x32_bf16 v[56:59], v[140:143], a[48:51], v[56:59]
    v_mfma_f32_16x16x32_bf16 v[60:63], v[140:143], a[52:55], v[60:63]
    buffer_load_dwordx4 v225, s[12:15], s32 offen offset:1024 lds
    v_mfma_f32_16x16x32_bf16 v[88:91], v[140:143], a[56:59], v[88:91]
    v_mfma_f32_16x16x32_bf16 v[92:95], v[140:143], a[60:63], v[92:95]
    s_waitcnt vmcnt(63) lgkmcnt(0)
    s_barrier
    v_mfma_f32_16x16x32_bf16 v[0:3], v[144:147], a[48:51], v[0:3]
    ds_read_b64_tr_b16 v[128:129], v216 offset:32768
    v_mfma_f32_16x16x32_bf16 v[4:7], v[144:147], a[52:55], v[4:7]
    ds_read_b64_tr_b16 v[130:131], v216 offset:34816
    v_mfma_f32_16x16x32_bf16 v[96:99], v[144:147], a[56:59], v[96:99]
    ds_read_b64_tr_b16 v[132:133], v217 offset:32768
    v_mfma_f32_16x16x32_bf16 v[100:103], v[144:147], a[60:63], v[100:103]
    ds_read_b64_tr_b16 v[134:135], v217 offset:34816
    v_mfma_f32_16x16x32_bf16 v[8:11], v[148:151], a[48:51], v[8:11]
    ds_read_b64_tr_b16 v[136:137], v218 offset:32768
    v_mfma_f32_16x16x32_bf16 v[12:15], v[148:151], a[52:55], v[12:15]
    ds_read_b64_tr_b16 v[138:139], v218 offset:34816
    v_mfma_f32_16x16x32_bf16 v[104:107], v[148:151], a[56:59], v[104:107]
    ds_read_b64_tr_b16 v[140:141], v219 offset:32768
    v_mfma_f32_16x16x32_bf16 v[108:111], v[148:151], a[60:63], v[108:111]
    ds_read_b64_tr_b16 v[142:143], v219 offset:34816
    v_mfma_f32_16x16x32_bf16 v[16:19], v[152:155], a[48:51], v[16:19]
    buffer_load_dwordx4 a[32:35], v226, s[8:11], s35 offen offset:2048 sc1
    v_mfma_f32_16x16x32_bf16 v[20:23], v[152:155], a[52:55], v[20:23]
    v_mfma_f32_16x16x32_bf16 v[112:115], v[152:155], a[56:59], v[112:115]
    v_mfma_f32_16x16x32_bf16 v[116:119], v[152:155], a[60:63], v[116:119]
    v_mfma_f32_16x16x32_bf16 v[24:27], v[156:159], a[48:51], v[24:27]
    buffer_load_dwordx4 a[36:39], v227, s[8:11], s35 offen offset:2048 sc1
    v_mfma_f32_16x16x32_bf16 v[28:31], v[156:159], a[52:55], v[28:31]
    v_mfma_f32_16x16x32_bf16 v[120:123], v[156:159], a[56:59], v[120:123]
    v_mfma_f32_16x16x32_bf16 v[124:127], v[156:159], a[60:63], v[124:127]
    s_waitcnt vmcnt(38) lgkmcnt(0)
    v_mfma_f32_16x16x32_bf16 v[32:35], v[128:131], a[64:67], v[32:35]
    ds_read_b64_tr_b16 v[144:145], v220 offset:32768
    v_mfma_f32_16x16x32_bf16 v[36:39], v[128:131], a[68:71], v[36:39]
    ds_read_b64_tr_b16 v[146:147], v220 offset:34816
    v_mfma_f32_16x16x32_bf16 v[64:67], v[128:131], a[72:75], v[64:67]
    ds_read_b64_tr_b16 v[148:149], v221 offset:32768
    v_mfma_f32_16x16x32_bf16 v[68:71], v[128:131], a[76:79], v[68:71]
    ds_read_b64_tr_b16 v[150:151], v221 offset:34816
    v_mfma_f32_16x16x32_bf16 v[40:43], v[132:135], a[64:67], v[40:43]
    ds_read_b64_tr_b16 v[152:153], v222 offset:32768
    v_mfma_f32_16x16x32_bf16 v[44:47], v[132:135], a[68:71], v[44:47]
    ds_read_b64_tr_b16 v[154:155], v222 offset:34816
    v_mfma_f32_16x16x32_bf16 v[72:75], v[132:135], a[72:75], v[72:75]
    ds_read_b64_tr_b16 v[156:157], v223 offset:32768
    v_mfma_f32_16x16x32_bf16 v[76:79], v[132:135], a[76:79], v[76:79]
    ds_read_b64_tr_b16 v[158:159], v223 offset:34816
    v_mfma_f32_16x16x32_bf16 v[48:51], v[136:139], a[64:67], v[48:51]
    buffer_load_dwordx4 a[40:43], v245, s[8:11], s35 offen offset:2048 sc1
    v_mfma_f32_16x16x32_bf16 v[52:55], v[136:139], a[68:71], v[52:55]
    v_mfma_f32_16x16x32_bf16 v[80:83], v[136:139], a[72:75], v[80:83]
    v_mfma_f32_16x16x32_bf16 v[84:87], v[136:139], a[76:79], v[84:87]
    buffer_load_dwordx4 a[44:47], v246, s[8:11], s35 offen offset:2048 sc1
    v_mfma_f32_16x16x32_bf16 v[56:59], v[140:143], a[64:67], v[56:59]
    v_mfma_f32_16x16x32_bf16 v[60:63], v[140:143], a[68:71], v[60:63]
    s_mov_b32 s32, 0
    buffer_load_dwordx4 v[192:195], v229, s[16:19], s32 offen
    v_mfma_f32_16x16x32_bf16 v[88:91], v[140:143], a[72:75], v[88:91]
    v_mfma_f32_16x16x32_bf16 v[92:95], v[140:143], a[76:79], v[92:95]
    s_waitcnt lgkmcnt(0)
    v_mfma_f32_16x16x32_bf16 v[0:3], v[144:147], a[64:67], v[0:3]
    ds_read_b64_tr_b16 v[128:129], v216 offset:40960
    v_mfma_f32_16x16x32_bf16 v[4:7], v[144:147], a[68:71], v[4:7]
    ds_read_b64_tr_b16 v[130:131], v216 offset:43008
    v_mfma_f32_16x16x32_bf16 v[96:99], v[144:147], a[72:75], v[96:99]
    ds_read_b64_tr_b16 v[132:133], v217 offset:40960
    v_mfma_f32_16x16x32_bf16 v[100:103], v[144:147], a[76:79], v[100:103]
    ds_read_b64_tr_b16 v[134:135], v217 offset:43008
    v_mfma_f32_16x16x32_bf16 v[8:11], v[148:151], a[64:67], v[8:11]
    ds_read_b64_tr_b16 v[136:137], v218 offset:40960
    v_mfma_f32_16x16x32_bf16 v[12:15], v[148:151], a[68:71], v[12:15]
    ds_read_b64_tr_b16 v[138:139], v218 offset:43008
    v_mfma_f32_16x16x32_bf16 v[104:107], v[148:151], a[72:75], v[104:107]
    ds_read_b64_tr_b16 v[140:141], v219 offset:40960
    v_mfma_f32_16x16x32_bf16 v[108:111], v[148:151], a[76:79], v[108:111]
    ds_read_b64_tr_b16 v[142:143], v219 offset:43008
    v_mfma_f32_16x16x32_bf16 v[16:19], v[152:155], a[64:67], v[16:19]
    buffer_load_dwordx4 a[48:51], v226, s[8:11], s35 offen offset:3072 sc1
    v_mfma_f32_16x16x32_bf16 v[20:23], v[152:155], a[68:71], v[20:23]
    v_mfma_f32_16x16x32_bf16 v[112:115], v[152:155], a[72:75], v[112:115]
    v_mfma_f32_16x16x32_bf16 v[116:119], v[152:155], a[76:79], v[116:119]
    v_mfma_f32_16x16x32_bf16 v[24:27], v[156:159], a[64:67], v[24:27]
    buffer_load_dwordx4 a[52:55], v227, s[8:11], s35 offen offset:3072 sc1
    v_mfma_f32_16x16x32_bf16 v[28:31], v[156:159], a[68:71], v[28:31]
    s_mov_b32 s32, 16384
    buffer_load_dwordx4 v[196:199], v229, s[16:19], s32 offen
    v_mfma_f32_16x16x32_bf16 v[120:123], v[156:159], a[72:75], v[120:123]
    v_mfma_f32_16x16x32_bf16 v[124:127], v[156:159], a[76:79], v[124:127]
    buffer_load_dwordx4 a[56:59], v245, s[8:11], s35 offen offset:3072 sc1
    s_waitcnt vmcnt(38) lgkmcnt(0)
    v_mfma_f32_16x16x32_bf16 v[32:35], v[128:131], a[80:83], v[32:35]
    ds_read_b64_tr_b16 v[144:145], v220 offset:40960
    v_mfma_f32_16x16x32_bf16 v[36:39], v[128:131], a[84:87], v[36:39]
    ds_read_b64_tr_b16 v[146:147], v220 offset:43008
    v_mfma_f32_16x16x32_bf16 v[64:67], v[128:131], a[88:91], v[64:67]
    ds_read_b64_tr_b16 v[148:149], v221 offset:40960
    v_mfma_f32_16x16x32_bf16 v[68:71], v[128:131], a[92:95], v[68:71]
    ds_read_b64_tr_b16 v[150:151], v221 offset:43008
    v_mfma_f32_16x16x32_bf16 v[40:43], v[132:135], a[80:83], v[40:43]
    ds_read_b64_tr_b16 v[152:153], v222 offset:40960
    v_mfma_f32_16x16x32_bf16 v[44:47], v[132:135], a[84:87], v[44:47]
    ds_read_b64_tr_b16 v[154:155], v222 offset:43008
    v_mfma_f32_16x16x32_bf16 v[72:75], v[132:135], a[88:91], v[72:75]
    ds_read_b64_tr_b16 v[156:157], v223 offset:40960
    v_mfma_f32_16x16x32_bf16 v[76:79], v[132:135], a[92:95], v[76:79]
    ds_read_b64_tr_b16 v[158:159], v223 offset:43008
    v_mfma_f32_16x16x32_bf16 v[48:51], v[136:139], a[80:83], v[48:51]
    buffer_load_dwordx4 a[60:63], v246, s[8:11], s35 offen offset:3072 sc1
    v_mfma_f32_16x16x32_bf16 v[52:55], v[136:139], a[84:87], v[52:55]
    v_mfma_f32_16x16x32_bf16 v[80:83], v[136:139], a[88:91], v[80:83]
    v_mfma_f32_16x16x32_bf16 v[84:87], v[136:139], a[92:95], v[84:87]
    s_add_u32 s35, s35, 4096
    buffer_load_dwordx4 a[64:67], v226, s[8:11], s35 offen offset:0 sc1
    v_mfma_f32_16x16x32_bf16 v[56:59], v[140:143], a[80:83], v[56:59]
    v_mfma_f32_16x16x32_bf16 v[60:63], v[140:143], a[84:87], v[60:63]
    s_mov_b32 s32, 32768
    buffer_load_dwordx4 v[200:203], v229, s[16:19], s32 offen
    v_mfma_f32_16x16x32_bf16 v[88:91], v[140:143], a[88:91], v[88:91]
    v_mfma_f32_16x16x32_bf16 v[92:95], v[140:143], a[92:95], v[92:95]
    s_waitcnt lgkmcnt(0)
    v_mfma_f32_16x16x32_bf16 v[0:3], v[144:147], a[80:83], v[0:3]
    ds_read_b64_tr_b16 v[128:129], v216 offset:49152
    v_mfma_f32_16x16x32_bf16 v[4:7], v[144:147], a[84:87], v[4:7]
    ds_read_b64_tr_b16 v[130:131], v216 offset:51200
    v_mfma_f32_16x16x32_bf16 v[96:99], v[144:147], a[88:91], v[96:99]
    ds_read_b64_tr_b16 v[132:133], v217 offset:49152
    v_mfma_f32_16x16x32_bf16 v[100:103], v[144:147], a[92:95], v[100:103]
    ds_read_b64_tr_b16 v[134:135], v217 offset:51200
    v_mfma_f32_16x16x32_bf16 v[8:11], v[148:151], a[80:83], v[8:11]
    ds_read_b64_tr_b16 v[136:137], v218 offset:49152
    v_mfma_f32_16x16x32_bf16 v[12:15], v[148:151], a[84:87], v[12:15]
    ds_read_b64_tr_b16 v[138:139], v218 offset:51200
    v_mfma_f32_16x16x32_bf16 v[104:107], v[148:151], a[88:91], v[104:107]
    ds_read_b64_tr_b16 v[140:141], v219 offset:49152
    v_mfma_f32_16x16x32_bf16 v[108:111], v[148:151], a[92:95], v[108:111]
    ds_read_b64_tr_b16 v[142:143], v219 offset:51200
    v_mfma_f32_16x16x32_bf16 v[16:19], v[152:155], a[80:83], v[16:19]
    buffer_load_dwordx4 a[68:71], v227, s[8:11], s35 offen offset:0 sc1
    v_mfma_f32_16x16x32_bf16 v[20:23], v[152:155], a[84:87], v[20:23]
    v_mfma_f32_16x16x32_bf16 v[112:115], v[152:155], a[88:91], v[112:115]
    v_mfma_f32_16x16x32_bf16 v[116:119], v[152:155], a[92:95], v[116:119]
    v_mfma_f32_16x16x32_bf16 v[24:27], v[156:159], a[80:83], v[24:27]
    buffer_load_dwordx4 a[72:75], v245, s[8:11], s35 offen offset:0 sc1
    v_mfma_f32_16x16x32_bf16 v[28:31], v[156:159], a[84:87], v[28:31]
    s_mov_b32 s32, 49152
    buffer_load_dwordx4 v[204:207], v229, s[16:19], s32 offen
    v_mfma_f32_16x16x32_bf16 v[120:123], v[156:159], a[88:91], v[120:123]
    v_mfma_f32_16x16x32_bf16 v[124:127], v[156:159], a[92:95], v[124:127]
    s_waitcnt vmcnt(36) lgkmcnt(0)
    v_mfma_f32_16x16x32_bf16 v[32:35], v[128:131], a[96:99], v[32:35]
    ds_read_b64_tr_b16 v[144:145], v220 offset:49152
    v_mfma_f32_16x16x32_bf16 v[36:39], v[128:131], a[100:103], v[36:39]
    ds_read_b64_tr_b16 v[146:147], v220 offset:51200
    v_mfma_f32_16x16x32_bf16 v[64:67], v[128:131], a[104:107], v[64:67]
    ds_read_b64_tr_b16 v[148:149], v221 offset:49152
    v_mfma_f32_16x16x32_bf16 v[68:71], v[128:131], a[108:111], v[68:71]
    ds_read_b64_tr_b16 v[150:151], v221 offset:51200
    v_mfma_f32_16x16x32_bf16 v[40:43], v[132:135], a[96:99], v[40:43]
    ds_read_b64_tr_b16 v[152:153], v222 offset:49152
    v_mfma_f32_16x16x32_bf16 v[44:47], v[132:135], a[100:103], v[44:47]
    ds_read_b64_tr_b16 v[154:155], v222 offset:51200
    v_mfma_f32_16x16x32_bf16 v[72:75], v[132:135], a[104:107], v[72:75]
    ds_read_b64_tr_b16 v[156:157], v223 offset:49152
    v_mfma_f32_16x16x32_bf16 v[76:79], v[132:135], a[108:111], v[76:79]
    ds_read_b64_tr_b16 v[158:159], v223 offset:51200
    v_mfma_f32_16x16x32_bf16 v[48:51], v[136:139], a[96:99], v[48:51]
    buffer_load_dwordx4 a[76:79], v246, s[8:11], s35 offen offset:0 sc1
    v_mfma_f32_16x16x32_bf16 v[52:55], v[136:139], a[100:103], v[52:55]
    v_mfma_f32_16x16x32_bf16 v[80:83], v[136:139], a[104:107], v[80:83]
    v_mfma_f32_16x16x32_bf16 v[84:87], v[136:139], a[108:111], v[84:87]
    buffer_load_dwordx4 a[80:83], v226, s[8:11], s35 offen offset:1024 sc1
    v_mfma_f32_16x16x32_bf16 v[56:59], v[140:143], a[96:99], v[56:59]
    v_mfma_f32_16x16x32_bf16 v[60:63], v[140:143], a[100:103], v[60:63]
    buffer_load_dwordx4 v[208:211], v240, s[20:23], 0 offen
    v_mfma_f32_16x16x32_bf16 v[88:91], v[140:143], a[104:107], v[88:91]
    v_mfma_f32_16x16x32_bf16 v[92:95], v[140:143], a[108:111], v[92:95]
    s_waitcnt lgkmcnt(0)
    v_mfma_f32_16x16x32_bf16 v[0:3], v[144:147], a[96:99], v[0:3]
    ds_read_b64_tr_b16 v[128:129], v216 offset:57344
    v_mfma_f32_16x16x32_bf16 v[4:7], v[144:147], a[100:103], v[4:7]
    ds_read_b64_tr_b16 v[130:131], v216 offset:59392
    v_mfma_f32_16x16x32_bf16 v[96:99], v[144:147], a[104:107], v[96:99]
    ds_read_b64_tr_b16 v[132:133], v217 offset:57344
    v_mfma_f32_16x16x32_bf16 v[100:103], v[144:147], a[108:111], v[100:103]
    ds_read_b64_tr_b16 v[134:135], v217 offset:59392
    v_mfma_f32_16x16x32_bf16 v[8:11], v[148:151], a[96:99], v[8:11]
    ds_read_b64_tr_b16 v[136:137], v218 offset:57344
    v_mfma_f32_16x16x32_bf16 v[12:15], v[148:151], a[100:103], v[12:15]
    ds_read_b64_tr_b16 v[138:139], v218 offset:59392
    v_mfma_f32_16x16x32_bf16 v[104:107], v[148:151], a[104:107], v[104:107]
    ds_read_b64_tr_b16 v[140:141], v219 offset:57344
    v_mfma_f32_16x16x32_bf16 v[108:111], v[148:151], a[108:111], v[108:111]
    ds_read_b64_tr_b16 v[142:143], v219 offset:59392
    v_mfma_f32_16x16x32_bf16 v[16:19], v[152:155], a[96:99], v[16:19]
    buffer_load_dwordx4 a[84:87], v227, s[8:11], s35 offen offset:1024 sc1
    v_mfma_f32_16x16x32_bf16 v[20:23], v[152:155], a[100:103], v[20:23]
    v_mfma_f32_16x16x32_bf16 v[112:115], v[152:155], a[104:107], v[112:115]
    v_mfma_f32_16x16x32_bf16 v[116:119], v[152:155], a[108:111], v[116:119]
    v_mfma_f32_16x16x32_bf16 v[24:27], v[156:159], a[96:99], v[24:27]
    buffer_load_dwordx4 a[88:91], v245, s[8:11], s35 offen offset:1024 sc1
    v_mfma_f32_16x16x32_bf16 v[28:31], v[156:159], a[100:103], v[28:31]
    s_mov_b32 s32, kc_tail-kc_pc0
    v_lshlrev_b32 v234, 7, v230
    buffer_load_dword v241, v234, s[56:59], s32 offen
    v_mfma_f32_16x16x32_bf16 v[120:123], v[156:159], a[104:107], v[120:123]
    v_mfma_f32_16x16x32_bf16 v[124:127], v[156:159], a[108:111], v[124:127]
    buffer_load_dwordx4 a[92:95], v246, s[8:11], s35 offen offset:1024 sc1
    s_waitcnt vmcnt(35) lgkmcnt(0)
    v_mfma_f32_16x16x32_bf16 v[32:35], v[128:131], a[112:115], v[32:35]
    ds_read_b64_tr_b16 v[144:145], v220 offset:57344
    v_mfma_f32_16x16x32_bf16 v[36:39], v[128:131], a[116:119], v[36:39]
    ds_read_b64_tr_b16 v[146:147], v220 offset:59392
    v_mfma_f32_16x16x32_bf16 v[64:67], v[128:131], a[120:123], v[64:67]
    ds_read_b64_tr_b16 v[148:149], v221 offset:57344
    v_mfma_f32_16x16x32_bf16 v[68:71], v[128:131], a[124:127], v[68:71]
    ds_read_b64_tr_b16 v[150:151], v221 offset:59392
    v_mfma_f32_16x16x32_bf16 v[40:43], v[132:135], a[112:115], v[40:43]
    ds_read_b64_tr_b16 v[152:153], v222 offset:57344
    v_mfma_f32_16x16x32_bf16 v[44:47], v[132:135], a[116:119], v[44:47]
    ds_read_b64_tr_b16 v[154:155], v222 offset:59392
    v_mfma_f32_16x16x32_bf16 v[72:75], v[132:135], a[120:123], v[72:75]
    ds_read_b64_tr_b16 v[156:157], v223 offset:57344
    v_mfma_f32_16x16x32_bf16 v[76:79], v[132:135], a[124:127], v[76:79]
    ds_read_b64_tr_b16 v[158:159], v223 offset:59392
    v_mfma_f32_16x16x32_bf16 v[48:51], v[136:139], a[112:115], v[48:51]
    buffer_load_dwordx4 a[96:99], v226, s[8:11], s35 offen offset:2048 sc1
    v_mfma_f32_16x16x32_bf16 v[52:55], v[136:139], a[116:119], v[52:55]
    v_mfma_f32_16x16x32_bf16 v[80:83], v[136:139], a[120:123], v[80:83]
    v_mfma_f32_16x16x32_bf16 v[84:87], v[136:139], a[124:127], v[84:87]
    buffer_load_dwordx4 a[100:103], v227, s[8:11], s35 offen offset:2048 sc1
    v_mfma_f32_16x16x32_bf16 v[56:59], v[140:143], a[112:115], v[56:59]
    v_mfma_f32_16x16x32_bf16 v[60:63], v[140:143], a[116:119], v[60:63]
    v_mfma_f32_16x16x32_bf16 v[88:91], v[140:143], a[120:123], v[88:91]
    v_mfma_f32_16x16x32_bf16 v[92:95], v[140:143], a[124:127], v[92:95]
    s_waitcnt vmcnt(24) lgkmcnt(0)
    s_barrier
    v_mfma_f32_16x16x32_bf16 v[0:3], v[144:147], a[112:115], v[0:3]
    v_xor_b32 v220, 0x10000, v220
    ds_read_b64_tr_b16 v[128:129], v220 offset:0
    v_mfma_f32_16x16x32_bf16 v[4:7], v[144:147], a[116:119], v[4:7]
    ds_read_b64_tr_b16 v[130:131], v220 offset:2048
    v_mfma_f32_16x16x32_bf16 v[96:99], v[144:147], a[120:123], v[96:99]
    v_xor_b32 v221, 0x10000, v221
    ds_read_b64_tr_b16 v[132:133], v221 offset:0
    v_mfma_f32_16x16x32_bf16 v[100:103], v[144:147], a[124:127], v[100:103]
    ds_read_b64_tr_b16 v[134:135], v221 offset:2048
    v_mfma_f32_16x16x32_bf16 v[8:11], v[148:151], a[112:115], v[8:11]
    v_xor_b32 v222, 0x10000, v222
    ds_read_b64_tr_b16 v[136:137], v222 offset:0
    v_mfma_f32_16x16x32_bf16 v[12:15], v[148:151], a[116:119], v[12:15]
    ds_read_b64_tr_b16 v[138:139], v222 offset:2048
    v_mfma_f32_16x16x32_bf16 v[104:107], v[148:151], a[120:123], v[104:107]
    v_xor_b32 v223, 0x10000, v223
    ds_read_b64_tr_b16 v[140:141], v223 offset:0
    v_mfma_f32_16x16x32_bf16 v[108:111], v[148:151], a[124:127], v[108:111]
    ds_read_b64_tr_b16 v[142:143], v223 offset:2048
    v_mfma_f32_16x16x32_bf16 v[16:19], v[152:155], a[112:115], v[16:19]
    buffer_load_dwordx4 a[104:107], v245, s[8:11], s35 offen offset:2048 sc1
    v_mfma_f32_16x16x32_bf16 v[20:23], v[152:155], a[116:119], v[20:23]
    v_xor_b32 v216, 0x10000, v216
    v_mfma_f32_16x16x32_bf16 v[112:115], v[152:155], a[120:123], v[112:115]
    v_xor_b32 v217, 0x10000, v217
    v_mfma_f32_16x16x32_bf16 v[116:119], v[152:155], a[124:127], v[116:119]
    v_xor_b32 v218, 0x10000, v218
    v_mfma_f32_16x16x32_bf16 v[24:27], v[156:159], a[112:115], v[24:27]
    v_xor_b32 v219, 0x10000, v219
    buffer_load_dwordx4 a[108:111], v246, s[8:11], s35 offen offset:2048 sc1
    v_mfma_f32_16x16x32_bf16 v[28:31], v[156:159], a[116:119], v[28:31]
    v_mfma_f32_16x16x32_bf16 v[120:123], v[156:159], a[120:123], v[120:123]
    v_mfma_f32_16x16x32_bf16 v[124:127], v[156:159], a[124:127], v[124:127]
    s_waitcnt vmcnt(32) lgkmcnt(4)
    v_mfma_f32_16x16x32_bf16 v[96:99], v[128:131], a[8:11], v[96:99]
    ds_read_b64_tr_b16 v[144:145], v220 offset:8192
    v_mfma_f32_16x16x32_bf16 v[100:103], v[128:131], a[12:15], v[100:103]
    ds_read_b64_tr_b16 v[146:147], v220 offset:10240
    v_mfma_f32_16x16x32_bf16 v[104:107], v[132:135], a[8:11], v[104:107]
    ds_read_b64_tr_b16 v[148:149], v221 offset:8192
    buffer_load_dwordx4 a[112:115], v226, s[8:11], s35 offen offset:3072 sc1
    v_mfma_f32_16x16x32_bf16 v[108:111], v[132:135], a[12:15], v[108:111]
    ds_read_b64_tr_b16 v[150:151], v221 offset:10240
    s_waitcnt lgkmcnt(4)
    v_mfma_f32_16x16x32_bf16 v[112:115], v[136:139], a[8:11], v[112:115]
    ds_read_b64_tr_b16 v[152:153], v222 offset:8192
    v_mfma_f32_16x16x32_bf16 v[116:119], v[136:139], a[12:15], v[116:119]
    ds_read_b64_tr_b16 v[154:155], v222 offset:10240
    v_mfma_f32_16x16x32_bf16 v[120:123], v[140:143], a[8:11], v[120:123]
    ds_read_b64_tr_b16 v[156:157], v223 offset:8192
    buffer_load_dwordx4 a[116:119], v227, s[8:11], s35 offen offset:3072 sc1
    v_mfma_f32_16x16x32_bf16 v[124:127], v[140:143], a[12:15], v[124:127]
    ds_read_b64_tr_b16 v[158:159], v223 offset:10240
    s_waitcnt vmcnt(29) lgkmcnt(4)
    v_mfma_f32_16x16x32_bf16 v[96:99], v[144:147], a[24:27], v[96:99]
    ds_read_b64_tr_b16 v[128:129], v220 offset:16384
    v_mfma_f32_16x16x32_bf16 v[100:103], v[144:147], a[28:31], v[100:103]
    ds_read_b64_tr_b16 v[130:131], v220 offset:18432
    v_mfma_f32_16x16x32_bf16 v[104:107], v[148:151], a[24:27], v[104:107]
    ds_read_b64_tr_b16 v[132:133], v221 offset:16384
    buffer_load_dwordx4 a[120:123], v245, s[8:11], s35 offen offset:3072 sc1
    v_mfma_f32_16x16x32_bf16 v[108:111], v[148:151], a[28:31], v[108:111]
    ds_read_b64_tr_b16 v[134:135], v221 offset:18432
    s_waitcnt lgkmcnt(4)
    v_mfma_f32_16x16x32_bf16 v[112:115], v[152:155], a[24:27], v[112:115]
    ds_read_b64_tr_b16 v[136:137], v222 offset:16384
    v_mfma_f32_16x16x32_bf16 v[116:119], v[152:155], a[28:31], v[116:119]
    ds_read_b64_tr_b16 v[138:139], v222 offset:18432
    v_mfma_f32_16x16x32_bf16 v[120:123], v[156:159], a[24:27], v[120:123]
    ds_read_b64_tr_b16 v[140:141], v223 offset:16384
    buffer_load_dwordx4 a[124:127], v246, s[8:11], s35 offen offset:3072 sc1
    v_mfma_f32_16x16x32_bf16 v[124:127], v[156:159], a[28:31], v[124:127]
    ds_read_b64_tr_b16 v[142:143], v223 offset:18432
    s_waitcnt vmcnt(26) lgkmcnt(4)
    v_mfma_f32_16x16x32_bf16 v[96:99], v[128:131], a[40:43], v[96:99]
    ds_read_b64_tr_b16 v[144:145], v220 offset:24576
    v_mfma_f32_16x16x32_bf16 v[100:103], v[128:131], a[44:47], v[100:103]
    ds_read_b64_tr_b16 v[146:147], v220 offset:26624
    v_mfma_f32_16x16x32_bf16 v[104:107], v[132:135], a[40:43], v[104:107]
    ds_read_b64_tr_b16 v[148:149], v221 offset:24576
    v_mfma_f32_16x16x32_bf16 v[108:111], v[132:135], a[44:47], v[108:111]
    ds_read_b64_tr_b16 v[150:151], v221 offset:26624
    s_waitcnt lgkmcnt(4)
    v_mfma_f32_16x16x32_bf16 v[112:115], v[136:139], a[40:43], v[112:115]
    ds_read_b64_tr_b16 v[152:153], v222 offset:24576
    v_mfma_f32_16x16x32_bf16 v[116:119], v[136:139], a[44:47], v[116:119]
    ds_read_b64_tr_b16 v[154:155], v222 offset:26624
    v_mfma_f32_16x16x32_bf16 v[120:123], v[140:143], a[40:43], v[120:123]
    ds_read_b64_tr_b16 v[156:157], v223 offset:24576
    v_mfma_f32_16x16x32_bf16 v[124:127], v[140:143], a[44:47], v[124:127]
    ds_read_b64_tr_b16 v[158:159], v223 offset:26624
    s_waitcnt vmcnt(20) lgkmcnt(4)
    v_mfma_f32_16x16x32_bf16 v[96:99], v[144:147], a[56:59], v[96:99]
    ds_read_b64_tr_b16 v[128:129], v220 offset:32768
    v_mfma_f32_16x16x32_bf16 v[100:103], v[144:147], a[60:63], v[100:103]
    ds_read_b64_tr_b16 v[130:131], v220 offset:34816
    v_mfma_f32_16x16x32_bf16 v[104:107], v[148:151], a[56:59], v[104:107]
    ds_read_b64_tr_b16 v[132:133], v221 offset:32768
    v_mfma_f32_16x16x32_bf16 v[108:111], v[148:151], a[60:63], v[108:111]
    ds_read_b64_tr_b16 v[134:135], v221 offset:34816
    s_waitcnt lgkmcnt(4)
    v_mfma_f32_16x16x32_bf16 v[112:115], v[152:155], a[56:59], v[112:115]
    ds_read_b64_tr_b16 v[136:137], v222 offset:32768
    v_mfma_f32_16x16x32_bf16 v[116:119], v[152:155], a[60:63], v[116:119]
    ds_read_b64_tr_b16 v[138:139], v222 offset:34816
    v_mfma_f32_16x16x32_bf16 v[120:123], v[156:159], a[56:59], v[120:123]
    ds_read_b64_tr_b16 v[140:141], v223 offset:32768
    v_mfma_f32_16x16x32_bf16 v[124:127], v[156:159], a[60:63], v[124:127]
    ds_read_b64_tr_b16 v[142:143], v223 offset:34816
    s_waitcnt vmcnt(14) lgkmcnt(4)
    v_mfma_f32_16x16x32_bf16 v[96:99], v[128:131], a[72:75], v[96:99]
    ds_read_b64_tr_b16 v[144:145], v220 offset:40960
    v_mfma_f32_16x16x32_bf16 v[100:103], v[128:131], a[76:79], v[100:103]
    ds_read_b64_tr_b16 v[146:147], v220 offset:43008
    s_xor_b32 s7, s39, 24
    v_mfma_f32_16x16x32_bf16 v[104:107], v[132:135], a[72:75], v[104:107]
    ds_read_b64_tr_b16 v[148:149], v221 offset:40960
    v_mfma_f32_16x16x32_bf16 v[108:111], v[132:135], a[76:79], v[108:111]
    ds_read_b64_tr_b16 v[150:151], v221 offset:43008
    s_waitcnt lgkmcnt(4)
    v_mfma_f32_16x16x32_bf16 v[112:115], v[136:139], a[72:75], v[112:115]
    ds_read_b64_tr_b16 v[152:153], v222 offset:40960
    v_mfma_f32_16x16x32_bf16 v[116:119], v[136:139], a[76:79], v[116:119]
    ds_read_b64_tr_b16 v[154:155], v222 offset:43008
    s_mul_i32 s7, s7, 12288
    v_mfma_f32_16x16x32_bf16 v[120:123], v[140:143], a[72:75], v[120:123]
    ds_read_b64_tr_b16 v[156:157], v223 offset:40960
    s_add_u32 s7, s7, 0x5002000
    v_mfma_f32_16x16x32_bf16 v[124:127], v[140:143], a[76:79], v[124:127]
    ds_read_b64_tr_b16 v[158:159], v223 offset:43008
    s_waitcnt vmcnt(8) lgkmcnt(4)
    v_mfma_f32_16x16x32_bf16 v[96:99], v[144:147], a[88:91], v[96:99]
    ds_read_b64_tr_b16 v[128:129], v220 offset:49152
    v_mfma_f32_16x16x32_bf16 v[100:103], v[144:147], a[92:95], v[100:103]
    ds_read_b64_tr_b16 v[130:131], v220 offset:51200
    s_xor_b32 s37, s39, 8
    v_mfma_f32_16x16x32_bf16 v[104:107], v[148:151], a[88:91], v[104:107]
    ds_read_b64_tr_b16 v[132:133], v221 offset:49152
    v_mfma_f32_16x16x32_bf16 v[108:111], v[148:151], a[92:95], v[108:111]
    ds_read_b64_tr_b16 v[134:135], v221 offset:51200
    s_waitcnt lgkmcnt(4)
    v_mfma_f32_16x16x32_bf16 v[112:115], v[152:155], a[88:91], v[112:115]
    ds_read_b64_tr_b16 v[136:137], v222 offset:49152
    v_mfma_f32_16x16x32_bf16 v[116:119], v[152:155], a[92:95], v[116:119]
    ds_read_b64_tr_b16 v[138:139], v222 offset:51200
    s_mul_i32 s37, s37, 12288
    v_mfma_f32_16x16x32_bf16 v[120:123], v[156:159], a[88:91], v[120:123]
    ds_read_b64_tr_b16 v[140:141], v223 offset:49152
    s_add_u32 s37, s37, 0x5000000
    v_mfma_f32_16x16x32_bf16 v[124:127], v[156:159], a[92:95], v[124:127]
    ds_read_b64_tr_b16 v[142:143], v223 offset:51200
    s_waitcnt vmcnt(4) lgkmcnt(4)
    v_mfma_f32_16x16x32_bf16 v[96:99], v[128:131], a[104:107], v[96:99]
    ds_read_b64_tr_b16 v[144:145], v220 offset:57344
    v_mfma_f32_16x16x32_bf16 v[100:103], v[128:131], a[108:111], v[100:103]
    ds_read_b64_tr_b16 v[146:147], v220 offset:59392
    s_xor_b32 s38, s39, 16
    v_mfma_f32_16x16x32_bf16 v[104:107], v[132:135], a[104:107], v[104:107]
    ds_read_b64_tr_b16 v[148:149], v221 offset:57344
    v_mfma_f32_16x16x32_bf16 v[108:111], v[132:135], a[108:111], v[108:111]
    ds_read_b64_tr_b16 v[150:151], v221 offset:59392
    s_waitcnt lgkmcnt(4)
    v_mfma_f32_16x16x32_bf16 v[112:115], v[136:139], a[104:107], v[112:115]
    ds_read_b64_tr_b16 v[152:153], v222 offset:57344
    v_mfma_f32_16x16x32_bf16 v[116:119], v[136:139], a[108:111], v[116:119]
    ds_read_b64_tr_b16 v[154:155], v222 offset:59392
    s_mul_i32 s38, s38, 12288
    v_mfma_f32_16x16x32_bf16 v[120:123], v[140:143], a[104:107], v[120:123]
    ds_read_b64_tr_b16 v[156:157], v223 offset:57344
    s_add_u32 s38, s38, 0x5001000
    v_mfma_f32_16x16x32_bf16 v[124:127], v[140:143], a[108:111], v[124:127]
    ds_read_b64_tr_b16 v[158:159], v223 offset:59392
    s_waitcnt vmcnt(0) lgkmcnt(4)
    v_mfma_f32_16x16x32_bf16 v[96:99], v[144:147], a[120:123], v[96:99]
    ds_read_b64_tr_b16 v[128:129], v220 offset:0
    v_mfma_f32_16x16x32_bf16 v[100:103], v[144:147], a[124:127], v[100:103]
    ds_read_b64_tr_b16 v[130:131], v220 offset:2048
    v_mfma_f32_16x16x32_bf16 v[104:107], v[148:151], a[120:123], v[104:107]
    ds_read_b64_tr_b16 v[132:133], v221 offset:0
    v_mfma_f32_16x16x32_bf16 v[108:111], v[148:151], a[124:127], v[108:111]
    ds_read_b64_tr_b16 v[134:135], v221 offset:2048
    s_waitcnt lgkmcnt(4)
    v_mfma_f32_16x16x32_bf16 v[112:115], v[152:155], a[120:123], v[112:115]
    ds_read_b64_tr_b16 v[136:137], v222 offset:0
    v_mfma_f32_16x16x32_bf16 v[116:119], v[152:155], a[124:127], v[116:119]
    ds_read_b64_tr_b16 v[138:139], v222 offset:2048
    v_mfma_f32_16x16x32_bf16 v[120:123], v[156:159], a[120:123], v[120:123]
    ds_read_b64_tr_b16 v[140:141], v223 offset:0
    v_mfma_f32_16x16x32_bf16 v[124:127], v[156:159], a[124:127], v[124:127]
    ds_read_b64_tr_b16 v[142:143], v223 offset:2048
    s_waitcnt lgkmcnt(4)
    v_mfma_f32_16x16x32_bf16 v[0:3], v[128:131], a[0:3], v[0:3]
    ds_read_b64_tr_b16 v[144:145], v220 offset:8192
    v_mfma_f32_16x16x32_bf16 v[4:7], v[128:131], a[4:7], v[4:7]
    ds_read_b64_tr_b16 v[146:147], v220 offset:10240
    v_mfma_f32_16x16x32_bf16 v[8:11], v[132:135], a[0:3], v[8:11]
    ds_read_b64_tr_b16 v[148:149], v221 offset:8192
    v_mfma_f32_16x16x32_bf16 v[12:15], v[132:135], a[4:7], v[12:15]
    ds_read_b64_tr_b16 v[150:151], v221 offset:10240
    s_waitcnt lgkmcnt(4)
    v_mfma_f32_16x16x32_bf16 v[16:19], v[136:139], a[0:3], v[16:19]
    ds_read_b64_tr_b16 v[152:153], v222 offset:8192
    v_mfma_f32_16x16x32_bf16 v[20:23], v[136:139], a[4:7], v[20:23]
    ds_read_b64_tr_b16 v[154:155], v222 offset:10240
    v_mfma_f32_16x16x32_bf16 v[24:27], v[140:143], a[0:3], v[24:27]
    ds_read_b64_tr_b16 v[156:157], v223 offset:8192
    v_mfma_f32_16x16x32_bf16 v[28:31], v[140:143], a[4:7], v[28:31]
    ds_read_b64_tr_b16 v[158:159], v223 offset:10240
    s_waitcnt lgkmcnt(4)
    v_mfma_f32_16x16x32_bf16 v[0:3], v[144:147], a[16:19], v[0:3]
    ds_read_b64_tr_b16 v[128:129], v220 offset:16384
    s_mul_i32 s33, s39, 12288
    s_add_u32 s33, s33, 0x5002000
    v_mfma_f32_16x16x32_bf16 v[4:7], v[144:147], a[20:23], v[4:7]
    ds_read_b64_tr_b16 v[130:131], v220 offset:18432
    v_mfma_f32_16x16x32_bf16 v[8:11], v[148:151], a[16:19], v[8:11]
    ds_read_b64_tr_b16 v[132:133], v221 offset:16384
    v_cvt_pk_bf16_f32 v96, v96, v97
    v_mfma_f32_16x16x32_bf16 v[12:15], v[148:151], a[20:23], v[12:15]
    ds_read_b64_tr_b16 v[134:135], v221 offset:18432
    v_cvt_pk_bf16_f32 v97, v98, v99
    s_waitcnt lgkmcnt(4)
    v_mfma_f32_16x16x32_bf16 v[16:19], v[152:155], a[16:19], v[16:19]
    ds_read_b64_tr_b16 v[136:137], v222 offset:16384
    v_cvt_pk_bf16_f32 v98, v100, v101
    v_mfma_f32_16x16x32_bf16 v[20:23], v[152:155], a[20:23], v[20:23]
    ds_read_b64_tr_b16 v[138:139], v222 offset:18432
    v_cvt_pk_bf16_f32 v99, v102, v103
    v_mfma_f32_16x16x32_bf16 v[24:27], v[156:159], a[16:19], v[24:27]
    ds_read_b64_tr_b16 v[140:141], v223 offset:16384
    v_min_u32 v96, -2, v96
    v_mfma_f32_16x16x32_bf16 v[28:31], v[156:159], a[20:23], v[28:31]
    ds_read_b64_tr_b16 v[142:143], v223 offset:18432
    v_min_u32 v97, -2, v97
    s_waitcnt lgkmcnt(4)
    v_mfma_f32_16x16x32_bf16 v[0:3], v[128:131], a[32:35], v[0:3]
    ds_read_b64_tr_b16 v[144:145], v220 offset:24576
    v_min_u32 v98, -2, v98
    v_mfma_f32_16x16x32_bf16 v[4:7], v[128:131], a[36:39], v[4:7]
    ds_read_b64_tr_b16 v[146:147], v220 offset:26624
    v_min_u32 v99, -2, v99
    v_mfma_f32_16x16x32_bf16 v[8:11], v[132:135], a[32:35], v[8:11]
    ds_read_b64_tr_b16 v[148:149], v221 offset:24576
    buffer_store_dwordx4 v[96:99], v228, s[8:11], s33 offen offset:0 sc1
    v_mfma_f32_16x16x32_bf16 v[12:15], v[132:135], a[36:39], v[12:15]
    ds_read_b64_tr_b16 v[150:151], v221 offset:26624
    s_waitcnt lgkmcnt(4)
    v_mfma_f32_16x16x32_bf16 v[16:19], v[136:139], a[32:35], v[16:19]
    ds_read_b64_tr_b16 v[152:153], v222 offset:24576
    v_mfma_f32_16x16x32_bf16 v[20:23], v[136:139], a[36:39], v[20:23]
    ds_read_b64_tr_b16 v[154:155], v222 offset:26624
    v_mfma_f32_16x16x32_bf16 v[24:27], v[140:143], a[32:35], v[24:27]
    ds_read_b64_tr_b16 v[156:157], v223 offset:24576
    v_cvt_pk_bf16_f32 v100, v104, v105
    v_mfma_f32_16x16x32_bf16 v[28:31], v[140:143], a[36:39], v[28:31]
    ds_read_b64_tr_b16 v[158:159], v223 offset:26624
    v_cvt_pk_bf16_f32 v101, v106, v107
    s_waitcnt lgkmcnt(4)
    v_mfma_f32_16x16x32_bf16 v[0:3], v[144:147], a[48:51], v[0:3]
    ds_read_b64_tr_b16 v[128:129], v220 offset:32768
    v_cvt_pk_bf16_f32 v102, v108, v109
    v_mfma_f32_16x16x32_bf16 v[4:7], v[144:147], a[52:55], v[4:7]
    ds_read_b64_tr_b16 v[130:131], v220 offset:34816
    v_cvt_pk_bf16_f32 v103, v110, v111
    v_mfma_f32_16x16x32_bf16 v[8:11], v[148:151], a[48:51], v[8:11]
    ds_read_b64_tr_b16 v[132:133], v221 offset:32768
    v_min_u32 v100, -2, v100
    v_mfma_f32_16x16x32_bf16 v[12:15], v[148:151], a[52:55], v[12:15]
    ds_read_b64_tr_b16 v[134:135], v221 offset:34816
    v_min_u32 v101, -2, v101
    s_waitcnt lgkmcnt(4)
    v_mfma_f32_16x16x32_bf16 v[16:19], v[152:155], a[48:51], v[16:19]
    ds_read_b64_tr_b16 v[136:137], v222 offset:32768
    v_min_u32 v102, -2, v102
    v_mfma_f32_16x16x32_bf16 v[20:23], v[152:155], a[52:55], v[20:23]
    ds_read_b64_tr_b16 v[138:139], v222 offset:34816
    v_min_u32 v103, -2, v103
    v_mfma_f32_16x16x32_bf16 v[24:27], v[156:159], a[48:51], v[24:27]
    ds_read_b64_tr_b16 v[140:141], v223 offset:32768
    buffer_store_dwordx4 v[100:103], v228, s[8:11], s33 offen offset:1024 sc1
    v_mfma_f32_16x16x32_bf16 v[28:31], v[156:159], a[52:55], v[28:31]
    ds_read_b64_tr_b16 v[142:143], v223 offset:34816
    s_waitcnt lgkmcnt(4)
    v_mfma_f32_16x16x32_bf16 v[0:3], v[128:131], a[64:67], v[0:3]
    ds_read_b64_tr_b16 v[144:145], v220 offset:40960
    v_mfma_f32_16x16x32_bf16 v[4:7], v[128:131], a[68:71], v[4:7]
    ds_read_b64_tr_b16 v[146:147], v220 offset:43008
    v_mfma_f32_16x16x32_bf16 v[8:11], v[132:135], a[64:67], v[8:11]
    ds_read_b64_tr_b16 v[148:149], v221 offset:40960
    v_cvt_pk_bf16_f32 v104, v112, v113
    v_mfma_f32_16x16x32_bf16 v[12:15], v[132:135], a[68:71], v[12:15]
    ds_read_b64_tr_b16 v[150:151], v221 offset:43008
    v_cvt_pk_bf16_f32 v105, v114, v115
    s_waitcnt lgkmcnt(4)
    v_mfma_f32_16x16x32_bf16 v[16:19], v[136:139], a[64:67], v[16:19]
    ds_read_b64_tr_b16 v[152:153], v222 offset:40960
    v_cvt_pk_bf16_f32 v106, v116, v117
    v_mfma_f32_16x16x32_bf16 v[20:23], v[136:139], a[68:71], v[20:23]
    ds_read_b64_tr_b16 v[154:155], v222 offset:43008
    v_cvt_pk_bf16_f32 v107, v118, v119
    v_mfma_f32_16x16x32_bf16 v[24:27], v[140:143], a[64:67], v[24:27]
    ds_read_b64_tr_b16 v[156:157], v223 offset:40960
    v_min_u32 v104, -2, v104
    v_mfma_f32_16x16x32_bf16 v[28:31], v[140:143], a[68:71], v[28:31]
    ds_read_b64_tr_b16 v[158:159], v223 offset:43008
    v_min_u32 v105, -2, v105
    s_waitcnt lgkmcnt(4)
    v_mfma_f32_16x16x32_bf16 v[0:3], v[144:147], a[80:83], v[0:3]
    ds_read_b64_tr_b16 v[128:129], v220 offset:49152
    v_min_u32 v106, -2, v106
    v_mfma_f32_16x16x32_bf16 v[4:7], v[144:147], a[84:87], v[4:7]
    ds_read_b64_tr_b16 v[130:131], v220 offset:51200
    v_min_u32 v107, -2, v107
    v_mfma_f32_16x16x32_bf16 v[8:11], v[148:151], a[80:83], v[8:11]
    ds_read_b64_tr_b16 v[132:133], v221 offset:49152
    buffer_store_dwordx4 v[104:107], v228, s[8:11], s33 offen offset:2048 sc1
    v_mfma_f32_16x16x32_bf16 v[12:15], v[148:151], a[84:87], v[12:15]
    ds_read_b64_tr_b16 v[134:135], v221 offset:51200
    s_waitcnt lgkmcnt(4)
    v_mfma_f32_16x16x32_bf16 v[16:19], v[152:155], a[80:83], v[16:19]
    ds_read_b64_tr_b16 v[136:137], v222 offset:49152
    v_mfma_f32_16x16x32_bf16 v[20:23], v[152:155], a[84:87], v[20:23]
    ds_read_b64_tr_b16 v[138:139], v222 offset:51200
    v_mfma_f32_16x16x32_bf16 v[24:27], v[156:159], a[80:83], v[24:27]
    ds_read_b64_tr_b16 v[140:141], v223 offset:49152
    v_cvt_pk_bf16_f32 v108, v120, v121
    v_mfma_f32_16x16x32_bf16 v[28:31], v[156:159], a[84:87], v[28:31]
    ds_read_b64_tr_b16 v[142:143], v223 offset:51200
    v_cvt_pk_bf16_f32 v109, v122, v123
    s_waitcnt lgkmcnt(4)
    v_mfma_f32_16x16x32_bf16 v[0:3], v[128:131], a[96:99], v[0:3]
    ds_read_b64_tr_b16 v[144:145], v220 offset:57344
    v_cvt_pk_bf16_f32 v110, v124, v125
    v_mfma_f32_16x16x32_bf16 v[4:7], v[128:131], a[100:103], v[4:7]
    ds_read_b64_tr_b16 v[146:147], v220 offset:59392
    v_cvt_pk_bf16_f32 v111, v126, v127
    v_mfma_f32_16x16x32_bf16 v[8:11], v[132:135], a[96:99], v[8:11]
    ds_read_b64_tr_b16 v[148:149], v221 offset:57344
    v_min_u32 v108, -2, v108
    v_mfma_f32_16x16x32_bf16 v[12:15], v[132:135], a[100:103], v[12:15]
    ds_read_b64_tr_b16 v[150:151], v221 offset:59392
    v_min_u32 v109, -2, v109
    s_waitcnt lgkmcnt(4)
    v_mfma_f32_16x16x32_bf16 v[16:19], v[136:139], a[96:99], v[16:19]
    ds_read_b64_tr_b16 v[152:153], v222 offset:57344
    v_min_u32 v110, -2, v110
    v_mfma_f32_16x16x32_bf16 v[20:23], v[136:139], a[100:103], v[20:23]
    ds_read_b64_tr_b16 v[154:155], v222 offset:59392
    v_min_u32 v111, -2, v111
    v_mfma_f32_16x16x32_bf16 v[24:27], v[140:143], a[96:99], v[24:27]
    ds_read_b64_tr_b16 v[156:157], v223 offset:57344
    buffer_store_dwordx4 v[108:111], v228, s[8:11], s33 offen offset:3072 sc1
    v_mfma_f32_16x16x32_bf16 v[28:31], v[140:143], a[100:103], v[28:31]
    ds_read_b64_tr_b16 v[158:159], v223 offset:59392
    s_waitcnt lgkmcnt(4)
    v_mfma_f32_16x16x32_bf16 v[0:3], v[144:147], a[112:115], v[0:3]
    ds_read_b64_tr_b16 v[128:129], v216 offset:0
    v_mfma_f32_16x16x32_bf16 v[4:7], v[144:147], a[116:119], v[4:7]
    ds_read_b64_tr_b16 v[130:131], v216 offset:2048
    v_mfma_f32_16x16x32_bf16 v[8:11], v[148:151], a[112:115], v[8:11]
    ds_read_b64_tr_b16 v[132:133], v217 offset:0
    v_mfma_f32_16x16x32_bf16 v[12:15], v[148:151], a[116:119], v[12:15]
    ds_read_b64_tr_b16 v[134:135], v217 offset:2048
    s_waitcnt lgkmcnt(4)
    v_mfma_f32_16x16x32_bf16 v[16:19], v[152:155], a[112:115], v[16:19]
    ds_read_b64_tr_b16 v[136:137], v218 offset:0
    v_mfma_f32_16x16x32_bf16 v[20:23], v[152:155], a[116:119], v[20:23]
    ds_read_b64_tr_b16 v[138:139], v218 offset:2048
    v_mfma_f32_16x16x32_bf16 v[24:27], v[156:159], a[112:115], v[24:27]
    ds_read_b64_tr_b16 v[140:141], v219 offset:0
    v_mfma_f32_16x16x32_bf16 v[28:31], v[156:159], a[116:119], v[28:31]
    ds_read_b64_tr_b16 v[142:143], v219 offset:2048
    s_waitcnt lgkmcnt(4)
    v_mfma_f32_16x16x32_bf16 v[64:67], v[128:131], a[8:11], v[64:67]
    ds_read_b64_tr_b16 v[144:145], v216 offset:8192
    v_mfma_f32_16x16x32_bf16 v[68:71], v[128:131], a[12:15], v[68:71]
    ds_read_b64_tr_b16 v[146:147], v216 offset:10240
    v_mfma_f32_16x16x32_bf16 v[72:75], v[132:135], a[8:11], v[72:75]
    ds_read_b64_tr_b16 v[148:149], v217 offset:8192
    v_mfma_f32_16x16x32_bf16 v[76:79], v[132:135], a[12:15], v[76:79]
    ds_read_b64_tr_b16 v[150:151], v217 offset:10240
    s_waitcnt lgkmcnt(4)
    v_mfma_f32_16x16x32_bf16 v[80:83], v[136:139], a[8:11], v[80:83]
    ds_read_b64_tr_b16 v[152:153], v218 offset:8192
    v_mfma_f32_16x16x32_bf16 v[84:87], v[136:139], a[12:15], v[84:87]
    ds_read_b64_tr_b16 v[154:155], v218 offset:10240
    v_mfma_f32_16x16x32_bf16 v[88:91], v[140:143], a[8:11], v[88:91]
    ds_read_b64_tr_b16 v[156:157], v219 offset:8192
    v_mfma_f32_16x16x32_bf16 v[92:95], v[140:143], a[12:15], v[92:95]
    ds_read_b64_tr_b16 v[158:159], v219 offset:10240
    s_waitcnt lgkmcnt(4)
    v_mfma_f32_16x16x32_bf16 v[64:67], v[144:147], a[24:27], v[64:67]
    ds_read_b64_tr_b16 v[128:129], v216 offset:16384
    s_mul_i32 s33, s39, 12288
    s_add_u32 s33, s33, 0x5000000
    v_mfma_f32_16x16x32_bf16 v[68:71], v[144:147], a[28:31], v[68:71]
    ds_read_b64_tr_b16 v[130:131], v216 offset:18432
    v_mfma_f32_16x16x32_bf16 v[72:75], v[148:151], a[24:27], v[72:75]
    ds_read_b64_tr_b16 v[132:133], v217 offset:16384
    v_cvt_pk_bf16_f32 v0, v0, v1
    v_mfma_f32_16x16x32_bf16 v[76:79], v[148:151], a[28:31], v[76:79]
    ds_read_b64_tr_b16 v[134:135], v217 offset:18432
    v_cvt_pk_bf16_f32 v1, v2, v3
    s_waitcnt lgkmcnt(4)
    v_mfma_f32_16x16x32_bf16 v[80:83], v[152:155], a[24:27], v[80:83]
    ds_read_b64_tr_b16 v[136:137], v218 offset:16384
    v_cvt_pk_bf16_f32 v2, v4, v5
    v_mfma_f32_16x16x32_bf16 v[84:87], v[152:155], a[28:31], v[84:87]
    ds_read_b64_tr_b16 v[138:139], v218 offset:18432
    v_cvt_pk_bf16_f32 v3, v6, v7
    v_mfma_f32_16x16x32_bf16 v[88:91], v[156:159], a[24:27], v[88:91]
    ds_read_b64_tr_b16 v[140:141], v219 offset:16384
    v_min_u32 v0, -2, v0
    v_mfma_f32_16x16x32_bf16 v[92:95], v[156:159], a[28:31], v[92:95]
    ds_read_b64_tr_b16 v[142:143], v219 offset:18432
    v_min_u32 v1, -2, v1
    s_waitcnt lgkmcnt(4)
    v_mfma_f32_16x16x32_bf16 v[64:67], v[128:131], a[40:43], v[64:67]
    ds_read_b64_tr_b16 v[144:145], v216 offset:24576
    v_min_u32 v2, -2, v2
    v_mfma_f32_16x16x32_bf16 v[68:71], v[128:131], a[44:47], v[68:71]
    ds_read_b64_tr_b16 v[146:147], v216 offset:26624
    v_min_u32 v3, -2, v3
    v_mfma_f32_16x16x32_bf16 v[72:75], v[132:135], a[40:43], v[72:75]
    ds_read_b64_tr_b16 v[148:149], v217 offset:24576
    buffer_store_dwordx4 v[0:3], v228, s[8:11], s33 offen offset:0 sc1
    v_mfma_f32_16x16x32_bf16 v[76:79], v[132:135], a[44:47], v[76:79]
    ds_read_b64_tr_b16 v[150:151], v217 offset:26624
    s_waitcnt lgkmcnt(4)
    v_mfma_f32_16x16x32_bf16 v[80:83], v[136:139], a[40:43], v[80:83]
    ds_read_b64_tr_b16 v[152:153], v218 offset:24576
    v_mfma_f32_16x16x32_bf16 v[84:87], v[136:139], a[44:47], v[84:87]
    ds_read_b64_tr_b16 v[154:155], v218 offset:26624
    v_mfma_f32_16x16x32_bf16 v[88:91], v[140:143], a[40:43], v[88:91]
    ds_read_b64_tr_b16 v[156:157], v219 offset:24576
    v_cvt_pk_bf16_f32 v4, v8, v9
    v_mfma_f32_16x16x32_bf16 v[92:95], v[140:143], a[44:47], v[92:95]
    ds_read_b64_tr_b16 v[158:159], v219 offset:26624
    v_cvt_pk_bf16_f32 v5, v10, v11
    s_waitcnt lgkmcnt(4)
    v_mfma_f32_16x16x32_bf16 v[64:67], v[144:147], a[56:59], v[64:67]
    ds_read_b64_tr_b16 v[128:129], v216 offset:32768
    v_cvt_pk_bf16_f32 v6, v12, v13
    v_mfma_f32_16x16x32_bf16 v[68:71], v[144:147], a[60:63], v[68:71]
    ds_read_b64_tr_b16 v[130:131], v216 offset:34816
    v_cvt_pk_bf16_f32 v7, v14, v15
    v_mfma_f32_16x16x32_bf16 v[72:75], v[148:151], a[56:59], v[72:75]
    ds_read_b64_tr_b16 v[132:133], v217 offset:32768
    v_min_u32 v4, -2, v4
    v_mfma_f32_16x16x32_bf16 v[76:79], v[148:151], a[60:63], v[76:79]
    ds_read_b64_tr_b16 v[134:135], v217 offset:34816
    v_min_u32 v5, -2, v5
    s_waitcnt lgkmcnt(4)
    v_mfma_f32_16x16x32_bf16 v[80:83], v[152:155], a[56:59], v[80:83]
    ds_read_b64_tr_b16 v[136:137], v218 offset:32768
    v_min_u32 v6, -2, v6
    v_mfma_f32_16x16x32_bf16 v[84:87], v[152:155], a[60:63], v[84:87]
    ds_read_b64_tr_b16 v[138:139], v218 offset:34816
    v_min_u32 v7, -2, v7
    v_mfma_f32_16x16x32_bf16 v[88:91], v[156:159], a[56:59], v[88:91]
    ds_read_b64_tr_b16 v[140:141], v219 offset:32768
    buffer_store_dwordx4 v[4:7], v228, s[8:11], s33 offen offset:1024 sc1
    v_mfma_f32_16x16x32_bf16 v[92:95], v[156:159], a[60:63], v[92:95]
    ds_read_b64_tr_b16 v[142:143], v219 offset:34816
    s_waitcnt lgkmcnt(4)
    v_mfma_f32_16x16x32_bf16 v[64:67], v[128:131], a[72:75], v[64:67]
    ds_read_b64_tr_b16 v[144:145], v216 offset:40960
    v_mfma_f32_16x16x32_bf16 v[68:71], v[128:131], a[76:79], v[68:71]
    ds_read_b64_tr_b16 v[146:147], v216 offset:43008
    v_mfma_f32_16x16x32_bf16 v[72:75], v[132:135], a[72:75], v[72:75]
    ds_read_b64_tr_b16 v[148:149], v217 offset:40960
    v_cvt_pk_bf16_f32 v8, v16, v17
    v_mfma_f32_16x16x32_bf16 v[76:79], v[132:135], a[76:79], v[76:79]
    ds_read_b64_tr_b16 v[150:151], v217 offset:43008
    v_cvt_pk_bf16_f32 v9, v18, v19
    s_waitcnt lgkmcnt(4)
    v_mfma_f32_16x16x32_bf16 v[80:83], v[136:139], a[72:75], v[80:83]
    ds_read_b64_tr_b16 v[152:153], v218 offset:40960
    v_cvt_pk_bf16_f32 v10, v20, v21
    v_mfma_f32_16x16x32_bf16 v[84:87], v[136:139], a[76:79], v[84:87]
    ds_read_b64_tr_b16 v[154:155], v218 offset:43008
    v_cvt_pk_bf16_f32 v11, v22, v23
    v_mfma_f32_16x16x32_bf16 v[88:91], v[140:143], a[72:75], v[88:91]
    ds_read_b64_tr_b16 v[156:157], v219 offset:40960
    v_min_u32 v8, -2, v8
    v_mfma_f32_16x16x32_bf16 v[92:95], v[140:143], a[76:79], v[92:95]
    ds_read_b64_tr_b16 v[158:159], v219 offset:43008
    v_min_u32 v9, -2, v9
    s_waitcnt lgkmcnt(4)
    v_mfma_f32_16x16x32_bf16 v[64:67], v[144:147], a[88:91], v[64:67]
    ds_read_b64_tr_b16 v[128:129], v216 offset:49152
    v_min_u32 v10, -2, v10
    v_mfma_f32_16x16x32_bf16 v[68:71], v[144:147], a[92:95], v[68:71]
    ds_read_b64_tr_b16 v[130:131], v216 offset:51200
    v_min_u32 v11, -2, v11
    v_mfma_f32_16x16x32_bf16 v[72:75], v[148:151], a[88:91], v[72:75]
    ds_read_b64_tr_b16 v[132:133], v217 offset:49152
    buffer_store_dwordx4 v[8:11], v228, s[8:11], s33 offen offset:2048 sc1
    v_mfma_f32_16x16x32_bf16 v[76:79], v[148:151], a[92:95], v[76:79]
    ds_read_b64_tr_b16 v[134:135], v217 offset:51200
    s_waitcnt lgkmcnt(4)
    v_mfma_f32_16x16x32_bf16 v[80:83], v[152:155], a[88:91], v[80:83]
    ds_read_b64_tr_b16 v[136:137], v218 offset:49152
    v_mfma_f32_16x16x32_bf16 v[84:87], v[152:155], a[92:95], v[84:87]
    ds_read_b64_tr_b16 v[138:139], v218 offset:51200
    v_mfma_f32_16x16x32_bf16 v[88:91], v[156:159], a[88:91], v[88:91]
    ds_read_b64_tr_b16 v[140:141], v219 offset:49152
    v_cvt_pk_bf16_f32 v12, v24, v25
    v_mfma_f32_16x16x32_bf16 v[92:95], v[156:159], a[92:95], v[92:95]
    ds_read_b64_tr_b16 v[142:143], v219 offset:51200
    v_cvt_pk_bf16_f32 v13, v26, v27
    s_waitcnt lgkmcnt(4)
    v_mfma_f32_16x16x32_bf16 v[64:67], v[128:131], a[104:107], v[64:67]
    ds_read_b64_tr_b16 v[144:145], v216 offset:57344
    v_cvt_pk_bf16_f32 v14, v28, v29
    v_mfma_f32_16x16x32_bf16 v[68:71], v[128:131], a[108:111], v[68:71]
    ds_read_b64_tr_b16 v[146:147], v216 offset:59392
    v_cvt_pk_bf16_f32 v15, v30, v31
    v_mfma_f32_16x16x32_bf16 v[72:75], v[132:135], a[104:107], v[72:75]
    ds_read_b64_tr_b16 v[148:149], v217 offset:57344
    v_min_u32 v12, -2, v12
    v_mfma_f32_16x16x32_bf16 v[76:79], v[132:135], a[108:111], v[76:79]
    ds_read_b64_tr_b16 v[150:151], v217 offset:59392
    v_min_u32 v13, -2, v13
    s_waitcnt lgkmcnt(4)
    v_mfma_f32_16x16x32_bf16 v[80:83], v[136:139], a[104:107], v[80:83]
    ds_read_b64_tr_b16 v[152:153], v218 offset:57344
    v_min_u32 v14, -2, v14
    v_mfma_f32_16x16x32_bf16 v[84:87], v[136:139], a[108:111], v[84:87]
    ds_read_b64_tr_b16 v[154:155], v218 offset:59392
    v_min_u32 v15, -2, v15
    v_mfma_f32_16x16x32_bf16 v[88:91], v[140:143], a[104:107], v[88:91]
    ds_read_b64_tr_b16 v[156:157], v219 offset:57344
    buffer_store_dwordx4 v[12:15], v228, s[8:11], s33 offen offset:3072 sc1
    v_mfma_f32_16x16x32_bf16 v[92:95], v[140:143], a[108:111], v[92:95]
    ds_read_b64_tr_b16 v[158:159], v219 offset:59392
    s_waitcnt lgkmcnt(4)
    v_mfma_f32_16x16x32_bf16 v[64:67], v[144:147], a[120:123], v[64:67]
    ds_read_b64_tr_b16 v[128:129], v216 offset:0
    v_mfma_f32_16x16x32_bf16 v[68:71], v[144:147], a[124:127], v[68:71]
    ds_read_b64_tr_b16 v[130:131], v216 offset:2048
    v_mfma_f32_16x16x32_bf16 v[72:75], v[148:151], a[120:123], v[72:75]
    ds_read_b64_tr_b16 v[132:133], v217 offset:0
    v_mfma_f32_16x16x32_bf16 v[76:79], v[148:151], a[124:127], v[76:79]
    ds_read_b64_tr_b16 v[134:135], v217 offset:2048
    s_waitcnt lgkmcnt(4)
    v_mfma_f32_16x16x32_bf16 v[80:83], v[152:155], a[120:123], v[80:83]
    ds_read_b64_tr_b16 v[136:137], v218 offset:0
    v_mfma_f32_16x16x32_bf16 v[84:87], v[152:155], a[124:127], v[84:87]
    ds_read_b64_tr_b16 v[138:139], v218 offset:2048
    v_mfma_f32_16x16x32_bf16 v[88:91], v[156:159], a[120:123], v[88:91]
    ds_read_b64_tr_b16 v[140:141], v219 offset:0
    v_mfma_f32_16x16x32_bf16 v[92:95], v[156:159], a[124:127], v[92:95]
    ds_read_b64_tr_b16 v[142:143], v219 offset:2048
    s_waitcnt lgkmcnt(4)
    v_mfma_f32_16x16x32_bf16 v[32:35], v[128:131], a[0:3], v[32:35]
    ds_read_b64_tr_b16 v[144:145], v216 offset:8192
    v_mfma_f32_16x16x32_bf16 v[36:39], v[128:131], a[4:7], v[36:39]
    ds_read_b64_tr_b16 v[146:147], v216 offset:10240
    buffer_load_dwordx4 v[176:179], v228, s[8:11], s7 offen offset:0 sc1
    v_mfma_f32_16x16x32_bf16 v[40:43], v[132:135], a[0:3], v[40:43]
    ds_read_b64_tr_b16 v[148:149], v217 offset:8192
    v_mfma_f32_16x16x32_bf16 v[44:47], v[132:135], a[4:7], v[44:47]
    ds_read_b64_tr_b16 v[150:151], v217 offset:10240
    buffer_load_dwordx4 v[180:183], v228, s[8:11], s7 offen offset:1024 sc1
    s_waitcnt lgkmcnt(4)
    v_mfma_f32_16x16x32_bf16 v[48:51], v[136:139], a[0:3], v[48:51]
    ds_read_b64_tr_b16 v[152:153], v218 offset:8192
    v_mfma_f32_16x16x32_bf16 v[52:55], v[136:139], a[4:7], v[52:55]
    ds_read_b64_tr_b16 v[154:155], v218 offset:10240
    buffer_load_dwordx4 v[184:187], v228, s[8:11], s7 offen offset:2048 sc1
    v_mfma_f32_16x16x32_bf16 v[56:59], v[140:143], a[0:3], v[56:59]
    ds_read_b64_tr_b16 v[156:157], v219 offset:8192
    v_mfma_f32_16x16x32_bf16 v[60:63], v[140:143], a[4:7], v[60:63]
    ds_read_b64_tr_b16 v[158:159], v219 offset:10240
    buffer_load_dwordx4 v[188:191], v228, s[8:11], s7 offen offset:3072 sc1
    s_waitcnt lgkmcnt(4)
    v_mfma_f32_16x16x32_bf16 v[32:35], v[144:147], a[16:19], v[32:35]
    ds_read_b64_tr_b16 v[128:129], v216 offset:16384
    s_mul_i32 s33, s39, 12288
    s_add_u32 s33, s33, 0x5001000
    v_mfma_f32_16x16x32_bf16 v[36:39], v[144:147], a[20:23], v[36:39]
    ds_read_b64_tr_b16 v[130:131], v216 offset:18432
    v_mfma_f32_16x16x32_bf16 v[40:43], v[148:151], a[16:19], v[40:43]
    ds_read_b64_tr_b16 v[132:133], v217 offset:16384
    v_cvt_pk_bf16_f32 v64, v64, v65
    v_mfma_f32_16x16x32_bf16 v[44:47], v[148:151], a[20:23], v[44:47]
    ds_read_b64_tr_b16 v[134:135], v217 offset:18432
    v_cvt_pk_bf16_f32 v65, v66, v67
    s_waitcnt lgkmcnt(4)
    v_mfma_f32_16x16x32_bf16 v[48:51], v[152:155], a[16:19], v[48:51]
    ds_read_b64_tr_b16 v[136:137], v218 offset:16384
    v_cvt_pk_bf16_f32 v66, v68, v69
    v_mfma_f32_16x16x32_bf16 v[52:55], v[152:155], a[20:23], v[52:55]
    ds_read_b64_tr_b16 v[138:139], v218 offset:18432
    v_cvt_pk_bf16_f32 v67, v70, v71
    v_mfma_f32_16x16x32_bf16 v[56:59], v[156:159], a[16:19], v[56:59]
    ds_read_b64_tr_b16 v[140:141], v219 offset:16384
    v_min_u32 v64, -2, v64
    v_mfma_f32_16x16x32_bf16 v[60:63], v[156:159], a[20:23], v[60:63]
    ds_read_b64_tr_b16 v[142:143], v219 offset:18432
    v_min_u32 v65, -2, v65
    s_waitcnt lgkmcnt(4)
    v_mfma_f32_16x16x32_bf16 v[32:35], v[128:131], a[32:35], v[32:35]
    ds_read_b64_tr_b16 v[144:145], v216 offset:24576
    v_min_u32 v66, -2, v66
    v_mfma_f32_16x16x32_bf16 v[36:39], v[128:131], a[36:39], v[36:39]
    ds_read_b64_tr_b16 v[146:147], v216 offset:26624
    v_min_u32 v67, -2, v67
    v_mfma_f32_16x16x32_bf16 v[40:43], v[132:135], a[32:35], v[40:43]
    ds_read_b64_tr_b16 v[148:149], v217 offset:24576
    buffer_store_dwordx4 v[64:67], v228, s[8:11], s33 offen offset:0 sc1
    v_mfma_f32_16x16x32_bf16 v[44:47], v[132:135], a[36:39], v[44:47]
    ds_read_b64_tr_b16 v[150:151], v217 offset:26624
    s_waitcnt lgkmcnt(4)
    v_mfma_f32_16x16x32_bf16 v[48:51], v[136:139], a[32:35], v[48:51]
    ds_read_b64_tr_b16 v[152:153], v218 offset:24576
    v_mfma_f32_16x16x32_bf16 v[52:55], v[136:139], a[36:39], v[52:55]
    ds_read_b64_tr_b16 v[154:155], v218 offset:26624
    v_mfma_f32_16x16x32_bf16 v[56:59], v[140:143], a[32:35], v[56:59]
    ds_read_b64_tr_b16 v[156:157], v219 offset:24576
    v_cvt_pk_bf16_f32 v68, v72, v73
    v_mfma_f32_16x16x32_bf16 v[60:63], v[140:143], a[36:39], v[60:63]
    ds_read_b64_tr_b16 v[158:159], v219 offset:26624
    v_cvt_pk_bf16_f32 v69, v74, v75
    s_waitcnt lgkmcnt(4)
    v_mfma_f32_16x16x32_bf16 v[32:35], v[144:147], a[48:51], v[32:35]
    ds_read_b64_tr_b16 v[128:129], v216 offset:32768
    v_cvt_pk_bf16_f32 v70, v76, v77
    v_mfma_f32_16x16x32_bf16 v[36:39], v[144:147], a[52:55], v[36:39]
    ds_read_b64_tr_b16 v[130:131], v216 offset:34816
    v_cvt_pk_bf16_f32 v71, v78, v79
    v_mfma_f32_16x16x32_bf16 v[40:43], v[148:151], a[48:51], v[40:43]
    ds_read_b64_tr_b16 v[132:133], v217 offset:32768
    v_min_u32 v68, -2, v68
    v_mfma_f32_16x16x32_bf16 v[44:47], v[148:151], a[52:55], v[44:47]
    ds_read_b64_tr_b16 v[134:135], v217 offset:34816
    v_min_u32 v69, -2, v69
    s_waitcnt lgkmcnt(4)
    v_mfma_f32_16x16x32_bf16 v[48:51], v[152:155], a[48:51], v[48:51]
    ds_read_b64_tr_b16 v[136:137], v218 offset:32768
    v_min_u32 v70, -2, v70
    v_mfma_f32_16x16x32_bf16 v[52:55], v[152:155], a[52:55], v[52:55]
    ds_read_b64_tr_b16 v[138:139], v218 offset:34816
    v_min_u32 v71, -2, v71
    v_mfma_f32_16x16x32_bf16 v[56:59], v[156:159], a[48:51], v[56:59]
    ds_read_b64_tr_b16 v[140:141], v219 offset:32768
    buffer_store_dwordx4 v[68:71], v228, s[8:11], s33 offen offset:1024 sc1
    v_mfma_f32_16x16x32_bf16 v[60:63], v[156:159], a[52:55], v[60:63]
    ds_read_b64_tr_b16 v[142:143], v219 offset:34816
    s_waitcnt lgkmcnt(4)
    v_mfma_f32_16x16x32_bf16 v[32:35], v[128:131], a[64:67], v[32:35]
    ds_read_b64_tr_b16 v[144:145], v216 offset:40960
    v_mfma_f32_16x16x32_bf16 v[36:39], v[128:131], a[68:71], v[36:39]
    ds_read_b64_tr_b16 v[146:147], v216 offset:43008
    v_mfma_f32_16x16x32_bf16 v[40:43], v[132:135], a[64:67], v[40:43]
    ds_read_b64_tr_b16 v[148:149], v217 offset:40960
    v_cvt_pk_bf16_f32 v72, v80, v81
    v_mfma_f32_16x16x32_bf16 v[44:47], v[132:135], a[68:71], v[44:47]
    ds_read_b64_tr_b16 v[150:151], v217 offset:43008
    v_cvt_pk_bf16_f32 v73, v82, v83
    s_waitcnt lgkmcnt(4)
    v_mfma_f32_16x16x32_bf16 v[48:51], v[136:139], a[64:67], v[48:51]
    ds_read_b64_tr_b16 v[152:153], v218 offset:40960
    v_cvt_pk_bf16_f32 v74, v84, v85
    v_mfma_f32_16x16x32_bf16 v[52:55], v[136:139], a[68:71], v[52:55]
    ds_read_b64_tr_b16 v[154:155], v218 offset:43008
    v_cvt_pk_bf16_f32 v75, v86, v87
    v_mfma_f32_16x16x32_bf16 v[56:59], v[140:143], a[64:67], v[56:59]
    ds_read_b64_tr_b16 v[156:157], v219 offset:40960
    v_min_u32 v72, -2, v72
    v_mfma_f32_16x16x32_bf16 v[60:63], v[140:143], a[68:71], v[60:63]
    ds_read_b64_tr_b16 v[158:159], v219 offset:43008
    v_min_u32 v73, -2, v73
    s_waitcnt lgkmcnt(4)
    v_mfma_f32_16x16x32_bf16 v[32:35], v[144:147], a[80:83], v[32:35]
    ds_read_b64_tr_b16 v[128:129], v216 offset:49152
    v_min_u32 v74, -2, v74
    v_mfma_f32_16x16x32_bf16 v[36:39], v[144:147], a[84:87], v[36:39]
    ds_read_b64_tr_b16 v[130:131], v216 offset:51200
    v_min_u32 v75, -2, v75
    v_mfma_f32_16x16x32_bf16 v[40:43], v[148:151], a[80:83], v[40:43]
    ds_read_b64_tr_b16 v[132:133], v217 offset:49152
    buffer_store_dwordx4 v[72:75], v228, s[8:11], s33 offen offset:2048 sc1
    v_mfma_f32_16x16x32_bf16 v[44:47], v[148:151], a[84:87], v[44:47]
    ds_read_b64_tr_b16 v[134:135], v217 offset:51200
    s_waitcnt lgkmcnt(4)
    v_mfma_f32_16x16x32_bf16 v[48:51], v[152:155], a[80:83], v[48:51]
    ds_read_b64_tr_b16 v[136:137], v218 offset:49152
    v_mfma_f32_16x16x32_bf16 v[52:55], v[152:155], a[84:87], v[52:55]
    ds_read_b64_tr_b16 v[138:139], v218 offset:51200
    v_mfma_f32_16x16x32_bf16 v[56:59], v[156:159], a[80:83], v[56:59]
    ds_read_b64_tr_b16 v[140:141], v219 offset:49152
    v_cvt_pk_bf16_f32 v76, v88, v89
    v_mfma_f32_16x16x32_bf16 v[60:63], v[156:159], a[84:87], v[60:63]
    ds_read_b64_tr_b16 v[142:143], v219 offset:51200
    v_cvt_pk_bf16_f32 v77, v90, v91
    s_waitcnt lgkmcnt(4)
    v_mfma_f32_16x16x32_bf16 v[32:35], v[128:131], a[96:99], v[32:35]
    ds_read_b64_tr_b16 v[144:145], v216 offset:57344
    v_cvt_pk_bf16_f32 v78, v92, v93
    v_mfma_f32_16x16x32_bf16 v[36:39], v[128:131], a[100:103], v[36:39]
    ds_read_b64_tr_b16 v[146:147], v216 offset:59392
    v_cvt_pk_bf16_f32 v79, v94, v95
    v_mfma_f32_16x16x32_bf16 v[40:43], v[132:135], a[96:99], v[40:43]
    ds_read_b64_tr_b16 v[148:149], v217 offset:57344
    v_min_u32 v76, -2, v76
    v_mfma_f32_16x16x32_bf16 v[44:47], v[132:135], a[100:103], v[44:47]
    ds_read_b64_tr_b16 v[150:151], v217 offset:59392
    v_min_u32 v77, -2, v77
    s_waitcnt lgkmcnt(4)
    v_mfma_f32_16x16x32_bf16 v[48:51], v[136:139], a[96:99], v[48:51]
    ds_read_b64_tr_b16 v[152:153], v218 offset:57344
    v_min_u32 v78, -2, v78
    v_mfma_f32_16x16x32_bf16 v[52:55], v[136:139], a[100:103], v[52:55]
    ds_read_b64_tr_b16 v[154:155], v218 offset:59392
    v_min_u32 v79, -2, v79
    v_mfma_f32_16x16x32_bf16 v[56:59], v[140:143], a[96:99], v[56:59]
    ds_read_b64_tr_b16 v[156:157], v219 offset:57344
    buffer_store_dwordx4 v[76:79], v228, s[8:11], s33 offen offset:3072 sc1
    v_mfma_f32_16x16x32_bf16 v[60:63], v[140:143], a[100:103], v[60:63]
    ds_read_b64_tr_b16 v[158:159], v219 offset:59392
    s_waitcnt lgkmcnt(4)
    v_mfma_f32_16x16x32_bf16 v[32:35], v[144:147], a[112:115], v[32:35]
    buffer_load_dwordx4 v[96:99], v228, s[8:11], s37 offen offset:0 sc1
    v_mfma_f32_16x16x32_bf16 v[36:39], v[144:147], a[116:119], v[36:39]
    v_mfma_f32_16x16x32_bf16 v[40:43], v[148:151], a[112:115], v[40:43]
    buffer_load_dwordx4 v[100:103], v228, s[8:11], s37 offen offset:1024 sc1
    v_mfma_f32_16x16x32_bf16 v[44:47], v[148:151], a[116:119], v[44:47]
    s_waitcnt lgkmcnt(0)
    v_mfma_f32_16x16x32_bf16 v[48:51], v[152:155], a[112:115], v[48:51]
    buffer_load_dwordx4 v[104:107], v228, s[8:11], s37 offen offset:2048 sc1
    v_mfma_f32_16x16x32_bf16 v[52:55], v[152:155], a[116:119], v[52:55]
    v_mfma_f32_16x16x32_bf16 v[56:59], v[156:159], a[112:115], v[56:59]
    buffer_load_dwordx4 v[108:111], v228, s[8:11], s37 offen offset:3072 sc1
    v_mfma_f32_16x16x32_bf16 v[60:63], v[156:159], a[116:119], v[60:63]
kc_tail:
    buffer_load_dwordx4 v[160:163], v228, s[8:11], s38 offen offset:0 sc1
    buffer_load_dwordx4 v[164:167], v228, s[8:11], s38 offen offset:1024 sc1
    buffer_load_dwordx4 v[168:171], v228, s[8:11], s38 offen offset:2048 sc1
    buffer_load_dwordx4 v[172:175], v228, s[8:11], s38 offen offset:3072 sc1
    v_lshlrev_b32 v128, 16, v192
    v_and_b32 v129, 0xffff0000, v192
    v_lshlrev_b32 v130, 16, v193
    v_and_b32 v131, 0xffff0000, v193
    v_lshlrev_b32 v132, 16, v194
    v_and_b32 v133, 0xffff0000, v194
    v_lshlrev_b32 v134, 16, v195
    v_and_b32 v135, 0xffff0000, v195
    v_lshlrev_b32 v136, 16, v196
    v_and_b32 v137, 0xffff0000, v196
    v_lshlrev_b32 v138, 16, v197
    v_and_b32 v139, 0xffff0000, v197
    v_lshlrev_b32 v140, 16, v198
    v_and_b32 v141, 0xffff0000, v198
    v_lshlrev_b32 v142, 16, v199
    v_and_b32 v143, 0xffff0000, v199
    v_lshlrev_b32 v144, 16, v200
    v_and_b32 v145, 0xffff0000, v200
    v_lshlrev_b32 v146, 16, v201
    v_and_b32 v147, 0xffff0000, v201
    v_lshlrev_b32 v148, 16, v202
    v_and_b32 v149, 0xffff0000, v202
    v_lshlrev_b32 v150, 16, v203
    v_and_b32 v151, 0xffff0000, v203
    v_lshlrev_b32 v152, 16, v204
    v_and_b32 v153, 0xffff0000, v204
    v_lshlrev_b32 v154, 16, v205
    v_and_b32 v155, 0xffff0000, v205
    v_lshlrev_b32 v156, 16, v206
    v_and_b32 v157, 0xffff0000, v206
    v_lshlrev_b32 v158, 16, v207
    v_and_b32 v159, 0xffff0000, v207
    v_lshlrev_b32 v112, 16, v208
    v_and_b32 v113, 0xffff0000, v208
    v_lshlrev_b32 v114, 16, v209
    v_and_b32 v115, 0xffff0000, v209
    v_lshlrev_b32 v116, 16, v210
    v_and_b32 v117, 0xffff0000, v210
    v_lshlrev_b32 v118, 16, v211
    v_and_b32 v119, 0xffff0000, v211
    v_pk_add_f32 v[120:121], v[112:113], v[114:115]
    v_pk_add_f32 v[122:123], v[116:117], v[118:119]
    v_pk_add_f32 v[120:121], v[120:121], v[122:123]
    v_add_f32 v196, v120, v121
    s_barrier
    s_waitcnt vmcnt(12)
    v_max3_u32 v235, v176, v177, v178
    v_max3_u32 v235, v235, v179, v180
    v_max3_u32 v235, v235, v181, v182
    v_max3_u32 v235, v235, v183, v184
    v_max3_u32 v235, v235, v185, v186
    v_max3_u32 v235, v235, v187, v188
    v_max3_u32 v235, v235, v189, v190
    v_max_u32 v235, v235, v191
    v_cmp_eq_u32 vcc, -1, v235
    s_cbranch_vccnz kc_r3
kc_r3o:
    v_lshlrev_b32 v64, 16, v176
    v_and_b32 v65, 0xffff0000, v176
    v_lshlrev_b32 v66, 16, v177
    v_and_b32 v67, 0xffff0000, v177
    v_pk_add_f32 v[32:33], v[32:33], v[64:65]
    v_pk_add_f32 v[34:35], v[34:35], v[66:67]
    v_lshlrev_b32 v68, 16, v178
    v_and_b32 v69, 0xffff0000, v178
    v_lshlrev_b32 v70, 16, v179
    v_and_b32 v71, 0xffff0000, v179
    v_pk_add_f32 v[36:37], v[36:37], v[68:69]
    v_pk_add_f32 v[38:39], v[38:39], v[70:71]
    v_lshlrev_b32 v72, 16, v180
    v_and_b32 v73, 0xffff0000, v180
    v_lshlrev_b32 v74, 16, v181
    v_and_b32 v75, 0xffff0000, v181
    v_pk_add_f32 v[40:41], v[40:41], v[72:73]
    v_pk_add_f32 v[42:43], v[42:43], v[74:75]
    v_lshlrev_b32 v76, 16, v182
    v_and_b32 v77, 0xffff0000, v182
    v_lshlrev_b32 v78, 16, v183
    v_and_b32 v79, 0xffff0000, v183
    v_pk_add_f32 v[44:45], v[44:45], v[76:77]
    v_pk_add_f32 v[46:47], v[46:47], v[78:79]
    v_lshlrev_b32 v80, 16, v184
    v_and_b32 v81, 0xffff0000, v184
    v_lshlrev_b32 v82, 16, v185
    v_and_b32 v83, 0xffff0000, v185
    v_pk_add_f32 v[48:49], v[48:49], v[80:81]
    v_pk_add_f32 v[50:51], v[50:51], v[82:83]
    v_lshlrev_b32 v84, 16, v186
    v_and_b32 v85, 0xffff0000, v186
    v_lshlrev_b32 v86, 16, v187
    v_and_b32 v87, 0xffff0000, v187
    v_pk_add_f32 v[52:53], v[52:53], v[84:85]
    v_pk_add_f32 v[54:55], v[54:55], v[86:87]
    v_lshlrev_b32 v88, 16, v188
    v_and_b32 v89, 0xffff0000, v188
    v_lshlrev_b32 v90, 16, v189
    v_and_b32 v91, 0xffff0000, v189
    v_pk_add_f32 v[56:57], v[56:57], v[88:89]
    v_pk_add_f32 v[58:59], v[58:59], v[90:91]
    v_lshlrev_b32 v92, 16, v190
    v_and_b32 v93, 0xffff0000, v190
    v_lshlrev_b32 v94, 16, v191
    v_and_b32 v95, 0xffff0000, v191
    v_pk_add_f32 v[60:61], v[60:61], v[92:93]
    v_pk_add_f32 v[62:63], v[62:63], v[94:95]
    s_waitcnt vmcnt(4)
    v_max3_u32 v235, v96, v97, v98
    v_max3_u32 v235, v235, v99, v100
    v_max3_u32 v235, v235, v101, v102
    v_max3_u32 v235, v235, v103, v104
    v_max3_u32 v235, v235, v105, v106
    v_max3_u32 v235, v235, v107, v108
    v_max3_u32 v235, v235, v109, v110
    v_max_u32 v235, v235, v111
    v_cmp_eq_u32 vcc, -1, v235
    s_cbranch_vccnz kc_r1
kc_r1o:
    v_lshlrev_b32 v64, 16, v96
    v_and_b32 v65, 0xffff0000, v96
    v_lshlrev_b32 v66, 16, v97
    v_and_b32 v67, 0xffff0000, v97
    v_pk_add_f32 v[32:33], v[32:33], v[64:65]
    v_pk_add_f32 v[34:35], v[34:35], v[66:67]
    v_lshlrev_b32 v68, 16, v98
    v_and_b32 v69, 0xffff0000, v98
    v_lshlrev_b32 v70, 16, v99
    v_and_b32 v71, 0xffff0000, v99
    v_pk_add_f32 v[36:37], v[36:37], v[68:69]
    v_pk_add_f32 v[38:39], v[38:39], v[70:71]
    v_lshlrev_b32 v72, 16, v100
    v_and_b32 v73, 0xffff0000, v100
    v_lshlrev_b32 v74, 16, v101
    v_and_b32 v75, 0xffff0000, v101
    v_pk_add_f32 v[40:41], v[40:41], v[72:73]
    v_pk_add_f32 v[42:43], v[42:43], v[74:75]
    v_lshlrev_b32 v76, 16, v102
    v_and_b32 v77, 0xffff0000, v102
    v_lshlrev_b32 v78, 16, v103
    v_and_b32 v79, 0xffff0000, v103
    v_pk_add_f32 v[44:45], v[44:45], v[76:77]
    v_pk_add_f32 v[46:47], v[46:47], v[78:79]
    v_lshlrev_b32 v80, 16, v104
    v_and_b32 v81, 0xffff0000, v104
    v_lshlrev_b32 v82, 16, v105
    v_and_b32 v83, 0xffff0000, v105
    v_pk_add_f32 v[48:49], v[48:49], v[80:81]
    v_pk_add_f32 v[50:51], v[50:51], v[82:83]
    v_lshlrev_b32 v84, 16, v106
    v_and_b32 v85, 0xffff0000, v106
    v_lshlrev_b32 v86, 16, v107
    v_and_b32 v87, 0xffff0000, v107
    v_pk_add_f32 v[52:53], v[52:53], v[84:85]
    v_pk_add_f32 v[54:55], v[54:55], v[86:87]
    v_lshlrev_b32 v88, 16, v108
    v_and_b32 v89, 0xffff0000, v108
    v_lshlrev_b32 v90, 16, v109
    v_and_b32 v91, 0xffff0000, v109
    v_pk_add_f32 v[56:57], v[56:57], v[88:89]
    v_pk_add_f32 v[58:59], v[58:59], v[90:91]
    v_lshlrev_b32 v92, 16, v110
    v_and_b32 v93, 0xffff0000, v110
    v_lshlrev_b32 v94, 16, v111
    v_and_b32 v95, 0xffff0000, v111
    v_pk_add_f32 v[60:61], v[60:61], v[92:93]
    v_pk_add_f32 v[62:63], v[62:63], v[94:95]
    s_waitcnt vmcnt(0)
    v_max3_u32 v235, v160, v161, v162
    v_max3_u32 v235, v235, v163, v164
    v_max3_u32 v235, v235, v165, v166
    v_max3_u32 v235, v235, v167, v168
    v_max3_u32 v235, v235, v169, v170
    v_max3_u32 v235, v235, v171, v172
    v_max3_u32 v235, v235, v173, v174
    v_max_u32 v235, v235, v175
    v_cmp_eq_u32 vcc, -1, v235
    s_cbranch_vccnz kc_r2
kc_r2o:
    v_lshlrev_b32 v64, 16, v160
    v_and_b32 v65, 0xffff0000, v160
    v_lshlrev_b32 v66, 16, v161
    v_and_b32 v67, 0xffff0000, v161
    v_pk_add_f32 v[32:33], v[32:33], v[64:65]
    v_pk_add_f32 v[34:35], v[34:35], v[66:67]
    v_cvt_pk_bf16_f32 v0, v32, v33
    v_cvt_pk_bf16_f32 v1, v34, v35
    ds_write_b64 v238, v[0:1] offset:0
    v_lshlrev_b32 v68, 16, v162
    v_and_b32 v69, 0xffff0000, v162
    v_lshlrev_b32 v70, 16, v163
    v_and_b32 v71, 0xffff0000, v163
    v_pk_add_f32 v[36:37], v[36:37], v[68:69]
    v_pk_add_f32 v[38:39], v[38:39], v[70:71]
    v_cvt_pk_bf16_f32 v2, v36, v37
    v_cvt_pk_bf16_f32 v3, v38, v39
    ds_write_b64 v238, v[2:3] offset:2304
    v_lshlrev_b32 v72, 16, v164
    v_and_b32 v73, 0xffff0000, v164
    v_lshlrev_b32 v74, 16, v165
    v_and_b32 v75, 0xffff0000, v165
    v_pk_add_f32 v[40:41], v[40:41], v[72:73]
    v_pk_add_f32 v[42:43], v[42:43], v[74:75]
    v_cvt_pk_bf16_f32 v4, v40, v41
    v_cvt_pk_bf16_f32 v5, v42, v43
    ds_write_b64 v238, v[4:5] offset:32
    v_lshlrev_b32 v76, 16, v166
    v_and_b32 v77, 0xffff0000, v166
    v_lshlrev_b32 v78, 16, v167
    v_and_b32 v79, 0xffff0000, v167
    v_pk_add_f32 v[44:45], v[44:45], v[76:77]
    v_pk_add_f32 v[46:47], v[46:47], v[78:79]
    v_cvt_pk_bf16_f32 v6, v44, v45
    v_cvt_pk_bf16_f32 v7, v46, v47
    ds_write_b64 v238, v[6:7] offset:2336
    v_lshlrev_b32 v80, 16, v168
    v_and_b32 v81, 0xffff0000, v168
    v_lshlrev_b32 v82, 16, v169
    v_and_b32 v83, 0xffff0000, v169
    v_pk_add_f32 v[48:49], v[48:49], v[80:81]
    v_pk_add_f32 v[50:51], v[50:51], v[82:83]
    v_cvt_pk_bf16_f32 v8, v48, v49
    v_cvt_pk_bf16_f32 v9, v50, v51
    ds_write_b64 v238, v[8:9] offset:64
    v_lshlrev_b32 v84, 16, v170
    v_and_b32 v85, 0xffff0000, v170
    v_lshlrev_b32 v86, 16, v171
    v_and_b32 v87, 0xffff0000, v171
    v_pk_add_f32 v[52:53], v[52:53], v[84:85]
    v_pk_add_f32 v[54:55], v[54:55], v[86:87]
    v_cvt_pk_bf16_f32 v10, v52, v53
    v_cvt_pk_bf16_f32 v11, v54, v55
    ds_write_b64 v238, v[10:11] offset:2368
    v_lshlrev_b32 v88, 16, v172
    v_and_b32 v89, 0xffff0000, v172
    v_lshlrev_b32 v90, 16, v173
    v_and_b32 v91, 0xffff0000, v173
    v_pk_add_f32 v[56:57], v[56:57], v[88:89]
    v_pk_add_f32 v[58:59], v[58:59], v[90:91]
    v_cvt_pk_bf16_f32 v12, v56, v57
    v_cvt_pk_bf16_f32 v13, v58, v59
    ds_write_b64 v238, v[12:13] offset:96
    v_lshlrev_b32 v92, 16, v174
    v_and_b32 v93, 0xffff0000, v174
    v_lshlrev_b32 v94, 16, v175
    v_and_b32 v95, 0xffff0000, v175
    v_pk_add_f32 v[60:61], v[60:61], v[92:93]
    v_pk_add_f32 v[62:63], v[62:63], v[94:95]
    v_cvt_pk_bf16_f32 v14, v60, v61
    v_cvt_pk_bf16_f32 v15, v62, v63
    ds_write_b64 v238, v[14:15] offset:2400
    s_waitcnt lgkmcnt(0)
    ds_read_b128 v[16:19], v239 offset:0
    ds_read_b128 v[20:23], v239 offset:1152
    ds_read_b128 v[24:27], v239 offset:2304
    ds_read_b128 v[28:31], v239 offset:3456
    s_waitcnt lgkmcnt(3)
    v_lshlrev_b32 v64, 16, v16
    v_lshlrev_b32 v66, 16, v17
    v_lshlrev_b32 v68, 16, v18
    v_lshlrev_b32 v70, 16, v19
    v_and_b32 v65, 0xffff0000, v16
    v_and_b32 v67, 0xffff0000, v17
    v_and_b32 v69, 0xffff0000, v18
    v_and_b32 v71, 0xffff0000, v19
    v_pk_add_f32 v[64:65], v[64:65], v[128:129]
    v_pk_add_f32 v[66:67], v[66:67], v[130:131]
    v_pk_add_f32 v[68:69], v[68:69], v[132:133]
    v_pk_add_f32 v[70:71], v[70:71], v[134:135]
    v_cvt_pk_bf16_f32 v16, v64, v65
    v_cvt_pk_bf16_f32 v17, v66, v67
    v_cvt_pk_bf16_f32 v18, v68, v69
    v_cvt_pk_bf16_f32 v19, v70, v71
    v_lshlrev_b32 v64, 16, v16
    v_lshlrev_b32 v66, 16, v17
    v_lshlrev_b32 v68, 16, v18
    v_lshlrev_b32 v70, 16, v19
    v_and_b32 v65, 0xffff0000, v16
    v_and_b32 v67, 0xffff0000, v17
    v_and_b32 v69, 0xffff0000, v18
    v_and_b32 v71, 0xffff0000, v19
    s_mov_b32 s32, 0x3400000
    buffer_store_dwordx4 v[16:19], v229, s[8:11], s32 offen sc1
    v_pk_add_f32 v[160:161], v[64:65], v[66:67]
    v_pk_mul_f32 v[162:163], v[64:65], v[64:65]
    v_pk_mul_f32 v[164:165], v[64:65], v[112:113]
    v_pk_fma_f32 v[162:163], v[66:67], v[66:67], v[162:163]
    v_pk_fma_f32 v[164:165], v[66:67], v[114:115], v[164:165]
    v_pk_add_f32 v[160:161], v[160:161], v[68:69]
    v_pk_fma_f32 v[162:163], v[68:69], v[68:69], v[162:163]
    v_pk_fma_f32 v[164:165], v[68:69], v[116:117], v[164:165]
    v_pk_add_f32 v[160:161], v[160:161], v[70:71]
    v_pk_fma_f32 v[162:163], v[70:71], v[70:71], v[162:163]
    v_pk_fma_f32 v[164:165], v[70:71], v[118:119], v[164:165]
    v_add_f32 v184, v160, v161
    v_add_f32 v185, v162, v163
    v_add_f32 v186, v164, v165
    s_waitcnt lgkmcnt(2)
    v_lshlrev_b32 v72, 16, v20
    v_lshlrev_b32 v74, 16, v21
    v_lshlrev_b32 v76, 16, v22
    v_lshlrev_b32 v78, 16, v23
    v_and_b32 v73, 0xffff0000, v20
    v_and_b32 v75, 0xffff0000, v21
    v_and_b32 v77, 0xffff0000, v22
    v_and_b32 v79, 0xffff0000, v23
    v_pk_add_f32 v[72:73], v[72:73], v[136:137]
    v_pk_add_f32 v[74:75], v[74:75], v[138:139]
    v_pk_add_f32 v[76:77], v[76:77], v[140:141]
    v_pk_add_f32 v[78:79], v[78:79], v[142:143]
    v_cvt_pk_bf16_f32 v20, v72, v73
    v_cvt_pk_bf16_f32 v21, v74, v75
    v_cvt_pk_bf16_f32 v22, v76, v77
    v_cvt_pk_bf16_f32 v23, v78, v79
    v_lshlrev_b32 v72, 16, v20
    v_lshlrev_b32 v74, 16, v21
    v_lshlrev_b32 v76, 16, v22
    v_lshlrev_b32 v78, 16, v23
    v_and_b32 v73, 0xffff0000, v20
    v_and_b32 v75, 0xffff0000, v21
    v_and_b32 v77, 0xffff0000, v22
    v_and_b32 v79, 0xffff0000, v23
    s_mov_b32 s32, 0x3404000
    buffer_store_dwordx4 v[20:23], v229, s[8:11], s32 offen sc1
    v_pk_add_f32 v[166:167], v[72:73], v[74:75]
    v_pk_mul_f32 v[168:169], v[72:73], v[72:73]
    v_pk_mul_f32 v[170:171], v[72:73], v[112:113]
    v_pk_fma_f32 v[168:169], v[74:75], v[74:75], v[168:169]
    v_pk_fma_f32 v[170:171], v[74:75], v[114:115], v[170:171]
    v_pk_add_f32 v[166:167], v[166:167], v[76:77]
    v_pk_fma_f32 v[168:169], v[76:77], v[76:77], v[168:169]
    v_pk_fma_f32 v[170:171], v[76:77], v[116:117], v[170:171]
    v_pk_add_f32 v[166:167], v[166:167], v[78:79]
    v_pk_fma_f32 v[168:169], v[78:79], v[78:79], v[168:169]
    v_pk_fma_f32 v[170:171], v[78:79], v[118:119], v[170:171]
    v_add_f32 v187, v166, v167
    v_add_f32 v188, v168, v169
    v_add_f32 v189, v170, v171
    s_waitcnt lgkmcnt(1)
    v_lshlrev_b32 v80, 16, v24
    v_lshlrev_b32 v82, 16, v25
    v_lshlrev_b32 v84, 16, v26
    v_lshlrev_b32 v86, 16, v27
    v_and_b32 v81, 0xffff0000, v24
    v_and_b32 v83, 0xffff0000, v25
    v_and_b32 v85, 0xffff0000, v26
    v_and_b32 v87, 0xffff0000, v27
    v_pk_add_f32 v[80:81], v[80:81], v[144:145]
    v_pk_add_f32 v[82:83], v[82:83], v[146:147]
    v_pk_add_f32 v[84:85], v[84:85], v[148:149]
    v_pk_add_f32 v[86:87], v[86:87], v[150:151]
    v_cvt_pk_bf16_f32 v24, v80, v81
    v_cvt_pk_bf16_f32 v25, v82, v83
    v_cvt_pk_bf16_f32 v26, v84, v85
    v_cvt_pk_bf16_f32 v27, v86, v87
    v_lshlrev_b32 v80, 16, v24
    v_lshlrev_b32 v82, 16, v25
    v_lshlrev_b32 v84, 16, v26
    v_lshlrev_b32 v86, 16, v27
    v_and_b32 v81, 0xffff0000, v24
    v_and_b32 v83, 0xffff0000, v25
    v_and_b32 v85, 0xffff0000, v26
    v_and_b32 v87, 0xffff0000, v27
    s_mov_b32 s32, 0x3408000
    buffer_store_dwordx4 v[24:27], v229, s[8:11], s32 offen sc1
    v_pk_add_f32 v[172:173], v[80:81], v[82:83]
    v_pk_mul_f32 v[174:175], v[80:81], v[80:81]
    v_pk_mul_f32 v[176:177], v[80:81], v[112:113]
    v_pk_fma_f32 v[174:175], v[82:83], v[82:83], v[174:175]
    v_pk_fma_f32 v[176:177], v[82:83], v[114:115], v[176:177]
    v_pk_add_f32 v[172:173], v[172:173], v[84:85]
    v_pk_fma_f32 v[174:175], v[84:85], v[84:85], v[174:175]
    v_pk_fma_f32 v[176:177], v[84:85], v[116:117], v[176:177]
    v_pk_add_f32 v[172:173], v[172:173], v[86:87]
    v_pk_fma_f32 v[174:175], v[86:87], v[86:87], v[174:175]
    v_pk_fma_f32 v[176:177], v[86:87], v[118:119], v[176:177]
    v_add_f32 v190, v172, v173
    v_add_f32 v191, v174, v175
    v_add_f32 v192, v176, v177
    s_waitcnt lgkmcnt(0)
    v_lshlrev_b32 v88, 16, v28
    v_lshlrev_b32 v90, 16, v29
    v_lshlrev_b32 v92, 16, v30
    v_lshlrev_b32 v94, 16, v31
    v_and_b32 v89, 0xffff0000, v28
    v_and_b32 v91, 0xffff0000, v29
    v_and_b32 v93, 0xffff0000, v30
    v_and_b32 v95, 0xffff0000, v31
    v_pk_add_f32 v[88:89], v[88:89], v[152:153]
    v_pk_add_f32 v[90:91], v[90:91], v[154:155]
    v_pk_add_f32 v[92:93], v[92:93], v[156:157]
    v_pk_add_f32 v[94:95], v[94:95], v[158:159]
    v_cvt_pk_bf16_f32 v28, v88, v89
    v_cvt_pk_bf16_f32 v29, v90, v91
    v_cvt_pk_bf16_f32 v30, v92, v93
    v_cvt_pk_bf16_f32 v31, v94, v95
    v_lshlrev_b32 v88, 16, v28
    v_lshlrev_b32 v90, 16, v29
    v_lshlrev_b32 v92, 16, v30
    v_lshlrev_b32 v94, 16, v31
    v_and_b32 v89, 0xffff0000, v28
    v_and_b32 v91, 0xffff0000, v29
    v_and_b32 v93, 0xffff0000, v30
    v_and_b32 v95, 0xffff0000, v31
    s_mov_b32 s32, 0x340c000
    buffer_store_dwordx4 v[28:31], v229, s[8:11], s32 offen sc1
    v_pk_add_f32 v[178:179], v[88:89], v[90:91]
    v_pk_mul_f32 v[180:181], v[88:89], v[88:89]
    v_pk_mul_f32 v[182:183], v[88:89], v[112:113]
    v_pk_fma_f32 v[180:181], v[90:91], v[90:91], v[180:181]
    v_pk_fma_f32 v[182:183], v[90:91], v[114:115], v[182:183]
    v_pk_add_f32 v[178:179], v[178:179], v[92:93]
    v_pk_fma_f32 v[180:181], v[92:93], v[92:93], v[180:181]
    v_pk_fma_f32 v[182:183], v[92:93], v[116:117], v[182:183]
    v_pk_add_f32 v[178:179], v[178:179], v[94:95]
    v_pk_fma_f32 v[180:181], v[94:95], v[94:95], v[180:181]
    v_pk_fma_f32 v[182:183], v[94:95], v[118:119], v[182:183]
    v_add_f32 v193, v178, v179
    v_add_f32 v194, v180, v181
    v_add_f32 v195, v182, v183
    v_add_f32_dpp v196, v196, v196 quad_perm:[1,0,3,2] row_mask:0xf bank_mask:0xf
    v_add_f32_dpp v184, v184, v184 quad_perm:[1,0,3,2] row_mask:0xf bank_mask:0xf
    v_add_f32_dpp v185, v185, v185 quad_perm:[1,0,3,2] row_mask:0xf bank_mask:0xf
    v_add_f32_dpp v186, v186, v186 quad_perm:[1,0,3,2] row_mask:0xf bank_mask:0xf
    v_add_f32_dpp v187, v187, v187 quad_perm:[1,0,3,2] row_mask:0xf bank_mask:0xf
    v_add_f32_dpp v188, v188, v188 quad_perm:[1,0,3,2] row_mask:0xf bank_mask:0xf
    v_add_f32_dpp v189, v189, v189 quad_perm:[1,0,3,2] row_mask:0xf bank_mask:0xf
    v_add_f32_dpp v190, v190, v190 quad_perm:[1,0,3,2] row_mask:0xf bank_mask:0xf
    v_add_f32_dpp v191, v191, v191 quad_perm:[1,0,3,2] row_mask:0xf bank_mask:0xf
    v_add_f32_dpp v192, v192, v192 quad_perm:[1,0,3,2] row_mask:0xf bank_mask:0xf
    v_add_f32_dpp v193, v193, v193 quad_perm:[1,0,3,2] row_mask:0xf bank_mask:0xf
    v_add_f32_dpp v194, v194, v194 quad_perm:[1,0,3,2] row_mask:0xf bank_mask:0xf
    v_add_f32_dpp v195, v195, v195 quad_perm:[1,0,3,2] row_mask:0xf bank_mask:0xf
    v_add_f32_dpp v196, v196, v196 quad_perm:[2,3,0,1] row_mask:0xf bank_mask:0xf
    v_add_f32_dpp v184, v184, v184 quad_perm:[2,3,0,1] row_mask:0xf bank_mask:0xf
    v_add_f32_dpp v185, v185, v185 quad_perm:[2,3,0,1] row_mask:0xf bank_mask:0xf
    v_add_f32_dpp v186, v186, v186 quad_perm:[2,3,0,1] row_mask:0xf bank_mask:0xf
    v_add_f32_dpp v187, v187, v187 quad_perm:[2,3,0,1] row_mask:0xf bank_mask:0xf
    v_add_f32_dpp v188, v188, v188 quad_perm:[2,3,0,1] row_mask:0xf bank_mask:0xf
    v_add_f32_dpp v189, v189, v189 quad_perm:[2,3,0,1] row_mask:0xf bank_mask:0xf
    v_add_f32_dpp v190, v190, v190 quad_perm:[2,3,0,1] row_mask:0xf bank_mask:0xf
    v_add_f32_dpp v191, v191, v191 quad_perm:[2,3,0,1] row_mask:0xf bank_mask:0xf
    v_add_f32_dpp v192, v192, v192 quad_perm:[2,3,0,1] row_mask:0xf bank_mask:0xf
    v_add_f32_dpp v193, v193, v193 quad_perm:[2,3,0,1] row_mask:0xf bank_mask:0xf
    v_add_f32_dpp v194, v194, v194 quad_perm:[2,3,0,1] row_mask:0xf bank_mask:0xf
    v_add_f32_dpp v195, v195, v195 quad_perm:[2,3,0,1] row_mask:0xf bank_mask:0xf
    v_add_f32_dpp v196, v196, v196 row_half_mirror row_mask:0xf bank_mask:0xf
    v_add_f32_dpp v184, v184, v184 row_half_mirror row_mask:0xf bank_mask:0xf
    v_add_f32_dpp v185, v185, v185 row_half_mirror row_mask:0xf bank_mask:0xf
    v_add_f32_dpp v186, v186, v186 row_half_mirror row_mask:0xf bank_mask:0xf
    v_add_f32_dpp v187, v187, v187 row_half_mirror row_mask:0xf bank_mask:0xf
    v_add_f32_dpp v188, v188, v188 row_half_mirror row_mask:0xf bank_mask:0xf
    v_add_f32_dpp v189, v189, v189 row_half_mirror row_mask:0xf bank_mask:0xf
    v_add_f32_dpp v190, v190, v190 row_half_mirror row_mask:0xf bank_mask:0xf
    v_add_f32_dpp v191, v191, v191 row_half_mirror row_mask:0xf bank_mask:0xf
    v_add_f32_dpp v192, v192, v192 row_half_mirror row_mask:0xf bank_mask:0xf
    v_add_f32_dpp v193, v193, v193 row_half_mirror row_mask:0xf bank_mask:0xf
    v_add_f32_dpp v194, v194, v194 row_half_mirror row_mask:0xf bank_mask:0xf
    v_add_f32_dpp v195, v195, v195 row_half_mirror row_mask:0xf bank_mask:0xf
    v_cndmask_b32 v184, v184, v187, s[60:61]
    v_cndmask_b32 v190, v190, v193, s[60:61]
    v_cndmask_b32 v185, v185, v188, s[60:61]
    v_cndmask_b32 v191, v191, v194, s[60:61]
    v_cndmask_b32 v186, v186, v189, s[60:61]
    v_cndmask_b32 v192, v192, v195, s[60:61]
    v_cndmask_b32 v184, v184, v190, s[62:63]
    v_cndmask_b32 v185, v185, v191, s[62:63]
    v_cndmask_b32 v186, v186, v192, s[62:63]
    v_cndmask_b32 v184, v184, v185, s[40:41]
    v_cndmask_b32 v186, v186, v196, s[40:41]
    buffer_atomic_add_f32 v184, v231, s[8:11], s48 offen
    buffer_atomic_add_f32 v186, v232, s[8:11], s48 offen
    s_lshl_b32 s32, s3, 13
    v_add_u32 v234, s32, v228
    v_add_u32 v235, 65536, v234
    ds_write_b128 v234, a[128:131] offset:0
    ds_write_b128 v234, a[132:135] offset:1024
    ds_write_b128 v234, a[136:139] offset:2048
    ds_write_b128 v234, a[140:143] offset:3072
    ds_write_b128 v234, a[144:147] offset:4096
    ds_write_b128 v234, a[148:151] offset:5120
    ds_write_b128 v234, a[152:155] offset:6144
    ds_write_b128 v234, a[156:159] offset:7168
    s_waitcnt lgkmcnt(4)
    ds_write_b128 v234, a[160:163] offset:32768
    ds_write_b128 v234, a[164:167] offset:33792
    ds_write_b128 v234, a[168:171] offset:34816
    ds_write_b128 v234, a[172:175] offset:35840
    ds_write_b128 v234, a[176:179] offset:36864
    ds_write_b128 v234, a[180:183] offset:37888
    ds_write_b128 v234, a[184:187] offset:38912
    ds_write_b128 v234, a[188:191] offset:39936
    s_waitcnt lgkmcnt(4)
    ds_write_b128 v235, a[192:195] offset:0
    ds_write_b128 v235, a[196:199] offset:1024
    ds_write_b128 v235, a[200:203] offset:2048
    ds_write_b128 v235, a[204:207] offset:3072
    ds_write_b128 v235, a[208:211] offset:4096
    ds_write_b128 v235, a[212:215] offset:5120
    ds_write_b128 v235, a[216:219] offset:6144
    ds_write_b128 v235, a[220:223] offset:7168
    s_waitcnt lgkmcnt(4)
    s_lshl_b32 s35, s3, 13
    v_bfe_u32 v234, v237, 2, 3
    v_lshrrev_b32 v235, 5, v237
    v_lshl_add_u32 v234, v235, 4, v234
    v_lshlrev_b32 v234, 5, v234
    v_and_b32 v236, 3, v237
    v_lshl_add_u32 v234, v236, 3, v234
    v_add_u32 v217, s35, v234
    v_lshlrev_b32 v235, 5, v235
    v_bfe_u32 v236, v237, 4, 1
    v_lshl_add_u32 v235, v236, 3, v235
    v_and_b32 v236, 1, v237
    v_lshl_add_u32 v235, v236, 11, v235
    s_lshl_b32 s32, s3, 9
    s_add_u32 s32, s32, 98304
    v_add_u32 v218, s32, v235
    v_lshlrev_b32 v234, 4, v230
    v_add_u32 v220, 106752, v234
    v_add_u32 v221, 106752, v228
    v_lshrrev_b32 v236, 2, v237
    v_lshlrev_b32 v236, 7, v236
    v_and_b32 v234, 3, v237
    v_lshl_add_u32 v236, v234, 3, v236
    s_add_u32 s32, s35, 65536
    v_add_u32 v219, s32, v236
    s_lshl_b32 s32, s3, 12
    s_add_u32 s32, s32, 114944
    v_and_b32 v234, 15, v237
    v_min_u32 v234, 2, v234
    v_lshlrev_b32 v234, 10, v234
    v_lshrrev_b32 v235, 4, v237
    v_lshl_add_u32 v234, v235, 4, v234
    v_add_u32 v222, s32, v234
    v_add_u32 v223, s32, v228
    s_waitcnt vmcnt(0)
    s_barrier
    s_cmp_lg_u32 s3, 0
    s_cbranch_scc1 kc_a1
    s_lshl_b32 s32, s52, 7
    s_add_u32 s32, s32, 0x38a0000
    v_mov_b32 v235, 1
    buffer_atomic_add v235, v243, s[8:11], s32 offen sc0 sc1
    v_lshlrev_b32 v234, 7, v237
    v_cmp_gt_u32 vcc, 8, v237
    v_mov_b32 v236, 0x40000000
    s_mov_b32 s34, 0x38a0400
    v_cndmask_b32 v234, v236, v234, vcc
    s_waitcnt vmcnt(0)
    v_readfirstlane_b32 s36, v235
    s_cmp_lg_u32 s36, 31
    s_cbranch_scc1 kc_a1
    buffer_atomic_add v233, v234, s[8:11], s34 offen sc1
kc_a1:
    s_waitcnt lgkmcnt(0)
    ds_read_b64_tr_b16 a[0:1], v217 offset:0
    ds_read_b64_tr_b16 a[2:3], v217 offset:256
    ds_read_b64_tr_b16 a[32:33], v217 offset:32768
    ds_read_b64_tr_b16 a[34:35], v217 offset:33024
    ds_read_b64_tr_b16 a[4:5], v217 offset:1024
    ds_read_b64_tr_b16 a[6:7], v217 offset:1280
    ds_read_b64_tr_b16 a[36:37], v217 offset:33792
    ds_read_b64_tr_b16 a[38:39], v217 offset:34048
    s_waitcnt lgkmcnt(6)
    ds_read_b64_tr_b16 a[8:9], v217 offset:2048
    ds_read_b64_tr_b16 a[10:11], v217 offset:2304
    ds_read_b64_tr_b16 a[40:41], v217 offset:34816
    ds_read_b64_tr_b16 a[42:43], v217 offset:35072
    ds_read_b64_tr_b16 a[12:13], v217 offset:3072
    ds_read_b64_tr_b16 a[14:15], v217 offset:3328
    ds_read_b64_tr_b16 a[44:45], v217 offset:35840
    ds_read_b64_tr_b16 a[46:47], v217 offset:36096
    s_waitcnt lgkmcnt(6)
    ds_read_b64_tr_b16 a[16:17], v217 offset:4096
    ds_read_b64_tr_b16 a[18:19], v217 offset:4352
    ds_read_b64_tr_b16 a[48:49], v217 offset:36864
    ds_read_b64_tr_b16 a[50:51], v217 offset:37120
    ds_read_b64_tr_b16 a[20:21], v217 offset:5120
    ds_read_b64_tr_b16 a[22:23], v217 offset:5376
    ds_read_b64_tr_b16 a[52:53], v217 offset:37888
    ds_read_b64_tr_b16 a[54:55], v217 offset:38144
    s_waitcnt lgkmcnt(6)
    ds_read_b64_tr_b16 a[24:25], v217 offset:6144
    ds_read_b64_tr_b16 a[26:27], v217 offset:6400
    ds_read_b64_tr_b16 a[56:57], v217 offset:38912
    ds_read_b64_tr_b16 a[58:59], v217 offset:39168
    ds_read_b64_tr_b16 a[28:29], v217 offset:7168
    ds_read_b64_tr_b16 a[30:31], v217 offset:7424
    ds_read_b64_tr_b16 a[60:61], v217 offset:39936
    ds_read_b64_tr_b16 a[62:63], v217 offset:40192
    s_waitcnt lgkmcnt(6)
    ds_read_b64_tr_b16 a[64:65], v219 offset:0
    ds_read_b64_tr_b16 a[66:67], v219 offset:32
    ds_read_b64_tr_b16 a[68:69], v219 offset:64
    ds_read_b64_tr_b16 a[70:71], v219 offset:96
    ds_read_b64_tr_b16 a[72:73], v219 offset:2048
    ds_read_b64_tr_b16 a[74:75], v219 offset:2080
    ds_read_b64_tr_b16 a[76:77], v219 offset:2112
    ds_read_b64_tr_b16 a[78:79], v219 offset:2144
    s_waitcnt lgkmcnt(6)
    ds_read_b64_tr_b16 a[80:81], v219 offset:4096
    ds_read_b64_tr_b16 a[82:83], v219 offset:4128
    ds_read_b64_tr_b16 a[84:85], v219 offset:4160
    ds_read_b64_tr_b16 a[86:87], v219 offset:4192
    ds_read_b64_tr_b16 a[88:89], v219 offset:6144
    ds_read_b64_tr_b16 a[90:91], v219 offset:6176
    ds_read_b64_tr_b16 a[92:93], v219 offset:6208
    ds_read_b64_tr_b16 a[94:95], v219 offset:6240
    s_waitcnt lgkmcnt(6)
    v_mov_b32 v130, 0x3a800000
    v_mov_b32 v131, 0x3a800000
    v_mov_b32 v132, 0x3727c5ac
    v_mov_b32 v133, 0x3727c5ac
    s_mov_b32 s33, 0xfffff800
    s_lshl_b32 s39, s3, 11
    v_add_u32 v238, s39, v228
    v_lshlrev_b32 v239, 2, v242
    s_lshl_b32 s39, s3, 3
    s_add_u32 s7, s39, 106512
    v_lshlrev_b32 v141, 5, v237
    v_or_b32 v141, s39, v141
    s_cmp_lg_u32 s3, 0
    s_cbranch_scc1 kc_b12
    s_lshl_b32 s32, s52, 7
    s_add_u32 s32, s32, 0x38a0400
    s_mov_b32 s34, 0x400000
    s_branch kc_b11
kc_b10:
    s_sleep 2
kc_b11:
    buffer_load_dword v235, off, s[8:11], s32 sc1
    s_waitcnt vmcnt(0)
    v_cmp_ne_u32 vcc, 8, v235
    s_sub_u32 s34, s34, 1
    s_cbranch_scc1 kc_b12
    s_cbranch_vccnz kc_b10
kc_b12:
    s_barrier
    s_add_u32 s32, s48, 24576
    buffer_load_dword v128, off, s[8:11], s32 sc1
    buffer_load_dwordx4 v[32:35], v238, s[8:11], s48 offen offset:0 sc1
    buffer_load_dwordx4 v[40:43], v238, s[8:11], s49 offen offset:0 sc1
    buffer_load_dwordx4 v[48:51], v238, s[8:11], s50 offen offset:0 sc1
    buffer_load_dwordx4 v[36:39], v238, s[8:11], s48 offen offset:1024 sc1
    buffer_load_dwordx4 v[44:47], v238, s[8:11], s49 offen offset:1024 sc1
    buffer_load_dwordx4 v[52:55], v238, s[8:11], s50 offen offset:1024 sc1
    buffer_load_dword v0, v239, s[8:11], s48 offen offset:0 sc1
    buffer_load_dword v4, v239, s[8:11], s49 offen offset:0 sc1
    buffer_load_dword v1, v239, s[8:11], s48 offen offset:32 sc1
    buffer_load_dword v5, v239, s[8:11], s49 offen offset:32 sc1
    buffer_load_dword v2, v239, s[8:11], s48 offen offset:64 sc1
    buffer_load_dword v6, v239, s[8:11], s49 offen offset:64 sc1
    buffer_load_dword v3, v239, s[8:11], s48 offen offset:96 sc1
    buffer_load_dword v7, v239, s[8:11], s49 offen offset:96 sc1
    s_waitcnt vmcnt(8)
    v_mov_b32 v129, v128
    v_pk_mul_f32 v[32:33], v[32:33], v[130:131]
    v_pk_mul_f32 v[34:35], v[34:35], v[130:131]
    v_pk_mul_f32 v[36:37], v[36:37], v[130:131]
    v_pk_mul_f32 v[38:39], v[38:39], v[130:131]
    v_pk_fma_f32 v[40:41], v[40:41], v[130:131], v[132:133]
    v_pk_fma_f32 v[42:43], v[42:43], v[130:131], v[132:133]
    v_pk_fma_f32 v[44:45], v[44:45], v[130:131], v[132:133]
    v_pk_fma_f32 v[46:47], v[46:47], v[130:131], v[132:133]
    v_pk_fma_f32 v[40:41], v[32:33], v[32:33], v[40:41] neg_lo:[1,0,0] neg_hi:[1,0,0]
    v_pk_fma_f32 v[42:43], v[34:35], v[34:35], v[42:43] neg_lo:[1,0,0] neg_hi:[1,0,0]
    v_pk_fma_f32 v[44:45], v[36:37], v[36:37], v[44:45] neg_lo:[1,0,0] neg_hi:[1,0,0]
    v_pk_fma_f32 v[46:47], v[38:39], v[38:39], v[46:47] neg_lo:[1,0,0] neg_hi:[1,0,0]
    v_pk_fma_f32 v[48:49], v[32:33], v[128:129], v[48:49] neg_lo:[1,0,0] neg_hi:[1,0,0]
    v_pk_fma_f32 v[50:51], v[34:35], v[128:129], v[50:51] neg_lo:[1,0,0] neg_hi:[1,0,0]
    v_pk_fma_f32 v[52:53], v[36:37], v[128:129], v[52:53] neg_lo:[1,0,0] neg_hi:[1,0,0]
    v_pk_fma_f32 v[54:55], v[38:39], v[128:129], v[54:55] neg_lo:[1,0,0] neg_hi:[1,0,0]
    v_max_f32 v40, v40, v132
    v_max_f32 v42, v42, v132
    v_max_f32 v44, v44, v132
    v_max_f32 v46, v46, v132
    v_max_f32 v41, v41, v132
    v_max_f32 v43, v43, v132
    v_max_f32 v45, v45, v132
    v_max_f32 v47, v47, v132
    v_rsq_f32 v40, v40
    v_rsq_f32 v42, v42
    v_rsq_f32 v44, v44
    v_rsq_f32 v46, v46
    v_rsq_f32 v41, v41
    v_rsq_f32 v43, v43
    v_rsq_f32 v45, v45
    v_rsq_f32 v47, v47
    v_pk_mul_f32 v[48:49], v[48:49], v[40:41]
    v_pk_mul_f32 v[50:51], v[50:51], v[42:43]
    v_pk_mul_f32 v[52:53], v[52:53], v[44:45]
    v_pk_mul_f32 v[54:55], v[54:55], v[46:47]
    v_and_or_b32 v48, v48, s33, 0
    v_and_or_b32 v50, v50, s33, 2
    v_and_or_b32 v52, v52, s33, 4
    v_and_or_b32 v54, v54, s33, 6
    v_and_or_b32 v49, v49, s33, 1
    v_and_or_b32 v51, v51, s33, 3
    v_and_or_b32 v53, v53, s33, 5
    v_and_or_b32 v55, v55, s33, 7
    v_max_f32 v136, v48, v49
    v_min_f32 v137, v48, v49
    v_med3_f32 v137, v136, v50, v137
    v_max_f32 v136, v136, v50
    v_med3_f32 v137, v136, v51, v137
    v_max_f32 v136, v136, v51
    v_med3_f32 v137, v136, v52, v137
    v_max_f32 v136, v136, v52
    v_med3_f32 v137, v136, v53, v137
    v_max_f32 v136, v136, v53
    v_med3_f32 v137, v136, v54, v137
    v_max_f32 v136, v136, v54
    v_med3_f32 v137, v136, v55, v137
    v_max_f32 v136, v136, v55
    v_or_b32 v136, v141, v136
    v_or_b32 v137, v141, v137
    s_nop 1
    v_mov_b32_dpp v138, v136 quad_perm:[1,0,3,2] row_mask:0xf bank_mask:0xf
    v_mov_b32_dpp v139, v137 quad_perm:[1,0,3,2] row_mask:0xf bank_mask:0xf
    v_min_f32 v140, v136, v138
    v_max_f32 v136, v136, v138
    v_max3_f32 v137, v140, v137, v139
    s_nop 1
    v_mov_b32_dpp v138, v136 quad_perm:[2,3,0,1] row_mask:0xf bank_mask:0xf
    v_mov_b32_dpp v139, v137 quad_perm:[2,3,0,1] row_mask:0xf bank_mask:0xf
    v_min_f32 v140, v136, v138
    v_max_f32 v136, v136, v138
    v_max3_f32 v137, v140, v137, v139
    s_nop 1
    v_mov_b32_dpp v138, v136 row_half_mirror row_mask:0xf bank_mask:0xf
    v_mov_b32_dpp v139, v137 row_half_mirror row_mask:0xf bank_mask:0xf
    v_min_f32 v140, v136, v138
    v_max_f32 v136, v136, v138
    v_max3_f32 v137, v140, v137, v139
    s_nop 1
    v_mov_b32_dpp v138, v136 row_mirror row_mask:0xf bank_mask:0xf
    v_mov_b32_dpp v139, v137 row_mirror row_mask:0xf bank_mask:0xf
    v_min_f32 v140, v136, v138
    v_max_f32 v136, v136, v138
    v_max3_f32 v137, v140, v137, v139
    v_mov_b32 v138, v136
    v_mov_b32 v139, v137
    s_nop 1
    v_permlane16_swap_b32 v136, v138
    v_permlane16_swap_b32 v137, v139
    s_nop 0
    v_min_f32 v140, v136, v138
    v_max_f32 v136, v136, v138
    v_max3_f32 v137, v140, v137, v139
    v_mov_b32 v138, v136
    v_mov_b32 v139, v137
    s_nop 1
    v_permlane32_swap_b32 v136, v138
    v_permlane32_swap_b32 v137, v139
    s_nop 0
    v_min_f32 v140, v136, v138
    v_max_f32 v136, v136, v138
    v_max3_f32 v137, v140, v137, v139
    v_mov_b32 v234, s7
    ds_write_b64 v234, v[136:137]
    v_mov_b32 v234, 106512
    s_waitcnt lgkmcnt(0)
    s_barrier
    ds_read_b128 v[56:59], v234
    ds_read_b128 v[60:63], v234 offset:16
    s_waitcnt lgkmcnt(0)
    v_min_f32 v140, v56, v58
    v_max_f32 v56, v56, v58
    v_max3_f32 v57, v140, v57, v59
    v_min_f32 v140, v60, v62
    v_max_f32 v60, v60, v62
    v_max3_f32 v61, v140, v61, v63
    v_min_f32 v140, v56, v60
    v_max_f32 v56, v56, v60
    v_max3_f32 v57, v140, v57, v61
    v_bfe_u32 v234, v56, 5, 6
    v_bfe_u32 v235, v56, 2, 3
    v_and_b32 v8, 3, v56
    v_lshl_add_u32 v8, v234, 2, v8
    v_lshl_add_u32 v8, v235, 8, v8
    v_bfe_u32 v234, v57, 5, 6
    v_bfe_u32 v235, v57, 2, 3
    v_and_b32 v10, 3, v57
    v_lshl_add_u32 v10, v234, 2, v10
    v_lshl_add_u32 v10, v235, 8, v10
    s_cmp_lt_u32 s3, 2
    s_cselect_b64 vcc, -1, 0
    v_lshlrev_b32 v236, 4, v230
    v_cndmask_b32 v142, v10, v8, vcc
    v_lshlrev_b32 v234, 2, v142
    v_and_b32 v235, 2047, v236
    v_lshl_add_u32 v235, v142, 11, v235
    s_mov_b32 s32, 0x3400000
    buffer_load_dwordx4 v[32:35], v235, s[8:11], s32 offen sc1
    buffer_load_dword v144, v234, s[8:11], s48 offen sc1
    buffer_load_dword v145, v234, s[8:11], s49 offen sc1
    buffer_load_dword v146, v234, s[8:11], s50 offen sc1
    v_add_u32 v236, 98304, v236
    s_lshr_b32 s32, s3, 1
    s_lshl_b32 s32, s32, 2
    s_add_u32 s32, s32, 106496
    v_mov_b32 v234, s32
    s_waitcnt vmcnt(4)
    v_mul_f32 v0, 0x3a800000, v0
    v_mul_f32 v1, 0x3a800000, v1
    v_mul_f32 v2, 0x3a800000, v2
    v_mul_f32 v3, 0x3a800000, v3
    v_mul_f32 v4, 0x3a800000, v4
    v_mul_f32 v5, 0x3a800000, v5
    v_mul_f32 v6, 0x3a800000, v6
    v_mul_f32 v7, 0x3a800000, v7
    v_fma_f32 v4, -v0, v0, v4
    v_fma_f32 v5, -v1, v1, v5
    v_fma_f32 v6, -v2, v2, v6
    v_fma_f32 v7, -v3, v3, v7
    v_max_f32 v4, 0, v4
    v_max_f32 v5, 0, v5
    v_max_f32 v6, 0, v6
    v_max_f32 v7, 0, v7
    v_cvt_pk_bf16_f32 v12, v0, v4
    v_cvt_pk_bf16_f32 v13, v1, v5
    v_cvt_pk_bf16_f32 v14, v2, v6
    v_cvt_pk_bf16_f32 v15, v3, v7
    v_lshlrev_b32 v0, 16, v12
    v_lshlrev_b32 v1, 16, v13
    v_lshlrev_b32 v2, 16, v14
    v_lshlrev_b32 v3, 16, v15
    v_and_b32 v4, 0xffff0000, v12
    v_and_b32 v5, 0xffff0000, v13
    v_and_b32 v6, 0xffff0000, v14
    v_and_b32 v7, 0xffff0000, v15
    v_add_f32 v4, 0x3727c5ac, v4
    v_add_f32 v5, 0x3727c5ac, v5
    v_add_f32 v6, 0x3727c5ac, v6
    v_add_f32 v7, 0x3727c5ac, v7
    v_cvt_pk_bf16_f32 v4, v4, v4
    v_cvt_pk_bf16_f32 v5, v5, v5
    v_cvt_pk_bf16_f32 v6, v6, v6
    v_cvt_pk_bf16_f32 v7, v7, v7
    v_lshlrev_b32 v4, 16, v4
    v_lshlrev_b32 v5, 16, v5
    v_lshlrev_b32 v6, 16, v6
    v_lshlrev_b32 v7, 16, v7
    v_sqrt_f32 v4, v4
    v_sqrt_f32 v5, v5
    v_sqrt_f32 v6, v6
    v_sqrt_f32 v7, v7
    v_cvt_pk_bf16_f32 v4, v4, v4
    v_cvt_pk_bf16_f32 v5, v5, v5
    v_cvt_pk_bf16_f32 v6, v6, v6
    v_cvt_pk_bf16_f32 v7, v7, v7
    v_lshlrev_b32 v4, 16, v4
    v_lshlrev_b32 v5, 16, v5
    v_lshlrev_b32 v6, 16, v6
    v_lshlrev_b32 v7, 16, v7
    v_rcp_f32 v4, v4
    v_rcp_f32 v5, v5
    v_rcp_f32 v6, v6
    v_rcp_f32 v7, v7
    s_waitcnt vmcnt(0)
    v_mul_f32 v144, 0x3a800000, v144
    v_mul_f32 v145, 0x3a800000, v145
    v_fma_f32 v145, -v144, v144, v145
    v_max_f32 v145, 0, v145
    v_cvt_pk_bf16_f32 v140, v144, v145
    v_lshlrev_b32 v144, 16, v140
    v_and_b32 v145, 0xffff0000, v140
    v_add_f32 v145, 0x3727c5ac, v145
    v_cvt_pk_bf16_f32 v145, v145, v145
    v_lshlrev_b32 v145, 16, v145
    v_sqrt_f32 v145, v145
    s_nop 0
    v_cvt_pk_bf16_f32 v145, v145, v145
    v_lshlrev_b32 v145, 16, v145
    v_rcp_f32 v145, v145
    s_nop 0
    v_lshlrev_b32 v64, 16, v32
    v_lshlrev_b32 v66, 16, v33
    v_lshlrev_b32 v68, 16, v34
    v_lshlrev_b32 v70, 16, v35
    v_and_b32 v65, 0xffff0000, v32
    v_and_b32 v67, 0xffff0000, v33
    v_and_b32 v69, 0xffff0000, v34
    v_and_b32 v71, 0xffff0000, v35
    v_sub_f32 v64, v64, v144
    v_sub_f32 v66, v66, v144
    v_sub_f32 v68, v68, v144
    v_sub_f32 v70, v70, v144
    v_sub_f32 v65, v65, v144
    v_sub_f32 v67, v67, v144
    v_sub_f32 v69, v69, v144
    v_sub_f32 v71, v71, v144
    v_cvt_pk_bf16_f32 v65, v64, v65
    v_cvt_pk_bf16_f32 v67, v66, v67
    v_cvt_pk_bf16_f32 v69, v68, v69
    v_cvt_pk_bf16_f32 v71, v70, v71
    v_lshlrev_b32 v64, 16, v65
    v_lshlrev_b32 v66, 16, v67
    v_lshlrev_b32 v68, 16, v69
    v_lshlrev_b32 v70, 16, v71
    v_and_b32 v65, 0xffff0000, v65
    v_and_b32 v67, 0xffff0000, v67
    v_and_b32 v69, 0xffff0000, v69
    v_and_b32 v71, 0xffff0000, v71
    v_mul_f32 v64, v64, v145
    v_mul_f32 v66, v66, v145
    v_mul_f32 v68, v68, v145
    v_mul_f32 v70, v70, v145
    v_mul_f32 v65, v65, v145
    v_mul_f32 v67, v67, v145
    v_mul_f32 v69, v69, v145
    v_mul_f32 v71, v71, v145
    v_cvt_pk_bf16_f32 v48, v64, v65
    v_cvt_pk_bf16_f32 v49, v66, v67
    v_cvt_pk_bf16_f32 v50, v68, v69
    v_cvt_pk_bf16_f32 v51, v70, v71
    ds_write_b128 v236, v[48:51]
    ds_write_b128 v236, v[32:35] offset:4096
    v_fma_f32 v143, -v144, v128, v146
    v_mul_f32 v143, v143, v145
    ds_write_b32 v234, v143
    s_waitcnt lgkmcnt(0)
kc_com:
    s_barrier
    s_cmp_ge_u32 s53, 28
    s_cbranch_scc1 kc_red
    ds_read_b64 v[96:97], v218 offset:0
    ds_read_b64 v[98:99], v218 offset:16
    ds_read_b64 v[100:101], v218 offset:64
    ds_read_b64 v[102:103], v218 offset:80
    ds_read_b64 v[104:105], v218 offset:128
    ds_read_b64 v[106:107], v218 offset:144
    ds_read_b64 v[108:109], v218 offset:192
    ds_read_b64 v[110:111], v218 offset:208
    ds_read_b64 v[112:113], v218 offset:256
    ds_read_b64 v[114:115], v218 offset:272
    ds_read_b64 v[116:117], v218 offset:320
    ds_read_b64 v[118:119], v218 offset:336
    ds_read_b64 v[120:121], v218 offset:384
    ds_read_b64 v[122:123], v218 offset:400
    s_waitcnt lgkmcnt(12)
    ds_read_b64 v[124:125], v218 offset:448
    ds_read_b64 v[126:127], v218 offset:464
    v_mfma_f32_16x16x32_bf16 v[128:131], a[0:3], v[96:99], 0
    v_mfma_f32_16x16x32_bf16 v[132:135], a[32:35], v[96:99], 0
    s_waitcnt lgkmcnt(12)
    v_mfma_f32_16x16x32_bf16 v[128:131], a[4:7], v[100:103], v[128:131]
    v_mfma_f32_16x16x32_bf16 v[132:135], a[36:39], v[100:103], v[132:135]
    s_waitcnt lgkmcnt(10)
    v_mfma_f32_16x16x32_bf16 v[128:131], a[8:11], v[104:107], v[128:131]
    v_mfma_f32_16x16x32_bf16 v[132:135], a[40:43], v[104:107], v[132:135]
    s_waitcnt lgkmcnt(8)
    v_mfma_f32_16x16x32_bf16 v[128:131], a[12:15], v[108:111], v[128:131]
    v_mfma_f32_16x16x32_bf16 v[132:135], a[44:47], v[108:111], v[132:135]
    s_waitcnt lgkmcnt(6)
    v_mfma_f32_16x16x32_bf16 v[128:131], a[16:19], v[112:115], v[128:131]
    v_mfma_f32_16x16x32_bf16 v[132:135], a[48:51], v[112:115], v[132:135]
    s_waitcnt lgkmcnt(4)
    v_mfma_f32_16x16x32_bf16 v[128:131], a[20:23], v[116:119], v[128:131]
    v_mfma_f32_16x16x32_bf16 v[132:135], a[52:55], v[116:119], v[132:135]
    s_waitcnt lgkmcnt(2)
    v_mfma_f32_16x16x32_bf16 v[128:131], a[24:27], v[120:123], v[128:131]
    v_mfma_f32_16x16x32_bf16 v[132:135], a[56:59], v[120:123], v[132:135]
    s_waitcnt lgkmcnt(0)
    v_mfma_f32_16x16x32_bf16 v[128:131], a[28:31], v[124:127], v[128:131]
    v_mfma_f32_16x16x32_bf16 v[132:135], a[60:63], v[124:127], v[132:135]
    s_nop 6
    ds_write_b128 v220, v[128:131]
    ds_write_b128 v220, v[132:135] offset:4096
    s_waitcnt lgkmcnt(0)
    s_barrier
    ds_read_b128 v[32:35], v221 offset:0
    ds_read_b128 v[48:51], v221 offset:4096
    ds_read_b128 v[36:39], v221 offset:1024
    ds_read_b128 v[52:55], v221 offset:5120
    ds_read_b128 v[40:43], v221 offset:2048
    ds_read_b128 v[56:59], v221 offset:6144
    ds_read_b128 v[44:47], v221 offset:3072
    ds_read_b128 v[60:63], v221 offset:7168
    s_waitcnt lgkmcnt(0)
    v_add_f32 v32, v32, v36
    v_add_f32 v33, v33, v37
    v_add_f32 v34, v34, v38
    v_add_f32 v35, v35, v39
    v_add_f32 v40, v40, v44
    v_add_f32 v41, v41, v45
    v_add_f32 v42, v42, v46
    v_add_f32 v43, v43, v47
    v_add_f32 v48, v48, v52
    v_add_f32 v49, v49, v53
    v_add_f32 v50, v50, v54
    v_add_f32 v51, v51, v55
    v_add_f32 v56, v56, v60
    v_add_f32 v57, v57, v61
    v_add_f32 v58, v58, v62
    v_add_f32 v59, v59, v63
    v_add_f32 v32, v32, v40
    v_add_f32 v33, v33, v41
    v_add_f32 v34, v34, v42
    v_add_f32 v35, v35, v43
    v_add_f32 v48, v48, v56
    v_add_f32 v49, v49, v57
    v_add_f32 v50, v50, v58
    v_add_f32 v51, v51, v59
    v_cvt_pk_bf16_f32 v48, v32, v48
    v_cvt_pk_bf16_f32 v49, v33, v49
    v_cvt_pk_bf16_f32 v50, v34, v50
    v_cvt_pk_bf16_f32 v51, v35, v51
    v_lshlrev_b32 v32, 16, v48
    v_lshlrev_b32 v33, 16, v49
    v_lshlrev_b32 v34, 16, v50
    v_lshlrev_b32 v35, 16, v51
    v_and_b32 v48, 0xffff0000, v48
    v_and_b32 v49, 0xffff0000, v49
    v_and_b32 v50, 0xffff0000, v50
    v_and_b32 v51, 0xffff0000, v51
    v_mul_f32 v136, 0xbfb8aa3b, v32
    v_mul_f32 v137, 0xbfb8aa3b, v33
    v_mul_f32 v138, 0xbfb8aa3b, v34
    v_mul_f32 v139, 0xbfb8aa3b, v35
    v_exp_f32 v136, v136
    v_exp_f32 v137, v137
    v_exp_f32 v138, v138
    v_exp_f32 v139, v139
    v_add_f32 v136, 1.0, v136
    v_add_f32 v137, 1.0, v137
    v_add_f32 v138, 1.0, v138
    v_add_f32 v139, 1.0, v139
    v_rcp_f32 v136, v136
    v_rcp_f32 v137, v137
    v_rcp_f32 v138, v138
    v_rcp_f32 v139, v139
    v_mul_f32 v32, v32, v136
    v_mul_f32 v33, v33, v137
    v_mul_f32 v34, v34, v138
    v_mul_f32 v35, v35, v139
    v_cvt_pk_bf16_f32 v32, v32, v32
    v_cvt_pk_bf16_f32 v33, v33, v33
    v_cvt_pk_bf16_f32 v34, v34, v34
    v_cvt_pk_bf16_f32 v35, v35, v35
    v_lshlrev_b32 v32, 16, v32
    v_lshlrev_b32 v33, 16, v33
    v_lshlrev_b32 v34, 16, v34
    v_lshlrev_b32 v35, 16, v35
    v_mul_f32 v32, v32, v48
    v_mul_f32 v33, v33, v49
    v_mul_f32 v34, v34, v50
    v_mul_f32 v35, v35, v51
    v_cvt_pk_bf16_f32 v128, v32, v33
    v_cvt_pk_bf16_f32 v129, v34, v35
    s_nop 1
    v_mfma_f32_16x16x16_bf16 v[64:67], a[64:65], v[128:129], 0
    v_mfma_f32_16x16x16_bf16 v[68:71], a[66:67], v[128:129], 0
    v_mfma_f32_16x16x16_bf16 v[72:75], a[68:69], v[128:129], 0
    v_mfma_f32_16x16x16_bf16 v[76:79], a[70:71], v[128:129], 0
    v_mfma_f32_16x16x16_bf16 v[80:83], a[72:73], v[128:129], 0
    v_mfma_f32_16x16x16_bf16 v[84:87], a[74:75], v[128:129], 0
    v_mfma_f32_16x16x16_bf16 v[88:91], a[76:77], v[128:129], 0
    v_mfma_f32_16x16x16_bf16 v[92:95], a[78:79], v[128:129], 0
    v_mfma_f32_16x16x16_bf16 v[96:99], a[80:81], v[128:129], 0
    ds_write_b128 v222, v[64:67] offset:0
    v_mfma_f32_16x16x16_bf16 v[100:103], a[82:83], v[128:129], 0
    ds_write_b128 v222, v[68:71] offset:64
    v_mfma_f32_16x16x16_bf16 v[104:107], a[84:85], v[128:129], 0
    ds_write_b128 v222, v[72:75] offset:128
    v_mfma_f32_16x16x16_bf16 v[108:111], a[86:87], v[128:129], 0
    ds_write_b128 v222, v[76:79] offset:192
    v_mfma_f32_16x16x16_bf16 v[112:115], a[88:89], v[128:129], 0
    ds_write_b128 v222, v[80:83] offset:256
    v_mfma_f32_16x16x16_bf16 v[116:119], a[90:91], v[128:129], 0
    ds_write_b128 v222, v[84:87] offset:320
    v_mfma_f32_16x16x16_bf16 v[120:123], a[92:93], v[128:129], 0
    ds_write_b128 v222, v[88:91] offset:384
    v_mfma_f32_16x16x16_bf16 v[124:127], a[94:95], v[128:129], 0
    ds_write_b128 v222, v[92:95] offset:448
    s_waitcnt lgkmcnt(4)
    ds_write_b128 v222, v[96:99] offset:512
    ds_write_b128 v222, v[100:103] offset:576
    ds_write_b128 v222, v[104:107] offset:640
    ds_write_b128 v222, v[108:111] offset:704
    ds_write_b128 v222, v[112:115] offset:768
    ds_write_b128 v222, v[116:119] offset:832
    ds_write_b128 v222, v[120:123] offset:896
    ds_write_b128 v222, v[124:127] offset:960
    s_lshl_b32 s32, s54, 13
    s_lshl_b32 s33, s3, 10
    s_add_u32 s32, s32, s33
    s_add_u32 s32, s32, 0x3900000
    s_add_u32 s33, s32, 4096
    s_waitcnt lgkmcnt(0)
    ds_read_b128 v[32:35], v223
    ds_read_b128 v[36:39], v223 offset:1024
    s_waitcnt lgkmcnt(1)
    buffer_store_dwordx4 v[32:35], v228, s[8:11], s32 offen sc1
    s_waitcnt lgkmcnt(0)
    buffer_store_dwordx4 v[36:39], v228, s[8:11], s33 offen sc1
    v_lshlrev_b32 v144, 16, v16
    v_lshlrev_b32 v148, 16, v17
    v_lshlrev_b32 v152, 16, v18
    v_lshlrev_b32 v156, 16, v19
    v_and_b32 v145, 0xffff0000, v16
    v_and_b32 v149, 0xffff0000, v17
    v_and_b32 v153, 0xffff0000, v18
    v_and_b32 v157, 0xffff0000, v19
    v_sub_f32 v144, v144, v0
    v_sub_f32 v148, v148, v0
    v_sub_f32 v152, v152, v0
    v_sub_f32 v156, v156, v0
    v_sub_f32 v145, v145, v0
    v_sub_f32 v149, v149, v0
    v_sub_f32 v153, v153, v0
    v_sub_f32 v157, v157, v0
    v_cvt_pk_bf16_f32 v145, v144, v145
    v_cvt_pk_bf16_f32 v149, v148, v149
    v_cvt_pk_bf16_f32 v153, v152, v153
    v_cvt_pk_bf16_f32 v157, v156, v157
    v_lshlrev_b32 v144, 16, v145
    v_lshlrev_b32 v148, 16, v149
    v_lshlrev_b32 v152, 16, v153
    v_lshlrev_b32 v156, 16, v157
    v_and_b32 v145, 0xffff0000, v145
    v_and_b32 v149, 0xffff0000, v149
    v_and_b32 v153, 0xffff0000, v153
    v_and_b32 v157, 0xffff0000, v157
    v_mul_f32 v144, v144, v4
    v_mul_f32 v148, v148, v4
    v_mul_f32 v152, v152, v4
    v_mul_f32 v156, v156, v4
    v_mul_f32 v145, v145, v4
    v_mul_f32 v149, v149, v4
    v_mul_f32 v153, v153, v4
    v_mul_f32 v157, v157, v4
    v_cvt_pk_bf16_f32 v146, v144, v145
    v_cvt_pk_bf16_f32 v150, v148, v149
    v_cvt_pk_bf16_f32 v154, v152, v153
    v_cvt_pk_bf16_f32 v158, v156, v157
    v_lshlrev_b32 v144, 16, v146
    v_lshlrev_b32 v148, 16, v150
    v_lshlrev_b32 v152, 16, v154
    v_lshlrev_b32 v156, 16, v158
    v_and_b32 v145, 0xffff0000, v146
    v_and_b32 v149, 0xffff0000, v150
    v_and_b32 v153, 0xffff0000, v154
    v_and_b32 v157, 0xffff0000, v158
    v_lshlrev_b32 v146, 16, v16
    v_lshlrev_b32 v150, 16, v17
    v_lshlrev_b32 v154, 16, v18
    v_lshlrev_b32 v158, 16, v19
    v_and_b32 v147, 0xffff0000, v16
    v_and_b32 v151, 0xffff0000, v17
    v_and_b32 v155, 0xffff0000, v18
    v_and_b32 v159, 0xffff0000, v19
    v_pk_add_f32 v[144:145], v[144:145], v[146:147]
    v_pk_add_f32 v[148:149], v[148:149], v[150:151]
    v_pk_add_f32 v[152:153], v[152:153], v[154:155]
    v_pk_add_f32 v[156:157], v[156:157], v[158:159]
    v_cvt_pk_bf16_f32 v16, v144, v145
    v_cvt_pk_bf16_f32 v17, v148, v149
    v_cvt_pk_bf16_f32 v18, v152, v153
    v_cvt_pk_bf16_f32 v19, v156, v157
    v_add_u32 v160, 0, v242
    v_cmp_eq_u32 vcc, v160, v8
    v_cmp_eq_u32 s[60:61], v160, v10
    v_mov_b32 v161, 0x40000000
    s_or_b64 vcc, vcc, s[60:61]
    v_cndmask_b32 v12, v229, v161, vcc
    v_lshlrev_b32 v144, 16, v20
    v_lshlrev_b32 v148, 16, v21
    v_lshlrev_b32 v152, 16, v22
    v_lshlrev_b32 v156, 16, v23
    v_and_b32 v145, 0xffff0000, v20
    v_and_b32 v149, 0xffff0000, v21
    v_and_b32 v153, 0xffff0000, v22
    v_and_b32 v157, 0xffff0000, v23
    v_sub_f32 v144, v144, v1
    v_sub_f32 v148, v148, v1
    v_sub_f32 v152, v152, v1
    v_sub_f32 v156, v156, v1
    v_sub_f32 v145, v145, v1
    v_sub_f32 v149, v149, v1
    v_sub_f32 v153, v153, v1
    v_sub_f32 v157, v157, v1
    v_cvt_pk_bf16_f32 v145, v144, v145
    v_cvt_pk_bf16_f32 v149, v148, v149
    v_cvt_pk_bf16_f32 v153, v152, v153
    v_cvt_pk_bf16_f32 v157, v156, v157
    v_lshlrev_b32 v144, 16, v145
    v_lshlrev_b32 v148, 16, v149
    v_lshlrev_b32 v152, 16, v153
    v_lshlrev_b32 v156, 16, v157
    v_and_b32 v145, 0xffff0000, v145
    v_and_b32 v149, 0xffff0000, v149
    v_and_b32 v153, 0xffff0000, v153
    v_and_b32 v157, 0xffff0000, v157
    v_mul_f32 v144, v144, v5
    v_mul_f32 v148, v148, v5
    v_mul_f32 v152, v152, v5
    v_mul_f32 v156, v156, v5
    v_mul_f32 v145, v145, v5
    v_mul_f32 v149, v149, v5
    v_mul_f32 v153, v153, v5
    v_mul_f32 v157, v157, v5
    v_cvt_pk_bf16_f32 v146, v144, v145
    v_cvt_pk_bf16_f32 v150, v148, v149
    v_cvt_pk_bf16_f32 v154, v152, v153
    v_cvt_pk_bf16_f32 v158, v156, v157
    v_lshlrev_b32 v144, 16, v146
    v_lshlrev_b32 v148, 16, v150
    v_lshlrev_b32 v152, 16, v154
    v_lshlrev_b32 v156, 16, v158
    v_and_b32 v145, 0xffff0000, v146
    v_and_b32 v149, 0xffff0000, v150
    v_and_b32 v153, 0xffff0000, v154
    v_and_b32 v157, 0xffff0000, v158
    v_lshlrev_b32 v146, 16, v20
    v_lshlrev_b32 v150, 16, v21
    v_lshlrev_b32 v154, 16, v22
    v_lshlrev_b32 v158, 16, v23
    v_and_b32 v147, 0xffff0000, v20
    v_and_b32 v151, 0xffff0000, v21
    v_and_b32 v155, 0xffff0000, v22
    v_and_b32 v159, 0xffff0000, v23
    v_pk_add_f32 v[144:145], v[144:145], v[146:147]
    v_pk_add_f32 v[148:149], v[148:149], v[150:151]
    v_pk_add_f32 v[152:153], v[152:153], v[154:155]
    v_pk_add_f32 v[156:157], v[156:157], v[158:159]
    v_cvt_pk_bf16_f32 v20, v144, v145
    v_cvt_pk_bf16_f32 v21, v148, v149
    v_cvt_pk_bf16_f32 v22, v152, v153
    v_cvt_pk_bf16_f32 v23, v156, v157
    v_add_u32 v160, 8, v242
    v_cmp_eq_u32 vcc, v160, v8
    v_cmp_eq_u32 s[60:61], v160, v10
    v_mov_b32 v161, 0x40000000
    s_or_b64 vcc, vcc, s[60:61]
    v_cndmask_b32 v13, v229, v161, vcc
    s_waitcnt vmcnt(0)
    s_barrier
    s_cmp_lg_u32 s3, 0
    s_cbranch_scc1 kc_a2
    s_lshl_b32 s32, s52, 7
    s_add_u32 s32, s32, 0x38a0800
    v_mov_b32 v235, 1
    buffer_atomic_add v235, v243, s[8:11], s32 offen sc0 sc1
    v_lshlrev_b32 v234, 7, v237
    v_cmp_gt_u32 vcc, 8, v237
    v_mov_b32 v236, 0x40000000
    s_mov_b32 s34, 0x38a0c00
    v_cndmask_b32 v234, v236, v234, vcc
    s_waitcnt vmcnt(0)
    v_readfirstlane_b32 s36, v235
    s_cmp_lg_u32 s36, 27
    s_cbranch_scc1 kc_a2
    buffer_atomic_add v233, v234, s[8:11], s34 offen sc1
kc_a2:
    v_lshlrev_b32 v144, 16, v24
    v_lshlrev_b32 v148, 16, v25
    v_lshlrev_b32 v152, 16, v26
    v_lshlrev_b32 v156, 16, v27
    v_and_b32 v145, 0xffff0000, v24
    v_and_b32 v149, 0xffff0000, v25
    v_and_b32 v153, 0xffff0000, v26
    v_and_b32 v157, 0xffff0000, v27
    v_sub_f32 v144, v144, v2
    v_sub_f32 v148, v148, v2
    v_sub_f32 v152, v152, v2
    v_sub_f32 v156, v156, v2
    v_sub_f32 v145, v145, v2
    v_sub_f32 v149, v149, v2
    v_sub_f32 v153, v153, v2
    v_sub_f32 v157, v157, v2
    v_cvt_pk_bf16_f32 v145, v144, v145
    v_cvt_pk_bf16_f32 v149, v148, v149
    v_cvt_pk_bf16_f32 v153, v152, v153
    v_cvt_pk_bf16_f32 v157, v156, v157
    v_lshlrev_b32 v144, 16, v145
    v_lshlrev_b32 v148, 16, v149
    v_lshlrev_b32 v152, 16, v153
    v_lshlrev_b32 v156, 16, v157
    v_and_b32 v145, 0xffff0000, v145
    v_and_b32 v149, 0xffff0000, v149
    v_and_b32 v153, 0xffff0000, v153
    v_and_b32 v157, 0xffff0000, v157
    v_mul_f32 v144, v144, v6
    v_mul_f32 v148, v148, v6
    v_mul_f32 v152, v152, v6
    v_mul_f32 v156, v156, v6
    v_mul_f32 v145, v145, v6
    v_mul_f32 v149, v149, v6
    v_mul_f32 v153, v153, v6
    v_mul_f32 v157, v157, v6
    v_cvt_pk_bf16_f32 v146, v144, v145
    v_cvt_pk_bf16_f32 v150, v148, v149
    v_cvt_pk_bf16_f32 v154, v152, v153
    v_cvt_pk_bf16_f32 v158, v156, v157
    v_lshlrev_b32 v144, 16, v146
    v_lshlrev_b32 v148, 16, v150
    v_lshlrev_b32 v152, 16, v154
    v_lshlrev_b32 v156, 16, v158
    v_and_b32 v145, 0xffff0000, v146
    v_and_b32 v149, 0xffff0000, v150
    v_and_b32 v153, 0xffff0000, v154
    v_and_b32 v157, 0xffff0000, v158
    v_lshlrev_b32 v146, 16, v24
    v_lshlrev_b32 v150, 16, v25
    v_lshlrev_b32 v154, 16, v26
    v_lshlrev_b32 v158, 16, v27
    v_and_b32 v147, 0xffff0000, v24
    v_and_b32 v151, 0xffff0000, v25
    v_and_b32 v155, 0xffff0000, v26
    v_and_b32 v159, 0xffff0000, v27
    v_pk_add_f32 v[144:145], v[144:145], v[146:147]
    v_pk_add_f32 v[148:149], v[148:149], v[150:151]
    v_pk_add_f32 v[152:153], v[152:153], v[154:155]
    v_pk_add_f32 v[156:157], v[156:157], v[158:159]
    v_cvt_pk_bf16_f32 v24, v144, v145
    v_cvt_pk_bf16_f32 v25, v148, v149
    v_cvt_pk_bf16_f32 v26, v152, v153
    v_cvt_pk_bf16_f32 v27, v156, v157
    v_add_u32 v160, 16, v242
    v_cmp_eq_u32 vcc, v160, v8
    v_cmp_eq_u32 s[60:61], v160, v10
    v_mov_b32 v161, 0x40000000
    s_or_b64 vcc, vcc, s[60:61]
    v_cndmask_b32 v14, v229, v161, vcc
    v_lshlrev_b32 v144, 16, v28
    v_lshlrev_b32 v148, 16, v29
    v_lshlrev_b32 v152, 16, v30
    v_lshlrev_b32 v156, 16, v31
    v_and_b32 v145, 0xffff0000, v28
    v_and_b32 v149, 0xffff0000, v29
    v_and_b32 v153, 0xffff0000, v30
    v_and_b32 v157, 0xffff0000, v31
    v_sub_f32 v144, v144, v3
    v_sub_f32 v148, v148, v3
    v_sub_f32 v152, v152, v3
    v_sub_f32 v156, v156, v3
    v_sub_f32 v145, v145, v3
    v_sub_f32 v149, v149, v3
    v_sub_f32 v153, v153, v3
    v_sub_f32 v157, v157, v3
    v_cvt_pk_bf16_f32 v145, v144, v145
    v_cvt_pk_bf16_f32 v149, v148, v149
    v_cvt_pk_bf16_f32 v153, v152, v153
    v_cvt_pk_bf16_f32 v157, v156, v157
    v_lshlrev_b32 v144, 16, v145
    v_lshlrev_b32 v148, 16, v149
    v_lshlrev_b32 v152, 16, v153
    v_lshlrev_b32 v156, 16, v157
    v_and_b32 v145, 0xffff0000, v145
    v_and_b32 v149, 0xffff0000, v149
    v_and_b32 v153, 0xffff0000, v153
    v_and_b32 v157, 0xffff0000, v157
    v_mul_f32 v144, v144, v7
    v_mul_f32 v148, v148, v7
    v_mul_f32 v152, v152, v7
    v_mul_f32 v156, v156, v7
    v_mul_f32 v145, v145, v7
    v_mul_f32 v149, v149, v7
    v_mul_f32 v153, v153, v7
    v_mul_f32 v157, v157, v7
    v_cvt_pk_bf16_f32 v146, v144, v145
    v_cvt_pk_bf16_f32 v150, v148, v149
    v_cvt_pk_bf16_f32 v154, v152, v153
    v_cvt_pk_bf16_f32 v158, v156, v157
    v_lshlrev_b32 v144, 16, v146
    v_lshlrev_b32 v148, 16, v150
    v_lshlrev_b32 v152, 16, v154
    v_lshlrev_b32 v156, 16, v158
    v_and_b32 v145, 0xffff0000, v146
    v_and_b32 v149, 0xffff0000, v150
    v_and_b32 v153, 0xffff0000, v154
    v_and_b32 v157, 0xffff0000, v158
    v_lshlrev_b32 v146, 16, v28
    v_lshlrev_b32 v150, 16, v29
    v_lshlrev_b32 v154, 16, v30
    v_lshlrev_b32 v158, 16, v31
    v_and_b32 v147, 0xffff0000, v28
    v_and_b32 v151, 0xffff0000, v29
    v_and_b32 v155, 0xffff0000, v30
    v_and_b32 v159, 0xffff0000, v31
    v_pk_add_f32 v[144:145], v[144:145], v[146:147]
    v_pk_add_f32 v[148:149], v[148:149], v[150:151]
    v_pk_add_f32 v[152:153], v[152:153], v[154:155]
    v_pk_add_f32 v[156:157], v[156:157], v[158:159]
    v_cvt_pk_bf16_f32 v28, v144, v145
    v_cvt_pk_bf16_f32 v29, v148, v149
    v_cvt_pk_bf16_f32 v30, v152, v153
    v_cvt_pk_bf16_f32 v31, v156, v157
    v_add_u32 v160, 24, v242
    v_cmp_eq_u32 vcc, v160, v8
    v_cmp_eq_u32 s[60:61], v160, v10
    v_mov_b32 v161, 0x40000000
    s_or_b64 vcc, vcc, s[60:61]
    v_cndmask_b32 v15, v229, v161, vcc
    s_mov_b32 s32, 0
    buffer_store_dwordx4 v[16:19], v12, s[28:31], s32 offen
    s_mov_b32 s32, 16384
    buffer_store_dwordx4 v[20:23], v13, s[28:31], s32 offen
    s_mov_b32 s32, 32768
    buffer_store_dwordx4 v[24:27], v14, s[28:31], s32 offen
    s_mov_b32 s32, 49152
    buffer_store_dwordx4 v[28:31], v15, s[28:31], s32 offen
    s_branch kc_fin
kc_red:
    v_lshlrev_b32 v144, 16, v16
    v_lshlrev_b32 v148, 16, v17
    v_lshlrev_b32 v152, 16, v18
    v_lshlrev_b32 v156, 16, v19
    v_and_b32 v145, 0xffff0000, v16
    v_and_b32 v149, 0xffff0000, v17
    v_and_b32 v153, 0xffff0000, v18
    v_and_b32 v157, 0xffff0000, v19
    v_sub_f32 v144, v144, v0
    v_sub_f32 v148, v148, v0
    v_sub_f32 v152, v152, v0
    v_sub_f32 v156, v156, v0
    v_sub_f32 v145, v145, v0
    v_sub_f32 v149, v149, v0
    v_sub_f32 v153, v153, v0
    v_sub_f32 v157, v157, v0
    v_cvt_pk_bf16_f32 v145, v144, v145
    v_cvt_pk_bf16_f32 v149, v148, v149
    v_cvt_pk_bf16_f32 v153, v152, v153
    v_cvt_pk_bf16_f32 v157, v156, v157
    v_lshlrev_b32 v144, 16, v145
    v_lshlrev_b32 v148, 16, v149
    v_lshlrev_b32 v152, 16, v153
    v_lshlrev_b32 v156, 16, v157
    v_and_b32 v145, 0xffff0000, v145
    v_and_b32 v149, 0xffff0000, v149
    v_and_b32 v153, 0xffff0000, v153
    v_and_b32 v157, 0xffff0000, v157
    v_mul_f32 v144, v144, v4
    v_mul_f32 v148, v148, v4
    v_mul_f32 v152, v152, v4
    v_mul_f32 v156, v156, v4
    v_mul_f32 v145, v145, v4
    v_mul_f32 v149, v149, v4
    v_mul_f32 v153, v153, v4
    v_mul_f32 v157, v157, v4
    v_cvt_pk_bf16_f32 v146, v144, v145
    v_cvt_pk_bf16_f32 v150, v148, v149
    v_cvt_pk_bf16_f32 v154, v152, v153
    v_cvt_pk_bf16_f32 v158, v156, v157
    v_lshlrev_b32 v144, 16, v146
    v_lshlrev_b32 v148, 16, v150
    v_lshlrev_b32 v152, 16, v154
    v_lshlrev_b32 v156, 16, v158
    v_and_b32 v145, 0xffff0000, v146
    v_and_b32 v149, 0xffff0000, v150
    v_and_b32 v153, 0xffff0000, v154
    v_and_b32 v157, 0xffff0000, v158
    v_lshlrev_b32 v146, 16, v16
    v_lshlrev_b32 v150, 16, v17
    v_lshlrev_b32 v154, 16, v18
    v_lshlrev_b32 v158, 16, v19
    v_and_b32 v147, 0xffff0000, v16
    v_and_b32 v151, 0xffff0000, v17
    v_and_b32 v155, 0xffff0000, v18
    v_and_b32 v159, 0xffff0000, v19
    v_pk_add_f32 v[144:145], v[144:145], v[146:147]
    v_pk_add_f32 v[148:149], v[148:149], v[150:151]
    v_pk_add_f32 v[152:153], v[152:153], v[154:155]
    v_pk_add_f32 v[156:157], v[156:157], v[158:159]
    v_cvt_pk_bf16_f32 v16, v144, v145
    v_cvt_pk_bf16_f32 v17, v148, v149
    v_cvt_pk_bf16_f32 v18, v152, v153
    v_cvt_pk_bf16_f32 v19, v156, v157
    v_add_u32 v160, 0, v242
    v_cmp_eq_u32 vcc, v160, v8
    v_cmp_eq_u32 s[60:61], v160, v10
    v_mov_b32 v161, 0x40000000
    s_or_b64 vcc, vcc, s[60:61]
    v_cndmask_b32 v12, v229, v161, vcc
    v_lshlrev_b32 v144, 16, v20
    v_lshlrev_b32 v148, 16, v21
    v_lshlrev_b32 v152, 16, v22
    v_lshlrev_b32 v156, 16, v23
    v_and_b32 v145, 0xffff0000, v20
    v_and_b32 v149, 0xffff0000, v21
    v_and_b32 v153, 0xffff0000, v22
    v_and_b32 v157, 0xffff0000, v23
    v_sub_f32 v144, v144, v1
    v_sub_f32 v148, v148, v1
    v_sub_f32 v152, v152, v1
    v_sub_f32 v156, v156, v1
    v_sub_f32 v145, v145, v1
    v_sub_f32 v149, v149, v1
    v_sub_f32 v153, v153, v1
    v_sub_f32 v157, v157, v1
    v_cvt_pk_bf16_f32 v145, v144, v145
    v_cvt_pk_bf16_f32 v149, v148, v149
    v_cvt_pk_bf16_f32 v153, v152, v153
    v_cvt_pk_bf16_f32 v157, v156, v157
    v_lshlrev_b32 v144, 16, v145
    v_lshlrev_b32 v148, 16, v149
    v_lshlrev_b32 v152, 16, v153
    v_lshlrev_b32 v156, 16, v157
    v_and_b32 v145, 0xffff0000, v145
    v_and_b32 v149, 0xffff0000, v149
    v_and_b32 v153, 0xffff0000, v153
    v_and_b32 v157, 0xffff0000, v157
    v_mul_f32 v144, v144, v5
    v_mul_f32 v148, v148, v5
    v_mul_f32 v152, v152, v5
    v_mul_f32 v156, v156, v5
    v_mul_f32 v145, v145, v5
    v_mul_f32 v149, v149, v5
    v_mul_f32 v153, v153, v5
    v_mul_f32 v157, v157, v5
    v_cvt_pk_bf16_f32 v146, v144, v145
    v_cvt_pk_bf16_f32 v150, v148, v149
    v_cvt_pk_bf16_f32 v154, v152, v153
    v_cvt_pk_bf16_f32 v158, v156, v157
    v_lshlrev_b32 v144, 16, v146
    v_lshlrev_b32 v148, 16, v150
    v_lshlrev_b32 v152, 16, v154
    v_lshlrev_b32 v156, 16, v158
    v_and_b32 v145, 0xffff0000, v146
    v_and_b32 v149, 0xffff0000, v150
    v_and_b32 v153, 0xffff0000, v154
    v_and_b32 v157, 0xffff0000, v158
    v_lshlrev_b32 v146, 16, v20
    v_lshlrev_b32 v150, 16, v21
    v_lshlrev_b32 v154, 16, v22
    v_lshlrev_b32 v158, 16, v23
    v_and_b32 v147, 0xffff0000, v20
    v_and_b32 v151, 0xffff0000, v21
    v_and_b32 v155, 0xffff0000, v22
    v_and_b32 v159, 0xffff0000, v23
    v_pk_add_f32 v[144:145], v[144:145], v[146:147]
    v_pk_add_f32 v[148:149], v[148:149], v[150:151]
    v_pk_add_f32 v[152:153], v[152:153], v[154:155]
    v_pk_add_f32 v[156:157], v[156:157], v[158:159]
    v_cvt_pk_bf16_f32 v20, v144, v145
    v_cvt_pk_bf16_f32 v21, v148, v149
    v_cvt_pk_bf16_f32 v22, v152, v153
    v_cvt_pk_bf16_f32 v23, v156, v157
    v_add_u32 v160, 8, v242
    v_cmp_eq_u32 vcc, v160, v8
    v_cmp_eq_u32 s[60:61], v160, v10
    v_mov_b32 v161, 0x40000000
    s_or_b64 vcc, vcc, s[60:61]
    v_cndmask_b32 v13, v229, v161, vcc
    v_lshlrev_b32 v144, 16, v24
    v_lshlrev_b32 v148, 16, v25
    v_lshlrev_b32 v152, 16, v26
    v_lshlrev_b32 v156, 16, v27
    v_and_b32 v145, 0xffff0000, v24
    v_and_b32 v149, 0xffff0000, v25
    v_and_b32 v153, 0xffff0000, v26
    v_and_b32 v157, 0xffff0000, v27
    v_sub_f32 v144, v144, v2
    v_sub_f32 v148, v148, v2
    v_sub_f32 v152, v152, v2
    v_sub_f32 v156, v156, v2
    v_sub_f32 v145, v145, v2
    v_sub_f32 v149, v149, v2
    v_sub_f32 v153, v153, v2
    v_sub_f32 v157, v157, v2
    v_cvt_pk_bf16_f32 v145, v144, v145
    v_cvt_pk_bf16_f32 v149, v148, v149
    v_cvt_pk_bf16_f32 v153, v152, v153
    v_cvt_pk_bf16_f32 v157, v156, v157
    v_lshlrev_b32 v144, 16, v145
    v_lshlrev_b32 v148, 16, v149
    v_lshlrev_b32 v152, 16, v153
    v_lshlrev_b32 v156, 16, v157
    v_and_b32 v145, 0xffff0000, v145
    v_and_b32 v149, 0xffff0000, v149
    v_and_b32 v153, 0xffff0000, v153
    v_and_b32 v157, 0xffff0000, v157
    v_mul_f32 v144, v144, v6
    v_mul_f32 v148, v148, v6
    v_mul_f32 v152, v152, v6
    v_mul_f32 v156, v156, v6
    v_mul_f32 v145, v145, v6
    v_mul_f32 v149, v149, v6
    v_mul_f32 v153, v153, v6
    v_mul_f32 v157, v157, v6
    v_cvt_pk_bf16_f32 v146, v144, v145
    v_cvt_pk_bf16_f32 v150, v148, v149
    v_cvt_pk_bf16_f32 v154, v152, v153
    v_cvt_pk_bf16_f32 v158, v156, v157
    v_lshlrev_b32 v144, 16, v146
    v_lshlrev_b32 v148, 16, v150
    v_lshlrev_b32 v152, 16, v154
    v_lshlrev_b32 v156, 16, v158
    v_and_b32 v145, 0xffff0000, v146
    v_and_b32 v149, 0xffff0000, v150
    v_and_b32 v153, 0xffff0000, v154
    v_and_b32 v157, 0xffff0000, v158
    v_lshlrev_b32 v146, 16, v24
    v_lshlrev_b32 v150, 16, v25
    v_lshlrev_b32 v154, 16, v26
    v_lshlrev_b32 v158, 16, v27
    v_and_b32 v147, 0xffff0000, v24
    v_and_b32 v151, 0xffff0000, v25
    v_and_b32 v155, 0xffff0000, v26
    v_and_b32 v159, 0xffff0000, v27
    v_pk_add_f32 v[144:145], v[144:145], v[146:147]
    v_pk_add_f32 v[148:149], v[148:149], v[150:151]
    v_pk_add_f32 v[152:153], v[152:153], v[154:155]
    v_pk_add_f32 v[156:157], v[156:157], v[158:159]
    v_cvt_pk_bf16_f32 v24, v144, v145
    v_cvt_pk_bf16_f32 v25, v148, v149
    v_cvt_pk_bf16_f32 v26, v152, v153
    v_cvt_pk_bf16_f32 v27, v156, v157
    v_add_u32 v160, 16, v242
    v_cmp_eq_u32 vcc, v160, v8
    v_cmp_eq_u32 s[60:61], v160, v10
    v_mov_b32 v161, 0x40000000
    s_or_b64 vcc, vcc, s[60:61]
    v_cndmask_b32 v14, v229, v161, vcc
    v_lshlrev_b32 v144, 16, v28
    v_lshlrev_b32 v148, 16, v29
    v_lshlrev_b32 v152, 16, v30
    v_lshlrev_b32 v156, 16, v31
    v_and_b32 v145, 0xffff0000, v28
    v_and_b32 v149, 0xffff0000, v29
    v_and_b32 v153, 0xffff0000, v30
    v_and_b32 v157, 0xffff0000, v31
    v_sub_f32 v144, v144, v3
    v_sub_f32 v148, v148, v3
    v_sub_f32 v152, v152, v3
    v_sub_f32 v156, v156, v3
    v_sub_f32 v145, v145, v3
    v_sub_f32 v149, v149, v3
    v_sub_f32 v153, v153, v3
    v_sub_f32 v157, v157, v3
    v_cvt_pk_bf16_f32 v145, v144, v145
    v_cvt_pk_bf16_f32 v149, v148, v149
    v_cvt_pk_bf16_f32 v153, v152, v153
    v_cvt_pk_bf16_f32 v157, v156, v157
    v_lshlrev_b32 v144, 16, v145
    v_lshlrev_b32 v148, 16, v149
    v_lshlrev_b32 v152, 16, v153
    v_lshlrev_b32 v156, 16, v157
    v_and_b32 v145, 0xffff0000, v145
    v_and_b32 v149, 0xffff0000, v149
    v_and_b32 v153, 0xffff0000, v153
    v_and_b32 v157, 0xffff0000, v157
    v_mul_f32 v144, v144, v7
    v_mul_f32 v148, v148, v7
    v_mul_f32 v152, v152, v7
    v_mul_f32 v156, v156, v7
    v_mul_f32 v145, v145, v7
    v_mul_f32 v149, v149, v7
    v_mul_f32 v153, v153, v7
    v_mul_f32 v157, v157, v7
    v_cvt_pk_bf16_f32 v146, v144, v145
    v_cvt_pk_bf16_f32 v150, v148, v149
    v_cvt_pk_bf16_f32 v154, v152, v153
    v_cvt_pk_bf16_f32 v158, v156, v157
    v_lshlrev_b32 v144, 16, v146
    v_lshlrev_b32 v148, 16, v150
    v_lshlrev_b32 v152, 16, v154
    v_lshlrev_b32 v156, 16, v158
    v_and_b32 v145, 0xffff0000, v146
    v_and_b32 v149, 0xffff0000, v150
    v_and_b32 v153, 0xffff0000, v154
    v_and_b32 v157, 0xffff0000, v158
    v_lshlrev_b32 v146, 16, v28
    v_lshlrev_b32 v150, 16, v29
    v_lshlrev_b32 v154, 16, v30
    v_lshlrev_b32 v158, 16, v31
    v_and_b32 v147, 0xffff0000, v28
    v_and_b32 v151, 0xffff0000, v29
    v_and_b32 v155, 0xffff0000, v30
    v_and_b32 v159, 0xffff0000, v31
    v_pk_add_f32 v[144:145], v[144:145], v[146:147]
    v_pk_add_f32 v[148:149], v[148:149], v[150:151]
    v_pk_add_f32 v[152:153], v[152:153], v[154:155]
    v_pk_add_f32 v[156:157], v[156:157], v[158:159]
    v_cvt_pk_bf16_f32 v28, v144, v145
    v_cvt_pk_bf16_f32 v29, v148, v149
    v_cvt_pk_bf16_f32 v30, v152, v153
    v_cvt_pk_bf16_f32 v31, v156, v157
    v_add_u32 v160, 24, v242
    v_cmp_eq_u32 vcc, v160, v8
    v_cmp_eq_u32 s[60:61], v160, v10
    v_mov_b32 v161, 0x40000000
    s_or_b64 vcc, vcc, s[60:61]
    v_cndmask_b32 v15, v229, v161, vcc
    s_mov_b32 s32, 0
    buffer_store_dwordx4 v[16:19], v12, s[28:31], s32 offen
    s_mov_b32 s32, 16384
    buffer_store_dwordx4 v[20:23], v13, s[28:31], s32 offen
    s_mov_b32 s32, 32768
    buffer_store_dwordx4 v[24:27], v14, s[28:31], s32 offen
    s_mov_b32 s32, 49152
    buffer_store_dwordx4 v[28:31], v15, s[28:31], s32 offen
    s_sub_u32 s54, s2, 224
    v_lshrrev_b32 v234, 4, v230
    v_lshlrev_b32 v234, 13, v234
    v_and_b32 v235, 15, v237
    v_lshl_add_u32 v217, v235, 4, v234
    s_lshl_b32 s35, s54, 8
    s_add_u32 s35, s35, 0x3900000
    v_bfe_u32 v234, v237, 4, 1
    v_lshrrev_b32 v236, 5, v237
    v_lshl_add_u32 v234, v234, 1, v236
    v_lshl_add_u32 v234, v235, 2, v234
    s_lshl_b32 s32, s54, 6
    v_add_u32 v234, s32, v234
    v_lshlrev_b32 v218, 1, v234
    v_add_u32 v234, 98304, v218
    ds_read_u16 v100, v234
    ds_read_u16 v101, v234 offset:4096
    s_cmp_lt_u32 s54, 16
    s_cselect_b64 vcc, -1, 0
    v_cndmask_b32 v102, v10, v8, vcc
    s_cselect_b32 s32, 0, 4
    s_add_u32 s32, s32, 106496
    v_mov_b32 v234, s32
    ds_read_b32 v103, v234
    s_waitcnt lgkmcnt(0)
    v_cvt_pk_bf16_f32 v103, v103, v103
    v_lshlrev_b32 v103, 16, v103
    v_mul_f32 v103, 0xbfb8aa3b, v103
    v_exp_f32 v103, v103
    s_nop 0
    v_add_f32 v103, 1.0, v103
    v_rcp_f32 v103, v103
    s_nop 0
    v_cvt_pk_bf16_f32 v103, v103, v103
    v_lshlrev_b32 v103, 16, v103
    v_and_b32 v218, 2047, v218
    v_lshl_add_u32 v218, v102, 11, v218
    v_lshlrev_b32 v220, 2, v230
    v_add_u32 v220, 106752, v220
    v_lshlrev_b32 v221, 2, v237
    v_add_u32 v221, 106752, v221
    s_cmp_lg_u32 s3, 0
    s_cbranch_scc1 kc_b22
    s_lshl_b32 s32, s52, 7
    s_add_u32 s32, s32, 0x38a0c00
    s_mov_b32 s34, 0x400000
    s_branch kc_b21
kc_b20:
    s_sleep 2
kc_b21:
    buffer_load_dword v235, off, s[8:11], s32 sc1
    s_waitcnt vmcnt(0)
    v_cmp_ne_u32 vcc, 8, v235
    s_sub_u32 s34, s34, 1
    s_cbranch_scc1 kc_b22
    s_cbranch_vccnz kc_b20
kc_b22:
    s_barrier
    s_add_u32 s32, s35, 0
    buffer_load_dwordx4 v[32:35], v217, s[8:11], s32 offen sc1
    s_add_u32 s32, s35, 131072
    buffer_load_dwordx4 v[36:39], v217, s[8:11], s32 offen sc1
    s_add_u32 s32, s35, 262144
    buffer_load_dwordx4 v[40:43], v217, s[8:11], s32 offen sc1
    s_add_u32 s32, s35, 393216
    buffer_load_dwordx4 v[44:47], v217, s[8:11], s32 offen sc1
    s_add_u32 s32, s35, 524288
    buffer_load_dwordx4 v[48:51], v217, s[8:11], s32 offen sc1
    s_add_u32 s32, s35, 655360
    buffer_load_dwordx4 v[52:55], v217, s[8:11], s32 offen sc1
    s_add_u32 s32, s35, 786432
    buffer_load_dwordx4 v[56:59], v217, s[8:11], s32 offen sc1
    s_add_u32 s32, s35, 917504
    buffer_load_dwordx4 v[60:63], v217, s[8:11], s32 offen sc1
    s_add_u32 s32, s35, 1048576
    buffer_load_dwordx4 v[64:67], v217, s[8:11], s32 offen sc1
    s_add_u32 s32, s35, 1179648
    buffer_load_dwordx4 v[68:71], v217, s[8:11], s32 offen sc1
    s_add_u32 s32, s35, 1310720
    buffer_load_dwordx4 v[72:75], v217, s[8:11], s32 offen sc1
    s_add_u32 s32, s35, 1441792
    buffer_load_dwordx4 v[76:79], v217, s[8:11], s32 offen sc1
    s_add_u32 s32, s35, 1572864
    buffer_load_dwordx4 v[80:83], v217, s[8:11], s32 offen sc1
    s_add_u32 s32, s35, 1703936
    buffer_load_dwordx4 v[84:87], v217, s[8:11], s32 offen sc1
    s_waitcnt vmcnt(12)
    v_pk_add_f32 v[32:33], v[32:33], v[36:37]
    v_pk_add_f32 v[34:35], v[34:35], v[38:39]
    s_waitcnt vmcnt(11)
    v_pk_add_f32 v[32:33], v[32:33], v[40:41]
    v_pk_add_f32 v[34:35], v[34:35], v[42:43]
    s_waitcnt vmcnt(10)
    v_pk_add_f32 v[32:33], v[32:33], v[44:45]
    v_pk_add_f32 v[34:35], v[34:35], v[46:47]
    s_waitcnt vmcnt(9)
    v_pk_add_f32 v[32:33], v[32:33], v[48:49]
    v_pk_add_f32 v[34:35], v[34:35], v[50:51]
    s_waitcnt vmcnt(8)
    v_pk_add_f32 v[32:33], v[32:33], v[52:53]
    v_pk_add_f32 v[34:35], v[34:35], v[54:55]
    s_waitcnt vmcnt(7)
    v_pk_add_f32 v[32:33], v[32:33], v[56:57]
    v_pk_add_f32 v[34:35], v[34:35], v[58:59]
    s_waitcnt vmcnt(6)
    v_pk_add_f32 v[32:33], v[32:33], v[60:61]
    v_pk_add_f32 v[34:35], v[34:35], v[62:63]
    s_waitcnt vmcnt(5)
    v_pk_add_f32 v[32:33], v[32:33], v[64:65]
    v_pk_add_f32 v[34:35], v[34:35], v[66:67]
    s_waitcnt vmcnt(4)
    v_pk_add_f32 v[32:33], v[32:33], v[68:69]
    v_pk_add_f32 v[34:35], v[34:35], v[70:71]
    s_waitcnt vmcnt(3)
    v_pk_add_f32 v[32:33], v[32:33], v[72:73]
    v_pk_add_f32 v[34:35], v[34:35], v[74:75]
    s_waitcnt vmcnt(2)
    v_pk_add_f32 v[32:33], v[32:33], v[76:77]
    v_pk_add_f32 v[34:35], v[34:35], v[78:79]
    s_waitcnt vmcnt(1)
    v_pk_add_f32 v[32:33], v[32:33], v[80:81]
    v_pk_add_f32 v[34:35], v[34:35], v[82:83]
    s_waitcnt vmcnt(0)
    v_pk_add_f32 v[32:33], v[32:33], v[84:85]
    v_pk_add_f32 v[34:35], v[34:35], v[86:87]
    s_nop 1
    v_permlane32_swap_b32 v32, v33
    v_permlane32_swap_b32 v34, v35
    s_nop 0
    v_add_f32 v32, v32, v33
    v_add_f32 v34, v34, v35
    s_nop 1
    v_permlane16_swap_b32 v32, v34
    s_nop 0
    v_add_f32 v32, v32, v34
    ds_write_b32 v220, v32
    s_waitcnt lgkmcnt(0)
    s_barrier
    s_cmp_lg_u32 s3, 0
    s_cbranch_scc1 kc_fin
    ds_read_b32 v32, v221
    ds_read_b32 v33, v221 offset:256
    ds_read_b32 v34, v221 offset:512
    ds_read_b32 v35, v221 offset:768
    v_lshlrev_b32 v100, 16, v100
    v_lshlrev_b32 v101, 16, v101
    s_waitcnt lgkmcnt(0)
    v_add_f32 v32, v32, v33
    v_add_f32 v34, v34, v35
    v_add_f32 v32, v32, v34
    v_cvt_pk_bf16_f32 v32, v32, v32
    v_lshlrev_b32 v32, 16, v32
    v_mul_f32 v32, v32, v103
    v_cvt_pk_bf16_f32 v32, v32, v32
    v_lshlrev_b32 v32, 16, v32
    v_add_f32 v32, v32, v100
    v_cvt_pk_bf16_f32 v32, v32, v32
    v_lshlrev_b32 v32, 16, v32
    v_add_f32 v32, v32, v101
    v_cvt_pk_bf16_f32 v32, v32, v32
    buffer_store_short v32, v218, s[28:31], 0 offen
kc_fin:
    s_endpgm
kc_r3:
    s_mov_b32 s34, 0x400000
kc_r3l:
    s_sleep 4
    buffer_load_dwordx4 v[176:179], v228, s[8:11], s7 offen offset:0 sc1
    buffer_load_dwordx4 v[180:183], v228, s[8:11], s7 offen offset:1024 sc1
    buffer_load_dwordx4 v[184:187], v228, s[8:11], s7 offen offset:2048 sc1
    buffer_load_dwordx4 v[188:191], v228, s[8:11], s7 offen offset:3072 sc1
    s_waitcnt vmcnt(0)
    v_max3_u32 v235, v176, v177, v178
    v_max3_u32 v235, v235, v179, v180
    v_max3_u32 v235, v235, v181, v182
    v_max3_u32 v235, v235, v183, v184
    v_max3_u32 v235, v235, v185, v186
    v_max3_u32 v235, v235, v187, v188
    v_max3_u32 v235, v235, v189, v190
    v_max_u32 v235, v235, v191
    v_cmp_eq_u32 vcc, -1, v235
    s_sub_u32 s34, s34, 1
    s_cbranch_scc1 kc_r3o
    s_cbranch_vccnz kc_r3l
    s_branch kc_r3o
kc_r1:
    s_mov_b32 s34, 0x400000
kc_r1l:
    s_sleep 4
    buffer_load_dwordx4 v[96:99], v228, s[8:11], s37 offen offset:0 sc1
    buffer_load_dwordx4 v[100:103], v228, s[8:11], s37 offen offset:1024 sc1
    buffer_load_dwordx4 v[104:107], v228, s[8:11], s37 offen offset:2048 sc1
    buffer_load_dwordx4 v[108:111], v228, s[8:11], s37 offen offset:3072 sc1
    s_waitcnt vmcnt(0)
    v_max3_u32 v235, v96, v97, v98
    v_max3_u32 v235, v235, v99, v100
    v_max3_u32 v235, v235, v101, v102
    v_max3_u32 v235, v235, v103, v104
    v_max3_u32 v235, v235, v105, v106
    v_max3_u32 v235, v235, v107, v108
    v_max3_u32 v235, v235, v109, v110
    v_max_u32 v235, v235, v111
    v_cmp_eq_u32 vcc, -1, v235
    s_sub_u32 s34, s34, 1
    s_cbranch_scc1 kc_r1o
    s_cbranch_vccnz kc_r1l
    s_branch kc_r1o
kc_r2:
    s_mov_b32 s34, 0x400000
kc_r2l:
    s_sleep 4
    buffer_load_dwordx4 v[160:163], v228, s[8:11], s38 offen offset:0 sc1
    buffer_load_dwordx4 v[164:167], v228, s[8:11], s38 offen offset:1024 sc1
    buffer_load_dwordx4 v[168:171], v228, s[8:11], s38 offen offset:2048 sc1
    buffer_load_dwordx4 v[172:175], v228, s[8:11], s38 offen offset:3072 sc1
    s_waitcnt vmcnt(0)
    v_max3_u32 v235, v160, v161, v162
    v_max3_u32 v235, v235, v163, v164
    v_max3_u32 v235, v235, v165, v166
    v_max3_u32 v235, v235, v167, v168
    v_max3_u32 v235, v235, v169, v170
    v_max3_u32 v235, v235, v171, v172
    v_max3_u32 v235, v235, v173, v174
    v_max_u32 v235, v235, v175
    v_cmp_eq_u32 vcc, -1, v235
    s_sub_u32 s34, s34, 1
    s_cbranch_scc1 kc_r2o
    s_cbranch_vccnz kc_r2l
    s_branch kc_r2o
kc_end:
ka_done:
    s_endpgm
kf_fix1:
    s_cmp_eq_u32 s33, 0
    s_cselect_b32 s24, 0, 0x74000000
    s_cselect_b32 s36, 0, 0x1000
    s_mov_b32 s33, 1
    v_subrev_f32 v230, s24, v243
    v_add_f32 v231, 0, v230
    v_min_f32 v64, v228, v231
    v_add_f32 v232, 0xf1800000, v230
    v_min_f32 v65, v228, v232
    v_add_f32 v231, 0xf2000000, v230
    v_min_f32 v66, v228, v231
    v_add_f32 v232, 0xf2400000, v230
    v_min_f32 v67, v228, v232
    v_add_f32 v231, 0xf3000000, v230
    v_min_f32 v68, v228, v231
    v_add_f32 v232, 0xf3100000, v230
    v_min_f32 v69, v228, v232
    v_add_f32 v231, 0xf3200000, v230
    v_min_f32 v70, v228, v231
    v_add_f32 v232, 0xf3300000, v230
    v_min_f32 v71, v228, v232
    v_add_f32 v231, 0xf3800000, v230
    v_min_f32 v72, v228, v231
    v_add_f32 v232, 0xf3880000, v230
    v_min_f32 v73, v228, v232
    v_add_f32 v231, 0xf3900000, v230
    v_min_f32 v74, v228, v231
    v_add_f32 v232, 0xf3980000, v230
    v_min_f32 v75, v228, v232
    v_add_f32 v231, 0xf3c00000, v230
    v_min_f32 v76, v228, v231
    v_add_f32 v232, 0xf3c80000, v230
    v_min_f32 v77, v228, v232
    v_add_f32 v231, 0xf3d00000, v230
    v_min_f32 v78, v228, v231
    v_add_f32 v232, 0xf3d80000, v230
    v_min_f32 v79, v228, v232
    s_nop 1
    s_branch kf_fixr2
kf_fix3:
    s_cmp_eq_u32 s33, 0
    s_cselect_b32 s24, 0, 0x74000000
    s_cselect_b32 s36, 0, 0x1000
    s_mov_b32 s33, 1
    v_subrev_f32 v230, s24, v243
    v_add_f32 v231, 0, v230
    v_min_f32 v64, v228, v231
    v_add_f32 v232, 0xf1800000, v230
    v_min_f32 v65, v228, v232
    v_add_f32 v231, 0xf2000000, v230
    v_min_f32 v66, v228, v231
    v_add_f32 v232, 0xf2400000, v230
    v_min_f32 v67, v228, v232
    v_add_f32 v231, 0xf3000000, v230
    v_min_f32 v68, v228, v231
    v_add_f32 v232, 0xf3100000, v230
    v_min_f32 v69, v228, v232
    v_add_f32 v231, 0xf3200000, v230
    v_min_f32 v70, v228, v231
    v_add_f32 v232, 0xf3300000, v230
    v_min_f32 v71, v228, v232
    v_add_f32 v231, 0xf3800000, v230
    v_min_f32 v72, v228, v231
    v_add_f32 v232, 0xf3880000, v230
    v_min_f32 v73, v228, v232
    v_add_f32 v231, 0xf3900000, v230
    v_min_f32 v74, v228, v231
    v_add_f32 v232, 0xf3980000, v230
    v_min_f32 v75, v228, v232
    v_add_f32 v231, 0xf3c00000, v230
    v_min_f32 v76, v228, v231
    v_add_f32 v232, 0xf3c80000, v230
    v_min_f32 v77, v228, v232
    v_add_f32 v231, 0xf3d00000, v230
    v_min_f32 v78, v228, v231
    v_add_f32 v232, 0xf3d80000, v230
    v_min_f32 v79, v228, v232
    s_nop 1
    s_branch kf_fixr4
kf_l2p5:
    buffer_load_dword v252, v251, s[56:59], s28 offen
    s_add_u32 s28, s28, 2048
    buffer_store_dwordx4 v[200:203], v240, s[8:11], s29 offen sc1
    s_add_u32 s29, s29, 1024
    s_cmp_lt_u32 s29, s30
    s_cselect_b32 s27, 0, 0x1000
    s_branch kf_l2r6
kf_fix7:
    s_cmp_eq_u32 s33, 0
    s_cselect_b32 s24, 0, 0x74000000
    s_cselect_b32 s36, 0, 0x1000
    s_mov_b32 s33, 1
    v_subrev_f32 v230, s24, v243
    v_add_f32 v231, 0, v230
    v_min_f32 v64, v228, v231
    v_add_f32 v232, 0xf1800000, v230
    v_min_f32 v65, v228, v232
    v_add_f32 v231, 0xf2000000, v230
    v_min_f32 v66, v228, v231
    v_add_f32 v232, 0xf2400000, v230
    v_min_f32 v67, v228, v232
    v_add_f32 v231, 0xf3000000, v230
    v_min_f32 v68, v228, v231
    v_add_f32 v232, 0xf3100000, v230
    v_min_f32 v69, v228, v232
    v_add_f32 v231, 0xf3200000, v230
    v_min_f32 v70, v228, v231
    v_add_f32 v232, 0xf3300000, v230
    v_min_f32 v71, v228, v232
    v_add_f32 v231, 0xf3800000, v230
    v_min_f32 v72, v228, v231
    v_add_f32 v232, 0xf3880000, v230
    v_min_f32 v73, v228, v232
    v_add_f32 v231, 0xf3900000, v230
    v_min_f32 v74, v228, v231
    v_add_f32 v232, 0xf3980000, v230
    v_min_f32 v75, v228, v232
    v_add_f32 v231, 0xf3c00000, v230
    v_min_f32 v76, v228, v231
    v_add_f32 v232, 0xf3c80000, v230
    v_min_f32 v77, v228, v232
    v_add_f32 v231, 0xf3d00000, v230
    v_min_f32 v78, v228, v231
    v_add_f32 v232, 0xf3d80000, v230
    v_min_f32 v79, v228, v232
    s_nop 1
    s_branch kf_fixr8
kf_rare10:
    s_nop 15
    v_max3_f32 v230, v32, v33, v34
    v_max3_f32 v230, v230, v35, v36
    v_max3_f32 v230, v230, v37, v38
    v_max3_f32 v230, v230, v39, v40
    v_max3_f32 v230, v230, v41, v42
    v_max3_f32 v230, v230, v43, v44
    v_max3_f32 v230, v230, v45, v46
    v_max_f32 v230, v230, v47
    v_mov_b32 v231, v230
    s_nop 1
    v_permlane32_swap_b32 v230, v231
    s_nop 0
    v_max_f32 v230, v230, v231
    v_max_f32 v230, 0, v230
    v_sub_f32 v232, 0, v230
    v_exp_f32 v232, v232
    v_sub_f32 v228, v228, v230
    v_sub_f32 v64, v64, v230
    v_sub_f32 v0, v0, v230
    v_sub_f32 v32, v32, v230
    v_sub_f32 v65, v65, v230
    v_sub_f32 v1, v1, v230
    v_sub_f32 v33, v33, v230
    v_sub_f32 v66, v66, v230
    v_sub_f32 v2, v2, v230
    v_sub_f32 v34, v34, v230
    v_sub_f32 v67, v67, v230
    v_sub_f32 v3, v3, v230
    v_sub_f32 v35, v35, v230
    v_sub_f32 v68, v68, v230
    v_sub_f32 v4, v4, v230
    v_sub_f32 v36, v36, v230
    v_sub_f32 v69, v69, v230
    v_sub_f32 v5, v5, v230
    v_sub_f32 v37, v37, v230
    v_sub_f32 v70, v70, v230
    v_sub_f32 v6, v6, v230
    v_sub_f32 v38, v38, v230
    v_sub_f32 v71, v71, v230
    v_sub_f32 v7, v7, v230
    v_sub_f32 v39, v39, v230
    v_sub_f32 v72, v72, v230
    v_sub_f32 v8, v8, v230
    v_sub_f32 v40, v40, v230
    v_sub_f32 v73, v73, v230
    v_sub_f32 v9, v9, v230
    v_sub_f32 v41, v41, v230
    v_sub_f32 v74, v74, v230
    v_sub_f32 v10, v10, v230
    v_sub_f32 v42, v42, v230
    v_sub_f32 v75, v75, v230
    v_sub_f32 v11, v11, v230
    v_sub_f32 v43, v43, v230
    v_sub_f32 v76, v76, v230
    v_sub_f32 v12, v12, v230
    v_sub_f32 v44, v44, v230
    v_sub_f32 v77, v77, v230
    v_sub_f32 v13, v13, v230
    v_sub_f32 v45, v45, v230
    v_sub_f32 v78, v78, v230
    v_sub_f32 v14, v14, v230
    v_sub_f32 v46, v46, v230
    v_sub_f32 v79, v79, v230
    v_sub_f32 v15, v15, v230
    v_sub_f32 v47, v47, v230
    v_mul_f32 v226, v226, v232
    v_accvgpr_read_b32 v234, a0
    v_mul_f32 v234, v234, v232
    v_accvgpr_write_b32 a0, v234
    v_accvgpr_read_b32 v235, a1
    v_mul_f32 v235, v235, v232
    v_accvgpr_write_b32 a1, v235
    v_accvgpr_read_b32 v236, a2
    v_mul_f32 v236, v236, v232
    v_accvgpr_write_b32 a2, v236
    v_accvgpr_read_b32 v237, a3
    v_mul_f32 v237, v237, v232
    v_accvgpr_write_b32 a3, v237
    v_accvgpr_read_b32 v234, a4
    v_mul_f32 v234, v234, v232
    v_accvgpr_write_b32 a4, v234
    v_accvgpr_read_b32 v235, a5
    v_mul_f32 v235, v235, v232
    v_accvgpr_write_b32 a5, v235
    v_accvgpr_read_b32 v236, a6
    v_mul_f32 v236, v236, v232
    v_accvgpr_write_b32 a6, v236
    v_accvgpr_read_b32 v237, a7
    v_mul_f32 v237, v237, v232
    v_accvgpr_write_b32 a7, v237
    v_accvgpr_read_b32 v234, a8
    v_mul_f32 v234, v234, v232
    v_accvgpr_write_b32 a8, v234
    v_accvgpr_read_b32 v235, a9
    v_mul_f32 v235, v235, v232
    v_accvgpr_write_b32 a9, v235
    v_accvgpr_read_b32 v236, a10
    v_mul_f32 v236, v236, v232
    v_accvgpr_write_b32 a10, v236
    v_accvgpr_read_b32 v237, a11
    v_mul_f32 v237, v237, v232
    v_accvgpr_write_b32 a11, v237
    v_accvgpr_read_b32 v234, a12
    v_mul_f32 v234, v234, v232
    v_accvgpr_write_b32 a12, v234
    v_accvgpr_read_b32 v235, a13
    v_mul_f32 v235, v235, v232
    v_accvgpr_write_b32 a13, v235
    v_accvgpr_read_b32 v236, a14
    v_mul_f32 v236, v236, v232
    v_accvgpr_write_b32 a14, v236
    v_accvgpr_read_b32 v237, a15
    v_mul_f32 v237, v237, v232
    v_accvgpr_write_b32 a15, v237
    v_accvgpr_read_b32 v234, a16
    v_mul_f32 v234, v234, v232
    v_accvgpr_write_b32 a16, v234
    v_accvgpr_read_b32 v235, a17
    v_mul_f32 v235, v235, v232
    v_accvgpr_write_b32 a17, v235
    v_accvgpr_read_b32 v236, a18
    v_mul_f32 v236, v236, v232
    v_accvgpr_write_b32 a18, v236
    v_accvgpr_read_b32 v237, a19
    v_mul_f32 v237, v237, v232
    v_accvgpr_write_b32 a19, v237
    v_accvgpr_read_b32 v234, a20
    v_mul_f32 v234, v234, v232
    v_accvgpr_write_b32 a20, v234
    v_accvgpr_read_b32 v235, a21
    v_mul_f32 v235, v235, v232
    v_accvgpr_write_b32 a21, v235
    v_accvgpr_read_b32 v236, a22
    v_mul_f32 v236, v236, v232
    v_accvgpr_write_b32 a22, v236
    v_accvgpr_read_b32 v237, a23
    v_mul_f32 v237, v237, v232
    v_accvgpr_write_b32 a23, v237
    v_accvgpr_read_b32 v234, a24
    v_mul_f32 v234, v234, v232
    v_accvgpr_write_b32 a24, v234
    v_accvgpr_read_b32 v235, a25
    v_mul_f32 v235, v235, v232
    v_accvgpr_write_b32 a25, v235
    v_accvgpr_read_b32 v236, a26
    v_mul_f32 v236, v236, v232
    v_accvgpr_write_b32 a26, v236
    v_accvgpr_read_b32 v237, a27
    v_mul_f32 v237, v237, v232
    v_accvgpr_write_b32 a27, v237
    v_accvgpr_read_b32 v234, a28
    v_mul_f32 v234, v234, v232
    v_accvgpr_write_b32 a28, v234
    v_accvgpr_read_b32 v235, a29
    v_mul_f32 v235, v235, v232
    v_accvgpr_write_b32 a29, v235
    v_accvgpr_read_b32 v236, a30
    v_mul_f32 v236, v236, v232
    v_accvgpr_write_b32 a30, v236
    v_accvgpr_read_b32 v237, a31
    v_mul_f32 v237, v237, v232
    v_accvgpr_write_b32 a31, v237
    v_accvgpr_read_b32 v234, a32
    v_mul_f32 v234, v234, v232
    v_accvgpr_write_b32 a32, v234
    v_accvgpr_read_b32 v235, a33
    v_mul_f32 v235, v235, v232
    v_accvgpr_write_b32 a33, v235
    v_accvgpr_read_b32 v236, a34
    v_mul_f32 v236, v236, v232
    v_accvgpr_write_b32 a34, v236
    v_accvgpr_read_b32 v237, a35
    v_mul_f32 v237, v237, v232
    v_accvgpr_write_b32 a35, v237
    v_accvgpr_read_b32 v234, a36
    v_mul_f32 v234, v234, v232
    v_accvgpr_write_b32 a36, v234
    v_accvgpr_read_b32 v235, a37
    v_mul_f32 v235, v235, v232
    v_accvgpr_write_b32 a37, v235
    v_accvgpr_read_b32 v236, a38
    v_mul_f32 v236, v236, v232
    v_accvgpr_write_b32 a38, v236
    v_accvgpr_read_b32 v237, a39
    v_mul_f32 v237, v237, v232
    v_accvgpr_write_b32 a39, v237
    v_accvgpr_read_b32 v234, a40
    v_mul_f32 v234, v234, v232
    v_accvgpr_write_b32 a40, v234
    v_accvgpr_read_b32 v235, a41
    v_mul_f32 v235, v235, v232
    v_accvgpr_write_b32 a41, v235
    v_accvgpr_read_b32 v236, a42
    v_mul_f32 v236, v236, v232
    v_accvgpr_write_b32 a42, v236
    v_accvgpr_read_b32 v237, a43
    v_mul_f32 v237, v237, v232
    v_accvgpr_write_b32 a43, v237
    v_accvgpr_read_b32 v234, a44
    v_mul_f32 v234, v234, v232
    v_accvgpr_write_b32 a44, v234
    v_accvgpr_read_b32 v235, a45
    v_mul_f32 v235, v235, v232
    v_accvgpr_write_b32 a45, v235
    v_accvgpr_read_b32 v236, a46
    v_mul_f32 v236, v236, v232
    v_accvgpr_write_b32 a46, v236
    v_accvgpr_read_b32 v237, a47
    v_mul_f32 v237, v237, v232
    v_accvgpr_write_b32 a47, v237
    v_accvgpr_read_b32 v234, a48
    v_mul_f32 v234, v234, v232
    v_accvgpr_write_b32 a48, v234
    v_accvgpr_read_b32 v235, a49
    v_mul_f32 v235, v235, v232
    v_accvgpr_write_b32 a49, v235
    v_accvgpr_read_b32 v236, a50
    v_mul_f32 v236, v236, v232
    v_accvgpr_write_b32 a50, v236
    v_accvgpr_read_b32 v237, a51
    v_mul_f32 v237, v237, v232
    v_accvgpr_write_b32 a51, v237
    v_accvgpr_read_b32 v234, a52
    v_mul_f32 v234, v234, v232
    v_accvgpr_write_b32 a52, v234
    v_accvgpr_read_b32 v235, a53
    v_mul_f32 v235, v235, v232
    v_accvgpr_write_b32 a53, v235
    v_accvgpr_read_b32 v236, a54
    v_mul_f32 v236, v236, v232
    v_accvgpr_write_b32 a54, v236
    v_accvgpr_read_b32 v237, a55
    v_mul_f32 v237, v237, v232
    v_accvgpr_write_b32 a55, v237
    v_accvgpr_read_b32 v234, a56
    v_mul_f32 v234, v234, v232
    v_accvgpr_write_b32 a56, v234
    v_accvgpr_read_b32 v235, a57
    v_mul_f32 v235, v235, v232
    v_accvgpr_write_b32 a57, v235
    v_accvgpr_read_b32 v236, a58
    v_mul_f32 v236, v236, v232
    v_accvgpr_write_b32 a58, v236
    v_accvgpr_read_b32 v237, a59
    v_mul_f32 v237, v237, v232
    v_accvgpr_write_b32 a59, v237
    v_accvgpr_read_b32 v234, a60
    v_mul_f32 v234, v234, v232
    v_accvgpr_write_b32 a60, v234
    v_accvgpr_read_b32 v235, a61
    v_mul_f32 v235, v235, v232
    v_accvgpr_write_b32 a61, v235
    v_accvgpr_read_b32 v236, a62
    v_mul_f32 v236, v236, v232
    v_accvgpr_write_b32 a62, v236
    v_accvgpr_read_b32 v237, a63
    v_mul_f32 v237, v237, v232
    v_accvgpr_write_b32 a63, v237
    v_exp_f32 v136, v32
    v_exp_f32 v137, v33
    v_exp_f32 v130, v34
    v_exp_f32 v131, v35
    v_cvt_pk_bf16_f32 v112, v136, v137
    v_exp_f32 v132, v36
    v_exp_f32 v133, v37
    v_cvt_pk_bf16_f32 v113, v130, v131
    v_add_f32 v136, v136, v130
    v_add_f32 v137, v137, v131
    v_exp_f32 v134, v38
    v_exp_f32 v135, v39
    v_cvt_pk_bf16_f32 v114, v132, v133
    v_add_f32 v136, v136, v132
    v_add_f32 v137, v137, v133
    v_exp_f32 v128, v40
    v_exp_f32 v129, v41
    v_cvt_pk_bf16_f32 v115, v134, v135
    v_add_f32 v136, v136, v134
    v_add_f32 v137, v137, v135
    v_exp_f32 v130, v42
    v_exp_f32 v131, v43
    v_cvt_pk_bf16_f32 v116, v128, v129
    v_add_f32 v136, v136, v128
    v_add_f32 v137, v137, v129
    v_exp_f32 v132, v44
    v_exp_f32 v133, v45
    v_cvt_pk_bf16_f32 v117, v130, v131
    v_add_f32 v136, v136, v130
    v_add_f32 v137, v137, v131
    v_exp_f32 v134, v46
    v_exp_f32 v135, v47
    v_cvt_pk_bf16_f32 v118, v132, v133
    v_add_f32 v136, v136, v132
    v_add_f32 v137, v137, v133
    v_cvt_pk_bf16_f32 v119, v134, v135
    v_add_f32 v136, v136, v134
    v_add_f32 v137, v137, v135
    v_add_f32 v224, v136, v137
    v_max3_f32 v230, v48, v49, v50
    v_max3_f32 v230, v230, v51, v52
    v_max3_f32 v230, v230, v53, v54
    v_max3_f32 v230, v230, v55, v56
    v_max3_f32 v230, v230, v57, v58
    v_max3_f32 v230, v230, v59, v60
    v_max3_f32 v230, v230, v61, v62
    v_max_f32 v230, v230, v63
    v_mov_b32 v231, v230
    s_nop 1
    v_permlane32_swap_b32 v230, v231
    s_nop 0
    v_max_f32 v230, v230, v231
    v_max_f32 v230, 0, v230
    v_sub_f32 v232, 0, v230
    v_exp_f32 v232, v232
    v_sub_f32 v229, v229, v230
    v_sub_f32 v80, v80, v230
    v_sub_f32 v16, v16, v230
    v_sub_f32 v48, v48, v230
    v_sub_f32 v81, v81, v230
    v_sub_f32 v17, v17, v230
    v_sub_f32 v49, v49, v230
    v_sub_f32 v82, v82, v230
    v_sub_f32 v18, v18, v230
    v_sub_f32 v50, v50, v230
    v_sub_f32 v83, v83, v230
    v_sub_f32 v19, v19, v230
    v_sub_f32 v51, v51, v230
    v_sub_f32 v84, v84, v230
    v_sub_f32 v20, v20, v230
    v_sub_f32 v52, v52, v230
    v_sub_f32 v85, v85, v230
    v_sub_f32 v21, v21, v230
    v_sub_f32 v53, v53, v230
    v_sub_f32 v86, v86, v230
    v_sub_f32 v22, v22, v230
    v_sub_f32 v54, v54, v230
    v_sub_f32 v87, v87, v230
    v_sub_f32 v23, v23, v230
    v_sub_f32 v55, v55, v230
    v_sub_f32 v88, v88, v230
    v_sub_f32 v24, v24, v230
    v_sub_f32 v56, v56, v230
    v_sub_f32 v89, v89, v230
    v_sub_f32 v25, v25, v230
    v_sub_f32 v57, v57, v230
    v_sub_f32 v90, v90, v230
    v_sub_f32 v26, v26, v230
    v_sub_f32 v58, v58, v230
    v_sub_f32 v91, v91, v230
    v_sub_f32 v27, v27, v230
    v_sub_f32 v59, v59, v230
    v_sub_f32 v92, v92, v230
    v_sub_f32 v28, v28, v230
    v_sub_f32 v60, v60, v230
    v_sub_f32 v93, v93, v230
    v_sub_f32 v29, v29, v230
    v_sub_f32 v61, v61, v230
    v_sub_f32 v94, v94, v230
    v_sub_f32 v30, v30, v230
    v_sub_f32 v62, v62, v230
    v_sub_f32 v95, v95, v230
    v_sub_f32 v31, v31, v230
    v_sub_f32 v63, v63, v230
    v_mul_f32 v227, v227, v232
    v_accvgpr_read_b32 v234, a64
    v_mul_f32 v234, v234, v232
    v_accvgpr_write_b32 a64, v234
    v_accvgpr_read_b32 v235, a65
    v_mul_f32 v235, v235, v232
    v_accvgpr_write_b32 a65, v235
    v_accvgpr_read_b32 v236, a66
    v_mul_f32 v236, v236, v232
    v_accvgpr_write_b32 a66, v236
    v_accvgpr_read_b32 v237, a67
    v_mul_f32 v237, v237, v232
    v_accvgpr_write_b32 a67, v237
    v_accvgpr_read_b32 v234, a68
    v_mul_f32 v234, v234, v232
    v_accvgpr_write_b32 a68, v234
    v_accvgpr_read_b32 v235, a69
    v_mul_f32 v235, v235, v232
    v_accvgpr_write_b32 a69, v235
    v_accvgpr_read_b32 v236, a70
    v_mul_f32 v236, v236, v232
    v_accvgpr_write_b32 a70, v236
    v_accvgpr_read_b32 v237, a71
    v_mul_f32 v237, v237, v232
    v_accvgpr_write_b32 a71, v237
    v_accvgpr_read_b32 v234, a72
    v_mul_f32 v234, v234, v232
    v_accvgpr_write_b32 a72, v234
    v_accvgpr_read_b32 v235, a73
    v_mul_f32 v235, v235, v232
    v_accvgpr_write_b32 a73, v235
    v_accvgpr_read_b32 v236, a74
    v_mul_f32 v236, v236, v232
    v_accvgpr_write_b32 a74, v236
    v_accvgpr_read_b32 v237, a75
    v_mul_f32 v237, v237, v232
    v_accvgpr_write_b32 a75, v237
    v_accvgpr_read_b32 v234, a76
    v_mul_f32 v234, v234, v232
    v_accvgpr_write_b32 a76, v234
    v_accvgpr_read_b32 v235, a77
    v_mul_f32 v235, v235, v232
    v_accvgpr_write_b32 a77, v235
    v_accvgpr_read_b32 v236, a78
    v_mul_f32 v236, v236, v232
    v_accvgpr_write_b32 a78, v236
    v_accvgpr_read_b32 v237, a79
    v_mul_f32 v237, v237, v232
    v_accvgpr_write_b32 a79, v237
    v_accvgpr_read_b32 v234, a80
    v_mul_f32 v234, v234, v232
    v_accvgpr_write_b32 a80, v234
    v_accvgpr_read_b32 v235, a81
    v_mul_f32 v235, v235, v232
    v_accvgpr_write_b32 a81, v235
    v_accvgpr_read_b32 v236, a82
    v_mul_f32 v236, v236, v232
    v_accvgpr_write_b32 a82, v236
    v_accvgpr_read_b32 v237, a83
    v_mul_f32 v237, v237, v232
    v_accvgpr_write_b32 a83, v237
    v_accvgpr_read_b32 v234, a84
    v_mul_f32 v234, v234, v232
    v_accvgpr_write_b32 a84, v234
    v_accvgpr_read_b32 v235, a85
    v_mul_f32 v235, v235, v232
    v_accvgpr_write_b32 a85, v235
    v_accvgpr_read_b32 v236, a86
    v_mul_f32 v236, v236, v232
    v_accvgpr_write_b32 a86, v236
    v_accvgpr_read_b32 v237, a87
    v_mul_f32 v237, v237, v232
    v_accvgpr_write_b32 a87, v237
    v_accvgpr_read_b32 v234, a88
    v_mul_f32 v234, v234, v232
    v_accvgpr_write_b32 a88, v234
    v_accvgpr_read_b32 v235, a89
    v_mul_f32 v235, v235, v232
    v_accvgpr_write_b32 a89, v235
    v_accvgpr_read_b32 v236, a90
    v_mul_f32 v236, v236, v232
    v_accvgpr_write_b32 a90, v236
    v_accvgpr_read_b32 v237, a91
    v_mul_f32 v237, v237, v232
    v_accvgpr_write_b32 a91, v237
    v_accvgpr_read_b32 v234, a92
    v_mul_f32 v234, v234, v232
    v_accvgpr_write_b32 a92, v234
    v_accvgpr_read_b32 v235, a93
    v_mul_f32 v235, v235, v232
    v_accvgpr_write_b32 a93, v235
    v_accvgpr_read_b32 v236, a94
    v_mul_f32 v236, v236, v232
    v_accvgpr_write_b32 a94, v236
    v_accvgpr_read_b32 v237, a95
    v_mul_f32 v237, v237, v232
    v_accvgpr_write_b32 a95, v237
    v_accvgpr_read_b32 v234, a96
    v_mul_f32 v234, v234, v232
    v_accvgpr_write_b32 a96, v234
    v_accvgpr_read_b32 v235, a97
    v_mul_f32 v235, v235, v232
    v_accvgpr_write_b32 a97, v235
    v_accvgpr_read_b32 v236, a98
    v_mul_f32 v236, v236, v232
    v_accvgpr_write_b32 a98, v236
    v_accvgpr_read_b32 v237, a99
    v_mul_f32 v237, v237, v232
    v_accvgpr_write_b32 a99, v237
    v_accvgpr_read_b32 v234, a100
    v_mul_f32 v234, v234, v232
    v_accvgpr_write_b32 a100, v234
    v_accvgpr_read_b32 v235, a101
    v_mul_f32 v235, v235, v232
    v_accvgpr_write_b32 a101, v235
    v_accvgpr_read_b32 v236, a102
    v_mul_f32 v236, v236, v232
    v_accvgpr_write_b32 a102, v236
    v_accvgpr_read_b32 v237, a103
    v_mul_f32 v237, v237, v232
    v_accvgpr_write_b32 a103, v237
    v_accvgpr_read_b32 v234, a104
    v_mul_f32 v234, v234, v232
    v_accvgpr_write_b32 a104, v234
    v_accvgpr_read_b32 v235, a105
    v_mul_f32 v235, v235, v232
    v_accvgpr_write_b32 a105, v235
    v_accvgpr_read_b32 v236, a106
    v_mul_f32 v236, v236, v232
    v_accvgpr_write_b32 a106, v236
    v_accvgpr_read_b32 v237, a107
    v_mul_f32 v237, v237, v232
    v_accvgpr_write_b32 a107, v237
    v_accvgpr_read_b32 v234, a108
    v_mul_f32 v234, v234, v232
    v_accvgpr_write_b32 a108, v234
    v_accvgpr_read_b32 v235, a109
    v_mul_f32 v235, v235, v232
    v_accvgpr_write_b32 a109, v235
    v_accvgpr_read_b32 v236, a110
    v_mul_f32 v236, v236, v232
    v_accvgpr_write_b32 a110, v236
    v_accvgpr_read_b32 v237, a111
    v_mul_f32 v237, v237, v232
    v_accvgpr_write_b32 a111, v237
    v_accvgpr_read_b32 v234, a112
    v_mul_f32 v234, v234, v232
    v_accvgpr_write_b32 a112, v234
    v_accvgpr_read_b32 v235, a113
    v_mul_f32 v235, v235, v232
    v_accvgpr_write_b32 a113, v235
    v_accvgpr_read_b32 v236, a114
    v_mul_f32 v236, v236, v232
    v_accvgpr_write_b32 a114, v236
    v_accvgpr_read_b32 v237, a115
    v_mul_f32 v237, v237, v232
    v_accvgpr_write_b32 a115, v237
    v_accvgpr_read_b32 v234, a116
    v_mul_f32 v234, v234, v232
    v_accvgpr_write_b32 a116, v234
    v_accvgpr_read_b32 v235, a117
    v_mul_f32 v235, v235, v232
    v_accvgpr_write_b32 a117, v235
    v_accvgpr_read_b32 v236, a118
    v_mul_f32 v236, v236, v232
    v_accvgpr_write_b32 a118, v236
    v_accvgpr_read_b32 v237, a119
    v_mul_f32 v237, v237, v232
    v_accvgpr_write_b32 a119, v237
    v_accvgpr_read_b32 v234, a120
    v_mul_f32 v234, v234, v232
    v_accvgpr_write_b32 a120, v234
    v_accvgpr_read_b32 v235, a121
    v_mul_f32 v235, v235, v232
    v_accvgpr_write_b32 a121, v235
    v_accvgpr_read_b32 v236, a122
    v_mul_f32 v236, v236, v232
    v_accvgpr_write_b32 a122, v236
    v_accvgpr_read_b32 v237, a123
    v_mul_f32 v237, v237, v232
    v_accvgpr_write_b32 a123, v237
    v_accvgpr_read_b32 v234, a124
    v_mul_f32 v234, v234, v232
    v_accvgpr_write_b32 a124, v234
    v_accvgpr_read_b32 v235, a125
    v_mul_f32 v235, v235, v232
    v_accvgpr_write_b32 a125, v235
    v_accvgpr_read_b32 v236, a126
    v_mul_f32 v236, v236, v232
    v_accvgpr_write_b32 a126, v236
    v_accvgpr_read_b32 v237, a127
    v_mul_f32 v237, v237, v232
    v_accvgpr_write_b32 a127, v237
    v_exp_f32 v138, v48
    v_exp_f32 v139, v49
    v_exp_f32 v130, v50
    v_exp_f32 v131, v51
    v_cvt_pk_bf16_f32 v120, v138, v139
    v_exp_f32 v132, v52
    v_exp_f32 v133, v53
    v_cvt_pk_bf16_f32 v121, v130, v131
    v_add_f32 v138, v138, v130
    v_add_f32 v139, v139, v131
    v_exp_f32 v134, v54
    v_exp_f32 v135, v55
    v_cvt_pk_bf16_f32 v122, v132, v133
    v_add_f32 v138, v138, v132
    v_add_f32 v139, v139, v133
    v_exp_f32 v128, v56
    v_exp_f32 v129, v57
    v_cvt_pk_bf16_f32 v123, v134, v135
    v_add_f32 v138, v138, v134
    v_add_f32 v139, v139, v135
    v_exp_f32 v130, v58
    v_exp_f32 v131, v59
    v_cvt_pk_bf16_f32 v124, v128, v129
    v_add_f32 v138, v138, v128
    v_add_f32 v139, v139, v129
    v_exp_f32 v132, v60
    v_exp_f32 v133, v61
    v_cvt_pk_bf16_f32 v125, v130, v131
    v_add_f32 v138, v138, v130
    v_add_f32 v139, v139, v131
    v_exp_f32 v134, v62
    v_exp_f32 v135, v63
    v_cvt_pk_bf16_f32 v126, v132, v133
    v_add_f32 v138, v138, v132
    v_add_f32 v139, v139, v133
    v_cvt_pk_bf16_f32 v127, v134, v135
    v_add_f32 v138, v138, v134
    v_add_f32 v139, v139, v135
    v_add_f32 v225, v138, v139
    s_nop 1
    s_branch kf_rr9
kf_l2p11:
    buffer_load_dword v252, v251, s[56:59], s28 offen
    s_add_u32 s28, s28, 2048
    buffer_store_dwordx4 v[200:203], v240, s[8:11], s29 offen sc1
    s_add_u32 s29, s29, 1024
    s_cmp_lt_u32 s29, s30
    s_cselect_b32 s27, 0, 0x1000
    s_branch kf_l2r12
kf_fix13:
    s_cmp_eq_u32 s33, 0
    s_cselect_b32 s24, 0, 0x74000000
    s_cselect_b32 s36, 0, 0x1000
    s_mov_b32 s33, 1
    v_subrev_f32 v230, s24, v243
    v_add_f32 v231, 0, v230
    v_min_f32 v64, v228, v231
    v_add_f32 v232, 0xf1800000, v230
    v_min_f32 v65, v228, v232
    v_add_f32 v231, 0xf2000000, v230
    v_min_f32 v66, v228, v231
    v_add_f32 v232, 0xf2400000, v230
    v_min_f32 v67, v228, v232
    v_add_f32 v231, 0xf3000000, v230
    v_min_f32 v68, v228, v231
    v_add_f32 v232, 0xf3100000, v230
    v_min_f32 v69, v228, v232
    v_add_f32 v231, 0xf3200000, v230
    v_min_f32 v70, v228, v231
    v_add_f32 v232, 0xf3300000, v230
    v_min_f32 v71, v228, v232
    v_add_f32 v231, 0xf3800000, v230
    v_min_f32 v72, v228, v231
    v_add_f32 v232, 0xf3880000, v230
    v_min_f32 v73, v228, v232
    v_add_f32 v231, 0xf3900000, v230
    v_min_f32 v74, v228, v231
    v_add_f32 v232, 0xf3980000, v230
    v_min_f32 v75, v228, v232
    v_add_f32 v231, 0xf3c00000, v230
    v_min_f32 v76, v228, v231
    v_add_f32 v232, 0xf3c80000, v230
    v_min_f32 v77, v228, v232
    v_add_f32 v231, 0xf3d00000, v230
    v_min_f32 v78, v228, v231
    v_add_f32 v232, 0xf3d80000, v230
    v_min_f32 v79, v228, v232
    s_nop 1
    s_branch kf_fixr14
kf_rare16:
    s_nop 15
    v_max3_f32 v230, v0, v1, v2
    v_max3_f32 v230, v230, v3, v4
    v_max3_f32 v230, v230, v5, v6
    v_max3_f32 v230, v230, v7, v8
    v_max3_f32 v230, v230, v9, v10
    v_max3_f32 v230, v230, v11, v12
    v_max3_f32 v230, v230, v13, v14
    v_max_f32 v230, v230, v15
    v_mov_b32 v231, v230
    s_nop 1
    v_permlane32_swap_b32 v230, v231
    s_nop 0
    v_max_f32 v230, v230, v231
    v_max_f32 v230, 0, v230
    v_sub_f32 v232, 0, v230
    v_exp_f32 v232, v232
    v_sub_f32 v228, v228, v230
    v_sub_f32 v64, v64, v230
    v_sub_f32 v32, v32, v230
    v_sub_f32 v0, v0, v230
    v_sub_f32 v65, v65, v230
    v_sub_f32 v33, v33, v230
    v_sub_f32 v1, v1, v230
    v_sub_f32 v66, v66, v230
    v_sub_f32 v34, v34, v230
    v_sub_f32 v2, v2, v230
    v_sub_f32 v67, v67, v230
    v_sub_f32 v35, v35, v230
    v_sub_f32 v3, v3, v230
    v_sub_f32 v68, v68, v230
    v_sub_f32 v36, v36, v230
    v_sub_f32 v4, v4, v230
    v_sub_f32 v69, v69, v230
    v_sub_f32 v37, v37, v230
    v_sub_f32 v5, v5, v230
    v_sub_f32 v70, v70, v230
    v_sub_f32 v38, v38, v230
    v_sub_f32 v6, v6, v230
    v_sub_f32 v71, v71, v230
    v_sub_f32 v39, v39, v230
    v_sub_f32 v7, v7, v230
    v_sub_f32 v72, v72, v230
    v_sub_f32 v40, v40, v230
    v_sub_f32 v8, v8, v230
    v_sub_f32 v73, v73, v230
    v_sub_f32 v41, v41, v230
    v_sub_f32 v9, v9, v230
    v_sub_f32 v74, v74, v230
    v_sub_f32 v42, v42, v230
    v_sub_f32 v10, v10, v230
    v_sub_f32 v75, v75, v230
    v_sub_f32 v43, v43, v230
    v_sub_f32 v11, v11, v230
    v_sub_f32 v76, v76, v230
    v_sub_f32 v44, v44, v230
    v_sub_f32 v12, v12, v230
    v_sub_f32 v77, v77, v230
    v_sub_f32 v45, v45, v230
    v_sub_f32 v13, v13, v230
    v_sub_f32 v78, v78, v230
    v_sub_f32 v46, v46, v230
    v_sub_f32 v14, v14, v230
    v_sub_f32 v79, v79, v230
    v_sub_f32 v47, v47, v230
    v_sub_f32 v15, v15, v230
    v_mul_f32 v226, v226, v232
    v_accvgpr_read_b32 v234, a0
    v_mul_f32 v234, v234, v232
    v_accvgpr_write_b32 a0, v234
    v_accvgpr_read_b32 v235, a1
    v_mul_f32 v235, v235, v232
    v_accvgpr_write_b32 a1, v235
    v_accvgpr_read_b32 v236, a2
    v_mul_f32 v236, v236, v232
    v_accvgpr_write_b32 a2, v236
    v_accvgpr_read_b32 v237, a3
    v_mul_f32 v237, v237, v232
    v_accvgpr_write_b32 a3, v237
    v_accvgpr_read_b32 v234, a4
    v_mul_f32 v234, v234, v232
    v_accvgpr_write_b32 a4, v234
    v_accvgpr_read_b32 v235, a5
    v_mul_f32 v235, v235, v232
    v_accvgpr_write_b32 a5, v235
    v_accvgpr_read_b32 v236, a6
    v_mul_f32 v236, v236, v232
    v_accvgpr_write_b32 a6, v236
    v_accvgpr_read_b32 v237, a7
    v_mul_f32 v237, v237, v232
    v_accvgpr_write_b32 a7, v237
    v_accvgpr_read_b32 v234, a8
    v_mul_f32 v234, v234, v232
    v_accvgpr_write_b32 a8, v234
    v_accvgpr_read_b32 v235, a9
    v_mul_f32 v235, v235, v232
    v_accvgpr_write_b32 a9, v235
    v_accvgpr_read_b32 v236, a10
    v_mul_f32 v236, v236, v232
    v_accvgpr_write_b32 a10, v236
    v_accvgpr_read_b32 v237, a11
    v_mul_f32 v237, v237, v232
    v_accvgpr_write_b32 a11, v237
    v_accvgpr_read_b32 v234, a12
    v_mul_f32 v234, v234, v232
    v_accvgpr_write_b32 a12, v234
    v_accvgpr_read_b32 v235, a13
    v_mul_f32 v235, v235, v232
    v_accvgpr_write_b32 a13, v235
    v_accvgpr_read_b32 v236, a14
    v_mul_f32 v236, v236, v232
    v_accvgpr_write_b32 a14, v236
    v_accvgpr_read_b32 v237, a15
    v_mul_f32 v237, v237, v232
    v_accvgpr_write_b32 a15, v237
    v_accvgpr_read_b32 v234, a16
    v_mul_f32 v234, v234, v232
    v_accvgpr_write_b32 a16, v234
    v_accvgpr_read_b32 v235, a17
    v_mul_f32 v235, v235, v232
    v_accvgpr_write_b32 a17, v235
    v_accvgpr_read_b32 v236, a18
    v_mul_f32 v236, v236, v232
    v_accvgpr_write_b32 a18, v236
    v_accvgpr_read_b32 v237, a19
    v_mul_f32 v237, v237, v232
    v_accvgpr_write_b32 a19, v237
    v_accvgpr_read_b32 v234, a20
    v_mul_f32 v234, v234, v232
    v_accvgpr_write_b32 a20, v234
    v_accvgpr_read_b32 v235, a21
    v_mul_f32 v235, v235, v232
    v_accvgpr_write_b32 a21, v235
    v_accvgpr_read_b32 v236, a22
    v_mul_f32 v236, v236, v232
    v_accvgpr_write_b32 a22, v236
    v_accvgpr_read_b32 v237, a23
    v_mul_f32 v237, v237, v232
    v_accvgpr_write_b32 a23, v237
    v_accvgpr_read_b32 v234, a24
    v_mul_f32 v234, v234, v232
    v_accvgpr_write_b32 a24, v234
    v_accvgpr_read_b32 v235, a25
    v_mul_f32 v235, v235, v232
    v_accvgpr_write_b32 a25, v235
    v_accvgpr_read_b32 v236, a26
    v_mul_f32 v236, v236, v232
    v_accvgpr_write_b32 a26, v236
    v_accvgpr_read_b32 v237, a27
    v_mul_f32 v237, v237, v232
    v_accvgpr_write_b32 a27, v237
    v_accvgpr_read_b32 v234, a28
    v_mul_f32 v234, v234, v232
    v_accvgpr_write_b32 a28, v234
    v_accvgpr_read_b32 v235, a29
    v_mul_f32 v235, v235, v232
    v_accvgpr_write_b32 a29, v235
    v_accvgpr_read_b32 v236, a30
    v_mul_f32 v236, v236, v232
    v_accvgpr_write_b32 a30, v236
    v_accvgpr_read_b32 v237, a31
    v_mul_f32 v237, v237, v232
    v_accvgpr_write_b32 a31, v237
    v_accvgpr_read_b32 v234, a32
    v_mul_f32 v234, v234, v232
    v_accvgpr_write_b32 a32, v234
    v_accvgpr_read_b32 v235, a33
    v_mul_f32 v235, v235, v232
    v_accvgpr_write_b32 a33, v235
    v_accvgpr_read_b32 v236, a34
    v_mul_f32 v236, v236, v232
    v_accvgpr_write_b32 a34, v236
    v_accvgpr_read_b32 v237, a35
    v_mul_f32 v237, v237, v232
    v_accvgpr_write_b32 a35, v237
    v_accvgpr_read_b32 v234, a36
    v_mul_f32 v234, v234, v232
    v_accvgpr_write_b32 a36, v234
    v_accvgpr_read_b32 v235, a37
    v_mul_f32 v235, v235, v232
    v_accvgpr_write_b32 a37, v235
    v_accvgpr_read_b32 v236, a38
    v_mul_f32 v236, v236, v232
    v_accvgpr_write_b32 a38, v236
    v_accvgpr_read_b32 v237, a39
    v_mul_f32 v237, v237, v232
    v_accvgpr_write_b32 a39, v237
    v_accvgpr_read_b32 v234, a40
    v_mul_f32 v234, v234, v232
    v_accvgpr_write_b32 a40, v234
    v_accvgpr_read_b32 v235, a41
    v_mul_f32 v235, v235, v232
    v_accvgpr_write_b32 a41, v235
    v_accvgpr_read_b32 v236, a42
    v_mul_f32 v236, v236, v232
    v_accvgpr_write_b32 a42, v236
    v_accvgpr_read_b32 v237, a43
    v_mul_f32 v237, v237, v232
    v_accvgpr_write_b32 a43, v237
    v_accvgpr_read_b32 v234, a44
    v_mul_f32 v234, v234, v232
    v_accvgpr_write_b32 a44, v234
    v_accvgpr_read_b32 v235, a45
    v_mul_f32 v235, v235, v232
    v_accvgpr_write_b32 a45, v235
    v_accvgpr_read_b32 v236, a46
    v_mul_f32 v236, v236, v232
    v_accvgpr_write_b32 a46, v236
    v_accvgpr_read_b32 v237, a47
    v_mul_f32 v237, v237, v232
    v_accvgpr_write_b32 a47, v237
    v_accvgpr_read_b32 v234, a48
    v_mul_f32 v234, v234, v232
    v_accvgpr_write_b32 a48, v234
    v_accvgpr_read_b32 v235, a49
    v_mul_f32 v235, v235, v232
    v_accvgpr_write_b32 a49, v235
    v_accvgpr_read_b32 v236, a50
    v_mul_f32 v236, v236, v232
    v_accvgpr_write_b32 a50, v236
    v_accvgpr_read_b32 v237, a51
    v_mul_f32 v237, v237, v232
    v_accvgpr_write_b32 a51, v237
    v_accvgpr_read_b32 v234, a52
    v_mul_f32 v234, v234, v232
    v_accvgpr_write_b32 a52, v234
    v_accvgpr_read_b32 v235, a53
    v_mul_f32 v235, v235, v232
    v_accvgpr_write_b32 a53, v235
    v_accvgpr_read_b32 v236, a54
    v_mul_f32 v236, v236, v232
    v_accvgpr_write_b32 a54, v236
    v_accvgpr_read_b32 v237, a55
    v_mul_f32 v237, v237, v232
    v_accvgpr_write_b32 a55, v237
    v_accvgpr_read_b32 v234, a56
    v_mul_f32 v234, v234, v232
    v_accvgpr_write_b32 a56, v234
    v_accvgpr_read_b32 v235, a57
    v_mul_f32 v235, v235, v232
    v_accvgpr_write_b32 a57, v235
    v_accvgpr_read_b32 v236, a58
    v_mul_f32 v236, v236, v232
    v_accvgpr_write_b32 a58, v236
    v_accvgpr_read_b32 v237, a59
    v_mul_f32 v237, v237, v232
    v_accvgpr_write_b32 a59, v237
    v_accvgpr_read_b32 v234, a60
    v_mul_f32 v234, v234, v232
    v_accvgpr_write_b32 a60, v234
    v_accvgpr_read_b32 v235, a61
    v_mul_f32 v235, v235, v232
    v_accvgpr_write_b32 a61, v235
    v_accvgpr_read_b32 v236, a62
    v_mul_f32 v236, v236, v232
    v_accvgpr_write_b32 a62, v236
    v_accvgpr_read_b32 v237, a63
    v_mul_f32 v237, v237, v232
    v_accvgpr_write_b32 a63, v237
    v_exp_f32 v136, v0
    v_exp_f32 v137, v1
    v_exp_f32 v130, v2
    v_exp_f32 v131, v3
    v_cvt_pk_bf16_f32 v96, v136, v137
    v_exp_f32 v132, v4
    v_exp_f32 v133, v5
    v_cvt_pk_bf16_f32 v97, v130, v131
    v_add_f32 v136, v136, v130
    v_add_f32 v137, v137, v131
    v_exp_f32 v134, v6
    v_exp_f32 v135, v7
    v_cvt_pk_bf16_f32 v98, v132, v133
    v_add_f32 v136, v136, v132
    v_add_f32 v137, v137, v133
    v_exp_f32 v128, v8
    v_exp_f32 v129, v9
    v_cvt_pk_bf16_f32 v99, v134, v135
    v_add_f32 v136, v136, v134
    v_add_f32 v137, v137, v135
    v_exp_f32 v130, v10
    v_exp_f32 v131, v11
    v_cvt_pk_bf16_f32 v100, v128, v129
    v_add_f32 v136, v136, v128
    v_add_f32 v137, v137, v129
    v_exp_f32 v132, v12
    v_exp_f32 v133, v13
    v_cvt_pk_bf16_f32 v101, v130, v131
    v_add_f32 v136, v136, v130
    v_add_f32 v137, v137, v131
    v_exp_f32 v134, v14
    v_exp_f32 v135, v15
    v_cvt_pk_bf16_f32 v102, v132, v133
    v_add_f32 v136, v136, v132
    v_add_f32 v137, v137, v133
    v_cvt_pk_bf16_f32 v103, v134, v135
    v_add_f32 v136, v136, v134
    v_add_f32 v137, v137, v135
    v_add_f32 v224, v136, v137
    v_max3_f32 v230, v16, v17, v18
    v_max3_f32 v230, v230, v19, v20
    v_max3_f32 v230, v230, v21, v22
    v_max3_f32 v230, v230, v23, v24
    v_max3_f32 v230, v230, v25, v26
    v_max3_f32 v230, v230, v27, v28
    v_max3_f32 v230, v230, v29, v30
    v_max_f32 v230, v230, v31
    v_mov_b32 v231, v230
    s_nop 1
    v_permlane32_swap_b32 v230, v231
    s_nop 0
    v_max_f32 v230, v230, v231
    v_max_f32 v230, 0, v230
    v_sub_f32 v232, 0, v230
    v_exp_f32 v232, v232
    v_sub_f32 v229, v229, v230
    v_sub_f32 v80, v80, v230
    v_sub_f32 v48, v48, v230
    v_sub_f32 v16, v16, v230
    v_sub_f32 v81, v81, v230
    v_sub_f32 v49, v49, v230
    v_sub_f32 v17, v17, v230
    v_sub_f32 v82, v82, v230
    v_sub_f32 v50, v50, v230
    v_sub_f32 v18, v18, v230
    v_sub_f32 v83, v83, v230
    v_sub_f32 v51, v51, v230
    v_sub_f32 v19, v19, v230
    v_sub_f32 v84, v84, v230
    v_sub_f32 v52, v52, v230
    v_sub_f32 v20, v20, v230
    v_sub_f32 v85, v85, v230
    v_sub_f32 v53, v53, v230
    v_sub_f32 v21, v21, v230
    v_sub_f32 v86, v86, v230
    v_sub_f32 v54, v54, v230
    v_sub_f32 v22, v22, v230
    v_sub_f32 v87, v87, v230
    v_sub_f32 v55, v55, v230
    v_sub_f32 v23, v23, v230
    v_sub_f32 v88, v88, v230
    v_sub_f32 v56, v56, v230
    v_sub_f32 v24, v24, v230
    v_sub_f32 v89, v89, v230
    v_sub_f32 v57, v57, v230
    v_sub_f32 v25, v25, v230
    v_sub_f32 v90, v90, v230
    v_sub_f32 v58, v58, v230
    v_sub_f32 v26, v26, v230
    v_sub_f32 v91, v91, v230
    v_sub_f32 v59, v59, v230
    v_sub_f32 v27, v27, v230
    v_sub_f32 v92, v92, v230
    v_sub_f32 v60, v60, v230
    v_sub_f32 v28, v28, v230
    v_sub_f32 v93, v93, v230
    v_sub_f32 v61, v61, v230
    v_sub_f32 v29, v29, v230
    v_sub_f32 v94, v94, v230
    v_sub_f32 v62, v62, v230
    v_sub_f32 v30, v30, v230
    v_sub_f32 v95, v95, v230
    v_sub_f32 v63, v63, v230
    v_sub_f32 v31, v31, v230
    v_mul_f32 v227, v227, v232
    v_accvgpr_read_b32 v234, a64
    v_mul_f32 v234, v234, v232
    v_accvgpr_write_b32 a64, v234
    v_accvgpr_read_b32 v235, a65
    v_mul_f32 v235, v235, v232
    v_accvgpr_write_b32 a65, v235
    v_accvgpr_read_b32 v236, a66
    v_mul_f32 v236, v236, v232
    v_accvgpr_write_b32 a66, v236
    v_accvgpr_read_b32 v237, a67
    v_mul_f32 v237, v237, v232
    v_accvgpr_write_b32 a67, v237
    v_accvgpr_read_b32 v234, a68
    v_mul_f32 v234, v234, v232
    v_accvgpr_write_b32 a68, v234
    v_accvgpr_read_b32 v235, a69
    v_mul_f32 v235, v235, v232
    v_accvgpr_write_b32 a69, v235
    v_accvgpr_read_b32 v236, a70
    v_mul_f32 v236, v236, v232
    v_accvgpr_write_b32 a70, v236
    v_accvgpr_read_b32 v237, a71
    v_mul_f32 v237, v237, v232
    v_accvgpr_write_b32 a71, v237
    v_accvgpr_read_b32 v234, a72
    v_mul_f32 v234, v234, v232
    v_accvgpr_write_b32 a72, v234
    v_accvgpr_read_b32 v235, a73
    v_mul_f32 v235, v235, v232
    v_accvgpr_write_b32 a73, v235
    v_accvgpr_read_b32 v236, a74
    v_mul_f32 v236, v236, v232
    v_accvgpr_write_b32 a74, v236
    v_accvgpr_read_b32 v237, a75
    v_mul_f32 v237, v237, v232
    v_accvgpr_write_b32 a75, v237
    v_accvgpr_read_b32 v234, a76
    v_mul_f32 v234, v234, v232
    v_accvgpr_write_b32 a76, v234
    v_accvgpr_read_b32 v235, a77
    v_mul_f32 v235, v235, v232
    v_accvgpr_write_b32 a77, v235
    v_accvgpr_read_b32 v236, a78
    v_mul_f32 v236, v236, v232
    v_accvgpr_write_b32 a78, v236
    v_accvgpr_read_b32 v237, a79
    v_mul_f32 v237, v237, v232
    v_accvgpr_write_b32 a79, v237
    v_accvgpr_read_b32 v234, a80
    v_mul_f32 v234, v234, v232
    v_accvgpr_write_b32 a80, v234
    v_accvgpr_read_b32 v235, a81
    v_mul_f32 v235, v235, v232
    v_accvgpr_write_b32 a81, v235
    v_accvgpr_read_b32 v236, a82
    v_mul_f32 v236, v236, v232
    v_accvgpr_write_b32 a82, v236
    v_accvgpr_read_b32 v237, a83
    v_mul_f32 v237, v237, v232
    v_accvgpr_write_b32 a83, v237
    v_accvgpr_read_b32 v234, a84
    v_mul_f32 v234, v234, v232
    v_accvgpr_write_b32 a84, v234
    v_accvgpr_read_b32 v235, a85
    v_mul_f32 v235, v235, v232
    v_accvgpr_write_b32 a85, v235
    v_accvgpr_read_b32 v236, a86
    v_mul_f32 v236, v236, v232
    v_accvgpr_write_b32 a86, v236
    v_accvgpr_read_b32 v237, a87
    v_mul_f32 v237, v237, v232
    v_accvgpr_write_b32 a87, v237
    v_accvgpr_read_b32 v234, a88
    v_mul_f32 v234, v234, v232
    v_accvgpr_write_b32 a88, v234
    v_accvgpr_read_b32 v235, a89
    v_mul_f32 v235, v235, v232
    v_accvgpr_write_b32 a89, v235
    v_accvgpr_read_b32 v236, a90
    v_mul_f32 v236, v236, v232
    v_accvgpr_write_b32 a90, v236
    v_accvgpr_read_b32 v237, a91
    v_mul_f32 v237, v237, v232
    v_accvgpr_write_b32 a91, v237
    v_accvgpr_read_b32 v234, a92
    v_mul_f32 v234, v234, v232
    v_accvgpr_write_b32 a92, v234
    v_accvgpr_read_b32 v235, a93
    v_mul_f32 v235, v235, v232
    v_accvgpr_write_b32 a93, v235
    v_accvgpr_read_b32 v236, a94
    v_mul_f32 v236, v236, v232
    v_accvgpr_write_b32 a94, v236
    v_accvgpr_read_b32 v237, a95
    v_mul_f32 v237, v237, v232
    v_accvgpr_write_b32 a95, v237
    v_accvgpr_read_b32 v234, a96
    v_mul_f32 v234, v234, v232
    v_accvgpr_write_b32 a96, v234
    v_accvgpr_read_b32 v235, a97
    v_mul_f32 v235, v235, v232
    v_accvgpr_write_b32 a97, v235
    v_accvgpr_read_b32 v236, a98
    v_mul_f32 v236, v236, v232
    v_accvgpr_write_b32 a98, v236
    v_accvgpr_read_b32 v237, a99
    v_mul_f32 v237, v237, v232
    v_accvgpr_write_b32 a99, v237
    v_accvgpr_read_b32 v234, a100
    v_mul_f32 v234, v234, v232
    v_accvgpr_write_b32 a100, v234
    v_accvgpr_read_b32 v235, a101
    v_mul_f32 v235, v235, v232
    v_accvgpr_write_b32 a101, v235
    v_accvgpr_read_b32 v236, a102
    v_mul_f32 v236, v236, v232
    v_accvgpr_write_b32 a102, v236
    v_accvgpr_read_b32 v237, a103
    v_mul_f32 v237, v237, v232
    v_accvgpr_write_b32 a103, v237
    v_accvgpr_read_b32 v234, a104
    v_mul_f32 v234, v234, v232
    v_accvgpr_write_b32 a104, v234
    v_accvgpr_read_b32 v235, a105
    v_mul_f32 v235, v235, v232
    v_accvgpr_write_b32 a105, v235
    v_accvgpr_read_b32 v236, a106
    v_mul_f32 v236, v236, v232
    v_accvgpr_write_b32 a106, v236
    v_accvgpr_read_b32 v237, a107
    v_mul_f32 v237, v237, v232
    v_accvgpr_write_b32 a107, v237
    v_accvgpr_read_b32 v234, a108
    v_mul_f32 v234, v234, v232
    v_accvgpr_write_b32 a108, v234
    v_accvgpr_read_b32 v235, a109
    v_mul_f32 v235, v235, v232
    v_accvgpr_write_b32 a109, v235
    v_accvgpr_read_b32 v236, a110
    v_mul_f32 v236, v236, v232
    v_accvgpr_write_b32 a110, v236
    v_accvgpr_read_b32 v237, a111
    v_mul_f32 v237, v237, v232
    v_accvgpr_write_b32 a111, v237
    v_accvgpr_read_b32 v234, a112
    v_mul_f32 v234, v234, v232
    v_accvgpr_write_b32 a112, v234
    v_accvgpr_read_b32 v235, a113
    v_mul_f32 v235, v235, v232
    v_accvgpr_write_b32 a113, v235
    v_accvgpr_read_b32 v236, a114
    v_mul_f32 v236, v236, v232
    v_accvgpr_write_b32 a114, v236
    v_accvgpr_read_b32 v237, a115
    v_mul_f32 v237, v237, v232
    v_accvgpr_write_b32 a115, v237
    v_accvgpr_read_b32 v234, a116
    v_mul_f32 v234, v234, v232
    v_accvgpr_write_b32 a116, v234
    v_accvgpr_read_b32 v235, a117
    v_mul_f32 v235, v235, v232
    v_accvgpr_write_b32 a117, v235
    v_accvgpr_read_b32 v236, a118
    v_mul_f32 v236, v236, v232
    v_accvgpr_write_b32 a118, v236
    v_accvgpr_read_b32 v237, a119
    v_mul_f32 v237, v237, v232
    v_accvgpr_write_b32 a119, v237
    v_accvgpr_read_b32 v234, a120
    v_mul_f32 v234, v234, v232
    v_accvgpr_write_b32 a120, v234
    v_accvgpr_read_b32 v235, a121
    v_mul_f32 v235, v235, v232
    v_accvgpr_write_b32 a121, v235
    v_accvgpr_read_b32 v236, a122
    v_mul_f32 v236, v236, v232
    v_accvgpr_write_b32 a122, v236
    v_accvgpr_read_b32 v237, a123
    v_mul_f32 v237, v237, v232
    v_accvgpr_write_b32 a123, v237
    v_accvgpr_read_b32 v234, a124
    v_mul_f32 v234, v234, v232
    v_accvgpr_write_b32 a124, v234
    v_accvgpr_read_b32 v235, a125
    v_mul_f32 v235, v235, v232
    v_accvgpr_write_b32 a125, v235
    v_accvgpr_read_b32 v236, a126
    v_mul_f32 v236, v236, v232
    v_accvgpr_write_b32 a126, v236
    v_accvgpr_read_b32 v237, a127
    v_mul_f32 v237, v237, v232
    v_accvgpr_write_b32 a127, v237
    v_exp_f32 v138, v16
    v_exp_f32 v139, v17
    v_exp_f32 v130, v18
    v_exp_f32 v131, v19
    v_cvt_pk_bf16_f32 v104, v138, v139
    v_exp_f32 v132, v20
    v_exp_f32 v133, v21
    v_cvt_pk_bf16_f32 v105, v130, v131
    v_add_f32 v138, v138, v130
    v_add_f32 v139, v139, v131
    v_exp_f32 v134, v22
    v_exp_f32 v135, v23
    v_cvt_pk_bf16_f32 v106, v132, v133
    v_add_f32 v138, v138, v132
    v_add_f32 v139, v139, v133
    v_exp_f32 v128, v24
    v_exp_f32 v129, v25
    v_cvt_pk_bf16_f32 v107, v134, v135
    v_add_f32 v138, v138, v134
    v_add_f32 v139, v139, v135
    v_exp_f32 v130, v26
    v_exp_f32 v131, v27
    v_cvt_pk_bf16_f32 v108, v128, v129
    v_add_f32 v138, v138, v128
    v_add_f32 v139, v139, v129
    v_exp_f32 v132, v28
    v_exp_f32 v133, v29
    v_cvt_pk_bf16_f32 v109, v130, v131
    v_add_f32 v138, v138, v130
    v_add_f32 v139, v139, v131
    v_exp_f32 v134, v30
    v_exp_f32 v135, v31
    v_cvt_pk_bf16_f32 v110, v132, v133
    v_add_f32 v138, v138, v132
    v_add_f32 v139, v139, v133
    v_cvt_pk_bf16_f32 v111, v134, v135
    v_add_f32 v138, v138, v134
    v_add_f32 v139, v139, v135
    v_add_f32 v225, v138, v139
    s_nop 1
    s_branch kf_rr15
kf_l2p17:
    buffer_load_dword v252, v251, s[56:59], s28 offen
    s_add_u32 s28, s28, 2048
    buffer_store_dwordx4 v[200:203], v240, s[8:11], s29 offen sc1
    s_add_u32 s29, s29, 1024
    s_cmp_lt_u32 s29, s30
    s_cselect_b32 s27, 0, 0x1000
    s_branch kf_l2r18
kf_fix19:
    s_cmp_eq_u32 s33, 0
    s_cselect_b32 s24, 0, 0x74000000
    s_cselect_b32 s36, 0, 0x1000
    s_mov_b32 s33, 1
    v_subrev_f32 v230, s24, v243
    v_add_f32 v231, 0, v230
    v_min_f32 v80, v229, v231
    v_add_f32 v232, 0xf1800000, v230
    v_min_f32 v81, v229, v232
    v_add_f32 v231, 0xf2000000, v230
    v_min_f32 v82, v229, v231
    v_add_f32 v232, 0xf2400000, v230
    v_min_f32 v83, v229, v232
    v_add_f32 v231, 0xf3000000, v230
    v_min_f32 v84, v229, v231
    v_add_f32 v232, 0xf3100000, v230
    v_min_f32 v85, v229, v232
    v_add_f32 v231, 0xf3200000, v230
    v_min_f32 v86, v229, v231
    v_add_f32 v232, 0xf3300000, v230
    v_min_f32 v87, v229, v232
    v_add_f32 v231, 0xf3800000, v230
    v_min_f32 v88, v229, v231
    v_add_f32 v232, 0xf3880000, v230
    v_min_f32 v89, v229, v232
    v_add_f32 v231, 0xf3900000, v230
    v_min_f32 v90, v229, v231
    v_add_f32 v232, 0xf3980000, v230
    v_min_f32 v91, v229, v232
    v_add_f32 v231, 0xf3c00000, v230
    v_min_f32 v92, v229, v231
    v_add_f32 v232, 0xf3c80000, v230
    v_min_f32 v93, v229, v232
    v_add_f32 v231, 0xf3d00000, v230
    v_min_f32 v94, v229, v231
    v_add_f32 v232, 0xf3d80000, v230
    v_min_f32 v95, v229, v232
    s_nop 1
    s_branch kf_fixr20
kf_rare22:
    s_nop 15
    v_max3_f32 v230, v32, v33, v34
    v_max3_f32 v230, v230, v35, v36
    v_max3_f32 v230, v230, v37, v38
    v_max3_f32 v230, v230, v39, v40
    v_max3_f32 v230, v230, v41, v42
    v_max3_f32 v230, v230, v43, v44
    v_max3_f32 v230, v230, v45, v46
    v_max_f32 v230, v230, v47
    v_mov_b32 v231, v230
    s_nop 1
    v_permlane32_swap_b32 v230, v231
    s_nop 0
    v_max_f32 v230, v230, v231
    v_max_f32 v230, 0, v230
    v_sub_f32 v232, 0, v230
    v_exp_f32 v232, v232
    v_sub_f32 v228, v228, v230
    v_sub_f32 v64, v64, v230
    v_sub_f32 v0, v0, v230
    v_sub_f32 v32, v32, v230
    v_sub_f32 v65, v65, v230
    v_sub_f32 v1, v1, v230
    v_sub_f32 v33, v33, v230
    v_sub_f32 v66, v66, v230
    v_sub_f32 v2, v2, v230
    v_sub_f32 v34, v34, v230
    v_sub_f32 v67, v67, v230
    v_sub_f32 v3, v3, v230
    v_sub_f32 v35, v35, v230
    v_sub_f32 v68, v68, v230
    v_sub_f32 v4, v4, v230
    v_sub_f32 v36, v36, v230
    v_sub_f32 v69, v69, v230
    v_sub_f32 v5, v5, v230
    v_sub_f32 v37, v37, v230
    v_sub_f32 v70, v70, v230
    v_sub_f32 v6, v6, v230
    v_sub_f32 v38, v38, v230
    v_sub_f32 v71, v71, v230
    v_sub_f32 v7, v7, v230
    v_sub_f32 v39, v39, v230
    v_sub_f32 v72, v72, v230
    v_sub_f32 v8, v8, v230
    v_sub_f32 v40, v40, v230
    v_sub_f32 v73, v73, v230
    v_sub_f32 v9, v9, v230
    v_sub_f32 v41, v41, v230
    v_sub_f32 v74, v74, v230
    v_sub_f32 v10, v10, v230
    v_sub_f32 v42, v42, v230
    v_sub_f32 v75, v75, v230
    v_sub_f32 v11, v11, v230
    v_sub_f32 v43, v43, v230
    v_sub_f32 v76, v76, v230
    v_sub_f32 v12, v12, v230
    v_sub_f32 v44, v44, v230
    v_sub_f32 v77, v77, v230
    v_sub_f32 v13, v13, v230
    v_sub_f32 v45, v45, v230
    v_sub_f32 v78, v78, v230
    v_sub_f32 v14, v14, v230
    v_sub_f32 v46, v46, v230
    v_sub_f32 v79, v79, v230
    v_sub_f32 v15, v15, v230
    v_sub_f32 v47, v47, v230
    v_mul_f32 v226, v226, v232
    v_accvgpr_read_b32 v234, a0
    v_mul_f32 v234, v234, v232
    v_accvgpr_write_b32 a0, v234
    v_accvgpr_read_b32 v235, a1
    v_mul_f32 v235, v235, v232
    v_accvgpr_write_b32 a1, v235
    v_accvgpr_read_b32 v236, a2
    v_mul_f32 v236, v236, v232
    v_accvgpr_write_b32 a2, v236
    v_accvgpr_read_b32 v237, a3
    v_mul_f32 v237, v237, v232
    v_accvgpr_write_b32 a3, v237
    v_accvgpr_read_b32 v234, a4
    v_mul_f32 v234, v234, v232
    v_accvgpr_write_b32 a4, v234
    v_accvgpr_read_b32 v235, a5
    v_mul_f32 v235, v235, v232
    v_accvgpr_write_b32 a5, v235
    v_accvgpr_read_b32 v236, a6
    v_mul_f32 v236, v236, v232
    v_accvgpr_write_b32 a6, v236
    v_accvgpr_read_b32 v237, a7
    v_mul_f32 v237, v237, v232
    v_accvgpr_write_b32 a7, v237
    v_accvgpr_read_b32 v234, a8
    v_mul_f32 v234, v234, v232
    v_accvgpr_write_b32 a8, v234
    v_accvgpr_read_b32 v235, a9
    v_mul_f32 v235, v235, v232
    v_accvgpr_write_b32 a9, v235
    v_accvgpr_read_b32 v236, a10
    v_mul_f32 v236, v236, v232
    v_accvgpr_write_b32 a10, v236
    v_accvgpr_read_b32 v237, a11
    v_mul_f32 v237, v237, v232
    v_accvgpr_write_b32 a11, v237
    v_accvgpr_read_b32 v234, a12
    v_mul_f32 v234, v234, v232
    v_accvgpr_write_b32 a12, v234
    v_accvgpr_read_b32 v235, a13
    v_mul_f32 v235, v235, v232
    v_accvgpr_write_b32 a13, v235
    v_accvgpr_read_b32 v236, a14
    v_mul_f32 v236, v236, v232
    v_accvgpr_write_b32 a14, v236
    v_accvgpr_read_b32 v237, a15
    v_mul_f32 v237, v237, v232
    v_accvgpr_write_b32 a15, v237
    v_accvgpr_read_b32 v234, a16
    v_mul_f32 v234, v234, v232
    v_accvgpr_write_b32 a16, v234
    v_accvgpr_read_b32 v235, a17
    v_mul_f32 v235, v235, v232
    v_accvgpr_write_b32 a17, v235
    v_accvgpr_read_b32 v236, a18
    v_mul_f32 v236, v236, v232
    v_accvgpr_write_b32 a18, v236
    v_accvgpr_read_b32 v237, a19
    v_mul_f32 v237, v237, v232
    v_accvgpr_write_b32 a19, v237
    v_accvgpr_read_b32 v234, a20
    v_mul_f32 v234, v234, v232
    v_accvgpr_write_b32 a20, v234
    v_accvgpr_read_b32 v235, a21
    v_mul_f32 v235, v235, v232
    v_accvgpr_write_b32 a21, v235
    v_accvgpr_read_b32 v236, a22
    v_mul_f32 v236, v236, v232
    v_accvgpr_write_b32 a22, v236
    v_accvgpr_read_b32 v237, a23
    v_mul_f32 v237, v237, v232
    v_accvgpr_write_b32 a23, v237
    v_accvgpr_read_b32 v234, a24
    v_mul_f32 v234, v234, v232
    v_accvgpr_write_b32 a24, v234
    v_accvgpr_read_b32 v235, a25
    v_mul_f32 v235, v235, v232
    v_accvgpr_write_b32 a25, v235
    v_accvgpr_read_b32 v236, a26
    v_mul_f32 v236, v236, v232
    v_accvgpr_write_b32 a26, v236
    v_accvgpr_read_b32 v237, a27
    v_mul_f32 v237, v237, v232
    v_accvgpr_write_b32 a27, v237
    v_accvgpr_read_b32 v234, a28
    v_mul_f32 v234, v234, v232
    v_accvgpr_write_b32 a28, v234
    v_accvgpr_read_b32 v235, a29
    v_mul_f32 v235, v235, v232
    v_accvgpr_write_b32 a29, v235
    v_accvgpr_read_b32 v236, a30
    v_mul_f32 v236, v236, v232
    v_accvgpr_write_b32 a30, v236
    v_accvgpr_read_b32 v237, a31
    v_mul_f32 v237, v237, v232
    v_accvgpr_write_b32 a31, v237
    v_accvgpr_read_b32 v234, a32
    v_mul_f32 v234, v234, v232
    v_accvgpr_write_b32 a32, v234
    v_accvgpr_read_b32 v235, a33
    v_mul_f32 v235, v235, v232
    v_accvgpr_write_b32 a33, v235
    v_accvgpr_read_b32 v236, a34
    v_mul_f32 v236, v236, v232
    v_accvgpr_write_b32 a34, v236
    v_accvgpr_read_b32 v237, a35
    v_mul_f32 v237, v237, v232
    v_accvgpr_write_b32 a35, v237
    v_accvgpr_read_b32 v234, a36
    v_mul_f32 v234, v234, v232
    v_accvgpr_write_b32 a36, v234
    v_accvgpr_read_b32 v235, a37
    v_mul_f32 v235, v235, v232
    v_accvgpr_write_b32 a37, v235
    v_accvgpr_read_b32 v236, a38
    v_mul_f32 v236, v236, v232
    v_accvgpr_write_b32 a38, v236
    v_accvgpr_read_b32 v237, a39
    v_mul_f32 v237, v237, v232
    v_accvgpr_write_b32 a39, v237
    v_accvgpr_read_b32 v234, a40
    v_mul_f32 v234, v234, v232
    v_accvgpr_write_b32 a40, v234
    v_accvgpr_read_b32 v235, a41
    v_mul_f32 v235, v235, v232
    v_accvgpr_write_b32 a41, v235
    v_accvgpr_read_b32 v236, a42
    v_mul_f32 v236, v236, v232
    v_accvgpr_write_b32 a42, v236
    v_accvgpr_read_b32 v237, a43
    v_mul_f32 v237, v237, v232
    v_accvgpr_write_b32 a43, v237
    v_accvgpr_read_b32 v234, a44
    v_mul_f32 v234, v234, v232
    v_accvgpr_write_b32 a44, v234
    v_accvgpr_read_b32 v235, a45
    v_mul_f32 v235, v235, v232
    v_accvgpr_write_b32 a45, v235
    v_accvgpr_read_b32 v236, a46
    v_mul_f32 v236, v236, v232
    v_accvgpr_write_b32 a46, v236
    v_accvgpr_read_b32 v237, a47
    v_mul_f32 v237, v237, v232
    v_accvgpr_write_b32 a47, v237
    v_accvgpr_read_b32 v234, a48
    v_mul_f32 v234, v234, v232
    v_accvgpr_write_b32 a48, v234
    v_accvgpr_read_b32 v235, a49
    v_mul_f32 v235, v235, v232
    v_accvgpr_write_b32 a49, v235
    v_accvgpr_read_b32 v236, a50
    v_mul_f32 v236, v236, v232
    v_accvgpr_write_b32 a50, v236
    v_accvgpr_read_b32 v237, a51
    v_mul_f32 v237, v237, v232
    v_accvgpr_write_b32 a51, v237
    v_accvgpr_read_b32 v234, a52
    v_mul_f32 v234, v234, v232
    v_accvgpr_write_b32 a52, v234
    v_accvgpr_read_b32 v235, a53
    v_mul_f32 v235, v235, v232
    v_accvgpr_write_b32 a53, v235
    v_accvgpr_read_b32 v236, a54
    v_mul_f32 v236, v236, v232
    v_accvgpr_write_b32 a54, v236
    v_accvgpr_read_b32 v237, a55
    v_mul_f32 v237, v237, v232
    v_accvgpr_write_b32 a55, v237
    v_accvgpr_read_b32 v234, a56
    v_mul_f32 v234, v234, v232
    v_accvgpr_write_b32 a56, v234
    v_accvgpr_read_b32 v235, a57
    v_mul_f32 v235, v235, v232
    v_accvgpr_write_b32 a57, v235
    v_accvgpr_read_b32 v236, a58
    v_mul_f32 v236, v236, v232
    v_accvgpr_write_b32 a58, v236
    v_accvgpr_read_b32 v237, a59
    v_mul_f32 v237, v237, v232
    v_accvgpr_write_b32 a59, v237
    v_accvgpr_read_b32 v234, a60
    v_mul_f32 v234, v234, v232
    v_accvgpr_write_b32 a60, v234
    v_accvgpr_read_b32 v235, a61
    v_mul_f32 v235, v235, v232
    v_accvgpr_write_b32 a61, v235
    v_accvgpr_read_b32 v236, a62
    v_mul_f32 v236, v236, v232
    v_accvgpr_write_b32 a62, v236
    v_accvgpr_read_b32 v237, a63
    v_mul_f32 v237, v237, v232
    v_accvgpr_write_b32 a63, v237
    v_exp_f32 v136, v32
    v_exp_f32 v137, v33
    v_exp_f32 v130, v34
    v_exp_f32 v131, v35
    v_cvt_pk_bf16_f32 v112, v136, v137
    v_exp_f32 v132, v36
    v_exp_f32 v133, v37
    v_cvt_pk_bf16_f32 v113, v130, v131
    v_add_f32 v136, v136, v130
    v_add_f32 v137, v137, v131
    v_exp_f32 v134, v38
    v_exp_f32 v135, v39
    v_cvt_pk_bf16_f32 v114, v132, v133
    v_add_f32 v136, v136, v132
    v_add_f32 v137, v137, v133
    v_exp_f32 v128, v40
    v_exp_f32 v129, v41
    v_cvt_pk_bf16_f32 v115, v134, v135
    v_add_f32 v136, v136, v134
    v_add_f32 v137, v137, v135
    v_exp_f32 v130, v42
    v_exp_f32 v131, v43
    v_cvt_pk_bf16_f32 v116, v128, v129
    v_add_f32 v136, v136, v128
    v_add_f32 v137, v137, v129
    v_exp_f32 v132, v44
    v_exp_f32 v133, v45
    v_cvt_pk_bf16_f32 v117, v130, v131
    v_add_f32 v136, v136, v130
    v_add_f32 v137, v137, v131
    v_exp_f32 v134, v46
    v_exp_f32 v135, v47
    v_cvt_pk_bf16_f32 v118, v132, v133
    v_add_f32 v136, v136, v132
    v_add_f32 v137, v137, v133
    v_cvt_pk_bf16_f32 v119, v134, v135
    v_add_f32 v136, v136, v134
    v_add_f32 v137, v137, v135
    v_add_f32 v224, v136, v137
    v_max3_f32 v230, v48, v49, v50
    v_max3_f32 v230, v230, v51, v52
    v_max3_f32 v230, v230, v53, v54
    v_max3_f32 v230, v230, v55, v56
    v_max3_f32 v230, v230, v57, v58
    v_max3_f32 v230, v230, v59, v60
    v_max3_f32 v230, v230, v61, v62
    v_max_f32 v230, v230, v63
    v_mov_b32 v231, v230
    s_nop 1
    v_permlane32_swap_b32 v230, v231
    s_nop 0
    v_max_f32 v230, v230, v231
    v_max_f32 v230, 0, v230
    v_sub_f32 v232, 0, v230
    v_exp_f32 v232, v232
    v_sub_f32 v229, v229, v230
    v_sub_f32 v80, v80, v230
    v_sub_f32 v16, v16, v230
    v_sub_f32 v48, v48, v230
    v_sub_f32 v81, v81, v230
    v_sub_f32 v17, v17, v230
    v_sub_f32 v49, v49, v230
    v_sub_f32 v82, v82, v230
    v_sub_f32 v18, v18, v230
    v_sub_f32 v50, v50, v230
    v_sub_f32 v83, v83, v230
    v_sub_f32 v19, v19, v230
    v_sub_f32 v51, v51, v230
    v_sub_f32 v84, v84, v230
    v_sub_f32 v20, v20, v230
    v_sub_f32 v52, v52, v230
    v_sub_f32 v85, v85, v230
    v_sub_f32 v21, v21, v230
    v_sub_f32 v53, v53, v230
    v_sub_f32 v86, v86, v230
    v_sub_f32 v22, v22, v230
    v_sub_f32 v54, v54, v230
    v_sub_f32 v87, v87, v230
    v_sub_f32 v23, v23, v230
    v_sub_f32 v55, v55, v230
    v_sub_f32 v88, v88, v230
    v_sub_f32 v24, v24, v230
    v_sub_f32 v56, v56, v230
    v_sub_f32 v89, v89, v230
    v_sub_f32 v25, v25, v230
    v_sub_f32 v57, v57, v230
    v_sub_f32 v90, v90, v230
    v_sub_f32 v26, v26, v230
    v_sub_f32 v58, v58, v230
    v_sub_f32 v91, v91, v230
    v_sub_f32 v27, v27, v230
    v_sub_f32 v59, v59, v230
    v_sub_f32 v92, v92, v230
    v_sub_f32 v28, v28, v230
    v_sub_f32 v60, v60, v230
    v_sub_f32 v93, v93, v230
    v_sub_f32 v29, v29, v230
    v_sub_f32 v61, v61, v230
    v_sub_f32 v94, v94, v230
    v_sub_f32 v30, v30, v230
    v_sub_f32 v62, v62, v230
    v_sub_f32 v95, v95, v230
    v_sub_f32 v31, v31, v230
    v_sub_f32 v63, v63, v230
    v_mul_f32 v227, v227, v232
    v_accvgpr_read_b32 v234, a64
    v_mul_f32 v234, v234, v232
    v_accvgpr_write_b32 a64, v234
    v_accvgpr_read_b32 v235, a65
    v_mul_f32 v235, v235, v232
    v_accvgpr_write_b32 a65, v235
    v_accvgpr_read_b32 v236, a66
    v_mul_f32 v236, v236, v232
    v_accvgpr_write_b32 a66, v236
    v_accvgpr_read_b32 v237, a67
    v_mul_f32 v237, v237, v232
    v_accvgpr_write_b32 a67, v237
    v_accvgpr_read_b32 v234, a68
    v_mul_f32 v234, v234, v232
    v_accvgpr_write_b32 a68, v234
    v_accvgpr_read_b32 v235, a69
    v_mul_f32 v235, v235, v232
    v_accvgpr_write_b32 a69, v235
    v_accvgpr_read_b32 v236, a70
    v_mul_f32 v236, v236, v232
    v_accvgpr_write_b32 a70, v236
    v_accvgpr_read_b32 v237, a71
    v_mul_f32 v237, v237, v232
    v_accvgpr_write_b32 a71, v237
    v_accvgpr_read_b32 v234, a72
    v_mul_f32 v234, v234, v232
    v_accvgpr_write_b32 a72, v234
    v_accvgpr_read_b32 v235, a73
    v_mul_f32 v235, v235, v232
    v_accvgpr_write_b32 a73, v235
    v_accvgpr_read_b32 v236, a74
    v_mul_f32 v236, v236, v232
    v_accvgpr_write_b32 a74, v236
    v_accvgpr_read_b32 v237, a75
    v_mul_f32 v237, v237, v232
    v_accvgpr_write_b32 a75, v237
    v_accvgpr_read_b32 v234, a76
    v_mul_f32 v234, v234, v232
    v_accvgpr_write_b32 a76, v234
    v_accvgpr_read_b32 v235, a77
    v_mul_f32 v235, v235, v232
    v_accvgpr_write_b32 a77, v235
    v_accvgpr_read_b32 v236, a78
    v_mul_f32 v236, v236, v232
    v_accvgpr_write_b32 a78, v236
    v_accvgpr_read_b32 v237, a79
    v_mul_f32 v237, v237, v232
    v_accvgpr_write_b32 a79, v237
    v_accvgpr_read_b32 v234, a80
    v_mul_f32 v234, v234, v232
    v_accvgpr_write_b32 a80, v234
    v_accvgpr_read_b32 v235, a81
    v_mul_f32 v235, v235, v232
    v_accvgpr_write_b32 a81, v235
    v_accvgpr_read_b32 v236, a82
    v_mul_f32 v236, v236, v232
    v_accvgpr_write_b32 a82, v236
    v_accvgpr_read_b32 v237, a83
    v_mul_f32 v237, v237, v232
    v_accvgpr_write_b32 a83, v237
    v_accvgpr_read_b32 v234, a84
    v_mul_f32 v234, v234, v232
    v_accvgpr_write_b32 a84, v234
    v_accvgpr_read_b32 v235, a85
    v_mul_f32 v235, v235, v232
    v_accvgpr_write_b32 a85, v235
    v_accvgpr_read_b32 v236, a86
    v_mul_f32 v236, v236, v232
    v_accvgpr_write_b32 a86, v236
    v_accvgpr_read_b32 v237, a87
    v_mul_f32 v237, v237, v232
    v_accvgpr_write_b32 a87, v237
    v_accvgpr_read_b32 v234, a88
    v_mul_f32 v234, v234, v232
    v_accvgpr_write_b32 a88, v234
    v_accvgpr_read_b32 v235, a89
    v_mul_f32 v235, v235, v232
    v_accvgpr_write_b32 a89, v235
    v_accvgpr_read_b32 v236, a90
    v_mul_f32 v236, v236, v232
    v_accvgpr_write_b32 a90, v236
    v_accvgpr_read_b32 v237, a91
    v_mul_f32 v237, v237, v232
    v_accvgpr_write_b32 a91, v237
    v_accvgpr_read_b32 v234, a92
    v_mul_f32 v234, v234, v232
    v_accvgpr_write_b32 a92, v234
    v_accvgpr_read_b32 v235, a93
    v_mul_f32 v235, v235, v232
    v_accvgpr_write_b32 a93, v235
    v_accvgpr_read_b32 v236, a94
    v_mul_f32 v236, v236, v232
    v_accvgpr_write_b32 a94, v236
    v_accvgpr_read_b32 v237, a95
    v_mul_f32 v237, v237, v232
    v_accvgpr_write_b32 a95, v237
    v_accvgpr_read_b32 v234, a96
    v_mul_f32 v234, v234, v232
    v_accvgpr_write_b32 a96, v234
    v_accvgpr_read_b32 v235, a97
    v_mul_f32 v235, v235, v232
    v_accvgpr_write_b32 a97, v235
    v_accvgpr_read_b32 v236, a98
    v_mul_f32 v236, v236, v232
    v_accvgpr_write_b32 a98, v236
    v_accvgpr_read_b32 v237, a99
    v_mul_f32 v237, v237, v232
    v_accvgpr_write_b32 a99, v237
    v_accvgpr_read_b32 v234, a100
    v_mul_f32 v234, v234, v232
    v_accvgpr_write_b32 a100, v234
    v_accvgpr_read_b32 v235, a101
    v_mul_f32 v235, v235, v232
    v_accvgpr_write_b32 a101, v235
    v_accvgpr_read_b32 v236, a102
    v_mul_f32 v236, v236, v232
    v_accvgpr_write_b32 a102, v236
    v_accvgpr_read_b32 v237, a103
    v_mul_f32 v237, v237, v232
    v_accvgpr_write_b32 a103, v237
    v_accvgpr_read_b32 v234, a104
    v_mul_f32 v234, v234, v232
    v_accvgpr_write_b32 a104, v234
    v_accvgpr_read_b32 v235, a105
    v_mul_f32 v235, v235, v232
    v_accvgpr_write_b32 a105, v235
    v_accvgpr_read_b32 v236, a106
    v_mul_f32 v236, v236, v232
    v_accvgpr_write_b32 a106, v236
    v_accvgpr_read_b32 v237, a107
    v_mul_f32 v237, v237, v232
    v_accvgpr_write_b32 a107, v237
    v_accvgpr_read_b32 v234, a108
    v_mul_f32 v234, v234, v232
    v_accvgpr_write_b32 a108, v234
    v_accvgpr_read_b32 v235, a109
    v_mul_f32 v235, v235, v232
    v_accvgpr_write_b32 a109, v235
    v_accvgpr_read_b32 v236, a110
    v_mul_f32 v236, v236, v232
    v_accvgpr_write_b32 a110, v236
    v_accvgpr_read_b32 v237, a111
    v_mul_f32 v237, v237, v232
    v_accvgpr_write_b32 a111, v237
    v_accvgpr_read_b32 v234, a112
    v_mul_f32 v234, v234, v232
    v_accvgpr_write_b32 a112, v234
    v_accvgpr_read_b32 v235, a113
    v_mul_f32 v235, v235, v232
    v_accvgpr_write_b32 a113, v235
    v_accvgpr_read_b32 v236, a114
    v_mul_f32 v236, v236, v232
    v_accvgpr_write_b32 a114, v236
    v_accvgpr_read_b32 v237, a115
    v_mul_f32 v237, v237, v232
    v_accvgpr_write_b32 a115, v237
    v_accvgpr_read_b32 v234, a116
    v_mul_f32 v234, v234, v232
    v_accvgpr_write_b32 a116, v234
    v_accvgpr_read_b32 v235, a117
    v_mul_f32 v235, v235, v232
    v_accvgpr_write_b32 a117, v235
    v_accvgpr_read_b32 v236, a118
    v_mul_f32 v236, v236, v232
    v_accvgpr_write_b32 a118, v236
    v_accvgpr_read_b32 v237, a119
    v_mul_f32 v237, v237, v232
    v_accvgpr_write_b32 a119, v237
    v_accvgpr_read_b32 v234, a120
    v_mul_f32 v234, v234, v232
    v_accvgpr_write_b32 a120, v234
    v_accvgpr_read_b32 v235, a121
    v_mul_f32 v235, v235, v232
    v_accvgpr_write_b32 a121, v235
    v_accvgpr_read_b32 v236, a122
    v_mul_f32 v236, v236, v232
    v_accvgpr_write_b32 a122, v236
    v_accvgpr_read_b32 v237, a123
    v_mul_f32 v237, v237, v232
    v_accvgpr_write_b32 a123, v237
    v_accvgpr_read_b32 v234, a124
    v_mul_f32 v234, v234, v232
    v_accvgpr_write_b32 a124, v234
    v_accvgpr_read_b32 v235, a125
    v_mul_f32 v235, v235, v232
    v_accvgpr_write_b32 a125, v235
    v_accvgpr_read_b32 v236, a126
    v_mul_f32 v236, v236, v232
    v_accvgpr_write_b32 a126, v236
    v_accvgpr_read_b32 v237, a127
    v_mul_f32 v237, v237, v232
    v_accvgpr_write_b32 a127, v237
    v_exp_f32 v138, v48
    v_exp_f32 v139, v49
    v_exp_f32 v130, v50
    v_exp_f32 v131, v51
    v_cvt_pk_bf16_f32 v120, v138, v139
    v_exp_f32 v132, v52
    v_exp_f32 v133, v53
    v_cvt_pk_bf16_f32 v121, v130, v131
    v_add_f32 v138, v138, v130
    v_add_f32 v139, v139, v131
    v_exp_f32 v134, v54
    v_exp_f32 v135, v55
    v_cvt_pk_bf16_f32 v122, v132, v133
    v_add_f32 v138, v138, v132
    v_add_f32 v139, v139, v133
    v_exp_f32 v128, v56
    v_exp_f32 v129, v57
    v_cvt_pk_bf16_f32 v123, v134, v135
    v_add_f32 v138, v138, v134
    v_add_f32 v139, v139, v135
    v_exp_f32 v130, v58
    v_exp_f32 v131, v59
    v_cvt_pk_bf16_f32 v124, v128, v129
    v_add_f32 v138, v138, v128
    v_add_f32 v139, v139, v129
    v_exp_f32 v132, v60
    v_exp_f32 v133, v61
    v_cvt_pk_bf16_f32 v125, v130, v131
    v_add_f32 v138, v138, v130
    v_add_f32 v139, v139, v131
    v_exp_f32 v134, v62
    v_exp_f32 v135, v63
    v_cvt_pk_bf16_f32 v126, v132, v133
    v_add_f32 v138, v138, v132
    v_add_f32 v139, v139, v133
    v_cvt_pk_bf16_f32 v127, v134, v135
    v_add_f32 v138, v138, v134
    v_add_f32 v139, v139, v135
    v_add_f32 v225, v138, v139
    s_nop 1
    s_branch kf_rr21
kf_l2p23:
    buffer_load_dword v252, v251, s[56:59], s28 offen
    s_add_u32 s28, s28, 2048
    buffer_store_dwordx4 v[200:203], v240, s[8:11], s29 offen sc1
    s_add_u32 s29, s29, 1024
    s_cmp_lt_u32 s29, s30
    s_cselect_b32 s27, 0, 0x1000
    s_branch kf_l2r24
kf_fix25:
    s_cmp_eq_u32 s33, 0
    s_cselect_b32 s24, 0, 0x74000000
    s_cselect_b32 s36, 0, 0x1000
    s_mov_b32 s33, 1
    v_subrev_f32 v230, s24, v243
    v_add_f32 v231, 0, v230
    v_min_f32 v80, v229, v231
    v_add_f32 v232, 0xf1800000, v230
    v_min_f32 v81, v229, v232
    v_add_f32 v231, 0xf2000000, v230
    v_min_f32 v82, v229, v231
    v_add_f32 v232, 0xf2400000, v230
    v_min_f32 v83, v229, v232
    v_add_f32 v231, 0xf3000000, v230
    v_min_f32 v84, v229, v231
    v_add_f32 v232, 0xf3100000, v230
    v_min_f32 v85, v229, v232
    v_add_f32 v231, 0xf3200000, v230
    v_min_f32 v86, v229, v231
    v_add_f32 v232, 0xf3300000, v230
    v_min_f32 v87, v229, v232
    v_add_f32 v231, 0xf3800000, v230
    v_min_f32 v88, v229, v231
    v_add_f32 v232, 0xf3880000, v230
    v_min_f32 v89, v229, v232
    v_add_f32 v231, 0xf3900000, v230
    v_min_f32 v90, v229, v231
    v_add_f32 v232, 0xf3980000, v230
    v_min_f32 v91, v229, v232
    v_add_f32 v231, 0xf3c00000, v230
    v_min_f32 v92, v229, v231
    v_add_f32 v232, 0xf3c80000, v230
    v_min_f32 v93, v229, v232
    v_add_f32 v231, 0xf3d00000, v230
    v_min_f32 v94, v229, v231
    v_add_f32 v232, 0xf3d80000, v230
    v_min_f32 v95, v229, v232
    s_nop 1
    s_branch kf_fixr26
kf_rare28:
    s_nop 15
    v_max3_f32 v230, v16, v17, v18
    v_max3_f32 v230, v230, v19, v20
    v_max3_f32 v230, v230, v21, v22
    v_max3_f32 v230, v230, v23, v24
    v_max3_f32 v230, v230, v25, v26
    v_max3_f32 v230, v230, v27, v28
    v_max3_f32 v230, v230, v29, v30
    v_max_f32 v230, v230, v31
    v_mov_b32 v231, v230
    s_nop 1
    v_permlane32_swap_b32 v230, v231
    s_nop 0
    v_max_f32 v230, v230, v231
    v_max_f32 v230, 0, v230
    v_sub_f32 v232, 0, v230
    v_exp_f32 v232, v232
    v_sub_f32 v229, v229, v230
    v_sub_f32 v80, v80, v230
    v_sub_f32 v48, v48, v230
    v_sub_f32 v16, v16, v230
    v_sub_f32 v81, v81, v230
    v_sub_f32 v49, v49, v230
    v_sub_f32 v17, v17, v230
    v_sub_f32 v82, v82, v230
    v_sub_f32 v50, v50, v230
    v_sub_f32 v18, v18, v230
    v_sub_f32 v83, v83, v230
    v_sub_f32 v51, v51, v230
    v_sub_f32 v19, v19, v230
    v_sub_f32 v84, v84, v230
    v_sub_f32 v52, v52, v230
    v_sub_f32 v20, v20, v230
    v_sub_f32 v85, v85, v230
    v_sub_f32 v53, v53, v230
    v_sub_f32 v21, v21, v230
    v_sub_f32 v86, v86, v230
    v_sub_f32 v54, v54, v230
    v_sub_f32 v22, v22, v230
    v_sub_f32 v87, v87, v230
    v_sub_f32 v55, v55, v230
    v_sub_f32 v23, v23, v230
    v_sub_f32 v88, v88, v230
    v_sub_f32 v56, v56, v230
    v_sub_f32 v24, v24, v230
    v_sub_f32 v89, v89, v230
    v_sub_f32 v57, v57, v230
    v_sub_f32 v25, v25, v230
    v_sub_f32 v90, v90, v230
    v_sub_f32 v58, v58, v230
    v_sub_f32 v26, v26, v230
    v_sub_f32 v91, v91, v230
    v_sub_f32 v59, v59, v230
    v_sub_f32 v27, v27, v230
    v_sub_f32 v92, v92, v230
    v_sub_f32 v60, v60, v230
    v_sub_f32 v28, v28, v230
    v_sub_f32 v93, v93, v230
    v_sub_f32 v61, v61, v230
    v_sub_f32 v29, v29, v230
    v_sub_f32 v94, v94, v230
    v_sub_f32 v62, v62, v230
    v_sub_f32 v30, v30, v230
    v_sub_f32 v95, v95, v230
    v_sub_f32 v63, v63, v230
    v_sub_f32 v31, v31, v230
    v_mul_f32 v227, v227, v232
    v_accvgpr_read_b32 v234, a64
    v_mul_f32 v234, v234, v232
    v_accvgpr_write_b32 a64, v234
    v_accvgpr_read_b32 v235, a65
    v_mul_f32 v235, v235, v232
    v_accvgpr_write_b32 a65, v235
    v_accvgpr_read_b32 v236, a66
    v_mul_f32 v236, v236, v232
    v_accvgpr_write_b32 a66, v236
    v_accvgpr_read_b32 v237, a67
    v_mul_f32 v237, v237, v232
    v_accvgpr_write_b32 a67, v237
    v_accvgpr_read_b32 v234, a68
    v_mul_f32 v234, v234, v232
    v_accvgpr_write_b32 a68, v234
    v_accvgpr_read_b32 v235, a69
    v_mul_f32 v235, v235, v232
    v_accvgpr_write_b32 a69, v235
    v_accvgpr_read_b32 v236, a70
    v_mul_f32 v236, v236, v232
    v_accvgpr_write_b32 a70, v236
    v_accvgpr_read_b32 v237, a71
    v_mul_f32 v237, v237, v232
    v_accvgpr_write_b32 a71, v237
    v_accvgpr_read_b32 v234, a72
    v_mul_f32 v234, v234, v232
    v_accvgpr_write_b32 a72, v234
    v_accvgpr_read_b32 v235, a73
    v_mul_f32 v235, v235, v232
    v_accvgpr_write_b32 a73, v235
    v_accvgpr_read_b32 v236, a74
    v_mul_f32 v236, v236, v232
    v_accvgpr_write_b32 a74, v236
    v_accvgpr_read_b32 v237, a75
    v_mul_f32 v237, v237, v232
    v_accvgpr_write_b32 a75, v237
    v_accvgpr_read_b32 v234, a76
    v_mul_f32 v234, v234, v232
    v_accvgpr_write_b32 a76, v234
    v_accvgpr_read_b32 v235, a77
    v_mul_f32 v235, v235, v232
    v_accvgpr_write_b32 a77, v235
    v_accvgpr_read_b32 v236, a78
    v_mul_f32 v236, v236, v232
    v_accvgpr_write_b32 a78, v236
    v_accvgpr_read_b32 v237, a79
    v_mul_f32 v237, v237, v232
    v_accvgpr_write_b32 a79, v237
    v_accvgpr_read_b32 v234, a80
    v_mul_f32 v234, v234, v232
    v_accvgpr_write_b32 a80, v234
    v_accvgpr_read_b32 v235, a81
    v_mul_f32 v235, v235, v232
    v_accvgpr_write_b32 a81, v235
    v_accvgpr_read_b32 v236, a82
    v_mul_f32 v236, v236, v232
    v_accvgpr_write_b32 a82, v236
    v_accvgpr_read_b32 v237, a83
    v_mul_f32 v237, v237, v232
    v_accvgpr_write_b32 a83, v237
    v_accvgpr_read_b32 v234, a84
    v_mul_f32 v234, v234, v232
    v_accvgpr_write_b32 a84, v234
    v_accvgpr_read_b32 v235, a85
    v_mul_f32 v235, v235, v232
    v_accvgpr_write_b32 a85, v235
    v_accvgpr_read_b32 v236, a86
    v_mul_f32 v236, v236, v232
    v_accvgpr_write_b32 a86, v236
    v_accvgpr_read_b32 v237, a87
    v_mul_f32 v237, v237, v232
    v_accvgpr_write_b32 a87, v237
    v_accvgpr_read_b32 v234, a88
    v_mul_f32 v234, v234, v232
    v_accvgpr_write_b32 a88, v234
    v_accvgpr_read_b32 v235, a89
    v_mul_f32 v235, v235, v232
    v_accvgpr_write_b32 a89, v235
    v_accvgpr_read_b32 v236, a90
    v_mul_f32 v236, v236, v232
    v_accvgpr_write_b32 a90, v236
    v_accvgpr_read_b32 v237, a91
    v_mul_f32 v237, v237, v232
    v_accvgpr_write_b32 a91, v237
    v_accvgpr_read_b32 v234, a92
    v_mul_f32 v234, v234, v232
    v_accvgpr_write_b32 a92, v234
    v_accvgpr_read_b32 v235, a93
    v_mul_f32 v235, v235, v232
    v_accvgpr_write_b32 a93, v235
    v_accvgpr_read_b32 v236, a94
    v_mul_f32 v236, v236, v232
    v_accvgpr_write_b32 a94, v236
    v_accvgpr_read_b32 v237, a95
    v_mul_f32 v237, v237, v232
    v_accvgpr_write_b32 a95, v237
    v_accvgpr_read_b32 v234, a96
    v_mul_f32 v234, v234, v232
    v_accvgpr_write_b32 a96, v234
    v_accvgpr_read_b32 v235, a97
    v_mul_f32 v235, v235, v232
    v_accvgpr_write_b32 a97, v235
    v_accvgpr_read_b32 v236, a98
    v_mul_f32 v236, v236, v232
    v_accvgpr_write_b32 a98, v236
    v_accvgpr_read_b32 v237, a99
    v_mul_f32 v237, v237, v232
    v_accvgpr_write_b32 a99, v237
    v_accvgpr_read_b32 v234, a100
    v_mul_f32 v234, v234, v232
    v_accvgpr_write_b32 a100, v234
    v_accvgpr_read_b32 v235, a101
    v_mul_f32 v235, v235, v232
    v_accvgpr_write_b32 a101, v235
    v_accvgpr_read_b32 v236, a102
    v_mul_f32 v236, v236, v232
    v_accvgpr_write_b32 a102, v236
    v_accvgpr_read_b32 v237, a103
    v_mul_f32 v237, v237, v232
    v_accvgpr_write_b32 a103, v237
    v_accvgpr_read_b32 v234, a104
    v_mul_f32 v234, v234, v232
    v_accvgpr_write_b32 a104, v234
    v_accvgpr_read_b32 v235, a105
    v_mul_f32 v235, v235, v232
    v_accvgpr_write_b32 a105, v235
    v_accvgpr_read_b32 v236, a106
    v_mul_f32 v236, v236, v232
    v_accvgpr_write_b32 a106, v236
    v_accvgpr_read_b32 v237, a107
    v_mul_f32 v237, v237, v232
    v_accvgpr_write_b32 a107, v237
    v_accvgpr_read_b32 v234, a108
    v_mul_f32 v234, v234, v232
    v_accvgpr_write_b32 a108, v234
    v_accvgpr_read_b32 v235, a109
    v_mul_f32 v235, v235, v232
    v_accvgpr_write_b32 a109, v235
    v_accvgpr_read_b32 v236, a110
    v_mul_f32 v236, v236, v232
    v_accvgpr_write_b32 a110, v236
    v_accvgpr_read_b32 v237, a111
    v_mul_f32 v237, v237, v232
    v_accvgpr_write_b32 a111, v237
    v_accvgpr_read_b32 v234, a112
    v_mul_f32 v234, v234, v232
    v_accvgpr_write_b32 a112, v234
    v_accvgpr_read_b32 v235, a113
    v_mul_f32 v235, v235, v232
    v_accvgpr_write_b32 a113, v235
    v_accvgpr_read_b32 v236, a114
    v_mul_f32 v236, v236, v232
    v_accvgpr_write_b32 a114, v236
    v_accvgpr_read_b32 v237, a115
    v_mul_f32 v237, v237, v232
    v_accvgpr_write_b32 a115, v237
    v_accvgpr_read_b32 v234, a116
    v_mul_f32 v234, v234, v232
    v_accvgpr_write_b32 a116, v234
    v_accvgpr_read_b32 v235, a117
    v_mul_f32 v235, v235, v232
    v_accvgpr_write_b32 a117, v235
    v_accvgpr_read_b32 v236, a118
    v_mul_f32 v236, v236, v232
    v_accvgpr_write_b32 a118, v236
    v_accvgpr_read_b32 v237, a119
    v_mul_f32 v237, v237, v232
    v_accvgpr_write_b32 a119, v237
    v_accvgpr_read_b32 v234, a120
    v_mul_f32 v234, v234, v232
    v_accvgpr_write_b32 a120, v234
    v_accvgpr_read_b32 v235, a121
    v_mul_f32 v235, v235, v232
    v_accvgpr_write_b32 a121, v235
    v_accvgpr_read_b32 v236, a122
    v_mul_f32 v236, v236, v232
    v_accvgpr_write_b32 a122, v236
    v_accvgpr_read_b32 v237, a123
    v_mul_f32 v237, v237, v232
    v_accvgpr_write_b32 a123, v237
    v_accvgpr_read_b32 v234, a124
    v_mul_f32 v234, v234, v232
    v_accvgpr_write_b32 a124, v234
    v_accvgpr_read_b32 v235, a125
    v_mul_f32 v235, v235, v232
    v_accvgpr_write_b32 a125, v235
    v_accvgpr_read_b32 v236, a126
    v_mul_f32 v236, v236, v232
    v_accvgpr_write_b32 a126, v236
    v_accvgpr_read_b32 v237, a127
    v_mul_f32 v237, v237, v232
    v_accvgpr_write_b32 a127, v237
    v_exp_f32 v138, v16
    v_exp_f32 v139, v17
    v_exp_f32 v130, v18
    v_exp_f32 v131, v19
    v_cvt_pk_bf16_f32 v104, v138, v139
    v_exp_f32 v132, v20
    v_exp_f32 v133, v21
    v_cvt_pk_bf16_f32 v105, v130, v131
    v_add_f32 v138, v138, v130
    v_add_f32 v139, v139, v131
    v_exp_f32 v134, v22
    v_exp_f32 v135, v23
    v_cvt_pk_bf16_f32 v106, v132, v133
    v_add_f32 v138, v138, v132
    v_add_f32 v139, v139, v133
    v_exp_f32 v128, v24
    v_exp_f32 v129, v25
    v_cvt_pk_bf16_f32 v107, v134, v135
    v_add_f32 v138, v138, v134
    v_add_f32 v139, v139, v135
    v_exp_f32 v130, v26
    v_exp_f32 v131, v27
    v_cvt_pk_bf16_f32 v108, v128, v129
    v_add_f32 v138, v138, v128
    v_add_f32 v139, v139, v129
    v_exp_f32 v132, v28
    v_exp_f32 v133, v29
    v_cvt_pk_bf16_f32 v109, v130, v131
    v_add_f32 v138, v138, v130
    v_add_f32 v139, v139, v131
    v_exp_f32 v134, v30
    v_exp_f32 v135, v31
    v_cvt_pk_bf16_f32 v110, v132, v133
    v_add_f32 v138, v138, v132
    v_add_f32 v139, v139, v133
    v_cvt_pk_bf16_f32 v111, v134, v135
    v_add_f32 v138, v138, v134
    v_add_f32 v139, v139, v135
    v_add_f32 v225, v138, v139
    s_nop 1
    s_branch kf_rr27
kf_fix29:
    s_cmp_eq_u32 s33, 0
    s_cselect_b32 s24, 0, 0x74000000
    s_cselect_b32 s36, 0, 0x1000
    s_mov_b32 s33, 1
    v_subrev_f32 v230, s24, v243
    v_add_f32 v231, 0, v230
    v_min_f32 v80, v229, v231
    v_add_f32 v232, 0xf1800000, v230
    v_min_f32 v81, v229, v232
    v_add_f32 v231, 0xf2000000, v230
    v_min_f32 v82, v229, v231
    v_add_f32 v232, 0xf2400000, v230
    v_min_f32 v83, v229, v232
    v_add_f32 v231, 0xf3000000, v230
    v_min_f32 v84, v229, v231
    v_add_f32 v232, 0xf3100000, v230
    v_min_f32 v85, v229, v232
    v_add_f32 v231, 0xf3200000, v230
    v_min_f32 v86, v229, v231
    v_add_f32 v232, 0xf3300000, v230
    v_min_f32 v87, v229, v232
    v_add_f32 v231, 0xf3800000, v230
    v_min_f32 v88, v229, v231
    v_add_f32 v232, 0xf3880000, v230
    v_min_f32 v89, v229, v232
    v_add_f32 v231, 0xf3900000, v230
    v_min_f32 v90, v229, v231
    v_add_f32 v232, 0xf3980000, v230
    v_min_f32 v91, v229, v232
    v_add_f32 v231, 0xf3c00000, v230
    v_min_f32 v92, v229, v231
    v_add_f32 v232, 0xf3c80000, v230
    v_min_f32 v93, v229, v232
    v_add_f32 v231, 0xf3d00000, v230
    v_min_f32 v94, v229, v231
    v_add_f32 v232, 0xf3d80000, v230
    v_min_f32 v95, v229, v232
    s_nop 1
    s_branch kf_fixr30
kf_rare32:
    s_nop 15
    v_max3_f32 v230, v48, v49, v50
    v_max3_f32 v230, v230, v51, v52
    v_max3_f32 v230, v230, v53, v54
    v_max3_f32 v230, v230, v55, v56
    v_max3_f32 v230, v230, v57, v58
    v_max3_f32 v230, v230, v59, v60
    v_max3_f32 v230, v230, v61, v62
    v_max_f32 v230, v230, v63
    v_mov_b32 v231, v230
    s_nop 1
    v_permlane32_swap_b32 v230, v231
    s_nop 0
    v_max_f32 v230, v230, v231
    v_max_f32 v230, 0, v230
    v_sub_f32 v232, 0, v230
    v_exp_f32 v232, v232
    v_sub_f32 v229, v229, v230
    v_sub_f32 v80, v80, v230
    v_sub_f32 v16, v16, v230
    v_sub_f32 v48, v48, v230
    v_sub_f32 v81, v81, v230
    v_sub_f32 v17, v17, v230
    v_sub_f32 v49, v49, v230
    v_sub_f32 v82, v82, v230
    v_sub_f32 v18, v18, v230
    v_sub_f32 v50, v50, v230
    v_sub_f32 v83, v83, v230
    v_sub_f32 v19, v19, v230
    v_sub_f32 v51, v51, v230
    v_sub_f32 v84, v84, v230
    v_sub_f32 v20, v20, v230
    v_sub_f32 v52, v52, v230
    v_sub_f32 v85, v85, v230
    v_sub_f32 v21, v21, v230
    v_sub_f32 v53, v53, v230
    v_sub_f32 v86, v86, v230
    v_sub_f32 v22, v22, v230
    v_sub_f32 v54, v54, v230
    v_sub_f32 v87, v87, v230
    v_sub_f32 v23, v23, v230
    v_sub_f32 v55, v55, v230
    v_sub_f32 v88, v88, v230
    v_sub_f32 v24, v24, v230
    v_sub_f32 v56, v56, v230
    v_sub_f32 v89, v89, v230
    v_sub_f32 v25, v25, v230
    v_sub_f32 v57, v57, v230
    v_sub_f32 v90, v90, v230
    v_sub_f32 v26, v26, v230
    v_sub_f32 v58, v58, v230
    v_sub_f32 v91, v91, v230
    v_sub_f32 v27, v27, v230
    v_sub_f32 v59, v59, v230
    v_sub_f32 v92, v92, v230
    v_sub_f32 v28, v28, v230
    v_sub_f32 v60, v60, v230
    v_sub_f32 v93, v93, v230
    v_sub_f32 v29, v29, v230
    v_sub_f32 v61, v61, v230
    v_sub_f32 v94, v94, v230
    v_sub_f32 v30, v30, v230
    v_sub_f32 v62, v62, v230
    v_sub_f32 v95, v95, v230
    v_sub_f32 v31, v31, v230
    v_sub_f32 v63, v63, v230
    v_mul_f32 v227, v227, v232
    v_accvgpr_read_b32 v234, a64
    v_mul_f32 v234, v234, v232
    v_accvgpr_write_b32 a64, v234
    v_accvgpr_read_b32 v235, a65
    v_mul_f32 v235, v235, v232
    v_accvgpr_write_b32 a65, v235
    v_accvgpr_read_b32 v236, a66
    v_mul_f32 v236, v236, v232
    v_accvgpr_write_b32 a66, v236
    v_accvgpr_read_b32 v237, a67
    v_mul_f32 v237, v237, v232
    v_accvgpr_write_b32 a67, v237
    v_accvgpr_read_b32 v234, a68
    v_mul_f32 v234, v234, v232
    v_accvgpr_write_b32 a68, v234
    v_accvgpr_read_b32 v235, a69
    v_mul_f32 v235, v235, v232
    v_accvgpr_write_b32 a69, v235
    v_accvgpr_read_b32 v236, a70
    v_mul_f32 v236, v236, v232
    v_accvgpr_write_b32 a70, v236
    v_accvgpr_read_b32 v237, a71
    v_mul_f32 v237, v237, v232
    v_accvgpr_write_b32 a71, v237
    v_accvgpr_read_b32 v234, a72
    v_mul_f32 v234, v234, v232
    v_accvgpr_write_b32 a72, v234
    v_accvgpr_read_b32 v235, a73
    v_mul_f32 v235, v235, v232
    v_accvgpr_write_b32 a73, v235
    v_accvgpr_read_b32 v236, a74
    v_mul_f32 v236, v236, v232
    v_accvgpr_write_b32 a74, v236
    v_accvgpr_read_b32 v237, a75
    v_mul_f32 v237, v237, v232
    v_accvgpr_write_b32 a75, v237
    v_accvgpr_read_b32 v234, a76
    v_mul_f32 v234, v234, v232
    v_accvgpr_write_b32 a76, v234
    v_accvgpr_read_b32 v235, a77
    v_mul_f32 v235, v235, v232
    v_accvgpr_write_b32 a77, v235
    v_accvgpr_read_b32 v236, a78
    v_mul_f32 v236, v236, v232
    v_accvgpr_write_b32 a78, v236
    v_accvgpr_read_b32 v237, a79
    v_mul_f32 v237, v237, v232
    v_accvgpr_write_b32 a79, v237
    v_accvgpr_read_b32 v234, a80
    v_mul_f32 v234, v234, v232
    v_accvgpr_write_b32 a80, v234
    v_accvgpr_read_b32 v235, a81
    v_mul_f32 v235, v235, v232
    v_accvgpr_write_b32 a81, v235
    v_accvgpr_read_b32 v236, a82
    v_mul_f32 v236, v236, v232
    v_accvgpr_write_b32 a82, v236
    v_accvgpr_read_b32 v237, a83
    v_mul_f32 v237, v237, v232
    v_accvgpr_write_b32 a83, v237
    v_accvgpr_read_b32 v234, a84
    v_mul_f32 v234, v234, v232
    v_accvgpr_write_b32 a84, v234
    v_accvgpr_read_b32 v235, a85
    v_mul_f32 v235, v235, v232
    v_accvgpr_write_b32 a85, v235
    v_accvgpr_read_b32 v236, a86
    v_mul_f32 v236, v236, v232
    v_accvgpr_write_b32 a86, v236
    v_accvgpr_read_b32 v237, a87
    v_mul_f32 v237, v237, v232
    v_accvgpr_write_b32 a87, v237
    v_accvgpr_read_b32 v234, a88
    v_mul_f32 v234, v234, v232
    v_accvgpr_write_b32 a88, v234
    v_accvgpr_read_b32 v235, a89
    v_mul_f32 v235, v235, v232
    v_accvgpr_write_b32 a89, v235
    v_accvgpr_read_b32 v236, a90
    v_mul_f32 v236, v236, v232
    v_accvgpr_write_b32 a90, v236
    v_accvgpr_read_b32 v237, a91
    v_mul_f32 v237, v237, v232
    v_accvgpr_write_b32 a91, v237
    v_accvgpr_read_b32 v234, a92
    v_mul_f32 v234, v234, v232
    v_accvgpr_write_b32 a92, v234
    v_accvgpr_read_b32 v235, a93
    v_mul_f32 v235, v235, v232
    v_accvgpr_write_b32 a93, v235
    v_accvgpr_read_b32 v236, a94
    v_mul_f32 v236, v236, v232
    v_accvgpr_write_b32 a94, v236
    v_accvgpr_read_b32 v237, a95
    v_mul_f32 v237, v237, v232
    v_accvgpr_write_b32 a95, v237
    v_accvgpr_read_b32 v234, a96
    v_mul_f32 v234, v234, v232
    v_accvgpr_write_b32 a96, v234
    v_accvgpr_read_b32 v235, a97
    v_mul_f32 v235, v235, v232
    v_accvgpr_write_b32 a97, v235
    v_accvgpr_read_b32 v236, a98
    v_mul_f32 v236, v236, v232
    v_accvgpr_write_b32 a98, v236
    v_accvgpr_read_b32 v237, a99
    v_mul_f32 v237, v237, v232
    v_accvgpr_write_b32 a99, v237
    v_accvgpr_read_b32 v234, a100
    v_mul_f32 v234, v234, v232
    v_accvgpr_write_b32 a100, v234
    v_accvgpr_read_b32 v235, a101
    v_mul_f32 v235, v235, v232
    v_accvgpr_write_b32 a101, v235
    v_accvgpr_read_b32 v236, a102
    v_mul_f32 v236, v236, v232
    v_accvgpr_write_b32 a102, v236
    v_accvgpr_read_b32 v237, a103
    v_mul_f32 v237, v237, v232
    v_accvgpr_write_b32 a103, v237
    v_accvgpr_read_b32 v234, a104
    v_mul_f32 v234, v234, v232
    v_accvgpr_write_b32 a104, v234
    v_accvgpr_read_b32 v235, a105
    v_mul_f32 v235, v235, v232
    v_accvgpr_write_b32 a105, v235
    v_accvgpr_read_b32 v236, a106
    v_mul_f32 v236, v236, v232
    v_accvgpr_write_b32 a106, v236
    v_accvgpr_read_b32 v237, a107
    v_mul_f32 v237, v237, v232
    v_accvgpr_write_b32 a107, v237
    v_accvgpr_read_b32 v234, a108
    v_mul_f32 v234, v234, v232
    v_accvgpr_write_b32 a108, v234
    v_accvgpr_read_b32 v235, a109
    v_mul_f32 v235, v235, v232
    v_accvgpr_write_b32 a109, v235
    v_accvgpr_read_b32 v236, a110
    v_mul_f32 v236, v236, v232
    v_accvgpr_write_b32 a110, v236
    v_accvgpr_read_b32 v237, a111
    v_mul_f32 v237, v237, v232
    v_accvgpr_write_b32 a111, v237
    v_accvgpr_read_b32 v234, a112
    v_mul_f32 v234, v234, v232
    v_accvgpr_write_b32 a112, v234
    v_accvgpr_read_b32 v235, a113
    v_mul_f32 v235, v235, v232
    v_accvgpr_write_b32 a113, v235
    v_accvgpr_read_b32 v236, a114
    v_mul_f32 v236, v236, v232
    v_accvgpr_write_b32 a114, v236
    v_accvgpr_read_b32 v237, a115
    v_mul_f32 v237, v237, v232
    v_accvgpr_write_b32 a115, v237
    v_accvgpr_read_b32 v234, a116
    v_mul_f32 v234, v234, v232
    v_accvgpr_write_b32 a116, v234
    v_accvgpr_read_b32 v235, a117
    v_mul_f32 v235, v235, v232
    v_accvgpr_write_b32 a117, v235
    v_accvgpr_read_b32 v236, a118
    v_mul_f32 v236, v236, v232
    v_accvgpr_write_b32 a118, v236
    v_accvgpr_read_b32 v237, a119
    v_mul_f32 v237, v237, v232
    v_accvgpr_write_b32 a119, v237
    v_accvgpr_read_b32 v234, a120
    v_mul_f32 v234, v234, v232
    v_accvgpr_write_b32 a120, v234
    v_accvgpr_read_b32 v235, a121
    v_mul_f32 v235, v235, v232
    v_accvgpr_write_b32 a121, v235
    v_accvgpr_read_b32 v236, a122
    v_mul_f32 v236, v236, v232
    v_accvgpr_write_b32 a122, v236
    v_accvgpr_read_b32 v237, a123
    v_mul_f32 v237, v237, v232
    v_accvgpr_write_b32 a123, v237
    v_accvgpr_read_b32 v234, a124
    v_mul_f32 v234, v234, v232
    v_accvgpr_write_b32 a124, v234
    v_accvgpr_read_b32 v235, a125
    v_mul_f32 v235, v235, v232
    v_accvgpr_write_b32 a125, v235
    v_accvgpr_read_b32 v236, a126
    v_mul_f32 v236, v236, v232
    v_accvgpr_write_b32 a126, v236
    v_accvgpr_read_b32 v237, a127
    v_mul_f32 v237, v237, v232
    v_accvgpr_write_b32 a127, v237
    v_exp_f32 v138, v48
    v_exp_f32 v139, v49
    v_exp_f32 v130, v50
    v_exp_f32 v131, v51
    v_cvt_pk_bf16_f32 v120, v138, v139
    v_exp_f32 v132, v52
    v_exp_f32 v133, v53
    v_cvt_pk_bf16_f32 v121, v130, v131
    v_add_f32 v138, v138, v130
    v_add_f32 v139, v139, v131
    v_exp_f32 v134, v54
    v_exp_f32 v135, v55
    v_cvt_pk_bf16_f32 v122, v132, v133
    v_add_f32 v138, v138, v132
    v_add_f32 v139, v139, v133
    v_exp_f32 v128, v56
    v_exp_f32 v129, v57
    v_cvt_pk_bf16_f32 v123, v134, v135
    v_add_f32 v138, v138, v134
    v_add_f32 v139, v139, v135
    v_exp_f32 v130, v58
    v_exp_f32 v131, v59
    v_cvt_pk_bf16_f32 v124, v128, v129
    v_add_f32 v138, v138, v128
    v_add_f32 v139, v139, v129
    v_exp_f32 v132, v60
    v_exp_f32 v133, v61
    v_cvt_pk_bf16_f32 v125, v130, v131
    v_add_f32 v138, v138, v130
    v_add_f32 v139, v139, v131
    v_exp_f32 v134, v62
    v_exp_f32 v135, v63
    v_cvt_pk_bf16_f32 v126, v132, v133
    v_add_f32 v138, v138, v132
    v_add_f32 v139, v139, v133
    v_cvt_pk_bf16_f32 v127, v134, v135
    v_add_f32 v138, v138, v134
    v_add_f32 v139, v139, v135
    v_add_f32 v225, v138, v139
    s_nop 1
    s_branch kf_rr31
kf_l2p33:
    buffer_load_dword v252, v251, s[56:59], s28 offen
    s_add_u32 s28, s28, 2048
    buffer_store_dwordx4 v[200:203], v240, s[8:11], s29 offen sc1
    s_add_u32 s29, s29, 1024
    s_cmp_lt_u32 s29, s30
    s_cselect_b32 s27, 0, 0x1000
    s_branch kf_l2r34
kf_fix35:
    s_cmp_eq_u32 s33, 0
    s_cselect_b32 s24, 0, 0x74000000
    s_cselect_b32 s36, 0, 0x1000
    s_mov_b32 s33, 1
    v_subrev_f32 v230, s24, v243
    v_add_f32 v231, 0, v230
    v_min_f32 v80, v229, v231
    v_add_f32 v232, 0xf1800000, v230
    v_min_f32 v81, v229, v232
    v_add_f32 v231, 0xf2000000, v230
    v_min_f32 v82, v229, v231
    v_add_f32 v232, 0xf2400000, v230
    v_min_f32 v83, v229, v232
    v_add_f32 v231, 0xf3000000, v230
    v_min_f32 v84, v229, v231
    v_add_f32 v232, 0xf3100000, v230
    v_min_f32 v85, v229, v232
    v_add_f32 v231, 0xf3200000, v230
    v_min_f32 v86, v229, v231
    v_add_f32 v232, 0xf3300000, v230
    v_min_f32 v87, v229, v232
    v_add_f32 v231, 0xf3800000, v230
    v_min_f32 v88, v229, v231
    v_add_f32 v232, 0xf3880000, v230
    v_min_f32 v89, v229, v232
    v_add_f32 v231, 0xf3900000, v230
    v_min_f32 v90, v229, v231
    v_add_f32 v232, 0xf3980000, v230
    v_min_f32 v91, v229, v232
    v_add_f32 v231, 0xf3c00000, v230
    v_min_f32 v92, v229, v231
    v_add_f32 v232, 0xf3c80000, v230
    v_min_f32 v93, v229, v232
    v_add_f32 v231, 0xf3d00000, v230
    v_min_f32 v94, v229, v231
    v_add_f32 v232, 0xf3d80000, v230
    v_min_f32 v95, v229, v232
    s_nop 1
    s_branch kf_fixr36
kf_rare38:
    s_nop 15
    v_max3_f32 v230, v16, v17, v18
    v_max3_f32 v230, v230, v19, v20
    v_max3_f32 v230, v230, v21, v22
    v_max3_f32 v230, v230, v23, v24
    v_max3_f32 v230, v230, v25, v26
    v_max3_f32 v230, v230, v27, v28
    v_max3_f32 v230, v230, v29, v30
    v_max_f32 v230, v230, v31
    v_mov_b32 v231, v230
    s_nop 1
    v_permlane32_swap_b32 v230, v231
    s_nop 0
    v_max_f32 v230, v230, v231
    v_max_f32 v230, 0, v230
    v_sub_f32 v232, 0, v230
    v_exp_f32 v232, v232
    v_sub_f32 v229, v229, v230
    v_sub_f32 v80, v80, v230
    v_sub_f32 v48, v48, v230
    v_sub_f32 v16, v16, v230
    v_sub_f32 v81, v81, v230
    v_sub_f32 v49, v49, v230
    v_sub_f32 v17, v17, v230
    v_sub_f32 v82, v82, v230
    v_sub_f32 v50, v50, v230
    v_sub_f32 v18, v18, v230
    v_sub_f32 v83, v83, v230
    v_sub_f32 v51, v51, v230
    v_sub_f32 v19, v19, v230
    v_sub_f32 v84, v84, v230
    v_sub_f32 v52, v52, v230
    v_sub_f32 v20, v20, v230
    v_sub_f32 v85, v85, v230
    v_sub_f32 v53, v53, v230
    v_sub_f32 v21, v21, v230
    v_sub_f32 v86, v86, v230
    v_sub_f32 v54, v54, v230
    v_sub_f32 v22, v22, v230
    v_sub_f32 v87, v87, v230
    v_sub_f32 v55, v55, v230
    v_sub_f32 v23, v23, v230
    v_sub_f32 v88, v88, v230
    v_sub_f32 v56, v56, v230
    v_sub_f32 v24, v24, v230
    v_sub_f32 v89, v89, v230
    v_sub_f32 v57, v57, v230
    v_sub_f32 v25, v25, v230
    v_sub_f32 v90, v90, v230
    v_sub_f32 v58, v58, v230
    v_sub_f32 v26, v26, v230
    v_sub_f32 v91, v91, v230
    v_sub_f32 v59, v59, v230
    v_sub_f32 v27, v27, v230
    v_sub_f32 v92, v92, v230
    v_sub_f32 v60, v60, v230
    v_sub_f32 v28, v28, v230
    v_sub_f32 v93, v93, v230
    v_sub_f32 v61, v61, v230
    v_sub_f32 v29, v29, v230
    v_sub_f32 v94, v94, v230
    v_sub_f32 v62, v62, v230
    v_sub_f32 v30, v30, v230
    v_sub_f32 v95, v95, v230
    v_sub_f32 v63, v63, v230
    v_sub_f32 v31, v31, v230
    v_mul_f32 v227, v227, v232
    v_accvgpr_read_b32 v234, a64
    v_mul_f32 v234, v234, v232
    v_accvgpr_write_b32 a64, v234
    v_accvgpr_read_b32 v235, a65
    v_mul_f32 v235, v235, v232
    v_accvgpr_write_b32 a65, v235
    v_accvgpr_read_b32 v236, a66
    v_mul_f32 v236, v236, v232
    v_accvgpr_write_b32 a66, v236
    v_accvgpr_read_b32 v237, a67
    v_mul_f32 v237, v237, v232
    v_accvgpr_write_b32 a67, v237
    v_accvgpr_read_b32 v234, a68
    v_mul_f32 v234, v234, v232
    v_accvgpr_write_b32 a68, v234
    v_accvgpr_read_b32 v235, a69
    v_mul_f32 v235, v235, v232
    v_accvgpr_write_b32 a69, v235
    v_accvgpr_read_b32 v236, a70
    v_mul_f32 v236, v236, v232
    v_accvgpr_write_b32 a70, v236
    v_accvgpr_read_b32 v237, a71
    v_mul_f32 v237, v237, v232
    v_accvgpr_write_b32 a71, v237
    v_accvgpr_read_b32 v234, a72
    v_mul_f32 v234, v234, v232
    v_accvgpr_write_b32 a72, v234
    v_accvgpr_read_b32 v235, a73
    v_mul_f32 v235, v235, v232
    v_accvgpr_write_b32 a73, v235
    v_accvgpr_read_b32 v236, a74
    v_mul_f32 v236, v236, v232
    v_accvgpr_write_b32 a74, v236
    v_accvgpr_read_b32 v237, a75
    v_mul_f32 v237, v237, v232
    v_accvgpr_write_b32 a75, v237
    v_accvgpr_read_b32 v234, a76
    v_mul_f32 v234, v234, v232
    v_accvgpr_write_b32 a76, v234
    v_accvgpr_read_b32 v235, a77
    v_mul_f32 v235, v235, v232
    v_accvgpr_write_b32 a77, v235
    v_accvgpr_read_b32 v236, a78
    v_mul_f32 v236, v236, v232
    v_accvgpr_write_b32 a78, v236
    v_accvgpr_read_b32 v237, a79
    v_mul_f32 v237, v237, v232
    v_accvgpr_write_b32 a79, v237
    v_accvgpr_read_b32 v234, a80
    v_mul_f32 v234, v234, v232
    v_accvgpr_write_b32 a80, v234
    v_accvgpr_read_b32 v235, a81
    v_mul_f32 v235, v235, v232
    v_accvgpr_write_b32 a81, v235
    v_accvgpr_read_b32 v236, a82
    v_mul_f32 v236, v236, v232
    v_accvgpr_write_b32 a82, v236
    v_accvgpr_read_b32 v237, a83
    v_mul_f32 v237, v237, v232
    v_accvgpr_write_b32 a83, v237
    v_accvgpr_read_b32 v234, a84
    v_mul_f32 v234, v234, v232
    v_accvgpr_write_b32 a84, v234
    v_accvgpr_read_b32 v235, a85
    v_mul_f32 v235, v235, v232
    v_accvgpr_write_b32 a85, v235
    v_accvgpr_read_b32 v236, a86
    v_mul_f32 v236, v236, v232
    v_accvgpr_write_b32 a86, v236
    v_accvgpr_read_b32 v237, a87
    v_mul_f32 v237, v237, v232
    v_accvgpr_write_b32 a87, v237
    v_accvgpr_read_b32 v234, a88
    v_mul_f32 v234, v234, v232
    v_accvgpr_write_b32 a88, v234
    v_accvgpr_read_b32 v235, a89
    v_mul_f32 v235, v235, v232
    v_accvgpr_write_b32 a89, v235
    v_accvgpr_read_b32 v236, a90
    v_mul_f32 v236, v236, v232
    v_accvgpr_write_b32 a90, v236
    v_accvgpr_read_b32 v237, a91
    v_mul_f32 v237, v237, v232
    v_accvgpr_write_b32 a91, v237
    v_accvgpr_read_b32 v234, a92
    v_mul_f32 v234, v234, v232
    v_accvgpr_write_b32 a92, v234
    v_accvgpr_read_b32 v235, a93
    v_mul_f32 v235, v235, v232
    v_accvgpr_write_b32 a93, v235
    v_accvgpr_read_b32 v236, a94
    v_mul_f32 v236, v236, v232
    v_accvgpr_write_b32 a94, v236
    v_accvgpr_read_b32 v237, a95
    v_mul_f32 v237, v237, v232
    v_accvgpr_write_b32 a95, v237
    v_accvgpr_read_b32 v234, a96
    v_mul_f32 v234, v234, v232
    v_accvgpr_write_b32 a96, v234
    v_accvgpr_read_b32 v235, a97
    v_mul_f32 v235, v235, v232
    v_accvgpr_write_b32 a97, v235
    v_accvgpr_read_b32 v236, a98
    v_mul_f32 v236, v236, v232
    v_accvgpr_write_b32 a98, v236
    v_accvgpr_read_b32 v237, a99
    v_mul_f32 v237, v237, v232
    v_accvgpr_write_b32 a99, v237
    v_accvgpr_read_b32 v234, a100
    v_mul_f32 v234, v234, v232
    v_accvgpr_write_b32 a100, v234
    v_accvgpr_read_b32 v235, a101
    v_mul_f32 v235, v235, v232
    v_accvgpr_write_b32 a101, v235
    v_accvgpr_read_b32 v236, a102
    v_mul_f32 v236, v236, v232
    v_accvgpr_write_b32 a102, v236
    v_accvgpr_read_b32 v237, a103
    v_mul_f32 v237, v237, v232
    v_accvgpr_write_b32 a103, v237
    v_accvgpr_read_b32 v234, a104
    v_mul_f32 v234, v234, v232
    v_accvgpr_write_b32 a104, v234
    v_accvgpr_read_b32 v235, a105
    v_mul_f32 v235, v235, v232
    v_accvgpr_write_b32 a105, v235
    v_accvgpr_read_b32 v236, a106
    v_mul_f32 v236, v236, v232
    v_accvgpr_write_b32 a106, v236
    v_accvgpr_read_b32 v237, a107
    v_mul_f32 v237, v237, v232
    v_accvgpr_write_b32 a107, v237
    v_accvgpr_read_b32 v234, a108
    v_mul_f32 v234, v234, v232
    v_accvgpr_write_b32 a108, v234
    v_accvgpr_read_b32 v235, a109
    v_mul_f32 v235, v235, v232
    v_accvgpr_write_b32 a109, v235
    v_accvgpr_read_b32 v236, a110
    v_mul_f32 v236, v236, v232
    v_accvgpr_write_b32 a110, v236
    v_accvgpr_read_b32 v237, a111
    v_mul_f32 v237, v237, v232
    v_accvgpr_write_b32 a111, v237
    v_accvgpr_read_b32 v234, a112
    v_mul_f32 v234, v234, v232
    v_accvgpr_write_b32 a112, v234
    v_accvgpr_read_b32 v235, a113
    v_mul_f32 v235, v235, v232
    v_accvgpr_write_b32 a113, v235
    v_accvgpr_read_b32 v236, a114
    v_mul_f32 v236, v236, v232
    v_accvgpr_write_b32 a114, v236
    v_accvgpr_read_b32 v237, a115
    v_mul_f32 v237, v237, v232
    v_accvgpr_write_b32 a115, v237
    v_accvgpr_read_b32 v234, a116
    v_mul_f32 v234, v234, v232
    v_accvgpr_write_b32 a116, v234
    v_accvgpr_read_b32 v235, a117
    v_mul_f32 v235, v235, v232
    v_accvgpr_write_b32 a117, v235
    v_accvgpr_read_b32 v236, a118
    v_mul_f32 v236, v236, v232
    v_accvgpr_write_b32 a118, v236
    v_accvgpr_read_b32 v237, a119
    v_mul_f32 v237, v237, v232
    v_accvgpr_write_b32 a119, v237
    v_accvgpr_read_b32 v234, a120
    v_mul_f32 v234, v234, v232
    v_accvgpr_write_b32 a120, v234
    v_accvgpr_read_b32 v235, a121
    v_mul_f32 v235, v235, v232
    v_accvgpr_write_b32 a121, v235
    v_accvgpr_read_b32 v236, a122
    v_mul_f32 v236, v236, v232
    v_accvgpr_write_b32 a122, v236
    v_accvgpr_read_b32 v237, a123
    v_mul_f32 v237, v237, v232
    v_accvgpr_write_b32 a123, v237
    v_accvgpr_read_b32 v234, a124
    v_mul_f32 v234, v234, v232
    v_accvgpr_write_b32 a124, v234
    v_accvgpr_read_b32 v235, a125
    v_mul_f32 v235, v235, v232
    v_accvgpr_write_b32 a125, v235
    v_accvgpr_read_b32 v236, a126
    v_mul_f32 v236, v236, v232
    v_accvgpr_write_b32 a126, v236
    v_accvgpr_read_b32 v237, a127
    v_mul_f32 v237, v237, v232
    v_accvgpr_write_b32 a127, v237
    v_exp_f32 v138, v16
    v_exp_f32 v139, v17
    v_exp_f32 v130, v18
    v_exp_f32 v131, v19
    v_cvt_pk_bf16_f32 v104, v138, v139
    v_exp_f32 v132, v20
    v_exp_f32 v133, v21
    v_cvt_pk_bf16_f32 v105, v130, v131
    v_add_f32 v138, v138, v130
    v_add_f32 v139, v139, v131
    v_exp_f32 v134, v22
    v_exp_f32 v135, v23
    v_cvt_pk_bf16_f32 v106, v132, v133
    v_add_f32 v138, v138, v132
    v_add_f32 v139, v139, v133
    v_exp_f32 v128, v24
    v_exp_f32 v129, v25
    v_cvt_pk_bf16_f32 v107, v134, v135
    v_add_f32 v138, v138, v134
    v_add_f32 v139, v139, v135
    v_exp_f32 v130, v26
    v_exp_f32 v131, v27
    v_cvt_pk_bf16_f32 v108, v128, v129
    v_add_f32 v138, v138, v128
    v_add_f32 v139, v139, v129
    v_exp_f32 v132, v28
    v_exp_f32 v133, v29
    v_cvt_pk_bf16_f32 v109, v130, v131
    v_add_f32 v138, v138, v130
    v_add_f32 v139, v139, v131
    v_exp_f32 v134, v30
    v_exp_f32 v135, v31
    v_cvt_pk_bf16_f32 v110, v132, v133
    v_add_f32 v138, v138, v132
    v_add_f32 v139, v139, v133
    v_cvt_pk_bf16_f32 v111, v134, v135
    v_add_f32 v138, v138, v134
    v_add_f32 v139, v139, v135
    v_add_f32 v225, v138, v139
    s_nop 1
    s_branch kf_rr37
kf_rare40:
    s_nop 15
    v_max3_f32 v230, v48, v49, v50
    v_max3_f32 v230, v230, v51, v52
    v_max3_f32 v230, v230, v53, v54
    v_max3_f32 v230, v230, v55, v56
    v_max3_f32 v230, v230, v57, v58
    v_max3_f32 v230, v230, v59, v60
    v_max3_f32 v230, v230, v61, v62
    v_max_f32 v230, v230, v63
    v_mov_b32 v231, v230
    s_nop 1
    v_permlane32_swap_b32 v230, v231
    s_nop 0
    v_max_f32 v230, v230, v231
    v_max_f32 v230, 0, v230
    v_sub_f32 v232, 0, v230
    v_exp_f32 v232, v232
    v_sub_f32 v229, v229, v230
    v_sub_f32 v80, v80, v230
    v_sub_f32 v16, v16, v230
    v_sub_f32 v48, v48, v230
    v_sub_f32 v81, v81, v230
    v_sub_f32 v17, v17, v230
    v_sub_f32 v49, v49, v230
    v_sub_f32 v82, v82, v230
    v_sub_f32 v18, v18, v230
    v_sub_f32 v50, v50, v230
    v_sub_f32 v83, v83, v230
    v_sub_f32 v19, v19, v230
    v_sub_f32 v51, v51, v230
    v_sub_f32 v84, v84, v230
    v_sub_f32 v20, v20, v230
    v_sub_f32 v52, v52, v230
    v_sub_f32 v85, v85, v230
    v_sub_f32 v21, v21, v230
    v_sub_f32 v53, v53, v230
    v_sub_f32 v86, v86, v230
    v_sub_f32 v22, v22, v230
    v_sub_f32 v54, v54, v230
    v_sub_f32 v87, v87, v230
    v_sub_f32 v23, v23, v230
    v_sub_f32 v55, v55, v230
    v_sub_f32 v88, v88, v230
    v_sub_f32 v24, v24, v230
    v_sub_f32 v56, v56, v230
    v_sub_f32 v89, v89, v230
    v_sub_f32 v25, v25, v230
    v_sub_f32 v57, v57, v230
    v_sub_f32 v90, v90, v230
    v_sub_f32 v26, v26, v230
    v_sub_f32 v58, v58, v230
    v_sub_f32 v91, v91, v230
    v_sub_f32 v27, v27, v230
    v_sub_f32 v59, v59, v230
    v_sub_f32 v92, v92, v230
    v_sub_f32 v28, v28, v230
    v_sub_f32 v60, v60, v230
    v_sub_f32 v93, v93, v230
    v_sub_f32 v29, v29, v230
    v_sub_f32 v61, v61, v230
    v_sub_f32 v94, v94, v230
    v_sub_f32 v30, v30, v230
    v_sub_f32 v62, v62, v230
    v_sub_f32 v95, v95, v230
    v_sub_f32 v31, v31, v230
    v_sub_f32 v63, v63, v230
    v_mul_f32 v227, v227, v232
    v_accvgpr_read_b32 v234, a64
    v_mul_f32 v234, v234, v232
    v_accvgpr_write_b32 a64, v234
    v_accvgpr_read_b32 v235, a65
    v_mul_f32 v235, v235, v232
    v_accvgpr_write_b32 a65, v235
    v_accvgpr_read_b32 v236, a66
    v_mul_f32 v236, v236, v232
    v_accvgpr_write_b32 a66, v236
    v_accvgpr_read_b32 v237, a67
    v_mul_f32 v237, v237, v232
    v_accvgpr_write_b32 a67, v237
    v_accvgpr_read_b32 v234, a68
    v_mul_f32 v234, v234, v232
    v_accvgpr_write_b32 a68, v234
    v_accvgpr_read_b32 v235, a69
    v_mul_f32 v235, v235, v232
    v_accvgpr_write_b32 a69, v235
    v_accvgpr_read_b32 v236, a70
    v_mul_f32 v236, v236, v232
    v_accvgpr_write_b32 a70, v236
    v_accvgpr_read_b32 v237, a71
    v_mul_f32 v237, v237, v232
    v_accvgpr_write_b32 a71, v237
    v_accvgpr_read_b32 v234, a72
    v_mul_f32 v234, v234, v232
    v_accvgpr_write_b32 a72, v234
    v_accvgpr_read_b32 v235, a73
    v_mul_f32 v235, v235, v232
    v_accvgpr_write_b32 a73, v235
    v_accvgpr_read_b32 v236, a74
    v_mul_f32 v236, v236, v232
    v_accvgpr_write_b32 a74, v236
    v_accvgpr_read_b32 v237, a75
    v_mul_f32 v237, v237, v232
    v_accvgpr_write_b32 a75, v237
    v_accvgpr_read_b32 v234, a76
    v_mul_f32 v234, v234, v232
    v_accvgpr_write_b32 a76, v234
    v_accvgpr_read_b32 v235, a77
    v_mul_f32 v235, v235, v232
    v_accvgpr_write_b32 a77, v235
    v_accvgpr_read_b32 v236, a78
    v_mul_f32 v236, v236, v232
    v_accvgpr_write_b32 a78, v236
    v_accvgpr_read_b32 v237, a79
    v_mul_f32 v237, v237, v232
    v_accvgpr_write_b32 a79, v237
    v_accvgpr_read_b32 v234, a80
    v_mul_f32 v234, v234, v232
    v_accvgpr_write_b32 a80, v234
    v_accvgpr_read_b32 v235, a81
    v_mul_f32 v235, v235, v232
    v_accvgpr_write_b32 a81, v235
    v_accvgpr_read_b32 v236, a82
    v_mul_f32 v236, v236, v232
    v_accvgpr_write_b32 a82, v236
    v_accvgpr_read_b32 v237, a83
    v_mul_f32 v237, v237, v232
    v_accvgpr_write_b32 a83, v237
    v_accvgpr_read_b32 v234, a84
    v_mul_f32 v234, v234, v232
    v_accvgpr_write_b32 a84, v234
    v_accvgpr_read_b32 v235, a85
    v_mul_f32 v235, v235, v232
    v_accvgpr_write_b32 a85, v235
    v_accvgpr_read_b32 v236, a86
    v_mul_f32 v236, v236, v232
    v_accvgpr_write_b32 a86, v236
    v_accvgpr_read_b32 v237, a87
    v_mul_f32 v237, v237, v232
    v_accvgpr_write_b32 a87, v237
    v_accvgpr_read_b32 v234, a88
    v_mul_f32 v234, v234, v232
    v_accvgpr_write_b32 a88, v234
    v_accvgpr_read_b32 v235, a89
    v_mul_f32 v235, v235, v232
    v_accvgpr_write_b32 a89, v235
    v_accvgpr_read_b32 v236, a90
    v_mul_f32 v236, v236, v232
    v_accvgpr_write_b32 a90, v236
    v_accvgpr_read_b32 v237, a91
    v_mul_f32 v237, v237, v232
    v_accvgpr_write_b32 a91, v237
    v_accvgpr_read_b32 v234, a92
    v_mul_f32 v234, v234, v232
    v_accvgpr_write_b32 a92, v234
    v_accvgpr_read_b32 v235, a93
    v_mul_f32 v235, v235, v232
    v_accvgpr_write_b32 a93, v235
    v_accvgpr_read_b32 v236, a94
    v_mul_f32 v236, v236, v232
    v_accvgpr_write_b32 a94, v236
    v_accvgpr_read_b32 v237, a95
    v_mul_f32 v237, v237, v232
    v_accvgpr_write_b32 a95, v237
    v_accvgpr_read_b32 v234, a96
    v_mul_f32 v234, v234, v232
    v_accvgpr_write_b32 a96, v234
    v_accvgpr_read_b32 v235, a97
    v_mul_f32 v235, v235, v232
    v_accvgpr_write_b32 a97, v235
    v_accvgpr_read_b32 v236, a98
    v_mul_f32 v236, v236, v232
    v_accvgpr_write_b32 a98, v236
    v_accvgpr_read_b32 v237, a99
    v_mul_f32 v237, v237, v232
    v_accvgpr_write_b32 a99, v237
    v_accvgpr_read_b32 v234, a100
    v_mul_f32 v234, v234, v232
    v_accvgpr_write_b32 a100, v234
    v_accvgpr_read_b32 v235, a101
    v_mul_f32 v235, v235, v232
    v_accvgpr_write_b32 a101, v235
    v_accvgpr_read_b32 v236, a102
    v_mul_f32 v236, v236, v232
    v_accvgpr_write_b32 a102, v236
    v_accvgpr_read_b32 v237, a103
    v_mul_f32 v237, v237, v232
    v_accvgpr_write_b32 a103, v237
    v_accvgpr_read_b32 v234, a104
    v_mul_f32 v234, v234, v232
    v_accvgpr_write_b32 a104, v234
    v_accvgpr_read_b32 v235, a105
    v_mul_f32 v235, v235, v232
    v_accvgpr_write_b32 a105, v235
    v_accvgpr_read_b32 v236, a106
    v_mul_f32 v236, v236, v232
    v_accvgpr_write_b32 a106, v236
    v_accvgpr_read_b32 v237, a107
    v_mul_f32 v237, v237, v232
    v_accvgpr_write_b32 a107, v237
    v_accvgpr_read_b32 v234, a108
    v_mul_f32 v234, v234, v232
    v_accvgpr_write_b32 a108, v234
    v_accvgpr_read_b32 v235, a109
    v_mul_f32 v235, v235, v232
    v_accvgpr_write_b32 a109, v235
    v_accvgpr_read_b32 v236, a110
    v_mul_f32 v236, v236, v232
    v_accvgpr_write_b32 a110, v236
    v_accvgpr_read_b32 v237, a111
    v_mul_f32 v237, v237, v232
    v_accvgpr_write_b32 a111, v237
    v_accvgpr_read_b32 v234, a112
    v_mul_f32 v234, v234, v232
    v_accvgpr_write_b32 a112, v234
    v_accvgpr_read_b32 v235, a113
    v_mul_f32 v235, v235, v232
    v_accvgpr_write_b32 a113, v235
    v_accvgpr_read_b32 v236, a114
    v_mul_f32 v236, v236, v232
    v_accvgpr_write_b32 a114, v236
    v_accvgpr_read_b32 v237, a115
    v_mul_f32 v237, v237, v232
    v_accvgpr_write_b32 a115, v237
    v_accvgpr_read_b32 v234, a116
    v_mul_f32 v234, v234, v232
    v_accvgpr_write_b32 a116, v234
    v_accvgpr_read_b32 v235, a117
    v_mul_f32 v235, v235, v232
    v_accvgpr_write_b32 a117, v235
    v_accvgpr_read_b32 v236, a118
    v_mul_f32 v236, v236, v232
    v_accvgpr_write_b32 a118, v236
    v_accvgpr_read_b32 v237, a119
    v_mul_f32 v237, v237, v232
    v_accvgpr_write_b32 a119, v237
    v_accvgpr_read_b32 v234, a120
    v_mul_f32 v234, v234, v232
    v_accvgpr_write_b32 a120, v234
    v_accvgpr_read_b32 v235, a121
    v_mul_f32 v235, v235, v232
    v_accvgpr_write_b32 a121, v235
    v_accvgpr_read_b32 v236, a122
    v_mul_f32 v236, v236, v232
    v_accvgpr_write_b32 a122, v236
    v_accvgpr_read_b32 v237, a123
    v_mul_f32 v237, v237, v232
    v_accvgpr_write_b32 a123, v237
    v_accvgpr_read_b32 v234, a124
    v_mul_f32 v234, v234, v232
    v_accvgpr_write_b32 a124, v234
    v_accvgpr_read_b32 v235, a125
    v_mul_f32 v235, v235, v232
    v_accvgpr_write_b32 a125, v235
    v_accvgpr_read_b32 v236, a126
    v_mul_f32 v236, v236, v232
    v_accvgpr_write_b32 a126, v236
    v_accvgpr_read_b32 v237, a127
    v_mul_f32 v237, v237, v232
    v_accvgpr_write_b32 a127, v237
    v_exp_f32 v138, v48
    v_exp_f32 v139, v49
    v_exp_f32 v130, v50
    v_exp_f32 v131, v51
    v_cvt_pk_bf16_f32 v120, v138, v139
    v_exp_f32 v132, v52
    v_exp_f32 v133, v53
    v_cvt_pk_bf16_f32 v121, v130, v131
    v_add_f32 v138, v138, v130
    v_add_f32 v139, v139, v131
    v_exp_f32 v134, v54
    v_exp_f32 v135, v55
    v_cvt_pk_bf16_f32 v122, v132, v133
    v_add_f32 v138, v138, v132
    v_add_f32 v139, v139, v133
    v_exp_f32 v128, v56
    v_exp_f32 v129, v57
    v_cvt_pk_bf16_f32 v123, v134, v135
    v_add_f32 v138, v138, v134
    v_add_f32 v139, v139, v135
    v_exp_f32 v130, v58
    v_exp_f32 v131, v59
    v_cvt_pk_bf16_f32 v124, v128, v129
    v_add_f32 v138, v138, v128
    v_add_f32 v139, v139, v129
    v_exp_f32 v132, v60
    v_exp_f32 v133, v61
    v_cvt_pk_bf16_f32 v125, v130, v131
    v_add_f32 v138, v138, v130
    v_add_f32 v139, v139, v131
    v_exp_f32 v134, v62
    v_exp_f32 v135, v63
    v_cvt_pk_bf16_f32 v126, v132, v133
    v_add_f32 v138, v138, v132
    v_add_f32 v139, v139, v133
    v_cvt_pk_bf16_f32 v127, v134, v135
    v_add_f32 v138, v138, v134
    v_add_f32 v139, v139, v135
    v_add_f32 v225, v138, v139
    s_nop 1
    s_branch kf_rr39
kf_spin41:
    s_mov_b32 s25, 0x400000
kf_spin41_l:
    s_sleep 2
    buffer_load_dword v254, off, s[88:91], s97 sc1
    s_waitcnt vmcnt(0)
    v_readfirstlane_b32 s24, v254
    s_sub_u32 s25, s25, 1
    s_cbranch_scc1 kf_spinr42
    s_cmp_ge_u32 s24, 1
    s_cbranch_scc0 kf_spin41_l
    s_branch kf_spinr42
kf_spin43:
    s_mov_b32 s25, 0x400000
kf_spin43_l:
    s_sleep 2
    buffer_load_dword v254, off, s[88:91], s39 sc1
    s_waitcnt vmcnt(0)
    v_readfirstlane_b32 s24, v254
    s_sub_u32 s25, s25, 1
    s_cbranch_scc1 kf_spinr44
    s_cmp_ge_u32 s24, 32
    s_cbranch_scc0 kf_spin43_l
    s_branch kf_spinr44
kf_spin45:
    s_mov_b32 s25, 0x400000
kf_spin45_l:
    s_sleep 2
    buffer_load_dword v254, off, s[88:91], s97 sc1
    s_waitcnt vmcnt(0)
    v_readfirstlane_b32 s24, v254
    s_sub_u32 s25, s25, 1
    s_cbranch_scc1 kf_spinr46
    s_cmp_ge_u32 s24, 1
    s_cbranch_scc0 kf_spin45_l
    s_branch kf_spinr46
kf_spin47:
    s_mov_b32 s25, 0x400000
kf_spin47_l:
    s_sleep 2
    buffer_load_dword v254, off, s[88:91], s39 sc1
    s_waitcnt vmcnt(0)
    v_readfirstlane_b32 s24, v254
    s_sub_u32 s25, s25, 1
    s_cbranch_scc1 kf_spinr48
    s_cmp_ge_u32 s24, 32
    s_cbranch_scc0 kf_spin47_l
    s_branch kf_spinr48
kf_spin49:
    s_mov_b32 s25, 0x400000
kf_spin49_l:
    s_sleep 2
    buffer_load_dword v254, off, s[88:91], s35 sc1
    s_waitcnt vmcnt(0)
    v_readfirstlane_b32 s24, v254
    s_sub_u32 s25, s25, 1
    s_cbranch_scc1 kf_spinr50
    s_cmp_ge_u32 s24, 8
    s_cbranch_scc0 kf_spin49_l
    s_branch kf_spinr50

code_end:
.section .rodata,"a"
.p2align 6
.amdhsa_kernel sequential_preLN__compressed_kv_cla__moe_arch_mod__prompt_kernel
  .amdhsa_next_free_vgpr 512
  .amdhsa_next_free_sgpr 102
  .amdhsa_accum_offset 256
  .amdhsa_group_segment_fixed_size 0
  .amdhsa_kernarg_size 112
  .amdhsa_user_sgpr_count 2
  .amdhsa_user_sgpr_kernarg_segment_ptr 1
  .amdhsa_system_sgpr_workgroup_id_x 1
  .amdhsa_float_denorm_mode_32 3
.end_amdhsa_kernel
```

```asm
; @launch grid=(256,1,1) block=(256,1,1) lds=163840
.amdgcn_target "amdgcn-amd-amdhsa--gfx950"
.text
.globl sequential_preLN__compressed_kv_cla__moe_arch_mod__prompt_kernel
.p2align 8
.type sequential_preLN__compressed_kv_cla__moe_arch_mod__prompt_kernel,@function
sequential_preLN__compressed_kv_cla__moe_arch_mod__prompt_kernel:
    s_cmp_ge_u32 s2, 256
    s_cbranch_scc1 ka_done
    s_load_dwordx8 s[64:71], s[0:1], 0
    s_load_dwordx4 s[72:75], s[0:1], 32
    s_load_dwordx4 s[76:79], s[0:1], 64
    s_load_dwordx8 s[8:15], s[0:1], 80
    v_lshrrev_b32 v1, 6, v0
    v_and_b32 v2, 63, v0
    v_readfirstlane_b32 s3, v1
    v_mov_b32 v253, v0
    s_and_b32 s4, s2, 7
    s_lshl_b32 s4, s4, 2
    s_lshr_b32 s24, s2, 3
    s_and_b32 s24, s24, 3
    s_add_u32 s4, s4, s24
    s_lshr_b32 s5, s2, 5
    s_lshl2_add_u32 s6, s5, s3
    s_getpc_b64 s[56:57]
ka_pc:
    s_mov_b32 s58, code_end-ka_pc
    s_mov_b32 s59, 0x00020000
    s_lshr_b32 s24, s2, 3
    s_lshl2_add_u32 s24, s24, s3
    s_lshl_b32 s24, s24, 13
    v_lshlrev_b32 v3, 7, v2
    buffer_load_dword v252, v3, s[56:59], s24 offen
    v_mov_b32 v192, v2
    v_lshrrev_b32 v198, 3, v192
    v_and_b32 v199, 7, v192
    s_lshr_b32 s24, s3, 1
    s_lshl_b32 s24, s24, 5
    s_and_b32 s25, s3, 1
    s_lshl_b32 s26, s25, 3
    s_add_u32 s24, s24, s26
    v_add_u32 v194, s24, v198
    v_lshlrev_b32 v194, 10, v194
    v_lshrrev_b32 v195, 1, v198
    v_xor_b32 v195, v199, v195
    v_lshl_add_u32 v232, v195, 4, v194
    v_xor_b32 v195, 4, v195
    v_lshl_add_u32 v233, v195, 4, v194
    v_add_u32 v233, 15360, v233
    s_lshl_b32 s24, s4, 8
    s_lshl_b32 s26, s25, 7
    s_add_u32 s24, s24, s26
    v_lshlrev_b32 v194, 13, v198
    v_add_u32 v194, s24, v194
    v_bfe_u32 v195, v198, 1, 1
    v_xor_b32 v195, v199, v195
    v_lshl_add_u32 v234, v195, 4, v194
    v_xor_b32 v195, 4, v195
    v_lshl_add_u32 v235, v195, 4, v194
    v_add_u32 v235, 64512, v235
    s_lshl_b32 s34, s3, 11
    s_mul_i32 s35, s3, 24576
    s_add_u32 s35, s35, 65536
    s_lshl_b32 s32, s5, 18
    s_and_b32 s7, s4, 3
    s_lshl1_add_u32 s7, s7, s5
    s_add_u32 s80, s7, 0
    s_and_b32 s80, s80, 7
    s_lshl_b32 s80, s80, 7
    s_add_u32 s80, s80, s32
    s_add_u32 s81, s7, 1
    s_and_b32 s81, s81, 7
    s_lshl_b32 s81, s81, 7
    s_add_u32 s81, s81, s32
    s_add_u32 s82, s7, 2
    s_and_b32 s82, s82, 7
    s_lshl_b32 s82, s82, 7
    s_add_u32 s82, s82, s32
    s_add_u32 s83, s7, 3
    s_and_b32 s83, s83, 7
    s_lshl_b32 s83, s83, 7
    s_add_u32 s83, s83, s32
    s_add_u32 s84, s7, 4
    s_and_b32 s84, s84, 7
    s_lshl_b32 s84, s84, 7
    s_add_u32 s84, s84, s32
    s_add_u32 s85, s7, 5
    s_and_b32 s85, s85, 7
    s_lshl_b32 s85, s85, 7
    s_add_u32 s85, s85, s32
    s_add_u32 s86, s7, 6
    s_and_b32 s86, s86, 7
    s_lshl_b32 s86, s86, 7
    s_add_u32 s86, s86, s32
    s_add_u32 s87, s7, 7
    s_and_b32 s87, s87, 7
    s_lshl_b32 s87, s87, 7
    s_add_u32 s87, s87, s32
    s_waitcnt lgkmcnt(0)
    s_cmp_lt_u32 s3, 2
    s_cselect_b32 s48, s70, s72
    s_cselect_b32 s49, s71, s73
    s_mov_b32 s50, 0x400000
    s_mov_b32 s51, 0x00020000
    s_mov_b32 s44, s66
    s_mov_b32 s45, s67
    s_mov_b32 s46, 0x200000
    s_mov_b32 s47, 0x00020000
    s_add_u32 m0, s35, 0
    s_and_b32 s33, s80, 1023
    s_lshl_b32 s33, s33, 12
    buffer_load_dwordx4 v234, s[48:51], s33 offen lds
    buffer_load_dwordx4 v235, s[48:51], s33 offen offset:1024 lds
    s_add_u32 m0, s35, 2048
    s_add_u32 s33, s33, 131072
    buffer_load_dwordx4 v234, s[48:51], s33 offen lds
    buffer_load_dwordx4 v235, s[48:51], s33 offen offset:1024 lds
    s_add_u32 m0, s35, 4096
    s_add_u32 s33, s33, 131072
    buffer_load_dwordx4 v234, s[48:51], s33 offen lds
    buffer_load_dwordx4 v235, s[48:51], s33 offen offset:1024 lds
    s_add_u32 m0, s35, 6144
    s_add_u32 s33, s33, 131072
    buffer_load_dwordx4 v234, s[48:51], s33 offen lds
    buffer_load_dwordx4 v235, s[48:51], s33 offen offset:1024 lds
    s_add_u32 m0, s34, 0
    s_add_u32 s37, s80, 0
    buffer_load_dwordx4 v232, s[44:47], s37 offen lds
    buffer_load_dwordx4 v233, s[44:47], s37 offen offset:1024 lds
    s_add_u32 m0, s34, 8192
    s_add_u32 s37, s80, 65536
    buffer_load_dwordx4 v232, s[44:47], s37 offen lds
    buffer_load_dwordx4 v233, s[44:47], s37 offen offset:1024 lds
    s_mov_b32 s52, s64
    s_mov_b32 s53, s65
    s_mov_b32 s54, 0x400000
    s_mov_b32 s55, 0x00020000
    s_add_u32 s16, s14, 0x5c00000
    s_addc_u32 s17, s15, 0
    s_mov_b32 s18, 0x2140000
    s_mov_b32 s19, 0x00020000
    s_add_u32 s56, s14, 0x3800000
    s_addc_u32 s57, s15, 0
    s_mov_b32 s58, 0x6040
    s_mov_b32 s59, 0x00020000
    s_add_u32 s20, s14, 0x2400000
    s_addc_u32 s21, s15, 0
    s_mov_b32 s22, 0x1000000
    s_mov_b32 s23, 0x00020000
    s_mov_b32 s88, s12
    s_mov_b32 s89, s13
    s_mov_b32 s90, 0x100
    s_mov_b32 s91, 0x00020000
    s_cmp_lt_u32 s3, 2
    s_cselect_b32 s60, s8, s74
    s_cselect_b32 s61, s9, s75
    s_mov_b32 s62, 0x800000
    s_cselect_b32 s62, 0x700000, s62
    s_mov_b32 s63, 0x00020000
    s_cselect_b32 s41, s76, s78
    s_cselect_b32 s42, s77, s79
    s_mov_b32 s8, s14
    s_mov_b32 s9, s15
    s_mov_b32 s10, 0x400000
    s_mov_b32 s11, 0x00020000
    s_mov_b32 s12, s68
    s_mov_b32 s13, s69
    s_mov_b32 s14, 0x800000
    s_mov_b32 s15, 0x00020000
    s_cmp_eq_u32 s2, 0
    s_mov_b32 s97, 0x40000000
    s_cselect_b32 s97, 0xa0000, s97
    s_mov_b32 s58, 0xa4000
    v_lshlrev_b32 v194, 7, v253
    v_mov_b32 v195, 0
    buffer_store_dword v195, v194, s[56:59], s97 offen sc1
    s_cselect_b32 s97, 0, 0x40000000
    s_mov_b32 s58, 0x6040
    s_add_u32 m0, s35, 8192
    s_and_b32 s33, s81, 1023
    s_lshl_b32 s33, s33, 12
    buffer_load_dwordx4 v234, s[48:51], s33 offen lds
    buffer_load_dwordx4 v235, s[48:51], s33 offen offset:1024 lds
    s_add_u32 m0, s35, 10240
    s_add_u32 s33, s33, 131072
    buffer_load_dwordx4 v234, s[48:51], s33 offen lds
    buffer_load_dwordx4 v235, s[48:51], s33 offen offset:1024 lds
    s_add_u32 m0, s35, 12288
    s_add_u32 s33, s33, 131072
    buffer_load_dwordx4 v234, s[48:51], s33 offen lds
    buffer_load_dwordx4 v235, s[48:51], s33 offen offset:1024 lds
    s_add_u32 m0, s35, 14336
    s_add_u32 s33, s33, 131072
    buffer_load_dwordx4 v234, s[48:51], s33 offen lds
    buffer_load_dwordx4 v235, s[48:51], s33 offen offset:1024 lds
    s_add_u32 m0, s34, 16384
    s_add_u32 s37, s81, 0
    buffer_load_dwordx4 v232, s[44:47], s37 offen lds
    buffer_load_dwordx4 v233, s[44:47], s37 offen offset:1024 lds
    s_add_u32 m0, s34, 24576
    s_add_u32 s37, s81, 65536
    buffer_load_dwordx4 v232, s[44:47], s37 offen lds
    buffer_load_dwordx4 v233, s[44:47], s37 offen offset:1024 lds
    v_and_b32 v200, 15, v192
    v_lshrrev_b32 v201, 4, v192
    v_lshrrev_b32 v194, 1, v200
    v_xor_b32 v194, v201, v194
    v_lshlrev_b32 v194, 4, v194
    v_lshl_add_u32 v224, v200, 7, v194
    v_xor_b32 v225, 64, v224
    v_lshrrev_b32 v194, 2, v200
    v_lshl_add_u32 v195, v201, 3, v194
    v_lshlrev_b32 v195, 7, v195
    v_add_u32 v195, s35, v195
    v_and_b32 v196, 1, v200
    v_lshl_add_u32 v195, v196, 3, v195
    v_lshrrev_b32 v194, 1, v194
    v_and_b32 v196, 1, v201
    v_lshl_or_b32 v194, v196, 2, v194
    v_and_b32 v196, 2, v200
    v_xor_b32 v194, v194, v196
    v_xor_b32 v196, 0, v194
    v_lshl_add_u32 v228, v196, 4, v195
    v_xor_b32 v196, 1, v194
    v_lshl_add_u32 v229, v196, 4, v195
    v_xor_b32 v196, 4, v194
    v_lshl_add_u32 v230, v196, 4, v195
    v_xor_b32 v196, 5, v194
    v_lshl_add_u32 v231, v196, 4, v195
    s_mul_i32 s36, s4, 1089536
    s_mul_i32 s24, s5, 136192
    s_add_u32 s36, s36, s24
    s_and_b32 s24, s3, 1
    s_lshl_b32 s24, s24, 12
    s_and_b32 s26, s3, 2
    s_lshl_b32 s26, s26, 13
    s_add_u32 s36, s36, s24
    s_add_u32 s36, s36, s26
    v_bfe_u32 v194, v192, 3, 1
    v_lshlrev_b32 v194, 10, v194
    v_lshrrev_b32 v195, 5, v192
    v_lshl_add_u32 v194, v195, 8, v194
    v_bfe_u32 v195, v192, 4, 1
    v_lshl_add_u32 v194, v195, 7, v194
    v_lshl_add_u32 v239, v199, 4, v194
    s_lshl_b32 s24, s5, 7
    s_sub_u32 s26, 1792, s24
    s_cmp_lt_u32 s4, 16
    s_cselect_b32 s24, s24, s26
    s_lshl_b32 s26, s4, 3
    s_add_u32 s24, s24, s26
    v_lshrrev_b32 v194, 5, v253
    v_add_u32 v196, s24, v194
    v_and_b32 v195, 31, v192
    v_lshlrev_b32 v196, 11, v196
    v_lshl_add_u32 v236, v195, 4, v196
    v_xor_b32 v194, v194, v199
    v_lshlrev_b32 v194, 4, v194
    v_lshl_add_u32 v194, v195, 7, v194
    v_add_u32 v237, 81920, v194
    s_lshr_b32 s26, s24, 4
    s_lshl_b32 s26, s26, 15
    s_and_b32 s24, s24, 15
    s_lshl_b32 s24, s24, 4
    s_add_u32 s24, s24, s26
    v_lshrrev_b32 v194, 3, v253
    v_lshlrev_b32 v194, 8, v194
    v_xor_b32 v195, v199, v198
    v_lshl_add_u32 v194, v195, 4, v194
    v_add_u32 v238, s24, v194
    v_lshlrev_b32 v240, 4, v192
    s_lshl_b32 s24, s3, 12
    v_add_u32 v242, s24, v240
    s_lshl_b32 s24, s6, 16
    v_add_u32 v248, s24, v240
    s_sub_u32 s25, 63, s6
    s_lshl_b32 s24, s25, 16
    v_add_u32 v249, s24, v240
    v_bfe_u32 v194, v192, 2, 2
    v_lshlrev_b32 v194, 13, v194
    v_lshl_add_u32 v194, v201, 6, v194
    v_and_b32 v195, 3, v192
    v_lshl_add_u32 v194, v195, 4, v194
    s_lshl_b32 s24, s4, 8
    s_lshl_b32 s25, s3, 18
    s_add_u32 s24, s24, s25
    v_add_u32 v245, s24, v194
    s_lshl_b32 s31, s3, 13
    s_add_u32 s31, s31, 65536
    s_lshl_b32 s27, s5, 20
    s_mov_b32 s7, s27
    s_mov_b32 s43, 0x40000000
    s_lshr_b32 s28, s27, 8
    s_add_u32 s29, s28, 32768
    s_nop 0
    v_lshlrev_b32 v194, 11, v201
    v_bfe_u32 v195, v192, 2, 2
    v_lshl_add_u32 v194, v195, 6, v194
    v_bfe_u32 v195, v192, 4, 1
    v_lshl_add_u32 v194, v195, 5, v194
    v_and_b32 v195, 1, v192
    v_lshl_add_u32 v194, v195, 4, v194
    v_bfe_u32 v195, v192, 1, 1
    v_lshl_add_u32 v247, v195, 3, v194
    s_mov_b32 s30, 65536
    v_add_u32 v246, s30, v247
    v_and_b32 v194, 31, v192
    v_lshrrev_b32 v195, 5, v192
    v_lshlrev_b32 v195, 2, v195
    v_sub_u32 v194, v194, v195
    v_cvt_f32_i32 v194, v194
    v_add_f32 v194, 0.5, v194
    v_mul_f32 v243, 0x71800000, v194
    v_bfe_u32 v194, v192, 4, 1
    v_lshlrev_b32 v194, 17, v194
    v_lshrrev_b32 v195, 5, v192
    v_lshl_add_u32 v194, v195, 8, v194
    v_lshl_add_u32 v244, v200, 4, v194
    v_lshlrev_b32 v251, 7, v192
    v_cmp_gt_u32 vcc, 16, v192
    v_mov_b32 v194, 0x40000000
    v_mov_b32 v255, 1
    v_cndmask_b32 v251, v194, v251, vcc
    v_cmp_eq_u32 vcc, 0, v253
    s_nop 1
    v_cndmask_b32 v250, v194, v253, vcc
    s_waitcnt vmcnt(12)
    s_barrier
    ds_read_b128 v[64:67], v224 offset:0
    ds_read_b128 v[68:71], v224 offset:2048
    ds_read_b128 v[72:75], v224 offset:4096
    ds_read_b128 v[76:79], v224 offset:6144
    ds_read_b64_tr_b16 a[0:1], v228 offset:0
    ds_read_b64_tr_b16 a[2:3], v228 offset:512
    ds_read_b64_tr_b16 a[4:5], v229 offset:0
    ds_read_b64_tr_b16 a[6:7], v229 offset:512
    ds_read_b64_tr_b16 a[8:9], v230 offset:0
    ds_read_b64_tr_b16 a[10:11], v230 offset:512
    ds_read_b64_tr_b16 a[12:13], v231 offset:0
    ds_read_b64_tr_b16 a[14:15], v231 offset:512
    buffer_store_dword v255, v250, s[88:91], s97 offen sc1
    s_cmp_eq_u32 s3, 0
    s_cselect_b32 s97, 0, s43
    s_cmp_lt_u32 s3, 2
    s_cbranch_scc0 ka_V
    s_waitcnt lgkmcnt(0)
    v_mfma_f32_16x16x32_bf16 v[96:99], a[0:3], v[64:67], 0
    ds_read_b128 v[80:83], v224 offset:8192
    v_mfma_f32_16x16x32_bf16 v[100:103], a[4:7], v[64:67], 0
    ds_read_b128 v[84:87], v224 offset:10240
    v_mfma_f32_16x16x32_bf16 v[104:107], a[8:11], v[64:67], 0
    ds_read_b128 v[88:91], v224 offset:12288
    v_mfma_f32_16x16x32_bf16 v[108:111], a[12:15], v[64:67], 0
    ds_read_b128 v[92:95], v224 offset:14336
    v_mfma_f32_16x16x32_bf16 v[112:115], a[0:3], v[68:71], 0
    ds_read_b64_tr_b16 a[16:17], v228 offset:4096
    v_mfma_f32_16x16x32_bf16 v[116:119], a[4:7], v[68:71], 0
    ds_read_b64_tr_b16 a[18:19], v228 offset:4608
    v_mfma_f32_16x16x32_bf16 v[120:123], a[8:11], v[68:71], 0
    ds_read_b64_tr_b16 a[20:21], v229 offset:4096
    v_mfma_f32_16x16x32_bf16 v[124:127], a[12:15], v[68:71], 0
    ds_read_b64_tr_b16 a[22:23], v229 offset:4608
    v_mfma_f32_16x16x32_bf16 v[128:131], a[0:3], v[72:75], 0
    s_add_u32 m0, s35, 16384
    s_and_b32 s33, s82, 1023
    s_lshl_b32 s33, s33, 12
    buffer_load_dwordx4 v234, s[48:51], s33 offen lds
    v_mfma_f32_16x16x32_bf16 v[132:135], a[4:7], v[72:75], 0
    buffer_load_dwordx4 v235, s[48:51], s33 offen offset:1024 lds
    v_mfma_f32_16x16x32_bf16 v[136:139], a[8:11], v[72:75], 0
    s_add_u32 m0, s35, 18432
    s_add_u32 s33, s33, 131072
    buffer_load_dwordx4 v234, s[48:51], s33 offen lds
    v_mfma_f32_16x16x32_bf16 v[140:143], a[12:15], v[72:75], 0
    v_mfma_f32_16x16x32_bf16 v[144:147], a[0:3], v[76:79], 0
    buffer_load_dwordx4 v235, s[48:51], s33 offen offset:1024 lds
    v_mfma_f32_16x16x32_bf16 v[148:151], a[4:7], v[76:79], 0
    buffer_load_dwordx4 v[0:3], v236, s[52:55], 0 offen offset:0
    v_mfma_f32_16x16x32_bf16 v[152:155], a[8:11], v[76:79], 0
    buffer_load_dwordx4 v[4:7], v236, s[52:55], 0 offen offset:512
    v_mfma_f32_16x16x32_bf16 v[156:159], a[12:15], v[76:79], 0
    s_waitcnt lgkmcnt(0)
    v_mfma_f32_16x16x32_bf16 v[160:163], a[0:3], v[80:83], 0
    ds_read_b128 v[64:67], v225 offset:0
    v_mfma_f32_16x16x32_bf16 v[164:167], a[4:7], v[80:83], 0
    ds_read_b128 v[68:71], v225 offset:2048
    v_mfma_f32_16x16x32_bf16 v[168:171], a[8:11], v[80:83], 0
    ds_read_b128 v[72:75], v225 offset:4096
    v_mfma_f32_16x16x32_bf16 v[172:175], a[12:15], v[80:83], 0
    ds_read_b128 v[76:79], v225 offset:6144
    v_mfma_f32_16x16x32_bf16 v[176:179], a[0:3], v[84:87], 0
    ds_read_b64_tr_b16 a[24:25], v230 offset:4096
    v_mfma_f32_16x16x32_bf16 v[180:183], a[4:7], v[84:87], 0
    ds_read_b64_tr_b16 a[26:27], v230 offset:4608
    v_mfma_f32_16x16x32_bf16 v[184:187], a[8:11], v[84:87], 0
    ds_read_b64_tr_b16 a[28:29], v231 offset:4096
    v_mfma_f32_16x16x32_bf16 v[188:191], a[12:15], v[84:87], 0
    ds_read_b64_tr_b16 a[30:31], v231 offset:4608
    v_mfma_f32_16x16x32_bf16 v[192:195], a[0:3], v[88:91], 0
    s_add_u32 m0, s35, 20480
    s_add_u32 s33, s33, 131072
    buffer_load_dwordx4 v234, s[48:51], s33 offen lds
    v_mfma_f32_16x16x32_bf16 v[196:199], a[4:7], v[88:91], 0
    buffer_load_dwordx4 v235, s[48:51], s33 offen offset:1024 lds
    v_mfma_f32_16x16x32_bf16 v[200:203], a[8:11], v[88:91], 0
    s_add_u32 m0, s35, 22528
    s_add_u32 s33, s33, 131072
    buffer_load_dwordx4 v234, s[48:51], s33 offen lds
    v_mfma_f32_16x16x32_bf16 v[204:207], a[12:15], v[88:91], 0
    v_mfma_f32_16x16x32_bf16 v[208:211], a[0:3], v[92:95], 0
    buffer_load_dwordx4 v235, s[48:51], s33 offen offset:1024 lds
    v_mfma_f32_16x16x32_bf16 v[212:215], a[4:7], v[92:95], 0
    buffer_load_dwordx4 v[8:11], v236, s[52:55], 0 offen offset:1024
    v_mfma_f32_16x16x32_bf16 v[216:219], a[8:11], v[92:95], 0
    buffer_load_dwordx4 v[12:15], v236, s[52:55], 0 offen offset:1536
    v_mfma_f32_16x16x32_bf16 v[220:223], a[12:15], v[92:95], 0
    s_waitcnt vmcnt(17) lgkmcnt(0)
    v_mfma_f32_16x16x32_bf16 v[96:99], a[16:19], v[64:67], v[96:99]
    ds_read_b128 v[80:83], v225 offset:8192
    v_mfma_f32_16x16x32_bf16 v[100:103], a[20:23], v[64:67], v[100:103]
    ds_read_b128 v[84:87], v225 offset:10240
    v_mfma_f32_16x16x32_bf16 v[104:107], a[24:27], v[64:67], v[104:107]
    ds_read_b128 v[88:91], v225 offset:12288
    v_mfma_f32_16x16x32_bf16 v[108:111], a[28:31], v[64:67], v[108:111]
    ds_read_b128 v[92:95], v225 offset:14336
    v_mfma_f32_16x16x32_bf16 v[112:115], a[16:19], v[68:71], v[112:115]
    ds_read_b64_tr_b16 a[32:33], v228 offset:8192
    v_mfma_f32_16x16x32_bf16 v[116:119], a[20:23], v[68:71], v[116:119]
    ds_read_b64_tr_b16 a[34:35], v228 offset:8704
    v_mfma_f32_16x16x32_bf16 v[120:123], a[24:27], v[68:71], v[120:123]
    ds_read_b64_tr_b16 a[36:37], v229 offset:8192
    v_mfma_f32_16x16x32_bf16 v[124:127], a[28:31], v[68:71], v[124:127]
    ds_read_b64_tr_b16 a[38:39], v229 offset:8704
    v_mfma_f32_16x16x32_bf16 v[128:131], a[16:19], v[72:75], v[128:131]
    s_add_u32 m0, s34, 32768
    s_add_u32 s37, s82, 0
    buffer_load_dwordx4 v232, s[44:47], s37 offen lds
    v_mfma_f32_16x16x32_bf16 v[132:135], a[20:23], v[72:75], v[132:135]
    buffer_load_dwordx4 v233, s[44:47], s37 offen offset:1024 lds
    v_mfma_f32_16x16x32_bf16 v[136:139], a[24:27], v[72:75], v[136:139]
    s_add_u32 m0, s34, 40960
    s_add_u32 s37, s82, 65536
    buffer_load_dwordx4 v232, s[44:47], s37 offen lds
    v_mfma_f32_16x16x32_bf16 v[140:143], a[28:31], v[72:75], v[140:143]
    buffer_load_dwordx4 v233, s[44:47], s37 offen offset:1024 lds
    v_mfma_f32_16x16x32_bf16 v[144:147], a[16:19], v[76:79], v[144:147]
    s_add_u32 m0, s35, 0
    s_and_b32 s33, s83, 1023
    s_lshl_b32 s33, s33, 12
    buffer_load_dwordx4 v234, s[48:51], s33 offen lds
    v_mfma_f32_16x16x32_bf16 v[148:151], a[20:23], v[76:79], v[148:151]
    buffer_load_dwordx4 v235, s[48:51], s33 offen offset:1024 lds
    v_mfma_f32_16x16x32_bf16 v[152:155], a[24:27], v[76:79], v[152:155]
    s_add_u32 m0, s35, 2048
    s_add_u32 s33, s33, 131072
    buffer_load_dwordx4 v234, s[48:51], s33 offen lds
    v_mfma_f32_16x16x32_bf16 v[156:159], a[28:31], v[76:79], v[156:159]
    buffer_load_dwordx4 v235, s[48:51], s33 offen offset:1024 lds
    s_waitcnt vmcnt(21) lgkmcnt(0)
    s_barrier
    v_mfma_f32_16x16x32_bf16 v[160:163], a[16:19], v[80:83], v[160:163]
    ds_read_b128 v[64:67], v224 offset:16384
    v_mfma_f32_16x16x32_bf16 v[164:167], a[20:23], v[80:83], v[164:167]
    ds_read_b128 v[68:71], v224 offset:18432
    v_mfma_f32_16x16x32_bf16 v[168:171], a[24:27], v[80:83], v[168:171]
    ds_read_b128 v[72:75], v224 offset:20480
    v_mfma_f32_16x16x32_bf16 v[172:175], a[28:31], v[80:83], v[172:175]
    ds_read_b128 v[76:79], v224 offset:22528
    v_mfma_f32_16x16x32_bf16 v[176:179], a[16:19], v[84:87], v[176:179]
    ds_read_b64_tr_b16 a[40:41], v230 offset:8192
    v_mfma_f32_16x16x32_bf16 v[180:183], a[20:23], v[84:87], v[180:183]
    ds_read_b64_tr_b16 a[42:43], v230 offset:8704
    v_mfma_f32_16x16x32_bf16 v[184:187], a[24:27], v[84:87], v[184:187]
    ds_read_b64_tr_b16 a[44:45], v231 offset:8192
    v_mfma_f32_16x16x32_bf16 v[188:191], a[28:31], v[84:87], v[188:191]
    ds_read_b64_tr_b16 a[46:47], v231 offset:8704
    v_mfma_f32_16x16x32_bf16 v[192:195], a[16:19], v[88:91], v[192:195]
    s_add_u32 m0, s34, 49152
    s_add_u32 s37, s83, 0
    buffer_load_dwordx4 v232, s[44:47], s37 offen lds
    v_mfma_f32_16x16x32_bf16 v[196:199], a[20:23], v[88:91], v[196:199]
    buffer_load_dwordx4 v233, s[44:47], s37 offen offset:1024 lds
    v_mfma_f32_16x16x32_bf16 v[200:203], a[24:27], v[88:91], v[200:203]
    s_add_u32 m0, s34, 57344
    s_add_u32 s37, s83, 65536
    buffer_load_dwordx4 v232, s[44:47], s37 offen lds
    v_mfma_f32_16x16x32_bf16 v[204:207], a[28:31], v[88:91], v[204:207]
    v_mfma_f32_16x16x32_bf16 v[208:211], a[16:19], v[92:95], v[208:211]
    buffer_load_dwordx4 v233, s[44:47], s37 offen offset:1024 lds
    v_mfma_f32_16x16x32_bf16 v[212:215], a[20:23], v[92:95], v[212:215]
    s_add_u32 m0, s34, 0
    s_add_u32 s37, s84, 0
    buffer_load_dwordx4 v232, s[44:47], s37 offen lds
    v_mfma_f32_16x16x32_bf16 v[216:219], a[24:27], v[92:95], v[216:219]
    buffer_load_dwordx4 v233, s[44:47], s37 offen offset:1024 lds
    v_mfma_f32_16x16x32_bf16 v[220:223], a[28:31], v[92:95], v[220:223]
    s_waitcnt lgkmcnt(0)
    v_mfma_f32_16x16x32_bf16 v[96:99], a[32:35], v[64:67], v[96:99]
    ds_read_b128 v[80:83], v224 offset:24576
    v_mfma_f32_16x16x32_bf16 v[100:103], a[36:39], v[64:67], v[100:103]
    ds_read_b128 v[84:87], v224 offset:26624
    v_mfma_f32_16x16x32_bf16 v[104:107], a[40:43], v[64:67], v[104:107]
    ds_read_b128 v[88:91], v224 offset:28672
    v_mfma_f32_16x16x32_bf16 v[108:111], a[44:47], v[64:67], v[108:111]
    ds_read_b128 v[92:95], v224 offset:30720
    v_mfma_f32_16x16x32_bf16 v[112:115], a[32:35], v[68:71], v[112:115]
    ds_read_b64_tr_b16 a[48:49], v228 offset:12288
    v_mfma_f32_16x16x32_bf16 v[116:119], a[36:39], v[68:71], v[116:119]
    ds_read_b64_tr_b16 a[50:51], v228 offset:12800
    v_mfma_f32_16x16x32_bf16 v[120:123], a[40:43], v[68:71], v[120:123]
    ds_read_b64_tr_b16 a[52:53], v229 offset:12288
    v_mfma_f32_16x16x32_bf16 v[124:127], a[44:47], v[68:71], v[124:127]
    ds_read_b64_tr_b16 a[54:55], v229 offset:12800
    v_mfma_f32_16x16x32_bf16 v[128:131], a[32:35], v[72:75], v[128:131]
    s_add_u32 m0, s35, 4096
    s_add_u32 s33, s33, 131072
    buffer_load_dwordx4 v234, s[48:51], s33 offen lds
    v_mfma_f32_16x16x32_bf16 v[132:135], a[36:39], v[72:75], v[132:135]
    v_mfma_f32_16x16x32_bf16 v[136:139], a[40:43], v[72:75], v[136:139]
    buffer_load_dwordx4 v235, s[48:51], s33 offen offset:1024 lds
    v_mfma_f32_16x16x32_bf16 v[140:143], a[44:47], v[72:75], v[140:143]
    v_mfma_f32_16x16x32_bf16 v[144:147], a[32:35], v[76:79], v[144:147]
    s_add_u32 m0, s35, 6144
    s_add_u32 s33, s33, 131072
    buffer_load_dwordx4 v234, s[48:51], s33 offen lds
    v_mfma_f32_16x16x32_bf16 v[148:151], a[36:39], v[76:79], v[148:151]
    v_mfma_f32_16x16x32_bf16 v[152:155], a[40:43], v[76:79], v[152:155]
    buffer_load_dwordx4 v235, s[48:51], s33 offen offset:1024 lds
    v_mfma_f32_16x16x32_bf16 v[156:159], a[44:47], v[76:79], v[156:159]
    s_waitcnt lgkmcnt(0)
    v_mfma_f32_16x16x32_bf16 v[160:163], a[32:35], v[80:83], v[160:163]
    ds_read_b128 v[64:67], v225 offset:16384
    v_mfma_f32_16x16x32_bf16 v[164:167], a[36:39], v[80:83], v[164:167]
    ds_read_b128 v[68:71], v225 offset:18432
    v_mfma_f32_16x16x32_bf16 v[168:171], a[40:43], v[80:83], v[168:171]
    ds_read_b128 v[72:75], v225 offset:20480
    v_mfma_f32_16x16x32_bf16 v[172:175], a[44:47], v[80:83], v[172:175]
    ds_read_b128 v[76:79], v225 offset:22528
    v_mfma_f32_16x16x32_bf16 v[176:179], a[32:35], v[84:87], v[176:179]
    ds_read_b64_tr_b16 a[56:57], v230 offset:12288
    v_mfma_f32_16x16x32_bf16 v[180:183], a[36:39], v[84:87], v[180:183]
    ds_read_b64_tr_b16 a[58:59], v230 offset:12800
    v_mfma_f32_16x16x32_bf16 v[184:187], a[40:43], v[84:87], v[184:187]
    ds_read_b64_tr_b16 a[60:61], v231 offset:12288
    v_mfma_f32_16x16x32_bf16 v[188:191], a[44:47], v[84:87], v[188:191]
    ds_read_b64_tr_b16 a[62:63], v231 offset:12800
    v_mfma_f32_16x16x32_bf16 v[192:195], a[32:35], v[88:91], v[192:195]
    s_add_u32 m0, s34, 8192
    s_add_u32 s37, s84, 65536
    buffer_load_dwordx4 v232, s[44:47], s37 offen lds
    v_mfma_f32_16x16x32_bf16 v[196:199], a[36:39], v[88:91], v[196:199]
    v_mfma_f32_16x16x32_bf16 v[200:203], a[40:43], v[88:91], v[200:203]
    v_mfma_f32_16x16x32_bf16 v[204:207], a[44:47], v[88:91], v[204:207]
    v_mfma_f32_16x16x32_bf16 v[208:211], a[32:35], v[92:95], v[208:211]
    buffer_load_dwordx4 v233, s[44:47], s37 offen offset:1024 lds
    v_mfma_f32_16x16x32_bf16 v[212:215], a[36:39], v[92:95], v[212:215]
    v_mfma_f32_16x16x32_bf16 v[216:219], a[40:43], v[92:95], v[216:219]
    v_mfma_f32_16x16x32_bf16 v[220:223], a[44:47], v[92:95], v[220:223]
    s_waitcnt vmcnt(22) lgkmcnt(0)
    v_mfma_f32_16x16x32_bf16 v[96:99], a[48:51], v[64:67], v[96:99]
    ds_read_b128 v[80:83], v225 offset:24576
    v_mfma_f32_16x16x32_bf16 v[100:103], a[52:55], v[64:67], v[100:103]
    ds_read_b128 v[84:87], v225 offset:26624
    v_mfma_f32_16x16x32_bf16 v[104:107], a[56:59], v[64:67], v[104:107]
    ds_read_b128 v[88:91], v225 offset:28672
    v_mfma_f32_16x16x32_bf16 v[108:111], a[60:63], v[64:67], v[108:111]
    ds_read_b128 v[92:95], v225 offset:30720
    v_mfma_f32_16x16x32_bf16 v[112:115], a[48:51], v[68:71], v[112:115]
    ds_read_b64_tr_b16 a[64:65], v228 offset:16384
    v_mfma_f32_16x16x32_bf16 v[116:119], a[52:55], v[68:71], v[116:119]
    ds_read_b64_tr_b16 a[66:67], v228 offset:16896
    v_mfma_f32_16x16x32_bf16 v[120:123], a[56:59], v[68:71], v[120:123]
    ds_read_b64_tr_b16 a[68:69], v229 offset:16384
    v_mfma_f32_16x16x32_bf16 v[124:127], a[60:63], v[68:71], v[124:127]
    ds_read_b64_tr_b16 a[70:71], v229 offset:16896
    v_mfma_f32_16x16x32_bf16 v[128:131], a[48:51], v[72:75], v[128:131]
    s_add_u32 m0, s35, 8192
    s_and_b32 s33, s84, 1023
    s_lshl_b32 s33, s33, 12
    buffer_load_dwordx4 v234, s[48:51], s33 offen lds
    v_mfma_f32_16x16x32_bf16 v[132:135], a[52:55], v[72:75], v[132:135]
    v_mfma_f32_16x16x32_bf16 v[136:139], a[56:59], v[72:75], v[136:139]
    buffer_load_dwordx4 v235, s[48:51], s33 offen offset:1024 lds
    v_mfma_f32_16x16x32_bf16 v[140:143], a[60:63], v[72:75], v[140:143]
    v_mfma_f32_16x16x32_bf16 v[144:147], a[48:51], v[76:79], v[144:147]
    s_add_u32 m0, s35, 10240
    s_add_u32 s33, s33, 131072
    buffer_load_dwordx4 v234, s[48:51], s33 offen lds
    v_mfma_f32_16x16x32_bf16 v[148:151], a[52:55], v[76:79], v[148:151]
    v_mfma_f32_16x16x32_bf16 v[152:155], a[56:59], v[76:79], v[152:155]
    buffer_load_dwordx4 v235, s[48:51], s33 offen offset:1024 lds
    v_mfma_f32_16x16x32_bf16 v[156:159], a[60:63], v[76:79], v[156:159]
    s_waitcnt vmcnt(20) lgkmcnt(0)
    s_barrier
    v_mfma_f32_16x16x32_bf16 v[160:163], a[48:51], v[80:83], v[160:163]
    ds_read_b128 v[64:67], v224 offset:32768
    v_mfma_f32_16x16x32_bf16 v[164:167], a[52:55], v[80:83], v[164:167]
    ds_read_b128 v[68:71], v224 offset:34816
    v_mfma_f32_16x16x32_bf16 v[168:171], a[56:59], v[80:83], v[168:171]
    ds_read_b128 v[72:75], v224 offset:36864
    v_mfma_f32_16x16x32_bf16 v[172:175], a[60:63], v[80:83], v[172:175]
    ds_read_b128 v[76:79], v224 offset:38912
    v_mfma_f32_16x16x32_bf16 v[176:179], a[48:51], v[84:87], v[176:179]
    ds_read_b64_tr_b16 a[72:73], v230 offset:16384
    v_mfma_f32_16x16x32_bf16 v[180:183], a[52:55], v[84:87], v[180:183]
    ds_read_b64_tr_b16 a[74:75], v230 offset:16896
    v_mfma_f32_16x16x32_bf16 v[184:187], a[56:59], v[84:87], v[184:187]
    ds_read_b64_tr_b16 a[76:77], v231 offset:16384
    v_mfma_f32_16x16x32_bf16 v[188:191], a[60:63], v[84:87], v[188:191]
    ds_read_b64_tr_b16 a[78:79], v231 offset:16896
    v_mfma_f32_16x16x32_bf16 v[192:195], a[48:51], v[88:91], v[192:195]
    s_add_u32 m0, s34, 16384
    s_add_u32 s37, s85, 0
    buffer_load_dwordx4 v232, s[44:47], s37 offen lds
    v_mfma_f32_16x16x32_bf16 v[196:199], a[52:55], v[88:91], v[196:199]
    v_mfma_f32_16x16x32_bf16 v[200:203], a[56:59], v[88:91], v[200:203]
    v_mfma_f32_16x16x32_bf16 v[204:207], a[60:63], v[88:91], v[204:207]
    v_mfma_f32_16x16x32_bf16 v[208:211], a[48:51], v[92:95], v[208:211]
    buffer_load_dwordx4 v233, s[44:47], s37 offen offset:1024 lds
    v_mfma_f32_16x16x32_bf16 v[212:215], a[52:55], v[92:95], v[212:215]
    v_mfma_f32_16x16x32_bf16 v[216:219], a[56:59], v[92:95], v[216:219]
    v_mfma_f32_16x16x32_bf16 v[220:223], a[60:63], v[92:95], v[220:223]
    s_waitcnt lgkmcnt(0)
    v_mfma_f32_16x16x32_bf16 v[96:99], a[64:67], v[64:67], v[96:99]
    ds_read_b128 v[80:83], v224 offset:40960
    s_waitcnt vmcnt(26)
    v_mfma_f32_16x16x32_bf16 v[100:103], a[68:71], v[64:67], v[100:103]
    ds_read_b128 v[84:87], v224 offset:43008
    v_lshlrev_b32 v16, 16, v0
    v_mfma_f32_16x16x32_bf16 v[104:107], a[72:75], v[64:67], v[104:107]
    ds_read_b128 v[88:91], v224 offset:45056
    v_and_b32 v17, 0xffff0000, v0
    v_mfma_f32_16x16x32_bf16 v[108:111], a[76:79], v[64:67], v[108:111]
    ds_read_b128 v[92:95], v224 offset:47104
    v_lshlrev_b32 v18, 16, v1
    v_mfma_f32_16x16x32_bf16 v[112:115], a[64:67], v[68:71], v[112:115]
    ds_read_b64_tr_b16 a[80:81], v228 offset:20480
    v_and_b32 v19, 0xffff0000, v1
    v_mfma_f32_16x16x32_bf16 v[116:119], a[68:71], v[68:71], v[116:119]
    ds_read_b64_tr_b16 a[82:83], v228 offset:20992
    v_lshlrev_b32 v20, 16, v2
    v_mfma_f32_16x16x32_bf16 v[120:123], a[72:75], v[68:71], v[120:123]
    ds_read_b64_tr_b16 a[84:85], v229 offset:20480
    v_and_b32 v21, 0xffff0000, v2
    v_mfma_f32_16x16x32_bf16 v[124:127], a[76:79], v[68:71], v[124:127]
    ds_read_b64_tr_b16 a[86:87], v229 offset:20992
    v_lshlrev_b32 v22, 16, v3
    v_mfma_f32_16x16x32_bf16 v[128:131], a[64:67], v[72:75], v[128:131]
    s_add_u32 m0, s35, 12288
    s_add_u32 s33, s33, 131072
    buffer_load_dwordx4 v234, s[48:51], s33 offen lds
    v_mfma_f32_16x16x32_bf16 v[132:135], a[68:71], v[72:75], v[132:135]
    v_and_b32 v23, 0xffff0000, v3
    v_lshlrev_b32 v24, 16, v4
    v_mfma_f32_16x16x32_bf16 v[136:139], a[72:75], v[72:75], v[136:139]
    buffer_load_dwordx4 v235, s[48:51], s33 offen offset:1024 lds
    v_and_b32 v25, 0xffff0000, v4
    v_mfma_f32_16x16x32_bf16 v[140:143], a[76:79], v[72:75], v[140:143]
    v_lshlrev_b32 v26, 16, v5
    v_and_b32 v27, 0xffff0000, v5
    v_mfma_f32_16x16x32_bf16 v[144:147], a[64:67], v[76:79], v[144:147]
    s_add_u32 m0, s35, 14336
    s_add_u32 s33, s33, 131072
    buffer_load_dwordx4 v234, s[48:51], s33 offen lds
    v_mfma_f32_16x16x32_bf16 v[148:151], a[68:71], v[76:79], v[148:151]
    v_lshlrev_b32 v28, 16, v6
    v_and_b32 v29, 0xffff0000, v6
    v_mfma_f32_16x16x32_bf16 v[152:155], a[72:75], v[76:79], v[152:155]
    buffer_load_dwordx4 v235, s[48:51], s33 offen offset:1024 lds
    v_lshlrev_b32 v30, 16, v7
    v_mfma_f32_16x16x32_bf16 v[156:159], a[76:79], v[76:79], v[156:159]
    v_and_b32 v31, 0xffff0000, v7
    s_waitcnt lgkmcnt(0)
    v_mfma_f32_16x16x32_bf16 v[160:163], a[64:67], v[80:83], v[160:163]
    ds_read_b128 v[64:67], v225 offset:32768
    v_lshlrev_b32 v32, 16, v8
    v_mfma_f32_16x16x32_bf16 v[164:167], a[68:71], v[80:83], v[164:167]
    ds_read_b128 v[68:71], v225 offset:34816
    v_and_b32 v33, 0xffff0000, v8
    v_mfma_f32_16x16x32_bf16 v[168:171], a[72:75], v[80:83], v[168:171]
    ds_read_b128 v[72:75], v225 offset:36864
    v_lshlrev_b32 v34, 16, v9
    v_mfma_f32_16x16x32_bf16 v[172:175], a[76:79], v[80:83], v[172:175]
    ds_read_b128 v[76:79], v225 offset:38912
    v_and_b32 v35, 0xffff0000, v9
    v_mfma_f32_16x16x32_bf16 v[176:179], a[64:67], v[84:87], v[176:179]
    ds_read_b64_tr_b16 a[88:89], v230 offset:20480
    v_lshlrev_b32 v36, 16, v10
    v_mfma_f32_16x16x32_bf16 v[180:183], a[68:71], v[84:87], v[180:183]
    ds_read_b64_tr_b16 a[90:91], v230 offset:20992
    v_and_b32 v37, 0xffff0000, v10
    v_mfma_f32_16x16x32_bf16 v[184:187], a[72:75], v[84:87], v[184:187]
    ds_read_b64_tr_b16 a[92:93], v231 offset:20480
    v_lshlrev_b32 v38, 16, v11
    v_mfma_f32_16x16x32_bf16 v[188:191], a[76:79], v[84:87], v[188:191]
    ds_read_b64_tr_b16 a[94:95], v231 offset:20992
    v_and_b32 v39, 0xffff0000, v11
    v_mfma_f32_16x16x32_bf16 v[192:195], a[64:67], v[88:91], v[192:195]
    s_add_u32 m0, s34, 24576
    s_add_u32 s37, s85, 65536
    buffer_load_dwordx4 v232, s[44:47], s37 offen lds
    v_mfma_f32_16x16x32_bf16 v[196:199], a[68:71], v[88:91], v[196:199]
    v_lshlrev_b32 v40, 16, v12
    v_and_b32 v41, 0xffff0000, v12
    v_mfma_f32_16x16x32_bf16 v[200:203], a[72:75], v[88:91], v[200:203]
    v_lshlrev_b32 v42, 16, v13
    v_and_b32 v43, 0xffff0000, v13
    v_mfma_f32_16x16x32_bf16 v[204:207], a[76:79], v[88:91], v[204:207]
    v_lshlrev_b32 v44, 16, v14
    v_and_b32 v45, 0xffff0000, v14
    v_mfma_f32_16x16x32_bf16 v[208:211], a[64:67], v[92:95], v[208:211]
    buffer_load_dwordx4 v233, s[44:47], s37 offen offset:1024 lds
    v_lshlrev_b32 v46, 16, v15
    v_mfma_f32_16x16x32_bf16 v[212:215], a[68:71], v[92:95], v[212:215]
    v_and_b32 v47, 0xffff0000, v15
    v_add_f32 v52, v16, v20
    v_mfma_f32_16x16x32_bf16 v[216:219], a[72:75], v[92:95], v[216:219]
    v_add_f32 v53, v17, v21
    v_add_f32 v54, v18, v22
    v_mfma_f32_16x16x32_bf16 v[220:223], a[76:79], v[92:95], v[220:223]
    v_add_f32 v55, v19, v23
    s_waitcnt vmcnt(14) lgkmcnt(0)
    v_mfma_f32_16x16x32_bf16 v[96:99], a[80:83], v[64:67], v[96:99]
    ds_read_b128 v[80:83], v225 offset:40960
    v_add_f32 v52, v52, v24
    v_mfma_f32_16x16x32_bf16 v[100:103], a[84:87], v[64:67], v[100:103]
    ds_read_b128 v[84:87], v225 offset:43008
    v_add_f32 v53, v53, v25
    v_mfma_f32_16x16x32_bf16 v[104:107], a[88:91], v[64:67], v[104:107]
    ds_read_b128 v[88:91], v225 offset:45056
    v_add_f32 v54, v54, v26
    v_mfma_f32_16x16x32_bf16 v[108:111], a[92:95], v[64:67], v[108:111]
    ds_read_b128 v[92:95], v225 offset:47104
    v_add_f32 v55, v55, v27
    v_mfma_f32_16x16x32_bf16 v[112:115], a[80:83], v[68:71], v[112:115]
    ds_read_b64_tr_b16 a[96:97], v228 offset:0
    v_add_f32 v52, v52, v28
    v_mfma_f32_16x16x32_bf16 v[116:119], a[84:87], v[68:71], v[116:119]
    ds_read_b64_tr_b16 a[98:99], v228 offset:512
    v_add_f32 v53, v53, v29
    v_mfma_f32_16x16x32_bf16 v[120:123], a[88:91], v[68:71], v[120:123]
    ds_read_b64_tr_b16 a[100:101], v229 offset:0
    v_add_f32 v54, v54, v30
    v_mfma_f32_16x16x32_bf16 v[124:127], a[92:95], v[68:71], v[124:127]
    ds_read_b64_tr_b16 a[102:103], v229 offset:512
    v_add_f32 v55, v55, v31
    v_mfma_f32_16x16x32_bf16 v[128:131], a[80:83], v[72:75], v[128:131]
    s_add_u32 m0, s35, 16384
    s_and_b32 s33, s85, 1023
    s_lshl_b32 s33, s33, 12
    buffer_load_dwordx4 v234, s[48:51], s33 offen lds
    v_mfma_f32_16x16x32_bf16 v[132:135], a[84:87], v[72:75], v[132:135]
    buffer_load_dwordx4 v235, s[48:51], s33 offen offset:1024 lds
    v_add_f32 v52, v52, v32
    v_mfma_f32_16x16x32_bf16 v[136:139], a[88:91], v[72:75], v[136:139]
    s_add_u32 m0, s35, 18432
    s_add_u32 s33, s33, 131072
    buffer_load_dwordx4 v234, s[48:51], s33 offen lds
    v_mfma_f32_16x16x32_bf16 v[140:143], a[92:95], v[72:75], v[140:143]
    v_add_f32 v53, v53, v33
    v_add_f32 v54, v54, v34
    v_mfma_f32_16x16x32_bf16 v[144:147], a[80:83], v[76:79], v[144:147]
    buffer_load_dwordx4 v235, s[48:51], s33 offen offset:1024 lds
    v_add_f32 v55, v55, v35
    v_mfma_f32_16x16x32_bf16 v[148:151], a[84:87], v[76:79], v[148:151]
    s_lshl2_add_u32 s26, s4, s3
    s_lshl_b32 s26, s26, 10
    s_add_u32 s26, s26, s32
    s_add_u32 s26, s26, 131072
    v_mfma_f32_16x16x32_bf16 v[152:155], a[88:91], v[76:79], v[152:155]
    v_and_b32 v226, 0x40000380, v251
    buffer_load_dword v241, v226, s[44:47], s26 offen
    v_mfma_f32_16x16x32_bf16 v[156:159], a[92:95], v[76:79], v[156:159]
    s_waitcnt vmcnt(25) lgkmcnt(0)
    s_barrier
    v_mfma_f32_16x16x32_bf16 v[160:163], a[80:83], v[80:83], v[160:163]
    ds_read_b128 v[64:67], v224 offset:49152
    v_add_f32 v52, v52, v36
    v_add_f32 v53, v53, v37
    v_mfma_f32_16x16x32_bf16 v[164:167], a[84:87], v[80:83], v[164:167]
    ds_read_b128 v[68:71], v224 offset:51200
    v_add_f32 v54, v54, v38
    v_mfma_f32_16x16x32_bf16 v[168:171], a[88:91], v[80:83], v[168:171]
    ds_read_b128 v[72:75], v224 offset:53248
    v_add_f32 v55, v55, v39
    v_mfma_f32_16x16x32_bf16 v[172:175], a[92:95], v[80:83], v[172:175]
    ds_read_b128 v[76:79], v224 offset:55296
    v_add_f32 v52, v52, v40
    v_mfma_f32_16x16x32_bf16 v[176:179], a[80:83], v[84:87], v[176:179]
    ds_read_b64_tr_b16 a[104:105], v230 offset:0
    v_add_f32 v53, v53, v41
    v_mfma_f32_16x16x32_bf16 v[180:183], a[84:87], v[84:87], v[180:183]
    ds_read_b64_tr_b16 a[106:107], v230 offset:512
    v_add_f32 v54, v54, v42
    v_mfma_f32_16x16x32_bf16 v[184:187], a[88:91], v[84:87], v[184:187]
    ds_read_b64_tr_b16 a[108:109], v231 offset:0
    v_add_f32 v55, v55, v43
    v_mfma_f32_16x16x32_bf16 v[188:191], a[92:95], v[84:87], v[188:191]
    ds_read_b64_tr_b16 a[110:111], v231 offset:512
    v_add_f32 v52, v52, v44
    v_mfma_f32_16x16x32_bf16 v[192:195], a[80:83], v[88:91], v[192:195]
    s_add_u32 m0, s34, 32768
    s_add_u32 s37, s86, 0
    buffer_load_dwordx4 v232, s[44:47], s37 offen lds
    v_mfma_f32_16x16x32_bf16 v[196:199], a[84:87], v[88:91], v[196:199]
    v_add_f32 v53, v53, v45
    v_add_f32 v54, v54, v46
    v_mfma_f32_16x16x32_bf16 v[200:203], a[88:91], v[88:91], v[200:203]
    v_add_f32 v55, v55, v47
    v_add_f32 v52, v52, v53
    v_mfma_f32_16x16x32_bf16 v[204:207], a[92:95], v[88:91], v[204:207]
    v_add_f32 v54, v54, v55
    v_add_f32 v48, v52, v54
    v_mfma_f32_16x16x32_bf16 v[208:211], a[80:83], v[92:95], v[208:211]
    buffer_load_dwordx4 v233, s[44:47], s37 offen offset:1024 lds
    s_nop 1
    v_mfma_f32_16x16x32_bf16 v[212:215], a[84:87], v[92:95], v[212:215]
    v_add_f32_dpp v48, v48, v48 quad_perm:[1,0,3,2] row_mask:0xf bank_mask:0xf
    s_nop 1
    v_mfma_f32_16x16x32_bf16 v[216:219], a[88:91], v[92:95], v[216:219]
    v_add_f32_dpp v48, v48, v48 quad_perm:[2,3,0,1] row_mask:0xf bank_mask:0xf
    s_nop 1
    v_mfma_f32_16x16x32_bf16 v[220:223], a[92:95], v[92:95], v[220:223]
    v_add_f32_dpp v48, v48, v48 row_half_mirror row_mask:0xf bank_mask:0xf
    s_waitcnt lgkmcnt(0)
    v_mfma_f32_16x16x32_bf16 v[96:99], a[96:99], v[64:67], v[96:99]
    ds_read_b128 v[80:83], v224 offset:57344
    s_nop 1
    v_mfma_f32_16x16x32_bf16 v[100:103], a[100:103], v[64:67], v[100:103]
    ds_read_b128 v[84:87], v224 offset:59392
    v_add_f32_dpp v48, v48, v48 row_mirror row_mask:0xf bank_mask:0xf
    v_mfma_f32_16x16x32_bf16 v[104:107], a[104:107], v[64:67], v[104:107]
    ds_read_b128 v[88:91], v224 offset:61440
    s_nop 0
    v_mfma_f32_16x16x32_bf16 v[108:111], a[108:111], v[64:67], v[108:111]
    ds_read_b128 v[92:95], v224 offset:63488
    v_mov_b32 v49, v48
    v_mfma_f32_16x16x32_bf16 v[112:115], a[96:99], v[68:71], v[112:115]
    ds_read_b64_tr_b16 a[112:113], v228 offset:4096
    s_nop 1
    v_mfma_f32_16x16x32_bf16 v[116:119], a[100:103], v[68:71], v[116:119]
    ds_read_b64_tr_b16 a[114:115], v228 offset:4608
    v_permlane16_swap_b32 v48, v49
    v_mfma_f32_16x16x32_bf16 v[120:123], a[104:107], v[68:71], v[120:123]
    ds_read_b64_tr_b16 a[116:117], v229 offset:4096
    s_nop 0
    v_mfma_f32_16x16x32_bf16 v[124:127], a[108:111], v[68:71], v[124:127]
    ds_read_b64_tr_b16 a[118:119], v229 offset:4608
    v_add_f32 v48, v48, v49
    v_mfma_f32_16x16x32_bf16 v[128:131], a[96:99], v[72:75], v[128:131]
    s_add_u32 m0, s35, 20480
    s_add_u32 s33, s33, 131072
    buffer_load_dwordx4 v234, s[48:51], s33 offen lds
    v_mfma_f32_16x16x32_bf16 v[132:135], a[100:103], v[72:75], v[132:135]
    buffer_load_dwordx4 v235, s[48:51], s33 offen offset:1024 lds
    v_mul_f32 v48, 0x3a800000, v48
    v_mfma_f32_16x16x32_bf16 v[136:139], a[104:107], v[72:75], v[136:139]
    v_sub_f32 v56, v16, v48
    v_mul_f32 v52, v56, v56
    v_mfma_f32_16x16x32_bf16 v[140:143], a[108:111], v[72:75], v[140:143]
    s_add_u32 m0, s35, 22528
    s_add_u32 s33, s33, 131072
    buffer_load_dwordx4 v234, s[48:51], s33 offen lds
    v_mfma_f32_16x16x32_bf16 v[144:147], a[96:99], v[76:79], v[144:147]
    buffer_load_dwordx4 v235, s[48:51], s33 offen offset:1024 lds
    v_sub_f32 v57, v17, v48
    v_mfma_f32_16x16x32_bf16 v[148:151], a[100:103], v[76:79], v[148:151]
    v_mul_f32 v53, v57, v57
    v_sub_f32 v58, v18, v48
    v_mfma_f32_16x16x32_bf16 v[152:155], a[104:107], v[76:79], v[152:155]
    v_lshlrev_b32 v226, 7, v253
    s_lshl_b32 s25, s2, 15
    buffer_load_dword v241, v226, s[12:15], s25 offen
    v_mfma_f32_16x16x32_bf16 v[156:159], a[108:111], v[76:79], v[156:159]
    v_mul_f32 v54, v58, v58
    s_waitcnt lgkmcnt(0)
    v_mfma_f32_16x16x32_bf16 v[160:163], a[96:99], v[80:83], v[160:163]
    ds_read_b128 v[64:67], v225 offset:49152
    v_sub_f32 v59, v19, v48
    v_mfma_f32_16x16x32_bf16 v[164:167], a[100:103], v[80:83], v[164:167]
    ds_read_b128 v[68:71], v225 offset:51200
    v_mul_f32 v55, v59, v59
    v_mfma_f32_16x16x32_bf16 v[168:171], a[104:107], v[80:83], v[168:171]
    ds_read_b128 v[72:75], v225 offset:53248
    v_sub_f32 v56, v20, v48
    v_mfma_f32_16x16x32_bf16 v[172:175], a[108:111], v[80:83], v[172:175]
    ds_read_b128 v[76:79], v225 offset:55296
    v_fmac_f32 v52, v56, v56
    v_mfma_f32_16x16x32_bf16 v[176:179], a[96:99], v[84:87], v[176:179]
    ds_read_b64_tr_b16 a[120:121], v230 offset:4096
    v_sub_f32 v57, v21, v48
    v_mfma_f32_16x16x32_bf16 v[180:183], a[100:103], v[84:87], v[180:183]
    ds_read_b64_tr_b16 a[122:123], v230 offset:4608
    v_fmac_f32 v53, v57, v57
    v_mfma_f32_16x16x32_bf16 v[184:187], a[104:107], v[84:87], v[184:187]
    ds_read_b64_tr_b16 a[124:125], v231 offset:4096
    v_sub_f32 v58, v22, v48
    v_mfma_f32_16x16x32_bf16 v[188:191], a[108:111], v[84:87], v[188:191]
    ds_read_b64_tr_b16 a[126:127], v231 offset:4608
    v_fmac_f32 v54, v58, v58
    v_mfma_f32_16x16x32_bf16 v[192:195], a[96:99], v[88:91], v[192:195]
    s_add_u32 m0, s34, 40960
    s_add_u32 s37, s86, 65536
    buffer_load_dwordx4 v232, s[44:47], s37 offen lds
    v_mfma_f32_16x16x32_bf16 v[196:199], a[100:103], v[88:91], v[196:199]
    v_sub_f32 v59, v23, v48
    v_fmac_f32 v55, v59, v59
    v_mfma_f32_16x16x32_bf16 v[200:203], a[104:107], v[88:91], v[200:203]
    v_sub_f32 v56, v24, v48
    v_fmac_f32 v52, v56, v56
    v_mfma_f32_16x16x32_bf16 v[204:207], a[108:111], v[88:91], v[204:207]
    v_sub_f32 v57, v25, v48
    v_fmac_f32 v53, v57, v57
    v_mfma_f32_16x16x32_bf16 v[208:211], a[96:99], v[92:95], v[208:211]
    buffer_load_dwordx4 v233, s[44:47], s37 offen offset:1024 lds
    v_sub_f32 v58, v26, v48
    v_mfma_f32_16x16x32_bf16 v[212:215], a[100:103], v[92:95], v[212:215]
    v_fmac_f32 v54, v58, v58
    v_sub_f32 v59, v27, v48
    v_mfma_f32_16x16x32_bf16 v[216:219], a[104:107], v[92:95], v[216:219]
    v_fmac_f32 v55, v59, v59
    v_sub_f32 v56, v28, v48
    v_mfma_f32_16x16x32_bf16 v[220:223], a[108:111], v[92:95], v[220:223]
    v_fmac_f32 v52, v56, v56
    s_waitcnt vmcnt(16) lgkmcnt(0)
    v_mfma_f32_16x16x32_bf16 v[96:99], a[112:115], v[64:67], v[96:99]
    ds_read_b128 v[80:83], v225 offset:57344
    v_sub_f32 v57, v29, v48
    v_mfma_f32_16x16x32_bf16 v[100:103], a[116:119], v[64:67], v[100:103]
    ds_read_b128 v[84:87], v225 offset:59392
    v_fmac_f32 v53, v57, v57
    v_mfma_f32_16x16x32_bf16 v[104:107], a[120:123], v[64:67], v[104:107]
    ds_read_b128 v[88:91], v225 offset:61440
    v_sub_f32 v58, v30, v48
    v_mfma_f32_16x16x32_bf16 v[108:111], a[124:127], v[64:67], v[108:111]
    ds_read_b128 v[92:95], v225 offset:63488
    v_fmac_f32 v54, v58, v58
    v_mfma_f32_16x16x32_bf16 v[112:115], a[112:115], v[68:71], v[112:115]
    ds_read_b64_tr_b16 a[128:129], v228 offset:8192
    v_sub_f32 v59, v31, v48
    v_mfma_f32_16x16x32_bf16 v[116:119], a[116:119], v[68:71], v[116:119]
    ds_read_b64_tr_b16 a[130:131], v228 offset:8704
    v_fmac_f32 v55, v59, v59
    v_mfma_f32_16x16x32_bf16 v[120:123], a[120:123], v[68:71], v[120:123]
    ds_read_b64_tr_b16 a[132:133], v229 offset:8192
    v_sub_f32 v56, v32, v48
    v_mfma_f32_16x16x32_bf16 v[124:127], a[124:127], v[68:71], v[124:127]
    ds_read_b64_tr_b16 a[134:135], v229 offset:8704
    v_fmac_f32 v52, v56, v56
    v_mfma_f32_16x16x32_bf16 v[128:131], a[112:115], v[72:75], v[128:131]
    s_add_u32 m0, s35, 0
    s_and_b32 s33, s86, 1023
    s_lshl_b32 s33, s33, 12
    buffer_load_dwordx4 v234, s[48:51], s33 offen lds
    v_mfma_f32_16x16x32_bf16 v[132:135], a[116:119], v[72:75], v[132:135]
    v_sub_f32 v57, v33, v48
    v_fmac_f32 v53, v57, v57
    v_mfma_f32_16x16x32_bf16 v[136:139], a[120:123], v[72:75], v[136:139]
    buffer_load_dwordx4 v235, s[48:51], s33 offen offset:1024 lds
    v_sub_f32 v58, v34, v48
    v_mfma_f32_16x16x32_bf16 v[140:143], a[124:127], v[72:75], v[140:143]
    v_fmac_f32 v54, v58, v58
    v_sub_f32 v59, v35, v48
    v_mfma_f32_16x16x32_bf16 v[144:147], a[112:115], v[76:79], v[144:147]
    s_add_u32 m0, s35, 2048
    s_add_u32 s33, s33, 131072
    buffer_load_dwordx4 v234, s[48:51], s33 offen lds
    v_mfma_f32_16x16x32_bf16 v[148:151], a[116:119], v[76:79], v[148:151]
    v_fmac_f32 v55, v59, v59
    v_sub_f32 v56, v36, v48
    v_mfma_f32_16x16x32_bf16 v[152:155], a[120:123], v[76:79], v[152:155]
    buffer_load_dwordx4 v235, s[48:51], s33 offen offset:1024 lds
    v_fmac_f32 v52, v56, v56
    v_mfma_f32_16x16x32_bf16 v[156:159], a[124:127], v[76:79], v[156:159]
    s_waitcnt vmcnt(30) lgkmcnt(0)
    s_barrier
    v_mfma_f32_16x16x32_bf16 v[160:163], a[112:115], v[80:83], v[160:163]
    ds_read_b128 v[64:67], v224 offset:0
    v_sub_f32 v57, v37, v48
    v_mfma_f32_16x16x32_bf16 v[164:167], a[116:119], v[80:83], v[164:167]
    ds_read_b128 v[68:71], v224 offset:2048
    v_fmac_f32 v53, v57, v57
    v_mfma_f32_16x16x32_bf16 v[168:171], a[120:123], v[80:83], v[168:171]
    ds_read_b128 v[72:75], v224 offset:4096
    v_sub_f32 v58, v38, v48
    v_mfma_f32_16x16x32_bf16 v[172:175], a[124:127], v[80:83], v[172:175]
    ds_read_b128 v[76:79], v224 offset:6144
    v_fmac_f32 v54, v58, v58
    v_mfma_f32_16x16x32_bf16 v[176:179], a[112:115], v[84:87], v[176:179]
    ds_read_b64_tr_b16 a[136:137], v230 offset:8192
    v_sub_f32 v59, v39, v48
    v_mfma_f32_16x16x32_bf16 v[180:183], a[116:119], v[84:87], v[180:183]
    ds_read_b64_tr_b16 a[138:139], v230 offset:8704
    v_fmac_f32 v55, v59, v59
    v_mfma_f32_16x16x32_bf16 v[184:187], a[120:123], v[84:87], v[184:187]
    ds_read_b64_tr_b16 a[140:141], v231 offset:8192
    v_sub_f32 v56, v40, v48
    v_mfma_f32_16x16x32_bf16 v[188:191], a[124:127], v[84:87], v[188:191]
    ds_read_b64_tr_b16 a[142:143], v231 offset:8704
    v_fmac_f32 v52, v56, v56
    v_mfma_f32_16x16x32_bf16 v[192:195], a[112:115], v[88:91], v[192:195]
    s_add_u32 m0, s34, 49152
    s_add_u32 s37, s87, 0
    buffer_load_dwordx4 v232, s[44:47], s37 offen lds
    v_mfma_f32_16x16x32_bf16 v[196:199], a[116:119], v[88:91], v[196:199]
    v_sub_f32 v57, v41, v48
    v_fmac_f32 v53, v57, v57
    v_mfma_f32_16x16x32_bf16 v[200:203], a[120:123], v[88:91], v[200:203]
    v_sub_f32 v58, v42, v48
    v_fmac_f32 v54, v58, v58
    v_mfma_f32_16x16x32_bf16 v[204:207], a[124:127], v[88:91], v[204:207]
    v_sub_f32 v59, v43, v48
    v_fmac_f32 v55, v59, v59
    v_mfma_f32_16x16x32_bf16 v[208:211], a[112:115], v[92:95], v[208:211]
    buffer_load_dwordx4 v233, s[44:47], s37 offen offset:1024 lds
    v_sub_f32 v56, v44, v48
    v_mfma_f32_16x16x32_bf16 v[212:215], a[116:119], v[92:95], v[212:215]
    v_fmac_f32 v52, v56, v56
    v_sub_f32 v57, v45, v48
    v_mfma_f32_16x16x32_bf16 v[216:219], a[120:123], v[92:95], v[216:219]
    v_fmac_f32 v53, v57, v57
    v_sub_f32 v58, v46, v48
    v_mfma_f32_16x16x32_bf16 v[220:223], a[124:127], v[92:95], v[220:223]
    v_fmac_f32 v54, v58, v58
    s_waitcnt lgkmcnt(0)
    v_mfma_f32_16x16x32_bf16 v[96:99], a[128:131], v[64:67], v[96:99]
    ds_read_b128 v[80:83], v224 offset:8192
    v_sub_f32 v59, v47, v48
    v_mfma_f32_16x16x32_bf16 v[100:103], a[132:135], v[64:67], v[100:103]
    ds_read_b128 v[84:87], v224 offset:10240
    v_fmac_f32 v55, v59, v59
    v_mfma_f32_16x16x32_bf16 v[104:107], a[136:139], v[64:67], v[104:107]
    ds_read_b128 v[88:91], v224 offset:12288
    v_add_f32 v52, v52, v53
    v_mfma_f32_16x16x32_bf16 v[108:111], a[140:143], v[64:67], v[108:111]
    ds_read_b128 v[92:95], v224 offset:14336
    v_add_f32 v54, v54, v55
    v_mfma_f32_16x16x32_bf16 v[112:115], a[128:131], v[68:71], v[112:115]
    ds_read_b64_tr_b16 a[144:145], v228 offset:12288
    v_add_f32 v51, v52, v54
    v_mfma_f32_16x16x32_bf16 v[116:119], a[132:135], v[68:71], v[116:119]
    ds_read_b64_tr_b16 a[146:147], v228 offset:12800
    s_nop 1
    v_mfma_f32_16x16x32_bf16 v[120:123], a[136:139], v[68:71], v[120:123]
    ds_read_b64_tr_b16 a[148:149], v229 offset:12288
    v_add_f32_dpp v51, v51, v51 quad_perm:[1,0,3,2] row_mask:0xf bank_mask:0xf
    v_mfma_f32_16x16x32_bf16 v[124:127], a[140:143], v[68:71], v[124:127]
    ds_read_b64_tr_b16 a[150:151], v229 offset:12800
    s_nop 1
    v_mfma_f32_16x16x32_bf16 v[128:131], a[128:131], v[72:75], v[128:131]
    s_add_u32 m0, s35, 4096
    s_add_u32 s33, s33, 131072
    buffer_load_dwordx4 v234, s[48:51], s33 offen lds
    v_mfma_f32_16x16x32_bf16 v[132:135], a[132:135], v[72:75], v[132:135]
    v_add_f32_dpp v51, v51, v51 quad_perm:[2,3,0,1] row_mask:0xf bank_mask:0xf
    s_nop 1
    v_add_f32_dpp v51, v51, v51 row_half_mirror row_mask:0xf bank_mask:0xf
    v_mfma_f32_16x16x32_bf16 v[136:139], a[136:139], v[72:75], v[136:139]
    buffer_load_dwordx4 v235, s[48:51], s33 offen offset:1024 lds
    s_nop 1
    v_mfma_f32_16x16x32_bf16 v[140:143], a[140:143], v[72:75], v[140:143]
    v_add_f32_dpp v51, v51, v51 row_mirror row_mask:0xf bank_mask:0xf
    s_nop 0
    v_mfma_f32_16x16x32_bf16 v[144:147], a[128:131], v[76:79], v[144:147]
    s_add_u32 m0, s35, 6144
    s_add_u32 s33, s33, 131072
    buffer_load_dwordx4 v234, s[48:51], s33 offen lds
    v_mfma_f32_16x16x32_bf16 v[148:151], a[132:135], v[76:79], v[148:151]
    v_mov_b32 v49, v51
    s_nop 1
    v_mfma_f32_16x16x32_bf16 v[152:155], a[136:139], v[76:79], v[152:155]
    buffer_load_dwordx4 v235, s[48:51], s33 offen offset:1024 lds
    v_permlane16_swap_b32 v51, v49
    v_mfma_f32_16x16x32_bf16 v[156:159], a[140:143], v[76:79], v[156:159]
    s_nop 0
    s_waitcnt lgkmcnt(0)
    v_mfma_f32_16x16x32_bf16 v[160:163], a[128:131], v[80:83], v[160:163]
    ds_read_b128 v[64:67], v225 offset:0
    v_add_f32 v51, v51, v49
    v_mfma_f32_16x16x32_bf16 v[164:167], a[132:135], v[80:83], v[164:167]
    ds_read_b128 v[68:71], v225 offset:2048
    v_mul_f32 v51, 0x3a800000, v51
    v_mfma_f32_16x16x32_bf16 v[168:171], a[136:139], v[80:83], v[168:171]
    ds_read_b128 v[72:75], v225 offset:4096
    v_cvt_pk_bf16_f32 v50, v48, v51
    v_mfma_f32_16x16x32_bf16 v[172:175], a[140:143], v[80:83], v[172:175]
    ds_read_b128 v[76:79], v225 offset:6144
    v_and_b32 v51, 0xffff0000, v50
    v_mfma_f32_16x16x32_bf16 v[176:179], a[128:131], v[84:87], v[176:179]
    ds_read_b64_tr_b16 a[152:153], v230 offset:12288
    v_lshlrev_b32 v50, 16, v50
    v_mfma_f32_16x16x32_bf16 v[180:183], a[132:135], v[84:87], v[180:183]
    ds_read_b64_tr_b16 a[154:155], v230 offset:12800
    v_add_f32 v51, 0x3727c5ac, v51
    v_mfma_f32_16x16x32_bf16 v[184:187], a[136:139], v[84:87], v[184:187]
    ds_read_b64_tr_b16 a[156:157], v231 offset:12288
    v_cvt_pk_bf16_f32 v51, v51, v51
    v_mfma_f32_16x16x32_bf16 v[188:191], a[140:143], v[84:87], v[188:191]
    ds_read_b64_tr_b16 a[158:159], v231 offset:12800
    v_lshlrev_b32 v51, 16, v51
    v_mfma_f32_16x16x32_bf16 v[192:195], a[128:131], v[88:91], v[192:195]
    s_add_u32 m0, s34, 57344
    s_add_u32 s37, s87, 65536
    buffer_load_dwordx4 v232, s[44:47], s37 offen lds
    v_mfma_f32_16x16x32_bf16 v[196:199], a[132:135], v[88:91], v[196:199]
    v_sqrt_f32 v51, v51
    v_mfma_f32_16x16x32_bf16 v[200:203], a[136:139], v[88:91], v[200:203]
    s_nop 0
    v_cvt_pk_bf16_f32 v51, v51, v51
    v_mfma_f32_16x16x32_bf16 v[204:207], a[140:143], v[88:91], v[204:207]
    v_lshlrev_b32 v51, 16, v51
    v_mfma_f32_16x16x32_bf16 v[208:211], a[128:131], v[92:95], v[208:211]
    buffer_load_dwordx4 v233, s[44:47], s37 offen offset:1024 lds
    v_rcp_f32 v51, v51
    v_mfma_f32_16x16x32_bf16 v[212:215], a[132:135], v[92:95], v[212:215]
    s_nop 0
    v_sub_f32 v16, v16, v50
    v_mfma_f32_16x16x32_bf16 v[216:219], a[136:139], v[92:95], v[216:219]
    v_sub_f32 v17, v17, v50
    v_cvt_pk_bf16_f32 v17, v16, v17
    v_mfma_f32_16x16x32_bf16 v[220:223], a[140:143], v[92:95], v[220:223]
    v_lshlrev_b32 v16, 16, v17
    s_waitcnt vmcnt(15) lgkmcnt(0)
    v_mfma_f32_16x16x32_bf16 v[96:99], a[144:147], v[64:67], v[96:99]
    ds_read_b128 v[80:83], v225 offset:8192
    v_and_b32 v17, 0xffff0000, v17
    v_mfma_f32_16x16x32_bf16 v[100:103], a[148:151], v[64:67], v[100:103]
    ds_read_b128 v[84:87], v225 offset:10240
    v_mul_f32 v16, v16, v51
    v_mfma_f32_16x16x32_bf16 v[104:107], a[152:155], v[64:67], v[104:107]
    ds_read_b128 v[88:91], v225 offset:12288
    v_mul_f32 v17, v17, v51
    v_mfma_f32_16x16x32_bf16 v[108:111], a[156:159], v[64:67], v[108:111]
    ds_read_b128 v[92:95], v225 offset:14336
    v_cvt_pk_bf16_f32 v0, v16, v17
    v_mfma_f32_16x16x32_bf16 v[112:115], a[144:147], v[68:71], v[112:115]
    ds_read_b64_tr_b16 a[160:161], v228 offset:16384
    v_sub_f32 v18, v18, v50
    v_mfma_f32_16x16x32_bf16 v[116:119], a[148:151], v[68:71], v[116:119]
    ds_read_b64_tr_b16 a[162:163], v228 offset:16896
    v_sub_f32 v19, v19, v50
    v_mfma_f32_16x16x32_bf16 v[120:123], a[152:155], v[68:71], v[120:123]
    ds_read_b64_tr_b16 a[164:165], v229 offset:16384
    v_cvt_pk_bf16_f32 v19, v18, v19
    v_mfma_f32_16x16x32_bf16 v[124:127], a[156:159], v[68:71], v[124:127]
    ds_read_b64_tr_b16 a[166:167], v229 offset:16896
    v_lshlrev_b32 v18, 16, v19
    v_mfma_f32_16x16x32_bf16 v[128:131], a[144:147], v[72:75], v[128:131]
    s_add_u32 m0, s35, 8192
    s_and_b32 s33, s87, 1023
    s_lshl_b32 s33, s33, 12
    buffer_load_dwordx4 v234, s[48:51], s33 offen lds
    v_mfma_f32_16x16x32_bf16 v[132:135], a[148:151], v[72:75], v[132:135]
    v_and_b32 v19, 0xffff0000, v19
    v_mul_f32 v18, v18, v51
    v_mfma_f32_16x16x32_bf16 v[136:139], a[152:155], v[72:75], v[136:139]
    buffer_load_dwordx4 v235, s[48:51], s33 offen offset:1024 lds
    v_mul_f32 v19, v19, v51
    v_mfma_f32_16x16x32_bf16 v[140:143], a[156:159], v[72:75], v[140:143]
    v_cvt_pk_bf16_f32 v1, v18, v19
    v_sub_f32 v20, v20, v50
    v_mfma_f32_16x16x32_bf16 v[144:147], a[144:147], v[76:79], v[144:147]
    s_add_u32 m0, s35, 10240
    s_add_u32 s33, s33, 131072
    buffer_load_dwordx4 v234, s[48:51], s33 offen lds
    v_mfma_f32_16x16x32_bf16 v[148:151], a[148:151], v[76:79], v[148:151]
    v_sub_f32 v21, v21, v50
    v_cvt_pk_bf16_f32 v21, v20, v21
    v_mfma_f32_16x16x32_bf16 v[152:155], a[152:155], v[76:79], v[152:155]
    buffer_load_dwordx4 v235, s[48:51], s33 offen offset:1024 lds
    v_lshlrev_b32 v20, 16, v21
    v_mfma_f32_16x16x32_bf16 v[156:159], a[156:159], v[76:79], v[156:159]
    s_waitcnt vmcnt(30) lgkmcnt(0)
    s_barrier
    v_mfma_f32_16x16x32_bf16 v[160:163], a[144:147], v[80:83], v[160:163]
    ds_read_b128 v[64:67], v224 offset:16384
    v_and_b32 v21, 0xffff0000, v21
    v_mfma_f32_16x16x32_bf16 v[164:167], a[148:151], v[80:83], v[164:167]
    ds_read_b128 v[68:71], v224 offset:18432
    v_mul_f32 v20, v20, v51
    v_mfma_f32_16x16x32_bf16 v[168:171], a[152:155], v[80:83], v[168:171]
    ds_read_b128 v[72:75], v224 offset:20480
    v_mul_f32 v21, v21, v51
    v_mfma_f32_16x16x32_bf16 v[172:175], a[156:159], v[80:83], v[172:175]
    ds_read_b128 v[76:79], v224 offset:22528
    v_cvt_pk_bf16_f32 v2, v20, v21
    v_mfma_f32_16x16x32_bf16 v[176:179], a[144:147], v[84:87], v[176:179]
    ds_read_b64_tr_b16 a[168:169], v230 offset:16384
    v_sub_f32 v22, v22, v50
    v_mfma_f32_16x16x32_bf16 v[180:183], a[148:151], v[84:87], v[180:183]
    ds_read_b64_tr_b16 a[170:171], v230 offset:16896
    v_sub_f32 v23, v23, v50
    v_mfma_f32_16x16x32_bf16 v[184:187], a[152:155], v[84:87], v[184:187]
    ds_read_b64_tr_b16 a[172:173], v231 offset:16384
    v_cvt_pk_bf16_f32 v23, v22, v23
    v_mfma_f32_16x16x32_bf16 v[188:191], a[156:159], v[84:87], v[188:191]
    ds_read_b64_tr_b16 a[174:175], v231 offset:16896
    v_lshlrev_b32 v22, 16, v23
    v_mfma_f32_16x16x32_bf16 v[192:195], a[144:147], v[88:91], v[192:195]
    s_add_u32 m0, s34, 0
    s_add_u32 s37, s80, 131072
    buffer_load_dwordx4 v232, s[44:47], s37 offen lds
    v_mfma_f32_16x16x32_bf16 v[196:199], a[148:151], v[88:91], v[196:199]
    v_and_b32 v23, 0xffff0000, v23
    v_mul_f32 v22, v22, v51
    v_mfma_f32_16x16x32_bf16 v[200:203], a[152:155], v[88:91], v[200:203]
    v_mul_f32 v23, v23, v51
    v_cvt_pk_bf16_f32 v3, v22, v23
    v_mfma_f32_16x16x32_bf16 v[204:207], a[156:159], v[88:91], v[204:207]
    v_sub_f32 v24, v24, v50
    v_sub_f32 v25, v25, v50
    v_mfma_f32_16x16x32_bf16 v[208:211], a[144:147], v[92:95], v[208:211]
    buffer_load_dwordx4 v233, s[44:47], s37 offen offset:1024 lds
    v_cvt_pk_bf16_f32 v25, v24, v25
    v_mfma_f32_16x16x32_bf16 v[212:215], a[148:151], v[92:95], v[212:215]
    v_lshlrev_b32 v24, 16, v25
    v_and_b32 v25, 0xffff0000, v25
    v_mfma_f32_16x16x32_bf16 v[216:219], a[152:155], v[92:95], v[216:219]
    v_mul_f32 v24, v24, v51
    v_mul_f32 v25, v25, v51
    v_mfma_f32_16x16x32_bf16 v[220:223], a[156:159], v[92:95], v[220:223]
    v_cvt_pk_bf16_f32 v4, v24, v25
    s_waitcnt lgkmcnt(0)
    v_mfma_f32_16x16x32_bf16 v[96:99], a[160:163], v[64:67], v[96:99]
    ds_read_b128 v[80:83], v224 offset:24576
    v_sub_f32 v26, v26, v50
    v_mfma_f32_16x16x32_bf16 v[100:103], a[164:167], v[64:67], v[100:103]
    ds_read_b128 v[84:87], v224 offset:26624
    v_sub_f32 v27, v27, v50
    v_mfma_f32_16x16x32_bf16 v[104:107], a[168:171], v[64:67], v[104:107]
    ds_read_b128 v[88:91], v224 offset:28672
    v_cvt_pk_bf16_f32 v27, v26, v27
    v_mfma_f32_16x16x32_bf16 v[108:111], a[172:175], v[64:67], v[108:111]
    ds_read_b128 v[92:95], v224 offset:30720
    v_lshlrev_b32 v26, 16, v27
    v_mfma_f32_16x16x32_bf16 v[112:115], a[160:163], v[68:71], v[112:115]
    ds_read_b64_tr_b16 a[176:177], v228 offset:20480
    v_and_b32 v27, 0xffff0000, v27
    v_mfma_f32_16x16x32_bf16 v[116:119], a[164:167], v[68:71], v[116:119]
    ds_read_b64_tr_b16 a[178:179], v228 offset:20992
    v_mul_f32 v26, v26, v51
    v_mfma_f32_16x16x32_bf16 v[120:123], a[168:171], v[68:71], v[120:123]
    ds_read_b64_tr_b16 a[180:181], v229 offset:20480
    v_mul_f32 v27, v27, v51
    v_mfma_f32_16x16x32_bf16 v[124:127], a[172:175], v[68:71], v[124:127]
    ds_read_b64_tr_b16 a[182:183], v229 offset:20992
    v_cvt_pk_bf16_f32 v5, v26, v27
    v_mfma_f32_16x16x32_bf16 v[128:131], a[160:163], v[72:75], v[128:131]
    s_add_u32 m0, s35, 12288
    s_add_u32 s33, s33, 131072
    buffer_load_dwordx4 v234, s[48:51], s33 offen lds
    v_mfma_f32_16x16x32_bf16 v[132:135], a[164:167], v[72:75], v[132:135]
    v_sub_f32 v28, v28, v50
    v_sub_f32 v29, v29, v50
    v_mfma_f32_16x16x32_bf16 v[136:139], a[168:171], v[72:75], v[136:139]
    buffer_load_dwordx4 v235, s[48:51], s33 offen offset:1024 lds
    v_cvt_pk_bf16_f32 v29, v28, v29
    v_mfma_f32_16x16x32_bf16 v[140:143], a[172:175], v[72:75], v[140:143]
    v_lshlrev_b32 v28, 16, v29
    v_and_b32 v29, 0xffff0000, v29
    v_mfma_f32_16x16x32_bf16 v[144:147], a[160:163], v[76:79], v[144:147]
    s_add_u32 m0, s35, 14336
    s_add_u32 s33, s33, 131072
    buffer_load_dwordx4 v234, s[48:51], s33 offen lds
    v_mfma_f32_16x16x32_bf16 v[148:151], a[164:167], v[76:79], v[148:151]
    v_mul_f32 v28, v28, v51
    v_mul_f32 v29, v29, v51
    v_mfma_f32_16x16x32_bf16 v[152:155], a[168:171], v[76:79], v[152:155]
    buffer_load_dwordx4 v235, s[48:51], s33 offen offset:1024 lds
    v_cvt_pk_bf16_f32 v6, v28, v29
    v_mfma_f32_16x16x32_bf16 v[156:159], a[172:175], v[76:79], v[156:159]
    v_sub_f32 v30, v30, v50
    s_waitcnt lgkmcnt(0)
    v_mfma_f32_16x16x32_bf16 v[160:163], a[160:163], v[80:83], v[160:163]
    ds_read_b128 v[64:67], v225 offset:16384
    v_sub_f32 v31, v31, v50
    v_mfma_f32_16x16x32_bf16 v[164:167], a[164:167], v[80:83], v[164:167]
    ds_read_b128 v[68:71], v225 offset:18432
    v_cvt_pk_bf16_f32 v31, v30, v31
    v_mfma_f32_16x16x32_bf16 v[168:171], a[168:171], v[80:83], v[168:171]
    ds_read_b128 v[72:75], v225 offset:20480
    v_lshlrev_b32 v30, 16, v31
    v_mfma_f32_16x16x32_bf16 v[172:175], a[172:175], v[80:83], v[172:175]
    ds_read_b128 v[76:79], v225 offset:22528
    v_and_b32 v31, 0xffff0000, v31
    v_mfma_f32_16x16x32_bf16 v[176:179], a[160:163], v[84:87], v[176:179]
    ds_read_b64_tr_b16 a[184:185], v230 offset:20480
    v_mul_f32 v30, v30, v51
    v_mfma_f32_16x16x32_bf16 v[180:183], a[164:167], v[84:87], v[180:183]
    ds_read_b64_tr_b16 a[186:187], v230 offset:20992
    v_mul_f32 v31, v31, v51
    v_mfma_f32_16x16x32_bf16 v[184:187], a[168:171], v[84:87], v[184:187]
    ds_read_b64_tr_b16 a[188:189], v231 offset:20480
    v_cvt_pk_bf16_f32 v7, v30, v31
    v_mfma_f32_16x16x32_bf16 v[188:191], a[172:175], v[84:87], v[188:191]
    ds_read_b64_tr_b16 a[190:191], v231 offset:20992
    v_sub_f32 v32, v32, v50
    v_mfma_f32_16x16x32_bf16 v[192:195], a[160:163], v[88:91], v[192:195]
    s_add_u32 m0, s34, 8192
    s_add_u32 s37, s81, 131072
    buffer_load_dwordx4 v232, s[44:47], s37 offen lds
    v_mfma_f32_16x16x32_bf16 v[196:199], a[164:167], v[88:91], v[196:199]
    v_sub_f32 v33, v33, v50
    v_cvt_pk_bf16_f32 v33, v32, v33
    v_mfma_f32_16x16x32_bf16 v[200:203], a[168:171], v[88:91], v[200:203]
    v_lshlrev_b32 v32, 16, v33
    v_and_b32 v33, 0xffff0000, v33
    v_mfma_f32_16x16x32_bf16 v[204:207], a[172:175], v[88:91], v[204:207]
    v_mul_f32 v32, v32, v51
    v_mul_f32 v33, v33, v51
    v_mfma_f32_16x16x32_bf16 v[208:211], a[160:163], v[92:95], v[208:211]
    buffer_load_dwordx4 v233, s[44:47], s37 offen offset:1024 lds
    v_cvt_pk_bf16_f32 v8, v32, v33
    v_mfma_f32_16x16x32_bf16 v[212:215], a[164:167], v[92:95], v[212:215]
    v_sub_f32 v34, v34, v50
    v_sub_f32 v35, v35, v50
    v_mfma_f32_16x16x32_bf16 v[216:219], a[168:171], v[92:95], v[216:219]
    v_cvt_pk_bf16_f32 v35, v34, v35
    v_lshlrev_b32 v34, 16, v35
    v_mfma_f32_16x16x32_bf16 v[220:223], a[172:175], v[92:95], v[220:223]
    v_and_b32 v35, 0xffff0000, v35
    v_mul_f32 v34, v34, v51
    s_waitcnt vmcnt(14) lgkmcnt(0)
    v_mfma_f32_16x16x32_bf16 v[96:99], a[176:179], v[64:67], v[96:99]
    ds_read_b128 v[80:83], v225 offset:24576
    v_mul_f32 v35, v35, v51
    v_mfma_f32_16x16x32_bf16 v[100:103], a[180:183], v[64:67], v[100:103]
    ds_read_b128 v[84:87], v225 offset:26624
    v_cvt_pk_bf16_f32 v9, v34, v35
    v_mfma_f32_16x16x32_bf16 v[104:107], a[184:187], v[64:67], v[104:107]
    ds_read_b128 v[88:91], v225 offset:28672
    v_sub_f32 v36, v36, v50
    v_mfma_f32_16x16x32_bf16 v[108:111], a[188:191], v[64:67], v[108:111]
    ds_read_b128 v[92:95], v225 offset:30720
    v_sub_f32 v37, v37, v50
    v_mfma_f32_16x16x32_bf16 v[112:115], a[176:179], v[68:71], v[112:115]
    ds_read_b64_tr_b16 a[192:193], v228 offset:0
    v_cvt_pk_bf16_f32 v37, v36, v37
    v_mfma_f32_16x16x32_bf16 v[116:119], a[180:183], v[68:71], v[116:119]
    ds_read_b64_tr_b16 a[194:195], v228 offset:512
    v_lshlrev_b32 v36, 16, v37
    v_mfma_f32_16x16x32_bf16 v[120:123], a[184:187], v[68:71], v[120:123]
    ds_read_b64_tr_b16 a[196:197], v229 offset:0
    v_and_b32 v37, 0xffff0000, v37
    v_mfma_f32_16x16x32_bf16 v[124:127], a[188:191], v[68:71], v[124:127]
    ds_read_b64_tr_b16 a[198:199], v229 offset:512
    v_mul_f32 v36, v36, v51
    v_mfma_f32_16x16x32_bf16 v[128:131], a[176:179], v[72:75], v[128:131]
    v_mul_f32 v37, v37, v51
    v_cvt_pk_bf16_f32 v10, v36, v37
    v_mfma_f32_16x16x32_bf16 v[132:135], a[180:183], v[72:75], v[132:135]
    v_sub_f32 v38, v38, v50
    v_sub_f32 v39, v39, v50
    v_mfma_f32_16x16x32_bf16 v[136:139], a[184:187], v[72:75], v[136:139]
    v_cvt_pk_bf16_f32 v39, v38, v39
    v_lshlrev_b32 v38, 16, v39
    v_mfma_f32_16x16x32_bf16 v[140:143], a[188:191], v[72:75], v[140:143]
    v_and_b32 v39, 0xffff0000, v39
    v_mul_f32 v38, v38, v51
    v_mfma_f32_16x16x32_bf16 v[144:147], a[176:179], v[76:79], v[144:147]
    v_mul_f32 v39, v39, v51
    v_cvt_pk_bf16_f32 v11, v38, v39
    v_mfma_f32_16x16x32_bf16 v[148:151], a[180:183], v[76:79], v[148:151]
    v_sub_f32 v40, v40, v50
    v_sub_f32 v41, v41, v50
    v_mfma_f32_16x16x32_bf16 v[152:155], a[184:187], v[76:79], v[152:155]
    v_cvt_pk_bf16_f32 v41, v40, v41
    v_lshlrev_b32 v40, 16, v41
    v_mfma_f32_16x16x32_bf16 v[156:159], a[188:191], v[76:79], v[156:159]
    s_waitcnt vmcnt(24) lgkmcnt(0)
    s_barrier
    v_mfma_f32_16x16x32_bf16 v[160:163], a[176:179], v[80:83], v[160:163]
    ds_read_b128 v[64:67], v224 offset:32768
    v_and_b32 v41, 0xffff0000, v41
    v_mfma_f32_16x16x32_bf16 v[164:167], a[180:183], v[80:83], v[164:167]
    ds_read_b128 v[68:71], v224 offset:34816
    v_mul_f32 v40, v40, v51
    v_mfma_f32_16x16x32_bf16 v[168:171], a[184:187], v[80:83], v[168:171]
    ds_read_b128 v[72:75], v224 offset:36864
    v_mul_f32 v41, v41, v51
    v_mfma_f32_16x16x32_bf16 v[172:175], a[188:191], v[80:83], v[172:175]
    ds_read_b128 v[76:79], v224 offset:38912
    v_cvt_pk_bf16_f32 v12, v40, v41
    v_mfma_f32_16x16x32_bf16 v[176:179], a[176:179], v[84:87], v[176:179]
    ds_read_b64_tr_b16 a[200:201], v230 offset:0
    v_sub_f32 v42, v42, v50
    v_mfma_f32_16x16x32_bf16 v[180:183], a[180:183], v[84:87], v[180:183]
    ds_read_b64_tr_b16 a[202:203], v230 offset:512
    v_sub_f32 v43, v43, v50
    v_mfma_f32_16x16x32_bf16 v[184:187], a[184:187], v[84:87], v[184:187]
    ds_read_b64_tr_b16 a[204:205], v231 offset:0
    v_cvt_pk_bf16_f32 v43, v42, v43
    v_mfma_f32_16x16x32_bf16 v[188:191], a[188:191], v[84:87], v[188:191]
    ds_read_b64_tr_b16 a[206:207], v231 offset:512
    v_lshlrev_b32 v42, 16, v43
    v_mfma_f32_16x16x32_bf16 v[192:195], a[176:179], v[88:91], v[192:195]
    s_add_u32 m0, s34, 16384
    s_add_u32 s37, s82, 131072
    buffer_load_dwordx4 v232, s[44:47], s37 offen lds
    v_mfma_f32_16x16x32_bf16 v[196:199], a[180:183], v[88:91], v[196:199]
    v_and_b32 v43, 0xffff0000, v43
    v_mul_f32 v42, v42, v51
    v_mfma_f32_16x16x32_bf16 v[200:203], a[184:187], v[88:91], v[200:203]
    v_mul_f32 v43, v43, v51
    v_cvt_pk_bf16_f32 v13, v42, v43
    v_mfma_f32_16x16x32_bf16 v[204:207], a[188:191], v[88:91], v[204:207]
    v_sub_f32 v44, v44, v50
    v_sub_f32 v45, v45, v50
    v_mfma_f32_16x16x32_bf16 v[208:211], a[176:179], v[92:95], v[208:211]
    buffer_load_dwordx4 v233, s[44:47], s37 offen offset:1024 lds
    v_cvt_pk_bf16_f32 v45, v44, v45
    v_mfma_f32_16x16x32_bf16 v[212:215], a[180:183], v[92:95], v[212:215]
    v_lshlrev_b32 v44, 16, v45
    v_and_b32 v45, 0xffff0000, v45
    v_mfma_f32_16x16x32_bf16 v[216:219], a[184:187], v[92:95], v[216:219]
    v_mul_f32 v44, v44, v51
    v_mul_f32 v45, v45, v51
    v_mfma_f32_16x16x32_bf16 v[220:223], a[188:191], v[92:95], v[220:223]
    v_cvt_pk_bf16_f32 v14, v44, v45
    s_waitcnt lgkmcnt(0)
    v_mfma_f32_16x16x32_bf16 v[96:99], a[192:195], v[64:67], v[96:99]
    ds_read_b128 v[80:83], v224 offset:40960
    v_sub_f32 v46, v46, v50
    v_mfma_f32_16x16x32_bf16 v[100:103], a[196:199], v[64:67], v[100:103]
    ds_read_b128 v[84:87], v224 offset:43008
    v_sub_f32 v47, v47, v50
    v_mfma_f32_16x16x32_bf16 v[104:107], a[200:203], v[64:67], v[104:107]
    ds_read_b128 v[88:91], v224 offset:45056
    v_cvt_pk_bf16_f32 v47, v46, v47
    v_mfma_f32_16x16x32_bf16 v[108:111], a[204:207], v[64:67], v[108:111]
    ds_read_b128 v[92:95], v224 offset:47104
    v_lshlrev_b32 v46, 16, v47
    v_mfma_f32_16x16x32_bf16 v[112:115], a[192:195], v[68:71], v[112:115]
    ds_read_b64_tr_b16 a[208:209], v228 offset:4096
    v_and_b32 v47, 0xffff0000, v47
    v_mfma_f32_16x16x32_bf16 v[116:119], a[196:199], v[68:71], v[116:119]
    ds_read_b64_tr_b16 a[210:211], v228 offset:4608
    v_mul_f32 v46, v46, v51
    v_mfma_f32_16x16x32_bf16 v[120:123], a[200:203], v[68:71], v[120:123]
    ds_read_b64_tr_b16 a[212:213], v229 offset:4096
    v_mul_f32 v47, v47, v51
    v_mfma_f32_16x16x32_bf16 v[124:127], a[204:207], v[68:71], v[124:127]
    ds_read_b64_tr_b16 a[214:215], v229 offset:4608
    v_cvt_pk_bf16_f32 v15, v46, v47
    v_mfma_f32_16x16x32_bf16 v[128:131], a[192:195], v[72:75], v[128:131]
    v_mfma_f32_16x16x32_bf16 v[132:135], a[196:199], v[72:75], v[132:135]
    ds_write_b128 v237, v[0:3] offset:0
    v_mfma_f32_16x16x32_bf16 v[136:139], a[200:203], v[72:75], v[136:139]
    ds_write_b128 v237, v[4:7] offset:4096
    v_mfma_f32_16x16x32_bf16 v[140:143], a[204:207], v[72:75], v[140:143]
    ds_write_b128 v237, v[8:11] offset:24576
    v_mfma_f32_16x16x32_bf16 v[144:147], a[192:195], v[76:79], v[144:147]
    ds_write_b128 v237, v[12:15] offset:28672
    v_mfma_f32_16x16x32_bf16 v[148:151], a[196:199], v[76:79], v[148:151]
    v_mfma_f32_16x16x32_bf16 v[152:155], a[200:203], v[76:79], v[152:155]
    v_mfma_f32_16x16x32_bf16 v[156:159], a[204:207], v[76:79], v[156:159]
    s_waitcnt lgkmcnt(0)
    v_mfma_f32_16x16x32_bf16 v[160:163], a[192:195], v[80:83], v[160:163]
    ds_read_b128 v[64:67], v225 offset:32768
    v_mfma_f32_16x16x32_bf16 v[164:167], a[196:199], v[80:83], v[164:167]
    ds_read_b128 v[68:71], v225 offset:34816
    v_mfma_f32_16x16x32_bf16 v[168:171], a[200:203], v[80:83], v[168:171]
    ds_read_b128 v[72:75], v225 offset:36864
    v_mfma_f32_16x16x32_bf16 v[172:175], a[204:207], v[80:83], v[172:175]
    ds_read_b128 v[76:79], v225 offset:38912
    v_mfma_f32_16x16x32_bf16 v[176:179], a[192:195], v[84:87], v[176:179]
    ds_read_b64_tr_b16 a[216:217], v230 offset:4096
    v_mfma_f32_16x16x32_bf16 v[180:183], a[196:199], v[84:87], v[180:183]
    ds_read_b64_tr_b16 a[218:219], v230 offset:4608
    v_mfma_f32_16x16x32_bf16 v[184:187], a[200:203], v[84:87], v[184:187]
    ds_read_b64_tr_b16 a[220:221], v231 offset:4096
    v_mfma_f32_16x16x32_bf16 v[188:191], a[204:207], v[84:87], v[188:191]
    ds_read_b64_tr_b16 a[222:223], v231 offset:4608
    v_mfma_f32_16x16x32_bf16 v[192:195], a[192:195], v[88:91], v[192:195]
    s_add_u32 m0, s34, 24576
    s_add_u32 s37, s83, 131072
    buffer_load_dwordx4 v232, s[44:47], s37 offen lds
    v_mfma_f32_16x16x32_bf16 v[196:199], a[196:199], v[88:91], v[196:199]
    v_mfma_f32_16x16x32_bf16 v[200:203], a[200:203], v[88:91], v[200:203]
    buffer_load_dwordx4 v233, s[44:47], s37 offen offset:1024 lds
    v_mfma_f32_16x16x32_bf16 v[204:207], a[204:207], v[88:91], v[204:207]
    v_mfma_f32_16x16x32_bf16 v[208:211], a[192:195], v[92:95], v[208:211]
    v_mfma_f32_16x16x32_bf16 v[212:215], a[196:199], v[92:95], v[212:215]
    buffer_load_dword v254, off, s[88:91], s97 sc1
    v_mfma_f32_16x16x32_bf16 v[216:219], a[200:203], v[92:95], v[216:219]
    v_mfma_f32_16x16x32_bf16 v[220:223], a[204:207], v[92:95], v[220:223]
    s_waitcnt vmcnt(7) lgkmcnt(0)
    v_mfma_f32_16x16x32_bf16 v[96:99], a[208:211], v[64:67], v[96:99]
    ds_read_b128 v[80:83], v225 offset:40960
    v_mfma_f32_16x16x32_bf16 v[100:103], a[212:215], v[64:67], v[100:103]
    ds_read_b128 v[84:87], v225 offset:43008
    s_mul_i32 s38, s2, 100
    v_mfma_f32_16x16x32_bf16 v[104:107], a[216:219], v[64:67], v[104:107]
    ds_read_b128 v[88:91], v225 offset:45056
    v_mfma_f32_16x16x32_bf16 v[108:111], a[220:223], v[64:67], v[108:111]
    ds_read_b128 v[92:95], v225 offset:47104
    v_mfma_f32_16x16x32_bf16 v[112:115], a[208:211], v[68:71], v[112:115]
    ds_read_b64_tr_b16 a[224:225], v228 offset:8192
    v_lshl_add_u32 v60, v253, 2, s38
    v_mfma_f32_16x16x32_bf16 v[116:119], a[212:215], v[68:71], v[116:119]
    ds_read_b64_tr_b16 a[226:227], v228 offset:8704
    v_mfma_f32_16x16x32_bf16 v[120:123], a[216:219], v[68:71], v[120:123]
    ds_read_b64_tr_b16 a[228:229], v229 offset:8192
    v_mfma_f32_16x16x32_bf16 v[124:127], a[220:223], v[68:71], v[124:127]
    ds_read_b64_tr_b16 a[230:231], v229 offset:8704
    v_cmp_gt_u32 vcc, 25, v253
    v_mfma_f32_16x16x32_bf16 v[128:131], a[208:211], v[72:75], v[128:131]
    v_mov_b32 v61, 0
    v_mfma_f32_16x16x32_bf16 v[132:135], a[212:215], v[72:75], v[132:135]
    v_mfma_f32_16x16x32_bf16 v[136:139], a[216:219], v[72:75], v[136:139]
    v_mov_b32 v62, 0x7ffffff0
    v_mfma_f32_16x16x32_bf16 v[140:143], a[220:223], v[72:75], v[140:143]
    v_cndmask_b32 v60, v62, v60, vcc
    v_mfma_f32_16x16x32_bf16 v[144:147], a[208:211], v[76:79], v[144:147]
    v_mfma_f32_16x16x32_bf16 v[148:151], a[212:215], v[76:79], v[148:151]
    buffer_store_dword v61, v60, s[56:59], 0 offen sc1
    v_mfma_f32_16x16x32_bf16 v[152:155], a[216:219], v[76:79], v[152:155]
    v_mfma_f32_16x16x32_bf16 v[156:159], a[220:223], v[76:79], v[156:159]
    s_waitcnt vmcnt(18) lgkmcnt(0)
    s_barrier
    v_mfma_f32_16x16x32_bf16 v[160:163], a[208:211], v[80:83], v[160:163]
    ds_read_b128 v[64:67], v224 offset:49152
    v_mfma_f32_16x16x32_bf16 v[164:167], a[212:215], v[80:83], v[164:167]
    ds_read_b128 v[68:71], v224 offset:51200
    v_mfma_f32_16x16x32_bf16 v[168:171], a[216:219], v[80:83], v[168:171]
    ds_read_b128 v[72:75], v224 offset:53248
    v_mfma_f32_16x16x32_bf16 v[172:175], a[220:223], v[80:83], v[172:175]
    ds_read_b128 v[76:79], v224 offset:55296
    v_mfma_f32_16x16x32_bf16 v[176:179], a[208:211], v[84:87], v[176:179]
    ds_read_b64_tr_b16 a[232:233], v230 offset:8192
    v_mfma_f32_16x16x32_bf16 v[180:183], a[212:215], v[84:87], v[180:183]
    ds_read_b64_tr_b16 a[234:235], v230 offset:8704
    v_mfma_f32_16x16x32_bf16 v[184:187], a[216:219], v[84:87], v[184:187]
    ds_read_b64_tr_b16 a[236:237], v231 offset:8192
    v_mfma_f32_16x16x32_bf16 v[188:191], a[220:223], v[84:87], v[188:191]
    ds_read_b64_tr_b16 a[238:239], v231 offset:8704
    v_mfma_f32_16x16x32_bf16 v[192:195], a[208:211], v[88:91], v[192:195]
    v_lshlrev_b32 v237, 4, v253
    v_add_u32 v237, 81920, v237
    ds_read_b128 v[16:19], v237 offset:0
    ds_read_b128 v[20:23], v237 offset:4096
    ds_read_b128 v[24:27], v237 offset:24576
    ds_read_b128 v[28:31], v237 offset:28672
    s_add_u32 m0, s34, 32768
    s_add_u32 s37, s84, 131072
    buffer_load_dwordx4 v232, s[44:47], s37 offen lds
    v_mfma_f32_16x16x32_bf16 v[196:199], a[212:215], v[88:91], v[196:199]
    v_mfma_f32_16x16x32_bf16 v[200:203], a[216:219], v[88:91], v[200:203]
    v_mfma_f32_16x16x32_bf16 v[204:207], a[220:223], v[88:91], v[204:207]
    v_mfma_f32_16x16x32_bf16 v[208:211], a[208:211], v[92:95], v[208:211]
    buffer_load_dwordx4 v233, s[44:47], s37 offen offset:1024 lds
    v_mfma_f32_16x16x32_bf16 v[212:215], a[212:215], v[92:95], v[212:215]
    v_mfma_f32_16x16x32_bf16 v[216:219], a[216:219], v[92:95], v[216:219]
    v_mfma_f32_16x16x32_bf16 v[220:223], a[220:223], v[92:95], v[220:223]
    s_waitcnt lgkmcnt(0)
    v_mfma_f32_16x16x32_bf16 v[96:99], a[224:227], v[64:67], v[96:99]
    ds_read_b128 v[80:83], v224 offset:57344
    v_mfma_f32_16x16x32_bf16 v[100:103], a[228:231], v[64:67], v[100:103]
    ds_read_b128 v[84:87], v224 offset:59392
    v_mfma_f32_16x16x32_bf16 v[104:107], a[232:235], v[64:67], v[104:107]
    ds_read_b128 v[88:91], v224 offset:61440
    v_mfma_f32_16x16x32_bf16 v[108:111], a[236:239], v[64:67], v[108:111]
    ds_read_b128 v[92:95], v224 offset:63488
    v_mfma_f32_16x16x32_bf16 v[112:115], a[224:227], v[68:71], v[112:115]
    ds_read_b64_tr_b16 a[240:241], v228 offset:12288
    v_mfma_f32_16x16x32_bf16 v[116:119], a[228:231], v[68:71], v[116:119]
    ds_read_b64_tr_b16 a[242:243], v228 offset:12800
    s_mov_b32 s39, 0
    buffer_store_dwordx4 v[16:19], v238, s[8:11], s39 offen sc1
    v_mfma_f32_16x16x32_bf16 v[120:123], a[232:235], v[68:71], v[120:123]
    ds_read_b64_tr_b16 a[244:245], v229 offset:12288
    v_mfma_f32_16x16x32_bf16 v[124:127], a[236:239], v[68:71], v[124:127]
    ds_read_b64_tr_b16 a[246:247], v229 offset:12800
    v_mfma_f32_16x16x32_bf16 v[128:131], a[224:227], v[72:75], v[128:131]
    v_mfma_f32_16x16x32_bf16 v[132:135], a[228:231], v[72:75], v[132:135]
    v_mfma_f32_16x16x32_bf16 v[136:139], a[232:235], v[72:75], v[136:139]
    v_mfma_f32_16x16x32_bf16 v[140:143], a[236:239], v[72:75], v[140:143]
    v_mfma_f32_16x16x32_bf16 v[144:147], a[224:227], v[76:79], v[144:147]
    v_mfma_f32_16x16x32_bf16 v[148:151], a[228:231], v[76:79], v[148:151]
    s_mov_b32 s39, 8192
    buffer_store_dwordx4 v[20:23], v238, s[8:11], s39 offen sc1
    v_mfma_f32_16x16x32_bf16 v[152:155], a[232:235], v[76:79], v[152:155]
    v_mfma_f32_16x16x32_bf16 v[156:159], a[236:239], v[76:79], v[156:159]
    s_waitcnt lgkmcnt(0)
    v_mfma_f32_16x16x32_bf16 v[160:163], a[224:227], v[80:83], v[160:163]
    ds_read_b128 v[64:67], v225 offset:49152
    v_mfma_f32_16x16x32_bf16 v[164:167], a[228:231], v[80:83], v[164:167]
    ds_read_b128 v[68:71], v225 offset:51200
    v_mfma_f32_16x16x32_bf16 v[168:171], a[232:235], v[80:83], v[168:171]
    ds_read_b128 v[72:75], v225 offset:53248
    v_mfma_f32_16x16x32_bf16 v[172:175], a[236:239], v[80:83], v[172:175]
    ds_read_b128 v[76:79], v225 offset:55296
    v_mfma_f32_16x16x32_bf16 v[176:179], a[224:227], v[84:87], v[176:179]
    ds_read_b64_tr_b16 a[248:249], v230 offset:12288
    v_mfma_f32_16x16x32_bf16 v[180:183], a[228:231], v[84:87], v[180:183]
    ds_read_b64_tr_b16 a[250:251], v230 offset:12800
    s_mov_b32 s39, 16384
    buffer_store_dwordx4 v[24:27], v238, s[8:11], s39 offen sc1
    v_mfma_f32_16x16x32_bf16 v[184:187], a[232:235], v[84:87], v[184:187]
    ds_read_b64_tr_b16 a[252:253], v231 offset:12288
    v_mfma_f32_16x16x32_bf16 v[188:191], a[236:239], v[84:87], v[188:191]
    ds_read_b64_tr_b16 a[254:255], v231 offset:12800
    v_mfma_f32_16x16x32_bf16 v[192:195], a[224:227], v[88:91], v[192:195]
    s_add_u32 m0, s34, 40960
    s_add_u32 s37, s85, 131072
    buffer_load_dwordx4 v232, s[44:47], s37 offen lds
    v_mfma_f32_16x16x32_bf16 v[196:199], a[228:231], v[88:91], v[196:199]
    v_mfma_f32_16x16x32_bf16 v[200:203], a[232:235], v[88:91], v[200:203]
    v_mfma_f32_16x16x32_bf16 v[204:207], a[236:239], v[88:91], v[204:207]
    v_mfma_f32_16x16x32_bf16 v[208:211], a[224:227], v[92:95], v[208:211]
    buffer_load_dwordx4 v233, s[44:47], s37 offen offset:1024 lds
    v_mfma_f32_16x16x32_bf16 v[212:215], a[228:231], v[92:95], v[212:215]
    s_mov_b32 s39, 24576
    buffer_store_dwordx4 v[28:31], v238, s[8:11], s39 offen sc1
    v_mfma_f32_16x16x32_bf16 v[216:219], a[232:235], v[92:95], v[216:219]
    v_mfma_f32_16x16x32_bf16 v[220:223], a[236:239], v[92:95], v[220:223]
    s_waitcnt lgkmcnt(0)
    v_mfma_f32_16x16x32_bf16 v[96:99], a[240:243], v[64:67], v[96:99]
    ds_read_b128 v[80:83], v225 offset:57344
    v_mfma_f32_16x16x32_bf16 v[100:103], a[244:247], v[64:67], v[100:103]
    ds_read_b128 v[84:87], v225 offset:59392
    v_mfma_f32_16x16x32_bf16 v[104:107], a[248:251], v[64:67], v[104:107]
    ds_read_b128 v[88:91], v225 offset:61440
    v_mfma_f32_16x16x32_bf16 v[108:111], a[252:255], v[64:67], v[108:111]
    ds_read_b128 v[92:95], v225 offset:63488
    v_mfma_f32_16x16x32_bf16 v[112:115], a[240:243], v[68:71], v[112:115]
    v_mfma_f32_16x16x32_bf16 v[116:119], a[244:247], v[68:71], v[116:119]
    v_mfma_f32_16x16x32_bf16 v[120:123], a[248:251], v[68:71], v[120:123]
    v_mfma_f32_16x16x32_bf16 v[124:127], a[252:255], v[68:71], v[124:127]
    v_mfma_f32_16x16x32_bf16 v[128:131], a[240:243], v[72:75], v[128:131]
    v_mfma_f32_16x16x32_bf16 v[132:135], a[244:247], v[72:75], v[132:135]
    v_cvt_pk_bf16_f32 v0, v96, v97
    v_cvt_pk_bf16_f32 v1, v98, v99
    v_mfma_f32_16x16x32_bf16 v[136:139], a[248:251], v[72:75], v[136:139]
    v_cvt_pk_bf16_f32 v2, v100, v101
    v_cvt_pk_bf16_f32 v3, v102, v103
    v_mfma_f32_16x16x32_bf16 v[140:143], a[252:255], v[72:75], v[140:143]
    v_cvt_pk_bf16_f32 v4, v104, v105
    v_cvt_pk_bf16_f32 v5, v106, v107
    v_mfma_f32_16x16x32_bf16 v[144:147], a[240:243], v[76:79], v[144:147]
    v_cvt_pk_bf16_f32 v6, v108, v109
    v_cvt_pk_bf16_f32 v7, v110, v111
    v_mfma_f32_16x16x32_bf16 v[148:151], a[244:247], v[76:79], v[148:151]
    v_cvt_pk_bf16_f32 v8, v112, v113
    v_cvt_pk_bf16_f32 v9, v114, v115
    v_mfma_f32_16x16x32_bf16 v[152:155], a[248:251], v[76:79], v[152:155]
    v_cvt_pk_bf16_f32 v10, v116, v117
    v_cvt_pk_bf16_f32 v11, v118, v119
    v_mfma_f32_16x16x32_bf16 v[156:159], a[252:255], v[76:79], v[156:159]
    v_cvt_pk_bf16_f32 v12, v120, v121
    v_cvt_pk_bf16_f32 v13, v122, v123
    s_waitcnt vmcnt(14) lgkmcnt(0)
    s_barrier
    v_mfma_f32_16x16x32_bf16 v[160:163], a[240:243], v[80:83], v[160:163]
    ds_read_b128 v[64:67], v224 offset:0
    v_cvt_pk_bf16_f32 v14, v124, v125
    v_cvt_pk_bf16_f32 v15, v126, v127
    v_mfma_f32_16x16x32_bf16 v[164:167], a[244:247], v[80:83], v[164:167]
    ds_read_b128 v[68:71], v224 offset:2048
    v_cvt_pk_bf16_f32 v16, v128, v129
    v_cvt_pk_bf16_f32 v17, v130, v131
    v_mfma_f32_16x16x32_bf16 v[168:171], a[248:251], v[80:83], v[168:171]
    ds_read_b128 v[72:75], v224 offset:4096
    v_cvt_pk_bf16_f32 v18, v132, v133
    v_cvt_pk_bf16_f32 v19, v134, v135
    v_mfma_f32_16x16x32_bf16 v[172:175], a[252:255], v[80:83], v[172:175]
    ds_read_b128 v[76:79], v224 offset:6144
    v_cvt_pk_bf16_f32 v20, v136, v137
    v_cvt_pk_bf16_f32 v21, v138, v139
    v_mfma_f32_16x16x32_bf16 v[176:179], a[240:243], v[84:87], v[176:179]
    v_cvt_pk_bf16_f32 v22, v140, v141
    v_cvt_pk_bf16_f32 v23, v142, v143
    v_mfma_f32_16x16x32_bf16 v[180:183], a[244:247], v[84:87], v[180:183]
    v_cvt_pk_bf16_f32 v24, v144, v145
    v_cvt_pk_bf16_f32 v25, v146, v147
    v_mfma_f32_16x16x32_bf16 v[184:187], a[248:251], v[84:87], v[184:187]
    v_cvt_pk_bf16_f32 v26, v148, v149
    v_cvt_pk_bf16_f32 v27, v150, v151
    v_mfma_f32_16x16x32_bf16 v[188:191], a[252:255], v[84:87], v[188:191]
    v_cvt_pk_bf16_f32 v28, v152, v153
    v_cvt_pk_bf16_f32 v29, v154, v155
    v_mfma_f32_16x16x32_bf16 v[192:195], a[240:243], v[88:91], v[192:195]
    s_add_u32 m0, s34, 49152
    s_add_u32 s37, s86, 131072
    buffer_load_dwordx4 v232, s[44:47], s37 offen lds
    v_cvt_pk_bf16_f32 v30, v156, v157
    v_cvt_pk_bf16_f32 v31, v158, v159
    v_mfma_f32_16x16x32_bf16 v[196:199], a[244:247], v[88:91], v[196:199]
    v_cvt_pk_bf16_f32 v32, v160, v161
    v_cvt_pk_bf16_f32 v33, v162, v163
    v_mfma_f32_16x16x32_bf16 v[200:203], a[248:251], v[88:91], v[200:203]
    v_cvt_pk_bf16_f32 v34, v164, v165
    v_cvt_pk_bf16_f32 v35, v166, v167
    v_mfma_f32_16x16x32_bf16 v[204:207], a[252:255], v[88:91], v[204:207]
    v_cvt_pk_bf16_f32 v36, v168, v169
    v_cvt_pk_bf16_f32 v37, v170, v171
    v_mfma_f32_16x16x32_bf16 v[208:211], a[240:243], v[92:95], v[208:211]
    buffer_load_dwordx4 v233, s[44:47], s37 offen offset:1024 lds
    v_cvt_pk_bf16_f32 v38, v172, v173
    v_cvt_pk_bf16_f32 v39, v174, v175
    v_mfma_f32_16x16x32_bf16 v[212:215], a[244:247], v[92:95], v[212:215]
    v_cvt_pk_bf16_f32 v40, v176, v177
    v_cvt_pk_bf16_f32 v41, v178, v179
    v_mfma_f32_16x16x32_bf16 v[216:219], a[248:251], v[92:95], v[216:219]
    v_cvt_pk_bf16_f32 v42, v180, v181
    v_cvt_pk_bf16_f32 v43, v182, v183
    v_mfma_f32_16x16x32_bf16 v[220:223], a[252:255], v[92:95], v[220:223]
    v_cvt_pk_bf16_f32 v44, v184, v185
    v_cvt_pk_bf16_f32 v45, v186, v187
    s_waitcnt lgkmcnt(0)
    v_mfma_f32_16x16x32_bf16 v[96:99], a[0:3], v[64:67], 0
    ds_read_b128 v[80:83], v225 offset:0
    v_cvt_pk_bf16_f32 v46, v188, v189
    v_cvt_pk_bf16_f32 v47, v190, v191
    v_mfma_f32_16x16x32_bf16 v[100:103], a[4:7], v[64:67], 0
    ds_read_b128 v[84:87], v225 offset:2048
    v_cvt_pk_bf16_f32 v48, v192, v193
    v_cvt_pk_bf16_f32 v49, v194, v195
    v_mfma_f32_16x16x32_bf16 v[104:107], a[8:11], v[64:67], 0
    ds_read_b128 v[88:91], v225 offset:4096
    v_cvt_pk_bf16_f32 v50, v196, v197
    v_cvt_pk_bf16_f32 v51, v198, v199
    v_mfma_f32_16x16x32_bf16 v[108:111], a[12:15], v[64:67], 0
    ds_read_b128 v[92:95], v225 offset:6144
    v_cvt_pk_bf16_f32 v52, v200, v201
    v_cvt_pk_bf16_f32 v53, v202, v203
    v_mfma_f32_16x16x32_bf16 v[112:115], a[0:3], v[68:71], 0
    v_cvt_pk_bf16_f32 v54, v204, v205
    v_cvt_pk_bf16_f32 v55, v206, v207
    s_add_u32 s38, s36, 0
    buffer_store_dwordx4 v[0:3], v240, s[16:19], s38 offen offset:0 sc1
    v_mfma_f32_16x16x32_bf16 v[116:119], a[4:7], v[68:71], 0
    v_cvt_pk_bf16_f32 v56, v208, v209
    v_cvt_pk_bf16_f32 v57, v210, v211
    v_mfma_f32_16x16x32_bf16 v[120:123], a[8:11], v[68:71], 0
    v_cvt_pk_bf16_f32 v58, v212, v213
    v_cvt_pk_bf16_f32 v59, v214, v215
    v_mfma_f32_16x16x32_bf16 v[124:127], a[12:15], v[68:71], 0
    v_cvt_pk_bf16_f32 v60, v216, v217
    v_cvt_pk_bf16_f32 v61, v218, v219
    v_mfma_f32_16x16x32_bf16 v[128:131], a[0:3], v[72:75], 0
    v_xor_b32 v237, 32, v245
    v_xor_b32 v238, 32, v246
    v_cvt_pk_bf16_f32 v62, v220, v221
    v_cvt_pk_bf16_f32 v63, v222, v223
    v_mfma_f32_16x16x32_bf16 v[132:135], a[4:7], v[72:75], 0
    v_mfma_f32_16x16x32_bf16 v[136:139], a[8:11], v[72:75], 0
    v_mfma_f32_16x16x32_bf16 v[140:143], a[12:15], v[72:75], 0
    v_mfma_f32_16x16x32_bf16 v[144:147], a[0:3], v[76:79], 0
    v_mfma_f32_16x16x32_bf16 v[148:151], a[4:7], v[76:79], 0
    v_mfma_f32_16x16x32_bf16 v[152:155], a[8:11], v[76:79], 0
    v_mfma_f32_16x16x32_bf16 v[156:159], a[12:15], v[76:79], 0
    s_waitcnt lgkmcnt(0)
    v_mfma_f32_16x16x32_bf16 v[96:99], a[16:19], v[80:83], v[96:99]
    ds_read_b128 v[64:67], v224 offset:8192
    v_mfma_f32_16x16x32_bf16 v[100:103], a[20:23], v[80:83], v[100:103]
    ds_read_b128 v[68:71], v224 offset:10240
    v_mfma_f32_16x16x32_bf16 v[104:107], a[24:27], v[80:83], v[104:107]
    ds_read_b128 v[72:75], v224 offset:12288
    v_mfma_f32_16x16x32_bf16 v[108:111], a[28:31], v[80:83], v[108:111]
    ds_read_b128 v[76:79], v224 offset:14336
    v_mfma_f32_16x16x32_bf16 v[112:115], a[16:19], v[84:87], v[112:115]
    v_mfma_f32_16x16x32_bf16 v[116:119], a[20:23], v[84:87], v[116:119]
    v_mfma_f32_16x16x32_bf16 v[120:123], a[24:27], v[84:87], v[120:123]
    v_mfma_f32_16x16x32_bf16 v[124:127], a[28:31], v[84:87], v[124:127]
    v_mfma_f32_16x16x32_bf16 v[128:131], a[16:19], v[88:91], v[128:131]
    s_add_u32 m0, s34, 57344
    s_add_u32 s37, s87, 131072
    buffer_load_dwordx4 v232, s[44:47], s37 offen lds
    v_mfma_f32_16x16x32_bf16 v[132:135], a[20:23], v[88:91], v[132:135]
    s_add_u32 s38, s36, 0
    buffer_store_dwordx4 v[4:7], v240, s[16:19], s38 offen offset:2048 sc1
    v_mfma_f32_16x16x32_bf16 v[136:139], a[24:27], v[88:91], v[136:139]
    v_mfma_f32_16x16x32_bf16 v[140:143], a[28:31], v[88:91], v[140:143]
    v_mfma_f32_16x16x32_bf16 v[144:147], a[16:19], v[92:95], v[144:147]
    buffer_load_dwordx4 v233, s[44:47], s37 offen offset:1024 lds
    v_mfma_f32_16x16x32_bf16 v[148:151], a[20:23], v[92:95], v[148:151]
    v_mfma_f32_16x16x32_bf16 v[152:155], a[24:27], v[92:95], v[152:155]
    v_mfma_f32_16x16x32_bf16 v[156:159], a[28:31], v[92:95], v[156:159]
    s_waitcnt lgkmcnt(0)
    v_mfma_f32_16x16x32_bf16 v[96:99], a[32:35], v[64:67], v[96:99]
    ds_read_b128 v[80:83], v225 offset:8192
    v_mfma_f32_16x16x32_bf16 v[100:103], a[36:39], v[64:67], v[100:103]
    ds_read_b128 v[84:87], v225 offset:10240
    v_mfma_f32_16x16x32_bf16 v[104:107], a[40:43], v[64:67], v[104:107]
    ds_read_b128 v[88:91], v225 offset:12288
    v_mfma_f32_16x16x32_bf16 v[108:111], a[44:47], v[64:67], v[108:111]
    ds_read_b128 v[92:95], v225 offset:14336
    v_mfma_f32_16x16x32_bf16 v[112:115], a[32:35], v[68:71], v[112:115]
    v_mfma_f32_16x16x32_bf16 v[116:119], a[36:39], v[68:71], v[116:119]
    v_mfma_f32_16x16x32_bf16 v[120:123], a[40:43], v[68:71], v[120:123]
    v_mfma_f32_16x16x32_bf16 v[124:127], a[44:47], v[68:71], v[124:127]
    v_mfma_f32_16x16x32_bf16 v[128:131], a[32:35], v[72:75], v[128:131]
    s_waitcnt vmcnt(15)
    v_readfirstlane_b32 s24, v254
    s_lshl_b32 s25, s3, 16
    s_add_u32 s24, s24, s25
    s_cmp_ge_u32 s24, 1
    s_cbranch_scc0 kf_spin31
kf_spinr32:
    v_mfma_f32_16x16x32_bf16 v[132:135], a[36:39], v[72:75], v[132:135]
    v_mfma_f32_16x16x32_bf16 v[136:139], a[40:43], v[72:75], v[136:139]
    v_mfma_f32_16x16x32_bf16 v[140:143], a[44:47], v[72:75], v[140:143]
    v_mfma_f32_16x16x32_bf16 v[144:147], a[32:35], v[76:79], v[144:147]
    s_add_u32 s88, s20, 0x14a0000
    s_addc_u32 s89, s21, 0
    s_mov_b32 s90, 16384
    v_mfma_f32_16x16x32_bf16 v[148:151], a[36:39], v[76:79], v[148:151]
    v_mfma_f32_16x16x32_bf16 v[152:155], a[40:43], v[76:79], v[152:155]
    v_mfma_f32_16x16x32_bf16 v[156:159], a[44:47], v[76:79], v[156:159]
    s_add_u32 s38, s36, 0
    buffer_store_dwordx4 v[8:11], v240, s[16:19], s38 offen offset:1024 sc1
    s_waitcnt vmcnt(7) lgkmcnt(0)
    s_barrier
    v_mfma_f32_16x16x32_bf16 v[96:99], a[48:51], v[80:83], v[96:99]
    ds_read_b128 v[64:67], v224 offset:16384
    v_mfma_f32_16x16x32_bf16 v[100:103], a[52:55], v[80:83], v[100:103]
    ds_read_b128 v[68:71], v224 offset:18432
    v_mfma_f32_16x16x32_bf16 v[104:107], a[56:59], v[80:83], v[104:107]
    ds_read_b128 v[72:75], v224 offset:20480
    v_mfma_f32_16x16x32_bf16 v[108:111], a[60:63], v[80:83], v[108:111]
    ds_read_b128 v[76:79], v224 offset:22528
    v_mfma_f32_16x16x32_bf16 v[112:115], a[48:51], v[84:87], v[112:115]
    v_mfma_f32_16x16x32_bf16 v[116:119], a[52:55], v[84:87], v[116:119]
    v_mfma_f32_16x16x32_bf16 v[120:123], a[56:59], v[84:87], v[120:123]
    v_mfma_f32_16x16x32_bf16 v[124:127], a[60:63], v[84:87], v[124:127]
    v_mfma_f32_16x16x32_bf16 v[128:131], a[48:51], v[88:91], v[128:131]
    s_add_u32 m0, s34, 0
    s_add_u32 s37, s80, 196608
    buffer_load_dwordx4 v232, s[44:47], s37 offen lds
    v_mfma_f32_16x16x32_bf16 v[132:135], a[52:55], v[88:91], v[132:135]
    v_mfma_f32_16x16x32_bf16 v[136:139], a[56:59], v[88:91], v[136:139]
    buffer_load_dwordx4 v233, s[44:47], s37 offen offset:1024 lds
    v_mfma_f32_16x16x32_bf16 v[140:143], a[60:63], v[88:91], v[140:143]
    v_mfma_f32_16x16x32_bf16 v[144:147], a[48:51], v[92:95], v[144:147]
    v_mfma_f32_16x16x32_bf16 v[148:151], a[52:55], v[92:95], v[148:151]
    s_lshl_b32 s39, s5, 7
    s_add_u32 s39, s39, 8192
    buffer_atomic_add v255, v250, s[88:91], s39 offen sc1
    s_cmp_eq_u32 s3, 0
    s_cselect_b32 s39, s39, s43
    v_mfma_f32_16x16x32_bf16 v[152:155], a[56:59], v[92:95], v[152:155]
    v_mfma_f32_16x16x32_bf16 v[156:159], a[60:63], v[92:95], v[156:159]
    s_waitcnt lgkmcnt(0)
    v_mfma_f32_16x16x32_bf16 v[96:99], a[64:67], v[64:67], v[96:99]
    ds_read_b128 v[80:83], v225 offset:16384
    v_mfma_f32_16x16x32_bf16 v[100:103], a[68:71], v[64:67], v[100:103]
    ds_read_b128 v[84:87], v225 offset:18432
    v_mfma_f32_16x16x32_bf16 v[104:107], a[72:75], v[64:67], v[104:107]
    ds_read_b128 v[88:91], v225 offset:20480
    v_mfma_f32_16x16x32_bf16 v[108:111], a[76:79], v[64:67], v[108:111]
    ds_read_b128 v[92:95], v225 offset:22528
    v_mfma_f32_16x16x32_bf16 v[112:115], a[64:67], v[68:71], v[112:115]
    s_add_u32 s38, s36, 0
    buffer_store_dwordx4 v[12:15], v240, s[16:19], s38 offen offset:3072 sc1
    v_mfma_f32_16x16x32_bf16 v[116:119], a[68:71], v[68:71], v[116:119]
    v_mfma_f32_16x16x32_bf16 v[120:123], a[72:75], v[68:71], v[120:123]
    v_mfma_f32_16x16x32_bf16 v[124:127], a[76:79], v[68:71], v[124:127]
    v_mfma_f32_16x16x32_bf16 v[128:131], a[64:67], v[72:75], v[128:131]
    s_add_u32 m0, s31, 0
    s_add_u32 s24, s27, 0
    buffer_load_dwordx4 v245, s[12:15], s24 offen lds
    v_mfma_f32_16x16x32_bf16 v[132:135], a[68:71], v[72:75], v[132:135]
    v_mfma_f32_16x16x32_bf16 v[136:139], a[72:75], v[72:75], v[136:139]
    v_mfma_f32_16x16x32_bf16 v[140:143], a[76:79], v[72:75], v[140:143]
    v_mfma_f32_16x16x32_bf16 v[144:147], a[64:67], v[76:79], v[144:147]
    v_mfma_f32_16x16x32_bf16 v[148:151], a[68:71], v[76:79], v[148:151]
    v_mfma_f32_16x16x32_bf16 v[152:155], a[72:75], v[76:79], v[152:155]
    v_mfma_f32_16x16x32_bf16 v[156:159], a[76:79], v[76:79], v[156:159]
    s_waitcnt lgkmcnt(0)
    v_mfma_f32_16x16x32_bf16 v[96:99], a[80:83], v[80:83], v[96:99]
    ds_read_b128 v[64:67], v224 offset:24576
    v_mfma_f32_16x16x32_bf16 v[100:103], a[84:87], v[80:83], v[100:103]
    ds_read_b128 v[68:71], v224 offset:26624
    v_mfma_f32_16x16x32_bf16 v[104:107], a[88:91], v[80:83], v[104:107]
    ds_read_b128 v[72:75], v224 offset:28672
    v_mfma_f32_16x16x32_bf16 v[108:111], a[92:95], v[80:83], v[108:111]
    ds_read_b128 v[76:79], v224 offset:30720
    v_mfma_f32_16x16x32_bf16 v[112:115], a[80:83], v[84:87], v[112:115]
    v_mfma_f32_16x16x32_bf16 v[116:119], a[84:87], v[84:87], v[116:119]
    v_mfma_f32_16x16x32_bf16 v[120:123], a[88:91], v[84:87], v[120:123]
    v_mfma_f32_16x16x32_bf16 v[124:127], a[92:95], v[84:87], v[124:127]
    v_mfma_f32_16x16x32_bf16 v[128:131], a[80:83], v[88:91], v[128:131]
    s_add_u32 m0, s34, 8192
    s_add_u32 s37, s81, 196608
    buffer_load_dwordx4 v232, s[44:47], s37 offen lds
    v_mfma_f32_16x16x32_bf16 v[132:135], a[84:87], v[88:91], v[132:135]
    v_mfma_f32_16x16x32_bf16 v[136:139], a[88:91], v[88:91], v[136:139]
    buffer_load_dwordx4 v233, s[44:47], s37 offen offset:1024 lds
    s_add_u32 s38, s36, 8192
    buffer_store_dwordx4 v[16:19], v240, s[16:19], s38 offen offset:0 sc1
    v_mfma_f32_16x16x32_bf16 v[140:143], a[92:95], v[88:91], v[140:143]
    v_mfma_f32_16x16x32_bf16 v[144:147], a[80:83], v[92:95], v[144:147]
    v_mfma_f32_16x16x32_bf16 v[148:151], a[84:87], v[92:95], v[148:151]
    s_add_u32 m0, s31, 1024
    s_add_u32 s24, s27, 32768
    buffer_load_dwordx4 v245, s[12:15], s24 offen lds
    v_mfma_f32_16x16x32_bf16 v[152:155], a[88:91], v[92:95], v[152:155]
    v_mfma_f32_16x16x32_bf16 v[156:159], a[92:95], v[92:95], v[156:159]
    s_waitcnt lgkmcnt(0)
    v_mfma_f32_16x16x32_bf16 v[96:99], a[96:99], v[64:67], v[96:99]
    ds_read_b128 v[80:83], v225 offset:24576
    v_mfma_f32_16x16x32_bf16 v[100:103], a[100:103], v[64:67], v[100:103]
    ds_read_b128 v[84:87], v225 offset:26624
    v_mfma_f32_16x16x32_bf16 v[104:107], a[104:107], v[64:67], v[104:107]
    ds_read_b128 v[88:91], v225 offset:28672
    v_mfma_f32_16x16x32_bf16 v[108:111], a[108:111], v[64:67], v[108:111]
    ds_read_b128 v[92:95], v225 offset:30720
    v_mfma_f32_16x16x32_bf16 v[112:115], a[96:99], v[68:71], v[112:115]
    v_mfma_f32_16x16x32_bf16 v[116:119], a[100:103], v[68:71], v[116:119]
    v_mfma_f32_16x16x32_bf16 v[120:123], a[104:107], v[68:71], v[120:123]
    v_mfma_f32_16x16x32_bf16 v[124:127], a[108:111], v[68:71], v[124:127]
    v_mfma_f32_16x16x32_bf16 v[128:131], a[96:99], v[72:75], v[128:131]
    s_add_u32 m0, s31, 2048
    s_add_u32 s24, s27, 65536
    buffer_load_dwordx4 v237, s[12:15], s24 offen lds
    v_mfma_f32_16x16x32_bf16 v[132:135], a[100:103], v[72:75], v[132:135]
    v_mfma_f32_16x16x32_bf16 v[136:139], a[104:107], v[72:75], v[136:139]
    v_mfma_f32_16x16x32_bf16 v[140:143], a[108:111], v[72:75], v[140:143]
    v_mfma_f32_16x16x32_bf16 v[144:147], a[96:99], v[76:79], v[144:147]
    v_mfma_f32_16x16x32_bf16 v[148:151], a[100:103], v[76:79], v[148:151]
    v_mfma_f32_16x16x32_bf16 v[152:155], a[104:107], v[76:79], v[152:155]
    v_mfma_f32_16x16x32_bf16 v[156:159], a[108:111], v[76:79], v[156:159]
    s_add_u32 s38, s36, 8192
    buffer_store_dwordx4 v[20:23], v240, s[16:19], s38 offen offset:2048 sc1
    s_waitcnt vmcnt(19) lgkmcnt(0)
    s_barrier
    v_mfma_f32_16x16x32_bf16 v[96:99], a[112:115], v[80:83], v[96:99]
    ds_read_b128 v[64:67], v224 offset:32768
    v_mfma_f32_16x16x32_bf16 v[100:103], a[116:119], v[80:83], v[100:103]
    ds_read_b128 v[68:71], v224 offset:34816
    v_mfma_f32_16x16x32_bf16 v[104:107], a[120:123], v[80:83], v[104:107]
    ds_read_b128 v[72:75], v224 offset:36864
    v_mfma_f32_16x16x32_bf16 v[108:111], a[124:127], v[80:83], v[108:111]
    ds_read_b128 v[76:79], v224 offset:38912
    v_mfma_f32_16x16x32_bf16 v[112:115], a[112:115], v[84:87], v[112:115]
    v_mfma_f32_16x16x32_bf16 v[116:119], a[116:119], v[84:87], v[116:119]
    v_mfma_f32_16x16x32_bf16 v[120:123], a[120:123], v[84:87], v[120:123]
    v_mfma_f32_16x16x32_bf16 v[124:127], a[124:127], v[84:87], v[124:127]
    v_mfma_f32_16x16x32_bf16 v[128:131], a[112:115], v[88:91], v[128:131]
    s_add_u32 m0, s34, 16384
    s_add_u32 s37, s82, 196608
    buffer_load_dwordx4 v232, s[44:47], s37 offen lds
    v_mfma_f32_16x16x32_bf16 v[132:135], a[116:119], v[88:91], v[132:135]
    v_mfma_f32_16x16x32_bf16 v[136:139], a[120:123], v[88:91], v[136:139]
    buffer_load_dwordx4 v233, s[44:47], s37 offen offset:1024 lds
    v_mfma_f32_16x16x32_bf16 v[140:143], a[124:127], v[88:91], v[140:143]
    v_mfma_f32_16x16x32_bf16 v[144:147], a[112:115], v[92:95], v[144:147]
    v_mfma_f32_16x16x32_bf16 v[148:151], a[116:119], v[92:95], v[148:151]
    s_add_u32 m0, s31, 3072
    s_add_u32 s24, s27, 98304
    buffer_load_dwordx4 v237, s[12:15], s24 offen lds
    v_mfma_f32_16x16x32_bf16 v[152:155], a[120:123], v[92:95], v[152:155]
    v_mfma_f32_16x16x32_bf16 v[156:159], a[124:127], v[92:95], v[156:159]
    s_waitcnt lgkmcnt(0)
    v_mfma_f32_16x16x32_bf16 v[96:99], a[128:131], v[64:67], v[96:99]
    ds_read_b128 v[80:83], v225 offset:32768
    v_mfma_f32_16x16x32_bf16 v[100:103], a[132:135], v[64:67], v[100:103]
    ds_read_b128 v[84:87], v225 offset:34816
    v_mfma_f32_16x16x32_bf16 v[104:107], a[136:139], v[64:67], v[104:107]
    ds_read_b128 v[88:91], v225 offset:36864
    v_mfma_f32_16x16x32_bf16 v[108:111], a[140:143], v[64:67], v[108:111]
    ds_read_b128 v[92:95], v225 offset:38912
    v_mfma_f32_16x16x32_bf16 v[112:115], a[128:131], v[68:71], v[112:115]
    v_mfma_f32_16x16x32_bf16 v[116:119], a[132:135], v[68:71], v[116:119]
    s_add_u32 s38, s36, 8192
    buffer_store_dwordx4 v[24:27], v240, s[16:19], s38 offen offset:1024 sc1
    v_mfma_f32_16x16x32_bf16 v[120:123], a[136:139], v[68:71], v[120:123]
    v_mfma_f32_16x16x32_bf16 v[124:127], a[140:143], v[68:71], v[124:127]
    v_mfma_f32_16x16x32_bf16 v[128:131], a[128:131], v[72:75], v[128:131]
    s_add_u32 m0, s31, 4096
    s_add_u32 s24, s27, 131072
    buffer_load_dwordx4 v245, s[12:15], s24 offen lds
    v_mfma_f32_16x16x32_bf16 v[132:135], a[132:135], v[72:75], v[132:135]
    v_mfma_f32_16x16x32_bf16 v[136:139], a[136:139], v[72:75], v[136:139]
    v_mfma_f32_16x16x32_bf16 v[140:143], a[140:143], v[72:75], v[140:143]
    v_mfma_f32_16x16x32_bf16 v[144:147], a[128:131], v[76:79], v[144:147]
    v_mfma_f32_16x16x32_bf16 v[148:151], a[132:135], v[76:79], v[148:151]
    v_mfma_f32_16x16x32_bf16 v[152:155], a[136:139], v[76:79], v[152:155]
    v_mfma_f32_16x16x32_bf16 v[156:159], a[140:143], v[76:79], v[156:159]
    s_waitcnt lgkmcnt(0)
    v_mfma_f32_16x16x32_bf16 v[96:99], a[144:147], v[80:83], v[96:99]
    ds_read_b128 v[64:67], v224 offset:40960
    v_mfma_f32_16x16x32_bf16 v[100:103], a[148:151], v[80:83], v[100:103]
    ds_read_b128 v[68:71], v224 offset:43008
    v_mfma_f32_16x16x32_bf16 v[104:107], a[152:155], v[80:83], v[104:107]
    ds_read_b128 v[72:75], v224 offset:45056
    v_mfma_f32_16x16x32_bf16 v[108:111], a[156:159], v[80:83], v[108:111]
    ds_read_b128 v[76:79], v224 offset:47104
    v_mfma_f32_16x16x32_bf16 v[112:115], a[144:147], v[84:87], v[112:115]
    v_mfma_f32_16x16x32_bf16 v[116:119], a[148:151], v[84:87], v[116:119]
    v_mfma_f32_16x16x32_bf16 v[120:123], a[152:155], v[84:87], v[120:123]
    v_mfma_f32_16x16x32_bf16 v[124:127], a[156:159], v[84:87], v[124:127]
    v_mfma_f32_16x16x32_bf16 v[128:131], a[144:147], v[88:91], v[128:131]
    s_add_u32 m0, s34, 24576
    s_add_u32 s37, s83, 196608
    buffer_load_dwordx4 v232, s[44:47], s37 offen lds
    v_mfma_f32_16x16x32_bf16 v[132:135], a[148:151], v[88:91], v[132:135]
    v_mfma_f32_16x16x32_bf16 v[136:139], a[152:155], v[88:91], v[136:139]
    buffer_load_dwordx4 v233, s[44:47], s37 offen offset:1024 lds
    s_add_u32 s38, s36, 8192
    buffer_store_dwordx4 v[28:31], v240, s[16:19], s38 offen offset:3072 sc1
    v_mfma_f32_16x16x32_bf16 v[140:143], a[156:159], v[88:91], v[140:143]
    v_mfma_f32_16x16x32_bf16 v[144:147], a[144:147], v[92:95], v[144:147]
    v_mfma_f32_16x16x32_bf16 v[148:151], a[148:151], v[92:95], v[148:151]
    s_add_u32 m0, s31, 5120
    s_add_u32 s24, s27, 163840
    buffer_load_dwordx4 v245, s[12:15], s24 offen lds
    v_mfma_f32_16x16x32_bf16 v[152:155], a[152:155], v[92:95], v[152:155]
    v_mfma_f32_16x16x32_bf16 v[156:159], a[156:159], v[92:95], v[156:159]
    s_waitcnt lgkmcnt(0)
    v_mfma_f32_16x16x32_bf16 v[96:99], a[160:163], v[64:67], v[96:99]
    ds_read_b128 v[80:83], v225 offset:40960
    v_mfma_f32_16x16x32_bf16 v[100:103], a[164:167], v[64:67], v[100:103]
    ds_read_b128 v[84:87], v225 offset:43008
    v_mfma_f32_16x16x32_bf16 v[104:107], a[168:171], v[64:67], v[104:107]
    ds_read_b128 v[88:91], v225 offset:45056
    v_mfma_f32_16x16x32_bf16 v[108:111], a[172:175], v[64:67], v[108:111]
    ds_read_b128 v[92:95], v225 offset:47104
    v_mfma_f32_16x16x32_bf16 v[112:115], a[160:163], v[68:71], v[112:115]
    v_mfma_f32_16x16x32_bf16 v[116:119], a[164:167], v[68:71], v[116:119]
    v_mfma_f32_16x16x32_bf16 v[120:123], a[168:171], v[68:71], v[120:123]
    v_mfma_f32_16x16x32_bf16 v[124:127], a[172:175], v[68:71], v[124:127]
    v_mfma_f32_16x16x32_bf16 v[128:131], a[160:163], v[72:75], v[128:131]
    s_add_u32 m0, s31, 6144
    s_add_u32 s24, s27, 196608
    buffer_load_dwordx4 v237, s[12:15], s24 offen lds
    v_mfma_f32_16x16x32_bf16 v[132:135], a[164:167], v[72:75], v[132:135]
    v_mfma_f32_16x16x32_bf16 v[136:139], a[168:171], v[72:75], v[136:139]
    v_mfma_f32_16x16x32_bf16 v[140:143], a[172:175], v[72:75], v[140:143]
    v_mfma_f32_16x16x32_bf16 v[144:147], a[160:163], v[76:79], v[144:147]
    v_mfma_f32_16x16x32_bf16 v[148:151], a[164:167], v[76:79], v[148:151]
    v_mfma_f32_16x16x32_bf16 v[152:155], a[168:171], v[76:79], v[152:155]
    v_mfma_f32_16x16x32_bf16 v[156:159], a[172:175], v[76:79], v[156:159]
    s_waitcnt vmcnt(22) lgkmcnt(0)
    s_barrier
    v_mfma_f32_16x16x32_bf16 v[96:99], a[176:179], v[80:83], v[96:99]
    ds_read_b128 v[64:67], v224 offset:49152
    s_add_u32 s38, s36, 32768
    buffer_store_dwordx4 v[32:35], v240, s[16:19], s38 offen offset:1280 sc1
    v_mfma_f32_16x16x32_bf16 v[100:103], a[180:183], v[80:83], v[100:103]
    ds_read_b128 v[68:71], v224 offset:51200
    v_mfma_f32_16x16x32_bf16 v[104:107], a[184:187], v[80:83], v[104:107]
    ds_read_b128 v[72:75], v224 offset:53248
    v_mfma_f32_16x16x32_bf16 v[108:111], a[188:191], v[80:83], v[108:111]
    ds_read_b128 v[76:79], v224 offset:55296
    v_mfma_f32_16x16x32_bf16 v[112:115], a[176:179], v[84:87], v[112:115]
    v_mfma_f32_16x16x32_bf16 v[116:119], a[180:183], v[84:87], v[116:119]
    v_mfma_f32_16x16x32_bf16 v[120:123], a[184:187], v[84:87], v[120:123]
    v_mfma_f32_16x16x32_bf16 v[124:127], a[188:191], v[84:87], v[124:127]
    v_mfma_f32_16x16x32_bf16 v[128:131], a[176:179], v[88:91], v[128:131]
    s_add_u32 m0, s34, 32768
    s_add_u32 s37, s84, 196608
    buffer_load_dwordx4 v232, s[44:47], s37 offen lds
    v_mfma_f32_16x16x32_bf16 v[132:135], a[180:183], v[88:91], v[132:135]
    buffer_load_dwordx4 v233, s[44:47], s37 offen offset:1024 lds
    v_mfma_f32_16x16x32_bf16 v[136:139], a[184:187], v[88:91], v[136:139]
    v_mfma_f32_16x16x32_bf16 v[140:143], a[188:191], v[88:91], v[140:143]
    s_add_u32 m0, s31, 7168
    s_add_u32 s24, s27, 229376
    buffer_load_dwordx4 v237, s[12:15], s24 offen lds
    v_mfma_f32_16x16x32_bf16 v[144:147], a[176:179], v[92:95], v[144:147]
    s_add_u32 s27, s27, 1048576
    s_and_b32 s27, s27, 0x407fffff
    s_cmp_eq_u32 s27, s7
    s_cselect_b32 s27, s43, s27
    v_mfma_f32_16x16x32_bf16 v[148:151], a[180:183], v[92:95], v[148:151]
    v_mfma_f32_16x16x32_bf16 v[152:155], a[184:187], v[92:95], v[152:155]
    s_add_u32 s31, s31, 32768
    s_cmp_ge_u32 s31, 163840
    s_cselect_b32 s24, 98304, 0
    s_sub_u32 s31, s31, s24
    v_mfma_f32_16x16x32_bf16 v[156:159], a[188:191], v[92:95], v[156:159]
    s_waitcnt lgkmcnt(0)
    v_mfma_f32_16x16x32_bf16 v[96:99], a[192:195], v[64:67], v[96:99]
    ds_read_b128 v[80:83], v225 offset:49152
    v_mfma_f32_16x16x32_bf16 v[100:103], a[196:199], v[64:67], v[100:103]
    ds_read_b128 v[84:87], v225 offset:51200
    v_mfma_f32_16x16x32_bf16 v[104:107], a[200:203], v[64:67], v[104:107]
    ds_read_b128 v[88:91], v225 offset:53248
    v_mfma_f32_16x16x32_bf16 v[108:111], a[204:207], v[64:67], v[108:111]
    ds_read_b128 v[92:95], v225 offset:55296
    v_mfma_f32_16x16x32_bf16 v[112:115], a[192:195], v[68:71], v[112:115]
    v_mfma_f32_16x16x32_bf16 v[116:119], a[196:199], v[68:71], v[116:119]
    v_mfma_f32_16x16x32_bf16 v[120:123], a[200:203], v[68:71], v[120:123]
    s_add_u32 s38, s36, 32768
    buffer_store_dwordx4 v[36:39], v240, s[16:19], s38 offen offset:3328 sc1
    v_mfma_f32_16x16x32_bf16 v[124:127], a[204:207], v[68:71], v[124:127]
    v_mfma_f32_16x16x32_bf16 v[128:131], a[192:195], v[72:75], v[128:131]
    v_mfma_f32_16x16x32_bf16 v[132:135], a[196:199], v[72:75], v[132:135]
    v_mfma_f32_16x16x32_bf16 v[136:139], a[200:203], v[72:75], v[136:139]
    v_mfma_f32_16x16x32_bf16 v[140:143], a[204:207], v[72:75], v[140:143]
    v_mfma_f32_16x16x32_bf16 v[144:147], a[192:195], v[76:79], v[144:147]
    v_mfma_f32_16x16x32_bf16 v[148:151], a[196:199], v[76:79], v[148:151]
    v_mfma_f32_16x16x32_bf16 v[152:155], a[200:203], v[76:79], v[152:155]
    v_mfma_f32_16x16x32_bf16 v[156:159], a[204:207], v[76:79], v[156:159]
    s_waitcnt lgkmcnt(0)
    v_mfma_f32_16x16x32_bf16 v[96:99], a[208:211], v[80:83], v[96:99]
    ds_read_b128 v[64:67], v224 offset:57344
    v_mfma_f32_16x16x32_bf16 v[100:103], a[212:215], v[80:83], v[100:103]
    ds_read_b128 v[68:71], v224 offset:59392
    v_mfma_f32_16x16x32_bf16 v[104:107], a[216:219], v[80:83], v[104:107]
    ds_read_b128 v[72:75], v224 offset:61440
    v_mfma_f32_16x16x32_bf16 v[108:111], a[220:223], v[80:83], v[108:111]
    ds_read_b128 v[76:79], v224 offset:63488
    v_mfma_f32_16x16x32_bf16 v[112:115], a[208:211], v[84:87], v[112:115]
    v_mfma_f32_16x16x32_bf16 v[116:119], a[212:215], v[84:87], v[116:119]
    v_mfma_f32_16x16x32_bf16 v[120:123], a[216:219], v[84:87], v[120:123]
    v_mfma_f32_16x16x32_bf16 v[124:127], a[220:223], v[84:87], v[124:127]
    v_mfma_f32_16x16x32_bf16 v[128:131], a[208:211], v[88:91], v[128:131]
    s_add_u32 m0, s34, 40960
    s_add_u32 s37, s85, 196608
    buffer_load_dwordx4 v232, s[44:47], s37 offen lds
    v_mfma_f32_16x16x32_bf16 v[132:135], a[212:215], v[88:91], v[132:135]
    v_mfma_f32_16x16x32_bf16 v[136:139], a[216:219], v[88:91], v[136:139]
    v_mfma_f32_16x16x32_bf16 v[140:143], a[220:223], v[88:91], v[140:143]
    s_add_u32 s38, s36, 32768
    buffer_store_dwordx4 v[40:43], v240, s[16:19], s38 offen offset:2304 sc1
    v_mfma_f32_16x16x32_bf16 v[144:147], a[208:211], v[92:95], v[144:147]
    buffer_load_dwordx4 v233, s[44:47], s37 offen offset:1024 lds
    v_mfma_f32_16x16x32_bf16 v[148:151], a[212:215], v[92:95], v[148:151]
    v_mfma_f32_16x16x32_bf16 v[152:155], a[216:219], v[92:95], v[152:155]
    v_mfma_f32_16x16x32_bf16 v[156:159], a[220:223], v[92:95], v[156:159]
    s_waitcnt lgkmcnt(0)
    v_mfma_f32_16x16x32_bf16 v[96:99], a[224:227], v[64:67], v[96:99]
    ds_read_b128 v[80:83], v225 offset:57344
    v_mfma_f32_16x16x32_bf16 v[100:103], a[228:231], v[64:67], v[100:103]
    ds_read_b128 v[84:87], v225 offset:59392
    v_mfma_f32_16x16x32_bf16 v[104:107], a[232:235], v[64:67], v[104:107]
    ds_read_b128 v[88:91], v225 offset:61440
    v_mfma_f32_16x16x32_bf16 v[108:111], a[236:239], v[64:67], v[108:111]
    ds_read_b128 v[92:95], v225 offset:63488
    v_mfma_f32_16x16x32_bf16 v[112:115], a[224:227], v[68:71], v[112:115]
    v_mfma_f32_16x16x32_bf16 v[116:119], a[228:231], v[68:71], v[116:119]
    v_mfma_f32_16x16x32_bf16 v[120:123], a[232:235], v[68:71], v[120:123]
    v_mfma_f32_16x16x32_bf16 v[124:127], a[236:239], v[68:71], v[124:127]
    v_mfma_f32_16x16x32_bf16 v[128:131], a[224:227], v[72:75], v[128:131]
    s_add_u32 m0, s31, 0
    s_add_u32 s24, s27, 0
    buffer_load_dwordx4 v245, s[12:15], s24 offen lds
    v_mfma_f32_16x16x32_bf16 v[132:135], a[228:231], v[72:75], v[132:135]
    v_mfma_f32_16x16x32_bf16 v[136:139], a[232:235], v[72:75], v[136:139]
    v_mfma_f32_16x16x32_bf16 v[140:143], a[236:239], v[72:75], v[140:143]
    v_mfma_f32_16x16x32_bf16 v[144:147], a[224:227], v[76:79], v[144:147]
    v_mfma_f32_16x16x32_bf16 v[148:151], a[228:231], v[76:79], v[148:151]
    v_mfma_f32_16x16x32_bf16 v[152:155], a[232:235], v[76:79], v[152:155]
    v_mfma_f32_16x16x32_bf16 v[156:159], a[236:239], v[76:79], v[156:159]
    s_waitcnt vmcnt(23) lgkmcnt(0)
    s_barrier
    v_mfma_f32_16x16x32_bf16 v[96:99], a[240:243], v[80:83], v[96:99]
    ds_read_b128 v[64:67], v224 offset:0
    v_mfma_f32_16x16x32_bf16 v[100:103], a[244:247], v[80:83], v[100:103]
    ds_read_b128 v[68:71], v224 offset:2048
    s_add_u32 s38, s36, 36864
    buffer_store_dwordx4 v[44:47], v240, s[16:19], s38 offen offset:256 sc1
    v_mfma_f32_16x16x32_bf16 v[104:107], a[248:251], v[80:83], v[104:107]
    ds_read_b128 v[72:75], v224 offset:4096
    v_mfma_f32_16x16x32_bf16 v[108:111], a[252:255], v[80:83], v[108:111]
    ds_read_b128 v[76:79], v224 offset:6144
    v_mfma_f32_16x16x32_bf16 v[112:115], a[240:243], v[84:87], v[112:115]
    v_mfma_f32_16x16x32_bf16 v[116:119], a[244:247], v[84:87], v[116:119]
    v_mfma_f32_16x16x32_bf16 v[120:123], a[248:251], v[84:87], v[120:123]
    v_mfma_f32_16x16x32_bf16 v[124:127], a[252:255], v[84:87], v[124:127]
    v_mfma_f32_16x16x32_bf16 v[128:131], a[240:243], v[88:91], v[128:131]
    s_add_u32 m0, s34, 49152
    s_add_u32 s37, s86, 196608
    buffer_load_dwordx4 v232, s[44:47], s37 offen lds
    v_mfma_f32_16x16x32_bf16 v[132:135], a[244:247], v[88:91], v[132:135]
    v_mfma_f32_16x16x32_bf16 v[136:139], a[248:251], v[88:91], v[136:139]
    buffer_load_dwordx4 v233, s[44:47], s37 offen offset:1024 lds
    v_mfma_f32_16x16x32_bf16 v[140:143], a[252:255], v[88:91], v[140:143]
    v_mfma_f32_16x16x32_bf16 v[144:147], a[240:243], v[92:95], v[144:147]
    v_mfma_f32_16x16x32_bf16 v[148:151], a[244:247], v[92:95], v[148:151]
    s_add_u32 m0, s31, 1024
    s_add_u32 s24, s27, 32768
    buffer_load_dwordx4 v245, s[12:15], s24 offen lds
    v_mfma_f32_16x16x32_bf16 v[152:155], a[248:251], v[92:95], v[152:155]
    v_mfma_f32_16x16x32_bf16 v[156:159], a[252:255], v[92:95], v[156:159]
    s_waitcnt lgkmcnt(0)
    v_mfma_f32_16x16x32_bf16 v[160:163], a[0:3], v[64:67], 0
    ds_read_b128 v[80:83], v225 offset:0
    v_mfma_f32_16x16x32_bf16 v[164:167], a[4:7], v[64:67], 0
    ds_read_b128 v[84:87], v225 offset:2048
    v_mfma_f32_16x16x32_bf16 v[168:171], a[8:11], v[64:67], 0
    ds_read_b128 v[88:91], v225 offset:4096
    v_mfma_f32_16x16x32_bf16 v[172:175], a[12:15], v[64:67], 0
    ds_read_b128 v[92:95], v225 offset:6144
    v_mfma_f32_16x16x32_bf16 v[176:179], a[0:3], v[68:71], 0
    v_cvt_pk_bf16_f32 v0, v96, v97
    v_cvt_pk_bf16_f32 v1, v98, v99
    v_mfma_f32_16x16x32_bf16 v[180:183], a[4:7], v[68:71], 0
    v_mfma_f32_16x16x32_bf16 v[184:187], a[8:11], v[68:71], 0
    v_cvt_pk_bf16_f32 v2, v100, v101
    v_cvt_pk_bf16_f32 v3, v102, v103
    s_add_u32 s38, s36, 40960
    buffer_store_dwordx4 v[48:51], v240, s[16:19], s38 offen offset:1280 sc1
    v_mfma_f32_16x16x32_bf16 v[188:191], a[12:15], v[68:71], 0
    v_mfma_f32_16x16x32_bf16 v[192:195], a[0:3], v[72:75], 0
    s_add_u32 m0, s31, 2048
    s_add_u32 s24, s27, 65536
    buffer_load_dwordx4 v237, s[12:15], s24 offen lds
    v_cvt_pk_bf16_f32 v4, v104, v105
    v_cvt_pk_bf16_f32 v5, v106, v107
    v_mfma_f32_16x16x32_bf16 v[196:199], a[4:7], v[72:75], 0
    v_mfma_f32_16x16x32_bf16 v[200:203], a[8:11], v[72:75], 0
    v_cvt_pk_bf16_f32 v6, v108, v109
    v_cvt_pk_bf16_f32 v7, v110, v111
    v_mfma_f32_16x16x32_bf16 v[204:207], a[12:15], v[72:75], 0
    v_mfma_f32_16x16x32_bf16 v[208:211], a[0:3], v[76:79], 0
    v_cvt_pk_bf16_f32 v8, v112, v113
    v_cvt_pk_bf16_f32 v9, v114, v115
    v_mfma_f32_16x16x32_bf16 v[212:215], a[4:7], v[76:79], 0
    v_mfma_f32_16x16x32_bf16 v[216:219], a[8:11], v[76:79], 0
    v_cvt_pk_bf16_f32 v10, v116, v117
    v_cvt_pk_bf16_f32 v11, v118, v119
    v_mfma_f32_16x16x32_bf16 v[220:223], a[12:15], v[76:79], 0
    s_waitcnt lgkmcnt(0)
    v_mfma_f32_16x16x32_bf16 v[160:163], a[16:19], v[80:83], v[160:163]
    ds_read_b128 v[64:67], v224 offset:8192
    v_cvt_pk_bf16_f32 v12, v120, v121
    v_cvt_pk_bf16_f32 v13, v122, v123
    v_mfma_f32_16x16x32_bf16 v[164:167], a[20:23], v[80:83], v[164:167]
    ds_read_b128 v[68:71], v224 offset:10240
    v_mfma_f32_16x16x32_bf16 v[168:171], a[24:27], v[80:83], v[168:171]
    ds_read_b128 v[72:75], v224 offset:12288
    v_cvt_pk_bf16_f32 v14, v124, v125
    v_cvt_pk_bf16_f32 v15, v126, v127
    v_mfma_f32_16x16x32_bf16 v[172:175], a[28:31], v[80:83], v[172:175]
    ds_read_b128 v[76:79], v224 offset:14336
    v_mfma_f32_16x16x32_bf16 v[176:179], a[16:19], v[84:87], v[176:179]
    v_cvt_pk_bf16_f32 v16, v128, v129
    v_cvt_pk_bf16_f32 v17, v130, v131
    v_mfma_f32_16x16x32_bf16 v[180:183], a[20:23], v[84:87], v[180:183]
    v_mfma_f32_16x16x32_bf16 v[184:187], a[24:27], v[84:87], v[184:187]
    v_cvt_pk_bf16_f32 v18, v132, v133
    v_cvt_pk_bf16_f32 v19, v134, v135
    v_mfma_f32_16x16x32_bf16 v[188:191], a[28:31], v[84:87], v[188:191]
    v_mfma_f32_16x16x32_bf16 v[192:195], a[16:19], v[88:91], v[192:195]
    s_add_u32 m0, s34, 57344
    s_add_u32 s37, s87, 196608
    buffer_load_dwordx4 v232, s[44:47], s37 offen lds
    v_cvt_pk_bf16_f32 v20, v136, v137
    v_cvt_pk_bf16_f32 v21, v138, v139
    v_mfma_f32_16x16x32_bf16 v[196:199], a[20:23], v[88:91], v[196:199]
    v_mfma_f32_16x16x32_bf16 v[200:203], a[24:27], v[88:91], v[200:203]
    buffer_load_dwordx4 v233, s[44:47], s37 offen offset:1024 lds
    v_cvt_pk_bf16_f32 v22, v140, v141
    v_cvt_pk_bf16_f32 v23, v142, v143
    v_mfma_f32_16x16x32_bf16 v[204:207], a[28:31], v[88:91], v[204:207]
    v_mfma_f32_16x16x32_bf16 v[208:211], a[16:19], v[92:95], v[208:211]
    v_cvt_pk_bf16_f32 v24, v144, v145
    v_cvt_pk_bf16_f32 v25, v146, v147
    s_add_u32 s38, s36, 40960
    buffer_store_dwordx4 v[52:55], v240, s[16:19], s38 offen offset:3328 sc1
    v_mfma_f32_16x16x32_bf16 v[212:215], a[20:23], v[92:95], v[212:215]
    s_add_u32 m0, s31, 3072
    s_add_u32 s24, s27, 98304
    buffer_load_dwordx4 v237, s[12:15], s24 offen lds
    v_mfma_f32_16x16x32_bf16 v[216:219], a[24:27], v[92:95], v[216:219]
    v_cvt_pk_bf16_f32 v26, v148, v149
    v_cvt_pk_bf16_f32 v27, v150, v151
    v_mfma_f32_16x16x32_bf16 v[220:223], a[28:31], v[92:95], v[220:223]
    s_waitcnt lgkmcnt(0)
    v_mfma_f32_16x16x32_bf16 v[160:163], a[32:35], v[64:67], v[160:163]
    ds_read_b128 v[80:83], v225 offset:8192
    v_cvt_pk_bf16_f32 v28, v152, v153
    v_cvt_pk_bf16_f32 v29, v154, v155
    v_mfma_f32_16x16x32_bf16 v[164:167], a[36:39], v[64:67], v[164:167]
    ds_read_b128 v[84:87], v225 offset:10240
    v_mfma_f32_16x16x32_bf16 v[168:171], a[40:43], v[64:67], v[168:171]
    ds_read_b128 v[88:91], v225 offset:12288
    v_cvt_pk_bf16_f32 v30, v156, v157
    v_cvt_pk_bf16_f32 v31, v158, v159
    v_mfma_f32_16x16x32_bf16 v[172:175], a[44:47], v[64:67], v[172:175]
    ds_read_b128 v[92:95], v225 offset:14336
    v_mfma_f32_16x16x32_bf16 v[176:179], a[32:35], v[68:71], v[176:179]
    v_mfma_f32_16x16x32_bf16 v[180:183], a[36:39], v[68:71], v[180:183]
    v_mfma_f32_16x16x32_bf16 v[184:187], a[40:43], v[68:71], v[184:187]
    v_mfma_f32_16x16x32_bf16 v[188:191], a[44:47], v[68:71], v[188:191]
    v_mfma_f32_16x16x32_bf16 v[192:195], a[32:35], v[72:75], v[192:195]
    s_add_u32 m0, s31, 4096
    s_add_u32 s24, s27, 131072
    buffer_load_dwordx4 v245, s[12:15], s24 offen lds
    v_mfma_f32_16x16x32_bf16 v[196:199], a[36:39], v[72:75], v[196:199]
    v_mfma_f32_16x16x32_bf16 v[200:203], a[40:43], v[72:75], v[200:203]
    v_mfma_f32_16x16x32_bf16 v[204:207], a[44:47], v[72:75], v[204:207]
    v_mfma_f32_16x16x32_bf16 v[208:211], a[32:35], v[76:79], v[208:211]
    v_mfma_f32_16x16x32_bf16 v[212:215], a[36:39], v[76:79], v[212:215]
    v_mfma_f32_16x16x32_bf16 v[216:219], a[40:43], v[76:79], v[216:219]
    v_mfma_f32_16x16x32_bf16 v[220:223], a[44:47], v[76:79], v[220:223]
    s_waitcnt vmcnt(23) lgkmcnt(0)
    s_barrier
    v_mfma_f32_16x16x32_bf16 v[160:163], a[48:51], v[80:83], v[160:163]
    ds_read_b128 v[64:67], v224 offset:16384
    v_mfma_f32_16x16x32_bf16 v[164:167], a[52:55], v[80:83], v[164:167]
    ds_read_b128 v[68:71], v224 offset:18432
    s_add_u32 s38, s36, 40960
    buffer_store_dwordx4 v[56:59], v240, s[16:19], s38 offen offset:2304 sc1
    v_mfma_f32_16x16x32_bf16 v[168:171], a[56:59], v[80:83], v[168:171]
    ds_read_b128 v[72:75], v224 offset:20480
    v_mfma_f32_16x16x32_bf16 v[172:175], a[60:63], v[80:83], v[172:175]
    ds_read_b128 v[76:79], v224 offset:22528
    v_mfma_f32_16x16x32_bf16 v[176:179], a[48:51], v[84:87], v[176:179]
    v_mfma_f32_16x16x32_bf16 v[180:183], a[52:55], v[84:87], v[180:183]
    v_mfma_f32_16x16x32_bf16 v[184:187], a[56:59], v[84:87], v[184:187]
    v_mfma_f32_16x16x32_bf16 v[188:191], a[60:63], v[84:87], v[188:191]
    v_mfma_f32_16x16x32_bf16 v[192:195], a[48:51], v[88:91], v[192:195]
    s_add_u32 m0, s31, 5120
    s_add_u32 s24, s27, 163840
    buffer_load_dwordx4 v245, s[12:15], s24 offen lds
    v_mfma_f32_16x16x32_bf16 v[196:199], a[52:55], v[88:91], v[196:199]
    v_mfma_f32_16x16x32_bf16 v[200:203], a[56:59], v[88:91], v[200:203]
    v_mfma_f32_16x16x32_bf16 v[204:207], a[60:63], v[88:91], v[204:207]
    v_mfma_f32_16x16x32_bf16 v[208:211], a[48:51], v[92:95], v[208:211]
    v_mfma_f32_16x16x32_bf16 v[212:215], a[52:55], v[92:95], v[212:215]
    v_mfma_f32_16x16x32_bf16 v[216:219], a[56:59], v[92:95], v[216:219]
    v_mfma_f32_16x16x32_bf16 v[220:223], a[60:63], v[92:95], v[220:223]
    s_waitcnt lgkmcnt(0)
    v_mfma_f32_16x16x32_bf16 v[160:163], a[64:67], v[64:67], v[160:163]
    ds_read_b128 v[80:83], v225 offset:16384
    v_mfma_f32_16x16x32_bf16 v[164:167], a[68:71], v[64:67], v[164:167]
    ds_read_b128 v[84:87], v225 offset:18432
    v_mfma_f32_16x16x32_bf16 v[168:171], a[72:75], v[64:67], v[168:171]
    ds_read_b128 v[88:91], v225 offset:20480
    v_mfma_f32_16x16x32_bf16 v[172:175], a[76:79], v[64:67], v[172:175]
    ds_read_b128 v[92:95], v225 offset:22528
    v_mfma_f32_16x16x32_bf16 v[176:179], a[64:67], v[68:71], v[176:179]
    v_mfma_f32_16x16x32_bf16 v[180:183], a[68:71], v[68:71], v[180:183]
    v_mfma_f32_16x16x32_bf16 v[184:187], a[72:75], v[68:71], v[184:187]
    v_mfma_f32_16x16x32_bf16 v[188:191], a[76:79], v[68:71], v[188:191]
    s_add_u32 s38, s36, 45056
    buffer_store_dwordx4 v[60:63], v240, s[16:19], s38 offen offset:256 sc1
    v_mfma_f32_16x16x32_bf16 v[192:195], a[64:67], v[72:75], v[192:195]
    s_add_u32 m0, s31, 6144
    s_add_u32 s24, s27, 196608
    buffer_load_dwordx4 v237, s[12:15], s24 offen lds
    v_mfma_f32_16x16x32_bf16 v[196:199], a[68:71], v[72:75], v[196:199]
    v_mfma_f32_16x16x32_bf16 v[200:203], a[72:75], v[72:75], v[200:203]
    v_mfma_f32_16x16x32_bf16 v[204:207], a[76:79], v[72:75], v[204:207]
    v_mfma_f32_16x16x32_bf16 v[208:211], a[64:67], v[76:79], v[208:211]
    v_mfma_f32_16x16x32_bf16 v[212:215], a[68:71], v[76:79], v[212:215]
    v_mfma_f32_16x16x32_bf16 v[216:219], a[72:75], v[76:79], v[216:219]
    v_mfma_f32_16x16x32_bf16 v[220:223], a[76:79], v[76:79], v[220:223]
    s_waitcnt lgkmcnt(0)
    v_mfma_f32_16x16x32_bf16 v[160:163], a[80:83], v[80:83], v[160:163]
    ds_read_b128 v[64:67], v224 offset:24576
    v_mfma_f32_16x16x32_bf16 v[164:167], a[84:87], v[80:83], v[164:167]
    ds_read_b128 v[68:71], v224 offset:26624
    v_mfma_f32_16x16x32_bf16 v[168:171], a[88:91], v[80:83], v[168:171]
    ds_read_b128 v[72:75], v224 offset:28672
    v_mfma_f32_16x16x32_bf16 v[172:175], a[92:95], v[80:83], v[172:175]
    ds_read_b128 v[76:79], v224 offset:30720
    v_mfma_f32_16x16x32_bf16 v[176:179], a[80:83], v[84:87], v[176:179]
    v_mfma_f32_16x16x32_bf16 v[180:183], a[84:87], v[84:87], v[180:183]
    v_mfma_f32_16x16x32_bf16 v[184:187], a[88:91], v[84:87], v[184:187]
    v_mfma_f32_16x16x32_bf16 v[188:191], a[92:95], v[84:87], v[188:191]
    v_mfma_f32_16x16x32_bf16 v[192:195], a[80:83], v[88:91], v[192:195]
    s_add_u32 m0, s31, 7168
    s_add_u32 s24, s27, 229376
    buffer_load_dwordx4 v237, s[12:15], s24 offen lds
    v_mfma_f32_16x16x32_bf16 v[196:199], a[84:87], v[88:91], v[196:199]
    v_mfma_f32_16x16x32_bf16 v[200:203], a[88:91], v[88:91], v[200:203]
    s_add_u32 s27, s27, 1048576
    s_and_b32 s27, s27, 0x407fffff
    s_cmp_eq_u32 s27, s7
    s_cselect_b32 s27, s43, s27
    v_mfma_f32_16x16x32_bf16 v[204:207], a[92:95], v[88:91], v[204:207]
    v_mfma_f32_16x16x32_bf16 v[208:211], a[80:83], v[92:95], v[208:211]
    v_mfma_f32_16x16x32_bf16 v[212:215], a[84:87], v[92:95], v[212:215]
    s_add_u32 s31, s31, 32768
    s_cmp_ge_u32 s31, 163840
    s_cselect_b32 s24, 98304, 0
    s_sub_u32 s31, s31, s24
    s_add_u32 s38, s36, 65536
    buffer_store_dwordx4 v[0:3], v240, s[16:19], s38 offen offset:2560 sc1
    v_mfma_f32_16x16x32_bf16 v[216:219], a[88:91], v[92:95], v[216:219]
    v_mfma_f32_16x16x32_bf16 v[220:223], a[92:95], v[92:95], v[220:223]
    s_waitcnt lgkmcnt(0)
    v_mfma_f32_16x16x32_bf16 v[160:163], a[96:99], v[64:67], v[160:163]
    ds_read_b128 v[80:83], v225 offset:24576
    v_mfma_f32_16x16x32_bf16 v[164:167], a[100:103], v[64:67], v[164:167]
    ds_read_b128 v[84:87], v225 offset:26624
    v_mfma_f32_16x16x32_bf16 v[168:171], a[104:107], v[64:67], v[168:171]
    ds_read_b128 v[88:91], v225 offset:28672
    v_mfma_f32_16x16x32_bf16 v[172:175], a[108:111], v[64:67], v[172:175]
    ds_read_b128 v[92:95], v225 offset:30720
    v_mfma_f32_16x16x32_bf16 v[176:179], a[96:99], v[68:71], v[176:179]
    v_mfma_f32_16x16x32_bf16 v[180:183], a[100:103], v[68:71], v[180:183]
    v_mfma_f32_16x16x32_bf16 v[184:187], a[104:107], v[68:71], v[184:187]
    v_mfma_f32_16x16x32_bf16 v[188:191], a[108:111], v[68:71], v[188:191]
    v_mfma_f32_16x16x32_bf16 v[192:195], a[96:99], v[72:75], v[192:195]
    v_mfma_f32_16x16x32_bf16 v[196:199], a[100:103], v[72:75], v[196:199]
    v_mfma_f32_16x16x32_bf16 v[200:203], a[104:107], v[72:75], v[200:203]
    v_mfma_f32_16x16x32_bf16 v[204:207], a[108:111], v[72:75], v[204:207]
    v_mfma_f32_16x16x32_bf16 v[208:211], a[96:99], v[76:79], v[208:211]
    v_mfma_f32_16x16x32_bf16 v[212:215], a[100:103], v[76:79], v[212:215]
    v_mfma_f32_16x16x32_bf16 v[216:219], a[104:107], v[76:79], v[216:219]
    v_mfma_f32_16x16x32_bf16 v[220:223], a[108:111], v[76:79], v[220:223]
    s_waitcnt vmcnt(9) lgkmcnt(0)
    s_barrier
    v_mfma_f32_16x16x32_bf16 v[160:163], a[112:115], v[80:83], v[160:163]
    ds_read_b128 v[64:67], v224 offset:32768
    v_mfma_f32_16x16x32_bf16 v[164:167], a[116:119], v[80:83], v[164:167]
    ds_read_b128 v[68:71], v224 offset:34816
    v_mfma_f32_16x16x32_bf16 v[168:171], a[120:123], v[80:83], v[168:171]
    ds_read_b128 v[72:75], v224 offset:36864
    s_add_u32 s38, s36, 69632
    buffer_store_dwordx4 v[4:7], v240, s[16:19], s38 offen offset:512 sc1
    v_mfma_f32_16x16x32_bf16 v[172:175], a[124:127], v[80:83], v[172:175]
    ds_read_b128 v[76:79], v224 offset:38912
    v_mfma_f32_16x16x32_bf16 v[176:179], a[112:115], v[84:87], v[176:179]
    v_mfma_f32_16x16x32_bf16 v[180:183], a[116:119], v[84:87], v[180:183]
    v_mfma_f32_16x16x32_bf16 v[184:187], a[120:123], v[84:87], v[184:187]
    v_mfma_f32_16x16x32_bf16 v[188:191], a[124:127], v[84:87], v[188:191]
    v_mfma_f32_16x16x32_bf16 v[192:195], a[112:115], v[88:91], v[192:195]
    v_mfma_f32_16x16x32_bf16 v[196:199], a[116:119], v[88:91], v[196:199]
    v_mfma_f32_16x16x32_bf16 v[200:203], a[120:123], v[88:91], v[200:203]
    v_mfma_f32_16x16x32_bf16 v[204:207], a[124:127], v[88:91], v[204:207]
    v_mfma_f32_16x16x32_bf16 v[208:211], a[112:115], v[92:95], v[208:211]
    v_mfma_f32_16x16x32_bf16 v[212:215], a[116:119], v[92:95], v[212:215]
    v_mfma_f32_16x16x32_bf16 v[216:219], a[120:123], v[92:95], v[216:219]
    v_mfma_f32_16x16x32_bf16 v[220:223], a[124:127], v[92:95], v[220:223]
    s_waitcnt lgkmcnt(0)
    v_mfma_f32_16x16x32_bf16 v[160:163], a[128:131], v[64:67], v[160:163]
    ds_read_b128 v[80:83], v225 offset:32768
    v_mfma_f32_16x16x32_bf16 v[164:167], a[132:135], v[64:67], v[164:167]
    ds_read_b128 v[84:87], v225 offset:34816
    v_mfma_f32_16x16x32_bf16 v[168:171], a[136:139], v[64:67], v[168:171]
    ds_read_b128 v[88:91], v225 offset:36864
    v_mfma_f32_16x16x32_bf16 v[172:175], a[140:143], v[64:67], v[172:175]
    ds_read_b128 v[92:95], v225 offset:38912
    v_mfma_f32_16x16x32_bf16 v[176:179], a[128:131], v[68:71], v[176:179]
    v_mfma_f32_16x16x32_bf16 v[180:183], a[132:135], v[68:71], v[180:183]
    v_mfma_f32_16x16x32_bf16 v[184:187], a[136:139], v[68:71], v[184:187]
    v_mfma_f32_16x16x32_bf16 v[188:191], a[140:143], v[68:71], v[188:191]
    v_mfma_f32_16x16x32_bf16 v[192:195], a[128:131], v[72:75], v[192:195]
    buffer_load_dword v254, off, s[88:91], s39 sc1
    s_add_u32 s38, s36, 65536
    buffer_store_dwordx4 v[8:11], v240, s[16:19], s38 offen offset:3584 sc1
    v_mfma_f32_16x16x32_bf16 v[196:199], a[132:135], v[72:75], v[196:199]
    v_mfma_f32_16x16x32_bf16 v[200:203], a[136:139], v[72:75], v[200:203]
    v_mfma_f32_16x16x32_bf16 v[204:207], a[140:143], v[72:75], v[204:207]
    v_mfma_f32_16x16x32_bf16 v[208:211], a[128:131], v[76:79], v[208:211]
    v_mfma_f32_16x16x32_bf16 v[212:215], a[132:135], v[76:79], v[212:215]
    v_mfma_f32_16x16x32_bf16 v[216:219], a[136:139], v[76:79], v[216:219]
    v_mfma_f32_16x16x32_bf16 v[220:223], a[140:143], v[76:79], v[220:223]
    s_waitcnt lgkmcnt(0)
    v_mfma_f32_16x16x32_bf16 v[160:163], a[144:147], v[80:83], v[160:163]
    ds_read_b128 v[64:67], v224 offset:40960
    v_mfma_f32_16x16x32_bf16 v[164:167], a[148:151], v[80:83], v[164:167]
    ds_read_b128 v[68:71], v224 offset:43008
    v_mfma_f32_16x16x32_bf16 v[168:171], a[152:155], v[80:83], v[168:171]
    ds_read_b128 v[72:75], v224 offset:45056
    v_mfma_f32_16x16x32_bf16 v[172:175], a[156:159], v[80:83], v[172:175]
    ds_read_b128 v[76:79], v224 offset:47104
    v_mfma_f32_16x16x32_bf16 v[176:179], a[144:147], v[84:87], v[176:179]
    v_mfma_f32_16x16x32_bf16 v[180:183], a[148:151], v[84:87], v[180:183]
    v_mfma_f32_16x16x32_bf16 v[184:187], a[152:155], v[84:87], v[184:187]
    v_mfma_f32_16x16x32_bf16 v[188:191], a[156:159], v[84:87], v[188:191]
    v_mfma_f32_16x16x32_bf16 v[192:195], a[144:147], v[88:91], v[192:195]
    v_mfma_f32_16x16x32_bf16 v[196:199], a[148:151], v[88:91], v[196:199]
    v_mfma_f32_16x16x32_bf16 v[200:203], a[152:155], v[88:91], v[200:203]
    v_mfma_f32_16x16x32_bf16 v[204:207], a[156:159], v[88:91], v[204:207]
    v_mfma_f32_16x16x32_bf16 v[208:211], a[144:147], v[92:95], v[208:211]
    v_mfma_f32_16x16x32_bf16 v[212:215], a[148:151], v[92:95], v[212:215]
    s_add_u32 s38, s36, 69632
    buffer_store_dwordx4 v[12:15], v240, s[16:19], s38 offen offset:1536 sc1
    v_mfma_f32_16x16x32_bf16 v[216:219], a[152:155], v[92:95], v[216:219]
    v_mfma_f32_16x16x32_bf16 v[220:223], a[156:159], v[92:95], v[220:223]
    s_waitcnt lgkmcnt(0)
    v_mfma_f32_16x16x32_bf16 v[160:163], a[160:163], v[64:67], v[160:163]
    ds_read_b128 v[80:83], v225 offset:40960
    v_mfma_f32_16x16x32_bf16 v[164:167], a[164:167], v[64:67], v[164:167]
    ds_read_b128 v[84:87], v225 offset:43008
    v_mfma_f32_16x16x32_bf16 v[168:171], a[168:171], v[64:67], v[168:171]
    ds_read_b128 v[88:91], v225 offset:45056
    v_mfma_f32_16x16x32_bf16 v[172:175], a[172:175], v[64:67], v[172:175]
    ds_read_b128 v[92:95], v225 offset:47104
    v_mfma_f32_16x16x32_bf16 v[176:179], a[160:163], v[68:71], v[176:179]
    v_mfma_f32_16x16x32_bf16 v[180:183], a[164:167], v[68:71], v[180:183]
    v_mfma_f32_16x16x32_bf16 v[184:187], a[168:171], v[68:71], v[184:187]
    v_mfma_f32_16x16x32_bf16 v[188:191], a[172:175], v[68:71], v[188:191]
    v_mfma_f32_16x16x32_bf16 v[192:195], a[160:163], v[72:75], v[192:195]
    v_mfma_f32_16x16x32_bf16 v[196:199], a[164:167], v[72:75], v[196:199]
    v_mfma_f32_16x16x32_bf16 v[200:203], a[168:171], v[72:75], v[200:203]
    v_mfma_f32_16x16x32_bf16 v[204:207], a[172:175], v[72:75], v[204:207]
    v_mfma_f32_16x16x32_bf16 v[208:211], a[160:163], v[76:79], v[208:211]
    v_mfma_f32_16x16x32_bf16 v[212:215], a[164:167], v[76:79], v[212:215]
    v_mfma_f32_16x16x32_bf16 v[216:219], a[168:171], v[76:79], v[216:219]
    v_mfma_f32_16x16x32_bf16 v[220:223], a[172:175], v[76:79], v[220:223]
    s_waitcnt lgkmcnt(0)
    v_mfma_f32_16x16x32_bf16 v[160:163], a[176:179], v[80:83], v[160:163]
    ds_read_b128 v[64:67], v224 offset:49152
    v_mfma_f32_16x16x32_bf16 v[164:167], a[180:183], v[80:83], v[164:167]
    ds_read_b128 v[68:71], v224 offset:51200
    v_mfma_f32_16x16x32_bf16 v[168:171], a[184:187], v[80:83], v[168:171]
    ds_read_b128 v[72:75], v224 offset:53248
    v_mfma_f32_16x16x32_bf16 v[172:175], a[188:191], v[80:83], v[172:175]
    ds_read_b128 v[76:79], v224 offset:55296
    s_add_u32 s38, s36, 73728
    buffer_store_dwordx4 v[16:19], v240, s[16:19], s38 offen offset:2560 sc1
    v_mfma_f32_16x16x32_bf16 v[176:179], a[176:179], v[84:87], v[176:179]
    v_mfma_f32_16x16x32_bf16 v[180:183], a[180:183], v[84:87], v[180:183]
    v_mfma_f32_16x16x32_bf16 v[184:187], a[184:187], v[84:87], v[184:187]
    v_mfma_f32_16x16x32_bf16 v[188:191], a[188:191], v[84:87], v[188:191]
    v_mfma_f32_16x16x32_bf16 v[192:195], a[176:179], v[88:91], v[192:195]
    v_mfma_f32_16x16x32_bf16 v[196:199], a[180:183], v[88:91], v[196:199]
    v_mfma_f32_16x16x32_bf16 v[200:203], a[184:187], v[88:91], v[200:203]
    v_mfma_f32_16x16x32_bf16 v[204:207], a[188:191], v[88:91], v[204:207]
    v_mfma_f32_16x16x32_bf16 v[208:211], a[176:179], v[92:95], v[208:211]
    v_mfma_f32_16x16x32_bf16 v[212:215], a[180:183], v[92:95], v[212:215]
    v_mfma_f32_16x16x32_bf16 v[216:219], a[184:187], v[92:95], v[216:219]
    v_mfma_f32_16x16x32_bf16 v[220:223], a[188:191], v[92:95], v[220:223]
    s_waitcnt vmcnt(3)
    v_readfirstlane_b32 s24, v254
    s_lshl_b32 s25, s3, 16
    s_add_u32 s24, s24, s25
    s_cmp_ge_u32 s24, 32
    s_cbranch_scc0 kf_spin33
kf_spinr34:
    s_waitcnt lgkmcnt(0)
    s_barrier
    v_mfma_f32_16x16x32_bf16 v[160:163], a[192:195], v[64:67], v[160:163]
    ds_read_b128 v[80:83], v225 offset:49152
    v_mfma_f32_16x16x32_bf16 v[164:167], a[196:199], v[64:67], v[164:167]
    ds_read_b128 v[84:87], v225 offset:51200
    v_mfma_f32_16x16x32_bf16 v[168:171], a[200:203], v[64:67], v[168:171]
    ds_read_b128 v[88:91], v225 offset:53248
    v_mfma_f32_16x16x32_bf16 v[172:175], a[204:207], v[64:67], v[172:175]
    ds_read_b128 v[92:95], v225 offset:55296
    v_mfma_f32_16x16x32_bf16 v[176:179], a[192:195], v[68:71], v[176:179]
    v_mfma_f32_16x16x32_bf16 v[180:183], a[196:199], v[68:71], v[180:183]
    v_mfma_f32_16x16x32_bf16 v[184:187], a[200:203], v[68:71], v[184:187]
    v_mfma_f32_16x16x32_bf16 v[188:191], a[204:207], v[68:71], v[188:191]
    v_mfma_f32_16x16x32_bf16 v[192:195], a[192:195], v[72:75], v[192:195]
    buffer_load_dwordx4 a[128:131], v248, s[8:11], s28 offen offset:0 sc1
    s_add_u32 s38, s36, 77824
    buffer_store_dwordx4 v[20:23], v240, s[16:19], s38 offen offset:512 sc1
    v_mfma_f32_16x16x32_bf16 v[196:199], a[196:199], v[72:75], v[196:199]
    v_mfma_f32_16x16x32_bf16 v[200:203], a[200:203], v[72:75], v[200:203]
    buffer_load_dwordx4 a[132:135], v248, s[8:11], s29 offen offset:0 sc1
    v_mfma_f32_16x16x32_bf16 v[204:207], a[204:207], v[72:75], v[204:207]
    v_mfma_f32_16x16x32_bf16 v[208:211], a[192:195], v[76:79], v[208:211]
    v_mfma_f32_16x16x32_bf16 v[212:215], a[196:199], v[76:79], v[212:215]
    buffer_load_dwordx4 a[136:139], v249, s[8:11], s28 offen offset:0 sc1
    v_mfma_f32_16x16x32_bf16 v[216:219], a[200:203], v[76:79], v[216:219]
    v_mfma_f32_16x16x32_bf16 v[220:223], a[204:207], v[76:79], v[220:223]
    s_waitcnt lgkmcnt(0)
    v_mfma_f32_16x16x32_bf16 v[160:163], a[208:211], v[80:83], v[160:163]
    ds_read_b128 v[64:67], v224 offset:57344
    v_mfma_f32_16x16x32_bf16 v[164:167], a[212:215], v[80:83], v[164:167]
    ds_read_b128 v[68:71], v224 offset:59392
    v_mfma_f32_16x16x32_bf16 v[168:171], a[216:219], v[80:83], v[168:171]
    ds_read_b128 v[72:75], v224 offset:61440
    v_mfma_f32_16x16x32_bf16 v[172:175], a[220:223], v[80:83], v[172:175]
    ds_read_b128 v[76:79], v224 offset:63488
    v_mfma_f32_16x16x32_bf16 v[176:179], a[208:211], v[84:87], v[176:179]
    v_mfma_f32_16x16x32_bf16 v[180:183], a[212:215], v[84:87], v[180:183]
    v_mfma_f32_16x16x32_bf16 v[184:187], a[216:219], v[84:87], v[184:187]
    v_mfma_f32_16x16x32_bf16 v[188:191], a[220:223], v[84:87], v[188:191]
    v_mfma_f32_16x16x32_bf16 v[192:195], a[208:211], v[88:91], v[192:195]
    buffer_load_dwordx4 a[140:143], v249, s[8:11], s29 offen offset:0 sc1
    v_mfma_f32_16x16x32_bf16 v[196:199], a[212:215], v[88:91], v[196:199]
    v_mfma_f32_16x16x32_bf16 v[200:203], a[216:219], v[88:91], v[200:203]
    buffer_load_dwordx4 a[144:147], v248, s[8:11], s28 offen offset:1024 sc1
    v_mfma_f32_16x16x32_bf16 v[204:207], a[220:223], v[88:91], v[204:207]
    v_mfma_f32_16x16x32_bf16 v[208:211], a[208:211], v[92:95], v[208:211]
    v_mfma_f32_16x16x32_bf16 v[212:215], a[212:215], v[92:95], v[212:215]
    buffer_load_dwordx4 a[148:151], v248, s[8:11], s29 offen offset:1024 sc1
    v_mfma_f32_16x16x32_bf16 v[216:219], a[216:219], v[92:95], v[216:219]
    s_add_u32 s38, s36, 73728
    buffer_store_dwordx4 v[24:27], v240, s[16:19], s38 offen offset:3584 sc1
    v_mfma_f32_16x16x32_bf16 v[220:223], a[220:223], v[92:95], v[220:223]
    s_waitcnt lgkmcnt(0)
    v_mfma_f32_16x16x32_bf16 v[160:163], a[224:227], v[64:67], v[160:163]
    ds_read_b128 v[80:83], v225 offset:57344
    v_mfma_f32_16x16x32_bf16 v[164:167], a[228:231], v[64:67], v[164:167]
    ds_read_b128 v[84:87], v225 offset:59392
    v_mfma_f32_16x16x32_bf16 v[168:171], a[232:235], v[64:67], v[168:171]
    ds_read_b128 v[88:91], v225 offset:61440
    v_mfma_f32_16x16x32_bf16 v[172:175], a[236:239], v[64:67], v[172:175]
    ds_read_b128 v[92:95], v225 offset:63488
    v_mfma_f32_16x16x32_bf16 v[176:179], a[224:227], v[68:71], v[176:179]
    v_mfma_f32_16x16x32_bf16 v[180:183], a[228:231], v[68:71], v[180:183]
    v_mfma_f32_16x16x32_bf16 v[184:187], a[232:235], v[68:71], v[184:187]
    v_mfma_f32_16x16x32_bf16 v[188:191], a[236:239], v[68:71], v[188:191]
    v_mfma_f32_16x16x32_bf16 v[192:195], a[224:227], v[72:75], v[192:195]
    buffer_load_dwordx4 a[152:155], v249, s[8:11], s28 offen offset:1024 sc1
    v_mfma_f32_16x16x32_bf16 v[196:199], a[228:231], v[72:75], v[196:199]
    v_mfma_f32_16x16x32_bf16 v[200:203], a[232:235], v[72:75], v[200:203]
    buffer_load_dwordx4 a[156:159], v249, s[8:11], s29 offen offset:1024 sc1
    v_mfma_f32_16x16x32_bf16 v[204:207], a[236:239], v[72:75], v[204:207]
    v_mfma_f32_16x16x32_bf16 v[208:211], a[224:227], v[76:79], v[208:211]
    v_mfma_f32_16x16x32_bf16 v[212:215], a[228:231], v[76:79], v[212:215]
    buffer_load_dwordx4 a[160:163], v248, s[8:11], s28 offen offset:2048 sc1
    v_mfma_f32_16x16x32_bf16 v[216:219], a[232:235], v[76:79], v[216:219]
    v_mfma_f32_16x16x32_bf16 v[220:223], a[236:239], v[76:79], v[220:223]
    s_waitcnt vmcnt(38) lgkmcnt(0)
    s_barrier
    v_mfma_f32_16x16x32_bf16 v[160:163], a[240:243], v[80:83], v[160:163]
    ds_read_b64_tr_b16 a[192:193], v246 offset:0
    v_mfma_f32_16x16x32_bf16 v[164:167], a[244:247], v[80:83], v[164:167]
    ds_read_b64_tr_b16 a[194:195], v246 offset:1024
    v_mfma_f32_16x16x32_bf16 v[168:171], a[248:251], v[80:83], v[168:171]
    ds_read_b64_tr_b16 a[196:197], v238 offset:0
    v_mfma_f32_16x16x32_bf16 v[172:175], a[252:255], v[80:83], v[172:175]
    ds_read_b64_tr_b16 a[198:199], v238 offset:1024
    v_mfma_f32_16x16x32_bf16 v[176:179], a[240:243], v[84:87], v[176:179]
    ds_read_b64_tr_b16 a[200:201], v246 offset:256
    s_add_u32 s38, s36, 77824
    buffer_store_dwordx4 v[28:31], v240, s[16:19], s38 offen offset:1536 sc1
    v_mfma_f32_16x16x32_bf16 v[180:183], a[244:247], v[84:87], v[180:183]
    ds_read_b64_tr_b16 a[202:203], v246 offset:1280
    v_mfma_f32_16x16x32_bf16 v[184:187], a[248:251], v[84:87], v[184:187]
    ds_read_b64_tr_b16 a[204:205], v238 offset:256
    v_mfma_f32_16x16x32_bf16 v[188:191], a[252:255], v[84:87], v[188:191]
    ds_read_b64_tr_b16 a[206:207], v238 offset:1280
    v_mfma_f32_16x16x32_bf16 v[192:195], a[240:243], v[88:91], v[192:195]
    buffer_load_dwordx4 a[164:167], v248, s[8:11], s29 offen offset:2048 sc1
    v_mfma_f32_16x16x32_bf16 v[196:199], a[244:247], v[88:91], v[196:199]
    v_cvt_pk_bf16_f32 v32, v160, v161
    v_cvt_pk_bf16_f32 v33, v162, v163
    v_mfma_f32_16x16x32_bf16 v[200:203], a[248:251], v[88:91], v[200:203]
    buffer_load_dwordx4 a[168:171], v249, s[8:11], s28 offen offset:2048 sc1
    v_cvt_pk_bf16_f32 v34, v164, v165
    v_cvt_pk_bf16_f32 v35, v166, v167
    v_mfma_f32_16x16x32_bf16 v[204:207], a[252:255], v[88:91], v[204:207]
    v_cvt_pk_bf16_f32 v36, v168, v169
    v_cvt_pk_bf16_f32 v37, v170, v171
    v_mfma_f32_16x16x32_bf16 v[208:211], a[240:243], v[92:95], v[208:211]
    v_cvt_pk_bf16_f32 v38, v172, v173
    v_cvt_pk_bf16_f32 v39, v174, v175
    v_mfma_f32_16x16x32_bf16 v[212:215], a[244:247], v[92:95], v[212:215]
    buffer_load_dwordx4 a[172:175], v249, s[8:11], s29 offen offset:2048 sc1
    v_cvt_pk_bf16_f32 v40, v176, v177
    v_cvt_pk_bf16_f32 v41, v178, v179
    v_mfma_f32_16x16x32_bf16 v[216:219], a[248:251], v[92:95], v[216:219]
    v_cvt_pk_bf16_f32 v42, v180, v181
    v_cvt_pk_bf16_f32 v43, v182, v183
    v_mfma_f32_16x16x32_bf16 v[220:223], a[252:255], v[92:95], v[220:223]
    v_cvt_pk_bf16_f32 v44, v184, v185
    v_cvt_pk_bf16_f32 v45, v186, v187
    s_nop 3
    v_cvt_pk_bf16_f32 v46, v188, v189
    v_cvt_pk_bf16_f32 v47, v190, v191
    v_cvt_pk_bf16_f32 v48, v192, v193
    v_cvt_pk_bf16_f32 v49, v194, v195
    v_cvt_pk_bf16_f32 v50, v196, v197
    v_cvt_pk_bf16_f32 v51, v198, v199
    v_cvt_pk_bf16_f32 v52, v200, v201
    v_cvt_pk_bf16_f32 v53, v202, v203
    v_cvt_pk_bf16_f32 v54, v204, v205
    v_cvt_pk_bf16_f32 v55, v206, v207
    v_cvt_pk_bf16_f32 v56, v208, v209
    v_cvt_pk_bf16_f32 v57, v210, v211
    v_cvt_pk_bf16_f32 v58, v212, v213
    v_cvt_pk_bf16_f32 v59, v214, v215
    v_cvt_pk_bf16_f32 v60, v216, v217
    v_cvt_pk_bf16_f32 v61, v218, v219
    v_cvt_pk_bf16_f32 v62, v220, v221
    v_cvt_pk_bf16_f32 v63, v222, v223
    s_add_u32 s80, s36, 102144
    s_add_u32 s81, s36, 104192
    s_add_u32 s82, s36, 103168
    s_add_u32 s83, s36, 105216
    s_add_u32 s84, s36, 110336
    s_add_u32 s85, s36, 112384
    s_add_u32 s86, s36, 111360
    s_add_u32 s87, s36, 113408
    s_branch ka_Q
ka_V:
    s_waitcnt lgkmcnt(0)
    v_mfma_f32_16x16x32_bf16 v[96:99], v[64:67], a[0:3], 0
    ds_read_b128 v[80:83], v224 offset:8192
    v_mfma_f32_16x16x32_bf16 v[100:103], v[68:71], a[0:3], 0
    ds_read_b128 v[84:87], v224 offset:10240
    v_mfma_f32_16x16x32_bf16 v[104:107], v[64:67], a[4:7], 0
    ds_read_b128 v[88:91], v224 offset:12288
    v_mfma_f32_16x16x32_bf16 v[108:111], v[68:71], a[4:7], 0
    ds_read_b128 v[92:95], v224 offset:14336
    v_mfma_f32_16x16x32_bf16 v[112:115], v[64:67], a[8:11], 0
    ds_read_b64_tr_b16 a[16:17], v228 offset:4096
    v_mfma_f32_16x16x32_bf16 v[116:119], v[68:71], a[8:11], 0
    ds_read_b64_tr_b16 a[18:19], v228 offset:4608
    v_mfma_f32_16x16x32_bf16 v[120:123], v[64:67], a[12:15], 0
    ds_read_b64_tr_b16 a[20:21], v229 offset:4096
    v_mfma_f32_16x16x32_bf16 v[124:127], v[68:71], a[12:15], 0
    ds_read_b64_tr_b16 a[22:23], v229 offset:4608
    v_mfma_f32_16x16x32_bf16 v[128:131], v[72:75], a[0:3], 0
    s_add_u32 m0, s35, 16384
    s_and_b32 s33, s82, 1023
    s_lshl_b32 s33, s33, 12
    buffer_load_dwordx4 v234, s[48:51], s33 offen lds
    v_mfma_f32_16x16x32_bf16 v[132:135], v[76:79], a[0:3], 0
    buffer_load_dwordx4 v235, s[48:51], s33 offen offset:1024 lds
    v_mfma_f32_16x16x32_bf16 v[136:139], v[72:75], a[4:7], 0
    s_add_u32 m0, s35, 18432
    s_add_u32 s33, s33, 131072
    buffer_load_dwordx4 v234, s[48:51], s33 offen lds
    v_mfma_f32_16x16x32_bf16 v[140:143], v[76:79], a[4:7], 0
    v_mfma_f32_16x16x32_bf16 v[144:147], v[72:75], a[8:11], 0
    buffer_load_dwordx4 v235, s[48:51], s33 offen offset:1024 lds
    v_mfma_f32_16x16x32_bf16 v[148:151], v[76:79], a[8:11], 0
    buffer_load_dwordx4 v[0:3], v236, s[52:55], 0 offen offset:0
    v_mfma_f32_16x16x32_bf16 v[152:155], v[72:75], a[12:15], 0
    buffer_load_dwordx4 v[4:7], v236, s[52:55], 0 offen offset:512
    v_mfma_f32_16x16x32_bf16 v[156:159], v[76:79], a[12:15], 0
    s_waitcnt lgkmcnt(0)
    v_mfma_f32_16x16x32_bf16 v[160:163], v[80:83], a[0:3], 0
    ds_read_b128 v[64:67], v225 offset:0
    v_mfma_f32_16x16x32_bf16 v[164:167], v[84:87], a[0:3], 0
    ds_read_b128 v[68:71], v225 offset:2048
    v_mfma_f32_16x16x32_bf16 v[168:171], v[80:83], a[4:7], 0
    ds_read_b128 v[72:75], v225 offset:4096
    v_mfma_f32_16x16x32_bf16 v[172:175], v[84:87], a[4:7], 0
    ds_read_b128 v[76:79], v225 offset:6144
    v_mfma_f32_16x16x32_bf16 v[176:179], v[80:83], a[8:11], 0
    ds_read_b64_tr_b16 a[24:25], v230 offset:4096
    v_mfma_f32_16x16x32_bf16 v[180:183], v[84:87], a[8:11], 0
    ds_read_b64_tr_b16 a[26:27], v230 offset:4608
    v_mfma_f32_16x16x32_bf16 v[184:187], v[80:83], a[12:15], 0
    ds_read_b64_tr_b16 a[28:29], v231 offset:4096
    v_mfma_f32_16x16x32_bf16 v[188:191], v[84:87], a[12:15], 0
    ds_read_b64_tr_b16 a[30:31], v231 offset:4608
    v_mfma_f32_16x16x32_bf16 v[192:195], v[88:91], a[0:3], 0
    s_add_u32 m0, s35, 20480
    s_add_u32 s33, s33, 131072
    buffer_load_dwordx4 v234, s[48:51], s33 offen lds
    v_mfma_f32_16x16x32_bf16 v[196:199], v[92:95], a[0:3], 0
    buffer_load_dwordx4 v235, s[48:51], s33 offen offset:1024 lds
    v_mfma_f32_16x16x32_bf16 v[200:203], v[88:91], a[4:7], 0
    s_add_u32 m0, s35, 22528
    s_add_u32 s33, s33, 131072
    buffer_load_dwordx4 v234, s[48:51], s33 offen lds
    v_mfma_f32_16x16x32_bf16 v[204:207], v[92:95], a[4:7], 0
    v_mfma_f32_16x16x32_bf16 v[208:211], v[88:91], a[8:11], 0
    buffer_load_dwordx4 v235, s[48:51], s33 offen offset:1024 lds
    v_mfma_f32_16x16x32_bf16 v[212:215], v[92:95], a[8:11], 0
    buffer_load_dwordx4 v[8:11], v236, s[52:55], 0 offen offset:1024
    v_mfma_f32_16x16x32_bf16 v[216:219], v[88:91], a[12:15], 0
    buffer_load_dwordx4 v[12:15], v236, s[52:55], 0 offen offset:1536
    v_mfma_f32_16x16x32_bf16 v[220:223], v[92:95], a[12:15], 0
    s_waitcnt vmcnt(17) lgkmcnt(0)
    v_mfma_f32_16x16x32_bf16 v[96:99], v[64:67], a[16:19], v[96:99]
    ds_read_b128 v[80:83], v225 offset:8192
    v_mfma_f32_16x16x32_bf16 v[100:103], v[68:71], a[16:19], v[100:103]
    ds_read_b128 v[84:87], v225 offset:10240
    v_mfma_f32_16x16x32_bf16 v[104:107], v[64:67], a[20:23], v[104:107]
    ds_read_b128 v[88:91], v225 offset:12288
    v_mfma_f32_16x16x32_bf16 v[108:111], v[68:71], a[20:23], v[108:111]
    ds_read_b128 v[92:95], v225 offset:14336
    v_mfma_f32_16x16x32_bf16 v[112:115], v[64:67], a[24:27], v[112:115]
    ds_read_b64_tr_b16 a[32:33], v228 offset:8192
    v_mfma_f32_16x16x32_bf16 v[116:119], v[68:71], a[24:27], v[116:119]
    ds_read_b64_tr_b16 a[34:35], v228 offset:8704
    v_mfma_f32_16x16x32_bf16 v[120:123], v[64:67], a[28:31], v[120:123]
    ds_read_b64_tr_b16 a[36:37], v229 offset:8192
    v_mfma_f32_16x16x32_bf16 v[124:127], v[68:71], a[28:31], v[124:127]
    ds_read_b64_tr_b16 a[38:39], v229 offset:8704
    v_mfma_f32_16x16x32_bf16 v[128:131], v[72:75], a[16:19], v[128:131]
    s_add_u32 m0, s34, 32768
    s_add_u32 s37, s82, 0
    buffer_load_dwordx4 v232, s[44:47], s37 offen lds
    v_mfma_f32_16x16x32_bf16 v[132:135], v[76:79], a[16:19], v[132:135]
    buffer_load_dwordx4 v233, s[44:47], s37 offen offset:1024 lds
    v_mfma_f32_16x16x32_bf16 v[136:139], v[72:75], a[20:23], v[136:139]
    s_add_u32 m0, s34, 40960
    s_add_u32 s37, s82, 65536
    buffer_load_dwordx4 v232, s[44:47], s37 offen lds
    v_mfma_f32_16x16x32_bf16 v[140:143], v[76:79], a[20:23], v[140:143]
    buffer_load_dwordx4 v233, s[44:47], s37 offen offset:1024 lds
    v_mfma_f32_16x16x32_bf16 v[144:147], v[72:75], a[24:27], v[144:147]
    s_add_u32 m0, s35, 0
    s_and_b32 s33, s83, 1023
    s_lshl_b32 s33, s33, 12
    buffer_load_dwordx4 v234, s[48:51], s33 offen lds
    v_mfma_f32_16x16x32_bf16 v[148:151], v[76:79], a[24:27], v[148:151]
    buffer_load_dwordx4 v235, s[48:51], s33 offen offset:1024 lds
    v_mfma_f32_16x16x32_bf16 v[152:155], v[72:75], a[28:31], v[152:155]
    s_add_u32 m0, s35, 2048
    s_add_u32 s33, s33, 131072
    buffer_load_dwordx4 v234, s[48:51], s33 offen lds
    v_mfma_f32_16x16x32_bf16 v[156:159], v[76:79], a[28:31], v[156:159]
    buffer_load_dwordx4 v235, s[48:51], s33 offen offset:1024 lds
    s_waitcnt vmcnt(21) lgkmcnt(0)
    s_barrier
    v_mfma_f32_16x16x32_bf16 v[160:163], v[80:83], a[16:19], v[160:163]
    ds_read_b128 v[64:67], v224 offset:16384
    v_mfma_f32_16x16x32_bf16 v[164:167], v[84:87], a[16:19], v[164:167]
    ds_read_b128 v[68:71], v224 offset:18432
    v_mfma_f32_16x16x32_bf16 v[168:171], v[80:83], a[20:23], v[168:171]
    ds_read_b128 v[72:75], v224 offset:20480
    v_mfma_f32_16x16x32_bf16 v[172:175], v[84:87], a[20:23], v[172:175]
    ds_read_b128 v[76:79], v224 offset:22528
    v_mfma_f32_16x16x32_bf16 v[176:179], v[80:83], a[24:27], v[176:179]
    ds_read_b64_tr_b16 a[40:41], v230 offset:8192
    v_mfma_f32_16x16x32_bf16 v[180:183], v[84:87], a[24:27], v[180:183]
    ds_read_b64_tr_b16 a[42:43], v230 offset:8704
    v_mfma_f32_16x16x32_bf16 v[184:187], v[80:83], a[28:31], v[184:187]
    ds_read_b64_tr_b16 a[44:45], v231 offset:8192
    v_mfma_f32_16x16x32_bf16 v[188:191], v[84:87], a[28:31], v[188:191]
    ds_read_b64_tr_b16 a[46:47], v231 offset:8704
    v_mfma_f32_16x16x32_bf16 v[192:195], v[88:91], a[16:19], v[192:195]
    s_add_u32 m0, s34, 49152
    s_add_u32 s37, s83, 0
    buffer_load_dwordx4 v232, s[44:47], s37 offen lds
    v_mfma_f32_16x16x32_bf16 v[196:199], v[92:95], a[16:19], v[196:199]
    buffer_load_dwordx4 v233, s[44:47], s37 offen offset:1024 lds
    v_mfma_f32_16x16x32_bf16 v[200:203], v[88:91], a[20:23], v[200:203]
    s_add_u32 m0, s34, 57344
    s_add_u32 s37, s83, 65536
    buffer_load_dwordx4 v232, s[44:47], s37 offen lds
    v_mfma_f32_16x16x32_bf16 v[204:207], v[92:95], a[20:23], v[204:207]
    v_mfma_f32_16x16x32_bf16 v[208:211], v[88:91], a[24:27], v[208:211]
    buffer_load_dwordx4 v233, s[44:47], s37 offen offset:1024 lds
    v_mfma_f32_16x16x32_bf16 v[212:215], v[92:95], a[24:27], v[212:215]
    s_add_u32 m0, s34, 0
    s_add_u32 s37, s84, 0
    buffer_load_dwordx4 v232, s[44:47], s37 offen lds
    v_mfma_f32_16x16x32_bf16 v[216:219], v[88:91], a[28:31], v[216:219]
    buffer_load_dwordx4 v233, s[44:47], s37 offen offset:1024 lds
    v_mfma_f32_16x16x32_bf16 v[220:223], v[92:95], a[28:31], v[220:223]
    s_waitcnt lgkmcnt(0)
    v_mfma_f32_16x16x32_bf16 v[96:99], v[64:67], a[32:35], v[96:99]
    ds_read_b128 v[80:83], v224 offset:24576
    v_mfma_f32_16x16x32_bf16 v[100:103], v[68:71], a[32:35], v[100:103]
    ds_read_b128 v[84:87], v224 offset:26624
    v_mfma_f32_16x16x32_bf16 v[104:107], v[64:67], a[36:39], v[104:107]
    ds_read_b128 v[88:91], v224 offset:28672
    v_mfma_f32_16x16x32_bf16 v[108:111], v[68:71], a[36:39], v[108:111]
    ds_read_b128 v[92:95], v224 offset:30720
    v_mfma_f32_16x16x32_bf16 v[112:115], v[64:67], a[40:43], v[112:115]
    ds_read_b64_tr_b16 a[48:49], v228 offset:12288
    v_mfma_f32_16x16x32_bf16 v[116:119], v[68:71], a[40:43], v[116:119]
    ds_read_b64_tr_b16 a[50:51], v228 offset:12800
    v_mfma_f32_16x16x32_bf16 v[120:123], v[64:67], a[44:47], v[120:123]
    ds_read_b64_tr_b16 a[52:53], v229 offset:12288
    v_mfma_f32_16x16x32_bf16 v[124:127], v[68:71], a[44:47], v[124:127]
    ds_read_b64_tr_b16 a[54:55], v229 offset:12800
    v_mfma_f32_16x16x32_bf16 v[128:131], v[72:75], a[32:35], v[128:131]
    s_add_u32 m0, s35, 4096
    s_add_u32 s33, s33, 131072
    buffer_load_dwordx4 v234, s[48:51], s33 offen lds
    v_mfma_f32_16x16x32_bf16 v[132:135], v[76:79], a[32:35], v[132:135]
    v_mfma_f32_16x16x32_bf16 v[136:139], v[72:75], a[36:39], v[136:139]
    buffer_load_dwordx4 v235, s[48:51], s33 offen offset:1024 lds
    v_mfma_f32_16x16x32_bf16 v[140:143], v[76:79], a[36:39], v[140:143]
    v_mfma_f32_16x16x32_bf16 v[144:147], v[72:75], a[40:43], v[144:147]
    s_add_u32 m0, s35, 6144
    s_add_u32 s33, s33, 131072
    buffer_load_dwordx4 v234, s[48:51], s33 offen lds
    v_mfma_f32_16x16x32_bf16 v[148:151], v[76:79], a[40:43], v[148:151]
    v_mfma_f32_16x16x32_bf16 v[152:155], v[72:75], a[44:47], v[152:155]
    buffer_load_dwordx4 v235, s[48:51], s33 offen offset:1024 lds
    v_mfma_f32_16x16x32_bf16 v[156:159], v[76:79], a[44:47], v[156:159]
    s_waitcnt lgkmcnt(0)
    v_mfma_f32_16x16x32_bf16 v[160:163], v[80:83], a[32:35], v[160:163]
    ds_read_b128 v[64:67], v225 offset:16384
    v_mfma_f32_16x16x32_bf16 v[164:167], v[84:87], a[32:35], v[164:167]
    ds_read_b128 v[68:71], v225 offset:18432
    v_mfma_f32_16x16x32_bf16 v[168:171], v[80:83], a[36:39], v[168:171]
    ds_read_b128 v[72:75], v225 offset:20480
    v_mfma_f32_16x16x32_bf16 v[172:175], v[84:87], a[36:39], v[172:175]
    ds_read_b128 v[76:79], v225 offset:22528
    v_mfma_f32_16x16x32_bf16 v[176:179], v[80:83], a[40:43], v[176:179]
    ds_read_b64_tr_b16 a[56:57], v230 offset:12288
    v_mfma_f32_16x16x32_bf16 v[180:183], v[84:87], a[40:43], v[180:183]
    ds_read_b64_tr_b16 a[58:59], v230 offset:12800
    v_mfma_f32_16x16x32_bf16 v[184:187], v[80:83], a[44:47], v[184:187]
    ds_read_b64_tr_b16 a[60:61], v231 offset:12288
    v_mfma_f32_16x16x32_bf16 v[188:191], v[84:87], a[44:47], v[188:191]
    ds_read_b64_tr_b16 a[62:63], v231 offset:12800
    v_mfma_f32_16x16x32_bf16 v[192:195], v[88:91], a[32:35], v[192:195]
    s_add_u32 m0, s34, 8192
    s_add_u32 s37, s84, 65536
    buffer_load_dwordx4 v232, s[44:47], s37 offen lds
    v_mfma_f32_16x16x32_bf16 v[196:199], v[92:95], a[32:35], v[196:199]
    v_mfma_f32_16x16x32_bf16 v[200:203], v[88:91], a[36:39], v[200:203]
    v_mfma_f32_16x16x32_bf16 v[204:207], v[92:95], a[36:39], v[204:207]
    v_mfma_f32_16x16x32_bf16 v[208:211], v[88:91], a[40:43], v[208:211]
    buffer_load_dwordx4 v233, s[44:47], s37 offen offset:1024 lds
    v_mfma_f32_16x16x32_bf16 v[212:215], v[92:95], a[40:43], v[212:215]
    v_mfma_f32_16x16x32_bf16 v[216:219], v[88:91], a[44:47], v[216:219]
    v_mfma_f32_16x16x32_bf16 v[220:223], v[92:95], a[44:47], v[220:223]
    s_waitcnt vmcnt(22) lgkmcnt(0)
    v_mfma_f32_16x16x32_bf16 v[96:99], v[64:67], a[48:51], v[96:99]
    ds_read_b128 v[80:83], v225 offset:24576
    v_mfma_f32_16x16x32_bf16 v[100:103], v[68:71], a[48:51], v[100:103]
    ds_read_b128 v[84:87], v225 offset:26624
    v_mfma_f32_16x16x32_bf16 v[104:107], v[64:67], a[52:55], v[104:107]
    ds_read_b128 v[88:91], v225 offset:28672
    v_mfma_f32_16x16x32_bf16 v[108:111], v[68:71], a[52:55], v[108:111]
    ds_read_b128 v[92:95], v225 offset:30720
    v_mfma_f32_16x16x32_bf16 v[112:115], v[64:67], a[56:59], v[112:115]
    ds_read_b64_tr_b16 a[64:65], v228 offset:16384
    v_mfma_f32_16x16x32_bf16 v[116:119], v[68:71], a[56:59], v[116:119]
    ds_read_b64_tr_b16 a[66:67], v228 offset:16896
    v_mfma_f32_16x16x32_bf16 v[120:123], v[64:67], a[60:63], v[120:123]
    ds_read_b64_tr_b16 a[68:69], v229 offset:16384
    v_mfma_f32_16x16x32_bf16 v[124:127], v[68:71], a[60:63], v[124:127]
    ds_read_b64_tr_b16 a[70:71], v229 offset:16896
    v_mfma_f32_16x16x32_bf16 v[128:131], v[72:75], a[48:51], v[128:131]
    s_add_u32 m0, s35, 8192
    s_and_b32 s33, s84, 1023
    s_lshl_b32 s33, s33, 12
    buffer_load_dwordx4 v234, s[48:51], s33 offen lds
    v_mfma_f32_16x16x32_bf16 v[132:135], v[76:79], a[48:51], v[132:135]
    v_mfma_f32_16x16x32_bf16 v[136:139], v[72:75], a[52:55], v[136:139]
    buffer_load_dwordx4 v235, s[48:51], s33 offen offset:1024 lds
    v_mfma_f32_16x16x32_bf16 v[140:143], v[76:79], a[52:55], v[140:143]
    v_mfma_f32_16x16x32_bf16 v[144:147], v[72:75], a[56:59], v[144:147]
    s_add_u32 m0, s35, 10240
    s_add_u32 s33, s33, 131072
    buffer_load_dwordx4 v234, s[48:51], s33 offen lds
    v_mfma_f32_16x16x32_bf16 v[148:151], v[76:79], a[56:59], v[148:151]
    v_mfma_f32_16x16x32_bf16 v[152:155], v[72:75], a[60:63], v[152:155]
    buffer_load_dwordx4 v235, s[48:51], s33 offen offset:1024 lds
    v_mfma_f32_16x16x32_bf16 v[156:159], v[76:79], a[60:63], v[156:159]
    s_waitcnt vmcnt(20) lgkmcnt(0)
    s_barrier
    v_mfma_f32_16x16x32_bf16 v[160:163], v[80:83], a[48:51], v[160:163]
    ds_read_b128 v[64:67], v224 offset:32768
    v_mfma_f32_16x16x32_bf16 v[164:167], v[84:87], a[48:51], v[164:167]
    ds_read_b128 v[68:71], v224 offset:34816
    v_mfma_f32_16x16x32_bf16 v[168:171], v[80:83], a[52:55], v[168:171]
    ds_read_b128 v[72:75], v224 offset:36864
    v_mfma_f32_16x16x32_bf16 v[172:175], v[84:87], a[52:55], v[172:175]
    ds_read_b128 v[76:79], v224 offset:38912
    v_mfma_f32_16x16x32_bf16 v[176:179], v[80:83], a[56:59], v[176:179]
    ds_read_b64_tr_b16 a[72:73], v230 offset:16384
    v_mfma_f32_16x16x32_bf16 v[180:183], v[84:87], a[56:59], v[180:183]
    ds_read_b64_tr_b16 a[74:75], v230 offset:16896
    v_mfma_f32_16x16x32_bf16 v[184:187], v[80:83], a[60:63], v[184:187]
    ds_read_b64_tr_b16 a[76:77], v231 offset:16384
    v_mfma_f32_16x16x32_bf16 v[188:191], v[84:87], a[60:63], v[188:191]
    ds_read_b64_tr_b16 a[78:79], v231 offset:16896
    v_mfma_f32_16x16x32_bf16 v[192:195], v[88:91], a[48:51], v[192:195]
    s_add_u32 m0, s34, 16384
    s_add_u32 s37, s85, 0
    buffer_load_dwordx4 v232, s[44:47], s37 offen lds
    v_mfma_f32_16x16x32_bf16 v[196:199], v[92:95], a[48:51], v[196:199]
    v_mfma_f32_16x16x32_bf16 v[200:203], v[88:91], a[52:55], v[200:203]
    v_mfma_f32_16x16x32_bf16 v[204:207], v[92:95], a[52:55], v[204:207]
    v_mfma_f32_16x16x32_bf16 v[208:211], v[88:91], a[56:59], v[208:211]
    buffer_load_dwordx4 v233, s[44:47], s37 offen offset:1024 lds
    v_mfma_f32_16x16x32_bf16 v[212:215], v[92:95], a[56:59], v[212:215]
    v_mfma_f32_16x16x32_bf16 v[216:219], v[88:91], a[60:63], v[216:219]
    v_mfma_f32_16x16x32_bf16 v[220:223], v[92:95], a[60:63], v[220:223]
    s_waitcnt lgkmcnt(0)
    v_mfma_f32_16x16x32_bf16 v[96:99], v[64:67], a[64:67], v[96:99]
    ds_read_b128 v[80:83], v224 offset:40960
    s_waitcnt vmcnt(26)
    v_mfma_f32_16x16x32_bf16 v[100:103], v[68:71], a[64:67], v[100:103]
    ds_read_b128 v[84:87], v224 offset:43008
    v_lshlrev_b32 v16, 16, v0
    v_mfma_f32_16x16x32_bf16 v[104:107], v[64:67], a[68:71], v[104:107]
    ds_read_b128 v[88:91], v224 offset:45056
    v_and_b32 v17, 0xffff0000, v0
    v_mfma_f32_16x16x32_bf16 v[108:111], v[68:71], a[68:71], v[108:111]
    ds_read_b128 v[92:95], v224 offset:47104
    v_lshlrev_b32 v18, 16, v1
    v_mfma_f32_16x16x32_bf16 v[112:115], v[64:67], a[72:75], v[112:115]
    ds_read_b64_tr_b16 a[80:81], v228 offset:20480
    v_and_b32 v19, 0xffff0000, v1
    v_mfma_f32_16x16x32_bf16 v[116:119], v[68:71], a[72:75], v[116:119]
    ds_read_b64_tr_b16 a[82:83], v228 offset:20992
    v_lshlrev_b32 v20, 16, v2
    v_mfma_f32_16x16x32_bf16 v[120:123], v[64:67], a[76:79], v[120:123]
    ds_read_b64_tr_b16 a[84:85], v229 offset:20480
    v_and_b32 v21, 0xffff0000, v2
    v_mfma_f32_16x16x32_bf16 v[124:127], v[68:71], a[76:79], v[124:127]
    ds_read_b64_tr_b16 a[86:87], v229 offset:20992
    v_lshlrev_b32 v22, 16, v3
    v_mfma_f32_16x16x32_bf16 v[128:131], v[72:75], a[64:67], v[128:131]
    s_add_u32 m0, s35, 12288
    s_add_u32 s33, s33, 131072
    buffer_load_dwordx4 v234, s[48:51], s33 offen lds
    v_mfma_f32_16x16x32_bf16 v[132:135], v[76:79], a[64:67], v[132:135]
    v_and_b32 v23, 0xffff0000, v3
    v_lshlrev_b32 v24, 16, v4
    v_mfma_f32_16x16x32_bf16 v[136:139], v[72:75], a[68:71], v[136:139]
    buffer_load_dwordx4 v235, s[48:51], s33 offen offset:1024 lds
    v_and_b32 v25, 0xffff0000, v4
    v_mfma_f32_16x16x32_bf16 v[140:143], v[76:79], a[68:71], v[140:143]
    v_lshlrev_b32 v26, 16, v5
    v_and_b32 v27, 0xffff0000, v5
    v_mfma_f32_16x16x32_bf16 v[144:147], v[72:75], a[72:75], v[144:147]
    s_add_u32 m0, s35, 14336
    s_add_u32 s33, s33, 131072
    buffer_load_dwordx4 v234, s[48:51], s33 offen lds
    v_mfma_f32_16x16x32_bf16 v[148:151], v[76:79], a[72:75], v[148:151]
    v_lshlrev_b32 v28, 16, v6
    v_and_b32 v29, 0xffff0000, v6
    v_mfma_f32_16x16x32_bf16 v[152:155], v[72:75], a[76:79], v[152:155]
    buffer_load_dwordx4 v235, s[48:51], s33 offen offset:1024 lds
    v_lshlrev_b32 v30, 16, v7
    v_mfma_f32_16x16x32_bf16 v[156:159], v[76:79], a[76:79], v[156:159]
    v_and_b32 v31, 0xffff0000, v7
    s_waitcnt lgkmcnt(0)
    v_mfma_f32_16x16x32_bf16 v[160:163], v[80:83], a[64:67], v[160:163]
    ds_read_b128 v[64:67], v225 offset:32768
    v_lshlrev_b32 v32, 16, v8
    v_mfma_f32_16x16x32_bf16 v[164:167], v[84:87], a[64:67], v[164:167]
    ds_read_b128 v[68:71], v225 offset:34816
    v_and_b32 v33, 0xffff0000, v8
    v_mfma_f32_16x16x32_bf16 v[168:171], v[80:83], a[68:71], v[168:171]
    ds_read_b128 v[72:75], v225 offset:36864
    v_lshlrev_b32 v34, 16, v9
    v_mfma_f32_16x16x32_bf16 v[172:175], v[84:87], a[68:71], v[172:175]
    ds_read_b128 v[76:79], v225 offset:38912
    v_and_b32 v35, 0xffff0000, v9
    v_mfma_f32_16x16x32_bf16 v[176:179], v[80:83], a[72:75], v[176:179]
    ds_read_b64_tr_b16 a[88:89], v230 offset:20480
    v_lshlrev_b32 v36, 16, v10
    v_mfma_f32_16x16x32_bf16 v[180:183], v[84:87], a[72:75], v[180:183]
    ds_read_b64_tr_b16 a[90:91], v230 offset:20992
    v_and_b32 v37, 0xffff0000, v10
    v_mfma_f32_16x16x32_bf16 v[184:187], v[80:83], a[76:79], v[184:187]
    ds_read_b64_tr_b16 a[92:93], v231 offset:20480
    v_lshlrev_b32 v38, 16, v11
    v_mfma_f32_16x16x32_bf16 v[188:191], v[84:87], a[76:79], v[188:191]
    ds_read_b64_tr_b16 a[94:95], v231 offset:20992
    v_and_b32 v39, 0xffff0000, v11
    v_mfma_f32_16x16x32_bf16 v[192:195], v[88:91], a[64:67], v[192:195]
    s_add_u32 m0, s34, 24576
    s_add_u32 s37, s85, 65536
    buffer_load_dwordx4 v232, s[44:47], s37 offen lds
    v_mfma_f32_16x16x32_bf16 v[196:199], v[92:95], a[64:67], v[196:199]
    v_lshlrev_b32 v40, 16, v12
    v_and_b32 v41, 0xffff0000, v12
    v_mfma_f32_16x16x32_bf16 v[200:203], v[88:91], a[68:71], v[200:203]
    v_lshlrev_b32 v42, 16, v13
    v_and_b32 v43, 0xffff0000, v13
    v_mfma_f32_16x16x32_bf16 v[204:207], v[92:95], a[68:71], v[204:207]
    v_lshlrev_b32 v44, 16, v14
    v_and_b32 v45, 0xffff0000, v14
    v_mfma_f32_16x16x32_bf16 v[208:211], v[88:91], a[72:75], v[208:211]
    buffer_load_dwordx4 v233, s[44:47], s37 offen offset:1024 lds
    v_lshlrev_b32 v46, 16, v15
    v_mfma_f32_16x16x32_bf16 v[212:215], v[92:95], a[72:75], v[212:215]
    v_and_b32 v47, 0xffff0000, v15
    v_add_f32 v52, v16, v20
    v_mfma_f32_16x16x32_bf16 v[216:219], v[88:91], a[76:79], v[216:219]
    v_add_f32 v53, v17, v21
    v_add_f32 v54, v18, v22
    v_mfma_f32_16x16x32_bf16 v[220:223], v[92:95], a[76:79], v[220:223]
    v_add_f32 v55, v19, v23
    s_waitcnt vmcnt(14) lgkmcnt(0)
    v_mfma_f32_16x16x32_bf16 v[96:99], v[64:67], a[80:83], v[96:99]
    ds_read_b128 v[80:83], v225 offset:40960
    v_add_f32 v52, v52, v24
    v_mfma_f32_16x16x32_bf16 v[100:103], v[68:71], a[80:83], v[100:103]
    ds_read_b128 v[84:87], v225 offset:43008
    v_add_f32 v53, v53, v25
    v_mfma_f32_16x16x32_bf16 v[104:107], v[64:67], a[84:87], v[104:107]
    ds_read_b128 v[88:91], v225 offset:45056
    v_add_f32 v54, v54, v26
    v_mfma_f32_16x16x32_bf16 v[108:111], v[68:71], a[84:87], v[108:111]
    ds_read_b128 v[92:95], v225 offset:47104
    v_add_f32 v55, v55, v27
    v_mfma_f32_16x16x32_bf16 v[112:115], v[64:67], a[88:91], v[112:115]
    ds_read_b64_tr_b16 a[96:97], v228 offset:0
    v_add_f32 v52, v52, v28
    v_mfma_f32_16x16x32_bf16 v[116:119], v[68:71], a[88:91], v[116:119]
    ds_read_b64_tr_b16 a[98:99], v228 offset:512
    v_add_f32 v53, v53, v29
    v_mfma_f32_16x16x32_bf16 v[120:123], v[64:67], a[92:95], v[120:123]
    ds_read_b64_tr_b16 a[100:101], v229 offset:0
    v_add_f32 v54, v54, v30
    v_mfma_f32_16x16x32_bf16 v[124:127], v[68:71], a[92:95], v[124:127]
    ds_read_b64_tr_b16 a[102:103], v229 offset:512
    v_add_f32 v55, v55, v31
    v_mfma_f32_16x16x32_bf16 v[128:131], v[72:75], a[80:83], v[128:131]
    s_add_u32 m0, s35, 16384
    s_and_b32 s33, s85, 1023
    s_lshl_b32 s33, s33, 12
    buffer_load_dwordx4 v234, s[48:51], s33 offen lds
    v_mfma_f32_16x16x32_bf16 v[132:135], v[76:79], a[80:83], v[132:135]
    buffer_load_dwordx4 v235, s[48:51], s33 offen offset:1024 lds
    v_add_f32 v52, v52, v32
    v_mfma_f32_16x16x32_bf16 v[136:139], v[72:75], a[84:87], v[136:139]
    s_add_u32 m0, s35, 18432
    s_add_u32 s33, s33, 131072
    buffer_load_dwordx4 v234, s[48:51], s33 offen lds
    v_mfma_f32_16x16x32_bf16 v[140:143], v[76:79], a[84:87], v[140:143]
    v_add_f32 v53, v53, v33
    v_add_f32 v54, v54, v34
    v_mfma_f32_16x16x32_bf16 v[144:147], v[72:75], a[88:91], v[144:147]
    buffer_load_dwordx4 v235, s[48:51], s33 offen offset:1024 lds
    v_add_f32 v55, v55, v35
    v_mfma_f32_16x16x32_bf16 v[148:151], v[76:79], a[88:91], v[148:151]
    s_lshl2_add_u32 s26, s4, s3
    s_lshl_b32 s26, s26, 10
    s_add_u32 s26, s26, s32
    s_add_u32 s26, s26, 131072
    v_mfma_f32_16x16x32_bf16 v[152:155], v[72:75], a[92:95], v[152:155]
    v_and_b32 v226, 0x40000380, v251
    buffer_load_dword v241, v226, s[44:47], s26 offen
    v_mfma_f32_16x16x32_bf16 v[156:159], v[76:79], a[92:95], v[156:159]
    s_waitcnt vmcnt(25) lgkmcnt(0)
    s_barrier
    v_mfma_f32_16x16x32_bf16 v[160:163], v[80:83], a[80:83], v[160:163]
    ds_read_b128 v[64:67], v224 offset:49152
    v_add_f32 v52, v52, v36
    v_add_f32 v53, v53, v37
    v_mfma_f32_16x16x32_bf16 v[164:167], v[84:87], a[80:83], v[164:167]
    ds_read_b128 v[68:71], v224 offset:51200
    v_add_f32 v54, v54, v38
    v_mfma_f32_16x16x32_bf16 v[168:171], v[80:83], a[84:87], v[168:171]
    ds_read_b128 v[72:75], v224 offset:53248
    v_add_f32 v55, v55, v39
    v_mfma_f32_16x16x32_bf16 v[172:175], v[84:87], a[84:87], v[172:175]
    ds_read_b128 v[76:79], v224 offset:55296
    v_add_f32 v52, v52, v40
    v_mfma_f32_16x16x32_bf16 v[176:179], v[80:83], a[88:91], v[176:179]
    ds_read_b64_tr_b16 a[104:105], v230 offset:0
    v_add_f32 v53, v53, v41
    v_mfma_f32_16x16x32_bf16 v[180:183], v[84:87], a[88:91], v[180:183]
    ds_read_b64_tr_b16 a[106:107], v230 offset:512
    v_add_f32 v54, v54, v42
    v_mfma_f32_16x16x32_bf16 v[184:187], v[80:83], a[92:95], v[184:187]
    ds_read_b64_tr_b16 a[108:109], v231 offset:0
    v_add_f32 v55, v55, v43
    v_mfma_f32_16x16x32_bf16 v[188:191], v[84:87], a[92:95], v[188:191]
    ds_read_b64_tr_b16 a[110:111], v231 offset:512
    v_add_f32 v52, v52, v44
    v_mfma_f32_16x16x32_bf16 v[192:195], v[88:91], a[80:83], v[192:195]
    s_add_u32 m0, s34, 32768
    s_add_u32 s37, s86, 0
    buffer_load_dwordx4 v232, s[44:47], s37 offen lds
    v_mfma_f32_16x16x32_bf16 v[196:199], v[92:95], a[80:83], v[196:199]
    v_add_f32 v53, v53, v45
    v_add_f32 v54, v54, v46
    v_mfma_f32_16x16x32_bf16 v[200:203], v[88:91], a[84:87], v[200:203]
    v_add_f32 v55, v55, v47
    v_add_f32 v52, v52, v53
    v_mfma_f32_16x16x32_bf16 v[204:207], v[92:95], a[84:87], v[204:207]
    v_add_f32 v54, v54, v55
    v_add_f32 v48, v52, v54
    v_mfma_f32_16x16x32_bf16 v[208:211], v[88:91], a[88:91], v[208:211]
    buffer_load_dwordx4 v233, s[44:47], s37 offen offset:1024 lds
    s_nop 1
    v_mfma_f32_16x16x32_bf16 v[212:215], v[92:95], a[88:91], v[212:215]
    v_add_f32_dpp v48, v48, v48 quad_perm:[1,0,3,2] row_mask:0xf bank_mask:0xf
    s_nop 1
    v_mfma_f32_16x16x32_bf16 v[216:219], v[88:91], a[92:95], v[216:219]
    v_add_f32_dpp v48, v48, v48 quad_perm:[2,3,0,1] row_mask:0xf bank_mask:0xf
    s_nop 1
    v_mfma_f32_16x16x32_bf16 v[220:223], v[92:95], a[92:95], v[220:223]
    v_add_f32_dpp v48, v48, v48 row_half_mirror row_mask:0xf bank_mask:0xf
    s_waitcnt lgkmcnt(0)
    v_mfma_f32_16x16x32_bf16 v[96:99], v[64:67], a[96:99], v[96:99]
    ds_read_b128 v[80:83], v224 offset:57344
    s_nop 1
    v_mfma_f32_16x16x32_bf16 v[100:103], v[68:71], a[96:99], v[100:103]
    ds_read_b128 v[84:87], v224 offset:59392
    v_add_f32_dpp v48, v48, v48 row_mirror row_mask:0xf bank_mask:0xf
    v_mfma_f32_16x16x32_bf16 v[104:107], v[64:67], a[100:103], v[104:107]
    ds_read_b128 v[88:91], v224 offset:61440
    s_nop 0
    v_mfma_f32_16x16x32_bf16 v[108:111], v[68:71], a[100:103], v[108:111]
    ds_read_b128 v[92:95], v224 offset:63488
    v_mov_b32 v49, v48
    v_mfma_f32_16x16x32_bf16 v[112:115], v[64:67], a[104:107], v[112:115]
    ds_read_b64_tr_b16 a[112:113], v228 offset:4096
    s_nop 1
    v_mfma_f32_16x16x32_bf16 v[116:119], v[68:71], a[104:107], v[116:119]
    ds_read_b64_tr_b16 a[114:115], v228 offset:4608
    v_permlane16_swap_b32 v48, v49
    v_mfma_f32_16x16x32_bf16 v[120:123], v[64:67], a[108:111], v[120:123]
    ds_read_b64_tr_b16 a[116:117], v229 offset:4096
    s_nop 0
    v_mfma_f32_16x16x32_bf16 v[124:127], v[68:71], a[108:111], v[124:127]
    ds_read_b64_tr_b16 a[118:119], v229 offset:4608
    v_add_f32 v48, v48, v49
    v_mfma_f32_16x16x32_bf16 v[128:131], v[72:75], a[96:99], v[128:131]
    s_add_u32 m0, s35, 20480
    s_add_u32 s33, s33, 131072
    buffer_load_dwordx4 v234, s[48:51], s33 offen lds
    v_mfma_f32_16x16x32_bf16 v[132:135], v[76:79], a[96:99], v[132:135]
    buffer_load_dwordx4 v235, s[48:51], s33 offen offset:1024 lds
    v_mul_f32 v48, 0x3a800000, v48
    v_mfma_f32_16x16x32_bf16 v[136:139], v[72:75], a[100:103], v[136:139]
    v_sub_f32 v56, v16, v48
    v_mul_f32 v52, v56, v56
    v_mfma_f32_16x16x32_bf16 v[140:143], v[76:79], a[100:103], v[140:143]
    s_add_u32 m0, s35, 22528
    s_add_u32 s33, s33, 131072
    buffer_load_dwordx4 v234, s[48:51], s33 offen lds
    v_mfma_f32_16x16x32_bf16 v[144:147], v[72:75], a[104:107], v[144:147]
    buffer_load_dwordx4 v235, s[48:51], s33 offen offset:1024 lds
    v_sub_f32 v57, v17, v48
    v_mfma_f32_16x16x32_bf16 v[148:151], v[76:79], a[104:107], v[148:151]
    v_mul_f32 v53, v57, v57
    v_sub_f32 v58, v18, v48
    v_mfma_f32_16x16x32_bf16 v[152:155], v[72:75], a[108:111], v[152:155]
    v_lshlrev_b32 v226, 7, v253
    s_lshl_b32 s25, s2, 15
    buffer_load_dword v241, v226, s[12:15], s25 offen
    v_mfma_f32_16x16x32_bf16 v[156:159], v[76:79], a[108:111], v[156:159]
    v_mul_f32 v54, v58, v58
    s_waitcnt lgkmcnt(0)
    v_mfma_f32_16x16x32_bf16 v[160:163], v[80:83], a[96:99], v[160:163]
    ds_read_b128 v[64:67], v225 offset:49152
    v_sub_f32 v59, v19, v48
    v_mfma_f32_16x16x32_bf16 v[164:167], v[84:87], a[96:99], v[164:167]
    ds_read_b128 v[68:71], v225 offset:51200
    v_mul_f32 v55, v59, v59
    v_mfma_f32_16x16x32_bf16 v[168:171], v[80:83], a[100:103], v[168:171]
    ds_read_b128 v[72:75], v225 offset:53248
    v_sub_f32 v56, v20, v48
    v_mfma_f32_16x16x32_bf16 v[172:175], v[84:87], a[100:103], v[172:175]
    ds_read_b128 v[76:79], v225 offset:55296
    v_fmac_f32 v52, v56, v56
    v_mfma_f32_16x16x32_bf16 v[176:179], v[80:83], a[104:107], v[176:179]
    ds_read_b64_tr_b16 a[120:121], v230 offset:4096
    v_sub_f32 v57, v21, v48
    v_mfma_f32_16x16x32_bf16 v[180:183], v[84:87], a[104:107], v[180:183]
    ds_read_b64_tr_b16 a[122:123], v230 offset:4608
    v_fmac_f32 v53, v57, v57
    v_mfma_f32_16x16x32_bf16 v[184:187], v[80:83], a[108:111], v[184:187]
    ds_read_b64_tr_b16 a[124:125], v231 offset:4096
    v_sub_f32 v58, v22, v48
    v_mfma_f32_16x16x32_bf16 v[188:191], v[84:87], a[108:111], v[188:191]
    ds_read_b64_tr_b16 a[126:127], v231 offset:4608
    v_fmac_f32 v54, v58, v58
    v_mfma_f32_16x16x32_bf16 v[192:195], v[88:91], a[96:99], v[192:195]
    s_add_u32 m0, s34, 40960
    s_add_u32 s37, s86, 65536
    buffer_load_dwordx4 v232, s[44:47], s37 offen lds
    v_mfma_f32_16x16x32_bf16 v[196:199], v[92:95], a[96:99], v[196:199]
    v_sub_f32 v59, v23, v48
    v_fmac_f32 v55, v59, v59
    v_mfma_f32_16x16x32_bf16 v[200:203], v[88:91], a[100:103], v[200:203]
    v_sub_f32 v56, v24, v48
    v_fmac_f32 v52, v56, v56
    v_mfma_f32_16x16x32_bf16 v[204:207], v[92:95], a[100:103], v[204:207]
    v_sub_f32 v57, v25, v48
    v_fmac_f32 v53, v57, v57
    v_mfma_f32_16x16x32_bf16 v[208:211], v[88:91], a[104:107], v[208:211]
    buffer_load_dwordx4 v233, s[44:47], s37 offen offset:1024 lds
    v_sub_f32 v58, v26, v48
    v_mfma_f32_16x16x32_bf16 v[212:215], v[92:95], a[104:107], v[212:215]
    v_fmac_f32 v54, v58, v58
    v_sub_f32 v59, v27, v48
    v_mfma_f32_16x16x32_bf16 v[216:219], v[88:91], a[108:111], v[216:219]
    v_fmac_f32 v55, v59, v59
    v_sub_f32 v56, v28, v48
    v_mfma_f32_16x16x32_bf16 v[220:223], v[92:95], a[108:111], v[220:223]
    v_fmac_f32 v52, v56, v56
    s_waitcnt vmcnt(16) lgkmcnt(0)
    v_mfma_f32_16x16x32_bf16 v[96:99], v[64:67], a[112:115], v[96:99]
    ds_read_b128 v[80:83], v225 offset:57344
    v_sub_f32 v57, v29, v48
    v_mfma_f32_16x16x32_bf16 v[100:103], v[68:71], a[112:115], v[100:103]
    ds_read_b128 v[84:87], v225 offset:59392
    v_fmac_f32 v53, v57, v57
    v_mfma_f32_16x16x32_bf16 v[104:107], v[64:67], a[116:119], v[104:107]
    ds_read_b128 v[88:91], v225 offset:61440
    v_sub_f32 v58, v30, v48
    v_mfma_f32_16x16x32_bf16 v[108:111], v[68:71], a[116:119], v[108:111]
    ds_read_b128 v[92:95], v225 offset:63488
    v_fmac_f32 v54, v58, v58
    v_mfma_f32_16x16x32_bf16 v[112:115], v[64:67], a[120:123], v[112:115]
    ds_read_b64_tr_b16 a[128:129], v228 offset:8192
    v_sub_f32 v59, v31, v48
    v_mfma_f32_16x16x32_bf16 v[116:119], v[68:71], a[120:123], v[116:119]
    ds_read_b64_tr_b16 a[130:131], v228 offset:8704
    v_fmac_f32 v55, v59, v59
    v_mfma_f32_16x16x32_bf16 v[120:123], v[64:67], a[124:127], v[120:123]
    ds_read_b64_tr_b16 a[132:133], v229 offset:8192
    v_sub_f32 v56, v32, v48
    v_mfma_f32_16x16x32_bf16 v[124:127], v[68:71], a[124:127], v[124:127]
    ds_read_b64_tr_b16 a[134:135], v229 offset:8704
    v_fmac_f32 v52, v56, v56
    v_mfma_f32_16x16x32_bf16 v[128:131], v[72:75], a[112:115], v[128:131]
    s_add_u32 m0, s35, 0
    s_and_b32 s33, s86, 1023
    s_lshl_b32 s33, s33, 12
    buffer_load_dwordx4 v234, s[48:51], s33 offen lds
    v_mfma_f32_16x16x32_bf16 v[132:135], v[76:79], a[112:115], v[132:135]
    v_sub_f32 v57, v33, v48
    v_fmac_f32 v53, v57, v57
    v_mfma_f32_16x16x32_bf16 v[136:139], v[72:75], a[116:119], v[136:139]
    buffer_load_dwordx4 v235, s[48:51], s33 offen offset:1024 lds
    v_sub_f32 v58, v34, v48
    v_mfma_f32_16x16x32_bf16 v[140:143], v[76:79], a[116:119], v[140:143]
    v_fmac_f32 v54, v58, v58
    v_sub_f32 v59, v35, v48
    v_mfma_f32_16x16x32_bf16 v[144:147], v[72:75], a[120:123], v[144:147]
    s_add_u32 m0, s35, 2048
    s_add_u32 s33, s33, 131072
    buffer_load_dwordx4 v234, s[48:51], s33 offen lds
    v_mfma_f32_16x16x32_bf16 v[148:151], v[76:79], a[120:123], v[148:151]
    v_fmac_f32 v55, v59, v59
    v_sub_f32 v56, v36, v48
    v_mfma_f32_16x16x32_bf16 v[152:155], v[72:75], a[124:127], v[152:155]
    buffer_load_dwordx4 v235, s[48:51], s33 offen offset:1024 lds
    v_fmac_f32 v52, v56, v56
    v_mfma_f32_16x16x32_bf16 v[156:159], v[76:79], a[124:127], v[156:159]
    s_waitcnt vmcnt(30) lgkmcnt(0)
    s_barrier
    v_mfma_f32_16x16x32_bf16 v[160:163], v[80:83], a[112:115], v[160:163]
    ds_read_b128 v[64:67], v224 offset:0
    v_sub_f32 v57, v37, v48
    v_mfma_f32_16x16x32_bf16 v[164:167], v[84:87], a[112:115], v[164:167]
    ds_read_b128 v[68:71], v224 offset:2048
    v_fmac_f32 v53, v57, v57
    v_mfma_f32_16x16x32_bf16 v[168:171], v[80:83], a[116:119], v[168:171]
    ds_read_b128 v[72:75], v224 offset:4096
    v_sub_f32 v58, v38, v48
    v_mfma_f32_16x16x32_bf16 v[172:175], v[84:87], a[116:119], v[172:175]
    ds_read_b128 v[76:79], v224 offset:6144
    v_fmac_f32 v54, v58, v58
    v_mfma_f32_16x16x32_bf16 v[176:179], v[80:83], a[120:123], v[176:179]
    ds_read_b64_tr_b16 a[136:137], v230 offset:8192
    v_sub_f32 v59, v39, v48
    v_mfma_f32_16x16x32_bf16 v[180:183], v[84:87], a[120:123], v[180:183]
    ds_read_b64_tr_b16 a[138:139], v230 offset:8704
    v_fmac_f32 v55, v59, v59
    v_mfma_f32_16x16x32_bf16 v[184:187], v[80:83], a[124:127], v[184:187]
    ds_read_b64_tr_b16 a[140:141], v231 offset:8192
    v_sub_f32 v56, v40, v48
    v_mfma_f32_16x16x32_bf16 v[188:191], v[84:87], a[124:127], v[188:191]
    ds_read_b64_tr_b16 a[142:143], v231 offset:8704
    v_fmac_f32 v52, v56, v56
    v_mfma_f32_16x16x32_bf16 v[192:195], v[88:91], a[112:115], v[192:195]
    s_add_u32 m0, s34, 49152
    s_add_u32 s37, s87, 0
    buffer_load_dwordx4 v232, s[44:47], s37 offen lds
    v_mfma_f32_16x16x32_bf16 v[196:199], v[92:95], a[112:115], v[196:199]
    v_sub_f32 v57, v41, v48
    v_fmac_f32 v53, v57, v57
    v_mfma_f32_16x16x32_bf16 v[200:203], v[88:91], a[116:119], v[200:203]
    v_sub_f32 v58, v42, v48
    v_fmac_f32 v54, v58, v58
    v_mfma_f32_16x16x32_bf16 v[204:207], v[92:95], a[116:119], v[204:207]
    v_sub_f32 v59, v43, v48
    v_fmac_f32 v55, v59, v59
    v_mfma_f32_16x16x32_bf16 v[208:211], v[88:91], a[120:123], v[208:211]
    buffer_load_dwordx4 v233, s[44:47], s37 offen offset:1024 lds
    v_sub_f32 v56, v44, v48
    v_mfma_f32_16x16x32_bf16 v[212:215], v[92:95], a[120:123], v[212:215]
    v_fmac_f32 v52, v56, v56
    v_sub_f32 v57, v45, v48
    v_mfma_f32_16x16x32_bf16 v[216:219], v[88:91], a[124:127], v[216:219]
    v_fmac_f32 v53, v57, v57
    v_sub_f32 v58, v46, v48
    v_mfma_f32_16x16x32_bf16 v[220:223], v[92:95], a[124:127], v[220:223]
    v_fmac_f32 v54, v58, v58
    s_waitcnt lgkmcnt(0)
    v_mfma_f32_16x16x32_bf16 v[96:99], v[64:67], a[128:131], v[96:99]
    ds_read_b128 v[80:83], v224 offset:8192
    v_sub_f32 v59, v47, v48
    v_mfma_f32_16x16x32_bf16 v[100:103], v[68:71], a[128:131], v[100:103]
    ds_read_b128 v[84:87], v224 offset:10240
    v_fmac_f32 v55, v59, v59
    v_mfma_f32_16x16x32_bf16 v[104:107], v[64:67], a[132:135], v[104:107]
    ds_read_b128 v[88:91], v224 offset:12288
    v_add_f32 v52, v52, v53
    v_mfma_f32_16x16x32_bf16 v[108:111], v[68:71], a[132:135], v[108:111]
    ds_read_b128 v[92:95], v224 offset:14336
    v_add_f32 v54, v54, v55
    v_mfma_f32_16x16x32_bf16 v[112:115], v[64:67], a[136:139], v[112:115]
    ds_read_b64_tr_b16 a[144:145], v228 offset:12288
    v_add_f32 v51, v52, v54
    v_mfma_f32_16x16x32_bf16 v[116:119], v[68:71], a[136:139], v[116:119]
    ds_read_b64_tr_b16 a[146:147], v228 offset:12800
    s_nop 1
    v_mfma_f32_16x16x32_bf16 v[120:123], v[64:67], a[140:143], v[120:123]
    ds_read_b64_tr_b16 a[148:149], v229 offset:12288
    v_add_f32_dpp v51, v51, v51 quad_perm:[1,0,3,2] row_mask:0xf bank_mask:0xf
    v_mfma_f32_16x16x32_bf16 v[124:127], v[68:71], a[140:143], v[124:127]
    ds_read_b64_tr_b16 a[150:151], v229 offset:12800
    s_nop 1
    v_mfma_f32_16x16x32_bf16 v[128:131], v[72:75], a[128:131], v[128:131]
    s_add_u32 m0, s35, 4096
    s_add_u32 s33, s33, 131072
    buffer_load_dwordx4 v234, s[48:51], s33 offen lds
    v_mfma_f32_16x16x32_bf16 v[132:135], v[76:79], a[128:131], v[132:135]
    v_add_f32_dpp v51, v51, v51 quad_perm:[2,3,0,1] row_mask:0xf bank_mask:0xf
    s_nop 1
    v_add_f32_dpp v51, v51, v51 row_half_mirror row_mask:0xf bank_mask:0xf
    v_mfma_f32_16x16x32_bf16 v[136:139], v[72:75], a[132:135], v[136:139]
    buffer_load_dwordx4 v235, s[48:51], s33 offen offset:1024 lds
    s_nop 1
    v_mfma_f32_16x16x32_bf16 v[140:143], v[76:79], a[132:135], v[140:143]
    v_add_f32_dpp v51, v51, v51 row_mirror row_mask:0xf bank_mask:0xf
    s_nop 0
    v_mfma_f32_16x16x32_bf16 v[144:147], v[72:75], a[136:139], v[144:147]
    s_add_u32 m0, s35, 6144
    s_add_u32 s33, s33, 131072
    buffer_load_dwordx4 v234, s[48:51], s33 offen lds
    v_mfma_f32_16x16x32_bf16 v[148:151], v[76:79], a[136:139], v[148:151]
    v_mov_b32 v49, v51
    s_nop 1
    v_mfma_f32_16x16x32_bf16 v[152:155], v[72:75], a[140:143], v[152:155]
    buffer_load_dwordx4 v235, s[48:51], s33 offen offset:1024 lds
    v_permlane16_swap_b32 v51, v49
    v_mfma_f32_16x16x32_bf16 v[156:159], v[76:79], a[140:143], v[156:159]
    s_nop 0
    s_waitcnt lgkmcnt(0)
    v_mfma_f32_16x16x32_bf16 v[160:163], v[80:83], a[128:131], v[160:163]
    ds_read_b128 v[64:67], v225 offset:0
    v_add_f32 v51, v51, v49
    v_mfma_f32_16x16x32_bf16 v[164:167], v[84:87], a[128:131], v[164:167]
    ds_read_b128 v[68:71], v225 offset:2048
    v_mul_f32 v51, 0x3a800000, v51
    v_mfma_f32_16x16x32_bf16 v[168:171], v[80:83], a[132:135], v[168:171]
    ds_read_b128 v[72:75], v225 offset:4096
    v_cvt_pk_bf16_f32 v50, v48, v51
    v_mfma_f32_16x16x32_bf16 v[172:175], v[84:87], a[132:135], v[172:175]
    ds_read_b128 v[76:79], v225 offset:6144
    v_and_b32 v51, 0xffff0000, v50
    v_mfma_f32_16x16x32_bf16 v[176:179], v[80:83], a[136:139], v[176:179]
    ds_read_b64_tr_b16 a[152:153], v230 offset:12288
    v_lshlrev_b32 v50, 16, v50
    v_mfma_f32_16x16x32_bf16 v[180:183], v[84:87], a[136:139], v[180:183]
    ds_read_b64_tr_b16 a[154:155], v230 offset:12800
    v_add_f32 v51, 0x3727c5ac, v51
    v_mfma_f32_16x16x32_bf16 v[184:187], v[80:83], a[140:143], v[184:187]
    ds_read_b64_tr_b16 a[156:157], v231 offset:12288
    v_cvt_pk_bf16_f32 v51, v51, v51
    v_mfma_f32_16x16x32_bf16 v[188:191], v[84:87], a[140:143], v[188:191]
    ds_read_b64_tr_b16 a[158:159], v231 offset:12800
    v_lshlrev_b32 v51, 16, v51
    v_mfma_f32_16x16x32_bf16 v[192:195], v[88:91], a[128:131], v[192:195]
    s_add_u32 m0, s34, 57344
    s_add_u32 s37, s87, 65536
    buffer_load_dwordx4 v232, s[44:47], s37 offen lds
    v_mfma_f32_16x16x32_bf16 v[196:199], v[92:95], a[128:131], v[196:199]
    v_sqrt_f32 v51, v51
    v_mfma_f32_16x16x32_bf16 v[200:203], v[88:91], a[132:135], v[200:203]
    s_nop 0
    v_cvt_pk_bf16_f32 v51, v51, v51
    v_mfma_f32_16x16x32_bf16 v[204:207], v[92:95], a[132:135], v[204:207]
    v_lshlrev_b32 v51, 16, v51
    v_mfma_f32_16x16x32_bf16 v[208:211], v[88:91], a[136:139], v[208:211]
    buffer_load_dwordx4 v233, s[44:47], s37 offen offset:1024 lds
    v_rcp_f32 v51, v51
    v_mfma_f32_16x16x32_bf16 v[212:215], v[92:95], a[136:139], v[212:215]
    s_nop 0
    v_sub_f32 v16, v16, v50
    v_mfma_f32_16x16x32_bf16 v[216:219], v[88:91], a[140:143], v[216:219]
    v_sub_f32 v17, v17, v50
    v_cvt_pk_bf16_f32 v17, v16, v17
    v_mfma_f32_16x16x32_bf16 v[220:223], v[92:95], a[140:143], v[220:223]
    v_lshlrev_b32 v16, 16, v17
    s_waitcnt vmcnt(15) lgkmcnt(0)
    v_mfma_f32_16x16x32_bf16 v[96:99], v[64:67], a[144:147], v[96:99]
    ds_read_b128 v[80:83], v225 offset:8192
    v_and_b32 v17, 0xffff0000, v17
    v_mfma_f32_16x16x32_bf16 v[100:103], v[68:71], a[144:147], v[100:103]
    ds_read_b128 v[84:87], v225 offset:10240
    v_mul_f32 v16, v16, v51
    v_mfma_f32_16x16x32_bf16 v[104:107], v[64:67], a[148:151], v[104:107]
    ds_read_b128 v[88:91], v225 offset:12288
    v_mul_f32 v17, v17, v51
    v_mfma_f32_16x16x32_bf16 v[108:111], v[68:71], a[148:151], v[108:111]
    ds_read_b128 v[92:95], v225 offset:14336
    v_cvt_pk_bf16_f32 v0, v16, v17
    v_mfma_f32_16x16x32_bf16 v[112:115], v[64:67], a[152:155], v[112:115]
    ds_read_b64_tr_b16 a[160:161], v228 offset:16384
    v_sub_f32 v18, v18, v50
    v_mfma_f32_16x16x32_bf16 v[116:119], v[68:71], a[152:155], v[116:119]
    ds_read_b64_tr_b16 a[162:163], v228 offset:16896
    v_sub_f32 v19, v19, v50
    v_mfma_f32_16x16x32_bf16 v[120:123], v[64:67], a[156:159], v[120:123]
    ds_read_b64_tr_b16 a[164:165], v229 offset:16384
    v_cvt_pk_bf16_f32 v19, v18, v19
    v_mfma_f32_16x16x32_bf16 v[124:127], v[68:71], a[156:159], v[124:127]
    ds_read_b64_tr_b16 a[166:167], v229 offset:16896
    v_lshlrev_b32 v18, 16, v19
    v_mfma_f32_16x16x32_bf16 v[128:131], v[72:75], a[144:147], v[128:131]
    s_add_u32 m0, s35, 8192
    s_and_b32 s33, s87, 1023
    s_lshl_b32 s33, s33, 12
    buffer_load_dwordx4 v234, s[48:51], s33 offen lds
    v_mfma_f32_16x16x32_bf16 v[132:135], v[76:79], a[144:147], v[132:135]
    v_and_b32 v19, 0xffff0000, v19
    v_mul_f32 v18, v18, v51
    v_mfma_f32_16x16x32_bf16 v[136:139], v[72:75], a[148:151], v[136:139]
    buffer_load_dwordx4 v235, s[48:51], s33 offen offset:1024 lds
    v_mul_f32 v19, v19, v51
    v_mfma_f32_16x16x32_bf16 v[140:143], v[76:79], a[148:151], v[140:143]
    v_cvt_pk_bf16_f32 v1, v18, v19
    v_sub_f32 v20, v20, v50
    v_mfma_f32_16x16x32_bf16 v[144:147], v[72:75], a[152:155], v[144:147]
    s_add_u32 m0, s35, 10240
    s_add_u32 s33, s33, 131072
    buffer_load_dwordx4 v234, s[48:51], s33 offen lds
    v_mfma_f32_16x16x32_bf16 v[148:151], v[76:79], a[152:155], v[148:151]
    v_sub_f32 v21, v21, v50
    v_cvt_pk_bf16_f32 v21, v20, v21
    v_mfma_f32_16x16x32_bf16 v[152:155], v[72:75], a[156:159], v[152:155]
    buffer_load_dwordx4 v235, s[48:51], s33 offen offset:1024 lds
    v_lshlrev_b32 v20, 16, v21
    v_mfma_f32_16x16x32_bf16 v[156:159], v[76:79], a[156:159], v[156:159]
    s_waitcnt vmcnt(30) lgkmcnt(0)
    s_barrier
    v_mfma_f32_16x16x32_bf16 v[160:163], v[80:83], a[144:147], v[160:163]
    ds_read_b128 v[64:67], v224 offset:16384
    v_and_b32 v21, 0xffff0000, v21
    v_mfma_f32_16x16x32_bf16 v[164:167], v[84:87], a[144:147], v[164:167]
    ds_read_b128 v[68:71], v224 offset:18432
    v_mul_f32 v20, v20, v51
    v_mfma_f32_16x16x32_bf16 v[168:171], v[80:83], a[148:151], v[168:171]
    ds_read_b128 v[72:75], v224 offset:20480
    v_mul_f32 v21, v21, v51
    v_mfma_f32_16x16x32_bf16 v[172:175], v[84:87], a[148:151], v[172:175]
    ds_read_b128 v[76:79], v224 offset:22528
    v_cvt_pk_bf16_f32 v2, v20, v21
    v_mfma_f32_16x16x32_bf16 v[176:179], v[80:83], a[152:155], v[176:179]
    ds_read_b64_tr_b16 a[168:169], v230 offset:16384
    v_sub_f32 v22, v22, v50
    v_mfma_f32_16x16x32_bf16 v[180:183], v[84:87], a[152:155], v[180:183]
    ds_read_b64_tr_b16 a[170:171], v230 offset:16896
    v_sub_f32 v23, v23, v50
    v_mfma_f32_16x16x32_bf16 v[184:187], v[80:83], a[156:159], v[184:187]
    ds_read_b64_tr_b16 a[172:173], v231 offset:16384
    v_cvt_pk_bf16_f32 v23, v22, v23
    v_mfma_f32_16x16x32_bf16 v[188:191], v[84:87], a[156:159], v[188:191]
    ds_read_b64_tr_b16 a[174:175], v231 offset:16896
    v_lshlrev_b32 v22, 16, v23
    v_mfma_f32_16x16x32_bf16 v[192:195], v[88:91], a[144:147], v[192:195]
    s_add_u32 m0, s34, 0
    s_add_u32 s37, s80, 131072
    buffer_load_dwordx4 v232, s[44:47], s37 offen lds
    v_mfma_f32_16x16x32_bf16 v[196:199], v[92:95], a[144:147], v[196:199]
    v_and_b32 v23, 0xffff0000, v23
    v_mul_f32 v22, v22, v51
    v_mfma_f32_16x16x32_bf16 v[200:203], v[88:91], a[148:151], v[200:203]
    v_mul_f32 v23, v23, v51
    v_cvt_pk_bf16_f32 v3, v22, v23
    v_mfma_f32_16x16x32_bf16 v[204:207], v[92:95], a[148:151], v[204:207]
    v_sub_f32 v24, v24, v50
    v_sub_f32 v25, v25, v50
    v_mfma_f32_16x16x32_bf16 v[208:211], v[88:91], a[152:155], v[208:211]
    buffer_load_dwordx4 v233, s[44:47], s37 offen offset:1024 lds
    v_cvt_pk_bf16_f32 v25, v24, v25
    v_mfma_f32_16x16x32_bf16 v[212:215], v[92:95], a[152:155], v[212:215]
    v_lshlrev_b32 v24, 16, v25
    v_and_b32 v25, 0xffff0000, v25
    v_mfma_f32_16x16x32_bf16 v[216:219], v[88:91], a[156:159], v[216:219]
    v_mul_f32 v24, v24, v51
    v_mul_f32 v25, v25, v51
    v_mfma_f32_16x16x32_bf16 v[220:223], v[92:95], a[156:159], v[220:223]
    v_cvt_pk_bf16_f32 v4, v24, v25
    s_waitcnt lgkmcnt(0)
    v_mfma_f32_16x16x32_bf16 v[96:99], v[64:67], a[160:163], v[96:99]
    ds_read_b128 v[80:83], v224 offset:24576
    v_sub_f32 v26, v26, v50
    v_mfma_f32_16x16x32_bf16 v[100:103], v[68:71], a[160:163], v[100:103]
    ds_read_b128 v[84:87], v224 offset:26624
    v_sub_f32 v27, v27, v50
    v_mfma_f32_16x16x32_bf16 v[104:107], v[64:67], a[164:167], v[104:107]
    ds_read_b128 v[88:91], v224 offset:28672
    v_cvt_pk_bf16_f32 v27, v26, v27
    v_mfma_f32_16x16x32_bf16 v[108:111], v[68:71], a[164:167], v[108:111]
    ds_read_b128 v[92:95], v224 offset:30720
    v_lshlrev_b32 v26, 16, v27
    v_mfma_f32_16x16x32_bf16 v[112:115], v[64:67], a[168:171], v[112:115]
    ds_read_b64_tr_b16 a[176:177], v228 offset:20480
    v_and_b32 v27, 0xffff0000, v27
    v_mfma_f32_16x16x32_bf16 v[116:119], v[68:71], a[168:171], v[116:119]
    ds_read_b64_tr_b16 a[178:179], v228 offset:20992
    v_mul_f32 v26, v26, v51
    v_mfma_f32_16x16x32_bf16 v[120:123], v[64:67], a[172:175], v[120:123]
    ds_read_b64_tr_b16 a[180:181], v229 offset:20480
    v_mul_f32 v27, v27, v51
    v_mfma_f32_16x16x32_bf16 v[124:127], v[68:71], a[172:175], v[124:127]
    ds_read_b64_tr_b16 a[182:183], v229 offset:20992
    v_cvt_pk_bf16_f32 v5, v26, v27
    v_mfma_f32_16x16x32_bf16 v[128:131], v[72:75], a[160:163], v[128:131]
    s_add_u32 m0, s35, 12288
    s_add_u32 s33, s33, 131072
    buffer_load_dwordx4 v234, s[48:51], s33 offen lds
    v_mfma_f32_16x16x32_bf16 v[132:135], v[76:79], a[160:163], v[132:135]
    v_sub_f32 v28, v28, v50
    v_sub_f32 v29, v29, v50
    v_mfma_f32_16x16x32_bf16 v[136:139], v[72:75], a[164:167], v[136:139]
    buffer_load_dwordx4 v235, s[48:51], s33 offen offset:1024 lds
    v_cvt_pk_bf16_f32 v29, v28, v29
    v_mfma_f32_16x16x32_bf16 v[140:143], v[76:79], a[164:167], v[140:143]
    v_lshlrev_b32 v28, 16, v29
    v_and_b32 v29, 0xffff0000, v29
    v_mfma_f32_16x16x32_bf16 v[144:147], v[72:75], a[168:171], v[144:147]
    s_add_u32 m0, s35, 14336
    s_add_u32 s33, s33, 131072
    buffer_load_dwordx4 v234, s[48:51], s33 offen lds
    v_mfma_f32_16x16x32_bf16 v[148:151], v[76:79], a[168:171], v[148:151]
    v_mul_f32 v28, v28, v51
    v_mul_f32 v29, v29, v51
    v_mfma_f32_16x16x32_bf16 v[152:155], v[72:75], a[172:175], v[152:155]
    buffer_load_dwordx4 v235, s[48:51], s33 offen offset:1024 lds
    v_cvt_pk_bf16_f32 v6, v28, v29
    v_mfma_f32_16x16x32_bf16 v[156:159], v[76:79], a[172:175], v[156:159]
    v_sub_f32 v30, v30, v50
    s_waitcnt lgkmcnt(0)
    v_mfma_f32_16x16x32_bf16 v[160:163], v[80:83], a[160:163], v[160:163]
    ds_read_b128 v[64:67], v225 offset:16384
    v_sub_f32 v31, v31, v50
    v_mfma_f32_16x16x32_bf16 v[164:167], v[84:87], a[160:163], v[164:167]
    ds_read_b128 v[68:71], v225 offset:18432
    v_cvt_pk_bf16_f32 v31, v30, v31
    v_mfma_f32_16x16x32_bf16 v[168:171], v[80:83], a[164:167], v[168:171]
    ds_read_b128 v[72:75], v225 offset:20480
    v_lshlrev_b32 v30, 16, v31
    v_mfma_f32_16x16x32_bf16 v[172:175], v[84:87], a[164:167], v[172:175]
    ds_read_b128 v[76:79], v225 offset:22528
    v_and_b32 v31, 0xffff0000, v31
    v_mfma_f32_16x16x32_bf16 v[176:179], v[80:83], a[168:171], v[176:179]
    ds_read_b64_tr_b16 a[184:185], v230 offset:20480
    v_mul_f32 v30, v30, v51
    v_mfma_f32_16x16x32_bf16 v[180:183], v[84:87], a[168:171], v[180:183]
    ds_read_b64_tr_b16 a[186:187], v230 offset:20992
    v_mul_f32 v31, v31, v51
    v_mfma_f32_16x16x32_bf16 v[184:187], v[80:83], a[172:175], v[184:187]
    ds_read_b64_tr_b16 a[188:189], v231 offset:20480
    v_cvt_pk_bf16_f32 v7, v30, v31
    v_mfma_f32_16x16x32_bf16 v[188:191], v[84:87], a[172:175], v[188:191]
    ds_read_b64_tr_b16 a[190:191], v231 offset:20992
    v_sub_f32 v32, v32, v50
    v_mfma_f32_16x16x32_bf16 v[192:195], v[88:91], a[160:163], v[192:195]
    s_add_u32 m0, s34, 8192
    s_add_u32 s37, s81, 131072
    buffer_load_dwordx4 v232, s[44:47], s37 offen lds
    v_mfma_f32_16x16x32_bf16 v[196:199], v[92:95], a[160:163], v[196:199]
    v_sub_f32 v33, v33, v50
    v_cvt_pk_bf16_f32 v33, v32, v33
    v_mfma_f32_16x16x32_bf16 v[200:203], v[88:91], a[164:167], v[200:203]
    v_lshlrev_b32 v32, 16, v33
    v_and_b32 v33, 0xffff0000, v33
    v_mfma_f32_16x16x32_bf16 v[204:207], v[92:95], a[164:167], v[204:207]
    v_mul_f32 v32, v32, v51
    v_mul_f32 v33, v33, v51
    v_mfma_f32_16x16x32_bf16 v[208:211], v[88:91], a[168:171], v[208:211]
    buffer_load_dwordx4 v233, s[44:47], s37 offen offset:1024 lds
    v_cvt_pk_bf16_f32 v8, v32, v33
    v_mfma_f32_16x16x32_bf16 v[212:215], v[92:95], a[168:171], v[212:215]
    v_sub_f32 v34, v34, v50
    v_sub_f32 v35, v35, v50
    v_mfma_f32_16x16x32_bf16 v[216:219], v[88:91], a[172:175], v[216:219]
    v_cvt_pk_bf16_f32 v35, v34, v35
    v_lshlrev_b32 v34, 16, v35
    v_mfma_f32_16x16x32_bf16 v[220:223], v[92:95], a[172:175], v[220:223]
    v_and_b32 v35, 0xffff0000, v35
    v_mul_f32 v34, v34, v51
    s_waitcnt vmcnt(14) lgkmcnt(0)
    v_mfma_f32_16x16x32_bf16 v[96:99], v[64:67], a[176:179], v[96:99]
    ds_read_b128 v[80:83], v225 offset:24576
    v_mul_f32 v35, v35, v51
    v_mfma_f32_16x16x32_bf16 v[100:103], v[68:71], a[176:179], v[100:103]
    ds_read_b128 v[84:87], v225 offset:26624
    v_cvt_pk_bf16_f32 v9, v34, v35
    v_mfma_f32_16x16x32_bf16 v[104:107], v[64:67], a[180:183], v[104:107]
    ds_read_b128 v[88:91], v225 offset:28672
    v_sub_f32 v36, v36, v50
    v_mfma_f32_16x16x32_bf16 v[108:111], v[68:71], a[180:183], v[108:111]
    ds_read_b128 v[92:95], v225 offset:30720
    v_sub_f32 v37, v37, v50
    v_mfma_f32_16x16x32_bf16 v[112:115], v[64:67], a[184:187], v[112:115]
    ds_read_b64_tr_b16 a[192:193], v228 offset:0
    v_cvt_pk_bf16_f32 v37, v36, v37
    v_mfma_f32_16x16x32_bf16 v[116:119], v[68:71], a[184:187], v[116:119]
    ds_read_b64_tr_b16 a[194:195], v228 offset:512
    v_lshlrev_b32 v36, 16, v37
    v_mfma_f32_16x16x32_bf16 v[120:123], v[64:67], a[188:191], v[120:123]
    ds_read_b64_tr_b16 a[196:197], v229 offset:0
    v_and_b32 v37, 0xffff0000, v37
    v_mfma_f32_16x16x32_bf16 v[124:127], v[68:71], a[188:191], v[124:127]
    ds_read_b64_tr_b16 a[198:199], v229 offset:512
    v_mul_f32 v36, v36, v51
    v_mfma_f32_16x16x32_bf16 v[128:131], v[72:75], a[176:179], v[128:131]
    v_mul_f32 v37, v37, v51
    v_cvt_pk_bf16_f32 v10, v36, v37
    v_mfma_f32_16x16x32_bf16 v[132:135], v[76:79], a[176:179], v[132:135]
    v_sub_f32 v38, v38, v50
    v_sub_f32 v39, v39, v50
    v_mfma_f32_16x16x32_bf16 v[136:139], v[72:75], a[180:183], v[136:139]
    v_cvt_pk_bf16_f32 v39, v38, v39
    v_lshlrev_b32 v38, 16, v39
    v_mfma_f32_16x16x32_bf16 v[140:143], v[76:79], a[180:183], v[140:143]
    v_and_b32 v39, 0xffff0000, v39
    v_mul_f32 v38, v38, v51
    v_mfma_f32_16x16x32_bf16 v[144:147], v[72:75], a[184:187], v[144:147]
    v_mul_f32 v39, v39, v51
    v_cvt_pk_bf16_f32 v11, v38, v39
    v_mfma_f32_16x16x32_bf16 v[148:151], v[76:79], a[184:187], v[148:151]
    v_sub_f32 v40, v40, v50
    v_sub_f32 v41, v41, v50
    v_mfma_f32_16x16x32_bf16 v[152:155], v[72:75], a[188:191], v[152:155]
    v_cvt_pk_bf16_f32 v41, v40, v41
    v_lshlrev_b32 v40, 16, v41
    v_mfma_f32_16x16x32_bf16 v[156:159], v[76:79], a[188:191], v[156:159]
    s_waitcnt vmcnt(24) lgkmcnt(0)
    s_barrier
    v_mfma_f32_16x16x32_bf16 v[160:163], v[80:83], a[176:179], v[160:163]
    ds_read_b128 v[64:67], v224 offset:32768
    v_and_b32 v41, 0xffff0000, v41
    v_mfma_f32_16x16x32_bf16 v[164:167], v[84:87], a[176:179], v[164:167]
    ds_read_b128 v[68:71], v224 offset:34816
    v_mul_f32 v40, v40, v51
    v_mfma_f32_16x16x32_bf16 v[168:171], v[80:83], a[180:183], v[168:171]
    ds_read_b128 v[72:75], v224 offset:36864
    v_mul_f32 v41, v41, v51
    v_mfma_f32_16x16x32_bf16 v[172:175], v[84:87], a[180:183], v[172:175]
    ds_read_b128 v[76:79], v224 offset:38912
    v_cvt_pk_bf16_f32 v12, v40, v41
    v_mfma_f32_16x16x32_bf16 v[176:179], v[80:83], a[184:187], v[176:179]
    ds_read_b64_tr_b16 a[200:201], v230 offset:0
    v_sub_f32 v42, v42, v50
    v_mfma_f32_16x16x32_bf16 v[180:183], v[84:87], a[184:187], v[180:183]
    ds_read_b64_tr_b16 a[202:203], v230 offset:512
    v_sub_f32 v43, v43, v50
    v_mfma_f32_16x16x32_bf16 v[184:187], v[80:83], a[188:191], v[184:187]
    ds_read_b64_tr_b16 a[204:205], v231 offset:0
    v_cvt_pk_bf16_f32 v43, v42, v43
    v_mfma_f32_16x16x32_bf16 v[188:191], v[84:87], a[188:191], v[188:191]
    ds_read_b64_tr_b16 a[206:207], v231 offset:512
    v_lshlrev_b32 v42, 16, v43
    v_mfma_f32_16x16x32_bf16 v[192:195], v[88:91], a[176:179], v[192:195]
    s_add_u32 m0, s34, 16384
    s_add_u32 s37, s82, 131072
    buffer_load_dwordx4 v232, s[44:47], s37 offen lds
    v_mfma_f32_16x16x32_bf16 v[196:199], v[92:95], a[176:179], v[196:199]
    v_and_b32 v43, 0xffff0000, v43
    v_mul_f32 v42, v42, v51
    v_mfma_f32_16x16x32_bf16 v[200:203], v[88:91], a[180:183], v[200:203]
    v_mul_f32 v43, v43, v51
    v_cvt_pk_bf16_f32 v13, v42, v43
    v_mfma_f32_16x16x32_bf16 v[204:207], v[92:95], a[180:183], v[204:207]
    v_sub_f32 v44, v44, v50
    v_sub_f32 v45, v45, v50
    v_mfma_f32_16x16x32_bf16 v[208:211], v[88:91], a[184:187], v[208:211]
    buffer_load_dwordx4 v233, s[44:47], s37 offen offset:1024 lds
    v_cvt_pk_bf16_f32 v45, v44, v45
    v_mfma_f32_16x16x32_bf16 v[212:215], v[92:95], a[184:187], v[212:215]
    v_lshlrev_b32 v44, 16, v45
    v_and_b32 v45, 0xffff0000, v45
    v_mfma_f32_16x16x32_bf16 v[216:219], v[88:91], a[188:191], v[216:219]
    v_mul_f32 v44, v44, v51
    v_mul_f32 v45, v45, v51
    v_mfma_f32_16x16x32_bf16 v[220:223], v[92:95], a[188:191], v[220:223]
    v_cvt_pk_bf16_f32 v14, v44, v45
    s_waitcnt lgkmcnt(0)
    v_mfma_f32_16x16x32_bf16 v[96:99], v[64:67], a[192:195], v[96:99]
    ds_read_b128 v[80:83], v224 offset:40960
    v_sub_f32 v46, v46, v50
    v_mfma_f32_16x16x32_bf16 v[100:103], v[68:71], a[192:195], v[100:103]
    ds_read_b128 v[84:87], v224 offset:43008
    v_sub_f32 v47, v47, v50
    v_mfma_f32_16x16x32_bf16 v[104:107], v[64:67], a[196:199], v[104:107]
    ds_read_b128 v[88:91], v224 offset:45056
    v_cvt_pk_bf16_f32 v47, v46, v47
    v_mfma_f32_16x16x32_bf16 v[108:111], v[68:71], a[196:199], v[108:111]
    ds_read_b128 v[92:95], v224 offset:47104
    v_lshlrev_b32 v46, 16, v47
    v_mfma_f32_16x16x32_bf16 v[112:115], v[64:67], a[200:203], v[112:115]
    ds_read_b64_tr_b16 a[208:209], v228 offset:4096
    v_and_b32 v47, 0xffff0000, v47
    v_mfma_f32_16x16x32_bf16 v[116:119], v[68:71], a[200:203], v[116:119]
    ds_read_b64_tr_b16 a[210:211], v228 offset:4608
    v_mul_f32 v46, v46, v51
    v_mfma_f32_16x16x32_bf16 v[120:123], v[64:67], a[204:207], v[120:123]
    ds_read_b64_tr_b16 a[212:213], v229 offset:4096
    v_mul_f32 v47, v47, v51
    v_mfma_f32_16x16x32_bf16 v[124:127], v[68:71], a[204:207], v[124:127]
    ds_read_b64_tr_b16 a[214:215], v229 offset:4608
    v_cvt_pk_bf16_f32 v15, v46, v47
    v_mfma_f32_16x16x32_bf16 v[128:131], v[72:75], a[192:195], v[128:131]
    v_mfma_f32_16x16x32_bf16 v[132:135], v[76:79], a[192:195], v[132:135]
    ds_write_b128 v237, v[0:3] offset:0
    v_mfma_f32_16x16x32_bf16 v[136:139], v[72:75], a[196:199], v[136:139]
    ds_write_b128 v237, v[4:7] offset:4096
    v_mfma_f32_16x16x32_bf16 v[140:143], v[76:79], a[196:199], v[140:143]
    ds_write_b128 v237, v[8:11] offset:24576
    v_mfma_f32_16x16x32_bf16 v[144:147], v[72:75], a[200:203], v[144:147]
    ds_write_b128 v237, v[12:15] offset:28672
    v_mfma_f32_16x16x32_bf16 v[148:151], v[76:79], a[200:203], v[148:151]
    v_mfma_f32_16x16x32_bf16 v[152:155], v[72:75], a[204:207], v[152:155]
    v_mfma_f32_16x16x32_bf16 v[156:159], v[76:79], a[204:207], v[156:159]
    s_waitcnt lgkmcnt(0)
    v_mfma_f32_16x16x32_bf16 v[160:163], v[80:83], a[192:195], v[160:163]
    ds_read_b128 v[64:67], v225 offset:32768
    v_mfma_f32_16x16x32_bf16 v[164:167], v[84:87], a[192:195], v[164:167]
    ds_read_b128 v[68:71], v225 offset:34816
    v_mfma_f32_16x16x32_bf16 v[168:171], v[80:83], a[196:199], v[168:171]
    ds_read_b128 v[72:75], v225 offset:36864
    v_mfma_f32_16x16x32_bf16 v[172:175], v[84:87], a[196:199], v[172:175]
    ds_read_b128 v[76:79], v225 offset:38912
    v_mfma_f32_16x16x32_bf16 v[176:179], v[80:83], a[200:203], v[176:179]
    ds_read_b64_tr_b16 a[216:217], v230 offset:4096
    v_mfma_f32_16x16x32_bf16 v[180:183], v[84:87], a[200:203], v[180:183]
    ds_read_b64_tr_b16 a[218:219], v230 offset:4608
    v_mfma_f32_16x16x32_bf16 v[184:187], v[80:83], a[204:207], v[184:187]
    ds_read_b64_tr_b16 a[220:221], v231 offset:4096
    v_mfma_f32_16x16x32_bf16 v[188:191], v[84:87], a[204:207], v[188:191]
    ds_read_b64_tr_b16 a[222:223], v231 offset:4608
    v_mfma_f32_16x16x32_bf16 v[192:195], v[88:91], a[192:195], v[192:195]
    s_add_u32 m0, s34, 24576
    s_add_u32 s37, s83, 131072
    buffer_load_dwordx4 v232, s[44:47], s37 offen lds
    v_mfma_f32_16x16x32_bf16 v[196:199], v[92:95], a[192:195], v[196:199]
    v_mfma_f32_16x16x32_bf16 v[200:203], v[88:91], a[196:199], v[200:203]
    buffer_load_dwordx4 v233, s[44:47], s37 offen offset:1024 lds
    v_mfma_f32_16x16x32_bf16 v[204:207], v[92:95], a[196:199], v[204:207]
    v_mfma_f32_16x16x32_bf16 v[208:211], v[88:91], a[200:203], v[208:211]
    v_mfma_f32_16x16x32_bf16 v[212:215], v[92:95], a[200:203], v[212:215]
    buffer_load_dword v254, off, s[88:91], s97 sc1
    v_mfma_f32_16x16x32_bf16 v[216:219], v[88:91], a[204:207], v[216:219]
    v_mfma_f32_16x16x32_bf16 v[220:223], v[92:95], a[204:207], v[220:223]
    s_waitcnt vmcnt(7) lgkmcnt(0)
    v_mfma_f32_16x16x32_bf16 v[96:99], v[64:67], a[208:211], v[96:99]
    ds_read_b128 v[80:83], v225 offset:40960
    v_mfma_f32_16x16x32_bf16 v[100:103], v[68:71], a[208:211], v[100:103]
    ds_read_b128 v[84:87], v225 offset:43008
    s_mul_i32 s38, s2, 100
    v_mfma_f32_16x16x32_bf16 v[104:107], v[64:67], a[212:215], v[104:107]
    ds_read_b128 v[88:91], v225 offset:45056
    v_mfma_f32_16x16x32_bf16 v[108:111], v[68:71], a[212:215], v[108:111]
    ds_read_b128 v[92:95], v225 offset:47104
    v_mfma_f32_16x16x32_bf16 v[112:115], v[64:67], a[216:219], v[112:115]
    ds_read_b64_tr_b16 a[224:225], v228 offset:8192
    v_lshl_add_u32 v60, v253, 2, s38
    v_mfma_f32_16x16x32_bf16 v[116:119], v[68:71], a[216:219], v[116:119]
    ds_read_b64_tr_b16 a[226:227], v228 offset:8704
    v_mfma_f32_16x16x32_bf16 v[120:123], v[64:67], a[220:223], v[120:123]
    ds_read_b64_tr_b16 a[228:229], v229 offset:8192
    v_mfma_f32_16x16x32_bf16 v[124:127], v[68:71], a[220:223], v[124:127]
    ds_read_b64_tr_b16 a[230:231], v229 offset:8704
    v_cmp_gt_u32 vcc, 25, v253
    v_mfma_f32_16x16x32_bf16 v[128:131], v[72:75], a[208:211], v[128:131]
    v_mov_b32 v61, 0
    v_mfma_f32_16x16x32_bf16 v[132:135], v[76:79], a[208:211], v[132:135]
    v_mfma_f32_16x16x32_bf16 v[136:139], v[72:75], a[212:215], v[136:139]
    v_mov_b32 v62, 0x7ffffff0
    v_mfma_f32_16x16x32_bf16 v[140:143], v[76:79], a[212:215], v[140:143]
    v_cndmask_b32 v60, v62, v60, vcc
    v_mfma_f32_16x16x32_bf16 v[144:147], v[72:75], a[216:219], v[144:147]
    v_mfma_f32_16x16x32_bf16 v[148:151], v[76:79], a[216:219], v[148:151]
    buffer_store_dword v61, v60, s[56:59], 0 offen sc1
    v_mfma_f32_16x16x32_bf16 v[152:155], v[72:75], a[220:223], v[152:155]
    v_mfma_f32_16x16x32_bf16 v[156:159], v[76:79], a[220:223], v[156:159]
    s_waitcnt vmcnt(18) lgkmcnt(0)
    s_barrier
    v_mfma_f32_16x16x32_bf16 v[160:163], v[80:83], a[208:211], v[160:163]
    ds_read_b128 v[64:67], v224 offset:49152
    v_mfma_f32_16x16x32_bf16 v[164:167], v[84:87], a[208:211], v[164:167]
    ds_read_b128 v[68:71], v224 offset:51200
    v_mfma_f32_16x16x32_bf16 v[168:171], v[80:83], a[212:215], v[168:171]
    ds_read_b128 v[72:75], v224 offset:53248
    v_mfma_f32_16x16x32_bf16 v[172:175], v[84:87], a[212:215], v[172:175]
    ds_read_b128 v[76:79], v224 offset:55296
    v_mfma_f32_16x16x32_bf16 v[176:179], v[80:83], a[216:219], v[176:179]
    ds_read_b64_tr_b16 a[232:233], v230 offset:8192
    v_mfma_f32_16x16x32_bf16 v[180:183], v[84:87], a[216:219], v[180:183]
    ds_read_b64_tr_b16 a[234:235], v230 offset:8704
    v_mfma_f32_16x16x32_bf16 v[184:187], v[80:83], a[220:223], v[184:187]
    ds_read_b64_tr_b16 a[236:237], v231 offset:8192
    v_mfma_f32_16x16x32_bf16 v[188:191], v[84:87], a[220:223], v[188:191]
    ds_read_b64_tr_b16 a[238:239], v231 offset:8704
    v_mfma_f32_16x16x32_bf16 v[192:195], v[88:91], a[208:211], v[192:195]
    v_lshlrev_b32 v237, 4, v253
    v_add_u32 v237, 81920, v237
    ds_read_b128 v[16:19], v237 offset:0
    ds_read_b128 v[20:23], v237 offset:4096
    ds_read_b128 v[24:27], v237 offset:24576
    ds_read_b128 v[28:31], v237 offset:28672
    s_add_u32 m0, s34, 32768
    s_add_u32 s37, s84, 131072
    buffer_load_dwordx4 v232, s[44:47], s37 offen lds
    v_mfma_f32_16x16x32_bf16 v[196:199], v[92:95], a[208:211], v[196:199]
    v_mfma_f32_16x16x32_bf16 v[200:203], v[88:91], a[212:215], v[200:203]
    v_mfma_f32_16x16x32_bf16 v[204:207], v[92:95], a[212:215], v[204:207]
    v_mfma_f32_16x16x32_bf16 v[208:211], v[88:91], a[216:219], v[208:211]
    buffer_load_dwordx4 v233, s[44:47], s37 offen offset:1024 lds
    v_mfma_f32_16x16x32_bf16 v[212:215], v[92:95], a[216:219], v[212:215]
    v_mfma_f32_16x16x32_bf16 v[216:219], v[88:91], a[220:223], v[216:219]
    v_mfma_f32_16x16x32_bf16 v[220:223], v[92:95], a[220:223], v[220:223]
    s_waitcnt lgkmcnt(0)
    v_mfma_f32_16x16x32_bf16 v[96:99], v[64:67], a[224:227], v[96:99]
    ds_read_b128 v[80:83], v224 offset:57344
    v_mfma_f32_16x16x32_bf16 v[100:103], v[68:71], a[224:227], v[100:103]
    ds_read_b128 v[84:87], v224 offset:59392
    v_mfma_f32_16x16x32_bf16 v[104:107], v[64:67], a[228:231], v[104:107]
    ds_read_b128 v[88:91], v224 offset:61440
    v_mfma_f32_16x16x32_bf16 v[108:111], v[68:71], a[228:231], v[108:111]
    ds_read_b128 v[92:95], v224 offset:63488
    v_mfma_f32_16x16x32_bf16 v[112:115], v[64:67], a[232:235], v[112:115]
    ds_read_b64_tr_b16 a[240:241], v228 offset:12288
    v_mfma_f32_16x16x32_bf16 v[116:119], v[68:71], a[232:235], v[116:119]
    ds_read_b64_tr_b16 a[242:243], v228 offset:12800
    s_mov_b32 s39, 0
    buffer_store_dwordx4 v[16:19], v238, s[8:11], s39 offen sc1
    v_mfma_f32_16x16x32_bf16 v[120:123], v[64:67], a[236:239], v[120:123]
    ds_read_b64_tr_b16 a[244:245], v229 offset:12288
    v_mfma_f32_16x16x32_bf16 v[124:127], v[68:71], a[236:239], v[124:127]
    ds_read_b64_tr_b16 a[246:247], v229 offset:12800
    v_mfma_f32_16x16x32_bf16 v[128:131], v[72:75], a[224:227], v[128:131]
    v_mfma_f32_16x16x32_bf16 v[132:135], v[76:79], a[224:227], v[132:135]
    v_mfma_f32_16x16x32_bf16 v[136:139], v[72:75], a[228:231], v[136:139]
    v_mfma_f32_16x16x32_bf16 v[140:143], v[76:79], a[228:231], v[140:143]
    v_mfma_f32_16x16x32_bf16 v[144:147], v[72:75], a[232:235], v[144:147]
    v_mfma_f32_16x16x32_bf16 v[148:151], v[76:79], a[232:235], v[148:151]
    s_mov_b32 s39, 8192
    buffer_store_dwordx4 v[20:23], v238, s[8:11], s39 offen sc1
    v_mfma_f32_16x16x32_bf16 v[152:155], v[72:75], a[236:239], v[152:155]
    v_mfma_f32_16x16x32_bf16 v[156:159], v[76:79], a[236:239], v[156:159]
    s_waitcnt lgkmcnt(0)
    v_mfma_f32_16x16x32_bf16 v[160:163], v[80:83], a[224:227], v[160:163]
    ds_read_b128 v[64:67], v225 offset:49152
    v_mfma_f32_16x16x32_bf16 v[164:167], v[84:87], a[224:227], v[164:167]
    ds_read_b128 v[68:71], v225 offset:51200
    v_mfma_f32_16x16x32_bf16 v[168:171], v[80:83], a[228:231], v[168:171]
    ds_read_b128 v[72:75], v225 offset:53248
    v_mfma_f32_16x16x32_bf16 v[172:175], v[84:87], a[228:231], v[172:175]
    ds_read_b128 v[76:79], v225 offset:55296
    v_mfma_f32_16x16x32_bf16 v[176:179], v[80:83], a[232:235], v[176:179]
    ds_read_b64_tr_b16 a[248:249], v230 offset:12288
    v_mfma_f32_16x16x32_bf16 v[180:183], v[84:87], a[232:235], v[180:183]
    ds_read_b64_tr_b16 a[250:251], v230 offset:12800
    s_mov_b32 s39, 16384
    buffer_store_dwordx4 v[24:27], v238, s[8:11], s39 offen sc1
    v_mfma_f32_16x16x32_bf16 v[184:187], v[80:83], a[236:239], v[184:187]
    ds_read_b64_tr_b16 a[252:253], v231 offset:12288
    v_mfma_f32_16x16x32_bf16 v[188:191], v[84:87], a[236:239], v[188:191]
    ds_read_b64_tr_b16 a[254:255], v231 offset:12800
    v_mfma_f32_16x16x32_bf16 v[192:195], v[88:91], a[224:227], v[192:195]
    s_add_u32 m0, s34, 40960
    s_add_u32 s37, s85, 131072
    buffer_load_dwordx4 v232, s[44:47], s37 offen lds
    v_mfma_f32_16x16x32_bf16 v[196:199], v[92:95], a[224:227], v[196:199]
    v_mfma_f32_16x16x32_bf16 v[200:203], v[88:91], a[228:231], v[200:203]
    v_mfma_f32_16x16x32_bf16 v[204:207], v[92:95], a[228:231], v[204:207]
    v_mfma_f32_16x16x32_bf16 v[208:211], v[88:91], a[232:235], v[208:211]
    buffer_load_dwordx4 v233, s[44:47], s37 offen offset:1024 lds
    v_mfma_f32_16x16x32_bf16 v[212:215], v[92:95], a[232:235], v[212:215]
    s_mov_b32 s39, 24576
    buffer_store_dwordx4 v[28:31], v238, s[8:11], s39 offen sc1
    v_mfma_f32_16x16x32_bf16 v[216:219], v[88:91], a[236:239], v[216:219]
    v_mfma_f32_16x16x32_bf16 v[220:223], v[92:95], a[236:239], v[220:223]
    s_waitcnt lgkmcnt(0)
    v_mfma_f32_16x16x32_bf16 v[96:99], v[64:67], a[240:243], v[96:99]
    ds_read_b128 v[80:83], v225 offset:57344
    v_mfma_f32_16x16x32_bf16 v[100:103], v[68:71], a[240:243], v[100:103]
    ds_read_b128 v[84:87], v225 offset:59392
    v_mfma_f32_16x16x32_bf16 v[104:107], v[64:67], a[244:247], v[104:107]
    ds_read_b128 v[88:91], v225 offset:61440
    v_mfma_f32_16x16x32_bf16 v[108:111], v[68:71], a[244:247], v[108:111]
    ds_read_b128 v[92:95], v225 offset:63488
    v_mfma_f32_16x16x32_bf16 v[112:115], v[64:67], a[248:251], v[112:115]
    v_mfma_f32_16x16x32_bf16 v[116:119], v[68:71], a[248:251], v[116:119]
    v_mfma_f32_16x16x32_bf16 v[120:123], v[64:67], a[252:255], v[120:123]
    v_mfma_f32_16x16x32_bf16 v[124:127], v[68:71], a[252:255], v[124:127]
    v_mfma_f32_16x16x32_bf16 v[128:131], v[72:75], a[240:243], v[128:131]
    v_mfma_f32_16x16x32_bf16 v[132:135], v[76:79], a[240:243], v[132:135]
    v_cvt_pk_bf16_f32 v0, v96, v97
    v_cvt_pk_bf16_f32 v1, v98, v99
    v_mfma_f32_16x16x32_bf16 v[136:139], v[72:75], a[244:247], v[136:139]
    v_cvt_pk_bf16_f32 v2, v100, v101
    v_cvt_pk_bf16_f32 v3, v102, v103
    v_mfma_f32_16x16x32_bf16 v[140:143], v[76:79], a[244:247], v[140:143]
    v_cvt_pk_bf16_f32 v4, v104, v105
    v_cvt_pk_bf16_f32 v5, v106, v107
    v_mfma_f32_16x16x32_bf16 v[144:147], v[72:75], a[248:251], v[144:147]
    v_cvt_pk_bf16_f32 v6, v108, v109
    v_cvt_pk_bf16_f32 v7, v110, v111
    v_mfma_f32_16x16x32_bf16 v[148:151], v[76:79], a[248:251], v[148:151]
    v_cvt_pk_bf16_f32 v8, v112, v113
    v_cvt_pk_bf16_f32 v9, v114, v115
    v_mfma_f32_16x16x32_bf16 v[152:155], v[72:75], a[252:255], v[152:155]
    v_cvt_pk_bf16_f32 v10, v116, v117
    v_cvt_pk_bf16_f32 v11, v118, v119
    v_mfma_f32_16x16x32_bf16 v[156:159], v[76:79], a[252:255], v[156:159]
    v_cvt_pk_bf16_f32 v12, v120, v121
    v_cvt_pk_bf16_f32 v13, v122, v123
    s_waitcnt vmcnt(14) lgkmcnt(0)
    s_barrier
    v_mfma_f32_16x16x32_bf16 v[160:163], v[80:83], a[240:243], v[160:163]
    ds_read_b128 v[64:67], v224 offset:0
    v_cvt_pk_bf16_f32 v14, v124, v125
    v_cvt_pk_bf16_f32 v15, v126, v127
    v_mfma_f32_16x16x32_bf16 v[164:167], v[84:87], a[240:243], v[164:167]
    ds_read_b128 v[68:71], v224 offset:2048
    v_cvt_pk_bf16_f32 v16, v128, v129
    v_cvt_pk_bf16_f32 v17, v130, v131
    v_mfma_f32_16x16x32_bf16 v[168:171], v[80:83], a[244:247], v[168:171]
    ds_read_b128 v[72:75], v224 offset:4096
    v_cvt_pk_bf16_f32 v18, v132, v133
    v_cvt_pk_bf16_f32 v19, v134, v135
    v_mfma_f32_16x16x32_bf16 v[172:175], v[84:87], a[244:247], v[172:175]
    ds_read_b128 v[76:79], v224 offset:6144
    v_cvt_pk_bf16_f32 v20, v136, v137
    v_cvt_pk_bf16_f32 v21, v138, v139
    v_mfma_f32_16x16x32_bf16 v[176:179], v[80:83], a[248:251], v[176:179]
    v_cvt_pk_bf16_f32 v22, v140, v141
    v_cvt_pk_bf16_f32 v23, v142, v143
    v_mfma_f32_16x16x32_bf16 v[180:183], v[84:87], a[248:251], v[180:183]
    v_cvt_pk_bf16_f32 v24, v144, v145
    v_cvt_pk_bf16_f32 v25, v146, v147
    v_mfma_f32_16x16x32_bf16 v[184:187], v[80:83], a[252:255], v[184:187]
    v_cvt_pk_bf16_f32 v26, v148, v149
    v_cvt_pk_bf16_f32 v27, v150, v151
    v_mfma_f32_16x16x32_bf16 v[188:191], v[84:87], a[252:255], v[188:191]
    v_cvt_pk_bf16_f32 v28, v152, v153
    v_cvt_pk_bf16_f32 v29, v154, v155
    v_mfma_f32_16x16x32_bf16 v[192:195], v[88:91], a[240:243], v[192:195]
    s_add_u32 m0, s34, 49152
    s_add_u32 s37, s86, 131072
    buffer_load_dwordx4 v232, s[44:47], s37 offen lds
    v_cvt_pk_bf16_f32 v30, v156, v157
    v_cvt_pk_bf16_f32 v31, v158, v159
    v_mfma_f32_16x16x32_bf16 v[196:199], v[92:95], a[240:243], v[196:199]
    v_cvt_pk_bf16_f32 v32, v160, v161
    v_cvt_pk_bf16_f32 v33, v162, v163
    v_mfma_f32_16x16x32_bf16 v[200:203], v[88:91], a[244:247], v[200:203]
    v_cvt_pk_bf16_f32 v34, v164, v165
    v_cvt_pk_bf16_f32 v35, v166, v167
    v_mfma_f32_16x16x32_bf16 v[204:207], v[92:95], a[244:247], v[204:207]
    v_cvt_pk_bf16_f32 v36, v168, v169
    v_cvt_pk_bf16_f32 v37, v170, v171
    v_mfma_f32_16x16x32_bf16 v[208:211], v[88:91], a[248:251], v[208:211]
    buffer_load_dwordx4 v233, s[44:47], s37 offen offset:1024 lds
    v_cvt_pk_bf16_f32 v38, v172, v173
    v_cvt_pk_bf16_f32 v39, v174, v175
    v_mfma_f32_16x16x32_bf16 v[212:215], v[92:95], a[248:251], v[212:215]
    v_cvt_pk_bf16_f32 v40, v176, v177
    v_cvt_pk_bf16_f32 v41, v178, v179
    v_mfma_f32_16x16x32_bf16 v[216:219], v[88:91], a[252:255], v[216:219]
    v_cvt_pk_bf16_f32 v42, v180, v181
    v_cvt_pk_bf16_f32 v43, v182, v183
    v_mfma_f32_16x16x32_bf16 v[220:223], v[92:95], a[252:255], v[220:223]
    v_cvt_pk_bf16_f32 v44, v184, v185
    v_cvt_pk_bf16_f32 v45, v186, v187
    s_waitcnt lgkmcnt(0)
    v_mfma_f32_16x16x32_bf16 v[96:99], v[64:67], a[0:3], 0
    ds_read_b128 v[80:83], v225 offset:0
    v_cvt_pk_bf16_f32 v46, v188, v189
    v_cvt_pk_bf16_f32 v47, v190, v191
    v_mfma_f32_16x16x32_bf16 v[100:103], v[68:71], a[0:3], 0
    ds_read_b128 v[84:87], v225 offset:2048
    v_cvt_pk_bf16_f32 v48, v192, v193
    v_cvt_pk_bf16_f32 v49, v194, v195
    v_mfma_f32_16x16x32_bf16 v[104:107], v[64:67], a[4:7], 0
    ds_read_b128 v[88:91], v225 offset:4096
    v_cvt_pk_bf16_f32 v50, v196, v197
    v_cvt_pk_bf16_f32 v51, v198, v199
    v_mfma_f32_16x16x32_bf16 v[108:111], v[68:71], a[4:7], 0
    ds_read_b128 v[92:95], v225 offset:6144
    v_cvt_pk_bf16_f32 v52, v200, v201
    v_cvt_pk_bf16_f32 v53, v202, v203
    v_mfma_f32_16x16x32_bf16 v[112:115], v[64:67], a[8:11], 0
    v_cvt_pk_bf16_f32 v54, v204, v205
    v_cvt_pk_bf16_f32 v55, v206, v207
    s_add_u32 s38, s36, 0
    buffer_store_dwordx4 v[0:3], v240, s[16:19], s38 offen offset:0 sc1
    v_mfma_f32_16x16x32_bf16 v[116:119], v[68:71], a[8:11], 0
    v_cvt_pk_bf16_f32 v56, v208, v209
    v_cvt_pk_bf16_f32 v57, v210, v211
    v_mfma_f32_16x16x32_bf16 v[120:123], v[64:67], a[12:15], 0
    v_cvt_pk_bf16_f32 v58, v212, v213
    v_cvt_pk_bf16_f32 v59, v214, v215
    v_mfma_f32_16x16x32_bf16 v[124:127], v[68:71], a[12:15], 0
    v_cvt_pk_bf16_f32 v60, v216, v217
    v_cvt_pk_bf16_f32 v61, v218, v219
    v_mfma_f32_16x16x32_bf16 v[128:131], v[72:75], a[0:3], 0
    v_xor_b32 v237, 32, v245
    v_xor_b32 v238, 32, v246
    v_cvt_pk_bf16_f32 v62, v220, v221
    v_cvt_pk_bf16_f32 v63, v222, v223
    v_mfma_f32_16x16x32_bf16 v[132:135], v[76:79], a[0:3], 0
    v_mfma_f32_16x16x32_bf16 v[136:139], v[72:75], a[4:7], 0
    v_mfma_f32_16x16x32_bf16 v[140:143], v[76:79], a[4:7], 0
    v_mfma_f32_16x16x32_bf16 v[144:147], v[72:75], a[8:11], 0
    v_mfma_f32_16x16x32_bf16 v[148:151], v[76:79], a[8:11], 0
    v_mfma_f32_16x16x32_bf16 v[152:155], v[72:75], a[12:15], 0
    v_mfma_f32_16x16x32_bf16 v[156:159], v[76:79], a[12:15], 0
    s_waitcnt lgkmcnt(0)
    v_mfma_f32_16x16x32_bf16 v[96:99], v[80:83], a[16:19], v[96:99]
    ds_read_b128 v[64:67], v224 offset:8192
    v_mfma_f32_16x16x32_bf16 v[100:103], v[84:87], a[16:19], v[100:103]
    ds_read_b128 v[68:71], v224 offset:10240
    v_mfma_f32_16x16x32_bf16 v[104:107], v[80:83], a[20:23], v[104:107]
    ds_read_b128 v[72:75], v224 offset:12288
    v_mfma_f32_16x16x32_bf16 v[108:111], v[84:87], a[20:23], v[108:111]
    ds_read_b128 v[76:79], v224 offset:14336
    v_mfma_f32_16x16x32_bf16 v[112:115], v[80:83], a[24:27], v[112:115]
    v_mfma_f32_16x16x32_bf16 v[116:119], v[84:87], a[24:27], v[116:119]
    v_mfma_f32_16x16x32_bf16 v[120:123], v[80:83], a[28:31], v[120:123]
    v_mfma_f32_16x16x32_bf16 v[124:127], v[84:87], a[28:31], v[124:127]
    v_mfma_f32_16x16x32_bf16 v[128:131], v[88:91], a[16:19], v[128:131]
    s_add_u32 m0, s34, 57344
    s_add_u32 s37, s87, 131072
    buffer_load_dwordx4 v232, s[44:47], s37 offen lds
    v_mfma_f32_16x16x32_bf16 v[132:135], v[92:95], a[16:19], v[132:135]
    s_add_u32 s38, s36, 0
    buffer_store_dwordx4 v[4:7], v240, s[16:19], s38 offen offset:1024 sc1
    v_mfma_f32_16x16x32_bf16 v[136:139], v[88:91], a[20:23], v[136:139]
    v_mfma_f32_16x16x32_bf16 v[140:143], v[92:95], a[20:23], v[140:143]
    v_mfma_f32_16x16x32_bf16 v[144:147], v[88:91], a[24:27], v[144:147]
    buffer_load_dwordx4 v233, s[44:47], s37 offen offset:1024 lds
    v_mfma_f32_16x16x32_bf16 v[148:151], v[92:95], a[24:27], v[148:151]
    v_mfma_f32_16x16x32_bf16 v[152:155], v[88:91], a[28:31], v[152:155]
    v_mfma_f32_16x16x32_bf16 v[156:159], v[92:95], a[28:31], v[156:159]
    s_waitcnt lgkmcnt(0)
    v_mfma_f32_16x16x32_bf16 v[96:99], v[64:67], a[32:35], v[96:99]
    ds_read_b128 v[80:83], v225 offset:8192
    v_mfma_f32_16x16x32_bf16 v[100:103], v[68:71], a[32:35], v[100:103]
    ds_read_b128 v[84:87], v225 offset:10240
    v_mfma_f32_16x16x32_bf16 v[104:107], v[64:67], a[36:39], v[104:107]
    ds_read_b128 v[88:91], v225 offset:12288
    v_mfma_f32_16x16x32_bf16 v[108:111], v[68:71], a[36:39], v[108:111]
    ds_read_b128 v[92:95], v225 offset:14336
    v_mfma_f32_16x16x32_bf16 v[112:115], v[64:67], a[40:43], v[112:115]
    v_mfma_f32_16x16x32_bf16 v[116:119], v[68:71], a[40:43], v[116:119]
    v_mfma_f32_16x16x32_bf16 v[120:123], v[64:67], a[44:47], v[120:123]
    v_mfma_f32_16x16x32_bf16 v[124:127], v[68:71], a[44:47], v[124:127]
    v_mfma_f32_16x16x32_bf16 v[128:131], v[72:75], a[32:35], v[128:131]
    s_waitcnt vmcnt(15)
    v_readfirstlane_b32 s24, v254
    s_lshl_b32 s25, s3, 16
    s_add_u32 s24, s24, s25
    s_cmp_ge_u32 s24, 1
    s_cbranch_scc0 kf_spin35
kf_spinr36:
    v_mfma_f32_16x16x32_bf16 v[132:135], v[76:79], a[32:35], v[132:135]
    v_mfma_f32_16x16x32_bf16 v[136:139], v[72:75], a[36:39], v[136:139]
    v_mfma_f32_16x16x32_bf16 v[140:143], v[76:79], a[36:39], v[140:143]
    v_mfma_f32_16x16x32_bf16 v[144:147], v[72:75], a[40:43], v[144:147]
    s_add_u32 s88, s20, 0x14a0000
    s_addc_u32 s89, s21, 0
    s_mov_b32 s90, 16384
    v_mfma_f32_16x16x32_bf16 v[148:151], v[76:79], a[40:43], v[148:151]
    v_mfma_f32_16x16x32_bf16 v[152:155], v[72:75], a[44:47], v[152:155]
    v_mfma_f32_16x16x32_bf16 v[156:159], v[76:79], a[44:47], v[156:159]
    s_add_u32 s38, s36, 0
    buffer_store_dwordx4 v[8:11], v240, s[16:19], s38 offen offset:2048 sc1
    s_waitcnt vmcnt(7) lgkmcnt(0)
    s_barrier
    v_mfma_f32_16x16x32_bf16 v[96:99], v[80:83], a[48:51], v[96:99]
    ds_read_b128 v[64:67], v224 offset:16384
    v_mfma_f32_16x16x32_bf16 v[100:103], v[84:87], a[48:51], v[100:103]
    ds_read_b128 v[68:71], v224 offset:18432
    v_mfma_f32_16x16x32_bf16 v[104:107], v[80:83], a[52:55], v[104:107]
    ds_read_b128 v[72:75], v224 offset:20480
    v_mfma_f32_16x16x32_bf16 v[108:111], v[84:87], a[52:55], v[108:111]
    ds_read_b128 v[76:79], v224 offset:22528
    v_mfma_f32_16x16x32_bf16 v[112:115], v[80:83], a[56:59], v[112:115]
    v_mfma_f32_16x16x32_bf16 v[116:119], v[84:87], a[56:59], v[116:119]
    v_mfma_f32_16x16x32_bf16 v[120:123], v[80:83], a[60:63], v[120:123]
    v_mfma_f32_16x16x32_bf16 v[124:127], v[84:87], a[60:63], v[124:127]
    v_mfma_f32_16x16x32_bf16 v[128:131], v[88:91], a[48:51], v[128:131]
    s_add_u32 m0, s34, 0
    s_add_u32 s37, s80, 196608
    buffer_load_dwordx4 v232, s[44:47], s37 offen lds
    v_mfma_f32_16x16x32_bf16 v[132:135], v[92:95], a[48:51], v[132:135]
    v_mfma_f32_16x16x32_bf16 v[136:139], v[88:91], a[52:55], v[136:139]
    buffer_load_dwordx4 v233, s[44:47], s37 offen offset:1024 lds
    v_mfma_f32_16x16x32_bf16 v[140:143], v[92:95], a[52:55], v[140:143]
    v_mfma_f32_16x16x32_bf16 v[144:147], v[88:91], a[56:59], v[144:147]
    v_mfma_f32_16x16x32_bf16 v[148:151], v[92:95], a[56:59], v[148:151]
    s_lshl_b32 s39, s5, 7
    s_add_u32 s39, s39, 8192
    buffer_atomic_add v255, v250, s[88:91], s39 offen sc1
    s_cmp_eq_u32 s3, 0
    s_cselect_b32 s39, s39, s43
    v_mfma_f32_16x16x32_bf16 v[152:155], v[88:91], a[60:63], v[152:155]
    v_mfma_f32_16x16x32_bf16 v[156:159], v[92:95], a[60:63], v[156:159]
    s_waitcnt lgkmcnt(0)
    v_mfma_f32_16x16x32_bf16 v[96:99], v[64:67], a[64:67], v[96:99]
    ds_read_b128 v[80:83], v225 offset:16384
    v_mfma_f32_16x16x32_bf16 v[100:103], v[68:71], a[64:67], v[100:103]
    ds_read_b128 v[84:87], v225 offset:18432
    v_mfma_f32_16x16x32_bf16 v[104:107], v[64:67], a[68:71], v[104:107]
    ds_read_b128 v[88:91], v225 offset:20480
    v_mfma_f32_16x16x32_bf16 v[108:111], v[68:71], a[68:71], v[108:111]
    ds_read_b128 v[92:95], v225 offset:22528
    v_mfma_f32_16x16x32_bf16 v[112:115], v[64:67], a[72:75], v[112:115]
    s_add_u32 s38, s36, 0
    buffer_store_dwordx4 v[12:15], v240, s[16:19], s38 offen offset:3072 sc1
    v_mfma_f32_16x16x32_bf16 v[116:119], v[68:71], a[72:75], v[116:119]
    v_mfma_f32_16x16x32_bf16 v[120:123], v[64:67], a[76:79], v[120:123]
    v_mfma_f32_16x16x32_bf16 v[124:127], v[68:71], a[76:79], v[124:127]
    v_mfma_f32_16x16x32_bf16 v[128:131], v[72:75], a[64:67], v[128:131]
    s_add_u32 m0, s31, 0
    s_add_u32 s24, s27, 0
    buffer_load_dwordx4 v245, s[12:15], s24 offen lds
    v_mfma_f32_16x16x32_bf16 v[132:135], v[76:79], a[64:67], v[132:135]
    v_mfma_f32_16x16x32_bf16 v[136:139], v[72:75], a[68:71], v[136:139]
    v_mfma_f32_16x16x32_bf16 v[140:143], v[76:79], a[68:71], v[140:143]
    v_mfma_f32_16x16x32_bf16 v[144:147], v[72:75], a[72:75], v[144:147]
    v_mfma_f32_16x16x32_bf16 v[148:151], v[76:79], a[72:75], v[148:151]
    v_mfma_f32_16x16x32_bf16 v[152:155], v[72:75], a[76:79], v[152:155]
    v_mfma_f32_16x16x32_bf16 v[156:159], v[76:79], a[76:79], v[156:159]
    s_waitcnt lgkmcnt(0)
    v_mfma_f32_16x16x32_bf16 v[96:99], v[80:83], a[80:83], v[96:99]
    ds_read_b128 v[64:67], v224 offset:24576
    v_mfma_f32_16x16x32_bf16 v[100:103], v[84:87], a[80:83], v[100:103]
    ds_read_b128 v[68:71], v224 offset:26624
    v_mfma_f32_16x16x32_bf16 v[104:107], v[80:83], a[84:87], v[104:107]
    ds_read_b128 v[72:75], v224 offset:28672
    v_mfma_f32_16x16x32_bf16 v[108:111], v[84:87], a[84:87], v[108:111]
    ds_read_b128 v[76:79], v224 offset:30720
    v_mfma_f32_16x16x32_bf16 v[112:115], v[80:83], a[88:91], v[112:115]
    v_mfma_f32_16x16x32_bf16 v[116:119], v[84:87], a[88:91], v[116:119]
    v_mfma_f32_16x16x32_bf16 v[120:123], v[80:83], a[92:95], v[120:123]
    v_mfma_f32_16x16x32_bf16 v[124:127], v[84:87], a[92:95], v[124:127]
    v_mfma_f32_16x16x32_bf16 v[128:131], v[88:91], a[80:83], v[128:131]
    s_add_u32 m0, s34, 8192
    s_add_u32 s37, s81, 196608
    buffer_load_dwordx4 v232, s[44:47], s37 offen lds
    v_mfma_f32_16x16x32_bf16 v[132:135], v[92:95], a[80:83], v[132:135]
    v_mfma_f32_16x16x32_bf16 v[136:139], v[88:91], a[84:87], v[136:139]
    buffer_load_dwordx4 v233, s[44:47], s37 offen offset:1024 lds
    s_add_u32 s38, s36, 8192
    buffer_store_dwordx4 v[16:19], v240, s[16:19], s38 offen offset:0 sc1
    v_mfma_f32_16x16x32_bf16 v[140:143], v[92:95], a[84:87], v[140:143]
    v_mfma_f32_16x16x32_bf16 v[144:147], v[88:91], a[88:91], v[144:147]
    v_mfma_f32_16x16x32_bf16 v[148:151], v[92:95], a[88:91], v[148:151]
    s_add_u32 m0, s31, 1024
    s_add_u32 s24, s27, 32768
    buffer_load_dwordx4 v245, s[12:15], s24 offen lds
    v_mfma_f32_16x16x32_bf16 v[152:155], v[88:91], a[92:95], v[152:155]
    v_mfma_f32_16x16x32_bf16 v[156:159], v[92:95], a[92:95], v[156:159]
    s_waitcnt lgkmcnt(0)
    v_mfma_f32_16x16x32_bf16 v[96:99], v[64:67], a[96:99], v[96:99]
    ds_read_b128 v[80:83], v225 offset:24576
    v_mfma_f32_16x16x32_bf16 v[100:103], v[68:71], a[96:99], v[100:103]
    ds_read_b128 v[84:87], v225 offset:26624
    v_mfma_f32_16x16x32_bf16 v[104:107], v[64:67], a[100:103], v[104:107]
    ds_read_b128 v[88:91], v225 offset:28672
    v_mfma_f32_16x16x32_bf16 v[108:111], v[68:71], a[100:103], v[108:111]
    ds_read_b128 v[92:95], v225 offset:30720
    v_mfma_f32_16x16x32_bf16 v[112:115], v[64:67], a[104:107], v[112:115]
    v_mfma_f32_16x16x32_bf16 v[116:119], v[68:71], a[104:107], v[116:119]
    v_mfma_f32_16x16x32_bf16 v[120:123], v[64:67], a[108:111], v[120:123]
    v_mfma_f32_16x16x32_bf16 v[124:127], v[68:71], a[108:111], v[124:127]
    v_mfma_f32_16x16x32_bf16 v[128:131], v[72:75], a[96:99], v[128:131]
    s_add_u32 m0, s31, 2048
    s_add_u32 s24, s27, 65536
    buffer_load_dwordx4 v237, s[12:15], s24 offen lds
    v_mfma_f32_16x16x32_bf16 v[132:135], v[76:79], a[96:99], v[132:135]
    v_mfma_f32_16x16x32_bf16 v[136:139], v[72:75], a[100:103], v[136:139]
    v_mfma_f32_16x16x32_bf16 v[140:143], v[76:79], a[100:103], v[140:143]
    v_mfma_f32_16x16x32_bf16 v[144:147], v[72:75], a[104:107], v[144:147]
    v_mfma_f32_16x16x32_bf16 v[148:151], v[76:79], a[104:107], v[148:151]
    v_mfma_f32_16x16x32_bf16 v[152:155], v[72:75], a[108:111], v[152:155]
    v_mfma_f32_16x16x32_bf16 v[156:159], v[76:79], a[108:111], v[156:159]
    s_add_u32 s38, s36, 8192
    buffer_store_dwordx4 v[20:23], v240, s[16:19], s38 offen offset:1024 sc1
    s_waitcnt vmcnt(19) lgkmcnt(0)
    s_barrier
    v_mfma_f32_16x16x32_bf16 v[96:99], v[80:83], a[112:115], v[96:99]
    ds_read_b128 v[64:67], v224 offset:32768
    v_mfma_f32_16x16x32_bf16 v[100:103], v[84:87], a[112:115], v[100:103]
    ds_read_b128 v[68:71], v224 offset:34816
    v_mfma_f32_16x16x32_bf16 v[104:107], v[80:83], a[116:119], v[104:107]
    ds_read_b128 v[72:75], v224 offset:36864
    v_mfma_f32_16x16x32_bf16 v[108:111], v[84:87], a[116:119], v[108:111]
    ds_read_b128 v[76:79], v224 offset:38912
    v_mfma_f32_16x16x32_bf16 v[112:115], v[80:83], a[120:123], v[112:115]
    v_mfma_f32_16x16x32_bf16 v[116:119], v[84:87], a[120:123], v[116:119]
    v_mfma_f32_16x16x32_bf16 v[120:123], v[80:83], a[124:127], v[120:123]
    v_mfma_f32_16x16x32_bf16 v[124:127], v[84:87], a[124:127], v[124:127]
    v_mfma_f32_16x16x32_bf16 v[128:131], v[88:91], a[112:115], v[128:131]
    s_add_u32 m0, s34, 16384
    s_add_u32 s37, s82, 196608
    buffer_load_dwordx4 v232, s[44:47], s37 offen lds
    v_mfma_f32_16x16x32_bf16 v[132:135], v[92:95], a[112:115], v[132:135]
    v_mfma_f32_16x16x32_bf16 v[136:139], v[88:91], a[116:119], v[136:139]
    buffer_load_dwordx4 v233, s[44:47], s37 offen offset:1024 lds
    v_mfma_f32_16x16x32_bf16 v[140:143], v[92:95], a[116:119], v[140:143]
    v_mfma_f32_16x16x32_bf16 v[144:147], v[88:91], a[120:123], v[144:147]
    v_mfma_f32_16x16x32_bf16 v[148:151], v[92:95], a[120:123], v[148:151]
    s_add_u32 m0, s31, 3072
    s_add_u32 s24, s27, 98304
    buffer_load_dwordx4 v237, s[12:15], s24 offen lds
    v_mfma_f32_16x16x32_bf16 v[152:155], v[88:91], a[124:127], v[152:155]
    v_mfma_f32_16x16x32_bf16 v[156:159], v[92:95], a[124:127], v[156:159]
    s_waitcnt lgkmcnt(0)
    v_mfma_f32_16x16x32_bf16 v[96:99], v[64:67], a[128:131], v[96:99]
    ds_read_b128 v[80:83], v225 offset:32768
    v_mfma_f32_16x16x32_bf16 v[100:103], v[68:71], a[128:131], v[100:103]
    ds_read_b128 v[84:87], v225 offset:34816
    v_mfma_f32_16x16x32_bf16 v[104:107], v[64:67], a[132:135], v[104:107]
    ds_read_b128 v[88:91], v225 offset:36864
    v_mfma_f32_16x16x32_bf16 v[108:111], v[68:71], a[132:135], v[108:111]
    ds_read_b128 v[92:95], v225 offset:38912
    v_mfma_f32_16x16x32_bf16 v[112:115], v[64:67], a[136:139], v[112:115]
    v_mfma_f32_16x16x32_bf16 v[116:119], v[68:71], a[136:139], v[116:119]
    s_add_u32 s38, s36, 8192
    buffer_store_dwordx4 v[24:27], v240, s[16:19], s38 offen offset:2048 sc1
    v_mfma_f32_16x16x32_bf16 v[120:123], v[64:67], a[140:143], v[120:123]
    v_mfma_f32_16x16x32_bf16 v[124:127], v[68:71], a[140:143], v[124:127]
    v_mfma_f32_16x16x32_bf16 v[128:131], v[72:75], a[128:131], v[128:131]
    s_add_u32 m0, s31, 4096
    s_add_u32 s24, s27, 131072
    buffer_load_dwordx4 v245, s[12:15], s24 offen lds
    v_mfma_f32_16x16x32_bf16 v[132:135], v[76:79], a[128:131], v[132:135]
    v_mfma_f32_16x16x32_bf16 v[136:139], v[72:75], a[132:135], v[136:139]
    v_mfma_f32_16x16x32_bf16 v[140:143], v[76:79], a[132:135], v[140:143]
    v_mfma_f32_16x16x32_bf16 v[144:147], v[72:75], a[136:139], v[144:147]
    v_mfma_f32_16x16x32_bf16 v[148:151], v[76:79], a[136:139], v[148:151]
    v_mfma_f32_16x16x32_bf16 v[152:155], v[72:75], a[140:143], v[152:155]
    v_mfma_f32_16x16x32_bf16 v[156:159], v[76:79], a[140:143], v[156:159]
    s_waitcnt lgkmcnt(0)
    v_mfma_f32_16x16x32_bf16 v[96:99], v[80:83], a[144:147], v[96:99]
    ds_read_b128 v[64:67], v224 offset:40960
    v_mfma_f32_16x16x32_bf16 v[100:103], v[84:87], a[144:147], v[100:103]
    ds_read_b128 v[68:71], v224 offset:43008
    v_mfma_f32_16x16x32_bf16 v[104:107], v[80:83], a[148:151], v[104:107]
    ds_read_b128 v[72:75], v224 offset:45056
    v_mfma_f32_16x16x32_bf16 v[108:111], v[84:87], a[148:151], v[108:111]
    ds_read_b128 v[76:79], v224 offset:47104
    v_mfma_f32_16x16x32_bf16 v[112:115], v[80:83], a[152:155], v[112:115]
    v_mfma_f32_16x16x32_bf16 v[116:119], v[84:87], a[152:155], v[116:119]
    v_mfma_f32_16x16x32_bf16 v[120:123], v[80:83], a[156:159], v[120:123]
    v_mfma_f32_16x16x32_bf16 v[124:127], v[84:87], a[156:159], v[124:127]
    v_mfma_f32_16x16x32_bf16 v[128:131], v[88:91], a[144:147], v[128:131]
    s_add_u32 m0, s34, 24576
    s_add_u32 s37, s83, 196608
    buffer_load_dwordx4 v232, s[44:47], s37 offen lds
    v_mfma_f32_16x16x32_bf16 v[132:135], v[92:95], a[144:147], v[132:135]
    v_mfma_f32_16x16x32_bf16 v[136:139], v[88:91], a[148:151], v[136:139]
    buffer_load_dwordx4 v233, s[44:47], s37 offen offset:1024 lds
    s_add_u32 s38, s36, 8192
    buffer_store_dwordx4 v[28:31], v240, s[16:19], s38 offen offset:3072 sc1
    v_mfma_f32_16x16x32_bf16 v[140:143], v[92:95], a[148:151], v[140:143]
    v_mfma_f32_16x16x32_bf16 v[144:147], v[88:91], a[152:155], v[144:147]
    v_mfma_f32_16x16x32_bf16 v[148:151], v[92:95], a[152:155], v[148:151]
    s_add_u32 m0, s31, 5120
    s_add_u32 s24, s27, 163840
    buffer_load_dwordx4 v245, s[12:15], s24 offen lds
    v_mfma_f32_16x16x32_bf16 v[152:155], v[88:91], a[156:159], v[152:155]
    v_mfma_f32_16x16x32_bf16 v[156:159], v[92:95], a[156:159], v[156:159]
    s_waitcnt lgkmcnt(0)
    v_mfma_f32_16x16x32_bf16 v[96:99], v[64:67], a[160:163], v[96:99]
    ds_read_b128 v[80:83], v225 offset:40960
    v_mfma_f32_16x16x32_bf16 v[100:103], v[68:71], a[160:163], v[100:103]
    ds_read_b128 v[84:87], v225 offset:43008
    v_mfma_f32_16x16x32_bf16 v[104:107], v[64:67], a[164:167], v[104:107]
    ds_read_b128 v[88:91], v225 offset:45056
    v_mfma_f32_16x16x32_bf16 v[108:111], v[68:71], a[164:167], v[108:111]
    ds_read_b128 v[92:95], v225 offset:47104
    v_mfma_f32_16x16x32_bf16 v[112:115], v[64:67], a[168:171], v[112:115]
    v_mfma_f32_16x16x32_bf16 v[116:119], v[68:71], a[168:171], v[116:119]
    v_mfma_f32_16x16x32_bf16 v[120:123], v[64:67], a[172:175], v[120:123]
    v_mfma_f32_16x16x32_bf16 v[124:127], v[68:71], a[172:175], v[124:127]
    v_mfma_f32_16x16x32_bf16 v[128:131], v[72:75], a[160:163], v[128:131]
    s_add_u32 m0, s31, 6144
    s_add_u32 s24, s27, 196608
    buffer_load_dwordx4 v237, s[12:15], s24 offen lds
    v_mfma_f32_16x16x32_bf16 v[132:135], v[76:79], a[160:163], v[132:135]
    v_mfma_f32_16x16x32_bf16 v[136:139], v[72:75], a[164:167], v[136:139]
    v_mfma_f32_16x16x32_bf16 v[140:143], v[76:79], a[164:167], v[140:143]
    v_mfma_f32_16x16x32_bf16 v[144:147], v[72:75], a[168:171], v[144:147]
    v_mfma_f32_16x16x32_bf16 v[148:151], v[76:79], a[168:171], v[148:151]
    v_mfma_f32_16x16x32_bf16 v[152:155], v[72:75], a[172:175], v[152:155]
    v_mfma_f32_16x16x32_bf16 v[156:159], v[76:79], a[172:175], v[156:159]
    s_waitcnt vmcnt(22) lgkmcnt(0)
    s_barrier
    v_mfma_f32_16x16x32_bf16 v[96:99], v[80:83], a[176:179], v[96:99]
    ds_read_b128 v[64:67], v224 offset:49152
    s_add_u32 s38, s36, 32768
    buffer_store_dwordx4 v[32:35], v240, s[16:19], s38 offen offset:1280 sc1
    v_mfma_f32_16x16x32_bf16 v[100:103], v[84:87], a[176:179], v[100:103]
    ds_read_b128 v[68:71], v224 offset:51200
    v_mfma_f32_16x16x32_bf16 v[104:107], v[80:83], a[180:183], v[104:107]
    ds_read_b128 v[72:75], v224 offset:53248
    v_mfma_f32_16x16x32_bf16 v[108:111], v[84:87], a[180:183], v[108:111]
    ds_read_b128 v[76:79], v224 offset:55296
    v_mfma_f32_16x16x32_bf16 v[112:115], v[80:83], a[184:187], v[112:115]
    v_mfma_f32_16x16x32_bf16 v[116:119], v[84:87], a[184:187], v[116:119]
    v_mfma_f32_16x16x32_bf16 v[120:123], v[80:83], a[188:191], v[120:123]
    v_mfma_f32_16x16x32_bf16 v[124:127], v[84:87], a[188:191], v[124:127]
    v_mfma_f32_16x16x32_bf16 v[128:131], v[88:91], a[176:179], v[128:131]
    s_add_u32 m0, s34, 32768
    s_add_u32 s37, s84, 196608
    buffer_load_dwordx4 v232, s[44:47], s37 offen lds
    v_mfma_f32_16x16x32_bf16 v[132:135], v[92:95], a[176:179], v[132:135]
    buffer_load_dwordx4 v233, s[44:47], s37 offen offset:1024 lds
    v_mfma_f32_16x16x32_bf16 v[136:139], v[88:91], a[180:183], v[136:139]
    v_mfma_f32_16x16x32_bf16 v[140:143], v[92:95], a[180:183], v[140:143]
    s_add_u32 m0, s31, 7168
    s_add_u32 s24, s27, 229376
    buffer_load_dwordx4 v237, s[12:15], s24 offen lds
    v_mfma_f32_16x16x32_bf16 v[144:147], v[88:91], a[184:187], v[144:147]
    s_add_u32 s27, s27, 1048576
    s_and_b32 s27, s27, 0x407fffff
    s_cmp_eq_u32 s27, s7
    s_cselect_b32 s27, s43, s27
    v_mfma_f32_16x16x32_bf16 v[148:151], v[92:95], a[184:187], v[148:151]
    v_mfma_f32_16x16x32_bf16 v[152:155], v[88:91], a[188:191], v[152:155]
    s_add_u32 s31, s31, 32768
    s_cmp_ge_u32 s31, 163840
    s_cselect_b32 s24, 98304, 0
    s_sub_u32 s31, s31, s24
    v_mfma_f32_16x16x32_bf16 v[156:159], v[92:95], a[188:191], v[156:159]
    s_waitcnt lgkmcnt(0)
    v_mfma_f32_16x16x32_bf16 v[96:99], v[64:67], a[192:195], v[96:99]
    ds_read_b128 v[80:83], v225 offset:49152
    v_mfma_f32_16x16x32_bf16 v[100:103], v[68:71], a[192:195], v[100:103]
    ds_read_b128 v[84:87], v225 offset:51200
    v_mfma_f32_16x16x32_bf16 v[104:107], v[64:67], a[196:199], v[104:107]
    ds_read_b128 v[88:91], v225 offset:53248
    v_mfma_f32_16x16x32_bf16 v[108:111], v[68:71], a[196:199], v[108:111]
    ds_read_b128 v[92:95], v225 offset:55296
    v_mfma_f32_16x16x32_bf16 v[112:115], v[64:67], a[200:203], v[112:115]
    v_mfma_f32_16x16x32_bf16 v[116:119], v[68:71], a[200:203], v[116:119]
    v_mfma_f32_16x16x32_bf16 v[120:123], v[64:67], a[204:207], v[120:123]
    s_add_u32 s38, s36, 32768
    buffer_store_dwordx4 v[36:39], v240, s[16:19], s38 offen offset:2304 sc1
    v_mfma_f32_16x16x32_bf16 v[124:127], v[68:71], a[204:207], v[124:127]
    v_mfma_f32_16x16x32_bf16 v[128:131], v[72:75], a[192:195], v[128:131]
    v_mfma_f32_16x16x32_bf16 v[132:135], v[76:79], a[192:195], v[132:135]
    v_mfma_f32_16x16x32_bf16 v[136:139], v[72:75], a[196:199], v[136:139]
    v_mfma_f32_16x16x32_bf16 v[140:143], v[76:79], a[196:199], v[140:143]
    v_mfma_f32_16x16x32_bf16 v[144:147], v[72:75], a[200:203], v[144:147]
    v_mfma_f32_16x16x32_bf16 v[148:151], v[76:79], a[200:203], v[148:151]
    v_mfma_f32_16x16x32_bf16 v[152:155], v[72:75], a[204:207], v[152:155]
    v_mfma_f32_16x16x32_bf16 v[156:159], v[76:79], a[204:207], v[156:159]
    s_waitcnt lgkmcnt(0)
    v_mfma_f32_16x16x32_bf16 v[96:99], v[80:83], a[208:211], v[96:99]
    ds_read_b128 v[64:67], v224 offset:57344
    v_mfma_f32_16x16x32_bf16 v[100:103], v[84:87], a[208:211], v[100:103]
    ds_read_b128 v[68:71], v224 offset:59392
    v_mfma_f32_16x16x32_bf16 v[104:107], v[80:83], a[212:215], v[104:107]
    ds_read_b128 v[72:75], v224 offset:61440
    v_mfma_f32_16x16x32_bf16 v[108:111], v[84:87], a[212:215], v[108:111]
    ds_read_b128 v[76:79], v224 offset:63488
    v_mfma_f32_16x16x32_bf16 v[112:115], v[80:83], a[216:219], v[112:115]
    v_mfma_f32_16x16x32_bf16 v[116:119], v[84:87], a[216:219], v[116:119]
    v_mfma_f32_16x16x32_bf16 v[120:123], v[80:83], a[220:223], v[120:123]
    v_mfma_f32_16x16x32_bf16 v[124:127], v[84:87], a[220:223], v[124:127]
    v_mfma_f32_16x16x32_bf16 v[128:131], v[88:91], a[208:211], v[128:131]
    s_add_u32 m0, s34, 40960
    s_add_u32 s37, s85, 196608
    buffer_load_dwordx4 v232, s[44:47], s37 offen lds
    v_mfma_f32_16x16x32_bf16 v[132:135], v[92:95], a[208:211], v[132:135]
    v_mfma_f32_16x16x32_bf16 v[136:139], v[88:91], a[212:215], v[136:139]
    v_mfma_f32_16x16x32_bf16 v[140:143], v[92:95], a[212:215], v[140:143]
    s_add_u32 s38, s36, 32768
    buffer_store_dwordx4 v[40:43], v240, s[16:19], s38 offen offset:3328 sc1
    v_mfma_f32_16x16x32_bf16 v[144:147], v[88:91], a[216:219], v[144:147]
    buffer_load_dwordx4 v233, s[44:47], s37 offen offset:1024 lds
    v_mfma_f32_16x16x32_bf16 v[148:151], v[92:95], a[216:219], v[148:151]
    v_mfma_f32_16x16x32_bf16 v[152:155], v[88:91], a[220:223], v[152:155]
    v_mfma_f32_16x16x32_bf16 v[156:159], v[92:95], a[220:223], v[156:159]
    s_waitcnt lgkmcnt(0)
    v_mfma_f32_16x16x32_bf16 v[96:99], v[64:67], a[224:227], v[96:99]
    ds_read_b128 v[80:83], v225 offset:57344
    v_mfma_f32_16x16x32_bf16 v[100:103], v[68:71], a[224:227], v[100:103]
    ds_read_b128 v[84:87], v225 offset:59392
    v_mfma_f32_16x16x32_bf16 v[104:107], v[64:67], a[228:231], v[104:107]
    ds_read_b128 v[88:91], v225 offset:61440
    v_mfma_f32_16x16x32_bf16 v[108:111], v[68:71], a[228:231], v[108:111]
    ds_read_b128 v[92:95], v225 offset:63488
    v_mfma_f32_16x16x32_bf16 v[112:115], v[64:67], a[232:235], v[112:115]
    v_mfma_f32_16x16x32_bf16 v[116:119], v[68:71], a[232:235], v[116:119]
    v_mfma_f32_16x16x32_bf16 v[120:123], v[64:67], a[236:239], v[120:123]
    v_mfma_f32_16x16x32_bf16 v[124:127], v[68:71], a[236:239], v[124:127]
    v_mfma_f32_16x16x32_bf16 v[128:131], v[72:75], a[224:227], v[128:131]
    s_add_u32 m0, s31, 0
    s_add_u32 s24, s27, 0
    buffer_load_dwordx4 v245, s[12:15], s24 offen lds
    v_mfma_f32_16x16x32_bf16 v[132:135], v[76:79], a[224:227], v[132:135]
    v_mfma_f32_16x16x32_bf16 v[136:139], v[72:75], a[228:231], v[136:139]
    v_mfma_f32_16x16x32_bf16 v[140:143], v[76:79], a[228:231], v[140:143]
    v_mfma_f32_16x16x32_bf16 v[144:147], v[72:75], a[232:235], v[144:147]
    v_mfma_f32_16x16x32_bf16 v[148:151], v[76:79], a[232:235], v[148:151]
    v_mfma_f32_16x16x32_bf16 v[152:155], v[72:75], a[236:239], v[152:155]
    v_mfma_f32_16x16x32_bf16 v[156:159], v[76:79], a[236:239], v[156:159]
    s_waitcnt vmcnt(23) lgkmcnt(0)
    s_barrier
    v_mfma_f32_16x16x32_bf16 v[96:99], v[80:83], a[240:243], v[96:99]
    ds_read_b128 v[64:67], v224 offset:0
    v_mfma_f32_16x16x32_bf16 v[100:103], v[84:87], a[240:243], v[100:103]
    ds_read_b128 v[68:71], v224 offset:2048
    s_add_u32 s38, s36, 36864
    buffer_store_dwordx4 v[44:47], v240, s[16:19], s38 offen offset:256 sc1
    v_mfma_f32_16x16x32_bf16 v[104:107], v[80:83], a[244:247], v[104:107]
    ds_read_b128 v[72:75], v224 offset:4096
    v_mfma_f32_16x16x32_bf16 v[108:111], v[84:87], a[244:247], v[108:111]
    ds_read_b128 v[76:79], v224 offset:6144
    v_mfma_f32_16x16x32_bf16 v[112:115], v[80:83], a[248:251], v[112:115]
    v_mfma_f32_16x16x32_bf16 v[116:119], v[84:87], a[248:251], v[116:119]
    v_mfma_f32_16x16x32_bf16 v[120:123], v[80:83], a[252:255], v[120:123]
    v_mfma_f32_16x16x32_bf16 v[124:127], v[84:87], a[252:255], v[124:127]
    v_mfma_f32_16x16x32_bf16 v[128:131], v[88:91], a[240:243], v[128:131]
    s_add_u32 m0, s34, 49152
    s_add_u32 s37, s86, 196608
    buffer_load_dwordx4 v232, s[44:47], s37 offen lds
    v_mfma_f32_16x16x32_bf16 v[132:135], v[92:95], a[240:243], v[132:135]
    v_mfma_f32_16x16x32_bf16 v[136:139], v[88:91], a[244:247], v[136:139]
    buffer_load_dwordx4 v233, s[44:47], s37 offen offset:1024 lds
    v_mfma_f32_16x16x32_bf16 v[140:143], v[92:95], a[244:247], v[140:143]
    v_mfma_f32_16x16x32_bf16 v[144:147], v[88:91], a[248:251], v[144:147]
    v_mfma_f32_16x16x32_bf16 v[148:151], v[92:95], a[248:251], v[148:151]
    s_add_u32 m0, s31, 1024
    s_add_u32 s24, s27, 32768
    buffer_load_dwordx4 v245, s[12:15], s24 offen lds
    v_mfma_f32_16x16x32_bf16 v[152:155], v[88:91], a[252:255], v[152:155]
    v_mfma_f32_16x16x32_bf16 v[156:159], v[92:95], a[252:255], v[156:159]
    s_waitcnt lgkmcnt(0)
    v_mfma_f32_16x16x32_bf16 v[160:163], v[64:67], a[0:3], 0
    ds_read_b128 v[80:83], v225 offset:0
    v_mfma_f32_16x16x32_bf16 v[164:167], v[68:71], a[0:3], 0
    ds_read_b128 v[84:87], v225 offset:2048
    v_mfma_f32_16x16x32_bf16 v[168:171], v[64:67], a[4:7], 0
    ds_read_b128 v[88:91], v225 offset:4096
    v_mfma_f32_16x16x32_bf16 v[172:175], v[68:71], a[4:7], 0
    ds_read_b128 v[92:95], v225 offset:6144
    v_mfma_f32_16x16x32_bf16 v[176:179], v[64:67], a[8:11], 0
    v_cvt_pk_bf16_f32 v0, v96, v97
    v_cvt_pk_bf16_f32 v1, v98, v99
    v_mfma_f32_16x16x32_bf16 v[180:183], v[68:71], a[8:11], 0
    v_mfma_f32_16x16x32_bf16 v[184:187], v[64:67], a[12:15], 0
    v_cvt_pk_bf16_f32 v2, v100, v101
    v_cvt_pk_bf16_f32 v3, v102, v103
    s_add_u32 s38, s36, 40960
    buffer_store_dwordx4 v[48:51], v240, s[16:19], s38 offen offset:1280 sc1
    v_mfma_f32_16x16x32_bf16 v[188:191], v[68:71], a[12:15], 0
    v_mfma_f32_16x16x32_bf16 v[192:195], v[72:75], a[0:3], 0
    s_add_u32 m0, s31, 2048
    s_add_u32 s24, s27, 65536
    buffer_load_dwordx4 v237, s[12:15], s24 offen lds
    v_cvt_pk_bf16_f32 v4, v104, v105
    v_cvt_pk_bf16_f32 v5, v106, v107
    v_mfma_f32_16x16x32_bf16 v[196:199], v[76:79], a[0:3], 0
    v_mfma_f32_16x16x32_bf16 v[200:203], v[72:75], a[4:7], 0
    v_cvt_pk_bf16_f32 v6, v108, v109
    v_cvt_pk_bf16_f32 v7, v110, v111
    v_mfma_f32_16x16x32_bf16 v[204:207], v[76:79], a[4:7], 0
    v_mfma_f32_16x16x32_bf16 v[208:211], v[72:75], a[8:11], 0
    v_cvt_pk_bf16_f32 v8, v112, v113
    v_cvt_pk_bf16_f32 v9, v114, v115
    v_mfma_f32_16x16x32_bf16 v[212:215], v[76:79], a[8:11], 0
    v_mfma_f32_16x16x32_bf16 v[216:219], v[72:75], a[12:15], 0
    v_cvt_pk_bf16_f32 v10, v116, v117
    v_cvt_pk_bf16_f32 v11, v118, v119
    v_mfma_f32_16x16x32_bf16 v[220:223], v[76:79], a[12:15], 0
    s_waitcnt lgkmcnt(0)
    v_mfma_f32_16x16x32_bf16 v[160:163], v[80:83], a[16:19], v[160:163]
    ds_read_b128 v[64:67], v224 offset:8192
    v_cvt_pk_bf16_f32 v12, v120, v121
    v_cvt_pk_bf16_f32 v13, v122, v123
    v_mfma_f32_16x16x32_bf16 v[164:167], v[84:87], a[16:19], v[164:167]
    ds_read_b128 v[68:71], v224 offset:10240
    v_mfma_f32_16x16x32_bf16 v[168:171], v[80:83], a[20:23], v[168:171]
    ds_read_b128 v[72:75], v224 offset:12288
    v_cvt_pk_bf16_f32 v14, v124, v125
    v_cvt_pk_bf16_f32 v15, v126, v127
    v_mfma_f32_16x16x32_bf16 v[172:175], v[84:87], a[20:23], v[172:175]
    ds_read_b128 v[76:79], v224 offset:14336
    v_mfma_f32_16x16x32_bf16 v[176:179], v[80:83], a[24:27], v[176:179]
    v_cvt_pk_bf16_f32 v16, v128, v129
    v_cvt_pk_bf16_f32 v17, v130, v131
    v_mfma_f32_16x16x32_bf16 v[180:183], v[84:87], a[24:27], v[180:183]
    v_mfma_f32_16x16x32_bf16 v[184:187], v[80:83], a[28:31], v[184:187]
    v_cvt_pk_bf16_f32 v18, v132, v133
    v_cvt_pk_bf16_f32 v19, v134, v135
    v_mfma_f32_16x16x32_bf16 v[188:191], v[84:87], a[28:31], v[188:191]
    v_mfma_f32_16x16x32_bf16 v[192:195], v[88:91], a[16:19], v[192:195]
    s_add_u32 m0, s34, 57344
    s_add_u32 s37, s87, 196608
    buffer_load_dwordx4 v232, s[44:47], s37 offen lds
    v_cvt_pk_bf16_f32 v20, v136, v137
    v_cvt_pk_bf16_f32 v21, v138, v139
    v_mfma_f32_16x16x32_bf16 v[196:199], v[92:95], a[16:19], v[196:199]
    v_mfma_f32_16x16x32_bf16 v[200:203], v[88:91], a[20:23], v[200:203]
    buffer_load_dwordx4 v233, s[44:47], s37 offen offset:1024 lds
    v_cvt_pk_bf16_f32 v22, v140, v141
    v_cvt_pk_bf16_f32 v23, v142, v143
    v_mfma_f32_16x16x32_bf16 v[204:207], v[92:95], a[20:23], v[204:207]
    v_mfma_f32_16x16x32_bf16 v[208:211], v[88:91], a[24:27], v[208:211]
    v_cvt_pk_bf16_f32 v24, v144, v145
    v_cvt_pk_bf16_f32 v25, v146, v147
    s_add_u32 s38, s36, 40960
    buffer_store_dwordx4 v[52:55], v240, s[16:19], s38 offen offset:2304 sc1
    v_mfma_f32_16x16x32_bf16 v[212:215], v[92:95], a[24:27], v[212:215]
    s_add_u32 m0, s31, 3072
    s_add_u32 s24, s27, 98304
    buffer_load_dwordx4 v237, s[12:15], s24 offen lds
    v_mfma_f32_16x16x32_bf16 v[216:219], v[88:91], a[28:31], v[216:219]
    v_cvt_pk_bf16_f32 v26, v148, v149
    v_cvt_pk_bf16_f32 v27, v150, v151
    v_mfma_f32_16x16x32_bf16 v[220:223], v[92:95], a[28:31], v[220:223]
    s_waitcnt lgkmcnt(0)
    v_mfma_f32_16x16x32_bf16 v[160:163], v[64:67], a[32:35], v[160:163]
    ds_read_b128 v[80:83], v225 offset:8192
    v_cvt_pk_bf16_f32 v28, v152, v153
    v_cvt_pk_bf16_f32 v29, v154, v155
    v_mfma_f32_16x16x32_bf16 v[164:167], v[68:71], a[32:35], v[164:167]
    ds_read_b128 v[84:87], v225 offset:10240
    v_mfma_f32_16x16x32_bf16 v[168:171], v[64:67], a[36:39], v[168:171]
    ds_read_b128 v[88:91], v225 offset:12288
    v_cvt_pk_bf16_f32 v30, v156, v157
    v_cvt_pk_bf16_f32 v31, v158, v159
    v_mfma_f32_16x16x32_bf16 v[172:175], v[68:71], a[36:39], v[172:175]
    ds_read_b128 v[92:95], v225 offset:14336
    v_mfma_f32_16x16x32_bf16 v[176:179], v[64:67], a[40:43], v[176:179]
    v_mfma_f32_16x16x32_bf16 v[180:183], v[68:71], a[40:43], v[180:183]
    v_mfma_f32_16x16x32_bf16 v[184:187], v[64:67], a[44:47], v[184:187]
    v_mfma_f32_16x16x32_bf16 v[188:191], v[68:71], a[44:47], v[188:191]
    v_mfma_f32_16x16x32_bf16 v[192:195], v[72:75], a[32:35], v[192:195]
    s_add_u32 m0, s31, 4096
    s_add_u32 s24, s27, 131072
    buffer_load_dwordx4 v245, s[12:15], s24 offen lds
    v_mfma_f32_16x16x32_bf16 v[196:199], v[76:79], a[32:35], v[196:199]
    v_mfma_f32_16x16x32_bf16 v[200:203], v[72:75], a[36:39], v[200:203]
    v_mfma_f32_16x16x32_bf16 v[204:207], v[76:79], a[36:39], v[204:207]
    v_mfma_f32_16x16x32_bf16 v[208:211], v[72:75], a[40:43], v[208:211]
    v_mfma_f32_16x16x32_bf16 v[212:215], v[76:79], a[40:43], v[212:215]
    v_mfma_f32_16x16x32_bf16 v[216:219], v[72:75], a[44:47], v[216:219]
    v_mfma_f32_16x16x32_bf16 v[220:223], v[76:79], a[44:47], v[220:223]
    s_waitcnt vmcnt(23) lgkmcnt(0)
    s_barrier
    v_mfma_f32_16x16x32_bf16 v[160:163], v[80:83], a[48:51], v[160:163]
    ds_read_b128 v[64:67], v224 offset:16384
    v_mfma_f32_16x16x32_bf16 v[164:167], v[84:87], a[48:51], v[164:167]
    ds_read_b128 v[68:71], v224 offset:18432
    s_add_u32 s38, s36, 40960
    buffer_store_dwordx4 v[56:59], v240, s[16:19], s38 offen offset:3328 sc1
    v_mfma_f32_16x16x32_bf16 v[168:171], v[80:83], a[52:55], v[168:171]
    ds_read_b128 v[72:75], v224 offset:20480
    v_mfma_f32_16x16x32_bf16 v[172:175], v[84:87], a[52:55], v[172:175]
    ds_read_b128 v[76:79], v224 offset:22528
    v_mfma_f32_16x16x32_bf16 v[176:179], v[80:83], a[56:59], v[176:179]
    v_mfma_f32_16x16x32_bf16 v[180:183], v[84:87], a[56:59], v[180:183]
    v_mfma_f32_16x16x32_bf16 v[184:187], v[80:83], a[60:63], v[184:187]
    v_mfma_f32_16x16x32_bf16 v[188:191], v[84:87], a[60:63], v[188:191]
    v_mfma_f32_16x16x32_bf16 v[192:195], v[88:91], a[48:51], v[192:195]
    s_add_u32 m0, s31, 5120
    s_add_u32 s24, s27, 163840
    buffer_load_dwordx4 v245, s[12:15], s24 offen lds
    v_mfma_f32_16x16x32_bf16 v[196:199], v[92:95], a[48:51], v[196:199]
    v_mfma_f32_16x16x32_bf16 v[200:203], v[88:91], a[52:55], v[200:203]
    v_mfma_f32_16x16x32_bf16 v[204:207], v[92:95], a[52:55], v[204:207]
    v_mfma_f32_16x16x32_bf16 v[208:211], v[88:91], a[56:59], v[208:211]
    v_mfma_f32_16x16x32_bf16 v[212:215], v[92:95], a[56:59], v[212:215]
    v_mfma_f32_16x16x32_bf16 v[216:219], v[88:91], a[60:63], v[216:219]
    v_mfma_f32_16x16x32_bf16 v[220:223], v[92:95], a[60:63], v[220:223]
    s_waitcnt lgkmcnt(0)
    v_mfma_f32_16x16x32_bf16 v[160:163], v[64:67], a[64:67], v[160:163]
    ds_read_b128 v[80:83], v225 offset:16384
    v_mfma_f32_16x16x32_bf16 v[164:167], v[68:71], a[64:67], v[164:167]
    ds_read_b128 v[84:87], v225 offset:18432
    v_mfma_f32_16x16x32_bf16 v[168:171], v[64:67], a[68:71], v[168:171]
    ds_read_b128 v[88:91], v225 offset:20480
    v_mfma_f32_16x16x32_bf16 v[172:175], v[68:71], a[68:71], v[172:175]
    ds_read_b128 v[92:95], v225 offset:22528
    v_mfma_f32_16x16x32_bf16 v[176:179], v[64:67], a[72:75], v[176:179]
    v_mfma_f32_16x16x32_bf16 v[180:183], v[68:71], a[72:75], v[180:183]
    v_mfma_f32_16x16x32_bf16 v[184:187], v[64:67], a[76:79], v[184:187]
    v_mfma_f32_16x16x32_bf16 v[188:191], v[68:71], a[76:79], v[188:191]
    s_add_u32 s38, s36, 45056
    buffer_store_dwordx4 v[60:63], v240, s[16:19], s38 offen offset:256 sc1
    v_mfma_f32_16x16x32_bf16 v[192:195], v[72:75], a[64:67], v[192:195]
    s_add_u32 m0, s31, 6144
    s_add_u32 s24, s27, 196608
    buffer_load_dwordx4 v237, s[12:15], s24 offen lds
    v_mfma_f32_16x16x32_bf16 v[196:199], v[76:79], a[64:67], v[196:199]
    v_mfma_f32_16x16x32_bf16 v[200:203], v[72:75], a[68:71], v[200:203]
    v_mfma_f32_16x16x32_bf16 v[204:207], v[76:79], a[68:71], v[204:207]
    v_mfma_f32_16x16x32_bf16 v[208:211], v[72:75], a[72:75], v[208:211]
    v_mfma_f32_16x16x32_bf16 v[212:215], v[76:79], a[72:75], v[212:215]
    v_mfma_f32_16x16x32_bf16 v[216:219], v[72:75], a[76:79], v[216:219]
    v_mfma_f32_16x16x32_bf16 v[220:223], v[76:79], a[76:79], v[220:223]
    s_waitcnt lgkmcnt(0)
    v_mfma_f32_16x16x32_bf16 v[160:163], v[80:83], a[80:83], v[160:163]
    ds_read_b128 v[64:67], v224 offset:24576
    v_mfma_f32_16x16x32_bf16 v[164:167], v[84:87], a[80:83], v[164:167]
    ds_read_b128 v[68:71], v224 offset:26624
    v_mfma_f32_16x16x32_bf16 v[168:171], v[80:83], a[84:87], v[168:171]
    ds_read_b128 v[72:75], v224 offset:28672
    v_mfma_f32_16x16x32_bf16 v[172:175], v[84:87], a[84:87], v[172:175]
    ds_read_b128 v[76:79], v224 offset:30720
    v_mfma_f32_16x16x32_bf16 v[176:179], v[80:83], a[88:91], v[176:179]
    v_mfma_f32_16x16x32_bf16 v[180:183], v[84:87], a[88:91], v[180:183]
    v_mfma_f32_16x16x32_bf16 v[184:187], v[80:83], a[92:95], v[184:187]
    v_mfma_f32_16x16x32_bf16 v[188:191], v[84:87], a[92:95], v[188:191]
    v_mfma_f32_16x16x32_bf16 v[192:195], v[88:91], a[80:83], v[192:195]
    s_add_u32 m0, s31, 7168
    s_add_u32 s24, s27, 229376
    buffer_load_dwordx4 v237, s[12:15], s24 offen lds
    v_mfma_f32_16x16x32_bf16 v[196:199], v[92:95], a[80:83], v[196:199]
    v_mfma_f32_16x16x32_bf16 v[200:203], v[88:91], a[84:87], v[200:203]
    s_add_u32 s27, s27, 1048576
    s_and_b32 s27, s27, 0x407fffff
    s_cmp_eq_u32 s27, s7
    s_cselect_b32 s27, s43, s27
    v_mfma_f32_16x16x32_bf16 v[204:207], v[92:95], a[84:87], v[204:207]
    v_mfma_f32_16x16x32_bf16 v[208:211], v[88:91], a[88:91], v[208:211]
    v_mfma_f32_16x16x32_bf16 v[212:215], v[92:95], a[88:91], v[212:215]
    s_add_u32 s31, s31, 32768
    s_cmp_ge_u32 s31, 163840
    s_cselect_b32 s24, 98304, 0
    s_sub_u32 s31, s31, s24
    s_add_u32 s38, s36, 65536
    buffer_store_dwordx4 v[0:3], v240, s[16:19], s38 offen offset:2560 sc1
    v_mfma_f32_16x16x32_bf16 v[216:219], v[88:91], a[92:95], v[216:219]
    v_mfma_f32_16x16x32_bf16 v[220:223], v[92:95], a[92:95], v[220:223]
    s_waitcnt lgkmcnt(0)
    v_mfma_f32_16x16x32_bf16 v[160:163], v[64:67], a[96:99], v[160:163]
    ds_read_b128 v[80:83], v225 offset:24576
    v_mfma_f32_16x16x32_bf16 v[164:167], v[68:71], a[96:99], v[164:167]
    ds_read_b128 v[84:87], v225 offset:26624
    v_mfma_f32_16x16x32_bf16 v[168:171], v[64:67], a[100:103], v[168:171]
    ds_read_b128 v[88:91], v225 offset:28672
    v_mfma_f32_16x16x32_bf16 v[172:175], v[68:71], a[100:103], v[172:175]
    ds_read_b128 v[92:95], v225 offset:30720
    v_mfma_f32_16x16x32_bf16 v[176:179], v[64:67], a[104:107], v[176:179]
    v_mfma_f32_16x16x32_bf16 v[180:183], v[68:71], a[104:107], v[180:183]
    v_mfma_f32_16x16x32_bf16 v[184:187], v[64:67], a[108:111], v[184:187]
    v_mfma_f32_16x16x32_bf16 v[188:191], v[68:71], a[108:111], v[188:191]
    v_mfma_f32_16x16x32_bf16 v[192:195], v[72:75], a[96:99], v[192:195]
    v_mfma_f32_16x16x32_bf16 v[196:199], v[76:79], a[96:99], v[196:199]
    v_mfma_f32_16x16x32_bf16 v[200:203], v[72:75], a[100:103], v[200:203]
    v_mfma_f32_16x16x32_bf16 v[204:207], v[76:79], a[100:103], v[204:207]
    v_mfma_f32_16x16x32_bf16 v[208:211], v[72:75], a[104:107], v[208:211]
    v_mfma_f32_16x16x32_bf16 v[212:215], v[76:79], a[104:107], v[212:215]
    v_mfma_f32_16x16x32_bf16 v[216:219], v[72:75], a[108:111], v[216:219]
    v_mfma_f32_16x16x32_bf16 v[220:223], v[76:79], a[108:111], v[220:223]
    s_waitcnt vmcnt(9) lgkmcnt(0)
    s_barrier
    v_mfma_f32_16x16x32_bf16 v[160:163], v[80:83], a[112:115], v[160:163]
    ds_read_b128 v[64:67], v224 offset:32768
    v_mfma_f32_16x16x32_bf16 v[164:167], v[84:87], a[112:115], v[164:167]
    ds_read_b128 v[68:71], v224 offset:34816
    v_mfma_f32_16x16x32_bf16 v[168:171], v[80:83], a[116:119], v[168:171]
    ds_read_b128 v[72:75], v224 offset:36864
    s_add_u32 s38, s36, 65536
    buffer_store_dwordx4 v[4:7], v240, s[16:19], s38 offen offset:3584 sc1
    v_mfma_f32_16x16x32_bf16 v[172:175], v[84:87], a[116:119], v[172:175]
    ds_read_b128 v[76:79], v224 offset:38912
    v_mfma_f32_16x16x32_bf16 v[176:179], v[80:83], a[120:123], v[176:179]
    v_mfma_f32_16x16x32_bf16 v[180:183], v[84:87], a[120:123], v[180:183]
    v_mfma_f32_16x16x32_bf16 v[184:187], v[80:83], a[124:127], v[184:187]
    v_mfma_f32_16x16x32_bf16 v[188:191], v[84:87], a[124:127], v[188:191]
    v_mfma_f32_16x16x32_bf16 v[192:195], v[88:91], a[112:115], v[192:195]
    v_mfma_f32_16x16x32_bf16 v[196:199], v[92:95], a[112:115], v[196:199]
    v_mfma_f32_16x16x32_bf16 v[200:203], v[88:91], a[116:119], v[200:203]
    v_mfma_f32_16x16x32_bf16 v[204:207], v[92:95], a[116:119], v[204:207]
    v_mfma_f32_16x16x32_bf16 v[208:211], v[88:91], a[120:123], v[208:211]
    v_mfma_f32_16x16x32_bf16 v[212:215], v[92:95], a[120:123], v[212:215]
    v_mfma_f32_16x16x32_bf16 v[216:219], v[88:91], a[124:127], v[216:219]
    v_mfma_f32_16x16x32_bf16 v[220:223], v[92:95], a[124:127], v[220:223]
    s_waitcnt lgkmcnt(0)
    v_mfma_f32_16x16x32_bf16 v[160:163], v[64:67], a[128:131], v[160:163]
    ds_read_b128 v[80:83], v225 offset:32768
    v_mfma_f32_16x16x32_bf16 v[164:167], v[68:71], a[128:131], v[164:167]
    ds_read_b128 v[84:87], v225 offset:34816
    v_mfma_f32_16x16x32_bf16 v[168:171], v[64:67], a[132:135], v[168:171]
    ds_read_b128 v[88:91], v225 offset:36864
    v_mfma_f32_16x16x32_bf16 v[172:175], v[68:71], a[132:135], v[172:175]
    ds_read_b128 v[92:95], v225 offset:38912
    v_mfma_f32_16x16x32_bf16 v[176:179], v[64:67], a[136:139], v[176:179]
    v_mfma_f32_16x16x32_bf16 v[180:183], v[68:71], a[136:139], v[180:183]
    v_mfma_f32_16x16x32_bf16 v[184:187], v[64:67], a[140:143], v[184:187]
    v_mfma_f32_16x16x32_bf16 v[188:191], v[68:71], a[140:143], v[188:191]
    v_mfma_f32_16x16x32_bf16 v[192:195], v[72:75], a[128:131], v[192:195]
    buffer_load_dword v254, off, s[88:91], s39 sc1
    s_add_u32 s38, s36, 69632
    buffer_store_dwordx4 v[8:11], v240, s[16:19], s38 offen offset:512 sc1
    v_mfma_f32_16x16x32_bf16 v[196:199], v[76:79], a[128:131], v[196:199]
    v_mfma_f32_16x16x32_bf16 v[200:203], v[72:75], a[132:135], v[200:203]
    v_mfma_f32_16x16x32_bf16 v[204:207], v[76:79], a[132:135], v[204:207]
    v_mfma_f32_16x16x32_bf16 v[208:211], v[72:75], a[136:139], v[208:211]
    v_mfma_f32_16x16x32_bf16 v[212:215], v[76:79], a[136:139], v[212:215]
    v_mfma_f32_16x16x32_bf16 v[216:219], v[72:75], a[140:143], v[216:219]
    v_mfma_f32_16x16x32_bf16 v[220:223], v[76:79], a[140:143], v[220:223]
    s_waitcnt lgkmcnt(0)
    v_mfma_f32_16x16x32_bf16 v[160:163], v[80:83], a[144:147], v[160:163]
    ds_read_b128 v[64:67], v224 offset:40960
    v_mfma_f32_16x16x32_bf16 v[164:167], v[84:87], a[144:147], v[164:167]
    ds_read_b128 v[68:71], v224 offset:43008
    v_mfma_f32_16x16x32_bf16 v[168:171], v[80:83], a[148:151], v[168:171]
    ds_read_b128 v[72:75], v224 offset:45056
    v_mfma_f32_16x16x32_bf16 v[172:175], v[84:87], a[148:151], v[172:175]
    ds_read_b128 v[76:79], v224 offset:47104
    v_mfma_f32_16x16x32_bf16 v[176:179], v[80:83], a[152:155], v[176:179]
    v_mfma_f32_16x16x32_bf16 v[180:183], v[84:87], a[152:155], v[180:183]
    v_mfma_f32_16x16x32_bf16 v[184:187], v[80:83], a[156:159], v[184:187]
    v_mfma_f32_16x16x32_bf16 v[188:191], v[84:87], a[156:159], v[188:191]
    v_mfma_f32_16x16x32_bf16 v[192:195], v[88:91], a[144:147], v[192:195]
    v_mfma_f32_16x16x32_bf16 v[196:199], v[92:95], a[144:147], v[196:199]
    v_mfma_f32_16x16x32_bf16 v[200:203], v[88:91], a[148:151], v[200:203]
    v_mfma_f32_16x16x32_bf16 v[204:207], v[92:95], a[148:151], v[204:207]
    v_mfma_f32_16x16x32_bf16 v[208:211], v[88:91], a[152:155], v[208:211]
    v_mfma_f32_16x16x32_bf16 v[212:215], v[92:95], a[152:155], v[212:215]
    s_add_u32 s38, s36, 69632
    buffer_store_dwordx4 v[12:15], v240, s[16:19], s38 offen offset:1536 sc1
    v_mfma_f32_16x16x32_bf16 v[216:219], v[88:91], a[156:159], v[216:219]
    v_mfma_f32_16x16x32_bf16 v[220:223], v[92:95], a[156:159], v[220:223]
    s_waitcnt lgkmcnt(0)
    v_mfma_f32_16x16x32_bf16 v[160:163], v[64:67], a[160:163], v[160:163]
    ds_read_b128 v[80:83], v225 offset:40960
    v_mfma_f32_16x16x32_bf16 v[164:167], v[68:71], a[160:163], v[164:167]
    ds_read_b128 v[84:87], v225 offset:43008
    v_mfma_f32_16x16x32_bf16 v[168:171], v[64:67], a[164:167], v[168:171]
    ds_read_b128 v[88:91], v225 offset:45056
    v_mfma_f32_16x16x32_bf16 v[172:175], v[68:71], a[164:167], v[172:175]
    ds_read_b128 v[92:95], v225 offset:47104
    v_mfma_f32_16x16x32_bf16 v[176:179], v[64:67], a[168:171], v[176:179]
    v_mfma_f32_16x16x32_bf16 v[180:183], v[68:71], a[168:171], v[180:183]
    v_mfma_f32_16x16x32_bf16 v[184:187], v[64:67], a[172:175], v[184:187]
    v_mfma_f32_16x16x32_bf16 v[188:191], v[68:71], a[172:175], v[188:191]
    v_mfma_f32_16x16x32_bf16 v[192:195], v[72:75], a[160:163], v[192:195]
    v_mfma_f32_16x16x32_bf16 v[196:199], v[76:79], a[160:163], v[196:199]
    v_mfma_f32_16x16x32_bf16 v[200:203], v[72:75], a[164:167], v[200:203]
    v_mfma_f32_16x16x32_bf16 v[204:207], v[76:79], a[164:167], v[204:207]
    v_mfma_f32_16x16x32_bf16 v[208:211], v[72:75], a[168:171], v[208:211]
    v_mfma_f32_16x16x32_bf16 v[212:215], v[76:79], a[168:171], v[212:215]
    v_mfma_f32_16x16x32_bf16 v[216:219], v[72:75], a[172:175], v[216:219]
    v_mfma_f32_16x16x32_bf16 v[220:223], v[76:79], a[172:175], v[220:223]
    s_waitcnt lgkmcnt(0)
    v_mfma_f32_16x16x32_bf16 v[160:163], v[80:83], a[176:179], v[160:163]
    ds_read_b128 v[64:67], v224 offset:49152
    v_mfma_f32_16x16x32_bf16 v[164:167], v[84:87], a[176:179], v[164:167]
    ds_read_b128 v[68:71], v224 offset:51200
    v_mfma_f32_16x16x32_bf16 v[168:171], v[80:83], a[180:183], v[168:171]
    ds_read_b128 v[72:75], v224 offset:53248
    v_mfma_f32_16x16x32_bf16 v[172:175], v[84:87], a[180:183], v[172:175]
    ds_read_b128 v[76:79], v224 offset:55296
    s_add_u32 s38, s36, 73728
    buffer_store_dwordx4 v[16:19], v240, s[16:19], s38 offen offset:2560 sc1
    v_mfma_f32_16x16x32_bf16 v[176:179], v[80:83], a[184:187], v[176:179]
    v_mfma_f32_16x16x32_bf16 v[180:183], v[84:87], a[184:187], v[180:183]
    v_mfma_f32_16x16x32_bf16 v[184:187], v[80:83], a[188:191], v[184:187]
    v_mfma_f32_16x16x32_bf16 v[188:191], v[84:87], a[188:191], v[188:191]
    v_mfma_f32_16x16x32_bf16 v[192:195], v[88:91], a[176:179], v[192:195]
    v_mfma_f32_16x16x32_bf16 v[196:199], v[92:95], a[176:179], v[196:199]
    v_mfma_f32_16x16x32_bf16 v[200:203], v[88:91], a[180:183], v[200:203]
    v_mfma_f32_16x16x32_bf16 v[204:207], v[92:95], a[180:183], v[204:207]
    v_mfma_f32_16x16x32_bf16 v[208:211], v[88:91], a[184:187], v[208:211]
    v_mfma_f32_16x16x32_bf16 v[212:215], v[92:95], a[184:187], v[212:215]
    v_mfma_f32_16x16x32_bf16 v[216:219], v[88:91], a[188:191], v[216:219]
    v_mfma_f32_16x16x32_bf16 v[220:223], v[92:95], a[188:191], v[220:223]
    s_waitcnt vmcnt(3)
    v_readfirstlane_b32 s24, v254
    s_lshl_b32 s25, s3, 16
    s_add_u32 s24, s24, s25
    s_cmp_ge_u32 s24, 32
    s_cbranch_scc0 kf_spin37
kf_spinr38:
    s_waitcnt lgkmcnt(0)
    s_barrier
    v_mfma_f32_16x16x32_bf16 v[160:163], v[64:67], a[192:195], v[160:163]
    ds_read_b128 v[80:83], v225 offset:49152
    v_mfma_f32_16x16x32_bf16 v[164:167], v[68:71], a[192:195], v[164:167]
    ds_read_b128 v[84:87], v225 offset:51200
    v_mfma_f32_16x16x32_bf16 v[168:171], v[64:67], a[196:199], v[168:171]
    ds_read_b128 v[88:91], v225 offset:53248
    v_mfma_f32_16x16x32_bf16 v[172:175], v[68:71], a[196:199], v[172:175]
    ds_read_b128 v[92:95], v225 offset:55296
    v_mfma_f32_16x16x32_bf16 v[176:179], v[64:67], a[200:203], v[176:179]
    v_mfma_f32_16x16x32_bf16 v[180:183], v[68:71], a[200:203], v[180:183]
    v_mfma_f32_16x16x32_bf16 v[184:187], v[64:67], a[204:207], v[184:187]
    v_mfma_f32_16x16x32_bf16 v[188:191], v[68:71], a[204:207], v[188:191]
    v_mfma_f32_16x16x32_bf16 v[192:195], v[72:75], a[192:195], v[192:195]
    buffer_load_dwordx4 a[128:131], v248, s[8:11], s28 offen offset:0 sc1
    s_add_u32 s38, s36, 73728
    buffer_store_dwordx4 v[20:23], v240, s[16:19], s38 offen offset:3584 sc1
    v_mfma_f32_16x16x32_bf16 v[196:199], v[76:79], a[192:195], v[196:199]
    v_mfma_f32_16x16x32_bf16 v[200:203], v[72:75], a[196:199], v[200:203]
    buffer_load_dwordx4 a[132:135], v248, s[8:11], s29 offen offset:0 sc1
    v_mfma_f32_16x16x32_bf16 v[204:207], v[76:79], a[196:199], v[204:207]
    v_mfma_f32_16x16x32_bf16 v[208:211], v[72:75], a[200:203], v[208:211]
    v_mfma_f32_16x16x32_bf16 v[212:215], v[76:79], a[200:203], v[212:215]
    buffer_load_dwordx4 a[136:139], v249, s[8:11], s28 offen offset:0 sc1
    v_mfma_f32_16x16x32_bf16 v[216:219], v[72:75], a[204:207], v[216:219]
    v_mfma_f32_16x16x32_bf16 v[220:223], v[76:79], a[204:207], v[220:223]
    s_waitcnt lgkmcnt(0)
    v_mfma_f32_16x16x32_bf16 v[160:163], v[80:83], a[208:211], v[160:163]
    ds_read_b128 v[64:67], v224 offset:57344
    v_mfma_f32_16x16x32_bf16 v[164:167], v[84:87], a[208:211], v[164:167]
    ds_read_b128 v[68:71], v224 offset:59392
    v_mfma_f32_16x16x32_bf16 v[168:171], v[80:83], a[212:215], v[168:171]
    ds_read_b128 v[72:75], v224 offset:61440
    v_mfma_f32_16x16x32_bf16 v[172:175], v[84:87], a[212:215], v[172:175]
    ds_read_b128 v[76:79], v224 offset:63488
    v_mfma_f32_16x16x32_bf16 v[176:179], v[80:83], a[216:219], v[176:179]
    v_mfma_f32_16x16x32_bf16 v[180:183], v[84:87], a[216:219], v[180:183]
    v_mfma_f32_16x16x32_bf16 v[184:187], v[80:83], a[220:223], v[184:187]
    v_mfma_f32_16x16x32_bf16 v[188:191], v[84:87], a[220:223], v[188:191]
    v_mfma_f32_16x16x32_bf16 v[192:195], v[88:91], a[208:211], v[192:195]
    buffer_load_dwordx4 a[140:143], v249, s[8:11], s29 offen offset:0 sc1
    v_mfma_f32_16x16x32_bf16 v[196:199], v[92:95], a[208:211], v[196:199]
    v_mfma_f32_16x16x32_bf16 v[200:203], v[88:91], a[212:215], v[200:203]
    buffer_load_dwordx4 a[144:147], v248, s[8:11], s28 offen offset:1024 sc1
    v_mfma_f32_16x16x32_bf16 v[204:207], v[92:95], a[212:215], v[204:207]
    v_mfma_f32_16x16x32_bf16 v[208:211], v[88:91], a[216:219], v[208:211]
    v_mfma_f32_16x16x32_bf16 v[212:215], v[92:95], a[216:219], v[212:215]
    buffer_load_dwordx4 a[148:151], v248, s[8:11], s29 offen offset:1024 sc1
    v_mfma_f32_16x16x32_bf16 v[216:219], v[88:91], a[220:223], v[216:219]
    s_add_u32 s38, s36, 77824
    buffer_store_dwordx4 v[24:27], v240, s[16:19], s38 offen offset:512 sc1
    v_mfma_f32_16x16x32_bf16 v[220:223], v[92:95], a[220:223], v[220:223]
    s_waitcnt lgkmcnt(0)
    v_mfma_f32_16x16x32_bf16 v[160:163], v[64:67], a[224:227], v[160:163]
    ds_read_b128 v[80:83], v225 offset:57344
    v_mfma_f32_16x16x32_bf16 v[164:167], v[68:71], a[224:227], v[164:167]
    ds_read_b128 v[84:87], v225 offset:59392
    v_mfma_f32_16x16x32_bf16 v[168:171], v[64:67], a[228:231], v[168:171]
    ds_read_b128 v[88:91], v225 offset:61440
    v_mfma_f32_16x16x32_bf16 v[172:175], v[68:71], a[228:231], v[172:175]
    ds_read_b128 v[92:95], v225 offset:63488
    v_mfma_f32_16x16x32_bf16 v[176:179], v[64:67], a[232:235], v[176:179]
    v_mfma_f32_16x16x32_bf16 v[180:183], v[68:71], a[232:235], v[180:183]
    v_mfma_f32_16x16x32_bf16 v[184:187], v[64:67], a[236:239], v[184:187]
    v_mfma_f32_16x16x32_bf16 v[188:191], v[68:71], a[236:239], v[188:191]
    v_mfma_f32_16x16x32_bf16 v[192:195], v[72:75], a[224:227], v[192:195]
    buffer_load_dwordx4 a[152:155], v249, s[8:11], s28 offen offset:1024 sc1
    v_mfma_f32_16x16x32_bf16 v[196:199], v[76:79], a[224:227], v[196:199]
    v_mfma_f32_16x16x32_bf16 v[200:203], v[72:75], a[228:231], v[200:203]
    buffer_load_dwordx4 a[156:159], v249, s[8:11], s29 offen offset:1024 sc1
    v_mfma_f32_16x16x32_bf16 v[204:207], v[76:79], a[228:231], v[204:207]
    v_mfma_f32_16x16x32_bf16 v[208:211], v[72:75], a[232:235], v[208:211]
    v_mfma_f32_16x16x32_bf16 v[212:215], v[76:79], a[232:235], v[212:215]
    buffer_load_dwordx4 a[160:163], v248, s[8:11], s28 offen offset:2048 sc1
    v_mfma_f32_16x16x32_bf16 v[216:219], v[72:75], a[236:239], v[216:219]
    v_mfma_f32_16x16x32_bf16 v[220:223], v[76:79], a[236:239], v[220:223]
    s_waitcnt vmcnt(38) lgkmcnt(0)
    s_barrier
    v_mfma_f32_16x16x32_bf16 v[160:163], v[80:83], a[240:243], v[160:163]
    ds_read_b64_tr_b16 a[192:193], v246 offset:0
    v_mfma_f32_16x16x32_bf16 v[164:167], v[84:87], a[240:243], v[164:167]
    ds_read_b64_tr_b16 a[194:195], v246 offset:1024
    v_mfma_f32_16x16x32_bf16 v[168:171], v[80:83], a[244:247], v[168:171]
    ds_read_b64_tr_b16 a[196:197], v238 offset:0
    v_mfma_f32_16x16x32_bf16 v[172:175], v[84:87], a[244:247], v[172:175]
    ds_read_b64_tr_b16 a[198:199], v238 offset:1024
    v_mfma_f32_16x16x32_bf16 v[176:179], v[80:83], a[248:251], v[176:179]
    ds_read_b64_tr_b16 a[200:201], v246 offset:256
    s_add_u32 s38, s36, 77824
    buffer_store_dwordx4 v[28:31], v240, s[16:19], s38 offen offset:1536 sc1
    v_mfma_f32_16x16x32_bf16 v[180:183], v[84:87], a[248:251], v[180:183]
    ds_read_b64_tr_b16 a[202:203], v246 offset:1280
    v_mfma_f32_16x16x32_bf16 v[184:187], v[80:83], a[252:255], v[184:187]
    ds_read_b64_tr_b16 a[204:205], v238 offset:256
    v_mfma_f32_16x16x32_bf16 v[188:191], v[84:87], a[252:255], v[188:191]
    ds_read_b64_tr_b16 a[206:207], v238 offset:1280
    v_mfma_f32_16x16x32_bf16 v[192:195], v[88:91], a[240:243], v[192:195]
    buffer_load_dwordx4 a[164:167], v248, s[8:11], s29 offen offset:2048 sc1
    v_mfma_f32_16x16x32_bf16 v[196:199], v[92:95], a[240:243], v[196:199]
    v_cvt_pk_bf16_f32 v32, v160, v161
    v_cvt_pk_bf16_f32 v33, v162, v163
    v_mfma_f32_16x16x32_bf16 v[200:203], v[88:91], a[244:247], v[200:203]
    buffer_load_dwordx4 a[168:171], v249, s[8:11], s28 offen offset:2048 sc1
    v_cvt_pk_bf16_f32 v34, v164, v165
    v_cvt_pk_bf16_f32 v35, v166, v167
    v_mfma_f32_16x16x32_bf16 v[204:207], v[92:95], a[244:247], v[204:207]
    v_cvt_pk_bf16_f32 v36, v168, v169
    v_cvt_pk_bf16_f32 v37, v170, v171
    v_mfma_f32_16x16x32_bf16 v[208:211], v[88:91], a[248:251], v[208:211]
    v_cvt_pk_bf16_f32 v38, v172, v173
    v_cvt_pk_bf16_f32 v39, v174, v175
    v_mfma_f32_16x16x32_bf16 v[212:215], v[92:95], a[248:251], v[212:215]
    buffer_load_dwordx4 a[172:175], v249, s[8:11], s29 offen offset:2048 sc1
    v_cvt_pk_bf16_f32 v40, v176, v177
    v_cvt_pk_bf16_f32 v41, v178, v179
    v_mfma_f32_16x16x32_bf16 v[216:219], v[88:91], a[252:255], v[216:219]
    v_cvt_pk_bf16_f32 v42, v180, v181
    v_cvt_pk_bf16_f32 v43, v182, v183
    v_mfma_f32_16x16x32_bf16 v[220:223], v[92:95], a[252:255], v[220:223]
    v_cvt_pk_bf16_f32 v44, v184, v185
    v_cvt_pk_bf16_f32 v45, v186, v187
    s_nop 3
    v_cvt_pk_bf16_f32 v46, v188, v189
    v_cvt_pk_bf16_f32 v47, v190, v191
    v_cvt_pk_bf16_f32 v48, v192, v193
    v_cvt_pk_bf16_f32 v49, v194, v195
    v_cvt_pk_bf16_f32 v50, v196, v197
    v_cvt_pk_bf16_f32 v51, v198, v199
    v_cvt_pk_bf16_f32 v52, v200, v201
    v_cvt_pk_bf16_f32 v53, v202, v203
    v_cvt_pk_bf16_f32 v54, v204, v205
    v_cvt_pk_bf16_f32 v55, v206, v207
    v_cvt_pk_bf16_f32 v56, v208, v209
    v_cvt_pk_bf16_f32 v57, v210, v211
    v_cvt_pk_bf16_f32 v58, v212, v213
    v_cvt_pk_bf16_f32 v59, v214, v215
    v_cvt_pk_bf16_f32 v60, v216, v217
    v_cvt_pk_bf16_f32 v61, v218, v219
    v_cvt_pk_bf16_f32 v62, v220, v221
    v_cvt_pk_bf16_f32 v63, v222, v223
    s_add_u32 s80, s36, 102144
    s_add_u32 s81, s36, 103168
    s_add_u32 s82, s36, 104192
    s_add_u32 s83, s36, 105216
    s_add_u32 s84, s36, 110336
    s_add_u32 s85, s36, 111360
    s_add_u32 s86, s36, 112384
    s_add_u32 s87, s36, 113408
ka_Q:
    s_waitcnt vmcnt(10) lgkmcnt(0)
    v_mfma_f32_16x16x32_bf16 v[96:99], a[192:195], a[128:131], 0
    ds_read_b64_tr_b16 a[208:209], v246 offset:512
    s_lshl_b32 s97, s4, 7
    v_mfma_f32_16x16x32_bf16 v[100:103], a[192:195], a[132:135], 0
    ds_read_b64_tr_b16 a[210:211], v246 offset:1536
    s_add_u32 s97, s97, 12288
    s_cmp_eq_u32 s3, 0
    s_cselect_b32 s35, s97, s43
    v_mfma_f32_16x16x32_bf16 v[104:107], a[192:195], a[136:139], 0
    ds_read_b64_tr_b16 a[212:213], v238 offset:512
    s_lshl_b32 s37, s3, 12
    v_mfma_f32_16x16x32_bf16 v[108:111], a[192:195], a[140:143], 0
    ds_read_b64_tr_b16 a[214:215], v238 offset:1536
    s_mov_b32 s34, s37
    s_mul_i32 s32, s4, 1089536
    v_mfma_f32_16x16x32_bf16 v[112:115], a[196:199], a[128:131], 0
    ds_read_b64_tr_b16 a[216:217], v246 offset:768
    s_mov_b32 s33, 0
    v_mfma_f32_16x16x32_bf16 v[116:119], a[196:199], a[132:135], 0
    ds_read_b64_tr_b16 a[218:219], v246 offset:1792
    s_lshl_b32 s39, s6, 18
    v_mfma_f32_16x16x32_bf16 v[120:123], a[196:199], a[136:139], 0
    ds_read_b64_tr_b16 a[220:221], v238 offset:768
    s_sub_u32 s25, 63, s6
    s_lshl_b32 s40, s25, 18
    v_mfma_f32_16x16x32_bf16 v[124:127], a[196:199], a[140:143], 0
    ds_read_b64_tr_b16 a[222:223], v238 offset:1792
    s_lshl_b32 s25, s4, 12
    v_mfma_f32_16x16x32_bf16 v[128:131], a[200:203], a[128:131], 0
    buffer_load_dwordx4 a[176:179], v248, s[8:11], s28 offen offset:3072 sc1
    s_add_u32 s39, s39, s25
    s_add_u32 s40, s40, s25
    v_mfma_f32_16x16x32_bf16 v[132:135], a[200:203], a[132:135], 0
    s_mov_b32 s38, 0x47800000
    s_mov_b32 s36, s6
    v_mfma_f32_16x16x32_bf16 v[136:139], a[200:203], a[136:139], 0
    buffer_load_dwordx4 a[180:183], v248, s[8:11], s29 offen offset:3072 sc1
    s_mov_b32 s26, 6
    v_mfma_f32_16x16x32_bf16 v[140:143], a[200:203], a[140:143], 0
    s_add_u32 m0, s31, 0
    s_add_u32 s24, s27, 0
    s_mov_b32 s52, s41
    v_mfma_f32_16x16x32_bf16 v[144:147], a[204:207], a[128:131], 0
    buffer_load_dwordx4 v245, s[12:15], s24 offen lds
    s_mov_b32 s53, s42
    v_mfma_f32_16x16x32_bf16 v[148:151], a[204:207], a[132:135], 0
    s_mov_b32 s54, 0x700000
    s_add_u32 s48, s20, 0x1c00000
    s_addc_u32 s49, s21, 0
    v_mfma_f32_16x16x32_bf16 v[152:155], a[204:207], a[136:139], 0
    buffer_store_dwordx4 v[32:35], v240, s[16:19], s80 offen sc1
    s_mov_b32 s50, 0x1c00000
    s_and_b32 s25, s3, 1
    v_mfma_f32_16x16x32_bf16 v[156:159], a[204:207], a[140:143], 0
    s_lshl1_add_u32 s47, s4, s25
    s_waitcnt lgkmcnt(0)
    v_mfma_f32_16x16x32_bf16 v[160:163], a[208:211], a[128:131], 0
    ds_read_b64_tr_b16 a[192:193], v246 offset:8192
    s_lshr_b32 s101, s3, 1
    v_mfma_f32_16x16x32_bf16 v[164:167], a[208:211], a[132:135], 0
    ds_read_b64_tr_b16 a[194:195], v246 offset:9216
    s_add_u32 s45, s5, s101
    s_sub_u32 s45, s45, 1
    v_mfma_f32_16x16x32_bf16 v[168:171], a[208:211], a[136:139], 0
    ds_read_b64_tr_b16 a[196:197], v238 offset:8192
    s_mul_i32 s45, s45, s5
    v_mfma_f32_16x16x32_bf16 v[172:175], a[208:211], a[140:143], 0
    ds_read_b64_tr_b16 a[198:199], v238 offset:9216
    s_lshl_b32 s100, s101, 14
    s_add_u32 s100, s100, 114688
    v_mfma_f32_16x16x32_bf16 v[176:179], a[212:215], a[128:131], 0
    ds_read_b64_tr_b16 a[200:201], v246 offset:8448
    s_mul_i32 s100, s100, s47
    v_mfma_f32_16x16x32_bf16 v[180:183], a[212:215], a[132:135], 0
    ds_read_b64_tr_b16 a[202:203], v246 offset:9472
    s_lshl_b32 s25, s45, 11
    v_mfma_f32_16x16x32_bf16 v[184:187], a[212:215], a[136:139], 0
    ds_read_b64_tr_b16 a[204:205], v238 offset:8448
    s_add_u32 s100, s100, s25
    s_lshl_b32 s46, s47, 9
    v_mfma_f32_16x16x32_bf16 v[188:191], a[212:215], a[140:143], 0
    ds_read_b64_tr_b16 a[206:207], v238 offset:9472
    s_mul_i32 s44, s47, 114688
    v_mfma_f32_16x16x32_bf16 v[192:195], a[216:219], a[128:131], 0
    buffer_load_dwordx4 a[184:187], v249, s[8:11], s28 offen offset:3072 sc1
    s_add_u32 s47, s44, 7168
    s_lshl_b32 s25, s45, 7
    v_mfma_f32_16x16x32_bf16 v[196:199], a[216:219], a[132:135], 0
    s_add_u32 s44, s44, s25
    s_lshl_b32 s45, s45, 18
    v_mfma_f32_16x16x32_bf16 v[200:203], a[216:219], a[136:139], 0
    buffer_load_dwordx4 a[188:191], v249, s[8:11], s29 offen offset:3072 sc1
    s_add_u32 s46, s46, s45
    v_mfma_f32_16x16x32_bf16 v[204:207], a[216:219], a[140:143], 0
    s_add_u32 m0, s31, 1024
    s_add_u32 s24, s27, 32768
    s_lshr_b32 s25, s3, 1
    v_mfma_f32_16x16x32_bf16 v[208:211], a[220:223], a[128:131], 0
    buffer_load_dwordx4 v245, s[12:15], s24 offen lds
    s_lshl_b32 s25, s25, 15
    v_mfma_f32_16x16x32_bf16 v[212:215], a[220:223], a[132:135], 0
    s_add_u32 s46, s46, s25
    s_mov_b32 s45, s43
    v_mfma_f32_16x16x32_bf16 v[216:219], a[220:223], a[136:139], 0
    s_add_u32 s28, s28, 4096
    s_and_b32 s28, s28, 32767
    buffer_store_dwordx4 v[36:39], v240, s[16:19], s81 offen sc1
    v_mfma_f32_16x16x32_bf16 v[220:223], a[220:223], a[140:143], 0
    s_add_u32 s29, s28, 32768
    v_accvgpr_write_b32 a0, 0
    s_waitcnt vmcnt(13) lgkmcnt(0)
    v_mfma_f32_16x16x32_bf16 v[96:99], a[192:195], a[144:147], v[96:99]
    ds_read_b64_tr_b16 a[208:209], v246 offset:8704
    s_load_dwordx2 s[56:57], s[0:1], 40
    v_accvgpr_write_b32 a1, 0
    v_mfma_f32_16x16x32_bf16 v[100:103], a[192:195], a[148:151], v[100:103]
    ds_read_b64_tr_b16 a[210:211], v246 offset:9728
    v_accvgpr_write_b32 a2, 0
    v_mfma_f32_16x16x32_bf16 v[104:107], a[192:195], a[152:155], v[104:107]
    ds_read_b64_tr_b16 a[212:213], v238 offset:8704
    v_accvgpr_write_b32 a3, 0
    v_mfma_f32_16x16x32_bf16 v[108:111], a[192:195], a[156:159], v[108:111]
    ds_read_b64_tr_b16 a[214:215], v238 offset:9728
    v_accvgpr_write_b32 a4, 0
    v_accvgpr_write_b32 a5, 0
    v_mfma_f32_16x16x32_bf16 v[112:115], a[196:199], a[144:147], v[112:115]
    ds_read_b64_tr_b16 a[216:217], v246 offset:8960
    v_accvgpr_write_b32 a6, 0
    v_mfma_f32_16x16x32_bf16 v[116:119], a[196:199], a[148:151], v[116:119]
    ds_read_b64_tr_b16 a[218:219], v246 offset:9984
    v_accvgpr_write_b32 a7, 0
    v_accvgpr_write_b32 a8, 0
    v_mfma_f32_16x16x32_bf16 v[120:123], a[196:199], a[152:155], v[120:123]
    ds_read_b64_tr_b16 a[220:221], v238 offset:8960
    v_accvgpr_write_b32 a9, 0
    v_mfma_f32_16x16x32_bf16 v[124:127], a[196:199], a[156:159], v[124:127]
    ds_read_b64_tr_b16 a[222:223], v238 offset:9984
    v_accvgpr_write_b32 a10, 0
    v_mfma_f32_16x16x32_bf16 v[128:131], a[200:203], a[144:147], v[128:131]
    buffer_load_dwordx4 a[128:131], v248, s[8:11], s28 offen offset:0 sc1
    v_accvgpr_write_b32 a11, 0
    v_accvgpr_write_b32 a12, 0
    v_mfma_f32_16x16x32_bf16 v[132:135], a[200:203], a[148:151], v[132:135]
    v_accvgpr_write_b32 a13, 0
    v_accvgpr_write_b32 a14, 0
    v_mfma_f32_16x16x32_bf16 v[136:139], a[200:203], a[152:155], v[136:139]
    buffer_load_dwordx4 a[132:135], v248, s[8:11], s29 offen offset:0 sc1
    v_accvgpr_write_b32 a15, 0
    v_mfma_f32_16x16x32_bf16 v[140:143], a[200:203], a[156:159], v[140:143]
    s_add_u32 m0, s31, 2048
    s_add_u32 s24, s27, 65536
    v_accvgpr_write_b32 a16, 0
    v_mfma_f32_16x16x32_bf16 v[144:147], a[204:207], a[144:147], v[144:147]
    buffer_load_dwordx4 v237, s[12:15], s24 offen lds
    v_accvgpr_write_b32 a17, 0
    v_mfma_f32_16x16x32_bf16 v[148:151], a[204:207], a[148:151], v[148:151]
    v_accvgpr_write_b32 a18, 0
    v_accvgpr_write_b32 a19, 0
    v_accvgpr_write_b32 a20, 0
    v_mfma_f32_16x16x32_bf16 v[152:155], a[204:207], a[152:155], v[152:155]
    buffer_store_dwordx4 v[40:43], v240, s[16:19], s82 offen sc1
    v_accvgpr_write_b32 a21, 0
    v_mfma_f32_16x16x32_bf16 v[156:159], a[204:207], a[156:159], v[156:159]
    v_accvgpr_write_b32 a22, 0
    s_waitcnt lgkmcnt(0)
    v_mfma_f32_16x16x32_bf16 v[160:163], a[208:211], a[144:147], v[160:163]
    ds_read_b64_tr_b16 a[192:193], v246 offset:16384
    v_accvgpr_write_b32 a23, 0
    v_accvgpr_write_b32 a24, 0
    v_mfma_f32_16x16x32_bf16 v[164:167], a[208:211], a[148:151], v[164:167]
    ds_read_b64_tr_b16 a[194:195], v246 offset:17408
    v_accvgpr_write_b32 a25, 0
    v_mfma_f32_16x16x32_bf16 v[168:171], a[208:211], a[152:155], v[168:171]
    ds_read_b64_tr_b16 a[196:197], v238 offset:16384
    v_accvgpr_write_b32 a26, 0
    v_mfma_f32_16x16x32_bf16 v[172:175], a[208:211], a[156:159], v[172:175]
    ds_read_b64_tr_b16 a[198:199], v238 offset:17408
    v_accvgpr_write_b32 a27, 0
    v_accvgpr_write_b32 a28, 0
    v_mfma_f32_16x16x32_bf16 v[176:179], a[212:215], a[144:147], v[176:179]
    ds_read_b64_tr_b16 a[200:201], v246 offset:16640
    v_accvgpr_write_b32 a29, 0
    v_mfma_f32_16x16x32_bf16 v[180:183], a[212:215], a[148:151], v[180:183]
    ds_read_b64_tr_b16 a[202:203], v246 offset:17664
    v_accvgpr_write_b32 a30, 0
    v_accvgpr_write_b32 a31, 0
    v_mfma_f32_16x16x32_bf16 v[184:187], a[212:215], a[152:155], v[184:187]
    ds_read_b64_tr_b16 a[204:205], v238 offset:16640
    v_accvgpr_write_b32 a32, 0
    v_mfma_f32_16x16x32_bf16 v[188:191], a[212:215], a[156:159], v[188:191]
    ds_read_b64_tr_b16 a[206:207], v238 offset:17664
    v_accvgpr_write_b32 a33, 0
    v_mfma_f32_16x16x32_bf16 v[192:195], a[216:219], a[144:147], v[192:195]
    buffer_load_dwordx4 a[136:139], v249, s[8:11], s28 offen offset:0 sc1
    v_accvgpr_write_b32 a34, 0
    v_accvgpr_write_b32 a35, 0
    v_mfma_f32_16x16x32_bf16 v[196:199], a[216:219], a[148:151], v[196:199]
    v_accvgpr_write_b32 a36, 0
    v_accvgpr_write_b32 a37, 0
    v_mfma_f32_16x16x32_bf16 v[200:203], a[216:219], a[152:155], v[200:203]
    buffer_load_dwordx4 a[140:143], v249, s[8:11], s29 offen offset:0 sc1
    v_accvgpr_write_b32 a38, 0
    v_mfma_f32_16x16x32_bf16 v[204:207], a[216:219], a[156:159], v[204:207]
    s_add_u32 m0, s31, 3072
    s_add_u32 s24, s27, 98304
    v_accvgpr_write_b32 a39, 0
    v_mfma_f32_16x16x32_bf16 v[208:211], a[220:223], a[144:147], v[208:211]
    buffer_load_dwordx4 v237, s[12:15], s24 offen lds
    v_accvgpr_write_b32 a40, 0
    v_mfma_f32_16x16x32_bf16 v[212:215], a[220:223], a[148:151], v[212:215]
    v_accvgpr_write_b32 a41, 0
    v_accvgpr_write_b32 a42, 0
    v_accvgpr_write_b32 a43, 0
    v_mfma_f32_16x16x32_bf16 v[216:219], a[220:223], a[152:155], v[216:219]
    buffer_store_dwordx4 v[44:47], v240, s[16:19], s83 offen sc1
    v_accvgpr_write_b32 a44, 0
    v_mfma_f32_16x16x32_bf16 v[220:223], a[220:223], a[156:159], v[220:223]
    v_accvgpr_write_b32 a45, 0
    s_waitcnt vmcnt(16) lgkmcnt(0)
    v_mfma_f32_16x16x32_bf16 v[96:99], a[192:195], a[160:163], v[96:99]
    ds_read_b64_tr_b16 a[208:209], v246 offset:16896
    v_accvgpr_write_b32 a46, 0
    v_accvgpr_write_b32 a47, 0
    v_mfma_f32_16x16x32_bf16 v[100:103], a[192:195], a[164:167], v[100:103]
    ds_read_b64_tr_b16 a[210:211], v246 offset:17920
    v_accvgpr_write_b32 a48, 0
    v_mfma_f32_16x16x32_bf16 v[104:107], a[192:195], a[168:171], v[104:107]
    ds_read_b64_tr_b16 a[212:213], v238 offset:16896
    v_accvgpr_write_b32 a49, 0
    v_accvgpr_write_b32 a50, 0
    v_mfma_f32_16x16x32_bf16 v[108:111], a[192:195], a[172:175], v[108:111]
    ds_read_b64_tr_b16 a[214:215], v238 offset:17920
    v_accvgpr_write_b32 a51, 0
    v_mfma_f32_16x16x32_bf16 v[112:115], a[196:199], a[160:163], v[112:115]
    ds_read_b64_tr_b16 a[216:217], v246 offset:17152
    v_accvgpr_write_b32 a52, 0
    v_mfma_f32_16x16x32_bf16 v[116:119], a[196:199], a[164:167], v[116:119]
    ds_read_b64_tr_b16 a[218:219], v246 offset:18176
    v_accvgpr_write_b32 a53, 0
    v_accvgpr_write_b32 a54, 0
    v_mfma_f32_16x16x32_bf16 v[120:123], a[196:199], a[168:171], v[120:123]
    ds_read_b64_tr_b16 a[220:221], v238 offset:17152
    v_accvgpr_write_b32 a55, 0
    v_mfma_f32_16x16x32_bf16 v[124:127], a[196:199], a[172:175], v[124:127]
    ds_read_b64_tr_b16 a[222:223], v238 offset:18176
    v_accvgpr_write_b32 a56, 0
    v_accvgpr_write_b32 a57, 0
    v_mfma_f32_16x16x32_bf16 v[128:131], a[200:203], a[160:163], v[128:131]
    buffer_load_dwordx4 a[144:147], v248, s[8:11], s28 offen offset:1024 sc1
    v_accvgpr_write_b32 a58, 0
    v_mfma_f32_16x16x32_bf16 v[132:135], a[200:203], a[164:167], v[132:135]
    v_accvgpr_write_b32 a59, 0
    v_accvgpr_write_b32 a60, 0
    v_mfma_f32_16x16x32_bf16 v[136:139], a[200:203], a[168:171], v[136:139]
    buffer_load_dwordx4 a[148:151], v248, s[8:11], s29 offen offset:1024 sc1
    v_accvgpr_write_b32 a61, 0
    v_mfma_f32_16x16x32_bf16 v[140:143], a[200:203], a[172:175], v[140:143]
    s_add_u32 m0, s31, 4096
    s_add_u32 s24, s27, 131072
    v_accvgpr_write_b32 a62, 0
    v_mfma_f32_16x16x32_bf16 v[144:147], a[204:207], a[160:163], v[144:147]
    buffer_load_dwordx4 v245, s[12:15], s24 offen lds
    v_accvgpr_write_b32 a63, 0
    v_mfma_f32_16x16x32_bf16 v[148:151], a[204:207], a[164:167], v[148:151]
    v_accvgpr_write_b32 a64, 0
    v_accvgpr_write_b32 a65, 0
    v_accvgpr_write_b32 a66, 0
    v_mfma_f32_16x16x32_bf16 v[152:155], a[204:207], a[168:171], v[152:155]
    buffer_store_dwordx4 v[48:51], v240, s[16:19], s84 offen sc1
    v_accvgpr_write_b32 a67, 0
    v_mfma_f32_16x16x32_bf16 v[156:159], a[204:207], a[172:175], v[156:159]
    v_accvgpr_write_b32 a68, 0
    s_waitcnt lgkmcnt(0)
    v_mfma_f32_16x16x32_bf16 v[160:163], a[208:211], a[160:163], v[160:163]
    ds_read_b64_tr_b16 a[192:193], v246 offset:24576
    v_accvgpr_write_b32 a69, 0
    v_accvgpr_write_b32 a70, 0
    v_mfma_f32_16x16x32_bf16 v[164:167], a[208:211], a[164:167], v[164:167]
    ds_read_b64_tr_b16 a[194:195], v246 offset:25600
    v_accvgpr_write_b32 a71, 0
    v_mfma_f32_16x16x32_bf16 v[168:171], a[208:211], a[168:171], v[168:171]
    ds_read_b64_tr_b16 a[196:197], v238 offset:24576
    v_accvgpr_write_b32 a72, 0
    v_accvgpr_write_b32 a73, 0
    v_mfma_f32_16x16x32_bf16 v[172:175], a[208:211], a[172:175], v[172:175]
    ds_read_b64_tr_b16 a[198:199], v238 offset:25600
    v_accvgpr_write_b32 a74, 0
    v_mfma_f32_16x16x32_bf16 v[176:179], a[212:215], a[160:163], v[176:179]
    ds_read_b64_tr_b16 a[200:201], v246 offset:24832
    v_accvgpr_write_b32 a75, 0
    v_mfma_f32_16x16x32_bf16 v[180:183], a[212:215], a[164:167], v[180:183]
    ds_read_b64_tr_b16 a[202:203], v246 offset:25856
    v_accvgpr_write_b32 a76, 0
    v_accvgpr_write_b32 a77, 0
    v_mfma_f32_16x16x32_bf16 v[184:187], a[212:215], a[168:171], v[184:187]
    ds_read_b64_tr_b16 a[204:205], v238 offset:24832
    v_accvgpr_write_b32 a78, 0
    v_mfma_f32_16x16x32_bf16 v[188:191], a[212:215], a[172:175], v[188:191]
    ds_read_b64_tr_b16 a[206:207], v238 offset:25856
    v_accvgpr_write_b32 a79, 0
    v_accvgpr_write_b32 a80, 0
    v_mfma_f32_16x16x32_bf16 v[192:195], a[216:219], a[160:163], v[192:195]
    buffer_load_dwordx4 a[152:155], v249, s[8:11], s28 offen offset:1024 sc1
    v_accvgpr_write_b32 a81, 0
    v_mfma_f32_16x16x32_bf16 v[196:199], a[216:219], a[164:167], v[196:199]
    v_accvgpr_write_b32 a82, 0
    v_accvgpr_write_b32 a83, 0
    v_mfma_f32_16x16x32_bf16 v[200:203], a[216:219], a[168:171], v[200:203]
    buffer_load_dwordx4 a[156:159], v249, s[8:11], s29 offen offset:1024 sc1
    v_accvgpr_write_b32 a84, 0
    v_mfma_f32_16x16x32_bf16 v[204:207], a[216:219], a[172:175], v[204:207]
    s_add_u32 m0, s31, 5120
    s_add_u32 s24, s27, 163840
    v_accvgpr_write_b32 a85, 0
    v_mfma_f32_16x16x32_bf16 v[208:211], a[220:223], a[160:163], v[208:211]
    buffer_load_dwordx4 v245, s[12:15], s24 offen lds
    v_accvgpr_write_b32 a86, 0
    v_accvgpr_write_b32 a87, 0
    v_mfma_f32_16x16x32_bf16 v[212:215], a[220:223], a[164:167], v[212:215]
    v_accvgpr_write_b32 a88, 0
    v_accvgpr_write_b32 a89, 0
    v_mfma_f32_16x16x32_bf16 v[216:219], a[220:223], a[168:171], v[216:219]
    s_add_u32 s30, s30, 32768
    buffer_store_dwordx4 v[52:55], v240, s[16:19], s85 offen sc1
    v_mfma_f32_16x16x32_bf16 v[220:223], a[220:223], a[172:175], v[220:223]
    s_cmp_ge_u32 s30, 163840
    s_cselect_b32 s30, 65536, s30
    s_waitcnt vmcnt(18) lgkmcnt(0)
    v_mfma_f32_16x16x32_bf16 v[96:99], a[192:195], a[176:179], v[96:99]
    ds_read_b64_tr_b16 a[208:209], v246 offset:25088
    v_accvgpr_write_b32 a90, 0
    v_accvgpr_write_b32 a91, 0
    v_mfma_f32_16x16x32_bf16 v[100:103], a[192:195], a[180:183], v[100:103]
    ds_read_b64_tr_b16 a[210:211], v246 offset:26112
    v_accvgpr_write_b32 a92, 0
    v_mfma_f32_16x16x32_bf16 v[104:107], a[192:195], a[184:187], v[104:107]
    ds_read_b64_tr_b16 a[212:213], v238 offset:25088
    v_accvgpr_write_b32 a93, 0
    v_mfma_f32_16x16x32_bf16 v[108:111], a[192:195], a[188:191], v[108:111]
    ds_read_b64_tr_b16 a[214:215], v238 offset:26112
    v_accvgpr_write_b32 a94, 0
    v_accvgpr_write_b32 a95, 0
    v_mfma_f32_16x16x32_bf16 v[112:115], a[196:199], a[176:179], v[112:115]
    ds_read_b64_tr_b16 a[216:217], v246 offset:25344
    v_accvgpr_write_b32 a96, 0
    v_mfma_f32_16x16x32_bf16 v[116:119], a[196:199], a[180:183], v[116:119]
    ds_read_b64_tr_b16 a[218:219], v246 offset:26368
    v_accvgpr_write_b32 a97, 0
    v_accvgpr_write_b32 a98, 0
    v_mfma_f32_16x16x32_bf16 v[120:123], a[196:199], a[184:187], v[120:123]
    ds_read_b64_tr_b16 a[220:221], v238 offset:25344
    v_accvgpr_write_b32 a99, 0
    v_mfma_f32_16x16x32_bf16 v[124:127], a[196:199], a[188:191], v[124:127]
    ds_read_b64_tr_b16 a[222:223], v238 offset:26368
    v_accvgpr_write_b32 a100, 0
    v_mfma_f32_16x16x32_bf16 v[128:131], a[200:203], a[176:179], v[128:131]
    buffer_load_dwordx4 a[160:163], v248, s[8:11], s28 offen offset:2048 sc1
    v_accvgpr_write_b32 a101, 0
    v_accvgpr_write_b32 a102, 0
    v_mfma_f32_16x16x32_bf16 v[132:135], a[200:203], a[180:183], v[132:135]
    v_accvgpr_write_b32 a103, 0
    v_accvgpr_write_b32 a104, 0
    v_mfma_f32_16x16x32_bf16 v[136:139], a[200:203], a[184:187], v[136:139]
    buffer_load_dwordx4 a[164:167], v248, s[8:11], s29 offen offset:2048 sc1
    v_accvgpr_write_b32 a105, 0
    v_mfma_f32_16x16x32_bf16 v[140:143], a[200:203], a[188:191], v[140:143]
    s_add_u32 m0, s31, 6144
    s_add_u32 s24, s27, 196608
    v_accvgpr_write_b32 a106, 0
    v_mfma_f32_16x16x32_bf16 v[144:147], a[204:207], a[176:179], v[144:147]
    buffer_load_dwordx4 v237, s[12:15], s24 offen lds
    v_accvgpr_write_b32 a107, 0
    v_mfma_f32_16x16x32_bf16 v[148:151], a[204:207], a[180:183], v[148:151]
    v_accvgpr_write_b32 a108, 0
    v_accvgpr_write_b32 a109, 0
    v_accvgpr_write_b32 a110, 0
    v_mfma_f32_16x16x32_bf16 v[152:155], a[204:207], a[184:187], v[152:155]
    buffer_store_dwordx4 v[56:59], v240, s[16:19], s86 offen sc1
    v_accvgpr_write_b32 a111, 0
    v_mfma_f32_16x16x32_bf16 v[156:159], a[204:207], a[188:191], v[156:159]
    s_waitcnt vmcnt(49) lgkmcnt(0)
    s_barrier
    v_add_u32 v246, s30, v247
    v_mfma_f32_16x16x32_bf16 v[160:163], a[208:211], a[176:179], v[160:163]
    v_xor_b32 v238, 32, v246
    ds_read_b64_tr_b16 a[192:193], v246 offset:0
    v_accvgpr_write_b32 a112, 0
    v_mfma_f32_16x16x32_bf16 v[164:167], a[208:211], a[180:183], v[164:167]
    ds_read_b64_tr_b16 a[194:195], v246 offset:1024
    v_accvgpr_write_b32 a113, 0
    v_mfma_f32_16x16x32_bf16 v[168:171], a[208:211], a[184:187], v[168:171]
    ds_read_b64_tr_b16 a[196:197], v238 offset:0
    v_accvgpr_write_b32 a114, 0
    v_mfma_f32_16x16x32_bf16 v[172:175], a[208:211], a[188:191], v[172:175]
    ds_read_b64_tr_b16 a[198:199], v238 offset:1024
    v_accvgpr_write_b32 a115, 0
    v_accvgpr_write_b32 a116, 0
    v_mfma_f32_16x16x32_bf16 v[176:179], a[212:215], a[176:179], v[176:179]
    ds_read_b64_tr_b16 a[200:201], v246 offset:256
    v_accvgpr_write_b32 a117, 0
    v_mfma_f32_16x16x32_bf16 v[180:183], a[212:215], a[180:183], v[180:183]
    ds_read_b64_tr_b16 a[202:203], v246 offset:1280
    v_accvgpr_write_b32 a118, 0
    v_accvgpr_write_b32 a119, 0
    v_mfma_f32_16x16x32_bf16 v[184:187], a[212:215], a[184:187], v[184:187]
    ds_read_b64_tr_b16 a[204:205], v238 offset:256
    buffer_store_dwordx4 v[60:63], v240, s[16:19], s87 offen sc1
    v_mfma_f32_16x16x32_bf16 v[188:191], a[212:215], a[188:191], v[188:191]
    ds_read_b64_tr_b16 a[206:207], v238 offset:1280
    v_accvgpr_write_b32 a120, 0
    v_accvgpr_write_b32 a121, 0
    v_mfma_f32_16x16x32_bf16 v[192:195], a[216:219], a[176:179], v[192:195]
    buffer_load_dwordx4 a[168:171], v249, s[8:11], s28 offen offset:2048 sc1
    v_accvgpr_write_b32 a122, 0
    v_mfma_f32_16x16x32_bf16 v[196:199], a[216:219], a[180:183], v[196:199]
    s_lshl2_add_u32 s80, s2, s3
    s_mul_i32 s80, s80, 12288
    s_add_u32 s80, s80, 0x1000000
    v_mov_b32 v0, -1
    v_mov_b32 v1, -1
    v_mov_b32 v2, -1
    v_mov_b32 v3, -1
    v_mfma_f32_16x16x32_bf16 v[200:203], a[216:219], a[184:187], v[200:203]
    buffer_load_dwordx4 a[172:175], v249, s[8:11], s29 offen offset:2048 sc1
    v_accvgpr_write_b32 a123, 0
    v_accvgpr_write_b32 a124, 0
    v_mfma_f32_16x16x32_bf16 v[204:207], a[216:219], a[188:191], v[204:207]
    s_add_u32 m0, s31, 7168
    s_add_u32 s24, s27, 229376
    v_mfma_f32_16x16x32_bf16 v[208:211], a[220:223], a[176:179], v[208:211]
    buffer_load_dwordx4 v237, s[12:15], s24 offen lds
    v_accvgpr_write_b32 a125, 0
    v_accvgpr_write_b32 a126, 0
    v_mfma_f32_16x16x32_bf16 v[212:215], a[220:223], a[180:183], v[212:215]
    s_add_u32 s27, s27, 1048576
    s_and_b32 s27, s27, 0x407fffff
    v_mfma_f32_16x16x32_bf16 v[216:219], a[220:223], a[184:187], v[216:219]
    s_cmp_eq_u32 s27, s7
    s_cselect_b32 s27, s43, s27
    v_accvgpr_write_b32 a127, 0
    v_mfma_f32_16x16x32_bf16 v[220:223], a[220:223], a[188:191], v[220:223]
    s_add_u32 s31, s31, 32768
    s_cmp_ge_u32 s31, 163840
    s_cselect_b32 s24, 98304, 0
    s_sub_u32 s31, s31, s24
.p2align 3
ka_qp:
    s_waitcnt vmcnt(15) lgkmcnt(0)
    v_mfma_f32_16x16x32_bf16 v[96:99], a[192:195], a[128:131], v[96:99]
    ds_read_b64_tr_b16 a[208:209], v246 offset:512
    v_mfma_f32_16x16x32_bf16 v[100:103], a[192:195], a[132:135], v[100:103]
    ds_read_b64_tr_b16 a[210:211], v246 offset:1536
    v_mfma_f32_16x16x32_bf16 v[104:107], a[192:195], a[136:139], v[104:107]
    ds_read_b64_tr_b16 a[212:213], v238 offset:512
    v_mfma_f32_16x16x32_bf16 v[108:111], a[192:195], a[140:143], v[108:111]
    ds_read_b64_tr_b16 a[214:215], v238 offset:1536
    v_mfma_f32_16x16x32_bf16 v[112:115], a[196:199], a[128:131], v[112:115]
    ds_read_b64_tr_b16 a[216:217], v246 offset:768
    v_mfma_f32_16x16x32_bf16 v[116:119], a[196:199], a[132:135], v[116:119]
    ds_read_b64_tr_b16 a[218:219], v246 offset:1792
    v_mfma_f32_16x16x32_bf16 v[120:123], a[196:199], a[136:139], v[120:123]
    ds_read_b64_tr_b16 a[220:221], v238 offset:768
    v_mfma_f32_16x16x32_bf16 v[124:127], a[196:199], a[140:143], v[124:127]
    ds_read_b64_tr_b16 a[222:223], v238 offset:1792
    v_mfma_f32_16x16x32_bf16 v[128:131], a[200:203], a[128:131], v[128:131]
    buffer_load_dwordx4 a[176:179], v248, s[8:11], s28 offen offset:3072 sc1
    s_cmp_eq_u32 s26, 1
    s_cselect_b32 s41, s35, s43
    buffer_load_dword v254, off, s[88:91], s41 sc1
    v_mfma_f32_16x16x32_bf16 v[132:135], a[200:203], a[132:135], v[132:135]
    v_mfma_f32_16x16x32_bf16 v[136:139], a[200:203], a[136:139], v[136:139]
    buffer_load_dwordx4 a[180:183], v248, s[8:11], s29 offen offset:3072 sc1
    v_mfma_f32_16x16x32_bf16 v[140:143], a[200:203], a[140:143], v[140:143]
    s_add_u32 m0, s31, 0
    s_add_u32 s24, s27, 0
    v_mfma_f32_16x16x32_bf16 v[144:147], a[204:207], a[128:131], v[144:147]
    buffer_load_dwordx4 v245, s[12:15], s24 offen lds
    v_mfma_f32_16x16x32_bf16 v[148:151], a[204:207], a[132:135], v[148:151]
    v_mfma_f32_16x16x32_bf16 v[152:155], a[204:207], a[136:139], v[152:155]
    v_mfma_f32_16x16x32_bf16 v[156:159], a[204:207], a[140:143], v[156:159]
    s_waitcnt lgkmcnt(0)
    v_mfma_f32_16x16x32_bf16 v[160:163], a[208:211], a[128:131], v[160:163]
    ds_read_b64_tr_b16 a[192:193], v246 offset:8192
    v_mfma_f32_16x16x32_bf16 v[164:167], a[208:211], a[132:135], v[164:167]
    ds_read_b64_tr_b16 a[194:195], v246 offset:9216
    v_mfma_f32_16x16x32_bf16 v[168:171], a[208:211], a[136:139], v[168:171]
    ds_read_b64_tr_b16 a[196:197], v238 offset:8192
    v_mfma_f32_16x16x32_bf16 v[172:175], a[208:211], a[140:143], v[172:175]
    ds_read_b64_tr_b16 a[198:199], v238 offset:9216
    v_mfma_f32_16x16x32_bf16 v[176:179], a[212:215], a[128:131], v[176:179]
    ds_read_b64_tr_b16 a[200:201], v246 offset:8448
    v_mfma_f32_16x16x32_bf16 v[180:183], a[212:215], a[132:135], v[180:183]
    ds_read_b64_tr_b16 a[202:203], v246 offset:9472
    v_mfma_f32_16x16x32_bf16 v[184:187], a[212:215], a[136:139], v[184:187]
    ds_read_b64_tr_b16 a[204:205], v238 offset:8448
    v_mfma_f32_16x16x32_bf16 v[188:191], a[212:215], a[140:143], v[188:191]
    ds_read_b64_tr_b16 a[206:207], v238 offset:9472
    v_mfma_f32_16x16x32_bf16 v[192:195], a[216:219], a[128:131], v[192:195]
    buffer_load_dwordx4 a[184:187], v249, s[8:11], s28 offen offset:3072 sc1
    v_mfma_f32_16x16x32_bf16 v[196:199], a[216:219], a[132:135], v[196:199]
    v_mfma_f32_16x16x32_bf16 v[200:203], a[216:219], a[136:139], v[200:203]
    buffer_load_dwordx4 a[188:191], v249, s[8:11], s29 offen offset:3072 sc1
    v_mfma_f32_16x16x32_bf16 v[204:207], a[216:219], a[140:143], v[204:207]
    s_add_u32 m0, s31, 1024
    s_add_u32 s24, s27, 32768
    v_mfma_f32_16x16x32_bf16 v[208:211], a[220:223], a[128:131], v[208:211]
    buffer_load_dwordx4 v245, s[12:15], s24 offen lds
    v_mfma_f32_16x16x32_bf16 v[212:215], a[220:223], a[132:135], v[212:215]
    v_mfma_f32_16x16x32_bf16 v[216:219], a[220:223], a[136:139], v[216:219]
    s_add_u32 s28, s28, 4096
    s_and_b32 s28, s28, 32767
    v_mfma_f32_16x16x32_bf16 v[220:223], a[220:223], a[140:143], v[220:223]
    s_add_u32 s29, s28, 32768
    s_waitcnt vmcnt(16) lgkmcnt(0)
    v_mfma_f32_16x16x32_bf16 v[96:99], a[192:195], a[144:147], v[96:99]
    ds_read_b64_tr_b16 a[208:209], v246 offset:8704
    v_mfma_f32_16x16x32_bf16 v[100:103], a[192:195], a[148:151], v[100:103]
    ds_read_b64_tr_b16 a[210:211], v246 offset:9728
    v_mfma_f32_16x16x32_bf16 v[104:107], a[192:195], a[152:155], v[104:107]
    ds_read_b64_tr_b16 a[212:213], v238 offset:8704
    v_mfma_f32_16x16x32_bf16 v[108:111], a[192:195], a[156:159], v[108:111]
    ds_read_b64_tr_b16 a[214:215], v238 offset:9728
    v_mfma_f32_16x16x32_bf16 v[112:115], a[196:199], a[144:147], v[112:115]
    ds_read_b64_tr_b16 a[216:217], v246 offset:8960
    v_mfma_f32_16x16x32_bf16 v[116:119], a[196:199], a[148:151], v[116:119]
    ds_read_b64_tr_b16 a[218:219], v246 offset:9984
    v_mfma_f32_16x16x32_bf16 v[120:123], a[196:199], a[152:155], v[120:123]
    ds_read_b64_tr_b16 a[220:221], v238 offset:8960
    v_mfma_f32_16x16x32_bf16 v[124:127], a[196:199], a[156:159], v[124:127]
    ds_read_b64_tr_b16 a[222:223], v238 offset:9984
    v_mfma_f32_16x16x32_bf16 v[128:131], a[200:203], a[144:147], v[128:131]
    buffer_load_dwordx4 a[128:131], v248, s[8:11], s28 offen offset:0 sc1
    v_mfma_f32_16x16x32_bf16 v[132:135], a[200:203], a[148:151], v[132:135]
    v_mfma_f32_16x16x32_bf16 v[136:139], a[200:203], a[152:155], v[136:139]
    buffer_load_dwordx4 a[132:135], v248, s[8:11], s29 offen offset:0 sc1
    v_mfma_f32_16x16x32_bf16 v[140:143], a[200:203], a[156:159], v[140:143]
    s_add_u32 m0, s31, 2048
    s_add_u32 s24, s27, 65536
    v_mfma_f32_16x16x32_bf16 v[144:147], a[204:207], a[144:147], v[144:147]
    buffer_load_dwordx4 v237, s[12:15], s24 offen lds
    v_mfma_f32_16x16x32_bf16 v[148:151], a[204:207], a[148:151], v[148:151]
    buffer_store_dwordx4 v[0:3], v240, s[48:51], s80 offen sc1
    s_add_u32 s80, s80, 1024
    v_mfma_f32_16x16x32_bf16 v[152:155], a[204:207], a[152:155], v[152:155]
    v_mfma_f32_16x16x32_bf16 v[156:159], a[204:207], a[156:159], v[156:159]
    s_waitcnt lgkmcnt(0)
    v_mfma_f32_16x16x32_bf16 v[160:163], a[208:211], a[144:147], v[160:163]
    ds_read_b64_tr_b16 a[192:193], v246 offset:16384
    v_mfma_f32_16x16x32_bf16 v[164:167], a[208:211], a[148:151], v[164:167]
    ds_read_b64_tr_b16 a[194:195], v246 offset:17408
    v_mfma_f32_16x16x32_bf16 v[168:171], a[208:211], a[152:155], v[168:171]
    ds_read_b64_tr_b16 a[196:197], v238 offset:16384
    v_mfma_f32_16x16x32_bf16 v[172:175], a[208:211], a[156:159], v[172:175]
    ds_read_b64_tr_b16 a[198:199], v238 offset:17408
    v_mfma_f32_16x16x32_bf16 v[176:179], a[212:215], a[144:147], v[176:179]
    ds_read_b64_tr_b16 a[200:201], v246 offset:16640
    v_mfma_f32_16x16x32_bf16 v[180:183], a[212:215], a[148:151], v[180:183]
    ds_read_b64_tr_b16 a[202:203], v246 offset:17664
    v_mfma_f32_16x16x32_bf16 v[184:187], a[212:215], a[152:155], v[184:187]
    ds_read_b64_tr_b16 a[204:205], v238 offset:16640
    v_mfma_f32_16x16x32_bf16 v[188:191], a[212:215], a[156:159], v[188:191]
    ds_read_b64_tr_b16 a[206:207], v238 offset:17664
    v_mfma_f32_16x16x32_bf16 v[192:195], a[216:219], a[144:147], v[192:195]
    buffer_load_dwordx4 a[136:139], v249, s[8:11], s28 offen offset:0 sc1
    v_mfma_f32_16x16x32_bf16 v[196:199], a[216:219], a[148:151], v[196:199]
    v_mfma_f32_16x16x32_bf16 v[200:203], a[216:219], a[152:155], v[200:203]
    buffer_load_dwordx4 a[140:143], v249, s[8:11], s29 offen offset:0 sc1
    v_mfma_f32_16x16x32_bf16 v[204:207], a[216:219], a[156:159], v[204:207]
    s_add_u32 m0, s31, 3072
    s_add_u32 s24, s27, 98304
    v_mfma_f32_16x16x32_bf16 v[208:211], a[220:223], a[144:147], v[208:211]
    buffer_load_dwordx4 v237, s[12:15], s24 offen lds
    v_mfma_f32_16x16x32_bf16 v[212:215], a[220:223], a[148:151], v[212:215]
    v_mfma_f32_16x16x32_bf16 v[216:219], a[220:223], a[152:155], v[216:219]
    v_mfma_f32_16x16x32_bf16 v[220:223], a[220:223], a[156:159], v[220:223]
    s_waitcnt vmcnt(15) lgkmcnt(0)
    v_mfma_f32_16x16x32_bf16 v[96:99], a[192:195], a[160:163], v[96:99]
    ds_read_b64_tr_b16 a[208:209], v246 offset:16896
    v_mfma_f32_16x16x32_bf16 v[100:103], a[192:195], a[164:167], v[100:103]
    ds_read_b64_tr_b16 a[210:211], v246 offset:17920
    v_mfma_f32_16x16x32_bf16 v[104:107], a[192:195], a[168:171], v[104:107]
    ds_read_b64_tr_b16 a[212:213], v238 offset:16896
    v_mfma_f32_16x16x32_bf16 v[108:111], a[192:195], a[172:175], v[108:111]
    ds_read_b64_tr_b16 a[214:215], v238 offset:17920
    v_mfma_f32_16x16x32_bf16 v[112:115], a[196:199], a[160:163], v[112:115]
    ds_read_b64_tr_b16 a[216:217], v246 offset:17152
    v_mfma_f32_16x16x32_bf16 v[116:119], a[196:199], a[164:167], v[116:119]
    ds_read_b64_tr_b16 a[218:219], v246 offset:18176
    v_mfma_f32_16x16x32_bf16 v[120:123], a[196:199], a[168:171], v[120:123]
    ds_read_b64_tr_b16 a[220:221], v238 offset:17152
    v_mfma_f32_16x16x32_bf16 v[124:127], a[196:199], a[172:175], v[124:127]
    ds_read_b64_tr_b16 a[222:223], v238 offset:18176
    v_mfma_f32_16x16x32_bf16 v[128:131], a[200:203], a[160:163], v[128:131]
    buffer_load_dwordx4 a[144:147], v248, s[8:11], s28 offen offset:1024 sc1
    v_mfma_f32_16x16x32_bf16 v[132:135], a[200:203], a[164:167], v[132:135]
    v_mfma_f32_16x16x32_bf16 v[136:139], a[200:203], a[168:171], v[136:139]
    buffer_load_dwordx4 a[148:151], v248, s[8:11], s29 offen offset:1024 sc1
    v_mfma_f32_16x16x32_bf16 v[140:143], a[200:203], a[172:175], v[140:143]
    s_add_u32 m0, s31, 4096
    s_add_u32 s24, s27, 131072
    v_mfma_f32_16x16x32_bf16 v[144:147], a[204:207], a[160:163], v[144:147]
    buffer_load_dwordx4 v245, s[12:15], s24 offen lds
    v_mfma_f32_16x16x32_bf16 v[148:151], a[204:207], a[164:167], v[148:151]
    v_mfma_f32_16x16x32_bf16 v[152:155], a[204:207], a[168:171], v[152:155]
    v_mfma_f32_16x16x32_bf16 v[156:159], a[204:207], a[172:175], v[156:159]
    s_waitcnt lgkmcnt(0)
    v_mfma_f32_16x16x32_bf16 v[160:163], a[208:211], a[160:163], v[160:163]
    ds_read_b64_tr_b16 a[192:193], v246 offset:24576
    v_mfma_f32_16x16x32_bf16 v[164:167], a[208:211], a[164:167], v[164:167]
    ds_read_b64_tr_b16 a[194:195], v246 offset:25600
    v_mfma_f32_16x16x32_bf16 v[168:171], a[208:211], a[168:171], v[168:171]
    ds_read_b64_tr_b16 a[196:197], v238 offset:24576
    v_mfma_f32_16x16x32_bf16 v[172:175], a[208:211], a[172:175], v[172:175]
    ds_read_b64_tr_b16 a[198:199], v238 offset:25600
    v_mfma_f32_16x16x32_bf16 v[176:179], a[212:215], a[160:163], v[176:179]
    ds_read_b64_tr_b16 a[200:201], v246 offset:24832
    v_mfma_f32_16x16x32_bf16 v[180:183], a[212:215], a[164:167], v[180:183]
    ds_read_b64_tr_b16 a[202:203], v246 offset:25856
    v_mfma_f32_16x16x32_bf16 v[184:187], a[212:215], a[168:171], v[184:187]
    ds_read_b64_tr_b16 a[204:205], v238 offset:24832
    v_mfma_f32_16x16x32_bf16 v[188:191], a[212:215], a[172:175], v[188:191]
    ds_read_b64_tr_b16 a[206:207], v238 offset:25856
    v_mfma_f32_16x16x32_bf16 v[192:195], a[216:219], a[160:163], v[192:195]
    buffer_load_dwordx4 a[152:155], v249, s[8:11], s28 offen offset:1024 sc1
    v_mfma_f32_16x16x32_bf16 v[196:199], a[216:219], a[164:167], v[196:199]
    v_mfma_f32_16x16x32_bf16 v[200:203], a[216:219], a[168:171], v[200:203]
    buffer_load_dwordx4 a[156:159], v249, s[8:11], s29 offen offset:1024 sc1
    v_mfma_f32_16x16x32_bf16 v[204:207], a[216:219], a[172:175], v[204:207]
    s_add_u32 m0, s31, 5120
    s_add_u32 s24, s27, 163840
    v_mfma_f32_16x16x32_bf16 v[208:211], a[220:223], a[160:163], v[208:211]
    buffer_load_dwordx4 v245, s[12:15], s24 offen lds
    v_mfma_f32_16x16x32_bf16 v[212:215], a[220:223], a[164:167], v[212:215]
    buffer_store_dwordx4 v[0:3], v240, s[48:51], s80 offen sc1
    s_add_u32 s80, s80, 1024
    v_mfma_f32_16x16x32_bf16 v[216:219], a[220:223], a[168:171], v[216:219]
    s_add_u32 s30, s30, 32768
    v_mfma_f32_16x16x32_bf16 v[220:223], a[220:223], a[172:175], v[220:223]
    s_cmp_ge_u32 s30, 163840
    s_cselect_b32 s30, 65536, s30
    s_waitcnt vmcnt(15) lgkmcnt(0)
    v_mfma_f32_16x16x32_bf16 v[96:99], a[192:195], a[176:179], v[96:99]
    ds_read_b64_tr_b16 a[208:209], v246 offset:25088
    v_mfma_f32_16x16x32_bf16 v[100:103], a[192:195], a[180:183], v[100:103]
    ds_read_b64_tr_b16 a[210:211], v246 offset:26112
    v_mfma_f32_16x16x32_bf16 v[104:107], a[192:195], a[184:187], v[104:107]
    ds_read_b64_tr_b16 a[212:213], v238 offset:25088
    v_mfma_f32_16x16x32_bf16 v[108:111], a[192:195], a[188:191], v[108:111]
    ds_read_b64_tr_b16 a[214:215], v238 offset:26112
    v_mfma_f32_16x16x32_bf16 v[112:115], a[196:199], a[176:179], v[112:115]
    ds_read_b64_tr_b16 a[216:217], v246 offset:25344
    v_mfma_f32_16x16x32_bf16 v[116:119], a[196:199], a[180:183], v[116:119]
    ds_read_b64_tr_b16 a[218:219], v246 offset:26368
    v_mfma_f32_16x16x32_bf16 v[120:123], a[196:199], a[184:187], v[120:123]
    ds_read_b64_tr_b16 a[220:221], v238 offset:25344
    v_mfma_f32_16x16x32_bf16 v[124:127], a[196:199], a[188:191], v[124:127]
    ds_read_b64_tr_b16 a[222:223], v238 offset:26368
    v_mfma_f32_16x16x32_bf16 v[128:131], a[200:203], a[176:179], v[128:131]
    buffer_load_dwordx4 a[160:163], v248, s[8:11], s28 offen offset:2048 sc1
    v_mfma_f32_16x16x32_bf16 v[132:135], a[200:203], a[180:183], v[132:135]
    v_mfma_f32_16x16x32_bf16 v[136:139], a[200:203], a[184:187], v[136:139]
    buffer_load_dwordx4 a[164:167], v248, s[8:11], s29 offen offset:2048 sc1
    v_mfma_f32_16x16x32_bf16 v[140:143], a[200:203], a[188:191], v[140:143]
    s_add_u32 m0, s31, 6144
    s_add_u32 s24, s27, 196608
    v_mfma_f32_16x16x32_bf16 v[144:147], a[204:207], a[176:179], v[144:147]
    buffer_load_dwordx4 v237, s[12:15], s24 offen lds
    v_mfma_f32_16x16x32_bf16 v[148:151], a[204:207], a[180:183], v[148:151]
    v_mfma_f32_16x16x32_bf16 v[152:155], a[204:207], a[184:187], v[152:155]
    s_cmp_eq_u32 s26, 1
    s_cbranch_scc0 ka_nopk
    s_waitcnt vmcnt(22)
    v_readfirstlane_b32 s24, v254
    s_lshl_b32 s25, s3, 16
    s_add_u32 s24, s24, s25
    s_cmp_ge_u32 s24, 8
    s_cbranch_scc0 kf_spin39
kf_spinr40:
ka_nopk:
    v_mfma_f32_16x16x32_bf16 v[156:159], a[204:207], a[188:191], v[156:159]
    s_waitcnt vmcnt(24) lgkmcnt(0)
    s_barrier
    v_add_u32 v246, s30, v247
    v_mfma_f32_16x16x32_bf16 v[160:163], a[208:211], a[176:179], v[160:163]
    v_xor_b32 v238, 32, v246
    ds_read_b64_tr_b16 a[192:193], v246 offset:0
    v_mfma_f32_16x16x32_bf16 v[164:167], a[208:211], a[180:183], v[164:167]
    ds_read_b64_tr_b16 a[194:195], v246 offset:1024
    v_mfma_f32_16x16x32_bf16 v[168:171], a[208:211], a[184:187], v[168:171]
    ds_read_b64_tr_b16 a[196:197], v238 offset:0
    v_mfma_f32_16x16x32_bf16 v[172:175], a[208:211], a[188:191], v[172:175]
    ds_read_b64_tr_b16 a[198:199], v238 offset:1024
    v_mfma_f32_16x16x32_bf16 v[176:179], a[212:215], a[176:179], v[176:179]
    ds_read_b64_tr_b16 a[200:201], v246 offset:256
    v_mfma_f32_16x16x32_bf16 v[180:183], a[212:215], a[180:183], v[180:183]
    ds_read_b64_tr_b16 a[202:203], v246 offset:1280
    v_mfma_f32_16x16x32_bf16 v[184:187], a[212:215], a[184:187], v[184:187]
    ds_read_b64_tr_b16 a[204:205], v238 offset:256
    buffer_atomic_add v255, v250, s[88:91], s97 offen sc1
    s_mov_b32 s97, s43
    v_mfma_f32_16x16x32_bf16 v[188:191], a[212:215], a[188:191], v[188:191]
    ds_read_b64_tr_b16 a[206:207], v238 offset:1280
    v_mfma_f32_16x16x32_bf16 v[192:195], a[216:219], a[176:179], v[192:195]
    buffer_load_dwordx4 a[168:171], v249, s[8:11], s28 offen offset:2048 sc1
    v_mfma_f32_16x16x32_bf16 v[196:199], a[216:219], a[180:183], v[196:199]
    v_mfma_f32_16x16x32_bf16 v[200:203], a[216:219], a[184:187], v[200:203]
    buffer_load_dwordx4 a[172:175], v249, s[8:11], s29 offen offset:2048 sc1
    v_mfma_f32_16x16x32_bf16 v[204:207], a[216:219], a[188:191], v[204:207]
    s_add_u32 m0, s31, 7168
    s_add_u32 s24, s27, 229376
    v_mfma_f32_16x16x32_bf16 v[208:211], a[220:223], a[176:179], v[208:211]
    buffer_load_dwordx4 v237, s[12:15], s24 offen lds
    v_mfma_f32_16x16x32_bf16 v[212:215], a[220:223], a[180:183], v[212:215]
    s_add_u32 s27, s27, 1048576
    s_and_b32 s27, s27, 0x407fffff
    v_mfma_f32_16x16x32_bf16 v[216:219], a[220:223], a[184:187], v[216:219]
    s_cmp_eq_u32 s27, s7
    s_cselect_b32 s27, s43, s27
    v_mfma_f32_16x16x32_bf16 v[220:223], a[220:223], a[188:191], v[220:223]
    s_add_u32 s31, s31, 32768
    s_cmp_ge_u32 s31, 163840
    s_cselect_b32 s24, 98304, 0
    s_sub_u32 s31, s31, s24
    s_sub_u32 s26, s26, 1
    s_cmp_lg_u32 s26, 0
    s_cbranch_scc1 ka_qp
    s_waitcnt vmcnt(15) lgkmcnt(0)
    v_mfma_f32_16x16x32_bf16 v[96:99], a[192:195], a[128:131], v[96:99]
    ds_read_b64_tr_b16 a[208:209], v246 offset:512
    s_sub_u32 s42, s32, 17664
    v_mfma_f32_16x16x32_bf16 v[100:103], a[192:195], a[132:135], v[100:103]
    ds_read_b64_tr_b16 a[210:211], v246 offset:1536
    v_mfma_f32_16x16x32_bf16 v[104:107], a[192:195], a[136:139], v[104:107]
    ds_read_b64_tr_b16 a[212:213], v238 offset:512
    s_mov_b32 m0, s34
    s_add_u32 s41, s42, 17664
    v_mfma_f32_16x16x32_bf16 v[108:111], a[192:195], a[140:143], v[108:111]
    ds_read_b64_tr_b16 a[214:215], v238 offset:1536
    v_mfma_f32_16x16x32_bf16 v[112:115], a[196:199], a[128:131], v[112:115]
    ds_read_b64_tr_b16 a[216:217], v246 offset:768
    v_mfma_f32_16x16x32_bf16 v[116:119], a[196:199], a[132:135], v[116:119]
    ds_read_b64_tr_b16 a[218:219], v246 offset:1792
    buffer_load_dwordx4 v242, s[16:19], s41 offen offset:0 sc1 lds
    v_mfma_f32_16x16x32_bf16 v[120:123], a[196:199], a[136:139], v[120:123]
    ds_read_b64_tr_b16 a[220:221], v238 offset:768
    v_mfma_f32_16x16x32_bf16 v[124:127], a[196:199], a[140:143], v[124:127]
    ds_read_b64_tr_b16 a[222:223], v238 offset:1792
    v_mfma_f32_16x16x32_bf16 v[128:131], a[200:203], a[128:131], v[128:131]
    buffer_load_dwordx4 a[176:179], v248, s[8:11], s28 offen offset:3072 sc1
    buffer_load_dwordx4 v242, s[16:19], s41 offen offset:1024 sc1 lds
    v_mfma_f32_16x16x32_bf16 v[132:135], a[200:203], a[132:135], v[132:135]
    v_mfma_f32_16x16x32_bf16 v[136:139], a[200:203], a[136:139], v[136:139]
    buffer_load_dwordx4 a[180:183], v248, s[8:11], s29 offen offset:3072 sc1
    v_mfma_f32_16x16x32_bf16 v[140:143], a[200:203], a[140:143], v[140:143]
    buffer_load_dwordx4 v242, s[16:19], s41 offen offset:2048 sc1 lds
    v_mfma_f32_16x16x32_bf16 v[144:147], a[204:207], a[128:131], v[144:147]
    v_mfma_f32_16x16x32_bf16 v[148:151], a[204:207], a[132:135], v[148:151]
    v_mfma_f32_16x16x32_bf16 v[152:155], a[204:207], a[136:139], v[152:155]
    buffer_load_dwordx4 v242, s[16:19], s41 offen offset:3072 sc1 lds
    v_mfma_f32_16x16x32_bf16 v[156:159], a[204:207], a[140:143], v[156:159]
    s_waitcnt lgkmcnt(0)
    v_mfma_f32_16x16x32_bf16 v[160:163], a[208:211], a[128:131], v[160:163]
    ds_read_b64_tr_b16 a[192:193], v246 offset:8192
    v_mfma_f32_16x16x32_bf16 v[164:167], a[208:211], a[132:135], v[164:167]
    ds_read_b64_tr_b16 a[194:195], v246 offset:9216
    v_mfma_f32_16x16x32_bf16 v[168:171], a[208:211], a[136:139], v[168:171]
    ds_read_b64_tr_b16 a[196:197], v238 offset:8192
    s_add_u32 s34, s34, 32768
    s_cmp_ge_u32 s34, 163840
    s_cselect_b32 s34, s37, s34
    s_add_u32 s42, s42, 34048
    v_mfma_f32_16x16x32_bf16 v[172:175], a[208:211], a[140:143], v[172:175]
    ds_read_b64_tr_b16 a[198:199], v238 offset:9216
    v_mfma_f32_16x16x32_bf16 v[176:179], a[212:215], a[128:131], v[176:179]
    ds_read_b64_tr_b16 a[200:201], v246 offset:8448
    v_mfma_f32_16x16x32_bf16 v[180:183], a[212:215], a[132:135], v[180:183]
    ds_read_b64_tr_b16 a[202:203], v246 offset:9472
    s_mov_b32 m0, s34
    s_add_u32 s41, s42, 17664
    v_mfma_f32_16x16x32_bf16 v[184:187], a[212:215], a[136:139], v[184:187]
    ds_read_b64_tr_b16 a[204:205], v238 offset:8448
    v_mfma_f32_16x16x32_bf16 v[188:191], a[212:215], a[140:143], v[188:191]
    ds_read_b64_tr_b16 a[206:207], v238 offset:9472
    v_mfma_f32_16x16x32_bf16 v[192:195], a[216:219], a[128:131], v[192:195]
    buffer_load_dwordx4 a[184:187], v249, s[8:11], s28 offen offset:3072 sc1
    buffer_load_dwordx4 v242, s[16:19], s41 offen offset:0 sc1 lds
    v_mfma_f32_16x16x32_bf16 v[196:199], a[216:219], a[132:135], v[196:199]
    v_mfma_f32_16x16x32_bf16 v[200:203], a[216:219], a[136:139], v[200:203]
    buffer_load_dwordx4 a[188:191], v249, s[8:11], s29 offen offset:3072 sc1
    v_mfma_f32_16x16x32_bf16 v[204:207], a[216:219], a[140:143], v[204:207]
    buffer_load_dwordx4 v242, s[16:19], s41 offen offset:1024 sc1 lds
    v_mfma_f32_16x16x32_bf16 v[208:211], a[220:223], a[128:131], v[208:211]
    v_mfma_f32_16x16x32_bf16 v[212:215], a[220:223], a[132:135], v[212:215]
    v_mfma_f32_16x16x32_bf16 v[216:219], a[220:223], a[136:139], v[216:219]
    s_add_u32 s28, s28, 4096
    s_and_b32 s28, s28, 32767
    v_mfma_f32_16x16x32_bf16 v[220:223], a[220:223], a[140:143], v[220:223]
    s_add_u32 s29, s28, 32768
    buffer_load_dwordx4 v242, s[16:19], s41 offen offset:2048 sc1 lds
    s_waitcnt vmcnt(20) lgkmcnt(0)
    v_mfma_f32_16x16x32_bf16 v[96:99], a[192:195], a[144:147], v[96:99]
    ds_read_b64_tr_b16 a[208:209], v246 offset:8704
    v_mfma_f32_16x16x32_bf16 v[100:103], a[192:195], a[148:151], v[100:103]
    ds_read_b64_tr_b16 a[210:211], v246 offset:9728
    v_mfma_f32_16x16x32_bf16 v[104:107], a[192:195], a[152:155], v[104:107]
    ds_read_b64_tr_b16 a[212:213], v238 offset:8704
    buffer_load_dwordx4 v242, s[16:19], s41 offen offset:3072 sc1 lds
    v_mfma_f32_16x16x32_bf16 v[108:111], a[192:195], a[156:159], v[108:111]
    ds_read_b64_tr_b16 a[214:215], v238 offset:9728
    v_mfma_f32_16x16x32_bf16 v[112:115], a[196:199], a[144:147], v[112:115]
    ds_read_b64_tr_b16 a[216:217], v246 offset:8960
    v_mfma_f32_16x16x32_bf16 v[116:119], a[196:199], a[148:151], v[116:119]
    ds_read_b64_tr_b16 a[218:219], v246 offset:9984
    s_add_u32 m0, s34, 16384
    s_add_u32 s34, s34, 32768
    s_cmp_ge_u32 s34, 163840
    s_cselect_b32 s34, s37, s34
    v_mfma_f32_16x16x32_bf16 v[120:123], a[196:199], a[152:155], v[120:123]
    ds_read_b64_tr_b16 a[220:221], v238 offset:8960
    v_mfma_f32_16x16x32_bf16 v[124:127], a[196:199], a[156:159], v[124:127]
    ds_read_b64_tr_b16 a[222:223], v238 offset:9984
    v_mfma_f32_16x16x32_bf16 v[128:131], a[200:203], a[144:147], v[128:131]
    buffer_load_dwordx4 v242, s[16:19], s42 offen offset:0 sc1 lds
    v_mov_b32 v241, v239
    v_mfma_f32_16x16x32_bf16 v[132:135], a[200:203], a[148:151], v[132:135]
    v_lshrrev_b32 v230, 7, v240
    v_mfma_f32_16x16x32_bf16 v[136:139], a[200:203], a[152:155], v[136:139]
    v_mul_u32_u24 v253, 7168, v230
    v_mfma_f32_16x16x32_bf16 v[140:143], a[200:203], a[156:159], v[140:143]
    v_and_b32 v231, 0x70, v240
    v_mfma_f32_16x16x32_bf16 v[144:147], a[204:207], a[144:147], v[144:147]
    buffer_load_dwordx4 v242, s[16:19], s42 offen offset:1024 sc1 lds
    v_mfma_f32_16x16x32_bf16 v[148:151], a[204:207], a[148:151], v[148:151]
    v_add_u32 v253, v253, v231
    v_mfma_f32_16x16x32_bf16 v[152:155], a[204:207], a[152:155], v[152:155]
    v_lshlrev_b32 v255, 5, v230
    v_mfma_f32_16x16x32_bf16 v[156:159], a[204:207], a[156:159], v[156:159]
    buffer_load_dwordx4 v242, s[16:19], s42 offen offset:2048 sc1 lds
    s_waitcnt lgkmcnt(0)
    v_mfma_f32_16x16x32_bf16 v[160:163], a[208:211], a[144:147], v[160:163]
    ds_read_b64_tr_b16 a[192:193], v246 offset:16384
    v_and_b32 v230, 16, v240
    v_mfma_f32_16x16x32_bf16 v[164:167], a[208:211], a[148:151], v[164:167]
    ds_read_b64_tr_b16 a[194:195], v246 offset:17408
    v_mfma_f32_16x16x32_bf16 v[168:171], a[208:211], a[152:155], v[168:171]
    ds_read_b64_tr_b16 a[196:197], v238 offset:16384
    buffer_load_dwordx4 v242, s[16:19], s42 offen offset:3072 sc1 lds
    s_add_u32 s42, s42, 34048
    v_mfma_f32_16x16x32_bf16 v[172:175], a[208:211], a[156:159], v[172:175]
    ds_read_b64_tr_b16 a[198:199], v238 offset:17408
    v_add_u32 v255, v255, v230
    v_mfma_f32_16x16x32_bf16 v[176:179], a[212:215], a[144:147], v[176:179]
    ds_read_b64_tr_b16 a[200:201], v246 offset:16640
    v_mfma_f32_16x16x32_bf16 v[180:183], a[212:215], a[148:151], v[180:183]
    ds_read_b64_tr_b16 a[202:203], v246 offset:17664
    s_mov_b32 m0, s34
    s_add_u32 s41, s42, 17664
    v_mfma_f32_16x16x32_bf16 v[184:187], a[212:215], a[152:155], v[184:187]
    ds_read_b64_tr_b16 a[204:205], v238 offset:16640
    v_lshrrev_b32 v231, 5, v231
    v_mfma_f32_16x16x32_bf16 v[188:191], a[212:215], a[156:159], v[188:191]
    ds_read_b64_tr_b16 a[206:207], v238 offset:17664
    v_mfma_f32_16x16x32_bf16 v[192:195], a[216:219], a[144:147], v[192:195]
    buffer_load_dwordx4 v242, s[16:19], s41 offen offset:0 sc1 lds
    v_lshl_add_u32 v255, v231, 16, v255
    v_mfma_f32_16x16x32_bf16 v[196:199], a[216:219], a[148:151], v[196:199]
    v_mov_b32 v64, 0
    v_mfma_f32_16x16x32_bf16 v[200:203], a[216:219], a[152:155], v[200:203]
    v_mov_b32 v65, 0
    v_mfma_f32_16x16x32_bf16 v[204:207], a[216:219], a[156:159], v[204:207]
    v_mov_b32 v66, 0
    v_mfma_f32_16x16x32_bf16 v[208:211], a[220:223], a[144:147], v[208:211]
    buffer_load_dwordx4 v242, s[16:19], s41 offen offset:1024 sc1 lds
    v_mfma_f32_16x16x32_bf16 v[212:215], a[220:223], a[148:151], v[212:215]
    v_mov_b32 v67, 0
    v_mfma_f32_16x16x32_bf16 v[216:219], a[220:223], a[152:155], v[216:219]
    v_mov_b32 v68, 0
    v_mfma_f32_16x16x32_bf16 v[220:223], a[220:223], a[156:159], v[220:223]
    buffer_load_dwordx4 v242, s[16:19], s41 offen offset:2048 sc1 lds
    s_waitcnt vmcnt(20) lgkmcnt(0)
    v_mfma_f32_16x16x32_bf16 v[96:99], a[192:195], a[160:163], v[96:99]
    ds_read_b64_tr_b16 a[208:209], v246 offset:16896
    v_mov_b32 v69, 0
    v_mfma_f32_16x16x32_bf16 v[100:103], a[192:195], a[164:167], v[100:103]
    ds_read_b64_tr_b16 a[210:211], v246 offset:17920
    v_mfma_f32_16x16x32_bf16 v[104:107], a[192:195], a[168:171], v[104:107]
    ds_read_b64_tr_b16 a[212:213], v238 offset:16896
    buffer_load_dwordx4 v242, s[16:19], s41 offen offset:3072 sc1 lds
    v_mfma_f32_16x16x32_bf16 v[108:111], a[192:195], a[172:175], v[108:111]
    ds_read_b64_tr_b16 a[214:215], v238 offset:17920
    v_mov_b32 v70, 0
    v_mfma_f32_16x16x32_bf16 v[112:115], a[196:199], a[160:163], v[112:115]
    ds_read_b64_tr_b16 a[216:217], v246 offset:17152
    v_mfma_f32_16x16x32_bf16 v[116:119], a[196:199], a[164:167], v[116:119]
    ds_read_b64_tr_b16 a[218:219], v246 offset:18176
    s_add_u32 m0, s34, 16384
    s_add_u32 s34, s34, 32768
    s_cmp_ge_u32 s34, 163840
    s_cselect_b32 s34, s37, s34
    v_mfma_f32_16x16x32_bf16 v[120:123], a[196:199], a[168:171], v[120:123]
    ds_read_b64_tr_b16 a[220:221], v238 offset:17152
    v_mov_b32 v71, 0
    v_mfma_f32_16x16x32_bf16 v[124:127], a[196:199], a[172:175], v[124:127]
    ds_read_b64_tr_b16 a[222:223], v238 offset:18176
    v_mfma_f32_16x16x32_bf16 v[128:131], a[200:203], a[160:163], v[128:131]
    v_mov_b32 v72, 0
    v_mfma_f32_16x16x32_bf16 v[132:135], a[200:203], a[164:167], v[132:135]
    buffer_load_dwordx4 v242, s[16:19], s42 offen offset:0 sc1 lds
    v_mov_b32 v73, 0
    v_mfma_f32_16x16x32_bf16 v[136:139], a[200:203], a[168:171], v[136:139]
    v_mov_b32 v74, 0
    v_mfma_f32_16x16x32_bf16 v[140:143], a[200:203], a[172:175], v[140:143]
    v_mov_b32 v75, 0
    v_mfma_f32_16x16x32_bf16 v[144:147], a[204:207], a[160:163], v[144:147]
    buffer_load_dwordx4 v242, s[16:19], s42 offen offset:1024 sc1 lds
    v_mfma_f32_16x16x32_bf16 v[148:151], a[204:207], a[164:167], v[148:151]
    v_mov_b32 v76, 0
    v_mfma_f32_16x16x32_bf16 v[152:155], a[204:207], a[168:171], v[152:155]
    v_mov_b32 v77, 0
    v_mfma_f32_16x16x32_bf16 v[156:159], a[204:207], a[172:175], v[156:159]
    buffer_load_dwordx4 v242, s[16:19], s42 offen offset:2048 sc1 lds
    s_waitcnt lgkmcnt(0)
    v_mfma_f32_16x16x32_bf16 v[160:163], a[208:211], a[160:163], v[160:163]
    ds_read_b64_tr_b16 a[192:193], v246 offset:24576
    v_mov_b32 v78, 0
    v_mfma_f32_16x16x32_bf16 v[164:167], a[208:211], a[164:167], v[164:167]
    ds_read_b64_tr_b16 a[194:195], v246 offset:25600
    v_mfma_f32_16x16x32_bf16 v[168:171], a[208:211], a[168:171], v[168:171]
    ds_read_b64_tr_b16 a[196:197], v238 offset:24576
    buffer_load_dwordx4 v242, s[16:19], s42 offen offset:3072 sc1 lds
    s_add_u32 s42, s42, 34048
    v_mfma_f32_16x16x32_bf16 v[172:175], a[208:211], a[172:175], v[172:175]
    ds_read_b64_tr_b16 a[198:199], v238 offset:25600
    v_mov_b32 v79, 0
    v_mfma_f32_16x16x32_bf16 v[176:179], a[212:215], a[160:163], v[176:179]
    ds_read_b64_tr_b16 a[200:201], v246 offset:24832
    v_mfma_f32_16x16x32_bf16 v[180:183], a[212:215], a[164:167], v[180:183]
    ds_read_b64_tr_b16 a[202:203], v246 offset:25856
    v_mov_b32 v228, 0
    v_mfma_f32_16x16x32_bf16 v[184:187], a[212:215], a[168:171], v[184:187]
    ds_read_b64_tr_b16 a[204:205], v238 offset:24832
    v_mfma_f32_16x16x32_bf16 v[188:191], a[212:215], a[172:175], v[188:191]
    ds_read_b64_tr_b16 a[206:207], v238 offset:25856
    v_mov_b32 v226, 0
    v_mfma_f32_16x16x32_bf16 v[192:195], a[216:219], a[160:163], v[192:195]
    v_mov_b32 v80, 0
    v_mfma_f32_16x16x32_bf16 v[196:199], a[216:219], a[164:167], v[196:199]
    v_mov_b32 v81, 0
    v_mfma_f32_16x16x32_bf16 v[200:203], a[216:219], a[168:171], v[200:203]
    v_mov_b32 v82, 0
    v_mfma_f32_16x16x32_bf16 v[204:207], a[216:219], a[172:175], v[204:207]
    v_mov_b32 v83, 0
    v_mfma_f32_16x16x32_bf16 v[208:211], a[220:223], a[160:163], v[208:211]
    v_mov_b32 v84, 0
    v_mfma_f32_16x16x32_bf16 v[212:215], a[220:223], a[164:167], v[212:215]
    v_mov_b32 v85, 0
    v_mfma_f32_16x16x32_bf16 v[216:219], a[220:223], a[168:171], v[216:219]
    v_mov_b32 v86, 0
    v_mfma_f32_16x16x32_bf16 v[220:223], a[220:223], a[172:175], v[220:223]
    s_waitcnt vmcnt(15) lgkmcnt(0)
    v_mfma_f32_16x16x32_bf16 v[96:99], a[192:195], a[176:179], v[96:99]
    ds_read_b64_tr_b16 a[208:209], v246 offset:25088
    v_mov_b32 v87, 0
    v_mfma_f32_16x16x32_bf16 v[100:103], a[192:195], a[180:183], v[100:103]
    ds_read_b64_tr_b16 a[210:211], v246 offset:26112
    v_mfma_f32_16x16x32_bf16 v[104:107], a[192:195], a[184:187], v[104:107]
    ds_read_b64_tr_b16 a[212:213], v238 offset:25088
    v_mov_b32 v88, 0
    v_mfma_f32_16x16x32_bf16 v[108:111], a[192:195], a[188:191], v[108:111]
    ds_read_b64_tr_b16 a[214:215], v238 offset:26112
    v_mfma_f32_16x16x32_bf16 v[112:115], a[196:199], a[176:179], v[112:115]
    ds_read_b64_tr_b16 a[216:217], v246 offset:25344
    v_mov_b32 v89, 0
    v_mfma_f32_16x16x32_bf16 v[116:119], a[196:199], a[180:183], v[116:119]
    ds_read_b64_tr_b16 a[218:219], v246 offset:26368
    v_mfma_f32_16x16x32_bf16 v[120:123], a[196:199], a[184:187], v[120:123]
    ds_read_b64_tr_b16 a[220:221], v238 offset:25344
    v_mov_b32 v90, 0
    v_mfma_f32_16x16x32_bf16 v[124:127], a[196:199], a[188:191], v[124:127]
    ds_read_b64_tr_b16 a[222:223], v238 offset:26368
    v_mfma_f32_16x16x32_bf16 v[128:131], a[200:203], a[176:179], v[128:131]
    v_mov_b32 v91, 0
    v_mfma_f32_16x16x32_bf16 v[132:135], a[200:203], a[180:183], v[132:135]
    v_mov_b32 v92, 0
    v_mfma_f32_16x16x32_bf16 v[136:139], a[200:203], a[184:187], v[136:139]
    v_mov_b32 v93, 0
    v_mfma_f32_16x16x32_bf16 v[140:143], a[200:203], a[188:191], v[140:143]
    v_mov_b32 v94, 0
    v_mfma_f32_16x16x32_bf16 v[144:147], a[204:207], a[176:179], v[144:147]
    v_mov_b32 v95, 0
    v_mfma_f32_16x16x32_bf16 v[148:151], a[204:207], a[180:183], v[148:151]
    v_mov_b32 v229, 0
    v_mfma_f32_16x16x32_bf16 v[152:155], a[204:207], a[184:187], v[152:155]
    v_mov_b32 v227, 0
    v_mfma_f32_16x16x32_bf16 v[156:159], a[204:207], a[188:191], v[156:159]
    s_waitcnt vmcnt(8) lgkmcnt(0)
    s_barrier
    v_mfma_f32_16x16x32_bf16 v[160:163], a[208:211], a[176:179], v[160:163]
    ds_read_b128 a[192:195], v241 offset:0
    s_mov_b32 m0, s34
    s_add_u32 s41, s42, 17664
    v_mfma_f32_16x16x32_bf16 v[164:167], a[208:211], a[180:183], v[164:167]
    ds_read_b128 a[196:199], v241 offset:512
    buffer_load_dwordx4 v242, s[16:19], s41 offen offset:0 sc1 lds
    v_mfma_f32_16x16x32_bf16 v[168:171], a[208:211], a[184:187], v[168:171]
    ds_read_b128 a[200:203], v241 offset:2048
    v_mfma_f32_16x16x32_bf16 v[172:175], a[208:211], a[188:191], v[172:175]
    ds_read_b128 a[204:207], v241 offset:2560
    buffer_load_dwordx4 v242, s[16:19], s41 offen offset:1024 sc1 lds
    v_mfma_f32_16x16x32_bf16 v[176:179], a[212:215], a[176:179], v[176:179]
    ds_read_b128 a[224:227], v241 offset:8192
    buffer_load_dwordx4 v242, s[16:19], s41 offen offset:2048 sc1 lds
    v_mfma_f32_16x16x32_bf16 v[180:183], a[212:215], a[180:183], v[180:183]
    ds_read_b128 a[228:231], v241 offset:8704
    v_mfma_f32_16x16x32_bf16 v[184:187], a[212:215], a[184:187], v[184:187]
    ds_read_b128 a[232:235], v241 offset:10240
    buffer_load_dwordx4 v242, s[16:19], s41 offen offset:3072 sc1 lds
    v_mfma_f32_16x16x32_bf16 v[188:191], a[212:215], a[188:191], v[188:191]
    ds_read_b128 a[236:239], v241 offset:10752
    v_mfma_f32_16x16x32_bf16 v[192:195], a[216:219], a[176:179], v[192:195]
    ds_read_b128 a[240:243], v241 offset:12288
    s_add_u32 m0, s34, 16384
    s_add_u32 s34, s34, 32768
    s_cmp_ge_u32 s34, 163840
    s_cselect_b32 s34, s37, s34
    v_mfma_f32_16x16x32_bf16 v[196:199], a[216:219], a[180:183], v[196:199]
    ds_read_b128 a[244:247], v241 offset:12800
    buffer_load_dwordx4 v242, s[16:19], s42 offen offset:0 sc1 lds
    v_mfma_f32_16x16x32_bf16 v[200:203], a[216:219], a[184:187], v[200:203]
    ds_read_b128 a[248:251], v241 offset:14336
    v_mfma_f32_16x16x32_bf16 v[204:207], a[216:219], a[188:191], v[204:207]
    ds_read_b128 a[252:255], v241 offset:14848
    buffer_load_dwordx4 v242, s[16:19], s42 offen offset:1024 sc1 lds
    v_mfma_f32_16x16x32_bf16 v[208:211], a[220:223], a[176:179], v[208:211]
    buffer_load_dwordx4 v242, s[16:19], s42 offen offset:2048 sc1 lds
    v_mfma_f32_16x16x32_bf16 v[212:215], a[220:223], a[180:183], v[212:215]
    v_mfma_f32_16x16x32_bf16 v[216:219], a[220:223], a[184:187], v[216:219]
    buffer_load_dwordx4 v242, s[16:19], s42 offen offset:3072 sc1 lds
    s_add_u32 s42, s42, 34048
    v_mfma_f32_16x16x32_bf16 v[220:223], a[220:223], a[188:191], v[220:223]
    s_mov_b32 s25, 0x3e0293ee
    s_waitcnt lgkmcnt(8)
    ds_read_b128 a[208:211], v241 offset:4096
    ds_read_b128 a[212:215], v241 offset:4608
    ds_read_b128 a[216:219], v241 offset:6144
    ds_read_b128 a[220:223], v241 offset:6656
    s_sub_u32 s36, s36, 1
    s_cbranch_scc1 kf_fix1
kf_fixr2:
    v_mul_f32 v96, s25, v96
    v_mul_f32 v97, s25, v97
    v_mul_f32 v98, s25, v98
    v_mul_f32 v99, s25, v99
    v_mul_f32 v100, s25, v100
    v_mul_f32 v101, s25, v101
    v_mul_f32 v102, s25, v102
    v_mul_f32 v103, s25, v103
    v_mul_f32 v104, s25, v104
    v_mul_f32 v105, s25, v105
    v_mul_f32 v106, s25, v106
    v_mul_f32 v107, s25, v107
    v_mul_f32 v108, s25, v108
    v_mul_f32 v109, s25, v109
    v_mul_f32 v110, s25, v110
    v_mul_f32 v111, s25, v111
    v_cvt_pk_bf16_f32 v96, v96, v97
    v_cvt_pk_bf16_f32 v97, v98, v99
    v_cvt_pk_bf16_f32 v100, v100, v101
    v_cvt_pk_bf16_f32 v101, v102, v103
    v_cvt_pk_bf16_f32 v104, v104, v105
    v_cvt_pk_bf16_f32 v105, v106, v107
    v_cvt_pk_bf16_f32 v108, v108, v109
    v_cvt_pk_bf16_f32 v109, v110, v111
    v_permlane16_swap_b32 v96, v100
    v_permlane16_swap_b32 v97, v101
    v_permlane16_swap_b32 v104, v108
    v_permlane16_swap_b32 v105, v109
    v_accvgpr_write_b32 a128, v96
    v_accvgpr_write_b32 a129, v97
    v_accvgpr_write_b32 a130, v100
    v_accvgpr_write_b32 a131, v101
    v_accvgpr_write_b32 a160, v104
    v_accvgpr_write_b32 a161, v105
    v_accvgpr_write_b32 a162, v108
    v_accvgpr_write_b32 a163, v109
    v_mul_f32 v112, s25, v112
    v_mul_f32 v113, s25, v113
    v_mul_f32 v114, s25, v114
    v_mul_f32 v115, s25, v115
    v_mul_f32 v116, s25, v116
    v_mul_f32 v117, s25, v117
    v_mul_f32 v118, s25, v118
    v_mul_f32 v119, s25, v119
    v_mul_f32 v120, s25, v120
    v_mul_f32 v121, s25, v121
    v_mul_f32 v122, s25, v122
    v_mul_f32 v123, s25, v123
    v_mul_f32 v124, s25, v124
    v_mul_f32 v125, s25, v125
    v_mul_f32 v126, s25, v126
    v_mul_f32 v127, s25, v127
    v_cvt_pk_bf16_f32 v112, v112, v113
    v_cvt_pk_bf16_f32 v113, v114, v115
    v_cvt_pk_bf16_f32 v116, v116, v117
    v_cvt_pk_bf16_f32 v117, v118, v119
    v_cvt_pk_bf16_f32 v120, v120, v121
    v_cvt_pk_bf16_f32 v121, v122, v123
    v_cvt_pk_bf16_f32 v124, v124, v125
    v_cvt_pk_bf16_f32 v125, v126, v127
    v_permlane16_swap_b32 v112, v116
    v_permlane16_swap_b32 v113, v117
    v_permlane16_swap_b32 v120, v124
    v_permlane16_swap_b32 v121, v125
    v_accvgpr_write_b32 a132, v112
    v_accvgpr_write_b32 a133, v113
    v_accvgpr_write_b32 a134, v116
    v_accvgpr_write_b32 a135, v117
    v_accvgpr_write_b32 a164, v120
    v_accvgpr_write_b32 a165, v121
    v_accvgpr_write_b32 a166, v124
    v_accvgpr_write_b32 a167, v125
    s_nop 1
    v_mfma_f32_32x32x16_bf16 v[0:15], a[192:195], a[128:131], v[64:79]
    v_mul_f32 v128, s25, v128
    v_mul_f32 v129, s25, v129
    v_mul_f32 v130, s25, v130
    v_mul_f32 v131, s25, v131
    v_mul_f32 v132, s25, v132
    v_mul_f32 v133, s25, v133
    v_mfma_f32_32x32x16_bf16 v[16:31], a[192:195], a[160:163], v[80:95]
    v_mul_f32 v134, s25, v134
    v_mul_f32 v135, s25, v135
    v_mul_f32 v136, s25, v136
    v_mul_f32 v137, s25, v137
    v_mul_f32 v138, s25, v138
    v_mul_f32 v139, s25, v139
    v_mfma_f32_32x32x16_bf16 v[0:15], a[196:199], a[132:135], v[0:15]
    v_mul_f32 v140, s25, v140
    v_mul_f32 v141, s25, v141
    v_mul_f32 v142, s25, v142
    v_mul_f32 v143, s25, v143
    v_cvt_pk_bf16_f32 v128, v128, v129
    v_cvt_pk_bf16_f32 v129, v130, v131
    v_mfma_f32_32x32x16_bf16 v[16:31], a[196:199], a[164:167], v[16:31]
    v_cvt_pk_bf16_f32 v132, v132, v133
    v_cvt_pk_bf16_f32 v133, v134, v135
    v_cvt_pk_bf16_f32 v136, v136, v137
    v_cvt_pk_bf16_f32 v137, v138, v139
    v_cvt_pk_bf16_f32 v140, v140, v141
    v_cvt_pk_bf16_f32 v141, v142, v143
    v_permlane16_swap_b32 v128, v132
    v_permlane16_swap_b32 v129, v133
    v_permlane16_swap_b32 v136, v140
    v_permlane16_swap_b32 v137, v141
    v_accvgpr_write_b32 a136, v128
    v_accvgpr_write_b32 a137, v129
    v_accvgpr_write_b32 a138, v132
    v_accvgpr_write_b32 a139, v133
    v_accvgpr_write_b32 a168, v136
    v_accvgpr_write_b32 a169, v137
    v_accvgpr_write_b32 a170, v140
    v_accvgpr_write_b32 a171, v141
    v_mul_f32 v144, s25, v144
    v_mul_f32 v145, s25, v145
    v_mul_f32 v146, s25, v146
    v_mul_f32 v147, s25, v147
    v_mul_f32 v148, s25, v148
    v_mul_f32 v149, s25, v149
    v_mul_f32 v150, s25, v150
    v_mul_f32 v151, s25, v151
    v_mul_f32 v152, s25, v152
    v_mul_f32 v153, s25, v153
    v_mul_f32 v154, s25, v154
    v_mul_f32 v155, s25, v155
    v_mul_f32 v156, s25, v156
    v_mul_f32 v157, s25, v157
    v_mul_f32 v158, s25, v158
    v_mul_f32 v159, s25, v159
    v_cvt_pk_bf16_f32 v144, v144, v145
    v_cvt_pk_bf16_f32 v145, v146, v147
    v_cvt_pk_bf16_f32 v148, v148, v149
    v_cvt_pk_bf16_f32 v149, v150, v151
    v_cvt_pk_bf16_f32 v152, v152, v153
    v_cvt_pk_bf16_f32 v153, v154, v155
    v_cvt_pk_bf16_f32 v156, v156, v157
    v_cvt_pk_bf16_f32 v157, v158, v159
    v_permlane16_swap_b32 v144, v148
    v_permlane16_swap_b32 v145, v149
    v_permlane16_swap_b32 v152, v156
    v_permlane16_swap_b32 v153, v157
    v_accvgpr_write_b32 a140, v144
    v_accvgpr_write_b32 a141, v145
    v_accvgpr_write_b32 a142, v148
    v_accvgpr_write_b32 a143, v149
    v_accvgpr_write_b32 a172, v152
    v_accvgpr_write_b32 a173, v153
    v_accvgpr_write_b32 a174, v156
    v_accvgpr_write_b32 a175, v157
    s_nop 1
    v_mfma_f32_32x32x16_bf16 v[0:15], a[200:203], a[136:139], v[0:15]
    v_mul_f32 v160, s25, v160
    v_mul_f32 v161, s25, v161
    v_mul_f32 v162, s25, v162
    v_mul_f32 v163, s25, v163
    v_mul_f32 v164, s25, v164
    v_mul_f32 v165, s25, v165
    v_mfma_f32_32x32x16_bf16 v[16:31], a[200:203], a[168:171], v[16:31]
    v_mul_f32 v166, s25, v166
    v_mul_f32 v167, s25, v167
    v_mul_f32 v168, s25, v168
    v_mul_f32 v169, s25, v169
    v_mul_f32 v170, s25, v170
    v_mul_f32 v171, s25, v171
    v_mfma_f32_32x32x16_bf16 v[0:15], a[204:207], a[140:143], v[0:15]
    v_mul_f32 v172, s25, v172
    v_mul_f32 v173, s25, v173
    v_mul_f32 v174, s25, v174
    v_mul_f32 v175, s25, v175
    v_cvt_pk_bf16_f32 v160, v160, v161
    v_cvt_pk_bf16_f32 v161, v162, v163
    v_mfma_f32_32x32x16_bf16 v[16:31], a[204:207], a[172:175], v[16:31]
    v_cvt_pk_bf16_f32 v164, v164, v165
    v_cvt_pk_bf16_f32 v165, v166, v167
    v_cvt_pk_bf16_f32 v168, v168, v169
    v_cvt_pk_bf16_f32 v169, v170, v171
    v_cvt_pk_bf16_f32 v172, v172, v173
    v_cvt_pk_bf16_f32 v173, v174, v175
    v_permlane16_swap_b32 v160, v164
    v_permlane16_swap_b32 v161, v165
    v_permlane16_swap_b32 v168, v172
    v_permlane16_swap_b32 v169, v173
    v_accvgpr_write_b32 a144, v160
    v_accvgpr_write_b32 a145, v161
    v_accvgpr_write_b32 a146, v164
    v_accvgpr_write_b32 a147, v165
    v_accvgpr_write_b32 a176, v168
    v_accvgpr_write_b32 a177, v169
    v_accvgpr_write_b32 a178, v172
    v_accvgpr_write_b32 a179, v173
    v_mul_f32 v176, s25, v176
    v_mul_f32 v177, s25, v177
    v_mul_f32 v178, s25, v178
    v_mul_f32 v179, s25, v179
    v_mul_f32 v180, s25, v180
    v_mul_f32 v181, s25, v181
    v_mul_f32 v182, s25, v182
    v_mul_f32 v183, s25, v183
    v_mul_f32 v184, s25, v184
    v_mul_f32 v185, s25, v185
    v_mul_f32 v186, s25, v186
    v_mul_f32 v187, s25, v187
    v_mul_f32 v188, s25, v188
    v_mul_f32 v189, s25, v189
    v_mul_f32 v190, s25, v190
    v_mul_f32 v191, s25, v191
    v_cvt_pk_bf16_f32 v176, v176, v177
    v_cvt_pk_bf16_f32 v177, v178, v179
    v_cvt_pk_bf16_f32 v180, v180, v181
    v_cvt_pk_bf16_f32 v181, v182, v183
    v_cvt_pk_bf16_f32 v184, v184, v185
    v_cvt_pk_bf16_f32 v185, v186, v187
    v_cvt_pk_bf16_f32 v188, v188, v189
    v_cvt_pk_bf16_f32 v189, v190, v191
    v_permlane16_swap_b32 v176, v180
    v_permlane16_swap_b32 v177, v181
    v_permlane16_swap_b32 v184, v188
    v_permlane16_swap_b32 v185, v189
    v_accvgpr_write_b32 a148, v176
    v_accvgpr_write_b32 a149, v177
    v_accvgpr_write_b32 a150, v180
    v_accvgpr_write_b32 a151, v181
    v_accvgpr_write_b32 a180, v184
    v_accvgpr_write_b32 a181, v185
    v_accvgpr_write_b32 a182, v188
    v_accvgpr_write_b32 a183, v189
    s_nop 1
    s_waitcnt lgkmcnt(0)
    v_mfma_f32_32x32x16_bf16 v[0:15], a[208:211], a[144:147], v[0:15]
    v_mul_f32 v192, s25, v192
    v_mul_f32 v193, s25, v193
    v_mul_f32 v194, s25, v194
    v_mul_f32 v195, s25, v195
    v_mul_f32 v196, s25, v196
    v_mul_f32 v197, s25, v197
    v_mfma_f32_32x32x16_bf16 v[16:31], a[208:211], a[176:179], v[16:31]
    v_mul_f32 v198, s25, v198
    v_mul_f32 v199, s25, v199
    v_mul_f32 v200, s25, v200
    v_mul_f32 v201, s25, v201
    v_mul_f32 v202, s25, v202
    v_mul_f32 v203, s25, v203
    v_mfma_f32_32x32x16_bf16 v[0:15], a[212:215], a[148:151], v[0:15]
    v_mul_f32 v204, s25, v204
    v_mul_f32 v205, s25, v205
    v_mul_f32 v206, s25, v206
    v_mul_f32 v207, s25, v207
    v_cvt_pk_bf16_f32 v192, v192, v193
    v_cvt_pk_bf16_f32 v193, v194, v195
    v_mfma_f32_32x32x16_bf16 v[16:31], a[212:215], a[180:183], v[16:31]
    v_cvt_pk_bf16_f32 v196, v196, v197
    v_cvt_pk_bf16_f32 v197, v198, v199
    v_cvt_pk_bf16_f32 v200, v200, v201
    v_cvt_pk_bf16_f32 v201, v202, v203
    v_cvt_pk_bf16_f32 v204, v204, v205
    v_cvt_pk_bf16_f32 v205, v206, v207
    v_permlane16_swap_b32 v192, v196
    v_permlane16_swap_b32 v193, v197
    v_permlane16_swap_b32 v200, v204
    v_permlane16_swap_b32 v201, v205
    v_accvgpr_write_b32 a152, v192
    v_accvgpr_write_b32 a153, v193
    v_accvgpr_write_b32 a154, v196
    v_accvgpr_write_b32 a155, v197
    v_accvgpr_write_b32 a184, v200
    v_accvgpr_write_b32 a185, v201
    v_accvgpr_write_b32 a186, v204
    v_accvgpr_write_b32 a187, v205
    v_mul_f32 v208, s25, v208
    v_mul_f32 v209, s25, v209
    v_mul_f32 v210, s25, v210
    v_mul_f32 v211, s25, v211
    v_mul_f32 v212, s25, v212
    v_mul_f32 v213, s25, v213
    v_mul_f32 v214, s25, v214
    v_mul_f32 v215, s25, v215
    v_mul_f32 v216, s25, v216
    v_mul_f32 v217, s25, v217
    v_mul_f32 v218, s25, v218
    v_mul_f32 v219, s25, v219
    v_mul_f32 v220, s25, v220
    v_mul_f32 v221, s25, v221
    v_mul_f32 v222, s25, v222
    v_mul_f32 v223, s25, v223
    v_cvt_pk_bf16_f32 v208, v208, v209
    v_cvt_pk_bf16_f32 v209, v210, v211
    v_cvt_pk_bf16_f32 v212, v212, v213
    v_cvt_pk_bf16_f32 v213, v214, v215
    v_cvt_pk_bf16_f32 v216, v216, v217
    v_cvt_pk_bf16_f32 v217, v218, v219
    v_cvt_pk_bf16_f32 v220, v220, v221
    v_cvt_pk_bf16_f32 v221, v222, v223
    v_permlane16_swap_b32 v208, v212
    v_permlane16_swap_b32 v209, v213
    v_permlane16_swap_b32 v216, v220
    v_permlane16_swap_b32 v217, v221
    v_accvgpr_write_b32 a156, v208
    v_accvgpr_write_b32 a157, v209
    v_accvgpr_write_b32 a158, v212
    v_accvgpr_write_b32 a159, v213
    v_accvgpr_write_b32 a188, v216
    v_accvgpr_write_b32 a189, v217
    v_accvgpr_write_b32 a190, v220
    v_accvgpr_write_b32 a191, v221
    s_nop 1
    v_mfma_f32_32x32x16_bf16 v[0:15], a[216:219], a[152:155], v[0:15]
    v_mfma_f32_32x32x16_bf16 v[16:31], a[216:219], a[184:187], v[16:31]
    v_mfma_f32_32x32x16_bf16 v[0:15], a[220:223], a[156:159], v[0:15]
    v_mfma_f32_32x32x16_bf16 v[16:31], a[220:223], a[188:191], v[16:31]
    s_nop 11
    v_max3_f32 v230, v0, v1, v2
    v_max3_f32 v232, v16, v17, v18
    v_max3_f32 v230, v230, v3, v4
    v_max3_f32 v232, v232, v19, v20
    v_max3_f32 v230, v230, v5, v6
    v_max3_f32 v232, v232, v21, v22
    v_max3_f32 v230, v230, v7, v8
    v_max3_f32 v232, v232, v23, v24
    v_max3_f32 v230, v230, v9, v10
    v_max3_f32 v232, v232, v25, v26
    v_max3_f32 v230, v230, v11, v12
    v_max3_f32 v232, v232, v27, v28
    v_max3_f32 v230, v230, v13, v14
    v_max3_f32 v232, v232, v29, v30
    v_max_f32 v230, v230, v15
    v_max_f32 v232, v232, v31
    v_mov_b32 v231, v230
    v_mov_b32 v233, v232
    s_nop 1
    s_nop 1
    v_permlane32_swap_b32 v230, v231
    v_permlane32_swap_b32 v232, v233
    s_nop 0
    s_nop 0
    v_max_f32 v230, v230, v231
    v_max_f32 v232, v232, v233
    v_sub_f32 v228, 0, v230
    v_sub_f32 v64, v64, v230
    v_sub_f32 v65, v65, v230
    v_sub_f32 v66, v66, v230
    v_sub_f32 v67, v67, v230
    v_sub_f32 v68, v68, v230
    v_sub_f32 v69, v69, v230
    v_sub_f32 v70, v70, v230
    v_sub_f32 v71, v71, v230
    v_sub_f32 v72, v72, v230
    v_sub_f32 v73, v73, v230
    v_sub_f32 v74, v74, v230
    v_sub_f32 v75, v75, v230
    v_sub_f32 v76, v76, v230
    v_sub_f32 v77, v77, v230
    v_sub_f32 v78, v78, v230
    v_sub_f32 v79, v79, v230
    v_sub_f32 v229, 0, v232
    v_sub_f32 v80, v80, v232
    v_sub_f32 v81, v81, v232
    v_sub_f32 v82, v82, v232
    v_sub_f32 v83, v83, v232
    v_sub_f32 v84, v84, v232
    v_sub_f32 v85, v85, v232
    v_sub_f32 v86, v86, v232
    v_sub_f32 v87, v87, v232
    v_sub_f32 v88, v88, v232
    v_sub_f32 v89, v89, v232
    v_sub_f32 v90, v90, v232
    v_sub_f32 v91, v91, v232
    v_sub_f32 v92, v92, v232
    v_sub_f32 v93, v93, v232
    v_sub_f32 v94, v94, v232
    v_sub_f32 v95, v95, v232
    v_sub_f32 v0, v0, v230
    v_sub_f32 v1, v1, v230
    v_sub_f32 v2, v2, v230
    v_sub_f32 v3, v3, v230
    v_sub_f32 v4, v4, v230
    v_sub_f32 v5, v5, v230
    v_sub_f32 v6, v6, v230
    v_sub_f32 v7, v7, v230
    v_sub_f32 v8, v8, v230
    v_sub_f32 v9, v9, v230
    v_sub_f32 v10, v10, v230
    v_sub_f32 v11, v11, v230
    v_sub_f32 v12, v12, v230
    v_sub_f32 v13, v13, v230
    v_sub_f32 v14, v14, v230
    v_sub_f32 v15, v15, v230
    v_sub_f32 v16, v16, v232
    v_sub_f32 v17, v17, v232
    v_sub_f32 v18, v18, v232
    v_sub_f32 v19, v19, v232
    v_sub_f32 v20, v20, v232
    v_sub_f32 v21, v21, v232
    v_sub_f32 v22, v22, v232
    v_sub_f32 v23, v23, v232
    v_sub_f32 v24, v24, v232
    v_sub_f32 v25, v25, v232
    v_sub_f32 v26, v26, v232
    v_sub_f32 v27, v27, v232
    v_sub_f32 v28, v28, v232
    v_sub_f32 v29, v29, v232
    v_sub_f32 v30, v30, v232
    v_sub_f32 v31, v31, v232
    s_mov_b32 s35, 32768
    v_add_u32 v241, s35, v239
    s_sub_u32 s36, s36, 1
    s_cbranch_scc1 kf_fix3
kf_fixr4:
    v_mfma_f32_32x32x16_bf16 v[32:47], a[224:227], a[128:131], v[64:79]
    ds_read_b128 a[192:195], v241 offset:0
    v_exp_f32 v136, v0
    v_exp_f32 v137, v1
    v_exp_f32 v130, v2
    v_mfma_f32_32x32x16_bf16 v[48:63], a[224:227], a[160:163], v[80:95]
    v_exp_f32 v131, v3
    v_cvt_pk_bf16_f32 v96, v136, v137
    v_exp_f32 v132, v4
    v_exp_f32 v133, v5
    v_cvt_pk_bf16_f32 v97, v130, v131
    v_add_f32 v136, v136, v130
    v_mfma_f32_32x32x16_bf16 v[32:47], a[228:231], a[132:135], v[32:47]
    ds_read_b128 a[196:199], v241 offset:512
    v_add_f32 v137, v137, v131
    v_exp_f32 v134, v6
    v_exp_f32 v135, v7
    v_cvt_pk_bf16_f32 v98, v132, v133
    v_mfma_f32_32x32x16_bf16 v[48:63], a[228:231], a[164:167], v[48:63]
    v_add_f32 v136, v136, v132
    v_add_f32 v137, v137, v133
    v_exp_f32 v128, v8
    v_exp_f32 v129, v9
    v_cvt_pk_bf16_f32 v99, v134, v135
    v_add_f32 v136, v136, v134
    v_add_f32 v137, v137, v135
    v_mfma_f32_32x32x16_bf16 v[32:47], a[232:235], a[136:139], v[32:47]
    ds_read_b128 a[200:203], v241 offset:2048
    v_exp_f32 v130, v10
    v_exp_f32 v131, v11
    v_cvt_pk_bf16_f32 v100, v128, v129
    v_add_f32 v136, v136, v128
    v_mfma_f32_32x32x16_bf16 v[48:63], a[232:235], a[168:171], v[48:63]
    v_add_f32 v137, v137, v129
    v_exp_f32 v132, v12
    v_exp_f32 v133, v13
    v_cvt_pk_bf16_f32 v101, v130, v131
    v_add_f32 v136, v136, v130
    v_add_f32 v137, v137, v131
    v_mfma_f32_32x32x16_bf16 v[32:47], a[236:239], a[140:143], v[32:47]
    ds_read_b128 a[204:207], v241 offset:2560
    v_exp_f32 v134, v14
    v_exp_f32 v135, v15
    v_cvt_pk_bf16_f32 v102, v132, v133
    v_add_f32 v136, v136, v132
    v_add_f32 v137, v137, v133
    v_mfma_f32_32x32x16_bf16 v[48:63], a[236:239], a[172:175], v[48:63]
    v_exp_f32 v138, v16
    v_exp_f32 v139, v17
    v_cvt_pk_bf16_f32 v103, v134, v135
    v_add_f32 v136, v136, v134
    v_add_f32 v137, v137, v135
    v_add_f32 v224, v136, v137
    v_mfma_f32_32x32x16_bf16 v[32:47], a[240:243], a[144:147], v[32:47]
    ds_read_b128 a[208:211], v241 offset:4096
    v_exp_f32 v130, v18
    v_exp_f32 v131, v19
    v_cvt_pk_bf16_f32 v104, v138, v139
    v_exp_f32 v132, v20
    v_mfma_f32_32x32x16_bf16 v[48:63], a[240:243], a[176:179], v[48:63]
    v_exp_f32 v133, v21
    v_cvt_pk_bf16_f32 v105, v130, v131
    v_add_f32 v138, v138, v130
    v_add_f32 v139, v139, v131
    v_exp_f32 v134, v22
    v_mfma_f32_32x32x16_bf16 v[32:47], a[244:247], a[148:151], v[32:47]
    ds_read_b128 a[212:215], v241 offset:4608
    v_exp_f32 v135, v23
    v_cvt_pk_bf16_f32 v106, v132, v133
    v_add_f32 v138, v138, v132
    v_add_f32 v139, v139, v133
    v_exp_f32 v128, v24
    v_mfma_f32_32x32x16_bf16 v[48:63], a[244:247], a[180:183], v[48:63]
    v_exp_f32 v129, v25
    v_cvt_pk_bf16_f32 v107, v134, v135
    v_add_f32 v138, v138, v134
    v_add_f32 v139, v139, v135
    v_exp_f32 v130, v26
    v_exp_f32 v131, v27
    v_mfma_f32_32x32x16_bf16 v[32:47], a[248:251], a[152:155], v[32:47]
    ds_read_b128 a[216:219], v241 offset:6144
    v_cvt_pk_bf16_f32 v108, v128, v129
    v_add_f32 v138, v138, v128
    v_add_f32 v139, v139, v129
    v_exp_f32 v132, v28
    v_exp_f32 v133, v29
    v_mfma_f32_32x32x16_bf16 v[48:63], a[248:251], a[184:187], v[48:63]
    v_cvt_pk_bf16_f32 v109, v130, v131
    v_add_f32 v138, v138, v130
    v_add_f32 v139, v139, v131
    v_exp_f32 v134, v30
    v_exp_f32 v135, v31
    v_mfma_f32_32x32x16_bf16 v[32:47], a[252:255], a[156:159], v[32:47]
    ds_read_b128 a[220:223], v241 offset:6656
    v_cvt_pk_bf16_f32 v110, v132, v133
    v_add_f32 v138, v138, v132
    v_add_f32 v139, v139, v133
    v_cvt_pk_bf16_f32 v111, v134, v135
    v_add_f32 v138, v138, v134
    v_add_f32 v139, v139, v135
    v_add_f32 v225, v138, v139
    v_mfma_f32_32x32x16_bf16 v[48:63], a[252:255], a[188:191], v[48:63]
    ds_read_b128 a[224:227], v241 offset:16384
    ds_read_b128 a[228:231], v241 offset:18432
    ds_read_b128 a[232:235], v241 offset:20480
    ds_read_b128 a[236:239], v241 offset:22528
    s_mov_b32 s58, 0x800000
    s_mov_b32 s31, s101
    s_and_b32 s28, s2, 6
    s_lshl_b32 s28, s28, 20
    s_lshr_b32 s27, s2, 3
    s_lshl2_add_u32 s27, s27, s3
    s_lshl_b32 s27, s27, 14
    s_add_u32 s28, s28, s27
    s_mov_b32 s27, 19
    s_add_u32 s8, s20, 0x2c00000
    s_addc_u32 s9, s21, 0
    s_mov_b32 s10, 0xc00000
    s_lshl2_add_u32 s29, s2, s3
    s_mul_i32 s29, s29, 12288
    s_add_u32 s30, s29, 12288
    v_mov_b32 v200, -1
    v_mov_b32 v201, -1
    v_mov_b32 v202, -1
    v_mov_b32 v203, -1
    s_lshl1_add_u32 s26, s5, s31
    s_branch ka_p1_e
.p2align 3
ka_p1:
    s_sub_u32 s36, s36, 1
    s_cbranch_scc1 kf_fix5
kf_fixr6:
    s_waitcnt lgkmcnt(8)
    v_mfma_f32_32x32x16_bf16 v[0:15], a[192:195], a[128:131], v[64:79]
    ds_read_b128 a[240:243], v241 offset:16896
    v_add_f32 v226, v226, v224
    v_add_f32 v227, v227, v225
    v_exp_f32 v136, v32
    v_mfma_f32_32x32x16_bf16 v[16:31], a[192:195], a[160:163], v[80:95]
    s_waitcnt vmcnt(11)
    buffer_store_dwordx4 v[192:195], v255, s[48:51], s45 offen offset:0 sc1
    s_cmp_lt_u32 s44, s47
    s_cselect_b32 s101, s44, s43
    buffer_load_dwordx4 v[192:195], v253, s[52:55], s101 offen
    v_mfma_f32_32x32x16_bf16 v[0:15], a[196:199], a[132:135], v[0:15]
    ds_read_b128 a[244:247], v241 offset:18944
    v_exp_f32 v137, v33
    v_exp_f32 v130, v34
    v_mfma_f32_32x32x16_bf16 v[16:31], a[196:199], a[164:167], v[16:31]
    v_exp_f32 v131, v35
    v_cvt_pk_bf16_f32 v112, v136, v137
    v_exp_f32 v132, v36
    v_mfma_f32_32x32x16_bf16 v[0:15], a[200:203], a[136:139], v[0:15]
    ds_read_b128 a[248:251], v241 offset:20992
    v_exp_f32 v133, v37
    v_cvt_pk_bf16_f32 v113, v130, v131
    v_mfma_f32_32x32x16_bf16 v[16:31], a[200:203], a[168:171], v[16:31]
    v_add_f32 v136, v136, v130
    v_add_f32 v137, v137, v131
    v_exp_f32 v134, v38
    v_mfma_f32_32x32x16_bf16 v[0:15], a[204:207], a[140:143], v[0:15]
    ds_read_b128 a[252:255], v241 offset:23040
    s_mov_b32 m0, s34
    s_add_u32 s41, s42, 17664
    v_exp_f32 v135, v39
    v_cvt_pk_bf16_f32 v114, v132, v133
    v_mfma_f32_32x32x16_bf16 v[16:31], a[204:207], a[172:175], v[16:31]
    v_add_f32 v136, v136, v132
    v_add_f32 v137, v137, v133
    v_exp_f32 v128, v40
    s_waitcnt lgkmcnt(8)
    v_mfma_f32_32x32x16_bf16 v[0:15], a[208:211], a[144:147], v[0:15]
    ds_read_b128 a[192:195], v241 offset:8192
    v_exp_f32 v129, v41
    v_cvt_pk_bf16_f32 v115, v134, v135
    v_mfma_f32_32x32x16_bf16 v[16:31], a[208:211], a[176:179], v[16:31]
    v_add_f32 v136, v136, v134
    v_add_f32 v137, v137, v135
    v_exp_f32 v130, v42
    v_mfma_f32_32x32x16_bf16 v[0:15], a[212:215], a[148:151], v[0:15]
    ds_read_b128 a[196:199], v241 offset:8704
    v_exp_f32 v131, v43
    v_cvt_pk_bf16_f32 v116, v128, v129
    v_add_f32 v136, v136, v128
    v_mfma_f32_32x32x16_bf16 v[16:31], a[212:215], a[180:183], v[16:31]
    buffer_load_dwordx4 v242, s[16:19], s41 offen offset:0 sc1 lds
    v_add_f32 v137, v137, v129
    v_exp_f32 v132, v44
    v_mfma_f32_32x32x16_bf16 v[0:15], a[216:219], a[152:155], v[0:15]
    ds_read_b128 a[200:203], v241 offset:10240
    v_exp_f32 v133, v45
    v_cvt_pk_bf16_f32 v117, v130, v131
    v_add_f32 v136, v136, v130
    v_mfma_f32_32x32x16_bf16 v[16:31], a[216:219], a[184:187], v[16:31]
    v_add_f32 v137, v137, v131
    v_exp_f32 v134, v46
    v_exp_f32 v135, v47
    v_mfma_f32_32x32x16_bf16 v[0:15], a[220:223], a[156:159], v[0:15]
    ds_read_b128 a[204:207], v241 offset:10752
    v_cvt_pk_bf16_f32 v118, v132, v133
    v_add_f32 v136, v136, v132
    v_add_f32 v137, v137, v133
    v_mfma_f32_32x32x16_bf16 v[16:31], a[220:223], a[188:191], v[16:31]
    v_exp_f32 v138, v48
    v_exp_f32 v139, v49
    s_waitcnt lgkmcnt(8)
    v_mfma_f32_32x32x16_bf16 a[0:15], a[224:227], v[96:99], a[0:15]
    ds_read_b128 a[208:211], v241 offset:12288
    buffer_load_dwordx4 v242, s[16:19], s41 offen offset:1024 sc1 lds
    v_cvt_pk_bf16_f32 v119, v134, v135
    v_add_f32 v136, v136, v134
    v_add_f32 v137, v137, v135
    v_mfma_f32_32x32x16_bf16 a[64:79], a[224:227], v[104:107], a[64:79]
    v_add_f32 v224, v136, v137
    v_exp_f32 v130, v50
    v_exp_f32 v131, v51
    v_mfma_f32_32x32x16_bf16 a[16:31], a[228:231], v[96:99], a[16:31]
    ds_read_b128 a[212:215], v241 offset:12800
    v_cvt_pk_bf16_f32 v120, v138, v139
    v_exp_f32 v132, v52
    v_mfma_f32_32x32x16_bf16 a[80:95], a[228:231], v[104:107], a[80:95]
    v_exp_f32 v133, v53
    v_cvt_pk_bf16_f32 v121, v130, v131
    v_add_f32 v138, v138, v130
    v_mfma_f32_32x32x16_bf16 a[32:47], a[232:235], v[96:99], a[32:47]
    ds_read_b128 a[216:219], v241 offset:14336
    v_add_f32 v139, v139, v131
    v_exp_f32 v134, v54
    v_exp_f32 v135, v55
    v_mfma_f32_32x32x16_bf16 a[96:111], a[232:235], v[104:107], a[96:111]
    buffer_load_dwordx4 v242, s[16:19], s41 offen offset:2048 sc1 lds
    v_cvt_pk_bf16_f32 v122, v132, v133
    v_add_f32 v138, v138, v132
    v_add_f32 v139, v139, v133
    v_mfma_f32_32x32x16_bf16 a[48:63], a[236:239], v[96:99], a[48:63]
    ds_read_b128 a[220:223], v241 offset:14848
    v_exp_f32 v128, v56
    v_exp_f32 v129, v57
    v_mfma_f32_32x32x16_bf16 a[112:127], a[236:239], v[104:107], a[112:127]
    v_cvt_pk_bf16_f32 v123, v134, v135
    v_add_f32 v138, v138, v134
    v_add_f32 v139, v139, v135
    s_waitcnt lgkmcnt(8)
    v_mfma_f32_32x32x16_bf16 a[0:15], a[240:243], v[100:103], a[0:15]
    ds_read_b128 a[224:227], v241 offset:24576
    v_exp_f32 v130, v58
    v_exp_f32 v131, v59
    v_mfma_f32_32x32x16_bf16 a[64:79], a[240:243], v[108:111], a[64:79]
    v_cvt_pk_bf16_f32 v124, v128, v129
    v_add_f32 v138, v138, v128
    v_add_f32 v139, v139, v129
    v_exp_f32 v132, v60
    v_mfma_f32_32x32x16_bf16 a[16:31], a[244:247], v[100:103], a[16:31]
    ds_read_b128 a[228:231], v241 offset:26624
    buffer_load_dwordx4 v242, s[16:19], s41 offen offset:3072 sc1 lds
    v_exp_f32 v133, v61
    v_mfma_f32_32x32x16_bf16 a[80:95], a[244:247], v[108:111], a[80:95]
    v_cvt_pk_bf16_f32 v125, v130, v131
    v_add_f32 v138, v138, v130
    v_add_f32 v139, v139, v131
    v_exp_f32 v134, v62
    v_mfma_f32_32x32x16_bf16 a[32:47], a[248:251], v[100:103], a[32:47]
    ds_read_b128 a[232:235], v241 offset:28672
    v_exp_f32 v135, v63
    v_cvt_pk_bf16_f32 v126, v132, v133
    v_mfma_f32_32x32x16_bf16 a[96:111], a[248:251], v[108:111], a[96:111]
    v_add_f32 v138, v138, v132
    v_add_f32 v139, v139, v133
    v_cvt_pk_bf16_f32 v127, v134, v135
    v_add_f32 v138, v138, v134
    v_mfma_f32_32x32x16_bf16 a[48:63], a[252:255], v[100:103], a[48:63]
    ds_read_b128 a[236:239], v241 offset:30720
    v_add_f32 v139, v139, v135
    v_add_f32 v225, v138, v139
    v_max_f32 v230, v224, v225
    v_cmp_lt_f32 vcc, s38, v230
    v_mfma_f32_32x32x16_bf16 a[112:127], a[252:255], v[108:111], a[112:127]
    s_cbranch_vccnz kf_rare8
kf_rr7:
    s_sub_u32 s36, s36, 1
    s_cbranch_scc1 kf_fix9
kf_fixr10:
    s_waitcnt lgkmcnt(8)
    v_mfma_f32_32x32x16_bf16 v[32:47], a[192:195], a[128:131], v[64:79]
    ds_read_b128 a[240:243], v241 offset:25088
    v_add_f32 v226, v226, v224
    v_add_f32 v227, v227, v225
    v_exp_f32 v136, v0
    v_mfma_f32_32x32x16_bf16 v[48:63], a[192:195], a[160:163], v[80:95]
    s_waitcnt vmcnt(11)
    buffer_store_dwordx4 v[196:199], v255, s[48:51], s45 offen offset:256 sc1
    s_add_u32 s101, s101, 57344
    buffer_load_dwordx4 v[196:199], v253, s[52:55], s101 offen
    v_exp_f32 v137, v1
    v_mfma_f32_32x32x16_bf16 v[32:47], a[196:199], a[132:135], v[32:47]
    ds_read_b128 a[244:247], v241 offset:27136
    v_exp_f32 v130, v2
    v_exp_f32 v131, v3
    v_mfma_f32_32x32x16_bf16 v[48:63], a[196:199], a[164:167], v[48:63]
    v_cvt_pk_bf16_f32 v96, v136, v137
    v_exp_f32 v132, v4
    v_mfma_f32_32x32x16_bf16 v[32:47], a[200:203], a[136:139], v[32:47]
    ds_read_b128 a[248:251], v241 offset:29184
    s_cmp_lt_u32 s44, s47
    s_cselect_b32 s45, s46, s43
    s_add_u32 s44, s44, 128
    s_add_u32 s46, s46, 262144
    v_exp_f32 v133, v5
    v_mfma_f32_32x32x16_bf16 v[48:63], a[200:203], a[168:171], v[48:63]
    v_cvt_pk_bf16_f32 v97, v130, v131
    v_add_f32 v136, v136, v130
    v_add_f32 v137, v137, v131
    v_exp_f32 v134, v6
    v_mfma_f32_32x32x16_bf16 v[32:47], a[204:207], a[140:143], v[32:47]
    ds_read_b128 a[252:255], v241 offset:31232
    v_exp_f32 v135, v7
    v_cvt_pk_bf16_f32 v98, v132, v133
    v_mfma_f32_32x32x16_bf16 v[48:63], a[204:207], a[172:175], v[48:63]
    v_add_f32 v136, v136, v132
    v_add_f32 v137, v137, v133
    v_exp_f32 v128, v8
    s_waitcnt lgkmcnt(8)
    v_mfma_f32_32x32x16_bf16 v[32:47], a[208:211], a[144:147], v[32:47]
    s_waitcnt vmcnt(16)
    s_barrier
    s_add_u32 s35, s35, 32768
    s_cmp_ge_u32 s35, 163840
    s_cselect_b32 s35, 0, s35
    v_add_u32 v241, s35, v239
    ds_read_b128 a[192:195], v241 offset:0
    s_add_u32 m0, s34, 16384
    s_add_u32 s34, s34, 32768
    s_cmp_ge_u32 s34, 163840
    s_cselect_b32 s34, s37, s34
    v_mfma_f32_32x32x16_bf16 v[48:63], a[208:211], a[176:179], v[48:63]
    v_exp_f32 v129, v9
    v_cvt_pk_bf16_f32 v99, v134, v135
    v_add_f32 v136, v136, v134
    v_add_f32 v137, v137, v135
    v_mfma_f32_32x32x16_bf16 v[32:47], a[212:215], a[148:151], v[32:47]
    ds_read_b128 a[196:199], v241 offset:512
    v_exp_f32 v130, v10
    v_exp_f32 v131, v11
    v_mfma_f32_32x32x16_bf16 v[48:63], a[212:215], a[180:183], v[48:63]
    v_cvt_pk_bf16_f32 v100, v128, v129
    v_add_f32 v136, v136, v128
    v_add_f32 v137, v137, v129
    v_exp_f32 v132, v12
    v_mfma_f32_32x32x16_bf16 v[32:47], a[216:219], a[152:155], v[32:47]
    ds_read_b128 a[200:203], v241 offset:2048
    buffer_load_dwordx4 v242, s[16:19], s42 offen offset:0 sc1 lds
    v_exp_f32 v133, v13
    v_mfma_f32_32x32x16_bf16 v[48:63], a[216:219], a[184:187], v[48:63]
    v_cvt_pk_bf16_f32 v101, v130, v131
    v_add_f32 v136, v136, v130
    v_add_f32 v137, v137, v131
    v_exp_f32 v134, v14
    v_mfma_f32_32x32x16_bf16 v[32:47], a[220:223], a[156:159], v[32:47]
    ds_read_b128 a[204:207], v241 offset:2560
    v_exp_f32 v135, v15
    v_cvt_pk_bf16_f32 v102, v132, v133
    v_add_f32 v136, v136, v132
    v_mfma_f32_32x32x16_bf16 v[48:63], a[220:223], a[188:191], v[48:63]
    v_add_f32 v137, v137, v133
    v_exp_f32 v138, v16
    s_waitcnt lgkmcnt(8)
    v_mfma_f32_32x32x16_bf16 a[0:15], a[224:227], v[112:115], a[0:15]
    ds_read_b128 a[208:211], v241 offset:4096
    buffer_load_dwordx4 v242, s[16:19], s42 offen offset:1024 sc1 lds
    v_exp_f32 v139, v17
    v_cvt_pk_bf16_f32 v103, v134, v135
    v_add_f32 v136, v136, v134
    v_mfma_f32_32x32x16_bf16 a[64:79], a[224:227], v[120:123], a[64:79]
    v_add_f32 v137, v137, v135
    v_add_f32 v224, v136, v137
    v_exp_f32 v130, v18
    v_mfma_f32_32x32x16_bf16 a[16:31], a[228:231], v[112:115], a[16:31]
    ds_read_b128 a[212:215], v241 offset:4608
    v_exp_f32 v131, v19
    v_cvt_pk_bf16_f32 v104, v138, v139
    v_exp_f32 v132, v20
    v_mfma_f32_32x32x16_bf16 a[80:95], a[228:231], v[120:123], a[80:95]
    buffer_load_dwordx4 v242, s[16:19], s42 offen offset:2048 sc1 lds
    v_exp_f32 v133, v21
    v_cvt_pk_bf16_f32 v105, v130, v131
    v_mfma_f32_32x32x16_bf16 a[32:47], a[232:235], v[112:115], a[32:47]
    ds_read_b128 a[216:219], v241 offset:6144
    v_add_f32 v138, v138, v130
    v_add_f32 v139, v139, v131
    v_exp_f32 v134, v22
    v_mfma_f32_32x32x16_bf16 a[96:111], a[232:235], v[120:123], a[96:111]
    v_exp_f32 v135, v23
    v_cvt_pk_bf16_f32 v106, v132, v133
    v_add_f32 v138, v138, v132
    v_add_f32 v139, v139, v133
    v_mfma_f32_32x32x16_bf16 a[48:63], a[236:239], v[112:115], a[48:63]
    ds_read_b128 a[220:223], v241 offset:6656
    v_exp_f32 v128, v24
    v_exp_f32 v129, v25
    v_mfma_f32_32x32x16_bf16 a[112:127], a[236:239], v[120:123], a[112:127]
    buffer_load_dwordx4 v242, s[16:19], s42 offen offset:3072 sc1 lds
    s_add_u32 s42, s42, 34048
    v_cvt_pk_bf16_f32 v107, v134, v135
    v_add_f32 v138, v138, v134
    s_waitcnt lgkmcnt(8)
    v_mfma_f32_32x32x16_bf16 a[0:15], a[240:243], v[116:119], a[0:15]
    ds_read_b128 a[224:227], v241 offset:16384
    v_add_f32 v139, v139, v135
    v_exp_f32 v130, v26
    v_mfma_f32_32x32x16_bf16 a[64:79], a[240:243], v[124:127], a[64:79]
    v_exp_f32 v131, v27
    v_cvt_pk_bf16_f32 v108, v128, v129
    v_add_f32 v138, v138, v128
    v_add_f32 v139, v139, v129
    v_mfma_f32_32x32x16_bf16 a[16:31], a[244:247], v[116:119], a[16:31]
    ds_read_b128 a[228:231], v241 offset:18432
    v_exp_f32 v132, v28
    v_exp_f32 v133, v29
    v_mfma_f32_32x32x16_bf16 a[80:95], a[244:247], v[124:127], a[80:95]
    buffer_load_dword v252, v251, s[60:63], s100 offen
    s_add_u32 s100, s100, 2048
    v_cvt_pk_bf16_f32 v109, v130, v131
    v_add_f32 v138, v138, v130
    v_add_f32 v139, v139, v131
    v_mfma_f32_32x32x16_bf16 a[32:47], a[248:251], v[116:119], a[32:47]
    ds_read_b128 a[232:235], v241 offset:20480
    v_exp_f32 v134, v30
    v_exp_f32 v135, v31
    v_mfma_f32_32x32x16_bf16 a[96:111], a[248:251], v[124:127], a[96:111]
    v_cvt_pk_bf16_f32 v110, v132, v133
    v_add_f32 v138, v138, v132
    v_add_f32 v139, v139, v133
    v_cvt_pk_bf16_f32 v111, v134, v135
    v_add_f32 v138, v138, v134
    v_mfma_f32_32x32x16_bf16 a[48:63], a[252:255], v[116:119], a[48:63]
    ds_read_b128 a[236:239], v241 offset:22528
    v_add_f32 v139, v139, v135
    v_add_f32 v225, v138, v139
    v_max_f32 v230, v224, v225
    v_cmp_lt_f32 vcc, s38, v230
    v_mfma_f32_32x32x16_bf16 a[112:127], a[252:255], v[124:127], a[112:127]
    s_cbranch_vccnz kf_rare12
kf_rr11:
ka_p1_e:
    s_sub_u32 s26, s26, 1
    s_cbranch_scc0 ka_p1
    s_lshl2_add_u32 s36, s5, s6
    s_lshl1_add_u32 s36, s31, s36
    s_sub_u32 s36, 61, s36
    s_mov_b32 s33, 0
    s_sub_u32 s36, s36, 1
    s_cbranch_scc1 kf_fix13
kf_fixr14:
    s_waitcnt lgkmcnt(8)
    v_mfma_f32_32x32x16_bf16 v[16:31], a[192:195], a[160:163], v[80:95]
    ds_read_b128 a[240:243], v241 offset:16896
    v_add_f32 v226, v226, v224
    v_add_f32 v227, v227, v225
    v_exp_f32 v136, v32
    v_exp_f32 v137, v33
    v_mfma_f32_32x32x16_bf16 v[16:31], a[196:199], a[164:167], v[16:31]
    ds_read_b128 a[244:247], v241 offset:18944
    s_waitcnt vmcnt(11)
    buffer_store_dwordx4 v[192:195], v255, s[48:51], s45 offen offset:0 sc1
    v_exp_f32 v130, v34
    v_mfma_f32_32x32x16_bf16 v[16:31], a[200:203], a[168:171], v[16:31]
    ds_read_b128 a[248:251], v241 offset:20992
    v_exp_f32 v131, v35
    v_cvt_pk_bf16_f32 v112, v136, v137
    v_exp_f32 v132, v36
    v_mfma_f32_32x32x16_bf16 v[16:31], a[204:207], a[172:175], v[16:31]
    ds_read_b128 a[252:255], v241 offset:23040
    v_exp_f32 v133, v37
    v_cvt_pk_bf16_f32 v113, v130, v131
    v_add_f32 v136, v136, v130
    s_waitcnt lgkmcnt(8)
    v_mfma_f32_32x32x16_bf16 v[16:31], a[208:211], a[176:179], v[16:31]
    ds_read_b128 a[192:195], v241 offset:8192
    s_mov_b32 m0, s34
    s_add_u32 s41, s42, 17664
    v_add_f32 v137, v137, v131
    v_exp_f32 v134, v38
    v_mfma_f32_32x32x16_bf16 v[16:31], a[212:215], a[180:183], v[16:31]
    ds_read_b128 a[196:199], v241 offset:8704
    v_exp_f32 v135, v39
    v_cvt_pk_bf16_f32 v114, v132, v133
    v_add_f32 v136, v136, v132
    v_add_f32 v137, v137, v133
    v_mfma_f32_32x32x16_bf16 v[16:31], a[216:219], a[184:187], v[16:31]
    ds_read_b128 a[200:203], v241 offset:10240
    v_exp_f32 v128, v40
    v_exp_f32 v129, v41
    v_cvt_pk_bf16_f32 v115, v134, v135
    v_add_f32 v136, v136, v134
    v_mfma_f32_32x32x16_bf16 v[16:31], a[220:223], a[188:191], v[16:31]
    ds_read_b128 a[204:207], v241 offset:10752
    v_add_f32 v137, v137, v135
    v_exp_f32 v130, v42
    s_waitcnt lgkmcnt(8)
    v_mfma_f32_32x32x16_bf16 a[0:15], a[224:227], v[96:99], a[0:15]
    ds_read_b128 a[208:211], v241 offset:12288
    buffer_load_dwordx4 v242, s[16:19], s41 offen offset:0 sc1 lds
    v_exp_f32 v131, v43
    v_cvt_pk_bf16_f32 v116, v128, v129
    v_add_f32 v136, v136, v128
    v_add_f32 v137, v137, v129
    v_mfma_f32_32x32x16_bf16 a[64:79], a[224:227], v[104:107], a[64:79]
    v_exp_f32 v132, v44
    v_exp_f32 v133, v45
    v_cvt_pk_bf16_f32 v117, v130, v131
    v_add_f32 v136, v136, v130
    v_mfma_f32_32x32x16_bf16 a[16:31], a[228:231], v[96:99], a[16:31]
    ds_read_b128 a[212:215], v241 offset:12800
    v_add_f32 v137, v137, v131
    v_exp_f32 v134, v46
    v_exp_f32 v135, v47
    v_mfma_f32_32x32x16_bf16 a[80:95], a[228:231], v[104:107], a[80:95]
    v_cvt_pk_bf16_f32 v118, v132, v133
    v_add_f32 v136, v136, v132
    v_add_f32 v137, v137, v133
    v_exp_f32 v138, v48
    v_exp_f32 v139, v49
    v_mfma_f32_32x32x16_bf16 a[32:47], a[232:235], v[96:99], a[32:47]
    ds_read_b128 a[216:219], v241 offset:14336
    buffer_load_dwordx4 v242, s[16:19], s41 offen offset:1024 sc1 lds
    v_cvt_pk_bf16_f32 v119, v134, v135
    v_add_f32 v136, v136, v134
    v_add_f32 v137, v137, v135
    v_add_f32 v224, v136, v137
    v_mfma_f32_32x32x16_bf16 a[96:111], a[232:235], v[104:107], a[96:111]
    v_exp_f32 v130, v50
    v_exp_f32 v131, v51
    v_cvt_pk_bf16_f32 v120, v138, v139
    v_mfma_f32_32x32x16_bf16 a[48:63], a[236:239], v[96:99], a[48:63]
    ds_read_b128 a[220:223], v241 offset:14848
    v_exp_f32 v132, v52
    v_exp_f32 v133, v53
    v_cvt_pk_bf16_f32 v121, v130, v131
    v_add_f32 v138, v138, v130
    v_mfma_f32_32x32x16_bf16 a[112:127], a[236:239], v[104:107], a[112:127]
    buffer_load_dwordx4 v242, s[16:19], s41 offen offset:2048 sc1 lds
    v_add_f32 v139, v139, v131
    v_exp_f32 v134, v54
    v_exp_f32 v135, v55
    s_waitcnt lgkmcnt(8)
    v_mfma_f32_32x32x16_bf16 a[0:15], a[240:243], v[100:103], a[0:15]
    ds_read_b128 a[224:227], v241 offset:24576
    v_cvt_pk_bf16_f32 v122, v132, v133
    v_add_f32 v138, v138, v132
    v_add_f32 v139, v139, v133
    v_exp_f32 v128, v56
    v_mfma_f32_32x32x16_bf16 a[64:79], a[240:243], v[108:111], a[64:79]
    v_exp_f32 v129, v57
    v_cvt_pk_bf16_f32 v123, v134, v135
    v_add_f32 v138, v138, v134
    v_add_f32 v139, v139, v135
    v_mfma_f32_32x32x16_bf16 a[16:31], a[244:247], v[100:103], a[16:31]
    ds_read_b128 a[228:231], v241 offset:26624
    v_exp_f32 v130, v58
    v_exp_f32 v131, v59
    v_cvt_pk_bf16_f32 v124, v128, v129
    v_mfma_f32_32x32x16_bf16 a[80:95], a[244:247], v[108:111], a[80:95]
    buffer_load_dwordx4 v242, s[16:19], s41 offen offset:3072 sc1 lds
    v_add_f32 v138, v138, v128
    v_add_f32 v139, v139, v129
    v_exp_f32 v132, v60
    v_exp_f32 v133, v61
    v_mfma_f32_32x32x16_bf16 a[32:47], a[248:251], v[100:103], a[32:47]
    ds_read_b128 a[232:235], v241 offset:28672
    v_cvt_pk_bf16_f32 v125, v130, v131
    v_add_f32 v138, v138, v130
    v_add_f32 v139, v139, v131
    v_exp_f32 v134, v62
    v_mfma_f32_32x32x16_bf16 a[96:111], a[248:251], v[108:111], a[96:111]
    v_exp_f32 v135, v63
    v_cvt_pk_bf16_f32 v126, v132, v133
    v_add_f32 v138, v138, v132
    v_add_f32 v139, v139, v133
    v_cvt_pk_bf16_f32 v127, v134, v135
    v_mfma_f32_32x32x16_bf16 a[48:63], a[252:255], v[100:103], a[48:63]
    ds_read_b128 a[236:239], v241 offset:30720
    v_add_f32 v138, v138, v134
    v_add_f32 v139, v139, v135
    v_add_f32 v225, v138, v139
    v_max_f32 v230, v224, v225
    v_cmp_lt_f32 vcc, s38, v230
    v_mfma_f32_32x32x16_bf16 a[112:127], a[252:255], v[108:111], a[112:127]
    s_cbranch_vccnz kf_rare16
kf_rr15:
    s_sub_u32 s36, s36, 1
    s_cbranch_scc1 kf_fix17
kf_fixr18:
    s_waitcnt lgkmcnt(8)
    v_mfma_f32_32x32x16_bf16 v[48:63], a[192:195], a[160:163], v[80:95]
    ds_read_b128 a[240:243], v241 offset:25088
    v_add_f32 v226, v226, v224
    v_add_f32 v227, v227, v225
    v_mfma_f32_32x32x16_bf16 v[48:63], a[196:199], a[164:167], v[48:63]
    ds_read_b128 a[244:247], v241 offset:27136
    s_waitcnt vmcnt(10)
    buffer_store_dwordx4 v[196:199], v255, s[48:51], s45 offen offset:256 sc1
    v_exp_f32 v138, v16
    v_mfma_f32_32x32x16_bf16 v[48:63], a[200:203], a[168:171], v[48:63]
    ds_read_b128 a[248:251], v241 offset:29184
    v_exp_f32 v139, v17
    v_exp_f32 v130, v18
    v_mfma_f32_32x32x16_bf16 v[48:63], a[204:207], a[172:175], v[48:63]
    ds_read_b128 a[252:255], v241 offset:31232
    v_exp_f32 v131, v19
    s_waitcnt lgkmcnt(8)
    v_mfma_f32_32x32x16_bf16 v[48:63], a[208:211], a[176:179], v[48:63]
    s_waitcnt vmcnt(14)
    s_barrier
    s_add_u32 s35, s35, 32768
    s_cmp_ge_u32 s35, 163840
    s_cselect_b32 s35, 0, s35
    v_add_u32 v241, s35, v239
    ds_read_b128 a[192:195], v241 offset:0
    s_add_u32 m0, s34, 16384
    s_add_u32 s34, s34, 32768
    s_cmp_ge_u32 s34, 163840
    s_cselect_b32 s34, s37, s34
    v_mfma_f32_32x32x16_bf16 v[48:63], a[212:215], a[180:183], v[48:63]
    ds_read_b128 a[196:199], v241 offset:512
    v_cvt_pk_bf16_f32 v104, v138, v139
    v_mfma_f32_32x32x16_bf16 v[48:63], a[216:219], a[184:187], v[48:63]
    ds_read_b128 a[200:203], v241 offset:2048
    v_exp_f32 v132, v20
    v_exp_f32 v133, v21
    v_mfma_f32_32x32x16_bf16 v[48:63], a[220:223], a[188:191], v[48:63]
    ds_read_b128 a[204:207], v241 offset:2560
    v_cvt_pk_bf16_f32 v105, v130, v131
    v_add_f32 v138, v138, v130
    s_waitcnt lgkmcnt(8)
    v_mfma_f32_32x32x16_bf16 a[0:15], a[224:227], v[112:115], a[0:15]
    ds_read_b128 a[208:211], v241 offset:4096
    buffer_load_dwordx4 v242, s[16:19], s42 offen offset:0 sc1 lds
    v_add_f32 v139, v139, v131
    v_mfma_f32_32x32x16_bf16 a[64:79], a[224:227], v[120:123], a[64:79]
    v_exp_f32 v134, v22
    v_exp_f32 v135, v23
    v_mfma_f32_32x32x16_bf16 a[16:31], a[228:231], v[112:115], a[16:31]
    ds_read_b128 a[212:215], v241 offset:4608
    v_cvt_pk_bf16_f32 v106, v132, v133
    v_add_f32 v138, v138, v132
    v_add_f32 v139, v139, v133
    v_mfma_f32_32x32x16_bf16 a[80:95], a[228:231], v[120:123], a[80:95]
    v_exp_f32 v128, v24
    v_exp_f32 v129, v25
    v_mfma_f32_32x32x16_bf16 a[32:47], a[232:235], v[112:115], a[32:47]
    ds_read_b128 a[216:219], v241 offset:6144
    buffer_load_dwordx4 v242, s[16:19], s42 offen offset:1024 sc1 lds
    v_cvt_pk_bf16_f32 v107, v134, v135
    v_mfma_f32_32x32x16_bf16 a[96:111], a[232:235], v[120:123], a[96:111]
    v_add_f32 v138, v138, v134
    v_add_f32 v139, v139, v135
    v_exp_f32 v130, v26
    v_mfma_f32_32x32x16_bf16 a[48:63], a[236:239], v[112:115], a[48:63]
    ds_read_b128 a[220:223], v241 offset:6656
    v_exp_f32 v131, v27
    v_mfma_f32_32x32x16_bf16 a[112:127], a[236:239], v[120:123], a[112:127]
    buffer_load_dwordx4 v242, s[16:19], s42 offen offset:2048 sc1 lds
    v_cvt_pk_bf16_f32 v108, v128, v129
    v_add_f32 v138, v138, v128
    s_waitcnt lgkmcnt(8)
    v_mfma_f32_32x32x16_bf16 a[0:15], a[240:243], v[116:119], a[0:15]
    ds_read_b128 a[224:227], v241 offset:16384
    v_add_f32 v139, v139, v129
    v_exp_f32 v132, v28
    v_mfma_f32_32x32x16_bf16 a[64:79], a[240:243], v[124:127], a[64:79]
    v_exp_f32 v133, v29
    v_cvt_pk_bf16_f32 v109, v130, v131
    v_mfma_f32_32x32x16_bf16 a[16:31], a[244:247], v[116:119], a[16:31]
    ds_read_b128 a[228:231], v241 offset:18432
    v_add_f32 v138, v138, v130
    v_add_f32 v139, v139, v131
    v_exp_f32 v134, v30
    v_mfma_f32_32x32x16_bf16 a[80:95], a[244:247], v[124:127], a[80:95]
    buffer_load_dwordx4 v242, s[16:19], s42 offen offset:3072 sc1 lds
    s_add_u32 s42, s42, 34048
    v_exp_f32 v135, v31
    v_mfma_f32_32x32x16_bf16 a[32:47], a[248:251], v[116:119], a[32:47]
    ds_read_b128 a[232:235], v241 offset:20480
    v_cvt_pk_bf16_f32 v110, v132, v133
    v_add_f32 v138, v138, v132
    v_mfma_f32_32x32x16_bf16 a[96:111], a[248:251], v[124:127], a[96:111]
    v_add_f32 v139, v139, v133
    v_cvt_pk_bf16_f32 v111, v134, v135
    v_add_f32 v138, v138, v134
    v_mfma_f32_32x32x16_bf16 a[48:63], a[252:255], v[116:119], a[48:63]
    ds_read_b128 a[236:239], v241 offset:22528
    v_add_f32 v139, v139, v135
    v_add_f32 v225, v138, v139
    v_cmp_lt_f32 vcc, s38, v225
    v_mfma_f32_32x32x16_bf16 a[112:127], a[252:255], v[124:127], a[112:127]
    s_cbranch_vccnz kf_rare20
kf_rr19:
    s_nop 7
    v_mov_b32 v230, v226
    s_nop 1
    v_permlane32_swap_b32 v226, v230
    s_nop 0
    v_add_f32 v230, v230, v226
    v_rcp_f32 v230, v230
    s_nop 0
    v_accvgpr_read_b32 v160, a0
    v_accvgpr_read_b32 v161, a1
    v_accvgpr_read_b32 v162, a2
    v_accvgpr_read_b32 v163, a3
    v_accvgpr_read_b32 v164, a4
    v_accvgpr_read_b32 v165, a5
    v_accvgpr_read_b32 v166, a6
    v_accvgpr_read_b32 v167, a7
    v_mul_f32 v160, v160, v230
    v_mul_f32 v161, v161, v230
    v_mul_f32 v162, v162, v230
    v_mul_f32 v163, v163, v230
    v_mul_f32 v164, v164, v230
    v_mul_f32 v165, v165, v230
    v_mul_f32 v166, v166, v230
    v_mul_f32 v167, v167, v230
    v_cvt_pk_bf16_f32 v176, v160, v161
    v_cvt_pk_bf16_f32 v177, v162, v163
    v_cvt_pk_bf16_f32 v178, v164, v165
    v_cvt_pk_bf16_f32 v179, v166, v167
    buffer_store_dwordx4 v[176:179], v244, s[20:23], s39 offen offset:0 sc1
    v_accvgpr_read_b32 v168, a8
    v_accvgpr_read_b32 v169, a9
    v_accvgpr_read_b32 v170, a10
    v_accvgpr_read_b32 v171, a11
    v_accvgpr_read_b32 v172, a12
    v_accvgpr_read_b32 v173, a13
    v_accvgpr_read_b32 v174, a14
    v_accvgpr_read_b32 v175, a15
    v_mul_f32 v168, v168, v230
    v_mul_f32 v169, v169, v230
    v_mul_f32 v170, v170, v230
    v_mul_f32 v171, v171, v230
    v_mul_f32 v172, v172, v230
    v_mul_f32 v173, v173, v230
    v_mul_f32 v174, v174, v230
    v_mul_f32 v175, v175, v230
    v_cvt_pk_bf16_f32 v180, v168, v169
    v_cvt_pk_bf16_f32 v181, v170, v171
    v_cvt_pk_bf16_f32 v182, v172, v173
    v_cvt_pk_bf16_f32 v183, v174, v175
    buffer_store_dwordx4 v[180:183], v244, s[20:23], s39 offen offset:512 sc1
    v_accvgpr_read_b32 v160, a16
    v_accvgpr_read_b32 v161, a17
    v_accvgpr_read_b32 v162, a18
    v_accvgpr_read_b32 v163, a19
    v_accvgpr_read_b32 v164, a20
    v_accvgpr_read_b32 v165, a21
    v_accvgpr_read_b32 v166, a22
    v_accvgpr_read_b32 v167, a23
    v_mul_f32 v160, v160, v230
    v_mul_f32 v161, v161, v230
    v_mul_f32 v162, v162, v230
    v_mul_f32 v163, v163, v230
    v_mul_f32 v164, v164, v230
    v_mul_f32 v165, v165, v230
    v_mul_f32 v166, v166, v230
    v_mul_f32 v167, v167, v230
    v_cvt_pk_bf16_f32 v184, v160, v161
    v_cvt_pk_bf16_f32 v185, v162, v163
    v_cvt_pk_bf16_f32 v186, v164, v165
    v_cvt_pk_bf16_f32 v187, v166, v167
    buffer_store_dwordx4 v[184:187], v244, s[20:23], s39 offen offset:1024 sc1
    v_accvgpr_read_b32 v168, a24
    v_accvgpr_read_b32 v169, a25
    v_accvgpr_read_b32 v170, a26
    v_accvgpr_read_b32 v171, a27
    v_accvgpr_read_b32 v172, a28
    v_accvgpr_read_b32 v173, a29
    v_accvgpr_read_b32 v174, a30
    v_accvgpr_read_b32 v175, a31
    v_mul_f32 v168, v168, v230
    v_mul_f32 v169, v169, v230
    v_mul_f32 v170, v170, v230
    v_mul_f32 v171, v171, v230
    v_mul_f32 v172, v172, v230
    v_mul_f32 v173, v173, v230
    v_mul_f32 v174, v174, v230
    v_mul_f32 v175, v175, v230
    v_cvt_pk_bf16_f32 v188, v168, v169
    v_cvt_pk_bf16_f32 v189, v170, v171
    v_cvt_pk_bf16_f32 v190, v172, v173
    v_cvt_pk_bf16_f32 v191, v174, v175
    buffer_store_dwordx4 v[188:191], v244, s[20:23], s39 offen offset:1536 sc1
    v_accvgpr_read_b32 v160, a32
    v_accvgpr_read_b32 v161, a33
    v_accvgpr_read_b32 v162, a34
    v_accvgpr_read_b32 v163, a35
    v_accvgpr_read_b32 v164, a36
    v_accvgpr_read_b32 v165, a37
    v_accvgpr_read_b32 v166, a38
    v_accvgpr_read_b32 v167, a39
    v_mul_f32 v160, v160, v230
    v_mul_f32 v161, v161, v230
    v_mul_f32 v162, v162, v230
    v_mul_f32 v163, v163, v230
    v_mul_f32 v164, v164, v230
    v_mul_f32 v165, v165, v230
    v_mul_f32 v166, v166, v230
    v_mul_f32 v167, v167, v230
    v_cvt_pk_bf16_f32 v176, v160, v161
    v_cvt_pk_bf16_f32 v177, v162, v163
    v_cvt_pk_bf16_f32 v178, v164, v165
    v_cvt_pk_bf16_f32 v179, v166, v167
    buffer_store_dwordx4 v[176:179], v244, s[20:23], s39 offen offset:2048 sc1
    v_accvgpr_read_b32 v168, a40
    v_accvgpr_read_b32 v169, a41
    v_accvgpr_read_b32 v170, a42
    v_accvgpr_read_b32 v171, a43
    v_accvgpr_read_b32 v172, a44
    v_accvgpr_read_b32 v173, a45
    v_accvgpr_read_b32 v174, a46
    v_accvgpr_read_b32 v175, a47
    v_mul_f32 v168, v168, v230
    v_mul_f32 v169, v169, v230
    v_mul_f32 v170, v170, v230
    v_mul_f32 v171, v171, v230
    v_mul_f32 v172, v172, v230
    v_mul_f32 v173, v173, v230
    v_mul_f32 v174, v174, v230
    v_mul_f32 v175, v175, v230
    v_cvt_pk_bf16_f32 v180, v168, v169
    v_cvt_pk_bf16_f32 v181, v170, v171
    v_cvt_pk_bf16_f32 v182, v172, v173
    v_cvt_pk_bf16_f32 v183, v174, v175
    buffer_store_dwordx4 v[180:183], v244, s[20:23], s39 offen offset:2560 sc1
    v_accvgpr_read_b32 v160, a48
    v_accvgpr_read_b32 v161, a49
    v_accvgpr_read_b32 v162, a50
    v_accvgpr_read_b32 v163, a51
    v_accvgpr_read_b32 v164, a52
    v_accvgpr_read_b32 v165, a53
    v_accvgpr_read_b32 v166, a54
    v_accvgpr_read_b32 v167, a55
    v_mul_f32 v160, v160, v230
    v_mul_f32 v161, v161, v230
    v_mul_f32 v162, v162, v230
    v_mul_f32 v163, v163, v230
    v_mul_f32 v164, v164, v230
    v_mul_f32 v165, v165, v230
    v_mul_f32 v166, v166, v230
    v_mul_f32 v167, v167, v230
    v_cvt_pk_bf16_f32 v184, v160, v161
    v_cvt_pk_bf16_f32 v185, v162, v163
    v_cvt_pk_bf16_f32 v186, v164, v165
    v_cvt_pk_bf16_f32 v187, v166, v167
    buffer_store_dwordx4 v[184:187], v244, s[20:23], s39 offen offset:3072 sc1
    v_accvgpr_read_b32 v168, a56
    v_accvgpr_read_b32 v169, a57
    v_accvgpr_read_b32 v170, a58
    v_accvgpr_read_b32 v171, a59
    v_accvgpr_read_b32 v172, a60
    v_accvgpr_read_b32 v173, a61
    v_accvgpr_read_b32 v174, a62
    v_accvgpr_read_b32 v175, a63
    v_mul_f32 v168, v168, v230
    v_mul_f32 v169, v169, v230
    v_mul_f32 v170, v170, v230
    v_mul_f32 v171, v171, v230
    v_mul_f32 v172, v172, v230
    v_mul_f32 v173, v173, v230
    v_mul_f32 v174, v174, v230
    v_mul_f32 v175, v175, v230
    v_cvt_pk_bf16_f32 v188, v168, v169
    v_cvt_pk_bf16_f32 v189, v170, v171
    v_cvt_pk_bf16_f32 v190, v172, v173
    v_cvt_pk_bf16_f32 v191, v174, v175
    buffer_store_dwordx4 v[188:191], v244, s[20:23], s39 offen offset:3584 sc1
    s_lshl1_add_u32 s26, s5, s31
    s_lshl_b32 s26, s26, 1
    s_sub_u32 s26, 30, s26
    s_branch ka_p2_e
.p2align 3
ka_p2:
    s_sub_u32 s36, s36, 1
    s_cbranch_scc1 kf_fix21
kf_fixr22:
    s_waitcnt lgkmcnt(8)
    v_mfma_f32_32x32x16_bf16 v[16:31], a[192:195], a[160:163], v[80:95]
    ds_read_b128 a[240:243], v241 offset:16896
    v_add_f32 v227, v227, v225
    v_exp_f32 v138, v48
    v_exp_f32 v139, v49
    v_mfma_f32_32x32x16_bf16 v[16:31], a[196:199], a[164:167], v[16:31]
    ds_read_b128 a[244:247], v241 offset:18944
    s_mov_b32 m0, s34
    s_add_u32 s41, s42, 17664
    v_exp_f32 v130, v50
    v_mfma_f32_32x32x16_bf16 v[16:31], a[200:203], a[168:171], v[16:31]
    ds_read_b128 a[248:251], v241 offset:20992
    v_exp_f32 v131, v51
    v_cvt_pk_bf16_f32 v120, v138, v139
    v_exp_f32 v132, v52
    v_mfma_f32_32x32x16_bf16 v[16:31], a[204:207], a[172:175], v[16:31]
    ds_read_b128 a[252:255], v241 offset:23040
    buffer_load_dwordx4 v242, s[16:19], s41 offen offset:0 sc1 lds
    v_exp_f32 v133, v53
    s_waitcnt lgkmcnt(8)
    v_mfma_f32_32x32x16_bf16 v[16:31], a[208:211], a[176:179], v[16:31]
    ds_read_b128 a[192:195], v241 offset:8192
    v_cvt_pk_bf16_f32 v121, v130, v131
    v_add_f32 v138, v138, v130
    v_add_f32 v139, v139, v131
    v_exp_f32 v134, v54
    v_mfma_f32_32x32x16_bf16 v[16:31], a[212:215], a[180:183], v[16:31]
    ds_read_b128 a[196:199], v241 offset:8704
    v_exp_f32 v135, v55
    v_cvt_pk_bf16_f32 v122, v132, v133
    v_mfma_f32_32x32x16_bf16 v[16:31], a[216:219], a[184:187], v[16:31]
    ds_read_b128 a[200:203], v241 offset:10240
    buffer_load_dwordx4 v242, s[16:19], s41 offen offset:1024 sc1 lds
    v_add_f32 v138, v138, v132
    v_add_f32 v139, v139, v133
    v_exp_f32 v128, v56
    v_mfma_f32_32x32x16_bf16 v[16:31], a[220:223], a[188:191], v[16:31]
    ds_read_b128 a[204:207], v241 offset:10752
    v_exp_f32 v129, v57
    v_cvt_pk_bf16_f32 v123, v134, v135
    s_waitcnt lgkmcnt(8)
    v_mfma_f32_32x32x16_bf16 a[64:79], a[224:227], v[104:107], a[64:79]
    ds_read_b128 a[208:211], v241 offset:12288
    v_add_f32 v138, v138, v134
    v_add_f32 v139, v139, v135
    v_exp_f32 v130, v58
    v_mfma_f32_32x32x16_bf16 a[80:95], a[228:231], v[104:107], a[80:95]
    ds_read_b128 a[212:215], v241 offset:12800
    buffer_load_dwordx4 v242, s[16:19], s41 offen offset:2048 sc1 lds
    v_exp_f32 v131, v59
    v_cvt_pk_bf16_f32 v124, v128, v129
    v_add_f32 v138, v138, v128
    v_mfma_f32_32x32x16_bf16 a[96:111], a[232:235], v[104:107], a[96:111]
    ds_read_b128 a[216:219], v241 offset:14336
    v_add_f32 v139, v139, v129
    v_exp_f32 v132, v60
    v_exp_f32 v133, v61
    v_mfma_f32_32x32x16_bf16 a[112:127], a[236:239], v[104:107], a[112:127]
    ds_read_b128 a[220:223], v241 offset:14848
    v_cvt_pk_bf16_f32 v125, v130, v131
    v_add_f32 v138, v138, v130
    v_add_f32 v139, v139, v131
    s_waitcnt lgkmcnt(8)
    v_mfma_f32_32x32x16_bf16 a[64:79], a[240:243], v[108:111], a[64:79]
    ds_read_b128 a[224:227], v241 offset:24576
    buffer_load_dwordx4 v242, s[16:19], s41 offen offset:3072 sc1 lds
    v_exp_f32 v134, v62
    v_exp_f32 v135, v63
    v_mfma_f32_32x32x16_bf16 a[80:95], a[244:247], v[108:111], a[80:95]
    ds_read_b128 a[228:231], v241 offset:26624
    v_cvt_pk_bf16_f32 v126, v132, v133
    v_add_f32 v138, v138, v132
    v_add_f32 v139, v139, v133
    v_cvt_pk_bf16_f32 v127, v134, v135
    v_mfma_f32_32x32x16_bf16 a[96:111], a[248:251], v[108:111], a[96:111]
    ds_read_b128 a[232:235], v241 offset:28672
    v_add_f32 v138, v138, v134
    v_add_f32 v139, v139, v135
    v_add_f32 v225, v138, v139
    v_cmp_lt_f32 vcc, s38, v225
    v_mfma_f32_32x32x16_bf16 a[112:127], a[252:255], v[108:111], a[112:127]
    ds_read_b128 a[236:239], v241 offset:30720
    s_cbranch_vccnz kf_rare24
kf_rr23:
    s_sub_u32 s36, s36, 1
    s_cbranch_scc1 kf_fix25
kf_fixr26:
    s_waitcnt lgkmcnt(8)
    v_mfma_f32_32x32x16_bf16 v[48:63], a[192:195], a[160:163], v[80:95]
    ds_read_b128 a[240:243], v241 offset:25088
    v_add_f32 v227, v227, v225
    v_exp_f32 v138, v16
    v_exp_f32 v139, v17
    v_mfma_f32_32x32x16_bf16 v[48:63], a[196:199], a[164:167], v[48:63]
    ds_read_b128 a[244:247], v241 offset:27136
    s_add_u32 m0, s34, 16384
    s_add_u32 s34, s34, 32768
    s_cmp_ge_u32 s34, 163840
    s_cselect_b32 s34, s37, s34
    v_mfma_f32_32x32x16_bf16 v[48:63], a[200:203], a[168:171], v[48:63]
    ds_read_b128 a[248:251], v241 offset:29184
    v_exp_f32 v130, v18
    v_exp_f32 v131, v19
    v_cvt_pk_bf16_f32 v104, v138, v139
    v_mfma_f32_32x32x16_bf16 v[48:63], a[204:207], a[172:175], v[48:63]
    ds_read_b128 a[252:255], v241 offset:31232
    buffer_load_dwordx4 v242, s[16:19], s42 offen offset:0 sc1 lds
    v_exp_f32 v132, v20
    v_exp_f32 v133, v21
    s_waitcnt lgkmcnt(8)
    v_mfma_f32_32x32x16_bf16 v[48:63], a[208:211], a[176:179], v[48:63]
    s_waitcnt vmcnt(13)
    s_barrier
    s_add_u32 s35, s35, 32768
    s_cmp_ge_u32 s35, 163840
    s_cselect_b32 s35, 0, s35
    v_add_u32 v241, s35, v239
    ds_read_b128 a[192:195], v241 offset:0
    v_mfma_f32_32x32x16_bf16 v[48:63], a[212:215], a[180:183], v[48:63]
    ds_read_b128 a[196:199], v241 offset:512
    v_cvt_pk_bf16_f32 v105, v130, v131
    v_add_f32 v138, v138, v130
    v_add_f32 v139, v139, v131
    v_exp_f32 v134, v22
    v_mfma_f32_32x32x16_bf16 v[48:63], a[216:219], a[184:187], v[48:63]
    ds_read_b128 a[200:203], v241 offset:2048
    buffer_load_dwordx4 v242, s[16:19], s42 offen offset:1024 sc1 lds
    v_exp_f32 v135, v23
    v_cvt_pk_bf16_f32 v106, v132, v133
    v_add_f32 v138, v138, v132
    v_mfma_f32_32x32x16_bf16 v[48:63], a[220:223], a[188:191], v[48:63]
    ds_read_b128 a[204:207], v241 offset:2560
    v_add_f32 v139, v139, v133
    v_exp_f32 v128, v24
    s_waitcnt lgkmcnt(8)
    v_mfma_f32_32x32x16_bf16 a[64:79], a[224:227], v[120:123], a[64:79]
    ds_read_b128 a[208:211], v241 offset:4096
    v_exp_f32 v129, v25
    v_cvt_pk_bf16_f32 v107, v134, v135
    v_add_f32 v138, v138, v134
    v_add_f32 v139, v139, v135
    v_mfma_f32_32x32x16_bf16 a[80:95], a[228:231], v[120:123], a[80:95]
    ds_read_b128 a[212:215], v241 offset:4608
    buffer_load_dwordx4 v242, s[16:19], s42 offen offset:2048 sc1 lds
    v_exp_f32 v130, v26
    v_exp_f32 v131, v27
    v_mfma_f32_32x32x16_bf16 a[96:111], a[232:235], v[120:123], a[96:111]
    ds_read_b128 a[216:219], v241 offset:6144
    v_cvt_pk_bf16_f32 v108, v128, v129
    v_add_f32 v138, v138, v128
    v_add_f32 v139, v139, v129
    v_exp_f32 v132, v28
    v_mfma_f32_32x32x16_bf16 a[112:127], a[236:239], v[120:123], a[112:127]
    ds_read_b128 a[220:223], v241 offset:6656
    v_exp_f32 v133, v29
    v_cvt_pk_bf16_f32 v109, v130, v131
    v_add_f32 v138, v138, v130
    s_waitcnt lgkmcnt(8)
    v_mfma_f32_32x32x16_bf16 a[64:79], a[240:243], v[124:127], a[64:79]
    ds_read_b128 a[224:227], v241 offset:16384
    buffer_load_dwordx4 v242, s[16:19], s42 offen offset:3072 sc1 lds
    s_add_u32 s42, s42, 34048
    v_add_f32 v139, v139, v131
    v_exp_f32 v134, v30
    v_mfma_f32_32x32x16_bf16 a[80:95], a[244:247], v[124:127], a[80:95]
    ds_read_b128 a[228:231], v241 offset:18432
    v_exp_f32 v135, v31
    v_cvt_pk_bf16_f32 v110, v132, v133
    v_add_f32 v138, v138, v132
    v_add_f32 v139, v139, v133
    v_mfma_f32_32x32x16_bf16 a[96:111], a[248:251], v[124:127], a[96:111]
    ds_read_b128 a[232:235], v241 offset:20480
    v_cvt_pk_bf16_f32 v111, v134, v135
    v_add_f32 v138, v138, v134
    v_add_f32 v139, v139, v135
    v_add_f32 v225, v138, v139
    v_cmp_lt_f32 vcc, s38, v225
    v_mfma_f32_32x32x16_bf16 a[112:127], a[252:255], v[124:127], a[112:127]
    ds_read_b128 a[236:239], v241 offset:22528
    s_cbranch_vccnz kf_rare28
kf_rr27:
ka_p2_e:
    s_sub_u32 s26, s26, 1
    s_cbranch_scc0 ka_p2
    s_waitcnt lgkmcnt(0)
    ds_read_b128 a[224:227], v241 offset:16384
    ds_read_b128 a[228:231], v241 offset:18432
    ds_read_b128 a[232:235], v241 offset:20480
    ds_read_b128 a[236:239], v241 offset:22528
    ds_read_b128 a[240:243], v241 offset:16896
    ds_read_b128 a[244:247], v241 offset:18944
    ds_read_b128 a[248:251], v241 offset:20992
    ds_read_b128 a[252:255], v241 offset:23040
    ds_read_b128 a[192:195], v241 offset:24576
    ds_read_b128 a[196:199], v241 offset:26624
    ds_read_b128 a[200:203], v241 offset:28672
    ds_read_b128 a[204:207], v241 offset:30720
    ds_read_b128 a[208:211], v241 offset:25088
    ds_read_b128 a[212:215], v241 offset:27136
    ds_read_b128 a[216:219], v241 offset:29184
    s_waitcnt lgkmcnt(7)
    ds_read_b128 a[220:223], v241 offset:31232
    v_mfma_f32_32x32x16_bf16 a[64:79], a[224:227], v[104:107], a[64:79]
    v_add_f32 v227, v227, v225
    v_exp_f32 v138, v48
    v_exp_f32 v139, v49
    v_exp_f32 v130, v50
    v_exp_f32 v131, v51
    v_mfma_f32_32x32x16_bf16 a[80:95], a[228:231], v[104:107], a[80:95]
    v_cvt_pk_bf16_f32 v120, v138, v139
    v_exp_f32 v132, v52
    v_exp_f32 v133, v53
    v_cvt_pk_bf16_f32 v121, v130, v131
    v_add_f32 v138, v138, v130
    v_mfma_f32_32x32x16_bf16 a[96:111], a[232:235], v[104:107], a[96:111]
    v_add_f32 v139, v139, v131
    v_exp_f32 v134, v54
    v_exp_f32 v135, v55
    v_cvt_pk_bf16_f32 v122, v132, v133
    v_add_f32 v138, v138, v132
    v_add_f32 v139, v139, v133
    v_mfma_f32_32x32x16_bf16 a[112:127], a[236:239], v[104:107], a[112:127]
    v_exp_f32 v128, v56
    v_exp_f32 v129, v57
    v_cvt_pk_bf16_f32 v123, v134, v135
    v_add_f32 v138, v138, v134
    v_add_f32 v139, v139, v135
    v_exp_f32 v130, v58
    v_mfma_f32_32x32x16_bf16 a[64:79], a[240:243], v[108:111], a[64:79]
    v_exp_f32 v131, v59
    v_cvt_pk_bf16_f32 v124, v128, v129
    v_add_f32 v138, v138, v128
    v_add_f32 v139, v139, v129
    v_exp_f32 v132, v60
    v_mfma_f32_32x32x16_bf16 a[80:95], a[244:247], v[108:111], a[80:95]
    v_exp_f32 v133, v61
    v_cvt_pk_bf16_f32 v125, v130, v131
    v_add_f32 v138, v138, v130
    v_add_f32 v139, v139, v131
    v_exp_f32 v134, v62
    v_exp_f32 v135, v63
    v_mfma_f32_32x32x16_bf16 a[96:111], a[248:251], v[108:111], a[96:111]
    v_cvt_pk_bf16_f32 v126, v132, v133
    v_add_f32 v138, v138, v132
    v_add_f32 v139, v139, v133
    v_cvt_pk_bf16_f32 v127, v134, v135
    v_add_f32 v138, v138, v134
    v_add_f32 v139, v139, v135
    v_add_f32 v225, v138, v139
    v_cmp_lt_f32 vcc, s38, v225
    v_mfma_f32_32x32x16_bf16 a[112:127], a[252:255], v[108:111], a[112:127]
    s_cbranch_vccnz kf_rare30
kf_rr29:
    s_waitcnt lgkmcnt(0)
    v_add_f32 v227, v227, v225
    s_nop 0
    v_mfma_f32_32x32x16_bf16 a[64:79], a[192:195], v[120:123], a[64:79]
    v_mfma_f32_32x32x16_bf16 a[80:95], a[196:199], v[120:123], a[80:95]
    v_mfma_f32_32x32x16_bf16 a[96:111], a[200:203], v[120:123], a[96:111]
    v_mfma_f32_32x32x16_bf16 a[112:127], a[204:207], v[120:123], a[112:127]
    v_mfma_f32_32x32x16_bf16 a[64:79], a[208:211], v[124:127], a[64:79]
    v_mfma_f32_32x32x16_bf16 a[80:95], a[212:215], v[124:127], a[80:95]
    v_mfma_f32_32x32x16_bf16 a[96:111], a[216:219], v[124:127], a[96:111]
    v_mfma_f32_32x32x16_bf16 a[112:127], a[220:223], v[124:127], a[112:127]
    s_cmp_eq_u32 s31, 0
    s_cbranch_scc1 ka_nox
    s_waitcnt vmcnt(8)
    s_barrier
ka_nox:
    s_nop 7
    s_nop 7
    v_mov_b32 v230, v227
    s_nop 1
    v_permlane32_swap_b32 v227, v230
    s_nop 0
    v_add_f32 v230, v230, v227
    v_rcp_f32 v230, v230
    s_nop 0
    v_accvgpr_read_b32 v160, a64
    v_accvgpr_read_b32 v161, a65
    v_accvgpr_read_b32 v162, a66
    v_accvgpr_read_b32 v163, a67
    v_accvgpr_read_b32 v164, a68
    v_accvgpr_read_b32 v165, a69
    v_accvgpr_read_b32 v166, a70
    v_accvgpr_read_b32 v167, a71
    v_mul_f32 v160, v160, v230
    v_mul_f32 v161, v161, v230
    v_mul_f32 v162, v162, v230
    v_mul_f32 v163, v163, v230
    v_mul_f32 v164, v164, v230
    v_mul_f32 v165, v165, v230
    v_mul_f32 v166, v166, v230
    v_mul_f32 v167, v167, v230
    v_cvt_pk_bf16_f32 v176, v160, v161
    v_cvt_pk_bf16_f32 v177, v162, v163
    v_cvt_pk_bf16_f32 v178, v164, v165
    v_cvt_pk_bf16_f32 v179, v166, v167
    buffer_store_dwordx4 v[176:179], v244, s[20:23], s40 offen offset:0 sc1
    v_accvgpr_read_b32 v168, a72
    v_accvgpr_read_b32 v169, a73
    v_accvgpr_read_b32 v170, a74
    v_accvgpr_read_b32 v171, a75
    v_accvgpr_read_b32 v172, a76
    v_accvgpr_read_b32 v173, a77
    v_accvgpr_read_b32 v174, a78
    v_accvgpr_read_b32 v175, a79
    v_mul_f32 v168, v168, v230
    v_mul_f32 v169, v169, v230
    v_mul_f32 v170, v170, v230
    v_mul_f32 v171, v171, v230
    v_mul_f32 v172, v172, v230
    v_mul_f32 v173, v173, v230
    v_mul_f32 v174, v174, v230
    v_mul_f32 v175, v175, v230
    v_cvt_pk_bf16_f32 v180, v168, v169
    v_cvt_pk_bf16_f32 v181, v170, v171
    v_cvt_pk_bf16_f32 v182, v172, v173
    v_cvt_pk_bf16_f32 v183, v174, v175
    buffer_store_dwordx4 v[180:183], v244, s[20:23], s40 offen offset:512 sc1
    v_accvgpr_read_b32 v160, a80
    v_accvgpr_read_b32 v161, a81
    v_accvgpr_read_b32 v162, a82
    v_accvgpr_read_b32 v163, a83
    v_accvgpr_read_b32 v164, a84
    v_accvgpr_read_b32 v165, a85
    v_accvgpr_read_b32 v166, a86
    v_accvgpr_read_b32 v167, a87
    v_mul_f32 v160, v160, v230
    v_mul_f32 v161, v161, v230
    v_mul_f32 v162, v162, v230
    v_mul_f32 v163, v163, v230
    v_mul_f32 v164, v164, v230
    v_mul_f32 v165, v165, v230
    v_mul_f32 v166, v166, v230
    v_mul_f32 v167, v167, v230
    v_cvt_pk_bf16_f32 v184, v160, v161
    v_cvt_pk_bf16_f32 v185, v162, v163
    v_cvt_pk_bf16_f32 v186, v164, v165
    v_cvt_pk_bf16_f32 v187, v166, v167
    buffer_store_dwordx4 v[184:187], v244, s[20:23], s40 offen offset:1024 sc1
    v_accvgpr_read_b32 v168, a88
    v_accvgpr_read_b32 v169, a89
    v_accvgpr_read_b32 v170, a90
    v_accvgpr_read_b32 v171, a91
    v_accvgpr_read_b32 v172, a92
    v_accvgpr_read_b32 v173, a93
    v_accvgpr_read_b32 v174, a94
    v_accvgpr_read_b32 v175, a95
    v_mul_f32 v168, v168, v230
    v_mul_f32 v169, v169, v230
    v_mul_f32 v170, v170, v230
    v_mul_f32 v171, v171, v230
    v_mul_f32 v172, v172, v230
    v_mul_f32 v173, v173, v230
    v_mul_f32 v174, v174, v230
    v_mul_f32 v175, v175, v230
    v_cvt_pk_bf16_f32 v188, v168, v169
    v_cvt_pk_bf16_f32 v189, v170, v171
    v_cvt_pk_bf16_f32 v190, v172, v173
    v_cvt_pk_bf16_f32 v191, v174, v175
    buffer_store_dwordx4 v[188:191], v244, s[20:23], s40 offen offset:1536 sc1
    v_accvgpr_read_b32 v160, a96
    v_accvgpr_read_b32 v161, a97
    v_accvgpr_read_b32 v162, a98
    v_accvgpr_read_b32 v163, a99
    v_accvgpr_read_b32 v164, a100
    v_accvgpr_read_b32 v165, a101
    v_accvgpr_read_b32 v166, a102
    v_accvgpr_read_b32 v167, a103
    v_mul_f32 v160, v160, v230
    v_mul_f32 v161, v161, v230
    v_mul_f32 v162, v162, v230
    v_mul_f32 v163, v163, v230
    v_mul_f32 v164, v164, v230
    v_mul_f32 v165, v165, v230
    v_mul_f32 v166, v166, v230
    v_mul_f32 v167, v167, v230
    v_cvt_pk_bf16_f32 v176, v160, v161
    v_cvt_pk_bf16_f32 v177, v162, v163
    v_cvt_pk_bf16_f32 v178, v164, v165
    v_cvt_pk_bf16_f32 v179, v166, v167
    buffer_store_dwordx4 v[176:179], v244, s[20:23], s40 offen offset:2048 sc1
    v_accvgpr_read_b32 v168, a104
    v_accvgpr_read_b32 v169, a105
    v_accvgpr_read_b32 v170, a106
    v_accvgpr_read_b32 v171, a107
    v_accvgpr_read_b32 v172, a108
    v_accvgpr_read_b32 v173, a109
    v_accvgpr_read_b32 v174, a110
    v_accvgpr_read_b32 v175, a111
    v_mul_f32 v168, v168, v230
    v_mul_f32 v169, v169, v230
    v_mul_f32 v170, v170, v230
    v_mul_f32 v171, v171, v230
    v_mul_f32 v172, v172, v230
    v_mul_f32 v173, v173, v230
    v_mul_f32 v174, v174, v230
    v_mul_f32 v175, v175, v230
    v_cvt_pk_bf16_f32 v180, v168, v169
    v_cvt_pk_bf16_f32 v181, v170, v171
    v_cvt_pk_bf16_f32 v182, v172, v173
    v_cvt_pk_bf16_f32 v183, v174, v175
    buffer_store_dwordx4 v[180:183], v244, s[20:23], s40 offen offset:2560 sc1
    v_accvgpr_read_b32 v160, a112
    v_accvgpr_read_b32 v161, a113
    v_accvgpr_read_b32 v162, a114
    v_accvgpr_read_b32 v163, a115
    v_accvgpr_read_b32 v164, a116
    v_accvgpr_read_b32 v165, a117
    v_accvgpr_read_b32 v166, a118
    v_accvgpr_read_b32 v167, a119
    v_mul_f32 v160, v160, v230
    v_mul_f32 v161, v161, v230
    v_mul_f32 v162, v162, v230
    v_mul_f32 v163, v163, v230
    v_mul_f32 v164, v164, v230
    v_mul_f32 v165, v165, v230
    v_mul_f32 v166, v166, v230
    v_mul_f32 v167, v167, v230
    v_cvt_pk_bf16_f32 v184, v160, v161
    v_cvt_pk_bf16_f32 v185, v162, v163
    v_cvt_pk_bf16_f32 v186, v164, v165
    v_cvt_pk_bf16_f32 v187, v166, v167
    buffer_store_dwordx4 v[184:187], v244, s[20:23], s40 offen offset:3072 sc1
    v_accvgpr_read_b32 v168, a120
    v_accvgpr_read_b32 v169, a121
    v_accvgpr_read_b32 v170, a122
    v_accvgpr_read_b32 v171, a123
    v_accvgpr_read_b32 v172, a124
    v_accvgpr_read_b32 v173, a125
    v_accvgpr_read_b32 v174, a126
    v_accvgpr_read_b32 v175, a127
    v_mul_f32 v168, v168, v230
    v_mul_f32 v169, v169, v230
    v_mul_f32 v170, v170, v230
    v_mul_f32 v171, v171, v230
    v_mul_f32 v172, v172, v230
    v_mul_f32 v173, v173, v230
    v_mul_f32 v174, v174, v230
    v_mul_f32 v175, v175, v230
    v_cvt_pk_bf16_f32 v188, v168, v169
    v_cvt_pk_bf16_f32 v189, v170, v171
    v_cvt_pk_bf16_f32 v190, v172, v173
    v_cvt_pk_bf16_f32 v191, v174, v175
    buffer_store_dwordx4 v[188:191], v244, s[20:23], s40 offen offset:3584 sc1
    s_load_dwordx2 s[40:41], s[0:1], 0
    s_load_dwordx2 s[42:43], s[0:1], 40
    s_load_dwordx2 s[44:45], s[0:1], 56
    s_load_dwordx2 s[46:47], s[0:1], 104
    s_load_dwordx4 s[60:63], s[0:1], 80
    v_mbcnt_lo_u32_b32 v237, -1, 0
    v_mbcnt_hi_u32_b32 v237, -1, v237
    s_lshl_b32 s32, s3, 6
    v_add_u32 v230, s32, v237
    s_lshr_b32 s53, s2, 3
    s_lshr_b32 s6, s2, 1
    s_and_b32 s6, s6, 3
    s_and_b32 s4, s2, 1
    s_lshl_b32 s4, s4, 2
    s_and_b32 s33, s53, 3
    s_add_u32 s4, s4, s33
    s_lshr_b32 s5, s53, 2
    v_lshlrev_b32 v228, 4, v237
    v_lshrrev_b32 v234, 4, v237
    v_and_b32 v235, 15, v237
    v_lshlrev_b32 v236, 1, v234
    v_xor_b32 v235, v235, v236
    v_lshlrev_b32 v234, 11, v234
    s_lshl_b32 s32, s3, 14
    s_lshl_b32 s33, s5, 8
    s_add_u32 s32, s32, s33
    v_add_u32 v234, s32, v234
    v_lshl_add_u32 v224, v235, 4, v234
    v_xor_b32 v235, 8, v235
    v_lshl_add_u32 v225, v235, 4, v234
    v_add_u32 v225, 7168, v225
    s_lshl_b32 s37, s6, 21
    s_lshl_b32 s38, s3, 11
    s_and_b32 s32, s6, 2
    s_lshl2_add_u32 s32, s3, s32
    s_lshl_b32 s32, s32, 17
    v_add_u32 v226, s32, v228
    v_add_u32 v227, 0x20000, v226
    v_xor_b32 v245, 0x40000, v226
    v_xor_b32 v246, 0x40000, v227
    s_lshl_b32 s35, s4, 21
    s_lshl_b32 s32, s6, 15
    s_add_u32 s35, s35, s32
    s_add_u32 s35, s35, 0x2400000
    s_getpc_b64 s[56:57]
kc_pc0:
    s_mov_b32 s58, kc_end-kc_pc0
    s_mov_b32 s59, 0x00020000
    v_lshlrev_b32 v234, 7, v230
    buffer_load_dword v241, v234, s[56:59], 0 offen
    s_waitcnt lgkmcnt(0)
    s_mov_b32 s8, s46
    s_mov_b32 s9, s47
    s_mov_b32 s10, 0x10000000
    s_mov_b32 s11, 0x00020000
    s_mov_b32 s12, s42
    s_mov_b32 s13, s43
    s_mov_b32 s14, 0x800000
    s_mov_b32 s15, 0x00020000
    s_mov_b32 s16, s40
    s_mov_b32 s17, s41
    s_mov_b32 s18, 0x400000
    s_mov_b32 s19, 0x00020000
    s_mov_b32 s20, s44
    s_mov_b32 s21, s45
    s_mov_b32 s22, 0x800
    s_mov_b32 s23, 0x00020000
    s_mov_b32 s24, s60
    s_mov_b32 s25, s61
    s_mov_b32 s26, 0x700000
    s_mov_b32 s27, 0x00020000
    s_mov_b32 s28, s62
    s_mov_b32 s29, s63
    s_mov_b32 s30, 0x400000
    s_mov_b32 s31, 0x00020000
    s_lshr_b32 s44, s6, 1
    s_and_b32 s6, s6, 1
    v_bfe_u32 v234, v237, 2, 3
    v_lshrrev_b32 v235, 5, v237
    v_lshl_add_u32 v235, v235, 4, v234
    v_lshlrev_b32 v235, 8, v235
    v_and_b32 v236, 1, v237
    v_lshl_add_u32 v235, v236, 3, v235
    v_lshlrev_b32 v234, 1, v234
    v_bfe_u32 v236, v237, 1, 1
    v_or_b32 v234, v234, v236
    s_lshl_b32 s32, s6, 3
    v_xor_b32 v234, s32, v234
    v_xor_b32 v236, 0, v234
    v_lshl_add_u32 v216, v236, 4, v235
    v_xor_b32 v236, 2, v234
    v_lshl_add_u32 v217, v236, 4, v235
    v_xor_b32 v236, 4, v234
    v_lshl_add_u32 v218, v236, 4, v235
    v_xor_b32 v236, 6, v234
    v_lshl_add_u32 v219, v236, 4, v235
    v_xor_b32 v236, 8, v234
    v_lshl_add_u32 v220, v236, 4, v235
    v_xor_b32 v236, 10, v234
    v_lshl_add_u32 v221, v236, 4, v235
    v_xor_b32 v236, 12, v234
    v_lshl_add_u32 v222, v236, 4, v235
    v_xor_b32 v236, 14, v234
    v_lshl_add_u32 v223, v236, 4, v235
    s_lshl2_add_u32 s32, s4, s3
    s_lshl1_add_u32 s32, s32, s44
    s_lshl_b32 s44, s32, 5
    v_lshrrev_b32 v234, 3, v237
    v_add_u32 v242, s44, v234
    v_and_b32 v235, 7, v237
    s_lshl1_add_u32 s33, s5, s6
    s_lshl_b32 s33, s33, 7
    v_lshl_add_u32 v240, v235, 4, s33
    v_lshl_add_u32 v229, v242, 11, v240
    s_mul_i32 s32, s3, 4608
    s_add_u32 s32, s32, 131072
    v_mul_u32_u24 v234, 144, v234
    v_lshl_add_u32 v234, v235, 4, v234
    v_add_u32 v239, s32, v234
    v_and_b32 v234, 15, v237
    v_mul_u32_u24 v234, 144, v234
    v_lshrrev_b32 v236, 4, v237
    v_lshl_add_u32 v234, v236, 3, v234
    v_add_u32 v238, s32, v234
    v_and_b32 v234, 3, v237
    v_lshl_add_u32 v234, v234, 3, v242
    v_lshlrev_b32 v234, 2, v234
    v_lshrrev_b32 v235, 2, v235
    v_lshl_add_u32 v231, v235, 13, v234
    v_lshlrev_b32 v235, 30, v235
    v_add_u32 v235, 16384, v235
    v_add_u32 v232, v235, v234
    s_cmp_eq_u32 s44, 0
    s_cselect_b32 s32, 4, 64
    v_cmp_eq_u32 vcc, s32, v237
    v_mov_b32 v235, 24576
    v_mov_b32 v233, 1
    v_cndmask_b32 v232, v232, v235, vcc
    v_and_b32 v234, 1, v237
    v_cmp_ne_u32 s[60:61], 0, v234
    v_and_b32 v234, 2, v237
    v_cmp_ne_u32 s[62:63], 0, v234
    v_and_b32 v234, 4, v237
    v_cmp_ne_u32 s[40:41], 0, v234
    v_cmp_eq_u32 vcc, 0, v237
    v_mov_b32 v235, 0x40000000
    s_nop 0
    v_cndmask_b32 v243, v235, v237, vcc
    s_lshl2_add_u32 s39, s2, s3
    s_mov_b32 s48, 0x3800000
    s_mov_b32 s49, 0x3802000
    s_mov_b32 s50, 0x3804000
    s_and_b32 s52, s2, 7
    s_mul_i32 s54, s52, 28
    s_add_u32 s54, s54, s53
    v_lshrrev_b32 v234, 3, v237
    v_lshlrev_b32 v234, 11, v234
    v_and_b32 v235, 7, v237
    v_lshl_add_u32 v244, v235, 4, v234
    s_lshl_b32 s55, s54, 16
    s_lshl_b32 s32, s3, 13
    s_add_u32 s55, s55, s32
    s_add_u32 s55, s55, 0x4000000
    s_lshl_b32 s51, s54, 15
    s_lshl_b32 s32, s3, 9
    s_add_u32 s51, s51, s32
    s_cmp_ge_u32 s53, 28
    s_cselect_b32 s55, 0x40000000, s55
    s_cselect_b32 s51, 0x40000000, s51
    s_waitcnt vmcnt(0)
    s_barrier
    s_cmp_lg_u32 s3, 0
    s_cbranch_scc1 kc_a0
    s_lshl_b32 s32, s52, 7
    s_add_u32 s32, s32, 0x38a1000
    v_mov_b32 v235, 1
    buffer_atomic_add v235, v243, s[8:11], s32 offen sc0 sc1
    v_lshlrev_b32 v234, 7, v237
    v_cmp_gt_u32 vcc, 8, v237
    v_mov_b32 v236, 0x40000000
    s_mov_b32 s34, 0x38a1400
    v_cndmask_b32 v234, v236, v234, vcc
    s_waitcnt vmcnt(0)
    v_readfirstlane_b32 s36, v235
    s_cmp_lg_u32 s36, 31
    s_cbranch_scc1 kc_a0
    buffer_atomic_add v233, v234, s[8:11], s34 offen sc1
kc_a0:
    s_add_u32 m0, s38, 0
    s_add_u32 s32, s37, 0
    buffer_load_dwordx4 v224, s[12:15], s32 offen lds
    buffer_load_dwordx4 v225, s[12:15], s32 offen offset:1024 lds
    s_add_u32 m0, s38, 8192
    s_add_u32 s32, s37, 65536
    buffer_load_dwordx4 v224, s[12:15], s32 offen lds
    buffer_load_dwordx4 v225, s[12:15], s32 offen offset:1024 lds
    s_add_u32 m0, s38, 16384
    s_add_u32 s32, s37, 131072
    buffer_load_dwordx4 v224, s[12:15], s32 offen lds
    buffer_load_dwordx4 v225, s[12:15], s32 offen offset:1024 lds
    s_add_u32 m0, s38, 24576
    s_add_u32 s32, s37, 196608
    buffer_load_dwordx4 v224, s[12:15], s32 offen lds
    buffer_load_dwordx4 v225, s[12:15], s32 offen offset:1024 lds
    s_add_u32 m0, s38, 32768
    s_add_u32 s32, s37, 262144
    buffer_load_dwordx4 v224, s[12:15], s32 offen lds
    buffer_load_dwordx4 v225, s[12:15], s32 offen offset:1024 lds
    s_add_u32 m0, s38, 40960
    s_add_u32 s32, s37, 327680
    buffer_load_dwordx4 v224, s[12:15], s32 offen lds
    buffer_load_dwordx4 v225, s[12:15], s32 offen offset:1024 lds
    s_add_u32 m0, s38, 49152
    s_add_u32 s32, s37, 393216
    buffer_load_dwordx4 v224, s[12:15], s32 offen lds
    buffer_load_dwordx4 v225, s[12:15], s32 offen offset:1024 lds
    s_add_u32 m0, s38, 57344
    s_add_u32 s32, s37, 458752
    buffer_load_dwordx4 v224, s[12:15], s32 offen lds
    buffer_load_dwordx4 v225, s[12:15], s32 offen offset:1024 lds
    s_add_u32 m0, s38, 65536
    s_add_u32 s32, s37, 524288
    buffer_load_dwordx4 v224, s[12:15], s32 offen lds
    buffer_load_dwordx4 v225, s[12:15], s32 offen offset:1024 lds
    s_add_u32 m0, s38, 73728
    s_add_u32 s32, s37, 589824
    buffer_load_dwordx4 v224, s[12:15], s32 offen lds
    buffer_load_dwordx4 v225, s[12:15], s32 offen offset:1024 lds
    s_add_u32 m0, s38, 81920
    s_add_u32 s32, s37, 655360
    buffer_load_dwordx4 v224, s[12:15], s32 offen lds
    buffer_load_dwordx4 v225, s[12:15], s32 offen offset:1024 lds
    s_add_u32 m0, s38, 90112
    s_add_u32 s32, s37, 720896
    buffer_load_dwordx4 v224, s[12:15], s32 offen lds
    buffer_load_dwordx4 v225, s[12:15], s32 offen offset:1024 lds
    s_add_u32 m0, s38, 98304
    s_add_u32 s32, s37, 786432
    buffer_load_dwordx4 v224, s[12:15], s32 offen lds
    buffer_load_dwordx4 v225, s[12:15], s32 offen offset:1024 lds
    s_add_u32 m0, s38, 106496
    s_add_u32 s32, s37, 851968
    buffer_load_dwordx4 v224, s[12:15], s32 offen lds
    buffer_load_dwordx4 v225, s[12:15], s32 offen offset:1024 lds
    s_add_u32 m0, s38, 114688
    s_add_u32 s32, s37, 917504
    buffer_load_dwordx4 v224, s[12:15], s32 offen lds
    buffer_load_dwordx4 v225, s[12:15], s32 offen offset:1024 lds
    s_add_u32 m0, s38, 122880
    s_add_u32 s32, s37, 983040
    buffer_load_dwordx4 v224, s[12:15], s32 offen lds
    buffer_load_dwordx4 v225, s[12:15], s32 offen offset:1024 lds
    s_add_u32 s33, s51, 0
    buffer_load_dwordx4 a[192:195], v244, s[24:27], s33 offen offset:0
    s_add_u32 s33, s51, 16384
    buffer_load_dwordx4 a[196:199], v244, s[24:27], s33 offen offset:0
    s_add_u32 s33, s51, 0
    buffer_load_dwordx4 a[200:203], v244, s[24:27], s33 offen offset:128
    s_add_u32 s33, s51, 16384
    buffer_load_dwordx4 a[204:207], v244, s[24:27], s33 offen offset:128
    s_add_u32 s33, s51, 0
    buffer_load_dwordx4 a[208:211], v244, s[24:27], s33 offen offset:256
    s_add_u32 s33, s51, 16384
    buffer_load_dwordx4 a[212:215], v244, s[24:27], s33 offen offset:256
    s_add_u32 s33, s51, 0
    buffer_load_dwordx4 a[216:219], v244, s[24:27], s33 offen offset:384
    s_add_u32 s33, s51, 16384
    buffer_load_dwordx4 a[220:223], v244, s[24:27], s33 offen offset:384
    s_cmp_lg_u32 s3, 0
    s_cbranch_scc1 kc_b02
    s_lshl_b32 s32, s52, 7
    s_add_u32 s32, s32, 0x38a1400
    s_mov_b32 s34, 0x400000
    s_branch kc_b01
kc_b00:
    s_sleep 2
kc_b01:
    buffer_load_dword v235, off, s[8:11], s32 sc1
    s_waitcnt vmcnt(0)
    v_cmp_ne_u32 vcc, 8, v235
    s_sub_u32 s34, s34, 1
    s_cbranch_scc1 kc_b02
    s_cbranch_vccnz kc_b00
kc_b02:
    s_waitcnt vmcnt(9)
    s_barrier
    buffer_load_dwordx4 a[0:3], v226, s[8:11], s35 offen offset:0 sc1
    buffer_load_dwordx4 a[4:7], v227, s[8:11], s35 offen offset:0 sc1
    buffer_load_dwordx4 a[8:11], v245, s[8:11], s35 offen offset:0 sc1
    buffer_load_dwordx4 a[12:15], v246, s[8:11], s35 offen offset:0 sc1
    buffer_load_dwordx4 a[16:19], v226, s[8:11], s35 offen offset:1024 sc1
    buffer_load_dwordx4 a[20:23], v227, s[8:11], s35 offen offset:1024 sc1
    buffer_load_dwordx4 a[24:27], v245, s[8:11], s35 offen offset:1024 sc1
    buffer_load_dwordx4 a[28:31], v246, s[8:11], s35 offen offset:1024 sc1
    buffer_load_dwordx4 a[32:35], v226, s[8:11], s35 offen offset:2048 sc1
    buffer_load_dwordx4 a[36:39], v227, s[8:11], s35 offen offset:2048 sc1
    buffer_load_dwordx4 a[40:43], v245, s[8:11], s35 offen offset:2048 sc1
    buffer_load_dwordx4 a[44:47], v246, s[8:11], s35 offen offset:2048 sc1
    buffer_load_dwordx4 a[48:51], v226, s[8:11], s35 offen offset:3072 sc1
    buffer_load_dwordx4 a[52:55], v227, s[8:11], s35 offen offset:3072 sc1
    buffer_load_dwordx4 a[56:59], v245, s[8:11], s35 offen offset:3072 sc1
    buffer_load_dwordx4 a[60:63], v246, s[8:11], s35 offen offset:3072 sc1
    ds_read_b64_tr_b16 v[128:129], v216 offset:0
    ds_read_b64_tr_b16 v[130:131], v216 offset:2048
    ds_read_b64_tr_b16 v[132:133], v217 offset:0
    ds_read_b64_tr_b16 v[134:135], v217 offset:2048
    ds_read_b64_tr_b16 v[136:137], v218 offset:0
    ds_read_b64_tr_b16 v[138:139], v218 offset:2048
    ds_read_b64_tr_b16 v[140:141], v219 offset:0
    ds_read_b64_tr_b16 v[142:143], v219 offset:2048
    s_waitcnt vmcnt(12) lgkmcnt(0)
    v_mfma_f32_16x16x32_bf16 v[32:35], v[128:131], a[0:3], 0
    ds_read_b64_tr_b16 v[144:145], v220 offset:0
    v_mfma_f32_16x16x32_bf16 v[36:39], v[128:131], a[4:7], 0
    ds_read_b64_tr_b16 v[146:147], v220 offset:2048
    v_mfma_f32_16x16x32_bf16 v[64:67], v[128:131], a[8:11], 0
    ds_read_b64_tr_b16 v[148:149], v221 offset:0
    v_mfma_f32_16x16x32_bf16 v[68:71], v[128:131], a[12:15], 0
    ds_read_b64_tr_b16 v[150:151], v221 offset:2048
    v_mfma_f32_16x16x32_bf16 v[40:43], v[132:135], a[0:3], 0
    ds_read_b64_tr_b16 v[152:153], v222 offset:0
    v_mfma_f32_16x16x32_bf16 v[44:47], v[132:135], a[4:7], 0
    ds_read_b64_tr_b16 v[154:155], v222 offset:2048
    v_mfma_f32_16x16x32_bf16 v[72:75], v[132:135], a[8:11], 0
    ds_read_b64_tr_b16 v[156:157], v223 offset:0
    v_mfma_f32_16x16x32_bf16 v[76:79], v[132:135], a[12:15], 0
    ds_read_b64_tr_b16 v[158:159], v223 offset:2048
    v_mfma_f32_16x16x32_bf16 v[48:51], v[136:139], a[0:3], 0
    s_add_u32 s35, s35, 4096
    buffer_load_dwordx4 a[64:67], v226, s[8:11], s35 offen offset:0 sc1
    v_mfma_f32_16x16x32_bf16 v[52:55], v[136:139], a[4:7], 0
    v_mfma_f32_16x16x32_bf16 v[80:83], v[136:139], a[8:11], 0
    v_mfma_f32_16x16x32_bf16 v[84:87], v[136:139], a[12:15], 0
    buffer_load_dwordx4 a[68:71], v227, s[8:11], s35 offen offset:0 sc1
    v_mfma_f32_16x16x32_bf16 v[56:59], v[140:143], a[0:3], 0
    v_mfma_f32_16x16x32_bf16 v[60:63], v[140:143], a[4:7], 0
    v_mfma_f32_16x16x32_bf16 v[88:91], v[140:143], a[8:11], 0
    v_mfma_f32_16x16x32_bf16 v[92:95], v[140:143], a[12:15], 0
    s_waitcnt lgkmcnt(0)
    v_mfma_f32_16x16x32_bf16 v[0:3], v[144:147], a[0:3], 0
    ds_read_b64_tr_b16 v[128:129], v216 offset:8192
    v_mfma_f32_16x16x32_bf16 v[4:7], v[144:147], a[4:7], 0
    ds_read_b64_tr_b16 v[130:131], v216 offset:10240
    v_mfma_f32_16x16x32_bf16 v[96:99], v[144:147], a[8:11], 0
    ds_read_b64_tr_b16 v[132:133], v217 offset:8192
    v_mfma_f32_16x16x32_bf16 v[100:103], v[144:147], a[12:15], 0
    ds_read_b64_tr_b16 v[134:135], v217 offset:10240
    v_mfma_f32_16x16x32_bf16 v[8:11], v[148:151], a[0:3], 0
    ds_read_b64_tr_b16 v[136:137], v218 offset:8192
    v_mfma_f32_16x16x32_bf16 v[12:15], v[148:151], a[4:7], 0
    ds_read_b64_tr_b16 v[138:139], v218 offset:10240
    v_mfma_f32_16x16x32_bf16 v[104:107], v[148:151], a[8:11], 0
    ds_read_b64_tr_b16 v[140:141], v219 offset:8192
    v_mfma_f32_16x16x32_bf16 v[108:111], v[148:151], a[12:15], 0
    ds_read_b64_tr_b16 v[142:143], v219 offset:10240
    v_mfma_f32_16x16x32_bf16 v[16:19], v[152:155], a[0:3], 0
    buffer_load_dwordx4 a[72:75], v245, s[8:11], s35 offen offset:0 sc1
    v_mfma_f32_16x16x32_bf16 v[20:23], v[152:155], a[4:7], 0
    v_mfma_f32_16x16x32_bf16 v[112:115], v[152:155], a[8:11], 0
    v_mfma_f32_16x16x32_bf16 v[116:119], v[152:155], a[12:15], 0
    v_mfma_f32_16x16x32_bf16 v[24:27], v[156:159], a[0:3], 0
    buffer_load_dwordx4 a[76:79], v246, s[8:11], s35 offen offset:0 sc1
    v_mfma_f32_16x16x32_bf16 v[28:31], v[156:159], a[4:7], 0
    v_mfma_f32_16x16x32_bf16 v[120:123], v[156:159], a[8:11], 0
    v_mfma_f32_16x16x32_bf16 v[124:127], v[156:159], a[12:15], 0
    buffer_load_dwordx4 a[80:83], v226, s[8:11], s35 offen offset:1024 sc1
    s_waitcnt vmcnt(13) lgkmcnt(0)
    v_mfma_f32_16x16x32_bf16 v[32:35], v[128:131], a[16:19], v[32:35]
    ds_read_b64_tr_b16 v[144:145], v220 offset:8192
    v_mfma_f32_16x16x32_bf16 v[36:39], v[128:131], a[20:23], v[36:39]
    ds_read_b64_tr_b16 v[146:147], v220 offset:10240
    v_mfma_f32_16x16x32_bf16 v[64:67], v[128:131], a[24:27], v[64:67]
    ds_read_b64_tr_b16 v[148:149], v221 offset:8192
    v_mfma_f32_16x16x32_bf16 v[68:71], v[128:131], a[28:31], v[68:71]
    ds_read_b64_tr_b16 v[150:151], v221 offset:10240
    v_mfma_f32_16x16x32_bf16 v[40:43], v[132:135], a[16:19], v[40:43]
    ds_read_b64_tr_b16 v[152:153], v222 offset:8192
    v_mfma_f32_16x16x32_bf16 v[44:47], v[132:135], a[20:23], v[44:47]
    ds_read_b64_tr_b16 v[154:155], v222 offset:10240
    v_mfma_f32_16x16x32_bf16 v[72:75], v[132:135], a[24:27], v[72:75]
    ds_read_b64_tr_b16 v[156:157], v223 offset:8192
    v_mfma_f32_16x16x32_bf16 v[76:79], v[132:135], a[28:31], v[76:79]
    ds_read_b64_tr_b16 v[158:159], v223 offset:10240
    v_mfma_f32_16x16x32_bf16 v[48:51], v[136:139], a[16:19], v[48:51]
    buffer_load_dwordx4 a[84:87], v227, s[8:11], s35 offen offset:1024 sc1
    v_mfma_f32_16x16x32_bf16 v[52:55], v[136:139], a[20:23], v[52:55]
    v_mfma_f32_16x16x32_bf16 v[80:83], v[136:139], a[24:27], v[80:83]
    v_mfma_f32_16x16x32_bf16 v[84:87], v[136:139], a[28:31], v[84:87]
    buffer_load_dwordx4 a[88:91], v245, s[8:11], s35 offen offset:1024 sc1
    v_mfma_f32_16x16x32_bf16 v[56:59], v[140:143], a[16:19], v[56:59]
    v_mfma_f32_16x16x32_bf16 v[60:63], v[140:143], a[20:23], v[60:63]
    v_mfma_f32_16x16x32_bf16 v[88:91], v[140:143], a[24:27], v[88:91]
    v_mfma_f32_16x16x32_bf16 v[92:95], v[140:143], a[28:31], v[92:95]
    s_waitcnt lgkmcnt(0)
    v_mfma_f32_16x16x32_bf16 v[0:3], v[144:147], a[16:19], v[0:3]
    ds_read_b64_tr_b16 v[128:129], v216 offset:16384
    v_mfma_f32_16x16x32_bf16 v[4:7], v[144:147], a[20:23], v[4:7]
    ds_read_b64_tr_b16 v[130:131], v216 offset:18432
    v_mfma_f32_16x16x32_bf16 v[96:99], v[144:147], a[24:27], v[96:99]
    ds_read_b64_tr_b16 v[132:133], v217 offset:16384
    v_mfma_f32_16x16x32_bf16 v[100:103], v[144:147], a[28:31], v[100:103]
    ds_read_b64_tr_b16 v[134:135], v217 offset:18432
    v_mfma_f32_16x16x32_bf16 v[8:11], v[148:151], a[16:19], v[8:11]
    ds_read_b64_tr_b16 v[136:137], v218 offset:16384
    v_mfma_f32_16x16x32_bf16 v[12:15], v[148:151], a[20:23], v[12:15]
    ds_read_b64_tr_b16 v[138:139], v218 offset:18432
    v_mfma_f32_16x16x32_bf16 v[104:107], v[148:151], a[24:27], v[104:107]
    ds_read_b64_tr_b16 v[140:141], v219 offset:16384
    v_mfma_f32_16x16x32_bf16 v[108:111], v[148:151], a[28:31], v[108:111]
    ds_read_b64_tr_b16 v[142:143], v219 offset:18432
    v_mfma_f32_16x16x32_bf16 v[16:19], v[152:155], a[16:19], v[16:19]
    buffer_load_dwordx4 a[92:95], v246, s[8:11], s35 offen offset:1024 sc1
    v_mfma_f32_16x16x32_bf16 v[20:23], v[152:155], a[20:23], v[20:23]
    v_mfma_f32_16x16x32_bf16 v[112:115], v[152:155], a[24:27], v[112:115]
    v_mfma_f32_16x16x32_bf16 v[116:119], v[152:155], a[28:31], v[116:119]
    v_mfma_f32_16x16x32_bf16 v[24:27], v[156:159], a[16:19], v[24:27]
    buffer_load_dwordx4 a[96:99], v226, s[8:11], s35 offen offset:2048 sc1
    v_mfma_f32_16x16x32_bf16 v[28:31], v[156:159], a[20:23], v[28:31]
    v_mfma_f32_16x16x32_bf16 v[120:123], v[156:159], a[24:27], v[120:123]
    v_mfma_f32_16x16x32_bf16 v[124:127], v[156:159], a[28:31], v[124:127]
    s_waitcnt vmcnt(13) lgkmcnt(0)
    v_mfma_f32_16x16x32_bf16 v[32:35], v[128:131], a[32:35], v[32:35]
    ds_read_b64_tr_b16 v[144:145], v220 offset:16384
    v_mfma_f32_16x16x32_bf16 v[36:39], v[128:131], a[36:39], v[36:39]
    ds_read_b64_tr_b16 v[146:147], v220 offset:18432
    v_mfma_f32_16x16x32_bf16 v[64:67], v[128:131], a[40:43], v[64:67]
    ds_read_b64_tr_b16 v[148:149], v221 offset:16384
    v_mfma_f32_16x16x32_bf16 v[68:71], v[128:131], a[44:47], v[68:71]
    ds_read_b64_tr_b16 v[150:151], v221 offset:18432
    v_mfma_f32_16x16x32_bf16 v[40:43], v[132:135], a[32:35], v[40:43]
    ds_read_b64_tr_b16 v[152:153], v222 offset:16384
    v_mfma_f32_16x16x32_bf16 v[44:47], v[132:135], a[36:39], v[44:47]
    ds_read_b64_tr_b16 v[154:155], v222 offset:18432
    v_mfma_f32_16x16x32_bf16 v[72:75], v[132:135], a[40:43], v[72:75]
    ds_read_b64_tr_b16 v[156:157], v223 offset:16384
    v_mfma_f32_16x16x32_bf16 v[76:79], v[132:135], a[44:47], v[76:79]
    ds_read_b64_tr_b16 v[158:159], v223 offset:18432
    v_mfma_f32_16x16x32_bf16 v[48:51], v[136:139], a[32:35], v[48:51]
    buffer_load_dwordx4 a[100:103], v227, s[8:11], s35 offen offset:2048 sc1
    v_mfma_f32_16x16x32_bf16 v[52:55], v[136:139], a[36:39], v[52:55]
    v_mfma_f32_16x16x32_bf16 v[80:83], v[136:139], a[40:43], v[80:83]
    v_mfma_f32_16x16x32_bf16 v[84:87], v[136:139], a[44:47], v[84:87]
    buffer_load_dwordx4 a[104:107], v245, s[8:11], s35 offen offset:2048 sc1
    v_mfma_f32_16x16x32_bf16 v[56:59], v[140:143], a[32:35], v[56:59]
    v_mfma_f32_16x16x32_bf16 v[60:63], v[140:143], a[36:39], v[60:63]
    v_mfma_f32_16x16x32_bf16 v[88:91], v[140:143], a[40:43], v[88:91]
    v_mfma_f32_16x16x32_bf16 v[92:95], v[140:143], a[44:47], v[92:95]
    s_waitcnt lgkmcnt(0)
    v_mfma_f32_16x16x32_bf16 v[0:3], v[144:147], a[32:35], v[0:3]
    ds_read_b64_tr_b16 v[128:129], v216 offset:24576
    v_mfma_f32_16x16x32_bf16 v[4:7], v[144:147], a[36:39], v[4:7]
    ds_read_b64_tr_b16 v[130:131], v216 offset:26624
    v_mfma_f32_16x16x32_bf16 v[96:99], v[144:147], a[40:43], v[96:99]
    ds_read_b64_tr_b16 v[132:133], v217 offset:24576
    v_mfma_f32_16x16x32_bf16 v[100:103], v[144:147], a[44:47], v[100:103]
    ds_read_b64_tr_b16 v[134:135], v217 offset:26624
    v_mfma_f32_16x16x32_bf16 v[8:11], v[148:151], a[32:35], v[8:11]
    ds_read_b64_tr_b16 v[136:137], v218 offset:24576
    v_mfma_f32_16x16x32_bf16 v[12:15], v[148:151], a[36:39], v[12:15]
    ds_read_b64_tr_b16 v[138:139], v218 offset:26624
    v_mfma_f32_16x16x32_bf16 v[104:107], v[148:151], a[40:43], v[104:107]
    ds_read_b64_tr_b16 v[140:141], v219 offset:24576
    v_mfma_f32_16x16x32_bf16 v[108:111], v[148:151], a[44:47], v[108:111]
    ds_read_b64_tr_b16 v[142:143], v219 offset:26624
    v_mfma_f32_16x16x32_bf16 v[16:19], v[152:155], a[32:35], v[16:19]
    buffer_load_dwordx4 a[108:111], v246, s[8:11], s35 offen offset:2048 sc1
    v_mfma_f32_16x16x32_bf16 v[20:23], v[152:155], a[36:39], v[20:23]
    v_mfma_f32_16x16x32_bf16 v[112:115], v[152:155], a[40:43], v[112:115]
    v_mfma_f32_16x16x32_bf16 v[116:119], v[152:155], a[44:47], v[116:119]
    v_mfma_f32_16x16x32_bf16 v[24:27], v[156:159], a[32:35], v[24:27]
    buffer_load_dwordx4 a[112:115], v226, s[8:11], s35 offen offset:3072 sc1
    v_mfma_f32_16x16x32_bf16 v[28:31], v[156:159], a[36:39], v[28:31]
    v_mfma_f32_16x16x32_bf16 v[120:123], v[156:159], a[40:43], v[120:123]
    v_mfma_f32_16x16x32_bf16 v[124:127], v[156:159], a[44:47], v[124:127]
    buffer_load_dwordx4 a[116:119], v227, s[8:11], s35 offen offset:3072 sc1
    s_waitcnt vmcnt(14) lgkmcnt(0)
    v_mfma_f32_16x16x32_bf16 v[32:35], v[128:131], a[48:51], v[32:35]
    ds_read_b64_tr_b16 v[144:145], v220 offset:24576
    v_mfma_f32_16x16x32_bf16 v[36:39], v[128:131], a[52:55], v[36:39]
    ds_read_b64_tr_b16 v[146:147], v220 offset:26624
    v_mfma_f32_16x16x32_bf16 v[64:67], v[128:131], a[56:59], v[64:67]
    ds_read_b64_tr_b16 v[148:149], v221 offset:24576
    v_mfma_f32_16x16x32_bf16 v[68:71], v[128:131], a[60:63], v[68:71]
    ds_read_b64_tr_b16 v[150:151], v221 offset:26624
    v_mfma_f32_16x16x32_bf16 v[40:43], v[132:135], a[48:51], v[40:43]
    ds_read_b64_tr_b16 v[152:153], v222 offset:24576
    v_mfma_f32_16x16x32_bf16 v[44:47], v[132:135], a[52:55], v[44:47]
    ds_read_b64_tr_b16 v[154:155], v222 offset:26624
    v_mfma_f32_16x16x32_bf16 v[72:75], v[132:135], a[56:59], v[72:75]
    ds_read_b64_tr_b16 v[156:157], v223 offset:24576
    v_mfma_f32_16x16x32_bf16 v[76:79], v[132:135], a[60:63], v[76:79]
    ds_read_b64_tr_b16 v[158:159], v223 offset:26624
    v_mfma_f32_16x16x32_bf16 v[48:51], v[136:139], a[48:51], v[48:51]
    buffer_load_dwordx4 a[120:123], v245, s[8:11], s35 offen offset:3072 sc1
    v_mfma_f32_16x16x32_bf16 v[52:55], v[136:139], a[52:55], v[52:55]
    v_mfma_f32_16x16x32_bf16 v[80:83], v[136:139], a[56:59], v[80:83]
    v_mfma_f32_16x16x32_bf16 v[84:87], v[136:139], a[60:63], v[84:87]
    buffer_load_dwordx4 a[124:127], v246, s[8:11], s35 offen offset:3072 sc1
    v_mfma_f32_16x16x32_bf16 v[56:59], v[140:143], a[48:51], v[56:59]
    v_mfma_f32_16x16x32_bf16 v[60:63], v[140:143], a[52:55], v[60:63]
    v_mfma_f32_16x16x32_bf16 v[88:91], v[140:143], a[56:59], v[88:91]
    v_mfma_f32_16x16x32_bf16 v[92:95], v[140:143], a[60:63], v[92:95]
    s_waitcnt lgkmcnt(0)
    s_barrier
    v_mfma_f32_16x16x32_bf16 v[0:3], v[144:147], a[48:51], v[0:3]
    ds_read_b64_tr_b16 v[128:129], v216 offset:32768
    v_mfma_f32_16x16x32_bf16 v[4:7], v[144:147], a[52:55], v[4:7]
    ds_read_b64_tr_b16 v[130:131], v216 offset:34816
    v_mfma_f32_16x16x32_bf16 v[96:99], v[144:147], a[56:59], v[96:99]
    ds_read_b64_tr_b16 v[132:133], v217 offset:32768
    v_mfma_f32_16x16x32_bf16 v[100:103], v[144:147], a[60:63], v[100:103]
    ds_read_b64_tr_b16 v[134:135], v217 offset:34816
    v_mfma_f32_16x16x32_bf16 v[8:11], v[148:151], a[48:51], v[8:11]
    ds_read_b64_tr_b16 v[136:137], v218 offset:32768
    v_mfma_f32_16x16x32_bf16 v[12:15], v[148:151], a[52:55], v[12:15]
    ds_read_b64_tr_b16 v[138:139], v218 offset:34816
    v_mfma_f32_16x16x32_bf16 v[104:107], v[148:151], a[56:59], v[104:107]
    ds_read_b64_tr_b16 v[140:141], v219 offset:32768
    v_mfma_f32_16x16x32_bf16 v[108:111], v[148:151], a[60:63], v[108:111]
    ds_read_b64_tr_b16 v[142:143], v219 offset:34816
    v_mfma_f32_16x16x32_bf16 v[16:19], v[152:155], a[48:51], v[16:19]
    s_add_u32 s35, s35, 4096
    buffer_load_dwordx4 a[0:3], v226, s[8:11], s35 offen offset:0 sc1
    v_mfma_f32_16x16x32_bf16 v[20:23], v[152:155], a[52:55], v[20:23]
    v_mfma_f32_16x16x32_bf16 v[112:115], v[152:155], a[56:59], v[112:115]
    v_mfma_f32_16x16x32_bf16 v[116:119], v[152:155], a[60:63], v[116:119]
    v_mfma_f32_16x16x32_bf16 v[24:27], v[156:159], a[48:51], v[24:27]
    buffer_load_dwordx4 a[4:7], v227, s[8:11], s35 offen offset:0 sc1
    v_mfma_f32_16x16x32_bf16 v[28:31], v[156:159], a[52:55], v[28:31]
    v_mfma_f32_16x16x32_bf16 v[120:123], v[156:159], a[56:59], v[120:123]
    v_mfma_f32_16x16x32_bf16 v[124:127], v[156:159], a[60:63], v[124:127]
    s_waitcnt vmcnt(14) lgkmcnt(0)
    v_mfma_f32_16x16x32_bf16 v[32:35], v[128:131], a[64:67], v[32:35]
    ds_read_b64_tr_b16 v[144:145], v220 offset:32768
    v_mfma_f32_16x16x32_bf16 v[36:39], v[128:131], a[68:71], v[36:39]
    ds_read_b64_tr_b16 v[146:147], v220 offset:34816
    v_mfma_f32_16x16x32_bf16 v[64:67], v[128:131], a[72:75], v[64:67]
    ds_read_b64_tr_b16 v[148:149], v221 offset:32768
    v_mfma_f32_16x16x32_bf16 v[68:71], v[128:131], a[76:79], v[68:71]
    ds_read_b64_tr_b16 v[150:151], v221 offset:34816
    v_mfma_f32_16x16x32_bf16 v[40:43], v[132:135], a[64:67], v[40:43]
    ds_read_b64_tr_b16 v[152:153], v222 offset:32768
    v_mfma_f32_16x16x32_bf16 v[44:47], v[132:135], a[68:71], v[44:47]
    ds_read_b64_tr_b16 v[154:155], v222 offset:34816
    v_mfma_f32_16x16x32_bf16 v[72:75], v[132:135], a[72:75], v[72:75]
    ds_read_b64_tr_b16 v[156:157], v223 offset:32768
    v_mfma_f32_16x16x32_bf16 v[76:79], v[132:135], a[76:79], v[76:79]
    ds_read_b64_tr_b16 v[158:159], v223 offset:34816
    v_mfma_f32_16x16x32_bf16 v[48:51], v[136:139], a[64:67], v[48:51]
    buffer_load_dwordx4 a[8:11], v245, s[8:11], s35 offen offset:0 sc1
    v_mfma_f32_16x16x32_bf16 v[52:55], v[136:139], a[68:71], v[52:55]
    s_add_u32 m0, s38, 0
    s_add_u32 s32, s37, 1048576
    v_mfma_f32_16x16x32_bf16 v[80:83], v[136:139], a[72:75], v[80:83]
    buffer_load_dwordx4 v224, s[12:15], s32 offen lds
    v_mfma_f32_16x16x32_bf16 v[84:87], v[136:139], a[76:79], v[84:87]
    buffer_load_dwordx4 a[12:15], v246, s[8:11], s35 offen offset:0 sc1
    v_mfma_f32_16x16x32_bf16 v[56:59], v[140:143], a[64:67], v[56:59]
    v_mfma_f32_16x16x32_bf16 v[60:63], v[140:143], a[68:71], v[60:63]
    buffer_load_dwordx4 v225, s[12:15], s32 offen offset:1024 lds
    v_mfma_f32_16x16x32_bf16 v[88:91], v[140:143], a[72:75], v[88:91]
    v_mfma_f32_16x16x32_bf16 v[92:95], v[140:143], a[76:79], v[92:95]
    s_waitcnt lgkmcnt(0)
    v_mfma_f32_16x16x32_bf16 v[0:3], v[144:147], a[64:67], v[0:3]
    ds_read_b64_tr_b16 v[128:129], v216 offset:40960
    v_mfma_f32_16x16x32_bf16 v[4:7], v[144:147], a[68:71], v[4:7]
    ds_read_b64_tr_b16 v[130:131], v216 offset:43008
    v_mfma_f32_16x16x32_bf16 v[96:99], v[144:147], a[72:75], v[96:99]
    ds_read_b64_tr_b16 v[132:133], v217 offset:40960
    v_mfma_f32_16x16x32_bf16 v[100:103], v[144:147], a[76:79], v[100:103]
    ds_read_b64_tr_b16 v[134:135], v217 offset:43008
    v_mfma_f32_16x16x32_bf16 v[8:11], v[148:151], a[64:67], v[8:11]
    ds_read_b64_tr_b16 v[136:137], v218 offset:40960
    v_mfma_f32_16x16x32_bf16 v[12:15], v[148:151], a[68:71], v[12:15]
    ds_read_b64_tr_b16 v[138:139], v218 offset:43008
    v_mfma_f32_16x16x32_bf16 v[104:107], v[148:151], a[72:75], v[104:107]
    ds_read_b64_tr_b16 v[140:141], v219 offset:40960
    v_mfma_f32_16x16x32_bf16 v[108:111], v[148:151], a[76:79], v[108:111]
    ds_read_b64_tr_b16 v[142:143], v219 offset:43008
    v_mfma_f32_16x16x32_bf16 v[16:19], v[152:155], a[64:67], v[16:19]
    buffer_load_dwordx4 a[16:19], v226, s[8:11], s35 offen offset:1024 sc1
    v_mfma_f32_16x16x32_bf16 v[20:23], v[152:155], a[68:71], v[20:23]
    v_mfma_f32_16x16x32_bf16 v[112:115], v[152:155], a[72:75], v[112:115]
    v_mfma_f32_16x16x32_bf16 v[116:119], v[152:155], a[76:79], v[116:119]
    v_mfma_f32_16x16x32_bf16 v[24:27], v[156:159], a[64:67], v[24:27]
    buffer_load_dwordx4 a[20:23], v227, s[8:11], s35 offen offset:1024 sc1
    v_mfma_f32_16x16x32_bf16 v[28:31], v[156:159], a[68:71], v[28:31]
    v_mfma_f32_16x16x32_bf16 v[120:123], v[156:159], a[72:75], v[120:123]
    v_mfma_f32_16x16x32_bf16 v[124:127], v[156:159], a[76:79], v[124:127]
    buffer_load_dwordx4 a[24:27], v245, s[8:11], s35 offen offset:1024 sc1
    s_waitcnt vmcnt(17) lgkmcnt(0)
    v_mfma_f32_16x16x32_bf16 v[32:35], v[128:131], a[80:83], v[32:35]
    ds_read_b64_tr_b16 v[144:145], v220 offset:40960
    v_mfma_f32_16x16x32_bf16 v[36:39], v[128:131], a[84:87], v[36:39]
    ds_read_b64_tr_b16 v[146:147], v220 offset:43008
    v_mfma_f32_16x16x32_bf16 v[64:67], v[128:131], a[88:91], v[64:67]
    ds_read_b64_tr_b16 v[148:149], v221 offset:40960
    v_mfma_f32_16x16x32_bf16 v[68:71], v[128:131], a[92:95], v[68:71]
    ds_read_b64_tr_b16 v[150:151], v221 offset:43008
    v_mfma_f32_16x16x32_bf16 v[40:43], v[132:135], a[80:83], v[40:43]
    ds_read_b64_tr_b16 v[152:153], v222 offset:40960
    v_mfma_f32_16x16x32_bf16 v[44:47], v[132:135], a[84:87], v[44:47]
    ds_read_b64_tr_b16 v[154:155], v222 offset:43008
    v_mfma_f32_16x16x32_bf16 v[72:75], v[132:135], a[88:91], v[72:75]
    ds_read_b64_tr_b16 v[156:157], v223 offset:40960
    v_mfma_f32_16x16x32_bf16 v[76:79], v[132:135], a[92:95], v[76:79]
    ds_read_b64_tr_b16 v[158:159], v223 offset:43008
    v_mfma_f32_16x16x32_bf16 v[48:51], v[136:139], a[80:83], v[48:51]
    buffer_load_dwordx4 a[28:31], v246, s[8:11], s35 offen offset:1024 sc1
    v_mfma_f32_16x16x32_bf16 v[52:55], v[136:139], a[84:87], v[52:55]
    s_add_u32 m0, s38, 8192
    s_add_u32 s32, s37, 1114112
    v_mfma_f32_16x16x32_bf16 v[80:83], v[136:139], a[88:91], v[80:83]
    buffer_load_dwordx4 v224, s[12:15], s32 offen lds
    v_mfma_f32_16x16x32_bf16 v[84:87], v[136:139], a[92:95], v[84:87]
    buffer_load_dwordx4 a[32:35], v226, s[8:11], s35 offen offset:2048 sc1
    v_mfma_f32_16x16x32_bf16 v[56:59], v[140:143], a[80:83], v[56:59]
    v_mfma_f32_16x16x32_bf16 v[60:63], v[140:143], a[84:87], v[60:63]
    buffer_load_dwordx4 v225, s[12:15], s32 offen offset:1024 lds
    v_mfma_f32_16x16x32_bf16 v[88:91], v[140:143], a[88:91], v[88:91]
    v_mfma_f32_16x16x32_bf16 v[92:95], v[140:143], a[92:95], v[92:95]
    s_waitcnt lgkmcnt(0)
    v_mfma_f32_16x16x32_bf16 v[0:3], v[144:147], a[80:83], v[0:3]
    ds_read_b64_tr_b16 v[128:129], v216 offset:49152
    v_mfma_f32_16x16x32_bf16 v[4:7], v[144:147], a[84:87], v[4:7]
    ds_read_b64_tr_b16 v[130:131], v216 offset:51200
    v_mfma_f32_16x16x32_bf16 v[96:99], v[144:147], a[88:91], v[96:99]
    ds_read_b64_tr_b16 v[132:133], v217 offset:49152
    v_mfma_f32_16x16x32_bf16 v[100:103], v[144:147], a[92:95], v[100:103]
    ds_read_b64_tr_b16 v[134:135], v217 offset:51200
    v_mfma_f32_16x16x32_bf16 v[8:11], v[148:151], a[80:83], v[8:11]
    ds_read_b64_tr_b16 v[136:137], v218 offset:49152
    v_mfma_f32_16x16x32_bf16 v[12:15], v[148:151], a[84:87], v[12:15]
    ds_read_b64_tr_b16 v[138:139], v218 offset:51200
    v_mfma_f32_16x16x32_bf16 v[104:107], v[148:151], a[88:91], v[104:107]
    ds_read_b64_tr_b16 v[140:141], v219 offset:49152
    v_mfma_f32_16x16x32_bf16 v[108:111], v[148:151], a[92:95], v[108:111]
    ds_read_b64_tr_b16 v[142:143], v219 offset:51200
    v_mfma_f32_16x16x32_bf16 v[16:19], v[152:155], a[80:83], v[16:19]
    buffer_load_dwordx4 a[36:39], v227, s[8:11], s35 offen offset:2048 sc1
    v_mfma_f32_16x16x32_bf16 v[20:23], v[152:155], a[84:87], v[20:23]
    v_mfma_f32_16x16x32_bf16 v[112:115], v[152:155], a[88:91], v[112:115]
    v_mfma_f32_16x16x32_bf16 v[116:119], v[152:155], a[92:95], v[116:119]
    v_mfma_f32_16x16x32_bf16 v[24:27], v[156:159], a[80:83], v[24:27]
    buffer_load_dwordx4 a[40:43], v245, s[8:11], s35 offen offset:2048 sc1
    v_mfma_f32_16x16x32_bf16 v[28:31], v[156:159], a[84:87], v[28:31]
    v_mfma_f32_16x16x32_bf16 v[120:123], v[156:159], a[88:91], v[120:123]
    v_mfma_f32_16x16x32_bf16 v[124:127], v[156:159], a[92:95], v[124:127]
    s_waitcnt vmcnt(19) lgkmcnt(0)
    v_mfma_f32_16x16x32_bf16 v[32:35], v[128:131], a[96:99], v[32:35]
    ds_read_b64_tr_b16 v[144:145], v220 offset:49152
    v_mfma_f32_16x16x32_bf16 v[36:39], v[128:131], a[100:103], v[36:39]
    ds_read_b64_tr_b16 v[146:147], v220 offset:51200
    v_mfma_f32_16x16x32_bf16 v[64:67], v[128:131], a[104:107], v[64:67]
    ds_read_b64_tr_b16 v[148:149], v221 offset:49152
    v_mfma_f32_16x16x32_bf16 v[68:71], v[128:131], a[108:111], v[68:71]
    ds_read_b64_tr_b16 v[150:151], v221 offset:51200
    v_mfma_f32_16x16x32_bf16 v[40:43], v[132:135], a[96:99], v[40:43]
    ds_read_b64_tr_b16 v[152:153], v222 offset:49152
    v_mfma_f32_16x16x32_bf16 v[44:47], v[132:135], a[100:103], v[44:47]
    ds_read_b64_tr_b16 v[154:155], v222 offset:51200
    v_mfma_f32_16x16x32_bf16 v[72:75], v[132:135], a[104:107], v[72:75]
    ds_read_b64_tr_b16 v[156:157], v223 offset:49152
    v_mfma_f32_16x16x32_bf16 v[76:79], v[132:135], a[108:111], v[76:79]
    ds_read_b64_tr_b16 v[158:159], v223 offset:51200
    v_mfma_f32_16x16x32_bf16 v[48:51], v[136:139], a[96:99], v[48:51]
    buffer_load_dwordx4 a[44:47], v246, s[8:11], s35 offen offset:2048 sc1
    v_mfma_f32_16x16x32_bf16 v[52:55], v[136:139], a[100:103], v[52:55]
    s_add_u32 m0, s38, 16384
    s_add_u32 s32, s37, 1179648
    v_mfma_f32_16x16x32_bf16 v[80:83], v[136:139], a[104:107], v[80:83]
    buffer_load_dwordx4 v224, s[12:15], s32 offen lds
    v_mfma_f32_16x16x32_bf16 v[84:87], v[136:139], a[108:111], v[84:87]
    buffer_load_dwordx4 a[48:51], v226, s[8:11], s35 offen offset:3072 sc1
    v_mfma_f32_16x16x32_bf16 v[56:59], v[140:143], a[96:99], v[56:59]
    v_mfma_f32_16x16x32_bf16 v[60:63], v[140:143], a[100:103], v[60:63]
    buffer_load_dwordx4 v225, s[12:15], s32 offen offset:1024 lds
    v_mfma_f32_16x16x32_bf16 v[88:91], v[140:143], a[104:107], v[88:91]
    v_mfma_f32_16x16x32_bf16 v[92:95], v[140:143], a[108:111], v[92:95]
    s_waitcnt lgkmcnt(0)
    v_mfma_f32_16x16x32_bf16 v[0:3], v[144:147], a[96:99], v[0:3]
    ds_read_b64_tr_b16 v[128:129], v216 offset:57344
    v_mfma_f32_16x16x32_bf16 v[4:7], v[144:147], a[100:103], v[4:7]
    ds_read_b64_tr_b16 v[130:131], v216 offset:59392
    v_mfma_f32_16x16x32_bf16 v[96:99], v[144:147], a[104:107], v[96:99]
    ds_read_b64_tr_b16 v[132:133], v217 offset:57344
    v_mfma_f32_16x16x32_bf16 v[100:103], v[144:147], a[108:111], v[100:103]
    ds_read_b64_tr_b16 v[134:135], v217 offset:59392
    v_mfma_f32_16x16x32_bf16 v[8:11], v[148:151], a[96:99], v[8:11]
    ds_read_b64_tr_b16 v[136:137], v218 offset:57344
    v_mfma_f32_16x16x32_bf16 v[12:15], v[148:151], a[100:103], v[12:15]
    ds_read_b64_tr_b16 v[138:139], v218 offset:59392
    v_mfma_f32_16x16x32_bf16 v[104:107], v[148:151], a[104:107], v[104:107]
    ds_read_b64_tr_b16 v[140:141], v219 offset:57344
    v_mfma_f32_16x16x32_bf16 v[108:111], v[148:151], a[108:111], v[108:111]
    ds_read_b64_tr_b16 v[142:143], v219 offset:59392
    v_mfma_f32_16x16x32_bf16 v[16:19], v[152:155], a[96:99], v[16:19]
    buffer_load_dwordx4 a[52:55], v227, s[8:11], s35 offen offset:3072 sc1
    v_mfma_f32_16x16x32_bf16 v[20:23], v[152:155], a[100:103], v[20:23]
    v_mfma_f32_16x16x32_bf16 v[112:115], v[152:155], a[104:107], v[112:115]
    v_mfma_f32_16x16x32_bf16 v[116:119], v[152:155], a[108:111], v[116:119]
    v_mfma_f32_16x16x32_bf16 v[24:27], v[156:159], a[96:99], v[24:27]
    buffer_load_dwordx4 a[56:59], v245, s[8:11], s35 offen offset:3072 sc1
    v_mfma_f32_16x16x32_bf16 v[28:31], v[156:159], a[100:103], v[28:31]
    v_mfma_f32_16x16x32_bf16 v[120:123], v[156:159], a[104:107], v[120:123]
    v_mfma_f32_16x16x32_bf16 v[124:127], v[156:159], a[108:111], v[124:127]
    buffer_load_dwordx4 a[60:63], v246, s[8:11], s35 offen offset:3072 sc1
    s_waitcnt vmcnt(22) lgkmcnt(0)
    v_mfma_f32_16x16x32_bf16 v[32:35], v[128:131], a[112:115], v[32:35]
    ds_read_b64_tr_b16 v[144:145], v220 offset:57344
    v_mfma_f32_16x16x32_bf16 v[36:39], v[128:131], a[116:119], v[36:39]
    ds_read_b64_tr_b16 v[146:147], v220 offset:59392
    v_mfma_f32_16x16x32_bf16 v[64:67], v[128:131], a[120:123], v[64:67]
    ds_read_b64_tr_b16 v[148:149], v221 offset:57344
    v_mfma_f32_16x16x32_bf16 v[68:71], v[128:131], a[124:127], v[68:71]
    ds_read_b64_tr_b16 v[150:151], v221 offset:59392
    v_mfma_f32_16x16x32_bf16 v[40:43], v[132:135], a[112:115], v[40:43]
    ds_read_b64_tr_b16 v[152:153], v222 offset:57344
    v_mfma_f32_16x16x32_bf16 v[44:47], v[132:135], a[116:119], v[44:47]
    ds_read_b64_tr_b16 v[154:155], v222 offset:59392
    v_mfma_f32_16x16x32_bf16 v[72:75], v[132:135], a[120:123], v[72:75]
    ds_read_b64_tr_b16 v[156:157], v223 offset:57344
    v_mfma_f32_16x16x32_bf16 v[76:79], v[132:135], a[124:127], v[76:79]
    ds_read_b64_tr_b16 v[158:159], v223 offset:59392
    v_mfma_f32_16x16x32_bf16 v[48:51], v[136:139], a[112:115], v[48:51]
    s_add_u32 s35, s35, 4096
    buffer_load_dwordx4 a[64:67], v226, s[8:11], s35 offen offset:0 sc1
    v_mfma_f32_16x16x32_bf16 v[52:55], v[136:139], a[116:119], v[52:55]
    s_add_u32 m0, s38, 24576
    s_add_u32 s32, s37, 1245184
    v_mfma_f32_16x16x32_bf16 v[80:83], v[136:139], a[120:123], v[80:83]
    buffer_load_dwordx4 v224, s[12:15], s32 offen lds
    v_mfma_f32_16x16x32_bf16 v[84:87], v[136:139], a[124:127], v[84:87]
    buffer_load_dwordx4 a[68:71], v227, s[8:11], s35 offen offset:0 sc1
    v_mfma_f32_16x16x32_bf16 v[56:59], v[140:143], a[112:115], v[56:59]
    v_mfma_f32_16x16x32_bf16 v[60:63], v[140:143], a[116:119], v[60:63]
    buffer_load_dwordx4 v225, s[12:15], s32 offen offset:1024 lds
    v_mfma_f32_16x16x32_bf16 v[88:91], v[140:143], a[120:123], v[88:91]
    v_mfma_f32_16x16x32_bf16 v[92:95], v[140:143], a[124:127], v[92:95]
    s_waitcnt lgkmcnt(0)
    s_barrier
    v_mfma_f32_16x16x32_bf16 v[0:3], v[144:147], a[112:115], v[0:3]
    v_xor_b32 v216, 0x10000, v216
    ds_read_b64_tr_b16 v[128:129], v216 offset:0
    v_mfma_f32_16x16x32_bf16 v[4:7], v[144:147], a[116:119], v[4:7]
    ds_read_b64_tr_b16 v[130:131], v216 offset:2048
    v_mfma_f32_16x16x32_bf16 v[96:99], v[144:147], a[120:123], v[96:99]
    v_xor_b32 v217, 0x10000, v217
    ds_read_b64_tr_b16 v[132:133], v217 offset:0
    v_mfma_f32_16x16x32_bf16 v[100:103], v[144:147], a[124:127], v[100:103]
    ds_read_b64_tr_b16 v[134:135], v217 offset:2048
    v_mfma_f32_16x16x32_bf16 v[8:11], v[148:151], a[112:115], v[8:11]
    v_xor_b32 v218, 0x10000, v218
    ds_read_b64_tr_b16 v[136:137], v218 offset:0
    v_mfma_f32_16x16x32_bf16 v[12:15], v[148:151], a[116:119], v[12:15]
    ds_read_b64_tr_b16 v[138:139], v218 offset:2048
    v_mfma_f32_16x16x32_bf16 v[104:107], v[148:151], a[120:123], v[104:107]
    v_xor_b32 v219, 0x10000, v219
    ds_read_b64_tr_b16 v[140:141], v219 offset:0
    v_mfma_f32_16x16x32_bf16 v[108:111], v[148:151], a[124:127], v[108:111]
    ds_read_b64_tr_b16 v[142:143], v219 offset:2048
    v_mfma_f32_16x16x32_bf16 v[16:19], v[152:155], a[112:115], v[16:19]
    buffer_load_dwordx4 a[72:75], v245, s[8:11], s35 offen offset:0 sc1
    v_mfma_f32_16x16x32_bf16 v[20:23], v[152:155], a[116:119], v[20:23]
    v_mfma_f32_16x16x32_bf16 v[112:115], v[152:155], a[120:123], v[112:115]
    v_mfma_f32_16x16x32_bf16 v[116:119], v[152:155], a[124:127], v[116:119]
    v_mfma_f32_16x16x32_bf16 v[24:27], v[156:159], a[112:115], v[24:27]
    buffer_load_dwordx4 a[76:79], v246, s[8:11], s35 offen offset:0 sc1
    v_mfma_f32_16x16x32_bf16 v[28:31], v[156:159], a[116:119], v[28:31]
    v_mfma_f32_16x16x32_bf16 v[120:123], v[156:159], a[120:123], v[120:123]
    v_mfma_f32_16x16x32_bf16 v[124:127], v[156:159], a[124:127], v[124:127]
    s_waitcnt vmcnt(23) lgkmcnt(0)
    v_mfma_f32_16x16x32_bf16 v[32:35], v[128:131], a[0:3], v[32:35]
    v_xor_b32 v220, 0x10000, v220
    ds_read_b64_tr_b16 v[144:145], v220 offset:0
    v_mfma_f32_16x16x32_bf16 v[36:39], v[128:131], a[4:7], v[36:39]
    ds_read_b64_tr_b16 v[146:147], v220 offset:2048
    v_mfma_f32_16x16x32_bf16 v[64:67], v[128:131], a[8:11], v[64:67]
    v_xor_b32 v221, 0x10000, v221
    ds_read_b64_tr_b16 v[148:149], v221 offset:0
    v_mfma_f32_16x16x32_bf16 v[68:71], v[128:131], a[12:15], v[68:71]
    ds_read_b64_tr_b16 v[150:151], v221 offset:2048
    v_mfma_f32_16x16x32_bf16 v[40:43], v[132:135], a[0:3], v[40:43]
    v_xor_b32 v222, 0x10000, v222
    ds_read_b64_tr_b16 v[152:153], v222 offset:0
    v_mfma_f32_16x16x32_bf16 v[44:47], v[132:135], a[4:7], v[44:47]
    ds_read_b64_tr_b16 v[154:155], v222 offset:2048
    v_mfma_f32_16x16x32_bf16 v[72:75], v[132:135], a[8:11], v[72:75]
    v_xor_b32 v223, 0x10000, v223
    ds_read_b64_tr_b16 v[156:157], v223 offset:0
    v_mfma_f32_16x16x32_bf16 v[76:79], v[132:135], a[12:15], v[76:79]
    ds_read_b64_tr_b16 v[158:159], v223 offset:2048
    v_mfma_f32_16x16x32_bf16 v[48:51], v[136:139], a[0:3], v[48:51]
    buffer_load_dwordx4 a[80:83], v226, s[8:11], s35 offen offset:1024 sc1
    v_mfma_f32_16x16x32_bf16 v[52:55], v[136:139], a[4:7], v[52:55]
    s_add_u32 m0, s38, 32768
    s_add_u32 s32, s37, 1310720
    v_mfma_f32_16x16x32_bf16 v[80:83], v[136:139], a[8:11], v[80:83]
    buffer_load_dwordx4 v224, s[12:15], s32 offen lds
    v_mfma_f32_16x16x32_bf16 v[84:87], v[136:139], a[12:15], v[84:87]
    buffer_load_dwordx4 a[84:87], v227, s[8:11], s35 offen offset:1024 sc1
    v_mfma_f32_16x16x32_bf16 v[56:59], v[140:143], a[0:3], v[56:59]
    v_mfma_f32_16x16x32_bf16 v[60:63], v[140:143], a[4:7], v[60:63]
    buffer_load_dwordx4 v225, s[12:15], s32 offen offset:1024 lds
    v_mfma_f32_16x16x32_bf16 v[88:91], v[140:143], a[8:11], v[88:91]
    v_mfma_f32_16x16x32_bf16 v[92:95], v[140:143], a[12:15], v[92:95]
    s_waitcnt lgkmcnt(0)
    v_mfma_f32_16x16x32_bf16 v[0:3], v[144:147], a[0:3], v[0:3]
    ds_read_b64_tr_b16 v[128:129], v216 offset:8192
    v_mfma_f32_16x16x32_bf16 v[4:7], v[144:147], a[4:7], v[4:7]
    ds_read_b64_tr_b16 v[130:131], v216 offset:10240
    v_mfma_f32_16x16x32_bf16 v[96:99], v[144:147], a[8:11], v[96:99]
    ds_read_b64_tr_b16 v[132:133], v217 offset:8192
    v_mfma_f32_16x16x32_bf16 v[100:103], v[144:147], a[12:15], v[100:103]
    ds_read_b64_tr_b16 v[134:135], v217 offset:10240
    v_mfma_f32_16x16x32_bf16 v[8:11], v[148:151], a[0:3], v[8:11]
    ds_read_b64_tr_b16 v[136:137], v218 offset:8192
    v_mfma_f32_16x16x32_bf16 v[12:15], v[148:151], a[4:7], v[12:15]
    ds_read_b64_tr_b16 v[138:139], v218 offset:10240
    v_mfma_f32_16x16x32_bf16 v[104:107], v[148:151], a[8:11], v[104:107]
    ds_read_b64_tr_b16 v[140:141], v219 offset:8192
    v_mfma_f32_16x16x32_bf16 v[108:111], v[148:151], a[12:15], v[108:111]
    ds_read_b64_tr_b16 v[142:143], v219 offset:10240
    v_mfma_f32_16x16x32_bf16 v[16:19], v[152:155], a[0:3], v[16:19]
    buffer_load_dwordx4 a[88:91], v245, s[8:11], s35 offen offset:1024 sc1
    v_mfma_f32_16x16x32_bf16 v[20:23], v[152:155], a[4:7], v[20:23]
    v_mfma_f32_16x16x32_bf16 v[112:115], v[152:155], a[8:11], v[112:115]
    v_mfma_f32_16x16x32_bf16 v[116:119], v[152:155], a[12:15], v[116:119]
    v_mfma_f32_16x16x32_bf16 v[24:27], v[156:159], a[0:3], v[24:27]
    buffer_load_dwordx4 a[92:95], v246, s[8:11], s35 offen offset:1024 sc1
    v_mfma_f32_16x16x32_bf16 v[28:31], v[156:159], a[4:7], v[28:31]
    v_mfma_f32_16x16x32_bf16 v[120:123], v[156:159], a[8:11], v[120:123]
    v_mfma_f32_16x16x32_bf16 v[124:127], v[156:159], a[12:15], v[124:127]
    buffer_load_dwordx4 a[96:99], v226, s[8:11], s35 offen offset:2048 sc1
    s_waitcnt vmcnt(25) lgkmcnt(0)
    v_mfma_f32_16x16x32_bf16 v[32:35], v[128:131], a[16:19], v[32:35]
    ds_read_b64_tr_b16 v[144:145], v220 offset:8192
    v_mfma_f32_16x16x32_bf16 v[36:39], v[128:131], a[20:23], v[36:39]
    ds_read_b64_tr_b16 v[146:147], v220 offset:10240
    v_mfma_f32_16x16x32_bf16 v[64:67], v[128:131], a[24:27], v[64:67]
    ds_read_b64_tr_b16 v[148:149], v221 offset:8192
    v_mfma_f32_16x16x32_bf16 v[68:71], v[128:131], a[28:31], v[68:71]
    ds_read_b64_tr_b16 v[150:151], v221 offset:10240
    v_mfma_f32_16x16x32_bf16 v[40:43], v[132:135], a[16:19], v[40:43]
    ds_read_b64_tr_b16 v[152:153], v222 offset:8192
    v_mfma_f32_16x16x32_bf16 v[44:47], v[132:135], a[20:23], v[44:47]
    ds_read_b64_tr_b16 v[154:155], v222 offset:10240
    v_mfma_f32_16x16x32_bf16 v[72:75], v[132:135], a[24:27], v[72:75]
    ds_read_b64_tr_b16 v[156:157], v223 offset:8192
    v_mfma_f32_16x16x32_bf16 v[76:79], v[132:135], a[28:31], v[76:79]
    ds_read_b64_tr_b16 v[158:159], v223 offset:10240
    v_mfma_f32_16x16x32_bf16 v[48:51], v[136:139], a[16:19], v[48:51]
    buffer_load_dwordx4 a[100:103], v227, s[8:11], s35 offen offset:2048 sc1
    v_mfma_f32_16x16x32_bf16 v[52:55], v[136:139], a[20:23], v[52:55]
    s_add_u32 m0, s38, 40960
    s_add_u32 s32, s37, 1376256
    v_mfma_f32_16x16x32_bf16 v[80:83], v[136:139], a[24:27], v[80:83]
    buffer_load_dwordx4 v224, s[12:15], s32 offen lds
    v_mfma_f32_16x16x32_bf16 v[84:87], v[136:139], a[28:31], v[84:87]
    buffer_load_dwordx4 a[104:107], v245, s[8:11], s35 offen offset:2048 sc1
    v_mfma_f32_16x16x32_bf16 v[56:59], v[140:143], a[16:19], v[56:59]
    v_mfma_f32_16x16x32_bf16 v[60:63], v[140:143], a[20:23], v[60:63]
    buffer_load_dwordx4 v225, s[12:15], s32 offen offset:1024 lds
    v_mfma_f32_16x16x32_bf16 v[88:91], v[140:143], a[24:27], v[88:91]
    v_mfma_f32_16x16x32_bf16 v[92:95], v[140:143], a[28:31], v[92:95]
    s_waitcnt lgkmcnt(0)
    v_mfma_f32_16x16x32_bf16 v[0:3], v[144:147], a[16:19], v[0:3]
    ds_read_b64_tr_b16 v[128:129], v216 offset:16384
    v_mfma_f32_16x16x32_bf16 v[4:7], v[144:147], a[20:23], v[4:7]
    ds_read_b64_tr_b16 v[130:131], v216 offset:18432
    v_mfma_f32_16x16x32_bf16 v[96:99], v[144:147], a[24:27], v[96:99]
    ds_read_b64_tr_b16 v[132:133], v217 offset:16384
    v_mfma_f32_16x16x32_bf16 v[100:103], v[144:147], a[28:31], v[100:103]
    ds_read_b64_tr_b16 v[134:135], v217 offset:18432
    v_mfma_f32_16x16x32_bf16 v[8:11], v[148:151], a[16:19], v[8:11]
    ds_read_b64_tr_b16 v[136:137], v218 offset:16384
    v_mfma_f32_16x16x32_bf16 v[12:15], v[148:151], a[20:23], v[12:15]
    ds_read_b64_tr_b16 v[138:139], v218 offset:18432
    v_mfma_f32_16x16x32_bf16 v[104:107], v[148:151], a[24:27], v[104:107]
    ds_read_b64_tr_b16 v[140:141], v219 offset:16384
    v_mfma_f32_16x16x32_bf16 v[108:111], v[148:151], a[28:31], v[108:111]
    ds_read_b64_tr_b16 v[142:143], v219 offset:18432
    v_mfma_f32_16x16x32_bf16 v[16:19], v[152:155], a[16:19], v[16:19]
    buffer_load_dwordx4 a[108:111], v246, s[8:11], s35 offen offset:2048 sc1
    v_mfma_f32_16x16x32_bf16 v[20:23], v[152:155], a[20:23], v[20:23]
    v_mfma_f32_16x16x32_bf16 v[112:115], v[152:155], a[24:27], v[112:115]
    v_mfma_f32_16x16x32_bf16 v[116:119], v[152:155], a[28:31], v[116:119]
    v_mfma_f32_16x16x32_bf16 v[24:27], v[156:159], a[16:19], v[24:27]
    buffer_load_dwordx4 a[112:115], v226, s[8:11], s35 offen offset:3072 sc1
    v_mfma_f32_16x16x32_bf16 v[28:31], v[156:159], a[20:23], v[28:31]
    v_mfma_f32_16x16x32_bf16 v[120:123], v[156:159], a[24:27], v[120:123]
    v_mfma_f32_16x16x32_bf16 v[124:127], v[156:159], a[28:31], v[124:127]
    s_waitcnt vmcnt(25) lgkmcnt(0)
    v_mfma_f32_16x16x32_bf16 v[32:35], v[128:131], a[32:35], v[32:35]
    ds_read_b64_tr_b16 v[144:145], v220 offset:16384
    v_mfma_f32_16x16x32_bf16 v[36:39], v[128:131], a[36:39], v[36:39]
    ds_read_b64_tr_b16 v[146:147], v220 offset:18432
    v_mfma_f32_16x16x32_bf16 v[64:67], v[128:131], a[40:43], v[64:67]
    ds_read_b64_tr_b16 v[148:149], v221 offset:16384
    v_mfma_f32_16x16x32_bf16 v[68:71], v[128:131], a[44:47], v[68:71]
    ds_read_b64_tr_b16 v[150:151], v221 offset:18432
    v_mfma_f32_16x16x32_bf16 v[40:43], v[132:135], a[32:35], v[40:43]
    ds_read_b64_tr_b16 v[152:153], v222 offset:16384
    v_mfma_f32_16x16x32_bf16 v[44:47], v[132:135], a[36:39], v[44:47]
    ds_read_b64_tr_b16 v[154:155], v222 offset:18432
    v_mfma_f32_16x16x32_bf16 v[72:75], v[132:135], a[40:43], v[72:75]
    ds_read_b64_tr_b16 v[156:157], v223 offset:16384
    v_mfma_f32_16x16x32_bf16 v[76:79], v[132:135], a[44:47], v[76:79]
    ds_read_b64_tr_b16 v[158:159], v223 offset:18432
    v_mfma_f32_16x16x32_bf16 v[48:51], v[136:139], a[32:35], v[48:51]
    buffer_load_dwordx4 a[116:119], v227, s[8:11], s35 offen offset:3072 sc1
    v_mfma_f32_16x16x32_bf16 v[52:55], v[136:139], a[36:39], v[52:55]
    s_add_u32 m0, s38, 49152
    s_add_u32 s32, s37, 1441792
    v_mfma_f32_16x16x32_bf16 v[80:83], v[136:139], a[40:43], v[80:83]
    buffer_load_dwordx4 v224, s[12:15], s32 offen lds
    v_mfma_f32_16x16x32_bf16 v[84:87], v[136:139], a[44:47], v[84:87]
    buffer_load_dwordx4 a[120:123], v245, s[8:11], s35 offen offset:3072 sc1
    v_mfma_f32_16x16x32_bf16 v[56:59], v[140:143], a[32:35], v[56:59]
    v_mfma_f32_16x16x32_bf16 v[60:63], v[140:143], a[36:39], v[60:63]
    buffer_load_dwordx4 v225, s[12:15], s32 offen offset:1024 lds
    v_mfma_f32_16x16x32_bf16 v[88:91], v[140:143], a[40:43], v[88:91]
    s_add_u32 s33, s55, 0
    buffer_load_dwordx4 a[128:131], v228, s[8:11], s33 offen offset:0 sc1
    v_mfma_f32_16x16x32_bf16 v[92:95], v[140:143], a[44:47], v[92:95]
    s_waitcnt lgkmcnt(0)
    v_mfma_f32_16x16x32_bf16 v[0:3], v[144:147], a[32:35], v[0:3]
    ds_read_b64_tr_b16 v[128:129], v216 offset:24576
    v_mfma_f32_16x16x32_bf16 v[4:7], v[144:147], a[36:39], v[4:7]
    ds_read_b64_tr_b16 v[130:131], v216 offset:26624
    v_mfma_f32_16x16x32_bf16 v[96:99], v[144:147], a[40:43], v[96:99]
    ds_read_b64_tr_b16 v[132:133], v217 offset:24576
    v_mfma_f32_16x16x32_bf16 v[100:103], v[144:147], a[44:47], v[100:103]
    ds_read_b64_tr_b16 v[134:135], v217 offset:26624
    v_mfma_f32_16x16x32_bf16 v[8:11], v[148:151], a[32:35], v[8:11]
    ds_read_b64_tr_b16 v[136:137], v218 offset:24576
    v_mfma_f32_16x16x32_bf16 v[12:15], v[148:151], a[36:39], v[12:15]
    ds_read_b64_tr_b16 v[138:139], v218 offset:26624
    v_mfma_f32_16x16x32_bf16 v[104:107], v[148:151], a[40:43], v[104:107]
    ds_read_b64_tr_b16 v[140:141], v219 offset:24576
    v_mfma_f32_16x16x32_bf16 v[108:111], v[148:151], a[44:47], v[108:111]
    ds_read_b64_tr_b16 v[142:143], v219 offset:26624
    v_mfma_f32_16x16x32_bf16 v[16:19], v[152:155], a[32:35], v[16:19]
    buffer_load_dwordx4 a[124:127], v246, s[8:11], s35 offen offset:3072 sc1
    v_mfma_f32_16x16x32_bf16 v[20:23], v[152:155], a[36:39], v[20:23]
    v_mfma_f32_16x16x32_bf16 v[112:115], v[152:155], a[40:43], v[112:115]
    v_mfma_f32_16x16x32_bf16 v[116:119], v[152:155], a[44:47], v[116:119]
    v_mfma_f32_16x16x32_bf16 v[24:27], v[156:159], a[32:35], v[24:27]
    s_add_u32 s35, s35, 4096
    buffer_load_dwordx4 a[0:3], v226, s[8:11], s35 offen offset:0 sc1
    v_mfma_f32_16x16x32_bf16 v[28:31], v[156:159], a[36:39], v[28:31]
    v_mfma_f32_16x16x32_bf16 v[120:123], v[156:159], a[40:43], v[120:123]
    buffer_load_dwordx4 a[132:135], v228, s[8:11], s33 offen offset:1024 sc1
    v_mfma_f32_16x16x32_bf16 v[124:127], v[156:159], a[44:47], v[124:127]
    buffer_load_dwordx4 a[4:7], v227, s[8:11], s35 offen offset:0 sc1
    s_waitcnt vmcnt(28) lgkmcnt(0)
    v_mfma_f32_16x16x32_bf16 v[32:35], v[128:131], a[48:51], v[32:35]
    ds_read_b64_tr_b16 v[144:145], v220 offset:24576
    v_mfma_f32_16x16x32_bf16 v[36:39], v[128:131], a[52:55], v[36:39]
    ds_read_b64_tr_b16 v[146:147], v220 offset:26624
    v_mfma_f32_16x16x32_bf16 v[64:67], v[128:131], a[56:59], v[64:67]
    ds_read_b64_tr_b16 v[148:149], v221 offset:24576
    v_mfma_f32_16x16x32_bf16 v[68:71], v[128:131], a[60:63], v[68:71]
    ds_read_b64_tr_b16 v[150:151], v221 offset:26624
    v_mfma_f32_16x16x32_bf16 v[40:43], v[132:135], a[48:51], v[40:43]
    ds_read_b64_tr_b16 v[152:153], v222 offset:24576
    v_mfma_f32_16x16x32_bf16 v[44:47], v[132:135], a[52:55], v[44:47]
    ds_read_b64_tr_b16 v[154:155], v222 offset:26624
    v_mfma_f32_16x16x32_bf16 v[72:75], v[132:135], a[56:59], v[72:75]
    ds_read_b64_tr_b16 v[156:157], v223 offset:24576
    v_mfma_f32_16x16x32_bf16 v[76:79], v[132:135], a[60:63], v[76:79]
    ds_read_b64_tr_b16 v[158:159], v223 offset:26624
    v_mfma_f32_16x16x32_bf16 v[48:51], v[136:139], a[48:51], v[48:51]
    buffer_load_dwordx4 a[8:11], v245, s[8:11], s35 offen offset:0 sc1
    v_mfma_f32_16x16x32_bf16 v[52:55], v[136:139], a[52:55], v[52:55]
    s_add_u32 m0, s38, 57344
    s_add_u32 s32, s37, 1507328
    v_mfma_f32_16x16x32_bf16 v[80:83], v[136:139], a[56:59], v[80:83]
    buffer_load_dwordx4 v224, s[12:15], s32 offen lds
    v_mfma_f32_16x16x32_bf16 v[84:87], v[136:139], a[60:63], v[84:87]
    buffer_load_dwordx4 a[12:15], v246, s[8:11], s35 offen offset:0 sc1
    v_mfma_f32_16x16x32_bf16 v[56:59], v[140:143], a[48:51], v[56:59]
    v_mfma_f32_16x16x32_bf16 v[60:63], v[140:143], a[52:55], v[60:63]
    buffer_load_dwordx4 v225, s[12:15], s32 offen offset:1024 lds
    v_mfma_f32_16x16x32_bf16 v[88:91], v[140:143], a[56:59], v[88:91]
    buffer_load_dwordx4 a[136:139], v228, s[8:11], s33 offen offset:2048 sc1
    v_mfma_f32_16x16x32_bf16 v[92:95], v[140:143], a[60:63], v[92:95]
    s_waitcnt lgkmcnt(0)
    s_barrier
    v_mfma_f32_16x16x32_bf16 v[0:3], v[144:147], a[48:51], v[0:3]
    ds_read_b64_tr_b16 v[128:129], v216 offset:32768
    v_mfma_f32_16x16x32_bf16 v[4:7], v[144:147], a[52:55], v[4:7]
    ds_read_b64_tr_b16 v[130:131], v216 offset:34816
    v_mfma_f32_16x16x32_bf16 v[96:99], v[144:147], a[56:59], v[96:99]
    ds_read_b64_tr_b16 v[132:133], v217 offset:32768
    v_mfma_f32_16x16x32_bf16 v[100:103], v[144:147], a[60:63], v[100:103]
    ds_read_b64_tr_b16 v[134:135], v217 offset:34816
    v_mfma_f32_16x16x32_bf16 v[8:11], v[148:151], a[48:51], v[8:11]
    ds_read_b64_tr_b16 v[136:137], v218 offset:32768
    v_mfma_f32_16x16x32_bf16 v[12:15], v[148:151], a[52:55], v[12:15]
    ds_read_b64_tr_b16 v[138:139], v218 offset:34816
    v_mfma_f32_16x16x32_bf16 v[104:107], v[148:151], a[56:59], v[104:107]
    ds_read_b64_tr_b16 v[140:141], v219 offset:32768
    v_mfma_f32_16x16x32_bf16 v[108:111], v[148:151], a[60:63], v[108:111]
    ds_read_b64_tr_b16 v[142:143], v219 offset:34816
    v_mfma_f32_16x16x32_bf16 v[16:19], v[152:155], a[48:51], v[16:19]
    buffer_load_dwordx4 a[16:19], v226, s[8:11], s35 offen offset:1024 sc1
    v_mfma_f32_16x16x32_bf16 v[20:23], v[152:155], a[52:55], v[20:23]
    v_mfma_f32_16x16x32_bf16 v[112:115], v[152:155], a[56:59], v[112:115]
    v_mfma_f32_16x16x32_bf16 v[116:119], v[152:155], a[60:63], v[116:119]
    v_mfma_f32_16x16x32_bf16 v[24:27], v[156:159], a[48:51], v[24:27]
    buffer_load_dwordx4 a[20:23], v227, s[8:11], s35 offen offset:1024 sc1
    v_mfma_f32_16x16x32_bf16 v[28:31], v[156:159], a[52:55], v[28:31]
    v_mfma_f32_16x16x32_bf16 v[120:123], v[156:159], a[56:59], v[120:123]
    buffer_load_dwordx4 a[140:143], v228, s[8:11], s33 offen offset:3072 sc1
    v_mfma_f32_16x16x32_bf16 v[124:127], v[156:159], a[60:63], v[124:127]
    s_waitcnt vmcnt(30) lgkmcnt(0)
    v_mfma_f32_16x16x32_bf16 v[32:35], v[128:131], a[64:67], v[32:35]
    ds_read_b64_tr_b16 v[144:145], v220 offset:32768
    v_mfma_f32_16x16x32_bf16 v[36:39], v[128:131], a[68:71], v[36:39]
    ds_read_b64_tr_b16 v[146:147], v220 offset:34816
    v_mfma_f32_16x16x32_bf16 v[64:67], v[128:131], a[72:75], v[64:67]
    ds_read_b64_tr_b16 v[148:149], v221 offset:32768
    v_mfma_f32_16x16x32_bf16 v[68:71], v[128:131], a[76:79], v[68:71]
    ds_read_b64_tr_b16 v[150:151], v221 offset:34816
    v_mfma_f32_16x16x32_bf16 v[40:43], v[132:135], a[64:67], v[40:43]
    ds_read_b64_tr_b16 v[152:153], v222 offset:32768
    v_mfma_f32_16x16x32_bf16 v[44:47], v[132:135], a[68:71], v[44:47]
    ds_read_b64_tr_b16 v[154:155], v222 offset:34816
    v_mfma_f32_16x16x32_bf16 v[72:75], v[132:135], a[72:75], v[72:75]
    ds_read_b64_tr_b16 v[156:157], v223 offset:32768
    v_mfma_f32_16x16x32_bf16 v[76:79], v[132:135], a[76:79], v[76:79]
    ds_read_b64_tr_b16 v[158:159], v223 offset:34816
    v_mfma_f32_16x16x32_bf16 v[48:51], v[136:139], a[64:67], v[48:51]
    buffer_load_dwordx4 a[24:27], v245, s[8:11], s35 offen offset:1024 sc1
    v_mfma_f32_16x16x32_bf16 v[52:55], v[136:139], a[68:71], v[52:55]
    s_add_u32 m0, s38, 65536
    s_add_u32 s32, s37, 1572864
    v_mfma_f32_16x16x32_bf16 v[80:83], v[136:139], a[72:75], v[80:83]
    buffer_load_dwordx4 v224, s[12:15], s32 offen lds
    v_mfma_f32_16x16x32_bf16 v[84:87], v[136:139], a[76:79], v[84:87]
    buffer_load_dwordx4 a[28:31], v246, s[8:11], s35 offen offset:1024 sc1
    v_mfma_f32_16x16x32_bf16 v[56:59], v[140:143], a[64:67], v[56:59]
    v_mfma_f32_16x16x32_bf16 v[60:63], v[140:143], a[68:71], v[60:63]
    buffer_load_dwordx4 v225, s[12:15], s32 offen offset:1024 lds
    v_mfma_f32_16x16x32_bf16 v[88:91], v[140:143], a[72:75], v[88:91]
    s_add_u32 s33, s55, 4096
    buffer_load_dwordx4 a[144:147], v228, s[8:11], s33 offen offset:0 sc1
    v_mfma_f32_16x16x32_bf16 v[92:95], v[140:143], a[76:79], v[92:95]
    s_waitcnt lgkmcnt(0)
    v_mfma_f32_16x16x32_bf16 v[0:3], v[144:147], a[64:67], v[0:3]
    ds_read_b64_tr_b16 v[128:129], v216 offset:40960
    v_mfma_f32_16x16x32_bf16 v[4:7], v[144:147], a[68:71], v[4:7]
    ds_read_b64_tr_b16 v[130:131], v216 offset:43008
    v_mfma_f32_16x16x32_bf16 v[96:99], v[144:147], a[72:75], v[96:99]
    ds_read_b64_tr_b16 v[132:133], v217 offset:40960
    v_mfma_f32_16x16x32_bf16 v[100:103], v[144:147], a[76:79], v[100:103]
    ds_read_b64_tr_b16 v[134:135], v217 offset:43008
    v_mfma_f32_16x16x32_bf16 v[8:11], v[148:151], a[64:67], v[8:11]
    ds_read_b64_tr_b16 v[136:137], v218 offset:40960
    v_mfma_f32_16x16x32_bf16 v[12:15], v[148:151], a[68:71], v[12:15]
    ds_read_b64_tr_b16 v[138:139], v218 offset:43008
    v_mfma_f32_16x16x32_bf16 v[104:107], v[148:151], a[72:75], v[104:107]
    ds_read_b64_tr_b16 v[140:141], v219 offset:40960
    v_mfma_f32_16x16x32_bf16 v[108:111], v[148:151], a[76:79], v[108:111]
    ds_read_b64_tr_b16 v[142:143], v219 offset:43008
    v_mfma_f32_16x16x32_bf16 v[16:19], v[152:155], a[64:67], v[16:19]
    buffer_load_dwordx4 a[32:35], v226, s[8:11], s35 offen offset:2048 sc1
    v_mfma_f32_16x16x32_bf16 v[20:23], v[152:155], a[68:71], v[20:23]
    v_mfma_f32_16x16x32_bf16 v[112:115], v[152:155], a[72:75], v[112:115]
    v_mfma_f32_16x16x32_bf16 v[116:119], v[152:155], a[76:79], v[116:119]
    v_mfma_f32_16x16x32_bf16 v[24:27], v[156:159], a[64:67], v[24:27]
    buffer_load_dwordx4 a[36:39], v227, s[8:11], s35 offen offset:2048 sc1
    v_mfma_f32_16x16x32_bf16 v[28:31], v[156:159], a[68:71], v[28:31]
    v_mfma_f32_16x16x32_bf16 v[120:123], v[156:159], a[72:75], v[120:123]
    buffer_load_dwordx4 a[148:151], v228, s[8:11], s33 offen offset:1024 sc1
    v_mfma_f32_16x16x32_bf16 v[124:127], v[156:159], a[76:79], v[124:127]
    buffer_load_dwordx4 a[40:43], v245, s[8:11], s35 offen offset:2048 sc1
    s_waitcnt vmcnt(33) lgkmcnt(0)
    v_mfma_f32_16x16x32_bf16 v[32:35], v[128:131], a[80:83], v[32:35]
    ds_read_b64_tr_b16 v[144:145], v220 offset:40960
    v_mfma_f32_16x16x32_bf16 v[36:39], v[128:131], a[84:87], v[36:39]
    ds_read_b64_tr_b16 v[146:147], v220 offset:43008
    v_mfma_f32_16x16x32_bf16 v[64:67], v[128:131], a[88:91], v[64:67]
    ds_read_b64_tr_b16 v[148:149], v221 offset:40960
    v_mfma_f32_16x16x32_bf16 v[68:71], v[128:131], a[92:95], v[68:71]
    ds_read_b64_tr_b16 v[150:151], v221 offset:43008
    v_mfma_f32_16x16x32_bf16 v[40:43], v[132:135], a[80:83], v[40:43]
    ds_read_b64_tr_b16 v[152:153], v222 offset:40960
    v_mfma_f32_16x16x32_bf16 v[44:47], v[132:135], a[84:87], v[44:47]
    ds_read_b64_tr_b16 v[154:155], v222 offset:43008
    v_mfma_f32_16x16x32_bf16 v[72:75], v[132:135], a[88:91], v[72:75]
    ds_read_b64_tr_b16 v[156:157], v223 offset:40960
    v_mfma_f32_16x16x32_bf16 v[76:79], v[132:135], a[92:95], v[76:79]
    ds_read_b64_tr_b16 v[158:159], v223 offset:43008
    v_mfma_f32_16x16x32_bf16 v[48:51], v[136:139], a[80:83], v[48:51]
    buffer_load_dwordx4 a[44:47], v246, s[8:11], s35 offen offset:2048 sc1
    v_mfma_f32_16x16x32_bf16 v[52:55], v[136:139], a[84:87], v[52:55]
    s_add_u32 m0, s38, 73728
    s_add_u32 s32, s37, 1638400
    v_mfma_f32_16x16x32_bf16 v[80:83], v[136:139], a[88:91], v[80:83]
    buffer_load_dwordx4 v224, s[12:15], s32 offen lds
    v_mfma_f32_16x16x32_bf16 v[84:87], v[136:139], a[92:95], v[84:87]
    buffer_load_dwordx4 a[48:51], v226, s[8:11], s35 offen offset:3072 sc1
    v_mfma_f32_16x16x32_bf16 v[56:59], v[140:143], a[80:83], v[56:59]
    v_mfma_f32_16x16x32_bf16 v[60:63], v[140:143], a[84:87], v[60:63]
    buffer_load_dwordx4 v225, s[12:15], s32 offen offset:1024 lds
    v_mfma_f32_16x16x32_bf16 v[88:91], v[140:143], a[88:91], v[88:91]
    buffer_load_dwordx4 a[152:155], v228, s[8:11], s33 offen offset:2048 sc1
    v_mfma_f32_16x16x32_bf16 v[92:95], v[140:143], a[92:95], v[92:95]
    s_waitcnt lgkmcnt(0)
    v_mfma_f32_16x16x32_bf16 v[0:3], v[144:147], a[80:83], v[0:3]
    ds_read_b64_tr_b16 v[128:129], v216 offset:49152
    v_mfma_f32_16x16x32_bf16 v[4:7], v[144:147], a[84:87], v[4:7]
    ds_read_b64_tr_b16 v[130:131], v216 offset:51200
    v_mfma_f32_16x16x32_bf16 v[96:99], v[144:147], a[88:91], v[96:99]
    ds_read_b64_tr_b16 v[132:133], v217 offset:49152
    v_mfma_f32_16x16x32_bf16 v[100:103], v[144:147], a[92:95], v[100:103]
    ds_read_b64_tr_b16 v[134:135], v217 offset:51200
    v_mfma_f32_16x16x32_bf16 v[8:11], v[148:151], a[80:83], v[8:11]
    ds_read_b64_tr_b16 v[136:137], v218 offset:49152
    v_mfma_f32_16x16x32_bf16 v[12:15], v[148:151], a[84:87], v[12:15]
    ds_read_b64_tr_b16 v[138:139], v218 offset:51200
    v_mfma_f32_16x16x32_bf16 v[104:107], v[148:151], a[88:91], v[104:107]
    ds_read_b64_tr_b16 v[140:141], v219 offset:49152
    v_mfma_f32_16x16x32_bf16 v[108:111], v[148:151], a[92:95], v[108:111]
    ds_read_b64_tr_b16 v[142:143], v219 offset:51200
    v_mfma_f32_16x16x32_bf16 v[16:19], v[152:155], a[80:83], v[16:19]
    buffer_load_dwordx4 a[52:55], v227, s[8:11], s35 offen offset:3072 sc1
    v_mfma_f32_16x16x32_bf16 v[20:23], v[152:155], a[84:87], v[20:23]
    v_mfma_f32_16x16x32_bf16 v[112:115], v[152:155], a[88:91], v[112:115]
    v_mfma_f32_16x16x32_bf16 v[116:119], v[152:155], a[92:95], v[116:119]
    v_mfma_f32_16x16x32_bf16 v[24:27], v[156:159], a[80:83], v[24:27]
    buffer_load_dwordx4 a[56:59], v245, s[8:11], s35 offen offset:3072 sc1
    v_mfma_f32_16x16x32_bf16 v[28:31], v[156:159], a[84:87], v[28:31]
    v_mfma_f32_16x16x32_bf16 v[120:123], v[156:159], a[88:91], v[120:123]
    buffer_load_dwordx4 a[156:159], v228, s[8:11], s33 offen offset:3072 sc1
    v_mfma_f32_16x16x32_bf16 v[124:127], v[156:159], a[92:95], v[124:127]
    s_waitcnt vmcnt(35) lgkmcnt(0)
    v_mfma_f32_16x16x32_bf16 v[32:35], v[128:131], a[96:99], v[32:35]
    ds_read_b64_tr_b16 v[144:145], v220 offset:49152
    v_mfma_f32_16x16x32_bf16 v[36:39], v[128:131], a[100:103], v[36:39]
    ds_read_b64_tr_b16 v[146:147], v220 offset:51200
    v_mfma_f32_16x16x32_bf16 v[64:67], v[128:131], a[104:107], v[64:67]
    ds_read_b64_tr_b16 v[148:149], v221 offset:49152
    v_mfma_f32_16x16x32_bf16 v[68:71], v[128:131], a[108:111], v[68:71]
    ds_read_b64_tr_b16 v[150:151], v221 offset:51200
    v_mfma_f32_16x16x32_bf16 v[40:43], v[132:135], a[96:99], v[40:43]
    ds_read_b64_tr_b16 v[152:153], v222 offset:49152
    v_mfma_f32_16x16x32_bf16 v[44:47], v[132:135], a[100:103], v[44:47]
    ds_read_b64_tr_b16 v[154:155], v222 offset:51200
    v_mfma_f32_16x16x32_bf16 v[72:75], v[132:135], a[104:107], v[72:75]
    ds_read_b64_tr_b16 v[156:157], v223 offset:49152
    v_mfma_f32_16x16x32_bf16 v[76:79], v[132:135], a[108:111], v[76:79]
    ds_read_b64_tr_b16 v[158:159], v223 offset:51200
    v_mfma_f32_16x16x32_bf16 v[48:51], v[136:139], a[96:99], v[48:51]
    buffer_load_dwordx4 a[60:63], v246, s[8:11], s35 offen offset:3072 sc1
    v_mfma_f32_16x16x32_bf16 v[52:55], v[136:139], a[100:103], v[52:55]
    s_add_u32 m0, s38, 81920
    s_add_u32 s32, s37, 1703936
    v_mfma_f32_16x16x32_bf16 v[80:83], v[136:139], a[104:107], v[80:83]
    buffer_load_dwordx4 v224, s[12:15], s32 offen lds
    v_mfma_f32_16x16x32_bf16 v[84:87], v[136:139], a[108:111], v[84:87]
    s_add_u32 s35, s35, 4096
    buffer_load_dwordx4 a[64:67], v226, s[8:11], s35 offen offset:0 sc1
    v_mfma_f32_16x16x32_bf16 v[56:59], v[140:143], a[96:99], v[56:59]
    v_mfma_f32_16x16x32_bf16 v[60:63], v[140:143], a[100:103], v[60:63]
    buffer_load_dwordx4 v225, s[12:15], s32 offen offset:1024 lds
    v_mfma_f32_16x16x32_bf16 v[88:91], v[140:143], a[104:107], v[88:91]
    s_add_u32 s33, s55, 32768
    buffer_load_dwordx4 a[160:163], v228, s[8:11], s33 offen offset:0 sc1
    v_mfma_f32_16x16x32_bf16 v[92:95], v[140:143], a[108:111], v[92:95]
    s_waitcnt lgkmcnt(0)
    v_mfma_f32_16x16x32_bf16 v[0:3], v[144:147], a[96:99], v[0:3]
    ds_read_b64_tr_b16 v[128:129], v216 offset:57344
    v_mfma_f32_16x16x32_bf16 v[4:7], v[144:147], a[100:103], v[4:7]
    ds_read_b64_tr_b16 v[130:131], v216 offset:59392
    v_mfma_f32_16x16x32_bf16 v[96:99], v[144:147], a[104:107], v[96:99]
    ds_read_b64_tr_b16 v[132:133], v217 offset:57344
    v_mfma_f32_16x16x32_bf16 v[100:103], v[144:147], a[108:111], v[100:103]
    ds_read_b64_tr_b16 v[134:135], v217 offset:59392
    v_mfma_f32_16x16x32_bf16 v[8:11], v[148:151], a[96:99], v[8:11]
    ds_read_b64_tr_b16 v[136:137], v218 offset:57344
    v_mfma_f32_16x16x32_bf16 v[12:15], v[148:151], a[100:103], v[12:15]
    ds_read_b64_tr_b16 v[138:139], v218 offset:59392
    v_mfma_f32_16x16x32_bf16 v[104:107], v[148:151], a[104:107], v[104:107]
    ds_read_b64_tr_b16 v[140:141], v219 offset:57344
    v_mfma_f32_16x16x32_bf16 v[108:111], v[148:151], a[108:111], v[108:111]
    ds_read_b64_tr_b16 v[142:143], v219 offset:59392
    v_mfma_f32_16x16x32_bf16 v[16:19], v[152:155], a[96:99], v[16:19]
    buffer_load_dwordx4 a[68:71], v227, s[8:11], s35 offen offset:0 sc1
    v_mfma_f32_16x16x32_bf16 v[20:23], v[152:155], a[100:103], v[20:23]
    v_mfma_f32_16x16x32_bf16 v[112:115], v[152:155], a[104:107], v[112:115]
    v_mfma_f32_16x16x32_bf16 v[116:119], v[152:155], a[108:111], v[116:119]
    v_mfma_f32_16x16x32_bf16 v[24:27], v[156:159], a[96:99], v[24:27]
    buffer_load_dwordx4 a[72:75], v245, s[8:11], s35 offen offset:0 sc1
    v_mfma_f32_16x16x32_bf16 v[28:31], v[156:159], a[100:103], v[28:31]
    v_mfma_f32_16x16x32_bf16 v[120:123], v[156:159], a[104:107], v[120:123]
    buffer_load_dwordx4 a[164:167], v228, s[8:11], s33 offen offset:1024 sc1
    v_mfma_f32_16x16x32_bf16 v[124:127], v[156:159], a[108:111], v[124:127]
    buffer_load_dwordx4 a[76:79], v246, s[8:11], s35 offen offset:0 sc1
    s_waitcnt vmcnt(37) lgkmcnt(0)
    v_mfma_f32_16x16x32_bf16 v[32:35], v[128:131], a[112:115], v[32:35]
    ds_read_b64_tr_b16 v[144:145], v220 offset:57344
    v_mfma_f32_16x16x32_bf16 v[36:39], v[128:131], a[116:119], v[36:39]
    ds_read_b64_tr_b16 v[146:147], v220 offset:59392
    v_mfma_f32_16x16x32_bf16 v[64:67], v[128:131], a[120:123], v[64:67]
    ds_read_b64_tr_b16 v[148:149], v221 offset:57344
    v_mfma_f32_16x16x32_bf16 v[68:71], v[128:131], a[124:127], v[68:71]
    ds_read_b64_tr_b16 v[150:151], v221 offset:59392
    v_mfma_f32_16x16x32_bf16 v[40:43], v[132:135], a[112:115], v[40:43]
    ds_read_b64_tr_b16 v[152:153], v222 offset:57344
    v_mfma_f32_16x16x32_bf16 v[44:47], v[132:135], a[116:119], v[44:47]
    ds_read_b64_tr_b16 v[154:155], v222 offset:59392
    v_mfma_f32_16x16x32_bf16 v[72:75], v[132:135], a[120:123], v[72:75]
    ds_read_b64_tr_b16 v[156:157], v223 offset:57344
    v_mfma_f32_16x16x32_bf16 v[76:79], v[132:135], a[124:127], v[76:79]
    ds_read_b64_tr_b16 v[158:159], v223 offset:59392
    v_mfma_f32_16x16x32_bf16 v[48:51], v[136:139], a[112:115], v[48:51]
    buffer_load_dwordx4 a[80:83], v226, s[8:11], s35 offen offset:1024 sc1
    v_mfma_f32_16x16x32_bf16 v[52:55], v[136:139], a[116:119], v[52:55]
    s_add_u32 m0, s38, 90112
    s_add_u32 s32, s37, 1769472
    v_mfma_f32_16x16x32_bf16 v[80:83], v[136:139], a[120:123], v[80:83]
    buffer_load_dwordx4 v224, s[12:15], s32 offen lds
    v_mfma_f32_16x16x32_bf16 v[84:87], v[136:139], a[124:127], v[84:87]
    buffer_load_dwordx4 a[84:87], v227, s[8:11], s35 offen offset:1024 sc1
    v_mfma_f32_16x16x32_bf16 v[56:59], v[140:143], a[112:115], v[56:59]
    v_mfma_f32_16x16x32_bf16 v[60:63], v[140:143], a[116:119], v[60:63]
    buffer_load_dwordx4 v225, s[12:15], s32 offen offset:1024 lds
    v_mfma_f32_16x16x32_bf16 v[88:91], v[140:143], a[120:123], v[88:91]
    buffer_load_dwordx4 a[168:171], v228, s[8:11], s33 offen offset:2048 sc1
    v_mfma_f32_16x16x32_bf16 v[92:95], v[140:143], a[124:127], v[92:95]
    s_waitcnt vmcnt(63) lgkmcnt(0)
    s_barrier
    v_mfma_f32_16x16x32_bf16 v[0:3], v[144:147], a[112:115], v[0:3]
    v_xor_b32 v216, 0x10000, v216
    ds_read_b64_tr_b16 v[128:129], v216 offset:0
    v_mfma_f32_16x16x32_bf16 v[4:7], v[144:147], a[116:119], v[4:7]
    ds_read_b64_tr_b16 v[130:131], v216 offset:2048
    v_mfma_f32_16x16x32_bf16 v[96:99], v[144:147], a[120:123], v[96:99]
    v_xor_b32 v217, 0x10000, v217
    ds_read_b64_tr_b16 v[132:133], v217 offset:0
    v_mfma_f32_16x16x32_bf16 v[100:103], v[144:147], a[124:127], v[100:103]
    ds_read_b64_tr_b16 v[134:135], v217 offset:2048
    v_mfma_f32_16x16x32_bf16 v[8:11], v[148:151], a[112:115], v[8:11]
    v_xor_b32 v218, 0x10000, v218
    ds_read_b64_tr_b16 v[136:137], v218 offset:0
    v_mfma_f32_16x16x32_bf16 v[12:15], v[148:151], a[116:119], v[12:15]
    ds_read_b64_tr_b16 v[138:139], v218 offset:2048
    v_mfma_f32_16x16x32_bf16 v[104:107], v[148:151], a[120:123], v[104:107]
    v_xor_b32 v219, 0x10000, v219
    ds_read_b64_tr_b16 v[140:141], v219 offset:0
    v_mfma_f32_16x16x32_bf16 v[108:111], v[148:151], a[124:127], v[108:111]
    ds_read_b64_tr_b16 v[142:143], v219 offset:2048
    v_mfma_f32_16x16x32_bf16 v[16:19], v[152:155], a[112:115], v[16:19]
    buffer_load_dwordx4 a[88:91], v245, s[8:11], s35 offen offset:1024 sc1
    v_mfma_f32_16x16x32_bf16 v[20:23], v[152:155], a[116:119], v[20:23]
    v_mfma_f32_16x16x32_bf16 v[112:115], v[152:155], a[120:123], v[112:115]
    v_mfma_f32_16x16x32_bf16 v[116:119], v[152:155], a[124:127], v[116:119]
    v_mfma_f32_16x16x32_bf16 v[24:27], v[156:159], a[112:115], v[24:27]
    buffer_load_dwordx4 a[92:95], v246, s[8:11], s35 offen offset:1024 sc1
    v_mfma_f32_16x16x32_bf16 v[28:31], v[156:159], a[116:119], v[28:31]
    v_mfma_f32_16x16x32_bf16 v[120:123], v[156:159], a[120:123], v[120:123]
    buffer_load_dwordx4 a[172:175], v228, s[8:11], s33 offen offset:3072 sc1
    v_mfma_f32_16x16x32_bf16 v[124:127], v[156:159], a[124:127], v[124:127]
    s_waitcnt vmcnt(39) lgkmcnt(0)
    v_mfma_f32_16x16x32_bf16 v[32:35], v[128:131], a[0:3], v[32:35]
    v_xor_b32 v220, 0x10000, v220
    ds_read_b64_tr_b16 v[144:145], v220 offset:0
    v_mfma_f32_16x16x32_bf16 v[36:39], v[128:131], a[4:7], v[36:39]
    ds_read_b64_tr_b16 v[146:147], v220 offset:2048
    v_mfma_f32_16x16x32_bf16 v[64:67], v[128:131], a[8:11], v[64:67]
    v_xor_b32 v221, 0x10000, v221
    ds_read_b64_tr_b16 v[148:149], v221 offset:0
    v_mfma_f32_16x16x32_bf16 v[68:71], v[128:131], a[12:15], v[68:71]
    ds_read_b64_tr_b16 v[150:151], v221 offset:2048
    v_mfma_f32_16x16x32_bf16 v[40:43], v[132:135], a[0:3], v[40:43]
    v_xor_b32 v222, 0x10000, v222
    ds_read_b64_tr_b16 v[152:153], v222 offset:0
    v_mfma_f32_16x16x32_bf16 v[44:47], v[132:135], a[4:7], v[44:47]
    ds_read_b64_tr_b16 v[154:155], v222 offset:2048
    v_mfma_f32_16x16x32_bf16 v[72:75], v[132:135], a[8:11], v[72:75]
    v_xor_b32 v223, 0x10000, v223
    ds_read_b64_tr_b16 v[156:157], v223 offset:0
    v_mfma_f32_16x16x32_bf16 v[76:79], v[132:135], a[12:15], v[76:79]
    ds_read_b64_tr_b16 v[158:159], v223 offset:2048
    v_mfma_f32_16x16x32_bf16 v[48:51], v[136:139], a[0:3], v[48:51]
    buffer_load_dwordx4 a[96:99], v226, s[8:11], s35 offen offset:2048 sc1
    v_mfma_f32_16x16x32_bf16 v[52:55], v[136:139], a[4:7], v[52:55]
    s_add_u32 m0, s38, 98304
    s_add_u32 s32, s37, 1835008
    v_mfma_f32_16x16x32_bf16 v[80:83], v[136:139], a[8:11], v[80:83]
    buffer_load_dwordx4 v224, s[12:15], s32 offen lds
    v_mfma_f32_16x16x32_bf16 v[84:87], v[136:139], a[12:15], v[84:87]
    buffer_load_dwordx4 a[100:103], v227, s[8:11], s35 offen offset:2048 sc1
    v_mfma_f32_16x16x32_bf16 v[56:59], v[140:143], a[0:3], v[56:59]
    v_mfma_f32_16x16x32_bf16 v[60:63], v[140:143], a[4:7], v[60:63]
    buffer_load_dwordx4 v225, s[12:15], s32 offen offset:1024 lds
    v_mfma_f32_16x16x32_bf16 v[88:91], v[140:143], a[8:11], v[88:91]
    s_add_u32 s33, s55, 36864
    buffer_load_dwordx4 a[176:179], v228, s[8:11], s33 offen offset:0 sc1
    v_mfma_f32_16x16x32_bf16 v[92:95], v[140:143], a[12:15], v[92:95]
    s_waitcnt lgkmcnt(0)
    v_mfma_f32_16x16x32_bf16 v[0:3], v[144:147], a[0:3], v[0:3]
    ds_read_b64_tr_b16 v[128:129], v216 offset:8192
    v_mfma_f32_16x16x32_bf16 v[4:7], v[144:147], a[4:7], v[4:7]
    ds_read_b64_tr_b16 v[130:131], v216 offset:10240
    v_mfma_f32_16x16x32_bf16 v[96:99], v[144:147], a[8:11], v[96:99]
    ds_read_b64_tr_b16 v[132:133], v217 offset:8192
    v_mfma_f32_16x16x32_bf16 v[100:103], v[144:147], a[12:15], v[100:103]
    ds_read_b64_tr_b16 v[134:135], v217 offset:10240
    v_mfma_f32_16x16x32_bf16 v[8:11], v[148:151], a[0:3], v[8:11]
    ds_read_b64_tr_b16 v[136:137], v218 offset:8192
    v_mfma_f32_16x16x32_bf16 v[12:15], v[148:151], a[4:7], v[12:15]
    ds_read_b64_tr_b16 v[138:139], v218 offset:10240
    v_mfma_f32_16x16x32_bf16 v[104:107], v[148:151], a[8:11], v[104:107]
    ds_read_b64_tr_b16 v[140:141], v219 offset:8192
    v_mfma_f32_16x16x32_bf16 v[108:111], v[148:151], a[12:15], v[108:111]
    ds_read_b64_tr_b16 v[142:143], v219 offset:10240
    v_mfma_f32_16x16x32_bf16 v[16:19], v[152:155], a[0:3], v[16:19]
    buffer_load_dwordx4 a[104:107], v245, s[8:11], s35 offen offset:2048 sc1
    v_mfma_f32_16x16x32_bf16 v[20:23], v[152:155], a[4:7], v[20:23]
    v_mfma_f32_16x16x32_bf16 v[112:115], v[152:155], a[8:11], v[112:115]
    v_mfma_f32_16x16x32_bf16 v[116:119], v[152:155], a[12:15], v[116:119]
    v_mfma_f32_16x16x32_bf16 v[24:27], v[156:159], a[0:3], v[24:27]
    buffer_load_dwordx4 a[108:111], v246, s[8:11], s35 offen offset:2048 sc1
    v_mfma_f32_16x16x32_bf16 v[28:31], v[156:159], a[4:7], v[28:31]
    v_mfma_f32_16x16x32_bf16 v[120:123], v[156:159], a[8:11], v[120:123]
    buffer_load_dwordx4 a[180:183], v228, s[8:11], s33 offen offset:1024 sc1
    v_mfma_f32_16x16x32_bf16 v[124:127], v[156:159], a[12:15], v[124:127]
    buffer_load_dwordx4 a[112:115], v226, s[8:11], s35 offen offset:3072 sc1
    s_waitcnt vmcnt(40) lgkmcnt(0)
    v_mfma_f32_16x16x32_bf16 v[32:35], v[128:131], a[16:19], v[32:35]
    ds_read_b64_tr_b16 v[144:145], v220 offset:8192
    v_mfma_f32_16x16x32_bf16 v[36:39], v[128:131], a[20:23], v[36:39]
    ds_read_b64_tr_b16 v[146:147], v220 offset:10240
    v_mfma_f32_16x16x32_bf16 v[64:67], v[128:131], a[24:27], v[64:67]
    ds_read_b64_tr_b16 v[148:149], v221 offset:8192
    v_mfma_f32_16x16x32_bf16 v[68:71], v[128:131], a[28:31], v[68:71]
    ds_read_b64_tr_b16 v[150:151], v221 offset:10240
    v_mfma_f32_16x16x32_bf16 v[40:43], v[132:135], a[16:19], v[40:43]
    ds_read_b64_tr_b16 v[152:153], v222 offset:8192
    v_mfma_f32_16x16x32_bf16 v[44:47], v[132:135], a[20:23], v[44:47]
    ds_read_b64_tr_b16 v[154:155], v222 offset:10240
    v_mfma_f32_16x16x32_bf16 v[72:75], v[132:135], a[24:27], v[72:75]
    ds_read_b64_tr_b16 v[156:157], v223 offset:8192
    v_mfma_f32_16x16x32_bf16 v[76:79], v[132:135], a[28:31], v[76:79]
    ds_read_b64_tr_b16 v[158:159], v223 offset:10240
    v_mfma_f32_16x16x32_bf16 v[48:51], v[136:139], a[16:19], v[48:51]
    buffer_load_dwordx4 a[116:119], v227, s[8:11], s35 offen offset:3072 sc1
    v_mfma_f32_16x16x32_bf16 v[52:55], v[136:139], a[20:23], v[52:55]
    s_add_u32 m0, s38, 106496
    s_add_u32 s32, s37, 1900544
    v_mfma_f32_16x16x32_bf16 v[80:83], v[136:139], a[24:27], v[80:83]
    buffer_load_dwordx4 v224, s[12:15], s32 offen lds
    v_mfma_f32_16x16x32_bf16 v[84:87], v[136:139], a[28:31], v[84:87]
    buffer_load_dwordx4 a[120:123], v245, s[8:11], s35 offen offset:3072 sc1
    v_mfma_f32_16x16x32_bf16 v[56:59], v[140:143], a[16:19], v[56:59]
    v_mfma_f32_16x16x32_bf16 v[60:63], v[140:143], a[20:23], v[60:63]
    buffer_load_dwordx4 v225, s[12:15], s32 offen offset:1024 lds
    v_mfma_f32_16x16x32_bf16 v[88:91], v[140:143], a[24:27], v[88:91]
    buffer_load_dwordx4 a[184:187], v228, s[8:11], s33 offen offset:2048 sc1
    v_mfma_f32_16x16x32_bf16 v[92:95], v[140:143], a[28:31], v[92:95]
    s_waitcnt lgkmcnt(0)
    v_mfma_f32_16x16x32_bf16 v[0:3], v[144:147], a[16:19], v[0:3]
    ds_read_b64_tr_b16 v[128:129], v216 offset:16384
    v_mfma_f32_16x16x32_bf16 v[4:7], v[144:147], a[20:23], v[4:7]
    ds_read_b64_tr_b16 v[130:131], v216 offset:18432
    v_mfma_f32_16x16x32_bf16 v[96:99], v[144:147], a[24:27], v[96:99]
    ds_read_b64_tr_b16 v[132:133], v217 offset:16384
    v_mfma_f32_16x16x32_bf16 v[100:103], v[144:147], a[28:31], v[100:103]
    ds_read_b64_tr_b16 v[134:135], v217 offset:18432
    v_mfma_f32_16x16x32_bf16 v[8:11], v[148:151], a[16:19], v[8:11]
    ds_read_b64_tr_b16 v[136:137], v218 offset:16384
    v_mfma_f32_16x16x32_bf16 v[12:15], v[148:151], a[20:23], v[12:15]
    ds_read_b64_tr_b16 v[138:139], v218 offset:18432
    v_mfma_f32_16x16x32_bf16 v[104:107], v[148:151], a[24:27], v[104:107]
    ds_read_b64_tr_b16 v[140:141], v219 offset:16384
    v_mfma_f32_16x16x32_bf16 v[108:111], v[148:151], a[28:31], v[108:111]
    ds_read_b64_tr_b16 v[142:143], v219 offset:18432
    v_mfma_f32_16x16x32_bf16 v[16:19], v[152:155], a[16:19], v[16:19]
    buffer_load_dwordx4 a[124:127], v246, s[8:11], s35 offen offset:3072 sc1
    v_mfma_f32_16x16x32_bf16 v[20:23], v[152:155], a[20:23], v[20:23]
    v_mfma_f32_16x16x32_bf16 v[112:115], v[152:155], a[24:27], v[112:115]
    v_mfma_f32_16x16x32_bf16 v[116:119], v[152:155], a[28:31], v[116:119]
    v_mfma_f32_16x16x32_bf16 v[24:27], v[156:159], a[16:19], v[24:27]
    s_add_u32 s35, s35, 4096
    buffer_load_dwordx4 a[0:3], v226, s[8:11], s35 offen offset:0 sc1
    v_mfma_f32_16x16x32_bf16 v[28:31], v[156:159], a[20:23], v[28:31]
    v_mfma_f32_16x16x32_bf16 v[120:123], v[156:159], a[24:27], v[120:123]
    buffer_load_dwordx4 a[188:191], v228, s[8:11], s33 offen offset:3072 sc1
    v_mfma_f32_16x16x32_bf16 v[124:127], v[156:159], a[28:31], v[124:127]
    s_waitcnt vmcnt(41) lgkmcnt(0)
    v_mfma_f32_16x16x32_bf16 v[32:35], v[128:131], a[32:35], v[32:35]
    ds_read_b64_tr_b16 v[144:145], v220 offset:16384
    v_mfma_f32_16x16x32_bf16 v[36:39], v[128:131], a[36:39], v[36:39]
    ds_read_b64_tr_b16 v[146:147], v220 offset:18432
    v_mfma_f32_16x16x32_bf16 v[64:67], v[128:131], a[40:43], v[64:67]
    ds_read_b64_tr_b16 v[148:149], v221 offset:16384
    v_mfma_f32_16x16x32_bf16 v[68:71], v[128:131], a[44:47], v[68:71]
    ds_read_b64_tr_b16 v[150:151], v221 offset:18432
    v_mfma_f32_16x16x32_bf16 v[40:43], v[132:135], a[32:35], v[40:43]
    ds_read_b64_tr_b16 v[152:153], v222 offset:16384
    v_mfma_f32_16x16x32_bf16 v[44:47], v[132:135], a[36:39], v[44:47]
    ds_read_b64_tr_b16 v[154:155], v222 offset:18432
    v_mfma_f32_16x16x32_bf16 v[72:75], v[132:135], a[40:43], v[72:75]
    ds_read_b64_tr_b16 v[156:157], v223 offset:16384
    v_mfma_f32_16x16x32_bf16 v[76:79], v[132:135], a[44:47], v[76:79]
    ds_read_b64_tr_b16 v[158:159], v223 offset:18432
    v_mfma_f32_16x16x32_bf16 v[48:51], v[136:139], a[32:35], v[48:51]
    buffer_load_dwordx4 a[4:7], v227, s[8:11], s35 offen offset:0 sc1
    v_mfma_f32_16x16x32_bf16 v[52:55], v[136:139], a[36:39], v[52:55]
    s_add_u32 m0, s38, 114688
    s_add_u32 s32, s37, 1966080
    v_mfma_f32_16x16x32_bf16 v[80:83], v[136:139], a[40:43], v[80:83]
    buffer_load_dwordx4 v224, s[12:15], s32 offen lds
    v_mfma_f32_16x16x32_bf16 v[84:87], v[136:139], a[44:47], v[84:87]
    buffer_load_dwordx4 a[8:11], v245, s[8:11], s35 offen offset:0 sc1
    v_mfma_f32_16x16x32_bf16 v[56:59], v[140:143], a[32:35], v[56:59]
    v_mfma_f32_16x16x32_bf16 v[60:63], v[140:143], a[36:39], v[60:63]
    buffer_load_dwordx4 v225, s[12:15], s32 offen offset:1024 lds
    v_mfma_f32_16x16x32_bf16 v[88:91], v[140:143], a[40:43], v[88:91]
    v_mfma_f32_16x16x32_bf16 v[92:95], v[140:143], a[44:47], v[92:95]
    s_waitcnt lgkmcnt(0)
    v_mfma_f32_16x16x32_bf16 v[0:3], v[144:147], a[32:35], v[0:3]
    ds_read_b64_tr_b16 v[128:129], v216 offset:24576
    v_mfma_f32_16x16x32_bf16 v[4:7], v[144:147], a[36:39], v[4:7]
    ds_read_b64_tr_b16 v[130:131], v216 offset:26624
    v_mfma_f32_16x16x32_bf16 v[96:99], v[144:147], a[40:43], v[96:99]
    ds_read_b64_tr_b16 v[132:133], v217 offset:24576
    v_mfma_f32_16x16x32_bf16 v[100:103], v[144:147], a[44:47], v[100:103]
    ds_read_b64_tr_b16 v[134:135], v217 offset:26624
    v_mfma_f32_16x16x32_bf16 v[8:11], v[148:151], a[32:35], v[8:11]
    ds_read_b64_tr_b16 v[136:137], v218 offset:24576
    v_mfma_f32_16x16x32_bf16 v[12:15], v[148:151], a[36:39], v[12:15]
    ds_read_b64_tr_b16 v[138:139], v218 offset:26624
    v_mfma_f32_16x16x32_bf16 v[104:107], v[148:151], a[40:43], v[104:107]
    ds_read_b64_tr_b16 v[140:141], v219 offset:24576
    v_mfma_f32_16x16x32_bf16 v[108:111], v[148:151], a[44:47], v[108:111]
    ds_read_b64_tr_b16 v[142:143], v219 offset:26624
    v_mfma_f32_16x16x32_bf16 v[16:19], v[152:155], a[32:35], v[16:19]
    buffer_load_dwordx4 a[12:15], v246, s[8:11], s35 offen offset:0 sc1
    v_mfma_f32_16x16x32_bf16 v[20:23], v[152:155], a[36:39], v[20:23]
    v_mfma_f32_16x16x32_bf16 v[112:115], v[152:155], a[40:43], v[112:115]
    v_mfma_f32_16x16x32_bf16 v[116:119], v[152:155], a[44:47], v[116:119]
    v_mfma_f32_16x16x32_bf16 v[24:27], v[156:159], a[32:35], v[24:27]
    buffer_load_dwordx4 a[16:19], v226, s[8:11], s35 offen offset:1024 sc1
    v_mfma_f32_16x16x32_bf16 v[28:31], v[156:159], a[36:39], v[28:31]
    v_mfma_f32_16x16x32_bf16 v[120:123], v[156:159], a[40:43], v[120:123]
    v_mfma_f32_16x16x32_bf16 v[124:127], v[156:159], a[44:47], v[124:127]
    buffer_load_dwordx4 a[20:23], v227, s[8:11], s35 offen offset:1024 sc1
    s_waitcnt vmcnt(40) lgkmcnt(0)
    v_mfma_f32_16x16x32_bf16 v[32:35], v[128:131], a[48:51], v[32:35]
    ds_read_b64_tr_b16 v[144:145], v220 offset:24576
    v_mfma_f32_16x16x32_bf16 v[36:39], v[128:131], a[52:55], v[36:39]
    ds_read_b64_tr_b16 v[146:147], v220 offset:26624
    v_mfma_f32_16x16x32_bf16 v[64:67], v[128:131], a[56:59], v[64:67]
    ds_read_b64_tr_b16 v[148:149], v221 offset:24576
    v_mfma_f32_16x16x32_bf16 v[68:71], v[128:131], a[60:63], v[68:71]
    ds_read_b64_tr_b16 v[150:151], v221 offset:26624
    v_mfma_f32_16x16x32_bf16 v[40:43], v[132:135], a[48:51], v[40:43]
    ds_read_b64_tr_b16 v[152:153], v222 offset:24576
    v_mfma_f32_16x16x32_bf16 v[44:47], v[132:135], a[52:55], v[44:47]
    ds_read_b64_tr_b16 v[154:155], v222 offset:26624
    v_mfma_f32_16x16x32_bf16 v[72:75], v[132:135], a[56:59], v[72:75]
    ds_read_b64_tr_b16 v[156:157], v223 offset:24576
    v_mfma_f32_16x16x32_bf16 v[76:79], v[132:135], a[60:63], v[76:79]
    ds_read_b64_tr_b16 v[158:159], v223 offset:26624
    v_mfma_f32_16x16x32_bf16 v[48:51], v[136:139], a[48:51], v[48:51]
    buffer_load_dwordx4 a[24:27], v245, s[8:11], s35 offen offset:1024 sc1
    v_mfma_f32_16x16x32_bf16 v[52:55], v[136:139], a[52:55], v[52:55]
    s_add_u32 m0, s38, 122880
    s_add_u32 s32, s37, 2031616
    v_mfma_f32_16x16x32_bf16 v[80:83], v[136:139], a[56:59], v[80:83]
    buffer_load_dwordx4 v224, s[12:15], s32 offen lds
    v_mfma_f32_16x16x32_bf16 v[84:87], v[136:139], a[60:63], v[84:87]
    buffer_load_dwordx4 a[28:31], v246, s[8:11], s35 offen offset:1024 sc1
    v_mfma_f32_16x16x32_bf16 v[56:59], v[140:143], a[48:51], v[56:59]
    v_mfma_f32_16x16x32_bf16 v[60:63], v[140:143], a[52:55], v[60:63]
    buffer_load_dwordx4 v225, s[12:15], s32 offen offset:1024 lds
    v_mfma_f32_16x16x32_bf16 v[88:91], v[140:143], a[56:59], v[88:91]
    v_mfma_f32_16x16x32_bf16 v[92:95], v[140:143], a[60:63], v[92:95]
    s_waitcnt vmcnt(63) lgkmcnt(0)
    s_barrier
    v_mfma_f32_16x16x32_bf16 v[0:3], v[144:147], a[48:51], v[0:3]
    ds_read_b64_tr_b16 v[128:129], v216 offset:32768
    v_mfma_f32_16x16x32_bf16 v[4:7], v[144:147], a[52:55], v[4:7]
    ds_read_b64_tr_b16 v[130:131], v216 offset:34816
    v_mfma_f32_16x16x32_bf16 v[96:99], v[144:147], a[56:59], v[96:99]
    ds_read_b64_tr_b16 v[132:133], v217 offset:32768
    v_mfma_f32_16x16x32_bf16 v[100:103], v[144:147], a[60:63], v[100:103]
    ds_read_b64_tr_b16 v[134:135], v217 offset:34816
    v_mfma_f32_16x16x32_bf16 v[8:11], v[148:151], a[48:51], v[8:11]
    ds_read_b64_tr_b16 v[136:137], v218 offset:32768
    v_mfma_f32_16x16x32_bf16 v[12:15], v[148:151], a[52:55], v[12:15]
    ds_read_b64_tr_b16 v[138:139], v218 offset:34816
    v_mfma_f32_16x16x32_bf16 v[104:107], v[148:151], a[56:59], v[104:107]
    ds_read_b64_tr_b16 v[140:141], v219 offset:32768
    v_mfma_f32_16x16x32_bf16 v[108:111], v[148:151], a[60:63], v[108:111]
    ds_read_b64_tr_b16 v[142:143], v219 offset:34816
    v_mfma_f32_16x16x32_bf16 v[16:19], v[152:155], a[48:51], v[16:19]
    buffer_load_dwordx4 a[32:35], v226, s[8:11], s35 offen offset:2048 sc1
    v_mfma_f32_16x16x32_bf16 v[20:23], v[152:155], a[52:55], v[20:23]
    v_mfma_f32_16x16x32_bf16 v[112:115], v[152:155], a[56:59], v[112:115]
    v_mfma_f32_16x16x32_bf16 v[116:119], v[152:155], a[60:63], v[116:119]
    v_mfma_f32_16x16x32_bf16 v[24:27], v[156:159], a[48:51], v[24:27]
    buffer_load_dwordx4 a[36:39], v227, s[8:11], s35 offen offset:2048 sc1
    v_mfma_f32_16x16x32_bf16 v[28:31], v[156:159], a[52:55], v[28:31]
    v_mfma_f32_16x16x32_bf16 v[120:123], v[156:159], a[56:59], v[120:123]
    v_mfma_f32_16x16x32_bf16 v[124:127], v[156:159], a[60:63], v[124:127]
    s_waitcnt vmcnt(38) lgkmcnt(0)
    v_mfma_f32_16x16x32_bf16 v[32:35], v[128:131], a[64:67], v[32:35]
    ds_read_b64_tr_b16 v[144:145], v220 offset:32768
    v_mfma_f32_16x16x32_bf16 v[36:39], v[128:131], a[68:71], v[36:39]
    ds_read_b64_tr_b16 v[146:147], v220 offset:34816
    v_mfma_f32_16x16x32_bf16 v[64:67], v[128:131], a[72:75], v[64:67]
    ds_read_b64_tr_b16 v[148:149], v221 offset:32768
    v_mfma_f32_16x16x32_bf16 v[68:71], v[128:131], a[76:79], v[68:71]
    ds_read_b64_tr_b16 v[150:151], v221 offset:34816
    v_mfma_f32_16x16x32_bf16 v[40:43], v[132:135], a[64:67], v[40:43]
    ds_read_b64_tr_b16 v[152:153], v222 offset:32768
    v_mfma_f32_16x16x32_bf16 v[44:47], v[132:135], a[68:71], v[44:47]
    ds_read_b64_tr_b16 v[154:155], v222 offset:34816
    v_mfma_f32_16x16x32_bf16 v[72:75], v[132:135], a[72:75], v[72:75]
    ds_read_b64_tr_b16 v[156:157], v223 offset:32768
    v_mfma_f32_16x16x32_bf16 v[76:79], v[132:135], a[76:79], v[76:79]
    ds_read_b64_tr_b16 v[158:159], v223 offset:34816
    v_mfma_f32_16x16x32_bf16 v[48:51], v[136:139], a[64:67], v[48:51]
    buffer_load_dwordx4 a[40:43], v245, s[8:11], s35 offen offset:2048 sc1
    v_mfma_f32_16x16x32_bf16 v[52:55], v[136:139], a[68:71], v[52:55]
    v_mfma_f32_16x16x32_bf16 v[80:83], v[136:139], a[72:75], v[80:83]
    v_mfma_f32_16x16x32_bf16 v[84:87], v[136:139], a[76:79], v[84:87]
    buffer_load_dwordx4 a[44:47], v246, s[8:11], s35 offen offset:2048 sc1
    v_mfma_f32_16x16x32_bf16 v[56:59], v[140:143], a[64:67], v[56:59]
    v_mfma_f32_16x16x32_bf16 v[60:63], v[140:143], a[68:71], v[60:63]
    s_mov_b32 s32, 0
    buffer_load_dwordx4 v[192:195], v229, s[16:19], s32 offen
    v_mfma_f32_16x16x32_bf16 v[88:91], v[140:143], a[72:75], v[88:91]
    v_mfma_f32_16x16x32_bf16 v[92:95], v[140:143], a[76:79], v[92:95]
    s_waitcnt lgkmcnt(0)
    v_mfma_f32_16x16x32_bf16 v[0:3], v[144:147], a[64:67], v[0:3]
    ds_read_b64_tr_b16 v[128:129], v216 offset:40960
    v_mfma_f32_16x16x32_bf16 v[4:7], v[144:147], a[68:71], v[4:7]
    ds_read_b64_tr_b16 v[130:131], v216 offset:43008
    v_mfma_f32_16x16x32_bf16 v[96:99], v[144:147], a[72:75], v[96:99]
    ds_read_b64_tr_b16 v[132:133], v217 offset:40960
    v_mfma_f32_16x16x32_bf16 v[100:103], v[144:147], a[76:79], v[100:103]
    ds_read_b64_tr_b16 v[134:135], v217 offset:43008
    v_mfma_f32_16x16x32_bf16 v[8:11], v[148:151], a[64:67], v[8:11]
    ds_read_b64_tr_b16 v[136:137], v218 offset:40960
    v_mfma_f32_16x16x32_bf16 v[12:15], v[148:151], a[68:71], v[12:15]
    ds_read_b64_tr_b16 v[138:139], v218 offset:43008
    v_mfma_f32_16x16x32_bf16 v[104:107], v[148:151], a[72:75], v[104:107]
    ds_read_b64_tr_b16 v[140:141], v219 offset:40960
    v_mfma_f32_16x16x32_bf16 v[108:111], v[148:151], a[76:79], v[108:111]
    ds_read_b64_tr_b16 v[142:143], v219 offset:43008
    v_mfma_f32_16x16x32_bf16 v[16:19], v[152:155], a[64:67], v[16:19]
    buffer_load_dwordx4 a[48:51], v226, s[8:11], s35 offen offset:3072 sc1
    v_mfma_f32_16x16x32_bf16 v[20:23], v[152:155], a[68:71], v[20:23]
    v_mfma_f32_16x16x32_bf16 v[112:115], v[152:155], a[72:75], v[112:115]
    v_mfma_f32_16x16x32_bf16 v[116:119], v[152:155], a[76:79], v[116:119]
    v_mfma_f32_16x16x32_bf16 v[24:27], v[156:159], a[64:67], v[24:27]
    buffer_load_dwordx4 a[52:55], v227, s[8:11], s35 offen offset:3072 sc1
    v_mfma_f32_16x16x32_bf16 v[28:31], v[156:159], a[68:71], v[28:31]
    s_mov_b32 s32, 16384
    buffer_load_dwordx4 v[196:199], v229, s[16:19], s32 offen
    v_mfma_f32_16x16x32_bf16 v[120:123], v[156:159], a[72:75], v[120:123]
    v_mfma_f32_16x16x32_bf16 v[124:127], v[156:159], a[76:79], v[124:127]
    buffer_load_dwordx4 a[56:59], v245, s[8:11], s35 offen offset:3072 sc1
    s_waitcnt vmcnt(38) lgkmcnt(0)
    v_mfma_f32_16x16x32_bf16 v[32:35], v[128:131], a[80:83], v[32:35]
    ds_read_b64_tr_b16 v[144:145], v220 offset:40960
    v_mfma_f32_16x16x32_bf16 v[36:39], v[128:131], a[84:87], v[36:39]
    ds_read_b64_tr_b16 v[146:147], v220 offset:43008
    v_mfma_f32_16x16x32_bf16 v[64:67], v[128:131], a[88:91], v[64:67]
    ds_read_b64_tr_b16 v[148:149], v221 offset:40960
    v_mfma_f32_16x16x32_bf16 v[68:71], v[128:131], a[92:95], v[68:71]
    ds_read_b64_tr_b16 v[150:151], v221 offset:43008
    v_mfma_f32_16x16x32_bf16 v[40:43], v[132:135], a[80:83], v[40:43]
    ds_read_b64_tr_b16 v[152:153], v222 offset:40960
    v_mfma_f32_16x16x32_bf16 v[44:47], v[132:135], a[84:87], v[44:47]
    ds_read_b64_tr_b16 v[154:155], v222 offset:43008
    v_mfma_f32_16x16x32_bf16 v[72:75], v[132:135], a[88:91], v[72:75]
    ds_read_b64_tr_b16 v[156:157], v223 offset:40960
    v_mfma_f32_16x16x32_bf16 v[76:79], v[132:135], a[92:95], v[76:79]
    ds_read_b64_tr_b16 v[158:159], v223 offset:43008
    v_mfma_f32_16x16x32_bf16 v[48:51], v[136:139], a[80:83], v[48:51]
    buffer_load_dwordx4 a[60:63], v246, s[8:11], s35 offen offset:3072 sc1
    v_mfma_f32_16x16x32_bf16 v[52:55], v[136:139], a[84:87], v[52:55]
    v_mfma_f32_16x16x32_bf16 v[80:83], v[136:139], a[88:91], v[80:83]
    v_mfma_f32_16x16x32_bf16 v[84:87], v[136:139], a[92:95], v[84:87]
    s_add_u32 s35, s35, 4096
    buffer_load_dwordx4 a[64:67], v226, s[8:11], s35 offen offset:0 sc1
    v_mfma_f32_16x16x32_bf16 v[56:59], v[140:143], a[80:83], v[56:59]
    v_mfma_f32_16x16x32_bf16 v[60:63], v[140:143], a[84:87], v[60:63]
    s_mov_b32 s32, 32768
    buffer_load_dwordx4 v[200:203], v229, s[16:19], s32 offen
    v_mfma_f32_16x16x32_bf16 v[88:91], v[140:143], a[88:91], v[88:91]
    v_mfma_f32_16x16x32_bf16 v[92:95], v[140:143], a[92:95], v[92:95]
    s_waitcnt lgkmcnt(0)
    v_mfma_f32_16x16x32_bf16 v[0:3], v[144:147], a[80:83], v[0:3]
    ds_read_b64_tr_b16 v[128:129], v216 offset:49152
    v_mfma_f32_16x16x32_bf16 v[4:7], v[144:147], a[84:87], v[4:7]
    ds_read_b64_tr_b16 v[130:131], v216 offset:51200
    v_mfma_f32_16x16x32_bf16 v[96:99], v[144:147], a[88:91], v[96:99]
    ds_read_b64_tr_b16 v[132:133], v217 offset:49152
    v_mfma_f32_16x16x32_bf16 v[100:103], v[144:147], a[92:95], v[100:103]
    ds_read_b64_tr_b16 v[134:135], v217 offset:51200
    v_mfma_f32_16x16x32_bf16 v[8:11], v[148:151], a[80:83], v[8:11]
    ds_read_b64_tr_b16 v[136:137], v218 offset:49152
    v_mfma_f32_16x16x32_bf16 v[12:15], v[148:151], a[84:87], v[12:15]
    ds_read_b64_tr_b16 v[138:139], v218 offset:51200
    v_mfma_f32_16x16x32_bf16 v[104:107], v[148:151], a[88:91], v[104:107]
    ds_read_b64_tr_b16 v[140:141], v219 offset:49152
    v_mfma_f32_16x16x32_bf16 v[108:111], v[148:151], a[92:95], v[108:111]
    ds_read_b64_tr_b16 v[142:143], v219 offset:51200
    v_mfma_f32_16x16x32_bf16 v[16:19], v[152:155], a[80:83], v[16:19]
    buffer_load_dwordx4 a[68:71], v227, s[8:11], s35 offen offset:0 sc1
    v_mfma_f32_16x16x32_bf16 v[20:23], v[152:155], a[84:87], v[20:23]
    v_mfma_f32_16x16x32_bf16 v[112:115], v[152:155], a[88:91], v[112:115]
    v_mfma_f32_16x16x32_bf16 v[116:119], v[152:155], a[92:95], v[116:119]
    v_mfma_f32_16x16x32_bf16 v[24:27], v[156:159], a[80:83], v[24:27]
    buffer_load_dwordx4 a[72:75], v245, s[8:11], s35 offen offset:0 sc1
    v_mfma_f32_16x16x32_bf16 v[28:31], v[156:159], a[84:87], v[28:31]
    s_mov_b32 s32, 49152
    buffer_load_dwordx4 v[204:207], v229, s[16:19], s32 offen
    v_mfma_f32_16x16x32_bf16 v[120:123], v[156:159], a[88:91], v[120:123]
    v_mfma_f32_16x16x32_bf16 v[124:127], v[156:159], a[92:95], v[124:127]
    s_waitcnt vmcnt(36) lgkmcnt(0)
    v_mfma_f32_16x16x32_bf16 v[32:35], v[128:131], a[96:99], v[32:35]
    ds_read_b64_tr_b16 v[144:145], v220 offset:49152
    v_mfma_f32_16x16x32_bf16 v[36:39], v[128:131], a[100:103], v[36:39]
    ds_read_b64_tr_b16 v[146:147], v220 offset:51200
    v_mfma_f32_16x16x32_bf16 v[64:67], v[128:131], a[104:107], v[64:67]
    ds_read_b64_tr_b16 v[148:149], v221 offset:49152
    v_mfma_f32_16x16x32_bf16 v[68:71], v[128:131], a[108:111], v[68:71]
    ds_read_b64_tr_b16 v[150:151], v221 offset:51200
    v_mfma_f32_16x16x32_bf16 v[40:43], v[132:135], a[96:99], v[40:43]
    ds_read_b64_tr_b16 v[152:153], v222 offset:49152
    v_mfma_f32_16x16x32_bf16 v[44:47], v[132:135], a[100:103], v[44:47]
    ds_read_b64_tr_b16 v[154:155], v222 offset:51200
    v_mfma_f32_16x16x32_bf16 v[72:75], v[132:135], a[104:107], v[72:75]
    ds_read_b64_tr_b16 v[156:157], v223 offset:49152
    v_mfma_f32_16x16x32_bf16 v[76:79], v[132:135], a[108:111], v[76:79]
    ds_read_b64_tr_b16 v[158:159], v223 offset:51200
    v_mfma_f32_16x16x32_bf16 v[48:51], v[136:139], a[96:99], v[48:51]
    buffer_load_dwordx4 a[76:79], v246, s[8:11], s35 offen offset:0 sc1
    v_mfma_f32_16x16x32_bf16 v[52:55], v[136:139], a[100:103], v[52:55]
    v_mfma_f32_16x16x32_bf16 v[80:83], v[136:139], a[104:107], v[80:83]
    v_mfma_f32_16x16x32_bf16 v[84:87], v[136:139], a[108:111], v[84:87]
    buffer_load_dwordx4 a[80:83], v226, s[8:11], s35 offen offset:1024 sc1
    v_mfma_f32_16x16x32_bf16 v[56:59], v[140:143], a[96:99], v[56:59]
    v_mfma_f32_16x16x32_bf16 v[60:63], v[140:143], a[100:103], v[60:63]
    buffer_load_dwordx4 v[208:211], v240, s[20:23], 0 offen
    v_mfma_f32_16x16x32_bf16 v[88:91], v[140:143], a[104:107], v[88:91]
    v_mfma_f32_16x16x32_bf16 v[92:95], v[140:143], a[108:111], v[92:95]
    s_waitcnt lgkmcnt(0)
    v_mfma_f32_16x16x32_bf16 v[0:3], v[144:147], a[96:99], v[0:3]
    ds_read_b64_tr_b16 v[128:129], v216 offset:57344
    v_mfma_f32_16x16x32_bf16 v[4:7], v[144:147], a[100:103], v[4:7]
    ds_read_b64_tr_b16 v[130:131], v216 offset:59392
    v_mfma_f32_16x16x32_bf16 v[96:99], v[144:147], a[104:107], v[96:99]
    ds_read_b64_tr_b16 v[132:133], v217 offset:57344
    v_mfma_f32_16x16x32_bf16 v[100:103], v[144:147], a[108:111], v[100:103]
    ds_read_b64_tr_b16 v[134:135], v217 offset:59392
    v_mfma_f32_16x16x32_bf16 v[8:11], v[148:151], a[96:99], v[8:11]
    ds_read_b64_tr_b16 v[136:137], v218 offset:57344
    v_mfma_f32_16x16x32_bf16 v[12:15], v[148:151], a[100:103], v[12:15]
    ds_read_b64_tr_b16 v[138:139], v218 offset:59392
    v_mfma_f32_16x16x32_bf16 v[104:107], v[148:151], a[104:107], v[104:107]
    ds_read_b64_tr_b16 v[140:141], v219 offset:57344
    v_mfma_f32_16x16x32_bf16 v[108:111], v[148:151], a[108:111], v[108:111]
    ds_read_b64_tr_b16 v[142:143], v219 offset:59392
    v_mfma_f32_16x16x32_bf16 v[16:19], v[152:155], a[96:99], v[16:19]
    buffer_load_dwordx4 a[84:87], v227, s[8:11], s35 offen offset:1024 sc1
    v_mfma_f32_16x16x32_bf16 v[20:23], v[152:155], a[100:103], v[20:23]
    v_mfma_f32_16x16x32_bf16 v[112:115], v[152:155], a[104:107], v[112:115]
    v_mfma_f32_16x16x32_bf16 v[116:119], v[152:155], a[108:111], v[116:119]
    v_mfma_f32_16x16x32_bf16 v[24:27], v[156:159], a[96:99], v[24:27]
    buffer_load_dwordx4 a[88:91], v245, s[8:11], s35 offen offset:1024 sc1
    v_mfma_f32_16x16x32_bf16 v[28:31], v[156:159], a[100:103], v[28:31]
    s_mov_b32 s32, kc_tail-kc_pc0
    v_lshlrev_b32 v234, 7, v230
    buffer_load_dword v241, v234, s[56:59], s32 offen
    v_mfma_f32_16x16x32_bf16 v[120:123], v[156:159], a[104:107], v[120:123]
    v_mfma_f32_16x16x32_bf16 v[124:127], v[156:159], a[108:111], v[124:127]
    buffer_load_dwordx4 a[92:95], v246, s[8:11], s35 offen offset:1024 sc1
    s_waitcnt vmcnt(35) lgkmcnt(0)
    v_mfma_f32_16x16x32_bf16 v[32:35], v[128:131], a[112:115], v[32:35]
    ds_read_b64_tr_b16 v[144:145], v220 offset:57344
    v_mfma_f32_16x16x32_bf16 v[36:39], v[128:131], a[116:119], v[36:39]
    ds_read_b64_tr_b16 v[146:147], v220 offset:59392
    v_mfma_f32_16x16x32_bf16 v[64:67], v[128:131], a[120:123], v[64:67]
    ds_read_b64_tr_b16 v[148:149], v221 offset:57344
    v_mfma_f32_16x16x32_bf16 v[68:71], v[128:131], a[124:127], v[68:71]
    ds_read_b64_tr_b16 v[150:151], v221 offset:59392
    v_mfma_f32_16x16x32_bf16 v[40:43], v[132:135], a[112:115], v[40:43]
    ds_read_b64_tr_b16 v[152:153], v222 offset:57344
    v_mfma_f32_16x16x32_bf16 v[44:47], v[132:135], a[116:119], v[44:47]
    ds_read_b64_tr_b16 v[154:155], v222 offset:59392
    v_mfma_f32_16x16x32_bf16 v[72:75], v[132:135], a[120:123], v[72:75]
    ds_read_b64_tr_b16 v[156:157], v223 offset:57344
    v_mfma_f32_16x16x32_bf16 v[76:79], v[132:135], a[124:127], v[76:79]
    ds_read_b64_tr_b16 v[158:159], v223 offset:59392
    v_mfma_f32_16x16x32_bf16 v[48:51], v[136:139], a[112:115], v[48:51]
    buffer_load_dwordx4 a[96:99], v226, s[8:11], s35 offen offset:2048 sc1
    v_mfma_f32_16x16x32_bf16 v[52:55], v[136:139], a[116:119], v[52:55]
    v_mfma_f32_16x16x32_bf16 v[80:83], v[136:139], a[120:123], v[80:83]
    v_mfma_f32_16x16x32_bf16 v[84:87], v[136:139], a[124:127], v[84:87]
    buffer_load_dwordx4 a[100:103], v227, s[8:11], s35 offen offset:2048 sc1
    v_mfma_f32_16x16x32_bf16 v[56:59], v[140:143], a[112:115], v[56:59]
    v_mfma_f32_16x16x32_bf16 v[60:63], v[140:143], a[116:119], v[60:63]
    v_mfma_f32_16x16x32_bf16 v[88:91], v[140:143], a[120:123], v[88:91]
    v_mfma_f32_16x16x32_bf16 v[92:95], v[140:143], a[124:127], v[92:95]
    s_waitcnt vmcnt(24) lgkmcnt(0)
    s_barrier
    v_mfma_f32_16x16x32_bf16 v[0:3], v[144:147], a[112:115], v[0:3]
    v_xor_b32 v220, 0x10000, v220
    ds_read_b64_tr_b16 v[128:129], v220 offset:0
    v_mfma_f32_16x16x32_bf16 v[4:7], v[144:147], a[116:119], v[4:7]
    ds_read_b64_tr_b16 v[130:131], v220 offset:2048
    v_mfma_f32_16x16x32_bf16 v[96:99], v[144:147], a[120:123], v[96:99]
    v_xor_b32 v221, 0x10000, v221
    ds_read_b64_tr_b16 v[132:133], v221 offset:0
    v_mfma_f32_16x16x32_bf16 v[100:103], v[144:147], a[124:127], v[100:103]
    ds_read_b64_tr_b16 v[134:135], v221 offset:2048
    v_mfma_f32_16x16x32_bf16 v[8:11], v[148:151], a[112:115], v[8:11]
    v_xor_b32 v222, 0x10000, v222
    ds_read_b64_tr_b16 v[136:137], v222 offset:0
    v_mfma_f32_16x16x32_bf16 v[12:15], v[148:151], a[116:119], v[12:15]
    ds_read_b64_tr_b16 v[138:139], v222 offset:2048
    v_mfma_f32_16x16x32_bf16 v[104:107], v[148:151], a[120:123], v[104:107]
    v_xor_b32 v223, 0x10000, v223
    ds_read_b64_tr_b16 v[140:141], v223 offset:0
    v_mfma_f32_16x16x32_bf16 v[108:111], v[148:151], a[124:127], v[108:111]
    ds_read_b64_tr_b16 v[142:143], v223 offset:2048
    v_mfma_f32_16x16x32_bf16 v[16:19], v[152:155], a[112:115], v[16:19]
    buffer_load_dwordx4 a[104:107], v245, s[8:11], s35 offen offset:2048 sc1
    v_mfma_f32_16x16x32_bf16 v[20:23], v[152:155], a[116:119], v[20:23]
    v_xor_b32 v216, 0x10000, v216
    v_mfma_f32_16x16x32_bf16 v[112:115], v[152:155], a[120:123], v[112:115]
    v_xor_b32 v217, 0x10000, v217
    v_mfma_f32_16x16x32_bf16 v[116:119], v[152:155], a[124:127], v[116:119]
    v_xor_b32 v218, 0x10000, v218
    v_mfma_f32_16x16x32_bf16 v[24:27], v[156:159], a[112:115], v[24:27]
    v_xor_b32 v219, 0x10000, v219
    buffer_load_dwordx4 a[108:111], v246, s[8:11], s35 offen offset:2048 sc1
    v_mfma_f32_16x16x32_bf16 v[28:31], v[156:159], a[116:119], v[28:31]
    v_mfma_f32_16x16x32_bf16 v[120:123], v[156:159], a[120:123], v[120:123]
    v_mfma_f32_16x16x32_bf16 v[124:127], v[156:159], a[124:127], v[124:127]
    s_waitcnt vmcnt(32) lgkmcnt(4)
    v_mfma_f32_16x16x32_bf16 v[96:99], v[128:131], a[8:11], v[96:99]
    ds_read_b64_tr_b16 v[144:145], v220 offset:8192
    v_mfma_f32_16x16x32_bf16 v[100:103], v[128:131], a[12:15], v[100:103]
    ds_read_b64_tr_b16 v[146:147], v220 offset:10240
    v_mfma_f32_16x16x32_bf16 v[104:107], v[132:135], a[8:11], v[104:107]
    ds_read_b64_tr_b16 v[148:149], v221 offset:8192
    buffer_load_dwordx4 a[112:115], v226, s[8:11], s35 offen offset:3072 sc1
    v_mfma_f32_16x16x32_bf16 v[108:111], v[132:135], a[12:15], v[108:111]
    ds_read_b64_tr_b16 v[150:151], v221 offset:10240
    s_waitcnt lgkmcnt(4)
    v_mfma_f32_16x16x32_bf16 v[112:115], v[136:139], a[8:11], v[112:115]
    ds_read_b64_tr_b16 v[152:153], v222 offset:8192
    v_mfma_f32_16x16x32_bf16 v[116:119], v[136:139], a[12:15], v[116:119]
    ds_read_b64_tr_b16 v[154:155], v222 offset:10240
    v_mfma_f32_16x16x32_bf16 v[120:123], v[140:143], a[8:11], v[120:123]
    ds_read_b64_tr_b16 v[156:157], v223 offset:8192
    buffer_load_dwordx4 a[116:119], v227, s[8:11], s35 offen offset:3072 sc1
    v_mfma_f32_16x16x32_bf16 v[124:127], v[140:143], a[12:15], v[124:127]
    ds_read_b64_tr_b16 v[158:159], v223 offset:10240
    s_waitcnt vmcnt(29) lgkmcnt(4)
    v_mfma_f32_16x16x32_bf16 v[96:99], v[144:147], a[24:27], v[96:99]
    ds_read_b64_tr_b16 v[128:129], v220 offset:16384
    v_mfma_f32_16x16x32_bf16 v[100:103], v[144:147], a[28:31], v[100:103]
    ds_read_b64_tr_b16 v[130:131], v220 offset:18432
    v_mfma_f32_16x16x32_bf16 v[104:107], v[148:151], a[24:27], v[104:107]
    ds_read_b64_tr_b16 v[132:133], v221 offset:16384
    buffer_load_dwordx4 a[120:123], v245, s[8:11], s35 offen offset:3072 sc1
    v_mfma_f32_16x16x32_bf16 v[108:111], v[148:151], a[28:31], v[108:111]
    ds_read_b64_tr_b16 v[134:135], v221 offset:18432
    s_waitcnt lgkmcnt(4)
    v_mfma_f32_16x16x32_bf16 v[112:115], v[152:155], a[24:27], v[112:115]
    ds_read_b64_tr_b16 v[136:137], v222 offset:16384
    v_mfma_f32_16x16x32_bf16 v[116:119], v[152:155], a[28:31], v[116:119]
    ds_read_b64_tr_b16 v[138:139], v222 offset:18432
    v_mfma_f32_16x16x32_bf16 v[120:123], v[156:159], a[24:27], v[120:123]
    ds_read_b64_tr_b16 v[140:141], v223 offset:16384
    buffer_load_dwordx4 a[124:127], v246, s[8:11], s35 offen offset:3072 sc1
    v_mfma_f32_16x16x32_bf16 v[124:127], v[156:159], a[28:31], v[124:127]
    ds_read_b64_tr_b16 v[142:143], v223 offset:18432
    s_waitcnt vmcnt(26) lgkmcnt(4)
    v_mfma_f32_16x16x32_bf16 v[96:99], v[128:131], a[40:43], v[96:99]
    ds_read_b64_tr_b16 v[144:145], v220 offset:24576
    v_mfma_f32_16x16x32_bf16 v[100:103], v[128:131], a[44:47], v[100:103]
    ds_read_b64_tr_b16 v[146:147], v220 offset:26624
    v_mfma_f32_16x16x32_bf16 v[104:107], v[132:135], a[40:43], v[104:107]
    ds_read_b64_tr_b16 v[148:149], v221 offset:24576
    v_mfma_f32_16x16x32_bf16 v[108:111], v[132:135], a[44:47], v[108:111]
    ds_read_b64_tr_b16 v[150:151], v221 offset:26624
    s_waitcnt lgkmcnt(4)
    v_mfma_f32_16x16x32_bf16 v[112:115], v[136:139], a[40:43], v[112:115]
    ds_read_b64_tr_b16 v[152:153], v222 offset:24576
    v_mfma_f32_16x16x32_bf16 v[116:119], v[136:139], a[44:47], v[116:119]
    ds_read_b64_tr_b16 v[154:155], v222 offset:26624
    v_mfma_f32_16x16x32_bf16 v[120:123], v[140:143], a[40:43], v[120:123]
    ds_read_b64_tr_b16 v[156:157], v223 offset:24576
    v_mfma_f32_16x16x32_bf16 v[124:127], v[140:143], a[44:47], v[124:127]
    ds_read_b64_tr_b16 v[158:159], v223 offset:26624
    s_waitcnt vmcnt(20) lgkmcnt(4)
    v_mfma_f32_16x16x32_bf16 v[96:99], v[144:147], a[56:59], v[96:99]
    ds_read_b64_tr_b16 v[128:129], v220 offset:32768
    v_mfma_f32_16x16x32_bf16 v[100:103], v[144:147], a[60:63], v[100:103]
    ds_read_b64_tr_b16 v[130:131], v220 offset:34816
    v_mfma_f32_16x16x32_bf16 v[104:107], v[148:151], a[56:59], v[104:107]
    ds_read_b64_tr_b16 v[132:133], v221 offset:32768
    v_mfma_f32_16x16x32_bf16 v[108:111], v[148:151], a[60:63], v[108:111]
    ds_read_b64_tr_b16 v[134:135], v221 offset:34816
    s_waitcnt lgkmcnt(4)
    v_mfma_f32_16x16x32_bf16 v[112:115], v[152:155], a[56:59], v[112:115]
    ds_read_b64_tr_b16 v[136:137], v222 offset:32768
    v_mfma_f32_16x16x32_bf16 v[116:119], v[152:155], a[60:63], v[116:119]
    ds_read_b64_tr_b16 v[138:139], v222 offset:34816
    v_mfma_f32_16x16x32_bf16 v[120:123], v[156:159], a[56:59], v[120:123]
    ds_read_b64_tr_b16 v[140:141], v223 offset:32768
    v_mfma_f32_16x16x32_bf16 v[124:127], v[156:159], a[60:63], v[124:127]
    ds_read_b64_tr_b16 v[142:143], v223 offset:34816
    s_waitcnt vmcnt(14) lgkmcnt(4)
    v_mfma_f32_16x16x32_bf16 v[96:99], v[128:131], a[72:75], v[96:99]
    ds_read_b64_tr_b16 v[144:145], v220 offset:40960
    v_mfma_f32_16x16x32_bf16 v[100:103], v[128:131], a[76:79], v[100:103]
    ds_read_b64_tr_b16 v[146:147], v220 offset:43008
    s_xor_b32 s7, s39, 24
    v_mfma_f32_16x16x32_bf16 v[104:107], v[132:135], a[72:75], v[104:107]
    ds_read_b64_tr_b16 v[148:149], v221 offset:40960
    v_mfma_f32_16x16x32_bf16 v[108:111], v[132:135], a[76:79], v[108:111]
    ds_read_b64_tr_b16 v[150:151], v221 offset:43008
    s_waitcnt lgkmcnt(4)
    v_mfma_f32_16x16x32_bf16 v[112:115], v[136:139], a[72:75], v[112:115]
    ds_read_b64_tr_b16 v[152:153], v222 offset:40960
    v_mfma_f32_16x16x32_bf16 v[116:119], v[136:139], a[76:79], v[116:119]
    ds_read_b64_tr_b16 v[154:155], v222 offset:43008
    s_mul_i32 s7, s7, 12288
    v_mfma_f32_16x16x32_bf16 v[120:123], v[140:143], a[72:75], v[120:123]
    ds_read_b64_tr_b16 v[156:157], v223 offset:40960
    s_add_u32 s7, s7, 0x5002000
    v_mfma_f32_16x16x32_bf16 v[124:127], v[140:143], a[76:79], v[124:127]
    ds_read_b64_tr_b16 v[158:159], v223 offset:43008
    s_waitcnt vmcnt(8) lgkmcnt(4)
    v_mfma_f32_16x16x32_bf16 v[96:99], v[144:147], a[88:91], v[96:99]
    ds_read_b64_tr_b16 v[128:129], v220 offset:49152
    v_mfma_f32_16x16x32_bf16 v[100:103], v[144:147], a[92:95], v[100:103]
    ds_read_b64_tr_b16 v[130:131], v220 offset:51200
    s_xor_b32 s37, s39, 8
    v_mfma_f32_16x16x32_bf16 v[104:107], v[148:151], a[88:91], v[104:107]
    ds_read_b64_tr_b16 v[132:133], v221 offset:49152
    v_mfma_f32_16x16x32_bf16 v[108:111], v[148:151], a[92:95], v[108:111]
    ds_read_b64_tr_b16 v[134:135], v221 offset:51200
    s_waitcnt lgkmcnt(4)
    v_mfma_f32_16x16x32_bf16 v[112:115], v[152:155], a[88:91], v[112:115]
    ds_read_b64_tr_b16 v[136:137], v222 offset:49152
    v_mfma_f32_16x16x32_bf16 v[116:119], v[152:155], a[92:95], v[116:119]
    ds_read_b64_tr_b16 v[138:139], v222 offset:51200
    s_mul_i32 s37, s37, 12288
    v_mfma_f32_16x16x32_bf16 v[120:123], v[156:159], a[88:91], v[120:123]
    ds_read_b64_tr_b16 v[140:141], v223 offset:49152
    s_add_u32 s37, s37, 0x5000000
    v_mfma_f32_16x16x32_bf16 v[124:127], v[156:159], a[92:95], v[124:127]
    ds_read_b64_tr_b16 v[142:143], v223 offset:51200
    s_waitcnt vmcnt(4) lgkmcnt(4)
    v_mfma_f32_16x16x32_bf16 v[96:99], v[128:131], a[104:107], v[96:99]
    ds_read_b64_tr_b16 v[144:145], v220 offset:57344
    v_mfma_f32_16x16x32_bf16 v[100:103], v[128:131], a[108:111], v[100:103]
    ds_read_b64_tr_b16 v[146:147], v220 offset:59392
    s_xor_b32 s38, s39, 16
    v_mfma_f32_16x16x32_bf16 v[104:107], v[132:135], a[104:107], v[104:107]
    ds_read_b64_tr_b16 v[148:149], v221 offset:57344
    v_mfma_f32_16x16x32_bf16 v[108:111], v[132:135], a[108:111], v[108:111]
    ds_read_b64_tr_b16 v[150:151], v221 offset:59392
    s_waitcnt lgkmcnt(4)
    v_mfma_f32_16x16x32_bf16 v[112:115], v[136:139], a[104:107], v[112:115]
    ds_read_b64_tr_b16 v[152:153], v222 offset:57344
    v_mfma_f32_16x16x32_bf16 v[116:119], v[136:139], a[108:111], v[116:119]
    ds_read_b64_tr_b16 v[154:155], v222 offset:59392
    s_mul_i32 s38, s38, 12288
    v_mfma_f32_16x16x32_bf16 v[120:123], v[140:143], a[104:107], v[120:123]
    ds_read_b64_tr_b16 v[156:157], v223 offset:57344
    s_add_u32 s38, s38, 0x5001000
    v_mfma_f32_16x16x32_bf16 v[124:127], v[140:143], a[108:111], v[124:127]
    ds_read_b64_tr_b16 v[158:159], v223 offset:59392
    s_waitcnt vmcnt(0) lgkmcnt(4)
    v_mfma_f32_16x16x32_bf16 v[96:99], v[144:147], a[120:123], v[96:99]
    ds_read_b64_tr_b16 v[128:129], v220 offset:0
    v_mfma_f32_16x16x32_bf16 v[100:103], v[144:147], a[124:127], v[100:103]
    ds_read_b64_tr_b16 v[130:131], v220 offset:2048
    v_mfma_f32_16x16x32_bf16 v[104:107], v[148:151], a[120:123], v[104:107]
    ds_read_b64_tr_b16 v[132:133], v221 offset:0
    v_mfma_f32_16x16x32_bf16 v[108:111], v[148:151], a[124:127], v[108:111]
    ds_read_b64_tr_b16 v[134:135], v221 offset:2048
    s_waitcnt lgkmcnt(4)
    v_mfma_f32_16x16x32_bf16 v[112:115], v[152:155], a[120:123], v[112:115]
    ds_read_b64_tr_b16 v[136:137], v222 offset:0
    v_mfma_f32_16x16x32_bf16 v[116:119], v[152:155], a[124:127], v[116:119]
    ds_read_b64_tr_b16 v[138:139], v222 offset:2048
    v_mfma_f32_16x16x32_bf16 v[120:123], v[156:159], a[120:123], v[120:123]
    ds_read_b64_tr_b16 v[140:141], v223 offset:0
    v_mfma_f32_16x16x32_bf16 v[124:127], v[156:159], a[124:127], v[124:127]
    ds_read_b64_tr_b16 v[142:143], v223 offset:2048
    s_waitcnt lgkmcnt(4)
    v_mfma_f32_16x16x32_bf16 v[0:3], v[128:131], a[0:3], v[0:3]
    ds_read_b64_tr_b16 v[144:145], v220 offset:8192
    v_mfma_f32_16x16x32_bf16 v[4:7], v[128:131], a[4:7], v[4:7]
    ds_read_b64_tr_b16 v[146:147], v220 offset:10240
    v_mfma_f32_16x16x32_bf16 v[8:11], v[132:135], a[0:3], v[8:11]
    ds_read_b64_tr_b16 v[148:149], v221 offset:8192
    v_mfma_f32_16x16x32_bf16 v[12:15], v[132:135], a[4:7], v[12:15]
    ds_read_b64_tr_b16 v[150:151], v221 offset:10240
    s_waitcnt lgkmcnt(4)
    v_mfma_f32_16x16x32_bf16 v[16:19], v[136:139], a[0:3], v[16:19]
    ds_read_b64_tr_b16 v[152:153], v222 offset:8192
    v_mfma_f32_16x16x32_bf16 v[20:23], v[136:139], a[4:7], v[20:23]
    ds_read_b64_tr_b16 v[154:155], v222 offset:10240
    v_mfma_f32_16x16x32_bf16 v[24:27], v[140:143], a[0:3], v[24:27]
    ds_read_b64_tr_b16 v[156:157], v223 offset:8192
    v_mfma_f32_16x16x32_bf16 v[28:31], v[140:143], a[4:7], v[28:31]
    ds_read_b64_tr_b16 v[158:159], v223 offset:10240
    s_waitcnt lgkmcnt(4)
    v_mfma_f32_16x16x32_bf16 v[0:3], v[144:147], a[16:19], v[0:3]
    ds_read_b64_tr_b16 v[128:129], v220 offset:16384
    s_mul_i32 s33, s39, 12288
    s_add_u32 s33, s33, 0x5002000
    v_mfma_f32_16x16x32_bf16 v[4:7], v[144:147], a[20:23], v[4:7]
    ds_read_b64_tr_b16 v[130:131], v220 offset:18432
    v_mfma_f32_16x16x32_bf16 v[8:11], v[148:151], a[16:19], v[8:11]
    ds_read_b64_tr_b16 v[132:133], v221 offset:16384
    v_cvt_pk_bf16_f32 v96, v96, v97
    v_mfma_f32_16x16x32_bf16 v[12:15], v[148:151], a[20:23], v[12:15]
    ds_read_b64_tr_b16 v[134:135], v221 offset:18432
    v_cvt_pk_bf16_f32 v97, v98, v99
    s_waitcnt lgkmcnt(4)
    v_mfma_f32_16x16x32_bf16 v[16:19], v[152:155], a[16:19], v[16:19]
    ds_read_b64_tr_b16 v[136:137], v222 offset:16384
    v_cvt_pk_bf16_f32 v98, v100, v101
    v_mfma_f32_16x16x32_bf16 v[20:23], v[152:155], a[20:23], v[20:23]
    ds_read_b64_tr_b16 v[138:139], v222 offset:18432
    v_cvt_pk_bf16_f32 v99, v102, v103
    v_mfma_f32_16x16x32_bf16 v[24:27], v[156:159], a[16:19], v[24:27]
    ds_read_b64_tr_b16 v[140:141], v223 offset:16384
    v_min_u32 v96, -2, v96
    v_mfma_f32_16x16x32_bf16 v[28:31], v[156:159], a[20:23], v[28:31]
    ds_read_b64_tr_b16 v[142:143], v223 offset:18432
    v_min_u32 v97, -2, v97
    s_waitcnt lgkmcnt(4)
    v_mfma_f32_16x16x32_bf16 v[0:3], v[128:131], a[32:35], v[0:3]
    ds_read_b64_tr_b16 v[144:145], v220 offset:24576
    v_min_u32 v98, -2, v98
    v_mfma_f32_16x16x32_bf16 v[4:7], v[128:131], a[36:39], v[4:7]
    ds_read_b64_tr_b16 v[146:147], v220 offset:26624
    v_min_u32 v99, -2, v99
    v_mfma_f32_16x16x32_bf16 v[8:11], v[132:135], a[32:35], v[8:11]
    ds_read_b64_tr_b16 v[148:149], v221 offset:24576
    buffer_store_dwordx4 v[96:99], v228, s[8:11], s33 offen offset:0 sc1
    v_mfma_f32_16x16x32_bf16 v[12:15], v[132:135], a[36:39], v[12:15]
    ds_read_b64_tr_b16 v[150:151], v221 offset:26624
    s_waitcnt lgkmcnt(4)
    v_mfma_f32_16x16x32_bf16 v[16:19], v[136:139], a[32:35], v[16:19]
    ds_read_b64_tr_b16 v[152:153], v222 offset:24576
    v_mfma_f32_16x16x32_bf16 v[20:23], v[136:139], a[36:39], v[20:23]
    ds_read_b64_tr_b16 v[154:155], v222 offset:26624
    v_mfma_f32_16x16x32_bf16 v[24:27], v[140:143], a[32:35], v[24:27]
    ds_read_b64_tr_b16 v[156:157], v223 offset:24576
    v_cvt_pk_bf16_f32 v100, v104, v105
    v_mfma_f32_16x16x32_bf16 v[28:31], v[140:143], a[36:39], v[28:31]
    ds_read_b64_tr_b16 v[158:159], v223 offset:26624
    v_cvt_pk_bf16_f32 v101, v106, v107
    s_waitcnt lgkmcnt(4)
    v_mfma_f32_16x16x32_bf16 v[0:3], v[144:147], a[48:51], v[0:3]
    ds_read_b64_tr_b16 v[128:129], v220 offset:32768
    v_cvt_pk_bf16_f32 v102, v108, v109
    v_mfma_f32_16x16x32_bf16 v[4:7], v[144:147], a[52:55], v[4:7]
    ds_read_b64_tr_b16 v[130:131], v220 offset:34816
    v_cvt_pk_bf16_f32 v103, v110, v111
    v_mfma_f32_16x16x32_bf16 v[8:11], v[148:151], a[48:51], v[8:11]
    ds_read_b64_tr_b16 v[132:133], v221 offset:32768
    v_min_u32 v100, -2, v100
    v_mfma_f32_16x16x32_bf16 v[12:15], v[148:151], a[52:55], v[12:15]
    ds_read_b64_tr_b16 v[134:135], v221 offset:34816
    v_min_u32 v101, -2, v101
    s_waitcnt lgkmcnt(4)
    v_mfma_f32_16x16x32_bf16 v[16:19], v[152:155], a[48:51], v[16:19]
    ds_read_b64_tr_b16 v[136:137], v222 offset:32768
    v_min_u32 v102, -2, v102
    v_mfma_f32_16x16x32_bf16 v[20:23], v[152:155], a[52:55], v[20:23]
    ds_read_b64_tr_b16 v[138:139], v222 offset:34816
    v_min_u32 v103, -2, v103
    v_mfma_f32_16x16x32_bf16 v[24:27], v[156:159], a[48:51], v[24:27]
    ds_read_b64_tr_b16 v[140:141], v223 offset:32768
    buffer_store_dwordx4 v[100:103], v228, s[8:11], s33 offen offset:1024 sc1
    v_mfma_f32_16x16x32_bf16 v[28:31], v[156:159], a[52:55], v[28:31]
    ds_read_b64_tr_b16 v[142:143], v223 offset:34816
    s_waitcnt lgkmcnt(4)
    v_mfma_f32_16x16x32_bf16 v[0:3], v[128:131], a[64:67], v[0:3]
    ds_read_b64_tr_b16 v[144:145], v220 offset:40960
    v_mfma_f32_16x16x32_bf16 v[4:7], v[128:131], a[68:71], v[4:7]
    ds_read_b64_tr_b16 v[146:147], v220 offset:43008
    v_mfma_f32_16x16x32_bf16 v[8:11], v[132:135], a[64:67], v[8:11]
    ds_read_b64_tr_b16 v[148:149], v221 offset:40960
    v_cvt_pk_bf16_f32 v104, v112, v113
    v_mfma_f32_16x16x32_bf16 v[12:15], v[132:135], a[68:71], v[12:15]
    ds_read_b64_tr_b16 v[150:151], v221 offset:43008
    v_cvt_pk_bf16_f32 v105, v114, v115
    s_waitcnt lgkmcnt(4)
    v_mfma_f32_16x16x32_bf16 v[16:19], v[136:139], a[64:67], v[16:19]
    ds_read_b64_tr_b16 v[152:153], v222 offset:40960
    v_cvt_pk_bf16_f32 v106, v116, v117
    v_mfma_f32_16x16x32_bf16 v[20:23], v[136:139], a[68:71], v[20:23]
    ds_read_b64_tr_b16 v[154:155], v222 offset:43008
    v_cvt_pk_bf16_f32 v107, v118, v119
    v_mfma_f32_16x16x32_bf16 v[24:27], v[140:143], a[64:67], v[24:27]
    ds_read_b64_tr_b16 v[156:157], v223 offset:40960
    v_min_u32 v104, -2, v104
    v_mfma_f32_16x16x32_bf16 v[28:31], v[140:143], a[68:71], v[28:31]
    ds_read_b64_tr_b16 v[158:159], v223 offset:43008
    v_min_u32 v105, -2, v105
    s_waitcnt lgkmcnt(4)
    v_mfma_f32_16x16x32_bf16 v[0:3], v[144:147], a[80:83], v[0:3]
    ds_read_b64_tr_b16 v[128:129], v220 offset:49152
    v_min_u32 v106, -2, v106
    v_mfma_f32_16x16x32_bf16 v[4:7], v[144:147], a[84:87], v[4:7]
    ds_read_b64_tr_b16 v[130:131], v220 offset:51200
    v_min_u32 v107, -2, v107
    v_mfma_f32_16x16x32_bf16 v[8:11], v[148:151], a[80:83], v[8:11]
    ds_read_b64_tr_b16 v[132:133], v221 offset:49152
    buffer_store_dwordx4 v[104:107], v228, s[8:11], s33 offen offset:2048 sc1
    v_mfma_f32_16x16x32_bf16 v[12:15], v[148:151], a[84:87], v[12:15]
    ds_read_b64_tr_b16 v[134:135], v221 offset:51200
    s_waitcnt lgkmcnt(4)
    v_mfma_f32_16x16x32_bf16 v[16:19], v[152:155], a[80:83], v[16:19]
    ds_read_b64_tr_b16 v[136:137], v222 offset:49152
    v_mfma_f32_16x16x32_bf16 v[20:23], v[152:155], a[84:87], v[20:23]
    ds_read_b64_tr_b16 v[138:139], v222 offset:51200
    v_mfma_f32_16x16x32_bf16 v[24:27], v[156:159], a[80:83], v[24:27]
    ds_read_b64_tr_b16 v[140:141], v223 offset:49152
    v_cvt_pk_bf16_f32 v108, v120, v121
    v_mfma_f32_16x16x32_bf16 v[28:31], v[156:159], a[84:87], v[28:31]
    ds_read_b64_tr_b16 v[142:143], v223 offset:51200
    v_cvt_pk_bf16_f32 v109, v122, v123
    s_waitcnt lgkmcnt(4)
    v_mfma_f32_16x16x32_bf16 v[0:3], v[128:131], a[96:99], v[0:3]
    ds_read_b64_tr_b16 v[144:145], v220 offset:57344
    v_cvt_pk_bf16_f32 v110, v124, v125
    v_mfma_f32_16x16x32_bf16 v[4:7], v[128:131], a[100:103], v[4:7]
    ds_read_b64_tr_b16 v[146:147], v220 offset:59392
    v_cvt_pk_bf16_f32 v111, v126, v127
    v_mfma_f32_16x16x32_bf16 v[8:11], v[132:135], a[96:99], v[8:11]
    ds_read_b64_tr_b16 v[148:149], v221 offset:57344
    v_min_u32 v108, -2, v108
    v_mfma_f32_16x16x32_bf16 v[12:15], v[132:135], a[100:103], v[12:15]
    ds_read_b64_tr_b16 v[150:151], v221 offset:59392
    v_min_u32 v109, -2, v109
    s_waitcnt lgkmcnt(4)
    v_mfma_f32_16x16x32_bf16 v[16:19], v[136:139], a[96:99], v[16:19]
    ds_read_b64_tr_b16 v[152:153], v222 offset:57344
    v_min_u32 v110, -2, v110
    v_mfma_f32_16x16x32_bf16 v[20:23], v[136:139], a[100:103], v[20:23]
    ds_read_b64_tr_b16 v[154:155], v222 offset:59392
    v_min_u32 v111, -2, v111
    v_mfma_f32_16x16x32_bf16 v[24:27], v[140:143], a[96:99], v[24:27]
    ds_read_b64_tr_b16 v[156:157], v223 offset:57344
    buffer_store_dwordx4 v[108:111], v228, s[8:11], s33 offen offset:3072 sc1
    v_mfma_f32_16x16x32_bf16 v[28:31], v[140:143], a[100:103], v[28:31]
    ds_read_b64_tr_b16 v[158:159], v223 offset:59392
    s_waitcnt lgkmcnt(4)
    v_mfma_f32_16x16x32_bf16 v[0:3], v[144:147], a[112:115], v[0:3]
    ds_read_b64_tr_b16 v[128:129], v216 offset:0
    v_mfma_f32_16x16x32_bf16 v[4:7], v[144:147], a[116:119], v[4:7]
    ds_read_b64_tr_b16 v[130:131], v216 offset:2048
    v_mfma_f32_16x16x32_bf16 v[8:11], v[148:151], a[112:115], v[8:11]
    ds_read_b64_tr_b16 v[132:133], v217 offset:0
    v_mfma_f32_16x16x32_bf16 v[12:15], v[148:151], a[116:119], v[12:15]
    ds_read_b64_tr_b16 v[134:135], v217 offset:2048
    s_waitcnt lgkmcnt(4)
    v_mfma_f32_16x16x32_bf16 v[16:19], v[152:155], a[112:115], v[16:19]
    ds_read_b64_tr_b16 v[136:137], v218 offset:0
    v_mfma_f32_16x16x32_bf16 v[20:23], v[152:155], a[116:119], v[20:23]
    ds_read_b64_tr_b16 v[138:139], v218 offset:2048
    v_mfma_f32_16x16x32_bf16 v[24:27], v[156:159], a[112:115], v[24:27]
    ds_read_b64_tr_b16 v[140:141], v219 offset:0
    v_mfma_f32_16x16x32_bf16 v[28:31], v[156:159], a[116:119], v[28:31]
    ds_read_b64_tr_b16 v[142:143], v219 offset:2048
    s_waitcnt lgkmcnt(4)
    v_mfma_f32_16x16x32_bf16 v[64:67], v[128:131], a[8:11], v[64:67]
    ds_read_b64_tr_b16 v[144:145], v216 offset:8192
    v_mfma_f32_16x16x32_bf16 v[68:71], v[128:131], a[12:15], v[68:71]
    ds_read_b64_tr_b16 v[146:147], v216 offset:10240
    v_mfma_f32_16x16x32_bf16 v[72:75], v[132:135], a[8:11], v[72:75]
    ds_read_b64_tr_b16 v[148:149], v217 offset:8192
    v_mfma_f32_16x16x32_bf16 v[76:79], v[132:135], a[12:15], v[76:79]
    ds_read_b64_tr_b16 v[150:151], v217 offset:10240
    s_waitcnt lgkmcnt(4)
    v_mfma_f32_16x16x32_bf16 v[80:83], v[136:139], a[8:11], v[80:83]
    ds_read_b64_tr_b16 v[152:153], v218 offset:8192
    v_mfma_f32_16x16x32_bf16 v[84:87], v[136:139], a[12:15], v[84:87]
    ds_read_b64_tr_b16 v[154:155], v218 offset:10240
    v_mfma_f32_16x16x32_bf16 v[88:91], v[140:143], a[8:11], v[88:91]
    ds_read_b64_tr_b16 v[156:157], v219 offset:8192
    v_mfma_f32_16x16x32_bf16 v[92:95], v[140:143], a[12:15], v[92:95]
    ds_read_b64_tr_b16 v[158:159], v219 offset:10240
    s_waitcnt lgkmcnt(4)
    v_mfma_f32_16x16x32_bf16 v[64:67], v[144:147], a[24:27], v[64:67]
    ds_read_b64_tr_b16 v[128:129], v216 offset:16384
    s_mul_i32 s33, s39, 12288
    s_add_u32 s33, s33, 0x5000000
    v_mfma_f32_16x16x32_bf16 v[68:71], v[144:147], a[28:31], v[68:71]
    ds_read_b64_tr_b16 v[130:131], v216 offset:18432
    v_mfma_f32_16x16x32_bf16 v[72:75], v[148:151], a[24:27], v[72:75]
    ds_read_b64_tr_b16 v[132:133], v217 offset:16384
    v_cvt_pk_bf16_f32 v0, v0, v1
    v_mfma_f32_16x16x32_bf16 v[76:79], v[148:151], a[28:31], v[76:79]
    ds_read_b64_tr_b16 v[134:135], v217 offset:18432
    v_cvt_pk_bf16_f32 v1, v2, v3
    s_waitcnt lgkmcnt(4)
    v_mfma_f32_16x16x32_bf16 v[80:83], v[152:155], a[24:27], v[80:83]
    ds_read_b64_tr_b16 v[136:137], v218 offset:16384
    v_cvt_pk_bf16_f32 v2, v4, v5
    v_mfma_f32_16x16x32_bf16 v[84:87], v[152:155], a[28:31], v[84:87]
    ds_read_b64_tr_b16 v[138:139], v218 offset:18432
    v_cvt_pk_bf16_f32 v3, v6, v7
    v_mfma_f32_16x16x32_bf16 v[88:91], v[156:159], a[24:27], v[88:91]
    ds_read_b64_tr_b16 v[140:141], v219 offset:16384
    v_min_u32 v0, -2, v0
    v_mfma_f32_16x16x32_bf16 v[92:95], v[156:159], a[28:31], v[92:95]
    ds_read_b64_tr_b16 v[142:143], v219 offset:18432
    v_min_u32 v1, -2, v1
    s_waitcnt lgkmcnt(4)
    v_mfma_f32_16x16x32_bf16 v[64:67], v[128:131], a[40:43], v[64:67]
    ds_read_b64_tr_b16 v[144:145], v216 offset:24576
    v_min_u32 v2, -2, v2
    v_mfma_f32_16x16x32_bf16 v[68:71], v[128:131], a[44:47], v[68:71]
    ds_read_b64_tr_b16 v[146:147], v216 offset:26624
    v_min_u32 v3, -2, v3
    v_mfma_f32_16x16x32_bf16 v[72:75], v[132:135], a[40:43], v[72:75]
    ds_read_b64_tr_b16 v[148:149], v217 offset:24576
    buffer_store_dwordx4 v[0:3], v228, s[8:11], s33 offen offset:0 sc1
    v_mfma_f32_16x16x32_bf16 v[76:79], v[132:135], a[44:47], v[76:79]
    ds_read_b64_tr_b16 v[150:151], v217 offset:26624
    s_waitcnt lgkmcnt(4)
    v_mfma_f32_16x16x32_bf16 v[80:83], v[136:139], a[40:43], v[80:83]
    ds_read_b64_tr_b16 v[152:153], v218 offset:24576
    v_mfma_f32_16x16x32_bf16 v[84:87], v[136:139], a[44:47], v[84:87]
    ds_read_b64_tr_b16 v[154:155], v218 offset:26624
    v_mfma_f32_16x16x32_bf16 v[88:91], v[140:143], a[40:43], v[88:91]
    ds_read_b64_tr_b16 v[156:157], v219 offset:24576
    v_cvt_pk_bf16_f32 v4, v8, v9
    v_mfma_f32_16x16x32_bf16 v[92:95], v[140:143], a[44:47], v[92:95]
    ds_read_b64_tr_b16 v[158:159], v219 offset:26624
    v_cvt_pk_bf16_f32 v5, v10, v11
    s_waitcnt lgkmcnt(4)
    v_mfma_f32_16x16x32_bf16 v[64:67], v[144:147], a[56:59], v[64:67]
    ds_read_b64_tr_b16 v[128:129], v216 offset:32768
    v_cvt_pk_bf16_f32 v6, v12, v13
    v_mfma_f32_16x16x32_bf16 v[68:71], v[144:147], a[60:63], v[68:71]
    ds_read_b64_tr_b16 v[130:131], v216 offset:34816
    v_cvt_pk_bf16_f32 v7, v14, v15
    v_mfma_f32_16x16x32_bf16 v[72:75], v[148:151], a[56:59], v[72:75]
    ds_read_b64_tr_b16 v[132:133], v217 offset:32768
    v_min_u32 v4, -2, v4
    v_mfma_f32_16x16x32_bf16 v[76:79], v[148:151], a[60:63], v[76:79]
    ds_read_b64_tr_b16 v[134:135], v217 offset:34816
    v_min_u32 v5, -2, v5
    s_waitcnt lgkmcnt(4)
    v_mfma_f32_16x16x32_bf16 v[80:83], v[152:155], a[56:59], v[80:83]
    ds_read_b64_tr_b16 v[136:137], v218 offset:32768
    v_min_u32 v6, -2, v6
    v_mfma_f32_16x16x32_bf16 v[84:87], v[152:155], a[60:63], v[84:87]
    ds_read_b64_tr_b16 v[138:139], v218 offset:34816
    v_min_u32 v7, -2, v7
    v_mfma_f32_16x16x32_bf16 v[88:91], v[156:159], a[56:59], v[88:91]
    ds_read_b64_tr_b16 v[140:141], v219 offset:32768
    buffer_store_dwordx4 v[4:7], v228, s[8:11], s33 offen offset:1024 sc1
    v_mfma_f32_16x16x32_bf16 v[92:95], v[156:159], a[60:63], v[92:95]
    ds_read_b64_tr_b16 v[142:143], v219 offset:34816
    s_waitcnt lgkmcnt(4)
    v_mfma_f32_16x16x32_bf16 v[64:67], v[128:131], a[72:75], v[64:67]
    ds_read_b64_tr_b16 v[144:145], v216 offset:40960
    v_mfma_f32_16x16x32_bf16 v[68:71], v[128:131], a[76:79], v[68:71]
    ds_read_b64_tr_b16 v[146:147], v216 offset:43008
    v_mfma_f32_16x16x32_bf16 v[72:75], v[132:135], a[72:75], v[72:75]
    ds_read_b64_tr_b16 v[148:149], v217 offset:40960
    v_cvt_pk_bf16_f32 v8, v16, v17
    v_mfma_f32_16x16x32_bf16 v[76:79], v[132:135], a[76:79], v[76:79]
    ds_read_b64_tr_b16 v[150:151], v217 offset:43008
    v_cvt_pk_bf16_f32 v9, v18, v19
    s_waitcnt lgkmcnt(4)
    v_mfma_f32_16x16x32_bf16 v[80:83], v[136:139], a[72:75], v[80:83]
    ds_read_b64_tr_b16 v[152:153], v218 offset:40960
    v_cvt_pk_bf16_f32 v10, v20, v21
    v_mfma_f32_16x16x32_bf16 v[84:87], v[136:139], a[76:79], v[84:87]
    ds_read_b64_tr_b16 v[154:155], v218 offset:43008
    v_cvt_pk_bf16_f32 v11, v22, v23
    v_mfma_f32_16x16x32_bf16 v[88:91], v[140:143], a[72:75], v[88:91]
    ds_read_b64_tr_b16 v[156:157], v219 offset:40960
    v_min_u32 v8, -2, v8
    v_mfma_f32_16x16x32_bf16 v[92:95], v[140:143], a[76:79], v[92:95]
    ds_read_b64_tr_b16 v[158:159], v219 offset:43008
    v_min_u32 v9, -2, v9
    s_waitcnt lgkmcnt(4)
    v_mfma_f32_16x16x32_bf16 v[64:67], v[144:147], a[88:91], v[64:67]
    ds_read_b64_tr_b16 v[128:129], v216 offset:49152
    v_min_u32 v10, -2, v10
    v_mfma_f32_16x16x32_bf16 v[68:71], v[144:147], a[92:95], v[68:71]
    ds_read_b64_tr_b16 v[130:131], v216 offset:51200
    v_min_u32 v11, -2, v11
    v_mfma_f32_16x16x32_bf16 v[72:75], v[148:151], a[88:91], v[72:75]
    ds_read_b64_tr_b16 v[132:133], v217 offset:49152
    buffer_store_dwordx4 v[8:11], v228, s[8:11], s33 offen offset:2048 sc1
    v_mfma_f32_16x16x32_bf16 v[76:79], v[148:151], a[92:95], v[76:79]
    ds_read_b64_tr_b16 v[134:135], v217 offset:51200
    s_waitcnt lgkmcnt(4)
    v_mfma_f32_16x16x32_bf16 v[80:83], v[152:155], a[88:91], v[80:83]
    ds_read_b64_tr_b16 v[136:137], v218 offset:49152
    v_mfma_f32_16x16x32_bf16 v[84:87], v[152:155], a[92:95], v[84:87]
    ds_read_b64_tr_b16 v[138:139], v218 offset:51200
    v_mfma_f32_16x16x32_bf16 v[88:91], v[156:159], a[88:91], v[88:91]
    ds_read_b64_tr_b16 v[140:141], v219 offset:49152
    v_cvt_pk_bf16_f32 v12, v24, v25
    v_mfma_f32_16x16x32_bf16 v[92:95], v[156:159], a[92:95], v[92:95]
    ds_read_b64_tr_b16 v[142:143], v219 offset:51200
    v_cvt_pk_bf16_f32 v13, v26, v27
    s_waitcnt lgkmcnt(4)
    v_mfma_f32_16x16x32_bf16 v[64:67], v[128:131], a[104:107], v[64:67]
    ds_read_b64_tr_b16 v[144:145], v216 offset:57344
    v_cvt_pk_bf16_f32 v14, v28, v29
    v_mfma_f32_16x16x32_bf16 v[68:71], v[128:131], a[108:111], v[68:71]
    ds_read_b64_tr_b16 v[146:147], v216 offset:59392
    v_cvt_pk_bf16_f32 v15, v30, v31
    v_mfma_f32_16x16x32_bf16 v[72:75], v[132:135], a[104:107], v[72:75]
    ds_read_b64_tr_b16 v[148:149], v217 offset:57344
    v_min_u32 v12, -2, v12
    v_mfma_f32_16x16x32_bf16 v[76:79], v[132:135], a[108:111], v[76:79]
    ds_read_b64_tr_b16 v[150:151], v217 offset:59392
    v_min_u32 v13, -2, v13
    s_waitcnt lgkmcnt(4)
    v_mfma_f32_16x16x32_bf16 v[80:83], v[136:139], a[104:107], v[80:83]
    ds_read_b64_tr_b16 v[152:153], v218 offset:57344
    v_min_u32 v14, -2, v14
    v_mfma_f32_16x16x32_bf16 v[84:87], v[136:139], a[108:111], v[84:87]
    ds_read_b64_tr_b16 v[154:155], v218 offset:59392
    v_min_u32 v15, -2, v15
    v_mfma_f32_16x16x32_bf16 v[88:91], v[140:143], a[104:107], v[88:91]
    ds_read_b64_tr_b16 v[156:157], v219 offset:57344
    buffer_store_dwordx4 v[12:15], v228, s[8:11], s33 offen offset:3072 sc1
    v_mfma_f32_16x16x32_bf16 v[92:95], v[140:143], a[108:111], v[92:95]
    ds_read_b64_tr_b16 v[158:159], v219 offset:59392
    s_waitcnt lgkmcnt(4)
    v_mfma_f32_16x16x32_bf16 v[64:67], v[144:147], a[120:123], v[64:67]
    ds_read_b64_tr_b16 v[128:129], v216 offset:0
    v_mfma_f32_16x16x32_bf16 v[68:71], v[144:147], a[124:127], v[68:71]
    ds_read_b64_tr_b16 v[130:131], v216 offset:2048
    v_mfma_f32_16x16x32_bf16 v[72:75], v[148:151], a[120:123], v[72:75]
    ds_read_b64_tr_b16 v[132:133], v217 offset:0
    v_mfma_f32_16x16x32_bf16 v[76:79], v[148:151], a[124:127], v[76:79]
    ds_read_b64_tr_b16 v[134:135], v217 offset:2048
    s_waitcnt lgkmcnt(4)
    v_mfma_f32_16x16x32_bf16 v[80:83], v[152:155], a[120:123], v[80:83]
    ds_read_b64_tr_b16 v[136:137], v218 offset:0
    v_mfma_f32_16x16x32_bf16 v[84:87], v[152:155], a[124:127], v[84:87]
    ds_read_b64_tr_b16 v[138:139], v218 offset:2048
    v_mfma_f32_16x16x32_bf16 v[88:91], v[156:159], a[120:123], v[88:91]
    ds_read_b64_tr_b16 v[140:141], v219 offset:0
    v_mfma_f32_16x16x32_bf16 v[92:95], v[156:159], a[124:127], v[92:95]
    ds_read_b64_tr_b16 v[142:143], v219 offset:2048
    s_waitcnt lgkmcnt(4)
    v_mfma_f32_16x16x32_bf16 v[32:35], v[128:131], a[0:3], v[32:35]
    ds_read_b64_tr_b16 v[144:145], v216 offset:8192
    v_mfma_f32_16x16x32_bf16 v[36:39], v[128:131], a[4:7], v[36:39]
    ds_read_b64_tr_b16 v[146:147], v216 offset:10240
    buffer_load_dwordx4 v[176:179], v228, s[8:11], s7 offen offset:0 sc1
    v_mfma_f32_16x16x32_bf16 v[40:43], v[132:135], a[0:3], v[40:43]
    ds_read_b64_tr_b16 v[148:149], v217 offset:8192
    v_mfma_f32_16x16x32_bf16 v[44:47], v[132:135], a[4:7], v[44:47]
    ds_read_b64_tr_b16 v[150:151], v217 offset:10240
    buffer_load_dwordx4 v[180:183], v228, s[8:11], s7 offen offset:1024 sc1
    s_waitcnt lgkmcnt(4)
    v_mfma_f32_16x16x32_bf16 v[48:51], v[136:139], a[0:3], v[48:51]
    ds_read_b64_tr_b16 v[152:153], v218 offset:8192
    v_mfma_f32_16x16x32_bf16 v[52:55], v[136:139], a[4:7], v[52:55]
    ds_read_b64_tr_b16 v[154:155], v218 offset:10240
    buffer_load_dwordx4 v[184:187], v228, s[8:11], s7 offen offset:2048 sc1
    v_mfma_f32_16x16x32_bf16 v[56:59], v[140:143], a[0:3], v[56:59]
    ds_read_b64_tr_b16 v[156:157], v219 offset:8192
    v_mfma_f32_16x16x32_bf16 v[60:63], v[140:143], a[4:7], v[60:63]
    ds_read_b64_tr_b16 v[158:159], v219 offset:10240
    buffer_load_dwordx4 v[188:191], v228, s[8:11], s7 offen offset:3072 sc1
    s_waitcnt lgkmcnt(4)
    v_mfma_f32_16x16x32_bf16 v[32:35], v[144:147], a[16:19], v[32:35]
    ds_read_b64_tr_b16 v[128:129], v216 offset:16384
    s_mul_i32 s33, s39, 12288
    s_add_u32 s33, s33, 0x5001000
    v_mfma_f32_16x16x32_bf16 v[36:39], v[144:147], a[20:23], v[36:39]
    ds_read_b64_tr_b16 v[130:131], v216 offset:18432
    v_mfma_f32_16x16x32_bf16 v[40:43], v[148:151], a[16:19], v[40:43]
    ds_read_b64_tr_b16 v[132:133], v217 offset:16384
    v_cvt_pk_bf16_f32 v64, v64, v65
    v_mfma_f32_16x16x32_bf16 v[44:47], v[148:151], a[20:23], v[44:47]
    ds_read_b64_tr_b16 v[134:135], v217 offset:18432
    v_cvt_pk_bf16_f32 v65, v66, v67
    s_waitcnt lgkmcnt(4)
    v_mfma_f32_16x16x32_bf16 v[48:51], v[152:155], a[16:19], v[48:51]
    ds_read_b64_tr_b16 v[136:137], v218 offset:16384
    v_cvt_pk_bf16_f32 v66, v68, v69
    v_mfma_f32_16x16x32_bf16 v[52:55], v[152:155], a[20:23], v[52:55]
    ds_read_b64_tr_b16 v[138:139], v218 offset:18432
    v_cvt_pk_bf16_f32 v67, v70, v71
    v_mfma_f32_16x16x32_bf16 v[56:59], v[156:159], a[16:19], v[56:59]
    ds_read_b64_tr_b16 v[140:141], v219 offset:16384
    v_min_u32 v64, -2, v64
    v_mfma_f32_16x16x32_bf16 v[60:63], v[156:159], a[20:23], v[60:63]
    ds_read_b64_tr_b16 v[142:143], v219 offset:18432
    v_min_u32 v65, -2, v65
    s_waitcnt lgkmcnt(4)
    v_mfma_f32_16x16x32_bf16 v[32:35], v[128:131], a[32:35], v[32:35]
    ds_read_b64_tr_b16 v[144:145], v216 offset:24576
    v_min_u32 v66, -2, v66
    v_mfma_f32_16x16x32_bf16 v[36:39], v[128:131], a[36:39], v[36:39]
    ds_read_b64_tr_b16 v[146:147], v216 offset:26624
    v_min_u32 v67, -2, v67
    v_mfma_f32_16x16x32_bf16 v[40:43], v[132:135], a[32:35], v[40:43]
    ds_read_b64_tr_b16 v[148:149], v217 offset:24576
    buffer_store_dwordx4 v[64:67], v228, s[8:11], s33 offen offset:0 sc1
    v_mfma_f32_16x16x32_bf16 v[44:47], v[132:135], a[36:39], v[44:47]
    ds_read_b64_tr_b16 v[150:151], v217 offset:26624
    s_waitcnt lgkmcnt(4)
    v_mfma_f32_16x16x32_bf16 v[48:51], v[136:139], a[32:35], v[48:51]
    ds_read_b64_tr_b16 v[152:153], v218 offset:24576
    v_mfma_f32_16x16x32_bf16 v[52:55], v[136:139], a[36:39], v[52:55]
    ds_read_b64_tr_b16 v[154:155], v218 offset:26624
    v_mfma_f32_16x16x32_bf16 v[56:59], v[140:143], a[32:35], v[56:59]
    ds_read_b64_tr_b16 v[156:157], v219 offset:24576
    v_cvt_pk_bf16_f32 v68, v72, v73
    v_mfma_f32_16x16x32_bf16 v[60:63], v[140:143], a[36:39], v[60:63]
    ds_read_b64_tr_b16 v[158:159], v219 offset:26624
    v_cvt_pk_bf16_f32 v69, v74, v75
    s_waitcnt lgkmcnt(4)
    v_mfma_f32_16x16x32_bf16 v[32:35], v[144:147], a[48:51], v[32:35]
    ds_read_b64_tr_b16 v[128:129], v216 offset:32768
    v_cvt_pk_bf16_f32 v70, v76, v77
    v_mfma_f32_16x16x32_bf16 v[36:39], v[144:147], a[52:55], v[36:39]
    ds_read_b64_tr_b16 v[130:131], v216 offset:34816
    v_cvt_pk_bf16_f32 v71, v78, v79
    v_mfma_f32_16x16x32_bf16 v[40:43], v[148:151], a[48:51], v[40:43]
    ds_read_b64_tr_b16 v[132:133], v217 offset:32768
    v_min_u32 v68, -2, v68
    v_mfma_f32_16x16x32_bf16 v[44:47], v[148:151], a[52:55], v[44:47]
    ds_read_b64_tr_b16 v[134:135], v217 offset:34816
    v_min_u32 v69, -2, v69
    s_waitcnt lgkmcnt(4)
    v_mfma_f32_16x16x32_bf16 v[48:51], v[152:155], a[48:51], v[48:51]
    ds_read_b64_tr_b16 v[136:137], v218 offset:32768
    v_min_u32 v70, -2, v70
    v_mfma_f32_16x16x32_bf16 v[52:55], v[152:155], a[52:55], v[52:55]
    ds_read_b64_tr_b16 v[138:139], v218 offset:34816
    v_min_u32 v71, -2, v71
    v_mfma_f32_16x16x32_bf16 v[56:59], v[156:159], a[48:51], v[56:59]
    ds_read_b64_tr_b16 v[140:141], v219 offset:32768
    buffer_store_dwordx4 v[68:71], v228, s[8:11], s33 offen offset:1024 sc1
    v_mfma_f32_16x16x32_bf16 v[60:63], v[156:159], a[52:55], v[60:63]
    ds_read_b64_tr_b16 v[142:143], v219 offset:34816
    s_waitcnt lgkmcnt(4)
    v_mfma_f32_16x16x32_bf16 v[32:35], v[128:131], a[64:67], v[32:35]
    ds_read_b64_tr_b16 v[144:145], v216 offset:40960
    v_mfma_f32_16x16x32_bf16 v[36:39], v[128:131], a[68:71], v[36:39]
    ds_read_b64_tr_b16 v[146:147], v216 offset:43008
    v_mfma_f32_16x16x32_bf16 v[40:43], v[132:135], a[64:67], v[40:43]
    ds_read_b64_tr_b16 v[148:149], v217 offset:40960
    v_cvt_pk_bf16_f32 v72, v80, v81
    v_mfma_f32_16x16x32_bf16 v[44:47], v[132:135], a[68:71], v[44:47]
    ds_read_b64_tr_b16 v[150:151], v217 offset:43008
    v_cvt_pk_bf16_f32 v73, v82, v83
    s_waitcnt lgkmcnt(4)
    v_mfma_f32_16x16x32_bf16 v[48:51], v[136:139], a[64:67], v[48:51]
    ds_read_b64_tr_b16 v[152:153], v218 offset:40960
    v_cvt_pk_bf16_f32 v74, v84, v85
    v_mfma_f32_16x16x32_bf16 v[52:55], v[136:139], a[68:71], v[52:55]
    ds_read_b64_tr_b16 v[154:155], v218 offset:43008
    v_cvt_pk_bf16_f32 v75, v86, v87
    v_mfma_f32_16x16x32_bf16 v[56:59], v[140:143], a[64:67], v[56:59]
    ds_read_b64_tr_b16 v[156:157], v219 offset:40960
    v_min_u32 v72, -2, v72
    v_mfma_f32_16x16x32_bf16 v[60:63], v[140:143], a[68:71], v[60:63]
    ds_read_b64_tr_b16 v[158:159], v219 offset:43008
    v_min_u32 v73, -2, v73
    s_waitcnt lgkmcnt(4)
    v_mfma_f32_16x16x32_bf16 v[32:35], v[144:147], a[80:83], v[32:35]
    ds_read_b64_tr_b16 v[128:129], v216 offset:49152
    v_min_u32 v74, -2, v74
    v_mfma_f32_16x16x32_bf16 v[36:39], v[144:147], a[84:87], v[36:39]
    ds_read_b64_tr_b16 v[130:131], v216 offset:51200
    v_min_u32 v75, -2, v75
    v_mfma_f32_16x16x32_bf16 v[40:43], v[148:151], a[80:83], v[40:43]
    ds_read_b64_tr_b16 v[132:133], v217 offset:49152
    buffer_store_dwordx4 v[72:75], v228, s[8:11], s33 offen offset:2048 sc1
    v_mfma_f32_16x16x32_bf16 v[44:47], v[148:151], a[84:87], v[44:47]
    ds_read_b64_tr_b16 v[134:135], v217 offset:51200
    s_waitcnt lgkmcnt(4)
    v_mfma_f32_16x16x32_bf16 v[48:51], v[152:155], a[80:83], v[48:51]
    ds_read_b64_tr_b16 v[136:137], v218 offset:49152
    v_mfma_f32_16x16x32_bf16 v[52:55], v[152:155], a[84:87], v[52:55]
    ds_read_b64_tr_b16 v[138:139], v218 offset:51200
    v_mfma_f32_16x16x32_bf16 v[56:59], v[156:159], a[80:83], v[56:59]
    ds_read_b64_tr_b16 v[140:141], v219 offset:49152
    v_cvt_pk_bf16_f32 v76, v88, v89
    v_mfma_f32_16x16x32_bf16 v[60:63], v[156:159], a[84:87], v[60:63]
    ds_read_b64_tr_b16 v[142:143], v219 offset:51200
    v_cvt_pk_bf16_f32 v77, v90, v91
    s_waitcnt lgkmcnt(4)
    v_mfma_f32_16x16x32_bf16 v[32:35], v[128:131], a[96:99], v[32:35]
    ds_read_b64_tr_b16 v[144:145], v216 offset:57344
    v_cvt_pk_bf16_f32 v78, v92, v93
    v_mfma_f32_16x16x32_bf16 v[36:39], v[128:131], a[100:103], v[36:39]
    ds_read_b64_tr_b16 v[146:147], v216 offset:59392
    v_cvt_pk_bf16_f32 v79, v94, v95
    v_mfma_f32_16x16x32_bf16 v[40:43], v[132:135], a[96:99], v[40:43]
    ds_read_b64_tr_b16 v[148:149], v217 offset:57344
    v_min_u32 v76, -2, v76
    v_mfma_f32_16x16x32_bf16 v[44:47], v[132:135], a[100:103], v[44:47]
    ds_read_b64_tr_b16 v[150:151], v217 offset:59392
    v_min_u32 v77, -2, v77
    s_waitcnt lgkmcnt(4)
    v_mfma_f32_16x16x32_bf16 v[48:51], v[136:139], a[96:99], v[48:51]
    ds_read_b64_tr_b16 v[152:153], v218 offset:57344
    v_min_u32 v78, -2, v78
    v_mfma_f32_16x16x32_bf16 v[52:55], v[136:139], a[100:103], v[52:55]
    ds_read_b64_tr_b16 v[154:155], v218 offset:59392
    v_min_u32 v79, -2, v79
    v_mfma_f32_16x16x32_bf16 v[56:59], v[140:143], a[96:99], v[56:59]
    ds_read_b64_tr_b16 v[156:157], v219 offset:57344
    buffer_store_dwordx4 v[76:79], v228, s[8:11], s33 offen offset:3072 sc1
    v_mfma_f32_16x16x32_bf16 v[60:63], v[140:143], a[100:103], v[60:63]
    ds_read_b64_tr_b16 v[158:159], v219 offset:59392
    s_waitcnt lgkmcnt(4)
    v_mfma_f32_16x16x32_bf16 v[32:35], v[144:147], a[112:115], v[32:35]
    buffer_load_dwordx4 v[96:99], v228, s[8:11], s37 offen offset:0 sc1
    v_mfma_f32_16x16x32_bf16 v[36:39], v[144:147], a[116:119], v[36:39]
    v_mfma_f32_16x16x32_bf16 v[40:43], v[148:151], a[112:115], v[40:43]
    buffer_load_dwordx4 v[100:103], v228, s[8:11], s37 offen offset:1024 sc1
    v_mfma_f32_16x16x32_bf16 v[44:47], v[148:151], a[116:119], v[44:47]
    s_waitcnt lgkmcnt(0)
    v_mfma_f32_16x16x32_bf16 v[48:51], v[152:155], a[112:115], v[48:51]
    buffer_load_dwordx4 v[104:107], v228, s[8:11], s37 offen offset:2048 sc1
    v_mfma_f32_16x16x32_bf16 v[52:55], v[152:155], a[116:119], v[52:55]
    v_mfma_f32_16x16x32_bf16 v[56:59], v[156:159], a[112:115], v[56:59]
    buffer_load_dwordx4 v[108:111], v228, s[8:11], s37 offen offset:3072 sc1
    v_mfma_f32_16x16x32_bf16 v[60:63], v[156:159], a[116:119], v[60:63]
kc_tail:
    buffer_load_dwordx4 v[160:163], v228, s[8:11], s38 offen offset:0 sc1
    buffer_load_dwordx4 v[164:167], v228, s[8:11], s38 offen offset:1024 sc1
    buffer_load_dwordx4 v[168:171], v228, s[8:11], s38 offen offset:2048 sc1
    buffer_load_dwordx4 v[172:175], v228, s[8:11], s38 offen offset:3072 sc1
    v_lshlrev_b32 v128, 16, v192
    v_and_b32 v129, 0xffff0000, v192
    v_lshlrev_b32 v130, 16, v193
    v_and_b32 v131, 0xffff0000, v193
    v_lshlrev_b32 v132, 16, v194
    v_and_b32 v133, 0xffff0000, v194
    v_lshlrev_b32 v134, 16, v195
    v_and_b32 v135, 0xffff0000, v195
    v_lshlrev_b32 v136, 16, v196
    v_and_b32 v137, 0xffff0000, v196
    v_lshlrev_b32 v138, 16, v197
    v_and_b32 v139, 0xffff0000, v197
    v_lshlrev_b32 v140, 16, v198
    v_and_b32 v141, 0xffff0000, v198
    v_lshlrev_b32 v142, 16, v199
    v_and_b32 v143, 0xffff0000, v199
    v_lshlrev_b32 v144, 16, v200
    v_and_b32 v145, 0xffff0000, v200
    v_lshlrev_b32 v146, 16, v201
    v_and_b32 v147, 0xffff0000, v201
    v_lshlrev_b32 v148, 16, v202
    v_and_b32 v149, 0xffff0000, v202
    v_lshlrev_b32 v150, 16, v203
    v_and_b32 v151, 0xffff0000, v203
    v_lshlrev_b32 v152, 16, v204
    v_and_b32 v153, 0xffff0000, v204
    v_lshlrev_b32 v154, 16, v205
    v_and_b32 v155, 0xffff0000, v205
    v_lshlrev_b32 v156, 16, v206
    v_and_b32 v157, 0xffff0000, v206
    v_lshlrev_b32 v158, 16, v207
    v_and_b32 v159, 0xffff0000, v207
    v_lshlrev_b32 v112, 16, v208
    v_and_b32 v113, 0xffff0000, v208
    v_lshlrev_b32 v114, 16, v209
    v_and_b32 v115, 0xffff0000, v209
    v_lshlrev_b32 v116, 16, v210
    v_and_b32 v117, 0xffff0000, v210
    v_lshlrev_b32 v118, 16, v211
    v_and_b32 v119, 0xffff0000, v211
    v_pk_add_f32 v[120:121], v[112:113], v[114:115]
    v_pk_add_f32 v[122:123], v[116:117], v[118:119]
    v_pk_add_f32 v[120:121], v[120:121], v[122:123]
    v_add_f32 v196, v120, v121
    s_barrier
    s_waitcnt vmcnt(12)
    v_max3_u32 v235, v176, v177, v178
    v_max3_u32 v235, v235, v179, v180
    v_max3_u32 v235, v235, v181, v182
    v_max3_u32 v235, v235, v183, v184
    v_max3_u32 v235, v235, v185, v186
    v_max3_u32 v235, v235, v187, v188
    v_max3_u32 v235, v235, v189, v190
    v_max_u32 v235, v235, v191
    v_cmp_eq_u32 vcc, -1, v235
    s_cbranch_vccnz kc_r3
kc_r3o:
    v_lshlrev_b32 v64, 16, v176
    v_and_b32 v65, 0xffff0000, v176
    v_lshlrev_b32 v66, 16, v177
    v_and_b32 v67, 0xffff0000, v177
    v_pk_add_f32 v[32:33], v[32:33], v[64:65]
    v_pk_add_f32 v[34:35], v[34:35], v[66:67]
    v_lshlrev_b32 v68, 16, v178
    v_and_b32 v69, 0xffff0000, v178
    v_lshlrev_b32 v70, 16, v179
    v_and_b32 v71, 0xffff0000, v179
    v_pk_add_f32 v[36:37], v[36:37], v[68:69]
    v_pk_add_f32 v[38:39], v[38:39], v[70:71]
    v_lshlrev_b32 v72, 16, v180
    v_and_b32 v73, 0xffff0000, v180
    v_lshlrev_b32 v74, 16, v181
    v_and_b32 v75, 0xffff0000, v181
    v_pk_add_f32 v[40:41], v[40:41], v[72:73]
    v_pk_add_f32 v[42:43], v[42:43], v[74:75]
    v_lshlrev_b32 v76, 16, v182
    v_and_b32 v77, 0xffff0000, v182
    v_lshlrev_b32 v78, 16, v183
    v_and_b32 v79, 0xffff0000, v183
    v_pk_add_f32 v[44:45], v[44:45], v[76:77]
    v_pk_add_f32 v[46:47], v[46:47], v[78:79]
    v_lshlrev_b32 v80, 16, v184
    v_and_b32 v81, 0xffff0000, v184
    v_lshlrev_b32 v82, 16, v185
    v_and_b32 v83, 0xffff0000, v185
    v_pk_add_f32 v[48:49], v[48:49], v[80:81]
    v_pk_add_f32 v[50:51], v[50:51], v[82:83]
    v_lshlrev_b32 v84, 16, v186
    v_and_b32 v85, 0xffff0000, v186
    v_lshlrev_b32 v86, 16, v187
    v_and_b32 v87, 0xffff0000, v187
    v_pk_add_f32 v[52:53], v[52:53], v[84:85]
    v_pk_add_f32 v[54:55], v[54:55], v[86:87]
    v_lshlrev_b32 v88, 16, v188
    v_and_b32 v89, 0xffff0000, v188
    v_lshlrev_b32 v90, 16, v189
    v_and_b32 v91, 0xffff0000, v189
    v_pk_add_f32 v[56:57], v[56:57], v[88:89]
    v_pk_add_f32 v[58:59], v[58:59], v[90:91]
    v_lshlrev_b32 v92, 16, v190
    v_and_b32 v93, 0xffff0000, v190
    v_lshlrev_b32 v94, 16, v191
    v_and_b32 v95, 0xffff0000, v191
    v_pk_add_f32 v[60:61], v[60:61], v[92:93]
    v_pk_add_f32 v[62:63], v[62:63], v[94:95]
    s_waitcnt vmcnt(4)
    v_max3_u32 v235, v96, v97, v98
    v_max3_u32 v235, v235, v99, v100
    v_max3_u32 v235, v235, v101, v102
    v_max3_u32 v235, v235, v103, v104
    v_max3_u32 v235, v235, v105, v106
    v_max3_u32 v235, v235, v107, v108
    v_max3_u32 v235, v235, v109, v110
    v_max_u32 v235, v235, v111
    v_cmp_eq_u32 vcc, -1, v235
    s_cbranch_vccnz kc_r1
kc_r1o:
    v_lshlrev_b32 v64, 16, v96
    v_and_b32 v65, 0xffff0000, v96
    v_lshlrev_b32 v66, 16, v97
    v_and_b32 v67, 0xffff0000, v97
    v_pk_add_f32 v[32:33], v[32:33], v[64:65]
    v_pk_add_f32 v[34:35], v[34:35], v[66:67]
    v_lshlrev_b32 v68, 16, v98
    v_and_b32 v69, 0xffff0000, v98
    v_lshlrev_b32 v70, 16, v99
    v_and_b32 v71, 0xffff0000, v99
    v_pk_add_f32 v[36:37], v[36:37], v[68:69]
    v_pk_add_f32 v[38:39], v[38:39], v[70:71]
    v_lshlrev_b32 v72, 16, v100
    v_and_b32 v73, 0xffff0000, v100
    v_lshlrev_b32 v74, 16, v101
    v_and_b32 v75, 0xffff0000, v101
    v_pk_add_f32 v[40:41], v[40:41], v[72:73]
    v_pk_add_f32 v[42:43], v[42:43], v[74:75]
    v_lshlrev_b32 v76, 16, v102
    v_and_b32 v77, 0xffff0000, v102
    v_lshlrev_b32 v78, 16, v103
    v_and_b32 v79, 0xffff0000, v103
    v_pk_add_f32 v[44:45], v[44:45], v[76:77]
    v_pk_add_f32 v[46:47], v[46:47], v[78:79]
    v_lshlrev_b32 v80, 16, v104
    v_and_b32 v81, 0xffff0000, v104
    v_lshlrev_b32 v82, 16, v105
    v_and_b32 v83, 0xffff0000, v105
    v_pk_add_f32 v[48:49], v[48:49], v[80:81]
    v_pk_add_f32 v[50:51], v[50:51], v[82:83]
    v_lshlrev_b32 v84, 16, v106
    v_and_b32 v85, 0xffff0000, v106
    v_lshlrev_b32 v86, 16, v107
    v_and_b32 v87, 0xffff0000, v107
    v_pk_add_f32 v[52:53], v[52:53], v[84:85]
    v_pk_add_f32 v[54:55], v[54:55], v[86:87]
    v_lshlrev_b32 v88, 16, v108
    v_and_b32 v89, 0xffff0000, v108
    v_lshlrev_b32 v90, 16, v109
    v_and_b32 v91, 0xffff0000, v109
    v_pk_add_f32 v[56:57], v[56:57], v[88:89]
    v_pk_add_f32 v[58:59], v[58:59], v[90:91]
    v_lshlrev_b32 v92, 16, v110
    v_and_b32 v93, 0xffff0000, v110
    v_lshlrev_b32 v94, 16, v111
    v_and_b32 v95, 0xffff0000, v111
    v_pk_add_f32 v[60:61], v[60:61], v[92:93]
    v_pk_add_f32 v[62:63], v[62:63], v[94:95]
    s_waitcnt vmcnt(0)
    v_max3_u32 v235, v160, v161, v162
    v_max3_u32 v235, v235, v163, v164
    v_max3_u32 v235, v235, v165, v166
    v_max3_u32 v235, v235, v167, v168
    v_max3_u32 v235, v235, v169, v170
    v_max3_u32 v235, v235, v171, v172
    v_max3_u32 v235, v235, v173, v174
    v_max_u32 v235, v235, v175
    v_cmp_eq_u32 vcc, -1, v235
    s_cbranch_vccnz kc_r2
kc_r2o:
    v_lshlrev_b32 v64, 16, v160
    v_and_b32 v65, 0xffff0000, v160
    v_lshlrev_b32 v66, 16, v161
    v_and_b32 v67, 0xffff0000, v161
    v_pk_add_f32 v[32:33], v[32:33], v[64:65]
    v_pk_add_f32 v[34:35], v[34:35], v[66:67]
    v_cvt_pk_bf16_f32 v0, v32, v33
    v_cvt_pk_bf16_f32 v1, v34, v35
    ds_write_b64 v238, v[0:1] offset:0
    v_lshlrev_b32 v68, 16, v162
    v_and_b32 v69, 0xffff0000, v162
    v_lshlrev_b32 v70, 16, v163
    v_and_b32 v71, 0xffff0000, v163
    v_pk_add_f32 v[36:37], v[36:37], v[68:69]
    v_pk_add_f32 v[38:39], v[38:39], v[70:71]
    v_cvt_pk_bf16_f32 v2, v36, v37
    v_cvt_pk_bf16_f32 v3, v38, v39
    ds_write_b64 v238, v[2:3] offset:2304
    v_lshlrev_b32 v72, 16, v164
    v_and_b32 v73, 0xffff0000, v164
    v_lshlrev_b32 v74, 16, v165
    v_and_b32 v75, 0xffff0000, v165
    v_pk_add_f32 v[40:41], v[40:41], v[72:73]
    v_pk_add_f32 v[42:43], v[42:43], v[74:75]
    v_cvt_pk_bf16_f32 v4, v40, v41
    v_cvt_pk_bf16_f32 v5, v42, v43
    ds_write_b64 v238, v[4:5] offset:32
    v_lshlrev_b32 v76, 16, v166
    v_and_b32 v77, 0xffff0000, v166
    v_lshlrev_b32 v78, 16, v167
    v_and_b32 v79, 0xffff0000, v167
    v_pk_add_f32 v[44:45], v[44:45], v[76:77]
    v_pk_add_f32 v[46:47], v[46:47], v[78:79]
    v_cvt_pk_bf16_f32 v6, v44, v45
    v_cvt_pk_bf16_f32 v7, v46, v47
    ds_write_b64 v238, v[6:7] offset:2336
    v_lshlrev_b32 v80, 16, v168
    v_and_b32 v81, 0xffff0000, v168
    v_lshlrev_b32 v82, 16, v169
    v_and_b32 v83, 0xffff0000, v169
    v_pk_add_f32 v[48:49], v[48:49], v[80:81]
    v_pk_add_f32 v[50:51], v[50:51], v[82:83]
    v_cvt_pk_bf16_f32 v8, v48, v49
    v_cvt_pk_bf16_f32 v9, v50, v51
    ds_write_b64 v238, v[8:9] offset:64
    v_lshlrev_b32 v84, 16, v170
    v_and_b32 v85, 0xffff0000, v170
    v_lshlrev_b32 v86, 16, v171
    v_and_b32 v87, 0xffff0000, v171
    v_pk_add_f32 v[52:53], v[52:53], v[84:85]
    v_pk_add_f32 v[54:55], v[54:55], v[86:87]
    v_cvt_pk_bf16_f32 v10, v52, v53
    v_cvt_pk_bf16_f32 v11, v54, v55
    ds_write_b64 v238, v[10:11] offset:2368
    v_lshlrev_b32 v88, 16, v172
    v_and_b32 v89, 0xffff0000, v172
    v_lshlrev_b32 v90, 16, v173
    v_and_b32 v91, 0xffff0000, v173
    v_pk_add_f32 v[56:57], v[56:57], v[88:89]
    v_pk_add_f32 v[58:59], v[58:59], v[90:91]
    v_cvt_pk_bf16_f32 v12, v56, v57
    v_cvt_pk_bf16_f32 v13, v58, v59
    ds_write_b64 v238, v[12:13] offset:96
    v_lshlrev_b32 v92, 16, v174
    v_and_b32 v93, 0xffff0000, v174
    v_lshlrev_b32 v94, 16, v175
    v_and_b32 v95, 0xffff0000, v175
    v_pk_add_f32 v[60:61], v[60:61], v[92:93]
    v_pk_add_f32 v[62:63], v[62:63], v[94:95]
    v_cvt_pk_bf16_f32 v14, v60, v61
    v_cvt_pk_bf16_f32 v15, v62, v63
    ds_write_b64 v238, v[14:15] offset:2400
    s_waitcnt lgkmcnt(0)
    ds_read_b128 v[16:19], v239 offset:0
    ds_read_b128 v[20:23], v239 offset:1152
    ds_read_b128 v[24:27], v239 offset:2304
    ds_read_b128 v[28:31], v239 offset:3456
    s_waitcnt lgkmcnt(3)
    v_lshlrev_b32 v64, 16, v16
    v_lshlrev_b32 v66, 16, v17
    v_lshlrev_b32 v68, 16, v18
    v_lshlrev_b32 v70, 16, v19
    v_and_b32 v65, 0xffff0000, v16
    v_and_b32 v67, 0xffff0000, v17
    v_and_b32 v69, 0xffff0000, v18
    v_and_b32 v71, 0xffff0000, v19
    v_pk_add_f32 v[64:65], v[64:65], v[128:129]
    v_pk_add_f32 v[66:67], v[66:67], v[130:131]
    v_pk_add_f32 v[68:69], v[68:69], v[132:133]
    v_pk_add_f32 v[70:71], v[70:71], v[134:135]
    v_cvt_pk_bf16_f32 v16, v64, v65
    v_cvt_pk_bf16_f32 v17, v66, v67
    v_cvt_pk_bf16_f32 v18, v68, v69
    v_cvt_pk_bf16_f32 v19, v70, v71
    v_lshlrev_b32 v64, 16, v16
    v_lshlrev_b32 v66, 16, v17
    v_lshlrev_b32 v68, 16, v18
    v_lshlrev_b32 v70, 16, v19
    v_and_b32 v65, 0xffff0000, v16
    v_and_b32 v67, 0xffff0000, v17
    v_and_b32 v69, 0xffff0000, v18
    v_and_b32 v71, 0xffff0000, v19
    s_mov_b32 s32, 0x3400000
    buffer_store_dwordx4 v[16:19], v229, s[8:11], s32 offen sc1
    v_pk_add_f32 v[160:161], v[64:65], v[66:67]
    v_pk_mul_f32 v[162:163], v[64:65], v[64:65]
    v_pk_mul_f32 v[164:165], v[64:65], v[112:113]
    v_pk_fma_f32 v[162:163], v[66:67], v[66:67], v[162:163]
    v_pk_fma_f32 v[164:165], v[66:67], v[114:115], v[164:165]
    v_pk_add_f32 v[160:161], v[160:161], v[68:69]
    v_pk_fma_f32 v[162:163], v[68:69], v[68:69], v[162:163]
    v_pk_fma_f32 v[164:165], v[68:69], v[116:117], v[164:165]
    v_pk_add_f32 v[160:161], v[160:161], v[70:71]
    v_pk_fma_f32 v[162:163], v[70:71], v[70:71], v[162:163]
    v_pk_fma_f32 v[164:165], v[70:71], v[118:119], v[164:165]
    v_add_f32 v184, v160, v161
    v_add_f32 v185, v162, v163
    v_add_f32 v186, v164, v165
    s_waitcnt lgkmcnt(2)
    v_lshlrev_b32 v72, 16, v20
    v_lshlrev_b32 v74, 16, v21
    v_lshlrev_b32 v76, 16, v22
    v_lshlrev_b32 v78, 16, v23
    v_and_b32 v73, 0xffff0000, v20
    v_and_b32 v75, 0xffff0000, v21
    v_and_b32 v77, 0xffff0000, v22
    v_and_b32 v79, 0xffff0000, v23
    v_pk_add_f32 v[72:73], v[72:73], v[136:137]
    v_pk_add_f32 v[74:75], v[74:75], v[138:139]
    v_pk_add_f32 v[76:77], v[76:77], v[140:141]
    v_pk_add_f32 v[78:79], v[78:79], v[142:143]
    v_cvt_pk_bf16_f32 v20, v72, v73
    v_cvt_pk_bf16_f32 v21, v74, v75
    v_cvt_pk_bf16_f32 v22, v76, v77
    v_cvt_pk_bf16_f32 v23, v78, v79
    v_lshlrev_b32 v72, 16, v20
    v_lshlrev_b32 v74, 16, v21
    v_lshlrev_b32 v76, 16, v22
    v_lshlrev_b32 v78, 16, v23
    v_and_b32 v73, 0xffff0000, v20
    v_and_b32 v75, 0xffff0000, v21
    v_and_b32 v77, 0xffff0000, v22
    v_and_b32 v79, 0xffff0000, v23
    s_mov_b32 s32, 0x3404000
    buffer_store_dwordx4 v[20:23], v229, s[8:11], s32 offen sc1
    v_pk_add_f32 v[166:167], v[72:73], v[74:75]
    v_pk_mul_f32 v[168:169], v[72:73], v[72:73]
    v_pk_mul_f32 v[170:171], v[72:73], v[112:113]
    v_pk_fma_f32 v[168:169], v[74:75], v[74:75], v[168:169]
    v_pk_fma_f32 v[170:171], v[74:75], v[114:115], v[170:171]
    v_pk_add_f32 v[166:167], v[166:167], v[76:77]
    v_pk_fma_f32 v[168:169], v[76:77], v[76:77], v[168:169]
    v_pk_fma_f32 v[170:171], v[76:77], v[116:117], v[170:171]
    v_pk_add_f32 v[166:167], v[166:167], v[78:79]
    v_pk_fma_f32 v[168:169], v[78:79], v[78:79], v[168:169]
    v_pk_fma_f32 v[170:171], v[78:79], v[118:119], v[170:171]
    v_add_f32 v187, v166, v167
    v_add_f32 v188, v168, v169
    v_add_f32 v189, v170, v171
    s_waitcnt lgkmcnt(1)
    v_lshlrev_b32 v80, 16, v24
    v_lshlrev_b32 v82, 16, v25
    v_lshlrev_b32 v84, 16, v26
    v_lshlrev_b32 v86, 16, v27
    v_and_b32 v81, 0xffff0000, v24
    v_and_b32 v83, 0xffff0000, v25
    v_and_b32 v85, 0xffff0000, v26
    v_and_b32 v87, 0xffff0000, v27
    v_pk_add_f32 v[80:81], v[80:81], v[144:145]
    v_pk_add_f32 v[82:83], v[82:83], v[146:147]
    v_pk_add_f32 v[84:85], v[84:85], v[148:149]
    v_pk_add_f32 v[86:87], v[86:87], v[150:151]
    v_cvt_pk_bf16_f32 v24, v80, v81
    v_cvt_pk_bf16_f32 v25, v82, v83
    v_cvt_pk_bf16_f32 v26, v84, v85
    v_cvt_pk_bf16_f32 v27, v86, v87
    v_lshlrev_b32 v80, 16, v24
    v_lshlrev_b32 v82, 16, v25
    v_lshlrev_b32 v84, 16, v26
    v_lshlrev_b32 v86, 16, v27
    v_and_b32 v81, 0xffff0000, v24
    v_and_b32 v83, 0xffff0000, v25
    v_and_b32 v85, 0xffff0000, v26
    v_and_b32 v87, 0xffff0000, v27
    s_mov_b32 s32, 0x3408000
    buffer_store_dwordx4 v[24:27], v229, s[8:11], s32 offen sc1
    v_pk_add_f32 v[172:173], v[80:81], v[82:83]
    v_pk_mul_f32 v[174:175], v[80:81], v[80:81]
    v_pk_mul_f32 v[176:177], v[80:81], v[112:113]
    v_pk_fma_f32 v[174:175], v[82:83], v[82:83], v[174:175]
    v_pk_fma_f32 v[176:177], v[82:83], v[114:115], v[176:177]
    v_pk_add_f32 v[172:173], v[172:173], v[84:85]
    v_pk_fma_f32 v[174:175], v[84:85], v[84:85], v[174:175]
    v_pk_fma_f32 v[176:177], v[84:85], v[116:117], v[176:177]
    v_pk_add_f32 v[172:173], v[172:173], v[86:87]
    v_pk_fma_f32 v[174:175], v[86:87], v[86:87], v[174:175]
    v_pk_fma_f32 v[176:177], v[86:87], v[118:119], v[176:177]
    v_add_f32 v190, v172, v173
    v_add_f32 v191, v174, v175
    v_add_f32 v192, v176, v177
    s_waitcnt lgkmcnt(0)
    v_lshlrev_b32 v88, 16, v28
    v_lshlrev_b32 v90, 16, v29
    v_lshlrev_b32 v92, 16, v30
    v_lshlrev_b32 v94, 16, v31
    v_and_b32 v89, 0xffff0000, v28
    v_and_b32 v91, 0xffff0000, v29
    v_and_b32 v93, 0xffff0000, v30
    v_and_b32 v95, 0xffff0000, v31
    v_pk_add_f32 v[88:89], v[88:89], v[152:153]
    v_pk_add_f32 v[90:91], v[90:91], v[154:155]
    v_pk_add_f32 v[92:93], v[92:93], v[156:157]
    v_pk_add_f32 v[94:95], v[94:95], v[158:159]
    v_cvt_pk_bf16_f32 v28, v88, v89
    v_cvt_pk_bf16_f32 v29, v90, v91
    v_cvt_pk_bf16_f32 v30, v92, v93
    v_cvt_pk_bf16_f32 v31, v94, v95
    v_lshlrev_b32 v88, 16, v28
    v_lshlrev_b32 v90, 16, v29
    v_lshlrev_b32 v92, 16, v30
    v_lshlrev_b32 v94, 16, v31
    v_and_b32 v89, 0xffff0000, v28
    v_and_b32 v91, 0xffff0000, v29
    v_and_b32 v93, 0xffff0000, v30
    v_and_b32 v95, 0xffff0000, v31
    s_mov_b32 s32, 0x340c000
    buffer_store_dwordx4 v[28:31], v229, s[8:11], s32 offen sc1
    v_pk_add_f32 v[178:179], v[88:89], v[90:91]
    v_pk_mul_f32 v[180:181], v[88:89], v[88:89]
    v_pk_mul_f32 v[182:183], v[88:89], v[112:113]
    v_pk_fma_f32 v[180:181], v[90:91], v[90:91], v[180:181]
    v_pk_fma_f32 v[182:183], v[90:91], v[114:115], v[182:183]
    v_pk_add_f32 v[178:179], v[178:179], v[92:93]
    v_pk_fma_f32 v[180:181], v[92:93], v[92:93], v[180:181]
    v_pk_fma_f32 v[182:183], v[92:93], v[116:117], v[182:183]
    v_pk_add_f32 v[178:179], v[178:179], v[94:95]
    v_pk_fma_f32 v[180:181], v[94:95], v[94:95], v[180:181]
    v_pk_fma_f32 v[182:183], v[94:95], v[118:119], v[182:183]
    v_add_f32 v193, v178, v179
    v_add_f32 v194, v180, v181
    v_add_f32 v195, v182, v183
    v_add_f32_dpp v196, v196, v196 quad_perm:[1,0,3,2] row_mask:0xf bank_mask:0xf
    v_add_f32_dpp v184, v184, v184 quad_perm:[1,0,3,2] row_mask:0xf bank_mask:0xf
    v_add_f32_dpp v185, v185, v185 quad_perm:[1,0,3,2] row_mask:0xf bank_mask:0xf
    v_add_f32_dpp v186, v186, v186 quad_perm:[1,0,3,2] row_mask:0xf bank_mask:0xf
    v_add_f32_dpp v187, v187, v187 quad_perm:[1,0,3,2] row_mask:0xf bank_mask:0xf
    v_add_f32_dpp v188, v188, v188 quad_perm:[1,0,3,2] row_mask:0xf bank_mask:0xf
    v_add_f32_dpp v189, v189, v189 quad_perm:[1,0,3,2] row_mask:0xf bank_mask:0xf
    v_add_f32_dpp v190, v190, v190 quad_perm:[1,0,3,2] row_mask:0xf bank_mask:0xf
    v_add_f32_dpp v191, v191, v191 quad_perm:[1,0,3,2] row_mask:0xf bank_mask:0xf
    v_add_f32_dpp v192, v192, v192 quad_perm:[1,0,3,2] row_mask:0xf bank_mask:0xf
    v_add_f32_dpp v193, v193, v193 quad_perm:[1,0,3,2] row_mask:0xf bank_mask:0xf
    v_add_f32_dpp v194, v194, v194 quad_perm:[1,0,3,2] row_mask:0xf bank_mask:0xf
    v_add_f32_dpp v195, v195, v195 quad_perm:[1,0,3,2] row_mask:0xf bank_mask:0xf
    v_add_f32_dpp v196, v196, v196 quad_perm:[2,3,0,1] row_mask:0xf bank_mask:0xf
    v_add_f32_dpp v184, v184, v184 quad_perm:[2,3,0,1] row_mask:0xf bank_mask:0xf
    v_add_f32_dpp v185, v185, v185 quad_perm:[2,3,0,1] row_mask:0xf bank_mask:0xf
    v_add_f32_dpp v186, v186, v186 quad_perm:[2,3,0,1] row_mask:0xf bank_mask:0xf
    v_add_f32_dpp v187, v187, v187 quad_perm:[2,3,0,1] row_mask:0xf bank_mask:0xf
    v_add_f32_dpp v188, v188, v188 quad_perm:[2,3,0,1] row_mask:0xf bank_mask:0xf
    v_add_f32_dpp v189, v189, v189 quad_perm:[2,3,0,1] row_mask:0xf bank_mask:0xf
    v_add_f32_dpp v190, v190, v190 quad_perm:[2,3,0,1] row_mask:0xf bank_mask:0xf
    v_add_f32_dpp v191, v191, v191 quad_perm:[2,3,0,1] row_mask:0xf bank_mask:0xf
    v_add_f32_dpp v192, v192, v192 quad_perm:[2,3,0,1] row_mask:0xf bank_mask:0xf
    v_add_f32_dpp v193, v193, v193 quad_perm:[2,3,0,1] row_mask:0xf bank_mask:0xf
    v_add_f32_dpp v194, v194, v194 quad_perm:[2,3,0,1] row_mask:0xf bank_mask:0xf
    v_add_f32_dpp v195, v195, v195 quad_perm:[2,3,0,1] row_mask:0xf bank_mask:0xf
    v_add_f32_dpp v196, v196, v196 row_half_mirror row_mask:0xf bank_mask:0xf
    v_add_f32_dpp v184, v184, v184 row_half_mirror row_mask:0xf bank_mask:0xf
    v_add_f32_dpp v185, v185, v185 row_half_mirror row_mask:0xf bank_mask:0xf
    v_add_f32_dpp v186, v186, v186 row_half_mirror row_mask:0xf bank_mask:0xf
    v_add_f32_dpp v187, v187, v187 row_half_mirror row_mask:0xf bank_mask:0xf
    v_add_f32_dpp v188, v188, v188 row_half_mirror row_mask:0xf bank_mask:0xf
    v_add_f32_dpp v189, v189, v189 row_half_mirror row_mask:0xf bank_mask:0xf
    v_add_f32_dpp v190, v190, v190 row_half_mirror row_mask:0xf bank_mask:0xf
    v_add_f32_dpp v191, v191, v191 row_half_mirror row_mask:0xf bank_mask:0xf
    v_add_f32_dpp v192, v192, v192 row_half_mirror row_mask:0xf bank_mask:0xf
    v_add_f32_dpp v193, v193, v193 row_half_mirror row_mask:0xf bank_mask:0xf
    v_add_f32_dpp v194, v194, v194 row_half_mirror row_mask:0xf bank_mask:0xf
    v_add_f32_dpp v195, v195, v195 row_half_mirror row_mask:0xf bank_mask:0xf
    v_cndmask_b32 v184, v184, v187, s[60:61]
    v_cndmask_b32 v190, v190, v193, s[60:61]
    v_cndmask_b32 v185, v185, v188, s[60:61]
    v_cndmask_b32 v191, v191, v194, s[60:61]
    v_cndmask_b32 v186, v186, v189, s[60:61]
    v_cndmask_b32 v192, v192, v195, s[60:61]
    v_cndmask_b32 v184, v184, v190, s[62:63]
    v_cndmask_b32 v185, v185, v191, s[62:63]
    v_cndmask_b32 v186, v186, v192, s[62:63]
    v_cndmask_b32 v184, v184, v185, s[40:41]
    v_cndmask_b32 v186, v186, v196, s[40:41]
    buffer_atomic_add_f32 v184, v231, s[8:11], s48 offen
    buffer_atomic_add_f32 v186, v232, s[8:11], s48 offen
    s_lshl_b32 s32, s3, 13
    v_add_u32 v234, s32, v228
    v_add_u32 v235, 65536, v234
    ds_write_b128 v234, a[128:131] offset:0
    ds_write_b128 v234, a[132:135] offset:1024
    ds_write_b128 v234, a[136:139] offset:2048
    ds_write_b128 v234, a[140:143] offset:3072
    ds_write_b128 v234, a[144:147] offset:4096
    ds_write_b128 v234, a[148:151] offset:5120
    ds_write_b128 v234, a[152:155] offset:6144
    ds_write_b128 v234, a[156:159] offset:7168
    s_waitcnt lgkmcnt(4)
    ds_write_b128 v234, a[160:163] offset:32768
    ds_write_b128 v234, a[164:167] offset:33792
    ds_write_b128 v234, a[168:171] offset:34816
    ds_write_b128 v234, a[172:175] offset:35840
    ds_write_b128 v234, a[176:179] offset:36864
    ds_write_b128 v234, a[180:183] offset:37888
    ds_write_b128 v234, a[184:187] offset:38912
    ds_write_b128 v234, a[188:191] offset:39936
    s_waitcnt lgkmcnt(4)
    ds_write_b128 v235, a[192:195] offset:0
    ds_write_b128 v235, a[196:199] offset:1024
    ds_write_b128 v235, a[200:203] offset:2048
    ds_write_b128 v235, a[204:207] offset:3072
    ds_write_b128 v235, a[208:211] offset:4096
    ds_write_b128 v235, a[212:215] offset:5120
    ds_write_b128 v235, a[216:219] offset:6144
    ds_write_b128 v235, a[220:223] offset:7168
    s_waitcnt lgkmcnt(4)
    s_lshl_b32 s35, s3, 13
    v_bfe_u32 v234, v237, 2, 3
    v_lshrrev_b32 v235, 5, v237
    v_lshl_add_u32 v234, v235, 4, v234
    v_lshlrev_b32 v234, 5, v234
    v_and_b32 v236, 3, v237
    v_lshl_add_u32 v234, v236, 3, v234
    v_add_u32 v217, s35, v234
    v_lshlrev_b32 v235, 5, v235
    v_bfe_u32 v236, v237, 4, 1
    v_lshl_add_u32 v235, v236, 3, v235
    v_and_b32 v236, 1, v237
    v_lshl_add_u32 v235, v236, 11, v235
    s_lshl_b32 s32, s3, 9
    s_add_u32 s32, s32, 98304
    v_add_u32 v218, s32, v235
    v_lshlrev_b32 v234, 4, v230
    v_add_u32 v220, 106752, v234
    v_add_u32 v221, 106752, v228
    v_lshrrev_b32 v236, 2, v237
    v_lshlrev_b32 v236, 7, v236
    v_and_b32 v234, 3, v237
    v_lshl_add_u32 v236, v234, 3, v236
    s_add_u32 s32, s35, 65536
    v_add_u32 v219, s32, v236
    s_lshl_b32 s32, s3, 12
    s_add_u32 s32, s32, 114944
    v_and_b32 v234, 15, v237
    v_min_u32 v234, 2, v234
    v_lshlrev_b32 v234, 10, v234
    v_lshrrev_b32 v235, 4, v237
    v_lshl_add_u32 v234, v235, 4, v234
    v_add_u32 v222, s32, v234
    v_add_u32 v223, s32, v228
    s_waitcnt vmcnt(0)
    s_barrier
    s_cmp_lg_u32 s3, 0
    s_cbranch_scc1 kc_a1
    s_lshl_b32 s32, s52, 7
    s_add_u32 s32, s32, 0x38a0000
    v_mov_b32 v235, 1
    buffer_atomic_add v235, v243, s[8:11], s32 offen sc0 sc1
    v_lshlrev_b32 v234, 7, v237
    v_cmp_gt_u32 vcc, 8, v237
    v_mov_b32 v236, 0x40000000
    s_mov_b32 s34, 0x38a0400
    v_cndmask_b32 v234, v236, v234, vcc
    s_waitcnt vmcnt(0)
    v_readfirstlane_b32 s36, v235
    s_cmp_lg_u32 s36, 31
    s_cbranch_scc1 kc_a1
    buffer_atomic_add v233, v234, s[8:11], s34 offen sc1
kc_a1:
    s_waitcnt lgkmcnt(0)
    ds_read_b64_tr_b16 a[0:1], v217 offset:0
    ds_read_b64_tr_b16 a[2:3], v217 offset:256
    ds_read_b64_tr_b16 a[32:33], v217 offset:32768
    ds_read_b64_tr_b16 a[34:35], v217 offset:33024
    ds_read_b64_tr_b16 a[4:5], v217 offset:1024
    ds_read_b64_tr_b16 a[6:7], v217 offset:1280
    ds_read_b64_tr_b16 a[36:37], v217 offset:33792
    ds_read_b64_tr_b16 a[38:39], v217 offset:34048
    s_waitcnt lgkmcnt(6)
    ds_read_b64_tr_b16 a[8:9], v217 offset:2048
    ds_read_b64_tr_b16 a[10:11], v217 offset:2304
    ds_read_b64_tr_b16 a[40:41], v217 offset:34816
    ds_read_b64_tr_b16 a[42:43], v217 offset:35072
    ds_read_b64_tr_b16 a[12:13], v217 offset:3072
    ds_read_b64_tr_b16 a[14:15], v217 offset:3328
    ds_read_b64_tr_b16 a[44:45], v217 offset:35840
    ds_read_b64_tr_b16 a[46:47], v217 offset:36096
    s_waitcnt lgkmcnt(6)
    ds_read_b64_tr_b16 a[16:17], v217 offset:4096
    ds_read_b64_tr_b16 a[18:19], v217 offset:4352
    ds_read_b64_tr_b16 a[48:49], v217 offset:36864
    ds_read_b64_tr_b16 a[50:51], v217 offset:37120
    ds_read_b64_tr_b16 a[20:21], v217 offset:5120
    ds_read_b64_tr_b16 a[22:23], v217 offset:5376
    ds_read_b64_tr_b16 a[52:53], v217 offset:37888
    ds_read_b64_tr_b16 a[54:55], v217 offset:38144
    s_waitcnt lgkmcnt(6)
    ds_read_b64_tr_b16 a[24:25], v217 offset:6144
    ds_read_b64_tr_b16 a[26:27], v217 offset:6400
    ds_read_b64_tr_b16 a[56:57], v217 offset:38912
    ds_read_b64_tr_b16 a[58:59], v217 offset:39168
    ds_read_b64_tr_b16 a[28:29], v217 offset:7168
    ds_read_b64_tr_b16 a[30:31], v217 offset:7424
    ds_read_b64_tr_b16 a[60:61], v217 offset:39936
    ds_read_b64_tr_b16 a[62:63], v217 offset:40192
    s_waitcnt lgkmcnt(6)
    ds_read_b64_tr_b16 a[64:65], v219 offset:0
    ds_read_b64_tr_b16 a[66:67], v219 offset:32
    ds_read_b64_tr_b16 a[68:69], v219 offset:64
    ds_read_b64_tr_b16 a[70:71], v219 offset:96
    ds_read_b64_tr_b16 a[72:73], v219 offset:2048
    ds_read_b64_tr_b16 a[74:75], v219 offset:2080
    ds_read_b64_tr_b16 a[76:77], v219 offset:2112
    ds_read_b64_tr_b16 a[78:79], v219 offset:2144
    s_waitcnt lgkmcnt(6)
    ds_read_b64_tr_b16 a[80:81], v219 offset:4096
    ds_read_b64_tr_b16 a[82:83], v219 offset:4128
    ds_read_b64_tr_b16 a[84:85], v219 offset:4160
    ds_read_b64_tr_b16 a[86:87], v219 offset:4192
    ds_read_b64_tr_b16 a[88:89], v219 offset:6144
    ds_read_b64_tr_b16 a[90:91], v219 offset:6176
    ds_read_b64_tr_b16 a[92:93], v219 offset:6208
    ds_read_b64_tr_b16 a[94:95], v219 offset:6240
    s_waitcnt lgkmcnt(6)
    v_mov_b32 v130, 0x3a800000
    v_mov_b32 v131, 0x3a800000
    v_mov_b32 v132, 0x3727c5ac
    v_mov_b32 v133, 0x3727c5ac
    s_mov_b32 s33, 0xfffff800
    s_lshl_b32 s39, s3, 11
    v_add_u32 v238, s39, v228
    v_lshlrev_b32 v239, 2, v242
    s_lshl_b32 s39, s3, 3
    s_add_u32 s7, s39, 106512
    v_lshlrev_b32 v141, 5, v237
    v_or_b32 v141, s39, v141
    s_cmp_lg_u32 s3, 0
    s_cbranch_scc1 kc_b12
    s_lshl_b32 s32, s52, 7
    s_add_u32 s32, s32, 0x38a0400
    s_mov_b32 s34, 0x400000
    s_branch kc_b11
kc_b10:
    s_sleep 2
kc_b11:
    buffer_load_dword v235, off, s[8:11], s32 sc1
    s_waitcnt vmcnt(0)
    v_cmp_ne_u32 vcc, 8, v235
    s_sub_u32 s34, s34, 1
    s_cbranch_scc1 kc_b12
    s_cbranch_vccnz kc_b10
kc_b12:
    s_barrier
    s_add_u32 s32, s48, 24576
    buffer_load_dword v128, off, s[8:11], s32 sc1
    buffer_load_dwordx4 v[32:35], v238, s[8:11], s48 offen offset:0 sc1
    buffer_load_dwordx4 v[40:43], v238, s[8:11], s49 offen offset:0 sc1
    buffer_load_dwordx4 v[48:51], v238, s[8:11], s50 offen offset:0 sc1
    buffer_load_dwordx4 v[36:39], v238, s[8:11], s48 offen offset:1024 sc1
    buffer_load_dwordx4 v[44:47], v238, s[8:11], s49 offen offset:1024 sc1
    buffer_load_dwordx4 v[52:55], v238, s[8:11], s50 offen offset:1024 sc1
    buffer_load_dword v0, v239, s[8:11], s48 offen offset:0 sc1
    buffer_load_dword v4, v239, s[8:11], s49 offen offset:0 sc1
    buffer_load_dword v1, v239, s[8:11], s48 offen offset:32 sc1
    buffer_load_dword v5, v239, s[8:11], s49 offen offset:32 sc1
    buffer_load_dword v2, v239, s[8:11], s48 offen offset:64 sc1
    buffer_load_dword v6, v239, s[8:11], s49 offen offset:64 sc1
    buffer_load_dword v3, v239, s[8:11], s48 offen offset:96 sc1
    buffer_load_dword v7, v239, s[8:11], s49 offen offset:96 sc1
    s_waitcnt vmcnt(8)
    v_mov_b32 v129, v128
    v_pk_mul_f32 v[32:33], v[32:33], v[130:131]
    v_pk_mul_f32 v[34:35], v[34:35], v[130:131]
    v_pk_mul_f32 v[36:37], v[36:37], v[130:131]
    v_pk_mul_f32 v[38:39], v[38:39], v[130:131]
    v_pk_fma_f32 v[40:41], v[40:41], v[130:131], v[132:133]
    v_pk_fma_f32 v[42:43], v[42:43], v[130:131], v[132:133]
    v_pk_fma_f32 v[44:45], v[44:45], v[130:131], v[132:133]
    v_pk_fma_f32 v[46:47], v[46:47], v[130:131], v[132:133]
    v_pk_fma_f32 v[40:41], v[32:33], v[32:33], v[40:41] neg_lo:[1,0,0] neg_hi:[1,0,0]
    v_pk_fma_f32 v[42:43], v[34:35], v[34:35], v[42:43] neg_lo:[1,0,0] neg_hi:[1,0,0]
    v_pk_fma_f32 v[44:45], v[36:37], v[36:37], v[44:45] neg_lo:[1,0,0] neg_hi:[1,0,0]
    v_pk_fma_f32 v[46:47], v[38:39], v[38:39], v[46:47] neg_lo:[1,0,0] neg_hi:[1,0,0]
    v_pk_fma_f32 v[48:49], v[32:33], v[128:129], v[48:49] neg_lo:[1,0,0] neg_hi:[1,0,0]
    v_pk_fma_f32 v[50:51], v[34:35], v[128:129], v[50:51] neg_lo:[1,0,0] neg_hi:[1,0,0]
    v_pk_fma_f32 v[52:53], v[36:37], v[128:129], v[52:53] neg_lo:[1,0,0] neg_hi:[1,0,0]
    v_pk_fma_f32 v[54:55], v[38:39], v[128:129], v[54:55] neg_lo:[1,0,0] neg_hi:[1,0,0]
    v_max_f32 v40, v40, v132
    v_max_f32 v42, v42, v132
    v_max_f32 v44, v44, v132
    v_max_f32 v46, v46, v132
    v_max_f32 v41, v41, v132
    v_max_f32 v43, v43, v132
    v_max_f32 v45, v45, v132
    v_max_f32 v47, v47, v132
    v_rsq_f32 v40, v40
    v_rsq_f32 v42, v42
    v_rsq_f32 v44, v44
    v_rsq_f32 v46, v46
    v_rsq_f32 v41, v41
    v_rsq_f32 v43, v43
    v_rsq_f32 v45, v45
    v_rsq_f32 v47, v47
    v_pk_mul_f32 v[48:49], v[48:49], v[40:41]
    v_pk_mul_f32 v[50:51], v[50:51], v[42:43]
    v_pk_mul_f32 v[52:53], v[52:53], v[44:45]
    v_pk_mul_f32 v[54:55], v[54:55], v[46:47]
    v_and_or_b32 v48, v48, s33, 0
    v_and_or_b32 v50, v50, s33, 2
    v_and_or_b32 v52, v52, s33, 4
    v_and_or_b32 v54, v54, s33, 6
    v_and_or_b32 v49, v49, s33, 1
    v_and_or_b32 v51, v51, s33, 3
    v_and_or_b32 v53, v53, s33, 5
    v_and_or_b32 v55, v55, s33, 7
    v_max_f32 v136, v48, v49
    v_min_f32 v137, v48, v49
    v_med3_f32 v137, v136, v50, v137
    v_max_f32 v136, v136, v50
    v_med3_f32 v137, v136, v51, v137
    v_max_f32 v136, v136, v51
    v_med3_f32 v137, v136, v52, v137
    v_max_f32 v136, v136, v52
    v_med3_f32 v137, v136, v53, v137
    v_max_f32 v136, v136, v53
    v_med3_f32 v137, v136, v54, v137
    v_max_f32 v136, v136, v54
    v_med3_f32 v137, v136, v55, v137
    v_max_f32 v136, v136, v55
    v_or_b32 v136, v141, v136
    v_or_b32 v137, v141, v137
    s_nop 1
    v_mov_b32_dpp v138, v136 quad_perm:[1,0,3,2] row_mask:0xf bank_mask:0xf
    v_mov_b32_dpp v139, v137 quad_perm:[1,0,3,2] row_mask:0xf bank_mask:0xf
    v_min_f32 v140, v136, v138
    v_max_f32 v136, v136, v138
    v_max3_f32 v137, v140, v137, v139
    s_nop 1
    v_mov_b32_dpp v138, v136 quad_perm:[2,3,0,1] row_mask:0xf bank_mask:0xf
    v_mov_b32_dpp v139, v137 quad_perm:[2,3,0,1] row_mask:0xf bank_mask:0xf
    v_min_f32 v140, v136, v138
    v_max_f32 v136, v136, v138
    v_max3_f32 v137, v140, v137, v139
    s_nop 1
    v_mov_b32_dpp v138, v136 row_half_mirror row_mask:0xf bank_mask:0xf
    v_mov_b32_dpp v139, v137 row_half_mirror row_mask:0xf bank_mask:0xf
    v_min_f32 v140, v136, v138
    v_max_f32 v136, v136, v138
    v_max3_f32 v137, v140, v137, v139
    s_nop 1
    v_mov_b32_dpp v138, v136 row_mirror row_mask:0xf bank_mask:0xf
    v_mov_b32_dpp v139, v137 row_mirror row_mask:0xf bank_mask:0xf
    v_min_f32 v140, v136, v138
    v_max_f32 v136, v136, v138
    v_max3_f32 v137, v140, v137, v139
    v_mov_b32 v138, v136
    v_mov_b32 v139, v137
    s_nop 1
    v_permlane16_swap_b32 v136, v138
    v_permlane16_swap_b32 v137, v139
    s_nop 0
    v_min_f32 v140, v136, v138
    v_max_f32 v136, v136, v138
    v_max3_f32 v137, v140, v137, v139
    v_mov_b32 v138, v136
    v_mov_b32 v139, v137
    s_nop 1
    v_permlane32_swap_b32 v136, v138
    v_permlane32_swap_b32 v137, v139
    s_nop 0
    v_min_f32 v140, v136, v138
    v_max_f32 v136, v136, v138
    v_max3_f32 v137, v140, v137, v139
    v_mov_b32 v234, s7
    ds_write_b64 v234, v[136:137]
    v_mov_b32 v234, 106512
    s_waitcnt lgkmcnt(0)
    s_barrier
    ds_read_b128 v[56:59], v234
    ds_read_b128 v[60:63], v234 offset:16
    s_waitcnt lgkmcnt(0)
    v_min_f32 v140, v56, v58
    v_max_f32 v56, v56, v58
    v_max3_f32 v57, v140, v57, v59
    v_min_f32 v140, v60, v62
    v_max_f32 v60, v60, v62
    v_max3_f32 v61, v140, v61, v63
    v_min_f32 v140, v56, v60
    v_max_f32 v56, v56, v60
    v_max3_f32 v57, v140, v57, v61
    v_bfe_u32 v234, v56, 5, 6
    v_bfe_u32 v235, v56, 2, 3
    v_and_b32 v8, 3, v56
    v_lshl_add_u32 v8, v234, 2, v8
    v_lshl_add_u32 v8, v235, 8, v8
    v_bfe_u32 v234, v57, 5, 6
    v_bfe_u32 v235, v57, 2, 3
    v_and_b32 v10, 3, v57
    v_lshl_add_u32 v10, v234, 2, v10
    v_lshl_add_u32 v10, v235, 8, v10
    s_cmp_lt_u32 s3, 2
    s_cselect_b64 vcc, -1, 0
    v_lshlrev_b32 v236, 4, v230
    v_cndmask_b32 v142, v10, v8, vcc
    v_lshlrev_b32 v234, 2, v142
    v_and_b32 v235, 2047, v236
    v_lshl_add_u32 v235, v142, 11, v235
    s_mov_b32 s32, 0x3400000
    buffer_load_dwordx4 v[32:35], v235, s[8:11], s32 offen sc1
    buffer_load_dword v144, v234, s[8:11], s48 offen sc1
    buffer_load_dword v145, v234, s[8:11], s49 offen sc1
    buffer_load_dword v146, v234, s[8:11], s50 offen sc1
    v_add_u32 v236, 98304, v236
    s_lshr_b32 s32, s3, 1
    s_lshl_b32 s32, s32, 2
    s_add_u32 s32, s32, 106496
    v_mov_b32 v234, s32
    s_waitcnt vmcnt(4)
    v_mul_f32 v0, 0x3a800000, v0
    v_mul_f32 v1, 0x3a800000, v1
    v_mul_f32 v2, 0x3a800000, v2
    v_mul_f32 v3, 0x3a800000, v3
    v_mul_f32 v4, 0x3a800000, v4
    v_mul_f32 v5, 0x3a800000, v5
    v_mul_f32 v6, 0x3a800000, v6
    v_mul_f32 v7, 0x3a800000, v7
    v_fma_f32 v4, -v0, v0, v4
    v_fma_f32 v5, -v1, v1, v5
    v_fma_f32 v6, -v2, v2, v6
    v_fma_f32 v7, -v3, v3, v7
    v_max_f32 v4, 0, v4
    v_max_f32 v5, 0, v5
    v_max_f32 v6, 0, v6
    v_max_f32 v7, 0, v7
    v_cvt_pk_bf16_f32 v12, v0, v4
    v_cvt_pk_bf16_f32 v13, v1, v5
    v_cvt_pk_bf16_f32 v14, v2, v6
    v_cvt_pk_bf16_f32 v15, v3, v7
    v_lshlrev_b32 v0, 16, v12
    v_lshlrev_b32 v1, 16, v13
    v_lshlrev_b32 v2, 16, v14
    v_lshlrev_b32 v3, 16, v15
    v_and_b32 v4, 0xffff0000, v12
    v_and_b32 v5, 0xffff0000, v13
    v_and_b32 v6, 0xffff0000, v14
    v_and_b32 v7, 0xffff0000, v15
    v_add_f32 v4, 0x3727c5ac, v4
    v_add_f32 v5, 0x3727c5ac, v5
    v_add_f32 v6, 0x3727c5ac, v6
    v_add_f32 v7, 0x3727c5ac, v7
    v_cvt_pk_bf16_f32 v4, v4, v4
    v_cvt_pk_bf16_f32 v5, v5, v5
    v_cvt_pk_bf16_f32 v6, v6, v6
    v_cvt_pk_bf16_f32 v7, v7, v7
    v_lshlrev_b32 v4, 16, v4
    v_lshlrev_b32 v5, 16, v5
    v_lshlrev_b32 v6, 16, v6
    v_lshlrev_b32 v7, 16, v7
    v_sqrt_f32 v4, v4
    v_sqrt_f32 v5, v5
    v_sqrt_f32 v6, v6
    v_sqrt_f32 v7, v7
    v_cvt_pk_bf16_f32 v4, v4, v4
    v_cvt_pk_bf16_f32 v5, v5, v5
    v_cvt_pk_bf16_f32 v6, v6, v6
    v_cvt_pk_bf16_f32 v7, v7, v7
    v_lshlrev_b32 v4, 16, v4
    v_lshlrev_b32 v5, 16, v5
    v_lshlrev_b32 v6, 16, v6
    v_lshlrev_b32 v7, 16, v7
    v_rcp_f32 v4, v4
    v_rcp_f32 v5, v5
    v_rcp_f32 v6, v6
    v_rcp_f32 v7, v7
    s_waitcnt vmcnt(0)
    v_mul_f32 v144, 0x3a800000, v144
    v_mul_f32 v145, 0x3a800000, v145
    v_fma_f32 v145, -v144, v144, v145
    v_max_f32 v145, 0, v145
    v_cvt_pk_bf16_f32 v140, v144, v145
    v_lshlrev_b32 v144, 16, v140
    v_and_b32 v145, 0xffff0000, v140
    v_add_f32 v145, 0x3727c5ac, v145
    v_cvt_pk_bf16_f32 v145, v145, v145
    v_lshlrev_b32 v145, 16, v145
    v_sqrt_f32 v145, v145
    s_nop 0
    v_cvt_pk_bf16_f32 v145, v145, v145
    v_lshlrev_b32 v145, 16, v145
    v_rcp_f32 v145, v145
    s_nop 0
    v_lshlrev_b32 v64, 16, v32
    v_lshlrev_b32 v66, 16, v33
    v_lshlrev_b32 v68, 16, v34
    v_lshlrev_b32 v70, 16, v35
    v_and_b32 v65, 0xffff0000, v32
    v_and_b32 v67, 0xffff0000, v33
    v_and_b32 v69, 0xffff0000, v34
    v_and_b32 v71, 0xffff0000, v35
    v_sub_f32 v64, v64, v144
    v_sub_f32 v66, v66, v144
    v_sub_f32 v68, v68, v144
    v_sub_f32 v70, v70, v144
    v_sub_f32 v65, v65, v144
    v_sub_f32 v67, v67, v144
    v_sub_f32 v69, v69, v144
    v_sub_f32 v71, v71, v144
    v_cvt_pk_bf16_f32 v65, v64, v65
    v_cvt_pk_bf16_f32 v67, v66, v67
    v_cvt_pk_bf16_f32 v69, v68, v69
    v_cvt_pk_bf16_f32 v71, v70, v71
    v_lshlrev_b32 v64, 16, v65
    v_lshlrev_b32 v66, 16, v67
    v_lshlrev_b32 v68, 16, v69
    v_lshlrev_b32 v70, 16, v71
    v_and_b32 v65, 0xffff0000, v65
    v_and_b32 v67, 0xffff0000, v67
    v_and_b32 v69, 0xffff0000, v69
    v_and_b32 v71, 0xffff0000, v71
    v_mul_f32 v64, v64, v145
    v_mul_f32 v66, v66, v145
    v_mul_f32 v68, v68, v145
    v_mul_f32 v70, v70, v145
    v_mul_f32 v65, v65, v145
    v_mul_f32 v67, v67, v145
    v_mul_f32 v69, v69, v145
    v_mul_f32 v71, v71, v145
    v_cvt_pk_bf16_f32 v48, v64, v65
    v_cvt_pk_bf16_f32 v49, v66, v67
    v_cvt_pk_bf16_f32 v50, v68, v69
    v_cvt_pk_bf16_f32 v51, v70, v71
    ds_write_b128 v236, v[48:51]
    ds_write_b128 v236, v[32:35] offset:4096
    v_fma_f32 v143, -v144, v128, v146
    v_mul_f32 v143, v143, v145
    ds_write_b32 v234, v143
    s_waitcnt lgkmcnt(0)
kc_com:
    s_barrier
    s_cmp_ge_u32 s53, 28
    s_cbranch_scc1 kc_red
    ds_read_b64 v[96:97], v218 offset:0
    ds_read_b64 v[98:99], v218 offset:16
    ds_read_b64 v[100:101], v218 offset:64
    ds_read_b64 v[102:103], v218 offset:80
    ds_read_b64 v[104:105], v218 offset:128
    ds_read_b64 v[106:107], v218 offset:144
    ds_read_b64 v[108:109], v218 offset:192
    ds_read_b64 v[110:111], v218 offset:208
    ds_read_b64 v[112:113], v218 offset:256
    ds_read_b64 v[114:115], v218 offset:272
    ds_read_b64 v[116:117], v218 offset:320
    ds_read_b64 v[118:119], v218 offset:336
    ds_read_b64 v[120:121], v218 offset:384
    ds_read_b64 v[122:123], v218 offset:400
    s_waitcnt lgkmcnt(12)
    ds_read_b64 v[124:125], v218 offset:448
    ds_read_b64 v[126:127], v218 offset:464
    v_mfma_f32_16x16x32_bf16 v[128:131], a[0:3], v[96:99], 0
    v_mfma_f32_16x16x32_bf16 v[132:135], a[32:35], v[96:99], 0
    s_waitcnt lgkmcnt(12)
    v_mfma_f32_16x16x32_bf16 v[128:131], a[4:7], v[100:103], v[128:131]
    v_mfma_f32_16x16x32_bf16 v[132:135], a[36:39], v[100:103], v[132:135]
    s_waitcnt lgkmcnt(10)
    v_mfma_f32_16x16x32_bf16 v[128:131], a[8:11], v[104:107], v[128:131]
    v_mfma_f32_16x16x32_bf16 v[132:135], a[40:43], v[104:107], v[132:135]
    s_waitcnt lgkmcnt(8)
    v_mfma_f32_16x16x32_bf16 v[128:131], a[12:15], v[108:111], v[128:131]
    v_mfma_f32_16x16x32_bf16 v[132:135], a[44:47], v[108:111], v[132:135]
    s_waitcnt lgkmcnt(6)
    v_mfma_f32_16x16x32_bf16 v[128:131], a[16:19], v[112:115], v[128:131]
    v_mfma_f32_16x16x32_bf16 v[132:135], a[48:51], v[112:115], v[132:135]
    s_waitcnt lgkmcnt(4)
    v_mfma_f32_16x16x32_bf16 v[128:131], a[20:23], v[116:119], v[128:131]
    v_mfma_f32_16x16x32_bf16 v[132:135], a[52:55], v[116:119], v[132:135]
    s_waitcnt lgkmcnt(2)
    v_mfma_f32_16x16x32_bf16 v[128:131], a[24:27], v[120:123], v[128:131]
    v_mfma_f32_16x16x32_bf16 v[132:135], a[56:59], v[120:123], v[132:135]
    s_waitcnt lgkmcnt(0)
    v_mfma_f32_16x16x32_bf16 v[128:131], a[28:31], v[124:127], v[128:131]
    v_mfma_f32_16x16x32_bf16 v[132:135], a[60:63], v[124:127], v[132:135]
    s_nop 6
    ds_write_b128 v220, v[128:131]
    ds_write_b128 v220, v[132:135] offset:4096
    s_waitcnt lgkmcnt(0)
    s_barrier
    ds_read_b128 v[32:35], v221 offset:0
    ds_read_b128 v[48:51], v221 offset:4096
    ds_read_b128 v[36:39], v221 offset:1024
    ds_read_b128 v[52:55], v221 offset:5120
    ds_read_b128 v[40:43], v221 offset:2048
    ds_read_b128 v[56:59], v221 offset:6144
    ds_read_b128 v[44:47], v221 offset:3072
    ds_read_b128 v[60:63], v221 offset:7168
    s_waitcnt lgkmcnt(0)
    v_add_f32 v32, v32, v36
    v_add_f32 v33, v33, v37
    v_add_f32 v34, v34, v38
    v_add_f32 v35, v35, v39
    v_add_f32 v40, v40, v44
    v_add_f32 v41, v41, v45
    v_add_f32 v42, v42, v46
    v_add_f32 v43, v43, v47
    v_add_f32 v48, v48, v52
    v_add_f32 v49, v49, v53
    v_add_f32 v50, v50, v54
    v_add_f32 v51, v51, v55
    v_add_f32 v56, v56, v60
    v_add_f32 v57, v57, v61
    v_add_f32 v58, v58, v62
    v_add_f32 v59, v59, v63
    v_add_f32 v32, v32, v40
    v_add_f32 v33, v33, v41
    v_add_f32 v34, v34, v42
    v_add_f32 v35, v35, v43
    v_add_f32 v48, v48, v56
    v_add_f32 v49, v49, v57
    v_add_f32 v50, v50, v58
    v_add_f32 v51, v51, v59
    v_cvt_pk_bf16_f32 v48, v32, v48
    v_cvt_pk_bf16_f32 v49, v33, v49
    v_cvt_pk_bf16_f32 v50, v34, v50
    v_cvt_pk_bf16_f32 v51, v35, v51
    v_lshlrev_b32 v32, 16, v48
    v_lshlrev_b32 v33, 16, v49
    v_lshlrev_b32 v34, 16, v50
    v_lshlrev_b32 v35, 16, v51
    v_and_b32 v48, 0xffff0000, v48
    v_and_b32 v49, 0xffff0000, v49
    v_and_b32 v50, 0xffff0000, v50
    v_and_b32 v51, 0xffff0000, v51
    v_mul_f32 v136, 0xbfb8aa3b, v32
    v_mul_f32 v137, 0xbfb8aa3b, v33
    v_mul_f32 v138, 0xbfb8aa3b, v34
    v_mul_f32 v139, 0xbfb8aa3b, v35
    v_exp_f32 v136, v136
    v_exp_f32 v137, v137
    v_exp_f32 v138, v138
    v_exp_f32 v139, v139
    v_add_f32 v136, 1.0, v136
    v_add_f32 v137, 1.0, v137
    v_add_f32 v138, 1.0, v138
    v_add_f32 v139, 1.0, v139
    v_rcp_f32 v136, v136
    v_rcp_f32 v137, v137
    v_rcp_f32 v138, v138
    v_rcp_f32 v139, v139
    v_mul_f32 v32, v32, v136
    v_mul_f32 v33, v33, v137
    v_mul_f32 v34, v34, v138
    v_mul_f32 v35, v35, v139
    v_cvt_pk_bf16_f32 v32, v32, v32
    v_cvt_pk_bf16_f32 v33, v33, v33
    v_cvt_pk_bf16_f32 v34, v34, v34
    v_cvt_pk_bf16_f32 v35, v35, v35
    v_lshlrev_b32 v32, 16, v32
    v_lshlrev_b32 v33, 16, v33
    v_lshlrev_b32 v34, 16, v34
    v_lshlrev_b32 v35, 16, v35
    v_mul_f32 v32, v32, v48
    v_mul_f32 v33, v33, v49
    v_mul_f32 v34, v34, v50
    v_mul_f32 v35, v35, v51
    v_cvt_pk_bf16_f32 v128, v32, v33
    v_cvt_pk_bf16_f32 v129, v34, v35
    s_nop 1
    v_mfma_f32_16x16x16_bf16 v[64:67], a[64:65], v[128:129], 0
    v_mfma_f32_16x16x16_bf16 v[68:71], a[66:67], v[128:129], 0
    v_mfma_f32_16x16x16_bf16 v[72:75], a[68:69], v[128:129], 0
    v_mfma_f32_16x16x16_bf16 v[76:79], a[70:71], v[128:129], 0
    v_mfma_f32_16x16x16_bf16 v[80:83], a[72:73], v[128:129], 0
    v_mfma_f32_16x16x16_bf16 v[84:87], a[74:75], v[128:129], 0
    v_mfma_f32_16x16x16_bf16 v[88:91], a[76:77], v[128:129], 0
    v_mfma_f32_16x16x16_bf16 v[92:95], a[78:79], v[128:129], 0
    v_mfma_f32_16x16x16_bf16 v[96:99], a[80:81], v[128:129], 0
    ds_write_b128 v222, v[64:67] offset:0
    v_mfma_f32_16x16x16_bf16 v[100:103], a[82:83], v[128:129], 0
    ds_write_b128 v222, v[68:71] offset:64
    v_mfma_f32_16x16x16_bf16 v[104:107], a[84:85], v[128:129], 0
    ds_write_b128 v222, v[72:75] offset:128
    v_mfma_f32_16x16x16_bf16 v[108:111], a[86:87], v[128:129], 0
    ds_write_b128 v222, v[76:79] offset:192
    v_mfma_f32_16x16x16_bf16 v[112:115], a[88:89], v[128:129], 0
    ds_write_b128 v222, v[80:83] offset:256
    v_mfma_f32_16x16x16_bf16 v[116:119], a[90:91], v[128:129], 0
    ds_write_b128 v222, v[84:87] offset:320
    v_mfma_f32_16x16x16_bf16 v[120:123], a[92:93], v[128:129], 0
    ds_write_b128 v222, v[88:91] offset:384
    v_mfma_f32_16x16x16_bf16 v[124:127], a[94:95], v[128:129], 0
    ds_write_b128 v222, v[92:95] offset:448
    s_waitcnt lgkmcnt(4)
    ds_write_b128 v222, v[96:99] offset:512
    ds_write_b128 v222, v[100:103] offset:576
    ds_write_b128 v222, v[104:107] offset:640
    ds_write_b128 v222, v[108:111] offset:704
    ds_write_b128 v222, v[112:115] offset:768
    ds_write_b128 v222, v[116:119] offset:832
    ds_write_b128 v222, v[120:123] offset:896
    ds_write_b128 v222, v[124:127] offset:960
    s_lshl_b32 s32, s54, 13
    s_lshl_b32 s33, s3, 10
    s_add_u32 s32, s32, s33
    s_add_u32 s32, s32, 0x3900000
    s_add_u32 s33, s32, 4096
    s_waitcnt lgkmcnt(0)
    ds_read_b128 v[32:35], v223
    ds_read_b128 v[36:39], v223 offset:1024
    s_waitcnt lgkmcnt(1)
    buffer_store_dwordx4 v[32:35], v228, s[8:11], s32 offen sc1
    s_waitcnt lgkmcnt(0)
    buffer_store_dwordx4 v[36:39], v228, s[8:11], s33 offen sc1
    v_lshlrev_b32 v144, 16, v16
    v_lshlrev_b32 v148, 16, v17
    v_lshlrev_b32 v152, 16, v18
    v_lshlrev_b32 v156, 16, v19
    v_and_b32 v145, 0xffff0000, v16
    v_and_b32 v149, 0xffff0000, v17
    v_and_b32 v153, 0xffff0000, v18
    v_and_b32 v157, 0xffff0000, v19
    v_sub_f32 v144, v144, v0
    v_sub_f32 v148, v148, v0
    v_sub_f32 v152, v152, v0
    v_sub_f32 v156, v156, v0
    v_sub_f32 v145, v145, v0
    v_sub_f32 v149, v149, v0
    v_sub_f32 v153, v153, v0
    v_sub_f32 v157, v157, v0
    v_cvt_pk_bf16_f32 v145, v144, v145
    v_cvt_pk_bf16_f32 v149, v148, v149
    v_cvt_pk_bf16_f32 v153, v152, v153
    v_cvt_pk_bf16_f32 v157, v156, v157
    v_lshlrev_b32 v144, 16, v145
    v_lshlrev_b32 v148, 16, v149
    v_lshlrev_b32 v152, 16, v153
    v_lshlrev_b32 v156, 16, v157
    v_and_b32 v145, 0xffff0000, v145
    v_and_b32 v149, 0xffff0000, v149
    v_and_b32 v153, 0xffff0000, v153
    v_and_b32 v157, 0xffff0000, v157
    v_mul_f32 v144, v144, v4
    v_mul_f32 v148, v148, v4
    v_mul_f32 v152, v152, v4
    v_mul_f32 v156, v156, v4
    v_mul_f32 v145, v145, v4
    v_mul_f32 v149, v149, v4
    v_mul_f32 v153, v153, v4
    v_mul_f32 v157, v157, v4
    v_cvt_pk_bf16_f32 v146, v144, v145
    v_cvt_pk_bf16_f32 v150, v148, v149
    v_cvt_pk_bf16_f32 v154, v152, v153
    v_cvt_pk_bf16_f32 v158, v156, v157
    v_lshlrev_b32 v144, 16, v146
    v_lshlrev_b32 v148, 16, v150
    v_lshlrev_b32 v152, 16, v154
    v_lshlrev_b32 v156, 16, v158
    v_and_b32 v145, 0xffff0000, v146
    v_and_b32 v149, 0xffff0000, v150
    v_and_b32 v153, 0xffff0000, v154
    v_and_b32 v157, 0xffff0000, v158
    v_lshlrev_b32 v146, 16, v16
    v_lshlrev_b32 v150, 16, v17
    v_lshlrev_b32 v154, 16, v18
    v_lshlrev_b32 v158, 16, v19
    v_and_b32 v147, 0xffff0000, v16
    v_and_b32 v151, 0xffff0000, v17
    v_and_b32 v155, 0xffff0000, v18
    v_and_b32 v159, 0xffff0000, v19
    v_pk_add_f32 v[144:145], v[144:145], v[146:147]
    v_pk_add_f32 v[148:149], v[148:149], v[150:151]
    v_pk_add_f32 v[152:153], v[152:153], v[154:155]
    v_pk_add_f32 v[156:157], v[156:157], v[158:159]
    v_cvt_pk_bf16_f32 v16, v144, v145
    v_cvt_pk_bf16_f32 v17, v148, v149
    v_cvt_pk_bf16_f32 v18, v152, v153
    v_cvt_pk_bf16_f32 v19, v156, v157
    v_add_u32 v160, 0, v242
    v_cmp_eq_u32 vcc, v160, v8
    v_cmp_eq_u32 s[60:61], v160, v10
    v_mov_b32 v161, 0x40000000
    s_or_b64 vcc, vcc, s[60:61]
    v_cndmask_b32 v12, v229, v161, vcc
    v_lshlrev_b32 v144, 16, v20
    v_lshlrev_b32 v148, 16, v21
    v_lshlrev_b32 v152, 16, v22
    v_lshlrev_b32 v156, 16, v23
    v_and_b32 v145, 0xffff0000, v20
    v_and_b32 v149, 0xffff0000, v21
    v_and_b32 v153, 0xffff0000, v22
    v_and_b32 v157, 0xffff0000, v23
    v_sub_f32 v144, v144, v1
    v_sub_f32 v148, v148, v1
    v_sub_f32 v152, v152, v1
    v_sub_f32 v156, v156, v1
    v_sub_f32 v145, v145, v1
    v_sub_f32 v149, v149, v1
    v_sub_f32 v153, v153, v1
    v_sub_f32 v157, v157, v1
    v_cvt_pk_bf16_f32 v145, v144, v145
    v_cvt_pk_bf16_f32 v149, v148, v149
    v_cvt_pk_bf16_f32 v153, v152, v153
    v_cvt_pk_bf16_f32 v157, v156, v157
    v_lshlrev_b32 v144, 16, v145
    v_lshlrev_b32 v148, 16, v149
    v_lshlrev_b32 v152, 16, v153
    v_lshlrev_b32 v156, 16, v157
    v_and_b32 v145, 0xffff0000, v145
    v_and_b32 v149, 0xffff0000, v149
    v_and_b32 v153, 0xffff0000, v153
    v_and_b32 v157, 0xffff0000, v157
    v_mul_f32 v144, v144, v5
    v_mul_f32 v148, v148, v5
    v_mul_f32 v152, v152, v5
    v_mul_f32 v156, v156, v5
    v_mul_f32 v145, v145, v5
    v_mul_f32 v149, v149, v5
    v_mul_f32 v153, v153, v5
    v_mul_f32 v157, v157, v5
    v_cvt_pk_bf16_f32 v146, v144, v145
    v_cvt_pk_bf16_f32 v150, v148, v149
    v_cvt_pk_bf16_f32 v154, v152, v153
    v_cvt_pk_bf16_f32 v158, v156, v157
    v_lshlrev_b32 v144, 16, v146
    v_lshlrev_b32 v148, 16, v150
    v_lshlrev_b32 v152, 16, v154
    v_lshlrev_b32 v156, 16, v158
    v_and_b32 v145, 0xffff0000, v146
    v_and_b32 v149, 0xffff0000, v150
    v_and_b32 v153, 0xffff0000, v154
    v_and_b32 v157, 0xffff0000, v158
    v_lshlrev_b32 v146, 16, v20
    v_lshlrev_b32 v150, 16, v21
    v_lshlrev_b32 v154, 16, v22
    v_lshlrev_b32 v158, 16, v23
    v_and_b32 v147, 0xffff0000, v20
    v_and_b32 v151, 0xffff0000, v21
    v_and_b32 v155, 0xffff0000, v22
    v_and_b32 v159, 0xffff0000, v23
    v_pk_add_f32 v[144:145], v[144:145], v[146:147]
    v_pk_add_f32 v[148:149], v[148:149], v[150:151]
    v_pk_add_f32 v[152:153], v[152:153], v[154:155]
    v_pk_add_f32 v[156:157], v[156:157], v[158:159]
    v_cvt_pk_bf16_f32 v20, v144, v145
    v_cvt_pk_bf16_f32 v21, v148, v149
    v_cvt_pk_bf16_f32 v22, v152, v153
    v_cvt_pk_bf16_f32 v23, v156, v157
    v_add_u32 v160, 8, v242
    v_cmp_eq_u32 vcc, v160, v8
    v_cmp_eq_u32 s[60:61], v160, v10
    v_mov_b32 v161, 0x40000000
    s_or_b64 vcc, vcc, s[60:61]
    v_cndmask_b32 v13, v229, v161, vcc
    s_waitcnt vmcnt(0)
    s_barrier
    s_cmp_lg_u32 s3, 0
    s_cbranch_scc1 kc_a2
    s_lshl_b32 s32, s52, 7
    s_add_u32 s32, s32, 0x38a0800
    v_mov_b32 v235, 1
    buffer_atomic_add v235, v243, s[8:11], s32 offen sc0 sc1
    v_lshlrev_b32 v234, 7, v237
    v_cmp_gt_u32 vcc, 8, v237
    v_mov_b32 v236, 0x40000000
    s_mov_b32 s34, 0x38a0c00
    v_cndmask_b32 v234, v236, v234, vcc
    s_waitcnt vmcnt(0)
    v_readfirstlane_b32 s36, v235
    s_cmp_lg_u32 s36, 27
    s_cbranch_scc1 kc_a2
    buffer_atomic_add v233, v234, s[8:11], s34 offen sc1
kc_a2:
    v_lshlrev_b32 v144, 16, v24
    v_lshlrev_b32 v148, 16, v25
    v_lshlrev_b32 v152, 16, v26
    v_lshlrev_b32 v156, 16, v27
    v_and_b32 v145, 0xffff0000, v24
    v_and_b32 v149, 0xffff0000, v25
    v_and_b32 v153, 0xffff0000, v26
    v_and_b32 v157, 0xffff0000, v27
    v_sub_f32 v144, v144, v2
    v_sub_f32 v148, v148, v2
    v_sub_f32 v152, v152, v2
    v_sub_f32 v156, v156, v2
    v_sub_f32 v145, v145, v2
    v_sub_f32 v149, v149, v2
    v_sub_f32 v153, v153, v2
    v_sub_f32 v157, v157, v2
    v_cvt_pk_bf16_f32 v145, v144, v145
    v_cvt_pk_bf16_f32 v149, v148, v149
    v_cvt_pk_bf16_f32 v153, v152, v153
    v_cvt_pk_bf16_f32 v157, v156, v157
    v_lshlrev_b32 v144, 16, v145
    v_lshlrev_b32 v148, 16, v149
    v_lshlrev_b32 v152, 16, v153
    v_lshlrev_b32 v156, 16, v157
    v_and_b32 v145, 0xffff0000, v145
    v_and_b32 v149, 0xffff0000, v149
    v_and_b32 v153, 0xffff0000, v153
    v_and_b32 v157, 0xffff0000, v157
    v_mul_f32 v144, v144, v6
    v_mul_f32 v148, v148, v6
    v_mul_f32 v152, v152, v6
    v_mul_f32 v156, v156, v6
    v_mul_f32 v145, v145, v6
    v_mul_f32 v149, v149, v6
    v_mul_f32 v153, v153, v6
    v_mul_f32 v157, v157, v6
    v_cvt_pk_bf16_f32 v146, v144, v145
    v_cvt_pk_bf16_f32 v150, v148, v149
    v_cvt_pk_bf16_f32 v154, v152, v153
    v_cvt_pk_bf16_f32 v158, v156, v157
    v_lshlrev_b32 v144, 16, v146
    v_lshlrev_b32 v148, 16, v150
    v_lshlrev_b32 v152, 16, v154
    v_lshlrev_b32 v156, 16, v158
    v_and_b32 v145, 0xffff0000, v146
    v_and_b32 v149, 0xffff0000, v150
    v_and_b32 v153, 0xffff0000, v154
    v_and_b32 v157, 0xffff0000, v158
    v_lshlrev_b32 v146, 16, v24
    v_lshlrev_b32 v150, 16, v25
    v_lshlrev_b32 v154, 16, v26
    v_lshlrev_b32 v158, 16, v27
    v_and_b32 v147, 0xffff0000, v24
    v_and_b32 v151, 0xffff0000, v25
    v_and_b32 v155, 0xffff0000, v26
    v_and_b32 v159, 0xffff0000, v27
    v_pk_add_f32 v[144:145], v[144:145], v[146:147]
    v_pk_add_f32 v[148:149], v[148:149], v[150:151]
    v_pk_add_f32 v[152:153], v[152:153], v[154:155]
    v_pk_add_f32 v[156:157], v[156:157], v[158:159]
    v_cvt_pk_bf16_f32 v24, v144, v145
    v_cvt_pk_bf16_f32 v25, v148, v149
    v_cvt_pk_bf16_f32 v26, v152, v153
    v_cvt_pk_bf16_f32 v27, v156, v157
    v_add_u32 v160, 16, v242
    v_cmp_eq_u32 vcc, v160, v8
    v_cmp_eq_u32 s[60:61], v160, v10
    v_mov_b32 v161, 0x40000000
    s_or_b64 vcc, vcc, s[60:61]
    v_cndmask_b32 v14, v229, v161, vcc
    v_lshlrev_b32 v144, 16, v28
    v_lshlrev_b32 v148, 16, v29
    v_lshlrev_b32 v152, 16, v30
    v_lshlrev_b32 v156, 16, v31
    v_and_b32 v145, 0xffff0000, v28
    v_and_b32 v149, 0xffff0000, v29
    v_and_b32 v153, 0xffff0000, v30
    v_and_b32 v157, 0xffff0000, v31
    v_sub_f32 v144, v144, v3
    v_sub_f32 v148, v148, v3
    v_sub_f32 v152, v152, v3
    v_sub_f32 v156, v156, v3
    v_sub_f32 v145, v145, v3
    v_sub_f32 v149, v149, v3
    v_sub_f32 v153, v153, v3
    v_sub_f32 v157, v157, v3
    v_cvt_pk_bf16_f32 v145, v144, v145
    v_cvt_pk_bf16_f32 v149, v148, v149
    v_cvt_pk_bf16_f32 v153, v152, v153
    v_cvt_pk_bf16_f32 v157, v156, v157
    v_lshlrev_b32 v144, 16, v145
    v_lshlrev_b32 v148, 16, v149
    v_lshlrev_b32 v152, 16, v153
    v_lshlrev_b32 v156, 16, v157
    v_and_b32 v145, 0xffff0000, v145
    v_and_b32 v149, 0xffff0000, v149
    v_and_b32 v153, 0xffff0000, v153
    v_and_b32 v157, 0xffff0000, v157
    v_mul_f32 v144, v144, v7
    v_mul_f32 v148, v148, v7
    v_mul_f32 v152, v152, v7
    v_mul_f32 v156, v156, v7
    v_mul_f32 v145, v145, v7
    v_mul_f32 v149, v149, v7
    v_mul_f32 v153, v153, v7
    v_mul_f32 v157, v157, v7
    v_cvt_pk_bf16_f32 v146, v144, v145
    v_cvt_pk_bf16_f32 v150, v148, v149
    v_cvt_pk_bf16_f32 v154, v152, v153
    v_cvt_pk_bf16_f32 v158, v156, v157
    v_lshlrev_b32 v144, 16, v146
    v_lshlrev_b32 v148, 16, v150
    v_lshlrev_b32 v152, 16, v154
    v_lshlrev_b32 v156, 16, v158
    v_and_b32 v145, 0xffff0000, v146
    v_and_b32 v149, 0xffff0000, v150
    v_and_b32 v153, 0xffff0000, v154
    v_and_b32 v157, 0xffff0000, v158
    v_lshlrev_b32 v146, 16, v28
    v_lshlrev_b32 v150, 16, v29
    v_lshlrev_b32 v154, 16, v30
    v_lshlrev_b32 v158, 16, v31
    v_and_b32 v147, 0xffff0000, v28
    v_and_b32 v151, 0xffff0000, v29
    v_and_b32 v155, 0xffff0000, v30
    v_and_b32 v159, 0xffff0000, v31
    v_pk_add_f32 v[144:145], v[144:145], v[146:147]
    v_pk_add_f32 v[148:149], v[148:149], v[150:151]
    v_pk_add_f32 v[152:153], v[152:153], v[154:155]
    v_pk_add_f32 v[156:157], v[156:157], v[158:159]
    v_cvt_pk_bf16_f32 v28, v144, v145
    v_cvt_pk_bf16_f32 v29, v148, v149
    v_cvt_pk_bf16_f32 v30, v152, v153
    v_cvt_pk_bf16_f32 v31, v156, v157
    v_add_u32 v160, 24, v242
    v_cmp_eq_u32 vcc, v160, v8
    v_cmp_eq_u32 s[60:61], v160, v10
    v_mov_b32 v161, 0x40000000
    s_or_b64 vcc, vcc, s[60:61]
    v_cndmask_b32 v15, v229, v161, vcc
    s_mov_b32 s32, 0
    buffer_store_dwordx4 v[16:19], v12, s[28:31], s32 offen
    s_mov_b32 s32, 16384
    buffer_store_dwordx4 v[20:23], v13, s[28:31], s32 offen
    s_mov_b32 s32, 32768
    buffer_store_dwordx4 v[24:27], v14, s[28:31], s32 offen
    s_mov_b32 s32, 49152
    buffer_store_dwordx4 v[28:31], v15, s[28:31], s32 offen
    s_branch kc_fin
kc_red:
    v_lshlrev_b32 v144, 16, v16
    v_lshlrev_b32 v148, 16, v17
    v_lshlrev_b32 v152, 16, v18
    v_lshlrev_b32 v156, 16, v19
    v_and_b32 v145, 0xffff0000, v16
    v_and_b32 v149, 0xffff0000, v17
    v_and_b32 v153, 0xffff0000, v18
    v_and_b32 v157, 0xffff0000, v19
    v_sub_f32 v144, v144, v0
    v_sub_f32 v148, v148, v0
    v_sub_f32 v152, v152, v0
    v_sub_f32 v156, v156, v0
    v_sub_f32 v145, v145, v0
    v_sub_f32 v149, v149, v0
    v_sub_f32 v153, v153, v0
    v_sub_f32 v157, v157, v0
    v_cvt_pk_bf16_f32 v145, v144, v145
    v_cvt_pk_bf16_f32 v149, v148, v149
    v_cvt_pk_bf16_f32 v153, v152, v153
    v_cvt_pk_bf16_f32 v157, v156, v157
    v_lshlrev_b32 v144, 16, v145
    v_lshlrev_b32 v148, 16, v149
    v_lshlrev_b32 v152, 16, v153
    v_lshlrev_b32 v156, 16, v157
    v_and_b32 v145, 0xffff0000, v145
    v_and_b32 v149, 0xffff0000, v149
    v_and_b32 v153, 0xffff0000, v153
    v_and_b32 v157, 0xffff0000, v157
    v_mul_f32 v144, v144, v4
    v_mul_f32 v148, v148, v4
    v_mul_f32 v152, v152, v4
    v_mul_f32 v156, v156, v4
    v_mul_f32 v145, v145, v4
    v_mul_f32 v149, v149, v4
    v_mul_f32 v153, v153, v4
    v_mul_f32 v157, v157, v4
    v_cvt_pk_bf16_f32 v146, v144, v145
    v_cvt_pk_bf16_f32 v150, v148, v149
    v_cvt_pk_bf16_f32 v154, v152, v153
    v_cvt_pk_bf16_f32 v158, v156, v157
    v_lshlrev_b32 v144, 16, v146
    v_lshlrev_b32 v148, 16, v150
    v_lshlrev_b32 v152, 16, v154
    v_lshlrev_b32 v156, 16, v158
    v_and_b32 v145, 0xffff0000, v146
    v_and_b32 v149, 0xffff0000, v150
    v_and_b32 v153, 0xffff0000, v154
    v_and_b32 v157, 0xffff0000, v158
    v_lshlrev_b32 v146, 16, v16
    v_lshlrev_b32 v150, 16, v17
    v_lshlrev_b32 v154, 16, v18
    v_lshlrev_b32 v158, 16, v19
    v_and_b32 v147, 0xffff0000, v16
    v_and_b32 v151, 0xffff0000, v17
    v_and_b32 v155, 0xffff0000, v18
    v_and_b32 v159, 0xffff0000, v19
    v_pk_add_f32 v[144:145], v[144:145], v[146:147]
    v_pk_add_f32 v[148:149], v[148:149], v[150:151]
    v_pk_add_f32 v[152:153], v[152:153], v[154:155]
    v_pk_add_f32 v[156:157], v[156:157], v[158:159]
    v_cvt_pk_bf16_f32 v16, v144, v145
    v_cvt_pk_bf16_f32 v17, v148, v149
    v_cvt_pk_bf16_f32 v18, v152, v153
    v_cvt_pk_bf16_f32 v19, v156, v157
    v_add_u32 v160, 0, v242
    v_cmp_eq_u32 vcc, v160, v8
    v_cmp_eq_u32 s[60:61], v160, v10
    v_mov_b32 v161, 0x40000000
    s_or_b64 vcc, vcc, s[60:61]
    v_cndmask_b32 v12, v229, v161, vcc
    v_lshlrev_b32 v144, 16, v20
    v_lshlrev_b32 v148, 16, v21
    v_lshlrev_b32 v152, 16, v22
    v_lshlrev_b32 v156, 16, v23
    v_and_b32 v145, 0xffff0000, v20
    v_and_b32 v149, 0xffff0000, v21
    v_and_b32 v153, 0xffff0000, v22
    v_and_b32 v157, 0xffff0000, v23
    v_sub_f32 v144, v144, v1
    v_sub_f32 v148, v148, v1
    v_sub_f32 v152, v152, v1
    v_sub_f32 v156, v156, v1
    v_sub_f32 v145, v145, v1
    v_sub_f32 v149, v149, v1
    v_sub_f32 v153, v153, v1
    v_sub_f32 v157, v157, v1
    v_cvt_pk_bf16_f32 v145, v144, v145
    v_cvt_pk_bf16_f32 v149, v148, v149
    v_cvt_pk_bf16_f32 v153, v152, v153
    v_cvt_pk_bf16_f32 v157, v156, v157
    v_lshlrev_b32 v144, 16, v145
    v_lshlrev_b32 v148, 16, v149
    v_lshlrev_b32 v152, 16, v153
    v_lshlrev_b32 v156, 16, v157
    v_and_b32 v145, 0xffff0000, v145
    v_and_b32 v149, 0xffff0000, v149
    v_and_b32 v153, 0xffff0000, v153
    v_and_b32 v157, 0xffff0000, v157
    v_mul_f32 v144, v144, v5
    v_mul_f32 v148, v148, v5
    v_mul_f32 v152, v152, v5
    v_mul_f32 v156, v156, v5
    v_mul_f32 v145, v145, v5
    v_mul_f32 v149, v149, v5
    v_mul_f32 v153, v153, v5
    v_mul_f32 v157, v157, v5
    v_cvt_pk_bf16_f32 v146, v144, v145
    v_cvt_pk_bf16_f32 v150, v148, v149
    v_cvt_pk_bf16_f32 v154, v152, v153
    v_cvt_pk_bf16_f32 v158, v156, v157
    v_lshlrev_b32 v144, 16, v146
    v_lshlrev_b32 v148, 16, v150
    v_lshlrev_b32 v152, 16, v154
    v_lshlrev_b32 v156, 16, v158
    v_and_b32 v145, 0xffff0000, v146
    v_and_b32 v149, 0xffff0000, v150
    v_and_b32 v153, 0xffff0000, v154
    v_and_b32 v157, 0xffff0000, v158
    v_lshlrev_b32 v146, 16, v20
    v_lshlrev_b32 v150, 16, v21
    v_lshlrev_b32 v154, 16, v22
    v_lshlrev_b32 v158, 16, v23
    v_and_b32 v147, 0xffff0000, v20
    v_and_b32 v151, 0xffff0000, v21
    v_and_b32 v155, 0xffff0000, v22
    v_and_b32 v159, 0xffff0000, v23
    v_pk_add_f32 v[144:145], v[144:145], v[146:147]
    v_pk_add_f32 v[148:149], v[148:149], v[150:151]
    v_pk_add_f32 v[152:153], v[152:153], v[154:155]
    v_pk_add_f32 v[156:157], v[156:157], v[158:159]
    v_cvt_pk_bf16_f32 v20, v144, v145
    v_cvt_pk_bf16_f32 v21, v148, v149
    v_cvt_pk_bf16_f32 v22, v152, v153
    v_cvt_pk_bf16_f32 v23, v156, v157
    v_add_u32 v160, 8, v242
    v_cmp_eq_u32 vcc, v160, v8
    v_cmp_eq_u32 s[60:61], v160, v10
    v_mov_b32 v161, 0x40000000
    s_or_b64 vcc, vcc, s[60:61]
    v_cndmask_b32 v13, v229, v161, vcc
    v_lshlrev_b32 v144, 16, v24
    v_lshlrev_b32 v148, 16, v25
    v_lshlrev_b32 v152, 16, v26
    v_lshlrev_b32 v156, 16, v27
    v_and_b32 v145, 0xffff0000, v24
    v_and_b32 v149, 0xffff0000, v25
    v_and_b32 v153, 0xffff0000, v26
    v_and_b32 v157, 0xffff0000, v27
    v_sub_f32 v144, v144, v2
    v_sub_f32 v148, v148, v2
    v_sub_f32 v152, v152, v2
    v_sub_f32 v156, v156, v2
    v_sub_f32 v145, v145, v2
    v_sub_f32 v149, v149, v2
    v_sub_f32 v153, v153, v2
    v_sub_f32 v157, v157, v2
    v_cvt_pk_bf16_f32 v145, v144, v145
    v_cvt_pk_bf16_f32 v149, v148, v149
    v_cvt_pk_bf16_f32 v153, v152, v153
    v_cvt_pk_bf16_f32 v157, v156, v157
    v_lshlrev_b32 v144, 16, v145
    v_lshlrev_b32 v148, 16, v149
    v_lshlrev_b32 v152, 16, v153
    v_lshlrev_b32 v156, 16, v157
    v_and_b32 v145, 0xffff0000, v145
    v_and_b32 v149, 0xffff0000, v149
    v_and_b32 v153, 0xffff0000, v153
    v_and_b32 v157, 0xffff0000, v157
    v_mul_f32 v144, v144, v6
    v_mul_f32 v148, v148, v6
    v_mul_f32 v152, v152, v6
    v_mul_f32 v156, v156, v6
    v_mul_f32 v145, v145, v6
    v_mul_f32 v149, v149, v6
    v_mul_f32 v153, v153, v6
    v_mul_f32 v157, v157, v6
    v_cvt_pk_bf16_f32 v146, v144, v145
    v_cvt_pk_bf16_f32 v150, v148, v149
    v_cvt_pk_bf16_f32 v154, v152, v153
    v_cvt_pk_bf16_f32 v158, v156, v157
    v_lshlrev_b32 v144, 16, v146
    v_lshlrev_b32 v148, 16, v150
    v_lshlrev_b32 v152, 16, v154
    v_lshlrev_b32 v156, 16, v158
    v_and_b32 v145, 0xffff0000, v146
    v_and_b32 v149, 0xffff0000, v150
    v_and_b32 v153, 0xffff0000, v154
    v_and_b32 v157, 0xffff0000, v158
    v_lshlrev_b32 v146, 16, v24
    v_lshlrev_b32 v150, 16, v25
    v_lshlrev_b32 v154, 16, v26
    v_lshlrev_b32 v158, 16, v27
    v_and_b32 v147, 0xffff0000, v24
    v_and_b32 v151, 0xffff0000, v25
    v_and_b32 v155, 0xffff0000, v26
    v_and_b32 v159, 0xffff0000, v27
    v_pk_add_f32 v[144:145], v[144:145], v[146:147]
    v_pk_add_f32 v[148:149], v[148:149], v[150:151]
    v_pk_add_f32 v[152:153], v[152:153], v[154:155]
    v_pk_add_f32 v[156:157], v[156:157], v[158:159]
    v_cvt_pk_bf16_f32 v24, v144, v145
    v_cvt_pk_bf16_f32 v25, v148, v149
    v_cvt_pk_bf16_f32 v26, v152, v153
    v_cvt_pk_bf16_f32 v27, v156, v157
    v_add_u32 v160, 16, v242
    v_cmp_eq_u32 vcc, v160, v8
    v_cmp_eq_u32 s[60:61], v160, v10
    v_mov_b32 v161, 0x40000000
    s_or_b64 vcc, vcc, s[60:61]
    v_cndmask_b32 v14, v229, v161, vcc
    v_lshlrev_b32 v144, 16, v28
    v_lshlrev_b32 v148, 16, v29
    v_lshlrev_b32 v152, 16, v30
    v_lshlrev_b32 v156, 16, v31
    v_and_b32 v145, 0xffff0000, v28
    v_and_b32 v149, 0xffff0000, v29
    v_and_b32 v153, 0xffff0000, v30
    v_and_b32 v157, 0xffff0000, v31
    v_sub_f32 v144, v144, v3
    v_sub_f32 v148, v148, v3
    v_sub_f32 v152, v152, v3
    v_sub_f32 v156, v156, v3
    v_sub_f32 v145, v145, v3
    v_sub_f32 v149, v149, v3
    v_sub_f32 v153, v153, v3
    v_sub_f32 v157, v157, v3
    v_cvt_pk_bf16_f32 v145, v144, v145
    v_cvt_pk_bf16_f32 v149, v148, v149
    v_cvt_pk_bf16_f32 v153, v152, v153
    v_cvt_pk_bf16_f32 v157, v156, v157
    v_lshlrev_b32 v144, 16, v145
    v_lshlrev_b32 v148, 16, v149
    v_lshlrev_b32 v152, 16, v153
    v_lshlrev_b32 v156, 16, v157
    v_and_b32 v145, 0xffff0000, v145
    v_and_b32 v149, 0xffff0000, v149
    v_and_b32 v153, 0xffff0000, v153
    v_and_b32 v157, 0xffff0000, v157
    v_mul_f32 v144, v144, v7
    v_mul_f32 v148, v148, v7
    v_mul_f32 v152, v152, v7
    v_mul_f32 v156, v156, v7
    v_mul_f32 v145, v145, v7
    v_mul_f32 v149, v149, v7
    v_mul_f32 v153, v153, v7
    v_mul_f32 v157, v157, v7
    v_cvt_pk_bf16_f32 v146, v144, v145
    v_cvt_pk_bf16_f32 v150, v148, v149
    v_cvt_pk_bf16_f32 v154, v152, v153
    v_cvt_pk_bf16_f32 v158, v156, v157
    v_lshlrev_b32 v144, 16, v146
    v_lshlrev_b32 v148, 16, v150
    v_lshlrev_b32 v152, 16, v154
    v_lshlrev_b32 v156, 16, v158
    v_and_b32 v145, 0xffff0000, v146
    v_and_b32 v149, 0xffff0000, v150
    v_and_b32 v153, 0xffff0000, v154
    v_and_b32 v157, 0xffff0000, v158
    v_lshlrev_b32 v146, 16, v28
    v_lshlrev_b32 v150, 16, v29
    v_lshlrev_b32 v154, 16, v30
    v_lshlrev_b32 v158, 16, v31
    v_and_b32 v147, 0xffff0000, v28
    v_and_b32 v151, 0xffff0000, v29
    v_and_b32 v155, 0xffff0000, v30
    v_and_b32 v159, 0xffff0000, v31
    v_pk_add_f32 v[144:145], v[144:145], v[146:147]
    v_pk_add_f32 v[148:149], v[148:149], v[150:151]
    v_pk_add_f32 v[152:153], v[152:153], v[154:155]
    v_pk_add_f32 v[156:157], v[156:157], v[158:159]
    v_cvt_pk_bf16_f32 v28, v144, v145
    v_cvt_pk_bf16_f32 v29, v148, v149
    v_cvt_pk_bf16_f32 v30, v152, v153
    v_cvt_pk_bf16_f32 v31, v156, v157
    v_add_u32 v160, 24, v242
    v_cmp_eq_u32 vcc, v160, v8
    v_cmp_eq_u32 s[60:61], v160, v10
    v_mov_b32 v161, 0x40000000
    s_or_b64 vcc, vcc, s[60:61]
    v_cndmask_b32 v15, v229, v161, vcc
    s_mov_b32 s32, 0
    buffer_store_dwordx4 v[16:19], v12, s[28:31], s32 offen
    s_mov_b32 s32, 16384
    buffer_store_dwordx4 v[20:23], v13, s[28:31], s32 offen
    s_mov_b32 s32, 32768
    buffer_store_dwordx4 v[24:27], v14, s[28:31], s32 offen
    s_mov_b32 s32, 49152
    buffer_store_dwordx4 v[28:31], v15, s[28:31], s32 offen
    s_sub_u32 s54, s2, 224
    v_lshrrev_b32 v234, 4, v230
    v_lshlrev_b32 v234, 13, v234
    v_and_b32 v235, 15, v237
    v_lshl_add_u32 v217, v235, 4, v234
    s_lshl_b32 s35, s54, 8
    s_add_u32 s35, s35, 0x3900000
    v_bfe_u32 v234, v237, 4, 1
    v_lshrrev_b32 v236, 5, v237
    v_lshl_add_u32 v234, v234, 1, v236
    v_lshl_add_u32 v234, v235, 2, v234
    s_lshl_b32 s32, s54, 6
    v_add_u32 v234, s32, v234
    v_lshlrev_b32 v218, 1, v234
    v_add_u32 v234, 98304, v218
    ds_read_u16 v100, v234
    ds_read_u16 v101, v234 offset:4096
    s_cmp_lt_u32 s54, 16
    s_cselect_b64 vcc, -1, 0
    v_cndmask_b32 v102, v10, v8, vcc
    s_cselect_b32 s32, 0, 4
    s_add_u32 s32, s32, 106496
    v_mov_b32 v234, s32
    ds_read_b32 v103, v234
    s_waitcnt lgkmcnt(0)
    v_cvt_pk_bf16_f32 v103, v103, v103
    v_lshlrev_b32 v103, 16, v103
    v_mul_f32 v103, 0xbfb8aa3b, v103
    v_exp_f32 v103, v103
    s_nop 0
    v_add_f32 v103, 1.0, v103
    v_rcp_f32 v103, v103
    s_nop 0
    v_cvt_pk_bf16_f32 v103, v103, v103
    v_lshlrev_b32 v103, 16, v103
    v_and_b32 v218, 2047, v218
    v_lshl_add_u32 v218, v102, 11, v218
    v_lshlrev_b32 v220, 2, v230
    v_add_u32 v220, 106752, v220
    v_lshlrev_b32 v221, 2, v237
    v_add_u32 v221, 106752, v221
    s_cmp_lg_u32 s3, 0
    s_cbranch_scc1 kc_b22
    s_lshl_b32 s32, s52, 7
    s_add_u32 s32, s32, 0x38a0c00
    s_mov_b32 s34, 0x400000
    s_branch kc_b21
kc_b20:
    s_sleep 2
kc_b21:
    buffer_load_dword v235, off, s[8:11], s32 sc1
    s_waitcnt vmcnt(0)
    v_cmp_ne_u32 vcc, 8, v235
    s_sub_u32 s34, s34, 1
    s_cbranch_scc1 kc_b22
    s_cbranch_vccnz kc_b20
kc_b22:
    s_barrier
    s_add_u32 s32, s35, 0
    buffer_load_dwordx4 v[32:35], v217, s[8:11], s32 offen sc1
    s_add_u32 s32, s35, 131072
    buffer_load_dwordx4 v[36:39], v217, s[8:11], s32 offen sc1
    s_add_u32 s32, s35, 262144
    buffer_load_dwordx4 v[40:43], v217, s[8:11], s32 offen sc1
    s_add_u32 s32, s35, 393216
    buffer_load_dwordx4 v[44:47], v217, s[8:11], s32 offen sc1
    s_add_u32 s32, s35, 524288
    buffer_load_dwordx4 v[48:51], v217, s[8:11], s32 offen sc1
    s_add_u32 s32, s35, 655360
    buffer_load_dwordx4 v[52:55], v217, s[8:11], s32 offen sc1
    s_add_u32 s32, s35, 786432
    buffer_load_dwordx4 v[56:59], v217, s[8:11], s32 offen sc1
    s_add_u32 s32, s35, 917504
    buffer_load_dwordx4 v[60:63], v217, s[8:11], s32 offen sc1
    s_add_u32 s32, s35, 1048576
    buffer_load_dwordx4 v[64:67], v217, s[8:11], s32 offen sc1
    s_add_u32 s32, s35, 1179648
    buffer_load_dwordx4 v[68:71], v217, s[8:11], s32 offen sc1
    s_add_u32 s32, s35, 1310720
    buffer_load_dwordx4 v[72:75], v217, s[8:11], s32 offen sc1
    s_add_u32 s32, s35, 1441792
    buffer_load_dwordx4 v[76:79], v217, s[8:11], s32 offen sc1
    s_add_u32 s32, s35, 1572864
    buffer_load_dwordx4 v[80:83], v217, s[8:11], s32 offen sc1
    s_add_u32 s32, s35, 1703936
    buffer_load_dwordx4 v[84:87], v217, s[8:11], s32 offen sc1
    s_waitcnt vmcnt(12)
    v_pk_add_f32 v[32:33], v[32:33], v[36:37]
    v_pk_add_f32 v[34:35], v[34:35], v[38:39]
    s_waitcnt vmcnt(11)
    v_pk_add_f32 v[32:33], v[32:33], v[40:41]
    v_pk_add_f32 v[34:35], v[34:35], v[42:43]
    s_waitcnt vmcnt(10)
    v_pk_add_f32 v[32:33], v[32:33], v[44:45]
    v_pk_add_f32 v[34:35], v[34:35], v[46:47]
    s_waitcnt vmcnt(9)
    v_pk_add_f32 v[32:33], v[32:33], v[48:49]
    v_pk_add_f32 v[34:35], v[34:35], v[50:51]
    s_waitcnt vmcnt(8)
    v_pk_add_f32 v[32:33], v[32:33], v[52:53]
    v_pk_add_f32 v[34:35], v[34:35], v[54:55]
    s_waitcnt vmcnt(7)
    v_pk_add_f32 v[32:33], v[32:33], v[56:57]
    v_pk_add_f32 v[34:35], v[34:35], v[58:59]
    s_waitcnt vmcnt(6)
    v_pk_add_f32 v[32:33], v[32:33], v[60:61]
    v_pk_add_f32 v[34:35], v[34:35], v[62:63]
    s_waitcnt vmcnt(5)
    v_pk_add_f32 v[32:33], v[32:33], v[64:65]
    v_pk_add_f32 v[34:35], v[34:35], v[66:67]
    s_waitcnt vmcnt(4)
    v_pk_add_f32 v[32:33], v[32:33], v[68:69]
    v_pk_add_f32 v[34:35], v[34:35], v[70:71]
    s_waitcnt vmcnt(3)
    v_pk_add_f32 v[32:33], v[32:33], v[72:73]
    v_pk_add_f32 v[34:35], v[34:35], v[74:75]
    s_waitcnt vmcnt(2)
    v_pk_add_f32 v[32:33], v[32:33], v[76:77]
    v_pk_add_f32 v[34:35], v[34:35], v[78:79]
    s_waitcnt vmcnt(1)
    v_pk_add_f32 v[32:33], v[32:33], v[80:81]
    v_pk_add_f32 v[34:35], v[34:35], v[82:83]
    s_waitcnt vmcnt(0)
    v_pk_add_f32 v[32:33], v[32:33], v[84:85]
    v_pk_add_f32 v[34:35], v[34:35], v[86:87]
    s_nop 1
    v_permlane32_swap_b32 v32, v33
    v_permlane32_swap_b32 v34, v35
    s_nop 0
    v_add_f32 v32, v32, v33
    v_add_f32 v34, v34, v35
    s_nop 1
    v_permlane16_swap_b32 v32, v34
    s_nop 0
    v_add_f32 v32, v32, v34
    ds_write_b32 v220, v32
    s_waitcnt lgkmcnt(0)
    s_barrier
    s_cmp_lg_u32 s3, 0
    s_cbranch_scc1 kc_fin
    ds_read_b32 v32, v221
    ds_read_b32 v33, v221 offset:256
    ds_read_b32 v34, v221 offset:512
    ds_read_b32 v35, v221 offset:768
    v_lshlrev_b32 v100, 16, v100
    v_lshlrev_b32 v101, 16, v101
    s_waitcnt lgkmcnt(0)
    v_add_f32 v32, v32, v33
    v_add_f32 v34, v34, v35
    v_add_f32 v32, v32, v34
    v_cvt_pk_bf16_f32 v32, v32, v32
    v_lshlrev_b32 v32, 16, v32
    v_mul_f32 v32, v32, v103
    v_cvt_pk_bf16_f32 v32, v32, v32
    v_lshlrev_b32 v32, 16, v32
    v_add_f32 v32, v32, v100
    v_cvt_pk_bf16_f32 v32, v32, v32
    v_lshlrev_b32 v32, 16, v32
    v_add_f32 v32, v32, v101
    v_cvt_pk_bf16_f32 v32, v32, v32
    buffer_store_short v32, v218, s[28:31], 0 offen
kc_fin:
    s_endpgm
kc_r3:
    s_mov_b32 s34, 0x400000
kc_r3l:
    s_sleep 4
    buffer_load_dwordx4 v[176:179], v228, s[8:11], s7 offen offset:0 sc1
    buffer_load_dwordx4 v[180:183], v228, s[8:11], s7 offen offset:1024 sc1
    buffer_load_dwordx4 v[184:187], v228, s[8:11], s7 offen offset:2048 sc1
    buffer_load_dwordx4 v[188:191], v228, s[8:11], s7 offen offset:3072 sc1
    s_waitcnt vmcnt(0)
    v_max3_u32 v235, v176, v177, v178
    v_max3_u32 v235, v235, v179, v180
    v_max3_u32 v235, v235, v181, v182
    v_max3_u32 v235, v235, v183, v184
    v_max3_u32 v235, v235, v185, v186
    v_max3_u32 v235, v235, v187, v188
    v_max3_u32 v235, v235, v189, v190
    v_max_u32 v235, v235, v191
    v_cmp_eq_u32 vcc, -1, v235
    s_sub_u32 s34, s34, 1
    s_cbranch_scc1 kc_r3o
    s_cbranch_vccnz kc_r3l
    s_branch kc_r3o
kc_r1:
    s_mov_b32 s34, 0x400000
kc_r1l:
    s_sleep 4
    buffer_load_dwordx4 v[96:99], v228, s[8:11], s37 offen offset:0 sc1
    buffer_load_dwordx4 v[100:103], v228, s[8:11], s37 offen offset:1024 sc1
    buffer_load_dwordx4 v[104:107], v228, s[8:11], s37 offen offset:2048 sc1
    buffer_load_dwordx4 v[108:111], v228, s[8:11], s37 offen offset:3072 sc1
    s_waitcnt vmcnt(0)
    v_max3_u32 v235, v96, v97, v98
    v_max3_u32 v235, v235, v99, v100
    v_max3_u32 v235, v235, v101, v102
    v_max3_u32 v235, v235, v103, v104
    v_max3_u32 v235, v235, v105, v106
    v_max3_u32 v235, v235, v107, v108
    v_max3_u32 v235, v235, v109, v110
    v_max_u32 v235, v235, v111
    v_cmp_eq_u32 vcc, -1, v235
    s_sub_u32 s34, s34, 1
    s_cbranch_scc1 kc_r1o
    s_cbranch_vccnz kc_r1l
    s_branch kc_r1o
kc_r2:
    s_mov_b32 s34, 0x400000
kc_r2l:
    s_sleep 4
    buffer_load_dwordx4 v[160:163], v228, s[8:11], s38 offen offset:0 sc1
    buffer_load_dwordx4 v[164:167], v228, s[8:11], s38 offen offset:1024 sc1
    buffer_load_dwordx4 v[168:171], v228, s[8:11], s38 offen offset:2048 sc1
    buffer_load_dwordx4 v[172:175], v228, s[8:11], s38 offen offset:3072 sc1
    s_waitcnt vmcnt(0)
    v_max3_u32 v235, v160, v161, v162
    v_max3_u32 v235, v235, v163, v164
    v_max3_u32 v235, v235, v165, v166
    v_max3_u32 v235, v235, v167, v168
    v_max3_u32 v235, v235, v169, v170
    v_max3_u32 v235, v235, v171, v172
    v_max3_u32 v235, v235, v173, v174
    v_max_u32 v235, v235, v175
    v_cmp_eq_u32 vcc, -1, v235
    s_sub_u32 s34, s34, 1
    s_cbranch_scc1 kc_r2o
    s_cbranch_vccnz kc_r2l
    s_branch kc_r2o
kc_end:
ka_done:
    s_endpgm
kf_fix1:
    s_cmp_eq_u32 s33, 0
    s_cselect_b32 s24, 0, 0x74000000
    s_cselect_b32 s36, 0, 0x1000
    s_mov_b32 s33, 1
    v_subrev_f32 v230, s24, v243
    v_add_f32 v231, 0, v230
    v_min_f32 v64, v228, v231
    v_add_f32 v232, 0xf1800000, v230
    v_min_f32 v65, v228, v232
    v_add_f32 v231, 0xf2000000, v230
    v_min_f32 v66, v228, v231
    v_add_f32 v232, 0xf2400000, v230
    v_min_f32 v67, v228, v232
    v_add_f32 v231, 0xf3000000, v230
    v_min_f32 v68, v228, v231
    v_add_f32 v232, 0xf3100000, v230
    v_min_f32 v69, v228, v232
    v_add_f32 v231, 0xf3200000, v230
    v_min_f32 v70, v228, v231
    v_add_f32 v232, 0xf3300000, v230
    v_min_f32 v71, v228, v232
    v_add_f32 v231, 0xf3800000, v230
    v_min_f32 v72, v228, v231
    v_add_f32 v232, 0xf3880000, v230
    v_min_f32 v73, v228, v232
    v_add_f32 v231, 0xf3900000, v230
    v_min_f32 v74, v228, v231
    v_add_f32 v232, 0xf3980000, v230
    v_min_f32 v75, v228, v232
    v_add_f32 v231, 0xf3c00000, v230
    v_min_f32 v76, v228, v231
    v_add_f32 v232, 0xf3c80000, v230
    v_min_f32 v77, v228, v232
    v_add_f32 v231, 0xf3d00000, v230
    v_min_f32 v78, v228, v231
    v_add_f32 v232, 0xf3d80000, v230
    v_min_f32 v79, v228, v232
    s_nop 1
    s_branch kf_fixr2
kf_fix3:
    s_cmp_eq_u32 s33, 0
    s_cselect_b32 s24, 0, 0x74000000
    s_cselect_b32 s36, 0, 0x1000
    s_mov_b32 s33, 1
    v_subrev_f32 v230, s24, v243
    v_add_f32 v231, 0, v230
    v_min_f32 v64, v228, v231
    v_add_f32 v232, 0xf1800000, v230
    v_min_f32 v65, v228, v232
    v_add_f32 v231, 0xf2000000, v230
    v_min_f32 v66, v228, v231
    v_add_f32 v232, 0xf2400000, v230
    v_min_f32 v67, v228, v232
    v_add_f32 v231, 0xf3000000, v230
    v_min_f32 v68, v228, v231
    v_add_f32 v232, 0xf3100000, v230
    v_min_f32 v69, v228, v232
    v_add_f32 v231, 0xf3200000, v230
    v_min_f32 v70, v228, v231
    v_add_f32 v232, 0xf3300000, v230
    v_min_f32 v71, v228, v232
    v_add_f32 v231, 0xf3800000, v230
    v_min_f32 v72, v228, v231
    v_add_f32 v232, 0xf3880000, v230
    v_min_f32 v73, v228, v232
    v_add_f32 v231, 0xf3900000, v230
    v_min_f32 v74, v228, v231
    v_add_f32 v232, 0xf3980000, v230
    v_min_f32 v75, v228, v232
    v_add_f32 v231, 0xf3c00000, v230
    v_min_f32 v76, v228, v231
    v_add_f32 v232, 0xf3c80000, v230
    v_min_f32 v77, v228, v232
    v_add_f32 v231, 0xf3d00000, v230
    v_min_f32 v78, v228, v231
    v_add_f32 v232, 0xf3d80000, v230
    v_min_f32 v79, v228, v232
    s_nop 1
    s_branch kf_fixr4
kf_fix5:
    s_cmp_eq_u32 s33, 0
    s_cselect_b32 s24, 0, 0x74000000
    s_cselect_b32 s36, 0, 0x1000
    s_mov_b32 s33, 1
    v_subrev_f32 v230, s24, v243
    v_add_f32 v231, 0, v230
    v_min_f32 v64, v228, v231
    v_add_f32 v232, 0xf1800000, v230
    v_min_f32 v65, v228, v232
    v_add_f32 v231, 0xf2000000, v230
    v_min_f32 v66, v228, v231
    v_add_f32 v232, 0xf2400000, v230
    v_min_f32 v67, v228, v232
    v_add_f32 v231, 0xf3000000, v230
    v_min_f32 v68, v228, v231
    v_add_f32 v232, 0xf3100000, v230
    v_min_f32 v69, v228, v232
    v_add_f32 v231, 0xf3200000, v230
    v_min_f32 v70, v228, v231
    v_add_f32 v232, 0xf3300000, v230
    v_min_f32 v71, v228, v232
    v_add_f32 v231, 0xf3800000, v230
    v_min_f32 v72, v228, v231
    v_add_f32 v232, 0xf3880000, v230
    v_min_f32 v73, v228, v232
    v_add_f32 v231, 0xf3900000, v230
    v_min_f32 v74, v228, v231
    v_add_f32 v232, 0xf3980000, v230
    v_min_f32 v75, v228, v232
    v_add_f32 v231, 0xf3c00000, v230
    v_min_f32 v76, v228, v231
    v_add_f32 v232, 0xf3c80000, v230
    v_min_f32 v77, v228, v232
    v_add_f32 v231, 0xf3d00000, v230
    v_min_f32 v78, v228, v231
    v_add_f32 v232, 0xf3d80000, v230
    v_min_f32 v79, v228, v232
    s_nop 1
    s_branch kf_fixr6
kf_rare8:
    s_nop 15
    v_max3_f32 v230, v32, v33, v34
    v_max3_f32 v230, v230, v35, v36
    v_max3_f32 v230, v230, v37, v38
    v_max3_f32 v230, v230, v39, v40
    v_max3_f32 v230, v230, v41, v42
    v_max3_f32 v230, v230, v43, v44
    v_max3_f32 v230, v230, v45, v46
    v_max_f32 v230, v230, v47
    v_mov_b32 v231, v230
    s_nop 1
    v_permlane32_swap_b32 v230, v231
    s_nop 0
    v_max_f32 v230, v230, v231
    v_max_f32 v230, 0, v230
    v_sub_f32 v232, 0, v230
    v_exp_f32 v232, v232
    v_sub_f32 v228, v228, v230
    v_sub_f32 v64, v64, v230
    v_sub_f32 v0, v0, v230
    v_sub_f32 v32, v32, v230
    v_sub_f32 v65, v65, v230
    v_sub_f32 v1, v1, v230
    v_sub_f32 v33, v33, v230
    v_sub_f32 v66, v66, v230
    v_sub_f32 v2, v2, v230
    v_sub_f32 v34, v34, v230
    v_sub_f32 v67, v67, v230
    v_sub_f32 v3, v3, v230
    v_sub_f32 v35, v35, v230
    v_sub_f32 v68, v68, v230
    v_sub_f32 v4, v4, v230
    v_sub_f32 v36, v36, v230
    v_sub_f32 v69, v69, v230
    v_sub_f32 v5, v5, v230
    v_sub_f32 v37, v37, v230
    v_sub_f32 v70, v70, v230
    v_sub_f32 v6, v6, v230
    v_sub_f32 v38, v38, v230
    v_sub_f32 v71, v71, v230
    v_sub_f32 v7, v7, v230
    v_sub_f32 v39, v39, v230
    v_sub_f32 v72, v72, v230
    v_sub_f32 v8, v8, v230
    v_sub_f32 v40, v40, v230
    v_sub_f32 v73, v73, v230
    v_sub_f32 v9, v9, v230
    v_sub_f32 v41, v41, v230
    v_sub_f32 v74, v74, v230
    v_sub_f32 v10, v10, v230
    v_sub_f32 v42, v42, v230
    v_sub_f32 v75, v75, v230
    v_sub_f32 v11, v11, v230
    v_sub_f32 v43, v43, v230
    v_sub_f32 v76, v76, v230
    v_sub_f32 v12, v12, v230
    v_sub_f32 v44, v44, v230
    v_sub_f32 v77, v77, v230
    v_sub_f32 v13, v13, v230
    v_sub_f32 v45, v45, v230
    v_sub_f32 v78, v78, v230
    v_sub_f32 v14, v14, v230
    v_sub_f32 v46, v46, v230
    v_sub_f32 v79, v79, v230
    v_sub_f32 v15, v15, v230
    v_sub_f32 v47, v47, v230
    v_mul_f32 v226, v226, v232
    v_accvgpr_read_b32 v234, a0
    v_mul_f32 v234, v234, v232
    v_accvgpr_write_b32 a0, v234
    v_accvgpr_read_b32 v235, a1
    v_mul_f32 v235, v235, v232
    v_accvgpr_write_b32 a1, v235
    v_accvgpr_read_b32 v236, a2
    v_mul_f32 v236, v236, v232
    v_accvgpr_write_b32 a2, v236
    v_accvgpr_read_b32 v237, a3
    v_mul_f32 v237, v237, v232
    v_accvgpr_write_b32 a3, v237
    v_accvgpr_read_b32 v234, a4
    v_mul_f32 v234, v234, v232
    v_accvgpr_write_b32 a4, v234
    v_accvgpr_read_b32 v235, a5
    v_mul_f32 v235, v235, v232
    v_accvgpr_write_b32 a5, v235
    v_accvgpr_read_b32 v236, a6
    v_mul_f32 v236, v236, v232
    v_accvgpr_write_b32 a6, v236
    v_accvgpr_read_b32 v237, a7
    v_mul_f32 v237, v237, v232
    v_accvgpr_write_b32 a7, v237
    v_accvgpr_read_b32 v234, a8
    v_mul_f32 v234, v234, v232
    v_accvgpr_write_b32 a8, v234
    v_accvgpr_read_b32 v235, a9
    v_mul_f32 v235, v235, v232
    v_accvgpr_write_b32 a9, v235
    v_accvgpr_read_b32 v236, a10
    v_mul_f32 v236, v236, v232
    v_accvgpr_write_b32 a10, v236
    v_accvgpr_read_b32 v237, a11
    v_mul_f32 v237, v237, v232
    v_accvgpr_write_b32 a11, v237
    v_accvgpr_read_b32 v234, a12
    v_mul_f32 v234, v234, v232
    v_accvgpr_write_b32 a12, v234
    v_accvgpr_read_b32 v235, a13
    v_mul_f32 v235, v235, v232
    v_accvgpr_write_b32 a13, v235
    v_accvgpr_read_b32 v236, a14
    v_mul_f32 v236, v236, v232
    v_accvgpr_write_b32 a14, v236
    v_accvgpr_read_b32 v237, a15
    v_mul_f32 v237, v237, v232
    v_accvgpr_write_b32 a15, v237
    v_accvgpr_read_b32 v234, a16
    v_mul_f32 v234, v234, v232
    v_accvgpr_write_b32 a16, v234
    v_accvgpr_read_b32 v235, a17
    v_mul_f32 v235, v235, v232
    v_accvgpr_write_b32 a17, v235
    v_accvgpr_read_b32 v236, a18
    v_mul_f32 v236, v236, v232
    v_accvgpr_write_b32 a18, v236
    v_accvgpr_read_b32 v237, a19
    v_mul_f32 v237, v237, v232
    v_accvgpr_write_b32 a19, v237
    v_accvgpr_read_b32 v234, a20
    v_mul_f32 v234, v234, v232
    v_accvgpr_write_b32 a20, v234
    v_accvgpr_read_b32 v235, a21
    v_mul_f32 v235, v235, v232
    v_accvgpr_write_b32 a21, v235
    v_accvgpr_read_b32 v236, a22
    v_mul_f32 v236, v236, v232
    v_accvgpr_write_b32 a22, v236
    v_accvgpr_read_b32 v237, a23
    v_mul_f32 v237, v237, v232
    v_accvgpr_write_b32 a23, v237
    v_accvgpr_read_b32 v234, a24
    v_mul_f32 v234, v234, v232
    v_accvgpr_write_b32 a24, v234
    v_accvgpr_read_b32 v235, a25
    v_mul_f32 v235, v235, v232
    v_accvgpr_write_b32 a25, v235
    v_accvgpr_read_b32 v236, a26
    v_mul_f32 v236, v236, v232
    v_accvgpr_write_b32 a26, v236
    v_accvgpr_read_b32 v237, a27
    v_mul_f32 v237, v237, v232
    v_accvgpr_write_b32 a27, v237
    v_accvgpr_read_b32 v234, a28
    v_mul_f32 v234, v234, v232
    v_accvgpr_write_b32 a28, v234
    v_accvgpr_read_b32 v235, a29
    v_mul_f32 v235, v235, v232
    v_accvgpr_write_b32 a29, v235
    v_accvgpr_read_b32 v236, a30
    v_mul_f32 v236, v236, v232
    v_accvgpr_write_b32 a30, v236
    v_accvgpr_read_b32 v237, a31
    v_mul_f32 v237, v237, v232
    v_accvgpr_write_b32 a31, v237
    v_accvgpr_read_b32 v234, a32
    v_mul_f32 v234, v234, v232
    v_accvgpr_write_b32 a32, v234
    v_accvgpr_read_b32 v235, a33
    v_mul_f32 v235, v235, v232
    v_accvgpr_write_b32 a33, v235
    v_accvgpr_read_b32 v236, a34
    v_mul_f32 v236, v236, v232
    v_accvgpr_write_b32 a34, v236
    v_accvgpr_read_b32 v237, a35
    v_mul_f32 v237, v237, v232
    v_accvgpr_write_b32 a35, v237
    v_accvgpr_read_b32 v234, a36
    v_mul_f32 v234, v234, v232
    v_accvgpr_write_b32 a36, v234
    v_accvgpr_read_b32 v235, a37
    v_mul_f32 v235, v235, v232
    v_accvgpr_write_b32 a37, v235
    v_accvgpr_read_b32 v236, a38
    v_mul_f32 v236, v236, v232
    v_accvgpr_write_b32 a38, v236
    v_accvgpr_read_b32 v237, a39
    v_mul_f32 v237, v237, v232
    v_accvgpr_write_b32 a39, v237
    v_accvgpr_read_b32 v234, a40
    v_mul_f32 v234, v234, v232
    v_accvgpr_write_b32 a40, v234
    v_accvgpr_read_b32 v235, a41
    v_mul_f32 v235, v235, v232
    v_accvgpr_write_b32 a41, v235
    v_accvgpr_read_b32 v236, a42
    v_mul_f32 v236, v236, v232
    v_accvgpr_write_b32 a42, v236
    v_accvgpr_read_b32 v237, a43
    v_mul_f32 v237, v237, v232
    v_accvgpr_write_b32 a43, v237
    v_accvgpr_read_b32 v234, a44
    v_mul_f32 v234, v234, v232
    v_accvgpr_write_b32 a44, v234
    v_accvgpr_read_b32 v235, a45
    v_mul_f32 v235, v235, v232
    v_accvgpr_write_b32 a45, v235
    v_accvgpr_read_b32 v236, a46
    v_mul_f32 v236, v236, v232
    v_accvgpr_write_b32 a46, v236
    v_accvgpr_read_b32 v237, a47
    v_mul_f32 v237, v237, v232
    v_accvgpr_write_b32 a47, v237
    v_accvgpr_read_b32 v234, a48
    v_mul_f32 v234, v234, v232
    v_accvgpr_write_b32 a48, v234
    v_accvgpr_read_b32 v235, a49
    v_mul_f32 v235, v235, v232
    v_accvgpr_write_b32 a49, v235
    v_accvgpr_read_b32 v236, a50
    v_mul_f32 v236, v236, v232
    v_accvgpr_write_b32 a50, v236
    v_accvgpr_read_b32 v237, a51
    v_mul_f32 v237, v237, v232
    v_accvgpr_write_b32 a51, v237
    v_accvgpr_read_b32 v234, a52
    v_mul_f32 v234, v234, v232
    v_accvgpr_write_b32 a52, v234
    v_accvgpr_read_b32 v235, a53
    v_mul_f32 v235, v235, v232
    v_accvgpr_write_b32 a53, v235
    v_accvgpr_read_b32 v236, a54
    v_mul_f32 v236, v236, v232
    v_accvgpr_write_b32 a54, v236
    v_accvgpr_read_b32 v237, a55
    v_mul_f32 v237, v237, v232
    v_accvgpr_write_b32 a55, v237
    v_accvgpr_read_b32 v234, a56
    v_mul_f32 v234, v234, v232
    v_accvgpr_write_b32 a56, v234
    v_accvgpr_read_b32 v235, a57
    v_mul_f32 v235, v235, v232
    v_accvgpr_write_b32 a57, v235
    v_accvgpr_read_b32 v236, a58
    v_mul_f32 v236, v236, v232
    v_accvgpr_write_b32 a58, v236
    v_accvgpr_read_b32 v237, a59
    v_mul_f32 v237, v237, v232
    v_accvgpr_write_b32 a59, v237
    v_accvgpr_read_b32 v234, a60
    v_mul_f32 v234, v234, v232
    v_accvgpr_write_b32 a60, v234
    v_accvgpr_read_b32 v235, a61
    v_mul_f32 v235, v235, v232
    v_accvgpr_write_b32 a61, v235
    v_accvgpr_read_b32 v236, a62
    v_mul_f32 v236, v236, v232
    v_accvgpr_write_b32 a62, v236
    v_accvgpr_read_b32 v237, a63
    v_mul_f32 v237, v237, v232
    v_accvgpr_write_b32 a63, v237
    v_exp_f32 v136, v32
    v_exp_f32 v137, v33
    v_exp_f32 v130, v34
    v_exp_f32 v131, v35
    v_cvt_pk_bf16_f32 v112, v136, v137
    v_exp_f32 v132, v36
    v_exp_f32 v133, v37
    v_cvt_pk_bf16_f32 v113, v130, v131
    v_add_f32 v136, v136, v130
    v_add_f32 v137, v137, v131
    v_exp_f32 v134, v38
    v_exp_f32 v135, v39
    v_cvt_pk_bf16_f32 v114, v132, v133
    v_add_f32 v136, v136, v132
    v_add_f32 v137, v137, v133
    v_exp_f32 v128, v40
    v_exp_f32 v129, v41
    v_cvt_pk_bf16_f32 v115, v134, v135
    v_add_f32 v136, v136, v134
    v_add_f32 v137, v137, v135
    v_exp_f32 v130, v42
    v_exp_f32 v131, v43
    v_cvt_pk_bf16_f32 v116, v128, v129
    v_add_f32 v136, v136, v128
    v_add_f32 v137, v137, v129
    v_exp_f32 v132, v44
    v_exp_f32 v133, v45
    v_cvt_pk_bf16_f32 v117, v130, v131
    v_add_f32 v136, v136, v130
    v_add_f32 v137, v137, v131
    v_exp_f32 v134, v46
    v_exp_f32 v135, v47
    v_cvt_pk_bf16_f32 v118, v132, v133
    v_add_f32 v136, v136, v132
    v_add_f32 v137, v137, v133
    v_cvt_pk_bf16_f32 v119, v134, v135
    v_add_f32 v136, v136, v134
    v_add_f32 v137, v137, v135
    v_add_f32 v224, v136, v137
    v_max3_f32 v230, v48, v49, v50
    v_max3_f32 v230, v230, v51, v52
    v_max3_f32 v230, v230, v53, v54
    v_max3_f32 v230, v230, v55, v56
    v_max3_f32 v230, v230, v57, v58
    v_max3_f32 v230, v230, v59, v60
    v_max3_f32 v230, v230, v61, v62
    v_max_f32 v230, v230, v63
    v_mov_b32 v231, v230
    s_nop 1
    v_permlane32_swap_b32 v230, v231
    s_nop 0
    v_max_f32 v230, v230, v231
    v_max_f32 v230, 0, v230
    v_sub_f32 v232, 0, v230
    v_exp_f32 v232, v232
    v_sub_f32 v229, v229, v230
    v_sub_f32 v80, v80, v230
    v_sub_f32 v16, v16, v230
    v_sub_f32 v48, v48, v230
    v_sub_f32 v81, v81, v230
    v_sub_f32 v17, v17, v230
    v_sub_f32 v49, v49, v230
    v_sub_f32 v82, v82, v230
    v_sub_f32 v18, v18, v230
    v_sub_f32 v50, v50, v230
    v_sub_f32 v83, v83, v230
    v_sub_f32 v19, v19, v230
    v_sub_f32 v51, v51, v230
    v_sub_f32 v84, v84, v230
    v_sub_f32 v20, v20, v230
    v_sub_f32 v52, v52, v230
    v_sub_f32 v85, v85, v230
    v_sub_f32 v21, v21, v230
    v_sub_f32 v53, v53, v230
    v_sub_f32 v86, v86, v230
    v_sub_f32 v22, v22, v230
    v_sub_f32 v54, v54, v230
    v_sub_f32 v87, v87, v230
    v_sub_f32 v23, v23, v230
    v_sub_f32 v55, v55, v230
    v_sub_f32 v88, v88, v230
    v_sub_f32 v24, v24, v230
    v_sub_f32 v56, v56, v230
    v_sub_f32 v89, v89, v230
    v_sub_f32 v25, v25, v230
    v_sub_f32 v57, v57, v230
    v_sub_f32 v90, v90, v230
    v_sub_f32 v26, v26, v230
    v_sub_f32 v58, v58, v230
    v_sub_f32 v91, v91, v230
    v_sub_f32 v27, v27, v230
    v_sub_f32 v59, v59, v230
    v_sub_f32 v92, v92, v230
    v_sub_f32 v28, v28, v230
    v_sub_f32 v60, v60, v230
    v_sub_f32 v93, v93, v230
    v_sub_f32 v29, v29, v230
    v_sub_f32 v61, v61, v230
    v_sub_f32 v94, v94, v230
    v_sub_f32 v30, v30, v230
    v_sub_f32 v62, v62, v230
    v_sub_f32 v95, v95, v230
    v_sub_f32 v31, v31, v230
    v_sub_f32 v63, v63, v230
    v_mul_f32 v227, v227, v232
    v_accvgpr_read_b32 v234, a64
    v_mul_f32 v234, v234, v232
    v_accvgpr_write_b32 a64, v234
    v_accvgpr_read_b32 v235, a65
    v_mul_f32 v235, v235, v232
    v_accvgpr_write_b32 a65, v235
    v_accvgpr_read_b32 v236, a66
    v_mul_f32 v236, v236, v232
    v_accvgpr_write_b32 a66, v236
    v_accvgpr_read_b32 v237, a67
    v_mul_f32 v237, v237, v232
    v_accvgpr_write_b32 a67, v237
    v_accvgpr_read_b32 v234, a68
    v_mul_f32 v234, v234, v232
    v_accvgpr_write_b32 a68, v234
    v_accvgpr_read_b32 v235, a69
    v_mul_f32 v235, v235, v232
    v_accvgpr_write_b32 a69, v235
    v_accvgpr_read_b32 v236, a70
    v_mul_f32 v236, v236, v232
    v_accvgpr_write_b32 a70, v236
    v_accvgpr_read_b32 v237, a71
    v_mul_f32 v237, v237, v232
    v_accvgpr_write_b32 a71, v237
    v_accvgpr_read_b32 v234, a72
    v_mul_f32 v234, v234, v232
    v_accvgpr_write_b32 a72, v234
    v_accvgpr_read_b32 v235, a73
    v_mul_f32 v235, v235, v232
    v_accvgpr_write_b32 a73, v235
    v_accvgpr_read_b32 v236, a74
    v_mul_f32 v236, v236, v232
    v_accvgpr_write_b32 a74, v236
    v_accvgpr_read_b32 v237, a75
    v_mul_f32 v237, v237, v232
    v_accvgpr_write_b32 a75, v237
    v_accvgpr_read_b32 v234, a76
    v_mul_f32 v234, v234, v232
    v_accvgpr_write_b32 a76, v234
    v_accvgpr_read_b32 v235, a77
    v_mul_f32 v235, v235, v232
    v_accvgpr_write_b32 a77, v235
    v_accvgpr_read_b32 v236, a78
    v_mul_f32 v236, v236, v232
    v_accvgpr_write_b32 a78, v236
    v_accvgpr_read_b32 v237, a79
    v_mul_f32 v237, v237, v232
    v_accvgpr_write_b32 a79, v237
    v_accvgpr_read_b32 v234, a80
    v_mul_f32 v234, v234, v232
    v_accvgpr_write_b32 a80, v234
    v_accvgpr_read_b32 v235, a81
    v_mul_f32 v235, v235, v232
    v_accvgpr_write_b32 a81, v235
    v_accvgpr_read_b32 v236, a82
    v_mul_f32 v236, v236, v232
    v_accvgpr_write_b32 a82, v236
    v_accvgpr_read_b32 v237, a83
    v_mul_f32 v237, v237, v232
    v_accvgpr_write_b32 a83, v237
    v_accvgpr_read_b32 v234, a84
    v_mul_f32 v234, v234, v232
    v_accvgpr_write_b32 a84, v234
    v_accvgpr_read_b32 v235, a85
    v_mul_f32 v235, v235, v232
    v_accvgpr_write_b32 a85, v235
    v_accvgpr_read_b32 v236, a86
    v_mul_f32 v236, v236, v232
    v_accvgpr_write_b32 a86, v236
    v_accvgpr_read_b32 v237, a87
    v_mul_f32 v237, v237, v232
    v_accvgpr_write_b32 a87, v237
    v_accvgpr_read_b32 v234, a88
    v_mul_f32 v234, v234, v232
    v_accvgpr_write_b32 a88, v234
    v_accvgpr_read_b32 v235, a89
    v_mul_f32 v235, v235, v232
    v_accvgpr_write_b32 a89, v235
    v_accvgpr_read_b32 v236, a90
    v_mul_f32 v236, v236, v232
    v_accvgpr_write_b32 a90, v236
    v_accvgpr_read_b32 v237, a91
    v_mul_f32 v237, v237, v232
    v_accvgpr_write_b32 a91, v237
    v_accvgpr_read_b32 v234, a92
    v_mul_f32 v234, v234, v232
    v_accvgpr_write_b32 a92, v234
    v_accvgpr_read_b32 v235, a93
    v_mul_f32 v235, v235, v232
    v_accvgpr_write_b32 a93, v235
    v_accvgpr_read_b32 v236, a94
    v_mul_f32 v236, v236, v232
    v_accvgpr_write_b32 a94, v236
    v_accvgpr_read_b32 v237, a95
    v_mul_f32 v237, v237, v232
    v_accvgpr_write_b32 a95, v237
    v_accvgpr_read_b32 v234, a96
    v_mul_f32 v234, v234, v232
    v_accvgpr_write_b32 a96, v234
    v_accvgpr_read_b32 v235, a97
    v_mul_f32 v235, v235, v232
    v_accvgpr_write_b32 a97, v235
    v_accvgpr_read_b32 v236, a98
    v_mul_f32 v236, v236, v232
    v_accvgpr_write_b32 a98, v236
    v_accvgpr_read_b32 v237, a99
    v_mul_f32 v237, v237, v232
    v_accvgpr_write_b32 a99, v237
    v_accvgpr_read_b32 v234, a100
    v_mul_f32 v234, v234, v232
    v_accvgpr_write_b32 a100, v234
    v_accvgpr_read_b32 v235, a101
    v_mul_f32 v235, v235, v232
    v_accvgpr_write_b32 a101, v235
    v_accvgpr_read_b32 v236, a102
    v_mul_f32 v236, v236, v232
    v_accvgpr_write_b32 a102, v236
    v_accvgpr_read_b32 v237, a103
    v_mul_f32 v237, v237, v232
    v_accvgpr_write_b32 a103, v237
    v_accvgpr_read_b32 v234, a104
    v_mul_f32 v234, v234, v232
    v_accvgpr_write_b32 a104, v234
    v_accvgpr_read_b32 v235, a105
    v_mul_f32 v235, v235, v232
    v_accvgpr_write_b32 a105, v235
    v_accvgpr_read_b32 v236, a106
    v_mul_f32 v236, v236, v232
    v_accvgpr_write_b32 a106, v236
    v_accvgpr_read_b32 v237, a107
    v_mul_f32 v237, v237, v232
    v_accvgpr_write_b32 a107, v237
    v_accvgpr_read_b32 v234, a108
    v_mul_f32 v234, v234, v232
    v_accvgpr_write_b32 a108, v234
    v_accvgpr_read_b32 v235, a109
    v_mul_f32 v235, v235, v232
    v_accvgpr_write_b32 a109, v235
    v_accvgpr_read_b32 v236, a110
    v_mul_f32 v236, v236, v232
    v_accvgpr_write_b32 a110, v236
    v_accvgpr_read_b32 v237, a111
    v_mul_f32 v237, v237, v232
    v_accvgpr_write_b32 a111, v237
    v_accvgpr_read_b32 v234, a112
    v_mul_f32 v234, v234, v232
    v_accvgpr_write_b32 a112, v234
    v_accvgpr_read_b32 v235, a113
    v_mul_f32 v235, v235, v232
    v_accvgpr_write_b32 a113, v235
    v_accvgpr_read_b32 v236, a114
    v_mul_f32 v236, v236, v232
    v_accvgpr_write_b32 a114, v236
    v_accvgpr_read_b32 v237, a115
    v_mul_f32 v237, v237, v232
    v_accvgpr_write_b32 a115, v237
    v_accvgpr_read_b32 v234, a116
    v_mul_f32 v234, v234, v232
    v_accvgpr_write_b32 a116, v234
    v_accvgpr_read_b32 v235, a117
    v_mul_f32 v235, v235, v232
    v_accvgpr_write_b32 a117, v235
    v_accvgpr_read_b32 v236, a118
    v_mul_f32 v236, v236, v232
    v_accvgpr_write_b32 a118, v236
    v_accvgpr_read_b32 v237, a119
    v_mul_f32 v237, v237, v232
    v_accvgpr_write_b32 a119, v237
    v_accvgpr_read_b32 v234, a120
    v_mul_f32 v234, v234, v232
    v_accvgpr_write_b32 a120, v234
    v_accvgpr_read_b32 v235, a121
    v_mul_f32 v235, v235, v232
    v_accvgpr_write_b32 a121, v235
    v_accvgpr_read_b32 v236, a122
    v_mul_f32 v236, v236, v232
    v_accvgpr_write_b32 a122, v236
    v_accvgpr_read_b32 v237, a123
    v_mul_f32 v237, v237, v232
    v_accvgpr_write_b32 a123, v237
    v_accvgpr_read_b32 v234, a124
    v_mul_f32 v234, v234, v232
    v_accvgpr_write_b32 a124, v234
    v_accvgpr_read_b32 v235, a125
    v_mul_f32 v235, v235, v232
    v_accvgpr_write_b32 a125, v235
    v_accvgpr_read_b32 v236, a126
    v_mul_f32 v236, v236, v232
    v_accvgpr_write_b32 a126, v236
    v_accvgpr_read_b32 v237, a127
    v_mul_f32 v237, v237, v232
    v_accvgpr_write_b32 a127, v237
    v_exp_f32 v138, v48
    v_exp_f32 v139, v49
    v_exp_f32 v130, v50
    v_exp_f32 v131, v51
    v_cvt_pk_bf16_f32 v120, v138, v139
    v_exp_f32 v132, v52
    v_exp_f32 v133, v53
    v_cvt_pk_bf16_f32 v121, v130, v131
    v_add_f32 v138, v138, v130
    v_add_f32 v139, v139, v131
    v_exp_f32 v134, v54
    v_exp_f32 v135, v55
    v_cvt_pk_bf16_f32 v122, v132, v133
    v_add_f32 v138, v138, v132
    v_add_f32 v139, v139, v133
    v_exp_f32 v128, v56
    v_exp_f32 v129, v57
    v_cvt_pk_bf16_f32 v123, v134, v135
    v_add_f32 v138, v138, v134
    v_add_f32 v139, v139, v135
    v_exp_f32 v130, v58
    v_exp_f32 v131, v59
    v_cvt_pk_bf16_f32 v124, v128, v129
    v_add_f32 v138, v138, v128
    v_add_f32 v139, v139, v129
    v_exp_f32 v132, v60
    v_exp_f32 v133, v61
    v_cvt_pk_bf16_f32 v125, v130, v131
    v_add_f32 v138, v138, v130
    v_add_f32 v139, v139, v131
    v_exp_f32 v134, v62
    v_exp_f32 v135, v63
    v_cvt_pk_bf16_f32 v126, v132, v133
    v_add_f32 v138, v138, v132
    v_add_f32 v139, v139, v133
    v_cvt_pk_bf16_f32 v127, v134, v135
    v_add_f32 v138, v138, v134
    v_add_f32 v139, v139, v135
    v_add_f32 v225, v138, v139
    s_nop 1
    s_branch kf_rr7
kf_fix9:
    s_cmp_eq_u32 s33, 0
    s_cselect_b32 s24, 0, 0x74000000
    s_cselect_b32 s36, 0, 0x1000
    s_mov_b32 s33, 1
    v_subrev_f32 v230, s24, v243
    v_add_f32 v231, 0, v230
    v_min_f32 v64, v228, v231
    v_add_f32 v232, 0xf1800000, v230
    v_min_f32 v65, v228, v232
    v_add_f32 v231, 0xf2000000, v230
    v_min_f32 v66, v228, v231
    v_add_f32 v232, 0xf2400000, v230
    v_min_f32 v67, v228, v232
    v_add_f32 v231, 0xf3000000, v230
    v_min_f32 v68, v228, v231
    v_add_f32 v232, 0xf3100000, v230
    v_min_f32 v69, v228, v232
    v_add_f32 v231, 0xf3200000, v230
    v_min_f32 v70, v228, v231
    v_add_f32 v232, 0xf3300000, v230
    v_min_f32 v71, v228, v232
    v_add_f32 v231, 0xf3800000, v230
    v_min_f32 v72, v228, v231
    v_add_f32 v232, 0xf3880000, v230
    v_min_f32 v73, v228, v232
    v_add_f32 v231, 0xf3900000, v230
    v_min_f32 v74, v228, v231
    v_add_f32 v232, 0xf3980000, v230
    v_min_f32 v75, v228, v232
    v_add_f32 v231, 0xf3c00000, v230
    v_min_f32 v76, v228, v231
    v_add_f32 v232, 0xf3c80000, v230
    v_min_f32 v77, v228, v232
    v_add_f32 v231, 0xf3d00000, v230
    v_min_f32 v78, v228, v231
    v_add_f32 v232, 0xf3d80000, v230
    v_min_f32 v79, v228, v232
    s_nop 1
    s_branch kf_fixr10
kf_rare12:
    s_nop 15
    v_max3_f32 v230, v0, v1, v2
    v_max3_f32 v230, v230, v3, v4
    v_max3_f32 v230, v230, v5, v6
    v_max3_f32 v230, v230, v7, v8
    v_max3_f32 v230, v230, v9, v10
    v_max3_f32 v230, v230, v11, v12
    v_max3_f32 v230, v230, v13, v14
    v_max_f32 v230, v230, v15
    v_mov_b32 v231, v230
    s_nop 1
    v_permlane32_swap_b32 v230, v231
    s_nop 0
    v_max_f32 v230, v230, v231
    v_max_f32 v230, 0, v230
    v_sub_f32 v232, 0, v230
    v_exp_f32 v232, v232
    v_sub_f32 v228, v228, v230
    v_sub_f32 v64, v64, v230
    v_sub_f32 v32, v32, v230
    v_sub_f32 v0, v0, v230
    v_sub_f32 v65, v65, v230
    v_sub_f32 v33, v33, v230
    v_sub_f32 v1, v1, v230
    v_sub_f32 v66, v66, v230
    v_sub_f32 v34, v34, v230
    v_sub_f32 v2, v2, v230
    v_sub_f32 v67, v67, v230
    v_sub_f32 v35, v35, v230
    v_sub_f32 v3, v3, v230
    v_sub_f32 v68, v68, v230
    v_sub_f32 v36, v36, v230
    v_sub_f32 v4, v4, v230
    v_sub_f32 v69, v69, v230
    v_sub_f32 v37, v37, v230
    v_sub_f32 v5, v5, v230
    v_sub_f32 v70, v70, v230
    v_sub_f32 v38, v38, v230
    v_sub_f32 v6, v6, v230
    v_sub_f32 v71, v71, v230
    v_sub_f32 v39, v39, v230
    v_sub_f32 v7, v7, v230
    v_sub_f32 v72, v72, v230
    v_sub_f32 v40, v40, v230
    v_sub_f32 v8, v8, v230
    v_sub_f32 v73, v73, v230
    v_sub_f32 v41, v41, v230
    v_sub_f32 v9, v9, v230
    v_sub_f32 v74, v74, v230
    v_sub_f32 v42, v42, v230
    v_sub_f32 v10, v10, v230
    v_sub_f32 v75, v75, v230
    v_sub_f32 v43, v43, v230
    v_sub_f32 v11, v11, v230
    v_sub_f32 v76, v76, v230
    v_sub_f32 v44, v44, v230
    v_sub_f32 v12, v12, v230
    v_sub_f32 v77, v77, v230
    v_sub_f32 v45, v45, v230
    v_sub_f32 v13, v13, v230
    v_sub_f32 v78, v78, v230
    v_sub_f32 v46, v46, v230
    v_sub_f32 v14, v14, v230
    v_sub_f32 v79, v79, v230
    v_sub_f32 v47, v47, v230
    v_sub_f32 v15, v15, v230
    v_mul_f32 v226, v226, v232
    v_accvgpr_read_b32 v234, a0
    v_mul_f32 v234, v234, v232
    v_accvgpr_write_b32 a0, v234
    v_accvgpr_read_b32 v235, a1
    v_mul_f32 v235, v235, v232
    v_accvgpr_write_b32 a1, v235
    v_accvgpr_read_b32 v236, a2
    v_mul_f32 v236, v236, v232
    v_accvgpr_write_b32 a2, v236
    v_accvgpr_read_b32 v237, a3
    v_mul_f32 v237, v237, v232
    v_accvgpr_write_b32 a3, v237
    v_accvgpr_read_b32 v234, a4
    v_mul_f32 v234, v234, v232
    v_accvgpr_write_b32 a4, v234
    v_accvgpr_read_b32 v235, a5
    v_mul_f32 v235, v235, v232
    v_accvgpr_write_b32 a5, v235
    v_accvgpr_read_b32 v236, a6
    v_mul_f32 v236, v236, v232
    v_accvgpr_write_b32 a6, v236
    v_accvgpr_read_b32 v237, a7
    v_mul_f32 v237, v237, v232
    v_accvgpr_write_b32 a7, v237
    v_accvgpr_read_b32 v234, a8
    v_mul_f32 v234, v234, v232
    v_accvgpr_write_b32 a8, v234
    v_accvgpr_read_b32 v235, a9
    v_mul_f32 v235, v235, v232
    v_accvgpr_write_b32 a9, v235
    v_accvgpr_read_b32 v236, a10
    v_mul_f32 v236, v236, v232
    v_accvgpr_write_b32 a10, v236
    v_accvgpr_read_b32 v237, a11
    v_mul_f32 v237, v237, v232
    v_accvgpr_write_b32 a11, v237
    v_accvgpr_read_b32 v234, a12
    v_mul_f32 v234, v234, v232
    v_accvgpr_write_b32 a12, v234
    v_accvgpr_read_b32 v235, a13
    v_mul_f32 v235, v235, v232
    v_accvgpr_write_b32 a13, v235
    v_accvgpr_read_b32 v236, a14
    v_mul_f32 v236, v236, v232
    v_accvgpr_write_b32 a14, v236
    v_accvgpr_read_b32 v237, a15
    v_mul_f32 v237, v237, v232
    v_accvgpr_write_b32 a15, v237
    v_accvgpr_read_b32 v234, a16
    v_mul_f32 v234, v234, v232
    v_accvgpr_write_b32 a16, v234
    v_accvgpr_read_b32 v235, a17
    v_mul_f32 v235, v235, v232
    v_accvgpr_write_b32 a17, v235
    v_accvgpr_read_b32 v236, a18
    v_mul_f32 v236, v236, v232
    v_accvgpr_write_b32 a18, v236
    v_accvgpr_read_b32 v237, a19
    v_mul_f32 v237, v237, v232
    v_accvgpr_write_b32 a19, v237
    v_accvgpr_read_b32 v234, a20
    v_mul_f32 v234, v234, v232
    v_accvgpr_write_b32 a20, v234
    v_accvgpr_read_b32 v235, a21
    v_mul_f32 v235, v235, v232
    v_accvgpr_write_b32 a21, v235
    v_accvgpr_read_b32 v236, a22
    v_mul_f32 v236, v236, v232
    v_accvgpr_write_b32 a22, v236
    v_accvgpr_read_b32 v237, a23
    v_mul_f32 v237, v237, v232
    v_accvgpr_write_b32 a23, v237
    v_accvgpr_read_b32 v234, a24
    v_mul_f32 v234, v234, v232
    v_accvgpr_write_b32 a24, v234
    v_accvgpr_read_b32 v235, a25
    v_mul_f32 v235, v235, v232
    v_accvgpr_write_b32 a25, v235
    v_accvgpr_read_b32 v236, a26
    v_mul_f32 v236, v236, v232
    v_accvgpr_write_b32 a26, v236
    v_accvgpr_read_b32 v237, a27
    v_mul_f32 v237, v237, v232
    v_accvgpr_write_b32 a27, v237
    v_accvgpr_read_b32 v234, a28
    v_mul_f32 v234, v234, v232
    v_accvgpr_write_b32 a28, v234
    v_accvgpr_read_b32 v235, a29
    v_mul_f32 v235, v235, v232
    v_accvgpr_write_b32 a29, v235
    v_accvgpr_read_b32 v236, a30
    v_mul_f32 v236, v236, v232
    v_accvgpr_write_b32 a30, v236
    v_accvgpr_read_b32 v237, a31
    v_mul_f32 v237, v237, v232
    v_accvgpr_write_b32 a31, v237
    v_accvgpr_read_b32 v234, a32
    v_mul_f32 v234, v234, v232
    v_accvgpr_write_b32 a32, v234
    v_accvgpr_read_b32 v235, a33
    v_mul_f32 v235, v235, v232
    v_accvgpr_write_b32 a33, v235
    v_accvgpr_read_b32 v236, a34
    v_mul_f32 v236, v236, v232
    v_accvgpr_write_b32 a34, v236
    v_accvgpr_read_b32 v237, a35
    v_mul_f32 v237, v237, v232
    v_accvgpr_write_b32 a35, v237
    v_accvgpr_read_b32 v234, a36
    v_mul_f32 v234, v234, v232
    v_accvgpr_write_b32 a36, v234
    v_accvgpr_read_b32 v235, a37
    v_mul_f32 v235, v235, v232
    v_accvgpr_write_b32 a37, v235
    v_accvgpr_read_b32 v236, a38
    v_mul_f32 v236, v236, v232
    v_accvgpr_write_b32 a38, v236
    v_accvgpr_read_b32 v237, a39
    v_mul_f32 v237, v237, v232
    v_accvgpr_write_b32 a39, v237
    v_accvgpr_read_b32 v234, a40
    v_mul_f32 v234, v234, v232
    v_accvgpr_write_b32 a40, v234
    v_accvgpr_read_b32 v235, a41
    v_mul_f32 v235, v235, v232
    v_accvgpr_write_b32 a41, v235
    v_accvgpr_read_b32 v236, a42
    v_mul_f32 v236, v236, v232
    v_accvgpr_write_b32 a42, v236
    v_accvgpr_read_b32 v237, a43
    v_mul_f32 v237, v237, v232
    v_accvgpr_write_b32 a43, v237
    v_accvgpr_read_b32 v234, a44
    v_mul_f32 v234, v234, v232
    v_accvgpr_write_b32 a44, v234
    v_accvgpr_read_b32 v235, a45
    v_mul_f32 v235, v235, v232
    v_accvgpr_write_b32 a45, v235
    v_accvgpr_read_b32 v236, a46
    v_mul_f32 v236, v236, v232
    v_accvgpr_write_b32 a46, v236
    v_accvgpr_read_b32 v237, a47
    v_mul_f32 v237, v237, v232
    v_accvgpr_write_b32 a47, v237
    v_accvgpr_read_b32 v234, a48
    v_mul_f32 v234, v234, v232
    v_accvgpr_write_b32 a48, v234
    v_accvgpr_read_b32 v235, a49
    v_mul_f32 v235, v235, v232
    v_accvgpr_write_b32 a49, v235
    v_accvgpr_read_b32 v236, a50
    v_mul_f32 v236, v236, v232
    v_accvgpr_write_b32 a50, v236
    v_accvgpr_read_b32 v237, a51
    v_mul_f32 v237, v237, v232
    v_accvgpr_write_b32 a51, v237
    v_accvgpr_read_b32 v234, a52
    v_mul_f32 v234, v234, v232
    v_accvgpr_write_b32 a52, v234
    v_accvgpr_read_b32 v235, a53
    v_mul_f32 v235, v235, v232
    v_accvgpr_write_b32 a53, v235
    v_accvgpr_read_b32 v236, a54
    v_mul_f32 v236, v236, v232
    v_accvgpr_write_b32 a54, v236
    v_accvgpr_read_b32 v237, a55
    v_mul_f32 v237, v237, v232
    v_accvgpr_write_b32 a55, v237
    v_accvgpr_read_b32 v234, a56
    v_mul_f32 v234, v234, v232
    v_accvgpr_write_b32 a56, v234
    v_accvgpr_read_b32 v235, a57
    v_mul_f32 v235, v235, v232
    v_accvgpr_write_b32 a57, v235
    v_accvgpr_read_b32 v236, a58
    v_mul_f32 v236, v236, v232
    v_accvgpr_write_b32 a58, v236
    v_accvgpr_read_b32 v237, a59
    v_mul_f32 v237, v237, v232
    v_accvgpr_write_b32 a59, v237
    v_accvgpr_read_b32 v234, a60
    v_mul_f32 v234, v234, v232
    v_accvgpr_write_b32 a60, v234
    v_accvgpr_read_b32 v235, a61
    v_mul_f32 v235, v235, v232
    v_accvgpr_write_b32 a61, v235
    v_accvgpr_read_b32 v236, a62
    v_mul_f32 v236, v236, v232
    v_accvgpr_write_b32 a62, v236
    v_accvgpr_read_b32 v237, a63
    v_mul_f32 v237, v237, v232
    v_accvgpr_write_b32 a63, v237
    v_exp_f32 v136, v0
    v_exp_f32 v137, v1
    v_exp_f32 v130, v2
    v_exp_f32 v131, v3
    v_cvt_pk_bf16_f32 v96, v136, v137
    v_exp_f32 v132, v4
    v_exp_f32 v133, v5
    v_cvt_pk_bf16_f32 v97, v130, v131
    v_add_f32 v136, v136, v130
    v_add_f32 v137, v137, v131
    v_exp_f32 v134, v6
    v_exp_f32 v135, v7
    v_cvt_pk_bf16_f32 v98, v132, v133
    v_add_f32 v136, v136, v132
    v_add_f32 v137, v137, v133
    v_exp_f32 v128, v8
    v_exp_f32 v129, v9
    v_cvt_pk_bf16_f32 v99, v134, v135
    v_add_f32 v136, v136, v134
    v_add_f32 v137, v137, v135
    v_exp_f32 v130, v10
    v_exp_f32 v131, v11
    v_cvt_pk_bf16_f32 v100, v128, v129
    v_add_f32 v136, v136, v128
    v_add_f32 v137, v137, v129
    v_exp_f32 v132, v12
    v_exp_f32 v133, v13
    v_cvt_pk_bf16_f32 v101, v130, v131
    v_add_f32 v136, v136, v130
    v_add_f32 v137, v137, v131
    v_exp_f32 v134, v14
    v_exp_f32 v135, v15
    v_cvt_pk_bf16_f32 v102, v132, v133
    v_add_f32 v136, v136, v132
    v_add_f32 v137, v137, v133
    v_cvt_pk_bf16_f32 v103, v134, v135
    v_add_f32 v136, v136, v134
    v_add_f32 v137, v137, v135
    v_add_f32 v224, v136, v137
    v_max3_f32 v230, v16, v17, v18
    v_max3_f32 v230, v230, v19, v20
    v_max3_f32 v230, v230, v21, v22
    v_max3_f32 v230, v230, v23, v24
    v_max3_f32 v230, v230, v25, v26
    v_max3_f32 v230, v230, v27, v28
    v_max3_f32 v230, v230, v29, v30
    v_max_f32 v230, v230, v31
    v_mov_b32 v231, v230
    s_nop 1
    v_permlane32_swap_b32 v230, v231
    s_nop 0
    v_max_f32 v230, v230, v231
    v_max_f32 v230, 0, v230
    v_sub_f32 v232, 0, v230
    v_exp_f32 v232, v232
    v_sub_f32 v229, v229, v230
    v_sub_f32 v80, v80, v230
    v_sub_f32 v48, v48, v230
    v_sub_f32 v16, v16, v230
    v_sub_f32 v81, v81, v230
    v_sub_f32 v49, v49, v230
    v_sub_f32 v17, v17, v230
    v_sub_f32 v82, v82, v230
    v_sub_f32 v50, v50, v230
    v_sub_f32 v18, v18, v230
    v_sub_f32 v83, v83, v230
    v_sub_f32 v51, v51, v230
    v_sub_f32 v19, v19, v230
    v_sub_f32 v84, v84, v230
    v_sub_f32 v52, v52, v230
    v_sub_f32 v20, v20, v230
    v_sub_f32 v85, v85, v230
    v_sub_f32 v53, v53, v230
    v_sub_f32 v21, v21, v230
    v_sub_f32 v86, v86, v230
    v_sub_f32 v54, v54, v230
    v_sub_f32 v22, v22, v230
    v_sub_f32 v87, v87, v230
    v_sub_f32 v55, v55, v230
    v_sub_f32 v23, v23, v230
    v_sub_f32 v88, v88, v230
    v_sub_f32 v56, v56, v230
    v_sub_f32 v24, v24, v230
    v_sub_f32 v89, v89, v230
    v_sub_f32 v57, v57, v230
    v_sub_f32 v25, v25, v230
    v_sub_f32 v90, v90, v230
    v_sub_f32 v58, v58, v230
    v_sub_f32 v26, v26, v230
    v_sub_f32 v91, v91, v230
    v_sub_f32 v59, v59, v230
    v_sub_f32 v27, v27, v230
    v_sub_f32 v92, v92, v230
    v_sub_f32 v60, v60, v230
    v_sub_f32 v28, v28, v230
    v_sub_f32 v93, v93, v230
    v_sub_f32 v61, v61, v230
    v_sub_f32 v29, v29, v230
    v_sub_f32 v94, v94, v230
    v_sub_f32 v62, v62, v230
    v_sub_f32 v30, v30, v230
    v_sub_f32 v95, v95, v230
    v_sub_f32 v63, v63, v230
    v_sub_f32 v31, v31, v230
    v_mul_f32 v227, v227, v232
    v_accvgpr_read_b32 v234, a64
    v_mul_f32 v234, v234, v232
    v_accvgpr_write_b32 a64, v234
    v_accvgpr_read_b32 v235, a65
    v_mul_f32 v235, v235, v232
    v_accvgpr_write_b32 a65, v235
    v_accvgpr_read_b32 v236, a66
    v_mul_f32 v236, v236, v232
    v_accvgpr_write_b32 a66, v236
    v_accvgpr_read_b32 v237, a67
    v_mul_f32 v237, v237, v232
    v_accvgpr_write_b32 a67, v237
    v_accvgpr_read_b32 v234, a68
    v_mul_f32 v234, v234, v232
    v_accvgpr_write_b32 a68, v234
    v_accvgpr_read_b32 v235, a69
    v_mul_f32 v235, v235, v232
    v_accvgpr_write_b32 a69, v235
    v_accvgpr_read_b32 v236, a70
    v_mul_f32 v236, v236, v232
    v_accvgpr_write_b32 a70, v236
    v_accvgpr_read_b32 v237, a71
    v_mul_f32 v237, v237, v232
    v_accvgpr_write_b32 a71, v237
    v_accvgpr_read_b32 v234, a72
    v_mul_f32 v234, v234, v232
    v_accvgpr_write_b32 a72, v234
    v_accvgpr_read_b32 v235, a73
    v_mul_f32 v235, v235, v232
    v_accvgpr_write_b32 a73, v235
    v_accvgpr_read_b32 v236, a74
    v_mul_f32 v236, v236, v232
    v_accvgpr_write_b32 a74, v236
    v_accvgpr_read_b32 v237, a75
    v_mul_f32 v237, v237, v232
    v_accvgpr_write_b32 a75, v237
    v_accvgpr_read_b32 v234, a76
    v_mul_f32 v234, v234, v232
    v_accvgpr_write_b32 a76, v234
    v_accvgpr_read_b32 v235, a77
    v_mul_f32 v235, v235, v232
    v_accvgpr_write_b32 a77, v235
    v_accvgpr_read_b32 v236, a78
    v_mul_f32 v236, v236, v232
    v_accvgpr_write_b32 a78, v236
    v_accvgpr_read_b32 v237, a79
    v_mul_f32 v237, v237, v232
    v_accvgpr_write_b32 a79, v237
    v_accvgpr_read_b32 v234, a80
    v_mul_f32 v234, v234, v232
    v_accvgpr_write_b32 a80, v234
    v_accvgpr_read_b32 v235, a81
    v_mul_f32 v235, v235, v232
    v_accvgpr_write_b32 a81, v235
    v_accvgpr_read_b32 v236, a82
    v_mul_f32 v236, v236, v232
    v_accvgpr_write_b32 a82, v236
    v_accvgpr_read_b32 v237, a83
    v_mul_f32 v237, v237, v232
    v_accvgpr_write_b32 a83, v237
    v_accvgpr_read_b32 v234, a84
    v_mul_f32 v234, v234, v232
    v_accvgpr_write_b32 a84, v234
    v_accvgpr_read_b32 v235, a85
    v_mul_f32 v235, v235, v232
    v_accvgpr_write_b32 a85, v235
    v_accvgpr_read_b32 v236, a86
    v_mul_f32 v236, v236, v232
    v_accvgpr_write_b32 a86, v236
    v_accvgpr_read_b32 v237, a87
    v_mul_f32 v237, v237, v232
    v_accvgpr_write_b32 a87, v237
    v_accvgpr_read_b32 v234, a88
    v_mul_f32 v234, v234, v232
    v_accvgpr_write_b32 a88, v234
    v_accvgpr_read_b32 v235, a89
    v_mul_f32 v235, v235, v232
    v_accvgpr_write_b32 a89, v235
    v_accvgpr_read_b32 v236, a90
    v_mul_f32 v236, v236, v232
    v_accvgpr_write_b32 a90, v236
    v_accvgpr_read_b32 v237, a91
    v_mul_f32 v237, v237, v232
    v_accvgpr_write_b32 a91, v237
    v_accvgpr_read_b32 v234, a92
    v_mul_f32 v234, v234, v232
    v_accvgpr_write_b32 a92, v234
    v_accvgpr_read_b32 v235, a93
    v_mul_f32 v235, v235, v232
    v_accvgpr_write_b32 a93, v235
    v_accvgpr_read_b32 v236, a94
    v_mul_f32 v236, v236, v232
    v_accvgpr_write_b32 a94, v236
    v_accvgpr_read_b32 v237, a95
    v_mul_f32 v237, v237, v232
    v_accvgpr_write_b32 a95, v237
    v_accvgpr_read_b32 v234, a96
    v_mul_f32 v234, v234, v232
    v_accvgpr_write_b32 a96, v234
    v_accvgpr_read_b32 v235, a97
    v_mul_f32 v235, v235, v232
    v_accvgpr_write_b32 a97, v235
    v_accvgpr_read_b32 v236, a98
    v_mul_f32 v236, v236, v232
    v_accvgpr_write_b32 a98, v236
    v_accvgpr_read_b32 v237, a99
    v_mul_f32 v237, v237, v232
    v_accvgpr_write_b32 a99, v237
    v_accvgpr_read_b32 v234, a100
    v_mul_f32 v234, v234, v232
    v_accvgpr_write_b32 a100, v234
    v_accvgpr_read_b32 v235, a101
    v_mul_f32 v235, v235, v232
    v_accvgpr_write_b32 a101, v235
    v_accvgpr_read_b32 v236, a102
    v_mul_f32 v236, v236, v232
    v_accvgpr_write_b32 a102, v236
    v_accvgpr_read_b32 v237, a103
    v_mul_f32 v237, v237, v232
    v_accvgpr_write_b32 a103, v237
    v_accvgpr_read_b32 v234, a104
    v_mul_f32 v234, v234, v232
    v_accvgpr_write_b32 a104, v234
    v_accvgpr_read_b32 v235, a105
    v_mul_f32 v235, v235, v232
    v_accvgpr_write_b32 a105, v235
    v_accvgpr_read_b32 v236, a106
    v_mul_f32 v236, v236, v232
    v_accvgpr_write_b32 a106, v236
    v_accvgpr_read_b32 v237, a107
    v_mul_f32 v237, v237, v232
    v_accvgpr_write_b32 a107, v237
    v_accvgpr_read_b32 v234, a108
    v_mul_f32 v234, v234, v232
    v_accvgpr_write_b32 a108, v234
    v_accvgpr_read_b32 v235, a109
    v_mul_f32 v235, v235, v232
    v_accvgpr_write_b32 a109, v235
    v_accvgpr_read_b32 v236, a110
    v_mul_f32 v236, v236, v232
    v_accvgpr_write_b32 a110, v236
    v_accvgpr_read_b32 v237, a111
    v_mul_f32 v237, v237, v232
    v_accvgpr_write_b32 a111, v237
    v_accvgpr_read_b32 v234, a112
    v_mul_f32 v234, v234, v232
    v_accvgpr_write_b32 a112, v234
    v_accvgpr_read_b32 v235, a113
    v_mul_f32 v235, v235, v232
    v_accvgpr_write_b32 a113, v235
    v_accvgpr_read_b32 v236, a114
    v_mul_f32 v236, v236, v232
    v_accvgpr_write_b32 a114, v236
    v_accvgpr_read_b32 v237, a115
    v_mul_f32 v237, v237, v232
    v_accvgpr_write_b32 a115, v237
    v_accvgpr_read_b32 v234, a116
    v_mul_f32 v234, v234, v232
    v_accvgpr_write_b32 a116, v234
    v_accvgpr_read_b32 v235, a117
    v_mul_f32 v235, v235, v232
    v_accvgpr_write_b32 a117, v235
    v_accvgpr_read_b32 v236, a118
    v_mul_f32 v236, v236, v232
    v_accvgpr_write_b32 a118, v236
    v_accvgpr_read_b32 v237, a119
    v_mul_f32 v237, v237, v232
    v_accvgpr_write_b32 a119, v237
    v_accvgpr_read_b32 v234, a120
    v_mul_f32 v234, v234, v232
    v_accvgpr_write_b32 a120, v234
    v_accvgpr_read_b32 v235, a121
    v_mul_f32 v235, v235, v232
    v_accvgpr_write_b32 a121, v235
    v_accvgpr_read_b32 v236, a122
    v_mul_f32 v236, v236, v232
    v_accvgpr_write_b32 a122, v236
    v_accvgpr_read_b32 v237, a123
    v_mul_f32 v237, v237, v232
    v_accvgpr_write_b32 a123, v237
    v_accvgpr_read_b32 v234, a124
    v_mul_f32 v234, v234, v232
    v_accvgpr_write_b32 a124, v234
    v_accvgpr_read_b32 v235, a125
    v_mul_f32 v235, v235, v232
    v_accvgpr_write_b32 a125, v235
    v_accvgpr_read_b32 v236, a126
    v_mul_f32 v236, v236, v232
    v_accvgpr_write_b32 a126, v236
    v_accvgpr_read_b32 v237, a127
    v_mul_f32 v237, v237, v232
    v_accvgpr_write_b32 a127, v237
    v_exp_f32 v138, v16
    v_exp_f32 v139, v17
    v_exp_f32 v130, v18
    v_exp_f32 v131, v19
    v_cvt_pk_bf16_f32 v104, v138, v139
    v_exp_f32 v132, v20
    v_exp_f32 v133, v21
    v_cvt_pk_bf16_f32 v105, v130, v131
    v_add_f32 v138, v138, v130
    v_add_f32 v139, v139, v131
    v_exp_f32 v134, v22
    v_exp_f32 v135, v23
    v_cvt_pk_bf16_f32 v106, v132, v133
    v_add_f32 v138, v138, v132
    v_add_f32 v139, v139, v133
    v_exp_f32 v128, v24
    v_exp_f32 v129, v25
    v_cvt_pk_bf16_f32 v107, v134, v135
    v_add_f32 v138, v138, v134
    v_add_f32 v139, v139, v135
    v_exp_f32 v130, v26
    v_exp_f32 v131, v27
    v_cvt_pk_bf16_f32 v108, v128, v129
    v_add_f32 v138, v138, v128
    v_add_f32 v139, v139, v129
    v_exp_f32 v132, v28
    v_exp_f32 v133, v29
    v_cvt_pk_bf16_f32 v109, v130, v131
    v_add_f32 v138, v138, v130
    v_add_f32 v139, v139, v131
    v_exp_f32 v134, v30
    v_exp_f32 v135, v31
    v_cvt_pk_bf16_f32 v110, v132, v133
    v_add_f32 v138, v138, v132
    v_add_f32 v139, v139, v133
    v_cvt_pk_bf16_f32 v111, v134, v135
    v_add_f32 v138, v138, v134
    v_add_f32 v139, v139, v135
    v_add_f32 v225, v138, v139
    s_nop 1
    s_branch kf_rr11
kf_fix13:
    s_cmp_eq_u32 s33, 0
    s_cselect_b32 s24, 0, 0x74000000
    s_cselect_b32 s36, 0, 0x1000
    s_mov_b32 s33, 1
    v_subrev_f32 v230, s24, v243
    v_add_f32 v231, 0, v230
    v_min_f32 v80, v229, v231
    v_add_f32 v232, 0xf1800000, v230
    v_min_f32 v81, v229, v232
    v_add_f32 v231, 0xf2000000, v230
    v_min_f32 v82, v229, v231
    v_add_f32 v232, 0xf2400000, v230
    v_min_f32 v83, v229, v232
    v_add_f32 v231, 0xf3000000, v230
    v_min_f32 v84, v229, v231
    v_add_f32 v232, 0xf3100000, v230
    v_min_f32 v85, v229, v232
    v_add_f32 v231, 0xf3200000, v230
    v_min_f32 v86, v229, v231
    v_add_f32 v232, 0xf3300000, v230
    v_min_f32 v87, v229, v232
    v_add_f32 v231, 0xf3800000, v230
    v_min_f32 v88, v229, v231
    v_add_f32 v232, 0xf3880000, v230
    v_min_f32 v89, v229, v232
    v_add_f32 v231, 0xf3900000, v230
    v_min_f32 v90, v229, v231
    v_add_f32 v232, 0xf3980000, v230
    v_min_f32 v91, v229, v232
    v_add_f32 v231, 0xf3c00000, v230
    v_min_f32 v92, v229, v231
    v_add_f32 v232, 0xf3c80000, v230
    v_min_f32 v93, v229, v232
    v_add_f32 v231, 0xf3d00000, v230
    v_min_f32 v94, v229, v231
    v_add_f32 v232, 0xf3d80000, v230
    v_min_f32 v95, v229, v232
    s_nop 1
    s_branch kf_fixr14
kf_rare16:
    s_nop 15
    v_max3_f32 v230, v32, v33, v34
    v_max3_f32 v230, v230, v35, v36
    v_max3_f32 v230, v230, v37, v38
    v_max3_f32 v230, v230, v39, v40
    v_max3_f32 v230, v230, v41, v42
    v_max3_f32 v230, v230, v43, v44
    v_max3_f32 v230, v230, v45, v46
    v_max_f32 v230, v230, v47
    v_mov_b32 v231, v230
    s_nop 1
    v_permlane32_swap_b32 v230, v231
    s_nop 0
    v_max_f32 v230, v230, v231
    v_max_f32 v230, 0, v230
    v_sub_f32 v232, 0, v230
    v_exp_f32 v232, v232
    v_sub_f32 v228, v228, v230
    v_sub_f32 v64, v64, v230
    v_sub_f32 v0, v0, v230
    v_sub_f32 v32, v32, v230
    v_sub_f32 v65, v65, v230
    v_sub_f32 v1, v1, v230
    v_sub_f32 v33, v33, v230
    v_sub_f32 v66, v66, v230
    v_sub_f32 v2, v2, v230
    v_sub_f32 v34, v34, v230
    v_sub_f32 v67, v67, v230
    v_sub_f32 v3, v3, v230
    v_sub_f32 v35, v35, v230
    v_sub_f32 v68, v68, v230
    v_sub_f32 v4, v4, v230
    v_sub_f32 v36, v36, v230
    v_sub_f32 v69, v69, v230
    v_sub_f32 v5, v5, v230
    v_sub_f32 v37, v37, v230
    v_sub_f32 v70, v70, v230
    v_sub_f32 v6, v6, v230
    v_sub_f32 v38, v38, v230
    v_sub_f32 v71, v71, v230
    v_sub_f32 v7, v7, v230
    v_sub_f32 v39, v39, v230
    v_sub_f32 v72, v72, v230
    v_sub_f32 v8, v8, v230
    v_sub_f32 v40, v40, v230
    v_sub_f32 v73, v73, v230
    v_sub_f32 v9, v9, v230
    v_sub_f32 v41, v41, v230
    v_sub_f32 v74, v74, v230
    v_sub_f32 v10, v10, v230
    v_sub_f32 v42, v42, v230
    v_sub_f32 v75, v75, v230
    v_sub_f32 v11, v11, v230
    v_sub_f32 v43, v43, v230
    v_sub_f32 v76, v76, v230
    v_sub_f32 v12, v12, v230
    v_sub_f32 v44, v44, v230
    v_sub_f32 v77, v77, v230
    v_sub_f32 v13, v13, v230
    v_sub_f32 v45, v45, v230
    v_sub_f32 v78, v78, v230
    v_sub_f32 v14, v14, v230
    v_sub_f32 v46, v46, v230
    v_sub_f32 v79, v79, v230
    v_sub_f32 v15, v15, v230
    v_sub_f32 v47, v47, v230
    v_mul_f32 v226, v226, v232
    v_accvgpr_read_b32 v234, a0
    v_mul_f32 v234, v234, v232
    v_accvgpr_write_b32 a0, v234
    v_accvgpr_read_b32 v235, a1
    v_mul_f32 v235, v235, v232
    v_accvgpr_write_b32 a1, v235
    v_accvgpr_read_b32 v236, a2
    v_mul_f32 v236, v236, v232
    v_accvgpr_write_b32 a2, v236
    v_accvgpr_read_b32 v237, a3
    v_mul_f32 v237, v237, v232
    v_accvgpr_write_b32 a3, v237
    v_accvgpr_read_b32 v234, a4
    v_mul_f32 v234, v234, v232
    v_accvgpr_write_b32 a4, v234
    v_accvgpr_read_b32 v235, a5
    v_mul_f32 v235, v235, v232
    v_accvgpr_write_b32 a5, v235
    v_accvgpr_read_b32 v236, a6
    v_mul_f32 v236, v236, v232
    v_accvgpr_write_b32 a6, v236
    v_accvgpr_read_b32 v237, a7
    v_mul_f32 v237, v237, v232
    v_accvgpr_write_b32 a7, v237
    v_accvgpr_read_b32 v234, a8
    v_mul_f32 v234, v234, v232
    v_accvgpr_write_b32 a8, v234
    v_accvgpr_read_b32 v235, a9
    v_mul_f32 v235, v235, v232
    v_accvgpr_write_b32 a9, v235
    v_accvgpr_read_b32 v236, a10
    v_mul_f32 v236, v236, v232
    v_accvgpr_write_b32 a10, v236
    v_accvgpr_read_b32 v237, a11
    v_mul_f32 v237, v237, v232
    v_accvgpr_write_b32 a11, v237
    v_accvgpr_read_b32 v234, a12
    v_mul_f32 v234, v234, v232
    v_accvgpr_write_b32 a12, v234
    v_accvgpr_read_b32 v235, a13
    v_mul_f32 v235, v235, v232
    v_accvgpr_write_b32 a13, v235
    v_accvgpr_read_b32 v236, a14
    v_mul_f32 v236, v236, v232
    v_accvgpr_write_b32 a14, v236
    v_accvgpr_read_b32 v237, a15
    v_mul_f32 v237, v237, v232
    v_accvgpr_write_b32 a15, v237
    v_accvgpr_read_b32 v234, a16
    v_mul_f32 v234, v234, v232
    v_accvgpr_write_b32 a16, v234
    v_accvgpr_read_b32 v235, a17
    v_mul_f32 v235, v235, v232
    v_accvgpr_write_b32 a17, v235
    v_accvgpr_read_b32 v236, a18
    v_mul_f32 v236, v236, v232
    v_accvgpr_write_b32 a18, v236
    v_accvgpr_read_b32 v237, a19
    v_mul_f32 v237, v237, v232
    v_accvgpr_write_b32 a19, v237
    v_accvgpr_read_b32 v234, a20
    v_mul_f32 v234, v234, v232
    v_accvgpr_write_b32 a20, v234
    v_accvgpr_read_b32 v235, a21
    v_mul_f32 v235, v235, v232
    v_accvgpr_write_b32 a21, v235
    v_accvgpr_read_b32 v236, a22
    v_mul_f32 v236, v236, v232
    v_accvgpr_write_b32 a22, v236
    v_accvgpr_read_b32 v237, a23
    v_mul_f32 v237, v237, v232
    v_accvgpr_write_b32 a23, v237
    v_accvgpr_read_b32 v234, a24
    v_mul_f32 v234, v234, v232
    v_accvgpr_write_b32 a24, v234
    v_accvgpr_read_b32 v235, a25
    v_mul_f32 v235, v235, v232
    v_accvgpr_write_b32 a25, v235
    v_accvgpr_read_b32 v236, a26
    v_mul_f32 v236, v236, v232
    v_accvgpr_write_b32 a26, v236
    v_accvgpr_read_b32 v237, a27
    v_mul_f32 v237, v237, v232
    v_accvgpr_write_b32 a27, v237
    v_accvgpr_read_b32 v234, a28
    v_mul_f32 v234, v234, v232
    v_accvgpr_write_b32 a28, v234
    v_accvgpr_read_b32 v235, a29
    v_mul_f32 v235, v235, v232
    v_accvgpr_write_b32 a29, v235
    v_accvgpr_read_b32 v236, a30
    v_mul_f32 v236, v236, v232
    v_accvgpr_write_b32 a30, v236
    v_accvgpr_read_b32 v237, a31
    v_mul_f32 v237, v237, v232
    v_accvgpr_write_b32 a31, v237
    v_accvgpr_read_b32 v234, a32
    v_mul_f32 v234, v234, v232
    v_accvgpr_write_b32 a32, v234
    v_accvgpr_read_b32 v235, a33
    v_mul_f32 v235, v235, v232
    v_accvgpr_write_b32 a33, v235
    v_accvgpr_read_b32 v236, a34
    v_mul_f32 v236, v236, v232
    v_accvgpr_write_b32 a34, v236
    v_accvgpr_read_b32 v237, a35
    v_mul_f32 v237, v237, v232
    v_accvgpr_write_b32 a35, v237
    v_accvgpr_read_b32 v234, a36
    v_mul_f32 v234, v234, v232
    v_accvgpr_write_b32 a36, v234
    v_accvgpr_read_b32 v235, a37
    v_mul_f32 v235, v235, v232
    v_accvgpr_write_b32 a37, v235
    v_accvgpr_read_b32 v236, a38
    v_mul_f32 v236, v236, v232
    v_accvgpr_write_b32 a38, v236
    v_accvgpr_read_b32 v237, a39
    v_mul_f32 v237, v237, v232
    v_accvgpr_write_b32 a39, v237
    v_accvgpr_read_b32 v234, a40
    v_mul_f32 v234, v234, v232
    v_accvgpr_write_b32 a40, v234
    v_accvgpr_read_b32 v235, a41
    v_mul_f32 v235, v235, v232
    v_accvgpr_write_b32 a41, v235
    v_accvgpr_read_b32 v236, a42
    v_mul_f32 v236, v236, v232
    v_accvgpr_write_b32 a42, v236
    v_accvgpr_read_b32 v237, a43
    v_mul_f32 v237, v237, v232
    v_accvgpr_write_b32 a43, v237
    v_accvgpr_read_b32 v234, a44
    v_mul_f32 v234, v234, v232
    v_accvgpr_write_b32 a44, v234
    v_accvgpr_read_b32 v235, a45
    v_mul_f32 v235, v235, v232
    v_accvgpr_write_b32 a45, v235
    v_accvgpr_read_b32 v236, a46
    v_mul_f32 v236, v236, v232
    v_accvgpr_write_b32 a46, v236
    v_accvgpr_read_b32 v237, a47
    v_mul_f32 v237, v237, v232
    v_accvgpr_write_b32 a47, v237
    v_accvgpr_read_b32 v234, a48
    v_mul_f32 v234, v234, v232
    v_accvgpr_write_b32 a48, v234
    v_accvgpr_read_b32 v235, a49
    v_mul_f32 v235, v235, v232
    v_accvgpr_write_b32 a49, v235
    v_accvgpr_read_b32 v236, a50
    v_mul_f32 v236, v236, v232
    v_accvgpr_write_b32 a50, v236
    v_accvgpr_read_b32 v237, a51
    v_mul_f32 v237, v237, v232
    v_accvgpr_write_b32 a51, v237
    v_accvgpr_read_b32 v234, a52
    v_mul_f32 v234, v234, v232
    v_accvgpr_write_b32 a52, v234
    v_accvgpr_read_b32 v235, a53
    v_mul_f32 v235, v235, v232
    v_accvgpr_write_b32 a53, v235
    v_accvgpr_read_b32 v236, a54
    v_mul_f32 v236, v236, v232
    v_accvgpr_write_b32 a54, v236
    v_accvgpr_read_b32 v237, a55
    v_mul_f32 v237, v237, v232
    v_accvgpr_write_b32 a55, v237
    v_accvgpr_read_b32 v234, a56
    v_mul_f32 v234, v234, v232
    v_accvgpr_write_b32 a56, v234
    v_accvgpr_read_b32 v235, a57
    v_mul_f32 v235, v235, v232
    v_accvgpr_write_b32 a57, v235
    v_accvgpr_read_b32 v236, a58
    v_mul_f32 v236, v236, v232
    v_accvgpr_write_b32 a58, v236
    v_accvgpr_read_b32 v237, a59
    v_mul_f32 v237, v237, v232
    v_accvgpr_write_b32 a59, v237
    v_accvgpr_read_b32 v234, a60
    v_mul_f32 v234, v234, v232
    v_accvgpr_write_b32 a60, v234
    v_accvgpr_read_b32 v235, a61
    v_mul_f32 v235, v235, v232
    v_accvgpr_write_b32 a61, v235
    v_accvgpr_read_b32 v236, a62
    v_mul_f32 v236, v236, v232
    v_accvgpr_write_b32 a62, v236
    v_accvgpr_read_b32 v237, a63
    v_mul_f32 v237, v237, v232
    v_accvgpr_write_b32 a63, v237
    v_exp_f32 v136, v32
    v_exp_f32 v137, v33
    v_exp_f32 v130, v34
    v_exp_f32 v131, v35
    v_cvt_pk_bf16_f32 v112, v136, v137
    v_exp_f32 v132, v36
    v_exp_f32 v133, v37
    v_cvt_pk_bf16_f32 v113, v130, v131
    v_add_f32 v136, v136, v130
    v_add_f32 v137, v137, v131
    v_exp_f32 v134, v38
    v_exp_f32 v135, v39
    v_cvt_pk_bf16_f32 v114, v132, v133
    v_add_f32 v136, v136, v132
    v_add_f32 v137, v137, v133
    v_exp_f32 v128, v40
    v_exp_f32 v129, v41
    v_cvt_pk_bf16_f32 v115, v134, v135
    v_add_f32 v136, v136, v134
    v_add_f32 v137, v137, v135
    v_exp_f32 v130, v42
    v_exp_f32 v131, v43
    v_cvt_pk_bf16_f32 v116, v128, v129
    v_add_f32 v136, v136, v128
    v_add_f32 v137, v137, v129
    v_exp_f32 v132, v44
    v_exp_f32 v133, v45
    v_cvt_pk_bf16_f32 v117, v130, v131
    v_add_f32 v136, v136, v130
    v_add_f32 v137, v137, v131
    v_exp_f32 v134, v46
    v_exp_f32 v135, v47
    v_cvt_pk_bf16_f32 v118, v132, v133
    v_add_f32 v136, v136, v132
    v_add_f32 v137, v137, v133
    v_cvt_pk_bf16_f32 v119, v134, v135
    v_add_f32 v136, v136, v134
    v_add_f32 v137, v137, v135
    v_add_f32 v224, v136, v137
    v_max3_f32 v230, v48, v49, v50
    v_max3_f32 v230, v230, v51, v52
    v_max3_f32 v230, v230, v53, v54
    v_max3_f32 v230, v230, v55, v56
    v_max3_f32 v230, v230, v57, v58
    v_max3_f32 v230, v230, v59, v60
    v_max3_f32 v230, v230, v61, v62
    v_max_f32 v230, v230, v63
    v_mov_b32 v231, v230
    s_nop 1
    v_permlane32_swap_b32 v230, v231
    s_nop 0
    v_max_f32 v230, v230, v231
    v_max_f32 v230, 0, v230
    v_sub_f32 v232, 0, v230
    v_exp_f32 v232, v232
    v_sub_f32 v229, v229, v230
    v_sub_f32 v80, v80, v230
    v_sub_f32 v16, v16, v230
    v_sub_f32 v48, v48, v230
    v_sub_f32 v81, v81, v230
    v_sub_f32 v17, v17, v230
    v_sub_f32 v49, v49, v230
    v_sub_f32 v82, v82, v230
    v_sub_f32 v18, v18, v230
    v_sub_f32 v50, v50, v230
    v_sub_f32 v83, v83, v230
    v_sub_f32 v19, v19, v230
    v_sub_f32 v51, v51, v230
    v_sub_f32 v84, v84, v230
    v_sub_f32 v20, v20, v230
    v_sub_f32 v52, v52, v230
    v_sub_f32 v85, v85, v230
    v_sub_f32 v21, v21, v230
    v_sub_f32 v53, v53, v230
    v_sub_f32 v86, v86, v230
    v_sub_f32 v22, v22, v230
    v_sub_f32 v54, v54, v230
    v_sub_f32 v87, v87, v230
    v_sub_f32 v23, v23, v230
    v_sub_f32 v55, v55, v230
    v_sub_f32 v88, v88, v230
    v_sub_f32 v24, v24, v230
    v_sub_f32 v56, v56, v230
    v_sub_f32 v89, v89, v230
    v_sub_f32 v25, v25, v230
    v_sub_f32 v57, v57, v230
    v_sub_f32 v90, v90, v230
    v_sub_f32 v26, v26, v230
    v_sub_f32 v58, v58, v230
    v_sub_f32 v91, v91, v230
    v_sub_f32 v27, v27, v230
    v_sub_f32 v59, v59, v230
    v_sub_f32 v92, v92, v230
    v_sub_f32 v28, v28, v230
    v_sub_f32 v60, v60, v230
    v_sub_f32 v93, v93, v230
    v_sub_f32 v29, v29, v230
    v_sub_f32 v61, v61, v230
    v_sub_f32 v94, v94, v230
    v_sub_f32 v30, v30, v230
    v_sub_f32 v62, v62, v230
    v_sub_f32 v95, v95, v230
    v_sub_f32 v31, v31, v230
    v_sub_f32 v63, v63, v230
    v_mul_f32 v227, v227, v232
    v_accvgpr_read_b32 v234, a64
    v_mul_f32 v234, v234, v232
    v_accvgpr_write_b32 a64, v234
    v_accvgpr_read_b32 v235, a65
    v_mul_f32 v235, v235, v232
    v_accvgpr_write_b32 a65, v235
    v_accvgpr_read_b32 v236, a66
    v_mul_f32 v236, v236, v232
    v_accvgpr_write_b32 a66, v236
    v_accvgpr_read_b32 v237, a67
    v_mul_f32 v237, v237, v232
    v_accvgpr_write_b32 a67, v237
    v_accvgpr_read_b32 v234, a68
    v_mul_f32 v234, v234, v232
    v_accvgpr_write_b32 a68, v234
    v_accvgpr_read_b32 v235, a69
    v_mul_f32 v235, v235, v232
    v_accvgpr_write_b32 a69, v235
    v_accvgpr_read_b32 v236, a70
    v_mul_f32 v236, v236, v232
    v_accvgpr_write_b32 a70, v236
    v_accvgpr_read_b32 v237, a71
    v_mul_f32 v237, v237, v232
    v_accvgpr_write_b32 a71, v237
    v_accvgpr_read_b32 v234, a72
    v_mul_f32 v234, v234, v232
    v_accvgpr_write_b32 a72, v234
    v_accvgpr_read_b32 v235, a73
    v_mul_f32 v235, v235, v232
    v_accvgpr_write_b32 a73, v235
    v_accvgpr_read_b32 v236, a74
    v_mul_f32 v236, v236, v232
    v_accvgpr_write_b32 a74, v236
    v_accvgpr_read_b32 v237, a75
    v_mul_f32 v237, v237, v232
    v_accvgpr_write_b32 a75, v237
    v_accvgpr_read_b32 v234, a76
    v_mul_f32 v234, v234, v232
    v_accvgpr_write_b32 a76, v234
    v_accvgpr_read_b32 v235, a77
    v_mul_f32 v235, v235, v232
    v_accvgpr_write_b32 a77, v235
    v_accvgpr_read_b32 v236, a78
    v_mul_f32 v236, v236, v232
    v_accvgpr_write_b32 a78, v236
    v_accvgpr_read_b32 v237, a79
    v_mul_f32 v237, v237, v232
    v_accvgpr_write_b32 a79, v237
    v_accvgpr_read_b32 v234, a80
    v_mul_f32 v234, v234, v232
    v_accvgpr_write_b32 a80, v234
    v_accvgpr_read_b32 v235, a81
    v_mul_f32 v235, v235, v232
    v_accvgpr_write_b32 a81, v235
    v_accvgpr_read_b32 v236, a82
    v_mul_f32 v236, v236, v232
    v_accvgpr_write_b32 a82, v236
    v_accvgpr_read_b32 v237, a83
    v_mul_f32 v237, v237, v232
    v_accvgpr_write_b32 a83, v237
    v_accvgpr_read_b32 v234, a84
    v_mul_f32 v234, v234, v232
    v_accvgpr_write_b32 a84, v234
    v_accvgpr_read_b32 v235, a85
    v_mul_f32 v235, v235, v232
    v_accvgpr_write_b32 a85, v235
    v_accvgpr_read_b32 v236, a86
    v_mul_f32 v236, v236, v232
    v_accvgpr_write_b32 a86, v236
    v_accvgpr_read_b32 v237, a87
    v_mul_f32 v237, v237, v232
    v_accvgpr_write_b32 a87, v237
    v_accvgpr_read_b32 v234, a88
    v_mul_f32 v234, v234, v232
    v_accvgpr_write_b32 a88, v234
    v_accvgpr_read_b32 v235, a89
    v_mul_f32 v235, v235, v232
    v_accvgpr_write_b32 a89, v235
    v_accvgpr_read_b32 v236, a90
    v_mul_f32 v236, v236, v232
    v_accvgpr_write_b32 a90, v236
    v_accvgpr_read_b32 v237, a91
    v_mul_f32 v237, v237, v232
    v_accvgpr_write_b32 a91, v237
    v_accvgpr_read_b32 v234, a92
    v_mul_f32 v234, v234, v232
    v_accvgpr_write_b32 a92, v234
    v_accvgpr_read_b32 v235, a93
    v_mul_f32 v235, v235, v232
    v_accvgpr_write_b32 a93, v235
    v_accvgpr_read_b32 v236, a94
    v_mul_f32 v236, v236, v232
    v_accvgpr_write_b32 a94, v236
    v_accvgpr_read_b32 v237, a95
    v_mul_f32 v237, v237, v232
    v_accvgpr_write_b32 a95, v237
    v_accvgpr_read_b32 v234, a96
    v_mul_f32 v234, v234, v232
    v_accvgpr_write_b32 a96, v234
    v_accvgpr_read_b32 v235, a97
    v_mul_f32 v235, v235, v232
    v_accvgpr_write_b32 a97, v235
    v_accvgpr_read_b32 v236, a98
    v_mul_f32 v236, v236, v232
    v_accvgpr_write_b32 a98, v236
    v_accvgpr_read_b32 v237, a99
    v_mul_f32 v237, v237, v232
    v_accvgpr_write_b32 a99, v237
    v_accvgpr_read_b32 v234, a100
    v_mul_f32 v234, v234, v232
    v_accvgpr_write_b32 a100, v234
    v_accvgpr_read_b32 v235, a101
    v_mul_f32 v235, v235, v232
    v_accvgpr_write_b32 a101, v235
    v_accvgpr_read_b32 v236, a102
    v_mul_f32 v236, v236, v232
    v_accvgpr_write_b32 a102, v236
    v_accvgpr_read_b32 v237, a103
    v_mul_f32 v237, v237, v232
    v_accvgpr_write_b32 a103, v237
    v_accvgpr_read_b32 v234, a104
    v_mul_f32 v234, v234, v232
    v_accvgpr_write_b32 a104, v234
    v_accvgpr_read_b32 v235, a105
    v_mul_f32 v235, v235, v232
    v_accvgpr_write_b32 a105, v235
    v_accvgpr_read_b32 v236, a106
    v_mul_f32 v236, v236, v232
    v_accvgpr_write_b32 a106, v236
    v_accvgpr_read_b32 v237, a107
    v_mul_f32 v237, v237, v232
    v_accvgpr_write_b32 a107, v237
    v_accvgpr_read_b32 v234, a108
    v_mul_f32 v234, v234, v232
    v_accvgpr_write_b32 a108, v234
    v_accvgpr_read_b32 v235, a109
    v_mul_f32 v235, v235, v232
    v_accvgpr_write_b32 a109, v235
    v_accvgpr_read_b32 v236, a110
    v_mul_f32 v236, v236, v232
    v_accvgpr_write_b32 a110, v236
    v_accvgpr_read_b32 v237, a111
    v_mul_f32 v237, v237, v232
    v_accvgpr_write_b32 a111, v237
    v_accvgpr_read_b32 v234, a112
    v_mul_f32 v234, v234, v232
    v_accvgpr_write_b32 a112, v234
    v_accvgpr_read_b32 v235, a113
    v_mul_f32 v235, v235, v232
    v_accvgpr_write_b32 a113, v235
    v_accvgpr_read_b32 v236, a114
    v_mul_f32 v236, v236, v232
    v_accvgpr_write_b32 a114, v236
    v_accvgpr_read_b32 v237, a115
    v_mul_f32 v237, v237, v232
    v_accvgpr_write_b32 a115, v237
    v_accvgpr_read_b32 v234, a116
    v_mul_f32 v234, v234, v232
    v_accvgpr_write_b32 a116, v234
    v_accvgpr_read_b32 v235, a117
    v_mul_f32 v235, v235, v232
    v_accvgpr_write_b32 a117, v235
    v_accvgpr_read_b32 v236, a118
    v_mul_f32 v236, v236, v232
    v_accvgpr_write_b32 a118, v236
    v_accvgpr_read_b32 v237, a119
    v_mul_f32 v237, v237, v232
    v_accvgpr_write_b32 a119, v237
    v_accvgpr_read_b32 v234, a120
    v_mul_f32 v234, v234, v232
    v_accvgpr_write_b32 a120, v234
    v_accvgpr_read_b32 v235, a121
    v_mul_f32 v235, v235, v232
    v_accvgpr_write_b32 a121, v235
    v_accvgpr_read_b32 v236, a122
    v_mul_f32 v236, v236, v232
    v_accvgpr_write_b32 a122, v236
    v_accvgpr_read_b32 v237, a123
    v_mul_f32 v237, v237, v232
    v_accvgpr_write_b32 a123, v237
    v_accvgpr_read_b32 v234, a124
    v_mul_f32 v234, v234, v232
    v_accvgpr_write_b32 a124, v234
    v_accvgpr_read_b32 v235, a125
    v_mul_f32 v235, v235, v232
    v_accvgpr_write_b32 a125, v235
    v_accvgpr_read_b32 v236, a126
    v_mul_f32 v236, v236, v232
    v_accvgpr_write_b32 a126, v236
    v_accvgpr_read_b32 v237, a127
    v_mul_f32 v237, v237, v232
    v_accvgpr_write_b32 a127, v237
    v_exp_f32 v138, v48
    v_exp_f32 v139, v49
    v_exp_f32 v130, v50
    v_exp_f32 v131, v51
    v_cvt_pk_bf16_f32 v120, v138, v139
    v_exp_f32 v132, v52
    v_exp_f32 v133, v53
    v_cvt_pk_bf16_f32 v121, v130, v131
    v_add_f32 v138, v138, v130
    v_add_f32 v139, v139, v131
    v_exp_f32 v134, v54
    v_exp_f32 v135, v55
    v_cvt_pk_bf16_f32 v122, v132, v133
    v_add_f32 v138, v138, v132
    v_add_f32 v139, v139, v133
    v_exp_f32 v128, v56
    v_exp_f32 v129, v57
    v_cvt_pk_bf16_f32 v123, v134, v135
    v_add_f32 v138, v138, v134
    v_add_f32 v139, v139, v135
    v_exp_f32 v130, v58
    v_exp_f32 v131, v59
    v_cvt_pk_bf16_f32 v124, v128, v129
    v_add_f32 v138, v138, v128
    v_add_f32 v139, v139, v129
    v_exp_f32 v132, v60
    v_exp_f32 v133, v61
    v_cvt_pk_bf16_f32 v125, v130, v131
    v_add_f32 v138, v138, v130
    v_add_f32 v139, v139, v131
    v_exp_f32 v134, v62
    v_exp_f32 v135, v63
    v_cvt_pk_bf16_f32 v126, v132, v133
    v_add_f32 v138, v138, v132
    v_add_f32 v139, v139, v133
    v_cvt_pk_bf16_f32 v127, v134, v135
    v_add_f32 v138, v138, v134
    v_add_f32 v139, v139, v135
    v_add_f32 v225, v138, v139
    s_nop 1
    s_branch kf_rr15
kf_fix17:
    s_cmp_eq_u32 s33, 0
    s_cselect_b32 s24, 0, 0x74000000
    s_cselect_b32 s36, 0, 0x1000
    s_mov_b32 s33, 1
    v_subrev_f32 v230, s24, v243
    v_add_f32 v231, 0, v230
    v_min_f32 v80, v229, v231
    v_add_f32 v232, 0xf1800000, v230
    v_min_f32 v81, v229, v232
    v_add_f32 v231, 0xf2000000, v230
    v_min_f32 v82, v229, v231
    v_add_f32 v232, 0xf2400000, v230
    v_min_f32 v83, v229, v232
    v_add_f32 v231, 0xf3000000, v230
    v_min_f32 v84, v229, v231
    v_add_f32 v232, 0xf3100000, v230
    v_min_f32 v85, v229, v232
    v_add_f32 v231, 0xf3200000, v230
    v_min_f32 v86, v229, v231
    v_add_f32 v232, 0xf3300000, v230
    v_min_f32 v87, v229, v232
    v_add_f32 v231, 0xf3800000, v230
    v_min_f32 v88, v229, v231
    v_add_f32 v232, 0xf3880000, v230
    v_min_f32 v89, v229, v232
    v_add_f32 v231, 0xf3900000, v230
    v_min_f32 v90, v229, v231
    v_add_f32 v232, 0xf3980000, v230
    v_min_f32 v91, v229, v232
    v_add_f32 v231, 0xf3c00000, v230
    v_min_f32 v92, v229, v231
    v_add_f32 v232, 0xf3c80000, v230
    v_min_f32 v93, v229, v232
    v_add_f32 v231, 0xf3d00000, v230
    v_min_f32 v94, v229, v231
    v_add_f32 v232, 0xf3d80000, v230
    v_min_f32 v95, v229, v232
    s_nop 1
    s_branch kf_fixr18
kf_rare20:
    s_nop 15
    v_max3_f32 v230, v16, v17, v18
    v_max3_f32 v230, v230, v19, v20
    v_max3_f32 v230, v230, v21, v22
    v_max3_f32 v230, v230, v23, v24
    v_max3_f32 v230, v230, v25, v26
    v_max3_f32 v230, v230, v27, v28
    v_max3_f32 v230, v230, v29, v30
    v_max_f32 v230, v230, v31
    v_mov_b32 v231, v230
    s_nop 1
    v_permlane32_swap_b32 v230, v231
    s_nop 0
    v_max_f32 v230, v230, v231
    v_max_f32 v230, 0, v230
    v_sub_f32 v232, 0, v230
    v_exp_f32 v232, v232
    v_sub_f32 v229, v229, v230
    v_sub_f32 v80, v80, v230
    v_sub_f32 v48, v48, v230
    v_sub_f32 v16, v16, v230
    v_sub_f32 v81, v81, v230
    v_sub_f32 v49, v49, v230
    v_sub_f32 v17, v17, v230
    v_sub_f32 v82, v82, v230
    v_sub_f32 v50, v50, v230
    v_sub_f32 v18, v18, v230
    v_sub_f32 v83, v83, v230
    v_sub_f32 v51, v51, v230
    v_sub_f32 v19, v19, v230
    v_sub_f32 v84, v84, v230
    v_sub_f32 v52, v52, v230
    v_sub_f32 v20, v20, v230
    v_sub_f32 v85, v85, v230
    v_sub_f32 v53, v53, v230
    v_sub_f32 v21, v21, v230
    v_sub_f32 v86, v86, v230
    v_sub_f32 v54, v54, v230
    v_sub_f32 v22, v22, v230
    v_sub_f32 v87, v87, v230
    v_sub_f32 v55, v55, v230
    v_sub_f32 v23, v23, v230
    v_sub_f32 v88, v88, v230
    v_sub_f32 v56, v56, v230
    v_sub_f32 v24, v24, v230
    v_sub_f32 v89, v89, v230
    v_sub_f32 v57, v57, v230
    v_sub_f32 v25, v25, v230
    v_sub_f32 v90, v90, v230
    v_sub_f32 v58, v58, v230
    v_sub_f32 v26, v26, v230
    v_sub_f32 v91, v91, v230
    v_sub_f32 v59, v59, v230
    v_sub_f32 v27, v27, v230
    v_sub_f32 v92, v92, v230
    v_sub_f32 v60, v60, v230
    v_sub_f32 v28, v28, v230
    v_sub_f32 v93, v93, v230
    v_sub_f32 v61, v61, v230
    v_sub_f32 v29, v29, v230
    v_sub_f32 v94, v94, v230
    v_sub_f32 v62, v62, v230
    v_sub_f32 v30, v30, v230
    v_sub_f32 v95, v95, v230
    v_sub_f32 v63, v63, v230
    v_sub_f32 v31, v31, v230
    v_mul_f32 v227, v227, v232
    v_accvgpr_read_b32 v234, a64
    v_mul_f32 v234, v234, v232
    v_accvgpr_write_b32 a64, v234
    v_accvgpr_read_b32 v235, a65
    v_mul_f32 v235, v235, v232
    v_accvgpr_write_b32 a65, v235
    v_accvgpr_read_b32 v236, a66
    v_mul_f32 v236, v236, v232
    v_accvgpr_write_b32 a66, v236
    v_accvgpr_read_b32 v237, a67
    v_mul_f32 v237, v237, v232
    v_accvgpr_write_b32 a67, v237
    v_accvgpr_read_b32 v234, a68
    v_mul_f32 v234, v234, v232
    v_accvgpr_write_b32 a68, v234
    v_accvgpr_read_b32 v235, a69
    v_mul_f32 v235, v235, v232
    v_accvgpr_write_b32 a69, v235
    v_accvgpr_read_b32 v236, a70
    v_mul_f32 v236, v236, v232
    v_accvgpr_write_b32 a70, v236
    v_accvgpr_read_b32 v237, a71
    v_mul_f32 v237, v237, v232
    v_accvgpr_write_b32 a71, v237
    v_accvgpr_read_b32 v234, a72
    v_mul_f32 v234, v234, v232
    v_accvgpr_write_b32 a72, v234
    v_accvgpr_read_b32 v235, a73
    v_mul_f32 v235, v235, v232
    v_accvgpr_write_b32 a73, v235
    v_accvgpr_read_b32 v236, a74
    v_mul_f32 v236, v236, v232
    v_accvgpr_write_b32 a74, v236
    v_accvgpr_read_b32 v237, a75
    v_mul_f32 v237, v237, v232
    v_accvgpr_write_b32 a75, v237
    v_accvgpr_read_b32 v234, a76
    v_mul_f32 v234, v234, v232
    v_accvgpr_write_b32 a76, v234
    v_accvgpr_read_b32 v235, a77
    v_mul_f32 v235, v235, v232
    v_accvgpr_write_b32 a77, v235
    v_accvgpr_read_b32 v236, a78
    v_mul_f32 v236, v236, v232
    v_accvgpr_write_b32 a78, v236
    v_accvgpr_read_b32 v237, a79
    v_mul_f32 v237, v237, v232
    v_accvgpr_write_b32 a79, v237
    v_accvgpr_read_b32 v234, a80
    v_mul_f32 v234, v234, v232
    v_accvgpr_write_b32 a80, v234
    v_accvgpr_read_b32 v235, a81
    v_mul_f32 v235, v235, v232
    v_accvgpr_write_b32 a81, v235
    v_accvgpr_read_b32 v236, a82
    v_mul_f32 v236, v236, v232
    v_accvgpr_write_b32 a82, v236
    v_accvgpr_read_b32 v237, a83
    v_mul_f32 v237, v237, v232
    v_accvgpr_write_b32 a83, v237
    v_accvgpr_read_b32 v234, a84
    v_mul_f32 v234, v234, v232
    v_accvgpr_write_b32 a84, v234
    v_accvgpr_read_b32 v235, a85
    v_mul_f32 v235, v235, v232
    v_accvgpr_write_b32 a85, v235
    v_accvgpr_read_b32 v236, a86
    v_mul_f32 v236, v236, v232
    v_accvgpr_write_b32 a86, v236
    v_accvgpr_read_b32 v237, a87
    v_mul_f32 v237, v237, v232
    v_accvgpr_write_b32 a87, v237
    v_accvgpr_read_b32 v234, a88
    v_mul_f32 v234, v234, v232
    v_accvgpr_write_b32 a88, v234
    v_accvgpr_read_b32 v235, a89
    v_mul_f32 v235, v235, v232
    v_accvgpr_write_b32 a89, v235
    v_accvgpr_read_b32 v236, a90
    v_mul_f32 v236, v236, v232
    v_accvgpr_write_b32 a90, v236
    v_accvgpr_read_b32 v237, a91
    v_mul_f32 v237, v237, v232
    v_accvgpr_write_b32 a91, v237
    v_accvgpr_read_b32 v234, a92
    v_mul_f32 v234, v234, v232
    v_accvgpr_write_b32 a92, v234
    v_accvgpr_read_b32 v235, a93
    v_mul_f32 v235, v235, v232
    v_accvgpr_write_b32 a93, v235
    v_accvgpr_read_b32 v236, a94
    v_mul_f32 v236, v236, v232
    v_accvgpr_write_b32 a94, v236
    v_accvgpr_read_b32 v237, a95
    v_mul_f32 v237, v237, v232
    v_accvgpr_write_b32 a95, v237
    v_accvgpr_read_b32 v234, a96
    v_mul_f32 v234, v234, v232
    v_accvgpr_write_b32 a96, v234
    v_accvgpr_read_b32 v235, a97
    v_mul_f32 v235, v235, v232
    v_accvgpr_write_b32 a97, v235
    v_accvgpr_read_b32 v236, a98
    v_mul_f32 v236, v236, v232
    v_accvgpr_write_b32 a98, v236
    v_accvgpr_read_b32 v237, a99
    v_mul_f32 v237, v237, v232
    v_accvgpr_write_b32 a99, v237
    v_accvgpr_read_b32 v234, a100
    v_mul_f32 v234, v234, v232
    v_accvgpr_write_b32 a100, v234
    v_accvgpr_read_b32 v235, a101
    v_mul_f32 v235, v235, v232
    v_accvgpr_write_b32 a101, v235
    v_accvgpr_read_b32 v236, a102
    v_mul_f32 v236, v236, v232
    v_accvgpr_write_b32 a102, v236
    v_accvgpr_read_b32 v237, a103
    v_mul_f32 v237, v237, v232
    v_accvgpr_write_b32 a103, v237
    v_accvgpr_read_b32 v234, a104
    v_mul_f32 v234, v234, v232
    v_accvgpr_write_b32 a104, v234
    v_accvgpr_read_b32 v235, a105
    v_mul_f32 v235, v235, v232
    v_accvgpr_write_b32 a105, v235
    v_accvgpr_read_b32 v236, a106
    v_mul_f32 v236, v236, v232
    v_accvgpr_write_b32 a106, v236
    v_accvgpr_read_b32 v237, a107
    v_mul_f32 v237, v237, v232
    v_accvgpr_write_b32 a107, v237
    v_accvgpr_read_b32 v234, a108
    v_mul_f32 v234, v234, v232
    v_accvgpr_write_b32 a108, v234
    v_accvgpr_read_b32 v235, a109
    v_mul_f32 v235, v235, v232
    v_accvgpr_write_b32 a109, v235
    v_accvgpr_read_b32 v236, a110
    v_mul_f32 v236, v236, v232
    v_accvgpr_write_b32 a110, v236
    v_accvgpr_read_b32 v237, a111
    v_mul_f32 v237, v237, v232
    v_accvgpr_write_b32 a111, v237
    v_accvgpr_read_b32 v234, a112
    v_mul_f32 v234, v234, v232
    v_accvgpr_write_b32 a112, v234
    v_accvgpr_read_b32 v235, a113
    v_mul_f32 v235, v235, v232
    v_accvgpr_write_b32 a113, v235
    v_accvgpr_read_b32 v236, a114
    v_mul_f32 v236, v236, v232
    v_accvgpr_write_b32 a114, v236
    v_accvgpr_read_b32 v237, a115
    v_mul_f32 v237, v237, v232
    v_accvgpr_write_b32 a115, v237
    v_accvgpr_read_b32 v234, a116
    v_mul_f32 v234, v234, v232
    v_accvgpr_write_b32 a116, v234
    v_accvgpr_read_b32 v235, a117
    v_mul_f32 v235, v235, v232
    v_accvgpr_write_b32 a117, v235
    v_accvgpr_read_b32 v236, a118
    v_mul_f32 v236, v236, v232
    v_accvgpr_write_b32 a118, v236
    v_accvgpr_read_b32 v237, a119
    v_mul_f32 v237, v237, v232
    v_accvgpr_write_b32 a119, v237
    v_accvgpr_read_b32 v234, a120
    v_mul_f32 v234, v234, v232
    v_accvgpr_write_b32 a120, v234
    v_accvgpr_read_b32 v235, a121
    v_mul_f32 v235, v235, v232
    v_accvgpr_write_b32 a121, v235
    v_accvgpr_read_b32 v236, a122
    v_mul_f32 v236, v236, v232
    v_accvgpr_write_b32 a122, v236
    v_accvgpr_read_b32 v237, a123
    v_mul_f32 v237, v237, v232
    v_accvgpr_write_b32 a123, v237
    v_accvgpr_read_b32 v234, a124
    v_mul_f32 v234, v234, v232
    v_accvgpr_write_b32 a124, v234
    v_accvgpr_read_b32 v235, a125
    v_mul_f32 v235, v235, v232
    v_accvgpr_write_b32 a125, v235
    v_accvgpr_read_b32 v236, a126
    v_mul_f32 v236, v236, v232
    v_accvgpr_write_b32 a126, v236
    v_accvgpr_read_b32 v237, a127
    v_mul_f32 v237, v237, v232
    v_accvgpr_write_b32 a127, v237
    v_exp_f32 v138, v16
    v_exp_f32 v139, v17
    v_exp_f32 v130, v18
    v_exp_f32 v131, v19
    v_cvt_pk_bf16_f32 v104, v138, v139
    v_exp_f32 v132, v20
    v_exp_f32 v133, v21
    v_cvt_pk_bf16_f32 v105, v130, v131
    v_add_f32 v138, v138, v130
    v_add_f32 v139, v139, v131
    v_exp_f32 v134, v22
    v_exp_f32 v135, v23
    v_cvt_pk_bf16_f32 v106, v132, v133
    v_add_f32 v138, v138, v132
    v_add_f32 v139, v139, v133
    v_exp_f32 v128, v24
    v_exp_f32 v129, v25
    v_cvt_pk_bf16_f32 v107, v134, v135
    v_add_f32 v138, v138, v134
    v_add_f32 v139, v139, v135
    v_exp_f32 v130, v26
    v_exp_f32 v131, v27
    v_cvt_pk_bf16_f32 v108, v128, v129
    v_add_f32 v138, v138, v128
    v_add_f32 v139, v139, v129
    v_exp_f32 v132, v28
    v_exp_f32 v133, v29
    v_cvt_pk_bf16_f32 v109, v130, v131
    v_add_f32 v138, v138, v130
    v_add_f32 v139, v139, v131
    v_exp_f32 v134, v30
    v_exp_f32 v135, v31
    v_cvt_pk_bf16_f32 v110, v132, v133
    v_add_f32 v138, v138, v132
    v_add_f32 v139, v139, v133
    v_cvt_pk_bf16_f32 v111, v134, v135
    v_add_f32 v138, v138, v134
    v_add_f32 v139, v139, v135
    v_add_f32 v225, v138, v139
    s_nop 1
    s_branch kf_rr19
kf_fix21:
    s_cmp_eq_u32 s33, 0
    s_cselect_b32 s24, 0, 0x74000000
    s_cselect_b32 s36, 0, 0x1000
    s_mov_b32 s33, 1
    v_subrev_f32 v230, s24, v243
    v_add_f32 v231, 0, v230
    v_min_f32 v80, v229, v231
    v_add_f32 v232, 0xf1800000, v230
    v_min_f32 v81, v229, v232
    v_add_f32 v231, 0xf2000000, v230
    v_min_f32 v82, v229, v231
    v_add_f32 v232, 0xf2400000, v230
    v_min_f32 v83, v229, v232
    v_add_f32 v231, 0xf3000000, v230
    v_min_f32 v84, v229, v231
    v_add_f32 v232, 0xf3100000, v230
    v_min_f32 v85, v229, v232
    v_add_f32 v231, 0xf3200000, v230
    v_min_f32 v86, v229, v231
    v_add_f32 v232, 0xf3300000, v230
    v_min_f32 v87, v229, v232
    v_add_f32 v231, 0xf3800000, v230
    v_min_f32 v88, v229, v231
    v_add_f32 v232, 0xf3880000, v230
    v_min_f32 v89, v229, v232
    v_add_f32 v231, 0xf3900000, v230
    v_min_f32 v90, v229, v231
    v_add_f32 v232, 0xf3980000, v230
    v_min_f32 v91, v229, v232
    v_add_f32 v231, 0xf3c00000, v230
    v_min_f32 v92, v229, v231
    v_add_f32 v232, 0xf3c80000, v230
    v_min_f32 v93, v229, v232
    v_add_f32 v231, 0xf3d00000, v230
    v_min_f32 v94, v229, v231
    v_add_f32 v232, 0xf3d80000, v230
    v_min_f32 v95, v229, v232
    s_nop 1
    s_branch kf_fixr22
kf_rare24:
    s_nop 15
    v_max3_f32 v230, v48, v49, v50
    v_max3_f32 v230, v230, v51, v52
    v_max3_f32 v230, v230, v53, v54
    v_max3_f32 v230, v230, v55, v56
    v_max3_f32 v230, v230, v57, v58
    v_max3_f32 v230, v230, v59, v60
    v_max3_f32 v230, v230, v61, v62
    v_max_f32 v230, v230, v63
    v_mov_b32 v231, v230
    s_nop 1
    v_permlane32_swap_b32 v230, v231
    s_nop 0
    v_max_f32 v230, v230, v231
    v_max_f32 v230, 0, v230
    v_sub_f32 v232, 0, v230
    v_exp_f32 v232, v232
    v_sub_f32 v229, v229, v230
    v_sub_f32 v80, v80, v230
    v_sub_f32 v16, v16, v230
    v_sub_f32 v48, v48, v230
    v_sub_f32 v81, v81, v230
    v_sub_f32 v17, v17, v230
    v_sub_f32 v49, v49, v230
    v_sub_f32 v82, v82, v230
    v_sub_f32 v18, v18, v230
    v_sub_f32 v50, v50, v230
    v_sub_f32 v83, v83, v230
    v_sub_f32 v19, v19, v230
    v_sub_f32 v51, v51, v230
    v_sub_f32 v84, v84, v230
    v_sub_f32 v20, v20, v230
    v_sub_f32 v52, v52, v230
    v_sub_f32 v85, v85, v230
    v_sub_f32 v21, v21, v230
    v_sub_f32 v53, v53, v230
    v_sub_f32 v86, v86, v230
    v_sub_f32 v22, v22, v230
    v_sub_f32 v54, v54, v230
    v_sub_f32 v87, v87, v230
    v_sub_f32 v23, v23, v230
    v_sub_f32 v55, v55, v230
    v_sub_f32 v88, v88, v230
    v_sub_f32 v24, v24, v230
    v_sub_f32 v56, v56, v230
    v_sub_f32 v89, v89, v230
    v_sub_f32 v25, v25, v230
    v_sub_f32 v57, v57, v230
    v_sub_f32 v90, v90, v230
    v_sub_f32 v26, v26, v230
    v_sub_f32 v58, v58, v230
    v_sub_f32 v91, v91, v230
    v_sub_f32 v27, v27, v230
    v_sub_f32 v59, v59, v230
    v_sub_f32 v92, v92, v230
    v_sub_f32 v28, v28, v230
    v_sub_f32 v60, v60, v230
    v_sub_f32 v93, v93, v230
    v_sub_f32 v29, v29, v230
    v_sub_f32 v61, v61, v230
    v_sub_f32 v94, v94, v230
    v_sub_f32 v30, v30, v230
    v_sub_f32 v62, v62, v230
    v_sub_f32 v95, v95, v230
    v_sub_f32 v31, v31, v230
    v_sub_f32 v63, v63, v230
    v_mul_f32 v227, v227, v232
    v_accvgpr_read_b32 v234, a64
    v_mul_f32 v234, v234, v232
    v_accvgpr_write_b32 a64, v234
    v_accvgpr_read_b32 v235, a65
    v_mul_f32 v235, v235, v232
    v_accvgpr_write_b32 a65, v235
    v_accvgpr_read_b32 v236, a66
    v_mul_f32 v236, v236, v232
    v_accvgpr_write_b32 a66, v236
    v_accvgpr_read_b32 v237, a67
    v_mul_f32 v237, v237, v232
    v_accvgpr_write_b32 a67, v237
    v_accvgpr_read_b32 v234, a68
    v_mul_f32 v234, v234, v232
    v_accvgpr_write_b32 a68, v234
    v_accvgpr_read_b32 v235, a69
    v_mul_f32 v235, v235, v232
    v_accvgpr_write_b32 a69, v235
    v_accvgpr_read_b32 v236, a70
    v_mul_f32 v236, v236, v232
    v_accvgpr_write_b32 a70, v236
    v_accvgpr_read_b32 v237, a71
    v_mul_f32 v237, v237, v232
    v_accvgpr_write_b32 a71, v237
    v_accvgpr_read_b32 v234, a72
    v_mul_f32 v234, v234, v232
    v_accvgpr_write_b32 a72, v234
    v_accvgpr_read_b32 v235, a73
    v_mul_f32 v235, v235, v232
    v_accvgpr_write_b32 a73, v235
    v_accvgpr_read_b32 v236, a74
    v_mul_f32 v236, v236, v232
    v_accvgpr_write_b32 a74, v236
    v_accvgpr_read_b32 v237, a75
    v_mul_f32 v237, v237, v232
    v_accvgpr_write_b32 a75, v237
    v_accvgpr_read_b32 v234, a76
    v_mul_f32 v234, v234, v232
    v_accvgpr_write_b32 a76, v234
    v_accvgpr_read_b32 v235, a77
    v_mul_f32 v235, v235, v232
    v_accvgpr_write_b32 a77, v235
    v_accvgpr_read_b32 v236, a78
    v_mul_f32 v236, v236, v232
    v_accvgpr_write_b32 a78, v236
    v_accvgpr_read_b32 v237, a79
    v_mul_f32 v237, v237, v232
    v_accvgpr_write_b32 a79, v237
    v_accvgpr_read_b32 v234, a80
    v_mul_f32 v234, v234, v232
    v_accvgpr_write_b32 a80, v234
    v_accvgpr_read_b32 v235, a81
    v_mul_f32 v235, v235, v232
    v_accvgpr_write_b32 a81, v235
    v_accvgpr_read_b32 v236, a82
    v_mul_f32 v236, v236, v232
    v_accvgpr_write_b32 a82, v236
    v_accvgpr_read_b32 v237, a83
    v_mul_f32 v237, v237, v232
    v_accvgpr_write_b32 a83, v237
    v_accvgpr_read_b32 v234, a84
    v_mul_f32 v234, v234, v232
    v_accvgpr_write_b32 a84, v234
    v_accvgpr_read_b32 v235, a85
    v_mul_f32 v235, v235, v232
    v_accvgpr_write_b32 a85, v235
    v_accvgpr_read_b32 v236, a86
    v_mul_f32 v236, v236, v232
    v_accvgpr_write_b32 a86, v236
    v_accvgpr_read_b32 v237, a87
    v_mul_f32 v237, v237, v232
    v_accvgpr_write_b32 a87, v237
    v_accvgpr_read_b32 v234, a88
    v_mul_f32 v234, v234, v232
    v_accvgpr_write_b32 a88, v234
    v_accvgpr_read_b32 v235, a89
    v_mul_f32 v235, v235, v232
    v_accvgpr_write_b32 a89, v235
    v_accvgpr_read_b32 v236, a90
    v_mul_f32 v236, v236, v232
    v_accvgpr_write_b32 a90, v236
    v_accvgpr_read_b32 v237, a91
    v_mul_f32 v237, v237, v232
    v_accvgpr_write_b32 a91, v237
    v_accvgpr_read_b32 v234, a92
    v_mul_f32 v234, v234, v232
    v_accvgpr_write_b32 a92, v234
    v_accvgpr_read_b32 v235, a93
    v_mul_f32 v235, v235, v232
    v_accvgpr_write_b32 a93, v235
    v_accvgpr_read_b32 v236, a94
    v_mul_f32 v236, v236, v232
    v_accvgpr_write_b32 a94, v236
    v_accvgpr_read_b32 v237, a95
    v_mul_f32 v237, v237, v232
    v_accvgpr_write_b32 a95, v237
    v_accvgpr_read_b32 v234, a96
    v_mul_f32 v234, v234, v232
    v_accvgpr_write_b32 a96, v234
    v_accvgpr_read_b32 v235, a97
    v_mul_f32 v235, v235, v232
    v_accvgpr_write_b32 a97, v235
    v_accvgpr_read_b32 v236, a98
    v_mul_f32 v236, v236, v232
    v_accvgpr_write_b32 a98, v236
    v_accvgpr_read_b32 v237, a99
    v_mul_f32 v237, v237, v232
    v_accvgpr_write_b32 a99, v237
    v_accvgpr_read_b32 v234, a100
    v_mul_f32 v234, v234, v232
    v_accvgpr_write_b32 a100, v234
    v_accvgpr_read_b32 v235, a101
    v_mul_f32 v235, v235, v232
    v_accvgpr_write_b32 a101, v235
    v_accvgpr_read_b32 v236, a102
    v_mul_f32 v236, v236, v232
    v_accvgpr_write_b32 a102, v236
    v_accvgpr_read_b32 v237, a103
    v_mul_f32 v237, v237, v232
    v_accvgpr_write_b32 a103, v237
    v_accvgpr_read_b32 v234, a104
    v_mul_f32 v234, v234, v232
    v_accvgpr_write_b32 a104, v234
    v_accvgpr_read_b32 v235, a105
    v_mul_f32 v235, v235, v232
    v_accvgpr_write_b32 a105, v235
    v_accvgpr_read_b32 v236, a106
    v_mul_f32 v236, v236, v232
    v_accvgpr_write_b32 a106, v236
    v_accvgpr_read_b32 v237, a107
    v_mul_f32 v237, v237, v232
    v_accvgpr_write_b32 a107, v237
    v_accvgpr_read_b32 v234, a108
    v_mul_f32 v234, v234, v232
    v_accvgpr_write_b32 a108, v234
    v_accvgpr_read_b32 v235, a109
    v_mul_f32 v235, v235, v232
    v_accvgpr_write_b32 a109, v235
    v_accvgpr_read_b32 v236, a110
    v_mul_f32 v236, v236, v232
    v_accvgpr_write_b32 a110, v236
    v_accvgpr_read_b32 v237, a111
    v_mul_f32 v237, v237, v232
    v_accvgpr_write_b32 a111, v237
    v_accvgpr_read_b32 v234, a112
    v_mul_f32 v234, v234, v232
    v_accvgpr_write_b32 a112, v234
    v_accvgpr_read_b32 v235, a113
    v_mul_f32 v235, v235, v232
    v_accvgpr_write_b32 a113, v235
    v_accvgpr_read_b32 v236, a114
    v_mul_f32 v236, v236, v232
    v_accvgpr_write_b32 a114, v236
    v_accvgpr_read_b32 v237, a115
    v_mul_f32 v237, v237, v232
    v_accvgpr_write_b32 a115, v237
    v_accvgpr_read_b32 v234, a116
    v_mul_f32 v234, v234, v232
    v_accvgpr_write_b32 a116, v234
    v_accvgpr_read_b32 v235, a117
    v_mul_f32 v235, v235, v232
    v_accvgpr_write_b32 a117, v235
    v_accvgpr_read_b32 v236, a118
    v_mul_f32 v236, v236, v232
    v_accvgpr_write_b32 a118, v236
    v_accvgpr_read_b32 v237, a119
    v_mul_f32 v237, v237, v232
    v_accvgpr_write_b32 a119, v237
    v_accvgpr_read_b32 v234, a120
    v_mul_f32 v234, v234, v232
    v_accvgpr_write_b32 a120, v234
    v_accvgpr_read_b32 v235, a121
    v_mul_f32 v235, v235, v232
    v_accvgpr_write_b32 a121, v235
    v_accvgpr_read_b32 v236, a122
    v_mul_f32 v236, v236, v232
    v_accvgpr_write_b32 a122, v236
    v_accvgpr_read_b32 v237, a123
    v_mul_f32 v237, v237, v232
    v_accvgpr_write_b32 a123, v237
    v_accvgpr_read_b32 v234, a124
    v_mul_f32 v234, v234, v232
    v_accvgpr_write_b32 a124, v234
    v_accvgpr_read_b32 v235, a125
    v_mul_f32 v235, v235, v232
    v_accvgpr_write_b32 a125, v235
    v_accvgpr_read_b32 v236, a126
    v_mul_f32 v236, v236, v232
    v_accvgpr_write_b32 a126, v236
    v_accvgpr_read_b32 v237, a127
    v_mul_f32 v237, v237, v232
    v_accvgpr_write_b32 a127, v237
    v_exp_f32 v138, v48
    v_exp_f32 v139, v49
    v_exp_f32 v130, v50
    v_exp_f32 v131, v51
    v_cvt_pk_bf16_f32 v120, v138, v139
    v_exp_f32 v132, v52
    v_exp_f32 v133, v53
    v_cvt_pk_bf16_f32 v121, v130, v131
    v_add_f32 v138, v138, v130
    v_add_f32 v139, v139, v131
    v_exp_f32 v134, v54
    v_exp_f32 v135, v55
    v_cvt_pk_bf16_f32 v122, v132, v133
    v_add_f32 v138, v138, v132
    v_add_f32 v139, v139, v133
    v_exp_f32 v128, v56
    v_exp_f32 v129, v57
    v_cvt_pk_bf16_f32 v123, v134, v135
    v_add_f32 v138, v138, v134
    v_add_f32 v139, v139, v135
    v_exp_f32 v130, v58
    v_exp_f32 v131, v59
    v_cvt_pk_bf16_f32 v124, v128, v129
    v_add_f32 v138, v138, v128
    v_add_f32 v139, v139, v129
    v_exp_f32 v132, v60
    v_exp_f32 v133, v61
    v_cvt_pk_bf16_f32 v125, v130, v131
    v_add_f32 v138, v138, v130
    v_add_f32 v139, v139, v131
    v_exp_f32 v134, v62
    v_exp_f32 v135, v63
    v_cvt_pk_bf16_f32 v126, v132, v133
    v_add_f32 v138, v138, v132
    v_add_f32 v139, v139, v133
    v_cvt_pk_bf16_f32 v127, v134, v135
    v_add_f32 v138, v138, v134
    v_add_f32 v139, v139, v135
    v_add_f32 v225, v138, v139
    s_nop 1
    s_branch kf_rr23
kf_fix25:
    s_cmp_eq_u32 s33, 0
    s_cselect_b32 s24, 0, 0x74000000
    s_cselect_b32 s36, 0, 0x1000
    s_mov_b32 s33, 1
    v_subrev_f32 v230, s24, v243
    v_add_f32 v231, 0, v230
    v_min_f32 v80, v229, v231
    v_add_f32 v232, 0xf1800000, v230
    v_min_f32 v81, v229, v232
    v_add_f32 v231, 0xf2000000, v230
    v_min_f32 v82, v229, v231
    v_add_f32 v232, 0xf2400000, v230
    v_min_f32 v83, v229, v232
    v_add_f32 v231, 0xf3000000, v230
    v_min_f32 v84, v229, v231
    v_add_f32 v232, 0xf3100000, v230
    v_min_f32 v85, v229, v232
    v_add_f32 v231, 0xf3200000, v230
    v_min_f32 v86, v229, v231
    v_add_f32 v232, 0xf3300000, v230
    v_min_f32 v87, v229, v232
    v_add_f32 v231, 0xf3800000, v230
    v_min_f32 v88, v229, v231
    v_add_f32 v232, 0xf3880000, v230
    v_min_f32 v89, v229, v232
    v_add_f32 v231, 0xf3900000, v230
    v_min_f32 v90, v229, v231
    v_add_f32 v232, 0xf3980000, v230
    v_min_f32 v91, v229, v232
    v_add_f32 v231, 0xf3c00000, v230
    v_min_f32 v92, v229, v231
    v_add_f32 v232, 0xf3c80000, v230
    v_min_f32 v93, v229, v232
    v_add_f32 v231, 0xf3d00000, v230
    v_min_f32 v94, v229, v231
    v_add_f32 v232, 0xf3d80000, v230
    v_min_f32 v95, v229, v232
    s_nop 1
    s_branch kf_fixr26
kf_rare28:
    s_nop 15
    v_max3_f32 v230, v16, v17, v18
    v_max3_f32 v230, v230, v19, v20
    v_max3_f32 v230, v230, v21, v22
    v_max3_f32 v230, v230, v23, v24
    v_max3_f32 v230, v230, v25, v26
    v_max3_f32 v230, v230, v27, v28
    v_max3_f32 v230, v230, v29, v30
    v_max_f32 v230, v230, v31
    v_mov_b32 v231, v230
    s_nop 1
    v_permlane32_swap_b32 v230, v231
    s_nop 0
    v_max_f32 v230, v230, v231
    v_max_f32 v230, 0, v230
    v_sub_f32 v232, 0, v230
    v_exp_f32 v232, v232
    v_sub_f32 v229, v229, v230
    v_sub_f32 v80, v80, v230
    v_sub_f32 v48, v48, v230
    v_sub_f32 v16, v16, v230
    v_sub_f32 v81, v81, v230
    v_sub_f32 v49, v49, v230
    v_sub_f32 v17, v17, v230
    v_sub_f32 v82, v82, v230
    v_sub_f32 v50, v50, v230
    v_sub_f32 v18, v18, v230
    v_sub_f32 v83, v83, v230
    v_sub_f32 v51, v51, v230
    v_sub_f32 v19, v19, v230
    v_sub_f32 v84, v84, v230
    v_sub_f32 v52, v52, v230
    v_sub_f32 v20, v20, v230
    v_sub_f32 v85, v85, v230
    v_sub_f32 v53, v53, v230
    v_sub_f32 v21, v21, v230
    v_sub_f32 v86, v86, v230
    v_sub_f32 v54, v54, v230
    v_sub_f32 v22, v22, v230
    v_sub_f32 v87, v87, v230
    v_sub_f32 v55, v55, v230
    v_sub_f32 v23, v23, v230
    v_sub_f32 v88, v88, v230
    v_sub_f32 v56, v56, v230
    v_sub_f32 v24, v24, v230
    v_sub_f32 v89, v89, v230
    v_sub_f32 v57, v57, v230
    v_sub_f32 v25, v25, v230
    v_sub_f32 v90, v90, v230
    v_sub_f32 v58, v58, v230
    v_sub_f32 v26, v26, v230
    v_sub_f32 v91, v91, v230
    v_sub_f32 v59, v59, v230
    v_sub_f32 v27, v27, v230
    v_sub_f32 v92, v92, v230
    v_sub_f32 v60, v60, v230
    v_sub_f32 v28, v28, v230
    v_sub_f32 v93, v93, v230
    v_sub_f32 v61, v61, v230
    v_sub_f32 v29, v29, v230
    v_sub_f32 v94, v94, v230
    v_sub_f32 v62, v62, v230
    v_sub_f32 v30, v30, v230
    v_sub_f32 v95, v95, v230
    v_sub_f32 v63, v63, v230
    v_sub_f32 v31, v31, v230
    v_mul_f32 v227, v227, v232
    v_accvgpr_read_b32 v234, a64
    v_mul_f32 v234, v234, v232
    v_accvgpr_write_b32 a64, v234
    v_accvgpr_read_b32 v235, a65
    v_mul_f32 v235, v235, v232
    v_accvgpr_write_b32 a65, v235
    v_accvgpr_read_b32 v236, a66
    v_mul_f32 v236, v236, v232
    v_accvgpr_write_b32 a66, v236
    v_accvgpr_read_b32 v237, a67
    v_mul_f32 v237, v237, v232
    v_accvgpr_write_b32 a67, v237
    v_accvgpr_read_b32 v234, a68
    v_mul_f32 v234, v234, v232
    v_accvgpr_write_b32 a68, v234
    v_accvgpr_read_b32 v235, a69
    v_mul_f32 v235, v235, v232
    v_accvgpr_write_b32 a69, v235
    v_accvgpr_read_b32 v236, a70
    v_mul_f32 v236, v236, v232
    v_accvgpr_write_b32 a70, v236
    v_accvgpr_read_b32 v237, a71
    v_mul_f32 v237, v237, v232
    v_accvgpr_write_b32 a71, v237
    v_accvgpr_read_b32 v234, a72
    v_mul_f32 v234, v234, v232
    v_accvgpr_write_b32 a72, v234
    v_accvgpr_read_b32 v235, a73
    v_mul_f32 v235, v235, v232
    v_accvgpr_write_b32 a73, v235
    v_accvgpr_read_b32 v236, a74
    v_mul_f32 v236, v236, v232
    v_accvgpr_write_b32 a74, v236
    v_accvgpr_read_b32 v237, a75
    v_mul_f32 v237, v237, v232
    v_accvgpr_write_b32 a75, v237
    v_accvgpr_read_b32 v234, a76
    v_mul_f32 v234, v234, v232
    v_accvgpr_write_b32 a76, v234
    v_accvgpr_read_b32 v235, a77
    v_mul_f32 v235, v235, v232
    v_accvgpr_write_b32 a77, v235
    v_accvgpr_read_b32 v236, a78
    v_mul_f32 v236, v236, v232
    v_accvgpr_write_b32 a78, v236
    v_accvgpr_read_b32 v237, a79
    v_mul_f32 v237, v237, v232
    v_accvgpr_write_b32 a79, v237
    v_accvgpr_read_b32 v234, a80
    v_mul_f32 v234, v234, v232
    v_accvgpr_write_b32 a80, v234
    v_accvgpr_read_b32 v235, a81
    v_mul_f32 v235, v235, v232
    v_accvgpr_write_b32 a81, v235
    v_accvgpr_read_b32 v236, a82
    v_mul_f32 v236, v236, v232
    v_accvgpr_write_b32 a82, v236
    v_accvgpr_read_b32 v237, a83
    v_mul_f32 v237, v237, v232
    v_accvgpr_write_b32 a83, v237
    v_accvgpr_read_b32 v234, a84
    v_mul_f32 v234, v234, v232
    v_accvgpr_write_b32 a84, v234
    v_accvgpr_read_b32 v235, a85
    v_mul_f32 v235, v235, v232
    v_accvgpr_write_b32 a85, v235
    v_accvgpr_read_b32 v236, a86
    v_mul_f32 v236, v236, v232
    v_accvgpr_write_b32 a86, v236
    v_accvgpr_read_b32 v237, a87
    v_mul_f32 v237, v237, v232
    v_accvgpr_write_b32 a87, v237
    v_accvgpr_read_b32 v234, a88
    v_mul_f32 v234, v234, v232
    v_accvgpr_write_b32 a88, v234
    v_accvgpr_read_b32 v235, a89
    v_mul_f32 v235, v235, v232
    v_accvgpr_write_b32 a89, v235
    v_accvgpr_read_b32 v236, a90
    v_mul_f32 v236, v236, v232
    v_accvgpr_write_b32 a90, v236
    v_accvgpr_read_b32 v237, a91
    v_mul_f32 v237, v237, v232
    v_accvgpr_write_b32 a91, v237
    v_accvgpr_read_b32 v234, a92
    v_mul_f32 v234, v234, v232
    v_accvgpr_write_b32 a92, v234
    v_accvgpr_read_b32 v235, a93
    v_mul_f32 v235, v235, v232
    v_accvgpr_write_b32 a93, v235
    v_accvgpr_read_b32 v236, a94
    v_mul_f32 v236, v236, v232
    v_accvgpr_write_b32 a94, v236
    v_accvgpr_read_b32 v237, a95
    v_mul_f32 v237, v237, v232
    v_accvgpr_write_b32 a95, v237
    v_accvgpr_read_b32 v234, a96
    v_mul_f32 v234, v234, v232
    v_accvgpr_write_b32 a96, v234
    v_accvgpr_read_b32 v235, a97
    v_mul_f32 v235, v235, v232
    v_accvgpr_write_b32 a97, v235
    v_accvgpr_read_b32 v236, a98
    v_mul_f32 v236, v236, v232
    v_accvgpr_write_b32 a98, v236
    v_accvgpr_read_b32 v237, a99
    v_mul_f32 v237, v237, v232
    v_accvgpr_write_b32 a99, v237
    v_accvgpr_read_b32 v234, a100
    v_mul_f32 v234, v234, v232
    v_accvgpr_write_b32 a100, v234
    v_accvgpr_read_b32 v235, a101
    v_mul_f32 v235, v235, v232
    v_accvgpr_write_b32 a101, v235
    v_accvgpr_read_b32 v236, a102
    v_mul_f32 v236, v236, v232
    v_accvgpr_write_b32 a102, v236
    v_accvgpr_read_b32 v237, a103
    v_mul_f32 v237, v237, v232
    v_accvgpr_write_b32 a103, v237
    v_accvgpr_read_b32 v234, a104
    v_mul_f32 v234, v234, v232
    v_accvgpr_write_b32 a104, v234
    v_accvgpr_read_b32 v235, a105
    v_mul_f32 v235, v235, v232
    v_accvgpr_write_b32 a105, v235
    v_accvgpr_read_b32 v236, a106
    v_mul_f32 v236, v236, v232
    v_accvgpr_write_b32 a106, v236
    v_accvgpr_read_b32 v237, a107
    v_mul_f32 v237, v237, v232
    v_accvgpr_write_b32 a107, v237
    v_accvgpr_read_b32 v234, a108
    v_mul_f32 v234, v234, v232
    v_accvgpr_write_b32 a108, v234
    v_accvgpr_read_b32 v235, a109
    v_mul_f32 v235, v235, v232
    v_accvgpr_write_b32 a109, v235
    v_accvgpr_read_b32 v236, a110
    v_mul_f32 v236, v236, v232
    v_accvgpr_write_b32 a110, v236
    v_accvgpr_read_b32 v237, a111
    v_mul_f32 v237, v237, v232
    v_accvgpr_write_b32 a111, v237
    v_accvgpr_read_b32 v234, a112
    v_mul_f32 v234, v234, v232
    v_accvgpr_write_b32 a112, v234
    v_accvgpr_read_b32 v235, a113
    v_mul_f32 v235, v235, v232
    v_accvgpr_write_b32 a113, v235
    v_accvgpr_read_b32 v236, a114
    v_mul_f32 v236, v236, v232
    v_accvgpr_write_b32 a114, v236
    v_accvgpr_read_b32 v237, a115
    v_mul_f32 v237, v237, v232
    v_accvgpr_write_b32 a115, v237
    v_accvgpr_read_b32 v234, a116
    v_mul_f32 v234, v234, v232
    v_accvgpr_write_b32 a116, v234
    v_accvgpr_read_b32 v235, a117
    v_mul_f32 v235, v235, v232
    v_accvgpr_write_b32 a117, v235
    v_accvgpr_read_b32 v236, a118
    v_mul_f32 v236, v236, v232
    v_accvgpr_write_b32 a118, v236
    v_accvgpr_read_b32 v237, a119
    v_mul_f32 v237, v237, v232
    v_accvgpr_write_b32 a119, v237
    v_accvgpr_read_b32 v234, a120
    v_mul_f32 v234, v234, v232
    v_accvgpr_write_b32 a120, v234
    v_accvgpr_read_b32 v235, a121
    v_mul_f32 v235, v235, v232
    v_accvgpr_write_b32 a121, v235
    v_accvgpr_read_b32 v236, a122
    v_mul_f32 v236, v236, v232
    v_accvgpr_write_b32 a122, v236
    v_accvgpr_read_b32 v237, a123
    v_mul_f32 v237, v237, v232
    v_accvgpr_write_b32 a123, v237
    v_accvgpr_read_b32 v234, a124
    v_mul_f32 v234, v234, v232
    v_accvgpr_write_b32 a124, v234
    v_accvgpr_read_b32 v235, a125
    v_mul_f32 v235, v235, v232
    v_accvgpr_write_b32 a125, v235
    v_accvgpr_read_b32 v236, a126
    v_mul_f32 v236, v236, v232
    v_accvgpr_write_b32 a126, v236
    v_accvgpr_read_b32 v237, a127
    v_mul_f32 v237, v237, v232
    v_accvgpr_write_b32 a127, v237
    v_exp_f32 v138, v16
    v_exp_f32 v139, v17
    v_exp_f32 v130, v18
    v_exp_f32 v131, v19
    v_cvt_pk_bf16_f32 v104, v138, v139
    v_exp_f32 v132, v20
    v_exp_f32 v133, v21
    v_cvt_pk_bf16_f32 v105, v130, v131
    v_add_f32 v138, v138, v130
    v_add_f32 v139, v139, v131
    v_exp_f32 v134, v22
    v_exp_f32 v135, v23
    v_cvt_pk_bf16_f32 v106, v132, v133
    v_add_f32 v138, v138, v132
    v_add_f32 v139, v139, v133
    v_exp_f32 v128, v24
    v_exp_f32 v129, v25
    v_cvt_pk_bf16_f32 v107, v134, v135
    v_add_f32 v138, v138, v134
    v_add_f32 v139, v139, v135
    v_exp_f32 v130, v26
    v_exp_f32 v131, v27
    v_cvt_pk_bf16_f32 v108, v128, v129
    v_add_f32 v138, v138, v128
    v_add_f32 v139, v139, v129
    v_exp_f32 v132, v28
    v_exp_f32 v133, v29
    v_cvt_pk_bf16_f32 v109, v130, v131
    v_add_f32 v138, v138, v130
    v_add_f32 v139, v139, v131
    v_exp_f32 v134, v30
    v_exp_f32 v135, v31
    v_cvt_pk_bf16_f32 v110, v132, v133
    v_add_f32 v138, v138, v132
    v_add_f32 v139, v139, v133
    v_cvt_pk_bf16_f32 v111, v134, v135
    v_add_f32 v138, v138, v134
    v_add_f32 v139, v139, v135
    v_add_f32 v225, v138, v139
    s_nop 1
    s_branch kf_rr27
kf_rare30:
    s_nop 15
    v_max3_f32 v230, v48, v49, v50
    v_max3_f32 v230, v230, v51, v52
    v_max3_f32 v230, v230, v53, v54
    v_max3_f32 v230, v230, v55, v56
    v_max3_f32 v230, v230, v57, v58
    v_max3_f32 v230, v230, v59, v60
    v_max3_f32 v230, v230, v61, v62
    v_max_f32 v230, v230, v63
    v_mov_b32 v231, v230
    s_nop 1
    v_permlane32_swap_b32 v230, v231
    s_nop 0
    v_max_f32 v230, v230, v231
    v_max_f32 v230, 0, v230
    v_sub_f32 v232, 0, v230
    v_exp_f32 v232, v232
    v_sub_f32 v229, v229, v230
    v_sub_f32 v80, v80, v230
    v_sub_f32 v16, v16, v230
    v_sub_f32 v48, v48, v230
    v_sub_f32 v81, v81, v230
    v_sub_f32 v17, v17, v230
    v_sub_f32 v49, v49, v230
    v_sub_f32 v82, v82, v230
    v_sub_f32 v18, v18, v230
    v_sub_f32 v50, v50, v230
    v_sub_f32 v83, v83, v230
    v_sub_f32 v19, v19, v230
    v_sub_f32 v51, v51, v230
    v_sub_f32 v84, v84, v230
    v_sub_f32 v20, v20, v230
    v_sub_f32 v52, v52, v230
    v_sub_f32 v85, v85, v230
    v_sub_f32 v21, v21, v230
    v_sub_f32 v53, v53, v230
    v_sub_f32 v86, v86, v230
    v_sub_f32 v22, v22, v230
    v_sub_f32 v54, v54, v230
    v_sub_f32 v87, v87, v230
    v_sub_f32 v23, v23, v230
    v_sub_f32 v55, v55, v230
    v_sub_f32 v88, v88, v230
    v_sub_f32 v24, v24, v230
    v_sub_f32 v56, v56, v230
    v_sub_f32 v89, v89, v230
    v_sub_f32 v25, v25, v230
    v_sub_f32 v57, v57, v230
    v_sub_f32 v90, v90, v230
    v_sub_f32 v26, v26, v230
    v_sub_f32 v58, v58, v230
    v_sub_f32 v91, v91, v230
    v_sub_f32 v27, v27, v230
    v_sub_f32 v59, v59, v230
    v_sub_f32 v92, v92, v230
    v_sub_f32 v28, v28, v230
    v_sub_f32 v60, v60, v230
    v_sub_f32 v93, v93, v230
    v_sub_f32 v29, v29, v230
    v_sub_f32 v61, v61, v230
    v_sub_f32 v94, v94, v230
    v_sub_f32 v30, v30, v230
    v_sub_f32 v62, v62, v230
    v_sub_f32 v95, v95, v230
    v_sub_f32 v31, v31, v230
    v_sub_f32 v63, v63, v230
    v_mul_f32 v227, v227, v232
    v_accvgpr_read_b32 v234, a64
    v_mul_f32 v234, v234, v232
    v_accvgpr_write_b32 a64, v234
    v_accvgpr_read_b32 v235, a65
    v_mul_f32 v235, v235, v232
    v_accvgpr_write_b32 a65, v235
    v_accvgpr_read_b32 v236, a66
    v_mul_f32 v236, v236, v232
    v_accvgpr_write_b32 a66, v236
    v_accvgpr_read_b32 v237, a67
    v_mul_f32 v237, v237, v232
    v_accvgpr_write_b32 a67, v237
    v_accvgpr_read_b32 v234, a68
    v_mul_f32 v234, v234, v232
    v_accvgpr_write_b32 a68, v234
    v_accvgpr_read_b32 v235, a69
    v_mul_f32 v235, v235, v232
    v_accvgpr_write_b32 a69, v235
    v_accvgpr_read_b32 v236, a70
    v_mul_f32 v236, v236, v232
    v_accvgpr_write_b32 a70, v236
    v_accvgpr_read_b32 v237, a71
    v_mul_f32 v237, v237, v232
    v_accvgpr_write_b32 a71, v237
    v_accvgpr_read_b32 v234, a72
    v_mul_f32 v234, v234, v232
    v_accvgpr_write_b32 a72, v234
    v_accvgpr_read_b32 v235, a73
    v_mul_f32 v235, v235, v232
    v_accvgpr_write_b32 a73, v235
    v_accvgpr_read_b32 v236, a74
    v_mul_f32 v236, v236, v232
    v_accvgpr_write_b32 a74, v236
    v_accvgpr_read_b32 v237, a75
    v_mul_f32 v237, v237, v232
    v_accvgpr_write_b32 a75, v237
    v_accvgpr_read_b32 v234, a76
    v_mul_f32 v234, v234, v232
    v_accvgpr_write_b32 a76, v234
    v_accvgpr_read_b32 v235, a77
    v_mul_f32 v235, v235, v232
    v_accvgpr_write_b32 a77, v235
    v_accvgpr_read_b32 v236, a78
    v_mul_f32 v236, v236, v232
    v_accvgpr_write_b32 a78, v236
    v_accvgpr_read_b32 v237, a79
    v_mul_f32 v237, v237, v232
    v_accvgpr_write_b32 a79, v237
    v_accvgpr_read_b32 v234, a80
    v_mul_f32 v234, v234, v232
    v_accvgpr_write_b32 a80, v234
    v_accvgpr_read_b32 v235, a81
    v_mul_f32 v235, v235, v232
    v_accvgpr_write_b32 a81, v235
    v_accvgpr_read_b32 v236, a82
    v_mul_f32 v236, v236, v232
    v_accvgpr_write_b32 a82, v236
    v_accvgpr_read_b32 v237, a83
    v_mul_f32 v237, v237, v232
    v_accvgpr_write_b32 a83, v237
    v_accvgpr_read_b32 v234, a84
    v_mul_f32 v234, v234, v232
    v_accvgpr_write_b32 a84, v234
    v_accvgpr_read_b32 v235, a85
    v_mul_f32 v235, v235, v232
    v_accvgpr_write_b32 a85, v235
    v_accvgpr_read_b32 v236, a86
    v_mul_f32 v236, v236, v232
    v_accvgpr_write_b32 a86, v236
    v_accvgpr_read_b32 v237, a87
    v_mul_f32 v237, v237, v232
    v_accvgpr_write_b32 a87, v237
    v_accvgpr_read_b32 v234, a88
    v_mul_f32 v234, v234, v232
    v_accvgpr_write_b32 a88, v234
    v_accvgpr_read_b32 v235, a89
    v_mul_f32 v235, v235, v232
    v_accvgpr_write_b32 a89, v235
    v_accvgpr_read_b32 v236, a90
    v_mul_f32 v236, v236, v232
    v_accvgpr_write_b32 a90, v236
    v_accvgpr_read_b32 v237, a91
    v_mul_f32 v237, v237, v232
    v_accvgpr_write_b32 a91, v237
    v_accvgpr_read_b32 v234, a92
    v_mul_f32 v234, v234, v232
    v_accvgpr_write_b32 a92, v234
    v_accvgpr_read_b32 v235, a93
    v_mul_f32 v235, v235, v232
    v_accvgpr_write_b32 a93, v235
    v_accvgpr_read_b32 v236, a94
    v_mul_f32 v236, v236, v232
    v_accvgpr_write_b32 a94, v236
    v_accvgpr_read_b32 v237, a95
    v_mul_f32 v237, v237, v232
    v_accvgpr_write_b32 a95, v237
    v_accvgpr_read_b32 v234, a96
    v_mul_f32 v234, v234, v232
    v_accvgpr_write_b32 a96, v234
    v_accvgpr_read_b32 v235, a97
    v_mul_f32 v235, v235, v232
    v_accvgpr_write_b32 a97, v235
    v_accvgpr_read_b32 v236, a98
    v_mul_f32 v236, v236, v232
    v_accvgpr_write_b32 a98, v236
    v_accvgpr_read_b32 v237, a99
    v_mul_f32 v237, v237, v232
    v_accvgpr_write_b32 a99, v237
    v_accvgpr_read_b32 v234, a100
    v_mul_f32 v234, v234, v232
    v_accvgpr_write_b32 a100, v234
    v_accvgpr_read_b32 v235, a101
    v_mul_f32 v235, v235, v232
    v_accvgpr_write_b32 a101, v235
    v_accvgpr_read_b32 v236, a102
    v_mul_f32 v236, v236, v232
    v_accvgpr_write_b32 a102, v236
    v_accvgpr_read_b32 v237, a103
    v_mul_f32 v237, v237, v232
    v_accvgpr_write_b32 a103, v237
    v_accvgpr_read_b32 v234, a104
    v_mul_f32 v234, v234, v232
    v_accvgpr_write_b32 a104, v234
    v_accvgpr_read_b32 v235, a105
    v_mul_f32 v235, v235, v232
    v_accvgpr_write_b32 a105, v235
    v_accvgpr_read_b32 v236, a106
    v_mul_f32 v236, v236, v232
    v_accvgpr_write_b32 a106, v236
    v_accvgpr_read_b32 v237, a107
    v_mul_f32 v237, v237, v232
    v_accvgpr_write_b32 a107, v237
    v_accvgpr_read_b32 v234, a108
    v_mul_f32 v234, v234, v232
    v_accvgpr_write_b32 a108, v234
    v_accvgpr_read_b32 v235, a109
    v_mul_f32 v235, v235, v232
    v_accvgpr_write_b32 a109, v235
    v_accvgpr_read_b32 v236, a110
    v_mul_f32 v236, v236, v232
    v_accvgpr_write_b32 a110, v236
    v_accvgpr_read_b32 v237, a111
    v_mul_f32 v237, v237, v232
    v_accvgpr_write_b32 a111, v237
    v_accvgpr_read_b32 v234, a112
    v_mul_f32 v234, v234, v232
    v_accvgpr_write_b32 a112, v234
    v_accvgpr_read_b32 v235, a113
    v_mul_f32 v235, v235, v232
    v_accvgpr_write_b32 a113, v235
    v_accvgpr_read_b32 v236, a114
    v_mul_f32 v236, v236, v232
    v_accvgpr_write_b32 a114, v236
    v_accvgpr_read_b32 v237, a115
    v_mul_f32 v237, v237, v232
    v_accvgpr_write_b32 a115, v237
    v_accvgpr_read_b32 v234, a116
    v_mul_f32 v234, v234, v232
    v_accvgpr_write_b32 a116, v234
    v_accvgpr_read_b32 v235, a117
    v_mul_f32 v235, v235, v232
    v_accvgpr_write_b32 a117, v235
    v_accvgpr_read_b32 v236, a118
    v_mul_f32 v236, v236, v232
    v_accvgpr_write_b32 a118, v236
    v_accvgpr_read_b32 v237, a119
    v_mul_f32 v237, v237, v232
    v_accvgpr_write_b32 a119, v237
    v_accvgpr_read_b32 v234, a120
    v_mul_f32 v234, v234, v232
    v_accvgpr_write_b32 a120, v234
    v_accvgpr_read_b32 v235, a121
    v_mul_f32 v235, v235, v232
    v_accvgpr_write_b32 a121, v235
    v_accvgpr_read_b32 v236, a122
    v_mul_f32 v236, v236, v232
    v_accvgpr_write_b32 a122, v236
    v_accvgpr_read_b32 v237, a123
    v_mul_f32 v237, v237, v232
    v_accvgpr_write_b32 a123, v237
    v_accvgpr_read_b32 v234, a124
    v_mul_f32 v234, v234, v232
    v_accvgpr_write_b32 a124, v234
    v_accvgpr_read_b32 v235, a125
    v_mul_f32 v235, v235, v232
    v_accvgpr_write_b32 a125, v235
    v_accvgpr_read_b32 v236, a126
    v_mul_f32 v236, v236, v232
    v_accvgpr_write_b32 a126, v236
    v_accvgpr_read_b32 v237, a127
    v_mul_f32 v237, v237, v232
    v_accvgpr_write_b32 a127, v237
    v_exp_f32 v138, v48
    v_exp_f32 v139, v49
    v_exp_f32 v130, v50
    v_exp_f32 v131, v51
    v_cvt_pk_bf16_f32 v120, v138, v139
    v_exp_f32 v132, v52
    v_exp_f32 v133, v53
    v_cvt_pk_bf16_f32 v121, v130, v131
    v_add_f32 v138, v138, v130
    v_add_f32 v139, v139, v131
    v_exp_f32 v134, v54
    v_exp_f32 v135, v55
    v_cvt_pk_bf16_f32 v122, v132, v133
    v_add_f32 v138, v138, v132
    v_add_f32 v139, v139, v133
    v_exp_f32 v128, v56
    v_exp_f32 v129, v57
    v_cvt_pk_bf16_f32 v123, v134, v135
    v_add_f32 v138, v138, v134
    v_add_f32 v139, v139, v135
    v_exp_f32 v130, v58
    v_exp_f32 v131, v59
    v_cvt_pk_bf16_f32 v124, v128, v129
    v_add_f32 v138, v138, v128
    v_add_f32 v139, v139, v129
    v_exp_f32 v132, v60
    v_exp_f32 v133, v61
    v_cvt_pk_bf16_f32 v125, v130, v131
    v_add_f32 v138, v138, v130
    v_add_f32 v139, v139, v131
    v_exp_f32 v134, v62
    v_exp_f32 v135, v63
    v_cvt_pk_bf16_f32 v126, v132, v133
    v_add_f32 v138, v138, v132
    v_add_f32 v139, v139, v133
    v_cvt_pk_bf16_f32 v127, v134, v135
    v_add_f32 v138, v138, v134
    v_add_f32 v139, v139, v135
    v_add_f32 v225, v138, v139
    s_nop 1
    s_branch kf_rr29
kf_spin31:
    s_mov_b32 s25, 0x400000
kf_spin31_l:
    s_sleep 2
    buffer_load_dword v254, off, s[88:91], s97 sc1
    s_waitcnt vmcnt(0)
    v_readfirstlane_b32 s24, v254
    s_sub_u32 s25, s25, 1
    s_cbranch_scc1 kf_spinr32
    s_cmp_ge_u32 s24, 1
    s_cbranch_scc0 kf_spin31_l
    s_branch kf_spinr32
kf_spin33:
    s_mov_b32 s25, 0x400000
kf_spin33_l:
    s_sleep 2
    buffer_load_dword v254, off, s[88:91], s39 sc1
    s_waitcnt vmcnt(0)
    v_readfirstlane_b32 s24, v254
    s_sub_u32 s25, s25, 1
    s_cbranch_scc1 kf_spinr34
    s_cmp_ge_u32 s24, 32
    s_cbranch_scc0 kf_spin33_l
    s_branch kf_spinr34
kf_spin35:
    s_mov_b32 s25, 0x400000
kf_spin35_l:
    s_sleep 2
    buffer_load_dword v254, off, s[88:91], s97 sc1
    s_waitcnt vmcnt(0)
    v_readfirstlane_b32 s24, v254
    s_sub_u32 s25, s25, 1
    s_cbranch_scc1 kf_spinr36
    s_cmp_ge_u32 s24, 1
    s_cbranch_scc0 kf_spin35_l
    s_branch kf_spinr36
kf_spin37:
    s_mov_b32 s25, 0x400000
kf_spin37_l:
    s_sleep 2
    buffer_load_dword v254, off, s[88:91], s39 sc1
    s_waitcnt vmcnt(0)
    v_readfirstlane_b32 s24, v254
    s_sub_u32 s25, s25, 1
    s_cbranch_scc1 kf_spinr38
    s_cmp_ge_u32 s24, 32
    s_cbranch_scc0 kf_spin37_l
    s_branch kf_spinr38
kf_spin39:
    s_mov_b32 s25, 0x400000
kf_spin39_l:
    s_sleep 2
    buffer_load_dword v254, off, s[88:91], s35 sc1
    s_waitcnt vmcnt(0)
    v_readfirstlane_b32 s24, v254
    s_sub_u32 s25, s25, 1
    s_cbranch_scc1 kf_spinr40
    s_cmp_ge_u32 s24, 8
    s_cbranch_scc0 kf_spin39_l
    s_branch kf_spinr40

code_end:
.section .rodata,"a"
.p2align 6
.amdhsa_kernel sequential_preLN__compressed_kv_cla__moe_arch_mod__prompt_kernel
  .amdhsa_next_free_vgpr 512
  .amdhsa_next_free_sgpr 102
  .amdhsa_accum_offset 256
  .amdhsa_group_segment_fixed_size 0
  .amdhsa_kernarg_size 112
  .amdhsa_user_sgpr_count 2
  .amdhsa_user_sgpr_kernarg_segment_ptr 1
  .amdhsa_system_sgpr_workgroup_id_x 1
  .amdhsa_float_denorm_mode_32 3
.end_amdhsa_kernel
```

```asm
; @launch grid=(256,1,1) block=(256,1,1) lds=163840
.amdgcn_target "amdgcn-amd-amdhsa--gfx950"
.text
.globl sequential_preLN__compressed_kv_cla__moe_arch_mod__prompt_kernel
.p2align 8
.type sequential_preLN__compressed_kv_cla__moe_arch_mod__prompt_kernel,@function
sequential_preLN__compressed_kv_cla__moe_arch_mod__prompt_kernel:
    s_cmp_ge_u32 s2, 256
    s_cbranch_scc1 ka_done
    s_load_dwordx8 s[64:71], s[0:1], 0
    s_load_dwordx4 s[72:75], s[0:1], 32
    s_load_dwordx4 s[76:79], s[0:1], 64
    s_load_dwordx8 s[8:15], s[0:1], 80
    v_lshrrev_b32 v1, 6, v0
    v_and_b32 v2, 63, v0
    v_readfirstlane_b32 s3, v1
    v_mov_b32 v253, v0
    s_and_b32 s4, s2, 7
    s_lshl_b32 s4, s4, 2
    s_lshr_b32 s24, s2, 3
    s_and_b32 s24, s24, 3
    s_add_u32 s4, s4, s24
    s_lshr_b32 s5, s2, 5
    s_lshl2_add_u32 s6, s5, s3
    s_getpc_b64 s[56:57]
ka_pc:
    s_mov_b32 s58, code_end-ka_pc
    s_mov_b32 s59, 0x00020000
    s_lshr_b32 s24, s2, 3
    s_lshl2_add_u32 s24, s24, s3
    s_lshl_b32 s24, s24, 13
    v_lshlrev_b32 v3, 7, v2
    buffer_load_dword v252, v3, s[56:59], s24 offen
    v_mov_b32 v192, v2
    v_lshrrev_b32 v198, 3, v192
    v_and_b32 v199, 7, v192
    s_lshr_b32 s24, s3, 1
    s_lshl_b32 s24, s24, 5
    s_and_b32 s25, s3, 1
    s_lshl_b32 s26, s25, 3
    s_add_u32 s24, s24, s26
    v_add_u32 v194, s24, v198
    v_lshlrev_b32 v194, 10, v194
    v_lshrrev_b32 v195, 1, v198
    v_xor_b32 v195, v199, v195
    v_lshl_add_u32 v232, v195, 4, v194
    v_xor_b32 v195, 4, v195
    v_lshl_add_u32 v233, v195, 4, v194
    v_add_u32 v233, 15360, v233
    s_lshl_b32 s24, s4, 8
    s_lshl_b32 s26, s25, 7
    s_add_u32 s24, s24, s26
    v_lshlrev_b32 v194, 13, v198
    v_add_u32 v194, s24, v194
    v_bfe_u32 v195, v198, 1, 1
    v_xor_b32 v195, v199, v195
    v_lshl_add_u32 v234, v195, 4, v194
    v_xor_b32 v195, 4, v195
    v_lshl_add_u32 v235, v195, 4, v194
    v_add_u32 v235, 64512, v235
    s_lshl_b32 s34, s3, 11
    s_mul_i32 s35, s3, 24576
    s_add_u32 s35, s35, 65536
    s_lshl_b32 s32, s5, 18
    s_and_b32 s7, s4, 3
    s_lshl1_add_u32 s7, s7, s5
    s_add_u32 s80, s7, 0
    s_and_b32 s80, s80, 7
    s_lshl_b32 s80, s80, 7
    s_add_u32 s80, s80, s32
    s_add_u32 s81, s7, 1
    s_and_b32 s81, s81, 7
    s_lshl_b32 s81, s81, 7
    s_add_u32 s81, s81, s32
    s_add_u32 s82, s7, 2
    s_and_b32 s82, s82, 7
    s_lshl_b32 s82, s82, 7
    s_add_u32 s82, s82, s32
    s_add_u32 s83, s7, 3
    s_and_b32 s83, s83, 7
    s_lshl_b32 s83, s83, 7
    s_add_u32 s83, s83, s32
    s_add_u32 s84, s7, 4
    s_and_b32 s84, s84, 7
    s_lshl_b32 s84, s84, 7
    s_add_u32 s84, s84, s32
    s_add_u32 s85, s7, 5
    s_and_b32 s85, s85, 7
    s_lshl_b32 s85, s85, 7
    s_add_u32 s85, s85, s32
    s_add_u32 s86, s7, 6
    s_and_b32 s86, s86, 7
    s_lshl_b32 s86, s86, 7
    s_add_u32 s86, s86, s32
    s_add_u32 s87, s7, 7
    s_and_b32 s87, s87, 7
    s_lshl_b32 s87, s87, 7
    s_add_u32 s87, s87, s32
    s_waitcnt lgkmcnt(0)
    s_cmp_lt_u32 s3, 2
    s_cselect_b32 s48, s70, s72
    s_cselect_b32 s49, s71, s73
    s_mov_b32 s50, 0x400000
    s_mov_b32 s51, 0x00020000
    s_mov_b32 s44, s66
    s_mov_b32 s45, s67
    s_mov_b32 s46, 0x200000
    s_mov_b32 s47, 0x00020000
    s_add_u32 m0, s35, 0
    s_and_b32 s33, s80, 1023
    s_lshl_b32 s33, s33, 12
    buffer_load_dwordx4 v234, s[48:51], s33 offen lds
    buffer_load_dwordx4 v235, s[48:51], s33 offen offset:1024 lds
    s_add_u32 m0, s35, 2048
    s_add_u32 s33, s33, 131072
    buffer_load_dwordx4 v234, s[48:51], s33 offen lds
    buffer_load_dwordx4 v235, s[48:51], s33 offen offset:1024 lds
    s_add_u32 m0, s34, 0
    s_add_u32 s37, s80, 0
    buffer_load_dwordx4 v232, s[44:47], s37 offen lds
    buffer_load_dwordx4 v233, s[44:47], s37 offen offset:1024 lds
    s_add_u32 m0, s34, 8192
    s_add_u32 s37, s80, 65536
    buffer_load_dwordx4 v232, s[44:47], s37 offen lds
    buffer_load_dwordx4 v233, s[44:47], s37 offen offset:1024 lds
    s_add_u32 m0, s35, 4096
    s_add_u32 s33, s33, 131072
    buffer_load_dwordx4 v234, s[48:51], s33 offen lds
    buffer_load_dwordx4 v235, s[48:51], s33 offen offset:1024 lds
    s_add_u32 m0, s35, 6144
    s_add_u32 s33, s33, 131072
    buffer_load_dwordx4 v234, s[48:51], s33 offen lds
    buffer_load_dwordx4 v235, s[48:51], s33 offen offset:1024 lds
    s_mov_b32 s52, s64
    s_mov_b32 s53, s65
    s_mov_b32 s54, 0x400000
    s_mov_b32 s55, 0x00020000
    s_add_u32 s16, s14, 0x5c00000
    s_addc_u32 s17, s15, 0
    s_mov_b32 s18, 0x2140000
    s_mov_b32 s19, 0x00020000
    s_add_u32 s56, s14, 0x3800000
    s_addc_u32 s57, s15, 0
    s_mov_b32 s58, 0x6040
    s_mov_b32 s59, 0x00020000
    s_add_u32 s20, s14, 0x2400000
    s_addc_u32 s21, s15, 0
    s_mov_b32 s22, 0x1000000
    s_mov_b32 s23, 0x00020000
    s_mov_b32 s88, s12
    s_mov_b32 s89, s13
    s_mov_b32 s90, 0x100
    s_mov_b32 s91, 0x00020000
    s_cmp_lt_u32 s3, 2
    s_cselect_b32 s60, s8, s74
    s_cselect_b32 s61, s9, s75
    s_mov_b32 s62, 0x800000
    s_cselect_b32 s62, 0x700000, s62
    s_mov_b32 s63, 0x00020000
    s_cselect_b32 s41, s76, s78
    s_cselect_b32 s42, s77, s79
    s_mov_b32 s8, s14
    s_mov_b32 s9, s15
    s_mov_b32 s10, 0x400000
    s_mov_b32 s11, 0x00020000
    s_mov_b32 s12, s68
    s_mov_b32 s13, s69
    s_mov_b32 s14, 0x800000
    s_mov_b32 s15, 0x00020000
    s_cmp_eq_u32 s2, 0
    s_mov_b32 s97, 0x40000000
    s_cselect_b32 s97, 0xa0000, s97
    s_mov_b32 s58, 0xa5000
    v_lshlrev_b32 v194, 7, v253
    v_mov_b32 v195, 0
    buffer_store_dword v195, v194, s[56:59], s97 offen sc1
    s_cselect_b32 s97, 0, 0x40000000
    s_mov_b32 s58, 0x6040
    s_add_u32 m0, s35, 8192
    s_and_b32 s33, s81, 1023
    s_lshl_b32 s33, s33, 12
    buffer_load_dwordx4 v234, s[48:51], s33 offen lds
    buffer_load_dwordx4 v235, s[48:51], s33 offen offset:1024 lds
    s_add_u32 m0, s35, 10240
    s_add_u32 s33, s33, 131072
    buffer_load_dwordx4 v234, s[48:51], s33 offen lds
    buffer_load_dwordx4 v235, s[48:51], s33 offen offset:1024 lds
    s_add_u32 m0, s35, 12288
    s_add_u32 s33, s33, 131072
    buffer_load_dwordx4 v234, s[48:51], s33 offen lds
    buffer_load_dwordx4 v235, s[48:51], s33 offen offset:1024 lds
    s_add_u32 m0, s35, 14336
    s_add_u32 s33, s33, 131072
    buffer_load_dwordx4 v234, s[48:51], s33 offen lds
    buffer_load_dwordx4 v235, s[48:51], s33 offen offset:1024 lds
    s_add_u32 m0, s34, 16384
    s_add_u32 s37, s81, 0
    buffer_load_dwordx4 v232, s[44:47], s37 offen lds
    buffer_load_dwordx4 v233, s[44:47], s37 offen offset:1024 lds
    s_add_u32 m0, s34, 24576
    s_add_u32 s37, s81, 65536
    buffer_load_dwordx4 v232, s[44:47], s37 offen lds
    buffer_load_dwordx4 v233, s[44:47], s37 offen offset:1024 lds
    v_and_b32 v200, 15, v192
    v_lshrrev_b32 v201, 4, v192
    v_lshrrev_b32 v194, 1, v200
    v_xor_b32 v194, v201, v194
    v_lshlrev_b32 v194, 4, v194
    v_lshl_add_u32 v224, v200, 7, v194
    v_xor_b32 v225, 64, v224
    v_lshrrev_b32 v194, 2, v200
    v_lshl_add_u32 v195, v201, 3, v194
    v_lshlrev_b32 v195, 7, v195
    v_add_u32 v195, s35, v195
    v_and_b32 v196, 1, v200
    v_lshl_add_u32 v195, v196, 3, v195
    v_lshrrev_b32 v194, 1, v194
    v_and_b32 v196, 1, v201
    v_lshl_or_b32 v194, v196, 2, v194
    v_and_b32 v196, 2, v200
    v_xor_b32 v194, v194, v196
    v_xor_b32 v196, 0, v194
    v_lshl_add_u32 v228, v196, 4, v195
    v_xor_b32 v196, 1, v194
    v_lshl_add_u32 v229, v196, 4, v195
    v_xor_b32 v196, 4, v194
    v_lshl_add_u32 v230, v196, 4, v195
    v_xor_b32 v196, 5, v194
    v_lshl_add_u32 v231, v196, 4, v195
    s_mul_i32 s36, s4, 1089536
    s_mul_i32 s24, s5, 136192
    s_add_u32 s36, s36, s24
    s_and_b32 s24, s3, 1
    s_lshl_b32 s24, s24, 12
    s_and_b32 s26, s3, 2
    s_lshl_b32 s26, s26, 13
    s_add_u32 s36, s36, s24
    s_add_u32 s36, s36, s26
    v_bfe_u32 v194, v192, 3, 1
    v_lshlrev_b32 v194, 10, v194
    v_lshrrev_b32 v195, 5, v192
    v_lshl_add_u32 v194, v195, 8, v194
    v_bfe_u32 v195, v192, 4, 1
    v_lshl_add_u32 v194, v195, 7, v194
    v_lshl_add_u32 v239, v199, 4, v194
    s_lshl_b32 s24, s5, 7
    s_sub_u32 s26, 1792, s24
    s_cmp_lt_u32 s4, 16
    s_cselect_b32 s24, s24, s26
    s_lshl_b32 s26, s4, 3
    s_add_u32 s24, s24, s26
    v_lshrrev_b32 v194, 5, v253
    v_add_u32 v196, s24, v194
    v_and_b32 v195, 31, v192
    v_lshlrev_b32 v196, 11, v196
    v_lshl_add_u32 v236, v195, 4, v196
    v_xor_b32 v194, v194, v199
    v_lshlrev_b32 v194, 4, v194
    v_lshl_add_u32 v194, v195, 7, v194
    v_add_u32 v237, 81920, v194
    s_lshr_b32 s26, s24, 4
    s_lshl_b32 s26, s26, 15
    s_and_b32 s24, s24, 15
    s_lshl_b32 s24, s24, 4
    s_add_u32 s24, s24, s26
    v_lshrrev_b32 v194, 3, v253
    v_lshlrev_b32 v194, 8, v194
    v_xor_b32 v195, v199, v198
    v_lshl_add_u32 v194, v195, 4, v194
    v_add_u32 v238, s24, v194
    v_lshlrev_b32 v240, 4, v192
    s_lshl_b32 s24, s3, 12
    v_add_u32 v242, s24, v240
    s_lshl_b32 s24, s6, 16
    v_add_u32 v248, s24, v240
    s_sub_u32 s25, 63, s6
    s_lshl_b32 s24, s25, 16
    v_add_u32 v249, s24, v240
    v_bfe_u32 v194, v192, 2, 2
    v_lshlrev_b32 v194, 13, v194
    v_lshl_add_u32 v194, v201, 6, v194
    v_and_b32 v195, 3, v192
    v_lshl_add_u32 v194, v195, 4, v194
    s_lshl_b32 s24, s4, 8
    s_lshl_b32 s25, s3, 18
    s_add_u32 s24, s24, s25
    v_add_u32 v245, s24, v194
    s_lshl_b32 s31, s3, 13
    s_add_u32 s31, s31, 65536
    s_lshl_b32 s27, s5, 20
    s_mov_b32 s7, s27
    s_mov_b32 s43, 0x40000000
    s_lshr_b32 s28, s27, 8
    s_add_u32 s29, s28, 32768
    s_nop 0
    v_lshlrev_b32 v194, 11, v201
    v_bfe_u32 v195, v192, 2, 2
    v_lshl_add_u32 v194, v195, 6, v194
    v_bfe_u32 v195, v192, 4, 1
    v_lshl_add_u32 v194, v195, 5, v194
    v_and_b32 v195, 1, v192
    v_lshl_add_u32 v194, v195, 4, v194
    v_bfe_u32 v195, v192, 1, 1
    v_lshl_add_u32 v247, v195, 3, v194
    s_mov_b32 s30, 65536
    v_add_u32 v246, s30, v247
    v_and_b32 v194, 31, v192
    v_lshrrev_b32 v195, 5, v192
    v_lshlrev_b32 v195, 2, v195
    v_sub_u32 v194, v194, v195
    v_cvt_f32_i32 v194, v194
    v_add_f32 v194, 0.5, v194
    v_mul_f32 v243, 0x71800000, v194
    v_bfe_u32 v194, v192, 4, 1
    v_lshlrev_b32 v194, 17, v194
    v_lshrrev_b32 v195, 5, v192
    v_lshl_add_u32 v194, v195, 8, v194
    v_lshl_add_u32 v244, v200, 4, v194
    v_lshlrev_b32 v251, 7, v192
    v_cmp_gt_u32 vcc, 16, v192
    v_mov_b32 v194, 0x40000000
    v_mov_b32 v255, 1
    v_cndmask_b32 v251, v194, v251, vcc
    v_cmp_eq_u32 vcc, 0, v253
    s_nop 1
    v_cndmask_b32 v250, v194, v253, vcc
    s_waitcnt vmcnt(19)
    s_barrier
    ds_read_b128 v[64:67], v224 offset:0
    ds_read_b128 v[68:71], v224 offset:2048
    ds_read_b128 v[72:75], v224 offset:4096
    ds_read_b128 v[76:79], v224 offset:6144
    ds_read_b64_tr_b16 a[0:1], v228 offset:0
    ds_read_b64_tr_b16 a[2:3], v228 offset:512
    ds_read_b64_tr_b16 a[4:5], v229 offset:0
    ds_read_b64_tr_b16 a[6:7], v229 offset:512
    ds_read_b64_tr_b16 a[8:9], v230 offset:0
    ds_read_b64_tr_b16 a[10:11], v230 offset:512
    ds_read_b64_tr_b16 a[12:13], v231 offset:0
    ds_read_b64_tr_b16 a[14:15], v231 offset:512
    s_waitcnt vmcnt(12)
    s_barrier
    buffer_store_dword v255, v250, s[88:91], s97 offen sc1
    s_cmp_eq_u32 s3, 0
    s_cselect_b32 s97, 0, s43
    s_cmp_lt_u32 s3, 2
    s_cbranch_scc0 ka_V
    s_waitcnt lgkmcnt(0)
    v_mfma_f32_16x16x32_bf16 v[96:99], a[0:3], v[64:67], 0
    ds_read_b128 v[80:83], v224 offset:8192
    v_mfma_f32_16x16x32_bf16 v[100:103], a[4:7], v[64:67], 0
    ds_read_b128 v[84:87], v224 offset:10240
    v_mfma_f32_16x16x32_bf16 v[104:107], a[8:11], v[64:67], 0
    ds_read_b128 v[88:91], v224 offset:12288
    v_mfma_f32_16x16x32_bf16 v[108:111], a[12:15], v[64:67], 0
    ds_read_b128 v[92:95], v224 offset:14336
    v_mfma_f32_16x16x32_bf16 v[112:115], a[0:3], v[68:71], 0
    ds_read_b64_tr_b16 a[16:17], v228 offset:4096
    v_mfma_f32_16x16x32_bf16 v[116:119], a[4:7], v[68:71], 0
    ds_read_b64_tr_b16 a[18:19], v228 offset:4608
    v_mfma_f32_16x16x32_bf16 v[120:123], a[8:11], v[68:71], 0
    ds_read_b64_tr_b16 a[20:21], v229 offset:4096
    v_mfma_f32_16x16x32_bf16 v[124:127], a[12:15], v[68:71], 0
    ds_read_b64_tr_b16 a[22:23], v229 offset:4608
    v_mfma_f32_16x16x32_bf16 v[128:131], a[0:3], v[72:75], 0
    s_add_u32 m0, s35, 16384
    s_and_b32 s33, s82, 1023
    s_lshl_b32 s33, s33, 12
    buffer_load_dwordx4 v234, s[48:51], s33 offen lds
    v_mfma_f32_16x16x32_bf16 v[132:135], a[4:7], v[72:75], 0
    buffer_load_dwordx4 v235, s[48:51], s33 offen offset:1024 lds
    v_mfma_f32_16x16x32_bf16 v[136:139], a[8:11], v[72:75], 0
    s_add_u32 m0, s35, 18432
    s_add_u32 s33, s33, 131072
    buffer_load_dwordx4 v234, s[48:51], s33 offen lds
    v_mfma_f32_16x16x32_bf16 v[140:143], a[12:15], v[72:75], 0
    v_mfma_f32_16x16x32_bf16 v[144:147], a[0:3], v[76:79], 0
    buffer_load_dwordx4 v235, s[48:51], s33 offen offset:1024 lds
    v_mfma_f32_16x16x32_bf16 v[148:151], a[4:7], v[76:79], 0
    buffer_load_dwordx4 v[0:3], v236, s[52:55], 0 offen offset:0
    v_mfma_f32_16x16x32_bf16 v[152:155], a[8:11], v[76:79], 0
    buffer_load_dwordx4 v[4:7], v236, s[52:55], 0 offen offset:512
    v_mfma_f32_16x16x32_bf16 v[156:159], a[12:15], v[76:79], 0
    s_waitcnt lgkmcnt(0)
    v_mfma_f32_16x16x32_bf16 v[160:163], a[0:3], v[80:83], 0
    ds_read_b128 v[64:67], v225 offset:0
    v_mfma_f32_16x16x32_bf16 v[164:167], a[4:7], v[80:83], 0
    ds_read_b128 v[68:71], v225 offset:2048
    v_mfma_f32_16x16x32_bf16 v[168:171], a[8:11], v[80:83], 0
    ds_read_b128 v[72:75], v225 offset:4096
    v_mfma_f32_16x16x32_bf16 v[172:175], a[12:15], v[80:83], 0
    ds_read_b128 v[76:79], v225 offset:6144
    v_mfma_f32_16x16x32_bf16 v[176:179], a[0:3], v[84:87], 0
    ds_read_b64_tr_b16 a[24:25], v230 offset:4096
    v_mfma_f32_16x16x32_bf16 v[180:183], a[4:7], v[84:87], 0
    ds_read_b64_tr_b16 a[26:27], v230 offset:4608
    v_mfma_f32_16x16x32_bf16 v[184:187], a[8:11], v[84:87], 0
    ds_read_b64_tr_b16 a[28:29], v231 offset:4096
    v_mfma_f32_16x16x32_bf16 v[188:191], a[12:15], v[84:87], 0
    ds_read_b64_tr_b16 a[30:31], v231 offset:4608
    v_mfma_f32_16x16x32_bf16 v[192:195], a[0:3], v[88:91], 0
    s_add_u32 m0, s35, 20480
    s_add_u32 s33, s33, 131072
    buffer_load_dwordx4 v234, s[48:51], s33 offen lds
    v_mfma_f32_16x16x32_bf16 v[196:199], a[4:7], v[88:91], 0
    buffer_load_dwordx4 v235, s[48:51], s33 offen offset:1024 lds
    v_mfma_f32_16x16x32_bf16 v[200:203], a[8:11], v[88:91], 0
    s_add_u32 m0, s35, 22528
    s_add_u32 s33, s33, 131072
    buffer_load_dwordx4 v234, s[48:51], s33 offen lds
    v_mfma_f32_16x16x32_bf16 v[204:207], a[12:15], v[88:91], 0
    v_mfma_f32_16x16x32_bf16 v[208:211], a[0:3], v[92:95], 0
    buffer_load_dwordx4 v235, s[48:51], s33 offen offset:1024 lds
    v_mfma_f32_16x16x32_bf16 v[212:215], a[4:7], v[92:95], 0
    buffer_load_dwordx4 v[8:11], v236, s[52:55], 0 offen offset:1024
    v_mfma_f32_16x16x32_bf16 v[216:219], a[8:11], v[92:95], 0
    buffer_load_dwordx4 v[12:15], v236, s[52:55], 0 offen offset:1536
    v_mfma_f32_16x16x32_bf16 v[220:223], a[12:15], v[92:95], 0
    s_waitcnt vmcnt(17) lgkmcnt(0)
    v_mfma_f32_16x16x32_bf16 v[96:99], a[16:19], v[64:67], v[96:99]
    ds_read_b128 v[80:83], v225 offset:8192
    v_mfma_f32_16x16x32_bf16 v[100:103], a[20:23], v[64:67], v[100:103]
    ds_read_b128 v[84:87], v225 offset:10240
    v_mfma_f32_16x16x32_bf16 v[104:107], a[24:27], v[64:67], v[104:107]
    ds_read_b128 v[88:91], v225 offset:12288
    v_mfma_f32_16x16x32_bf16 v[108:111], a[28:31], v[64:67], v[108:111]
    ds_read_b128 v[92:95], v225 offset:14336
    v_mfma_f32_16x16x32_bf16 v[112:115], a[16:19], v[68:71], v[112:115]
    ds_read_b64_tr_b16 a[32:33], v228 offset:8192
    v_mfma_f32_16x16x32_bf16 v[116:119], a[20:23], v[68:71], v[116:119]
    ds_read_b64_tr_b16 a[34:35], v228 offset:8704
    v_mfma_f32_16x16x32_bf16 v[120:123], a[24:27], v[68:71], v[120:123]
    ds_read_b64_tr_b16 a[36:37], v229 offset:8192
    v_mfma_f32_16x16x32_bf16 v[124:127], a[28:31], v[68:71], v[124:127]
    ds_read_b64_tr_b16 a[38:39], v229 offset:8704
    v_mfma_f32_16x16x32_bf16 v[128:131], a[16:19], v[72:75], v[128:131]
    s_add_u32 m0, s34, 32768
    s_add_u32 s37, s82, 0
    buffer_load_dwordx4 v232, s[44:47], s37 offen lds
    v_mfma_f32_16x16x32_bf16 v[132:135], a[20:23], v[72:75], v[132:135]
    buffer_load_dwordx4 v233, s[44:47], s37 offen offset:1024 lds
    v_mfma_f32_16x16x32_bf16 v[136:139], a[24:27], v[72:75], v[136:139]
    s_add_u32 m0, s34, 40960
    s_add_u32 s37, s82, 65536
    buffer_load_dwordx4 v232, s[44:47], s37 offen lds
    v_mfma_f32_16x16x32_bf16 v[140:143], a[28:31], v[72:75], v[140:143]
    buffer_load_dwordx4 v233, s[44:47], s37 offen offset:1024 lds
    v_mfma_f32_16x16x32_bf16 v[144:147], a[16:19], v[76:79], v[144:147]
    s_add_u32 m0, s35, 0
    s_and_b32 s33, s83, 1023
    s_lshl_b32 s33, s33, 12
    buffer_load_dwordx4 v234, s[48:51], s33 offen lds
    v_mfma_f32_16x16x32_bf16 v[148:151], a[20:23], v[76:79], v[148:151]
    buffer_load_dwordx4 v235, s[48:51], s33 offen offset:1024 lds
    v_mfma_f32_16x16x32_bf16 v[152:155], a[24:27], v[76:79], v[152:155]
    s_add_u32 m0, s35, 2048
    s_add_u32 s33, s33, 131072
    buffer_load_dwordx4 v234, s[48:51], s33 offen lds
    v_mfma_f32_16x16x32_bf16 v[156:159], a[28:31], v[76:79], v[156:159]
    buffer_load_dwordx4 v235, s[48:51], s33 offen offset:1024 lds
    s_waitcnt vmcnt(21) lgkmcnt(0)
    s_barrier
    v_mfma_f32_16x16x32_bf16 v[160:163], a[16:19], v[80:83], v[160:163]
    ds_read_b128 v[64:67], v224 offset:16384
    v_mfma_f32_16x16x32_bf16 v[164:167], a[20:23], v[80:83], v[164:167]
    ds_read_b128 v[68:71], v224 offset:18432
    v_mfma_f32_16x16x32_bf16 v[168:171], a[24:27], v[80:83], v[168:171]
    ds_read_b128 v[72:75], v224 offset:20480
    v_mfma_f32_16x16x32_bf16 v[172:175], a[28:31], v[80:83], v[172:175]
    ds_read_b128 v[76:79], v224 offset:22528
    v_mfma_f32_16x16x32_bf16 v[176:179], a[16:19], v[84:87], v[176:179]
    ds_read_b64_tr_b16 a[40:41], v230 offset:8192
    v_mfma_f32_16x16x32_bf16 v[180:183], a[20:23], v[84:87], v[180:183]
    ds_read_b64_tr_b16 a[42:43], v230 offset:8704
    v_mfma_f32_16x16x32_bf16 v[184:187], a[24:27], v[84:87], v[184:187]
    ds_read_b64_tr_b16 a[44:45], v231 offset:8192
    v_mfma_f32_16x16x32_bf16 v[188:191], a[28:31], v[84:87], v[188:191]
    ds_read_b64_tr_b16 a[46:47], v231 offset:8704
    v_mfma_f32_16x16x32_bf16 v[192:195], a[16:19], v[88:91], v[192:195]
    s_add_u32 m0, s34, 49152
    s_add_u32 s37, s83, 0
    buffer_load_dwordx4 v232, s[44:47], s37 offen lds
    v_mfma_f32_16x16x32_bf16 v[196:199], a[20:23], v[88:91], v[196:199]
    buffer_load_dwordx4 v233, s[44:47], s37 offen offset:1024 lds
    v_mfma_f32_16x16x32_bf16 v[200:203], a[24:27], v[88:91], v[200:203]
    s_add_u32 m0, s34, 57344
    s_add_u32 s37, s83, 65536
    buffer_load_dwordx4 v232, s[44:47], s37 offen lds
    v_mfma_f32_16x16x32_bf16 v[204:207], a[28:31], v[88:91], v[204:207]
    v_mfma_f32_16x16x32_bf16 v[208:211], a[16:19], v[92:95], v[208:211]
    buffer_load_dwordx4 v233, s[44:47], s37 offen offset:1024 lds
    v_mfma_f32_16x16x32_bf16 v[212:215], a[20:23], v[92:95], v[212:215]
    s_add_u32 m0, s34, 0
    s_add_u32 s37, s84, 0
    buffer_load_dwordx4 v232, s[44:47], s37 offen lds
    v_mfma_f32_16x16x32_bf16 v[216:219], a[24:27], v[92:95], v[216:219]
    buffer_load_dwordx4 v233, s[44:47], s37 offen offset:1024 lds
    v_mfma_f32_16x16x32_bf16 v[220:223], a[28:31], v[92:95], v[220:223]
    s_waitcnt lgkmcnt(0)
    v_mfma_f32_16x16x32_bf16 v[96:99], a[32:35], v[64:67], v[96:99]
    ds_read_b128 v[80:83], v224 offset:24576
    v_mfma_f32_16x16x32_bf16 v[100:103], a[36:39], v[64:67], v[100:103]
    ds_read_b128 v[84:87], v224 offset:26624
    v_mfma_f32_16x16x32_bf16 v[104:107], a[40:43], v[64:67], v[104:107]
    ds_read_b128 v[88:91], v224 offset:28672
    v_mfma_f32_16x16x32_bf16 v[108:111], a[44:47], v[64:67], v[108:111]
    ds_read_b128 v[92:95], v224 offset:30720
    v_mfma_f32_16x16x32_bf16 v[112:115], a[32:35], v[68:71], v[112:115]
    ds_read_b64_tr_b16 a[48:49], v228 offset:12288
    v_mfma_f32_16x16x32_bf16 v[116:119], a[36:39], v[68:71], v[116:119]
    ds_read_b64_tr_b16 a[50:51], v228 offset:12800
    v_mfma_f32_16x16x32_bf16 v[120:123], a[40:43], v[68:71], v[120:123]
    ds_read_b64_tr_b16 a[52:53], v229 offset:12288
    v_mfma_f32_16x16x32_bf16 v[124:127], a[44:47], v[68:71], v[124:127]
    ds_read_b64_tr_b16 a[54:55], v229 offset:12800
    v_mfma_f32_16x16x32_bf16 v[128:131], a[32:35], v[72:75], v[128:131]
    s_add_u32 m0, s35, 4096
    s_add_u32 s33, s33, 131072
    buffer_load_dwordx4 v234, s[48:51], s33 offen lds
    v_mfma_f32_16x16x32_bf16 v[132:135], a[36:39], v[72:75], v[132:135]
    v_mfma_f32_16x16x32_bf16 v[136:139], a[40:43], v[72:75], v[136:139]
    buffer_load_dwordx4 v235, s[48:51], s33 offen offset:1024 lds
    v_mfma_f32_16x16x32_bf16 v[140:143], a[44:47], v[72:75], v[140:143]
    v_mfma_f32_16x16x32_bf16 v[144:147], a[32:35], v[76:79], v[144:147]
    s_add_u32 m0, s35, 6144
    s_add_u32 s33, s33, 131072
    buffer_load_dwordx4 v234, s[48:51], s33 offen lds
    v_mfma_f32_16x16x32_bf16 v[148:151], a[36:39], v[76:79], v[148:151]
    v_mfma_f32_16x16x32_bf16 v[152:155], a[40:43], v[76:79], v[152:155]
    buffer_load_dwordx4 v235, s[48:51], s33 offen offset:1024 lds
    v_mfma_f32_16x16x32_bf16 v[156:159], a[44:47], v[76:79], v[156:159]
    s_waitcnt lgkmcnt(0)
    v_mfma_f32_16x16x32_bf16 v[160:163], a[32:35], v[80:83], v[160:163]
    ds_read_b128 v[64:67], v225 offset:16384
    v_mfma_f32_16x16x32_bf16 v[164:167], a[36:39], v[80:83], v[164:167]
    ds_read_b128 v[68:71], v225 offset:18432
    v_mfma_f32_16x16x32_bf16 v[168:171], a[40:43], v[80:83], v[168:171]
    ds_read_b128 v[72:75], v225 offset:20480
    v_mfma_f32_16x16x32_bf16 v[172:175], a[44:47], v[80:83], v[172:175]
    ds_read_b128 v[76:79], v225 offset:22528
    v_mfma_f32_16x16x32_bf16 v[176:179], a[32:35], v[84:87], v[176:179]
    ds_read_b64_tr_b16 a[56:57], v230 offset:12288
    v_mfma_f32_16x16x32_bf16 v[180:183], a[36:39], v[84:87], v[180:183]
    ds_read_b64_tr_b16 a[58:59], v230 offset:12800
    v_mfma_f32_16x16x32_bf16 v[184:187], a[40:43], v[84:87], v[184:187]
    ds_read_b64_tr_b16 a[60:61], v231 offset:12288
    v_mfma_f32_16x16x32_bf16 v[188:191], a[44:47], v[84:87], v[188:191]
    ds_read_b64_tr_b16 a[62:63], v231 offset:12800
    v_mfma_f32_16x16x32_bf16 v[192:195], a[32:35], v[88:91], v[192:195]
    s_add_u32 m0, s34, 8192
    s_add_u32 s37, s84, 65536
    buffer_load_dwordx4 v232, s[44:47], s37 offen lds
    v_mfma_f32_16x16x32_bf16 v[196:199], a[36:39], v[88:91], v[196:199]
    v_mfma_f32_16x16x32_bf16 v[200:203], a[40:43], v[88:91], v[200:203]
    v_mfma_f32_16x16x32_bf16 v[204:207], a[44:47], v[88:91], v[204:207]
    v_mfma_f32_16x16x32_bf16 v[208:211], a[32:35], v[92:95], v[208:211]
    buffer_load_dwordx4 v233, s[44:47], s37 offen offset:1024 lds
    v_mfma_f32_16x16x32_bf16 v[212:215], a[36:39], v[92:95], v[212:215]
    v_mfma_f32_16x16x32_bf16 v[216:219], a[40:43], v[92:95], v[216:219]
    v_mfma_f32_16x16x32_bf16 v[220:223], a[44:47], v[92:95], v[220:223]
    s_waitcnt vmcnt(22) lgkmcnt(0)
    v_mfma_f32_16x16x32_bf16 v[96:99], a[48:51], v[64:67], v[96:99]
    ds_read_b128 v[80:83], v225 offset:24576
    v_mfma_f32_16x16x32_bf16 v[100:103], a[52:55], v[64:67], v[100:103]
    ds_read_b128 v[84:87], v225 offset:26624
    v_mfma_f32_16x16x32_bf16 v[104:107], a[56:59], v[64:67], v[104:107]
    ds_read_b128 v[88:91], v225 offset:28672
    v_mfma_f32_16x16x32_bf16 v[108:111], a[60:63], v[64:67], v[108:111]
    ds_read_b128 v[92:95], v225 offset:30720
    v_mfma_f32_16x16x32_bf16 v[112:115], a[48:51], v[68:71], v[112:115]
    ds_read_b64_tr_b16 a[64:65], v228 offset:16384
    v_mfma_f32_16x16x32_bf16 v[116:119], a[52:55], v[68:71], v[116:119]
    ds_read_b64_tr_b16 a[66:67], v228 offset:16896
    v_mfma_f32_16x16x32_bf16 v[120:123], a[56:59], v[68:71], v[120:123]
    ds_read_b64_tr_b16 a[68:69], v229 offset:16384
    v_mfma_f32_16x16x32_bf16 v[124:127], a[60:63], v[68:71], v[124:127]
    ds_read_b64_tr_b16 a[70:71], v229 offset:16896
    v_mfma_f32_16x16x32_bf16 v[128:131], a[48:51], v[72:75], v[128:131]
    s_add_u32 m0, s35, 8192
    s_and_b32 s33, s84, 1023
    s_lshl_b32 s33, s33, 12
    buffer_load_dwordx4 v234, s[48:51], s33 offen lds
    v_mfma_f32_16x16x32_bf16 v[132:135], a[52:55], v[72:75], v[132:135]
    v_mfma_f32_16x16x32_bf16 v[136:139], a[56:59], v[72:75], v[136:139]
    buffer_load_dwordx4 v235, s[48:51], s33 offen offset:1024 lds
    v_mfma_f32_16x16x32_bf16 v[140:143], a[60:63], v[72:75], v[140:143]
    v_mfma_f32_16x16x32_bf16 v[144:147], a[48:51], v[76:79], v[144:147]
    s_add_u32 m0, s35, 10240
    s_add_u32 s33, s33, 131072
    buffer_load_dwordx4 v234, s[48:51], s33 offen lds
    v_mfma_f32_16x16x32_bf16 v[148:151], a[52:55], v[76:79], v[148:151]
    v_mfma_f32_16x16x32_bf16 v[152:155], a[56:59], v[76:79], v[152:155]
    buffer_load_dwordx4 v235, s[48:51], s33 offen offset:1024 lds
    v_mfma_f32_16x16x32_bf16 v[156:159], a[60:63], v[76:79], v[156:159]
    s_waitcnt vmcnt(20) lgkmcnt(0)
    s_barrier
    v_mfma_f32_16x16x32_bf16 v[160:163], a[48:51], v[80:83], v[160:163]
    ds_read_b128 v[64:67], v224 offset:32768
    v_mfma_f32_16x16x32_bf16 v[164:167], a[52:55], v[80:83], v[164:167]
    ds_read_b128 v[68:71], v224 offset:34816
    v_mfma_f32_16x16x32_bf16 v[168:171], a[56:59], v[80:83], v[168:171]
    ds_read_b128 v[72:75], v224 offset:36864
    v_mfma_f32_16x16x32_bf16 v[172:175], a[60:63], v[80:83], v[172:175]
    ds_read_b128 v[76:79], v224 offset:38912
    v_mfma_f32_16x16x32_bf16 v[176:179], a[48:51], v[84:87], v[176:179]
    ds_read_b64_tr_b16 a[72:73], v230 offset:16384
    v_mfma_f32_16x16x32_bf16 v[180:183], a[52:55], v[84:87], v[180:183]
    ds_read_b64_tr_b16 a[74:75], v230 offset:16896
    v_mfma_f32_16x16x32_bf16 v[184:187], a[56:59], v[84:87], v[184:187]
    ds_read_b64_tr_b16 a[76:77], v231 offset:16384
    v_mfma_f32_16x16x32_bf16 v[188:191], a[60:63], v[84:87], v[188:191]
    ds_read_b64_tr_b16 a[78:79], v231 offset:16896
    v_mfma_f32_16x16x32_bf16 v[192:195], a[48:51], v[88:91], v[192:195]
    s_add_u32 m0, s34, 16384
    s_add_u32 s37, s85, 0
    buffer_load_dwordx4 v232, s[44:47], s37 offen lds
    v_mfma_f32_16x16x32_bf16 v[196:199], a[52:55], v[88:91], v[196:199]
    v_mfma_f32_16x16x32_bf16 v[200:203], a[56:59], v[88:91], v[200:203]
    v_mfma_f32_16x16x32_bf16 v[204:207], a[60:63], v[88:91], v[204:207]
    v_mfma_f32_16x16x32_bf16 v[208:211], a[48:51], v[92:95], v[208:211]
    buffer_load_dwordx4 v233, s[44:47], s37 offen offset:1024 lds
    v_mfma_f32_16x16x32_bf16 v[212:215], a[52:55], v[92:95], v[212:215]
    v_mfma_f32_16x16x32_bf16 v[216:219], a[56:59], v[92:95], v[216:219]
    v_mfma_f32_16x16x32_bf16 v[220:223], a[60:63], v[92:95], v[220:223]
    s_waitcnt lgkmcnt(0)
    v_mfma_f32_16x16x32_bf16 v[96:99], a[64:67], v[64:67], v[96:99]
    ds_read_b128 v[80:83], v224 offset:40960
    s_waitcnt vmcnt(26)
    v_mfma_f32_16x16x32_bf16 v[100:103], a[68:71], v[64:67], v[100:103]
    ds_read_b128 v[84:87], v224 offset:43008
    v_lshlrev_b32 v16, 16, v0
    v_mfma_f32_16x16x32_bf16 v[104:107], a[72:75], v[64:67], v[104:107]
    ds_read_b128 v[88:91], v224 offset:45056
    v_and_b32 v17, 0xffff0000, v0
    v_mfma_f32_16x16x32_bf16 v[108:111], a[76:79], v[64:67], v[108:111]
    ds_read_b128 v[92:95], v224 offset:47104
    v_lshlrev_b32 v18, 16, v1
    v_mfma_f32_16x16x32_bf16 v[112:115], a[64:67], v[68:71], v[112:115]
    ds_read_b64_tr_b16 a[80:81], v228 offset:20480
    v_and_b32 v19, 0xffff0000, v1
    v_mfma_f32_16x16x32_bf16 v[116:119], a[68:71], v[68:71], v[116:119]
    ds_read_b64_tr_b16 a[82:83], v228 offset:20992
    v_lshlrev_b32 v20, 16, v2
    v_mfma_f32_16x16x32_bf16 v[120:123], a[72:75], v[68:71], v[120:123]
    ds_read_b64_tr_b16 a[84:85], v229 offset:20480
    v_and_b32 v21, 0xffff0000, v2
    v_mfma_f32_16x16x32_bf16 v[124:127], a[76:79], v[68:71], v[124:127]
    ds_read_b64_tr_b16 a[86:87], v229 offset:20992
    v_lshlrev_b32 v22, 16, v3
    v_mfma_f32_16x16x32_bf16 v[128:131], a[64:67], v[72:75], v[128:131]
    s_add_u32 m0, s35, 12288
    s_add_u32 s33, s33, 131072
    buffer_load_dwordx4 v234, s[48:51], s33 offen lds
    v_mfma_f32_16x16x32_bf16 v[132:135], a[68:71], v[72:75], v[132:135]
    v_and_b32 v23, 0xffff0000, v3
    v_lshlrev_b32 v24, 16, v4
    v_mfma_f32_16x16x32_bf16 v[136:139], a[72:75], v[72:75], v[136:139]
    buffer_load_dwordx4 v235, s[48:51], s33 offen offset:1024 lds
    v_and_b32 v25, 0xffff0000, v4
    v_mfma_f32_16x16x32_bf16 v[140:143], a[76:79], v[72:75], v[140:143]
    v_lshlrev_b32 v26, 16, v5
    v_and_b32 v27, 0xffff0000, v5
    v_mfma_f32_16x16x32_bf16 v[144:147], a[64:67], v[76:79], v[144:147]
    s_add_u32 m0, s35, 14336
    s_add_u32 s33, s33, 131072
    buffer_load_dwordx4 v234, s[48:51], s33 offen lds
    v_mfma_f32_16x16x32_bf16 v[148:151], a[68:71], v[76:79], v[148:151]
    v_lshlrev_b32 v28, 16, v6
    v_and_b32 v29, 0xffff0000, v6
    v_mfma_f32_16x16x32_bf16 v[152:155], a[72:75], v[76:79], v[152:155]
    buffer_load_dwordx4 v235, s[48:51], s33 offen offset:1024 lds
    v_lshlrev_b32 v30, 16, v7
    v_mfma_f32_16x16x32_bf16 v[156:159], a[76:79], v[76:79], v[156:159]
    v_and_b32 v31, 0xffff0000, v7
    s_waitcnt lgkmcnt(0)
    v_mfma_f32_16x16x32_bf16 v[160:163], a[64:67], v[80:83], v[160:163]
    ds_read_b128 v[64:67], v225 offset:32768
    v_lshlrev_b32 v32, 16, v8
    v_mfma_f32_16x16x32_bf16 v[164:167], a[68:71], v[80:83], v[164:167]
    ds_read_b128 v[68:71], v225 offset:34816
    v_and_b32 v33, 0xffff0000, v8
    v_mfma_f32_16x16x32_bf16 v[168:171], a[72:75], v[80:83], v[168:171]
    ds_read_b128 v[72:75], v225 offset:36864
    v_lshlrev_b32 v34, 16, v9
    v_mfma_f32_16x16x32_bf16 v[172:175], a[76:79], v[80:83], v[172:175]
    ds_read_b128 v[76:79], v225 offset:38912
    v_and_b32 v35, 0xffff0000, v9
    v_mfma_f32_16x16x32_bf16 v[176:179], a[64:67], v[84:87], v[176:179]
    ds_read_b64_tr_b16 a[88:89], v230 offset:20480
    v_lshlrev_b32 v36, 16, v10
    v_mfma_f32_16x16x32_bf16 v[180:183], a[68:71], v[84:87], v[180:183]
    ds_read_b64_tr_b16 a[90:91], v230 offset:20992
    v_and_b32 v37, 0xffff0000, v10
    v_mfma_f32_16x16x32_bf16 v[184:187], a[72:75], v[84:87], v[184:187]
    ds_read_b64_tr_b16 a[92:93], v231 offset:20480
    v_lshlrev_b32 v38, 16, v11
    v_mfma_f32_16x16x32_bf16 v[188:191], a[76:79], v[84:87], v[188:191]
    ds_read_b64_tr_b16 a[94:95], v231 offset:20992
    v_and_b32 v39, 0xffff0000, v11
    v_mfma_f32_16x16x32_bf16 v[192:195], a[64:67], v[88:91], v[192:195]
    s_add_u32 m0, s34, 24576
    s_add_u32 s37, s85, 65536
    buffer_load_dwordx4 v232, s[44:47], s37 offen lds
    v_mfma_f32_16x16x32_bf16 v[196:199], a[68:71], v[88:91], v[196:199]
    v_lshlrev_b32 v40, 16, v12
    v_and_b32 v41, 0xffff0000, v12
    v_mfma_f32_16x16x32_bf16 v[200:203], a[72:75], v[88:91], v[200:203]
    v_lshlrev_b32 v42, 16, v13
    v_and_b32 v43, 0xffff0000, v13
    v_mfma_f32_16x16x32_bf16 v[204:207], a[76:79], v[88:91], v[204:207]
    v_lshlrev_b32 v44, 16, v14
    v_and_b32 v45, 0xffff0000, v14
    v_mfma_f32_16x16x32_bf16 v[208:211], a[64:67], v[92:95], v[208:211]
    buffer_load_dwordx4 v233, s[44:47], s37 offen offset:1024 lds
    v_lshlrev_b32 v46, 16, v15
    v_mfma_f32_16x16x32_bf16 v[212:215], a[68:71], v[92:95], v[212:215]
    v_and_b32 v47, 0xffff0000, v15
    v_add_f32 v52, v16, v20
    v_mfma_f32_16x16x32_bf16 v[216:219], a[72:75], v[92:95], v[216:219]
    v_add_f32 v53, v17, v21
    v_add_f32 v54, v18, v22
    v_mfma_f32_16x16x32_bf16 v[220:223], a[76:79], v[92:95], v[220:223]
    v_add_f32 v55, v19, v23
    s_waitcnt vmcnt(14) lgkmcnt(0)
    v_mfma_f32_16x16x32_bf16 v[96:99], a[80:83], v[64:67], v[96:99]
    ds_read_b128 v[80:83], v225 offset:40960
    v_add_f32 v52, v52, v24
    v_add_f32 v53, v53, v25
    v_mfma_f32_16x16x32_bf16 v[100:103], a[84:87], v[64:67], v[100:103]
    ds_read_b128 v[84:87], v225 offset:43008
    v_add_f32 v54, v54, v26
    v_mfma_f32_16x16x32_bf16 v[104:107], a[88:91], v[64:67], v[104:107]
    ds_read_b128 v[88:91], v225 offset:45056
    v_add_f32 v55, v55, v27
    v_mfma_f32_16x16x32_bf16 v[108:111], a[92:95], v[64:67], v[108:111]
    ds_read_b128 v[92:95], v225 offset:47104
    v_add_f32 v52, v52, v28
    v_mfma_f32_16x16x32_bf16 v[112:115], a[80:83], v[68:71], v[112:115]
    ds_read_b64_tr_b16 a[96:97], v228 offset:0
    v_add_f32 v53, v53, v29
    v_mfma_f32_16x16x32_bf16 v[116:119], a[84:87], v[68:71], v[116:119]
    ds_read_b64_tr_b16 a[98:99], v228 offset:512
    v_add_f32 v54, v54, v30
    v_mfma_f32_16x16x32_bf16 v[120:123], a[88:91], v[68:71], v[120:123]
    ds_read_b64_tr_b16 a[100:101], v229 offset:0
    v_add_f32 v55, v55, v31
    v_mfma_f32_16x16x32_bf16 v[124:127], a[92:95], v[68:71], v[124:127]
    ds_read_b64_tr_b16 a[102:103], v229 offset:512
    v_add_f32 v52, v52, v32
    v_mfma_f32_16x16x32_bf16 v[128:131], a[80:83], v[72:75], v[128:131]
    s_add_u32 m0, s35, 16384
    s_and_b32 s33, s85, 1023
    s_lshl_b32 s33, s33, 12
    buffer_load_dwordx4 v234, s[48:51], s33 offen lds
    v_mfma_f32_16x16x32_bf16 v[132:135], a[84:87], v[72:75], v[132:135]
    buffer_load_dwordx4 v235, s[48:51], s33 offen offset:1024 lds
    v_add_f32 v53, v53, v33
    v_mfma_f32_16x16x32_bf16 v[136:139], a[88:91], v[72:75], v[136:139]
    s_add_u32 m0, s35, 18432
    s_add_u32 s33, s33, 131072
    buffer_load_dwordx4 v234, s[48:51], s33 offen lds
    v_mfma_f32_16x16x32_bf16 v[140:143], a[92:95], v[72:75], v[140:143]
    v_add_f32 v54, v54, v34
    v_add_f32 v55, v55, v35
    v_mfma_f32_16x16x32_bf16 v[144:147], a[80:83], v[76:79], v[144:147]
    buffer_load_dwordx4 v235, s[48:51], s33 offen offset:1024 lds
    v_add_f32 v52, v52, v36
    v_mfma_f32_16x16x32_bf16 v[148:151], a[84:87], v[76:79], v[148:151]
    s_lshl2_add_u32 s26, s4, s3
    s_lshl_b32 s26, s26, 10
    s_add_u32 s26, s26, s32
    s_add_u32 s26, s26, 131072
    v_mfma_f32_16x16x32_bf16 v[152:155], a[88:91], v[76:79], v[152:155]
    v_and_b32 v226, 0x40000380, v251
    buffer_load_dword v241, v226, s[44:47], s26 offen
    v_mfma_f32_16x16x32_bf16 v[156:159], a[92:95], v[76:79], v[156:159]
    s_waitcnt vmcnt(25) lgkmcnt(0)
    s_barrier
    v_mfma_f32_16x16x32_bf16 v[160:163], a[80:83], v[80:83], v[160:163]
    ds_read_b128 v[64:67], v224 offset:49152
    v_add_f32 v53, v53, v37
    v_mfma_f32_16x16x32_bf16 v[164:167], a[84:87], v[80:83], v[164:167]
    ds_read_b128 v[68:71], v224 offset:51200
    v_add_f32 v54, v54, v38
    v_mfma_f32_16x16x32_bf16 v[168:171], a[88:91], v[80:83], v[168:171]
    ds_read_b128 v[72:75], v224 offset:53248
    v_add_f32 v55, v55, v39
    v_mfma_f32_16x16x32_bf16 v[172:175], a[92:95], v[80:83], v[172:175]
    ds_read_b128 v[76:79], v224 offset:55296
    v_add_f32 v52, v52, v40
    v_mfma_f32_16x16x32_bf16 v[176:179], a[80:83], v[84:87], v[176:179]
    ds_read_b64_tr_b16 a[104:105], v230 offset:0
    v_add_f32 v53, v53, v41
    v_mfma_f32_16x16x32_bf16 v[180:183], a[84:87], v[84:87], v[180:183]
    ds_read_b64_tr_b16 a[106:107], v230 offset:512
    v_add_f32 v54, v54, v42
    v_mfma_f32_16x16x32_bf16 v[184:187], a[88:91], v[84:87], v[184:187]
    ds_read_b64_tr_b16 a[108:109], v231 offset:0
    v_add_f32 v55, v55, v43
    v_mfma_f32_16x16x32_bf16 v[188:191], a[92:95], v[84:87], v[188:191]
    ds_read_b64_tr_b16 a[110:111], v231 offset:512
    v_add_f32 v52, v52, v44
    v_mfma_f32_16x16x32_bf16 v[192:195], a[80:83], v[88:91], v[192:195]
    s_add_u32 m0, s34, 32768
    s_add_u32 s37, s86, 0
    buffer_load_dwordx4 v232, s[44:47], s37 offen lds
    v_mfma_f32_16x16x32_bf16 v[196:199], a[84:87], v[88:91], v[196:199]
    v_add_f32 v53, v53, v45
    v_add_f32 v54, v54, v46
    v_mfma_f32_16x16x32_bf16 v[200:203], a[88:91], v[88:91], v[200:203]
    v_add_f32 v55, v55, v47
    v_add_f32 v52, v52, v53
    v_mfma_f32_16x16x32_bf16 v[204:207], a[92:95], v[88:91], v[204:207]
    v_add_f32 v54, v54, v55
    v_add_f32 v48, v52, v54
    v_mfma_f32_16x16x32_bf16 v[208:211], a[80:83], v[92:95], v[208:211]
    buffer_load_dwordx4 v233, s[44:47], s37 offen offset:1024 lds
    s_nop 1
    v_mfma_f32_16x16x32_bf16 v[212:215], a[84:87], v[92:95], v[212:215]
    v_add_f32_dpp v48, v48, v48 quad_perm:[1,0,3,2] row_mask:0xf bank_mask:0xf
    s_nop 1
    v_mfma_f32_16x16x32_bf16 v[216:219], a[88:91], v[92:95], v[216:219]
    v_add_f32_dpp v48, v48, v48 quad_perm:[2,3,0,1] row_mask:0xf bank_mask:0xf
    s_nop 1
    v_mfma_f32_16x16x32_bf16 v[220:223], a[92:95], v[92:95], v[220:223]
    v_add_f32_dpp v48, v48, v48 row_half_mirror row_mask:0xf bank_mask:0xf
    s_waitcnt lgkmcnt(0)
    v_mfma_f32_16x16x32_bf16 v[96:99], a[96:99], v[64:67], v[96:99]
    ds_read_b128 v[80:83], v224 offset:57344
    s_nop 1
    v_mfma_f32_16x16x32_bf16 v[100:103], a[100:103], v[64:67], v[100:103]
    ds_read_b128 v[84:87], v224 offset:59392
    v_add_f32_dpp v48, v48, v48 row_mirror row_mask:0xf bank_mask:0xf
    v_mfma_f32_16x16x32_bf16 v[104:107], a[104:107], v[64:67], v[104:107]
    ds_read_b128 v[88:91], v224 offset:61440
    s_nop 0
    v_mfma_f32_16x16x32_bf16 v[108:111], a[108:111], v[64:67], v[108:111]
    ds_read_b128 v[92:95], v224 offset:63488
    v_mov_b32 v49, v48
    v_mfma_f32_16x16x32_bf16 v[112:115], a[96:99], v[68:71], v[112:115]
    ds_read_b64_tr_b16 a[112:113], v228 offset:4096
    s_nop 1
    v_mfma_f32_16x16x32_bf16 v[116:119], a[100:103], v[68:71], v[116:119]
    ds_read_b64_tr_b16 a[114:115], v228 offset:4608
    v_permlane16_swap_b32 v48, v49
    v_mfma_f32_16x16x32_bf16 v[120:123], a[104:107], v[68:71], v[120:123]
    ds_read_b64_tr_b16 a[116:117], v229 offset:4096
    s_nop 0
    v_mfma_f32_16x16x32_bf16 v[124:127], a[108:111], v[68:71], v[124:127]
    ds_read_b64_tr_b16 a[118:119], v229 offset:4608
    v_add_f32 v48, v48, v49
    v_mfma_f32_16x16x32_bf16 v[128:131], a[96:99], v[72:75], v[128:131]
    s_add_u32 m0, s35, 20480
    s_add_u32 s33, s33, 131072
    buffer_load_dwordx4 v234, s[48:51], s33 offen lds
    v_mfma_f32_16x16x32_bf16 v[132:135], a[100:103], v[72:75], v[132:135]
    buffer_load_dwordx4 v235, s[48:51], s33 offen offset:1024 lds
    v_mul_f32 v48, 0x3a800000, v48
    v_mfma_f32_16x16x32_bf16 v[136:139], a[104:107], v[72:75], v[136:139]
    v_sub_f32 v56, v16, v48
    v_mul_f32 v52, v56, v56
    v_mfma_f32_16x16x32_bf16 v[140:143], a[108:111], v[72:75], v[140:143]
    s_add_u32 m0, s35, 22528
    s_add_u32 s33, s33, 131072
    buffer_load_dwordx4 v234, s[48:51], s33 offen lds
    v_mfma_f32_16x16x32_bf16 v[144:147], a[96:99], v[76:79], v[144:147]
    buffer_load_dwordx4 v235, s[48:51], s33 offen offset:1024 lds
    v_sub_f32 v57, v17, v48
    v_mfma_f32_16x16x32_bf16 v[148:151], a[100:103], v[76:79], v[148:151]
    v_mul_f32 v53, v57, v57
    v_sub_f32 v58, v18, v48
    v_mfma_f32_16x16x32_bf16 v[152:155], a[104:107], v[76:79], v[152:155]
    v_lshlrev_b32 v226, 7, v253
    s_lshl_b32 s25, s2, 15
    buffer_load_dword v241, v226, s[12:15], s25 offen
    v_mfma_f32_16x16x32_bf16 v[156:159], a[108:111], v[76:79], v[156:159]
    v_mul_f32 v54, v58, v58
    s_waitcnt lgkmcnt(0)
    v_mfma_f32_16x16x32_bf16 v[160:163], a[96:99], v[80:83], v[160:163]
    ds_read_b128 v[64:67], v225 offset:49152
    v_sub_f32 v59, v19, v48
    v_mfma_f32_16x16x32_bf16 v[164:167], a[100:103], v[80:83], v[164:167]
    ds_read_b128 v[68:71], v225 offset:51200
    v_mul_f32 v55, v59, v59
    v_mfma_f32_16x16x32_bf16 v[168:171], a[104:107], v[80:83], v[168:171]
    ds_read_b128 v[72:75], v225 offset:53248
    v_sub_f32 v56, v20, v48
    v_mfma_f32_16x16x32_bf16 v[172:175], a[108:111], v[80:83], v[172:175]
    ds_read_b128 v[76:79], v225 offset:55296
    v_fmac_f32 v52, v56, v56
    v_mfma_f32_16x16x32_bf16 v[176:179], a[96:99], v[84:87], v[176:179]
    ds_read_b64_tr_b16 a[120:121], v230 offset:4096
    v_sub_f32 v57, v21, v48
    v_mfma_f32_16x16x32_bf16 v[180:183], a[100:103], v[84:87], v[180:183]
    ds_read_b64_tr_b16 a[122:123], v230 offset:4608
    v_fmac_f32 v53, v57, v57
    v_mfma_f32_16x16x32_bf16 v[184:187], a[104:107], v[84:87], v[184:187]
    ds_read_b64_tr_b16 a[124:125], v231 offset:4096
    v_sub_f32 v58, v22, v48
    v_mfma_f32_16x16x32_bf16 v[188:191], a[108:111], v[84:87], v[188:191]
    ds_read_b64_tr_b16 a[126:127], v231 offset:4608
    v_fmac_f32 v54, v58, v58
    v_mfma_f32_16x16x32_bf16 v[192:195], a[96:99], v[88:91], v[192:195]
    s_add_u32 m0, s34, 40960
    s_add_u32 s37, s86, 65536
    buffer_load_dwordx4 v232, s[44:47], s37 offen lds
    v_mfma_f32_16x16x32_bf16 v[196:199], a[100:103], v[88:91], v[196:199]
    v_sub_f32 v59, v23, v48
    v_fmac_f32 v55, v59, v59
    v_mfma_f32_16x16x32_bf16 v[200:203], a[104:107], v[88:91], v[200:203]
    v_sub_f32 v56, v24, v48
    v_fmac_f32 v52, v56, v56
    v_mfma_f32_16x16x32_bf16 v[204:207], a[108:111], v[88:91], v[204:207]
    v_sub_f32 v57, v25, v48
    v_fmac_f32 v53, v57, v57
    v_mfma_f32_16x16x32_bf16 v[208:211], a[96:99], v[92:95], v[208:211]
    buffer_load_dwordx4 v233, s[44:47], s37 offen offset:1024 lds
    v_sub_f32 v58, v26, v48
    v_mfma_f32_16x16x32_bf16 v[212:215], a[100:103], v[92:95], v[212:215]
    v_fmac_f32 v54, v58, v58
    v_sub_f32 v59, v27, v48
    v_mfma_f32_16x16x32_bf16 v[216:219], a[104:107], v[92:95], v[216:219]
    v_fmac_f32 v55, v59, v59
    v_sub_f32 v56, v28, v48
    v_mfma_f32_16x16x32_bf16 v[220:223], a[108:111], v[92:95], v[220:223]
    v_fmac_f32 v52, v56, v56
    s_waitcnt vmcnt(16) lgkmcnt(0)
    v_mfma_f32_16x16x32_bf16 v[96:99], a[112:115], v[64:67], v[96:99]
    ds_read_b128 v[80:83], v225 offset:57344
    v_sub_f32 v57, v29, v48
    v_mfma_f32_16x16x32_bf16 v[100:103], a[116:119], v[64:67], v[100:103]
    ds_read_b128 v[84:87], v225 offset:59392
    v_fmac_f32 v53, v57, v57
    v_mfma_f32_16x16x32_bf16 v[104:107], a[120:123], v[64:67], v[104:107]
    ds_read_b128 v[88:91], v225 offset:61440
    v_sub_f32 v58, v30, v48
    v_mfma_f32_16x16x32_bf16 v[108:111], a[124:127], v[64:67], v[108:111]
    ds_read_b128 v[92:95], v225 offset:63488
    v_fmac_f32 v54, v58, v58
    v_mfma_f32_16x16x32_bf16 v[112:115], a[112:115], v[68:71], v[112:115]
    ds_read_b64_tr_b16 a[128:129], v228 offset:8192
    v_sub_f32 v59, v31, v48
    v_mfma_f32_16x16x32_bf16 v[116:119], a[116:119], v[68:71], v[116:119]
    ds_read_b64_tr_b16 a[130:131], v228 offset:8704
    v_fmac_f32 v55, v59, v59
    v_mfma_f32_16x16x32_bf16 v[120:123], a[120:123], v[68:71], v[120:123]
    ds_read_b64_tr_b16 a[132:133], v229 offset:8192
    v_sub_f32 v56, v32, v48
    v_mfma_f32_16x16x32_bf16 v[124:127], a[124:127], v[68:71], v[124:127]
    ds_read_b64_tr_b16 a[134:135], v229 offset:8704
    v_fmac_f32 v52, v56, v56
    v_mfma_f32_16x16x32_bf16 v[128:131], a[112:115], v[72:75], v[128:131]
    s_add_u32 m0, s35, 0
    s_and_b32 s33, s86, 1023
    s_lshl_b32 s33, s33, 12
    buffer_load_dwordx4 v234, s[48:51], s33 offen lds
    v_mfma_f32_16x16x32_bf16 v[132:135], a[116:119], v[72:75], v[132:135]
    v_sub_f32 v57, v33, v48
    v_fmac_f32 v53, v57, v57
    v_sub_f32 v58, v34, v48
    v_mfma_f32_16x16x32_bf16 v[136:139], a[120:123], v[72:75], v[136:139]
    buffer_load_dwordx4 v235, s[48:51], s33 offen offset:1024 lds
    v_fmac_f32 v54, v58, v58
    v_mfma_f32_16x16x32_bf16 v[140:143], a[124:127], v[72:75], v[140:143]
    v_sub_f32 v59, v35, v48
    v_fmac_f32 v55, v59, v59
    v_mfma_f32_16x16x32_bf16 v[144:147], a[112:115], v[76:79], v[144:147]
    s_add_u32 m0, s35, 2048
    s_add_u32 s33, s33, 131072
    buffer_load_dwordx4 v234, s[48:51], s33 offen lds
    v_mfma_f32_16x16x32_bf16 v[148:151], a[116:119], v[76:79], v[148:151]
    v_sub_f32 v56, v36, v48
    v_fmac_f32 v52, v56, v56
    v_mfma_f32_16x16x32_bf16 v[152:155], a[120:123], v[76:79], v[152:155]
    buffer_load_dwordx4 v235, s[48:51], s33 offen offset:1024 lds
    v_sub_f32 v57, v37, v48
    v_mfma_f32_16x16x32_bf16 v[156:159], a[124:127], v[76:79], v[156:159]
    s_waitcnt vmcnt(30) lgkmcnt(0)
    s_barrier
    v_mfma_f32_16x16x32_bf16 v[160:163], a[112:115], v[80:83], v[160:163]
    ds_read_b128 v[64:67], v224 offset:0
    v_fmac_f32 v53, v57, v57
    v_mfma_f32_16x16x32_bf16 v[164:167], a[116:119], v[80:83], v[164:167]
    ds_read_b128 v[68:71], v224 offset:2048
    v_sub_f32 v58, v38, v48
    v_mfma_f32_16x16x32_bf16 v[168:171], a[120:123], v[80:83], v[168:171]
    ds_read_b128 v[72:75], v224 offset:4096
    v_fmac_f32 v54, v58, v58
    v_mfma_f32_16x16x32_bf16 v[172:175], a[124:127], v[80:83], v[172:175]
    ds_read_b128 v[76:79], v224 offset:6144
    v_sub_f32 v59, v39, v48
    v_mfma_f32_16x16x32_bf16 v[176:179], a[112:115], v[84:87], v[176:179]
    ds_read_b64_tr_b16 a[136:137], v230 offset:8192
    v_fmac_f32 v55, v59, v59
    v_mfma_f32_16x16x32_bf16 v[180:183], a[116:119], v[84:87], v[180:183]
    ds_read_b64_tr_b16 a[138:139], v230 offset:8704
    v_sub_f32 v56, v40, v48
    v_mfma_f32_16x16x32_bf16 v[184:187], a[120:123], v[84:87], v[184:187]
    ds_read_b64_tr_b16 a[140:141], v231 offset:8192
    v_fmac_f32 v52, v56, v56
    v_mfma_f32_16x16x32_bf16 v[188:191], a[124:127], v[84:87], v[188:191]
    ds_read_b64_tr_b16 a[142:143], v231 offset:8704
    v_sub_f32 v57, v41, v48
    v_mfma_f32_16x16x32_bf16 v[192:195], a[112:115], v[88:91], v[192:195]
    s_add_u32 m0, s34, 49152
    s_add_u32 s37, s87, 0
    buffer_load_dwordx4 v232, s[44:47], s37 offen lds
    v_mfma_f32_16x16x32_bf16 v[196:199], a[116:119], v[88:91], v[196:199]
    v_fmac_f32 v53, v57, v57
    v_sub_f32 v58, v42, v48
    v_mfma_f32_16x16x32_bf16 v[200:203], a[120:123], v[88:91], v[200:203]
    v_fmac_f32 v54, v58, v58
    v_sub_f32 v59, v43, v48
    v_mfma_f32_16x16x32_bf16 v[204:207], a[124:127], v[88:91], v[204:207]
    v_fmac_f32 v55, v59, v59
    v_sub_f32 v56, v44, v48
    v_mfma_f32_16x16x32_bf16 v[208:211], a[112:115], v[92:95], v[208:211]
    buffer_load_dwordx4 v233, s[44:47], s37 offen offset:1024 lds
    v_fmac_f32 v52, v56, v56
    v_mfma_f32_16x16x32_bf16 v[212:215], a[116:119], v[92:95], v[212:215]
    v_sub_f32 v57, v45, v48
    v_fmac_f32 v53, v57, v57
    v_mfma_f32_16x16x32_bf16 v[216:219], a[120:123], v[92:95], v[216:219]
    v_sub_f32 v58, v46, v48
    v_fmac_f32 v54, v58, v58
    v_mfma_f32_16x16x32_bf16 v[220:223], a[124:127], v[92:95], v[220:223]
    v_sub_f32 v59, v47, v48
    s_waitcnt lgkmcnt(0)
    v_mfma_f32_16x16x32_bf16 v[96:99], a[128:131], v[64:67], v[96:99]
    ds_read_b128 v[80:83], v224 offset:8192
    v_fmac_f32 v55, v59, v59
    v_mfma_f32_16x16x32_bf16 v[100:103], a[132:135], v[64:67], v[100:103]
    ds_read_b128 v[84:87], v224 offset:10240
    v_add_f32 v52, v52, v53
    v_mfma_f32_16x16x32_bf16 v[104:107], a[136:139], v[64:67], v[104:107]
    ds_read_b128 v[88:91], v224 offset:12288
    v_add_f32 v54, v54, v55
    v_mfma_f32_16x16x32_bf16 v[108:111], a[140:143], v[64:67], v[108:111]
    ds_read_b128 v[92:95], v224 offset:14336
    v_add_f32 v51, v52, v54
    v_mfma_f32_16x16x32_bf16 v[112:115], a[128:131], v[68:71], v[112:115]
    ds_read_b64_tr_b16 a[144:145], v228 offset:12288
    s_nop 1
    v_mfma_f32_16x16x32_bf16 v[116:119], a[132:135], v[68:71], v[116:119]
    ds_read_b64_tr_b16 a[146:147], v228 offset:12800
    v_add_f32_dpp v51, v51, v51 quad_perm:[1,0,3,2] row_mask:0xf bank_mask:0xf
    v_mfma_f32_16x16x32_bf16 v[120:123], a[136:139], v[68:71], v[120:123]
    ds_read_b64_tr_b16 a[148:149], v229 offset:12288
    s_nop 1
    v_mfma_f32_16x16x32_bf16 v[124:127], a[140:143], v[68:71], v[124:127]
    ds_read_b64_tr_b16 a[150:151], v229 offset:12800
    v_add_f32_dpp v51, v51, v51 quad_perm:[2,3,0,1] row_mask:0xf bank_mask:0xf
    v_mfma_f32_16x16x32_bf16 v[128:131], a[128:131], v[72:75], v[128:131]
    s_add_u32 m0, s35, 4096
    s_add_u32 s33, s33, 131072
    buffer_load_dwordx4 v234, s[48:51], s33 offen lds
    v_mfma_f32_16x16x32_bf16 v[132:135], a[132:135], v[72:75], v[132:135]
    s_nop 1
    v_add_f32_dpp v51, v51, v51 row_half_mirror row_mask:0xf bank_mask:0xf
    v_mfma_f32_16x16x32_bf16 v[136:139], a[136:139], v[72:75], v[136:139]
    buffer_load_dwordx4 v235, s[48:51], s33 offen offset:1024 lds
    s_nop 1
    v_mfma_f32_16x16x32_bf16 v[140:143], a[140:143], v[72:75], v[140:143]
    v_add_f32_dpp v51, v51, v51 row_mirror row_mask:0xf bank_mask:0xf
    s_nop 0
    v_mfma_f32_16x16x32_bf16 v[144:147], a[128:131], v[76:79], v[144:147]
    s_add_u32 m0, s35, 6144
    s_add_u32 s33, s33, 131072
    buffer_load_dwordx4 v234, s[48:51], s33 offen lds
    v_mfma_f32_16x16x32_bf16 v[148:151], a[132:135], v[76:79], v[148:151]
    v_mov_b32 v49, v51
    s_nop 1
    v_mfma_f32_16x16x32_bf16 v[152:155], a[136:139], v[76:79], v[152:155]
    buffer_load_dwordx4 v235, s[48:51], s33 offen offset:1024 lds
    v_permlane16_swap_b32 v51, v49
    v_mfma_f32_16x16x32_bf16 v[156:159], a[140:143], v[76:79], v[156:159]
    s_nop 0
    s_waitcnt lgkmcnt(0)
    v_mfma_f32_16x16x32_bf16 v[160:163], a[128:131], v[80:83], v[160:163]
    ds_read_b128 v[64:67], v225 offset:0
    v_add_f32 v51, v51, v49
    v_mfma_f32_16x16x32_bf16 v[164:167], a[132:135], v[80:83], v[164:167]
    ds_read_b128 v[68:71], v225 offset:2048
    v_mul_f32 v51, 0x3a800000, v51
    v_mfma_f32_16x16x32_bf16 v[168:171], a[136:139], v[80:83], v[168:171]
    ds_read_b128 v[72:75], v225 offset:4096
    v_cvt_pk_bf16_f32 v50, v48, v51
    v_mfma_f32_16x16x32_bf16 v[172:175], a[140:143], v[80:83], v[172:175]
    ds_read_b128 v[76:79], v225 offset:6144
    v_and_b32 v51, 0xffff0000, v50
    v_mfma_f32_16x16x32_bf16 v[176:179], a[128:131], v[84:87], v[176:179]
    ds_read_b64_tr_b16 a[152:153], v230 offset:12288
    v_lshlrev_b32 v50, 16, v50
    v_mfma_f32_16x16x32_bf16 v[180:183], a[132:135], v[84:87], v[180:183]
    ds_read_b64_tr_b16 a[154:155], v230 offset:12800
    v_add_f32 v51, 0x3727c5ac, v51
    v_mfma_f32_16x16x32_bf16 v[184:187], a[136:139], v[84:87], v[184:187]
    ds_read_b64_tr_b16 a[156:157], v231 offset:12288
    v_cvt_pk_bf16_f32 v51, v51, v51
    v_mfma_f32_16x16x32_bf16 v[188:191], a[140:143], v[84:87], v[188:191]
    ds_read_b64_tr_b16 a[158:159], v231 offset:12800
    v_lshlrev_b32 v51, 16, v51
    v_mfma_f32_16x16x32_bf16 v[192:195], a[128:131], v[88:91], v[192:195]
    s_add_u32 m0, s34, 57344
    s_add_u32 s37, s87, 65536
    buffer_load_dwordx4 v232, s[44:47], s37 offen lds
    v_mfma_f32_16x16x32_bf16 v[196:199], a[132:135], v[88:91], v[196:199]
    v_sqrt_f32 v51, v51
    v_mfma_f32_16x16x32_bf16 v[200:203], a[136:139], v[88:91], v[200:203]
    s_nop 0
    v_cvt_pk_bf16_f32 v51, v51, v51
    v_mfma_f32_16x16x32_bf16 v[204:207], a[140:143], v[88:91], v[204:207]
    v_lshlrev_b32 v51, 16, v51
    v_rcp_f32 v51, v51
    v_mfma_f32_16x16x32_bf16 v[208:211], a[128:131], v[92:95], v[208:211]
    buffer_load_dwordx4 v233, s[44:47], s37 offen offset:1024 lds
    v_mfma_f32_16x16x32_bf16 v[212:215], a[132:135], v[92:95], v[212:215]
    s_nop 0
    v_mul_f32 v51, 0x3e0293ee, v51
    v_mfma_f32_16x16x32_bf16 v[216:219], a[136:139], v[92:95], v[216:219]
    v_sub_f32 v16, v16, v50
    v_sub_f32 v17, v17, v50
    v_mfma_f32_16x16x32_bf16 v[220:223], a[140:143], v[92:95], v[220:223]
    v_cvt_pk_bf16_f32 v17, v16, v17
    s_waitcnt vmcnt(15) lgkmcnt(0)
    v_mfma_f32_16x16x32_bf16 v[96:99], a[144:147], v[64:67], v[96:99]
    ds_read_b128 v[80:83], v225 offset:8192
    v_lshlrev_b32 v16, 16, v17
    v_mfma_f32_16x16x32_bf16 v[100:103], a[148:151], v[64:67], v[100:103]
    ds_read_b128 v[84:87], v225 offset:10240
    v_and_b32 v17, 0xffff0000, v17
    v_mfma_f32_16x16x32_bf16 v[104:107], a[152:155], v[64:67], v[104:107]
    ds_read_b128 v[88:91], v225 offset:12288
    v_mul_f32 v16, v16, v51
    v_mfma_f32_16x16x32_bf16 v[108:111], a[156:159], v[64:67], v[108:111]
    ds_read_b128 v[92:95], v225 offset:14336
    v_mul_f32 v17, v17, v51
    v_mfma_f32_16x16x32_bf16 v[112:115], a[144:147], v[68:71], v[112:115]
    ds_read_b64_tr_b16 a[160:161], v228 offset:16384
    v_cvt_pk_bf16_f32 v0, v16, v17
    v_mfma_f32_16x16x32_bf16 v[116:119], a[148:151], v[68:71], v[116:119]
    ds_read_b64_tr_b16 a[162:163], v228 offset:16896
    v_sub_f32 v18, v18, v50
    v_mfma_f32_16x16x32_bf16 v[120:123], a[152:155], v[68:71], v[120:123]
    ds_read_b64_tr_b16 a[164:165], v229 offset:16384
    v_sub_f32 v19, v19, v50
    v_mfma_f32_16x16x32_bf16 v[124:127], a[156:159], v[68:71], v[124:127]
    ds_read_b64_tr_b16 a[166:167], v229 offset:16896
    v_cvt_pk_bf16_f32 v19, v18, v19
    v_mfma_f32_16x16x32_bf16 v[128:131], a[144:147], v[72:75], v[128:131]
    s_add_u32 m0, s35, 8192
    s_and_b32 s33, s87, 1023
    s_lshl_b32 s33, s33, 12
    buffer_load_dwordx4 v234, s[48:51], s33 offen lds
    v_mfma_f32_16x16x32_bf16 v[132:135], a[148:151], v[72:75], v[132:135]
    v_lshlrev_b32 v18, 16, v19
    v_and_b32 v19, 0xffff0000, v19
    v_mfma_f32_16x16x32_bf16 v[136:139], a[152:155], v[72:75], v[136:139]
    buffer_load_dwordx4 v235, s[48:51], s33 offen offset:1024 lds
    v_mul_f32 v18, v18, v51
    v_mul_f32 v19, v19, v51
    v_mfma_f32_16x16x32_bf16 v[140:143], a[156:159], v[72:75], v[140:143]
    v_cvt_pk_bf16_f32 v1, v18, v19
    v_sub_f32 v20, v20, v50
    v_mfma_f32_16x16x32_bf16 v[144:147], a[144:147], v[76:79], v[144:147]
    s_add_u32 m0, s35, 10240
    s_add_u32 s33, s33, 131072
    buffer_load_dwordx4 v234, s[48:51], s33 offen lds
    v_mfma_f32_16x16x32_bf16 v[148:151], a[148:151], v[76:79], v[148:151]
    v_sub_f32 v21, v21, v50
    v_cvt_pk_bf16_f32 v21, v20, v21
    v_mfma_f32_16x16x32_bf16 v[152:155], a[152:155], v[76:79], v[152:155]
    buffer_load_dwordx4 v235, s[48:51], s33 offen offset:1024 lds
    v_lshlrev_b32 v20, 16, v21
    v_mfma_f32_16x16x32_bf16 v[156:159], a[156:159], v[76:79], v[156:159]
    s_waitcnt vmcnt(30) lgkmcnt(0)
    s_barrier
    v_mfma_f32_16x16x32_bf16 v[160:163], a[144:147], v[80:83], v[160:163]
    ds_read_b128 v[64:67], v224 offset:16384
    v_and_b32 v21, 0xffff0000, v21
    v_mfma_f32_16x16x32_bf16 v[164:167], a[148:151], v[80:83], v[164:167]
    ds_read_b128 v[68:71], v224 offset:18432
    v_mul_f32 v20, v20, v51
    v_mfma_f32_16x16x32_bf16 v[168:171], a[152:155], v[80:83], v[168:171]
    ds_read_b128 v[72:75], v224 offset:20480
    v_mul_f32 v21, v21, v51
    v_mfma_f32_16x16x32_bf16 v[172:175], a[156:159], v[80:83], v[172:175]
    ds_read_b128 v[76:79], v224 offset:22528
    v_cvt_pk_bf16_f32 v2, v20, v21
    v_mfma_f32_16x16x32_bf16 v[176:179], a[144:147], v[84:87], v[176:179]
    ds_read_b64_tr_b16 a[168:169], v230 offset:16384
    v_sub_f32 v22, v22, v50
    v_mfma_f32_16x16x32_bf16 v[180:183], a[148:151], v[84:87], v[180:183]
    ds_read_b64_tr_b16 a[170:171], v230 offset:16896
    v_sub_f32 v23, v23, v50
    v_mfma_f32_16x16x32_bf16 v[184:187], a[152:155], v[84:87], v[184:187]
    ds_read_b64_tr_b16 a[172:173], v231 offset:16384
    v_cvt_pk_bf16_f32 v23, v22, v23
    v_mfma_f32_16x16x32_bf16 v[188:191], a[156:159], v[84:87], v[188:191]
    ds_read_b64_tr_b16 a[174:175], v231 offset:16896
    v_lshlrev_b32 v22, 16, v23
    v_mfma_f32_16x16x32_bf16 v[192:195], a[144:147], v[88:91], v[192:195]
    s_add_u32 m0, s34, 0
    s_add_u32 s37, s80, 131072
    buffer_load_dwordx4 v232, s[44:47], s37 offen lds
    v_mfma_f32_16x16x32_bf16 v[196:199], a[148:151], v[88:91], v[196:199]
    v_and_b32 v23, 0xffff0000, v23
    v_mul_f32 v22, v22, v51
    v_mfma_f32_16x16x32_bf16 v[200:203], a[152:155], v[88:91], v[200:203]
    v_mul_f32 v23, v23, v51
    v_cvt_pk_bf16_f32 v3, v22, v23
    v_mfma_f32_16x16x32_bf16 v[204:207], a[156:159], v[88:91], v[204:207]
    v_sub_f32 v24, v24, v50
    v_sub_f32 v25, v25, v50
    v_mfma_f32_16x16x32_bf16 v[208:211], a[144:147], v[92:95], v[208:211]
    buffer_load_dwordx4 v233, s[44:47], s37 offen offset:1024 lds
    v_cvt_pk_bf16_f32 v25, v24, v25
    v_mfma_f32_16x16x32_bf16 v[212:215], a[148:151], v[92:95], v[212:215]
    v_lshlrev_b32 v24, 16, v25
    v_and_b32 v25, 0xffff0000, v25
    v_mfma_f32_16x16x32_bf16 v[216:219], a[152:155], v[92:95], v[216:219]
    v_mul_f32 v24, v24, v51
    v_mul_f32 v25, v25, v51
    v_mfma_f32_16x16x32_bf16 v[220:223], a[156:159], v[92:95], v[220:223]
    v_cvt_pk_bf16_f32 v4, v24, v25
    s_waitcnt lgkmcnt(0)
    v_mfma_f32_16x16x32_bf16 v[96:99], a[160:163], v[64:67], v[96:99]
    ds_read_b128 v[80:83], v224 offset:24576
    v_sub_f32 v26, v26, v50
    v_mfma_f32_16x16x32_bf16 v[100:103], a[164:167], v[64:67], v[100:103]
    ds_read_b128 v[84:87], v224 offset:26624
    v_sub_f32 v27, v27, v50
    v_mfma_f32_16x16x32_bf16 v[104:107], a[168:171], v[64:67], v[104:107]
    ds_read_b128 v[88:91], v224 offset:28672
    v_cvt_pk_bf16_f32 v27, v26, v27
    v_mfma_f32_16x16x32_bf16 v[108:111], a[172:175], v[64:67], v[108:111]
    ds_read_b128 v[92:95], v224 offset:30720
    v_lshlrev_b32 v26, 16, v27
    v_mfma_f32_16x16x32_bf16 v[112:115], a[160:163], v[68:71], v[112:115]
    ds_read_b64_tr_b16 a[176:177], v228 offset:20480
    v_and_b32 v27, 0xffff0000, v27
    v_mfma_f32_16x16x32_bf16 v[116:119], a[164:167], v[68:71], v[116:119]
    ds_read_b64_tr_b16 a[178:179], v228 offset:20992
    v_mul_f32 v26, v26, v51
    v_mfma_f32_16x16x32_bf16 v[120:123], a[168:171], v[68:71], v[120:123]
    ds_read_b64_tr_b16 a[180:181], v229 offset:20480
    v_mul_f32 v27, v27, v51
    v_mfma_f32_16x16x32_bf16 v[124:127], a[172:175], v[68:71], v[124:127]
    ds_read_b64_tr_b16 a[182:183], v229 offset:20992
    v_cvt_pk_bf16_f32 v5, v26, v27
    v_mfma_f32_16x16x32_bf16 v[128:131], a[160:163], v[72:75], v[128:131]
    s_add_u32 m0, s35, 12288
    s_add_u32 s33, s33, 131072
    buffer_load_dwordx4 v234, s[48:51], s33 offen lds
    v_mfma_f32_16x16x32_bf16 v[132:135], a[164:167], v[72:75], v[132:135]
    v_sub_f32 v28, v28, v50
    v_sub_f32 v29, v29, v50
    v_mfma_f32_16x16x32_bf16 v[136:139], a[168:171], v[72:75], v[136:139]
    buffer_load_dwordx4 v235, s[48:51], s33 offen offset:1024 lds
    v_cvt_pk_bf16_f32 v29, v28, v29
    v_mfma_f32_16x16x32_bf16 v[140:143], a[172:175], v[72:75], v[140:143]
    v_lshlrev_b32 v28, 16, v29
    v_and_b32 v29, 0xffff0000, v29
    v_mfma_f32_16x16x32_bf16 v[144:147], a[160:163], v[76:79], v[144:147]
    s_add_u32 m0, s35, 14336
    s_add_u32 s33, s33, 131072
    buffer_load_dwordx4 v234, s[48:51], s33 offen lds
    v_mfma_f32_16x16x32_bf16 v[148:151], a[164:167], v[76:79], v[148:151]
    v_mul_f32 v28, v28, v51
    v_mul_f32 v29, v29, v51
    v_mfma_f32_16x16x32_bf16 v[152:155], a[168:171], v[76:79], v[152:155]
    buffer_load_dwordx4 v235, s[48:51], s33 offen offset:1024 lds
    v_cvt_pk_bf16_f32 v6, v28, v29
    v_mfma_f32_16x16x32_bf16 v[156:159], a[172:175], v[76:79], v[156:159]
    v_sub_f32 v30, v30, v50
    s_waitcnt lgkmcnt(0)
    v_mfma_f32_16x16x32_bf16 v[160:163], a[160:163], v[80:83], v[160:163]
    ds_read_b128 v[64:67], v225 offset:16384
    v_sub_f32 v31, v31, v50
    v_mfma_f32_16x16x32_bf16 v[164:167], a[164:167], v[80:83], v[164:167]
    ds_read_b128 v[68:71], v225 offset:18432
    v_cvt_pk_bf16_f32 v31, v30, v31
    v_mfma_f32_16x16x32_bf16 v[168:171], a[168:171], v[80:83], v[168:171]
    ds_read_b128 v[72:75], v225 offset:20480
    v_lshlrev_b32 v30, 16, v31
    v_mfma_f32_16x16x32_bf16 v[172:175], a[172:175], v[80:83], v[172:175]
    ds_read_b128 v[76:79], v225 offset:22528
    v_and_b32 v31, 0xffff0000, v31
    v_mfma_f32_16x16x32_bf16 v[176:179], a[160:163], v[84:87], v[176:179]
    ds_read_b64_tr_b16 a[184:185], v230 offset:20480
    v_mul_f32 v30, v30, v51
    v_mfma_f32_16x16x32_bf16 v[180:183], a[164:167], v[84:87], v[180:183]
    ds_read_b64_tr_b16 a[186:187], v230 offset:20992
    v_mul_f32 v31, v31, v51
    v_mfma_f32_16x16x32_bf16 v[184:187], a[168:171], v[84:87], v[184:187]
    ds_read_b64_tr_b16 a[188:189], v231 offset:20480
    v_cvt_pk_bf16_f32 v7, v30, v31
    v_mfma_f32_16x16x32_bf16 v[188:191], a[172:175], v[84:87], v[188:191]
    ds_read_b64_tr_b16 a[190:191], v231 offset:20992
    v_sub_f32 v32, v32, v50
    v_mfma_f32_16x16x32_bf16 v[192:195], a[160:163], v[88:91], v[192:195]
    s_add_u32 m0, s34, 8192
    s_add_u32 s37, s81, 131072
    buffer_load_dwordx4 v232, s[44:47], s37 offen lds
    v_mfma_f32_16x16x32_bf16 v[196:199], a[164:167], v[88:91], v[196:199]
    v_sub_f32 v33, v33, v50
    v_cvt_pk_bf16_f32 v33, v32, v33
    v_mfma_f32_16x16x32_bf16 v[200:203], a[168:171], v[88:91], v[200:203]
    v_lshlrev_b32 v32, 16, v33
    v_and_b32 v33, 0xffff0000, v33
    v_mfma_f32_16x16x32_bf16 v[204:207], a[172:175], v[88:91], v[204:207]
    v_mul_f32 v32, v32, v51
    v_mul_f32 v33, v33, v51
    v_mfma_f32_16x16x32_bf16 v[208:211], a[160:163], v[92:95], v[208:211]
    buffer_load_dwordx4 v233, s[44:47], s37 offen offset:1024 lds
    v_cvt_pk_bf16_f32 v8, v32, v33
    v_mfma_f32_16x16x32_bf16 v[212:215], a[164:167], v[92:95], v[212:215]
    v_sub_f32 v34, v34, v50
    v_sub_f32 v35, v35, v50
    v_mfma_f32_16x16x32_bf16 v[216:219], a[168:171], v[92:95], v[216:219]
    v_cvt_pk_bf16_f32 v35, v34, v35
    v_lshlrev_b32 v34, 16, v35
    v_mfma_f32_16x16x32_bf16 v[220:223], a[172:175], v[92:95], v[220:223]
    v_and_b32 v35, 0xffff0000, v35
    s_waitcnt vmcnt(14) lgkmcnt(0)
    v_mfma_f32_16x16x32_bf16 v[96:99], a[176:179], v[64:67], v[96:99]
    ds_read_b128 v[80:83], v225 offset:24576
    v_mul_f32 v34, v34, v51
    v_mfma_f32_16x16x32_bf16 v[100:103], a[180:183], v[64:67], v[100:103]
    ds_read_b128 v[84:87], v225 offset:26624
    v_mul_f32 v35, v35, v51
    v_mfma_f32_16x16x32_bf16 v[104:107], a[184:187], v[64:67], v[104:107]
    ds_read_b128 v[88:91], v225 offset:28672
    v_cvt_pk_bf16_f32 v9, v34, v35
    v_mfma_f32_16x16x32_bf16 v[108:111], a[188:191], v[64:67], v[108:111]
    ds_read_b128 v[92:95], v225 offset:30720
    v_sub_f32 v36, v36, v50
    v_mfma_f32_16x16x32_bf16 v[112:115], a[176:179], v[68:71], v[112:115]
    ds_read_b64_tr_b16 a[192:193], v228 offset:0
    v_sub_f32 v37, v37, v50
    v_mfma_f32_16x16x32_bf16 v[116:119], a[180:183], v[68:71], v[116:119]
    ds_read_b64_tr_b16 a[194:195], v228 offset:512
    v_cvt_pk_bf16_f32 v37, v36, v37
    v_mfma_f32_16x16x32_bf16 v[120:123], a[184:187], v[68:71], v[120:123]
    ds_read_b64_tr_b16 a[196:197], v229 offset:0
    v_lshlrev_b32 v36, 16, v37
    v_mfma_f32_16x16x32_bf16 v[124:127], a[188:191], v[68:71], v[124:127]
    ds_read_b64_tr_b16 a[198:199], v229 offset:512
    v_and_b32 v37, 0xffff0000, v37
    v_mfma_f32_16x16x32_bf16 v[128:131], a[176:179], v[72:75], v[128:131]
    v_mul_f32 v36, v36, v51
    v_mul_f32 v37, v37, v51
    v_mfma_f32_16x16x32_bf16 v[132:135], a[180:183], v[72:75], v[132:135]
    v_cvt_pk_bf16_f32 v10, v36, v37
    v_sub_f32 v38, v38, v50
    v_mfma_f32_16x16x32_bf16 v[136:139], a[184:187], v[72:75], v[136:139]
    v_sub_f32 v39, v39, v50
    v_cvt_pk_bf16_f32 v39, v38, v39
    v_lshlrev_b32 v38, 16, v39
    v_mfma_f32_16x16x32_bf16 v[140:143], a[188:191], v[72:75], v[140:143]
    v_and_b32 v39, 0xffff0000, v39
    v_mul_f32 v38, v38, v51
    v_mfma_f32_16x16x32_bf16 v[144:147], a[176:179], v[76:79], v[144:147]
    v_mul_f32 v39, v39, v51
    v_cvt_pk_bf16_f32 v11, v38, v39
    v_mfma_f32_16x16x32_bf16 v[148:151], a[180:183], v[76:79], v[148:151]
    v_sub_f32 v40, v40, v50
    v_sub_f32 v41, v41, v50
    v_mfma_f32_16x16x32_bf16 v[152:155], a[184:187], v[76:79], v[152:155]
    v_cvt_pk_bf16_f32 v41, v40, v41
    v_lshlrev_b32 v40, 16, v41
    v_mfma_f32_16x16x32_bf16 v[156:159], a[188:191], v[76:79], v[156:159]
    s_waitcnt vmcnt(24) lgkmcnt(0)
    s_barrier
    v_mfma_f32_16x16x32_bf16 v[160:163], a[176:179], v[80:83], v[160:163]
    ds_read_b128 v[64:67], v224 offset:32768
    v_and_b32 v41, 0xffff0000, v41
    v_mfma_f32_16x16x32_bf16 v[164:167], a[180:183], v[80:83], v[164:167]
    ds_read_b128 v[68:71], v224 offset:34816
    v_mul_f32 v40, v40, v51
    v_mfma_f32_16x16x32_bf16 v[168:171], a[184:187], v[80:83], v[168:171]
    ds_read_b128 v[72:75], v224 offset:36864
    v_mul_f32 v41, v41, v51
    v_mfma_f32_16x16x32_bf16 v[172:175], a[188:191], v[80:83], v[172:175]
    ds_read_b128 v[76:79], v224 offset:38912
    v_cvt_pk_bf16_f32 v12, v40, v41
    v_mfma_f32_16x16x32_bf16 v[176:179], a[176:179], v[84:87], v[176:179]
    ds_read_b64_tr_b16 a[200:201], v230 offset:0
    v_sub_f32 v42, v42, v50
    v_mfma_f32_16x16x32_bf16 v[180:183], a[180:183], v[84:87], v[180:183]
    ds_read_b64_tr_b16 a[202:203], v230 offset:512
    v_sub_f32 v43, v43, v50
    v_mfma_f32_16x16x32_bf16 v[184:187], a[184:187], v[84:87], v[184:187]
    ds_read_b64_tr_b16 a[204:205], v231 offset:0
    v_cvt_pk_bf16_f32 v43, v42, v43
    v_mfma_f32_16x16x32_bf16 v[188:191], a[188:191], v[84:87], v[188:191]
    ds_read_b64_tr_b16 a[206:207], v231 offset:512
    v_lshlrev_b32 v42, 16, v43
    v_mfma_f32_16x16x32_bf16 v[192:195], a[176:179], v[88:91], v[192:195]
    s_add_u32 m0, s34, 16384
    s_add_u32 s37, s82, 131072
    buffer_load_dwordx4 v232, s[44:47], s37 offen lds
    v_mfma_f32_16x16x32_bf16 v[196:199], a[180:183], v[88:91], v[196:199]
    v_and_b32 v43, 0xffff0000, v43
    v_mul_f32 v42, v42, v51
    v_mfma_f32_16x16x32_bf16 v[200:203], a[184:187], v[88:91], v[200:203]
    v_mul_f32 v43, v43, v51
    v_cvt_pk_bf16_f32 v13, v42, v43
    v_mfma_f32_16x16x32_bf16 v[204:207], a[188:191], v[88:91], v[204:207]
    v_sub_f32 v44, v44, v50
    v_sub_f32 v45, v45, v50
    v_mfma_f32_16x16x32_bf16 v[208:211], a[176:179], v[92:95], v[208:211]
    buffer_load_dwordx4 v233, s[44:47], s37 offen offset:1024 lds
    v_cvt_pk_bf16_f32 v45, v44, v45
    v_mfma_f32_16x16x32_bf16 v[212:215], a[180:183], v[92:95], v[212:215]
    v_lshlrev_b32 v44, 16, v45
    v_and_b32 v45, 0xffff0000, v45
    v_mfma_f32_16x16x32_bf16 v[216:219], a[184:187], v[92:95], v[216:219]
    v_mul_f32 v44, v44, v51
    v_mul_f32 v45, v45, v51
    v_mfma_f32_16x16x32_bf16 v[220:223], a[188:191], v[92:95], v[220:223]
    v_cvt_pk_bf16_f32 v14, v44, v45
    s_waitcnt lgkmcnt(0)
    v_mfma_f32_16x16x32_bf16 v[96:99], a[192:195], v[64:67], v[96:99]
    ds_read_b128 v[80:83], v224 offset:40960
    v_sub_f32 v46, v46, v50
    v_mfma_f32_16x16x32_bf16 v[100:103], a[196:199], v[64:67], v[100:103]
    ds_read_b128 v[84:87], v224 offset:43008
    v_sub_f32 v47, v47, v50
    v_mfma_f32_16x16x32_bf16 v[104:107], a[200:203], v[64:67], v[104:107]
    ds_read_b128 v[88:91], v224 offset:45056
    v_cvt_pk_bf16_f32 v47, v46, v47
    v_mfma_f32_16x16x32_bf16 v[108:111], a[204:207], v[64:67], v[108:111]
    ds_read_b128 v[92:95], v224 offset:47104
    v_lshlrev_b32 v46, 16, v47
    v_mfma_f32_16x16x32_bf16 v[112:115], a[192:195], v[68:71], v[112:115]
    ds_read_b64_tr_b16 a[208:209], v228 offset:4096
    v_and_b32 v47, 0xffff0000, v47
    v_mfma_f32_16x16x32_bf16 v[116:119], a[196:199], v[68:71], v[116:119]
    ds_read_b64_tr_b16 a[210:211], v228 offset:4608
    v_mul_f32 v46, v46, v51
    v_mfma_f32_16x16x32_bf16 v[120:123], a[200:203], v[68:71], v[120:123]
    ds_read_b64_tr_b16 a[212:213], v229 offset:4096
    v_mul_f32 v47, v47, v51
    v_mfma_f32_16x16x32_bf16 v[124:127], a[204:207], v[68:71], v[124:127]
    ds_read_b64_tr_b16 a[214:215], v229 offset:4608
    v_cvt_pk_bf16_f32 v15, v46, v47
    v_mfma_f32_16x16x32_bf16 v[128:131], a[192:195], v[72:75], v[128:131]
    v_mfma_f32_16x16x32_bf16 v[132:135], a[196:199], v[72:75], v[132:135]
    ds_write_b128 v237, v[0:3] offset:0
    v_mfma_f32_16x16x32_bf16 v[136:139], a[200:203], v[72:75], v[136:139]
    ds_write_b128 v237, v[4:7] offset:4096
    v_mfma_f32_16x16x32_bf16 v[140:143], a[204:207], v[72:75], v[140:143]
    ds_write_b128 v237, v[8:11] offset:24576
    v_mfma_f32_16x16x32_bf16 v[144:147], a[192:195], v[76:79], v[144:147]
    ds_write_b128 v237, v[12:15] offset:28672
    v_mfma_f32_16x16x32_bf16 v[148:151], a[196:199], v[76:79], v[148:151]
    v_mfma_f32_16x16x32_bf16 v[152:155], a[200:203], v[76:79], v[152:155]
    v_mfma_f32_16x16x32_bf16 v[156:159], a[204:207], v[76:79], v[156:159]
    s_waitcnt lgkmcnt(0)
    v_mfma_f32_16x16x32_bf16 v[160:163], a[192:195], v[80:83], v[160:163]
    ds_read_b128 v[64:67], v225 offset:32768
    v_mfma_f32_16x16x32_bf16 v[164:167], a[196:199], v[80:83], v[164:167]
    ds_read_b128 v[68:71], v225 offset:34816
    v_mfma_f32_16x16x32_bf16 v[168:171], a[200:203], v[80:83], v[168:171]
    ds_read_b128 v[72:75], v225 offset:36864
    v_mfma_f32_16x16x32_bf16 v[172:175], a[204:207], v[80:83], v[172:175]
    ds_read_b128 v[76:79], v225 offset:38912
    v_mfma_f32_16x16x32_bf16 v[176:179], a[192:195], v[84:87], v[176:179]
    ds_read_b64_tr_b16 a[216:217], v230 offset:4096
    v_mfma_f32_16x16x32_bf16 v[180:183], a[196:199], v[84:87], v[180:183]
    ds_read_b64_tr_b16 a[218:219], v230 offset:4608
    v_mfma_f32_16x16x32_bf16 v[184:187], a[200:203], v[84:87], v[184:187]
    ds_read_b64_tr_b16 a[220:221], v231 offset:4096
    v_mfma_f32_16x16x32_bf16 v[188:191], a[204:207], v[84:87], v[188:191]
    ds_read_b64_tr_b16 a[222:223], v231 offset:4608
    v_mfma_f32_16x16x32_bf16 v[192:195], a[192:195], v[88:91], v[192:195]
    s_add_u32 m0, s34, 24576
    s_add_u32 s37, s83, 131072
    buffer_load_dwordx4 v232, s[44:47], s37 offen lds
    v_mfma_f32_16x16x32_bf16 v[196:199], a[196:199], v[88:91], v[196:199]
    v_mfma_f32_16x16x32_bf16 v[200:203], a[200:203], v[88:91], v[200:203]
    buffer_load_dwordx4 v233, s[44:47], s37 offen offset:1024 lds
    v_mfma_f32_16x16x32_bf16 v[204:207], a[204:207], v[88:91], v[204:207]
    v_mfma_f32_16x16x32_bf16 v[208:211], a[192:195], v[92:95], v[208:211]
    v_mfma_f32_16x16x32_bf16 v[212:215], a[196:199], v[92:95], v[212:215]
    buffer_load_dword v254, off, s[88:91], s97 sc1
    v_mfma_f32_16x16x32_bf16 v[216:219], a[200:203], v[92:95], v[216:219]
    v_mfma_f32_16x16x32_bf16 v[220:223], a[204:207], v[92:95], v[220:223]
    s_waitcnt vmcnt(7) lgkmcnt(0)
    v_mfma_f32_16x16x32_bf16 v[96:99], a[208:211], v[64:67], v[96:99]
    ds_read_b128 v[80:83], v225 offset:40960
    v_mfma_f32_16x16x32_bf16 v[100:103], a[212:215], v[64:67], v[100:103]
    ds_read_b128 v[84:87], v225 offset:43008
    s_mul_i32 s38, s2, 100
    v_mfma_f32_16x16x32_bf16 v[104:107], a[216:219], v[64:67], v[104:107]
    ds_read_b128 v[88:91], v225 offset:45056
    v_mfma_f32_16x16x32_bf16 v[108:111], a[220:223], v[64:67], v[108:111]
    ds_read_b128 v[92:95], v225 offset:47104
    v_mfma_f32_16x16x32_bf16 v[112:115], a[208:211], v[68:71], v[112:115]
    ds_read_b64_tr_b16 a[224:225], v228 offset:8192
    v_lshl_add_u32 v60, v253, 2, s38
    v_mfma_f32_16x16x32_bf16 v[116:119], a[212:215], v[68:71], v[116:119]
    ds_read_b64_tr_b16 a[226:227], v228 offset:8704
    v_mfma_f32_16x16x32_bf16 v[120:123], a[216:219], v[68:71], v[120:123]
    ds_read_b64_tr_b16 a[228:229], v229 offset:8192
    v_mfma_f32_16x16x32_bf16 v[124:127], a[220:223], v[68:71], v[124:127]
    ds_read_b64_tr_b16 a[230:231], v229 offset:8704
    v_cmp_gt_u32 vcc, 25, v253
    v_mfma_f32_16x16x32_bf16 v[128:131], a[208:211], v[72:75], v[128:131]
    v_mov_b32 v61, 0
    v_mfma_f32_16x16x32_bf16 v[132:135], a[212:215], v[72:75], v[132:135]
    v_mfma_f32_16x16x32_bf16 v[136:139], a[216:219], v[72:75], v[136:139]
    v_mov_b32 v62, 0x7ffffff0
    v_mfma_f32_16x16x32_bf16 v[140:143], a[220:223], v[72:75], v[140:143]
    v_cndmask_b32 v60, v62, v60, vcc
    v_mfma_f32_16x16x32_bf16 v[144:147], a[208:211], v[76:79], v[144:147]
    v_mfma_f32_16x16x32_bf16 v[148:151], a[212:215], v[76:79], v[148:151]
    buffer_store_dword v61, v60, s[56:59], 0 offen sc1
    v_mfma_f32_16x16x32_bf16 v[152:155], a[216:219], v[76:79], v[152:155]
    v_mfma_f32_16x16x32_bf16 v[156:159], a[220:223], v[76:79], v[156:159]
    s_waitcnt vmcnt(18) lgkmcnt(0)
    s_barrier
    v_mfma_f32_16x16x32_bf16 v[160:163], a[208:211], v[80:83], v[160:163]
    ds_read_b128 v[64:67], v224 offset:49152
    v_mfma_f32_16x16x32_bf16 v[164:167], a[212:215], v[80:83], v[164:167]
    ds_read_b128 v[68:71], v224 offset:51200
    v_mfma_f32_16x16x32_bf16 v[168:171], a[216:219], v[80:83], v[168:171]
    ds_read_b128 v[72:75], v224 offset:53248
    v_mfma_f32_16x16x32_bf16 v[172:175], a[220:223], v[80:83], v[172:175]
    ds_read_b128 v[76:79], v224 offset:55296
    v_mfma_f32_16x16x32_bf16 v[176:179], a[208:211], v[84:87], v[176:179]
    ds_read_b64_tr_b16 a[232:233], v230 offset:8192
    v_mfma_f32_16x16x32_bf16 v[180:183], a[212:215], v[84:87], v[180:183]
    ds_read_b64_tr_b16 a[234:235], v230 offset:8704
    v_mfma_f32_16x16x32_bf16 v[184:187], a[216:219], v[84:87], v[184:187]
    ds_read_b64_tr_b16 a[236:237], v231 offset:8192
    v_mfma_f32_16x16x32_bf16 v[188:191], a[220:223], v[84:87], v[188:191]
    ds_read_b64_tr_b16 a[238:239], v231 offset:8704
    v_mfma_f32_16x16x32_bf16 v[192:195], a[208:211], v[88:91], v[192:195]
    v_lshlrev_b32 v237, 4, v253
    v_add_u32 v237, 81920, v237
    ds_read_b128 v[16:19], v237 offset:0
    ds_read_b128 v[20:23], v237 offset:4096
    ds_read_b128 v[24:27], v237 offset:24576
    ds_read_b128 v[28:31], v237 offset:28672
    s_add_u32 m0, s34, 32768
    s_add_u32 s37, s84, 131072
    buffer_load_dwordx4 v232, s[44:47], s37 offen lds
    v_mfma_f32_16x16x32_bf16 v[196:199], a[212:215], v[88:91], v[196:199]
    v_mfma_f32_16x16x32_bf16 v[200:203], a[216:219], v[88:91], v[200:203]
    v_mfma_f32_16x16x32_bf16 v[204:207], a[220:223], v[88:91], v[204:207]
    v_mfma_f32_16x16x32_bf16 v[208:211], a[208:211], v[92:95], v[208:211]
    buffer_load_dwordx4 v233, s[44:47], s37 offen offset:1024 lds
    v_mfma_f32_16x16x32_bf16 v[212:215], a[212:215], v[92:95], v[212:215]
    v_mfma_f32_16x16x32_bf16 v[216:219], a[216:219], v[92:95], v[216:219]
    v_mfma_f32_16x16x32_bf16 v[220:223], a[220:223], v[92:95], v[220:223]
    s_waitcnt lgkmcnt(0)
    v_mfma_f32_16x16x32_bf16 v[96:99], a[224:227], v[64:67], v[96:99]
    ds_read_b128 v[80:83], v224 offset:57344
    v_mfma_f32_16x16x32_bf16 v[100:103], a[228:231], v[64:67], v[100:103]
    ds_read_b128 v[84:87], v224 offset:59392
    v_mfma_f32_16x16x32_bf16 v[104:107], a[232:235], v[64:67], v[104:107]
    ds_read_b128 v[88:91], v224 offset:61440
    v_mfma_f32_16x16x32_bf16 v[108:111], a[236:239], v[64:67], v[108:111]
    ds_read_b128 v[92:95], v224 offset:63488
    v_mfma_f32_16x16x32_bf16 v[112:115], a[224:227], v[68:71], v[112:115]
    ds_read_b64_tr_b16 a[240:241], v228 offset:12288
    v_mfma_f32_16x16x32_bf16 v[116:119], a[228:231], v[68:71], v[116:119]
    ds_read_b64_tr_b16 a[242:243], v228 offset:12800
    s_mov_b32 s39, 0
    buffer_store_dwordx4 v[16:19], v238, s[8:11], s39 offen sc1
    v_mfma_f32_16x16x32_bf16 v[120:123], a[232:235], v[68:71], v[120:123]
    ds_read_b64_tr_b16 a[244:245], v229 offset:12288
    v_mfma_f32_16x16x32_bf16 v[124:127], a[236:239], v[68:71], v[124:127]
    ds_read_b64_tr_b16 a[246:247], v229 offset:12800
    v_mfma_f32_16x16x32_bf16 v[128:131], a[224:227], v[72:75], v[128:131]
    v_mfma_f32_16x16x32_bf16 v[132:135], a[228:231], v[72:75], v[132:135]
    v_mfma_f32_16x16x32_bf16 v[136:139], a[232:235], v[72:75], v[136:139]
    v_mfma_f32_16x16x32_bf16 v[140:143], a[236:239], v[72:75], v[140:143]
    v_mfma_f32_16x16x32_bf16 v[144:147], a[224:227], v[76:79], v[144:147]
    v_mfma_f32_16x16x32_bf16 v[148:151], a[228:231], v[76:79], v[148:151]
    s_mov_b32 s39, 8192
    buffer_store_dwordx4 v[20:23], v238, s[8:11], s39 offen sc1
    v_mfma_f32_16x16x32_bf16 v[152:155], a[232:235], v[76:79], v[152:155]
    v_mfma_f32_16x16x32_bf16 v[156:159], a[236:239], v[76:79], v[156:159]
    s_waitcnt lgkmcnt(0)
    v_mfma_f32_16x16x32_bf16 v[160:163], a[224:227], v[80:83], v[160:163]
    ds_read_b128 v[64:67], v225 offset:49152
    v_mfma_f32_16x16x32_bf16 v[164:167], a[228:231], v[80:83], v[164:167]
    ds_read_b128 v[68:71], v225 offset:51200
    v_mfma_f32_16x16x32_bf16 v[168:171], a[232:235], v[80:83], v[168:171]
    ds_read_b128 v[72:75], v225 offset:53248
    v_mfma_f32_16x16x32_bf16 v[172:175], a[236:239], v[80:83], v[172:175]
    ds_read_b128 v[76:79], v225 offset:55296
    v_mfma_f32_16x16x32_bf16 v[176:179], a[224:227], v[84:87], v[176:179]
    ds_read_b64_tr_b16 a[248:249], v230 offset:12288
    v_mfma_f32_16x16x32_bf16 v[180:183], a[228:231], v[84:87], v[180:183]
    ds_read_b64_tr_b16 a[250:251], v230 offset:12800
    s_mov_b32 s39, 16384
    buffer_store_dwordx4 v[24:27], v238, s[8:11], s39 offen sc1
    v_mfma_f32_16x16x32_bf16 v[184:187], a[232:235], v[84:87], v[184:187]
    ds_read_b64_tr_b16 a[252:253], v231 offset:12288
    v_mfma_f32_16x16x32_bf16 v[188:191], a[236:239], v[84:87], v[188:191]
    ds_read_b64_tr_b16 a[254:255], v231 offset:12800
    v_mfma_f32_16x16x32_bf16 v[192:195], a[224:227], v[88:91], v[192:195]
    s_add_u32 m0, s34, 40960
    s_add_u32 s37, s85, 131072
    buffer_load_dwordx4 v232, s[44:47], s37 offen lds
    v_mfma_f32_16x16x32_bf16 v[196:199], a[228:231], v[88:91], v[196:199]
    v_mfma_f32_16x16x32_bf16 v[200:203], a[232:235], v[88:91], v[200:203]
    v_mfma_f32_16x16x32_bf16 v[204:207], a[236:239], v[88:91], v[204:207]
    v_mfma_f32_16x16x32_bf16 v[208:211], a[224:227], v[92:95], v[208:211]
    buffer_load_dwordx4 v233, s[44:47], s37 offen offset:1024 lds
    v_mfma_f32_16x16x32_bf16 v[212:215], a[228:231], v[92:95], v[212:215]
    s_mov_b32 s39, 24576
    buffer_store_dwordx4 v[28:31], v238, s[8:11], s39 offen sc1
    v_mfma_f32_16x16x32_bf16 v[216:219], a[232:235], v[92:95], v[216:219]
    v_mfma_f32_16x16x32_bf16 v[220:223], a[236:239], v[92:95], v[220:223]
    s_waitcnt lgkmcnt(0)
    v_mfma_f32_16x16x32_bf16 v[96:99], a[240:243], v[64:67], v[96:99]
    ds_read_b128 v[80:83], v225 offset:57344
    v_mfma_f32_16x16x32_bf16 v[100:103], a[244:247], v[64:67], v[100:103]
    ds_read_b128 v[84:87], v225 offset:59392
    v_mfma_f32_16x16x32_bf16 v[104:107], a[248:251], v[64:67], v[104:107]
    ds_read_b128 v[88:91], v225 offset:61440
    v_mfma_f32_16x16x32_bf16 v[108:111], a[252:255], v[64:67], v[108:111]
    ds_read_b128 v[92:95], v225 offset:63488
    v_mfma_f32_16x16x32_bf16 v[112:115], a[240:243], v[68:71], v[112:115]
    v_mfma_f32_16x16x32_bf16 v[116:119], a[244:247], v[68:71], v[116:119]
    v_mfma_f32_16x16x32_bf16 v[120:123], a[248:251], v[68:71], v[120:123]
    v_mfma_f32_16x16x32_bf16 v[124:127], a[252:255], v[68:71], v[124:127]
    v_mfma_f32_16x16x32_bf16 v[128:131], a[240:243], v[72:75], v[128:131]
    v_mfma_f32_16x16x32_bf16 v[132:135], a[244:247], v[72:75], v[132:135]
    v_cvt_pk_bf16_f32 v0, v96, v97
    v_cvt_pk_bf16_f32 v1, v98, v99
    v_mfma_f32_16x16x32_bf16 v[136:139], a[248:251], v[72:75], v[136:139]
    v_cvt_pk_bf16_f32 v2, v100, v101
    v_cvt_pk_bf16_f32 v3, v102, v103
    v_mfma_f32_16x16x32_bf16 v[140:143], a[252:255], v[72:75], v[140:143]
    v_cvt_pk_bf16_f32 v4, v104, v105
    v_cvt_pk_bf16_f32 v5, v106, v107
    v_mfma_f32_16x16x32_bf16 v[144:147], a[240:243], v[76:79], v[144:147]
    v_cvt_pk_bf16_f32 v6, v108, v109
    v_cvt_pk_bf16_f32 v7, v110, v111
    v_mfma_f32_16x16x32_bf16 v[148:151], a[244:247], v[76:79], v[148:151]
    v_cvt_pk_bf16_f32 v8, v112, v113
    v_cvt_pk_bf16_f32 v9, v114, v115
    v_mfma_f32_16x16x32_bf16 v[152:155], a[248:251], v[76:79], v[152:155]
    v_cvt_pk_bf16_f32 v10, v116, v117
    v_cvt_pk_bf16_f32 v11, v118, v119
    v_mfma_f32_16x16x32_bf16 v[156:159], a[252:255], v[76:79], v[156:159]
    v_cvt_pk_bf16_f32 v12, v120, v121
    v_cvt_pk_bf16_f32 v13, v122, v123
    s_waitcnt vmcnt(14) lgkmcnt(0)
    s_barrier
    v_mfma_f32_16x16x32_bf16 v[160:163], a[240:243], v[80:83], v[160:163]
    ds_read_b128 v[64:67], v224 offset:0
    v_cvt_pk_bf16_f32 v14, v124, v125
    v_cvt_pk_bf16_f32 v15, v126, v127
    v_mfma_f32_16x16x32_bf16 v[164:167], a[244:247], v[80:83], v[164:167]
    ds_read_b128 v[68:71], v224 offset:2048
    v_cvt_pk_bf16_f32 v16, v128, v129
    v_cvt_pk_bf16_f32 v17, v130, v131
    v_mfma_f32_16x16x32_bf16 v[168:171], a[248:251], v[80:83], v[168:171]
    ds_read_b128 v[72:75], v224 offset:4096
    v_cvt_pk_bf16_f32 v18, v132, v133
    v_cvt_pk_bf16_f32 v19, v134, v135
    v_mfma_f32_16x16x32_bf16 v[172:175], a[252:255], v[80:83], v[172:175]
    ds_read_b128 v[76:79], v224 offset:6144
    v_cvt_pk_bf16_f32 v20, v136, v137
    v_cvt_pk_bf16_f32 v21, v138, v139
    v_mfma_f32_16x16x32_bf16 v[176:179], a[240:243], v[84:87], v[176:179]
    v_cvt_pk_bf16_f32 v22, v140, v141
    v_cvt_pk_bf16_f32 v23, v142, v143
    v_mfma_f32_16x16x32_bf16 v[180:183], a[244:247], v[84:87], v[180:183]
    v_cvt_pk_bf16_f32 v24, v144, v145
    v_cvt_pk_bf16_f32 v25, v146, v147
    v_mfma_f32_16x16x32_bf16 v[184:187], a[248:251], v[84:87], v[184:187]
    v_cvt_pk_bf16_f32 v26, v148, v149
    v_cvt_pk_bf16_f32 v27, v150, v151
    v_mfma_f32_16x16x32_bf16 v[188:191], a[252:255], v[84:87], v[188:191]
    v_cvt_pk_bf16_f32 v28, v152, v153
    v_cvt_pk_bf16_f32 v29, v154, v155
    v_mfma_f32_16x16x32_bf16 v[192:195], a[240:243], v[88:91], v[192:195]
    s_add_u32 m0, s34, 49152
    s_add_u32 s37, s86, 131072
    buffer_load_dwordx4 v232, s[44:47], s37 offen lds
    v_cvt_pk_bf16_f32 v30, v156, v157
    v_cvt_pk_bf16_f32 v31, v158, v159
    v_mfma_f32_16x16x32_bf16 v[196:199], a[244:247], v[88:91], v[196:199]
    v_cvt_pk_bf16_f32 v32, v160, v161
    v_cvt_pk_bf16_f32 v33, v162, v163
    v_mfma_f32_16x16x32_bf16 v[200:203], a[248:251], v[88:91], v[200:203]
    v_cvt_pk_bf16_f32 v34, v164, v165
    v_cvt_pk_bf16_f32 v35, v166, v167
    v_mfma_f32_16x16x32_bf16 v[204:207], a[252:255], v[88:91], v[204:207]
    v_cvt_pk_bf16_f32 v36, v168, v169
    v_cvt_pk_bf16_f32 v37, v170, v171
    v_mfma_f32_16x16x32_bf16 v[208:211], a[240:243], v[92:95], v[208:211]
    buffer_load_dwordx4 v233, s[44:47], s37 offen offset:1024 lds
    v_cvt_pk_bf16_f32 v38, v172, v173
    v_cvt_pk_bf16_f32 v39, v174, v175
    v_mfma_f32_16x16x32_bf16 v[212:215], a[244:247], v[92:95], v[212:215]
    v_cvt_pk_bf16_f32 v40, v176, v177
    v_cvt_pk_bf16_f32 v41, v178, v179
    v_mfma_f32_16x16x32_bf16 v[216:219], a[248:251], v[92:95], v[216:219]
    v_cvt_pk_bf16_f32 v42, v180, v181
    v_cvt_pk_bf16_f32 v43, v182, v183
    v_mfma_f32_16x16x32_bf16 v[220:223], a[252:255], v[92:95], v[220:223]
    v_cvt_pk_bf16_f32 v44, v184, v185
    v_cvt_pk_bf16_f32 v45, v186, v187
    s_waitcnt lgkmcnt(0)
    v_mfma_f32_16x16x32_bf16 v[96:99], a[0:3], v[64:67], 0
    ds_read_b128 v[80:83], v225 offset:0
    v_cvt_pk_bf16_f32 v46, v188, v189
    v_cvt_pk_bf16_f32 v47, v190, v191
    v_mfma_f32_16x16x32_bf16 v[100:103], a[4:7], v[64:67], 0
    ds_read_b128 v[84:87], v225 offset:2048
    v_cvt_pk_bf16_f32 v48, v192, v193
    v_cvt_pk_bf16_f32 v49, v194, v195
    v_mfma_f32_16x16x32_bf16 v[104:107], a[8:11], v[64:67], 0
    ds_read_b128 v[88:91], v225 offset:4096
    v_cvt_pk_bf16_f32 v50, v196, v197
    v_cvt_pk_bf16_f32 v51, v198, v199
    v_mfma_f32_16x16x32_bf16 v[108:111], a[12:15], v[64:67], 0
    ds_read_b128 v[92:95], v225 offset:6144
    v_cvt_pk_bf16_f32 v52, v200, v201
    v_cvt_pk_bf16_f32 v53, v202, v203
    v_mfma_f32_16x16x32_bf16 v[112:115], a[0:3], v[68:71], 0
    v_cvt_pk_bf16_f32 v54, v204, v205
    v_cvt_pk_bf16_f32 v55, v206, v207
    s_add_u32 s38, s36, 0
    buffer_store_dwordx4 v[0:3], v240, s[16:19], s38 offen offset:0 sc1
    v_mfma_f32_16x16x32_bf16 v[116:119], a[4:7], v[68:71], 0
    v_cvt_pk_bf16_f32 v56, v208, v209
    v_cvt_pk_bf16_f32 v57, v210, v211
    v_mfma_f32_16x16x32_bf16 v[120:123], a[8:11], v[68:71], 0
    v_cvt_pk_bf16_f32 v58, v212, v213
    v_cvt_pk_bf16_f32 v59, v214, v215
    v_mfma_f32_16x16x32_bf16 v[124:127], a[12:15], v[68:71], 0
    v_cvt_pk_bf16_f32 v60, v216, v217
    v_cvt_pk_bf16_f32 v61, v218, v219
    v_mfma_f32_16x16x32_bf16 v[128:131], a[0:3], v[72:75], 0
    v_xor_b32 v237, 32, v245
    v_xor_b32 v238, 32, v246
    v_cvt_pk_bf16_f32 v62, v220, v221
    v_cvt_pk_bf16_f32 v63, v222, v223
    v_mfma_f32_16x16x32_bf16 v[132:135], a[4:7], v[72:75], 0
    v_mfma_f32_16x16x32_bf16 v[136:139], a[8:11], v[72:75], 0
    v_mfma_f32_16x16x32_bf16 v[140:143], a[12:15], v[72:75], 0
    v_mfma_f32_16x16x32_bf16 v[144:147], a[0:3], v[76:79], 0
    v_mfma_f32_16x16x32_bf16 v[148:151], a[4:7], v[76:79], 0
    v_mfma_f32_16x16x32_bf16 v[152:155], a[8:11], v[76:79], 0
    v_mfma_f32_16x16x32_bf16 v[156:159], a[12:15], v[76:79], 0
    s_waitcnt lgkmcnt(0)
    v_mfma_f32_16x16x32_bf16 v[96:99], a[16:19], v[80:83], v[96:99]
    ds_read_b128 v[64:67], v224 offset:8192
    v_mfma_f32_16x16x32_bf16 v[100:103], a[20:23], v[80:83], v[100:103]
    ds_read_b128 v[68:71], v224 offset:10240
    v_mfma_f32_16x16x32_bf16 v[104:107], a[24:27], v[80:83], v[104:107]
    ds_read_b128 v[72:75], v224 offset:12288
    v_mfma_f32_16x16x32_bf16 v[108:111], a[28:31], v[80:83], v[108:111]
    ds_read_b128 v[76:79], v224 offset:14336
    v_mfma_f32_16x16x32_bf16 v[112:115], a[16:19], v[84:87], v[112:115]
    v_mfma_f32_16x16x32_bf16 v[116:119], a[20:23], v[84:87], v[116:119]
    v_mfma_f32_16x16x32_bf16 v[120:123], a[24:27], v[84:87], v[120:123]
    v_mfma_f32_16x16x32_bf16 v[124:127], a[28:31], v[84:87], v[124:127]
    v_mfma_f32_16x16x32_bf16 v[128:131], a[16:19], v[88:91], v[128:131]
    s_add_u32 m0, s34, 57344
    s_add_u32 s37, s87, 131072
    buffer_load_dwordx4 v232, s[44:47], s37 offen lds
    v_mfma_f32_16x16x32_bf16 v[132:135], a[20:23], v[88:91], v[132:135]
    s_add_u32 s38, s36, 0
    buffer_store_dwordx4 v[4:7], v240, s[16:19], s38 offen offset:2048 sc1
    v_mfma_f32_16x16x32_bf16 v[136:139], a[24:27], v[88:91], v[136:139]
    v_mfma_f32_16x16x32_bf16 v[140:143], a[28:31], v[88:91], v[140:143]
    v_mfma_f32_16x16x32_bf16 v[144:147], a[16:19], v[92:95], v[144:147]
    buffer_load_dwordx4 v233, s[44:47], s37 offen offset:1024 lds
    v_mfma_f32_16x16x32_bf16 v[148:151], a[20:23], v[92:95], v[148:151]
    v_mfma_f32_16x16x32_bf16 v[152:155], a[24:27], v[92:95], v[152:155]
    v_mfma_f32_16x16x32_bf16 v[156:159], a[28:31], v[92:95], v[156:159]
    s_waitcnt lgkmcnt(0)
    v_mfma_f32_16x16x32_bf16 v[96:99], a[32:35], v[64:67], v[96:99]
    ds_read_b128 v[80:83], v225 offset:8192
    v_mfma_f32_16x16x32_bf16 v[100:103], a[36:39], v[64:67], v[100:103]
    ds_read_b128 v[84:87], v225 offset:10240
    v_mfma_f32_16x16x32_bf16 v[104:107], a[40:43], v[64:67], v[104:107]
    ds_read_b128 v[88:91], v225 offset:12288
    v_mfma_f32_16x16x32_bf16 v[108:111], a[44:47], v[64:67], v[108:111]
    ds_read_b128 v[92:95], v225 offset:14336
    v_mfma_f32_16x16x32_bf16 v[112:115], a[32:35], v[68:71], v[112:115]
    v_mfma_f32_16x16x32_bf16 v[116:119], a[36:39], v[68:71], v[116:119]
    v_mfma_f32_16x16x32_bf16 v[120:123], a[40:43], v[68:71], v[120:123]
    v_mfma_f32_16x16x32_bf16 v[124:127], a[44:47], v[68:71], v[124:127]
    v_mfma_f32_16x16x32_bf16 v[128:131], a[32:35], v[72:75], v[128:131]
    s_waitcnt vmcnt(15)
    v_readfirstlane_b32 s24, v254
    s_lshl_b32 s25, s3, 16
    s_add_u32 s24, s24, s25
    s_cmp_ge_u32 s24, 1
    s_cbranch_scc0 kf_spin31
kf_spinr32:
    v_mfma_f32_16x16x32_bf16 v[132:135], a[36:39], v[72:75], v[132:135]
    v_mfma_f32_16x16x32_bf16 v[136:139], a[40:43], v[72:75], v[136:139]
    v_mfma_f32_16x16x32_bf16 v[140:143], a[44:47], v[72:75], v[140:143]
    v_mfma_f32_16x16x32_bf16 v[144:147], a[32:35], v[76:79], v[144:147]
    s_add_u32 s88, s20, 0x14a0000
    s_addc_u32 s89, s21, 0
    s_mov_b32 s90, 20480
    v_mfma_f32_16x16x32_bf16 v[148:151], a[36:39], v[76:79], v[148:151]
    v_mfma_f32_16x16x32_bf16 v[152:155], a[40:43], v[76:79], v[152:155]
    v_mfma_f32_16x16x32_bf16 v[156:159], a[44:47], v[76:79], v[156:159]
    s_add_u32 s38, s36, 0
    buffer_store_dwordx4 v[8:11], v240, s[16:19], s38 offen offset:1024 sc1
    s_waitcnt vmcnt(7) lgkmcnt(0)
    s_barrier
    v_mfma_f32_16x16x32_bf16 v[96:99], a[48:51], v[80:83], v[96:99]
    ds_read_b128 v[64:67], v224 offset:16384
    v_mfma_f32_16x16x32_bf16 v[100:103], a[52:55], v[80:83], v[100:103]
    ds_read_b128 v[68:71], v224 offset:18432
    v_mfma_f32_16x16x32_bf16 v[104:107], a[56:59], v[80:83], v[104:107]
    ds_read_b128 v[72:75], v224 offset:20480
    v_mfma_f32_16x16x32_bf16 v[108:111], a[60:63], v[80:83], v[108:111]
    ds_read_b128 v[76:79], v224 offset:22528
    v_mfma_f32_16x16x32_bf16 v[112:115], a[48:51], v[84:87], v[112:115]
    v_mfma_f32_16x16x32_bf16 v[116:119], a[52:55], v[84:87], v[116:119]
    v_mfma_f32_16x16x32_bf16 v[120:123], a[56:59], v[84:87], v[120:123]
    v_mfma_f32_16x16x32_bf16 v[124:127], a[60:63], v[84:87], v[124:127]
    v_mfma_f32_16x16x32_bf16 v[128:131], a[48:51], v[88:91], v[128:131]
    s_add_u32 m0, s34, 0
    s_add_u32 s37, s80, 196608
    buffer_load_dwordx4 v232, s[44:47], s37 offen lds
    v_mfma_f32_16x16x32_bf16 v[132:135], a[52:55], v[88:91], v[132:135]
    v_mfma_f32_16x16x32_bf16 v[136:139], a[56:59], v[88:91], v[136:139]
    buffer_load_dwordx4 v233, s[44:47], s37 offen offset:1024 lds
    v_mfma_f32_16x16x32_bf16 v[140:143], a[60:63], v[88:91], v[140:143]
    v_mfma_f32_16x16x32_bf16 v[144:147], a[48:51], v[92:95], v[144:147]
    v_mfma_f32_16x16x32_bf16 v[148:151], a[52:55], v[92:95], v[148:151]
    s_lshl_b32 s39, s5, 7
    s_add_u32 s39, s39, 8192
    buffer_atomic_add v255, v250, s[88:91], s39 offen sc1
    s_cmp_eq_u32 s3, 0
    s_cselect_b32 s39, s39, s43
    v_mfma_f32_16x16x32_bf16 v[152:155], a[56:59], v[92:95], v[152:155]
    v_mfma_f32_16x16x32_bf16 v[156:159], a[60:63], v[92:95], v[156:159]
    s_waitcnt lgkmcnt(0)
    v_mfma_f32_16x16x32_bf16 v[96:99], a[64:67], v[64:67], v[96:99]
    ds_read_b128 v[80:83], v225 offset:16384
    v_mfma_f32_16x16x32_bf16 v[100:103], a[68:71], v[64:67], v[100:103]
    ds_read_b128 v[84:87], v225 offset:18432
    v_mfma_f32_16x16x32_bf16 v[104:107], a[72:75], v[64:67], v[104:107]
    ds_read_b128 v[88:91], v225 offset:20480
    v_mfma_f32_16x16x32_bf16 v[108:111], a[76:79], v[64:67], v[108:111]
    ds_read_b128 v[92:95], v225 offset:22528
    v_mfma_f32_16x16x32_bf16 v[112:115], a[64:67], v[68:71], v[112:115]
    s_add_u32 s38, s36, 0
    buffer_store_dwordx4 v[12:15], v240, s[16:19], s38 offen offset:3072 sc1
    v_mfma_f32_16x16x32_bf16 v[116:119], a[68:71], v[68:71], v[116:119]
    v_mfma_f32_16x16x32_bf16 v[120:123], a[72:75], v[68:71], v[120:123]
    v_mfma_f32_16x16x32_bf16 v[124:127], a[76:79], v[68:71], v[124:127]
    v_mfma_f32_16x16x32_bf16 v[128:131], a[64:67], v[72:75], v[128:131]
    s_add_u32 m0, s31, 0
    s_add_u32 s24, s27, 0
    buffer_load_dwordx4 v245, s[12:15], s24 offen lds
    v_mfma_f32_16x16x32_bf16 v[132:135], a[68:71], v[72:75], v[132:135]
    v_mfma_f32_16x16x32_bf16 v[136:139], a[72:75], v[72:75], v[136:139]
    v_mfma_f32_16x16x32_bf16 v[140:143], a[76:79], v[72:75], v[140:143]
    v_mfma_f32_16x16x32_bf16 v[144:147], a[64:67], v[76:79], v[144:147]
    v_mfma_f32_16x16x32_bf16 v[148:151], a[68:71], v[76:79], v[148:151]
    v_mfma_f32_16x16x32_bf16 v[152:155], a[72:75], v[76:79], v[152:155]
    v_mfma_f32_16x16x32_bf16 v[156:159], a[76:79], v[76:79], v[156:159]
    s_waitcnt lgkmcnt(0)
    v_mfma_f32_16x16x32_bf16 v[96:99], a[80:83], v[80:83], v[96:99]
    ds_read_b128 v[64:67], v224 offset:24576
    v_mfma_f32_16x16x32_bf16 v[100:103], a[84:87], v[80:83], v[100:103]
    ds_read_b128 v[68:71], v224 offset:26624
    v_mfma_f32_16x16x32_bf16 v[104:107], a[88:91], v[80:83], v[104:107]
    ds_read_b128 v[72:75], v224 offset:28672
    v_mfma_f32_16x16x32_bf16 v[108:111], a[92:95], v[80:83], v[108:111]
    ds_read_b128 v[76:79], v224 offset:30720
    v_mfma_f32_16x16x32_bf16 v[112:115], a[80:83], v[84:87], v[112:115]
    v_mfma_f32_16x16x32_bf16 v[116:119], a[84:87], v[84:87], v[116:119]
    v_mfma_f32_16x16x32_bf16 v[120:123], a[88:91], v[84:87], v[120:123]
    v_mfma_f32_16x16x32_bf16 v[124:127], a[92:95], v[84:87], v[124:127]
    v_mfma_f32_16x16x32_bf16 v[128:131], a[80:83], v[88:91], v[128:131]
    s_add_u32 m0, s34, 8192
    s_add_u32 s37, s81, 196608
    buffer_load_dwordx4 v232, s[44:47], s37 offen lds
    v_mfma_f32_16x16x32_bf16 v[132:135], a[84:87], v[88:91], v[132:135]
    v_mfma_f32_16x16x32_bf16 v[136:139], a[88:91], v[88:91], v[136:139]
    buffer_load_dwordx4 v233, s[44:47], s37 offen offset:1024 lds
    s_add_u32 s38, s36, 8192
    buffer_store_dwordx4 v[16:19], v240, s[16:19], s38 offen offset:0 sc1
    v_mfma_f32_16x16x32_bf16 v[140:143], a[92:95], v[88:91], v[140:143]
    v_mfma_f32_16x16x32_bf16 v[144:147], a[80:83], v[92:95], v[144:147]
    v_mfma_f32_16x16x32_bf16 v[148:151], a[84:87], v[92:95], v[148:151]
    s_add_u32 m0, s31, 1024
    s_add_u32 s24, s27, 32768
    buffer_load_dwordx4 v245, s[12:15], s24 offen lds
    v_mfma_f32_16x16x32_bf16 v[152:155], a[88:91], v[92:95], v[152:155]
    v_mfma_f32_16x16x32_bf16 v[156:159], a[92:95], v[92:95], v[156:159]
    s_waitcnt lgkmcnt(0)
    v_mfma_f32_16x16x32_bf16 v[96:99], a[96:99], v[64:67], v[96:99]
    ds_read_b128 v[80:83], v225 offset:24576
    v_mfma_f32_16x16x32_bf16 v[100:103], a[100:103], v[64:67], v[100:103]
    ds_read_b128 v[84:87], v225 offset:26624
    v_mfma_f32_16x16x32_bf16 v[104:107], a[104:107], v[64:67], v[104:107]
    ds_read_b128 v[88:91], v225 offset:28672
    v_mfma_f32_16x16x32_bf16 v[108:111], a[108:111], v[64:67], v[108:111]
    ds_read_b128 v[92:95], v225 offset:30720
    v_mfma_f32_16x16x32_bf16 v[112:115], a[96:99], v[68:71], v[112:115]
    v_mfma_f32_16x16x32_bf16 v[116:119], a[100:103], v[68:71], v[116:119]
    v_mfma_f32_16x16x32_bf16 v[120:123], a[104:107], v[68:71], v[120:123]
    v_mfma_f32_16x16x32_bf16 v[124:127], a[108:111], v[68:71], v[124:127]
    v_mfma_f32_16x16x32_bf16 v[128:131], a[96:99], v[72:75], v[128:131]
    s_add_u32 m0, s31, 2048
    s_add_u32 s24, s27, 65536
    buffer_load_dwordx4 v237, s[12:15], s24 offen lds
    v_mfma_f32_16x16x32_bf16 v[132:135], a[100:103], v[72:75], v[132:135]
    v_mfma_f32_16x16x32_bf16 v[136:139], a[104:107], v[72:75], v[136:139]
    v_mfma_f32_16x16x32_bf16 v[140:143], a[108:111], v[72:75], v[140:143]
    v_mfma_f32_16x16x32_bf16 v[144:147], a[96:99], v[76:79], v[144:147]
    v_mfma_f32_16x16x32_bf16 v[148:151], a[100:103], v[76:79], v[148:151]
    v_mfma_f32_16x16x32_bf16 v[152:155], a[104:107], v[76:79], v[152:155]
    v_mfma_f32_16x16x32_bf16 v[156:159], a[108:111], v[76:79], v[156:159]
    s_add_u32 s38, s36, 8192
    buffer_store_dwordx4 v[20:23], v240, s[16:19], s38 offen offset:2048 sc1
    s_waitcnt vmcnt(19) lgkmcnt(0)
    s_barrier
    v_mfma_f32_16x16x32_bf16 v[96:99], a[112:115], v[80:83], v[96:99]
    ds_read_b128 v[64:67], v224 offset:32768
    v_mfma_f32_16x16x32_bf16 v[100:103], a[116:119], v[80:83], v[100:103]
    ds_read_b128 v[68:71], v224 offset:34816
    v_mfma_f32_16x16x32_bf16 v[104:107], a[120:123], v[80:83], v[104:107]
    ds_read_b128 v[72:75], v224 offset:36864
    v_mfma_f32_16x16x32_bf16 v[108:111], a[124:127], v[80:83], v[108:111]
    ds_read_b128 v[76:79], v224 offset:38912
    v_mfma_f32_16x16x32_bf16 v[112:115], a[112:115], v[84:87], v[112:115]
    v_mfma_f32_16x16x32_bf16 v[116:119], a[116:119], v[84:87], v[116:119]
    v_mfma_f32_16x16x32_bf16 v[120:123], a[120:123], v[84:87], v[120:123]
    v_mfma_f32_16x16x32_bf16 v[124:127], a[124:127], v[84:87], v[124:127]
    v_mfma_f32_16x16x32_bf16 v[128:131], a[112:115], v[88:91], v[128:131]
    s_add_u32 m0, s34, 16384
    s_add_u32 s37, s82, 196608
    buffer_load_dwordx4 v232, s[44:47], s37 offen lds
    v_mfma_f32_16x16x32_bf16 v[132:135], a[116:119], v[88:91], v[132:135]
    v_mfma_f32_16x16x32_bf16 v[136:139], a[120:123], v[88:91], v[136:139]
    buffer_load_dwordx4 v233, s[44:47], s37 offen offset:1024 lds
    v_mfma_f32_16x16x32_bf16 v[140:143], a[124:127], v[88:91], v[140:143]
    v_mfma_f32_16x16x32_bf16 v[144:147], a[112:115], v[92:95], v[144:147]
    v_mfma_f32_16x16x32_bf16 v[148:151], a[116:119], v[92:95], v[148:151]
    s_add_u32 m0, s31, 3072
    s_add_u32 s24, s27, 98304
    buffer_load_dwordx4 v237, s[12:15], s24 offen lds
    v_mfma_f32_16x16x32_bf16 v[152:155], a[120:123], v[92:95], v[152:155]
    v_mfma_f32_16x16x32_bf16 v[156:159], a[124:127], v[92:95], v[156:159]
    s_waitcnt lgkmcnt(0)
    v_mfma_f32_16x16x32_bf16 v[96:99], a[128:131], v[64:67], v[96:99]
    ds_read_b128 v[80:83], v225 offset:32768
    v_mfma_f32_16x16x32_bf16 v[100:103], a[132:135], v[64:67], v[100:103]
    ds_read_b128 v[84:87], v225 offset:34816
    v_mfma_f32_16x16x32_bf16 v[104:107], a[136:139], v[64:67], v[104:107]
    ds_read_b128 v[88:91], v225 offset:36864
    v_mfma_f32_16x16x32_bf16 v[108:111], a[140:143], v[64:67], v[108:111]
    ds_read_b128 v[92:95], v225 offset:38912
    v_mfma_f32_16x16x32_bf16 v[112:115], a[128:131], v[68:71], v[112:115]
    v_mfma_f32_16x16x32_bf16 v[116:119], a[132:135], v[68:71], v[116:119]
    s_add_u32 s38, s36, 8192
    buffer_store_dwordx4 v[24:27], v240, s[16:19], s38 offen offset:1024 sc1
    v_mfma_f32_16x16x32_bf16 v[120:123], a[136:139], v[68:71], v[120:123]
    v_mfma_f32_16x16x32_bf16 v[124:127], a[140:143], v[68:71], v[124:127]
    v_mfma_f32_16x16x32_bf16 v[128:131], a[128:131], v[72:75], v[128:131]
    s_add_u32 m0, s31, 4096
    s_add_u32 s24, s27, 131072
    buffer_load_dwordx4 v245, s[12:15], s24 offen lds
    v_mfma_f32_16x16x32_bf16 v[132:135], a[132:135], v[72:75], v[132:135]
    v_mfma_f32_16x16x32_bf16 v[136:139], a[136:139], v[72:75], v[136:139]
    v_mfma_f32_16x16x32_bf16 v[140:143], a[140:143], v[72:75], v[140:143]
    v_mfma_f32_16x16x32_bf16 v[144:147], a[128:131], v[76:79], v[144:147]
    v_mfma_f32_16x16x32_bf16 v[148:151], a[132:135], v[76:79], v[148:151]
    v_mfma_f32_16x16x32_bf16 v[152:155], a[136:139], v[76:79], v[152:155]
    v_mfma_f32_16x16x32_bf16 v[156:159], a[140:143], v[76:79], v[156:159]
    s_waitcnt lgkmcnt(0)
    v_mfma_f32_16x16x32_bf16 v[96:99], a[144:147], v[80:83], v[96:99]
    ds_read_b128 v[64:67], v224 offset:40960
    v_mfma_f32_16x16x32_bf16 v[100:103], a[148:151], v[80:83], v[100:103]
    ds_read_b128 v[68:71], v224 offset:43008
    v_mfma_f32_16x16x32_bf16 v[104:107], a[152:155], v[80:83], v[104:107]
    ds_read_b128 v[72:75], v224 offset:45056
    v_mfma_f32_16x16x32_bf16 v[108:111], a[156:159], v[80:83], v[108:111]
    ds_read_b128 v[76:79], v224 offset:47104
    v_mfma_f32_16x16x32_bf16 v[112:115], a[144:147], v[84:87], v[112:115]
    v_mfma_f32_16x16x32_bf16 v[116:119], a[148:151], v[84:87], v[116:119]
    v_mfma_f32_16x16x32_bf16 v[120:123], a[152:155], v[84:87], v[120:123]
    v_mfma_f32_16x16x32_bf16 v[124:127], a[156:159], v[84:87], v[124:127]
    v_mfma_f32_16x16x32_bf16 v[128:131], a[144:147], v[88:91], v[128:131]
    s_add_u32 m0, s34, 24576
    s_add_u32 s37, s83, 196608
    buffer_load_dwordx4 v232, s[44:47], s37 offen lds
    v_mfma_f32_16x16x32_bf16 v[132:135], a[148:151], v[88:91], v[132:135]
    v_mfma_f32_16x16x32_bf16 v[136:139], a[152:155], v[88:91], v[136:139]
    buffer_load_dwordx4 v233, s[44:47], s37 offen offset:1024 lds
    s_add_u32 s38, s36, 8192
    buffer_store_dwordx4 v[28:31], v240, s[16:19], s38 offen offset:3072 sc1
    v_mfma_f32_16x16x32_bf16 v[140:143], a[156:159], v[88:91], v[140:143]
    v_mfma_f32_16x16x32_bf16 v[144:147], a[144:147], v[92:95], v[144:147]
    v_mfma_f32_16x16x32_bf16 v[148:151], a[148:151], v[92:95], v[148:151]
    s_add_u32 m0, s31, 5120
    s_add_u32 s24, s27, 163840
    buffer_load_dwordx4 v245, s[12:15], s24 offen lds
    v_mfma_f32_16x16x32_bf16 v[152:155], a[152:155], v[92:95], v[152:155]
    v_mfma_f32_16x16x32_bf16 v[156:159], a[156:159], v[92:95], v[156:159]
    s_waitcnt lgkmcnt(0)
    v_mfma_f32_16x16x32_bf16 v[96:99], a[160:163], v[64:67], v[96:99]
    ds_read_b128 v[80:83], v225 offset:40960
    v_mfma_f32_16x16x32_bf16 v[100:103], a[164:167], v[64:67], v[100:103]
    ds_read_b128 v[84:87], v225 offset:43008
    v_mfma_f32_16x16x32_bf16 v[104:107], a[168:171], v[64:67], v[104:107]
    ds_read_b128 v[88:91], v225 offset:45056
    v_mfma_f32_16x16x32_bf16 v[108:111], a[172:175], v[64:67], v[108:111]
    ds_read_b128 v[92:95], v225 offset:47104
    v_mfma_f32_16x16x32_bf16 v[112:115], a[160:163], v[68:71], v[112:115]
    v_mfma_f32_16x16x32_bf16 v[116:119], a[164:167], v[68:71], v[116:119]
    v_mfma_f32_16x16x32_bf16 v[120:123], a[168:171], v[68:71], v[120:123]
    v_mfma_f32_16x16x32_bf16 v[124:127], a[172:175], v[68:71], v[124:127]
    v_mfma_f32_16x16x32_bf16 v[128:131], a[160:163], v[72:75], v[128:131]
    s_add_u32 m0, s31, 6144
    s_add_u32 s24, s27, 196608
    buffer_load_dwordx4 v237, s[12:15], s24 offen lds
    v_mfma_f32_16x16x32_bf16 v[132:135], a[164:167], v[72:75], v[132:135]
    v_mfma_f32_16x16x32_bf16 v[136:139], a[168:171], v[72:75], v[136:139]
    v_mfma_f32_16x16x32_bf16 v[140:143], a[172:175], v[72:75], v[140:143]
    v_mfma_f32_16x16x32_bf16 v[144:147], a[160:163], v[76:79], v[144:147]
    v_mfma_f32_16x16x32_bf16 v[148:151], a[164:167], v[76:79], v[148:151]
    v_mfma_f32_16x16x32_bf16 v[152:155], a[168:171], v[76:79], v[152:155]
    v_mfma_f32_16x16x32_bf16 v[156:159], a[172:175], v[76:79], v[156:159]
    s_waitcnt vmcnt(22) lgkmcnt(0)
    s_barrier
    v_mfma_f32_16x16x32_bf16 v[96:99], a[176:179], v[80:83], v[96:99]
    ds_read_b128 v[64:67], v224 offset:49152
    s_add_u32 s38, s36, 32768
    buffer_store_dwordx4 v[32:35], v240, s[16:19], s38 offen offset:1280 sc1
    v_mfma_f32_16x16x32_bf16 v[100:103], a[180:183], v[80:83], v[100:103]
    ds_read_b128 v[68:71], v224 offset:51200
    v_mfma_f32_16x16x32_bf16 v[104:107], a[184:187], v[80:83], v[104:107]
    ds_read_b128 v[72:75], v224 offset:53248
    v_mfma_f32_16x16x32_bf16 v[108:111], a[188:191], v[80:83], v[108:111]
    ds_read_b128 v[76:79], v224 offset:55296
    v_mfma_f32_16x16x32_bf16 v[112:115], a[176:179], v[84:87], v[112:115]
    v_mfma_f32_16x16x32_bf16 v[116:119], a[180:183], v[84:87], v[116:119]
    v_mfma_f32_16x16x32_bf16 v[120:123], a[184:187], v[84:87], v[120:123]
    v_mfma_f32_16x16x32_bf16 v[124:127], a[188:191], v[84:87], v[124:127]
    v_mfma_f32_16x16x32_bf16 v[128:131], a[176:179], v[88:91], v[128:131]
    s_add_u32 m0, s34, 32768
    s_add_u32 s37, s84, 196608
    buffer_load_dwordx4 v232, s[44:47], s37 offen lds
    v_mfma_f32_16x16x32_bf16 v[132:135], a[180:183], v[88:91], v[132:135]
    buffer_load_dwordx4 v233, s[44:47], s37 offen offset:1024 lds
    v_mfma_f32_16x16x32_bf16 v[136:139], a[184:187], v[88:91], v[136:139]
    v_mfma_f32_16x16x32_bf16 v[140:143], a[188:191], v[88:91], v[140:143]
    s_add_u32 m0, s31, 7168
    s_add_u32 s24, s27, 229376
    buffer_load_dwordx4 v237, s[12:15], s24 offen lds
    v_mfma_f32_16x16x32_bf16 v[144:147], a[176:179], v[92:95], v[144:147]
    s_add_u32 s27, s27, 1048576
    s_and_b32 s27, s27, 0x407fffff
    s_cmp_eq_u32 s27, s7
    s_cselect_b32 s27, s43, s27
    v_mfma_f32_16x16x32_bf16 v[148:151], a[180:183], v[92:95], v[148:151]
    v_mfma_f32_16x16x32_bf16 v[152:155], a[184:187], v[92:95], v[152:155]
    s_add_u32 s31, s31, 32768
    s_cmp_ge_u32 s31, 163840
    s_cselect_b32 s24, 98304, 0
    s_sub_u32 s31, s31, s24
    v_mfma_f32_16x16x32_bf16 v[156:159], a[188:191], v[92:95], v[156:159]
    s_waitcnt lgkmcnt(0)
    v_mfma_f32_16x16x32_bf16 v[96:99], a[192:195], v[64:67], v[96:99]
    ds_read_b128 v[80:83], v225 offset:49152
    v_mfma_f32_16x16x32_bf16 v[100:103], a[196:199], v[64:67], v[100:103]
    ds_read_b128 v[84:87], v225 offset:51200
    v_mfma_f32_16x16x32_bf16 v[104:107], a[200:203], v[64:67], v[104:107]
    ds_read_b128 v[88:91], v225 offset:53248
    v_mfma_f32_16x16x32_bf16 v[108:111], a[204:207], v[64:67], v[108:111]
    ds_read_b128 v[92:95], v225 offset:55296
    v_mfma_f32_16x16x32_bf16 v[112:115], a[192:195], v[68:71], v[112:115]
    v_mfma_f32_16x16x32_bf16 v[116:119], a[196:199], v[68:71], v[116:119]
    v_mfma_f32_16x16x32_bf16 v[120:123], a[200:203], v[68:71], v[120:123]
    s_add_u32 s38, s36, 32768
    buffer_store_dwordx4 v[36:39], v240, s[16:19], s38 offen offset:3328 sc1
    v_mfma_f32_16x16x32_bf16 v[124:127], a[204:207], v[68:71], v[124:127]
    v_mfma_f32_16x16x32_bf16 v[128:131], a[192:195], v[72:75], v[128:131]
    v_mfma_f32_16x16x32_bf16 v[132:135], a[196:199], v[72:75], v[132:135]
    v_mfma_f32_16x16x32_bf16 v[136:139], a[200:203], v[72:75], v[136:139]
    v_mfma_f32_16x16x32_bf16 v[140:143], a[204:207], v[72:75], v[140:143]
    v_mfma_f32_16x16x32_bf16 v[144:147], a[192:195], v[76:79], v[144:147]
    v_mfma_f32_16x16x32_bf16 v[148:151], a[196:199], v[76:79], v[148:151]
    v_mfma_f32_16x16x32_bf16 v[152:155], a[200:203], v[76:79], v[152:155]
    v_mfma_f32_16x16x32_bf16 v[156:159], a[204:207], v[76:79], v[156:159]
    s_waitcnt lgkmcnt(0)
    v_mfma_f32_16x16x32_bf16 v[96:99], a[208:211], v[80:83], v[96:99]
    ds_read_b128 v[64:67], v224 offset:57344
    v_mfma_f32_16x16x32_bf16 v[100:103], a[212:215], v[80:83], v[100:103]
    ds_read_b128 v[68:71], v224 offset:59392
    v_mfma_f32_16x16x32_bf16 v[104:107], a[216:219], v[80:83], v[104:107]
    ds_read_b128 v[72:75], v224 offset:61440
    v_mfma_f32_16x16x32_bf16 v[108:111], a[220:223], v[80:83], v[108:111]
    ds_read_b128 v[76:79], v224 offset:63488
    v_mfma_f32_16x16x32_bf16 v[112:115], a[208:211], v[84:87], v[112:115]
    v_mfma_f32_16x16x32_bf16 v[116:119], a[212:215], v[84:87], v[116:119]
    v_mfma_f32_16x16x32_bf16 v[120:123], a[216:219], v[84:87], v[120:123]
    v_mfma_f32_16x16x32_bf16 v[124:127], a[220:223], v[84:87], v[124:127]
    v_mfma_f32_16x16x32_bf16 v[128:131], a[208:211], v[88:91], v[128:131]
    s_add_u32 m0, s34, 40960
    s_add_u32 s37, s85, 196608
    buffer_load_dwordx4 v232, s[44:47], s37 offen lds
    v_mfma_f32_16x16x32_bf16 v[132:135], a[212:215], v[88:91], v[132:135]
    v_mfma_f32_16x16x32_bf16 v[136:139], a[216:219], v[88:91], v[136:139]
    v_mfma_f32_16x16x32_bf16 v[140:143], a[220:223], v[88:91], v[140:143]
    s_add_u32 s38, s36, 32768
    buffer_store_dwordx4 v[40:43], v240, s[16:19], s38 offen offset:2304 sc1
    v_mfma_f32_16x16x32_bf16 v[144:147], a[208:211], v[92:95], v[144:147]
    buffer_load_dwordx4 v233, s[44:47], s37 offen offset:1024 lds
    v_mfma_f32_16x16x32_bf16 v[148:151], a[212:215], v[92:95], v[148:151]
    v_mfma_f32_16x16x32_bf16 v[152:155], a[216:219], v[92:95], v[152:155]
    v_mfma_f32_16x16x32_bf16 v[156:159], a[220:223], v[92:95], v[156:159]
    s_waitcnt lgkmcnt(0)
    v_mfma_f32_16x16x32_bf16 v[96:99], a[224:227], v[64:67], v[96:99]
    ds_read_b128 v[80:83], v225 offset:57344
    v_mfma_f32_16x16x32_bf16 v[100:103], a[228:231], v[64:67], v[100:103]
    ds_read_b128 v[84:87], v225 offset:59392
    v_mfma_f32_16x16x32_bf16 v[104:107], a[232:235], v[64:67], v[104:107]
    ds_read_b128 v[88:91], v225 offset:61440
    v_mfma_f32_16x16x32_bf16 v[108:111], a[236:239], v[64:67], v[108:111]
    ds_read_b128 v[92:95], v225 offset:63488
    v_mfma_f32_16x16x32_bf16 v[112:115], a[224:227], v[68:71], v[112:115]
    v_mfma_f32_16x16x32_bf16 v[116:119], a[228:231], v[68:71], v[116:119]
    v_mfma_f32_16x16x32_bf16 v[120:123], a[232:235], v[68:71], v[120:123]
    v_mfma_f32_16x16x32_bf16 v[124:127], a[236:239], v[68:71], v[124:127]
    v_mfma_f32_16x16x32_bf16 v[128:131], a[224:227], v[72:75], v[128:131]
    s_add_u32 m0, s31, 0
    s_add_u32 s24, s27, 0
    buffer_load_dwordx4 v245, s[12:15], s24 offen lds
    v_mfma_f32_16x16x32_bf16 v[132:135], a[228:231], v[72:75], v[132:135]
    v_mfma_f32_16x16x32_bf16 v[136:139], a[232:235], v[72:75], v[136:139]
    v_mfma_f32_16x16x32_bf16 v[140:143], a[236:239], v[72:75], v[140:143]
    v_mfma_f32_16x16x32_bf16 v[144:147], a[224:227], v[76:79], v[144:147]
    v_mfma_f32_16x16x32_bf16 v[148:151], a[228:231], v[76:79], v[148:151]
    v_mfma_f32_16x16x32_bf16 v[152:155], a[232:235], v[76:79], v[152:155]
    v_mfma_f32_16x16x32_bf16 v[156:159], a[236:239], v[76:79], v[156:159]
    s_waitcnt vmcnt(23) lgkmcnt(0)
    s_barrier
    v_mfma_f32_16x16x32_bf16 v[96:99], a[240:243], v[80:83], v[96:99]
    ds_read_b128 v[64:67], v224 offset:0
    v_mfma_f32_16x16x32_bf16 v[100:103], a[244:247], v[80:83], v[100:103]
    ds_read_b128 v[68:71], v224 offset:2048
    s_add_u32 s38, s36, 36864
    buffer_store_dwordx4 v[44:47], v240, s[16:19], s38 offen offset:256 sc1
    v_mfma_f32_16x16x32_bf16 v[104:107], a[248:251], v[80:83], v[104:107]
    ds_read_b128 v[72:75], v224 offset:4096
    v_mfma_f32_16x16x32_bf16 v[108:111], a[252:255], v[80:83], v[108:111]
    ds_read_b128 v[76:79], v224 offset:6144
    v_mfma_f32_16x16x32_bf16 v[112:115], a[240:243], v[84:87], v[112:115]
    v_mfma_f32_16x16x32_bf16 v[116:119], a[244:247], v[84:87], v[116:119]
    v_mfma_f32_16x16x32_bf16 v[120:123], a[248:251], v[84:87], v[120:123]
    v_mfma_f32_16x16x32_bf16 v[124:127], a[252:255], v[84:87], v[124:127]
    v_mfma_f32_16x16x32_bf16 v[128:131], a[240:243], v[88:91], v[128:131]
    s_add_u32 m0, s34, 49152
    s_add_u32 s37, s86, 196608
    buffer_load_dwordx4 v232, s[44:47], s37 offen lds
    v_mfma_f32_16x16x32_bf16 v[132:135], a[244:247], v[88:91], v[132:135]
    v_mfma_f32_16x16x32_bf16 v[136:139], a[248:251], v[88:91], v[136:139]
    buffer_load_dwordx4 v233, s[44:47], s37 offen offset:1024 lds
    v_mfma_f32_16x16x32_bf16 v[140:143], a[252:255], v[88:91], v[140:143]
    v_mfma_f32_16x16x32_bf16 v[144:147], a[240:243], v[92:95], v[144:147]
    v_mfma_f32_16x16x32_bf16 v[148:151], a[244:247], v[92:95], v[148:151]
    s_add_u32 m0, s31, 1024
    s_add_u32 s24, s27, 32768
    buffer_load_dwordx4 v245, s[12:15], s24 offen lds
    v_mfma_f32_16x16x32_bf16 v[152:155], a[248:251], v[92:95], v[152:155]
    v_mfma_f32_16x16x32_bf16 v[156:159], a[252:255], v[92:95], v[156:159]
    s_waitcnt lgkmcnt(0)
    v_mfma_f32_16x16x32_bf16 v[160:163], a[0:3], v[64:67], 0
    ds_read_b128 v[80:83], v225 offset:0
    v_mfma_f32_16x16x32_bf16 v[164:167], a[4:7], v[64:67], 0
    ds_read_b128 v[84:87], v225 offset:2048
    v_mfma_f32_16x16x32_bf16 v[168:171], a[8:11], v[64:67], 0
    ds_read_b128 v[88:91], v225 offset:4096
    v_mfma_f32_16x16x32_bf16 v[172:175], a[12:15], v[64:67], 0
    ds_read_b128 v[92:95], v225 offset:6144
    v_mfma_f32_16x16x32_bf16 v[176:179], a[0:3], v[68:71], 0
    v_cvt_pk_bf16_f32 v0, v96, v97
    v_cvt_pk_bf16_f32 v1, v98, v99
    v_mfma_f32_16x16x32_bf16 v[180:183], a[4:7], v[68:71], 0
    v_mfma_f32_16x16x32_bf16 v[184:187], a[8:11], v[68:71], 0
    v_cvt_pk_bf16_f32 v2, v100, v101
    v_cvt_pk_bf16_f32 v3, v102, v103
    s_add_u32 s38, s36, 40960
    buffer_store_dwordx4 v[48:51], v240, s[16:19], s38 offen offset:1280 sc1
    v_mfma_f32_16x16x32_bf16 v[188:191], a[12:15], v[68:71], 0
    v_mfma_f32_16x16x32_bf16 v[192:195], a[0:3], v[72:75], 0
    s_add_u32 m0, s31, 2048
    s_add_u32 s24, s27, 65536
    buffer_load_dwordx4 v237, s[12:15], s24 offen lds
    v_cvt_pk_bf16_f32 v4, v104, v105
    v_cvt_pk_bf16_f32 v5, v106, v107
    v_mfma_f32_16x16x32_bf16 v[196:199], a[4:7], v[72:75], 0
    v_mfma_f32_16x16x32_bf16 v[200:203], a[8:11], v[72:75], 0
    v_cvt_pk_bf16_f32 v6, v108, v109
    v_cvt_pk_bf16_f32 v7, v110, v111
    v_mfma_f32_16x16x32_bf16 v[204:207], a[12:15], v[72:75], 0
    v_mfma_f32_16x16x32_bf16 v[208:211], a[0:3], v[76:79], 0
    v_cvt_pk_bf16_f32 v8, v112, v113
    v_cvt_pk_bf16_f32 v9, v114, v115
    v_mfma_f32_16x16x32_bf16 v[212:215], a[4:7], v[76:79], 0
    v_mfma_f32_16x16x32_bf16 v[216:219], a[8:11], v[76:79], 0
    v_cvt_pk_bf16_f32 v10, v116, v117
    v_cvt_pk_bf16_f32 v11, v118, v119
    v_mfma_f32_16x16x32_bf16 v[220:223], a[12:15], v[76:79], 0
    s_waitcnt lgkmcnt(0)
    v_mfma_f32_16x16x32_bf16 v[160:163], a[16:19], v[80:83], v[160:163]
    ds_read_b128 v[64:67], v224 offset:8192
    v_cvt_pk_bf16_f32 v12, v120, v121
    v_cvt_pk_bf16_f32 v13, v122, v123
    v_mfma_f32_16x16x32_bf16 v[164:167], a[20:23], v[80:83], v[164:167]
    ds_read_b128 v[68:71], v224 offset:10240
    v_mfma_f32_16x16x32_bf16 v[168:171], a[24:27], v[80:83], v[168:171]
    ds_read_b128 v[72:75], v224 offset:12288
    v_cvt_pk_bf16_f32 v14, v124, v125
    v_cvt_pk_bf16_f32 v15, v126, v127
    v_mfma_f32_16x16x32_bf16 v[172:175], a[28:31], v[80:83], v[172:175]
    ds_read_b128 v[76:79], v224 offset:14336
    v_mfma_f32_16x16x32_bf16 v[176:179], a[16:19], v[84:87], v[176:179]
    v_cvt_pk_bf16_f32 v16, v128, v129
    v_cvt_pk_bf16_f32 v17, v130, v131
    v_mfma_f32_16x16x32_bf16 v[180:183], a[20:23], v[84:87], v[180:183]
    v_mfma_f32_16x16x32_bf16 v[184:187], a[24:27], v[84:87], v[184:187]
    v_cvt_pk_bf16_f32 v18, v132, v133
    v_cvt_pk_bf16_f32 v19, v134, v135
    v_mfma_f32_16x16x32_bf16 v[188:191], a[28:31], v[84:87], v[188:191]
    v_mfma_f32_16x16x32_bf16 v[192:195], a[16:19], v[88:91], v[192:195]
    s_add_u32 m0, s34, 57344
    s_add_u32 s37, s87, 196608
    buffer_load_dwordx4 v232, s[44:47], s37 offen lds
    v_cvt_pk_bf16_f32 v20, v136, v137
    v_cvt_pk_bf16_f32 v21, v138, v139
    v_mfma_f32_16x16x32_bf16 v[196:199], a[20:23], v[88:91], v[196:199]
    v_mfma_f32_16x16x32_bf16 v[200:203], a[24:27], v[88:91], v[200:203]
    buffer_load_dwordx4 v233, s[44:47], s37 offen offset:1024 lds
    v_cvt_pk_bf16_f32 v22, v140, v141
    v_cvt_pk_bf16_f32 v23, v142, v143
    v_mfma_f32_16x16x32_bf16 v[204:207], a[28:31], v[88:91], v[204:207]
    v_mfma_f32_16x16x32_bf16 v[208:211], a[16:19], v[92:95], v[208:211]
    v_cvt_pk_bf16_f32 v24, v144, v145
    v_cvt_pk_bf16_f32 v25, v146, v147
    s_add_u32 s38, s36, 40960
    buffer_store_dwordx4 v[52:55], v240, s[16:19], s38 offen offset:3328 sc1
    v_mfma_f32_16x16x32_bf16 v[212:215], a[20:23], v[92:95], v[212:215]
    s_add_u32 m0, s31, 3072
    s_add_u32 s24, s27, 98304
    buffer_load_dwordx4 v237, s[12:15], s24 offen lds
    v_mfma_f32_16x16x32_bf16 v[216:219], a[24:27], v[92:95], v[216:219]
    v_cvt_pk_bf16_f32 v26, v148, v149
    v_cvt_pk_bf16_f32 v27, v150, v151
    v_mfma_f32_16x16x32_bf16 v[220:223], a[28:31], v[92:95], v[220:223]
    s_waitcnt lgkmcnt(0)
    v_mfma_f32_16x16x32_bf16 v[160:163], a[32:35], v[64:67], v[160:163]
    ds_read_b128 v[80:83], v225 offset:8192
    v_cvt_pk_bf16_f32 v28, v152, v153
    v_cvt_pk_bf16_f32 v29, v154, v155
    v_mfma_f32_16x16x32_bf16 v[164:167], a[36:39], v[64:67], v[164:167]
    ds_read_b128 v[84:87], v225 offset:10240
    v_mfma_f32_16x16x32_bf16 v[168:171], a[40:43], v[64:67], v[168:171]
    ds_read_b128 v[88:91], v225 offset:12288
    v_cvt_pk_bf16_f32 v30, v156, v157
    v_cvt_pk_bf16_f32 v31, v158, v159
    v_mfma_f32_16x16x32_bf16 v[172:175], a[44:47], v[64:67], v[172:175]
    ds_read_b128 v[92:95], v225 offset:14336
    v_mfma_f32_16x16x32_bf16 v[176:179], a[32:35], v[68:71], v[176:179]
    v_mfma_f32_16x16x32_bf16 v[180:183], a[36:39], v[68:71], v[180:183]
    v_mfma_f32_16x16x32_bf16 v[184:187], a[40:43], v[68:71], v[184:187]
    v_mfma_f32_16x16x32_bf16 v[188:191], a[44:47], v[68:71], v[188:191]
    v_mfma_f32_16x16x32_bf16 v[192:195], a[32:35], v[72:75], v[192:195]
    s_add_u32 m0, s31, 4096
    s_add_u32 s24, s27, 131072
    buffer_load_dwordx4 v245, s[12:15], s24 offen lds
    v_mfma_f32_16x16x32_bf16 v[196:199], a[36:39], v[72:75], v[196:199]
    v_mfma_f32_16x16x32_bf16 v[200:203], a[40:43], v[72:75], v[200:203]
    v_mfma_f32_16x16x32_bf16 v[204:207], a[44:47], v[72:75], v[204:207]
    v_mfma_f32_16x16x32_bf16 v[208:211], a[32:35], v[76:79], v[208:211]
    v_mfma_f32_16x16x32_bf16 v[212:215], a[36:39], v[76:79], v[212:215]
    v_mfma_f32_16x16x32_bf16 v[216:219], a[40:43], v[76:79], v[216:219]
    v_mfma_f32_16x16x32_bf16 v[220:223], a[44:47], v[76:79], v[220:223]
    s_waitcnt vmcnt(23) lgkmcnt(0)
    s_barrier
    v_mfma_f32_16x16x32_bf16 v[160:163], a[48:51], v[80:83], v[160:163]
    ds_read_b128 v[64:67], v224 offset:16384
    v_mfma_f32_16x16x32_bf16 v[164:167], a[52:55], v[80:83], v[164:167]
    ds_read_b128 v[68:71], v224 offset:18432
    s_add_u32 s38, s36, 40960
    buffer_store_dwordx4 v[56:59], v240, s[16:19], s38 offen offset:2304 sc1
    v_mfma_f32_16x16x32_bf16 v[168:171], a[56:59], v[80:83], v[168:171]
    ds_read_b128 v[72:75], v224 offset:20480
    v_mfma_f32_16x16x32_bf16 v[172:175], a[60:63], v[80:83], v[172:175]
    ds_read_b128 v[76:79], v224 offset:22528
    v_mfma_f32_16x16x32_bf16 v[176:179], a[48:51], v[84:87], v[176:179]
    v_mfma_f32_16x16x32_bf16 v[180:183], a[52:55], v[84:87], v[180:183]
    v_mfma_f32_16x16x32_bf16 v[184:187], a[56:59], v[84:87], v[184:187]
    v_mfma_f32_16x16x32_bf16 v[188:191], a[60:63], v[84:87], v[188:191]
    v_mfma_f32_16x16x32_bf16 v[192:195], a[48:51], v[88:91], v[192:195]
    s_add_u32 m0, s31, 5120
    s_add_u32 s24, s27, 163840
    buffer_load_dwordx4 v245, s[12:15], s24 offen lds
    v_mfma_f32_16x16x32_bf16 v[196:199], a[52:55], v[88:91], v[196:199]
    v_mfma_f32_16x16x32_bf16 v[200:203], a[56:59], v[88:91], v[200:203]
    v_mfma_f32_16x16x32_bf16 v[204:207], a[60:63], v[88:91], v[204:207]
    v_mfma_f32_16x16x32_bf16 v[208:211], a[48:51], v[92:95], v[208:211]
    v_mfma_f32_16x16x32_bf16 v[212:215], a[52:55], v[92:95], v[212:215]
    v_mfma_f32_16x16x32_bf16 v[216:219], a[56:59], v[92:95], v[216:219]
    v_mfma_f32_16x16x32_bf16 v[220:223], a[60:63], v[92:95], v[220:223]
    s_waitcnt lgkmcnt(0)
    v_mfma_f32_16x16x32_bf16 v[160:163], a[64:67], v[64:67], v[160:163]
    ds_read_b128 v[80:83], v225 offset:16384
    v_mfma_f32_16x16x32_bf16 v[164:167], a[68:71], v[64:67], v[164:167]
    ds_read_b128 v[84:87], v225 offset:18432
    v_mfma_f32_16x16x32_bf16 v[168:171], a[72:75], v[64:67], v[168:171]
    ds_read_b128 v[88:91], v225 offset:20480
    v_mfma_f32_16x16x32_bf16 v[172:175], a[76:79], v[64:67], v[172:175]
    ds_read_b128 v[92:95], v225 offset:22528
    v_mfma_f32_16x16x32_bf16 v[176:179], a[64:67], v[68:71], v[176:179]
    v_mfma_f32_16x16x32_bf16 v[180:183], a[68:71], v[68:71], v[180:183]
    v_mfma_f32_16x16x32_bf16 v[184:187], a[72:75], v[68:71], v[184:187]
    v_mfma_f32_16x16x32_bf16 v[188:191], a[76:79], v[68:71], v[188:191]
    s_add_u32 s38, s36, 45056
    buffer_store_dwordx4 v[60:63], v240, s[16:19], s38 offen offset:256 sc1
    v_mfma_f32_16x16x32_bf16 v[192:195], a[64:67], v[72:75], v[192:195]
    s_add_u32 m0, s31, 6144
    s_add_u32 s24, s27, 196608
    buffer_load_dwordx4 v237, s[12:15], s24 offen lds
    v_mfma_f32_16x16x32_bf16 v[196:199], a[68:71], v[72:75], v[196:199]
    v_mfma_f32_16x16x32_bf16 v[200:203], a[72:75], v[72:75], v[200:203]
    v_mfma_f32_16x16x32_bf16 v[204:207], a[76:79], v[72:75], v[204:207]
    v_mfma_f32_16x16x32_bf16 v[208:211], a[64:67], v[76:79], v[208:211]
    v_mfma_f32_16x16x32_bf16 v[212:215], a[68:71], v[76:79], v[212:215]
    v_mfma_f32_16x16x32_bf16 v[216:219], a[72:75], v[76:79], v[216:219]
    v_mfma_f32_16x16x32_bf16 v[220:223], a[76:79], v[76:79], v[220:223]
    s_waitcnt lgkmcnt(0)
    v_mfma_f32_16x16x32_bf16 v[160:163], a[80:83], v[80:83], v[160:163]
    ds_read_b128 v[64:67], v224 offset:24576
    v_mfma_f32_16x16x32_bf16 v[164:167], a[84:87], v[80:83], v[164:167]
    ds_read_b128 v[68:71], v224 offset:26624
    v_mfma_f32_16x16x32_bf16 v[168:171], a[88:91], v[80:83], v[168:171]
    ds_read_b128 v[72:75], v224 offset:28672
    v_mfma_f32_16x16x32_bf16 v[172:175], a[92:95], v[80:83], v[172:175]
    ds_read_b128 v[76:79], v224 offset:30720
    v_mfma_f32_16x16x32_bf16 v[176:179], a[80:83], v[84:87], v[176:179]
    v_mfma_f32_16x16x32_bf16 v[180:183], a[84:87], v[84:87], v[180:183]
    v_mfma_f32_16x16x32_bf16 v[184:187], a[88:91], v[84:87], v[184:187]
    v_mfma_f32_16x16x32_bf16 v[188:191], a[92:95], v[84:87], v[188:191]
    v_mfma_f32_16x16x32_bf16 v[192:195], a[80:83], v[88:91], v[192:195]
    s_add_u32 m0, s31, 7168
    s_add_u32 s24, s27, 229376
    buffer_load_dwordx4 v237, s[12:15], s24 offen lds
    v_mfma_f32_16x16x32_bf16 v[196:199], a[84:87], v[88:91], v[196:199]
    v_mfma_f32_16x16x32_bf16 v[200:203], a[88:91], v[88:91], v[200:203]
    s_add_u32 s27, s27, 1048576
    s_and_b32 s27, s27, 0x407fffff
    s_cmp_eq_u32 s27, s7
    s_cselect_b32 s27, s43, s27
    v_mfma_f32_16x16x32_bf16 v[204:207], a[92:95], v[88:91], v[204:207]
    v_mfma_f32_16x16x32_bf16 v[208:211], a[80:83], v[92:95], v[208:211]
    v_mfma_f32_16x16x32_bf16 v[212:215], a[84:87], v[92:95], v[212:215]
    s_add_u32 s31, s31, 32768
    s_cmp_ge_u32 s31, 163840
    s_cselect_b32 s24, 98304, 0
    s_sub_u32 s31, s31, s24
    s_add_u32 s38, s36, 65536
    buffer_store_dwordx4 v[0:3], v240, s[16:19], s38 offen offset:2560 sc1
    v_mfma_f32_16x16x32_bf16 v[216:219], a[88:91], v[92:95], v[216:219]
    v_mfma_f32_16x16x32_bf16 v[220:223], a[92:95], v[92:95], v[220:223]
    s_waitcnt lgkmcnt(0)
    v_mfma_f32_16x16x32_bf16 v[160:163], a[96:99], v[64:67], v[160:163]
    ds_read_b128 v[80:83], v225 offset:24576
    v_mfma_f32_16x16x32_bf16 v[164:167], a[100:103], v[64:67], v[164:167]
    ds_read_b128 v[84:87], v225 offset:26624
    v_mfma_f32_16x16x32_bf16 v[168:171], a[104:107], v[64:67], v[168:171]
    ds_read_b128 v[88:91], v225 offset:28672
    v_mfma_f32_16x16x32_bf16 v[172:175], a[108:111], v[64:67], v[172:175]
    ds_read_b128 v[92:95], v225 offset:30720
    v_mfma_f32_16x16x32_bf16 v[176:179], a[96:99], v[68:71], v[176:179]
    v_mfma_f32_16x16x32_bf16 v[180:183], a[100:103], v[68:71], v[180:183]
    v_mfma_f32_16x16x32_bf16 v[184:187], a[104:107], v[68:71], v[184:187]
    v_mfma_f32_16x16x32_bf16 v[188:191], a[108:111], v[68:71], v[188:191]
    v_mfma_f32_16x16x32_bf16 v[192:195], a[96:99], v[72:75], v[192:195]
    v_mfma_f32_16x16x32_bf16 v[196:199], a[100:103], v[72:75], v[196:199]
    v_mfma_f32_16x16x32_bf16 v[200:203], a[104:107], v[72:75], v[200:203]
    v_mfma_f32_16x16x32_bf16 v[204:207], a[108:111], v[72:75], v[204:207]
    v_mfma_f32_16x16x32_bf16 v[208:211], a[96:99], v[76:79], v[208:211]
    v_mfma_f32_16x16x32_bf16 v[212:215], a[100:103], v[76:79], v[212:215]
    v_mfma_f32_16x16x32_bf16 v[216:219], a[104:107], v[76:79], v[216:219]
    v_mfma_f32_16x16x32_bf16 v[220:223], a[108:111], v[76:79], v[220:223]
    s_waitcnt vmcnt(9) lgkmcnt(0)
    s_barrier
    v_mfma_f32_16x16x32_bf16 v[160:163], a[112:115], v[80:83], v[160:163]
    ds_read_b128 v[64:67], v224 offset:32768
    v_mfma_f32_16x16x32_bf16 v[164:167], a[116:119], v[80:83], v[164:167]
    ds_read_b128 v[68:71], v224 offset:34816
    v_mfma_f32_16x16x32_bf16 v[168:171], a[120:123], v[80:83], v[168:171]
    ds_read_b128 v[72:75], v224 offset:36864
    s_add_u32 s38, s36, 69632
    buffer_store_dwordx4 v[4:7], v240, s[16:19], s38 offen offset:512 sc1
    v_mfma_f32_16x16x32_bf16 v[172:175], a[124:127], v[80:83], v[172:175]
    ds_read_b128 v[76:79], v224 offset:38912
    v_mfma_f32_16x16x32_bf16 v[176:179], a[112:115], v[84:87], v[176:179]
    v_mfma_f32_16x16x32_bf16 v[180:183], a[116:119], v[84:87], v[180:183]
    v_mfma_f32_16x16x32_bf16 v[184:187], a[120:123], v[84:87], v[184:187]
    v_mfma_f32_16x16x32_bf16 v[188:191], a[124:127], v[84:87], v[188:191]
    v_mfma_f32_16x16x32_bf16 v[192:195], a[112:115], v[88:91], v[192:195]
    v_mfma_f32_16x16x32_bf16 v[196:199], a[116:119], v[88:91], v[196:199]
    v_mfma_f32_16x16x32_bf16 v[200:203], a[120:123], v[88:91], v[200:203]
    v_mfma_f32_16x16x32_bf16 v[204:207], a[124:127], v[88:91], v[204:207]
    v_mfma_f32_16x16x32_bf16 v[208:211], a[112:115], v[92:95], v[208:211]
    v_mfma_f32_16x16x32_bf16 v[212:215], a[116:119], v[92:95], v[212:215]
    v_mfma_f32_16x16x32_bf16 v[216:219], a[120:123], v[92:95], v[216:219]
    v_mfma_f32_16x16x32_bf16 v[220:223], a[124:127], v[92:95], v[220:223]
    s_waitcnt lgkmcnt(0)
    v_mfma_f32_16x16x32_bf16 v[160:163], a[128:131], v[64:67], v[160:163]
    ds_read_b128 v[80:83], v225 offset:32768
    v_mfma_f32_16x16x32_bf16 v[164:167], a[132:135], v[64:67], v[164:167]
    ds_read_b128 v[84:87], v225 offset:34816
    v_mfma_f32_16x16x32_bf16 v[168:171], a[136:139], v[64:67], v[168:171]
    ds_read_b128 v[88:91], v225 offset:36864
    v_mfma_f32_16x16x32_bf16 v[172:175], a[140:143], v[64:67], v[172:175]
    ds_read_b128 v[92:95], v225 offset:38912
    v_mfma_f32_16x16x32_bf16 v[176:179], a[128:131], v[68:71], v[176:179]
    v_mfma_f32_16x16x32_bf16 v[180:183], a[132:135], v[68:71], v[180:183]
    v_mfma_f32_16x16x32_bf16 v[184:187], a[136:139], v[68:71], v[184:187]
    v_mfma_f32_16x16x32_bf16 v[188:191], a[140:143], v[68:71], v[188:191]
    v_mfma_f32_16x16x32_bf16 v[192:195], a[128:131], v[72:75], v[192:195]
    buffer_load_dword v254, off, s[88:91], s39 sc1
    s_add_u32 s38, s36, 65536
    buffer_store_dwordx4 v[8:11], v240, s[16:19], s38 offen offset:3584 sc1
    v_mfma_f32_16x16x32_bf16 v[196:199], a[132:135], v[72:75], v[196:199]
    v_mfma_f32_16x16x32_bf16 v[200:203], a[136:139], v[72:75], v[200:203]
    v_mfma_f32_16x16x32_bf16 v[204:207], a[140:143], v[72:75], v[204:207]
    v_mfma_f32_16x16x32_bf16 v[208:211], a[128:131], v[76:79], v[208:211]
    v_mfma_f32_16x16x32_bf16 v[212:215], a[132:135], v[76:79], v[212:215]
    v_mfma_f32_16x16x32_bf16 v[216:219], a[136:139], v[76:79], v[216:219]
    v_mfma_f32_16x16x32_bf16 v[220:223], a[140:143], v[76:79], v[220:223]
    s_waitcnt lgkmcnt(0)
    v_mfma_f32_16x16x32_bf16 v[160:163], a[144:147], v[80:83], v[160:163]
    ds_read_b128 v[64:67], v224 offset:40960
    v_mfma_f32_16x16x32_bf16 v[164:167], a[148:151], v[80:83], v[164:167]
    ds_read_b128 v[68:71], v224 offset:43008
    v_mfma_f32_16x16x32_bf16 v[168:171], a[152:155], v[80:83], v[168:171]
    ds_read_b128 v[72:75], v224 offset:45056
    v_mfma_f32_16x16x32_bf16 v[172:175], a[156:159], v[80:83], v[172:175]
    ds_read_b128 v[76:79], v224 offset:47104
    v_mfma_f32_16x16x32_bf16 v[176:179], a[144:147], v[84:87], v[176:179]
    v_mfma_f32_16x16x32_bf16 v[180:183], a[148:151], v[84:87], v[180:183]
    v_mfma_f32_16x16x32_bf16 v[184:187], a[152:155], v[84:87], v[184:187]
    v_mfma_f32_16x16x32_bf16 v[188:191], a[156:159], v[84:87], v[188:191]
    v_mfma_f32_16x16x32_bf16 v[192:195], a[144:147], v[88:91], v[192:195]
    v_mfma_f32_16x16x32_bf16 v[196:199], a[148:151], v[88:91], v[196:199]
    v_mfma_f32_16x16x32_bf16 v[200:203], a[152:155], v[88:91], v[200:203]
    v_mfma_f32_16x16x32_bf16 v[204:207], a[156:159], v[88:91], v[204:207]
    v_mfma_f32_16x16x32_bf16 v[208:211], a[144:147], v[92:95], v[208:211]
    v_mfma_f32_16x16x32_bf16 v[212:215], a[148:151], v[92:95], v[212:215]
    s_add_u32 s38, s36, 69632
    buffer_store_dwordx4 v[12:15], v240, s[16:19], s38 offen offset:1536 sc1
    v_mfma_f32_16x16x32_bf16 v[216:219], a[152:155], v[92:95], v[216:219]
    v_mfma_f32_16x16x32_bf16 v[220:223], a[156:159], v[92:95], v[220:223]
    s_waitcnt lgkmcnt(0)
    v_mfma_f32_16x16x32_bf16 v[160:163], a[160:163], v[64:67], v[160:163]
    ds_read_b128 v[80:83], v225 offset:40960
    v_mfma_f32_16x16x32_bf16 v[164:167], a[164:167], v[64:67], v[164:167]
    ds_read_b128 v[84:87], v225 offset:43008
    v_mfma_f32_16x16x32_bf16 v[168:171], a[168:171], v[64:67], v[168:171]
    ds_read_b128 v[88:91], v225 offset:45056
    v_mfma_f32_16x16x32_bf16 v[172:175], a[172:175], v[64:67], v[172:175]
    ds_read_b128 v[92:95], v225 offset:47104
    v_mfma_f32_16x16x32_bf16 v[176:179], a[160:163], v[68:71], v[176:179]
    v_mfma_f32_16x16x32_bf16 v[180:183], a[164:167], v[68:71], v[180:183]
    v_mfma_f32_16x16x32_bf16 v[184:187], a[168:171], v[68:71], v[184:187]
    v_mfma_f32_16x16x32_bf16 v[188:191], a[172:175], v[68:71], v[188:191]
    v_mfma_f32_16x16x32_bf16 v[192:195], a[160:163], v[72:75], v[192:195]
    v_mfma_f32_16x16x32_bf16 v[196:199], a[164:167], v[72:75], v[196:199]
    v_mfma_f32_16x16x32_bf16 v[200:203], a[168:171], v[72:75], v[200:203]
    v_mfma_f32_16x16x32_bf16 v[204:207], a[172:175], v[72:75], v[204:207]
    v_mfma_f32_16x16x32_bf16 v[208:211], a[160:163], v[76:79], v[208:211]
    v_mfma_f32_16x16x32_bf16 v[212:215], a[164:167], v[76:79], v[212:215]
    v_mfma_f32_16x16x32_bf16 v[216:219], a[168:171], v[76:79], v[216:219]
    v_mfma_f32_16x16x32_bf16 v[220:223], a[172:175], v[76:79], v[220:223]
    s_waitcnt lgkmcnt(0)
    v_mfma_f32_16x16x32_bf16 v[160:163], a[176:179], v[80:83], v[160:163]
    ds_read_b128 v[64:67], v224 offset:49152
    v_mfma_f32_16x16x32_bf16 v[164:167], a[180:183], v[80:83], v[164:167]
    ds_read_b128 v[68:71], v224 offset:51200
    v_mfma_f32_16x16x32_bf16 v[168:171], a[184:187], v[80:83], v[168:171]
    ds_read_b128 v[72:75], v224 offset:53248
    v_mfma_f32_16x16x32_bf16 v[172:175], a[188:191], v[80:83], v[172:175]
    ds_read_b128 v[76:79], v224 offset:55296
    s_add_u32 s38, s36, 73728
    buffer_store_dwordx4 v[16:19], v240, s[16:19], s38 offen offset:2560 sc1
    v_mfma_f32_16x16x32_bf16 v[176:179], a[176:179], v[84:87], v[176:179]
    v_mfma_f32_16x16x32_bf16 v[180:183], a[180:183], v[84:87], v[180:183]
    v_mfma_f32_16x16x32_bf16 v[184:187], a[184:187], v[84:87], v[184:187]
    v_mfma_f32_16x16x32_bf16 v[188:191], a[188:191], v[84:87], v[188:191]
    v_mfma_f32_16x16x32_bf16 v[192:195], a[176:179], v[88:91], v[192:195]
    v_mfma_f32_16x16x32_bf16 v[196:199], a[180:183], v[88:91], v[196:199]
    v_mfma_f32_16x16x32_bf16 v[200:203], a[184:187], v[88:91], v[200:203]
    v_mfma_f32_16x16x32_bf16 v[204:207], a[188:191], v[88:91], v[204:207]
    v_mfma_f32_16x16x32_bf16 v[208:211], a[176:179], v[92:95], v[208:211]
    v_mfma_f32_16x16x32_bf16 v[212:215], a[180:183], v[92:95], v[212:215]
    v_mfma_f32_16x16x32_bf16 v[216:219], a[184:187], v[92:95], v[216:219]
    v_mfma_f32_16x16x32_bf16 v[220:223], a[188:191], v[92:95], v[220:223]
    s_waitcnt vmcnt(3)
    v_readfirstlane_b32 s24, v254
    s_lshl_b32 s25, s3, 16
    s_add_u32 s24, s24, s25
    s_cmp_ge_u32 s24, 32
    s_cbranch_scc0 kf_spin33
kf_spinr34:
    s_waitcnt lgkmcnt(0)
    s_barrier
    v_mfma_f32_16x16x32_bf16 v[160:163], a[192:195], v[64:67], v[160:163]
    ds_read_b128 v[80:83], v225 offset:49152
    v_mfma_f32_16x16x32_bf16 v[164:167], a[196:199], v[64:67], v[164:167]
    ds_read_b128 v[84:87], v225 offset:51200
    v_mfma_f32_16x16x32_bf16 v[168:171], a[200:203], v[64:67], v[168:171]
    ds_read_b128 v[88:91], v225 offset:53248
    v_mfma_f32_16x16x32_bf16 v[172:175], a[204:207], v[64:67], v[172:175]
    ds_read_b128 v[92:95], v225 offset:55296
    v_mfma_f32_16x16x32_bf16 v[176:179], a[192:195], v[68:71], v[176:179]
    v_mfma_f32_16x16x32_bf16 v[180:183], a[196:199], v[68:71], v[180:183]
    v_mfma_f32_16x16x32_bf16 v[184:187], a[200:203], v[68:71], v[184:187]
    v_mfma_f32_16x16x32_bf16 v[188:191], a[204:207], v[68:71], v[188:191]
    v_mfma_f32_16x16x32_bf16 v[192:195], a[192:195], v[72:75], v[192:195]
    buffer_load_dwordx4 a[128:131], v248, s[8:11], s28 offen offset:0 sc1
    s_add_u32 s38, s36, 77824
    buffer_store_dwordx4 v[20:23], v240, s[16:19], s38 offen offset:512 sc1
    v_mfma_f32_16x16x32_bf16 v[196:199], a[196:199], v[72:75], v[196:199]
    v_mfma_f32_16x16x32_bf16 v[200:203], a[200:203], v[72:75], v[200:203]
    buffer_load_dwordx4 a[132:135], v248, s[8:11], s29 offen offset:0 sc1
    v_mfma_f32_16x16x32_bf16 v[204:207], a[204:207], v[72:75], v[204:207]
    v_mfma_f32_16x16x32_bf16 v[208:211], a[192:195], v[76:79], v[208:211]
    v_mfma_f32_16x16x32_bf16 v[212:215], a[196:199], v[76:79], v[212:215]
    buffer_load_dwordx4 a[136:139], v249, s[8:11], s28 offen offset:0 sc1
    v_mfma_f32_16x16x32_bf16 v[216:219], a[200:203], v[76:79], v[216:219]
    v_mfma_f32_16x16x32_bf16 v[220:223], a[204:207], v[76:79], v[220:223]
    s_waitcnt lgkmcnt(0)
    v_mfma_f32_16x16x32_bf16 v[160:163], a[208:211], v[80:83], v[160:163]
    ds_read_b128 v[64:67], v224 offset:57344
    v_mfma_f32_16x16x32_bf16 v[164:167], a[212:215], v[80:83], v[164:167]
    ds_read_b128 v[68:71], v224 offset:59392
    v_mfma_f32_16x16x32_bf16 v[168:171], a[216:219], v[80:83], v[168:171]
    ds_read_b128 v[72:75], v224 offset:61440
    v_mfma_f32_16x16x32_bf16 v[172:175], a[220:223], v[80:83], v[172:175]
    ds_read_b128 v[76:79], v224 offset:63488
    v_mfma_f32_16x16x32_bf16 v[176:179], a[208:211], v[84:87], v[176:179]
    v_mfma_f32_16x16x32_bf16 v[180:183], a[212:215], v[84:87], v[180:183]
    v_mfma_f32_16x16x32_bf16 v[184:187], a[216:219], v[84:87], v[184:187]
    v_mfma_f32_16x16x32_bf16 v[188:191], a[220:223], v[84:87], v[188:191]
    v_mfma_f32_16x16x32_bf16 v[192:195], a[208:211], v[88:91], v[192:195]
    buffer_load_dwordx4 a[140:143], v249, s[8:11], s29 offen offset:0 sc1
    v_mfma_f32_16x16x32_bf16 v[196:199], a[212:215], v[88:91], v[196:199]
    v_mfma_f32_16x16x32_bf16 v[200:203], a[216:219], v[88:91], v[200:203]
    buffer_load_dwordx4 a[144:147], v248, s[8:11], s28 offen offset:1024 sc1
    v_mfma_f32_16x16x32_bf16 v[204:207], a[220:223], v[88:91], v[204:207]
    v_mfma_f32_16x16x32_bf16 v[208:211], a[208:211], v[92:95], v[208:211]
    v_mfma_f32_16x16x32_bf16 v[212:215], a[212:215], v[92:95], v[212:215]
    buffer_load_dwordx4 a[148:151], v248, s[8:11], s29 offen offset:1024 sc1
    v_mfma_f32_16x16x32_bf16 v[216:219], a[216:219], v[92:95], v[216:219]
    s_add_u32 s38, s36, 73728
    buffer_store_dwordx4 v[24:27], v240, s[16:19], s38 offen offset:3584 sc1
    v_mfma_f32_16x16x32_bf16 v[220:223], a[220:223], v[92:95], v[220:223]
    s_waitcnt lgkmcnt(0)
    v_mfma_f32_16x16x32_bf16 v[160:163], a[224:227], v[64:67], v[160:163]
    ds_read_b128 v[80:83], v225 offset:57344
    v_mfma_f32_16x16x32_bf16 v[164:167], a[228:231], v[64:67], v[164:167]
    ds_read_b128 v[84:87], v225 offset:59392
    v_mfma_f32_16x16x32_bf16 v[168:171], a[232:235], v[64:67], v[168:171]
    ds_read_b128 v[88:91], v225 offset:61440
    v_mfma_f32_16x16x32_bf16 v[172:175], a[236:239], v[64:67], v[172:175]
    ds_read_b128 v[92:95], v225 offset:63488
    v_mfma_f32_16x16x32_bf16 v[176:179], a[224:227], v[68:71], v[176:179]
    v_mfma_f32_16x16x32_bf16 v[180:183], a[228:231], v[68:71], v[180:183]
    v_mfma_f32_16x16x32_bf16 v[184:187], a[232:235], v[68:71], v[184:187]
    v_mfma_f32_16x16x32_bf16 v[188:191], a[236:239], v[68:71], v[188:191]
    v_mfma_f32_16x16x32_bf16 v[192:195], a[224:227], v[72:75], v[192:195]
    buffer_load_dwordx4 a[152:155], v249, s[8:11], s28 offen offset:1024 sc1
    v_mfma_f32_16x16x32_bf16 v[196:199], a[228:231], v[72:75], v[196:199]
    v_mfma_f32_16x16x32_bf16 v[200:203], a[232:235], v[72:75], v[200:203]
    buffer_load_dwordx4 a[156:159], v249, s[8:11], s29 offen offset:1024 sc1
    v_mfma_f32_16x16x32_bf16 v[204:207], a[236:239], v[72:75], v[204:207]
    v_mfma_f32_16x16x32_bf16 v[208:211], a[224:227], v[76:79], v[208:211]
    v_mfma_f32_16x16x32_bf16 v[212:215], a[228:231], v[76:79], v[212:215]
    buffer_load_dwordx4 a[160:163], v248, s[8:11], s28 offen offset:2048 sc1
    v_mfma_f32_16x16x32_bf16 v[216:219], a[232:235], v[76:79], v[216:219]
    v_mfma_f32_16x16x32_bf16 v[220:223], a[236:239], v[76:79], v[220:223]
    s_waitcnt vmcnt(38) lgkmcnt(0)
    s_barrier
    v_mfma_f32_16x16x32_bf16 v[160:163], a[240:243], v[80:83], v[160:163]
    ds_read_b64_tr_b16 a[192:193], v246 offset:0
    v_mfma_f32_16x16x32_bf16 v[164:167], a[244:247], v[80:83], v[164:167]
    ds_read_b64_tr_b16 a[194:195], v246 offset:1024
    v_mfma_f32_16x16x32_bf16 v[168:171], a[248:251], v[80:83], v[168:171]
    ds_read_b64_tr_b16 a[196:197], v238 offset:0
    v_mfma_f32_16x16x32_bf16 v[172:175], a[252:255], v[80:83], v[172:175]
    ds_read_b64_tr_b16 a[198:199], v238 offset:1024
    v_mfma_f32_16x16x32_bf16 v[176:179], a[240:243], v[84:87], v[176:179]
    ds_read_b64_tr_b16 a[200:201], v246 offset:256
    s_add_u32 s38, s36, 77824
    buffer_store_dwordx4 v[28:31], v240, s[16:19], s38 offen offset:1536 sc1
    v_mfma_f32_16x16x32_bf16 v[180:183], a[244:247], v[84:87], v[180:183]
    ds_read_b64_tr_b16 a[202:203], v246 offset:1280
    v_mfma_f32_16x16x32_bf16 v[184:187], a[248:251], v[84:87], v[184:187]
    ds_read_b64_tr_b16 a[204:205], v238 offset:256
    v_mfma_f32_16x16x32_bf16 v[188:191], a[252:255], v[84:87], v[188:191]
    ds_read_b64_tr_b16 a[206:207], v238 offset:1280
    v_mfma_f32_16x16x32_bf16 v[192:195], a[240:243], v[88:91], v[192:195]
    buffer_load_dwordx4 a[164:167], v248, s[8:11], s29 offen offset:2048 sc1
    v_mfma_f32_16x16x32_bf16 v[196:199], a[244:247], v[88:91], v[196:199]
    v_cvt_pk_bf16_f32 v32, v160, v161
    v_cvt_pk_bf16_f32 v33, v162, v163
    v_mfma_f32_16x16x32_bf16 v[200:203], a[248:251], v[88:91], v[200:203]
    buffer_load_dwordx4 a[168:171], v249, s[8:11], s28 offen offset:2048 sc1
    v_cvt_pk_bf16_f32 v34, v164, v165
    v_cvt_pk_bf16_f32 v35, v166, v167
    v_mfma_f32_16x16x32_bf16 v[204:207], a[252:255], v[88:91], v[204:207]
    v_cvt_pk_bf16_f32 v36, v168, v169
    v_cvt_pk_bf16_f32 v37, v170, v171
    v_mfma_f32_16x16x32_bf16 v[208:211], a[240:243], v[92:95], v[208:211]
    v_cvt_pk_bf16_f32 v38, v172, v173
    v_cvt_pk_bf16_f32 v39, v174, v175
    v_mfma_f32_16x16x32_bf16 v[212:215], a[244:247], v[92:95], v[212:215]
    buffer_load_dwordx4 a[172:175], v249, s[8:11], s29 offen offset:2048 sc1
    v_cvt_pk_bf16_f32 v40, v176, v177
    v_cvt_pk_bf16_f32 v41, v178, v179
    v_mfma_f32_16x16x32_bf16 v[216:219], a[248:251], v[92:95], v[216:219]
    v_cvt_pk_bf16_f32 v42, v180, v181
    v_cvt_pk_bf16_f32 v43, v182, v183
    v_mfma_f32_16x16x32_bf16 v[220:223], a[252:255], v[92:95], v[220:223]
    v_cvt_pk_bf16_f32 v44, v184, v185
    v_cvt_pk_bf16_f32 v45, v186, v187
    s_nop 3
    v_cvt_pk_bf16_f32 v46, v188, v189
    v_cvt_pk_bf16_f32 v47, v190, v191
    v_cvt_pk_bf16_f32 v48, v192, v193
    v_cvt_pk_bf16_f32 v49, v194, v195
    v_cvt_pk_bf16_f32 v50, v196, v197
    v_cvt_pk_bf16_f32 v51, v198, v199
    v_cvt_pk_bf16_f32 v52, v200, v201
    v_cvt_pk_bf16_f32 v53, v202, v203
    v_cvt_pk_bf16_f32 v54, v204, v205
    v_cvt_pk_bf16_f32 v55, v206, v207
    v_cvt_pk_bf16_f32 v56, v208, v209
    v_cvt_pk_bf16_f32 v57, v210, v211
    v_cvt_pk_bf16_f32 v58, v212, v213
    v_cvt_pk_bf16_f32 v59, v214, v215
    v_cvt_pk_bf16_f32 v60, v216, v217
    v_cvt_pk_bf16_f32 v61, v218, v219
    v_cvt_pk_bf16_f32 v62, v220, v221
    v_cvt_pk_bf16_f32 v63, v222, v223
    s_add_u32 s80, s36, 102144
    s_add_u32 s81, s36, 104192
    s_add_u32 s82, s36, 103168
    s_add_u32 s83, s36, 105216
    s_add_u32 s84, s36, 110336
    s_add_u32 s85, s36, 112384
    s_add_u32 s86, s36, 111360
    s_add_u32 s87, s36, 113408
    s_branch ka_Q
ka_V:
    s_waitcnt lgkmcnt(0)
    v_mfma_f32_16x16x32_bf16 v[96:99], v[64:67], a[0:3], 0
    ds_read_b128 v[80:83], v224 offset:8192
    v_mfma_f32_16x16x32_bf16 v[100:103], v[68:71], a[0:3], 0
    ds_read_b128 v[84:87], v224 offset:10240
    v_mfma_f32_16x16x32_bf16 v[104:107], v[64:67], a[4:7], 0
    ds_read_b128 v[88:91], v224 offset:12288
    v_mfma_f32_16x16x32_bf16 v[108:111], v[68:71], a[4:7], 0
    ds_read_b128 v[92:95], v224 offset:14336
    v_mfma_f32_16x16x32_bf16 v[112:115], v[64:67], a[8:11], 0
    ds_read_b64_tr_b16 a[16:17], v228 offset:4096
    v_mfma_f32_16x16x32_bf16 v[116:119], v[68:71], a[8:11], 0
    ds_read_b64_tr_b16 a[18:19], v228 offset:4608
    v_mfma_f32_16x16x32_bf16 v[120:123], v[64:67], a[12:15], 0
    ds_read_b64_tr_b16 a[20:21], v229 offset:4096
    v_mfma_f32_16x16x32_bf16 v[124:127], v[68:71], a[12:15], 0
    ds_read_b64_tr_b16 a[22:23], v229 offset:4608
    v_mfma_f32_16x16x32_bf16 v[128:131], v[72:75], a[0:3], 0
    s_add_u32 m0, s35, 16384
    s_and_b32 s33, s82, 1023
    s_lshl_b32 s33, s33, 12
    buffer_load_dwordx4 v234, s[48:51], s33 offen lds
    v_mfma_f32_16x16x32_bf16 v[132:135], v[76:79], a[0:3], 0
    buffer_load_dwordx4 v235, s[48:51], s33 offen offset:1024 lds
    v_mfma_f32_16x16x32_bf16 v[136:139], v[72:75], a[4:7], 0
    s_add_u32 m0, s35, 18432
    s_add_u32 s33, s33, 131072
    buffer_load_dwordx4 v234, s[48:51], s33 offen lds
    v_mfma_f32_16x16x32_bf16 v[140:143], v[76:79], a[4:7], 0
    v_mfma_f32_16x16x32_bf16 v[144:147], v[72:75], a[8:11], 0
    buffer_load_dwordx4 v235, s[48:51], s33 offen offset:1024 lds
    v_mfma_f32_16x16x32_bf16 v[148:151], v[76:79], a[8:11], 0
    buffer_load_dwordx4 v[0:3], v236, s[52:55], 0 offen offset:0
    v_mfma_f32_16x16x32_bf16 v[152:155], v[72:75], a[12:15], 0
    buffer_load_dwordx4 v[4:7], v236, s[52:55], 0 offen offset:512
    v_mfma_f32_16x16x32_bf16 v[156:159], v[76:79], a[12:15], 0
    s_waitcnt lgkmcnt(0)
    v_mfma_f32_16x16x32_bf16 v[160:163], v[80:83], a[0:3], 0
    ds_read_b128 v[64:67], v225 offset:0
    v_mfma_f32_16x16x32_bf16 v[164:167], v[84:87], a[0:3], 0
    ds_read_b128 v[68:71], v225 offset:2048
    v_mfma_f32_16x16x32_bf16 v[168:171], v[80:83], a[4:7], 0
    ds_read_b128 v[72:75], v225 offset:4096
    v_mfma_f32_16x16x32_bf16 v[172:175], v[84:87], a[4:7], 0
    ds_read_b128 v[76:79], v225 offset:6144
    v_mfma_f32_16x16x32_bf16 v[176:179], v[80:83], a[8:11], 0
    ds_read_b64_tr_b16 a[24:25], v230 offset:4096
    v_mfma_f32_16x16x32_bf16 v[180:183], v[84:87], a[8:11], 0
    ds_read_b64_tr_b16 a[26:27], v230 offset:4608
    v_mfma_f32_16x16x32_bf16 v[184:187], v[80:83], a[12:15], 0
    ds_read_b64_tr_b16 a[28:29], v231 offset:4096
    v_mfma_f32_16x16x32_bf16 v[188:191], v[84:87], a[12:15], 0
    ds_read_b64_tr_b16 a[30:31], v231 offset:4608
    v_mfma_f32_16x16x32_bf16 v[192:195], v[88:91], a[0:3], 0
    s_add_u32 m0, s35, 20480
    s_add_u32 s33, s33, 131072
    buffer_load_dwordx4 v234, s[48:51], s33 offen lds
    v_mfma_f32_16x16x32_bf16 v[196:199], v[92:95], a[0:3], 0
    buffer_load_dwordx4 v235, s[48:51], s33 offen offset:1024 lds
    v_mfma_f32_16x16x32_bf16 v[200:203], v[88:91], a[4:7], 0
    s_add_u32 m0, s35, 22528
    s_add_u32 s33, s33, 131072
    buffer_load_dwordx4 v234, s[48:51], s33 offen lds
    v_mfma_f32_16x16x32_bf16 v[204:207], v[92:95], a[4:7], 0
    v_mfma_f32_16x16x32_bf16 v[208:211], v[88:91], a[8:11], 0
    buffer_load_dwordx4 v235, s[48:51], s33 offen offset:1024 lds
    v_mfma_f32_16x16x32_bf16 v[212:215], v[92:95], a[8:11], 0
    buffer_load_dwordx4 v[8:11], v236, s[52:55], 0 offen offset:1024
    v_mfma_f32_16x16x32_bf16 v[216:219], v[88:91], a[12:15], 0
    buffer_load_dwordx4 v[12:15], v236, s[52:55], 0 offen offset:1536
    v_mfma_f32_16x16x32_bf16 v[220:223], v[92:95], a[12:15], 0
    s_waitcnt vmcnt(17) lgkmcnt(0)
    v_mfma_f32_16x16x32_bf16 v[96:99], v[64:67], a[16:19], v[96:99]
    ds_read_b128 v[80:83], v225 offset:8192
    v_mfma_f32_16x16x32_bf16 v[100:103], v[68:71], a[16:19], v[100:103]
    ds_read_b128 v[84:87], v225 offset:10240
    v_mfma_f32_16x16x32_bf16 v[104:107], v[64:67], a[20:23], v[104:107]
    ds_read_b128 v[88:91], v225 offset:12288
    v_mfma_f32_16x16x32_bf16 v[108:111], v[68:71], a[20:23], v[108:111]
    ds_read_b128 v[92:95], v225 offset:14336
    v_mfma_f32_16x16x32_bf16 v[112:115], v[64:67], a[24:27], v[112:115]
    ds_read_b64_tr_b16 a[32:33], v228 offset:8192
    v_mfma_f32_16x16x32_bf16 v[116:119], v[68:71], a[24:27], v[116:119]
    ds_read_b64_tr_b16 a[34:35], v228 offset:8704
    v_mfma_f32_16x16x32_bf16 v[120:123], v[64:67], a[28:31], v[120:123]
    ds_read_b64_tr_b16 a[36:37], v229 offset:8192
    v_mfma_f32_16x16x32_bf16 v[124:127], v[68:71], a[28:31], v[124:127]
    ds_read_b64_tr_b16 a[38:39], v229 offset:8704
    v_mfma_f32_16x16x32_bf16 v[128:131], v[72:75], a[16:19], v[128:131]
    s_add_u32 m0, s34, 32768
    s_add_u32 s37, s82, 0
    buffer_load_dwordx4 v232, s[44:47], s37 offen lds
    v_mfma_f32_16x16x32_bf16 v[132:135], v[76:79], a[16:19], v[132:135]
    buffer_load_dwordx4 v233, s[44:47], s37 offen offset:1024 lds
    v_mfma_f32_16x16x32_bf16 v[136:139], v[72:75], a[20:23], v[136:139]
    s_add_u32 m0, s34, 40960
    s_add_u32 s37, s82, 65536
    buffer_load_dwordx4 v232, s[44:47], s37 offen lds
    v_mfma_f32_16x16x32_bf16 v[140:143], v[76:79], a[20:23], v[140:143]
    buffer_load_dwordx4 v233, s[44:47], s37 offen offset:1024 lds
    v_mfma_f32_16x16x32_bf16 v[144:147], v[72:75], a[24:27], v[144:147]
    s_add_u32 m0, s35, 0
    s_and_b32 s33, s83, 1023
    s_lshl_b32 s33, s33, 12
    buffer_load_dwordx4 v234, s[48:51], s33 offen lds
    v_mfma_f32_16x16x32_bf16 v[148:151], v[76:79], a[24:27], v[148:151]
    buffer_load_dwordx4 v235, s[48:51], s33 offen offset:1024 lds
    v_mfma_f32_16x16x32_bf16 v[152:155], v[72:75], a[28:31], v[152:155]
    s_add_u32 m0, s35, 2048
    s_add_u32 s33, s33, 131072
    buffer_load_dwordx4 v234, s[48:51], s33 offen lds
    v_mfma_f32_16x16x32_bf16 v[156:159], v[76:79], a[28:31], v[156:159]
    buffer_load_dwordx4 v235, s[48:51], s33 offen offset:1024 lds
    s_waitcnt vmcnt(21) lgkmcnt(0)
    s_barrier
    v_mfma_f32_16x16x32_bf16 v[160:163], v[80:83], a[16:19], v[160:163]
    ds_read_b128 v[64:67], v224 offset:16384
    v_mfma_f32_16x16x32_bf16 v[164:167], v[84:87], a[16:19], v[164:167]
    ds_read_b128 v[68:71], v224 offset:18432
    v_mfma_f32_16x16x32_bf16 v[168:171], v[80:83], a[20:23], v[168:171]
    ds_read_b128 v[72:75], v224 offset:20480
    v_mfma_f32_16x16x32_bf16 v[172:175], v[84:87], a[20:23], v[172:175]
    ds_read_b128 v[76:79], v224 offset:22528
    v_mfma_f32_16x16x32_bf16 v[176:179], v[80:83], a[24:27], v[176:179]
    ds_read_b64_tr_b16 a[40:41], v230 offset:8192
    v_mfma_f32_16x16x32_bf16 v[180:183], v[84:87], a[24:27], v[180:183]
    ds_read_b64_tr_b16 a[42:43], v230 offset:8704
    v_mfma_f32_16x16x32_bf16 v[184:187], v[80:83], a[28:31], v[184:187]
    ds_read_b64_tr_b16 a[44:45], v231 offset:8192
    v_mfma_f32_16x16x32_bf16 v[188:191], v[84:87], a[28:31], v[188:191]
    ds_read_b64_tr_b16 a[46:47], v231 offset:8704
    v_mfma_f32_16x16x32_bf16 v[192:195], v[88:91], a[16:19], v[192:195]
    s_add_u32 m0, s34, 49152
    s_add_u32 s37, s83, 0
    buffer_load_dwordx4 v232, s[44:47], s37 offen lds
    v_mfma_f32_16x16x32_bf16 v[196:199], v[92:95], a[16:19], v[196:199]
    buffer_load_dwordx4 v233, s[44:47], s37 offen offset:1024 lds
    v_mfma_f32_16x16x32_bf16 v[200:203], v[88:91], a[20:23], v[200:203]
    s_add_u32 m0, s34, 57344
    s_add_u32 s37, s83, 65536
    buffer_load_dwordx4 v232, s[44:47], s37 offen lds
    v_mfma_f32_16x16x32_bf16 v[204:207], v[92:95], a[20:23], v[204:207]
    v_mfma_f32_16x16x32_bf16 v[208:211], v[88:91], a[24:27], v[208:211]
    buffer_load_dwordx4 v233, s[44:47], s37 offen offset:1024 lds
    v_mfma_f32_16x16x32_bf16 v[212:215], v[92:95], a[24:27], v[212:215]
    s_add_u32 m0, s34, 0
    s_add_u32 s37, s84, 0
    buffer_load_dwordx4 v232, s[44:47], s37 offen lds
    v_mfma_f32_16x16x32_bf16 v[216:219], v[88:91], a[28:31], v[216:219]
    buffer_load_dwordx4 v233, s[44:47], s37 offen offset:1024 lds
    v_mfma_f32_16x16x32_bf16 v[220:223], v[92:95], a[28:31], v[220:223]
    s_waitcnt lgkmcnt(0)
    v_mfma_f32_16x16x32_bf16 v[96:99], v[64:67], a[32:35], v[96:99]
    ds_read_b128 v[80:83], v224 offset:24576
    v_mfma_f32_16x16x32_bf16 v[100:103], v[68:71], a[32:35], v[100:103]
    ds_read_b128 v[84:87], v224 offset:26624
    v_mfma_f32_16x16x32_bf16 v[104:107], v[64:67], a[36:39], v[104:107]
    ds_read_b128 v[88:91], v224 offset:28672
    v_mfma_f32_16x16x32_bf16 v[108:111], v[68:71], a[36:39], v[108:111]
    ds_read_b128 v[92:95], v224 offset:30720
    v_mfma_f32_16x16x32_bf16 v[112:115], v[64:67], a[40:43], v[112:115]
    ds_read_b64_tr_b16 a[48:49], v228 offset:12288
    v_mfma_f32_16x16x32_bf16 v[116:119], v[68:71], a[40:43], v[116:119]
    ds_read_b64_tr_b16 a[50:51], v228 offset:12800
    v_mfma_f32_16x16x32_bf16 v[120:123], v[64:67], a[44:47], v[120:123]
    ds_read_b64_tr_b16 a[52:53], v229 offset:12288
    v_mfma_f32_16x16x32_bf16 v[124:127], v[68:71], a[44:47], v[124:127]
    ds_read_b64_tr_b16 a[54:55], v229 offset:12800
    v_mfma_f32_16x16x32_bf16 v[128:131], v[72:75], a[32:35], v[128:131]
    s_add_u32 m0, s35, 4096
    s_add_u32 s33, s33, 131072
    buffer_load_dwordx4 v234, s[48:51], s33 offen lds
    v_mfma_f32_16x16x32_bf16 v[132:135], v[76:79], a[32:35], v[132:135]
    v_mfma_f32_16x16x32_bf16 v[136:139], v[72:75], a[36:39], v[136:139]
    buffer_load_dwordx4 v235, s[48:51], s33 offen offset:1024 lds
    v_mfma_f32_16x16x32_bf16 v[140:143], v[76:79], a[36:39], v[140:143]
    v_mfma_f32_16x16x32_bf16 v[144:147], v[72:75], a[40:43], v[144:147]
    s_add_u32 m0, s35, 6144
    s_add_u32 s33, s33, 131072
    buffer_load_dwordx4 v234, s[48:51], s33 offen lds
    v_mfma_f32_16x16x32_bf16 v[148:151], v[76:79], a[40:43], v[148:151]
    v_mfma_f32_16x16x32_bf16 v[152:155], v[72:75], a[44:47], v[152:155]
    buffer_load_dwordx4 v235, s[48:51], s33 offen offset:1024 lds
    v_mfma_f32_16x16x32_bf16 v[156:159], v[76:79], a[44:47], v[156:159]
    s_waitcnt lgkmcnt(0)
    v_mfma_f32_16x16x32_bf16 v[160:163], v[80:83], a[32:35], v[160:163]
    ds_read_b128 v[64:67], v225 offset:16384
    v_mfma_f32_16x16x32_bf16 v[164:167], v[84:87], a[32:35], v[164:167]
    ds_read_b128 v[68:71], v225 offset:18432
    v_mfma_f32_16x16x32_bf16 v[168:171], v[80:83], a[36:39], v[168:171]
    ds_read_b128 v[72:75], v225 offset:20480
    v_mfma_f32_16x16x32_bf16 v[172:175], v[84:87], a[36:39], v[172:175]
    ds_read_b128 v[76:79], v225 offset:22528
    v_mfma_f32_16x16x32_bf16 v[176:179], v[80:83], a[40:43], v[176:179]
    ds_read_b64_tr_b16 a[56:57], v230 offset:12288
    v_mfma_f32_16x16x32_bf16 v[180:183], v[84:87], a[40:43], v[180:183]
    ds_read_b64_tr_b16 a[58:59], v230 offset:12800
    v_mfma_f32_16x16x32_bf16 v[184:187], v[80:83], a[44:47], v[184:187]
    ds_read_b64_tr_b16 a[60:61], v231 offset:12288
    v_mfma_f32_16x16x32_bf16 v[188:191], v[84:87], a[44:47], v[188:191]
    ds_read_b64_tr_b16 a[62:63], v231 offset:12800
    v_mfma_f32_16x16x32_bf16 v[192:195], v[88:91], a[32:35], v[192:195]
    s_add_u32 m0, s34, 8192
    s_add_u32 s37, s84, 65536
    buffer_load_dwordx4 v232, s[44:47], s37 offen lds
    v_mfma_f32_16x16x32_bf16 v[196:199], v[92:95], a[32:35], v[196:199]
    v_mfma_f32_16x16x32_bf16 v[200:203], v[88:91], a[36:39], v[200:203]
    v_mfma_f32_16x16x32_bf16 v[204:207], v[92:95], a[36:39], v[204:207]
    v_mfma_f32_16x16x32_bf16 v[208:211], v[88:91], a[40:43], v[208:211]
    buffer_load_dwordx4 v233, s[44:47], s37 offen offset:1024 lds
    v_mfma_f32_16x16x32_bf16 v[212:215], v[92:95], a[40:43], v[212:215]
    v_mfma_f32_16x16x32_bf16 v[216:219], v[88:91], a[44:47], v[216:219]
    v_mfma_f32_16x16x32_bf16 v[220:223], v[92:95], a[44:47], v[220:223]
    s_waitcnt vmcnt(22) lgkmcnt(0)
    v_mfma_f32_16x16x32_bf16 v[96:99], v[64:67], a[48:51], v[96:99]
    ds_read_b128 v[80:83], v225 offset:24576
    v_mfma_f32_16x16x32_bf16 v[100:103], v[68:71], a[48:51], v[100:103]
    ds_read_b128 v[84:87], v225 offset:26624
    v_mfma_f32_16x16x32_bf16 v[104:107], v[64:67], a[52:55], v[104:107]
    ds_read_b128 v[88:91], v225 offset:28672
    v_mfma_f32_16x16x32_bf16 v[108:111], v[68:71], a[52:55], v[108:111]
    ds_read_b128 v[92:95], v225 offset:30720
    v_mfma_f32_16x16x32_bf16 v[112:115], v[64:67], a[56:59], v[112:115]
    ds_read_b64_tr_b16 a[64:65], v228 offset:16384
    v_mfma_f32_16x16x32_bf16 v[116:119], v[68:71], a[56:59], v[116:119]
    ds_read_b64_tr_b16 a[66:67], v228 offset:16896
    v_mfma_f32_16x16x32_bf16 v[120:123], v[64:67], a[60:63], v[120:123]
    ds_read_b64_tr_b16 a[68:69], v229 offset:16384
    v_mfma_f32_16x16x32_bf16 v[124:127], v[68:71], a[60:63], v[124:127]
    ds_read_b64_tr_b16 a[70:71], v229 offset:16896
    v_mfma_f32_16x16x32_bf16 v[128:131], v[72:75], a[48:51], v[128:131]
    s_add_u32 m0, s35, 8192
    s_and_b32 s33, s84, 1023
    s_lshl_b32 s33, s33, 12
    buffer_load_dwordx4 v234, s[48:51], s33 offen lds
    v_mfma_f32_16x16x32_bf16 v[132:135], v[76:79], a[48:51], v[132:135]
    v_mfma_f32_16x16x32_bf16 v[136:139], v[72:75], a[52:55], v[136:139]
    buffer_load_dwordx4 v235, s[48:51], s33 offen offset:1024 lds
    v_mfma_f32_16x16x32_bf16 v[140:143], v[76:79], a[52:55], v[140:143]
    v_mfma_f32_16x16x32_bf16 v[144:147], v[72:75], a[56:59], v[144:147]
    s_add_u32 m0, s35, 10240
    s_add_u32 s33, s33, 131072
    buffer_load_dwordx4 v234, s[48:51], s33 offen lds
    v_mfma_f32_16x16x32_bf16 v[148:151], v[76:79], a[56:59], v[148:151]
    v_mfma_f32_16x16x32_bf16 v[152:155], v[72:75], a[60:63], v[152:155]
    buffer_load_dwordx4 v235, s[48:51], s33 offen offset:1024 lds
    v_mfma_f32_16x16x32_bf16 v[156:159], v[76:79], a[60:63], v[156:159]
    s_waitcnt vmcnt(20) lgkmcnt(0)
    s_barrier
    v_mfma_f32_16x16x32_bf16 v[160:163], v[80:83], a[48:51], v[160:163]
    ds_read_b128 v[64:67], v224 offset:32768
    v_mfma_f32_16x16x32_bf16 v[164:167], v[84:87], a[48:51], v[164:167]
    ds_read_b128 v[68:71], v224 offset:34816
    v_mfma_f32_16x16x32_bf16 v[168:171], v[80:83], a[52:55], v[168:171]
    ds_read_b128 v[72:75], v224 offset:36864
    v_mfma_f32_16x16x32_bf16 v[172:175], v[84:87], a[52:55], v[172:175]
    ds_read_b128 v[76:79], v224 offset:38912
    v_mfma_f32_16x16x32_bf16 v[176:179], v[80:83], a[56:59], v[176:179]
    ds_read_b64_tr_b16 a[72:73], v230 offset:16384
    v_mfma_f32_16x16x32_bf16 v[180:183], v[84:87], a[56:59], v[180:183]
    ds_read_b64_tr_b16 a[74:75], v230 offset:16896
    v_mfma_f32_16x16x32_bf16 v[184:187], v[80:83], a[60:63], v[184:187]
    ds_read_b64_tr_b16 a[76:77], v231 offset:16384
    v_mfma_f32_16x16x32_bf16 v[188:191], v[84:87], a[60:63], v[188:191]
    ds_read_b64_tr_b16 a[78:79], v231 offset:16896
    v_mfma_f32_16x16x32_bf16 v[192:195], v[88:91], a[48:51], v[192:195]
    s_add_u32 m0, s34, 16384
    s_add_u32 s37, s85, 0
    buffer_load_dwordx4 v232, s[44:47], s37 offen lds
    v_mfma_f32_16x16x32_bf16 v[196:199], v[92:95], a[48:51], v[196:199]
    v_mfma_f32_16x16x32_bf16 v[200:203], v[88:91], a[52:55], v[200:203]
    v_mfma_f32_16x16x32_bf16 v[204:207], v[92:95], a[52:55], v[204:207]
    v_mfma_f32_16x16x32_bf16 v[208:211], v[88:91], a[56:59], v[208:211]
    buffer_load_dwordx4 v233, s[44:47], s37 offen offset:1024 lds
    v_mfma_f32_16x16x32_bf16 v[212:215], v[92:95], a[56:59], v[212:215]
    v_mfma_f32_16x16x32_bf16 v[216:219], v[88:91], a[60:63], v[216:219]
    v_mfma_f32_16x16x32_bf16 v[220:223], v[92:95], a[60:63], v[220:223]
    s_waitcnt lgkmcnt(0)
    v_mfma_f32_16x16x32_bf16 v[96:99], v[64:67], a[64:67], v[96:99]
    ds_read_b128 v[80:83], v224 offset:40960
    s_waitcnt vmcnt(26)
    v_mfma_f32_16x16x32_bf16 v[100:103], v[68:71], a[64:67], v[100:103]
    ds_read_b128 v[84:87], v224 offset:43008
    v_lshlrev_b32 v16, 16, v0
    v_mfma_f32_16x16x32_bf16 v[104:107], v[64:67], a[68:71], v[104:107]
    ds_read_b128 v[88:91], v224 offset:45056
    v_and_b32 v17, 0xffff0000, v0
    v_mfma_f32_16x16x32_bf16 v[108:111], v[68:71], a[68:71], v[108:111]
    ds_read_b128 v[92:95], v224 offset:47104
    v_lshlrev_b32 v18, 16, v1
    v_mfma_f32_16x16x32_bf16 v[112:115], v[64:67], a[72:75], v[112:115]
    ds_read_b64_tr_b16 a[80:81], v228 offset:20480
    v_and_b32 v19, 0xffff0000, v1
    v_mfma_f32_16x16x32_bf16 v[116:119], v[68:71], a[72:75], v[116:119]
    ds_read_b64_tr_b16 a[82:83], v228 offset:20992
    v_lshlrev_b32 v20, 16, v2
    v_mfma_f32_16x16x32_bf16 v[120:123], v[64:67], a[76:79], v[120:123]
    ds_read_b64_tr_b16 a[84:85], v229 offset:20480
    v_and_b32 v21, 0xffff0000, v2
    v_mfma_f32_16x16x32_bf16 v[124:127], v[68:71], a[76:79], v[124:127]
    ds_read_b64_tr_b16 a[86:87], v229 offset:20992
    v_lshlrev_b32 v22, 16, v3
    v_mfma_f32_16x16x32_bf16 v[128:131], v[72:75], a[64:67], v[128:131]
    s_add_u32 m0, s35, 12288
    s_add_u32 s33, s33, 131072
    buffer_load_dwordx4 v234, s[48:51], s33 offen lds
    v_mfma_f32_16x16x32_bf16 v[132:135], v[76:79], a[64:67], v[132:135]
    v_and_b32 v23, 0xffff0000, v3
    v_lshlrev_b32 v24, 16, v4
    v_mfma_f32_16x16x32_bf16 v[136:139], v[72:75], a[68:71], v[136:139]
    buffer_load_dwordx4 v235, s[48:51], s33 offen offset:1024 lds
    v_and_b32 v25, 0xffff0000, v4
    v_mfma_f32_16x16x32_bf16 v[140:143], v[76:79], a[68:71], v[140:143]
    v_lshlrev_b32 v26, 16, v5
    v_and_b32 v27, 0xffff0000, v5
    v_mfma_f32_16x16x32_bf16 v[144:147], v[72:75], a[72:75], v[144:147]
    s_add_u32 m0, s35, 14336
    s_add_u32 s33, s33, 131072
    buffer_load_dwordx4 v234, s[48:51], s33 offen lds
    v_mfma_f32_16x16x32_bf16 v[148:151], v[76:79], a[72:75], v[148:151]
    v_lshlrev_b32 v28, 16, v6
    v_and_b32 v29, 0xffff0000, v6
    v_mfma_f32_16x16x32_bf16 v[152:155], v[72:75], a[76:79], v[152:155]
    buffer_load_dwordx4 v235, s[48:51], s33 offen offset:1024 lds
    v_lshlrev_b32 v30, 16, v7
    v_mfma_f32_16x16x32_bf16 v[156:159], v[76:79], a[76:79], v[156:159]
    v_and_b32 v31, 0xffff0000, v7
    s_waitcnt lgkmcnt(0)
    v_mfma_f32_16x16x32_bf16 v[160:163], v[80:83], a[64:67], v[160:163]
    ds_read_b128 v[64:67], v225 offset:32768
    v_lshlrev_b32 v32, 16, v8
    v_mfma_f32_16x16x32_bf16 v[164:167], v[84:87], a[64:67], v[164:167]
    ds_read_b128 v[68:71], v225 offset:34816
    v_and_b32 v33, 0xffff0000, v8
    v_mfma_f32_16x16x32_bf16 v[168:171], v[80:83], a[68:71], v[168:171]
    ds_read_b128 v[72:75], v225 offset:36864
    v_lshlrev_b32 v34, 16, v9
    v_mfma_f32_16x16x32_bf16 v[172:175], v[84:87], a[68:71], v[172:175]
    ds_read_b128 v[76:79], v225 offset:38912
    v_and_b32 v35, 0xffff0000, v9
    v_mfma_f32_16x16x32_bf16 v[176:179], v[80:83], a[72:75], v[176:179]
    ds_read_b64_tr_b16 a[88:89], v230 offset:20480
    v_lshlrev_b32 v36, 16, v10
    v_mfma_f32_16x16x32_bf16 v[180:183], v[84:87], a[72:75], v[180:183]
    ds_read_b64_tr_b16 a[90:91], v230 offset:20992
    v_and_b32 v37, 0xffff0000, v10
    v_mfma_f32_16x16x32_bf16 v[184:187], v[80:83], a[76:79], v[184:187]
    ds_read_b64_tr_b16 a[92:93], v231 offset:20480
    v_lshlrev_b32 v38, 16, v11
    v_mfma_f32_16x16x32_bf16 v[188:191], v[84:87], a[76:79], v[188:191]
    ds_read_b64_tr_b16 a[94:95], v231 offset:20992
    v_and_b32 v39, 0xffff0000, v11
    v_mfma_f32_16x16x32_bf16 v[192:195], v[88:91], a[64:67], v[192:195]
    s_add_u32 m0, s34, 24576
    s_add_u32 s37, s85, 65536
    buffer_load_dwordx4 v232, s[44:47], s37 offen lds
    v_mfma_f32_16x16x32_bf16 v[196:199], v[92:95], a[64:67], v[196:199]
    v_lshlrev_b32 v40, 16, v12
    v_and_b32 v41, 0xffff0000, v12
    v_mfma_f32_16x16x32_bf16 v[200:203], v[88:91], a[68:71], v[200:203]
    v_lshlrev_b32 v42, 16, v13
    v_and_b32 v43, 0xffff0000, v13
    v_mfma_f32_16x16x32_bf16 v[204:207], v[92:95], a[68:71], v[204:207]
    v_lshlrev_b32 v44, 16, v14
    v_and_b32 v45, 0xffff0000, v14
    v_mfma_f32_16x16x32_bf16 v[208:211], v[88:91], a[72:75], v[208:211]
    buffer_load_dwordx4 v233, s[44:47], s37 offen offset:1024 lds
    v_lshlrev_b32 v46, 16, v15
    v_mfma_f32_16x16x32_bf16 v[212:215], v[92:95], a[72:75], v[212:215]
    v_and_b32 v47, 0xffff0000, v15
    v_add_f32 v52, v16, v20
    v_mfma_f32_16x16x32_bf16 v[216:219], v[88:91], a[76:79], v[216:219]
    v_add_f32 v53, v17, v21
    v_add_f32 v54, v18, v22
    v_mfma_f32_16x16x32_bf16 v[220:223], v[92:95], a[76:79], v[220:223]
    v_add_f32 v55, v19, v23
    s_waitcnt vmcnt(14) lgkmcnt(0)
    v_mfma_f32_16x16x32_bf16 v[96:99], v[64:67], a[80:83], v[96:99]
    ds_read_b128 v[80:83], v225 offset:40960
    v_add_f32 v52, v52, v24
    v_add_f32 v53, v53, v25
    v_mfma_f32_16x16x32_bf16 v[100:103], v[68:71], a[80:83], v[100:103]
    ds_read_b128 v[84:87], v225 offset:43008
    v_add_f32 v54, v54, v26
    v_mfma_f32_16x16x32_bf16 v[104:107], v[64:67], a[84:87], v[104:107]
    ds_read_b128 v[88:91], v225 offset:45056
    v_add_f32 v55, v55, v27
    v_mfma_f32_16x16x32_bf16 v[108:111], v[68:71], a[84:87], v[108:111]
    ds_read_b128 v[92:95], v225 offset:47104
    v_add_f32 v52, v52, v28
    v_mfma_f32_16x16x32_bf16 v[112:115], v[64:67], a[88:91], v[112:115]
    ds_read_b64_tr_b16 a[96:97], v228 offset:0
    v_add_f32 v53, v53, v29
    v_mfma_f32_16x16x32_bf16 v[116:119], v[68:71], a[88:91], v[116:119]
    ds_read_b64_tr_b16 a[98:99], v228 offset:512
    v_add_f32 v54, v54, v30
    v_mfma_f32_16x16x32_bf16 v[120:123], v[64:67], a[92:95], v[120:123]
    ds_read_b64_tr_b16 a[100:101], v229 offset:0
    v_add_f32 v55, v55, v31
    v_mfma_f32_16x16x32_bf16 v[124:127], v[68:71], a[92:95], v[124:127]
    ds_read_b64_tr_b16 a[102:103], v229 offset:512
    v_add_f32 v52, v52, v32
    v_mfma_f32_16x16x32_bf16 v[128:131], v[72:75], a[80:83], v[128:131]
    s_add_u32 m0, s35, 16384
    s_and_b32 s33, s85, 1023
    s_lshl_b32 s33, s33, 12
    buffer_load_dwordx4 v234, s[48:51], s33 offen lds
    v_mfma_f32_16x16x32_bf16 v[132:135], v[76:79], a[80:83], v[132:135]
    buffer_load_dwordx4 v235, s[48:51], s33 offen offset:1024 lds
    v_add_f32 v53, v53, v33
    v_mfma_f32_16x16x32_bf16 v[136:139], v[72:75], a[84:87], v[136:139]
    s_add_u32 m0, s35, 18432
    s_add_u32 s33, s33, 131072
    buffer_load_dwordx4 v234, s[48:51], s33 offen lds
    v_mfma_f32_16x16x32_bf16 v[140:143], v[76:79], a[84:87], v[140:143]
    v_add_f32 v54, v54, v34
    v_add_f32 v55, v55, v35
    v_mfma_f32_16x16x32_bf16 v[144:147], v[72:75], a[88:91], v[144:147]
    buffer_load_dwordx4 v235, s[48:51], s33 offen offset:1024 lds
    v_add_f32 v52, v52, v36
    v_mfma_f32_16x16x32_bf16 v[148:151], v[76:79], a[88:91], v[148:151]
    s_lshl2_add_u32 s26, s4, s3
    s_lshl_b32 s26, s26, 10
    s_add_u32 s26, s26, s32
    s_add_u32 s26, s26, 131072
    v_mfma_f32_16x16x32_bf16 v[152:155], v[72:75], a[92:95], v[152:155]
    v_and_b32 v226, 0x40000380, v251
    buffer_load_dword v241, v226, s[44:47], s26 offen
    v_mfma_f32_16x16x32_bf16 v[156:159], v[76:79], a[92:95], v[156:159]
    s_waitcnt vmcnt(25) lgkmcnt(0)
    s_barrier
    v_mfma_f32_16x16x32_bf16 v[160:163], v[80:83], a[80:83], v[160:163]
    ds_read_b128 v[64:67], v224 offset:49152
    v_add_f32 v53, v53, v37
    v_mfma_f32_16x16x32_bf16 v[164:167], v[84:87], a[80:83], v[164:167]
    ds_read_b128 v[68:71], v224 offset:51200
    v_add_f32 v54, v54, v38
    v_mfma_f32_16x16x32_bf16 v[168:171], v[80:83], a[84:87], v[168:171]
    ds_read_b128 v[72:75], v224 offset:53248
    v_add_f32 v55, v55, v39
    v_mfma_f32_16x16x32_bf16 v[172:175], v[84:87], a[84:87], v[172:175]
    ds_read_b128 v[76:79], v224 offset:55296
    v_add_f32 v52, v52, v40
    v_mfma_f32_16x16x32_bf16 v[176:179], v[80:83], a[88:91], v[176:179]
    ds_read_b64_tr_b16 a[104:105], v230 offset:0
    v_add_f32 v53, v53, v41
    v_mfma_f32_16x16x32_bf16 v[180:183], v[84:87], a[88:91], v[180:183]
    ds_read_b64_tr_b16 a[106:107], v230 offset:512
    v_add_f32 v54, v54, v42
    v_mfma_f32_16x16x32_bf16 v[184:187], v[80:83], a[92:95], v[184:187]
    ds_read_b64_tr_b16 a[108:109], v231 offset:0
    v_add_f32 v55, v55, v43
    v_mfma_f32_16x16x32_bf16 v[188:191], v[84:87], a[92:95], v[188:191]
    ds_read_b64_tr_b16 a[110:111], v231 offset:512
    v_add_f32 v52, v52, v44
    v_mfma_f32_16x16x32_bf16 v[192:195], v[88:91], a[80:83], v[192:195]
    s_add_u32 m0, s34, 32768
    s_add_u32 s37, s86, 0
    buffer_load_dwordx4 v232, s[44:47], s37 offen lds
    v_mfma_f32_16x16x32_bf16 v[196:199], v[92:95], a[80:83], v[196:199]
    v_add_f32 v53, v53, v45
    v_add_f32 v54, v54, v46
    v_mfma_f32_16x16x32_bf16 v[200:203], v[88:91], a[84:87], v[200:203]
    v_add_f32 v55, v55, v47
    v_add_f32 v52, v52, v53
    v_mfma_f32_16x16x32_bf16 v[204:207], v[92:95], a[84:87], v[204:207]
    v_add_f32 v54, v54, v55
    v_add_f32 v48, v52, v54
    v_mfma_f32_16x16x32_bf16 v[208:211], v[88:91], a[88:91], v[208:211]
    buffer_load_dwordx4 v233, s[44:47], s37 offen offset:1024 lds
    s_nop 1
    v_mfma_f32_16x16x32_bf16 v[212:215], v[92:95], a[88:91], v[212:215]
    v_add_f32_dpp v48, v48, v48 quad_perm:[1,0,3,2] row_mask:0xf bank_mask:0xf
    s_nop 1
    v_mfma_f32_16x16x32_bf16 v[216:219], v[88:91], a[92:95], v[216:219]
    v_add_f32_dpp v48, v48, v48 quad_perm:[2,3,0,1] row_mask:0xf bank_mask:0xf
    s_nop 1
    v_mfma_f32_16x16x32_bf16 v[220:223], v[92:95], a[92:95], v[220:223]
    v_add_f32_dpp v48, v48, v48 row_half_mirror row_mask:0xf bank_mask:0xf
    s_waitcnt lgkmcnt(0)
    v_mfma_f32_16x16x32_bf16 v[96:99], v[64:67], a[96:99], v[96:99]
    ds_read_b128 v[80:83], v224 offset:57344
    s_nop 1
    v_mfma_f32_16x16x32_bf16 v[100:103], v[68:71], a[96:99], v[100:103]
    ds_read_b128 v[84:87], v224 offset:59392
    v_add_f32_dpp v48, v48, v48 row_mirror row_mask:0xf bank_mask:0xf
    v_mfma_f32_16x16x32_bf16 v[104:107], v[64:67], a[100:103], v[104:107]
    ds_read_b128 v[88:91], v224 offset:61440
    s_nop 0
    v_mfma_f32_16x16x32_bf16 v[108:111], v[68:71], a[100:103], v[108:111]
    ds_read_b128 v[92:95], v224 offset:63488
    v_mov_b32 v49, v48
    v_mfma_f32_16x16x32_bf16 v[112:115], v[64:67], a[104:107], v[112:115]
    ds_read_b64_tr_b16 a[112:113], v228 offset:4096
    s_nop 1
    v_mfma_f32_16x16x32_bf16 v[116:119], v[68:71], a[104:107], v[116:119]
    ds_read_b64_tr_b16 a[114:115], v228 offset:4608
    v_permlane16_swap_b32 v48, v49
    v_mfma_f32_16x16x32_bf16 v[120:123], v[64:67], a[108:111], v[120:123]
    ds_read_b64_tr_b16 a[116:117], v229 offset:4096
    s_nop 0
    v_mfma_f32_16x16x32_bf16 v[124:127], v[68:71], a[108:111], v[124:127]
    ds_read_b64_tr_b16 a[118:119], v229 offset:4608
    v_add_f32 v48, v48, v49
    v_mfma_f32_16x16x32_bf16 v[128:131], v[72:75], a[96:99], v[128:131]
    s_add_u32 m0, s35, 20480
    s_add_u32 s33, s33, 131072
    buffer_load_dwordx4 v234, s[48:51], s33 offen lds
    v_mfma_f32_16x16x32_bf16 v[132:135], v[76:79], a[96:99], v[132:135]
    buffer_load_dwordx4 v235, s[48:51], s33 offen offset:1024 lds
    v_mul_f32 v48, 0x3a800000, v48
    v_mfma_f32_16x16x32_bf16 v[136:139], v[72:75], a[100:103], v[136:139]
    v_sub_f32 v56, v16, v48
    v_mul_f32 v52, v56, v56
    v_mfma_f32_16x16x32_bf16 v[140:143], v[76:79], a[100:103], v[140:143]
    s_add_u32 m0, s35, 22528
    s_add_u32 s33, s33, 131072
    buffer_load_dwordx4 v234, s[48:51], s33 offen lds
    v_mfma_f32_16x16x32_bf16 v[144:147], v[72:75], a[104:107], v[144:147]
    buffer_load_dwordx4 v235, s[48:51], s33 offen offset:1024 lds
    v_sub_f32 v57, v17, v48
    v_mfma_f32_16x16x32_bf16 v[148:151], v[76:79], a[104:107], v[148:151]
    v_mul_f32 v53, v57, v57
    v_sub_f32 v58, v18, v48
    v_mfma_f32_16x16x32_bf16 v[152:155], v[72:75], a[108:111], v[152:155]
    v_lshlrev_b32 v226, 7, v253
    s_lshl_b32 s25, s2, 15
    buffer_load_dword v241, v226, s[12:15], s25 offen
    v_mfma_f32_16x16x32_bf16 v[156:159], v[76:79], a[108:111], v[156:159]
    v_mul_f32 v54, v58, v58
    s_waitcnt lgkmcnt(0)
    v_mfma_f32_16x16x32_bf16 v[160:163], v[80:83], a[96:99], v[160:163]
    ds_read_b128 v[64:67], v225 offset:49152
    v_sub_f32 v59, v19, v48
    v_mfma_f32_16x16x32_bf16 v[164:167], v[84:87], a[96:99], v[164:167]
    ds_read_b128 v[68:71], v225 offset:51200
    v_mul_f32 v55, v59, v59
    v_mfma_f32_16x16x32_bf16 v[168:171], v[80:83], a[100:103], v[168:171]
    ds_read_b128 v[72:75], v225 offset:53248
    v_sub_f32 v56, v20, v48
    v_mfma_f32_16x16x32_bf16 v[172:175], v[84:87], a[100:103], v[172:175]
    ds_read_b128 v[76:79], v225 offset:55296
    v_fmac_f32 v52, v56, v56
    v_mfma_f32_16x16x32_bf16 v[176:179], v[80:83], a[104:107], v[176:179]
    ds_read_b64_tr_b16 a[120:121], v230 offset:4096
    v_sub_f32 v57, v21, v48
    v_mfma_f32_16x16x32_bf16 v[180:183], v[84:87], a[104:107], v[180:183]
    ds_read_b64_tr_b16 a[122:123], v230 offset:4608
    v_fmac_f32 v53, v57, v57
    v_mfma_f32_16x16x32_bf16 v[184:187], v[80:83], a[108:111], v[184:187]
    ds_read_b64_tr_b16 a[124:125], v231 offset:4096
    v_sub_f32 v58, v22, v48
    v_mfma_f32_16x16x32_bf16 v[188:191], v[84:87], a[108:111], v[188:191]
    ds_read_b64_tr_b16 a[126:127], v231 offset:4608
    v_fmac_f32 v54, v58, v58
    v_mfma_f32_16x16x32_bf16 v[192:195], v[88:91], a[96:99], v[192:195]
    s_add_u32 m0, s34, 40960
    s_add_u32 s37, s86, 65536
    buffer_load_dwordx4 v232, s[44:47], s37 offen lds
    v_mfma_f32_16x16x32_bf16 v[196:199], v[92:95], a[96:99], v[196:199]
    v_sub_f32 v59, v23, v48
    v_fmac_f32 v55, v59, v59
    v_mfma_f32_16x16x32_bf16 v[200:203], v[88:91], a[100:103], v[200:203]
    v_sub_f32 v56, v24, v48
    v_fmac_f32 v52, v56, v56
    v_mfma_f32_16x16x32_bf16 v[204:207], v[92:95], a[100:103], v[204:207]
    v_sub_f32 v57, v25, v48
    v_fmac_f32 v53, v57, v57
    v_mfma_f32_16x16x32_bf16 v[208:211], v[88:91], a[104:107], v[208:211]
    buffer_load_dwordx4 v233, s[44:47], s37 offen offset:1024 lds
    v_sub_f32 v58, v26, v48
    v_mfma_f32_16x16x32_bf16 v[212:215], v[92:95], a[104:107], v[212:215]
    v_fmac_f32 v54, v58, v58
    v_sub_f32 v59, v27, v48
    v_mfma_f32_16x16x32_bf16 v[216:219], v[88:91], a[108:111], v[216:219]
    v_fmac_f32 v55, v59, v59
    v_sub_f32 v56, v28, v48
    v_mfma_f32_16x16x32_bf16 v[220:223], v[92:95], a[108:111], v[220:223]
    v_fmac_f32 v52, v56, v56
    s_waitcnt vmcnt(16) lgkmcnt(0)
    v_mfma_f32_16x16x32_bf16 v[96:99], v[64:67], a[112:115], v[96:99]
    ds_read_b128 v[80:83], v225 offset:57344
    v_sub_f32 v57, v29, v48
    v_mfma_f32_16x16x32_bf16 v[100:103], v[68:71], a[112:115], v[100:103]
    ds_read_b128 v[84:87], v225 offset:59392
    v_fmac_f32 v53, v57, v57
    v_mfma_f32_16x16x32_bf16 v[104:107], v[64:67], a[116:119], v[104:107]
    ds_read_b128 v[88:91], v225 offset:61440
    v_sub_f32 v58, v30, v48
    v_mfma_f32_16x16x32_bf16 v[108:111], v[68:71], a[116:119], v[108:111]
    ds_read_b128 v[92:95], v225 offset:63488
    v_fmac_f32 v54, v58, v58
    v_mfma_f32_16x16x32_bf16 v[112:115], v[64:67], a[120:123], v[112:115]
    ds_read_b64_tr_b16 a[128:129], v228 offset:8192
    v_sub_f32 v59, v31, v48
    v_mfma_f32_16x16x32_bf16 v[116:119], v[68:71], a[120:123], v[116:119]
    ds_read_b64_tr_b16 a[130:131], v228 offset:8704
    v_fmac_f32 v55, v59, v59
    v_mfma_f32_16x16x32_bf16 v[120:123], v[64:67], a[124:127], v[120:123]
    ds_read_b64_tr_b16 a[132:133], v229 offset:8192
    v_sub_f32 v56, v32, v48
    v_mfma_f32_16x16x32_bf16 v[124:127], v[68:71], a[124:127], v[124:127]
    ds_read_b64_tr_b16 a[134:135], v229 offset:8704
    v_fmac_f32 v52, v56, v56
    v_mfma_f32_16x16x32_bf16 v[128:131], v[72:75], a[112:115], v[128:131]
    s_add_u32 m0, s35, 0
    s_and_b32 s33, s86, 1023
    s_lshl_b32 s33, s33, 12
    buffer_load_dwordx4 v234, s[48:51], s33 offen lds
    v_mfma_f32_16x16x32_bf16 v[132:135], v[76:79], a[112:115], v[132:135]
    v_sub_f32 v57, v33, v48
    v_fmac_f32 v53, v57, v57
    v_sub_f32 v58, v34, v48
    v_mfma_f32_16x16x32_bf16 v[136:139], v[72:75], a[116:119], v[136:139]
    buffer_load_dwordx4 v235, s[48:51], s33 offen offset:1024 lds
    v_fmac_f32 v54, v58, v58
    v_mfma_f32_16x16x32_bf16 v[140:143], v[76:79], a[116:119], v[140:143]
    v_sub_f32 v59, v35, v48
    v_fmac_f32 v55, v59, v59
    v_mfma_f32_16x16x32_bf16 v[144:147], v[72:75], a[120:123], v[144:147]
    s_add_u32 m0, s35, 2048
    s_add_u32 s33, s33, 131072
    buffer_load_dwordx4 v234, s[48:51], s33 offen lds
    v_mfma_f32_16x16x32_bf16 v[148:151], v[76:79], a[120:123], v[148:151]
    v_sub_f32 v56, v36, v48
    v_fmac_f32 v52, v56, v56
    v_mfma_f32_16x16x32_bf16 v[152:155], v[72:75], a[124:127], v[152:155]
    buffer_load_dwordx4 v235, s[48:51], s33 offen offset:1024 lds
    v_sub_f32 v57, v37, v48
    v_mfma_f32_16x16x32_bf16 v[156:159], v[76:79], a[124:127], v[156:159]
    s_waitcnt vmcnt(30) lgkmcnt(0)
    s_barrier
    v_mfma_f32_16x16x32_bf16 v[160:163], v[80:83], a[112:115], v[160:163]
    ds_read_b128 v[64:67], v224 offset:0
    v_fmac_f32 v53, v57, v57
    v_mfma_f32_16x16x32_bf16 v[164:167], v[84:87], a[112:115], v[164:167]
    ds_read_b128 v[68:71], v224 offset:2048
    v_sub_f32 v58, v38, v48
    v_mfma_f32_16x16x32_bf16 v[168:171], v[80:83], a[116:119], v[168:171]
    ds_read_b128 v[72:75], v224 offset:4096
    v_fmac_f32 v54, v58, v58
    v_mfma_f32_16x16x32_bf16 v[172:175], v[84:87], a[116:119], v[172:175]
    ds_read_b128 v[76:79], v224 offset:6144
    v_sub_f32 v59, v39, v48
    v_mfma_f32_16x16x32_bf16 v[176:179], v[80:83], a[120:123], v[176:179]
    ds_read_b64_tr_b16 a[136:137], v230 offset:8192
    v_fmac_f32 v55, v59, v59
    v_mfma_f32_16x16x32_bf16 v[180:183], v[84:87], a[120:123], v[180:183]
    ds_read_b64_tr_b16 a[138:139], v230 offset:8704
    v_sub_f32 v56, v40, v48
    v_mfma_f32_16x16x32_bf16 v[184:187], v[80:83], a[124:127], v[184:187]
    ds_read_b64_tr_b16 a[140:141], v231 offset:8192
    v_fmac_f32 v52, v56, v56
    v_mfma_f32_16x16x32_bf16 v[188:191], v[84:87], a[124:127], v[188:191]
    ds_read_b64_tr_b16 a[142:143], v231 offset:8704
    v_sub_f32 v57, v41, v48
    v_mfma_f32_16x16x32_bf16 v[192:195], v[88:91], a[112:115], v[192:195]
    s_add_u32 m0, s34, 49152
    s_add_u32 s37, s87, 0
    buffer_load_dwordx4 v232, s[44:47], s37 offen lds
    v_mfma_f32_16x16x32_bf16 v[196:199], v[92:95], a[112:115], v[196:199]
    v_fmac_f32 v53, v57, v57
    v_sub_f32 v58, v42, v48
    v_mfma_f32_16x16x32_bf16 v[200:203], v[88:91], a[116:119], v[200:203]
    v_fmac_f32 v54, v58, v58
    v_sub_f32 v59, v43, v48
    v_mfma_f32_16x16x32_bf16 v[204:207], v[92:95], a[116:119], v[204:207]
    v_fmac_f32 v55, v59, v59
    v_sub_f32 v56, v44, v48
    v_mfma_f32_16x16x32_bf16 v[208:211], v[88:91], a[120:123], v[208:211]
    buffer_load_dwordx4 v233, s[44:47], s37 offen offset:1024 lds
    v_fmac_f32 v52, v56, v56
    v_mfma_f32_16x16x32_bf16 v[212:215], v[92:95], a[120:123], v[212:215]
    v_sub_f32 v57, v45, v48
    v_fmac_f32 v53, v57, v57
    v_mfma_f32_16x16x32_bf16 v[216:219], v[88:91], a[124:127], v[216:219]
    v_sub_f32 v58, v46, v48
    v_fmac_f32 v54, v58, v58
    v_mfma_f32_16x16x32_bf16 v[220:223], v[92:95], a[124:127], v[220:223]
    v_sub_f32 v59, v47, v48
    s_waitcnt lgkmcnt(0)
    v_mfma_f32_16x16x32_bf16 v[96:99], v[64:67], a[128:131], v[96:99]
    ds_read_b128 v[80:83], v224 offset:8192
    v_fmac_f32 v55, v59, v59
    v_mfma_f32_16x16x32_bf16 v[100:103], v[68:71], a[128:131], v[100:103]
    ds_read_b128 v[84:87], v224 offset:10240
    v_add_f32 v52, v52, v53
    v_mfma_f32_16x16x32_bf16 v[104:107], v[64:67], a[132:135], v[104:107]
    ds_read_b128 v[88:91], v224 offset:12288
    v_add_f32 v54, v54, v55
    v_mfma_f32_16x16x32_bf16 v[108:111], v[68:71], a[132:135], v[108:111]
    ds_read_b128 v[92:95], v224 offset:14336
    v_add_f32 v51, v52, v54
    v_mfma_f32_16x16x32_bf16 v[112:115], v[64:67], a[136:139], v[112:115]
    ds_read_b64_tr_b16 a[144:145], v228 offset:12288
    s_nop 1
    v_mfma_f32_16x16x32_bf16 v[116:119], v[68:71], a[136:139], v[116:119]
    ds_read_b64_tr_b16 a[146:147], v228 offset:12800
    v_add_f32_dpp v51, v51, v51 quad_perm:[1,0,3,2] row_mask:0xf bank_mask:0xf
    v_mfma_f32_16x16x32_bf16 v[120:123], v[64:67], a[140:143], v[120:123]
    ds_read_b64_tr_b16 a[148:149], v229 offset:12288
    s_nop 1
    v_mfma_f32_16x16x32_bf16 v[124:127], v[68:71], a[140:143], v[124:127]
    ds_read_b64_tr_b16 a[150:151], v229 offset:12800
    v_add_f32_dpp v51, v51, v51 quad_perm:[2,3,0,1] row_mask:0xf bank_mask:0xf
    v_mfma_f32_16x16x32_bf16 v[128:131], v[72:75], a[128:131], v[128:131]
    s_add_u32 m0, s35, 4096
    s_add_u32 s33, s33, 131072
    buffer_load_dwordx4 v234, s[48:51], s33 offen lds
    v_mfma_f32_16x16x32_bf16 v[132:135], v[76:79], a[128:131], v[132:135]
    s_nop 1
    v_add_f32_dpp v51, v51, v51 row_half_mirror row_mask:0xf bank_mask:0xf
    v_mfma_f32_16x16x32_bf16 v[136:139], v[72:75], a[132:135], v[136:139]
    buffer_load_dwordx4 v235, s[48:51], s33 offen offset:1024 lds
    s_nop 1
    v_mfma_f32_16x16x32_bf16 v[140:143], v[76:79], a[132:135], v[140:143]
    v_add_f32_dpp v51, v51, v51 row_mirror row_mask:0xf bank_mask:0xf
    s_nop 0
    v_mfma_f32_16x16x32_bf16 v[144:147], v[72:75], a[136:139], v[144:147]
    s_add_u32 m0, s35, 6144
    s_add_u32 s33, s33, 131072
    buffer_load_dwordx4 v234, s[48:51], s33 offen lds
    v_mfma_f32_16x16x32_bf16 v[148:151], v[76:79], a[136:139], v[148:151]
    v_mov_b32 v49, v51
    s_nop 1
    v_mfma_f32_16x16x32_bf16 v[152:155], v[72:75], a[140:143], v[152:155]
    buffer_load_dwordx4 v235, s[48:51], s33 offen offset:1024 lds
    v_permlane16_swap_b32 v51, v49
    v_mfma_f32_16x16x32_bf16 v[156:159], v[76:79], a[140:143], v[156:159]
    s_nop 0
    s_waitcnt lgkmcnt(0)
    v_mfma_f32_16x16x32_bf16 v[160:163], v[80:83], a[128:131], v[160:163]
    ds_read_b128 v[64:67], v225 offset:0
    v_add_f32 v51, v51, v49
    v_mfma_f32_16x16x32_bf16 v[164:167], v[84:87], a[128:131], v[164:167]
    ds_read_b128 v[68:71], v225 offset:2048
    v_mul_f32 v51, 0x3a800000, v51
    v_mfma_f32_16x16x32_bf16 v[168:171], v[80:83], a[132:135], v[168:171]
    ds_read_b128 v[72:75], v225 offset:4096
    v_cvt_pk_bf16_f32 v50, v48, v51
    v_mfma_f32_16x16x32_bf16 v[172:175], v[84:87], a[132:135], v[172:175]
    ds_read_b128 v[76:79], v225 offset:6144
    v_and_b32 v51, 0xffff0000, v50
    v_mfma_f32_16x16x32_bf16 v[176:179], v[80:83], a[136:139], v[176:179]
    ds_read_b64_tr_b16 a[152:153], v230 offset:12288
    v_lshlrev_b32 v50, 16, v50
    v_mfma_f32_16x16x32_bf16 v[180:183], v[84:87], a[136:139], v[180:183]
    ds_read_b64_tr_b16 a[154:155], v230 offset:12800
    v_add_f32 v51, 0x3727c5ac, v51
    v_mfma_f32_16x16x32_bf16 v[184:187], v[80:83], a[140:143], v[184:187]
    ds_read_b64_tr_b16 a[156:157], v231 offset:12288
    v_cvt_pk_bf16_f32 v51, v51, v51
    v_mfma_f32_16x16x32_bf16 v[188:191], v[84:87], a[140:143], v[188:191]
    ds_read_b64_tr_b16 a[158:159], v231 offset:12800
    v_lshlrev_b32 v51, 16, v51
    v_mfma_f32_16x16x32_bf16 v[192:195], v[88:91], a[128:131], v[192:195]
    s_add_u32 m0, s34, 57344
    s_add_u32 s37, s87, 65536
    buffer_load_dwordx4 v232, s[44:47], s37 offen lds
    v_mfma_f32_16x16x32_bf16 v[196:199], v[92:95], a[128:131], v[196:199]
    v_sqrt_f32 v51, v51
    v_mfma_f32_16x16x32_bf16 v[200:203], v[88:91], a[132:135], v[200:203]
    s_nop 0
    v_cvt_pk_bf16_f32 v51, v51, v51
    v_mfma_f32_16x16x32_bf16 v[204:207], v[92:95], a[132:135], v[204:207]
    v_lshlrev_b32 v51, 16, v51
    v_rcp_f32 v51, v51
    v_mfma_f32_16x16x32_bf16 v[208:211], v[88:91], a[136:139], v[208:211]
    buffer_load_dwordx4 v233, s[44:47], s37 offen offset:1024 lds
    v_mfma_f32_16x16x32_bf16 v[212:215], v[92:95], a[136:139], v[212:215]
    s_nop 0
    v_mul_f32 v51, 0x3e0293ee, v51
    v_mfma_f32_16x16x32_bf16 v[216:219], v[88:91], a[140:143], v[216:219]
    v_sub_f32 v16, v16, v50
    v_sub_f32 v17, v17, v50
    v_mfma_f32_16x16x32_bf16 v[220:223], v[92:95], a[140:143], v[220:223]
    v_cvt_pk_bf16_f32 v17, v16, v17
    s_waitcnt vmcnt(15) lgkmcnt(0)
    v_mfma_f32_16x16x32_bf16 v[96:99], v[64:67], a[144:147], v[96:99]
    ds_read_b128 v[80:83], v225 offset:8192
    v_lshlrev_b32 v16, 16, v17
    v_mfma_f32_16x16x32_bf16 v[100:103], v[68:71], a[144:147], v[100:103]
    ds_read_b128 v[84:87], v225 offset:10240
    v_and_b32 v17, 0xffff0000, v17
    v_mfma_f32_16x16x32_bf16 v[104:107], v[64:67], a[148:151], v[104:107]
    ds_read_b128 v[88:91], v225 offset:12288
    v_mul_f32 v16, v16, v51
    v_mfma_f32_16x16x32_bf16 v[108:111], v[68:71], a[148:151], v[108:111]
    ds_read_b128 v[92:95], v225 offset:14336
    v_mul_f32 v17, v17, v51
    v_mfma_f32_16x16x32_bf16 v[112:115], v[64:67], a[152:155], v[112:115]
    ds_read_b64_tr_b16 a[160:161], v228 offset:16384
    v_cvt_pk_bf16_f32 v0, v16, v17
    v_mfma_f32_16x16x32_bf16 v[116:119], v[68:71], a[152:155], v[116:119]
    ds_read_b64_tr_b16 a[162:163], v228 offset:16896
    v_sub_f32 v18, v18, v50
    v_mfma_f32_16x16x32_bf16 v[120:123], v[64:67], a[156:159], v[120:123]
    ds_read_b64_tr_b16 a[164:165], v229 offset:16384
    v_sub_f32 v19, v19, v50
    v_mfma_f32_16x16x32_bf16 v[124:127], v[68:71], a[156:159], v[124:127]
    ds_read_b64_tr_b16 a[166:167], v229 offset:16896
    v_cvt_pk_bf16_f32 v19, v18, v19
    v_mfma_f32_16x16x32_bf16 v[128:131], v[72:75], a[144:147], v[128:131]
    s_add_u32 m0, s35, 8192
    s_and_b32 s33, s87, 1023
    s_lshl_b32 s33, s33, 12
    buffer_load_dwordx4 v234, s[48:51], s33 offen lds
    v_mfma_f32_16x16x32_bf16 v[132:135], v[76:79], a[144:147], v[132:135]
    v_lshlrev_b32 v18, 16, v19
    v_and_b32 v19, 0xffff0000, v19
    v_mfma_f32_16x16x32_bf16 v[136:139], v[72:75], a[148:151], v[136:139]
    buffer_load_dwordx4 v235, s[48:51], s33 offen offset:1024 lds
    v_mul_f32 v18, v18, v51
    v_mul_f32 v19, v19, v51
    v_mfma_f32_16x16x32_bf16 v[140:143], v[76:79], a[148:151], v[140:143]
    v_cvt_pk_bf16_f32 v1, v18, v19
    v_sub_f32 v20, v20, v50
    v_mfma_f32_16x16x32_bf16 v[144:147], v[72:75], a[152:155], v[144:147]
    s_add_u32 m0, s35, 10240
    s_add_u32 s33, s33, 131072
    buffer_load_dwordx4 v234, s[48:51], s33 offen lds
    v_mfma_f32_16x16x32_bf16 v[148:151], v[76:79], a[152:155], v[148:151]
    v_sub_f32 v21, v21, v50
    v_cvt_pk_bf16_f32 v21, v20, v21
    v_mfma_f32_16x16x32_bf16 v[152:155], v[72:75], a[156:159], v[152:155]
    buffer_load_dwordx4 v235, s[48:51], s33 offen offset:1024 lds
    v_lshlrev_b32 v20, 16, v21
    v_mfma_f32_16x16x32_bf16 v[156:159], v[76:79], a[156:159], v[156:159]
    s_waitcnt vmcnt(30) lgkmcnt(0)
    s_barrier
    v_mfma_f32_16x16x32_bf16 v[160:163], v[80:83], a[144:147], v[160:163]
    ds_read_b128 v[64:67], v224 offset:16384
    v_and_b32 v21, 0xffff0000, v21
    v_mfma_f32_16x16x32_bf16 v[164:167], v[84:87], a[144:147], v[164:167]
    ds_read_b128 v[68:71], v224 offset:18432
    v_mul_f32 v20, v20, v51
    v_mfma_f32_16x16x32_bf16 v[168:171], v[80:83], a[148:151], v[168:171]
    ds_read_b128 v[72:75], v224 offset:20480
    v_mul_f32 v21, v21, v51
    v_mfma_f32_16x16x32_bf16 v[172:175], v[84:87], a[148:151], v[172:175]
    ds_read_b128 v[76:79], v224 offset:22528
    v_cvt_pk_bf16_f32 v2, v20, v21
    v_mfma_f32_16x16x32_bf16 v[176:179], v[80:83], a[152:155], v[176:179]
    ds_read_b64_tr_b16 a[168:169], v230 offset:16384
    v_sub_f32 v22, v22, v50
    v_mfma_f32_16x16x32_bf16 v[180:183], v[84:87], a[152:155], v[180:183]
    ds_read_b64_tr_b16 a[170:171], v230 offset:16896
    v_sub_f32 v23, v23, v50
    v_mfma_f32_16x16x32_bf16 v[184:187], v[80:83], a[156:159], v[184:187]
    ds_read_b64_tr_b16 a[172:173], v231 offset:16384
    v_cvt_pk_bf16_f32 v23, v22, v23
    v_mfma_f32_16x16x32_bf16 v[188:191], v[84:87], a[156:159], v[188:191]
    ds_read_b64_tr_b16 a[174:175], v231 offset:16896
    v_lshlrev_b32 v22, 16, v23
    v_mfma_f32_16x16x32_bf16 v[192:195], v[88:91], a[144:147], v[192:195]
    s_add_u32 m0, s34, 0
    s_add_u32 s37, s80, 131072
    buffer_load_dwordx4 v232, s[44:47], s37 offen lds
    v_mfma_f32_16x16x32_bf16 v[196:199], v[92:95], a[144:147], v[196:199]
    v_and_b32 v23, 0xffff0000, v23
    v_mul_f32 v22, v22, v51
    v_mfma_f32_16x16x32_bf16 v[200:203], v[88:91], a[148:151], v[200:203]
    v_mul_f32 v23, v23, v51
    v_cvt_pk_bf16_f32 v3, v22, v23
    v_mfma_f32_16x16x32_bf16 v[204:207], v[92:95], a[148:151], v[204:207]
    v_sub_f32 v24, v24, v50
    v_sub_f32 v25, v25, v50
    v_mfma_f32_16x16x32_bf16 v[208:211], v[88:91], a[152:155], v[208:211]
    buffer_load_dwordx4 v233, s[44:47], s37 offen offset:1024 lds
    v_cvt_pk_bf16_f32 v25, v24, v25
    v_mfma_f32_16x16x32_bf16 v[212:215], v[92:95], a[152:155], v[212:215]
    v_lshlrev_b32 v24, 16, v25
    v_and_b32 v25, 0xffff0000, v25
    v_mfma_f32_16x16x32_bf16 v[216:219], v[88:91], a[156:159], v[216:219]
    v_mul_f32 v24, v24, v51
    v_mul_f32 v25, v25, v51
    v_mfma_f32_16x16x32_bf16 v[220:223], v[92:95], a[156:159], v[220:223]
    v_cvt_pk_bf16_f32 v4, v24, v25
    s_waitcnt lgkmcnt(0)
    v_mfma_f32_16x16x32_bf16 v[96:99], v[64:67], a[160:163], v[96:99]
    ds_read_b128 v[80:83], v224 offset:24576
    v_sub_f32 v26, v26, v50
    v_mfma_f32_16x16x32_bf16 v[100:103], v[68:71], a[160:163], v[100:103]
    ds_read_b128 v[84:87], v224 offset:26624
    v_sub_f32 v27, v27, v50
    v_mfma_f32_16x16x32_bf16 v[104:107], v[64:67], a[164:167], v[104:107]
    ds_read_b128 v[88:91], v224 offset:28672
    v_cvt_pk_bf16_f32 v27, v26, v27
    v_mfma_f32_16x16x32_bf16 v[108:111], v[68:71], a[164:167], v[108:111]
    ds_read_b128 v[92:95], v224 offset:30720
    v_lshlrev_b32 v26, 16, v27
    v_mfma_f32_16x16x32_bf16 v[112:115], v[64:67], a[168:171], v[112:115]
    ds_read_b64_tr_b16 a[176:177], v228 offset:20480
    v_and_b32 v27, 0xffff0000, v27
    v_mfma_f32_16x16x32_bf16 v[116:119], v[68:71], a[168:171], v[116:119]
    ds_read_b64_tr_b16 a[178:179], v228 offset:20992
    v_mul_f32 v26, v26, v51
    v_mfma_f32_16x16x32_bf16 v[120:123], v[64:67], a[172:175], v[120:123]
    ds_read_b64_tr_b16 a[180:181], v229 offset:20480
    v_mul_f32 v27, v27, v51
    v_mfma_f32_16x16x32_bf16 v[124:127], v[68:71], a[172:175], v[124:127]
    ds_read_b64_tr_b16 a[182:183], v229 offset:20992
    v_cvt_pk_bf16_f32 v5, v26, v27
    v_mfma_f32_16x16x32_bf16 v[128:131], v[72:75], a[160:163], v[128:131]
    s_add_u32 m0, s35, 12288
    s_add_u32 s33, s33, 131072
    buffer_load_dwordx4 v234, s[48:51], s33 offen lds
    v_mfma_f32_16x16x32_bf16 v[132:135], v[76:79], a[160:163], v[132:135]
    v_sub_f32 v28, v28, v50
    v_sub_f32 v29, v29, v50
    v_mfma_f32_16x16x32_bf16 v[136:139], v[72:75], a[164:167], v[136:139]
    buffer_load_dwordx4 v235, s[48:51], s33 offen offset:1024 lds
    v_cvt_pk_bf16_f32 v29, v28, v29
    v_mfma_f32_16x16x32_bf16 v[140:143], v[76:79], a[164:167], v[140:143]
    v_lshlrev_b32 v28, 16, v29
    v_and_b32 v29, 0xffff0000, v29
    v_mfma_f32_16x16x32_bf16 v[144:147], v[72:75], a[168:171], v[144:147]
    s_add_u32 m0, s35, 14336
    s_add_u32 s33, s33, 131072
    buffer_load_dwordx4 v234, s[48:51], s33 offen lds
    v_mfma_f32_16x16x32_bf16 v[148:151], v[76:79], a[168:171], v[148:151]
    v_mul_f32 v28, v28, v51
    v_mul_f32 v29, v29, v51
    v_mfma_f32_16x16x32_bf16 v[152:155], v[72:75], a[172:175], v[152:155]
    buffer_load_dwordx4 v235, s[48:51], s33 offen offset:1024 lds
    v_cvt_pk_bf16_f32 v6, v28, v29
    v_mfma_f32_16x16x32_bf16 v[156:159], v[76:79], a[172:175], v[156:159]
    v_sub_f32 v30, v30, v50
    s_waitcnt lgkmcnt(0)
    v_mfma_f32_16x16x32_bf16 v[160:163], v[80:83], a[160:163], v[160:163]
    ds_read_b128 v[64:67], v225 offset:16384
    v_sub_f32 v31, v31, v50
    v_mfma_f32_16x16x32_bf16 v[164:167], v[84:87], a[160:163], v[164:167]
    ds_read_b128 v[68:71], v225 offset:18432
    v_cvt_pk_bf16_f32 v31, v30, v31
    v_mfma_f32_16x16x32_bf16 v[168:171], v[80:83], a[164:167], v[168:171]
    ds_read_b128 v[72:75], v225 offset:20480
    v_lshlrev_b32 v30, 16, v31
    v_mfma_f32_16x16x32_bf16 v[172:175], v[84:87], a[164:167], v[172:175]
    ds_read_b128 v[76:79], v225 offset:22528
    v_and_b32 v31, 0xffff0000, v31
    v_mfma_f32_16x16x32_bf16 v[176:179], v[80:83], a[168:171], v[176:179]
    ds_read_b64_tr_b16 a[184:185], v230 offset:20480
    v_mul_f32 v30, v30, v51
    v_mfma_f32_16x16x32_bf16 v[180:183], v[84:87], a[168:171], v[180:183]
    ds_read_b64_tr_b16 a[186:187], v230 offset:20992
    v_mul_f32 v31, v31, v51
    v_mfma_f32_16x16x32_bf16 v[184:187], v[80:83], a[172:175], v[184:187]
    ds_read_b64_tr_b16 a[188:189], v231 offset:20480
    v_cvt_pk_bf16_f32 v7, v30, v31
    v_mfma_f32_16x16x32_bf16 v[188:191], v[84:87], a[172:175], v[188:191]
    ds_read_b64_tr_b16 a[190:191], v231 offset:20992
    v_sub_f32 v32, v32, v50
    v_mfma_f32_16x16x32_bf16 v[192:195], v[88:91], a[160:163], v[192:195]
    s_add_u32 m0, s34, 8192
    s_add_u32 s37, s81, 131072
    buffer_load_dwordx4 v232, s[44:47], s37 offen lds
    v_mfma_f32_16x16x32_bf16 v[196:199], v[92:95], a[160:163], v[196:199]
    v_sub_f32 v33, v33, v50
    v_cvt_pk_bf16_f32 v33, v32, v33
    v_mfma_f32_16x16x32_bf16 v[200:203], v[88:91], a[164:167], v[200:203]
    v_lshlrev_b32 v32, 16, v33
    v_and_b32 v33, 0xffff0000, v33
    v_mfma_f32_16x16x32_bf16 v[204:207], v[92:95], a[164:167], v[204:207]
    v_mul_f32 v32, v32, v51
    v_mul_f32 v33, v33, v51
    v_mfma_f32_16x16x32_bf16 v[208:211], v[88:91], a[168:171], v[208:211]
    buffer_load_dwordx4 v233, s[44:47], s37 offen offset:1024 lds
    v_cvt_pk_bf16_f32 v8, v32, v33
    v_mfma_f32_16x16x32_bf16 v[212:215], v[92:95], a[168:171], v[212:215]
    v_sub_f32 v34, v34, v50
    v_sub_f32 v35, v35, v50
    v_mfma_f32_16x16x32_bf16 v[216:219], v[88:91], a[172:175], v[216:219]
    v_cvt_pk_bf16_f32 v35, v34, v35
    v_lshlrev_b32 v34, 16, v35
    v_mfma_f32_16x16x32_bf16 v[220:223], v[92:95], a[172:175], v[220:223]
    v_and_b32 v35, 0xffff0000, v35
    s_waitcnt vmcnt(14) lgkmcnt(0)
    v_mfma_f32_16x16x32_bf16 v[96:99], v[64:67], a[176:179], v[96:99]
    ds_read_b128 v[80:83], v225 offset:24576
    v_mul_f32 v34, v34, v51
    v_mfma_f32_16x16x32_bf16 v[100:103], v[68:71], a[176:179], v[100:103]
    ds_read_b128 v[84:87], v225 offset:26624
    v_mul_f32 v35, v35, v51
    v_mfma_f32_16x16x32_bf16 v[104:107], v[64:67], a[180:183], v[104:107]
    ds_read_b128 v[88:91], v225 offset:28672
    v_cvt_pk_bf16_f32 v9, v34, v35
    v_mfma_f32_16x16x32_bf16 v[108:111], v[68:71], a[180:183], v[108:111]
    ds_read_b128 v[92:95], v225 offset:30720
    v_sub_f32 v36, v36, v50
    v_mfma_f32_16x16x32_bf16 v[112:115], v[64:67], a[184:187], v[112:115]
    ds_read_b64_tr_b16 a[192:193], v228 offset:0
    v_sub_f32 v37, v37, v50
    v_mfma_f32_16x16x32_bf16 v[116:119], v[68:71], a[184:187], v[116:119]
    ds_read_b64_tr_b16 a[194:195], v228 offset:512
    v_cvt_pk_bf16_f32 v37, v36, v37
    v_mfma_f32_16x16x32_bf16 v[120:123], v[64:67], a[188:191], v[120:123]
    ds_read_b64_tr_b16 a[196:197], v229 offset:0
    v_lshlrev_b32 v36, 16, v37
    v_mfma_f32_16x16x32_bf16 v[124:127], v[68:71], a[188:191], v[124:127]
    ds_read_b64_tr_b16 a[198:199], v229 offset:512
    v_and_b32 v37, 0xffff0000, v37
    v_mfma_f32_16x16x32_bf16 v[128:131], v[72:75], a[176:179], v[128:131]
    v_mul_f32 v36, v36, v51
    v_mul_f32 v37, v37, v51
    v_mfma_f32_16x16x32_bf16 v[132:135], v[76:79], a[176:179], v[132:135]
    v_cvt_pk_bf16_f32 v10, v36, v37
    v_sub_f32 v38, v38, v50
    v_mfma_f32_16x16x32_bf16 v[136:139], v[72:75], a[180:183], v[136:139]
    v_sub_f32 v39, v39, v50
    v_cvt_pk_bf16_f32 v39, v38, v39
    v_lshlrev_b32 v38, 16, v39
    v_mfma_f32_16x16x32_bf16 v[140:143], v[76:79], a[180:183], v[140:143]
    v_and_b32 v39, 0xffff0000, v39
    v_mul_f32 v38, v38, v51
    v_mfma_f32_16x16x32_bf16 v[144:147], v[72:75], a[184:187], v[144:147]
    v_mul_f32 v39, v39, v51
    v_cvt_pk_bf16_f32 v11, v38, v39
    v_mfma_f32_16x16x32_bf16 v[148:151], v[76:79], a[184:187], v[148:151]
    v_sub_f32 v40, v40, v50
    v_sub_f32 v41, v41, v50
    v_mfma_f32_16x16x32_bf16 v[152:155], v[72:75], a[188:191], v[152:155]
    v_cvt_pk_bf16_f32 v41, v40, v41
    v_lshlrev_b32 v40, 16, v41
    v_mfma_f32_16x16x32_bf16 v[156:159], v[76:79], a[188:191], v[156:159]
    s_waitcnt vmcnt(24) lgkmcnt(0)
    s_barrier
    v_mfma_f32_16x16x32_bf16 v[160:163], v[80:83], a[176:179], v[160:163]
    ds_read_b128 v[64:67], v224 offset:32768
    v_and_b32 v41, 0xffff0000, v41
    v_mfma_f32_16x16x32_bf16 v[164:167], v[84:87], a[176:179], v[164:167]
    ds_read_b128 v[68:71], v224 offset:34816
    v_mul_f32 v40, v40, v51
    v_mfma_f32_16x16x32_bf16 v[168:171], v[80:83], a[180:183], v[168:171]
    ds_read_b128 v[72:75], v224 offset:36864
    v_mul_f32 v41, v41, v51
    v_mfma_f32_16x16x32_bf16 v[172:175], v[84:87], a[180:183], v[172:175]
    ds_read_b128 v[76:79], v224 offset:38912
    v_cvt_pk_bf16_f32 v12, v40, v41
    v_mfma_f32_16x16x32_bf16 v[176:179], v[80:83], a[184:187], v[176:179]
    ds_read_b64_tr_b16 a[200:201], v230 offset:0
    v_sub_f32 v42, v42, v50
    v_mfma_f32_16x16x32_bf16 v[180:183], v[84:87], a[184:187], v[180:183]
    ds_read_b64_tr_b16 a[202:203], v230 offset:512
    v_sub_f32 v43, v43, v50
    v_mfma_f32_16x16x32_bf16 v[184:187], v[80:83], a[188:191], v[184:187]
    ds_read_b64_tr_b16 a[204:205], v231 offset:0
    v_cvt_pk_bf16_f32 v43, v42, v43
    v_mfma_f32_16x16x32_bf16 v[188:191], v[84:87], a[188:191], v[188:191]
    ds_read_b64_tr_b16 a[206:207], v231 offset:512
    v_lshlrev_b32 v42, 16, v43
    v_mfma_f32_16x16x32_bf16 v[192:195], v[88:91], a[176:179], v[192:195]
    s_add_u32 m0, s34, 16384
    s_add_u32 s37, s82, 131072
    buffer_load_dwordx4 v232, s[44:47], s37 offen lds
    v_mfma_f32_16x16x32_bf16 v[196:199], v[92:95], a[176:179], v[196:199]
    v_and_b32 v43, 0xffff0000, v43
    v_mul_f32 v42, v42, v51
    v_mfma_f32_16x16x32_bf16 v[200:203], v[88:91], a[180:183], v[200:203]
    v_mul_f32 v43, v43, v51
    v_cvt_pk_bf16_f32 v13, v42, v43
    v_mfma_f32_16x16x32_bf16 v[204:207], v[92:95], a[180:183], v[204:207]
    v_sub_f32 v44, v44, v50
    v_sub_f32 v45, v45, v50
    v_mfma_f32_16x16x32_bf16 v[208:211], v[88:91], a[184:187], v[208:211]
    buffer_load_dwordx4 v233, s[44:47], s37 offen offset:1024 lds
    v_cvt_pk_bf16_f32 v45, v44, v45
    v_mfma_f32_16x16x32_bf16 v[212:215], v[92:95], a[184:187], v[212:215]
    v_lshlrev_b32 v44, 16, v45
    v_and_b32 v45, 0xffff0000, v45
    v_mfma_f32_16x16x32_bf16 v[216:219], v[88:91], a[188:191], v[216:219]
    v_mul_f32 v44, v44, v51
    v_mul_f32 v45, v45, v51
    v_mfma_f32_16x16x32_bf16 v[220:223], v[92:95], a[188:191], v[220:223]
    v_cvt_pk_bf16_f32 v14, v44, v45
    s_waitcnt lgkmcnt(0)
    v_mfma_f32_16x16x32_bf16 v[96:99], v[64:67], a[192:195], v[96:99]
    ds_read_b128 v[80:83], v224 offset:40960
    v_sub_f32 v46, v46, v50
    v_mfma_f32_16x16x32_bf16 v[100:103], v[68:71], a[192:195], v[100:103]
    ds_read_b128 v[84:87], v224 offset:43008
    v_sub_f32 v47, v47, v50
    v_mfma_f32_16x16x32_bf16 v[104:107], v[64:67], a[196:199], v[104:107]
    ds_read_b128 v[88:91], v224 offset:45056
    v_cvt_pk_bf16_f32 v47, v46, v47
    v_mfma_f32_16x16x32_bf16 v[108:111], v[68:71], a[196:199], v[108:111]
    ds_read_b128 v[92:95], v224 offset:47104
    v_lshlrev_b32 v46, 16, v47
    v_mfma_f32_16x16x32_bf16 v[112:115], v[64:67], a[200:203], v[112:115]
    ds_read_b64_tr_b16 a[208:209], v228 offset:4096
    v_and_b32 v47, 0xffff0000, v47
    v_mfma_f32_16x16x32_bf16 v[116:119], v[68:71], a[200:203], v[116:119]
    ds_read_b64_tr_b16 a[210:211], v228 offset:4608
    v_mul_f32 v46, v46, v51
    v_mfma_f32_16x16x32_bf16 v[120:123], v[64:67], a[204:207], v[120:123]
    ds_read_b64_tr_b16 a[212:213], v229 offset:4096
    v_mul_f32 v47, v47, v51
    v_mfma_f32_16x16x32_bf16 v[124:127], v[68:71], a[204:207], v[124:127]
    ds_read_b64_tr_b16 a[214:215], v229 offset:4608
    v_cvt_pk_bf16_f32 v15, v46, v47
    v_mfma_f32_16x16x32_bf16 v[128:131], v[72:75], a[192:195], v[128:131]
    v_mfma_f32_16x16x32_bf16 v[132:135], v[76:79], a[192:195], v[132:135]
    ds_write_b128 v237, v[0:3] offset:0
    v_mfma_f32_16x16x32_bf16 v[136:139], v[72:75], a[196:199], v[136:139]
    ds_write_b128 v237, v[4:7] offset:4096
    v_mfma_f32_16x16x32_bf16 v[140:143], v[76:79], a[196:199], v[140:143]
    ds_write_b128 v237, v[8:11] offset:24576
    v_mfma_f32_16x16x32_bf16 v[144:147], v[72:75], a[200:203], v[144:147]
    ds_write_b128 v237, v[12:15] offset:28672
    v_mfma_f32_16x16x32_bf16 v[148:151], v[76:79], a[200:203], v[148:151]
    v_mfma_f32_16x16x32_bf16 v[152:155], v[72:75], a[204:207], v[152:155]
    v_mfma_f32_16x16x32_bf16 v[156:159], v[76:79], a[204:207], v[156:159]
    s_waitcnt lgkmcnt(0)
    v_mfma_f32_16x16x32_bf16 v[160:163], v[80:83], a[192:195], v[160:163]
    ds_read_b128 v[64:67], v225 offset:32768
    v_mfma_f32_16x16x32_bf16 v[164:167], v[84:87], a[192:195], v[164:167]
    ds_read_b128 v[68:71], v225 offset:34816
    v_mfma_f32_16x16x32_bf16 v[168:171], v[80:83], a[196:199], v[168:171]
    ds_read_b128 v[72:75], v225 offset:36864
    v_mfma_f32_16x16x32_bf16 v[172:175], v[84:87], a[196:199], v[172:175]
    ds_read_b128 v[76:79], v225 offset:38912
    v_mfma_f32_16x16x32_bf16 v[176:179], v[80:83], a[200:203], v[176:179]
    ds_read_b64_tr_b16 a[216:217], v230 offset:4096
    v_mfma_f32_16x16x32_bf16 v[180:183], v[84:87], a[200:203], v[180:183]
    ds_read_b64_tr_b16 a[218:219], v230 offset:4608
    v_mfma_f32_16x16x32_bf16 v[184:187], v[80:83], a[204:207], v[184:187]
    ds_read_b64_tr_b16 a[220:221], v231 offset:4096
    v_mfma_f32_16x16x32_bf16 v[188:191], v[84:87], a[204:207], v[188:191]
    ds_read_b64_tr_b16 a[222:223], v231 offset:4608
    v_mfma_f32_16x16x32_bf16 v[192:195], v[88:91], a[192:195], v[192:195]
    s_add_u32 m0, s34, 24576
    s_add_u32 s37, s83, 131072
    buffer_load_dwordx4 v232, s[44:47], s37 offen lds
    v_mfma_f32_16x16x32_bf16 v[196:199], v[92:95], a[192:195], v[196:199]
    v_mfma_f32_16x16x32_bf16 v[200:203], v[88:91], a[196:199], v[200:203]
    buffer_load_dwordx4 v233, s[44:47], s37 offen offset:1024 lds
    v_mfma_f32_16x16x32_bf16 v[204:207], v[92:95], a[196:199], v[204:207]
    v_mfma_f32_16x16x32_bf16 v[208:211], v[88:91], a[200:203], v[208:211]
    v_mfma_f32_16x16x32_bf16 v[212:215], v[92:95], a[200:203], v[212:215]
    buffer_load_dword v254, off, s[88:91], s97 sc1
    v_mfma_f32_16x16x32_bf16 v[216:219], v[88:91], a[204:207], v[216:219]
    v_mfma_f32_16x16x32_bf16 v[220:223], v[92:95], a[204:207], v[220:223]
    s_waitcnt vmcnt(7) lgkmcnt(0)
    v_mfma_f32_16x16x32_bf16 v[96:99], v[64:67], a[208:211], v[96:99]
    ds_read_b128 v[80:83], v225 offset:40960
    v_mfma_f32_16x16x32_bf16 v[100:103], v[68:71], a[208:211], v[100:103]
    ds_read_b128 v[84:87], v225 offset:43008
    s_mul_i32 s38, s2, 100
    v_mfma_f32_16x16x32_bf16 v[104:107], v[64:67], a[212:215], v[104:107]
    ds_read_b128 v[88:91], v225 offset:45056
    v_mfma_f32_16x16x32_bf16 v[108:111], v[68:71], a[212:215], v[108:111]
    ds_read_b128 v[92:95], v225 offset:47104
    v_mfma_f32_16x16x32_bf16 v[112:115], v[64:67], a[216:219], v[112:115]
    ds_read_b64_tr_b16 a[224:225], v228 offset:8192
    v_lshl_add_u32 v60, v253, 2, s38
    v_mfma_f32_16x16x32_bf16 v[116:119], v[68:71], a[216:219], v[116:119]
    ds_read_b64_tr_b16 a[226:227], v228 offset:8704
    v_mfma_f32_16x16x32_bf16 v[120:123], v[64:67], a[220:223], v[120:123]
    ds_read_b64_tr_b16 a[228:229], v229 offset:8192
    v_mfma_f32_16x16x32_bf16 v[124:127], v[68:71], a[220:223], v[124:127]
    ds_read_b64_tr_b16 a[230:231], v229 offset:8704
    v_cmp_gt_u32 vcc, 25, v253
    v_mfma_f32_16x16x32_bf16 v[128:131], v[72:75], a[208:211], v[128:131]
    v_mov_b32 v61, 0
    v_mfma_f32_16x16x32_bf16 v[132:135], v[76:79], a[208:211], v[132:135]
    v_mfma_f32_16x16x32_bf16 v[136:139], v[72:75], a[212:215], v[136:139]
    v_mov_b32 v62, 0x7ffffff0
    v_mfma_f32_16x16x32_bf16 v[140:143], v[76:79], a[212:215], v[140:143]
    v_cndmask_b32 v60, v62, v60, vcc
    v_mfma_f32_16x16x32_bf16 v[144:147], v[72:75], a[216:219], v[144:147]
    v_mfma_f32_16x16x32_bf16 v[148:151], v[76:79], a[216:219], v[148:151]
    buffer_store_dword v61, v60, s[56:59], 0 offen sc1
    v_mfma_f32_16x16x32_bf16 v[152:155], v[72:75], a[220:223], v[152:155]
    v_mfma_f32_16x16x32_bf16 v[156:159], v[76:79], a[220:223], v[156:159]
    s_waitcnt vmcnt(18) lgkmcnt(0)
    s_barrier
    v_mfma_f32_16x16x32_bf16 v[160:163], v[80:83], a[208:211], v[160:163]
    ds_read_b128 v[64:67], v224 offset:49152
    v_mfma_f32_16x16x32_bf16 v[164:167], v[84:87], a[208:211], v[164:167]
    ds_read_b128 v[68:71], v224 offset:51200
    v_mfma_f32_16x16x32_bf16 v[168:171], v[80:83], a[212:215], v[168:171]
    ds_read_b128 v[72:75], v224 offset:53248
    v_mfma_f32_16x16x32_bf16 v[172:175], v[84:87], a[212:215], v[172:175]
    ds_read_b128 v[76:79], v224 offset:55296
    v_mfma_f32_16x16x32_bf16 v[176:179], v[80:83], a[216:219], v[176:179]
    ds_read_b64_tr_b16 a[232:233], v230 offset:8192
    v_mfma_f32_16x16x32_bf16 v[180:183], v[84:87], a[216:219], v[180:183]
    ds_read_b64_tr_b16 a[234:235], v230 offset:8704
    v_mfma_f32_16x16x32_bf16 v[184:187], v[80:83], a[220:223], v[184:187]
    ds_read_b64_tr_b16 a[236:237], v231 offset:8192
    v_mfma_f32_16x16x32_bf16 v[188:191], v[84:87], a[220:223], v[188:191]
    ds_read_b64_tr_b16 a[238:239], v231 offset:8704
    v_mfma_f32_16x16x32_bf16 v[192:195], v[88:91], a[208:211], v[192:195]
    v_lshlrev_b32 v237, 4, v253
    v_add_u32 v237, 81920, v237
    ds_read_b128 v[16:19], v237 offset:0
    ds_read_b128 v[20:23], v237 offset:4096
    ds_read_b128 v[24:27], v237 offset:24576
    ds_read_b128 v[28:31], v237 offset:28672
    s_add_u32 m0, s34, 32768
    s_add_u32 s37, s84, 131072
    buffer_load_dwordx4 v232, s[44:47], s37 offen lds
    v_mfma_f32_16x16x32_bf16 v[196:199], v[92:95], a[208:211], v[196:199]
    v_mfma_f32_16x16x32_bf16 v[200:203], v[88:91], a[212:215], v[200:203]
    v_mfma_f32_16x16x32_bf16 v[204:207], v[92:95], a[212:215], v[204:207]
    v_mfma_f32_16x16x32_bf16 v[208:211], v[88:91], a[216:219], v[208:211]
    buffer_load_dwordx4 v233, s[44:47], s37 offen offset:1024 lds
    v_mfma_f32_16x16x32_bf16 v[212:215], v[92:95], a[216:219], v[212:215]
    v_mfma_f32_16x16x32_bf16 v[216:219], v[88:91], a[220:223], v[216:219]
    v_mfma_f32_16x16x32_bf16 v[220:223], v[92:95], a[220:223], v[220:223]
    s_waitcnt lgkmcnt(0)
    v_mfma_f32_16x16x32_bf16 v[96:99], v[64:67], a[224:227], v[96:99]
    ds_read_b128 v[80:83], v224 offset:57344
    v_mfma_f32_16x16x32_bf16 v[100:103], v[68:71], a[224:227], v[100:103]
    ds_read_b128 v[84:87], v224 offset:59392
    v_mfma_f32_16x16x32_bf16 v[104:107], v[64:67], a[228:231], v[104:107]
    ds_read_b128 v[88:91], v224 offset:61440
    v_mfma_f32_16x16x32_bf16 v[108:111], v[68:71], a[228:231], v[108:111]
    ds_read_b128 v[92:95], v224 offset:63488
    v_mfma_f32_16x16x32_bf16 v[112:115], v[64:67], a[232:235], v[112:115]
    ds_read_b64_tr_b16 a[240:241], v228 offset:12288
    v_mfma_f32_16x16x32_bf16 v[116:119], v[68:71], a[232:235], v[116:119]
    ds_read_b64_tr_b16 a[242:243], v228 offset:12800
    s_mov_b32 s39, 0
    buffer_store_dwordx4 v[16:19], v238, s[8:11], s39 offen sc1
    v_mfma_f32_16x16x32_bf16 v[120:123], v[64:67], a[236:239], v[120:123]
    ds_read_b64_tr_b16 a[244:245], v229 offset:12288
    v_mfma_f32_16x16x32_bf16 v[124:127], v[68:71], a[236:239], v[124:127]
    ds_read_b64_tr_b16 a[246:247], v229 offset:12800
    v_mfma_f32_16x16x32_bf16 v[128:131], v[72:75], a[224:227], v[128:131]
    v_mfma_f32_16x16x32_bf16 v[132:135], v[76:79], a[224:227], v[132:135]
    v_mfma_f32_16x16x32_bf16 v[136:139], v[72:75], a[228:231], v[136:139]
    v_mfma_f32_16x16x32_bf16 v[140:143], v[76:79], a[228:231], v[140:143]
    v_mfma_f32_16x16x32_bf16 v[144:147], v[72:75], a[232:235], v[144:147]
    v_mfma_f32_16x16x32_bf16 v[148:151], v[76:79], a[232:235], v[148:151]
    s_mov_b32 s39, 8192
    buffer_store_dwordx4 v[20:23], v238, s[8:11], s39 offen sc1
    v_mfma_f32_16x16x32_bf16 v[152:155], v[72:75], a[236:239], v[152:155]
    v_mfma_f32_16x16x32_bf16 v[156:159], v[76:79], a[236:239], v[156:159]
    s_waitcnt lgkmcnt(0)
    v_mfma_f32_16x16x32_bf16 v[160:163], v[80:83], a[224:227], v[160:163]
    ds_read_b128 v[64:67], v225 offset:49152
    v_mfma_f32_16x16x32_bf16 v[164:167], v[84:87], a[224:227], v[164:167]
    ds_read_b128 v[68:71], v225 offset:51200
    v_mfma_f32_16x16x32_bf16 v[168:171], v[80:83], a[228:231], v[168:171]
    ds_read_b128 v[72:75], v225 offset:53248
    v_mfma_f32_16x16x32_bf16 v[172:175], v[84:87], a[228:231], v[172:175]
    ds_read_b128 v[76:79], v225 offset:55296
    v_mfma_f32_16x16x32_bf16 v[176:179], v[80:83], a[232:235], v[176:179]
    ds_read_b64_tr_b16 a[248:249], v230 offset:12288
    v_mfma_f32_16x16x32_bf16 v[180:183], v[84:87], a[232:235], v[180:183]
    ds_read_b64_tr_b16 a[250:251], v230 offset:12800
    s_mov_b32 s39, 16384
    buffer_store_dwordx4 v[24:27], v238, s[8:11], s39 offen sc1
    v_mfma_f32_16x16x32_bf16 v[184:187], v[80:83], a[236:239], v[184:187]
    ds_read_b64_tr_b16 a[252:253], v231 offset:12288
    v_mfma_f32_16x16x32_bf16 v[188:191], v[84:87], a[236:239], v[188:191]
    ds_read_b64_tr_b16 a[254:255], v231 offset:12800
    v_mfma_f32_16x16x32_bf16 v[192:195], v[88:91], a[224:227], v[192:195]
    s_add_u32 m0, s34, 40960
    s_add_u32 s37, s85, 131072
    buffer_load_dwordx4 v232, s[44:47], s37 offen lds
    v_mfma_f32_16x16x32_bf16 v[196:199], v[92:95], a[224:227], v[196:199]
    v_mfma_f32_16x16x32_bf16 v[200:203], v[88:91], a[228:231], v[200:203]
    v_mfma_f32_16x16x32_bf16 v[204:207], v[92:95], a[228:231], v[204:207]
    v_mfma_f32_16x16x32_bf16 v[208:211], v[88:91], a[232:235], v[208:211]
    buffer_load_dwordx4 v233, s[44:47], s37 offen offset:1024 lds
    v_mfma_f32_16x16x32_bf16 v[212:215], v[92:95], a[232:235], v[212:215]
    s_mov_b32 s39, 24576
    buffer_store_dwordx4 v[28:31], v238, s[8:11], s39 offen sc1
    v_mfma_f32_16x16x32_bf16 v[216:219], v[88:91], a[236:239], v[216:219]
    v_mfma_f32_16x16x32_bf16 v[220:223], v[92:95], a[236:239], v[220:223]
    s_waitcnt lgkmcnt(0)
    v_mfma_f32_16x16x32_bf16 v[96:99], v[64:67], a[240:243], v[96:99]
    ds_read_b128 v[80:83], v225 offset:57344
    v_mfma_f32_16x16x32_bf16 v[100:103], v[68:71], a[240:243], v[100:103]
    ds_read_b128 v[84:87], v225 offset:59392
    v_mfma_f32_16x16x32_bf16 v[104:107], v[64:67], a[244:247], v[104:107]
    ds_read_b128 v[88:91], v225 offset:61440
    v_mfma_f32_16x16x32_bf16 v[108:111], v[68:71], a[244:247], v[108:111]
    ds_read_b128 v[92:95], v225 offset:63488
    v_mfma_f32_16x16x32_bf16 v[112:115], v[64:67], a[248:251], v[112:115]
    v_mfma_f32_16x16x32_bf16 v[116:119], v[68:71], a[248:251], v[116:119]
    v_mfma_f32_16x16x32_bf16 v[120:123], v[64:67], a[252:255], v[120:123]
    v_mfma_f32_16x16x32_bf16 v[124:127], v[68:71], a[252:255], v[124:127]
    v_mfma_f32_16x16x32_bf16 v[128:131], v[72:75], a[240:243], v[128:131]
    v_mfma_f32_16x16x32_bf16 v[132:135], v[76:79], a[240:243], v[132:135]
    v_cvt_pk_bf16_f32 v0, v96, v97
    v_cvt_pk_bf16_f32 v1, v98, v99
    v_mfma_f32_16x16x32_bf16 v[136:139], v[72:75], a[244:247], v[136:139]
    v_cvt_pk_bf16_f32 v2, v100, v101
    v_cvt_pk_bf16_f32 v3, v102, v103
    v_mfma_f32_16x16x32_bf16 v[140:143], v[76:79], a[244:247], v[140:143]
    v_cvt_pk_bf16_f32 v4, v104, v105
    v_cvt_pk_bf16_f32 v5, v106, v107
    v_mfma_f32_16x16x32_bf16 v[144:147], v[72:75], a[248:251], v[144:147]
    v_cvt_pk_bf16_f32 v6, v108, v109
    v_cvt_pk_bf16_f32 v7, v110, v111
    v_mfma_f32_16x16x32_bf16 v[148:151], v[76:79], a[248:251], v[148:151]
    v_cvt_pk_bf16_f32 v8, v112, v113
    v_cvt_pk_bf16_f32 v9, v114, v115
    v_mfma_f32_16x16x32_bf16 v[152:155], v[72:75], a[252:255], v[152:155]
    v_cvt_pk_bf16_f32 v10, v116, v117
    v_cvt_pk_bf16_f32 v11, v118, v119
    v_mfma_f32_16x16x32_bf16 v[156:159], v[76:79], a[252:255], v[156:159]
    v_cvt_pk_bf16_f32 v12, v120, v121
    v_cvt_pk_bf16_f32 v13, v122, v123
    s_waitcnt vmcnt(14) lgkmcnt(0)
    s_barrier
    v_mfma_f32_16x16x32_bf16 v[160:163], v[80:83], a[240:243], v[160:163]
    ds_read_b128 v[64:67], v224 offset:0
    v_cvt_pk_bf16_f32 v14, v124, v125
    v_cvt_pk_bf16_f32 v15, v126, v127
    v_mfma_f32_16x16x32_bf16 v[164:167], v[84:87], a[240:243], v[164:167]
    ds_read_b128 v[68:71], v224 offset:2048
    v_cvt_pk_bf16_f32 v16, v128, v129
    v_cvt_pk_bf16_f32 v17, v130, v131
    v_mfma_f32_16x16x32_bf16 v[168:171], v[80:83], a[244:247], v[168:171]
    ds_read_b128 v[72:75], v224 offset:4096
    v_cvt_pk_bf16_f32 v18, v132, v133
    v_cvt_pk_bf16_f32 v19, v134, v135
    v_mfma_f32_16x16x32_bf16 v[172:175], v[84:87], a[244:247], v[172:175]
    ds_read_b128 v[76:79], v224 offset:6144
    v_cvt_pk_bf16_f32 v20, v136, v137
    v_cvt_pk_bf16_f32 v21, v138, v139
    v_mfma_f32_16x16x32_bf16 v[176:179], v[80:83], a[248:251], v[176:179]
    v_cvt_pk_bf16_f32 v22, v140, v141
    v_cvt_pk_bf16_f32 v23, v142, v143
    v_mfma_f32_16x16x32_bf16 v[180:183], v[84:87], a[248:251], v[180:183]
    v_cvt_pk_bf16_f32 v24, v144, v145
    v_cvt_pk_bf16_f32 v25, v146, v147
    v_mfma_f32_16x16x32_bf16 v[184:187], v[80:83], a[252:255], v[184:187]
    v_cvt_pk_bf16_f32 v26, v148, v149
    v_cvt_pk_bf16_f32 v27, v150, v151
    v_mfma_f32_16x16x32_bf16 v[188:191], v[84:87], a[252:255], v[188:191]
    v_cvt_pk_bf16_f32 v28, v152, v153
    v_cvt_pk_bf16_f32 v29, v154, v155
    v_mfma_f32_16x16x32_bf16 v[192:195], v[88:91], a[240:243], v[192:195]
    s_add_u32 m0, s34, 49152
    s_add_u32 s37, s86, 131072
    buffer_load_dwordx4 v232, s[44:47], s37 offen lds
    v_cvt_pk_bf16_f32 v30, v156, v157
    v_cvt_pk_bf16_f32 v31, v158, v159
    v_mfma_f32_16x16x32_bf16 v[196:199], v[92:95], a[240:243], v[196:199]
    v_cvt_pk_bf16_f32 v32, v160, v161
    v_cvt_pk_bf16_f32 v33, v162, v163
    v_mfma_f32_16x16x32_bf16 v[200:203], v[88:91], a[244:247], v[200:203]
    v_cvt_pk_bf16_f32 v34, v164, v165
    v_cvt_pk_bf16_f32 v35, v166, v167
    v_mfma_f32_16x16x32_bf16 v[204:207], v[92:95], a[244:247], v[204:207]
    v_cvt_pk_bf16_f32 v36, v168, v169
    v_cvt_pk_bf16_f32 v37, v170, v171
    v_mfma_f32_16x16x32_bf16 v[208:211], v[88:91], a[248:251], v[208:211]
    buffer_load_dwordx4 v233, s[44:47], s37 offen offset:1024 lds
    v_cvt_pk_bf16_f32 v38, v172, v173
    v_cvt_pk_bf16_f32 v39, v174, v175
    v_mfma_f32_16x16x32_bf16 v[212:215], v[92:95], a[248:251], v[212:215]
    v_cvt_pk_bf16_f32 v40, v176, v177
    v_cvt_pk_bf16_f32 v41, v178, v179
    v_mfma_f32_16x16x32_bf16 v[216:219], v[88:91], a[252:255], v[216:219]
    v_cvt_pk_bf16_f32 v42, v180, v181
    v_cvt_pk_bf16_f32 v43, v182, v183
    v_mfma_f32_16x16x32_bf16 v[220:223], v[92:95], a[252:255], v[220:223]
    v_cvt_pk_bf16_f32 v44, v184, v185
    v_cvt_pk_bf16_f32 v45, v186, v187
    s_waitcnt lgkmcnt(0)
    v_mfma_f32_16x16x32_bf16 v[96:99], v[64:67], a[0:3], 0
    ds_read_b128 v[80:83], v225 offset:0
    v_cvt_pk_bf16_f32 v46, v188, v189
    v_cvt_pk_bf16_f32 v47, v190, v191
    v_mfma_f32_16x16x32_bf16 v[100:103], v[68:71], a[0:3], 0
    ds_read_b128 v[84:87], v225 offset:2048
    v_cvt_pk_bf16_f32 v48, v192, v193
    v_cvt_pk_bf16_f32 v49, v194, v195
    v_mfma_f32_16x16x32_bf16 v[104:107], v[64:67], a[4:7], 0
    ds_read_b128 v[88:91], v225 offset:4096
    v_cvt_pk_bf16_f32 v50, v196, v197
    v_cvt_pk_bf16_f32 v51, v198, v199
    v_mfma_f32_16x16x32_bf16 v[108:111], v[68:71], a[4:7], 0
    ds_read_b128 v[92:95], v225 offset:6144
    v_cvt_pk_bf16_f32 v52, v200, v201
    v_cvt_pk_bf16_f32 v53, v202, v203
    v_mfma_f32_16x16x32_bf16 v[112:115], v[64:67], a[8:11], 0
    v_cvt_pk_bf16_f32 v54, v204, v205
    v_cvt_pk_bf16_f32 v55, v206, v207
    s_add_u32 s38, s36, 0
    buffer_store_dwordx4 v[0:3], v240, s[16:19], s38 offen offset:0 sc1
    v_mfma_f32_16x16x32_bf16 v[116:119], v[68:71], a[8:11], 0
    v_cvt_pk_bf16_f32 v56, v208, v209
    v_cvt_pk_bf16_f32 v57, v210, v211
    v_mfma_f32_16x16x32_bf16 v[120:123], v[64:67], a[12:15], 0
    v_cvt_pk_bf16_f32 v58, v212, v213
    v_cvt_pk_bf16_f32 v59, v214, v215
    v_mfma_f32_16x16x32_bf16 v[124:127], v[68:71], a[12:15], 0
    v_cvt_pk_bf16_f32 v60, v216, v217
    v_cvt_pk_bf16_f32 v61, v218, v219
    v_mfma_f32_16x16x32_bf16 v[128:131], v[72:75], a[0:3], 0
    v_xor_b32 v237, 32, v245
    v_xor_b32 v238, 32, v246
    v_cvt_pk_bf16_f32 v62, v220, v221
    v_cvt_pk_bf16_f32 v63, v222, v223
    v_mfma_f32_16x16x32_bf16 v[132:135], v[76:79], a[0:3], 0
    v_mfma_f32_16x16x32_bf16 v[136:139], v[72:75], a[4:7], 0
    v_mfma_f32_16x16x32_bf16 v[140:143], v[76:79], a[4:7], 0
    v_mfma_f32_16x16x32_bf16 v[144:147], v[72:75], a[8:11], 0
    v_mfma_f32_16x16x32_bf16 v[148:151], v[76:79], a[8:11], 0
    v_mfma_f32_16x16x32_bf16 v[152:155], v[72:75], a[12:15], 0
    v_mfma_f32_16x16x32_bf16 v[156:159], v[76:79], a[12:15], 0
    s_waitcnt lgkmcnt(0)
    v_mfma_f32_16x16x32_bf16 v[96:99], v[80:83], a[16:19], v[96:99]
    ds_read_b128 v[64:67], v224 offset:8192
    v_mfma_f32_16x16x32_bf16 v[100:103], v[84:87], a[16:19], v[100:103]
    ds_read_b128 v[68:71], v224 offset:10240
    v_mfma_f32_16x16x32_bf16 v[104:107], v[80:83], a[20:23], v[104:107]
    ds_read_b128 v[72:75], v224 offset:12288
    v_mfma_f32_16x16x32_bf16 v[108:111], v[84:87], a[20:23], v[108:111]
    ds_read_b128 v[76:79], v224 offset:14336
    v_mfma_f32_16x16x32_bf16 v[112:115], v[80:83], a[24:27], v[112:115]
    v_mfma_f32_16x16x32_bf16 v[116:119], v[84:87], a[24:27], v[116:119]
    v_mfma_f32_16x16x32_bf16 v[120:123], v[80:83], a[28:31], v[120:123]
    v_mfma_f32_16x16x32_bf16 v[124:127], v[84:87], a[28:31], v[124:127]
    v_mfma_f32_16x16x32_bf16 v[128:131], v[88:91], a[16:19], v[128:131]
    s_add_u32 m0, s34, 57344
    s_add_u32 s37, s87, 131072
    buffer_load_dwordx4 v232, s[44:47], s37 offen lds
    v_mfma_f32_16x16x32_bf16 v[132:135], v[92:95], a[16:19], v[132:135]
    s_add_u32 s38, s36, 0
    buffer_store_dwordx4 v[4:7], v240, s[16:19], s38 offen offset:1024 sc1
    v_mfma_f32_16x16x32_bf16 v[136:139], v[88:91], a[20:23], v[136:139]
    v_mfma_f32_16x16x32_bf16 v[140:143], v[92:95], a[20:23], v[140:143]
    v_mfma_f32_16x16x32_bf16 v[144:147], v[88:91], a[24:27], v[144:147]
    buffer_load_dwordx4 v233, s[44:47], s37 offen offset:1024 lds
    v_mfma_f32_16x16x32_bf16 v[148:151], v[92:95], a[24:27], v[148:151]
    v_mfma_f32_16x16x32_bf16 v[152:155], v[88:91], a[28:31], v[152:155]
    v_mfma_f32_16x16x32_bf16 v[156:159], v[92:95], a[28:31], v[156:159]
    s_waitcnt lgkmcnt(0)
    v_mfma_f32_16x16x32_bf16 v[96:99], v[64:67], a[32:35], v[96:99]
    ds_read_b128 v[80:83], v225 offset:8192
    v_mfma_f32_16x16x32_bf16 v[100:103], v[68:71], a[32:35], v[100:103]
    ds_read_b128 v[84:87], v225 offset:10240
    v_mfma_f32_16x16x32_bf16 v[104:107], v[64:67], a[36:39], v[104:107]
    ds_read_b128 v[88:91], v225 offset:12288
    v_mfma_f32_16x16x32_bf16 v[108:111], v[68:71], a[36:39], v[108:111]
    ds_read_b128 v[92:95], v225 offset:14336
    v_mfma_f32_16x16x32_bf16 v[112:115], v[64:67], a[40:43], v[112:115]
    v_mfma_f32_16x16x32_bf16 v[116:119], v[68:71], a[40:43], v[116:119]
    v_mfma_f32_16x16x32_bf16 v[120:123], v[64:67], a[44:47], v[120:123]
    v_mfma_f32_16x16x32_bf16 v[124:127], v[68:71], a[44:47], v[124:127]
    v_mfma_f32_16x16x32_bf16 v[128:131], v[72:75], a[32:35], v[128:131]
    s_waitcnt vmcnt(15)
    v_readfirstlane_b32 s24, v254
    s_lshl_b32 s25, s3, 16
    s_add_u32 s24, s24, s25
    s_cmp_ge_u32 s24, 1
    s_cbranch_scc0 kf_spin35
kf_spinr36:
    v_mfma_f32_16x16x32_bf16 v[132:135], v[76:79], a[32:35], v[132:135]
    v_mfma_f32_16x16x32_bf16 v[136:139], v[72:75], a[36:39], v[136:139]
    v_mfma_f32_16x16x32_bf16 v[140:143], v[76:79], a[36:39], v[140:143]
    v_mfma_f32_16x16x32_bf16 v[144:147], v[72:75], a[40:43], v[144:147]
    s_add_u32 s88, s20, 0x14a0000
    s_addc_u32 s89, s21, 0
    s_mov_b32 s90, 20480
    v_mfma_f32_16x16x32_bf16 v[148:151], v[76:79], a[40:43], v[148:151]
    v_mfma_f32_16x16x32_bf16 v[152:155], v[72:75], a[44:47], v[152:155]
    v_mfma_f32_16x16x32_bf16 v[156:159], v[76:79], a[44:47], v[156:159]
    s_add_u32 s38, s36, 0
    buffer_store_dwordx4 v[8:11], v240, s[16:19], s38 offen offset:2048 sc1
    s_waitcnt vmcnt(7) lgkmcnt(0)
    s_barrier
    v_mfma_f32_16x16x32_bf16 v[96:99], v[80:83], a[48:51], v[96:99]
    ds_read_b128 v[64:67], v224 offset:16384
    v_mfma_f32_16x16x32_bf16 v[100:103], v[84:87], a[48:51], v[100:103]
    ds_read_b128 v[68:71], v224 offset:18432
    v_mfma_f32_16x16x32_bf16 v[104:107], v[80:83], a[52:55], v[104:107]
    ds_read_b128 v[72:75], v224 offset:20480
    v_mfma_f32_16x16x32_bf16 v[108:111], v[84:87], a[52:55], v[108:111]
    ds_read_b128 v[76:79], v224 offset:22528
    v_mfma_f32_16x16x32_bf16 v[112:115], v[80:83], a[56:59], v[112:115]
    v_mfma_f32_16x16x32_bf16 v[116:119], v[84:87], a[56:59], v[116:119]
    v_mfma_f32_16x16x32_bf16 v[120:123], v[80:83], a[60:63], v[120:123]
    v_mfma_f32_16x16x32_bf16 v[124:127], v[84:87], a[60:63], v[124:127]
    v_mfma_f32_16x16x32_bf16 v[128:131], v[88:91], a[48:51], v[128:131]
    s_add_u32 m0, s34, 0
    s_add_u32 s37, s80, 196608
    buffer_load_dwordx4 v232, s[44:47], s37 offen lds
    v_mfma_f32_16x16x32_bf16 v[132:135], v[92:95], a[48:51], v[132:135]
    v_mfma_f32_16x16x32_bf16 v[136:139], v[88:91], a[52:55], v[136:139]
    buffer_load_dwordx4 v233, s[44:47], s37 offen offset:1024 lds
    v_mfma_f32_16x16x32_bf16 v[140:143], v[92:95], a[52:55], v[140:143]
    v_mfma_f32_16x16x32_bf16 v[144:147], v[88:91], a[56:59], v[144:147]
    v_mfma_f32_16x16x32_bf16 v[148:151], v[92:95], a[56:59], v[148:151]
    s_lshl_b32 s39, s5, 7
    s_add_u32 s39, s39, 8192
    buffer_atomic_add v255, v250, s[88:91], s39 offen sc1
    s_cmp_eq_u32 s3, 0
    s_cselect_b32 s39, s39, s43
    v_mfma_f32_16x16x32_bf16 v[152:155], v[88:91], a[60:63], v[152:155]
    v_mfma_f32_16x16x32_bf16 v[156:159], v[92:95], a[60:63], v[156:159]
    s_waitcnt lgkmcnt(0)
    v_mfma_f32_16x16x32_bf16 v[96:99], v[64:67], a[64:67], v[96:99]
    ds_read_b128 v[80:83], v225 offset:16384
    v_mfma_f32_16x16x32_bf16 v[100:103], v[68:71], a[64:67], v[100:103]
    ds_read_b128 v[84:87], v225 offset:18432
    v_mfma_f32_16x16x32_bf16 v[104:107], v[64:67], a[68:71], v[104:107]
    ds_read_b128 v[88:91], v225 offset:20480
    v_mfma_f32_16x16x32_bf16 v[108:111], v[68:71], a[68:71], v[108:111]
    ds_read_b128 v[92:95], v225 offset:22528
    v_mfma_f32_16x16x32_bf16 v[112:115], v[64:67], a[72:75], v[112:115]
    s_add_u32 s38, s36, 0
    buffer_store_dwordx4 v[12:15], v240, s[16:19], s38 offen offset:3072 sc1
    v_mfma_f32_16x16x32_bf16 v[116:119], v[68:71], a[72:75], v[116:119]
    v_mfma_f32_16x16x32_bf16 v[120:123], v[64:67], a[76:79], v[120:123]
    v_mfma_f32_16x16x32_bf16 v[124:127], v[68:71], a[76:79], v[124:127]
    v_mfma_f32_16x16x32_bf16 v[128:131], v[72:75], a[64:67], v[128:131]
    s_add_u32 m0, s31, 0
    s_add_u32 s24, s27, 0
    buffer_load_dwordx4 v245, s[12:15], s24 offen lds
    v_mfma_f32_16x16x32_bf16 v[132:135], v[76:79], a[64:67], v[132:135]
    v_mfma_f32_16x16x32_bf16 v[136:139], v[72:75], a[68:71], v[136:139]
    v_mfma_f32_16x16x32_bf16 v[140:143], v[76:79], a[68:71], v[140:143]
    v_mfma_f32_16x16x32_bf16 v[144:147], v[72:75], a[72:75], v[144:147]
    v_mfma_f32_16x16x32_bf16 v[148:151], v[76:79], a[72:75], v[148:151]
    v_mfma_f32_16x16x32_bf16 v[152:155], v[72:75], a[76:79], v[152:155]
    v_mfma_f32_16x16x32_bf16 v[156:159], v[76:79], a[76:79], v[156:159]
    s_waitcnt lgkmcnt(0)
    v_mfma_f32_16x16x32_bf16 v[96:99], v[80:83], a[80:83], v[96:99]
    ds_read_b128 v[64:67], v224 offset:24576
    v_mfma_f32_16x16x32_bf16 v[100:103], v[84:87], a[80:83], v[100:103]
    ds_read_b128 v[68:71], v224 offset:26624
    v_mfma_f32_16x16x32_bf16 v[104:107], v[80:83], a[84:87], v[104:107]
    ds_read_b128 v[72:75], v224 offset:28672
    v_mfma_f32_16x16x32_bf16 v[108:111], v[84:87], a[84:87], v[108:111]
    ds_read_b128 v[76:79], v224 offset:30720
    v_mfma_f32_16x16x32_bf16 v[112:115], v[80:83], a[88:91], v[112:115]
    v_mfma_f32_16x16x32_bf16 v[116:119], v[84:87], a[88:91], v[116:119]
    v_mfma_f32_16x16x32_bf16 v[120:123], v[80:83], a[92:95], v[120:123]
    v_mfma_f32_16x16x32_bf16 v[124:127], v[84:87], a[92:95], v[124:127]
    v_mfma_f32_16x16x32_bf16 v[128:131], v[88:91], a[80:83], v[128:131]
    s_add_u32 m0, s34, 8192
    s_add_u32 s37, s81, 196608
    buffer_load_dwordx4 v232, s[44:47], s37 offen lds
    v_mfma_f32_16x16x32_bf16 v[132:135], v[92:95], a[80:83], v[132:135]
    v_mfma_f32_16x16x32_bf16 v[136:139], v[88:91], a[84:87], v[136:139]
    buffer_load_dwordx4 v233, s[44:47], s37 offen offset:1024 lds
    s_add_u32 s38, s36, 8192
    buffer_store_dwordx4 v[16:19], v240, s[16:19], s38 offen offset:0 sc1
    v_mfma_f32_16x16x32_bf16 v[140:143], v[92:95], a[84:87], v[140:143]
    v_mfma_f32_16x16x32_bf16 v[144:147], v[88:91], a[88:91], v[144:147]
    v_mfma_f32_16x16x32_bf16 v[148:151], v[92:95], a[88:91], v[148:151]
    s_add_u32 m0, s31, 1024
    s_add_u32 s24, s27, 32768
    buffer_load_dwordx4 v245, s[12:15], s24 offen lds
    v_mfma_f32_16x16x32_bf16 v[152:155], v[88:91], a[92:95], v[152:155]
    v_mfma_f32_16x16x32_bf16 v[156:159], v[92:95], a[92:95], v[156:159]
    s_waitcnt lgkmcnt(0)
    v_mfma_f32_16x16x32_bf16 v[96:99], v[64:67], a[96:99], v[96:99]
    ds_read_b128 v[80:83], v225 offset:24576
    v_mfma_f32_16x16x32_bf16 v[100:103], v[68:71], a[96:99], v[100:103]
    ds_read_b128 v[84:87], v225 offset:26624
    v_mfma_f32_16x16x32_bf16 v[104:107], v[64:67], a[100:103], v[104:107]
    ds_read_b128 v[88:91], v225 offset:28672
    v_mfma_f32_16x16x32_bf16 v[108:111], v[68:71], a[100:103], v[108:111]
    ds_read_b128 v[92:95], v225 offset:30720
    v_mfma_f32_16x16x32_bf16 v[112:115], v[64:67], a[104:107], v[112:115]
    v_mfma_f32_16x16x32_bf16 v[116:119], v[68:71], a[104:107], v[116:119]
    v_mfma_f32_16x16x32_bf16 v[120:123], v[64:67], a[108:111], v[120:123]
    v_mfma_f32_16x16x32_bf16 v[124:127], v[68:71], a[108:111], v[124:127]
    v_mfma_f32_16x16x32_bf16 v[128:131], v[72:75], a[96:99], v[128:131]
    s_add_u32 m0, s31, 2048
    s_add_u32 s24, s27, 65536
    buffer_load_dwordx4 v237, s[12:15], s24 offen lds
    v_mfma_f32_16x16x32_bf16 v[132:135], v[76:79], a[96:99], v[132:135]
    v_mfma_f32_16x16x32_bf16 v[136:139], v[72:75], a[100:103], v[136:139]
    v_mfma_f32_16x16x32_bf16 v[140:143], v[76:79], a[100:103], v[140:143]
    v_mfma_f32_16x16x32_bf16 v[144:147], v[72:75], a[104:107], v[144:147]
    v_mfma_f32_16x16x32_bf16 v[148:151], v[76:79], a[104:107], v[148:151]
    v_mfma_f32_16x16x32_bf16 v[152:155], v[72:75], a[108:111], v[152:155]
    v_mfma_f32_16x16x32_bf16 v[156:159], v[76:79], a[108:111], v[156:159]
    s_add_u32 s38, s36, 8192
    buffer_store_dwordx4 v[20:23], v240, s[16:19], s38 offen offset:1024 sc1
    s_waitcnt vmcnt(19) lgkmcnt(0)
    s_barrier
    v_mfma_f32_16x16x32_bf16 v[96:99], v[80:83], a[112:115], v[96:99]
    ds_read_b128 v[64:67], v224 offset:32768
    v_mfma_f32_16x16x32_bf16 v[100:103], v[84:87], a[112:115], v[100:103]
    ds_read_b128 v[68:71], v224 offset:34816
    v_mfma_f32_16x16x32_bf16 v[104:107], v[80:83], a[116:119], v[104:107]
    ds_read_b128 v[72:75], v224 offset:36864
    v_mfma_f32_16x16x32_bf16 v[108:111], v[84:87], a[116:119], v[108:111]
    ds_read_b128 v[76:79], v224 offset:38912
    v_mfma_f32_16x16x32_bf16 v[112:115], v[80:83], a[120:123], v[112:115]
    v_mfma_f32_16x16x32_bf16 v[116:119], v[84:87], a[120:123], v[116:119]
    v_mfma_f32_16x16x32_bf16 v[120:123], v[80:83], a[124:127], v[120:123]
    v_mfma_f32_16x16x32_bf16 v[124:127], v[84:87], a[124:127], v[124:127]
    v_mfma_f32_16x16x32_bf16 v[128:131], v[88:91], a[112:115], v[128:131]
    s_add_u32 m0, s34, 16384
    s_add_u32 s37, s82, 196608
    buffer_load_dwordx4 v232, s[44:47], s37 offen lds
    v_mfma_f32_16x16x32_bf16 v[132:135], v[92:95], a[112:115], v[132:135]
    v_mfma_f32_16x16x32_bf16 v[136:139], v[88:91], a[116:119], v[136:139]
    buffer_load_dwordx4 v233, s[44:47], s37 offen offset:1024 lds
    v_mfma_f32_16x16x32_bf16 v[140:143], v[92:95], a[116:119], v[140:143]
    v_mfma_f32_16x16x32_bf16 v[144:147], v[88:91], a[120:123], v[144:147]
    v_mfma_f32_16x16x32_bf16 v[148:151], v[92:95], a[120:123], v[148:151]
    s_add_u32 m0, s31, 3072
    s_add_u32 s24, s27, 98304
    buffer_load_dwordx4 v237, s[12:15], s24 offen lds
    v_mfma_f32_16x16x32_bf16 v[152:155], v[88:91], a[124:127], v[152:155]
    v_mfma_f32_16x16x32_bf16 v[156:159], v[92:95], a[124:127], v[156:159]
    s_waitcnt lgkmcnt(0)
    v_mfma_f32_16x16x32_bf16 v[96:99], v[64:67], a[128:131], v[96:99]
    ds_read_b128 v[80:83], v225 offset:32768
    v_mfma_f32_16x16x32_bf16 v[100:103], v[68:71], a[128:131], v[100:103]
    ds_read_b128 v[84:87], v225 offset:34816
    v_mfma_f32_16x16x32_bf16 v[104:107], v[64:67], a[132:135], v[104:107]
    ds_read_b128 v[88:91], v225 offset:36864
    v_mfma_f32_16x16x32_bf16 v[108:111], v[68:71], a[132:135], v[108:111]
    ds_read_b128 v[92:95], v225 offset:38912
    v_mfma_f32_16x16x32_bf16 v[112:115], v[64:67], a[136:139], v[112:115]
    v_mfma_f32_16x16x32_bf16 v[116:119], v[68:71], a[136:139], v[116:119]
    s_add_u32 s38, s36, 8192
    buffer_store_dwordx4 v[24:27], v240, s[16:19], s38 offen offset:2048 sc1
    v_mfma_f32_16x16x32_bf16 v[120:123], v[64:67], a[140:143], v[120:123]
    v_mfma_f32_16x16x32_bf16 v[124:127], v[68:71], a[140:143], v[124:127]
    v_mfma_f32_16x16x32_bf16 v[128:131], v[72:75], a[128:131], v[128:131]
    s_add_u32 m0, s31, 4096
    s_add_u32 s24, s27, 131072
    buffer_load_dwordx4 v245, s[12:15], s24 offen lds
    v_mfma_f32_16x16x32_bf16 v[132:135], v[76:79], a[128:131], v[132:135]
    v_mfma_f32_16x16x32_bf16 v[136:139], v[72:75], a[132:135], v[136:139]
    v_mfma_f32_16x16x32_bf16 v[140:143], v[76:79], a[132:135], v[140:143]
    v_mfma_f32_16x16x32_bf16 v[144:147], v[72:75], a[136:139], v[144:147]
    v_mfma_f32_16x16x32_bf16 v[148:151], v[76:79], a[136:139], v[148:151]
    v_mfma_f32_16x16x32_bf16 v[152:155], v[72:75], a[140:143], v[152:155]
    v_mfma_f32_16x16x32_bf16 v[156:159], v[76:79], a[140:143], v[156:159]
    s_waitcnt lgkmcnt(0)
    v_mfma_f32_16x16x32_bf16 v[96:99], v[80:83], a[144:147], v[96:99]
    ds_read_b128 v[64:67], v224 offset:40960
    v_mfma_f32_16x16x32_bf16 v[100:103], v[84:87], a[144:147], v[100:103]
    ds_read_b128 v[68:71], v224 offset:43008
    v_mfma_f32_16x16x32_bf16 v[104:107], v[80:83], a[148:151], v[104:107]
    ds_read_b128 v[72:75], v224 offset:45056
    v_mfma_f32_16x16x32_bf16 v[108:111], v[84:87], a[148:151], v[108:111]
    ds_read_b128 v[76:79], v224 offset:47104
    v_mfma_f32_16x16x32_bf16 v[112:115], v[80:83], a[152:155], v[112:115]
    v_mfma_f32_16x16x32_bf16 v[116:119], v[84:87], a[152:155], v[116:119]
    v_mfma_f32_16x16x32_bf16 v[120:123], v[80:83], a[156:159], v[120:123]
    v_mfma_f32_16x16x32_bf16 v[124:127], v[84:87], a[156:159], v[124:127]
    v_mfma_f32_16x16x32_bf16 v[128:131], v[88:91], a[144:147], v[128:131]
    s_add_u32 m0, s34, 24576
    s_add_u32 s37, s83, 196608
    buffer_load_dwordx4 v232, s[44:47], s37 offen lds
    v_mfma_f32_16x16x32_bf16 v[132:135], v[92:95], a[144:147], v[132:135]
    v_mfma_f32_16x16x32_bf16 v[136:139], v[88:91], a[148:151], v[136:139]
    buffer_load_dwordx4 v233, s[44:47], s37 offen offset:1024 lds
    s_add_u32 s38, s36, 8192
    buffer_store_dwordx4 v[28:31], v240, s[16:19], s38 offen offset:3072 sc1
    v_mfma_f32_16x16x32_bf16 v[140:143], v[92:95], a[148:151], v[140:143]
    v_mfma_f32_16x16x32_bf16 v[144:147], v[88:91], a[152:155], v[144:147]
    v_mfma_f32_16x16x32_bf16 v[148:151], v[92:95], a[152:155], v[148:151]
    s_add_u32 m0, s31, 5120
    s_add_u32 s24, s27, 163840
    buffer_load_dwordx4 v245, s[12:15], s24 offen lds
    v_mfma_f32_16x16x32_bf16 v[152:155], v[88:91], a[156:159], v[152:155]
    v_mfma_f32_16x16x32_bf16 v[156:159], v[92:95], a[156:159], v[156:159]
    s_waitcnt lgkmcnt(0)
    v_mfma_f32_16x16x32_bf16 v[96:99], v[64:67], a[160:163], v[96:99]
    ds_read_b128 v[80:83], v225 offset:40960
    v_mfma_f32_16x16x32_bf16 v[100:103], v[68:71], a[160:163], v[100:103]
    ds_read_b128 v[84:87], v225 offset:43008
    v_mfma_f32_16x16x32_bf16 v[104:107], v[64:67], a[164:167], v[104:107]
    ds_read_b128 v[88:91], v225 offset:45056
    v_mfma_f32_16x16x32_bf16 v[108:111], v[68:71], a[164:167], v[108:111]
    ds_read_b128 v[92:95], v225 offset:47104
    v_mfma_f32_16x16x32_bf16 v[112:115], v[64:67], a[168:171], v[112:115]
    v_mfma_f32_16x16x32_bf16 v[116:119], v[68:71], a[168:171], v[116:119]
    v_mfma_f32_16x16x32_bf16 v[120:123], v[64:67], a[172:175], v[120:123]
    v_mfma_f32_16x16x32_bf16 v[124:127], v[68:71], a[172:175], v[124:127]
    v_mfma_f32_16x16x32_bf16 v[128:131], v[72:75], a[160:163], v[128:131]
    s_add_u32 m0, s31, 6144
    s_add_u32 s24, s27, 196608
    buffer_load_dwordx4 v237, s[12:15], s24 offen lds
    v_mfma_f32_16x16x32_bf16 v[132:135], v[76:79], a[160:163], v[132:135]
    v_mfma_f32_16x16x32_bf16 v[136:139], v[72:75], a[164:167], v[136:139]
    v_mfma_f32_16x16x32_bf16 v[140:143], v[76:79], a[164:167], v[140:143]
    v_mfma_f32_16x16x32_bf16 v[144:147], v[72:75], a[168:171], v[144:147]
    v_mfma_f32_16x16x32_bf16 v[148:151], v[76:79], a[168:171], v[148:151]
    v_mfma_f32_16x16x32_bf16 v[152:155], v[72:75], a[172:175], v[152:155]
    v_mfma_f32_16x16x32_bf16 v[156:159], v[76:79], a[172:175], v[156:159]
    s_waitcnt vmcnt(22) lgkmcnt(0)
    s_barrier
    v_mfma_f32_16x16x32_bf16 v[96:99], v[80:83], a[176:179], v[96:99]
    ds_read_b128 v[64:67], v224 offset:49152
    s_add_u32 s38, s36, 32768
    buffer_store_dwordx4 v[32:35], v240, s[16:19], s38 offen offset:1280 sc1
    v_mfma_f32_16x16x32_bf16 v[100:103], v[84:87], a[176:179], v[100:103]
    ds_read_b128 v[68:71], v224 offset:51200
    v_mfma_f32_16x16x32_bf16 v[104:107], v[80:83], a[180:183], v[104:107]
    ds_read_b128 v[72:75], v224 offset:53248
    v_mfma_f32_16x16x32_bf16 v[108:111], v[84:87], a[180:183], v[108:111]
    ds_read_b128 v[76:79], v224 offset:55296
    v_mfma_f32_16x16x32_bf16 v[112:115], v[80:83], a[184:187], v[112:115]
    v_mfma_f32_16x16x32_bf16 v[116:119], v[84:87], a[184:187], v[116:119]
    v_mfma_f32_16x16x32_bf16 v[120:123], v[80:83], a[188:191], v[120:123]
    v_mfma_f32_16x16x32_bf16 v[124:127], v[84:87], a[188:191], v[124:127]
    v_mfma_f32_16x16x32_bf16 v[128:131], v[88:91], a[176:179], v[128:131]
    s_add_u32 m0, s34, 32768
    s_add_u32 s37, s84, 196608
    buffer_load_dwordx4 v232, s[44:47], s37 offen lds
    v_mfma_f32_16x16x32_bf16 v[132:135], v[92:95], a[176:179], v[132:135]
    buffer_load_dwordx4 v233, s[44:47], s37 offen offset:1024 lds
    v_mfma_f32_16x16x32_bf16 v[136:139], v[88:91], a[180:183], v[136:139]
    v_mfma_f32_16x16x32_bf16 v[140:143], v[92:95], a[180:183], v[140:143]
    s_add_u32 m0, s31, 7168
    s_add_u32 s24, s27, 229376
    buffer_load_dwordx4 v237, s[12:15], s24 offen lds
    v_mfma_f32_16x16x32_bf16 v[144:147], v[88:91], a[184:187], v[144:147]
    s_add_u32 s27, s27, 1048576
    s_and_b32 s27, s27, 0x407fffff
    s_cmp_eq_u32 s27, s7
    s_cselect_b32 s27, s43, s27
    v_mfma_f32_16x16x32_bf16 v[148:151], v[92:95], a[184:187], v[148:151]
    v_mfma_f32_16x16x32_bf16 v[152:155], v[88:91], a[188:191], v[152:155]
    s_add_u32 s31, s31, 32768
    s_cmp_ge_u32 s31, 163840
    s_cselect_b32 s24, 98304, 0
    s_sub_u32 s31, s31, s24
    v_mfma_f32_16x16x32_bf16 v[156:159], v[92:95], a[188:191], v[156:159]
    s_waitcnt lgkmcnt(0)
    v_mfma_f32_16x16x32_bf16 v[96:99], v[64:67], a[192:195], v[96:99]
    ds_read_b128 v[80:83], v225 offset:49152
    v_mfma_f32_16x16x32_bf16 v[100:103], v[68:71], a[192:195], v[100:103]
    ds_read_b128 v[84:87], v225 offset:51200
    v_mfma_f32_16x16x32_bf16 v[104:107], v[64:67], a[196:199], v[104:107]
    ds_read_b128 v[88:91], v225 offset:53248
    v_mfma_f32_16x16x32_bf16 v[108:111], v[68:71], a[196:199], v[108:111]
    ds_read_b128 v[92:95], v225 offset:55296
    v_mfma_f32_16x16x32_bf16 v[112:115], v[64:67], a[200:203], v[112:115]
    v_mfma_f32_16x16x32_bf16 v[116:119], v[68:71], a[200:203], v[116:119]
    v_mfma_f32_16x16x32_bf16 v[120:123], v[64:67], a[204:207], v[120:123]
    s_add_u32 s38, s36, 32768
    buffer_store_dwordx4 v[36:39], v240, s[16:19], s38 offen offset:2304 sc1
    v_mfma_f32_16x16x32_bf16 v[124:127], v[68:71], a[204:207], v[124:127]
    v_mfma_f32_16x16x32_bf16 v[128:131], v[72:75], a[192:195], v[128:131]
    v_mfma_f32_16x16x32_bf16 v[132:135], v[76:79], a[192:195], v[132:135]
    v_mfma_f32_16x16x32_bf16 v[136:139], v[72:75], a[196:199], v[136:139]
    v_mfma_f32_16x16x32_bf16 v[140:143], v[76:79], a[196:199], v[140:143]
    v_mfma_f32_16x16x32_bf16 v[144:147], v[72:75], a[200:203], v[144:147]
    v_mfma_f32_16x16x32_bf16 v[148:151], v[76:79], a[200:203], v[148:151]
    v_mfma_f32_16x16x32_bf16 v[152:155], v[72:75], a[204:207], v[152:155]
    v_mfma_f32_16x16x32_bf16 v[156:159], v[76:79], a[204:207], v[156:159]
    s_waitcnt lgkmcnt(0)
    v_mfma_f32_16x16x32_bf16 v[96:99], v[80:83], a[208:211], v[96:99]
    ds_read_b128 v[64:67], v224 offset:57344
    v_mfma_f32_16x16x32_bf16 v[100:103], v[84:87], a[208:211], v[100:103]
    ds_read_b128 v[68:71], v224 offset:59392
    v_mfma_f32_16x16x32_bf16 v[104:107], v[80:83], a[212:215], v[104:107]
    ds_read_b128 v[72:75], v224 offset:61440
    v_mfma_f32_16x16x32_bf16 v[108:111], v[84:87], a[212:215], v[108:111]
    ds_read_b128 v[76:79], v224 offset:63488
    v_mfma_f32_16x16x32_bf16 v[112:115], v[80:83], a[216:219], v[112:115]
    v_mfma_f32_16x16x32_bf16 v[116:119], v[84:87], a[216:219], v[116:119]
    v_mfma_f32_16x16x32_bf16 v[120:123], v[80:83], a[220:223], v[120:123]
    v_mfma_f32_16x16x32_bf16 v[124:127], v[84:87], a[220:223], v[124:127]
    v_mfma_f32_16x16x32_bf16 v[128:131], v[88:91], a[208:211], v[128:131]
    s_add_u32 m0, s34, 40960
    s_add_u32 s37, s85, 196608
    buffer_load_dwordx4 v232, s[44:47], s37 offen lds
    v_mfma_f32_16x16x32_bf16 v[132:135], v[92:95], a[208:211], v[132:135]
    v_mfma_f32_16x16x32_bf16 v[136:139], v[88:91], a[212:215], v[136:139]
    v_mfma_f32_16x16x32_bf16 v[140:143], v[92:95], a[212:215], v[140:143]
    s_add_u32 s38, s36, 32768
    buffer_store_dwordx4 v[40:43], v240, s[16:19], s38 offen offset:3328 sc1
    v_mfma_f32_16x16x32_bf16 v[144:147], v[88:91], a[216:219], v[144:147]
    buffer_load_dwordx4 v233, s[44:47], s37 offen offset:1024 lds
    v_mfma_f32_16x16x32_bf16 v[148:151], v[92:95], a[216:219], v[148:151]
    v_mfma_f32_16x16x32_bf16 v[152:155], v[88:91], a[220:223], v[152:155]
    v_mfma_f32_16x16x32_bf16 v[156:159], v[92:95], a[220:223], v[156:159]
    s_waitcnt lgkmcnt(0)
    v_mfma_f32_16x16x32_bf16 v[96:99], v[64:67], a[224:227], v[96:99]
    ds_read_b128 v[80:83], v225 offset:57344
    v_mfma_f32_16x16x32_bf16 v[100:103], v[68:71], a[224:227], v[100:103]
    ds_read_b128 v[84:87], v225 offset:59392
    v_mfma_f32_16x16x32_bf16 v[104:107], v[64:67], a[228:231], v[104:107]
    ds_read_b128 v[88:91], v225 offset:61440
    v_mfma_f32_16x16x32_bf16 v[108:111], v[68:71], a[228:231], v[108:111]
    ds_read_b128 v[92:95], v225 offset:63488
    v_mfma_f32_16x16x32_bf16 v[112:115], v[64:67], a[232:235], v[112:115]
    v_mfma_f32_16x16x32_bf16 v[116:119], v[68:71], a[232:235], v[116:119]
    v_mfma_f32_16x16x32_bf16 v[120:123], v[64:67], a[236:239], v[120:123]
    v_mfma_f32_16x16x32_bf16 v[124:127], v[68:71], a[236:239], v[124:127]
    v_mfma_f32_16x16x32_bf16 v[128:131], v[72:75], a[224:227], v[128:131]
    s_add_u32 m0, s31, 0
    s_add_u32 s24, s27, 0
    buffer_load_dwordx4 v245, s[12:15], s24 offen lds
    v_mfma_f32_16x16x32_bf16 v[132:135], v[76:79], a[224:227], v[132:135]
    v_mfma_f32_16x16x32_bf16 v[136:139], v[72:75], a[228:231], v[136:139]
    v_mfma_f32_16x16x32_bf16 v[140:143], v[76:79], a[228:231], v[140:143]
    v_mfma_f32_16x16x32_bf16 v[144:147], v[72:75], a[232:235], v[144:147]
    v_mfma_f32_16x16x32_bf16 v[148:151], v[76:79], a[232:235], v[148:151]
    v_mfma_f32_16x16x32_bf16 v[152:155], v[72:75], a[236:239], v[152:155]
    v_mfma_f32_16x16x32_bf16 v[156:159], v[76:79], a[236:239], v[156:159]
    s_waitcnt vmcnt(23) lgkmcnt(0)
    s_barrier
    v_mfma_f32_16x16x32_bf16 v[96:99], v[80:83], a[240:243], v[96:99]
    ds_read_b128 v[64:67], v224 offset:0
    v_mfma_f32_16x16x32_bf16 v[100:103], v[84:87], a[240:243], v[100:103]
    ds_read_b128 v[68:71], v224 offset:2048
    s_add_u32 s38, s36, 36864
    buffer_store_dwordx4 v[44:47], v240, s[16:19], s38 offen offset:256 sc1
    v_mfma_f32_16x16x32_bf16 v[104:107], v[80:83], a[244:247], v[104:107]
    ds_read_b128 v[72:75], v224 offset:4096
    v_mfma_f32_16x16x32_bf16 v[108:111], v[84:87], a[244:247], v[108:111]
    ds_read_b128 v[76:79], v224 offset:6144
    v_mfma_f32_16x16x32_bf16 v[112:115], v[80:83], a[248:251], v[112:115]
    v_mfma_f32_16x16x32_bf16 v[116:119], v[84:87], a[248:251], v[116:119]
    v_mfma_f32_16x16x32_bf16 v[120:123], v[80:83], a[252:255], v[120:123]
    v_mfma_f32_16x16x32_bf16 v[124:127], v[84:87], a[252:255], v[124:127]
    v_mfma_f32_16x16x32_bf16 v[128:131], v[88:91], a[240:243], v[128:131]
    s_add_u32 m0, s34, 49152
    s_add_u32 s37, s86, 196608
    buffer_load_dwordx4 v232, s[44:47], s37 offen lds
    v_mfma_f32_16x16x32_bf16 v[132:135], v[92:95], a[240:243], v[132:135]
    v_mfma_f32_16x16x32_bf16 v[136:139], v[88:91], a[244:247], v[136:139]
    buffer_load_dwordx4 v233, s[44:47], s37 offen offset:1024 lds
    v_mfma_f32_16x16x32_bf16 v[140:143], v[92:95], a[244:247], v[140:143]
    v_mfma_f32_16x16x32_bf16 v[144:147], v[88:91], a[248:251], v[144:147]
    v_mfma_f32_16x16x32_bf16 v[148:151], v[92:95], a[248:251], v[148:151]
    s_add_u32 m0, s31, 1024
    s_add_u32 s24, s27, 32768
    buffer_load_dwordx4 v245, s[12:15], s24 offen lds
    v_mfma_f32_16x16x32_bf16 v[152:155], v[88:91], a[252:255], v[152:155]
    v_mfma_f32_16x16x32_bf16 v[156:159], v[92:95], a[252:255], v[156:159]
    s_waitcnt lgkmcnt(0)
    v_mfma_f32_16x16x32_bf16 v[160:163], v[64:67], a[0:3], 0
    ds_read_b128 v[80:83], v225 offset:0
    v_mfma_f32_16x16x32_bf16 v[164:167], v[68:71], a[0:3], 0
    ds_read_b128 v[84:87], v225 offset:2048
    v_mfma_f32_16x16x32_bf16 v[168:171], v[64:67], a[4:7], 0
    ds_read_b128 v[88:91], v225 offset:4096
    v_mfma_f32_16x16x32_bf16 v[172:175], v[68:71], a[4:7], 0
    ds_read_b128 v[92:95], v225 offset:6144
    v_mfma_f32_16x16x32_bf16 v[176:179], v[64:67], a[8:11], 0
    v_cvt_pk_bf16_f32 v0, v96, v97
    v_cvt_pk_bf16_f32 v1, v98, v99
    v_mfma_f32_16x16x32_bf16 v[180:183], v[68:71], a[8:11], 0
    v_mfma_f32_16x16x32_bf16 v[184:187], v[64:67], a[12:15], 0
    v_cvt_pk_bf16_f32 v2, v100, v101
    v_cvt_pk_bf16_f32 v3, v102, v103
    s_add_u32 s38, s36, 40960
    buffer_store_dwordx4 v[48:51], v240, s[16:19], s38 offen offset:1280 sc1
    v_mfma_f32_16x16x32_bf16 v[188:191], v[68:71], a[12:15], 0
    v_mfma_f32_16x16x32_bf16 v[192:195], v[72:75], a[0:3], 0
    s_add_u32 m0, s31, 2048
    s_add_u32 s24, s27, 65536
    buffer_load_dwordx4 v237, s[12:15], s24 offen lds
    v_cvt_pk_bf16_f32 v4, v104, v105
    v_cvt_pk_bf16_f32 v5, v106, v107
    v_mfma_f32_16x16x32_bf16 v[196:199], v[76:79], a[0:3], 0
    v_mfma_f32_16x16x32_bf16 v[200:203], v[72:75], a[4:7], 0
    v_cvt_pk_bf16_f32 v6, v108, v109
    v_cvt_pk_bf16_f32 v7, v110, v111
    v_mfma_f32_16x16x32_bf16 v[204:207], v[76:79], a[4:7], 0
    v_mfma_f32_16x16x32_bf16 v[208:211], v[72:75], a[8:11], 0
    v_cvt_pk_bf16_f32 v8, v112, v113
    v_cvt_pk_bf16_f32 v9, v114, v115
    v_mfma_f32_16x16x32_bf16 v[212:215], v[76:79], a[8:11], 0
    v_mfma_f32_16x16x32_bf16 v[216:219], v[72:75], a[12:15], 0
    v_cvt_pk_bf16_f32 v10, v116, v117
    v_cvt_pk_bf16_f32 v11, v118, v119
    v_mfma_f32_16x16x32_bf16 v[220:223], v[76:79], a[12:15], 0
    s_waitcnt lgkmcnt(0)
    v_mfma_f32_16x16x32_bf16 v[160:163], v[80:83], a[16:19], v[160:163]
    ds_read_b128 v[64:67], v224 offset:8192
    v_cvt_pk_bf16_f32 v12, v120, v121
    v_cvt_pk_bf16_f32 v13, v122, v123
    v_mfma_f32_16x16x32_bf16 v[164:167], v[84:87], a[16:19], v[164:167]
    ds_read_b128 v[68:71], v224 offset:10240
    v_mfma_f32_16x16x32_bf16 v[168:171], v[80:83], a[20:23], v[168:171]
    ds_read_b128 v[72:75], v224 offset:12288
    v_cvt_pk_bf16_f32 v14, v124, v125
    v_cvt_pk_bf16_f32 v15, v126, v127
    v_mfma_f32_16x16x32_bf16 v[172:175], v[84:87], a[20:23], v[172:175]
    ds_read_b128 v[76:79], v224 offset:14336
    v_mfma_f32_16x16x32_bf16 v[176:179], v[80:83], a[24:27], v[176:179]
    v_cvt_pk_bf16_f32 v16, v128, v129
    v_cvt_pk_bf16_f32 v17, v130, v131
    v_mfma_f32_16x16x32_bf16 v[180:183], v[84:87], a[24:27], v[180:183]
    v_mfma_f32_16x16x32_bf16 v[184:187], v[80:83], a[28:31], v[184:187]
    v_cvt_pk_bf16_f32 v18, v132, v133
    v_cvt_pk_bf16_f32 v19, v134, v135
    v_mfma_f32_16x16x32_bf16 v[188:191], v[84:87], a[28:31], v[188:191]
    v_mfma_f32_16x16x32_bf16 v[192:195], v[88:91], a[16:19], v[192:195]
    s_add_u32 m0, s34, 57344
    s_add_u32 s37, s87, 196608
    buffer_load_dwordx4 v232, s[44:47], s37 offen lds
    v_cvt_pk_bf16_f32 v20, v136, v137
    v_cvt_pk_bf16_f32 v21, v138, v139
    v_mfma_f32_16x16x32_bf16 v[196:199], v[92:95], a[16:19], v[196:199]
    v_mfma_f32_16x16x32_bf16 v[200:203], v[88:91], a[20:23], v[200:203]
    buffer_load_dwordx4 v233, s[44:47], s37 offen offset:1024 lds
    v_cvt_pk_bf16_f32 v22, v140, v141
    v_cvt_pk_bf16_f32 v23, v142, v143
    v_mfma_f32_16x16x32_bf16 v[204:207], v[92:95], a[20:23], v[204:207]
    v_mfma_f32_16x16x32_bf16 v[208:211], v[88:91], a[24:27], v[208:211]
    v_cvt_pk_bf16_f32 v24, v144, v145
    v_cvt_pk_bf16_f32 v25, v146, v147
    s_add_u32 s38, s36, 40960
    buffer_store_dwordx4 v[52:55], v240, s[16:19], s38 offen offset:2304 sc1
    v_mfma_f32_16x16x32_bf16 v[212:215], v[92:95], a[24:27], v[212:215]
    s_add_u32 m0, s31, 3072
    s_add_u32 s24, s27, 98304
    buffer_load_dwordx4 v237, s[12:15], s24 offen lds
    v_mfma_f32_16x16x32_bf16 v[216:219], v[88:91], a[28:31], v[216:219]
    v_cvt_pk_bf16_f32 v26, v148, v149
    v_cvt_pk_bf16_f32 v27, v150, v151
    v_mfma_f32_16x16x32_bf16 v[220:223], v[92:95], a[28:31], v[220:223]
    s_waitcnt lgkmcnt(0)
    v_mfma_f32_16x16x32_bf16 v[160:163], v[64:67], a[32:35], v[160:163]
    ds_read_b128 v[80:83], v225 offset:8192
    v_cvt_pk_bf16_f32 v28, v152, v153
    v_cvt_pk_bf16_f32 v29, v154, v155
    v_mfma_f32_16x16x32_bf16 v[164:167], v[68:71], a[32:35], v[164:167]
    ds_read_b128 v[84:87], v225 offset:10240
    v_mfma_f32_16x16x32_bf16 v[168:171], v[64:67], a[36:39], v[168:171]
    ds_read_b128 v[88:91], v225 offset:12288
    v_cvt_pk_bf16_f32 v30, v156, v157
    v_cvt_pk_bf16_f32 v31, v158, v159
    v_mfma_f32_16x16x32_bf16 v[172:175], v[68:71], a[36:39], v[172:175]
    ds_read_b128 v[92:95], v225 offset:14336
    v_mfma_f32_16x16x32_bf16 v[176:179], v[64:67], a[40:43], v[176:179]
    v_mfma_f32_16x16x32_bf16 v[180:183], v[68:71], a[40:43], v[180:183]
    v_mfma_f32_16x16x32_bf16 v[184:187], v[64:67], a[44:47], v[184:187]
    v_mfma_f32_16x16x32_bf16 v[188:191], v[68:71], a[44:47], v[188:191]
    v_mfma_f32_16x16x32_bf16 v[192:195], v[72:75], a[32:35], v[192:195]
    s_add_u32 m0, s31, 4096
    s_add_u32 s24, s27, 131072
    buffer_load_dwordx4 v245, s[12:15], s24 offen lds
    v_mfma_f32_16x16x32_bf16 v[196:199], v[76:79], a[32:35], v[196:199]
    v_mfma_f32_16x16x32_bf16 v[200:203], v[72:75], a[36:39], v[200:203]
    v_mfma_f32_16x16x32_bf16 v[204:207], v[76:79], a[36:39], v[204:207]
    v_mfma_f32_16x16x32_bf16 v[208:211], v[72:75], a[40:43], v[208:211]
    v_mfma_f32_16x16x32_bf16 v[212:215], v[76:79], a[40:43], v[212:215]
    v_mfma_f32_16x16x32_bf16 v[216:219], v[72:75], a[44:47], v[216:219]
    v_mfma_f32_16x16x32_bf16 v[220:223], v[76:79], a[44:47], v[220:223]
    s_waitcnt vmcnt(23) lgkmcnt(0)
    s_barrier
    v_mfma_f32_16x16x32_bf16 v[160:163], v[80:83], a[48:51], v[160:163]
    ds_read_b128 v[64:67], v224 offset:16384
    v_mfma_f32_16x16x32_bf16 v[164:167], v[84:87], a[48:51], v[164:167]
    ds_read_b128 v[68:71], v224 offset:18432
    s_add_u32 s38, s36, 40960
    buffer_store_dwordx4 v[56:59], v240, s[16:19], s38 offen offset:3328 sc1
    v_mfma_f32_16x16x32_bf16 v[168:171], v[80:83], a[52:55], v[168:171]
    ds_read_b128 v[72:75], v224 offset:20480
    v_mfma_f32_16x16x32_bf16 v[172:175], v[84:87], a[52:55], v[172:175]
    ds_read_b128 v[76:79], v224 offset:22528
    v_mfma_f32_16x16x32_bf16 v[176:179], v[80:83], a[56:59], v[176:179]
    v_mfma_f32_16x16x32_bf16 v[180:183], v[84:87], a[56:59], v[180:183]
    v_mfma_f32_16x16x32_bf16 v[184:187], v[80:83], a[60:63], v[184:187]
    v_mfma_f32_16x16x32_bf16 v[188:191], v[84:87], a[60:63], v[188:191]
    v_mfma_f32_16x16x32_bf16 v[192:195], v[88:91], a[48:51], v[192:195]
    s_add_u32 m0, s31, 5120
    s_add_u32 s24, s27, 163840
    buffer_load_dwordx4 v245, s[12:15], s24 offen lds
    v_mfma_f32_16x16x32_bf16 v[196:199], v[92:95], a[48:51], v[196:199]
    v_mfma_f32_16x16x32_bf16 v[200:203], v[88:91], a[52:55], v[200:203]
    v_mfma_f32_16x16x32_bf16 v[204:207], v[92:95], a[52:55], v[204:207]
    v_mfma_f32_16x16x32_bf16 v[208:211], v[88:91], a[56:59], v[208:211]
    v_mfma_f32_16x16x32_bf16 v[212:215], v[92:95], a[56:59], v[212:215]
    v_mfma_f32_16x16x32_bf16 v[216:219], v[88:91], a[60:63], v[216:219]
    v_mfma_f32_16x16x32_bf16 v[220:223], v[92:95], a[60:63], v[220:223]
    s_waitcnt lgkmcnt(0)
    v_mfma_f32_16x16x32_bf16 v[160:163], v[64:67], a[64:67], v[160:163]
    ds_read_b128 v[80:83], v225 offset:16384
    v_mfma_f32_16x16x32_bf16 v[164:167], v[68:71], a[64:67], v[164:167]
    ds_read_b128 v[84:87], v225 offset:18432
    v_mfma_f32_16x16x32_bf16 v[168:171], v[64:67], a[68:71], v[168:171]
    ds_read_b128 v[88:91], v225 offset:20480
    v_mfma_f32_16x16x32_bf16 v[172:175], v[68:71], a[68:71], v[172:175]
    ds_read_b128 v[92:95], v225 offset:22528
    v_mfma_f32_16x16x32_bf16 v[176:179], v[64:67], a[72:75], v[176:179]
    v_mfma_f32_16x16x32_bf16 v[180:183], v[68:71], a[72:75], v[180:183]
    v_mfma_f32_16x16x32_bf16 v[184:187], v[64:67], a[76:79], v[184:187]
    v_mfma_f32_16x16x32_bf16 v[188:191], v[68:71], a[76:79], v[188:191]
    s_add_u32 s38, s36, 45056
    buffer_store_dwordx4 v[60:63], v240, s[16:19], s38 offen offset:256 sc1
    v_mfma_f32_16x16x32_bf16 v[192:195], v[72:75], a[64:67], v[192:195]
    s_add_u32 m0, s31, 6144
    s_add_u32 s24, s27, 196608
    buffer_load_dwordx4 v237, s[12:15], s24 offen lds
    v_mfma_f32_16x16x32_bf16 v[196:199], v[76:79], a[64:67], v[196:199]
    v_mfma_f32_16x16x32_bf16 v[200:203], v[72:75], a[68:71], v[200:203]
    v_mfma_f32_16x16x32_bf16 v[204:207], v[76:79], a[68:71], v[204:207]
    v_mfma_f32_16x16x32_bf16 v[208:211], v[72:75], a[72:75], v[208:211]
    v_mfma_f32_16x16x32_bf16 v[212:215], v[76:79], a[72:75], v[212:215]
    v_mfma_f32_16x16x32_bf16 v[216:219], v[72:75], a[76:79], v[216:219]
    v_mfma_f32_16x16x32_bf16 v[220:223], v[76:79], a[76:79], v[220:223]
    s_waitcnt lgkmcnt(0)
    v_mfma_f32_16x16x32_bf16 v[160:163], v[80:83], a[80:83], v[160:163]
    ds_read_b128 v[64:67], v224 offset:24576
    v_mfma_f32_16x16x32_bf16 v[164:167], v[84:87], a[80:83], v[164:167]
    ds_read_b128 v[68:71], v224 offset:26624
    v_mfma_f32_16x16x32_bf16 v[168:171], v[80:83], a[84:87], v[168:171]
    ds_read_b128 v[72:75], v224 offset:28672
    v_mfma_f32_16x16x32_bf16 v[172:175], v[84:87], a[84:87], v[172:175]
    ds_read_b128 v[76:79], v224 offset:30720
    v_mfma_f32_16x16x32_bf16 v[176:179], v[80:83], a[88:91], v[176:179]
    v_mfma_f32_16x16x32_bf16 v[180:183], v[84:87], a[88:91], v[180:183]
    v_mfma_f32_16x16x32_bf16 v[184:187], v[80:83], a[92:95], v[184:187]
    v_mfma_f32_16x16x32_bf16 v[188:191], v[84:87], a[92:95], v[188:191]
    v_mfma_f32_16x16x32_bf16 v[192:195], v[88:91], a[80:83], v[192:195]
    s_add_u32 m0, s31, 7168
    s_add_u32 s24, s27, 229376
    buffer_load_dwordx4 v237, s[12:15], s24 offen lds
    v_mfma_f32_16x16x32_bf16 v[196:199], v[92:95], a[80:83], v[196:199]
    v_mfma_f32_16x16x32_bf16 v[200:203], v[88:91], a[84:87], v[200:203]
    s_add_u32 s27, s27, 1048576
    s_and_b32 s27, s27, 0x407fffff
    s_cmp_eq_u32 s27, s7
    s_cselect_b32 s27, s43, s27
    v_mfma_f32_16x16x32_bf16 v[204:207], v[92:95], a[84:87], v[204:207]
    v_mfma_f32_16x16x32_bf16 v[208:211], v[88:91], a[88:91], v[208:211]
    v_mfma_f32_16x16x32_bf16 v[212:215], v[92:95], a[88:91], v[212:215]
    s_add_u32 s31, s31, 32768
    s_cmp_ge_u32 s31, 163840
    s_cselect_b32 s24, 98304, 0
    s_sub_u32 s31, s31, s24
    s_add_u32 s38, s36, 65536
    buffer_store_dwordx4 v[0:3], v240, s[16:19], s38 offen offset:2560 sc1
    v_mfma_f32_16x16x32_bf16 v[216:219], v[88:91], a[92:95], v[216:219]
    v_mfma_f32_16x16x32_bf16 v[220:223], v[92:95], a[92:95], v[220:223]
    s_waitcnt lgkmcnt(0)
    v_mfma_f32_16x16x32_bf16 v[160:163], v[64:67], a[96:99], v[160:163]
    ds_read_b128 v[80:83], v225 offset:24576
    v_mfma_f32_16x16x32_bf16 v[164:167], v[68:71], a[96:99], v[164:167]
    ds_read_b128 v[84:87], v225 offset:26624
    v_mfma_f32_16x16x32_bf16 v[168:171], v[64:67], a[100:103], v[168:171]
    ds_read_b128 v[88:91], v225 offset:28672
    v_mfma_f32_16x16x32_bf16 v[172:175], v[68:71], a[100:103], v[172:175]
    ds_read_b128 v[92:95], v225 offset:30720
    v_mfma_f32_16x16x32_bf16 v[176:179], v[64:67], a[104:107], v[176:179]
    v_mfma_f32_16x16x32_bf16 v[180:183], v[68:71], a[104:107], v[180:183]
    v_mfma_f32_16x16x32_bf16 v[184:187], v[64:67], a[108:111], v[184:187]
    v_mfma_f32_16x16x32_bf16 v[188:191], v[68:71], a[108:111], v[188:191]
    v_mfma_f32_16x16x32_bf16 v[192:195], v[72:75], a[96:99], v[192:195]
    v_mfma_f32_16x16x32_bf16 v[196:199], v[76:79], a[96:99], v[196:199]
    v_mfma_f32_16x16x32_bf16 v[200:203], v[72:75], a[100:103], v[200:203]
    v_mfma_f32_16x16x32_bf16 v[204:207], v[76:79], a[100:103], v[204:207]
    v_mfma_f32_16x16x32_bf16 v[208:211], v[72:75], a[104:107], v[208:211]
    v_mfma_f32_16x16x32_bf16 v[212:215], v[76:79], a[104:107], v[212:215]
    v_mfma_f32_16x16x32_bf16 v[216:219], v[72:75], a[108:111], v[216:219]
    v_mfma_f32_16x16x32_bf16 v[220:223], v[76:79], a[108:111], v[220:223]
    s_waitcnt vmcnt(9) lgkmcnt(0)
    s_barrier
    v_mfma_f32_16x16x32_bf16 v[160:163], v[80:83], a[112:115], v[160:163]
    ds_read_b128 v[64:67], v224 offset:32768
    v_mfma_f32_16x16x32_bf16 v[164:167], v[84:87], a[112:115], v[164:167]
    ds_read_b128 v[68:71], v224 offset:34816
    v_mfma_f32_16x16x32_bf16 v[168:171], v[80:83], a[116:119], v[168:171]
    ds_read_b128 v[72:75], v224 offset:36864
    s_add_u32 s38, s36, 65536
    buffer_store_dwordx4 v[4:7], v240, s[16:19], s38 offen offset:3584 sc1
    v_mfma_f32_16x16x32_bf16 v[172:175], v[84:87], a[116:119], v[172:175]
    ds_read_b128 v[76:79], v224 offset:38912
    v_mfma_f32_16x16x32_bf16 v[176:179], v[80:83], a[120:123], v[176:179]
    v_mfma_f32_16x16x32_bf16 v[180:183], v[84:87], a[120:123], v[180:183]
    v_mfma_f32_16x16x32_bf16 v[184:187], v[80:83], a[124:127], v[184:187]
    v_mfma_f32_16x16x32_bf16 v[188:191], v[84:87], a[124:127], v[188:191]
    v_mfma_f32_16x16x32_bf16 v[192:195], v[88:91], a[112:115], v[192:195]
    v_mfma_f32_16x16x32_bf16 v[196:199], v[92:95], a[112:115], v[196:199]
    v_mfma_f32_16x16x32_bf16 v[200:203], v[88:91], a[116:119], v[200:203]
    v_mfma_f32_16x16x32_bf16 v[204:207], v[92:95], a[116:119], v[204:207]
    v_mfma_f32_16x16x32_bf16 v[208:211], v[88:91], a[120:123], v[208:211]
    v_mfma_f32_16x16x32_bf16 v[212:215], v[92:95], a[120:123], v[212:215]
    v_mfma_f32_16x16x32_bf16 v[216:219], v[88:91], a[124:127], v[216:219]
    v_mfma_f32_16x16x32_bf16 v[220:223], v[92:95], a[124:127], v[220:223]
    s_waitcnt lgkmcnt(0)
    v_mfma_f32_16x16x32_bf16 v[160:163], v[64:67], a[128:131], v[160:163]
    ds_read_b128 v[80:83], v225 offset:32768
    v_mfma_f32_16x16x32_bf16 v[164:167], v[68:71], a[128:131], v[164:167]
    ds_read_b128 v[84:87], v225 offset:34816
    v_mfma_f32_16x16x32_bf16 v[168:171], v[64:67], a[132:135], v[168:171]
    ds_read_b128 v[88:91], v225 offset:36864
    v_mfma_f32_16x16x32_bf16 v[172:175], v[68:71], a[132:135], v[172:175]
    ds_read_b128 v[92:95], v225 offset:38912
    v_mfma_f32_16x16x32_bf16 v[176:179], v[64:67], a[136:139], v[176:179]
    v_mfma_f32_16x16x32_bf16 v[180:183], v[68:71], a[136:139], v[180:183]
    v_mfma_f32_16x16x32_bf16 v[184:187], v[64:67], a[140:143], v[184:187]
    v_mfma_f32_16x16x32_bf16 v[188:191], v[68:71], a[140:143], v[188:191]
    v_mfma_f32_16x16x32_bf16 v[192:195], v[72:75], a[128:131], v[192:195]
    buffer_load_dword v254, off, s[88:91], s39 sc1
    s_add_u32 s38, s36, 69632
    buffer_store_dwordx4 v[8:11], v240, s[16:19], s38 offen offset:512 sc1
    v_mfma_f32_16x16x32_bf16 v[196:199], v[76:79], a[128:131], v[196:199]
    v_mfma_f32_16x16x32_bf16 v[200:203], v[72:75], a[132:135], v[200:203]
    v_mfma_f32_16x16x32_bf16 v[204:207], v[76:79], a[132:135], v[204:207]
    v_mfma_f32_16x16x32_bf16 v[208:211], v[72:75], a[136:139], v[208:211]
    v_mfma_f32_16x16x32_bf16 v[212:215], v[76:79], a[136:139], v[212:215]
    v_mfma_f32_16x16x32_bf16 v[216:219], v[72:75], a[140:143], v[216:219]
    v_mfma_f32_16x16x32_bf16 v[220:223], v[76:79], a[140:143], v[220:223]
    s_waitcnt lgkmcnt(0)
    v_mfma_f32_16x16x32_bf16 v[160:163], v[80:83], a[144:147], v[160:163]
    ds_read_b128 v[64:67], v224 offset:40960
    v_mfma_f32_16x16x32_bf16 v[164:167], v[84:87], a[144:147], v[164:167]
    ds_read_b128 v[68:71], v224 offset:43008
    v_mfma_f32_16x16x32_bf16 v[168:171], v[80:83], a[148:151], v[168:171]
    ds_read_b128 v[72:75], v224 offset:45056
    v_mfma_f32_16x16x32_bf16 v[172:175], v[84:87], a[148:151], v[172:175]
    ds_read_b128 v[76:79], v224 offset:47104
    v_mfma_f32_16x16x32_bf16 v[176:179], v[80:83], a[152:155], v[176:179]
    v_mfma_f32_16x16x32_bf16 v[180:183], v[84:87], a[152:155], v[180:183]
    v_mfma_f32_16x16x32_bf16 v[184:187], v[80:83], a[156:159], v[184:187]
    v_mfma_f32_16x16x32_bf16 v[188:191], v[84:87], a[156:159], v[188:191]
    v_mfma_f32_16x16x32_bf16 v[192:195], v[88:91], a[144:147], v[192:195]
    v_mfma_f32_16x16x32_bf16 v[196:199], v[92:95], a[144:147], v[196:199]
    v_mfma_f32_16x16x32_bf16 v[200:203], v[88:91], a[148:151], v[200:203]
    v_mfma_f32_16x16x32_bf16 v[204:207], v[92:95], a[148:151], v[204:207]
    v_mfma_f32_16x16x32_bf16 v[208:211], v[88:91], a[152:155], v[208:211]
    v_mfma_f32_16x16x32_bf16 v[212:215], v[92:95], a[152:155], v[212:215]
    s_add_u32 s38, s36, 69632
    buffer_store_dwordx4 v[12:15], v240, s[16:19], s38 offen offset:1536 sc1
    v_mfma_f32_16x16x32_bf16 v[216:219], v[88:91], a[156:159], v[216:219]
    v_mfma_f32_16x16x32_bf16 v[220:223], v[92:95], a[156:159], v[220:223]
    s_waitcnt lgkmcnt(0)
    v_mfma_f32_16x16x32_bf16 v[160:163], v[64:67], a[160:163], v[160:163]
    ds_read_b128 v[80:83], v225 offset:40960
    v_mfma_f32_16x16x32_bf16 v[164:167], v[68:71], a[160:163], v[164:167]
    ds_read_b128 v[84:87], v225 offset:43008
    v_mfma_f32_16x16x32_bf16 v[168:171], v[64:67], a[164:167], v[168:171]
    ds_read_b128 v[88:91], v225 offset:45056
    v_mfma_f32_16x16x32_bf16 v[172:175], v[68:71], a[164:167], v[172:175]
    ds_read_b128 v[92:95], v225 offset:47104
    v_mfma_f32_16x16x32_bf16 v[176:179], v[64:67], a[168:171], v[176:179]
    v_mfma_f32_16x16x32_bf16 v[180:183], v[68:71], a[168:171], v[180:183]
    v_mfma_f32_16x16x32_bf16 v[184:187], v[64:67], a[172:175], v[184:187]
    v_mfma_f32_16x16x32_bf16 v[188:191], v[68:71], a[172:175], v[188:191]
    v_mfma_f32_16x16x32_bf16 v[192:195], v[72:75], a[160:163], v[192:195]
    v_mfma_f32_16x16x32_bf16 v[196:199], v[76:79], a[160:163], v[196:199]
    v_mfma_f32_16x16x32_bf16 v[200:203], v[72:75], a[164:167], v[200:203]
    v_mfma_f32_16x16x32_bf16 v[204:207], v[76:79], a[164:167], v[204:207]
    v_mfma_f32_16x16x32_bf16 v[208:211], v[72:75], a[168:171], v[208:211]
    v_mfma_f32_16x16x32_bf16 v[212:215], v[76:79], a[168:171], v[212:215]
    v_mfma_f32_16x16x32_bf16 v[216:219], v[72:75], a[172:175], v[216:219]
    v_mfma_f32_16x16x32_bf16 v[220:223], v[76:79], a[172:175], v[220:223]
    s_waitcnt lgkmcnt(0)
    v_mfma_f32_16x16x32_bf16 v[160:163], v[80:83], a[176:179], v[160:163]
    ds_read_b128 v[64:67], v224 offset:49152
    v_mfma_f32_16x16x32_bf16 v[164:167], v[84:87], a[176:179], v[164:167]
    ds_read_b128 v[68:71], v224 offset:51200
    v_mfma_f32_16x16x32_bf16 v[168:171], v[80:83], a[180:183], v[168:171]
    ds_read_b128 v[72:75], v224 offset:53248
    v_mfma_f32_16x16x32_bf16 v[172:175], v[84:87], a[180:183], v[172:175]
    ds_read_b128 v[76:79], v224 offset:55296
    s_add_u32 s38, s36, 73728
    buffer_store_dwordx4 v[16:19], v240, s[16:19], s38 offen offset:2560 sc1
    v_mfma_f32_16x16x32_bf16 v[176:179], v[80:83], a[184:187], v[176:179]
    v_mfma_f32_16x16x32_bf16 v[180:183], v[84:87], a[184:187], v[180:183]
    v_mfma_f32_16x16x32_bf16 v[184:187], v[80:83], a[188:191], v[184:187]
    v_mfma_f32_16x16x32_bf16 v[188:191], v[84:87], a[188:191], v[188:191]
    v_mfma_f32_16x16x32_bf16 v[192:195], v[88:91], a[176:179], v[192:195]
    v_mfma_f32_16x16x32_bf16 v[196:199], v[92:95], a[176:179], v[196:199]
    v_mfma_f32_16x16x32_bf16 v[200:203], v[88:91], a[180:183], v[200:203]
    v_mfma_f32_16x16x32_bf16 v[204:207], v[92:95], a[180:183], v[204:207]
    v_mfma_f32_16x16x32_bf16 v[208:211], v[88:91], a[184:187], v[208:211]
    v_mfma_f32_16x16x32_bf16 v[212:215], v[92:95], a[184:187], v[212:215]
    v_mfma_f32_16x16x32_bf16 v[216:219], v[88:91], a[188:191], v[216:219]
    v_mfma_f32_16x16x32_bf16 v[220:223], v[92:95], a[188:191], v[220:223]
    s_waitcnt vmcnt(3)
    v_readfirstlane_b32 s24, v254
    s_lshl_b32 s25, s3, 16
    s_add_u32 s24, s24, s25
    s_cmp_ge_u32 s24, 32
    s_cbranch_scc0 kf_spin37
kf_spinr38:
    s_waitcnt lgkmcnt(0)
    s_barrier
    v_mfma_f32_16x16x32_bf16 v[160:163], v[64:67], a[192:195], v[160:163]
    ds_read_b128 v[80:83], v225 offset:49152
    v_mfma_f32_16x16x32_bf16 v[164:167], v[68:71], a[192:195], v[164:167]
    ds_read_b128 v[84:87], v225 offset:51200
    v_mfma_f32_16x16x32_bf16 v[168:171], v[64:67], a[196:199], v[168:171]
    ds_read_b128 v[88:91], v225 offset:53248
    v_mfma_f32_16x16x32_bf16 v[172:175], v[68:71], a[196:199], v[172:175]
    ds_read_b128 v[92:95], v225 offset:55296
    v_mfma_f32_16x16x32_bf16 v[176:179], v[64:67], a[200:203], v[176:179]
    v_mfma_f32_16x16x32_bf16 v[180:183], v[68:71], a[200:203], v[180:183]
    v_mfma_f32_16x16x32_bf16 v[184:187], v[64:67], a[204:207], v[184:187]
    v_mfma_f32_16x16x32_bf16 v[188:191], v[68:71], a[204:207], v[188:191]
    v_mfma_f32_16x16x32_bf16 v[192:195], v[72:75], a[192:195], v[192:195]
    buffer_load_dwordx4 a[128:131], v248, s[8:11], s28 offen offset:0 sc1
    s_add_u32 s38, s36, 73728
    buffer_store_dwordx4 v[20:23], v240, s[16:19], s38 offen offset:3584 sc1
    v_mfma_f32_16x16x32_bf16 v[196:199], v[76:79], a[192:195], v[196:199]
    v_mfma_f32_16x16x32_bf16 v[200:203], v[72:75], a[196:199], v[200:203]
    buffer_load_dwordx4 a[132:135], v248, s[8:11], s29 offen offset:0 sc1
    v_mfma_f32_16x16x32_bf16 v[204:207], v[76:79], a[196:199], v[204:207]
    v_mfma_f32_16x16x32_bf16 v[208:211], v[72:75], a[200:203], v[208:211]
    v_mfma_f32_16x16x32_bf16 v[212:215], v[76:79], a[200:203], v[212:215]
    buffer_load_dwordx4 a[136:139], v249, s[8:11], s28 offen offset:0 sc1
    v_mfma_f32_16x16x32_bf16 v[216:219], v[72:75], a[204:207], v[216:219]
    v_mfma_f32_16x16x32_bf16 v[220:223], v[76:79], a[204:207], v[220:223]
    s_waitcnt lgkmcnt(0)
    v_mfma_f32_16x16x32_bf16 v[160:163], v[80:83], a[208:211], v[160:163]
    ds_read_b128 v[64:67], v224 offset:57344
    v_mfma_f32_16x16x32_bf16 v[164:167], v[84:87], a[208:211], v[164:167]
    ds_read_b128 v[68:71], v224 offset:59392
    v_mfma_f32_16x16x32_bf16 v[168:171], v[80:83], a[212:215], v[168:171]
    ds_read_b128 v[72:75], v224 offset:61440
    v_mfma_f32_16x16x32_bf16 v[172:175], v[84:87], a[212:215], v[172:175]
    ds_read_b128 v[76:79], v224 offset:63488
    v_mfma_f32_16x16x32_bf16 v[176:179], v[80:83], a[216:219], v[176:179]
    v_mfma_f32_16x16x32_bf16 v[180:183], v[84:87], a[216:219], v[180:183]
    v_mfma_f32_16x16x32_bf16 v[184:187], v[80:83], a[220:223], v[184:187]
    v_mfma_f32_16x16x32_bf16 v[188:191], v[84:87], a[220:223], v[188:191]
    v_mfma_f32_16x16x32_bf16 v[192:195], v[88:91], a[208:211], v[192:195]
    buffer_load_dwordx4 a[140:143], v249, s[8:11], s29 offen offset:0 sc1
    v_mfma_f32_16x16x32_bf16 v[196:199], v[92:95], a[208:211], v[196:199]
    v_mfma_f32_16x16x32_bf16 v[200:203], v[88:91], a[212:215], v[200:203]
    buffer_load_dwordx4 a[144:147], v248, s[8:11], s28 offen offset:1024 sc1
    v_mfma_f32_16x16x32_bf16 v[204:207], v[92:95], a[212:215], v[204:207]
    v_mfma_f32_16x16x32_bf16 v[208:211], v[88:91], a[216:219], v[208:211]
    v_mfma_f32_16x16x32_bf16 v[212:215], v[92:95], a[216:219], v[212:215]
    buffer_load_dwordx4 a[148:151], v248, s[8:11], s29 offen offset:1024 sc1
    v_mfma_f32_16x16x32_bf16 v[216:219], v[88:91], a[220:223], v[216:219]
    s_add_u32 s38, s36, 77824
    buffer_store_dwordx4 v[24:27], v240, s[16:19], s38 offen offset:512 sc1
    v_mfma_f32_16x16x32_bf16 v[220:223], v[92:95], a[220:223], v[220:223]
    s_waitcnt lgkmcnt(0)
    v_mfma_f32_16x16x32_bf16 v[160:163], v[64:67], a[224:227], v[160:163]
    ds_read_b128 v[80:83], v225 offset:57344
    v_mfma_f32_16x16x32_bf16 v[164:167], v[68:71], a[224:227], v[164:167]
    ds_read_b128 v[84:87], v225 offset:59392
    v_mfma_f32_16x16x32_bf16 v[168:171], v[64:67], a[228:231], v[168:171]
    ds_read_b128 v[88:91], v225 offset:61440
    v_mfma_f32_16x16x32_bf16 v[172:175], v[68:71], a[228:231], v[172:175]
    ds_read_b128 v[92:95], v225 offset:63488
    v_mfma_f32_16x16x32_bf16 v[176:179], v[64:67], a[232:235], v[176:179]
    v_mfma_f32_16x16x32_bf16 v[180:183], v[68:71], a[232:235], v[180:183]
    v_mfma_f32_16x16x32_bf16 v[184:187], v[64:67], a[236:239], v[184:187]
    v_mfma_f32_16x16x32_bf16 v[188:191], v[68:71], a[236:239], v[188:191]
    v_mfma_f32_16x16x32_bf16 v[192:195], v[72:75], a[224:227], v[192:195]
    buffer_load_dwordx4 a[152:155], v249, s[8:11], s28 offen offset:1024 sc1
    v_mfma_f32_16x16x32_bf16 v[196:199], v[76:79], a[224:227], v[196:199]
    v_mfma_f32_16x16x32_bf16 v[200:203], v[72:75], a[228:231], v[200:203]
    buffer_load_dwordx4 a[156:159], v249, s[8:11], s29 offen offset:1024 sc1
    v_mfma_f32_16x16x32_bf16 v[204:207], v[76:79], a[228:231], v[204:207]
    v_mfma_f32_16x16x32_bf16 v[208:211], v[72:75], a[232:235], v[208:211]
    v_mfma_f32_16x16x32_bf16 v[212:215], v[76:79], a[232:235], v[212:215]
    buffer_load_dwordx4 a[160:163], v248, s[8:11], s28 offen offset:2048 sc1
    v_mfma_f32_16x16x32_bf16 v[216:219], v[72:75], a[236:239], v[216:219]
    v_mfma_f32_16x16x32_bf16 v[220:223], v[76:79], a[236:239], v[220:223]
    s_waitcnt vmcnt(38) lgkmcnt(0)
    s_barrier
    v_mfma_f32_16x16x32_bf16 v[160:163], v[80:83], a[240:243], v[160:163]
    ds_read_b64_tr_b16 a[192:193], v246 offset:0
    v_mfma_f32_16x16x32_bf16 v[164:167], v[84:87], a[240:243], v[164:167]
    ds_read_b64_tr_b16 a[194:195], v246 offset:1024
    v_mfma_f32_16x16x32_bf16 v[168:171], v[80:83], a[244:247], v[168:171]
    ds_read_b64_tr_b16 a[196:197], v238 offset:0
    v_mfma_f32_16x16x32_bf16 v[172:175], v[84:87], a[244:247], v[172:175]
    ds_read_b64_tr_b16 a[198:199], v238 offset:1024
    v_mfma_f32_16x16x32_bf16 v[176:179], v[80:83], a[248:251], v[176:179]
    ds_read_b64_tr_b16 a[200:201], v246 offset:256
    s_add_u32 s38, s36, 77824
    buffer_store_dwordx4 v[28:31], v240, s[16:19], s38 offen offset:1536 sc1
    v_mfma_f32_16x16x32_bf16 v[180:183], v[84:87], a[248:251], v[180:183]
    ds_read_b64_tr_b16 a[202:203], v246 offset:1280
    v_mfma_f32_16x16x32_bf16 v[184:187], v[80:83], a[252:255], v[184:187]
    ds_read_b64_tr_b16 a[204:205], v238 offset:256
    v_mfma_f32_16x16x32_bf16 v[188:191], v[84:87], a[252:255], v[188:191]
    ds_read_b64_tr_b16 a[206:207], v238 offset:1280
    v_mfma_f32_16x16x32_bf16 v[192:195], v[88:91], a[240:243], v[192:195]
    buffer_load_dwordx4 a[164:167], v248, s[8:11], s29 offen offset:2048 sc1
    v_mfma_f32_16x16x32_bf16 v[196:199], v[92:95], a[240:243], v[196:199]
    v_cvt_pk_bf16_f32 v32, v160, v161
    v_cvt_pk_bf16_f32 v33, v162, v163
    v_mfma_f32_16x16x32_bf16 v[200:203], v[88:91], a[244:247], v[200:203]
    buffer_load_dwordx4 a[168:171], v249, s[8:11], s28 offen offset:2048 sc1
    v_cvt_pk_bf16_f32 v34, v164, v165
    v_cvt_pk_bf16_f32 v35, v166, v167
    v_mfma_f32_16x16x32_bf16 v[204:207], v[92:95], a[244:247], v[204:207]
    v_cvt_pk_bf16_f32 v36, v168, v169
    v_cvt_pk_bf16_f32 v37, v170, v171
    v_mfma_f32_16x16x32_bf16 v[208:211], v[88:91], a[248:251], v[208:211]
    v_cvt_pk_bf16_f32 v38, v172, v173
    v_cvt_pk_bf16_f32 v39, v174, v175
    v_mfma_f32_16x16x32_bf16 v[212:215], v[92:95], a[248:251], v[212:215]
    buffer_load_dwordx4 a[172:175], v249, s[8:11], s29 offen offset:2048 sc1
    v_cvt_pk_bf16_f32 v40, v176, v177
    v_cvt_pk_bf16_f32 v41, v178, v179
    v_mfma_f32_16x16x32_bf16 v[216:219], v[88:91], a[252:255], v[216:219]
    v_cvt_pk_bf16_f32 v42, v180, v181
    v_cvt_pk_bf16_f32 v43, v182, v183
    v_mfma_f32_16x16x32_bf16 v[220:223], v[92:95], a[252:255], v[220:223]
    v_cvt_pk_bf16_f32 v44, v184, v185
    v_cvt_pk_bf16_f32 v45, v186, v187
    s_nop 3
    v_cvt_pk_bf16_f32 v46, v188, v189
    v_cvt_pk_bf16_f32 v47, v190, v191
    v_cvt_pk_bf16_f32 v48, v192, v193
    v_cvt_pk_bf16_f32 v49, v194, v195
    v_cvt_pk_bf16_f32 v50, v196, v197
    v_cvt_pk_bf16_f32 v51, v198, v199
    v_cvt_pk_bf16_f32 v52, v200, v201
    v_cvt_pk_bf16_f32 v53, v202, v203
    v_cvt_pk_bf16_f32 v54, v204, v205
    v_cvt_pk_bf16_f32 v55, v206, v207
    v_cvt_pk_bf16_f32 v56, v208, v209
    v_cvt_pk_bf16_f32 v57, v210, v211
    v_cvt_pk_bf16_f32 v58, v212, v213
    v_cvt_pk_bf16_f32 v59, v214, v215
    v_cvt_pk_bf16_f32 v60, v216, v217
    v_cvt_pk_bf16_f32 v61, v218, v219
    v_cvt_pk_bf16_f32 v62, v220, v221
    v_cvt_pk_bf16_f32 v63, v222, v223
    s_add_u32 s80, s36, 102144
    s_add_u32 s81, s36, 103168
    s_add_u32 s82, s36, 104192
    s_add_u32 s83, s36, 105216
    s_add_u32 s84, s36, 110336
    s_add_u32 s85, s36, 111360
    s_add_u32 s86, s36, 112384
    s_add_u32 s87, s36, 113408
ka_Q:
    s_waitcnt vmcnt(10) lgkmcnt(0)
    v_mfma_f32_16x16x32_bf16 v[96:99], a[192:195], a[128:131], 0
    ds_read_b64_tr_b16 a[208:209], v246 offset:512
    s_lshl_b32 s97, s4, 7
    v_mfma_f32_16x16x32_bf16 v[100:103], a[192:195], a[132:135], 0
    ds_read_b64_tr_b16 a[210:211], v246 offset:1536
    s_add_u32 s97, s97, 12288
    s_cmp_eq_u32 s3, 0
    s_cselect_b32 s35, s97, s43
    v_mfma_f32_16x16x32_bf16 v[104:107], a[192:195], a[136:139], 0
    ds_read_b64_tr_b16 a[212:213], v238 offset:512
    s_lshl_b32 s37, s3, 12
    v_mfma_f32_16x16x32_bf16 v[108:111], a[192:195], a[140:143], 0
    ds_read_b64_tr_b16 a[214:215], v238 offset:1536
    s_mov_b32 s34, s37
    s_mul_i32 s32, s4, 1089536
    v_mfma_f32_16x16x32_bf16 v[112:115], a[196:199], a[128:131], 0
    ds_read_b64_tr_b16 a[216:217], v246 offset:768
    s_mov_b32 s33, 0
    v_mfma_f32_16x16x32_bf16 v[116:119], a[196:199], a[132:135], 0
    ds_read_b64_tr_b16 a[218:219], v246 offset:1792
    s_lshl_b32 s39, s6, 18
    v_mfma_f32_16x16x32_bf16 v[120:123], a[196:199], a[136:139], 0
    ds_read_b64_tr_b16 a[220:221], v238 offset:768
    s_sub_u32 s25, 63, s6
    s_lshl_b32 s40, s25, 18
    v_mfma_f32_16x16x32_bf16 v[124:127], a[196:199], a[140:143], 0
    ds_read_b64_tr_b16 a[222:223], v238 offset:1792
    s_lshl_b32 s25, s4, 12
    v_mfma_f32_16x16x32_bf16 v[128:131], a[200:203], a[128:131], 0
    buffer_load_dwordx4 a[176:179], v248, s[8:11], s28 offen offset:3072 sc1
    s_add_u32 s39, s39, s25
    s_add_u32 s40, s40, s25
    v_mfma_f32_16x16x32_bf16 v[132:135], a[200:203], a[132:135], 0
    s_mov_b32 s38, 0x47800000
    s_mov_b32 s36, s6
    v_mfma_f32_16x16x32_bf16 v[136:139], a[200:203], a[136:139], 0
    buffer_load_dwordx4 a[180:183], v248, s[8:11], s29 offen offset:3072 sc1
    s_mov_b32 s26, 6
    v_mfma_f32_16x16x32_bf16 v[140:143], a[200:203], a[140:143], 0
    s_add_u32 m0, s31, 0
    s_add_u32 s24, s27, 0
    s_mov_b32 s52, s41
    v_mfma_f32_16x16x32_bf16 v[144:147], a[204:207], a[128:131], 0
    buffer_load_dwordx4 v245, s[12:15], s24 offen lds
    s_mov_b32 s53, s42
    v_mfma_f32_16x16x32_bf16 v[148:151], a[204:207], a[132:135], 0
    s_mov_b32 s54, 0x700000
    s_add_u32 s48, s20, 0x1c00000
    s_addc_u32 s49, s21, 0
    v_mfma_f32_16x16x32_bf16 v[152:155], a[204:207], a[136:139], 0
    buffer_store_dwordx4 v[32:35], v240, s[16:19], s80 offen sc1
    s_mov_b32 s50, 0x1c00000
    s_and_b32 s25, s3, 1
    v_mfma_f32_16x16x32_bf16 v[156:159], a[204:207], a[140:143], 0
    s_lshl1_add_u32 s47, s4, s25
    s_waitcnt lgkmcnt(0)
    v_mfma_f32_16x16x32_bf16 v[160:163], a[208:211], a[128:131], 0
    ds_read_b64_tr_b16 a[192:193], v246 offset:8192
    s_lshr_b32 s101, s3, 1
    v_mfma_f32_16x16x32_bf16 v[164:167], a[208:211], a[132:135], 0
    ds_read_b64_tr_b16 a[194:195], v246 offset:9216
    s_add_u32 s45, s5, s101
    s_sub_u32 s45, s45, 1
    v_mfma_f32_16x16x32_bf16 v[168:171], a[208:211], a[136:139], 0
    ds_read_b64_tr_b16 a[196:197], v238 offset:8192
    s_mul_i32 s45, s45, s5
    v_mfma_f32_16x16x32_bf16 v[172:175], a[208:211], a[140:143], 0
    ds_read_b64_tr_b16 a[198:199], v238 offset:9216
    s_lshl_b32 s100, s101, 14
    s_add_u32 s100, s100, 114688
    v_mfma_f32_16x16x32_bf16 v[176:179], a[212:215], a[128:131], 0
    ds_read_b64_tr_b16 a[200:201], v246 offset:8448
    s_mul_i32 s100, s100, s47
    v_mfma_f32_16x16x32_bf16 v[180:183], a[212:215], a[132:135], 0
    ds_read_b64_tr_b16 a[202:203], v246 offset:9472
    s_lshl_b32 s25, s45, 11
    v_mfma_f32_16x16x32_bf16 v[184:187], a[212:215], a[136:139], 0
    ds_read_b64_tr_b16 a[204:205], v238 offset:8448
    s_add_u32 s100, s100, s25
    s_lshl_b32 s46, s47, 9
    v_mfma_f32_16x16x32_bf16 v[188:191], a[212:215], a[140:143], 0
    ds_read_b64_tr_b16 a[206:207], v238 offset:9472
    s_mul_i32 s44, s47, 114688
    v_mfma_f32_16x16x32_bf16 v[192:195], a[216:219], a[128:131], 0
    buffer_load_dwordx4 a[184:187], v249, s[8:11], s28 offen offset:3072 sc1
    s_add_u32 s47, s44, 7168
    s_lshl_b32 s25, s45, 7
    v_mfma_f32_16x16x32_bf16 v[196:199], a[216:219], a[132:135], 0
    s_add_u32 s44, s44, s25
    s_lshl_b32 s45, s45, 18
    v_mfma_f32_16x16x32_bf16 v[200:203], a[216:219], a[136:139], 0
    buffer_load_dwordx4 a[188:191], v249, s[8:11], s29 offen offset:3072 sc1
    s_add_u32 s46, s46, s45
    v_mfma_f32_16x16x32_bf16 v[204:207], a[216:219], a[140:143], 0
    s_add_u32 m0, s31, 1024
    s_add_u32 s24, s27, 32768
    s_lshr_b32 s25, s3, 1
    v_mfma_f32_16x16x32_bf16 v[208:211], a[220:223], a[128:131], 0
    buffer_load_dwordx4 v245, s[12:15], s24 offen lds
    s_lshl_b32 s25, s25, 15
    v_mfma_f32_16x16x32_bf16 v[212:215], a[220:223], a[132:135], 0
    s_add_u32 s46, s46, s25
    s_mov_b32 s45, s43
    v_mfma_f32_16x16x32_bf16 v[216:219], a[220:223], a[136:139], 0
    s_add_u32 s28, s28, 4096
    s_and_b32 s28, s28, 32767
    buffer_store_dwordx4 v[36:39], v240, s[16:19], s81 offen sc1
    v_mfma_f32_16x16x32_bf16 v[220:223], a[220:223], a[140:143], 0
    s_add_u32 s29, s28, 32768
    v_accvgpr_write_b32 a0, 0
    s_waitcnt vmcnt(13) lgkmcnt(0)
    v_mfma_f32_16x16x32_bf16 v[96:99], a[192:195], a[144:147], v[96:99]
    ds_read_b64_tr_b16 a[208:209], v246 offset:8704
    s_load_dwordx2 s[56:57], s[0:1], 40
    v_accvgpr_write_b32 a1, 0
    v_mfma_f32_16x16x32_bf16 v[100:103], a[192:195], a[148:151], v[100:103]
    ds_read_b64_tr_b16 a[210:211], v246 offset:9728
    v_accvgpr_write_b32 a2, 0
    v_mfma_f32_16x16x32_bf16 v[104:107], a[192:195], a[152:155], v[104:107]
    ds_read_b64_tr_b16 a[212:213], v238 offset:8704
    v_accvgpr_write_b32 a3, 0
    v_mfma_f32_16x16x32_bf16 v[108:111], a[192:195], a[156:159], v[108:111]
    ds_read_b64_tr_b16 a[214:215], v238 offset:9728
    v_accvgpr_write_b32 a4, 0
    v_accvgpr_write_b32 a5, 0
    v_mfma_f32_16x16x32_bf16 v[112:115], a[196:199], a[144:147], v[112:115]
    ds_read_b64_tr_b16 a[216:217], v246 offset:8960
    v_accvgpr_write_b32 a6, 0
    v_mfma_f32_16x16x32_bf16 v[116:119], a[196:199], a[148:151], v[116:119]
    ds_read_b64_tr_b16 a[218:219], v246 offset:9984
    v_accvgpr_write_b32 a7, 0
    v_accvgpr_write_b32 a8, 0
    v_mfma_f32_16x16x32_bf16 v[120:123], a[196:199], a[152:155], v[120:123]
    ds_read_b64_tr_b16 a[220:221], v238 offset:8960
    v_accvgpr_write_b32 a9, 0
    v_mfma_f32_16x16x32_bf16 v[124:127], a[196:199], a[156:159], v[124:127]
    ds_read_b64_tr_b16 a[222:223], v238 offset:9984
    v_accvgpr_write_b32 a10, 0
    v_mfma_f32_16x16x32_bf16 v[128:131], a[200:203], a[144:147], v[128:131]
    buffer_load_dwordx4 a[128:131], v248, s[8:11], s28 offen offset:0 sc1
    v_accvgpr_write_b32 a11, 0
    v_accvgpr_write_b32 a12, 0
    v_mfma_f32_16x16x32_bf16 v[132:135], a[200:203], a[148:151], v[132:135]
    v_accvgpr_write_b32 a13, 0
    v_accvgpr_write_b32 a14, 0
    v_mfma_f32_16x16x32_bf16 v[136:139], a[200:203], a[152:155], v[136:139]
    buffer_load_dwordx4 a[132:135], v248, s[8:11], s29 offen offset:0 sc1
    v_accvgpr_write_b32 a15, 0
    v_mfma_f32_16x16x32_bf16 v[140:143], a[200:203], a[156:159], v[140:143]
    s_add_u32 m0, s31, 2048
    s_add_u32 s24, s27, 65536
    v_accvgpr_write_b32 a16, 0
    v_mfma_f32_16x16x32_bf16 v[144:147], a[204:207], a[144:147], v[144:147]
    buffer_load_dwordx4 v237, s[12:15], s24 offen lds
    v_accvgpr_write_b32 a17, 0
    v_mfma_f32_16x16x32_bf16 v[148:151], a[204:207], a[148:151], v[148:151]
    v_accvgpr_write_b32 a18, 0
    v_accvgpr_write_b32 a19, 0
    v_accvgpr_write_b32 a20, 0
    v_mfma_f32_16x16x32_bf16 v[152:155], a[204:207], a[152:155], v[152:155]
    buffer_store_dwordx4 v[40:43], v240, s[16:19], s82 offen sc1
    v_accvgpr_write_b32 a21, 0
    v_mfma_f32_16x16x32_bf16 v[156:159], a[204:207], a[156:159], v[156:159]
    v_accvgpr_write_b32 a22, 0
    s_waitcnt lgkmcnt(0)
    v_mfma_f32_16x16x32_bf16 v[160:163], a[208:211], a[144:147], v[160:163]
    ds_read_b64_tr_b16 a[192:193], v246 offset:16384
    v_accvgpr_write_b32 a23, 0
    v_accvgpr_write_b32 a24, 0
    v_mfma_f32_16x16x32_bf16 v[164:167], a[208:211], a[148:151], v[164:167]
    ds_read_b64_tr_b16 a[194:195], v246 offset:17408
    v_accvgpr_write_b32 a25, 0
    v_mfma_f32_16x16x32_bf16 v[168:171], a[208:211], a[152:155], v[168:171]
    ds_read_b64_tr_b16 a[196:197], v238 offset:16384
    v_accvgpr_write_b32 a26, 0
    v_mfma_f32_16x16x32_bf16 v[172:175], a[208:211], a[156:159], v[172:175]
    ds_read_b64_tr_b16 a[198:199], v238 offset:17408
    v_accvgpr_write_b32 a27, 0
    v_accvgpr_write_b32 a28, 0
    v_mfma_f32_16x16x32_bf16 v[176:179], a[212:215], a[144:147], v[176:179]
    ds_read_b64_tr_b16 a[200:201], v246 offset:16640
    v_accvgpr_write_b32 a29, 0
    v_mfma_f32_16x16x32_bf16 v[180:183], a[212:215], a[148:151], v[180:183]
    ds_read_b64_tr_b16 a[202:203], v246 offset:17664
    v_accvgpr_write_b32 a30, 0
    v_accvgpr_write_b32 a31, 0
    v_mfma_f32_16x16x32_bf16 v[184:187], a[212:215], a[152:155], v[184:187]
    ds_read_b64_tr_b16 a[204:205], v238 offset:16640
    v_accvgpr_write_b32 a32, 0
    v_mfma_f32_16x16x32_bf16 v[188:191], a[212:215], a[156:159], v[188:191]
    ds_read_b64_tr_b16 a[206:207], v238 offset:17664
    v_accvgpr_write_b32 a33, 0
    v_mfma_f32_16x16x32_bf16 v[192:195], a[216:219], a[144:147], v[192:195]
    buffer_load_dwordx4 a[136:139], v249, s[8:11], s28 offen offset:0 sc1
    v_accvgpr_write_b32 a34, 0
    v_accvgpr_write_b32 a35, 0
    v_mfma_f32_16x16x32_bf16 v[196:199], a[216:219], a[148:151], v[196:199]
    v_accvgpr_write_b32 a36, 0
    v_accvgpr_write_b32 a37, 0
    v_mfma_f32_16x16x32_bf16 v[200:203], a[216:219], a[152:155], v[200:203]
    buffer_load_dwordx4 a[140:143], v249, s[8:11], s29 offen offset:0 sc1
    v_accvgpr_write_b32 a38, 0
    v_mfma_f32_16x16x32_bf16 v[204:207], a[216:219], a[156:159], v[204:207]
    s_add_u32 m0, s31, 3072
    s_add_u32 s24, s27, 98304
    v_accvgpr_write_b32 a39, 0
    v_mfma_f32_16x16x32_bf16 v[208:211], a[220:223], a[144:147], v[208:211]
    buffer_load_dwordx4 v237, s[12:15], s24 offen lds
    v_accvgpr_write_b32 a40, 0
    v_mfma_f32_16x16x32_bf16 v[212:215], a[220:223], a[148:151], v[212:215]
    v_accvgpr_write_b32 a41, 0
    v_accvgpr_write_b32 a42, 0
    v_accvgpr_write_b32 a43, 0
    v_mfma_f32_16x16x32_bf16 v[216:219], a[220:223], a[152:155], v[216:219]
    buffer_store_dwordx4 v[44:47], v240, s[16:19], s83 offen sc1
    v_accvgpr_write_b32 a44, 0
    v_mfma_f32_16x16x32_bf16 v[220:223], a[220:223], a[156:159], v[220:223]
    v_accvgpr_write_b32 a45, 0
    s_waitcnt vmcnt(16) lgkmcnt(0)
    v_mfma_f32_16x16x32_bf16 v[96:99], a[192:195], a[160:163], v[96:99]
    ds_read_b64_tr_b16 a[208:209], v246 offset:16896
    v_accvgpr_write_b32 a46, 0
    v_accvgpr_write_b32 a47, 0
    v_mfma_f32_16x16x32_bf16 v[100:103], a[192:195], a[164:167], v[100:103]
    ds_read_b64_tr_b16 a[210:211], v246 offset:17920
    v_accvgpr_write_b32 a48, 0
    v_mfma_f32_16x16x32_bf16 v[104:107], a[192:195], a[168:171], v[104:107]
    ds_read_b64_tr_b16 a[212:213], v238 offset:16896
    v_accvgpr_write_b32 a49, 0
    v_accvgpr_write_b32 a50, 0
    v_mfma_f32_16x16x32_bf16 v[108:111], a[192:195], a[172:175], v[108:111]
    ds_read_b64_tr_b16 a[214:215], v238 offset:17920
    v_accvgpr_write_b32 a51, 0
    v_mfma_f32_16x16x32_bf16 v[112:115], a[196:199], a[160:163], v[112:115]
    ds_read_b64_tr_b16 a[216:217], v246 offset:17152
    v_accvgpr_write_b32 a52, 0
    v_mfma_f32_16x16x32_bf16 v[116:119], a[196:199], a[164:167], v[116:119]
    ds_read_b64_tr_b16 a[218:219], v246 offset:18176
    v_accvgpr_write_b32 a53, 0
    v_accvgpr_write_b32 a54, 0
    v_mfma_f32_16x16x32_bf16 v[120:123], a[196:199], a[168:171], v[120:123]
    ds_read_b64_tr_b16 a[220:221], v238 offset:17152
    v_accvgpr_write_b32 a55, 0
    v_mfma_f32_16x16x32_bf16 v[124:127], a[196:199], a[172:175], v[124:127]
    ds_read_b64_tr_b16 a[222:223], v238 offset:18176
    v_accvgpr_write_b32 a56, 0
    v_accvgpr_write_b32 a57, 0
    v_mfma_f32_16x16x32_bf16 v[128:131], a[200:203], a[160:163], v[128:131]
    buffer_load_dwordx4 a[144:147], v248, s[8:11], s28 offen offset:1024 sc1
    v_accvgpr_write_b32 a58, 0
    v_mfma_f32_16x16x32_bf16 v[132:135], a[200:203], a[164:167], v[132:135]
    v_accvgpr_write_b32 a59, 0
    v_accvgpr_write_b32 a60, 0
    v_mfma_f32_16x16x32_bf16 v[136:139], a[200:203], a[168:171], v[136:139]
    buffer_load_dwordx4 a[148:151], v248, s[8:11], s29 offen offset:1024 sc1
    v_accvgpr_write_b32 a61, 0
    v_mfma_f32_16x16x32_bf16 v[140:143], a[200:203], a[172:175], v[140:143]
    s_add_u32 m0, s31, 4096
    s_add_u32 s24, s27, 131072
    v_accvgpr_write_b32 a62, 0
    v_mfma_f32_16x16x32_bf16 v[144:147], a[204:207], a[160:163], v[144:147]
    buffer_load_dwordx4 v245, s[12:15], s24 offen lds
    v_accvgpr_write_b32 a63, 0
    v_mfma_f32_16x16x32_bf16 v[148:151], a[204:207], a[164:167], v[148:151]
    v_accvgpr_write_b32 a64, 0
    v_accvgpr_write_b32 a65, 0
    v_accvgpr_write_b32 a66, 0
    v_mfma_f32_16x16x32_bf16 v[152:155], a[204:207], a[168:171], v[152:155]
    buffer_store_dwordx4 v[48:51], v240, s[16:19], s84 offen sc1
    v_accvgpr_write_b32 a67, 0
    v_mfma_f32_16x16x32_bf16 v[156:159], a[204:207], a[172:175], v[156:159]
    v_accvgpr_write_b32 a68, 0
    s_waitcnt lgkmcnt(0)
    v_mfma_f32_16x16x32_bf16 v[160:163], a[208:211], a[160:163], v[160:163]
    ds_read_b64_tr_b16 a[192:193], v246 offset:24576
    v_accvgpr_write_b32 a69, 0
    v_accvgpr_write_b32 a70, 0
    v_mfma_f32_16x16x32_bf16 v[164:167], a[208:211], a[164:167], v[164:167]
    ds_read_b64_tr_b16 a[194:195], v246 offset:25600
    v_accvgpr_write_b32 a71, 0
    v_mfma_f32_16x16x32_bf16 v[168:171], a[208:211], a[168:171], v[168:171]
    ds_read_b64_tr_b16 a[196:197], v238 offset:24576
    v_accvgpr_write_b32 a72, 0
    v_accvgpr_write_b32 a73, 0
    v_mfma_f32_16x16x32_bf16 v[172:175], a[208:211], a[172:175], v[172:175]
    ds_read_b64_tr_b16 a[198:199], v238 offset:25600
    v_accvgpr_write_b32 a74, 0
    v_mfma_f32_16x16x32_bf16 v[176:179], a[212:215], a[160:163], v[176:179]
    ds_read_b64_tr_b16 a[200:201], v246 offset:24832
    v_accvgpr_write_b32 a75, 0
    v_mfma_f32_16x16x32_bf16 v[180:183], a[212:215], a[164:167], v[180:183]
    ds_read_b64_tr_b16 a[202:203], v246 offset:25856
    v_accvgpr_write_b32 a76, 0
    v_accvgpr_write_b32 a77, 0
    v_mfma_f32_16x16x32_bf16 v[184:187], a[212:215], a[168:171], v[184:187]
    ds_read_b64_tr_b16 a[204:205], v238 offset:24832
    v_accvgpr_write_b32 a78, 0
    v_mfma_f32_16x16x32_bf16 v[188:191], a[212:215], a[172:175], v[188:191]
    ds_read_b64_tr_b16 a[206:207], v238 offset:25856
    v_accvgpr_write_b32 a79, 0
    v_accvgpr_write_b32 a80, 0
    v_mfma_f32_16x16x32_bf16 v[192:195], a[216:219], a[160:163], v[192:195]
    buffer_load_dwordx4 a[152:155], v249, s[8:11], s28 offen offset:1024 sc1
    v_accvgpr_write_b32 a81, 0
    v_mfma_f32_16x16x32_bf16 v[196:199], a[216:219], a[164:167], v[196:199]
    v_accvgpr_write_b32 a82, 0
    v_accvgpr_write_b32 a83, 0
    v_mfma_f32_16x16x32_bf16 v[200:203], a[216:219], a[168:171], v[200:203]
    buffer_load_dwordx4 a[156:159], v249, s[8:11], s29 offen offset:1024 sc1
    v_accvgpr_write_b32 a84, 0
    v_mfma_f32_16x16x32_bf16 v[204:207], a[216:219], a[172:175], v[204:207]
    s_add_u32 m0, s31, 5120
    s_add_u32 s24, s27, 163840
    v_accvgpr_write_b32 a85, 0
    v_mfma_f32_16x16x32_bf16 v[208:211], a[220:223], a[160:163], v[208:211]
    buffer_load_dwordx4 v245, s[12:15], s24 offen lds
    v_accvgpr_write_b32 a86, 0
    v_accvgpr_write_b32 a87, 0
    v_mfma_f32_16x16x32_bf16 v[212:215], a[220:223], a[164:167], v[212:215]
    v_accvgpr_write_b32 a88, 0
    v_accvgpr_write_b32 a89, 0
    v_mfma_f32_16x16x32_bf16 v[216:219], a[220:223], a[168:171], v[216:219]
    s_add_u32 s30, s30, 32768
    buffer_store_dwordx4 v[52:55], v240, s[16:19], s85 offen sc1
    v_mfma_f32_16x16x32_bf16 v[220:223], a[220:223], a[172:175], v[220:223]
    s_cmp_ge_u32 s30, 163840
    s_cselect_b32 s30, 65536, s30
    s_waitcnt vmcnt(18) lgkmcnt(0)
    v_mfma_f32_16x16x32_bf16 v[96:99], a[192:195], a[176:179], v[96:99]
    ds_read_b64_tr_b16 a[208:209], v246 offset:25088
    v_accvgpr_write_b32 a90, 0
    v_accvgpr_write_b32 a91, 0
    v_mfma_f32_16x16x32_bf16 v[100:103], a[192:195], a[180:183], v[100:103]
    ds_read_b64_tr_b16 a[210:211], v246 offset:26112
    v_accvgpr_write_b32 a92, 0
    v_mfma_f32_16x16x32_bf16 v[104:107], a[192:195], a[184:187], v[104:107]
    ds_read_b64_tr_b16 a[212:213], v238 offset:25088
    v_accvgpr_write_b32 a93, 0
    v_mfma_f32_16x16x32_bf16 v[108:111], a[192:195], a[188:191], v[108:111]
    ds_read_b64_tr_b16 a[214:215], v238 offset:26112
    v_accvgpr_write_b32 a94, 0
    v_accvgpr_write_b32 a95, 0
    v_mfma_f32_16x16x32_bf16 v[112:115], a[196:199], a[176:179], v[112:115]
    ds_read_b64_tr_b16 a[216:217], v246 offset:25344
    v_accvgpr_write_b32 a96, 0
    v_mfma_f32_16x16x32_bf16 v[116:119], a[196:199], a[180:183], v[116:119]
    ds_read_b64_tr_b16 a[218:219], v246 offset:26368
    v_accvgpr_write_b32 a97, 0
    v_accvgpr_write_b32 a98, 0
    v_mfma_f32_16x16x32_bf16 v[120:123], a[196:199], a[184:187], v[120:123]
    ds_read_b64_tr_b16 a[220:221], v238 offset:25344
    v_accvgpr_write_b32 a99, 0
    v_mfma_f32_16x16x32_bf16 v[124:127], a[196:199], a[188:191], v[124:127]
    ds_read_b64_tr_b16 a[222:223], v238 offset:26368
    v_accvgpr_write_b32 a100, 0
    v_mfma_f32_16x16x32_bf16 v[128:131], a[200:203], a[176:179], v[128:131]
    buffer_load_dwordx4 a[160:163], v248, s[8:11], s28 offen offset:2048 sc1
    v_accvgpr_write_b32 a101, 0
    v_accvgpr_write_b32 a102, 0
    v_mfma_f32_16x16x32_bf16 v[132:135], a[200:203], a[180:183], v[132:135]
    v_accvgpr_write_b32 a103, 0
    v_accvgpr_write_b32 a104, 0
    v_mfma_f32_16x16x32_bf16 v[136:139], a[200:203], a[184:187], v[136:139]
    buffer_load_dwordx4 a[164:167], v248, s[8:11], s29 offen offset:2048 sc1
    v_accvgpr_write_b32 a105, 0
    v_mfma_f32_16x16x32_bf16 v[140:143], a[200:203], a[188:191], v[140:143]
    s_add_u32 m0, s31, 6144
    s_add_u32 s24, s27, 196608
    v_accvgpr_write_b32 a106, 0
    v_mfma_f32_16x16x32_bf16 v[144:147], a[204:207], a[176:179], v[144:147]
    buffer_load_dwordx4 v237, s[12:15], s24 offen lds
    v_accvgpr_write_b32 a107, 0
    v_mfma_f32_16x16x32_bf16 v[148:151], a[204:207], a[180:183], v[148:151]
    v_accvgpr_write_b32 a108, 0
    v_accvgpr_write_b32 a109, 0
    v_accvgpr_write_b32 a110, 0
    v_mfma_f32_16x16x32_bf16 v[152:155], a[204:207], a[184:187], v[152:155]
    buffer_store_dwordx4 v[56:59], v240, s[16:19], s86 offen sc1
    v_accvgpr_write_b32 a111, 0
    v_mfma_f32_16x16x32_bf16 v[156:159], a[204:207], a[188:191], v[156:159]
    s_waitcnt vmcnt(49) lgkmcnt(0)
    s_barrier
    v_add_u32 v246, s30, v247
    v_mfma_f32_16x16x32_bf16 v[160:163], a[208:211], a[176:179], v[160:163]
    v_xor_b32 v238, 32, v246
    ds_read_b64_tr_b16 a[192:193], v246 offset:0
    v_accvgpr_write_b32 a112, 0
    v_mfma_f32_16x16x32_bf16 v[164:167], a[208:211], a[180:183], v[164:167]
    ds_read_b64_tr_b16 a[194:195], v246 offset:1024
    v_accvgpr_write_b32 a113, 0
    v_mfma_f32_16x16x32_bf16 v[168:171], a[208:211], a[184:187], v[168:171]
    ds_read_b64_tr_b16 a[196:197], v238 offset:0
    v_accvgpr_write_b32 a114, 0
    v_mfma_f32_16x16x32_bf16 v[172:175], a[208:211], a[188:191], v[172:175]
    ds_read_b64_tr_b16 a[198:199], v238 offset:1024
    v_accvgpr_write_b32 a115, 0
    v_accvgpr_write_b32 a116, 0
    v_mfma_f32_16x16x32_bf16 v[176:179], a[212:215], a[176:179], v[176:179]
    ds_read_b64_tr_b16 a[200:201], v246 offset:256
    v_accvgpr_write_b32 a117, 0
    v_mfma_f32_16x16x32_bf16 v[180:183], a[212:215], a[180:183], v[180:183]
    ds_read_b64_tr_b16 a[202:203], v246 offset:1280
    v_accvgpr_write_b32 a118, 0
    v_accvgpr_write_b32 a119, 0
    v_mfma_f32_16x16x32_bf16 v[184:187], a[212:215], a[184:187], v[184:187]
    ds_read_b64_tr_b16 a[204:205], v238 offset:256
    buffer_store_dwordx4 v[60:63], v240, s[16:19], s87 offen sc1
    v_mfma_f32_16x16x32_bf16 v[188:191], a[212:215], a[188:191], v[188:191]
    ds_read_b64_tr_b16 a[206:207], v238 offset:1280
    v_accvgpr_write_b32 a120, 0
    v_accvgpr_write_b32 a121, 0
    v_mfma_f32_16x16x32_bf16 v[192:195], a[216:219], a[176:179], v[192:195]
    buffer_load_dwordx4 a[168:171], v249, s[8:11], s28 offen offset:2048 sc1
    v_accvgpr_write_b32 a122, 0
    v_mfma_f32_16x16x32_bf16 v[196:199], a[216:219], a[180:183], v[196:199]
    s_lshl2_add_u32 s80, s2, s3
    s_mul_i32 s80, s80, 12288
    s_add_u32 s80, s80, 0x1000000
    v_mov_b32 v0, -1
    v_mov_b32 v1, -1
    v_mov_b32 v2, -1
    v_mov_b32 v3, -1
    v_mfma_f32_16x16x32_bf16 v[200:203], a[216:219], a[184:187], v[200:203]
    buffer_load_dwordx4 a[172:175], v249, s[8:11], s29 offen offset:2048 sc1
    v_accvgpr_write_b32 a123, 0
    v_accvgpr_write_b32 a124, 0
    v_mfma_f32_16x16x32_bf16 v[204:207], a[216:219], a[188:191], v[204:207]
    s_add_u32 m0, s31, 7168
    s_add_u32 s24, s27, 229376
    v_mfma_f32_16x16x32_bf16 v[208:211], a[220:223], a[176:179], v[208:211]
    buffer_load_dwordx4 v237, s[12:15], s24 offen lds
    v_accvgpr_write_b32 a125, 0
    v_accvgpr_write_b32 a126, 0
    v_mfma_f32_16x16x32_bf16 v[212:215], a[220:223], a[180:183], v[212:215]
    s_add_u32 s27, s27, 1048576
    s_and_b32 s27, s27, 0x407fffff
    v_mfma_f32_16x16x32_bf16 v[216:219], a[220:223], a[184:187], v[216:219]
    s_cmp_eq_u32 s27, s7
    s_cselect_b32 s27, s43, s27
    v_accvgpr_write_b32 a127, 0
    v_mfma_f32_16x16x32_bf16 v[220:223], a[220:223], a[188:191], v[220:223]
    s_add_u32 s31, s31, 32768
    s_cmp_ge_u32 s31, 163840
    s_cselect_b32 s24, 98304, 0
    s_sub_u32 s31, s31, s24
.p2align 3
ka_qp:
    s_waitcnt vmcnt(15) lgkmcnt(0)
    v_mfma_f32_16x16x32_bf16 v[96:99], a[192:195], a[128:131], v[96:99]
    ds_read_b64_tr_b16 a[208:209], v246 offset:512
    v_mfma_f32_16x16x32_bf16 v[100:103], a[192:195], a[132:135], v[100:103]
    ds_read_b64_tr_b16 a[210:211], v246 offset:1536
    v_mfma_f32_16x16x32_bf16 v[104:107], a[192:195], a[136:139], v[104:107]
    ds_read_b64_tr_b16 a[212:213], v238 offset:512
    v_mfma_f32_16x16x32_bf16 v[108:111], a[192:195], a[140:143], v[108:111]
    ds_read_b64_tr_b16 a[214:215], v238 offset:1536
    v_mfma_f32_16x16x32_bf16 v[112:115], a[196:199], a[128:131], v[112:115]
    ds_read_b64_tr_b16 a[216:217], v246 offset:768
    v_mfma_f32_16x16x32_bf16 v[116:119], a[196:199], a[132:135], v[116:119]
    ds_read_b64_tr_b16 a[218:219], v246 offset:1792
    v_mfma_f32_16x16x32_bf16 v[120:123], a[196:199], a[136:139], v[120:123]
    ds_read_b64_tr_b16 a[220:221], v238 offset:768
    v_mfma_f32_16x16x32_bf16 v[124:127], a[196:199], a[140:143], v[124:127]
    ds_read_b64_tr_b16 a[222:223], v238 offset:1792
    v_mfma_f32_16x16x32_bf16 v[128:131], a[200:203], a[128:131], v[128:131]
    buffer_load_dwordx4 a[176:179], v248, s[8:11], s28 offen offset:3072 sc1
    s_cmp_eq_u32 s26, 1
    s_cselect_b32 s41, s35, s43
    buffer_load_dword v254, off, s[88:91], s41 sc1
    v_mfma_f32_16x16x32_bf16 v[132:135], a[200:203], a[132:135], v[132:135]
    v_mfma_f32_16x16x32_bf16 v[136:139], a[200:203], a[136:139], v[136:139]
    buffer_load_dwordx4 a[180:183], v248, s[8:11], s29 offen offset:3072 sc1
    v_mfma_f32_16x16x32_bf16 v[140:143], a[200:203], a[140:143], v[140:143]
    s_add_u32 m0, s31, 0
    s_add_u32 s24, s27, 0
    v_mfma_f32_16x16x32_bf16 v[144:147], a[204:207], a[128:131], v[144:147]
    buffer_load_dwordx4 v245, s[12:15], s24 offen lds
    v_mfma_f32_16x16x32_bf16 v[148:151], a[204:207], a[132:135], v[148:151]
    v_mfma_f32_16x16x32_bf16 v[152:155], a[204:207], a[136:139], v[152:155]
    v_mfma_f32_16x16x32_bf16 v[156:159], a[204:207], a[140:143], v[156:159]
    s_waitcnt lgkmcnt(0)
    v_mfma_f32_16x16x32_bf16 v[160:163], a[208:211], a[128:131], v[160:163]
    ds_read_b64_tr_b16 a[192:193], v246 offset:8192
    v_mfma_f32_16x16x32_bf16 v[164:167], a[208:211], a[132:135], v[164:167]
    ds_read_b64_tr_b16 a[194:195], v246 offset:9216
    v_mfma_f32_16x16x32_bf16 v[168:171], a[208:211], a[136:139], v[168:171]
    ds_read_b64_tr_b16 a[196:197], v238 offset:8192
    v_mfma_f32_16x16x32_bf16 v[172:175], a[208:211], a[140:143], v[172:175]
    ds_read_b64_tr_b16 a[198:199], v238 offset:9216
    v_mfma_f32_16x16x32_bf16 v[176:179], a[212:215], a[128:131], v[176:179]
    ds_read_b64_tr_b16 a[200:201], v246 offset:8448
    v_mfma_f32_16x16x32_bf16 v[180:183], a[212:215], a[132:135], v[180:183]
    ds_read_b64_tr_b16 a[202:203], v246 offset:9472
    v_mfma_f32_16x16x32_bf16 v[184:187], a[212:215], a[136:139], v[184:187]
    ds_read_b64_tr_b16 a[204:205], v238 offset:8448
    v_mfma_f32_16x16x32_bf16 v[188:191], a[212:215], a[140:143], v[188:191]
    ds_read_b64_tr_b16 a[206:207], v238 offset:9472
    v_mfma_f32_16x16x32_bf16 v[192:195], a[216:219], a[128:131], v[192:195]
    buffer_load_dwordx4 a[184:187], v249, s[8:11], s28 offen offset:3072 sc1
    v_mfma_f32_16x16x32_bf16 v[196:199], a[216:219], a[132:135], v[196:199]
    v_mfma_f32_16x16x32_bf16 v[200:203], a[216:219], a[136:139], v[200:203]
    buffer_load_dwordx4 a[188:191], v249, s[8:11], s29 offen offset:3072 sc1
    v_mfma_f32_16x16x32_bf16 v[204:207], a[216:219], a[140:143], v[204:207]
    s_add_u32 m0, s31, 1024
    s_add_u32 s24, s27, 32768
    v_mfma_f32_16x16x32_bf16 v[208:211], a[220:223], a[128:131], v[208:211]
    buffer_load_dwordx4 v245, s[12:15], s24 offen lds
    v_mfma_f32_16x16x32_bf16 v[212:215], a[220:223], a[132:135], v[212:215]
    v_mfma_f32_16x16x32_bf16 v[216:219], a[220:223], a[136:139], v[216:219]
    s_add_u32 s28, s28, 4096
    s_and_b32 s28, s28, 32767
    v_mfma_f32_16x16x32_bf16 v[220:223], a[220:223], a[140:143], v[220:223]
    s_add_u32 s29, s28, 32768
    s_waitcnt vmcnt(16) lgkmcnt(0)
    v_mfma_f32_16x16x32_bf16 v[96:99], a[192:195], a[144:147], v[96:99]
    ds_read_b64_tr_b16 a[208:209], v246 offset:8704
    v_mfma_f32_16x16x32_bf16 v[100:103], a[192:195], a[148:151], v[100:103]
    ds_read_b64_tr_b16 a[210:211], v246 offset:9728
    v_mfma_f32_16x16x32_bf16 v[104:107], a[192:195], a[152:155], v[104:107]
    ds_read_b64_tr_b16 a[212:213], v238 offset:8704
    v_mfma_f32_16x16x32_bf16 v[108:111], a[192:195], a[156:159], v[108:111]
    ds_read_b64_tr_b16 a[214:215], v238 offset:9728
    v_mfma_f32_16x16x32_bf16 v[112:115], a[196:199], a[144:147], v[112:115]
    ds_read_b64_tr_b16 a[216:217], v246 offset:8960
    v_mfma_f32_16x16x32_bf16 v[116:119], a[196:199], a[148:151], v[116:119]
    ds_read_b64_tr_b16 a[218:219], v246 offset:9984
    v_mfma_f32_16x16x32_bf16 v[120:123], a[196:199], a[152:155], v[120:123]
    ds_read_b64_tr_b16 a[220:221], v238 offset:8960
    v_mfma_f32_16x16x32_bf16 v[124:127], a[196:199], a[156:159], v[124:127]
    ds_read_b64_tr_b16 a[222:223], v238 offset:9984
    v_mfma_f32_16x16x32_bf16 v[128:131], a[200:203], a[144:147], v[128:131]
    buffer_load_dwordx4 a[128:131], v248, s[8:11], s28 offen offset:0 sc1
    v_mfma_f32_16x16x32_bf16 v[132:135], a[200:203], a[148:151], v[132:135]
    v_mfma_f32_16x16x32_bf16 v[136:139], a[200:203], a[152:155], v[136:139]
    buffer_load_dwordx4 a[132:135], v248, s[8:11], s29 offen offset:0 sc1
    v_mfma_f32_16x16x32_bf16 v[140:143], a[200:203], a[156:159], v[140:143]
    s_add_u32 m0, s31, 2048
    s_add_u32 s24, s27, 65536
    v_mfma_f32_16x16x32_bf16 v[144:147], a[204:207], a[144:147], v[144:147]
    buffer_load_dwordx4 v237, s[12:15], s24 offen lds
    v_mfma_f32_16x16x32_bf16 v[148:151], a[204:207], a[148:151], v[148:151]
    buffer_store_dwordx4 v[0:3], v240, s[48:51], s80 offen sc1
    s_add_u32 s80, s80, 1024
    v_mfma_f32_16x16x32_bf16 v[152:155], a[204:207], a[152:155], v[152:155]
    v_mfma_f32_16x16x32_bf16 v[156:159], a[204:207], a[156:159], v[156:159]
    s_waitcnt lgkmcnt(0)
    v_mfma_f32_16x16x32_bf16 v[160:163], a[208:211], a[144:147], v[160:163]
    ds_read_b64_tr_b16 a[192:193], v246 offset:16384
    v_mfma_f32_16x16x32_bf16 v[164:167], a[208:211], a[148:151], v[164:167]
    ds_read_b64_tr_b16 a[194:195], v246 offset:17408
    v_mfma_f32_16x16x32_bf16 v[168:171], a[208:211], a[152:155], v[168:171]
    ds_read_b64_tr_b16 a[196:197], v238 offset:16384
    v_mfma_f32_16x16x32_bf16 v[172:175], a[208:211], a[156:159], v[172:175]
    ds_read_b64_tr_b16 a[198:199], v238 offset:17408
    v_mfma_f32_16x16x32_bf16 v[176:179], a[212:215], a[144:147], v[176:179]
    ds_read_b64_tr_b16 a[200:201], v246 offset:16640
    v_mfma_f32_16x16x32_bf16 v[180:183], a[212:215], a[148:151], v[180:183]
    ds_read_b64_tr_b16 a[202:203], v246 offset:17664
    v_mfma_f32_16x16x32_bf16 v[184:187], a[212:215], a[152:155], v[184:187]
    ds_read_b64_tr_b16 a[204:205], v238 offset:16640
    v_mfma_f32_16x16x32_bf16 v[188:191], a[212:215], a[156:159], v[188:191]
    ds_read_b64_tr_b16 a[206:207], v238 offset:17664
    v_mfma_f32_16x16x32_bf16 v[192:195], a[216:219], a[144:147], v[192:195]
    buffer_load_dwordx4 a[136:139], v249, s[8:11], s28 offen offset:0 sc1
    v_mfma_f32_16x16x32_bf16 v[196:199], a[216:219], a[148:151], v[196:199]
    v_mfma_f32_16x16x32_bf16 v[200:203], a[216:219], a[152:155], v[200:203]
    buffer_load_dwordx4 a[140:143], v249, s[8:11], s29 offen offset:0 sc1
    v_mfma_f32_16x16x32_bf16 v[204:207], a[216:219], a[156:159], v[204:207]
    s_add_u32 m0, s31, 3072
    s_add_u32 s24, s27, 98304
    v_mfma_f32_16x16x32_bf16 v[208:211], a[220:223], a[144:147], v[208:211]
    buffer_load_dwordx4 v237, s[12:15], s24 offen lds
    v_mfma_f32_16x16x32_bf16 v[212:215], a[220:223], a[148:151], v[212:215]
    v_mfma_f32_16x16x32_bf16 v[216:219], a[220:223], a[152:155], v[216:219]
    v_mfma_f32_16x16x32_bf16 v[220:223], a[220:223], a[156:159], v[220:223]
    s_waitcnt vmcnt(15) lgkmcnt(0)
    v_mfma_f32_16x16x32_bf16 v[96:99], a[192:195], a[160:163], v[96:99]
    ds_read_b64_tr_b16 a[208:209], v246 offset:16896
    v_mfma_f32_16x16x32_bf16 v[100:103], a[192:195], a[164:167], v[100:103]
    ds_read_b64_tr_b16 a[210:211], v246 offset:17920
    v_mfma_f32_16x16x32_bf16 v[104:107], a[192:195], a[168:171], v[104:107]
    ds_read_b64_tr_b16 a[212:213], v238 offset:16896
    v_mfma_f32_16x16x32_bf16 v[108:111], a[192:195], a[172:175], v[108:111]
    ds_read_b64_tr_b16 a[214:215], v238 offset:17920
    v_mfma_f32_16x16x32_bf16 v[112:115], a[196:199], a[160:163], v[112:115]
    ds_read_b64_tr_b16 a[216:217], v246 offset:17152
    v_mfma_f32_16x16x32_bf16 v[116:119], a[196:199], a[164:167], v[116:119]
    ds_read_b64_tr_b16 a[218:219], v246 offset:18176
    v_mfma_f32_16x16x32_bf16 v[120:123], a[196:199], a[168:171], v[120:123]
    ds_read_b64_tr_b16 a[220:221], v238 offset:17152
    v_mfma_f32_16x16x32_bf16 v[124:127], a[196:199], a[172:175], v[124:127]
    ds_read_b64_tr_b16 a[222:223], v238 offset:18176
    v_mfma_f32_16x16x32_bf16 v[128:131], a[200:203], a[160:163], v[128:131]
    buffer_load_dwordx4 a[144:147], v248, s[8:11], s28 offen offset:1024 sc1
    v_mfma_f32_16x16x32_bf16 v[132:135], a[200:203], a[164:167], v[132:135]
    v_mfma_f32_16x16x32_bf16 v[136:139], a[200:203], a[168:171], v[136:139]
    buffer_load_dwordx4 a[148:151], v248, s[8:11], s29 offen offset:1024 sc1
    v_mfma_f32_16x16x32_bf16 v[140:143], a[200:203], a[172:175], v[140:143]
    s_add_u32 m0, s31, 4096
    s_add_u32 s24, s27, 131072
    v_mfma_f32_16x16x32_bf16 v[144:147], a[204:207], a[160:163], v[144:147]
    buffer_load_dwordx4 v245, s[12:15], s24 offen lds
    v_mfma_f32_16x16x32_bf16 v[148:151], a[204:207], a[164:167], v[148:151]
    v_mfma_f32_16x16x32_bf16 v[152:155], a[204:207], a[168:171], v[152:155]
    v_mfma_f32_16x16x32_bf16 v[156:159], a[204:207], a[172:175], v[156:159]
    s_waitcnt lgkmcnt(0)
    v_mfma_f32_16x16x32_bf16 v[160:163], a[208:211], a[160:163], v[160:163]
    ds_read_b64_tr_b16 a[192:193], v246 offset:24576
    v_mfma_f32_16x16x32_bf16 v[164:167], a[208:211], a[164:167], v[164:167]
    ds_read_b64_tr_b16 a[194:195], v246 offset:25600
    v_mfma_f32_16x16x32_bf16 v[168:171], a[208:211], a[168:171], v[168:171]
    ds_read_b64_tr_b16 a[196:197], v238 offset:24576
    v_mfma_f32_16x16x32_bf16 v[172:175], a[208:211], a[172:175], v[172:175]
    ds_read_b64_tr_b16 a[198:199], v238 offset:25600
    v_mfma_f32_16x16x32_bf16 v[176:179], a[212:215], a[160:163], v[176:179]
    ds_read_b64_tr_b16 a[200:201], v246 offset:24832
    v_mfma_f32_16x16x32_bf16 v[180:183], a[212:215], a[164:167], v[180:183]
    ds_read_b64_tr_b16 a[202:203], v246 offset:25856
    v_mfma_f32_16x16x32_bf16 v[184:187], a[212:215], a[168:171], v[184:187]
    ds_read_b64_tr_b16 a[204:205], v238 offset:24832
    v_mfma_f32_16x16x32_bf16 v[188:191], a[212:215], a[172:175], v[188:191]
    ds_read_b64_tr_b16 a[206:207], v238 offset:25856
    v_mfma_f32_16x16x32_bf16 v[192:195], a[216:219], a[160:163], v[192:195]
    buffer_load_dwordx4 a[152:155], v249, s[8:11], s28 offen offset:1024 sc1
    v_mfma_f32_16x16x32_bf16 v[196:199], a[216:219], a[164:167], v[196:199]
    v_mfma_f32_16x16x32_bf16 v[200:203], a[216:219], a[168:171], v[200:203]
    buffer_load_dwordx4 a[156:159], v249, s[8:11], s29 offen offset:1024 sc1
    v_mfma_f32_16x16x32_bf16 v[204:207], a[216:219], a[172:175], v[204:207]
    s_add_u32 m0, s31, 5120
    s_add_u32 s24, s27, 163840
    v_mfma_f32_16x16x32_bf16 v[208:211], a[220:223], a[160:163], v[208:211]
    buffer_load_dwordx4 v245, s[12:15], s24 offen lds
    v_mfma_f32_16x16x32_bf16 v[212:215], a[220:223], a[164:167], v[212:215]
    buffer_store_dwordx4 v[0:3], v240, s[48:51], s80 offen sc1
    s_add_u32 s80, s80, 1024
    v_mfma_f32_16x16x32_bf16 v[216:219], a[220:223], a[168:171], v[216:219]
    s_add_u32 s30, s30, 32768
    v_mfma_f32_16x16x32_bf16 v[220:223], a[220:223], a[172:175], v[220:223]
    s_cmp_ge_u32 s30, 163840
    s_cselect_b32 s30, 65536, s30
    s_waitcnt vmcnt(15) lgkmcnt(0)
    v_mfma_f32_16x16x32_bf16 v[96:99], a[192:195], a[176:179], v[96:99]
    ds_read_b64_tr_b16 a[208:209], v246 offset:25088
    v_mfma_f32_16x16x32_bf16 v[100:103], a[192:195], a[180:183], v[100:103]
    ds_read_b64_tr_b16 a[210:211], v246 offset:26112
    v_mfma_f32_16x16x32_bf16 v[104:107], a[192:195], a[184:187], v[104:107]
    ds_read_b64_tr_b16 a[212:213], v238 offset:25088
    v_mfma_f32_16x16x32_bf16 v[108:111], a[192:195], a[188:191], v[108:111]
    ds_read_b64_tr_b16 a[214:215], v238 offset:26112
    v_mfma_f32_16x16x32_bf16 v[112:115], a[196:199], a[176:179], v[112:115]
    ds_read_b64_tr_b16 a[216:217], v246 offset:25344
    v_mfma_f32_16x16x32_bf16 v[116:119], a[196:199], a[180:183], v[116:119]
    ds_read_b64_tr_b16 a[218:219], v246 offset:26368
    v_mfma_f32_16x16x32_bf16 v[120:123], a[196:199], a[184:187], v[120:123]
    ds_read_b64_tr_b16 a[220:221], v238 offset:25344
    v_mfma_f32_16x16x32_bf16 v[124:127], a[196:199], a[188:191], v[124:127]
    ds_read_b64_tr_b16 a[222:223], v238 offset:26368
    v_mfma_f32_16x16x32_bf16 v[128:131], a[200:203], a[176:179], v[128:131]
    buffer_load_dwordx4 a[160:163], v248, s[8:11], s28 offen offset:2048 sc1
    v_mfma_f32_16x16x32_bf16 v[132:135], a[200:203], a[180:183], v[132:135]
    v_mfma_f32_16x16x32_bf16 v[136:139], a[200:203], a[184:187], v[136:139]
    buffer_load_dwordx4 a[164:167], v248, s[8:11], s29 offen offset:2048 sc1
    v_mfma_f32_16x16x32_bf16 v[140:143], a[200:203], a[188:191], v[140:143]
    s_add_u32 m0, s31, 6144
    s_add_u32 s24, s27, 196608
    v_mfma_f32_16x16x32_bf16 v[144:147], a[204:207], a[176:179], v[144:147]
    buffer_load_dwordx4 v237, s[12:15], s24 offen lds
    v_mfma_f32_16x16x32_bf16 v[148:151], a[204:207], a[180:183], v[148:151]
    v_mfma_f32_16x16x32_bf16 v[152:155], a[204:207], a[184:187], v[152:155]
    s_cmp_eq_u32 s26, 1
    s_cbranch_scc0 ka_nopk
    s_waitcnt vmcnt(22)
    v_readfirstlane_b32 s24, v254
    s_lshl_b32 s25, s3, 16
    s_add_u32 s24, s24, s25
    s_cmp_ge_u32 s24, 8
    s_cbranch_scc0 kf_spin39
kf_spinr40:
ka_nopk:
    v_mfma_f32_16x16x32_bf16 v[156:159], a[204:207], a[188:191], v[156:159]
    s_waitcnt vmcnt(24) lgkmcnt(0)
    s_barrier
    v_add_u32 v246, s30, v247
    v_mfma_f32_16x16x32_bf16 v[160:163], a[208:211], a[176:179], v[160:163]
    v_xor_b32 v238, 32, v246
    ds_read_b64_tr_b16 a[192:193], v246 offset:0
    v_mfma_f32_16x16x32_bf16 v[164:167], a[208:211], a[180:183], v[164:167]
    ds_read_b64_tr_b16 a[194:195], v246 offset:1024
    v_mfma_f32_16x16x32_bf16 v[168:171], a[208:211], a[184:187], v[168:171]
    ds_read_b64_tr_b16 a[196:197], v238 offset:0
    v_mfma_f32_16x16x32_bf16 v[172:175], a[208:211], a[188:191], v[172:175]
    ds_read_b64_tr_b16 a[198:199], v238 offset:1024
    v_mfma_f32_16x16x32_bf16 v[176:179], a[212:215], a[176:179], v[176:179]
    ds_read_b64_tr_b16 a[200:201], v246 offset:256
    v_mfma_f32_16x16x32_bf16 v[180:183], a[212:215], a[180:183], v[180:183]
    ds_read_b64_tr_b16 a[202:203], v246 offset:1280
    v_mfma_f32_16x16x32_bf16 v[184:187], a[212:215], a[184:187], v[184:187]
    ds_read_b64_tr_b16 a[204:205], v238 offset:256
    buffer_atomic_add v255, v250, s[88:91], s97 offen sc1
    s_mov_b32 s97, s43
    v_mfma_f32_16x16x32_bf16 v[188:191], a[212:215], a[188:191], v[188:191]
    ds_read_b64_tr_b16 a[206:207], v238 offset:1280
    v_mfma_f32_16x16x32_bf16 v[192:195], a[216:219], a[176:179], v[192:195]
    buffer_load_dwordx4 a[168:171], v249, s[8:11], s28 offen offset:2048 sc1
    v_mfma_f32_16x16x32_bf16 v[196:199], a[216:219], a[180:183], v[196:199]
    v_mfma_f32_16x16x32_bf16 v[200:203], a[216:219], a[184:187], v[200:203]
    buffer_load_dwordx4 a[172:175], v249, s[8:11], s29 offen offset:2048 sc1
    v_mfma_f32_16x16x32_bf16 v[204:207], a[216:219], a[188:191], v[204:207]
    s_add_u32 m0, s31, 7168
    s_add_u32 s24, s27, 229376
    v_mfma_f32_16x16x32_bf16 v[208:211], a[220:223], a[176:179], v[208:211]
    buffer_load_dwordx4 v237, s[12:15], s24 offen lds
    v_mfma_f32_16x16x32_bf16 v[212:215], a[220:223], a[180:183], v[212:215]
    s_add_u32 s27, s27, 1048576
    s_and_b32 s27, s27, 0x407fffff
    v_mfma_f32_16x16x32_bf16 v[216:219], a[220:223], a[184:187], v[216:219]
    s_cmp_eq_u32 s27, s7
    s_cselect_b32 s27, s43, s27
    v_mfma_f32_16x16x32_bf16 v[220:223], a[220:223], a[188:191], v[220:223]
    s_add_u32 s31, s31, 32768
    s_cmp_ge_u32 s31, 163840
    s_cselect_b32 s24, 98304, 0
    s_sub_u32 s31, s31, s24
    s_sub_u32 s26, s26, 1
    s_cmp_lg_u32 s26, 0
    s_cbranch_scc1 ka_qp
    s_waitcnt vmcnt(15) lgkmcnt(0)
    v_mfma_f32_16x16x32_bf16 v[96:99], a[192:195], a[128:131], v[96:99]
    ds_read_b64_tr_b16 a[208:209], v246 offset:512
    s_sub_u32 s42, s32, 17664
    v_mfma_f32_16x16x32_bf16 v[100:103], a[192:195], a[132:135], v[100:103]
    ds_read_b64_tr_b16 a[210:211], v246 offset:1536
    v_mfma_f32_16x16x32_bf16 v[104:107], a[192:195], a[136:139], v[104:107]
    ds_read_b64_tr_b16 a[212:213], v238 offset:512
    s_mov_b32 m0, s34
    s_add_u32 s41, s42, 17664
    v_mfma_f32_16x16x32_bf16 v[108:111], a[192:195], a[140:143], v[108:111]
    ds_read_b64_tr_b16 a[214:215], v238 offset:1536
    v_mfma_f32_16x16x32_bf16 v[112:115], a[196:199], a[128:131], v[112:115]
    ds_read_b64_tr_b16 a[216:217], v246 offset:768
    v_mfma_f32_16x16x32_bf16 v[116:119], a[196:199], a[132:135], v[116:119]
    ds_read_b64_tr_b16 a[218:219], v246 offset:1792
    buffer_load_dwordx4 v242, s[16:19], s41 offen offset:0 sc1 lds
    v_mfma_f32_16x16x32_bf16 v[120:123], a[196:199], a[136:139], v[120:123]
    ds_read_b64_tr_b16 a[220:221], v238 offset:768
    v_mfma_f32_16x16x32_bf16 v[124:127], a[196:199], a[140:143], v[124:127]
    ds_read_b64_tr_b16 a[222:223], v238 offset:1792
    v_mfma_f32_16x16x32_bf16 v[128:131], a[200:203], a[128:131], v[128:131]
    buffer_load_dwordx4 a[176:179], v248, s[8:11], s28 offen offset:3072 sc1
    buffer_load_dwordx4 v242, s[16:19], s41 offen offset:1024 sc1 lds
    v_mfma_f32_16x16x32_bf16 v[132:135], a[200:203], a[132:135], v[132:135]
    v_mfma_f32_16x16x32_bf16 v[136:139], a[200:203], a[136:139], v[136:139]
    buffer_load_dwordx4 a[180:183], v248, s[8:11], s29 offen offset:3072 sc1
    v_mfma_f32_16x16x32_bf16 v[140:143], a[200:203], a[140:143], v[140:143]
    buffer_load_dwordx4 v242, s[16:19], s41 offen offset:2048 sc1 lds
    v_mfma_f32_16x16x32_bf16 v[144:147], a[204:207], a[128:131], v[144:147]
    v_mfma_f32_16x16x32_bf16 v[148:151], a[204:207], a[132:135], v[148:151]
    v_mfma_f32_16x16x32_bf16 v[152:155], a[204:207], a[136:139], v[152:155]
    buffer_load_dwordx4 v242, s[16:19], s41 offen offset:3072 sc1 lds
    v_mfma_f32_16x16x32_bf16 v[156:159], a[204:207], a[140:143], v[156:159]
    s_waitcnt lgkmcnt(0)
    v_mfma_f32_16x16x32_bf16 v[160:163], a[208:211], a[128:131], v[160:163]
    ds_read_b64_tr_b16 a[192:193], v246 offset:8192
    v_mfma_f32_16x16x32_bf16 v[164:167], a[208:211], a[132:135], v[164:167]
    ds_read_b64_tr_b16 a[194:195], v246 offset:9216
    v_mfma_f32_16x16x32_bf16 v[168:171], a[208:211], a[136:139], v[168:171]
    ds_read_b64_tr_b16 a[196:197], v238 offset:8192
    s_add_u32 s34, s34, 32768
    s_cmp_ge_u32 s34, 163840
    s_cselect_b32 s34, s37, s34
    s_add_u32 s42, s42, 34048
    v_mfma_f32_16x16x32_bf16 v[172:175], a[208:211], a[140:143], v[172:175]
    ds_read_b64_tr_b16 a[198:199], v238 offset:9216
    v_mfma_f32_16x16x32_bf16 v[176:179], a[212:215], a[128:131], v[176:179]
    ds_read_b64_tr_b16 a[200:201], v246 offset:8448
    v_mfma_f32_16x16x32_bf16 v[180:183], a[212:215], a[132:135], v[180:183]
    ds_read_b64_tr_b16 a[202:203], v246 offset:9472
    s_mov_b32 m0, s34
    s_add_u32 s41, s42, 17664
    v_mfma_f32_16x16x32_bf16 v[184:187], a[212:215], a[136:139], v[184:187]
    ds_read_b64_tr_b16 a[204:205], v238 offset:8448
    v_mfma_f32_16x16x32_bf16 v[188:191], a[212:215], a[140:143], v[188:191]
    ds_read_b64_tr_b16 a[206:207], v238 offset:9472
    v_mfma_f32_16x16x32_bf16 v[192:195], a[216:219], a[128:131], v[192:195]
    buffer_load_dwordx4 a[184:187], v249, s[8:11], s28 offen offset:3072 sc1
    buffer_load_dwordx4 v242, s[16:19], s41 offen offset:0 sc1 lds
    v_mfma_f32_16x16x32_bf16 v[196:199], a[216:219], a[132:135], v[196:199]
    v_mfma_f32_16x16x32_bf16 v[200:203], a[216:219], a[136:139], v[200:203]
    buffer_load_dwordx4 a[188:191], v249, s[8:11], s29 offen offset:3072 sc1
    v_mfma_f32_16x16x32_bf16 v[204:207], a[216:219], a[140:143], v[204:207]
    buffer_load_dwordx4 v242, s[16:19], s41 offen offset:1024 sc1 lds
    v_mfma_f32_16x16x32_bf16 v[208:211], a[220:223], a[128:131], v[208:211]
    v_mfma_f32_16x16x32_bf16 v[212:215], a[220:223], a[132:135], v[212:215]
    v_mfma_f32_16x16x32_bf16 v[216:219], a[220:223], a[136:139], v[216:219]
    s_add_u32 s28, s28, 4096
    s_and_b32 s28, s28, 32767
    v_mfma_f32_16x16x32_bf16 v[220:223], a[220:223], a[140:143], v[220:223]
    s_add_u32 s29, s28, 32768
    buffer_load_dwordx4 v242, s[16:19], s41 offen offset:2048 sc1 lds
    s_waitcnt vmcnt(20) lgkmcnt(0)
    v_mfma_f32_16x16x32_bf16 v[96:99], a[192:195], a[144:147], v[96:99]
    ds_read_b64_tr_b16 a[208:209], v246 offset:8704
    s_load_dwordx2 s[80:81], s[0:1], 0
    s_load_dwordx2 s[82:83], s[0:1], 56
    s_load_dwordx4 s[84:87], s[0:1], 80
    v_mfma_f32_16x16x32_bf16 v[100:103], a[192:195], a[148:151], v[100:103]
    ds_read_b64_tr_b16 a[210:211], v246 offset:9728
    v_mfma_f32_16x16x32_bf16 v[104:107], a[192:195], a[152:155], v[104:107]
    ds_read_b64_tr_b16 a[212:213], v238 offset:8704
    buffer_load_dwordx4 v242, s[16:19], s41 offen offset:3072 sc1 lds
    v_mfma_f32_16x16x32_bf16 v[108:111], a[192:195], a[156:159], v[108:111]
    ds_read_b64_tr_b16 a[214:215], v238 offset:9728
    v_mfma_f32_16x16x32_bf16 v[112:115], a[196:199], a[144:147], v[112:115]
    ds_read_b64_tr_b16 a[216:217], v246 offset:8960
    v_mfma_f32_16x16x32_bf16 v[116:119], a[196:199], a[148:151], v[116:119]
    ds_read_b64_tr_b16 a[218:219], v246 offset:9984
    s_add_u32 m0, s34, 16384
    s_add_u32 s34, s34, 32768
    s_cmp_ge_u32 s34, 163840
    s_cselect_b32 s34, s37, s34
    v_mfma_f32_16x16x32_bf16 v[120:123], a[196:199], a[152:155], v[120:123]
    ds_read_b64_tr_b16 a[220:221], v238 offset:8960
    v_mfma_f32_16x16x32_bf16 v[124:127], a[196:199], a[156:159], v[124:127]
    ds_read_b64_tr_b16 a[222:223], v238 offset:9984
    v_mfma_f32_16x16x32_bf16 v[128:131], a[200:203], a[144:147], v[128:131]
    buffer_load_dwordx4 v242, s[16:19], s42 offen offset:0 sc1 lds
    v_mov_b32 v241, v239
    v_mfma_f32_16x16x32_bf16 v[132:135], a[200:203], a[148:151], v[132:135]
    v_lshrrev_b32 v230, 7, v240
    v_mfma_f32_16x16x32_bf16 v[136:139], a[200:203], a[152:155], v[136:139]
    v_mul_u32_u24 v253, 7168, v230
    v_mfma_f32_16x16x32_bf16 v[140:143], a[200:203], a[156:159], v[140:143]
    v_and_b32 v231, 0x70, v240
    v_mfma_f32_16x16x32_bf16 v[144:147], a[204:207], a[144:147], v[144:147]
    buffer_load_dwordx4 v242, s[16:19], s42 offen offset:1024 sc1 lds
    v_mfma_f32_16x16x32_bf16 v[148:151], a[204:207], a[148:151], v[148:151]
    v_add_u32 v253, v253, v231
    v_mfma_f32_16x16x32_bf16 v[152:155], a[204:207], a[152:155], v[152:155]
    v_lshlrev_b32 v255, 5, v230
    v_mfma_f32_16x16x32_bf16 v[156:159], a[204:207], a[156:159], v[156:159]
    buffer_load_dwordx4 v242, s[16:19], s42 offen offset:2048 sc1 lds
    s_waitcnt lgkmcnt(0)
    v_mfma_f32_16x16x32_bf16 v[160:163], a[208:211], a[144:147], v[160:163]
    ds_read_b64_tr_b16 a[192:193], v246 offset:16384
    v_and_b32 v230, 16, v240
    v_mfma_f32_16x16x32_bf16 v[164:167], a[208:211], a[148:151], v[164:167]
    ds_read_b64_tr_b16 a[194:195], v246 offset:17408
    v_mfma_f32_16x16x32_bf16 v[168:171], a[208:211], a[152:155], v[168:171]
    ds_read_b64_tr_b16 a[196:197], v238 offset:16384
    buffer_load_dwordx4 v242, s[16:19], s42 offen offset:3072 sc1 lds
    s_add_u32 s42, s42, 34048
    v_mfma_f32_16x16x32_bf16 v[172:175], a[208:211], a[156:159], v[172:175]
    ds_read_b64_tr_b16 a[198:199], v238 offset:17408
    v_add_u32 v255, v255, v230
    v_mfma_f32_16x16x32_bf16 v[176:179], a[212:215], a[144:147], v[176:179]
    ds_read_b64_tr_b16 a[200:201], v246 offset:16640
    v_mfma_f32_16x16x32_bf16 v[180:183], a[212:215], a[148:151], v[180:183]
    ds_read_b64_tr_b16 a[202:203], v246 offset:17664
    s_mov_b32 m0, s34
    s_add_u32 s41, s42, 17664
    v_mfma_f32_16x16x32_bf16 v[184:187], a[212:215], a[152:155], v[184:187]
    ds_read_b64_tr_b16 a[204:205], v238 offset:16640
    v_lshrrev_b32 v231, 5, v231
    v_mfma_f32_16x16x32_bf16 v[188:191], a[212:215], a[156:159], v[188:191]
    ds_read_b64_tr_b16 a[206:207], v238 offset:17664
    v_mfma_f32_16x16x32_bf16 v[192:195], a[216:219], a[144:147], v[192:195]
    buffer_load_dwordx4 v242, s[16:19], s41 offen offset:0 sc1 lds
    v_lshl_add_u32 v255, v231, 16, v255
    v_mfma_f32_16x16x32_bf16 v[196:199], a[216:219], a[148:151], v[196:199]
    v_mov_b32 v64, 0
    v_mfma_f32_16x16x32_bf16 v[200:203], a[216:219], a[152:155], v[200:203]
    v_mov_b32 v65, 0
    v_mfma_f32_16x16x32_bf16 v[204:207], a[216:219], a[156:159], v[204:207]
    v_mov_b32 v66, 0
    v_mfma_f32_16x16x32_bf16 v[208:211], a[220:223], a[144:147], v[208:211]
    buffer_load_dwordx4 v242, s[16:19], s41 offen offset:1024 sc1 lds
    v_mfma_f32_16x16x32_bf16 v[212:215], a[220:223], a[148:151], v[212:215]
    v_mov_b32 v67, 0
    v_mfma_f32_16x16x32_bf16 v[216:219], a[220:223], a[152:155], v[216:219]
    v_mov_b32 v68, 0
    v_mfma_f32_16x16x32_bf16 v[220:223], a[220:223], a[156:159], v[220:223]
    buffer_load_dwordx4 v242, s[16:19], s41 offen offset:2048 sc1 lds
    s_waitcnt vmcnt(20) lgkmcnt(0)
    v_mfma_f32_16x16x32_bf16 v[96:99], a[192:195], a[160:163], v[96:99]
    ds_read_b64_tr_b16 a[208:209], v246 offset:16896
    v_mov_b32 v69, 0
    v_mfma_f32_16x16x32_bf16 v[100:103], a[192:195], a[164:167], v[100:103]
    ds_read_b64_tr_b16 a[210:211], v246 offset:17920
    v_mfma_f32_16x16x32_bf16 v[104:107], a[192:195], a[168:171], v[104:107]
    ds_read_b64_tr_b16 a[212:213], v238 offset:16896
    buffer_load_dwordx4 v242, s[16:19], s41 offen offset:3072 sc1 lds
    v_mfma_f32_16x16x32_bf16 v[108:111], a[192:195], a[172:175], v[108:111]
    ds_read_b64_tr_b16 a[214:215], v238 offset:17920
    v_mov_b32 v70, 0
    v_mfma_f32_16x16x32_bf16 v[112:115], a[196:199], a[160:163], v[112:115]
    ds_read_b64_tr_b16 a[216:217], v246 offset:17152
    v_mfma_f32_16x16x32_bf16 v[116:119], a[196:199], a[164:167], v[116:119]
    ds_read_b64_tr_b16 a[218:219], v246 offset:18176
    s_add_u32 m0, s34, 16384
    s_add_u32 s34, s34, 32768
    s_cmp_ge_u32 s34, 163840
    s_cselect_b32 s34, s37, s34
    v_mfma_f32_16x16x32_bf16 v[120:123], a[196:199], a[168:171], v[120:123]
    ds_read_b64_tr_b16 a[220:221], v238 offset:17152
    v_mov_b32 v71, 0
    v_mfma_f32_16x16x32_bf16 v[124:127], a[196:199], a[172:175], v[124:127]
    ds_read_b64_tr_b16 a[222:223], v238 offset:18176
    v_mfma_f32_16x16x32_bf16 v[128:131], a[200:203], a[160:163], v[128:131]
    v_mov_b32 v72, 0
    v_mfma_f32_16x16x32_bf16 v[132:135], a[200:203], a[164:167], v[132:135]
    buffer_load_dwordx4 v242, s[16:19], s42 offen offset:0 sc1 lds
    v_mov_b32 v73, 0
    v_mfma_f32_16x16x32_bf16 v[136:139], a[200:203], a[168:171], v[136:139]
    v_mov_b32 v74, 0
    v_mfma_f32_16x16x32_bf16 v[140:143], a[200:203], a[172:175], v[140:143]
    v_mov_b32 v75, 0
    v_mfma_f32_16x16x32_bf16 v[144:147], a[204:207], a[160:163], v[144:147]
    buffer_load_dwordx4 v242, s[16:19], s42 offen offset:1024 sc1 lds
    v_mfma_f32_16x16x32_bf16 v[148:151], a[204:207], a[164:167], v[148:151]
    v_mov_b32 v76, 0
    v_mfma_f32_16x16x32_bf16 v[152:155], a[204:207], a[168:171], v[152:155]
    v_mov_b32 v77, 0
    v_mfma_f32_16x16x32_bf16 v[156:159], a[204:207], a[172:175], v[156:159]
    buffer_load_dwordx4 v242, s[16:19], s42 offen offset:2048 sc1 lds
    s_waitcnt lgkmcnt(0)
    v_mfma_f32_16x16x32_bf16 v[160:163], a[208:211], a[160:163], v[160:163]
    ds_read_b64_tr_b16 a[192:193], v246 offset:24576
    v_mov_b32 v78, 0
    v_mfma_f32_16x16x32_bf16 v[164:167], a[208:211], a[164:167], v[164:167]
    ds_read_b64_tr_b16 a[194:195], v246 offset:25600
    v_mfma_f32_16x16x32_bf16 v[168:171], a[208:211], a[168:171], v[168:171]
    ds_read_b64_tr_b16 a[196:197], v238 offset:24576
    buffer_load_dwordx4 v242, s[16:19], s42 offen offset:3072 sc1 lds
    s_add_u32 s42, s42, 34048
    v_mfma_f32_16x16x32_bf16 v[172:175], a[208:211], a[172:175], v[172:175]
    ds_read_b64_tr_b16 a[198:199], v238 offset:25600
    v_mov_b32 v79, 0
    v_mfma_f32_16x16x32_bf16 v[176:179], a[212:215], a[160:163], v[176:179]
    ds_read_b64_tr_b16 a[200:201], v246 offset:24832
    v_mfma_f32_16x16x32_bf16 v[180:183], a[212:215], a[164:167], v[180:183]
    ds_read_b64_tr_b16 a[202:203], v246 offset:25856
    v_mov_b32 v228, 0
    v_mfma_f32_16x16x32_bf16 v[184:187], a[212:215], a[168:171], v[184:187]
    ds_read_b64_tr_b16 a[204:205], v238 offset:24832
    v_mfma_f32_16x16x32_bf16 v[188:191], a[212:215], a[172:175], v[188:191]
    ds_read_b64_tr_b16 a[206:207], v238 offset:25856
    v_mov_b32 v226, 0
    v_mfma_f32_16x16x32_bf16 v[192:195], a[216:219], a[160:163], v[192:195]
    v_mov_b32 v80, 0
    v_mfma_f32_16x16x32_bf16 v[196:199], a[216:219], a[164:167], v[196:199]
    v_mov_b32 v81, 0
    v_mfma_f32_16x16x32_bf16 v[200:203], a[216:219], a[168:171], v[200:203]
    v_mov_b32 v82, 0
    v_mfma_f32_16x16x32_bf16 v[204:207], a[216:219], a[172:175], v[204:207]
    v_mov_b32 v83, 0
    v_mfma_f32_16x16x32_bf16 v[208:211], a[220:223], a[160:163], v[208:211]
    v_mov_b32 v84, 0
    v_mfma_f32_16x16x32_bf16 v[212:215], a[220:223], a[164:167], v[212:215]
    v_mov_b32 v85, 0
    v_mfma_f32_16x16x32_bf16 v[216:219], a[220:223], a[168:171], v[216:219]
    v_mov_b32 v86, 0
    v_mfma_f32_16x16x32_bf16 v[220:223], a[220:223], a[172:175], v[220:223]
    s_waitcnt vmcnt(15) lgkmcnt(0)
    v_mfma_f32_16x16x32_bf16 v[96:99], a[192:195], a[176:179], v[96:99]
    ds_read_b64_tr_b16 a[208:209], v246 offset:25088
    v_mov_b32 v87, 0
    v_mfma_f32_16x16x32_bf16 v[100:103], a[192:195], a[180:183], v[100:103]
    ds_read_b64_tr_b16 a[210:211], v246 offset:26112
    v_mfma_f32_16x16x32_bf16 v[104:107], a[192:195], a[184:187], v[104:107]
    ds_read_b64_tr_b16 a[212:213], v238 offset:25088
    v_mov_b32 v88, 0
    v_mfma_f32_16x16x32_bf16 v[108:111], a[192:195], a[188:191], v[108:111]
    ds_read_b64_tr_b16 a[214:215], v238 offset:26112
    v_mfma_f32_16x16x32_bf16 v[112:115], a[196:199], a[176:179], v[112:115]
    ds_read_b64_tr_b16 a[216:217], v246 offset:25344
    v_mov_b32 v89, 0
    v_mfma_f32_16x16x32_bf16 v[116:119], a[196:199], a[180:183], v[116:119]
    ds_read_b64_tr_b16 a[218:219], v246 offset:26368
    v_mfma_f32_16x16x32_bf16 v[120:123], a[196:199], a[184:187], v[120:123]
    ds_read_b64_tr_b16 a[220:221], v238 offset:25344
    v_mov_b32 v90, 0
    v_mfma_f32_16x16x32_bf16 v[124:127], a[196:199], a[188:191], v[124:127]
    ds_read_b64_tr_b16 a[222:223], v238 offset:26368
    v_mfma_f32_16x16x32_bf16 v[128:131], a[200:203], a[176:179], v[128:131]
    v_mov_b32 v91, 0
    v_mfma_f32_16x16x32_bf16 v[132:135], a[200:203], a[180:183], v[132:135]
    v_mov_b32 v92, 0
    v_mfma_f32_16x16x32_bf16 v[136:139], a[200:203], a[184:187], v[136:139]
    v_mov_b32 v93, 0
    v_mfma_f32_16x16x32_bf16 v[140:143], a[200:203], a[188:191], v[140:143]
    v_mov_b32 v94, 0
    v_mfma_f32_16x16x32_bf16 v[144:147], a[204:207], a[176:179], v[144:147]
    v_mov_b32 v95, 0
    v_mfma_f32_16x16x32_bf16 v[148:151], a[204:207], a[180:183], v[148:151]
    v_mov_b32 v229, 0
    v_mfma_f32_16x16x32_bf16 v[152:155], a[204:207], a[184:187], v[152:155]
    v_mov_b32 v227, 0
    v_mfma_f32_16x16x32_bf16 v[156:159], a[204:207], a[188:191], v[156:159]
    s_waitcnt vmcnt(8) lgkmcnt(0)
    s_barrier
    v_mfma_f32_16x16x32_bf16 v[160:163], a[208:211], a[176:179], v[160:163]
    ds_read_b128 a[192:195], v241 offset:0
    s_mov_b32 m0, s34
    s_add_u32 s41, s42, 17664
    v_mfma_f32_16x16x32_bf16 v[164:167], a[208:211], a[180:183], v[164:167]
    ds_read_b128 a[196:199], v241 offset:512
    buffer_load_dwordx4 v242, s[16:19], s41 offen offset:0 sc1 lds
    v_mfma_f32_16x16x32_bf16 v[168:171], a[208:211], a[184:187], v[168:171]
    ds_read_b128 a[200:203], v241 offset:2048
    v_mfma_f32_16x16x32_bf16 v[172:175], a[208:211], a[188:191], v[172:175]
    ds_read_b128 a[204:207], v241 offset:2560
    buffer_load_dwordx4 v242, s[16:19], s41 offen offset:1024 sc1 lds
    v_mfma_f32_16x16x32_bf16 v[176:179], a[212:215], a[176:179], v[176:179]
    ds_read_b128 a[224:227], v241 offset:8192
    buffer_load_dwordx4 v242, s[16:19], s41 offen offset:2048 sc1 lds
    v_mfma_f32_16x16x32_bf16 v[180:183], a[212:215], a[180:183], v[180:183]
    ds_read_b128 a[228:231], v241 offset:8704
    v_mfma_f32_16x16x32_bf16 v[184:187], a[212:215], a[184:187], v[184:187]
    ds_read_b128 a[232:235], v241 offset:10240
    buffer_load_dwordx4 v242, s[16:19], s41 offen offset:3072 sc1 lds
    v_mfma_f32_16x16x32_bf16 v[188:191], a[212:215], a[188:191], v[188:191]
    ds_read_b128 a[236:239], v241 offset:10752
    v_mfma_f32_16x16x32_bf16 v[192:195], a[216:219], a[176:179], v[192:195]
    ds_read_b128 a[240:243], v241 offset:12288
    s_add_u32 m0, s34, 16384
    s_add_u32 s34, s34, 32768
    s_cmp_ge_u32 s34, 163840
    s_cselect_b32 s34, s37, s34
    v_mfma_f32_16x16x32_bf16 v[196:199], a[216:219], a[180:183], v[196:199]
    ds_read_b128 a[244:247], v241 offset:12800
    buffer_load_dwordx4 v242, s[16:19], s42 offen offset:0 sc1 lds
    v_mfma_f32_16x16x32_bf16 v[200:203], a[216:219], a[184:187], v[200:203]
    ds_read_b128 a[248:251], v241 offset:14336
    v_mfma_f32_16x16x32_bf16 v[204:207], a[216:219], a[188:191], v[204:207]
    ds_read_b128 a[252:255], v241 offset:14848
    buffer_load_dwordx4 v242, s[16:19], s42 offen offset:1024 sc1 lds
    v_mfma_f32_16x16x32_bf16 v[208:211], a[220:223], a[176:179], v[208:211]
    buffer_load_dwordx4 v242, s[16:19], s42 offen offset:2048 sc1 lds
    v_mfma_f32_16x16x32_bf16 v[212:215], a[220:223], a[180:183], v[212:215]
    v_mfma_f32_16x16x32_bf16 v[216:219], a[220:223], a[184:187], v[216:219]
    buffer_load_dwordx4 v242, s[16:19], s42 offen offset:3072 sc1 lds
    s_add_u32 s42, s42, 34048
    v_mfma_f32_16x16x32_bf16 v[220:223], a[220:223], a[188:191], v[220:223]
    s_mov_b32 s25, 0x3e0293ee
    s_waitcnt lgkmcnt(8)
    ds_read_b128 a[208:211], v241 offset:4096
    ds_read_b128 a[212:215], v241 offset:4608
    ds_read_b128 a[216:219], v241 offset:6144
    ds_read_b128 a[220:223], v241 offset:6656
    s_sub_u32 s36, s36, 1
    s_cbranch_scc1 kf_fix1
kf_fixr2:
    v_cvt_pk_bf16_f32 v96, v96, v97
    v_cvt_pk_bf16_f32 v97, v98, v99
    v_cvt_pk_bf16_f32 v100, v100, v101
    v_cvt_pk_bf16_f32 v101, v102, v103
    v_cvt_pk_bf16_f32 v104, v104, v105
    v_cvt_pk_bf16_f32 v105, v106, v107
    v_cvt_pk_bf16_f32 v108, v108, v109
    v_cvt_pk_bf16_f32 v109, v110, v111
    v_permlane16_swap_b32 v96, v100
    v_permlane16_swap_b32 v97, v101
    v_permlane16_swap_b32 v104, v108
    v_permlane16_swap_b32 v105, v109
    v_accvgpr_write_b32 a128, v96
    v_accvgpr_write_b32 a129, v97
    v_accvgpr_write_b32 a130, v100
    v_accvgpr_write_b32 a131, v101
    v_accvgpr_write_b32 a160, v104
    v_accvgpr_write_b32 a161, v105
    v_accvgpr_write_b32 a162, v108
    v_accvgpr_write_b32 a163, v109
    v_cvt_pk_bf16_f32 v112, v112, v113
    v_cvt_pk_bf16_f32 v113, v114, v115
    v_cvt_pk_bf16_f32 v116, v116, v117
    v_cvt_pk_bf16_f32 v117, v118, v119
    v_cvt_pk_bf16_f32 v120, v120, v121
    v_cvt_pk_bf16_f32 v121, v122, v123
    v_cvt_pk_bf16_f32 v124, v124, v125
    v_cvt_pk_bf16_f32 v125, v126, v127
    v_permlane16_swap_b32 v112, v116
    v_permlane16_swap_b32 v113, v117
    v_permlane16_swap_b32 v120, v124
    v_permlane16_swap_b32 v121, v125
    v_accvgpr_write_b32 a132, v112
    v_accvgpr_write_b32 a133, v113
    v_accvgpr_write_b32 a134, v116
    v_accvgpr_write_b32 a135, v117
    v_accvgpr_write_b32 a164, v120
    v_accvgpr_write_b32 a165, v121
    v_accvgpr_write_b32 a166, v124
    v_accvgpr_write_b32 a167, v125
    s_nop 1
    v_mfma_f32_32x32x16_bf16 v[0:15], a[192:195], a[128:131], v[64:79]
    v_cvt_pk_bf16_f32 v128, v128, v129
    v_cvt_pk_bf16_f32 v129, v130, v131
    v_cvt_pk_bf16_f32 v132, v132, v133
    v_cvt_pk_bf16_f32 v133, v134, v135
    v_cvt_pk_bf16_f32 v136, v136, v137
    v_cvt_pk_bf16_f32 v137, v138, v139
    v_cvt_pk_bf16_f32 v140, v140, v141
    v_cvt_pk_bf16_f32 v141, v142, v143
    v_permlane16_swap_b32 v128, v132
    v_permlane16_swap_b32 v129, v133
    v_mfma_f32_32x32x16_bf16 v[16:31], a[192:195], a[160:163], v[80:95]
    v_permlane16_swap_b32 v136, v140
    v_permlane16_swap_b32 v137, v141
    v_accvgpr_write_b32 a136, v128
    v_accvgpr_write_b32 a137, v129
    v_accvgpr_write_b32 a138, v132
    v_accvgpr_write_b32 a139, v133
    v_accvgpr_write_b32 a168, v136
    v_accvgpr_write_b32 a169, v137
    v_accvgpr_write_b32 a170, v140
    v_accvgpr_write_b32 a171, v141
    v_mfma_f32_32x32x16_bf16 v[0:15], a[196:199], a[132:135], v[0:15]
    v_cvt_pk_bf16_f32 v144, v144, v145
    v_cvt_pk_bf16_f32 v145, v146, v147
    v_cvt_pk_bf16_f32 v148, v148, v149
    v_cvt_pk_bf16_f32 v149, v150, v151
    v_cvt_pk_bf16_f32 v152, v152, v153
    v_cvt_pk_bf16_f32 v153, v154, v155
    v_cvt_pk_bf16_f32 v156, v156, v157
    v_cvt_pk_bf16_f32 v157, v158, v159
    v_permlane16_swap_b32 v144, v148
    v_permlane16_swap_b32 v145, v149
    v_mfma_f32_32x32x16_bf16 v[16:31], a[196:199], a[164:167], v[16:31]
    v_permlane16_swap_b32 v152, v156
    v_permlane16_swap_b32 v153, v157
    v_accvgpr_write_b32 a140, v144
    v_accvgpr_write_b32 a141, v145
    v_accvgpr_write_b32 a142, v148
    v_accvgpr_write_b32 a143, v149
    v_accvgpr_write_b32 a172, v152
    v_accvgpr_write_b32 a173, v153
    v_accvgpr_write_b32 a174, v156
    v_accvgpr_write_b32 a175, v157
    s_nop 1
    v_mfma_f32_32x32x16_bf16 v[0:15], a[200:203], a[136:139], v[0:15]
    v_cvt_pk_bf16_f32 v160, v160, v161
    v_cvt_pk_bf16_f32 v161, v162, v163
    v_cvt_pk_bf16_f32 v164, v164, v165
    v_cvt_pk_bf16_f32 v165, v166, v167
    v_cvt_pk_bf16_f32 v168, v168, v169
    v_cvt_pk_bf16_f32 v169, v170, v171
    v_cvt_pk_bf16_f32 v172, v172, v173
    v_cvt_pk_bf16_f32 v173, v174, v175
    v_permlane16_swap_b32 v160, v164
    v_permlane16_swap_b32 v161, v165
    v_mfma_f32_32x32x16_bf16 v[16:31], a[200:203], a[168:171], v[16:31]
    v_permlane16_swap_b32 v168, v172
    v_permlane16_swap_b32 v169, v173
    v_accvgpr_write_b32 a144, v160
    v_accvgpr_write_b32 a145, v161
    v_accvgpr_write_b32 a146, v164
    v_accvgpr_write_b32 a147, v165
    v_accvgpr_write_b32 a176, v168
    v_accvgpr_write_b32 a177, v169
    v_accvgpr_write_b32 a178, v172
    v_accvgpr_write_b32 a179, v173
    v_mfma_f32_32x32x16_bf16 v[0:15], a[204:207], a[140:143], v[0:15]
    v_cvt_pk_bf16_f32 v176, v176, v177
    v_cvt_pk_bf16_f32 v177, v178, v179
    v_cvt_pk_bf16_f32 v180, v180, v181
    v_cvt_pk_bf16_f32 v181, v182, v183
    v_cvt_pk_bf16_f32 v184, v184, v185
    v_cvt_pk_bf16_f32 v185, v186, v187
    v_cvt_pk_bf16_f32 v188, v188, v189
    v_cvt_pk_bf16_f32 v189, v190, v191
    v_permlane16_swap_b32 v176, v180
    v_permlane16_swap_b32 v177, v181
    v_mfma_f32_32x32x16_bf16 v[16:31], a[204:207], a[172:175], v[16:31]
    v_permlane16_swap_b32 v184, v188
    v_permlane16_swap_b32 v185, v189
    v_accvgpr_write_b32 a148, v176
    v_accvgpr_write_b32 a149, v177
    v_accvgpr_write_b32 a150, v180
    v_accvgpr_write_b32 a151, v181
    v_accvgpr_write_b32 a180, v184
    v_accvgpr_write_b32 a181, v185
    v_accvgpr_write_b32 a182, v188
    v_accvgpr_write_b32 a183, v189
    s_nop 1
    s_waitcnt lgkmcnt(0)
    v_mfma_f32_32x32x16_bf16 v[0:15], a[208:211], a[144:147], v[0:15]
    v_cvt_pk_bf16_f32 v192, v192, v193
    v_cvt_pk_bf16_f32 v193, v194, v195
    v_cvt_pk_bf16_f32 v196, v196, v197
    v_cvt_pk_bf16_f32 v197, v198, v199
    v_cvt_pk_bf16_f32 v200, v200, v201
    v_cvt_pk_bf16_f32 v201, v202, v203
    v_cvt_pk_bf16_f32 v204, v204, v205
    v_cvt_pk_bf16_f32 v205, v206, v207
    v_permlane16_swap_b32 v192, v196
    v_permlane16_swap_b32 v193, v197
    v_mfma_f32_32x32x16_bf16 v[16:31], a[208:211], a[176:179], v[16:31]
    v_permlane16_swap_b32 v200, v204
    v_permlane16_swap_b32 v201, v205
    v_accvgpr_write_b32 a152, v192
    v_accvgpr_write_b32 a153, v193
    v_accvgpr_write_b32 a154, v196
    v_accvgpr_write_b32 a155, v197
    v_accvgpr_write_b32 a184, v200
    v_accvgpr_write_b32 a185, v201
    v_accvgpr_write_b32 a186, v204
    v_accvgpr_write_b32 a187, v205
    v_mfma_f32_32x32x16_bf16 v[0:15], a[212:215], a[148:151], v[0:15]
    v_cvt_pk_bf16_f32 v208, v208, v209
    v_cvt_pk_bf16_f32 v209, v210, v211
    v_cvt_pk_bf16_f32 v212, v212, v213
    v_cvt_pk_bf16_f32 v213, v214, v215
    v_cvt_pk_bf16_f32 v216, v216, v217
    v_cvt_pk_bf16_f32 v217, v218, v219
    v_cvt_pk_bf16_f32 v220, v220, v221
    v_cvt_pk_bf16_f32 v221, v222, v223
    v_permlane16_swap_b32 v208, v212
    v_permlane16_swap_b32 v209, v213
    v_mfma_f32_32x32x16_bf16 v[16:31], a[212:215], a[180:183], v[16:31]
    v_permlane16_swap_b32 v216, v220
    v_permlane16_swap_b32 v217, v221
    v_accvgpr_write_b32 a156, v208
    v_accvgpr_write_b32 a157, v209
    v_accvgpr_write_b32 a158, v212
    v_accvgpr_write_b32 a159, v213
    v_accvgpr_write_b32 a188, v216
    v_accvgpr_write_b32 a189, v217
    v_accvgpr_write_b32 a190, v220
    v_accvgpr_write_b32 a191, v221
    s_nop 1
    v_mfma_f32_32x32x16_bf16 v[0:15], a[216:219], a[152:155], v[0:15]
    v_mfma_f32_32x32x16_bf16 v[16:31], a[216:219], a[184:187], v[16:31]
    v_mfma_f32_32x32x16_bf16 v[0:15], a[220:223], a[156:159], v[0:15]
    v_mfma_f32_32x32x16_bf16 v[16:31], a[220:223], a[188:191], v[16:31]
    s_nop 11
    v_max3_f32 v230, v0, v1, v2
    v_max3_f32 v232, v16, v17, v18
    v_max3_f32 v230, v230, v3, v4
    v_max3_f32 v232, v232, v19, v20
    v_max3_f32 v230, v230, v5, v6
    v_max3_f32 v232, v232, v21, v22
    v_max3_f32 v230, v230, v7, v8
    v_max3_f32 v232, v232, v23, v24
    v_max3_f32 v230, v230, v9, v10
    v_max3_f32 v232, v232, v25, v26
    v_max3_f32 v230, v230, v11, v12
    v_max3_f32 v232, v232, v27, v28
    v_max3_f32 v230, v230, v13, v14
    v_max3_f32 v232, v232, v29, v30
    v_max_f32 v230, v230, v15
    v_max_f32 v232, v232, v31
    v_mov_b32 v231, v230
    v_mov_b32 v233, v232
    s_nop 1
    s_nop 1
    v_permlane32_swap_b32 v230, v231
    v_permlane32_swap_b32 v232, v233
    s_nop 0
    s_nop 0
    v_max_f32 v230, v230, v231
    v_max_f32 v232, v232, v233
    v_sub_f32 v228, 0, v230
    v_sub_f32 v64, v64, v230
    v_sub_f32 v65, v65, v230
    v_sub_f32 v66, v66, v230
    v_sub_f32 v67, v67, v230
    v_sub_f32 v68, v68, v230
    v_sub_f32 v69, v69, v230
    v_sub_f32 v70, v70, v230
    v_sub_f32 v71, v71, v230
    v_sub_f32 v72, v72, v230
    v_sub_f32 v73, v73, v230
    v_sub_f32 v74, v74, v230
    v_sub_f32 v75, v75, v230
    v_sub_f32 v76, v76, v230
    v_sub_f32 v77, v77, v230
    v_sub_f32 v78, v78, v230
    v_sub_f32 v79, v79, v230
    v_sub_f32 v229, 0, v232
    v_sub_f32 v80, v80, v232
    v_sub_f32 v81, v81, v232
    v_sub_f32 v82, v82, v232
    v_sub_f32 v83, v83, v232
    v_sub_f32 v84, v84, v232
    v_sub_f32 v85, v85, v232
    v_sub_f32 v86, v86, v232
    v_sub_f32 v87, v87, v232
    v_sub_f32 v88, v88, v232
    v_sub_f32 v89, v89, v232
    v_sub_f32 v90, v90, v232
    v_sub_f32 v91, v91, v232
    v_sub_f32 v92, v92, v232
    v_sub_f32 v93, v93, v232
    v_sub_f32 v94, v94, v232
    v_sub_f32 v95, v95, v232
    v_sub_f32 v0, v0, v230
    v_sub_f32 v1, v1, v230
    v_sub_f32 v2, v2, v230
    v_sub_f32 v3, v3, v230
    v_sub_f32 v4, v4, v230
    v_sub_f32 v5, v5, v230
    v_sub_f32 v6, v6, v230
    v_sub_f32 v7, v7, v230
    v_sub_f32 v8, v8, v230
    v_sub_f32 v9, v9, v230
    v_sub_f32 v10, v10, v230
    v_sub_f32 v11, v11, v230
    v_sub_f32 v12, v12, v230
    v_sub_f32 v13, v13, v230
    v_sub_f32 v14, v14, v230
    v_sub_f32 v15, v15, v230
    v_sub_f32 v16, v16, v232
    v_sub_f32 v17, v17, v232
    v_sub_f32 v18, v18, v232
    v_sub_f32 v19, v19, v232
    v_sub_f32 v20, v20, v232
    v_sub_f32 v21, v21, v232
    v_sub_f32 v22, v22, v232
    v_sub_f32 v23, v23, v232
    v_sub_f32 v24, v24, v232
    v_sub_f32 v25, v25, v232
    v_sub_f32 v26, v26, v232
    v_sub_f32 v27, v27, v232
    v_sub_f32 v28, v28, v232
    v_sub_f32 v29, v29, v232
    v_sub_f32 v30, v30, v232
    v_sub_f32 v31, v31, v232
    s_mov_b32 s35, 32768
    v_add_u32 v241, s35, v239
    s_sub_u32 s36, s36, 1
    s_cbranch_scc1 kf_fix3
kf_fixr4:
    v_mfma_f32_32x32x16_bf16 v[32:47], a[224:227], a[128:131], v[64:79]
    ds_read_b128 a[192:195], v241 offset:0
    v_exp_f32 v136, v0
    v_exp_f32 v137, v1
    v_exp_f32 v130, v2
    v_mfma_f32_32x32x16_bf16 v[48:63], a[224:227], a[160:163], v[80:95]
    v_exp_f32 v131, v3
    v_cvt_pk_bf16_f32 v96, v136, v137
    v_exp_f32 v132, v4
    v_exp_f32 v133, v5
    v_cvt_pk_bf16_f32 v97, v130, v131
    v_add_f32 v136, v136, v130
    v_mfma_f32_32x32x16_bf16 v[32:47], a[228:231], a[132:135], v[32:47]
    ds_read_b128 a[196:199], v241 offset:512
    v_add_f32 v137, v137, v131
    v_exp_f32 v134, v6
    v_exp_f32 v135, v7
    v_cvt_pk_bf16_f32 v98, v132, v133
    v_mfma_f32_32x32x16_bf16 v[48:63], a[228:231], a[164:167], v[48:63]
    v_add_f32 v136, v136, v132
    v_add_f32 v137, v137, v133
    v_exp_f32 v128, v8
    v_exp_f32 v129, v9
    v_cvt_pk_bf16_f32 v99, v134, v135
    v_add_f32 v136, v136, v134
    v_add_f32 v137, v137, v135
    v_mfma_f32_32x32x16_bf16 v[32:47], a[232:235], a[136:139], v[32:47]
    ds_read_b128 a[200:203], v241 offset:2048
    v_exp_f32 v130, v10
    v_exp_f32 v131, v11
    v_cvt_pk_bf16_f32 v100, v128, v129
    v_add_f32 v136, v136, v128
    v_mfma_f32_32x32x16_bf16 v[48:63], a[232:235], a[168:171], v[48:63]
    v_add_f32 v137, v137, v129
    v_exp_f32 v132, v12
    v_exp_f32 v133, v13
    v_cvt_pk_bf16_f32 v101, v130, v131
    v_add_f32 v136, v136, v130
    v_add_f32 v137, v137, v131
    v_mfma_f32_32x32x16_bf16 v[32:47], a[236:239], a[140:143], v[32:47]
    ds_read_b128 a[204:207], v241 offset:2560
    v_exp_f32 v134, v14
    v_exp_f32 v135, v15
    v_cvt_pk_bf16_f32 v102, v132, v133
    v_add_f32 v136, v136, v132
    v_add_f32 v137, v137, v133
    v_mfma_f32_32x32x16_bf16 v[48:63], a[236:239], a[172:175], v[48:63]
    v_exp_f32 v138, v16
    v_exp_f32 v139, v17
    v_cvt_pk_bf16_f32 v103, v134, v135
    v_add_f32 v136, v136, v134
    v_add_f32 v137, v137, v135
    v_add_f32 v224, v136, v137
    v_mfma_f32_32x32x16_bf16 v[32:47], a[240:243], a[144:147], v[32:47]
    ds_read_b128 a[208:211], v241 offset:4096
    v_exp_f32 v130, v18
    v_exp_f32 v131, v19
    v_cvt_pk_bf16_f32 v104, v138, v139
    v_exp_f32 v132, v20
    v_mfma_f32_32x32x16_bf16 v[48:63], a[240:243], a[176:179], v[48:63]
    v_exp_f32 v133, v21
    v_cvt_pk_bf16_f32 v105, v130, v131
    v_add_f32 v138, v138, v130
    v_add_f32 v139, v139, v131
    v_exp_f32 v134, v22
    v_mfma_f32_32x32x16_bf16 v[32:47], a[244:247], a[148:151], v[32:47]
    ds_read_b128 a[212:215], v241 offset:4608
    v_exp_f32 v135, v23
    v_cvt_pk_bf16_f32 v106, v132, v133
    v_add_f32 v138, v138, v132
    v_add_f32 v139, v139, v133
    v_exp_f32 v128, v24
    v_mfma_f32_32x32x16_bf16 v[48:63], a[244:247], a[180:183], v[48:63]
    v_exp_f32 v129, v25
    v_cvt_pk_bf16_f32 v107, v134, v135
    v_add_f32 v138, v138, v134
    v_add_f32 v139, v139, v135
    v_exp_f32 v130, v26
    v_exp_f32 v131, v27
    v_mfma_f32_32x32x16_bf16 v[32:47], a[248:251], a[152:155], v[32:47]
    ds_read_b128 a[216:219], v241 offset:6144
    v_cvt_pk_bf16_f32 v108, v128, v129
    v_add_f32 v138, v138, v128
    v_add_f32 v139, v139, v129
    v_exp_f32 v132, v28
    v_exp_f32 v133, v29
    v_mfma_f32_32x32x16_bf16 v[48:63], a[248:251], a[184:187], v[48:63]
    v_cvt_pk_bf16_f32 v109, v130, v131
    v_add_f32 v138, v138, v130
    v_add_f32 v139, v139, v131
    v_exp_f32 v134, v30
    v_exp_f32 v135, v31
    v_mfma_f32_32x32x16_bf16 v[32:47], a[252:255], a[156:159], v[32:47]
    ds_read_b128 a[220:223], v241 offset:6656
    v_cvt_pk_bf16_f32 v110, v132, v133
    v_add_f32 v138, v138, v132
    v_add_f32 v139, v139, v133
    v_cvt_pk_bf16_f32 v111, v134, v135
    v_add_f32 v138, v138, v134
    v_add_f32 v139, v139, v135
    v_add_f32 v225, v138, v139
    v_mfma_f32_32x32x16_bf16 v[48:63], a[252:255], a[188:191], v[48:63]
    ds_read_b128 a[224:227], v241 offset:16384
    ds_read_b128 a[228:231], v241 offset:18432
    ds_read_b128 a[232:235], v241 offset:20480
    ds_read_b128 a[236:239], v241 offset:22528
    s_mul_i32 s27, s5, 68096
    s_sub_u32 s27, s32, s27
    s_add_u32 s18, s27, 1089536
    s_mov_b32 s58, 0x800000
    s_mov_b32 s31, s101
    s_and_b32 s28, s2, 6
    s_lshl_b32 s28, s28, 20
    s_lshr_b32 s27, s2, 3
    s_lshl2_add_u32 s27, s27, s3
    s_lshl_b32 s27, s27, 14
    s_add_u32 s28, s28, s27
    s_mov_b32 s27, 19
    s_add_u32 s8, s20, 0x2c00000
    s_addc_u32 s9, s21, 0
    s_mov_b32 s10, 0xc00000
    s_lshl2_add_u32 s29, s2, s3
    s_mul_i32 s29, s29, 12288
    s_add_u32 s30, s29, 12288
    v_mov_b32 v200, -1
    v_mov_b32 v201, -1
    v_mov_b32 v202, -1
    v_mov_b32 v203, -1
    s_lshl1_add_u32 s26, s5, s31
    s_branch ka_p1_e
.p2align 3
ka_p1:
    s_sub_u32 s36, s36, 1
    s_cbranch_scc1 kf_fix5
kf_fixr6:
    s_waitcnt lgkmcnt(8)
    v_mfma_f32_32x32x16_bf16 v[0:15], a[192:195], a[128:131], v[64:79]
    ds_read_b128 a[240:243], v241 offset:16896
    v_add_f32 v226, v226, v224
    v_add_f32 v227, v227, v225
    v_exp_f32 v136, v32
    v_mfma_f32_32x32x16_bf16 v[16:31], a[192:195], a[160:163], v[80:95]
    s_waitcnt vmcnt(11)
    buffer_store_dwordx4 v[192:195], v255, s[48:51], s45 offen offset:0 sc1
    s_cmp_lt_u32 s44, s47
    s_cselect_b32 s101, s44, s43
    buffer_load_dwordx4 v[192:195], v253, s[52:55], s101 offen
    v_mfma_f32_32x32x16_bf16 v[0:15], a[196:199], a[132:135], v[0:15]
    ds_read_b128 a[244:247], v241 offset:18944
    v_exp_f32 v137, v33
    v_exp_f32 v130, v34
    v_mfma_f32_32x32x16_bf16 v[16:31], a[196:199], a[164:167], v[16:31]
    v_exp_f32 v131, v35
    v_cvt_pk_bf16_f32 v112, v136, v137
    v_exp_f32 v132, v36
    v_mfma_f32_32x32x16_bf16 v[0:15], a[200:203], a[136:139], v[0:15]
    ds_read_b128 a[248:251], v241 offset:20992
    v_exp_f32 v133, v37
    v_cvt_pk_bf16_f32 v113, v130, v131
    v_mfma_f32_32x32x16_bf16 v[16:31], a[200:203], a[168:171], v[16:31]
    v_add_f32 v136, v136, v130
    v_add_f32 v137, v137, v131
    v_exp_f32 v134, v38
    v_mfma_f32_32x32x16_bf16 v[0:15], a[204:207], a[140:143], v[0:15]
    ds_read_b128 a[252:255], v241 offset:23040
    s_mov_b32 m0, s34
    s_add_u32 s41, s42, 17664
    v_exp_f32 v135, v39
    v_cvt_pk_bf16_f32 v114, v132, v133
    v_mfma_f32_32x32x16_bf16 v[16:31], a[204:207], a[172:175], v[16:31]
    v_add_f32 v136, v136, v132
    v_add_f32 v137, v137, v133
    v_exp_f32 v128, v40
    s_waitcnt lgkmcnt(8)
    v_mfma_f32_32x32x16_bf16 v[0:15], a[208:211], a[144:147], v[0:15]
    ds_read_b128 a[192:195], v241 offset:8192
    v_exp_f32 v129, v41
    v_cvt_pk_bf16_f32 v115, v134, v135
    v_mfma_f32_32x32x16_bf16 v[16:31], a[208:211], a[176:179], v[16:31]
    v_add_f32 v136, v136, v134
    v_add_f32 v137, v137, v135
    v_exp_f32 v130, v42
    v_mfma_f32_32x32x16_bf16 v[0:15], a[212:215], a[148:151], v[0:15]
    ds_read_b128 a[196:199], v241 offset:8704
    v_exp_f32 v131, v43
    v_cvt_pk_bf16_f32 v116, v128, v129
    v_add_f32 v136, v136, v128
    v_mfma_f32_32x32x16_bf16 v[16:31], a[212:215], a[180:183], v[16:31]
    buffer_load_dwordx4 v242, s[16:19], s41 offen offset:0 sc1 lds
    v_add_f32 v137, v137, v129
    v_exp_f32 v132, v44
    v_mfma_f32_32x32x16_bf16 v[0:15], a[216:219], a[152:155], v[0:15]
    ds_read_b128 a[200:203], v241 offset:10240
    v_exp_f32 v133, v45
    v_cvt_pk_bf16_f32 v117, v130, v131
    v_add_f32 v136, v136, v130
    v_mfma_f32_32x32x16_bf16 v[16:31], a[216:219], a[184:187], v[16:31]
    v_add_f32 v137, v137, v131
    v_exp_f32 v134, v46
    v_exp_f32 v135, v47
    v_mfma_f32_32x32x16_bf16 v[0:15], a[220:223], a[156:159], v[0:15]
    ds_read_b128 a[204:207], v241 offset:10752
    v_cvt_pk_bf16_f32 v118, v132, v133
    v_add_f32 v136, v136, v132
    v_add_f32 v137, v137, v133
    v_mfma_f32_32x32x16_bf16 v[16:31], a[220:223], a[188:191], v[16:31]
    v_exp_f32 v138, v48
    v_exp_f32 v139, v49
    s_waitcnt lgkmcnt(8)
    v_mfma_f32_32x32x16_bf16 a[0:15], a[224:227], v[96:99], a[0:15]
    ds_read_b128 a[208:211], v241 offset:12288
    buffer_load_dwordx4 v242, s[16:19], s41 offen offset:1024 sc1 lds
    v_cvt_pk_bf16_f32 v119, v134, v135
    v_add_f32 v136, v136, v134
    v_add_f32 v137, v137, v135
    v_mfma_f32_32x32x16_bf16 a[64:79], a[224:227], v[104:107], a[64:79]
    v_add_f32 v224, v136, v137
    v_exp_f32 v130, v50
    v_exp_f32 v131, v51
    v_mfma_f32_32x32x16_bf16 a[16:31], a[228:231], v[96:99], a[16:31]
    ds_read_b128 a[212:215], v241 offset:12800
    v_cvt_pk_bf16_f32 v120, v138, v139
    v_exp_f32 v132, v52
    v_mfma_f32_32x32x16_bf16 a[80:95], a[228:231], v[104:107], a[80:95]
    v_exp_f32 v133, v53
    v_cvt_pk_bf16_f32 v121, v130, v131
    v_add_f32 v138, v138, v130
    v_mfma_f32_32x32x16_bf16 a[32:47], a[232:235], v[96:99], a[32:47]
    ds_read_b128 a[216:219], v241 offset:14336
    v_add_f32 v139, v139, v131
    v_exp_f32 v134, v54
    v_exp_f32 v135, v55
    v_mfma_f32_32x32x16_bf16 a[96:111], a[232:235], v[104:107], a[96:111]
    buffer_load_dwordx4 v242, s[16:19], s41 offen offset:2048 sc1 lds
    v_cvt_pk_bf16_f32 v122, v132, v133
    v_add_f32 v138, v138, v132
    v_add_f32 v139, v139, v133
    v_mfma_f32_32x32x16_bf16 a[48:63], a[236:239], v[96:99], a[48:63]
    ds_read_b128 a[220:223], v241 offset:14848
    v_exp_f32 v128, v56
    v_exp_f32 v129, v57
    v_mfma_f32_32x32x16_bf16 a[112:127], a[236:239], v[104:107], a[112:127]
    v_cvt_pk_bf16_f32 v123, v134, v135
    v_add_f32 v138, v138, v134
    v_add_f32 v139, v139, v135
    s_waitcnt lgkmcnt(8)
    v_mfma_f32_32x32x16_bf16 a[0:15], a[240:243], v[100:103], a[0:15]
    ds_read_b128 a[224:227], v241 offset:24576
    v_exp_f32 v130, v58
    v_exp_f32 v131, v59
    v_mfma_f32_32x32x16_bf16 a[64:79], a[240:243], v[108:111], a[64:79]
    v_cvt_pk_bf16_f32 v124, v128, v129
    v_add_f32 v138, v138, v128
    v_add_f32 v139, v139, v129
    v_exp_f32 v132, v60
    v_mfma_f32_32x32x16_bf16 a[16:31], a[244:247], v[100:103], a[16:31]
    ds_read_b128 a[228:231], v241 offset:26624
    buffer_load_dwordx4 v242, s[16:19], s41 offen offset:3072 sc1 lds
    v_exp_f32 v133, v61
    v_mfma_f32_32x32x16_bf16 a[80:95], a[244:247], v[108:111], a[80:95]
    v_cvt_pk_bf16_f32 v125, v130, v131
    v_add_f32 v138, v138, v130
    v_add_f32 v139, v139, v131
    v_exp_f32 v134, v62
    v_mfma_f32_32x32x16_bf16 a[32:47], a[248:251], v[100:103], a[32:47]
    ds_read_b128 a[232:235], v241 offset:28672
    v_exp_f32 v135, v63
    v_cvt_pk_bf16_f32 v126, v132, v133
    v_mfma_f32_32x32x16_bf16 a[96:111], a[248:251], v[108:111], a[96:111]
    v_add_f32 v138, v138, v132
    v_add_f32 v139, v139, v133
    v_cvt_pk_bf16_f32 v127, v134, v135
    v_add_f32 v138, v138, v134
    v_mfma_f32_32x32x16_bf16 a[48:63], a[252:255], v[100:103], a[48:63]
    ds_read_b128 a[236:239], v241 offset:30720
    v_add_f32 v139, v139, v135
    v_add_f32 v225, v138, v139
    v_max_f32 v230, v224, v225
    v_cmp_lt_f32 vcc, s38, v230
    v_mfma_f32_32x32x16_bf16 a[112:127], a[252:255], v[108:111], a[112:127]
    s_cbranch_vccnz kf_rare8
kf_rr7:
    s_sub_u32 s36, s36, 1
    s_cbranch_scc1 kf_fix9
kf_fixr10:
    s_waitcnt lgkmcnt(8)
    v_mfma_f32_32x32x16_bf16 v[32:47], a[192:195], a[128:131], v[64:79]
    ds_read_b128 a[240:243], v241 offset:25088
    v_add_f32 v226, v226, v224
    v_add_f32 v227, v227, v225
    v_exp_f32 v136, v0
    v_mfma_f32_32x32x16_bf16 v[48:63], a[192:195], a[160:163], v[80:95]
    s_waitcnt vmcnt(11)
    buffer_store_dwordx4 v[196:199], v255, s[48:51], s45 offen offset:256 sc1
    s_add_u32 s101, s101, 57344
    buffer_load_dwordx4 v[196:199], v253, s[52:55], s101 offen
    v_exp_f32 v137, v1
    v_mfma_f32_32x32x16_bf16 v[32:47], a[196:199], a[132:135], v[32:47]
    ds_read_b128 a[244:247], v241 offset:27136
    v_exp_f32 v130, v2
    v_exp_f32 v131, v3
    v_mfma_f32_32x32x16_bf16 v[48:63], a[196:199], a[164:167], v[48:63]
    v_cvt_pk_bf16_f32 v96, v136, v137
    v_exp_f32 v132, v4
    v_mfma_f32_32x32x16_bf16 v[32:47], a[200:203], a[136:139], v[32:47]
    ds_read_b128 a[248:251], v241 offset:29184
    s_cmp_lt_u32 s44, s47
    s_cselect_b32 s45, s46, s43
    s_add_u32 s44, s44, 128
    s_add_u32 s46, s46, 262144
    v_exp_f32 v133, v5
    v_mfma_f32_32x32x16_bf16 v[48:63], a[200:203], a[168:171], v[48:63]
    v_cvt_pk_bf16_f32 v97, v130, v131
    v_add_f32 v136, v136, v130
    v_add_f32 v137, v137, v131
    v_exp_f32 v134, v6
    v_mfma_f32_32x32x16_bf16 v[32:47], a[204:207], a[140:143], v[32:47]
    ds_read_b128 a[252:255], v241 offset:31232
    v_exp_f32 v135, v7
    v_cvt_pk_bf16_f32 v98, v132, v133
    v_mfma_f32_32x32x16_bf16 v[48:63], a[204:207], a[172:175], v[48:63]
    v_add_f32 v136, v136, v132
    v_add_f32 v137, v137, v133
    v_exp_f32 v128, v8
    s_waitcnt lgkmcnt(8)
    v_mfma_f32_32x32x16_bf16 v[32:47], a[208:211], a[144:147], v[32:47]
    s_waitcnt vmcnt(16)
    s_barrier
    s_add_u32 s35, s35, 32768
    s_cmp_ge_u32 s35, 163840
    s_cselect_b32 s35, 0, s35
    v_add_u32 v241, s35, v239
    ds_read_b128 a[192:195], v241 offset:0
    s_add_u32 m0, s34, 16384
    s_add_u32 s34, s34, 32768
    s_cmp_ge_u32 s34, 163840
    s_cselect_b32 s34, s37, s34
    v_mfma_f32_32x32x16_bf16 v[48:63], a[208:211], a[176:179], v[48:63]
    v_exp_f32 v129, v9
    v_cvt_pk_bf16_f32 v99, v134, v135
    v_add_f32 v136, v136, v134
    v_add_f32 v137, v137, v135
    v_mfma_f32_32x32x16_bf16 v[32:47], a[212:215], a[148:151], v[32:47]
    ds_read_b128 a[196:199], v241 offset:512
    v_exp_f32 v130, v10
    v_exp_f32 v131, v11
    v_mfma_f32_32x32x16_bf16 v[48:63], a[212:215], a[180:183], v[48:63]
    v_cvt_pk_bf16_f32 v100, v128, v129
    v_add_f32 v136, v136, v128
    v_add_f32 v137, v137, v129
    v_exp_f32 v132, v12
    v_mfma_f32_32x32x16_bf16 v[32:47], a[216:219], a[152:155], v[32:47]
    ds_read_b128 a[200:203], v241 offset:2048
    buffer_load_dwordx4 v242, s[16:19], s42 offen offset:0 sc1 lds
    v_exp_f32 v133, v13
    v_mfma_f32_32x32x16_bf16 v[48:63], a[216:219], a[184:187], v[48:63]
    v_cvt_pk_bf16_f32 v101, v130, v131
    v_add_f32 v136, v136, v130
    v_add_f32 v137, v137, v131
    v_exp_f32 v134, v14
    v_mfma_f32_32x32x16_bf16 v[32:47], a[220:223], a[156:159], v[32:47]
    ds_read_b128 a[204:207], v241 offset:2560
    v_exp_f32 v135, v15
    v_cvt_pk_bf16_f32 v102, v132, v133
    v_add_f32 v136, v136, v132
    v_mfma_f32_32x32x16_bf16 v[48:63], a[220:223], a[188:191], v[48:63]
    v_add_f32 v137, v137, v133
    v_exp_f32 v138, v16
    s_waitcnt lgkmcnt(8)
    v_mfma_f32_32x32x16_bf16 a[0:15], a[224:227], v[112:115], a[0:15]
    ds_read_b128 a[208:211], v241 offset:4096
    buffer_load_dwordx4 v242, s[16:19], s42 offen offset:1024 sc1 lds
    v_exp_f32 v139, v17
    v_cvt_pk_bf16_f32 v103, v134, v135
    v_add_f32 v136, v136, v134
    v_mfma_f32_32x32x16_bf16 a[64:79], a[224:227], v[120:123], a[64:79]
    v_add_f32 v137, v137, v135
    v_add_f32 v224, v136, v137
    v_exp_f32 v130, v18
    v_mfma_f32_32x32x16_bf16 a[16:31], a[228:231], v[112:115], a[16:31]
    ds_read_b128 a[212:215], v241 offset:4608
    v_exp_f32 v131, v19
    v_cvt_pk_bf16_f32 v104, v138, v139
    v_exp_f32 v132, v20
    v_mfma_f32_32x32x16_bf16 a[80:95], a[228:231], v[120:123], a[80:95]
    buffer_load_dwordx4 v242, s[16:19], s42 offen offset:2048 sc1 lds
    v_exp_f32 v133, v21
    v_cvt_pk_bf16_f32 v105, v130, v131
    v_mfma_f32_32x32x16_bf16 a[32:47], a[232:235], v[112:115], a[32:47]
    ds_read_b128 a[216:219], v241 offset:6144
    v_add_f32 v138, v138, v130
    v_add_f32 v139, v139, v131
    v_exp_f32 v134, v22
    v_mfma_f32_32x32x16_bf16 a[96:111], a[232:235], v[120:123], a[96:111]
    v_exp_f32 v135, v23
    v_cvt_pk_bf16_f32 v106, v132, v133
    v_add_f32 v138, v138, v132
    v_add_f32 v139, v139, v133
    v_mfma_f32_32x32x16_bf16 a[48:63], a[236:239], v[112:115], a[48:63]
    ds_read_b128 a[220:223], v241 offset:6656
    v_exp_f32 v128, v24
    v_exp_f32 v129, v25
    v_mfma_f32_32x32x16_bf16 a[112:127], a[236:239], v[120:123], a[112:127]
    buffer_load_dwordx4 v242, s[16:19], s42 offen offset:3072 sc1 lds
    s_add_u32 s42, s42, 34048
    v_cvt_pk_bf16_f32 v107, v134, v135
    v_add_f32 v138, v138, v134
    s_waitcnt lgkmcnt(8)
    v_mfma_f32_32x32x16_bf16 a[0:15], a[240:243], v[116:119], a[0:15]
    ds_read_b128 a[224:227], v241 offset:16384
    v_add_f32 v139, v139, v135
    v_exp_f32 v130, v26
    v_mfma_f32_32x32x16_bf16 a[64:79], a[240:243], v[124:127], a[64:79]
    v_exp_f32 v131, v27
    v_cvt_pk_bf16_f32 v108, v128, v129
    v_add_f32 v138, v138, v128
    v_add_f32 v139, v139, v129
    v_mfma_f32_32x32x16_bf16 a[16:31], a[244:247], v[116:119], a[16:31]
    ds_read_b128 a[228:231], v241 offset:18432
    v_exp_f32 v132, v28
    v_exp_f32 v133, v29
    v_mfma_f32_32x32x16_bf16 a[80:95], a[244:247], v[124:127], a[80:95]
    buffer_load_dword v252, v251, s[60:63], s100 offen
    s_add_u32 s100, s100, 2048
    v_cvt_pk_bf16_f32 v109, v130, v131
    v_add_f32 v138, v138, v130
    v_add_f32 v139, v139, v131
    v_mfma_f32_32x32x16_bf16 a[32:47], a[248:251], v[116:119], a[32:47]
    ds_read_b128 a[232:235], v241 offset:20480
    v_exp_f32 v134, v30
    v_exp_f32 v135, v31
    v_mfma_f32_32x32x16_bf16 a[96:111], a[248:251], v[124:127], a[96:111]
    v_cvt_pk_bf16_f32 v110, v132, v133
    v_add_f32 v138, v138, v132
    v_add_f32 v139, v139, v133
    v_cvt_pk_bf16_f32 v111, v134, v135
    v_add_f32 v138, v138, v134
    v_mfma_f32_32x32x16_bf16 a[48:63], a[252:255], v[116:119], a[48:63]
    ds_read_b128 a[236:239], v241 offset:22528
    v_add_f32 v139, v139, v135
    v_add_f32 v225, v138, v139
    v_max_f32 v230, v224, v225
    v_cmp_lt_f32 vcc, s38, v230
    v_mfma_f32_32x32x16_bf16 a[112:127], a[252:255], v[124:127], a[112:127]
    s_cbranch_vccnz kf_rare12
kf_rr11:
ka_p1_e:
    s_sub_u32 s26, s26, 1
    s_cbranch_scc0 ka_p1
    s_lshl2_add_u32 s36, s5, s6
    s_lshl1_add_u32 s36, s31, s36
    s_sub_u32 s36, 61, s36
    s_mov_b32 s33, 0
    s_sub_u32 s36, s36, 1
    s_cbranch_scc1 kf_fix13
kf_fixr14:
    s_waitcnt lgkmcnt(8)
    v_mfma_f32_32x32x16_bf16 v[16:31], a[192:195], a[160:163], v[80:95]
    ds_read_b128 a[240:243], v241 offset:16896
    v_add_f32 v226, v226, v224
    v_add_f32 v227, v227, v225
    v_exp_f32 v136, v32
    v_exp_f32 v137, v33
    v_mfma_f32_32x32x16_bf16 v[16:31], a[196:199], a[164:167], v[16:31]
    ds_read_b128 a[244:247], v241 offset:18944
    s_waitcnt vmcnt(11)
    buffer_store_dwordx4 v[192:195], v255, s[48:51], s45 offen offset:0 sc1
    v_exp_f32 v130, v34
    v_mfma_f32_32x32x16_bf16 v[16:31], a[200:203], a[168:171], v[16:31]
    ds_read_b128 a[248:251], v241 offset:20992
    v_exp_f32 v131, v35
    v_cvt_pk_bf16_f32 v112, v136, v137
    v_exp_f32 v132, v36
    v_mfma_f32_32x32x16_bf16 v[16:31], a[204:207], a[172:175], v[16:31]
    ds_read_b128 a[252:255], v241 offset:23040
    v_exp_f32 v133, v37
    v_cvt_pk_bf16_f32 v113, v130, v131
    v_add_f32 v136, v136, v130
    s_waitcnt lgkmcnt(8)
    v_mfma_f32_32x32x16_bf16 v[16:31], a[208:211], a[176:179], v[16:31]
    ds_read_b128 a[192:195], v241 offset:8192
    s_mov_b32 m0, s34
    s_add_u32 s41, s42, 17664
    v_add_f32 v137, v137, v131
    v_exp_f32 v134, v38
    v_mfma_f32_32x32x16_bf16 v[16:31], a[212:215], a[180:183], v[16:31]
    ds_read_b128 a[196:199], v241 offset:8704
    v_exp_f32 v135, v39
    v_cvt_pk_bf16_f32 v114, v132, v133
    v_add_f32 v136, v136, v132
    v_add_f32 v137, v137, v133
    v_mfma_f32_32x32x16_bf16 v[16:31], a[216:219], a[184:187], v[16:31]
    ds_read_b128 a[200:203], v241 offset:10240
    v_exp_f32 v128, v40
    v_exp_f32 v129, v41
    v_cvt_pk_bf16_f32 v115, v134, v135
    v_add_f32 v136, v136, v134
    v_mfma_f32_32x32x16_bf16 v[16:31], a[220:223], a[188:191], v[16:31]
    ds_read_b128 a[204:207], v241 offset:10752
    v_add_f32 v137, v137, v135
    v_exp_f32 v130, v42
    s_waitcnt lgkmcnt(8)
    v_mfma_f32_32x32x16_bf16 a[0:15], a[224:227], v[96:99], a[0:15]
    ds_read_b128 a[208:211], v241 offset:12288
    buffer_load_dwordx4 v242, s[16:19], s41 offen offset:0 sc1 lds
    v_exp_f32 v131, v43
    v_cvt_pk_bf16_f32 v116, v128, v129
    v_add_f32 v136, v136, v128
    v_add_f32 v137, v137, v129
    v_mfma_f32_32x32x16_bf16 a[64:79], a[224:227], v[104:107], a[64:79]
    v_exp_f32 v132, v44
    v_exp_f32 v133, v45
    v_cvt_pk_bf16_f32 v117, v130, v131
    v_add_f32 v136, v136, v130
    v_mfma_f32_32x32x16_bf16 a[16:31], a[228:231], v[96:99], a[16:31]
    ds_read_b128 a[212:215], v241 offset:12800
    v_add_f32 v137, v137, v131
    v_exp_f32 v134, v46
    v_exp_f32 v135, v47
    v_mfma_f32_32x32x16_bf16 a[80:95], a[228:231], v[104:107], a[80:95]
    v_cvt_pk_bf16_f32 v118, v132, v133
    v_add_f32 v136, v136, v132
    v_add_f32 v137, v137, v133
    v_exp_f32 v138, v48
    v_exp_f32 v139, v49
    v_mfma_f32_32x32x16_bf16 a[32:47], a[232:235], v[96:99], a[32:47]
    ds_read_b128 a[216:219], v241 offset:14336
    buffer_load_dwordx4 v242, s[16:19], s41 offen offset:1024 sc1 lds
    v_cvt_pk_bf16_f32 v119, v134, v135
    v_add_f32 v136, v136, v134
    v_add_f32 v137, v137, v135
    v_add_f32 v224, v136, v137
    v_mfma_f32_32x32x16_bf16 a[96:111], a[232:235], v[104:107], a[96:111]
    v_exp_f32 v130, v50
    v_exp_f32 v131, v51
    v_cvt_pk_bf16_f32 v120, v138, v139
    v_mfma_f32_32x32x16_bf16 a[48:63], a[236:239], v[96:99], a[48:63]
    ds_read_b128 a[220:223], v241 offset:14848
    v_exp_f32 v132, v52
    v_exp_f32 v133, v53
    v_cvt_pk_bf16_f32 v121, v130, v131
    v_add_f32 v138, v138, v130
    v_mfma_f32_32x32x16_bf16 a[112:127], a[236:239], v[104:107], a[112:127]
    buffer_load_dwordx4 v242, s[16:19], s41 offen offset:2048 sc1 lds
    v_add_f32 v139, v139, v131
    v_exp_f32 v134, v54
    v_exp_f32 v135, v55
    s_waitcnt lgkmcnt(8)
    v_mfma_f32_32x32x16_bf16 a[0:15], a[240:243], v[100:103], a[0:15]
    ds_read_b128 a[224:227], v241 offset:24576
    v_cvt_pk_bf16_f32 v122, v132, v133
    v_add_f32 v138, v138, v132
    v_add_f32 v139, v139, v133
    v_exp_f32 v128, v56
    v_mfma_f32_32x32x16_bf16 a[64:79], a[240:243], v[108:111], a[64:79]
    v_exp_f32 v129, v57
    v_cvt_pk_bf16_f32 v123, v134, v135
    v_add_f32 v138, v138, v134
    v_add_f32 v139, v139, v135
    v_mfma_f32_32x32x16_bf16 a[16:31], a[244:247], v[100:103], a[16:31]
    ds_read_b128 a[228:231], v241 offset:26624
    v_exp_f32 v130, v58
    v_exp_f32 v131, v59
    v_cvt_pk_bf16_f32 v124, v128, v129
    v_mfma_f32_32x32x16_bf16 a[80:95], a[244:247], v[108:111], a[80:95]
    buffer_load_dwordx4 v242, s[16:19], s41 offen offset:3072 sc1 lds
    v_add_f32 v138, v138, v128
    v_add_f32 v139, v139, v129
    v_exp_f32 v132, v60
    v_exp_f32 v133, v61
    v_mfma_f32_32x32x16_bf16 a[32:47], a[248:251], v[100:103], a[32:47]
    ds_read_b128 a[232:235], v241 offset:28672
    v_cvt_pk_bf16_f32 v125, v130, v131
    v_add_f32 v138, v138, v130
    v_add_f32 v139, v139, v131
    v_exp_f32 v134, v62
    v_mfma_f32_32x32x16_bf16 a[96:111], a[248:251], v[108:111], a[96:111]
    v_exp_f32 v135, v63
    v_cvt_pk_bf16_f32 v126, v132, v133
    v_add_f32 v138, v138, v132
    v_add_f32 v139, v139, v133
    v_cvt_pk_bf16_f32 v127, v134, v135
    v_mfma_f32_32x32x16_bf16 a[48:63], a[252:255], v[100:103], a[48:63]
    ds_read_b128 a[236:239], v241 offset:30720
    v_add_f32 v138, v138, v134
    v_add_f32 v139, v139, v135
    v_add_f32 v225, v138, v139
    v_max_f32 v230, v224, v225
    v_cmp_lt_f32 vcc, s38, v230
    v_mfma_f32_32x32x16_bf16 a[112:127], a[252:255], v[108:111], a[112:127]
    s_cbranch_vccnz kf_rare16
kf_rr15:
    s_sub_u32 s36, s36, 1
    s_cbranch_scc1 kf_fix17
kf_fixr18:
    s_waitcnt lgkmcnt(8)
    v_mfma_f32_32x32x16_bf16 v[48:63], a[192:195], a[160:163], v[80:95]
    ds_read_b128 a[240:243], v241 offset:25088
    v_add_f32 v226, v226, v224
    v_add_f32 v227, v227, v225
    v_mfma_f32_32x32x16_bf16 v[48:63], a[196:199], a[164:167], v[48:63]
    ds_read_b128 a[244:247], v241 offset:27136
    s_waitcnt vmcnt(10)
    buffer_store_dwordx4 v[196:199], v255, s[48:51], s45 offen offset:256 sc1
    v_exp_f32 v138, v16
    v_mfma_f32_32x32x16_bf16 v[48:63], a[200:203], a[168:171], v[48:63]
    ds_read_b128 a[248:251], v241 offset:29184
    v_exp_f32 v139, v17
    v_exp_f32 v130, v18
    v_mfma_f32_32x32x16_bf16 v[48:63], a[204:207], a[172:175], v[48:63]
    ds_read_b128 a[252:255], v241 offset:31232
    v_exp_f32 v131, v19
    s_waitcnt lgkmcnt(8)
    v_mfma_f32_32x32x16_bf16 v[48:63], a[208:211], a[176:179], v[48:63]
    s_waitcnt vmcnt(14)
    s_barrier
    s_add_u32 s35, s35, 32768
    s_cmp_ge_u32 s35, 163840
    s_cselect_b32 s35, 0, s35
    v_add_u32 v241, s35, v239
    ds_read_b128 a[192:195], v241 offset:0
    s_add_u32 m0, s34, 16384
    s_add_u32 s34, s34, 32768
    s_cmp_ge_u32 s34, 163840
    s_cselect_b32 s34, s37, s34
    v_mfma_f32_32x32x16_bf16 v[48:63], a[212:215], a[180:183], v[48:63]
    ds_read_b128 a[196:199], v241 offset:512
    v_cvt_pk_bf16_f32 v104, v138, v139
    v_mfma_f32_32x32x16_bf16 v[48:63], a[216:219], a[184:187], v[48:63]
    ds_read_b128 a[200:203], v241 offset:2048
    v_exp_f32 v132, v20
    v_exp_f32 v133, v21
    v_mfma_f32_32x32x16_bf16 v[48:63], a[220:223], a[188:191], v[48:63]
    ds_read_b128 a[204:207], v241 offset:2560
    v_cvt_pk_bf16_f32 v105, v130, v131
    v_add_f32 v138, v138, v130
    s_waitcnt lgkmcnt(8)
    v_mfma_f32_32x32x16_bf16 a[0:15], a[224:227], v[112:115], a[0:15]
    ds_read_b128 a[208:211], v241 offset:4096
    buffer_load_dwordx4 v242, s[16:19], s42 offen offset:0 sc1 lds
    v_add_f32 v139, v139, v131
    v_mfma_f32_32x32x16_bf16 a[64:79], a[224:227], v[120:123], a[64:79]
    v_exp_f32 v134, v22
    v_exp_f32 v135, v23
    v_mfma_f32_32x32x16_bf16 a[16:31], a[228:231], v[112:115], a[16:31]
    ds_read_b128 a[212:215], v241 offset:4608
    v_cvt_pk_bf16_f32 v106, v132, v133
    v_add_f32 v138, v138, v132
    v_add_f32 v139, v139, v133
    v_mfma_f32_32x32x16_bf16 a[80:95], a[228:231], v[120:123], a[80:95]
    v_exp_f32 v128, v24
    v_exp_f32 v129, v25
    v_mfma_f32_32x32x16_bf16 a[32:47], a[232:235], v[112:115], a[32:47]
    ds_read_b128 a[216:219], v241 offset:6144
    buffer_load_dwordx4 v242, s[16:19], s42 offen offset:1024 sc1 lds
    v_cvt_pk_bf16_f32 v107, v134, v135
    v_mfma_f32_32x32x16_bf16 a[96:111], a[232:235], v[120:123], a[96:111]
    v_add_f32 v138, v138, v134
    v_add_f32 v139, v139, v135
    v_exp_f32 v130, v26
    v_mfma_f32_32x32x16_bf16 a[48:63], a[236:239], v[112:115], a[48:63]
    ds_read_b128 a[220:223], v241 offset:6656
    v_exp_f32 v131, v27
    v_mfma_f32_32x32x16_bf16 a[112:127], a[236:239], v[120:123], a[112:127]
    buffer_load_dwordx4 v242, s[16:19], s42 offen offset:2048 sc1 lds
    v_cvt_pk_bf16_f32 v108, v128, v129
    v_add_f32 v138, v138, v128
    s_waitcnt lgkmcnt(8)
    v_mfma_f32_32x32x16_bf16 a[0:15], a[240:243], v[116:119], a[0:15]
    ds_read_b128 a[224:227], v241 offset:16384
    v_add_f32 v139, v139, v129
    v_exp_f32 v132, v28
    v_mfma_f32_32x32x16_bf16 a[64:79], a[240:243], v[124:127], a[64:79]
    v_exp_f32 v133, v29
    v_cvt_pk_bf16_f32 v109, v130, v131
    v_mfma_f32_32x32x16_bf16 a[16:31], a[244:247], v[116:119], a[16:31]
    ds_read_b128 a[228:231], v241 offset:18432
    v_add_f32 v138, v138, v130
    v_add_f32 v139, v139, v131
    v_exp_f32 v134, v30
    v_mfma_f32_32x32x16_bf16 a[80:95], a[244:247], v[124:127], a[80:95]
    buffer_load_dwordx4 v242, s[16:19], s42 offen offset:3072 sc1 lds
    s_add_u32 s42, s42, 34048
    v_exp_f32 v135, v31
    v_mfma_f32_32x32x16_bf16 a[32:47], a[248:251], v[116:119], a[32:47]
    ds_read_b128 a[232:235], v241 offset:20480
    v_cvt_pk_bf16_f32 v110, v132, v133
    v_add_f32 v138, v138, v132
    v_mfma_f32_32x32x16_bf16 a[96:111], a[248:251], v[124:127], a[96:111]
    v_add_f32 v139, v139, v133
    v_cvt_pk_bf16_f32 v111, v134, v135
    v_add_f32 v138, v138, v134
    v_mfma_f32_32x32x16_bf16 a[48:63], a[252:255], v[116:119], a[48:63]
    ds_read_b128 a[236:239], v241 offset:22528
    v_add_f32 v139, v139, v135
    v_add_f32 v225, v138, v139
    v_cmp_lt_f32 vcc, s38, v225
    v_mfma_f32_32x32x16_bf16 a[112:127], a[252:255], v[124:127], a[112:127]
    s_cbranch_vccnz kf_rare20
kf_rr19:
    s_nop 7
    v_mov_b32 v230, v226
    s_nop 1
    v_permlane32_swap_b32 v226, v230
    s_nop 0
    v_add_f32 v230, v230, v226
    v_rcp_f32 v230, v230
    s_nop 0
    v_accvgpr_read_b32 v160, a0
    v_accvgpr_read_b32 v161, a1
    v_accvgpr_read_b32 v162, a2
    v_accvgpr_read_b32 v163, a3
    v_accvgpr_read_b32 v164, a4
    v_accvgpr_read_b32 v165, a5
    v_accvgpr_read_b32 v166, a6
    v_accvgpr_read_b32 v167, a7
    v_mul_f32 v160, v160, v230
    v_mul_f32 v161, v161, v230
    v_mul_f32 v162, v162, v230
    v_mul_f32 v163, v163, v230
    v_mul_f32 v164, v164, v230
    v_mul_f32 v165, v165, v230
    v_mul_f32 v166, v166, v230
    v_mul_f32 v167, v167, v230
    v_cvt_pk_bf16_f32 v176, v160, v161
    v_cvt_pk_bf16_f32 v177, v162, v163
    v_cvt_pk_bf16_f32 v178, v164, v165
    v_cvt_pk_bf16_f32 v179, v166, v167
    buffer_store_dwordx4 v[176:179], v244, s[20:23], s39 offen offset:0 sc1
    v_accvgpr_read_b32 v168, a8
    v_accvgpr_read_b32 v169, a9
    v_accvgpr_read_b32 v170, a10
    v_accvgpr_read_b32 v171, a11
    v_accvgpr_read_b32 v172, a12
    v_accvgpr_read_b32 v173, a13
    v_accvgpr_read_b32 v174, a14
    v_accvgpr_read_b32 v175, a15
    v_mul_f32 v168, v168, v230
    v_mul_f32 v169, v169, v230
    v_mul_f32 v170, v170, v230
    v_mul_f32 v171, v171, v230
    v_mul_f32 v172, v172, v230
    v_mul_f32 v173, v173, v230
    v_mul_f32 v174, v174, v230
    v_mul_f32 v175, v175, v230
    v_cvt_pk_bf16_f32 v180, v168, v169
    v_cvt_pk_bf16_f32 v181, v170, v171
    v_cvt_pk_bf16_f32 v182, v172, v173
    v_cvt_pk_bf16_f32 v183, v174, v175
    buffer_store_dwordx4 v[180:183], v244, s[20:23], s39 offen offset:512 sc1
    v_accvgpr_read_b32 v160, a16
    v_accvgpr_read_b32 v161, a17
    v_accvgpr_read_b32 v162, a18
    v_accvgpr_read_b32 v163, a19
    v_accvgpr_read_b32 v164, a20
    v_accvgpr_read_b32 v165, a21
    v_accvgpr_read_b32 v166, a22
    v_accvgpr_read_b32 v167, a23
    v_mul_f32 v160, v160, v230
    v_mul_f32 v161, v161, v230
    v_mul_f32 v162, v162, v230
    v_mul_f32 v163, v163, v230
    v_mul_f32 v164, v164, v230
    v_mul_f32 v165, v165, v230
    v_mul_f32 v166, v166, v230
    v_mul_f32 v167, v167, v230
    v_cvt_pk_bf16_f32 v184, v160, v161
    v_cvt_pk_bf16_f32 v185, v162, v163
    v_cvt_pk_bf16_f32 v186, v164, v165
    v_cvt_pk_bf16_f32 v187, v166, v167
    buffer_store_dwordx4 v[184:187], v244, s[20:23], s39 offen offset:1024 sc1
    v_accvgpr_read_b32 v168, a24
    v_accvgpr_read_b32 v169, a25
    v_accvgpr_read_b32 v170, a26
    v_accvgpr_read_b32 v171, a27
    v_accvgpr_read_b32 v172, a28
    v_accvgpr_read_b32 v173, a29
    v_accvgpr_read_b32 v174, a30
    v_accvgpr_read_b32 v175, a31
    v_mul_f32 v168, v168, v230
    v_mul_f32 v169, v169, v230
    v_mul_f32 v170, v170, v230
    v_mul_f32 v171, v171, v230
    v_mul_f32 v172, v172, v230
    v_mul_f32 v173, v173, v230
    v_mul_f32 v174, v174, v230
    v_mul_f32 v175, v175, v230
    v_cvt_pk_bf16_f32 v188, v168, v169
    v_cvt_pk_bf16_f32 v189, v170, v171
    v_cvt_pk_bf16_f32 v190, v172, v173
    v_cvt_pk_bf16_f32 v191, v174, v175
    buffer_store_dwordx4 v[188:191], v244, s[20:23], s39 offen offset:1536 sc1
    v_accvgpr_read_b32 v160, a32
    v_accvgpr_read_b32 v161, a33
    v_accvgpr_read_b32 v162, a34
    v_accvgpr_read_b32 v163, a35
    v_accvgpr_read_b32 v164, a36
    v_accvgpr_read_b32 v165, a37
    v_accvgpr_read_b32 v166, a38
    v_accvgpr_read_b32 v167, a39
    v_mul_f32 v160, v160, v230
    v_mul_f32 v161, v161, v230
    v_mul_f32 v162, v162, v230
    v_mul_f32 v163, v163, v230
    v_mul_f32 v164, v164, v230
    v_mul_f32 v165, v165, v230
    v_mul_f32 v166, v166, v230
    v_mul_f32 v167, v167, v230
    v_cvt_pk_bf16_f32 v176, v160, v161
    v_cvt_pk_bf16_f32 v177, v162, v163
    v_cvt_pk_bf16_f32 v178, v164, v165
    v_cvt_pk_bf16_f32 v179, v166, v167
    buffer_store_dwordx4 v[176:179], v244, s[20:23], s39 offen offset:2048 sc1
    v_accvgpr_read_b32 v168, a40
    v_accvgpr_read_b32 v169, a41
    v_accvgpr_read_b32 v170, a42
    v_accvgpr_read_b32 v171, a43
    v_accvgpr_read_b32 v172, a44
    v_accvgpr_read_b32 v173, a45
    v_accvgpr_read_b32 v174, a46
    v_accvgpr_read_b32 v175, a47
    v_mul_f32 v168, v168, v230
    v_mul_f32 v169, v169, v230
    v_mul_f32 v170, v170, v230
    v_mul_f32 v171, v171, v230
    v_mul_f32 v172, v172, v230
    v_mul_f32 v173, v173, v230
    v_mul_f32 v174, v174, v230
    v_mul_f32 v175, v175, v230
    v_cvt_pk_bf16_f32 v180, v168, v169
    v_cvt_pk_bf16_f32 v181, v170, v171
    v_cvt_pk_bf16_f32 v182, v172, v173
    v_cvt_pk_bf16_f32 v183, v174, v175
    buffer_store_dwordx4 v[180:183], v244, s[20:23], s39 offen offset:2560 sc1
    v_accvgpr_read_b32 v160, a48
    v_accvgpr_read_b32 v161, a49
    v_accvgpr_read_b32 v162, a50
    v_accvgpr_read_b32 v163, a51
    v_accvgpr_read_b32 v164, a52
    v_accvgpr_read_b32 v165, a53
    v_accvgpr_read_b32 v166, a54
    v_accvgpr_read_b32 v167, a55
    v_mul_f32 v160, v160, v230
    v_mul_f32 v161, v161, v230
    v_mul_f32 v162, v162, v230
    v_mul_f32 v163, v163, v230
    v_mul_f32 v164, v164, v230
    v_mul_f32 v165, v165, v230
    v_mul_f32 v166, v166, v230
    v_mul_f32 v167, v167, v230
    v_cvt_pk_bf16_f32 v184, v160, v161
    v_cvt_pk_bf16_f32 v185, v162, v163
    v_cvt_pk_bf16_f32 v186, v164, v165
    v_cvt_pk_bf16_f32 v187, v166, v167
    buffer_store_dwordx4 v[184:187], v244, s[20:23], s39 offen offset:3072 sc1
    v_accvgpr_read_b32 v168, a56
    v_accvgpr_read_b32 v169, a57
    v_accvgpr_read_b32 v170, a58
    v_accvgpr_read_b32 v171, a59
    v_accvgpr_read_b32 v172, a60
    v_accvgpr_read_b32 v173, a61
    v_accvgpr_read_b32 v174, a62
    v_accvgpr_read_b32 v175, a63
    v_mul_f32 v168, v168, v230
    v_mul_f32 v169, v169, v230
    v_mul_f32 v170, v170, v230
    v_mul_f32 v171, v171, v230
    v_mul_f32 v172, v172, v230
    v_mul_f32 v173, v173, v230
    v_mul_f32 v174, v174, v230
    v_mul_f32 v175, v175, v230
    v_cvt_pk_bf16_f32 v188, v168, v169
    v_cvt_pk_bf16_f32 v189, v170, v171
    v_cvt_pk_bf16_f32 v190, v172, v173
    v_cvt_pk_bf16_f32 v191, v174, v175
    buffer_store_dwordx4 v[188:191], v244, s[20:23], s39 offen offset:3584 sc1
    s_lshl1_add_u32 s26, s5, s31
    s_lshl_b32 s26, s26, 1
    s_sub_u32 s26, 30, s26
    s_branch ka_p2_e
.p2align 3
ka_p2:
    s_sub_u32 s36, s36, 1
    s_cbranch_scc1 kf_fix21
kf_fixr22:
    s_waitcnt lgkmcnt(8)
    v_mfma_f32_32x32x16_bf16 v[16:31], a[192:195], a[160:163], v[80:95]
    ds_read_b128 a[240:243], v241 offset:16896
    v_add_f32 v227, v227, v225
    v_exp_f32 v138, v48
    v_exp_f32 v139, v49
    v_mfma_f32_32x32x16_bf16 v[16:31], a[196:199], a[164:167], v[16:31]
    ds_read_b128 a[244:247], v241 offset:18944
    s_mov_b32 m0, s34
    s_add_u32 s41, s42, 17664
    v_exp_f32 v130, v50
    v_mfma_f32_32x32x16_bf16 v[16:31], a[200:203], a[168:171], v[16:31]
    ds_read_b128 a[248:251], v241 offset:20992
    v_exp_f32 v131, v51
    v_cvt_pk_bf16_f32 v120, v138, v139
    v_exp_f32 v132, v52
    v_mfma_f32_32x32x16_bf16 v[16:31], a[204:207], a[172:175], v[16:31]
    ds_read_b128 a[252:255], v241 offset:23040
    buffer_load_dwordx4 v242, s[16:19], s41 offen offset:0 sc1 lds
    v_exp_f32 v133, v53
    s_waitcnt lgkmcnt(8)
    v_mfma_f32_32x32x16_bf16 v[16:31], a[208:211], a[176:179], v[16:31]
    ds_read_b128 a[192:195], v241 offset:8192
    v_cvt_pk_bf16_f32 v121, v130, v131
    v_add_f32 v138, v138, v130
    v_add_f32 v139, v139, v131
    v_exp_f32 v134, v54
    v_mfma_f32_32x32x16_bf16 v[16:31], a[212:215], a[180:183], v[16:31]
    ds_read_b128 a[196:199], v241 offset:8704
    v_exp_f32 v135, v55
    v_cvt_pk_bf16_f32 v122, v132, v133
    v_mfma_f32_32x32x16_bf16 v[16:31], a[216:219], a[184:187], v[16:31]
    ds_read_b128 a[200:203], v241 offset:10240
    buffer_load_dwordx4 v242, s[16:19], s41 offen offset:1024 sc1 lds
    v_add_f32 v138, v138, v132
    v_add_f32 v139, v139, v133
    v_exp_f32 v128, v56
    v_mfma_f32_32x32x16_bf16 v[16:31], a[220:223], a[188:191], v[16:31]
    ds_read_b128 a[204:207], v241 offset:10752
    v_exp_f32 v129, v57
    v_cvt_pk_bf16_f32 v123, v134, v135
    s_waitcnt lgkmcnt(8)
    v_mfma_f32_32x32x16_bf16 a[64:79], a[224:227], v[104:107], a[64:79]
    ds_read_b128 a[208:211], v241 offset:12288
    v_add_f32 v138, v138, v134
    v_add_f32 v139, v139, v135
    v_exp_f32 v130, v58
    v_mfma_f32_32x32x16_bf16 a[80:95], a[228:231], v[104:107], a[80:95]
    ds_read_b128 a[212:215], v241 offset:12800
    buffer_load_dwordx4 v242, s[16:19], s41 offen offset:2048 sc1 lds
    v_exp_f32 v131, v59
    v_cvt_pk_bf16_f32 v124, v128, v129
    v_add_f32 v138, v138, v128
    v_mfma_f32_32x32x16_bf16 a[96:111], a[232:235], v[104:107], a[96:111]
    ds_read_b128 a[216:219], v241 offset:14336
    v_add_f32 v139, v139, v129
    v_exp_f32 v132, v60
    v_exp_f32 v133, v61
    v_mfma_f32_32x32x16_bf16 a[112:127], a[236:239], v[104:107], a[112:127]
    ds_read_b128 a[220:223], v241 offset:14848
    v_cvt_pk_bf16_f32 v125, v130, v131
    v_add_f32 v138, v138, v130
    v_add_f32 v139, v139, v131
    s_waitcnt lgkmcnt(8)
    v_mfma_f32_32x32x16_bf16 a[64:79], a[240:243], v[108:111], a[64:79]
    ds_read_b128 a[224:227], v241 offset:24576
    buffer_load_dwordx4 v242, s[16:19], s41 offen offset:3072 sc1 lds
    v_exp_f32 v134, v62
    v_exp_f32 v135, v63
    v_mfma_f32_32x32x16_bf16 a[80:95], a[244:247], v[108:111], a[80:95]
    ds_read_b128 a[228:231], v241 offset:26624
    v_cvt_pk_bf16_f32 v126, v132, v133
    v_add_f32 v138, v138, v132
    v_add_f32 v139, v139, v133
    v_cvt_pk_bf16_f32 v127, v134, v135
    v_mfma_f32_32x32x16_bf16 a[96:111], a[248:251], v[108:111], a[96:111]
    ds_read_b128 a[232:235], v241 offset:28672
    v_add_f32 v138, v138, v134
    v_add_f32 v139, v139, v135
    v_add_f32 v225, v138, v139
    v_cmp_lt_f32 vcc, s38, v225
    v_mfma_f32_32x32x16_bf16 a[112:127], a[252:255], v[108:111], a[112:127]
    ds_read_b128 a[236:239], v241 offset:30720
    s_cbranch_vccnz kf_rare24
kf_rr23:
    s_sub_u32 s36, s36, 1
    s_cbranch_scc1 kf_fix25
kf_fixr26:
    s_waitcnt lgkmcnt(8)
    v_mfma_f32_32x32x16_bf16 v[48:63], a[192:195], a[160:163], v[80:95]
    ds_read_b128 a[240:243], v241 offset:25088
    v_add_f32 v227, v227, v225
    v_exp_f32 v138, v16
    v_exp_f32 v139, v17
    v_mfma_f32_32x32x16_bf16 v[48:63], a[196:199], a[164:167], v[48:63]
    ds_read_b128 a[244:247], v241 offset:27136
    s_add_u32 m0, s34, 16384
    s_add_u32 s34, s34, 32768
    s_cmp_ge_u32 s34, 163840
    s_cselect_b32 s34, s37, s34
    v_mfma_f32_32x32x16_bf16 v[48:63], a[200:203], a[168:171], v[48:63]
    ds_read_b128 a[248:251], v241 offset:29184
    v_exp_f32 v130, v18
    v_exp_f32 v131, v19
    v_cvt_pk_bf16_f32 v104, v138, v139
    v_mfma_f32_32x32x16_bf16 v[48:63], a[204:207], a[172:175], v[48:63]
    ds_read_b128 a[252:255], v241 offset:31232
    buffer_load_dwordx4 v242, s[16:19], s42 offen offset:0 sc1 lds
    v_exp_f32 v132, v20
    v_exp_f32 v133, v21
    s_waitcnt lgkmcnt(8)
    v_mfma_f32_32x32x16_bf16 v[48:63], a[208:211], a[176:179], v[48:63]
    s_waitcnt vmcnt(13)
    s_barrier
    s_add_u32 s35, s35, 32768
    s_cmp_ge_u32 s35, 163840
    s_cselect_b32 s35, 0, s35
    v_add_u32 v241, s35, v239
    ds_read_b128 a[192:195], v241 offset:0
    v_mfma_f32_32x32x16_bf16 v[48:63], a[212:215], a[180:183], v[48:63]
    ds_read_b128 a[196:199], v241 offset:512
    v_cvt_pk_bf16_f32 v105, v130, v131
    v_add_f32 v138, v138, v130
    v_add_f32 v139, v139, v131
    v_exp_f32 v134, v22
    v_mfma_f32_32x32x16_bf16 v[48:63], a[216:219], a[184:187], v[48:63]
    ds_read_b128 a[200:203], v241 offset:2048
    buffer_load_dwordx4 v242, s[16:19], s42 offen offset:1024 sc1 lds
    v_exp_f32 v135, v23
    v_cvt_pk_bf16_f32 v106, v132, v133
    v_add_f32 v138, v138, v132
    v_mfma_f32_32x32x16_bf16 v[48:63], a[220:223], a[188:191], v[48:63]
    ds_read_b128 a[204:207], v241 offset:2560
    v_add_f32 v139, v139, v133
    v_exp_f32 v128, v24
    s_waitcnt lgkmcnt(8)
    v_mfma_f32_32x32x16_bf16 a[64:79], a[224:227], v[120:123], a[64:79]
    ds_read_b128 a[208:211], v241 offset:4096
    v_exp_f32 v129, v25
    v_cvt_pk_bf16_f32 v107, v134, v135
    v_add_f32 v138, v138, v134
    v_add_f32 v139, v139, v135
    v_mfma_f32_32x32x16_bf16 a[80:95], a[228:231], v[120:123], a[80:95]
    ds_read_b128 a[212:215], v241 offset:4608
    buffer_load_dwordx4 v242, s[16:19], s42 offen offset:2048 sc1 lds
    v_exp_f32 v130, v26
    v_exp_f32 v131, v27
    v_mfma_f32_32x32x16_bf16 a[96:111], a[232:235], v[120:123], a[96:111]
    ds_read_b128 a[216:219], v241 offset:6144
    v_cvt_pk_bf16_f32 v108, v128, v129
    v_add_f32 v138, v138, v128
    v_add_f32 v139, v139, v129
    v_exp_f32 v132, v28
    v_mfma_f32_32x32x16_bf16 a[112:127], a[236:239], v[120:123], a[112:127]
    ds_read_b128 a[220:223], v241 offset:6656
    v_exp_f32 v133, v29
    v_cvt_pk_bf16_f32 v109, v130, v131
    v_add_f32 v138, v138, v130
    s_waitcnt lgkmcnt(8)
    v_mfma_f32_32x32x16_bf16 a[64:79], a[240:243], v[124:127], a[64:79]
    ds_read_b128 a[224:227], v241 offset:16384
    buffer_load_dwordx4 v242, s[16:19], s42 offen offset:3072 sc1 lds
    s_add_u32 s42, s42, 34048
    v_add_f32 v139, v139, v131
    v_exp_f32 v134, v30
    v_mfma_f32_32x32x16_bf16 a[80:95], a[244:247], v[124:127], a[80:95]
    ds_read_b128 a[228:231], v241 offset:18432
    v_exp_f32 v135, v31
    v_cvt_pk_bf16_f32 v110, v132, v133
    v_add_f32 v138, v138, v132
    v_add_f32 v139, v139, v133
    v_mfma_f32_32x32x16_bf16 a[96:111], a[248:251], v[124:127], a[96:111]
    ds_read_b128 a[232:235], v241 offset:20480
    v_cvt_pk_bf16_f32 v111, v134, v135
    v_add_f32 v138, v138, v134
    v_add_f32 v139, v139, v135
    v_add_f32 v225, v138, v139
    v_cmp_lt_f32 vcc, s38, v225
    v_mfma_f32_32x32x16_bf16 a[112:127], a[252:255], v[124:127], a[112:127]
    ds_read_b128 a[236:239], v241 offset:22528
    s_cbranch_vccnz kf_rare28
kf_rr27:
ka_p2_e:
    s_sub_u32 s26, s26, 1
    s_cbranch_scc0 ka_p2
    s_waitcnt lgkmcnt(0)
    ds_read_b128 a[224:227], v241 offset:16384
    ds_read_b128 a[228:231], v241 offset:18432
    ds_read_b128 a[232:235], v241 offset:20480
    ds_read_b128 a[236:239], v241 offset:22528
    ds_read_b128 a[240:243], v241 offset:16896
    ds_read_b128 a[244:247], v241 offset:18944
    ds_read_b128 a[248:251], v241 offset:20992
    ds_read_b128 a[252:255], v241 offset:23040
    ds_read_b128 a[192:195], v241 offset:24576
    ds_read_b128 a[196:199], v241 offset:26624
    ds_read_b128 a[200:203], v241 offset:28672
    ds_read_b128 a[204:207], v241 offset:30720
    ds_read_b128 a[208:211], v241 offset:25088
    ds_read_b128 a[212:215], v241 offset:27136
    ds_read_b128 a[216:219], v241 offset:29184
    s_waitcnt lgkmcnt(7)
    ds_read_b128 a[220:223], v241 offset:31232
    v_mfma_f32_32x32x16_bf16 a[64:79], a[224:227], v[104:107], a[64:79]
    v_add_f32 v227, v227, v225
    v_exp_f32 v138, v48
    v_exp_f32 v139, v49
    v_exp_f32 v130, v50
    v_exp_f32 v131, v51
    v_mfma_f32_32x32x16_bf16 a[80:95], a[228:231], v[104:107], a[80:95]
    v_cvt_pk_bf16_f32 v120, v138, v139
    v_exp_f32 v132, v52
    v_exp_f32 v133, v53
    v_cvt_pk_bf16_f32 v121, v130, v131
    v_add_f32 v138, v138, v130
    v_mfma_f32_32x32x16_bf16 a[96:111], a[232:235], v[104:107], a[96:111]
    v_add_f32 v139, v139, v131
    v_exp_f32 v134, v54
    v_exp_f32 v135, v55
    v_cvt_pk_bf16_f32 v122, v132, v133
    v_add_f32 v138, v138, v132
    v_add_f32 v139, v139, v133
    v_mfma_f32_32x32x16_bf16 a[112:127], a[236:239], v[104:107], a[112:127]
    v_exp_f32 v128, v56
    v_exp_f32 v129, v57
    v_cvt_pk_bf16_f32 v123, v134, v135
    v_add_f32 v138, v138, v134
    v_add_f32 v139, v139, v135
    v_exp_f32 v130, v58
    v_mfma_f32_32x32x16_bf16 a[64:79], a[240:243], v[108:111], a[64:79]
    v_exp_f32 v131, v59
    v_cvt_pk_bf16_f32 v124, v128, v129
    v_add_f32 v138, v138, v128
    v_add_f32 v139, v139, v129
    v_exp_f32 v132, v60
    v_mfma_f32_32x32x16_bf16 a[80:95], a[244:247], v[108:111], a[80:95]
    v_exp_f32 v133, v61
    v_cvt_pk_bf16_f32 v125, v130, v131
    v_add_f32 v138, v138, v130
    v_add_f32 v139, v139, v131
    v_exp_f32 v134, v62
    v_exp_f32 v135, v63
    v_mfma_f32_32x32x16_bf16 a[96:111], a[248:251], v[108:111], a[96:111]
    v_cvt_pk_bf16_f32 v126, v132, v133
    v_add_f32 v138, v138, v132
    v_add_f32 v139, v139, v133
    v_cvt_pk_bf16_f32 v127, v134, v135
    v_add_f32 v138, v138, v134
    v_add_f32 v139, v139, v135
    v_add_f32 v225, v138, v139
    v_cmp_lt_f32 vcc, s38, v225
    v_mfma_f32_32x32x16_bf16 a[112:127], a[252:255], v[108:111], a[112:127]
    s_cbranch_vccnz kf_rare30
kf_rr29:
    s_waitcnt lgkmcnt(0)
    v_add_f32 v227, v227, v225
    s_nop 0
    v_mfma_f32_32x32x16_bf16 a[64:79], a[192:195], v[120:123], a[64:79]
    v_mfma_f32_32x32x16_bf16 a[80:95], a[196:199], v[120:123], a[80:95]
    v_mfma_f32_32x32x16_bf16 a[96:111], a[200:203], v[120:123], a[96:111]
    v_mfma_f32_32x32x16_bf16 a[112:127], a[204:207], v[120:123], a[112:127]
    v_mfma_f32_32x32x16_bf16 a[64:79], a[208:211], v[124:127], a[64:79]
    v_mfma_f32_32x32x16_bf16 a[80:95], a[212:215], v[124:127], a[80:95]
    v_mfma_f32_32x32x16_bf16 a[96:111], a[216:219], v[124:127], a[96:111]
    v_mfma_f32_32x32x16_bf16 a[112:127], a[220:223], v[124:127], a[112:127]
    s_cmp_eq_u32 s31, 0
    s_cbranch_scc1 ka_nox
    s_waitcnt vmcnt(8)
    s_barrier
ka_nox:
    s_nop 7
    s_nop 7
    v_mov_b32 v230, v227
    s_nop 1
    v_permlane32_swap_b32 v227, v230
    s_nop 0
    v_add_f32 v230, v230, v227
    v_rcp_f32 v230, v230
    s_nop 0
    v_accvgpr_read_b32 v160, a64
    v_accvgpr_read_b32 v161, a65
    v_accvgpr_read_b32 v162, a66
    v_accvgpr_read_b32 v163, a67
    v_accvgpr_read_b32 v164, a68
    v_accvgpr_read_b32 v165, a69
    v_accvgpr_read_b32 v166, a70
    v_accvgpr_read_b32 v167, a71
    v_mul_f32 v160, v160, v230
    v_mul_f32 v161, v161, v230
    v_mul_f32 v162, v162, v230
    v_mul_f32 v163, v163, v230
    v_mul_f32 v164, v164, v230
    v_mul_f32 v165, v165, v230
    v_mul_f32 v166, v166, v230
    v_mul_f32 v167, v167, v230
    v_cvt_pk_bf16_f32 v176, v160, v161
    v_cvt_pk_bf16_f32 v177, v162, v163
    v_cvt_pk_bf16_f32 v178, v164, v165
    v_cvt_pk_bf16_f32 v179, v166, v167
    buffer_store_dwordx4 v[176:179], v244, s[20:23], s40 offen offset:0 sc1
    v_accvgpr_read_b32 v168, a72
    v_accvgpr_read_b32 v169, a73
    v_accvgpr_read_b32 v170, a74
    v_accvgpr_read_b32 v171, a75
    v_accvgpr_read_b32 v172, a76
    v_accvgpr_read_b32 v173, a77
    v_accvgpr_read_b32 v174, a78
    v_accvgpr_read_b32 v175, a79
    v_mul_f32 v168, v168, v230
    v_mul_f32 v169, v169, v230
    v_mul_f32 v170, v170, v230
    v_mul_f32 v171, v171, v230
    v_mul_f32 v172, v172, v230
    v_mul_f32 v173, v173, v230
    v_mul_f32 v174, v174, v230
    v_mul_f32 v175, v175, v230
    v_cvt_pk_bf16_f32 v180, v168, v169
    v_cvt_pk_bf16_f32 v181, v170, v171
    v_cvt_pk_bf16_f32 v182, v172, v173
    v_cvt_pk_bf16_f32 v183, v174, v175
    buffer_store_dwordx4 v[180:183], v244, s[20:23], s40 offen offset:512 sc1
    v_accvgpr_read_b32 v160, a80
    v_accvgpr_read_b32 v161, a81
    v_accvgpr_read_b32 v162, a82
    v_accvgpr_read_b32 v163, a83
    v_accvgpr_read_b32 v164, a84
    v_accvgpr_read_b32 v165, a85
    v_accvgpr_read_b32 v166, a86
    v_accvgpr_read_b32 v167, a87
    v_mul_f32 v160, v160, v230
    v_mul_f32 v161, v161, v230
    v_mul_f32 v162, v162, v230
    v_mul_f32 v163, v163, v230
    v_mul_f32 v164, v164, v230
    v_mul_f32 v165, v165, v230
    v_mul_f32 v166, v166, v230
    v_mul_f32 v167, v167, v230
    v_cvt_pk_bf16_f32 v184, v160, v161
    v_cvt_pk_bf16_f32 v185, v162, v163
    v_cvt_pk_bf16_f32 v186, v164, v165
    v_cvt_pk_bf16_f32 v187, v166, v167
    buffer_store_dwordx4 v[184:187], v244, s[20:23], s40 offen offset:1024 sc1
    v_accvgpr_read_b32 v168, a88
    v_accvgpr_read_b32 v169, a89
    v_accvgpr_read_b32 v170, a90
    v_accvgpr_read_b32 v171, a91
    v_accvgpr_read_b32 v172, a92
    v_accvgpr_read_b32 v173, a93
    v_accvgpr_read_b32 v174, a94
    v_accvgpr_read_b32 v175, a95
    v_mul_f32 v168, v168, v230
    v_mul_f32 v169, v169, v230
    v_mul_f32 v170, v170, v230
    v_mul_f32 v171, v171, v230
    v_mul_f32 v172, v172, v230
    v_mul_f32 v173, v173, v230
    v_mul_f32 v174, v174, v230
    v_mul_f32 v175, v175, v230
    v_cvt_pk_bf16_f32 v188, v168, v169
    v_cvt_pk_bf16_f32 v189, v170, v171
    v_cvt_pk_bf16_f32 v190, v172, v173
    v_cvt_pk_bf16_f32 v191, v174, v175
    buffer_store_dwordx4 v[188:191], v244, s[20:23], s40 offen offset:1536 sc1
    v_accvgpr_read_b32 v160, a96
    v_accvgpr_read_b32 v161, a97
    v_accvgpr_read_b32 v162, a98
    v_accvgpr_read_b32 v163, a99
    v_accvgpr_read_b32 v164, a100
    v_accvgpr_read_b32 v165, a101
    v_accvgpr_read_b32 v166, a102
    v_accvgpr_read_b32 v167, a103
    v_mul_f32 v160, v160, v230
    v_mul_f32 v161, v161, v230
    v_mul_f32 v162, v162, v230
    v_mul_f32 v163, v163, v230
    v_mul_f32 v164, v164, v230
    v_mul_f32 v165, v165, v230
    v_mul_f32 v166, v166, v230
    v_mul_f32 v167, v167, v230
    v_cvt_pk_bf16_f32 v176, v160, v161
    v_cvt_pk_bf16_f32 v177, v162, v163
    v_cvt_pk_bf16_f32 v178, v164, v165
    v_cvt_pk_bf16_f32 v179, v166, v167
    buffer_store_dwordx4 v[176:179], v244, s[20:23], s40 offen offset:2048 sc1
    v_accvgpr_read_b32 v168, a104
    v_accvgpr_read_b32 v169, a105
    v_accvgpr_read_b32 v170, a106
    v_accvgpr_read_b32 v171, a107
    v_accvgpr_read_b32 v172, a108
    v_accvgpr_read_b32 v173, a109
    v_accvgpr_read_b32 v174, a110
    v_accvgpr_read_b32 v175, a111
    v_mul_f32 v168, v168, v230
    v_mul_f32 v169, v169, v230
    v_mul_f32 v170, v170, v230
    v_mul_f32 v171, v171, v230
    v_mul_f32 v172, v172, v230
    v_mul_f32 v173, v173, v230
    v_mul_f32 v174, v174, v230
    v_mul_f32 v175, v175, v230
    v_cvt_pk_bf16_f32 v180, v168, v169
    v_cvt_pk_bf16_f32 v181, v170, v171
    v_cvt_pk_bf16_f32 v182, v172, v173
    v_cvt_pk_bf16_f32 v183, v174, v175
    buffer_store_dwordx4 v[180:183], v244, s[20:23], s40 offen offset:2560 sc1
    v_accvgpr_read_b32 v160, a112
    v_accvgpr_read_b32 v161, a113
    v_accvgpr_read_b32 v162, a114
    v_accvgpr_read_b32 v163, a115
    v_accvgpr_read_b32 v164, a116
    v_accvgpr_read_b32 v165, a117
    v_accvgpr_read_b32 v166, a118
    v_accvgpr_read_b32 v167, a119
    v_mul_f32 v160, v160, v230
    v_mul_f32 v161, v161, v230
    v_mul_f32 v162, v162, v230
    v_mul_f32 v163, v163, v230
    v_mul_f32 v164, v164, v230
    v_mul_f32 v165, v165, v230
    v_mul_f32 v166, v166, v230
    v_mul_f32 v167, v167, v230
    v_cvt_pk_bf16_f32 v184, v160, v161
    v_cvt_pk_bf16_f32 v185, v162, v163
    v_cvt_pk_bf16_f32 v186, v164, v165
    v_cvt_pk_bf16_f32 v187, v166, v167
    buffer_store_dwordx4 v[184:187], v244, s[20:23], s40 offen offset:3072 sc1
    v_accvgpr_read_b32 v168, a120
    v_accvgpr_read_b32 v169, a121
    v_accvgpr_read_b32 v170, a122
    v_accvgpr_read_b32 v171, a123
    v_accvgpr_read_b32 v172, a124
    v_accvgpr_read_b32 v173, a125
    v_accvgpr_read_b32 v174, a126
    v_accvgpr_read_b32 v175, a127
    v_mul_f32 v168, v168, v230
    v_mul_f32 v169, v169, v230
    v_mul_f32 v170, v170, v230
    v_mul_f32 v171, v171, v230
    v_mul_f32 v172, v172, v230
    v_mul_f32 v173, v173, v230
    v_mul_f32 v174, v174, v230
    v_mul_f32 v175, v175, v230
    v_cvt_pk_bf16_f32 v188, v168, v169
    v_cvt_pk_bf16_f32 v189, v170, v171
    v_cvt_pk_bf16_f32 v190, v172, v173
    v_cvt_pk_bf16_f32 v191, v174, v175
    buffer_store_dwordx4 v[188:191], v244, s[20:23], s40 offen offset:3584 sc1
    s_sub_u32 s46, s20, 0x2400000
    s_subb_u32 s47, s21, 0
    s_mov_b64 s[42:43], s[56:57]
    s_mov_b64 s[40:41], s[80:81]
    s_mov_b64 s[44:45], s[82:83]
    s_mov_b64 s[60:61], s[84:85]
    s_mov_b64 s[62:63], s[86:87]
    v_mbcnt_lo_u32_b32 v237, -1, 0
    v_mbcnt_hi_u32_b32 v237, -1, v237
    s_lshl_b32 s32, s3, 6
    v_add_u32 v230, s32, v237
    s_lshr_b32 s53, s2, 3
    s_lshr_b32 s6, s2, 1
    s_and_b32 s6, s6, 3
    s_and_b32 s4, s2, 1
    s_lshl_b32 s4, s4, 2
    s_and_b32 s33, s53, 3
    s_add_u32 s4, s4, s33
    s_lshr_b32 s5, s53, 2
    v_lshlrev_b32 v228, 4, v237
    v_lshrrev_b32 v234, 4, v237
    v_and_b32 v235, 15, v237
    v_lshlrev_b32 v236, 1, v234
    v_xor_b32 v235, v235, v236
    v_lshlrev_b32 v234, 11, v234
    s_lshl_b32 s32, s3, 14
    s_lshl_b32 s33, s5, 8
    s_add_u32 s32, s32, s33
    v_add_u32 v234, s32, v234
    v_lshl_add_u32 v224, v235, 4, v234
    v_xor_b32 v235, 8, v235
    v_lshl_add_u32 v225, v235, 4, v234
    v_add_u32 v225, 7168, v225
    s_lshl_b32 s37, s6, 21
    s_lshl_b32 s38, s3, 11
    s_lshl2_add_u32 s4, s4, s3
    s_sub_u32 s32, 63, s4
    s_cmp_lt_u32 s6, 2
    s_cselect_b32 s4, s4, s32
    s_lshl_b32 s32, s4, 18
    v_add_u32 v226, s32, v228
    v_add_u32 v227, 0x20000, v226
    v_xor_b32 v245, 0xfc0000, v226
    v_xor_b32 v246, 0xfc0000, v227
    s_lshl_b32 s35, s6, 15
    s_add_u32 s35, s35, 0x2400000
    s_getpc_b64 s[56:57]
kc_pc0:
    s_mov_b32 s58, kc_end-kc_pc0
    s_mov_b32 s59, 0x00020000
    v_lshlrev_b32 v234, 7, v230
    buffer_load_dword v241, v234, s[56:59], 0 offen
    s_waitcnt lgkmcnt(0)
    s_mov_b32 s8, s46
    s_mov_b32 s9, s47
    s_mov_b32 s10, 0x10000000
    s_mov_b32 s11, 0x00020000
    s_mov_b32 s12, s42
    s_mov_b32 s13, s43
    s_mov_b32 s14, 0x800000
    s_mov_b32 s15, 0x00020000
    s_mov_b32 s16, s40
    s_mov_b32 s17, s41
    s_mov_b32 s18, 0x400000
    s_mov_b32 s19, 0x00020000
    s_mov_b32 s20, s44
    s_mov_b32 s21, s45
    s_mov_b32 s22, 0x800
    s_mov_b32 s23, 0x00020000
    s_mov_b32 s24, s60
    s_mov_b32 s25, s61
    s_mov_b32 s26, 0x700000
    s_mov_b32 s27, 0x00020000
    s_mov_b32 s28, s62
    s_mov_b32 s29, s63
    s_mov_b32 s30, 0x400000
    s_mov_b32 s31, 0x00020000
    s_lshr_b32 s44, s6, 1
    s_and_b32 s6, s6, 1
    v_bfe_u32 v234, v237, 2, 3
    v_lshrrev_b32 v235, 5, v237
    v_lshl_add_u32 v235, v235, 4, v234
    v_lshlrev_b32 v235, 8, v235
    v_and_b32 v236, 1, v237
    v_lshl_add_u32 v235, v236, 3, v235
    v_lshlrev_b32 v234, 1, v234
    v_bfe_u32 v236, v237, 1, 1
    v_or_b32 v234, v234, v236
    s_lshl_b32 s32, s6, 3
    v_xor_b32 v234, s32, v234
    v_xor_b32 v236, 0, v234
    v_lshl_add_u32 v216, v236, 4, v235
    v_xor_b32 v236, 2, v234
    v_lshl_add_u32 v217, v236, 4, v235
    v_xor_b32 v236, 4, v234
    v_lshl_add_u32 v218, v236, 4, v235
    v_xor_b32 v236, 6, v234
    v_lshl_add_u32 v219, v236, 4, v235
    v_xor_b32 v236, 8, v234
    v_lshl_add_u32 v220, v236, 4, v235
    v_xor_b32 v236, 10, v234
    v_lshl_add_u32 v221, v236, 4, v235
    v_xor_b32 v236, 12, v234
    v_lshl_add_u32 v222, v236, 4, v235
    v_xor_b32 v236, 14, v234
    v_lshl_add_u32 v223, v236, 4, v235
    s_lshl_b32 s44, s4, 5
    v_lshrrev_b32 v234, 3, v237
    v_add_u32 v242, s44, v234
    v_and_b32 v235, 7, v237
    s_lshl1_add_u32 s33, s5, s6
    s_lshl_b32 s33, s33, 7
    v_lshl_add_u32 v240, v235, 4, s33
    v_lshl_add_u32 v229, v242, 11, v240
    s_mul_i32 s32, s3, 4608
    s_add_u32 s32, s32, 131072
    v_mul_u32_u24 v234, 144, v234
    v_lshl_add_u32 v234, v235, 4, v234
    v_add_u32 v239, s32, v234
    v_and_b32 v234, 15, v237
    v_mul_u32_u24 v234, 144, v234
    v_lshrrev_b32 v236, 4, v237
    v_lshl_add_u32 v234, v236, 3, v234
    v_add_u32 v238, s32, v234
    v_and_b32 v234, 3, v237
    v_lshl_add_u32 v234, v234, 3, v242
    v_lshlrev_b32 v234, 2, v234
    v_lshrrev_b32 v235, 2, v235
    v_lshl_add_u32 v231, v235, 13, v234
    v_lshlrev_b32 v235, 30, v235
    v_add_u32 v235, 16384, v235
    v_add_u32 v232, v235, v234
    s_cmp_eq_u32 s44, 0
    s_cselect_b32 s32, 4, 64
    v_cmp_eq_u32 vcc, s32, v237
    v_mov_b32 v235, 24576
    v_mov_b32 v233, 1
    v_cndmask_b32 v232, v232, v235, vcc
    v_and_b32 v234, 1, v237
    v_cmp_ne_u32 s[60:61], 0, v234
    v_and_b32 v234, 2, v237
    v_cmp_ne_u32 s[62:63], 0, v234
    v_and_b32 v234, 4, v237
    v_cmp_ne_u32 s[40:41], 0, v234
    v_cmp_eq_u32 vcc, 0, v237
    v_mov_b32 v235, 0x40000000
    s_nop 0
    v_cndmask_b32 v243, v235, v237, vcc
    s_lshl2_add_u32 s39, s2, s3
    s_mov_b32 s48, 0x3800000
    s_mov_b32 s49, 0x3802000
    s_mov_b32 s50, 0x3804000
    s_and_b32 s52, s2, 7
    s_mul_i32 s54, s52, 28
    s_add_u32 s54, s54, s53
    v_lshrrev_b32 v234, 3, v237
    v_lshlrev_b32 v234, 11, v234
    v_and_b32 v235, 7, v237
    v_lshl_add_u32 v244, v235, 4, v234
    s_lshl_b32 s55, s54, 16
    s_lshl_b32 s32, s3, 13
    s_add_u32 s55, s55, s32
    s_add_u32 s55, s55, 0x4000000
    s_lshl_b32 s51, s54, 15
    s_lshl_b32 s32, s3, 9
    s_add_u32 s51, s51, s32
    s_cmp_ge_u32 s53, 28
    s_cselect_b32 s55, 0x40000000, s55
    s_cselect_b32 s51, 0x40000000, s51
    s_lshr_b32 s32, s2, 5
    s_lshl_b32 s32, s32, 9
    s_and_b32 s33, s2, 6
    s_lshl_b32 s33, s33, 6
    s_add_u32 s32, s32, s33
    s_add_u32 s32, s32, 0x38a4000
    s_waitcnt vmcnt(0)
    s_barrier
    s_cmp_lg_u32 s3, 0
    s_cbranch_scc1 kc_a0
    buffer_atomic_add v233, v243, s[8:11], s32 offen sc1
    s_lshl_b32 s32, s52, 7
    s_add_u32 s32, s32, 0x38a1000
    v_mov_b32 v235, 1
    buffer_atomic_add v235, v243, s[8:11], s32 offen sc0 sc1
    v_lshlrev_b32 v234, 7, v237
    v_cmp_gt_u32 vcc, 8, v237
    v_mov_b32 v236, 0x40000000
    s_mov_b32 s34, 0x38a1400
    v_cndmask_b32 v234, v236, v234, vcc
    s_waitcnt vmcnt(0)
    v_readfirstlane_b32 s36, v235
    s_cmp_lg_u32 s36, 31
    s_cbranch_scc1 kc_a0
    buffer_atomic_add v233, v234, s[8:11], s34 offen sc1
kc_a0:
    s_add_u32 m0, s38, 0
    s_add_u32 s32, s37, 0
    buffer_load_dwordx4 v224, s[12:15], s32 offen lds
    buffer_load_dwordx4 v225, s[12:15], s32 offen offset:1024 lds
    s_add_u32 m0, s38, 8192
    s_add_u32 s32, s37, 65536
    buffer_load_dwordx4 v224, s[12:15], s32 offen lds
    buffer_load_dwordx4 v225, s[12:15], s32 offen offset:1024 lds
    s_add_u32 m0, s38, 16384
    s_add_u32 s32, s37, 131072
    buffer_load_dwordx4 v224, s[12:15], s32 offen lds
    buffer_load_dwordx4 v225, s[12:15], s32 offen offset:1024 lds
    s_add_u32 m0, s38, 24576
    s_add_u32 s32, s37, 196608
    buffer_load_dwordx4 v224, s[12:15], s32 offen lds
    buffer_load_dwordx4 v225, s[12:15], s32 offen offset:1024 lds
    s_add_u32 m0, s38, 32768
    s_add_u32 s32, s37, 262144
    buffer_load_dwordx4 v224, s[12:15], s32 offen lds
    buffer_load_dwordx4 v225, s[12:15], s32 offen offset:1024 lds
    s_add_u32 m0, s38, 40960
    s_add_u32 s32, s37, 327680
    buffer_load_dwordx4 v224, s[12:15], s32 offen lds
    buffer_load_dwordx4 v225, s[12:15], s32 offen offset:1024 lds
    s_add_u32 m0, s38, 49152
    s_add_u32 s32, s37, 393216
    buffer_load_dwordx4 v224, s[12:15], s32 offen lds
    buffer_load_dwordx4 v225, s[12:15], s32 offen offset:1024 lds
    s_add_u32 m0, s38, 57344
    s_add_u32 s32, s37, 458752
    buffer_load_dwordx4 v224, s[12:15], s32 offen lds
    buffer_load_dwordx4 v225, s[12:15], s32 offen offset:1024 lds
    s_add_u32 m0, s38, 65536
    s_add_u32 s32, s37, 524288
    buffer_load_dwordx4 v224, s[12:15], s32 offen lds
    buffer_load_dwordx4 v225, s[12:15], s32 offen offset:1024 lds
    s_add_u32 m0, s38, 73728
    s_add_u32 s32, s37, 589824
    buffer_load_dwordx4 v224, s[12:15], s32 offen lds
    buffer_load_dwordx4 v225, s[12:15], s32 offen offset:1024 lds
    s_add_u32 m0, s38, 81920
    s_add_u32 s32, s37, 655360
    buffer_load_dwordx4 v224, s[12:15], s32 offen lds
    buffer_load_dwordx4 v225, s[12:15], s32 offen offset:1024 lds
    s_add_u32 m0, s38, 90112
    s_add_u32 s32, s37, 720896
    buffer_load_dwordx4 v224, s[12:15], s32 offen lds
    buffer_load_dwordx4 v225, s[12:15], s32 offen offset:1024 lds
    s_add_u32 m0, s38, 98304
    s_add_u32 s32, s37, 786432
    buffer_load_dwordx4 v224, s[12:15], s32 offen lds
    buffer_load_dwordx4 v225, s[12:15], s32 offen offset:1024 lds
    s_add_u32 m0, s38, 106496
    s_add_u32 s32, s37, 851968
    buffer_load_dwordx4 v224, s[12:15], s32 offen lds
    buffer_load_dwordx4 v225, s[12:15], s32 offen offset:1024 lds
    s_add_u32 m0, s38, 114688
    s_add_u32 s32, s37, 917504
    buffer_load_dwordx4 v224, s[12:15], s32 offen lds
    buffer_load_dwordx4 v225, s[12:15], s32 offen offset:1024 lds
    s_add_u32 m0, s38, 122880
    s_add_u32 s32, s37, 983040
    buffer_load_dwordx4 v224, s[12:15], s32 offen lds
    buffer_load_dwordx4 v225, s[12:15], s32 offen offset:1024 lds
    s_add_u32 s33, s51, 0
    buffer_load_dwordx4 a[192:195], v244, s[24:27], s33 offen offset:0
    s_add_u32 s33, s51, 16384
    buffer_load_dwordx4 a[196:199], v244, s[24:27], s33 offen offset:0
    s_add_u32 s33, s51, 0
    buffer_load_dwordx4 a[200:203], v244, s[24:27], s33 offen offset:128
    s_add_u32 s33, s51, 16384
    buffer_load_dwordx4 a[204:207], v244, s[24:27], s33 offen offset:128
    s_add_u32 s33, s51, 0
    buffer_load_dwordx4 a[208:211], v244, s[24:27], s33 offen offset:256
    s_add_u32 s33, s51, 16384
    buffer_load_dwordx4 a[212:215], v244, s[24:27], s33 offen offset:256
    s_add_u32 s33, s51, 0
    buffer_load_dwordx4 a[216:219], v244, s[24:27], s33 offen offset:384
    s_add_u32 s33, s51, 16384
    buffer_load_dwordx4 a[220:223], v244, s[24:27], s33 offen offset:384
    s_cmp_lg_u32 s3, 0
    s_cbranch_scc1 kc_b02
    s_and_b32 s32, s2, 1
    s_lshl_b32 s32, s32, 2
    s_and_b32 s33, s53, 3
    s_add_u32 s32, s32, s33
    s_lshl_b32 s32, s32, 9
    s_and_b32 s33, s2, 6
    s_lshl_b32 s33, s33, 6
    s_add_u32 s32, s32, s33
    s_add_u32 s32, s32, 0x38a4000
    s_mov_b32 s34, 0x400000
    s_branch kc_b01
kc_b00:
    s_sleep 2
kc_b01:
    buffer_load_dword v235, off, s[8:11], s32 sc1
    s_waitcnt vmcnt(0)
    v_cmp_ne_u32 vcc, 8, v235
    s_sub_u32 s34, s34, 1
    s_cbranch_scc1 kc_b02
    s_cbranch_vccnz kc_b00
kc_b02:
    s_waitcnt vmcnt(8)
    s_barrier
    buffer_load_dwordx4 a[0:3], v226, s[8:11], s35 offen offset:0 sc1
    buffer_load_dwordx4 a[4:7], v227, s[8:11], s35 offen offset:0 sc1
    buffer_load_dwordx4 a[8:11], v245, s[8:11], s35 offen offset:0 sc1
    buffer_load_dwordx4 a[12:15], v246, s[8:11], s35 offen offset:0 sc1
    buffer_load_dwordx4 a[16:19], v226, s[8:11], s35 offen offset:1024 sc1
    buffer_load_dwordx4 a[20:23], v227, s[8:11], s35 offen offset:1024 sc1
    buffer_load_dwordx4 a[24:27], v245, s[8:11], s35 offen offset:1024 sc1
    buffer_load_dwordx4 a[28:31], v246, s[8:11], s35 offen offset:1024 sc1
    buffer_load_dwordx4 a[32:35], v226, s[8:11], s35 offen offset:2048 sc1
    buffer_load_dwordx4 a[36:39], v227, s[8:11], s35 offen offset:2048 sc1
    buffer_load_dwordx4 a[40:43], v245, s[8:11], s35 offen offset:2048 sc1
    buffer_load_dwordx4 a[44:47], v246, s[8:11], s35 offen offset:2048 sc1
    buffer_load_dwordx4 a[48:51], v226, s[8:11], s35 offen offset:3072 sc1
    buffer_load_dwordx4 a[52:55], v227, s[8:11], s35 offen offset:3072 sc1
    buffer_load_dwordx4 a[56:59], v245, s[8:11], s35 offen offset:3072 sc1
    buffer_load_dwordx4 a[60:63], v246, s[8:11], s35 offen offset:3072 sc1
    ds_read_b64_tr_b16 v[128:129], v216 offset:0
    ds_read_b64_tr_b16 v[130:131], v216 offset:2048
    ds_read_b64_tr_b16 v[132:133], v217 offset:0
    ds_read_b64_tr_b16 v[134:135], v217 offset:2048
    ds_read_b64_tr_b16 v[136:137], v218 offset:0
    ds_read_b64_tr_b16 v[138:139], v218 offset:2048
    ds_read_b64_tr_b16 v[140:141], v219 offset:0
    ds_read_b64_tr_b16 v[142:143], v219 offset:2048
    s_waitcnt vmcnt(12) lgkmcnt(0)
    v_mfma_f32_16x16x32_bf16 v[32:35], v[128:131], a[0:3], 0
    ds_read_b64_tr_b16 v[144:145], v220 offset:0
    v_mfma_f32_16x16x32_bf16 v[36:39], v[128:131], a[4:7], 0
    ds_read_b64_tr_b16 v[146:147], v220 offset:2048
    v_mfma_f32_16x16x32_bf16 v[64:67], v[128:131], a[8:11], 0
    ds_read_b64_tr_b16 v[148:149], v221 offset:0
    v_mfma_f32_16x16x32_bf16 v[68:71], v[128:131], a[12:15], 0
    ds_read_b64_tr_b16 v[150:151], v221 offset:2048
    v_mfma_f32_16x16x32_bf16 v[40:43], v[132:135], a[0:3], 0
    ds_read_b64_tr_b16 v[152:153], v222 offset:0
    v_mfma_f32_16x16x32_bf16 v[44:47], v[132:135], a[4:7], 0
    ds_read_b64_tr_b16 v[154:155], v222 offset:2048
    v_mfma_f32_16x16x32_bf16 v[72:75], v[132:135], a[8:11], 0
    ds_read_b64_tr_b16 v[156:157], v223 offset:0
    v_mfma_f32_16x16x32_bf16 v[76:79], v[132:135], a[12:15], 0
    ds_read_b64_tr_b16 v[158:159], v223 offset:2048
    v_mfma_f32_16x16x32_bf16 v[48:51], v[136:139], a[0:3], 0
    s_add_u32 s35, s35, 4096
    buffer_load_dwordx4 a[64:67], v226, s[8:11], s35 offen offset:0 sc1
    v_mfma_f32_16x16x32_bf16 v[52:55], v[136:139], a[4:7], 0
    v_mfma_f32_16x16x32_bf16 v[80:83], v[136:139], a[8:11], 0
    v_mfma_f32_16x16x32_bf16 v[84:87], v[136:139], a[12:15], 0
    buffer_load_dwordx4 a[68:71], v227, s[8:11], s35 offen offset:0 sc1
    v_mfma_f32_16x16x32_bf16 v[56:59], v[140:143], a[0:3], 0
    v_mfma_f32_16x16x32_bf16 v[60:63], v[140:143], a[4:7], 0
    v_mfma_f32_16x16x32_bf16 v[88:91], v[140:143], a[8:11], 0
    v_mfma_f32_16x16x32_bf16 v[92:95], v[140:143], a[12:15], 0
    s_waitcnt lgkmcnt(0)
    v_mfma_f32_16x16x32_bf16 v[0:3], v[144:147], a[0:3], 0
    ds_read_b64_tr_b16 v[128:129], v216 offset:8192
    v_mfma_f32_16x16x32_bf16 v[4:7], v[144:147], a[4:7], 0
    ds_read_b64_tr_b16 v[130:131], v216 offset:10240
    v_mfma_f32_16x16x32_bf16 v[96:99], v[144:147], a[8:11], 0
    ds_read_b64_tr_b16 v[132:133], v217 offset:8192
    v_mfma_f32_16x16x32_bf16 v[100:103], v[144:147], a[12:15], 0
    ds_read_b64_tr_b16 v[134:135], v217 offset:10240
    v_mfma_f32_16x16x32_bf16 v[8:11], v[148:151], a[0:3], 0
    ds_read_b64_tr_b16 v[136:137], v218 offset:8192
    v_mfma_f32_16x16x32_bf16 v[12:15], v[148:151], a[4:7], 0
    ds_read_b64_tr_b16 v[138:139], v218 offset:10240
    v_mfma_f32_16x16x32_bf16 v[104:107], v[148:151], a[8:11], 0
    ds_read_b64_tr_b16 v[140:141], v219 offset:8192
    v_mfma_f32_16x16x32_bf16 v[108:111], v[148:151], a[12:15], 0
    ds_read_b64_tr_b16 v[142:143], v219 offset:10240
    v_mfma_f32_16x16x32_bf16 v[16:19], v[152:155], a[0:3], 0
    buffer_load_dwordx4 a[72:75], v245, s[8:11], s35 offen offset:0 sc1
    v_mfma_f32_16x16x32_bf16 v[20:23], v[152:155], a[4:7], 0
    v_mfma_f32_16x16x32_bf16 v[112:115], v[152:155], a[8:11], 0
    v_mfma_f32_16x16x32_bf16 v[116:119], v[152:155], a[12:15], 0
    v_mfma_f32_16x16x32_bf16 v[24:27], v[156:159], a[0:3], 0
    buffer_load_dwordx4 a[76:79], v246, s[8:11], s35 offen offset:0 sc1
    v_mfma_f32_16x16x32_bf16 v[28:31], v[156:159], a[4:7], 0
    v_mfma_f32_16x16x32_bf16 v[120:123], v[156:159], a[8:11], 0
    v_mfma_f32_16x16x32_bf16 v[124:127], v[156:159], a[12:15], 0
    buffer_load_dwordx4 a[80:83], v226, s[8:11], s35 offen offset:1024 sc1
    s_waitcnt vmcnt(13) lgkmcnt(0)
    v_mfma_f32_16x16x32_bf16 v[32:35], v[128:131], a[16:19], v[32:35]
    ds_read_b64_tr_b16 v[144:145], v220 offset:8192
    v_mfma_f32_16x16x32_bf16 v[36:39], v[128:131], a[20:23], v[36:39]
    ds_read_b64_tr_b16 v[146:147], v220 offset:10240
    v_mfma_f32_16x16x32_bf16 v[64:67], v[128:131], a[24:27], v[64:67]
    ds_read_b64_tr_b16 v[148:149], v221 offset:8192
    v_mfma_f32_16x16x32_bf16 v[68:71], v[128:131], a[28:31], v[68:71]
    ds_read_b64_tr_b16 v[150:151], v221 offset:10240
    v_mfma_f32_16x16x32_bf16 v[40:43], v[132:135], a[16:19], v[40:43]
    ds_read_b64_tr_b16 v[152:153], v222 offset:8192
    v_mfma_f32_16x16x32_bf16 v[44:47], v[132:135], a[20:23], v[44:47]
    ds_read_b64_tr_b16 v[154:155], v222 offset:10240
    v_mfma_f32_16x16x32_bf16 v[72:75], v[132:135], a[24:27], v[72:75]
    ds_read_b64_tr_b16 v[156:157], v223 offset:8192
    v_mfma_f32_16x16x32_bf16 v[76:79], v[132:135], a[28:31], v[76:79]
    ds_read_b64_tr_b16 v[158:159], v223 offset:10240
    v_mfma_f32_16x16x32_bf16 v[48:51], v[136:139], a[16:19], v[48:51]
    buffer_load_dwordx4 a[84:87], v227, s[8:11], s35 offen offset:1024 sc1
    v_mfma_f32_16x16x32_bf16 v[52:55], v[136:139], a[20:23], v[52:55]
    v_mfma_f32_16x16x32_bf16 v[80:83], v[136:139], a[24:27], v[80:83]
    v_mfma_f32_16x16x32_bf16 v[84:87], v[136:139], a[28:31], v[84:87]
    buffer_load_dwordx4 a[88:91], v245, s[8:11], s35 offen offset:1024 sc1
    v_mfma_f32_16x16x32_bf16 v[56:59], v[140:143], a[16:19], v[56:59]
    v_mfma_f32_16x16x32_bf16 v[60:63], v[140:143], a[20:23], v[60:63]
    v_mfma_f32_16x16x32_bf16 v[88:91], v[140:143], a[24:27], v[88:91]
    v_mfma_f32_16x16x32_bf16 v[92:95], v[140:143], a[28:31], v[92:95]
    s_waitcnt lgkmcnt(0)
    v_mfma_f32_16x16x32_bf16 v[0:3], v[144:147], a[16:19], v[0:3]
    ds_read_b64_tr_b16 v[128:129], v216 offset:16384
    v_mfma_f32_16x16x32_bf16 v[4:7], v[144:147], a[20:23], v[4:7]
    ds_read_b64_tr_b16 v[130:131], v216 offset:18432
    v_mfma_f32_16x16x32_bf16 v[96:99], v[144:147], a[24:27], v[96:99]
    ds_read_b64_tr_b16 v[132:133], v217 offset:16384
    v_mfma_f32_16x16x32_bf16 v[100:103], v[144:147], a[28:31], v[100:103]
    ds_read_b64_tr_b16 v[134:135], v217 offset:18432
    v_mfma_f32_16x16x32_bf16 v[8:11], v[148:151], a[16:19], v[8:11]
    ds_read_b64_tr_b16 v[136:137], v218 offset:16384
    v_mfma_f32_16x16x32_bf16 v[12:15], v[148:151], a[20:23], v[12:15]
    ds_read_b64_tr_b16 v[138:139], v218 offset:18432
    v_mfma_f32_16x16x32_bf16 v[104:107], v[148:151], a[24:27], v[104:107]
    ds_read_b64_tr_b16 v[140:141], v219 offset:16384
    v_mfma_f32_16x16x32_bf16 v[108:111], v[148:151], a[28:31], v[108:111]
    ds_read_b64_tr_b16 v[142:143], v219 offset:18432
    v_mfma_f32_16x16x32_bf16 v[16:19], v[152:155], a[16:19], v[16:19]
    buffer_load_dwordx4 a[92:95], v246, s[8:11], s35 offen offset:1024 sc1
    v_mfma_f32_16x16x32_bf16 v[20:23], v[152:155], a[20:23], v[20:23]
    v_mfma_f32_16x16x32_bf16 v[112:115], v[152:155], a[24:27], v[112:115]
    v_mfma_f32_16x16x32_bf16 v[116:119], v[152:155], a[28:31], v[116:119]
    v_mfma_f32_16x16x32_bf16 v[24:27], v[156:159], a[16:19], v[24:27]
    buffer_load_dwordx4 a[96:99], v226, s[8:11], s35 offen offset:2048 sc1
    v_mfma_f32_16x16x32_bf16 v[28:31], v[156:159], a[20:23], v[28:31]
    v_mfma_f32_16x16x32_bf16 v[120:123], v[156:159], a[24:27], v[120:123]
    v_mfma_f32_16x16x32_bf16 v[124:127], v[156:159], a[28:31], v[124:127]
    s_waitcnt vmcnt(13) lgkmcnt(0)
    v_mfma_f32_16x16x32_bf16 v[32:35], v[128:131], a[32:35], v[32:35]
    ds_read_b64_tr_b16 v[144:145], v220 offset:16384
    v_mfma_f32_16x16x32_bf16 v[36:39], v[128:131], a[36:39], v[36:39]
    ds_read_b64_tr_b16 v[146:147], v220 offset:18432
    v_mfma_f32_16x16x32_bf16 v[64:67], v[128:131], a[40:43], v[64:67]
    ds_read_b64_tr_b16 v[148:149], v221 offset:16384
    v_mfma_f32_16x16x32_bf16 v[68:71], v[128:131], a[44:47], v[68:71]
    ds_read_b64_tr_b16 v[150:151], v221 offset:18432
    v_mfma_f32_16x16x32_bf16 v[40:43], v[132:135], a[32:35], v[40:43]
    ds_read_b64_tr_b16 v[152:153], v222 offset:16384
    v_mfma_f32_16x16x32_bf16 v[44:47], v[132:135], a[36:39], v[44:47]
    ds_read_b64_tr_b16 v[154:155], v222 offset:18432
    v_mfma_f32_16x16x32_bf16 v[72:75], v[132:135], a[40:43], v[72:75]
    ds_read_b64_tr_b16 v[156:157], v223 offset:16384
    v_mfma_f32_16x16x32_bf16 v[76:79], v[132:135], a[44:47], v[76:79]
    ds_read_b64_tr_b16 v[158:159], v223 offset:18432
    v_mfma_f32_16x16x32_bf16 v[48:51], v[136:139], a[32:35], v[48:51]
    buffer_load_dwordx4 a[100:103], v227, s[8:11], s35 offen offset:2048 sc1
    v_mfma_f32_16x16x32_bf16 v[52:55], v[136:139], a[36:39], v[52:55]
    v_mfma_f32_16x16x32_bf16 v[80:83], v[136:139], a[40:43], v[80:83]
    v_mfma_f32_16x16x32_bf16 v[84:87], v[136:139], a[44:47], v[84:87]
    buffer_load_dwordx4 a[104:107], v245, s[8:11], s35 offen offset:2048 sc1
    v_mfma_f32_16x16x32_bf16 v[56:59], v[140:143], a[32:35], v[56:59]
    v_mfma_f32_16x16x32_bf16 v[60:63], v[140:143], a[36:39], v[60:63]
    v_mfma_f32_16x16x32_bf16 v[88:91], v[140:143], a[40:43], v[88:91]
    v_mfma_f32_16x16x32_bf16 v[92:95], v[140:143], a[44:47], v[92:95]
    s_waitcnt lgkmcnt(0)
    v_mfma_f32_16x16x32_bf16 v[0:3], v[144:147], a[32:35], v[0:3]
    ds_read_b64_tr_b16 v[128:129], v216 offset:24576
    v_mfma_f32_16x16x32_bf16 v[4:7], v[144:147], a[36:39], v[4:7]
    ds_read_b64_tr_b16 v[130:131], v216 offset:26624
    v_mfma_f32_16x16x32_bf16 v[96:99], v[144:147], a[40:43], v[96:99]
    ds_read_b64_tr_b16 v[132:133], v217 offset:24576
    v_mfma_f32_16x16x32_bf16 v[100:103], v[144:147], a[44:47], v[100:103]
    ds_read_b64_tr_b16 v[134:135], v217 offset:26624
    v_mfma_f32_16x16x32_bf16 v[8:11], v[148:151], a[32:35], v[8:11]
    ds_read_b64_tr_b16 v[136:137], v218 offset:24576
    v_mfma_f32_16x16x32_bf16 v[12:15], v[148:151], a[36:39], v[12:15]
    ds_read_b64_tr_b16 v[138:139], v218 offset:26624
    v_mfma_f32_16x16x32_bf16 v[104:107], v[148:151], a[40:43], v[104:107]
    ds_read_b64_tr_b16 v[140:141], v219 offset:24576
    v_mfma_f32_16x16x32_bf16 v[108:111], v[148:151], a[44:47], v[108:111]
    ds_read_b64_tr_b16 v[142:143], v219 offset:26624
    v_mfma_f32_16x16x32_bf16 v[16:19], v[152:155], a[32:35], v[16:19]
    buffer_load_dwordx4 a[108:111], v246, s[8:11], s35 offen offset:2048 sc1
    v_mfma_f32_16x16x32_bf16 v[20:23], v[152:155], a[36:39], v[20:23]
    v_mfma_f32_16x16x32_bf16 v[112:115], v[152:155], a[40:43], v[112:115]
    v_mfma_f32_16x16x32_bf16 v[116:119], v[152:155], a[44:47], v[116:119]
    v_mfma_f32_16x16x32_bf16 v[24:27], v[156:159], a[32:35], v[24:27]
    buffer_load_dwordx4 a[112:115], v226, s[8:11], s35 offen offset:3072 sc1
    v_mfma_f32_16x16x32_bf16 v[28:31], v[156:159], a[36:39], v[28:31]
    v_mfma_f32_16x16x32_bf16 v[120:123], v[156:159], a[40:43], v[120:123]
    v_mfma_f32_16x16x32_bf16 v[124:127], v[156:159], a[44:47], v[124:127]
    buffer_load_dwordx4 a[116:119], v227, s[8:11], s35 offen offset:3072 sc1
    s_waitcnt vmcnt(14) lgkmcnt(0)
    v_mfma_f32_16x16x32_bf16 v[32:35], v[128:131], a[48:51], v[32:35]
    ds_read_b64_tr_b16 v[144:145], v220 offset:24576
    v_mfma_f32_16x16x32_bf16 v[36:39], v[128:131], a[52:55], v[36:39]
    ds_read_b64_tr_b16 v[146:147], v220 offset:26624
    v_mfma_f32_16x16x32_bf16 v[64:67], v[128:131], a[56:59], v[64:67]
    ds_read_b64_tr_b16 v[148:149], v221 offset:24576
    v_mfma_f32_16x16x32_bf16 v[68:71], v[128:131], a[60:63], v[68:71]
    ds_read_b64_tr_b16 v[150:151], v221 offset:26624
    v_mfma_f32_16x16x32_bf16 v[40:43], v[132:135], a[48:51], v[40:43]
    ds_read_b64_tr_b16 v[152:153], v222 offset:24576
    v_mfma_f32_16x16x32_bf16 v[44:47], v[132:135], a[52:55], v[44:47]
    ds_read_b64_tr_b16 v[154:155], v222 offset:26624
    v_mfma_f32_16x16x32_bf16 v[72:75], v[132:135], a[56:59], v[72:75]
    ds_read_b64_tr_b16 v[156:157], v223 offset:24576
    v_mfma_f32_16x16x32_bf16 v[76:79], v[132:135], a[60:63], v[76:79]
    ds_read_b64_tr_b16 v[158:159], v223 offset:26624
    v_mfma_f32_16x16x32_bf16 v[48:51], v[136:139], a[48:51], v[48:51]
    buffer_load_dwordx4 a[120:123], v245, s[8:11], s35 offen offset:3072 sc1
    v_mfma_f32_16x16x32_bf16 v[52:55], v[136:139], a[52:55], v[52:55]
    v_mfma_f32_16x16x32_bf16 v[80:83], v[136:139], a[56:59], v[80:83]
    v_mfma_f32_16x16x32_bf16 v[84:87], v[136:139], a[60:63], v[84:87]
    buffer_load_dwordx4 a[124:127], v246, s[8:11], s35 offen offset:3072 sc1
    v_mfma_f32_16x16x32_bf16 v[56:59], v[140:143], a[48:51], v[56:59]
    v_mfma_f32_16x16x32_bf16 v[60:63], v[140:143], a[52:55], v[60:63]
    v_mfma_f32_16x16x32_bf16 v[88:91], v[140:143], a[56:59], v[88:91]
    v_mfma_f32_16x16x32_bf16 v[92:95], v[140:143], a[60:63], v[92:95]
    s_waitcnt lgkmcnt(0)
    s_barrier
    v_mfma_f32_16x16x32_bf16 v[0:3], v[144:147], a[48:51], v[0:3]
    ds_read_b64_tr_b16 v[128:129], v216 offset:32768
    v_mfma_f32_16x16x32_bf16 v[4:7], v[144:147], a[52:55], v[4:7]
    ds_read_b64_tr_b16 v[130:131], v216 offset:34816
    v_mfma_f32_16x16x32_bf16 v[96:99], v[144:147], a[56:59], v[96:99]
    ds_read_b64_tr_b16 v[132:133], v217 offset:32768
    v_mfma_f32_16x16x32_bf16 v[100:103], v[144:147], a[60:63], v[100:103]
    ds_read_b64_tr_b16 v[134:135], v217 offset:34816
    v_mfma_f32_16x16x32_bf16 v[8:11], v[148:151], a[48:51], v[8:11]
    ds_read_b64_tr_b16 v[136:137], v218 offset:32768
    v_mfma_f32_16x16x32_bf16 v[12:15], v[148:151], a[52:55], v[12:15]
    ds_read_b64_tr_b16 v[138:139], v218 offset:34816
    v_mfma_f32_16x16x32_bf16 v[104:107], v[148:151], a[56:59], v[104:107]
    ds_read_b64_tr_b16 v[140:141], v219 offset:32768
    v_mfma_f32_16x16x32_bf16 v[108:111], v[148:151], a[60:63], v[108:111]
    ds_read_b64_tr_b16 v[142:143], v219 offset:34816
    v_mfma_f32_16x16x32_bf16 v[16:19], v[152:155], a[48:51], v[16:19]
    s_add_u32 s35, s35, 4096
    buffer_load_dwordx4 a[0:3], v226, s[8:11], s35 offen offset:0 sc1
    v_mfma_f32_16x16x32_bf16 v[20:23], v[152:155], a[52:55], v[20:23]
    v_mfma_f32_16x16x32_bf16 v[112:115], v[152:155], a[56:59], v[112:115]
    v_mfma_f32_16x16x32_bf16 v[116:119], v[152:155], a[60:63], v[116:119]
    v_mfma_f32_16x16x32_bf16 v[24:27], v[156:159], a[48:51], v[24:27]
    buffer_load_dwordx4 a[4:7], v227, s[8:11], s35 offen offset:0 sc1
    v_mfma_f32_16x16x32_bf16 v[28:31], v[156:159], a[52:55], v[28:31]
    v_mfma_f32_16x16x32_bf16 v[120:123], v[156:159], a[56:59], v[120:123]
    v_mfma_f32_16x16x32_bf16 v[124:127], v[156:159], a[60:63], v[124:127]
    s_waitcnt vmcnt(14) lgkmcnt(0)
    v_mfma_f32_16x16x32_bf16 v[32:35], v[128:131], a[64:67], v[32:35]
    ds_read_b64_tr_b16 v[144:145], v220 offset:32768
    v_mfma_f32_16x16x32_bf16 v[36:39], v[128:131], a[68:71], v[36:39]
    ds_read_b64_tr_b16 v[146:147], v220 offset:34816
    v_mfma_f32_16x16x32_bf16 v[64:67], v[128:131], a[72:75], v[64:67]
    ds_read_b64_tr_b16 v[148:149], v221 offset:32768
    v_mfma_f32_16x16x32_bf16 v[68:71], v[128:131], a[76:79], v[68:71]
    ds_read_b64_tr_b16 v[150:151], v221 offset:34816
    v_mfma_f32_16x16x32_bf16 v[40:43], v[132:135], a[64:67], v[40:43]
    ds_read_b64_tr_b16 v[152:153], v222 offset:32768
    v_mfma_f32_16x16x32_bf16 v[44:47], v[132:135], a[68:71], v[44:47]
    ds_read_b64_tr_b16 v[154:155], v222 offset:34816
    v_mfma_f32_16x16x32_bf16 v[72:75], v[132:135], a[72:75], v[72:75]
    ds_read_b64_tr_b16 v[156:157], v223 offset:32768
    v_mfma_f32_16x16x32_bf16 v[76:79], v[132:135], a[76:79], v[76:79]
    ds_read_b64_tr_b16 v[158:159], v223 offset:34816
    v_mfma_f32_16x16x32_bf16 v[48:51], v[136:139], a[64:67], v[48:51]
    buffer_load_dwordx4 a[8:11], v245, s[8:11], s35 offen offset:0 sc1
    v_mfma_f32_16x16x32_bf16 v[52:55], v[136:139], a[68:71], v[52:55]
    s_add_u32 m0, s38, 0
    s_add_u32 s32, s37, 1048576
    v_mfma_f32_16x16x32_bf16 v[80:83], v[136:139], a[72:75], v[80:83]
    buffer_load_dwordx4 v224, s[12:15], s32 offen lds
    v_mfma_f32_16x16x32_bf16 v[84:87], v[136:139], a[76:79], v[84:87]
    buffer_load_dwordx4 a[12:15], v246, s[8:11], s35 offen offset:0 sc1
    v_mfma_f32_16x16x32_bf16 v[56:59], v[140:143], a[64:67], v[56:59]
    v_mfma_f32_16x16x32_bf16 v[60:63], v[140:143], a[68:71], v[60:63]
    buffer_load_dwordx4 v225, s[12:15], s32 offen offset:1024 lds
    v_mfma_f32_16x16x32_bf16 v[88:91], v[140:143], a[72:75], v[88:91]
    v_mfma_f32_16x16x32_bf16 v[92:95], v[140:143], a[76:79], v[92:95]
    s_waitcnt lgkmcnt(0)
    v_mfma_f32_16x16x32_bf16 v[0:3], v[144:147], a[64:67], v[0:3]
    ds_read_b64_tr_b16 v[128:129], v216 offset:40960
    v_mfma_f32_16x16x32_bf16 v[4:7], v[144:147], a[68:71], v[4:7]
    ds_read_b64_tr_b16 v[130:131], v216 offset:43008
    v_mfma_f32_16x16x32_bf16 v[96:99], v[144:147], a[72:75], v[96:99]
    ds_read_b64_tr_b16 v[132:133], v217 offset:40960
    v_mfma_f32_16x16x32_bf16 v[100:103], v[144:147], a[76:79], v[100:103]
    ds_read_b64_tr_b16 v[134:135], v217 offset:43008
    v_mfma_f32_16x16x32_bf16 v[8:11], v[148:151], a[64:67], v[8:11]
    ds_read_b64_tr_b16 v[136:137], v218 offset:40960
    v_mfma_f32_16x16x32_bf16 v[12:15], v[148:151], a[68:71], v[12:15]
    ds_read_b64_tr_b16 v[138:139], v218 offset:43008
    v_mfma_f32_16x16x32_bf16 v[104:107], v[148:151], a[72:75], v[104:107]
    ds_read_b64_tr_b16 v[140:141], v219 offset:40960
    v_mfma_f32_16x16x32_bf16 v[108:111], v[148:151], a[76:79], v[108:111]
    ds_read_b64_tr_b16 v[142:143], v219 offset:43008
    v_mfma_f32_16x16x32_bf16 v[16:19], v[152:155], a[64:67], v[16:19]
    buffer_load_dwordx4 a[16:19], v226, s[8:11], s35 offen offset:1024 sc1
    v_mfma_f32_16x16x32_bf16 v[20:23], v[152:155], a[68:71], v[20:23]
    v_mfma_f32_16x16x32_bf16 v[112:115], v[152:155], a[72:75], v[112:115]
    v_mfma_f32_16x16x32_bf16 v[116:119], v[152:155], a[76:79], v[116:119]
    v_mfma_f32_16x16x32_bf16 v[24:27], v[156:159], a[64:67], v[24:27]
    buffer_load_dwordx4 a[20:23], v227, s[8:11], s35 offen offset:1024 sc1
    v_mfma_f32_16x16x32_bf16 v[28:31], v[156:159], a[68:71], v[28:31]
    v_mfma_f32_16x16x32_bf16 v[120:123], v[156:159], a[72:75], v[120:123]
    v_mfma_f32_16x16x32_bf16 v[124:127], v[156:159], a[76:79], v[124:127]
    buffer_load_dwordx4 a[24:27], v245, s[8:11], s35 offen offset:1024 sc1
    s_waitcnt vmcnt(17) lgkmcnt(0)
    v_mfma_f32_16x16x32_bf16 v[32:35], v[128:131], a[80:83], v[32:35]
    ds_read_b64_tr_b16 v[144:145], v220 offset:40960
    v_mfma_f32_16x16x32_bf16 v[36:39], v[128:131], a[84:87], v[36:39]
    ds_read_b64_tr_b16 v[146:147], v220 offset:43008
    v_mfma_f32_16x16x32_bf16 v[64:67], v[128:131], a[88:91], v[64:67]
    ds_read_b64_tr_b16 v[148:149], v221 offset:40960
    v_mfma_f32_16x16x32_bf16 v[68:71], v[128:131], a[92:95], v[68:71]
    ds_read_b64_tr_b16 v[150:151], v221 offset:43008
    v_mfma_f32_16x16x32_bf16 v[40:43], v[132:135], a[80:83], v[40:43]
    ds_read_b64_tr_b16 v[152:153], v222 offset:40960
    v_mfma_f32_16x16x32_bf16 v[44:47], v[132:135], a[84:87], v[44:47]
    ds_read_b64_tr_b16 v[154:155], v222 offset:43008
    v_mfma_f32_16x16x32_bf16 v[72:75], v[132:135], a[88:91], v[72:75]
    ds_read_b64_tr_b16 v[156:157], v223 offset:40960
    v_mfma_f32_16x16x32_bf16 v[76:79], v[132:135], a[92:95], v[76:79]
    ds_read_b64_tr_b16 v[158:159], v223 offset:43008
    v_mfma_f32_16x16x32_bf16 v[48:51], v[136:139], a[80:83], v[48:51]
    buffer_load_dwordx4 a[28:31], v246, s[8:11], s35 offen offset:1024 sc1
    v_mfma_f32_16x16x32_bf16 v[52:55], v[136:139], a[84:87], v[52:55]
    s_add_u32 m0, s38, 8192
    s_add_u32 s32, s37, 1114112
    v_mfma_f32_16x16x32_bf16 v[80:83], v[136:139], a[88:91], v[80:83]
    buffer_load_dwordx4 v224, s[12:15], s32 offen lds
    v_mfma_f32_16x16x32_bf16 v[84:87], v[136:139], a[92:95], v[84:87]
    buffer_load_dwordx4 a[32:35], v226, s[8:11], s35 offen offset:2048 sc1
    v_mfma_f32_16x16x32_bf16 v[56:59], v[140:143], a[80:83], v[56:59]
    v_mfma_f32_16x16x32_bf16 v[60:63], v[140:143], a[84:87], v[60:63]
    buffer_load_dwordx4 v225, s[12:15], s32 offen offset:1024 lds
    v_mfma_f32_16x16x32_bf16 v[88:91], v[140:143], a[88:91], v[88:91]
    v_mfma_f32_16x16x32_bf16 v[92:95], v[140:143], a[92:95], v[92:95]
    s_waitcnt lgkmcnt(0)
    v_mfma_f32_16x16x32_bf16 v[0:3], v[144:147], a[80:83], v[0:3]
    ds_read_b64_tr_b16 v[128:129], v216 offset:49152
    v_mfma_f32_16x16x32_bf16 v[4:7], v[144:147], a[84:87], v[4:7]
    ds_read_b64_tr_b16 v[130:131], v216 offset:51200
    v_mfma_f32_16x16x32_bf16 v[96:99], v[144:147], a[88:91], v[96:99]
    ds_read_b64_tr_b16 v[132:133], v217 offset:49152
    v_mfma_f32_16x16x32_bf16 v[100:103], v[144:147], a[92:95], v[100:103]
    ds_read_b64_tr_b16 v[134:135], v217 offset:51200
    v_mfma_f32_16x16x32_bf16 v[8:11], v[148:151], a[80:83], v[8:11]
    ds_read_b64_tr_b16 v[136:137], v218 offset:49152
    v_mfma_f32_16x16x32_bf16 v[12:15], v[148:151], a[84:87], v[12:15]
    ds_read_b64_tr_b16 v[138:139], v218 offset:51200
    v_mfma_f32_16x16x32_bf16 v[104:107], v[148:151], a[88:91], v[104:107]
    ds_read_b64_tr_b16 v[140:141], v219 offset:49152
    v_mfma_f32_16x16x32_bf16 v[108:111], v[148:151], a[92:95], v[108:111]
    ds_read_b64_tr_b16 v[142:143], v219 offset:51200
    v_mfma_f32_16x16x32_bf16 v[16:19], v[152:155], a[80:83], v[16:19]
    buffer_load_dwordx4 a[36:39], v227, s[8:11], s35 offen offset:2048 sc1
    v_mfma_f32_16x16x32_bf16 v[20:23], v[152:155], a[84:87], v[20:23]
    v_mfma_f32_16x16x32_bf16 v[112:115], v[152:155], a[88:91], v[112:115]
    v_mfma_f32_16x16x32_bf16 v[116:119], v[152:155], a[92:95], v[116:119]
    v_mfma_f32_16x16x32_bf16 v[24:27], v[156:159], a[80:83], v[24:27]
    buffer_load_dwordx4 a[40:43], v245, s[8:11], s35 offen offset:2048 sc1
    v_mfma_f32_16x16x32_bf16 v[28:31], v[156:159], a[84:87], v[28:31]
    v_mfma_f32_16x16x32_bf16 v[120:123], v[156:159], a[88:91], v[120:123]
    v_mfma_f32_16x16x32_bf16 v[124:127], v[156:159], a[92:95], v[124:127]
    s_waitcnt vmcnt(19) lgkmcnt(0)
    v_mfma_f32_16x16x32_bf16 v[32:35], v[128:131], a[96:99], v[32:35]
    ds_read_b64_tr_b16 v[144:145], v220 offset:49152
    v_mfma_f32_16x16x32_bf16 v[36:39], v[128:131], a[100:103], v[36:39]
    ds_read_b64_tr_b16 v[146:147], v220 offset:51200
    v_mfma_f32_16x16x32_bf16 v[64:67], v[128:131], a[104:107], v[64:67]
    ds_read_b64_tr_b16 v[148:149], v221 offset:49152
    v_mfma_f32_16x16x32_bf16 v[68:71], v[128:131], a[108:111], v[68:71]
    ds_read_b64_tr_b16 v[150:151], v221 offset:51200
    v_mfma_f32_16x16x32_bf16 v[40:43], v[132:135], a[96:99], v[40:43]
    ds_read_b64_tr_b16 v[152:153], v222 offset:49152
    v_mfma_f32_16x16x32_bf16 v[44:47], v[132:135], a[100:103], v[44:47]
    ds_read_b64_tr_b16 v[154:155], v222 offset:51200
    v_mfma_f32_16x16x32_bf16 v[72:75], v[132:135], a[104:107], v[72:75]
    ds_read_b64_tr_b16 v[156:157], v223 offset:49152
    v_mfma_f32_16x16x32_bf16 v[76:79], v[132:135], a[108:111], v[76:79]
    ds_read_b64_tr_b16 v[158:159], v223 offset:51200
    v_mfma_f32_16x16x32_bf16 v[48:51], v[136:139], a[96:99], v[48:51]
    buffer_load_dwordx4 a[44:47], v246, s[8:11], s35 offen offset:2048 sc1
    v_mfma_f32_16x16x32_bf16 v[52:55], v[136:139], a[100:103], v[52:55]
    s_add_u32 m0, s38, 16384
    s_add_u32 s32, s37, 1179648
    v_mfma_f32_16x16x32_bf16 v[80:83], v[136:139], a[104:107], v[80:83]
    buffer_load_dwordx4 v224, s[12:15], s32 offen lds
    v_mfma_f32_16x16x32_bf16 v[84:87], v[136:139], a[108:111], v[84:87]
    buffer_load_dwordx4 a[48:51], v226, s[8:11], s35 offen offset:3072 sc1
    v_mfma_f32_16x16x32_bf16 v[56:59], v[140:143], a[96:99], v[56:59]
    v_mfma_f32_16x16x32_bf16 v[60:63], v[140:143], a[100:103], v[60:63]
    buffer_load_dwordx4 v225, s[12:15], s32 offen offset:1024 lds
    v_mfma_f32_16x16x32_bf16 v[88:91], v[140:143], a[104:107], v[88:91]
    v_mfma_f32_16x16x32_bf16 v[92:95], v[140:143], a[108:111], v[92:95]
    s_waitcnt lgkmcnt(0)
    v_mfma_f32_16x16x32_bf16 v[0:3], v[144:147], a[96:99], v[0:3]
    ds_read_b64_tr_b16 v[128:129], v216 offset:57344
    v_mfma_f32_16x16x32_bf16 v[4:7], v[144:147], a[100:103], v[4:7]
    ds_read_b64_tr_b16 v[130:131], v216 offset:59392
    v_mfma_f32_16x16x32_bf16 v[96:99], v[144:147], a[104:107], v[96:99]
    ds_read_b64_tr_b16 v[132:133], v217 offset:57344
    v_mfma_f32_16x16x32_bf16 v[100:103], v[144:147], a[108:111], v[100:103]
    ds_read_b64_tr_b16 v[134:135], v217 offset:59392
    v_mfma_f32_16x16x32_bf16 v[8:11], v[148:151], a[96:99], v[8:11]
    ds_read_b64_tr_b16 v[136:137], v218 offset:57344
    v_mfma_f32_16x16x32_bf16 v[12:15], v[148:151], a[100:103], v[12:15]
    ds_read_b64_tr_b16 v[138:139], v218 offset:59392
    v_mfma_f32_16x16x32_bf16 v[104:107], v[148:151], a[104:107], v[104:107]
    ds_read_b64_tr_b16 v[140:141], v219 offset:57344
    v_mfma_f32_16x16x32_bf16 v[108:111], v[148:151], a[108:111], v[108:111]
    ds_read_b64_tr_b16 v[142:143], v219 offset:59392
    v_mfma_f32_16x16x32_bf16 v[16:19], v[152:155], a[96:99], v[16:19]
    buffer_load_dwordx4 a[52:55], v227, s[8:11], s35 offen offset:3072 sc1
    v_mfma_f32_16x16x32_bf16 v[20:23], v[152:155], a[100:103], v[20:23]
    v_mfma_f32_16x16x32_bf16 v[112:115], v[152:155], a[104:107], v[112:115]
    v_mfma_f32_16x16x32_bf16 v[116:119], v[152:155], a[108:111], v[116:119]
    v_mfma_f32_16x16x32_bf16 v[24:27], v[156:159], a[96:99], v[24:27]
    buffer_load_dwordx4 a[56:59], v245, s[8:11], s35 offen offset:3072 sc1
    v_mfma_f32_16x16x32_bf16 v[28:31], v[156:159], a[100:103], v[28:31]
    v_mfma_f32_16x16x32_bf16 v[120:123], v[156:159], a[104:107], v[120:123]
    v_mfma_f32_16x16x32_bf16 v[124:127], v[156:159], a[108:111], v[124:127]
    buffer_load_dwordx4 a[60:63], v246, s[8:11], s35 offen offset:3072 sc1
    s_waitcnt vmcnt(22) lgkmcnt(0)
    v_mfma_f32_16x16x32_bf16 v[32:35], v[128:131], a[112:115], v[32:35]
    ds_read_b64_tr_b16 v[144:145], v220 offset:57344
    v_mfma_f32_16x16x32_bf16 v[36:39], v[128:131], a[116:119], v[36:39]
    ds_read_b64_tr_b16 v[146:147], v220 offset:59392
    v_mfma_f32_16x16x32_bf16 v[64:67], v[128:131], a[120:123], v[64:67]
    ds_read_b64_tr_b16 v[148:149], v221 offset:57344
    v_mfma_f32_16x16x32_bf16 v[68:71], v[128:131], a[124:127], v[68:71]
    ds_read_b64_tr_b16 v[150:151], v221 offset:59392
    v_mfma_f32_16x16x32_bf16 v[40:43], v[132:135], a[112:115], v[40:43]
    ds_read_b64_tr_b16 v[152:153], v222 offset:57344
    v_mfma_f32_16x16x32_bf16 v[44:47], v[132:135], a[116:119], v[44:47]
    ds_read_b64_tr_b16 v[154:155], v222 offset:59392
    v_mfma_f32_16x16x32_bf16 v[72:75], v[132:135], a[120:123], v[72:75]
    ds_read_b64_tr_b16 v[156:157], v223 offset:57344
    v_mfma_f32_16x16x32_bf16 v[76:79], v[132:135], a[124:127], v[76:79]
    ds_read_b64_tr_b16 v[158:159], v223 offset:59392
    v_mfma_f32_16x16x32_bf16 v[48:51], v[136:139], a[112:115], v[48:51]
    s_add_u32 s35, s35, 4096
    buffer_load_dwordx4 a[64:67], v226, s[8:11], s35 offen offset:0 sc1
    v_mfma_f32_16x16x32_bf16 v[52:55], v[136:139], a[116:119], v[52:55]
    s_add_u32 m0, s38, 24576
    s_add_u32 s32, s37, 1245184
    v_mfma_f32_16x16x32_bf16 v[80:83], v[136:139], a[120:123], v[80:83]
    buffer_load_dwordx4 v224, s[12:15], s32 offen lds
    v_mfma_f32_16x16x32_bf16 v[84:87], v[136:139], a[124:127], v[84:87]
    buffer_load_dwordx4 a[68:71], v227, s[8:11], s35 offen offset:0 sc1
    v_mfma_f32_16x16x32_bf16 v[56:59], v[140:143], a[112:115], v[56:59]
    v_mfma_f32_16x16x32_bf16 v[60:63], v[140:143], a[116:119], v[60:63]
    buffer_load_dwordx4 v225, s[12:15], s32 offen offset:1024 lds
    v_mfma_f32_16x16x32_bf16 v[88:91], v[140:143], a[120:123], v[88:91]
    v_mfma_f32_16x16x32_bf16 v[92:95], v[140:143], a[124:127], v[92:95]
    s_waitcnt lgkmcnt(0)
    s_barrier
    v_mfma_f32_16x16x32_bf16 v[0:3], v[144:147], a[112:115], v[0:3]
    v_xor_b32 v216, 0x10000, v216
    ds_read_b64_tr_b16 v[128:129], v216 offset:0
    v_mfma_f32_16x16x32_bf16 v[4:7], v[144:147], a[116:119], v[4:7]
    ds_read_b64_tr_b16 v[130:131], v216 offset:2048
    v_mfma_f32_16x16x32_bf16 v[96:99], v[144:147], a[120:123], v[96:99]
    v_xor_b32 v217, 0x10000, v217
    ds_read_b64_tr_b16 v[132:133], v217 offset:0
    v_mfma_f32_16x16x32_bf16 v[100:103], v[144:147], a[124:127], v[100:103]
    ds_read_b64_tr_b16 v[134:135], v217 offset:2048
    v_mfma_f32_16x16x32_bf16 v[8:11], v[148:151], a[112:115], v[8:11]
    v_xor_b32 v218, 0x10000, v218
    ds_read_b64_tr_b16 v[136:137], v218 offset:0
    v_mfma_f32_16x16x32_bf16 v[12:15], v[148:151], a[116:119], v[12:15]
    ds_read_b64_tr_b16 v[138:139], v218 offset:2048
    v_mfma_f32_16x16x32_bf16 v[104:107], v[148:151], a[120:123], v[104:107]
    v_xor_b32 v219, 0x10000, v219
    ds_read_b64_tr_b16 v[140:141], v219 offset:0
    v_mfma_f32_16x16x32_bf16 v[108:111], v[148:151], a[124:127], v[108:111]
    ds_read_b64_tr_b16 v[142:143], v219 offset:2048
    v_mfma_f32_16x16x32_bf16 v[16:19], v[152:155], a[112:115], v[16:19]
    buffer_load_dwordx4 a[72:75], v245, s[8:11], s35 offen offset:0 sc1
    v_mfma_f32_16x16x32_bf16 v[20:23], v[152:155], a[116:119], v[20:23]
    v_mfma_f32_16x16x32_bf16 v[112:115], v[152:155], a[120:123], v[112:115]
    v_mfma_f32_16x16x32_bf16 v[116:119], v[152:155], a[124:127], v[116:119]
    v_mfma_f32_16x16x32_bf16 v[24:27], v[156:159], a[112:115], v[24:27]
    buffer_load_dwordx4 a[76:79], v246, s[8:11], s35 offen offset:0 sc1
    v_mfma_f32_16x16x32_bf16 v[28:31], v[156:159], a[116:119], v[28:31]
    v_mfma_f32_16x16x32_bf16 v[120:123], v[156:159], a[120:123], v[120:123]
    v_mfma_f32_16x16x32_bf16 v[124:127], v[156:159], a[124:127], v[124:127]
    s_waitcnt vmcnt(23) lgkmcnt(0)
    v_mfma_f32_16x16x32_bf16 v[32:35], v[128:131], a[0:3], v[32:35]
    v_xor_b32 v220, 0x10000, v220
    ds_read_b64_tr_b16 v[144:145], v220 offset:0
    v_mfma_f32_16x16x32_bf16 v[36:39], v[128:131], a[4:7], v[36:39]
    ds_read_b64_tr_b16 v[146:147], v220 offset:2048
    v_mfma_f32_16x16x32_bf16 v[64:67], v[128:131], a[8:11], v[64:67]
    v_xor_b32 v221, 0x10000, v221
    ds_read_b64_tr_b16 v[148:149], v221 offset:0
    v_mfma_f32_16x16x32_bf16 v[68:71], v[128:131], a[12:15], v[68:71]
    ds_read_b64_tr_b16 v[150:151], v221 offset:2048
    v_mfma_f32_16x16x32_bf16 v[40:43], v[132:135], a[0:3], v[40:43]
    v_xor_b32 v222, 0x10000, v222
    ds_read_b64_tr_b16 v[152:153], v222 offset:0
    v_mfma_f32_16x16x32_bf16 v[44:47], v[132:135], a[4:7], v[44:47]
    ds_read_b64_tr_b16 v[154:155], v222 offset:2048
    v_mfma_f32_16x16x32_bf16 v[72:75], v[132:135], a[8:11], v[72:75]
    v_xor_b32 v223, 0x10000, v223
    ds_read_b64_tr_b16 v[156:157], v223 offset:0
    v_mfma_f32_16x16x32_bf16 v[76:79], v[132:135], a[12:15], v[76:79]
    ds_read_b64_tr_b16 v[158:159], v223 offset:2048
    v_mfma_f32_16x16x32_bf16 v[48:51], v[136:139], a[0:3], v[48:51]
    buffer_load_dwordx4 a[80:83], v226, s[8:11], s35 offen offset:1024 sc1
    v_mfma_f32_16x16x32_bf16 v[52:55], v[136:139], a[4:7], v[52:55]
    s_add_u32 m0, s38, 32768
    s_add_u32 s32, s37, 1310720
    v_mfma_f32_16x16x32_bf16 v[80:83], v[136:139], a[8:11], v[80:83]
    buffer_load_dwordx4 v224, s[12:15], s32 offen lds
    v_mfma_f32_16x16x32_bf16 v[84:87], v[136:139], a[12:15], v[84:87]
    buffer_load_dwordx4 a[84:87], v227, s[8:11], s35 offen offset:1024 sc1
    v_mfma_f32_16x16x32_bf16 v[56:59], v[140:143], a[0:3], v[56:59]
    v_mfma_f32_16x16x32_bf16 v[60:63], v[140:143], a[4:7], v[60:63]
    buffer_load_dwordx4 v225, s[12:15], s32 offen offset:1024 lds
    v_mfma_f32_16x16x32_bf16 v[88:91], v[140:143], a[8:11], v[88:91]
    s_lshl_b32 s45, s52, 7
    s_add_u32 s45, s45, 0x38a1400
    v_mfma_f32_16x16x32_bf16 v[92:95], v[140:143], a[12:15], v[92:95]
    s_waitcnt lgkmcnt(0)
    v_mfma_f32_16x16x32_bf16 v[0:3], v[144:147], a[0:3], v[0:3]
    ds_read_b64_tr_b16 v[128:129], v216 offset:8192
    v_mfma_f32_16x16x32_bf16 v[4:7], v[144:147], a[4:7], v[4:7]
    ds_read_b64_tr_b16 v[130:131], v216 offset:10240
    v_mfma_f32_16x16x32_bf16 v[96:99], v[144:147], a[8:11], v[96:99]
    ds_read_b64_tr_b16 v[132:133], v217 offset:8192
    v_mfma_f32_16x16x32_bf16 v[100:103], v[144:147], a[12:15], v[100:103]
    ds_read_b64_tr_b16 v[134:135], v217 offset:10240
    v_mfma_f32_16x16x32_bf16 v[8:11], v[148:151], a[0:3], v[8:11]
    ds_read_b64_tr_b16 v[136:137], v218 offset:8192
    v_mfma_f32_16x16x32_bf16 v[12:15], v[148:151], a[4:7], v[12:15]
    ds_read_b64_tr_b16 v[138:139], v218 offset:10240
    v_mfma_f32_16x16x32_bf16 v[104:107], v[148:151], a[8:11], v[104:107]
    ds_read_b64_tr_b16 v[140:141], v219 offset:8192
    v_mfma_f32_16x16x32_bf16 v[108:111], v[148:151], a[12:15], v[108:111]
    ds_read_b64_tr_b16 v[142:143], v219 offset:10240
    v_mfma_f32_16x16x32_bf16 v[16:19], v[152:155], a[0:3], v[16:19]
    buffer_load_dwordx4 a[88:91], v245, s[8:11], s35 offen offset:1024 sc1
    v_mfma_f32_16x16x32_bf16 v[20:23], v[152:155], a[4:7], v[20:23]
    s_cmp_eq_u32 s3, 0
    s_cselect_b32 s45, s45, 0x40000000
    v_mfma_f32_16x16x32_bf16 v[112:115], v[152:155], a[8:11], v[112:115]
    buffer_load_dword v235, off, s[8:11], s45 sc1
    v_mfma_f32_16x16x32_bf16 v[116:119], v[152:155], a[12:15], v[116:119]
    v_mfma_f32_16x16x32_bf16 v[24:27], v[156:159], a[0:3], v[24:27]
    buffer_load_dwordx4 a[92:95], v246, s[8:11], s35 offen offset:1024 sc1
    v_mfma_f32_16x16x32_bf16 v[28:31], v[156:159], a[4:7], v[28:31]
    v_mfma_f32_16x16x32_bf16 v[120:123], v[156:159], a[8:11], v[120:123]
    v_mfma_f32_16x16x32_bf16 v[124:127], v[156:159], a[12:15], v[124:127]
    buffer_load_dwordx4 a[96:99], v226, s[8:11], s35 offen offset:2048 sc1
    s_waitcnt vmcnt(26) lgkmcnt(0)
    v_mfma_f32_16x16x32_bf16 v[32:35], v[128:131], a[16:19], v[32:35]
    ds_read_b64_tr_b16 v[144:145], v220 offset:8192
    v_mfma_f32_16x16x32_bf16 v[36:39], v[128:131], a[20:23], v[36:39]
    ds_read_b64_tr_b16 v[146:147], v220 offset:10240
    v_mfma_f32_16x16x32_bf16 v[64:67], v[128:131], a[24:27], v[64:67]
    ds_read_b64_tr_b16 v[148:149], v221 offset:8192
    v_mfma_f32_16x16x32_bf16 v[68:71], v[128:131], a[28:31], v[68:71]
    ds_read_b64_tr_b16 v[150:151], v221 offset:10240
    v_mfma_f32_16x16x32_bf16 v[40:43], v[132:135], a[16:19], v[40:43]
    ds_read_b64_tr_b16 v[152:153], v222 offset:8192
    v_mfma_f32_16x16x32_bf16 v[44:47], v[132:135], a[20:23], v[44:47]
    ds_read_b64_tr_b16 v[154:155], v222 offset:10240
    v_mfma_f32_16x16x32_bf16 v[72:75], v[132:135], a[24:27], v[72:75]
    ds_read_b64_tr_b16 v[156:157], v223 offset:8192
    v_mfma_f32_16x16x32_bf16 v[76:79], v[132:135], a[28:31], v[76:79]
    ds_read_b64_tr_b16 v[158:159], v223 offset:10240
    v_mfma_f32_16x16x32_bf16 v[48:51], v[136:139], a[16:19], v[48:51]
    buffer_load_dwordx4 a[100:103], v227, s[8:11], s35 offen offset:2048 sc1
    v_mfma_f32_16x16x32_bf16 v[52:55], v[136:139], a[20:23], v[52:55]
    s_add_u32 m0, s38, 40960
    s_add_u32 s32, s37, 1376256
    v_mfma_f32_16x16x32_bf16 v[80:83], v[136:139], a[24:27], v[80:83]
    buffer_load_dwordx4 v224, s[12:15], s32 offen lds
    v_mfma_f32_16x16x32_bf16 v[84:87], v[136:139], a[28:31], v[84:87]
    buffer_load_dwordx4 a[104:107], v245, s[8:11], s35 offen offset:2048 sc1
    v_mfma_f32_16x16x32_bf16 v[56:59], v[140:143], a[16:19], v[56:59]
    v_mfma_f32_16x16x32_bf16 v[60:63], v[140:143], a[20:23], v[60:63]
    buffer_load_dwordx4 v225, s[12:15], s32 offen offset:1024 lds
    v_mfma_f32_16x16x32_bf16 v[88:91], v[140:143], a[24:27], v[88:91]
    v_mfma_f32_16x16x32_bf16 v[92:95], v[140:143], a[28:31], v[92:95]
    s_waitcnt lgkmcnt(0)
    v_mfma_f32_16x16x32_bf16 v[0:3], v[144:147], a[16:19], v[0:3]
    ds_read_b64_tr_b16 v[128:129], v216 offset:16384
    v_mfma_f32_16x16x32_bf16 v[4:7], v[144:147], a[20:23], v[4:7]
    ds_read_b64_tr_b16 v[130:131], v216 offset:18432
    v_mfma_f32_16x16x32_bf16 v[96:99], v[144:147], a[24:27], v[96:99]
    ds_read_b64_tr_b16 v[132:133], v217 offset:16384
    v_mfma_f32_16x16x32_bf16 v[100:103], v[144:147], a[28:31], v[100:103]
    ds_read_b64_tr_b16 v[134:135], v217 offset:18432
    v_mfma_f32_16x16x32_bf16 v[8:11], v[148:151], a[16:19], v[8:11]
    ds_read_b64_tr_b16 v[136:137], v218 offset:16384
    v_mfma_f32_16x16x32_bf16 v[12:15], v[148:151], a[20:23], v[12:15]
    ds_read_b64_tr_b16 v[138:139], v218 offset:18432
    v_mfma_f32_16x16x32_bf16 v[104:107], v[148:151], a[24:27], v[104:107]
    ds_read_b64_tr_b16 v[140:141], v219 offset:16384
    v_mfma_f32_16x16x32_bf16 v[108:111], v[148:151], a[28:31], v[108:111]
    ds_read_b64_tr_b16 v[142:143], v219 offset:18432
    v_mfma_f32_16x16x32_bf16 v[16:19], v[152:155], a[16:19], v[16:19]
    buffer_load_dwordx4 a[108:111], v246, s[8:11], s35 offen offset:2048 sc1
    v_mfma_f32_16x16x32_bf16 v[20:23], v[152:155], a[20:23], v[20:23]
    v_mfma_f32_16x16x32_bf16 v[112:115], v[152:155], a[24:27], v[112:115]
    v_mfma_f32_16x16x32_bf16 v[116:119], v[152:155], a[28:31], v[116:119]
    v_mfma_f32_16x16x32_bf16 v[24:27], v[156:159], a[16:19], v[24:27]
    buffer_load_dwordx4 a[112:115], v226, s[8:11], s35 offen offset:3072 sc1
    v_mfma_f32_16x16x32_bf16 v[28:31], v[156:159], a[20:23], v[28:31]
    v_mfma_f32_16x16x32_bf16 v[120:123], v[156:159], a[24:27], v[120:123]
    v_mfma_f32_16x16x32_bf16 v[124:127], v[156:159], a[28:31], v[124:127]
    s_waitcnt vmcnt(26) lgkmcnt(0)
    v_mfma_f32_16x16x32_bf16 v[32:35], v[128:131], a[32:35], v[32:35]
    ds_read_b64_tr_b16 v[144:145], v220 offset:16384
    v_mfma_f32_16x16x32_bf16 v[36:39], v[128:131], a[36:39], v[36:39]
    ds_read_b64_tr_b16 v[146:147], v220 offset:18432
    v_mfma_f32_16x16x32_bf16 v[64:67], v[128:131], a[40:43], v[64:67]
    ds_read_b64_tr_b16 v[148:149], v221 offset:16384
    v_mfma_f32_16x16x32_bf16 v[68:71], v[128:131], a[44:47], v[68:71]
    ds_read_b64_tr_b16 v[150:151], v221 offset:18432
    v_mfma_f32_16x16x32_bf16 v[40:43], v[132:135], a[32:35], v[40:43]
    ds_read_b64_tr_b16 v[152:153], v222 offset:16384
    v_mfma_f32_16x16x32_bf16 v[44:47], v[132:135], a[36:39], v[44:47]
    ds_read_b64_tr_b16 v[154:155], v222 offset:18432
    v_mfma_f32_16x16x32_bf16 v[72:75], v[132:135], a[40:43], v[72:75]
    ds_read_b64_tr_b16 v[156:157], v223 offset:16384
    v_mfma_f32_16x16x32_bf16 v[76:79], v[132:135], a[44:47], v[76:79]
    ds_read_b64_tr_b16 v[158:159], v223 offset:18432
    v_mfma_f32_16x16x32_bf16 v[48:51], v[136:139], a[32:35], v[48:51]
    buffer_load_dwordx4 a[116:119], v227, s[8:11], s35 offen offset:3072 sc1
    v_mfma_f32_16x16x32_bf16 v[52:55], v[136:139], a[36:39], v[52:55]
    s_add_u32 m0, s38, 49152
    s_add_u32 s32, s37, 1441792
    v_mfma_f32_16x16x32_bf16 v[80:83], v[136:139], a[40:43], v[80:83]
    buffer_load_dwordx4 v224, s[12:15], s32 offen lds
    v_mfma_f32_16x16x32_bf16 v[84:87], v[136:139], a[44:47], v[84:87]
    buffer_load_dwordx4 a[120:123], v245, s[8:11], s35 offen offset:3072 sc1
    v_mfma_f32_16x16x32_bf16 v[56:59], v[140:143], a[32:35], v[56:59]
    v_mfma_f32_16x16x32_bf16 v[60:63], v[140:143], a[36:39], v[60:63]
    buffer_load_dwordx4 v225, s[12:15], s32 offen offset:1024 lds
    v_mfma_f32_16x16x32_bf16 v[88:91], v[140:143], a[40:43], v[88:91]
    v_mfma_f32_16x16x32_bf16 v[92:95], v[140:143], a[44:47], v[92:95]
    s_waitcnt lgkmcnt(0)
    v_mfma_f32_16x16x32_bf16 v[0:3], v[144:147], a[32:35], v[0:3]
    ds_read_b64_tr_b16 v[128:129], v216 offset:24576
    v_mfma_f32_16x16x32_bf16 v[4:7], v[144:147], a[36:39], v[4:7]
    ds_read_b64_tr_b16 v[130:131], v216 offset:26624
    v_mfma_f32_16x16x32_bf16 v[96:99], v[144:147], a[40:43], v[96:99]
    ds_read_b64_tr_b16 v[132:133], v217 offset:24576
    v_mfma_f32_16x16x32_bf16 v[100:103], v[144:147], a[44:47], v[100:103]
    ds_read_b64_tr_b16 v[134:135], v217 offset:26624
    v_mfma_f32_16x16x32_bf16 v[8:11], v[148:151], a[32:35], v[8:11]
    ds_read_b64_tr_b16 v[136:137], v218 offset:24576
    v_mfma_f32_16x16x32_bf16 v[12:15], v[148:151], a[36:39], v[12:15]
    ds_read_b64_tr_b16 v[138:139], v218 offset:26624
    v_mfma_f32_16x16x32_bf16 v[104:107], v[148:151], a[40:43], v[104:107]
    ds_read_b64_tr_b16 v[140:141], v219 offset:24576
    v_mfma_f32_16x16x32_bf16 v[108:111], v[148:151], a[44:47], v[108:111]
    ds_read_b64_tr_b16 v[142:143], v219 offset:26624
    v_mfma_f32_16x16x32_bf16 v[16:19], v[152:155], a[32:35], v[16:19]
    buffer_load_dwordx4 a[124:127], v246, s[8:11], s35 offen offset:3072 sc1
    v_mfma_f32_16x16x32_bf16 v[20:23], v[152:155], a[36:39], v[20:23]
    v_mfma_f32_16x16x32_bf16 v[112:115], v[152:155], a[40:43], v[112:115]
    v_mfma_f32_16x16x32_bf16 v[116:119], v[152:155], a[44:47], v[116:119]
    v_mfma_f32_16x16x32_bf16 v[24:27], v[156:159], a[32:35], v[24:27]
    s_add_u32 s35, s35, 4096
    buffer_load_dwordx4 a[0:3], v226, s[8:11], s35 offen offset:0 sc1
    v_mfma_f32_16x16x32_bf16 v[28:31], v[156:159], a[36:39], v[28:31]
    v_mfma_f32_16x16x32_bf16 v[120:123], v[156:159], a[40:43], v[120:123]
    v_mfma_f32_16x16x32_bf16 v[124:127], v[156:159], a[44:47], v[124:127]
    buffer_load_dwordx4 a[4:7], v227, s[8:11], s35 offen offset:0 sc1
    s_waitcnt vmcnt(27) lgkmcnt(0)
    v_mfma_f32_16x16x32_bf16 v[32:35], v[128:131], a[48:51], v[32:35]
    ds_read_b64_tr_b16 v[144:145], v220 offset:24576
    v_mfma_f32_16x16x32_bf16 v[36:39], v[128:131], a[52:55], v[36:39]
    ds_read_b64_tr_b16 v[146:147], v220 offset:26624
    v_mfma_f32_16x16x32_bf16 v[64:67], v[128:131], a[56:59], v[64:67]
    ds_read_b64_tr_b16 v[148:149], v221 offset:24576
    v_mfma_f32_16x16x32_bf16 v[68:71], v[128:131], a[60:63], v[68:71]
    ds_read_b64_tr_b16 v[150:151], v221 offset:26624
    v_mfma_f32_16x16x32_bf16 v[40:43], v[132:135], a[48:51], v[40:43]
    ds_read_b64_tr_b16 v[152:153], v222 offset:24576
    v_mfma_f32_16x16x32_bf16 v[44:47], v[132:135], a[52:55], v[44:47]
    ds_read_b64_tr_b16 v[154:155], v222 offset:26624
    v_mfma_f32_16x16x32_bf16 v[72:75], v[132:135], a[56:59], v[72:75]
    ds_read_b64_tr_b16 v[156:157], v223 offset:24576
    v_mfma_f32_16x16x32_bf16 v[76:79], v[132:135], a[60:63], v[76:79]
    ds_read_b64_tr_b16 v[158:159], v223 offset:26624
    v_mfma_f32_16x16x32_bf16 v[48:51], v[136:139], a[48:51], v[48:51]
    buffer_load_dwordx4 a[8:11], v245, s[8:11], s35 offen offset:0 sc1
    v_mfma_f32_16x16x32_bf16 v[52:55], v[136:139], a[52:55], v[52:55]
    s_add_u32 m0, s38, 57344
    s_add_u32 s32, s37, 1507328
    v_mfma_f32_16x16x32_bf16 v[80:83], v[136:139], a[56:59], v[80:83]
    buffer_load_dwordx4 v224, s[12:15], s32 offen lds
    v_mfma_f32_16x16x32_bf16 v[84:87], v[136:139], a[60:63], v[84:87]
    buffer_load_dwordx4 a[12:15], v246, s[8:11], s35 offen offset:0 sc1
    v_mfma_f32_16x16x32_bf16 v[56:59], v[140:143], a[48:51], v[56:59]
    v_mfma_f32_16x16x32_bf16 v[60:63], v[140:143], a[52:55], v[60:63]
    buffer_load_dwordx4 v225, s[12:15], s32 offen offset:1024 lds
    v_mfma_f32_16x16x32_bf16 v[88:91], v[140:143], a[56:59], v[88:91]
    s_waitcnt vmcnt(19)
    v_readfirstlane_b32 s36, v235
    s_lshl_b32 s34, s3, 8
    s_add_u32 s36, s36, s34
    s_cmp_ge_u32 s36, 8
    s_cbranch_scc0 kc_g
kc_gr:
    v_mfma_f32_16x16x32_bf16 v[92:95], v[140:143], a[60:63], v[92:95]
    s_waitcnt lgkmcnt(0)
    s_barrier
    v_mfma_f32_16x16x32_bf16 v[0:3], v[144:147], a[48:51], v[0:3]
    ds_read_b64_tr_b16 v[128:129], v216 offset:32768
    v_mfma_f32_16x16x32_bf16 v[4:7], v[144:147], a[52:55], v[4:7]
    ds_read_b64_tr_b16 v[130:131], v216 offset:34816
    v_mfma_f32_16x16x32_bf16 v[96:99], v[144:147], a[56:59], v[96:99]
    ds_read_b64_tr_b16 v[132:133], v217 offset:32768
    v_mfma_f32_16x16x32_bf16 v[100:103], v[144:147], a[60:63], v[100:103]
    ds_read_b64_tr_b16 v[134:135], v217 offset:34816
    v_mfma_f32_16x16x32_bf16 v[8:11], v[148:151], a[48:51], v[8:11]
    ds_read_b64_tr_b16 v[136:137], v218 offset:32768
    v_mfma_f32_16x16x32_bf16 v[12:15], v[148:151], a[52:55], v[12:15]
    ds_read_b64_tr_b16 v[138:139], v218 offset:34816
    v_mfma_f32_16x16x32_bf16 v[104:107], v[148:151], a[56:59], v[104:107]
    ds_read_b64_tr_b16 v[140:141], v219 offset:32768
    v_mfma_f32_16x16x32_bf16 v[108:111], v[148:151], a[60:63], v[108:111]
    ds_read_b64_tr_b16 v[142:143], v219 offset:34816
    v_mfma_f32_16x16x32_bf16 v[16:19], v[152:155], a[48:51], v[16:19]
    buffer_load_dwordx4 a[16:19], v226, s[8:11], s35 offen offset:1024 sc1
    v_mfma_f32_16x16x32_bf16 v[20:23], v[152:155], a[52:55], v[20:23]
    v_mfma_f32_16x16x32_bf16 v[112:115], v[152:155], a[56:59], v[112:115]
    v_mfma_f32_16x16x32_bf16 v[116:119], v[152:155], a[60:63], v[116:119]
    v_mfma_f32_16x16x32_bf16 v[24:27], v[156:159], a[48:51], v[24:27]
    buffer_load_dwordx4 a[20:23], v227, s[8:11], s35 offen offset:1024 sc1
    v_mfma_f32_16x16x32_bf16 v[28:31], v[156:159], a[52:55], v[28:31]
    v_mfma_f32_16x16x32_bf16 v[120:123], v[156:159], a[56:59], v[120:123]
    v_mfma_f32_16x16x32_bf16 v[124:127], v[156:159], a[60:63], v[124:127]
    s_waitcnt vmcnt(27) lgkmcnt(0)
    v_mfma_f32_16x16x32_bf16 v[32:35], v[128:131], a[64:67], v[32:35]
    ds_read_b64_tr_b16 v[144:145], v220 offset:32768
    v_mfma_f32_16x16x32_bf16 v[36:39], v[128:131], a[68:71], v[36:39]
    ds_read_b64_tr_b16 v[146:147], v220 offset:34816
    v_mfma_f32_16x16x32_bf16 v[64:67], v[128:131], a[72:75], v[64:67]
    ds_read_b64_tr_b16 v[148:149], v221 offset:32768
    v_mfma_f32_16x16x32_bf16 v[68:71], v[128:131], a[76:79], v[68:71]
    ds_read_b64_tr_b16 v[150:151], v221 offset:34816
    v_mfma_f32_16x16x32_bf16 v[40:43], v[132:135], a[64:67], v[40:43]
    ds_read_b64_tr_b16 v[152:153], v222 offset:32768
    v_mfma_f32_16x16x32_bf16 v[44:47], v[132:135], a[68:71], v[44:47]
    ds_read_b64_tr_b16 v[154:155], v222 offset:34816
    v_mfma_f32_16x16x32_bf16 v[72:75], v[132:135], a[72:75], v[72:75]
    ds_read_b64_tr_b16 v[156:157], v223 offset:32768
    v_mfma_f32_16x16x32_bf16 v[76:79], v[132:135], a[76:79], v[76:79]
    ds_read_b64_tr_b16 v[158:159], v223 offset:34816
    v_mfma_f32_16x16x32_bf16 v[48:51], v[136:139], a[64:67], v[48:51]
    buffer_load_dwordx4 a[24:27], v245, s[8:11], s35 offen offset:1024 sc1
    v_mfma_f32_16x16x32_bf16 v[52:55], v[136:139], a[68:71], v[52:55]
    s_add_u32 m0, s38, 65536
    s_add_u32 s32, s37, 1572864
    v_mfma_f32_16x16x32_bf16 v[80:83], v[136:139], a[72:75], v[80:83]
    buffer_load_dwordx4 v224, s[12:15], s32 offen lds
    v_mfma_f32_16x16x32_bf16 v[84:87], v[136:139], a[76:79], v[84:87]
    buffer_load_dwordx4 a[28:31], v246, s[8:11], s35 offen offset:1024 sc1
    v_mfma_f32_16x16x32_bf16 v[56:59], v[140:143], a[64:67], v[56:59]
    v_mfma_f32_16x16x32_bf16 v[60:63], v[140:143], a[68:71], v[60:63]
    buffer_load_dwordx4 v225, s[12:15], s32 offen offset:1024 lds
    v_mfma_f32_16x16x32_bf16 v[88:91], v[140:143], a[72:75], v[88:91]
    s_add_u32 s33, s55, 0
    buffer_load_dwordx4 a[128:131], v228, s[8:11], s33 offen offset:0 sc1
    v_mfma_f32_16x16x32_bf16 v[92:95], v[140:143], a[76:79], v[92:95]
    s_waitcnt lgkmcnt(0)
    v_mfma_f32_16x16x32_bf16 v[0:3], v[144:147], a[64:67], v[0:3]
    ds_read_b64_tr_b16 v[128:129], v216 offset:40960
    v_mfma_f32_16x16x32_bf16 v[4:7], v[144:147], a[68:71], v[4:7]
    ds_read_b64_tr_b16 v[130:131], v216 offset:43008
    v_mfma_f32_16x16x32_bf16 v[96:99], v[144:147], a[72:75], v[96:99]
    ds_read_b64_tr_b16 v[132:133], v217 offset:40960
    v_mfma_f32_16x16x32_bf16 v[100:103], v[144:147], a[76:79], v[100:103]
    ds_read_b64_tr_b16 v[134:135], v217 offset:43008
    v_mfma_f32_16x16x32_bf16 v[8:11], v[148:151], a[64:67], v[8:11]
    ds_read_b64_tr_b16 v[136:137], v218 offset:40960
    v_mfma_f32_16x16x32_bf16 v[12:15], v[148:151], a[68:71], v[12:15]
    ds_read_b64_tr_b16 v[138:139], v218 offset:43008
    v_mfma_f32_16x16x32_bf16 v[104:107], v[148:151], a[72:75], v[104:107]
    ds_read_b64_tr_b16 v[140:141], v219 offset:40960
    v_mfma_f32_16x16x32_bf16 v[108:111], v[148:151], a[76:79], v[108:111]
    ds_read_b64_tr_b16 v[142:143], v219 offset:43008
    v_mfma_f32_16x16x32_bf16 v[16:19], v[152:155], a[64:67], v[16:19]
    buffer_load_dwordx4 a[32:35], v226, s[8:11], s35 offen offset:2048 sc1
    v_mfma_f32_16x16x32_bf16 v[20:23], v[152:155], a[68:71], v[20:23]
    v_mfma_f32_16x16x32_bf16 v[112:115], v[152:155], a[72:75], v[112:115]
    v_mfma_f32_16x16x32_bf16 v[116:119], v[152:155], a[76:79], v[116:119]
    v_mfma_f32_16x16x32_bf16 v[24:27], v[156:159], a[64:67], v[24:27]
    buffer_load_dwordx4 a[36:39], v227, s[8:11], s35 offen offset:2048 sc1
    v_mfma_f32_16x16x32_bf16 v[28:31], v[156:159], a[68:71], v[28:31]
    v_mfma_f32_16x16x32_bf16 v[120:123], v[156:159], a[72:75], v[120:123]
    buffer_load_dwordx4 a[132:135], v228, s[8:11], s33 offen offset:1024 sc1
    v_mfma_f32_16x16x32_bf16 v[124:127], v[156:159], a[76:79], v[124:127]
    buffer_load_dwordx4 a[40:43], v245, s[8:11], s35 offen offset:2048 sc1
    s_waitcnt vmcnt(29) lgkmcnt(0)
    v_mfma_f32_16x16x32_bf16 v[32:35], v[128:131], a[80:83], v[32:35]
    ds_read_b64_tr_b16 v[144:145], v220 offset:40960
    v_mfma_f32_16x16x32_bf16 v[36:39], v[128:131], a[84:87], v[36:39]
    ds_read_b64_tr_b16 v[146:147], v220 offset:43008
    v_mfma_f32_16x16x32_bf16 v[64:67], v[128:131], a[88:91], v[64:67]
    ds_read_b64_tr_b16 v[148:149], v221 offset:40960
    v_mfma_f32_16x16x32_bf16 v[68:71], v[128:131], a[92:95], v[68:71]
    ds_read_b64_tr_b16 v[150:151], v221 offset:43008
    v_mfma_f32_16x16x32_bf16 v[40:43], v[132:135], a[80:83], v[40:43]
    ds_read_b64_tr_b16 v[152:153], v222 offset:40960
    v_mfma_f32_16x16x32_bf16 v[44:47], v[132:135], a[84:87], v[44:47]
    ds_read_b64_tr_b16 v[154:155], v222 offset:43008
    v_mfma_f32_16x16x32_bf16 v[72:75], v[132:135], a[88:91], v[72:75]
    ds_read_b64_tr_b16 v[156:157], v223 offset:40960
    v_mfma_f32_16x16x32_bf16 v[76:79], v[132:135], a[92:95], v[76:79]
    ds_read_b64_tr_b16 v[158:159], v223 offset:43008
    v_mfma_f32_16x16x32_bf16 v[48:51], v[136:139], a[80:83], v[48:51]
    buffer_load_dwordx4 a[44:47], v246, s[8:11], s35 offen offset:2048 sc1
    v_mfma_f32_16x16x32_bf16 v[52:55], v[136:139], a[84:87], v[52:55]
    s_add_u32 m0, s38, 73728
    s_add_u32 s32, s37, 1638400
    v_mfma_f32_16x16x32_bf16 v[80:83], v[136:139], a[88:91], v[80:83]
    buffer_load_dwordx4 v224, s[12:15], s32 offen lds
    v_mfma_f32_16x16x32_bf16 v[84:87], v[136:139], a[92:95], v[84:87]
    buffer_load_dwordx4 a[48:51], v226, s[8:11], s35 offen offset:3072 sc1
    v_mfma_f32_16x16x32_bf16 v[56:59], v[140:143], a[80:83], v[56:59]
    v_mfma_f32_16x16x32_bf16 v[60:63], v[140:143], a[84:87], v[60:63]
    buffer_load_dwordx4 v225, s[12:15], s32 offen offset:1024 lds
    v_mfma_f32_16x16x32_bf16 v[88:91], v[140:143], a[88:91], v[88:91]
    buffer_load_dwordx4 a[136:139], v228, s[8:11], s33 offen offset:2048 sc1
    v_mfma_f32_16x16x32_bf16 v[92:95], v[140:143], a[92:95], v[92:95]
    s_waitcnt lgkmcnt(0)
    v_mfma_f32_16x16x32_bf16 v[0:3], v[144:147], a[80:83], v[0:3]
    ds_read_b64_tr_b16 v[128:129], v216 offset:49152
    v_mfma_f32_16x16x32_bf16 v[4:7], v[144:147], a[84:87], v[4:7]
    ds_read_b64_tr_b16 v[130:131], v216 offset:51200
    v_mfma_f32_16x16x32_bf16 v[96:99], v[144:147], a[88:91], v[96:99]
    ds_read_b64_tr_b16 v[132:133], v217 offset:49152
    v_mfma_f32_16x16x32_bf16 v[100:103], v[144:147], a[92:95], v[100:103]
    ds_read_b64_tr_b16 v[134:135], v217 offset:51200
    v_mfma_f32_16x16x32_bf16 v[8:11], v[148:151], a[80:83], v[8:11]
    ds_read_b64_tr_b16 v[136:137], v218 offset:49152
    v_mfma_f32_16x16x32_bf16 v[12:15], v[148:151], a[84:87], v[12:15]
    ds_read_b64_tr_b16 v[138:139], v218 offset:51200
    v_mfma_f32_16x16x32_bf16 v[104:107], v[148:151], a[88:91], v[104:107]
    ds_read_b64_tr_b16 v[140:141], v219 offset:49152
    v_mfma_f32_16x16x32_bf16 v[108:111], v[148:151], a[92:95], v[108:111]
    ds_read_b64_tr_b16 v[142:143], v219 offset:51200
    v_mfma_f32_16x16x32_bf16 v[16:19], v[152:155], a[80:83], v[16:19]
    buffer_load_dwordx4 a[52:55], v227, s[8:11], s35 offen offset:3072 sc1
    v_mfma_f32_16x16x32_bf16 v[20:23], v[152:155], a[84:87], v[20:23]
    v_mfma_f32_16x16x32_bf16 v[112:115], v[152:155], a[88:91], v[112:115]
    v_mfma_f32_16x16x32_bf16 v[116:119], v[152:155], a[92:95], v[116:119]
    v_mfma_f32_16x16x32_bf16 v[24:27], v[156:159], a[80:83], v[24:27]
    buffer_load_dwordx4 a[56:59], v245, s[8:11], s35 offen offset:3072 sc1
    v_mfma_f32_16x16x32_bf16 v[28:31], v[156:159], a[84:87], v[28:31]
    v_mfma_f32_16x16x32_bf16 v[120:123], v[156:159], a[88:91], v[120:123]
    buffer_load_dwordx4 a[140:143], v228, s[8:11], s33 offen offset:3072 sc1
    v_mfma_f32_16x16x32_bf16 v[124:127], v[156:159], a[92:95], v[124:127]
    s_waitcnt vmcnt(31) lgkmcnt(0)
    v_mfma_f32_16x16x32_bf16 v[32:35], v[128:131], a[96:99], v[32:35]
    ds_read_b64_tr_b16 v[144:145], v220 offset:49152
    v_mfma_f32_16x16x32_bf16 v[36:39], v[128:131], a[100:103], v[36:39]
    ds_read_b64_tr_b16 v[146:147], v220 offset:51200
    v_mfma_f32_16x16x32_bf16 v[64:67], v[128:131], a[104:107], v[64:67]
    ds_read_b64_tr_b16 v[148:149], v221 offset:49152
    v_mfma_f32_16x16x32_bf16 v[68:71], v[128:131], a[108:111], v[68:71]
    ds_read_b64_tr_b16 v[150:151], v221 offset:51200
    v_mfma_f32_16x16x32_bf16 v[40:43], v[132:135], a[96:99], v[40:43]
    ds_read_b64_tr_b16 v[152:153], v222 offset:49152
    v_mfma_f32_16x16x32_bf16 v[44:47], v[132:135], a[100:103], v[44:47]
    ds_read_b64_tr_b16 v[154:155], v222 offset:51200
    v_mfma_f32_16x16x32_bf16 v[72:75], v[132:135], a[104:107], v[72:75]
    ds_read_b64_tr_b16 v[156:157], v223 offset:49152
    v_mfma_f32_16x16x32_bf16 v[76:79], v[132:135], a[108:111], v[76:79]
    ds_read_b64_tr_b16 v[158:159], v223 offset:51200
    v_mfma_f32_16x16x32_bf16 v[48:51], v[136:139], a[96:99], v[48:51]
    buffer_load_dwordx4 a[60:63], v246, s[8:11], s35 offen offset:3072 sc1
    v_mfma_f32_16x16x32_bf16 v[52:55], v[136:139], a[100:103], v[52:55]
    s_add_u32 m0, s38, 81920
    s_add_u32 s32, s37, 1703936
    v_mfma_f32_16x16x32_bf16 v[80:83], v[136:139], a[104:107], v[80:83]
    buffer_load_dwordx4 v224, s[12:15], s32 offen lds
    v_mfma_f32_16x16x32_bf16 v[84:87], v[136:139], a[108:111], v[84:87]
    s_add_u32 s35, s35, 4096
    buffer_load_dwordx4 a[64:67], v226, s[8:11], s35 offen offset:0 sc1
    v_mfma_f32_16x16x32_bf16 v[56:59], v[140:143], a[96:99], v[56:59]
    v_mfma_f32_16x16x32_bf16 v[60:63], v[140:143], a[100:103], v[60:63]
    buffer_load_dwordx4 v225, s[12:15], s32 offen offset:1024 lds
    v_mfma_f32_16x16x32_bf16 v[88:91], v[140:143], a[104:107], v[88:91]
    s_add_u32 s33, s55, 4096
    buffer_load_dwordx4 a[144:147], v228, s[8:11], s33 offen offset:0 sc1
    v_mfma_f32_16x16x32_bf16 v[92:95], v[140:143], a[108:111], v[92:95]
    s_waitcnt lgkmcnt(0)
    v_mfma_f32_16x16x32_bf16 v[0:3], v[144:147], a[96:99], v[0:3]
    ds_read_b64_tr_b16 v[128:129], v216 offset:57344
    v_mfma_f32_16x16x32_bf16 v[4:7], v[144:147], a[100:103], v[4:7]
    ds_read_b64_tr_b16 v[130:131], v216 offset:59392
    v_mfma_f32_16x16x32_bf16 v[96:99], v[144:147], a[104:107], v[96:99]
    ds_read_b64_tr_b16 v[132:133], v217 offset:57344
    v_mfma_f32_16x16x32_bf16 v[100:103], v[144:147], a[108:111], v[100:103]
    ds_read_b64_tr_b16 v[134:135], v217 offset:59392
    v_mfma_f32_16x16x32_bf16 v[8:11], v[148:151], a[96:99], v[8:11]
    ds_read_b64_tr_b16 v[136:137], v218 offset:57344
    v_mfma_f32_16x16x32_bf16 v[12:15], v[148:151], a[100:103], v[12:15]
    ds_read_b64_tr_b16 v[138:139], v218 offset:59392
    v_mfma_f32_16x16x32_bf16 v[104:107], v[148:151], a[104:107], v[104:107]
    ds_read_b64_tr_b16 v[140:141], v219 offset:57344
    v_mfma_f32_16x16x32_bf16 v[108:111], v[148:151], a[108:111], v[108:111]
    ds_read_b64_tr_b16 v[142:143], v219 offset:59392
    v_mfma_f32_16x16x32_bf16 v[16:19], v[152:155], a[96:99], v[16:19]
    buffer_load_dwordx4 a[68:71], v227, s[8:11], s35 offen offset:0 sc1
    v_mfma_f32_16x16x32_bf16 v[20:23], v[152:155], a[100:103], v[20:23]
    v_mfma_f32_16x16x32_bf16 v[112:115], v[152:155], a[104:107], v[112:115]
    v_mfma_f32_16x16x32_bf16 v[116:119], v[152:155], a[108:111], v[116:119]
    v_mfma_f32_16x16x32_bf16 v[24:27], v[156:159], a[96:99], v[24:27]
    buffer_load_dwordx4 a[72:75], v245, s[8:11], s35 offen offset:0 sc1
    v_mfma_f32_16x16x32_bf16 v[28:31], v[156:159], a[100:103], v[28:31]
    v_mfma_f32_16x16x32_bf16 v[120:123], v[156:159], a[104:107], v[120:123]
    buffer_load_dwordx4 a[148:151], v228, s[8:11], s33 offen offset:1024 sc1
    v_mfma_f32_16x16x32_bf16 v[124:127], v[156:159], a[108:111], v[124:127]
    buffer_load_dwordx4 a[76:79], v246, s[8:11], s35 offen offset:0 sc1
    s_waitcnt vmcnt(34) lgkmcnt(0)
    v_mfma_f32_16x16x32_bf16 v[32:35], v[128:131], a[112:115], v[32:35]
    ds_read_b64_tr_b16 v[144:145], v220 offset:57344
    v_mfma_f32_16x16x32_bf16 v[36:39], v[128:131], a[116:119], v[36:39]
    ds_read_b64_tr_b16 v[146:147], v220 offset:59392
    v_mfma_f32_16x16x32_bf16 v[64:67], v[128:131], a[120:123], v[64:67]
    ds_read_b64_tr_b16 v[148:149], v221 offset:57344
    v_mfma_f32_16x16x32_bf16 v[68:71], v[128:131], a[124:127], v[68:71]
    ds_read_b64_tr_b16 v[150:151], v221 offset:59392
    v_mfma_f32_16x16x32_bf16 v[40:43], v[132:135], a[112:115], v[40:43]
    ds_read_b64_tr_b16 v[152:153], v222 offset:57344
    v_mfma_f32_16x16x32_bf16 v[44:47], v[132:135], a[116:119], v[44:47]
    ds_read_b64_tr_b16 v[154:155], v222 offset:59392
    v_mfma_f32_16x16x32_bf16 v[72:75], v[132:135], a[120:123], v[72:75]
    ds_read_b64_tr_b16 v[156:157], v223 offset:57344
    v_mfma_f32_16x16x32_bf16 v[76:79], v[132:135], a[124:127], v[76:79]
    ds_read_b64_tr_b16 v[158:159], v223 offset:59392
    v_mfma_f32_16x16x32_bf16 v[48:51], v[136:139], a[112:115], v[48:51]
    buffer_load_dwordx4 a[80:83], v226, s[8:11], s35 offen offset:1024 sc1
    v_mfma_f32_16x16x32_bf16 v[52:55], v[136:139], a[116:119], v[52:55]
    s_add_u32 m0, s38, 90112
    s_add_u32 s32, s37, 1769472
    v_mfma_f32_16x16x32_bf16 v[80:83], v[136:139], a[120:123], v[80:83]
    buffer_load_dwordx4 v224, s[12:15], s32 offen lds
    v_mfma_f32_16x16x32_bf16 v[84:87], v[136:139], a[124:127], v[84:87]
    buffer_load_dwordx4 a[84:87], v227, s[8:11], s35 offen offset:1024 sc1
    v_mfma_f32_16x16x32_bf16 v[56:59], v[140:143], a[112:115], v[56:59]
    v_mfma_f32_16x16x32_bf16 v[60:63], v[140:143], a[116:119], v[60:63]
    buffer_load_dwordx4 v225, s[12:15], s32 offen offset:1024 lds
    v_mfma_f32_16x16x32_bf16 v[88:91], v[140:143], a[120:123], v[88:91]
    buffer_load_dwordx4 a[152:155], v228, s[8:11], s33 offen offset:2048 sc1
    v_mfma_f32_16x16x32_bf16 v[92:95], v[140:143], a[124:127], v[92:95]
    s_waitcnt vmcnt(60) lgkmcnt(0)
    s_barrier
    v_mfma_f32_16x16x32_bf16 v[0:3], v[144:147], a[112:115], v[0:3]
    v_xor_b32 v216, 0x10000, v216
    ds_read_b64_tr_b16 v[128:129], v216 offset:0
    v_mfma_f32_16x16x32_bf16 v[4:7], v[144:147], a[116:119], v[4:7]
    ds_read_b64_tr_b16 v[130:131], v216 offset:2048
    v_mfma_f32_16x16x32_bf16 v[96:99], v[144:147], a[120:123], v[96:99]
    v_xor_b32 v217, 0x10000, v217
    ds_read_b64_tr_b16 v[132:133], v217 offset:0
    v_mfma_f32_16x16x32_bf16 v[100:103], v[144:147], a[124:127], v[100:103]
    ds_read_b64_tr_b16 v[134:135], v217 offset:2048
    v_mfma_f32_16x16x32_bf16 v[8:11], v[148:151], a[112:115], v[8:11]
    v_xor_b32 v218, 0x10000, v218
    ds_read_b64_tr_b16 v[136:137], v218 offset:0
    v_mfma_f32_16x16x32_bf16 v[12:15], v[148:151], a[116:119], v[12:15]
    ds_read_b64_tr_b16 v[138:139], v218 offset:2048
    v_mfma_f32_16x16x32_bf16 v[104:107], v[148:151], a[120:123], v[104:107]
    v_xor_b32 v219, 0x10000, v219
    ds_read_b64_tr_b16 v[140:141], v219 offset:0
    v_mfma_f32_16x16x32_bf16 v[108:111], v[148:151], a[124:127], v[108:111]
    ds_read_b64_tr_b16 v[142:143], v219 offset:2048
    v_mfma_f32_16x16x32_bf16 v[16:19], v[152:155], a[112:115], v[16:19]
    buffer_load_dwordx4 a[88:91], v245, s[8:11], s35 offen offset:1024 sc1
    v_mfma_f32_16x16x32_bf16 v[20:23], v[152:155], a[116:119], v[20:23]
    v_mfma_f32_16x16x32_bf16 v[112:115], v[152:155], a[120:123], v[112:115]
    v_mfma_f32_16x16x32_bf16 v[116:119], v[152:155], a[124:127], v[116:119]
    v_mfma_f32_16x16x32_bf16 v[24:27], v[156:159], a[112:115], v[24:27]
    buffer_load_dwordx4 a[92:95], v246, s[8:11], s35 offen offset:1024 sc1
    v_mfma_f32_16x16x32_bf16 v[28:31], v[156:159], a[116:119], v[28:31]
    v_mfma_f32_16x16x32_bf16 v[120:123], v[156:159], a[120:123], v[120:123]
    buffer_load_dwordx4 a[156:159], v228, s[8:11], s33 offen offset:3072 sc1
    v_mfma_f32_16x16x32_bf16 v[124:127], v[156:159], a[124:127], v[124:127]
    s_waitcnt vmcnt(37) lgkmcnt(0)
    v_mfma_f32_16x16x32_bf16 v[32:35], v[128:131], a[0:3], v[32:35]
    v_xor_b32 v220, 0x10000, v220
    ds_read_b64_tr_b16 v[144:145], v220 offset:0
    v_mfma_f32_16x16x32_bf16 v[36:39], v[128:131], a[4:7], v[36:39]
    ds_read_b64_tr_b16 v[146:147], v220 offset:2048
    v_mfma_f32_16x16x32_bf16 v[64:67], v[128:131], a[8:11], v[64:67]
    v_xor_b32 v221, 0x10000, v221
    ds_read_b64_tr_b16 v[148:149], v221 offset:0
    v_mfma_f32_16x16x32_bf16 v[68:71], v[128:131], a[12:15], v[68:71]
    ds_read_b64_tr_b16 v[150:151], v221 offset:2048
    v_mfma_f32_16x16x32_bf16 v[40:43], v[132:135], a[0:3], v[40:43]
    v_xor_b32 v222, 0x10000, v222
    ds_read_b64_tr_b16 v[152:153], v222 offset:0
    v_mfma_f32_16x16x32_bf16 v[44:47], v[132:135], a[4:7], v[44:47]
    ds_read_b64_tr_b16 v[154:155], v222 offset:2048
    v_mfma_f32_16x16x32_bf16 v[72:75], v[132:135], a[8:11], v[72:75]
    v_xor_b32 v223, 0x10000, v223
    ds_read_b64_tr_b16 v[156:157], v223 offset:0
    v_mfma_f32_16x16x32_bf16 v[76:79], v[132:135], a[12:15], v[76:79]
    ds_read_b64_tr_b16 v[158:159], v223 offset:2048
    v_mfma_f32_16x16x32_bf16 v[48:51], v[136:139], a[0:3], v[48:51]
    buffer_load_dwordx4 a[96:99], v226, s[8:11], s35 offen offset:2048 sc1
    v_mfma_f32_16x16x32_bf16 v[52:55], v[136:139], a[4:7], v[52:55]
    s_add_u32 m0, s38, 98304
    s_add_u32 s32, s37, 1835008
    v_mfma_f32_16x16x32_bf16 v[80:83], v[136:139], a[8:11], v[80:83]
    buffer_load_dwordx4 v224, s[12:15], s32 offen lds
    v_mfma_f32_16x16x32_bf16 v[84:87], v[136:139], a[12:15], v[84:87]
    buffer_load_dwordx4 a[100:103], v227, s[8:11], s35 offen offset:2048 sc1
    v_mfma_f32_16x16x32_bf16 v[56:59], v[140:143], a[0:3], v[56:59]
    v_mfma_f32_16x16x32_bf16 v[60:63], v[140:143], a[4:7], v[60:63]
    buffer_load_dwordx4 v225, s[12:15], s32 offen offset:1024 lds
    v_mfma_f32_16x16x32_bf16 v[88:91], v[140:143], a[8:11], v[88:91]
    s_add_u32 s33, s55, 32768
    buffer_load_dwordx4 a[160:163], v228, s[8:11], s33 offen offset:0 sc1
    v_mfma_f32_16x16x32_bf16 v[92:95], v[140:143], a[12:15], v[92:95]
    s_waitcnt lgkmcnt(0)
    v_mfma_f32_16x16x32_bf16 v[0:3], v[144:147], a[0:3], v[0:3]
    ds_read_b64_tr_b16 v[128:129], v216 offset:8192
    v_mfma_f32_16x16x32_bf16 v[4:7], v[144:147], a[4:7], v[4:7]
    ds_read_b64_tr_b16 v[130:131], v216 offset:10240
    v_mfma_f32_16x16x32_bf16 v[96:99], v[144:147], a[8:11], v[96:99]
    ds_read_b64_tr_b16 v[132:133], v217 offset:8192
    v_mfma_f32_16x16x32_bf16 v[100:103], v[144:147], a[12:15], v[100:103]
    ds_read_b64_tr_b16 v[134:135], v217 offset:10240
    v_mfma_f32_16x16x32_bf16 v[8:11], v[148:151], a[0:3], v[8:11]
    ds_read_b64_tr_b16 v[136:137], v218 offset:8192
    v_mfma_f32_16x16x32_bf16 v[12:15], v[148:151], a[4:7], v[12:15]
    ds_read_b64_tr_b16 v[138:139], v218 offset:10240
    v_mfma_f32_16x16x32_bf16 v[104:107], v[148:151], a[8:11], v[104:107]
    ds_read_b64_tr_b16 v[140:141], v219 offset:8192
    v_mfma_f32_16x16x32_bf16 v[108:111], v[148:151], a[12:15], v[108:111]
    ds_read_b64_tr_b16 v[142:143], v219 offset:10240
    v_mfma_f32_16x16x32_bf16 v[16:19], v[152:155], a[0:3], v[16:19]
    buffer_load_dwordx4 a[104:107], v245, s[8:11], s35 offen offset:2048 sc1
    v_mfma_f32_16x16x32_bf16 v[20:23], v[152:155], a[4:7], v[20:23]
    v_mfma_f32_16x16x32_bf16 v[112:115], v[152:155], a[8:11], v[112:115]
    v_mfma_f32_16x16x32_bf16 v[116:119], v[152:155], a[12:15], v[116:119]
    v_mfma_f32_16x16x32_bf16 v[24:27], v[156:159], a[0:3], v[24:27]
    buffer_load_dwordx4 a[108:111], v246, s[8:11], s35 offen offset:2048 sc1
    v_mfma_f32_16x16x32_bf16 v[28:31], v[156:159], a[4:7], v[28:31]
    v_mfma_f32_16x16x32_bf16 v[120:123], v[156:159], a[8:11], v[120:123]
    buffer_load_dwordx4 a[164:167], v228, s[8:11], s33 offen offset:1024 sc1
    v_mfma_f32_16x16x32_bf16 v[124:127], v[156:159], a[12:15], v[124:127]
    buffer_load_dwordx4 a[112:115], v226, s[8:11], s35 offen offset:3072 sc1
    s_waitcnt vmcnt(40) lgkmcnt(0)
    v_mfma_f32_16x16x32_bf16 v[32:35], v[128:131], a[16:19], v[32:35]
    ds_read_b64_tr_b16 v[144:145], v220 offset:8192
    v_mfma_f32_16x16x32_bf16 v[36:39], v[128:131], a[20:23], v[36:39]
    ds_read_b64_tr_b16 v[146:147], v220 offset:10240
    v_mfma_f32_16x16x32_bf16 v[64:67], v[128:131], a[24:27], v[64:67]
    ds_read_b64_tr_b16 v[148:149], v221 offset:8192
    v_mfma_f32_16x16x32_bf16 v[68:71], v[128:131], a[28:31], v[68:71]
    ds_read_b64_tr_b16 v[150:151], v221 offset:10240
    v_mfma_f32_16x16x32_bf16 v[40:43], v[132:135], a[16:19], v[40:43]
    ds_read_b64_tr_b16 v[152:153], v222 offset:8192
    v_mfma_f32_16x16x32_bf16 v[44:47], v[132:135], a[20:23], v[44:47]
    ds_read_b64_tr_b16 v[154:155], v222 offset:10240
    v_mfma_f32_16x16x32_bf16 v[72:75], v[132:135], a[24:27], v[72:75]
    ds_read_b64_tr_b16 v[156:157], v223 offset:8192
    v_mfma_f32_16x16x32_bf16 v[76:79], v[132:135], a[28:31], v[76:79]
    ds_read_b64_tr_b16 v[158:159], v223 offset:10240
    v_mfma_f32_16x16x32_bf16 v[48:51], v[136:139], a[16:19], v[48:51]
    buffer_load_dwordx4 a[116:119], v227, s[8:11], s35 offen offset:3072 sc1
    v_mfma_f32_16x16x32_bf16 v[52:55], v[136:139], a[20:23], v[52:55]
    s_add_u32 m0, s38, 106496
    s_add_u32 s32, s37, 1900544
    v_mfma_f32_16x16x32_bf16 v[80:83], v[136:139], a[24:27], v[80:83]
    buffer_load_dwordx4 v224, s[12:15], s32 offen lds
    v_mfma_f32_16x16x32_bf16 v[84:87], v[136:139], a[28:31], v[84:87]
    buffer_load_dwordx4 a[120:123], v245, s[8:11], s35 offen offset:3072 sc1
    v_mfma_f32_16x16x32_bf16 v[56:59], v[140:143], a[16:19], v[56:59]
    v_mfma_f32_16x16x32_bf16 v[60:63], v[140:143], a[20:23], v[60:63]
    buffer_load_dwordx4 v225, s[12:15], s32 offen offset:1024 lds
    v_mfma_f32_16x16x32_bf16 v[88:91], v[140:143], a[24:27], v[88:91]
    buffer_load_dwordx4 a[168:171], v228, s[8:11], s33 offen offset:2048 sc1
    v_mfma_f32_16x16x32_bf16 v[92:95], v[140:143], a[28:31], v[92:95]
    s_waitcnt lgkmcnt(0)
    v_mfma_f32_16x16x32_bf16 v[0:3], v[144:147], a[16:19], v[0:3]
    ds_read_b64_tr_b16 v[128:129], v216 offset:16384
    v_mfma_f32_16x16x32_bf16 v[4:7], v[144:147], a[20:23], v[4:7]
    ds_read_b64_tr_b16 v[130:131], v216 offset:18432
    v_mfma_f32_16x16x32_bf16 v[96:99], v[144:147], a[24:27], v[96:99]
    ds_read_b64_tr_b16 v[132:133], v217 offset:16384
    v_mfma_f32_16x16x32_bf16 v[100:103], v[144:147], a[28:31], v[100:103]
    ds_read_b64_tr_b16 v[134:135], v217 offset:18432
    v_mfma_f32_16x16x32_bf16 v[8:11], v[148:151], a[16:19], v[8:11]
    ds_read_b64_tr_b16 v[136:137], v218 offset:16384
    v_mfma_f32_16x16x32_bf16 v[12:15], v[148:151], a[20:23], v[12:15]
    ds_read_b64_tr_b16 v[138:139], v218 offset:18432
    v_mfma_f32_16x16x32_bf16 v[104:107], v[148:151], a[24:27], v[104:107]
    ds_read_b64_tr_b16 v[140:141], v219 offset:16384
    v_mfma_f32_16x16x32_bf16 v[108:111], v[148:151], a[28:31], v[108:111]
    ds_read_b64_tr_b16 v[142:143], v219 offset:18432
    v_mfma_f32_16x16x32_bf16 v[16:19], v[152:155], a[16:19], v[16:19]
    buffer_load_dwordx4 a[124:127], v246, s[8:11], s35 offen offset:3072 sc1
    v_mfma_f32_16x16x32_bf16 v[20:23], v[152:155], a[20:23], v[20:23]
    v_mfma_f32_16x16x32_bf16 v[112:115], v[152:155], a[24:27], v[112:115]
    v_mfma_f32_16x16x32_bf16 v[116:119], v[152:155], a[28:31], v[116:119]
    v_mfma_f32_16x16x32_bf16 v[24:27], v[156:159], a[16:19], v[24:27]
    s_add_u32 s35, s35, 4096
    buffer_load_dwordx4 a[0:3], v226, s[8:11], s35 offen offset:0 sc1
    v_mfma_f32_16x16x32_bf16 v[28:31], v[156:159], a[20:23], v[28:31]
    v_mfma_f32_16x16x32_bf16 v[120:123], v[156:159], a[24:27], v[120:123]
    buffer_load_dwordx4 a[172:175], v228, s[8:11], s33 offen offset:3072 sc1
    v_mfma_f32_16x16x32_bf16 v[124:127], v[156:159], a[28:31], v[124:127]
    s_waitcnt vmcnt(41) lgkmcnt(0)
    v_mfma_f32_16x16x32_bf16 v[32:35], v[128:131], a[32:35], v[32:35]
    ds_read_b64_tr_b16 v[144:145], v220 offset:16384
    v_mfma_f32_16x16x32_bf16 v[36:39], v[128:131], a[36:39], v[36:39]
    ds_read_b64_tr_b16 v[146:147], v220 offset:18432
    v_mfma_f32_16x16x32_bf16 v[64:67], v[128:131], a[40:43], v[64:67]
    ds_read_b64_tr_b16 v[148:149], v221 offset:16384
    v_mfma_f32_16x16x32_bf16 v[68:71], v[128:131], a[44:47], v[68:71]
    ds_read_b64_tr_b16 v[150:151], v221 offset:18432
    v_mfma_f32_16x16x32_bf16 v[40:43], v[132:135], a[32:35], v[40:43]
    ds_read_b64_tr_b16 v[152:153], v222 offset:16384
    v_mfma_f32_16x16x32_bf16 v[44:47], v[132:135], a[36:39], v[44:47]
    ds_read_b64_tr_b16 v[154:155], v222 offset:18432
    v_mfma_f32_16x16x32_bf16 v[72:75], v[132:135], a[40:43], v[72:75]
    ds_read_b64_tr_b16 v[156:157], v223 offset:16384
    v_mfma_f32_16x16x32_bf16 v[76:79], v[132:135], a[44:47], v[76:79]
    ds_read_b64_tr_b16 v[158:159], v223 offset:18432
    v_mfma_f32_16x16x32_bf16 v[48:51], v[136:139], a[32:35], v[48:51]
    buffer_load_dwordx4 a[4:7], v227, s[8:11], s35 offen offset:0 sc1
    v_mfma_f32_16x16x32_bf16 v[52:55], v[136:139], a[36:39], v[52:55]
    s_add_u32 m0, s38, 114688
    s_add_u32 s32, s37, 1966080
    v_mfma_f32_16x16x32_bf16 v[80:83], v[136:139], a[40:43], v[80:83]
    buffer_load_dwordx4 v224, s[12:15], s32 offen lds
    v_mfma_f32_16x16x32_bf16 v[84:87], v[136:139], a[44:47], v[84:87]
    buffer_load_dwordx4 a[8:11], v245, s[8:11], s35 offen offset:0 sc1
    v_mfma_f32_16x16x32_bf16 v[56:59], v[140:143], a[32:35], v[56:59]
    v_mfma_f32_16x16x32_bf16 v[60:63], v[140:143], a[36:39], v[60:63]
    buffer_load_dwordx4 v225, s[12:15], s32 offen offset:1024 lds
    v_mfma_f32_16x16x32_bf16 v[88:91], v[140:143], a[40:43], v[88:91]
    s_add_u32 s33, s55, 36864
    buffer_load_dwordx4 a[176:179], v228, s[8:11], s33 offen offset:0 sc1
    v_mfma_f32_16x16x32_bf16 v[92:95], v[140:143], a[44:47], v[92:95]
    s_waitcnt lgkmcnt(0)
    v_mfma_f32_16x16x32_bf16 v[0:3], v[144:147], a[32:35], v[0:3]
    ds_read_b64_tr_b16 v[128:129], v216 offset:24576
    v_mfma_f32_16x16x32_bf16 v[4:7], v[144:147], a[36:39], v[4:7]
    ds_read_b64_tr_b16 v[130:131], v216 offset:26624
    v_mfma_f32_16x16x32_bf16 v[96:99], v[144:147], a[40:43], v[96:99]
    ds_read_b64_tr_b16 v[132:133], v217 offset:24576
    v_mfma_f32_16x16x32_bf16 v[100:103], v[144:147], a[44:47], v[100:103]
    ds_read_b64_tr_b16 v[134:135], v217 offset:26624
    v_mfma_f32_16x16x32_bf16 v[8:11], v[148:151], a[32:35], v[8:11]
    ds_read_b64_tr_b16 v[136:137], v218 offset:24576
    v_mfma_f32_16x16x32_bf16 v[12:15], v[148:151], a[36:39], v[12:15]
    ds_read_b64_tr_b16 v[138:139], v218 offset:26624
    v_mfma_f32_16x16x32_bf16 v[104:107], v[148:151], a[40:43], v[104:107]
    ds_read_b64_tr_b16 v[140:141], v219 offset:24576
    v_mfma_f32_16x16x32_bf16 v[108:111], v[148:151], a[44:47], v[108:111]
    ds_read_b64_tr_b16 v[142:143], v219 offset:26624
    v_mfma_f32_16x16x32_bf16 v[16:19], v[152:155], a[32:35], v[16:19]
    buffer_load_dwordx4 a[12:15], v246, s[8:11], s35 offen offset:0 sc1
    v_mfma_f32_16x16x32_bf16 v[20:23], v[152:155], a[36:39], v[20:23]
    v_mfma_f32_16x16x32_bf16 v[112:115], v[152:155], a[40:43], v[112:115]
    v_mfma_f32_16x16x32_bf16 v[116:119], v[152:155], a[44:47], v[116:119]
    v_mfma_f32_16x16x32_bf16 v[24:27], v[156:159], a[32:35], v[24:27]
    buffer_load_dwordx4 a[16:19], v226, s[8:11], s35 offen offset:1024 sc1
    v_mfma_f32_16x16x32_bf16 v[28:31], v[156:159], a[36:39], v[28:31]
    v_mfma_f32_16x16x32_bf16 v[120:123], v[156:159], a[40:43], v[120:123]
    buffer_load_dwordx4 a[180:183], v228, s[8:11], s33 offen offset:1024 sc1
    v_mfma_f32_16x16x32_bf16 v[124:127], v[156:159], a[44:47], v[124:127]
    buffer_load_dwordx4 a[20:23], v227, s[8:11], s35 offen offset:1024 sc1
    s_waitcnt vmcnt(42) lgkmcnt(0)
    v_mfma_f32_16x16x32_bf16 v[32:35], v[128:131], a[48:51], v[32:35]
    ds_read_b64_tr_b16 v[144:145], v220 offset:24576
    v_mfma_f32_16x16x32_bf16 v[36:39], v[128:131], a[52:55], v[36:39]
    ds_read_b64_tr_b16 v[146:147], v220 offset:26624
    v_mfma_f32_16x16x32_bf16 v[64:67], v[128:131], a[56:59], v[64:67]
    ds_read_b64_tr_b16 v[148:149], v221 offset:24576
    v_mfma_f32_16x16x32_bf16 v[68:71], v[128:131], a[60:63], v[68:71]
    ds_read_b64_tr_b16 v[150:151], v221 offset:26624
    v_mfma_f32_16x16x32_bf16 v[40:43], v[132:135], a[48:51], v[40:43]
    ds_read_b64_tr_b16 v[152:153], v222 offset:24576
    v_mfma_f32_16x16x32_bf16 v[44:47], v[132:135], a[52:55], v[44:47]
    ds_read_b64_tr_b16 v[154:155], v222 offset:26624
    v_mfma_f32_16x16x32_bf16 v[72:75], v[132:135], a[56:59], v[72:75]
    ds_read_b64_tr_b16 v[156:157], v223 offset:24576
    v_mfma_f32_16x16x32_bf16 v[76:79], v[132:135], a[60:63], v[76:79]
    ds_read_b64_tr_b16 v[158:159], v223 offset:26624
    v_mfma_f32_16x16x32_bf16 v[48:51], v[136:139], a[48:51], v[48:51]
    buffer_load_dwordx4 a[24:27], v245, s[8:11], s35 offen offset:1024 sc1
    v_mfma_f32_16x16x32_bf16 v[52:55], v[136:139], a[52:55], v[52:55]
    s_add_u32 m0, s38, 122880
    s_add_u32 s32, s37, 2031616
    v_mfma_f32_16x16x32_bf16 v[80:83], v[136:139], a[56:59], v[80:83]
    buffer_load_dwordx4 v224, s[12:15], s32 offen lds
    v_mfma_f32_16x16x32_bf16 v[84:87], v[136:139], a[60:63], v[84:87]
    buffer_load_dwordx4 a[28:31], v246, s[8:11], s35 offen offset:1024 sc1
    v_mfma_f32_16x16x32_bf16 v[56:59], v[140:143], a[48:51], v[56:59]
    v_mfma_f32_16x16x32_bf16 v[60:63], v[140:143], a[52:55], v[60:63]
    buffer_load_dwordx4 v225, s[12:15], s32 offen offset:1024 lds
    v_mfma_f32_16x16x32_bf16 v[88:91], v[140:143], a[56:59], v[88:91]
    buffer_load_dwordx4 a[184:187], v228, s[8:11], s33 offen offset:2048 sc1
    v_mfma_f32_16x16x32_bf16 v[92:95], v[140:143], a[60:63], v[92:95]
    s_waitcnt vmcnt(63) lgkmcnt(0)
    s_barrier
    v_mfma_f32_16x16x32_bf16 v[0:3], v[144:147], a[48:51], v[0:3]
    ds_read_b64_tr_b16 v[128:129], v216 offset:32768
    v_mfma_f32_16x16x32_bf16 v[4:7], v[144:147], a[52:55], v[4:7]
    ds_read_b64_tr_b16 v[130:131], v216 offset:34816
    v_mfma_f32_16x16x32_bf16 v[96:99], v[144:147], a[56:59], v[96:99]
    ds_read_b64_tr_b16 v[132:133], v217 offset:32768
    v_mfma_f32_16x16x32_bf16 v[100:103], v[144:147], a[60:63], v[100:103]
    ds_read_b64_tr_b16 v[134:135], v217 offset:34816
    v_mfma_f32_16x16x32_bf16 v[8:11], v[148:151], a[48:51], v[8:11]
    ds_read_b64_tr_b16 v[136:137], v218 offset:32768
    v_mfma_f32_16x16x32_bf16 v[12:15], v[148:151], a[52:55], v[12:15]
    ds_read_b64_tr_b16 v[138:139], v218 offset:34816
    v_mfma_f32_16x16x32_bf16 v[104:107], v[148:151], a[56:59], v[104:107]
    ds_read_b64_tr_b16 v[140:141], v219 offset:32768
    v_mfma_f32_16x16x32_bf16 v[108:111], v[148:151], a[60:63], v[108:111]
    ds_read_b64_tr_b16 v[142:143], v219 offset:34816
    v_mfma_f32_16x16x32_bf16 v[16:19], v[152:155], a[48:51], v[16:19]
    buffer_load_dwordx4 a[32:35], v226, s[8:11], s35 offen offset:2048 sc1
    v_mfma_f32_16x16x32_bf16 v[20:23], v[152:155], a[52:55], v[20:23]
    v_mfma_f32_16x16x32_bf16 v[112:115], v[152:155], a[56:59], v[112:115]
    v_mfma_f32_16x16x32_bf16 v[116:119], v[152:155], a[60:63], v[116:119]
    v_mfma_f32_16x16x32_bf16 v[24:27], v[156:159], a[48:51], v[24:27]
    buffer_load_dwordx4 a[36:39], v227, s[8:11], s35 offen offset:2048 sc1
    v_mfma_f32_16x16x32_bf16 v[28:31], v[156:159], a[52:55], v[28:31]
    v_mfma_f32_16x16x32_bf16 v[120:123], v[156:159], a[56:59], v[120:123]
    buffer_load_dwordx4 a[188:191], v228, s[8:11], s33 offen offset:3072 sc1
    v_mfma_f32_16x16x32_bf16 v[124:127], v[156:159], a[60:63], v[124:127]
    s_waitcnt vmcnt(42) lgkmcnt(0)
    v_mfma_f32_16x16x32_bf16 v[32:35], v[128:131], a[64:67], v[32:35]
    ds_read_b64_tr_b16 v[144:145], v220 offset:32768
    v_mfma_f32_16x16x32_bf16 v[36:39], v[128:131], a[68:71], v[36:39]
    ds_read_b64_tr_b16 v[146:147], v220 offset:34816
    v_mfma_f32_16x16x32_bf16 v[64:67], v[128:131], a[72:75], v[64:67]
    ds_read_b64_tr_b16 v[148:149], v221 offset:32768
    v_mfma_f32_16x16x32_bf16 v[68:71], v[128:131], a[76:79], v[68:71]
    ds_read_b64_tr_b16 v[150:151], v221 offset:34816
    v_mfma_f32_16x16x32_bf16 v[40:43], v[132:135], a[64:67], v[40:43]
    ds_read_b64_tr_b16 v[152:153], v222 offset:32768
    v_mfma_f32_16x16x32_bf16 v[44:47], v[132:135], a[68:71], v[44:47]
    ds_read_b64_tr_b16 v[154:155], v222 offset:34816
    v_mfma_f32_16x16x32_bf16 v[72:75], v[132:135], a[72:75], v[72:75]
    ds_read_b64_tr_b16 v[156:157], v223 offset:32768
    v_mfma_f32_16x16x32_bf16 v[76:79], v[132:135], a[76:79], v[76:79]
    ds_read_b64_tr_b16 v[158:159], v223 offset:34816
    v_mfma_f32_16x16x32_bf16 v[48:51], v[136:139], a[64:67], v[48:51]
    buffer_load_dwordx4 a[40:43], v245, s[8:11], s35 offen offset:2048 sc1
    v_mfma_f32_16x16x32_bf16 v[52:55], v[136:139], a[68:71], v[52:55]
    v_mfma_f32_16x16x32_bf16 v[80:83], v[136:139], a[72:75], v[80:83]
    v_mfma_f32_16x16x32_bf16 v[84:87], v[136:139], a[76:79], v[84:87]
    buffer_load_dwordx4 a[44:47], v246, s[8:11], s35 offen offset:2048 sc1
    v_mfma_f32_16x16x32_bf16 v[56:59], v[140:143], a[64:67], v[56:59]
    v_mfma_f32_16x16x32_bf16 v[60:63], v[140:143], a[68:71], v[60:63]
    s_mov_b32 s32, 0
    buffer_load_dwordx4 v[192:195], v229, s[16:19], s32 offen
    v_mfma_f32_16x16x32_bf16 v[88:91], v[140:143], a[72:75], v[88:91]
    v_mfma_f32_16x16x32_bf16 v[92:95], v[140:143], a[76:79], v[92:95]
    s_waitcnt lgkmcnt(0)
    v_mfma_f32_16x16x32_bf16 v[0:3], v[144:147], a[64:67], v[0:3]
    ds_read_b64_tr_b16 v[128:129], v216 offset:40960
    v_mfma_f32_16x16x32_bf16 v[4:7], v[144:147], a[68:71], v[4:7]
    ds_read_b64_tr_b16 v[130:131], v216 offset:43008
    v_mfma_f32_16x16x32_bf16 v[96:99], v[144:147], a[72:75], v[96:99]
    ds_read_b64_tr_b16 v[132:133], v217 offset:40960
    v_mfma_f32_16x16x32_bf16 v[100:103], v[144:147], a[76:79], v[100:103]
    ds_read_b64_tr_b16 v[134:135], v217 offset:43008
    v_mfma_f32_16x16x32_bf16 v[8:11], v[148:151], a[64:67], v[8:11]
    ds_read_b64_tr_b16 v[136:137], v218 offset:40960
    v_mfma_f32_16x16x32_bf16 v[12:15], v[148:151], a[68:71], v[12:15]
    ds_read_b64_tr_b16 v[138:139], v218 offset:43008
    v_mfma_f32_16x16x32_bf16 v[104:107], v[148:151], a[72:75], v[104:107]
    ds_read_b64_tr_b16 v[140:141], v219 offset:40960
    v_mfma_f32_16x16x32_bf16 v[108:111], v[148:151], a[76:79], v[108:111]
    ds_read_b64_tr_b16 v[142:143], v219 offset:43008
    v_mfma_f32_16x16x32_bf16 v[16:19], v[152:155], a[64:67], v[16:19]
    buffer_load_dwordx4 a[48:51], v226, s[8:11], s35 offen offset:3072 sc1
    v_mfma_f32_16x16x32_bf16 v[20:23], v[152:155], a[68:71], v[20:23]
    v_mfma_f32_16x16x32_bf16 v[112:115], v[152:155], a[72:75], v[112:115]
    v_mfma_f32_16x16x32_bf16 v[116:119], v[152:155], a[76:79], v[116:119]
    v_mfma_f32_16x16x32_bf16 v[24:27], v[156:159], a[64:67], v[24:27]
    buffer_load_dwordx4 a[52:55], v227, s[8:11], s35 offen offset:3072 sc1
    v_mfma_f32_16x16x32_bf16 v[28:31], v[156:159], a[68:71], v[28:31]
    s_mov_b32 s32, 16384
    buffer_load_dwordx4 v[196:199], v229, s[16:19], s32 offen
    v_mfma_f32_16x16x32_bf16 v[120:123], v[156:159], a[72:75], v[120:123]
    v_mfma_f32_16x16x32_bf16 v[124:127], v[156:159], a[76:79], v[124:127]
    buffer_load_dwordx4 a[56:59], v245, s[8:11], s35 offen offset:3072 sc1
    s_waitcnt vmcnt(42) lgkmcnt(0)
    v_mfma_f32_16x16x32_bf16 v[32:35], v[128:131], a[80:83], v[32:35]
    ds_read_b64_tr_b16 v[144:145], v220 offset:40960
    v_mfma_f32_16x16x32_bf16 v[36:39], v[128:131], a[84:87], v[36:39]
    ds_read_b64_tr_b16 v[146:147], v220 offset:43008
    v_mfma_f32_16x16x32_bf16 v[64:67], v[128:131], a[88:91], v[64:67]
    ds_read_b64_tr_b16 v[148:149], v221 offset:40960
    v_mfma_f32_16x16x32_bf16 v[68:71], v[128:131], a[92:95], v[68:71]
    ds_read_b64_tr_b16 v[150:151], v221 offset:43008
    v_mfma_f32_16x16x32_bf16 v[40:43], v[132:135], a[80:83], v[40:43]
    ds_read_b64_tr_b16 v[152:153], v222 offset:40960
    v_mfma_f32_16x16x32_bf16 v[44:47], v[132:135], a[84:87], v[44:47]
    ds_read_b64_tr_b16 v[154:155], v222 offset:43008
    v_mfma_f32_16x16x32_bf16 v[72:75], v[132:135], a[88:91], v[72:75]
    ds_read_b64_tr_b16 v[156:157], v223 offset:40960
    v_mfma_f32_16x16x32_bf16 v[76:79], v[132:135], a[92:95], v[76:79]
    ds_read_b64_tr_b16 v[158:159], v223 offset:43008
    v_mfma_f32_16x16x32_bf16 v[48:51], v[136:139], a[80:83], v[48:51]
    buffer_load_dwordx4 a[60:63], v246, s[8:11], s35 offen offset:3072 sc1
    v_mfma_f32_16x16x32_bf16 v[52:55], v[136:139], a[84:87], v[52:55]
    v_mfma_f32_16x16x32_bf16 v[80:83], v[136:139], a[88:91], v[80:83]
    v_mfma_f32_16x16x32_bf16 v[84:87], v[136:139], a[92:95], v[84:87]
    s_add_u32 s35, s35, 4096
    buffer_load_dwordx4 a[64:67], v226, s[8:11], s35 offen offset:0 sc1
    v_mfma_f32_16x16x32_bf16 v[56:59], v[140:143], a[80:83], v[56:59]
    v_mfma_f32_16x16x32_bf16 v[60:63], v[140:143], a[84:87], v[60:63]
    s_mov_b32 s32, 32768
    buffer_load_dwordx4 v[200:203], v229, s[16:19], s32 offen
    v_mfma_f32_16x16x32_bf16 v[88:91], v[140:143], a[88:91], v[88:91]
    v_mfma_f32_16x16x32_bf16 v[92:95], v[140:143], a[92:95], v[92:95]
    s_waitcnt lgkmcnt(0)
    v_mfma_f32_16x16x32_bf16 v[0:3], v[144:147], a[80:83], v[0:3]
    ds_read_b64_tr_b16 v[128:129], v216 offset:49152
    v_mfma_f32_16x16x32_bf16 v[4:7], v[144:147], a[84:87], v[4:7]
    ds_read_b64_tr_b16 v[130:131], v216 offset:51200
    v_mfma_f32_16x16x32_bf16 v[96:99], v[144:147], a[88:91], v[96:99]
    ds_read_b64_tr_b16 v[132:133], v217 offset:49152
    v_mfma_f32_16x16x32_bf16 v[100:103], v[144:147], a[92:95], v[100:103]
    ds_read_b64_tr_b16 v[134:135], v217 offset:51200
    v_mfma_f32_16x16x32_bf16 v[8:11], v[148:151], a[80:83], v[8:11]
    ds_read_b64_tr_b16 v[136:137], v218 offset:49152
    v_mfma_f32_16x16x32_bf16 v[12:15], v[148:151], a[84:87], v[12:15]
    ds_read_b64_tr_b16 v[138:139], v218 offset:51200
    v_mfma_f32_16x16x32_bf16 v[104:107], v[148:151], a[88:91], v[104:107]
    ds_read_b64_tr_b16 v[140:141], v219 offset:49152
    v_mfma_f32_16x16x32_bf16 v[108:111], v[148:151], a[92:95], v[108:111]
    ds_read_b64_tr_b16 v[142:143], v219 offset:51200
    v_mfma_f32_16x16x32_bf16 v[16:19], v[152:155], a[80:83], v[16:19]
    buffer_load_dwordx4 a[68:71], v227, s[8:11], s35 offen offset:0 sc1
    v_mfma_f32_16x16x32_bf16 v[20:23], v[152:155], a[84:87], v[20:23]
    v_mfma_f32_16x16x32_bf16 v[112:115], v[152:155], a[88:91], v[112:115]
    v_mfma_f32_16x16x32_bf16 v[116:119], v[152:155], a[92:95], v[116:119]
    v_mfma_f32_16x16x32_bf16 v[24:27], v[156:159], a[80:83], v[24:27]
    buffer_load_dwordx4 a[72:75], v245, s[8:11], s35 offen offset:0 sc1
    v_mfma_f32_16x16x32_bf16 v[28:31], v[156:159], a[84:87], v[28:31]
    s_mov_b32 s32, 49152
    buffer_load_dwordx4 v[204:207], v229, s[16:19], s32 offen
    v_mfma_f32_16x16x32_bf16 v[120:123], v[156:159], a[88:91], v[120:123]
    v_mfma_f32_16x16x32_bf16 v[124:127], v[156:159], a[92:95], v[124:127]
    s_waitcnt vmcnt(40) lgkmcnt(0)
    v_mfma_f32_16x16x32_bf16 v[32:35], v[128:131], a[96:99], v[32:35]
    ds_read_b64_tr_b16 v[144:145], v220 offset:49152
    v_mfma_f32_16x16x32_bf16 v[36:39], v[128:131], a[100:103], v[36:39]
    ds_read_b64_tr_b16 v[146:147], v220 offset:51200
    v_mfma_f32_16x16x32_bf16 v[64:67], v[128:131], a[104:107], v[64:67]
    ds_read_b64_tr_b16 v[148:149], v221 offset:49152
    v_mfma_f32_16x16x32_bf16 v[68:71], v[128:131], a[108:111], v[68:71]
    ds_read_b64_tr_b16 v[150:151], v221 offset:51200
    v_mfma_f32_16x16x32_bf16 v[40:43], v[132:135], a[96:99], v[40:43]
    ds_read_b64_tr_b16 v[152:153], v222 offset:49152
    v_mfma_f32_16x16x32_bf16 v[44:47], v[132:135], a[100:103], v[44:47]
    ds_read_b64_tr_b16 v[154:155], v222 offset:51200
    v_mfma_f32_16x16x32_bf16 v[72:75], v[132:135], a[104:107], v[72:75]
    ds_read_b64_tr_b16 v[156:157], v223 offset:49152
    v_mfma_f32_16x16x32_bf16 v[76:79], v[132:135], a[108:111], v[76:79]
    ds_read_b64_tr_b16 v[158:159], v223 offset:51200
    v_mfma_f32_16x16x32_bf16 v[48:51], v[136:139], a[96:99], v[48:51]
    buffer_load_dwordx4 a[76:79], v246, s[8:11], s35 offen offset:0 sc1
    v_mfma_f32_16x16x32_bf16 v[52:55], v[136:139], a[100:103], v[52:55]
    v_mfma_f32_16x16x32_bf16 v[80:83], v[136:139], a[104:107], v[80:83]
    v_mfma_f32_16x16x32_bf16 v[84:87], v[136:139], a[108:111], v[84:87]
    buffer_load_dwordx4 a[80:83], v226, s[8:11], s35 offen offset:1024 sc1
    v_mfma_f32_16x16x32_bf16 v[56:59], v[140:143], a[96:99], v[56:59]
    v_mfma_f32_16x16x32_bf16 v[60:63], v[140:143], a[100:103], v[60:63]
    buffer_load_dwordx4 v[208:211], v240, s[20:23], 0 offen
    v_mfma_f32_16x16x32_bf16 v[88:91], v[140:143], a[104:107], v[88:91]
    v_mfma_f32_16x16x32_bf16 v[92:95], v[140:143], a[108:111], v[92:95]
    s_waitcnt lgkmcnt(0)
    v_mfma_f32_16x16x32_bf16 v[0:3], v[144:147], a[96:99], v[0:3]
    ds_read_b64_tr_b16 v[128:129], v216 offset:57344
    v_mfma_f32_16x16x32_bf16 v[4:7], v[144:147], a[100:103], v[4:7]
    ds_read_b64_tr_b16 v[130:131], v216 offset:59392
    v_mfma_f32_16x16x32_bf16 v[96:99], v[144:147], a[104:107], v[96:99]
    ds_read_b64_tr_b16 v[132:133], v217 offset:57344
    v_mfma_f32_16x16x32_bf16 v[100:103], v[144:147], a[108:111], v[100:103]
    ds_read_b64_tr_b16 v[134:135], v217 offset:59392
    v_mfma_f32_16x16x32_bf16 v[8:11], v[148:151], a[96:99], v[8:11]
    ds_read_b64_tr_b16 v[136:137], v218 offset:57344
    v_mfma_f32_16x16x32_bf16 v[12:15], v[148:151], a[100:103], v[12:15]
    ds_read_b64_tr_b16 v[138:139], v218 offset:59392
    v_mfma_f32_16x16x32_bf16 v[104:107], v[148:151], a[104:107], v[104:107]
    ds_read_b64_tr_b16 v[140:141], v219 offset:57344
    v_mfma_f32_16x16x32_bf16 v[108:111], v[148:151], a[108:111], v[108:111]
    ds_read_b64_tr_b16 v[142:143], v219 offset:59392
    v_mfma_f32_16x16x32_bf16 v[16:19], v[152:155], a[96:99], v[16:19]
    buffer_load_dwordx4 a[84:87], v227, s[8:11], s35 offen offset:1024 sc1
    v_mfma_f32_16x16x32_bf16 v[20:23], v[152:155], a[100:103], v[20:23]
    v_mfma_f32_16x16x32_bf16 v[112:115], v[152:155], a[104:107], v[112:115]
    v_mfma_f32_16x16x32_bf16 v[116:119], v[152:155], a[108:111], v[116:119]
    v_mfma_f32_16x16x32_bf16 v[24:27], v[156:159], a[96:99], v[24:27]
    buffer_load_dwordx4 a[88:91], v245, s[8:11], s35 offen offset:1024 sc1
    v_mfma_f32_16x16x32_bf16 v[28:31], v[156:159], a[100:103], v[28:31]
    s_mov_b32 s32, kc_tail-kc_pc0
    v_lshlrev_b32 v234, 7, v230
    buffer_load_dword v241, v234, s[56:59], s32 offen
    v_mfma_f32_16x16x32_bf16 v[120:123], v[156:159], a[104:107], v[120:123]
    v_mfma_f32_16x16x32_bf16 v[124:127], v[156:159], a[108:111], v[124:127]
    buffer_load_dwordx4 a[92:95], v246, s[8:11], s35 offen offset:1024 sc1
    s_waitcnt vmcnt(39) lgkmcnt(0)
    v_mfma_f32_16x16x32_bf16 v[32:35], v[128:131], a[112:115], v[32:35]
    ds_read_b64_tr_b16 v[144:145], v220 offset:57344
    v_mfma_f32_16x16x32_bf16 v[36:39], v[128:131], a[116:119], v[36:39]
    ds_read_b64_tr_b16 v[146:147], v220 offset:59392
    v_mfma_f32_16x16x32_bf16 v[64:67], v[128:131], a[120:123], v[64:67]
    ds_read_b64_tr_b16 v[148:149], v221 offset:57344
    v_mfma_f32_16x16x32_bf16 v[68:71], v[128:131], a[124:127], v[68:71]
    ds_read_b64_tr_b16 v[150:151], v221 offset:59392
    v_mfma_f32_16x16x32_bf16 v[40:43], v[132:135], a[112:115], v[40:43]
    ds_read_b64_tr_b16 v[152:153], v222 offset:57344
    v_mfma_f32_16x16x32_bf16 v[44:47], v[132:135], a[116:119], v[44:47]
    ds_read_b64_tr_b16 v[154:155], v222 offset:59392
    v_mfma_f32_16x16x32_bf16 v[72:75], v[132:135], a[120:123], v[72:75]
    ds_read_b64_tr_b16 v[156:157], v223 offset:57344
    v_mfma_f32_16x16x32_bf16 v[76:79], v[132:135], a[124:127], v[76:79]
    ds_read_b64_tr_b16 v[158:159], v223 offset:59392
    v_mfma_f32_16x16x32_bf16 v[48:51], v[136:139], a[112:115], v[48:51]
    buffer_load_dwordx4 a[96:99], v226, s[8:11], s35 offen offset:2048 sc1
    v_mfma_f32_16x16x32_bf16 v[52:55], v[136:139], a[116:119], v[52:55]
    v_mfma_f32_16x16x32_bf16 v[80:83], v[136:139], a[120:123], v[80:83]
    v_mfma_f32_16x16x32_bf16 v[84:87], v[136:139], a[124:127], v[84:87]
    buffer_load_dwordx4 a[100:103], v227, s[8:11], s35 offen offset:2048 sc1
    v_mfma_f32_16x16x32_bf16 v[56:59], v[140:143], a[112:115], v[56:59]
    v_mfma_f32_16x16x32_bf16 v[60:63], v[140:143], a[116:119], v[60:63]
    v_mfma_f32_16x16x32_bf16 v[88:91], v[140:143], a[120:123], v[88:91]
    v_mfma_f32_16x16x32_bf16 v[92:95], v[140:143], a[124:127], v[92:95]
    s_waitcnt vmcnt(26) lgkmcnt(0)
    s_barrier
    v_mfma_f32_16x16x32_bf16 v[0:3], v[144:147], a[112:115], v[0:3]
    v_xor_b32 v220, 0x10000, v220
    ds_read_b64_tr_b16 v[128:129], v220 offset:0
    v_mfma_f32_16x16x32_bf16 v[4:7], v[144:147], a[116:119], v[4:7]
    ds_read_b64_tr_b16 v[130:131], v220 offset:2048
    v_mfma_f32_16x16x32_bf16 v[96:99], v[144:147], a[120:123], v[96:99]
    v_xor_b32 v221, 0x10000, v221
    ds_read_b64_tr_b16 v[132:133], v221 offset:0
    v_mfma_f32_16x16x32_bf16 v[100:103], v[144:147], a[124:127], v[100:103]
    ds_read_b64_tr_b16 v[134:135], v221 offset:2048
    v_mfma_f32_16x16x32_bf16 v[8:11], v[148:151], a[112:115], v[8:11]
    v_xor_b32 v222, 0x10000, v222
    ds_read_b64_tr_b16 v[136:137], v222 offset:0
    v_mfma_f32_16x16x32_bf16 v[12:15], v[148:151], a[116:119], v[12:15]
    ds_read_b64_tr_b16 v[138:139], v222 offset:2048
    v_mfma_f32_16x16x32_bf16 v[104:107], v[148:151], a[120:123], v[104:107]
    v_xor_b32 v223, 0x10000, v223
    ds_read_b64_tr_b16 v[140:141], v223 offset:0
    v_mfma_f32_16x16x32_bf16 v[108:111], v[148:151], a[124:127], v[108:111]
    ds_read_b64_tr_b16 v[142:143], v223 offset:2048
    v_mfma_f32_16x16x32_bf16 v[16:19], v[152:155], a[112:115], v[16:19]
    buffer_load_dwordx4 a[104:107], v245, s[8:11], s35 offen offset:2048 sc1
    v_mfma_f32_16x16x32_bf16 v[20:23], v[152:155], a[116:119], v[20:23]
    v_xor_b32 v216, 0x10000, v216
    v_mfma_f32_16x16x32_bf16 v[112:115], v[152:155], a[120:123], v[112:115]
    v_xor_b32 v217, 0x10000, v217
    v_mfma_f32_16x16x32_bf16 v[116:119], v[152:155], a[124:127], v[116:119]
    v_xor_b32 v218, 0x10000, v218
    v_mfma_f32_16x16x32_bf16 v[24:27], v[156:159], a[112:115], v[24:27]
    v_xor_b32 v219, 0x10000, v219
    buffer_load_dwordx4 a[108:111], v246, s[8:11], s35 offen offset:2048 sc1
    v_mfma_f32_16x16x32_bf16 v[28:31], v[156:159], a[116:119], v[28:31]
    v_mfma_f32_16x16x32_bf16 v[120:123], v[156:159], a[120:123], v[120:123]
    v_mfma_f32_16x16x32_bf16 v[124:127], v[156:159], a[124:127], v[124:127]
    s_waitcnt vmcnt(35) lgkmcnt(4)
    v_mfma_f32_16x16x32_bf16 v[96:99], v[128:131], a[8:11], v[96:99]
    ds_read_b64_tr_b16 v[144:145], v220 offset:8192
    v_mfma_f32_16x16x32_bf16 v[100:103], v[128:131], a[12:15], v[100:103]
    ds_read_b64_tr_b16 v[146:147], v220 offset:10240
    v_mfma_f32_16x16x32_bf16 v[104:107], v[132:135], a[8:11], v[104:107]
    ds_read_b64_tr_b16 v[148:149], v221 offset:8192
    buffer_load_dwordx4 a[112:115], v226, s[8:11], s35 offen offset:3072 sc1
    v_mfma_f32_16x16x32_bf16 v[108:111], v[132:135], a[12:15], v[108:111]
    ds_read_b64_tr_b16 v[150:151], v221 offset:10240
    s_waitcnt lgkmcnt(4)
    v_mfma_f32_16x16x32_bf16 v[112:115], v[136:139], a[8:11], v[112:115]
    ds_read_b64_tr_b16 v[152:153], v222 offset:8192
    v_mfma_f32_16x16x32_bf16 v[116:119], v[136:139], a[12:15], v[116:119]
    ds_read_b64_tr_b16 v[154:155], v222 offset:10240
    v_mfma_f32_16x16x32_bf16 v[120:123], v[140:143], a[8:11], v[120:123]
    ds_read_b64_tr_b16 v[156:157], v223 offset:8192
    buffer_load_dwordx4 a[116:119], v227, s[8:11], s35 offen offset:3072 sc1
    v_mfma_f32_16x16x32_bf16 v[124:127], v[140:143], a[12:15], v[124:127]
    ds_read_b64_tr_b16 v[158:159], v223 offset:10240
    s_waitcnt vmcnt(31) lgkmcnt(4)
    v_mfma_f32_16x16x32_bf16 v[96:99], v[144:147], a[24:27], v[96:99]
    ds_read_b64_tr_b16 v[128:129], v220 offset:16384
    v_mfma_f32_16x16x32_bf16 v[100:103], v[144:147], a[28:31], v[100:103]
    ds_read_b64_tr_b16 v[130:131], v220 offset:18432
    v_mfma_f32_16x16x32_bf16 v[104:107], v[148:151], a[24:27], v[104:107]
    ds_read_b64_tr_b16 v[132:133], v221 offset:16384
    buffer_load_dwordx4 a[120:123], v245, s[8:11], s35 offen offset:3072 sc1
    v_mfma_f32_16x16x32_bf16 v[108:111], v[148:151], a[28:31], v[108:111]
    ds_read_b64_tr_b16 v[134:135], v221 offset:18432
    s_waitcnt lgkmcnt(4)
    v_mfma_f32_16x16x32_bf16 v[112:115], v[152:155], a[24:27], v[112:115]
    ds_read_b64_tr_b16 v[136:137], v222 offset:16384
    v_mfma_f32_16x16x32_bf16 v[116:119], v[152:155], a[28:31], v[116:119]
    ds_read_b64_tr_b16 v[138:139], v222 offset:18432
    v_mfma_f32_16x16x32_bf16 v[120:123], v[156:159], a[24:27], v[120:123]
    ds_read_b64_tr_b16 v[140:141], v223 offset:16384
    buffer_load_dwordx4 a[124:127], v246, s[8:11], s35 offen offset:3072 sc1
    v_mfma_f32_16x16x32_bf16 v[124:127], v[156:159], a[28:31], v[124:127]
    ds_read_b64_tr_b16 v[142:143], v223 offset:18432
    s_waitcnt vmcnt(26) lgkmcnt(4)
    v_mfma_f32_16x16x32_bf16 v[96:99], v[128:131], a[40:43], v[96:99]
    ds_read_b64_tr_b16 v[144:145], v220 offset:24576
    v_mfma_f32_16x16x32_bf16 v[100:103], v[128:131], a[44:47], v[100:103]
    ds_read_b64_tr_b16 v[146:147], v220 offset:26624
    v_mfma_f32_16x16x32_bf16 v[104:107], v[132:135], a[40:43], v[104:107]
    ds_read_b64_tr_b16 v[148:149], v221 offset:24576
    v_mfma_f32_16x16x32_bf16 v[108:111], v[132:135], a[44:47], v[108:111]
    ds_read_b64_tr_b16 v[150:151], v221 offset:26624
    s_waitcnt lgkmcnt(4)
    v_mfma_f32_16x16x32_bf16 v[112:115], v[136:139], a[40:43], v[112:115]
    ds_read_b64_tr_b16 v[152:153], v222 offset:24576
    v_mfma_f32_16x16x32_bf16 v[116:119], v[136:139], a[44:47], v[116:119]
    ds_read_b64_tr_b16 v[154:155], v222 offset:26624
    v_mfma_f32_16x16x32_bf16 v[120:123], v[140:143], a[40:43], v[120:123]
    ds_read_b64_tr_b16 v[156:157], v223 offset:24576
    v_mfma_f32_16x16x32_bf16 v[124:127], v[140:143], a[44:47], v[124:127]
    ds_read_b64_tr_b16 v[158:159], v223 offset:26624
    s_waitcnt vmcnt(20) lgkmcnt(4)
    v_mfma_f32_16x16x32_bf16 v[96:99], v[144:147], a[56:59], v[96:99]
    ds_read_b64_tr_b16 v[128:129], v220 offset:32768
    v_mfma_f32_16x16x32_bf16 v[100:103], v[144:147], a[60:63], v[100:103]
    ds_read_b64_tr_b16 v[130:131], v220 offset:34816
    v_mfma_f32_16x16x32_bf16 v[104:107], v[148:151], a[56:59], v[104:107]
    ds_read_b64_tr_b16 v[132:133], v221 offset:32768
    v_mfma_f32_16x16x32_bf16 v[108:111], v[148:151], a[60:63], v[108:111]
    ds_read_b64_tr_b16 v[134:135], v221 offset:34816
    s_waitcnt lgkmcnt(4)
    v_mfma_f32_16x16x32_bf16 v[112:115], v[152:155], a[56:59], v[112:115]
    ds_read_b64_tr_b16 v[136:137], v222 offset:32768
    v_mfma_f32_16x16x32_bf16 v[116:119], v[152:155], a[60:63], v[116:119]
    ds_read_b64_tr_b16 v[138:139], v222 offset:34816
    v_mfma_f32_16x16x32_bf16 v[120:123], v[156:159], a[56:59], v[120:123]
    ds_read_b64_tr_b16 v[140:141], v223 offset:32768
    v_mfma_f32_16x16x32_bf16 v[124:127], v[156:159], a[60:63], v[124:127]
    ds_read_b64_tr_b16 v[142:143], v223 offset:34816
    s_waitcnt vmcnt(14) lgkmcnt(4)
    v_mfma_f32_16x16x32_bf16 v[96:99], v[128:131], a[72:75], v[96:99]
    ds_read_b64_tr_b16 v[144:145], v220 offset:40960
    v_mfma_f32_16x16x32_bf16 v[100:103], v[128:131], a[76:79], v[100:103]
    ds_read_b64_tr_b16 v[146:147], v220 offset:43008
    s_xor_b32 s7, s39, 24
    v_mfma_f32_16x16x32_bf16 v[104:107], v[132:135], a[72:75], v[104:107]
    ds_read_b64_tr_b16 v[148:149], v221 offset:40960
    v_mfma_f32_16x16x32_bf16 v[108:111], v[132:135], a[76:79], v[108:111]
    ds_read_b64_tr_b16 v[150:151], v221 offset:43008
    s_waitcnt lgkmcnt(4)
    v_mfma_f32_16x16x32_bf16 v[112:115], v[136:139], a[72:75], v[112:115]
    ds_read_b64_tr_b16 v[152:153], v222 offset:40960
    v_mfma_f32_16x16x32_bf16 v[116:119], v[136:139], a[76:79], v[116:119]
    ds_read_b64_tr_b16 v[154:155], v222 offset:43008
    s_mul_i32 s7, s7, 12288
    v_mfma_f32_16x16x32_bf16 v[120:123], v[140:143], a[72:75], v[120:123]
    ds_read_b64_tr_b16 v[156:157], v223 offset:40960
    s_add_u32 s7, s7, 0x5002000
    v_mfma_f32_16x16x32_bf16 v[124:127], v[140:143], a[76:79], v[124:127]
    ds_read_b64_tr_b16 v[158:159], v223 offset:43008
    s_waitcnt vmcnt(8) lgkmcnt(4)
    v_mfma_f32_16x16x32_bf16 v[96:99], v[144:147], a[88:91], v[96:99]
    ds_read_b64_tr_b16 v[128:129], v220 offset:49152
    v_mfma_f32_16x16x32_bf16 v[100:103], v[144:147], a[92:95], v[100:103]
    ds_read_b64_tr_b16 v[130:131], v220 offset:51200
    s_xor_b32 s37, s39, 8
    v_mfma_f32_16x16x32_bf16 v[104:107], v[148:151], a[88:91], v[104:107]
    ds_read_b64_tr_b16 v[132:133], v221 offset:49152
    v_mfma_f32_16x16x32_bf16 v[108:111], v[148:151], a[92:95], v[108:111]
    ds_read_b64_tr_b16 v[134:135], v221 offset:51200
    s_waitcnt lgkmcnt(4)
    v_mfma_f32_16x16x32_bf16 v[112:115], v[152:155], a[88:91], v[112:115]
    ds_read_b64_tr_b16 v[136:137], v222 offset:49152
    v_mfma_f32_16x16x32_bf16 v[116:119], v[152:155], a[92:95], v[116:119]
    ds_read_b64_tr_b16 v[138:139], v222 offset:51200
    s_mul_i32 s37, s37, 12288
    v_mfma_f32_16x16x32_bf16 v[120:123], v[156:159], a[88:91], v[120:123]
    ds_read_b64_tr_b16 v[140:141], v223 offset:49152
    s_add_u32 s37, s37, 0x5000000
    v_mfma_f32_16x16x32_bf16 v[124:127], v[156:159], a[92:95], v[124:127]
    ds_read_b64_tr_b16 v[142:143], v223 offset:51200
    s_waitcnt vmcnt(4) lgkmcnt(4)
    v_mfma_f32_16x16x32_bf16 v[96:99], v[128:131], a[104:107], v[96:99]
    ds_read_b64_tr_b16 v[144:145], v220 offset:57344
    v_mfma_f32_16x16x32_bf16 v[100:103], v[128:131], a[108:111], v[100:103]
    ds_read_b64_tr_b16 v[146:147], v220 offset:59392
    s_xor_b32 s38, s39, 16
    v_mfma_f32_16x16x32_bf16 v[104:107], v[132:135], a[104:107], v[104:107]
    ds_read_b64_tr_b16 v[148:149], v221 offset:57344
    v_mfma_f32_16x16x32_bf16 v[108:111], v[132:135], a[108:111], v[108:111]
    ds_read_b64_tr_b16 v[150:151], v221 offset:59392
    s_waitcnt lgkmcnt(4)
    v_mfma_f32_16x16x32_bf16 v[112:115], v[136:139], a[104:107], v[112:115]
    ds_read_b64_tr_b16 v[152:153], v222 offset:57344
    v_mfma_f32_16x16x32_bf16 v[116:119], v[136:139], a[108:111], v[116:119]
    ds_read_b64_tr_b16 v[154:155], v222 offset:59392
    s_mul_i32 s38, s38, 12288
    v_mfma_f32_16x16x32_bf16 v[120:123], v[140:143], a[104:107], v[120:123]
    ds_read_b64_tr_b16 v[156:157], v223 offset:57344
    s_add_u32 s38, s38, 0x5001000
    v_mfma_f32_16x16x32_bf16 v[124:127], v[140:143], a[108:111], v[124:127]
    ds_read_b64_tr_b16 v[158:159], v223 offset:59392
    s_waitcnt vmcnt(0) lgkmcnt(4)
    v_mfma_f32_16x16x32_bf16 v[96:99], v[144:147], a[120:123], v[96:99]
    ds_read_b64_tr_b16 v[128:129], v220 offset:0
    v_mfma_f32_16x16x32_bf16 v[100:103], v[144:147], a[124:127], v[100:103]
    ds_read_b64_tr_b16 v[130:131], v220 offset:2048
    v_mfma_f32_16x16x32_bf16 v[104:107], v[148:151], a[120:123], v[104:107]
    ds_read_b64_tr_b16 v[132:133], v221 offset:0
    v_mfma_f32_16x16x32_bf16 v[108:111], v[148:151], a[124:127], v[108:111]
    ds_read_b64_tr_b16 v[134:135], v221 offset:2048
    s_waitcnt lgkmcnt(4)
    v_mfma_f32_16x16x32_bf16 v[112:115], v[152:155], a[120:123], v[112:115]
    ds_read_b64_tr_b16 v[136:137], v222 offset:0
    v_mfma_f32_16x16x32_bf16 v[116:119], v[152:155], a[124:127], v[116:119]
    ds_read_b64_tr_b16 v[138:139], v222 offset:2048
    v_mfma_f32_16x16x32_bf16 v[120:123], v[156:159], a[120:123], v[120:123]
    ds_read_b64_tr_b16 v[140:141], v223 offset:0
    v_mfma_f32_16x16x32_bf16 v[124:127], v[156:159], a[124:127], v[124:127]
    ds_read_b64_tr_b16 v[142:143], v223 offset:2048
    s_waitcnt lgkmcnt(4)
    v_mfma_f32_16x16x32_bf16 v[0:3], v[128:131], a[0:3], v[0:3]
    ds_read_b64_tr_b16 v[144:145], v220 offset:8192
    v_mfma_f32_16x16x32_bf16 v[4:7], v[128:131], a[4:7], v[4:7]
    ds_read_b64_tr_b16 v[146:147], v220 offset:10240
    v_mfma_f32_16x16x32_bf16 v[8:11], v[132:135], a[0:3], v[8:11]
    ds_read_b64_tr_b16 v[148:149], v221 offset:8192
    v_mfma_f32_16x16x32_bf16 v[12:15], v[132:135], a[4:7], v[12:15]
    ds_read_b64_tr_b16 v[150:151], v221 offset:10240
    s_waitcnt lgkmcnt(4)
    v_mfma_f32_16x16x32_bf16 v[16:19], v[136:139], a[0:3], v[16:19]
    ds_read_b64_tr_b16 v[152:153], v222 offset:8192
    v_mfma_f32_16x16x32_bf16 v[20:23], v[136:139], a[4:7], v[20:23]
    ds_read_b64_tr_b16 v[154:155], v222 offset:10240
    v_mfma_f32_16x16x32_bf16 v[24:27], v[140:143], a[0:3], v[24:27]
    ds_read_b64_tr_b16 v[156:157], v223 offset:8192
    v_mfma_f32_16x16x32_bf16 v[28:31], v[140:143], a[4:7], v[28:31]
    ds_read_b64_tr_b16 v[158:159], v223 offset:10240
    s_waitcnt lgkmcnt(4)
    v_mfma_f32_16x16x32_bf16 v[0:3], v[144:147], a[16:19], v[0:3]
    ds_read_b64_tr_b16 v[128:129], v220 offset:16384
    s_mul_i32 s33, s39, 12288
    s_add_u32 s33, s33, 0x5002000
    v_mfma_f32_16x16x32_bf16 v[4:7], v[144:147], a[20:23], v[4:7]
    ds_read_b64_tr_b16 v[130:131], v220 offset:18432
    v_mfma_f32_16x16x32_bf16 v[8:11], v[148:151], a[16:19], v[8:11]
    ds_read_b64_tr_b16 v[132:133], v221 offset:16384
    v_cvt_pk_bf16_f32 v96, v96, v97
    v_mfma_f32_16x16x32_bf16 v[12:15], v[148:151], a[20:23], v[12:15]
    ds_read_b64_tr_b16 v[134:135], v221 offset:18432
    v_cvt_pk_bf16_f32 v97, v98, v99
    s_waitcnt lgkmcnt(4)
    v_mfma_f32_16x16x32_bf16 v[16:19], v[152:155], a[16:19], v[16:19]
    ds_read_b64_tr_b16 v[136:137], v222 offset:16384
    v_cvt_pk_bf16_f32 v98, v100, v101
    v_mfma_f32_16x16x32_bf16 v[20:23], v[152:155], a[20:23], v[20:23]
    ds_read_b64_tr_b16 v[138:139], v222 offset:18432
    v_cvt_pk_bf16_f32 v99, v102, v103
    v_mfma_f32_16x16x32_bf16 v[24:27], v[156:159], a[16:19], v[24:27]
    ds_read_b64_tr_b16 v[140:141], v223 offset:16384
    v_min_u32 v96, -2, v96
    v_mfma_f32_16x16x32_bf16 v[28:31], v[156:159], a[20:23], v[28:31]
    ds_read_b64_tr_b16 v[142:143], v223 offset:18432
    v_min_u32 v97, -2, v97
    s_waitcnt lgkmcnt(4)
    v_mfma_f32_16x16x32_bf16 v[0:3], v[128:131], a[32:35], v[0:3]
    ds_read_b64_tr_b16 v[144:145], v220 offset:24576
    v_min_u32 v98, -2, v98
    v_mfma_f32_16x16x32_bf16 v[4:7], v[128:131], a[36:39], v[4:7]
    ds_read_b64_tr_b16 v[146:147], v220 offset:26624
    v_min_u32 v99, -2, v99
    v_mfma_f32_16x16x32_bf16 v[8:11], v[132:135], a[32:35], v[8:11]
    ds_read_b64_tr_b16 v[148:149], v221 offset:24576
    buffer_store_dwordx4 v[96:99], v228, s[8:11], s33 offen offset:0 sc1
    v_mfma_f32_16x16x32_bf16 v[12:15], v[132:135], a[36:39], v[12:15]
    ds_read_b64_tr_b16 v[150:151], v221 offset:26624
    s_waitcnt lgkmcnt(4)
    v_mfma_f32_16x16x32_bf16 v[16:19], v[136:139], a[32:35], v[16:19]
    ds_read_b64_tr_b16 v[152:153], v222 offset:24576
    v_mfma_f32_16x16x32_bf16 v[20:23], v[136:139], a[36:39], v[20:23]
    ds_read_b64_tr_b16 v[154:155], v222 offset:26624
    v_mfma_f32_16x16x32_bf16 v[24:27], v[140:143], a[32:35], v[24:27]
    ds_read_b64_tr_b16 v[156:157], v223 offset:24576
    v_cvt_pk_bf16_f32 v100, v104, v105
    v_mfma_f32_16x16x32_bf16 v[28:31], v[140:143], a[36:39], v[28:31]
    ds_read_b64_tr_b16 v[158:159], v223 offset:26624
    v_cvt_pk_bf16_f32 v101, v106, v107
    s_waitcnt lgkmcnt(4)
    v_mfma_f32_16x16x32_bf16 v[0:3], v[144:147], a[48:51], v[0:3]
    ds_read_b64_tr_b16 v[128:129], v220 offset:32768
    v_cvt_pk_bf16_f32 v102, v108, v109
    v_mfma_f32_16x16x32_bf16 v[4:7], v[144:147], a[52:55], v[4:7]
    ds_read_b64_tr_b16 v[130:131], v220 offset:34816
    v_cvt_pk_bf16_f32 v103, v110, v111
    v_mfma_f32_16x16x32_bf16 v[8:11], v[148:151], a[48:51], v[8:11]
    ds_read_b64_tr_b16 v[132:133], v221 offset:32768
    v_min_u32 v100, -2, v100
    v_mfma_f32_16x16x32_bf16 v[12:15], v[148:151], a[52:55], v[12:15]
    ds_read_b64_tr_b16 v[134:135], v221 offset:34816
    v_min_u32 v101, -2, v101
    s_waitcnt lgkmcnt(4)
    v_mfma_f32_16x16x32_bf16 v[16:19], v[152:155], a[48:51], v[16:19]
    ds_read_b64_tr_b16 v[136:137], v222 offset:32768
    v_min_u32 v102, -2, v102
    v_mfma_f32_16x16x32_bf16 v[20:23], v[152:155], a[52:55], v[20:23]
    ds_read_b64_tr_b16 v[138:139], v222 offset:34816
    v_min_u32 v103, -2, v103
    v_mfma_f32_16x16x32_bf16 v[24:27], v[156:159], a[48:51], v[24:27]
    ds_read_b64_tr_b16 v[140:141], v223 offset:32768
    buffer_store_dwordx4 v[100:103], v228, s[8:11], s33 offen offset:1024 sc1
    v_mfma_f32_16x16x32_bf16 v[28:31], v[156:159], a[52:55], v[28:31]
    ds_read_b64_tr_b16 v[142:143], v223 offset:34816
    s_waitcnt lgkmcnt(4)
    v_mfma_f32_16x16x32_bf16 v[0:3], v[128:131], a[64:67], v[0:3]
    ds_read_b64_tr_b16 v[144:145], v220 offset:40960
    v_mfma_f32_16x16x32_bf16 v[4:7], v[128:131], a[68:71], v[4:7]
    ds_read_b64_tr_b16 v[146:147], v220 offset:43008
    v_mfma_f32_16x16x32_bf16 v[8:11], v[132:135], a[64:67], v[8:11]
    ds_read_b64_tr_b16 v[148:149], v221 offset:40960
    v_cvt_pk_bf16_f32 v104, v112, v113
    v_mfma_f32_16x16x32_bf16 v[12:15], v[132:135], a[68:71], v[12:15]
    ds_read_b64_tr_b16 v[150:151], v221 offset:43008
    v_cvt_pk_bf16_f32 v105, v114, v115
    s_waitcnt lgkmcnt(4)
    v_mfma_f32_16x16x32_bf16 v[16:19], v[136:139], a[64:67], v[16:19]
    ds_read_b64_tr_b16 v[152:153], v222 offset:40960
    v_cvt_pk_bf16_f32 v106, v116, v117
    v_mfma_f32_16x16x32_bf16 v[20:23], v[136:139], a[68:71], v[20:23]
    ds_read_b64_tr_b16 v[154:155], v222 offset:43008
    v_cvt_pk_bf16_f32 v107, v118, v119
    v_mfma_f32_16x16x32_bf16 v[24:27], v[140:143], a[64:67], v[24:27]
    ds_read_b64_tr_b16 v[156:157], v223 offset:40960
    v_min_u32 v104, -2, v104
    v_mfma_f32_16x16x32_bf16 v[28:31], v[140:143], a[68:71], v[28:31]
    ds_read_b64_tr_b16 v[158:159], v223 offset:43008
    v_min_u32 v105, -2, v105
    s_waitcnt lgkmcnt(4)
    v_mfma_f32_16x16x32_bf16 v[0:3], v[144:147], a[80:83], v[0:3]
    ds_read_b64_tr_b16 v[128:129], v220 offset:49152
    v_min_u32 v106, -2, v106
    v_mfma_f32_16x16x32_bf16 v[4:7], v[144:147], a[84:87], v[4:7]
    ds_read_b64_tr_b16 v[130:131], v220 offset:51200
    v_min_u32 v107, -2, v107
    v_mfma_f32_16x16x32_bf16 v[8:11], v[148:151], a[80:83], v[8:11]
    ds_read_b64_tr_b16 v[132:133], v221 offset:49152
    buffer_store_dwordx4 v[104:107], v228, s[8:11], s33 offen offset:2048 sc1
    v_mfma_f32_16x16x32_bf16 v[12:15], v[148:151], a[84:87], v[12:15]
    ds_read_b64_tr_b16 v[134:135], v221 offset:51200
    s_waitcnt lgkmcnt(4)
    v_mfma_f32_16x16x32_bf16 v[16:19], v[152:155], a[80:83], v[16:19]
    ds_read_b64_tr_b16 v[136:137], v222 offset:49152
    v_mfma_f32_16x16x32_bf16 v[20:23], v[152:155], a[84:87], v[20:23]
    ds_read_b64_tr_b16 v[138:139], v222 offset:51200
    v_mfma_f32_16x16x32_bf16 v[24:27], v[156:159], a[80:83], v[24:27]
    ds_read_b64_tr_b16 v[140:141], v223 offset:49152
    v_cvt_pk_bf16_f32 v108, v120, v121
    v_mfma_f32_16x16x32_bf16 v[28:31], v[156:159], a[84:87], v[28:31]
    ds_read_b64_tr_b16 v[142:143], v223 offset:51200
    v_cvt_pk_bf16_f32 v109, v122, v123
    s_waitcnt lgkmcnt(4)
    v_mfma_f32_16x16x32_bf16 v[0:3], v[128:131], a[96:99], v[0:3]
    ds_read_b64_tr_b16 v[144:145], v220 offset:57344
    v_cvt_pk_bf16_f32 v110, v124, v125
    v_mfma_f32_16x16x32_bf16 v[4:7], v[128:131], a[100:103], v[4:7]
    ds_read_b64_tr_b16 v[146:147], v220 offset:59392
    v_cvt_pk_bf16_f32 v111, v126, v127
    v_mfma_f32_16x16x32_bf16 v[8:11], v[132:135], a[96:99], v[8:11]
    ds_read_b64_tr_b16 v[148:149], v221 offset:57344
    v_min_u32 v108, -2, v108
    v_mfma_f32_16x16x32_bf16 v[12:15], v[132:135], a[100:103], v[12:15]
    ds_read_b64_tr_b16 v[150:151], v221 offset:59392
    v_min_u32 v109, -2, v109
    s_waitcnt lgkmcnt(4)
    v_mfma_f32_16x16x32_bf16 v[16:19], v[136:139], a[96:99], v[16:19]
    ds_read_b64_tr_b16 v[152:153], v222 offset:57344
    v_min_u32 v110, -2, v110
    v_mfma_f32_16x16x32_bf16 v[20:23], v[136:139], a[100:103], v[20:23]
    ds_read_b64_tr_b16 v[154:155], v222 offset:59392
    v_min_u32 v111, -2, v111
    v_mfma_f32_16x16x32_bf16 v[24:27], v[140:143], a[96:99], v[24:27]
    ds_read_b64_tr_b16 v[156:157], v223 offset:57344
    buffer_store_dwordx4 v[108:111], v228, s[8:11], s33 offen offset:3072 sc1
    v_mfma_f32_16x16x32_bf16 v[28:31], v[140:143], a[100:103], v[28:31]
    ds_read_b64_tr_b16 v[158:159], v223 offset:59392
    s_waitcnt lgkmcnt(4)
    v_mfma_f32_16x16x32_bf16 v[0:3], v[144:147], a[112:115], v[0:3]
    ds_read_b64_tr_b16 v[128:129], v216 offset:0
    v_mfma_f32_16x16x32_bf16 v[4:7], v[144:147], a[116:119], v[4:7]
    ds_read_b64_tr_b16 v[130:131], v216 offset:2048
    v_mfma_f32_16x16x32_bf16 v[8:11], v[148:151], a[112:115], v[8:11]
    ds_read_b64_tr_b16 v[132:133], v217 offset:0
    v_mfma_f32_16x16x32_bf16 v[12:15], v[148:151], a[116:119], v[12:15]
    ds_read_b64_tr_b16 v[134:135], v217 offset:2048
    s_waitcnt lgkmcnt(4)
    v_mfma_f32_16x16x32_bf16 v[16:19], v[152:155], a[112:115], v[16:19]
    ds_read_b64_tr_b16 v[136:137], v218 offset:0
    v_mfma_f32_16x16x32_bf16 v[20:23], v[152:155], a[116:119], v[20:23]
    ds_read_b64_tr_b16 v[138:139], v218 offset:2048
    v_mfma_f32_16x16x32_bf16 v[24:27], v[156:159], a[112:115], v[24:27]
    ds_read_b64_tr_b16 v[140:141], v219 offset:0
    v_mfma_f32_16x16x32_bf16 v[28:31], v[156:159], a[116:119], v[28:31]
    ds_read_b64_tr_b16 v[142:143], v219 offset:2048
    s_waitcnt lgkmcnt(4)
    v_mfma_f32_16x16x32_bf16 v[64:67], v[128:131], a[8:11], v[64:67]
    ds_read_b64_tr_b16 v[144:145], v216 offset:8192
    v_mfma_f32_16x16x32_bf16 v[68:71], v[128:131], a[12:15], v[68:71]
    ds_read_b64_tr_b16 v[146:147], v216 offset:10240
    v_mfma_f32_16x16x32_bf16 v[72:75], v[132:135], a[8:11], v[72:75]
    ds_read_b64_tr_b16 v[148:149], v217 offset:8192
    v_mfma_f32_16x16x32_bf16 v[76:79], v[132:135], a[12:15], v[76:79]
    ds_read_b64_tr_b16 v[150:151], v217 offset:10240
    s_waitcnt lgkmcnt(4)
    v_mfma_f32_16x16x32_bf16 v[80:83], v[136:139], a[8:11], v[80:83]
    ds_read_b64_tr_b16 v[152:153], v218 offset:8192
    v_mfma_f32_16x16x32_bf16 v[84:87], v[136:139], a[12:15], v[84:87]
    ds_read_b64_tr_b16 v[154:155], v218 offset:10240
    v_mfma_f32_16x16x32_bf16 v[88:91], v[140:143], a[8:11], v[88:91]
    ds_read_b64_tr_b16 v[156:157], v219 offset:8192
    v_mfma_f32_16x16x32_bf16 v[92:95], v[140:143], a[12:15], v[92:95]
    ds_read_b64_tr_b16 v[158:159], v219 offset:10240
    s_waitcnt lgkmcnt(4)
    v_mfma_f32_16x16x32_bf16 v[64:67], v[144:147], a[24:27], v[64:67]
    ds_read_b64_tr_b16 v[128:129], v216 offset:16384
    s_mul_i32 s33, s39, 12288
    s_add_u32 s33, s33, 0x5000000
    v_mfma_f32_16x16x32_bf16 v[68:71], v[144:147], a[28:31], v[68:71]
    ds_read_b64_tr_b16 v[130:131], v216 offset:18432
    v_mfma_f32_16x16x32_bf16 v[72:75], v[148:151], a[24:27], v[72:75]
    ds_read_b64_tr_b16 v[132:133], v217 offset:16384
    v_cvt_pk_bf16_f32 v0, v0, v1
    v_mfma_f32_16x16x32_bf16 v[76:79], v[148:151], a[28:31], v[76:79]
    ds_read_b64_tr_b16 v[134:135], v217 offset:18432
    v_cvt_pk_bf16_f32 v1, v2, v3
    s_waitcnt lgkmcnt(4)
    v_mfma_f32_16x16x32_bf16 v[80:83], v[152:155], a[24:27], v[80:83]
    ds_read_b64_tr_b16 v[136:137], v218 offset:16384
    v_cvt_pk_bf16_f32 v2, v4, v5
    v_mfma_f32_16x16x32_bf16 v[84:87], v[152:155], a[28:31], v[84:87]
    ds_read_b64_tr_b16 v[138:139], v218 offset:18432
    v_cvt_pk_bf16_f32 v3, v6, v7
    v_mfma_f32_16x16x32_bf16 v[88:91], v[156:159], a[24:27], v[88:91]
    ds_read_b64_tr_b16 v[140:141], v219 offset:16384
    v_min_u32 v0, -2, v0
    v_mfma_f32_16x16x32_bf16 v[92:95], v[156:159], a[28:31], v[92:95]
    ds_read_b64_tr_b16 v[142:143], v219 offset:18432
    v_min_u32 v1, -2, v1
    s_waitcnt lgkmcnt(4)
    v_mfma_f32_16x16x32_bf16 v[64:67], v[128:131], a[40:43], v[64:67]
    ds_read_b64_tr_b16 v[144:145], v216 offset:24576
    v_min_u32 v2, -2, v2
    v_mfma_f32_16x16x32_bf16 v[68:71], v[128:131], a[44:47], v[68:71]
    ds_read_b64_tr_b16 v[146:147], v216 offset:26624
    v_min_u32 v3, -2, v3
    v_mfma_f32_16x16x32_bf16 v[72:75], v[132:135], a[40:43], v[72:75]
    ds_read_b64_tr_b16 v[148:149], v217 offset:24576
    buffer_store_dwordx4 v[0:3], v228, s[8:11], s33 offen offset:0 sc1
    v_mfma_f32_16x16x32_bf16 v[76:79], v[132:135], a[44:47], v[76:79]
    ds_read_b64_tr_b16 v[150:151], v217 offset:26624
    s_waitcnt lgkmcnt(4)
    v_mfma_f32_16x16x32_bf16 v[80:83], v[136:139], a[40:43], v[80:83]
    ds_read_b64_tr_b16 v[152:153], v218 offset:24576
    v_mfma_f32_16x16x32_bf16 v[84:87], v[136:139], a[44:47], v[84:87]
    ds_read_b64_tr_b16 v[154:155], v218 offset:26624
    v_mfma_f32_16x16x32_bf16 v[88:91], v[140:143], a[40:43], v[88:91]
    ds_read_b64_tr_b16 v[156:157], v219 offset:24576
    v_cvt_pk_bf16_f32 v4, v8, v9
    v_mfma_f32_16x16x32_bf16 v[92:95], v[140:143], a[44:47], v[92:95]
    ds_read_b64_tr_b16 v[158:159], v219 offset:26624
    v_cvt_pk_bf16_f32 v5, v10, v11
    s_waitcnt lgkmcnt(4)
    v_mfma_f32_16x16x32_bf16 v[64:67], v[144:147], a[56:59], v[64:67]
    ds_read_b64_tr_b16 v[128:129], v216 offset:32768
    v_cvt_pk_bf16_f32 v6, v12, v13
    v_mfma_f32_16x16x32_bf16 v[68:71], v[144:147], a[60:63], v[68:71]
    ds_read_b64_tr_b16 v[130:131], v216 offset:34816
    v_cvt_pk_bf16_f32 v7, v14, v15
    v_mfma_f32_16x16x32_bf16 v[72:75], v[148:151], a[56:59], v[72:75]
    ds_read_b64_tr_b16 v[132:133], v217 offset:32768
    v_min_u32 v4, -2, v4
    v_mfma_f32_16x16x32_bf16 v[76:79], v[148:151], a[60:63], v[76:79]
    ds_read_b64_tr_b16 v[134:135], v217 offset:34816
    v_min_u32 v5, -2, v5
    s_waitcnt lgkmcnt(4)
    v_mfma_f32_16x16x32_bf16 v[80:83], v[152:155], a[56:59], v[80:83]
    ds_read_b64_tr_b16 v[136:137], v218 offset:32768
    v_min_u32 v6, -2, v6
    v_mfma_f32_16x16x32_bf16 v[84:87], v[152:155], a[60:63], v[84:87]
    ds_read_b64_tr_b16 v[138:139], v218 offset:34816
    v_min_u32 v7, -2, v7
    v_mfma_f32_16x16x32_bf16 v[88:91], v[156:159], a[56:59], v[88:91]
    ds_read_b64_tr_b16 v[140:141], v219 offset:32768
    buffer_store_dwordx4 v[4:7], v228, s[8:11], s33 offen offset:1024 sc1
    v_mfma_f32_16x16x32_bf16 v[92:95], v[156:159], a[60:63], v[92:95]
    ds_read_b64_tr_b16 v[142:143], v219 offset:34816
    s_waitcnt lgkmcnt(4)
    v_mfma_f32_16x16x32_bf16 v[64:67], v[128:131], a[72:75], v[64:67]
    ds_read_b64_tr_b16 v[144:145], v216 offset:40960
    v_mfma_f32_16x16x32_bf16 v[68:71], v[128:131], a[76:79], v[68:71]
    ds_read_b64_tr_b16 v[146:147], v216 offset:43008
    v_mfma_f32_16x16x32_bf16 v[72:75], v[132:135], a[72:75], v[72:75]
    ds_read_b64_tr_b16 v[148:149], v217 offset:40960
    v_cvt_pk_bf16_f32 v8, v16, v17
    v_mfma_f32_16x16x32_bf16 v[76:79], v[132:135], a[76:79], v[76:79]
    ds_read_b64_tr_b16 v[150:151], v217 offset:43008
    v_cvt_pk_bf16_f32 v9, v18, v19
    s_waitcnt lgkmcnt(4)
    v_mfma_f32_16x16x32_bf16 v[80:83], v[136:139], a[72:75], v[80:83]
    ds_read_b64_tr_b16 v[152:153], v218 offset:40960
    v_cvt_pk_bf16_f32 v10, v20, v21
    v_mfma_f32_16x16x32_bf16 v[84:87], v[136:139], a[76:79], v[84:87]
    ds_read_b64_tr_b16 v[154:155], v218 offset:43008
    v_cvt_pk_bf16_f32 v11, v22, v23
    v_mfma_f32_16x16x32_bf16 v[88:91], v[140:143], a[72:75], v[88:91]
    ds_read_b64_tr_b16 v[156:157], v219 offset:40960
    v_min_u32 v8, -2, v8
    v_mfma_f32_16x16x32_bf16 v[92:95], v[140:143], a[76:79], v[92:95]
    ds_read_b64_tr_b16 v[158:159], v219 offset:43008
    v_min_u32 v9, -2, v9
    s_waitcnt lgkmcnt(4)
    v_mfma_f32_16x16x32_bf16 v[64:67], v[144:147], a[88:91], v[64:67]
    ds_read_b64_tr_b16 v[128:129], v216 offset:49152
    v_min_u32 v10, -2, v10
    v_mfma_f32_16x16x32_bf16 v[68:71], v[144:147], a[92:95], v[68:71]
    ds_read_b64_tr_b16 v[130:131], v216 offset:51200
    v_min_u32 v11, -2, v11
    v_mfma_f32_16x16x32_bf16 v[72:75], v[148:151], a[88:91], v[72:75]
    ds_read_b64_tr_b16 v[132:133], v217 offset:49152
    buffer_store_dwordx4 v[8:11], v228, s[8:11], s33 offen offset:2048 sc1
    v_mfma_f32_16x16x32_bf16 v[76:79], v[148:151], a[92:95], v[76:79]
    ds_read_b64_tr_b16 v[134:135], v217 offset:51200
    s_waitcnt lgkmcnt(4)
    v_mfma_f32_16x16x32_bf16 v[80:83], v[152:155], a[88:91], v[80:83]
    ds_read_b64_tr_b16 v[136:137], v218 offset:49152
    v_mfma_f32_16x16x32_bf16 v[84:87], v[152:155], a[92:95], v[84:87]
    ds_read_b64_tr_b16 v[138:139], v218 offset:51200
    v_mfma_f32_16x16x32_bf16 v[88:91], v[156:159], a[88:91], v[88:91]
    ds_read_b64_tr_b16 v[140:141], v219 offset:49152
    v_cvt_pk_bf16_f32 v12, v24, v25
    v_mfma_f32_16x16x32_bf16 v[92:95], v[156:159], a[92:95], v[92:95]
    ds_read_b64_tr_b16 v[142:143], v219 offset:51200
    v_cvt_pk_bf16_f32 v13, v26, v27
    s_waitcnt lgkmcnt(4)
    v_mfma_f32_16x16x32_bf16 v[64:67], v[128:131], a[104:107], v[64:67]
    ds_read_b64_tr_b16 v[144:145], v216 offset:57344
    v_cvt_pk_bf16_f32 v14, v28, v29
    v_mfma_f32_16x16x32_bf16 v[68:71], v[128:131], a[108:111], v[68:71]
    ds_read_b64_tr_b16 v[146:147], v216 offset:59392
    v_cvt_pk_bf16_f32 v15, v30, v31
    v_mfma_f32_16x16x32_bf16 v[72:75], v[132:135], a[104:107], v[72:75]
    ds_read_b64_tr_b16 v[148:149], v217 offset:57344
    v_min_u32 v12, -2, v12
    v_mfma_f32_16x16x32_bf16 v[76:79], v[132:135], a[108:111], v[76:79]
    ds_read_b64_tr_b16 v[150:151], v217 offset:59392
    v_min_u32 v13, -2, v13
    s_waitcnt lgkmcnt(4)
    v_mfma_f32_16x16x32_bf16 v[80:83], v[136:139], a[104:107], v[80:83]
    ds_read_b64_tr_b16 v[152:153], v218 offset:57344
    v_min_u32 v14, -2, v14
    v_mfma_f32_16x16x32_bf16 v[84:87], v[136:139], a[108:111], v[84:87]
    ds_read_b64_tr_b16 v[154:155], v218 offset:59392
    v_min_u32 v15, -2, v15
    v_mfma_f32_16x16x32_bf16 v[88:91], v[140:143], a[104:107], v[88:91]
    ds_read_b64_tr_b16 v[156:157], v219 offset:57344
    buffer_store_dwordx4 v[12:15], v228, s[8:11], s33 offen offset:3072 sc1
    v_mfma_f32_16x16x32_bf16 v[92:95], v[140:143], a[108:111], v[92:95]
    ds_read_b64_tr_b16 v[158:159], v219 offset:59392
    s_waitcnt lgkmcnt(4)
    v_mfma_f32_16x16x32_bf16 v[64:67], v[144:147], a[120:123], v[64:67]
    ds_read_b64_tr_b16 v[128:129], v216 offset:0
    v_mfma_f32_16x16x32_bf16 v[68:71], v[144:147], a[124:127], v[68:71]
    ds_read_b64_tr_b16 v[130:131], v216 offset:2048
    v_mfma_f32_16x16x32_bf16 v[72:75], v[148:151], a[120:123], v[72:75]
    ds_read_b64_tr_b16 v[132:133], v217 offset:0
    v_mfma_f32_16x16x32_bf16 v[76:79], v[148:151], a[124:127], v[76:79]
    ds_read_b64_tr_b16 v[134:135], v217 offset:2048
    s_waitcnt lgkmcnt(4)
    v_mfma_f32_16x16x32_bf16 v[80:83], v[152:155], a[120:123], v[80:83]
    ds_read_b64_tr_b16 v[136:137], v218 offset:0
    v_mfma_f32_16x16x32_bf16 v[84:87], v[152:155], a[124:127], v[84:87]
    ds_read_b64_tr_b16 v[138:139], v218 offset:2048
    v_mfma_f32_16x16x32_bf16 v[88:91], v[156:159], a[120:123], v[88:91]
    ds_read_b64_tr_b16 v[140:141], v219 offset:0
    v_mfma_f32_16x16x32_bf16 v[92:95], v[156:159], a[124:127], v[92:95]
    ds_read_b64_tr_b16 v[142:143], v219 offset:2048
    s_waitcnt lgkmcnt(4)
    v_mfma_f32_16x16x32_bf16 v[32:35], v[128:131], a[0:3], v[32:35]
    ds_read_b64_tr_b16 v[144:145], v216 offset:8192
    v_mfma_f32_16x16x32_bf16 v[36:39], v[128:131], a[4:7], v[36:39]
    ds_read_b64_tr_b16 v[146:147], v216 offset:10240
    buffer_load_dwordx4 v[176:179], v228, s[8:11], s7 offen offset:0 sc1
    v_mfma_f32_16x16x32_bf16 v[40:43], v[132:135], a[0:3], v[40:43]
    ds_read_b64_tr_b16 v[148:149], v217 offset:8192
    v_mfma_f32_16x16x32_bf16 v[44:47], v[132:135], a[4:7], v[44:47]
    ds_read_b64_tr_b16 v[150:151], v217 offset:10240
    buffer_load_dwordx4 v[180:183], v228, s[8:11], s7 offen offset:1024 sc1
    s_waitcnt lgkmcnt(4)
    v_mfma_f32_16x16x32_bf16 v[48:51], v[136:139], a[0:3], v[48:51]
    ds_read_b64_tr_b16 v[152:153], v218 offset:8192
    v_mfma_f32_16x16x32_bf16 v[52:55], v[136:139], a[4:7], v[52:55]
    ds_read_b64_tr_b16 v[154:155], v218 offset:10240
    buffer_load_dwordx4 v[184:187], v228, s[8:11], s7 offen offset:2048 sc1
    v_mfma_f32_16x16x32_bf16 v[56:59], v[140:143], a[0:3], v[56:59]
    ds_read_b64_tr_b16 v[156:157], v219 offset:8192
    v_mfma_f32_16x16x32_bf16 v[60:63], v[140:143], a[4:7], v[60:63]
    ds_read_b64_tr_b16 v[158:159], v219 offset:10240
    buffer_load_dwordx4 v[188:191], v228, s[8:11], s7 offen offset:3072 sc1
    s_waitcnt lgkmcnt(4)
    v_mfma_f32_16x16x32_bf16 v[32:35], v[144:147], a[16:19], v[32:35]
    ds_read_b64_tr_b16 v[128:129], v216 offset:16384
    s_mul_i32 s33, s39, 12288
    s_add_u32 s33, s33, 0x5001000
    v_mfma_f32_16x16x32_bf16 v[36:39], v[144:147], a[20:23], v[36:39]
    ds_read_b64_tr_b16 v[130:131], v216 offset:18432
    v_mfma_f32_16x16x32_bf16 v[40:43], v[148:151], a[16:19], v[40:43]
    ds_read_b64_tr_b16 v[132:133], v217 offset:16384
    v_cvt_pk_bf16_f32 v64, v64, v65
    v_mfma_f32_16x16x32_bf16 v[44:47], v[148:151], a[20:23], v[44:47]
    ds_read_b64_tr_b16 v[134:135], v217 offset:18432
    v_cvt_pk_bf16_f32 v65, v66, v67
    s_waitcnt lgkmcnt(4)
    v_mfma_f32_16x16x32_bf16 v[48:51], v[152:155], a[16:19], v[48:51]
    ds_read_b64_tr_b16 v[136:137], v218 offset:16384
    v_cvt_pk_bf16_f32 v66, v68, v69
    v_mfma_f32_16x16x32_bf16 v[52:55], v[152:155], a[20:23], v[52:55]
    ds_read_b64_tr_b16 v[138:139], v218 offset:18432
    v_cvt_pk_bf16_f32 v67, v70, v71
    v_mfma_f32_16x16x32_bf16 v[56:59], v[156:159], a[16:19], v[56:59]
    ds_read_b64_tr_b16 v[140:141], v219 offset:16384
    v_min_u32 v64, -2, v64
    v_mfma_f32_16x16x32_bf16 v[60:63], v[156:159], a[20:23], v[60:63]
    ds_read_b64_tr_b16 v[142:143], v219 offset:18432
    v_min_u32 v65, -2, v65
    s_waitcnt lgkmcnt(4)
    v_mfma_f32_16x16x32_bf16 v[32:35], v[128:131], a[32:35], v[32:35]
    ds_read_b64_tr_b16 v[144:145], v216 offset:24576
    v_min_u32 v66, -2, v66
    v_mfma_f32_16x16x32_bf16 v[36:39], v[128:131], a[36:39], v[36:39]
    ds_read_b64_tr_b16 v[146:147], v216 offset:26624
    v_min_u32 v67, -2, v67
    v_mfma_f32_16x16x32_bf16 v[40:43], v[132:135], a[32:35], v[40:43]
    ds_read_b64_tr_b16 v[148:149], v217 offset:24576
    buffer_store_dwordx4 v[64:67], v228, s[8:11], s33 offen offset:0 sc1
    v_mfma_f32_16x16x32_bf16 v[44:47], v[132:135], a[36:39], v[44:47]
    ds_read_b64_tr_b16 v[150:151], v217 offset:26624
    s_waitcnt lgkmcnt(4)
    v_mfma_f32_16x16x32_bf16 v[48:51], v[136:139], a[32:35], v[48:51]
    ds_read_b64_tr_b16 v[152:153], v218 offset:24576
    v_mfma_f32_16x16x32_bf16 v[52:55], v[136:139], a[36:39], v[52:55]
    ds_read_b64_tr_b16 v[154:155], v218 offset:26624
    v_mfma_f32_16x16x32_bf16 v[56:59], v[140:143], a[32:35], v[56:59]
    ds_read_b64_tr_b16 v[156:157], v219 offset:24576
    v_cvt_pk_bf16_f32 v68, v72, v73
    v_mfma_f32_16x16x32_bf16 v[60:63], v[140:143], a[36:39], v[60:63]
    ds_read_b64_tr_b16 v[158:159], v219 offset:26624
    v_cvt_pk_bf16_f32 v69, v74, v75
    s_waitcnt lgkmcnt(4)
    v_mfma_f32_16x16x32_bf16 v[32:35], v[144:147], a[48:51], v[32:35]
    ds_read_b64_tr_b16 v[128:129], v216 offset:32768
    v_cvt_pk_bf16_f32 v70, v76, v77
    v_mfma_f32_16x16x32_bf16 v[36:39], v[144:147], a[52:55], v[36:39]
    ds_read_b64_tr_b16 v[130:131], v216 offset:34816
    v_cvt_pk_bf16_f32 v71, v78, v79
    v_mfma_f32_16x16x32_bf16 v[40:43], v[148:151], a[48:51], v[40:43]
    ds_read_b64_tr_b16 v[132:133], v217 offset:32768
    v_min_u32 v68, -2, v68
    v_mfma_f32_16x16x32_bf16 v[44:47], v[148:151], a[52:55], v[44:47]
    ds_read_b64_tr_b16 v[134:135], v217 offset:34816
    v_min_u32 v69, -2, v69
    s_waitcnt lgkmcnt(4)
    v_mfma_f32_16x16x32_bf16 v[48:51], v[152:155], a[48:51], v[48:51]
    ds_read_b64_tr_b16 v[136:137], v218 offset:32768
    v_min_u32 v70, -2, v70
    v_mfma_f32_16x16x32_bf16 v[52:55], v[152:155], a[52:55], v[52:55]
    ds_read_b64_tr_b16 v[138:139], v218 offset:34816
    v_min_u32 v71, -2, v71
    v_mfma_f32_16x16x32_bf16 v[56:59], v[156:159], a[48:51], v[56:59]
    ds_read_b64_tr_b16 v[140:141], v219 offset:32768
    buffer_store_dwordx4 v[68:71], v228, s[8:11], s33 offen offset:1024 sc1
    v_mfma_f32_16x16x32_bf16 v[60:63], v[156:159], a[52:55], v[60:63]
    ds_read_b64_tr_b16 v[142:143], v219 offset:34816
    s_waitcnt lgkmcnt(4)
    v_mfma_f32_16x16x32_bf16 v[32:35], v[128:131], a[64:67], v[32:35]
    ds_read_b64_tr_b16 v[144:145], v216 offset:40960
    v_mfma_f32_16x16x32_bf16 v[36:39], v[128:131], a[68:71], v[36:39]
    ds_read_b64_tr_b16 v[146:147], v216 offset:43008
    v_mfma_f32_16x16x32_bf16 v[40:43], v[132:135], a[64:67], v[40:43]
    ds_read_b64_tr_b16 v[148:149], v217 offset:40960
    v_cvt_pk_bf16_f32 v72, v80, v81
    v_mfma_f32_16x16x32_bf16 v[44:47], v[132:135], a[68:71], v[44:47]
    ds_read_b64_tr_b16 v[150:151], v217 offset:43008
    v_cvt_pk_bf16_f32 v73, v82, v83
    s_waitcnt lgkmcnt(4)
    v_mfma_f32_16x16x32_bf16 v[48:51], v[136:139], a[64:67], v[48:51]
    ds_read_b64_tr_b16 v[152:153], v218 offset:40960
    v_cvt_pk_bf16_f32 v74, v84, v85
    v_mfma_f32_16x16x32_bf16 v[52:55], v[136:139], a[68:71], v[52:55]
    ds_read_b64_tr_b16 v[154:155], v218 offset:43008
    v_cvt_pk_bf16_f32 v75, v86, v87
    v_mfma_f32_16x16x32_bf16 v[56:59], v[140:143], a[64:67], v[56:59]
    ds_read_b64_tr_b16 v[156:157], v219 offset:40960
    v_min_u32 v72, -2, v72
    v_mfma_f32_16x16x32_bf16 v[60:63], v[140:143], a[68:71], v[60:63]
    ds_read_b64_tr_b16 v[158:159], v219 offset:43008
    v_min_u32 v73, -2, v73
    s_waitcnt lgkmcnt(4)
    v_mfma_f32_16x16x32_bf16 v[32:35], v[144:147], a[80:83], v[32:35]
    ds_read_b64_tr_b16 v[128:129], v216 offset:49152
    v_min_u32 v74, -2, v74
    v_mfma_f32_16x16x32_bf16 v[36:39], v[144:147], a[84:87], v[36:39]
    ds_read_b64_tr_b16 v[130:131], v216 offset:51200
    v_min_u32 v75, -2, v75
    v_mfma_f32_16x16x32_bf16 v[40:43], v[148:151], a[80:83], v[40:43]
    ds_read_b64_tr_b16 v[132:133], v217 offset:49152
    buffer_store_dwordx4 v[72:75], v228, s[8:11], s33 offen offset:2048 sc1
    v_mfma_f32_16x16x32_bf16 v[44:47], v[148:151], a[84:87], v[44:47]
    ds_read_b64_tr_b16 v[134:135], v217 offset:51200
    s_waitcnt lgkmcnt(4)
    v_mfma_f32_16x16x32_bf16 v[48:51], v[152:155], a[80:83], v[48:51]
    ds_read_b64_tr_b16 v[136:137], v218 offset:49152
    v_mfma_f32_16x16x32_bf16 v[52:55], v[152:155], a[84:87], v[52:55]
    ds_read_b64_tr_b16 v[138:139], v218 offset:51200
    v_mfma_f32_16x16x32_bf16 v[56:59], v[156:159], a[80:83], v[56:59]
    ds_read_b64_tr_b16 v[140:141], v219 offset:49152
    v_cvt_pk_bf16_f32 v76, v88, v89
    v_mfma_f32_16x16x32_bf16 v[60:63], v[156:159], a[84:87], v[60:63]
    ds_read_b64_tr_b16 v[142:143], v219 offset:51200
    v_cvt_pk_bf16_f32 v77, v90, v91
    s_waitcnt lgkmcnt(4)
    v_mfma_f32_16x16x32_bf16 v[32:35], v[128:131], a[96:99], v[32:35]
    ds_read_b64_tr_b16 v[144:145], v216 offset:57344
    v_cvt_pk_bf16_f32 v78, v92, v93
    v_mfma_f32_16x16x32_bf16 v[36:39], v[128:131], a[100:103], v[36:39]
    ds_read_b64_tr_b16 v[146:147], v216 offset:59392
    v_cvt_pk_bf16_f32 v79, v94, v95
    v_mfma_f32_16x16x32_bf16 v[40:43], v[132:135], a[96:99], v[40:43]
    ds_read_b64_tr_b16 v[148:149], v217 offset:57344
    v_min_u32 v76, -2, v76
    v_mfma_f32_16x16x32_bf16 v[44:47], v[132:135], a[100:103], v[44:47]
    ds_read_b64_tr_b16 v[150:151], v217 offset:59392
    v_min_u32 v77, -2, v77
    s_waitcnt lgkmcnt(4)
    v_mfma_f32_16x16x32_bf16 v[48:51], v[136:139], a[96:99], v[48:51]
    ds_read_b64_tr_b16 v[152:153], v218 offset:57344
    v_min_u32 v78, -2, v78
    v_mfma_f32_16x16x32_bf16 v[52:55], v[136:139], a[100:103], v[52:55]
    ds_read_b64_tr_b16 v[154:155], v218 offset:59392
    v_min_u32 v79, -2, v79
    v_mfma_f32_16x16x32_bf16 v[56:59], v[140:143], a[96:99], v[56:59]
    ds_read_b64_tr_b16 v[156:157], v219 offset:57344
    buffer_store_dwordx4 v[76:79], v228, s[8:11], s33 offen offset:3072 sc1
    v_mfma_f32_16x16x32_bf16 v[60:63], v[140:143], a[100:103], v[60:63]
    ds_read_b64_tr_b16 v[158:159], v219 offset:59392
    s_waitcnt lgkmcnt(4)
    v_mfma_f32_16x16x32_bf16 v[32:35], v[144:147], a[112:115], v[32:35]
    buffer_load_dwordx4 v[96:99], v228, s[8:11], s37 offen offset:0 sc1
    v_mfma_f32_16x16x32_bf16 v[36:39], v[144:147], a[116:119], v[36:39]
    v_mfma_f32_16x16x32_bf16 v[40:43], v[148:151], a[112:115], v[40:43]
    buffer_load_dwordx4 v[100:103], v228, s[8:11], s37 offen offset:1024 sc1
    v_mfma_f32_16x16x32_bf16 v[44:47], v[148:151], a[116:119], v[44:47]
    s_waitcnt lgkmcnt(0)
    v_mfma_f32_16x16x32_bf16 v[48:51], v[152:155], a[112:115], v[48:51]
    buffer_load_dwordx4 v[104:107], v228, s[8:11], s37 offen offset:2048 sc1
    v_mfma_f32_16x16x32_bf16 v[52:55], v[152:155], a[116:119], v[52:55]
    v_mfma_f32_16x16x32_bf16 v[56:59], v[156:159], a[112:115], v[56:59]
    buffer_load_dwordx4 v[108:111], v228, s[8:11], s37 offen offset:3072 sc1
    v_mfma_f32_16x16x32_bf16 v[60:63], v[156:159], a[116:119], v[60:63]
kc_tail:
    buffer_load_dwordx4 v[160:163], v228, s[8:11], s38 offen offset:0 sc1
    buffer_load_dwordx4 v[164:167], v228, s[8:11], s38 offen offset:1024 sc1
    buffer_load_dwordx4 v[168:171], v228, s[8:11], s38 offen offset:2048 sc1
    buffer_load_dwordx4 v[172:175], v228, s[8:11], s38 offen offset:3072 sc1
    v_lshlrev_b32 v128, 16, v192
    v_and_b32 v129, 0xffff0000, v192
    v_lshlrev_b32 v130, 16, v193
    v_and_b32 v131, 0xffff0000, v193
    v_lshlrev_b32 v132, 16, v194
    v_and_b32 v133, 0xffff0000, v194
    v_lshlrev_b32 v134, 16, v195
    v_and_b32 v135, 0xffff0000, v195
    v_lshlrev_b32 v136, 16, v196
    v_and_b32 v137, 0xffff0000, v196
    v_lshlrev_b32 v138, 16, v197
    v_and_b32 v139, 0xffff0000, v197
    v_lshlrev_b32 v140, 16, v198
    v_and_b32 v141, 0xffff0000, v198
    v_lshlrev_b32 v142, 16, v199
    v_and_b32 v143, 0xffff0000, v199
    v_lshlrev_b32 v144, 16, v200
    v_and_b32 v145, 0xffff0000, v200
    v_lshlrev_b32 v146, 16, v201
    v_and_b32 v147, 0xffff0000, v201
    v_lshlrev_b32 v148, 16, v202
    v_and_b32 v149, 0xffff0000, v202
    v_lshlrev_b32 v150, 16, v203
    v_and_b32 v151, 0xffff0000, v203
    v_lshlrev_b32 v152, 16, v204
    v_and_b32 v153, 0xffff0000, v204
    v_lshlrev_b32 v154, 16, v205
    v_and_b32 v155, 0xffff0000, v205
    v_lshlrev_b32 v156, 16, v206
    v_and_b32 v157, 0xffff0000, v206
    v_lshlrev_b32 v158, 16, v207
    v_and_b32 v159, 0xffff0000, v207
    v_lshlrev_b32 v112, 16, v208
    v_and_b32 v113, 0xffff0000, v208
    v_lshlrev_b32 v114, 16, v209
    v_and_b32 v115, 0xffff0000, v209
    v_lshlrev_b32 v116, 16, v210
    v_and_b32 v117, 0xffff0000, v210
    v_lshlrev_b32 v118, 16, v211
    v_and_b32 v119, 0xffff0000, v211
    v_pk_add_f32 v[120:121], v[112:113], v[114:115]
    v_pk_add_f32 v[122:123], v[116:117], v[118:119]
    v_pk_add_f32 v[120:121], v[120:121], v[122:123]
    v_add_f32 v196, v120, v121
    s_barrier
    s_waitcnt vmcnt(12)
    v_max3_u32 v235, v176, v177, v178
    v_max3_u32 v235, v235, v179, v180
    v_max3_u32 v235, v235, v181, v182
    v_max3_u32 v235, v235, v183, v184
    v_max3_u32 v235, v235, v185, v186
    v_max3_u32 v235, v235, v187, v188
    v_max3_u32 v235, v235, v189, v190
    v_max_u32 v235, v235, v191
    v_cmp_eq_u32 vcc, -1, v235
    s_cbranch_vccnz kc_r3
kc_r3o:
    v_lshlrev_b32 v64, 16, v176
    v_and_b32 v65, 0xffff0000, v176
    v_lshlrev_b32 v66, 16, v177
    v_and_b32 v67, 0xffff0000, v177
    v_pk_add_f32 v[32:33], v[32:33], v[64:65]
    v_pk_add_f32 v[34:35], v[34:35], v[66:67]
    v_lshlrev_b32 v68, 16, v178
    v_and_b32 v69, 0xffff0000, v178
    v_lshlrev_b32 v70, 16, v179
    v_and_b32 v71, 0xffff0000, v179
    v_pk_add_f32 v[36:37], v[36:37], v[68:69]
    v_pk_add_f32 v[38:39], v[38:39], v[70:71]
    v_lshlrev_b32 v72, 16, v180
    v_and_b32 v73, 0xffff0000, v180
    v_lshlrev_b32 v74, 16, v181
    v_and_b32 v75, 0xffff0000, v181
    v_pk_add_f32 v[40:41], v[40:41], v[72:73]
    v_pk_add_f32 v[42:43], v[42:43], v[74:75]
    v_lshlrev_b32 v76, 16, v182
    v_and_b32 v77, 0xffff0000, v182
    v_lshlrev_b32 v78, 16, v183
    v_and_b32 v79, 0xffff0000, v183
    v_pk_add_f32 v[44:45], v[44:45], v[76:77]
    v_pk_add_f32 v[46:47], v[46:47], v[78:79]
    v_lshlrev_b32 v80, 16, v184
    v_and_b32 v81, 0xffff0000, v184
    v_lshlrev_b32 v82, 16, v185
    v_and_b32 v83, 0xffff0000, v185
    v_pk_add_f32 v[48:49], v[48:49], v[80:81]
    v_pk_add_f32 v[50:51], v[50:51], v[82:83]
    v_lshlrev_b32 v84, 16, v186
    v_and_b32 v85, 0xffff0000, v186
    v_lshlrev_b32 v86, 16, v187
    v_and_b32 v87, 0xffff0000, v187
    v_pk_add_f32 v[52:53], v[52:53], v[84:85]
    v_pk_add_f32 v[54:55], v[54:55], v[86:87]
    v_lshlrev_b32 v88, 16, v188
    v_and_b32 v89, 0xffff0000, v188
    v_lshlrev_b32 v90, 16, v189
    v_and_b32 v91, 0xffff0000, v189
    v_pk_add_f32 v[56:57], v[56:57], v[88:89]
    v_pk_add_f32 v[58:59], v[58:59], v[90:91]
    v_lshlrev_b32 v92, 16, v190
    v_and_b32 v93, 0xffff0000, v190
    v_lshlrev_b32 v94, 16, v191
    v_and_b32 v95, 0xffff0000, v191
    v_pk_add_f32 v[60:61], v[60:61], v[92:93]
    v_pk_add_f32 v[62:63], v[62:63], v[94:95]
    s_waitcnt vmcnt(4)
    v_max3_u32 v235, v96, v97, v98
    v_max3_u32 v235, v235, v99, v100
    v_max3_u32 v235, v235, v101, v102
    v_max3_u32 v235, v235, v103, v104
    v_max3_u32 v235, v235, v105, v106
    v_max3_u32 v235, v235, v107, v108
    v_max3_u32 v235, v235, v109, v110
    v_max_u32 v235, v235, v111
    v_cmp_eq_u32 vcc, -1, v235
    s_cbranch_vccnz kc_r1
kc_r1o:
    v_lshlrev_b32 v64, 16, v96
    v_and_b32 v65, 0xffff0000, v96
    v_lshlrev_b32 v66, 16, v97
    v_and_b32 v67, 0xffff0000, v97
    v_pk_add_f32 v[32:33], v[32:33], v[64:65]
    v_pk_add_f32 v[34:35], v[34:35], v[66:67]
    v_lshlrev_b32 v68, 16, v98
    v_and_b32 v69, 0xffff0000, v98
    v_lshlrev_b32 v70, 16, v99
    v_and_b32 v71, 0xffff0000, v99
    v_pk_add_f32 v[36:37], v[36:37], v[68:69]
    v_pk_add_f32 v[38:39], v[38:39], v[70:71]
    v_lshlrev_b32 v72, 16, v100
    v_and_b32 v73, 0xffff0000, v100
    v_lshlrev_b32 v74, 16, v101
    v_and_b32 v75, 0xffff0000, v101
    v_pk_add_f32 v[40:41], v[40:41], v[72:73]
    v_pk_add_f32 v[42:43], v[42:43], v[74:75]
    v_lshlrev_b32 v76, 16, v102
    v_and_b32 v77, 0xffff0000, v102
    v_lshlrev_b32 v78, 16, v103
    v_and_b32 v79, 0xffff0000, v103
    v_pk_add_f32 v[44:45], v[44:45], v[76:77]
    v_pk_add_f32 v[46:47], v[46:47], v[78:79]
    v_lshlrev_b32 v80, 16, v104
    v_and_b32 v81, 0xffff0000, v104
    v_lshlrev_b32 v82, 16, v105
    v_and_b32 v83, 0xffff0000, v105
    v_pk_add_f32 v[48:49], v[48:49], v[80:81]
    v_pk_add_f32 v[50:51], v[50:51], v[82:83]
    v_lshlrev_b32 v84, 16, v106
    v_and_b32 v85, 0xffff0000, v106
    v_lshlrev_b32 v86, 16, v107
    v_and_b32 v87, 0xffff0000, v107
    v_pk_add_f32 v[52:53], v[52:53], v[84:85]
    v_pk_add_f32 v[54:55], v[54:55], v[86:87]
    v_lshlrev_b32 v88, 16, v108
    v_and_b32 v89, 0xffff0000, v108
    v_lshlrev_b32 v90, 16, v109
    v_and_b32 v91, 0xffff0000, v109
    v_pk_add_f32 v[56:57], v[56:57], v[88:89]
    v_pk_add_f32 v[58:59], v[58:59], v[90:91]
    v_lshlrev_b32 v92, 16, v110
    v_and_b32 v93, 0xffff0000, v110
    v_lshlrev_b32 v94, 16, v111
    v_and_b32 v95, 0xffff0000, v111
    v_pk_add_f32 v[60:61], v[60:61], v[92:93]
    v_pk_add_f32 v[62:63], v[62:63], v[94:95]
    s_waitcnt vmcnt(0)
    v_max3_u32 v235, v160, v161, v162
    v_max3_u32 v235, v235, v163, v164
    v_max3_u32 v235, v235, v165, v166
    v_max3_u32 v235, v235, v167, v168
    v_max3_u32 v235, v235, v169, v170
    v_max3_u32 v235, v235, v171, v172
    v_max3_u32 v235, v235, v173, v174
    v_max_u32 v235, v235, v175
    v_cmp_eq_u32 vcc, -1, v235
    s_cbranch_vccnz kc_r2
kc_r2o:
    v_lshlrev_b32 v64, 16, v160
    v_and_b32 v65, 0xffff0000, v160
    v_lshlrev_b32 v66, 16, v161
    v_and_b32 v67, 0xffff0000, v161
    v_pk_add_f32 v[32:33], v[32:33], v[64:65]
    v_pk_add_f32 v[34:35], v[34:35], v[66:67]
    v_cvt_pk_bf16_f32 v0, v32, v33
    v_cvt_pk_bf16_f32 v1, v34, v35
    ds_write_b64 v238, v[0:1] offset:0
    v_lshlrev_b32 v68, 16, v162
    v_and_b32 v69, 0xffff0000, v162
    v_lshlrev_b32 v70, 16, v163
    v_and_b32 v71, 0xffff0000, v163
    v_pk_add_f32 v[36:37], v[36:37], v[68:69]
    v_pk_add_f32 v[38:39], v[38:39], v[70:71]
    v_cvt_pk_bf16_f32 v2, v36, v37
    v_cvt_pk_bf16_f32 v3, v38, v39
    ds_write_b64 v238, v[2:3] offset:2304
    v_lshlrev_b32 v72, 16, v164
    v_and_b32 v73, 0xffff0000, v164
    v_lshlrev_b32 v74, 16, v165
    v_and_b32 v75, 0xffff0000, v165
    v_pk_add_f32 v[40:41], v[40:41], v[72:73]
    v_pk_add_f32 v[42:43], v[42:43], v[74:75]
    v_cvt_pk_bf16_f32 v4, v40, v41
    v_cvt_pk_bf16_f32 v5, v42, v43
    ds_write_b64 v238, v[4:5] offset:32
    v_lshlrev_b32 v76, 16, v166
    v_and_b32 v77, 0xffff0000, v166
    v_lshlrev_b32 v78, 16, v167
    v_and_b32 v79, 0xffff0000, v167
    v_pk_add_f32 v[44:45], v[44:45], v[76:77]
    v_pk_add_f32 v[46:47], v[46:47], v[78:79]
    v_cvt_pk_bf16_f32 v6, v44, v45
    v_cvt_pk_bf16_f32 v7, v46, v47
    ds_write_b64 v238, v[6:7] offset:2336
    v_lshlrev_b32 v80, 16, v168
    v_and_b32 v81, 0xffff0000, v168
    v_lshlrev_b32 v82, 16, v169
    v_and_b32 v83, 0xffff0000, v169
    v_pk_add_f32 v[48:49], v[48:49], v[80:81]
    v_pk_add_f32 v[50:51], v[50:51], v[82:83]
    v_cvt_pk_bf16_f32 v8, v48, v49
    v_cvt_pk_bf16_f32 v9, v50, v51
    ds_write_b64 v238, v[8:9] offset:64
    v_lshlrev_b32 v84, 16, v170
    v_and_b32 v85, 0xffff0000, v170
    v_lshlrev_b32 v86, 16, v171
    v_and_b32 v87, 0xffff0000, v171
    v_pk_add_f32 v[52:53], v[52:53], v[84:85]
    v_pk_add_f32 v[54:55], v[54:55], v[86:87]
    v_cvt_pk_bf16_f32 v10, v52, v53
    v_cvt_pk_bf16_f32 v11, v54, v55
    ds_write_b64 v238, v[10:11] offset:2368
    v_lshlrev_b32 v88, 16, v172
    v_and_b32 v89, 0xffff0000, v172
    v_lshlrev_b32 v90, 16, v173
    v_and_b32 v91, 0xffff0000, v173
    v_pk_add_f32 v[56:57], v[56:57], v[88:89]
    v_pk_add_f32 v[58:59], v[58:59], v[90:91]
    v_cvt_pk_bf16_f32 v12, v56, v57
    v_cvt_pk_bf16_f32 v13, v58, v59
    ds_write_b64 v238, v[12:13] offset:96
    v_lshlrev_b32 v92, 16, v174
    v_and_b32 v93, 0xffff0000, v174
    v_lshlrev_b32 v94, 16, v175
    v_and_b32 v95, 0xffff0000, v175
    v_pk_add_f32 v[60:61], v[60:61], v[92:93]
    v_pk_add_f32 v[62:63], v[62:63], v[94:95]
    v_cvt_pk_bf16_f32 v14, v60, v61
    v_cvt_pk_bf16_f32 v15, v62, v63
    ds_write_b64 v238, v[14:15] offset:2400
    s_waitcnt lgkmcnt(0)
    ds_read_b128 v[16:19], v239 offset:0
    ds_read_b128 v[20:23], v239 offset:1152
    ds_read_b128 v[24:27], v239 offset:2304
    ds_read_b128 v[28:31], v239 offset:3456
    s_waitcnt lgkmcnt(3)
    v_lshlrev_b32 v64, 16, v16
    v_lshlrev_b32 v66, 16, v17
    v_lshlrev_b32 v68, 16, v18
    v_lshlrev_b32 v70, 16, v19
    v_and_b32 v65, 0xffff0000, v16
    v_and_b32 v67, 0xffff0000, v17
    v_and_b32 v69, 0xffff0000, v18
    v_and_b32 v71, 0xffff0000, v19
    v_pk_add_f32 v[64:65], v[64:65], v[128:129]
    v_pk_add_f32 v[66:67], v[66:67], v[130:131]
    v_pk_add_f32 v[68:69], v[68:69], v[132:133]
    v_pk_add_f32 v[70:71], v[70:71], v[134:135]
    v_cvt_pk_bf16_f32 v16, v64, v65
    v_cvt_pk_bf16_f32 v17, v66, v67
    v_cvt_pk_bf16_f32 v18, v68, v69
    v_cvt_pk_bf16_f32 v19, v70, v71
    v_lshlrev_b32 v64, 16, v16
    v_lshlrev_b32 v66, 16, v17
    v_lshlrev_b32 v68, 16, v18
    v_lshlrev_b32 v70, 16, v19
    v_and_b32 v65, 0xffff0000, v16
    v_and_b32 v67, 0xffff0000, v17
    v_and_b32 v69, 0xffff0000, v18
    v_and_b32 v71, 0xffff0000, v19
    s_mov_b32 s32, 0x3400000
    buffer_store_dwordx4 v[16:19], v229, s[8:11], s32 offen sc1
    v_pk_add_f32 v[160:161], v[64:65], v[66:67]
    v_pk_mul_f32 v[162:163], v[64:65], v[64:65]
    v_pk_mul_f32 v[164:165], v[64:65], v[112:113]
    v_pk_fma_f32 v[162:163], v[66:67], v[66:67], v[162:163]
    v_pk_fma_f32 v[164:165], v[66:67], v[114:115], v[164:165]
    v_pk_add_f32 v[160:161], v[160:161], v[68:69]
    v_pk_fma_f32 v[162:163], v[68:69], v[68:69], v[162:163]
    v_pk_fma_f32 v[164:165], v[68:69], v[116:117], v[164:165]
    v_pk_add_f32 v[160:161], v[160:161], v[70:71]
    v_pk_fma_f32 v[162:163], v[70:71], v[70:71], v[162:163]
    v_pk_fma_f32 v[164:165], v[70:71], v[118:119], v[164:165]
    v_add_f32 v184, v160, v161
    v_add_f32 v185, v162, v163
    v_add_f32 v186, v164, v165
    s_waitcnt lgkmcnt(2)
    v_lshlrev_b32 v72, 16, v20
    v_lshlrev_b32 v74, 16, v21
    v_lshlrev_b32 v76, 16, v22
    v_lshlrev_b32 v78, 16, v23
    v_and_b32 v73, 0xffff0000, v20
    v_and_b32 v75, 0xffff0000, v21
    v_and_b32 v77, 0xffff0000, v22
    v_and_b32 v79, 0xffff0000, v23
    v_pk_add_f32 v[72:73], v[72:73], v[136:137]
    v_pk_add_f32 v[74:75], v[74:75], v[138:139]
    v_pk_add_f32 v[76:77], v[76:77], v[140:141]
    v_pk_add_f32 v[78:79], v[78:79], v[142:143]
    v_cvt_pk_bf16_f32 v20, v72, v73
    v_cvt_pk_bf16_f32 v21, v74, v75
    v_cvt_pk_bf16_f32 v22, v76, v77
    v_cvt_pk_bf16_f32 v23, v78, v79
    v_lshlrev_b32 v72, 16, v20
    v_lshlrev_b32 v74, 16, v21
    v_lshlrev_b32 v76, 16, v22
    v_lshlrev_b32 v78, 16, v23
    v_and_b32 v73, 0xffff0000, v20
    v_and_b32 v75, 0xffff0000, v21
    v_and_b32 v77, 0xffff0000, v22
    v_and_b32 v79, 0xffff0000, v23
    s_mov_b32 s32, 0x3404000
    buffer_store_dwordx4 v[20:23], v229, s[8:11], s32 offen sc1
    v_pk_add_f32 v[166:167], v[72:73], v[74:75]
    v_pk_mul_f32 v[168:169], v[72:73], v[72:73]
    v_pk_mul_f32 v[170:171], v[72:73], v[112:113]
    v_pk_fma_f32 v[168:169], v[74:75], v[74:75], v[168:169]
    v_pk_fma_f32 v[170:171], v[74:75], v[114:115], v[170:171]
    v_pk_add_f32 v[166:167], v[166:167], v[76:77]
    v_pk_fma_f32 v[168:169], v[76:77], v[76:77], v[168:169]
    v_pk_fma_f32 v[170:171], v[76:77], v[116:117], v[170:171]
    v_pk_add_f32 v[166:167], v[166:167], v[78:79]
    v_pk_fma_f32 v[168:169], v[78:79], v[78:79], v[168:169]
    v_pk_fma_f32 v[170:171], v[78:79], v[118:119], v[170:171]
    v_add_f32 v187, v166, v167
    v_add_f32 v188, v168, v169
    v_add_f32 v189, v170, v171
    s_waitcnt lgkmcnt(1)
    v_lshlrev_b32 v80, 16, v24
    v_lshlrev_b32 v82, 16, v25
    v_lshlrev_b32 v84, 16, v26
    v_lshlrev_b32 v86, 16, v27
    v_and_b32 v81, 0xffff0000, v24
    v_and_b32 v83, 0xffff0000, v25
    v_and_b32 v85, 0xffff0000, v26
    v_and_b32 v87, 0xffff0000, v27
    v_pk_add_f32 v[80:81], v[80:81], v[144:145]
    v_pk_add_f32 v[82:83], v[82:83], v[146:147]
    v_pk_add_f32 v[84:85], v[84:85], v[148:149]
    v_pk_add_f32 v[86:87], v[86:87], v[150:151]
    v_cvt_pk_bf16_f32 v24, v80, v81
    v_cvt_pk_bf16_f32 v25, v82, v83
    v_cvt_pk_bf16_f32 v26, v84, v85
    v_cvt_pk_bf16_f32 v27, v86, v87
    v_lshlrev_b32 v80, 16, v24
    v_lshlrev_b32 v82, 16, v25
    v_lshlrev_b32 v84, 16, v26
    v_lshlrev_b32 v86, 16, v27
    v_and_b32 v81, 0xffff0000, v24
    v_and_b32 v83, 0xffff0000, v25
    v_and_b32 v85, 0xffff0000, v26
    v_and_b32 v87, 0xffff0000, v27
    s_mov_b32 s32, 0x3408000
    buffer_store_dwordx4 v[24:27], v229, s[8:11], s32 offen sc1
    v_pk_add_f32 v[172:173], v[80:81], v[82:83]
    v_pk_mul_f32 v[174:175], v[80:81], v[80:81]
    v_pk_mul_f32 v[176:177], v[80:81], v[112:113]
    v_pk_fma_f32 v[174:175], v[82:83], v[82:83], v[174:175]
    v_pk_fma_f32 v[176:177], v[82:83], v[114:115], v[176:177]
    v_pk_add_f32 v[172:173], v[172:173], v[84:85]
    v_pk_fma_f32 v[174:175], v[84:85], v[84:85], v[174:175]
    v_pk_fma_f32 v[176:177], v[84:85], v[116:117], v[176:177]
    v_pk_add_f32 v[172:173], v[172:173], v[86:87]
    v_pk_fma_f32 v[174:175], v[86:87], v[86:87], v[174:175]
    v_pk_fma_f32 v[176:177], v[86:87], v[118:119], v[176:177]
    v_add_f32 v190, v172, v173
    v_add_f32 v191, v174, v175
    v_add_f32 v192, v176, v177
    s_waitcnt lgkmcnt(0)
    v_lshlrev_b32 v88, 16, v28
    v_lshlrev_b32 v90, 16, v29
    v_lshlrev_b32 v92, 16, v30
    v_lshlrev_b32 v94, 16, v31
    v_and_b32 v89, 0xffff0000, v28
    v_and_b32 v91, 0xffff0000, v29
    v_and_b32 v93, 0xffff0000, v30
    v_and_b32 v95, 0xffff0000, v31
    v_pk_add_f32 v[88:89], v[88:89], v[152:153]
    v_pk_add_f32 v[90:91], v[90:91], v[154:155]
    v_pk_add_f32 v[92:93], v[92:93], v[156:157]
    v_pk_add_f32 v[94:95], v[94:95], v[158:159]
    v_cvt_pk_bf16_f32 v28, v88, v89
    v_cvt_pk_bf16_f32 v29, v90, v91
    v_cvt_pk_bf16_f32 v30, v92, v93
    v_cvt_pk_bf16_f32 v31, v94, v95
    v_lshlrev_b32 v88, 16, v28
    v_lshlrev_b32 v90, 16, v29
    v_lshlrev_b32 v92, 16, v30
    v_lshlrev_b32 v94, 16, v31
    v_and_b32 v89, 0xffff0000, v28
    v_and_b32 v91, 0xffff0000, v29
    v_and_b32 v93, 0xffff0000, v30
    v_and_b32 v95, 0xffff0000, v31
    s_mov_b32 s32, 0x340c000
    buffer_store_dwordx4 v[28:31], v229, s[8:11], s32 offen sc1
    v_pk_add_f32 v[178:179], v[88:89], v[90:91]
    v_pk_mul_f32 v[180:181], v[88:89], v[88:89]
    v_pk_mul_f32 v[182:183], v[88:89], v[112:113]
    v_pk_fma_f32 v[180:181], v[90:91], v[90:91], v[180:181]
    v_pk_fma_f32 v[182:183], v[90:91], v[114:115], v[182:183]
    v_pk_add_f32 v[178:179], v[178:179], v[92:93]
    v_pk_fma_f32 v[180:181], v[92:93], v[92:93], v[180:181]
    v_pk_fma_f32 v[182:183], v[92:93], v[116:117], v[182:183]
    v_pk_add_f32 v[178:179], v[178:179], v[94:95]
    v_pk_fma_f32 v[180:181], v[94:95], v[94:95], v[180:181]
    v_pk_fma_f32 v[182:183], v[94:95], v[118:119], v[182:183]
    v_add_f32 v193, v178, v179
    v_add_f32 v194, v180, v181
    v_add_f32 v195, v182, v183
    v_add_f32_dpp v196, v196, v196 quad_perm:[1,0,3,2] row_mask:0xf bank_mask:0xf
    v_add_f32_dpp v184, v184, v184 quad_perm:[1,0,3,2] row_mask:0xf bank_mask:0xf
    v_add_f32_dpp v185, v185, v185 quad_perm:[1,0,3,2] row_mask:0xf bank_mask:0xf
    v_add_f32_dpp v186, v186, v186 quad_perm:[1,0,3,2] row_mask:0xf bank_mask:0xf
    v_add_f32_dpp v187, v187, v187 quad_perm:[1,0,3,2] row_mask:0xf bank_mask:0xf
    v_add_f32_dpp v188, v188, v188 quad_perm:[1,0,3,2] row_mask:0xf bank_mask:0xf
    v_add_f32_dpp v189, v189, v189 quad_perm:[1,0,3,2] row_mask:0xf bank_mask:0xf
    v_add_f32_dpp v190, v190, v190 quad_perm:[1,0,3,2] row_mask:0xf bank_mask:0xf
    v_add_f32_dpp v191, v191, v191 quad_perm:[1,0,3,2] row_mask:0xf bank_mask:0xf
    v_add_f32_dpp v192, v192, v192 quad_perm:[1,0,3,2] row_mask:0xf bank_mask:0xf
    v_add_f32_dpp v193, v193, v193 quad_perm:[1,0,3,2] row_mask:0xf bank_mask:0xf
    v_add_f32_dpp v194, v194, v194 quad_perm:[1,0,3,2] row_mask:0xf bank_mask:0xf
    v_add_f32_dpp v195, v195, v195 quad_perm:[1,0,3,2] row_mask:0xf bank_mask:0xf
    v_add_f32_dpp v196, v196, v196 quad_perm:[2,3,0,1] row_mask:0xf bank_mask:0xf
    v_add_f32_dpp v184, v184, v184 quad_perm:[2,3,0,1] row_mask:0xf bank_mask:0xf
    v_add_f32_dpp v185, v185, v185 quad_perm:[2,3,0,1] row_mask:0xf bank_mask:0xf
    v_add_f32_dpp v186, v186, v186 quad_perm:[2,3,0,1] row_mask:0xf bank_mask:0xf
    v_add_f32_dpp v187, v187, v187 quad_perm:[2,3,0,1] row_mask:0xf bank_mask:0xf
    v_add_f32_dpp v188, v188, v188 quad_perm:[2,3,0,1] row_mask:0xf bank_mask:0xf
    v_add_f32_dpp v189, v189, v189 quad_perm:[2,3,0,1] row_mask:0xf bank_mask:0xf
    v_add_f32_dpp v190, v190, v190 quad_perm:[2,3,0,1] row_mask:0xf bank_mask:0xf
    v_add_f32_dpp v191, v191, v191 quad_perm:[2,3,0,1] row_mask:0xf bank_mask:0xf
    v_add_f32_dpp v192, v192, v192 quad_perm:[2,3,0,1] row_mask:0xf bank_mask:0xf
    v_add_f32_dpp v193, v193, v193 quad_perm:[2,3,0,1] row_mask:0xf bank_mask:0xf
    v_add_f32_dpp v194, v194, v194 quad_perm:[2,3,0,1] row_mask:0xf bank_mask:0xf
    v_add_f32_dpp v195, v195, v195 quad_perm:[2,3,0,1] row_mask:0xf bank_mask:0xf
    v_add_f32_dpp v196, v196, v196 row_half_mirror row_mask:0xf bank_mask:0xf
    v_add_f32_dpp v184, v184, v184 row_half_mirror row_mask:0xf bank_mask:0xf
    v_add_f32_dpp v185, v185, v185 row_half_mirror row_mask:0xf bank_mask:0xf
    v_add_f32_dpp v186, v186, v186 row_half_mirror row_mask:0xf bank_mask:0xf
    v_add_f32_dpp v187, v187, v187 row_half_mirror row_mask:0xf bank_mask:0xf
    v_add_f32_dpp v188, v188, v188 row_half_mirror row_mask:0xf bank_mask:0xf
    v_add_f32_dpp v189, v189, v189 row_half_mirror row_mask:0xf bank_mask:0xf
    v_add_f32_dpp v190, v190, v190 row_half_mirror row_mask:0xf bank_mask:0xf
    v_add_f32_dpp v191, v191, v191 row_half_mirror row_mask:0xf bank_mask:0xf
    v_add_f32_dpp v192, v192, v192 row_half_mirror row_mask:0xf bank_mask:0xf
    v_add_f32_dpp v193, v193, v193 row_half_mirror row_mask:0xf bank_mask:0xf
    v_add_f32_dpp v194, v194, v194 row_half_mirror row_mask:0xf bank_mask:0xf
    v_add_f32_dpp v195, v195, v195 row_half_mirror row_mask:0xf bank_mask:0xf
    v_cndmask_b32 v184, v184, v187, s[60:61]
    v_cndmask_b32 v190, v190, v193, s[60:61]
    v_cndmask_b32 v185, v185, v188, s[60:61]
    v_cndmask_b32 v191, v191, v194, s[60:61]
    v_cndmask_b32 v186, v186, v189, s[60:61]
    v_cndmask_b32 v192, v192, v195, s[60:61]
    v_cndmask_b32 v184, v184, v190, s[62:63]
    v_cndmask_b32 v185, v185, v191, s[62:63]
    v_cndmask_b32 v186, v186, v192, s[62:63]
    v_cndmask_b32 v184, v184, v185, s[40:41]
    v_cndmask_b32 v186, v186, v196, s[40:41]
    buffer_atomic_add_f32 v184, v231, s[8:11], s48 offen
    buffer_atomic_add_f32 v186, v232, s[8:11], s48 offen
    s_lshl_b32 s32, s3, 13
    v_add_u32 v234, s32, v228
    v_add_u32 v235, 65536, v234
    ds_write_b128 v234, a[128:131] offset:0
    ds_write_b128 v234, a[132:135] offset:1024
    ds_write_b128 v234, a[136:139] offset:2048
    ds_write_b128 v234, a[140:143] offset:3072
    ds_write_b128 v234, a[144:147] offset:4096
    ds_write_b128 v234, a[148:151] offset:5120
    ds_write_b128 v234, a[152:155] offset:6144
    ds_write_b128 v234, a[156:159] offset:7168
    s_waitcnt lgkmcnt(4)
    ds_write_b128 v234, a[160:163] offset:32768
    ds_write_b128 v234, a[164:167] offset:33792
    ds_write_b128 v234, a[168:171] offset:34816
    ds_write_b128 v234, a[172:175] offset:35840
    ds_write_b128 v234, a[176:179] offset:36864
    ds_write_b128 v234, a[180:183] offset:37888
    ds_write_b128 v234, a[184:187] offset:38912
    ds_write_b128 v234, a[188:191] offset:39936
    s_waitcnt lgkmcnt(4)
    ds_write_b128 v235, a[192:195] offset:0
    ds_write_b128 v235, a[196:199] offset:1024
    ds_write_b128 v235, a[200:203] offset:2048
    ds_write_b128 v235, a[204:207] offset:3072
    ds_write_b128 v235, a[208:211] offset:4096
    ds_write_b128 v235, a[212:215] offset:5120
    ds_write_b128 v235, a[216:219] offset:6144
    ds_write_b128 v235, a[220:223] offset:7168
    s_waitcnt lgkmcnt(4)
    s_lshl_b32 s35, s3, 13
    v_bfe_u32 v234, v237, 2, 3
    v_lshrrev_b32 v235, 5, v237
    v_lshl_add_u32 v234, v235, 4, v234
    v_lshlrev_b32 v234, 5, v234
    v_and_b32 v236, 3, v237
    v_lshl_add_u32 v234, v236, 3, v234
    v_add_u32 v217, s35, v234
    v_lshlrev_b32 v235, 5, v235
    v_bfe_u32 v236, v237, 4, 1
    v_lshl_add_u32 v235, v236, 3, v235
    v_and_b32 v236, 1, v237
    v_lshl_add_u32 v235, v236, 11, v235
    s_lshl_b32 s32, s3, 9
    s_add_u32 s32, s32, 98304
    v_add_u32 v218, s32, v235
    v_lshlrev_b32 v234, 4, v230
    v_add_u32 v220, 106752, v234
    v_add_u32 v221, 106752, v228
    v_lshrrev_b32 v236, 2, v237
    v_lshlrev_b32 v236, 7, v236
    v_and_b32 v234, 3, v237
    v_lshl_add_u32 v236, v234, 3, v236
    s_add_u32 s32, s35, 65536
    v_add_u32 v219, s32, v236
    s_lshl_b32 s32, s3, 12
    s_add_u32 s32, s32, 114944
    v_and_b32 v234, 15, v237
    v_min_u32 v234, 2, v234
    v_lshlrev_b32 v234, 10, v234
    v_lshrrev_b32 v235, 4, v237
    v_lshl_add_u32 v234, v235, 4, v234
    v_add_u32 v222, s32, v234
    v_add_u32 v223, s32, v228
    s_waitcnt vmcnt(0)
    s_barrier
    s_cmp_lg_u32 s3, 0
    s_cbranch_scc1 kc_a1
    s_lshl_b32 s32, s52, 7
    s_add_u32 s32, s32, 0x38a0000
    v_mov_b32 v235, 1
    buffer_atomic_add v235, v243, s[8:11], s32 offen sc0 sc1
    v_lshlrev_b32 v234, 7, v237
    v_cmp_gt_u32 vcc, 8, v237
    v_mov_b32 v236, 0x40000000
    s_mov_b32 s34, 0x38a0400
    v_cndmask_b32 v234, v236, v234, vcc
    s_waitcnt vmcnt(0)
    v_readfirstlane_b32 s36, v235
    s_cmp_lg_u32 s36, 31
    s_cbranch_scc1 kc_a1
    buffer_atomic_add v233, v234, s[8:11], s34 offen sc1
kc_a1:
    s_waitcnt lgkmcnt(0)
    ds_read_b64_tr_b16 a[0:1], v217 offset:0
    ds_read_b64_tr_b16 a[2:3], v217 offset:256
    ds_read_b64_tr_b16 a[32:33], v217 offset:32768
    ds_read_b64_tr_b16 a[34:35], v217 offset:33024
    ds_read_b64_tr_b16 a[4:5], v217 offset:1024
    ds_read_b64_tr_b16 a[6:7], v217 offset:1280
    ds_read_b64_tr_b16 a[36:37], v217 offset:33792
    ds_read_b64_tr_b16 a[38:39], v217 offset:34048
    s_waitcnt lgkmcnt(6)
    ds_read_b64_tr_b16 a[8:9], v217 offset:2048
    ds_read_b64_tr_b16 a[10:11], v217 offset:2304
    ds_read_b64_tr_b16 a[40:41], v217 offset:34816
    ds_read_b64_tr_b16 a[42:43], v217 offset:35072
    ds_read_b64_tr_b16 a[12:13], v217 offset:3072
    ds_read_b64_tr_b16 a[14:15], v217 offset:3328
    ds_read_b64_tr_b16 a[44:45], v217 offset:35840
    ds_read_b64_tr_b16 a[46:47], v217 offset:36096
    s_waitcnt lgkmcnt(6)
    ds_read_b64_tr_b16 a[16:17], v217 offset:4096
    ds_read_b64_tr_b16 a[18:19], v217 offset:4352
    ds_read_b64_tr_b16 a[48:49], v217 offset:36864
    ds_read_b64_tr_b16 a[50:51], v217 offset:37120
    ds_read_b64_tr_b16 a[20:21], v217 offset:5120
    ds_read_b64_tr_b16 a[22:23], v217 offset:5376
    ds_read_b64_tr_b16 a[52:53], v217 offset:37888
    ds_read_b64_tr_b16 a[54:55], v217 offset:38144
    s_waitcnt lgkmcnt(6)
    ds_read_b64_tr_b16 a[24:25], v217 offset:6144
    ds_read_b64_tr_b16 a[26:27], v217 offset:6400
    ds_read_b64_tr_b16 a[56:57], v217 offset:38912
    ds_read_b64_tr_b16 a[58:59], v217 offset:39168
    ds_read_b64_tr_b16 a[28:29], v217 offset:7168
    ds_read_b64_tr_b16 a[30:31], v217 offset:7424
    ds_read_b64_tr_b16 a[60:61], v217 offset:39936
    ds_read_b64_tr_b16 a[62:63], v217 offset:40192
    s_waitcnt lgkmcnt(6)
    ds_read_b64_tr_b16 a[64:65], v219 offset:0
    ds_read_b64_tr_b16 a[66:67], v219 offset:32
    ds_read_b64_tr_b16 a[68:69], v219 offset:64
    ds_read_b64_tr_b16 a[70:71], v219 offset:96
    ds_read_b64_tr_b16 a[72:73], v219 offset:2048
    ds_read_b64_tr_b16 a[74:75], v219 offset:2080
    ds_read_b64_tr_b16 a[76:77], v219 offset:2112
    ds_read_b64_tr_b16 a[78:79], v219 offset:2144
    s_waitcnt lgkmcnt(6)
    ds_read_b64_tr_b16 a[80:81], v219 offset:4096
    ds_read_b64_tr_b16 a[82:83], v219 offset:4128
    ds_read_b64_tr_b16 a[84:85], v219 offset:4160
    ds_read_b64_tr_b16 a[86:87], v219 offset:4192
    ds_read_b64_tr_b16 a[88:89], v219 offset:6144
    ds_read_b64_tr_b16 a[90:91], v219 offset:6176
    ds_read_b64_tr_b16 a[92:93], v219 offset:6208
    ds_read_b64_tr_b16 a[94:95], v219 offset:6240
    s_waitcnt lgkmcnt(6)
    v_mov_b32 v130, 0x3a800000
    v_mov_b32 v131, 0x3a800000
    v_mov_b32 v132, 0x3727c5ac
    v_mov_b32 v133, 0x3727c5ac
    s_mov_b32 s33, 0xfffff800
    s_lshl_b32 s39, s3, 11
    v_add_u32 v238, s39, v228
    v_lshlrev_b32 v239, 2, v242
    s_lshl_b32 s39, s3, 3
    s_add_u32 s7, s39, 106512
    v_lshlrev_b32 v141, 5, v237
    v_or_b32 v141, s39, v141
    s_cmp_lg_u32 s3, 0
    s_cbranch_scc1 kc_b12
    s_lshl_b32 s32, s52, 7
    s_add_u32 s32, s32, 0x38a0400
    s_mov_b32 s34, 0x400000
    s_branch kc_b11
kc_b10:
    s_sleep 2
kc_b11:
    buffer_load_dword v235, off, s[8:11], s32 sc1
    s_waitcnt vmcnt(0)
    v_cmp_ne_u32 vcc, 8, v235
    s_sub_u32 s34, s34, 1
    s_cbranch_scc1 kc_b12
    s_cbranch_vccnz kc_b10
kc_b12:
    s_barrier
    s_add_u32 s32, s48, 24576
    buffer_load_dword v128, off, s[8:11], s32 sc1
    buffer_load_dwordx4 v[32:35], v238, s[8:11], s48 offen offset:0 sc1
    buffer_load_dwordx4 v[40:43], v238, s[8:11], s49 offen offset:0 sc1
    buffer_load_dwordx4 v[48:51], v238, s[8:11], s50 offen offset:0 sc1
    buffer_load_dwordx4 v[36:39], v238, s[8:11], s48 offen offset:1024 sc1
    buffer_load_dwordx4 v[44:47], v238, s[8:11], s49 offen offset:1024 sc1
    buffer_load_dwordx4 v[52:55], v238, s[8:11], s50 offen offset:1024 sc1
    buffer_load_dword v0, v239, s[8:11], s48 offen offset:0 sc1
    buffer_load_dword v4, v239, s[8:11], s49 offen offset:0 sc1
    buffer_load_dword v1, v239, s[8:11], s48 offen offset:32 sc1
    buffer_load_dword v5, v239, s[8:11], s49 offen offset:32 sc1
    buffer_load_dword v2, v239, s[8:11], s48 offen offset:64 sc1
    buffer_load_dword v6, v239, s[8:11], s49 offen offset:64 sc1
    buffer_load_dword v3, v239, s[8:11], s48 offen offset:96 sc1
    buffer_load_dword v7, v239, s[8:11], s49 offen offset:96 sc1
    s_waitcnt vmcnt(8)
    v_mov_b32 v129, v128
    v_pk_mul_f32 v[32:33], v[32:33], v[130:131]
    v_pk_mul_f32 v[34:35], v[34:35], v[130:131]
    v_pk_mul_f32 v[36:37], v[36:37], v[130:131]
    v_pk_mul_f32 v[38:39], v[38:39], v[130:131]
    v_pk_fma_f32 v[40:41], v[40:41], v[130:131], v[132:133]
    v_pk_fma_f32 v[42:43], v[42:43], v[130:131], v[132:133]
    v_pk_fma_f32 v[44:45], v[44:45], v[130:131], v[132:133]
    v_pk_fma_f32 v[46:47], v[46:47], v[130:131], v[132:133]
    v_pk_fma_f32 v[40:41], v[32:33], v[32:33], v[40:41] neg_lo:[1,0,0] neg_hi:[1,0,0]
    v_pk_fma_f32 v[42:43], v[34:35], v[34:35], v[42:43] neg_lo:[1,0,0] neg_hi:[1,0,0]
    v_pk_fma_f32 v[44:45], v[36:37], v[36:37], v[44:45] neg_lo:[1,0,0] neg_hi:[1,0,0]
    v_pk_fma_f32 v[46:47], v[38:39], v[38:39], v[46:47] neg_lo:[1,0,0] neg_hi:[1,0,0]
    v_pk_fma_f32 v[48:49], v[32:33], v[128:129], v[48:49] neg_lo:[1,0,0] neg_hi:[1,0,0]
    v_pk_fma_f32 v[50:51], v[34:35], v[128:129], v[50:51] neg_lo:[1,0,0] neg_hi:[1,0,0]
    v_pk_fma_f32 v[52:53], v[36:37], v[128:129], v[52:53] neg_lo:[1,0,0] neg_hi:[1,0,0]
    v_pk_fma_f32 v[54:55], v[38:39], v[128:129], v[54:55] neg_lo:[1,0,0] neg_hi:[1,0,0]
    v_max_f32 v40, v40, v132
    v_max_f32 v42, v42, v132
    v_max_f32 v44, v44, v132
    v_max_f32 v46, v46, v132
    v_max_f32 v41, v41, v132
    v_max_f32 v43, v43, v132
    v_max_f32 v45, v45, v132
    v_max_f32 v47, v47, v132
    v_rsq_f32 v40, v40
    v_rsq_f32 v42, v42
    v_rsq_f32 v44, v44
    v_rsq_f32 v46, v46
    v_rsq_f32 v41, v41
    v_rsq_f32 v43, v43
    v_rsq_f32 v45, v45
    v_rsq_f32 v47, v47
    v_pk_mul_f32 v[48:49], v[48:49], v[40:41]
    v_pk_mul_f32 v[50:51], v[50:51], v[42:43]
    v_pk_mul_f32 v[52:53], v[52:53], v[44:45]
    v_pk_mul_f32 v[54:55], v[54:55], v[46:47]
    v_and_or_b32 v48, v48, s33, 0
    v_and_or_b32 v50, v50, s33, 2
    v_and_or_b32 v52, v52, s33, 4
    v_and_or_b32 v54, v54, s33, 6
    v_and_or_b32 v49, v49, s33, 1
    v_and_or_b32 v51, v51, s33, 3
    v_and_or_b32 v53, v53, s33, 5
    v_and_or_b32 v55, v55, s33, 7
    v_max_f32 v136, v48, v49
    v_min_f32 v137, v48, v49
    v_med3_f32 v137, v136, v50, v137
    v_max_f32 v136, v136, v50
    v_med3_f32 v137, v136, v51, v137
    v_max_f32 v136, v136, v51
    v_med3_f32 v137, v136, v52, v137
    v_max_f32 v136, v136, v52
    v_med3_f32 v137, v136, v53, v137
    v_max_f32 v136, v136, v53
    v_med3_f32 v137, v136, v54, v137
    v_max_f32 v136, v136, v54
    v_med3_f32 v137, v136, v55, v137
    v_max_f32 v136, v136, v55
    v_or_b32 v136, v141, v136
    v_or_b32 v137, v141, v137
    s_nop 1
    v_mov_b32_dpp v138, v136 quad_perm:[1,0,3,2] row_mask:0xf bank_mask:0xf
    v_mov_b32_dpp v139, v137 quad_perm:[1,0,3,2] row_mask:0xf bank_mask:0xf
    v_min_f32 v140, v136, v138
    v_max_f32 v136, v136, v138
    v_max3_f32 v137, v140, v137, v139
    s_nop 1
    v_mov_b32_dpp v138, v136 quad_perm:[2,3,0,1] row_mask:0xf bank_mask:0xf
    v_mov_b32_dpp v139, v137 quad_perm:[2,3,0,1] row_mask:0xf bank_mask:0xf
    v_min_f32 v140, v136, v138
    v_max_f32 v136, v136, v138
    v_max3_f32 v137, v140, v137, v139
    s_nop 1
    v_mov_b32_dpp v138, v136 row_half_mirror row_mask:0xf bank_mask:0xf
    v_mov_b32_dpp v139, v137 row_half_mirror row_mask:0xf bank_mask:0xf
    v_min_f32 v140, v136, v138
    v_max_f32 v136, v136, v138
    v_max3_f32 v137, v140, v137, v139
    s_nop 1
    v_mov_b32_dpp v138, v136 row_mirror row_mask:0xf bank_mask:0xf
    v_mov_b32_dpp v139, v137 row_mirror row_mask:0xf bank_mask:0xf
    v_min_f32 v140, v136, v138
    v_max_f32 v136, v136, v138
    v_max3_f32 v137, v140, v137, v139
    v_mov_b32 v138, v136
    v_mov_b32 v139, v137
    s_nop 1
    v_permlane16_swap_b32 v136, v138
    v_permlane16_swap_b32 v137, v139
    s_nop 0
    v_min_f32 v140, v136, v138
    v_max_f32 v136, v136, v138
    v_max3_f32 v137, v140, v137, v139
    v_mov_b32 v138, v136
    v_mov_b32 v139, v137
    s_nop 1
    v_permlane32_swap_b32 v136, v138
    v_permlane32_swap_b32 v137, v139
    s_nop 0
    v_min_f32 v140, v136, v138
    v_max_f32 v136, v136, v138
    v_max3_f32 v137, v140, v137, v139
    v_mov_b32 v234, s7
    ds_write_b64 v234, v[136:137]
    v_mov_b32 v234, 106512
    s_waitcnt lgkmcnt(0)
    s_barrier
    ds_read_b128 v[56:59], v234
    ds_read_b128 v[60:63], v234 offset:16
    s_waitcnt lgkmcnt(0)
    v_min_f32 v140, v56, v58
    v_max_f32 v56, v56, v58
    v_max3_f32 v57, v140, v57, v59
    v_min_f32 v140, v60, v62
    v_max_f32 v60, v60, v62
    v_max3_f32 v61, v140, v61, v63
    v_min_f32 v140, v56, v60
    v_max_f32 v56, v56, v60
    v_max3_f32 v57, v140, v57, v61
    v_bfe_u32 v234, v56, 5, 6
    v_bfe_u32 v235, v56, 2, 3
    v_and_b32 v8, 3, v56
    v_lshl_add_u32 v8, v234, 2, v8
    v_lshl_add_u32 v8, v235, 8, v8
    v_bfe_u32 v234, v57, 5, 6
    v_bfe_u32 v235, v57, 2, 3
    v_and_b32 v10, 3, v57
    v_lshl_add_u32 v10, v234, 2, v10
    v_lshl_add_u32 v10, v235, 8, v10
    s_cmp_lt_u32 s3, 2
    s_cselect_b64 vcc, -1, 0
    v_lshlrev_b32 v236, 4, v230
    v_cndmask_b32 v142, v10, v8, vcc
    v_lshlrev_b32 v234, 2, v142
    v_and_b32 v235, 2047, v236
    v_lshl_add_u32 v235, v142, 11, v235
    s_mov_b32 s32, 0x3400000
    buffer_load_dwordx4 v[32:35], v235, s[8:11], s32 offen sc1
    buffer_load_dword v144, v234, s[8:11], s48 offen sc1
    buffer_load_dword v145, v234, s[8:11], s49 offen sc1
    buffer_load_dword v146, v234, s[8:11], s50 offen sc1
    v_add_u32 v236, 98304, v236
    s_lshr_b32 s32, s3, 1
    s_lshl_b32 s32, s32, 2
    s_add_u32 s32, s32, 106496
    v_mov_b32 v234, s32
    s_waitcnt vmcnt(4)
    v_mul_f32 v0, 0x3a800000, v0
    v_mul_f32 v1, 0x3a800000, v1
    v_mul_f32 v2, 0x3a800000, v2
    v_mul_f32 v3, 0x3a800000, v3
    v_mul_f32 v4, 0x3a800000, v4
    v_mul_f32 v5, 0x3a800000, v5
    v_mul_f32 v6, 0x3a800000, v6
    v_mul_f32 v7, 0x3a800000, v7
    v_fma_f32 v4, -v0, v0, v4
    v_fma_f32 v5, -v1, v1, v5
    v_fma_f32 v6, -v2, v2, v6
    v_fma_f32 v7, -v3, v3, v7
    v_max_f32 v4, 0, v4
    v_max_f32 v5, 0, v5
    v_max_f32 v6, 0, v6
    v_max_f32 v7, 0, v7
    v_cvt_pk_bf16_f32 v12, v0, v4
    v_cvt_pk_bf16_f32 v13, v1, v5
    v_cvt_pk_bf16_f32 v14, v2, v6
    v_cvt_pk_bf16_f32 v15, v3, v7
    v_lshlrev_b32 v0, 16, v12
    v_lshlrev_b32 v1, 16, v13
    v_lshlrev_b32 v2, 16, v14
    v_lshlrev_b32 v3, 16, v15
    v_and_b32 v4, 0xffff0000, v12
    v_and_b32 v5, 0xffff0000, v13
    v_and_b32 v6, 0xffff0000, v14
    v_and_b32 v7, 0xffff0000, v15
    v_add_f32 v4, 0x3727c5ac, v4
    v_add_f32 v5, 0x3727c5ac, v5
    v_add_f32 v6, 0x3727c5ac, v6
    v_add_f32 v7, 0x3727c5ac, v7
    v_cvt_pk_bf16_f32 v4, v4, v4
    v_cvt_pk_bf16_f32 v5, v5, v5
    v_cvt_pk_bf16_f32 v6, v6, v6
    v_cvt_pk_bf16_f32 v7, v7, v7
    v_lshlrev_b32 v4, 16, v4
    v_lshlrev_b32 v5, 16, v5
    v_lshlrev_b32 v6, 16, v6
    v_lshlrev_b32 v7, 16, v7
    v_sqrt_f32 v4, v4
    v_sqrt_f32 v5, v5
    v_sqrt_f32 v6, v6
    v_sqrt_f32 v7, v7
    v_cvt_pk_bf16_f32 v4, v4, v4
    v_cvt_pk_bf16_f32 v5, v5, v5
    v_cvt_pk_bf16_f32 v6, v6, v6
    v_cvt_pk_bf16_f32 v7, v7, v7
    v_lshlrev_b32 v4, 16, v4
    v_lshlrev_b32 v5, 16, v5
    v_lshlrev_b32 v6, 16, v6
    v_lshlrev_b32 v7, 16, v7
    v_rcp_f32 v4, v4
    v_rcp_f32 v5, v5
    v_rcp_f32 v6, v6
    v_rcp_f32 v7, v7
    s_waitcnt vmcnt(0)
    v_mul_f32 v144, 0x3a800000, v144
    v_mul_f32 v145, 0x3a800000, v145
    v_fma_f32 v145, -v144, v144, v145
    v_max_f32 v145, 0, v145
    v_cvt_pk_bf16_f32 v140, v144, v145
    v_lshlrev_b32 v144, 16, v140
    v_and_b32 v145, 0xffff0000, v140
    v_add_f32 v145, 0x3727c5ac, v145
    v_cvt_pk_bf16_f32 v145, v145, v145
    v_lshlrev_b32 v145, 16, v145
    v_sqrt_f32 v145, v145
    s_nop 0
    v_cvt_pk_bf16_f32 v145, v145, v145
    v_lshlrev_b32 v145, 16, v145
    v_rcp_f32 v145, v145
    s_nop 0
    v_lshlrev_b32 v64, 16, v32
    v_lshlrev_b32 v66, 16, v33
    v_lshlrev_b32 v68, 16, v34
    v_lshlrev_b32 v70, 16, v35
    v_and_b32 v65, 0xffff0000, v32
    v_and_b32 v67, 0xffff0000, v33
    v_and_b32 v69, 0xffff0000, v34
    v_and_b32 v71, 0xffff0000, v35
    v_sub_f32 v64, v64, v144
    v_sub_f32 v66, v66, v144
    v_sub_f32 v68, v68, v144
    v_sub_f32 v70, v70, v144
    v_sub_f32 v65, v65, v144
    v_sub_f32 v67, v67, v144
    v_sub_f32 v69, v69, v144
    v_sub_f32 v71, v71, v144
    v_cvt_pk_bf16_f32 v65, v64, v65
    v_cvt_pk_bf16_f32 v67, v66, v67
    v_cvt_pk_bf16_f32 v69, v68, v69
    v_cvt_pk_bf16_f32 v71, v70, v71
    v_lshlrev_b32 v64, 16, v65
    v_lshlrev_b32 v66, 16, v67
    v_lshlrev_b32 v68, 16, v69
    v_lshlrev_b32 v70, 16, v71
    v_and_b32 v65, 0xffff0000, v65
    v_and_b32 v67, 0xffff0000, v67
    v_and_b32 v69, 0xffff0000, v69
    v_and_b32 v71, 0xffff0000, v71
    v_mul_f32 v64, v64, v145
    v_mul_f32 v66, v66, v145
    v_mul_f32 v68, v68, v145
    v_mul_f32 v70, v70, v145
    v_mul_f32 v65, v65, v145
    v_mul_f32 v67, v67, v145
    v_mul_f32 v69, v69, v145
    v_mul_f32 v71, v71, v145
    v_cvt_pk_bf16_f32 v48, v64, v65
    v_cvt_pk_bf16_f32 v49, v66, v67
    v_cvt_pk_bf16_f32 v50, v68, v69
    v_cvt_pk_bf16_f32 v51, v70, v71
    ds_write_b128 v236, v[48:51]
    ds_write_b128 v236, v[32:35] offset:4096
    v_fma_f32 v143, -v144, v128, v146
    v_mul_f32 v143, v143, v145
    ds_write_b32 v234, v143
    s_waitcnt lgkmcnt(0)
kc_com:
    s_barrier
    s_cmp_ge_u32 s53, 28
    s_cbranch_scc1 kc_red
    ds_read_b64 v[96:97], v218 offset:0
    ds_read_b64 v[98:99], v218 offset:16
    ds_read_b64 v[100:101], v218 offset:64
    ds_read_b64 v[102:103], v218 offset:80
    ds_read_b64 v[104:105], v218 offset:128
    ds_read_b64 v[106:107], v218 offset:144
    ds_read_b64 v[108:109], v218 offset:192
    ds_read_b64 v[110:111], v218 offset:208
    ds_read_b64 v[112:113], v218 offset:256
    ds_read_b64 v[114:115], v218 offset:272
    ds_read_b64 v[116:117], v218 offset:320
    ds_read_b64 v[118:119], v218 offset:336
    ds_read_b64 v[120:121], v218 offset:384
    ds_read_b64 v[122:123], v218 offset:400
    s_waitcnt lgkmcnt(12)
    ds_read_b64 v[124:125], v218 offset:448
    ds_read_b64 v[126:127], v218 offset:464
    v_mfma_f32_16x16x32_bf16 v[128:131], a[0:3], v[96:99], 0
    v_mfma_f32_16x16x32_bf16 v[132:135], a[32:35], v[96:99], 0
    s_waitcnt lgkmcnt(12)
    v_mfma_f32_16x16x32_bf16 v[128:131], a[4:7], v[100:103], v[128:131]
    v_mfma_f32_16x16x32_bf16 v[132:135], a[36:39], v[100:103], v[132:135]
    s_waitcnt lgkmcnt(10)
    v_mfma_f32_16x16x32_bf16 v[128:131], a[8:11], v[104:107], v[128:131]
    v_mfma_f32_16x16x32_bf16 v[132:135], a[40:43], v[104:107], v[132:135]
    s_waitcnt lgkmcnt(8)
    v_mfma_f32_16x16x32_bf16 v[128:131], a[12:15], v[108:111], v[128:131]
    v_mfma_f32_16x16x32_bf16 v[132:135], a[44:47], v[108:111], v[132:135]
    s_waitcnt lgkmcnt(6)
    v_mfma_f32_16x16x32_bf16 v[128:131], a[16:19], v[112:115], v[128:131]
    v_mfma_f32_16x16x32_bf16 v[132:135], a[48:51], v[112:115], v[132:135]
    s_waitcnt lgkmcnt(4)
    v_mfma_f32_16x16x32_bf16 v[128:131], a[20:23], v[116:119], v[128:131]
    v_mfma_f32_16x16x32_bf16 v[132:135], a[52:55], v[116:119], v[132:135]
    s_waitcnt lgkmcnt(2)
    v_mfma_f32_16x16x32_bf16 v[128:131], a[24:27], v[120:123], v[128:131]
    v_mfma_f32_16x16x32_bf16 v[132:135], a[56:59], v[120:123], v[132:135]
    s_waitcnt lgkmcnt(0)
    v_mfma_f32_16x16x32_bf16 v[128:131], a[28:31], v[124:127], v[128:131]
    v_mfma_f32_16x16x32_bf16 v[132:135], a[60:63], v[124:127], v[132:135]
    s_nop 6
    ds_write_b128 v220, v[128:131]
    ds_write_b128 v220, v[132:135] offset:4096
    s_waitcnt lgkmcnt(0)
    s_barrier
    ds_read_b128 v[32:35], v221 offset:0
    ds_read_b128 v[48:51], v221 offset:4096
    ds_read_b128 v[36:39], v221 offset:1024
    ds_read_b128 v[52:55], v221 offset:5120
    ds_read_b128 v[40:43], v221 offset:2048
    ds_read_b128 v[56:59], v221 offset:6144
    ds_read_b128 v[44:47], v221 offset:3072
    ds_read_b128 v[60:63], v221 offset:7168
    s_waitcnt lgkmcnt(0)
    v_add_f32 v32, v32, v36
    v_add_f32 v33, v33, v37
    v_add_f32 v34, v34, v38
    v_add_f32 v35, v35, v39
    v_add_f32 v40, v40, v44
    v_add_f32 v41, v41, v45
    v_add_f32 v42, v42, v46
    v_add_f32 v43, v43, v47
    v_add_f32 v48, v48, v52
    v_add_f32 v49, v49, v53
    v_add_f32 v50, v50, v54
    v_add_f32 v51, v51, v55
    v_add_f32 v56, v56, v60
    v_add_f32 v57, v57, v61
    v_add_f32 v58, v58, v62
    v_add_f32 v59, v59, v63
    v_add_f32 v32, v32, v40
    v_add_f32 v33, v33, v41
    v_add_f32 v34, v34, v42
    v_add_f32 v35, v35, v43
    v_add_f32 v48, v48, v56
    v_add_f32 v49, v49, v57
    v_add_f32 v50, v50, v58
    v_add_f32 v51, v51, v59
    v_cvt_pk_bf16_f32 v48, v32, v48
    v_cvt_pk_bf16_f32 v49, v33, v49
    v_cvt_pk_bf16_f32 v50, v34, v50
    v_cvt_pk_bf16_f32 v51, v35, v51
    v_lshlrev_b32 v32, 16, v48
    v_lshlrev_b32 v33, 16, v49
    v_lshlrev_b32 v34, 16, v50
    v_lshlrev_b32 v35, 16, v51
    v_and_b32 v48, 0xffff0000, v48
    v_and_b32 v49, 0xffff0000, v49
    v_and_b32 v50, 0xffff0000, v50
    v_and_b32 v51, 0xffff0000, v51
    v_mul_f32 v136, 0xbfb8aa3b, v32
    v_mul_f32 v137, 0xbfb8aa3b, v33
    v_mul_f32 v138, 0xbfb8aa3b, v34
    v_mul_f32 v139, 0xbfb8aa3b, v35
    v_exp_f32 v136, v136
    v_exp_f32 v137, v137
    v_exp_f32 v138, v138
    v_exp_f32 v139, v139
    v_add_f32 v136, 1.0, v136
    v_add_f32 v137, 1.0, v137
    v_add_f32 v138, 1.0, v138
    v_add_f32 v139, 1.0, v139
    v_rcp_f32 v136, v136
    v_rcp_f32 v137, v137
    v_rcp_f32 v138, v138
    v_rcp_f32 v139, v139
    v_mul_f32 v32, v32, v136
    v_mul_f32 v33, v33, v137
    v_mul_f32 v34, v34, v138
    v_mul_f32 v35, v35, v139
    v_cvt_pk_bf16_f32 v32, v32, v32
    v_cvt_pk_bf16_f32 v33, v33, v33
    v_cvt_pk_bf16_f32 v34, v34, v34
    v_cvt_pk_bf16_f32 v35, v35, v35
    v_lshlrev_b32 v32, 16, v32
    v_lshlrev_b32 v33, 16, v33
    v_lshlrev_b32 v34, 16, v34
    v_lshlrev_b32 v35, 16, v35
    v_mul_f32 v32, v32, v48
    v_mul_f32 v33, v33, v49
    v_mul_f32 v34, v34, v50
    v_mul_f32 v35, v35, v51
    v_cvt_pk_bf16_f32 v128, v32, v33
    v_cvt_pk_bf16_f32 v129, v34, v35
    s_nop 1
    v_mfma_f32_16x16x16_bf16 v[64:67], a[64:65], v[128:129], 0
    v_mfma_f32_16x16x16_bf16 v[68:71], a[66:67], v[128:129], 0
    v_mfma_f32_16x16x16_bf16 v[72:75], a[68:69], v[128:129], 0
    v_mfma_f32_16x16x16_bf16 v[76:79], a[70:71], v[128:129], 0
    v_mfma_f32_16x16x16_bf16 v[80:83], a[72:73], v[128:129], 0
    v_mfma_f32_16x16x16_bf16 v[84:87], a[74:75], v[128:129], 0
    v_mfma_f32_16x16x16_bf16 v[88:91], a[76:77], v[128:129], 0
    v_mfma_f32_16x16x16_bf16 v[92:95], a[78:79], v[128:129], 0
    v_mfma_f32_16x16x16_bf16 v[96:99], a[80:81], v[128:129], 0
    ds_write_b128 v222, v[64:67] offset:0
    v_mfma_f32_16x16x16_bf16 v[100:103], a[82:83], v[128:129], 0
    ds_write_b128 v222, v[68:71] offset:64
    v_mfma_f32_16x16x16_bf16 v[104:107], a[84:85], v[128:129], 0
    ds_write_b128 v222, v[72:75] offset:128
    v_mfma_f32_16x16x16_bf16 v[108:111], a[86:87], v[128:129], 0
    ds_write_b128 v222, v[76:79] offset:192
    v_mfma_f32_16x16x16_bf16 v[112:115], a[88:89], v[128:129], 0
    ds_write_b128 v222, v[80:83] offset:256
    v_mfma_f32_16x16x16_bf16 v[116:119], a[90:91], v[128:129], 0
    ds_write_b128 v222, v[84:87] offset:320
    v_mfma_f32_16x16x16_bf16 v[120:123], a[92:93], v[128:129], 0
    ds_write_b128 v222, v[88:91] offset:384
    v_mfma_f32_16x16x16_bf16 v[124:127], a[94:95], v[128:129], 0
    ds_write_b128 v222, v[92:95] offset:448
    s_waitcnt lgkmcnt(4)
    ds_write_b128 v222, v[96:99] offset:512
    ds_write_b128 v222, v[100:103] offset:576
    ds_write_b128 v222, v[104:107] offset:640
    ds_write_b128 v222, v[108:111] offset:704
    ds_write_b128 v222, v[112:115] offset:768
    ds_write_b128 v222, v[116:119] offset:832
    ds_write_b128 v222, v[120:123] offset:896
    ds_write_b128 v222, v[124:127] offset:960
    s_lshl_b32 s32, s54, 13
    s_lshl_b32 s33, s3, 10
    s_add_u32 s32, s32, s33
    s_add_u32 s32, s32, 0x3900000
    s_add_u32 s33, s32, 4096
    s_waitcnt lgkmcnt(0)
    ds_read_b128 v[32:35], v223
    ds_read_b128 v[36:39], v223 offset:1024
    s_waitcnt lgkmcnt(1)
    buffer_store_dwordx4 v[32:35], v228, s[8:11], s32 offen sc1
    s_waitcnt lgkmcnt(0)
    buffer_store_dwordx4 v[36:39], v228, s[8:11], s33 offen sc1
    v_lshlrev_b32 v144, 16, v16
    v_lshlrev_b32 v148, 16, v17
    v_lshlrev_b32 v152, 16, v18
    v_lshlrev_b32 v156, 16, v19
    v_and_b32 v145, 0xffff0000, v16
    v_and_b32 v149, 0xffff0000, v17
    v_and_b32 v153, 0xffff0000, v18
    v_and_b32 v157, 0xffff0000, v19
    v_sub_f32 v144, v144, v0
    v_sub_f32 v148, v148, v0
    v_sub_f32 v152, v152, v0
    v_sub_f32 v156, v156, v0
    v_sub_f32 v145, v145, v0
    v_sub_f32 v149, v149, v0
    v_sub_f32 v153, v153, v0
    v_sub_f32 v157, v157, v0
    v_cvt_pk_bf16_f32 v145, v144, v145
    v_cvt_pk_bf16_f32 v149, v148, v149
    v_cvt_pk_bf16_f32 v153, v152, v153
    v_cvt_pk_bf16_f32 v157, v156, v157
    v_lshlrev_b32 v144, 16, v145
    v_lshlrev_b32 v148, 16, v149
    v_lshlrev_b32 v152, 16, v153
    v_lshlrev_b32 v156, 16, v157
    v_and_b32 v145, 0xffff0000, v145
    v_and_b32 v149, 0xffff0000, v149
    v_and_b32 v153, 0xffff0000, v153
    v_and_b32 v157, 0xffff0000, v157
    v_mul_f32 v144, v144, v4
    v_mul_f32 v148, v148, v4
    v_mul_f32 v152, v152, v4
    v_mul_f32 v156, v156, v4
    v_mul_f32 v145, v145, v4
    v_mul_f32 v149, v149, v4
    v_mul_f32 v153, v153, v4
    v_mul_f32 v157, v157, v4
    v_cvt_pk_bf16_f32 v146, v144, v145
    v_cvt_pk_bf16_f32 v150, v148, v149
    v_cvt_pk_bf16_f32 v154, v152, v153
    v_cvt_pk_bf16_f32 v158, v156, v157
    v_lshlrev_b32 v144, 16, v146
    v_lshlrev_b32 v148, 16, v150
    v_lshlrev_b32 v152, 16, v154
    v_lshlrev_b32 v156, 16, v158
    v_and_b32 v145, 0xffff0000, v146
    v_and_b32 v149, 0xffff0000, v150
    v_and_b32 v153, 0xffff0000, v154
    v_and_b32 v157, 0xffff0000, v158
    v_lshlrev_b32 v146, 16, v16
    v_lshlrev_b32 v150, 16, v17
    v_lshlrev_b32 v154, 16, v18
    v_lshlrev_b32 v158, 16, v19
    v_and_b32 v147, 0xffff0000, v16
    v_and_b32 v151, 0xffff0000, v17
    v_and_b32 v155, 0xffff0000, v18
    v_and_b32 v159, 0xffff0000, v19
    v_pk_add_f32 v[144:145], v[144:145], v[146:147]
    v_pk_add_f32 v[148:149], v[148:149], v[150:151]
    v_pk_add_f32 v[152:153], v[152:153], v[154:155]
    v_pk_add_f32 v[156:157], v[156:157], v[158:159]
    v_cvt_pk_bf16_f32 v16, v144, v145
    v_cvt_pk_bf16_f32 v17, v148, v149
    v_cvt_pk_bf16_f32 v18, v152, v153
    v_cvt_pk_bf16_f32 v19, v156, v157
    v_add_u32 v160, 0, v242
    v_cmp_eq_u32 vcc, v160, v8
    v_cmp_eq_u32 s[60:61], v160, v10
    v_mov_b32 v161, 0x40000000
    s_or_b64 vcc, vcc, s[60:61]
    v_cndmask_b32 v12, v229, v161, vcc
    v_lshlrev_b32 v144, 16, v20
    v_lshlrev_b32 v148, 16, v21
    v_lshlrev_b32 v152, 16, v22
    v_lshlrev_b32 v156, 16, v23
    v_and_b32 v145, 0xffff0000, v20
    v_and_b32 v149, 0xffff0000, v21
    v_and_b32 v153, 0xffff0000, v22
    v_and_b32 v157, 0xffff0000, v23
    v_sub_f32 v144, v144, v1
    v_sub_f32 v148, v148, v1
    v_sub_f32 v152, v152, v1
    v_sub_f32 v156, v156, v1
    v_sub_f32 v145, v145, v1
    v_sub_f32 v149, v149, v1
    v_sub_f32 v153, v153, v1
    v_sub_f32 v157, v157, v1
    v_cvt_pk_bf16_f32 v145, v144, v145
    v_cvt_pk_bf16_f32 v149, v148, v149
    v_cvt_pk_bf16_f32 v153, v152, v153
    v_cvt_pk_bf16_f32 v157, v156, v157
    v_lshlrev_b32 v144, 16, v145
    v_lshlrev_b32 v148, 16, v149
    v_lshlrev_b32 v152, 16, v153
    v_lshlrev_b32 v156, 16, v157
    v_and_b32 v145, 0xffff0000, v145
    v_and_b32 v149, 0xffff0000, v149
    v_and_b32 v153, 0xffff0000, v153
    v_and_b32 v157, 0xffff0000, v157
    v_mul_f32 v144, v144, v5
    v_mul_f32 v148, v148, v5
    v_mul_f32 v152, v152, v5
    v_mul_f32 v156, v156, v5
    v_mul_f32 v145, v145, v5
    v_mul_f32 v149, v149, v5
    v_mul_f32 v153, v153, v5
    v_mul_f32 v157, v157, v5
    v_cvt_pk_bf16_f32 v146, v144, v145
    v_cvt_pk_bf16_f32 v150, v148, v149
    v_cvt_pk_bf16_f32 v154, v152, v153
    v_cvt_pk_bf16_f32 v158, v156, v157
    v_lshlrev_b32 v144, 16, v146
    v_lshlrev_b32 v148, 16, v150
    v_lshlrev_b32 v152, 16, v154
    v_lshlrev_b32 v156, 16, v158
    v_and_b32 v145, 0xffff0000, v146
    v_and_b32 v149, 0xffff0000, v150
    v_and_b32 v153, 0xffff0000, v154
    v_and_b32 v157, 0xffff0000, v158
    v_lshlrev_b32 v146, 16, v20
    v_lshlrev_b32 v150, 16, v21
    v_lshlrev_b32 v154, 16, v22
    v_lshlrev_b32 v158, 16, v23
    v_and_b32 v147, 0xffff0000, v20
    v_and_b32 v151, 0xffff0000, v21
    v_and_b32 v155, 0xffff0000, v22
    v_and_b32 v159, 0xffff0000, v23
    v_pk_add_f32 v[144:145], v[144:145], v[146:147]
    v_pk_add_f32 v[148:149], v[148:149], v[150:151]
    v_pk_add_f32 v[152:153], v[152:153], v[154:155]
    v_pk_add_f32 v[156:157], v[156:157], v[158:159]
    v_cvt_pk_bf16_f32 v20, v144, v145
    v_cvt_pk_bf16_f32 v21, v148, v149
    v_cvt_pk_bf16_f32 v22, v152, v153
    v_cvt_pk_bf16_f32 v23, v156, v157
    v_add_u32 v160, 8, v242
    v_cmp_eq_u32 vcc, v160, v8
    v_cmp_eq_u32 s[60:61], v160, v10
    v_mov_b32 v161, 0x40000000
    s_or_b64 vcc, vcc, s[60:61]
    v_cndmask_b32 v13, v229, v161, vcc
    s_waitcnt vmcnt(0)
    s_barrier
    s_cmp_lg_u32 s3, 0
    s_cbranch_scc1 kc_a2
    s_lshl_b32 s32, s52, 7
    s_add_u32 s32, s32, 0x38a0800
    v_mov_b32 v235, 1
    buffer_atomic_add v235, v243, s[8:11], s32 offen sc0 sc1
    v_lshlrev_b32 v234, 7, v237
    v_cmp_gt_u32 vcc, 8, v237
    v_mov_b32 v236, 0x40000000
    s_mov_b32 s34, 0x38a0c00
    v_cndmask_b32 v234, v236, v234, vcc
    s_waitcnt vmcnt(0)
    v_readfirstlane_b32 s36, v235
    s_cmp_lg_u32 s36, 27
    s_cbranch_scc1 kc_a2
    buffer_atomic_add v233, v234, s[8:11], s34 offen sc1
kc_a2:
    v_lshlrev_b32 v144, 16, v24
    v_lshlrev_b32 v148, 16, v25
    v_lshlrev_b32 v152, 16, v26
    v_lshlrev_b32 v156, 16, v27
    v_and_b32 v145, 0xffff0000, v24
    v_and_b32 v149, 0xffff0000, v25
    v_and_b32 v153, 0xffff0000, v26
    v_and_b32 v157, 0xffff0000, v27
    v_sub_f32 v144, v144, v2
    v_sub_f32 v148, v148, v2
    v_sub_f32 v152, v152, v2
    v_sub_f32 v156, v156, v2
    v_sub_f32 v145, v145, v2
    v_sub_f32 v149, v149, v2
    v_sub_f32 v153, v153, v2
    v_sub_f32 v157, v157, v2
    v_cvt_pk_bf16_f32 v145, v144, v145
    v_cvt_pk_bf16_f32 v149, v148, v149
    v_cvt_pk_bf16_f32 v153, v152, v153
    v_cvt_pk_bf16_f32 v157, v156, v157
    v_lshlrev_b32 v144, 16, v145
    v_lshlrev_b32 v148, 16, v149
    v_lshlrev_b32 v152, 16, v153
    v_lshlrev_b32 v156, 16, v157
    v_and_b32 v145, 0xffff0000, v145
    v_and_b32 v149, 0xffff0000, v149
    v_and_b32 v153, 0xffff0000, v153
    v_and_b32 v157, 0xffff0000, v157
    v_mul_f32 v144, v144, v6
    v_mul_f32 v148, v148, v6
    v_mul_f32 v152, v152, v6
    v_mul_f32 v156, v156, v6
    v_mul_f32 v145, v145, v6
    v_mul_f32 v149, v149, v6
    v_mul_f32 v153, v153, v6
    v_mul_f32 v157, v157, v6
    v_cvt_pk_bf16_f32 v146, v144, v145
    v_cvt_pk_bf16_f32 v150, v148, v149
    v_cvt_pk_bf16_f32 v154, v152, v153
    v_cvt_pk_bf16_f32 v158, v156, v157
    v_lshlrev_b32 v144, 16, v146
    v_lshlrev_b32 v148, 16, v150
    v_lshlrev_b32 v152, 16, v154
    v_lshlrev_b32 v156, 16, v158
    v_and_b32 v145, 0xffff0000, v146
    v_and_b32 v149, 0xffff0000, v150
    v_and_b32 v153, 0xffff0000, v154
    v_and_b32 v157, 0xffff0000, v158
    v_lshlrev_b32 v146, 16, v24
    v_lshlrev_b32 v150, 16, v25
    v_lshlrev_b32 v154, 16, v26
    v_lshlrev_b32 v158, 16, v27
    v_and_b32 v147, 0xffff0000, v24
    v_and_b32 v151, 0xffff0000, v25
    v_and_b32 v155, 0xffff0000, v26
    v_and_b32 v159, 0xffff0000, v27
    v_pk_add_f32 v[144:145], v[144:145], v[146:147]
    v_pk_add_f32 v[148:149], v[148:149], v[150:151]
    v_pk_add_f32 v[152:153], v[152:153], v[154:155]
    v_pk_add_f32 v[156:157], v[156:157], v[158:159]
    v_cvt_pk_bf16_f32 v24, v144, v145
    v_cvt_pk_bf16_f32 v25, v148, v149
    v_cvt_pk_bf16_f32 v26, v152, v153
    v_cvt_pk_bf16_f32 v27, v156, v157
    v_add_u32 v160, 16, v242
    v_cmp_eq_u32 vcc, v160, v8
    v_cmp_eq_u32 s[60:61], v160, v10
    v_mov_b32 v161, 0x40000000
    s_or_b64 vcc, vcc, s[60:61]
    v_cndmask_b32 v14, v229, v161, vcc
    v_lshlrev_b32 v144, 16, v28
    v_lshlrev_b32 v148, 16, v29
    v_lshlrev_b32 v152, 16, v30
    v_lshlrev_b32 v156, 16, v31
    v_and_b32 v145, 0xffff0000, v28
    v_and_b32 v149, 0xffff0000, v29
    v_and_b32 v153, 0xffff0000, v30
    v_and_b32 v157, 0xffff0000, v31
    v_sub_f32 v144, v144, v3
    v_sub_f32 v148, v148, v3
    v_sub_f32 v152, v152, v3
    v_sub_f32 v156, v156, v3
    v_sub_f32 v145, v145, v3
    v_sub_f32 v149, v149, v3
    v_sub_f32 v153, v153, v3
    v_sub_f32 v157, v157, v3
    v_cvt_pk_bf16_f32 v145, v144, v145
    v_cvt_pk_bf16_f32 v149, v148, v149
    v_cvt_pk_bf16_f32 v153, v152, v153
    v_cvt_pk_bf16_f32 v157, v156, v157
    v_lshlrev_b32 v144, 16, v145
    v_lshlrev_b32 v148, 16, v149
    v_lshlrev_b32 v152, 16, v153
    v_lshlrev_b32 v156, 16, v157
    v_and_b32 v145, 0xffff0000, v145
    v_and_b32 v149, 0xffff0000, v149
    v_and_b32 v153, 0xffff0000, v153
    v_and_b32 v157, 0xffff0000, v157
    v_mul_f32 v144, v144, v7
    v_mul_f32 v148, v148, v7
    v_mul_f32 v152, v152, v7
    v_mul_f32 v156, v156, v7
    v_mul_f32 v145, v145, v7
    v_mul_f32 v149, v149, v7
    v_mul_f32 v153, v153, v7
    v_mul_f32 v157, v157, v7
    v_cvt_pk_bf16_f32 v146, v144, v145
    v_cvt_pk_bf16_f32 v150, v148, v149
    v_cvt_pk_bf16_f32 v154, v152, v153
    v_cvt_pk_bf16_f32 v158, v156, v157
    v_lshlrev_b32 v144, 16, v146
    v_lshlrev_b32 v148, 16, v150
    v_lshlrev_b32 v152, 16, v154
    v_lshlrev_b32 v156, 16, v158
    v_and_b32 v145, 0xffff0000, v146
    v_and_b32 v149, 0xffff0000, v150
    v_and_b32 v153, 0xffff0000, v154
    v_and_b32 v157, 0xffff0000, v158
    v_lshlrev_b32 v146, 16, v28
    v_lshlrev_b32 v150, 16, v29
    v_lshlrev_b32 v154, 16, v30
    v_lshlrev_b32 v158, 16, v31
    v_and_b32 v147, 0xffff0000, v28
    v_and_b32 v151, 0xffff0000, v29
    v_and_b32 v155, 0xffff0000, v30
    v_and_b32 v159, 0xffff0000, v31
    v_pk_add_f32 v[144:145], v[144:145], v[146:147]
    v_pk_add_f32 v[148:149], v[148:149], v[150:151]
    v_pk_add_f32 v[152:153], v[152:153], v[154:155]
    v_pk_add_f32 v[156:157], v[156:157], v[158:159]
    v_cvt_pk_bf16_f32 v28, v144, v145
    v_cvt_pk_bf16_f32 v29, v148, v149
    v_cvt_pk_bf16_f32 v30, v152, v153
    v_cvt_pk_bf16_f32 v31, v156, v157
    v_add_u32 v160, 24, v242
    v_cmp_eq_u32 vcc, v160, v8
    v_cmp_eq_u32 s[60:61], v160, v10
    v_mov_b32 v161, 0x40000000
    s_or_b64 vcc, vcc, s[60:61]
    v_cndmask_b32 v15, v229, v161, vcc
    s_mov_b32 s32, 0
    buffer_store_dwordx4 v[16:19], v12, s[28:31], s32 offen
    s_mov_b32 s32, 16384
    buffer_store_dwordx4 v[20:23], v13, s[28:31], s32 offen
    s_mov_b32 s32, 32768
    buffer_store_dwordx4 v[24:27], v14, s[28:31], s32 offen
    s_mov_b32 s32, 49152
    buffer_store_dwordx4 v[28:31], v15, s[28:31], s32 offen
    s_branch kc_fin
kc_red:
    v_lshlrev_b32 v144, 16, v16
    v_lshlrev_b32 v148, 16, v17
    v_lshlrev_b32 v152, 16, v18
    v_lshlrev_b32 v156, 16, v19
    v_and_b32 v145, 0xffff0000, v16
    v_and_b32 v149, 0xffff0000, v17
    v_and_b32 v153, 0xffff0000, v18
    v_and_b32 v157, 0xffff0000, v19
    v_sub_f32 v144, v144, v0
    v_sub_f32 v148, v148, v0
    v_sub_f32 v152, v152, v0
    v_sub_f32 v156, v156, v0
    v_sub_f32 v145, v145, v0
    v_sub_f32 v149, v149, v0
    v_sub_f32 v153, v153, v0
    v_sub_f32 v157, v157, v0
    v_cvt_pk_bf16_f32 v145, v144, v145
    v_cvt_pk_bf16_f32 v149, v148, v149
    v_cvt_pk_bf16_f32 v153, v152, v153
    v_cvt_pk_bf16_f32 v157, v156, v157
    v_lshlrev_b32 v144, 16, v145
    v_lshlrev_b32 v148, 16, v149
    v_lshlrev_b32 v152, 16, v153
    v_lshlrev_b32 v156, 16, v157
    v_and_b32 v145, 0xffff0000, v145
    v_and_b32 v149, 0xffff0000, v149
    v_and_b32 v153, 0xffff0000, v153
    v_and_b32 v157, 0xffff0000, v157
    v_mul_f32 v144, v144, v4
    v_mul_f32 v148, v148, v4
    v_mul_f32 v152, v152, v4
    v_mul_f32 v156, v156, v4
    v_mul_f32 v145, v145, v4
    v_mul_f32 v149, v149, v4
    v_mul_f32 v153, v153, v4
    v_mul_f32 v157, v157, v4
    v_cvt_pk_bf16_f32 v146, v144, v145
    v_cvt_pk_bf16_f32 v150, v148, v149
    v_cvt_pk_bf16_f32 v154, v152, v153
    v_cvt_pk_bf16_f32 v158, v156, v157
    v_lshlrev_b32 v144, 16, v146
    v_lshlrev_b32 v148, 16, v150
    v_lshlrev_b32 v152, 16, v154
    v_lshlrev_b32 v156, 16, v158
    v_and_b32 v145, 0xffff0000, v146
    v_and_b32 v149, 0xffff0000, v150
    v_and_b32 v153, 0xffff0000, v154
    v_and_b32 v157, 0xffff0000, v158
    v_lshlrev_b32 v146, 16, v16
    v_lshlrev_b32 v150, 16, v17
    v_lshlrev_b32 v154, 16, v18
    v_lshlrev_b32 v158, 16, v19
    v_and_b32 v147, 0xffff0000, v16
    v_and_b32 v151, 0xffff0000, v17
    v_and_b32 v155, 0xffff0000, v18
    v_and_b32 v159, 0xffff0000, v19
    v_pk_add_f32 v[144:145], v[144:145], v[146:147]
    v_pk_add_f32 v[148:149], v[148:149], v[150:151]
    v_pk_add_f32 v[152:153], v[152:153], v[154:155]
    v_pk_add_f32 v[156:157], v[156:157], v[158:159]
    v_cvt_pk_bf16_f32 v16, v144, v145
    v_cvt_pk_bf16_f32 v17, v148, v149
    v_cvt_pk_bf16_f32 v18, v152, v153
    v_cvt_pk_bf16_f32 v19, v156, v157
    v_add_u32 v160, 0, v242
    v_cmp_eq_u32 vcc, v160, v8
    v_cmp_eq_u32 s[60:61], v160, v10
    v_mov_b32 v161, 0x40000000
    s_or_b64 vcc, vcc, s[60:61]
    v_cndmask_b32 v12, v229, v161, vcc
    v_lshlrev_b32 v144, 16, v20
    v_lshlrev_b32 v148, 16, v21
    v_lshlrev_b32 v152, 16, v22
    v_lshlrev_b32 v156, 16, v23
    v_and_b32 v145, 0xffff0000, v20
    v_and_b32 v149, 0xffff0000, v21
    v_and_b32 v153, 0xffff0000, v22
    v_and_b32 v157, 0xffff0000, v23
    v_sub_f32 v144, v144, v1
    v_sub_f32 v148, v148, v1
    v_sub_f32 v152, v152, v1
    v_sub_f32 v156, v156, v1
    v_sub_f32 v145, v145, v1
    v_sub_f32 v149, v149, v1
    v_sub_f32 v153, v153, v1
    v_sub_f32 v157, v157, v1
    v_cvt_pk_bf16_f32 v145, v144, v145
    v_cvt_pk_bf16_f32 v149, v148, v149
    v_cvt_pk_bf16_f32 v153, v152, v153
    v_cvt_pk_bf16_f32 v157, v156, v157
    v_lshlrev_b32 v144, 16, v145
    v_lshlrev_b32 v148, 16, v149
    v_lshlrev_b32 v152, 16, v153
    v_lshlrev_b32 v156, 16, v157
    v_and_b32 v145, 0xffff0000, v145
    v_and_b32 v149, 0xffff0000, v149
    v_and_b32 v153, 0xffff0000, v153
    v_and_b32 v157, 0xffff0000, v157
    v_mul_f32 v144, v144, v5
    v_mul_f32 v148, v148, v5
    v_mul_f32 v152, v152, v5
    v_mul_f32 v156, v156, v5
    v_mul_f32 v145, v145, v5
    v_mul_f32 v149, v149, v5
    v_mul_f32 v153, v153, v5
    v_mul_f32 v157, v157, v5
    v_cvt_pk_bf16_f32 v146, v144, v145
    v_cvt_pk_bf16_f32 v150, v148, v149
    v_cvt_pk_bf16_f32 v154, v152, v153
    v_cvt_pk_bf16_f32 v158, v156, v157
    v_lshlrev_b32 v144, 16, v146
    v_lshlrev_b32 v148, 16, v150
    v_lshlrev_b32 v152, 16, v154
    v_lshlrev_b32 v156, 16, v158
    v_and_b32 v145, 0xffff0000, v146
    v_and_b32 v149, 0xffff0000, v150
    v_and_b32 v153, 0xffff0000, v154
    v_and_b32 v157, 0xffff0000, v158
    v_lshlrev_b32 v146, 16, v20
    v_lshlrev_b32 v150, 16, v21
    v_lshlrev_b32 v154, 16, v22
    v_lshlrev_b32 v158, 16, v23
    v_and_b32 v147, 0xffff0000, v20
    v_and_b32 v151, 0xffff0000, v21
    v_and_b32 v155, 0xffff0000, v22
    v_and_b32 v159, 0xffff0000, v23
    v_pk_add_f32 v[144:145], v[144:145], v[146:147]
    v_pk_add_f32 v[148:149], v[148:149], v[150:151]
    v_pk_add_f32 v[152:153], v[152:153], v[154:155]
    v_pk_add_f32 v[156:157], v[156:157], v[158:159]
    v_cvt_pk_bf16_f32 v20, v144, v145
    v_cvt_pk_bf16_f32 v21, v148, v149
    v_cvt_pk_bf16_f32 v22, v152, v153
    v_cvt_pk_bf16_f32 v23, v156, v157
    v_add_u32 v160, 8, v242
    v_cmp_eq_u32 vcc, v160, v8
    v_cmp_eq_u32 s[60:61], v160, v10
    v_mov_b32 v161, 0x40000000
    s_or_b64 vcc, vcc, s[60:61]
    v_cndmask_b32 v13, v229, v161, vcc
    v_lshlrev_b32 v144, 16, v24
    v_lshlrev_b32 v148, 16, v25
    v_lshlrev_b32 v152, 16, v26
    v_lshlrev_b32 v156, 16, v27
    v_and_b32 v145, 0xffff0000, v24
    v_and_b32 v149, 0xffff0000, v25
    v_and_b32 v153, 0xffff0000, v26
    v_and_b32 v157, 0xffff0000, v27
    v_sub_f32 v144, v144, v2
    v_sub_f32 v148, v148, v2
    v_sub_f32 v152, v152, v2
    v_sub_f32 v156, v156, v2
    v_sub_f32 v145, v145, v2
    v_sub_f32 v149, v149, v2
    v_sub_f32 v153, v153, v2
    v_sub_f32 v157, v157, v2
    v_cvt_pk_bf16_f32 v145, v144, v145
    v_cvt_pk_bf16_f32 v149, v148, v149
    v_cvt_pk_bf16_f32 v153, v152, v153
    v_cvt_pk_bf16_f32 v157, v156, v157
    v_lshlrev_b32 v144, 16, v145
    v_lshlrev_b32 v148, 16, v149
    v_lshlrev_b32 v152, 16, v153
    v_lshlrev_b32 v156, 16, v157
    v_and_b32 v145, 0xffff0000, v145
    v_and_b32 v149, 0xffff0000, v149
    v_and_b32 v153, 0xffff0000, v153
    v_and_b32 v157, 0xffff0000, v157
    v_mul_f32 v144, v144, v6
    v_mul_f32 v148, v148, v6
    v_mul_f32 v152, v152, v6
    v_mul_f32 v156, v156, v6
    v_mul_f32 v145, v145, v6
    v_mul_f32 v149, v149, v6
    v_mul_f32 v153, v153, v6
    v_mul_f32 v157, v157, v6
    v_cvt_pk_bf16_f32 v146, v144, v145
    v_cvt_pk_bf16_f32 v150, v148, v149
    v_cvt_pk_bf16_f32 v154, v152, v153
    v_cvt_pk_bf16_f32 v158, v156, v157
    v_lshlrev_b32 v144, 16, v146
    v_lshlrev_b32 v148, 16, v150
    v_lshlrev_b32 v152, 16, v154
    v_lshlrev_b32 v156, 16, v158
    v_and_b32 v145, 0xffff0000, v146
    v_and_b32 v149, 0xffff0000, v150
    v_and_b32 v153, 0xffff0000, v154
    v_and_b32 v157, 0xffff0000, v158
    v_lshlrev_b32 v146, 16, v24
    v_lshlrev_b32 v150, 16, v25
    v_lshlrev_b32 v154, 16, v26
    v_lshlrev_b32 v158, 16, v27
    v_and_b32 v147, 0xffff0000, v24
    v_and_b32 v151, 0xffff0000, v25
    v_and_b32 v155, 0xffff0000, v26
    v_and_b32 v159, 0xffff0000, v27
    v_pk_add_f32 v[144:145], v[144:145], v[146:147]
    v_pk_add_f32 v[148:149], v[148:149], v[150:151]
    v_pk_add_f32 v[152:153], v[152:153], v[154:155]
    v_pk_add_f32 v[156:157], v[156:157], v[158:159]
    v_cvt_pk_bf16_f32 v24, v144, v145
    v_cvt_pk_bf16_f32 v25, v148, v149
    v_cvt_pk_bf16_f32 v26, v152, v153
    v_cvt_pk_bf16_f32 v27, v156, v157
    v_add_u32 v160, 16, v242
    v_cmp_eq_u32 vcc, v160, v8
    v_cmp_eq_u32 s[60:61], v160, v10
    v_mov_b32 v161, 0x40000000
    s_or_b64 vcc, vcc, s[60:61]
    v_cndmask_b32 v14, v229, v161, vcc
    v_lshlrev_b32 v144, 16, v28
    v_lshlrev_b32 v148, 16, v29
    v_lshlrev_b32 v152, 16, v30
    v_lshlrev_b32 v156, 16, v31
    v_and_b32 v145, 0xffff0000, v28
    v_and_b32 v149, 0xffff0000, v29
    v_and_b32 v153, 0xffff0000, v30
    v_and_b32 v157, 0xffff0000, v31
    v_sub_f32 v144, v144, v3
    v_sub_f32 v148, v148, v3
    v_sub_f32 v152, v152, v3
    v_sub_f32 v156, v156, v3
    v_sub_f32 v145, v145, v3
    v_sub_f32 v149, v149, v3
    v_sub_f32 v153, v153, v3
    v_sub_f32 v157, v157, v3
    v_cvt_pk_bf16_f32 v145, v144, v145
    v_cvt_pk_bf16_f32 v149, v148, v149
    v_cvt_pk_bf16_f32 v153, v152, v153
    v_cvt_pk_bf16_f32 v157, v156, v157
    v_lshlrev_b32 v144, 16, v145
    v_lshlrev_b32 v148, 16, v149
    v_lshlrev_b32 v152, 16, v153
    v_lshlrev_b32 v156, 16, v157
    v_and_b32 v145, 0xffff0000, v145
    v_and_b32 v149, 0xffff0000, v149
    v_and_b32 v153, 0xffff0000, v153
    v_and_b32 v157, 0xffff0000, v157
    v_mul_f32 v144, v144, v7
    v_mul_f32 v148, v148, v7
    v_mul_f32 v152, v152, v7
    v_mul_f32 v156, v156, v7
    v_mul_f32 v145, v145, v7
    v_mul_f32 v149, v149, v7
    v_mul_f32 v153, v153, v7
    v_mul_f32 v157, v157, v7
    v_cvt_pk_bf16_f32 v146, v144, v145
    v_cvt_pk_bf16_f32 v150, v148, v149
    v_cvt_pk_bf16_f32 v154, v152, v153
    v_cvt_pk_bf16_f32 v158, v156, v157
    v_lshlrev_b32 v144, 16, v146
    v_lshlrev_b32 v148, 16, v150
    v_lshlrev_b32 v152, 16, v154
    v_lshlrev_b32 v156, 16, v158
    v_and_b32 v145, 0xffff0000, v146
    v_and_b32 v149, 0xffff0000, v150
    v_and_b32 v153, 0xffff0000, v154
    v_and_b32 v157, 0xffff0000, v158
    v_lshlrev_b32 v146, 16, v28
    v_lshlrev_b32 v150, 16, v29
    v_lshlrev_b32 v154, 16, v30
    v_lshlrev_b32 v158, 16, v31
    v_and_b32 v147, 0xffff0000, v28
    v_and_b32 v151, 0xffff0000, v29
    v_and_b32 v155, 0xffff0000, v30
    v_and_b32 v159, 0xffff0000, v31
    v_pk_add_f32 v[144:145], v[144:145], v[146:147]
    v_pk_add_f32 v[148:149], v[148:149], v[150:151]
    v_pk_add_f32 v[152:153], v[152:153], v[154:155]
    v_pk_add_f32 v[156:157], v[156:157], v[158:159]
    v_cvt_pk_bf16_f32 v28, v144, v145
    v_cvt_pk_bf16_f32 v29, v148, v149
    v_cvt_pk_bf16_f32 v30, v152, v153
    v_cvt_pk_bf16_f32 v31, v156, v157
    v_add_u32 v160, 24, v242
    v_cmp_eq_u32 vcc, v160, v8
    v_cmp_eq_u32 s[60:61], v160, v10
    v_mov_b32 v161, 0x40000000
    s_or_b64 vcc, vcc, s[60:61]
    v_cndmask_b32 v15, v229, v161, vcc
    s_mov_b32 s32, 0
    buffer_store_dwordx4 v[16:19], v12, s[28:31], s32 offen
    s_mov_b32 s32, 16384
    buffer_store_dwordx4 v[20:23], v13, s[28:31], s32 offen
    s_mov_b32 s32, 32768
    buffer_store_dwordx4 v[24:27], v14, s[28:31], s32 offen
    s_mov_b32 s32, 49152
    buffer_store_dwordx4 v[28:31], v15, s[28:31], s32 offen
    s_sub_u32 s54, s2, 224
    v_lshrrev_b32 v234, 4, v230
    v_lshlrev_b32 v234, 13, v234
    v_and_b32 v235, 15, v237
    v_lshl_add_u32 v217, v235, 4, v234
    s_lshl_b32 s35, s54, 8
    s_add_u32 s35, s35, 0x3900000
    v_bfe_u32 v234, v237, 4, 1
    v_lshrrev_b32 v236, 5, v237
    v_lshl_add_u32 v234, v234, 1, v236
    v_lshl_add_u32 v234, v235, 2, v234
    s_lshl_b32 s32, s54, 6
    v_add_u32 v234, s32, v234
    v_lshlrev_b32 v218, 1, v234
    v_add_u32 v234, 98304, v218
    ds_read_u16 v100, v234
    ds_read_u16 v101, v234 offset:4096
    s_cmp_lt_u32 s54, 16
    s_cselect_b64 vcc, -1, 0
    v_cndmask_b32 v102, v10, v8, vcc
    s_cselect_b32 s32, 0, 4
    s_add_u32 s32, s32, 106496
    v_mov_b32 v234, s32
    ds_read_b32 v103, v234
    s_waitcnt lgkmcnt(0)
    v_cvt_pk_bf16_f32 v103, v103, v103
    v_lshlrev_b32 v103, 16, v103
    v_mul_f32 v103, 0xbfb8aa3b, v103
    v_exp_f32 v103, v103
    s_nop 0
    v_add_f32 v103, 1.0, v103
    v_rcp_f32 v103, v103
    s_nop 0
    v_cvt_pk_bf16_f32 v103, v103, v103
    v_lshlrev_b32 v103, 16, v103
    v_and_b32 v218, 2047, v218
    v_lshl_add_u32 v218, v102, 11, v218
    v_lshlrev_b32 v220, 2, v230
    v_add_u32 v220, 106752, v220
    v_lshlrev_b32 v221, 2, v237
    v_add_u32 v221, 106752, v221
    s_cmp_lg_u32 s3, 0
    s_cbranch_scc1 kc_b22
    s_lshl_b32 s32, s52, 7
    s_add_u32 s32, s32, 0x38a0c00
    s_mov_b32 s34, 0x400000
    s_branch kc_b21
kc_b20:
    s_sleep 2
kc_b21:
    buffer_load_dword v235, off, s[8:11], s32 sc1
    s_waitcnt vmcnt(0)
    v_cmp_ne_u32 vcc, 8, v235
    s_sub_u32 s34, s34, 1
    s_cbranch_scc1 kc_b22
    s_cbranch_vccnz kc_b20
kc_b22:
    s_barrier
    s_add_u32 s32, s35, 0
    buffer_load_dwordx4 v[32:35], v217, s[8:11], s32 offen sc1
    s_add_u32 s32, s35, 131072
    buffer_load_dwordx4 v[36:39], v217, s[8:11], s32 offen sc1
    s_add_u32 s32, s35, 262144
    buffer_load_dwordx4 v[40:43], v217, s[8:11], s32 offen sc1
    s_add_u32 s32, s35, 393216
    buffer_load_dwordx4 v[44:47], v217, s[8:11], s32 offen sc1
    s_add_u32 s32, s35, 524288
    buffer_load_dwordx4 v[48:51], v217, s[8:11], s32 offen sc1
    s_add_u32 s32, s35, 655360
    buffer_load_dwordx4 v[52:55], v217, s[8:11], s32 offen sc1
    s_add_u32 s32, s35, 786432
    buffer_load_dwordx4 v[56:59], v217, s[8:11], s32 offen sc1
    s_add_u32 s32, s35, 917504
    buffer_load_dwordx4 v[60:63], v217, s[8:11], s32 offen sc1
    s_add_u32 s32, s35, 1048576
    buffer_load_dwordx4 v[64:67], v217, s[8:11], s32 offen sc1
    s_add_u32 s32, s35, 1179648
    buffer_load_dwordx4 v[68:71], v217, s[8:11], s32 offen sc1
    s_add_u32 s32, s35, 1310720
    buffer_load_dwordx4 v[72:75], v217, s[8:11], s32 offen sc1
    s_add_u32 s32, s35, 1441792
    buffer_load_dwordx4 v[76:79], v217, s[8:11], s32 offen sc1
    s_add_u32 s32, s35, 1572864
    buffer_load_dwordx4 v[80:83], v217, s[8:11], s32 offen sc1
    s_add_u32 s32, s35, 1703936
    buffer_load_dwordx4 v[84:87], v217, s[8:11], s32 offen sc1
    s_waitcnt vmcnt(12)
    v_pk_add_f32 v[32:33], v[32:33], v[36:37]
    v_pk_add_f32 v[34:35], v[34:35], v[38:39]
    s_waitcnt vmcnt(11)
    v_pk_add_f32 v[32:33], v[32:33], v[40:41]
    v_pk_add_f32 v[34:35], v[34:35], v[42:43]
    s_waitcnt vmcnt(10)
    v_pk_add_f32 v[32:33], v[32:33], v[44:45]
    v_pk_add_f32 v[34:35], v[34:35], v[46:47]
    s_waitcnt vmcnt(9)
    v_pk_add_f32 v[32:33], v[32:33], v[48:49]
    v_pk_add_f32 v[34:35], v[34:35], v[50:51]
    s_waitcnt vmcnt(8)
    v_pk_add_f32 v[32:33], v[32:33], v[52:53]
    v_pk_add_f32 v[34:35], v[34:35], v[54:55]
    s_waitcnt vmcnt(7)
    v_pk_add_f32 v[32:33], v[32:33], v[56:57]
    v_pk_add_f32 v[34:35], v[34:35], v[58:59]
    s_waitcnt vmcnt(6)
    v_pk_add_f32 v[32:33], v[32:33], v[60:61]
    v_pk_add_f32 v[34:35], v[34:35], v[62:63]
    s_waitcnt vmcnt(5)
    v_pk_add_f32 v[32:33], v[32:33], v[64:65]
    v_pk_add_f32 v[34:35], v[34:35], v[66:67]
    s_waitcnt vmcnt(4)
    v_pk_add_f32 v[32:33], v[32:33], v[68:69]
    v_pk_add_f32 v[34:35], v[34:35], v[70:71]
    s_waitcnt vmcnt(3)
    v_pk_add_f32 v[32:33], v[32:33], v[72:73]
    v_pk_add_f32 v[34:35], v[34:35], v[74:75]
    s_waitcnt vmcnt(2)
    v_pk_add_f32 v[32:33], v[32:33], v[76:77]
    v_pk_add_f32 v[34:35], v[34:35], v[78:79]
    s_waitcnt vmcnt(1)
    v_pk_add_f32 v[32:33], v[32:33], v[80:81]
    v_pk_add_f32 v[34:35], v[34:35], v[82:83]
    s_waitcnt vmcnt(0)
    v_pk_add_f32 v[32:33], v[32:33], v[84:85]
    v_pk_add_f32 v[34:35], v[34:35], v[86:87]
    s_nop 1
    v_permlane32_swap_b32 v32, v33
    v_permlane32_swap_b32 v34, v35
    s_nop 0
    v_add_f32 v32, v32, v33
    v_add_f32 v34, v34, v35
    s_nop 1
    v_permlane16_swap_b32 v32, v34
    s_nop 0
    v_add_f32 v32, v32, v34
    ds_write_b32 v220, v32
    s_waitcnt lgkmcnt(0)
    s_barrier
    s_cmp_lg_u32 s3, 0
    s_cbranch_scc1 kc_fin
    ds_read_b32 v32, v221
    ds_read_b32 v33, v221 offset:256
    ds_read_b32 v34, v221 offset:512
    ds_read_b32 v35, v221 offset:768
    v_lshlrev_b32 v100, 16, v100
    v_lshlrev_b32 v101, 16, v101
    s_waitcnt lgkmcnt(0)
    v_add_f32 v32, v32, v33
    v_add_f32 v34, v34, v35
    v_add_f32 v32, v32, v34
    v_cvt_pk_bf16_f32 v32, v32, v32
    v_lshlrev_b32 v32, 16, v32
    v_mul_f32 v32, v32, v103
    v_cvt_pk_bf16_f32 v32, v32, v32
    v_lshlrev_b32 v32, 16, v32
    v_add_f32 v32, v32, v100
    v_cvt_pk_bf16_f32 v32, v32, v32
    v_lshlrev_b32 v32, 16, v32
    v_add_f32 v32, v32, v101
    v_cvt_pk_bf16_f32 v32, v32, v32
    buffer_store_short v32, v218, s[28:31], 0 offen
kc_fin:
    s_endpgm
kc_r3:
    s_mov_b32 s34, 0x400000
kc_r3l:
    s_sleep 4
    buffer_load_dwordx4 v[176:179], v228, s[8:11], s7 offen offset:0 sc1
    buffer_load_dwordx4 v[180:183], v228, s[8:11], s7 offen offset:1024 sc1
    buffer_load_dwordx4 v[184:187], v228, s[8:11], s7 offen offset:2048 sc1
    buffer_load_dwordx4 v[188:191], v228, s[8:11], s7 offen offset:3072 sc1
    s_waitcnt vmcnt(0)
    v_max3_u32 v235, v176, v177, v178
    v_max3_u32 v235, v235, v179, v180
    v_max3_u32 v235, v235, v181, v182
    v_max3_u32 v235, v235, v183, v184
    v_max3_u32 v235, v235, v185, v186
    v_max3_u32 v235, v235, v187, v188
    v_max3_u32 v235, v235, v189, v190
    v_max_u32 v235, v235, v191
    v_cmp_eq_u32 vcc, -1, v235
    s_sub_u32 s34, s34, 1
    s_cbranch_scc1 kc_r3o
    s_cbranch_vccnz kc_r3l
    s_branch kc_r3o
kc_r1:
    s_mov_b32 s34, 0x400000
kc_r1l:
    s_sleep 4
    buffer_load_dwordx4 v[96:99], v228, s[8:11], s37 offen offset:0 sc1
    buffer_load_dwordx4 v[100:103], v228, s[8:11], s37 offen offset:1024 sc1
    buffer_load_dwordx4 v[104:107], v228, s[8:11], s37 offen offset:2048 sc1
    buffer_load_dwordx4 v[108:111], v228, s[8:11], s37 offen offset:3072 sc1
    s_waitcnt vmcnt(0)
    v_max3_u32 v235, v96, v97, v98
    v_max3_u32 v235, v235, v99, v100
    v_max3_u32 v235, v235, v101, v102
    v_max3_u32 v235, v235, v103, v104
    v_max3_u32 v235, v235, v105, v106
    v_max3_u32 v235, v235, v107, v108
    v_max3_u32 v235, v235, v109, v110
    v_max_u32 v235, v235, v111
    v_cmp_eq_u32 vcc, -1, v235
    s_sub_u32 s34, s34, 1
    s_cbranch_scc1 kc_r1o
    s_cbranch_vccnz kc_r1l
    s_branch kc_r1o
kc_r2:
    s_mov_b32 s34, 0x400000
kc_r2l:
    s_sleep 4
    buffer_load_dwordx4 v[160:163], v228, s[8:11], s38 offen offset:0 sc1
    buffer_load_dwordx4 v[164:167], v228, s[8:11], s38 offen offset:1024 sc1
    buffer_load_dwordx4 v[168:171], v228, s[8:11], s38 offen offset:2048 sc1
    buffer_load_dwordx4 v[172:175], v228, s[8:11], s38 offen offset:3072 sc1
    s_waitcnt vmcnt(0)
    v_max3_u32 v235, v160, v161, v162
    v_max3_u32 v235, v235, v163, v164
    v_max3_u32 v235, v235, v165, v166
    v_max3_u32 v235, v235, v167, v168
    v_max3_u32 v235, v235, v169, v170
    v_max3_u32 v235, v235, v171, v172
    v_max3_u32 v235, v235, v173, v174
    v_max_u32 v235, v235, v175
    v_cmp_eq_u32 vcc, -1, v235
    s_sub_u32 s34, s34, 1
    s_cbranch_scc1 kc_r2o
    s_cbranch_vccnz kc_r2l
    s_branch kc_r2o
kc_g:
    s_mov_b32 s34, 0x400000
    s_branch kc_gs1
kc_gs0:
    s_sleep 2
kc_gs1:
    buffer_load_dword v235, off, s[8:11], s45 sc1
    s_waitcnt vmcnt(0)
    v_cmp_ne_u32 vcc, 8, v235
    s_sub_u32 s34, s34, 1
    s_cbranch_scc1 kc_gs2
    s_cbranch_vccnz kc_gs0
kc_gs2:
    s_branch kc_gr
kc_end:
ka_done:
    s_endpgm
kf_fix1:
    s_cmp_eq_u32 s33, 0
    s_cselect_b32 s24, 0, 0x74000000
    s_cselect_b32 s36, 0, 0x1000
    s_mov_b32 s33, 1
    v_subrev_f32 v230, s24, v243
    v_add_f32 v231, 0, v230
    v_min_f32 v64, v228, v231
    v_add_f32 v232, 0xf1800000, v230
    v_min_f32 v65, v228, v232
    v_add_f32 v231, 0xf2000000, v230
    v_min_f32 v66, v228, v231
    v_add_f32 v232, 0xf2400000, v230
    v_min_f32 v67, v228, v232
    v_add_f32 v231, 0xf3000000, v230
    v_min_f32 v68, v228, v231
    v_add_f32 v232, 0xf3100000, v230
    v_min_f32 v69, v228, v232
    v_add_f32 v231, 0xf3200000, v230
    v_min_f32 v70, v228, v231
    v_add_f32 v232, 0xf3300000, v230
    v_min_f32 v71, v228, v232
    v_add_f32 v231, 0xf3800000, v230
    v_min_f32 v72, v228, v231
    v_add_f32 v232, 0xf3880000, v230
    v_min_f32 v73, v228, v232
    v_add_f32 v231, 0xf3900000, v230
    v_min_f32 v74, v228, v231
    v_add_f32 v232, 0xf3980000, v230
    v_min_f32 v75, v228, v232
    v_add_f32 v231, 0xf3c00000, v230
    v_min_f32 v76, v228, v231
    v_add_f32 v232, 0xf3c80000, v230
    v_min_f32 v77, v228, v232
    v_add_f32 v231, 0xf3d00000, v230
    v_min_f32 v78, v228, v231
    v_add_f32 v232, 0xf3d80000, v230
    v_min_f32 v79, v228, v232
    s_nop 1
    s_branch kf_fixr2
kf_fix3:
    s_cmp_eq_u32 s33, 0
    s_cselect_b32 s24, 0, 0x74000000
    s_cselect_b32 s36, 0, 0x1000
    s_mov_b32 s33, 1
    v_subrev_f32 v230, s24, v243
    v_add_f32 v231, 0, v230
    v_min_f32 v64, v228, v231
    v_add_f32 v232, 0xf1800000, v230
    v_min_f32 v65, v228, v232
    v_add_f32 v231, 0xf2000000, v230
    v_min_f32 v66, v228, v231
    v_add_f32 v232, 0xf2400000, v230
    v_min_f32 v67, v228, v232
    v_add_f32 v231, 0xf3000000, v230
    v_min_f32 v68, v228, v231
    v_add_f32 v232, 0xf3100000, v230
    v_min_f32 v69, v228, v232
    v_add_f32 v231, 0xf3200000, v230
    v_min_f32 v70, v228, v231
    v_add_f32 v232, 0xf3300000, v230
    v_min_f32 v71, v228, v232
    v_add_f32 v231, 0xf3800000, v230
    v_min_f32 v72, v228, v231
    v_add_f32 v232, 0xf3880000, v230
    v_min_f32 v73, v228, v232
    v_add_f32 v231, 0xf3900000, v230
    v_min_f32 v74, v228, v231
    v_add_f32 v232, 0xf3980000, v230
    v_min_f32 v75, v228, v232
    v_add_f32 v231, 0xf3c00000, v230
    v_min_f32 v76, v228, v231
    v_add_f32 v232, 0xf3c80000, v230
    v_min_f32 v77, v228, v232
    v_add_f32 v231, 0xf3d00000, v230
    v_min_f32 v78, v228, v231
    v_add_f32 v232, 0xf3d80000, v230
    v_min_f32 v79, v228, v232
    s_nop 1
    s_branch kf_fixr4
kf_fix5:
    s_cmp_eq_u32 s33, 0
    s_cselect_b32 s24, 0, 0x74000000
    s_cselect_b32 s36, 0, 0x1000
    s_mov_b32 s33, 1
    v_subrev_f32 v230, s24, v243
    v_add_f32 v231, 0, v230
    v_min_f32 v64, v228, v231
    v_add_f32 v232, 0xf1800000, v230
    v_min_f32 v65, v228, v232
    v_add_f32 v231, 0xf2000000, v230
    v_min_f32 v66, v228, v231
    v_add_f32 v232, 0xf2400000, v230
    v_min_f32 v67, v228, v232
    v_add_f32 v231, 0xf3000000, v230
    v_min_f32 v68, v228, v231
    v_add_f32 v232, 0xf3100000, v230
    v_min_f32 v69, v228, v232
    v_add_f32 v231, 0xf3200000, v230
    v_min_f32 v70, v228, v231
    v_add_f32 v232, 0xf3300000, v230
    v_min_f32 v71, v228, v232
    v_add_f32 v231, 0xf3800000, v230
    v_min_f32 v72, v228, v231
    v_add_f32 v232, 0xf3880000, v230
    v_min_f32 v73, v228, v232
    v_add_f32 v231, 0xf3900000, v230
    v_min_f32 v74, v228, v231
    v_add_f32 v232, 0xf3980000, v230
    v_min_f32 v75, v228, v232
    v_add_f32 v231, 0xf3c00000, v230
    v_min_f32 v76, v228, v231
    v_add_f32 v232, 0xf3c80000, v230
    v_min_f32 v77, v228, v232
    v_add_f32 v231, 0xf3d00000, v230
    v_min_f32 v78, v228, v231
    v_add_f32 v232, 0xf3d80000, v230
    v_min_f32 v79, v228, v232
    s_nop 1
    s_branch kf_fixr6
kf_rare8:
    s_nop 15
    v_max3_f32 v230, v32, v33, v34
    v_max3_f32 v230, v230, v35, v36
    v_max3_f32 v230, v230, v37, v38
    v_max3_f32 v230, v230, v39, v40
    v_max3_f32 v230, v230, v41, v42
    v_max3_f32 v230, v230, v43, v44
    v_max3_f32 v230, v230, v45, v46
    v_max_f32 v230, v230, v47
    v_mov_b32 v231, v230
    s_nop 1
    v_permlane32_swap_b32 v230, v231
    s_nop 0
    v_max_f32 v230, v230, v231
    v_max_f32 v230, 0, v230
    v_sub_f32 v232, 0, v230
    v_exp_f32 v232, v232
    v_sub_f32 v228, v228, v230
    v_sub_f32 v64, v64, v230
    v_sub_f32 v0, v0, v230
    v_sub_f32 v32, v32, v230
    v_sub_f32 v65, v65, v230
    v_sub_f32 v1, v1, v230
    v_sub_f32 v33, v33, v230
    v_sub_f32 v66, v66, v230
    v_sub_f32 v2, v2, v230
    v_sub_f32 v34, v34, v230
    v_sub_f32 v67, v67, v230
    v_sub_f32 v3, v3, v230
    v_sub_f32 v35, v35, v230
    v_sub_f32 v68, v68, v230
    v_sub_f32 v4, v4, v230
    v_sub_f32 v36, v36, v230
    v_sub_f32 v69, v69, v230
    v_sub_f32 v5, v5, v230
    v_sub_f32 v37, v37, v230
    v_sub_f32 v70, v70, v230
    v_sub_f32 v6, v6, v230
    v_sub_f32 v38, v38, v230
    v_sub_f32 v71, v71, v230
    v_sub_f32 v7, v7, v230
    v_sub_f32 v39, v39, v230
    v_sub_f32 v72, v72, v230
    v_sub_f32 v8, v8, v230
    v_sub_f32 v40, v40, v230
    v_sub_f32 v73, v73, v230
    v_sub_f32 v9, v9, v230
    v_sub_f32 v41, v41, v230
    v_sub_f32 v74, v74, v230
    v_sub_f32 v10, v10, v230
    v_sub_f32 v42, v42, v230
    v_sub_f32 v75, v75, v230
    v_sub_f32 v11, v11, v230
    v_sub_f32 v43, v43, v230
    v_sub_f32 v76, v76, v230
    v_sub_f32 v12, v12, v230
    v_sub_f32 v44, v44, v230
    v_sub_f32 v77, v77, v230
    v_sub_f32 v13, v13, v230
    v_sub_f32 v45, v45, v230
    v_sub_f32 v78, v78, v230
    v_sub_f32 v14, v14, v230
    v_sub_f32 v46, v46, v230
    v_sub_f32 v79, v79, v230
    v_sub_f32 v15, v15, v230
    v_sub_f32 v47, v47, v230
    v_mul_f32 v226, v226, v232
    v_accvgpr_read_b32 v234, a0
    v_mul_f32 v234, v234, v232
    v_accvgpr_write_b32 a0, v234
    v_accvgpr_read_b32 v235, a1
    v_mul_f32 v235, v235, v232
    v_accvgpr_write_b32 a1, v235
    v_accvgpr_read_b32 v236, a2
    v_mul_f32 v236, v236, v232
    v_accvgpr_write_b32 a2, v236
    v_accvgpr_read_b32 v237, a3
    v_mul_f32 v237, v237, v232
    v_accvgpr_write_b32 a3, v237
    v_accvgpr_read_b32 v234, a4
    v_mul_f32 v234, v234, v232
    v_accvgpr_write_b32 a4, v234
    v_accvgpr_read_b32 v235, a5
    v_mul_f32 v235, v235, v232
    v_accvgpr_write_b32 a5, v235
    v_accvgpr_read_b32 v236, a6
    v_mul_f32 v236, v236, v232
    v_accvgpr_write_b32 a6, v236
    v_accvgpr_read_b32 v237, a7
    v_mul_f32 v237, v237, v232
    v_accvgpr_write_b32 a7, v237
    v_accvgpr_read_b32 v234, a8
    v_mul_f32 v234, v234, v232
    v_accvgpr_write_b32 a8, v234
    v_accvgpr_read_b32 v235, a9
    v_mul_f32 v235, v235, v232
    v_accvgpr_write_b32 a9, v235
    v_accvgpr_read_b32 v236, a10
    v_mul_f32 v236, v236, v232
    v_accvgpr_write_b32 a10, v236
    v_accvgpr_read_b32 v237, a11
    v_mul_f32 v237, v237, v232
    v_accvgpr_write_b32 a11, v237
    v_accvgpr_read_b32 v234, a12
    v_mul_f32 v234, v234, v232
    v_accvgpr_write_b32 a12, v234
    v_accvgpr_read_b32 v235, a13
    v_mul_f32 v235, v235, v232
    v_accvgpr_write_b32 a13, v235
    v_accvgpr_read_b32 v236, a14
    v_mul_f32 v236, v236, v232
    v_accvgpr_write_b32 a14, v236
    v_accvgpr_read_b32 v237, a15
    v_mul_f32 v237, v237, v232
    v_accvgpr_write_b32 a15, v237
    v_accvgpr_read_b32 v234, a16
    v_mul_f32 v234, v234, v232
    v_accvgpr_write_b32 a16, v234
    v_accvgpr_read_b32 v235, a17
    v_mul_f32 v235, v235, v232
    v_accvgpr_write_b32 a17, v235
    v_accvgpr_read_b32 v236, a18
    v_mul_f32 v236, v236, v232
    v_accvgpr_write_b32 a18, v236
    v_accvgpr_read_b32 v237, a19
    v_mul_f32 v237, v237, v232
    v_accvgpr_write_b32 a19, v237
    v_accvgpr_read_b32 v234, a20
    v_mul_f32 v234, v234, v232
    v_accvgpr_write_b32 a20, v234
    v_accvgpr_read_b32 v235, a21
    v_mul_f32 v235, v235, v232
    v_accvgpr_write_b32 a21, v235
    v_accvgpr_read_b32 v236, a22
    v_mul_f32 v236, v236, v232
    v_accvgpr_write_b32 a22, v236
    v_accvgpr_read_b32 v237, a23
    v_mul_f32 v237, v237, v232
    v_accvgpr_write_b32 a23, v237
    v_accvgpr_read_b32 v234, a24
    v_mul_f32 v234, v234, v232
    v_accvgpr_write_b32 a24, v234
    v_accvgpr_read_b32 v235, a25
    v_mul_f32 v235, v235, v232
    v_accvgpr_write_b32 a25, v235
    v_accvgpr_read_b32 v236, a26
    v_mul_f32 v236, v236, v232
    v_accvgpr_write_b32 a26, v236
    v_accvgpr_read_b32 v237, a27
    v_mul_f32 v237, v237, v232
    v_accvgpr_write_b32 a27, v237
    v_accvgpr_read_b32 v234, a28
    v_mul_f32 v234, v234, v232
    v_accvgpr_write_b32 a28, v234
    v_accvgpr_read_b32 v235, a29
    v_mul_f32 v235, v235, v232
    v_accvgpr_write_b32 a29, v235
    v_accvgpr_read_b32 v236, a30
    v_mul_f32 v236, v236, v232
    v_accvgpr_write_b32 a30, v236
    v_accvgpr_read_b32 v237, a31
    v_mul_f32 v237, v237, v232
    v_accvgpr_write_b32 a31, v237
    v_accvgpr_read_b32 v234, a32
    v_mul_f32 v234, v234, v232
    v_accvgpr_write_b32 a32, v234
    v_accvgpr_read_b32 v235, a33
    v_mul_f32 v235, v235, v232
    v_accvgpr_write_b32 a33, v235
    v_accvgpr_read_b32 v236, a34
    v_mul_f32 v236, v236, v232
    v_accvgpr_write_b32 a34, v236
    v_accvgpr_read_b32 v237, a35
    v_mul_f32 v237, v237, v232
    v_accvgpr_write_b32 a35, v237
    v_accvgpr_read_b32 v234, a36
    v_mul_f32 v234, v234, v232
    v_accvgpr_write_b32 a36, v234
    v_accvgpr_read_b32 v235, a37
    v_mul_f32 v235, v235, v232
    v_accvgpr_write_b32 a37, v235
    v_accvgpr_read_b32 v236, a38
    v_mul_f32 v236, v236, v232
    v_accvgpr_write_b32 a38, v236
    v_accvgpr_read_b32 v237, a39
    v_mul_f32 v237, v237, v232
    v_accvgpr_write_b32 a39, v237
    v_accvgpr_read_b32 v234, a40
    v_mul_f32 v234, v234, v232
    v_accvgpr_write_b32 a40, v234
    v_accvgpr_read_b32 v235, a41
    v_mul_f32 v235, v235, v232
    v_accvgpr_write_b32 a41, v235
    v_accvgpr_read_b32 v236, a42
    v_mul_f32 v236, v236, v232
    v_accvgpr_write_b32 a42, v236
    v_accvgpr_read_b32 v237, a43
    v_mul_f32 v237, v237, v232
    v_accvgpr_write_b32 a43, v237
    v_accvgpr_read_b32 v234, a44
    v_mul_f32 v234, v234, v232
    v_accvgpr_write_b32 a44, v234
    v_accvgpr_read_b32 v235, a45
    v_mul_f32 v235, v235, v232
    v_accvgpr_write_b32 a45, v235
    v_accvgpr_read_b32 v236, a46
    v_mul_f32 v236, v236, v232
    v_accvgpr_write_b32 a46, v236
    v_accvgpr_read_b32 v237, a47
    v_mul_f32 v237, v237, v232
    v_accvgpr_write_b32 a47, v237
    v_accvgpr_read_b32 v234, a48
    v_mul_f32 v234, v234, v232
    v_accvgpr_write_b32 a48, v234
    v_accvgpr_read_b32 v235, a49
    v_mul_f32 v235, v235, v232
    v_accvgpr_write_b32 a49, v235
    v_accvgpr_read_b32 v236, a50
    v_mul_f32 v236, v236, v232
    v_accvgpr_write_b32 a50, v236
    v_accvgpr_read_b32 v237, a51
    v_mul_f32 v237, v237, v232
    v_accvgpr_write_b32 a51, v237
    v_accvgpr_read_b32 v234, a52
    v_mul_f32 v234, v234, v232
    v_accvgpr_write_b32 a52, v234
    v_accvgpr_read_b32 v235, a53
    v_mul_f32 v235, v235, v232
    v_accvgpr_write_b32 a53, v235
    v_accvgpr_read_b32 v236, a54
    v_mul_f32 v236, v236, v232
    v_accvgpr_write_b32 a54, v236
    v_accvgpr_read_b32 v237, a55
    v_mul_f32 v237, v237, v232
    v_accvgpr_write_b32 a55, v237
    v_accvgpr_read_b32 v234, a56
    v_mul_f32 v234, v234, v232
    v_accvgpr_write_b32 a56, v234
    v_accvgpr_read_b32 v235, a57
    v_mul_f32 v235, v235, v232
    v_accvgpr_write_b32 a57, v235
    v_accvgpr_read_b32 v236, a58
    v_mul_f32 v236, v236, v232
    v_accvgpr_write_b32 a58, v236
    v_accvgpr_read_b32 v237, a59
    v_mul_f32 v237, v237, v232
    v_accvgpr_write_b32 a59, v237
    v_accvgpr_read_b32 v234, a60
    v_mul_f32 v234, v234, v232
    v_accvgpr_write_b32 a60, v234
    v_accvgpr_read_b32 v235, a61
    v_mul_f32 v235, v235, v232
    v_accvgpr_write_b32 a61, v235
    v_accvgpr_read_b32 v236, a62
    v_mul_f32 v236, v236, v232
    v_accvgpr_write_b32 a62, v236
    v_accvgpr_read_b32 v237, a63
    v_mul_f32 v237, v237, v232
    v_accvgpr_write_b32 a63, v237
    v_exp_f32 v136, v32
    v_exp_f32 v137, v33
    v_exp_f32 v130, v34
    v_exp_f32 v131, v35
    v_cvt_pk_bf16_f32 v112, v136, v137
    v_exp_f32 v132, v36
    v_exp_f32 v133, v37
    v_cvt_pk_bf16_f32 v113, v130, v131
    v_add_f32 v136, v136, v130
    v_add_f32 v137, v137, v131
    v_exp_f32 v134, v38
    v_exp_f32 v135, v39
    v_cvt_pk_bf16_f32 v114, v132, v133
    v_add_f32 v136, v136, v132
    v_add_f32 v137, v137, v133
    v_exp_f32 v128, v40
    v_exp_f32 v129, v41
    v_cvt_pk_bf16_f32 v115, v134, v135
    v_add_f32 v136, v136, v134
    v_add_f32 v137, v137, v135
    v_exp_f32 v130, v42
    v_exp_f32 v131, v43
    v_cvt_pk_bf16_f32 v116, v128, v129
    v_add_f32 v136, v136, v128
    v_add_f32 v137, v137, v129
    v_exp_f32 v132, v44
    v_exp_f32 v133, v45
    v_cvt_pk_bf16_f32 v117, v130, v131
    v_add_f32 v136, v136, v130
    v_add_f32 v137, v137, v131
    v_exp_f32 v134, v46
    v_exp_f32 v135, v47
    v_cvt_pk_bf16_f32 v118, v132, v133
    v_add_f32 v136, v136, v132
    v_add_f32 v137, v137, v133
    v_cvt_pk_bf16_f32 v119, v134, v135
    v_add_f32 v136, v136, v134
    v_add_f32 v137, v137, v135
    v_add_f32 v224, v136, v137
    v_max3_f32 v230, v48, v49, v50
    v_max3_f32 v230, v230, v51, v52
    v_max3_f32 v230, v230, v53, v54
    v_max3_f32 v230, v230, v55, v56
    v_max3_f32 v230, v230, v57, v58
    v_max3_f32 v230, v230, v59, v60
    v_max3_f32 v230, v230, v61, v62
    v_max_f32 v230, v230, v63
    v_mov_b32 v231, v230
    s_nop 1
    v_permlane32_swap_b32 v230, v231
    s_nop 0
    v_max_f32 v230, v230, v231
    v_max_f32 v230, 0, v230
    v_sub_f32 v232, 0, v230
    v_exp_f32 v232, v232
    v_sub_f32 v229, v229, v230
    v_sub_f32 v80, v80, v230
    v_sub_f32 v16, v16, v230
    v_sub_f32 v48, v48, v230
    v_sub_f32 v81, v81, v230
    v_sub_f32 v17, v17, v230
    v_sub_f32 v49, v49, v230
    v_sub_f32 v82, v82, v230
    v_sub_f32 v18, v18, v230
    v_sub_f32 v50, v50, v230
    v_sub_f32 v83, v83, v230
    v_sub_f32 v19, v19, v230
    v_sub_f32 v51, v51, v230
    v_sub_f32 v84, v84, v230
    v_sub_f32 v20, v20, v230
    v_sub_f32 v52, v52, v230
    v_sub_f32 v85, v85, v230
    v_sub_f32 v21, v21, v230
    v_sub_f32 v53, v53, v230
    v_sub_f32 v86, v86, v230
    v_sub_f32 v22, v22, v230
    v_sub_f32 v54, v54, v230
    v_sub_f32 v87, v87, v230
    v_sub_f32 v23, v23, v230
    v_sub_f32 v55, v55, v230
    v_sub_f32 v88, v88, v230
    v_sub_f32 v24, v24, v230
    v_sub_f32 v56, v56, v230
    v_sub_f32 v89, v89, v230
    v_sub_f32 v25, v25, v230
    v_sub_f32 v57, v57, v230
    v_sub_f32 v90, v90, v230
    v_sub_f32 v26, v26, v230
    v_sub_f32 v58, v58, v230
    v_sub_f32 v91, v91, v230
    v_sub_f32 v27, v27, v230
    v_sub_f32 v59, v59, v230
    v_sub_f32 v92, v92, v230
    v_sub_f32 v28, v28, v230
    v_sub_f32 v60, v60, v230
    v_sub_f32 v93, v93, v230
    v_sub_f32 v29, v29, v230
    v_sub_f32 v61, v61, v230
    v_sub_f32 v94, v94, v230
    v_sub_f32 v30, v30, v230
    v_sub_f32 v62, v62, v230
    v_sub_f32 v95, v95, v230
    v_sub_f32 v31, v31, v230
    v_sub_f32 v63, v63, v230
    v_mul_f32 v227, v227, v232
    v_accvgpr_read_b32 v234, a64
    v_mul_f32 v234, v234, v232
    v_accvgpr_write_b32 a64, v234
    v_accvgpr_read_b32 v235, a65
    v_mul_f32 v235, v235, v232
    v_accvgpr_write_b32 a65, v235
    v_accvgpr_read_b32 v236, a66
    v_mul_f32 v236, v236, v232
    v_accvgpr_write_b32 a66, v236
    v_accvgpr_read_b32 v237, a67
    v_mul_f32 v237, v237, v232
    v_accvgpr_write_b32 a67, v237
    v_accvgpr_read_b32 v234, a68
    v_mul_f32 v234, v234, v232
    v_accvgpr_write_b32 a68, v234
    v_accvgpr_read_b32 v235, a69
    v_mul_f32 v235, v235, v232
    v_accvgpr_write_b32 a69, v235
    v_accvgpr_read_b32 v236, a70
    v_mul_f32 v236, v236, v232
    v_accvgpr_write_b32 a70, v236
    v_accvgpr_read_b32 v237, a71
    v_mul_f32 v237, v237, v232
    v_accvgpr_write_b32 a71, v237
    v_accvgpr_read_b32 v234, a72
    v_mul_f32 v234, v234, v232
    v_accvgpr_write_b32 a72, v234
    v_accvgpr_read_b32 v235, a73
    v_mul_f32 v235, v235, v232
    v_accvgpr_write_b32 a73, v235
    v_accvgpr_read_b32 v236, a74
    v_mul_f32 v236, v236, v232
    v_accvgpr_write_b32 a74, v236
    v_accvgpr_read_b32 v237, a75
    v_mul_f32 v237, v237, v232
    v_accvgpr_write_b32 a75, v237
    v_accvgpr_read_b32 v234, a76
    v_mul_f32 v234, v234, v232
    v_accvgpr_write_b32 a76, v234
    v_accvgpr_read_b32 v235, a77
    v_mul_f32 v235, v235, v232
    v_accvgpr_write_b32 a77, v235
    v_accvgpr_read_b32 v236, a78
    v_mul_f32 v236, v236, v232
    v_accvgpr_write_b32 a78, v236
    v_accvgpr_read_b32 v237, a79
    v_mul_f32 v237, v237, v232
    v_accvgpr_write_b32 a79, v237
    v_accvgpr_read_b32 v234, a80
    v_mul_f32 v234, v234, v232
    v_accvgpr_write_b32 a80, v234
    v_accvgpr_read_b32 v235, a81
    v_mul_f32 v235, v235, v232
    v_accvgpr_write_b32 a81, v235
    v_accvgpr_read_b32 v236, a82
    v_mul_f32 v236, v236, v232
    v_accvgpr_write_b32 a82, v236
    v_accvgpr_read_b32 v237, a83
    v_mul_f32 v237, v237, v232
    v_accvgpr_write_b32 a83, v237
    v_accvgpr_read_b32 v234, a84
    v_mul_f32 v234, v234, v232
    v_accvgpr_write_b32 a84, v234
    v_accvgpr_read_b32 v235, a85
    v_mul_f32 v235, v235, v232
    v_accvgpr_write_b32 a85, v235
    v_accvgpr_read_b32 v236, a86
    v_mul_f32 v236, v236, v232
    v_accvgpr_write_b32 a86, v236
    v_accvgpr_read_b32 v237, a87
    v_mul_f32 v237, v237, v232
    v_accvgpr_write_b32 a87, v237
    v_accvgpr_read_b32 v234, a88
    v_mul_f32 v234, v234, v232
    v_accvgpr_write_b32 a88, v234
    v_accvgpr_read_b32 v235, a89
    v_mul_f32 v235, v235, v232
    v_accvgpr_write_b32 a89, v235
    v_accvgpr_read_b32 v236, a90
    v_mul_f32 v236, v236, v232
    v_accvgpr_write_b32 a90, v236
    v_accvgpr_read_b32 v237, a91
    v_mul_f32 v237, v237, v232
    v_accvgpr_write_b32 a91, v237
    v_accvgpr_read_b32 v234, a92
    v_mul_f32 v234, v234, v232
    v_accvgpr_write_b32 a92, v234
    v_accvgpr_read_b32 v235, a93
    v_mul_f32 v235, v235, v232
    v_accvgpr_write_b32 a93, v235
    v_accvgpr_read_b32 v236, a94
    v_mul_f32 v236, v236, v232
    v_accvgpr_write_b32 a94, v236
    v_accvgpr_read_b32 v237, a95
    v_mul_f32 v237, v237, v232
    v_accvgpr_write_b32 a95, v237
    v_accvgpr_read_b32 v234, a96
    v_mul_f32 v234, v234, v232
    v_accvgpr_write_b32 a96, v234
    v_accvgpr_read_b32 v235, a97
    v_mul_f32 v235, v235, v232
    v_accvgpr_write_b32 a97, v235
    v_accvgpr_read_b32 v236, a98
    v_mul_f32 v236, v236, v232
    v_accvgpr_write_b32 a98, v236
    v_accvgpr_read_b32 v237, a99
    v_mul_f32 v237, v237, v232
    v_accvgpr_write_b32 a99, v237
    v_accvgpr_read_b32 v234, a100
    v_mul_f32 v234, v234, v232
    v_accvgpr_write_b32 a100, v234
    v_accvgpr_read_b32 v235, a101
    v_mul_f32 v235, v235, v232
    v_accvgpr_write_b32 a101, v235
    v_accvgpr_read_b32 v236, a102
    v_mul_f32 v236, v236, v232
    v_accvgpr_write_b32 a102, v236
    v_accvgpr_read_b32 v237, a103
    v_mul_f32 v237, v237, v232
    v_accvgpr_write_b32 a103, v237
    v_accvgpr_read_b32 v234, a104
    v_mul_f32 v234, v234, v232
    v_accvgpr_write_b32 a104, v234
    v_accvgpr_read_b32 v235, a105
    v_mul_f32 v235, v235, v232
    v_accvgpr_write_b32 a105, v235
    v_accvgpr_read_b32 v236, a106
    v_mul_f32 v236, v236, v232
    v_accvgpr_write_b32 a106, v236
    v_accvgpr_read_b32 v237, a107
    v_mul_f32 v237, v237, v232
    v_accvgpr_write_b32 a107, v237
    v_accvgpr_read_b32 v234, a108
    v_mul_f32 v234, v234, v232
    v_accvgpr_write_b32 a108, v234
    v_accvgpr_read_b32 v235, a109
    v_mul_f32 v235, v235, v232
    v_accvgpr_write_b32 a109, v235
    v_accvgpr_read_b32 v236, a110
    v_mul_f32 v236, v236, v232
    v_accvgpr_write_b32 a110, v236
    v_accvgpr_read_b32 v237, a111
    v_mul_f32 v237, v237, v232
    v_accvgpr_write_b32 a111, v237
    v_accvgpr_read_b32 v234, a112
    v_mul_f32 v234, v234, v232
    v_accvgpr_write_b32 a112, v234
    v_accvgpr_read_b32 v235, a113
    v_mul_f32 v235, v235, v232
    v_accvgpr_write_b32 a113, v235
    v_accvgpr_read_b32 v236, a114
    v_mul_f32 v236, v236, v232
    v_accvgpr_write_b32 a114, v236
    v_accvgpr_read_b32 v237, a115
    v_mul_f32 v237, v237, v232
    v_accvgpr_write_b32 a115, v237
    v_accvgpr_read_b32 v234, a116
    v_mul_f32 v234, v234, v232
    v_accvgpr_write_b32 a116, v234
    v_accvgpr_read_b32 v235, a117
    v_mul_f32 v235, v235, v232
    v_accvgpr_write_b32 a117, v235
    v_accvgpr_read_b32 v236, a118
    v_mul_f32 v236, v236, v232
    v_accvgpr_write_b32 a118, v236
    v_accvgpr_read_b32 v237, a119
    v_mul_f32 v237, v237, v232
    v_accvgpr_write_b32 a119, v237
    v_accvgpr_read_b32 v234, a120
    v_mul_f32 v234, v234, v232
    v_accvgpr_write_b32 a120, v234
    v_accvgpr_read_b32 v235, a121
    v_mul_f32 v235, v235, v232
    v_accvgpr_write_b32 a121, v235
    v_accvgpr_read_b32 v236, a122
    v_mul_f32 v236, v236, v232
    v_accvgpr_write_b32 a122, v236
    v_accvgpr_read_b32 v237, a123
    v_mul_f32 v237, v237, v232
    v_accvgpr_write_b32 a123, v237
    v_accvgpr_read_b32 v234, a124
    v_mul_f32 v234, v234, v232
    v_accvgpr_write_b32 a124, v234
    v_accvgpr_read_b32 v235, a125
    v_mul_f32 v235, v235, v232
    v_accvgpr_write_b32 a125, v235
    v_accvgpr_read_b32 v236, a126
    v_mul_f32 v236, v236, v232
    v_accvgpr_write_b32 a126, v236
    v_accvgpr_read_b32 v237, a127
    v_mul_f32 v237, v237, v232
    v_accvgpr_write_b32 a127, v237
    v_exp_f32 v138, v48
    v_exp_f32 v139, v49
    v_exp_f32 v130, v50
    v_exp_f32 v131, v51
    v_cvt_pk_bf16_f32 v120, v138, v139
    v_exp_f32 v132, v52
    v_exp_f32 v133, v53
    v_cvt_pk_bf16_f32 v121, v130, v131
    v_add_f32 v138, v138, v130
    v_add_f32 v139, v139, v131
    v_exp_f32 v134, v54
    v_exp_f32 v135, v55
    v_cvt_pk_bf16_f32 v122, v132, v133
    v_add_f32 v138, v138, v132
    v_add_f32 v139, v139, v133
    v_exp_f32 v128, v56
    v_exp_f32 v129, v57
    v_cvt_pk_bf16_f32 v123, v134, v135
    v_add_f32 v138, v138, v134
    v_add_f32 v139, v139, v135
    v_exp_f32 v130, v58
    v_exp_f32 v131, v59
    v_cvt_pk_bf16_f32 v124, v128, v129
    v_add_f32 v138, v138, v128
    v_add_f32 v139, v139, v129
    v_exp_f32 v132, v60
    v_exp_f32 v133, v61
    v_cvt_pk_bf16_f32 v125, v130, v131
    v_add_f32 v138, v138, v130
    v_add_f32 v139, v139, v131
    v_exp_f32 v134, v62
    v_exp_f32 v135, v63
    v_cvt_pk_bf16_f32 v126, v132, v133
    v_add_f32 v138, v138, v132
    v_add_f32 v139, v139, v133
    v_cvt_pk_bf16_f32 v127, v134, v135
    v_add_f32 v138, v138, v134
    v_add_f32 v139, v139, v135
    v_add_f32 v225, v138, v139
    s_nop 1
    s_branch kf_rr7
kf_fix9:
    s_cmp_eq_u32 s33, 0
    s_cselect_b32 s24, 0, 0x74000000
    s_cselect_b32 s36, 0, 0x1000
    s_mov_b32 s33, 1
    v_subrev_f32 v230, s24, v243
    v_add_f32 v231, 0, v230
    v_min_f32 v64, v228, v231
    v_add_f32 v232, 0xf1800000, v230
    v_min_f32 v65, v228, v232
    v_add_f32 v231, 0xf2000000, v230
    v_min_f32 v66, v228, v231
    v_add_f32 v232, 0xf2400000, v230
    v_min_f32 v67, v228, v232
    v_add_f32 v231, 0xf3000000, v230
    v_min_f32 v68, v228, v231
    v_add_f32 v232, 0xf3100000, v230
    v_min_f32 v69, v228, v232
    v_add_f32 v231, 0xf3200000, v230
    v_min_f32 v70, v228, v231
    v_add_f32 v232, 0xf3300000, v230
    v_min_f32 v71, v228, v232
    v_add_f32 v231, 0xf3800000, v230
    v_min_f32 v72, v228, v231
    v_add_f32 v232, 0xf3880000, v230
    v_min_f32 v73, v228, v232
    v_add_f32 v231, 0xf3900000, v230
    v_min_f32 v74, v228, v231
    v_add_f32 v232, 0xf3980000, v230
    v_min_f32 v75, v228, v232
    v_add_f32 v231, 0xf3c00000, v230
    v_min_f32 v76, v228, v231
    v_add_f32 v232, 0xf3c80000, v230
    v_min_f32 v77, v228, v232
    v_add_f32 v231, 0xf3d00000, v230
    v_min_f32 v78, v228, v231
    v_add_f32 v232, 0xf3d80000, v230
    v_min_f32 v79, v228, v232
    s_nop 1
    s_branch kf_fixr10
kf_rare12:
    s_nop 15
    v_max3_f32 v230, v0, v1, v2
    v_max3_f32 v230, v230, v3, v4
    v_max3_f32 v230, v230, v5, v6
    v_max3_f32 v230, v230, v7, v8
    v_max3_f32 v230, v230, v9, v10
    v_max3_f32 v230, v230, v11, v12
    v_max3_f32 v230, v230, v13, v14
    v_max_f32 v230, v230, v15
    v_mov_b32 v231, v230
    s_nop 1
    v_permlane32_swap_b32 v230, v231
    s_nop 0
    v_max_f32 v230, v230, v231
    v_max_f32 v230, 0, v230
    v_sub_f32 v232, 0, v230
    v_exp_f32 v232, v232
    v_sub_f32 v228, v228, v230
    v_sub_f32 v64, v64, v230
    v_sub_f32 v32, v32, v230
    v_sub_f32 v0, v0, v230
    v_sub_f32 v65, v65, v230
    v_sub_f32 v33, v33, v230
    v_sub_f32 v1, v1, v230
    v_sub_f32 v66, v66, v230
    v_sub_f32 v34, v34, v230
    v_sub_f32 v2, v2, v230
    v_sub_f32 v67, v67, v230
    v_sub_f32 v35, v35, v230
    v_sub_f32 v3, v3, v230
    v_sub_f32 v68, v68, v230
    v_sub_f32 v36, v36, v230
    v_sub_f32 v4, v4, v230
    v_sub_f32 v69, v69, v230
    v_sub_f32 v37, v37, v230
    v_sub_f32 v5, v5, v230
    v_sub_f32 v70, v70, v230
    v_sub_f32 v38, v38, v230
    v_sub_f32 v6, v6, v230
    v_sub_f32 v71, v71, v230
    v_sub_f32 v39, v39, v230
    v_sub_f32 v7, v7, v230
    v_sub_f32 v72, v72, v230
    v_sub_f32 v40, v40, v230
    v_sub_f32 v8, v8, v230
    v_sub_f32 v73, v73, v230
    v_sub_f32 v41, v41, v230
    v_sub_f32 v9, v9, v230
    v_sub_f32 v74, v74, v230
    v_sub_f32 v42, v42, v230
    v_sub_f32 v10, v10, v230
    v_sub_f32 v75, v75, v230
    v_sub_f32 v43, v43, v230
    v_sub_f32 v11, v11, v230
    v_sub_f32 v76, v76, v230
    v_sub_f32 v44, v44, v230
    v_sub_f32 v12, v12, v230
    v_sub_f32 v77, v77, v230
    v_sub_f32 v45, v45, v230
    v_sub_f32 v13, v13, v230
    v_sub_f32 v78, v78, v230
    v_sub_f32 v46, v46, v230
    v_sub_f32 v14, v14, v230
    v_sub_f32 v79, v79, v230
    v_sub_f32 v47, v47, v230
    v_sub_f32 v15, v15, v230
    v_mul_f32 v226, v226, v232
    v_accvgpr_read_b32 v234, a0
    v_mul_f32 v234, v234, v232
    v_accvgpr_write_b32 a0, v234
    v_accvgpr_read_b32 v235, a1
    v_mul_f32 v235, v235, v232
    v_accvgpr_write_b32 a1, v235
    v_accvgpr_read_b32 v236, a2
    v_mul_f32 v236, v236, v232
    v_accvgpr_write_b32 a2, v236
    v_accvgpr_read_b32 v237, a3
    v_mul_f32 v237, v237, v232
    v_accvgpr_write_b32 a3, v237
    v_accvgpr_read_b32 v234, a4
    v_mul_f32 v234, v234, v232
    v_accvgpr_write_b32 a4, v234
    v_accvgpr_read_b32 v235, a5
    v_mul_f32 v235, v235, v232
    v_accvgpr_write_b32 a5, v235
    v_accvgpr_read_b32 v236, a6
    v_mul_f32 v236, v236, v232
    v_accvgpr_write_b32 a6, v236
    v_accvgpr_read_b32 v237, a7
    v_mul_f32 v237, v237, v232
    v_accvgpr_write_b32 a7, v237
    v_accvgpr_read_b32 v234, a8
    v_mul_f32 v234, v234, v232
    v_accvgpr_write_b32 a8, v234
    v_accvgpr_read_b32 v235, a9
    v_mul_f32 v235, v235, v232
    v_accvgpr_write_b32 a9, v235
    v_accvgpr_read_b32 v236, a10
    v_mul_f32 v236, v236, v232
    v_accvgpr_write_b32 a10, v236
    v_accvgpr_read_b32 v237, a11
    v_mul_f32 v237, v237, v232
    v_accvgpr_write_b32 a11, v237
    v_accvgpr_read_b32 v234, a12
    v_mul_f32 v234, v234, v232
    v_accvgpr_write_b32 a12, v234
    v_accvgpr_read_b32 v235, a13
    v_mul_f32 v235, v235, v232
    v_accvgpr_write_b32 a13, v235
    v_accvgpr_read_b32 v236, a14
    v_mul_f32 v236, v236, v232
    v_accvgpr_write_b32 a14, v236
    v_accvgpr_read_b32 v237, a15
    v_mul_f32 v237, v237, v232
    v_accvgpr_write_b32 a15, v237
    v_accvgpr_read_b32 v234, a16
    v_mul_f32 v234, v234, v232
    v_accvgpr_write_b32 a16, v234
    v_accvgpr_read_b32 v235, a17
    v_mul_f32 v235, v235, v232
    v_accvgpr_write_b32 a17, v235
    v_accvgpr_read_b32 v236, a18
    v_mul_f32 v236, v236, v232
    v_accvgpr_write_b32 a18, v236
    v_accvgpr_read_b32 v237, a19
    v_mul_f32 v237, v237, v232
    v_accvgpr_write_b32 a19, v237
    v_accvgpr_read_b32 v234, a20
    v_mul_f32 v234, v234, v232
    v_accvgpr_write_b32 a20, v234
    v_accvgpr_read_b32 v235, a21
    v_mul_f32 v235, v235, v232
    v_accvgpr_write_b32 a21, v235
    v_accvgpr_read_b32 v236, a22
    v_mul_f32 v236, v236, v232
    v_accvgpr_write_b32 a22, v236
    v_accvgpr_read_b32 v237, a23
    v_mul_f32 v237, v237, v232
    v_accvgpr_write_b32 a23, v237
    v_accvgpr_read_b32 v234, a24
    v_mul_f32 v234, v234, v232
    v_accvgpr_write_b32 a24, v234
    v_accvgpr_read_b32 v235, a25
    v_mul_f32 v235, v235, v232
    v_accvgpr_write_b32 a25, v235
    v_accvgpr_read_b32 v236, a26
    v_mul_f32 v236, v236, v232
    v_accvgpr_write_b32 a26, v236
    v_accvgpr_read_b32 v237, a27
    v_mul_f32 v237, v237, v232
    v_accvgpr_write_b32 a27, v237
    v_accvgpr_read_b32 v234, a28
    v_mul_f32 v234, v234, v232
    v_accvgpr_write_b32 a28, v234
    v_accvgpr_read_b32 v235, a29
    v_mul_f32 v235, v235, v232
    v_accvgpr_write_b32 a29, v235
    v_accvgpr_read_b32 v236, a30
    v_mul_f32 v236, v236, v232
    v_accvgpr_write_b32 a30, v236
    v_accvgpr_read_b32 v237, a31
    v_mul_f32 v237, v237, v232
    v_accvgpr_write_b32 a31, v237
    v_accvgpr_read_b32 v234, a32
    v_mul_f32 v234, v234, v232
    v_accvgpr_write_b32 a32, v234
    v_accvgpr_read_b32 v235, a33
    v_mul_f32 v235, v235, v232
    v_accvgpr_write_b32 a33, v235
    v_accvgpr_read_b32 v236, a34
    v_mul_f32 v236, v236, v232
    v_accvgpr_write_b32 a34, v236
    v_accvgpr_read_b32 v237, a35
    v_mul_f32 v237, v237, v232
    v_accvgpr_write_b32 a35, v237
    v_accvgpr_read_b32 v234, a36
    v_mul_f32 v234, v234, v232
    v_accvgpr_write_b32 a36, v234
    v_accvgpr_read_b32 v235, a37
    v_mul_f32 v235, v235, v232
    v_accvgpr_write_b32 a37, v235
    v_accvgpr_read_b32 v236, a38
    v_mul_f32 v236, v236, v232
    v_accvgpr_write_b32 a38, v236
    v_accvgpr_read_b32 v237, a39
    v_mul_f32 v237, v237, v232
    v_accvgpr_write_b32 a39, v237
    v_accvgpr_read_b32 v234, a40
    v_mul_f32 v234, v234, v232
    v_accvgpr_write_b32 a40, v234
    v_accvgpr_read_b32 v235, a41
    v_mul_f32 v235, v235, v232
    v_accvgpr_write_b32 a41, v235
    v_accvgpr_read_b32 v236, a42
    v_mul_f32 v236, v236, v232
    v_accvgpr_write_b32 a42, v236
    v_accvgpr_read_b32 v237, a43
    v_mul_f32 v237, v237, v232
    v_accvgpr_write_b32 a43, v237
    v_accvgpr_read_b32 v234, a44
    v_mul_f32 v234, v234, v232
    v_accvgpr_write_b32 a44, v234
    v_accvgpr_read_b32 v235, a45
    v_mul_f32 v235, v235, v232
    v_accvgpr_write_b32 a45, v235
    v_accvgpr_read_b32 v236, a46
    v_mul_f32 v236, v236, v232
    v_accvgpr_write_b32 a46, v236
    v_accvgpr_read_b32 v237, a47
    v_mul_f32 v237, v237, v232
    v_accvgpr_write_b32 a47, v237
    v_accvgpr_read_b32 v234, a48
    v_mul_f32 v234, v234, v232
    v_accvgpr_write_b32 a48, v234
    v_accvgpr_read_b32 v235, a49
    v_mul_f32 v235, v235, v232
    v_accvgpr_write_b32 a49, v235
    v_accvgpr_read_b32 v236, a50
    v_mul_f32 v236, v236, v232
    v_accvgpr_write_b32 a50, v236
    v_accvgpr_read_b32 v237, a51
    v_mul_f32 v237, v237, v232
    v_accvgpr_write_b32 a51, v237
    v_accvgpr_read_b32 v234, a52
    v_mul_f32 v234, v234, v232
    v_accvgpr_write_b32 a52, v234
    v_accvgpr_read_b32 v235, a53
    v_mul_f32 v235, v235, v232
    v_accvgpr_write_b32 a53, v235
    v_accvgpr_read_b32 v236, a54
    v_mul_f32 v236, v236, v232
    v_accvgpr_write_b32 a54, v236
    v_accvgpr_read_b32 v237, a55
    v_mul_f32 v237, v237, v232
    v_accvgpr_write_b32 a55, v237
    v_accvgpr_read_b32 v234, a56
    v_mul_f32 v234, v234, v232
    v_accvgpr_write_b32 a56, v234
    v_accvgpr_read_b32 v235, a57
    v_mul_f32 v235, v235, v232
    v_accvgpr_write_b32 a57, v235
    v_accvgpr_read_b32 v236, a58
    v_mul_f32 v236, v236, v232
    v_accvgpr_write_b32 a58, v236
    v_accvgpr_read_b32 v237, a59
    v_mul_f32 v237, v237, v232
    v_accvgpr_write_b32 a59, v237
    v_accvgpr_read_b32 v234, a60
    v_mul_f32 v234, v234, v232
    v_accvgpr_write_b32 a60, v234
    v_accvgpr_read_b32 v235, a61
    v_mul_f32 v235, v235, v232
    v_accvgpr_write_b32 a61, v235
    v_accvgpr_read_b32 v236, a62
    v_mul_f32 v236, v236, v232
    v_accvgpr_write_b32 a62, v236
    v_accvgpr_read_b32 v237, a63
    v_mul_f32 v237, v237, v232
    v_accvgpr_write_b32 a63, v237
    v_exp_f32 v136, v0
    v_exp_f32 v137, v1
    v_exp_f32 v130, v2
    v_exp_f32 v131, v3
    v_cvt_pk_bf16_f32 v96, v136, v137
    v_exp_f32 v132, v4
    v_exp_f32 v133, v5
    v_cvt_pk_bf16_f32 v97, v130, v131
    v_add_f32 v136, v136, v130
    v_add_f32 v137, v137, v131
    v_exp_f32 v134, v6
    v_exp_f32 v135, v7
    v_cvt_pk_bf16_f32 v98, v132, v133
    v_add_f32 v136, v136, v132
    v_add_f32 v137, v137, v133
    v_exp_f32 v128, v8
    v_exp_f32 v129, v9
    v_cvt_pk_bf16_f32 v99, v134, v135
    v_add_f32 v136, v136, v134
    v_add_f32 v137, v137, v135
    v_exp_f32 v130, v10
    v_exp_f32 v131, v11
    v_cvt_pk_bf16_f32 v100, v128, v129
    v_add_f32 v136, v136, v128
    v_add_f32 v137, v137, v129
    v_exp_f32 v132, v12
    v_exp_f32 v133, v13
    v_cvt_pk_bf16_f32 v101, v130, v131
    v_add_f32 v136, v136, v130
    v_add_f32 v137, v137, v131
    v_exp_f32 v134, v14
    v_exp_f32 v135, v15
    v_cvt_pk_bf16_f32 v102, v132, v133
    v_add_f32 v136, v136, v132
    v_add_f32 v137, v137, v133
    v_cvt_pk_bf16_f32 v103, v134, v135
    v_add_f32 v136, v136, v134
    v_add_f32 v137, v137, v135
    v_add_f32 v224, v136, v137
    v_max3_f32 v230, v16, v17, v18
    v_max3_f32 v230, v230, v19, v20
    v_max3_f32 v230, v230, v21, v22
    v_max3_f32 v230, v230, v23, v24
    v_max3_f32 v230, v230, v25, v26
    v_max3_f32 v230, v230, v27, v28
    v_max3_f32 v230, v230, v29, v30
    v_max_f32 v230, v230, v31
    v_mov_b32 v231, v230
    s_nop 1
    v_permlane32_swap_b32 v230, v231
    s_nop 0
    v_max_f32 v230, v230, v231
    v_max_f32 v230, 0, v230
    v_sub_f32 v232, 0, v230
    v_exp_f32 v232, v232
    v_sub_f32 v229, v229, v230
    v_sub_f32 v80, v80, v230
    v_sub_f32 v48, v48, v230
    v_sub_f32 v16, v16, v230
    v_sub_f32 v81, v81, v230
    v_sub_f32 v49, v49, v230
    v_sub_f32 v17, v17, v230
    v_sub_f32 v82, v82, v230
    v_sub_f32 v50, v50, v230
    v_sub_f32 v18, v18, v230
    v_sub_f32 v83, v83, v230
    v_sub_f32 v51, v51, v230
    v_sub_f32 v19, v19, v230
    v_sub_f32 v84, v84, v230
    v_sub_f32 v52, v52, v230
    v_sub_f32 v20, v20, v230
    v_sub_f32 v85, v85, v230
    v_sub_f32 v53, v53, v230
    v_sub_f32 v21, v21, v230
    v_sub_f32 v86, v86, v230
    v_sub_f32 v54, v54, v230
    v_sub_f32 v22, v22, v230
    v_sub_f32 v87, v87, v230
    v_sub_f32 v55, v55, v230
    v_sub_f32 v23, v23, v230
    v_sub_f32 v88, v88, v230
    v_sub_f32 v56, v56, v230
    v_sub_f32 v24, v24, v230
    v_sub_f32 v89, v89, v230
    v_sub_f32 v57, v57, v230
    v_sub_f32 v25, v25, v230
    v_sub_f32 v90, v90, v230
    v_sub_f32 v58, v58, v230
    v_sub_f32 v26, v26, v230
    v_sub_f32 v91, v91, v230
    v_sub_f32 v59, v59, v230
    v_sub_f32 v27, v27, v230
    v_sub_f32 v92, v92, v230
    v_sub_f32 v60, v60, v230
    v_sub_f32 v28, v28, v230
    v_sub_f32 v93, v93, v230
    v_sub_f32 v61, v61, v230
    v_sub_f32 v29, v29, v230
    v_sub_f32 v94, v94, v230
    v_sub_f32 v62, v62, v230
    v_sub_f32 v30, v30, v230
    v_sub_f32 v95, v95, v230
    v_sub_f32 v63, v63, v230
    v_sub_f32 v31, v31, v230
    v_mul_f32 v227, v227, v232
    v_accvgpr_read_b32 v234, a64
    v_mul_f32 v234, v234, v232
    v_accvgpr_write_b32 a64, v234
    v_accvgpr_read_b32 v235, a65
    v_mul_f32 v235, v235, v232
    v_accvgpr_write_b32 a65, v235
    v_accvgpr_read_b32 v236, a66
    v_mul_f32 v236, v236, v232
    v_accvgpr_write_b32 a66, v236
    v_accvgpr_read_b32 v237, a67
    v_mul_f32 v237, v237, v232
    v_accvgpr_write_b32 a67, v237
    v_accvgpr_read_b32 v234, a68
    v_mul_f32 v234, v234, v232
    v_accvgpr_write_b32 a68, v234
    v_accvgpr_read_b32 v235, a69
    v_mul_f32 v235, v235, v232
    v_accvgpr_write_b32 a69, v235
    v_accvgpr_read_b32 v236, a70
    v_mul_f32 v236, v236, v232
    v_accvgpr_write_b32 a70, v236
    v_accvgpr_read_b32 v237, a71
    v_mul_f32 v237, v237, v232
    v_accvgpr_write_b32 a71, v237
    v_accvgpr_read_b32 v234, a72
    v_mul_f32 v234, v234, v232
    v_accvgpr_write_b32 a72, v234
    v_accvgpr_read_b32 v235, a73
    v_mul_f32 v235, v235, v232
    v_accvgpr_write_b32 a73, v235
    v_accvgpr_read_b32 v236, a74
    v_mul_f32 v236, v236, v232
    v_accvgpr_write_b32 a74, v236
    v_accvgpr_read_b32 v237, a75
    v_mul_f32 v237, v237, v232
    v_accvgpr_write_b32 a75, v237
    v_accvgpr_read_b32 v234, a76
    v_mul_f32 v234, v234, v232
    v_accvgpr_write_b32 a76, v234
    v_accvgpr_read_b32 v235, a77
    v_mul_f32 v235, v235, v232
    v_accvgpr_write_b32 a77, v235
    v_accvgpr_read_b32 v236, a78
    v_mul_f32 v236, v236, v232
    v_accvgpr_write_b32 a78, v236
    v_accvgpr_read_b32 v237, a79
    v_mul_f32 v237, v237, v232
    v_accvgpr_write_b32 a79, v237
    v_accvgpr_read_b32 v234, a80
    v_mul_f32 v234, v234, v232
    v_accvgpr_write_b32 a80, v234
    v_accvgpr_read_b32 v235, a81
    v_mul_f32 v235, v235, v232
    v_accvgpr_write_b32 a81, v235
    v_accvgpr_read_b32 v236, a82
    v_mul_f32 v236, v236, v232
    v_accvgpr_write_b32 a82, v236
    v_accvgpr_read_b32 v237, a83
    v_mul_f32 v237, v237, v232
    v_accvgpr_write_b32 a83, v237
    v_accvgpr_read_b32 v234, a84
    v_mul_f32 v234, v234, v232
    v_accvgpr_write_b32 a84, v234
    v_accvgpr_read_b32 v235, a85
    v_mul_f32 v235, v235, v232
    v_accvgpr_write_b32 a85, v235
    v_accvgpr_read_b32 v236, a86
    v_mul_f32 v236, v236, v232
    v_accvgpr_write_b32 a86, v236
    v_accvgpr_read_b32 v237, a87
    v_mul_f32 v237, v237, v232
    v_accvgpr_write_b32 a87, v237
    v_accvgpr_read_b32 v234, a88
    v_mul_f32 v234, v234, v232
    v_accvgpr_write_b32 a88, v234
    v_accvgpr_read_b32 v235, a89
    v_mul_f32 v235, v235, v232
    v_accvgpr_write_b32 a89, v235
    v_accvgpr_read_b32 v236, a90
    v_mul_f32 v236, v236, v232
    v_accvgpr_write_b32 a90, v236
    v_accvgpr_read_b32 v237, a91
    v_mul_f32 v237, v237, v232
    v_accvgpr_write_b32 a91, v237
    v_accvgpr_read_b32 v234, a92
    v_mul_f32 v234, v234, v232
    v_accvgpr_write_b32 a92, v234
    v_accvgpr_read_b32 v235, a93
    v_mul_f32 v235, v235, v232
    v_accvgpr_write_b32 a93, v235
    v_accvgpr_read_b32 v236, a94
    v_mul_f32 v236, v236, v232
    v_accvgpr_write_b32 a94, v236
    v_accvgpr_read_b32 v237, a95
    v_mul_f32 v237, v237, v232
    v_accvgpr_write_b32 a95, v237
    v_accvgpr_read_b32 v234, a96
    v_mul_f32 v234, v234, v232
    v_accvgpr_write_b32 a96, v234
    v_accvgpr_read_b32 v235, a97
    v_mul_f32 v235, v235, v232
    v_accvgpr_write_b32 a97, v235
    v_accvgpr_read_b32 v236, a98
    v_mul_f32 v236, v236, v232
    v_accvgpr_write_b32 a98, v236
    v_accvgpr_read_b32 v237, a99
    v_mul_f32 v237, v237, v232
    v_accvgpr_write_b32 a99, v237
    v_accvgpr_read_b32 v234, a100
    v_mul_f32 v234, v234, v232
    v_accvgpr_write_b32 a100, v234
    v_accvgpr_read_b32 v235, a101
    v_mul_f32 v235, v235, v232
    v_accvgpr_write_b32 a101, v235
    v_accvgpr_read_b32 v236, a102
    v_mul_f32 v236, v236, v232
    v_accvgpr_write_b32 a102, v236
    v_accvgpr_read_b32 v237, a103
    v_mul_f32 v237, v237, v232
    v_accvgpr_write_b32 a103, v237
    v_accvgpr_read_b32 v234, a104
    v_mul_f32 v234, v234, v232
    v_accvgpr_write_b32 a104, v234
    v_accvgpr_read_b32 v235, a105
    v_mul_f32 v235, v235, v232
    v_accvgpr_write_b32 a105, v235
    v_accvgpr_read_b32 v236, a106
    v_mul_f32 v236, v236, v232
    v_accvgpr_write_b32 a106, v236
    v_accvgpr_read_b32 v237, a107
    v_mul_f32 v237, v237, v232
    v_accvgpr_write_b32 a107, v237
    v_accvgpr_read_b32 v234, a108
    v_mul_f32 v234, v234, v232
    v_accvgpr_write_b32 a108, v234
    v_accvgpr_read_b32 v235, a109
    v_mul_f32 v235, v235, v232
    v_accvgpr_write_b32 a109, v235
    v_accvgpr_read_b32 v236, a110
    v_mul_f32 v236, v236, v232
    v_accvgpr_write_b32 a110, v236
    v_accvgpr_read_b32 v237, a111
    v_mul_f32 v237, v237, v232
    v_accvgpr_write_b32 a111, v237
    v_accvgpr_read_b32 v234, a112
    v_mul_f32 v234, v234, v232
    v_accvgpr_write_b32 a112, v234
    v_accvgpr_read_b32 v235, a113
    v_mul_f32 v235, v235, v232
    v_accvgpr_write_b32 a113, v235
    v_accvgpr_read_b32 v236, a114
    v_mul_f32 v236, v236, v232
    v_accvgpr_write_b32 a114, v236
    v_accvgpr_read_b32 v237, a115
    v_mul_f32 v237, v237, v232
    v_accvgpr_write_b32 a115, v237
    v_accvgpr_read_b32 v234, a116
    v_mul_f32 v234, v234, v232
    v_accvgpr_write_b32 a116, v234
    v_accvgpr_read_b32 v235, a117
    v_mul_f32 v235, v235, v232
    v_accvgpr_write_b32 a117, v235
    v_accvgpr_read_b32 v236, a118
    v_mul_f32 v236, v236, v232
    v_accvgpr_write_b32 a118, v236
    v_accvgpr_read_b32 v237, a119
    v_mul_f32 v237, v237, v232
    v_accvgpr_write_b32 a119, v237
    v_accvgpr_read_b32 v234, a120
    v_mul_f32 v234, v234, v232
    v_accvgpr_write_b32 a120, v234
    v_accvgpr_read_b32 v235, a121
    v_mul_f32 v235, v235, v232
    v_accvgpr_write_b32 a121, v235
    v_accvgpr_read_b32 v236, a122
    v_mul_f32 v236, v236, v232
    v_accvgpr_write_b32 a122, v236
    v_accvgpr_read_b32 v237, a123
    v_mul_f32 v237, v237, v232
    v_accvgpr_write_b32 a123, v237
    v_accvgpr_read_b32 v234, a124
    v_mul_f32 v234, v234, v232
    v_accvgpr_write_b32 a124, v234
    v_accvgpr_read_b32 v235, a125
    v_mul_f32 v235, v235, v232
    v_accvgpr_write_b32 a125, v235
    v_accvgpr_read_b32 v236, a126
    v_mul_f32 v236, v236, v232
    v_accvgpr_write_b32 a126, v236
    v_accvgpr_read_b32 v237, a127
    v_mul_f32 v237, v237, v232
    v_accvgpr_write_b32 a127, v237
    v_exp_f32 v138, v16
    v_exp_f32 v139, v17
    v_exp_f32 v130, v18
    v_exp_f32 v131, v19
    v_cvt_pk_bf16_f32 v104, v138, v139
    v_exp_f32 v132, v20
    v_exp_f32 v133, v21
    v_cvt_pk_bf16_f32 v105, v130, v131
    v_add_f32 v138, v138, v130
    v_add_f32 v139, v139, v131
    v_exp_f32 v134, v22
    v_exp_f32 v135, v23
    v_cvt_pk_bf16_f32 v106, v132, v133
    v_add_f32 v138, v138, v132
    v_add_f32 v139, v139, v133
    v_exp_f32 v128, v24
    v_exp_f32 v129, v25
    v_cvt_pk_bf16_f32 v107, v134, v135
    v_add_f32 v138, v138, v134
    v_add_f32 v139, v139, v135
    v_exp_f32 v130, v26
    v_exp_f32 v131, v27
    v_cvt_pk_bf16_f32 v108, v128, v129
    v_add_f32 v138, v138, v128
    v_add_f32 v139, v139, v129
    v_exp_f32 v132, v28
    v_exp_f32 v133, v29
    v_cvt_pk_bf16_f32 v109, v130, v131
    v_add_f32 v138, v138, v130
    v_add_f32 v139, v139, v131
    v_exp_f32 v134, v30
    v_exp_f32 v135, v31
    v_cvt_pk_bf16_f32 v110, v132, v133
    v_add_f32 v138, v138, v132
    v_add_f32 v139, v139, v133
    v_cvt_pk_bf16_f32 v111, v134, v135
    v_add_f32 v138, v138, v134
    v_add_f32 v139, v139, v135
    v_add_f32 v225, v138, v139
    s_nop 1
    s_branch kf_rr11
kf_fix13:
    s_cmp_eq_u32 s33, 0
    s_cselect_b32 s24, 0, 0x74000000
    s_cselect_b32 s36, 0, 0x1000
    s_mov_b32 s33, 1
    v_subrev_f32 v230, s24, v243
    v_add_f32 v231, 0, v230
    v_min_f32 v80, v229, v231
    v_add_f32 v232, 0xf1800000, v230
    v_min_f32 v81, v229, v232
    v_add_f32 v231, 0xf2000000, v230
    v_min_f32 v82, v229, v231
    v_add_f32 v232, 0xf2400000, v230
    v_min_f32 v83, v229, v232
    v_add_f32 v231, 0xf3000000, v230
    v_min_f32 v84, v229, v231
    v_add_f32 v232, 0xf3100000, v230
    v_min_f32 v85, v229, v232
    v_add_f32 v231, 0xf3200000, v230
    v_min_f32 v86, v229, v231
    v_add_f32 v232, 0xf3300000, v230
    v_min_f32 v87, v229, v232
    v_add_f32 v231, 0xf3800000, v230
    v_min_f32 v88, v229, v231
    v_add_f32 v232, 0xf3880000, v230
    v_min_f32 v89, v229, v232
    v_add_f32 v231, 0xf3900000, v230
    v_min_f32 v90, v229, v231
    v_add_f32 v232, 0xf3980000, v230
    v_min_f32 v91, v229, v232
    v_add_f32 v231, 0xf3c00000, v230
    v_min_f32 v92, v229, v231
    v_add_f32 v232, 0xf3c80000, v230
    v_min_f32 v93, v229, v232
    v_add_f32 v231, 0xf3d00000, v230
    v_min_f32 v94, v229, v231
    v_add_f32 v232, 0xf3d80000, v230
    v_min_f32 v95, v229, v232
    s_nop 1
    s_branch kf_fixr14
kf_rare16:
    s_nop 15
    v_max3_f32 v230, v32, v33, v34
    v_max3_f32 v230, v230, v35, v36
    v_max3_f32 v230, v230, v37, v38
    v_max3_f32 v230, v230, v39, v40
    v_max3_f32 v230, v230, v41, v42
    v_max3_f32 v230, v230, v43, v44
    v_max3_f32 v230, v230, v45, v46
    v_max_f32 v230, v230, v47
    v_mov_b32 v231, v230
    s_nop 1
    v_permlane32_swap_b32 v230, v231
    s_nop 0
    v_max_f32 v230, v230, v231
    v_max_f32 v230, 0, v230
    v_sub_f32 v232, 0, v230
    v_exp_f32 v232, v232
    v_sub_f32 v228, v228, v230
    v_sub_f32 v64, v64, v230
    v_sub_f32 v0, v0, v230
    v_sub_f32 v32, v32, v230
    v_sub_f32 v65, v65, v230
    v_sub_f32 v1, v1, v230
    v_sub_f32 v33, v33, v230
    v_sub_f32 v66, v66, v230
    v_sub_f32 v2, v2, v230
    v_sub_f32 v34, v34, v230
    v_sub_f32 v67, v67, v230
    v_sub_f32 v3, v3, v230
    v_sub_f32 v35, v35, v230
    v_sub_f32 v68, v68, v230
    v_sub_f32 v4, v4, v230
    v_sub_f32 v36, v36, v230
    v_sub_f32 v69, v69, v230
    v_sub_f32 v5, v5, v230
    v_sub_f32 v37, v37, v230
    v_sub_f32 v70, v70, v230
    v_sub_f32 v6, v6, v230
    v_sub_f32 v38, v38, v230
    v_sub_f32 v71, v71, v230
    v_sub_f32 v7, v7, v230
    v_sub_f32 v39, v39, v230
    v_sub_f32 v72, v72, v230
    v_sub_f32 v8, v8, v230
    v_sub_f32 v40, v40, v230
    v_sub_f32 v73, v73, v230
    v_sub_f32 v9, v9, v230
    v_sub_f32 v41, v41, v230
    v_sub_f32 v74, v74, v230
    v_sub_f32 v10, v10, v230
    v_sub_f32 v42, v42, v230
    v_sub_f32 v75, v75, v230
    v_sub_f32 v11, v11, v230
    v_sub_f32 v43, v43, v230
    v_sub_f32 v76, v76, v230
    v_sub_f32 v12, v12, v230
    v_sub_f32 v44, v44, v230
    v_sub_f32 v77, v77, v230
    v_sub_f32 v13, v13, v230
    v_sub_f32 v45, v45, v230
    v_sub_f32 v78, v78, v230
    v_sub_f32 v14, v14, v230
    v_sub_f32 v46, v46, v230
    v_sub_f32 v79, v79, v230
    v_sub_f32 v15, v15, v230
    v_sub_f32 v47, v47, v230
    v_mul_f32 v226, v226, v232
    v_accvgpr_read_b32 v234, a0
    v_mul_f32 v234, v234, v232
    v_accvgpr_write_b32 a0, v234
    v_accvgpr_read_b32 v235, a1
    v_mul_f32 v235, v235, v232
    v_accvgpr_write_b32 a1, v235
    v_accvgpr_read_b32 v236, a2
    v_mul_f32 v236, v236, v232
    v_accvgpr_write_b32 a2, v236
    v_accvgpr_read_b32 v237, a3
    v_mul_f32 v237, v237, v232
    v_accvgpr_write_b32 a3, v237
    v_accvgpr_read_b32 v234, a4
    v_mul_f32 v234, v234, v232
    v_accvgpr_write_b32 a4, v234
    v_accvgpr_read_b32 v235, a5
    v_mul_f32 v235, v235, v232
    v_accvgpr_write_b32 a5, v235
    v_accvgpr_read_b32 v236, a6
    v_mul_f32 v236, v236, v232
    v_accvgpr_write_b32 a6, v236
    v_accvgpr_read_b32 v237, a7
    v_mul_f32 v237, v237, v232
    v_accvgpr_write_b32 a7, v237
    v_accvgpr_read_b32 v234, a8
    v_mul_f32 v234, v234, v232
    v_accvgpr_write_b32 a8, v234
    v_accvgpr_read_b32 v235, a9
    v_mul_f32 v235, v235, v232
    v_accvgpr_write_b32 a9, v235
    v_accvgpr_read_b32 v236, a10
    v_mul_f32 v236, v236, v232
    v_accvgpr_write_b32 a10, v236
    v_accvgpr_read_b32 v237, a11
    v_mul_f32 v237, v237, v232
    v_accvgpr_write_b32 a11, v237
    v_accvgpr_read_b32 v234, a12
    v_mul_f32 v234, v234, v232
    v_accvgpr_write_b32 a12, v234
    v_accvgpr_read_b32 v235, a13
    v_mul_f32 v235, v235, v232
    v_accvgpr_write_b32 a13, v235
    v_accvgpr_read_b32 v236, a14
    v_mul_f32 v236, v236, v232
    v_accvgpr_write_b32 a14, v236
    v_accvgpr_read_b32 v237, a15
    v_mul_f32 v237, v237, v232
    v_accvgpr_write_b32 a15, v237
    v_accvgpr_read_b32 v234, a16
    v_mul_f32 v234, v234, v232
    v_accvgpr_write_b32 a16, v234
    v_accvgpr_read_b32 v235, a17
    v_mul_f32 v235, v235, v232
    v_accvgpr_write_b32 a17, v235
    v_accvgpr_read_b32 v236, a18
    v_mul_f32 v236, v236, v232
    v_accvgpr_write_b32 a18, v236
    v_accvgpr_read_b32 v237, a19
    v_mul_f32 v237, v237, v232
    v_accvgpr_write_b32 a19, v237
    v_accvgpr_read_b32 v234, a20
    v_mul_f32 v234, v234, v232
    v_accvgpr_write_b32 a20, v234
    v_accvgpr_read_b32 v235, a21
    v_mul_f32 v235, v235, v232
    v_accvgpr_write_b32 a21, v235
    v_accvgpr_read_b32 v236, a22
    v_mul_f32 v236, v236, v232
    v_accvgpr_write_b32 a22, v236
    v_accvgpr_read_b32 v237, a23
    v_mul_f32 v237, v237, v232
    v_accvgpr_write_b32 a23, v237
    v_accvgpr_read_b32 v234, a24
    v_mul_f32 v234, v234, v232
    v_accvgpr_write_b32 a24, v234
    v_accvgpr_read_b32 v235, a25
    v_mul_f32 v235, v235, v232
    v_accvgpr_write_b32 a25, v235
    v_accvgpr_read_b32 v236, a26
    v_mul_f32 v236, v236, v232
    v_accvgpr_write_b32 a26, v236
    v_accvgpr_read_b32 v237, a27
    v_mul_f32 v237, v237, v232
    v_accvgpr_write_b32 a27, v237
    v_accvgpr_read_b32 v234, a28
    v_mul_f32 v234, v234, v232
    v_accvgpr_write_b32 a28, v234
    v_accvgpr_read_b32 v235, a29
    v_mul_f32 v235, v235, v232
    v_accvgpr_write_b32 a29, v235
    v_accvgpr_read_b32 v236, a30
    v_mul_f32 v236, v236, v232
    v_accvgpr_write_b32 a30, v236
    v_accvgpr_read_b32 v237, a31
    v_mul_f32 v237, v237, v232
    v_accvgpr_write_b32 a31, v237
    v_accvgpr_read_b32 v234, a32
    v_mul_f32 v234, v234, v232
    v_accvgpr_write_b32 a32, v234
    v_accvgpr_read_b32 v235, a33
    v_mul_f32 v235, v235, v232
    v_accvgpr_write_b32 a33, v235
    v_accvgpr_read_b32 v236, a34
    v_mul_f32 v236, v236, v232
    v_accvgpr_write_b32 a34, v236
    v_accvgpr_read_b32 v237, a35
    v_mul_f32 v237, v237, v232
    v_accvgpr_write_b32 a35, v237
    v_accvgpr_read_b32 v234, a36
    v_mul_f32 v234, v234, v232
    v_accvgpr_write_b32 a36, v234
    v_accvgpr_read_b32 v235, a37
    v_mul_f32 v235, v235, v232
    v_accvgpr_write_b32 a37, v235
    v_accvgpr_read_b32 v236, a38
    v_mul_f32 v236, v236, v232
    v_accvgpr_write_b32 a38, v236
    v_accvgpr_read_b32 v237, a39
    v_mul_f32 v237, v237, v232
    v_accvgpr_write_b32 a39, v237
    v_accvgpr_read_b32 v234, a40
    v_mul_f32 v234, v234, v232
    v_accvgpr_write_b32 a40, v234
    v_accvgpr_read_b32 v235, a41
    v_mul_f32 v235, v235, v232
    v_accvgpr_write_b32 a41, v235
    v_accvgpr_read_b32 v236, a42
    v_mul_f32 v236, v236, v232
    v_accvgpr_write_b32 a42, v236
    v_accvgpr_read_b32 v237, a43
    v_mul_f32 v237, v237, v232
    v_accvgpr_write_b32 a43, v237
    v_accvgpr_read_b32 v234, a44
    v_mul_f32 v234, v234, v232
    v_accvgpr_write_b32 a44, v234
    v_accvgpr_read_b32 v235, a45
    v_mul_f32 v235, v235, v232
    v_accvgpr_write_b32 a45, v235
    v_accvgpr_read_b32 v236, a46
    v_mul_f32 v236, v236, v232
    v_accvgpr_write_b32 a46, v236
    v_accvgpr_read_b32 v237, a47
    v_mul_f32 v237, v237, v232
    v_accvgpr_write_b32 a47, v237
    v_accvgpr_read_b32 v234, a48
    v_mul_f32 v234, v234, v232
    v_accvgpr_write_b32 a48, v234
    v_accvgpr_read_b32 v235, a49
    v_mul_f32 v235, v235, v232
    v_accvgpr_write_b32 a49, v235
    v_accvgpr_read_b32 v236, a50
    v_mul_f32 v236, v236, v232
    v_accvgpr_write_b32 a50, v236
    v_accvgpr_read_b32 v237, a51
    v_mul_f32 v237, v237, v232
    v_accvgpr_write_b32 a51, v237
    v_accvgpr_read_b32 v234, a52
    v_mul_f32 v234, v234, v232
    v_accvgpr_write_b32 a52, v234
    v_accvgpr_read_b32 v235, a53
    v_mul_f32 v235, v235, v232
    v_accvgpr_write_b32 a53, v235
    v_accvgpr_read_b32 v236, a54
    v_mul_f32 v236, v236, v232
    v_accvgpr_write_b32 a54, v236
    v_accvgpr_read_b32 v237, a55
    v_mul_f32 v237, v237, v232
    v_accvgpr_write_b32 a55, v237
    v_accvgpr_read_b32 v234, a56
    v_mul_f32 v234, v234, v232
    v_accvgpr_write_b32 a56, v234
    v_accvgpr_read_b32 v235, a57
    v_mul_f32 v235, v235, v232
    v_accvgpr_write_b32 a57, v235
    v_accvgpr_read_b32 v236, a58
    v_mul_f32 v236, v236, v232
    v_accvgpr_write_b32 a58, v236
    v_accvgpr_read_b32 v237, a59
    v_mul_f32 v237, v237, v232
    v_accvgpr_write_b32 a59, v237
    v_accvgpr_read_b32 v234, a60
    v_mul_f32 v234, v234, v232
    v_accvgpr_write_b32 a60, v234
    v_accvgpr_read_b32 v235, a61
    v_mul_f32 v235, v235, v232
    v_accvgpr_write_b32 a61, v235
    v_accvgpr_read_b32 v236, a62
    v_mul_f32 v236, v236, v232
    v_accvgpr_write_b32 a62, v236
    v_accvgpr_read_b32 v237, a63
    v_mul_f32 v237, v237, v232
    v_accvgpr_write_b32 a63, v237
    v_exp_f32 v136, v32
    v_exp_f32 v137, v33
    v_exp_f32 v130, v34
    v_exp_f32 v131, v35
    v_cvt_pk_bf16_f32 v112, v136, v137
    v_exp_f32 v132, v36
    v_exp_f32 v133, v37
    v_cvt_pk_bf16_f32 v113, v130, v131
    v_add_f32 v136, v136, v130
    v_add_f32 v137, v137, v131
    v_exp_f32 v134, v38
    v_exp_f32 v135, v39
    v_cvt_pk_bf16_f32 v114, v132, v133
    v_add_f32 v136, v136, v132
    v_add_f32 v137, v137, v133
    v_exp_f32 v128, v40
    v_exp_f32 v129, v41
    v_cvt_pk_bf16_f32 v115, v134, v135
    v_add_f32 v136, v136, v134
    v_add_f32 v137, v137, v135
    v_exp_f32 v130, v42
    v_exp_f32 v131, v43
    v_cvt_pk_bf16_f32 v116, v128, v129
    v_add_f32 v136, v136, v128
    v_add_f32 v137, v137, v129
    v_exp_f32 v132, v44
    v_exp_f32 v133, v45
    v_cvt_pk_bf16_f32 v117, v130, v131
    v_add_f32 v136, v136, v130
    v_add_f32 v137, v137, v131
    v_exp_f32 v134, v46
    v_exp_f32 v135, v47
    v_cvt_pk_bf16_f32 v118, v132, v133
    v_add_f32 v136, v136, v132
    v_add_f32 v137, v137, v133
    v_cvt_pk_bf16_f32 v119, v134, v135
    v_add_f32 v136, v136, v134
    v_add_f32 v137, v137, v135
    v_add_f32 v224, v136, v137
    v_max3_f32 v230, v48, v49, v50
    v_max3_f32 v230, v230, v51, v52
    v_max3_f32 v230, v230, v53, v54
    v_max3_f32 v230, v230, v55, v56
    v_max3_f32 v230, v230, v57, v58
    v_max3_f32 v230, v230, v59, v60
    v_max3_f32 v230, v230, v61, v62
    v_max_f32 v230, v230, v63
    v_mov_b32 v231, v230
    s_nop 1
    v_permlane32_swap_b32 v230, v231
    s_nop 0
    v_max_f32 v230, v230, v231
    v_max_f32 v230, 0, v230
    v_sub_f32 v232, 0, v230
    v_exp_f32 v232, v232
    v_sub_f32 v229, v229, v230
    v_sub_f32 v80, v80, v230
    v_sub_f32 v16, v16, v230
    v_sub_f32 v48, v48, v230
    v_sub_f32 v81, v81, v230
    v_sub_f32 v17, v17, v230
    v_sub_f32 v49, v49, v230
    v_sub_f32 v82, v82, v230
    v_sub_f32 v18, v18, v230
    v_sub_f32 v50, v50, v230
    v_sub_f32 v83, v83, v230
    v_sub_f32 v19, v19, v230
    v_sub_f32 v51, v51, v230
    v_sub_f32 v84, v84, v230
    v_sub_f32 v20, v20, v230
    v_sub_f32 v52, v52, v230
    v_sub_f32 v85, v85, v230
    v_sub_f32 v21, v21, v230
    v_sub_f32 v53, v53, v230
    v_sub_f32 v86, v86, v230
    v_sub_f32 v22, v22, v230
    v_sub_f32 v54, v54, v230
    v_sub_f32 v87, v87, v230
    v_sub_f32 v23, v23, v230
    v_sub_f32 v55, v55, v230
    v_sub_f32 v88, v88, v230
    v_sub_f32 v24, v24, v230
    v_sub_f32 v56, v56, v230
    v_sub_f32 v89, v89, v230
    v_sub_f32 v25, v25, v230
    v_sub_f32 v57, v57, v230
    v_sub_f32 v90, v90, v230
    v_sub_f32 v26, v26, v230
    v_sub_f32 v58, v58, v230
    v_sub_f32 v91, v91, v230
    v_sub_f32 v27, v27, v230
    v_sub_f32 v59, v59, v230
    v_sub_f32 v92, v92, v230
    v_sub_f32 v28, v28, v230
    v_sub_f32 v60, v60, v230
    v_sub_f32 v93, v93, v230
    v_sub_f32 v29, v29, v230
    v_sub_f32 v61, v61, v230
    v_sub_f32 v94, v94, v230
    v_sub_f32 v30, v30, v230
    v_sub_f32 v62, v62, v230
    v_sub_f32 v95, v95, v230
    v_sub_f32 v31, v31, v230
    v_sub_f32 v63, v63, v230
    v_mul_f32 v227, v227, v232
    v_accvgpr_read_b32 v234, a64
    v_mul_f32 v234, v234, v232
    v_accvgpr_write_b32 a64, v234
    v_accvgpr_read_b32 v235, a65
    v_mul_f32 v235, v235, v232
    v_accvgpr_write_b32 a65, v235
    v_accvgpr_read_b32 v236, a66
    v_mul_f32 v236, v236, v232
    v_accvgpr_write_b32 a66, v236
    v_accvgpr_read_b32 v237, a67
    v_mul_f32 v237, v237, v232
    v_accvgpr_write_b32 a67, v237
    v_accvgpr_read_b32 v234, a68
    v_mul_f32 v234, v234, v232
    v_accvgpr_write_b32 a68, v234
    v_accvgpr_read_b32 v235, a69
    v_mul_f32 v235, v235, v232
    v_accvgpr_write_b32 a69, v235
    v_accvgpr_read_b32 v236, a70
    v_mul_f32 v236, v236, v232
    v_accvgpr_write_b32 a70, v236
    v_accvgpr_read_b32 v237, a71
    v_mul_f32 v237, v237, v232
    v_accvgpr_write_b32 a71, v237
    v_accvgpr_read_b32 v234, a72
    v_mul_f32 v234, v234, v232
    v_accvgpr_write_b32 a72, v234
    v_accvgpr_read_b32 v235, a73
    v_mul_f32 v235, v235, v232
    v_accvgpr_write_b32 a73, v235
    v_accvgpr_read_b32 v236, a74
    v_mul_f32 v236, v236, v232
    v_accvgpr_write_b32 a74, v236
    v_accvgpr_read_b32 v237, a75
    v_mul_f32 v237, v237, v232
    v_accvgpr_write_b32 a75, v237
    v_accvgpr_read_b32 v234, a76
    v_mul_f32 v234, v234, v232
    v_accvgpr_write_b32 a76, v234
    v_accvgpr_read_b32 v235, a77
    v_mul_f32 v235, v235, v232
    v_accvgpr_write_b32 a77, v235
    v_accvgpr_read_b32 v236, a78
    v_mul_f32 v236, v236, v232
    v_accvgpr_write_b32 a78, v236
    v_accvgpr_read_b32 v237, a79
    v_mul_f32 v237, v237, v232
    v_accvgpr_write_b32 a79, v237
    v_accvgpr_read_b32 v234, a80
    v_mul_f32 v234, v234, v232
    v_accvgpr_write_b32 a80, v234
    v_accvgpr_read_b32 v235, a81
    v_mul_f32 v235, v235, v232
    v_accvgpr_write_b32 a81, v235
    v_accvgpr_read_b32 v236, a82
    v_mul_f32 v236, v236, v232
    v_accvgpr_write_b32 a82, v236
    v_accvgpr_read_b32 v237, a83
    v_mul_f32 v237, v237, v232
    v_accvgpr_write_b32 a83, v237
    v_accvgpr_read_b32 v234, a84
    v_mul_f32 v234, v234, v232
    v_accvgpr_write_b32 a84, v234
    v_accvgpr_read_b32 v235, a85
    v_mul_f32 v235, v235, v232
    v_accvgpr_write_b32 a85, v235
    v_accvgpr_read_b32 v236, a86
    v_mul_f32 v236, v236, v232
    v_accvgpr_write_b32 a86, v236
    v_accvgpr_read_b32 v237, a87
    v_mul_f32 v237, v237, v232
    v_accvgpr_write_b32 a87, v237
    v_accvgpr_read_b32 v234, a88
    v_mul_f32 v234, v234, v232
    v_accvgpr_write_b32 a88, v234
    v_accvgpr_read_b32 v235, a89
    v_mul_f32 v235, v235, v232
    v_accvgpr_write_b32 a89, v235
    v_accvgpr_read_b32 v236, a90
    v_mul_f32 v236, v236, v232
    v_accvgpr_write_b32 a90, v236
    v_accvgpr_read_b32 v237, a91
    v_mul_f32 v237, v237, v232
    v_accvgpr_write_b32 a91, v237
    v_accvgpr_read_b32 v234, a92
    v_mul_f32 v234, v234, v232
    v_accvgpr_write_b32 a92, v234
    v_accvgpr_read_b32 v235, a93
    v_mul_f32 v235, v235, v232
    v_accvgpr_write_b32 a93, v235
    v_accvgpr_read_b32 v236, a94
    v_mul_f32 v236, v236, v232
    v_accvgpr_write_b32 a94, v236
    v_accvgpr_read_b32 v237, a95
    v_mul_f32 v237, v237, v232
    v_accvgpr_write_b32 a95, v237
    v_accvgpr_read_b32 v234, a96
    v_mul_f32 v234, v234, v232
    v_accvgpr_write_b32 a96, v234
    v_accvgpr_read_b32 v235, a97
    v_mul_f32 v235, v235, v232
    v_accvgpr_write_b32 a97, v235
    v_accvgpr_read_b32 v236, a98
    v_mul_f32 v236, v236, v232
    v_accvgpr_write_b32 a98, v236
    v_accvgpr_read_b32 v237, a99
    v_mul_f32 v237, v237, v232
    v_accvgpr_write_b32 a99, v237
    v_accvgpr_read_b32 v234, a100
    v_mul_f32 v234, v234, v232
    v_accvgpr_write_b32 a100, v234
    v_accvgpr_read_b32 v235, a101
    v_mul_f32 v235, v235, v232
    v_accvgpr_write_b32 a101, v235
    v_accvgpr_read_b32 v236, a102
    v_mul_f32 v236, v236, v232
    v_accvgpr_write_b32 a102, v236
    v_accvgpr_read_b32 v237, a103
    v_mul_f32 v237, v237, v232
    v_accvgpr_write_b32 a103, v237
    v_accvgpr_read_b32 v234, a104
    v_mul_f32 v234, v234, v232
    v_accvgpr_write_b32 a104, v234
    v_accvgpr_read_b32 v235, a105
    v_mul_f32 v235, v235, v232
    v_accvgpr_write_b32 a105, v235
    v_accvgpr_read_b32 v236, a106
    v_mul_f32 v236, v236, v232
    v_accvgpr_write_b32 a106, v236
    v_accvgpr_read_b32 v237, a107
    v_mul_f32 v237, v237, v232
    v_accvgpr_write_b32 a107, v237
    v_accvgpr_read_b32 v234, a108
    v_mul_f32 v234, v234, v232
    v_accvgpr_write_b32 a108, v234
    v_accvgpr_read_b32 v235, a109
    v_mul_f32 v235, v235, v232
    v_accvgpr_write_b32 a109, v235
    v_accvgpr_read_b32 v236, a110
    v_mul_f32 v236, v236, v232
    v_accvgpr_write_b32 a110, v236
    v_accvgpr_read_b32 v237, a111
    v_mul_f32 v237, v237, v232
    v_accvgpr_write_b32 a111, v237
    v_accvgpr_read_b32 v234, a112
    v_mul_f32 v234, v234, v232
    v_accvgpr_write_b32 a112, v234
    v_accvgpr_read_b32 v235, a113
    v_mul_f32 v235, v235, v232
    v_accvgpr_write_b32 a113, v235
    v_accvgpr_read_b32 v236, a114
    v_mul_f32 v236, v236, v232
    v_accvgpr_write_b32 a114, v236
    v_accvgpr_read_b32 v237, a115
    v_mul_f32 v237, v237, v232
    v_accvgpr_write_b32 a115, v237
    v_accvgpr_read_b32 v234, a116
    v_mul_f32 v234, v234, v232
    v_accvgpr_write_b32 a116, v234
    v_accvgpr_read_b32 v235, a117
    v_mul_f32 v235, v235, v232
    v_accvgpr_write_b32 a117, v235
    v_accvgpr_read_b32 v236, a118
    v_mul_f32 v236, v236, v232
    v_accvgpr_write_b32 a118, v236
    v_accvgpr_read_b32 v237, a119
    v_mul_f32 v237, v237, v232
    v_accvgpr_write_b32 a119, v237
    v_accvgpr_read_b32 v234, a120
    v_mul_f32 v234, v234, v232
    v_accvgpr_write_b32 a120, v234
    v_accvgpr_read_b32 v235, a121
    v_mul_f32 v235, v235, v232
    v_accvgpr_write_b32 a121, v235
    v_accvgpr_read_b32 v236, a122
    v_mul_f32 v236, v236, v232
    v_accvgpr_write_b32 a122, v236
    v_accvgpr_read_b32 v237, a123
    v_mul_f32 v237, v237, v232
    v_accvgpr_write_b32 a123, v237
    v_accvgpr_read_b32 v234, a124
    v_mul_f32 v234, v234, v232
    v_accvgpr_write_b32 a124, v234
    v_accvgpr_read_b32 v235, a125
    v_mul_f32 v235, v235, v232
    v_accvgpr_write_b32 a125, v235
    v_accvgpr_read_b32 v236, a126
    v_mul_f32 v236, v236, v232
    v_accvgpr_write_b32 a126, v236
    v_accvgpr_read_b32 v237, a127
    v_mul_f32 v237, v237, v232
    v_accvgpr_write_b32 a127, v237
    v_exp_f32 v138, v48
    v_exp_f32 v139, v49
    v_exp_f32 v130, v50
    v_exp_f32 v131, v51
    v_cvt_pk_bf16_f32 v120, v138, v139
    v_exp_f32 v132, v52
    v_exp_f32 v133, v53
    v_cvt_pk_bf16_f32 v121, v130, v131
    v_add_f32 v138, v138, v130
    v_add_f32 v139, v139, v131
    v_exp_f32 v134, v54
    v_exp_f32 v135, v55
    v_cvt_pk_bf16_f32 v122, v132, v133
    v_add_f32 v138, v138, v132
    v_add_f32 v139, v139, v133
    v_exp_f32 v128, v56
    v_exp_f32 v129, v57
    v_cvt_pk_bf16_f32 v123, v134, v135
    v_add_f32 v138, v138, v134
    v_add_f32 v139, v139, v135
    v_exp_f32 v130, v58
    v_exp_f32 v131, v59
    v_cvt_pk_bf16_f32 v124, v128, v129
    v_add_f32 v138, v138, v128
    v_add_f32 v139, v139, v129
    v_exp_f32 v132, v60
    v_exp_f32 v133, v61
    v_cvt_pk_bf16_f32 v125, v130, v131
    v_add_f32 v138, v138, v130
    v_add_f32 v139, v139, v131
    v_exp_f32 v134, v62
    v_exp_f32 v135, v63
    v_cvt_pk_bf16_f32 v126, v132, v133
    v_add_f32 v138, v138, v132
    v_add_f32 v139, v139, v133
    v_cvt_pk_bf16_f32 v127, v134, v135
    v_add_f32 v138, v138, v134
    v_add_f32 v139, v139, v135
    v_add_f32 v225, v138, v139
    s_nop 1
    s_branch kf_rr15
kf_fix17:
    s_cmp_eq_u32 s33, 0
    s_cselect_b32 s24, 0, 0x74000000
    s_cselect_b32 s36, 0, 0x1000
    s_mov_b32 s33, 1
    v_subrev_f32 v230, s24, v243
    v_add_f32 v231, 0, v230
    v_min_f32 v80, v229, v231
    v_add_f32 v232, 0xf1800000, v230
    v_min_f32 v81, v229, v232
    v_add_f32 v231, 0xf2000000, v230
    v_min_f32 v82, v229, v231
    v_add_f32 v232, 0xf2400000, v230
    v_min_f32 v83, v229, v232
    v_add_f32 v231, 0xf3000000, v230
    v_min_f32 v84, v229, v231
    v_add_f32 v232, 0xf3100000, v230
    v_min_f32 v85, v229, v232
    v_add_f32 v231, 0xf3200000, v230
    v_min_f32 v86, v229, v231
    v_add_f32 v232, 0xf3300000, v230
    v_min_f32 v87, v229, v232
    v_add_f32 v231, 0xf3800000, v230
    v_min_f32 v88, v229, v231
    v_add_f32 v232, 0xf3880000, v230
    v_min_f32 v89, v229, v232
    v_add_f32 v231, 0xf3900000, v230
    v_min_f32 v90, v229, v231
    v_add_f32 v232, 0xf3980000, v230
    v_min_f32 v91, v229, v232
    v_add_f32 v231, 0xf3c00000, v230
    v_min_f32 v92, v229, v231
    v_add_f32 v232, 0xf3c80000, v230
    v_min_f32 v93, v229, v232
    v_add_f32 v231, 0xf3d00000, v230
    v_min_f32 v94, v229, v231
    v_add_f32 v232, 0xf3d80000, v230
    v_min_f32 v95, v229, v232
    s_nop 1
    s_branch kf_fixr18
kf_rare20:
    s_nop 15
    v_max3_f32 v230, v16, v17, v18
    v_max3_f32 v230, v230, v19, v20
    v_max3_f32 v230, v230, v21, v22
    v_max3_f32 v230, v230, v23, v24
    v_max3_f32 v230, v230, v25, v26
    v_max3_f32 v230, v230, v27, v28
    v_max3_f32 v230, v230, v29, v30
    v_max_f32 v230, v230, v31
    v_mov_b32 v231, v230
    s_nop 1
    v_permlane32_swap_b32 v230, v231
    s_nop 0
    v_max_f32 v230, v230, v231
    v_max_f32 v230, 0, v230
    v_sub_f32 v232, 0, v230
    v_exp_f32 v232, v232
    v_sub_f32 v229, v229, v230
    v_sub_f32 v80, v80, v230
    v_sub_f32 v48, v48, v230
    v_sub_f32 v16, v16, v230
    v_sub_f32 v81, v81, v230
    v_sub_f32 v49, v49, v230
    v_sub_f32 v17, v17, v230
    v_sub_f32 v82, v82, v230
    v_sub_f32 v50, v50, v230
    v_sub_f32 v18, v18, v230
    v_sub_f32 v83, v83, v230
    v_sub_f32 v51, v51, v230
    v_sub_f32 v19, v19, v230
    v_sub_f32 v84, v84, v230
    v_sub_f32 v52, v52, v230
    v_sub_f32 v20, v20, v230
    v_sub_f32 v85, v85, v230
    v_sub_f32 v53, v53, v230
    v_sub_f32 v21, v21, v230
    v_sub_f32 v86, v86, v230
    v_sub_f32 v54, v54, v230
    v_sub_f32 v22, v22, v230
    v_sub_f32 v87, v87, v230
    v_sub_f32 v55, v55, v230
    v_sub_f32 v23, v23, v230
    v_sub_f32 v88, v88, v230
    v_sub_f32 v56, v56, v230
    v_sub_f32 v24, v24, v230
    v_sub_f32 v89, v89, v230
    v_sub_f32 v57, v57, v230
    v_sub_f32 v25, v25, v230
    v_sub_f32 v90, v90, v230
    v_sub_f32 v58, v58, v230
    v_sub_f32 v26, v26, v230
    v_sub_f32 v91, v91, v230
    v_sub_f32 v59, v59, v230
    v_sub_f32 v27, v27, v230
    v_sub_f32 v92, v92, v230
    v_sub_f32 v60, v60, v230
    v_sub_f32 v28, v28, v230
    v_sub_f32 v93, v93, v230
    v_sub_f32 v61, v61, v230
    v_sub_f32 v29, v29, v230
    v_sub_f32 v94, v94, v230
    v_sub_f32 v62, v62, v230
    v_sub_f32 v30, v30, v230
    v_sub_f32 v95, v95, v230
    v_sub_f32 v63, v63, v230
    v_sub_f32 v31, v31, v230
    v_mul_f32 v227, v227, v232
    v_accvgpr_read_b32 v234, a64
    v_mul_f32 v234, v234, v232
    v_accvgpr_write_b32 a64, v234
    v_accvgpr_read_b32 v235, a65
    v_mul_f32 v235, v235, v232
    v_accvgpr_write_b32 a65, v235
    v_accvgpr_read_b32 v236, a66
    v_mul_f32 v236, v236, v232
    v_accvgpr_write_b32 a66, v236
    v_accvgpr_read_b32 v237, a67
    v_mul_f32 v237, v237, v232
    v_accvgpr_write_b32 a67, v237
    v_accvgpr_read_b32 v234, a68
    v_mul_f32 v234, v234, v232
    v_accvgpr_write_b32 a68, v234
    v_accvgpr_read_b32 v235, a69
    v_mul_f32 v235, v235, v232
    v_accvgpr_write_b32 a69, v235
    v_accvgpr_read_b32 v236, a70
    v_mul_f32 v236, v236, v232
    v_accvgpr_write_b32 a70, v236
    v_accvgpr_read_b32 v237, a71
    v_mul_f32 v237, v237, v232
    v_accvgpr_write_b32 a71, v237
    v_accvgpr_read_b32 v234, a72
    v_mul_f32 v234, v234, v232
    v_accvgpr_write_b32 a72, v234
    v_accvgpr_read_b32 v235, a73
    v_mul_f32 v235, v235, v232
    v_accvgpr_write_b32 a73, v235
    v_accvgpr_read_b32 v236, a74
    v_mul_f32 v236, v236, v232
    v_accvgpr_write_b32 a74, v236
    v_accvgpr_read_b32 v237, a75
    v_mul_f32 v237, v237, v232
    v_accvgpr_write_b32 a75, v237
    v_accvgpr_read_b32 v234, a76
    v_mul_f32 v234, v234, v232
    v_accvgpr_write_b32 a76, v234
    v_accvgpr_read_b32 v235, a77
    v_mul_f32 v235, v235, v232
    v_accvgpr_write_b32 a77, v235
    v_accvgpr_read_b32 v236, a78
    v_mul_f32 v236, v236, v232
    v_accvgpr_write_b32 a78, v236
    v_accvgpr_read_b32 v237, a79
    v_mul_f32 v237, v237, v232
    v_accvgpr_write_b32 a79, v237
    v_accvgpr_read_b32 v234, a80
    v_mul_f32 v234, v234, v232
    v_accvgpr_write_b32 a80, v234
    v_accvgpr_read_b32 v235, a81
    v_mul_f32 v235, v235, v232
    v_accvgpr_write_b32 a81, v235
    v_accvgpr_read_b32 v236, a82
    v_mul_f32 v236, v236, v232
    v_accvgpr_write_b32 a82, v236
    v_accvgpr_read_b32 v237, a83
    v_mul_f32 v237, v237, v232
    v_accvgpr_write_b32 a83, v237
    v_accvgpr_read_b32 v234, a84
    v_mul_f32 v234, v234, v232
    v_accvgpr_write_b32 a84, v234
    v_accvgpr_read_b32 v235, a85
    v_mul_f32 v235, v235, v232
    v_accvgpr_write_b32 a85, v235
    v_accvgpr_read_b32 v236, a86
    v_mul_f32 v236, v236, v232
    v_accvgpr_write_b32 a86, v236
    v_accvgpr_read_b32 v237, a87
    v_mul_f32 v237, v237, v232
    v_accvgpr_write_b32 a87, v237
    v_accvgpr_read_b32 v234, a88
    v_mul_f32 v234, v234, v232
    v_accvgpr_write_b32 a88, v234
    v_accvgpr_read_b32 v235, a89
    v_mul_f32 v235, v235, v232
    v_accvgpr_write_b32 a89, v235
    v_accvgpr_read_b32 v236, a90
    v_mul_f32 v236, v236, v232
    v_accvgpr_write_b32 a90, v236
    v_accvgpr_read_b32 v237, a91
    v_mul_f32 v237, v237, v232
    v_accvgpr_write_b32 a91, v237
    v_accvgpr_read_b32 v234, a92
    v_mul_f32 v234, v234, v232
    v_accvgpr_write_b32 a92, v234
    v_accvgpr_read_b32 v235, a93
    v_mul_f32 v235, v235, v232
    v_accvgpr_write_b32 a93, v235
    v_accvgpr_read_b32 v236, a94
    v_mul_f32 v236, v236, v232
    v_accvgpr_write_b32 a94, v236
    v_accvgpr_read_b32 v237, a95
    v_mul_f32 v237, v237, v232
    v_accvgpr_write_b32 a95, v237
    v_accvgpr_read_b32 v234, a96
    v_mul_f32 v234, v234, v232
    v_accvgpr_write_b32 a96, v234
    v_accvgpr_read_b32 v235, a97
    v_mul_f32 v235, v235, v232
    v_accvgpr_write_b32 a97, v235
    v_accvgpr_read_b32 v236, a98
    v_mul_f32 v236, v236, v232
    v_accvgpr_write_b32 a98, v236
    v_accvgpr_read_b32 v237, a99
    v_mul_f32 v237, v237, v232
    v_accvgpr_write_b32 a99, v237
    v_accvgpr_read_b32 v234, a100
    v_mul_f32 v234, v234, v232
    v_accvgpr_write_b32 a100, v234
    v_accvgpr_read_b32 v235, a101
    v_mul_f32 v235, v235, v232
    v_accvgpr_write_b32 a101, v235
    v_accvgpr_read_b32 v236, a102
    v_mul_f32 v236, v236, v232
    v_accvgpr_write_b32 a102, v236
    v_accvgpr_read_b32 v237, a103
    v_mul_f32 v237, v237, v232
    v_accvgpr_write_b32 a103, v237
    v_accvgpr_read_b32 v234, a104
    v_mul_f32 v234, v234, v232
    v_accvgpr_write_b32 a104, v234
    v_accvgpr_read_b32 v235, a105
    v_mul_f32 v235, v235, v232
    v_accvgpr_write_b32 a105, v235
    v_accvgpr_read_b32 v236, a106
    v_mul_f32 v236, v236, v232
    v_accvgpr_write_b32 a106, v236
    v_accvgpr_read_b32 v237, a107
    v_mul_f32 v237, v237, v232
    v_accvgpr_write_b32 a107, v237
    v_accvgpr_read_b32 v234, a108
    v_mul_f32 v234, v234, v232
    v_accvgpr_write_b32 a108, v234
    v_accvgpr_read_b32 v235, a109
    v_mul_f32 v235, v235, v232
    v_accvgpr_write_b32 a109, v235
    v_accvgpr_read_b32 v236, a110
    v_mul_f32 v236, v236, v232
    v_accvgpr_write_b32 a110, v236
    v_accvgpr_read_b32 v237, a111
    v_mul_f32 v237, v237, v232
    v_accvgpr_write_b32 a111, v237
    v_accvgpr_read_b32 v234, a112
    v_mul_f32 v234, v234, v232
    v_accvgpr_write_b32 a112, v234
    v_accvgpr_read_b32 v235, a113
    v_mul_f32 v235, v235, v232
    v_accvgpr_write_b32 a113, v235
    v_accvgpr_read_b32 v236, a114
    v_mul_f32 v236, v236, v232
    v_accvgpr_write_b32 a114, v236
    v_accvgpr_read_b32 v237, a115
    v_mul_f32 v237, v237, v232
    v_accvgpr_write_b32 a115, v237
    v_accvgpr_read_b32 v234, a116
    v_mul_f32 v234, v234, v232
    v_accvgpr_write_b32 a116, v234
    v_accvgpr_read_b32 v235, a117
    v_mul_f32 v235, v235, v232
    v_accvgpr_write_b32 a117, v235
    v_accvgpr_read_b32 v236, a118
    v_mul_f32 v236, v236, v232
    v_accvgpr_write_b32 a118, v236
    v_accvgpr_read_b32 v237, a119
    v_mul_f32 v237, v237, v232
    v_accvgpr_write_b32 a119, v237
    v_accvgpr_read_b32 v234, a120
    v_mul_f32 v234, v234, v232
    v_accvgpr_write_b32 a120, v234
    v_accvgpr_read_b32 v235, a121
    v_mul_f32 v235, v235, v232
    v_accvgpr_write_b32 a121, v235
    v_accvgpr_read_b32 v236, a122
    v_mul_f32 v236, v236, v232
    v_accvgpr_write_b32 a122, v236
    v_accvgpr_read_b32 v237, a123
    v_mul_f32 v237, v237, v232
    v_accvgpr_write_b32 a123, v237
    v_accvgpr_read_b32 v234, a124
    v_mul_f32 v234, v234, v232
    v_accvgpr_write_b32 a124, v234
    v_accvgpr_read_b32 v235, a125
    v_mul_f32 v235, v235, v232
    v_accvgpr_write_b32 a125, v235
    v_accvgpr_read_b32 v236, a126
    v_mul_f32 v236, v236, v232
    v_accvgpr_write_b32 a126, v236
    v_accvgpr_read_b32 v237, a127
    v_mul_f32 v237, v237, v232
    v_accvgpr_write_b32 a127, v237
    v_exp_f32 v138, v16
    v_exp_f32 v139, v17
    v_exp_f32 v130, v18
    v_exp_f32 v131, v19
    v_cvt_pk_bf16_f32 v104, v138, v139
    v_exp_f32 v132, v20
    v_exp_f32 v133, v21
    v_cvt_pk_bf16_f32 v105, v130, v131
    v_add_f32 v138, v138, v130
    v_add_f32 v139, v139, v131
    v_exp_f32 v134, v22
    v_exp_f32 v135, v23
    v_cvt_pk_bf16_f32 v106, v132, v133
    v_add_f32 v138, v138, v132
    v_add_f32 v139, v139, v133
    v_exp_f32 v128, v24
    v_exp_f32 v129, v25
    v_cvt_pk_bf16_f32 v107, v134, v135
    v_add_f32 v138, v138, v134
    v_add_f32 v139, v139, v135
    v_exp_f32 v130, v26
    v_exp_f32 v131, v27
    v_cvt_pk_bf16_f32 v108, v128, v129
    v_add_f32 v138, v138, v128
    v_add_f32 v139, v139, v129
    v_exp_f32 v132, v28
    v_exp_f32 v133, v29
    v_cvt_pk_bf16_f32 v109, v130, v131
    v_add_f32 v138, v138, v130
    v_add_f32 v139, v139, v131
    v_exp_f32 v134, v30
    v_exp_f32 v135, v31
    v_cvt_pk_bf16_f32 v110, v132, v133
    v_add_f32 v138, v138, v132
    v_add_f32 v139, v139, v133
    v_cvt_pk_bf16_f32 v111, v134, v135
    v_add_f32 v138, v138, v134
    v_add_f32 v139, v139, v135
    v_add_f32 v225, v138, v139
    s_nop 1
    s_branch kf_rr19
kf_fix21:
    s_cmp_eq_u32 s33, 0
    s_cselect_b32 s24, 0, 0x74000000
    s_cselect_b32 s36, 0, 0x1000
    s_mov_b32 s33, 1
    v_subrev_f32 v230, s24, v243
    v_add_f32 v231, 0, v230
    v_min_f32 v80, v229, v231
    v_add_f32 v232, 0xf1800000, v230
    v_min_f32 v81, v229, v232
    v_add_f32 v231, 0xf2000000, v230
    v_min_f32 v82, v229, v231
    v_add_f32 v232, 0xf2400000, v230
    v_min_f32 v83, v229, v232
    v_add_f32 v231, 0xf3000000, v230
    v_min_f32 v84, v229, v231
    v_add_f32 v232, 0xf3100000, v230
    v_min_f32 v85, v229, v232
    v_add_f32 v231, 0xf3200000, v230
    v_min_f32 v86, v229, v231
    v_add_f32 v232, 0xf3300000, v230
    v_min_f32 v87, v229, v232
    v_add_f32 v231, 0xf3800000, v230
    v_min_f32 v88, v229, v231
    v_add_f32 v232, 0xf3880000, v230
    v_min_f32 v89, v229, v232
    v_add_f32 v231, 0xf3900000, v230
    v_min_f32 v90, v229, v231
    v_add_f32 v232, 0xf3980000, v230
    v_min_f32 v91, v229, v232
    v_add_f32 v231, 0xf3c00000, v230
    v_min_f32 v92, v229, v231
    v_add_f32 v232, 0xf3c80000, v230
    v_min_f32 v93, v229, v232
    v_add_f32 v231, 0xf3d00000, v230
    v_min_f32 v94, v229, v231
    v_add_f32 v232, 0xf3d80000, v230
    v_min_f32 v95, v229, v232
    s_nop 1
    s_branch kf_fixr22
kf_rare24:
    s_nop 15
    v_max3_f32 v230, v48, v49, v50
    v_max3_f32 v230, v230, v51, v52
    v_max3_f32 v230, v230, v53, v54
    v_max3_f32 v230, v230, v55, v56
    v_max3_f32 v230, v230, v57, v58
    v_max3_f32 v230, v230, v59, v60
    v_max3_f32 v230, v230, v61, v62
    v_max_f32 v230, v230, v63
    v_mov_b32 v231, v230
    s_nop 1
    v_permlane32_swap_b32 v230, v231
    s_nop 0
    v_max_f32 v230, v230, v231
    v_max_f32 v230, 0, v230
    v_sub_f32 v232, 0, v230
    v_exp_f32 v232, v232
    v_sub_f32 v229, v229, v230
    v_sub_f32 v80, v80, v230
    v_sub_f32 v16, v16, v230
    v_sub_f32 v48, v48, v230
    v_sub_f32 v81, v81, v230
    v_sub_f32 v17, v17, v230
    v_sub_f32 v49, v49, v230
    v_sub_f32 v82, v82, v230
    v_sub_f32 v18, v18, v230
    v_sub_f32 v50, v50, v230
    v_sub_f32 v83, v83, v230
    v_sub_f32 v19, v19, v230
    v_sub_f32 v51, v51, v230
    v_sub_f32 v84, v84, v230
    v_sub_f32 v20, v20, v230
    v_sub_f32 v52, v52, v230
    v_sub_f32 v85, v85, v230
    v_sub_f32 v21, v21, v230
    v_sub_f32 v53, v53, v230
    v_sub_f32 v86, v86, v230
    v_sub_f32 v22, v22, v230
    v_sub_f32 v54, v54, v230
    v_sub_f32 v87, v87, v230
    v_sub_f32 v23, v23, v230
    v_sub_f32 v55, v55, v230
    v_sub_f32 v88, v88, v230
    v_sub_f32 v24, v24, v230
    v_sub_f32 v56, v56, v230
    v_sub_f32 v89, v89, v230
    v_sub_f32 v25, v25, v230
    v_sub_f32 v57, v57, v230
    v_sub_f32 v90, v90, v230
    v_sub_f32 v26, v26, v230
    v_sub_f32 v58, v58, v230
    v_sub_f32 v91, v91, v230
    v_sub_f32 v27, v27, v230
    v_sub_f32 v59, v59, v230
    v_sub_f32 v92, v92, v230
    v_sub_f32 v28, v28, v230
    v_sub_f32 v60, v60, v230
    v_sub_f32 v93, v93, v230
    v_sub_f32 v29, v29, v230
    v_sub_f32 v61, v61, v230
    v_sub_f32 v94, v94, v230
    v_sub_f32 v30, v30, v230
    v_sub_f32 v62, v62, v230
    v_sub_f32 v95, v95, v230
    v_sub_f32 v31, v31, v230
    v_sub_f32 v63, v63, v230
    v_mul_f32 v227, v227, v232
    v_accvgpr_read_b32 v234, a64
    v_mul_f32 v234, v234, v232
    v_accvgpr_write_b32 a64, v234
    v_accvgpr_read_b32 v235, a65
    v_mul_f32 v235, v235, v232
    v_accvgpr_write_b32 a65, v235
    v_accvgpr_read_b32 v236, a66
    v_mul_f32 v236, v236, v232
    v_accvgpr_write_b32 a66, v236
    v_accvgpr_read_b32 v237, a67
    v_mul_f32 v237, v237, v232
    v_accvgpr_write_b32 a67, v237
    v_accvgpr_read_b32 v234, a68
    v_mul_f32 v234, v234, v232
    v_accvgpr_write_b32 a68, v234
    v_accvgpr_read_b32 v235, a69
    v_mul_f32 v235, v235, v232
    v_accvgpr_write_b32 a69, v235
    v_accvgpr_read_b32 v236, a70
    v_mul_f32 v236, v236, v232
    v_accvgpr_write_b32 a70, v236
    v_accvgpr_read_b32 v237, a71
    v_mul_f32 v237, v237, v232
    v_accvgpr_write_b32 a71, v237
    v_accvgpr_read_b32 v234, a72
    v_mul_f32 v234, v234, v232
    v_accvgpr_write_b32 a72, v234
    v_accvgpr_read_b32 v235, a73
    v_mul_f32 v235, v235, v232
    v_accvgpr_write_b32 a73, v235
    v_accvgpr_read_b32 v236, a74
    v_mul_f32 v236, v236, v232
    v_accvgpr_write_b32 a74, v236
    v_accvgpr_read_b32 v237, a75
    v_mul_f32 v237, v237, v232
    v_accvgpr_write_b32 a75, v237
    v_accvgpr_read_b32 v234, a76
    v_mul_f32 v234, v234, v232
    v_accvgpr_write_b32 a76, v234
    v_accvgpr_read_b32 v235, a77
    v_mul_f32 v235, v235, v232
    v_accvgpr_write_b32 a77, v235
    v_accvgpr_read_b32 v236, a78
    v_mul_f32 v236, v236, v232
    v_accvgpr_write_b32 a78, v236
    v_accvgpr_read_b32 v237, a79
    v_mul_f32 v237, v237, v232
    v_accvgpr_write_b32 a79, v237
    v_accvgpr_read_b32 v234, a80
    v_mul_f32 v234, v234, v232
    v_accvgpr_write_b32 a80, v234
    v_accvgpr_read_b32 v235, a81
    v_mul_f32 v235, v235, v232
    v_accvgpr_write_b32 a81, v235
    v_accvgpr_read_b32 v236, a82
    v_mul_f32 v236, v236, v232
    v_accvgpr_write_b32 a82, v236
    v_accvgpr_read_b32 v237, a83
    v_mul_f32 v237, v237, v232
    v_accvgpr_write_b32 a83, v237
    v_accvgpr_read_b32 v234, a84
    v_mul_f32 v234, v234, v232
    v_accvgpr_write_b32 a84, v234
    v_accvgpr_read_b32 v235, a85
    v_mul_f32 v235, v235, v232
    v_accvgpr_write_b32 a85, v235
    v_accvgpr_read_b32 v236, a86
    v_mul_f32 v236, v236, v232
    v_accvgpr_write_b32 a86, v236
    v_accvgpr_read_b32 v237, a87
    v_mul_f32 v237, v237, v232
    v_accvgpr_write_b32 a87, v237
    v_accvgpr_read_b32 v234, a88
    v_mul_f32 v234, v234, v232
    v_accvgpr_write_b32 a88, v234
    v_accvgpr_read_b32 v235, a89
    v_mul_f32 v235, v235, v232
    v_accvgpr_write_b32 a89, v235
    v_accvgpr_read_b32 v236, a90
    v_mul_f32 v236, v236, v232
    v_accvgpr_write_b32 a90, v236
    v_accvgpr_read_b32 v237, a91
    v_mul_f32 v237, v237, v232
    v_accvgpr_write_b32 a91, v237
    v_accvgpr_read_b32 v234, a92
    v_mul_f32 v234, v234, v232
    v_accvgpr_write_b32 a92, v234
    v_accvgpr_read_b32 v235, a93
    v_mul_f32 v235, v235, v232
    v_accvgpr_write_b32 a93, v235
    v_accvgpr_read_b32 v236, a94
    v_mul_f32 v236, v236, v232
    v_accvgpr_write_b32 a94, v236
    v_accvgpr_read_b32 v237, a95
    v_mul_f32 v237, v237, v232
    v_accvgpr_write_b32 a95, v237
    v_accvgpr_read_b32 v234, a96
    v_mul_f32 v234, v234, v232
    v_accvgpr_write_b32 a96, v234
    v_accvgpr_read_b32 v235, a97
    v_mul_f32 v235, v235, v232
    v_accvgpr_write_b32 a97, v235
    v_accvgpr_read_b32 v236, a98
    v_mul_f32 v236, v236, v232
    v_accvgpr_write_b32 a98, v236
    v_accvgpr_read_b32 v237, a99
    v_mul_f32 v237, v237, v232
    v_accvgpr_write_b32 a99, v237
    v_accvgpr_read_b32 v234, a100
    v_mul_f32 v234, v234, v232
    v_accvgpr_write_b32 a100, v234
    v_accvgpr_read_b32 v235, a101
    v_mul_f32 v235, v235, v232
    v_accvgpr_write_b32 a101, v235
    v_accvgpr_read_b32 v236, a102
    v_mul_f32 v236, v236, v232
    v_accvgpr_write_b32 a102, v236
    v_accvgpr_read_b32 v237, a103
    v_mul_f32 v237, v237, v232
    v_accvgpr_write_b32 a103, v237
    v_accvgpr_read_b32 v234, a104
    v_mul_f32 v234, v234, v232
    v_accvgpr_write_b32 a104, v234
    v_accvgpr_read_b32 v235, a105
    v_mul_f32 v235, v235, v232
    v_accvgpr_write_b32 a105, v235
    v_accvgpr_read_b32 v236, a106
    v_mul_f32 v236, v236, v232
    v_accvgpr_write_b32 a106, v236
    v_accvgpr_read_b32 v237, a107
    v_mul_f32 v237, v237, v232
    v_accvgpr_write_b32 a107, v237
    v_accvgpr_read_b32 v234, a108
    v_mul_f32 v234, v234, v232
    v_accvgpr_write_b32 a108, v234
    v_accvgpr_read_b32 v235, a109
    v_mul_f32 v235, v235, v232
    v_accvgpr_write_b32 a109, v235
    v_accvgpr_read_b32 v236, a110
    v_mul_f32 v236, v236, v232
    v_accvgpr_write_b32 a110, v236
    v_accvgpr_read_b32 v237, a111
    v_mul_f32 v237, v237, v232
    v_accvgpr_write_b32 a111, v237
    v_accvgpr_read_b32 v234, a112
    v_mul_f32 v234, v234, v232
    v_accvgpr_write_b32 a112, v234
    v_accvgpr_read_b32 v235, a113
    v_mul_f32 v235, v235, v232
    v_accvgpr_write_b32 a113, v235
    v_accvgpr_read_b32 v236, a114
    v_mul_f32 v236, v236, v232
    v_accvgpr_write_b32 a114, v236
    v_accvgpr_read_b32 v237, a115
    v_mul_f32 v237, v237, v232
    v_accvgpr_write_b32 a115, v237
    v_accvgpr_read_b32 v234, a116
    v_mul_f32 v234, v234, v232
    v_accvgpr_write_b32 a116, v234
    v_accvgpr_read_b32 v235, a117
    v_mul_f32 v235, v235, v232
    v_accvgpr_write_b32 a117, v235
    v_accvgpr_read_b32 v236, a118
    v_mul_f32 v236, v236, v232
    v_accvgpr_write_b32 a118, v236
    v_accvgpr_read_b32 v237, a119
    v_mul_f32 v237, v237, v232
    v_accvgpr_write_b32 a119, v237
    v_accvgpr_read_b32 v234, a120
    v_mul_f32 v234, v234, v232
    v_accvgpr_write_b32 a120, v234
    v_accvgpr_read_b32 v235, a121
    v_mul_f32 v235, v235, v232
    v_accvgpr_write_b32 a121, v235
    v_accvgpr_read_b32 v236, a122
    v_mul_f32 v236, v236, v232
    v_accvgpr_write_b32 a122, v236
    v_accvgpr_read_b32 v237, a123
    v_mul_f32 v237, v237, v232
    v_accvgpr_write_b32 a123, v237
    v_accvgpr_read_b32 v234, a124
    v_mul_f32 v234, v234, v232
    v_accvgpr_write_b32 a124, v234
    v_accvgpr_read_b32 v235, a125
    v_mul_f32 v235, v235, v232
    v_accvgpr_write_b32 a125, v235
    v_accvgpr_read_b32 v236, a126
    v_mul_f32 v236, v236, v232
    v_accvgpr_write_b32 a126, v236
    v_accvgpr_read_b32 v237, a127
    v_mul_f32 v237, v237, v232
    v_accvgpr_write_b32 a127, v237
    v_exp_f32 v138, v48
    v_exp_f32 v139, v49
    v_exp_f32 v130, v50
    v_exp_f32 v131, v51
    v_cvt_pk_bf16_f32 v120, v138, v139
    v_exp_f32 v132, v52
    v_exp_f32 v133, v53
    v_cvt_pk_bf16_f32 v121, v130, v131
    v_add_f32 v138, v138, v130
    v_add_f32 v139, v139, v131
    v_exp_f32 v134, v54
    v_exp_f32 v135, v55
    v_cvt_pk_bf16_f32 v122, v132, v133
    v_add_f32 v138, v138, v132
    v_add_f32 v139, v139, v133
    v_exp_f32 v128, v56
    v_exp_f32 v129, v57
    v_cvt_pk_bf16_f32 v123, v134, v135
    v_add_f32 v138, v138, v134
    v_add_f32 v139, v139, v135
    v_exp_f32 v130, v58
    v_exp_f32 v131, v59
    v_cvt_pk_bf16_f32 v124, v128, v129
    v_add_f32 v138, v138, v128
    v_add_f32 v139, v139, v129
    v_exp_f32 v132, v60
    v_exp_f32 v133, v61
    v_cvt_pk_bf16_f32 v125, v130, v131
    v_add_f32 v138, v138, v130
    v_add_f32 v139, v139, v131
    v_exp_f32 v134, v62
    v_exp_f32 v135, v63
    v_cvt_pk_bf16_f32 v126, v132, v133
    v_add_f32 v138, v138, v132
    v_add_f32 v139, v139, v133
    v_cvt_pk_bf16_f32 v127, v134, v135
    v_add_f32 v138, v138, v134
    v_add_f32 v139, v139, v135
    v_add_f32 v225, v138, v139
    s_nop 1
    s_branch kf_rr23
kf_fix25:
    s_cmp_eq_u32 s33, 0
    s_cselect_b32 s24, 0, 0x74000000
    s_cselect_b32 s36, 0, 0x1000
    s_mov_b32 s33, 1
    v_subrev_f32 v230, s24, v243
    v_add_f32 v231, 0, v230
    v_min_f32 v80, v229, v231
    v_add_f32 v232, 0xf1800000, v230
    v_min_f32 v81, v229, v232
    v_add_f32 v231, 0xf2000000, v230
    v_min_f32 v82, v229, v231
    v_add_f32 v232, 0xf2400000, v230
    v_min_f32 v83, v229, v232
    v_add_f32 v231, 0xf3000000, v230
    v_min_f32 v84, v229, v231
    v_add_f32 v232, 0xf3100000, v230
    v_min_f32 v85, v229, v232
    v_add_f32 v231, 0xf3200000, v230
    v_min_f32 v86, v229, v231
    v_add_f32 v232, 0xf3300000, v230
    v_min_f32 v87, v229, v232
    v_add_f32 v231, 0xf3800000, v230
    v_min_f32 v88, v229, v231
    v_add_f32 v232, 0xf3880000, v230
    v_min_f32 v89, v229, v232
    v_add_f32 v231, 0xf3900000, v230
    v_min_f32 v90, v229, v231
    v_add_f32 v232, 0xf3980000, v230
    v_min_f32 v91, v229, v232
    v_add_f32 v231, 0xf3c00000, v230
    v_min_f32 v92, v229, v231
    v_add_f32 v232, 0xf3c80000, v230
    v_min_f32 v93, v229, v232
    v_add_f32 v231, 0xf3d00000, v230
    v_min_f32 v94, v229, v231
    v_add_f32 v232, 0xf3d80000, v230
    v_min_f32 v95, v229, v232
    s_nop 1
    s_branch kf_fixr26
kf_rare28:
    s_nop 15
    v_max3_f32 v230, v16, v17, v18
    v_max3_f32 v230, v230, v19, v20
    v_max3_f32 v230, v230, v21, v22
    v_max3_f32 v230, v230, v23, v24
    v_max3_f32 v230, v230, v25, v26
    v_max3_f32 v230, v230, v27, v28
    v_max3_f32 v230, v230, v29, v30
    v_max_f32 v230, v230, v31
    v_mov_b32 v231, v230
    s_nop 1
    v_permlane32_swap_b32 v230, v231
    s_nop 0
    v_max_f32 v230, v230, v231
    v_max_f32 v230, 0, v230
    v_sub_f32 v232, 0, v230
    v_exp_f32 v232, v232
    v_sub_f32 v229, v229, v230
    v_sub_f32 v80, v80, v230
    v_sub_f32 v48, v48, v230
    v_sub_f32 v16, v16, v230
    v_sub_f32 v81, v81, v230
    v_sub_f32 v49, v49, v230
    v_sub_f32 v17, v17, v230
    v_sub_f32 v82, v82, v230
    v_sub_f32 v50, v50, v230
    v_sub_f32 v18, v18, v230
    v_sub_f32 v83, v83, v230
    v_sub_f32 v51, v51, v230
    v_sub_f32 v19, v19, v230
    v_sub_f32 v84, v84, v230
    v_sub_f32 v52, v52, v230
    v_sub_f32 v20, v20, v230
    v_sub_f32 v85, v85, v230
    v_sub_f32 v53, v53, v230
    v_sub_f32 v21, v21, v230
    v_sub_f32 v86, v86, v230
    v_sub_f32 v54, v54, v230
    v_sub_f32 v22, v22, v230
    v_sub_f32 v87, v87, v230
    v_sub_f32 v55, v55, v230
    v_sub_f32 v23, v23, v230
    v_sub_f32 v88, v88, v230
    v_sub_f32 v56, v56, v230
    v_sub_f32 v24, v24, v230
    v_sub_f32 v89, v89, v230
    v_sub_f32 v57, v57, v230
    v_sub_f32 v25, v25, v230
    v_sub_f32 v90, v90, v230
    v_sub_f32 v58, v58, v230
    v_sub_f32 v26, v26, v230
    v_sub_f32 v91, v91, v230
    v_sub_f32 v59, v59, v230
    v_sub_f32 v27, v27, v230
    v_sub_f32 v92, v92, v230
    v_sub_f32 v60, v60, v230
    v_sub_f32 v28, v28, v230
    v_sub_f32 v93, v93, v230
    v_sub_f32 v61, v61, v230
    v_sub_f32 v29, v29, v230
    v_sub_f32 v94, v94, v230
    v_sub_f32 v62, v62, v230
    v_sub_f32 v30, v30, v230
    v_sub_f32 v95, v95, v230
    v_sub_f32 v63, v63, v230
    v_sub_f32 v31, v31, v230
    v_mul_f32 v227, v227, v232
    v_accvgpr_read_b32 v234, a64
    v_mul_f32 v234, v234, v232
    v_accvgpr_write_b32 a64, v234
    v_accvgpr_read_b32 v235, a65
    v_mul_f32 v235, v235, v232
    v_accvgpr_write_b32 a65, v235
    v_accvgpr_read_b32 v236, a66
    v_mul_f32 v236, v236, v232
    v_accvgpr_write_b32 a66, v236
    v_accvgpr_read_b32 v237, a67
    v_mul_f32 v237, v237, v232
    v_accvgpr_write_b32 a67, v237
    v_accvgpr_read_b32 v234, a68
    v_mul_f32 v234, v234, v232
    v_accvgpr_write_b32 a68, v234
    v_accvgpr_read_b32 v235, a69
    v_mul_f32 v235, v235, v232
    v_accvgpr_write_b32 a69, v235
    v_accvgpr_read_b32 v236, a70
    v_mul_f32 v236, v236, v232
    v_accvgpr_write_b32 a70, v236
    v_accvgpr_read_b32 v237, a71
    v_mul_f32 v237, v237, v232
    v_accvgpr_write_b32 a71, v237
    v_accvgpr_read_b32 v234, a72
    v_mul_f32 v234, v234, v232
    v_accvgpr_write_b32 a72, v234
    v_accvgpr_read_b32 v235, a73
    v_mul_f32 v235, v235, v232
    v_accvgpr_write_b32 a73, v235
    v_accvgpr_read_b32 v236, a74
    v_mul_f32 v236, v236, v232
    v_accvgpr_write_b32 a74, v236
    v_accvgpr_read_b32 v237, a75
    v_mul_f32 v237, v237, v232
    v_accvgpr_write_b32 a75, v237
    v_accvgpr_read_b32 v234, a76
    v_mul_f32 v234, v234, v232
    v_accvgpr_write_b32 a76, v234
    v_accvgpr_read_b32 v235, a77
    v_mul_f32 v235, v235, v232
    v_accvgpr_write_b32 a77, v235
    v_accvgpr_read_b32 v236, a78
    v_mul_f32 v236, v236, v232
    v_accvgpr_write_b32 a78, v236
    v_accvgpr_read_b32 v237, a79
    v_mul_f32 v237, v237, v232
    v_accvgpr_write_b32 a79, v237
    v_accvgpr_read_b32 v234, a80
    v_mul_f32 v234, v234, v232
    v_accvgpr_write_b32 a80, v234
    v_accvgpr_read_b32 v235, a81
    v_mul_f32 v235, v235, v232
    v_accvgpr_write_b32 a81, v235
    v_accvgpr_read_b32 v236, a82
    v_mul_f32 v236, v236, v232
    v_accvgpr_write_b32 a82, v236
    v_accvgpr_read_b32 v237, a83
    v_mul_f32 v237, v237, v232
    v_accvgpr_write_b32 a83, v237
    v_accvgpr_read_b32 v234, a84
    v_mul_f32 v234, v234, v232
    v_accvgpr_write_b32 a84, v234
    v_accvgpr_read_b32 v235, a85
    v_mul_f32 v235, v235, v232
    v_accvgpr_write_b32 a85, v235
    v_accvgpr_read_b32 v236, a86
    v_mul_f32 v236, v236, v232
    v_accvgpr_write_b32 a86, v236
    v_accvgpr_read_b32 v237, a87
    v_mul_f32 v237, v237, v232
    v_accvgpr_write_b32 a87, v237
    v_accvgpr_read_b32 v234, a88
    v_mul_f32 v234, v234, v232
    v_accvgpr_write_b32 a88, v234
    v_accvgpr_read_b32 v235, a89
    v_mul_f32 v235, v235, v232
    v_accvgpr_write_b32 a89, v235
    v_accvgpr_read_b32 v236, a90
    v_mul_f32 v236, v236, v232
    v_accvgpr_write_b32 a90, v236
    v_accvgpr_read_b32 v237, a91
    v_mul_f32 v237, v237, v232
    v_accvgpr_write_b32 a91, v237
    v_accvgpr_read_b32 v234, a92
    v_mul_f32 v234, v234, v232
    v_accvgpr_write_b32 a92, v234
    v_accvgpr_read_b32 v235, a93
    v_mul_f32 v235, v235, v232
    v_accvgpr_write_b32 a93, v235
    v_accvgpr_read_b32 v236, a94
    v_mul_f32 v236, v236, v232
    v_accvgpr_write_b32 a94, v236
    v_accvgpr_read_b32 v237, a95
    v_mul_f32 v237, v237, v232
    v_accvgpr_write_b32 a95, v237
    v_accvgpr_read_b32 v234, a96
    v_mul_f32 v234, v234, v232
    v_accvgpr_write_b32 a96, v234
    v_accvgpr_read_b32 v235, a97
    v_mul_f32 v235, v235, v232
    v_accvgpr_write_b32 a97, v235
    v_accvgpr_read_b32 v236, a98
    v_mul_f32 v236, v236, v232
    v_accvgpr_write_b32 a98, v236
    v_accvgpr_read_b32 v237, a99
    v_mul_f32 v237, v237, v232
    v_accvgpr_write_b32 a99, v237
    v_accvgpr_read_b32 v234, a100
    v_mul_f32 v234, v234, v232
    v_accvgpr_write_b32 a100, v234
    v_accvgpr_read_b32 v235, a101
    v_mul_f32 v235, v235, v232
    v_accvgpr_write_b32 a101, v235
    v_accvgpr_read_b32 v236, a102
    v_mul_f32 v236, v236, v232
    v_accvgpr_write_b32 a102, v236
    v_accvgpr_read_b32 v237, a103
    v_mul_f32 v237, v237, v232
    v_accvgpr_write_b32 a103, v237
    v_accvgpr_read_b32 v234, a104
    v_mul_f32 v234, v234, v232
    v_accvgpr_write_b32 a104, v234
    v_accvgpr_read_b32 v235, a105
    v_mul_f32 v235, v235, v232
    v_accvgpr_write_b32 a105, v235
    v_accvgpr_read_b32 v236, a106
    v_mul_f32 v236, v236, v232
    v_accvgpr_write_b32 a106, v236
    v_accvgpr_read_b32 v237, a107
    v_mul_f32 v237, v237, v232
    v_accvgpr_write_b32 a107, v237
    v_accvgpr_read_b32 v234, a108
    v_mul_f32 v234, v234, v232
    v_accvgpr_write_b32 a108, v234
    v_accvgpr_read_b32 v235, a109
    v_mul_f32 v235, v235, v232
    v_accvgpr_write_b32 a109, v235
    v_accvgpr_read_b32 v236, a110
    v_mul_f32 v236, v236, v232
    v_accvgpr_write_b32 a110, v236
    v_accvgpr_read_b32 v237, a111
    v_mul_f32 v237, v237, v232
    v_accvgpr_write_b32 a111, v237
    v_accvgpr_read_b32 v234, a112
    v_mul_f32 v234, v234, v232
    v_accvgpr_write_b32 a112, v234
    v_accvgpr_read_b32 v235, a113
    v_mul_f32 v235, v235, v232
    v_accvgpr_write_b32 a113, v235
    v_accvgpr_read_b32 v236, a114
    v_mul_f32 v236, v236, v232
    v_accvgpr_write_b32 a114, v236
    v_accvgpr_read_b32 v237, a115
    v_mul_f32 v237, v237, v232
    v_accvgpr_write_b32 a115, v237
    v_accvgpr_read_b32 v234, a116
    v_mul_f32 v234, v234, v232
    v_accvgpr_write_b32 a116, v234
    v_accvgpr_read_b32 v235, a117
    v_mul_f32 v235, v235, v232
    v_accvgpr_write_b32 a117, v235
    v_accvgpr_read_b32 v236, a118
    v_mul_f32 v236, v236, v232
    v_accvgpr_write_b32 a118, v236
    v_accvgpr_read_b32 v237, a119
    v_mul_f32 v237, v237, v232
    v_accvgpr_write_b32 a119, v237
    v_accvgpr_read_b32 v234, a120
    v_mul_f32 v234, v234, v232
    v_accvgpr_write_b32 a120, v234
    v_accvgpr_read_b32 v235, a121
    v_mul_f32 v235, v235, v232
    v_accvgpr_write_b32 a121, v235
    v_accvgpr_read_b32 v236, a122
    v_mul_f32 v236, v236, v232
    v_accvgpr_write_b32 a122, v236
    v_accvgpr_read_b32 v237, a123
    v_mul_f32 v237, v237, v232
    v_accvgpr_write_b32 a123, v237
    v_accvgpr_read_b32 v234, a124
    v_mul_f32 v234, v234, v232
    v_accvgpr_write_b32 a124, v234
    v_accvgpr_read_b32 v235, a125
    v_mul_f32 v235, v235, v232
    v_accvgpr_write_b32 a125, v235
    v_accvgpr_read_b32 v236, a126
    v_mul_f32 v236, v236, v232
    v_accvgpr_write_b32 a126, v236
    v_accvgpr_read_b32 v237, a127
    v_mul_f32 v237, v237, v232
    v_accvgpr_write_b32 a127, v237
    v_exp_f32 v138, v16
    v_exp_f32 v139, v17
    v_exp_f32 v130, v18
    v_exp_f32 v131, v19
    v_cvt_pk_bf16_f32 v104, v138, v139
    v_exp_f32 v132, v20
    v_exp_f32 v133, v21
    v_cvt_pk_bf16_f32 v105, v130, v131
    v_add_f32 v138, v138, v130
    v_add_f32 v139, v139, v131
    v_exp_f32 v134, v22
    v_exp_f32 v135, v23
    v_cvt_pk_bf16_f32 v106, v132, v133
    v_add_f32 v138, v138, v132
    v_add_f32 v139, v139, v133
    v_exp_f32 v128, v24
    v_exp_f32 v129, v25
    v_cvt_pk_bf16_f32 v107, v134, v135
    v_add_f32 v138, v138, v134
    v_add_f32 v139, v139, v135
    v_exp_f32 v130, v26
    v_exp_f32 v131, v27
    v_cvt_pk_bf16_f32 v108, v128, v129
    v_add_f32 v138, v138, v128
    v_add_f32 v139, v139, v129
    v_exp_f32 v132, v28
    v_exp_f32 v133, v29
    v_cvt_pk_bf16_f32 v109, v130, v131
    v_add_f32 v138, v138, v130
    v_add_f32 v139, v139, v131
    v_exp_f32 v134, v30
    v_exp_f32 v135, v31
    v_cvt_pk_bf16_f32 v110, v132, v133
    v_add_f32 v138, v138, v132
    v_add_f32 v139, v139, v133
    v_cvt_pk_bf16_f32 v111, v134, v135
    v_add_f32 v138, v138, v134
    v_add_f32 v139, v139, v135
    v_add_f32 v225, v138, v139
    s_nop 1
    s_branch kf_rr27
kf_rare30:
    s_nop 15
    v_max3_f32 v230, v48, v49, v50
    v_max3_f32 v230, v230, v51, v52
    v_max3_f32 v230, v230, v53, v54
    v_max3_f32 v230, v230, v55, v56
    v_max3_f32 v230, v230, v57, v58
    v_max3_f32 v230, v230, v59, v60
    v_max3_f32 v230, v230, v61, v62
    v_max_f32 v230, v230, v63
    v_mov_b32 v231, v230
    s_nop 1
    v_permlane32_swap_b32 v230, v231
    s_nop 0
    v_max_f32 v230, v230, v231
    v_max_f32 v230, 0, v230
    v_sub_f32 v232, 0, v230
    v_exp_f32 v232, v232
    v_sub_f32 v229, v229, v230
    v_sub_f32 v80, v80, v230
    v_sub_f32 v16, v16, v230
    v_sub_f32 v48, v48, v230
    v_sub_f32 v81, v81, v230
    v_sub_f32 v17, v17, v230
    v_sub_f32 v49, v49, v230
    v_sub_f32 v82, v82, v230
    v_sub_f32 v18, v18, v230
    v_sub_f32 v50, v50, v230
    v_sub_f32 v83, v83, v230
    v_sub_f32 v19, v19, v230
    v_sub_f32 v51, v51, v230
    v_sub_f32 v84, v84, v230
    v_sub_f32 v20, v20, v230
    v_sub_f32 v52, v52, v230
    v_sub_f32 v85, v85, v230
    v_sub_f32 v21, v21, v230
    v_sub_f32 v53, v53, v230
    v_sub_f32 v86, v86, v230
    v_sub_f32 v22, v22, v230
    v_sub_f32 v54, v54, v230
    v_sub_f32 v87, v87, v230
    v_sub_f32 v23, v23, v230
    v_sub_f32 v55, v55, v230
    v_sub_f32 v88, v88, v230
    v_sub_f32 v24, v24, v230
    v_sub_f32 v56, v56, v230
    v_sub_f32 v89, v89, v230
    v_sub_f32 v25, v25, v230
    v_sub_f32 v57, v57, v230
    v_sub_f32 v90, v90, v230
    v_sub_f32 v26, v26, v230
    v_sub_f32 v58, v58, v230
    v_sub_f32 v91, v91, v230
    v_sub_f32 v27, v27, v230
    v_sub_f32 v59, v59, v230
    v_sub_f32 v92, v92, v230
    v_sub_f32 v28, v28, v230
    v_sub_f32 v60, v60, v230
    v_sub_f32 v93, v93, v230
    v_sub_f32 v29, v29, v230
    v_sub_f32 v61, v61, v230
    v_sub_f32 v94, v94, v230
    v_sub_f32 v30, v30, v230
    v_sub_f32 v62, v62, v230
    v_sub_f32 v95, v95, v230
    v_sub_f32 v31, v31, v230
    v_sub_f32 v63, v63, v230
    v_mul_f32 v227, v227, v232
    v_accvgpr_read_b32 v234, a64
    v_mul_f32 v234, v234, v232
    v_accvgpr_write_b32 a64, v234
    v_accvgpr_read_b32 v235, a65
    v_mul_f32 v235, v235, v232
    v_accvgpr_write_b32 a65, v235
    v_accvgpr_read_b32 v236, a66
    v_mul_f32 v236, v236, v232
    v_accvgpr_write_b32 a66, v236
    v_accvgpr_read_b32 v237, a67
    v_mul_f32 v237, v237, v232
    v_accvgpr_write_b32 a67, v237
    v_accvgpr_read_b32 v234, a68
    v_mul_f32 v234, v234, v232
    v_accvgpr_write_b32 a68, v234
    v_accvgpr_read_b32 v235, a69
    v_mul_f32 v235, v235, v232
    v_accvgpr_write_b32 a69, v235
    v_accvgpr_read_b32 v236, a70
    v_mul_f32 v236, v236, v232
    v_accvgpr_write_b32 a70, v236
    v_accvgpr_read_b32 v237, a71
    v_mul_f32 v237, v237, v232
    v_accvgpr_write_b32 a71, v237
    v_accvgpr_read_b32 v234, a72
    v_mul_f32 v234, v234, v232
    v_accvgpr_write_b32 a72, v234
    v_accvgpr_read_b32 v235, a73
    v_mul_f32 v235, v235, v232
    v_accvgpr_write_b32 a73, v235
    v_accvgpr_read_b32 v236, a74
    v_mul_f32 v236, v236, v232
    v_accvgpr_write_b32 a74, v236
    v_accvgpr_read_b32 v237, a75
    v_mul_f32 v237, v237, v232
    v_accvgpr_write_b32 a75, v237
    v_accvgpr_read_b32 v234, a76
    v_mul_f32 v234, v234, v232
    v_accvgpr_write_b32 a76, v234
    v_accvgpr_read_b32 v235, a77
    v_mul_f32 v235, v235, v232
    v_accvgpr_write_b32 a77, v235
    v_accvgpr_read_b32 v236, a78
    v_mul_f32 v236, v236, v232
    v_accvgpr_write_b32 a78, v236
    v_accvgpr_read_b32 v237, a79
    v_mul_f32 v237, v237, v232
    v_accvgpr_write_b32 a79, v237
    v_accvgpr_read_b32 v234, a80
    v_mul_f32 v234, v234, v232
    v_accvgpr_write_b32 a80, v234
    v_accvgpr_read_b32 v235, a81
    v_mul_f32 v235, v235, v232
    v_accvgpr_write_b32 a81, v235
    v_accvgpr_read_b32 v236, a82
    v_mul_f32 v236, v236, v232
    v_accvgpr_write_b32 a82, v236
    v_accvgpr_read_b32 v237, a83
    v_mul_f32 v237, v237, v232
    v_accvgpr_write_b32 a83, v237
    v_accvgpr_read_b32 v234, a84
    v_mul_f32 v234, v234, v232
    v_accvgpr_write_b32 a84, v234
    v_accvgpr_read_b32 v235, a85
    v_mul_f32 v235, v235, v232
    v_accvgpr_write_b32 a85, v235
    v_accvgpr_read_b32 v236, a86
    v_mul_f32 v236, v236, v232
    v_accvgpr_write_b32 a86, v236
    v_accvgpr_read_b32 v237, a87
    v_mul_f32 v237, v237, v232
    v_accvgpr_write_b32 a87, v237
    v_accvgpr_read_b32 v234, a88
    v_mul_f32 v234, v234, v232
    v_accvgpr_write_b32 a88, v234
    v_accvgpr_read_b32 v235, a89
    v_mul_f32 v235, v235, v232
    v_accvgpr_write_b32 a89, v235
    v_accvgpr_read_b32 v236, a90
    v_mul_f32 v236, v236, v232
    v_accvgpr_write_b32 a90, v236
    v_accvgpr_read_b32 v237, a91
    v_mul_f32 v237, v237, v232
    v_accvgpr_write_b32 a91, v237
    v_accvgpr_read_b32 v234, a92
    v_mul_f32 v234, v234, v232
    v_accvgpr_write_b32 a92, v234
    v_accvgpr_read_b32 v235, a93
    v_mul_f32 v235, v235, v232
    v_accvgpr_write_b32 a93, v235
    v_accvgpr_read_b32 v236, a94
    v_mul_f32 v236, v236, v232
    v_accvgpr_write_b32 a94, v236
    v_accvgpr_read_b32 v237, a95
    v_mul_f32 v237, v237, v232
    v_accvgpr_write_b32 a95, v237
    v_accvgpr_read_b32 v234, a96
    v_mul_f32 v234, v234, v232
    v_accvgpr_write_b32 a96, v234
    v_accvgpr_read_b32 v235, a97
    v_mul_f32 v235, v235, v232
    v_accvgpr_write_b32 a97, v235
    v_accvgpr_read_b32 v236, a98
    v_mul_f32 v236, v236, v232
    v_accvgpr_write_b32 a98, v236
    v_accvgpr_read_b32 v237, a99
    v_mul_f32 v237, v237, v232
    v_accvgpr_write_b32 a99, v237
    v_accvgpr_read_b32 v234, a100
    v_mul_f32 v234, v234, v232
    v_accvgpr_write_b32 a100, v234
    v_accvgpr_read_b32 v235, a101
    v_mul_f32 v235, v235, v232
    v_accvgpr_write_b32 a101, v235
    v_accvgpr_read_b32 v236, a102
    v_mul_f32 v236, v236, v232
    v_accvgpr_write_b32 a102, v236
    v_accvgpr_read_b32 v237, a103
    v_mul_f32 v237, v237, v232
    v_accvgpr_write_b32 a103, v237
    v_accvgpr_read_b32 v234, a104
    v_mul_f32 v234, v234, v232
    v_accvgpr_write_b32 a104, v234
    v_accvgpr_read_b32 v235, a105
    v_mul_f32 v235, v235, v232
    v_accvgpr_write_b32 a105, v235
    v_accvgpr_read_b32 v236, a106
    v_mul_f32 v236, v236, v232
    v_accvgpr_write_b32 a106, v236
    v_accvgpr_read_b32 v237, a107
    v_mul_f32 v237, v237, v232
    v_accvgpr_write_b32 a107, v237
    v_accvgpr_read_b32 v234, a108
    v_mul_f32 v234, v234, v232
    v_accvgpr_write_b32 a108, v234
    v_accvgpr_read_b32 v235, a109
    v_mul_f32 v235, v235, v232
    v_accvgpr_write_b32 a109, v235
    v_accvgpr_read_b32 v236, a110
    v_mul_f32 v236, v236, v232
    v_accvgpr_write_b32 a110, v236
    v_accvgpr_read_b32 v237, a111
    v_mul_f32 v237, v237, v232
    v_accvgpr_write_b32 a111, v237
    v_accvgpr_read_b32 v234, a112
    v_mul_f32 v234, v234, v232
    v_accvgpr_write_b32 a112, v234
    v_accvgpr_read_b32 v235, a113
    v_mul_f32 v235, v235, v232
    v_accvgpr_write_b32 a113, v235
    v_accvgpr_read_b32 v236, a114
    v_mul_f32 v236, v236, v232
    v_accvgpr_write_b32 a114, v236
    v_accvgpr_read_b32 v237, a115
    v_mul_f32 v237, v237, v232
    v_accvgpr_write_b32 a115, v237
    v_accvgpr_read_b32 v234, a116
    v_mul_f32 v234, v234, v232
    v_accvgpr_write_b32 a116, v234
    v_accvgpr_read_b32 v235, a117
    v_mul_f32 v235, v235, v232
    v_accvgpr_write_b32 a117, v235
    v_accvgpr_read_b32 v236, a118
    v_mul_f32 v236, v236, v232
    v_accvgpr_write_b32 a118, v236
    v_accvgpr_read_b32 v237, a119
    v_mul_f32 v237, v237, v232
    v_accvgpr_write_b32 a119, v237
    v_accvgpr_read_b32 v234, a120
    v_mul_f32 v234, v234, v232
    v_accvgpr_write_b32 a120, v234
    v_accvgpr_read_b32 v235, a121
    v_mul_f32 v235, v235, v232
    v_accvgpr_write_b32 a121, v235
    v_accvgpr_read_b32 v236, a122
    v_mul_f32 v236, v236, v232
    v_accvgpr_write_b32 a122, v236
    v_accvgpr_read_b32 v237, a123
    v_mul_f32 v237, v237, v232
    v_accvgpr_write_b32 a123, v237
    v_accvgpr_read_b32 v234, a124
    v_mul_f32 v234, v234, v232
    v_accvgpr_write_b32 a124, v234
    v_accvgpr_read_b32 v235, a125
    v_mul_f32 v235, v235, v232
    v_accvgpr_write_b32 a125, v235
    v_accvgpr_read_b32 v236, a126
    v_mul_f32 v236, v236, v232
    v_accvgpr_write_b32 a126, v236
    v_accvgpr_read_b32 v237, a127
    v_mul_f32 v237, v237, v232
    v_accvgpr_write_b32 a127, v237
    v_exp_f32 v138, v48
    v_exp_f32 v139, v49
    v_exp_f32 v130, v50
    v_exp_f32 v131, v51
    v_cvt_pk_bf16_f32 v120, v138, v139
    v_exp_f32 v132, v52
    v_exp_f32 v133, v53
    v_cvt_pk_bf16_f32 v121, v130, v131
    v_add_f32 v138, v138, v130
    v_add_f32 v139, v139, v131
    v_exp_f32 v134, v54
    v_exp_f32 v135, v55
    v_cvt_pk_bf16_f32 v122, v132, v133
    v_add_f32 v138, v138, v132
    v_add_f32 v139, v139, v133
    v_exp_f32 v128, v56
    v_exp_f32 v129, v57
    v_cvt_pk_bf16_f32 v123, v134, v135
    v_add_f32 v138, v138, v134
    v_add_f32 v139, v139, v135
    v_exp_f32 v130, v58
    v_exp_f32 v131, v59
    v_cvt_pk_bf16_f32 v124, v128, v129
    v_add_f32 v138, v138, v128
    v_add_f32 v139, v139, v129
    v_exp_f32 v132, v60
    v_exp_f32 v133, v61
    v_cvt_pk_bf16_f32 v125, v130, v131
    v_add_f32 v138, v138, v130
    v_add_f32 v139, v139, v131
    v_exp_f32 v134, v62
    v_exp_f32 v135, v63
    v_cvt_pk_bf16_f32 v126, v132, v133
    v_add_f32 v138, v138, v132
    v_add_f32 v139, v139, v133
    v_cvt_pk_bf16_f32 v127, v134, v135
    v_add_f32 v138, v138, v134
    v_add_f32 v139, v139, v135
    v_add_f32 v225, v138, v139
    s_nop 1
    s_branch kf_rr29
kf_spin31:
    s_mov_b32 s25, 0x400000
kf_spin31_l:
    s_sleep 2
    buffer_load_dword v254, off, s[88:91], s97 sc1
    s_waitcnt vmcnt(0)
    v_readfirstlane_b32 s24, v254
    s_sub_u32 s25, s25, 1
    s_cbranch_scc1 kf_spinr32
    s_cmp_ge_u32 s24, 1
    s_cbranch_scc0 kf_spin31_l
    s_branch kf_spinr32
kf_spin33:
    s_mov_b32 s25, 0x400000
kf_spin33_l:
    s_sleep 2
    buffer_load_dword v254, off, s[88:91], s39 sc1
    s_waitcnt vmcnt(0)
    v_readfirstlane_b32 s24, v254
    s_sub_u32 s25, s25, 1
    s_cbranch_scc1 kf_spinr34
    s_cmp_ge_u32 s24, 32
    s_cbranch_scc0 kf_spin33_l
    s_branch kf_spinr34
kf_spin35:
    s_mov_b32 s25, 0x400000
kf_spin35_l:
    s_sleep 2
    buffer_load_dword v254, off, s[88:91], s97 sc1
    s_waitcnt vmcnt(0)
    v_readfirstlane_b32 s24, v254
    s_sub_u32 s25, s25, 1
    s_cbranch_scc1 kf_spinr36
    s_cmp_ge_u32 s24, 1
    s_cbranch_scc0 kf_spin35_l
    s_branch kf_spinr36
kf_spin37:
    s_mov_b32 s25, 0x400000
kf_spin37_l:
    s_sleep 2
    buffer_load_dword v254, off, s[88:91], s39 sc1
    s_waitcnt vmcnt(0)
    v_readfirstlane_b32 s24, v254
    s_sub_u32 s25, s25, 1
    s_cbranch_scc1 kf_spinr38
    s_cmp_ge_u32 s24, 32
    s_cbranch_scc0 kf_spin37_l
    s_branch kf_spinr38
kf_spin39:
    s_mov_b32 s25, 0x400000
kf_spin39_l:
    s_sleep 2
    buffer_load_dword v254, off, s[88:91], s35 sc1
    s_waitcnt vmcnt(0)
    v_readfirstlane_b32 s24, v254
    s_sub_u32 s25, s25, 1
    s_cbranch_scc1 kf_spinr40
    s_cmp_ge_u32 s24, 8
    s_cbranch_scc0 kf_spin39_l
    s_branch kf_spinr40

code_end:
.section .rodata,"a"
.p2align 6
.amdhsa_kernel sequential_preLN__compressed_kv_cla__moe_arch_mod__prompt_kernel
  .amdhsa_next_free_vgpr 512
  .amdhsa_next_free_sgpr 102
  .amdhsa_accum_offset 256
  .amdhsa_group_segment_fixed_size 0
  .amdhsa_kernarg_size 112
  .amdhsa_user_sgpr_count 2
  .amdhsa_user_sgpr_kernarg_segment_ptr 1
  .amdhsa_system_sgpr_workgroup_id_x 1
  .amdhsa_float_denorm_mode_32 3
.end_amdhsa_kernel
```

```asm
; @launch grid=(256,1,1) block=(256,1,1) lds=163840
.amdgcn_target "amdgcn-amd-amdhsa--gfx950"
.text
.globl sequential_preLN__compressed_kv_cla__moe_arch_mod__prompt_kernel
.p2align 8
.type sequential_preLN__compressed_kv_cla__moe_arch_mod__prompt_kernel,@function
sequential_preLN__compressed_kv_cla__moe_arch_mod__prompt_kernel:
    s_cmp_ge_u32 s2, 256
    s_cbranch_scc1 ka_done
    s_load_dwordx8 s[64:71], s[0:1], 0
    s_load_dwordx4 s[72:75], s[0:1], 32
    s_load_dwordx4 s[76:79], s[0:1], 64
    s_load_dwordx8 s[8:15], s[0:1], 80
    v_lshrrev_b32 v1, 6, v0
    v_and_b32 v2, 63, v0
    v_readfirstlane_b32 s3, v1
    v_mov_b32 v253, v0
    s_and_b32 s4, s2, 7
    s_lshl_b32 s4, s4, 2
    s_lshr_b32 s24, s2, 3
    s_and_b32 s24, s24, 3
    s_add_u32 s4, s4, s24
    s_lshr_b32 s5, s2, 5
    s_lshl2_add_u32 s6, s5, s3
    s_getpc_b64 s[56:57]
ka_pc:
    s_mov_b32 s58, code_end-ka_pc
    s_mov_b32 s59, 0x00020000
    s_lshr_b32 s24, s2, 3
    s_xor_b32 s24, s24, 31
    s_lshl2_add_u32 s24, s24, s3
    s_lshl_b32 s24, s24, 13
    v_lshlrev_b32 v3, 7, v2
    buffer_load_dword v252, v3, s[56:59], s24 offen
    v_mov_b32 v192, v2
    v_lshrrev_b32 v198, 3, v192
    v_and_b32 v199, 7, v192
    s_lshr_b32 s24, s3, 1
    s_lshl_b32 s24, s24, 5
    s_and_b32 s25, s3, 1
    s_lshl_b32 s26, s25, 3
    s_add_u32 s24, s24, s26
    v_add_u32 v194, s24, v198
    v_lshlrev_b32 v194, 10, v194
    v_lshrrev_b32 v195, 1, v198
    v_xor_b32 v195, v199, v195
    v_lshl_add_u32 v232, v195, 4, v194
    v_xor_b32 v195, 4, v195
    v_lshl_add_u32 v233, v195, 4, v194
    v_add_u32 v233, 15360, v233
    s_lshl_b32 s24, s4, 8
    s_lshl_b32 s26, s25, 7
    s_add_u32 s24, s24, s26
    v_lshlrev_b32 v194, 13, v198
    v_add_u32 v194, s24, v194
    v_bfe_u32 v195, v198, 1, 1
    v_xor_b32 v195, v199, v195
    v_lshl_add_u32 v234, v195, 4, v194
    v_xor_b32 v195, 4, v195
    v_lshl_add_u32 v235, v195, 4, v194
    v_add_u32 v235, 64512, v235
    s_lshl_b32 s34, s3, 11
    s_mul_i32 s35, s3, 24576
    s_add_u32 s35, s35, 65536
    s_lshl_b32 s32, s5, 18
    s_and_b32 s7, s4, 3
    s_lshl1_add_u32 s7, s7, s5
    s_add_u32 s80, s7, 0
    s_and_b32 s80, s80, 7
    s_lshl_b32 s80, s80, 7
    s_add_u32 s80, s80, s32
    s_add_u32 s81, s7, 1
    s_and_b32 s81, s81, 7
    s_lshl_b32 s81, s81, 7
    s_add_u32 s81, s81, s32
    s_add_u32 s82, s7, 2
    s_and_b32 s82, s82, 7
    s_lshl_b32 s82, s82, 7
    s_add_u32 s82, s82, s32
    s_add_u32 s83, s7, 3
    s_and_b32 s83, s83, 7
    s_lshl_b32 s83, s83, 7
    s_add_u32 s83, s83, s32
    s_add_u32 s84, s7, 4
    s_and_b32 s84, s84, 7
    s_lshl_b32 s84, s84, 7
    s_add_u32 s84, s84, s32
    s_add_u32 s85, s7, 5
    s_and_b32 s85, s85, 7
    s_lshl_b32 s85, s85, 7
    s_add_u32 s85, s85, s32
    s_add_u32 s86, s7, 6
    s_and_b32 s86, s86, 7
    s_lshl_b32 s86, s86, 7
    s_add_u32 s86, s86, s32
    s_add_u32 s87, s7, 7
    s_and_b32 s87, s87, 7
    s_lshl_b32 s87, s87, 7
    s_add_u32 s87, s87, s32
    s_waitcnt lgkmcnt(0)
    s_cmp_lt_u32 s3, 2
    s_cselect_b32 s48, s70, s72
    s_cselect_b32 s49, s71, s73
    s_mov_b32 s50, 0x400000
    s_mov_b32 s51, 0x00020000
    s_mov_b32 s44, s66
    s_mov_b32 s45, s67
    s_mov_b32 s46, 0x200000
    s_mov_b32 s47, 0x00020000
    s_add_u32 m0, s35, 0
    s_and_b32 s33, s80, 1023
    s_lshl_b32 s33, s33, 12
    buffer_load_dwordx4 v234, s[48:51], s33 offen lds
    buffer_load_dwordx4 v235, s[48:51], s33 offen offset:1024 lds
    s_add_u32 m0, s35, 2048
    s_add_u32 s33, s33, 131072
    buffer_load_dwordx4 v234, s[48:51], s33 offen lds
    buffer_load_dwordx4 v235, s[48:51], s33 offen offset:1024 lds
    s_add_u32 m0, s34, 0
    s_add_u32 s37, s80, 0
    buffer_load_dwordx4 v232, s[44:47], s37 offen lds
    buffer_load_dwordx4 v233, s[44:47], s37 offen offset:1024 lds
    s_add_u32 m0, s34, 8192
    s_add_u32 s37, s80, 65536
    buffer_load_dwordx4 v232, s[44:47], s37 offen lds
    buffer_load_dwordx4 v233, s[44:47], s37 offen offset:1024 lds
    s_add_u32 m0, s35, 4096
    s_add_u32 s33, s33, 131072
    buffer_load_dwordx4 v234, s[48:51], s33 offen lds
    buffer_load_dwordx4 v235, s[48:51], s33 offen offset:1024 lds
    s_add_u32 m0, s35, 6144
    s_add_u32 s33, s33, 131072
    buffer_load_dwordx4 v234, s[48:51], s33 offen lds
    buffer_load_dwordx4 v235, s[48:51], s33 offen offset:1024 lds
    s_mov_b32 s52, s64
    s_mov_b32 s53, s65
    s_mov_b32 s54, 0x400000
    s_mov_b32 s55, 0x00020000
    s_add_u32 s16, s14, 0x5c00000
    s_addc_u32 s17, s15, 0
    s_mov_b32 s18, 0x2140000
    s_mov_b32 s19, 0x00020000
    s_add_u32 s56, s14, 0x3800000
    s_addc_u32 s57, s15, 0
    s_mov_b32 s58, 0x6040
    s_mov_b32 s59, 0x00020000
    s_add_u32 s20, s14, 0x2400000
    s_addc_u32 s21, s15, 0
    s_mov_b32 s22, 0x1000000
    s_mov_b32 s23, 0x00020000
    s_mov_b32 s88, s12
    s_mov_b32 s89, s13
    s_mov_b32 s90, 0x100
    s_mov_b32 s91, 0x00020000
    s_cmp_lt_u32 s3, 2
    s_cselect_b32 s60, s8, s74
    s_cselect_b32 s61, s9, s75
    s_mov_b32 s62, 0x800000
    s_cselect_b32 s62, 0x700000, s62
    s_mov_b32 s63, 0x00020000
    s_cselect_b32 s41, s76, s78
    s_cselect_b32 s42, s77, s79
    s_mov_b32 s8, s14
    s_mov_b32 s9, s15
    s_mov_b32 s10, 0x400000
    s_mov_b32 s11, 0x00020000
    s_mov_b32 s12, s68
    s_mov_b32 s13, s69
    s_mov_b32 s14, 0x800000
    s_mov_b32 s15, 0x00020000
    s_cmp_eq_u32 s2, 200
    s_mov_b32 s97, 0x40000000
    s_cselect_b32 s97, 0xa0000, s97
    s_mov_b32 s58, 0xa5000
    v_lshlrev_b32 v194, 7, v253
    v_mov_b32 v195, 0
    buffer_store_dword v195, v194, s[56:59], s97 offen sc1
    s_cselect_b32 s97, 0, 0x40000000
    s_mov_b32 s58, 0x6040
    s_add_u32 m0, s35, 8192
    s_and_b32 s33, s81, 1023
    s_lshl_b32 s33, s33, 12
    buffer_load_dwordx4 v234, s[48:51], s33 offen lds
    buffer_load_dwordx4 v235, s[48:51], s33 offen offset:1024 lds
    s_add_u32 m0, s35, 10240
    s_add_u32 s33, s33, 131072
    buffer_load_dwordx4 v234, s[48:51], s33 offen lds
    buffer_load_dwordx4 v235, s[48:51], s33 offen offset:1024 lds
    s_add_u32 m0, s35, 12288
    s_add_u32 s33, s33, 131072
    buffer_load_dwordx4 v234, s[48:51], s33 offen lds
    buffer_load_dwordx4 v235, s[48:51], s33 offen offset:1024 lds
    s_add_u32 m0, s35, 14336
    s_add_u32 s33, s33, 131072
    buffer_load_dwordx4 v234, s[48:51], s33 offen lds
    buffer_load_dwordx4 v235, s[48:51], s33 offen offset:1024 lds
    s_add_u32 m0, s34, 16384
    s_add_u32 s37, s81, 0
    buffer_load_dwordx4 v232, s[44:47], s37 offen lds
    buffer_load_dwordx4 v233, s[44:47], s37 offen offset:1024 lds
    s_add_u32 m0, s34, 24576
    s_add_u32 s37, s81, 65536
    buffer_load_dwordx4 v232, s[44:47], s37 offen lds
    buffer_load_dwordx4 v233, s[44:47], s37 offen offset:1024 lds
    v_and_b32 v200, 15, v192
    v_lshrrev_b32 v201, 4, v192
    v_lshrrev_b32 v194, 1, v200
    v_xor_b32 v194, v201, v194
    v_lshlrev_b32 v194, 4, v194
    v_lshl_add_u32 v224, v200, 7, v194
    v_xor_b32 v225, 64, v224
    v_lshrrev_b32 v194, 2, v200
    v_lshl_add_u32 v195, v201, 3, v194
    v_lshlrev_b32 v195, 7, v195
    v_add_u32 v195, s35, v195
    v_and_b32 v196, 1, v200
    v_lshl_add_u32 v195, v196, 3, v195
    v_lshrrev_b32 v194, 1, v194
    v_and_b32 v196, 1, v201
    v_lshl_or_b32 v194, v196, 2, v194
    v_and_b32 v196, 2, v200
    v_xor_b32 v194, v194, v196
    v_xor_b32 v196, 0, v194
    v_lshl_add_u32 v228, v196, 4, v195
    v_xor_b32 v196, 1, v194
    v_lshl_add_u32 v229, v196, 4, v195
    v_xor_b32 v196, 4, v194
    v_lshl_add_u32 v230, v196, 4, v195
    v_xor_b32 v196, 5, v194
    v_lshl_add_u32 v231, v196, 4, v195
    s_mul_i32 s36, s4, 1089536
    s_mul_i32 s24, s5, 136192
    s_add_u32 s36, s36, s24
    s_and_b32 s24, s3, 1
    s_lshl_b32 s24, s24, 12
    s_and_b32 s26, s3, 2
    s_lshl_b32 s26, s26, 13
    s_add_u32 s36, s36, s24
    s_add_u32 s36, s36, s26
    s_lshl_b32 s24, s5, 7
    s_sub_u32 s26, 1792, s24
    s_cmp_lt_u32 s4, 16
    s_cselect_b32 s24, s24, s26
    s_lshl_b32 s26, s4, 3
    s_add_u32 s24, s24, s26
    v_lshrrev_b32 v194, 5, v253
    v_add_u32 v196, s24, v194
    v_and_b32 v195, 31, v192
    v_lshlrev_b32 v196, 11, v196
    v_lshl_add_u32 v236, v195, 4, v196
    v_xor_b32 v194, v194, v199
    v_lshlrev_b32 v194, 4, v194
    v_lshl_add_u32 v194, v195, 7, v194
    v_add_u32 v237, 81920, v194
    s_lshr_b32 s26, s24, 4
    s_lshl_b32 s26, s26, 15
    s_and_b32 s24, s24, 15
    s_lshl_b32 s24, s24, 4
    s_add_u32 s24, s24, s26
    v_lshrrev_b32 v194, 3, v253
    v_lshlrev_b32 v194, 8, v194
    v_xor_b32 v195, v199, v198
    v_lshl_add_u32 v194, v195, 4, v194
    v_add_u32 v238, s24, v194
    v_lshlrev_b32 v240, 4, v192
    s_lshl_b32 s24, s3, 12
    v_add_u32 v242, s24, v240
    s_lshl_b32 s24, s6, 16
    v_add_u32 v248, s24, v240
    s_sub_u32 s25, 63, s6
    s_lshl_b32 s24, s25, 16
    v_add_u32 v249, s24, v240
    v_bfe_u32 v194, v192, 2, 2
    v_lshlrev_b32 v194, 13, v194
    v_lshl_add_u32 v194, v201, 6, v194
    v_and_b32 v195, 3, v192
    v_lshl_add_u32 v194, v195, 4, v194
    s_lshl_b32 s24, s4, 8
    s_lshl_b32 s25, s3, 18
    s_add_u32 s24, s24, s25
    v_add_u32 v245, s24, v194
    s_lshl_b32 s31, s3, 13
    s_add_u32 s31, s31, 65536
    s_lshl_b32 s27, s5, 20
    s_mov_b32 s7, s27
    s_mov_b32 s43, 0x40000000
    s_lshr_b32 s28, s27, 8
    s_add_u32 s29, s28, 32768
    s_nop 0
    v_lshlrev_b32 v194, 11, v201
    v_bfe_u32 v195, v192, 2, 2
    v_lshl_add_u32 v194, v195, 6, v194
    v_bfe_u32 v195, v192, 4, 1
    v_lshl_add_u32 v194, v195, 4, v194
    v_and_b32 v195, 1, v192
    v_lshl_add_u32 v194, v195, 3, v194
    v_bfe_u32 v195, v192, 1, 1
    v_lshl_add_u32 v247, v195, 5, v194
    s_mov_b32 s30, 65536
    v_add_u32 v246, s30, v247
    v_lshrrev_b32 v195, 5, v192
    v_lshlrev_b32 v195, 4, v195
    v_sub_u32 v194, v200, v195
    v_bfe_u32 v195, v192, 4, 1
    v_lshlrev_b32 v195, 2, v195
    v_sub_u32 v194, v194, v195
    v_cvt_f32_i32 v194, v194
    v_add_f32 v194, 0.5, v194
    v_mul_f32 v243, 0x71800000, v194
    v_add_u32 v244, 0x20000, v240
    v_lshlrev_b32 v251, 7, v192
    v_cmp_gt_u32 vcc, 16, v192
    v_mov_b32 v194, 0x40000000
    v_mov_b32 v255, 1
    v_cndmask_b32 v251, v194, v251, vcc
    v_cmp_eq_u32 vcc, 0, v253
    s_nop 1
    v_cndmask_b32 v250, v194, v253, vcc
    s_waitcnt vmcnt(19)
    s_barrier
    ds_read_b128 v[64:67], v224 offset:0
    ds_read_b128 v[68:71], v224 offset:2048
    ds_read_b128 v[72:75], v224 offset:4096
    ds_read_b128 v[76:79], v224 offset:6144
    ds_read_b64_tr_b16 a[0:1], v228 offset:0
    ds_read_b64_tr_b16 a[2:3], v228 offset:512
    ds_read_b64_tr_b16 a[4:5], v229 offset:0
    ds_read_b64_tr_b16 a[6:7], v229 offset:512
    ds_read_b64_tr_b16 a[8:9], v230 offset:0
    ds_read_b64_tr_b16 a[10:11], v230 offset:512
    ds_read_b64_tr_b16 a[12:13], v231 offset:0
    ds_read_b64_tr_b16 a[14:15], v231 offset:512
    s_waitcnt vmcnt(12)
    s_barrier
    buffer_store_dword v255, v250, s[88:91], s97 offen sc1
    s_cmp_eq_u32 s3, 0
    s_cselect_b32 s97, 0, s43
    s_cmp_lt_u32 s3, 2
    s_cbranch_scc0 ka_V
    s_waitcnt lgkmcnt(0)
    v_mfma_f32_16x16x32_bf16 v[96:99], a[0:3], v[64:67], 0
    ds_read_b128 v[80:83], v224 offset:8192
    v_mfma_f32_16x16x32_bf16 v[100:103], a[4:7], v[64:67], 0
    ds_read_b128 v[84:87], v224 offset:10240
    v_mfma_f32_16x16x32_bf16 v[104:107], a[8:11], v[64:67], 0
    ds_read_b128 v[88:91], v224 offset:12288
    v_mfma_f32_16x16x32_bf16 v[108:111], a[12:15], v[64:67], 0
    ds_read_b128 v[92:95], v224 offset:14336
    v_mfma_f32_16x16x32_bf16 v[112:115], a[0:3], v[68:71], 0
    ds_read_b64_tr_b16 a[16:17], v228 offset:4096
    v_mfma_f32_16x16x32_bf16 v[116:119], a[4:7], v[68:71], 0
    ds_read_b64_tr_b16 a[18:19], v228 offset:4608
    v_mfma_f32_16x16x32_bf16 v[120:123], a[8:11], v[68:71], 0
    ds_read_b64_tr_b16 a[20:21], v229 offset:4096
    v_mfma_f32_16x16x32_bf16 v[124:127], a[12:15], v[68:71], 0
    ds_read_b64_tr_b16 a[22:23], v229 offset:4608
    v_mfma_f32_16x16x32_bf16 v[128:131], a[0:3], v[72:75], 0
    s_add_u32 m0, s35, 16384
    s_and_b32 s33, s82, 1023
    s_lshl_b32 s33, s33, 12
    buffer_load_dwordx4 v234, s[48:51], s33 offen lds
    v_mfma_f32_16x16x32_bf16 v[132:135], a[4:7], v[72:75], 0
    buffer_load_dwordx4 v235, s[48:51], s33 offen offset:1024 lds
    v_mfma_f32_16x16x32_bf16 v[136:139], a[8:11], v[72:75], 0
    s_add_u32 m0, s35, 18432
    s_add_u32 s33, s33, 131072
    buffer_load_dwordx4 v234, s[48:51], s33 offen lds
    v_mfma_f32_16x16x32_bf16 v[140:143], a[12:15], v[72:75], 0
    v_mfma_f32_16x16x32_bf16 v[144:147], a[0:3], v[76:79], 0
    buffer_load_dwordx4 v235, s[48:51], s33 offen offset:1024 lds
    v_mfma_f32_16x16x32_bf16 v[148:151], a[4:7], v[76:79], 0
    buffer_load_dwordx4 v[0:3], v236, s[52:55], 0 offen offset:0
    v_mfma_f32_16x16x32_bf16 v[152:155], a[8:11], v[76:79], 0
    buffer_load_dwordx4 v[4:7], v236, s[52:55], 0 offen offset:512
    v_mfma_f32_16x16x32_bf16 v[156:159], a[12:15], v[76:79], 0
    s_waitcnt lgkmcnt(0)
    v_mfma_f32_16x16x32_bf16 v[160:163], a[0:3], v[80:83], 0
    ds_read_b128 v[64:67], v225 offset:0
    v_mfma_f32_16x16x32_bf16 v[164:167], a[4:7], v[80:83], 0
    ds_read_b128 v[68:71], v225 offset:2048
    v_mfma_f32_16x16x32_bf16 v[168:171], a[8:11], v[80:83], 0
    ds_read_b128 v[72:75], v225 offset:4096
    v_mfma_f32_16x16x32_bf16 v[172:175], a[12:15], v[80:83], 0
    ds_read_b128 v[76:79], v225 offset:6144
    v_mfma_f32_16x16x32_bf16 v[176:179], a[0:3], v[84:87], 0
    ds_read_b64_tr_b16 a[24:25], v230 offset:4096
    v_mfma_f32_16x16x32_bf16 v[180:183], a[4:7], v[84:87], 0
    ds_read_b64_tr_b16 a[26:27], v230 offset:4608
    v_mfma_f32_16x16x32_bf16 v[184:187], a[8:11], v[84:87], 0
    ds_read_b64_tr_b16 a[28:29], v231 offset:4096
    v_mfma_f32_16x16x32_bf16 v[188:191], a[12:15], v[84:87], 0
    ds_read_b64_tr_b16 a[30:31], v231 offset:4608
    v_mfma_f32_16x16x32_bf16 v[192:195], a[0:3], v[88:91], 0
    s_add_u32 m0, s35, 20480
    s_add_u32 s33, s33, 131072
    buffer_load_dwordx4 v234, s[48:51], s33 offen lds
    v_mfma_f32_16x16x32_bf16 v[196:199], a[4:7], v[88:91], 0
    buffer_load_dwordx4 v235, s[48:51], s33 offen offset:1024 lds
    v_mfma_f32_16x16x32_bf16 v[200:203], a[8:11], v[88:91], 0
    s_add_u32 m0, s35, 22528
    s_add_u32 s33, s33, 131072
    buffer_load_dwordx4 v234, s[48:51], s33 offen lds
    v_mfma_f32_16x16x32_bf16 v[204:207], a[12:15], v[88:91], 0
    v_mfma_f32_16x16x32_bf16 v[208:211], a[0:3], v[92:95], 0
    buffer_load_dwordx4 v235, s[48:51], s33 offen offset:1024 lds
    v_mfma_f32_16x16x32_bf16 v[212:215], a[4:7], v[92:95], 0
    buffer_load_dwordx4 v[8:11], v236, s[52:55], 0 offen offset:1024
    v_mfma_f32_16x16x32_bf16 v[216:219], a[8:11], v[92:95], 0
    buffer_load_dwordx4 v[12:15], v236, s[52:55], 0 offen offset:1536
    v_mfma_f32_16x16x32_bf16 v[220:223], a[12:15], v[92:95], 0
    s_waitcnt vmcnt(17) lgkmcnt(0)
    v_mfma_f32_16x16x32_bf16 v[96:99], a[16:19], v[64:67], v[96:99]
    ds_read_b128 v[80:83], v225 offset:8192
    v_mfma_f32_16x16x32_bf16 v[100:103], a[20:23], v[64:67], v[100:103]
    ds_read_b128 v[84:87], v225 offset:10240
    v_mfma_f32_16x16x32_bf16 v[104:107], a[24:27], v[64:67], v[104:107]
    ds_read_b128 v[88:91], v225 offset:12288
    v_mfma_f32_16x16x32_bf16 v[108:111], a[28:31], v[64:67], v[108:111]
    ds_read_b128 v[92:95], v225 offset:14336
    v_mfma_f32_16x16x32_bf16 v[112:115], a[16:19], v[68:71], v[112:115]
    ds_read_b64_tr_b16 a[32:33], v228 offset:8192
    v_mfma_f32_16x16x32_bf16 v[116:119], a[20:23], v[68:71], v[116:119]
    ds_read_b64_tr_b16 a[34:35], v228 offset:8704
    v_mfma_f32_16x16x32_bf16 v[120:123], a[24:27], v[68:71], v[120:123]
    ds_read_b64_tr_b16 a[36:37], v229 offset:8192
    v_mfma_f32_16x16x32_bf16 v[124:127], a[28:31], v[68:71], v[124:127]
    ds_read_b64_tr_b16 a[38:39], v229 offset:8704
    v_mfma_f32_16x16x32_bf16 v[128:131], a[16:19], v[72:75], v[128:131]
    s_add_u32 m0, s34, 32768
    s_add_u32 s37, s82, 0
    buffer_load_dwordx4 v232, s[44:47], s37 offen lds
    v_mfma_f32_16x16x32_bf16 v[132:135], a[20:23], v[72:75], v[132:135]
    buffer_load_dwordx4 v233, s[44:47], s37 offen offset:1024 lds
    v_mfma_f32_16x16x32_bf16 v[136:139], a[24:27], v[72:75], v[136:139]
    s_add_u32 m0, s34, 40960
    s_add_u32 s37, s82, 65536
    buffer_load_dwordx4 v232, s[44:47], s37 offen lds
    v_mfma_f32_16x16x32_bf16 v[140:143], a[28:31], v[72:75], v[140:143]
    buffer_load_dwordx4 v233, s[44:47], s37 offen offset:1024 lds
    v_mfma_f32_16x16x32_bf16 v[144:147], a[16:19], v[76:79], v[144:147]
    s_add_u32 m0, s35, 0
    s_and_b32 s33, s83, 1023
    s_lshl_b32 s33, s33, 12
    buffer_load_dwordx4 v234, s[48:51], s33 offen lds
    v_mfma_f32_16x16x32_bf16 v[148:151], a[20:23], v[76:79], v[148:151]
    buffer_load_dwordx4 v235, s[48:51], s33 offen offset:1024 lds
    v_mfma_f32_16x16x32_bf16 v[152:155], a[24:27], v[76:79], v[152:155]
    s_add_u32 m0, s35, 2048
    s_add_u32 s33, s33, 131072
    buffer_load_dwordx4 v234, s[48:51], s33 offen lds
    v_mfma_f32_16x16x32_bf16 v[156:159], a[28:31], v[76:79], v[156:159]
    buffer_load_dwordx4 v235, s[48:51], s33 offen offset:1024 lds
    s_waitcnt vmcnt(21) lgkmcnt(0)
    s_barrier
    v_mfma_f32_16x16x32_bf16 v[160:163], a[16:19], v[80:83], v[160:163]
    ds_read_b128 v[64:67], v224 offset:16384
    v_mfma_f32_16x16x32_bf16 v[164:167], a[20:23], v[80:83], v[164:167]
    ds_read_b128 v[68:71], v224 offset:18432
    v_mfma_f32_16x16x32_bf16 v[168:171], a[24:27], v[80:83], v[168:171]
    ds_read_b128 v[72:75], v224 offset:20480
    v_mfma_f32_16x16x32_bf16 v[172:175], a[28:31], v[80:83], v[172:175]
    ds_read_b128 v[76:79], v224 offset:22528
    v_mfma_f32_16x16x32_bf16 v[176:179], a[16:19], v[84:87], v[176:179]
    ds_read_b64_tr_b16 a[40:41], v230 offset:8192
    v_mfma_f32_16x16x32_bf16 v[180:183], a[20:23], v[84:87], v[180:183]
    ds_read_b64_tr_b16 a[42:43], v230 offset:8704
    v_mfma_f32_16x16x32_bf16 v[184:187], a[24:27], v[84:87], v[184:187]
    ds_read_b64_tr_b16 a[44:45], v231 offset:8192
    v_mfma_f32_16x16x32_bf16 v[188:191], a[28:31], v[84:87], v[188:191]
    ds_read_b64_tr_b16 a[46:47], v231 offset:8704
    v_mfma_f32_16x16x32_bf16 v[192:195], a[16:19], v[88:91], v[192:195]
    s_add_u32 m0, s34, 49152
    s_add_u32 s37, s83, 0
    buffer_load_dwordx4 v232, s[44:47], s37 offen lds
    v_mfma_f32_16x16x32_bf16 v[196:199], a[20:23], v[88:91], v[196:199]
    buffer_load_dwordx4 v233, s[44:47], s37 offen offset:1024 lds
    v_mfma_f32_16x16x32_bf16 v[200:203], a[24:27], v[88:91], v[200:203]
    s_add_u32 m0, s34, 57344
    s_add_u32 s37, s83, 65536
    buffer_load_dwordx4 v232, s[44:47], s37 offen lds
    v_mfma_f32_16x16x32_bf16 v[204:207], a[28:31], v[88:91], v[204:207]
    v_mfma_f32_16x16x32_bf16 v[208:211], a[16:19], v[92:95], v[208:211]
    buffer_load_dwordx4 v233, s[44:47], s37 offen offset:1024 lds
    v_mfma_f32_16x16x32_bf16 v[212:215], a[20:23], v[92:95], v[212:215]
    s_add_u32 m0, s34, 0
    s_add_u32 s37, s84, 0
    buffer_load_dwordx4 v232, s[44:47], s37 offen lds
    v_mfma_f32_16x16x32_bf16 v[216:219], a[24:27], v[92:95], v[216:219]
    buffer_load_dwordx4 v233, s[44:47], s37 offen offset:1024 lds
    v_mfma_f32_16x16x32_bf16 v[220:223], a[28:31], v[92:95], v[220:223]
    s_waitcnt lgkmcnt(0)
    v_mfma_f32_16x16x32_bf16 v[96:99], a[32:35], v[64:67], v[96:99]
    ds_read_b128 v[80:83], v224 offset:24576
    v_mfma_f32_16x16x32_bf16 v[100:103], a[36:39], v[64:67], v[100:103]
    ds_read_b128 v[84:87], v224 offset:26624
    v_mfma_f32_16x16x32_bf16 v[104:107], a[40:43], v[64:67], v[104:107]
    ds_read_b128 v[88:91], v224 offset:28672
    v_mfma_f32_16x16x32_bf16 v[108:111], a[44:47], v[64:67], v[108:111]
    ds_read_b128 v[92:95], v224 offset:30720
    v_mfma_f32_16x16x32_bf16 v[112:115], a[32:35], v[68:71], v[112:115]
    ds_read_b64_tr_b16 a[48:49], v228 offset:12288
    v_mfma_f32_16x16x32_bf16 v[116:119], a[36:39], v[68:71], v[116:119]
    ds_read_b64_tr_b16 a[50:51], v228 offset:12800
    v_mfma_f32_16x16x32_bf16 v[120:123], a[40:43], v[68:71], v[120:123]
    ds_read_b64_tr_b16 a[52:53], v229 offset:12288
    v_mfma_f32_16x16x32_bf16 v[124:127], a[44:47], v[68:71], v[124:127]
    ds_read_b64_tr_b16 a[54:55], v229 offset:12800
    v_mfma_f32_16x16x32_bf16 v[128:131], a[32:35], v[72:75], v[128:131]
    s_add_u32 m0, s35, 4096
    s_add_u32 s33, s33, 131072
    buffer_load_dwordx4 v234, s[48:51], s33 offen lds
    v_mfma_f32_16x16x32_bf16 v[132:135], a[36:39], v[72:75], v[132:135]
    v_mfma_f32_16x16x32_bf16 v[136:139], a[40:43], v[72:75], v[136:139]
    buffer_load_dwordx4 v235, s[48:51], s33 offen offset:1024 lds
    v_mfma_f32_16x16x32_bf16 v[140:143], a[44:47], v[72:75], v[140:143]
    v_mfma_f32_16x16x32_bf16 v[144:147], a[32:35], v[76:79], v[144:147]
    s_add_u32 m0, s35, 6144
    s_add_u32 s33, s33, 131072
    buffer_load_dwordx4 v234, s[48:51], s33 offen lds
    v_mfma_f32_16x16x32_bf16 v[148:151], a[36:39], v[76:79], v[148:151]
    v_mfma_f32_16x16x32_bf16 v[152:155], a[40:43], v[76:79], v[152:155]
    buffer_load_dwordx4 v235, s[48:51], s33 offen offset:1024 lds
    v_mfma_f32_16x16x32_bf16 v[156:159], a[44:47], v[76:79], v[156:159]
    s_waitcnt lgkmcnt(0)
    v_mfma_f32_16x16x32_bf16 v[160:163], a[32:35], v[80:83], v[160:163]
    ds_read_b128 v[64:67], v225 offset:16384
    v_mfma_f32_16x16x32_bf16 v[164:167], a[36:39], v[80:83], v[164:167]
    ds_read_b128 v[68:71], v225 offset:18432
    v_mfma_f32_16x16x32_bf16 v[168:171], a[40:43], v[80:83], v[168:171]
    ds_read_b128 v[72:75], v225 offset:20480
    v_mfma_f32_16x16x32_bf16 v[172:175], a[44:47], v[80:83], v[172:175]
    ds_read_b128 v[76:79], v225 offset:22528
    v_mfma_f32_16x16x32_bf16 v[176:179], a[32:35], v[84:87], v[176:179]
    ds_read_b64_tr_b16 a[56:57], v230 offset:12288
    v_mfma_f32_16x16x32_bf16 v[180:183], a[36:39], v[84:87], v[180:183]
    ds_read_b64_tr_b16 a[58:59], v230 offset:12800
    v_mfma_f32_16x16x32_bf16 v[184:187], a[40:43], v[84:87], v[184:187]
    ds_read_b64_tr_b16 a[60:61], v231 offset:12288
    v_mfma_f32_16x16x32_bf16 v[188:191], a[44:47], v[84:87], v[188:191]
    ds_read_b64_tr_b16 a[62:63], v231 offset:12800
    v_mfma_f32_16x16x32_bf16 v[192:195], a[32:35], v[88:91], v[192:195]
    s_add_u32 m0, s34, 8192
    s_add_u32 s37, s84, 65536
    buffer_load_dwordx4 v232, s[44:47], s37 offen lds
    v_mfma_f32_16x16x32_bf16 v[196:199], a[36:39], v[88:91], v[196:199]
    v_mfma_f32_16x16x32_bf16 v[200:203], a[40:43], v[88:91], v[200:203]
    v_mfma_f32_16x16x32_bf16 v[204:207], a[44:47], v[88:91], v[204:207]
    v_mfma_f32_16x16x32_bf16 v[208:211], a[32:35], v[92:95], v[208:211]
    buffer_load_dwordx4 v233, s[44:47], s37 offen offset:1024 lds
    v_mfma_f32_16x16x32_bf16 v[212:215], a[36:39], v[92:95], v[212:215]
    v_mfma_f32_16x16x32_bf16 v[216:219], a[40:43], v[92:95], v[216:219]
    v_mfma_f32_16x16x32_bf16 v[220:223], a[44:47], v[92:95], v[220:223]
    s_waitcnt vmcnt(22) lgkmcnt(0)
    v_mfma_f32_16x16x32_bf16 v[96:99], a[48:51], v[64:67], v[96:99]
    ds_read_b128 v[80:83], v225 offset:24576
    v_mfma_f32_16x16x32_bf16 v[100:103], a[52:55], v[64:67], v[100:103]
    ds_read_b128 v[84:87], v225 offset:26624
    v_mfma_f32_16x16x32_bf16 v[104:107], a[56:59], v[64:67], v[104:107]
    ds_read_b128 v[88:91], v225 offset:28672
    v_mfma_f32_16x16x32_bf16 v[108:111], a[60:63], v[64:67], v[108:111]
    ds_read_b128 v[92:95], v225 offset:30720
    v_mfma_f32_16x16x32_bf16 v[112:115], a[48:51], v[68:71], v[112:115]
    ds_read_b64_tr_b16 a[64:65], v228 offset:16384
    v_mfma_f32_16x16x32_bf16 v[116:119], a[52:55], v[68:71], v[116:119]
    ds_read_b64_tr_b16 a[66:67], v228 offset:16896
    v_mfma_f32_16x16x32_bf16 v[120:123], a[56:59], v[68:71], v[120:123]
    ds_read_b64_tr_b16 a[68:69], v229 offset:16384
    v_mfma_f32_16x16x32_bf16 v[124:127], a[60:63], v[68:71], v[124:127]
    ds_read_b64_tr_b16 a[70:71], v229 offset:16896
    v_mfma_f32_16x16x32_bf16 v[128:131], a[48:51], v[72:75], v[128:131]
    s_add_u32 m0, s35, 8192
    s_and_b32 s33, s84, 1023
    s_lshl_b32 s33, s33, 12
    buffer_load_dwordx4 v234, s[48:51], s33 offen lds
    v_mfma_f32_16x16x32_bf16 v[132:135], a[52:55], v[72:75], v[132:135]
    v_mfma_f32_16x16x32_bf16 v[136:139], a[56:59], v[72:75], v[136:139]
    buffer_load_dwordx4 v235, s[48:51], s33 offen offset:1024 lds
    v_mfma_f32_16x16x32_bf16 v[140:143], a[60:63], v[72:75], v[140:143]
    v_mfma_f32_16x16x32_bf16 v[144:147], a[48:51], v[76:79], v[144:147]
    s_add_u32 m0, s35, 10240
    s_add_u32 s33, s33, 131072
    buffer_load_dwordx4 v234, s[48:51], s33 offen lds
    v_mfma_f32_16x16x32_bf16 v[148:151], a[52:55], v[76:79], v[148:151]
    v_mfma_f32_16x16x32_bf16 v[152:155], a[56:59], v[76:79], v[152:155]
    buffer_load_dwordx4 v235, s[48:51], s33 offen offset:1024 lds
    v_mfma_f32_16x16x32_bf16 v[156:159], a[60:63], v[76:79], v[156:159]
    s_waitcnt vmcnt(20) lgkmcnt(0)
    s_barrier
    v_mfma_f32_16x16x32_bf16 v[160:163], a[48:51], v[80:83], v[160:163]
    ds_read_b128 v[64:67], v224 offset:32768
    v_mfma_f32_16x16x32_bf16 v[164:167], a[52:55], v[80:83], v[164:167]
    ds_read_b128 v[68:71], v224 offset:34816
    v_mfma_f32_16x16x32_bf16 v[168:171], a[56:59], v[80:83], v[168:171]
    ds_read_b128 v[72:75], v224 offset:36864
    v_mfma_f32_16x16x32_bf16 v[172:175], a[60:63], v[80:83], v[172:175]
    ds_read_b128 v[76:79], v224 offset:38912
    v_mfma_f32_16x16x32_bf16 v[176:179], a[48:51], v[84:87], v[176:179]
    ds_read_b64_tr_b16 a[72:73], v230 offset:16384
    v_mfma_f32_16x16x32_bf16 v[180:183], a[52:55], v[84:87], v[180:183]
    ds_read_b64_tr_b16 a[74:75], v230 offset:16896
    v_mfma_f32_16x16x32_bf16 v[184:187], a[56:59], v[84:87], v[184:187]
    ds_read_b64_tr_b16 a[76:77], v231 offset:16384
    v_mfma_f32_16x16x32_bf16 v[188:191], a[60:63], v[84:87], v[188:191]
    ds_read_b64_tr_b16 a[78:79], v231 offset:16896
    v_mfma_f32_16x16x32_bf16 v[192:195], a[48:51], v[88:91], v[192:195]
    s_add_u32 m0, s34, 16384
    s_add_u32 s37, s85, 0
    buffer_load_dwordx4 v232, s[44:47], s37 offen lds
    v_mfma_f32_16x16x32_bf16 v[196:199], a[52:55], v[88:91], v[196:199]
    v_mfma_f32_16x16x32_bf16 v[200:203], a[56:59], v[88:91], v[200:203]
    v_mfma_f32_16x16x32_bf16 v[204:207], a[60:63], v[88:91], v[204:207]
    v_mfma_f32_16x16x32_bf16 v[208:211], a[48:51], v[92:95], v[208:211]
    buffer_load_dwordx4 v233, s[44:47], s37 offen offset:1024 lds
    v_mfma_f32_16x16x32_bf16 v[212:215], a[52:55], v[92:95], v[212:215]
    v_mfma_f32_16x16x32_bf16 v[216:219], a[56:59], v[92:95], v[216:219]
    v_mfma_f32_16x16x32_bf16 v[220:223], a[60:63], v[92:95], v[220:223]
    s_waitcnt lgkmcnt(0)
    v_mfma_f32_16x16x32_bf16 v[96:99], a[64:67], v[64:67], v[96:99]
    ds_read_b128 v[80:83], v224 offset:40960
    s_waitcnt vmcnt(26)
    v_mfma_f32_16x16x32_bf16 v[100:103], a[68:71], v[64:67], v[100:103]
    ds_read_b128 v[84:87], v224 offset:43008
    v_lshlrev_b32 v16, 16, v0
    v_mfma_f32_16x16x32_bf16 v[104:107], a[72:75], v[64:67], v[104:107]
    ds_read_b128 v[88:91], v224 offset:45056
    v_and_b32 v17, 0xffff0000, v0
    v_mfma_f32_16x16x32_bf16 v[108:111], a[76:79], v[64:67], v[108:111]
    ds_read_b128 v[92:95], v224 offset:47104
    v_lshlrev_b32 v18, 16, v1
    v_mfma_f32_16x16x32_bf16 v[112:115], a[64:67], v[68:71], v[112:115]
    ds_read_b64_tr_b16 a[80:81], v228 offset:20480
    v_and_b32 v19, 0xffff0000, v1
    v_mfma_f32_16x16x32_bf16 v[116:119], a[68:71], v[68:71], v[116:119]
    ds_read_b64_tr_b16 a[82:83], v228 offset:20992
    v_lshlrev_b32 v20, 16, v2
    v_mfma_f32_16x16x32_bf16 v[120:123], a[72:75], v[68:71], v[120:123]
    ds_read_b64_tr_b16 a[84:85], v229 offset:20480
    v_and_b32 v21, 0xffff0000, v2
    v_mfma_f32_16x16x32_bf16 v[124:127], a[76:79], v[68:71], v[124:127]
    ds_read_b64_tr_b16 a[86:87], v229 offset:20992
    v_lshlrev_b32 v22, 16, v3
    v_mfma_f32_16x16x32_bf16 v[128:131], a[64:67], v[72:75], v[128:131]
    s_add_u32 m0, s35, 12288
    s_add_u32 s33, s33, 131072
    buffer_load_dwordx4 v234, s[48:51], s33 offen lds
    v_mfma_f32_16x16x32_bf16 v[132:135], a[68:71], v[72:75], v[132:135]
    v_and_b32 v23, 0xffff0000, v3
    v_lshlrev_b32 v24, 16, v4
    v_mfma_f32_16x16x32_bf16 v[136:139], a[72:75], v[72:75], v[136:139]
    buffer_load_dwordx4 v235, s[48:51], s33 offen offset:1024 lds
    v_and_b32 v25, 0xffff0000, v4
    v_mfma_f32_16x16x32_bf16 v[140:143], a[76:79], v[72:75], v[140:143]
    v_lshlrev_b32 v26, 16, v5
    v_and_b32 v27, 0xffff0000, v5
    v_mfma_f32_16x16x32_bf16 v[144:147], a[64:67], v[76:79], v[144:147]
    s_add_u32 m0, s35, 14336
    s_add_u32 s33, s33, 131072
    buffer_load_dwordx4 v234, s[48:51], s33 offen lds
    v_mfma_f32_16x16x32_bf16 v[148:151], a[68:71], v[76:79], v[148:151]
    v_lshlrev_b32 v28, 16, v6
    v_and_b32 v29, 0xffff0000, v6
    v_mfma_f32_16x16x32_bf16 v[152:155], a[72:75], v[76:79], v[152:155]
    buffer_load_dwordx4 v235, s[48:51], s33 offen offset:1024 lds
    v_lshlrev_b32 v30, 16, v7
    v_mfma_f32_16x16x32_bf16 v[156:159], a[76:79], v[76:79], v[156:159]
    v_and_b32 v31, 0xffff0000, v7
    s_waitcnt lgkmcnt(0)
    v_mfma_f32_16x16x32_bf16 v[160:163], a[64:67], v[80:83], v[160:163]
    ds_read_b128 v[64:67], v225 offset:32768
    v_lshlrev_b32 v32, 16, v8
    v_mfma_f32_16x16x32_bf16 v[164:167], a[68:71], v[80:83], v[164:167]
    ds_read_b128 v[68:71], v225 offset:34816
    v_and_b32 v33, 0xffff0000, v8
    v_mfma_f32_16x16x32_bf16 v[168:171], a[72:75], v[80:83], v[168:171]
    ds_read_b128 v[72:75], v225 offset:36864
    v_lshlrev_b32 v34, 16, v9
    v_mfma_f32_16x16x32_bf16 v[172:175], a[76:79], v[80:83], v[172:175]
    ds_read_b128 v[76:79], v225 offset:38912
    v_and_b32 v35, 0xffff0000, v9
    v_mfma_f32_16x16x32_bf16 v[176:179], a[64:67], v[84:87], v[176:179]
    ds_read_b64_tr_b16 a[88:89], v230 offset:20480
    v_lshlrev_b32 v36, 16, v10
    v_mfma_f32_16x16x32_bf16 v[180:183], a[68:71], v[84:87], v[180:183]
    ds_read_b64_tr_b16 a[90:91], v230 offset:20992
    v_and_b32 v37, 0xffff0000, v10
    v_mfma_f32_16x16x32_bf16 v[184:187], a[72:75], v[84:87], v[184:187]
    ds_read_b64_tr_b16 a[92:93], v231 offset:20480
    v_lshlrev_b32 v38, 16, v11
    v_mfma_f32_16x16x32_bf16 v[188:191], a[76:79], v[84:87], v[188:191]
    ds_read_b64_tr_b16 a[94:95], v231 offset:20992
    v_and_b32 v39, 0xffff0000, v11
    v_mfma_f32_16x16x32_bf16 v[192:195], a[64:67], v[88:91], v[192:195]
    s_add_u32 m0, s34, 24576
    s_add_u32 s37, s85, 65536
    buffer_load_dwordx4 v232, s[44:47], s37 offen lds
    v_mfma_f32_16x16x32_bf16 v[196:199], a[68:71], v[88:91], v[196:199]
    v_lshlrev_b32 v40, 16, v12
    v_and_b32 v41, 0xffff0000, v12
    v_mfma_f32_16x16x32_bf16 v[200:203], a[72:75], v[88:91], v[200:203]
    v_lshlrev_b32 v42, 16, v13
    v_and_b32 v43, 0xffff0000, v13
    v_mfma_f32_16x16x32_bf16 v[204:207], a[76:79], v[88:91], v[204:207]
    v_lshlrev_b32 v44, 16, v14
    v_and_b32 v45, 0xffff0000, v14
    v_mfma_f32_16x16x32_bf16 v[208:211], a[64:67], v[92:95], v[208:211]
    buffer_load_dwordx4 v233, s[44:47], s37 offen offset:1024 lds
    v_lshlrev_b32 v46, 16, v15
    v_mfma_f32_16x16x32_bf16 v[212:215], a[68:71], v[92:95], v[212:215]
    v_and_b32 v47, 0xffff0000, v15
    v_add_f32 v52, v16, v20
    v_mfma_f32_16x16x32_bf16 v[216:219], a[72:75], v[92:95], v[216:219]
    v_add_f32 v53, v17, v21
    v_add_f32 v54, v18, v22
    v_mfma_f32_16x16x32_bf16 v[220:223], a[76:79], v[92:95], v[220:223]
    v_add_f32 v55, v19, v23
    s_waitcnt vmcnt(14) lgkmcnt(0)
    v_mfma_f32_16x16x32_bf16 v[96:99], a[80:83], v[64:67], v[96:99]
    ds_read_b128 v[80:83], v225 offset:40960
    v_add_f32 v52, v52, v24
    v_add_f32 v53, v53, v25
    v_mfma_f32_16x16x32_bf16 v[100:103], a[84:87], v[64:67], v[100:103]
    ds_read_b128 v[84:87], v225 offset:43008
    v_add_f32 v54, v54, v26
    v_mfma_f32_16x16x32_bf16 v[104:107], a[88:91], v[64:67], v[104:107]
    ds_read_b128 v[88:91], v225 offset:45056
    v_add_f32 v55, v55, v27
    v_mfma_f32_16x16x32_bf16 v[108:111], a[92:95], v[64:67], v[108:111]
    ds_read_b128 v[92:95], v225 offset:47104
    v_add_f32 v52, v52, v28
    v_mfma_f32_16x16x32_bf16 v[112:115], a[80:83], v[68:71], v[112:115]
    ds_read_b64_tr_b16 a[96:97], v228 offset:0
    v_add_f32 v53, v53, v29
    v_mfma_f32_16x16x32_bf16 v[116:119], a[84:87], v[68:71], v[116:119]
    ds_read_b64_tr_b16 a[98:99], v228 offset:512
    v_add_f32 v54, v54, v30
    v_mfma_f32_16x16x32_bf16 v[120:123], a[88:91], v[68:71], v[120:123]
    ds_read_b64_tr_b16 a[100:101], v229 offset:0
    v_add_f32 v55, v55, v31
    v_mfma_f32_16x16x32_bf16 v[124:127], a[92:95], v[68:71], v[124:127]
    ds_read_b64_tr_b16 a[102:103], v229 offset:512
    v_add_f32 v52, v52, v32
    v_mfma_f32_16x16x32_bf16 v[128:131], a[80:83], v[72:75], v[128:131]
    s_add_u32 m0, s35, 16384
    s_and_b32 s33, s85, 1023
    s_lshl_b32 s33, s33, 12
    buffer_load_dwordx4 v234, s[48:51], s33 offen lds
    v_mfma_f32_16x16x32_bf16 v[132:135], a[84:87], v[72:75], v[132:135]
    buffer_load_dwordx4 v235, s[48:51], s33 offen offset:1024 lds
    v_add_f32 v53, v53, v33
    v_mfma_f32_16x16x32_bf16 v[136:139], a[88:91], v[72:75], v[136:139]
    s_add_u32 m0, s35, 18432
    s_add_u32 s33, s33, 131072
    buffer_load_dwordx4 v234, s[48:51], s33 offen lds
    v_mfma_f32_16x16x32_bf16 v[140:143], a[92:95], v[72:75], v[140:143]
    v_add_f32 v54, v54, v34
    v_add_f32 v55, v55, v35
    v_mfma_f32_16x16x32_bf16 v[144:147], a[80:83], v[76:79], v[144:147]
    buffer_load_dwordx4 v235, s[48:51], s33 offen offset:1024 lds
    v_add_f32 v52, v52, v36
    v_mfma_f32_16x16x32_bf16 v[148:151], a[84:87], v[76:79], v[148:151]
    s_lshl2_add_u32 s26, s4, s3
    s_lshl_b32 s26, s26, 10
    s_add_u32 s26, s26, s32
    s_add_u32 s26, s26, 131072
    v_mfma_f32_16x16x32_bf16 v[152:155], a[88:91], v[76:79], v[152:155]
    v_and_b32 v226, 0x40000380, v251
    buffer_load_dword v241, v226, s[44:47], s26 offen
    v_mfma_f32_16x16x32_bf16 v[156:159], a[92:95], v[76:79], v[156:159]
    s_waitcnt vmcnt(25) lgkmcnt(0)
    s_barrier
    v_mfma_f32_16x16x32_bf16 v[160:163], a[80:83], v[80:83], v[160:163]
    ds_read_b128 v[64:67], v224 offset:49152
    v_add_f32 v53, v53, v37
    v_mfma_f32_16x16x32_bf16 v[164:167], a[84:87], v[80:83], v[164:167]
    ds_read_b128 v[68:71], v224 offset:51200
    v_add_f32 v54, v54, v38
    v_mfma_f32_16x16x32_bf16 v[168:171], a[88:91], v[80:83], v[168:171]
    ds_read_b128 v[72:75], v224 offset:53248
    v_add_f32 v55, v55, v39
    v_mfma_f32_16x16x32_bf16 v[172:175], a[92:95], v[80:83], v[172:175]
    ds_read_b128 v[76:79], v224 offset:55296
    v_add_f32 v52, v52, v40
    v_mfma_f32_16x16x32_bf16 v[176:179], a[80:83], v[84:87], v[176:179]
    ds_read_b64_tr_b16 a[104:105], v230 offset:0
    v_add_f32 v53, v53, v41
    v_mfma_f32_16x16x32_bf16 v[180:183], a[84:87], v[84:87], v[180:183]
    ds_read_b64_tr_b16 a[106:107], v230 offset:512
    v_add_f32 v54, v54, v42
    v_mfma_f32_16x16x32_bf16 v[184:187], a[88:91], v[84:87], v[184:187]
    ds_read_b64_tr_b16 a[108:109], v231 offset:0
    v_add_f32 v55, v55, v43
    v_mfma_f32_16x16x32_bf16 v[188:191], a[92:95], v[84:87], v[188:191]
    ds_read_b64_tr_b16 a[110:111], v231 offset:512
    v_add_f32 v52, v52, v44
    v_mfma_f32_16x16x32_bf16 v[192:195], a[80:83], v[88:91], v[192:195]
    s_add_u32 m0, s34, 32768
    s_add_u32 s37, s86, 0
    buffer_load_dwordx4 v232, s[44:47], s37 offen lds
    v_mfma_f32_16x16x32_bf16 v[196:199], a[84:87], v[88:91], v[196:199]
    v_add_f32 v53, v53, v45
    v_add_f32 v54, v54, v46
    v_mfma_f32_16x16x32_bf16 v[200:203], a[88:91], v[88:91], v[200:203]
    v_add_f32 v55, v55, v47
    v_add_f32 v52, v52, v53
    v_mfma_f32_16x16x32_bf16 v[204:207], a[92:95], v[88:91], v[204:207]
    v_add_f32 v54, v54, v55
    v_add_f32 v48, v52, v54
    v_mfma_f32_16x16x32_bf16 v[208:211], a[80:83], v[92:95], v[208:211]
    buffer_load_dwordx4 v233, s[44:47], s37 offen offset:1024 lds
    s_nop 1
    v_mfma_f32_16x16x32_bf16 v[212:215], a[84:87], v[92:95], v[212:215]
    v_add_f32_dpp v48, v48, v48 quad_perm:[1,0,3,2] row_mask:0xf bank_mask:0xf
    s_nop 1
    v_mfma_f32_16x16x32_bf16 v[216:219], a[88:91], v[92:95], v[216:219]
    v_add_f32_dpp v48, v48, v48 quad_perm:[2,3,0,1] row_mask:0xf bank_mask:0xf
    s_nop 1
    v_mfma_f32_16x16x32_bf16 v[220:223], a[92:95], v[92:95], v[220:223]
    v_add_f32_dpp v48, v48, v48 row_half_mirror row_mask:0xf bank_mask:0xf
    s_waitcnt lgkmcnt(0)
    v_mfma_f32_16x16x32_bf16 v[96:99], a[96:99], v[64:67], v[96:99]
    ds_read_b128 v[80:83], v224 offset:57344
    s_nop 1
    v_mfma_f32_16x16x32_bf16 v[100:103], a[100:103], v[64:67], v[100:103]
    ds_read_b128 v[84:87], v224 offset:59392
    v_add_f32_dpp v48, v48, v48 row_mirror row_mask:0xf bank_mask:0xf
    v_mfma_f32_16x16x32_bf16 v[104:107], a[104:107], v[64:67], v[104:107]
    ds_read_b128 v[88:91], v224 offset:61440
    s_nop 0
    v_mfma_f32_16x16x32_bf16 v[108:111], a[108:111], v[64:67], v[108:111]
    ds_read_b128 v[92:95], v224 offset:63488
    v_mov_b32 v49, v48
    v_mfma_f32_16x16x32_bf16 v[112:115], a[96:99], v[68:71], v[112:115]
    ds_read_b64_tr_b16 a[112:113], v228 offset:4096
    s_nop 1
    v_mfma_f32_16x16x32_bf16 v[116:119], a[100:103], v[68:71], v[116:119]
    ds_read_b64_tr_b16 a[114:115], v228 offset:4608
    v_permlane16_swap_b32 v48, v49
    v_mfma_f32_16x16x32_bf16 v[120:123], a[104:107], v[68:71], v[120:123]
    ds_read_b64_tr_b16 a[116:117], v229 offset:4096
    s_nop 0
    v_mfma_f32_16x16x32_bf16 v[124:127], a[108:111], v[68:71], v[124:127]
    ds_read_b64_tr_b16 a[118:119], v229 offset:4608
    v_add_f32 v48, v48, v49
    v_mfma_f32_16x16x32_bf16 v[128:131], a[96:99], v[72:75], v[128:131]
    s_add_u32 m0, s35, 20480
    s_add_u32 s33, s33, 131072
    buffer_load_dwordx4 v234, s[48:51], s33 offen lds
    v_mfma_f32_16x16x32_bf16 v[132:135], a[100:103], v[72:75], v[132:135]
    buffer_load_dwordx4 v235, s[48:51], s33 offen offset:1024 lds
    v_mul_f32 v48, 0x3a800000, v48
    v_mfma_f32_16x16x32_bf16 v[136:139], a[104:107], v[72:75], v[136:139]
    v_sub_f32 v56, v16, v48
    v_mul_f32 v52, v56, v56
    v_mfma_f32_16x16x32_bf16 v[140:143], a[108:111], v[72:75], v[140:143]
    s_add_u32 m0, s35, 22528
    s_add_u32 s33, s33, 131072
    buffer_load_dwordx4 v234, s[48:51], s33 offen lds
    v_mfma_f32_16x16x32_bf16 v[144:147], a[96:99], v[76:79], v[144:147]
    buffer_load_dwordx4 v235, s[48:51], s33 offen offset:1024 lds
    v_sub_f32 v57, v17, v48
    v_mfma_f32_16x16x32_bf16 v[148:151], a[100:103], v[76:79], v[148:151]
    v_mul_f32 v53, v57, v57
    v_sub_f32 v58, v18, v48
    v_mfma_f32_16x16x32_bf16 v[152:155], a[104:107], v[76:79], v[152:155]
    v_lshlrev_b32 v226, 7, v253
    s_lshl_b32 s25, s2, 15
    buffer_load_dword v241, v226, s[12:15], s25 offen
    v_mfma_f32_16x16x32_bf16 v[156:159], a[108:111], v[76:79], v[156:159]
    v_mul_f32 v54, v58, v58
    s_waitcnt lgkmcnt(0)
    v_mfma_f32_16x16x32_bf16 v[160:163], a[96:99], v[80:83], v[160:163]
    ds_read_b128 v[64:67], v225 offset:49152
    v_sub_f32 v59, v19, v48
    v_mfma_f32_16x16x32_bf16 v[164:167], a[100:103], v[80:83], v[164:167]
    ds_read_b128 v[68:71], v225 offset:51200
    v_mul_f32 v55, v59, v59
    v_mfma_f32_16x16x32_bf16 v[168:171], a[104:107], v[80:83], v[168:171]
    ds_read_b128 v[72:75], v225 offset:53248
    v_sub_f32 v56, v20, v48
    v_mfma_f32_16x16x32_bf16 v[172:175], a[108:111], v[80:83], v[172:175]
    ds_read_b128 v[76:79], v225 offset:55296
    v_fmac_f32 v52, v56, v56
    v_mfma_f32_16x16x32_bf16 v[176:179], a[96:99], v[84:87], v[176:179]
    ds_read_b64_tr_b16 a[120:121], v230 offset:4096
    v_sub_f32 v57, v21, v48
    v_mfma_f32_16x16x32_bf16 v[180:183], a[100:103], v[84:87], v[180:183]
    ds_read_b64_tr_b16 a[122:123], v230 offset:4608
    v_fmac_f32 v53, v57, v57
    v_mfma_f32_16x16x32_bf16 v[184:187], a[104:107], v[84:87], v[184:187]
    ds_read_b64_tr_b16 a[124:125], v231 offset:4096
    v_sub_f32 v58, v22, v48
    v_mfma_f32_16x16x32_bf16 v[188:191], a[108:111], v[84:87], v[188:191]
    ds_read_b64_tr_b16 a[126:127], v231 offset:4608
    v_fmac_f32 v54, v58, v58
    v_mfma_f32_16x16x32_bf16 v[192:195], a[96:99], v[88:91], v[192:195]
    s_add_u32 m0, s34, 40960
    s_add_u32 s37, s86, 65536
    buffer_load_dwordx4 v232, s[44:47], s37 offen lds
    v_mfma_f32_16x16x32_bf16 v[196:199], a[100:103], v[88:91], v[196:199]
    v_sub_f32 v59, v23, v48
    v_fmac_f32 v55, v59, v59
    v_mfma_f32_16x16x32_bf16 v[200:203], a[104:107], v[88:91], v[200:203]
    v_sub_f32 v56, v24, v48
    v_fmac_f32 v52, v56, v56
    v_mfma_f32_16x16x32_bf16 v[204:207], a[108:111], v[88:91], v[204:207]
    v_sub_f32 v57, v25, v48
    v_fmac_f32 v53, v57, v57
    v_mfma_f32_16x16x32_bf16 v[208:211], a[96:99], v[92:95], v[208:211]
    buffer_load_dwordx4 v233, s[44:47], s37 offen offset:1024 lds
    v_sub_f32 v58, v26, v48
    v_mfma_f32_16x16x32_bf16 v[212:215], a[100:103], v[92:95], v[212:215]
    v_fmac_f32 v54, v58, v58
    v_sub_f32 v59, v27, v48
    v_mfma_f32_16x16x32_bf16 v[216:219], a[104:107], v[92:95], v[216:219]
    v_fmac_f32 v55, v59, v59
    v_sub_f32 v56, v28, v48
    v_mfma_f32_16x16x32_bf16 v[220:223], a[108:111], v[92:95], v[220:223]
    v_fmac_f32 v52, v56, v56
    s_waitcnt vmcnt(16) lgkmcnt(0)
    v_mfma_f32_16x16x32_bf16 v[96:99], a[112:115], v[64:67], v[96:99]
    ds_read_b128 v[80:83], v225 offset:57344
    v_sub_f32 v57, v29, v48
    v_mfma_f32_16x16x32_bf16 v[100:103], a[116:119], v[64:67], v[100:103]
    ds_read_b128 v[84:87], v225 offset:59392
    v_fmac_f32 v53, v57, v57
    v_mfma_f32_16x16x32_bf16 v[104:107], a[120:123], v[64:67], v[104:107]
    ds_read_b128 v[88:91], v225 offset:61440
    v_sub_f32 v58, v30, v48
    v_mfma_f32_16x16x32_bf16 v[108:111], a[124:127], v[64:67], v[108:111]
    ds_read_b128 v[92:95], v225 offset:63488
    v_fmac_f32 v54, v58, v58
    v_mfma_f32_16x16x32_bf16 v[112:115], a[112:115], v[68:71], v[112:115]
    ds_read_b64_tr_b16 a[128:129], v228 offset:8192
    v_sub_f32 v59, v31, v48
    v_mfma_f32_16x16x32_bf16 v[116:119], a[116:119], v[68:71], v[116:119]
    ds_read_b64_tr_b16 a[130:131], v228 offset:8704
    v_fmac_f32 v55, v59, v59
    v_mfma_f32_16x16x32_bf16 v[120:123], a[120:123], v[68:71], v[120:123]
    ds_read_b64_tr_b16 a[132:133], v229 offset:8192
    v_sub_f32 v56, v32, v48
    v_mfma_f32_16x16x32_bf16 v[124:127], a[124:127], v[68:71], v[124:127]
    ds_read_b64_tr_b16 a[134:135], v229 offset:8704
    v_fmac_f32 v52, v56, v56
    v_mfma_f32_16x16x32_bf16 v[128:131], a[112:115], v[72:75], v[128:131]
    s_add_u32 m0, s35, 0
    s_and_b32 s33, s86, 1023
    s_lshl_b32 s33, s33, 12
    buffer_load_dwordx4 v234, s[48:51], s33 offen lds
    v_mfma_f32_16x16x32_bf16 v[132:135], a[116:119], v[72:75], v[132:135]
    v_sub_f32 v57, v33, v48
    v_fmac_f32 v53, v57, v57
    v_sub_f32 v58, v34, v48
    v_mfma_f32_16x16x32_bf16 v[136:139], a[120:123], v[72:75], v[136:139]
    buffer_load_dwordx4 v235, s[48:51], s33 offen offset:1024 lds
    v_fmac_f32 v54, v58, v58
    v_mfma_f32_16x16x32_bf16 v[140:143], a[124:127], v[72:75], v[140:143]
    v_sub_f32 v59, v35, v48
    v_fmac_f32 v55, v59, v59
    v_mfma_f32_16x16x32_bf16 v[144:147], a[112:115], v[76:79], v[144:147]
    s_add_u32 m0, s35, 2048
    s_add_u32 s33, s33, 131072
    buffer_load_dwordx4 v234, s[48:51], s33 offen lds
    v_mfma_f32_16x16x32_bf16 v[148:151], a[116:119], v[76:79], v[148:151]
    v_sub_f32 v56, v36, v48
    v_fmac_f32 v52, v56, v56
    v_mfma_f32_16x16x32_bf16 v[152:155], a[120:123], v[76:79], v[152:155]
    buffer_load_dwordx4 v235, s[48:51], s33 offen offset:1024 lds
    v_sub_f32 v57, v37, v48
    v_mfma_f32_16x16x32_bf16 v[156:159], a[124:127], v[76:79], v[156:159]
    s_waitcnt vmcnt(30) lgkmcnt(0)
    s_barrier
    v_mfma_f32_16x16x32_bf16 v[160:163], a[112:115], v[80:83], v[160:163]
    ds_read_b128 v[64:67], v224 offset:0
    v_fmac_f32 v53, v57, v57
    v_mfma_f32_16x16x32_bf16 v[164:167], a[116:119], v[80:83], v[164:167]
    ds_read_b128 v[68:71], v224 offset:2048
    v_sub_f32 v58, v38, v48
    v_mfma_f32_16x16x32_bf16 v[168:171], a[120:123], v[80:83], v[168:171]
    ds_read_b128 v[72:75], v224 offset:4096
    v_fmac_f32 v54, v58, v58
    v_mfma_f32_16x16x32_bf16 v[172:175], a[124:127], v[80:83], v[172:175]
    ds_read_b128 v[76:79], v224 offset:6144
    v_sub_f32 v59, v39, v48
    v_mfma_f32_16x16x32_bf16 v[176:179], a[112:115], v[84:87], v[176:179]
    ds_read_b64_tr_b16 a[136:137], v230 offset:8192
    v_fmac_f32 v55, v59, v59
    v_mfma_f32_16x16x32_bf16 v[180:183], a[116:119], v[84:87], v[180:183]
    ds_read_b64_tr_b16 a[138:139], v230 offset:8704
    v_sub_f32 v56, v40, v48
    v_mfma_f32_16x16x32_bf16 v[184:187], a[120:123], v[84:87], v[184:187]
    ds_read_b64_tr_b16 a[140:141], v231 offset:8192
    v_fmac_f32 v52, v56, v56
    v_mfma_f32_16x16x32_bf16 v[188:191], a[124:127], v[84:87], v[188:191]
    ds_read_b64_tr_b16 a[142:143], v231 offset:8704
    v_sub_f32 v57, v41, v48
    v_mfma_f32_16x16x32_bf16 v[192:195], a[112:115], v[88:91], v[192:195]
    s_add_u32 m0, s34, 49152
    s_add_u32 s37, s87, 0
    buffer_load_dwordx4 v232, s[44:47], s37 offen lds
    v_mfma_f32_16x16x32_bf16 v[196:199], a[116:119], v[88:91], v[196:199]
    v_fmac_f32 v53, v57, v57
    v_sub_f32 v58, v42, v48
    v_mfma_f32_16x16x32_bf16 v[200:203], a[120:123], v[88:91], v[200:203]
    v_fmac_f32 v54, v58, v58
    v_sub_f32 v59, v43, v48
    v_mfma_f32_16x16x32_bf16 v[204:207], a[124:127], v[88:91], v[204:207]
    v_fmac_f32 v55, v59, v59
    v_sub_f32 v56, v44, v48
    v_mfma_f32_16x16x32_bf16 v[208:211], a[112:115], v[92:95], v[208:211]
    buffer_load_dwordx4 v233, s[44:47], s37 offen offset:1024 lds
    v_fmac_f32 v52, v56, v56
    v_mfma_f32_16x16x32_bf16 v[212:215], a[116:119], v[92:95], v[212:215]
    v_sub_f32 v57, v45, v48
    v_fmac_f32 v53, v57, v57
    v_mfma_f32_16x16x32_bf16 v[216:219], a[120:123], v[92:95], v[216:219]
    v_sub_f32 v58, v46, v48
    v_fmac_f32 v54, v58, v58
    v_mfma_f32_16x16x32_bf16 v[220:223], a[124:127], v[92:95], v[220:223]
    v_sub_f32 v59, v47, v48
    s_waitcnt lgkmcnt(0)
    v_mfma_f32_16x16x32_bf16 v[96:99], a[128:131], v[64:67], v[96:99]
    ds_read_b128 v[80:83], v224 offset:8192
    v_fmac_f32 v55, v59, v59
    v_mfma_f32_16x16x32_bf16 v[100:103], a[132:135], v[64:67], v[100:103]
    ds_read_b128 v[84:87], v224 offset:10240
    v_add_f32 v52, v52, v53
    v_mfma_f32_16x16x32_bf16 v[104:107], a[136:139], v[64:67], v[104:107]
    ds_read_b128 v[88:91], v224 offset:12288
    v_add_f32 v54, v54, v55
    v_mfma_f32_16x16x32_bf16 v[108:111], a[140:143], v[64:67], v[108:111]
    ds_read_b128 v[92:95], v224 offset:14336
    v_add_f32 v51, v52, v54
    v_mfma_f32_16x16x32_bf16 v[112:115], a[128:131], v[68:71], v[112:115]
    ds_read_b64_tr_b16 a[144:145], v228 offset:12288
    s_nop 1
    v_mfma_f32_16x16x32_bf16 v[116:119], a[132:135], v[68:71], v[116:119]
    ds_read_b64_tr_b16 a[146:147], v228 offset:12800
    v_add_f32_dpp v51, v51, v51 quad_perm:[1,0,3,2] row_mask:0xf bank_mask:0xf
    v_mfma_f32_16x16x32_bf16 v[120:123], a[136:139], v[68:71], v[120:123]
    ds_read_b64_tr_b16 a[148:149], v229 offset:12288
    s_nop 1
    v_mfma_f32_16x16x32_bf16 v[124:127], a[140:143], v[68:71], v[124:127]
    ds_read_b64_tr_b16 a[150:151], v229 offset:12800
    v_add_f32_dpp v51, v51, v51 quad_perm:[2,3,0,1] row_mask:0xf bank_mask:0xf
    v_mfma_f32_16x16x32_bf16 v[128:131], a[128:131], v[72:75], v[128:131]
    s_add_u32 m0, s35, 4096
    s_add_u32 s33, s33, 131072
    buffer_load_dwordx4 v234, s[48:51], s33 offen lds
    v_mfma_f32_16x16x32_bf16 v[132:135], a[132:135], v[72:75], v[132:135]
    s_nop 1
    v_add_f32_dpp v51, v51, v51 row_half_mirror row_mask:0xf bank_mask:0xf
    v_mfma_f32_16x16x32_bf16 v[136:139], a[136:139], v[72:75], v[136:139]
    buffer_load_dwordx4 v235, s[48:51], s33 offen offset:1024 lds
    s_nop 1
    v_mfma_f32_16x16x32_bf16 v[140:143], a[140:143], v[72:75], v[140:143]
    v_add_f32_dpp v51, v51, v51 row_mirror row_mask:0xf bank_mask:0xf
    s_nop 0
    v_mfma_f32_16x16x32_bf16 v[144:147], a[128:131], v[76:79], v[144:147]
    s_add_u32 m0, s35, 6144
    s_add_u32 s33, s33, 131072
    buffer_load_dwordx4 v234, s[48:51], s33 offen lds
    v_mfma_f32_16x16x32_bf16 v[148:151], a[132:135], v[76:79], v[148:151]
    v_mov_b32 v49, v51
    s_nop 1
    v_mfma_f32_16x16x32_bf16 v[152:155], a[136:139], v[76:79], v[152:155]
    buffer_load_dwordx4 v235, s[48:51], s33 offen offset:1024 lds
    v_permlane16_swap_b32 v51, v49
    v_mfma_f32_16x16x32_bf16 v[156:159], a[140:143], v[76:79], v[156:159]
    s_nop 0
    s_waitcnt lgkmcnt(0)
    v_mfma_f32_16x16x32_bf16 v[160:163], a[128:131], v[80:83], v[160:163]
    ds_read_b128 v[64:67], v225 offset:0
    v_add_f32 v51, v51, v49
    v_mfma_f32_16x16x32_bf16 v[164:167], a[132:135], v[80:83], v[164:167]
    ds_read_b128 v[68:71], v225 offset:2048
    v_mul_f32 v51, 0x3a800000, v51
    v_mfma_f32_16x16x32_bf16 v[168:171], a[136:139], v[80:83], v[168:171]
    ds_read_b128 v[72:75], v225 offset:4096
    v_cvt_pk_bf16_f32 v50, v48, v51
    v_mfma_f32_16x16x32_bf16 v[172:175], a[140:143], v[80:83], v[172:175]
    ds_read_b128 v[76:79], v225 offset:6144
    v_and_b32 v51, 0xffff0000, v50
    v_mfma_f32_16x16x32_bf16 v[176:179], a[128:131], v[84:87], v[176:179]
    ds_read_b64_tr_b16 a[152:153], v230 offset:12288
    v_lshlrev_b32 v50, 16, v50
    v_mfma_f32_16x16x32_bf16 v[180:183], a[132:135], v[84:87], v[180:183]
    ds_read_b64_tr_b16 a[154:155], v230 offset:12800
    v_add_f32 v51, 0x3727c5ac, v51
    v_mfma_f32_16x16x32_bf16 v[184:187], a[136:139], v[84:87], v[184:187]
    ds_read_b64_tr_b16 a[156:157], v231 offset:12288
    v_cvt_pk_bf16_f32 v51, v51, v51
    v_mfma_f32_16x16x32_bf16 v[188:191], a[140:143], v[84:87], v[188:191]
    ds_read_b64_tr_b16 a[158:159], v231 offset:12800
    v_lshlrev_b32 v51, 16, v51
    v_mfma_f32_16x16x32_bf16 v[192:195], a[128:131], v[88:91], v[192:195]
    s_add_u32 m0, s34, 57344
    s_add_u32 s37, s87, 65536
    buffer_load_dwordx4 v232, s[44:47], s37 offen lds
    v_mfma_f32_16x16x32_bf16 v[196:199], a[132:135], v[88:91], v[196:199]
    v_sqrt_f32 v51, v51
    v_mfma_f32_16x16x32_bf16 v[200:203], a[136:139], v[88:91], v[200:203]
    s_nop 0
    v_cvt_pk_bf16_f32 v51, v51, v51
    v_mfma_f32_16x16x32_bf16 v[204:207], a[140:143], v[88:91], v[204:207]
    v_lshlrev_b32 v51, 16, v51
    v_rcp_f32 v51, v51
    v_mfma_f32_16x16x32_bf16 v[208:211], a[128:131], v[92:95], v[208:211]
    buffer_load_dwordx4 v233, s[44:47], s37 offen offset:1024 lds
    v_mfma_f32_16x16x32_bf16 v[212:215], a[132:135], v[92:95], v[212:215]
    s_nop 0
    v_mul_f32 v51, 0x3e0293ee, v51
    v_mfma_f32_16x16x32_bf16 v[216:219], a[136:139], v[92:95], v[216:219]
    v_sub_f32 v16, v16, v50
    v_sub_f32 v17, v17, v50
    v_mfma_f32_16x16x32_bf16 v[220:223], a[140:143], v[92:95], v[220:223]
    v_cvt_pk_bf16_f32 v17, v16, v17
    s_waitcnt vmcnt(15) lgkmcnt(0)
    v_mfma_f32_16x16x32_bf16 v[96:99], a[144:147], v[64:67], v[96:99]
    ds_read_b128 v[80:83], v225 offset:8192
    v_lshlrev_b32 v16, 16, v17
    v_mfma_f32_16x16x32_bf16 v[100:103], a[148:151], v[64:67], v[100:103]
    ds_read_b128 v[84:87], v225 offset:10240
    v_and_b32 v17, 0xffff0000, v17
    v_mfma_f32_16x16x32_bf16 v[104:107], a[152:155], v[64:67], v[104:107]
    ds_read_b128 v[88:91], v225 offset:12288
    v_mul_f32 v16, v16, v51
    v_mfma_f32_16x16x32_bf16 v[108:111], a[156:159], v[64:67], v[108:111]
    ds_read_b128 v[92:95], v225 offset:14336
    v_mul_f32 v17, v17, v51
    v_mfma_f32_16x16x32_bf16 v[112:115], a[144:147], v[68:71], v[112:115]
    ds_read_b64_tr_b16 a[160:161], v228 offset:16384
    v_cvt_pk_bf16_f32 v0, v16, v17
    v_mfma_f32_16x16x32_bf16 v[116:119], a[148:151], v[68:71], v[116:119]
    ds_read_b64_tr_b16 a[162:163], v228 offset:16896
    v_sub_f32 v18, v18, v50
    v_mfma_f32_16x16x32_bf16 v[120:123], a[152:155], v[68:71], v[120:123]
    ds_read_b64_tr_b16 a[164:165], v229 offset:16384
    v_sub_f32 v19, v19, v50
    v_mfma_f32_16x16x32_bf16 v[124:127], a[156:159], v[68:71], v[124:127]
    ds_read_b64_tr_b16 a[166:167], v229 offset:16896
    v_cvt_pk_bf16_f32 v19, v18, v19
    v_mfma_f32_16x16x32_bf16 v[128:131], a[144:147], v[72:75], v[128:131]
    s_add_u32 m0, s35, 8192
    s_and_b32 s33, s87, 1023
    s_lshl_b32 s33, s33, 12
    buffer_load_dwordx4 v234, s[48:51], s33 offen lds
    v_mfma_f32_16x16x32_bf16 v[132:135], a[148:151], v[72:75], v[132:135]
    v_lshlrev_b32 v18, 16, v19
    v_and_b32 v19, 0xffff0000, v19
    v_mfma_f32_16x16x32_bf16 v[136:139], a[152:155], v[72:75], v[136:139]
    buffer_load_dwordx4 v235, s[48:51], s33 offen offset:1024 lds
    v_mul_f32 v18, v18, v51
    v_mul_f32 v19, v19, v51
    v_mfma_f32_16x16x32_bf16 v[140:143], a[156:159], v[72:75], v[140:143]
    v_cvt_pk_bf16_f32 v1, v18, v19
    v_sub_f32 v20, v20, v50
    v_mfma_f32_16x16x32_bf16 v[144:147], a[144:147], v[76:79], v[144:147]
    s_add_u32 m0, s35, 10240
    s_add_u32 s33, s33, 131072
    buffer_load_dwordx4 v234, s[48:51], s33 offen lds
    v_mfma_f32_16x16x32_bf16 v[148:151], a[148:151], v[76:79], v[148:151]
    v_sub_f32 v21, v21, v50
    v_cvt_pk_bf16_f32 v21, v20, v21
    v_mfma_f32_16x16x32_bf16 v[152:155], a[152:155], v[76:79], v[152:155]
    buffer_load_dwordx4 v235, s[48:51], s33 offen offset:1024 lds
    v_lshlrev_b32 v20, 16, v21
    v_mfma_f32_16x16x32_bf16 v[156:159], a[156:159], v[76:79], v[156:159]
    s_waitcnt vmcnt(30) lgkmcnt(0)
    s_barrier
    v_mfma_f32_16x16x32_bf16 v[160:163], a[144:147], v[80:83], v[160:163]
    ds_read_b128 v[64:67], v224 offset:16384
    v_and_b32 v21, 0xffff0000, v21
    v_mfma_f32_16x16x32_bf16 v[164:167], a[148:151], v[80:83], v[164:167]
    ds_read_b128 v[68:71], v224 offset:18432
    v_mul_f32 v20, v20, v51
    v_mfma_f32_16x16x32_bf16 v[168:171], a[152:155], v[80:83], v[168:171]
    ds_read_b128 v[72:75], v224 offset:20480
    v_mul_f32 v21, v21, v51
    v_mfma_f32_16x16x32_bf16 v[172:175], a[156:159], v[80:83], v[172:175]
    ds_read_b128 v[76:79], v224 offset:22528
    v_cvt_pk_bf16_f32 v2, v20, v21
    v_mfma_f32_16x16x32_bf16 v[176:179], a[144:147], v[84:87], v[176:179]
    ds_read_b64_tr_b16 a[168:169], v230 offset:16384
    v_sub_f32 v22, v22, v50
    v_mfma_f32_16x16x32_bf16 v[180:183], a[148:151], v[84:87], v[180:183]
    ds_read_b64_tr_b16 a[170:171], v230 offset:16896
    v_sub_f32 v23, v23, v50
    v_mfma_f32_16x16x32_bf16 v[184:187], a[152:155], v[84:87], v[184:187]
    ds_read_b64_tr_b16 a[172:173], v231 offset:16384
    v_cvt_pk_bf16_f32 v23, v22, v23
    v_mfma_f32_16x16x32_bf16 v[188:191], a[156:159], v[84:87], v[188:191]
    ds_read_b64_tr_b16 a[174:175], v231 offset:16896
    v_lshlrev_b32 v22, 16, v23
    v_mfma_f32_16x16x32_bf16 v[192:195], a[144:147], v[88:91], v[192:195]
    s_add_u32 m0, s34, 0
    s_add_u32 s37, s80, 131072
    buffer_load_dwordx4 v232, s[44:47], s37 offen lds
    v_mfma_f32_16x16x32_bf16 v[196:199], a[148:151], v[88:91], v[196:199]
    v_and_b32 v23, 0xffff0000, v23
    v_mul_f32 v22, v22, v51
    v_mfma_f32_16x16x32_bf16 v[200:203], a[152:155], v[88:91], v[200:203]
    v_mul_f32 v23, v23, v51
    v_cvt_pk_bf16_f32 v3, v22, v23
    v_mfma_f32_16x16x32_bf16 v[204:207], a[156:159], v[88:91], v[204:207]
    v_sub_f32 v24, v24, v50
    v_sub_f32 v25, v25, v50
    v_mfma_f32_16x16x32_bf16 v[208:211], a[144:147], v[92:95], v[208:211]
    buffer_load_dwordx4 v233, s[44:47], s37 offen offset:1024 lds
    v_cvt_pk_bf16_f32 v25, v24, v25
    v_mfma_f32_16x16x32_bf16 v[212:215], a[148:151], v[92:95], v[212:215]
    v_lshlrev_b32 v24, 16, v25
    v_and_b32 v25, 0xffff0000, v25
    v_mfma_f32_16x16x32_bf16 v[216:219], a[152:155], v[92:95], v[216:219]
    v_mul_f32 v24, v24, v51
    v_mul_f32 v25, v25, v51
    v_mfma_f32_16x16x32_bf16 v[220:223], a[156:159], v[92:95], v[220:223]
    v_cvt_pk_bf16_f32 v4, v24, v25
    s_waitcnt lgkmcnt(0)
    v_mfma_f32_16x16x32_bf16 v[96:99], a[160:163], v[64:67], v[96:99]
    ds_read_b128 v[80:83], v224 offset:24576
    v_sub_f32 v26, v26, v50
    v_mfma_f32_16x16x32_bf16 v[100:103], a[164:167], v[64:67], v[100:103]
    ds_read_b128 v[84:87], v224 offset:26624
    v_sub_f32 v27, v27, v50
    v_mfma_f32_16x16x32_bf16 v[104:107], a[168:171], v[64:67], v[104:107]
    ds_read_b128 v[88:91], v224 offset:28672
    v_cvt_pk_bf16_f32 v27, v26, v27
    v_mfma_f32_16x16x32_bf16 v[108:111], a[172:175], v[64:67], v[108:111]
    ds_read_b128 v[92:95], v224 offset:30720
    v_lshlrev_b32 v26, 16, v27
    v_mfma_f32_16x16x32_bf16 v[112:115], a[160:163], v[68:71], v[112:115]
    ds_read_b64_tr_b16 a[176:177], v228 offset:20480
    v_and_b32 v27, 0xffff0000, v27
    v_mfma_f32_16x16x32_bf16 v[116:119], a[164:167], v[68:71], v[116:119]
    ds_read_b64_tr_b16 a[178:179], v228 offset:20992
    v_mul_f32 v26, v26, v51
    v_mfma_f32_16x16x32_bf16 v[120:123], a[168:171], v[68:71], v[120:123]
    ds_read_b64_tr_b16 a[180:181], v229 offset:20480
    v_mul_f32 v27, v27, v51
    v_mfma_f32_16x16x32_bf16 v[124:127], a[172:175], v[68:71], v[124:127]
    ds_read_b64_tr_b16 a[182:183], v229 offset:20992
    v_cvt_pk_bf16_f32 v5, v26, v27
    v_mfma_f32_16x16x32_bf16 v[128:131], a[160:163], v[72:75], v[128:131]
    s_add_u32 m0, s35, 12288
    s_add_u32 s33, s33, 131072
    buffer_load_dwordx4 v234, s[48:51], s33 offen lds
    v_mfma_f32_16x16x32_bf16 v[132:135], a[164:167], v[72:75], v[132:135]
    v_sub_f32 v28, v28, v50
    v_sub_f32 v29, v29, v50
    v_mfma_f32_16x16x32_bf16 v[136:139], a[168:171], v[72:75], v[136:139]
    buffer_load_dwordx4 v235, s[48:51], s33 offen offset:1024 lds
    v_cvt_pk_bf16_f32 v29, v28, v29
    v_mfma_f32_16x16x32_bf16 v[140:143], a[172:175], v[72:75], v[140:143]
    v_lshlrev_b32 v28, 16, v29
    v_and_b32 v29, 0xffff0000, v29
    v_mfma_f32_16x16x32_bf16 v[144:147], a[160:163], v[76:79], v[144:147]
    s_add_u32 m0, s35, 14336
    s_add_u32 s33, s33, 131072
    buffer_load_dwordx4 v234, s[48:51], s33 offen lds
    v_mfma_f32_16x16x32_bf16 v[148:151], a[164:167], v[76:79], v[148:151]
    v_mul_f32 v28, v28, v51
    v_mul_f32 v29, v29, v51
    v_mfma_f32_16x16x32_bf16 v[152:155], a[168:171], v[76:79], v[152:155]
    buffer_load_dwordx4 v235, s[48:51], s33 offen offset:1024 lds
    v_cvt_pk_bf16_f32 v6, v28, v29
    v_mfma_f32_16x16x32_bf16 v[156:159], a[172:175], v[76:79], v[156:159]
    v_sub_f32 v30, v30, v50
    s_waitcnt lgkmcnt(0)
    v_mfma_f32_16x16x32_bf16 v[160:163], a[160:163], v[80:83], v[160:163]
    ds_read_b128 v[64:67], v225 offset:16384
    v_sub_f32 v31, v31, v50
    v_mfma_f32_16x16x32_bf16 v[164:167], a[164:167], v[80:83], v[164:167]
    ds_read_b128 v[68:71], v225 offset:18432
    v_cvt_pk_bf16_f32 v31, v30, v31
    v_mfma_f32_16x16x32_bf16 v[168:171], a[168:171], v[80:83], v[168:171]
    ds_read_b128 v[72:75], v225 offset:20480
    v_lshlrev_b32 v30, 16, v31
    v_mfma_f32_16x16x32_bf16 v[172:175], a[172:175], v[80:83], v[172:175]
    ds_read_b128 v[76:79], v225 offset:22528
    v_and_b32 v31, 0xffff0000, v31
    v_mfma_f32_16x16x32_bf16 v[176:179], a[160:163], v[84:87], v[176:179]
    ds_read_b64_tr_b16 a[184:185], v230 offset:20480
    v_mul_f32 v30, v30, v51
    v_mfma_f32_16x16x32_bf16 v[180:183], a[164:167], v[84:87], v[180:183]
    ds_read_b64_tr_b16 a[186:187], v230 offset:20992
    v_mul_f32 v31, v31, v51
    v_mfma_f32_16x16x32_bf16 v[184:187], a[168:171], v[84:87], v[184:187]
    ds_read_b64_tr_b16 a[188:189], v231 offset:20480
    v_cvt_pk_bf16_f32 v7, v30, v31
    v_mfma_f32_16x16x32_bf16 v[188:191], a[172:175], v[84:87], v[188:191]
    ds_read_b64_tr_b16 a[190:191], v231 offset:20992
    v_sub_f32 v32, v32, v50
    v_mfma_f32_16x16x32_bf16 v[192:195], a[160:163], v[88:91], v[192:195]
    s_add_u32 m0, s34, 8192
    s_add_u32 s37, s81, 131072
    buffer_load_dwordx4 v232, s[44:47], s37 offen lds
    v_mfma_f32_16x16x32_bf16 v[196:199], a[164:167], v[88:91], v[196:199]
    v_sub_f32 v33, v33, v50
    v_cvt_pk_bf16_f32 v33, v32, v33
    v_mfma_f32_16x16x32_bf16 v[200:203], a[168:171], v[88:91], v[200:203]
    v_lshlrev_b32 v32, 16, v33
    v_and_b32 v33, 0xffff0000, v33
    v_mfma_f32_16x16x32_bf16 v[204:207], a[172:175], v[88:91], v[204:207]
    v_mul_f32 v32, v32, v51
    v_mul_f32 v33, v33, v51
    v_mfma_f32_16x16x32_bf16 v[208:211], a[160:163], v[92:95], v[208:211]
    buffer_load_dwordx4 v233, s[44:47], s37 offen offset:1024 lds
    v_cvt_pk_bf16_f32 v8, v32, v33
    v_mfma_f32_16x16x32_bf16 v[212:215], a[164:167], v[92:95], v[212:215]
    v_sub_f32 v34, v34, v50
    v_sub_f32 v35, v35, v50
    v_mfma_f32_16x16x32_bf16 v[216:219], a[168:171], v[92:95], v[216:219]
    v_cvt_pk_bf16_f32 v35, v34, v35
    v_lshlrev_b32 v34, 16, v35
    v_mfma_f32_16x16x32_bf16 v[220:223], a[172:175], v[92:95], v[220:223]
    v_and_b32 v35, 0xffff0000, v35
    s_waitcnt vmcnt(14) lgkmcnt(0)
    v_mfma_f32_16x16x32_bf16 v[96:99], a[176:179], v[64:67], v[96:99]
    ds_read_b128 v[80:83], v225 offset:24576
    v_mul_f32 v34, v34, v51
    v_mfma_f32_16x16x32_bf16 v[100:103], a[180:183], v[64:67], v[100:103]
    ds_read_b128 v[84:87], v225 offset:26624
    v_mul_f32 v35, v35, v51
    v_mfma_f32_16x16x32_bf16 v[104:107], a[184:187], v[64:67], v[104:107]
    ds_read_b128 v[88:91], v225 offset:28672
    v_cvt_pk_bf16_f32 v9, v34, v35
    v_mfma_f32_16x16x32_bf16 v[108:111], a[188:191], v[64:67], v[108:111]
    ds_read_b128 v[92:95], v225 offset:30720
    v_sub_f32 v36, v36, v50
    v_mfma_f32_16x16x32_bf16 v[112:115], a[176:179], v[68:71], v[112:115]
    ds_read_b64_tr_b16 a[192:193], v228 offset:0
    v_sub_f32 v37, v37, v50
    v_mfma_f32_16x16x32_bf16 v[116:119], a[180:183], v[68:71], v[116:119]
    ds_read_b64_tr_b16 a[194:195], v228 offset:512
    v_cvt_pk_bf16_f32 v37, v36, v37
    v_mfma_f32_16x16x32_bf16 v[120:123], a[184:187], v[68:71], v[120:123]
    ds_read_b64_tr_b16 a[196:197], v229 offset:0
    v_lshlrev_b32 v36, 16, v37
    v_mfma_f32_16x16x32_bf16 v[124:127], a[188:191], v[68:71], v[124:127]
    ds_read_b64_tr_b16 a[198:199], v229 offset:512
    v_and_b32 v37, 0xffff0000, v37
    v_mfma_f32_16x16x32_bf16 v[128:131], a[176:179], v[72:75], v[128:131]
    v_mul_f32 v36, v36, v51
    v_mul_f32 v37, v37, v51
    v_mfma_f32_16x16x32_bf16 v[132:135], a[180:183], v[72:75], v[132:135]
    v_cvt_pk_bf16_f32 v10, v36, v37
    v_sub_f32 v38, v38, v50
    v_mfma_f32_16x16x32_bf16 v[136:139], a[184:187], v[72:75], v[136:139]
    v_sub_f32 v39, v39, v50
    v_cvt_pk_bf16_f32 v39, v38, v39
    v_lshlrev_b32 v38, 16, v39
    v_mfma_f32_16x16x32_bf16 v[140:143], a[188:191], v[72:75], v[140:143]
    v_and_b32 v39, 0xffff0000, v39
    v_mul_f32 v38, v38, v51
    v_mfma_f32_16x16x32_bf16 v[144:147], a[176:179], v[76:79], v[144:147]
    v_mul_f32 v39, v39, v51
    v_cvt_pk_bf16_f32 v11, v38, v39
    v_mfma_f32_16x16x32_bf16 v[148:151], a[180:183], v[76:79], v[148:151]
    v_sub_f32 v40, v40, v50
    v_sub_f32 v41, v41, v50
    v_mfma_f32_16x16x32_bf16 v[152:155], a[184:187], v[76:79], v[152:155]
    v_cvt_pk_bf16_f32 v41, v40, v41
    v_lshlrev_b32 v40, 16, v41
    v_mfma_f32_16x16x32_bf16 v[156:159], a[188:191], v[76:79], v[156:159]
    s_waitcnt vmcnt(24) lgkmcnt(0)
    s_barrier
    v_mfma_f32_16x16x32_bf16 v[160:163], a[176:179], v[80:83], v[160:163]
    ds_read_b128 v[64:67], v224 offset:32768
    v_and_b32 v41, 0xffff0000, v41
    v_mfma_f32_16x16x32_bf16 v[164:167], a[180:183], v[80:83], v[164:167]
    ds_read_b128 v[68:71], v224 offset:34816
    v_mul_f32 v40, v40, v51
    v_mfma_f32_16x16x32_bf16 v[168:171], a[184:187], v[80:83], v[168:171]
    ds_read_b128 v[72:75], v224 offset:36864
    v_mul_f32 v41, v41, v51
    v_mfma_f32_16x16x32_bf16 v[172:175], a[188:191], v[80:83], v[172:175]
    ds_read_b128 v[76:79], v224 offset:38912
    v_cvt_pk_bf16_f32 v12, v40, v41
    v_mfma_f32_16x16x32_bf16 v[176:179], a[176:179], v[84:87], v[176:179]
    ds_read_b64_tr_b16 a[200:201], v230 offset:0
    v_sub_f32 v42, v42, v50
    v_mfma_f32_16x16x32_bf16 v[180:183], a[180:183], v[84:87], v[180:183]
    ds_read_b64_tr_b16 a[202:203], v230 offset:512
    v_sub_f32 v43, v43, v50
    v_mfma_f32_16x16x32_bf16 v[184:187], a[184:187], v[84:87], v[184:187]
    ds_read_b64_tr_b16 a[204:205], v231 offset:0
    v_cvt_pk_bf16_f32 v43, v42, v43
    v_mfma_f32_16x16x32_bf16 v[188:191], a[188:191], v[84:87], v[188:191]
    ds_read_b64_tr_b16 a[206:207], v231 offset:512
    v_lshlrev_b32 v42, 16, v43
    v_mfma_f32_16x16x32_bf16 v[192:195], a[176:179], v[88:91], v[192:195]
    s_add_u32 m0, s34, 16384
    s_add_u32 s37, s82, 131072
    buffer_load_dwordx4 v232, s[44:47], s37 offen lds
    v_mfma_f32_16x16x32_bf16 v[196:199], a[180:183], v[88:91], v[196:199]
    v_and_b32 v43, 0xffff0000, v43
    v_mul_f32 v42, v42, v51
    v_mfma_f32_16x16x32_bf16 v[200:203], a[184:187], v[88:91], v[200:203]
    v_mul_f32 v43, v43, v51
    v_cvt_pk_bf16_f32 v13, v42, v43
    v_mfma_f32_16x16x32_bf16 v[204:207], a[188:191], v[88:91], v[204:207]
    v_sub_f32 v44, v44, v50
    v_sub_f32 v45, v45, v50
    v_mfma_f32_16x16x32_bf16 v[208:211], a[176:179], v[92:95], v[208:211]
    buffer_load_dwordx4 v233, s[44:47], s37 offen offset:1024 lds
    v_cvt_pk_bf16_f32 v45, v44, v45
    v_mfma_f32_16x16x32_bf16 v[212:215], a[180:183], v[92:95], v[212:215]
    v_lshlrev_b32 v44, 16, v45
    v_and_b32 v45, 0xffff0000, v45
    v_mfma_f32_16x16x32_bf16 v[216:219], a[184:187], v[92:95], v[216:219]
    v_mul_f32 v44, v44, v51
    v_mul_f32 v45, v45, v51
    v_mfma_f32_16x16x32_bf16 v[220:223], a[188:191], v[92:95], v[220:223]
    v_cvt_pk_bf16_f32 v14, v44, v45
    s_waitcnt lgkmcnt(0)
    v_mfma_f32_16x16x32_bf16 v[96:99], a[192:195], v[64:67], v[96:99]
    ds_read_b128 v[80:83], v224 offset:40960
    v_sub_f32 v46, v46, v50
    v_mfma_f32_16x16x32_bf16 v[100:103], a[196:199], v[64:67], v[100:103]
    ds_read_b128 v[84:87], v224 offset:43008
    v_sub_f32 v47, v47, v50
    v_mfma_f32_16x16x32_bf16 v[104:107], a[200:203], v[64:67], v[104:107]
    ds_read_b128 v[88:91], v224 offset:45056
    v_cvt_pk_bf16_f32 v47, v46, v47
    v_mfma_f32_16x16x32_bf16 v[108:111], a[204:207], v[64:67], v[108:111]
    ds_read_b128 v[92:95], v224 offset:47104
    v_lshlrev_b32 v46, 16, v47
    v_mfma_f32_16x16x32_bf16 v[112:115], a[192:195], v[68:71], v[112:115]
    ds_read_b64_tr_b16 a[208:209], v228 offset:4096
    v_and_b32 v47, 0xffff0000, v47
    v_mfma_f32_16x16x32_bf16 v[116:119], a[196:199], v[68:71], v[116:119]
    ds_read_b64_tr_b16 a[210:211], v228 offset:4608
    v_mul_f32 v46, v46, v51
    v_mfma_f32_16x16x32_bf16 v[120:123], a[200:203], v[68:71], v[120:123]
    ds_read_b64_tr_b16 a[212:213], v229 offset:4096
    v_mul_f32 v47, v47, v51
    v_mfma_f32_16x16x32_bf16 v[124:127], a[204:207], v[68:71], v[124:127]
    ds_read_b64_tr_b16 a[214:215], v229 offset:4608
    v_cvt_pk_bf16_f32 v15, v46, v47
    v_mfma_f32_16x16x32_bf16 v[128:131], a[192:195], v[72:75], v[128:131]
    v_mfma_f32_16x16x32_bf16 v[132:135], a[196:199], v[72:75], v[132:135]
    ds_write_b128 v237, v[0:3] offset:0
    v_mfma_f32_16x16x32_bf16 v[136:139], a[200:203], v[72:75], v[136:139]
    ds_write_b128 v237, v[4:7] offset:4096
    v_mfma_f32_16x16x32_bf16 v[140:143], a[204:207], v[72:75], v[140:143]
    ds_write_b128 v237, v[8:11] offset:24576
    v_mfma_f32_16x16x32_bf16 v[144:147], a[192:195], v[76:79], v[144:147]
    ds_write_b128 v237, v[12:15] offset:28672
    v_mfma_f32_16x16x32_bf16 v[148:151], a[196:199], v[76:79], v[148:151]
    v_mfma_f32_16x16x32_bf16 v[152:155], a[200:203], v[76:79], v[152:155]
    v_mfma_f32_16x16x32_bf16 v[156:159], a[204:207], v[76:79], v[156:159]
    s_waitcnt lgkmcnt(0)
    v_mfma_f32_16x16x32_bf16 v[160:163], a[192:195], v[80:83], v[160:163]
    ds_read_b128 v[64:67], v225 offset:32768
    v_mfma_f32_16x16x32_bf16 v[164:167], a[196:199], v[80:83], v[164:167]
    ds_read_b128 v[68:71], v225 offset:34816
    v_mfma_f32_16x16x32_bf16 v[168:171], a[200:203], v[80:83], v[168:171]
    ds_read_b128 v[72:75], v225 offset:36864
    v_mfma_f32_16x16x32_bf16 v[172:175], a[204:207], v[80:83], v[172:175]
    ds_read_b128 v[76:79], v225 offset:38912
    v_mfma_f32_16x16x32_bf16 v[176:179], a[192:195], v[84:87], v[176:179]
    ds_read_b64_tr_b16 a[216:217], v230 offset:4096
    v_mfma_f32_16x16x32_bf16 v[180:183], a[196:199], v[84:87], v[180:183]
    ds_read_b64_tr_b16 a[218:219], v230 offset:4608
    v_mfma_f32_16x16x32_bf16 v[184:187], a[200:203], v[84:87], v[184:187]
    ds_read_b64_tr_b16 a[220:221], v231 offset:4096
    v_mfma_f32_16x16x32_bf16 v[188:191], a[204:207], v[84:87], v[188:191]
    ds_read_b64_tr_b16 a[222:223], v231 offset:4608
    v_mfma_f32_16x16x32_bf16 v[192:195], a[192:195], v[88:91], v[192:195]
    s_add_u32 m0, s34, 24576
    s_add_u32 s37, s83, 131072
    buffer_load_dwordx4 v232, s[44:47], s37 offen lds
    v_mfma_f32_16x16x32_bf16 v[196:199], a[196:199], v[88:91], v[196:199]
    v_mfma_f32_16x16x32_bf16 v[200:203], a[200:203], v[88:91], v[200:203]
    buffer_load_dwordx4 v233, s[44:47], s37 offen offset:1024 lds
    v_mfma_f32_16x16x32_bf16 v[204:207], a[204:207], v[88:91], v[204:207]
    v_mfma_f32_16x16x32_bf16 v[208:211], a[192:195], v[92:95], v[208:211]
    v_mfma_f32_16x16x32_bf16 v[212:215], a[196:199], v[92:95], v[212:215]
    buffer_load_dword v254, off, s[88:91], s97 sc1
    v_mfma_f32_16x16x32_bf16 v[216:219], a[200:203], v[92:95], v[216:219]
    v_mfma_f32_16x16x32_bf16 v[220:223], a[204:207], v[92:95], v[220:223]
    s_waitcnt vmcnt(7) lgkmcnt(0)
    v_mfma_f32_16x16x32_bf16 v[96:99], a[208:211], v[64:67], v[96:99]
    ds_read_b128 v[80:83], v225 offset:40960
    v_mfma_f32_16x16x32_bf16 v[100:103], a[212:215], v[64:67], v[100:103]
    ds_read_b128 v[84:87], v225 offset:43008
    s_mul_i32 s38, s2, 100
    v_mfma_f32_16x16x32_bf16 v[104:107], a[216:219], v[64:67], v[104:107]
    ds_read_b128 v[88:91], v225 offset:45056
    v_mfma_f32_16x16x32_bf16 v[108:111], a[220:223], v[64:67], v[108:111]
    ds_read_b128 v[92:95], v225 offset:47104
    v_mfma_f32_16x16x32_bf16 v[112:115], a[208:211], v[68:71], v[112:115]
    ds_read_b64_tr_b16 a[224:225], v228 offset:8192
    v_lshl_add_u32 v60, v253, 2, s38
    v_mfma_f32_16x16x32_bf16 v[116:119], a[212:215], v[68:71], v[116:119]
    ds_read_b64_tr_b16 a[226:227], v228 offset:8704
    v_mfma_f32_16x16x32_bf16 v[120:123], a[216:219], v[68:71], v[120:123]
    ds_read_b64_tr_b16 a[228:229], v229 offset:8192
    v_mfma_f32_16x16x32_bf16 v[124:127], a[220:223], v[68:71], v[124:127]
    ds_read_b64_tr_b16 a[230:231], v229 offset:8704
    v_cmp_gt_u32 vcc, 25, v253
    v_mfma_f32_16x16x32_bf16 v[128:131], a[208:211], v[72:75], v[128:131]
    v_mov_b32 v61, 0
    v_mfma_f32_16x16x32_bf16 v[132:135], a[212:215], v[72:75], v[132:135]
    v_mfma_f32_16x16x32_bf16 v[136:139], a[216:219], v[72:75], v[136:139]
    v_mov_b32 v62, 0x7ffffff0
    v_mfma_f32_16x16x32_bf16 v[140:143], a[220:223], v[72:75], v[140:143]
    v_cndmask_b32 v60, v62, v60, vcc
    v_mfma_f32_16x16x32_bf16 v[144:147], a[208:211], v[76:79], v[144:147]
    v_mfma_f32_16x16x32_bf16 v[148:151], a[212:215], v[76:79], v[148:151]
    buffer_store_dword v61, v60, s[56:59], 0 offen sc1
    v_mfma_f32_16x16x32_bf16 v[152:155], a[216:219], v[76:79], v[152:155]
    v_mfma_f32_16x16x32_bf16 v[156:159], a[220:223], v[76:79], v[156:159]
    s_waitcnt vmcnt(18) lgkmcnt(0)
    s_barrier
    v_mfma_f32_16x16x32_bf16 v[160:163], a[208:211], v[80:83], v[160:163]
    ds_read_b128 v[64:67], v224 offset:49152
    v_mfma_f32_16x16x32_bf16 v[164:167], a[212:215], v[80:83], v[164:167]
    ds_read_b128 v[68:71], v224 offset:51200
    v_mfma_f32_16x16x32_bf16 v[168:171], a[216:219], v[80:83], v[168:171]
    ds_read_b128 v[72:75], v224 offset:53248
    v_mfma_f32_16x16x32_bf16 v[172:175], a[220:223], v[80:83], v[172:175]
    ds_read_b128 v[76:79], v224 offset:55296
    v_mfma_f32_16x16x32_bf16 v[176:179], a[208:211], v[84:87], v[176:179]
    ds_read_b64_tr_b16 a[232:233], v230 offset:8192
    v_mfma_f32_16x16x32_bf16 v[180:183], a[212:215], v[84:87], v[180:183]
    ds_read_b64_tr_b16 a[234:235], v230 offset:8704
    v_mfma_f32_16x16x32_bf16 v[184:187], a[216:219], v[84:87], v[184:187]
    ds_read_b64_tr_b16 a[236:237], v231 offset:8192
    v_mfma_f32_16x16x32_bf16 v[188:191], a[220:223], v[84:87], v[188:191]
    ds_read_b64_tr_b16 a[238:239], v231 offset:8704
    v_mfma_f32_16x16x32_bf16 v[192:195], a[208:211], v[88:91], v[192:195]
    v_lshlrev_b32 v237, 4, v253
    v_add_u32 v237, 81920, v237
    ds_read_b128 v[16:19], v237 offset:0
    ds_read_b128 v[20:23], v237 offset:4096
    ds_read_b128 v[24:27], v237 offset:24576
    ds_read_b128 v[28:31], v237 offset:28672
    s_add_u32 m0, s34, 32768
    s_add_u32 s37, s84, 131072
    buffer_load_dwordx4 v232, s[44:47], s37 offen lds
    v_mfma_f32_16x16x32_bf16 v[196:199], a[212:215], v[88:91], v[196:199]
    v_mfma_f32_16x16x32_bf16 v[200:203], a[216:219], v[88:91], v[200:203]
    v_mfma_f32_16x16x32_bf16 v[204:207], a[220:223], v[88:91], v[204:207]
    v_mfma_f32_16x16x32_bf16 v[208:211], a[208:211], v[92:95], v[208:211]
    buffer_load_dwordx4 v233, s[44:47], s37 offen offset:1024 lds
    v_mfma_f32_16x16x32_bf16 v[212:215], a[212:215], v[92:95], v[212:215]
    v_mfma_f32_16x16x32_bf16 v[216:219], a[216:219], v[92:95], v[216:219]
    v_mfma_f32_16x16x32_bf16 v[220:223], a[220:223], v[92:95], v[220:223]
    s_waitcnt lgkmcnt(0)
    v_mfma_f32_16x16x32_bf16 v[96:99], a[224:227], v[64:67], v[96:99]
    ds_read_b128 v[80:83], v224 offset:57344
    v_mfma_f32_16x16x32_bf16 v[100:103], a[228:231], v[64:67], v[100:103]
    ds_read_b128 v[84:87], v224 offset:59392
    v_mfma_f32_16x16x32_bf16 v[104:107], a[232:235], v[64:67], v[104:107]
    ds_read_b128 v[88:91], v224 offset:61440
    v_mfma_f32_16x16x32_bf16 v[108:111], a[236:239], v[64:67], v[108:111]
    ds_read_b128 v[92:95], v224 offset:63488
    v_mfma_f32_16x16x32_bf16 v[112:115], a[224:227], v[68:71], v[112:115]
    ds_read_b64_tr_b16 a[240:241], v228 offset:12288
    v_mfma_f32_16x16x32_bf16 v[116:119], a[228:231], v[68:71], v[116:119]
    ds_read_b64_tr_b16 a[242:243], v228 offset:12800
    s_mov_b32 s39, 0
    buffer_store_dwordx4 v[16:19], v238, s[8:11], s39 offen sc1
    v_mfma_f32_16x16x32_bf16 v[120:123], a[232:235], v[68:71], v[120:123]
    ds_read_b64_tr_b16 a[244:245], v229 offset:12288
    v_mfma_f32_16x16x32_bf16 v[124:127], a[236:239], v[68:71], v[124:127]
    ds_read_b64_tr_b16 a[246:247], v229 offset:12800
    v_mfma_f32_16x16x32_bf16 v[128:131], a[224:227], v[72:75], v[128:131]
    v_mfma_f32_16x16x32_bf16 v[132:135], a[228:231], v[72:75], v[132:135]
    v_mfma_f32_16x16x32_bf16 v[136:139], a[232:235], v[72:75], v[136:139]
    v_mfma_f32_16x16x32_bf16 v[140:143], a[236:239], v[72:75], v[140:143]
    v_mfma_f32_16x16x32_bf16 v[144:147], a[224:227], v[76:79], v[144:147]
    v_mfma_f32_16x16x32_bf16 v[148:151], a[228:231], v[76:79], v[148:151]
    s_mov_b32 s39, 8192
    buffer_store_dwordx4 v[20:23], v238, s[8:11], s39 offen sc1
    v_mfma_f32_16x16x32_bf16 v[152:155], a[232:235], v[76:79], v[152:155]
    v_mfma_f32_16x16x32_bf16 v[156:159], a[236:239], v[76:79], v[156:159]
    s_waitcnt lgkmcnt(0)
    v_mfma_f32_16x16x32_bf16 v[160:163], a[224:227], v[80:83], v[160:163]
    ds_read_b128 v[64:67], v225 offset:49152
    v_mfma_f32_16x16x32_bf16 v[164:167], a[228:231], v[80:83], v[164:167]
    ds_read_b128 v[68:71], v225 offset:51200
    v_mfma_f32_16x16x32_bf16 v[168:171], a[232:235], v[80:83], v[168:171]
    ds_read_b128 v[72:75], v225 offset:53248
    v_mfma_f32_16x16x32_bf16 v[172:175], a[236:239], v[80:83], v[172:175]
    ds_read_b128 v[76:79], v225 offset:55296
    v_mfma_f32_16x16x32_bf16 v[176:179], a[224:227], v[84:87], v[176:179]
    ds_read_b64_tr_b16 a[248:249], v230 offset:12288
    v_mfma_f32_16x16x32_bf16 v[180:183], a[228:231], v[84:87], v[180:183]
    ds_read_b64_tr_b16 a[250:251], v230 offset:12800
    s_mov_b32 s39, 16384
    buffer_store_dwordx4 v[24:27], v238, s[8:11], s39 offen sc1
    v_mfma_f32_16x16x32_bf16 v[184:187], a[232:235], v[84:87], v[184:187]
    ds_read_b64_tr_b16 a[252:253], v231 offset:12288
    v_mfma_f32_16x16x32_bf16 v[188:191], a[236:239], v[84:87], v[188:191]
    ds_read_b64_tr_b16 a[254:255], v231 offset:12800
    v_mfma_f32_16x16x32_bf16 v[192:195], a[224:227], v[88:91], v[192:195]
    s_add_u32 m0, s34, 40960
    s_add_u32 s37, s85, 131072
    buffer_load_dwordx4 v232, s[44:47], s37 offen lds
    v_mfma_f32_16x16x32_bf16 v[196:199], a[228:231], v[88:91], v[196:199]
    v_mfma_f32_16x16x32_bf16 v[200:203], a[232:235], v[88:91], v[200:203]
    v_mfma_f32_16x16x32_bf16 v[204:207], a[236:239], v[88:91], v[204:207]
    v_mfma_f32_16x16x32_bf16 v[208:211], a[224:227], v[92:95], v[208:211]
    buffer_load_dwordx4 v233, s[44:47], s37 offen offset:1024 lds
    v_mfma_f32_16x16x32_bf16 v[212:215], a[228:231], v[92:95], v[212:215]
    s_mov_b32 s39, 24576
    buffer_store_dwordx4 v[28:31], v238, s[8:11], s39 offen sc1
    v_mfma_f32_16x16x32_bf16 v[216:219], a[232:235], v[92:95], v[216:219]
    v_mfma_f32_16x16x32_bf16 v[220:223], a[236:239], v[92:95], v[220:223]
    s_waitcnt lgkmcnt(0)
    v_mfma_f32_16x16x32_bf16 v[96:99], a[240:243], v[64:67], v[96:99]
    ds_read_b128 v[80:83], v225 offset:57344
    v_mfma_f32_16x16x32_bf16 v[100:103], a[244:247], v[64:67], v[100:103]
    ds_read_b128 v[84:87], v225 offset:59392
    v_mfma_f32_16x16x32_bf16 v[104:107], a[248:251], v[64:67], v[104:107]
    ds_read_b128 v[88:91], v225 offset:61440
    v_mfma_f32_16x16x32_bf16 v[108:111], a[252:255], v[64:67], v[108:111]
    ds_read_b128 v[92:95], v225 offset:63488
    v_mfma_f32_16x16x32_bf16 v[112:115], a[240:243], v[68:71], v[112:115]
    v_mfma_f32_16x16x32_bf16 v[116:119], a[244:247], v[68:71], v[116:119]
    v_mfma_f32_16x16x32_bf16 v[120:123], a[248:251], v[68:71], v[120:123]
    v_mfma_f32_16x16x32_bf16 v[124:127], a[252:255], v[68:71], v[124:127]
    v_mfma_f32_16x16x32_bf16 v[128:131], a[240:243], v[72:75], v[128:131]
    v_mfma_f32_16x16x32_bf16 v[132:135], a[244:247], v[72:75], v[132:135]
    v_cvt_pk_bf16_f32 v0, v96, v97
    v_cvt_pk_bf16_f32 v1, v98, v99
    v_mfma_f32_16x16x32_bf16 v[136:139], a[248:251], v[72:75], v[136:139]
    v_cvt_pk_bf16_f32 v2, v100, v101
    v_cvt_pk_bf16_f32 v3, v102, v103
    v_mfma_f32_16x16x32_bf16 v[140:143], a[252:255], v[72:75], v[140:143]
    v_cvt_pk_bf16_f32 v4, v104, v105
    v_cvt_pk_bf16_f32 v5, v106, v107
    v_mfma_f32_16x16x32_bf16 v[144:147], a[240:243], v[76:79], v[144:147]
    v_cvt_pk_bf16_f32 v6, v108, v109
    v_cvt_pk_bf16_f32 v7, v110, v111
    v_mfma_f32_16x16x32_bf16 v[148:151], a[244:247], v[76:79], v[148:151]
    v_cvt_pk_bf16_f32 v8, v112, v113
    v_cvt_pk_bf16_f32 v9, v114, v115
    v_mfma_f32_16x16x32_bf16 v[152:155], a[248:251], v[76:79], v[152:155]
    v_cvt_pk_bf16_f32 v10, v116, v117
    v_cvt_pk_bf16_f32 v11, v118, v119
    v_mfma_f32_16x16x32_bf16 v[156:159], a[252:255], v[76:79], v[156:159]
    v_cvt_pk_bf16_f32 v12, v120, v121
    v_cvt_pk_bf16_f32 v13, v122, v123
    s_waitcnt vmcnt(14) lgkmcnt(0)
    s_barrier
    v_mfma_f32_16x16x32_bf16 v[160:163], a[240:243], v[80:83], v[160:163]
    ds_read_b128 v[64:67], v224 offset:0
    v_cvt_pk_bf16_f32 v14, v124, v125
    v_cvt_pk_bf16_f32 v15, v126, v127
    v_mfma_f32_16x16x32_bf16 v[164:167], a[244:247], v[80:83], v[164:167]
    ds_read_b128 v[68:71], v224 offset:2048
    v_cvt_pk_bf16_f32 v16, v128, v129
    v_cvt_pk_bf16_f32 v17, v130, v131
    v_mfma_f32_16x16x32_bf16 v[168:171], a[248:251], v[80:83], v[168:171]
    ds_read_b128 v[72:75], v224 offset:4096
    v_cvt_pk_bf16_f32 v18, v132, v133
    v_cvt_pk_bf16_f32 v19, v134, v135
    v_mfma_f32_16x16x32_bf16 v[172:175], a[252:255], v[80:83], v[172:175]
    ds_read_b128 v[76:79], v224 offset:6144
    v_cvt_pk_bf16_f32 v20, v136, v137
    v_cvt_pk_bf16_f32 v21, v138, v139
    v_mfma_f32_16x16x32_bf16 v[176:179], a[240:243], v[84:87], v[176:179]
    v_cvt_pk_bf16_f32 v22, v140, v141
    v_cvt_pk_bf16_f32 v23, v142, v143
    v_mfma_f32_16x16x32_bf16 v[180:183], a[244:247], v[84:87], v[180:183]
    v_cvt_pk_bf16_f32 v24, v144, v145
    v_cvt_pk_bf16_f32 v25, v146, v147
    v_mfma_f32_16x16x32_bf16 v[184:187], a[248:251], v[84:87], v[184:187]
    v_cvt_pk_bf16_f32 v26, v148, v149
    v_cvt_pk_bf16_f32 v27, v150, v151
    v_mfma_f32_16x16x32_bf16 v[188:191], a[252:255], v[84:87], v[188:191]
    v_cvt_pk_bf16_f32 v28, v152, v153
    v_cvt_pk_bf16_f32 v29, v154, v155
    v_mfma_f32_16x16x32_bf16 v[192:195], a[240:243], v[88:91], v[192:195]
    s_add_u32 m0, s34, 49152
    s_add_u32 s37, s86, 131072
    buffer_load_dwordx4 v232, s[44:47], s37 offen lds
    v_cvt_pk_bf16_f32 v30, v156, v157
    v_cvt_pk_bf16_f32 v31, v158, v159
    v_mfma_f32_16x16x32_bf16 v[196:199], a[244:247], v[88:91], v[196:199]
    v_cvt_pk_bf16_f32 v32, v160, v161
    v_cvt_pk_bf16_f32 v33, v162, v163
    v_mfma_f32_16x16x32_bf16 v[200:203], a[248:251], v[88:91], v[200:203]
    v_cvt_pk_bf16_f32 v34, v164, v165
    v_cvt_pk_bf16_f32 v35, v166, v167
    v_mfma_f32_16x16x32_bf16 v[204:207], a[252:255], v[88:91], v[204:207]
    v_cvt_pk_bf16_f32 v36, v168, v169
    v_cvt_pk_bf16_f32 v37, v170, v171
    v_mfma_f32_16x16x32_bf16 v[208:211], a[240:243], v[92:95], v[208:211]
    buffer_load_dwordx4 v233, s[44:47], s37 offen offset:1024 lds
    v_cvt_pk_bf16_f32 v38, v172, v173
    v_cvt_pk_bf16_f32 v39, v174, v175
    v_mfma_f32_16x16x32_bf16 v[212:215], a[244:247], v[92:95], v[212:215]
    v_cvt_pk_bf16_f32 v40, v176, v177
    v_cvt_pk_bf16_f32 v41, v178, v179
    v_mfma_f32_16x16x32_bf16 v[216:219], a[248:251], v[92:95], v[216:219]
    v_cvt_pk_bf16_f32 v42, v180, v181
    v_cvt_pk_bf16_f32 v43, v182, v183
    v_mfma_f32_16x16x32_bf16 v[220:223], a[252:255], v[92:95], v[220:223]
    v_cvt_pk_bf16_f32 v44, v184, v185
    v_cvt_pk_bf16_f32 v45, v186, v187
    s_waitcnt lgkmcnt(0)
    v_mfma_f32_16x16x32_bf16 v[96:99], a[0:3], v[64:67], 0
    ds_read_b128 v[80:83], v225 offset:0
    v_cvt_pk_bf16_f32 v46, v188, v189
    v_cvt_pk_bf16_f32 v47, v190, v191
    v_mfma_f32_16x16x32_bf16 v[100:103], a[4:7], v[64:67], 0
    ds_read_b128 v[84:87], v225 offset:2048
    v_cvt_pk_bf16_f32 v48, v192, v193
    v_cvt_pk_bf16_f32 v49, v194, v195
    v_mfma_f32_16x16x32_bf16 v[104:107], a[8:11], v[64:67], 0
    ds_read_b128 v[88:91], v225 offset:4096
    v_cvt_pk_bf16_f32 v50, v196, v197
    v_cvt_pk_bf16_f32 v51, v198, v199
    v_mfma_f32_16x16x32_bf16 v[108:111], a[12:15], v[64:67], 0
    ds_read_b128 v[92:95], v225 offset:6144
    v_cvt_pk_bf16_f32 v52, v200, v201
    v_cvt_pk_bf16_f32 v53, v202, v203
    v_mfma_f32_16x16x32_bf16 v[112:115], a[0:3], v[68:71], 0
    v_cvt_pk_bf16_f32 v54, v204, v205
    v_cvt_pk_bf16_f32 v55, v206, v207
    s_add_u32 s38, s36, 0
    buffer_store_dwordx4 v[0:3], v240, s[16:19], s38 offen offset:0 sc1
    v_mfma_f32_16x16x32_bf16 v[116:119], a[4:7], v[68:71], 0
    v_cvt_pk_bf16_f32 v56, v208, v209
    v_cvt_pk_bf16_f32 v57, v210, v211
    v_mfma_f32_16x16x32_bf16 v[120:123], a[8:11], v[68:71], 0
    v_cvt_pk_bf16_f32 v58, v212, v213
    v_cvt_pk_bf16_f32 v59, v214, v215
    v_mfma_f32_16x16x32_bf16 v[124:127], a[12:15], v[68:71], 0
    v_cvt_pk_bf16_f32 v60, v216, v217
    v_cvt_pk_bf16_f32 v61, v218, v219
    v_mfma_f32_16x16x32_bf16 v[128:131], a[0:3], v[72:75], 0
    v_xor_b32 v237, 16, v245
    v_xor_b32 v238, 16, v246
    v_cvt_pk_bf16_f32 v62, v220, v221
    v_cvt_pk_bf16_f32 v63, v222, v223
    v_mfma_f32_16x16x32_bf16 v[132:135], a[4:7], v[72:75], 0
    v_mfma_f32_16x16x32_bf16 v[136:139], a[8:11], v[72:75], 0
    v_mfma_f32_16x16x32_bf16 v[140:143], a[12:15], v[72:75], 0
    v_mfma_f32_16x16x32_bf16 v[144:147], a[0:3], v[76:79], 0
    v_mfma_f32_16x16x32_bf16 v[148:151], a[4:7], v[76:79], 0
    v_mfma_f32_16x16x32_bf16 v[152:155], a[8:11], v[76:79], 0
    v_mfma_f32_16x16x32_bf16 v[156:159], a[12:15], v[76:79], 0
    s_waitcnt lgkmcnt(0)
    v_mfma_f32_16x16x32_bf16 v[96:99], a[16:19], v[80:83], v[96:99]
    ds_read_b128 v[64:67], v224 offset:8192
    v_mfma_f32_16x16x32_bf16 v[100:103], a[20:23], v[80:83], v[100:103]
    ds_read_b128 v[68:71], v224 offset:10240
    v_mfma_f32_16x16x32_bf16 v[104:107], a[24:27], v[80:83], v[104:107]
    ds_read_b128 v[72:75], v224 offset:12288
    v_mfma_f32_16x16x32_bf16 v[108:111], a[28:31], v[80:83], v[108:111]
    ds_read_b128 v[76:79], v224 offset:14336
    v_mfma_f32_16x16x32_bf16 v[112:115], a[16:19], v[84:87], v[112:115]
    v_mfma_f32_16x16x32_bf16 v[116:119], a[20:23], v[84:87], v[116:119]
    v_mfma_f32_16x16x32_bf16 v[120:123], a[24:27], v[84:87], v[120:123]
    v_mfma_f32_16x16x32_bf16 v[124:127], a[28:31], v[84:87], v[124:127]
    v_mfma_f32_16x16x32_bf16 v[128:131], a[16:19], v[88:91], v[128:131]
    s_add_u32 m0, s34, 57344
    s_add_u32 s37, s87, 131072
    buffer_load_dwordx4 v232, s[44:47], s37 offen lds
    v_mfma_f32_16x16x32_bf16 v[132:135], a[20:23], v[88:91], v[132:135]
    s_add_u32 s38, s36, 0
    buffer_store_dwordx4 v[4:7], v240, s[16:19], s38 offen offset:2048 sc1
    v_mfma_f32_16x16x32_bf16 v[136:139], a[24:27], v[88:91], v[136:139]
    v_mfma_f32_16x16x32_bf16 v[140:143], a[28:31], v[88:91], v[140:143]
    v_mfma_f32_16x16x32_bf16 v[144:147], a[16:19], v[92:95], v[144:147]
    buffer_load_dwordx4 v233, s[44:47], s37 offen offset:1024 lds
    v_mfma_f32_16x16x32_bf16 v[148:151], a[20:23], v[92:95], v[148:151]
    v_mfma_f32_16x16x32_bf16 v[152:155], a[24:27], v[92:95], v[152:155]
    v_mfma_f32_16x16x32_bf16 v[156:159], a[28:31], v[92:95], v[156:159]
    s_waitcnt lgkmcnt(0)
    v_mfma_f32_16x16x32_bf16 v[96:99], a[32:35], v[64:67], v[96:99]
    ds_read_b128 v[80:83], v225 offset:8192
    v_mfma_f32_16x16x32_bf16 v[100:103], a[36:39], v[64:67], v[100:103]
    ds_read_b128 v[84:87], v225 offset:10240
    v_mfma_f32_16x16x32_bf16 v[104:107], a[40:43], v[64:67], v[104:107]
    ds_read_b128 v[88:91], v225 offset:12288
    v_mfma_f32_16x16x32_bf16 v[108:111], a[44:47], v[64:67], v[108:111]
    ds_read_b128 v[92:95], v225 offset:14336
    v_mfma_f32_16x16x32_bf16 v[112:115], a[32:35], v[68:71], v[112:115]
    v_mfma_f32_16x16x32_bf16 v[116:119], a[36:39], v[68:71], v[116:119]
    v_mfma_f32_16x16x32_bf16 v[120:123], a[40:43], v[68:71], v[120:123]
    v_mfma_f32_16x16x32_bf16 v[124:127], a[44:47], v[68:71], v[124:127]
    v_mfma_f32_16x16x32_bf16 v[128:131], a[32:35], v[72:75], v[128:131]
    s_waitcnt vmcnt(15)
    v_readfirstlane_b32 s24, v254
    s_lshl_b32 s25, s3, 16
    s_add_u32 s24, s24, s25
    s_cmp_ge_u32 s24, 1
    s_cbranch_scc0 kf_spin31
kf_spinr32:
    v_mfma_f32_16x16x32_bf16 v[132:135], a[36:39], v[72:75], v[132:135]
    v_mfma_f32_16x16x32_bf16 v[136:139], a[40:43], v[72:75], v[136:139]
    v_mfma_f32_16x16x32_bf16 v[140:143], a[44:47], v[72:75], v[140:143]
    v_mfma_f32_16x16x32_bf16 v[144:147], a[32:35], v[76:79], v[144:147]
    s_add_u32 s88, s20, 0x14a0000
    s_addc_u32 s89, s21, 0
    s_mov_b32 s90, 20480
    v_mfma_f32_16x16x32_bf16 v[148:151], a[36:39], v[76:79], v[148:151]
    v_mfma_f32_16x16x32_bf16 v[152:155], a[40:43], v[76:79], v[152:155]
    v_mfma_f32_16x16x32_bf16 v[156:159], a[44:47], v[76:79], v[156:159]
    s_add_u32 s38, s36, 0
    buffer_store_dwordx4 v[8:11], v240, s[16:19], s38 offen offset:1024 sc1
    s_waitcnt vmcnt(7) lgkmcnt(0)
    s_barrier
    v_mfma_f32_16x16x32_bf16 v[96:99], a[48:51], v[80:83], v[96:99]
    ds_read_b128 v[64:67], v224 offset:16384
    v_mfma_f32_16x16x32_bf16 v[100:103], a[52:55], v[80:83], v[100:103]
    ds_read_b128 v[68:71], v224 offset:18432
    v_mfma_f32_16x16x32_bf16 v[104:107], a[56:59], v[80:83], v[104:107]
    ds_read_b128 v[72:75], v224 offset:20480
    v_mfma_f32_16x16x32_bf16 v[108:111], a[60:63], v[80:83], v[108:111]
    ds_read_b128 v[76:79], v224 offset:22528
    v_mfma_f32_16x16x32_bf16 v[112:115], a[48:51], v[84:87], v[112:115]
    v_mfma_f32_16x16x32_bf16 v[116:119], a[52:55], v[84:87], v[116:119]
    v_mfma_f32_16x16x32_bf16 v[120:123], a[56:59], v[84:87], v[120:123]
    v_mfma_f32_16x16x32_bf16 v[124:127], a[60:63], v[84:87], v[124:127]
    v_mfma_f32_16x16x32_bf16 v[128:131], a[48:51], v[88:91], v[128:131]
    s_add_u32 m0, s34, 0
    s_add_u32 s37, s80, 196608
    buffer_load_dwordx4 v232, s[44:47], s37 offen lds
    v_mfma_f32_16x16x32_bf16 v[132:135], a[52:55], v[88:91], v[132:135]
    v_mfma_f32_16x16x32_bf16 v[136:139], a[56:59], v[88:91], v[136:139]
    buffer_load_dwordx4 v233, s[44:47], s37 offen offset:1024 lds
    v_mfma_f32_16x16x32_bf16 v[140:143], a[60:63], v[88:91], v[140:143]
    v_mfma_f32_16x16x32_bf16 v[144:147], a[48:51], v[92:95], v[144:147]
    v_mfma_f32_16x16x32_bf16 v[148:151], a[52:55], v[92:95], v[148:151]
    s_lshl_b32 s39, s5, 7
    s_add_u32 s39, s39, 8192
    buffer_atomic_add v255, v250, s[88:91], s39 offen sc1
    s_cmp_eq_u32 s3, 0
    s_cselect_b32 s39, s39, s43
    v_mfma_f32_16x16x32_bf16 v[152:155], a[56:59], v[92:95], v[152:155]
    v_mfma_f32_16x16x32_bf16 v[156:159], a[60:63], v[92:95], v[156:159]
    s_waitcnt lgkmcnt(0)
    v_mfma_f32_16x16x32_bf16 v[96:99], a[64:67], v[64:67], v[96:99]
    ds_read_b128 v[80:83], v225 offset:16384
    v_mfma_f32_16x16x32_bf16 v[100:103], a[68:71], v[64:67], v[100:103]
    ds_read_b128 v[84:87], v225 offset:18432
    v_mfma_f32_16x16x32_bf16 v[104:107], a[72:75], v[64:67], v[104:107]
    ds_read_b128 v[88:91], v225 offset:20480
    v_mfma_f32_16x16x32_bf16 v[108:111], a[76:79], v[64:67], v[108:111]
    ds_read_b128 v[92:95], v225 offset:22528
    v_mfma_f32_16x16x32_bf16 v[112:115], a[64:67], v[68:71], v[112:115]
    s_add_u32 s38, s36, 0
    buffer_store_dwordx4 v[12:15], v240, s[16:19], s38 offen offset:3072 sc1
    v_mfma_f32_16x16x32_bf16 v[116:119], a[68:71], v[68:71], v[116:119]
    v_mfma_f32_16x16x32_bf16 v[120:123], a[72:75], v[68:71], v[120:123]
    v_mfma_f32_16x16x32_bf16 v[124:127], a[76:79], v[68:71], v[124:127]
    v_mfma_f32_16x16x32_bf16 v[128:131], a[64:67], v[72:75], v[128:131]
    s_add_u32 m0, s31, 0
    s_add_u32 s24, s27, 0
    buffer_load_dwordx4 v245, s[12:15], s24 offen lds
    v_mfma_f32_16x16x32_bf16 v[132:135], a[68:71], v[72:75], v[132:135]
    v_mfma_f32_16x16x32_bf16 v[136:139], a[72:75], v[72:75], v[136:139]
    v_mfma_f32_16x16x32_bf16 v[140:143], a[76:79], v[72:75], v[140:143]
    v_mfma_f32_16x16x32_bf16 v[144:147], a[64:67], v[76:79], v[144:147]
    v_mfma_f32_16x16x32_bf16 v[148:151], a[68:71], v[76:79], v[148:151]
    v_mfma_f32_16x16x32_bf16 v[152:155], a[72:75], v[76:79], v[152:155]
    v_mfma_f32_16x16x32_bf16 v[156:159], a[76:79], v[76:79], v[156:159]
    s_waitcnt lgkmcnt(0)
    v_mfma_f32_16x16x32_bf16 v[96:99], a[80:83], v[80:83], v[96:99]
    ds_read_b128 v[64:67], v224 offset:24576
    v_mfma_f32_16x16x32_bf16 v[100:103], a[84:87], v[80:83], v[100:103]
    ds_read_b128 v[68:71], v224 offset:26624
    v_mfma_f32_16x16x32_bf16 v[104:107], a[88:91], v[80:83], v[104:107]
    ds_read_b128 v[72:75], v224 offset:28672
    v_mfma_f32_16x16x32_bf16 v[108:111], a[92:95], v[80:83], v[108:111]
    ds_read_b128 v[76:79], v224 offset:30720
    v_mfma_f32_16x16x32_bf16 v[112:115], a[80:83], v[84:87], v[112:115]
    v_mfma_f32_16x16x32_bf16 v[116:119], a[84:87], v[84:87], v[116:119]
    v_mfma_f32_16x16x32_bf16 v[120:123], a[88:91], v[84:87], v[120:123]
    v_mfma_f32_16x16x32_bf16 v[124:127], a[92:95], v[84:87], v[124:127]
    v_mfma_f32_16x16x32_bf16 v[128:131], a[80:83], v[88:91], v[128:131]
    s_add_u32 m0, s34, 8192
    s_add_u32 s37, s81, 196608
    buffer_load_dwordx4 v232, s[44:47], s37 offen lds
    v_mfma_f32_16x16x32_bf16 v[132:135], a[84:87], v[88:91], v[132:135]
    v_mfma_f32_16x16x32_bf16 v[136:139], a[88:91], v[88:91], v[136:139]
    buffer_load_dwordx4 v233, s[44:47], s37 offen offset:1024 lds
    s_add_u32 s38, s36, 8192
    buffer_store_dwordx4 v[16:19], v240, s[16:19], s38 offen offset:0 sc1
    v_mfma_f32_16x16x32_bf16 v[140:143], a[92:95], v[88:91], v[140:143]
    v_mfma_f32_16x16x32_bf16 v[144:147], a[80:83], v[92:95], v[144:147]
    v_mfma_f32_16x16x32_bf16 v[148:151], a[84:87], v[92:95], v[148:151]
    s_add_u32 m0, s31, 1024
    s_add_u32 s24, s27, 32768
    buffer_load_dwordx4 v245, s[12:15], s24 offen lds
    v_mfma_f32_16x16x32_bf16 v[152:155], a[88:91], v[92:95], v[152:155]
    v_mfma_f32_16x16x32_bf16 v[156:159], a[92:95], v[92:95], v[156:159]
    s_waitcnt lgkmcnt(0)
    v_mfma_f32_16x16x32_bf16 v[96:99], a[96:99], v[64:67], v[96:99]
    ds_read_b128 v[80:83], v225 offset:24576
    v_mfma_f32_16x16x32_bf16 v[100:103], a[100:103], v[64:67], v[100:103]
    ds_read_b128 v[84:87], v225 offset:26624
    v_mfma_f32_16x16x32_bf16 v[104:107], a[104:107], v[64:67], v[104:107]
    ds_read_b128 v[88:91], v225 offset:28672
    v_mfma_f32_16x16x32_bf16 v[108:111], a[108:111], v[64:67], v[108:111]
    ds_read_b128 v[92:95], v225 offset:30720
    v_mfma_f32_16x16x32_bf16 v[112:115], a[96:99], v[68:71], v[112:115]
    v_mfma_f32_16x16x32_bf16 v[116:119], a[100:103], v[68:71], v[116:119]
    v_mfma_f32_16x16x32_bf16 v[120:123], a[104:107], v[68:71], v[120:123]
    v_mfma_f32_16x16x32_bf16 v[124:127], a[108:111], v[68:71], v[124:127]
    v_mfma_f32_16x16x32_bf16 v[128:131], a[96:99], v[72:75], v[128:131]
    s_add_u32 m0, s31, 2048
    s_add_u32 s24, s27, 65536
    buffer_load_dwordx4 v237, s[12:15], s24 offen lds
    v_mfma_f32_16x16x32_bf16 v[132:135], a[100:103], v[72:75], v[132:135]
    v_mfma_f32_16x16x32_bf16 v[136:139], a[104:107], v[72:75], v[136:139]
    v_mfma_f32_16x16x32_bf16 v[140:143], a[108:111], v[72:75], v[140:143]
    v_mfma_f32_16x16x32_bf16 v[144:147], a[96:99], v[76:79], v[144:147]
    v_mfma_f32_16x16x32_bf16 v[148:151], a[100:103], v[76:79], v[148:151]
    v_mfma_f32_16x16x32_bf16 v[152:155], a[104:107], v[76:79], v[152:155]
    v_mfma_f32_16x16x32_bf16 v[156:159], a[108:111], v[76:79], v[156:159]
    s_add_u32 s38, s36, 8192
    buffer_store_dwordx4 v[20:23], v240, s[16:19], s38 offen offset:2048 sc1
    s_waitcnt vmcnt(19) lgkmcnt(0)
    s_barrier
    v_mfma_f32_16x16x32_bf16 v[96:99], a[112:115], v[80:83], v[96:99]
    ds_read_b128 v[64:67], v224 offset:32768
    v_mfma_f32_16x16x32_bf16 v[100:103], a[116:119], v[80:83], v[100:103]
    ds_read_b128 v[68:71], v224 offset:34816
    v_mfma_f32_16x16x32_bf16 v[104:107], a[120:123], v[80:83], v[104:107]
    ds_read_b128 v[72:75], v224 offset:36864
    v_mfma_f32_16x16x32_bf16 v[108:111], a[124:127], v[80:83], v[108:111]
    ds_read_b128 v[76:79], v224 offset:38912
    v_mfma_f32_16x16x32_bf16 v[112:115], a[112:115], v[84:87], v[112:115]
    v_mfma_f32_16x16x32_bf16 v[116:119], a[116:119], v[84:87], v[116:119]
    v_mfma_f32_16x16x32_bf16 v[120:123], a[120:123], v[84:87], v[120:123]
    v_mfma_f32_16x16x32_bf16 v[124:127], a[124:127], v[84:87], v[124:127]
    v_mfma_f32_16x16x32_bf16 v[128:131], a[112:115], v[88:91], v[128:131]
    s_add_u32 m0, s34, 16384
    s_add_u32 s37, s82, 196608
    buffer_load_dwordx4 v232, s[44:47], s37 offen lds
    v_mfma_f32_16x16x32_bf16 v[132:135], a[116:119], v[88:91], v[132:135]
    v_mfma_f32_16x16x32_bf16 v[136:139], a[120:123], v[88:91], v[136:139]
    buffer_load_dwordx4 v233, s[44:47], s37 offen offset:1024 lds
    v_mfma_f32_16x16x32_bf16 v[140:143], a[124:127], v[88:91], v[140:143]
    v_mfma_f32_16x16x32_bf16 v[144:147], a[112:115], v[92:95], v[144:147]
    v_mfma_f32_16x16x32_bf16 v[148:151], a[116:119], v[92:95], v[148:151]
    s_add_u32 m0, s31, 3072
    s_add_u32 s24, s27, 98304
    buffer_load_dwordx4 v237, s[12:15], s24 offen lds
    v_mfma_f32_16x16x32_bf16 v[152:155], a[120:123], v[92:95], v[152:155]
    v_mfma_f32_16x16x32_bf16 v[156:159], a[124:127], v[92:95], v[156:159]
    s_waitcnt lgkmcnt(0)
    v_mfma_f32_16x16x32_bf16 v[96:99], a[128:131], v[64:67], v[96:99]
    ds_read_b128 v[80:83], v225 offset:32768
    v_mfma_f32_16x16x32_bf16 v[100:103], a[132:135], v[64:67], v[100:103]
    ds_read_b128 v[84:87], v225 offset:34816
    v_mfma_f32_16x16x32_bf16 v[104:107], a[136:139], v[64:67], v[104:107]
    ds_read_b128 v[88:91], v225 offset:36864
    v_mfma_f32_16x16x32_bf16 v[108:111], a[140:143], v[64:67], v[108:111]
    ds_read_b128 v[92:95], v225 offset:38912
    v_mfma_f32_16x16x32_bf16 v[112:115], a[128:131], v[68:71], v[112:115]
    v_mfma_f32_16x16x32_bf16 v[116:119], a[132:135], v[68:71], v[116:119]
    s_add_u32 s38, s36, 8192
    buffer_store_dwordx4 v[24:27], v240, s[16:19], s38 offen offset:1024 sc1
    v_mfma_f32_16x16x32_bf16 v[120:123], a[136:139], v[68:71], v[120:123]
    v_mfma_f32_16x16x32_bf16 v[124:127], a[140:143], v[68:71], v[124:127]
    v_mfma_f32_16x16x32_bf16 v[128:131], a[128:131], v[72:75], v[128:131]
    s_add_u32 m0, s31, 4096
    s_add_u32 s24, s27, 131072
    buffer_load_dwordx4 v245, s[12:15], s24 offen lds
    v_mfma_f32_16x16x32_bf16 v[132:135], a[132:135], v[72:75], v[132:135]
    v_mfma_f32_16x16x32_bf16 v[136:139], a[136:139], v[72:75], v[136:139]
    v_mfma_f32_16x16x32_bf16 v[140:143], a[140:143], v[72:75], v[140:143]
    v_mfma_f32_16x16x32_bf16 v[144:147], a[128:131], v[76:79], v[144:147]
    v_mfma_f32_16x16x32_bf16 v[148:151], a[132:135], v[76:79], v[148:151]
    v_mfma_f32_16x16x32_bf16 v[152:155], a[136:139], v[76:79], v[152:155]
    v_mfma_f32_16x16x32_bf16 v[156:159], a[140:143], v[76:79], v[156:159]
    s_waitcnt lgkmcnt(0)
    v_mfma_f32_16x16x32_bf16 v[96:99], a[144:147], v[80:83], v[96:99]
    ds_read_b128 v[64:67], v224 offset:40960
    v_mfma_f32_16x16x32_bf16 v[100:103], a[148:151], v[80:83], v[100:103]
    ds_read_b128 v[68:71], v224 offset:43008
    v_mfma_f32_16x16x32_bf16 v[104:107], a[152:155], v[80:83], v[104:107]
    ds_read_b128 v[72:75], v224 offset:45056
    v_mfma_f32_16x16x32_bf16 v[108:111], a[156:159], v[80:83], v[108:111]
    ds_read_b128 v[76:79], v224 offset:47104
    v_mfma_f32_16x16x32_bf16 v[112:115], a[144:147], v[84:87], v[112:115]
    v_mfma_f32_16x16x32_bf16 v[116:119], a[148:151], v[84:87], v[116:119]
    v_mfma_f32_16x16x32_bf16 v[120:123], a[152:155], v[84:87], v[120:123]
    v_mfma_f32_16x16x32_bf16 v[124:127], a[156:159], v[84:87], v[124:127]
    v_mfma_f32_16x16x32_bf16 v[128:131], a[144:147], v[88:91], v[128:131]
    s_add_u32 m0, s34, 24576
    s_add_u32 s37, s83, 196608
    buffer_load_dwordx4 v232, s[44:47], s37 offen lds
    v_mfma_f32_16x16x32_bf16 v[132:135], a[148:151], v[88:91], v[132:135]
    v_mfma_f32_16x16x32_bf16 v[136:139], a[152:155], v[88:91], v[136:139]
    buffer_load_dwordx4 v233, s[44:47], s37 offen offset:1024 lds
    s_add_u32 s38, s36, 8192
    buffer_store_dwordx4 v[28:31], v240, s[16:19], s38 offen offset:3072 sc1
    v_mfma_f32_16x16x32_bf16 v[140:143], a[156:159], v[88:91], v[140:143]
    v_mfma_f32_16x16x32_bf16 v[144:147], a[144:147], v[92:95], v[144:147]
    v_mfma_f32_16x16x32_bf16 v[148:151], a[148:151], v[92:95], v[148:151]
    s_add_u32 m0, s31, 5120
    s_add_u32 s24, s27, 163840
    buffer_load_dwordx4 v245, s[12:15], s24 offen lds
    v_mfma_f32_16x16x32_bf16 v[152:155], a[152:155], v[92:95], v[152:155]
    v_mfma_f32_16x16x32_bf16 v[156:159], a[156:159], v[92:95], v[156:159]
    s_waitcnt lgkmcnt(0)
    v_mfma_f32_16x16x32_bf16 v[96:99], a[160:163], v[64:67], v[96:99]
    ds_read_b128 v[80:83], v225 offset:40960
    v_mfma_f32_16x16x32_bf16 v[100:103], a[164:167], v[64:67], v[100:103]
    ds_read_b128 v[84:87], v225 offset:43008
    v_mfma_f32_16x16x32_bf16 v[104:107], a[168:171], v[64:67], v[104:107]
    ds_read_b128 v[88:91], v225 offset:45056
    v_mfma_f32_16x16x32_bf16 v[108:111], a[172:175], v[64:67], v[108:111]
    ds_read_b128 v[92:95], v225 offset:47104
    v_mfma_f32_16x16x32_bf16 v[112:115], a[160:163], v[68:71], v[112:115]
    v_mfma_f32_16x16x32_bf16 v[116:119], a[164:167], v[68:71], v[116:119]
    v_mfma_f32_16x16x32_bf16 v[120:123], a[168:171], v[68:71], v[120:123]
    v_mfma_f32_16x16x32_bf16 v[124:127], a[172:175], v[68:71], v[124:127]
    v_mfma_f32_16x16x32_bf16 v[128:131], a[160:163], v[72:75], v[128:131]
    s_add_u32 m0, s31, 6144
    s_add_u32 s24, s27, 196608
    buffer_load_dwordx4 v237, s[12:15], s24 offen lds
    v_mfma_f32_16x16x32_bf16 v[132:135], a[164:167], v[72:75], v[132:135]
    v_mfma_f32_16x16x32_bf16 v[136:139], a[168:171], v[72:75], v[136:139]
    v_mfma_f32_16x16x32_bf16 v[140:143], a[172:175], v[72:75], v[140:143]
    v_mfma_f32_16x16x32_bf16 v[144:147], a[160:163], v[76:79], v[144:147]
    v_mfma_f32_16x16x32_bf16 v[148:151], a[164:167], v[76:79], v[148:151]
    v_mfma_f32_16x16x32_bf16 v[152:155], a[168:171], v[76:79], v[152:155]
    v_mfma_f32_16x16x32_bf16 v[156:159], a[172:175], v[76:79], v[156:159]
    s_waitcnt vmcnt(22) lgkmcnt(0)
    s_barrier
    v_mfma_f32_16x16x32_bf16 v[96:99], a[176:179], v[80:83], v[96:99]
    ds_read_b128 v[64:67], v224 offset:49152
    s_add_u32 s38, s36, 32768
    buffer_store_dwordx4 v[32:35], v240, s[16:19], s38 offen offset:1280 sc1
    v_mfma_f32_16x16x32_bf16 v[100:103], a[180:183], v[80:83], v[100:103]
    ds_read_b128 v[68:71], v224 offset:51200
    v_mfma_f32_16x16x32_bf16 v[104:107], a[184:187], v[80:83], v[104:107]
    ds_read_b128 v[72:75], v224 offset:53248
    v_mfma_f32_16x16x32_bf16 v[108:111], a[188:191], v[80:83], v[108:111]
    ds_read_b128 v[76:79], v224 offset:55296
    v_mfma_f32_16x16x32_bf16 v[112:115], a[176:179], v[84:87], v[112:115]
    v_mfma_f32_16x16x32_bf16 v[116:119], a[180:183], v[84:87], v[116:119]
    v_mfma_f32_16x16x32_bf16 v[120:123], a[184:187], v[84:87], v[120:123]
    v_mfma_f32_16x16x32_bf16 v[124:127], a[188:191], v[84:87], v[124:127]
    v_mfma_f32_16x16x32_bf16 v[128:131], a[176:179], v[88:91], v[128:131]
    s_add_u32 m0, s34, 32768
    s_add_u32 s37, s84, 196608
    buffer_load_dwordx4 v232, s[44:47], s37 offen lds
    v_mfma_f32_16x16x32_bf16 v[132:135], a[180:183], v[88:91], v[132:135]
    buffer_load_dwordx4 v233, s[44:47], s37 offen offset:1024 lds
    v_mfma_f32_16x16x32_bf16 v[136:139], a[184:187], v[88:91], v[136:139]
    v_mfma_f32_16x16x32_bf16 v[140:143], a[188:191], v[88:91], v[140:143]
    s_add_u32 m0, s31, 7168
    s_add_u32 s24, s27, 229376
    buffer_load_dwordx4 v237, s[12:15], s24 offen lds
    v_mfma_f32_16x16x32_bf16 v[144:147], a[176:179], v[92:95], v[144:147]
    s_add_u32 s27, s27, 1048576
    s_and_b32 s27, s27, 0x407fffff
    s_cmp_eq_u32 s27, s7
    s_cselect_b32 s27, s43, s27
    v_mfma_f32_16x16x32_bf16 v[148:151], a[180:183], v[92:95], v[148:151]
    v_mfma_f32_16x16x32_bf16 v[152:155], a[184:187], v[92:95], v[152:155]
    s_add_u32 s31, s31, 32768
    s_cmp_ge_u32 s31, 163840
    s_cselect_b32 s24, 98304, 0
    s_sub_u32 s31, s31, s24
    v_mfma_f32_16x16x32_bf16 v[156:159], a[188:191], v[92:95], v[156:159]
    s_waitcnt lgkmcnt(0)
    v_mfma_f32_16x16x32_bf16 v[96:99], a[192:195], v[64:67], v[96:99]
    ds_read_b128 v[80:83], v225 offset:49152
    v_mfma_f32_16x16x32_bf16 v[100:103], a[196:199], v[64:67], v[100:103]
    ds_read_b128 v[84:87], v225 offset:51200
    v_mfma_f32_16x16x32_bf16 v[104:107], a[200:203], v[64:67], v[104:107]
    ds_read_b128 v[88:91], v225 offset:53248
    v_mfma_f32_16x16x32_bf16 v[108:111], a[204:207], v[64:67], v[108:111]
    ds_read_b128 v[92:95], v225 offset:55296
    v_mfma_f32_16x16x32_bf16 v[112:115], a[192:195], v[68:71], v[112:115]
    v_mfma_f32_16x16x32_bf16 v[116:119], a[196:199], v[68:71], v[116:119]
    v_mfma_f32_16x16x32_bf16 v[120:123], a[200:203], v[68:71], v[120:123]
    s_add_u32 s38, s36, 32768
    buffer_store_dwordx4 v[36:39], v240, s[16:19], s38 offen offset:3328 sc1
    v_mfma_f32_16x16x32_bf16 v[124:127], a[204:207], v[68:71], v[124:127]
    v_mfma_f32_16x16x32_bf16 v[128:131], a[192:195], v[72:75], v[128:131]
    v_mfma_f32_16x16x32_bf16 v[132:135], a[196:199], v[72:75], v[132:135]
    v_mfma_f32_16x16x32_bf16 v[136:139], a[200:203], v[72:75], v[136:139]
    v_mfma_f32_16x16x32_bf16 v[140:143], a[204:207], v[72:75], v[140:143]
    v_mfma_f32_16x16x32_bf16 v[144:147], a[192:195], v[76:79], v[144:147]
    v_mfma_f32_16x16x32_bf16 v[148:151], a[196:199], v[76:79], v[148:151]
    v_mfma_f32_16x16x32_bf16 v[152:155], a[200:203], v[76:79], v[152:155]
    v_mfma_f32_16x16x32_bf16 v[156:159], a[204:207], v[76:79], v[156:159]
    s_waitcnt lgkmcnt(0)
    v_mfma_f32_16x16x32_bf16 v[96:99], a[208:211], v[80:83], v[96:99]
    ds_read_b128 v[64:67], v224 offset:57344
    v_mfma_f32_16x16x32_bf16 v[100:103], a[212:215], v[80:83], v[100:103]
    ds_read_b128 v[68:71], v224 offset:59392
    v_mfma_f32_16x16x32_bf16 v[104:107], a[216:219], v[80:83], v[104:107]
    ds_read_b128 v[72:75], v224 offset:61440
    v_mfma_f32_16x16x32_bf16 v[108:111], a[220:223], v[80:83], v[108:111]
    ds_read_b128 v[76:79], v224 offset:63488
    v_mfma_f32_16x16x32_bf16 v[112:115], a[208:211], v[84:87], v[112:115]
    v_mfma_f32_16x16x32_bf16 v[116:119], a[212:215], v[84:87], v[116:119]
    v_mfma_f32_16x16x32_bf16 v[120:123], a[216:219], v[84:87], v[120:123]
    v_mfma_f32_16x16x32_bf16 v[124:127], a[220:223], v[84:87], v[124:127]
    v_mfma_f32_16x16x32_bf16 v[128:131], a[208:211], v[88:91], v[128:131]
    s_add_u32 m0, s34, 40960
    s_add_u32 s37, s85, 196608
    buffer_load_dwordx4 v232, s[44:47], s37 offen lds
    v_mfma_f32_16x16x32_bf16 v[132:135], a[212:215], v[88:91], v[132:135]
    v_mfma_f32_16x16x32_bf16 v[136:139], a[216:219], v[88:91], v[136:139]
    v_mfma_f32_16x16x32_bf16 v[140:143], a[220:223], v[88:91], v[140:143]
    s_add_u32 s38, s36, 32768
    buffer_store_dwordx4 v[40:43], v240, s[16:19], s38 offen offset:2304 sc1
    v_mfma_f32_16x16x32_bf16 v[144:147], a[208:211], v[92:95], v[144:147]
    buffer_load_dwordx4 v233, s[44:47], s37 offen offset:1024 lds
    v_mfma_f32_16x16x32_bf16 v[148:151], a[212:215], v[92:95], v[148:151]
    v_mfma_f32_16x16x32_bf16 v[152:155], a[216:219], v[92:95], v[152:155]
    v_mfma_f32_16x16x32_bf16 v[156:159], a[220:223], v[92:95], v[156:159]
    s_waitcnt lgkmcnt(0)
    v_mfma_f32_16x16x32_bf16 v[96:99], a[224:227], v[64:67], v[96:99]
    ds_read_b128 v[80:83], v225 offset:57344
    v_mfma_f32_16x16x32_bf16 v[100:103], a[228:231], v[64:67], v[100:103]
    ds_read_b128 v[84:87], v225 offset:59392
    v_mfma_f32_16x16x32_bf16 v[104:107], a[232:235], v[64:67], v[104:107]
    ds_read_b128 v[88:91], v225 offset:61440
    v_mfma_f32_16x16x32_bf16 v[108:111], a[236:239], v[64:67], v[108:111]
    ds_read_b128 v[92:95], v225 offset:63488
    v_mfma_f32_16x16x32_bf16 v[112:115], a[224:227], v[68:71], v[112:115]
    v_mfma_f32_16x16x32_bf16 v[116:119], a[228:231], v[68:71], v[116:119]
    v_mfma_f32_16x16x32_bf16 v[120:123], a[232:235], v[68:71], v[120:123]
    v_mfma_f32_16x16x32_bf16 v[124:127], a[236:239], v[68:71], v[124:127]
    v_mfma_f32_16x16x32_bf16 v[128:131], a[224:227], v[72:75], v[128:131]
    s_add_u32 m0, s31, 0
    s_add_u32 s24, s27, 0
    buffer_load_dwordx4 v245, s[12:15], s24 offen lds
    v_mfma_f32_16x16x32_bf16 v[132:135], a[228:231], v[72:75], v[132:135]
    v_mfma_f32_16x16x32_bf16 v[136:139], a[232:235], v[72:75], v[136:139]
    v_mfma_f32_16x16x32_bf16 v[140:143], a[236:239], v[72:75], v[140:143]
    v_mfma_f32_16x16x32_bf16 v[144:147], a[224:227], v[76:79], v[144:147]
    v_mfma_f32_16x16x32_bf16 v[148:151], a[228:231], v[76:79], v[148:151]
    v_mfma_f32_16x16x32_bf16 v[152:155], a[232:235], v[76:79], v[152:155]
    v_mfma_f32_16x16x32_bf16 v[156:159], a[236:239], v[76:79], v[156:159]
    s_waitcnt vmcnt(23) lgkmcnt(0)
    s_barrier
    v_mfma_f32_16x16x32_bf16 v[96:99], a[240:243], v[80:83], v[96:99]
    ds_read_b128 v[64:67], v224 offset:0
    v_mfma_f32_16x16x32_bf16 v[100:103], a[244:247], v[80:83], v[100:103]
    ds_read_b128 v[68:71], v224 offset:2048
    s_add_u32 s38, s36, 36864
    buffer_store_dwordx4 v[44:47], v240, s[16:19], s38 offen offset:256 sc1
    v_mfma_f32_16x16x32_bf16 v[104:107], a[248:251], v[80:83], v[104:107]
    ds_read_b128 v[72:75], v224 offset:4096
    v_mfma_f32_16x16x32_bf16 v[108:111], a[252:255], v[80:83], v[108:111]
    ds_read_b128 v[76:79], v224 offset:6144
    v_mfma_f32_16x16x32_bf16 v[112:115], a[240:243], v[84:87], v[112:115]
    v_mfma_f32_16x16x32_bf16 v[116:119], a[244:247], v[84:87], v[116:119]
    v_mfma_f32_16x16x32_bf16 v[120:123], a[248:251], v[84:87], v[120:123]
    v_mfma_f32_16x16x32_bf16 v[124:127], a[252:255], v[84:87], v[124:127]
    v_mfma_f32_16x16x32_bf16 v[128:131], a[240:243], v[88:91], v[128:131]
    s_add_u32 m0, s34, 49152
    s_add_u32 s37, s86, 196608
    buffer_load_dwordx4 v232, s[44:47], s37 offen lds
    v_mfma_f32_16x16x32_bf16 v[132:135], a[244:247], v[88:91], v[132:135]
    v_mfma_f32_16x16x32_bf16 v[136:139], a[248:251], v[88:91], v[136:139]
    buffer_load_dwordx4 v233, s[44:47], s37 offen offset:1024 lds
    v_mfma_f32_16x16x32_bf16 v[140:143], a[252:255], v[88:91], v[140:143]
    v_mfma_f32_16x16x32_bf16 v[144:147], a[240:243], v[92:95], v[144:147]
    v_mfma_f32_16x16x32_bf16 v[148:151], a[244:247], v[92:95], v[148:151]
    s_add_u32 m0, s31, 1024
    s_add_u32 s24, s27, 32768
    buffer_load_dwordx4 v245, s[12:15], s24 offen lds
    v_mfma_f32_16x16x32_bf16 v[152:155], a[248:251], v[92:95], v[152:155]
    v_mfma_f32_16x16x32_bf16 v[156:159], a[252:255], v[92:95], v[156:159]
    s_waitcnt lgkmcnt(0)
    v_mfma_f32_16x16x32_bf16 v[160:163], a[0:3], v[64:67], 0
    ds_read_b128 v[80:83], v225 offset:0
    v_mfma_f32_16x16x32_bf16 v[164:167], a[4:7], v[64:67], 0
    ds_read_b128 v[84:87], v225 offset:2048
    v_mfma_f32_16x16x32_bf16 v[168:171], a[8:11], v[64:67], 0
    ds_read_b128 v[88:91], v225 offset:4096
    v_mfma_f32_16x16x32_bf16 v[172:175], a[12:15], v[64:67], 0
    ds_read_b128 v[92:95], v225 offset:6144
    v_mfma_f32_16x16x32_bf16 v[176:179], a[0:3], v[68:71], 0
    v_cvt_pk_bf16_f32 v0, v96, v97
    v_cvt_pk_bf16_f32 v1, v98, v99
    v_mfma_f32_16x16x32_bf16 v[180:183], a[4:7], v[68:71], 0
    v_mfma_f32_16x16x32_bf16 v[184:187], a[8:11], v[68:71], 0
    v_cvt_pk_bf16_f32 v2, v100, v101
    v_cvt_pk_bf16_f32 v3, v102, v103
    s_add_u32 s38, s36, 40960
    buffer_store_dwordx4 v[48:51], v240, s[16:19], s38 offen offset:1280 sc1
    v_mfma_f32_16x16x32_bf16 v[188:191], a[12:15], v[68:71], 0
    v_mfma_f32_16x16x32_bf16 v[192:195], a[0:3], v[72:75], 0
    s_add_u32 m0, s31, 2048
    s_add_u32 s24, s27, 65536
    buffer_load_dwordx4 v237, s[12:15], s24 offen lds
    v_cvt_pk_bf16_f32 v4, v104, v105
    v_cvt_pk_bf16_f32 v5, v106, v107
    v_mfma_f32_16x16x32_bf16 v[196:199], a[4:7], v[72:75], 0
    v_mfma_f32_16x16x32_bf16 v[200:203], a[8:11], v[72:75], 0
    v_cvt_pk_bf16_f32 v6, v108, v109
    v_cvt_pk_bf16_f32 v7, v110, v111
    v_mfma_f32_16x16x32_bf16 v[204:207], a[12:15], v[72:75], 0
    v_mfma_f32_16x16x32_bf16 v[208:211], a[0:3], v[76:79], 0
    v_cvt_pk_bf16_f32 v8, v112, v113
    v_cvt_pk_bf16_f32 v9, v114, v115
    v_mfma_f32_16x16x32_bf16 v[212:215], a[4:7], v[76:79], 0
    v_mfma_f32_16x16x32_bf16 v[216:219], a[8:11], v[76:79], 0
    v_cvt_pk_bf16_f32 v10, v116, v117
    v_cvt_pk_bf16_f32 v11, v118, v119
    v_mfma_f32_16x16x32_bf16 v[220:223], a[12:15], v[76:79], 0
    s_waitcnt lgkmcnt(0)
    v_mfma_f32_16x16x32_bf16 v[160:163], a[16:19], v[80:83], v[160:163]
    ds_read_b128 v[64:67], v224 offset:8192
    v_cvt_pk_bf16_f32 v12, v120, v121
    v_cvt_pk_bf16_f32 v13, v122, v123
    v_mfma_f32_16x16x32_bf16 v[164:167], a[20:23], v[80:83], v[164:167]
    ds_read_b128 v[68:71], v224 offset:10240
    v_mfma_f32_16x16x32_bf16 v[168:171], a[24:27], v[80:83], v[168:171]
    ds_read_b128 v[72:75], v224 offset:12288
    v_cvt_pk_bf16_f32 v14, v124, v125
    v_cvt_pk_bf16_f32 v15, v126, v127
    v_mfma_f32_16x16x32_bf16 v[172:175], a[28:31], v[80:83], v[172:175]
    ds_read_b128 v[76:79], v224 offset:14336
    v_mfma_f32_16x16x32_bf16 v[176:179], a[16:19], v[84:87], v[176:179]
    v_cvt_pk_bf16_f32 v16, v128, v129
    v_cvt_pk_bf16_f32 v17, v130, v131
    v_mfma_f32_16x16x32_bf16 v[180:183], a[20:23], v[84:87], v[180:183]
    v_mfma_f32_16x16x32_bf16 v[184:187], a[24:27], v[84:87], v[184:187]
    v_cvt_pk_bf16_f32 v18, v132, v133
    v_cvt_pk_bf16_f32 v19, v134, v135
    v_mfma_f32_16x16x32_bf16 v[188:191], a[28:31], v[84:87], v[188:191]
    v_mfma_f32_16x16x32_bf16 v[192:195], a[16:19], v[88:91], v[192:195]
    s_add_u32 m0, s34, 57344
    s_add_u32 s37, s87, 196608
    buffer_load_dwordx4 v232, s[44:47], s37 offen lds
    v_cvt_pk_bf16_f32 v20, v136, v137
    v_cvt_pk_bf16_f32 v21, v138, v139
    v_mfma_f32_16x16x32_bf16 v[196:199], a[20:23], v[88:91], v[196:199]
    v_mfma_f32_16x16x32_bf16 v[200:203], a[24:27], v[88:91], v[200:203]
    buffer_load_dwordx4 v233, s[44:47], s37 offen offset:1024 lds
    v_cvt_pk_bf16_f32 v22, v140, v141
    v_cvt_pk_bf16_f32 v23, v142, v143
    v_mfma_f32_16x16x32_bf16 v[204:207], a[28:31], v[88:91], v[204:207]
    v_mfma_f32_16x16x32_bf16 v[208:211], a[16:19], v[92:95], v[208:211]
    v_cvt_pk_bf16_f32 v24, v144, v145
    v_cvt_pk_bf16_f32 v25, v146, v147
    s_add_u32 s38, s36, 40960
    buffer_store_dwordx4 v[52:55], v240, s[16:19], s38 offen offset:3328 sc1
    v_mfma_f32_16x16x32_bf16 v[212:215], a[20:23], v[92:95], v[212:215]
    s_add_u32 m0, s31, 3072
    s_add_u32 s24, s27, 98304
    buffer_load_dwordx4 v237, s[12:15], s24 offen lds
    v_mfma_f32_16x16x32_bf16 v[216:219], a[24:27], v[92:95], v[216:219]
    v_cvt_pk_bf16_f32 v26, v148, v149
    v_cvt_pk_bf16_f32 v27, v150, v151
    v_mfma_f32_16x16x32_bf16 v[220:223], a[28:31], v[92:95], v[220:223]
    s_waitcnt lgkmcnt(0)
    v_mfma_f32_16x16x32_bf16 v[160:163], a[32:35], v[64:67], v[160:163]
    ds_read_b128 v[80:83], v225 offset:8192
    v_cvt_pk_bf16_f32 v28, v152, v153
    v_cvt_pk_bf16_f32 v29, v154, v155
    v_mfma_f32_16x16x32_bf16 v[164:167], a[36:39], v[64:67], v[164:167]
    ds_read_b128 v[84:87], v225 offset:10240
    v_mfma_f32_16x16x32_bf16 v[168:171], a[40:43], v[64:67], v[168:171]
    ds_read_b128 v[88:91], v225 offset:12288
    v_cvt_pk_bf16_f32 v30, v156, v157
    v_cvt_pk_bf16_f32 v31, v158, v159
    v_mfma_f32_16x16x32_bf16 v[172:175], a[44:47], v[64:67], v[172:175]
    ds_read_b128 v[92:95], v225 offset:14336
    v_mfma_f32_16x16x32_bf16 v[176:179], a[32:35], v[68:71], v[176:179]
    v_mfma_f32_16x16x32_bf16 v[180:183], a[36:39], v[68:71], v[180:183]
    v_mfma_f32_16x16x32_bf16 v[184:187], a[40:43], v[68:71], v[184:187]
    v_mfma_f32_16x16x32_bf16 v[188:191], a[44:47], v[68:71], v[188:191]
    v_mfma_f32_16x16x32_bf16 v[192:195], a[32:35], v[72:75], v[192:195]
    s_add_u32 m0, s31, 4096
    s_add_u32 s24, s27, 131072
    buffer_load_dwordx4 v245, s[12:15], s24 offen lds
    v_mfma_f32_16x16x32_bf16 v[196:199], a[36:39], v[72:75], v[196:199]
    v_mfma_f32_16x16x32_bf16 v[200:203], a[40:43], v[72:75], v[200:203]
    v_mfma_f32_16x16x32_bf16 v[204:207], a[44:47], v[72:75], v[204:207]
    v_mfma_f32_16x16x32_bf16 v[208:211], a[32:35], v[76:79], v[208:211]
    v_mfma_f32_16x16x32_bf16 v[212:215], a[36:39], v[76:79], v[212:215]
    v_mfma_f32_16x16x32_bf16 v[216:219], a[40:43], v[76:79], v[216:219]
    v_mfma_f32_16x16x32_bf16 v[220:223], a[44:47], v[76:79], v[220:223]
    s_waitcnt vmcnt(23) lgkmcnt(0)
    s_barrier
    v_mfma_f32_16x16x32_bf16 v[160:163], a[48:51], v[80:83], v[160:163]
    ds_read_b128 v[64:67], v224 offset:16384
    v_mfma_f32_16x16x32_bf16 v[164:167], a[52:55], v[80:83], v[164:167]
    ds_read_b128 v[68:71], v224 offset:18432
    s_add_u32 s38, s36, 40960
    buffer_store_dwordx4 v[56:59], v240, s[16:19], s38 offen offset:2304 sc1
    v_mfma_f32_16x16x32_bf16 v[168:171], a[56:59], v[80:83], v[168:171]
    ds_read_b128 v[72:75], v224 offset:20480
    v_mfma_f32_16x16x32_bf16 v[172:175], a[60:63], v[80:83], v[172:175]
    ds_read_b128 v[76:79], v224 offset:22528
    v_mfma_f32_16x16x32_bf16 v[176:179], a[48:51], v[84:87], v[176:179]
    v_mfma_f32_16x16x32_bf16 v[180:183], a[52:55], v[84:87], v[180:183]
    v_mfma_f32_16x16x32_bf16 v[184:187], a[56:59], v[84:87], v[184:187]
    v_mfma_f32_16x16x32_bf16 v[188:191], a[60:63], v[84:87], v[188:191]
    v_mfma_f32_16x16x32_bf16 v[192:195], a[48:51], v[88:91], v[192:195]
    s_add_u32 m0, s31, 5120
    s_add_u32 s24, s27, 163840
    buffer_load_dwordx4 v245, s[12:15], s24 offen lds
    v_mfma_f32_16x16x32_bf16 v[196:199], a[52:55], v[88:91], v[196:199]
    v_mfma_f32_16x16x32_bf16 v[200:203], a[56:59], v[88:91], v[200:203]
    v_mfma_f32_16x16x32_bf16 v[204:207], a[60:63], v[88:91], v[204:207]
    v_mfma_f32_16x16x32_bf16 v[208:211], a[48:51], v[92:95], v[208:211]
    v_mfma_f32_16x16x32_bf16 v[212:215], a[52:55], v[92:95], v[212:215]
    v_mfma_f32_16x16x32_bf16 v[216:219], a[56:59], v[92:95], v[216:219]
    v_mfma_f32_16x16x32_bf16 v[220:223], a[60:63], v[92:95], v[220:223]
    s_waitcnt lgkmcnt(0)
    v_mfma_f32_16x16x32_bf16 v[160:163], a[64:67], v[64:67], v[160:163]
    ds_read_b128 v[80:83], v225 offset:16384
    v_mfma_f32_16x16x32_bf16 v[164:167], a[68:71], v[64:67], v[164:167]
    ds_read_b128 v[84:87], v225 offset:18432
    v_mfma_f32_16x16x32_bf16 v[168:171], a[72:75], v[64:67], v[168:171]
    ds_read_b128 v[88:91], v225 offset:20480
    v_mfma_f32_16x16x32_bf16 v[172:175], a[76:79], v[64:67], v[172:175]
    ds_read_b128 v[92:95], v225 offset:22528
    v_mfma_f32_16x16x32_bf16 v[176:179], a[64:67], v[68:71], v[176:179]
    v_mfma_f32_16x16x32_bf16 v[180:183], a[68:71], v[68:71], v[180:183]
    v_mfma_f32_16x16x32_bf16 v[184:187], a[72:75], v[68:71], v[184:187]
    v_mfma_f32_16x16x32_bf16 v[188:191], a[76:79], v[68:71], v[188:191]
    s_add_u32 s38, s36, 45056
    buffer_store_dwordx4 v[60:63], v240, s[16:19], s38 offen offset:256 sc1
    v_mfma_f32_16x16x32_bf16 v[192:195], a[64:67], v[72:75], v[192:195]
    s_add_u32 m0, s31, 6144
    s_add_u32 s24, s27, 196608
    buffer_load_dwordx4 v237, s[12:15], s24 offen lds
    v_mfma_f32_16x16x32_bf16 v[196:199], a[68:71], v[72:75], v[196:199]
    v_mfma_f32_16x16x32_bf16 v[200:203], a[72:75], v[72:75], v[200:203]
    v_mfma_f32_16x16x32_bf16 v[204:207], a[76:79], v[72:75], v[204:207]
    v_mfma_f32_16x16x32_bf16 v[208:211], a[64:67], v[76:79], v[208:211]
    v_mfma_f32_16x16x32_bf16 v[212:215], a[68:71], v[76:79], v[212:215]
    v_mfma_f32_16x16x32_bf16 v[216:219], a[72:75], v[76:79], v[216:219]
    v_mfma_f32_16x16x32_bf16 v[220:223], a[76:79], v[76:79], v[220:223]
    s_waitcnt lgkmcnt(0)
    v_mfma_f32_16x16x32_bf16 v[160:163], a[80:83], v[80:83], v[160:163]
    ds_read_b128 v[64:67], v224 offset:24576
    v_mfma_f32_16x16x32_bf16 v[164:167], a[84:87], v[80:83], v[164:167]
    ds_read_b128 v[68:71], v224 offset:26624
    v_mfma_f32_16x16x32_bf16 v[168:171], a[88:91], v[80:83], v[168:171]
    ds_read_b128 v[72:75], v224 offset:28672
    v_mfma_f32_16x16x32_bf16 v[172:175], a[92:95], v[80:83], v[172:175]
    ds_read_b128 v[76:79], v224 offset:30720
    v_mfma_f32_16x16x32_bf16 v[176:179], a[80:83], v[84:87], v[176:179]
    v_mfma_f32_16x16x32_bf16 v[180:183], a[84:87], v[84:87], v[180:183]
    v_mfma_f32_16x16x32_bf16 v[184:187], a[88:91], v[84:87], v[184:187]
    v_mfma_f32_16x16x32_bf16 v[188:191], a[92:95], v[84:87], v[188:191]
    v_mfma_f32_16x16x32_bf16 v[192:195], a[80:83], v[88:91], v[192:195]
    s_add_u32 m0, s31, 7168
    s_add_u32 s24, s27, 229376
    buffer_load_dwordx4 v237, s[12:15], s24 offen lds
    v_mfma_f32_16x16x32_bf16 v[196:199], a[84:87], v[88:91], v[196:199]
    v_mfma_f32_16x16x32_bf16 v[200:203], a[88:91], v[88:91], v[200:203]
    s_add_u32 s27, s27, 1048576
    s_and_b32 s27, s27, 0x407fffff
    s_cmp_eq_u32 s27, s7
    s_cselect_b32 s27, s43, s27
    v_mfma_f32_16x16x32_bf16 v[204:207], a[92:95], v[88:91], v[204:207]
    v_mfma_f32_16x16x32_bf16 v[208:211], a[80:83], v[92:95], v[208:211]
    v_mfma_f32_16x16x32_bf16 v[212:215], a[84:87], v[92:95], v[212:215]
    s_add_u32 s31, s31, 32768
    s_cmp_ge_u32 s31, 163840
    s_cselect_b32 s24, 98304, 0
    s_sub_u32 s31, s31, s24
    s_add_u32 s38, s36, 65536
    buffer_store_dwordx4 v[0:3], v240, s[16:19], s38 offen offset:2560 sc1
    v_mfma_f32_16x16x32_bf16 v[216:219], a[88:91], v[92:95], v[216:219]
    v_mfma_f32_16x16x32_bf16 v[220:223], a[92:95], v[92:95], v[220:223]
    s_waitcnt lgkmcnt(0)
    v_mfma_f32_16x16x32_bf16 v[160:163], a[96:99], v[64:67], v[160:163]
    ds_read_b128 v[80:83], v225 offset:24576
    v_mfma_f32_16x16x32_bf16 v[164:167], a[100:103], v[64:67], v[164:167]
    ds_read_b128 v[84:87], v225 offset:26624
    v_mfma_f32_16x16x32_bf16 v[168:171], a[104:107], v[64:67], v[168:171]
    ds_read_b128 v[88:91], v225 offset:28672
    v_mfma_f32_16x16x32_bf16 v[172:175], a[108:111], v[64:67], v[172:175]
    ds_read_b128 v[92:95], v225 offset:30720
    v_mfma_f32_16x16x32_bf16 v[176:179], a[96:99], v[68:71], v[176:179]
    v_mfma_f32_16x16x32_bf16 v[180:183], a[100:103], v[68:71], v[180:183]
    v_mfma_f32_16x16x32_bf16 v[184:187], a[104:107], v[68:71], v[184:187]
    v_mfma_f32_16x16x32_bf16 v[188:191], a[108:111], v[68:71], v[188:191]
    v_mfma_f32_16x16x32_bf16 v[192:195], a[96:99], v[72:75], v[192:195]
    v_mfma_f32_16x16x32_bf16 v[196:199], a[100:103], v[72:75], v[196:199]
    v_mfma_f32_16x16x32_bf16 v[200:203], a[104:107], v[72:75], v[200:203]
    v_mfma_f32_16x16x32_bf16 v[204:207], a[108:111], v[72:75], v[204:207]
    v_mfma_f32_16x16x32_bf16 v[208:211], a[96:99], v[76:79], v[208:211]
    v_mfma_f32_16x16x32_bf16 v[212:215], a[100:103], v[76:79], v[212:215]
    v_mfma_f32_16x16x32_bf16 v[216:219], a[104:107], v[76:79], v[216:219]
    v_mfma_f32_16x16x32_bf16 v[220:223], a[108:111], v[76:79], v[220:223]
    s_waitcnt vmcnt(9) lgkmcnt(0)
    s_barrier
    v_mfma_f32_16x16x32_bf16 v[160:163], a[112:115], v[80:83], v[160:163]
    ds_read_b128 v[64:67], v224 offset:32768
    v_mfma_f32_16x16x32_bf16 v[164:167], a[116:119], v[80:83], v[164:167]
    ds_read_b128 v[68:71], v224 offset:34816
    v_mfma_f32_16x16x32_bf16 v[168:171], a[120:123], v[80:83], v[168:171]
    ds_read_b128 v[72:75], v224 offset:36864
    s_add_u32 s38, s36, 69632
    buffer_store_dwordx4 v[4:7], v240, s[16:19], s38 offen offset:512 sc1
    v_mfma_f32_16x16x32_bf16 v[172:175], a[124:127], v[80:83], v[172:175]
    ds_read_b128 v[76:79], v224 offset:38912
    v_mfma_f32_16x16x32_bf16 v[176:179], a[112:115], v[84:87], v[176:179]
    v_mfma_f32_16x16x32_bf16 v[180:183], a[116:119], v[84:87], v[180:183]
    v_mfma_f32_16x16x32_bf16 v[184:187], a[120:123], v[84:87], v[184:187]
    v_mfma_f32_16x16x32_bf16 v[188:191], a[124:127], v[84:87], v[188:191]
    v_mfma_f32_16x16x32_bf16 v[192:195], a[112:115], v[88:91], v[192:195]
    v_mfma_f32_16x16x32_bf16 v[196:199], a[116:119], v[88:91], v[196:199]
    v_mfma_f32_16x16x32_bf16 v[200:203], a[120:123], v[88:91], v[200:203]
    v_mfma_f32_16x16x32_bf16 v[204:207], a[124:127], v[88:91], v[204:207]
    v_mfma_f32_16x16x32_bf16 v[208:211], a[112:115], v[92:95], v[208:211]
    v_mfma_f32_16x16x32_bf16 v[212:215], a[116:119], v[92:95], v[212:215]
    v_mfma_f32_16x16x32_bf16 v[216:219], a[120:123], v[92:95], v[216:219]
    v_mfma_f32_16x16x32_bf16 v[220:223], a[124:127], v[92:95], v[220:223]
    s_waitcnt lgkmcnt(0)
    v_mfma_f32_16x16x32_bf16 v[160:163], a[128:131], v[64:67], v[160:163]
    ds_read_b128 v[80:83], v225 offset:32768
    v_mfma_f32_16x16x32_bf16 v[164:167], a[132:135], v[64:67], v[164:167]
    ds_read_b128 v[84:87], v225 offset:34816
    v_mfma_f32_16x16x32_bf16 v[168:171], a[136:139], v[64:67], v[168:171]
    ds_read_b128 v[88:91], v225 offset:36864
    v_mfma_f32_16x16x32_bf16 v[172:175], a[140:143], v[64:67], v[172:175]
    ds_read_b128 v[92:95], v225 offset:38912
    v_mfma_f32_16x16x32_bf16 v[176:179], a[128:131], v[68:71], v[176:179]
    v_mfma_f32_16x16x32_bf16 v[180:183], a[132:135], v[68:71], v[180:183]
    v_mfma_f32_16x16x32_bf16 v[184:187], a[136:139], v[68:71], v[184:187]
    v_mfma_f32_16x16x32_bf16 v[188:191], a[140:143], v[68:71], v[188:191]
    v_mfma_f32_16x16x32_bf16 v[192:195], a[128:131], v[72:75], v[192:195]
    buffer_load_dword v254, off, s[88:91], s39 sc1
    s_add_u32 s38, s36, 65536
    buffer_store_dwordx4 v[8:11], v240, s[16:19], s38 offen offset:3584 sc1
    v_mfma_f32_16x16x32_bf16 v[196:199], a[132:135], v[72:75], v[196:199]
    v_mfma_f32_16x16x32_bf16 v[200:203], a[136:139], v[72:75], v[200:203]
    v_mfma_f32_16x16x32_bf16 v[204:207], a[140:143], v[72:75], v[204:207]
    v_mfma_f32_16x16x32_bf16 v[208:211], a[128:131], v[76:79], v[208:211]
    v_mfma_f32_16x16x32_bf16 v[212:215], a[132:135], v[76:79], v[212:215]
    v_mfma_f32_16x16x32_bf16 v[216:219], a[136:139], v[76:79], v[216:219]
    v_mfma_f32_16x16x32_bf16 v[220:223], a[140:143], v[76:79], v[220:223]
    s_waitcnt lgkmcnt(0)
    v_mfma_f32_16x16x32_bf16 v[160:163], a[144:147], v[80:83], v[160:163]
    ds_read_b128 v[64:67], v224 offset:40960
    v_mfma_f32_16x16x32_bf16 v[164:167], a[148:151], v[80:83], v[164:167]
    ds_read_b128 v[68:71], v224 offset:43008
    v_mfma_f32_16x16x32_bf16 v[168:171], a[152:155], v[80:83], v[168:171]
    ds_read_b128 v[72:75], v224 offset:45056
    v_mfma_f32_16x16x32_bf16 v[172:175], a[156:159], v[80:83], v[172:175]
    ds_read_b128 v[76:79], v224 offset:47104
    v_mfma_f32_16x16x32_bf16 v[176:179], a[144:147], v[84:87], v[176:179]
    v_mfma_f32_16x16x32_bf16 v[180:183], a[148:151], v[84:87], v[180:183]
    v_mfma_f32_16x16x32_bf16 v[184:187], a[152:155], v[84:87], v[184:187]
    v_mfma_f32_16x16x32_bf16 v[188:191], a[156:159], v[84:87], v[188:191]
    v_mfma_f32_16x16x32_bf16 v[192:195], a[144:147], v[88:91], v[192:195]
    v_mfma_f32_16x16x32_bf16 v[196:199], a[148:151], v[88:91], v[196:199]
    v_mfma_f32_16x16x32_bf16 v[200:203], a[152:155], v[88:91], v[200:203]
    v_mfma_f32_16x16x32_bf16 v[204:207], a[156:159], v[88:91], v[204:207]
    v_mfma_f32_16x16x32_bf16 v[208:211], a[144:147], v[92:95], v[208:211]
    v_mfma_f32_16x16x32_bf16 v[212:215], a[148:151], v[92:95], v[212:215]
    s_add_u32 s38, s36, 69632
    buffer_store_dwordx4 v[12:15], v240, s[16:19], s38 offen offset:1536 sc1
    v_mfma_f32_16x16x32_bf16 v[216:219], a[152:155], v[92:95], v[216:219]
    v_mfma_f32_16x16x32_bf16 v[220:223], a[156:159], v[92:95], v[220:223]
    s_waitcnt lgkmcnt(0)
    v_mfma_f32_16x16x32_bf16 v[160:163], a[160:163], v[64:67], v[160:163]
    ds_read_b128 v[80:83], v225 offset:40960
    v_mfma_f32_16x16x32_bf16 v[164:167], a[164:167], v[64:67], v[164:167]
    ds_read_b128 v[84:87], v225 offset:43008
    v_mfma_f32_16x16x32_bf16 v[168:171], a[168:171], v[64:67], v[168:171]
    ds_read_b128 v[88:91], v225 offset:45056
    v_mfma_f32_16x16x32_bf16 v[172:175], a[172:175], v[64:67], v[172:175]
    ds_read_b128 v[92:95], v225 offset:47104
    v_mfma_f32_16x16x32_bf16 v[176:179], a[160:163], v[68:71], v[176:179]
    v_mfma_f32_16x16x32_bf16 v[180:183], a[164:167], v[68:71], v[180:183]
    v_mfma_f32_16x16x32_bf16 v[184:187], a[168:171], v[68:71], v[184:187]
    v_mfma_f32_16x16x32_bf16 v[188:191], a[172:175], v[68:71], v[188:191]
    v_mfma_f32_16x16x32_bf16 v[192:195], a[160:163], v[72:75], v[192:195]
    v_mfma_f32_16x16x32_bf16 v[196:199], a[164:167], v[72:75], v[196:199]
    v_mfma_f32_16x16x32_bf16 v[200:203], a[168:171], v[72:75], v[200:203]
    v_mfma_f32_16x16x32_bf16 v[204:207], a[172:175], v[72:75], v[204:207]
    v_mfma_f32_16x16x32_bf16 v[208:211], a[160:163], v[76:79], v[208:211]
    v_mfma_f32_16x16x32_bf16 v[212:215], a[164:167], v[76:79], v[212:215]
    v_mfma_f32_16x16x32_bf16 v[216:219], a[168:171], v[76:79], v[216:219]
    v_mfma_f32_16x16x32_bf16 v[220:223], a[172:175], v[76:79], v[220:223]
    s_waitcnt lgkmcnt(0)
    v_mfma_f32_16x16x32_bf16 v[160:163], a[176:179], v[80:83], v[160:163]
    ds_read_b128 v[64:67], v224 offset:49152
    v_mfma_f32_16x16x32_bf16 v[164:167], a[180:183], v[80:83], v[164:167]
    ds_read_b128 v[68:71], v224 offset:51200
    v_mfma_f32_16x16x32_bf16 v[168:171], a[184:187], v[80:83], v[168:171]
    ds_read_b128 v[72:75], v224 offset:53248
    v_mfma_f32_16x16x32_bf16 v[172:175], a[188:191], v[80:83], v[172:175]
    ds_read_b128 v[76:79], v224 offset:55296
    s_add_u32 s38, s36, 73728
    buffer_store_dwordx4 v[16:19], v240, s[16:19], s38 offen offset:2560 sc1
    v_mfma_f32_16x16x32_bf16 v[176:179], a[176:179], v[84:87], v[176:179]
    v_mfma_f32_16x16x32_bf16 v[180:183], a[180:183], v[84:87], v[180:183]
    v_mfma_f32_16x16x32_bf16 v[184:187], a[184:187], v[84:87], v[184:187]
    v_mfma_f32_16x16x32_bf16 v[188:191], a[188:191], v[84:87], v[188:191]
    v_mfma_f32_16x16x32_bf16 v[192:195], a[176:179], v[88:91], v[192:195]
    v_mfma_f32_16x16x32_bf16 v[196:199], a[180:183], v[88:91], v[196:199]
    v_mfma_f32_16x16x32_bf16 v[200:203], a[184:187], v[88:91], v[200:203]
    v_mfma_f32_16x16x32_bf16 v[204:207], a[188:191], v[88:91], v[204:207]
    v_mfma_f32_16x16x32_bf16 v[208:211], a[176:179], v[92:95], v[208:211]
    v_mfma_f32_16x16x32_bf16 v[212:215], a[180:183], v[92:95], v[212:215]
    v_mfma_f32_16x16x32_bf16 v[216:219], a[184:187], v[92:95], v[216:219]
    v_mfma_f32_16x16x32_bf16 v[220:223], a[188:191], v[92:95], v[220:223]
    s_waitcnt vmcnt(3)
    v_readfirstlane_b32 s24, v254
    s_lshl_b32 s25, s3, 16
    s_add_u32 s24, s24, s25
    s_cmp_ge_u32 s24, 32
    s_cbranch_scc0 kf_spin33
kf_spinr34:
    s_waitcnt lgkmcnt(0)
    s_barrier
    v_mfma_f32_16x16x32_bf16 v[160:163], a[192:195], v[64:67], v[160:163]
    ds_read_b128 v[80:83], v225 offset:49152
    v_mfma_f32_16x16x32_bf16 v[164:167], a[196:199], v[64:67], v[164:167]
    ds_read_b128 v[84:87], v225 offset:51200
    v_mfma_f32_16x16x32_bf16 v[168:171], a[200:203], v[64:67], v[168:171]
    ds_read_b128 v[88:91], v225 offset:53248
    v_mfma_f32_16x16x32_bf16 v[172:175], a[204:207], v[64:67], v[172:175]
    ds_read_b128 v[92:95], v225 offset:55296
    v_mfma_f32_16x16x32_bf16 v[176:179], a[192:195], v[68:71], v[176:179]
    v_mfma_f32_16x16x32_bf16 v[180:183], a[196:199], v[68:71], v[180:183]
    v_mfma_f32_16x16x32_bf16 v[184:187], a[200:203], v[68:71], v[184:187]
    v_mfma_f32_16x16x32_bf16 v[188:191], a[204:207], v[68:71], v[188:191]
    v_mfma_f32_16x16x32_bf16 v[192:195], a[192:195], v[72:75], v[192:195]
    buffer_load_dwordx4 a[128:131], v248, s[8:11], s28 offen offset:0 sc1
    s_add_u32 s38, s36, 77824
    buffer_store_dwordx4 v[20:23], v240, s[16:19], s38 offen offset:512 sc1
    v_mfma_f32_16x16x32_bf16 v[196:199], a[196:199], v[72:75], v[196:199]
    v_mfma_f32_16x16x32_bf16 v[200:203], a[200:203], v[72:75], v[200:203]
    buffer_load_dwordx4 a[132:135], v248, s[8:11], s29 offen offset:0 sc1
    v_mfma_f32_16x16x32_bf16 v[204:207], a[204:207], v[72:75], v[204:207]
    v_mfma_f32_16x16x32_bf16 v[208:211], a[192:195], v[76:79], v[208:211]
    v_mfma_f32_16x16x32_bf16 v[212:215], a[196:199], v[76:79], v[212:215]
    buffer_load_dwordx4 a[136:139], v249, s[8:11], s28 offen offset:0 sc1
    v_mfma_f32_16x16x32_bf16 v[216:219], a[200:203], v[76:79], v[216:219]
    v_mfma_f32_16x16x32_bf16 v[220:223], a[204:207], v[76:79], v[220:223]
    s_waitcnt lgkmcnt(0)
    v_mfma_f32_16x16x32_bf16 v[160:163], a[208:211], v[80:83], v[160:163]
    ds_read_b128 v[64:67], v224 offset:57344
    v_mfma_f32_16x16x32_bf16 v[164:167], a[212:215], v[80:83], v[164:167]
    ds_read_b128 v[68:71], v224 offset:59392
    v_mfma_f32_16x16x32_bf16 v[168:171], a[216:219], v[80:83], v[168:171]
    ds_read_b128 v[72:75], v224 offset:61440
    v_mfma_f32_16x16x32_bf16 v[172:175], a[220:223], v[80:83], v[172:175]
    ds_read_b128 v[76:79], v224 offset:63488
    v_mfma_f32_16x16x32_bf16 v[176:179], a[208:211], v[84:87], v[176:179]
    v_mfma_f32_16x16x32_bf16 v[180:183], a[212:215], v[84:87], v[180:183]
    v_mfma_f32_16x16x32_bf16 v[184:187], a[216:219], v[84:87], v[184:187]
    v_mfma_f32_16x16x32_bf16 v[188:191], a[220:223], v[84:87], v[188:191]
    v_mfma_f32_16x16x32_bf16 v[192:195], a[208:211], v[88:91], v[192:195]
    buffer_load_dwordx4 a[140:143], v249, s[8:11], s29 offen offset:0 sc1
    v_mfma_f32_16x16x32_bf16 v[196:199], a[212:215], v[88:91], v[196:199]
    v_mfma_f32_16x16x32_bf16 v[200:203], a[216:219], v[88:91], v[200:203]
    buffer_load_dwordx4 a[144:147], v248, s[8:11], s28 offen offset:1024 sc1
    v_mfma_f32_16x16x32_bf16 v[204:207], a[220:223], v[88:91], v[204:207]
    v_mfma_f32_16x16x32_bf16 v[208:211], a[208:211], v[92:95], v[208:211]
    v_mfma_f32_16x16x32_bf16 v[212:215], a[212:215], v[92:95], v[212:215]
    buffer_load_dwordx4 a[148:151], v248, s[8:11], s29 offen offset:1024 sc1
    v_mfma_f32_16x16x32_bf16 v[216:219], a[216:219], v[92:95], v[216:219]
    s_add_u32 s38, s36, 73728
    buffer_store_dwordx4 v[24:27], v240, s[16:19], s38 offen offset:3584 sc1
    v_mfma_f32_16x16x32_bf16 v[220:223], a[220:223], v[92:95], v[220:223]
    s_waitcnt lgkmcnt(0)
    v_mfma_f32_16x16x32_bf16 v[160:163], a[224:227], v[64:67], v[160:163]
    ds_read_b128 v[80:83], v225 offset:57344
    v_mfma_f32_16x16x32_bf16 v[164:167], a[228:231], v[64:67], v[164:167]
    ds_read_b128 v[84:87], v225 offset:59392
    v_mfma_f32_16x16x32_bf16 v[168:171], a[232:235], v[64:67], v[168:171]
    ds_read_b128 v[88:91], v225 offset:61440
    v_mfma_f32_16x16x32_bf16 v[172:175], a[236:239], v[64:67], v[172:175]
    ds_read_b128 v[92:95], v225 offset:63488
    v_mfma_f32_16x16x32_bf16 v[176:179], a[224:227], v[68:71], v[176:179]
    v_mfma_f32_16x16x32_bf16 v[180:183], a[228:231], v[68:71], v[180:183]
    v_mfma_f32_16x16x32_bf16 v[184:187], a[232:235], v[68:71], v[184:187]
    v_mfma_f32_16x16x32_bf16 v[188:191], a[236:239], v[68:71], v[188:191]
    v_mfma_f32_16x16x32_bf16 v[192:195], a[224:227], v[72:75], v[192:195]
    buffer_load_dwordx4 a[152:155], v249, s[8:11], s28 offen offset:1024 sc1
    v_mfma_f32_16x16x32_bf16 v[196:199], a[228:231], v[72:75], v[196:199]
    v_mfma_f32_16x16x32_bf16 v[200:203], a[232:235], v[72:75], v[200:203]
    buffer_load_dwordx4 a[156:159], v249, s[8:11], s29 offen offset:1024 sc1
    v_mfma_f32_16x16x32_bf16 v[204:207], a[236:239], v[72:75], v[204:207]
    v_mfma_f32_16x16x32_bf16 v[208:211], a[224:227], v[76:79], v[208:211]
    v_mfma_f32_16x16x32_bf16 v[212:215], a[228:231], v[76:79], v[212:215]
    buffer_load_dwordx4 a[160:163], v248, s[8:11], s28 offen offset:2048 sc1
    v_mfma_f32_16x16x32_bf16 v[216:219], a[232:235], v[76:79], v[216:219]
    v_mfma_f32_16x16x32_bf16 v[220:223], a[236:239], v[76:79], v[220:223]
    s_waitcnt vmcnt(38) lgkmcnt(0)
    s_barrier
    v_mfma_f32_16x16x32_bf16 v[160:163], a[240:243], v[80:83], v[160:163]
    ds_read_b64_tr_b16 a[192:193], v246 offset:0
    v_mfma_f32_16x16x32_bf16 v[164:167], a[244:247], v[80:83], v[164:167]
    ds_read_b64_tr_b16 a[194:195], v246 offset:1024
    v_mfma_f32_16x16x32_bf16 v[168:171], a[248:251], v[80:83], v[168:171]
    ds_read_b64_tr_b16 a[196:197], v238 offset:0
    v_mfma_f32_16x16x32_bf16 v[172:175], a[252:255], v[80:83], v[172:175]
    ds_read_b64_tr_b16 a[198:199], v238 offset:1024
    v_mfma_f32_16x16x32_bf16 v[176:179], a[240:243], v[84:87], v[176:179]
    ds_read_b64_tr_b16 a[200:201], v246 offset:256
    s_add_u32 s38, s36, 77824
    buffer_store_dwordx4 v[28:31], v240, s[16:19], s38 offen offset:1536 sc1
    v_mfma_f32_16x16x32_bf16 v[180:183], a[244:247], v[84:87], v[180:183]
    ds_read_b64_tr_b16 a[202:203], v246 offset:1280
    v_mfma_f32_16x16x32_bf16 v[184:187], a[248:251], v[84:87], v[184:187]
    ds_read_b64_tr_b16 a[204:205], v238 offset:256
    v_mfma_f32_16x16x32_bf16 v[188:191], a[252:255], v[84:87], v[188:191]
    ds_read_b64_tr_b16 a[206:207], v238 offset:1280
    v_mfma_f32_16x16x32_bf16 v[192:195], a[240:243], v[88:91], v[192:195]
    buffer_load_dwordx4 a[164:167], v248, s[8:11], s29 offen offset:2048 sc1
    v_mfma_f32_16x16x32_bf16 v[196:199], a[244:247], v[88:91], v[196:199]
    v_cvt_pk_bf16_f32 v32, v160, v161
    v_cvt_pk_bf16_f32 v33, v162, v163
    v_mfma_f32_16x16x32_bf16 v[200:203], a[248:251], v[88:91], v[200:203]
    buffer_load_dwordx4 a[168:171], v249, s[8:11], s28 offen offset:2048 sc1
    v_cvt_pk_bf16_f32 v34, v164, v165
    v_cvt_pk_bf16_f32 v35, v166, v167
    v_mfma_f32_16x16x32_bf16 v[204:207], a[252:255], v[88:91], v[204:207]
    v_cvt_pk_bf16_f32 v36, v168, v169
    v_cvt_pk_bf16_f32 v37, v170, v171
    v_mfma_f32_16x16x32_bf16 v[208:211], a[240:243], v[92:95], v[208:211]
    v_cvt_pk_bf16_f32 v38, v172, v173
    v_cvt_pk_bf16_f32 v39, v174, v175
    v_mfma_f32_16x16x32_bf16 v[212:215], a[244:247], v[92:95], v[212:215]
    buffer_load_dwordx4 a[172:175], v249, s[8:11], s29 offen offset:2048 sc1
    v_cvt_pk_bf16_f32 v40, v176, v177
    v_cvt_pk_bf16_f32 v41, v178, v179
    v_mfma_f32_16x16x32_bf16 v[216:219], a[248:251], v[92:95], v[216:219]
    v_cvt_pk_bf16_f32 v42, v180, v181
    v_cvt_pk_bf16_f32 v43, v182, v183
    v_mfma_f32_16x16x32_bf16 v[220:223], a[252:255], v[92:95], v[220:223]
    v_cvt_pk_bf16_f32 v44, v184, v185
    v_cvt_pk_bf16_f32 v45, v186, v187
    s_nop 3
    v_cvt_pk_bf16_f32 v46, v188, v189
    v_cvt_pk_bf16_f32 v47, v190, v191
    v_cvt_pk_bf16_f32 v48, v192, v193
    v_cvt_pk_bf16_f32 v49, v194, v195
    v_cvt_pk_bf16_f32 v50, v196, v197
    v_cvt_pk_bf16_f32 v51, v198, v199
    v_cvt_pk_bf16_f32 v52, v200, v201
    v_cvt_pk_bf16_f32 v53, v202, v203
    v_cvt_pk_bf16_f32 v54, v204, v205
    v_cvt_pk_bf16_f32 v55, v206, v207
    v_cvt_pk_bf16_f32 v56, v208, v209
    v_cvt_pk_bf16_f32 v57, v210, v211
    v_cvt_pk_bf16_f32 v58, v212, v213
    v_cvt_pk_bf16_f32 v59, v214, v215
    v_cvt_pk_bf16_f32 v60, v216, v217
    v_cvt_pk_bf16_f32 v61, v218, v219
    v_cvt_pk_bf16_f32 v62, v220, v221
    v_cvt_pk_bf16_f32 v63, v222, v223
    s_add_u32 s80, s36, 102144
    s_add_u32 s81, s36, 104192
    s_add_u32 s82, s36, 103168
    s_add_u32 s83, s36, 105216
    s_add_u32 s84, s36, 110336
    s_add_u32 s85, s36, 112384
    s_add_u32 s86, s36, 111360
    s_add_u32 s87, s36, 113408
    s_branch ka_Q
ka_V:
    s_waitcnt lgkmcnt(0)
    v_mfma_f32_16x16x32_bf16 v[96:99], v[64:67], a[0:3], 0
    ds_read_b128 v[80:83], v224 offset:8192
    v_mfma_f32_16x16x32_bf16 v[100:103], v[68:71], a[0:3], 0
    ds_read_b128 v[84:87], v224 offset:10240
    v_mfma_f32_16x16x32_bf16 v[104:107], v[64:67], a[4:7], 0
    ds_read_b128 v[88:91], v224 offset:12288
    v_mfma_f32_16x16x32_bf16 v[108:111], v[68:71], a[4:7], 0
    ds_read_b128 v[92:95], v224 offset:14336
    v_mfma_f32_16x16x32_bf16 v[112:115], v[64:67], a[8:11], 0
    ds_read_b64_tr_b16 a[16:17], v228 offset:4096
    v_mfma_f32_16x16x32_bf16 v[116:119], v[68:71], a[8:11], 0
    ds_read_b64_tr_b16 a[18:19], v228 offset:4608
    v_mfma_f32_16x16x32_bf16 v[120:123], v[64:67], a[12:15], 0
    ds_read_b64_tr_b16 a[20:21], v229 offset:4096
    v_mfma_f32_16x16x32_bf16 v[124:127], v[68:71], a[12:15], 0
    ds_read_b64_tr_b16 a[22:23], v229 offset:4608
    v_mfma_f32_16x16x32_bf16 v[128:131], v[72:75], a[0:3], 0
    s_add_u32 m0, s35, 16384
    s_and_b32 s33, s82, 1023
    s_lshl_b32 s33, s33, 12
    buffer_load_dwordx4 v234, s[48:51], s33 offen lds
    v_mfma_f32_16x16x32_bf16 v[132:135], v[76:79], a[0:3], 0
    buffer_load_dwordx4 v235, s[48:51], s33 offen offset:1024 lds
    v_mfma_f32_16x16x32_bf16 v[136:139], v[72:75], a[4:7], 0
    s_add_u32 m0, s35, 18432
    s_add_u32 s33, s33, 131072
    buffer_load_dwordx4 v234, s[48:51], s33 offen lds
    v_mfma_f32_16x16x32_bf16 v[140:143], v[76:79], a[4:7], 0
    v_mfma_f32_16x16x32_bf16 v[144:147], v[72:75], a[8:11], 0
    buffer_load_dwordx4 v235, s[48:51], s33 offen offset:1024 lds
    v_mfma_f32_16x16x32_bf16 v[148:151], v[76:79], a[8:11], 0
    buffer_load_dwordx4 v[0:3], v236, s[52:55], 0 offen offset:0
    v_mfma_f32_16x16x32_bf16 v[152:155], v[72:75], a[12:15], 0
    buffer_load_dwordx4 v[4:7], v236, s[52:55], 0 offen offset:512
    v_mfma_f32_16x16x32_bf16 v[156:159], v[76:79], a[12:15], 0
    s_waitcnt lgkmcnt(0)
    v_mfma_f32_16x16x32_bf16 v[160:163], v[80:83], a[0:3], 0
    ds_read_b128 v[64:67], v225 offset:0
    v_mfma_f32_16x16x32_bf16 v[164:167], v[84:87], a[0:3], 0
    ds_read_b128 v[68:71], v225 offset:2048
    v_mfma_f32_16x16x32_bf16 v[168:171], v[80:83], a[4:7], 0
    ds_read_b128 v[72:75], v225 offset:4096
    v_mfma_f32_16x16x32_bf16 v[172:175], v[84:87], a[4:7], 0
    ds_read_b128 v[76:79], v225 offset:6144
    v_mfma_f32_16x16x32_bf16 v[176:179], v[80:83], a[8:11], 0
    ds_read_b64_tr_b16 a[24:25], v230 offset:4096
    v_mfma_f32_16x16x32_bf16 v[180:183], v[84:87], a[8:11], 0
    ds_read_b64_tr_b16 a[26:27], v230 offset:4608
    v_mfma_f32_16x16x32_bf16 v[184:187], v[80:83], a[12:15], 0
    ds_read_b64_tr_b16 a[28:29], v231 offset:4096
    v_mfma_f32_16x16x32_bf16 v[188:191], v[84:87], a[12:15], 0
    ds_read_b64_tr_b16 a[30:31], v231 offset:4608
    v_mfma_f32_16x16x32_bf16 v[192:195], v[88:91], a[0:3], 0
    s_add_u32 m0, s35, 20480
    s_add_u32 s33, s33, 131072
    buffer_load_dwordx4 v234, s[48:51], s33 offen lds
    v_mfma_f32_16x16x32_bf16 v[196:199], v[92:95], a[0:3], 0
    buffer_load_dwordx4 v235, s[48:51], s33 offen offset:1024 lds
    v_mfma_f32_16x16x32_bf16 v[200:203], v[88:91], a[4:7], 0
    s_add_u32 m0, s35, 22528
    s_add_u32 s33, s33, 131072
    buffer_load_dwordx4 v234, s[48:51], s33 offen lds
    v_mfma_f32_16x16x32_bf16 v[204:207], v[92:95], a[4:7], 0
    v_mfma_f32_16x16x32_bf16 v[208:211], v[88:91], a[8:11], 0
    buffer_load_dwordx4 v235, s[48:51], s33 offen offset:1024 lds
    v_mfma_f32_16x16x32_bf16 v[212:215], v[92:95], a[8:11], 0
    buffer_load_dwordx4 v[8:11], v236, s[52:55], 0 offen offset:1024
    v_mfma_f32_16x16x32_bf16 v[216:219], v[88:91], a[12:15], 0
    buffer_load_dwordx4 v[12:15], v236, s[52:55], 0 offen offset:1536
    v_mfma_f32_16x16x32_bf16 v[220:223], v[92:95], a[12:15], 0
    s_waitcnt vmcnt(17) lgkmcnt(0)
    v_mfma_f32_16x16x32_bf16 v[96:99], v[64:67], a[16:19], v[96:99]
    ds_read_b128 v[80:83], v225 offset:8192
    v_mfma_f32_16x16x32_bf16 v[100:103], v[68:71], a[16:19], v[100:103]
    ds_read_b128 v[84:87], v225 offset:10240
    v_mfma_f32_16x16x32_bf16 v[104:107], v[64:67], a[20:23], v[104:107]
    ds_read_b128 v[88:91], v225 offset:12288
    v_mfma_f32_16x16x32_bf16 v[108:111], v[68:71], a[20:23], v[108:111]
    ds_read_b128 v[92:95], v225 offset:14336
    v_mfma_f32_16x16x32_bf16 v[112:115], v[64:67], a[24:27], v[112:115]
    ds_read_b64_tr_b16 a[32:33], v228 offset:8192
    v_mfma_f32_16x16x32_bf16 v[116:119], v[68:71], a[24:27], v[116:119]
    ds_read_b64_tr_b16 a[34:35], v228 offset:8704
    v_mfma_f32_16x16x32_bf16 v[120:123], v[64:67], a[28:31], v[120:123]
    ds_read_b64_tr_b16 a[36:37], v229 offset:8192
    v_mfma_f32_16x16x32_bf16 v[124:127], v[68:71], a[28:31], v[124:127]
    ds_read_b64_tr_b16 a[38:39], v229 offset:8704
    v_mfma_f32_16x16x32_bf16 v[128:131], v[72:75], a[16:19], v[128:131]
    s_add_u32 m0, s34, 32768
    s_add_u32 s37, s82, 0
    buffer_load_dwordx4 v232, s[44:47], s37 offen lds
    v_mfma_f32_16x16x32_bf16 v[132:135], v[76:79], a[16:19], v[132:135]
    buffer_load_dwordx4 v233, s[44:47], s37 offen offset:1024 lds
    v_mfma_f32_16x16x32_bf16 v[136:139], v[72:75], a[20:23], v[136:139]
    s_add_u32 m0, s34, 40960
    s_add_u32 s37, s82, 65536
    buffer_load_dwordx4 v232, s[44:47], s37 offen lds
    v_mfma_f32_16x16x32_bf16 v[140:143], v[76:79], a[20:23], v[140:143]
    buffer_load_dwordx4 v233, s[44:47], s37 offen offset:1024 lds
    v_mfma_f32_16x16x32_bf16 v[144:147], v[72:75], a[24:27], v[144:147]
    s_add_u32 m0, s35, 0
    s_and_b32 s33, s83, 1023
    s_lshl_b32 s33, s33, 12
    buffer_load_dwordx4 v234, s[48:51], s33 offen lds
    v_mfma_f32_16x16x32_bf16 v[148:151], v[76:79], a[24:27], v[148:151]
    buffer_load_dwordx4 v235, s[48:51], s33 offen offset:1024 lds
    v_mfma_f32_16x16x32_bf16 v[152:155], v[72:75], a[28:31], v[152:155]
    s_add_u32 m0, s35, 2048
    s_add_u32 s33, s33, 131072
    buffer_load_dwordx4 v234, s[48:51], s33 offen lds
    v_mfma_f32_16x16x32_bf16 v[156:159], v[76:79], a[28:31], v[156:159]
    buffer_load_dwordx4 v235, s[48:51], s33 offen offset:1024 lds
    s_waitcnt vmcnt(21) lgkmcnt(0)
    s_barrier
    v_mfma_f32_16x16x32_bf16 v[160:163], v[80:83], a[16:19], v[160:163]
    ds_read_b128 v[64:67], v224 offset:16384
    v_mfma_f32_16x16x32_bf16 v[164:167], v[84:87], a[16:19], v[164:167]
    ds_read_b128 v[68:71], v224 offset:18432
    v_mfma_f32_16x16x32_bf16 v[168:171], v[80:83], a[20:23], v[168:171]
    ds_read_b128 v[72:75], v224 offset:20480
    v_mfma_f32_16x16x32_bf16 v[172:175], v[84:87], a[20:23], v[172:175]
    ds_read_b128 v[76:79], v224 offset:22528
    v_mfma_f32_16x16x32_bf16 v[176:179], v[80:83], a[24:27], v[176:179]
    ds_read_b64_tr_b16 a[40:41], v230 offset:8192
    v_mfma_f32_16x16x32_bf16 v[180:183], v[84:87], a[24:27], v[180:183]
    ds_read_b64_tr_b16 a[42:43], v230 offset:8704
    v_mfma_f32_16x16x32_bf16 v[184:187], v[80:83], a[28:31], v[184:187]
    ds_read_b64_tr_b16 a[44:45], v231 offset:8192
    v_mfma_f32_16x16x32_bf16 v[188:191], v[84:87], a[28:31], v[188:191]
    ds_read_b64_tr_b16 a[46:47], v231 offset:8704
    v_mfma_f32_16x16x32_bf16 v[192:195], v[88:91], a[16:19], v[192:195]
    s_add_u32 m0, s34, 49152
    s_add_u32 s37, s83, 0
    buffer_load_dwordx4 v232, s[44:47], s37 offen lds
    v_mfma_f32_16x16x32_bf16 v[196:199], v[92:95], a[16:19], v[196:199]
    buffer_load_dwordx4 v233, s[44:47], s37 offen offset:1024 lds
    v_mfma_f32_16x16x32_bf16 v[200:203], v[88:91], a[20:23], v[200:203]
    s_add_u32 m0, s34, 57344
    s_add_u32 s37, s83, 65536
    buffer_load_dwordx4 v232, s[44:47], s37 offen lds
    v_mfma_f32_16x16x32_bf16 v[204:207], v[92:95], a[20:23], v[204:207]
    v_mfma_f32_16x16x32_bf16 v[208:211], v[88:91], a[24:27], v[208:211]
    buffer_load_dwordx4 v233, s[44:47], s37 offen offset:1024 lds
    v_mfma_f32_16x16x32_bf16 v[212:215], v[92:95], a[24:27], v[212:215]
    s_add_u32 m0, s34, 0
    s_add_u32 s37, s84, 0
    buffer_load_dwordx4 v232, s[44:47], s37 offen lds
    v_mfma_f32_16x16x32_bf16 v[216:219], v[88:91], a[28:31], v[216:219]
    buffer_load_dwordx4 v233, s[44:47], s37 offen offset:1024 lds
    v_mfma_f32_16x16x32_bf16 v[220:223], v[92:95], a[28:31], v[220:223]
    s_waitcnt lgkmcnt(0)
    v_mfma_f32_16x16x32_bf16 v[96:99], v[64:67], a[32:35], v[96:99]
    ds_read_b128 v[80:83], v224 offset:24576
    v_mfma_f32_16x16x32_bf16 v[100:103], v[68:71], a[32:35], v[100:103]
    ds_read_b128 v[84:87], v224 offset:26624
    v_mfma_f32_16x16x32_bf16 v[104:107], v[64:67], a[36:39], v[104:107]
    ds_read_b128 v[88:91], v224 offset:28672
    v_mfma_f32_16x16x32_bf16 v[108:111], v[68:71], a[36:39], v[108:111]
    ds_read_b128 v[92:95], v224 offset:30720
    v_mfma_f32_16x16x32_bf16 v[112:115], v[64:67], a[40:43], v[112:115]
    ds_read_b64_tr_b16 a[48:49], v228 offset:12288
    v_mfma_f32_16x16x32_bf16 v[116:119], v[68:71], a[40:43], v[116:119]
    ds_read_b64_tr_b16 a[50:51], v228 offset:12800
    v_mfma_f32_16x16x32_bf16 v[120:123], v[64:67], a[44:47], v[120:123]
    ds_read_b64_tr_b16 a[52:53], v229 offset:12288
    v_mfma_f32_16x16x32_bf16 v[124:127], v[68:71], a[44:47], v[124:127]
    ds_read_b64_tr_b16 a[54:55], v229 offset:12800
    v_mfma_f32_16x16x32_bf16 v[128:131], v[72:75], a[32:35], v[128:131]
    s_add_u32 m0, s35, 4096
    s_add_u32 s33, s33, 131072
    buffer_load_dwordx4 v234, s[48:51], s33 offen lds
    v_mfma_f32_16x16x32_bf16 v[132:135], v[76:79], a[32:35], v[132:135]
    v_mfma_f32_16x16x32_bf16 v[136:139], v[72:75], a[36:39], v[136:139]
    buffer_load_dwordx4 v235, s[48:51], s33 offen offset:1024 lds
    v_mfma_f32_16x16x32_bf16 v[140:143], v[76:79], a[36:39], v[140:143]
    v_mfma_f32_16x16x32_bf16 v[144:147], v[72:75], a[40:43], v[144:147]
    s_add_u32 m0, s35, 6144
    s_add_u32 s33, s33, 131072
    buffer_load_dwordx4 v234, s[48:51], s33 offen lds
    v_mfma_f32_16x16x32_bf16 v[148:151], v[76:79], a[40:43], v[148:151]
    v_mfma_f32_16x16x32_bf16 v[152:155], v[72:75], a[44:47], v[152:155]
    buffer_load_dwordx4 v235, s[48:51], s33 offen offset:1024 lds
    v_mfma_f32_16x16x32_bf16 v[156:159], v[76:79], a[44:47], v[156:159]
    s_waitcnt lgkmcnt(0)
    v_mfma_f32_16x16x32_bf16 v[160:163], v[80:83], a[32:35], v[160:163]
    ds_read_b128 v[64:67], v225 offset:16384
    v_mfma_f32_16x16x32_bf16 v[164:167], v[84:87], a[32:35], v[164:167]
    ds_read_b128 v[68:71], v225 offset:18432
    v_mfma_f32_16x16x32_bf16 v[168:171], v[80:83], a[36:39], v[168:171]
    ds_read_b128 v[72:75], v225 offset:20480
    v_mfma_f32_16x16x32_bf16 v[172:175], v[84:87], a[36:39], v[172:175]
    ds_read_b128 v[76:79], v225 offset:22528
    v_mfma_f32_16x16x32_bf16 v[176:179], v[80:83], a[40:43], v[176:179]
    ds_read_b64_tr_b16 a[56:57], v230 offset:12288
    v_mfma_f32_16x16x32_bf16 v[180:183], v[84:87], a[40:43], v[180:183]
    ds_read_b64_tr_b16 a[58:59], v230 offset:12800
    v_mfma_f32_16x16x32_bf16 v[184:187], v[80:83], a[44:47], v[184:187]
    ds_read_b64_tr_b16 a[60:61], v231 offset:12288
    v_mfma_f32_16x16x32_bf16 v[188:191], v[84:87], a[44:47], v[188:191]
    ds_read_b64_tr_b16 a[62:63], v231 offset:12800
    v_mfma_f32_16x16x32_bf16 v[192:195], v[88:91], a[32:35], v[192:195]
    s_add_u32 m0, s34, 8192
    s_add_u32 s37, s84, 65536
    buffer_load_dwordx4 v232, s[44:47], s37 offen lds
    v_mfma_f32_16x16x32_bf16 v[196:199], v[92:95], a[32:35], v[196:199]
    v_mfma_f32_16x16x32_bf16 v[200:203], v[88:91], a[36:39], v[200:203]
    v_mfma_f32_16x16x32_bf16 v[204:207], v[92:95], a[36:39], v[204:207]
    v_mfma_f32_16x16x32_bf16 v[208:211], v[88:91], a[40:43], v[208:211]
    buffer_load_dwordx4 v233, s[44:47], s37 offen offset:1024 lds
    v_mfma_f32_16x16x32_bf16 v[212:215], v[92:95], a[40:43], v[212:215]
    v_mfma_f32_16x16x32_bf16 v[216:219], v[88:91], a[44:47], v[216:219]
    v_mfma_f32_16x16x32_bf16 v[220:223], v[92:95], a[44:47], v[220:223]
    s_waitcnt vmcnt(22) lgkmcnt(0)
    v_mfma_f32_16x16x32_bf16 v[96:99], v[64:67], a[48:51], v[96:99]
    ds_read_b128 v[80:83], v225 offset:24576
    v_mfma_f32_16x16x32_bf16 v[100:103], v[68:71], a[48:51], v[100:103]
    ds_read_b128 v[84:87], v225 offset:26624
    v_mfma_f32_16x16x32_bf16 v[104:107], v[64:67], a[52:55], v[104:107]
    ds_read_b128 v[88:91], v225 offset:28672
    v_mfma_f32_16x16x32_bf16 v[108:111], v[68:71], a[52:55], v[108:111]
    ds_read_b128 v[92:95], v225 offset:30720
    v_mfma_f32_16x16x32_bf16 v[112:115], v[64:67], a[56:59], v[112:115]
    ds_read_b64_tr_b16 a[64:65], v228 offset:16384
    v_mfma_f32_16x16x32_bf16 v[116:119], v[68:71], a[56:59], v[116:119]
    ds_read_b64_tr_b16 a[66:67], v228 offset:16896
    v_mfma_f32_16x16x32_bf16 v[120:123], v[64:67], a[60:63], v[120:123]
    ds_read_b64_tr_b16 a[68:69], v229 offset:16384
    v_mfma_f32_16x16x32_bf16 v[124:127], v[68:71], a[60:63], v[124:127]
    ds_read_b64_tr_b16 a[70:71], v229 offset:16896
    v_mfma_f32_16x16x32_bf16 v[128:131], v[72:75], a[48:51], v[128:131]
    s_add_u32 m0, s35, 8192
    s_and_b32 s33, s84, 1023
    s_lshl_b32 s33, s33, 12
    buffer_load_dwordx4 v234, s[48:51], s33 offen lds
    v_mfma_f32_16x16x32_bf16 v[132:135], v[76:79], a[48:51], v[132:135]
    v_mfma_f32_16x16x32_bf16 v[136:139], v[72:75], a[52:55], v[136:139]
    buffer_load_dwordx4 v235, s[48:51], s33 offen offset:1024 lds
    v_mfma_f32_16x16x32_bf16 v[140:143], v[76:79], a[52:55], v[140:143]
    v_mfma_f32_16x16x32_bf16 v[144:147], v[72:75], a[56:59], v[144:147]
    s_add_u32 m0, s35, 10240
    s_add_u32 s33, s33, 131072
    buffer_load_dwordx4 v234, s[48:51], s33 offen lds
    v_mfma_f32_16x16x32_bf16 v[148:151], v[76:79], a[56:59], v[148:151]
    v_mfma_f32_16x16x32_bf16 v[152:155], v[72:75], a[60:63], v[152:155]
    buffer_load_dwordx4 v235, s[48:51], s33 offen offset:1024 lds
    v_mfma_f32_16x16x32_bf16 v[156:159], v[76:79], a[60:63], v[156:159]
    s_waitcnt vmcnt(20) lgkmcnt(0)
    s_barrier
    v_mfma_f32_16x16x32_bf16 v[160:163], v[80:83], a[48:51], v[160:163]
    ds_read_b128 v[64:67], v224 offset:32768
    v_mfma_f32_16x16x32_bf16 v[164:167], v[84:87], a[48:51], v[164:167]
    ds_read_b128 v[68:71], v224 offset:34816
    v_mfma_f32_16x16x32_bf16 v[168:171], v[80:83], a[52:55], v[168:171]
    ds_read_b128 v[72:75], v224 offset:36864
    v_mfma_f32_16x16x32_bf16 v[172:175], v[84:87], a[52:55], v[172:175]
    ds_read_b128 v[76:79], v224 offset:38912
    v_mfma_f32_16x16x32_bf16 v[176:179], v[80:83], a[56:59], v[176:179]
    ds_read_b64_tr_b16 a[72:73], v230 offset:16384
    v_mfma_f32_16x16x32_bf16 v[180:183], v[84:87], a[56:59], v[180:183]
    ds_read_b64_tr_b16 a[74:75], v230 offset:16896
    v_mfma_f32_16x16x32_bf16 v[184:187], v[80:83], a[60:63], v[184:187]
    ds_read_b64_tr_b16 a[76:77], v231 offset:16384
    v_mfma_f32_16x16x32_bf16 v[188:191], v[84:87], a[60:63], v[188:191]
    ds_read_b64_tr_b16 a[78:79], v231 offset:16896
    v_mfma_f32_16x16x32_bf16 v[192:195], v[88:91], a[48:51], v[192:195]
    s_add_u32 m0, s34, 16384
    s_add_u32 s37, s85, 0
    buffer_load_dwordx4 v232, s[44:47], s37 offen lds
    v_mfma_f32_16x16x32_bf16 v[196:199], v[92:95], a[48:51], v[196:199]
    v_mfma_f32_16x16x32_bf16 v[200:203], v[88:91], a[52:55], v[200:203]
    v_mfma_f32_16x16x32_bf16 v[204:207], v[92:95], a[52:55], v[204:207]
    v_mfma_f32_16x16x32_bf16 v[208:211], v[88:91], a[56:59], v[208:211]
    buffer_load_dwordx4 v233, s[44:47], s37 offen offset:1024 lds
    v_mfma_f32_16x16x32_bf16 v[212:215], v[92:95], a[56:59], v[212:215]
    v_mfma_f32_16x16x32_bf16 v[216:219], v[88:91], a[60:63], v[216:219]
    v_mfma_f32_16x16x32_bf16 v[220:223], v[92:95], a[60:63], v[220:223]
    s_waitcnt lgkmcnt(0)
    v_mfma_f32_16x16x32_bf16 v[96:99], v[64:67], a[64:67], v[96:99]
    ds_read_b128 v[80:83], v224 offset:40960
    s_waitcnt vmcnt(26)
    v_mfma_f32_16x16x32_bf16 v[100:103], v[68:71], a[64:67], v[100:103]
    ds_read_b128 v[84:87], v224 offset:43008
    v_lshlrev_b32 v16, 16, v0
    v_mfma_f32_16x16x32_bf16 v[104:107], v[64:67], a[68:71], v[104:107]
    ds_read_b128 v[88:91], v224 offset:45056
    v_and_b32 v17, 0xffff0000, v0
    v_mfma_f32_16x16x32_bf16 v[108:111], v[68:71], a[68:71], v[108:111]
    ds_read_b128 v[92:95], v224 offset:47104
    v_lshlrev_b32 v18, 16, v1
    v_mfma_f32_16x16x32_bf16 v[112:115], v[64:67], a[72:75], v[112:115]
    ds_read_b64_tr_b16 a[80:81], v228 offset:20480
    v_and_b32 v19, 0xffff0000, v1
    v_mfma_f32_16x16x32_bf16 v[116:119], v[68:71], a[72:75], v[116:119]
    ds_read_b64_tr_b16 a[82:83], v228 offset:20992
    v_lshlrev_b32 v20, 16, v2
    v_mfma_f32_16x16x32_bf16 v[120:123], v[64:67], a[76:79], v[120:123]
    ds_read_b64_tr_b16 a[84:85], v229 offset:20480
    v_and_b32 v21, 0xffff0000, v2
    v_mfma_f32_16x16x32_bf16 v[124:127], v[68:71], a[76:79], v[124:127]
    ds_read_b64_tr_b16 a[86:87], v229 offset:20992
    v_lshlrev_b32 v22, 16, v3
    v_mfma_f32_16x16x32_bf16 v[128:131], v[72:75], a[64:67], v[128:131]
    s_add_u32 m0, s35, 12288
    s_add_u32 s33, s33, 131072
    buffer_load_dwordx4 v234, s[48:51], s33 offen lds
    v_mfma_f32_16x16x32_bf16 v[132:135], v[76:79], a[64:67], v[132:135]
    v_and_b32 v23, 0xffff0000, v3
    v_lshlrev_b32 v24, 16, v4
    v_mfma_f32_16x16x32_bf16 v[136:139], v[72:75], a[68:71], v[136:139]
    buffer_load_dwordx4 v235, s[48:51], s33 offen offset:1024 lds
    v_and_b32 v25, 0xffff0000, v4
    v_mfma_f32_16x16x32_bf16 v[140:143], v[76:79], a[68:71], v[140:143]
    v_lshlrev_b32 v26, 16, v5
    v_and_b32 v27, 0xffff0000, v5
    v_mfma_f32_16x16x32_bf16 v[144:147], v[72:75], a[72:75], v[144:147]
    s_add_u32 m0, s35, 14336
    s_add_u32 s33, s33, 131072
    buffer_load_dwordx4 v234, s[48:51], s33 offen lds
    v_mfma_f32_16x16x32_bf16 v[148:151], v[76:79], a[72:75], v[148:151]
    v_lshlrev_b32 v28, 16, v6
    v_and_b32 v29, 0xffff0000, v6
    v_mfma_f32_16x16x32_bf16 v[152:155], v[72:75], a[76:79], v[152:155]
    buffer_load_dwordx4 v235, s[48:51], s33 offen offset:1024 lds
    v_lshlrev_b32 v30, 16, v7
    v_mfma_f32_16x16x32_bf16 v[156:159], v[76:79], a[76:79], v[156:159]
    v_and_b32 v31, 0xffff0000, v7
    s_waitcnt lgkmcnt(0)
    v_mfma_f32_16x16x32_bf16 v[160:163], v[80:83], a[64:67], v[160:163]
    ds_read_b128 v[64:67], v225 offset:32768
    v_lshlrev_b32 v32, 16, v8
    v_mfma_f32_16x16x32_bf16 v[164:167], v[84:87], a[64:67], v[164:167]
    ds_read_b128 v[68:71], v225 offset:34816
    v_and_b32 v33, 0xffff0000, v8
    v_mfma_f32_16x16x32_bf16 v[168:171], v[80:83], a[68:71], v[168:171]
    ds_read_b128 v[72:75], v225 offset:36864
    v_lshlrev_b32 v34, 16, v9
    v_mfma_f32_16x16x32_bf16 v[172:175], v[84:87], a[68:71], v[172:175]
    ds_read_b128 v[76:79], v225 offset:38912
    v_and_b32 v35, 0xffff0000, v9
    v_mfma_f32_16x16x32_bf16 v[176:179], v[80:83], a[72:75], v[176:179]
    ds_read_b64_tr_b16 a[88:89], v230 offset:20480
    v_lshlrev_b32 v36, 16, v10
    v_mfma_f32_16x16x32_bf16 v[180:183], v[84:87], a[72:75], v[180:183]
    ds_read_b64_tr_b16 a[90:91], v230 offset:20992
    v_and_b32 v37, 0xffff0000, v10
    v_mfma_f32_16x16x32_bf16 v[184:187], v[80:83], a[76:79], v[184:187]
    ds_read_b64_tr_b16 a[92:93], v231 offset:20480
    v_lshlrev_b32 v38, 16, v11
    v_mfma_f32_16x16x32_bf16 v[188:191], v[84:87], a[76:79], v[188:191]
    ds_read_b64_tr_b16 a[94:95], v231 offset:20992
    v_and_b32 v39, 0xffff0000, v11
    v_mfma_f32_16x16x32_bf16 v[192:195], v[88:91], a[64:67], v[192:195]
    s_add_u32 m0, s34, 24576
    s_add_u32 s37, s85, 65536
    buffer_load_dwordx4 v232, s[44:47], s37 offen lds
    v_mfma_f32_16x16x32_bf16 v[196:199], v[92:95], a[64:67], v[196:199]
    v_lshlrev_b32 v40, 16, v12
    v_and_b32 v41, 0xffff0000, v12
    v_mfma_f32_16x16x32_bf16 v[200:203], v[88:91], a[68:71], v[200:203]
    v_lshlrev_b32 v42, 16, v13
    v_and_b32 v43, 0xffff0000, v13
    v_mfma_f32_16x16x32_bf16 v[204:207], v[92:95], a[68:71], v[204:207]
    v_lshlrev_b32 v44, 16, v14
    v_and_b32 v45, 0xffff0000, v14
    v_mfma_f32_16x16x32_bf16 v[208:211], v[88:91], a[72:75], v[208:211]
    buffer_load_dwordx4 v233, s[44:47], s37 offen offset:1024 lds
    v_lshlrev_b32 v46, 16, v15
    v_mfma_f32_16x16x32_bf16 v[212:215], v[92:95], a[72:75], v[212:215]
    v_and_b32 v47, 0xffff0000, v15
    v_add_f32 v52, v16, v20
    v_mfma_f32_16x16x32_bf16 v[216:219], v[88:91], a[76:79], v[216:219]
    v_add_f32 v53, v17, v21
    v_add_f32 v54, v18, v22
    v_mfma_f32_16x16x32_bf16 v[220:223], v[92:95], a[76:79], v[220:223]
    v_add_f32 v55, v19, v23
    s_waitcnt vmcnt(14) lgkmcnt(0)
    v_mfma_f32_16x16x32_bf16 v[96:99], v[64:67], a[80:83], v[96:99]
    ds_read_b128 v[80:83], v225 offset:40960
    v_add_f32 v52, v52, v24
    v_add_f32 v53, v53, v25
    v_mfma_f32_16x16x32_bf16 v[100:103], v[68:71], a[80:83], v[100:103]
    ds_read_b128 v[84:87], v225 offset:43008
    v_add_f32 v54, v54, v26
    v_mfma_f32_16x16x32_bf16 v[104:107], v[64:67], a[84:87], v[104:107]
    ds_read_b128 v[88:91], v225 offset:45056
    v_add_f32 v55, v55, v27
    v_mfma_f32_16x16x32_bf16 v[108:111], v[68:71], a[84:87], v[108:111]
    ds_read_b128 v[92:95], v225 offset:47104
    v_add_f32 v52, v52, v28
    v_mfma_f32_16x16x32_bf16 v[112:115], v[64:67], a[88:91], v[112:115]
    ds_read_b64_tr_b16 a[96:97], v228 offset:0
    v_add_f32 v53, v53, v29
    v_mfma_f32_16x16x32_bf16 v[116:119], v[68:71], a[88:91], v[116:119]
    ds_read_b64_tr_b16 a[98:99], v228 offset:512
    v_add_f32 v54, v54, v30
    v_mfma_f32_16x16x32_bf16 v[120:123], v[64:67], a[92:95], v[120:123]
    ds_read_b64_tr_b16 a[100:101], v229 offset:0
    v_add_f32 v55, v55, v31
    v_mfma_f32_16x16x32_bf16 v[124:127], v[68:71], a[92:95], v[124:127]
    ds_read_b64_tr_b16 a[102:103], v229 offset:512
    v_add_f32 v52, v52, v32
    v_mfma_f32_16x16x32_bf16 v[128:131], v[72:75], a[80:83], v[128:131]
    s_add_u32 m0, s35, 16384
    s_and_b32 s33, s85, 1023
    s_lshl_b32 s33, s33, 12
    buffer_load_dwordx4 v234, s[48:51], s33 offen lds
    v_mfma_f32_16x16x32_bf16 v[132:135], v[76:79], a[80:83], v[132:135]
    buffer_load_dwordx4 v235, s[48:51], s33 offen offset:1024 lds
    v_add_f32 v53, v53, v33
    v_mfma_f32_16x16x32_bf16 v[136:139], v[72:75], a[84:87], v[136:139]
    s_add_u32 m0, s35, 18432
    s_add_u32 s33, s33, 131072
    buffer_load_dwordx4 v234, s[48:51], s33 offen lds
    v_mfma_f32_16x16x32_bf16 v[140:143], v[76:79], a[84:87], v[140:143]
    v_add_f32 v54, v54, v34
    v_add_f32 v55, v55, v35
    v_mfma_f32_16x16x32_bf16 v[144:147], v[72:75], a[88:91], v[144:147]
    buffer_load_dwordx4 v235, s[48:51], s33 offen offset:1024 lds
    v_add_f32 v52, v52, v36
    v_mfma_f32_16x16x32_bf16 v[148:151], v[76:79], a[88:91], v[148:151]
    s_lshl2_add_u32 s26, s4, s3
    s_lshl_b32 s26, s26, 10
    s_add_u32 s26, s26, s32
    s_add_u32 s26, s26, 131072
    v_mfma_f32_16x16x32_bf16 v[152:155], v[72:75], a[92:95], v[152:155]
    v_and_b32 v226, 0x40000380, v251
    buffer_load_dword v241, v226, s[44:47], s26 offen
    v_mfma_f32_16x16x32_bf16 v[156:159], v[76:79], a[92:95], v[156:159]
    s_waitcnt vmcnt(25) lgkmcnt(0)
    s_barrier
    v_mfma_f32_16x16x32_bf16 v[160:163], v[80:83], a[80:83], v[160:163]
    ds_read_b128 v[64:67], v224 offset:49152
    v_add_f32 v53, v53, v37
    v_mfma_f32_16x16x32_bf16 v[164:167], v[84:87], a[80:83], v[164:167]
    ds_read_b128 v[68:71], v224 offset:51200
    v_add_f32 v54, v54, v38
    v_mfma_f32_16x16x32_bf16 v[168:171], v[80:83], a[84:87], v[168:171]
    ds_read_b128 v[72:75], v224 offset:53248
    v_add_f32 v55, v55, v39
    v_mfma_f32_16x16x32_bf16 v[172:175], v[84:87], a[84:87], v[172:175]
    ds_read_b128 v[76:79], v224 offset:55296
    v_add_f32 v52, v52, v40
    v_mfma_f32_16x16x32_bf16 v[176:179], v[80:83], a[88:91], v[176:179]
    ds_read_b64_tr_b16 a[104:105], v230 offset:0
    v_add_f32 v53, v53, v41
    v_mfma_f32_16x16x32_bf16 v[180:183], v[84:87], a[88:91], v[180:183]
    ds_read_b64_tr_b16 a[106:107], v230 offset:512
    v_add_f32 v54, v54, v42
    v_mfma_f32_16x16x32_bf16 v[184:187], v[80:83], a[92:95], v[184:187]
    ds_read_b64_tr_b16 a[108:109], v231 offset:0
    v_add_f32 v55, v55, v43
    v_mfma_f32_16x16x32_bf16 v[188:191], v[84:87], a[92:95], v[188:191]
    ds_read_b64_tr_b16 a[110:111], v231 offset:512
    v_add_f32 v52, v52, v44
    v_mfma_f32_16x16x32_bf16 v[192:195], v[88:91], a[80:83], v[192:195]
    s_add_u32 m0, s34, 32768
    s_add_u32 s37, s86, 0
    buffer_load_dwordx4 v232, s[44:47], s37 offen lds
    v_mfma_f32_16x16x32_bf16 v[196:199], v[92:95], a[80:83], v[196:199]
    v_add_f32 v53, v53, v45
    v_add_f32 v54, v54, v46
    v_mfma_f32_16x16x32_bf16 v[200:203], v[88:91], a[84:87], v[200:203]
    v_add_f32 v55, v55, v47
    v_add_f32 v52, v52, v53
    v_mfma_f32_16x16x32_bf16 v[204:207], v[92:95], a[84:87], v[204:207]
    v_add_f32 v54, v54, v55
    v_add_f32 v48, v52, v54
    v_mfma_f32_16x16x32_bf16 v[208:211], v[88:91], a[88:91], v[208:211]
    buffer_load_dwordx4 v233, s[44:47], s37 offen offset:1024 lds
    s_nop 1
    v_mfma_f32_16x16x32_bf16 v[212:215], v[92:95], a[88:91], v[212:215]
    v_add_f32_dpp v48, v48, v48 quad_perm:[1,0,3,2] row_mask:0xf bank_mask:0xf
    s_nop 1
    v_mfma_f32_16x16x32_bf16 v[216:219], v[88:91], a[92:95], v[216:219]
    v_add_f32_dpp v48, v48, v48 quad_perm:[2,3,0,1] row_mask:0xf bank_mask:0xf
    s_nop 1
    v_mfma_f32_16x16x32_bf16 v[220:223], v[92:95], a[92:95], v[220:223]
    v_add_f32_dpp v48, v48, v48 row_half_mirror row_mask:0xf bank_mask:0xf
    s_waitcnt lgkmcnt(0)
    v_mfma_f32_16x16x32_bf16 v[96:99], v[64:67], a[96:99], v[96:99]
    ds_read_b128 v[80:83], v224 offset:57344
    s_nop 1
    v_mfma_f32_16x16x32_bf16 v[100:103], v[68:71], a[96:99], v[100:103]
    ds_read_b128 v[84:87], v224 offset:59392
    v_add_f32_dpp v48, v48, v48 row_mirror row_mask:0xf bank_mask:0xf
    v_mfma_f32_16x16x32_bf16 v[104:107], v[64:67], a[100:103], v[104:107]
    ds_read_b128 v[88:91], v224 offset:61440
    s_nop 0
    v_mfma_f32_16x16x32_bf16 v[108:111], v[68:71], a[100:103], v[108:111]
    ds_read_b128 v[92:95], v224 offset:63488
    v_mov_b32 v49, v48
    v_mfma_f32_16x16x32_bf16 v[112:115], v[64:67], a[104:107], v[112:115]
    ds_read_b64_tr_b16 a[112:113], v228 offset:4096
    s_nop 1
    v_mfma_f32_16x16x32_bf16 v[116:119], v[68:71], a[104:107], v[116:119]
    ds_read_b64_tr_b16 a[114:115], v228 offset:4608
    v_permlane16_swap_b32 v48, v49
    v_mfma_f32_16x16x32_bf16 v[120:123], v[64:67], a[108:111], v[120:123]
    ds_read_b64_tr_b16 a[116:117], v229 offset:4096
    s_nop 0
    v_mfma_f32_16x16x32_bf16 v[124:127], v[68:71], a[108:111], v[124:127]
    ds_read_b64_tr_b16 a[118:119], v229 offset:4608
    v_add_f32 v48, v48, v49
    v_mfma_f32_16x16x32_bf16 v[128:131], v[72:75], a[96:99], v[128:131]
    s_add_u32 m0, s35, 20480
    s_add_u32 s33, s33, 131072
    buffer_load_dwordx4 v234, s[48:51], s33 offen lds
    v_mfma_f32_16x16x32_bf16 v[132:135], v[76:79], a[96:99], v[132:135]
    buffer_load_dwordx4 v235, s[48:51], s33 offen offset:1024 lds
    v_mul_f32 v48, 0x3a800000, v48
    v_mfma_f32_16x16x32_bf16 v[136:139], v[72:75], a[100:103], v[136:139]
    v_sub_f32 v56, v16, v48
    v_mul_f32 v52, v56, v56
    v_mfma_f32_16x16x32_bf16 v[140:143], v[76:79], a[100:103], v[140:143]
    s_add_u32 m0, s35, 22528
    s_add_u32 s33, s33, 131072
    buffer_load_dwordx4 v234, s[48:51], s33 offen lds
    v_mfma_f32_16x16x32_bf16 v[144:147], v[72:75], a[104:107], v[144:147]
    buffer_load_dwordx4 v235, s[48:51], s33 offen offset:1024 lds
    v_sub_f32 v57, v17, v48
    v_mfma_f32_16x16x32_bf16 v[148:151], v[76:79], a[104:107], v[148:151]
    v_mul_f32 v53, v57, v57
    v_sub_f32 v58, v18, v48
    v_mfma_f32_16x16x32_bf16 v[152:155], v[72:75], a[108:111], v[152:155]
    v_lshlrev_b32 v226, 7, v253
    s_lshl_b32 s25, s2, 15
    buffer_load_dword v241, v226, s[12:15], s25 offen
    v_mfma_f32_16x16x32_bf16 v[156:159], v[76:79], a[108:111], v[156:159]
    v_mul_f32 v54, v58, v58
    s_waitcnt lgkmcnt(0)
    v_mfma_f32_16x16x32_bf16 v[160:163], v[80:83], a[96:99], v[160:163]
    ds_read_b128 v[64:67], v225 offset:49152
    v_sub_f32 v59, v19, v48
    v_mfma_f32_16x16x32_bf16 v[164:167], v[84:87], a[96:99], v[164:167]
    ds_read_b128 v[68:71], v225 offset:51200
    v_mul_f32 v55, v59, v59
    v_mfma_f32_16x16x32_bf16 v[168:171], v[80:83], a[100:103], v[168:171]
    ds_read_b128 v[72:75], v225 offset:53248
    v_sub_f32 v56, v20, v48
    v_mfma_f32_16x16x32_bf16 v[172:175], v[84:87], a[100:103], v[172:175]
    ds_read_b128 v[76:79], v225 offset:55296
    v_fmac_f32 v52, v56, v56
    v_mfma_f32_16x16x32_bf16 v[176:179], v[80:83], a[104:107], v[176:179]
    ds_read_b64_tr_b16 a[120:121], v230 offset:4096
    v_sub_f32 v57, v21, v48
    v_mfma_f32_16x16x32_bf16 v[180:183], v[84:87], a[104:107], v[180:183]
    ds_read_b64_tr_b16 a[122:123], v230 offset:4608
    v_fmac_f32 v53, v57, v57
    v_mfma_f32_16x16x32_bf16 v[184:187], v[80:83], a[108:111], v[184:187]
    ds_read_b64_tr_b16 a[124:125], v231 offset:4096
    v_sub_f32 v58, v22, v48
    v_mfma_f32_16x16x32_bf16 v[188:191], v[84:87], a[108:111], v[188:191]
    ds_read_b64_tr_b16 a[126:127], v231 offset:4608
    v_fmac_f32 v54, v58, v58
    v_mfma_f32_16x16x32_bf16 v[192:195], v[88:91], a[96:99], v[192:195]
    s_add_u32 m0, s34, 40960
    s_add_u32 s37, s86, 65536
    buffer_load_dwordx4 v232, s[44:47], s37 offen lds
    v_mfma_f32_16x16x32_bf16 v[196:199], v[92:95], a[96:99], v[196:199]
    v_sub_f32 v59, v23, v48
    v_fmac_f32 v55, v59, v59
    v_mfma_f32_16x16x32_bf16 v[200:203], v[88:91], a[100:103], v[200:203]
    v_sub_f32 v56, v24, v48
    v_fmac_f32 v52, v56, v56
    v_mfma_f32_16x16x32_bf16 v[204:207], v[92:95], a[100:103], v[204:207]
    v_sub_f32 v57, v25, v48
    v_fmac_f32 v53, v57, v57
    v_mfma_f32_16x16x32_bf16 v[208:211], v[88:91], a[104:107], v[208:211]
    buffer_load_dwordx4 v233, s[44:47], s37 offen offset:1024 lds
    v_sub_f32 v58, v26, v48
    v_mfma_f32_16x16x32_bf16 v[212:215], v[92:95], a[104:107], v[212:215]
    v_fmac_f32 v54, v58, v58
    v_sub_f32 v59, v27, v48
    v_mfma_f32_16x16x32_bf16 v[216:219], v[88:91], a[108:111], v[216:219]
    v_fmac_f32 v55, v59, v59
    v_sub_f32 v56, v28, v48
    v_mfma_f32_16x16x32_bf16 v[220:223], v[92:95], a[108:111], v[220:223]
    v_fmac_f32 v52, v56, v56
    s_waitcnt vmcnt(16) lgkmcnt(0)
    v_mfma_f32_16x16x32_bf16 v[96:99], v[64:67], a[112:115], v[96:99]
    ds_read_b128 v[80:83], v225 offset:57344
    v_sub_f32 v57, v29, v48
    v_mfma_f32_16x16x32_bf16 v[100:103], v[68:71], a[112:115], v[100:103]
    ds_read_b128 v[84:87], v225 offset:59392
    v_fmac_f32 v53, v57, v57
    v_mfma_f32_16x16x32_bf16 v[104:107], v[64:67], a[116:119], v[104:107]
    ds_read_b128 v[88:91], v225 offset:61440
    v_sub_f32 v58, v30, v48
    v_mfma_f32_16x16x32_bf16 v[108:111], v[68:71], a[116:119], v[108:111]
    ds_read_b128 v[92:95], v225 offset:63488
    v_fmac_f32 v54, v58, v58
    v_mfma_f32_16x16x32_bf16 v[112:115], v[64:67], a[120:123], v[112:115]
    ds_read_b64_tr_b16 a[128:129], v228 offset:8192
    v_sub_f32 v59, v31, v48
    v_mfma_f32_16x16x32_bf16 v[116:119], v[68:71], a[120:123], v[116:119]
    ds_read_b64_tr_b16 a[130:131], v228 offset:8704
    v_fmac_f32 v55, v59, v59
    v_mfma_f32_16x16x32_bf16 v[120:123], v[64:67], a[124:127], v[120:123]
    ds_read_b64_tr_b16 a[132:133], v229 offset:8192
    v_sub_f32 v56, v32, v48
    v_mfma_f32_16x16x32_bf16 v[124:127], v[68:71], a[124:127], v[124:127]
    ds_read_b64_tr_b16 a[134:135], v229 offset:8704
    v_fmac_f32 v52, v56, v56
    v_mfma_f32_16x16x32_bf16 v[128:131], v[72:75], a[112:115], v[128:131]
    s_add_u32 m0, s35, 0
    s_and_b32 s33, s86, 1023
    s_lshl_b32 s33, s33, 12
    buffer_load_dwordx4 v234, s[48:51], s33 offen lds
    v_mfma_f32_16x16x32_bf16 v[132:135], v[76:79], a[112:115], v[132:135]
    v_sub_f32 v57, v33, v48
    v_fmac_f32 v53, v57, v57
    v_sub_f32 v58, v34, v48
    v_mfma_f32_16x16x32_bf16 v[136:139], v[72:75], a[116:119], v[136:139]
    buffer_load_dwordx4 v235, s[48:51], s33 offen offset:1024 lds
    v_fmac_f32 v54, v58, v58
    v_mfma_f32_16x16x32_bf16 v[140:143], v[76:79], a[116:119], v[140:143]
    v_sub_f32 v59, v35, v48
    v_fmac_f32 v55, v59, v59
    v_mfma_f32_16x16x32_bf16 v[144:147], v[72:75], a[120:123], v[144:147]
    s_add_u32 m0, s35, 2048
    s_add_u32 s33, s33, 131072
    buffer_load_dwordx4 v234, s[48:51], s33 offen lds
    v_mfma_f32_16x16x32_bf16 v[148:151], v[76:79], a[120:123], v[148:151]
    v_sub_f32 v56, v36, v48
    v_fmac_f32 v52, v56, v56
    v_mfma_f32_16x16x32_bf16 v[152:155], v[72:75], a[124:127], v[152:155]
    buffer_load_dwordx4 v235, s[48:51], s33 offen offset:1024 lds
    v_sub_f32 v57, v37, v48
    v_mfma_f32_16x16x32_bf16 v[156:159], v[76:79], a[124:127], v[156:159]
    s_waitcnt vmcnt(30) lgkmcnt(0)
    s_barrier
    v_mfma_f32_16x16x32_bf16 v[160:163], v[80:83], a[112:115], v[160:163]
    ds_read_b128 v[64:67], v224 offset:0
    v_fmac_f32 v53, v57, v57
    v_mfma_f32_16x16x32_bf16 v[164:167], v[84:87], a[112:115], v[164:167]
    ds_read_b128 v[68:71], v224 offset:2048
    v_sub_f32 v58, v38, v48
    v_mfma_f32_16x16x32_bf16 v[168:171], v[80:83], a[116:119], v[168:171]
    ds_read_b128 v[72:75], v224 offset:4096
    v_fmac_f32 v54, v58, v58
    v_mfma_f32_16x16x32_bf16 v[172:175], v[84:87], a[116:119], v[172:175]
    ds_read_b128 v[76:79], v224 offset:6144
    v_sub_f32 v59, v39, v48
    v_mfma_f32_16x16x32_bf16 v[176:179], v[80:83], a[120:123], v[176:179]
    ds_read_b64_tr_b16 a[136:137], v230 offset:8192
    v_fmac_f32 v55, v59, v59
    v_mfma_f32_16x16x32_bf16 v[180:183], v[84:87], a[120:123], v[180:183]
    ds_read_b64_tr_b16 a[138:139], v230 offset:8704
    v_sub_f32 v56, v40, v48
    v_mfma_f32_16x16x32_bf16 v[184:187], v[80:83], a[124:127], v[184:187]
    ds_read_b64_tr_b16 a[140:141], v231 offset:8192
    v_fmac_f32 v52, v56, v56
    v_mfma_f32_16x16x32_bf16 v[188:191], v[84:87], a[124:127], v[188:191]
    ds_read_b64_tr_b16 a[142:143], v231 offset:8704
    v_sub_f32 v57, v41, v48
    v_mfma_f32_16x16x32_bf16 v[192:195], v[88:91], a[112:115], v[192:195]
    s_add_u32 m0, s34, 49152
    s_add_u32 s37, s87, 0
    buffer_load_dwordx4 v232, s[44:47], s37 offen lds
    v_mfma_f32_16x16x32_bf16 v[196:199], v[92:95], a[112:115], v[196:199]
    v_fmac_f32 v53, v57, v57
    v_sub_f32 v58, v42, v48
    v_mfma_f32_16x16x32_bf16 v[200:203], v[88:91], a[116:119], v[200:203]
    v_fmac_f32 v54, v58, v58
    v_sub_f32 v59, v43, v48
    v_mfma_f32_16x16x32_bf16 v[204:207], v[92:95], a[116:119], v[204:207]
    v_fmac_f32 v55, v59, v59
    v_sub_f32 v56, v44, v48
    v_mfma_f32_16x16x32_bf16 v[208:211], v[88:91], a[120:123], v[208:211]
    buffer_load_dwordx4 v233, s[44:47], s37 offen offset:1024 lds
    v_fmac_f32 v52, v56, v56
    v_mfma_f32_16x16x32_bf16 v[212:215], v[92:95], a[120:123], v[212:215]
    v_sub_f32 v57, v45, v48
    v_fmac_f32 v53, v57, v57
    v_mfma_f32_16x16x32_bf16 v[216:219], v[88:91], a[124:127], v[216:219]
    v_sub_f32 v58, v46, v48
    v_fmac_f32 v54, v58, v58
    v_mfma_f32_16x16x32_bf16 v[220:223], v[92:95], a[124:127], v[220:223]
    v_sub_f32 v59, v47, v48
    s_waitcnt lgkmcnt(0)
    v_mfma_f32_16x16x32_bf16 v[96:99], v[64:67], a[128:131], v[96:99]
    ds_read_b128 v[80:83], v224 offset:8192
    v_fmac_f32 v55, v59, v59
    v_mfma_f32_16x16x32_bf16 v[100:103], v[68:71], a[128:131], v[100:103]
    ds_read_b128 v[84:87], v224 offset:10240
    v_add_f32 v52, v52, v53
    v_mfma_f32_16x16x32_bf16 v[104:107], v[64:67], a[132:135], v[104:107]
    ds_read_b128 v[88:91], v224 offset:12288
    v_add_f32 v54, v54, v55
    v_mfma_f32_16x16x32_bf16 v[108:111], v[68:71], a[132:135], v[108:111]
    ds_read_b128 v[92:95], v224 offset:14336
    v_add_f32 v51, v52, v54
    v_mfma_f32_16x16x32_bf16 v[112:115], v[64:67], a[136:139], v[112:115]
    ds_read_b64_tr_b16 a[144:145], v228 offset:12288
    s_nop 1
    v_mfma_f32_16x16x32_bf16 v[116:119], v[68:71], a[136:139], v[116:119]
    ds_read_b64_tr_b16 a[146:147], v228 offset:12800
    v_add_f32_dpp v51, v51, v51 quad_perm:[1,0,3,2] row_mask:0xf bank_mask:0xf
    v_mfma_f32_16x16x32_bf16 v[120:123], v[64:67], a[140:143], v[120:123]
    ds_read_b64_tr_b16 a[148:149], v229 offset:12288
    s_nop 1
    v_mfma_f32_16x16x32_bf16 v[124:127], v[68:71], a[140:143], v[124:127]
    ds_read_b64_tr_b16 a[150:151], v229 offset:12800
    v_add_f32_dpp v51, v51, v51 quad_perm:[2,3,0,1] row_mask:0xf bank_mask:0xf
    v_mfma_f32_16x16x32_bf16 v[128:131], v[72:75], a[128:131], v[128:131]
    s_add_u32 m0, s35, 4096
    s_add_u32 s33, s33, 131072
    buffer_load_dwordx4 v234, s[48:51], s33 offen lds
    v_mfma_f32_16x16x32_bf16 v[132:135], v[76:79], a[128:131], v[132:135]
    s_nop 1
    v_add_f32_dpp v51, v51, v51 row_half_mirror row_mask:0xf bank_mask:0xf
    v_mfma_f32_16x16x32_bf16 v[136:139], v[72:75], a[132:135], v[136:139]
    buffer_load_dwordx4 v235, s[48:51], s33 offen offset:1024 lds
    s_nop 1
    v_mfma_f32_16x16x32_bf16 v[140:143], v[76:79], a[132:135], v[140:143]
    v_add_f32_dpp v51, v51, v51 row_mirror row_mask:0xf bank_mask:0xf
    s_nop 0
    v_mfma_f32_16x16x32_bf16 v[144:147], v[72:75], a[136:139], v[144:147]
    s_add_u32 m0, s35, 6144
    s_add_u32 s33, s33, 131072
    buffer_load_dwordx4 v234, s[48:51], s33 offen lds
    v_mfma_f32_16x16x32_bf16 v[148:151], v[76:79], a[136:139], v[148:151]
    v_mov_b32 v49, v51
    s_nop 1
    v_mfma_f32_16x16x32_bf16 v[152:155], v[72:75], a[140:143], v[152:155]
    buffer_load_dwordx4 v235, s[48:51], s33 offen offset:1024 lds
    v_permlane16_swap_b32 v51, v49
    v_mfma_f32_16x16x32_bf16 v[156:159], v[76:79], a[140:143], v[156:159]
    s_nop 0
    s_waitcnt lgkmcnt(0)
    v_mfma_f32_16x16x32_bf16 v[160:163], v[80:83], a[128:131], v[160:163]
    ds_read_b128 v[64:67], v225 offset:0
    v_add_f32 v51, v51, v49
    v_mfma_f32_16x16x32_bf16 v[164:167], v[84:87], a[128:131], v[164:167]
    ds_read_b128 v[68:71], v225 offset:2048
    v_mul_f32 v51, 0x3a800000, v51
    v_mfma_f32_16x16x32_bf16 v[168:171], v[80:83], a[132:135], v[168:171]
    ds_read_b128 v[72:75], v225 offset:4096
    v_cvt_pk_bf16_f32 v50, v48, v51
    v_mfma_f32_16x16x32_bf16 v[172:175], v[84:87], a[132:135], v[172:175]
    ds_read_b128 v[76:79], v225 offset:6144
    v_and_b32 v51, 0xffff0000, v50
    v_mfma_f32_16x16x32_bf16 v[176:179], v[80:83], a[136:139], v[176:179]
    ds_read_b64_tr_b16 a[152:153], v230 offset:12288
    v_lshlrev_b32 v50, 16, v50
    v_mfma_f32_16x16x32_bf16 v[180:183], v[84:87], a[136:139], v[180:183]
    ds_read_b64_tr_b16 a[154:155], v230 offset:12800
    v_add_f32 v51, 0x3727c5ac, v51
    v_mfma_f32_16x16x32_bf16 v[184:187], v[80:83], a[140:143], v[184:187]
    ds_read_b64_tr_b16 a[156:157], v231 offset:12288
    v_cvt_pk_bf16_f32 v51, v51, v51
    v_mfma_f32_16x16x32_bf16 v[188:191], v[84:87], a[140:143], v[188:191]
    ds_read_b64_tr_b16 a[158:159], v231 offset:12800
    v_lshlrev_b32 v51, 16, v51
    v_mfma_f32_16x16x32_bf16 v[192:195], v[88:91], a[128:131], v[192:195]
    s_add_u32 m0, s34, 57344
    s_add_u32 s37, s87, 65536
    buffer_load_dwordx4 v232, s[44:47], s37 offen lds
    v_mfma_f32_16x16x32_bf16 v[196:199], v[92:95], a[128:131], v[196:199]
    v_sqrt_f32 v51, v51
    v_mfma_f32_16x16x32_bf16 v[200:203], v[88:91], a[132:135], v[200:203]
    s_nop 0
    v_cvt_pk_bf16_f32 v51, v51, v51
    v_mfma_f32_16x16x32_bf16 v[204:207], v[92:95], a[132:135], v[204:207]
    v_lshlrev_b32 v51, 16, v51
    v_rcp_f32 v51, v51
    v_mfma_f32_16x16x32_bf16 v[208:211], v[88:91], a[136:139], v[208:211]
    buffer_load_dwordx4 v233, s[44:47], s37 offen offset:1024 lds
    v_mfma_f32_16x16x32_bf16 v[212:215], v[92:95], a[136:139], v[212:215]
    s_nop 0
    v_mul_f32 v51, 0x3e0293ee, v51
    v_mfma_f32_16x16x32_bf16 v[216:219], v[88:91], a[140:143], v[216:219]
    v_sub_f32 v16, v16, v50
    v_sub_f32 v17, v17, v50
    v_mfma_f32_16x16x32_bf16 v[220:223], v[92:95], a[140:143], v[220:223]
    v_cvt_pk_bf16_f32 v17, v16, v17
    s_waitcnt vmcnt(15) lgkmcnt(0)
    v_mfma_f32_16x16x32_bf16 v[96:99], v[64:67], a[144:147], v[96:99]
    ds_read_b128 v[80:83], v225 offset:8192
    v_lshlrev_b32 v16, 16, v17
    v_mfma_f32_16x16x32_bf16 v[100:103], v[68:71], a[144:147], v[100:103]
    ds_read_b128 v[84:87], v225 offset:10240
    v_and_b32 v17, 0xffff0000, v17
    v_mfma_f32_16x16x32_bf16 v[104:107], v[64:67], a[148:151], v[104:107]
    ds_read_b128 v[88:91], v225 offset:12288
    v_mul_f32 v16, v16, v51
    v_mfma_f32_16x16x32_bf16 v[108:111], v[68:71], a[148:151], v[108:111]
    ds_read_b128 v[92:95], v225 offset:14336
    v_mul_f32 v17, v17, v51
    v_mfma_f32_16x16x32_bf16 v[112:115], v[64:67], a[152:155], v[112:115]
    ds_read_b64_tr_b16 a[160:161], v228 offset:16384
    v_cvt_pk_bf16_f32 v0, v16, v17
    v_mfma_f32_16x16x32_bf16 v[116:119], v[68:71], a[152:155], v[116:119]
    ds_read_b64_tr_b16 a[162:163], v228 offset:16896
    v_sub_f32 v18, v18, v50
    v_mfma_f32_16x16x32_bf16 v[120:123], v[64:67], a[156:159], v[120:123]
    ds_read_b64_tr_b16 a[164:165], v229 offset:16384
    v_sub_f32 v19, v19, v50
    v_mfma_f32_16x16x32_bf16 v[124:127], v[68:71], a[156:159], v[124:127]
    ds_read_b64_tr_b16 a[166:167], v229 offset:16896
    v_cvt_pk_bf16_f32 v19, v18, v19
    v_mfma_f32_16x16x32_bf16 v[128:131], v[72:75], a[144:147], v[128:131]
    s_add_u32 m0, s35, 8192
    s_and_b32 s33, s87, 1023
    s_lshl_b32 s33, s33, 12
    buffer_load_dwordx4 v234, s[48:51], s33 offen lds
    v_mfma_f32_16x16x32_bf16 v[132:135], v[76:79], a[144:147], v[132:135]
    v_lshlrev_b32 v18, 16, v19
    v_and_b32 v19, 0xffff0000, v19
    v_mfma_f32_16x16x32_bf16 v[136:139], v[72:75], a[148:151], v[136:139]
    buffer_load_dwordx4 v235, s[48:51], s33 offen offset:1024 lds
    v_mul_f32 v18, v18, v51
    v_mul_f32 v19, v19, v51
    v_mfma_f32_16x16x32_bf16 v[140:143], v[76:79], a[148:151], v[140:143]
    v_cvt_pk_bf16_f32 v1, v18, v19
    v_sub_f32 v20, v20, v50
    v_mfma_f32_16x16x32_bf16 v[144:147], v[72:75], a[152:155], v[144:147]
    s_add_u32 m0, s35, 10240
    s_add_u32 s33, s33, 131072
    buffer_load_dwordx4 v234, s[48:51], s33 offen lds
    v_mfma_f32_16x16x32_bf16 v[148:151], v[76:79], a[152:155], v[148:151]
    v_sub_f32 v21, v21, v50
    v_cvt_pk_bf16_f32 v21, v20, v21
    v_mfma_f32_16x16x32_bf16 v[152:155], v[72:75], a[156:159], v[152:155]
    buffer_load_dwordx4 v235, s[48:51], s33 offen offset:1024 lds
    v_lshlrev_b32 v20, 16, v21
    v_mfma_f32_16x16x32_bf16 v[156:159], v[76:79], a[156:159], v[156:159]
    s_waitcnt vmcnt(30) lgkmcnt(0)
    s_barrier
    v_mfma_f32_16x16x32_bf16 v[160:163], v[80:83], a[144:147], v[160:163]
    ds_read_b128 v[64:67], v224 offset:16384
    v_and_b32 v21, 0xffff0000, v21
    v_mfma_f32_16x16x32_bf16 v[164:167], v[84:87], a[144:147], v[164:167]
    ds_read_b128 v[68:71], v224 offset:18432
    v_mul_f32 v20, v20, v51
    v_mfma_f32_16x16x32_bf16 v[168:171], v[80:83], a[148:151], v[168:171]
    ds_read_b128 v[72:75], v224 offset:20480
    v_mul_f32 v21, v21, v51
    v_mfma_f32_16x16x32_bf16 v[172:175], v[84:87], a[148:151], v[172:175]
    ds_read_b128 v[76:79], v224 offset:22528
    v_cvt_pk_bf16_f32 v2, v20, v21
    v_mfma_f32_16x16x32_bf16 v[176:179], v[80:83], a[152:155], v[176:179]
    ds_read_b64_tr_b16 a[168:169], v230 offset:16384
    v_sub_f32 v22, v22, v50
    v_mfma_f32_16x16x32_bf16 v[180:183], v[84:87], a[152:155], v[180:183]
    ds_read_b64_tr_b16 a[170:171], v230 offset:16896
    v_sub_f32 v23, v23, v50
    v_mfma_f32_16x16x32_bf16 v[184:187], v[80:83], a[156:159], v[184:187]
    ds_read_b64_tr_b16 a[172:173], v231 offset:16384
    v_cvt_pk_bf16_f32 v23, v22, v23
    v_mfma_f32_16x16x32_bf16 v[188:191], v[84:87], a[156:159], v[188:191]
    ds_read_b64_tr_b16 a[174:175], v231 offset:16896
    v_lshlrev_b32 v22, 16, v23
    v_mfma_f32_16x16x32_bf16 v[192:195], v[88:91], a[144:147], v[192:195]
    s_add_u32 m0, s34, 0
    s_add_u32 s37, s80, 131072
    buffer_load_dwordx4 v232, s[44:47], s37 offen lds
    v_mfma_f32_16x16x32_bf16 v[196:199], v[92:95], a[144:147], v[196:199]
    v_and_b32 v23, 0xffff0000, v23
    v_mul_f32 v22, v22, v51
    v_mfma_f32_16x16x32_bf16 v[200:203], v[88:91], a[148:151], v[200:203]
    v_mul_f32 v23, v23, v51
    v_cvt_pk_bf16_f32 v3, v22, v23
    v_mfma_f32_16x16x32_bf16 v[204:207], v[92:95], a[148:151], v[204:207]
    v_sub_f32 v24, v24, v50
    v_sub_f32 v25, v25, v50
    v_mfma_f32_16x16x32_bf16 v[208:211], v[88:91], a[152:155], v[208:211]
    buffer_load_dwordx4 v233, s[44:47], s37 offen offset:1024 lds
    v_cvt_pk_bf16_f32 v25, v24, v25
    v_mfma_f32_16x16x32_bf16 v[212:215], v[92:95], a[152:155], v[212:215]
    v_lshlrev_b32 v24, 16, v25
    v_and_b32 v25, 0xffff0000, v25
    v_mfma_f32_16x16x32_bf16 v[216:219], v[88:91], a[156:159], v[216:219]
    v_mul_f32 v24, v24, v51
    v_mul_f32 v25, v25, v51
    v_mfma_f32_16x16x32_bf16 v[220:223], v[92:95], a[156:159], v[220:223]
    v_cvt_pk_bf16_f32 v4, v24, v25
    s_waitcnt lgkmcnt(0)
    v_mfma_f32_16x16x32_bf16 v[96:99], v[64:67], a[160:163], v[96:99]
    ds_read_b128 v[80:83], v224 offset:24576
    v_sub_f32 v26, v26, v50
    v_mfma_f32_16x16x32_bf16 v[100:103], v[68:71], a[160:163], v[100:103]
    ds_read_b128 v[84:87], v224 offset:26624
    v_sub_f32 v27, v27, v50
    v_mfma_f32_16x16x32_bf16 v[104:107], v[64:67], a[164:167], v[104:107]
    ds_read_b128 v[88:91], v224 offset:28672
    v_cvt_pk_bf16_f32 v27, v26, v27
    v_mfma_f32_16x16x32_bf16 v[108:111], v[68:71], a[164:167], v[108:111]
    ds_read_b128 v[92:95], v224 offset:30720
    v_lshlrev_b32 v26, 16, v27
    v_mfma_f32_16x16x32_bf16 v[112:115], v[64:67], a[168:171], v[112:115]
    ds_read_b64_tr_b16 a[176:177], v228 offset:20480
    v_and_b32 v27, 0xffff0000, v27
    v_mfma_f32_16x16x32_bf16 v[116:119], v[68:71], a[168:171], v[116:119]
    ds_read_b64_tr_b16 a[178:179], v228 offset:20992
    v_mul_f32 v26, v26, v51
    v_mfma_f32_16x16x32_bf16 v[120:123], v[64:67], a[172:175], v[120:123]
    ds_read_b64_tr_b16 a[180:181], v229 offset:20480
    v_mul_f32 v27, v27, v51
    v_mfma_f32_16x16x32_bf16 v[124:127], v[68:71], a[172:175], v[124:127]
    ds_read_b64_tr_b16 a[182:183], v229 offset:20992
    v_cvt_pk_bf16_f32 v5, v26, v27
    v_mfma_f32_16x16x32_bf16 v[128:131], v[72:75], a[160:163], v[128:131]
    s_add_u32 m0, s35, 12288
    s_add_u32 s33, s33, 131072
    buffer_load_dwordx4 v234, s[48:51], s33 offen lds
    v_mfma_f32_16x16x32_bf16 v[132:135], v[76:79], a[160:163], v[132:135]
    v_sub_f32 v28, v28, v50
    v_sub_f32 v29, v29, v50
    v_mfma_f32_16x16x32_bf16 v[136:139], v[72:75], a[164:167], v[136:139]
    buffer_load_dwordx4 v235, s[48:51], s33 offen offset:1024 lds
    v_cvt_pk_bf16_f32 v29, v28, v29
    v_mfma_f32_16x16x32_bf16 v[140:143], v[76:79], a[164:167], v[140:143]
    v_lshlrev_b32 v28, 16, v29
    v_and_b32 v29, 0xffff0000, v29
    v_mfma_f32_16x16x32_bf16 v[144:147], v[72:75], a[168:171], v[144:147]
    s_add_u32 m0, s35, 14336
    s_add_u32 s33, s33, 131072
    buffer_load_dwordx4 v234, s[48:51], s33 offen lds
    v_mfma_f32_16x16x32_bf16 v[148:151], v[76:79], a[168:171], v[148:151]
    v_mul_f32 v28, v28, v51
    v_mul_f32 v29, v29, v51
    v_mfma_f32_16x16x32_bf16 v[152:155], v[72:75], a[172:175], v[152:155]
    buffer_load_dwordx4 v235, s[48:51], s33 offen offset:1024 lds
    v_cvt_pk_bf16_f32 v6, v28, v29
    v_mfma_f32_16x16x32_bf16 v[156:159], v[76:79], a[172:175], v[156:159]
    v_sub_f32 v30, v30, v50
    s_waitcnt lgkmcnt(0)
    v_mfma_f32_16x16x32_bf16 v[160:163], v[80:83], a[160:163], v[160:163]
    ds_read_b128 v[64:67], v225 offset:16384
    v_sub_f32 v31, v31, v50
    v_mfma_f32_16x16x32_bf16 v[164:167], v[84:87], a[160:163], v[164:167]
    ds_read_b128 v[68:71], v225 offset:18432
    v_cvt_pk_bf16_f32 v31, v30, v31
    v_mfma_f32_16x16x32_bf16 v[168:171], v[80:83], a[164:167], v[168:171]
    ds_read_b128 v[72:75], v225 offset:20480
    v_lshlrev_b32 v30, 16, v31
    v_mfma_f32_16x16x32_bf16 v[172:175], v[84:87], a[164:167], v[172:175]
    ds_read_b128 v[76:79], v225 offset:22528
    v_and_b32 v31, 0xffff0000, v31
    v_mfma_f32_16x16x32_bf16 v[176:179], v[80:83], a[168:171], v[176:179]
    ds_read_b64_tr_b16 a[184:185], v230 offset:20480
    v_mul_f32 v30, v30, v51
    v_mfma_f32_16x16x32_bf16 v[180:183], v[84:87], a[168:171], v[180:183]
    ds_read_b64_tr_b16 a[186:187], v230 offset:20992
    v_mul_f32 v31, v31, v51
    v_mfma_f32_16x16x32_bf16 v[184:187], v[80:83], a[172:175], v[184:187]
    ds_read_b64_tr_b16 a[188:189], v231 offset:20480
    v_cvt_pk_bf16_f32 v7, v30, v31
    v_mfma_f32_16x16x32_bf16 v[188:191], v[84:87], a[172:175], v[188:191]
    ds_read_b64_tr_b16 a[190:191], v231 offset:20992
    v_sub_f32 v32, v32, v50
    v_mfma_f32_16x16x32_bf16 v[192:195], v[88:91], a[160:163], v[192:195]
    s_add_u32 m0, s34, 8192
    s_add_u32 s37, s81, 131072
    buffer_load_dwordx4 v232, s[44:47], s37 offen lds
    v_mfma_f32_16x16x32_bf16 v[196:199], v[92:95], a[160:163], v[196:199]
    v_sub_f32 v33, v33, v50
    v_cvt_pk_bf16_f32 v33, v32, v33
    v_mfma_f32_16x16x32_bf16 v[200:203], v[88:91], a[164:167], v[200:203]
    v_lshlrev_b32 v32, 16, v33
    v_and_b32 v33, 0xffff0000, v33
    v_mfma_f32_16x16x32_bf16 v[204:207], v[92:95], a[164:167], v[204:207]
    v_mul_f32 v32, v32, v51
    v_mul_f32 v33, v33, v51
    v_mfma_f32_16x16x32_bf16 v[208:211], v[88:91], a[168:171], v[208:211]
    buffer_load_dwordx4 v233, s[44:47], s37 offen offset:1024 lds
    v_cvt_pk_bf16_f32 v8, v32, v33
    v_mfma_f32_16x16x32_bf16 v[212:215], v[92:95], a[168:171], v[212:215]
    v_sub_f32 v34, v34, v50
    v_sub_f32 v35, v35, v50
    v_mfma_f32_16x16x32_bf16 v[216:219], v[88:91], a[172:175], v[216:219]
    v_cvt_pk_bf16_f32 v35, v34, v35
    v_lshlrev_b32 v34, 16, v35
    v_mfma_f32_16x16x32_bf16 v[220:223], v[92:95], a[172:175], v[220:223]
    v_and_b32 v35, 0xffff0000, v35
    s_waitcnt vmcnt(14) lgkmcnt(0)
    v_mfma_f32_16x16x32_bf16 v[96:99], v[64:67], a[176:179], v[96:99]
    ds_read_b128 v[80:83], v225 offset:24576
    v_mul_f32 v34, v34, v51
    v_mfma_f32_16x16x32_bf16 v[100:103], v[68:71], a[176:179], v[100:103]
    ds_read_b128 v[84:87], v225 offset:26624
    v_mul_f32 v35, v35, v51
    v_mfma_f32_16x16x32_bf16 v[104:107], v[64:67], a[180:183], v[104:107]
    ds_read_b128 v[88:91], v225 offset:28672
    v_cvt_pk_bf16_f32 v9, v34, v35
    v_mfma_f32_16x16x32_bf16 v[108:111], v[68:71], a[180:183], v[108:111]
    ds_read_b128 v[92:95], v225 offset:30720
    v_sub_f32 v36, v36, v50
    v_mfma_f32_16x16x32_bf16 v[112:115], v[64:67], a[184:187], v[112:115]
    ds_read_b64_tr_b16 a[192:193], v228 offset:0
    v_sub_f32 v37, v37, v50
    v_mfma_f32_16x16x32_bf16 v[116:119], v[68:71], a[184:187], v[116:119]
    ds_read_b64_tr_b16 a[194:195], v228 offset:512
    v_cvt_pk_bf16_f32 v37, v36, v37
    v_mfma_f32_16x16x32_bf16 v[120:123], v[64:67], a[188:191], v[120:123]
    ds_read_b64_tr_b16 a[196:197], v229 offset:0
    v_lshlrev_b32 v36, 16, v37
    v_mfma_f32_16x16x32_bf16 v[124:127], v[68:71], a[188:191], v[124:127]
    ds_read_b64_tr_b16 a[198:199], v229 offset:512
    v_and_b32 v37, 0xffff0000, v37
    v_mfma_f32_16x16x32_bf16 v[128:131], v[72:75], a[176:179], v[128:131]
    v_mul_f32 v36, v36, v51
    v_mul_f32 v37, v37, v51
    v_mfma_f32_16x16x32_bf16 v[132:135], v[76:79], a[176:179], v[132:135]
    v_cvt_pk_bf16_f32 v10, v36, v37
    v_sub_f32 v38, v38, v50
    v_mfma_f32_16x16x32_bf16 v[136:139], v[72:75], a[180:183], v[136:139]
    v_sub_f32 v39, v39, v50
    v_cvt_pk_bf16_f32 v39, v38, v39
    v_lshlrev_b32 v38, 16, v39
    v_mfma_f32_16x16x32_bf16 v[140:143], v[76:79], a[180:183], v[140:143]
    v_and_b32 v39, 0xffff0000, v39
    v_mul_f32 v38, v38, v51
    v_mfma_f32_16x16x32_bf16 v[144:147], v[72:75], a[184:187], v[144:147]
    v_mul_f32 v39, v39, v51
    v_cvt_pk_bf16_f32 v11, v38, v39
    v_mfma_f32_16x16x32_bf16 v[148:151], v[76:79], a[184:187], v[148:151]
    v_sub_f32 v40, v40, v50
    v_sub_f32 v41, v41, v50
    v_mfma_f32_16x16x32_bf16 v[152:155], v[72:75], a[188:191], v[152:155]
    v_cvt_pk_bf16_f32 v41, v40, v41
    v_lshlrev_b32 v40, 16, v41
    v_mfma_f32_16x16x32_bf16 v[156:159], v[76:79], a[188:191], v[156:159]
    s_waitcnt vmcnt(24) lgkmcnt(0)
    s_barrier
    v_mfma_f32_16x16x32_bf16 v[160:163], v[80:83], a[176:179], v[160:163]
    ds_read_b128 v[64:67], v224 offset:32768
    v_and_b32 v41, 0xffff0000, v41
    v_mfma_f32_16x16x32_bf16 v[164:167], v[84:87], a[176:179], v[164:167]
    ds_read_b128 v[68:71], v224 offset:34816
    v_mul_f32 v40, v40, v51
    v_mfma_f32_16x16x32_bf16 v[168:171], v[80:83], a[180:183], v[168:171]
    ds_read_b128 v[72:75], v224 offset:36864
    v_mul_f32 v41, v41, v51
    v_mfma_f32_16x16x32_bf16 v[172:175], v[84:87], a[180:183], v[172:175]
    ds_read_b128 v[76:79], v224 offset:38912
    v_cvt_pk_bf16_f32 v12, v40, v41
    v_mfma_f32_16x16x32_bf16 v[176:179], v[80:83], a[184:187], v[176:179]
    ds_read_b64_tr_b16 a[200:201], v230 offset:0
    v_sub_f32 v42, v42, v50
    v_mfma_f32_16x16x32_bf16 v[180:183], v[84:87], a[184:187], v[180:183]
    ds_read_b64_tr_b16 a[202:203], v230 offset:512
    v_sub_f32 v43, v43, v50
    v_mfma_f32_16x16x32_bf16 v[184:187], v[80:83], a[188:191], v[184:187]
    ds_read_b64_tr_b16 a[204:205], v231 offset:0
    v_cvt_pk_bf16_f32 v43, v42, v43
    v_mfma_f32_16x16x32_bf16 v[188:191], v[84:87], a[188:191], v[188:191]
    ds_read_b64_tr_b16 a[206:207], v231 offset:512
    v_lshlrev_b32 v42, 16, v43
    v_mfma_f32_16x16x32_bf16 v[192:195], v[88:91], a[176:179], v[192:195]
    s_add_u32 m0, s34, 16384
    s_add_u32 s37, s82, 131072
    buffer_load_dwordx4 v232, s[44:47], s37 offen lds
    v_mfma_f32_16x16x32_bf16 v[196:199], v[92:95], a[176:179], v[196:199]
    v_and_b32 v43, 0xffff0000, v43
    v_mul_f32 v42, v42, v51
    v_mfma_f32_16x16x32_bf16 v[200:203], v[88:91], a[180:183], v[200:203]
    v_mul_f32 v43, v43, v51
    v_cvt_pk_bf16_f32 v13, v42, v43
    v_mfma_f32_16x16x32_bf16 v[204:207], v[92:95], a[180:183], v[204:207]
    v_sub_f32 v44, v44, v50
    v_sub_f32 v45, v45, v50
    v_mfma_f32_16x16x32_bf16 v[208:211], v[88:91], a[184:187], v[208:211]
    buffer_load_dwordx4 v233, s[44:47], s37 offen offset:1024 lds
    v_cvt_pk_bf16_f32 v45, v44, v45
    v_mfma_f32_16x16x32_bf16 v[212:215], v[92:95], a[184:187], v[212:215]
    v_lshlrev_b32 v44, 16, v45
    v_and_b32 v45, 0xffff0000, v45
    v_mfma_f32_16x16x32_bf16 v[216:219], v[88:91], a[188:191], v[216:219]
    v_mul_f32 v44, v44, v51
    v_mul_f32 v45, v45, v51
    v_mfma_f32_16x16x32_bf16 v[220:223], v[92:95], a[188:191], v[220:223]
    v_cvt_pk_bf16_f32 v14, v44, v45
    s_waitcnt lgkmcnt(0)
    v_mfma_f32_16x16x32_bf16 v[96:99], v[64:67], a[192:195], v[96:99]
    ds_read_b128 v[80:83], v224 offset:40960
    v_sub_f32 v46, v46, v50
    v_mfma_f32_16x16x32_bf16 v[100:103], v[68:71], a[192:195], v[100:103]
    ds_read_b128 v[84:87], v224 offset:43008
    v_sub_f32 v47, v47, v50
    v_mfma_f32_16x16x32_bf16 v[104:107], v[64:67], a[196:199], v[104:107]
    ds_read_b128 v[88:91], v224 offset:45056
    v_cvt_pk_bf16_f32 v47, v46, v47
    v_mfma_f32_16x16x32_bf16 v[108:111], v[68:71], a[196:199], v[108:111]
    ds_read_b128 v[92:95], v224 offset:47104
    v_lshlrev_b32 v46, 16, v47
    v_mfma_f32_16x16x32_bf16 v[112:115], v[64:67], a[200:203], v[112:115]
    ds_read_b64_tr_b16 a[208:209], v228 offset:4096
    v_and_b32 v47, 0xffff0000, v47
    v_mfma_f32_16x16x32_bf16 v[116:119], v[68:71], a[200:203], v[116:119]
    ds_read_b64_tr_b16 a[210:211], v228 offset:4608
    v_mul_f32 v46, v46, v51
    v_mfma_f32_16x16x32_bf16 v[120:123], v[64:67], a[204:207], v[120:123]
    ds_read_b64_tr_b16 a[212:213], v229 offset:4096
    v_mul_f32 v47, v47, v51
    v_mfma_f32_16x16x32_bf16 v[124:127], v[68:71], a[204:207], v[124:127]
    ds_read_b64_tr_b16 a[214:215], v229 offset:4608
    v_cvt_pk_bf16_f32 v15, v46, v47
    v_mfma_f32_16x16x32_bf16 v[128:131], v[72:75], a[192:195], v[128:131]
    v_mfma_f32_16x16x32_bf16 v[132:135], v[76:79], a[192:195], v[132:135]
    ds_write_b128 v237, v[0:3] offset:0
    v_mfma_f32_16x16x32_bf16 v[136:139], v[72:75], a[196:199], v[136:139]
    ds_write_b128 v237, v[4:7] offset:4096
    v_mfma_f32_16x16x32_bf16 v[140:143], v[76:79], a[196:199], v[140:143]
    ds_write_b128 v237, v[8:11] offset:24576
    v_mfma_f32_16x16x32_bf16 v[144:147], v[72:75], a[200:203], v[144:147]
    ds_write_b128 v237, v[12:15] offset:28672
    v_mfma_f32_16x16x32_bf16 v[148:151], v[76:79], a[200:203], v[148:151]
    v_mfma_f32_16x16x32_bf16 v[152:155], v[72:75], a[204:207], v[152:155]
    v_mfma_f32_16x16x32_bf16 v[156:159], v[76:79], a[204:207], v[156:159]
    s_waitcnt lgkmcnt(0)
    v_mfma_f32_16x16x32_bf16 v[160:163], v[80:83], a[192:195], v[160:163]
    ds_read_b128 v[64:67], v225 offset:32768
    v_mfma_f32_16x16x32_bf16 v[164:167], v[84:87], a[192:195], v[164:167]
    ds_read_b128 v[68:71], v225 offset:34816
    v_mfma_f32_16x16x32_bf16 v[168:171], v[80:83], a[196:199], v[168:171]
    ds_read_b128 v[72:75], v225 offset:36864
    v_mfma_f32_16x16x32_bf16 v[172:175], v[84:87], a[196:199], v[172:175]
    ds_read_b128 v[76:79], v225 offset:38912
    v_mfma_f32_16x16x32_bf16 v[176:179], v[80:83], a[200:203], v[176:179]
    ds_read_b64_tr_b16 a[216:217], v230 offset:4096
    v_mfma_f32_16x16x32_bf16 v[180:183], v[84:87], a[200:203], v[180:183]
    ds_read_b64_tr_b16 a[218:219], v230 offset:4608
    v_mfma_f32_16x16x32_bf16 v[184:187], v[80:83], a[204:207], v[184:187]
    ds_read_b64_tr_b16 a[220:221], v231 offset:4096
    v_mfma_f32_16x16x32_bf16 v[188:191], v[84:87], a[204:207], v[188:191]
    ds_read_b64_tr_b16 a[222:223], v231 offset:4608
    v_mfma_f32_16x16x32_bf16 v[192:195], v[88:91], a[192:195], v[192:195]
    s_add_u32 m0, s34, 24576
    s_add_u32 s37, s83, 131072
    buffer_load_dwordx4 v232, s[44:47], s37 offen lds
    v_mfma_f32_16x16x32_bf16 v[196:199], v[92:95], a[192:195], v[196:199]
    v_mfma_f32_16x16x32_bf16 v[200:203], v[88:91], a[196:199], v[200:203]
    buffer_load_dwordx4 v233, s[44:47], s37 offen offset:1024 lds
    v_mfma_f32_16x16x32_bf16 v[204:207], v[92:95], a[196:199], v[204:207]
    v_mfma_f32_16x16x32_bf16 v[208:211], v[88:91], a[200:203], v[208:211]
    v_mfma_f32_16x16x32_bf16 v[212:215], v[92:95], a[200:203], v[212:215]
    buffer_load_dword v254, off, s[88:91], s97 sc1
    v_mfma_f32_16x16x32_bf16 v[216:219], v[88:91], a[204:207], v[216:219]
    v_mfma_f32_16x16x32_bf16 v[220:223], v[92:95], a[204:207], v[220:223]
    s_waitcnt vmcnt(7) lgkmcnt(0)
    v_mfma_f32_16x16x32_bf16 v[96:99], v[64:67], a[208:211], v[96:99]
    ds_read_b128 v[80:83], v225 offset:40960
    v_mfma_f32_16x16x32_bf16 v[100:103], v[68:71], a[208:211], v[100:103]
    ds_read_b128 v[84:87], v225 offset:43008
    s_mul_i32 s38, s2, 100
    v_mfma_f32_16x16x32_bf16 v[104:107], v[64:67], a[212:215], v[104:107]
    ds_read_b128 v[88:91], v225 offset:45056
    v_mfma_f32_16x16x32_bf16 v[108:111], v[68:71], a[212:215], v[108:111]
    ds_read_b128 v[92:95], v225 offset:47104
    v_mfma_f32_16x16x32_bf16 v[112:115], v[64:67], a[216:219], v[112:115]
    ds_read_b64_tr_b16 a[224:225], v228 offset:8192
    v_lshl_add_u32 v60, v253, 2, s38
    v_mfma_f32_16x16x32_bf16 v[116:119], v[68:71], a[216:219], v[116:119]
    ds_read_b64_tr_b16 a[226:227], v228 offset:8704
    v_mfma_f32_16x16x32_bf16 v[120:123], v[64:67], a[220:223], v[120:123]
    ds_read_b64_tr_b16 a[228:229], v229 offset:8192
    v_mfma_f32_16x16x32_bf16 v[124:127], v[68:71], a[220:223], v[124:127]
    ds_read_b64_tr_b16 a[230:231], v229 offset:8704
    v_cmp_gt_u32 vcc, 25, v253
    v_mfma_f32_16x16x32_bf16 v[128:131], v[72:75], a[208:211], v[128:131]
    v_mov_b32 v61, 0
    v_mfma_f32_16x16x32_bf16 v[132:135], v[76:79], a[208:211], v[132:135]
    v_mfma_f32_16x16x32_bf16 v[136:139], v[72:75], a[212:215], v[136:139]
    v_mov_b32 v62, 0x7ffffff0
    v_mfma_f32_16x16x32_bf16 v[140:143], v[76:79], a[212:215], v[140:143]
    v_cndmask_b32 v60, v62, v60, vcc
    v_mfma_f32_16x16x32_bf16 v[144:147], v[72:75], a[216:219], v[144:147]
    v_mfma_f32_16x16x32_bf16 v[148:151], v[76:79], a[216:219], v[148:151]
    buffer_store_dword v61, v60, s[56:59], 0 offen sc1
    v_mfma_f32_16x16x32_bf16 v[152:155], v[72:75], a[220:223], v[152:155]
    v_mfma_f32_16x16x32_bf16 v[156:159], v[76:79], a[220:223], v[156:159]
    s_waitcnt vmcnt(18) lgkmcnt(0)
    s_barrier
    v_mfma_f32_16x16x32_bf16 v[160:163], v[80:83], a[208:211], v[160:163]
    ds_read_b128 v[64:67], v224 offset:49152
    v_mfma_f32_16x16x32_bf16 v[164:167], v[84:87], a[208:211], v[164:167]
    ds_read_b128 v[68:71], v224 offset:51200
    v_mfma_f32_16x16x32_bf16 v[168:171], v[80:83], a[212:215], v[168:171]
    ds_read_b128 v[72:75], v224 offset:53248
    v_mfma_f32_16x16x32_bf16 v[172:175], v[84:87], a[212:215], v[172:175]
    ds_read_b128 v[76:79], v224 offset:55296
    v_mfma_f32_16x16x32_bf16 v[176:179], v[80:83], a[216:219], v[176:179]
    ds_read_b64_tr_b16 a[232:233], v230 offset:8192
    v_mfma_f32_16x16x32_bf16 v[180:183], v[84:87], a[216:219], v[180:183]
    ds_read_b64_tr_b16 a[234:235], v230 offset:8704
    v_mfma_f32_16x16x32_bf16 v[184:187], v[80:83], a[220:223], v[184:187]
    ds_read_b64_tr_b16 a[236:237], v231 offset:8192
    v_mfma_f32_16x16x32_bf16 v[188:191], v[84:87], a[220:223], v[188:191]
    ds_read_b64_tr_b16 a[238:239], v231 offset:8704
    v_mfma_f32_16x16x32_bf16 v[192:195], v[88:91], a[208:211], v[192:195]
    v_lshlrev_b32 v237, 4, v253
    v_add_u32 v237, 81920, v237
    ds_read_b128 v[16:19], v237 offset:0
    ds_read_b128 v[20:23], v237 offset:4096
    ds_read_b128 v[24:27], v237 offset:24576
    ds_read_b128 v[28:31], v237 offset:28672
    s_add_u32 m0, s34, 32768
    s_add_u32 s37, s84, 131072
    buffer_load_dwordx4 v232, s[44:47], s37 offen lds
    v_mfma_f32_16x16x32_bf16 v[196:199], v[92:95], a[208:211], v[196:199]
    v_mfma_f32_16x16x32_bf16 v[200:203], v[88:91], a[212:215], v[200:203]
    v_mfma_f32_16x16x32_bf16 v[204:207], v[92:95], a[212:215], v[204:207]
    v_mfma_f32_16x16x32_bf16 v[208:211], v[88:91], a[216:219], v[208:211]
    buffer_load_dwordx4 v233, s[44:47], s37 offen offset:1024 lds
    v_mfma_f32_16x16x32_bf16 v[212:215], v[92:95], a[216:219], v[212:215]
    v_mfma_f32_16x16x32_bf16 v[216:219], v[88:91], a[220:223], v[216:219]
    v_mfma_f32_16x16x32_bf16 v[220:223], v[92:95], a[220:223], v[220:223]
    s_waitcnt lgkmcnt(0)
    v_mfma_f32_16x16x32_bf16 v[96:99], v[64:67], a[224:227], v[96:99]
    ds_read_b128 v[80:83], v224 offset:57344
    v_mfma_f32_16x16x32_bf16 v[100:103], v[68:71], a[224:227], v[100:103]
    ds_read_b128 v[84:87], v224 offset:59392
    v_mfma_f32_16x16x32_bf16 v[104:107], v[64:67], a[228:231], v[104:107]
    ds_read_b128 v[88:91], v224 offset:61440
    v_mfma_f32_16x16x32_bf16 v[108:111], v[68:71], a[228:231], v[108:111]
    ds_read_b128 v[92:95], v224 offset:63488
    v_mfma_f32_16x16x32_bf16 v[112:115], v[64:67], a[232:235], v[112:115]
    ds_read_b64_tr_b16 a[240:241], v228 offset:12288
    v_mfma_f32_16x16x32_bf16 v[116:119], v[68:71], a[232:235], v[116:119]
    ds_read_b64_tr_b16 a[242:243], v228 offset:12800
    s_mov_b32 s39, 0
    buffer_store_dwordx4 v[16:19], v238, s[8:11], s39 offen sc1
    v_mfma_f32_16x16x32_bf16 v[120:123], v[64:67], a[236:239], v[120:123]
    ds_read_b64_tr_b16 a[244:245], v229 offset:12288
    v_mfma_f32_16x16x32_bf16 v[124:127], v[68:71], a[236:239], v[124:127]
    ds_read_b64_tr_b16 a[246:247], v229 offset:12800
    v_mfma_f32_16x16x32_bf16 v[128:131], v[72:75], a[224:227], v[128:131]
    v_mfma_f32_16x16x32_bf16 v[132:135], v[76:79], a[224:227], v[132:135]
    v_mfma_f32_16x16x32_bf16 v[136:139], v[72:75], a[228:231], v[136:139]
    v_mfma_f32_16x16x32_bf16 v[140:143], v[76:79], a[228:231], v[140:143]
    v_mfma_f32_16x16x32_bf16 v[144:147], v[72:75], a[232:235], v[144:147]
    v_mfma_f32_16x16x32_bf16 v[148:151], v[76:79], a[232:235], v[148:151]
    s_mov_b32 s39, 8192
    buffer_store_dwordx4 v[20:23], v238, s[8:11], s39 offen sc1
    v_mfma_f32_16x16x32_bf16 v[152:155], v[72:75], a[236:239], v[152:155]
    v_mfma_f32_16x16x32_bf16 v[156:159], v[76:79], a[236:239], v[156:159]
    s_waitcnt lgkmcnt(0)
    v_mfma_f32_16x16x32_bf16 v[160:163], v[80:83], a[224:227], v[160:163]
    ds_read_b128 v[64:67], v225 offset:49152
    v_mfma_f32_16x16x32_bf16 v[164:167], v[84:87], a[224:227], v[164:167]
    ds_read_b128 v[68:71], v225 offset:51200
    v_mfma_f32_16x16x32_bf16 v[168:171], v[80:83], a[228:231], v[168:171]
    ds_read_b128 v[72:75], v225 offset:53248
    v_mfma_f32_16x16x32_bf16 v[172:175], v[84:87], a[228:231], v[172:175]
    ds_read_b128 v[76:79], v225 offset:55296
    v_mfma_f32_16x16x32_bf16 v[176:179], v[80:83], a[232:235], v[176:179]
    ds_read_b64_tr_b16 a[248:249], v230 offset:12288
    v_mfma_f32_16x16x32_bf16 v[180:183], v[84:87], a[232:235], v[180:183]
    ds_read_b64_tr_b16 a[250:251], v230 offset:12800
    s_mov_b32 s39, 16384
    buffer_store_dwordx4 v[24:27], v238, s[8:11], s39 offen sc1
    v_mfma_f32_16x16x32_bf16 v[184:187], v[80:83], a[236:239], v[184:187]
    ds_read_b64_tr_b16 a[252:253], v231 offset:12288
    v_mfma_f32_16x16x32_bf16 v[188:191], v[84:87], a[236:239], v[188:191]
    ds_read_b64_tr_b16 a[254:255], v231 offset:12800
    v_mfma_f32_16x16x32_bf16 v[192:195], v[88:91], a[224:227], v[192:195]
    s_add_u32 m0, s34, 40960
    s_add_u32 s37, s85, 131072
    buffer_load_dwordx4 v232, s[44:47], s37 offen lds
    v_mfma_f32_16x16x32_bf16 v[196:199], v[92:95], a[224:227], v[196:199]
    v_mfma_f32_16x16x32_bf16 v[200:203], v[88:91], a[228:231], v[200:203]
    v_mfma_f32_16x16x32_bf16 v[204:207], v[92:95], a[228:231], v[204:207]
    v_mfma_f32_16x16x32_bf16 v[208:211], v[88:91], a[232:235], v[208:211]
    buffer_load_dwordx4 v233, s[44:47], s37 offen offset:1024 lds
    v_mfma_f32_16x16x32_bf16 v[212:215], v[92:95], a[232:235], v[212:215]
    s_mov_b32 s39, 24576
    buffer_store_dwordx4 v[28:31], v238, s[8:11], s39 offen sc1
    v_mfma_f32_16x16x32_bf16 v[216:219], v[88:91], a[236:239], v[216:219]
    v_mfma_f32_16x16x32_bf16 v[220:223], v[92:95], a[236:239], v[220:223]
    s_waitcnt lgkmcnt(0)
    v_mfma_f32_16x16x32_bf16 v[96:99], v[64:67], a[240:243], v[96:99]
    ds_read_b128 v[80:83], v225 offset:57344
    v_mfma_f32_16x16x32_bf16 v[100:103], v[68:71], a[240:243], v[100:103]
    ds_read_b128 v[84:87], v225 offset:59392
    v_mfma_f32_16x16x32_bf16 v[104:107], v[64:67], a[244:247], v[104:107]
    ds_read_b128 v[88:91], v225 offset:61440
    v_mfma_f32_16x16x32_bf16 v[108:111], v[68:71], a[244:247], v[108:111]
    ds_read_b128 v[92:95], v225 offset:63488
    v_mfma_f32_16x16x32_bf16 v[112:115], v[64:67], a[248:251], v[112:115]
    v_mfma_f32_16x16x32_bf16 v[116:119], v[68:71], a[248:251], v[116:119]
    v_mfma_f32_16x16x32_bf16 v[120:123], v[64:67], a[252:255], v[120:123]
    v_mfma_f32_16x16x32_bf16 v[124:127], v[68:71], a[252:255], v[124:127]
    v_mfma_f32_16x16x32_bf16 v[128:131], v[72:75], a[240:243], v[128:131]
    v_mfma_f32_16x16x32_bf16 v[132:135], v[76:79], a[240:243], v[132:135]
    v_cvt_pk_bf16_f32 v0, v96, v97
    v_cvt_pk_bf16_f32 v1, v98, v99
    v_mfma_f32_16x16x32_bf16 v[136:139], v[72:75], a[244:247], v[136:139]
    v_cvt_pk_bf16_f32 v2, v100, v101
    v_cvt_pk_bf16_f32 v3, v102, v103
    v_mfma_f32_16x16x32_bf16 v[140:143], v[76:79], a[244:247], v[140:143]
    v_cvt_pk_bf16_f32 v4, v104, v105
    v_cvt_pk_bf16_f32 v5, v106, v107
    v_mfma_f32_16x16x32_bf16 v[144:147], v[72:75], a[248:251], v[144:147]
    v_cvt_pk_bf16_f32 v6, v108, v109
    v_cvt_pk_bf16_f32 v7, v110, v111
    v_mfma_f32_16x16x32_bf16 v[148:151], v[76:79], a[248:251], v[148:151]
    v_cvt_pk_bf16_f32 v8, v112, v113
    v_cvt_pk_bf16_f32 v9, v114, v115
    v_mfma_f32_16x16x32_bf16 v[152:155], v[72:75], a[252:255], v[152:155]
    v_cvt_pk_bf16_f32 v10, v116, v117
    v_cvt_pk_bf16_f32 v11, v118, v119
    v_mfma_f32_16x16x32_bf16 v[156:159], v[76:79], a[252:255], v[156:159]
    v_cvt_pk_bf16_f32 v12, v120, v121
    v_cvt_pk_bf16_f32 v13, v122, v123
    s_waitcnt vmcnt(14) lgkmcnt(0)
    s_barrier
    v_mfma_f32_16x16x32_bf16 v[160:163], v[80:83], a[240:243], v[160:163]
    ds_read_b128 v[64:67], v224 offset:0
    v_cvt_pk_bf16_f32 v14, v124, v125
    v_cvt_pk_bf16_f32 v15, v126, v127
    v_mfma_f32_16x16x32_bf16 v[164:167], v[84:87], a[240:243], v[164:167]
    ds_read_b128 v[68:71], v224 offset:2048
    v_cvt_pk_bf16_f32 v16, v128, v129
    v_cvt_pk_bf16_f32 v17, v130, v131
    v_mfma_f32_16x16x32_bf16 v[168:171], v[80:83], a[244:247], v[168:171]
    ds_read_b128 v[72:75], v224 offset:4096
    v_cvt_pk_bf16_f32 v18, v132, v133
    v_cvt_pk_bf16_f32 v19, v134, v135
    v_mfma_f32_16x16x32_bf16 v[172:175], v[84:87], a[244:247], v[172:175]
    ds_read_b128 v[76:79], v224 offset:6144
    v_cvt_pk_bf16_f32 v20, v136, v137
    v_cvt_pk_bf16_f32 v21, v138, v139
    v_mfma_f32_16x16x32_bf16 v[176:179], v[80:83], a[248:251], v[176:179]
    v_cvt_pk_bf16_f32 v22, v140, v141
    v_cvt_pk_bf16_f32 v23, v142, v143
    v_mfma_f32_16x16x32_bf16 v[180:183], v[84:87], a[248:251], v[180:183]
    v_cvt_pk_bf16_f32 v24, v144, v145
    v_cvt_pk_bf16_f32 v25, v146, v147
    v_mfma_f32_16x16x32_bf16 v[184:187], v[80:83], a[252:255], v[184:187]
    v_cvt_pk_bf16_f32 v26, v148, v149
    v_cvt_pk_bf16_f32 v27, v150, v151
    v_mfma_f32_16x16x32_bf16 v[188:191], v[84:87], a[252:255], v[188:191]
    v_cvt_pk_bf16_f32 v28, v152, v153
    v_cvt_pk_bf16_f32 v29, v154, v155
    v_mfma_f32_16x16x32_bf16 v[192:195], v[88:91], a[240:243], v[192:195]
    s_add_u32 m0, s34, 49152
    s_add_u32 s37, s86, 131072
    buffer_load_dwordx4 v232, s[44:47], s37 offen lds
    v_cvt_pk_bf16_f32 v30, v156, v157
    v_cvt_pk_bf16_f32 v31, v158, v159
    v_mfma_f32_16x16x32_bf16 v[196:199], v[92:95], a[240:243], v[196:199]
    v_cvt_pk_bf16_f32 v32, v160, v161
    v_cvt_pk_bf16_f32 v33, v162, v163
    v_mfma_f32_16x16x32_bf16 v[200:203], v[88:91], a[244:247], v[200:203]
    v_cvt_pk_bf16_f32 v34, v164, v165
    v_cvt_pk_bf16_f32 v35, v166, v167
    v_mfma_f32_16x16x32_bf16 v[204:207], v[92:95], a[244:247], v[204:207]
    v_cvt_pk_bf16_f32 v36, v168, v169
    v_cvt_pk_bf16_f32 v37, v170, v171
    v_mfma_f32_16x16x32_bf16 v[208:211], v[88:91], a[248:251], v[208:211]
    buffer_load_dwordx4 v233, s[44:47], s37 offen offset:1024 lds
    v_cvt_pk_bf16_f32 v38, v172, v173
    v_cvt_pk_bf16_f32 v39, v174, v175
    v_mfma_f32_16x16x32_bf16 v[212:215], v[92:95], a[248:251], v[212:215]
    v_cvt_pk_bf16_f32 v40, v176, v177
    v_cvt_pk_bf16_f32 v41, v178, v179
    v_mfma_f32_16x16x32_bf16 v[216:219], v[88:91], a[252:255], v[216:219]
    v_cvt_pk_bf16_f32 v42, v180, v181
    v_cvt_pk_bf16_f32 v43, v182, v183
    v_mfma_f32_16x16x32_bf16 v[220:223], v[92:95], a[252:255], v[220:223]
    v_cvt_pk_bf16_f32 v44, v184, v185
    v_cvt_pk_bf16_f32 v45, v186, v187
    s_waitcnt lgkmcnt(0)
    v_mfma_f32_16x16x32_bf16 v[96:99], v[64:67], a[0:3], 0
    ds_read_b128 v[80:83], v225 offset:0
    v_cvt_pk_bf16_f32 v46, v188, v189
    v_cvt_pk_bf16_f32 v47, v190, v191
    v_mfma_f32_16x16x32_bf16 v[100:103], v[68:71], a[0:3], 0
    ds_read_b128 v[84:87], v225 offset:2048
    v_cvt_pk_bf16_f32 v48, v192, v193
    v_cvt_pk_bf16_f32 v49, v194, v195
    v_mfma_f32_16x16x32_bf16 v[104:107], v[64:67], a[4:7], 0
    ds_read_b128 v[88:91], v225 offset:4096
    v_cvt_pk_bf16_f32 v50, v196, v197
    v_cvt_pk_bf16_f32 v51, v198, v199
    v_mfma_f32_16x16x32_bf16 v[108:111], v[68:71], a[4:7], 0
    ds_read_b128 v[92:95], v225 offset:6144
    v_cvt_pk_bf16_f32 v52, v200, v201
    v_cvt_pk_bf16_f32 v53, v202, v203
    v_mfma_f32_16x16x32_bf16 v[112:115], v[64:67], a[8:11], 0
    v_cvt_pk_bf16_f32 v54, v204, v205
    v_cvt_pk_bf16_f32 v55, v206, v207
    s_add_u32 s38, s36, 0
    buffer_store_dwordx4 v[0:3], v240, s[16:19], s38 offen offset:0 sc1
    v_mfma_f32_16x16x32_bf16 v[116:119], v[68:71], a[8:11], 0
    v_cvt_pk_bf16_f32 v56, v208, v209
    v_cvt_pk_bf16_f32 v57, v210, v211
    v_mfma_f32_16x16x32_bf16 v[120:123], v[64:67], a[12:15], 0
    v_cvt_pk_bf16_f32 v58, v212, v213
    v_cvt_pk_bf16_f32 v59, v214, v215
    v_mfma_f32_16x16x32_bf16 v[124:127], v[68:71], a[12:15], 0
    v_cvt_pk_bf16_f32 v60, v216, v217
    v_cvt_pk_bf16_f32 v61, v218, v219
    v_mfma_f32_16x16x32_bf16 v[128:131], v[72:75], a[0:3], 0
    v_xor_b32 v237, 16, v245
    v_xor_b32 v238, 16, v246
    v_cvt_pk_bf16_f32 v62, v220, v221
    v_cvt_pk_bf16_f32 v63, v222, v223
    v_mfma_f32_16x16x32_bf16 v[132:135], v[76:79], a[0:3], 0
    v_mfma_f32_16x16x32_bf16 v[136:139], v[72:75], a[4:7], 0
    v_mfma_f32_16x16x32_bf16 v[140:143], v[76:79], a[4:7], 0
    v_mfma_f32_16x16x32_bf16 v[144:147], v[72:75], a[8:11], 0
    v_mfma_f32_16x16x32_bf16 v[148:151], v[76:79], a[8:11], 0
    v_mfma_f32_16x16x32_bf16 v[152:155], v[72:75], a[12:15], 0
    v_mfma_f32_16x16x32_bf16 v[156:159], v[76:79], a[12:15], 0
    s_waitcnt lgkmcnt(0)
    v_mfma_f32_16x16x32_bf16 v[96:99], v[80:83], a[16:19], v[96:99]
    ds_read_b128 v[64:67], v224 offset:8192
    v_mfma_f32_16x16x32_bf16 v[100:103], v[84:87], a[16:19], v[100:103]
    ds_read_b128 v[68:71], v224 offset:10240
    v_mfma_f32_16x16x32_bf16 v[104:107], v[80:83], a[20:23], v[104:107]
    ds_read_b128 v[72:75], v224 offset:12288
    v_mfma_f32_16x16x32_bf16 v[108:111], v[84:87], a[20:23], v[108:111]
    ds_read_b128 v[76:79], v224 offset:14336
    v_mfma_f32_16x16x32_bf16 v[112:115], v[80:83], a[24:27], v[112:115]
    v_mfma_f32_16x16x32_bf16 v[116:119], v[84:87], a[24:27], v[116:119]
    v_mfma_f32_16x16x32_bf16 v[120:123], v[80:83], a[28:31], v[120:123]
    v_mfma_f32_16x16x32_bf16 v[124:127], v[84:87], a[28:31], v[124:127]
    v_mfma_f32_16x16x32_bf16 v[128:131], v[88:91], a[16:19], v[128:131]
    s_add_u32 m0, s34, 57344
    s_add_u32 s37, s87, 131072
    buffer_load_dwordx4 v232, s[44:47], s37 offen lds
    v_mfma_f32_16x16x32_bf16 v[132:135], v[92:95], a[16:19], v[132:135]
    s_add_u32 s38, s36, 0
    buffer_store_dwordx4 v[4:7], v240, s[16:19], s38 offen offset:1024 sc1
    v_mfma_f32_16x16x32_bf16 v[136:139], v[88:91], a[20:23], v[136:139]
    v_mfma_f32_16x16x32_bf16 v[140:143], v[92:95], a[20:23], v[140:143]
    v_mfma_f32_16x16x32_bf16 v[144:147], v[88:91], a[24:27], v[144:147]
    buffer_load_dwordx4 v233, s[44:47], s37 offen offset:1024 lds
    v_mfma_f32_16x16x32_bf16 v[148:151], v[92:95], a[24:27], v[148:151]
    v_mfma_f32_16x16x32_bf16 v[152:155], v[88:91], a[28:31], v[152:155]
    v_mfma_f32_16x16x32_bf16 v[156:159], v[92:95], a[28:31], v[156:159]
    s_waitcnt lgkmcnt(0)
    v_mfma_f32_16x16x32_bf16 v[96:99], v[64:67], a[32:35], v[96:99]
    ds_read_b128 v[80:83], v225 offset:8192
    v_mfma_f32_16x16x32_bf16 v[100:103], v[68:71], a[32:35], v[100:103]
    ds_read_b128 v[84:87], v225 offset:10240
    v_mfma_f32_16x16x32_bf16 v[104:107], v[64:67], a[36:39], v[104:107]
    ds_read_b128 v[88:91], v225 offset:12288
    v_mfma_f32_16x16x32_bf16 v[108:111], v[68:71], a[36:39], v[108:111]
    ds_read_b128 v[92:95], v225 offset:14336
    v_mfma_f32_16x16x32_bf16 v[112:115], v[64:67], a[40:43], v[112:115]
    v_mfma_f32_16x16x32_bf16 v[116:119], v[68:71], a[40:43], v[116:119]
    v_mfma_f32_16x16x32_bf16 v[120:123], v[64:67], a[44:47], v[120:123]
    v_mfma_f32_16x16x32_bf16 v[124:127], v[68:71], a[44:47], v[124:127]
    v_mfma_f32_16x16x32_bf16 v[128:131], v[72:75], a[32:35], v[128:131]
    s_waitcnt vmcnt(15)
    v_readfirstlane_b32 s24, v254
    s_lshl_b32 s25, s3, 16
    s_add_u32 s24, s24, s25
    s_cmp_ge_u32 s24, 1
    s_cbranch_scc0 kf_spin35
kf_spinr36:
    v_mfma_f32_16x16x32_bf16 v[132:135], v[76:79], a[32:35], v[132:135]
    v_mfma_f32_16x16x32_bf16 v[136:139], v[72:75], a[36:39], v[136:139]
    v_mfma_f32_16x16x32_bf16 v[140:143], v[76:79], a[36:39], v[140:143]
    v_mfma_f32_16x16x32_bf16 v[144:147], v[72:75], a[40:43], v[144:147]
    s_add_u32 s88, s20, 0x14a0000
    s_addc_u32 s89, s21, 0
    s_mov_b32 s90, 20480
    v_mfma_f32_16x16x32_bf16 v[148:151], v[76:79], a[40:43], v[148:151]
    v_mfma_f32_16x16x32_bf16 v[152:155], v[72:75], a[44:47], v[152:155]
    v_mfma_f32_16x16x32_bf16 v[156:159], v[76:79], a[44:47], v[156:159]
    s_add_u32 s38, s36, 0
    buffer_store_dwordx4 v[8:11], v240, s[16:19], s38 offen offset:2048 sc1
    s_waitcnt vmcnt(7) lgkmcnt(0)
    s_barrier
    v_mfma_f32_16x16x32_bf16 v[96:99], v[80:83], a[48:51], v[96:99]
    ds_read_b128 v[64:67], v224 offset:16384
    v_mfma_f32_16x16x32_bf16 v[100:103], v[84:87], a[48:51], v[100:103]
    ds_read_b128 v[68:71], v224 offset:18432
    v_mfma_f32_16x16x32_bf16 v[104:107], v[80:83], a[52:55], v[104:107]
    ds_read_b128 v[72:75], v224 offset:20480
    v_mfma_f32_16x16x32_bf16 v[108:111], v[84:87], a[52:55], v[108:111]
    ds_read_b128 v[76:79], v224 offset:22528
    v_mfma_f32_16x16x32_bf16 v[112:115], v[80:83], a[56:59], v[112:115]
    v_mfma_f32_16x16x32_bf16 v[116:119], v[84:87], a[56:59], v[116:119]
    v_mfma_f32_16x16x32_bf16 v[120:123], v[80:83], a[60:63], v[120:123]
    v_mfma_f32_16x16x32_bf16 v[124:127], v[84:87], a[60:63], v[124:127]
    v_mfma_f32_16x16x32_bf16 v[128:131], v[88:91], a[48:51], v[128:131]
    s_add_u32 m0, s34, 0
    s_add_u32 s37, s80, 196608
    buffer_load_dwordx4 v232, s[44:47], s37 offen lds
    v_mfma_f32_16x16x32_bf16 v[132:135], v[92:95], a[48:51], v[132:135]
    v_mfma_f32_16x16x32_bf16 v[136:139], v[88:91], a[52:55], v[136:139]
    buffer_load_dwordx4 v233, s[44:47], s37 offen offset:1024 lds
    v_mfma_f32_16x16x32_bf16 v[140:143], v[92:95], a[52:55], v[140:143]
    v_mfma_f32_16x16x32_bf16 v[144:147], v[88:91], a[56:59], v[144:147]
    v_mfma_f32_16x16x32_bf16 v[148:151], v[92:95], a[56:59], v[148:151]
    s_lshl_b32 s39, s5, 7
    s_add_u32 s39, s39, 8192
    buffer_atomic_add v255, v250, s[88:91], s39 offen sc1
    s_cmp_eq_u32 s3, 0
    s_cselect_b32 s39, s39, s43
    v_mfma_f32_16x16x32_bf16 v[152:155], v[88:91], a[60:63], v[152:155]
    v_mfma_f32_16x16x32_bf16 v[156:159], v[92:95], a[60:63], v[156:159]
    s_waitcnt lgkmcnt(0)
    v_mfma_f32_16x16x32_bf16 v[96:99], v[64:67], a[64:67], v[96:99]
    ds_read_b128 v[80:83], v225 offset:16384
    v_mfma_f32_16x16x32_bf16 v[100:103], v[68:71], a[64:67], v[100:103]
    ds_read_b128 v[84:87], v225 offset:18432
    v_mfma_f32_16x16x32_bf16 v[104:107], v[64:67], a[68:71], v[104:107]
    ds_read_b128 v[88:91], v225 offset:20480
    v_mfma_f32_16x16x32_bf16 v[108:111], v[68:71], a[68:71], v[108:111]
    ds_read_b128 v[92:95], v225 offset:22528
    v_mfma_f32_16x16x32_bf16 v[112:115], v[64:67], a[72:75], v[112:115]
    s_add_u32 s38, s36, 0
    buffer_store_dwordx4 v[12:15], v240, s[16:19], s38 offen offset:3072 sc1
    v_mfma_f32_16x16x32_bf16 v[116:119], v[68:71], a[72:75], v[116:119]
    v_mfma_f32_16x16x32_bf16 v[120:123], v[64:67], a[76:79], v[120:123]
    v_mfma_f32_16x16x32_bf16 v[124:127], v[68:71], a[76:79], v[124:127]
    v_mfma_f32_16x16x32_bf16 v[128:131], v[72:75], a[64:67], v[128:131]
    s_add_u32 m0, s31, 0
    s_add_u32 s24, s27, 0
    buffer_load_dwordx4 v245, s[12:15], s24 offen lds
    v_mfma_f32_16x16x32_bf16 v[132:135], v[76:79], a[64:67], v[132:135]
    v_mfma_f32_16x16x32_bf16 v[136:139], v[72:75], a[68:71], v[136:139]
    v_mfma_f32_16x16x32_bf16 v[140:143], v[76:79], a[68:71], v[140:143]
    v_mfma_f32_16x16x32_bf16 v[144:147], v[72:75], a[72:75], v[144:147]
    v_mfma_f32_16x16x32_bf16 v[148:151], v[76:79], a[72:75], v[148:151]
    v_mfma_f32_16x16x32_bf16 v[152:155], v[72:75], a[76:79], v[152:155]
    v_mfma_f32_16x16x32_bf16 v[156:159], v[76:79], a[76:79], v[156:159]
    s_waitcnt lgkmcnt(0)
    v_mfma_f32_16x16x32_bf16 v[96:99], v[80:83], a[80:83], v[96:99]
    ds_read_b128 v[64:67], v224 offset:24576
    v_mfma_f32_16x16x32_bf16 v[100:103], v[84:87], a[80:83], v[100:103]
    ds_read_b128 v[68:71], v224 offset:26624
    v_mfma_f32_16x16x32_bf16 v[104:107], v[80:83], a[84:87], v[104:107]
    ds_read_b128 v[72:75], v224 offset:28672
    v_mfma_f32_16x16x32_bf16 v[108:111], v[84:87], a[84:87], v[108:111]
    ds_read_b128 v[76:79], v224 offset:30720
    v_mfma_f32_16x16x32_bf16 v[112:115], v[80:83], a[88:91], v[112:115]
    v_mfma_f32_16x16x32_bf16 v[116:119], v[84:87], a[88:91], v[116:119]
    v_mfma_f32_16x16x32_bf16 v[120:123], v[80:83], a[92:95], v[120:123]
    v_mfma_f32_16x16x32_bf16 v[124:127], v[84:87], a[92:95], v[124:127]
    v_mfma_f32_16x16x32_bf16 v[128:131], v[88:91], a[80:83], v[128:131]
    s_add_u32 m0, s34, 8192
    s_add_u32 s37, s81, 196608
    buffer_load_dwordx4 v232, s[44:47], s37 offen lds
    v_mfma_f32_16x16x32_bf16 v[132:135], v[92:95], a[80:83], v[132:135]
    v_mfma_f32_16x16x32_bf16 v[136:139], v[88:91], a[84:87], v[136:139]
    buffer_load_dwordx4 v233, s[44:47], s37 offen offset:1024 lds
    s_add_u32 s38, s36, 8192
    buffer_store_dwordx4 v[16:19], v240, s[16:19], s38 offen offset:0 sc1
    v_mfma_f32_16x16x32_bf16 v[140:143], v[92:95], a[84:87], v[140:143]
    v_mfma_f32_16x16x32_bf16 v[144:147], v[88:91], a[88:91], v[144:147]
    v_mfma_f32_16x16x32_bf16 v[148:151], v[92:95], a[88:91], v[148:151]
    s_add_u32 m0, s31, 1024
    s_add_u32 s24, s27, 32768
    buffer_load_dwordx4 v245, s[12:15], s24 offen lds
    v_mfma_f32_16x16x32_bf16 v[152:155], v[88:91], a[92:95], v[152:155]
    v_mfma_f32_16x16x32_bf16 v[156:159], v[92:95], a[92:95], v[156:159]
    s_waitcnt lgkmcnt(0)
    v_mfma_f32_16x16x32_bf16 v[96:99], v[64:67], a[96:99], v[96:99]
    ds_read_b128 v[80:83], v225 offset:24576
    v_mfma_f32_16x16x32_bf16 v[100:103], v[68:71], a[96:99], v[100:103]
    ds_read_b128 v[84:87], v225 offset:26624
    v_mfma_f32_16x16x32_bf16 v[104:107], v[64:67], a[100:103], v[104:107]
    ds_read_b128 v[88:91], v225 offset:28672
    v_mfma_f32_16x16x32_bf16 v[108:111], v[68:71], a[100:103], v[108:111]
    ds_read_b128 v[92:95], v225 offset:30720
    v_mfma_f32_16x16x32_bf16 v[112:115], v[64:67], a[104:107], v[112:115]
    v_mfma_f32_16x16x32_bf16 v[116:119], v[68:71], a[104:107], v[116:119]
    v_mfma_f32_16x16x32_bf16 v[120:123], v[64:67], a[108:111], v[120:123]
    v_mfma_f32_16x16x32_bf16 v[124:127], v[68:71], a[108:111], v[124:127]
    v_mfma_f32_16x16x32_bf16 v[128:131], v[72:75], a[96:99], v[128:131]
    s_add_u32 m0, s31, 2048
    s_add_u32 s24, s27, 65536
    buffer_load_dwordx4 v237, s[12:15], s24 offen lds
    v_mfma_f32_16x16x32_bf16 v[132:135], v[76:79], a[96:99], v[132:135]
    v_mfma_f32_16x16x32_bf16 v[136:139], v[72:75], a[100:103], v[136:139]
    v_mfma_f32_16x16x32_bf16 v[140:143], v[76:79], a[100:103], v[140:143]
    v_mfma_f32_16x16x32_bf16 v[144:147], v[72:75], a[104:107], v[144:147]
    v_mfma_f32_16x16x32_bf16 v[148:151], v[76:79], a[104:107], v[148:151]
    v_mfma_f32_16x16x32_bf16 v[152:155], v[72:75], a[108:111], v[152:155]
    v_mfma_f32_16x16x32_bf16 v[156:159], v[76:79], a[108:111], v[156:159]
    s_add_u32 s38, s36, 8192
    buffer_store_dwordx4 v[20:23], v240, s[16:19], s38 offen offset:1024 sc1
    s_waitcnt vmcnt(19) lgkmcnt(0)
    s_barrier
    v_mfma_f32_16x16x32_bf16 v[96:99], v[80:83], a[112:115], v[96:99]
    ds_read_b128 v[64:67], v224 offset:32768
    v_mfma_f32_16x16x32_bf16 v[100:103], v[84:87], a[112:115], v[100:103]
    ds_read_b128 v[68:71], v224 offset:34816
    v_mfma_f32_16x16x32_bf16 v[104:107], v[80:83], a[116:119], v[104:107]
    ds_read_b128 v[72:75], v224 offset:36864
    v_mfma_f32_16x16x32_bf16 v[108:111], v[84:87], a[116:119], v[108:111]
    ds_read_b128 v[76:79], v224 offset:38912
    v_mfma_f32_16x16x32_bf16 v[112:115], v[80:83], a[120:123], v[112:115]
    v_mfma_f32_16x16x32_bf16 v[116:119], v[84:87], a[120:123], v[116:119]
    v_mfma_f32_16x16x32_bf16 v[120:123], v[80:83], a[124:127], v[120:123]
    v_mfma_f32_16x16x32_bf16 v[124:127], v[84:87], a[124:127], v[124:127]
    v_mfma_f32_16x16x32_bf16 v[128:131], v[88:91], a[112:115], v[128:131]
    s_add_u32 m0, s34, 16384
    s_add_u32 s37, s82, 196608
    buffer_load_dwordx4 v232, s[44:47], s37 offen lds
    v_mfma_f32_16x16x32_bf16 v[132:135], v[92:95], a[112:115], v[132:135]
    v_mfma_f32_16x16x32_bf16 v[136:139], v[88:91], a[116:119], v[136:139]
    buffer_load_dwordx4 v233, s[44:47], s37 offen offset:1024 lds
    v_mfma_f32_16x16x32_bf16 v[140:143], v[92:95], a[116:119], v[140:143]
    v_mfma_f32_16x16x32_bf16 v[144:147], v[88:91], a[120:123], v[144:147]
    v_mfma_f32_16x16x32_bf16 v[148:151], v[92:95], a[120:123], v[148:151]
    s_add_u32 m0, s31, 3072
    s_add_u32 s24, s27, 98304
    buffer_load_dwordx4 v237, s[12:15], s24 offen lds
    v_mfma_f32_16x16x32_bf16 v[152:155], v[88:91], a[124:127], v[152:155]
    v_mfma_f32_16x16x32_bf16 v[156:159], v[92:95], a[124:127], v[156:159]
    s_waitcnt lgkmcnt(0)
    v_mfma_f32_16x16x32_bf16 v[96:99], v[64:67], a[128:131], v[96:99]
    ds_read_b128 v[80:83], v225 offset:32768
    v_mfma_f32_16x16x32_bf16 v[100:103], v[68:71], a[128:131], v[100:103]
    ds_read_b128 v[84:87], v225 offset:34816
    v_mfma_f32_16x16x32_bf16 v[104:107], v[64:67], a[132:135], v[104:107]
    ds_read_b128 v[88:91], v225 offset:36864
    v_mfma_f32_16x16x32_bf16 v[108:111], v[68:71], a[132:135], v[108:111]
    ds_read_b128 v[92:95], v225 offset:38912
    v_mfma_f32_16x16x32_bf16 v[112:115], v[64:67], a[136:139], v[112:115]
    v_mfma_f32_16x16x32_bf16 v[116:119], v[68:71], a[136:139], v[116:119]
    s_add_u32 s38, s36, 8192
    buffer_store_dwordx4 v[24:27], v240, s[16:19], s38 offen offset:2048 sc1
    v_mfma_f32_16x16x32_bf16 v[120:123], v[64:67], a[140:143], v[120:123]
    v_mfma_f32_16x16x32_bf16 v[124:127], v[68:71], a[140:143], v[124:127]
    v_mfma_f32_16x16x32_bf16 v[128:131], v[72:75], a[128:131], v[128:131]
    s_add_u32 m0, s31, 4096
    s_add_u32 s24, s27, 131072
    buffer_load_dwordx4 v245, s[12:15], s24 offen lds
    v_mfma_f32_16x16x32_bf16 v[132:135], v[76:79], a[128:131], v[132:135]
    v_mfma_f32_16x16x32_bf16 v[136:139], v[72:75], a[132:135], v[136:139]
    v_mfma_f32_16x16x32_bf16 v[140:143], v[76:79], a[132:135], v[140:143]
    v_mfma_f32_16x16x32_bf16 v[144:147], v[72:75], a[136:139], v[144:147]
    v_mfma_f32_16x16x32_bf16 v[148:151], v[76:79], a[136:139], v[148:151]
    v_mfma_f32_16x16x32_bf16 v[152:155], v[72:75], a[140:143], v[152:155]
    v_mfma_f32_16x16x32_bf16 v[156:159], v[76:79], a[140:143], v[156:159]
    s_waitcnt lgkmcnt(0)
    v_mfma_f32_16x16x32_bf16 v[96:99], v[80:83], a[144:147], v[96:99]
    ds_read_b128 v[64:67], v224 offset:40960
    v_mfma_f32_16x16x32_bf16 v[100:103], v[84:87], a[144:147], v[100:103]
    ds_read_b128 v[68:71], v224 offset:43008
    v_mfma_f32_16x16x32_bf16 v[104:107], v[80:83], a[148:151], v[104:107]
    ds_read_b128 v[72:75], v224 offset:45056
    v_mfma_f32_16x16x32_bf16 v[108:111], v[84:87], a[148:151], v[108:111]
    ds_read_b128 v[76:79], v224 offset:47104
    v_mfma_f32_16x16x32_bf16 v[112:115], v[80:83], a[152:155], v[112:115]
    v_mfma_f32_16x16x32_bf16 v[116:119], v[84:87], a[152:155], v[116:119]
    v_mfma_f32_16x16x32_bf16 v[120:123], v[80:83], a[156:159], v[120:123]
    v_mfma_f32_16x16x32_bf16 v[124:127], v[84:87], a[156:159], v[124:127]
    v_mfma_f32_16x16x32_bf16 v[128:131], v[88:91], a[144:147], v[128:131]
    s_add_u32 m0, s34, 24576
    s_add_u32 s37, s83, 196608
    buffer_load_dwordx4 v232, s[44:47], s37 offen lds
    v_mfma_f32_16x16x32_bf16 v[132:135], v[92:95], a[144:147], v[132:135]
    v_mfma_f32_16x16x32_bf16 v[136:139], v[88:91], a[148:151], v[136:139]
    buffer_load_dwordx4 v233, s[44:47], s37 offen offset:1024 lds
    s_add_u32 s38, s36, 8192
    buffer_store_dwordx4 v[28:31], v240, s[16:19], s38 offen offset:3072 sc1
    v_mfma_f32_16x16x32_bf16 v[140:143], v[92:95], a[148:151], v[140:143]
    v_mfma_f32_16x16x32_bf16 v[144:147], v[88:91], a[152:155], v[144:147]
    v_mfma_f32_16x16x32_bf16 v[148:151], v[92:95], a[152:155], v[148:151]
    s_add_u32 m0, s31, 5120
    s_add_u32 s24, s27, 163840
    buffer_load_dwordx4 v245, s[12:15], s24 offen lds
    v_mfma_f32_16x16x32_bf16 v[152:155], v[88:91], a[156:159], v[152:155]
    v_mfma_f32_16x16x32_bf16 v[156:159], v[92:95], a[156:159], v[156:159]
    s_waitcnt lgkmcnt(0)
    v_mfma_f32_16x16x32_bf16 v[96:99], v[64:67], a[160:163], v[96:99]
    ds_read_b128 v[80:83], v225 offset:40960
    v_mfma_f32_16x16x32_bf16 v[100:103], v[68:71], a[160:163], v[100:103]
    ds_read_b128 v[84:87], v225 offset:43008
    v_mfma_f32_16x16x32_bf16 v[104:107], v[64:67], a[164:167], v[104:107]
    ds_read_b128 v[88:91], v225 offset:45056
    v_mfma_f32_16x16x32_bf16 v[108:111], v[68:71], a[164:167], v[108:111]
    ds_read_b128 v[92:95], v225 offset:47104
    v_mfma_f32_16x16x32_bf16 v[112:115], v[64:67], a[168:171], v[112:115]
    v_mfma_f32_16x16x32_bf16 v[116:119], v[68:71], a[168:171], v[116:119]
    v_mfma_f32_16x16x32_bf16 v[120:123], v[64:67], a[172:175], v[120:123]
    v_mfma_f32_16x16x32_bf16 v[124:127], v[68:71], a[172:175], v[124:127]
    v_mfma_f32_16x16x32_bf16 v[128:131], v[72:75], a[160:163], v[128:131]
    s_add_u32 m0, s31, 6144
    s_add_u32 s24, s27, 196608
    buffer_load_dwordx4 v237, s[12:15], s24 offen lds
    v_mfma_f32_16x16x32_bf16 v[132:135], v[76:79], a[160:163], v[132:135]
    v_mfma_f32_16x16x32_bf16 v[136:139], v[72:75], a[164:167], v[136:139]
    v_mfma_f32_16x16x32_bf16 v[140:143], v[76:79], a[164:167], v[140:143]
    v_mfma_f32_16x16x32_bf16 v[144:147], v[72:75], a[168:171], v[144:147]
    v_mfma_f32_16x16x32_bf16 v[148:151], v[76:79], a[168:171], v[148:151]
    v_mfma_f32_16x16x32_bf16 v[152:155], v[72:75], a[172:175], v[152:155]
    v_mfma_f32_16x16x32_bf16 v[156:159], v[76:79], a[172:175], v[156:159]
    s_waitcnt vmcnt(22) lgkmcnt(0)
    s_barrier
    v_mfma_f32_16x16x32_bf16 v[96:99], v[80:83], a[176:179], v[96:99]
    ds_read_b128 v[64:67], v224 offset:49152
    s_add_u32 s38, s36, 32768
    buffer_store_dwordx4 v[32:35], v240, s[16:19], s38 offen offset:1280 sc1
    v_mfma_f32_16x16x32_bf16 v[100:103], v[84:87], a[176:179], v[100:103]
    ds_read_b128 v[68:71], v224 offset:51200
    v_mfma_f32_16x16x32_bf16 v[104:107], v[80:83], a[180:183], v[104:107]
    ds_read_b128 v[72:75], v224 offset:53248
    v_mfma_f32_16x16x32_bf16 v[108:111], v[84:87], a[180:183], v[108:111]
    ds_read_b128 v[76:79], v224 offset:55296
    v_mfma_f32_16x16x32_bf16 v[112:115], v[80:83], a[184:187], v[112:115]
    v_mfma_f32_16x16x32_bf16 v[116:119], v[84:87], a[184:187], v[116:119]
    v_mfma_f32_16x16x32_bf16 v[120:123], v[80:83], a[188:191], v[120:123]
    v_mfma_f32_16x16x32_bf16 v[124:127], v[84:87], a[188:191], v[124:127]
    v_mfma_f32_16x16x32_bf16 v[128:131], v[88:91], a[176:179], v[128:131]
    s_add_u32 m0, s34, 32768
    s_add_u32 s37, s84, 196608
    buffer_load_dwordx4 v232, s[44:47], s37 offen lds
    v_mfma_f32_16x16x32_bf16 v[132:135], v[92:95], a[176:179], v[132:135]
    buffer_load_dwordx4 v233, s[44:47], s37 offen offset:1024 lds
    v_mfma_f32_16x16x32_bf16 v[136:139], v[88:91], a[180:183], v[136:139]
    v_mfma_f32_16x16x32_bf16 v[140:143], v[92:95], a[180:183], v[140:143]
    s_add_u32 m0, s31, 7168
    s_add_u32 s24, s27, 229376
    buffer_load_dwordx4 v237, s[12:15], s24 offen lds
    v_mfma_f32_16x16x32_bf16 v[144:147], v[88:91], a[184:187], v[144:147]
    s_add_u32 s27, s27, 1048576
    s_and_b32 s27, s27, 0x407fffff
    s_cmp_eq_u32 s27, s7
    s_cselect_b32 s27, s43, s27
    v_mfma_f32_16x16x32_bf16 v[148:151], v[92:95], a[184:187], v[148:151]
    v_mfma_f32_16x16x32_bf16 v[152:155], v[88:91], a[188:191], v[152:155]
    s_add_u32 s31, s31, 32768
    s_cmp_ge_u32 s31, 163840
    s_cselect_b32 s24, 98304, 0
    s_sub_u32 s31, s31, s24
    v_mfma_f32_16x16x32_bf16 v[156:159], v[92:95], a[188:191], v[156:159]
    s_waitcnt lgkmcnt(0)
    v_mfma_f32_16x16x32_bf16 v[96:99], v[64:67], a[192:195], v[96:99]
    ds_read_b128 v[80:83], v225 offset:49152
    v_mfma_f32_16x16x32_bf16 v[100:103], v[68:71], a[192:195], v[100:103]
    ds_read_b128 v[84:87], v225 offset:51200
    v_mfma_f32_16x16x32_bf16 v[104:107], v[64:67], a[196:199], v[104:107]
    ds_read_b128 v[88:91], v225 offset:53248
    v_mfma_f32_16x16x32_bf16 v[108:111], v[68:71], a[196:199], v[108:111]
    ds_read_b128 v[92:95], v225 offset:55296
    v_mfma_f32_16x16x32_bf16 v[112:115], v[64:67], a[200:203], v[112:115]
    v_mfma_f32_16x16x32_bf16 v[116:119], v[68:71], a[200:203], v[116:119]
    v_mfma_f32_16x16x32_bf16 v[120:123], v[64:67], a[204:207], v[120:123]
    s_add_u32 s38, s36, 32768
    buffer_store_dwordx4 v[36:39], v240, s[16:19], s38 offen offset:2304 sc1
    v_mfma_f32_16x16x32_bf16 v[124:127], v[68:71], a[204:207], v[124:127]
    v_mfma_f32_16x16x32_bf16 v[128:131], v[72:75], a[192:195], v[128:131]
    v_mfma_f32_16x16x32_bf16 v[132:135], v[76:79], a[192:195], v[132:135]
    v_mfma_f32_16x16x32_bf16 v[136:139], v[72:75], a[196:199], v[136:139]
    v_mfma_f32_16x16x32_bf16 v[140:143], v[76:79], a[196:199], v[140:143]
    v_mfma_f32_16x16x32_bf16 v[144:147], v[72:75], a[200:203], v[144:147]
    v_mfma_f32_16x16x32_bf16 v[148:151], v[76:79], a[200:203], v[148:151]
    v_mfma_f32_16x16x32_bf16 v[152:155], v[72:75], a[204:207], v[152:155]
    v_mfma_f32_16x16x32_bf16 v[156:159], v[76:79], a[204:207], v[156:159]
    s_waitcnt lgkmcnt(0)
    v_mfma_f32_16x16x32_bf16 v[96:99], v[80:83], a[208:211], v[96:99]
    ds_read_b128 v[64:67], v224 offset:57344
    v_mfma_f32_16x16x32_bf16 v[100:103], v[84:87], a[208:211], v[100:103]
    ds_read_b128 v[68:71], v224 offset:59392
    v_mfma_f32_16x16x32_bf16 v[104:107], v[80:83], a[212:215], v[104:107]
    ds_read_b128 v[72:75], v224 offset:61440
    v_mfma_f32_16x16x32_bf16 v[108:111], v[84:87], a[212:215], v[108:111]
    ds_read_b128 v[76:79], v224 offset:63488
    v_mfma_f32_16x16x32_bf16 v[112:115], v[80:83], a[216:219], v[112:115]
    v_mfma_f32_16x16x32_bf16 v[116:119], v[84:87], a[216:219], v[116:119]
    v_mfma_f32_16x16x32_bf16 v[120:123], v[80:83], a[220:223], v[120:123]
    v_mfma_f32_16x16x32_bf16 v[124:127], v[84:87], a[220:223], v[124:127]
    v_mfma_f32_16x16x32_bf16 v[128:131], v[88:91], a[208:211], v[128:131]
    s_add_u32 m0, s34, 40960
    s_add_u32 s37, s85, 196608
    buffer_load_dwordx4 v232, s[44:47], s37 offen lds
    v_mfma_f32_16x16x32_bf16 v[132:135], v[92:95], a[208:211], v[132:135]
    v_mfma_f32_16x16x32_bf16 v[136:139], v[88:91], a[212:215], v[136:139]
    v_mfma_f32_16x16x32_bf16 v[140:143], v[92:95], a[212:215], v[140:143]
    s_add_u32 s38, s36, 32768
    buffer_store_dwordx4 v[40:43], v240, s[16:19], s38 offen offset:3328 sc1
    v_mfma_f32_16x16x32_bf16 v[144:147], v[88:91], a[216:219], v[144:147]
    buffer_load_dwordx4 v233, s[44:47], s37 offen offset:1024 lds
    v_mfma_f32_16x16x32_bf16 v[148:151], v[92:95], a[216:219], v[148:151]
    v_mfma_f32_16x16x32_bf16 v[152:155], v[88:91], a[220:223], v[152:155]
    v_mfma_f32_16x16x32_bf16 v[156:159], v[92:95], a[220:223], v[156:159]
    s_waitcnt lgkmcnt(0)
    v_mfma_f32_16x16x32_bf16 v[96:99], v[64:67], a[224:227], v[96:99]
    ds_read_b128 v[80:83], v225 offset:57344
    v_mfma_f32_16x16x32_bf16 v[100:103], v[68:71], a[224:227], v[100:103]
    ds_read_b128 v[84:87], v225 offset:59392
    v_mfma_f32_16x16x32_bf16 v[104:107], v[64:67], a[228:231], v[104:107]
    ds_read_b128 v[88:91], v225 offset:61440
    v_mfma_f32_16x16x32_bf16 v[108:111], v[68:71], a[228:231], v[108:111]
    ds_read_b128 v[92:95], v225 offset:63488
    v_mfma_f32_16x16x32_bf16 v[112:115], v[64:67], a[232:235], v[112:115]
    v_mfma_f32_16x16x32_bf16 v[116:119], v[68:71], a[232:235], v[116:119]
    v_mfma_f32_16x16x32_bf16 v[120:123], v[64:67], a[236:239], v[120:123]
    v_mfma_f32_16x16x32_bf16 v[124:127], v[68:71], a[236:239], v[124:127]
    v_mfma_f32_16x16x32_bf16 v[128:131], v[72:75], a[224:227], v[128:131]
    s_add_u32 m0, s31, 0
    s_add_u32 s24, s27, 0
    buffer_load_dwordx4 v245, s[12:15], s24 offen lds
    v_mfma_f32_16x16x32_bf16 v[132:135], v[76:79], a[224:227], v[132:135]
    v_mfma_f32_16x16x32_bf16 v[136:139], v[72:75], a[228:231], v[136:139]
    v_mfma_f32_16x16x32_bf16 v[140:143], v[76:79], a[228:231], v[140:143]
    v_mfma_f32_16x16x32_bf16 v[144:147], v[72:75], a[232:235], v[144:147]
    v_mfma_f32_16x16x32_bf16 v[148:151], v[76:79], a[232:235], v[148:151]
    v_mfma_f32_16x16x32_bf16 v[152:155], v[72:75], a[236:239], v[152:155]
    v_mfma_f32_16x16x32_bf16 v[156:159], v[76:79], a[236:239], v[156:159]
    s_waitcnt vmcnt(23) lgkmcnt(0)
    s_barrier
    v_mfma_f32_16x16x32_bf16 v[96:99], v[80:83], a[240:243], v[96:99]
    ds_read_b128 v[64:67], v224 offset:0
    v_mfma_f32_16x16x32_bf16 v[100:103], v[84:87], a[240:243], v[100:103]
    ds_read_b128 v[68:71], v224 offset:2048
    s_add_u32 s38, s36, 36864
    buffer_store_dwordx4 v[44:47], v240, s[16:19], s38 offen offset:256 sc1
    v_mfma_f32_16x16x32_bf16 v[104:107], v[80:83], a[244:247], v[104:107]
    ds_read_b128 v[72:75], v224 offset:4096
    v_mfma_f32_16x16x32_bf16 v[108:111], v[84:87], a[244:247], v[108:111]
    ds_read_b128 v[76:79], v224 offset:6144
    v_mfma_f32_16x16x32_bf16 v[112:115], v[80:83], a[248:251], v[112:115]
    v_mfma_f32_16x16x32_bf16 v[116:119], v[84:87], a[248:251], v[116:119]
    v_mfma_f32_16x16x32_bf16 v[120:123], v[80:83], a[252:255], v[120:123]
    v_mfma_f32_16x16x32_bf16 v[124:127], v[84:87], a[252:255], v[124:127]
    v_mfma_f32_16x16x32_bf16 v[128:131], v[88:91], a[240:243], v[128:131]
    s_add_u32 m0, s34, 49152
    s_add_u32 s37, s86, 196608
    buffer_load_dwordx4 v232, s[44:47], s37 offen lds
    v_mfma_f32_16x16x32_bf16 v[132:135], v[92:95], a[240:243], v[132:135]
    v_mfma_f32_16x16x32_bf16 v[136:139], v[88:91], a[244:247], v[136:139]
    buffer_load_dwordx4 v233, s[44:47], s37 offen offset:1024 lds
    v_mfma_f32_16x16x32_bf16 v[140:143], v[92:95], a[244:247], v[140:143]
    v_mfma_f32_16x16x32_bf16 v[144:147], v[88:91], a[248:251], v[144:147]
    v_mfma_f32_16x16x32_bf16 v[148:151], v[92:95], a[248:251], v[148:151]
    s_add_u32 m0, s31, 1024
    s_add_u32 s24, s27, 32768
    buffer_load_dwordx4 v245, s[12:15], s24 offen lds
    v_mfma_f32_16x16x32_bf16 v[152:155], v[88:91], a[252:255], v[152:155]
    v_mfma_f32_16x16x32_bf16 v[156:159], v[92:95], a[252:255], v[156:159]
    s_waitcnt lgkmcnt(0)
    v_mfma_f32_16x16x32_bf16 v[160:163], v[64:67], a[0:3], 0
    ds_read_b128 v[80:83], v225 offset:0
    v_mfma_f32_16x16x32_bf16 v[164:167], v[68:71], a[0:3], 0
    ds_read_b128 v[84:87], v225 offset:2048
    v_mfma_f32_16x16x32_bf16 v[168:171], v[64:67], a[4:7], 0
    ds_read_b128 v[88:91], v225 offset:4096
    v_mfma_f32_16x16x32_bf16 v[172:175], v[68:71], a[4:7], 0
    ds_read_b128 v[92:95], v225 offset:6144
    v_mfma_f32_16x16x32_bf16 v[176:179], v[64:67], a[8:11], 0
    v_cvt_pk_bf16_f32 v0, v96, v97
    v_cvt_pk_bf16_f32 v1, v98, v99
    v_mfma_f32_16x16x32_bf16 v[180:183], v[68:71], a[8:11], 0
    v_mfma_f32_16x16x32_bf16 v[184:187], v[64:67], a[12:15], 0
    v_cvt_pk_bf16_f32 v2, v100, v101
    v_cvt_pk_bf16_f32 v3, v102, v103
    s_add_u32 s38, s36, 40960
    buffer_store_dwordx4 v[48:51], v240, s[16:19], s38 offen offset:1280 sc1
    v_mfma_f32_16x16x32_bf16 v[188:191], v[68:71], a[12:15], 0
    v_mfma_f32_16x16x32_bf16 v[192:195], v[72:75], a[0:3], 0
    s_add_u32 m0, s31, 2048
    s_add_u32 s24, s27, 65536
    buffer_load_dwordx4 v237, s[12:15], s24 offen lds
    v_cvt_pk_bf16_f32 v4, v104, v105
    v_cvt_pk_bf16_f32 v5, v106, v107
    v_mfma_f32_16x16x32_bf16 v[196:199], v[76:79], a[0:3], 0
    v_mfma_f32_16x16x32_bf16 v[200:203], v[72:75], a[4:7], 0
    v_cvt_pk_bf16_f32 v6, v108, v109
    v_cvt_pk_bf16_f32 v7, v110, v111
    v_mfma_f32_16x16x32_bf16 v[204:207], v[76:79], a[4:7], 0
    v_mfma_f32_16x16x32_bf16 v[208:211], v[72:75], a[8:11], 0
    v_cvt_pk_bf16_f32 v8, v112, v113
    v_cvt_pk_bf16_f32 v9, v114, v115
    v_mfma_f32_16x16x32_bf16 v[212:215], v[76:79], a[8:11], 0
    v_mfma_f32_16x16x32_bf16 v[216:219], v[72:75], a[12:15], 0
    v_cvt_pk_bf16_f32 v10, v116, v117
    v_cvt_pk_bf16_f32 v11, v118, v119
    v_mfma_f32_16x16x32_bf16 v[220:223], v[76:79], a[12:15], 0
    s_waitcnt lgkmcnt(0)
    v_mfma_f32_16x16x32_bf16 v[160:163], v[80:83], a[16:19], v[160:163]
    ds_read_b128 v[64:67], v224 offset:8192
    v_cvt_pk_bf16_f32 v12, v120, v121
    v_cvt_pk_bf16_f32 v13, v122, v123
    v_mfma_f32_16x16x32_bf16 v[164:167], v[84:87], a[16:19], v[164:167]
    ds_read_b128 v[68:71], v224 offset:10240
    v_mfma_f32_16x16x32_bf16 v[168:171], v[80:83], a[20:23], v[168:171]
    ds_read_b128 v[72:75], v224 offset:12288
    v_cvt_pk_bf16_f32 v14, v124, v125
    v_cvt_pk_bf16_f32 v15, v126, v127
    v_mfma_f32_16x16x32_bf16 v[172:175], v[84:87], a[20:23], v[172:175]
    ds_read_b128 v[76:79], v224 offset:14336
    v_mfma_f32_16x16x32_bf16 v[176:179], v[80:83], a[24:27], v[176:179]
    v_cvt_pk_bf16_f32 v16, v128, v129
    v_cvt_pk_bf16_f32 v17, v130, v131
    v_mfma_f32_16x16x32_bf16 v[180:183], v[84:87], a[24:27], v[180:183]
    v_mfma_f32_16x16x32_bf16 v[184:187], v[80:83], a[28:31], v[184:187]
    v_cvt_pk_bf16_f32 v18, v132, v133
    v_cvt_pk_bf16_f32 v19, v134, v135
    v_mfma_f32_16x16x32_bf16 v[188:191], v[84:87], a[28:31], v[188:191]
    v_mfma_f32_16x16x32_bf16 v[192:195], v[88:91], a[16:19], v[192:195]
    s_add_u32 m0, s34, 57344
    s_add_u32 s37, s87, 196608
    buffer_load_dwordx4 v232, s[44:47], s37 offen lds
    v_cvt_pk_bf16_f32 v20, v136, v137
    v_cvt_pk_bf16_f32 v21, v138, v139
    v_mfma_f32_16x16x32_bf16 v[196:199], v[92:95], a[16:19], v[196:199]
    v_mfma_f32_16x16x32_bf16 v[200:203], v[88:91], a[20:23], v[200:203]
    buffer_load_dwordx4 v233, s[44:47], s37 offen offset:1024 lds
    v_cvt_pk_bf16_f32 v22, v140, v141
    v_cvt_pk_bf16_f32 v23, v142, v143
    v_mfma_f32_16x16x32_bf16 v[204:207], v[92:95], a[20:23], v[204:207]
    v_mfma_f32_16x16x32_bf16 v[208:211], v[88:91], a[24:27], v[208:211]
    v_cvt_pk_bf16_f32 v24, v144, v145
    v_cvt_pk_bf16_f32 v25, v146, v147
    s_add_u32 s38, s36, 40960
    buffer_store_dwordx4 v[52:55], v240, s[16:19], s38 offen offset:2304 sc1
    v_mfma_f32_16x16x32_bf16 v[212:215], v[92:95], a[24:27], v[212:215]
    s_add_u32 m0, s31, 3072
    s_add_u32 s24, s27, 98304
    buffer_load_dwordx4 v237, s[12:15], s24 offen lds
    v_mfma_f32_16x16x32_bf16 v[216:219], v[88:91], a[28:31], v[216:219]
    v_cvt_pk_bf16_f32 v26, v148, v149
    v_cvt_pk_bf16_f32 v27, v150, v151
    v_mfma_f32_16x16x32_bf16 v[220:223], v[92:95], a[28:31], v[220:223]
    s_waitcnt lgkmcnt(0)
    v_mfma_f32_16x16x32_bf16 v[160:163], v[64:67], a[32:35], v[160:163]
    ds_read_b128 v[80:83], v225 offset:8192
    v_cvt_pk_bf16_f32 v28, v152, v153
    v_cvt_pk_bf16_f32 v29, v154, v155
    v_mfma_f32_16x16x32_bf16 v[164:167], v[68:71], a[32:35], v[164:167]
    ds_read_b128 v[84:87], v225 offset:10240
    v_mfma_f32_16x16x32_bf16 v[168:171], v[64:67], a[36:39], v[168:171]
    ds_read_b128 v[88:91], v225 offset:12288
    v_cvt_pk_bf16_f32 v30, v156, v157
    v_cvt_pk_bf16_f32 v31, v158, v159
    v_mfma_f32_16x16x32_bf16 v[172:175], v[68:71], a[36:39], v[172:175]
    ds_read_b128 v[92:95], v225 offset:14336
    v_mfma_f32_16x16x32_bf16 v[176:179], v[64:67], a[40:43], v[176:179]
    v_mfma_f32_16x16x32_bf16 v[180:183], v[68:71], a[40:43], v[180:183]
    v_mfma_f32_16x16x32_bf16 v[184:187], v[64:67], a[44:47], v[184:187]
    v_mfma_f32_16x16x32_bf16 v[188:191], v[68:71], a[44:47], v[188:191]
    v_mfma_f32_16x16x32_bf16 v[192:195], v[72:75], a[32:35], v[192:195]
    s_add_u32 m0, s31, 4096
    s_add_u32 s24, s27, 131072
    buffer_load_dwordx4 v245, s[12:15], s24 offen lds
    v_mfma_f32_16x16x32_bf16 v[196:199], v[76:79], a[32:35], v[196:199]
    v_mfma_f32_16x16x32_bf16 v[200:203], v[72:75], a[36:39], v[200:203]
    v_mfma_f32_16x16x32_bf16 v[204:207], v[76:79], a[36:39], v[204:207]
    v_mfma_f32_16x16x32_bf16 v[208:211], v[72:75], a[40:43], v[208:211]
    v_mfma_f32_16x16x32_bf16 v[212:215], v[76:79], a[40:43], v[212:215]
    v_mfma_f32_16x16x32_bf16 v[216:219], v[72:75], a[44:47], v[216:219]
    v_mfma_f32_16x16x32_bf16 v[220:223], v[76:79], a[44:47], v[220:223]
    s_waitcnt vmcnt(23) lgkmcnt(0)
    s_barrier
    v_mfma_f32_16x16x32_bf16 v[160:163], v[80:83], a[48:51], v[160:163]
    ds_read_b128 v[64:67], v224 offset:16384
    v_mfma_f32_16x16x32_bf16 v[164:167], v[84:87], a[48:51], v[164:167]
    ds_read_b128 v[68:71], v224 offset:18432
    s_add_u32 s38, s36, 40960
    buffer_store_dwordx4 v[56:59], v240, s[16:19], s38 offen offset:3328 sc1
    v_mfma_f32_16x16x32_bf16 v[168:171], v[80:83], a[52:55], v[168:171]
    ds_read_b128 v[72:75], v224 offset:20480
    v_mfma_f32_16x16x32_bf16 v[172:175], v[84:87], a[52:55], v[172:175]
    ds_read_b128 v[76:79], v224 offset:22528
    v_mfma_f32_16x16x32_bf16 v[176:179], v[80:83], a[56:59], v[176:179]
    v_mfma_f32_16x16x32_bf16 v[180:183], v[84:87], a[56:59], v[180:183]
    v_mfma_f32_16x16x32_bf16 v[184:187], v[80:83], a[60:63], v[184:187]
    v_mfma_f32_16x16x32_bf16 v[188:191], v[84:87], a[60:63], v[188:191]
    v_mfma_f32_16x16x32_bf16 v[192:195], v[88:91], a[48:51], v[192:195]
    s_add_u32 m0, s31, 5120
    s_add_u32 s24, s27, 163840
    buffer_load_dwordx4 v245, s[12:15], s24 offen lds
    v_mfma_f32_16x16x32_bf16 v[196:199], v[92:95], a[48:51], v[196:199]
    v_mfma_f32_16x16x32_bf16 v[200:203], v[88:91], a[52:55], v[200:203]
    v_mfma_f32_16x16x32_bf16 v[204:207], v[92:95], a[52:55], v[204:207]
    v_mfma_f32_16x16x32_bf16 v[208:211], v[88:91], a[56:59], v[208:211]
    v_mfma_f32_16x16x32_bf16 v[212:215], v[92:95], a[56:59], v[212:215]
    v_mfma_f32_16x16x32_bf16 v[216:219], v[88:91], a[60:63], v[216:219]
    v_mfma_f32_16x16x32_bf16 v[220:223], v[92:95], a[60:63], v[220:223]
    s_waitcnt lgkmcnt(0)
    v_mfma_f32_16x16x32_bf16 v[160:163], v[64:67], a[64:67], v[160:163]
    ds_read_b128 v[80:83], v225 offset:16384
    v_mfma_f32_16x16x32_bf16 v[164:167], v[68:71], a[64:67], v[164:167]
    ds_read_b128 v[84:87], v225 offset:18432
    v_mfma_f32_16x16x32_bf16 v[168:171], v[64:67], a[68:71], v[168:171]
    ds_read_b128 v[88:91], v225 offset:20480
    v_mfma_f32_16x16x32_bf16 v[172:175], v[68:71], a[68:71], v[172:175]
    ds_read_b128 v[92:95], v225 offset:22528
    v_mfma_f32_16x16x32_bf16 v[176:179], v[64:67], a[72:75], v[176:179]
    v_mfma_f32_16x16x32_bf16 v[180:183], v[68:71], a[72:75], v[180:183]
    v_mfma_f32_16x16x32_bf16 v[184:187], v[64:67], a[76:79], v[184:187]
    v_mfma_f32_16x16x32_bf16 v[188:191], v[68:71], a[76:79], v[188:191]
    s_add_u32 s38, s36, 45056
    buffer_store_dwordx4 v[60:63], v240, s[16:19], s38 offen offset:256 sc1
    v_mfma_f32_16x16x32_bf16 v[192:195], v[72:75], a[64:67], v[192:195]
    s_add_u32 m0, s31, 6144
    s_add_u32 s24, s27, 196608
    buffer_load_dwordx4 v237, s[12:15], s24 offen lds
    v_mfma_f32_16x16x32_bf16 v[196:199], v[76:79], a[64:67], v[196:199]
    v_mfma_f32_16x16x32_bf16 v[200:203], v[72:75], a[68:71], v[200:203]
    v_mfma_f32_16x16x32_bf16 v[204:207], v[76:79], a[68:71], v[204:207]
    v_mfma_f32_16x16x32_bf16 v[208:211], v[72:75], a[72:75], v[208:211]
    v_mfma_f32_16x16x32_bf16 v[212:215], v[76:79], a[72:75], v[212:215]
    v_mfma_f32_16x16x32_bf16 v[216:219], v[72:75], a[76:79], v[216:219]
    v_mfma_f32_16x16x32_bf16 v[220:223], v[76:79], a[76:79], v[220:223]
    s_waitcnt lgkmcnt(0)
    v_mfma_f32_16x16x32_bf16 v[160:163], v[80:83], a[80:83], v[160:163]
    ds_read_b128 v[64:67], v224 offset:24576
    v_mfma_f32_16x16x32_bf16 v[164:167], v[84:87], a[80:83], v[164:167]
    ds_read_b128 v[68:71], v224 offset:26624
    v_mfma_f32_16x16x32_bf16 v[168:171], v[80:83], a[84:87], v[168:171]
    ds_read_b128 v[72:75], v224 offset:28672
    v_mfma_f32_16x16x32_bf16 v[172:175], v[84:87], a[84:87], v[172:175]
    ds_read_b128 v[76:79], v224 offset:30720
    v_mfma_f32_16x16x32_bf16 v[176:179], v[80:83], a[88:91], v[176:179]
    v_mfma_f32_16x16x32_bf16 v[180:183], v[84:87], a[88:91], v[180:183]
    v_mfma_f32_16x16x32_bf16 v[184:187], v[80:83], a[92:95], v[184:187]
    v_mfma_f32_16x16x32_bf16 v[188:191], v[84:87], a[92:95], v[188:191]
    v_mfma_f32_16x16x32_bf16 v[192:195], v[88:91], a[80:83], v[192:195]
    s_add_u32 m0, s31, 7168
    s_add_u32 s24, s27, 229376
    buffer_load_dwordx4 v237, s[12:15], s24 offen lds
    v_mfma_f32_16x16x32_bf16 v[196:199], v[92:95], a[80:83], v[196:199]
    v_mfma_f32_16x16x32_bf16 v[200:203], v[88:91], a[84:87], v[200:203]
    s_add_u32 s27, s27, 1048576
    s_and_b32 s27, s27, 0x407fffff
    s_cmp_eq_u32 s27, s7
    s_cselect_b32 s27, s43, s27
    v_mfma_f32_16x16x32_bf16 v[204:207], v[92:95], a[84:87], v[204:207]
    v_mfma_f32_16x16x32_bf16 v[208:211], v[88:91], a[88:91], v[208:211]
    v_mfma_f32_16x16x32_bf16 v[212:215], v[92:95], a[88:91], v[212:215]
    s_add_u32 s31, s31, 32768
    s_cmp_ge_u32 s31, 163840
    s_cselect_b32 s24, 98304, 0
    s_sub_u32 s31, s31, s24
    s_add_u32 s38, s36, 65536
    buffer_store_dwordx4 v[0:3], v240, s[16:19], s38 offen offset:2560 sc1
    v_mfma_f32_16x16x32_bf16 v[216:219], v[88:91], a[92:95], v[216:219]
    v_mfma_f32_16x16x32_bf16 v[220:223], v[92:95], a[92:95], v[220:223]
    s_waitcnt lgkmcnt(0)
    v_mfma_f32_16x16x32_bf16 v[160:163], v[64:67], a[96:99], v[160:163]
    ds_read_b128 v[80:83], v225 offset:24576
    v_mfma_f32_16x16x32_bf16 v[164:167], v[68:71], a[96:99], v[164:167]
    ds_read_b128 v[84:87], v225 offset:26624
    v_mfma_f32_16x16x32_bf16 v[168:171], v[64:67], a[100:103], v[168:171]
    ds_read_b128 v[88:91], v225 offset:28672
    v_mfma_f32_16x16x32_bf16 v[172:175], v[68:71], a[100:103], v[172:175]
    ds_read_b128 v[92:95], v225 offset:30720
    v_mfma_f32_16x16x32_bf16 v[176:179], v[64:67], a[104:107], v[176:179]
    v_mfma_f32_16x16x32_bf16 v[180:183], v[68:71], a[104:107], v[180:183]
    v_mfma_f32_16x16x32_bf16 v[184:187], v[64:67], a[108:111], v[184:187]
    v_mfma_f32_16x16x32_bf16 v[188:191], v[68:71], a[108:111], v[188:191]
    v_mfma_f32_16x16x32_bf16 v[192:195], v[72:75], a[96:99], v[192:195]
    v_mfma_f32_16x16x32_bf16 v[196:199], v[76:79], a[96:99], v[196:199]
    v_mfma_f32_16x16x32_bf16 v[200:203], v[72:75], a[100:103], v[200:203]
    v_mfma_f32_16x16x32_bf16 v[204:207], v[76:79], a[100:103], v[204:207]
    v_mfma_f32_16x16x32_bf16 v[208:211], v[72:75], a[104:107], v[208:211]
    v_mfma_f32_16x16x32_bf16 v[212:215], v[76:79], a[104:107], v[212:215]
    v_mfma_f32_16x16x32_bf16 v[216:219], v[72:75], a[108:111], v[216:219]
    v_mfma_f32_16x16x32_bf16 v[220:223], v[76:79], a[108:111], v[220:223]
    s_waitcnt vmcnt(9) lgkmcnt(0)
    s_barrier
    v_mfma_f32_16x16x32_bf16 v[160:163], v[80:83], a[112:115], v[160:163]
    ds_read_b128 v[64:67], v224 offset:32768
    v_mfma_f32_16x16x32_bf16 v[164:167], v[84:87], a[112:115], v[164:167]
    ds_read_b128 v[68:71], v224 offset:34816
    v_mfma_f32_16x16x32_bf16 v[168:171], v[80:83], a[116:119], v[168:171]
    ds_read_b128 v[72:75], v224 offset:36864
    s_add_u32 s38, s36, 65536
    buffer_store_dwordx4 v[4:7], v240, s[16:19], s38 offen offset:3584 sc1
    v_mfma_f32_16x16x32_bf16 v[172:175], v[84:87], a[116:119], v[172:175]
    ds_read_b128 v[76:79], v224 offset:38912
    v_mfma_f32_16x16x32_bf16 v[176:179], v[80:83], a[120:123], v[176:179]
    v_mfma_f32_16x16x32_bf16 v[180:183], v[84:87], a[120:123], v[180:183]
    v_mfma_f32_16x16x32_bf16 v[184:187], v[80:83], a[124:127], v[184:187]
    v_mfma_f32_16x16x32_bf16 v[188:191], v[84:87], a[124:127], v[188:191]
    v_mfma_f32_16x16x32_bf16 v[192:195], v[88:91], a[112:115], v[192:195]
    v_mfma_f32_16x16x32_bf16 v[196:199], v[92:95], a[112:115], v[196:199]
    v_mfma_f32_16x16x32_bf16 v[200:203], v[88:91], a[116:119], v[200:203]
    v_mfma_f32_16x16x32_bf16 v[204:207], v[92:95], a[116:119], v[204:207]
    v_mfma_f32_16x16x32_bf16 v[208:211], v[88:91], a[120:123], v[208:211]
    v_mfma_f32_16x16x32_bf16 v[212:215], v[92:95], a[120:123], v[212:215]
    v_mfma_f32_16x16x32_bf16 v[216:219], v[88:91], a[124:127], v[216:219]
    v_mfma_f32_16x16x32_bf16 v[220:223], v[92:95], a[124:127], v[220:223]
    s_waitcnt lgkmcnt(0)
    v_mfma_f32_16x16x32_bf16 v[160:163], v[64:67], a[128:131], v[160:163]
    ds_read_b128 v[80:83], v225 offset:32768
    v_mfma_f32_16x16x32_bf16 v[164:167], v[68:71], a[128:131], v[164:167]
    ds_read_b128 v[84:87], v225 offset:34816
    v_mfma_f32_16x16x32_bf16 v[168:171], v[64:67], a[132:135], v[168:171]
    ds_read_b128 v[88:91], v225 offset:36864
    v_mfma_f32_16x16x32_bf16 v[172:175], v[68:71], a[132:135], v[172:175]
    ds_read_b128 v[92:95], v225 offset:38912
    v_mfma_f32_16x16x32_bf16 v[176:179], v[64:67], a[136:139], v[176:179]
    v_mfma_f32_16x16x32_bf16 v[180:183], v[68:71], a[136:139], v[180:183]
    v_mfma_f32_16x16x32_bf16 v[184:187], v[64:67], a[140:143], v[184:187]
    v_mfma_f32_16x16x32_bf16 v[188:191], v[68:71], a[140:143], v[188:191]
    v_mfma_f32_16x16x32_bf16 v[192:195], v[72:75], a[128:131], v[192:195]
    buffer_load_dword v254, off, s[88:91], s39 sc1
    s_add_u32 s38, s36, 69632
    buffer_store_dwordx4 v[8:11], v240, s[16:19], s38 offen offset:512 sc1
    v_mfma_f32_16x16x32_bf16 v[196:199], v[76:79], a[128:131], v[196:199]
    v_mfma_f32_16x16x32_bf16 v[200:203], v[72:75], a[132:135], v[200:203]
    v_mfma_f32_16x16x32_bf16 v[204:207], v[76:79], a[132:135], v[204:207]
    v_mfma_f32_16x16x32_bf16 v[208:211], v[72:75], a[136:139], v[208:211]
    v_mfma_f32_16x16x32_bf16 v[212:215], v[76:79], a[136:139], v[212:215]
    v_mfma_f32_16x16x32_bf16 v[216:219], v[72:75], a[140:143], v[216:219]
    v_mfma_f32_16x16x32_bf16 v[220:223], v[76:79], a[140:143], v[220:223]
    s_waitcnt lgkmcnt(0)
    v_mfma_f32_16x16x32_bf16 v[160:163], v[80:83], a[144:147], v[160:163]
    ds_read_b128 v[64:67], v224 offset:40960
    v_mfma_f32_16x16x32_bf16 v[164:167], v[84:87], a[144:147], v[164:167]
    ds_read_b128 v[68:71], v224 offset:43008
    v_mfma_f32_16x16x32_bf16 v[168:171], v[80:83], a[148:151], v[168:171]
    ds_read_b128 v[72:75], v224 offset:45056
    v_mfma_f32_16x16x32_bf16 v[172:175], v[84:87], a[148:151], v[172:175]
    ds_read_b128 v[76:79], v224 offset:47104
    v_mfma_f32_16x16x32_bf16 v[176:179], v[80:83], a[152:155], v[176:179]
    v_mfma_f32_16x16x32_bf16 v[180:183], v[84:87], a[152:155], v[180:183]
    v_mfma_f32_16x16x32_bf16 v[184:187], v[80:83], a[156:159], v[184:187]
    v_mfma_f32_16x16x32_bf16 v[188:191], v[84:87], a[156:159], v[188:191]
    v_mfma_f32_16x16x32_bf16 v[192:195], v[88:91], a[144:147], v[192:195]
    v_mfma_f32_16x16x32_bf16 v[196:199], v[92:95], a[144:147], v[196:199]
    v_mfma_f32_16x16x32_bf16 v[200:203], v[88:91], a[148:151], v[200:203]
    v_mfma_f32_16x16x32_bf16 v[204:207], v[92:95], a[148:151], v[204:207]
    v_mfma_f32_16x16x32_bf16 v[208:211], v[88:91], a[152:155], v[208:211]
    v_mfma_f32_16x16x32_bf16 v[212:215], v[92:95], a[152:155], v[212:215]
    s_add_u32 s38, s36, 69632
    buffer_store_dwordx4 v[12:15], v240, s[16:19], s38 offen offset:1536 sc1
    v_mfma_f32_16x16x32_bf16 v[216:219], v[88:91], a[156:159], v[216:219]
    v_mfma_f32_16x16x32_bf16 v[220:223], v[92:95], a[156:159], v[220:223]
    s_waitcnt lgkmcnt(0)
    v_mfma_f32_16x16x32_bf16 v[160:163], v[64:67], a[160:163], v[160:163]
    ds_read_b128 v[80:83], v225 offset:40960
    v_mfma_f32_16x16x32_bf16 v[164:167], v[68:71], a[160:163], v[164:167]
    ds_read_b128 v[84:87], v225 offset:43008
    v_mfma_f32_16x16x32_bf16 v[168:171], v[64:67], a[164:167], v[168:171]
    ds_read_b128 v[88:91], v225 offset:45056
    v_mfma_f32_16x16x32_bf16 v[172:175], v[68:71], a[164:167], v[172:175]
    ds_read_b128 v[92:95], v225 offset:47104
    v_mfma_f32_16x16x32_bf16 v[176:179], v[64:67], a[168:171], v[176:179]
    v_mfma_f32_16x16x32_bf16 v[180:183], v[68:71], a[168:171], v[180:183]
    v_mfma_f32_16x16x32_bf16 v[184:187], v[64:67], a[172:175], v[184:187]
    v_mfma_f32_16x16x32_bf16 v[188:191], v[68:71], a[172:175], v[188:191]
    v_mfma_f32_16x16x32_bf16 v[192:195], v[72:75], a[160:163], v[192:195]
    v_mfma_f32_16x16x32_bf16 v[196:199], v[76:79], a[160:163], v[196:199]
    v_mfma_f32_16x16x32_bf16 v[200:203], v[72:75], a[164:167], v[200:203]
    v_mfma_f32_16x16x32_bf16 v[204:207], v[76:79], a[164:167], v[204:207]
    v_mfma_f32_16x16x32_bf16 v[208:211], v[72:75], a[168:171], v[208:211]
    v_mfma_f32_16x16x32_bf16 v[212:215], v[76:79], a[168:171], v[212:215]
    v_mfma_f32_16x16x32_bf16 v[216:219], v[72:75], a[172:175], v[216:219]
    v_mfma_f32_16x16x32_bf16 v[220:223], v[76:79], a[172:175], v[220:223]
    s_waitcnt lgkmcnt(0)
    v_mfma_f32_16x16x32_bf16 v[160:163], v[80:83], a[176:179], v[160:163]
    ds_read_b128 v[64:67], v224 offset:49152
    v_mfma_f32_16x16x32_bf16 v[164:167], v[84:87], a[176:179], v[164:167]
    ds_read_b128 v[68:71], v224 offset:51200
    v_mfma_f32_16x16x32_bf16 v[168:171], v[80:83], a[180:183], v[168:171]
    ds_read_b128 v[72:75], v224 offset:53248
    v_mfma_f32_16x16x32_bf16 v[172:175], v[84:87], a[180:183], v[172:175]
    ds_read_b128 v[76:79], v224 offset:55296
    s_add_u32 s38, s36, 73728
    buffer_store_dwordx4 v[16:19], v240, s[16:19], s38 offen offset:2560 sc1
    v_mfma_f32_16x16x32_bf16 v[176:179], v[80:83], a[184:187], v[176:179]
    v_mfma_f32_16x16x32_bf16 v[180:183], v[84:87], a[184:187], v[180:183]
    v_mfma_f32_16x16x32_bf16 v[184:187], v[80:83], a[188:191], v[184:187]
    v_mfma_f32_16x16x32_bf16 v[188:191], v[84:87], a[188:191], v[188:191]
    v_mfma_f32_16x16x32_bf16 v[192:195], v[88:91], a[176:179], v[192:195]
    v_mfma_f32_16x16x32_bf16 v[196:199], v[92:95], a[176:179], v[196:199]
    v_mfma_f32_16x16x32_bf16 v[200:203], v[88:91], a[180:183], v[200:203]
    v_mfma_f32_16x16x32_bf16 v[204:207], v[92:95], a[180:183], v[204:207]
    v_mfma_f32_16x16x32_bf16 v[208:211], v[88:91], a[184:187], v[208:211]
    v_mfma_f32_16x16x32_bf16 v[212:215], v[92:95], a[184:187], v[212:215]
    v_mfma_f32_16x16x32_bf16 v[216:219], v[88:91], a[188:191], v[216:219]
    v_mfma_f32_16x16x32_bf16 v[220:223], v[92:95], a[188:191], v[220:223]
    s_waitcnt vmcnt(3)
    v_readfirstlane_b32 s24, v254
    s_lshl_b32 s25, s3, 16
    s_add_u32 s24, s24, s25
    s_cmp_ge_u32 s24, 32
    s_cbranch_scc0 kf_spin37
kf_spinr38:
    s_waitcnt lgkmcnt(0)
    s_barrier
    v_mfma_f32_16x16x32_bf16 v[160:163], v[64:67], a[192:195], v[160:163]
    ds_read_b128 v[80:83], v225 offset:49152
    v_mfma_f32_16x16x32_bf16 v[164:167], v[68:71], a[192:195], v[164:167]
    ds_read_b128 v[84:87], v225 offset:51200
    v_mfma_f32_16x16x32_bf16 v[168:171], v[64:67], a[196:199], v[168:171]
    ds_read_b128 v[88:91], v225 offset:53248
    v_mfma_f32_16x16x32_bf16 v[172:175], v[68:71], a[196:199], v[172:175]
    ds_read_b128 v[92:95], v225 offset:55296
    v_mfma_f32_16x16x32_bf16 v[176:179], v[64:67], a[200:203], v[176:179]
    v_mfma_f32_16x16x32_bf16 v[180:183], v[68:71], a[200:203], v[180:183]
    v_mfma_f32_16x16x32_bf16 v[184:187], v[64:67], a[204:207], v[184:187]
    v_mfma_f32_16x16x32_bf16 v[188:191], v[68:71], a[204:207], v[188:191]
    v_mfma_f32_16x16x32_bf16 v[192:195], v[72:75], a[192:195], v[192:195]
    buffer_load_dwordx4 a[128:131], v248, s[8:11], s28 offen offset:0 sc1
    s_add_u32 s38, s36, 73728
    buffer_store_dwordx4 v[20:23], v240, s[16:19], s38 offen offset:3584 sc1
    v_mfma_f32_16x16x32_bf16 v[196:199], v[76:79], a[192:195], v[196:199]
    v_mfma_f32_16x16x32_bf16 v[200:203], v[72:75], a[196:199], v[200:203]
    buffer_load_dwordx4 a[132:135], v248, s[8:11], s29 offen offset:0 sc1
    v_mfma_f32_16x16x32_bf16 v[204:207], v[76:79], a[196:199], v[204:207]
    v_mfma_f32_16x16x32_bf16 v[208:211], v[72:75], a[200:203], v[208:211]
    v_mfma_f32_16x16x32_bf16 v[212:215], v[76:79], a[200:203], v[212:215]
    buffer_load_dwordx4 a[136:139], v249, s[8:11], s28 offen offset:0 sc1
    v_mfma_f32_16x16x32_bf16 v[216:219], v[72:75], a[204:207], v[216:219]
    v_mfma_f32_16x16x32_bf16 v[220:223], v[76:79], a[204:207], v[220:223]
    s_waitcnt lgkmcnt(0)
    v_mfma_f32_16x16x32_bf16 v[160:163], v[80:83], a[208:211], v[160:163]
    ds_read_b128 v[64:67], v224 offset:57344
    v_mfma_f32_16x16x32_bf16 v[164:167], v[84:87], a[208:211], v[164:167]
    ds_read_b128 v[68:71], v224 offset:59392
    v_mfma_f32_16x16x32_bf16 v[168:171], v[80:83], a[212:215], v[168:171]
    ds_read_b128 v[72:75], v224 offset:61440
    v_mfma_f32_16x16x32_bf16 v[172:175], v[84:87], a[212:215], v[172:175]
    ds_read_b128 v[76:79], v224 offset:63488
    v_mfma_f32_16x16x32_bf16 v[176:179], v[80:83], a[216:219], v[176:179]
    v_mfma_f32_16x16x32_bf16 v[180:183], v[84:87], a[216:219], v[180:183]
    v_mfma_f32_16x16x32_bf16 v[184:187], v[80:83], a[220:223], v[184:187]
    v_mfma_f32_16x16x32_bf16 v[188:191], v[84:87], a[220:223], v[188:191]
    v_mfma_f32_16x16x32_bf16 v[192:195], v[88:91], a[208:211], v[192:195]
    buffer_load_dwordx4 a[140:143], v249, s[8:11], s29 offen offset:0 sc1
    v_mfma_f32_16x16x32_bf16 v[196:199], v[92:95], a[208:211], v[196:199]
    v_mfma_f32_16x16x32_bf16 v[200:203], v[88:91], a[212:215], v[200:203]
    buffer_load_dwordx4 a[144:147], v248, s[8:11], s28 offen offset:1024 sc1
    v_mfma_f32_16x16x32_bf16 v[204:207], v[92:95], a[212:215], v[204:207]
    v_mfma_f32_16x16x32_bf16 v[208:211], v[88:91], a[216:219], v[208:211]
    v_mfma_f32_16x16x32_bf16 v[212:215], v[92:95], a[216:219], v[212:215]
    buffer_load_dwordx4 a[148:151], v248, s[8:11], s29 offen offset:1024 sc1
    v_mfma_f32_16x16x32_bf16 v[216:219], v[88:91], a[220:223], v[216:219]
    s_add_u32 s38, s36, 77824
    buffer_store_dwordx4 v[24:27], v240, s[16:19], s38 offen offset:512 sc1
    v_mfma_f32_16x16x32_bf16 v[220:223], v[92:95], a[220:223], v[220:223]
    s_waitcnt lgkmcnt(0)
    v_mfma_f32_16x16x32_bf16 v[160:163], v[64:67], a[224:227], v[160:163]
    ds_read_b128 v[80:83], v225 offset:57344
    v_mfma_f32_16x16x32_bf16 v[164:167], v[68:71], a[224:227], v[164:167]
    ds_read_b128 v[84:87], v225 offset:59392
    v_mfma_f32_16x16x32_bf16 v[168:171], v[64:67], a[228:231], v[168:171]
    ds_read_b128 v[88:91], v225 offset:61440
    v_mfma_f32_16x16x32_bf16 v[172:175], v[68:71], a[228:231], v[172:175]
    ds_read_b128 v[92:95], v225 offset:63488
    v_mfma_f32_16x16x32_bf16 v[176:179], v[64:67], a[232:235], v[176:179]
    v_mfma_f32_16x16x32_bf16 v[180:183], v[68:71], a[232:235], v[180:183]
    v_mfma_f32_16x16x32_bf16 v[184:187], v[64:67], a[236:239], v[184:187]
    v_mfma_f32_16x16x32_bf16 v[188:191], v[68:71], a[236:239], v[188:191]
    v_mfma_f32_16x16x32_bf16 v[192:195], v[72:75], a[224:227], v[192:195]
    buffer_load_dwordx4 a[152:155], v249, s[8:11], s28 offen offset:1024 sc1
    v_mfma_f32_16x16x32_bf16 v[196:199], v[76:79], a[224:227], v[196:199]
    v_mfma_f32_16x16x32_bf16 v[200:203], v[72:75], a[228:231], v[200:203]
    buffer_load_dwordx4 a[156:159], v249, s[8:11], s29 offen offset:1024 sc1
    v_mfma_f32_16x16x32_bf16 v[204:207], v[76:79], a[228:231], v[204:207]
    v_mfma_f32_16x16x32_bf16 v[208:211], v[72:75], a[232:235], v[208:211]
    v_mfma_f32_16x16x32_bf16 v[212:215], v[76:79], a[232:235], v[212:215]
    buffer_load_dwordx4 a[160:163], v248, s[8:11], s28 offen offset:2048 sc1
    v_mfma_f32_16x16x32_bf16 v[216:219], v[72:75], a[236:239], v[216:219]
    v_mfma_f32_16x16x32_bf16 v[220:223], v[76:79], a[236:239], v[220:223]
    s_waitcnt vmcnt(38) lgkmcnt(0)
    s_barrier
    v_mfma_f32_16x16x32_bf16 v[160:163], v[80:83], a[240:243], v[160:163]
    ds_read_b64_tr_b16 a[192:193], v246 offset:0
    v_mfma_f32_16x16x32_bf16 v[164:167], v[84:87], a[240:243], v[164:167]
    ds_read_b64_tr_b16 a[194:195], v246 offset:1024
    v_mfma_f32_16x16x32_bf16 v[168:171], v[80:83], a[244:247], v[168:171]
    ds_read_b64_tr_b16 a[196:197], v238 offset:0
    v_mfma_f32_16x16x32_bf16 v[172:175], v[84:87], a[244:247], v[172:175]
    ds_read_b64_tr_b16 a[198:199], v238 offset:1024
    v_mfma_f32_16x16x32_bf16 v[176:179], v[80:83], a[248:251], v[176:179]
    ds_read_b64_tr_b16 a[200:201], v246 offset:256
    s_add_u32 s38, s36, 77824
    buffer_store_dwordx4 v[28:31], v240, s[16:19], s38 offen offset:1536 sc1
    v_mfma_f32_16x16x32_bf16 v[180:183], v[84:87], a[248:251], v[180:183]
    ds_read_b64_tr_b16 a[202:203], v246 offset:1280
    v_mfma_f32_16x16x32_bf16 v[184:187], v[80:83], a[252:255], v[184:187]
    ds_read_b64_tr_b16 a[204:205], v238 offset:256
    v_mfma_f32_16x16x32_bf16 v[188:191], v[84:87], a[252:255], v[188:191]
    ds_read_b64_tr_b16 a[206:207], v238 offset:1280
    v_mfma_f32_16x16x32_bf16 v[192:195], v[88:91], a[240:243], v[192:195]
    buffer_load_dwordx4 a[164:167], v248, s[8:11], s29 offen offset:2048 sc1
    v_mfma_f32_16x16x32_bf16 v[196:199], v[92:95], a[240:243], v[196:199]
    v_cvt_pk_bf16_f32 v32, v160, v161
    v_cvt_pk_bf16_f32 v33, v162, v163
    v_mfma_f32_16x16x32_bf16 v[200:203], v[88:91], a[244:247], v[200:203]
    buffer_load_dwordx4 a[168:171], v249, s[8:11], s28 offen offset:2048 sc1
    v_cvt_pk_bf16_f32 v34, v164, v165
    v_cvt_pk_bf16_f32 v35, v166, v167
    v_mfma_f32_16x16x32_bf16 v[204:207], v[92:95], a[244:247], v[204:207]
    v_cvt_pk_bf16_f32 v36, v168, v169
    v_cvt_pk_bf16_f32 v37, v170, v171
    v_mfma_f32_16x16x32_bf16 v[208:211], v[88:91], a[248:251], v[208:211]
    v_cvt_pk_bf16_f32 v38, v172, v173
    v_cvt_pk_bf16_f32 v39, v174, v175
    v_mfma_f32_16x16x32_bf16 v[212:215], v[92:95], a[248:251], v[212:215]
    buffer_load_dwordx4 a[172:175], v249, s[8:11], s29 offen offset:2048 sc1
    v_cvt_pk_bf16_f32 v40, v176, v177
    v_cvt_pk_bf16_f32 v41, v178, v179
    v_mfma_f32_16x16x32_bf16 v[216:219], v[88:91], a[252:255], v[216:219]
    v_cvt_pk_bf16_f32 v42, v180, v181
    v_cvt_pk_bf16_f32 v43, v182, v183
    v_mfma_f32_16x16x32_bf16 v[220:223], v[92:95], a[252:255], v[220:223]
    v_cvt_pk_bf16_f32 v44, v184, v185
    v_cvt_pk_bf16_f32 v45, v186, v187
    s_nop 3
    v_cvt_pk_bf16_f32 v46, v188, v189
    v_cvt_pk_bf16_f32 v47, v190, v191
    v_cvt_pk_bf16_f32 v48, v192, v193
    v_cvt_pk_bf16_f32 v49, v194, v195
    v_cvt_pk_bf16_f32 v50, v196, v197
    v_cvt_pk_bf16_f32 v51, v198, v199
    v_cvt_pk_bf16_f32 v52, v200, v201
    v_cvt_pk_bf16_f32 v53, v202, v203
    v_cvt_pk_bf16_f32 v54, v204, v205
    v_cvt_pk_bf16_f32 v55, v206, v207
    v_cvt_pk_bf16_f32 v56, v208, v209
    v_cvt_pk_bf16_f32 v57, v210, v211
    v_cvt_pk_bf16_f32 v58, v212, v213
    v_cvt_pk_bf16_f32 v59, v214, v215
    v_cvt_pk_bf16_f32 v60, v216, v217
    v_cvt_pk_bf16_f32 v61, v218, v219
    v_cvt_pk_bf16_f32 v62, v220, v221
    v_cvt_pk_bf16_f32 v63, v222, v223
    s_add_u32 s80, s36, 102144
    s_add_u32 s81, s36, 103168
    s_add_u32 s82, s36, 104192
    s_add_u32 s83, s36, 105216
    s_add_u32 s84, s36, 110336
    s_add_u32 s85, s36, 111360
    s_add_u32 s86, s36, 112384
    s_add_u32 s87, s36, 113408
ka_Q:
    s_waitcnt vmcnt(10) lgkmcnt(0)
    v_mfma_f32_16x16x32_bf16 v[96:99], a[192:195], a[128:131], 0
    ds_read_b64_tr_b16 a[208:209], v246 offset:512
    s_lshl_b32 s97, s4, 7
    v_mfma_f32_16x16x32_bf16 v[100:103], a[192:195], a[132:135], 0
    ds_read_b64_tr_b16 a[210:211], v246 offset:1536
    s_add_u32 s97, s97, 12288
    s_cmp_eq_u32 s3, 0
    s_cselect_b32 s35, s97, s43
    v_mfma_f32_16x16x32_bf16 v[104:107], a[192:195], a[136:139], 0
    ds_read_b64_tr_b16 a[212:213], v238 offset:512
    s_lshl_b32 s37, s3, 12
    v_mfma_f32_16x16x32_bf16 v[108:111], a[192:195], a[140:143], 0
    ds_read_b64_tr_b16 a[214:215], v238 offset:1536
    s_mov_b32 s34, s37
    s_mul_i32 s32, s4, 1089536
    v_mfma_f32_16x16x32_bf16 v[112:115], a[196:199], a[128:131], 0
    ds_read_b64_tr_b16 a[216:217], v246 offset:768
    s_mov_b32 s33, 0
    v_mfma_f32_16x16x32_bf16 v[116:119], a[196:199], a[132:135], 0
    ds_read_b64_tr_b16 a[218:219], v246 offset:1792
    s_lshl_b32 s39, s6, 18
    v_mfma_f32_16x16x32_bf16 v[120:123], a[196:199], a[136:139], 0
    ds_read_b64_tr_b16 a[220:221], v238 offset:768
    s_sub_u32 s25, 63, s6
    s_lshl_b32 s40, s25, 18
    v_mfma_f32_16x16x32_bf16 v[124:127], a[196:199], a[140:143], 0
    ds_read_b64_tr_b16 a[222:223], v238 offset:1792
    s_lshl_b32 s25, s4, 12
    v_mfma_f32_16x16x32_bf16 v[128:131], a[200:203], a[128:131], 0
    buffer_load_dwordx4 a[176:179], v248, s[8:11], s28 offen offset:3072 sc1
    s_add_u32 s39, s39, s25
    s_add_u32 s40, s40, s25
    v_mfma_f32_16x16x32_bf16 v[132:135], a[200:203], a[132:135], 0
    s_mov_b32 s38, 0x40004000
    s_mov_b32 s36, s6
    v_mfma_f32_16x16x32_bf16 v[136:139], a[200:203], a[136:139], 0
    buffer_load_dwordx4 a[180:183], v248, s[8:11], s29 offen offset:3072 sc1
    s_mov_b32 s26, 6
    v_mfma_f32_16x16x32_bf16 v[140:143], a[200:203], a[140:143], 0
    s_add_u32 m0, s31, 0
    s_add_u32 s24, s27, 0
    s_mov_b32 s52, s41
    v_mfma_f32_16x16x32_bf16 v[144:147], a[204:207], a[128:131], 0
    buffer_load_dwordx4 v245, s[12:15], s24 offen lds
    s_mov_b32 s53, s42
    v_mfma_f32_16x16x32_bf16 v[148:151], a[204:207], a[132:135], 0
    s_mov_b32 s54, 0x700000
    s_add_u32 s48, s20, 0x1c00000
    s_addc_u32 s49, s21, 0
    v_mfma_f32_16x16x32_bf16 v[152:155], a[204:207], a[136:139], 0
    buffer_store_dwordx4 v[32:35], v240, s[16:19], s80 offen sc1
    s_mov_b32 s50, 0x1c00000
    s_and_b32 s25, s3, 1
    v_mfma_f32_16x16x32_bf16 v[156:159], a[204:207], a[140:143], 0
    s_lshl1_add_u32 s47, s4, s25
    s_waitcnt lgkmcnt(0)
    v_mfma_f32_16x16x32_bf16 v[160:163], a[208:211], a[128:131], 0
    ds_read_b64_tr_b16 a[192:193], v246 offset:8192
    s_lshr_b32 s101, s3, 1
    v_mfma_f32_16x16x32_bf16 v[164:167], a[208:211], a[132:135], 0
    ds_read_b64_tr_b16 a[194:195], v246 offset:9216
    s_add_u32 s45, s5, s101
    s_sub_u32 s45, s45, 1
    v_mfma_f32_16x16x32_bf16 v[168:171], a[208:211], a[136:139], 0
    ds_read_b64_tr_b16 a[196:197], v238 offset:8192
    s_mul_i32 s45, s45, s5
    v_mfma_f32_16x16x32_bf16 v[172:175], a[208:211], a[140:143], 0
    ds_read_b64_tr_b16 a[198:199], v238 offset:9216
    s_lshl_b32 s100, s101, 14
    s_add_u32 s100, s100, 114688
    v_mfma_f32_16x16x32_bf16 v[176:179], a[212:215], a[128:131], 0
    ds_read_b64_tr_b16 a[200:201], v246 offset:8448
    s_mul_i32 s100, s100, s47
    v_mfma_f32_16x16x32_bf16 v[180:183], a[212:215], a[132:135], 0
    ds_read_b64_tr_b16 a[202:203], v246 offset:9472
    s_lshl_b32 s25, s45, 11
    v_mfma_f32_16x16x32_bf16 v[184:187], a[212:215], a[136:139], 0
    ds_read_b64_tr_b16 a[204:205], v238 offset:8448
    s_add_u32 s100, s100, s25
    s_lshl_b32 s46, s47, 9
    v_mfma_f32_16x16x32_bf16 v[188:191], a[212:215], a[140:143], 0
    ds_read_b64_tr_b16 a[206:207], v238 offset:9472
    s_mul_i32 s44, s47, 114688
    v_mfma_f32_16x16x32_bf16 v[192:195], a[216:219], a[128:131], 0
    buffer_load_dwordx4 a[184:187], v249, s[8:11], s28 offen offset:3072 sc1
    s_add_u32 s47, s44, 7168
    s_lshl_b32 s25, s45, 7
    v_mfma_f32_16x16x32_bf16 v[196:199], a[216:219], a[132:135], 0
    s_add_u32 s44, s44, s25
    s_lshl_b32 s45, s45, 18
    v_mfma_f32_16x16x32_bf16 v[200:203], a[216:219], a[136:139], 0
    buffer_load_dwordx4 a[188:191], v249, s[8:11], s29 offen offset:3072 sc1
    s_add_u32 s46, s46, s45
    v_mfma_f32_16x16x32_bf16 v[204:207], a[216:219], a[140:143], 0
    s_add_u32 m0, s31, 1024
    s_add_u32 s24, s27, 32768
    s_lshr_b32 s25, s3, 1
    v_mfma_f32_16x16x32_bf16 v[208:211], a[220:223], a[128:131], 0
    buffer_load_dwordx4 v245, s[12:15], s24 offen lds
    s_lshl_b32 s25, s25, 15
    v_mfma_f32_16x16x32_bf16 v[212:215], a[220:223], a[132:135], 0
    s_add_u32 s46, s46, s25
    s_mov_b32 s45, s43
    v_mfma_f32_16x16x32_bf16 v[216:219], a[220:223], a[136:139], 0
    s_add_u32 s28, s28, 4096
    s_and_b32 s28, s28, 32767
    buffer_store_dwordx4 v[36:39], v240, s[16:19], s81 offen sc1
    v_mfma_f32_16x16x32_bf16 v[220:223], a[220:223], a[140:143], 0
    s_add_u32 s29, s28, 32768
    v_accvgpr_write_b32 a0, 0
    s_waitcnt vmcnt(13) lgkmcnt(0)
    v_mfma_f32_16x16x32_bf16 v[96:99], a[192:195], a[144:147], v[96:99]
    ds_read_b64_tr_b16 a[208:209], v246 offset:8704
    s_load_dwordx2 s[56:57], s[0:1], 40
    v_accvgpr_write_b32 a1, 0
    v_mfma_f32_16x16x32_bf16 v[100:103], a[192:195], a[148:151], v[100:103]
    ds_read_b64_tr_b16 a[210:211], v246 offset:9728
    v_accvgpr_write_b32 a2, 0
    v_mfma_f32_16x16x32_bf16 v[104:107], a[192:195], a[152:155], v[104:107]
    ds_read_b64_tr_b16 a[212:213], v238 offset:8704
    v_accvgpr_write_b32 a3, 0
    v_mfma_f32_16x16x32_bf16 v[108:111], a[192:195], a[156:159], v[108:111]
    ds_read_b64_tr_b16 a[214:215], v238 offset:9728
    v_accvgpr_write_b32 a4, 0
    v_accvgpr_write_b32 a5, 0
    v_mfma_f32_16x16x32_bf16 v[112:115], a[196:199], a[144:147], v[112:115]
    ds_read_b64_tr_b16 a[216:217], v246 offset:8960
    v_accvgpr_write_b32 a6, 0
    v_mfma_f32_16x16x32_bf16 v[116:119], a[196:199], a[148:151], v[116:119]
    ds_read_b64_tr_b16 a[218:219], v246 offset:9984
    v_accvgpr_write_b32 a7, 0
    v_accvgpr_write_b32 a8, 0
    v_mfma_f32_16x16x32_bf16 v[120:123], a[196:199], a[152:155], v[120:123]
    ds_read_b64_tr_b16 a[220:221], v238 offset:8960
    v_accvgpr_write_b32 a9, 0
    v_mfma_f32_16x16x32_bf16 v[124:127], a[196:199], a[156:159], v[124:127]
    ds_read_b64_tr_b16 a[222:223], v238 offset:9984
    v_accvgpr_write_b32 a10, 0
    v_mfma_f32_16x16x32_bf16 v[128:131], a[200:203], a[144:147], v[128:131]
    buffer_load_dwordx4 a[128:131], v248, s[8:11], s28 offen offset:0 sc1
    v_accvgpr_write_b32 a11, 0
    v_accvgpr_write_b32 a12, 0
    v_mfma_f32_16x16x32_bf16 v[132:135], a[200:203], a[148:151], v[132:135]
    v_accvgpr_write_b32 a13, 0
    v_accvgpr_write_b32 a14, 0
    v_mfma_f32_16x16x32_bf16 v[136:139], a[200:203], a[152:155], v[136:139]
    buffer_load_dwordx4 a[132:135], v248, s[8:11], s29 offen offset:0 sc1
    v_accvgpr_write_b32 a15, 0
    v_mfma_f32_16x16x32_bf16 v[140:143], a[200:203], a[156:159], v[140:143]
    s_add_u32 m0, s31, 2048
    s_add_u32 s24, s27, 65536
    v_accvgpr_write_b32 a16, 0
    v_mfma_f32_16x16x32_bf16 v[144:147], a[204:207], a[144:147], v[144:147]
    buffer_load_dwordx4 v237, s[12:15], s24 offen lds
    v_accvgpr_write_b32 a17, 0
    v_mfma_f32_16x16x32_bf16 v[148:151], a[204:207], a[148:151], v[148:151]
    v_accvgpr_write_b32 a18, 0
    v_accvgpr_write_b32 a19, 0
    v_accvgpr_write_b32 a20, 0
    v_mfma_f32_16x16x32_bf16 v[152:155], a[204:207], a[152:155], v[152:155]
    buffer_store_dwordx4 v[40:43], v240, s[16:19], s82 offen sc1
    v_accvgpr_write_b32 a21, 0
    v_mfma_f32_16x16x32_bf16 v[156:159], a[204:207], a[156:159], v[156:159]
    v_accvgpr_write_b32 a22, 0
    s_waitcnt lgkmcnt(0)
    v_mfma_f32_16x16x32_bf16 v[160:163], a[208:211], a[144:147], v[160:163]
    ds_read_b64_tr_b16 a[192:193], v246 offset:16384
    v_accvgpr_write_b32 a23, 0
    v_accvgpr_write_b32 a24, 0
    v_mfma_f32_16x16x32_bf16 v[164:167], a[208:211], a[148:151], v[164:167]
    ds_read_b64_tr_b16 a[194:195], v246 offset:17408
    v_accvgpr_write_b32 a25, 0
    v_mfma_f32_16x16x32_bf16 v[168:171], a[208:211], a[152:155], v[168:171]
    ds_read_b64_tr_b16 a[196:197], v238 offset:16384
    v_accvgpr_write_b32 a26, 0
    v_mfma_f32_16x16x32_bf16 v[172:175], a[208:211], a[156:159], v[172:175]
    ds_read_b64_tr_b16 a[198:199], v238 offset:17408
    v_accvgpr_write_b32 a27, 0
    v_accvgpr_write_b32 a28, 0
    v_mfma_f32_16x16x32_bf16 v[176:179], a[212:215], a[144:147], v[176:179]
    ds_read_b64_tr_b16 a[200:201], v246 offset:16640
    v_accvgpr_write_b32 a29, 0
    v_mfma_f32_16x16x32_bf16 v[180:183], a[212:215], a[148:151], v[180:183]
    ds_read_b64_tr_b16 a[202:203], v246 offset:17664
    v_accvgpr_write_b32 a30, 0
    v_accvgpr_write_b32 a31, 0
    v_mfma_f32_16x16x32_bf16 v[184:187], a[212:215], a[152:155], v[184:187]
    ds_read_b64_tr_b16 a[204:205], v238 offset:16640
    v_accvgpr_write_b32 a32, 0
    v_mfma_f32_16x16x32_bf16 v[188:191], a[212:215], a[156:159], v[188:191]
    ds_read_b64_tr_b16 a[206:207], v238 offset:17664
    v_accvgpr_write_b32 a33, 0
    v_mfma_f32_16x16x32_bf16 v[192:195], a[216:219], a[144:147], v[192:195]
    buffer_load_dwordx4 a[136:139], v249, s[8:11], s28 offen offset:0 sc1
    v_accvgpr_write_b32 a34, 0
    v_accvgpr_write_b32 a35, 0
    v_mfma_f32_16x16x32_bf16 v[196:199], a[216:219], a[148:151], v[196:199]
    v_accvgpr_write_b32 a36, 0
    v_accvgpr_write_b32 a37, 0
    v_mfma_f32_16x16x32_bf16 v[200:203], a[216:219], a[152:155], v[200:203]
    buffer_load_dwordx4 a[140:143], v249, s[8:11], s29 offen offset:0 sc1
    v_accvgpr_write_b32 a38, 0
    v_mfma_f32_16x16x32_bf16 v[204:207], a[216:219], a[156:159], v[204:207]
    s_add_u32 m0, s31, 3072
    s_add_u32 s24, s27, 98304
    v_accvgpr_write_b32 a39, 0
    v_mfma_f32_16x16x32_bf16 v[208:211], a[220:223], a[144:147], v[208:211]
    buffer_load_dwordx4 v237, s[12:15], s24 offen lds
    v_accvgpr_write_b32 a40, 0
    v_mfma_f32_16x16x32_bf16 v[212:215], a[220:223], a[148:151], v[212:215]
    v_accvgpr_write_b32 a41, 0
    v_accvgpr_write_b32 a42, 0
    v_accvgpr_write_b32 a43, 0
    v_mfma_f32_16x16x32_bf16 v[216:219], a[220:223], a[152:155], v[216:219]
    buffer_store_dwordx4 v[44:47], v240, s[16:19], s83 offen sc1
    v_accvgpr_write_b32 a44, 0
    v_mfma_f32_16x16x32_bf16 v[220:223], a[220:223], a[156:159], v[220:223]
    v_accvgpr_write_b32 a45, 0
    s_waitcnt vmcnt(16) lgkmcnt(0)
    v_mfma_f32_16x16x32_bf16 v[96:99], a[192:195], a[160:163], v[96:99]
    ds_read_b64_tr_b16 a[208:209], v246 offset:16896
    v_accvgpr_write_b32 a46, 0
    v_accvgpr_write_b32 a47, 0
    v_mfma_f32_16x16x32_bf16 v[100:103], a[192:195], a[164:167], v[100:103]
    ds_read_b64_tr_b16 a[210:211], v246 offset:17920
    v_accvgpr_write_b32 a48, 0
    v_mfma_f32_16x16x32_bf16 v[104:107], a[192:195], a[168:171], v[104:107]
    ds_read_b64_tr_b16 a[212:213], v238 offset:16896
    v_accvgpr_write_b32 a49, 0
    v_accvgpr_write_b32 a50, 0
    v_mfma_f32_16x16x32_bf16 v[108:111], a[192:195], a[172:175], v[108:111]
    ds_read_b64_tr_b16 a[214:215], v238 offset:17920
    v_accvgpr_write_b32 a51, 0
    v_mfma_f32_16x16x32_bf16 v[112:115], a[196:199], a[160:163], v[112:115]
    ds_read_b64_tr_b16 a[216:217], v246 offset:17152
    v_accvgpr_write_b32 a52, 0
    v_mfma_f32_16x16x32_bf16 v[116:119], a[196:199], a[164:167], v[116:119]
    ds_read_b64_tr_b16 a[218:219], v246 offset:18176
    v_accvgpr_write_b32 a53, 0
    v_accvgpr_write_b32 a54, 0
    v_mfma_f32_16x16x32_bf16 v[120:123], a[196:199], a[168:171], v[120:123]
    ds_read_b64_tr_b16 a[220:221], v238 offset:17152
    v_accvgpr_write_b32 a55, 0
    v_mfma_f32_16x16x32_bf16 v[124:127], a[196:199], a[172:175], v[124:127]
    ds_read_b64_tr_b16 a[222:223], v238 offset:18176
    v_accvgpr_write_b32 a56, 0
    v_accvgpr_write_b32 a57, 0
    v_mfma_f32_16x16x32_bf16 v[128:131], a[200:203], a[160:163], v[128:131]
    buffer_load_dwordx4 a[144:147], v248, s[8:11], s28 offen offset:1024 sc1
    v_accvgpr_write_b32 a58, 0
    v_mfma_f32_16x16x32_bf16 v[132:135], a[200:203], a[164:167], v[132:135]
    v_accvgpr_write_b32 a59, 0
    v_accvgpr_write_b32 a60, 0
    v_mfma_f32_16x16x32_bf16 v[136:139], a[200:203], a[168:171], v[136:139]
    buffer_load_dwordx4 a[148:151], v248, s[8:11], s29 offen offset:1024 sc1
    v_accvgpr_write_b32 a61, 0
    v_mfma_f32_16x16x32_bf16 v[140:143], a[200:203], a[172:175], v[140:143]
    s_add_u32 m0, s31, 4096
    s_add_u32 s24, s27, 131072
    v_accvgpr_write_b32 a62, 0
    v_mfma_f32_16x16x32_bf16 v[144:147], a[204:207], a[160:163], v[144:147]
    buffer_load_dwordx4 v245, s[12:15], s24 offen lds
    v_accvgpr_write_b32 a63, 0
    v_mfma_f32_16x16x32_bf16 v[148:151], a[204:207], a[164:167], v[148:151]
    v_accvgpr_write_b32 a64, 0
    v_accvgpr_write_b32 a65, 0
    v_accvgpr_write_b32 a66, 0
    v_mfma_f32_16x16x32_bf16 v[152:155], a[204:207], a[168:171], v[152:155]
    buffer_store_dwordx4 v[48:51], v240, s[16:19], s84 offen sc1
    v_accvgpr_write_b32 a67, 0
    v_mfma_f32_16x16x32_bf16 v[156:159], a[204:207], a[172:175], v[156:159]
    v_accvgpr_write_b32 a68, 0
    s_waitcnt lgkmcnt(0)
    v_mfma_f32_16x16x32_bf16 v[160:163], a[208:211], a[160:163], v[160:163]
    ds_read_b64_tr_b16 a[192:193], v246 offset:24576
    v_accvgpr_write_b32 a69, 0
    v_accvgpr_write_b32 a70, 0
    v_mfma_f32_16x16x32_bf16 v[164:167], a[208:211], a[164:167], v[164:167]
    ds_read_b64_tr_b16 a[194:195], v246 offset:25600
    v_accvgpr_write_b32 a71, 0
    v_mfma_f32_16x16x32_bf16 v[168:171], a[208:211], a[168:171], v[168:171]
    ds_read_b64_tr_b16 a[196:197], v238 offset:24576
    v_accvgpr_write_b32 a72, 0
    v_accvgpr_write_b32 a73, 0
    v_mfma_f32_16x16x32_bf16 v[172:175], a[208:211], a[172:175], v[172:175]
    ds_read_b64_tr_b16 a[198:199], v238 offset:25600
    v_accvgpr_write_b32 a74, 0
    v_mfma_f32_16x16x32_bf16 v[176:179], a[212:215], a[160:163], v[176:179]
    ds_read_b64_tr_b16 a[200:201], v246 offset:24832
    v_accvgpr_write_b32 a75, 0
    v_mfma_f32_16x16x32_bf16 v[180:183], a[212:215], a[164:167], v[180:183]
    ds_read_b64_tr_b16 a[202:203], v246 offset:25856
    v_accvgpr_write_b32 a76, 0
    v_accvgpr_write_b32 a77, 0
    v_mfma_f32_16x16x32_bf16 v[184:187], a[212:215], a[168:171], v[184:187]
    ds_read_b64_tr_b16 a[204:205], v238 offset:24832
    v_accvgpr_write_b32 a78, 0
    v_mfma_f32_16x16x32_bf16 v[188:191], a[212:215], a[172:175], v[188:191]
    ds_read_b64_tr_b16 a[206:207], v238 offset:25856
    v_accvgpr_write_b32 a79, 0
    v_accvgpr_write_b32 a80, 0
    v_mfma_f32_16x16x32_bf16 v[192:195], a[216:219], a[160:163], v[192:195]
    buffer_load_dwordx4 a[152:155], v249, s[8:11], s28 offen offset:1024 sc1
    v_accvgpr_write_b32 a81, 0
    v_mfma_f32_16x16x32_bf16 v[196:199], a[216:219], a[164:167], v[196:199]
    v_accvgpr_write_b32 a82, 0
    v_accvgpr_write_b32 a83, 0
    v_mfma_f32_16x16x32_bf16 v[200:203], a[216:219], a[168:171], v[200:203]
    buffer_load_dwordx4 a[156:159], v249, s[8:11], s29 offen offset:1024 sc1
    v_accvgpr_write_b32 a84, 0
    v_mfma_f32_16x16x32_bf16 v[204:207], a[216:219], a[172:175], v[204:207]
    s_add_u32 m0, s31, 5120
    s_add_u32 s24, s27, 163840
    v_accvgpr_write_b32 a85, 0
    v_mfma_f32_16x16x32_bf16 v[208:211], a[220:223], a[160:163], v[208:211]
    buffer_load_dwordx4 v245, s[12:15], s24 offen lds
    v_accvgpr_write_b32 a86, 0
    v_accvgpr_write_b32 a87, 0
    v_mfma_f32_16x16x32_bf16 v[212:215], a[220:223], a[164:167], v[212:215]
    v_accvgpr_write_b32 a88, 0
    v_accvgpr_write_b32 a89, 0
    v_mfma_f32_16x16x32_bf16 v[216:219], a[220:223], a[168:171], v[216:219]
    s_add_u32 s30, s30, 32768
    buffer_store_dwordx4 v[52:55], v240, s[16:19], s85 offen sc1
    v_mfma_f32_16x16x32_bf16 v[220:223], a[220:223], a[172:175], v[220:223]
    s_cmp_ge_u32 s30, 163840
    s_cselect_b32 s30, 65536, s30
    s_waitcnt vmcnt(18) lgkmcnt(0)
    v_mfma_f32_16x16x32_bf16 v[96:99], a[192:195], a[176:179], v[96:99]
    ds_read_b64_tr_b16 a[208:209], v246 offset:25088
    v_accvgpr_write_b32 a90, 0
    v_accvgpr_write_b32 a91, 0
    v_mfma_f32_16x16x32_bf16 v[100:103], a[192:195], a[180:183], v[100:103]
    ds_read_b64_tr_b16 a[210:211], v246 offset:26112
    v_accvgpr_write_b32 a92, 0
    v_mfma_f32_16x16x32_bf16 v[104:107], a[192:195], a[184:187], v[104:107]
    ds_read_b64_tr_b16 a[212:213], v238 offset:25088
    v_accvgpr_write_b32 a93, 0
    v_mfma_f32_16x16x32_bf16 v[108:111], a[192:195], a[188:191], v[108:111]
    ds_read_b64_tr_b16 a[214:215], v238 offset:26112
    v_accvgpr_write_b32 a94, 0
    v_accvgpr_write_b32 a95, 0
    v_mfma_f32_16x16x32_bf16 v[112:115], a[196:199], a[176:179], v[112:115]
    ds_read_b64_tr_b16 a[216:217], v246 offset:25344
    v_accvgpr_write_b32 a96, 0
    v_mfma_f32_16x16x32_bf16 v[116:119], a[196:199], a[180:183], v[116:119]
    ds_read_b64_tr_b16 a[218:219], v246 offset:26368
    v_accvgpr_write_b32 a97, 0
    v_accvgpr_write_b32 a98, 0
    v_mfma_f32_16x16x32_bf16 v[120:123], a[196:199], a[184:187], v[120:123]
    ds_read_b64_tr_b16 a[220:221], v238 offset:25344
    v_accvgpr_write_b32 a99, 0
    v_mfma_f32_16x16x32_bf16 v[124:127], a[196:199], a[188:191], v[124:127]
    ds_read_b64_tr_b16 a[222:223], v238 offset:26368
    v_accvgpr_write_b32 a100, 0
    v_mfma_f32_16x16x32_bf16 v[128:131], a[200:203], a[176:179], v[128:131]
    buffer_load_dwordx4 a[160:163], v248, s[8:11], s28 offen offset:2048 sc1
    v_accvgpr_write_b32 a101, 0
    v_accvgpr_write_b32 a102, 0
    v_mfma_f32_16x16x32_bf16 v[132:135], a[200:203], a[180:183], v[132:135]
    v_accvgpr_write_b32 a103, 0
    v_accvgpr_write_b32 a104, 0
    v_mfma_f32_16x16x32_bf16 v[136:139], a[200:203], a[184:187], v[136:139]
    buffer_load_dwordx4 a[164:167], v248, s[8:11], s29 offen offset:2048 sc1
    v_accvgpr_write_b32 a105, 0
    v_mfma_f32_16x16x32_bf16 v[140:143], a[200:203], a[188:191], v[140:143]
    s_add_u32 m0, s31, 6144
    s_add_u32 s24, s27, 196608
    v_accvgpr_write_b32 a106, 0
    v_mfma_f32_16x16x32_bf16 v[144:147], a[204:207], a[176:179], v[144:147]
    buffer_load_dwordx4 v237, s[12:15], s24 offen lds
    v_accvgpr_write_b32 a107, 0
    v_mfma_f32_16x16x32_bf16 v[148:151], a[204:207], a[180:183], v[148:151]
    v_accvgpr_write_b32 a108, 0
    v_accvgpr_write_b32 a109, 0
    v_accvgpr_write_b32 a110, 0
    v_mfma_f32_16x16x32_bf16 v[152:155], a[204:207], a[184:187], v[152:155]
    buffer_store_dwordx4 v[56:59], v240, s[16:19], s86 offen sc1
    v_accvgpr_write_b32 a111, 0
    v_mfma_f32_16x16x32_bf16 v[156:159], a[204:207], a[188:191], v[156:159]
    s_waitcnt vmcnt(49) lgkmcnt(0)
    s_barrier
    v_add_u32 v246, s30, v247
    v_mfma_f32_16x16x32_bf16 v[160:163], a[208:211], a[176:179], v[160:163]
    v_xor_b32 v238, 16, v246
    ds_read_b64_tr_b16 a[192:193], v246 offset:0
    v_accvgpr_write_b32 a112, 0
    v_mfma_f32_16x16x32_bf16 v[164:167], a[208:211], a[180:183], v[164:167]
    ds_read_b64_tr_b16 a[194:195], v246 offset:1024
    v_accvgpr_write_b32 a113, 0
    v_mfma_f32_16x16x32_bf16 v[168:171], a[208:211], a[184:187], v[168:171]
    ds_read_b64_tr_b16 a[196:197], v238 offset:0
    v_accvgpr_write_b32 a114, 0
    v_mfma_f32_16x16x32_bf16 v[172:175], a[208:211], a[188:191], v[172:175]
    ds_read_b64_tr_b16 a[198:199], v238 offset:1024
    v_accvgpr_write_b32 a115, 0
    v_accvgpr_write_b32 a116, 0
    v_mfma_f32_16x16x32_bf16 v[176:179], a[212:215], a[176:179], v[176:179]
    ds_read_b64_tr_b16 a[200:201], v246 offset:256
    v_accvgpr_write_b32 a117, 0
    v_mfma_f32_16x16x32_bf16 v[180:183], a[212:215], a[180:183], v[180:183]
    ds_read_b64_tr_b16 a[202:203], v246 offset:1280
    v_accvgpr_write_b32 a118, 0
    v_accvgpr_write_b32 a119, 0
    v_mfma_f32_16x16x32_bf16 v[184:187], a[212:215], a[184:187], v[184:187]
    ds_read_b64_tr_b16 a[204:205], v238 offset:256
    buffer_store_dwordx4 v[60:63], v240, s[16:19], s87 offen sc1
    v_mfma_f32_16x16x32_bf16 v[188:191], a[212:215], a[188:191], v[188:191]
    ds_read_b64_tr_b16 a[206:207], v238 offset:1280
    v_accvgpr_write_b32 a120, 0
    v_accvgpr_write_b32 a121, 0
    v_mfma_f32_16x16x32_bf16 v[192:195], a[216:219], a[176:179], v[192:195]
    buffer_load_dwordx4 a[168:171], v249, s[8:11], s28 offen offset:2048 sc1
    v_accvgpr_write_b32 a122, 0
    v_mfma_f32_16x16x32_bf16 v[196:199], a[216:219], a[180:183], v[196:199]
    s_lshl2_add_u32 s80, s2, s3
    s_mul_i32 s80, s80, 12288
    s_add_u32 s80, s80, 0x1000000
    v_mov_b32 v0, -1
    v_mov_b32 v1, -1
    v_mov_b32 v2, -1
    v_mov_b32 v3, -1
    v_mfma_f32_16x16x32_bf16 v[200:203], a[216:219], a[184:187], v[200:203]
    buffer_load_dwordx4 a[172:175], v249, s[8:11], s29 offen offset:2048 sc1
    v_accvgpr_write_b32 a123, 0
    v_accvgpr_write_b32 a124, 0
    v_mfma_f32_16x16x32_bf16 v[204:207], a[216:219], a[188:191], v[204:207]
    s_add_u32 m0, s31, 7168
    s_add_u32 s24, s27, 229376
    v_mfma_f32_16x16x32_bf16 v[208:211], a[220:223], a[176:179], v[208:211]
    buffer_load_dwordx4 v237, s[12:15], s24 offen lds
    v_accvgpr_write_b32 a125, 0
    v_accvgpr_write_b32 a126, 0
    v_mfma_f32_16x16x32_bf16 v[212:215], a[220:223], a[180:183], v[212:215]
    s_add_u32 s27, s27, 1048576
    s_and_b32 s27, s27, 0x407fffff
    v_mfma_f32_16x16x32_bf16 v[216:219], a[220:223], a[184:187], v[216:219]
    s_cmp_eq_u32 s27, s7
    s_cselect_b32 s27, s43, s27
    v_accvgpr_write_b32 a127, 0
    v_mfma_f32_16x16x32_bf16 v[220:223], a[220:223], a[188:191], v[220:223]
    s_add_u32 s31, s31, 32768
    s_cmp_ge_u32 s31, 163840
    s_cselect_b32 s24, 98304, 0
    s_sub_u32 s31, s31, s24
.p2align 3
ka_qp:
    s_waitcnt vmcnt(15) lgkmcnt(0)
    v_mfma_f32_16x16x32_bf16 v[96:99], a[192:195], a[128:131], v[96:99]
    ds_read_b64_tr_b16 a[208:209], v246 offset:512
    v_mfma_f32_16x16x32_bf16 v[100:103], a[192:195], a[132:135], v[100:103]
    ds_read_b64_tr_b16 a[210:211], v246 offset:1536
    v_mfma_f32_16x16x32_bf16 v[104:107], a[192:195], a[136:139], v[104:107]
    ds_read_b64_tr_b16 a[212:213], v238 offset:512
    v_mfma_f32_16x16x32_bf16 v[108:111], a[192:195], a[140:143], v[108:111]
    ds_read_b64_tr_b16 a[214:215], v238 offset:1536
    v_mfma_f32_16x16x32_bf16 v[112:115], a[196:199], a[128:131], v[112:115]
    ds_read_b64_tr_b16 a[216:217], v246 offset:768
    v_mfma_f32_16x16x32_bf16 v[116:119], a[196:199], a[132:135], v[116:119]
    ds_read_b64_tr_b16 a[218:219], v246 offset:1792
    v_mfma_f32_16x16x32_bf16 v[120:123], a[196:199], a[136:139], v[120:123]
    ds_read_b64_tr_b16 a[220:221], v238 offset:768
    v_mfma_f32_16x16x32_bf16 v[124:127], a[196:199], a[140:143], v[124:127]
    ds_read_b64_tr_b16 a[222:223], v238 offset:1792
    v_mfma_f32_16x16x32_bf16 v[128:131], a[200:203], a[128:131], v[128:131]
    buffer_load_dwordx4 a[176:179], v248, s[8:11], s28 offen offset:3072 sc1
    s_cmp_eq_u32 s26, 1
    s_cselect_b32 s41, s35, s43
    buffer_load_dword v254, off, s[88:91], s41 sc1
    v_mfma_f32_16x16x32_bf16 v[132:135], a[200:203], a[132:135], v[132:135]
    v_mfma_f32_16x16x32_bf16 v[136:139], a[200:203], a[136:139], v[136:139]
    buffer_load_dwordx4 a[180:183], v248, s[8:11], s29 offen offset:3072 sc1
    v_mfma_f32_16x16x32_bf16 v[140:143], a[200:203], a[140:143], v[140:143]
    s_add_u32 m0, s31, 0
    s_add_u32 s24, s27, 0
    v_mfma_f32_16x16x32_bf16 v[144:147], a[204:207], a[128:131], v[144:147]
    buffer_load_dwordx4 v245, s[12:15], s24 offen lds
    v_mfma_f32_16x16x32_bf16 v[148:151], a[204:207], a[132:135], v[148:151]
    v_mfma_f32_16x16x32_bf16 v[152:155], a[204:207], a[136:139], v[152:155]
    v_mfma_f32_16x16x32_bf16 v[156:159], a[204:207], a[140:143], v[156:159]
    s_waitcnt lgkmcnt(0)
    v_mfma_f32_16x16x32_bf16 v[160:163], a[208:211], a[128:131], v[160:163]
    ds_read_b64_tr_b16 a[192:193], v246 offset:8192
    v_mfma_f32_16x16x32_bf16 v[164:167], a[208:211], a[132:135], v[164:167]
    ds_read_b64_tr_b16 a[194:195], v246 offset:9216
    v_mfma_f32_16x16x32_bf16 v[168:171], a[208:211], a[136:139], v[168:171]
    ds_read_b64_tr_b16 a[196:197], v238 offset:8192
    v_mfma_f32_16x16x32_bf16 v[172:175], a[208:211], a[140:143], v[172:175]
    ds_read_b64_tr_b16 a[198:199], v238 offset:9216
    v_mfma_f32_16x16x32_bf16 v[176:179], a[212:215], a[128:131], v[176:179]
    ds_read_b64_tr_b16 a[200:201], v246 offset:8448
    v_mfma_f32_16x16x32_bf16 v[180:183], a[212:215], a[132:135], v[180:183]
    ds_read_b64_tr_b16 a[202:203], v246 offset:9472
    v_mfma_f32_16x16x32_bf16 v[184:187], a[212:215], a[136:139], v[184:187]
    ds_read_b64_tr_b16 a[204:205], v238 offset:8448
    v_mfma_f32_16x16x32_bf16 v[188:191], a[212:215], a[140:143], v[188:191]
    ds_read_b64_tr_b16 a[206:207], v238 offset:9472
    v_mfma_f32_16x16x32_bf16 v[192:195], a[216:219], a[128:131], v[192:195]
    buffer_load_dwordx4 a[184:187], v249, s[8:11], s28 offen offset:3072 sc1
    v_mfma_f32_16x16x32_bf16 v[196:199], a[216:219], a[132:135], v[196:199]
    v_mfma_f32_16x16x32_bf16 v[200:203], a[216:219], a[136:139], v[200:203]
    buffer_load_dwordx4 a[188:191], v249, s[8:11], s29 offen offset:3072 sc1
    v_mfma_f32_16x16x32_bf16 v[204:207], a[216:219], a[140:143], v[204:207]
    s_add_u32 m0, s31, 1024
    s_add_u32 s24, s27, 32768
    v_mfma_f32_16x16x32_bf16 v[208:211], a[220:223], a[128:131], v[208:211]
    buffer_load_dwordx4 v245, s[12:15], s24 offen lds
    v_mfma_f32_16x16x32_bf16 v[212:215], a[220:223], a[132:135], v[212:215]
    v_mfma_f32_16x16x32_bf16 v[216:219], a[220:223], a[136:139], v[216:219]
    s_add_u32 s28, s28, 4096
    s_and_b32 s28, s28, 32767
    v_mfma_f32_16x16x32_bf16 v[220:223], a[220:223], a[140:143], v[220:223]
    s_add_u32 s29, s28, 32768
    s_waitcnt vmcnt(16) lgkmcnt(0)
    v_mfma_f32_16x16x32_bf16 v[96:99], a[192:195], a[144:147], v[96:99]
    ds_read_b64_tr_b16 a[208:209], v246 offset:8704
    v_mfma_f32_16x16x32_bf16 v[100:103], a[192:195], a[148:151], v[100:103]
    ds_read_b64_tr_b16 a[210:211], v246 offset:9728
    v_mfma_f32_16x16x32_bf16 v[104:107], a[192:195], a[152:155], v[104:107]
    ds_read_b64_tr_b16 a[212:213], v238 offset:8704
    v_mfma_f32_16x16x32_bf16 v[108:111], a[192:195], a[156:159], v[108:111]
    ds_read_b64_tr_b16 a[214:215], v238 offset:9728
    v_mfma_f32_16x16x32_bf16 v[112:115], a[196:199], a[144:147], v[112:115]
    ds_read_b64_tr_b16 a[216:217], v246 offset:8960
    v_mfma_f32_16x16x32_bf16 v[116:119], a[196:199], a[148:151], v[116:119]
    ds_read_b64_tr_b16 a[218:219], v246 offset:9984
    v_mfma_f32_16x16x32_bf16 v[120:123], a[196:199], a[152:155], v[120:123]
    ds_read_b64_tr_b16 a[220:221], v238 offset:8960
    v_mfma_f32_16x16x32_bf16 v[124:127], a[196:199], a[156:159], v[124:127]
    ds_read_b64_tr_b16 a[222:223], v238 offset:9984
    v_mfma_f32_16x16x32_bf16 v[128:131], a[200:203], a[144:147], v[128:131]
    buffer_load_dwordx4 a[128:131], v248, s[8:11], s28 offen offset:0 sc1
    v_mfma_f32_16x16x32_bf16 v[132:135], a[200:203], a[148:151], v[132:135]
    v_mfma_f32_16x16x32_bf16 v[136:139], a[200:203], a[152:155], v[136:139]
    buffer_load_dwordx4 a[132:135], v248, s[8:11], s29 offen offset:0 sc1
    v_mfma_f32_16x16x32_bf16 v[140:143], a[200:203], a[156:159], v[140:143]
    s_add_u32 m0, s31, 2048
    s_add_u32 s24, s27, 65536
    v_mfma_f32_16x16x32_bf16 v[144:147], a[204:207], a[144:147], v[144:147]
    buffer_load_dwordx4 v237, s[12:15], s24 offen lds
    v_mfma_f32_16x16x32_bf16 v[148:151], a[204:207], a[148:151], v[148:151]
    buffer_store_dwordx4 v[0:3], v240, s[48:51], s80 offen sc1
    s_add_u32 s80, s80, 1024
    v_mfma_f32_16x16x32_bf16 v[152:155], a[204:207], a[152:155], v[152:155]
    v_mfma_f32_16x16x32_bf16 v[156:159], a[204:207], a[156:159], v[156:159]
    s_waitcnt lgkmcnt(0)
    v_mfma_f32_16x16x32_bf16 v[160:163], a[208:211], a[144:147], v[160:163]
    ds_read_b64_tr_b16 a[192:193], v246 offset:16384
    v_mfma_f32_16x16x32_bf16 v[164:167], a[208:211], a[148:151], v[164:167]
    ds_read_b64_tr_b16 a[194:195], v246 offset:17408
    v_mfma_f32_16x16x32_bf16 v[168:171], a[208:211], a[152:155], v[168:171]
    ds_read_b64_tr_b16 a[196:197], v238 offset:16384
    v_mfma_f32_16x16x32_bf16 v[172:175], a[208:211], a[156:159], v[172:175]
    ds_read_b64_tr_b16 a[198:199], v238 offset:17408
    v_mfma_f32_16x16x32_bf16 v[176:179], a[212:215], a[144:147], v[176:179]
    ds_read_b64_tr_b16 a[200:201], v246 offset:16640
    v_mfma_f32_16x16x32_bf16 v[180:183], a[212:215], a[148:151], v[180:183]
    ds_read_b64_tr_b16 a[202:203], v246 offset:17664
    v_mfma_f32_16x16x32_bf16 v[184:187], a[212:215], a[152:155], v[184:187]
    ds_read_b64_tr_b16 a[204:205], v238 offset:16640
    v_mfma_f32_16x16x32_bf16 v[188:191], a[212:215], a[156:159], v[188:191]
    ds_read_b64_tr_b16 a[206:207], v238 offset:17664
    v_mfma_f32_16x16x32_bf16 v[192:195], a[216:219], a[144:147], v[192:195]
    buffer_load_dwordx4 a[136:139], v249, s[8:11], s28 offen offset:0 sc1
    v_mfma_f32_16x16x32_bf16 v[196:199], a[216:219], a[148:151], v[196:199]
    v_mfma_f32_16x16x32_bf16 v[200:203], a[216:219], a[152:155], v[200:203]
    buffer_load_dwordx4 a[140:143], v249, s[8:11], s29 offen offset:0 sc1
    v_mfma_f32_16x16x32_bf16 v[204:207], a[216:219], a[156:159], v[204:207]
    s_add_u32 m0, s31, 3072
    s_add_u32 s24, s27, 98304
    v_mfma_f32_16x16x32_bf16 v[208:211], a[220:223], a[144:147], v[208:211]
    buffer_load_dwordx4 v237, s[12:15], s24 offen lds
    v_mfma_f32_16x16x32_bf16 v[212:215], a[220:223], a[148:151], v[212:215]
    v_mfma_f32_16x16x32_bf16 v[216:219], a[220:223], a[152:155], v[216:219]
    v_mfma_f32_16x16x32_bf16 v[220:223], a[220:223], a[156:159], v[220:223]
    s_waitcnt vmcnt(15) lgkmcnt(0)
    v_mfma_f32_16x16x32_bf16 v[96:99], a[192:195], a[160:163], v[96:99]
    ds_read_b64_tr_b16 a[208:209], v246 offset:16896
    v_mfma_f32_16x16x32_bf16 v[100:103], a[192:195], a[164:167], v[100:103]
    ds_read_b64_tr_b16 a[210:211], v246 offset:17920
    v_mfma_f32_16x16x32_bf16 v[104:107], a[192:195], a[168:171], v[104:107]
    ds_read_b64_tr_b16 a[212:213], v238 offset:16896
    v_mfma_f32_16x16x32_bf16 v[108:111], a[192:195], a[172:175], v[108:111]
    ds_read_b64_tr_b16 a[214:215], v238 offset:17920
    v_mfma_f32_16x16x32_bf16 v[112:115], a[196:199], a[160:163], v[112:115]
    ds_read_b64_tr_b16 a[216:217], v246 offset:17152
    v_mfma_f32_16x16x32_bf16 v[116:119], a[196:199], a[164:167], v[116:119]
    ds_read_b64_tr_b16 a[218:219], v246 offset:18176
    v_mfma_f32_16x16x32_bf16 v[120:123], a[196:199], a[168:171], v[120:123]
    ds_read_b64_tr_b16 a[220:221], v238 offset:17152
    v_mfma_f32_16x16x32_bf16 v[124:127], a[196:199], a[172:175], v[124:127]
    ds_read_b64_tr_b16 a[222:223], v238 offset:18176
    v_mfma_f32_16x16x32_bf16 v[128:131], a[200:203], a[160:163], v[128:131]
    buffer_load_dwordx4 a[144:147], v248, s[8:11], s28 offen offset:1024 sc1
    v_mfma_f32_16x16x32_bf16 v[132:135], a[200:203], a[164:167], v[132:135]
    v_mfma_f32_16x16x32_bf16 v[136:139], a[200:203], a[168:171], v[136:139]
    buffer_load_dwordx4 a[148:151], v248, s[8:11], s29 offen offset:1024 sc1
    v_mfma_f32_16x16x32_bf16 v[140:143], a[200:203], a[172:175], v[140:143]
    s_add_u32 m0, s31, 4096
    s_add_u32 s24, s27, 131072
    v_mfma_f32_16x16x32_bf16 v[144:147], a[204:207], a[160:163], v[144:147]
    buffer_load_dwordx4 v245, s[12:15], s24 offen lds
    v_mfma_f32_16x16x32_bf16 v[148:151], a[204:207], a[164:167], v[148:151]
    v_mfma_f32_16x16x32_bf16 v[152:155], a[204:207], a[168:171], v[152:155]
    v_mfma_f32_16x16x32_bf16 v[156:159], a[204:207], a[172:175], v[156:159]
    s_waitcnt lgkmcnt(0)
    v_mfma_f32_16x16x32_bf16 v[160:163], a[208:211], a[160:163], v[160:163]
    ds_read_b64_tr_b16 a[192:193], v246 offset:24576
    v_mfma_f32_16x16x32_bf16 v[164:167], a[208:211], a[164:167], v[164:167]
    ds_read_b64_tr_b16 a[194:195], v246 offset:25600
    v_mfma_f32_16x16x32_bf16 v[168:171], a[208:211], a[168:171], v[168:171]
    ds_read_b64_tr_b16 a[196:197], v238 offset:24576
    v_mfma_f32_16x16x32_bf16 v[172:175], a[208:211], a[172:175], v[172:175]
    ds_read_b64_tr_b16 a[198:199], v238 offset:25600
    v_mfma_f32_16x16x32_bf16 v[176:179], a[212:215], a[160:163], v[176:179]
    ds_read_b64_tr_b16 a[200:201], v246 offset:24832
    v_mfma_f32_16x16x32_bf16 v[180:183], a[212:215], a[164:167], v[180:183]
    ds_read_b64_tr_b16 a[202:203], v246 offset:25856
    v_mfma_f32_16x16x32_bf16 v[184:187], a[212:215], a[168:171], v[184:187]
    ds_read_b64_tr_b16 a[204:205], v238 offset:24832
    v_mfma_f32_16x16x32_bf16 v[188:191], a[212:215], a[172:175], v[188:191]
    ds_read_b64_tr_b16 a[206:207], v238 offset:25856
    v_mfma_f32_16x16x32_bf16 v[192:195], a[216:219], a[160:163], v[192:195]
    buffer_load_dwordx4 a[152:155], v249, s[8:11], s28 offen offset:1024 sc1
    v_mfma_f32_16x16x32_bf16 v[196:199], a[216:219], a[164:167], v[196:199]
    v_mfma_f32_16x16x32_bf16 v[200:203], a[216:219], a[168:171], v[200:203]
    buffer_load_dwordx4 a[156:159], v249, s[8:11], s29 offen offset:1024 sc1
    v_mfma_f32_16x16x32_bf16 v[204:207], a[216:219], a[172:175], v[204:207]
    s_add_u32 m0, s31, 5120
    s_add_u32 s24, s27, 163840
    v_mfma_f32_16x16x32_bf16 v[208:211], a[220:223], a[160:163], v[208:211]
    buffer_load_dwordx4 v245, s[12:15], s24 offen lds
    v_mfma_f32_16x16x32_bf16 v[212:215], a[220:223], a[164:167], v[212:215]
    buffer_store_dwordx4 v[0:3], v240, s[48:51], s80 offen sc1
    s_add_u32 s80, s80, 1024
    v_mfma_f32_16x16x32_bf16 v[216:219], a[220:223], a[168:171], v[216:219]
    s_add_u32 s30, s30, 32768
    v_mfma_f32_16x16x32_bf16 v[220:223], a[220:223], a[172:175], v[220:223]
    s_cmp_ge_u32 s30, 163840
    s_cselect_b32 s30, 65536, s30
    s_waitcnt vmcnt(15) lgkmcnt(0)
    v_mfma_f32_16x16x32_bf16 v[96:99], a[192:195], a[176:179], v[96:99]
    ds_read_b64_tr_b16 a[208:209], v246 offset:25088
    v_mfma_f32_16x16x32_bf16 v[100:103], a[192:195], a[180:183], v[100:103]
    ds_read_b64_tr_b16 a[210:211], v246 offset:26112
    v_mfma_f32_16x16x32_bf16 v[104:107], a[192:195], a[184:187], v[104:107]
    ds_read_b64_tr_b16 a[212:213], v238 offset:25088
    v_mfma_f32_16x16x32_bf16 v[108:111], a[192:195], a[188:191], v[108:111]
    ds_read_b64_tr_b16 a[214:215], v238 offset:26112
    v_mfma_f32_16x16x32_bf16 v[112:115], a[196:199], a[176:179], v[112:115]
    ds_read_b64_tr_b16 a[216:217], v246 offset:25344
    v_mfma_f32_16x16x32_bf16 v[116:119], a[196:199], a[180:183], v[116:119]
    ds_read_b64_tr_b16 a[218:219], v246 offset:26368
    v_mfma_f32_16x16x32_bf16 v[120:123], a[196:199], a[184:187], v[120:123]
    ds_read_b64_tr_b16 a[220:221], v238 offset:25344
    v_mfma_f32_16x16x32_bf16 v[124:127], a[196:199], a[188:191], v[124:127]
    ds_read_b64_tr_b16 a[222:223], v238 offset:26368
    v_mfma_f32_16x16x32_bf16 v[128:131], a[200:203], a[176:179], v[128:131]
    buffer_load_dwordx4 a[160:163], v248, s[8:11], s28 offen offset:2048 sc1
    v_mfma_f32_16x16x32_bf16 v[132:135], a[200:203], a[180:183], v[132:135]
    v_mfma_f32_16x16x32_bf16 v[136:139], a[200:203], a[184:187], v[136:139]
    buffer_load_dwordx4 a[164:167], v248, s[8:11], s29 offen offset:2048 sc1
    v_mfma_f32_16x16x32_bf16 v[140:143], a[200:203], a[188:191], v[140:143]
    s_add_u32 m0, s31, 6144
    s_add_u32 s24, s27, 196608
    v_mfma_f32_16x16x32_bf16 v[144:147], a[204:207], a[176:179], v[144:147]
    buffer_load_dwordx4 v237, s[12:15], s24 offen lds
    v_mfma_f32_16x16x32_bf16 v[148:151], a[204:207], a[180:183], v[148:151]
    v_mfma_f32_16x16x32_bf16 v[152:155], a[204:207], a[184:187], v[152:155]
    s_cmp_eq_u32 s26, 1
    s_cbranch_scc0 ka_nopk
    s_waitcnt vmcnt(22)
    v_readfirstlane_b32 s24, v254
    s_lshl_b32 s25, s3, 16
    s_add_u32 s24, s24, s25
    s_cmp_ge_u32 s24, 8
    s_cbranch_scc0 kf_spin39
kf_spinr40:
ka_nopk:
    v_mfma_f32_16x16x32_bf16 v[156:159], a[204:207], a[188:191], v[156:159]
    s_waitcnt vmcnt(24) lgkmcnt(0)
    s_barrier
    v_add_u32 v246, s30, v247
    v_mfma_f32_16x16x32_bf16 v[160:163], a[208:211], a[176:179], v[160:163]
    v_xor_b32 v238, 16, v246
    ds_read_b64_tr_b16 a[192:193], v246 offset:0
    v_mfma_f32_16x16x32_bf16 v[164:167], a[208:211], a[180:183], v[164:167]
    ds_read_b64_tr_b16 a[194:195], v246 offset:1024
    v_mfma_f32_16x16x32_bf16 v[168:171], a[208:211], a[184:187], v[168:171]
    ds_read_b64_tr_b16 a[196:197], v238 offset:0
    v_mfma_f32_16x16x32_bf16 v[172:175], a[208:211], a[188:191], v[172:175]
    ds_read_b64_tr_b16 a[198:199], v238 offset:1024
    v_mfma_f32_16x16x32_bf16 v[176:179], a[212:215], a[176:179], v[176:179]
    ds_read_b64_tr_b16 a[200:201], v246 offset:256
    v_mfma_f32_16x16x32_bf16 v[180:183], a[212:215], a[180:183], v[180:183]
    ds_read_b64_tr_b16 a[202:203], v246 offset:1280
    v_mfma_f32_16x16x32_bf16 v[184:187], a[212:215], a[184:187], v[184:187]
    ds_read_b64_tr_b16 a[204:205], v238 offset:256
    buffer_atomic_add v255, v250, s[88:91], s97 offen sc1
    s_mov_b32 s97, s43
    v_mfma_f32_16x16x32_bf16 v[188:191], a[212:215], a[188:191], v[188:191]
    ds_read_b64_tr_b16 a[206:207], v238 offset:1280
    v_mfma_f32_16x16x32_bf16 v[192:195], a[216:219], a[176:179], v[192:195]
    buffer_load_dwordx4 a[168:171], v249, s[8:11], s28 offen offset:2048 sc1
    v_mfma_f32_16x16x32_bf16 v[196:199], a[216:219], a[180:183], v[196:199]
    v_mfma_f32_16x16x32_bf16 v[200:203], a[216:219], a[184:187], v[200:203]
    buffer_load_dwordx4 a[172:175], v249, s[8:11], s29 offen offset:2048 sc1
    v_mfma_f32_16x16x32_bf16 v[204:207], a[216:219], a[188:191], v[204:207]
    s_add_u32 m0, s31, 7168
    s_add_u32 s24, s27, 229376
    v_mfma_f32_16x16x32_bf16 v[208:211], a[220:223], a[176:179], v[208:211]
    buffer_load_dwordx4 v237, s[12:15], s24 offen lds
    v_mfma_f32_16x16x32_bf16 v[212:215], a[220:223], a[180:183], v[212:215]
    s_add_u32 s27, s27, 1048576
    s_and_b32 s27, s27, 0x407fffff
    v_mfma_f32_16x16x32_bf16 v[216:219], a[220:223], a[184:187], v[216:219]
    s_cmp_eq_u32 s27, s7
    s_cselect_b32 s27, s43, s27
    v_mfma_f32_16x16x32_bf16 v[220:223], a[220:223], a[188:191], v[220:223]
    s_add_u32 s31, s31, 32768
    s_cmp_ge_u32 s31, 163840
    s_cselect_b32 s24, 98304, 0
    s_sub_u32 s31, s31, s24
    s_sub_u32 s26, s26, 1
    s_cmp_lg_u32 s26, 0
    s_cbranch_scc1 ka_qp
    s_waitcnt vmcnt(15) lgkmcnt(0)
    v_mfma_f32_16x16x32_bf16 v[96:99], a[192:195], a[128:131], v[96:99]
    ds_read_b64_tr_b16 a[208:209], v246 offset:512
    s_sub_u32 s42, s32, 17664
    v_mfma_f32_16x16x32_bf16 v[100:103], a[192:195], a[132:135], v[100:103]
    ds_read_b64_tr_b16 a[210:211], v246 offset:1536
    v_mfma_f32_16x16x32_bf16 v[104:107], a[192:195], a[136:139], v[104:107]
    ds_read_b64_tr_b16 a[212:213], v238 offset:512
    s_mov_b32 m0, s34
    s_add_u32 s41, s42, 17664
    v_mfma_f32_16x16x32_bf16 v[108:111], a[192:195], a[140:143], v[108:111]
    ds_read_b64_tr_b16 a[214:215], v238 offset:1536
    v_mfma_f32_16x16x32_bf16 v[112:115], a[196:199], a[128:131], v[112:115]
    ds_read_b64_tr_b16 a[216:217], v246 offset:768
    v_mfma_f32_16x16x32_bf16 v[116:119], a[196:199], a[132:135], v[116:119]
    ds_read_b64_tr_b16 a[218:219], v246 offset:1792
    buffer_load_dwordx4 v242, s[16:19], s41 offen offset:0 sc1 lds
    v_mfma_f32_16x16x32_bf16 v[120:123], a[196:199], a[136:139], v[120:123]
    ds_read_b64_tr_b16 a[220:221], v238 offset:768
    v_mfma_f32_16x16x32_bf16 v[124:127], a[196:199], a[140:143], v[124:127]
    ds_read_b64_tr_b16 a[222:223], v238 offset:1792
    v_mfma_f32_16x16x32_bf16 v[128:131], a[200:203], a[128:131], v[128:131]
    buffer_load_dwordx4 a[176:179], v248, s[8:11], s28 offen offset:3072 sc1
    buffer_load_dwordx4 v242, s[16:19], s41 offen offset:1024 sc1 lds
    v_mfma_f32_16x16x32_bf16 v[132:135], a[200:203], a[132:135], v[132:135]
    v_mfma_f32_16x16x32_bf16 v[136:139], a[200:203], a[136:139], v[136:139]
    buffer_load_dwordx4 a[180:183], v248, s[8:11], s29 offen offset:3072 sc1
    v_mfma_f32_16x16x32_bf16 v[140:143], a[200:203], a[140:143], v[140:143]
    buffer_load_dwordx4 v242, s[16:19], s41 offen offset:2048 sc1 lds
    v_mfma_f32_16x16x32_bf16 v[144:147], a[204:207], a[128:131], v[144:147]
    v_mfma_f32_16x16x32_bf16 v[148:151], a[204:207], a[132:135], v[148:151]
    v_mfma_f32_16x16x32_bf16 v[152:155], a[204:207], a[136:139], v[152:155]
    buffer_load_dwordx4 v242, s[16:19], s41 offen offset:3072 sc1 lds
    v_mfma_f32_16x16x32_bf16 v[156:159], a[204:207], a[140:143], v[156:159]
    s_waitcnt lgkmcnt(0)
    v_mfma_f32_16x16x32_bf16 v[160:163], a[208:211], a[128:131], v[160:163]
    ds_read_b64_tr_b16 a[192:193], v246 offset:8192
    v_mfma_f32_16x16x32_bf16 v[164:167], a[208:211], a[132:135], v[164:167]
    ds_read_b64_tr_b16 a[194:195], v246 offset:9216
    v_mfma_f32_16x16x32_bf16 v[168:171], a[208:211], a[136:139], v[168:171]
    ds_read_b64_tr_b16 a[196:197], v238 offset:8192
    s_add_u32 s34, s34, 32768
    s_cmp_ge_u32 s34, 163840
    s_cselect_b32 s34, s37, s34
    s_add_u32 s42, s42, 34048
    v_mfma_f32_16x16x32_bf16 v[172:175], a[208:211], a[140:143], v[172:175]
    ds_read_b64_tr_b16 a[198:199], v238 offset:9216
    v_mfma_f32_16x16x32_bf16 v[176:179], a[212:215], a[128:131], v[176:179]
    ds_read_b64_tr_b16 a[200:201], v246 offset:8448
    v_mfma_f32_16x16x32_bf16 v[180:183], a[212:215], a[132:135], v[180:183]
    ds_read_b64_tr_b16 a[202:203], v246 offset:9472
    s_mov_b32 m0, s34
    s_add_u32 s41, s42, 17664
    v_mfma_f32_16x16x32_bf16 v[184:187], a[212:215], a[136:139], v[184:187]
    ds_read_b64_tr_b16 a[204:205], v238 offset:8448
    v_mfma_f32_16x16x32_bf16 v[188:191], a[212:215], a[140:143], v[188:191]
    ds_read_b64_tr_b16 a[206:207], v238 offset:9472
    v_mfma_f32_16x16x32_bf16 v[192:195], a[216:219], a[128:131], v[192:195]
    buffer_load_dwordx4 a[184:187], v249, s[8:11], s28 offen offset:3072 sc1
    buffer_load_dwordx4 v242, s[16:19], s41 offen offset:0 sc1 lds
    v_mfma_f32_16x16x32_bf16 v[196:199], a[216:219], a[132:135], v[196:199]
    v_mfma_f32_16x16x32_bf16 v[200:203], a[216:219], a[136:139], v[200:203]
    buffer_load_dwordx4 a[188:191], v249, s[8:11], s29 offen offset:3072 sc1
    v_mfma_f32_16x16x32_bf16 v[204:207], a[216:219], a[140:143], v[204:207]
    buffer_load_dwordx4 v242, s[16:19], s41 offen offset:1024 sc1 lds
    v_mfma_f32_16x16x32_bf16 v[208:211], a[220:223], a[128:131], v[208:211]
    v_mfma_f32_16x16x32_bf16 v[212:215], a[220:223], a[132:135], v[212:215]
    v_mfma_f32_16x16x32_bf16 v[216:219], a[220:223], a[136:139], v[216:219]
    s_add_u32 s28, s28, 4096
    s_and_b32 s28, s28, 32767
    v_mfma_f32_16x16x32_bf16 v[220:223], a[220:223], a[140:143], v[220:223]
    s_add_u32 s29, s28, 32768
    buffer_load_dwordx4 v242, s[16:19], s41 offen offset:2048 sc1 lds
    s_waitcnt vmcnt(20) lgkmcnt(0)
    v_mfma_f32_16x16x32_bf16 v[96:99], a[192:195], a[144:147], v[96:99]
    ds_read_b64_tr_b16 a[208:209], v246 offset:8704
    s_load_dwordx2 s[80:81], s[0:1], 0
    s_load_dwordx2 s[82:83], s[0:1], 56
    s_load_dwordx4 s[84:87], s[0:1], 80
    v_mfma_f32_16x16x32_bf16 v[100:103], a[192:195], a[148:151], v[100:103]
    ds_read_b64_tr_b16 a[210:211], v246 offset:9728
    v_mfma_f32_16x16x32_bf16 v[104:107], a[192:195], a[152:155], v[104:107]
    ds_read_b64_tr_b16 a[212:213], v238 offset:8704
    buffer_load_dwordx4 v242, s[16:19], s41 offen offset:3072 sc1 lds
    v_mfma_f32_16x16x32_bf16 v[108:111], a[192:195], a[156:159], v[108:111]
    ds_read_b64_tr_b16 a[214:215], v238 offset:9728
    v_mfma_f32_16x16x32_bf16 v[112:115], a[196:199], a[144:147], v[112:115]
    ds_read_b64_tr_b16 a[216:217], v246 offset:8960
    v_mfma_f32_16x16x32_bf16 v[116:119], a[196:199], a[148:151], v[116:119]
    ds_read_b64_tr_b16 a[218:219], v246 offset:9984
    s_add_u32 m0, s34, 16384
    s_add_u32 s34, s34, 32768
    s_cmp_ge_u32 s34, 163840
    s_cselect_b32 s34, s37, s34
    v_mfma_f32_16x16x32_bf16 v[120:123], a[196:199], a[152:155], v[120:123]
    ds_read_b64_tr_b16 a[220:221], v238 offset:8960
    v_mfma_f32_16x16x32_bf16 v[124:127], a[196:199], a[156:159], v[124:127]
    ds_read_b64_tr_b16 a[222:223], v238 offset:9984
    v_mfma_f32_16x16x32_bf16 v[128:131], a[200:203], a[144:147], v[128:131]
    buffer_load_dwordx4 v242, s[16:19], s42 offen offset:0 sc1 lds
    v_mov_b32 v241, v240
    v_mfma_f32_16x16x32_bf16 v[132:135], a[200:203], a[148:151], v[132:135]
    v_lshrrev_b32 v230, 7, v240
    v_mfma_f32_16x16x32_bf16 v[136:139], a[200:203], a[152:155], v[136:139]
    v_mul_u32_u24 v253, 7168, v230
    v_mfma_f32_16x16x32_bf16 v[140:143], a[200:203], a[156:159], v[140:143]
    v_and_b32 v231, 0x70, v240
    v_mfma_f32_16x16x32_bf16 v[144:147], a[204:207], a[144:147], v[144:147]
    buffer_load_dwordx4 v242, s[16:19], s42 offen offset:1024 sc1 lds
    v_mfma_f32_16x16x32_bf16 v[148:151], a[204:207], a[148:151], v[148:151]
    v_add_u32 v253, v253, v231
    v_mfma_f32_16x16x32_bf16 v[152:155], a[204:207], a[152:155], v[152:155]
    v_lshlrev_b32 v255, 5, v230
    v_mfma_f32_16x16x32_bf16 v[156:159], a[204:207], a[156:159], v[156:159]
    buffer_load_dwordx4 v242, s[16:19], s42 offen offset:2048 sc1 lds
    s_waitcnt lgkmcnt(0)
    v_mfma_f32_16x16x32_bf16 v[160:163], a[208:211], a[144:147], v[160:163]
    ds_read_b64_tr_b16 a[192:193], v246 offset:16384
    v_and_b32 v230, 16, v240
    v_mfma_f32_16x16x32_bf16 v[164:167], a[208:211], a[148:151], v[164:167]
    ds_read_b64_tr_b16 a[194:195], v246 offset:17408
    v_mfma_f32_16x16x32_bf16 v[168:171], a[208:211], a[152:155], v[168:171]
    ds_read_b64_tr_b16 a[196:197], v238 offset:16384
    buffer_load_dwordx4 v242, s[16:19], s42 offen offset:3072 sc1 lds
    s_add_u32 s42, s42, 34048
    v_mfma_f32_16x16x32_bf16 v[172:175], a[208:211], a[156:159], v[172:175]
    ds_read_b64_tr_b16 a[198:199], v238 offset:17408
    v_add_u32 v255, v255, v230
    v_mfma_f32_16x16x32_bf16 v[176:179], a[212:215], a[144:147], v[176:179]
    ds_read_b64_tr_b16 a[200:201], v246 offset:16640
    v_mfma_f32_16x16x32_bf16 v[180:183], a[212:215], a[148:151], v[180:183]
    ds_read_b64_tr_b16 a[202:203], v246 offset:17664
    s_mov_b32 m0, s34
    s_add_u32 s41, s42, 17664
    v_mfma_f32_16x16x32_bf16 v[184:187], a[212:215], a[152:155], v[184:187]
    ds_read_b64_tr_b16 a[204:205], v238 offset:16640
    v_lshrrev_b32 v231, 5, v231
    v_mfma_f32_16x16x32_bf16 v[188:191], a[212:215], a[156:159], v[188:191]
    ds_read_b64_tr_b16 a[206:207], v238 offset:17664
    v_mfma_f32_16x16x32_bf16 v[192:195], a[216:219], a[144:147], v[192:195]
    buffer_load_dwordx4 v242, s[16:19], s41 offen offset:0 sc1 lds
    v_lshl_add_u32 v255, v231, 16, v255
    v_mfma_f32_16x16x32_bf16 v[196:199], a[216:219], a[148:151], v[196:199]
    v_mov_b32 v64, 0
    v_mfma_f32_16x16x32_bf16 v[200:203], a[216:219], a[152:155], v[200:203]
    v_mov_b32 v65, 0
    v_mfma_f32_16x16x32_bf16 v[204:207], a[216:219], a[156:159], v[204:207]
    v_mov_b32 v66, 0
    v_mfma_f32_16x16x32_bf16 v[208:211], a[220:223], a[144:147], v[208:211]
    buffer_load_dwordx4 v242, s[16:19], s41 offen offset:1024 sc1 lds
    v_mfma_f32_16x16x32_bf16 v[212:215], a[220:223], a[148:151], v[212:215]
    v_mov_b32 v67, 0
    v_mfma_f32_16x16x32_bf16 v[216:219], a[220:223], a[152:155], v[216:219]
    v_mov_b32 v68, 0
    v_mfma_f32_16x16x32_bf16 v[220:223], a[220:223], a[156:159], v[220:223]
    buffer_load_dwordx4 v242, s[16:19], s41 offen offset:2048 sc1 lds
    s_waitcnt vmcnt(20) lgkmcnt(0)
    v_mfma_f32_16x16x32_bf16 v[96:99], a[192:195], a[160:163], v[96:99]
    ds_read_b64_tr_b16 a[208:209], v246 offset:16896
    v_mov_b32 v69, 0
    v_mfma_f32_16x16x32_bf16 v[100:103], a[192:195], a[164:167], v[100:103]
    ds_read_b64_tr_b16 a[210:211], v246 offset:17920
    v_mfma_f32_16x16x32_bf16 v[104:107], a[192:195], a[168:171], v[104:107]
    ds_read_b64_tr_b16 a[212:213], v238 offset:16896
    buffer_load_dwordx4 v242, s[16:19], s41 offen offset:3072 sc1 lds
    v_mfma_f32_16x16x32_bf16 v[108:111], a[192:195], a[172:175], v[108:111]
    ds_read_b64_tr_b16 a[214:215], v238 offset:17920
    v_mov_b32 v70, 0
    v_mfma_f32_16x16x32_bf16 v[112:115], a[196:199], a[160:163], v[112:115]
    ds_read_b64_tr_b16 a[216:217], v246 offset:17152
    v_mfma_f32_16x16x32_bf16 v[116:119], a[196:199], a[164:167], v[116:119]
    ds_read_b64_tr_b16 a[218:219], v246 offset:18176
    s_add_u32 m0, s34, 16384
    s_add_u32 s34, s34, 32768
    s_cmp_ge_u32 s34, 163840
    s_cselect_b32 s34, s37, s34
    v_mfma_f32_16x16x32_bf16 v[120:123], a[196:199], a[168:171], v[120:123]
    ds_read_b64_tr_b16 a[220:221], v238 offset:17152
    v_mov_b32 v71, 0
    v_mfma_f32_16x16x32_bf16 v[124:127], a[196:199], a[172:175], v[124:127]
    ds_read_b64_tr_b16 a[222:223], v238 offset:18176
    v_mfma_f32_16x16x32_bf16 v[128:131], a[200:203], a[160:163], v[128:131]
    v_mov_b32 v72, 0
    v_mfma_f32_16x16x32_bf16 v[132:135], a[200:203], a[164:167], v[132:135]
    buffer_load_dwordx4 v242, s[16:19], s42 offen offset:0 sc1 lds
    v_mov_b32 v73, 0
    v_mfma_f32_16x16x32_bf16 v[136:139], a[200:203], a[168:171], v[136:139]
    v_mov_b32 v74, 0
    v_mfma_f32_16x16x32_bf16 v[140:143], a[200:203], a[172:175], v[140:143]
    v_mov_b32 v75, 0
    v_mfma_f32_16x16x32_bf16 v[144:147], a[204:207], a[160:163], v[144:147]
    buffer_load_dwordx4 v242, s[16:19], s42 offen offset:1024 sc1 lds
    v_mfma_f32_16x16x32_bf16 v[148:151], a[204:207], a[164:167], v[148:151]
    v_mov_b32 v76, 0
    v_mfma_f32_16x16x32_bf16 v[152:155], a[204:207], a[168:171], v[152:155]
    v_mov_b32 v77, 0
    v_mfma_f32_16x16x32_bf16 v[156:159], a[204:207], a[172:175], v[156:159]
    buffer_load_dwordx4 v242, s[16:19], s42 offen offset:2048 sc1 lds
    s_waitcnt lgkmcnt(0)
    v_mfma_f32_16x16x32_bf16 v[160:163], a[208:211], a[160:163], v[160:163]
    ds_read_b64_tr_b16 a[192:193], v246 offset:24576
    v_mov_b32 v78, 0
    v_mfma_f32_16x16x32_bf16 v[164:167], a[208:211], a[164:167], v[164:167]
    ds_read_b64_tr_b16 a[194:195], v246 offset:25600
    v_mfma_f32_16x16x32_bf16 v[168:171], a[208:211], a[168:171], v[168:171]
    ds_read_b64_tr_b16 a[196:197], v238 offset:24576
    buffer_load_dwordx4 v242, s[16:19], s42 offen offset:3072 sc1 lds
    s_add_u32 s42, s42, 34048
    v_mfma_f32_16x16x32_bf16 v[172:175], a[208:211], a[172:175], v[172:175]
    ds_read_b64_tr_b16 a[198:199], v238 offset:25600
    v_mov_b32 v79, 0
    v_mfma_f32_16x16x32_bf16 v[176:179], a[212:215], a[160:163], v[176:179]
    ds_read_b64_tr_b16 a[200:201], v246 offset:24832
    v_mfma_f32_16x16x32_bf16 v[180:183], a[212:215], a[164:167], v[180:183]
    ds_read_b64_tr_b16 a[202:203], v246 offset:25856
    v_mov_b32 v80, 0
    v_mfma_f32_16x16x32_bf16 v[184:187], a[212:215], a[168:171], v[184:187]
    ds_read_b64_tr_b16 a[204:205], v238 offset:24832
    v_mfma_f32_16x16x32_bf16 v[188:191], a[212:215], a[172:175], v[188:191]
    ds_read_b64_tr_b16 a[206:207], v238 offset:25856
    v_mov_b32 v81, 0
    v_mfma_f32_16x16x32_bf16 v[192:195], a[216:219], a[160:163], v[192:195]
    v_mov_b32 v82, 0
    v_mfma_f32_16x16x32_bf16 v[196:199], a[216:219], a[164:167], v[196:199]
    v_mov_b32 v83, 0
    v_mfma_f32_16x16x32_bf16 v[200:203], a[216:219], a[168:171], v[200:203]
    v_mov_b32 v84, 0
    v_mfma_f32_16x16x32_bf16 v[204:207], a[216:219], a[172:175], v[204:207]
    v_mov_b32 v85, 0
    v_mfma_f32_16x16x32_bf16 v[208:211], a[220:223], a[160:163], v[208:211]
    v_mov_b32 v86, 0
    v_mfma_f32_16x16x32_bf16 v[212:215], a[220:223], a[164:167], v[212:215]
    v_mov_b32 v87, 0
    v_mfma_f32_16x16x32_bf16 v[216:219], a[220:223], a[168:171], v[216:219]
    v_mov_b32 v88, 0
    v_mfma_f32_16x16x32_bf16 v[220:223], a[220:223], a[172:175], v[220:223]
    s_waitcnt vmcnt(15) lgkmcnt(0)
    v_mfma_f32_16x16x32_bf16 v[96:99], a[192:195], a[176:179], v[96:99]
    ds_read_b64_tr_b16 a[208:209], v246 offset:25088
    v_mov_b32 v89, 0
    v_mfma_f32_16x16x32_bf16 v[100:103], a[192:195], a[180:183], v[100:103]
    ds_read_b64_tr_b16 a[210:211], v246 offset:26112
    v_mfma_f32_16x16x32_bf16 v[104:107], a[192:195], a[184:187], v[104:107]
    ds_read_b64_tr_b16 a[212:213], v238 offset:25088
    v_mov_b32 v90, 0
    v_mfma_f32_16x16x32_bf16 v[108:111], a[192:195], a[188:191], v[108:111]
    ds_read_b64_tr_b16 a[214:215], v238 offset:26112
    v_mfma_f32_16x16x32_bf16 v[112:115], a[196:199], a[176:179], v[112:115]
    ds_read_b64_tr_b16 a[216:217], v246 offset:25344
    v_mov_b32 v91, 0
    v_mfma_f32_16x16x32_bf16 v[116:119], a[196:199], a[180:183], v[116:119]
    ds_read_b64_tr_b16 a[218:219], v246 offset:26368
    v_mfma_f32_16x16x32_bf16 v[120:123], a[196:199], a[184:187], v[120:123]
    ds_read_b64_tr_b16 a[220:221], v238 offset:25344
    v_mov_b32 v92, 0
    v_mfma_f32_16x16x32_bf16 v[124:127], a[196:199], a[188:191], v[124:127]
    ds_read_b64_tr_b16 a[222:223], v238 offset:26368
    v_mfma_f32_16x16x32_bf16 v[128:131], a[200:203], a[176:179], v[128:131]
    v_mov_b32 v93, 0
    v_mfma_f32_16x16x32_bf16 v[132:135], a[200:203], a[180:183], v[132:135]
    v_mov_b32 v94, 0
    v_mfma_f32_16x16x32_bf16 v[136:139], a[200:203], a[184:187], v[136:139]
    v_mov_b32 v95, 0
    v_mfma_f32_16x16x32_bf16 v[140:143], a[200:203], a[188:191], v[140:143]
    v_mov_b32 v224, 0
    v_mfma_f32_16x16x32_bf16 v[144:147], a[204:207], a[176:179], v[144:147]
    v_mov_b32 v225, 0
    v_mfma_f32_16x16x32_bf16 v[148:151], a[204:207], a[180:183], v[148:151]
    v_mov_b32 v226, 0
    v_mfma_f32_16x16x32_bf16 v[152:155], a[204:207], a[184:187], v[152:155]
    v_mov_b32 v227, 0
    v_mfma_f32_16x16x32_bf16 v[156:159], a[204:207], a[188:191], v[156:159]
    s_waitcnt vmcnt(8) lgkmcnt(0)
    s_barrier
    v_mfma_f32_16x16x32_bf16 v[160:163], a[208:211], a[176:179], v[160:163]
    ds_read_b128 a[192:195], v241 offset:0
    s_mov_b32 m0, s34
    s_add_u32 s41, s42, 17664
    v_mfma_f32_16x16x32_bf16 v[164:167], a[208:211], a[180:183], v[164:167]
    ds_read_b128 a[196:199], v241 offset:1024
    buffer_load_dwordx4 v242, s[16:19], s41 offen offset:0 sc1 lds
    v_mfma_f32_16x16x32_bf16 v[168:171], a[208:211], a[184:187], v[168:171]
    ds_read_b128 a[200:203], v241 offset:2048
    v_mfma_f32_16x16x32_bf16 v[172:175], a[208:211], a[188:191], v[172:175]
    ds_read_b128 a[204:207], v241 offset:3072
    buffer_load_dwordx4 v242, s[16:19], s41 offen offset:1024 sc1 lds
    v_mfma_f32_16x16x32_bf16 v[176:179], a[212:215], a[176:179], v[176:179]
    ds_read_b128 a[224:227], v241 offset:8192
    buffer_load_dwordx4 v242, s[16:19], s41 offen offset:2048 sc1 lds
    v_mfma_f32_16x16x32_bf16 v[180:183], a[212:215], a[180:183], v[180:183]
    ds_read_b128 a[228:231], v241 offset:9216
    v_mfma_f32_16x16x32_bf16 v[184:187], a[212:215], a[184:187], v[184:187]
    ds_read_b128 a[232:235], v241 offset:10240
    buffer_load_dwordx4 v242, s[16:19], s41 offen offset:3072 sc1 lds
    v_mfma_f32_16x16x32_bf16 v[188:191], a[212:215], a[188:191], v[188:191]
    ds_read_b128 a[236:239], v241 offset:11264
    v_mfma_f32_16x16x32_bf16 v[192:195], a[216:219], a[176:179], v[192:195]
    ds_read_b128 a[240:243], v241 offset:12288
    s_add_u32 m0, s34, 16384
    s_add_u32 s34, s34, 32768
    s_cmp_ge_u32 s34, 163840
    s_cselect_b32 s34, s37, s34
    v_mfma_f32_16x16x32_bf16 v[196:199], a[216:219], a[180:183], v[196:199]
    ds_read_b128 a[244:247], v241 offset:13312
    buffer_load_dwordx4 v242, s[16:19], s42 offen offset:0 sc1 lds
    v_mfma_f32_16x16x32_bf16 v[200:203], a[216:219], a[184:187], v[200:203]
    ds_read_b128 a[248:251], v241 offset:14336
    v_mfma_f32_16x16x32_bf16 v[204:207], a[216:219], a[188:191], v[204:207]
    ds_read_b128 a[252:255], v241 offset:15360
    buffer_load_dwordx4 v242, s[16:19], s42 offen offset:1024 sc1 lds
    v_mfma_f32_16x16x32_bf16 v[208:211], a[220:223], a[176:179], v[208:211]
    buffer_load_dwordx4 v242, s[16:19], s42 offen offset:2048 sc1 lds
    v_mfma_f32_16x16x32_bf16 v[212:215], a[220:223], a[180:183], v[212:215]
    v_mfma_f32_16x16x32_bf16 v[216:219], a[220:223], a[184:187], v[216:219]
    buffer_load_dwordx4 v242, s[16:19], s42 offen offset:3072 sc1 lds
    s_add_u32 s42, s42, 34048
    v_mfma_f32_16x16x32_bf16 v[220:223], a[220:223], a[188:191], v[220:223]
    s_waitcnt lgkmcnt(8)
    ds_read_b128 a[208:211], v241 offset:4096
    ds_read_b128 a[212:215], v241 offset:5120
    ds_read_b128 a[216:219], v241 offset:6144
    ds_read_b128 a[220:223], v241 offset:7168
    s_sub_u32 s36, s36, 1
    s_cbranch_scc1 kf_fix1
kf_fixr2:
    v_cvt_pk_bf16_f32 v96, v96, v97
    v_cvt_pk_bf16_f32 v97, v98, v99
    v_cvt_pk_bf16_f32 v98, v112, v113
    v_cvt_pk_bf16_f32 v99, v114, v115
    v_accvgpr_write_b32 a128, v96
    v_accvgpr_write_b32 a129, v97
    v_accvgpr_write_b32 a130, v98
    v_accvgpr_write_b32 a131, v99
    v_cvt_pk_bf16_f32 v100, v100, v101
    v_cvt_pk_bf16_f32 v101, v102, v103
    v_cvt_pk_bf16_f32 v102, v116, v117
    v_cvt_pk_bf16_f32 v103, v118, v119
    v_accvgpr_write_b32 a144, v100
    v_accvgpr_write_b32 a145, v101
    v_accvgpr_write_b32 a146, v102
    v_accvgpr_write_b32 a147, v103
    v_cvt_pk_bf16_f32 v104, v104, v105
    v_cvt_pk_bf16_f32 v105, v106, v107
    v_cvt_pk_bf16_f32 v106, v120, v121
    v_cvt_pk_bf16_f32 v107, v122, v123
    v_accvgpr_write_b32 a160, v104
    v_accvgpr_write_b32 a161, v105
    v_accvgpr_write_b32 a162, v106
    v_accvgpr_write_b32 a163, v107
    v_cvt_pk_bf16_f32 v108, v108, v109
    v_cvt_pk_bf16_f32 v109, v110, v111
    v_cvt_pk_bf16_f32 v110, v124, v125
    v_cvt_pk_bf16_f32 v111, v126, v127
    v_accvgpr_write_b32 a176, v108
    v_accvgpr_write_b32 a177, v109
    v_accvgpr_write_b32 a178, v110
    v_accvgpr_write_b32 a179, v111
    s_nop 1
    v_mfma_f32_16x16x32_bf16 v[0:3], a[192:195], a[128:131], v[64:67]
    v_cvt_pk_bf16_f32 v128, v128, v129
    v_cvt_pk_bf16_f32 v129, v130, v131
    v_cvt_pk_bf16_f32 v130, v144, v145
    v_cvt_pk_bf16_f32 v131, v146, v147
    v_mfma_f32_16x16x32_bf16 v[8:11], a[192:195], a[144:147], v[72:75]
    v_accvgpr_write_b32 a132, v128
    v_accvgpr_write_b32 a133, v129
    v_accvgpr_write_b32 a134, v130
    v_accvgpr_write_b32 a135, v131
    v_mfma_f32_16x16x32_bf16 v[16:19], a[192:195], a[160:163], v[80:83]
    v_cvt_pk_bf16_f32 v132, v132, v133
    v_cvt_pk_bf16_f32 v133, v134, v135
    v_cvt_pk_bf16_f32 v134, v148, v149
    v_cvt_pk_bf16_f32 v135, v150, v151
    v_mfma_f32_16x16x32_bf16 v[24:27], a[192:195], a[176:179], v[88:91]
    v_accvgpr_write_b32 a148, v132
    v_accvgpr_write_b32 a149, v133
    v_accvgpr_write_b32 a150, v134
    v_accvgpr_write_b32 a151, v135
    v_mfma_f32_16x16x32_bf16 v[4:7], a[196:199], a[128:131], v[68:71]
    v_cvt_pk_bf16_f32 v136, v136, v137
    v_cvt_pk_bf16_f32 v137, v138, v139
    v_cvt_pk_bf16_f32 v138, v152, v153
    v_cvt_pk_bf16_f32 v139, v154, v155
    v_mfma_f32_16x16x32_bf16 v[12:15], a[196:199], a[144:147], v[76:79]
    v_accvgpr_write_b32 a164, v136
    v_accvgpr_write_b32 a165, v137
    v_accvgpr_write_b32 a166, v138
    v_accvgpr_write_b32 a167, v139
    v_mfma_f32_16x16x32_bf16 v[20:23], a[196:199], a[160:163], v[84:87]
    v_cvt_pk_bf16_f32 v140, v140, v141
    v_cvt_pk_bf16_f32 v141, v142, v143
    v_cvt_pk_bf16_f32 v142, v156, v157
    v_cvt_pk_bf16_f32 v143, v158, v159
    v_mfma_f32_16x16x32_bf16 v[28:31], a[196:199], a[176:179], v[92:95]
    v_accvgpr_write_b32 a180, v140
    v_accvgpr_write_b32 a181, v141
    v_accvgpr_write_b32 a182, v142
    v_accvgpr_write_b32 a183, v143
    s_nop 1
    v_mfma_f32_16x16x32_bf16 v[0:3], a[200:203], a[132:135], v[0:3]
    v_cvt_pk_bf16_f32 v160, v160, v161
    v_cvt_pk_bf16_f32 v161, v162, v163
    v_cvt_pk_bf16_f32 v162, v176, v177
    v_cvt_pk_bf16_f32 v163, v178, v179
    v_mfma_f32_16x16x32_bf16 v[8:11], a[200:203], a[148:151], v[8:11]
    v_accvgpr_write_b32 a136, v160
    v_accvgpr_write_b32 a137, v161
    v_accvgpr_write_b32 a138, v162
    v_accvgpr_write_b32 a139, v163
    v_mfma_f32_16x16x32_bf16 v[16:19], a[200:203], a[164:167], v[16:19]
    v_cvt_pk_bf16_f32 v164, v164, v165
    v_cvt_pk_bf16_f32 v165, v166, v167
    v_cvt_pk_bf16_f32 v166, v180, v181
    v_cvt_pk_bf16_f32 v167, v182, v183
    v_mfma_f32_16x16x32_bf16 v[24:27], a[200:203], a[180:183], v[24:27]
    v_accvgpr_write_b32 a152, v164
    v_accvgpr_write_b32 a153, v165
    v_accvgpr_write_b32 a154, v166
    v_accvgpr_write_b32 a155, v167
    v_mfma_f32_16x16x32_bf16 v[4:7], a[204:207], a[132:135], v[4:7]
    v_cvt_pk_bf16_f32 v168, v168, v169
    v_cvt_pk_bf16_f32 v169, v170, v171
    v_cvt_pk_bf16_f32 v170, v184, v185
    v_cvt_pk_bf16_f32 v171, v186, v187
    v_mfma_f32_16x16x32_bf16 v[12:15], a[204:207], a[148:151], v[12:15]
    v_accvgpr_write_b32 a168, v168
    v_accvgpr_write_b32 a169, v169
    v_accvgpr_write_b32 a170, v170
    v_accvgpr_write_b32 a171, v171
    v_mfma_f32_16x16x32_bf16 v[20:23], a[204:207], a[164:167], v[20:23]
    v_cvt_pk_bf16_f32 v172, v172, v173
    v_cvt_pk_bf16_f32 v173, v174, v175
    v_cvt_pk_bf16_f32 v174, v188, v189
    v_cvt_pk_bf16_f32 v175, v190, v191
    v_mfma_f32_16x16x32_bf16 v[28:31], a[204:207], a[180:183], v[28:31]
    v_accvgpr_write_b32 a184, v172
    v_accvgpr_write_b32 a185, v173
    v_accvgpr_write_b32 a186, v174
    v_accvgpr_write_b32 a187, v175
    s_nop 1
    s_waitcnt lgkmcnt(0)
    v_mfma_f32_16x16x32_bf16 v[0:3], a[208:211], a[136:139], v[0:3]
    v_cvt_pk_bf16_f32 v192, v192, v193
    v_cvt_pk_bf16_f32 v193, v194, v195
    v_cvt_pk_bf16_f32 v194, v208, v209
    v_cvt_pk_bf16_f32 v195, v210, v211
    v_mfma_f32_16x16x32_bf16 v[8:11], a[208:211], a[152:155], v[8:11]
    v_accvgpr_write_b32 a140, v192
    v_accvgpr_write_b32 a141, v193
    v_accvgpr_write_b32 a142, v194
    v_accvgpr_write_b32 a143, v195
    v_mfma_f32_16x16x32_bf16 v[16:19], a[208:211], a[168:171], v[16:19]
    v_cvt_pk_bf16_f32 v196, v196, v197
    v_cvt_pk_bf16_f32 v197, v198, v199
    v_cvt_pk_bf16_f32 v198, v212, v213
    v_cvt_pk_bf16_f32 v199, v214, v215
    v_mfma_f32_16x16x32_bf16 v[24:27], a[208:211], a[184:187], v[24:27]
    v_accvgpr_write_b32 a156, v196
    v_accvgpr_write_b32 a157, v197
    v_accvgpr_write_b32 a158, v198
    v_accvgpr_write_b32 a159, v199
    v_mfma_f32_16x16x32_bf16 v[4:7], a[212:215], a[136:139], v[4:7]
    v_cvt_pk_bf16_f32 v200, v200, v201
    v_cvt_pk_bf16_f32 v201, v202, v203
    v_cvt_pk_bf16_f32 v202, v216, v217
    v_cvt_pk_bf16_f32 v203, v218, v219
    v_mfma_f32_16x16x32_bf16 v[12:15], a[212:215], a[152:155], v[12:15]
    v_accvgpr_write_b32 a172, v200
    v_accvgpr_write_b32 a173, v201
    v_accvgpr_write_b32 a174, v202
    v_accvgpr_write_b32 a175, v203
    v_mfma_f32_16x16x32_bf16 v[20:23], a[212:215], a[168:171], v[20:23]
    v_cvt_pk_bf16_f32 v204, v204, v205
    v_cvt_pk_bf16_f32 v205, v206, v207
    v_cvt_pk_bf16_f32 v206, v220, v221
    v_cvt_pk_bf16_f32 v207, v222, v223
    v_mfma_f32_16x16x32_bf16 v[28:31], a[212:215], a[184:187], v[28:31]
    v_accvgpr_write_b32 a188, v204
    v_accvgpr_write_b32 a189, v205
    v_accvgpr_write_b32 a190, v206
    v_accvgpr_write_b32 a191, v207
    s_nop 1
    v_mfma_f32_16x16x32_bf16 v[0:3], a[216:219], a[140:143], v[0:3]
    v_mov_b32 v144, 0
    v_mov_b32 v145, 0
    v_mov_b32 v146, 0
    v_mfma_f32_16x16x32_bf16 v[8:11], a[216:219], a[156:159], v[8:11]
    v_mov_b32 v147, 0
    v_mov_b32 v148, 0
    v_mfma_f32_16x16x32_bf16 v[16:19], a[216:219], a[172:175], v[16:19]
    v_mov_b32 v149, 0
    v_mov_b32 v150, 0
    v_mov_b32 v151, 0
    v_mfma_f32_16x16x32_bf16 v[24:27], a[216:219], a[188:191], v[24:27]
    v_mov_b32 v152, 0
    v_mov_b32 v153, 0
    v_mfma_f32_16x16x32_bf16 v[4:7], a[220:223], a[140:143], v[4:7]
    v_mov_b32 v154, 0
    v_mov_b32 v155, 0
    v_mov_b32 v156, 0
    v_mfma_f32_16x16x32_bf16 v[12:15], a[220:223], a[156:159], v[12:15]
    v_mov_b32 v157, 0
    v_mov_b32 v158, 0
    v_mfma_f32_16x16x32_bf16 v[20:23], a[220:223], a[172:175], v[20:23]
    v_mov_b32 v159, 0
    v_mov_b32 v204, 0x3f803f80
    v_mov_b32 v205, 0x3f803f80
    v_mfma_f32_16x16x32_bf16 v[28:31], a[220:223], a[188:191], v[28:31]
    v_mov_b32 v206, 0x3f803f80
    v_mov_b32 v207, 0x3f803f80
    s_nop 4
    v_max3_f32 v128, v0, v1, v2
    v_max3_f32 v130, v8, v9, v10
    v_max3_f32 v132, v16, v17, v18
    v_max3_f32 v134, v24, v25, v26
    v_max3_f32 v128, v128, v3, v4
    v_max3_f32 v130, v130, v11, v12
    v_max3_f32 v132, v132, v19, v20
    v_max3_f32 v134, v134, v27, v28
    v_max3_f32 v128, v128, v5, v6
    v_max3_f32 v130, v130, v13, v14
    v_max3_f32 v132, v132, v21, v22
    v_max3_f32 v134, v134, v29, v30
    v_max_f32 v128, v128, v7
    v_max_f32 v130, v130, v15
    v_max_f32 v132, v132, v23
    v_max_f32 v134, v134, v31
    v_mov_b32 v129, v128
    v_mov_b32 v131, v130
    v_mov_b32 v133, v132
    v_mov_b32 v135, v134
    v_permlane16_swap_b32 v128, v129
    v_permlane16_swap_b32 v130, v131
    v_permlane16_swap_b32 v132, v133
    v_permlane16_swap_b32 v134, v135
    v_max_f32 v128, v128, v129
    v_max_f32 v130, v130, v131
    v_max_f32 v132, v132, v133
    v_max_f32 v134, v134, v135
    v_mov_b32 v129, v128
    v_mov_b32 v131, v130
    v_mov_b32 v133, v132
    v_mov_b32 v135, v134
    v_permlane32_swap_b32 v128, v129
    v_permlane32_swap_b32 v130, v131
    v_permlane32_swap_b32 v132, v133
    v_permlane32_swap_b32 v134, v135
    v_max_f32 v128, v128, v129
    v_max_f32 v130, v130, v131
    v_max_f32 v132, v132, v133
    v_max_f32 v134, v134, v135
    v_add_f32 v128, 0x41800000, v128
    v_add_f32 v130, 0x41800000, v130
    v_add_f32 v132, 0x41800000, v132
    v_add_f32 v134, 0x41800000, v134
    v_sub_f32 v224, 0, v128
    v_sub_f32 v64, v64, v128
    v_sub_f32 v65, v65, v128
    v_sub_f32 v66, v66, v128
    v_sub_f32 v67, v67, v128
    v_sub_f32 v68, v68, v128
    v_sub_f32 v69, v69, v128
    v_sub_f32 v70, v70, v128
    v_sub_f32 v71, v71, v128
    v_sub_f32 v225, 0, v130
    v_sub_f32 v72, v72, v130
    v_sub_f32 v73, v73, v130
    v_sub_f32 v74, v74, v130
    v_sub_f32 v75, v75, v130
    v_sub_f32 v76, v76, v130
    v_sub_f32 v77, v77, v130
    v_sub_f32 v78, v78, v130
    v_sub_f32 v79, v79, v130
    v_sub_f32 v226, 0, v132
    v_sub_f32 v80, v80, v132
    v_sub_f32 v81, v81, v132
    v_sub_f32 v82, v82, v132
    v_sub_f32 v83, v83, v132
    v_sub_f32 v84, v84, v132
    v_sub_f32 v85, v85, v132
    v_sub_f32 v86, v86, v132
    v_sub_f32 v87, v87, v132
    v_sub_f32 v227, 0, v134
    v_sub_f32 v88, v88, v134
    v_sub_f32 v89, v89, v134
    v_sub_f32 v90, v90, v134
    v_sub_f32 v91, v91, v134
    v_sub_f32 v92, v92, v134
    v_sub_f32 v93, v93, v134
    v_sub_f32 v94, v94, v134
    v_sub_f32 v95, v95, v134
    v_sub_f32 v0, v0, v128
    v_sub_f32 v1, v1, v128
    v_sub_f32 v2, v2, v128
    v_sub_f32 v3, v3, v128
    v_sub_f32 v4, v4, v128
    v_sub_f32 v5, v5, v128
    v_sub_f32 v6, v6, v128
    v_sub_f32 v7, v7, v128
    v_sub_f32 v8, v8, v130
    v_sub_f32 v9, v9, v130
    v_sub_f32 v10, v10, v130
    v_sub_f32 v11, v11, v130
    v_sub_f32 v12, v12, v130
    v_sub_f32 v13, v13, v130
    v_sub_f32 v14, v14, v130
    v_sub_f32 v15, v15, v130
    v_sub_f32 v16, v16, v132
    v_sub_f32 v17, v17, v132
    v_sub_f32 v18, v18, v132
    v_sub_f32 v19, v19, v132
    v_sub_f32 v20, v20, v132
    v_sub_f32 v21, v21, v132
    v_sub_f32 v22, v22, v132
    v_sub_f32 v23, v23, v132
    v_sub_f32 v24, v24, v134
    v_sub_f32 v25, v25, v134
    v_sub_f32 v26, v26, v134
    v_sub_f32 v27, v27, v134
    v_sub_f32 v28, v28, v134
    v_sub_f32 v29, v29, v134
    v_sub_f32 v30, v30, v134
    v_sub_f32 v31, v31, v134
    s_mov_b32 s35, 32768
    v_add_u32 v241, s35, v240
    s_sub_u32 s36, s36, 1
    s_cbranch_scc1 kf_fix3
kf_fixr4:
    v_mfma_f32_16x16x32_bf16 v[32:35], a[224:227], a[128:131], v[64:67]
    ds_read_b128 a[192:195], v241 offset:0
    v_exp_f32 v128, v0
    v_mfma_f32_16x16x32_bf16 v[40:43], a[224:227], a[144:147], v[72:75]
    v_exp_f32 v129, v1
    v_mfma_f32_16x16x32_bf16 v[48:51], a[224:227], a[160:163], v[80:83]
    v_exp_f32 v130, v2
    v_cvt_pk_bf16_f32 v96, v128, v129
    v_mfma_f32_16x16x32_bf16 v[56:59], a[224:227], a[176:179], v[88:91]
    v_exp_f32 v131, v3
    v_mfma_f32_16x16x32_bf16 v[36:39], a[228:231], a[128:131], v[68:71]
    ds_read_b128 a[196:199], v241 offset:1024
    v_exp_f32 v132, v4
    v_mfma_f32_16x16x32_bf16 v[44:47], a[228:231], a[144:147], v[76:79]
    v_exp_f32 v133, v5
    v_cvt_pk_bf16_f32 v97, v130, v131
    v_mfma_f32_16x16x32_bf16 v[52:55], a[228:231], a[160:163], v[84:87]
    v_exp_f32 v134, v6
    v_cvt_pk_bf16_f32 v98, v132, v133
    v_mfma_f32_16x16x32_bf16 v[60:63], a[228:231], a[176:179], v[92:95]
    v_exp_f32 v135, v7
    v_mfma_f32_16x16x32_bf16 v[32:35], a[232:235], a[132:135], v[32:35]
    ds_read_b128 a[200:203], v241 offset:2048
    v_exp_f32 v136, v8
    v_mfma_f32_16x16x32_bf16 v[40:43], a[232:235], a[148:151], v[40:43]
    v_exp_f32 v137, v9
    v_cvt_pk_bf16_f32 v99, v134, v135
    v_mfma_f32_16x16x32_bf16 v[48:51], a[232:235], a[164:167], v[48:51]
    v_exp_f32 v138, v10
    v_exp_f32 v139, v11
    v_mfma_f32_16x16x32_bf16 v[56:59], a[232:235], a[180:183], v[56:59]
    v_exp_f32 v140, v12
    v_cvt_pk_bf16_f32 v100, v136, v137
    v_mfma_f32_16x16x32_bf16 v[36:39], a[236:239], a[132:135], v[36:39]
    ds_read_b128 a[204:207], v241 offset:3072
    v_exp_f32 v141, v13
    v_mfma_f32_16x16x32_bf16 v[44:47], a[236:239], a[148:151], v[44:47]
    v_exp_f32 v142, v14
    v_cvt_pk_bf16_f32 v101, v138, v139
    v_mfma_f32_16x16x32_bf16 v[52:55], a[236:239], a[164:167], v[52:55]
    v_exp_f32 v143, v15
    v_cvt_pk_bf16_f32 v102, v140, v141
    v_mfma_f32_16x16x32_bf16 v[60:63], a[236:239], a[180:183], v[60:63]
    v_exp_f32 v128, v16
    v_cvt_pk_bf16_f32 v103, v142, v143
    v_mfma_f32_16x16x32_bf16 v[32:35], a[240:243], a[136:139], v[32:35]
    ds_read_b128 a[208:211], v241 offset:4096
    v_exp_f32 v129, v17
    v_mfma_f32_16x16x32_bf16 v[40:43], a[240:243], a[152:155], v[40:43]
    v_exp_f32 v130, v18
    v_cvt_pk_bf16_f32 v104, v128, v129
    v_mfma_f32_16x16x32_bf16 v[48:51], a[240:243], a[168:171], v[48:51]
    v_exp_f32 v131, v19
    v_mfma_f32_16x16x32_bf16 v[56:59], a[240:243], a[184:187], v[56:59]
    v_exp_f32 v132, v20
    v_cvt_pk_bf16_f32 v105, v130, v131
    v_mfma_f32_16x16x32_bf16 v[36:39], a[244:247], a[136:139], v[36:39]
    ds_read_b128 a[212:215], v241 offset:5120
    v_exp_f32 v133, v21
    v_mfma_f32_16x16x32_bf16 v[44:47], a[244:247], a[152:155], v[44:47]
    v_exp_f32 v134, v22
    v_exp_f32 v135, v23
    v_mfma_f32_16x16x32_bf16 v[52:55], a[244:247], a[168:171], v[52:55]
    v_exp_f32 v136, v24
    v_cvt_pk_bf16_f32 v106, v132, v133
    v_mfma_f32_16x16x32_bf16 v[60:63], a[244:247], a[184:187], v[60:63]
    v_exp_f32 v137, v25
    v_cvt_pk_bf16_f32 v107, v134, v135
    v_mfma_f32_16x16x32_bf16 v[32:35], a[248:251], a[140:143], v[32:35]
    ds_read_b128 a[216:219], v241 offset:6144
    v_exp_f32 v138, v26
    v_mfma_f32_16x16x32_bf16 v[40:43], a[248:251], a[156:159], v[40:43]
    v_exp_f32 v139, v27
    v_cvt_pk_bf16_f32 v108, v136, v137
    v_mfma_f32_16x16x32_bf16 v[48:51], a[248:251], a[172:175], v[48:51]
    v_exp_f32 v140, v28
    v_cvt_pk_bf16_f32 v109, v138, v139
    v_mfma_f32_16x16x32_bf16 v[56:59], a[248:251], a[188:191], v[56:59]
    v_exp_f32 v141, v29
    v_mfma_f32_16x16x32_bf16 v[36:39], a[252:255], a[140:143], v[36:39]
    ds_read_b128 a[220:223], v241 offset:7168
    v_exp_f32 v142, v30
    v_mfma_f32_16x16x32_bf16 v[44:47], a[252:255], a[156:159], v[44:47]
    v_exp_f32 v143, v31
    v_cvt_pk_bf16_f32 v110, v140, v141
    v_mfma_f32_16x16x32_bf16 v[52:55], a[252:255], a[172:175], v[52:55]
    v_cvt_pk_bf16_f32 v111, v142, v143
    v_mfma_f32_16x16x32_bf16 v[60:63], a[252:255], a[188:191], v[60:63]
    v_add_f32 v200, 0, v243
    v_min_f32 v200, 0, v200
    v_add_f32 v201, 0xf1800000, v243
    v_min_f32 v201, 0, v201
    v_add_f32 v202, 0xf2000000, v243
    v_min_f32 v202, 0, v202
    v_add_f32 v203, 0xf2400000, v243
    v_min_f32 v203, 0, v203
    v_add_f32 v209, 0xf3000000, v243
    v_min_f32 v209, 0, v209
    v_add_f32 v210, 0xf3100000, v243
    v_min_f32 v210, 0, v210
    v_add_f32 v211, 0xf3200000, v243
    v_min_f32 v211, 0, v211
    v_add_f32 v212, 0xf3300000, v243
    v_min_f32 v212, 0, v212
    v_add_f32 v213, 0x73800000, v243
    v_min_f32 v213, 0, v213
    v_add_f32 v214, 0x73700000, v243
    v_min_f32 v214, 0, v214
    v_add_f32 v215, 0x73600000, v243
    v_min_f32 v215, 0, v215
    v_add_f32 v216, 0x73500000, v243
    v_min_f32 v216, 0, v216
    v_add_f32 v217, 0x73000000, v243
    v_min_f32 v217, 0, v217
    v_add_f32 v218, 0x72e00000, v243
    v_min_f32 v218, 0, v218
    v_add_f32 v219, 0x72c00000, v243
    v_min_f32 v219, 0, v219
    v_add_f32 v220, 0x72a00000, v243
    v_min_f32 v220, 0, v220
    ds_read_b128 a[224:227], v241 offset:16384
    ds_read_b128 a[228:231], v241 offset:17408
    ds_read_b128 a[232:235], v241 offset:18432
    ds_read_b128 a[236:239], v241 offset:19456
    s_mul_i32 s27, s5, 68096
    s_sub_u32 s27, s32, s27
    s_add_u32 s18, s27, 1089536
    s_mov_b32 s31, s101
    v_mul_u32_u24 v245, 448, v240
    v_and_b32 v230, 0x40000000, v251
    v_or_b32 v245, v245, v230
    s_lshl1_add_u32 s26, s5, s31
    s_branch ka_p1_e
.p2align 5
ka_p1:
    s_sub_u32 s36, s36, 1
    s_cbranch_scc1 kf_fix7
kf_fixr8:
    s_waitcnt lgkmcnt(8)
    v_mfma_f32_16x16x32_bf16 v[0:3], a[192:195], a[128:131], v[64:67]
    ds_read_b128 a[240:243], v241 offset:20480
    s_waitcnt vmcnt(11)
    v_mfma_f32_16x16x32_bf16 v[8:11], a[192:195], a[144:147], v[72:75]
    v_exp_f32 v128, v32
    v_mfma_f32_16x16x32_bf16 v[16:19], a[192:195], a[160:163], v[80:83]
    v_exp_f32 v129, v33
    v_mfma_f32_16x16x32_bf16 v[24:27], a[192:195], a[176:179], v[88:91]
    v_exp_f32 v130, v34
    v_mfma_f32_16x16x32_bf16 v[4:7], a[196:199], a[128:131], v[68:71]
    ds_read_b128 a[244:247], v241 offset:21504
    buffer_store_dwordx4 v[192:195], v255, s[48:51], s45 offen offset:0 sc1
    v_mfma_f32_16x16x32_bf16 v[12:15], a[196:199], a[144:147], v[76:79]
    s_cmp_lt_u32 s44, s47
    s_cselect_b32 s101, s44, s43
    v_mfma_f32_16x16x32_bf16 v[20:23], a[196:199], a[160:163], v[84:87]
    buffer_load_dwordx4 v[192:195], v253, s[52:55], s101 offen
    v_cvt_pk_bf16_f32 v112, v128, v129
    v_mfma_f32_16x16x32_bf16 v[28:31], a[196:199], a[176:179], v[92:95]
    v_exp_f32 v131, v35
    v_mfma_f32_16x16x32_bf16 v[0:3], a[200:203], a[132:135], v[0:3]
    ds_read_b128 a[248:251], v241 offset:22528
    v_cvt_pk_bf16_f32 v113, v130, v131
    v_mfma_f32_16x16x32_bf16 v[8:11], a[200:203], a[148:151], v[8:11]
    v_exp_f32 v132, v36
    v_mfma_f32_16x16x32_bf16 v[16:19], a[200:203], a[164:167], v[16:19]
    v_exp_f32 v133, v37
    v_mfma_f32_16x16x32_bf16 v[24:27], a[200:203], a[180:183], v[24:27]
    v_exp_f32 v134, v38
    v_mfma_f32_16x16x32_bf16 v[4:7], a[204:207], a[132:135], v[4:7]
    ds_read_b128 a[252:255], v241 offset:23552
    s_mov_b32 m0, s34
    v_mfma_f32_16x16x32_bf16 v[12:15], a[204:207], a[148:151], v[12:15]
    s_add_u32 s41, s42, 17664
    v_cvt_pk_bf16_f32 v114, v132, v133
    v_mfma_f32_16x16x32_bf16 v[20:23], a[204:207], a[164:167], v[20:23]
    v_exp_f32 v135, v39
    v_mfma_f32_16x16x32_bf16 v[28:31], a[204:207], a[180:183], v[28:31]
    v_or3_b32 v208, v112, v113, v114
    s_waitcnt lgkmcnt(8)
    v_mfma_f32_16x16x32_bf16 v[0:3], a[208:211], a[136:139], v[0:3]
    ds_read_b128 a[192:195], v241 offset:8192
    v_cvt_pk_bf16_f32 v115, v134, v135
    v_mfma_f32_16x16x32_bf16 v[8:11], a[208:211], a[152:155], v[8:11]
    v_exp_f32 v136, v40
    v_mfma_f32_16x16x32_bf16 v[16:19], a[208:211], a[168:171], v[16:19]
    v_exp_f32 v137, v41
    v_mfma_f32_16x16x32_bf16 v[24:27], a[208:211], a[184:187], v[24:27]
    v_exp_f32 v138, v42
    v_mfma_f32_16x16x32_bf16 v[4:7], a[212:215], a[136:139], v[4:7]
    ds_read_b128 a[196:199], v241 offset:9216
    buffer_load_dwordx4 v242, s[16:19], s41 offen offset:0 sc1 lds
    v_mfma_f32_16x16x32_bf16 v[12:15], a[212:215], a[152:155], v[12:15]
    v_exp_f32 v139, v43
    v_mfma_f32_16x16x32_bf16 v[20:23], a[212:215], a[168:171], v[20:23]
    v_exp_f32 v140, v44
    v_mfma_f32_16x16x32_bf16 v[28:31], a[212:215], a[184:187], v[28:31]
    v_exp_f32 v141, v45
    v_mfma_f32_16x16x32_bf16 v[0:3], a[216:219], a[140:143], v[0:3]
    ds_read_b128 a[200:203], v241 offset:10240
    v_cvt_pk_bf16_f32 v116, v136, v137
    v_mfma_f32_16x16x32_bf16 v[8:11], a[216:219], a[156:159], v[8:11]
    v_exp_f32 v142, v46
    v_mfma_f32_16x16x32_bf16 v[16:19], a[216:219], a[172:175], v[16:19]
    v_exp_f32 v143, v47
    v_mfma_f32_16x16x32_bf16 v[24:27], a[216:219], a[188:191], v[24:27]
    v_or3_b32 v208, v208, v115, v116
    v_cvt_pk_bf16_f32 v117, v138, v139
    v_mfma_f32_16x16x32_bf16 v[4:7], a[220:223], a[140:143], v[4:7]
    ds_read_b128 a[204:207], v241 offset:11264
    buffer_load_dwordx4 v242, s[16:19], s41 offen offset:1024 sc1 lds
    v_mfma_f32_16x16x32_bf16 v[12:15], a[220:223], a[156:159], v[12:15]
    v_exp_f32 v128, v48
    v_mfma_f32_16x16x32_bf16 v[20:23], a[220:223], a[172:175], v[20:23]
    v_exp_f32 v129, v49
    v_mfma_f32_16x16x32_bf16 v[28:31], a[220:223], a[188:191], v[28:31]
    v_cvt_pk_bf16_f32 v118, v140, v141
    s_waitcnt lgkmcnt(8)
    v_mfma_f32_16x16x32_bf16 a[0:3], a[224:227], v[96:99], a[0:3]
    ds_read_b128 a[208:211], v241 offset:12288
    v_or3_b32 v208, v208, v117, v118
    v_mfma_f32_16x16x32_bf16 a[32:35], a[224:227], v[100:103], a[32:35]
    v_exp_f32 v130, v50
    v_mfma_f32_16x16x32_bf16 a[64:67], a[224:227], v[104:107], a[64:67]
    v_exp_f32 v131, v51
    v_mfma_f32_16x16x32_bf16 a[96:99], a[224:227], v[108:111], a[96:99]
    v_exp_f32 v132, v52
    v_mfma_f32_16x16x32_bf16 a[4:7], a[228:231], v[96:99], a[4:7]
    ds_read_b128 a[212:215], v241 offset:13312
    v_cvt_pk_bf16_f32 v119, v142, v143
    v_mfma_f32_16x16x32_bf16 a[36:39], a[228:231], v[100:103], a[36:39]
    buffer_load_dwordx4 v242, s[16:19], s41 offen offset:2048 sc1 lds
    v_cvt_pk_bf16_f32 v120, v128, v129
    v_mfma_f32_16x16x32_bf16 a[68:71], a[228:231], v[104:107], a[68:71]
    v_exp_f32 v133, v53
    v_mfma_f32_16x16x32_bf16 a[100:103], a[228:231], v[108:111], a[100:103]
    v_exp_f32 v134, v54
    v_mfma_f32_16x16x32_bf16 a[8:11], a[232:235], v[96:99], a[8:11]
    ds_read_b128 a[216:219], v241 offset:14336
    v_or3_b32 v208, v208, v119, v120
    v_mfma_f32_16x16x32_bf16 a[40:43], a[232:235], v[100:103], a[40:43]
    v_exp_f32 v135, v55
    v_mfma_f32_16x16x32_bf16 a[72:75], a[232:235], v[104:107], a[72:75]
    v_exp_f32 v136, v56
    v_mfma_f32_16x16x32_bf16 a[104:107], a[232:235], v[108:111], a[104:107]
    v_exp_f32 v137, v57
    v_mfma_f32_16x16x32_bf16 a[12:15], a[236:239], v[96:99], a[12:15]
    ds_read_b128 a[220:223], v241 offset:15360
    v_cvt_pk_bf16_f32 v121, v130, v131
    v_mfma_f32_16x16x32_bf16 a[44:47], a[236:239], v[100:103], a[44:47]
    v_cvt_pk_bf16_f32 v122, v132, v133
    v_or3_b32 v208, v208, v121, v122
    v_mfma_f32_16x16x32_bf16 a[76:79], a[236:239], v[104:107], a[76:79]
    buffer_load_dwordx4 v242, s[16:19], s41 offen offset:3072 sc1 lds
    v_cvt_pk_bf16_f32 v123, v134, v135
    v_mfma_f32_16x16x32_bf16 a[108:111], a[236:239], v[108:111], a[108:111]
    v_cvt_pk_bf16_f32 v124, v136, v137
    s_waitcnt lgkmcnt(8)
    v_mfma_f32_16x16x32_bf16 a[16:19], a[240:243], v[96:99], a[16:19]
    ds_read_b128 a[224:227], v241 offset:24576
    v_or3_b32 v208, v208, v123, v124
    v_mfma_f32_16x16x32_bf16 a[48:51], a[240:243], v[100:103], a[48:51]
    v_exp_f32 v138, v58
    v_mfma_f32_16x16x32_bf16 a[80:83], a[240:243], v[104:107], a[80:83]
    v_exp_f32 v139, v59
    v_mfma_f32_16x16x32_bf16 a[112:115], a[240:243], v[108:111], a[112:115]
    v_exp_f32 v140, v60
    v_mfma_f32_16x16x32_bf16 a[20:23], a[244:247], v[96:99], a[20:23]
    ds_read_b128 a[228:231], v241 offset:25600
    v_cvt_pk_bf16_f32 v125, v138, v139
    v_mfma_f32_16x16x32_bf16 a[52:55], a[244:247], v[100:103], a[52:55]
    v_exp_f32 v141, v61
    v_mfma_f32_16x16x32_bf16 a[84:87], a[244:247], v[104:107], a[84:87]
    v_exp_f32 v142, v62
    v_mfma_f32_16x16x32_bf16 a[116:119], a[244:247], v[108:111], a[116:119]
    s_add_u32 s35, s35, 32768
    v_cvt_pk_bf16_f32 v126, v140, v141
    v_mfma_f32_16x16x32_bf16 a[24:27], a[248:251], v[96:99], a[24:27]
    ds_read_b128 a[232:235], v241 offset:26624
    v_or3_b32 v208, v208, v125, v126
    v_mfma_f32_16x16x32_bf16 a[56:59], a[248:251], v[100:103], a[56:59]
    s_cmp_ge_u32 s35, 163840
    s_cselect_b32 s35, 0, s35
    v_mfma_f32_16x16x32_bf16 a[88:91], a[248:251], v[104:107], a[88:91]
    v_exp_f32 v143, v63
    v_mfma_f32_16x16x32_bf16 a[120:123], a[248:251], v[108:111], a[120:123]
    v_cvt_pk_bf16_f32 v127, v142, v143
    v_or_b32 v208, v208, v127
    v_mfma_f32_16x16x32_bf16 a[28:31], a[252:255], v[96:99], a[28:31]
    ds_read_b128 a[236:239], v241 offset:27648
    v_and_b32 v208, s38, v208
    v_mfma_f32_16x16x32_bf16 a[60:63], a[252:255], v[100:103], a[60:63]
    v_cmp_ne_u32 vcc, 0, v208
    v_mfma_f32_16x16x32_bf16 a[92:95], a[252:255], v[104:107], a[92:95]
    v_mfma_f32_16x16x32_bf16 a[124:127], a[252:255], v[108:111], a[124:127]
    v_mfma_f32_16x16x32_bf16 v[144:147], v[204:207], v[96:99], v[144:147]
    v_mfma_f32_16x16x32_bf16 v[148:151], v[204:207], v[100:103], v[148:151]
    v_mfma_f32_16x16x32_bf16 v[152:155], v[204:207], v[104:107], v[152:155]
    v_mfma_f32_16x16x32_bf16 v[156:159], v[204:207], v[108:111], v[156:159]
    s_cbranch_vccnz kf_rare6
kf_rr5:
    s_sub_u32 s36, s36, 1
    s_cbranch_scc1 kf_fix11
kf_fixr12:
    s_waitcnt lgkmcnt(8)
    v_mfma_f32_16x16x32_bf16 v[32:35], a[192:195], a[128:131], v[64:67]
    ds_read_b128 a[240:243], v241 offset:28672
    s_waitcnt vmcnt(11)
    v_mfma_f32_16x16x32_bf16 v[40:43], a[192:195], a[144:147], v[72:75]
    v_exp_f32 v128, v0
    v_mfma_f32_16x16x32_bf16 v[48:51], a[192:195], a[160:163], v[80:83]
    v_exp_f32 v129, v1
    v_mfma_f32_16x16x32_bf16 v[56:59], a[192:195], a[176:179], v[88:91]
    v_exp_f32 v130, v2
    v_mfma_f32_16x16x32_bf16 v[36:39], a[196:199], a[128:131], v[68:71]
    ds_read_b128 a[244:247], v241 offset:29696
    buffer_store_dwordx4 v[196:199], v255, s[48:51], s45 offen offset:256 sc1
    v_mfma_f32_16x16x32_bf16 v[44:47], a[196:199], a[144:147], v[76:79]
    s_add_u32 s101, s101, 57344
    buffer_load_dwordx4 v[196:199], v253, s[52:55], s101 offen
    v_mfma_f32_16x16x32_bf16 v[52:55], a[196:199], a[160:163], v[84:87]
    v_exp_f32 v131, v3
    v_mfma_f32_16x16x32_bf16 v[60:63], a[196:199], a[176:179], v[92:95]
    v_exp_f32 v132, v4
    v_mfma_f32_16x16x32_bf16 v[32:35], a[200:203], a[132:135], v[32:35]
    ds_read_b128 a[248:251], v241 offset:30720
    v_cvt_pk_bf16_f32 v96, v128, v129
    v_mfma_f32_16x16x32_bf16 v[40:43], a[200:203], a[148:151], v[40:43]
    s_cmp_lt_u32 s44, s47
    s_cselect_b32 s45, s46, s43
    v_mfma_f32_16x16x32_bf16 v[48:51], a[200:203], a[164:167], v[48:51]
    v_exp_f32 v133, v5
    v_mfma_f32_16x16x32_bf16 v[56:59], a[200:203], a[180:183], v[56:59]
    v_exp_f32 v134, v6
    v_mfma_f32_16x16x32_bf16 v[36:39], a[204:207], a[132:135], v[36:39]
    ds_read_b128 a[252:255], v241 offset:31744
    s_add_u32 s44, s44, 128
    v_mfma_f32_16x16x32_bf16 v[44:47], a[204:207], a[148:151], v[44:47]
    s_add_u32 s46, s46, 262144
    v_cvt_pk_bf16_f32 v97, v130, v131
    v_mfma_f32_16x16x32_bf16 v[52:55], a[204:207], a[164:167], v[52:55]
    v_exp_f32 v135, v7
    v_mfma_f32_16x16x32_bf16 v[60:63], a[204:207], a[180:183], v[60:63]
    v_cvt_pk_bf16_f32 v98, v132, v133
    s_waitcnt lgkmcnt(8)
    v_mfma_f32_16x16x32_bf16 v[32:35], a[208:211], a[136:139], v[32:35]
    s_waitcnt vmcnt(16)
    s_barrier
    v_add_u32 v241, s35, v240
    ds_read_b128 a[192:195], v241 offset:0
    v_mfma_f32_16x16x32_bf16 v[40:43], a[208:211], a[152:155], v[40:43]
    v_exp_f32 v136, v8
    v_mfma_f32_16x16x32_bf16 v[48:51], a[208:211], a[168:171], v[48:51]
    v_exp_f32 v137, v9
    v_mfma_f32_16x16x32_bf16 v[56:59], a[208:211], a[184:187], v[56:59]
    v_exp_f32 v138, v10
    v_mfma_f32_16x16x32_bf16 v[36:39], a[212:215], a[136:139], v[36:39]
    ds_read_b128 a[196:199], v241 offset:1024
    s_add_u32 m0, s34, 16384
    v_mfma_f32_16x16x32_bf16 v[44:47], a[212:215], a[152:155], v[44:47]
    s_add_u32 s34, s34, 32768
    v_or3_b32 v208, v96, v97, v98
    v_mfma_f32_16x16x32_bf16 v[52:55], a[212:215], a[168:171], v[52:55]
    s_cmp_ge_u32 s34, 163840
    s_cselect_b32 s34, s37, s34
    v_mfma_f32_16x16x32_bf16 v[60:63], a[212:215], a[184:187], v[60:63]
    v_exp_f32 v139, v11
    v_mfma_f32_16x16x32_bf16 v[32:35], a[216:219], a[140:143], v[32:35]
    ds_read_b128 a[200:203], v241 offset:2048
    v_cvt_pk_bf16_f32 v99, v134, v135
    v_mfma_f32_16x16x32_bf16 v[40:43], a[216:219], a[156:159], v[40:43]
    v_exp_f32 v140, v12
    v_mfma_f32_16x16x32_bf16 v[48:51], a[216:219], a[172:175], v[48:51]
    v_exp_f32 v141, v13
    v_mfma_f32_16x16x32_bf16 v[56:59], a[216:219], a[188:191], v[56:59]
    v_cvt_pk_bf16_f32 v100, v136, v137
    buffer_load_dwordx4 v242, s[16:19], s42 offen offset:0 sc1 lds
    v_mfma_f32_16x16x32_bf16 v[36:39], a[220:223], a[140:143], v[36:39]
    ds_read_b128 a[204:207], v241 offset:3072
    v_or3_b32 v208, v208, v99, v100
    v_mfma_f32_16x16x32_bf16 v[44:47], a[220:223], a[156:159], v[44:47]
    v_exp_f32 v142, v14
    v_mfma_f32_16x16x32_bf16 v[52:55], a[220:223], a[172:175], v[52:55]
    v_exp_f32 v143, v15
    v_mfma_f32_16x16x32_bf16 v[60:63], a[220:223], a[188:191], v[60:63]
    v_cvt_pk_bf16_f32 v101, v138, v139
    s_waitcnt lgkmcnt(8)
    v_mfma_f32_16x16x32_bf16 a[0:3], a[224:227], v[112:115], a[0:3]
    ds_read_b128 a[208:211], v241 offset:4096
    v_cvt_pk_bf16_f32 v102, v140, v141
    v_mfma_f32_16x16x32_bf16 a[32:35], a[224:227], v[116:119], a[32:35]
    v_exp_f32 v128, v16
    v_mfma_f32_16x16x32_bf16 a[64:67], a[224:227], v[120:123], a[64:67]
    v_exp_f32 v129, v17
    v_mfma_f32_16x16x32_bf16 a[96:99], a[224:227], v[124:127], a[96:99]
    v_exp_f32 v130, v18
    v_mfma_f32_16x16x32_bf16 a[4:7], a[228:231], v[112:115], a[4:7]
    ds_read_b128 a[212:215], v241 offset:5120
    buffer_load_dwordx4 v242, s[16:19], s42 offen offset:1024 sc1 lds
    v_mfma_f32_16x16x32_bf16 a[36:39], a[228:231], v[116:119], a[36:39]
    v_exp_f32 v131, v19
    v_mfma_f32_16x16x32_bf16 a[68:71], a[228:231], v[120:123], a[68:71]
    v_or3_b32 v208, v208, v101, v102
    v_cvt_pk_bf16_f32 v103, v142, v143
    v_mfma_f32_16x16x32_bf16 a[100:103], a[228:231], v[124:127], a[100:103]
    v_exp_f32 v132, v20
    v_mfma_f32_16x16x32_bf16 a[8:11], a[232:235], v[112:115], a[8:11]
    ds_read_b128 a[216:219], v241 offset:6144
    v_cvt_pk_bf16_f32 v104, v128, v129
    v_mfma_f32_16x16x32_bf16 a[40:43], a[232:235], v[116:119], a[40:43]
    v_exp_f32 v133, v21
    v_mfma_f32_16x16x32_bf16 a[72:75], a[232:235], v[120:123], a[72:75]
    v_exp_f32 v134, v22
    v_mfma_f32_16x16x32_bf16 a[104:107], a[232:235], v[124:127], a[104:107]
    v_exp_f32 v135, v23
    v_mfma_f32_16x16x32_bf16 a[12:15], a[236:239], v[112:115], a[12:15]
    ds_read_b128 a[220:223], v241 offset:7168
    buffer_load_dwordx4 v242, s[16:19], s42 offen offset:2048 sc1 lds
    v_mfma_f32_16x16x32_bf16 a[44:47], a[236:239], v[116:119], a[44:47]
    v_or3_b32 v208, v208, v103, v104
    v_cvt_pk_bf16_f32 v105, v130, v131
    v_mfma_f32_16x16x32_bf16 a[76:79], a[236:239], v[120:123], a[76:79]
    v_exp_f32 v136, v24
    v_mfma_f32_16x16x32_bf16 a[108:111], a[236:239], v[124:127], a[108:111]
    v_cvt_pk_bf16_f32 v106, v132, v133
    s_waitcnt lgkmcnt(8)
    v_mfma_f32_16x16x32_bf16 a[16:19], a[240:243], v[112:115], a[16:19]
    ds_read_b128 a[224:227], v241 offset:16384
    v_or3_b32 v208, v208, v105, v106
    v_mfma_f32_16x16x32_bf16 a[48:51], a[240:243], v[116:119], a[48:51]
    v_exp_f32 v137, v25
    v_mfma_f32_16x16x32_bf16 a[80:83], a[240:243], v[120:123], a[80:83]
    v_exp_f32 v138, v26
    v_mfma_f32_16x16x32_bf16 a[112:115], a[240:243], v[124:127], a[112:115]
    v_exp_f32 v139, v27
    v_mfma_f32_16x16x32_bf16 a[20:23], a[244:247], v[112:115], a[20:23]
    ds_read_b128 a[228:231], v241 offset:17408
    buffer_load_dwordx4 v242, s[16:19], s42 offen offset:3072 sc1 lds
    v_mfma_f32_16x16x32_bf16 a[52:55], a[244:247], v[116:119], a[52:55]
    s_add_u32 s42, s42, 34048
    v_cvt_pk_bf16_f32 v107, v134, v135
    v_mfma_f32_16x16x32_bf16 a[84:87], a[244:247], v[120:123], a[84:87]
    v_exp_f32 v140, v28
    v_mfma_f32_16x16x32_bf16 a[116:119], a[244:247], v[124:127], a[116:119]
    v_exp_f32 v141, v29
    v_mfma_f32_16x16x32_bf16 a[24:27], a[248:251], v[112:115], a[24:27]
    ds_read_b128 a[232:235], v241 offset:18432
    v_cvt_pk_bf16_f32 v108, v136, v137
    v_mfma_f32_16x16x32_bf16 a[56:59], a[248:251], v[116:119], a[56:59]
    v_exp_f32 v142, v30
    v_mfma_f32_16x16x32_bf16 a[88:91], a[248:251], v[120:123], a[88:91]
    v_exp_f32 v143, v31
    v_mfma_f32_16x16x32_bf16 a[120:123], a[248:251], v[124:127], a[120:123]
    buffer_load_dword v252, v251, s[60:63], s100 offen
    s_add_u32 s100, s100, 2048
    v_mfma_f32_16x16x32_bf16 a[28:31], a[252:255], v[112:115], a[28:31]
    ds_read_b128 a[236:239], v241 offset:19456
    v_or3_b32 v208, v208, v107, v108
    v_mfma_f32_16x16x32_bf16 a[60:63], a[252:255], v[116:119], a[60:63]
    v_cvt_pk_bf16_f32 v109, v138, v139
    v_cvt_pk_bf16_f32 v110, v140, v141
    v_mfma_f32_16x16x32_bf16 a[92:95], a[252:255], v[120:123], a[92:95]
    v_or3_b32 v208, v208, v109, v110
    v_cvt_pk_bf16_f32 v111, v142, v143
    v_mfma_f32_16x16x32_bf16 a[124:127], a[252:255], v[124:127], a[124:127]
    v_or_b32 v208, v208, v111
    v_and_b32 v208, s38, v208
    v_mfma_f32_16x16x32_bf16 v[144:147], v[204:207], v[112:115], v[144:147]
    v_cmp_ne_u32 vcc, 0, v208
    v_mfma_f32_16x16x32_bf16 v[148:151], v[204:207], v[116:119], v[148:151]
    v_mfma_f32_16x16x32_bf16 v[152:155], v[204:207], v[120:123], v[152:155]
    v_mfma_f32_16x16x32_bf16 v[156:159], v[204:207], v[124:127], v[156:159]
    s_cbranch_vccnz kf_rare10
kf_rr9:
ka_p1_e:
    s_sub_u32 s26, s26, 1
    s_cbranch_scc0 ka_p1
    s_branch ka_p1_x
kf_fix7:
    s_mov_b32 s24, 0
    s_branch kf_fix7c
kf_fix11:
    s_mov_b32 s24, 1
kf_fix7c:
    s_cmp_eq_u32 s33, 0
    s_cbranch_scc0 kf_fix7f
    s_mov_b32 s36, 0
    s_mov_b32 s33, 1
    v_add_f32 v64, v224, v200
    v_add_f32 v65, v224, v201
    v_add_f32 v66, v224, v202
    v_add_f32 v67, v224, v203
    v_add_f32 v68, v224, v209
    v_add_f32 v69, v224, v210
    v_add_f32 v70, v224, v211
    v_add_f32 v71, v224, v212
    v_add_f32 v72, v225, v213
    v_add_f32 v73, v225, v214
    v_add_f32 v74, v225, v215
    v_add_f32 v75, v225, v216
    v_add_f32 v76, v225, v217
    v_add_f32 v77, v225, v218
    v_add_f32 v78, v225, v219
    v_add_f32 v79, v225, v220
    s_cmp_eq_u32 s24, 0
    s_cbranch_scc1 kf_fixr8
    s_branch kf_fixr12
kf_fix7f:
    s_mov_b32 s36, 0x1000
    v_mov_b32 v64, 0xf1800000
    v_mov_b32 v65, v64
    v_mov_b32 v66, v64
    v_mov_b32 v67, v64
    v_mov_b32 v68, v64
    v_mov_b32 v69, v64
    v_mov_b32 v70, v64
    v_mov_b32 v71, v64
    v_mov_b32 v72, v64
    v_mov_b32 v73, v64
    v_mov_b32 v74, v64
    v_mov_b32 v75, v64
    v_mov_b32 v76, v64
    v_mov_b32 v77, v64
    v_mov_b32 v78, v64
    v_mov_b32 v79, v64
    s_cmp_eq_u32 s24, 0
    s_cbranch_scc1 kf_fixr8
    s_branch kf_fixr12
kf_fix15:
    s_mov_b32 s24, 0
    s_branch kf_fix15c
kf_fix19:
    s_mov_b32 s24, 1
kf_fix15c:
    s_cmp_eq_u32 s33, 0
    s_cbranch_scc0 kf_fix15f
    s_mov_b32 s36, 0
    s_mov_b32 s33, 1
    v_add_f32 v80, v226, v200
    v_add_f32 v81, v226, v201
    v_add_f32 v82, v226, v202
    v_add_f32 v83, v226, v203
    v_add_f32 v84, v226, v209
    v_add_f32 v85, v226, v210
    v_add_f32 v86, v226, v211
    v_add_f32 v87, v226, v212
    v_add_f32 v88, v227, v213
    v_add_f32 v89, v227, v214
    v_add_f32 v90, v227, v215
    v_add_f32 v91, v227, v216
    v_add_f32 v92, v227, v217
    v_add_f32 v93, v227, v218
    v_add_f32 v94, v227, v219
    v_add_f32 v95, v227, v220
    s_cmp_eq_u32 s24, 0
    s_cbranch_scc1 kf_fixr16
    s_branch kf_fixr20
kf_fix15f:
    s_mov_b32 s36, 0x1000
    v_mov_b32 v80, 0xf1800000
    v_mov_b32 v81, v80
    v_mov_b32 v82, v80
    v_mov_b32 v83, v80
    v_mov_b32 v84, v80
    v_mov_b32 v85, v80
    v_mov_b32 v86, v80
    v_mov_b32 v87, v80
    v_mov_b32 v88, v80
    v_mov_b32 v89, v80
    v_mov_b32 v90, v80
    v_mov_b32 v91, v80
    v_mov_b32 v92, v80
    v_mov_b32 v93, v80
    v_mov_b32 v94, v80
    v_mov_b32 v95, v80
    s_cmp_eq_u32 s24, 0
    s_cbranch_scc1 kf_fixr16
    s_branch kf_fixr20
ka_p1_x:
    s_lshl2_add_u32 s36, s5, s6
    s_lshl1_add_u32 s36, s31, s36
    s_sub_u32 s36, 61, s36
    s_mov_b32 s33, 0
    s_sub_u32 s36, s36, 1
    s_cbranch_scc1 kf_fix15
kf_fixr16:
    s_waitcnt lgkmcnt(8)
    v_mfma_f32_16x16x32_bf16 v[16:19], a[192:195], a[160:163], v[80:83]
    ds_read_b128 a[240:243], v241 offset:20480
    ds_read_b128 a[244:247], v241 offset:21504
    v_mfma_f32_16x16x32_bf16 v[24:27], a[192:195], a[176:179], v[88:91]
    s_waitcnt vmcnt(11)
    v_exp_f32 v128, v32
    v_mfma_f32_16x16x32_bf16 v[20:23], a[196:199], a[160:163], v[84:87]
    v_exp_f32 v129, v33
    v_mfma_f32_16x16x32_bf16 v[28:31], a[196:199], a[176:179], v[92:95]
    buffer_store_dwordx4 v[192:195], v255, s[48:51], s45 offen offset:0 sc1
    v_exp_f32 v130, v34
    v_mfma_f32_16x16x32_bf16 v[16:19], a[200:203], a[164:167], v[16:19]
    ds_read_b128 a[248:251], v241 offset:22528
    ds_read_b128 a[252:255], v241 offset:23552
    v_mfma_f32_16x16x32_bf16 v[24:27], a[200:203], a[180:183], v[24:27]
    v_exp_f32 v131, v35
    v_mfma_f32_16x16x32_bf16 v[20:23], a[204:207], a[164:167], v[20:23]
    v_exp_f32 v132, v36
    v_cvt_pk_bf16_f32 v112, v128, v129
    v_mfma_f32_16x16x32_bf16 v[28:31], a[204:207], a[180:183], v[28:31]
    s_mov_b32 m0, s34
    s_waitcnt lgkmcnt(8)
    v_mfma_f32_16x16x32_bf16 v[16:19], a[208:211], a[168:171], v[16:19]
    ds_read_b128 a[192:195], v241 offset:8192
    ds_read_b128 a[196:199], v241 offset:9216
    v_mfma_f32_16x16x32_bf16 v[24:27], a[208:211], a[184:187], v[24:27]
    s_add_u32 s41, s42, 17664
    v_exp_f32 v133, v37
    v_mfma_f32_16x16x32_bf16 v[20:23], a[212:215], a[168:171], v[20:23]
    v_exp_f32 v134, v38
    v_mfma_f32_16x16x32_bf16 v[28:31], a[212:215], a[184:187], v[28:31]
    v_exp_f32 v135, v39
    v_mfma_f32_16x16x32_bf16 v[16:19], a[216:219], a[172:175], v[16:19]
    ds_read_b128 a[200:203], v241 offset:10240
    ds_read_b128 a[204:207], v241 offset:11264
    v_cvt_pk_bf16_f32 v113, v130, v131
    v_mfma_f32_16x16x32_bf16 v[24:27], a[216:219], a[188:191], v[24:27]
    v_exp_f32 v136, v40
    v_mfma_f32_16x16x32_bf16 v[20:23], a[220:223], a[172:175], v[20:23]
    v_exp_f32 v137, v41
    v_mfma_f32_16x16x32_bf16 v[28:31], a[220:223], a[188:191], v[28:31]
    v_cvt_pk_bf16_f32 v114, v132, v133
    buffer_load_dwordx4 v242, s[16:19], s41 offen offset:0 sc1 lds
    s_waitcnt lgkmcnt(8)
    v_mfma_f32_16x16x32_bf16 a[0:3], a[224:227], v[96:99], a[0:3]
    ds_read_b128 a[208:211], v241 offset:12288
    v_or3_b32 v208, v112, v113, v114
    v_mfma_f32_16x16x32_bf16 a[32:35], a[224:227], v[100:103], a[32:35]
    v_exp_f32 v138, v42
    v_mfma_f32_16x16x32_bf16 a[64:67], a[224:227], v[104:107], a[64:67]
    v_exp_f32 v139, v43
    v_cvt_pk_bf16_f32 v115, v134, v135
    v_mfma_f32_16x16x32_bf16 a[96:99], a[224:227], v[108:111], a[96:99]
    v_exp_f32 v140, v44
    v_mfma_f32_16x16x32_bf16 a[4:7], a[228:231], v[96:99], a[4:7]
    ds_read_b128 a[212:215], v241 offset:13312
    v_cvt_pk_bf16_f32 v116, v136, v137
    v_mfma_f32_16x16x32_bf16 a[36:39], a[228:231], v[100:103], a[36:39]
    buffer_load_dwordx4 v242, s[16:19], s41 offen offset:1024 sc1 lds
    v_exp_f32 v141, v45
    v_mfma_f32_16x16x32_bf16 a[68:71], a[228:231], v[104:107], a[68:71]
    v_exp_f32 v142, v46
    v_mfma_f32_16x16x32_bf16 a[100:103], a[228:231], v[108:111], a[100:103]
    v_exp_f32 v143, v47
    v_mfma_f32_16x16x32_bf16 a[8:11], a[232:235], v[96:99], a[8:11]
    ds_read_b128 a[216:219], v241 offset:14336
    v_or3_b32 v208, v208, v115, v116
    v_cvt_pk_bf16_f32 v117, v138, v139
    v_mfma_f32_16x16x32_bf16 a[40:43], a[232:235], v[100:103], a[40:43]
    v_exp_f32 v128, v48
    v_mfma_f32_16x16x32_bf16 a[72:75], a[232:235], v[104:107], a[72:75]
    v_exp_f32 v129, v49
    v_mfma_f32_16x16x32_bf16 a[104:107], a[232:235], v[108:111], a[104:107]
    v_cvt_pk_bf16_f32 v118, v140, v141
    v_exp_f32 v130, v50
    v_mfma_f32_16x16x32_bf16 a[12:15], a[236:239], v[96:99], a[12:15]
    ds_read_b128 a[220:223], v241 offset:15360
    buffer_load_dwordx4 v242, s[16:19], s41 offen offset:2048 sc1 lds
    v_mfma_f32_16x16x32_bf16 a[44:47], a[236:239], v[100:103], a[44:47]
    v_exp_f32 v131, v51
    v_or3_b32 v208, v208, v117, v118
    v_mfma_f32_16x16x32_bf16 a[76:79], a[236:239], v[104:107], a[76:79]
    v_exp_f32 v132, v52
    v_mfma_f32_16x16x32_bf16 a[108:111], a[236:239], v[108:111], a[108:111]
    v_cvt_pk_bf16_f32 v119, v142, v143
    s_waitcnt lgkmcnt(8)
    v_mfma_f32_16x16x32_bf16 a[16:19], a[240:243], v[96:99], a[16:19]
    ds_read_b128 a[224:227], v241 offset:24576
    v_exp_f32 v133, v53
    v_mfma_f32_16x16x32_bf16 a[48:51], a[240:243], v[100:103], a[48:51]
    v_cvt_pk_bf16_f32 v120, v128, v129
    v_or3_b32 v208, v208, v119, v120
    v_mfma_f32_16x16x32_bf16 a[80:83], a[240:243], v[104:107], a[80:83]
    v_exp_f32 v134, v54
    v_mfma_f32_16x16x32_bf16 a[112:115], a[240:243], v[108:111], a[112:115]
    buffer_load_dwordx4 v242, s[16:19], s41 offen offset:3072 sc1 lds
    v_exp_f32 v135, v55
    v_mfma_f32_16x16x32_bf16 a[20:23], a[244:247], v[96:99], a[20:23]
    ds_read_b128 a[228:231], v241 offset:25600
    v_cvt_pk_bf16_f32 v121, v130, v131
    v_mfma_f32_16x16x32_bf16 a[52:55], a[244:247], v[100:103], a[52:55]
    v_exp_f32 v136, v56
    v_mfma_f32_16x16x32_bf16 a[84:87], a[244:247], v[104:107], a[84:87]
    v_exp_f32 v137, v57
    v_cvt_pk_bf16_f32 v122, v132, v133
    v_mfma_f32_16x16x32_bf16 a[116:119], a[244:247], v[108:111], a[116:119]
    v_exp_f32 v138, v58
    v_mfma_f32_16x16x32_bf16 a[24:27], a[248:251], v[96:99], a[24:27]
    ds_read_b128 a[232:235], v241 offset:26624
    v_or3_b32 v208, v208, v121, v122
    v_mfma_f32_16x16x32_bf16 a[56:59], a[248:251], v[100:103], a[56:59]
    v_exp_f32 v139, v59
    v_cvt_pk_bf16_f32 v123, v134, v135
    v_mfma_f32_16x16x32_bf16 a[88:91], a[248:251], v[104:107], a[88:91]
    v_exp_f32 v140, v60
    v_mfma_f32_16x16x32_bf16 a[120:123], a[248:251], v[108:111], a[120:123]
    v_exp_f32 v141, v61
    v_mfma_f32_16x16x32_bf16 a[28:31], a[252:255], v[96:99], a[28:31]
    ds_read_b128 a[236:239], v241 offset:27648
    v_cvt_pk_bf16_f32 v124, v136, v137
    s_add_u32 s35, s35, 32768
    v_mfma_f32_16x16x32_bf16 a[60:63], a[252:255], v[100:103], a[60:63]
    s_cmp_ge_u32 s35, 163840
    s_cselect_b32 s35, 0, s35
    v_mfma_f32_16x16x32_bf16 a[92:95], a[252:255], v[104:107], a[92:95]
    v_exp_f32 v142, v62
    v_mfma_f32_16x16x32_bf16 a[124:127], a[252:255], v[108:111], a[124:127]
    v_exp_f32 v143, v63
    v_or3_b32 v208, v208, v123, v124
    v_mfma_f32_16x16x32_bf16 v[144:147], v[204:207], v[96:99], v[144:147]
    v_cvt_pk_bf16_f32 v125, v138, v139
    v_cvt_pk_bf16_f32 v126, v140, v141
    v_mfma_f32_16x16x32_bf16 v[148:151], v[204:207], v[100:103], v[148:151]
    v_or3_b32 v208, v208, v125, v126
    v_cvt_pk_bf16_f32 v127, v142, v143
    v_mfma_f32_16x16x32_bf16 v[152:155], v[204:207], v[104:107], v[152:155]
    v_or_b32 v208, v208, v127
    v_and_b32 v208, s38, v208
    v_cmp_ne_u32 vcc, 0, v208
    v_mfma_f32_16x16x32_bf16 v[156:159], v[204:207], v[108:111], v[156:159]
    s_cbranch_vccnz kf_rare14
kf_rr13:
    s_sub_u32 s36, s36, 1
    s_cbranch_scc1 kf_fix19
kf_fixr20:
    s_waitcnt lgkmcnt(8)
    v_mfma_f32_16x16x32_bf16 v[48:51], a[192:195], a[160:163], v[80:83]
    ds_read_b128 a[240:243], v241 offset:28672
    ds_read_b128 a[244:247], v241 offset:29696
    v_mfma_f32_16x16x32_bf16 v[56:59], a[192:195], a[176:179], v[88:91]
    v_exp_f32 v128, v16
    v_mfma_f32_16x16x32_bf16 v[52:55], a[196:199], a[160:163], v[84:87]
    v_exp_f32 v129, v17
    v_mfma_f32_16x16x32_bf16 v[60:63], a[196:199], a[176:179], v[92:95]
    s_waitcnt vmcnt(10)
    buffer_store_dwordx4 v[196:199], v255, s[48:51], s45 offen offset:256 sc1
    v_mfma_f32_16x16x32_bf16 v[48:51], a[200:203], a[164:167], v[48:51]
    ds_read_b128 a[248:251], v241 offset:30720
    ds_read_b128 a[252:255], v241 offset:31744
    v_mfma_f32_16x16x32_bf16 v[56:59], a[200:203], a[180:183], v[56:59]
    v_exp_f32 v130, v18
    v_mfma_f32_16x16x32_bf16 v[52:55], a[204:207], a[164:167], v[52:55]
    v_exp_f32 v131, v19
    v_mfma_f32_16x16x32_bf16 v[60:63], a[204:207], a[180:183], v[60:63]
    v_cvt_pk_bf16_f32 v104, v128, v129
    s_waitcnt lgkmcnt(8)
    v_mfma_f32_16x16x32_bf16 v[48:51], a[208:211], a[168:171], v[48:51]
    s_waitcnt vmcnt(14)
    s_barrier
    v_add_u32 v241, s35, v240
    ds_read_b128 a[192:195], v241 offset:0
    v_mfma_f32_16x16x32_bf16 v[56:59], a[208:211], a[184:187], v[56:59]
    s_add_u32 m0, s34, 16384
    s_add_u32 s34, s34, 32768
    v_mfma_f32_16x16x32_bf16 v[52:55], a[212:215], a[168:171], v[52:55]
    ds_read_b128 a[196:199], v241 offset:1024
    v_cvt_pk_bf16_f32 v105, v130, v131
    v_mfma_f32_16x16x32_bf16 v[60:63], a[212:215], a[184:187], v[60:63]
    s_cmp_ge_u32 s34, 163840
    s_cselect_b32 s34, s37, s34
    v_mfma_f32_16x16x32_bf16 v[48:51], a[216:219], a[172:175], v[48:51]
    ds_read_b128 a[200:203], v241 offset:2048
    ds_read_b128 a[204:207], v241 offset:3072
    v_mfma_f32_16x16x32_bf16 v[56:59], a[216:219], a[188:191], v[56:59]
    v_exp_f32 v132, v20
    v_mfma_f32_16x16x32_bf16 v[52:55], a[220:223], a[172:175], v[52:55]
    v_exp_f32 v133, v21
    v_mfma_f32_16x16x32_bf16 v[60:63], a[220:223], a[188:191], v[60:63]
    v_cvt_pk_bf16_f32 v106, v132, v133
    s_waitcnt lgkmcnt(8)
    v_mfma_f32_16x16x32_bf16 a[0:3], a[224:227], v[112:115], a[0:3]
    ds_read_b128 a[208:211], v241 offset:4096
    v_or3_b32 v208, v104, v105, v106
    v_mfma_f32_16x16x32_bf16 a[32:35], a[224:227], v[116:119], a[32:35]
    v_exp_f32 v134, v22
    v_mfma_f32_16x16x32_bf16 a[64:67], a[224:227], v[120:123], a[64:67]
    buffer_load_dwordx4 v242, s[16:19], s42 offen offset:0 sc1 lds
    v_mfma_f32_16x16x32_bf16 a[96:99], a[224:227], v[124:127], a[96:99]
    v_exp_f32 v135, v23
    v_mfma_f32_16x16x32_bf16 a[4:7], a[228:231], v[112:115], a[4:7]
    ds_read_b128 a[212:215], v241 offset:5120
    v_cvt_pk_bf16_f32 v107, v134, v135
    v_mfma_f32_16x16x32_bf16 a[36:39], a[228:231], v[116:119], a[36:39]
    v_exp_f32 v136, v24
    v_mfma_f32_16x16x32_bf16 a[68:71], a[228:231], v[120:123], a[68:71]
    v_exp_f32 v137, v25
    v_mfma_f32_16x16x32_bf16 a[100:103], a[228:231], v[124:127], a[100:103]
    v_exp_f32 v138, v26
    v_mfma_f32_16x16x32_bf16 a[8:11], a[232:235], v[112:115], a[8:11]
    ds_read_b128 a[216:219], v241 offset:6144
    v_cvt_pk_bf16_f32 v108, v136, v137
    v_mfma_f32_16x16x32_bf16 a[40:43], a[232:235], v[116:119], a[40:43]
    buffer_load_dwordx4 v242, s[16:19], s42 offen offset:1024 sc1 lds
    v_or3_b32 v208, v208, v107, v108
    v_mfma_f32_16x16x32_bf16 a[72:75], a[232:235], v[120:123], a[72:75]
    v_exp_f32 v139, v27
    v_mfma_f32_16x16x32_bf16 a[104:107], a[232:235], v[124:127], a[104:107]
    v_exp_f32 v140, v28
    v_mfma_f32_16x16x32_bf16 a[12:15], a[236:239], v[112:115], a[12:15]
    ds_read_b128 a[220:223], v241 offset:7168
    v_cvt_pk_bf16_f32 v109, v138, v139
    v_mfma_f32_16x16x32_bf16 a[44:47], a[236:239], v[116:119], a[44:47]
    v_exp_f32 v141, v29
    v_mfma_f32_16x16x32_bf16 a[76:79], a[236:239], v[120:123], a[76:79]
    v_exp_f32 v142, v30
    v_mfma_f32_16x16x32_bf16 a[108:111], a[236:239], v[124:127], a[108:111]
    v_cvt_pk_bf16_f32 v110, v140, v141
    s_waitcnt lgkmcnt(8)
    v_mfma_f32_16x16x32_bf16 a[16:19], a[240:243], v[112:115], a[16:19]
    ds_read_b128 a[224:227], v241 offset:16384
    v_or3_b32 v208, v208, v109, v110
    v_mfma_f32_16x16x32_bf16 a[48:51], a[240:243], v[116:119], a[48:51]
    buffer_load_dwordx4 v242, s[16:19], s42 offen offset:2048 sc1 lds
    v_mfma_f32_16x16x32_bf16 a[80:83], a[240:243], v[120:123], a[80:83]
    v_exp_f32 v143, v31
    v_mfma_f32_16x16x32_bf16 a[112:115], a[240:243], v[124:127], a[112:115]
    v_cvt_pk_bf16_f32 v111, v142, v143
    v_or_b32 v208, v208, v111
    v_mfma_f32_16x16x32_bf16 a[20:23], a[244:247], v[112:115], a[20:23]
    ds_read_b128 a[228:231], v241 offset:17408
    v_and_b32 v208, s38, v208
    v_mfma_f32_16x16x32_bf16 a[52:55], a[244:247], v[116:119], a[52:55]
    v_cmp_ne_u32 vcc, 0, v208
    buffer_load_dwordx4 v242, s[16:19], s42 offen offset:3072 sc1 lds
    v_mfma_f32_16x16x32_bf16 a[84:87], a[244:247], v[120:123], a[84:87]
    s_add_u32 s42, s42, 34048
    v_mfma_f32_16x16x32_bf16 a[116:119], a[244:247], v[124:127], a[116:119]
    v_mfma_f32_16x16x32_bf16 a[24:27], a[248:251], v[112:115], a[24:27]
    ds_read_b128 a[232:235], v241 offset:18432
    v_mfma_f32_16x16x32_bf16 a[56:59], a[248:251], v[116:119], a[56:59]
    v_mfma_f32_16x16x32_bf16 a[88:91], a[248:251], v[120:123], a[88:91]
    v_mfma_f32_16x16x32_bf16 a[120:123], a[248:251], v[124:127], a[120:123]
    v_mfma_f32_16x16x32_bf16 a[28:31], a[252:255], v[112:115], a[28:31]
    ds_read_b128 a[236:239], v241 offset:19456
    v_mfma_f32_16x16x32_bf16 a[60:63], a[252:255], v[116:119], a[60:63]
    v_mfma_f32_16x16x32_bf16 a[92:95], a[252:255], v[120:123], a[92:95]
    v_mfma_f32_16x16x32_bf16 a[124:127], a[252:255], v[124:127], a[124:127]
    v_mfma_f32_16x16x32_bf16 v[144:147], v[204:207], v[112:115], v[144:147]
    v_mfma_f32_16x16x32_bf16 v[148:151], v[204:207], v[116:119], v[148:151]
    v_mfma_f32_16x16x32_bf16 v[152:155], v[204:207], v[120:123], v[152:155]
    v_mfma_f32_16x16x32_bf16 v[156:159], v[204:207], v[124:127], v[156:159]
    s_cbranch_vccnz kf_rare18
kf_rr17:
    s_nop 6
    v_rcp_f32 v230, v144
    v_rcp_f32 v231, v148
    v_accvgpr_read_b32 v160, a0
    v_accvgpr_read_b32 v161, a1
    v_accvgpr_read_b32 v162, a2
    v_accvgpr_read_b32 v163, a3
    v_accvgpr_read_b32 v164, a4
    v_accvgpr_read_b32 v165, a5
    v_accvgpr_read_b32 v166, a6
    v_accvgpr_read_b32 v167, a7
    v_mul_f32 v160, v160, v230
    v_mul_f32 v161, v161, v230
    v_mul_f32 v162, v162, v230
    v_mul_f32 v163, v163, v230
    v_mul_f32 v164, v164, v230
    v_mul_f32 v165, v165, v230
    v_mul_f32 v166, v166, v230
    v_mul_f32 v167, v167, v230
    v_cvt_pk_bf16_f32 v176, v160, v161
    v_cvt_pk_bf16_f32 v177, v162, v163
    v_cvt_pk_bf16_f32 v178, v164, v165
    v_cvt_pk_bf16_f32 v179, v166, v167
    buffer_store_dwordx4 v[176:179], v240, s[20:23], s39 offen offset:0 sc1
    v_accvgpr_read_b32 v168, a8
    v_accvgpr_read_b32 v169, a9
    v_accvgpr_read_b32 v170, a10
    v_accvgpr_read_b32 v171, a11
    v_accvgpr_read_b32 v172, a12
    v_accvgpr_read_b32 v173, a13
    v_accvgpr_read_b32 v174, a14
    v_accvgpr_read_b32 v175, a15
    v_mul_f32 v168, v168, v230
    v_mul_f32 v169, v169, v230
    v_mul_f32 v170, v170, v230
    v_mul_f32 v171, v171, v230
    v_mul_f32 v172, v172, v230
    v_mul_f32 v173, v173, v230
    v_mul_f32 v174, v174, v230
    v_mul_f32 v175, v175, v230
    v_cvt_pk_bf16_f32 v180, v168, v169
    v_cvt_pk_bf16_f32 v181, v170, v171
    v_cvt_pk_bf16_f32 v182, v172, v173
    v_cvt_pk_bf16_f32 v183, v174, v175
    buffer_store_dwordx4 v[180:183], v240, s[20:23], s39 offen offset:1024 sc1
    v_accvgpr_read_b32 v160, a16
    v_accvgpr_read_b32 v161, a17
    v_accvgpr_read_b32 v162, a18
    v_accvgpr_read_b32 v163, a19
    v_accvgpr_read_b32 v164, a20
    v_accvgpr_read_b32 v165, a21
    v_accvgpr_read_b32 v166, a22
    v_accvgpr_read_b32 v167, a23
    v_mul_f32 v160, v160, v230
    v_mul_f32 v161, v161, v230
    v_mul_f32 v162, v162, v230
    v_mul_f32 v163, v163, v230
    v_mul_f32 v164, v164, v230
    v_mul_f32 v165, v165, v230
    v_mul_f32 v166, v166, v230
    v_mul_f32 v167, v167, v230
    v_cvt_pk_bf16_f32 v184, v160, v161
    v_cvt_pk_bf16_f32 v185, v162, v163
    v_cvt_pk_bf16_f32 v186, v164, v165
    v_cvt_pk_bf16_f32 v187, v166, v167
    buffer_store_dwordx4 v[184:187], v240, s[20:23], s39 offen offset:2048 sc1
    v_accvgpr_read_b32 v168, a24
    v_accvgpr_read_b32 v169, a25
    v_accvgpr_read_b32 v170, a26
    v_accvgpr_read_b32 v171, a27
    v_accvgpr_read_b32 v172, a28
    v_accvgpr_read_b32 v173, a29
    v_accvgpr_read_b32 v174, a30
    v_accvgpr_read_b32 v175, a31
    v_mul_f32 v168, v168, v230
    v_mul_f32 v169, v169, v230
    v_mul_f32 v170, v170, v230
    v_mul_f32 v171, v171, v230
    v_mul_f32 v172, v172, v230
    v_mul_f32 v173, v173, v230
    v_mul_f32 v174, v174, v230
    v_mul_f32 v175, v175, v230
    v_cvt_pk_bf16_f32 v188, v168, v169
    v_cvt_pk_bf16_f32 v189, v170, v171
    v_cvt_pk_bf16_f32 v190, v172, v173
    v_cvt_pk_bf16_f32 v191, v174, v175
    buffer_store_dwordx4 v[188:191], v240, s[20:23], s39 offen offset:3072 sc1
    v_accvgpr_read_b32 v160, a32
    v_accvgpr_read_b32 v161, a33
    v_accvgpr_read_b32 v162, a34
    v_accvgpr_read_b32 v163, a35
    v_accvgpr_read_b32 v164, a36
    v_accvgpr_read_b32 v165, a37
    v_accvgpr_read_b32 v166, a38
    v_accvgpr_read_b32 v167, a39
    v_mul_f32 v160, v160, v231
    v_mul_f32 v161, v161, v231
    v_mul_f32 v162, v162, v231
    v_mul_f32 v163, v163, v231
    v_mul_f32 v164, v164, v231
    v_mul_f32 v165, v165, v231
    v_mul_f32 v166, v166, v231
    v_mul_f32 v167, v167, v231
    v_cvt_pk_bf16_f32 v176, v160, v161
    v_cvt_pk_bf16_f32 v177, v162, v163
    v_cvt_pk_bf16_f32 v178, v164, v165
    v_cvt_pk_bf16_f32 v179, v166, v167
    buffer_store_dwordx4 v[176:179], v244, s[20:23], s39 offen offset:0 sc1
    v_accvgpr_read_b32 v168, a40
    v_accvgpr_read_b32 v169, a41
    v_accvgpr_read_b32 v170, a42
    v_accvgpr_read_b32 v171, a43
    v_accvgpr_read_b32 v172, a44
    v_accvgpr_read_b32 v173, a45
    v_accvgpr_read_b32 v174, a46
    v_accvgpr_read_b32 v175, a47
    v_mul_f32 v168, v168, v231
    v_mul_f32 v169, v169, v231
    v_mul_f32 v170, v170, v231
    v_mul_f32 v171, v171, v231
    v_mul_f32 v172, v172, v231
    v_mul_f32 v173, v173, v231
    v_mul_f32 v174, v174, v231
    v_mul_f32 v175, v175, v231
    v_cvt_pk_bf16_f32 v180, v168, v169
    v_cvt_pk_bf16_f32 v181, v170, v171
    v_cvt_pk_bf16_f32 v182, v172, v173
    v_cvt_pk_bf16_f32 v183, v174, v175
    buffer_store_dwordx4 v[180:183], v244, s[20:23], s39 offen offset:1024 sc1
    v_accvgpr_read_b32 v160, a48
    v_accvgpr_read_b32 v161, a49
    v_accvgpr_read_b32 v162, a50
    v_accvgpr_read_b32 v163, a51
    v_accvgpr_read_b32 v164, a52
    v_accvgpr_read_b32 v165, a53
    v_accvgpr_read_b32 v166, a54
    v_accvgpr_read_b32 v167, a55
    v_mul_f32 v160, v160, v231
    v_mul_f32 v161, v161, v231
    v_mul_f32 v162, v162, v231
    v_mul_f32 v163, v163, v231
    v_mul_f32 v164, v164, v231
    v_mul_f32 v165, v165, v231
    v_mul_f32 v166, v166, v231
    v_mul_f32 v167, v167, v231
    v_cvt_pk_bf16_f32 v184, v160, v161
    v_cvt_pk_bf16_f32 v185, v162, v163
    v_cvt_pk_bf16_f32 v186, v164, v165
    v_cvt_pk_bf16_f32 v187, v166, v167
    buffer_store_dwordx4 v[184:187], v244, s[20:23], s39 offen offset:2048 sc1
    v_accvgpr_read_b32 v168, a56
    v_accvgpr_read_b32 v169, a57
    v_accvgpr_read_b32 v170, a58
    v_accvgpr_read_b32 v171, a59
    v_accvgpr_read_b32 v172, a60
    v_accvgpr_read_b32 v173, a61
    v_accvgpr_read_b32 v174, a62
    v_accvgpr_read_b32 v175, a63
    v_mul_f32 v168, v168, v231
    v_mul_f32 v169, v169, v231
    v_mul_f32 v170, v170, v231
    v_mul_f32 v171, v171, v231
    v_mul_f32 v172, v172, v231
    v_mul_f32 v173, v173, v231
    v_mul_f32 v174, v174, v231
    v_mul_f32 v175, v175, v231
    v_cvt_pk_bf16_f32 v188, v168, v169
    v_cvt_pk_bf16_f32 v189, v170, v171
    v_cvt_pk_bf16_f32 v190, v172, v173
    v_cvt_pk_bf16_f32 v191, v174, v175
    buffer_store_dwordx4 v[188:191], v244, s[20:23], s39 offen offset:3072 sc1
    s_lshl1_add_u32 s26, s5, s31
    s_lshl_b32 s26, s26, 1
    s_sub_u32 s26, 30, s26
    s_branch ka_p2_e
.p2align 5
ka_p2:
    s_sub_u32 s36, s36, 1
    s_cbranch_scc1 kf_fix23
kf_fixr24:
    s_waitcnt lgkmcnt(8)
    v_mfma_f32_16x16x32_bf16 v[16:19], a[192:195], a[160:163], v[80:83]
    ds_read_b128 a[240:243], v241 offset:20480
    ds_read_b128 a[244:247], v241 offset:21504
    v_mfma_f32_16x16x32_bf16 v[24:27], a[192:195], a[176:179], v[88:91]
    v_exp_f32 v128, v48
    v_mfma_f32_16x16x32_bf16 v[20:23], a[196:199], a[160:163], v[84:87]
    s_mov_b32 m0, s34
    v_exp_f32 v129, v49
    v_mfma_f32_16x16x32_bf16 v[28:31], a[196:199], a[176:179], v[92:95]
    v_exp_f32 v130, v50
    v_mfma_f32_16x16x32_bf16 v[16:19], a[200:203], a[164:167], v[16:19]
    ds_read_b128 a[248:251], v241 offset:22528
    ds_read_b128 a[252:255], v241 offset:23552
    v_mfma_f32_16x16x32_bf16 v[24:27], a[200:203], a[180:183], v[24:27]
    s_add_u32 s41, s42, 17664
    v_cvt_pk_bf16_f32 v120, v128, v129
    v_mfma_f32_16x16x32_bf16 v[20:23], a[204:207], a[164:167], v[20:23]
    buffer_load_dwordx4 v242, s[16:19], s41 offen offset:0 sc1 lds
    v_exp_f32 v131, v51
    v_mfma_f32_16x16x32_bf16 v[28:31], a[204:207], a[180:183], v[28:31]
    v_cvt_pk_bf16_f32 v121, v130, v131
    s_waitcnt lgkmcnt(8)
    v_mfma_f32_16x16x32_bf16 v[16:19], a[208:211], a[168:171], v[16:19]
    ds_read_b128 a[192:195], v241 offset:8192
    ds_read_b128 a[196:199], v241 offset:9216
    v_mfma_f32_16x16x32_bf16 v[24:27], a[208:211], a[184:187], v[24:27]
    v_exp_f32 v132, v52
    v_mfma_f32_16x16x32_bf16 v[20:23], a[212:215], a[168:171], v[20:23]
    v_exp_f32 v133, v53
    buffer_load_dwordx4 v242, s[16:19], s41 offen offset:1024 sc1 lds
    v_mfma_f32_16x16x32_bf16 v[28:31], a[212:215], a[184:187], v[28:31]
    v_exp_f32 v134, v54
    v_mfma_f32_16x16x32_bf16 v[16:19], a[216:219], a[172:175], v[16:19]
    ds_read_b128 a[200:203], v241 offset:10240
    ds_read_b128 a[204:207], v241 offset:11264
    v_mfma_f32_16x16x32_bf16 v[24:27], a[216:219], a[188:191], v[24:27]
    v_exp_f32 v135, v55
    v_mfma_f32_16x16x32_bf16 v[20:23], a[220:223], a[172:175], v[20:23]
    v_exp_f32 v136, v56
    v_cvt_pk_bf16_f32 v122, v132, v133
    v_mfma_f32_16x16x32_bf16 v[28:31], a[220:223], a[188:191], v[28:31]
    v_or3_b32 v208, v120, v121, v122
    s_waitcnt lgkmcnt(8)
    v_mfma_f32_16x16x32_bf16 a[64:67], a[224:227], v[104:107], a[64:67]
    ds_read_b128 a[208:211], v241 offset:12288
    ds_read_b128 a[212:215], v241 offset:13312
    v_mfma_f32_16x16x32_bf16 a[96:99], a[224:227], v[108:111], a[96:99]
    v_exp_f32 v137, v57
    v_mfma_f32_16x16x32_bf16 a[68:71], a[228:231], v[104:107], a[68:71]
    v_exp_f32 v138, v58
    v_mfma_f32_16x16x32_bf16 a[100:103], a[228:231], v[108:111], a[100:103]
    buffer_load_dwordx4 v242, s[16:19], s41 offen offset:2048 sc1 lds
    v_exp_f32 v139, v59
    v_mfma_f32_16x16x32_bf16 a[72:75], a[232:235], v[104:107], a[72:75]
    ds_read_b128 a[216:219], v241 offset:14336
    ds_read_b128 a[220:223], v241 offset:15360
    v_mfma_f32_16x16x32_bf16 a[104:107], a[232:235], v[108:111], a[104:107]
    v_exp_f32 v140, v60
    v_mfma_f32_16x16x32_bf16 a[76:79], a[236:239], v[104:107], a[76:79]
    buffer_load_dwordx4 v242, s[16:19], s41 offen offset:3072 sc1 lds
    v_cvt_pk_bf16_f32 v123, v134, v135
    v_mfma_f32_16x16x32_bf16 a[108:111], a[236:239], v[108:111], a[108:111]
    v_exp_f32 v141, v61
    s_waitcnt lgkmcnt(8)
    v_mfma_f32_16x16x32_bf16 a[80:83], a[240:243], v[104:107], a[80:83]
    ds_read_b128 a[224:227], v241 offset:24576
    ds_read_b128 a[228:231], v241 offset:25600
    v_mfma_f32_16x16x32_bf16 a[112:115], a[240:243], v[108:111], a[112:115]
    v_cvt_pk_bf16_f32 v124, v136, v137
    v_or3_b32 v208, v208, v123, v124
    v_mfma_f32_16x16x32_bf16 a[84:87], a[244:247], v[104:107], a[84:87]
    v_exp_f32 v142, v62
    v_mfma_f32_16x16x32_bf16 a[116:119], a[244:247], v[108:111], a[116:119]
    s_add_u32 s35, s35, 32768
    s_cmp_ge_u32 s35, 163840
    s_cselect_b32 s35, 0, s35
    v_mfma_f32_16x16x32_bf16 a[88:91], a[248:251], v[104:107], a[88:91]
    ds_read_b128 a[232:235], v241 offset:26624
    ds_read_b128 a[236:239], v241 offset:27648
    v_mfma_f32_16x16x32_bf16 a[120:123], a[248:251], v[108:111], a[120:123]
    v_exp_f32 v143, v63
    v_mfma_f32_16x16x32_bf16 a[92:95], a[252:255], v[104:107], a[92:95]
    v_cvt_pk_bf16_f32 v125, v138, v139
    v_cvt_pk_bf16_f32 v126, v140, v141
    v_mfma_f32_16x16x32_bf16 a[124:127], a[252:255], v[108:111], a[124:127]
    v_or3_b32 v208, v208, v125, v126
    v_cvt_pk_bf16_f32 v127, v142, v143
    v_or_b32 v208, v208, v127
    v_mfma_f32_16x16x32_bf16 v[152:155], v[204:207], v[104:107], v[152:155]
    v_and_b32 v208, s38, v208
    v_cmp_ne_u32 vcc, 0, v208
    v_mfma_f32_16x16x32_bf16 v[156:159], v[204:207], v[108:111], v[156:159]
    s_cbranch_vccnz kf_rare22
kf_rr21:
    s_sub_u32 s36, s36, 1
    s_cbranch_scc1 kf_fix27
kf_fixr28:
    s_waitcnt lgkmcnt(8)
    v_mfma_f32_16x16x32_bf16 v[48:51], a[192:195], a[160:163], v[80:83]
    ds_read_b128 a[240:243], v241 offset:28672
    ds_read_b128 a[244:247], v241 offset:29696
    v_mfma_f32_16x16x32_bf16 v[56:59], a[192:195], a[176:179], v[88:91]
    s_add_u32 m0, s34, 16384
    v_exp_f32 v128, v16
    v_mfma_f32_16x16x32_bf16 v[52:55], a[196:199], a[160:163], v[84:87]
    v_exp_f32 v129, v17
    v_mfma_f32_16x16x32_bf16 v[60:63], a[196:199], a[176:179], v[92:95]
    v_exp_f32 v130, v18
    v_mfma_f32_16x16x32_bf16 v[48:51], a[200:203], a[164:167], v[48:51]
    ds_read_b128 a[248:251], v241 offset:30720
    ds_read_b128 a[252:255], v241 offset:31744
    s_add_u32 s34, s34, 32768
    v_mfma_f32_16x16x32_bf16 v[56:59], a[200:203], a[180:183], v[56:59]
    s_cmp_ge_u32 s34, 163840
    s_cselect_b32 s34, s37, s34
    v_mfma_f32_16x16x32_bf16 v[52:55], a[204:207], a[164:167], v[52:55]
    v_exp_f32 v131, v19
    v_mfma_f32_16x16x32_bf16 v[60:63], a[204:207], a[180:183], v[60:63]
    v_exp_f32 v132, v20
    s_waitcnt lgkmcnt(8)
    v_mfma_f32_16x16x32_bf16 v[48:51], a[208:211], a[168:171], v[48:51]
    s_waitcnt vmcnt(12)
    s_barrier
    v_add_u32 v241, s35, v240
    ds_read_b128 a[192:195], v241 offset:0
    v_mfma_f32_16x16x32_bf16 v[56:59], a[208:211], a[184:187], v[56:59]
    v_exp_f32 v133, v21
    v_mfma_f32_16x16x32_bf16 v[52:55], a[212:215], a[168:171], v[52:55]
    ds_read_b128 a[196:199], v241 offset:1024
    buffer_load_dwordx4 v242, s[16:19], s42 offen offset:0 sc1 lds
    v_mfma_f32_16x16x32_bf16 v[60:63], a[212:215], a[184:187], v[60:63]
    v_exp_f32 v134, v22
    v_cvt_pk_bf16_f32 v104, v128, v129
    v_mfma_f32_16x16x32_bf16 v[48:51], a[216:219], a[172:175], v[48:51]
    ds_read_b128 a[200:203], v241 offset:2048
    ds_read_b128 a[204:207], v241 offset:3072
    v_mfma_f32_16x16x32_bf16 v[56:59], a[216:219], a[188:191], v[56:59]
    v_exp_f32 v135, v23
    v_mfma_f32_16x16x32_bf16 v[52:55], a[220:223], a[172:175], v[52:55]
    buffer_load_dwordx4 v242, s[16:19], s42 offen offset:1024 sc1 lds
    v_exp_f32 v136, v24
    v_mfma_f32_16x16x32_bf16 v[60:63], a[220:223], a[188:191], v[60:63]
    v_cvt_pk_bf16_f32 v105, v130, v131
    s_waitcnt lgkmcnt(8)
    v_mfma_f32_16x16x32_bf16 a[64:67], a[224:227], v[120:123], a[64:67]
    ds_read_b128 a[208:211], v241 offset:4096
    ds_read_b128 a[212:215], v241 offset:5120
    v_mfma_f32_16x16x32_bf16 a[96:99], a[224:227], v[124:127], a[96:99]
    v_exp_f32 v137, v25
    v_mfma_f32_16x16x32_bf16 a[68:71], a[228:231], v[120:123], a[68:71]
    v_cvt_pk_bf16_f32 v106, v132, v133
    v_exp_f32 v138, v26
    v_mfma_f32_16x16x32_bf16 a[100:103], a[228:231], v[124:127], a[100:103]
    v_exp_f32 v139, v27
    v_mfma_f32_16x16x32_bf16 a[72:75], a[232:235], v[120:123], a[72:75]
    ds_read_b128 a[216:219], v241 offset:6144
    ds_read_b128 a[220:223], v241 offset:7168
    v_mfma_f32_16x16x32_bf16 a[104:107], a[232:235], v[124:127], a[104:107]
    buffer_load_dwordx4 v242, s[16:19], s42 offen offset:2048 sc1 lds
    v_or3_b32 v208, v104, v105, v106
    v_cvt_pk_bf16_f32 v107, v134, v135
    v_mfma_f32_16x16x32_bf16 a[76:79], a[236:239], v[120:123], a[76:79]
    v_exp_f32 v140, v28
    v_mfma_f32_16x16x32_bf16 a[108:111], a[236:239], v[124:127], a[108:111]
    v_cvt_pk_bf16_f32 v108, v136, v137
    s_waitcnt lgkmcnt(8)
    v_mfma_f32_16x16x32_bf16 a[80:83], a[240:243], v[120:123], a[80:83]
    ds_read_b128 a[224:227], v241 offset:16384
    ds_read_b128 a[228:231], v241 offset:17408
    v_or3_b32 v208, v208, v107, v108
    v_mfma_f32_16x16x32_bf16 a[112:115], a[240:243], v[124:127], a[112:115]
    v_exp_f32 v141, v29
    v_mfma_f32_16x16x32_bf16 a[84:87], a[244:247], v[120:123], a[84:87]
    v_exp_f32 v142, v30
    v_mfma_f32_16x16x32_bf16 a[116:119], a[244:247], v[124:127], a[116:119]
    v_exp_f32 v143, v31
    v_mfma_f32_16x16x32_bf16 a[88:91], a[248:251], v[120:123], a[88:91]
    ds_read_b128 a[232:235], v241 offset:18432
    ds_read_b128 a[236:239], v241 offset:19456
    buffer_load_dwordx4 v242, s[16:19], s42 offen offset:3072 sc1 lds
    v_mfma_f32_16x16x32_bf16 a[120:123], a[248:251], v[124:127], a[120:123]
    s_add_u32 s42, s42, 34048
    v_cvt_pk_bf16_f32 v109, v138, v139
    v_mfma_f32_16x16x32_bf16 a[92:95], a[252:255], v[120:123], a[92:95]
    v_cvt_pk_bf16_f32 v110, v140, v141
    v_or3_b32 v208, v208, v109, v110
    v_mfma_f32_16x16x32_bf16 a[124:127], a[252:255], v[124:127], a[124:127]
    v_cvt_pk_bf16_f32 v111, v142, v143
    v_or_b32 v208, v208, v111
    v_and_b32 v208, s38, v208
    v_mfma_f32_16x16x32_bf16 v[152:155], v[204:207], v[120:123], v[152:155]
    v_cmp_ne_u32 vcc, 0, v208
    v_mfma_f32_16x16x32_bf16 v[156:159], v[204:207], v[124:127], v[156:159]
    s_cbranch_vccnz kf_rare26
kf_rr25:
ka_p2_e:
    s_sub_u32 s26, s26, 1
    s_cbranch_scc0 ka_p2
    s_branch ka_p2_x
kf_fix23:
    s_mov_b32 s24, 0
    s_branch kf_fix23c
kf_fix27:
    s_mov_b32 s24, 1
kf_fix23c:
    s_cmp_eq_u32 s33, 0
    s_cbranch_scc0 kf_fix23f
    s_mov_b32 s36, 0
    s_mov_b32 s33, 1
    v_add_f32 v80, v226, v200
    v_add_f32 v81, v226, v201
    v_add_f32 v82, v226, v202
    v_add_f32 v83, v226, v203
    v_add_f32 v84, v226, v209
    v_add_f32 v85, v226, v210
    v_add_f32 v86, v226, v211
    v_add_f32 v87, v226, v212
    v_add_f32 v88, v227, v213
    v_add_f32 v89, v227, v214
    v_add_f32 v90, v227, v215
    v_add_f32 v91, v227, v216
    v_add_f32 v92, v227, v217
    v_add_f32 v93, v227, v218
    v_add_f32 v94, v227, v219
    v_add_f32 v95, v227, v220
    s_cmp_eq_u32 s24, 0
    s_cbranch_scc1 kf_fixr24
    s_branch kf_fixr28
kf_fix23f:
    s_mov_b32 s36, 0x1000
    v_mov_b32 v80, 0xf1800000
    v_mov_b32 v81, v80
    v_mov_b32 v82, v80
    v_mov_b32 v83, v80
    v_mov_b32 v84, v80
    v_mov_b32 v85, v80
    v_mov_b32 v86, v80
    v_mov_b32 v87, v80
    v_mov_b32 v88, v80
    v_mov_b32 v89, v80
    v_mov_b32 v90, v80
    v_mov_b32 v91, v80
    v_mov_b32 v92, v80
    v_mov_b32 v93, v80
    v_mov_b32 v94, v80
    v_mov_b32 v95, v80
    s_cmp_eq_u32 s24, 0
    s_cbranch_scc1 kf_fixr24
    s_branch kf_fixr28
ka_p2_x:
    s_waitcnt lgkmcnt(0)
    ds_read_b128 a[224:227], v241 offset:16384
    ds_read_b128 a[228:231], v241 offset:17408
    ds_read_b128 a[232:235], v241 offset:18432
    ds_read_b128 a[236:239], v241 offset:19456
    ds_read_b128 a[240:243], v241 offset:20480
    ds_read_b128 a[244:247], v241 offset:21504
    ds_read_b128 a[248:251], v241 offset:22528
    ds_read_b128 a[252:255], v241 offset:23552
    ds_read_b128 a[192:195], v241 offset:24576
    ds_read_b128 a[196:199], v241 offset:25600
    ds_read_b128 a[200:203], v241 offset:26624
    ds_read_b128 a[204:207], v241 offset:27648
    ds_read_b128 a[208:211], v241 offset:28672
    ds_read_b128 a[212:215], v241 offset:29696
    ds_read_b128 a[216:219], v241 offset:30720
    s_waitcnt lgkmcnt(7)
    ds_read_b128 a[220:223], v241 offset:31744
    v_mfma_f32_16x16x32_bf16 a[64:67], a[224:227], v[104:107], a[64:67]
    v_exp_f32 v128, v48
    v_exp_f32 v129, v49
    v_mfma_f32_16x16x32_bf16 a[96:99], a[224:227], v[108:111], a[96:99]
    v_exp_f32 v130, v50
    v_cvt_pk_bf16_f32 v120, v128, v129
    v_mfma_f32_16x16x32_bf16 a[68:71], a[228:231], v[104:107], a[68:71]
    v_exp_f32 v131, v51
    v_mfma_f32_16x16x32_bf16 a[100:103], a[228:231], v[108:111], a[100:103]
    v_exp_f32 v132, v52
    v_cvt_pk_bf16_f32 v121, v130, v131
    v_mfma_f32_16x16x32_bf16 a[72:75], a[232:235], v[104:107], a[72:75]
    v_exp_f32 v133, v53
    v_mfma_f32_16x16x32_bf16 a[104:107], a[232:235], v[108:111], a[104:107]
    v_exp_f32 v134, v54
    v_cvt_pk_bf16_f32 v122, v132, v133
    v_mfma_f32_16x16x32_bf16 a[76:79], a[236:239], v[104:107], a[76:79]
    v_exp_f32 v135, v55
    v_or3_b32 v208, v120, v121, v122
    v_mfma_f32_16x16x32_bf16 a[108:111], a[236:239], v[108:111], a[108:111]
    v_exp_f32 v136, v56
    v_cvt_pk_bf16_f32 v123, v134, v135
    v_mfma_f32_16x16x32_bf16 a[80:83], a[240:243], v[104:107], a[80:83]
    v_exp_f32 v137, v57
    v_mfma_f32_16x16x32_bf16 a[112:115], a[240:243], v[108:111], a[112:115]
    v_exp_f32 v138, v58
    v_cvt_pk_bf16_f32 v124, v136, v137
    v_mfma_f32_16x16x32_bf16 a[84:87], a[244:247], v[104:107], a[84:87]
    v_exp_f32 v139, v59
    v_or3_b32 v208, v208, v123, v124
    v_mfma_f32_16x16x32_bf16 a[116:119], a[244:247], v[108:111], a[116:119]
    v_exp_f32 v140, v60
    v_cvt_pk_bf16_f32 v125, v138, v139
    v_mfma_f32_16x16x32_bf16 a[88:91], a[248:251], v[104:107], a[88:91]
    v_exp_f32 v141, v61
    v_mfma_f32_16x16x32_bf16 a[120:123], a[248:251], v[108:111], a[120:123]
    v_exp_f32 v142, v62
    v_cvt_pk_bf16_f32 v126, v140, v141
    v_mfma_f32_16x16x32_bf16 a[92:95], a[252:255], v[104:107], a[92:95]
    v_exp_f32 v143, v63
    v_or3_b32 v208, v208, v125, v126
    v_mfma_f32_16x16x32_bf16 a[124:127], a[252:255], v[108:111], a[124:127]
    v_cvt_pk_bf16_f32 v127, v142, v143
    v_or_b32 v208, v208, v127
    v_and_b32 v208, s38, v208
    v_mfma_f32_16x16x32_bf16 v[152:155], v[204:207], v[104:107], v[152:155]
    v_cmp_ne_u32 vcc, 0, v208
    v_mfma_f32_16x16x32_bf16 v[156:159], v[204:207], v[108:111], v[156:159]
    s_cbranch_vccnz kf_rare30
kf_rr29:
    s_waitcnt lgkmcnt(0)
    s_nop 0
    v_mfma_f32_16x16x32_bf16 a[64:67], a[192:195], v[120:123], a[64:67]
    v_mfma_f32_16x16x32_bf16 a[96:99], a[192:195], v[124:127], a[96:99]
    v_mfma_f32_16x16x32_bf16 a[68:71], a[196:199], v[120:123], a[68:71]
    v_mfma_f32_16x16x32_bf16 a[100:103], a[196:199], v[124:127], a[100:103]
    v_mfma_f32_16x16x32_bf16 a[72:75], a[200:203], v[120:123], a[72:75]
    v_mfma_f32_16x16x32_bf16 a[104:107], a[200:203], v[124:127], a[104:107]
    v_mfma_f32_16x16x32_bf16 a[76:79], a[204:207], v[120:123], a[76:79]
    v_mfma_f32_16x16x32_bf16 a[108:111], a[204:207], v[124:127], a[108:111]
    v_mfma_f32_16x16x32_bf16 a[80:83], a[208:211], v[120:123], a[80:83]
    v_mfma_f32_16x16x32_bf16 a[112:115], a[208:211], v[124:127], a[112:115]
    v_mfma_f32_16x16x32_bf16 a[84:87], a[212:215], v[120:123], a[84:87]
    v_mfma_f32_16x16x32_bf16 a[116:119], a[212:215], v[124:127], a[116:119]
    v_mfma_f32_16x16x32_bf16 a[88:91], a[216:219], v[120:123], a[88:91]
    v_mfma_f32_16x16x32_bf16 a[120:123], a[216:219], v[124:127], a[120:123]
    v_mfma_f32_16x16x32_bf16 a[92:95], a[220:223], v[120:123], a[92:95]
    v_mfma_f32_16x16x32_bf16 a[124:127], a[220:223], v[124:127], a[124:127]
    v_mfma_f32_16x16x32_bf16 v[152:155], v[204:207], v[120:123], v[152:155]
    v_mfma_f32_16x16x32_bf16 v[156:159], v[204:207], v[124:127], v[156:159]
    s_cmp_eq_u32 s31, 0
    s_cbranch_scc1 ka_nox
    s_waitcnt vmcnt(8)
    s_barrier
ka_nox:
    s_nop 6
    v_rcp_f32 v230, v152
    v_rcp_f32 v231, v156
    v_accvgpr_read_b32 v160, a64
    v_accvgpr_read_b32 v161, a65
    v_accvgpr_read_b32 v162, a66
    v_accvgpr_read_b32 v163, a67
    v_accvgpr_read_b32 v164, a68
    v_accvgpr_read_b32 v165, a69
    v_accvgpr_read_b32 v166, a70
    v_accvgpr_read_b32 v167, a71
    v_mul_f32 v160, v160, v230
    v_mul_f32 v161, v161, v230
    v_mul_f32 v162, v162, v230
    v_mul_f32 v163, v163, v230
    v_mul_f32 v164, v164, v230
    v_mul_f32 v165, v165, v230
    v_mul_f32 v166, v166, v230
    v_mul_f32 v167, v167, v230
    v_cvt_pk_bf16_f32 v176, v160, v161
    v_cvt_pk_bf16_f32 v177, v162, v163
    v_cvt_pk_bf16_f32 v178, v164, v165
    v_cvt_pk_bf16_f32 v179, v166, v167
    buffer_store_dwordx4 v[176:179], v240, s[20:23], s40 offen offset:0 sc1
    v_accvgpr_read_b32 v168, a72
    v_accvgpr_read_b32 v169, a73
    v_accvgpr_read_b32 v170, a74
    v_accvgpr_read_b32 v171, a75
    v_accvgpr_read_b32 v172, a76
    v_accvgpr_read_b32 v173, a77
    v_accvgpr_read_b32 v174, a78
    v_accvgpr_read_b32 v175, a79
    v_mul_f32 v168, v168, v230
    v_mul_f32 v169, v169, v230
    v_mul_f32 v170, v170, v230
    v_mul_f32 v171, v171, v230
    v_mul_f32 v172, v172, v230
    v_mul_f32 v173, v173, v230
    v_mul_f32 v174, v174, v230
    v_mul_f32 v175, v175, v230
    v_cvt_pk_bf16_f32 v180, v168, v169
    v_cvt_pk_bf16_f32 v181, v170, v171
    v_cvt_pk_bf16_f32 v182, v172, v173
    v_cvt_pk_bf16_f32 v183, v174, v175
    buffer_store_dwordx4 v[180:183], v240, s[20:23], s40 offen offset:1024 sc1
    v_accvgpr_read_b32 v160, a80
    v_accvgpr_read_b32 v161, a81
    v_accvgpr_read_b32 v162, a82
    v_accvgpr_read_b32 v163, a83
    v_accvgpr_read_b32 v164, a84
    v_accvgpr_read_b32 v165, a85
    v_accvgpr_read_b32 v166, a86
    v_accvgpr_read_b32 v167, a87
    v_mul_f32 v160, v160, v230
    v_mul_f32 v161, v161, v230
    v_mul_f32 v162, v162, v230
    v_mul_f32 v163, v163, v230
    v_mul_f32 v164, v164, v230
    v_mul_f32 v165, v165, v230
    v_mul_f32 v166, v166, v230
    v_mul_f32 v167, v167, v230
    v_cvt_pk_bf16_f32 v184, v160, v161
    v_cvt_pk_bf16_f32 v185, v162, v163
    v_cvt_pk_bf16_f32 v186, v164, v165
    v_cvt_pk_bf16_f32 v187, v166, v167
    buffer_store_dwordx4 v[184:187], v240, s[20:23], s40 offen offset:2048 sc1
    v_accvgpr_read_b32 v168, a88
    v_accvgpr_read_b32 v169, a89
    v_accvgpr_read_b32 v170, a90
    v_accvgpr_read_b32 v171, a91
    v_accvgpr_read_b32 v172, a92
    v_accvgpr_read_b32 v173, a93
    v_accvgpr_read_b32 v174, a94
    v_accvgpr_read_b32 v175, a95
    v_mul_f32 v168, v168, v230
    v_mul_f32 v169, v169, v230
    v_mul_f32 v170, v170, v230
    v_mul_f32 v171, v171, v230
    v_mul_f32 v172, v172, v230
    v_mul_f32 v173, v173, v230
    v_mul_f32 v174, v174, v230
    v_mul_f32 v175, v175, v230
    v_cvt_pk_bf16_f32 v188, v168, v169
    v_cvt_pk_bf16_f32 v189, v170, v171
    v_cvt_pk_bf16_f32 v190, v172, v173
    v_cvt_pk_bf16_f32 v191, v174, v175
    buffer_store_dwordx4 v[188:191], v240, s[20:23], s40 offen offset:3072 sc1
    v_accvgpr_read_b32 v160, a96
    v_accvgpr_read_b32 v161, a97
    v_accvgpr_read_b32 v162, a98
    v_accvgpr_read_b32 v163, a99
    v_accvgpr_read_b32 v164, a100
    v_accvgpr_read_b32 v165, a101
    v_accvgpr_read_b32 v166, a102
    v_accvgpr_read_b32 v167, a103
    v_mul_f32 v160, v160, v231
    v_mul_f32 v161, v161, v231
    v_mul_f32 v162, v162, v231
    v_mul_f32 v163, v163, v231
    v_mul_f32 v164, v164, v231
    v_mul_f32 v165, v165, v231
    v_mul_f32 v166, v166, v231
    v_mul_f32 v167, v167, v231
    v_cvt_pk_bf16_f32 v176, v160, v161
    v_cvt_pk_bf16_f32 v177, v162, v163
    v_cvt_pk_bf16_f32 v178, v164, v165
    v_cvt_pk_bf16_f32 v179, v166, v167
    buffer_store_dwordx4 v[176:179], v244, s[20:23], s40 offen offset:0 sc1
    v_accvgpr_read_b32 v168, a104
    v_accvgpr_read_b32 v169, a105
    v_accvgpr_read_b32 v170, a106
    v_accvgpr_read_b32 v171, a107
    v_accvgpr_read_b32 v172, a108
    v_accvgpr_read_b32 v173, a109
    v_accvgpr_read_b32 v174, a110
    v_accvgpr_read_b32 v175, a111
    v_mul_f32 v168, v168, v231
    v_mul_f32 v169, v169, v231
    v_mul_f32 v170, v170, v231
    v_mul_f32 v171, v171, v231
    v_mul_f32 v172, v172, v231
    v_mul_f32 v173, v173, v231
    v_mul_f32 v174, v174, v231
    v_mul_f32 v175, v175, v231
    v_cvt_pk_bf16_f32 v180, v168, v169
    v_cvt_pk_bf16_f32 v181, v170, v171
    v_cvt_pk_bf16_f32 v182, v172, v173
    v_cvt_pk_bf16_f32 v183, v174, v175
    buffer_store_dwordx4 v[180:183], v244, s[20:23], s40 offen offset:1024 sc1
    v_accvgpr_read_b32 v160, a112
    v_accvgpr_read_b32 v161, a113
    v_accvgpr_read_b32 v162, a114
    v_accvgpr_read_b32 v163, a115
    v_accvgpr_read_b32 v164, a116
    v_accvgpr_read_b32 v165, a117
    v_accvgpr_read_b32 v166, a118
    v_accvgpr_read_b32 v167, a119
    v_mul_f32 v160, v160, v231
    v_mul_f32 v161, v161, v231
    v_mul_f32 v162, v162, v231
    v_mul_f32 v163, v163, v231
    v_mul_f32 v164, v164, v231
    v_mul_f32 v165, v165, v231
    v_mul_f32 v166, v166, v231
    v_mul_f32 v167, v167, v231
    v_cvt_pk_bf16_f32 v184, v160, v161
    v_cvt_pk_bf16_f32 v185, v162, v163
    v_cvt_pk_bf16_f32 v186, v164, v165
    v_cvt_pk_bf16_f32 v187, v166, v167
    buffer_store_dwordx4 v[184:187], v244, s[20:23], s40 offen offset:2048 sc1
    v_accvgpr_read_b32 v168, a120
    v_accvgpr_read_b32 v169, a121
    v_accvgpr_read_b32 v170, a122
    v_accvgpr_read_b32 v171, a123
    v_accvgpr_read_b32 v172, a124
    v_accvgpr_read_b32 v173, a125
    v_accvgpr_read_b32 v174, a126
    v_accvgpr_read_b32 v175, a127
    v_mul_f32 v168, v168, v231
    v_mul_f32 v169, v169, v231
    v_mul_f32 v170, v170, v231
    v_mul_f32 v171, v171, v231
    v_mul_f32 v172, v172, v231
    v_mul_f32 v173, v173, v231
    v_mul_f32 v174, v174, v231
    v_mul_f32 v175, v175, v231
    v_cvt_pk_bf16_f32 v188, v168, v169
    v_cvt_pk_bf16_f32 v189, v170, v171
    v_cvt_pk_bf16_f32 v190, v172, v173
    v_cvt_pk_bf16_f32 v191, v174, v175
    buffer_store_dwordx4 v[188:191], v244, s[20:23], s40 offen offset:3072 sc1
    s_sub_u32 s46, s20, 0x2400000
    s_subb_u32 s47, s21, 0
    s_mov_b64 s[42:43], s[56:57]
    s_mov_b64 s[40:41], s[80:81]
    s_mov_b64 s[44:45], s[82:83]
    s_mov_b64 s[60:61], s[84:85]
    s_mov_b64 s[62:63], s[86:87]
    v_mbcnt_lo_u32_b32 v237, -1, 0
    v_mbcnt_hi_u32_b32 v237, -1, v237
    s_lshl_b32 s32, s3, 6
    v_add_u32 v230, s32, v237
    s_lshr_b32 s53, s2, 3
    s_lshr_b32 s6, s2, 1
    s_and_b32 s6, s6, 3
    s_and_b32 s4, s2, 1
    s_lshl_b32 s4, s4, 2
    s_and_b32 s33, s53, 3
    s_add_u32 s4, s4, s33
    s_lshr_b32 s5, s53, 2
    v_lshlrev_b32 v228, 4, v237
    v_lshrrev_b32 v234, 4, v237
    v_and_b32 v235, 15, v237
    v_lshlrev_b32 v236, 1, v234
    v_xor_b32 v235, v235, v236
    v_lshlrev_b32 v234, 11, v234
    s_lshl_b32 s32, s3, 14
    s_lshl_b32 s33, s5, 8
    s_add_u32 s32, s32, s33
    v_add_u32 v234, s32, v234
    v_lshl_add_u32 v224, v235, 4, v234
    v_xor_b32 v235, 8, v235
    v_lshl_add_u32 v225, v235, 4, v234
    v_add_u32 v225, 7168, v225
    s_lshl_b32 s37, s6, 21
    s_lshl_b32 s38, s3, 11
    s_lshl2_add_u32 s4, s4, s3
    s_sub_u32 s32, 63, s4
    s_cmp_lt_u32 s6, 2
    s_cselect_b32 s4, s4, s32
    s_lshl_b32 s32, s4, 18
    v_add_u32 v226, s32, v228
    v_add_u32 v227, 0x20000, v226
    v_xor_b32 v245, 0xfc0000, v226
    v_xor_b32 v246, 0xfc0000, v227
    s_lshl_b32 s35, s6, 15
    s_add_u32 s35, s35, 0x2400000
    s_getpc_b64 s[56:57]
kc_pc0:
    s_mov_b32 s58, kc_end-kc_pc0
    s_mov_b32 s59, 0x00020000
    v_lshlrev_b32 v234, 7, v230
    buffer_load_dword v241, v234, s[56:59], 0 offen
    s_waitcnt lgkmcnt(0)
    s_mov_b32 s8, s46
    s_mov_b32 s9, s47
    s_mov_b32 s10, 0x10000000
    s_mov_b32 s11, 0x00020000
    s_mov_b32 s12, s42
    s_mov_b32 s13, s43
    s_mov_b32 s14, 0x800000
    s_mov_b32 s15, 0x00020000
    s_mov_b32 s16, s40
    s_mov_b32 s17, s41
    s_mov_b32 s18, 0x400000
    s_mov_b32 s19, 0x00020000
    s_mov_b32 s20, s44
    s_mov_b32 s21, s45
    s_mov_b32 s22, 0x800
    s_mov_b32 s23, 0x00020000
    s_mov_b32 s24, s60
    s_mov_b32 s25, s61
    s_mov_b32 s26, 0x700000
    s_mov_b32 s27, 0x00020000
    s_mov_b32 s28, s62
    s_mov_b32 s29, s63
    s_mov_b32 s30, 0x400000
    s_mov_b32 s31, 0x00020000
    s_lshr_b32 s44, s6, 1
    s_and_b32 s6, s6, 1
    v_bfe_u32 v234, v237, 2, 3
    v_lshrrev_b32 v235, 5, v237
    v_lshl_add_u32 v235, v235, 4, v234
    v_lshlrev_b32 v235, 8, v235
    v_and_b32 v236, 1, v237
    v_lshl_add_u32 v235, v236, 3, v235
    v_lshlrev_b32 v234, 1, v234
    v_bfe_u32 v236, v237, 1, 1
    v_or_b32 v234, v234, v236
    s_lshl_b32 s32, s6, 3
    v_xor_b32 v234, s32, v234
    v_xor_b32 v236, 0, v234
    v_lshl_add_u32 v216, v236, 4, v235
    v_xor_b32 v236, 2, v234
    v_lshl_add_u32 v217, v236, 4, v235
    v_xor_b32 v236, 4, v234
    v_lshl_add_u32 v218, v236, 4, v235
    v_xor_b32 v236, 6, v234
    v_lshl_add_u32 v219, v236, 4, v235
    v_xor_b32 v236, 8, v234
    v_lshl_add_u32 v220, v236, 4, v235
    v_xor_b32 v236, 10, v234
    v_lshl_add_u32 v221, v236, 4, v235
    v_xor_b32 v236, 12, v234
    v_lshl_add_u32 v222, v236, 4, v235
    v_xor_b32 v236, 14, v234
    v_lshl_add_u32 v223, v236, 4, v235
    s_lshl_b32 s44, s4, 5
    v_lshrrev_b32 v234, 3, v237
    v_add_u32 v242, s44, v234
    v_and_b32 v235, 7, v237
    s_lshl1_add_u32 s33, s5, s6
    s_lshl_b32 s33, s33, 7
    v_lshl_add_u32 v240, v235, 4, s33
    v_lshl_add_u32 v229, v242, 11, v240
    s_mul_i32 s32, s3, 4608
    s_add_u32 s32, s32, 131072
    v_mul_u32_u24 v234, 144, v234
    v_lshl_add_u32 v234, v235, 4, v234
    v_add_u32 v239, s32, v234
    v_and_b32 v234, 15, v237
    v_mul_u32_u24 v234, 144, v234
    v_lshrrev_b32 v236, 4, v237
    v_lshl_add_u32 v234, v236, 3, v234
    v_add_u32 v238, s32, v234
    v_and_b32 v234, 3, v237
    v_lshl_add_u32 v234, v234, 3, v242
    v_lshlrev_b32 v234, 2, v234
    v_lshrrev_b32 v235, 2, v235
    v_lshl_add_u32 v231, v235, 13, v234
    v_lshlrev_b32 v235, 30, v235
    v_add_u32 v235, 16384, v235
    v_add_u32 v232, v235, v234
    s_cmp_eq_u32 s44, 0
    s_cselect_b32 s32, 4, 64
    v_cmp_eq_u32 vcc, s32, v237
    v_mov_b32 v235, 24576
    v_mov_b32 v233, 1
    v_cndmask_b32 v232, v232, v235, vcc
    v_and_b32 v234, 1, v237
    v_cmp_ne_u32 s[60:61], 0, v234
    v_and_b32 v234, 2, v237
    v_cmp_ne_u32 s[62:63], 0, v234
    v_and_b32 v234, 4, v237
    v_cmp_ne_u32 s[40:41], 0, v234
    v_cmp_eq_u32 vcc, 0, v237
    v_mov_b32 v235, 0x40000000
    s_nop 0
    v_cndmask_b32 v243, v235, v237, vcc
    s_lshl2_add_u32 s39, s2, s3
    s_mov_b32 s48, 0x3800000
    s_mov_b32 s49, 0x3802000
    s_mov_b32 s50, 0x3804000
    s_and_b32 s52, s2, 7
    s_mul_i32 s54, s52, 28
    s_add_u32 s54, s54, s53
    v_lshrrev_b32 v234, 3, v237
    v_lshlrev_b32 v234, 11, v234
    v_and_b32 v235, 7, v237
    v_lshl_add_u32 v244, v235, 4, v234
    s_lshl_b32 s55, s54, 16
    s_lshl_b32 s32, s3, 13
    s_add_u32 s55, s55, s32
    s_add_u32 s55, s55, 0x4000000
    s_lshl_b32 s51, s54, 15
    s_lshl_b32 s32, s3, 9
    s_add_u32 s51, s51, s32
    s_cmp_ge_u32 s53, 28
    s_cselect_b32 s55, 0x40000000, s55
    s_cselect_b32 s51, 0x40000000, s51
    s_lshr_b32 s32, s2, 5
    s_lshl_b32 s32, s32, 9
    s_and_b32 s33, s2, 6
    s_lshl_b32 s33, s33, 6
    s_add_u32 s32, s32, s33
    s_add_u32 s32, s32, 0x38a4000
    s_waitcnt vmcnt(0)
    s_barrier
    s_cmp_lg_u32 s3, 0
    s_cbranch_scc1 kc_a0
    buffer_atomic_add v233, v243, s[8:11], s32 offen sc1
    s_lshl_b32 s32, s52, 7
    s_add_u32 s32, s32, 0x38a1000
    v_mov_b32 v235, 1
    buffer_atomic_add v235, v243, s[8:11], s32 offen sc0 sc1
    v_lshlrev_b32 v234, 7, v237
    v_cmp_gt_u32 vcc, 8, v237
    v_mov_b32 v236, 0x40000000
    s_mov_b32 s34, 0x38a1400
    v_cndmask_b32 v234, v236, v234, vcc
    s_waitcnt vmcnt(0)
    v_readfirstlane_b32 s36, v235
    s_cmp_lg_u32 s36, 31
    s_cbranch_scc1 kc_a0
    buffer_atomic_add v233, v234, s[8:11], s34 offen sc1
kc_a0:
    s_add_u32 m0, s38, 0
    s_add_u32 s32, s37, 0
    buffer_load_dwordx4 v224, s[12:15], s32 offen lds
    buffer_load_dwordx4 v225, s[12:15], s32 offen offset:1024 lds
    s_add_u32 m0, s38, 8192
    s_add_u32 s32, s37, 65536
    buffer_load_dwordx4 v224, s[12:15], s32 offen lds
    buffer_load_dwordx4 v225, s[12:15], s32 offen offset:1024 lds
    s_add_u32 m0, s38, 16384
    s_add_u32 s32, s37, 131072
    buffer_load_dwordx4 v224, s[12:15], s32 offen lds
    buffer_load_dwordx4 v225, s[12:15], s32 offen offset:1024 lds
    s_add_u32 m0, s38, 24576
    s_add_u32 s32, s37, 196608
    buffer_load_dwordx4 v224, s[12:15], s32 offen lds
    buffer_load_dwordx4 v225, s[12:15], s32 offen offset:1024 lds
    s_add_u32 m0, s38, 32768
    s_add_u32 s32, s37, 262144
    buffer_load_dwordx4 v224, s[12:15], s32 offen lds
    buffer_load_dwordx4 v225, s[12:15], s32 offen offset:1024 lds
    s_add_u32 m0, s38, 40960
    s_add_u32 s32, s37, 327680
    buffer_load_dwordx4 v224, s[12:15], s32 offen lds
    buffer_load_dwordx4 v225, s[12:15], s32 offen offset:1024 lds
    s_add_u32 m0, s38, 49152
    s_add_u32 s32, s37, 393216
    buffer_load_dwordx4 v224, s[12:15], s32 offen lds
    buffer_load_dwordx4 v225, s[12:15], s32 offen offset:1024 lds
    s_add_u32 m0, s38, 57344
    s_add_u32 s32, s37, 458752
    buffer_load_dwordx4 v224, s[12:15], s32 offen lds
    buffer_load_dwordx4 v225, s[12:15], s32 offen offset:1024 lds
    s_add_u32 m0, s38, 65536
    s_add_u32 s32, s37, 524288
    buffer_load_dwordx4 v224, s[12:15], s32 offen lds
    buffer_load_dwordx4 v225, s[12:15], s32 offen offset:1024 lds
    s_add_u32 m0, s38, 73728
    s_add_u32 s32, s37, 589824
    buffer_load_dwordx4 v224, s[12:15], s32 offen lds
    buffer_load_dwordx4 v225, s[12:15], s32 offen offset:1024 lds
    s_add_u32 m0, s38, 81920
    s_add_u32 s32, s37, 655360
    buffer_load_dwordx4 v224, s[12:15], s32 offen lds
    buffer_load_dwordx4 v225, s[12:15], s32 offen offset:1024 lds
    s_add_u32 m0, s38, 90112
    s_add_u32 s32, s37, 720896
    buffer_load_dwordx4 v224, s[12:15], s32 offen lds
    buffer_load_dwordx4 v225, s[12:15], s32 offen offset:1024 lds
    s_add_u32 m0, s38, 98304
    s_add_u32 s32, s37, 786432
    buffer_load_dwordx4 v224, s[12:15], s32 offen lds
    buffer_load_dwordx4 v225, s[12:15], s32 offen offset:1024 lds
    s_add_u32 m0, s38, 106496
    s_add_u32 s32, s37, 851968
    buffer_load_dwordx4 v224, s[12:15], s32 offen lds
    buffer_load_dwordx4 v225, s[12:15], s32 offen offset:1024 lds
    s_add_u32 m0, s38, 114688
    s_add_u32 s32, s37, 917504
    buffer_load_dwordx4 v224, s[12:15], s32 offen lds
    buffer_load_dwordx4 v225, s[12:15], s32 offen offset:1024 lds
    s_add_u32 m0, s38, 122880
    s_add_u32 s32, s37, 983040
    buffer_load_dwordx4 v224, s[12:15], s32 offen lds
    buffer_load_dwordx4 v225, s[12:15], s32 offen offset:1024 lds
    s_add_u32 s33, s51, 0
    buffer_load_dwordx4 a[192:195], v244, s[24:27], s33 offen offset:0
    s_add_u32 s33, s51, 16384
    buffer_load_dwordx4 a[196:199], v244, s[24:27], s33 offen offset:0
    s_add_u32 s33, s51, 0
    buffer_load_dwordx4 a[200:203], v244, s[24:27], s33 offen offset:128
    s_add_u32 s33, s51, 16384
    buffer_load_dwordx4 a[204:207], v244, s[24:27], s33 offen offset:128
    s_add_u32 s33, s51, 0
    buffer_load_dwordx4 a[208:211], v244, s[24:27], s33 offen offset:256
    s_add_u32 s33, s51, 16384
    buffer_load_dwordx4 a[212:215], v244, s[24:27], s33 offen offset:256
    s_add_u32 s33, s51, 0
    buffer_load_dwordx4 a[216:219], v244, s[24:27], s33 offen offset:384
    s_add_u32 s33, s51, 16384
    buffer_load_dwordx4 a[220:223], v244, s[24:27], s33 offen offset:384
    s_cmp_lg_u32 s3, 0
    s_cbranch_scc1 kc_b03
    s_and_b32 s32, s2, 1
    s_lshl_b32 s32, s32, 2
    s_and_b32 s33, s53, 3
    s_add_u32 s32, s32, s33
    s_lshl_b32 s32, s32, 9
    s_and_b32 s33, s2, 6
    s_lshl_b32 s33, s33, 6
    s_add_u32 s32, s32, s33
    s_add_u32 s32, s32, 0x38a4000
    s_mov_b32 s34, 0x400000
    s_branch kc_b01
kc_b00:
    s_sleep 2
kc_b01:
    buffer_load_dword v235, off, s[8:11], s32 sc1
    s_waitcnt vmcnt(0)
    v_cmp_ne_u32 vcc, 8, v235
    s_sub_u32 s34, s34, 1
    s_cbranch_scc1 kc_b02
    s_cbranch_vccnz kc_b00
kc_b02:
kc_b03:
    s_waitcnt vmcnt(8)
    s_barrier
    buffer_load_dwordx4 a[0:3], v226, s[8:11], s35 offen offset:0 sc1
    buffer_load_dwordx4 a[4:7], v227, s[8:11], s35 offen offset:0 sc1
    buffer_load_dwordx4 a[8:11], v245, s[8:11], s35 offen offset:0 sc1
    buffer_load_dwordx4 a[12:15], v246, s[8:11], s35 offen offset:0 sc1
    buffer_load_dwordx4 a[16:19], v226, s[8:11], s35 offen offset:1024 sc1
    buffer_load_dwordx4 a[20:23], v227, s[8:11], s35 offen offset:1024 sc1
    buffer_load_dwordx4 a[24:27], v245, s[8:11], s35 offen offset:1024 sc1
    buffer_load_dwordx4 a[28:31], v246, s[8:11], s35 offen offset:1024 sc1
    buffer_load_dwordx4 a[32:35], v226, s[8:11], s35 offen offset:2048 sc1
    buffer_load_dwordx4 a[36:39], v227, s[8:11], s35 offen offset:2048 sc1
    buffer_load_dwordx4 a[40:43], v245, s[8:11], s35 offen offset:2048 sc1
    buffer_load_dwordx4 a[44:47], v246, s[8:11], s35 offen offset:2048 sc1
    buffer_load_dwordx4 a[48:51], v226, s[8:11], s35 offen offset:3072 sc1
    buffer_load_dwordx4 a[52:55], v227, s[8:11], s35 offen offset:3072 sc1
    buffer_load_dwordx4 a[56:59], v245, s[8:11], s35 offen offset:3072 sc1
    buffer_load_dwordx4 a[60:63], v246, s[8:11], s35 offen offset:3072 sc1
    ds_read_b64_tr_b16 v[128:129], v216 offset:0
    ds_read_b64_tr_b16 v[130:131], v216 offset:2048
    ds_read_b64_tr_b16 v[132:133], v217 offset:0
    ds_read_b64_tr_b16 v[134:135], v217 offset:2048
    ds_read_b64_tr_b16 v[136:137], v218 offset:0
    ds_read_b64_tr_b16 v[138:139], v218 offset:2048
    ds_read_b64_tr_b16 v[140:141], v219 offset:0
    ds_read_b64_tr_b16 v[142:143], v219 offset:2048
    s_waitcnt vmcnt(12) lgkmcnt(0)
    v_mfma_f32_16x16x32_bf16 v[32:35], v[128:131], a[0:3], 0
    ds_read_b64_tr_b16 v[144:145], v220 offset:0
    v_mfma_f32_16x16x32_bf16 v[36:39], v[128:131], a[4:7], 0
    ds_read_b64_tr_b16 v[146:147], v220 offset:2048
    v_mfma_f32_16x16x32_bf16 v[64:67], v[128:131], a[8:11], 0
    ds_read_b64_tr_b16 v[148:149], v221 offset:0
    v_mfma_f32_16x16x32_bf16 v[68:71], v[128:131], a[12:15], 0
    ds_read_b64_tr_b16 v[150:151], v221 offset:2048
    v_mfma_f32_16x16x32_bf16 v[40:43], v[132:135], a[0:3], 0
    ds_read_b64_tr_b16 v[152:153], v222 offset:0
    v_mfma_f32_16x16x32_bf16 v[44:47], v[132:135], a[4:7], 0
    ds_read_b64_tr_b16 v[154:155], v222 offset:2048
    v_mfma_f32_16x16x32_bf16 v[72:75], v[132:135], a[8:11], 0
    ds_read_b64_tr_b16 v[156:157], v223 offset:0
    v_mfma_f32_16x16x32_bf16 v[76:79], v[132:135], a[12:15], 0
    ds_read_b64_tr_b16 v[158:159], v223 offset:2048
    v_mfma_f32_16x16x32_bf16 v[48:51], v[136:139], a[0:3], 0
    s_add_u32 s35, s35, 4096
    buffer_load_dwordx4 a[64:67], v226, s[8:11], s35 offen offset:0 sc1
    v_mfma_f32_16x16x32_bf16 v[52:55], v[136:139], a[4:7], 0
    v_mfma_f32_16x16x32_bf16 v[80:83], v[136:139], a[8:11], 0
    v_mfma_f32_16x16x32_bf16 v[84:87], v[136:139], a[12:15], 0
    buffer_load_dwordx4 a[68:71], v227, s[8:11], s35 offen offset:0 sc1
    v_mfma_f32_16x16x32_bf16 v[56:59], v[140:143], a[0:3], 0
    v_mfma_f32_16x16x32_bf16 v[60:63], v[140:143], a[4:7], 0
    v_mfma_f32_16x16x32_bf16 v[88:91], v[140:143], a[8:11], 0
    v_mfma_f32_16x16x32_bf16 v[92:95], v[140:143], a[12:15], 0
    s_waitcnt lgkmcnt(0)
    v_mfma_f32_16x16x32_bf16 v[0:3], v[144:147], a[0:3], 0
    ds_read_b64_tr_b16 v[128:129], v216 offset:8192
    v_mfma_f32_16x16x32_bf16 v[4:7], v[144:147], a[4:7], 0
    ds_read_b64_tr_b16 v[130:131], v216 offset:10240
    v_mfma_f32_16x16x32_bf16 v[96:99], v[144:147], a[8:11], 0
    ds_read_b64_tr_b16 v[132:133], v217 offset:8192
    v_mfma_f32_16x16x32_bf16 v[100:103], v[144:147], a[12:15], 0
    ds_read_b64_tr_b16 v[134:135], v217 offset:10240
    v_mfma_f32_16x16x32_bf16 v[8:11], v[148:151], a[0:3], 0
    ds_read_b64_tr_b16 v[136:137], v218 offset:8192
    v_mfma_f32_16x16x32_bf16 v[12:15], v[148:151], a[4:7], 0
    ds_read_b64_tr_b16 v[138:139], v218 offset:10240
    v_mfma_f32_16x16x32_bf16 v[104:107], v[148:151], a[8:11], 0
    ds_read_b64_tr_b16 v[140:141], v219 offset:8192
    v_mfma_f32_16x16x32_bf16 v[108:111], v[148:151], a[12:15], 0
    ds_read_b64_tr_b16 v[142:143], v219 offset:10240
    v_mfma_f32_16x16x32_bf16 v[16:19], v[152:155], a[0:3], 0
    buffer_load_dwordx4 a[72:75], v245, s[8:11], s35 offen offset:0 sc1
    v_mfma_f32_16x16x32_bf16 v[20:23], v[152:155], a[4:7], 0
    v_mfma_f32_16x16x32_bf16 v[112:115], v[152:155], a[8:11], 0
    v_mfma_f32_16x16x32_bf16 v[116:119], v[152:155], a[12:15], 0
    v_mfma_f32_16x16x32_bf16 v[24:27], v[156:159], a[0:3], 0
    buffer_load_dwordx4 a[76:79], v246, s[8:11], s35 offen offset:0 sc1
    v_mfma_f32_16x16x32_bf16 v[28:31], v[156:159], a[4:7], 0
    v_mfma_f32_16x16x32_bf16 v[120:123], v[156:159], a[8:11], 0
    v_mfma_f32_16x16x32_bf16 v[124:127], v[156:159], a[12:15], 0
    buffer_load_dwordx4 a[80:83], v226, s[8:11], s35 offen offset:1024 sc1
    s_waitcnt vmcnt(13) lgkmcnt(0)
    v_mfma_f32_16x16x32_bf16 v[32:35], v[128:131], a[16:19], v[32:35]
    ds_read_b64_tr_b16 v[144:145], v220 offset:8192
    v_mfma_f32_16x16x32_bf16 v[36:39], v[128:131], a[20:23], v[36:39]
    ds_read_b64_tr_b16 v[146:147], v220 offset:10240
    v_mfma_f32_16x16x32_bf16 v[64:67], v[128:131], a[24:27], v[64:67]
    ds_read_b64_tr_b16 v[148:149], v221 offset:8192
    v_mfma_f32_16x16x32_bf16 v[68:71], v[128:131], a[28:31], v[68:71]
    ds_read_b64_tr_b16 v[150:151], v221 offset:10240
    v_mfma_f32_16x16x32_bf16 v[40:43], v[132:135], a[16:19], v[40:43]
    ds_read_b64_tr_b16 v[152:153], v222 offset:8192
    v_mfma_f32_16x16x32_bf16 v[44:47], v[132:135], a[20:23], v[44:47]
    ds_read_b64_tr_b16 v[154:155], v222 offset:10240
    v_mfma_f32_16x16x32_bf16 v[72:75], v[132:135], a[24:27], v[72:75]
    ds_read_b64_tr_b16 v[156:157], v223 offset:8192
    v_mfma_f32_16x16x32_bf16 v[76:79], v[132:135], a[28:31], v[76:79]
    ds_read_b64_tr_b16 v[158:159], v223 offset:10240
    v_mfma_f32_16x16x32_bf16 v[48:51], v[136:139], a[16:19], v[48:51]
    buffer_load_dwordx4 a[84:87], v227, s[8:11], s35 offen offset:1024 sc1
    v_mfma_f32_16x16x32_bf16 v[52:55], v[136:139], a[20:23], v[52:55]
    v_mfma_f32_16x16x32_bf16 v[80:83], v[136:139], a[24:27], v[80:83]
    v_mfma_f32_16x16x32_bf16 v[84:87], v[136:139], a[28:31], v[84:87]
    buffer_load_dwordx4 a[88:91], v245, s[8:11], s35 offen offset:1024 sc1
    v_mfma_f32_16x16x32_bf16 v[56:59], v[140:143], a[16:19], v[56:59]
    v_mfma_f32_16x16x32_bf16 v[60:63], v[140:143], a[20:23], v[60:63]
    v_mfma_f32_16x16x32_bf16 v[88:91], v[140:143], a[24:27], v[88:91]
    v_mfma_f32_16x16x32_bf16 v[92:95], v[140:143], a[28:31], v[92:95]
    s_waitcnt lgkmcnt(0)
    v_mfma_f32_16x16x32_bf16 v[0:3], v[144:147], a[16:19], v[0:3]
    ds_read_b64_tr_b16 v[128:129], v216 offset:16384
    v_mfma_f32_16x16x32_bf16 v[4:7], v[144:147], a[20:23], v[4:7]
    ds_read_b64_tr_b16 v[130:131], v216 offset:18432
    v_mfma_f32_16x16x32_bf16 v[96:99], v[144:147], a[24:27], v[96:99]
    ds_read_b64_tr_b16 v[132:133], v217 offset:16384
    v_mfma_f32_16x16x32_bf16 v[100:103], v[144:147], a[28:31], v[100:103]
    ds_read_b64_tr_b16 v[134:135], v217 offset:18432
    v_mfma_f32_16x16x32_bf16 v[8:11], v[148:151], a[16:19], v[8:11]
    ds_read_b64_tr_b16 v[136:137], v218 offset:16384
    v_mfma_f32_16x16x32_bf16 v[12:15], v[148:151], a[20:23], v[12:15]
    ds_read_b64_tr_b16 v[138:139], v218 offset:18432
    v_mfma_f32_16x16x32_bf16 v[104:107], v[148:151], a[24:27], v[104:107]
    ds_read_b64_tr_b16 v[140:141], v219 offset:16384
    v_mfma_f32_16x16x32_bf16 v[108:111], v[148:151], a[28:31], v[108:111]
    ds_read_b64_tr_b16 v[142:143], v219 offset:18432
    v_mfma_f32_16x16x32_bf16 v[16:19], v[152:155], a[16:19], v[16:19]
    buffer_load_dwordx4 a[92:95], v246, s[8:11], s35 offen offset:1024 sc1
    v_mfma_f32_16x16x32_bf16 v[20:23], v[152:155], a[20:23], v[20:23]
    v_mfma_f32_16x16x32_bf16 v[112:115], v[152:155], a[24:27], v[112:115]
    v_mfma_f32_16x16x32_bf16 v[116:119], v[152:155], a[28:31], v[116:119]
    v_mfma_f32_16x16x32_bf16 v[24:27], v[156:159], a[16:19], v[24:27]
    buffer_load_dwordx4 a[96:99], v226, s[8:11], s35 offen offset:2048 sc1
    v_mfma_f32_16x16x32_bf16 v[28:31], v[156:159], a[20:23], v[28:31]
    v_mfma_f32_16x16x32_bf16 v[120:123], v[156:159], a[24:27], v[120:123]
    v_mfma_f32_16x16x32_bf16 v[124:127], v[156:159], a[28:31], v[124:127]
    s_waitcnt vmcnt(13) lgkmcnt(0)
    v_mfma_f32_16x16x32_bf16 v[32:35], v[128:131], a[32:35], v[32:35]
    ds_read_b64_tr_b16 v[144:145], v220 offset:16384
    v_mfma_f32_16x16x32_bf16 v[36:39], v[128:131], a[36:39], v[36:39]
    ds_read_b64_tr_b16 v[146:147], v220 offset:18432
    v_mfma_f32_16x16x32_bf16 v[64:67], v[128:131], a[40:43], v[64:67]
    ds_read_b64_tr_b16 v[148:149], v221 offset:16384
    v_mfma_f32_16x16x32_bf16 v[68:71], v[128:131], a[44:47], v[68:71]
    ds_read_b64_tr_b16 v[150:151], v221 offset:18432
    v_mfma_f32_16x16x32_bf16 v[40:43], v[132:135], a[32:35], v[40:43]
    ds_read_b64_tr_b16 v[152:153], v222 offset:16384
    v_mfma_f32_16x16x32_bf16 v[44:47], v[132:135], a[36:39], v[44:47]
    ds_read_b64_tr_b16 v[154:155], v222 offset:18432
    v_mfma_f32_16x16x32_bf16 v[72:75], v[132:135], a[40:43], v[72:75]
    ds_read_b64_tr_b16 v[156:157], v223 offset:16384
    v_mfma_f32_16x16x32_bf16 v[76:79], v[132:135], a[44:47], v[76:79]
    ds_read_b64_tr_b16 v[158:159], v223 offset:18432
    v_mfma_f32_16x16x32_bf16 v[48:51], v[136:139], a[32:35], v[48:51]
    buffer_load_dwordx4 a[100:103], v227, s[8:11], s35 offen offset:2048 sc1
    v_mfma_f32_16x16x32_bf16 v[52:55], v[136:139], a[36:39], v[52:55]
    v_mfma_f32_16x16x32_bf16 v[80:83], v[136:139], a[40:43], v[80:83]
    v_mfma_f32_16x16x32_bf16 v[84:87], v[136:139], a[44:47], v[84:87]
    buffer_load_dwordx4 a[104:107], v245, s[8:11], s35 offen offset:2048 sc1
    v_mfma_f32_16x16x32_bf16 v[56:59], v[140:143], a[32:35], v[56:59]
    v_mfma_f32_16x16x32_bf16 v[60:63], v[140:143], a[36:39], v[60:63]
    v_mfma_f32_16x16x32_bf16 v[88:91], v[140:143], a[40:43], v[88:91]
    v_mfma_f32_16x16x32_bf16 v[92:95], v[140:143], a[44:47], v[92:95]
    s_waitcnt lgkmcnt(0)
    v_mfma_f32_16x16x32_bf16 v[0:3], v[144:147], a[32:35], v[0:3]
    ds_read_b64_tr_b16 v[128:129], v216 offset:24576
    v_mfma_f32_16x16x32_bf16 v[4:7], v[144:147], a[36:39], v[4:7]
    ds_read_b64_tr_b16 v[130:131], v216 offset:26624
    v_mfma_f32_16x16x32_bf16 v[96:99], v[144:147], a[40:43], v[96:99]
    ds_read_b64_tr_b16 v[132:133], v217 offset:24576
    v_mfma_f32_16x16x32_bf16 v[100:103], v[144:147], a[44:47], v[100:103]
    ds_read_b64_tr_b16 v[134:135], v217 offset:26624
    v_mfma_f32_16x16x32_bf16 v[8:11], v[148:151], a[32:35], v[8:11]
    ds_read_b64_tr_b16 v[136:137], v218 offset:24576
    v_mfma_f32_16x16x32_bf16 v[12:15], v[148:151], a[36:39], v[12:15]
    ds_read_b64_tr_b16 v[138:139], v218 offset:26624
    v_mfma_f32_16x16x32_bf16 v[104:107], v[148:151], a[40:43], v[104:107]
    ds_read_b64_tr_b16 v[140:141], v219 offset:24576
    v_mfma_f32_16x16x32_bf16 v[108:111], v[148:151], a[44:47], v[108:111]
    ds_read_b64_tr_b16 v[142:143], v219 offset:26624
    v_mfma_f32_16x16x32_bf16 v[16:19], v[152:155], a[32:35], v[16:19]
    buffer_load_dwordx4 a[108:111], v246, s[8:11], s35 offen offset:2048 sc1
    v_mfma_f32_16x16x32_bf16 v[20:23], v[152:155], a[36:39], v[20:23]
    v_mfma_f32_16x16x32_bf16 v[112:115], v[152:155], a[40:43], v[112:115]
    v_mfma_f32_16x16x32_bf16 v[116:119], v[152:155], a[44:47], v[116:119]
    v_mfma_f32_16x16x32_bf16 v[24:27], v[156:159], a[32:35], v[24:27]
    buffer_load_dwordx4 a[112:115], v226, s[8:11], s35 offen offset:3072 sc1
    v_mfma_f32_16x16x32_bf16 v[28:31], v[156:159], a[36:39], v[28:31]
    v_mfma_f32_16x16x32_bf16 v[120:123], v[156:159], a[40:43], v[120:123]
    v_mfma_f32_16x16x32_bf16 v[124:127], v[156:159], a[44:47], v[124:127]
    buffer_load_dwordx4 a[116:119], v227, s[8:11], s35 offen offset:3072 sc1
    s_waitcnt vmcnt(14) lgkmcnt(0)
    v_mfma_f32_16x16x32_bf16 v[32:35], v[128:131], a[48:51], v[32:35]
    ds_read_b64_tr_b16 v[144:145], v220 offset:24576
    v_mfma_f32_16x16x32_bf16 v[36:39], v[128:131], a[52:55], v[36:39]
    ds_read_b64_tr_b16 v[146:147], v220 offset:26624
    v_mfma_f32_16x16x32_bf16 v[64:67], v[128:131], a[56:59], v[64:67]
    ds_read_b64_tr_b16 v[148:149], v221 offset:24576
    v_mfma_f32_16x16x32_bf16 v[68:71], v[128:131], a[60:63], v[68:71]
    ds_read_b64_tr_b16 v[150:151], v221 offset:26624
    v_mfma_f32_16x16x32_bf16 v[40:43], v[132:135], a[48:51], v[40:43]
    ds_read_b64_tr_b16 v[152:153], v222 offset:24576
    v_mfma_f32_16x16x32_bf16 v[44:47], v[132:135], a[52:55], v[44:47]
    ds_read_b64_tr_b16 v[154:155], v222 offset:26624
    v_mfma_f32_16x16x32_bf16 v[72:75], v[132:135], a[56:59], v[72:75]
    ds_read_b64_tr_b16 v[156:157], v223 offset:24576
    v_mfma_f32_16x16x32_bf16 v[76:79], v[132:135], a[60:63], v[76:79]
    ds_read_b64_tr_b16 v[158:159], v223 offset:26624
    v_mfma_f32_16x16x32_bf16 v[48:51], v[136:139], a[48:51], v[48:51]
    buffer_load_dwordx4 a[120:123], v245, s[8:11], s35 offen offset:3072 sc1
    v_mfma_f32_16x16x32_bf16 v[52:55], v[136:139], a[52:55], v[52:55]
    v_mfma_f32_16x16x32_bf16 v[80:83], v[136:139], a[56:59], v[80:83]
    v_mfma_f32_16x16x32_bf16 v[84:87], v[136:139], a[60:63], v[84:87]
    buffer_load_dwordx4 a[124:127], v246, s[8:11], s35 offen offset:3072 sc1
    v_mfma_f32_16x16x32_bf16 v[56:59], v[140:143], a[48:51], v[56:59]
    v_mfma_f32_16x16x32_bf16 v[60:63], v[140:143], a[52:55], v[60:63]
    v_mfma_f32_16x16x32_bf16 v[88:91], v[140:143], a[56:59], v[88:91]
    v_mfma_f32_16x16x32_bf16 v[92:95], v[140:143], a[60:63], v[92:95]
    s_waitcnt lgkmcnt(0)
    s_barrier
    v_mfma_f32_16x16x32_bf16 v[0:3], v[144:147], a[48:51], v[0:3]
    ds_read_b64_tr_b16 v[128:129], v216 offset:32768
    v_mfma_f32_16x16x32_bf16 v[4:7], v[144:147], a[52:55], v[4:7]
    ds_read_b64_tr_b16 v[130:131], v216 offset:34816
    v_mfma_f32_16x16x32_bf16 v[96:99], v[144:147], a[56:59], v[96:99]
    ds_read_b64_tr_b16 v[132:133], v217 offset:32768
    v_mfma_f32_16x16x32_bf16 v[100:103], v[144:147], a[60:63], v[100:103]
    ds_read_b64_tr_b16 v[134:135], v217 offset:34816
    v_mfma_f32_16x16x32_bf16 v[8:11], v[148:151], a[48:51], v[8:11]
    ds_read_b64_tr_b16 v[136:137], v218 offset:32768
    v_mfma_f32_16x16x32_bf16 v[12:15], v[148:151], a[52:55], v[12:15]
    ds_read_b64_tr_b16 v[138:139], v218 offset:34816
    v_mfma_f32_16x16x32_bf16 v[104:107], v[148:151], a[56:59], v[104:107]
    ds_read_b64_tr_b16 v[140:141], v219 offset:32768
    v_mfma_f32_16x16x32_bf16 v[108:111], v[148:151], a[60:63], v[108:111]
    ds_read_b64_tr_b16 v[142:143], v219 offset:34816
    v_mfma_f32_16x16x32_bf16 v[16:19], v[152:155], a[48:51], v[16:19]
    s_add_u32 s35, s35, 4096
    buffer_load_dwordx4 a[0:3], v226, s[8:11], s35 offen offset:0 sc1
    v_mfma_f32_16x16x32_bf16 v[20:23], v[152:155], a[52:55], v[20:23]
    v_mfma_f32_16x16x32_bf16 v[112:115], v[152:155], a[56:59], v[112:115]
    v_mfma_f32_16x16x32_bf16 v[116:119], v[152:155], a[60:63], v[116:119]
    v_mfma_f32_16x16x32_bf16 v[24:27], v[156:159], a[48:51], v[24:27]
    buffer_load_dwordx4 a[4:7], v227, s[8:11], s35 offen offset:0 sc1
    v_mfma_f32_16x16x32_bf16 v[28:31], v[156:159], a[52:55], v[28:31]
    v_mfma_f32_16x16x32_bf16 v[120:123], v[156:159], a[56:59], v[120:123]
    v_mfma_f32_16x16x32_bf16 v[124:127], v[156:159], a[60:63], v[124:127]
    s_waitcnt vmcnt(14) lgkmcnt(0)
    v_mfma_f32_16x16x32_bf16 v[32:35], v[128:131], a[64:67], v[32:35]
    ds_read_b64_tr_b16 v[144:145], v220 offset:32768
    v_mfma_f32_16x16x32_bf16 v[36:39], v[128:131], a[68:71], v[36:39]
    ds_read_b64_tr_b16 v[146:147], v220 offset:34816
    v_mfma_f32_16x16x32_bf16 v[64:67], v[128:131], a[72:75], v[64:67]
    ds_read_b64_tr_b16 v[148:149], v221 offset:32768
    v_mfma_f32_16x16x32_bf16 v[68:71], v[128:131], a[76:79], v[68:71]
    ds_read_b64_tr_b16 v[150:151], v221 offset:34816
    v_mfma_f32_16x16x32_bf16 v[40:43], v[132:135], a[64:67], v[40:43]
    ds_read_b64_tr_b16 v[152:153], v222 offset:32768
    v_mfma_f32_16x16x32_bf16 v[44:47], v[132:135], a[68:71], v[44:47]
    ds_read_b64_tr_b16 v[154:155], v222 offset:34816
    v_mfma_f32_16x16x32_bf16 v[72:75], v[132:135], a[72:75], v[72:75]
    ds_read_b64_tr_b16 v[156:157], v223 offset:32768
    v_mfma_f32_16x16x32_bf16 v[76:79], v[132:135], a[76:79], v[76:79]
    ds_read_b64_tr_b16 v[158:159], v223 offset:34816
    v_mfma_f32_16x16x32_bf16 v[48:51], v[136:139], a[64:67], v[48:51]
    buffer_load_dwordx4 a[8:11], v245, s[8:11], s35 offen offset:0 sc1
    v_mfma_f32_16x16x32_bf16 v[52:55], v[136:139], a[68:71], v[52:55]
    s_add_u32 m0, s38, 0
    s_add_u32 s32, s37, 1048576
    v_mfma_f32_16x16x32_bf16 v[80:83], v[136:139], a[72:75], v[80:83]
    buffer_load_dwordx4 v224, s[12:15], s32 offen lds
    v_mfma_f32_16x16x32_bf16 v[84:87], v[136:139], a[76:79], v[84:87]
    buffer_load_dwordx4 a[12:15], v246, s[8:11], s35 offen offset:0 sc1
    v_mfma_f32_16x16x32_bf16 v[56:59], v[140:143], a[64:67], v[56:59]
    v_mfma_f32_16x16x32_bf16 v[60:63], v[140:143], a[68:71], v[60:63]
    buffer_load_dwordx4 v225, s[12:15], s32 offen offset:1024 lds
    v_mfma_f32_16x16x32_bf16 v[88:91], v[140:143], a[72:75], v[88:91]
    v_mfma_f32_16x16x32_bf16 v[92:95], v[140:143], a[76:79], v[92:95]
    s_waitcnt lgkmcnt(0)
    v_mfma_f32_16x16x32_bf16 v[0:3], v[144:147], a[64:67], v[0:3]
    ds_read_b64_tr_b16 v[128:129], v216 offset:40960
    v_mfma_f32_16x16x32_bf16 v[4:7], v[144:147], a[68:71], v[4:7]
    ds_read_b64_tr_b16 v[130:131], v216 offset:43008
    v_mfma_f32_16x16x32_bf16 v[96:99], v[144:147], a[72:75], v[96:99]
    ds_read_b64_tr_b16 v[132:133], v217 offset:40960
    v_mfma_f32_16x16x32_bf16 v[100:103], v[144:147], a[76:79], v[100:103]
    ds_read_b64_tr_b16 v[134:135], v217 offset:43008
    v_mfma_f32_16x16x32_bf16 v[8:11], v[148:151], a[64:67], v[8:11]
    ds_read_b64_tr_b16 v[136:137], v218 offset:40960
    v_mfma_f32_16x16x32_bf16 v[12:15], v[148:151], a[68:71], v[12:15]
    ds_read_b64_tr_b16 v[138:139], v218 offset:43008
    v_mfma_f32_16x16x32_bf16 v[104:107], v[148:151], a[72:75], v[104:107]
    ds_read_b64_tr_b16 v[140:141], v219 offset:40960
    v_mfma_f32_16x16x32_bf16 v[108:111], v[148:151], a[76:79], v[108:111]
    ds_read_b64_tr_b16 v[142:143], v219 offset:43008
    v_mfma_f32_16x16x32_bf16 v[16:19], v[152:155], a[64:67], v[16:19]
    buffer_load_dwordx4 a[16:19], v226, s[8:11], s35 offen offset:1024 sc1
    v_mfma_f32_16x16x32_bf16 v[20:23], v[152:155], a[68:71], v[20:23]
    v_mfma_f32_16x16x32_bf16 v[112:115], v[152:155], a[72:75], v[112:115]
    v_mfma_f32_16x16x32_bf16 v[116:119], v[152:155], a[76:79], v[116:119]
    v_mfma_f32_16x16x32_bf16 v[24:27], v[156:159], a[64:67], v[24:27]
    buffer_load_dwordx4 a[20:23], v227, s[8:11], s35 offen offset:1024 sc1
    v_mfma_f32_16x16x32_bf16 v[28:31], v[156:159], a[68:71], v[28:31]
    v_mfma_f32_16x16x32_bf16 v[120:123], v[156:159], a[72:75], v[120:123]
    v_mfma_f32_16x16x32_bf16 v[124:127], v[156:159], a[76:79], v[124:127]
    buffer_load_dwordx4 a[24:27], v245, s[8:11], s35 offen offset:1024 sc1
    s_waitcnt vmcnt(17) lgkmcnt(0)
    v_mfma_f32_16x16x32_bf16 v[32:35], v[128:131], a[80:83], v[32:35]
    ds_read_b64_tr_b16 v[144:145], v220 offset:40960
    v_mfma_f32_16x16x32_bf16 v[36:39], v[128:131], a[84:87], v[36:39]
    ds_read_b64_tr_b16 v[146:147], v220 offset:43008
    v_mfma_f32_16x16x32_bf16 v[64:67], v[128:131], a[88:91], v[64:67]
    ds_read_b64_tr_b16 v[148:149], v221 offset:40960
    v_mfma_f32_16x16x32_bf16 v[68:71], v[128:131], a[92:95], v[68:71]
    ds_read_b64_tr_b16 v[150:151], v221 offset:43008
    v_mfma_f32_16x16x32_bf16 v[40:43], v[132:135], a[80:83], v[40:43]
    ds_read_b64_tr_b16 v[152:153], v222 offset:40960
    v_mfma_f32_16x16x32_bf16 v[44:47], v[132:135], a[84:87], v[44:47]
    ds_read_b64_tr_b16 v[154:155], v222 offset:43008
    v_mfma_f32_16x16x32_bf16 v[72:75], v[132:135], a[88:91], v[72:75]
    ds_read_b64_tr_b16 v[156:157], v223 offset:40960
    v_mfma_f32_16x16x32_bf16 v[76:79], v[132:135], a[92:95], v[76:79]
    ds_read_b64_tr_b16 v[158:159], v223 offset:43008
    v_mfma_f32_16x16x32_bf16 v[48:51], v[136:139], a[80:83], v[48:51]
    buffer_load_dwordx4 a[28:31], v246, s[8:11], s35 offen offset:1024 sc1
    v_mfma_f32_16x16x32_bf16 v[52:55], v[136:139], a[84:87], v[52:55]
    s_add_u32 m0, s38, 8192
    s_add_u32 s32, s37, 1114112
    v_mfma_f32_16x16x32_bf16 v[80:83], v[136:139], a[88:91], v[80:83]
    buffer_load_dwordx4 v224, s[12:15], s32 offen lds
    v_mfma_f32_16x16x32_bf16 v[84:87], v[136:139], a[92:95], v[84:87]
    buffer_load_dwordx4 a[32:35], v226, s[8:11], s35 offen offset:2048 sc1
    v_mfma_f32_16x16x32_bf16 v[56:59], v[140:143], a[80:83], v[56:59]
    v_mfma_f32_16x16x32_bf16 v[60:63], v[140:143], a[84:87], v[60:63]
    buffer_load_dwordx4 v225, s[12:15], s32 offen offset:1024 lds
    v_mfma_f32_16x16x32_bf16 v[88:91], v[140:143], a[88:91], v[88:91]
    v_mfma_f32_16x16x32_bf16 v[92:95], v[140:143], a[92:95], v[92:95]
    s_waitcnt lgkmcnt(0)
    v_mfma_f32_16x16x32_bf16 v[0:3], v[144:147], a[80:83], v[0:3]
    ds_read_b64_tr_b16 v[128:129], v216 offset:49152
    v_mfma_f32_16x16x32_bf16 v[4:7], v[144:147], a[84:87], v[4:7]
    ds_read_b64_tr_b16 v[130:131], v216 offset:51200
    v_mfma_f32_16x16x32_bf16 v[96:99], v[144:147], a[88:91], v[96:99]
    ds_read_b64_tr_b16 v[132:133], v217 offset:49152
    v_mfma_f32_16x16x32_bf16 v[100:103], v[144:147], a[92:95], v[100:103]
    ds_read_b64_tr_b16 v[134:135], v217 offset:51200
    v_mfma_f32_16x16x32_bf16 v[8:11], v[148:151], a[80:83], v[8:11]
    ds_read_b64_tr_b16 v[136:137], v218 offset:49152
    v_mfma_f32_16x16x32_bf16 v[12:15], v[148:151], a[84:87], v[12:15]
    ds_read_b64_tr_b16 v[138:139], v218 offset:51200
    v_mfma_f32_16x16x32_bf16 v[104:107], v[148:151], a[88:91], v[104:107]
    ds_read_b64_tr_b16 v[140:141], v219 offset:49152
    v_mfma_f32_16x16x32_bf16 v[108:111], v[148:151], a[92:95], v[108:111]
    ds_read_b64_tr_b16 v[142:143], v219 offset:51200
    v_mfma_f32_16x16x32_bf16 v[16:19], v[152:155], a[80:83], v[16:19]
    buffer_load_dwordx4 a[36:39], v227, s[8:11], s35 offen offset:2048 sc1
    v_mfma_f32_16x16x32_bf16 v[20:23], v[152:155], a[84:87], v[20:23]
    v_mfma_f32_16x16x32_bf16 v[112:115], v[152:155], a[88:91], v[112:115]
    v_mfma_f32_16x16x32_bf16 v[116:119], v[152:155], a[92:95], v[116:119]
    v_mfma_f32_16x16x32_bf16 v[24:27], v[156:159], a[80:83], v[24:27]
    buffer_load_dwordx4 a[40:43], v245, s[8:11], s35 offen offset:2048 sc1
    v_mfma_f32_16x16x32_bf16 v[28:31], v[156:159], a[84:87], v[28:31]
    v_mfma_f32_16x16x32_bf16 v[120:123], v[156:159], a[88:91], v[120:123]
    v_mfma_f32_16x16x32_bf16 v[124:127], v[156:159], a[92:95], v[124:127]
    s_waitcnt vmcnt(19) lgkmcnt(0)
    v_mfma_f32_16x16x32_bf16 v[32:35], v[128:131], a[96:99], v[32:35]
    ds_read_b64_tr_b16 v[144:145], v220 offset:49152
    v_mfma_f32_16x16x32_bf16 v[36:39], v[128:131], a[100:103], v[36:39]
    ds_read_b64_tr_b16 v[146:147], v220 offset:51200
    v_mfma_f32_16x16x32_bf16 v[64:67], v[128:131], a[104:107], v[64:67]
    ds_read_b64_tr_b16 v[148:149], v221 offset:49152
    v_mfma_f32_16x16x32_bf16 v[68:71], v[128:131], a[108:111], v[68:71]
    ds_read_b64_tr_b16 v[150:151], v221 offset:51200
    v_mfma_f32_16x16x32_bf16 v[40:43], v[132:135], a[96:99], v[40:43]
    ds_read_b64_tr_b16 v[152:153], v222 offset:49152
    v_mfma_f32_16x16x32_bf16 v[44:47], v[132:135], a[100:103], v[44:47]
    ds_read_b64_tr_b16 v[154:155], v222 offset:51200
    v_mfma_f32_16x16x32_bf16 v[72:75], v[132:135], a[104:107], v[72:75]
    ds_read_b64_tr_b16 v[156:157], v223 offset:49152
    v_mfma_f32_16x16x32_bf16 v[76:79], v[132:135], a[108:111], v[76:79]
    ds_read_b64_tr_b16 v[158:159], v223 offset:51200
    v_mfma_f32_16x16x32_bf16 v[48:51], v[136:139], a[96:99], v[48:51]
    buffer_load_dwordx4 a[44:47], v246, s[8:11], s35 offen offset:2048 sc1
    v_mfma_f32_16x16x32_bf16 v[52:55], v[136:139], a[100:103], v[52:55]
    s_add_u32 m0, s38, 16384
    s_add_u32 s32, s37, 1179648
    v_mfma_f32_16x16x32_bf16 v[80:83], v[136:139], a[104:107], v[80:83]
    buffer_load_dwordx4 v224, s[12:15], s32 offen lds
    v_mfma_f32_16x16x32_bf16 v[84:87], v[136:139], a[108:111], v[84:87]
    buffer_load_dwordx4 a[48:51], v226, s[8:11], s35 offen offset:3072 sc1
    v_mfma_f32_16x16x32_bf16 v[56:59], v[140:143], a[96:99], v[56:59]
    v_mfma_f32_16x16x32_bf16 v[60:63], v[140:143], a[100:103], v[60:63]
    buffer_load_dwordx4 v225, s[12:15], s32 offen offset:1024 lds
    v_mfma_f32_16x16x32_bf16 v[88:91], v[140:143], a[104:107], v[88:91]
    v_mfma_f32_16x16x32_bf16 v[92:95], v[140:143], a[108:111], v[92:95]
    s_waitcnt lgkmcnt(0)
    v_mfma_f32_16x16x32_bf16 v[0:3], v[144:147], a[96:99], v[0:3]
    ds_read_b64_tr_b16 v[128:129], v216 offset:57344
    v_mfma_f32_16x16x32_bf16 v[4:7], v[144:147], a[100:103], v[4:7]
    ds_read_b64_tr_b16 v[130:131], v216 offset:59392
    v_mfma_f32_16x16x32_bf16 v[96:99], v[144:147], a[104:107], v[96:99]
    ds_read_b64_tr_b16 v[132:133], v217 offset:57344
    v_mfma_f32_16x16x32_bf16 v[100:103], v[144:147], a[108:111], v[100:103]
    ds_read_b64_tr_b16 v[134:135], v217 offset:59392
    v_mfma_f32_16x16x32_bf16 v[8:11], v[148:151], a[96:99], v[8:11]
    ds_read_b64_tr_b16 v[136:137], v218 offset:57344
    v_mfma_f32_16x16x32_bf16 v[12:15], v[148:151], a[100:103], v[12:15]
    ds_read_b64_tr_b16 v[138:139], v218 offset:59392
    v_mfma_f32_16x16x32_bf16 v[104:107], v[148:151], a[104:107], v[104:107]
    ds_read_b64_tr_b16 v[140:141], v219 offset:57344
    v_mfma_f32_16x16x32_bf16 v[108:111], v[148:151], a[108:111], v[108:111]
    ds_read_b64_tr_b16 v[142:143], v219 offset:59392
    v_mfma_f32_16x16x32_bf16 v[16:19], v[152:155], a[96:99], v[16:19]
    buffer_load_dwordx4 a[52:55], v227, s[8:11], s35 offen offset:3072 sc1
    v_mfma_f32_16x16x32_bf16 v[20:23], v[152:155], a[100:103], v[20:23]
    v_mfma_f32_16x16x32_bf16 v[112:115], v[152:155], a[104:107], v[112:115]
    v_mfma_f32_16x16x32_bf16 v[116:119], v[152:155], a[108:111], v[116:119]
    v_mfma_f32_16x16x32_bf16 v[24:27], v[156:159], a[96:99], v[24:27]
    buffer_load_dwordx4 a[56:59], v245, s[8:11], s35 offen offset:3072 sc1
    v_mfma_f32_16x16x32_bf16 v[28:31], v[156:159], a[100:103], v[28:31]
    v_mfma_f32_16x16x32_bf16 v[120:123], v[156:159], a[104:107], v[120:123]
    v_mfma_f32_16x16x32_bf16 v[124:127], v[156:159], a[108:111], v[124:127]
    buffer_load_dwordx4 a[60:63], v246, s[8:11], s35 offen offset:3072 sc1
    s_waitcnt vmcnt(22) lgkmcnt(0)
    v_mfma_f32_16x16x32_bf16 v[32:35], v[128:131], a[112:115], v[32:35]
    ds_read_b64_tr_b16 v[144:145], v220 offset:57344
    v_mfma_f32_16x16x32_bf16 v[36:39], v[128:131], a[116:119], v[36:39]
    ds_read_b64_tr_b16 v[146:147], v220 offset:59392
    v_mfma_f32_16x16x32_bf16 v[64:67], v[128:131], a[120:123], v[64:67]
    ds_read_b64_tr_b16 v[148:149], v221 offset:57344
    v_mfma_f32_16x16x32_bf16 v[68:71], v[128:131], a[124:127], v[68:71]
    ds_read_b64_tr_b16 v[150:151], v221 offset:59392
    v_mfma_f32_16x16x32_bf16 v[40:43], v[132:135], a[112:115], v[40:43]
    ds_read_b64_tr_b16 v[152:153], v222 offset:57344
    v_mfma_f32_16x16x32_bf16 v[44:47], v[132:135], a[116:119], v[44:47]
    ds_read_b64_tr_b16 v[154:155], v222 offset:59392
    v_mfma_f32_16x16x32_bf16 v[72:75], v[132:135], a[120:123], v[72:75]
    ds_read_b64_tr_b16 v[156:157], v223 offset:57344
    v_mfma_f32_16x16x32_bf16 v[76:79], v[132:135], a[124:127], v[76:79]
    ds_read_b64_tr_b16 v[158:159], v223 offset:59392
    v_mfma_f32_16x16x32_bf16 v[48:51], v[136:139], a[112:115], v[48:51]
    s_add_u32 s35, s35, 4096
    buffer_load_dwordx4 a[64:67], v226, s[8:11], s35 offen offset:0 sc1
    v_mfma_f32_16x16x32_bf16 v[52:55], v[136:139], a[116:119], v[52:55]
    s_add_u32 m0, s38, 24576
    s_add_u32 s32, s37, 1245184
    v_mfma_f32_16x16x32_bf16 v[80:83], v[136:139], a[120:123], v[80:83]
    buffer_load_dwordx4 v224, s[12:15], s32 offen lds
    v_mfma_f32_16x16x32_bf16 v[84:87], v[136:139], a[124:127], v[84:87]
    buffer_load_dwordx4 a[68:71], v227, s[8:11], s35 offen offset:0 sc1
    v_mfma_f32_16x16x32_bf16 v[56:59], v[140:143], a[112:115], v[56:59]
    v_mfma_f32_16x16x32_bf16 v[60:63], v[140:143], a[116:119], v[60:63]
    buffer_load_dwordx4 v225, s[12:15], s32 offen offset:1024 lds
    v_mfma_f32_16x16x32_bf16 v[88:91], v[140:143], a[120:123], v[88:91]
    v_mfma_f32_16x16x32_bf16 v[92:95], v[140:143], a[124:127], v[92:95]
    s_waitcnt lgkmcnt(0)
    s_barrier
    v_mfma_f32_16x16x32_bf16 v[0:3], v[144:147], a[112:115], v[0:3]
    v_xor_b32 v216, 0x10000, v216
    ds_read_b64_tr_b16 v[128:129], v216 offset:0
    v_mfma_f32_16x16x32_bf16 v[4:7], v[144:147], a[116:119], v[4:7]
    ds_read_b64_tr_b16 v[130:131], v216 offset:2048
    v_mfma_f32_16x16x32_bf16 v[96:99], v[144:147], a[120:123], v[96:99]
    v_xor_b32 v217, 0x10000, v217
    ds_read_b64_tr_b16 v[132:133], v217 offset:0
    v_mfma_f32_16x16x32_bf16 v[100:103], v[144:147], a[124:127], v[100:103]
    ds_read_b64_tr_b16 v[134:135], v217 offset:2048
    v_mfma_f32_16x16x32_bf16 v[8:11], v[148:151], a[112:115], v[8:11]
    v_xor_b32 v218, 0x10000, v218
    ds_read_b64_tr_b16 v[136:137], v218 offset:0
    v_mfma_f32_16x16x32_bf16 v[12:15], v[148:151], a[116:119], v[12:15]
    ds_read_b64_tr_b16 v[138:139], v218 offset:2048
    v_mfma_f32_16x16x32_bf16 v[104:107], v[148:151], a[120:123], v[104:107]
    v_xor_b32 v219, 0x10000, v219
    ds_read_b64_tr_b16 v[140:141], v219 offset:0
    v_mfma_f32_16x16x32_bf16 v[108:111], v[148:151], a[124:127], v[108:111]
    ds_read_b64_tr_b16 v[142:143], v219 offset:2048
    v_mfma_f32_16x16x32_bf16 v[16:19], v[152:155], a[112:115], v[16:19]
    buffer_load_dwordx4 a[72:75], v245, s[8:11], s35 offen offset:0 sc1
    v_mfma_f32_16x16x32_bf16 v[20:23], v[152:155], a[116:119], v[20:23]
    v_mfma_f32_16x16x32_bf16 v[112:115], v[152:155], a[120:123], v[112:115]
    v_mfma_f32_16x16x32_bf16 v[116:119], v[152:155], a[124:127], v[116:119]
    v_mfma_f32_16x16x32_bf16 v[24:27], v[156:159], a[112:115], v[24:27]
    buffer_load_dwordx4 a[76:79], v246, s[8:11], s35 offen offset:0 sc1
    v_mfma_f32_16x16x32_bf16 v[28:31], v[156:159], a[116:119], v[28:31]
    v_mfma_f32_16x16x32_bf16 v[120:123], v[156:159], a[120:123], v[120:123]
    v_mfma_f32_16x16x32_bf16 v[124:127], v[156:159], a[124:127], v[124:127]
    s_waitcnt vmcnt(23) lgkmcnt(0)
    v_mfma_f32_16x16x32_bf16 v[32:35], v[128:131], a[0:3], v[32:35]
    v_xor_b32 v220, 0x10000, v220
    ds_read_b64_tr_b16 v[144:145], v220 offset:0
    v_mfma_f32_16x16x32_bf16 v[36:39], v[128:131], a[4:7], v[36:39]
    ds_read_b64_tr_b16 v[146:147], v220 offset:2048
    v_mfma_f32_16x16x32_bf16 v[64:67], v[128:131], a[8:11], v[64:67]
    v_xor_b32 v221, 0x10000, v221
    ds_read_b64_tr_b16 v[148:149], v221 offset:0
    v_mfma_f32_16x16x32_bf16 v[68:71], v[128:131], a[12:15], v[68:71]
    ds_read_b64_tr_b16 v[150:151], v221 offset:2048
    v_mfma_f32_16x16x32_bf16 v[40:43], v[132:135], a[0:3], v[40:43]
    v_xor_b32 v222, 0x10000, v222
    ds_read_b64_tr_b16 v[152:153], v222 offset:0
    v_mfma_f32_16x16x32_bf16 v[44:47], v[132:135], a[4:7], v[44:47]
    ds_read_b64_tr_b16 v[154:155], v222 offset:2048
    v_mfma_f32_16x16x32_bf16 v[72:75], v[132:135], a[8:11], v[72:75]
    v_xor_b32 v223, 0x10000, v223
    ds_read_b64_tr_b16 v[156:157], v223 offset:0
    v_mfma_f32_16x16x32_bf16 v[76:79], v[132:135], a[12:15], v[76:79]
    ds_read_b64_tr_b16 v[158:159], v223 offset:2048
    v_mfma_f32_16x16x32_bf16 v[48:51], v[136:139], a[0:3], v[48:51]
    buffer_load_dwordx4 a[80:83], v226, s[8:11], s35 offen offset:1024 sc1
    v_mfma_f32_16x16x32_bf16 v[52:55], v[136:139], a[4:7], v[52:55]
    s_add_u32 m0, s38, 32768
    s_add_u32 s32, s37, 1310720
    v_mfma_f32_16x16x32_bf16 v[80:83], v[136:139], a[8:11], v[80:83]
    buffer_load_dwordx4 v224, s[12:15], s32 offen lds
    v_mfma_f32_16x16x32_bf16 v[84:87], v[136:139], a[12:15], v[84:87]
    buffer_load_dwordx4 a[84:87], v227, s[8:11], s35 offen offset:1024 sc1
    v_mfma_f32_16x16x32_bf16 v[56:59], v[140:143], a[0:3], v[56:59]
    v_mfma_f32_16x16x32_bf16 v[60:63], v[140:143], a[4:7], v[60:63]
    buffer_load_dwordx4 v225, s[12:15], s32 offen offset:1024 lds
    v_mfma_f32_16x16x32_bf16 v[88:91], v[140:143], a[8:11], v[88:91]
    s_lshl_b32 s45, s52, 7
    s_add_u32 s45, s45, 0x38a1400
    v_mfma_f32_16x16x32_bf16 v[92:95], v[140:143], a[12:15], v[92:95]
    s_waitcnt lgkmcnt(0)
    v_mfma_f32_16x16x32_bf16 v[0:3], v[144:147], a[0:3], v[0:3]
    ds_read_b64_tr_b16 v[128:129], v216 offset:8192
    v_mfma_f32_16x16x32_bf16 v[4:7], v[144:147], a[4:7], v[4:7]
    ds_read_b64_tr_b16 v[130:131], v216 offset:10240
    v_mfma_f32_16x16x32_bf16 v[96:99], v[144:147], a[8:11], v[96:99]
    ds_read_b64_tr_b16 v[132:133], v217 offset:8192
    v_mfma_f32_16x16x32_bf16 v[100:103], v[144:147], a[12:15], v[100:103]
    ds_read_b64_tr_b16 v[134:135], v217 offset:10240
    v_mfma_f32_16x16x32_bf16 v[8:11], v[148:151], a[0:3], v[8:11]
    ds_read_b64_tr_b16 v[136:137], v218 offset:8192
    v_mfma_f32_16x16x32_bf16 v[12:15], v[148:151], a[4:7], v[12:15]
    ds_read_b64_tr_b16 v[138:139], v218 offset:10240
    v_mfma_f32_16x16x32_bf16 v[104:107], v[148:151], a[8:11], v[104:107]
    ds_read_b64_tr_b16 v[140:141], v219 offset:8192
    v_mfma_f32_16x16x32_bf16 v[108:111], v[148:151], a[12:15], v[108:111]
    ds_read_b64_tr_b16 v[142:143], v219 offset:10240
    v_mfma_f32_16x16x32_bf16 v[16:19], v[152:155], a[0:3], v[16:19]
    buffer_load_dwordx4 a[88:91], v245, s[8:11], s35 offen offset:1024 sc1
    v_mfma_f32_16x16x32_bf16 v[20:23], v[152:155], a[4:7], v[20:23]
    s_cmp_eq_u32 s3, 0
    s_cselect_b32 s45, s45, 0x40000000
    v_mfma_f32_16x16x32_bf16 v[112:115], v[152:155], a[8:11], v[112:115]
    buffer_load_dword v235, off, s[8:11], s45 sc1
    v_mfma_f32_16x16x32_bf16 v[116:119], v[152:155], a[12:15], v[116:119]
    v_mfma_f32_16x16x32_bf16 v[24:27], v[156:159], a[0:3], v[24:27]
    buffer_load_dwordx4 a[92:95], v246, s[8:11], s35 offen offset:1024 sc1
    v_mfma_f32_16x16x32_bf16 v[28:31], v[156:159], a[4:7], v[28:31]
    v_mfma_f32_16x16x32_bf16 v[120:123], v[156:159], a[8:11], v[120:123]
    v_mfma_f32_16x16x32_bf16 v[124:127], v[156:159], a[12:15], v[124:127]
    buffer_load_dwordx4 a[96:99], v226, s[8:11], s35 offen offset:2048 sc1
    s_waitcnt vmcnt(26) lgkmcnt(0)
    v_mfma_f32_16x16x32_bf16 v[32:35], v[128:131], a[16:19], v[32:35]
    ds_read_b64_tr_b16 v[144:145], v220 offset:8192
    v_mfma_f32_16x16x32_bf16 v[36:39], v[128:131], a[20:23], v[36:39]
    ds_read_b64_tr_b16 v[146:147], v220 offset:10240
    v_mfma_f32_16x16x32_bf16 v[64:67], v[128:131], a[24:27], v[64:67]
    ds_read_b64_tr_b16 v[148:149], v221 offset:8192
    v_mfma_f32_16x16x32_bf16 v[68:71], v[128:131], a[28:31], v[68:71]
    ds_read_b64_tr_b16 v[150:151], v221 offset:10240
    v_mfma_f32_16x16x32_bf16 v[40:43], v[132:135], a[16:19], v[40:43]
    ds_read_b64_tr_b16 v[152:153], v222 offset:8192
    v_mfma_f32_16x16x32_bf16 v[44:47], v[132:135], a[20:23], v[44:47]
    ds_read_b64_tr_b16 v[154:155], v222 offset:10240
    v_mfma_f32_16x16x32_bf16 v[72:75], v[132:135], a[24:27], v[72:75]
    ds_read_b64_tr_b16 v[156:157], v223 offset:8192
    v_mfma_f32_16x16x32_bf16 v[76:79], v[132:135], a[28:31], v[76:79]
    ds_read_b64_tr_b16 v[158:159], v223 offset:10240
    v_mfma_f32_16x16x32_bf16 v[48:51], v[136:139], a[16:19], v[48:51]
    buffer_load_dwordx4 a[100:103], v227, s[8:11], s35 offen offset:2048 sc1
    v_mfma_f32_16x16x32_bf16 v[52:55], v[136:139], a[20:23], v[52:55]
    s_add_u32 m0, s38, 40960
    s_add_u32 s32, s37, 1376256
    v_mfma_f32_16x16x32_bf16 v[80:83], v[136:139], a[24:27], v[80:83]
    buffer_load_dwordx4 v224, s[12:15], s32 offen lds
    v_mfma_f32_16x16x32_bf16 v[84:87], v[136:139], a[28:31], v[84:87]
    buffer_load_dwordx4 a[104:107], v245, s[8:11], s35 offen offset:2048 sc1
    v_mfma_f32_16x16x32_bf16 v[56:59], v[140:143], a[16:19], v[56:59]
    v_mfma_f32_16x16x32_bf16 v[60:63], v[140:143], a[20:23], v[60:63]
    buffer_load_dwordx4 v225, s[12:15], s32 offen offset:1024 lds
    v_mfma_f32_16x16x32_bf16 v[88:91], v[140:143], a[24:27], v[88:91]
    v_mfma_f32_16x16x32_bf16 v[92:95], v[140:143], a[28:31], v[92:95]
    s_waitcnt lgkmcnt(0)
    v_mfma_f32_16x16x32_bf16 v[0:3], v[144:147], a[16:19], v[0:3]
    ds_read_b64_tr_b16 v[128:129], v216 offset:16384
    v_mfma_f32_16x16x32_bf16 v[4:7], v[144:147], a[20:23], v[4:7]
    ds_read_b64_tr_b16 v[130:131], v216 offset:18432
    v_mfma_f32_16x16x32_bf16 v[96:99], v[144:147], a[24:27], v[96:99]
    ds_read_b64_tr_b16 v[132:133], v217 offset:16384
    v_mfma_f32_16x16x32_bf16 v[100:103], v[144:147], a[28:31], v[100:103]
    ds_read_b64_tr_b16 v[134:135], v217 offset:18432
    v_mfma_f32_16x16x32_bf16 v[8:11], v[148:151], a[16:19], v[8:11]
    ds_read_b64_tr_b16 v[136:137], v218 offset:16384
    v_mfma_f32_16x16x32_bf16 v[12:15], v[148:151], a[20:23], v[12:15]
    ds_read_b64_tr_b16 v[138:139], v218 offset:18432
    v_mfma_f32_16x16x32_bf16 v[104:107], v[148:151], a[24:27], v[104:107]
    ds_read_b64_tr_b16 v[140:141], v219 offset:16384
    v_mfma_f32_16x16x32_bf16 v[108:111], v[148:151], a[28:31], v[108:111]
    ds_read_b64_tr_b16 v[142:143], v219 offset:18432
    v_mfma_f32_16x16x32_bf16 v[16:19], v[152:155], a[16:19], v[16:19]
    buffer_load_dwordx4 a[108:111], v246, s[8:11], s35 offen offset:2048 sc1
    v_mfma_f32_16x16x32_bf16 v[20:23], v[152:155], a[20:23], v[20:23]
    v_mfma_f32_16x16x32_bf16 v[112:115], v[152:155], a[24:27], v[112:115]
    v_mfma_f32_16x16x32_bf16 v[116:119], v[152:155], a[28:31], v[116:119]
    v_mfma_f32_16x16x32_bf16 v[24:27], v[156:159], a[16:19], v[24:27]
    buffer_load_dwordx4 a[112:115], v226, s[8:11], s35 offen offset:3072 sc1
    v_mfma_f32_16x16x32_bf16 v[28:31], v[156:159], a[20:23], v[28:31]
    v_mfma_f32_16x16x32_bf16 v[120:123], v[156:159], a[24:27], v[120:123]
    v_mfma_f32_16x16x32_bf16 v[124:127], v[156:159], a[28:31], v[124:127]
    s_waitcnt vmcnt(26) lgkmcnt(0)
    v_mfma_f32_16x16x32_bf16 v[32:35], v[128:131], a[32:35], v[32:35]
    ds_read_b64_tr_b16 v[144:145], v220 offset:16384
    v_mfma_f32_16x16x32_bf16 v[36:39], v[128:131], a[36:39], v[36:39]
    ds_read_b64_tr_b16 v[146:147], v220 offset:18432
    v_mfma_f32_16x16x32_bf16 v[64:67], v[128:131], a[40:43], v[64:67]
    ds_read_b64_tr_b16 v[148:149], v221 offset:16384
    v_mfma_f32_16x16x32_bf16 v[68:71], v[128:131], a[44:47], v[68:71]
    ds_read_b64_tr_b16 v[150:151], v221 offset:18432
    v_mfma_f32_16x16x32_bf16 v[40:43], v[132:135], a[32:35], v[40:43]
    ds_read_b64_tr_b16 v[152:153], v222 offset:16384
    v_mfma_f32_16x16x32_bf16 v[44:47], v[132:135], a[36:39], v[44:47]
    ds_read_b64_tr_b16 v[154:155], v222 offset:18432
    v_mfma_f32_16x16x32_bf16 v[72:75], v[132:135], a[40:43], v[72:75]
    ds_read_b64_tr_b16 v[156:157], v223 offset:16384
    v_mfma_f32_16x16x32_bf16 v[76:79], v[132:135], a[44:47], v[76:79]
    ds_read_b64_tr_b16 v[158:159], v223 offset:18432
    v_mfma_f32_16x16x32_bf16 v[48:51], v[136:139], a[32:35], v[48:51]
    buffer_load_dwordx4 a[116:119], v227, s[8:11], s35 offen offset:3072 sc1
    v_mfma_f32_16x16x32_bf16 v[52:55], v[136:139], a[36:39], v[52:55]
    s_add_u32 m0, s38, 49152
    s_add_u32 s32, s37, 1441792
    v_mfma_f32_16x16x32_bf16 v[80:83], v[136:139], a[40:43], v[80:83]
    buffer_load_dwordx4 v224, s[12:15], s32 offen lds
    v_mfma_f32_16x16x32_bf16 v[84:87], v[136:139], a[44:47], v[84:87]
    buffer_load_dwordx4 a[120:123], v245, s[8:11], s35 offen offset:3072 sc1
    v_mfma_f32_16x16x32_bf16 v[56:59], v[140:143], a[32:35], v[56:59]
    v_mfma_f32_16x16x32_bf16 v[60:63], v[140:143], a[36:39], v[60:63]
    buffer_load_dwordx4 v225, s[12:15], s32 offen offset:1024 lds
    v_mfma_f32_16x16x32_bf16 v[88:91], v[140:143], a[40:43], v[88:91]
    v_mfma_f32_16x16x32_bf16 v[92:95], v[140:143], a[44:47], v[92:95]
    s_waitcnt lgkmcnt(0)
    v_mfma_f32_16x16x32_bf16 v[0:3], v[144:147], a[32:35], v[0:3]
    ds_read_b64_tr_b16 v[128:129], v216 offset:24576
    v_mfma_f32_16x16x32_bf16 v[4:7], v[144:147], a[36:39], v[4:7]
    ds_read_b64_tr_b16 v[130:131], v216 offset:26624
    v_mfma_f32_16x16x32_bf16 v[96:99], v[144:147], a[40:43], v[96:99]
    ds_read_b64_tr_b16 v[132:133], v217 offset:24576
    v_mfma_f32_16x16x32_bf16 v[100:103], v[144:147], a[44:47], v[100:103]
    ds_read_b64_tr_b16 v[134:135], v217 offset:26624
    v_mfma_f32_16x16x32_bf16 v[8:11], v[148:151], a[32:35], v[8:11]
    ds_read_b64_tr_b16 v[136:137], v218 offset:24576
    v_mfma_f32_16x16x32_bf16 v[12:15], v[148:151], a[36:39], v[12:15]
    ds_read_b64_tr_b16 v[138:139], v218 offset:26624
    v_mfma_f32_16x16x32_bf16 v[104:107], v[148:151], a[40:43], v[104:107]
    ds_read_b64_tr_b16 v[140:141], v219 offset:24576
    v_mfma_f32_16x16x32_bf16 v[108:111], v[148:151], a[44:47], v[108:111]
    ds_read_b64_tr_b16 v[142:143], v219 offset:26624
    v_mfma_f32_16x16x32_bf16 v[16:19], v[152:155], a[32:35], v[16:19]
    buffer_load_dwordx4 a[124:127], v246, s[8:11], s35 offen offset:3072 sc1
    v_mfma_f32_16x16x32_bf16 v[20:23], v[152:155], a[36:39], v[20:23]
    v_mfma_f32_16x16x32_bf16 v[112:115], v[152:155], a[40:43], v[112:115]
    v_mfma_f32_16x16x32_bf16 v[116:119], v[152:155], a[44:47], v[116:119]
    v_mfma_f32_16x16x32_bf16 v[24:27], v[156:159], a[32:35], v[24:27]
    s_add_u32 s35, s35, 4096
    buffer_load_dwordx4 a[0:3], v226, s[8:11], s35 offen offset:0 sc1
    v_mfma_f32_16x16x32_bf16 v[28:31], v[156:159], a[36:39], v[28:31]
    v_mfma_f32_16x16x32_bf16 v[120:123], v[156:159], a[40:43], v[120:123]
    v_mfma_f32_16x16x32_bf16 v[124:127], v[156:159], a[44:47], v[124:127]
    buffer_load_dwordx4 a[4:7], v227, s[8:11], s35 offen offset:0 sc1
    s_waitcnt vmcnt(27) lgkmcnt(0)
    v_mfma_f32_16x16x32_bf16 v[32:35], v[128:131], a[48:51], v[32:35]
    ds_read_b64_tr_b16 v[144:145], v220 offset:24576
    v_mfma_f32_16x16x32_bf16 v[36:39], v[128:131], a[52:55], v[36:39]
    ds_read_b64_tr_b16 v[146:147], v220 offset:26624
    v_mfma_f32_16x16x32_bf16 v[64:67], v[128:131], a[56:59], v[64:67]
    ds_read_b64_tr_b16 v[148:149], v221 offset:24576
    v_mfma_f32_16x16x32_bf16 v[68:71], v[128:131], a[60:63], v[68:71]
    ds_read_b64_tr_b16 v[150:151], v221 offset:26624
    v_mfma_f32_16x16x32_bf16 v[40:43], v[132:135], a[48:51], v[40:43]
    ds_read_b64_tr_b16 v[152:153], v222 offset:24576
    v_mfma_f32_16x16x32_bf16 v[44:47], v[132:135], a[52:55], v[44:47]
    ds_read_b64_tr_b16 v[154:155], v222 offset:26624
    v_mfma_f32_16x16x32_bf16 v[72:75], v[132:135], a[56:59], v[72:75]
    ds_read_b64_tr_b16 v[156:157], v223 offset:24576
    v_mfma_f32_16x16x32_bf16 v[76:79], v[132:135], a[60:63], v[76:79]
    ds_read_b64_tr_b16 v[158:159], v223 offset:26624
    v_mfma_f32_16x16x32_bf16 v[48:51], v[136:139], a[48:51], v[48:51]
    buffer_load_dwordx4 a[8:11], v245, s[8:11], s35 offen offset:0 sc1
    v_mfma_f32_16x16x32_bf16 v[52:55], v[136:139], a[52:55], v[52:55]
    s_add_u32 m0, s38, 57344
    s_add_u32 s32, s37, 1507328
    v_mfma_f32_16x16x32_bf16 v[80:83], v[136:139], a[56:59], v[80:83]
    buffer_load_dwordx4 v224, s[12:15], s32 offen lds
    v_mfma_f32_16x16x32_bf16 v[84:87], v[136:139], a[60:63], v[84:87]
    buffer_load_dwordx4 a[12:15], v246, s[8:11], s35 offen offset:0 sc1
    v_mfma_f32_16x16x32_bf16 v[56:59], v[140:143], a[48:51], v[56:59]
    v_mfma_f32_16x16x32_bf16 v[60:63], v[140:143], a[52:55], v[60:63]
    buffer_load_dwordx4 v225, s[12:15], s32 offen offset:1024 lds
    v_mfma_f32_16x16x32_bf16 v[88:91], v[140:143], a[56:59], v[88:91]
    s_waitcnt vmcnt(19)
    v_readfirstlane_b32 s36, v235
    s_lshl_b32 s34, s3, 8
    s_add_u32 s36, s36, s34
    s_cmp_ge_u32 s36, 8
    s_cbranch_scc0 kc_g
kc_gr:
    v_mfma_f32_16x16x32_bf16 v[92:95], v[140:143], a[60:63], v[92:95]
    s_waitcnt lgkmcnt(0)
    s_barrier
    v_mfma_f32_16x16x32_bf16 v[0:3], v[144:147], a[48:51], v[0:3]
    ds_read_b64_tr_b16 v[128:129], v216 offset:32768
    v_mfma_f32_16x16x32_bf16 v[4:7], v[144:147], a[52:55], v[4:7]
    ds_read_b64_tr_b16 v[130:131], v216 offset:34816
    v_mfma_f32_16x16x32_bf16 v[96:99], v[144:147], a[56:59], v[96:99]
    ds_read_b64_tr_b16 v[132:133], v217 offset:32768
    v_mfma_f32_16x16x32_bf16 v[100:103], v[144:147], a[60:63], v[100:103]
    ds_read_b64_tr_b16 v[134:135], v217 offset:34816
    v_mfma_f32_16x16x32_bf16 v[8:11], v[148:151], a[48:51], v[8:11]
    ds_read_b64_tr_b16 v[136:137], v218 offset:32768
    v_mfma_f32_16x16x32_bf16 v[12:15], v[148:151], a[52:55], v[12:15]
    ds_read_b64_tr_b16 v[138:139], v218 offset:34816
    v_mfma_f32_16x16x32_bf16 v[104:107], v[148:151], a[56:59], v[104:107]
    ds_read_b64_tr_b16 v[140:141], v219 offset:32768
    v_mfma_f32_16x16x32_bf16 v[108:111], v[148:151], a[60:63], v[108:111]
    ds_read_b64_tr_b16 v[142:143], v219 offset:34816
    v_mfma_f32_16x16x32_bf16 v[16:19], v[152:155], a[48:51], v[16:19]
    buffer_load_dwordx4 a[16:19], v226, s[8:11], s35 offen offset:1024 sc1
    v_mfma_f32_16x16x32_bf16 v[20:23], v[152:155], a[52:55], v[20:23]
    v_mfma_f32_16x16x32_bf16 v[112:115], v[152:155], a[56:59], v[112:115]
    v_mfma_f32_16x16x32_bf16 v[116:119], v[152:155], a[60:63], v[116:119]
    v_mfma_f32_16x16x32_bf16 v[24:27], v[156:159], a[48:51], v[24:27]
    buffer_load_dwordx4 a[20:23], v227, s[8:11], s35 offen offset:1024 sc1
    v_mfma_f32_16x16x32_bf16 v[28:31], v[156:159], a[52:55], v[28:31]
    v_mfma_f32_16x16x32_bf16 v[120:123], v[156:159], a[56:59], v[120:123]
    v_mfma_f32_16x16x32_bf16 v[124:127], v[156:159], a[60:63], v[124:127]
    s_waitcnt vmcnt(27) lgkmcnt(0)
    v_mfma_f32_16x16x32_bf16 v[32:35], v[128:131], a[64:67], v[32:35]
    ds_read_b64_tr_b16 v[144:145], v220 offset:32768
    v_mfma_f32_16x16x32_bf16 v[36:39], v[128:131], a[68:71], v[36:39]
    ds_read_b64_tr_b16 v[146:147], v220 offset:34816
    v_mfma_f32_16x16x32_bf16 v[64:67], v[128:131], a[72:75], v[64:67]
    ds_read_b64_tr_b16 v[148:149], v221 offset:32768
    v_mfma_f32_16x16x32_bf16 v[68:71], v[128:131], a[76:79], v[68:71]
    ds_read_b64_tr_b16 v[150:151], v221 offset:34816
    v_mfma_f32_16x16x32_bf16 v[40:43], v[132:135], a[64:67], v[40:43]
    ds_read_b64_tr_b16 v[152:153], v222 offset:32768
    v_mfma_f32_16x16x32_bf16 v[44:47], v[132:135], a[68:71], v[44:47]
    ds_read_b64_tr_b16 v[154:155], v222 offset:34816
    v_mfma_f32_16x16x32_bf16 v[72:75], v[132:135], a[72:75], v[72:75]
    ds_read_b64_tr_b16 v[156:157], v223 offset:32768
    v_mfma_f32_16x16x32_bf16 v[76:79], v[132:135], a[76:79], v[76:79]
    ds_read_b64_tr_b16 v[158:159], v223 offset:34816
    v_mfma_f32_16x16x32_bf16 v[48:51], v[136:139], a[64:67], v[48:51]
    buffer_load_dwordx4 a[24:27], v245, s[8:11], s35 offen offset:1024 sc1
    v_mfma_f32_16x16x32_bf16 v[52:55], v[136:139], a[68:71], v[52:55]
    s_add_u32 m0, s38, 65536
    s_add_u32 s32, s37, 1572864
    v_mfma_f32_16x16x32_bf16 v[80:83], v[136:139], a[72:75], v[80:83]
    buffer_load_dwordx4 v224, s[12:15], s32 offen lds
    v_mfma_f32_16x16x32_bf16 v[84:87], v[136:139], a[76:79], v[84:87]
    buffer_load_dwordx4 a[28:31], v246, s[8:11], s35 offen offset:1024 sc1
    v_mfma_f32_16x16x32_bf16 v[56:59], v[140:143], a[64:67], v[56:59]
    v_mfma_f32_16x16x32_bf16 v[60:63], v[140:143], a[68:71], v[60:63]
    buffer_load_dwordx4 v225, s[12:15], s32 offen offset:1024 lds
    v_mfma_f32_16x16x32_bf16 v[88:91], v[140:143], a[72:75], v[88:91]
    s_add_u32 s33, s55, 0
    buffer_load_dwordx4 a[128:131], v228, s[8:11], s33 offen offset:0 sc1
    v_mfma_f32_16x16x32_bf16 v[92:95], v[140:143], a[76:79], v[92:95]
    s_waitcnt lgkmcnt(0)
    v_mfma_f32_16x16x32_bf16 v[0:3], v[144:147], a[64:67], v[0:3]
    ds_read_b64_tr_b16 v[128:129], v216 offset:40960
    v_mfma_f32_16x16x32_bf16 v[4:7], v[144:147], a[68:71], v[4:7]
    ds_read_b64_tr_b16 v[130:131], v216 offset:43008
    v_mfma_f32_16x16x32_bf16 v[96:99], v[144:147], a[72:75], v[96:99]
    ds_read_b64_tr_b16 v[132:133], v217 offset:40960
    v_mfma_f32_16x16x32_bf16 v[100:103], v[144:147], a[76:79], v[100:103]
    ds_read_b64_tr_b16 v[134:135], v217 offset:43008
    v_mfma_f32_16x16x32_bf16 v[8:11], v[148:151], a[64:67], v[8:11]
    ds_read_b64_tr_b16 v[136:137], v218 offset:40960
    v_mfma_f32_16x16x32_bf16 v[12:15], v[148:151], a[68:71], v[12:15]
    ds_read_b64_tr_b16 v[138:139], v218 offset:43008
    v_mfma_f32_16x16x32_bf16 v[104:107], v[148:151], a[72:75], v[104:107]
    ds_read_b64_tr_b16 v[140:141], v219 offset:40960
    v_mfma_f32_16x16x32_bf16 v[108:111], v[148:151], a[76:79], v[108:111]
    ds_read_b64_tr_b16 v[142:143], v219 offset:43008
    v_mfma_f32_16x16x32_bf16 v[16:19], v[152:155], a[64:67], v[16:19]
    buffer_load_dwordx4 a[32:35], v226, s[8:11], s35 offen offset:2048 sc1
    v_mfma_f32_16x16x32_bf16 v[20:23], v[152:155], a[68:71], v[20:23]
    v_mfma_f32_16x16x32_bf16 v[112:115], v[152:155], a[72:75], v[112:115]
    v_mfma_f32_16x16x32_bf16 v[116:119], v[152:155], a[76:79], v[116:119]
    v_mfma_f32_16x16x32_bf16 v[24:27], v[156:159], a[64:67], v[24:27]
    buffer_load_dwordx4 a[36:39], v227, s[8:11], s35 offen offset:2048 sc1
    v_mfma_f32_16x16x32_bf16 v[28:31], v[156:159], a[68:71], v[28:31]
    v_mfma_f32_16x16x32_bf16 v[120:123], v[156:159], a[72:75], v[120:123]
    buffer_load_dwordx4 a[132:135], v228, s[8:11], s33 offen offset:1024 sc1
    v_mfma_f32_16x16x32_bf16 v[124:127], v[156:159], a[76:79], v[124:127]
    buffer_load_dwordx4 a[40:43], v245, s[8:11], s35 offen offset:2048 sc1
    s_waitcnt vmcnt(29) lgkmcnt(0)
    v_mfma_f32_16x16x32_bf16 v[32:35], v[128:131], a[80:83], v[32:35]
    ds_read_b64_tr_b16 v[144:145], v220 offset:40960
    v_mfma_f32_16x16x32_bf16 v[36:39], v[128:131], a[84:87], v[36:39]
    ds_read_b64_tr_b16 v[146:147], v220 offset:43008
    v_mfma_f32_16x16x32_bf16 v[64:67], v[128:131], a[88:91], v[64:67]
    ds_read_b64_tr_b16 v[148:149], v221 offset:40960
    v_mfma_f32_16x16x32_bf16 v[68:71], v[128:131], a[92:95], v[68:71]
    ds_read_b64_tr_b16 v[150:151], v221 offset:43008
    v_mfma_f32_16x16x32_bf16 v[40:43], v[132:135], a[80:83], v[40:43]
    ds_read_b64_tr_b16 v[152:153], v222 offset:40960
    v_mfma_f32_16x16x32_bf16 v[44:47], v[132:135], a[84:87], v[44:47]
    ds_read_b64_tr_b16 v[154:155], v222 offset:43008
    v_mfma_f32_16x16x32_bf16 v[72:75], v[132:135], a[88:91], v[72:75]
    ds_read_b64_tr_b16 v[156:157], v223 offset:40960
    v_mfma_f32_16x16x32_bf16 v[76:79], v[132:135], a[92:95], v[76:79]
    ds_read_b64_tr_b16 v[158:159], v223 offset:43008
    v_mfma_f32_16x16x32_bf16 v[48:51], v[136:139], a[80:83], v[48:51]
    buffer_load_dwordx4 a[44:47], v246, s[8:11], s35 offen offset:2048 sc1
    v_mfma_f32_16x16x32_bf16 v[52:55], v[136:139], a[84:87], v[52:55]
    s_add_u32 m0, s38, 73728
    s_add_u32 s32, s37, 1638400
    v_mfma_f32_16x16x32_bf16 v[80:83], v[136:139], a[88:91], v[80:83]
    buffer_load_dwordx4 v224, s[12:15], s32 offen lds
    v_mfma_f32_16x16x32_bf16 v[84:87], v[136:139], a[92:95], v[84:87]
    buffer_load_dwordx4 a[48:51], v226, s[8:11], s35 offen offset:3072 sc1
    v_mfma_f32_16x16x32_bf16 v[56:59], v[140:143], a[80:83], v[56:59]
    v_mfma_f32_16x16x32_bf16 v[60:63], v[140:143], a[84:87], v[60:63]
    buffer_load_dwordx4 v225, s[12:15], s32 offen offset:1024 lds
    v_mfma_f32_16x16x32_bf16 v[88:91], v[140:143], a[88:91], v[88:91]
    buffer_load_dwordx4 a[136:139], v228, s[8:11], s33 offen offset:2048 sc1
    v_mfma_f32_16x16x32_bf16 v[92:95], v[140:143], a[92:95], v[92:95]
    s_waitcnt lgkmcnt(0)
    v_mfma_f32_16x16x32_bf16 v[0:3], v[144:147], a[80:83], v[0:3]
    ds_read_b64_tr_b16 v[128:129], v216 offset:49152
    v_mfma_f32_16x16x32_bf16 v[4:7], v[144:147], a[84:87], v[4:7]
    ds_read_b64_tr_b16 v[130:131], v216 offset:51200
    v_mfma_f32_16x16x32_bf16 v[96:99], v[144:147], a[88:91], v[96:99]
    ds_read_b64_tr_b16 v[132:133], v217 offset:49152
    v_mfma_f32_16x16x32_bf16 v[100:103], v[144:147], a[92:95], v[100:103]
    ds_read_b64_tr_b16 v[134:135], v217 offset:51200
    v_mfma_f32_16x16x32_bf16 v[8:11], v[148:151], a[80:83], v[8:11]
    ds_read_b64_tr_b16 v[136:137], v218 offset:49152
    v_mfma_f32_16x16x32_bf16 v[12:15], v[148:151], a[84:87], v[12:15]
    ds_read_b64_tr_b16 v[138:139], v218 offset:51200
    v_mfma_f32_16x16x32_bf16 v[104:107], v[148:151], a[88:91], v[104:107]
    ds_read_b64_tr_b16 v[140:141], v219 offset:49152
    v_mfma_f32_16x16x32_bf16 v[108:111], v[148:151], a[92:95], v[108:111]
    ds_read_b64_tr_b16 v[142:143], v219 offset:51200
    v_mfma_f32_16x16x32_bf16 v[16:19], v[152:155], a[80:83], v[16:19]
    buffer_load_dwordx4 a[52:55], v227, s[8:11], s35 offen offset:3072 sc1
    v_mfma_f32_16x16x32_bf16 v[20:23], v[152:155], a[84:87], v[20:23]
    v_mfma_f32_16x16x32_bf16 v[112:115], v[152:155], a[88:91], v[112:115]
    v_mfma_f32_16x16x32_bf16 v[116:119], v[152:155], a[92:95], v[116:119]
    v_mfma_f32_16x16x32_bf16 v[24:27], v[156:159], a[80:83], v[24:27]
    buffer_load_dwordx4 a[56:59], v245, s[8:11], s35 offen offset:3072 sc1
    v_mfma_f32_16x16x32_bf16 v[28:31], v[156:159], a[84:87], v[28:31]
    v_mfma_f32_16x16x32_bf16 v[120:123], v[156:159], a[88:91], v[120:123]
    buffer_load_dwordx4 a[140:143], v228, s[8:11], s33 offen offset:3072 sc1
    v_mfma_f32_16x16x32_bf16 v[124:127], v[156:159], a[92:95], v[124:127]
    s_waitcnt vmcnt(31) lgkmcnt(0)
    v_mfma_f32_16x16x32_bf16 v[32:35], v[128:131], a[96:99], v[32:35]
    ds_read_b64_tr_b16 v[144:145], v220 offset:49152
    v_mfma_f32_16x16x32_bf16 v[36:39], v[128:131], a[100:103], v[36:39]
    ds_read_b64_tr_b16 v[146:147], v220 offset:51200
    v_mfma_f32_16x16x32_bf16 v[64:67], v[128:131], a[104:107], v[64:67]
    ds_read_b64_tr_b16 v[148:149], v221 offset:49152
    v_mfma_f32_16x16x32_bf16 v[68:71], v[128:131], a[108:111], v[68:71]
    ds_read_b64_tr_b16 v[150:151], v221 offset:51200
    v_mfma_f32_16x16x32_bf16 v[40:43], v[132:135], a[96:99], v[40:43]
    ds_read_b64_tr_b16 v[152:153], v222 offset:49152
    v_mfma_f32_16x16x32_bf16 v[44:47], v[132:135], a[100:103], v[44:47]
    ds_read_b64_tr_b16 v[154:155], v222 offset:51200
    v_mfma_f32_16x16x32_bf16 v[72:75], v[132:135], a[104:107], v[72:75]
    ds_read_b64_tr_b16 v[156:157], v223 offset:49152
    v_mfma_f32_16x16x32_bf16 v[76:79], v[132:135], a[108:111], v[76:79]
    ds_read_b64_tr_b16 v[158:159], v223 offset:51200
    v_mfma_f32_16x16x32_bf16 v[48:51], v[136:139], a[96:99], v[48:51]
    buffer_load_dwordx4 a[60:63], v246, s[8:11], s35 offen offset:3072 sc1
    v_mfma_f32_16x16x32_bf16 v[52:55], v[136:139], a[100:103], v[52:55]
    s_add_u32 m0, s38, 81920
    s_add_u32 s32, s37, 1703936
    v_mfma_f32_16x16x32_bf16 v[80:83], v[136:139], a[104:107], v[80:83]
    buffer_load_dwordx4 v224, s[12:15], s32 offen lds
    v_mfma_f32_16x16x32_bf16 v[84:87], v[136:139], a[108:111], v[84:87]
    s_add_u32 s35, s35, 4096
    buffer_load_dwordx4 a[64:67], v226, s[8:11], s35 offen offset:0 sc1
    v_mfma_f32_16x16x32_bf16 v[56:59], v[140:143], a[96:99], v[56:59]
    v_mfma_f32_16x16x32_bf16 v[60:63], v[140:143], a[100:103], v[60:63]
    buffer_load_dwordx4 v225, s[12:15], s32 offen offset:1024 lds
    v_mfma_f32_16x16x32_bf16 v[88:91], v[140:143], a[104:107], v[88:91]
    s_add_u32 s33, s55, 4096
    buffer_load_dwordx4 a[144:147], v228, s[8:11], s33 offen offset:0 sc1
    v_mfma_f32_16x16x32_bf16 v[92:95], v[140:143], a[108:111], v[92:95]
    s_waitcnt lgkmcnt(0)
    v_mfma_f32_16x16x32_bf16 v[0:3], v[144:147], a[96:99], v[0:3]
    ds_read_b64_tr_b16 v[128:129], v216 offset:57344
    v_mfma_f32_16x16x32_bf16 v[4:7], v[144:147], a[100:103], v[4:7]
    ds_read_b64_tr_b16 v[130:131], v216 offset:59392
    v_mfma_f32_16x16x32_bf16 v[96:99], v[144:147], a[104:107], v[96:99]
    ds_read_b64_tr_b16 v[132:133], v217 offset:57344
    v_mfma_f32_16x16x32_bf16 v[100:103], v[144:147], a[108:111], v[100:103]
    ds_read_b64_tr_b16 v[134:135], v217 offset:59392
    v_mfma_f32_16x16x32_bf16 v[8:11], v[148:151], a[96:99], v[8:11]
    ds_read_b64_tr_b16 v[136:137], v218 offset:57344
    v_mfma_f32_16x16x32_bf16 v[12:15], v[148:151], a[100:103], v[12:15]
    ds_read_b64_tr_b16 v[138:139], v218 offset:59392
    v_mfma_f32_16x16x32_bf16 v[104:107], v[148:151], a[104:107], v[104:107]
    ds_read_b64_tr_b16 v[140:141], v219 offset:57344
    v_mfma_f32_16x16x32_bf16 v[108:111], v[148:151], a[108:111], v[108:111]
    ds_read_b64_tr_b16 v[142:143], v219 offset:59392
    v_mfma_f32_16x16x32_bf16 v[16:19], v[152:155], a[96:99], v[16:19]
    buffer_load_dwordx4 a[68:71], v227, s[8:11], s35 offen offset:0 sc1
    v_mfma_f32_16x16x32_bf16 v[20:23], v[152:155], a[100:103], v[20:23]
    v_mfma_f32_16x16x32_bf16 v[112:115], v[152:155], a[104:107], v[112:115]
    v_mfma_f32_16x16x32_bf16 v[116:119], v[152:155], a[108:111], v[116:119]
    v_mfma_f32_16x16x32_bf16 v[24:27], v[156:159], a[96:99], v[24:27]
    buffer_load_dwordx4 a[72:75], v245, s[8:11], s35 offen offset:0 sc1
    v_mfma_f32_16x16x32_bf16 v[28:31], v[156:159], a[100:103], v[28:31]
    v_mfma_f32_16x16x32_bf16 v[120:123], v[156:159], a[104:107], v[120:123]
    buffer_load_dwordx4 a[148:151], v228, s[8:11], s33 offen offset:1024 sc1
    v_mfma_f32_16x16x32_bf16 v[124:127], v[156:159], a[108:111], v[124:127]
    buffer_load_dwordx4 a[76:79], v246, s[8:11], s35 offen offset:0 sc1
    s_waitcnt vmcnt(34) lgkmcnt(0)
    v_mfma_f32_16x16x32_bf16 v[32:35], v[128:131], a[112:115], v[32:35]
    ds_read_b64_tr_b16 v[144:145], v220 offset:57344
    v_mfma_f32_16x16x32_bf16 v[36:39], v[128:131], a[116:119], v[36:39]
    ds_read_b64_tr_b16 v[146:147], v220 offset:59392
    v_mfma_f32_16x16x32_bf16 v[64:67], v[128:131], a[120:123], v[64:67]
    ds_read_b64_tr_b16 v[148:149], v221 offset:57344
    v_mfma_f32_16x16x32_bf16 v[68:71], v[128:131], a[124:127], v[68:71]
    ds_read_b64_tr_b16 v[150:151], v221 offset:59392
    v_mfma_f32_16x16x32_bf16 v[40:43], v[132:135], a[112:115], v[40:43]
    ds_read_b64_tr_b16 v[152:153], v222 offset:57344
    v_mfma_f32_16x16x32_bf16 v[44:47], v[132:135], a[116:119], v[44:47]
    ds_read_b64_tr_b16 v[154:155], v222 offset:59392
    v_mfma_f32_16x16x32_bf16 v[72:75], v[132:135], a[120:123], v[72:75]
    ds_read_b64_tr_b16 v[156:157], v223 offset:57344
    v_mfma_f32_16x16x32_bf16 v[76:79], v[132:135], a[124:127], v[76:79]
    ds_read_b64_tr_b16 v[158:159], v223 offset:59392
    v_mfma_f32_16x16x32_bf16 v[48:51], v[136:139], a[112:115], v[48:51]
    buffer_load_dwordx4 a[80:83], v226, s[8:11], s35 offen offset:1024 sc1
    v_mfma_f32_16x16x32_bf16 v[52:55], v[136:139], a[116:119], v[52:55]
    s_add_u32 m0, s38, 90112
    s_add_u32 s32, s37, 1769472
    v_mfma_f32_16x16x32_bf16 v[80:83], v[136:139], a[120:123], v[80:83]
    buffer_load_dwordx4 v224, s[12:15], s32 offen lds
    v_mfma_f32_16x16x32_bf16 v[84:87], v[136:139], a[124:127], v[84:87]
    buffer_load_dwordx4 a[84:87], v227, s[8:11], s35 offen offset:1024 sc1
    v_mfma_f32_16x16x32_bf16 v[56:59], v[140:143], a[112:115], v[56:59]
    v_mfma_f32_16x16x32_bf16 v[60:63], v[140:143], a[116:119], v[60:63]
    buffer_load_dwordx4 v225, s[12:15], s32 offen offset:1024 lds
    v_mfma_f32_16x16x32_bf16 v[88:91], v[140:143], a[120:123], v[88:91]
    buffer_load_dwordx4 a[152:155], v228, s[8:11], s33 offen offset:2048 sc1
    v_mfma_f32_16x16x32_bf16 v[92:95], v[140:143], a[124:127], v[92:95]
    s_waitcnt vmcnt(60) lgkmcnt(0)
    s_barrier
    v_mfma_f32_16x16x32_bf16 v[0:3], v[144:147], a[112:115], v[0:3]
    v_xor_b32 v216, 0x10000, v216
    ds_read_b64_tr_b16 v[128:129], v216 offset:0
    v_mfma_f32_16x16x32_bf16 v[4:7], v[144:147], a[116:119], v[4:7]
    ds_read_b64_tr_b16 v[130:131], v216 offset:2048
    v_mfma_f32_16x16x32_bf16 v[96:99], v[144:147], a[120:123], v[96:99]
    v_xor_b32 v217, 0x10000, v217
    ds_read_b64_tr_b16 v[132:133], v217 offset:0
    v_mfma_f32_16x16x32_bf16 v[100:103], v[144:147], a[124:127], v[100:103]
    ds_read_b64_tr_b16 v[134:135], v217 offset:2048
    v_mfma_f32_16x16x32_bf16 v[8:11], v[148:151], a[112:115], v[8:11]
    v_xor_b32 v218, 0x10000, v218
    ds_read_b64_tr_b16 v[136:137], v218 offset:0
    v_mfma_f32_16x16x32_bf16 v[12:15], v[148:151], a[116:119], v[12:15]
    ds_read_b64_tr_b16 v[138:139], v218 offset:2048
    v_mfma_f32_16x16x32_bf16 v[104:107], v[148:151], a[120:123], v[104:107]
    v_xor_b32 v219, 0x10000, v219
    ds_read_b64_tr_b16 v[140:141], v219 offset:0
    v_mfma_f32_16x16x32_bf16 v[108:111], v[148:151], a[124:127], v[108:111]
    ds_read_b64_tr_b16 v[142:143], v219 offset:2048
    v_mfma_f32_16x16x32_bf16 v[16:19], v[152:155], a[112:115], v[16:19]
    buffer_load_dwordx4 a[88:91], v245, s[8:11], s35 offen offset:1024 sc1
    v_mfma_f32_16x16x32_bf16 v[20:23], v[152:155], a[116:119], v[20:23]
    v_mfma_f32_16x16x32_bf16 v[112:115], v[152:155], a[120:123], v[112:115]
    v_mfma_f32_16x16x32_bf16 v[116:119], v[152:155], a[124:127], v[116:119]
    v_mfma_f32_16x16x32_bf16 v[24:27], v[156:159], a[112:115], v[24:27]
    buffer_load_dwordx4 a[92:95], v246, s[8:11], s35 offen offset:1024 sc1
    v_mfma_f32_16x16x32_bf16 v[28:31], v[156:159], a[116:119], v[28:31]
    v_mfma_f32_16x16x32_bf16 v[120:123], v[156:159], a[120:123], v[120:123]
    buffer_load_dwordx4 a[156:159], v228, s[8:11], s33 offen offset:3072 sc1
    v_mfma_f32_16x16x32_bf16 v[124:127], v[156:159], a[124:127], v[124:127]
    s_waitcnt vmcnt(37) lgkmcnt(0)
    v_mfma_f32_16x16x32_bf16 v[32:35], v[128:131], a[0:3], v[32:35]
    v_xor_b32 v220, 0x10000, v220
    ds_read_b64_tr_b16 v[144:145], v220 offset:0
    v_mfma_f32_16x16x32_bf16 v[36:39], v[128:131], a[4:7], v[36:39]
    ds_read_b64_tr_b16 v[146:147], v220 offset:2048
    v_mfma_f32_16x16x32_bf16 v[64:67], v[128:131], a[8:11], v[64:67]
    v_xor_b32 v221, 0x10000, v221
    ds_read_b64_tr_b16 v[148:149], v221 offset:0
    v_mfma_f32_16x16x32_bf16 v[68:71], v[128:131], a[12:15], v[68:71]
    ds_read_b64_tr_b16 v[150:151], v221 offset:2048
    v_mfma_f32_16x16x32_bf16 v[40:43], v[132:135], a[0:3], v[40:43]
    v_xor_b32 v222, 0x10000, v222
    ds_read_b64_tr_b16 v[152:153], v222 offset:0
    v_mfma_f32_16x16x32_bf16 v[44:47], v[132:135], a[4:7], v[44:47]
    ds_read_b64_tr_b16 v[154:155], v222 offset:2048
    v_mfma_f32_16x16x32_bf16 v[72:75], v[132:135], a[8:11], v[72:75]
    v_xor_b32 v223, 0x10000, v223
    ds_read_b64_tr_b16 v[156:157], v223 offset:0
    v_mfma_f32_16x16x32_bf16 v[76:79], v[132:135], a[12:15], v[76:79]
    ds_read_b64_tr_b16 v[158:159], v223 offset:2048
    v_mfma_f32_16x16x32_bf16 v[48:51], v[136:139], a[0:3], v[48:51]
    buffer_load_dwordx4 a[96:99], v226, s[8:11], s35 offen offset:2048 sc1
    v_mfma_f32_16x16x32_bf16 v[52:55], v[136:139], a[4:7], v[52:55]
    s_add_u32 m0, s38, 98304
    s_add_u32 s32, s37, 1835008
    v_mfma_f32_16x16x32_bf16 v[80:83], v[136:139], a[8:11], v[80:83]
    buffer_load_dwordx4 v224, s[12:15], s32 offen lds
    v_mfma_f32_16x16x32_bf16 v[84:87], v[136:139], a[12:15], v[84:87]
    buffer_load_dwordx4 a[100:103], v227, s[8:11], s35 offen offset:2048 sc1
    v_mfma_f32_16x16x32_bf16 v[56:59], v[140:143], a[0:3], v[56:59]
    v_mfma_f32_16x16x32_bf16 v[60:63], v[140:143], a[4:7], v[60:63]
    buffer_load_dwordx4 v225, s[12:15], s32 offen offset:1024 lds
    v_mfma_f32_16x16x32_bf16 v[88:91], v[140:143], a[8:11], v[88:91]
    s_add_u32 s33, s55, 32768
    buffer_load_dwordx4 a[160:163], v228, s[8:11], s33 offen offset:0 sc1
    v_mfma_f32_16x16x32_bf16 v[92:95], v[140:143], a[12:15], v[92:95]
    s_waitcnt lgkmcnt(0)
    v_mfma_f32_16x16x32_bf16 v[0:3], v[144:147], a[0:3], v[0:3]
    ds_read_b64_tr_b16 v[128:129], v216 offset:8192
    v_mfma_f32_16x16x32_bf16 v[4:7], v[144:147], a[4:7], v[4:7]
    ds_read_b64_tr_b16 v[130:131], v216 offset:10240
    v_mfma_f32_16x16x32_bf16 v[96:99], v[144:147], a[8:11], v[96:99]
    ds_read_b64_tr_b16 v[132:133], v217 offset:8192
    v_mfma_f32_16x16x32_bf16 v[100:103], v[144:147], a[12:15], v[100:103]
    ds_read_b64_tr_b16 v[134:135], v217 offset:10240
    v_mfma_f32_16x16x32_bf16 v[8:11], v[148:151], a[0:3], v[8:11]
    ds_read_b64_tr_b16 v[136:137], v218 offset:8192
    v_mfma_f32_16x16x32_bf16 v[12:15], v[148:151], a[4:7], v[12:15]
    ds_read_b64_tr_b16 v[138:139], v218 offset:10240
    v_mfma_f32_16x16x32_bf16 v[104:107], v[148:151], a[8:11], v[104:107]
    ds_read_b64_tr_b16 v[140:141], v219 offset:8192
    v_mfma_f32_16x16x32_bf16 v[108:111], v[148:151], a[12:15], v[108:111]
    ds_read_b64_tr_b16 v[142:143], v219 offset:10240
    v_mfma_f32_16x16x32_bf16 v[16:19], v[152:155], a[0:3], v[16:19]
    buffer_load_dwordx4 a[104:107], v245, s[8:11], s35 offen offset:2048 sc1
    v_mfma_f32_16x16x32_bf16 v[20:23], v[152:155], a[4:7], v[20:23]
    v_mfma_f32_16x16x32_bf16 v[112:115], v[152:155], a[8:11], v[112:115]
    v_mfma_f32_16x16x32_bf16 v[116:119], v[152:155], a[12:15], v[116:119]
    v_mfma_f32_16x16x32_bf16 v[24:27], v[156:159], a[0:3], v[24:27]
    buffer_load_dwordx4 a[108:111], v246, s[8:11], s35 offen offset:2048 sc1
    v_mfma_f32_16x16x32_bf16 v[28:31], v[156:159], a[4:7], v[28:31]
    v_mfma_f32_16x16x32_bf16 v[120:123], v[156:159], a[8:11], v[120:123]
    buffer_load_dwordx4 a[164:167], v228, s[8:11], s33 offen offset:1024 sc1
    v_mfma_f32_16x16x32_bf16 v[124:127], v[156:159], a[12:15], v[124:127]
    buffer_load_dwordx4 a[112:115], v226, s[8:11], s35 offen offset:3072 sc1
    s_waitcnt vmcnt(40) lgkmcnt(0)
    v_mfma_f32_16x16x32_bf16 v[32:35], v[128:131], a[16:19], v[32:35]
    ds_read_b64_tr_b16 v[144:145], v220 offset:8192
    v_mfma_f32_16x16x32_bf16 v[36:39], v[128:131], a[20:23], v[36:39]
    ds_read_b64_tr_b16 v[146:147], v220 offset:10240
    v_mfma_f32_16x16x32_bf16 v[64:67], v[128:131], a[24:27], v[64:67]
    ds_read_b64_tr_b16 v[148:149], v221 offset:8192
    v_mfma_f32_16x16x32_bf16 v[68:71], v[128:131], a[28:31], v[68:71]
    ds_read_b64_tr_b16 v[150:151], v221 offset:10240
    v_mfma_f32_16x16x32_bf16 v[40:43], v[132:135], a[16:19], v[40:43]
    ds_read_b64_tr_b16 v[152:153], v222 offset:8192
    v_mfma_f32_16x16x32_bf16 v[44:47], v[132:135], a[20:23], v[44:47]
    ds_read_b64_tr_b16 v[154:155], v222 offset:10240
    v_mfma_f32_16x16x32_bf16 v[72:75], v[132:135], a[24:27], v[72:75]
    ds_read_b64_tr_b16 v[156:157], v223 offset:8192
    v_mfma_f32_16x16x32_bf16 v[76:79], v[132:135], a[28:31], v[76:79]
    ds_read_b64_tr_b16 v[158:159], v223 offset:10240
    v_mfma_f32_16x16x32_bf16 v[48:51], v[136:139], a[16:19], v[48:51]
    buffer_load_dwordx4 a[116:119], v227, s[8:11], s35 offen offset:3072 sc1
    v_mfma_f32_16x16x32_bf16 v[52:55], v[136:139], a[20:23], v[52:55]
    s_add_u32 m0, s38, 106496
    s_add_u32 s32, s37, 1900544
    v_mfma_f32_16x16x32_bf16 v[80:83], v[136:139], a[24:27], v[80:83]
    buffer_load_dwordx4 v224, s[12:15], s32 offen lds
    v_mfma_f32_16x16x32_bf16 v[84:87], v[136:139], a[28:31], v[84:87]
    buffer_load_dwordx4 a[120:123], v245, s[8:11], s35 offen offset:3072 sc1
    v_mfma_f32_16x16x32_bf16 v[56:59], v[140:143], a[16:19], v[56:59]
    v_mfma_f32_16x16x32_bf16 v[60:63], v[140:143], a[20:23], v[60:63]
    buffer_load_dwordx4 v225, s[12:15], s32 offen offset:1024 lds
    v_mfma_f32_16x16x32_bf16 v[88:91], v[140:143], a[24:27], v[88:91]
    buffer_load_dwordx4 a[168:171], v228, s[8:11], s33 offen offset:2048 sc1
    v_mfma_f32_16x16x32_bf16 v[92:95], v[140:143], a[28:31], v[92:95]
    s_waitcnt lgkmcnt(0)
    v_mfma_f32_16x16x32_bf16 v[0:3], v[144:147], a[16:19], v[0:3]
    ds_read_b64_tr_b16 v[128:129], v216 offset:16384
    v_mfma_f32_16x16x32_bf16 v[4:7], v[144:147], a[20:23], v[4:7]
    ds_read_b64_tr_b16 v[130:131], v216 offset:18432
    v_mfma_f32_16x16x32_bf16 v[96:99], v[144:147], a[24:27], v[96:99]
    ds_read_b64_tr_b16 v[132:133], v217 offset:16384
    v_mfma_f32_16x16x32_bf16 v[100:103], v[144:147], a[28:31], v[100:103]
    ds_read_b64_tr_b16 v[134:135], v217 offset:18432
    v_mfma_f32_16x16x32_bf16 v[8:11], v[148:151], a[16:19], v[8:11]
    ds_read_b64_tr_b16 v[136:137], v218 offset:16384
    v_mfma_f32_16x16x32_bf16 v[12:15], v[148:151], a[20:23], v[12:15]
    ds_read_b64_tr_b16 v[138:139], v218 offset:18432
    v_mfma_f32_16x16x32_bf16 v[104:107], v[148:151], a[24:27], v[104:107]
    ds_read_b64_tr_b16 v[140:141], v219 offset:16384
    v_mfma_f32_16x16x32_bf16 v[108:111], v[148:151], a[28:31], v[108:111]
    ds_read_b64_tr_b16 v[142:143], v219 offset:18432
    v_mfma_f32_16x16x32_bf16 v[16:19], v[152:155], a[16:19], v[16:19]
    buffer_load_dwordx4 a[124:127], v246, s[8:11], s35 offen offset:3072 sc1
    v_mfma_f32_16x16x32_bf16 v[20:23], v[152:155], a[20:23], v[20:23]
    v_mfma_f32_16x16x32_bf16 v[112:115], v[152:155], a[24:27], v[112:115]
    v_mfma_f32_16x16x32_bf16 v[116:119], v[152:155], a[28:31], v[116:119]
    v_mfma_f32_16x16x32_bf16 v[24:27], v[156:159], a[16:19], v[24:27]
    s_add_u32 s35, s35, 4096
    buffer_load_dwordx4 a[0:3], v226, s[8:11], s35 offen offset:0 sc1
    v_mfma_f32_16x16x32_bf16 v[28:31], v[156:159], a[20:23], v[28:31]
    v_mfma_f32_16x16x32_bf16 v[120:123], v[156:159], a[24:27], v[120:123]
    buffer_load_dwordx4 a[172:175], v228, s[8:11], s33 offen offset:3072 sc1
    v_mfma_f32_16x16x32_bf16 v[124:127], v[156:159], a[28:31], v[124:127]
    s_waitcnt vmcnt(41) lgkmcnt(0)
    v_mfma_f32_16x16x32_bf16 v[32:35], v[128:131], a[32:35], v[32:35]
    ds_read_b64_tr_b16 v[144:145], v220 offset:16384
    v_mfma_f32_16x16x32_bf16 v[36:39], v[128:131], a[36:39], v[36:39]
    ds_read_b64_tr_b16 v[146:147], v220 offset:18432
    v_mfma_f32_16x16x32_bf16 v[64:67], v[128:131], a[40:43], v[64:67]
    ds_read_b64_tr_b16 v[148:149], v221 offset:16384
    v_mfma_f32_16x16x32_bf16 v[68:71], v[128:131], a[44:47], v[68:71]
    ds_read_b64_tr_b16 v[150:151], v221 offset:18432
    v_mfma_f32_16x16x32_bf16 v[40:43], v[132:135], a[32:35], v[40:43]
    ds_read_b64_tr_b16 v[152:153], v222 offset:16384
    v_mfma_f32_16x16x32_bf16 v[44:47], v[132:135], a[36:39], v[44:47]
    ds_read_b64_tr_b16 v[154:155], v222 offset:18432
    v_mfma_f32_16x16x32_bf16 v[72:75], v[132:135], a[40:43], v[72:75]
    ds_read_b64_tr_b16 v[156:157], v223 offset:16384
    v_mfma_f32_16x16x32_bf16 v[76:79], v[132:135], a[44:47], v[76:79]
    ds_read_b64_tr_b16 v[158:159], v223 offset:18432
    v_mfma_f32_16x16x32_bf16 v[48:51], v[136:139], a[32:35], v[48:51]
    buffer_load_dwordx4 a[4:7], v227, s[8:11], s35 offen offset:0 sc1
    v_mfma_f32_16x16x32_bf16 v[52:55], v[136:139], a[36:39], v[52:55]
    s_add_u32 m0, s38, 114688
    s_add_u32 s32, s37, 1966080
    v_mfma_f32_16x16x32_bf16 v[80:83], v[136:139], a[40:43], v[80:83]
    buffer_load_dwordx4 v224, s[12:15], s32 offen lds
    v_mfma_f32_16x16x32_bf16 v[84:87], v[136:139], a[44:47], v[84:87]
    buffer_load_dwordx4 a[8:11], v245, s[8:11], s35 offen offset:0 sc1
    v_mfma_f32_16x16x32_bf16 v[56:59], v[140:143], a[32:35], v[56:59]
    v_mfma_f32_16x16x32_bf16 v[60:63], v[140:143], a[36:39], v[60:63]
    buffer_load_dwordx4 v225, s[12:15], s32 offen offset:1024 lds
    v_mfma_f32_16x16x32_bf16 v[88:91], v[140:143], a[40:43], v[88:91]
    s_add_u32 s33, s55, 36864
    buffer_load_dwordx4 a[176:179], v228, s[8:11], s33 offen offset:0 sc1
    v_mfma_f32_16x16x32_bf16 v[92:95], v[140:143], a[44:47], v[92:95]
    s_waitcnt lgkmcnt(0)
    v_mfma_f32_16x16x32_bf16 v[0:3], v[144:147], a[32:35], v[0:3]
    ds_read_b64_tr_b16 v[128:129], v216 offset:24576
    v_mfma_f32_16x16x32_bf16 v[4:7], v[144:147], a[36:39], v[4:7]
    ds_read_b64_tr_b16 v[130:131], v216 offset:26624
    v_mfma_f32_16x16x32_bf16 v[96:99], v[144:147], a[40:43], v[96:99]
    ds_read_b64_tr_b16 v[132:133], v217 offset:24576
    v_mfma_f32_16x16x32_bf16 v[100:103], v[144:147], a[44:47], v[100:103]
    ds_read_b64_tr_b16 v[134:135], v217 offset:26624
    v_mfma_f32_16x16x32_bf16 v[8:11], v[148:151], a[32:35], v[8:11]
    ds_read_b64_tr_b16 v[136:137], v218 offset:24576
    v_mfma_f32_16x16x32_bf16 v[12:15], v[148:151], a[36:39], v[12:15]
    ds_read_b64_tr_b16 v[138:139], v218 offset:26624
    v_mfma_f32_16x16x32_bf16 v[104:107], v[148:151], a[40:43], v[104:107]
    ds_read_b64_tr_b16 v[140:141], v219 offset:24576
    v_mfma_f32_16x16x32_bf16 v[108:111], v[148:151], a[44:47], v[108:111]
    ds_read_b64_tr_b16 v[142:143], v219 offset:26624
    v_mfma_f32_16x16x32_bf16 v[16:19], v[152:155], a[32:35], v[16:19]
    buffer_load_dwordx4 a[12:15], v246, s[8:11], s35 offen offset:0 sc1
    v_mfma_f32_16x16x32_bf16 v[20:23], v[152:155], a[36:39], v[20:23]
    v_mfma_f32_16x16x32_bf16 v[112:115], v[152:155], a[40:43], v[112:115]
    v_mfma_f32_16x16x32_bf16 v[116:119], v[152:155], a[44:47], v[116:119]
    v_mfma_f32_16x16x32_bf16 v[24:27], v[156:159], a[32:35], v[24:27]
    buffer_load_dwordx4 a[16:19], v226, s[8:11], s35 offen offset:1024 sc1
    v_mfma_f32_16x16x32_bf16 v[28:31], v[156:159], a[36:39], v[28:31]
    v_mfma_f32_16x16x32_bf16 v[120:123], v[156:159], a[40:43], v[120:123]
    buffer_load_dwordx4 a[180:183], v228, s[8:11], s33 offen offset:1024 sc1
    v_mfma_f32_16x16x32_bf16 v[124:127], v[156:159], a[44:47], v[124:127]
    buffer_load_dwordx4 a[20:23], v227, s[8:11], s35 offen offset:1024 sc1
    s_waitcnt vmcnt(42) lgkmcnt(0)
    v_mfma_f32_16x16x32_bf16 v[32:35], v[128:131], a[48:51], v[32:35]
    ds_read_b64_tr_b16 v[144:145], v220 offset:24576
    v_mfma_f32_16x16x32_bf16 v[36:39], v[128:131], a[52:55], v[36:39]
    ds_read_b64_tr_b16 v[146:147], v220 offset:26624
    v_mfma_f32_16x16x32_bf16 v[64:67], v[128:131], a[56:59], v[64:67]
    ds_read_b64_tr_b16 v[148:149], v221 offset:24576
    v_mfma_f32_16x16x32_bf16 v[68:71], v[128:131], a[60:63], v[68:71]
    ds_read_b64_tr_b16 v[150:151], v221 offset:26624
    v_mfma_f32_16x16x32_bf16 v[40:43], v[132:135], a[48:51], v[40:43]
    ds_read_b64_tr_b16 v[152:153], v222 offset:24576
    v_mfma_f32_16x16x32_bf16 v[44:47], v[132:135], a[52:55], v[44:47]
    ds_read_b64_tr_b16 v[154:155], v222 offset:26624
    v_mfma_f32_16x16x32_bf16 v[72:75], v[132:135], a[56:59], v[72:75]
    ds_read_b64_tr_b16 v[156:157], v223 offset:24576
    v_mfma_f32_16x16x32_bf16 v[76:79], v[132:135], a[60:63], v[76:79]
    ds_read_b64_tr_b16 v[158:159], v223 offset:26624
    v_mfma_f32_16x16x32_bf16 v[48:51], v[136:139], a[48:51], v[48:51]
    buffer_load_dwordx4 a[24:27], v245, s[8:11], s35 offen offset:1024 sc1
    v_mfma_f32_16x16x32_bf16 v[52:55], v[136:139], a[52:55], v[52:55]
    s_add_u32 m0, s38, 122880
    s_add_u32 s32, s37, 2031616
    v_mfma_f32_16x16x32_bf16 v[80:83], v[136:139], a[56:59], v[80:83]
    buffer_load_dwordx4 v224, s[12:15], s32 offen lds
    v_mfma_f32_16x16x32_bf16 v[84:87], v[136:139], a[60:63], v[84:87]
    buffer_load_dwordx4 a[28:31], v246, s[8:11], s35 offen offset:1024 sc1
    v_mfma_f32_16x16x32_bf16 v[56:59], v[140:143], a[48:51], v[56:59]
    v_mfma_f32_16x16x32_bf16 v[60:63], v[140:143], a[52:55], v[60:63]
    buffer_load_dwordx4 v225, s[12:15], s32 offen offset:1024 lds
    v_mfma_f32_16x16x32_bf16 v[88:91], v[140:143], a[56:59], v[88:91]
    buffer_load_dwordx4 a[184:187], v228, s[8:11], s33 offen offset:2048 sc1
    v_mfma_f32_16x16x32_bf16 v[92:95], v[140:143], a[60:63], v[92:95]
    s_waitcnt vmcnt(63) lgkmcnt(0)
    s_barrier
    v_mfma_f32_16x16x32_bf16 v[0:3], v[144:147], a[48:51], v[0:3]
    ds_read_b64_tr_b16 v[128:129], v216 offset:32768
    v_mfma_f32_16x16x32_bf16 v[4:7], v[144:147], a[52:55], v[4:7]
    ds_read_b64_tr_b16 v[130:131], v216 offset:34816
    v_mfma_f32_16x16x32_bf16 v[96:99], v[144:147], a[56:59], v[96:99]
    ds_read_b64_tr_b16 v[132:133], v217 offset:32768
    v_mfma_f32_16x16x32_bf16 v[100:103], v[144:147], a[60:63], v[100:103]
    ds_read_b64_tr_b16 v[134:135], v217 offset:34816
    v_mfma_f32_16x16x32_bf16 v[8:11], v[148:151], a[48:51], v[8:11]
    ds_read_b64_tr_b16 v[136:137], v218 offset:32768
    v_mfma_f32_16x16x32_bf16 v[12:15], v[148:151], a[52:55], v[12:15]
    ds_read_b64_tr_b16 v[138:139], v218 offset:34816
    v_mfma_f32_16x16x32_bf16 v[104:107], v[148:151], a[56:59], v[104:107]
    ds_read_b64_tr_b16 v[140:141], v219 offset:32768
    v_mfma_f32_16x16x32_bf16 v[108:111], v[148:151], a[60:63], v[108:111]
    ds_read_b64_tr_b16 v[142:143], v219 offset:34816
    v_mfma_f32_16x16x32_bf16 v[16:19], v[152:155], a[48:51], v[16:19]
    buffer_load_dwordx4 a[32:35], v226, s[8:11], s35 offen offset:2048 sc1
    v_mfma_f32_16x16x32_bf16 v[20:23], v[152:155], a[52:55], v[20:23]
    v_mfma_f32_16x16x32_bf16 v[112:115], v[152:155], a[56:59], v[112:115]
    v_mfma_f32_16x16x32_bf16 v[116:119], v[152:155], a[60:63], v[116:119]
    v_mfma_f32_16x16x32_bf16 v[24:27], v[156:159], a[48:51], v[24:27]
    buffer_load_dwordx4 a[36:39], v227, s[8:11], s35 offen offset:2048 sc1
    v_mfma_f32_16x16x32_bf16 v[28:31], v[156:159], a[52:55], v[28:31]
    v_mfma_f32_16x16x32_bf16 v[120:123], v[156:159], a[56:59], v[120:123]
    buffer_load_dwordx4 a[188:191], v228, s[8:11], s33 offen offset:3072 sc1
    v_mfma_f32_16x16x32_bf16 v[124:127], v[156:159], a[60:63], v[124:127]
    s_waitcnt vmcnt(42) lgkmcnt(0)
    v_mfma_f32_16x16x32_bf16 v[32:35], v[128:131], a[64:67], v[32:35]
    ds_read_b64_tr_b16 v[144:145], v220 offset:32768
    v_mfma_f32_16x16x32_bf16 v[36:39], v[128:131], a[68:71], v[36:39]
    ds_read_b64_tr_b16 v[146:147], v220 offset:34816
    v_mfma_f32_16x16x32_bf16 v[64:67], v[128:131], a[72:75], v[64:67]
    ds_read_b64_tr_b16 v[148:149], v221 offset:32768
    v_mfma_f32_16x16x32_bf16 v[68:71], v[128:131], a[76:79], v[68:71]
    ds_read_b64_tr_b16 v[150:151], v221 offset:34816
    v_mfma_f32_16x16x32_bf16 v[40:43], v[132:135], a[64:67], v[40:43]
    ds_read_b64_tr_b16 v[152:153], v222 offset:32768
    v_mfma_f32_16x16x32_bf16 v[44:47], v[132:135], a[68:71], v[44:47]
    ds_read_b64_tr_b16 v[154:155], v222 offset:34816
    v_mfma_f32_16x16x32_bf16 v[72:75], v[132:135], a[72:75], v[72:75]
    ds_read_b64_tr_b16 v[156:157], v223 offset:32768
    v_mfma_f32_16x16x32_bf16 v[76:79], v[132:135], a[76:79], v[76:79]
    ds_read_b64_tr_b16 v[158:159], v223 offset:34816
    v_mfma_f32_16x16x32_bf16 v[48:51], v[136:139], a[64:67], v[48:51]
    buffer_load_dwordx4 a[40:43], v245, s[8:11], s35 offen offset:2048 sc1
    v_mfma_f32_16x16x32_bf16 v[52:55], v[136:139], a[68:71], v[52:55]
    v_mfma_f32_16x16x32_bf16 v[80:83], v[136:139], a[72:75], v[80:83]
    v_mfma_f32_16x16x32_bf16 v[84:87], v[136:139], a[76:79], v[84:87]
    buffer_load_dwordx4 a[44:47], v246, s[8:11], s35 offen offset:2048 sc1
    v_mfma_f32_16x16x32_bf16 v[56:59], v[140:143], a[64:67], v[56:59]
    v_mfma_f32_16x16x32_bf16 v[60:63], v[140:143], a[68:71], v[60:63]
    s_mov_b32 s32, 0
    buffer_load_dwordx4 v[192:195], v229, s[16:19], s32 offen
    v_mfma_f32_16x16x32_bf16 v[88:91], v[140:143], a[72:75], v[88:91]
    v_mfma_f32_16x16x32_bf16 v[92:95], v[140:143], a[76:79], v[92:95]
    s_waitcnt lgkmcnt(0)
    v_mfma_f32_16x16x32_bf16 v[0:3], v[144:147], a[64:67], v[0:3]
    ds_read_b64_tr_b16 v[128:129], v216 offset:40960
    v_mfma_f32_16x16x32_bf16 v[4:7], v[144:147], a[68:71], v[4:7]
    ds_read_b64_tr_b16 v[130:131], v216 offset:43008
    v_mfma_f32_16x16x32_bf16 v[96:99], v[144:147], a[72:75], v[96:99]
    ds_read_b64_tr_b16 v[132:133], v217 offset:40960
    v_mfma_f32_16x16x32_bf16 v[100:103], v[144:147], a[76:79], v[100:103]
    ds_read_b64_tr_b16 v[134:135], v217 offset:43008
    v_mfma_f32_16x16x32_bf16 v[8:11], v[148:151], a[64:67], v[8:11]
    ds_read_b64_tr_b16 v[136:137], v218 offset:40960
    v_mfma_f32_16x16x32_bf16 v[12:15], v[148:151], a[68:71], v[12:15]
    ds_read_b64_tr_b16 v[138:139], v218 offset:43008
    v_mfma_f32_16x16x32_bf16 v[104:107], v[148:151], a[72:75], v[104:107]
    ds_read_b64_tr_b16 v[140:141], v219 offset:40960
    v_mfma_f32_16x16x32_bf16 v[108:111], v[148:151], a[76:79], v[108:111]
    ds_read_b64_tr_b16 v[142:143], v219 offset:43008
    v_mfma_f32_16x16x32_bf16 v[16:19], v[152:155], a[64:67], v[16:19]
    buffer_load_dwordx4 a[48:51], v226, s[8:11], s35 offen offset:3072 sc1
    v_mfma_f32_16x16x32_bf16 v[20:23], v[152:155], a[68:71], v[20:23]
    v_mfma_f32_16x16x32_bf16 v[112:115], v[152:155], a[72:75], v[112:115]
    v_mfma_f32_16x16x32_bf16 v[116:119], v[152:155], a[76:79], v[116:119]
    v_mfma_f32_16x16x32_bf16 v[24:27], v[156:159], a[64:67], v[24:27]
    buffer_load_dwordx4 a[52:55], v227, s[8:11], s35 offen offset:3072 sc1
    v_mfma_f32_16x16x32_bf16 v[28:31], v[156:159], a[68:71], v[28:31]
    s_mov_b32 s32, 16384
    buffer_load_dwordx4 v[196:199], v229, s[16:19], s32 offen
    v_mfma_f32_16x16x32_bf16 v[120:123], v[156:159], a[72:75], v[120:123]
    v_mfma_f32_16x16x32_bf16 v[124:127], v[156:159], a[76:79], v[124:127]
    buffer_load_dwordx4 a[56:59], v245, s[8:11], s35 offen offset:3072 sc1
    s_waitcnt vmcnt(42) lgkmcnt(0)
    v_mfma_f32_16x16x32_bf16 v[32:35], v[128:131], a[80:83], v[32:35]
    ds_read_b64_tr_b16 v[144:145], v220 offset:40960
    v_mfma_f32_16x16x32_bf16 v[36:39], v[128:131], a[84:87], v[36:39]
    ds_read_b64_tr_b16 v[146:147], v220 offset:43008
    v_mfma_f32_16x16x32_bf16 v[64:67], v[128:131], a[88:91], v[64:67]
    ds_read_b64_tr_b16 v[148:149], v221 offset:40960
    v_mfma_f32_16x16x32_bf16 v[68:71], v[128:131], a[92:95], v[68:71]
    ds_read_b64_tr_b16 v[150:151], v221 offset:43008
    v_mfma_f32_16x16x32_bf16 v[40:43], v[132:135], a[80:83], v[40:43]
    ds_read_b64_tr_b16 v[152:153], v222 offset:40960
    v_mfma_f32_16x16x32_bf16 v[44:47], v[132:135], a[84:87], v[44:47]
    ds_read_b64_tr_b16 v[154:155], v222 offset:43008
    v_mfma_f32_16x16x32_bf16 v[72:75], v[132:135], a[88:91], v[72:75]
    ds_read_b64_tr_b16 v[156:157], v223 offset:40960
    v_mfma_f32_16x16x32_bf16 v[76:79], v[132:135], a[92:95], v[76:79]
    ds_read_b64_tr_b16 v[158:159], v223 offset:43008
    v_mfma_f32_16x16x32_bf16 v[48:51], v[136:139], a[80:83], v[48:51]
    buffer_load_dwordx4 a[60:63], v246, s[8:11], s35 offen offset:3072 sc1
    v_mfma_f32_16x16x32_bf16 v[52:55], v[136:139], a[84:87], v[52:55]
    v_mfma_f32_16x16x32_bf16 v[80:83], v[136:139], a[88:91], v[80:83]
    v_mfma_f32_16x16x32_bf16 v[84:87], v[136:139], a[92:95], v[84:87]
    s_add_u32 s35, s35, 4096
    buffer_load_dwordx4 a[64:67], v226, s[8:11], s35 offen offset:0 sc1
    v_mfma_f32_16x16x32_bf16 v[56:59], v[140:143], a[80:83], v[56:59]
    v_mfma_f32_16x16x32_bf16 v[60:63], v[140:143], a[84:87], v[60:63]
    s_mov_b32 s32, 32768
    buffer_load_dwordx4 v[200:203], v229, s[16:19], s32 offen
    v_mfma_f32_16x16x32_bf16 v[88:91], v[140:143], a[88:91], v[88:91]
    v_mfma_f32_16x16x32_bf16 v[92:95], v[140:143], a[92:95], v[92:95]
    s_waitcnt lgkmcnt(0)
    v_mfma_f32_16x16x32_bf16 v[0:3], v[144:147], a[80:83], v[0:3]
    ds_read_b64_tr_b16 v[128:129], v216 offset:49152
    v_mfma_f32_16x16x32_bf16 v[4:7], v[144:147], a[84:87], v[4:7]
    ds_read_b64_tr_b16 v[130:131], v216 offset:51200
    v_mfma_f32_16x16x32_bf16 v[96:99], v[144:147], a[88:91], v[96:99]
    ds_read_b64_tr_b16 v[132:133], v217 offset:49152
    v_mfma_f32_16x16x32_bf16 v[100:103], v[144:147], a[92:95], v[100:103]
    ds_read_b64_tr_b16 v[134:135], v217 offset:51200
    v_mfma_f32_16x16x32_bf16 v[8:11], v[148:151], a[80:83], v[8:11]
    ds_read_b64_tr_b16 v[136:137], v218 offset:49152
    v_mfma_f32_16x16x32_bf16 v[12:15], v[148:151], a[84:87], v[12:15]
    ds_read_b64_tr_b16 v[138:139], v218 offset:51200
    v_mfma_f32_16x16x32_bf16 v[104:107], v[148:151], a[88:91], v[104:107]
    ds_read_b64_tr_b16 v[140:141], v219 offset:49152
    v_mfma_f32_16x16x32_bf16 v[108:111], v[148:151], a[92:95], v[108:111]
    ds_read_b64_tr_b16 v[142:143], v219 offset:51200
    v_mfma_f32_16x16x32_bf16 v[16:19], v[152:155], a[80:83], v[16:19]
    buffer_load_dwordx4 a[68:71], v227, s[8:11], s35 offen offset:0 sc1
    v_mfma_f32_16x16x32_bf16 v[20:23], v[152:155], a[84:87], v[20:23]
    v_mfma_f32_16x16x32_bf16 v[112:115], v[152:155], a[88:91], v[112:115]
    v_mfma_f32_16x16x32_bf16 v[116:119], v[152:155], a[92:95], v[116:119]
    v_mfma_f32_16x16x32_bf16 v[24:27], v[156:159], a[80:83], v[24:27]
    buffer_load_dwordx4 a[72:75], v245, s[8:11], s35 offen offset:0 sc1
    v_mfma_f32_16x16x32_bf16 v[28:31], v[156:159], a[84:87], v[28:31]
    s_mov_b32 s32, 49152
    buffer_load_dwordx4 v[204:207], v229, s[16:19], s32 offen
    v_mfma_f32_16x16x32_bf16 v[120:123], v[156:159], a[88:91], v[120:123]
    v_mfma_f32_16x16x32_bf16 v[124:127], v[156:159], a[92:95], v[124:127]
    s_waitcnt vmcnt(40) lgkmcnt(0)
    v_mfma_f32_16x16x32_bf16 v[32:35], v[128:131], a[96:99], v[32:35]
    ds_read_b64_tr_b16 v[144:145], v220 offset:49152
    v_mfma_f32_16x16x32_bf16 v[36:39], v[128:131], a[100:103], v[36:39]
    ds_read_b64_tr_b16 v[146:147], v220 offset:51200
    v_mfma_f32_16x16x32_bf16 v[64:67], v[128:131], a[104:107], v[64:67]
    ds_read_b64_tr_b16 v[148:149], v221 offset:49152
    v_mfma_f32_16x16x32_bf16 v[68:71], v[128:131], a[108:111], v[68:71]
    ds_read_b64_tr_b16 v[150:151], v221 offset:51200
    v_mfma_f32_16x16x32_bf16 v[40:43], v[132:135], a[96:99], v[40:43]
    ds_read_b64_tr_b16 v[152:153], v222 offset:49152
    v_mfma_f32_16x16x32_bf16 v[44:47], v[132:135], a[100:103], v[44:47]
    ds_read_b64_tr_b16 v[154:155], v222 offset:51200
    v_mfma_f32_16x16x32_bf16 v[72:75], v[132:135], a[104:107], v[72:75]
    ds_read_b64_tr_b16 v[156:157], v223 offset:49152
    v_mfma_f32_16x16x32_bf16 v[76:79], v[132:135], a[108:111], v[76:79]
    ds_read_b64_tr_b16 v[158:159], v223 offset:51200
    v_mfma_f32_16x16x32_bf16 v[48:51], v[136:139], a[96:99], v[48:51]
    buffer_load_dwordx4 a[76:79], v246, s[8:11], s35 offen offset:0 sc1
    v_mfma_f32_16x16x32_bf16 v[52:55], v[136:139], a[100:103], v[52:55]
    v_mfma_f32_16x16x32_bf16 v[80:83], v[136:139], a[104:107], v[80:83]
    v_mfma_f32_16x16x32_bf16 v[84:87], v[136:139], a[108:111], v[84:87]
    buffer_load_dwordx4 a[80:83], v226, s[8:11], s35 offen offset:1024 sc1
    v_mfma_f32_16x16x32_bf16 v[56:59], v[140:143], a[96:99], v[56:59]
    v_mfma_f32_16x16x32_bf16 v[60:63], v[140:143], a[100:103], v[60:63]
    buffer_load_dwordx4 v[208:211], v240, s[20:23], 0 offen
    v_mfma_f32_16x16x32_bf16 v[88:91], v[140:143], a[104:107], v[88:91]
    v_mfma_f32_16x16x32_bf16 v[92:95], v[140:143], a[108:111], v[92:95]
    s_waitcnt lgkmcnt(0)
    v_mfma_f32_16x16x32_bf16 v[0:3], v[144:147], a[96:99], v[0:3]
    ds_read_b64_tr_b16 v[128:129], v216 offset:57344
    v_mfma_f32_16x16x32_bf16 v[4:7], v[144:147], a[100:103], v[4:7]
    ds_read_b64_tr_b16 v[130:131], v216 offset:59392
    v_mfma_f32_16x16x32_bf16 v[96:99], v[144:147], a[104:107], v[96:99]
    ds_read_b64_tr_b16 v[132:133], v217 offset:57344
    v_mfma_f32_16x16x32_bf16 v[100:103], v[144:147], a[108:111], v[100:103]
    ds_read_b64_tr_b16 v[134:135], v217 offset:59392
    v_mfma_f32_16x16x32_bf16 v[8:11], v[148:151], a[96:99], v[8:11]
    ds_read_b64_tr_b16 v[136:137], v218 offset:57344
    v_mfma_f32_16x16x32_bf16 v[12:15], v[148:151], a[100:103], v[12:15]
    ds_read_b64_tr_b16 v[138:139], v218 offset:59392
    v_mfma_f32_16x16x32_bf16 v[104:107], v[148:151], a[104:107], v[104:107]
    ds_read_b64_tr_b16 v[140:141], v219 offset:57344
    v_mfma_f32_16x16x32_bf16 v[108:111], v[148:151], a[108:111], v[108:111]
    ds_read_b64_tr_b16 v[142:143], v219 offset:59392
    v_mfma_f32_16x16x32_bf16 v[16:19], v[152:155], a[96:99], v[16:19]
    buffer_load_dwordx4 a[84:87], v227, s[8:11], s35 offen offset:1024 sc1
    v_mfma_f32_16x16x32_bf16 v[20:23], v[152:155], a[100:103], v[20:23]
    v_mfma_f32_16x16x32_bf16 v[112:115], v[152:155], a[104:107], v[112:115]
    v_mfma_f32_16x16x32_bf16 v[116:119], v[152:155], a[108:111], v[116:119]
    v_mfma_f32_16x16x32_bf16 v[24:27], v[156:159], a[96:99], v[24:27]
    buffer_load_dwordx4 a[88:91], v245, s[8:11], s35 offen offset:1024 sc1
    v_mfma_f32_16x16x32_bf16 v[28:31], v[156:159], a[100:103], v[28:31]
    s_mov_b32 s32, kc_tail-kc_pc0
    v_lshlrev_b32 v234, 7, v230
    buffer_load_dword v241, v234, s[56:59], s32 offen
    v_mfma_f32_16x16x32_bf16 v[120:123], v[156:159], a[104:107], v[120:123]
    v_mfma_f32_16x16x32_bf16 v[124:127], v[156:159], a[108:111], v[124:127]
    buffer_load_dwordx4 a[92:95], v246, s[8:11], s35 offen offset:1024 sc1
    s_waitcnt vmcnt(39) lgkmcnt(0)
    v_mfma_f32_16x16x32_bf16 v[32:35], v[128:131], a[112:115], v[32:35]
    ds_read_b64_tr_b16 v[144:145], v220 offset:57344
    v_mfma_f32_16x16x32_bf16 v[36:39], v[128:131], a[116:119], v[36:39]
    ds_read_b64_tr_b16 v[146:147], v220 offset:59392
    v_mfma_f32_16x16x32_bf16 v[64:67], v[128:131], a[120:123], v[64:67]
    ds_read_b64_tr_b16 v[148:149], v221 offset:57344
    v_mfma_f32_16x16x32_bf16 v[68:71], v[128:131], a[124:127], v[68:71]
    ds_read_b64_tr_b16 v[150:151], v221 offset:59392
    v_mfma_f32_16x16x32_bf16 v[40:43], v[132:135], a[112:115], v[40:43]
    ds_read_b64_tr_b16 v[152:153], v222 offset:57344
    v_mfma_f32_16x16x32_bf16 v[44:47], v[132:135], a[116:119], v[44:47]
    ds_read_b64_tr_b16 v[154:155], v222 offset:59392
    v_mfma_f32_16x16x32_bf16 v[72:75], v[132:135], a[120:123], v[72:75]
    ds_read_b64_tr_b16 v[156:157], v223 offset:57344
    v_mfma_f32_16x16x32_bf16 v[76:79], v[132:135], a[124:127], v[76:79]
    ds_read_b64_tr_b16 v[158:159], v223 offset:59392
    v_mfma_f32_16x16x32_bf16 v[48:51], v[136:139], a[112:115], v[48:51]
    buffer_load_dwordx4 a[96:99], v226, s[8:11], s35 offen offset:2048 sc1
    v_mfma_f32_16x16x32_bf16 v[52:55], v[136:139], a[116:119], v[52:55]
    v_mfma_f32_16x16x32_bf16 v[80:83], v[136:139], a[120:123], v[80:83]
    v_mfma_f32_16x16x32_bf16 v[84:87], v[136:139], a[124:127], v[84:87]
    buffer_load_dwordx4 a[100:103], v227, s[8:11], s35 offen offset:2048 sc1
    v_mfma_f32_16x16x32_bf16 v[56:59], v[140:143], a[112:115], v[56:59]
    v_mfma_f32_16x16x32_bf16 v[60:63], v[140:143], a[116:119], v[60:63]
    v_mfma_f32_16x16x32_bf16 v[88:91], v[140:143], a[120:123], v[88:91]
    v_mfma_f32_16x16x32_bf16 v[92:95], v[140:143], a[124:127], v[92:95]
    s_waitcnt vmcnt(26) lgkmcnt(0)
    s_barrier
    v_mfma_f32_16x16x32_bf16 v[0:3], v[144:147], a[112:115], v[0:3]
    v_xor_b32 v220, 0x10000, v220
    ds_read_b64_tr_b16 v[128:129], v220 offset:0
    v_mfma_f32_16x16x32_bf16 v[4:7], v[144:147], a[116:119], v[4:7]
    ds_read_b64_tr_b16 v[130:131], v220 offset:2048
    v_mfma_f32_16x16x32_bf16 v[96:99], v[144:147], a[120:123], v[96:99]
    v_xor_b32 v221, 0x10000, v221
    ds_read_b64_tr_b16 v[132:133], v221 offset:0
    v_mfma_f32_16x16x32_bf16 v[100:103], v[144:147], a[124:127], v[100:103]
    ds_read_b64_tr_b16 v[134:135], v221 offset:2048
    v_mfma_f32_16x16x32_bf16 v[8:11], v[148:151], a[112:115], v[8:11]
    v_xor_b32 v222, 0x10000, v222
    ds_read_b64_tr_b16 v[136:137], v222 offset:0
    v_mfma_f32_16x16x32_bf16 v[12:15], v[148:151], a[116:119], v[12:15]
    ds_read_b64_tr_b16 v[138:139], v222 offset:2048
    v_mfma_f32_16x16x32_bf16 v[104:107], v[148:151], a[120:123], v[104:107]
    v_xor_b32 v223, 0x10000, v223
    ds_read_b64_tr_b16 v[140:141], v223 offset:0
    v_mfma_f32_16x16x32_bf16 v[108:111], v[148:151], a[124:127], v[108:111]
    ds_read_b64_tr_b16 v[142:143], v223 offset:2048
    v_mfma_f32_16x16x32_bf16 v[16:19], v[152:155], a[112:115], v[16:19]
    buffer_load_dwordx4 a[104:107], v245, s[8:11], s35 offen offset:2048 sc1
    v_mfma_f32_16x16x32_bf16 v[20:23], v[152:155], a[116:119], v[20:23]
    v_xor_b32 v216, 0x10000, v216
    v_mfma_f32_16x16x32_bf16 v[112:115], v[152:155], a[120:123], v[112:115]
    v_xor_b32 v217, 0x10000, v217
    v_mfma_f32_16x16x32_bf16 v[116:119], v[152:155], a[124:127], v[116:119]
    v_xor_b32 v218, 0x10000, v218
    v_mfma_f32_16x16x32_bf16 v[24:27], v[156:159], a[112:115], v[24:27]
    v_xor_b32 v219, 0x10000, v219
    buffer_load_dwordx4 a[108:111], v246, s[8:11], s35 offen offset:2048 sc1
    v_mfma_f32_16x16x32_bf16 v[28:31], v[156:159], a[116:119], v[28:31]
    v_mfma_f32_16x16x32_bf16 v[120:123], v[156:159], a[120:123], v[120:123]
    v_mfma_f32_16x16x32_bf16 v[124:127], v[156:159], a[124:127], v[124:127]
    s_waitcnt vmcnt(35) lgkmcnt(4)
    v_mfma_f32_16x16x32_bf16 v[96:99], v[128:131], a[8:11], v[96:99]
    ds_read_b64_tr_b16 v[144:145], v220 offset:8192
    v_mfma_f32_16x16x32_bf16 v[100:103], v[128:131], a[12:15], v[100:103]
    ds_read_b64_tr_b16 v[146:147], v220 offset:10240
    v_mfma_f32_16x16x32_bf16 v[104:107], v[132:135], a[8:11], v[104:107]
    ds_read_b64_tr_b16 v[148:149], v221 offset:8192
    buffer_load_dwordx4 a[112:115], v226, s[8:11], s35 offen offset:3072 sc1
    v_mfma_f32_16x16x32_bf16 v[108:111], v[132:135], a[12:15], v[108:111]
    ds_read_b64_tr_b16 v[150:151], v221 offset:10240
    s_waitcnt lgkmcnt(4)
    v_mfma_f32_16x16x32_bf16 v[112:115], v[136:139], a[8:11], v[112:115]
    ds_read_b64_tr_b16 v[152:153], v222 offset:8192
    v_mfma_f32_16x16x32_bf16 v[116:119], v[136:139], a[12:15], v[116:119]
    ds_read_b64_tr_b16 v[154:155], v222 offset:10240
    v_mfma_f32_16x16x32_bf16 v[120:123], v[140:143], a[8:11], v[120:123]
    ds_read_b64_tr_b16 v[156:157], v223 offset:8192
    buffer_load_dwordx4 a[116:119], v227, s[8:11], s35 offen offset:3072 sc1
    v_mfma_f32_16x16x32_bf16 v[124:127], v[140:143], a[12:15], v[124:127]
    ds_read_b64_tr_b16 v[158:159], v223 offset:10240
    s_waitcnt vmcnt(31) lgkmcnt(4)
    v_mfma_f32_16x16x32_bf16 v[96:99], v[144:147], a[24:27], v[96:99]
    ds_read_b64_tr_b16 v[128:129], v220 offset:16384
    v_mfma_f32_16x16x32_bf16 v[100:103], v[144:147], a[28:31], v[100:103]
    ds_read_b64_tr_b16 v[130:131], v220 offset:18432
    v_mfma_f32_16x16x32_bf16 v[104:107], v[148:151], a[24:27], v[104:107]
    ds_read_b64_tr_b16 v[132:133], v221 offset:16384
    buffer_load_dwordx4 a[120:123], v245, s[8:11], s35 offen offset:3072 sc1
    v_mfma_f32_16x16x32_bf16 v[108:111], v[148:151], a[28:31], v[108:111]
    ds_read_b64_tr_b16 v[134:135], v221 offset:18432
    s_waitcnt lgkmcnt(4)
    v_mfma_f32_16x16x32_bf16 v[112:115], v[152:155], a[24:27], v[112:115]
    ds_read_b64_tr_b16 v[136:137], v222 offset:16384
    v_mfma_f32_16x16x32_bf16 v[116:119], v[152:155], a[28:31], v[116:119]
    ds_read_b64_tr_b16 v[138:139], v222 offset:18432
    v_mfma_f32_16x16x32_bf16 v[120:123], v[156:159], a[24:27], v[120:123]
    ds_read_b64_tr_b16 v[140:141], v223 offset:16384
    buffer_load_dwordx4 a[124:127], v246, s[8:11], s35 offen offset:3072 sc1
    v_mfma_f32_16x16x32_bf16 v[124:127], v[156:159], a[28:31], v[124:127]
    ds_read_b64_tr_b16 v[142:143], v223 offset:18432
    s_waitcnt vmcnt(26) lgkmcnt(4)
    v_mfma_f32_16x16x32_bf16 v[96:99], v[128:131], a[40:43], v[96:99]
    ds_read_b64_tr_b16 v[144:145], v220 offset:24576
    v_mfma_f32_16x16x32_bf16 v[100:103], v[128:131], a[44:47], v[100:103]
    ds_read_b64_tr_b16 v[146:147], v220 offset:26624
    v_mfma_f32_16x16x32_bf16 v[104:107], v[132:135], a[40:43], v[104:107]
    ds_read_b64_tr_b16 v[148:149], v221 offset:24576
    v_mfma_f32_16x16x32_bf16 v[108:111], v[132:135], a[44:47], v[108:111]
    ds_read_b64_tr_b16 v[150:151], v221 offset:26624
    s_waitcnt lgkmcnt(4)
    v_mfma_f32_16x16x32_bf16 v[112:115], v[136:139], a[40:43], v[112:115]
    ds_read_b64_tr_b16 v[152:153], v222 offset:24576
    v_mfma_f32_16x16x32_bf16 v[116:119], v[136:139], a[44:47], v[116:119]
    ds_read_b64_tr_b16 v[154:155], v222 offset:26624
    v_mfma_f32_16x16x32_bf16 v[120:123], v[140:143], a[40:43], v[120:123]
    ds_read_b64_tr_b16 v[156:157], v223 offset:24576
    v_mfma_f32_16x16x32_bf16 v[124:127], v[140:143], a[44:47], v[124:127]
    ds_read_b64_tr_b16 v[158:159], v223 offset:26624
    s_waitcnt vmcnt(20) lgkmcnt(4)
    v_mfma_f32_16x16x32_bf16 v[96:99], v[144:147], a[56:59], v[96:99]
    ds_read_b64_tr_b16 v[128:129], v220 offset:32768
    v_mfma_f32_16x16x32_bf16 v[100:103], v[144:147], a[60:63], v[100:103]
    ds_read_b64_tr_b16 v[130:131], v220 offset:34816
    v_mfma_f32_16x16x32_bf16 v[104:107], v[148:151], a[56:59], v[104:107]
    ds_read_b64_tr_b16 v[132:133], v221 offset:32768
    v_mfma_f32_16x16x32_bf16 v[108:111], v[148:151], a[60:63], v[108:111]
    ds_read_b64_tr_b16 v[134:135], v221 offset:34816
    s_waitcnt lgkmcnt(4)
    v_mfma_f32_16x16x32_bf16 v[112:115], v[152:155], a[56:59], v[112:115]
    ds_read_b64_tr_b16 v[136:137], v222 offset:32768
    v_mfma_f32_16x16x32_bf16 v[116:119], v[152:155], a[60:63], v[116:119]
    ds_read_b64_tr_b16 v[138:139], v222 offset:34816
    v_mfma_f32_16x16x32_bf16 v[120:123], v[156:159], a[56:59], v[120:123]
    ds_read_b64_tr_b16 v[140:141], v223 offset:32768
    v_mfma_f32_16x16x32_bf16 v[124:127], v[156:159], a[60:63], v[124:127]
    ds_read_b64_tr_b16 v[142:143], v223 offset:34816
    s_waitcnt vmcnt(14) lgkmcnt(4)
    v_mfma_f32_16x16x32_bf16 v[96:99], v[128:131], a[72:75], v[96:99]
    ds_read_b64_tr_b16 v[144:145], v220 offset:40960
    v_mfma_f32_16x16x32_bf16 v[100:103], v[128:131], a[76:79], v[100:103]
    ds_read_b64_tr_b16 v[146:147], v220 offset:43008
    s_xor_b32 s7, s39, 24
    v_mfma_f32_16x16x32_bf16 v[104:107], v[132:135], a[72:75], v[104:107]
    ds_read_b64_tr_b16 v[148:149], v221 offset:40960
    v_mfma_f32_16x16x32_bf16 v[108:111], v[132:135], a[76:79], v[108:111]
    ds_read_b64_tr_b16 v[150:151], v221 offset:43008
    s_waitcnt lgkmcnt(4)
    v_mfma_f32_16x16x32_bf16 v[112:115], v[136:139], a[72:75], v[112:115]
    ds_read_b64_tr_b16 v[152:153], v222 offset:40960
    v_mfma_f32_16x16x32_bf16 v[116:119], v[136:139], a[76:79], v[116:119]
    ds_read_b64_tr_b16 v[154:155], v222 offset:43008
    s_mul_i32 s7, s7, 12288
    v_mfma_f32_16x16x32_bf16 v[120:123], v[140:143], a[72:75], v[120:123]
    ds_read_b64_tr_b16 v[156:157], v223 offset:40960
    s_add_u32 s7, s7, 0x5002000
    v_mfma_f32_16x16x32_bf16 v[124:127], v[140:143], a[76:79], v[124:127]
    ds_read_b64_tr_b16 v[158:159], v223 offset:43008
    s_waitcnt vmcnt(8) lgkmcnt(4)
    v_mfma_f32_16x16x32_bf16 v[96:99], v[144:147], a[88:91], v[96:99]
    ds_read_b64_tr_b16 v[128:129], v220 offset:49152
    v_mfma_f32_16x16x32_bf16 v[100:103], v[144:147], a[92:95], v[100:103]
    ds_read_b64_tr_b16 v[130:131], v220 offset:51200
    s_xor_b32 s37, s39, 8
    v_mfma_f32_16x16x32_bf16 v[104:107], v[148:151], a[88:91], v[104:107]
    ds_read_b64_tr_b16 v[132:133], v221 offset:49152
    v_mfma_f32_16x16x32_bf16 v[108:111], v[148:151], a[92:95], v[108:111]
    ds_read_b64_tr_b16 v[134:135], v221 offset:51200
    s_waitcnt lgkmcnt(4)
    v_mfma_f32_16x16x32_bf16 v[112:115], v[152:155], a[88:91], v[112:115]
    ds_read_b64_tr_b16 v[136:137], v222 offset:49152
    v_mfma_f32_16x16x32_bf16 v[116:119], v[152:155], a[92:95], v[116:119]
    ds_read_b64_tr_b16 v[138:139], v222 offset:51200
    s_mul_i32 s37, s37, 12288
    v_mfma_f32_16x16x32_bf16 v[120:123], v[156:159], a[88:91], v[120:123]
    ds_read_b64_tr_b16 v[140:141], v223 offset:49152
    s_add_u32 s37, s37, 0x5000000
    v_mfma_f32_16x16x32_bf16 v[124:127], v[156:159], a[92:95], v[124:127]
    ds_read_b64_tr_b16 v[142:143], v223 offset:51200
    s_waitcnt vmcnt(4) lgkmcnt(4)
    v_mfma_f32_16x16x32_bf16 v[96:99], v[128:131], a[104:107], v[96:99]
    ds_read_b64_tr_b16 v[144:145], v220 offset:57344
    v_mfma_f32_16x16x32_bf16 v[100:103], v[128:131], a[108:111], v[100:103]
    ds_read_b64_tr_b16 v[146:147], v220 offset:59392
    s_xor_b32 s38, s39, 16
    v_mfma_f32_16x16x32_bf16 v[104:107], v[132:135], a[104:107], v[104:107]
    ds_read_b64_tr_b16 v[148:149], v221 offset:57344
    v_mfma_f32_16x16x32_bf16 v[108:111], v[132:135], a[108:111], v[108:111]
    ds_read_b64_tr_b16 v[150:151], v221 offset:59392
    s_waitcnt lgkmcnt(4)
    v_mfma_f32_16x16x32_bf16 v[112:115], v[136:139], a[104:107], v[112:115]
    ds_read_b64_tr_b16 v[152:153], v222 offset:57344
    v_mfma_f32_16x16x32_bf16 v[116:119], v[136:139], a[108:111], v[116:119]
    ds_read_b64_tr_b16 v[154:155], v222 offset:59392
    s_mul_i32 s38, s38, 12288
    v_mfma_f32_16x16x32_bf16 v[120:123], v[140:143], a[104:107], v[120:123]
    ds_read_b64_tr_b16 v[156:157], v223 offset:57344
    s_add_u32 s38, s38, 0x5001000
    v_mfma_f32_16x16x32_bf16 v[124:127], v[140:143], a[108:111], v[124:127]
    ds_read_b64_tr_b16 v[158:159], v223 offset:59392
    s_waitcnt vmcnt(0) lgkmcnt(4)
    v_mfma_f32_16x16x32_bf16 v[96:99], v[144:147], a[120:123], v[96:99]
    ds_read_b64_tr_b16 v[128:129], v220 offset:0
    v_mfma_f32_16x16x32_bf16 v[100:103], v[144:147], a[124:127], v[100:103]
    ds_read_b64_tr_b16 v[130:131], v220 offset:2048
    v_mfma_f32_16x16x32_bf16 v[104:107], v[148:151], a[120:123], v[104:107]
    ds_read_b64_tr_b16 v[132:133], v221 offset:0
    v_mfma_f32_16x16x32_bf16 v[108:111], v[148:151], a[124:127], v[108:111]
    ds_read_b64_tr_b16 v[134:135], v221 offset:2048
    s_waitcnt lgkmcnt(4)
    v_mfma_f32_16x16x32_bf16 v[112:115], v[152:155], a[120:123], v[112:115]
    ds_read_b64_tr_b16 v[136:137], v222 offset:0
    v_mfma_f32_16x16x32_bf16 v[116:119], v[152:155], a[124:127], v[116:119]
    ds_read_b64_tr_b16 v[138:139], v222 offset:2048
    v_mfma_f32_16x16x32_bf16 v[120:123], v[156:159], a[120:123], v[120:123]
    ds_read_b64_tr_b16 v[140:141], v223 offset:0
    v_mfma_f32_16x16x32_bf16 v[124:127], v[156:159], a[124:127], v[124:127]
    ds_read_b64_tr_b16 v[142:143], v223 offset:2048
    s_waitcnt lgkmcnt(4)
    v_mfma_f32_16x16x32_bf16 v[0:3], v[128:131], a[0:3], v[0:3]
    ds_read_b64_tr_b16 v[144:145], v220 offset:8192
    v_mfma_f32_16x16x32_bf16 v[4:7], v[128:131], a[4:7], v[4:7]
    ds_read_b64_tr_b16 v[146:147], v220 offset:10240
    v_mfma_f32_16x16x32_bf16 v[8:11], v[132:135], a[0:3], v[8:11]
    ds_read_b64_tr_b16 v[148:149], v221 offset:8192
    v_mfma_f32_16x16x32_bf16 v[12:15], v[132:135], a[4:7], v[12:15]
    ds_read_b64_tr_b16 v[150:151], v221 offset:10240
    s_waitcnt lgkmcnt(4)
    v_mfma_f32_16x16x32_bf16 v[16:19], v[136:139], a[0:3], v[16:19]
    ds_read_b64_tr_b16 v[152:153], v222 offset:8192
    v_mfma_f32_16x16x32_bf16 v[20:23], v[136:139], a[4:7], v[20:23]
    ds_read_b64_tr_b16 v[154:155], v222 offset:10240
    v_mfma_f32_16x16x32_bf16 v[24:27], v[140:143], a[0:3], v[24:27]
    ds_read_b64_tr_b16 v[156:157], v223 offset:8192
    v_mfma_f32_16x16x32_bf16 v[28:31], v[140:143], a[4:7], v[28:31]
    ds_read_b64_tr_b16 v[158:159], v223 offset:10240
    s_waitcnt lgkmcnt(4)
    v_mfma_f32_16x16x32_bf16 v[0:3], v[144:147], a[16:19], v[0:3]
    ds_read_b64_tr_b16 v[128:129], v220 offset:16384
    s_mul_i32 s33, s39, 12288
    s_add_u32 s33, s33, 0x5002000
    v_mfma_f32_16x16x32_bf16 v[4:7], v[144:147], a[20:23], v[4:7]
    ds_read_b64_tr_b16 v[130:131], v220 offset:18432
    v_mfma_f32_16x16x32_bf16 v[8:11], v[148:151], a[16:19], v[8:11]
    ds_read_b64_tr_b16 v[132:133], v221 offset:16384
    v_cvt_pk_bf16_f32 v96, v96, v97
    v_mfma_f32_16x16x32_bf16 v[12:15], v[148:151], a[20:23], v[12:15]
    ds_read_b64_tr_b16 v[134:135], v221 offset:18432
    v_cvt_pk_bf16_f32 v97, v98, v99
    s_waitcnt lgkmcnt(4)
    v_mfma_f32_16x16x32_bf16 v[16:19], v[152:155], a[16:19], v[16:19]
    ds_read_b64_tr_b16 v[136:137], v222 offset:16384
    v_cvt_pk_bf16_f32 v98, v100, v101
    v_mfma_f32_16x16x32_bf16 v[20:23], v[152:155], a[20:23], v[20:23]
    ds_read_b64_tr_b16 v[138:139], v222 offset:18432
    v_cvt_pk_bf16_f32 v99, v102, v103
    v_mfma_f32_16x16x32_bf16 v[24:27], v[156:159], a[16:19], v[24:27]
    ds_read_b64_tr_b16 v[140:141], v223 offset:16384
    v_min_u32 v96, -2, v96
    v_mfma_f32_16x16x32_bf16 v[28:31], v[156:159], a[20:23], v[28:31]
    ds_read_b64_tr_b16 v[142:143], v223 offset:18432
    v_min_u32 v97, -2, v97
    s_waitcnt lgkmcnt(4)
    v_mfma_f32_16x16x32_bf16 v[0:3], v[128:131], a[32:35], v[0:3]
    ds_read_b64_tr_b16 v[144:145], v220 offset:24576
    v_min_u32 v98, -2, v98
    v_mfma_f32_16x16x32_bf16 v[4:7], v[128:131], a[36:39], v[4:7]
    ds_read_b64_tr_b16 v[146:147], v220 offset:26624
    v_min_u32 v99, -2, v99
    v_mfma_f32_16x16x32_bf16 v[8:11], v[132:135], a[32:35], v[8:11]
    ds_read_b64_tr_b16 v[148:149], v221 offset:24576
    buffer_store_dwordx4 v[96:99], v228, s[8:11], s33 offen offset:0 sc1
    v_mfma_f32_16x16x32_bf16 v[12:15], v[132:135], a[36:39], v[12:15]
    ds_read_b64_tr_b16 v[150:151], v221 offset:26624
    s_waitcnt lgkmcnt(4)
    v_mfma_f32_16x16x32_bf16 v[16:19], v[136:139], a[32:35], v[16:19]
    ds_read_b64_tr_b16 v[152:153], v222 offset:24576
    v_mfma_f32_16x16x32_bf16 v[20:23], v[136:139], a[36:39], v[20:23]
    ds_read_b64_tr_b16 v[154:155], v222 offset:26624
    v_mfma_f32_16x16x32_bf16 v[24:27], v[140:143], a[32:35], v[24:27]
    ds_read_b64_tr_b16 v[156:157], v223 offset:24576
    v_cvt_pk_bf16_f32 v100, v104, v105
    v_mfma_f32_16x16x32_bf16 v[28:31], v[140:143], a[36:39], v[28:31]
    ds_read_b64_tr_b16 v[158:159], v223 offset:26624
    v_cvt_pk_bf16_f32 v101, v106, v107
    s_waitcnt lgkmcnt(4)
    v_mfma_f32_16x16x32_bf16 v[0:3], v[144:147], a[48:51], v[0:3]
    ds_read_b64_tr_b16 v[128:129], v220 offset:32768
    v_cvt_pk_bf16_f32 v102, v108, v109
    v_mfma_f32_16x16x32_bf16 v[4:7], v[144:147], a[52:55], v[4:7]
    ds_read_b64_tr_b16 v[130:131], v220 offset:34816
    v_cvt_pk_bf16_f32 v103, v110, v111
    v_mfma_f32_16x16x32_bf16 v[8:11], v[148:151], a[48:51], v[8:11]
    ds_read_b64_tr_b16 v[132:133], v221 offset:32768
    v_min_u32 v100, -2, v100
    v_mfma_f32_16x16x32_bf16 v[12:15], v[148:151], a[52:55], v[12:15]
    ds_read_b64_tr_b16 v[134:135], v221 offset:34816
    v_min_u32 v101, -2, v101
    s_waitcnt lgkmcnt(4)
    v_mfma_f32_16x16x32_bf16 v[16:19], v[152:155], a[48:51], v[16:19]
    ds_read_b64_tr_b16 v[136:137], v222 offset:32768
    v_min_u32 v102, -2, v102
    v_mfma_f32_16x16x32_bf16 v[20:23], v[152:155], a[52:55], v[20:23]
    ds_read_b64_tr_b16 v[138:139], v222 offset:34816
    v_min_u32 v103, -2, v103
    v_mfma_f32_16x16x32_bf16 v[24:27], v[156:159], a[48:51], v[24:27]
    ds_read_b64_tr_b16 v[140:141], v223 offset:32768
    buffer_store_dwordx4 v[100:103], v228, s[8:11], s33 offen offset:1024 sc1
    v_mfma_f32_16x16x32_bf16 v[28:31], v[156:159], a[52:55], v[28:31]
    ds_read_b64_tr_b16 v[142:143], v223 offset:34816
    s_waitcnt lgkmcnt(4)
    v_mfma_f32_16x16x32_bf16 v[0:3], v[128:131], a[64:67], v[0:3]
    ds_read_b64_tr_b16 v[144:145], v220 offset:40960
    v_mfma_f32_16x16x32_bf16 v[4:7], v[128:131], a[68:71], v[4:7]
    ds_read_b64_tr_b16 v[146:147], v220 offset:43008
    v_mfma_f32_16x16x32_bf16 v[8:11], v[132:135], a[64:67], v[8:11]
    ds_read_b64_tr_b16 v[148:149], v221 offset:40960
    v_cvt_pk_bf16_f32 v104, v112, v113
    v_mfma_f32_16x16x32_bf16 v[12:15], v[132:135], a[68:71], v[12:15]
    ds_read_b64_tr_b16 v[150:151], v221 offset:43008
    v_cvt_pk_bf16_f32 v105, v114, v115
    s_waitcnt lgkmcnt(4)
    v_mfma_f32_16x16x32_bf16 v[16:19], v[136:139], a[64:67], v[16:19]
    ds_read_b64_tr_b16 v[152:153], v222 offset:40960
    v_cvt_pk_bf16_f32 v106, v116, v117
    v_mfma_f32_16x16x32_bf16 v[20:23], v[136:139], a[68:71], v[20:23]
    ds_read_b64_tr_b16 v[154:155], v222 offset:43008
    v_cvt_pk_bf16_f32 v107, v118, v119
    v_mfma_f32_16x16x32_bf16 v[24:27], v[140:143], a[64:67], v[24:27]
    ds_read_b64_tr_b16 v[156:157], v223 offset:40960
    v_min_u32 v104, -2, v104
    v_mfma_f32_16x16x32_bf16 v[28:31], v[140:143], a[68:71], v[28:31]
    ds_read_b64_tr_b16 v[158:159], v223 offset:43008
    v_min_u32 v105, -2, v105
    s_waitcnt lgkmcnt(4)
    v_mfma_f32_16x16x32_bf16 v[0:3], v[144:147], a[80:83], v[0:3]
    ds_read_b64_tr_b16 v[128:129], v220 offset:49152
    v_min_u32 v106, -2, v106
    v_mfma_f32_16x16x32_bf16 v[4:7], v[144:147], a[84:87], v[4:7]
    ds_read_b64_tr_b16 v[130:131], v220 offset:51200
    v_min_u32 v107, -2, v107
    v_mfma_f32_16x16x32_bf16 v[8:11], v[148:151], a[80:83], v[8:11]
    ds_read_b64_tr_b16 v[132:133], v221 offset:49152
    buffer_store_dwordx4 v[104:107], v228, s[8:11], s33 offen offset:2048 sc1
    v_mfma_f32_16x16x32_bf16 v[12:15], v[148:151], a[84:87], v[12:15]
    ds_read_b64_tr_b16 v[134:135], v221 offset:51200
    s_waitcnt lgkmcnt(4)
    v_mfma_f32_16x16x32_bf16 v[16:19], v[152:155], a[80:83], v[16:19]
    ds_read_b64_tr_b16 v[136:137], v222 offset:49152
    v_mfma_f32_16x16x32_bf16 v[20:23], v[152:155], a[84:87], v[20:23]
    ds_read_b64_tr_b16 v[138:139], v222 offset:51200
    v_mfma_f32_16x16x32_bf16 v[24:27], v[156:159], a[80:83], v[24:27]
    ds_read_b64_tr_b16 v[140:141], v223 offset:49152
    v_cvt_pk_bf16_f32 v108, v120, v121
    v_mfma_f32_16x16x32_bf16 v[28:31], v[156:159], a[84:87], v[28:31]
    ds_read_b64_tr_b16 v[142:143], v223 offset:51200
    v_cvt_pk_bf16_f32 v109, v122, v123
    s_waitcnt lgkmcnt(4)
    v_mfma_f32_16x16x32_bf16 v[0:3], v[128:131], a[96:99], v[0:3]
    ds_read_b64_tr_b16 v[144:145], v220 offset:57344
    v_cvt_pk_bf16_f32 v110, v124, v125
    v_mfma_f32_16x16x32_bf16 v[4:7], v[128:131], a[100:103], v[4:7]
    ds_read_b64_tr_b16 v[146:147], v220 offset:59392
    v_cvt_pk_bf16_f32 v111, v126, v127
    v_mfma_f32_16x16x32_bf16 v[8:11], v[132:135], a[96:99], v[8:11]
    ds_read_b64_tr_b16 v[148:149], v221 offset:57344
    v_min_u32 v108, -2, v108
    v_mfma_f32_16x16x32_bf16 v[12:15], v[132:135], a[100:103], v[12:15]
    ds_read_b64_tr_b16 v[150:151], v221 offset:59392
    v_min_u32 v109, -2, v109
    s_waitcnt lgkmcnt(4)
    v_mfma_f32_16x16x32_bf16 v[16:19], v[136:139], a[96:99], v[16:19]
    ds_read_b64_tr_b16 v[152:153], v222 offset:57344
    v_min_u32 v110, -2, v110
    v_mfma_f32_16x16x32_bf16 v[20:23], v[136:139], a[100:103], v[20:23]
    ds_read_b64_tr_b16 v[154:155], v222 offset:59392
    v_min_u32 v111, -2, v111
    v_mfma_f32_16x16x32_bf16 v[24:27], v[140:143], a[96:99], v[24:27]
    ds_read_b64_tr_b16 v[156:157], v223 offset:57344
    buffer_store_dwordx4 v[108:111], v228, s[8:11], s33 offen offset:3072 sc1
    v_mfma_f32_16x16x32_bf16 v[28:31], v[140:143], a[100:103], v[28:31]
    ds_read_b64_tr_b16 v[158:159], v223 offset:59392
    s_waitcnt lgkmcnt(4)
    v_mfma_f32_16x16x32_bf16 v[0:3], v[144:147], a[112:115], v[0:3]
    ds_read_b64_tr_b16 v[128:129], v216 offset:0
    v_mfma_f32_16x16x32_bf16 v[4:7], v[144:147], a[116:119], v[4:7]
    ds_read_b64_tr_b16 v[130:131], v216 offset:2048
    v_mfma_f32_16x16x32_bf16 v[8:11], v[148:151], a[112:115], v[8:11]
    ds_read_b64_tr_b16 v[132:133], v217 offset:0
    v_mfma_f32_16x16x32_bf16 v[12:15], v[148:151], a[116:119], v[12:15]
    ds_read_b64_tr_b16 v[134:135], v217 offset:2048
    s_waitcnt lgkmcnt(4)
    v_mfma_f32_16x16x32_bf16 v[16:19], v[152:155], a[112:115], v[16:19]
    ds_read_b64_tr_b16 v[136:137], v218 offset:0
    v_mfma_f32_16x16x32_bf16 v[20:23], v[152:155], a[116:119], v[20:23]
    ds_read_b64_tr_b16 v[138:139], v218 offset:2048
    v_mfma_f32_16x16x32_bf16 v[24:27], v[156:159], a[112:115], v[24:27]
    ds_read_b64_tr_b16 v[140:141], v219 offset:0
    v_mfma_f32_16x16x32_bf16 v[28:31], v[156:159], a[116:119], v[28:31]
    ds_read_b64_tr_b16 v[142:143], v219 offset:2048
    s_waitcnt lgkmcnt(4)
    v_mfma_f32_16x16x32_bf16 v[64:67], v[128:131], a[8:11], v[64:67]
    ds_read_b64_tr_b16 v[144:145], v216 offset:8192
    v_mfma_f32_16x16x32_bf16 v[68:71], v[128:131], a[12:15], v[68:71]
    ds_read_b64_tr_b16 v[146:147], v216 offset:10240
    v_mfma_f32_16x16x32_bf16 v[72:75], v[132:135], a[8:11], v[72:75]
    ds_read_b64_tr_b16 v[148:149], v217 offset:8192
    v_mfma_f32_16x16x32_bf16 v[76:79], v[132:135], a[12:15], v[76:79]
    ds_read_b64_tr_b16 v[150:151], v217 offset:10240
    s_waitcnt lgkmcnt(4)
    v_mfma_f32_16x16x32_bf16 v[80:83], v[136:139], a[8:11], v[80:83]
    ds_read_b64_tr_b16 v[152:153], v218 offset:8192
    v_mfma_f32_16x16x32_bf16 v[84:87], v[136:139], a[12:15], v[84:87]
    ds_read_b64_tr_b16 v[154:155], v218 offset:10240
    v_mfma_f32_16x16x32_bf16 v[88:91], v[140:143], a[8:11], v[88:91]
    ds_read_b64_tr_b16 v[156:157], v219 offset:8192
    v_mfma_f32_16x16x32_bf16 v[92:95], v[140:143], a[12:15], v[92:95]
    ds_read_b64_tr_b16 v[158:159], v219 offset:10240
    s_waitcnt lgkmcnt(4)
    v_mfma_f32_16x16x32_bf16 v[64:67], v[144:147], a[24:27], v[64:67]
    ds_read_b64_tr_b16 v[128:129], v216 offset:16384
    s_mul_i32 s33, s39, 12288
    s_add_u32 s33, s33, 0x5000000
    v_mfma_f32_16x16x32_bf16 v[68:71], v[144:147], a[28:31], v[68:71]
    ds_read_b64_tr_b16 v[130:131], v216 offset:18432
    v_mfma_f32_16x16x32_bf16 v[72:75], v[148:151], a[24:27], v[72:75]
    ds_read_b64_tr_b16 v[132:133], v217 offset:16384
    v_cvt_pk_bf16_f32 v0, v0, v1
    v_mfma_f32_16x16x32_bf16 v[76:79], v[148:151], a[28:31], v[76:79]
    ds_read_b64_tr_b16 v[134:135], v217 offset:18432
    v_cvt_pk_bf16_f32 v1, v2, v3
    s_waitcnt lgkmcnt(4)
    v_mfma_f32_16x16x32_bf16 v[80:83], v[152:155], a[24:27], v[80:83]
    ds_read_b64_tr_b16 v[136:137], v218 offset:16384
    v_cvt_pk_bf16_f32 v2, v4, v5
    v_mfma_f32_16x16x32_bf16 v[84:87], v[152:155], a[28:31], v[84:87]
    ds_read_b64_tr_b16 v[138:139], v218 offset:18432
    v_cvt_pk_bf16_f32 v3, v6, v7
    v_mfma_f32_16x16x32_bf16 v[88:91], v[156:159], a[24:27], v[88:91]
    ds_read_b64_tr_b16 v[140:141], v219 offset:16384
    v_min_u32 v0, -2, v0
    v_mfma_f32_16x16x32_bf16 v[92:95], v[156:159], a[28:31], v[92:95]
    ds_read_b64_tr_b16 v[142:143], v219 offset:18432
    v_min_u32 v1, -2, v1
    s_waitcnt lgkmcnt(4)
    v_mfma_f32_16x16x32_bf16 v[64:67], v[128:131], a[40:43], v[64:67]
    ds_read_b64_tr_b16 v[144:145], v216 offset:24576
    v_min_u32 v2, -2, v2
    v_mfma_f32_16x16x32_bf16 v[68:71], v[128:131], a[44:47], v[68:71]
    ds_read_b64_tr_b16 v[146:147], v216 offset:26624
    v_min_u32 v3, -2, v3
    v_mfma_f32_16x16x32_bf16 v[72:75], v[132:135], a[40:43], v[72:75]
    ds_read_b64_tr_b16 v[148:149], v217 offset:24576
    buffer_store_dwordx4 v[0:3], v228, s[8:11], s33 offen offset:0 sc1
    v_mfma_f32_16x16x32_bf16 v[76:79], v[132:135], a[44:47], v[76:79]
    ds_read_b64_tr_b16 v[150:151], v217 offset:26624
    s_waitcnt lgkmcnt(4)
    v_mfma_f32_16x16x32_bf16 v[80:83], v[136:139], a[40:43], v[80:83]
    ds_read_b64_tr_b16 v[152:153], v218 offset:24576
    v_mfma_f32_16x16x32_bf16 v[84:87], v[136:139], a[44:47], v[84:87]
    ds_read_b64_tr_b16 v[154:155], v218 offset:26624
    v_mfma_f32_16x16x32_bf16 v[88:91], v[140:143], a[40:43], v[88:91]
    ds_read_b64_tr_b16 v[156:157], v219 offset:24576
    v_cvt_pk_bf16_f32 v4, v8, v9
    v_mfma_f32_16x16x32_bf16 v[92:95], v[140:143], a[44:47], v[92:95]
    ds_read_b64_tr_b16 v[158:159], v219 offset:26624
    v_cvt_pk_bf16_f32 v5, v10, v11
    s_waitcnt lgkmcnt(4)
    v_mfma_f32_16x16x32_bf16 v[64:67], v[144:147], a[56:59], v[64:67]
    ds_read_b64_tr_b16 v[128:129], v216 offset:32768
    v_cvt_pk_bf16_f32 v6, v12, v13
    v_mfma_f32_16x16x32_bf16 v[68:71], v[144:147], a[60:63], v[68:71]
    ds_read_b64_tr_b16 v[130:131], v216 offset:34816
    v_cvt_pk_bf16_f32 v7, v14, v15
    v_mfma_f32_16x16x32_bf16 v[72:75], v[148:151], a[56:59], v[72:75]
    ds_read_b64_tr_b16 v[132:133], v217 offset:32768
    v_min_u32 v4, -2, v4
    v_mfma_f32_16x16x32_bf16 v[76:79], v[148:151], a[60:63], v[76:79]
    ds_read_b64_tr_b16 v[134:135], v217 offset:34816
    v_min_u32 v5, -2, v5
    s_waitcnt lgkmcnt(4)
    v_mfma_f32_16x16x32_bf16 v[80:83], v[152:155], a[56:59], v[80:83]
    ds_read_b64_tr_b16 v[136:137], v218 offset:32768
    v_min_u32 v6, -2, v6
    v_mfma_f32_16x16x32_bf16 v[84:87], v[152:155], a[60:63], v[84:87]
    ds_read_b64_tr_b16 v[138:139], v218 offset:34816
    v_min_u32 v7, -2, v7
    v_mfma_f32_16x16x32_bf16 v[88:91], v[156:159], a[56:59], v[88:91]
    ds_read_b64_tr_b16 v[140:141], v219 offset:32768
    buffer_store_dwordx4 v[4:7], v228, s[8:11], s33 offen offset:1024 sc1
    v_mfma_f32_16x16x32_bf16 v[92:95], v[156:159], a[60:63], v[92:95]
    ds_read_b64_tr_b16 v[142:143], v219 offset:34816
    s_waitcnt lgkmcnt(4)
    v_mfma_f32_16x16x32_bf16 v[64:67], v[128:131], a[72:75], v[64:67]
    ds_read_b64_tr_b16 v[144:145], v216 offset:40960
    v_mfma_f32_16x16x32_bf16 v[68:71], v[128:131], a[76:79], v[68:71]
    ds_read_b64_tr_b16 v[146:147], v216 offset:43008
    v_mfma_f32_16x16x32_bf16 v[72:75], v[132:135], a[72:75], v[72:75]
    ds_read_b64_tr_b16 v[148:149], v217 offset:40960
    v_cvt_pk_bf16_f32 v8, v16, v17
    v_mfma_f32_16x16x32_bf16 v[76:79], v[132:135], a[76:79], v[76:79]
    ds_read_b64_tr_b16 v[150:151], v217 offset:43008
    v_cvt_pk_bf16_f32 v9, v18, v19
    s_waitcnt lgkmcnt(4)
    v_mfma_f32_16x16x32_bf16 v[80:83], v[136:139], a[72:75], v[80:83]
    ds_read_b64_tr_b16 v[152:153], v218 offset:40960
    v_cvt_pk_bf16_f32 v10, v20, v21
    v_mfma_f32_16x16x32_bf16 v[84:87], v[136:139], a[76:79], v[84:87]
    ds_read_b64_tr_b16 v[154:155], v218 offset:43008
    v_cvt_pk_bf16_f32 v11, v22, v23
    v_mfma_f32_16x16x32_bf16 v[88:91], v[140:143], a[72:75], v[88:91]
    ds_read_b64_tr_b16 v[156:157], v219 offset:40960
    v_min_u32 v8, -2, v8
    v_mfma_f32_16x16x32_bf16 v[92:95], v[140:143], a[76:79], v[92:95]
    ds_read_b64_tr_b16 v[158:159], v219 offset:43008
    v_min_u32 v9, -2, v9
    s_waitcnt lgkmcnt(4)
    v_mfma_f32_16x16x32_bf16 v[64:67], v[144:147], a[88:91], v[64:67]
    ds_read_b64_tr_b16 v[128:129], v216 offset:49152
    v_min_u32 v10, -2, v10
    v_mfma_f32_16x16x32_bf16 v[68:71], v[144:147], a[92:95], v[68:71]
    ds_read_b64_tr_b16 v[130:131], v216 offset:51200
    v_min_u32 v11, -2, v11
    v_mfma_f32_16x16x32_bf16 v[72:75], v[148:151], a[88:91], v[72:75]
    ds_read_b64_tr_b16 v[132:133], v217 offset:49152
    buffer_store_dwordx4 v[8:11], v228, s[8:11], s33 offen offset:2048 sc1
    v_mfma_f32_16x16x32_bf16 v[76:79], v[148:151], a[92:95], v[76:79]
    ds_read_b64_tr_b16 v[134:135], v217 offset:51200
    s_waitcnt lgkmcnt(4)
    v_mfma_f32_16x16x32_bf16 v[80:83], v[152:155], a[88:91], v[80:83]
    ds_read_b64_tr_b16 v[136:137], v218 offset:49152
    v_mfma_f32_16x16x32_bf16 v[84:87], v[152:155], a[92:95], v[84:87]
    ds_read_b64_tr_b16 v[138:139], v218 offset:51200
    v_mfma_f32_16x16x32_bf16 v[88:91], v[156:159], a[88:91], v[88:91]
    ds_read_b64_tr_b16 v[140:141], v219 offset:49152
    v_cvt_pk_bf16_f32 v12, v24, v25
    v_mfma_f32_16x16x32_bf16 v[92:95], v[156:159], a[92:95], v[92:95]
    ds_read_b64_tr_b16 v[142:143], v219 offset:51200
    v_cvt_pk_bf16_f32 v13, v26, v27
    s_waitcnt lgkmcnt(4)
    v_mfma_f32_16x16x32_bf16 v[64:67], v[128:131], a[104:107], v[64:67]
    ds_read_b64_tr_b16 v[144:145], v216 offset:57344
    v_cvt_pk_bf16_f32 v14, v28, v29
    v_mfma_f32_16x16x32_bf16 v[68:71], v[128:131], a[108:111], v[68:71]
    ds_read_b64_tr_b16 v[146:147], v216 offset:59392
    v_cvt_pk_bf16_f32 v15, v30, v31
    v_mfma_f32_16x16x32_bf16 v[72:75], v[132:135], a[104:107], v[72:75]
    ds_read_b64_tr_b16 v[148:149], v217 offset:57344
    v_min_u32 v12, -2, v12
    v_mfma_f32_16x16x32_bf16 v[76:79], v[132:135], a[108:111], v[76:79]
    ds_read_b64_tr_b16 v[150:151], v217 offset:59392
    v_min_u32 v13, -2, v13
    s_waitcnt lgkmcnt(4)
    v_mfma_f32_16x16x32_bf16 v[80:83], v[136:139], a[104:107], v[80:83]
    ds_read_b64_tr_b16 v[152:153], v218 offset:57344
    v_min_u32 v14, -2, v14
    v_mfma_f32_16x16x32_bf16 v[84:87], v[136:139], a[108:111], v[84:87]
    ds_read_b64_tr_b16 v[154:155], v218 offset:59392
    v_min_u32 v15, -2, v15
    v_mfma_f32_16x16x32_bf16 v[88:91], v[140:143], a[104:107], v[88:91]
    ds_read_b64_tr_b16 v[156:157], v219 offset:57344
    buffer_store_dwordx4 v[12:15], v228, s[8:11], s33 offen offset:3072 sc1
    v_mfma_f32_16x16x32_bf16 v[92:95], v[140:143], a[108:111], v[92:95]
    ds_read_b64_tr_b16 v[158:159], v219 offset:59392
    s_waitcnt lgkmcnt(4)
    v_mfma_f32_16x16x32_bf16 v[64:67], v[144:147], a[120:123], v[64:67]
    ds_read_b64_tr_b16 v[128:129], v216 offset:0
    v_mfma_f32_16x16x32_bf16 v[68:71], v[144:147], a[124:127], v[68:71]
    ds_read_b64_tr_b16 v[130:131], v216 offset:2048
    v_mfma_f32_16x16x32_bf16 v[72:75], v[148:151], a[120:123], v[72:75]
    ds_read_b64_tr_b16 v[132:133], v217 offset:0
    v_mfma_f32_16x16x32_bf16 v[76:79], v[148:151], a[124:127], v[76:79]
    ds_read_b64_tr_b16 v[134:135], v217 offset:2048
    s_waitcnt lgkmcnt(4)
    v_mfma_f32_16x16x32_bf16 v[80:83], v[152:155], a[120:123], v[80:83]
    ds_read_b64_tr_b16 v[136:137], v218 offset:0
    v_mfma_f32_16x16x32_bf16 v[84:87], v[152:155], a[124:127], v[84:87]
    ds_read_b64_tr_b16 v[138:139], v218 offset:2048
    v_mfma_f32_16x16x32_bf16 v[88:91], v[156:159], a[120:123], v[88:91]
    ds_read_b64_tr_b16 v[140:141], v219 offset:0
    v_mfma_f32_16x16x32_bf16 v[92:95], v[156:159], a[124:127], v[92:95]
    ds_read_b64_tr_b16 v[142:143], v219 offset:2048
    s_waitcnt lgkmcnt(4)
    v_mfma_f32_16x16x32_bf16 v[32:35], v[128:131], a[0:3], v[32:35]
    ds_read_b64_tr_b16 v[144:145], v216 offset:8192
    v_mfma_f32_16x16x32_bf16 v[36:39], v[128:131], a[4:7], v[36:39]
    ds_read_b64_tr_b16 v[146:147], v216 offset:10240
    buffer_load_dwordx4 v[176:179], v228, s[8:11], s7 offen offset:0 sc1
    v_mfma_f32_16x16x32_bf16 v[40:43], v[132:135], a[0:3], v[40:43]
    ds_read_b64_tr_b16 v[148:149], v217 offset:8192
    v_mfma_f32_16x16x32_bf16 v[44:47], v[132:135], a[4:7], v[44:47]
    ds_read_b64_tr_b16 v[150:151], v217 offset:10240
    buffer_load_dwordx4 v[180:183], v228, s[8:11], s7 offen offset:1024 sc1
    s_waitcnt lgkmcnt(4)
    v_mfma_f32_16x16x32_bf16 v[48:51], v[136:139], a[0:3], v[48:51]
    ds_read_b64_tr_b16 v[152:153], v218 offset:8192
    v_mfma_f32_16x16x32_bf16 v[52:55], v[136:139], a[4:7], v[52:55]
    ds_read_b64_tr_b16 v[154:155], v218 offset:10240
    buffer_load_dwordx4 v[184:187], v228, s[8:11], s7 offen offset:2048 sc1
    v_mfma_f32_16x16x32_bf16 v[56:59], v[140:143], a[0:3], v[56:59]
    ds_read_b64_tr_b16 v[156:157], v219 offset:8192
    v_mfma_f32_16x16x32_bf16 v[60:63], v[140:143], a[4:7], v[60:63]
    ds_read_b64_tr_b16 v[158:159], v219 offset:10240
    buffer_load_dwordx4 v[188:191], v228, s[8:11], s7 offen offset:3072 sc1
    s_waitcnt lgkmcnt(4)
    v_mfma_f32_16x16x32_bf16 v[32:35], v[144:147], a[16:19], v[32:35]
    ds_read_b64_tr_b16 v[128:129], v216 offset:16384
    s_mul_i32 s33, s39, 12288
    s_add_u32 s33, s33, 0x5001000
    v_mfma_f32_16x16x32_bf16 v[36:39], v[144:147], a[20:23], v[36:39]
    ds_read_b64_tr_b16 v[130:131], v216 offset:18432
    v_mfma_f32_16x16x32_bf16 v[40:43], v[148:151], a[16:19], v[40:43]
    ds_read_b64_tr_b16 v[132:133], v217 offset:16384
    v_cvt_pk_bf16_f32 v64, v64, v65
    v_mfma_f32_16x16x32_bf16 v[44:47], v[148:151], a[20:23], v[44:47]
    ds_read_b64_tr_b16 v[134:135], v217 offset:18432
    v_cvt_pk_bf16_f32 v65, v66, v67
    s_waitcnt lgkmcnt(4)
    v_mfma_f32_16x16x32_bf16 v[48:51], v[152:155], a[16:19], v[48:51]
    ds_read_b64_tr_b16 v[136:137], v218 offset:16384
    v_cvt_pk_bf16_f32 v66, v68, v69
    v_mfma_f32_16x16x32_bf16 v[52:55], v[152:155], a[20:23], v[52:55]
    ds_read_b64_tr_b16 v[138:139], v218 offset:18432
    v_cvt_pk_bf16_f32 v67, v70, v71
    v_mfma_f32_16x16x32_bf16 v[56:59], v[156:159], a[16:19], v[56:59]
    ds_read_b64_tr_b16 v[140:141], v219 offset:16384
    v_min_u32 v64, -2, v64
    v_mfma_f32_16x16x32_bf16 v[60:63], v[156:159], a[20:23], v[60:63]
    ds_read_b64_tr_b16 v[142:143], v219 offset:18432
    v_min_u32 v65, -2, v65
    s_waitcnt lgkmcnt(4)
    v_mfma_f32_16x16x32_bf16 v[32:35], v[128:131], a[32:35], v[32:35]
    ds_read_b64_tr_b16 v[144:145], v216 offset:24576
    v_min_u32 v66, -2, v66
    v_mfma_f32_16x16x32_bf16 v[36:39], v[128:131], a[36:39], v[36:39]
    ds_read_b64_tr_b16 v[146:147], v216 offset:26624
    v_min_u32 v67, -2, v67
    v_mfma_f32_16x16x32_bf16 v[40:43], v[132:135], a[32:35], v[40:43]
    ds_read_b64_tr_b16 v[148:149], v217 offset:24576
    buffer_store_dwordx4 v[64:67], v228, s[8:11], s33 offen offset:0 sc1
    v_mfma_f32_16x16x32_bf16 v[44:47], v[132:135], a[36:39], v[44:47]
    ds_read_b64_tr_b16 v[150:151], v217 offset:26624
    s_waitcnt lgkmcnt(4)
    v_mfma_f32_16x16x32_bf16 v[48:51], v[136:139], a[32:35], v[48:51]
    ds_read_b64_tr_b16 v[152:153], v218 offset:24576
    v_mfma_f32_16x16x32_bf16 v[52:55], v[136:139], a[36:39], v[52:55]
    ds_read_b64_tr_b16 v[154:155], v218 offset:26624
    v_mfma_f32_16x16x32_bf16 v[56:59], v[140:143], a[32:35], v[56:59]
    ds_read_b64_tr_b16 v[156:157], v219 offset:24576
    v_cvt_pk_bf16_f32 v68, v72, v73
    v_mfma_f32_16x16x32_bf16 v[60:63], v[140:143], a[36:39], v[60:63]
    ds_read_b64_tr_b16 v[158:159], v219 offset:26624
    v_cvt_pk_bf16_f32 v69, v74, v75
    s_waitcnt lgkmcnt(4)
    v_mfma_f32_16x16x32_bf16 v[32:35], v[144:147], a[48:51], v[32:35]
    ds_read_b64_tr_b16 v[128:129], v216 offset:32768
    v_cvt_pk_bf16_f32 v70, v76, v77
    v_mfma_f32_16x16x32_bf16 v[36:39], v[144:147], a[52:55], v[36:39]
    ds_read_b64_tr_b16 v[130:131], v216 offset:34816
    v_cvt_pk_bf16_f32 v71, v78, v79
    v_mfma_f32_16x16x32_bf16 v[40:43], v[148:151], a[48:51], v[40:43]
    ds_read_b64_tr_b16 v[132:133], v217 offset:32768
    v_min_u32 v68, -2, v68
    v_mfma_f32_16x16x32_bf16 v[44:47], v[148:151], a[52:55], v[44:47]
    ds_read_b64_tr_b16 v[134:135], v217 offset:34816
    v_min_u32 v69, -2, v69
    s_waitcnt lgkmcnt(4)
    v_mfma_f32_16x16x32_bf16 v[48:51], v[152:155], a[48:51], v[48:51]
    ds_read_b64_tr_b16 v[136:137], v218 offset:32768
    v_min_u32 v70, -2, v70
    v_mfma_f32_16x16x32_bf16 v[52:55], v[152:155], a[52:55], v[52:55]
    ds_read_b64_tr_b16 v[138:139], v218 offset:34816
    v_min_u32 v71, -2, v71
    v_mfma_f32_16x16x32_bf16 v[56:59], v[156:159], a[48:51], v[56:59]
    ds_read_b64_tr_b16 v[140:141], v219 offset:32768
    buffer_store_dwordx4 v[68:71], v228, s[8:11], s33 offen offset:1024 sc1
    v_mfma_f32_16x16x32_bf16 v[60:63], v[156:159], a[52:55], v[60:63]
    ds_read_b64_tr_b16 v[142:143], v219 offset:34816
    s_waitcnt lgkmcnt(4)
    v_mfma_f32_16x16x32_bf16 v[32:35], v[128:131], a[64:67], v[32:35]
    ds_read_b64_tr_b16 v[144:145], v216 offset:40960
    v_mfma_f32_16x16x32_bf16 v[36:39], v[128:131], a[68:71], v[36:39]
    ds_read_b64_tr_b16 v[146:147], v216 offset:43008
    v_mfma_f32_16x16x32_bf16 v[40:43], v[132:135], a[64:67], v[40:43]
    ds_read_b64_tr_b16 v[148:149], v217 offset:40960
    v_cvt_pk_bf16_f32 v72, v80, v81
    v_mfma_f32_16x16x32_bf16 v[44:47], v[132:135], a[68:71], v[44:47]
    ds_read_b64_tr_b16 v[150:151], v217 offset:43008
    v_cvt_pk_bf16_f32 v73, v82, v83
    s_waitcnt lgkmcnt(4)
    v_mfma_f32_16x16x32_bf16 v[48:51], v[136:139], a[64:67], v[48:51]
    ds_read_b64_tr_b16 v[152:153], v218 offset:40960
    v_cvt_pk_bf16_f32 v74, v84, v85
    v_mfma_f32_16x16x32_bf16 v[52:55], v[136:139], a[68:71], v[52:55]
    ds_read_b64_tr_b16 v[154:155], v218 offset:43008
    v_cvt_pk_bf16_f32 v75, v86, v87
    v_mfma_f32_16x16x32_bf16 v[56:59], v[140:143], a[64:67], v[56:59]
    ds_read_b64_tr_b16 v[156:157], v219 offset:40960
    v_min_u32 v72, -2, v72
    v_mfma_f32_16x16x32_bf16 v[60:63], v[140:143], a[68:71], v[60:63]
    ds_read_b64_tr_b16 v[158:159], v219 offset:43008
    v_min_u32 v73, -2, v73
    s_waitcnt lgkmcnt(4)
    v_mfma_f32_16x16x32_bf16 v[32:35], v[144:147], a[80:83], v[32:35]
    ds_read_b64_tr_b16 v[128:129], v216 offset:49152
    v_min_u32 v74, -2, v74
    v_mfma_f32_16x16x32_bf16 v[36:39], v[144:147], a[84:87], v[36:39]
    ds_read_b64_tr_b16 v[130:131], v216 offset:51200
    v_min_u32 v75, -2, v75
    v_mfma_f32_16x16x32_bf16 v[40:43], v[148:151], a[80:83], v[40:43]
    ds_read_b64_tr_b16 v[132:133], v217 offset:49152
    buffer_store_dwordx4 v[72:75], v228, s[8:11], s33 offen offset:2048 sc1
    v_mfma_f32_16x16x32_bf16 v[44:47], v[148:151], a[84:87], v[44:47]
    ds_read_b64_tr_b16 v[134:135], v217 offset:51200
    s_waitcnt lgkmcnt(4)
    v_mfma_f32_16x16x32_bf16 v[48:51], v[152:155], a[80:83], v[48:51]
    ds_read_b64_tr_b16 v[136:137], v218 offset:49152
    v_mfma_f32_16x16x32_bf16 v[52:55], v[152:155], a[84:87], v[52:55]
    ds_read_b64_tr_b16 v[138:139], v218 offset:51200
    v_mfma_f32_16x16x32_bf16 v[56:59], v[156:159], a[80:83], v[56:59]
    ds_read_b64_tr_b16 v[140:141], v219 offset:49152
    v_cvt_pk_bf16_f32 v76, v88, v89
    v_mfma_f32_16x16x32_bf16 v[60:63], v[156:159], a[84:87], v[60:63]
    ds_read_b64_tr_b16 v[142:143], v219 offset:51200
    v_cvt_pk_bf16_f32 v77, v90, v91
    s_waitcnt lgkmcnt(4)
    v_mfma_f32_16x16x32_bf16 v[32:35], v[128:131], a[96:99], v[32:35]
    ds_read_b64_tr_b16 v[144:145], v216 offset:57344
    v_cvt_pk_bf16_f32 v78, v92, v93
    v_mfma_f32_16x16x32_bf16 v[36:39], v[128:131], a[100:103], v[36:39]
    ds_read_b64_tr_b16 v[146:147], v216 offset:59392
    v_cvt_pk_bf16_f32 v79, v94, v95
    v_mfma_f32_16x16x32_bf16 v[40:43], v[132:135], a[96:99], v[40:43]
    ds_read_b64_tr_b16 v[148:149], v217 offset:57344
    v_min_u32 v76, -2, v76
    v_mfma_f32_16x16x32_bf16 v[44:47], v[132:135], a[100:103], v[44:47]
    ds_read_b64_tr_b16 v[150:151], v217 offset:59392
    v_min_u32 v77, -2, v77
    s_waitcnt lgkmcnt(4)
    v_mfma_f32_16x16x32_bf16 v[48:51], v[136:139], a[96:99], v[48:51]
    ds_read_b64_tr_b16 v[152:153], v218 offset:57344
    v_min_u32 v78, -2, v78
    v_mfma_f32_16x16x32_bf16 v[52:55], v[136:139], a[100:103], v[52:55]
    ds_read_b64_tr_b16 v[154:155], v218 offset:59392
    v_min_u32 v79, -2, v79
    v_mfma_f32_16x16x32_bf16 v[56:59], v[140:143], a[96:99], v[56:59]
    ds_read_b64_tr_b16 v[156:157], v219 offset:57344
    buffer_store_dwordx4 v[76:79], v228, s[8:11], s33 offen offset:3072 sc1
    v_mfma_f32_16x16x32_bf16 v[60:63], v[140:143], a[100:103], v[60:63]
    ds_read_b64_tr_b16 v[158:159], v219 offset:59392
    s_waitcnt lgkmcnt(4)
    v_mfma_f32_16x16x32_bf16 v[32:35], v[144:147], a[112:115], v[32:35]
    buffer_load_dwordx4 v[96:99], v228, s[8:11], s37 offen offset:0 sc1
    v_mfma_f32_16x16x32_bf16 v[36:39], v[144:147], a[116:119], v[36:39]
    v_mfma_f32_16x16x32_bf16 v[40:43], v[148:151], a[112:115], v[40:43]
    buffer_load_dwordx4 v[100:103], v228, s[8:11], s37 offen offset:1024 sc1
    v_mfma_f32_16x16x32_bf16 v[44:47], v[148:151], a[116:119], v[44:47]
    s_waitcnt lgkmcnt(0)
    v_mfma_f32_16x16x32_bf16 v[48:51], v[152:155], a[112:115], v[48:51]
    buffer_load_dwordx4 v[104:107], v228, s[8:11], s37 offen offset:2048 sc1
    v_mfma_f32_16x16x32_bf16 v[52:55], v[152:155], a[116:119], v[52:55]
    v_mfma_f32_16x16x32_bf16 v[56:59], v[156:159], a[112:115], v[56:59]
    buffer_load_dwordx4 v[108:111], v228, s[8:11], s37 offen offset:3072 sc1
    v_mfma_f32_16x16x32_bf16 v[60:63], v[156:159], a[116:119], v[60:63]
kc_tail:
    buffer_load_dwordx4 v[160:163], v228, s[8:11], s38 offen offset:0 sc1
    buffer_load_dwordx4 v[164:167], v228, s[8:11], s38 offen offset:1024 sc1
    buffer_load_dwordx4 v[168:171], v228, s[8:11], s38 offen offset:2048 sc1
    buffer_load_dwordx4 v[172:175], v228, s[8:11], s38 offen offset:3072 sc1
    v_lshlrev_b32 v128, 16, v192
    v_and_b32 v129, 0xffff0000, v192
    v_lshlrev_b32 v130, 16, v193
    v_and_b32 v131, 0xffff0000, v193
    v_lshlrev_b32 v132, 16, v194
    v_and_b32 v133, 0xffff0000, v194
    v_lshlrev_b32 v134, 16, v195
    v_and_b32 v135, 0xffff0000, v195
    v_lshlrev_b32 v136, 16, v196
    v_and_b32 v137, 0xffff0000, v196
    v_lshlrev_b32 v138, 16, v197
    v_and_b32 v139, 0xffff0000, v197
    v_lshlrev_b32 v140, 16, v198
    v_and_b32 v141, 0xffff0000, v198
    v_lshlrev_b32 v142, 16, v199
    v_and_b32 v143, 0xffff0000, v199
    v_lshlrev_b32 v144, 16, v200
    v_and_b32 v145, 0xffff0000, v200
    v_lshlrev_b32 v146, 16, v201
    v_and_b32 v147, 0xffff0000, v201
    v_lshlrev_b32 v148, 16, v202
    v_and_b32 v149, 0xffff0000, v202
    v_lshlrev_b32 v150, 16, v203
    v_and_b32 v151, 0xffff0000, v203
    v_lshlrev_b32 v152, 16, v204
    v_and_b32 v153, 0xffff0000, v204
    v_lshlrev_b32 v154, 16, v205
    v_and_b32 v155, 0xffff0000, v205
    v_lshlrev_b32 v156, 16, v206
    v_and_b32 v157, 0xffff0000, v206
    v_lshlrev_b32 v158, 16, v207
    v_and_b32 v159, 0xffff0000, v207
    v_lshlrev_b32 v112, 16, v208
    v_and_b32 v113, 0xffff0000, v208
    v_lshlrev_b32 v114, 16, v209
    v_and_b32 v115, 0xffff0000, v209
    v_lshlrev_b32 v116, 16, v210
    v_and_b32 v117, 0xffff0000, v210
    v_lshlrev_b32 v118, 16, v211
    v_and_b32 v119, 0xffff0000, v211
    v_pk_add_f32 v[120:121], v[112:113], v[114:115]
    v_pk_add_f32 v[122:123], v[116:117], v[118:119]
    v_pk_add_f32 v[120:121], v[120:121], v[122:123]
    v_add_f32 v196, v120, v121
    s_barrier
    s_waitcnt vmcnt(12)
    v_max3_u32 v235, v176, v177, v178
    v_max3_u32 v235, v235, v179, v180
    v_max3_u32 v235, v235, v181, v182
    v_max3_u32 v235, v235, v183, v184
    v_max3_u32 v235, v235, v185, v186
    v_max3_u32 v235, v235, v187, v188
    v_max3_u32 v235, v235, v189, v190
    v_max_u32 v235, v235, v191
    v_cmp_eq_u32 vcc, -1, v235
    s_cbranch_vccnz kc_r3
kc_r3o:
    v_lshlrev_b32 v64, 16, v176
    v_and_b32 v65, 0xffff0000, v176
    v_lshlrev_b32 v66, 16, v177
    v_and_b32 v67, 0xffff0000, v177
    v_pk_add_f32 v[32:33], v[32:33], v[64:65]
    v_pk_add_f32 v[34:35], v[34:35], v[66:67]
    v_lshlrev_b32 v68, 16, v178
    v_and_b32 v69, 0xffff0000, v178
    v_lshlrev_b32 v70, 16, v179
    v_and_b32 v71, 0xffff0000, v179
    v_pk_add_f32 v[36:37], v[36:37], v[68:69]
    v_pk_add_f32 v[38:39], v[38:39], v[70:71]
    v_lshlrev_b32 v72, 16, v180
    v_and_b32 v73, 0xffff0000, v180
    v_lshlrev_b32 v74, 16, v181
    v_and_b32 v75, 0xffff0000, v181
    v_pk_add_f32 v[40:41], v[40:41], v[72:73]
    v_pk_add_f32 v[42:43], v[42:43], v[74:75]
    v_lshlrev_b32 v76, 16, v182
    v_and_b32 v77, 0xffff0000, v182
    v_lshlrev_b32 v78, 16, v183
    v_and_b32 v79, 0xffff0000, v183
    v_pk_add_f32 v[44:45], v[44:45], v[76:77]
    v_pk_add_f32 v[46:47], v[46:47], v[78:79]
    v_lshlrev_b32 v80, 16, v184
    v_and_b32 v81, 0xffff0000, v184
    v_lshlrev_b32 v82, 16, v185
    v_and_b32 v83, 0xffff0000, v185
    v_pk_add_f32 v[48:49], v[48:49], v[80:81]
    v_pk_add_f32 v[50:51], v[50:51], v[82:83]
    v_lshlrev_b32 v84, 16, v186
    v_and_b32 v85, 0xffff0000, v186
    v_lshlrev_b32 v86, 16, v187
    v_and_b32 v87, 0xffff0000, v187
    v_pk_add_f32 v[52:53], v[52:53], v[84:85]
    v_pk_add_f32 v[54:55], v[54:55], v[86:87]
    v_lshlrev_b32 v88, 16, v188
    v_and_b32 v89, 0xffff0000, v188
    v_lshlrev_b32 v90, 16, v189
    v_and_b32 v91, 0xffff0000, v189
    v_pk_add_f32 v[56:57], v[56:57], v[88:89]
    v_pk_add_f32 v[58:59], v[58:59], v[90:91]
    v_lshlrev_b32 v92, 16, v190
    v_and_b32 v93, 0xffff0000, v190
    v_lshlrev_b32 v94, 16, v191
    v_and_b32 v95, 0xffff0000, v191
    v_pk_add_f32 v[60:61], v[60:61], v[92:93]
    v_pk_add_f32 v[62:63], v[62:63], v[94:95]
    s_waitcnt vmcnt(4)
    v_max3_u32 v235, v96, v97, v98
    v_max3_u32 v235, v235, v99, v100
    v_max3_u32 v235, v235, v101, v102
    v_max3_u32 v235, v235, v103, v104
    v_max3_u32 v235, v235, v105, v106
    v_max3_u32 v235, v235, v107, v108
    v_max3_u32 v235, v235, v109, v110
    v_max_u32 v235, v235, v111
    v_cmp_eq_u32 vcc, -1, v235
    s_cbranch_vccnz kc_r1
kc_r1o:
    v_lshlrev_b32 v64, 16, v96
    v_and_b32 v65, 0xffff0000, v96
    v_lshlrev_b32 v66, 16, v97
    v_and_b32 v67, 0xffff0000, v97
    v_pk_add_f32 v[32:33], v[32:33], v[64:65]
    v_pk_add_f32 v[34:35], v[34:35], v[66:67]
    v_lshlrev_b32 v68, 16, v98
    v_and_b32 v69, 0xffff0000, v98
    v_lshlrev_b32 v70, 16, v99
    v_and_b32 v71, 0xffff0000, v99
    v_pk_add_f32 v[36:37], v[36:37], v[68:69]
    v_pk_add_f32 v[38:39], v[38:39], v[70:71]
    v_lshlrev_b32 v72, 16, v100
    v_and_b32 v73, 0xffff0000, v100
    v_lshlrev_b32 v74, 16, v101
    v_and_b32 v75, 0xffff0000, v101
    v_pk_add_f32 v[40:41], v[40:41], v[72:73]
    v_pk_add_f32 v[42:43], v[42:43], v[74:75]
    v_lshlrev_b32 v76, 16, v102
    v_and_b32 v77, 0xffff0000, v102
    v_lshlrev_b32 v78, 16, v103
    v_and_b32 v79, 0xffff0000, v103
    v_pk_add_f32 v[44:45], v[44:45], v[76:77]
    v_pk_add_f32 v[46:47], v[46:47], v[78:79]
    v_lshlrev_b32 v80, 16, v104
    v_and_b32 v81, 0xffff0000, v104
    v_lshlrev_b32 v82, 16, v105
    v_and_b32 v83, 0xffff0000, v105
    v_pk_add_f32 v[48:49], v[48:49], v[80:81]
    v_pk_add_f32 v[50:51], v[50:51], v[82:83]
    v_lshlrev_b32 v84, 16, v106
    v_and_b32 v85, 0xffff0000, v106
    v_lshlrev_b32 v86, 16, v107
    v_and_b32 v87, 0xffff0000, v107
    v_pk_add_f32 v[52:53], v[52:53], v[84:85]
    v_pk_add_f32 v[54:55], v[54:55], v[86:87]
    v_lshlrev_b32 v88, 16, v108
    v_and_b32 v89, 0xffff0000, v108
    v_lshlrev_b32 v90, 16, v109
    v_and_b32 v91, 0xffff0000, v109
    v_pk_add_f32 v[56:57], v[56:57], v[88:89]
    v_pk_add_f32 v[58:59], v[58:59], v[90:91]
    v_lshlrev_b32 v92, 16, v110
    v_and_b32 v93, 0xffff0000, v110
    v_lshlrev_b32 v94, 16, v111
    v_and_b32 v95, 0xffff0000, v111
    v_pk_add_f32 v[60:61], v[60:61], v[92:93]
    v_pk_add_f32 v[62:63], v[62:63], v[94:95]
    s_waitcnt vmcnt(0)
    v_max3_u32 v235, v160, v161, v162
    v_max3_u32 v235, v235, v163, v164
    v_max3_u32 v235, v235, v165, v166
    v_max3_u32 v235, v235, v167, v168
    v_max3_u32 v235, v235, v169, v170
    v_max3_u32 v235, v235, v171, v172
    v_max3_u32 v235, v235, v173, v174
    v_max_u32 v235, v235, v175
    v_cmp_eq_u32 vcc, -1, v235
    s_cbranch_vccnz kc_r2
kc_r2o:
    v_lshlrev_b32 v64, 16, v160
    v_and_b32 v65, 0xffff0000, v160
    v_lshlrev_b32 v66, 16, v161
    v_and_b32 v67, 0xffff0000, v161
    v_pk_add_f32 v[32:33], v[32:33], v[64:65]
    v_pk_add_f32 v[34:35], v[34:35], v[66:67]
    v_cvt_pk_bf16_f32 v0, v32, v33
    v_cvt_pk_bf16_f32 v1, v34, v35
    ds_write_b64 v238, v[0:1] offset:0
    v_lshlrev_b32 v68, 16, v162
    v_and_b32 v69, 0xffff0000, v162
    v_lshlrev_b32 v70, 16, v163
    v_and_b32 v71, 0xffff0000, v163
    v_pk_add_f32 v[36:37], v[36:37], v[68:69]
    v_pk_add_f32 v[38:39], v[38:39], v[70:71]
    v_cvt_pk_bf16_f32 v2, v36, v37
    v_cvt_pk_bf16_f32 v3, v38, v39
    ds_write_b64 v238, v[2:3] offset:2304
    v_lshlrev_b32 v72, 16, v164
    v_and_b32 v73, 0xffff0000, v164
    v_lshlrev_b32 v74, 16, v165
    v_and_b32 v75, 0xffff0000, v165
    v_pk_add_f32 v[40:41], v[40:41], v[72:73]
    v_pk_add_f32 v[42:43], v[42:43], v[74:75]
    v_cvt_pk_bf16_f32 v4, v40, v41
    v_cvt_pk_bf16_f32 v5, v42, v43
    ds_write_b64 v238, v[4:5] offset:32
    v_lshlrev_b32 v76, 16, v166
    v_and_b32 v77, 0xffff0000, v166
    v_lshlrev_b32 v78, 16, v167
    v_and_b32 v79, 0xffff0000, v167
    v_pk_add_f32 v[44:45], v[44:45], v[76:77]
    v_pk_add_f32 v[46:47], v[46:47], v[78:79]
    v_cvt_pk_bf16_f32 v6, v44, v45
    v_cvt_pk_bf16_f32 v7, v46, v47
    ds_write_b64 v238, v[6:7] offset:2336
    v_lshlrev_b32 v80, 16, v168
    v_and_b32 v81, 0xffff0000, v168
    v_lshlrev_b32 v82, 16, v169
    v_and_b32 v83, 0xffff0000, v169
    v_pk_add_f32 v[48:49], v[48:49], v[80:81]
    v_pk_add_f32 v[50:51], v[50:51], v[82:83]
    v_cvt_pk_bf16_f32 v8, v48, v49
    v_cvt_pk_bf16_f32 v9, v50, v51
    ds_write_b64 v238, v[8:9] offset:64
    v_lshlrev_b32 v84, 16, v170
    v_and_b32 v85, 0xffff0000, v170
    v_lshlrev_b32 v86, 16, v171
    v_and_b32 v87, 0xffff0000, v171
    v_pk_add_f32 v[52:53], v[52:53], v[84:85]
    v_pk_add_f32 v[54:55], v[54:55], v[86:87]
    v_cvt_pk_bf16_f32 v10, v52, v53
    v_cvt_pk_bf16_f32 v11, v54, v55
    ds_write_b64 v238, v[10:11] offset:2368
    v_lshlrev_b32 v88, 16, v172
    v_and_b32 v89, 0xffff0000, v172
    v_lshlrev_b32 v90, 16, v173
    v_and_b32 v91, 0xffff0000, v173
    v_pk_add_f32 v[56:57], v[56:57], v[88:89]
    v_pk_add_f32 v[58:59], v[58:59], v[90:91]
    v_cvt_pk_bf16_f32 v12, v56, v57
    v_cvt_pk_bf16_f32 v13, v58, v59
    ds_write_b64 v238, v[12:13] offset:96
    v_lshlrev_b32 v92, 16, v174
    v_and_b32 v93, 0xffff0000, v174
    v_lshlrev_b32 v94, 16, v175
    v_and_b32 v95, 0xffff0000, v175
    v_pk_add_f32 v[60:61], v[60:61], v[92:93]
    v_pk_add_f32 v[62:63], v[62:63], v[94:95]
    v_cvt_pk_bf16_f32 v14, v60, v61
    v_cvt_pk_bf16_f32 v15, v62, v63
    ds_write_b64 v238, v[14:15] offset:2400
    s_waitcnt lgkmcnt(0)
    ds_read_b128 v[16:19], v239 offset:0
    ds_read_b128 v[20:23], v239 offset:1152
    ds_read_b128 v[24:27], v239 offset:2304
    ds_read_b128 v[28:31], v239 offset:3456
    s_waitcnt lgkmcnt(3)
    v_lshlrev_b32 v64, 16, v16
    v_lshlrev_b32 v66, 16, v17
    v_lshlrev_b32 v68, 16, v18
    v_lshlrev_b32 v70, 16, v19
    v_and_b32 v65, 0xffff0000, v16
    v_and_b32 v67, 0xffff0000, v17
    v_and_b32 v69, 0xffff0000, v18
    v_and_b32 v71, 0xffff0000, v19
    v_pk_add_f32 v[64:65], v[64:65], v[128:129]
    v_pk_add_f32 v[66:67], v[66:67], v[130:131]
    v_pk_add_f32 v[68:69], v[68:69], v[132:133]
    v_pk_add_f32 v[70:71], v[70:71], v[134:135]
    v_cvt_pk_bf16_f32 v16, v64, v65
    v_cvt_pk_bf16_f32 v17, v66, v67
    v_cvt_pk_bf16_f32 v18, v68, v69
    v_cvt_pk_bf16_f32 v19, v70, v71
    v_lshlrev_b32 v64, 16, v16
    v_lshlrev_b32 v66, 16, v17
    v_lshlrev_b32 v68, 16, v18
    v_lshlrev_b32 v70, 16, v19
    v_and_b32 v65, 0xffff0000, v16
    v_and_b32 v67, 0xffff0000, v17
    v_and_b32 v69, 0xffff0000, v18
    v_and_b32 v71, 0xffff0000, v19
    s_mov_b32 s32, 0x3400000
    buffer_store_dwordx4 v[16:19], v229, s[8:11], s32 offen sc1
    v_pk_add_f32 v[160:161], v[64:65], v[66:67]
    v_pk_mul_f32 v[162:163], v[64:65], v[64:65]
    v_pk_mul_f32 v[164:165], v[64:65], v[112:113]
    v_pk_fma_f32 v[162:163], v[66:67], v[66:67], v[162:163]
    v_pk_fma_f32 v[164:165], v[66:67], v[114:115], v[164:165]
    v_pk_add_f32 v[160:161], v[160:161], v[68:69]
    v_pk_fma_f32 v[162:163], v[68:69], v[68:69], v[162:163]
    v_pk_fma_f32 v[164:165], v[68:69], v[116:117], v[164:165]
    v_pk_add_f32 v[160:161], v[160:161], v[70:71]
    v_pk_fma_f32 v[162:163], v[70:71], v[70:71], v[162:163]
    v_pk_fma_f32 v[164:165], v[70:71], v[118:119], v[164:165]
    v_add_f32 v184, v160, v161
    v_add_f32 v185, v162, v163
    v_add_f32 v186, v164, v165
    s_waitcnt lgkmcnt(2)
    v_lshlrev_b32 v72, 16, v20
    v_lshlrev_b32 v74, 16, v21
    v_lshlrev_b32 v76, 16, v22
    v_lshlrev_b32 v78, 16, v23
    v_and_b32 v73, 0xffff0000, v20
    v_and_b32 v75, 0xffff0000, v21
    v_and_b32 v77, 0xffff0000, v22
    v_and_b32 v79, 0xffff0000, v23
    v_pk_add_f32 v[72:73], v[72:73], v[136:137]
    v_pk_add_f32 v[74:75], v[74:75], v[138:139]
    v_pk_add_f32 v[76:77], v[76:77], v[140:141]
    v_pk_add_f32 v[78:79], v[78:79], v[142:143]
    v_cvt_pk_bf16_f32 v20, v72, v73
    v_cvt_pk_bf16_f32 v21, v74, v75
    v_cvt_pk_bf16_f32 v22, v76, v77
    v_cvt_pk_bf16_f32 v23, v78, v79
    v_lshlrev_b32 v72, 16, v20
    v_lshlrev_b32 v74, 16, v21
    v_lshlrev_b32 v76, 16, v22
    v_lshlrev_b32 v78, 16, v23
    v_and_b32 v73, 0xffff0000, v20
    v_and_b32 v75, 0xffff0000, v21
    v_and_b32 v77, 0xffff0000, v22
    v_and_b32 v79, 0xffff0000, v23
    s_mov_b32 s32, 0x3404000
    buffer_store_dwordx4 v[20:23], v229, s[8:11], s32 offen sc1
    v_pk_add_f32 v[166:167], v[72:73], v[74:75]
    v_pk_mul_f32 v[168:169], v[72:73], v[72:73]
    v_pk_mul_f32 v[170:171], v[72:73], v[112:113]
    v_pk_fma_f32 v[168:169], v[74:75], v[74:75], v[168:169]
    v_pk_fma_f32 v[170:171], v[74:75], v[114:115], v[170:171]
    v_pk_add_f32 v[166:167], v[166:167], v[76:77]
    v_pk_fma_f32 v[168:169], v[76:77], v[76:77], v[168:169]
    v_pk_fma_f32 v[170:171], v[76:77], v[116:117], v[170:171]
    v_pk_add_f32 v[166:167], v[166:167], v[78:79]
    v_pk_fma_f32 v[168:169], v[78:79], v[78:79], v[168:169]
    v_pk_fma_f32 v[170:171], v[78:79], v[118:119], v[170:171]
    v_add_f32 v187, v166, v167
    v_add_f32 v188, v168, v169
    v_add_f32 v189, v170, v171
    s_waitcnt lgkmcnt(1)
    v_lshlrev_b32 v80, 16, v24
    v_lshlrev_b32 v82, 16, v25
    v_lshlrev_b32 v84, 16, v26
    v_lshlrev_b32 v86, 16, v27
    v_and_b32 v81, 0xffff0000, v24
    v_and_b32 v83, 0xffff0000, v25
    v_and_b32 v85, 0xffff0000, v26
    v_and_b32 v87, 0xffff0000, v27
    v_pk_add_f32 v[80:81], v[80:81], v[144:145]
    v_pk_add_f32 v[82:83], v[82:83], v[146:147]
    v_pk_add_f32 v[84:85], v[84:85], v[148:149]
    v_pk_add_f32 v[86:87], v[86:87], v[150:151]
    v_cvt_pk_bf16_f32 v24, v80, v81
    v_cvt_pk_bf16_f32 v25, v82, v83
    v_cvt_pk_bf16_f32 v26, v84, v85
    v_cvt_pk_bf16_f32 v27, v86, v87
    v_lshlrev_b32 v80, 16, v24
    v_lshlrev_b32 v82, 16, v25
    v_lshlrev_b32 v84, 16, v26
    v_lshlrev_b32 v86, 16, v27
    v_and_b32 v81, 0xffff0000, v24
    v_and_b32 v83, 0xffff0000, v25
    v_and_b32 v85, 0xffff0000, v26
    v_and_b32 v87, 0xffff0000, v27
    s_mov_b32 s32, 0x3408000
    buffer_store_dwordx4 v[24:27], v229, s[8:11], s32 offen sc1
    v_pk_add_f32 v[172:173], v[80:81], v[82:83]
    v_pk_mul_f32 v[174:175], v[80:81], v[80:81]
    v_pk_mul_f32 v[176:177], v[80:81], v[112:113]
    v_pk_fma_f32 v[174:175], v[82:83], v[82:83], v[174:175]
    v_pk_fma_f32 v[176:177], v[82:83], v[114:115], v[176:177]
    v_pk_add_f32 v[172:173], v[172:173], v[84:85]
    v_pk_fma_f32 v[174:175], v[84:85], v[84:85], v[174:175]
    v_pk_fma_f32 v[176:177], v[84:85], v[116:117], v[176:177]
    v_pk_add_f32 v[172:173], v[172:173], v[86:87]
    v_pk_fma_f32 v[174:175], v[86:87], v[86:87], v[174:175]
    v_pk_fma_f32 v[176:177], v[86:87], v[118:119], v[176:177]
    v_add_f32 v190, v172, v173
    v_add_f32 v191, v174, v175
    v_add_f32 v192, v176, v177
    s_waitcnt lgkmcnt(0)
    v_lshlrev_b32 v88, 16, v28
    v_lshlrev_b32 v90, 16, v29
    v_lshlrev_b32 v92, 16, v30
    v_lshlrev_b32 v94, 16, v31
    v_and_b32 v89, 0xffff0000, v28
    v_and_b32 v91, 0xffff0000, v29
    v_and_b32 v93, 0xffff0000, v30
    v_and_b32 v95, 0xffff0000, v31
    v_pk_add_f32 v[88:89], v[88:89], v[152:153]
    v_pk_add_f32 v[90:91], v[90:91], v[154:155]
    v_pk_add_f32 v[92:93], v[92:93], v[156:157]
    v_pk_add_f32 v[94:95], v[94:95], v[158:159]
    v_cvt_pk_bf16_f32 v28, v88, v89
    v_cvt_pk_bf16_f32 v29, v90, v91
    v_cvt_pk_bf16_f32 v30, v92, v93
    v_cvt_pk_bf16_f32 v31, v94, v95
    v_lshlrev_b32 v88, 16, v28
    v_lshlrev_b32 v90, 16, v29
    v_lshlrev_b32 v92, 16, v30
    v_lshlrev_b32 v94, 16, v31
    v_and_b32 v89, 0xffff0000, v28
    v_and_b32 v91, 0xffff0000, v29
    v_and_b32 v93, 0xffff0000, v30
    v_and_b32 v95, 0xffff0000, v31
    s_mov_b32 s32, 0x340c000
    buffer_store_dwordx4 v[28:31], v229, s[8:11], s32 offen sc1
    v_pk_add_f32 v[178:179], v[88:89], v[90:91]
    v_pk_mul_f32 v[180:181], v[88:89], v[88:89]
    v_pk_mul_f32 v[182:183], v[88:89], v[112:113]
    v_pk_fma_f32 v[180:181], v[90:91], v[90:91], v[180:181]
    v_pk_fma_f32 v[182:183], v[90:91], v[114:115], v[182:183]
    v_pk_add_f32 v[178:179], v[178:179], v[92:93]
    v_pk_fma_f32 v[180:181], v[92:93], v[92:93], v[180:181]
    v_pk_fma_f32 v[182:183], v[92:93], v[116:117], v[182:183]
    v_pk_add_f32 v[178:179], v[178:179], v[94:95]
    v_pk_fma_f32 v[180:181], v[94:95], v[94:95], v[180:181]
    v_pk_fma_f32 v[182:183], v[94:95], v[118:119], v[182:183]
    v_add_f32 v193, v178, v179
    v_add_f32 v194, v180, v181
    v_add_f32 v195, v182, v183
    v_add_f32_dpp v196, v196, v196 quad_perm:[1,0,3,2] row_mask:0xf bank_mask:0xf
    v_add_f32_dpp v184, v184, v184 quad_perm:[1,0,3,2] row_mask:0xf bank_mask:0xf
    v_add_f32_dpp v185, v185, v185 quad_perm:[1,0,3,2] row_mask:0xf bank_mask:0xf
    v_add_f32_dpp v186, v186, v186 quad_perm:[1,0,3,2] row_mask:0xf bank_mask:0xf
    v_add_f32_dpp v187, v187, v187 quad_perm:[1,0,3,2] row_mask:0xf bank_mask:0xf
    v_add_f32_dpp v188, v188, v188 quad_perm:[1,0,3,2] row_mask:0xf bank_mask:0xf
    v_add_f32_dpp v189, v189, v189 quad_perm:[1,0,3,2] row_mask:0xf bank_mask:0xf
    v_add_f32_dpp v190, v190, v190 quad_perm:[1,0,3,2] row_mask:0xf bank_mask:0xf
    v_add_f32_dpp v191, v191, v191 quad_perm:[1,0,3,2] row_mask:0xf bank_mask:0xf
    v_add_f32_dpp v192, v192, v192 quad_perm:[1,0,3,2] row_mask:0xf bank_mask:0xf
    v_add_f32_dpp v193, v193, v193 quad_perm:[1,0,3,2] row_mask:0xf bank_mask:0xf
    v_add_f32_dpp v194, v194, v194 quad_perm:[1,0,3,2] row_mask:0xf bank_mask:0xf
    v_add_f32_dpp v195, v195, v195 quad_perm:[1,0,3,2] row_mask:0xf bank_mask:0xf
    v_add_f32_dpp v196, v196, v196 quad_perm:[2,3,0,1] row_mask:0xf bank_mask:0xf
    v_add_f32_dpp v184, v184, v184 quad_perm:[2,3,0,1] row_mask:0xf bank_mask:0xf
    v_add_f32_dpp v185, v185, v185 quad_perm:[2,3,0,1] row_mask:0xf bank_mask:0xf
    v_add_f32_dpp v186, v186, v186 quad_perm:[2,3,0,1] row_mask:0xf bank_mask:0xf
    v_add_f32_dpp v187, v187, v187 quad_perm:[2,3,0,1] row_mask:0xf bank_mask:0xf
    v_add_f32_dpp v188, v188, v188 quad_perm:[2,3,0,1] row_mask:0xf bank_mask:0xf
    v_add_f32_dpp v189, v189, v189 quad_perm:[2,3,0,1] row_mask:0xf bank_mask:0xf
    v_add_f32_dpp v190, v190, v190 quad_perm:[2,3,0,1] row_mask:0xf bank_mask:0xf
    v_add_f32_dpp v191, v191, v191 quad_perm:[2,3,0,1] row_mask:0xf bank_mask:0xf
    v_add_f32_dpp v192, v192, v192 quad_perm:[2,3,0,1] row_mask:0xf bank_mask:0xf
    v_add_f32_dpp v193, v193, v193 quad_perm:[2,3,0,1] row_mask:0xf bank_mask:0xf
    v_add_f32_dpp v194, v194, v194 quad_perm:[2,3,0,1] row_mask:0xf bank_mask:0xf
    v_add_f32_dpp v195, v195, v195 quad_perm:[2,3,0,1] row_mask:0xf bank_mask:0xf
    v_add_f32_dpp v196, v196, v196 row_half_mirror row_mask:0xf bank_mask:0xf
    v_add_f32_dpp v184, v184, v184 row_half_mirror row_mask:0xf bank_mask:0xf
    v_add_f32_dpp v185, v185, v185 row_half_mirror row_mask:0xf bank_mask:0xf
    v_add_f32_dpp v186, v186, v186 row_half_mirror row_mask:0xf bank_mask:0xf
    v_add_f32_dpp v187, v187, v187 row_half_mirror row_mask:0xf bank_mask:0xf
    v_add_f32_dpp v188, v188, v188 row_half_mirror row_mask:0xf bank_mask:0xf
    v_add_f32_dpp v189, v189, v189 row_half_mirror row_mask:0xf bank_mask:0xf
    v_add_f32_dpp v190, v190, v190 row_half_mirror row_mask:0xf bank_mask:0xf
    v_add_f32_dpp v191, v191, v191 row_half_mirror row_mask:0xf bank_mask:0xf
    v_add_f32_dpp v192, v192, v192 row_half_mirror row_mask:0xf bank_mask:0xf
    v_add_f32_dpp v193, v193, v193 row_half_mirror row_mask:0xf bank_mask:0xf
    v_add_f32_dpp v194, v194, v194 row_half_mirror row_mask:0xf bank_mask:0xf
    v_add_f32_dpp v195, v195, v195 row_half_mirror row_mask:0xf bank_mask:0xf
    v_cndmask_b32 v184, v184, v187, s[60:61]
    v_cndmask_b32 v190, v190, v193, s[60:61]
    v_cndmask_b32 v185, v185, v188, s[60:61]
    v_cndmask_b32 v191, v191, v194, s[60:61]
    v_cndmask_b32 v186, v186, v189, s[60:61]
    v_cndmask_b32 v192, v192, v195, s[60:61]
    v_cndmask_b32 v184, v184, v190, s[62:63]
    v_cndmask_b32 v185, v185, v191, s[62:63]
    v_cndmask_b32 v186, v186, v192, s[62:63]
    v_cndmask_b32 v184, v184, v185, s[40:41]
    v_cndmask_b32 v186, v186, v196, s[40:41]
    buffer_atomic_add_f32 v184, v231, s[8:11], s48 offen
    buffer_atomic_add_f32 v186, v232, s[8:11], s48 offen
    s_lshl_b32 s32, s3, 13
    v_add_u32 v234, s32, v228
    v_add_u32 v235, 65536, v234
    ds_write_b128 v234, a[128:131] offset:0
    ds_write_b128 v234, a[132:135] offset:1024
    ds_write_b128 v234, a[136:139] offset:2048
    ds_write_b128 v234, a[140:143] offset:3072
    ds_write_b128 v234, a[144:147] offset:4096
    ds_write_b128 v234, a[148:151] offset:5120
    ds_write_b128 v234, a[152:155] offset:6144
    ds_write_b128 v234, a[156:159] offset:7168
    s_waitcnt lgkmcnt(4)
    ds_write_b128 v234, a[160:163] offset:32768
    ds_write_b128 v234, a[164:167] offset:33792
    ds_write_b128 v234, a[168:171] offset:34816
    ds_write_b128 v234, a[172:175] offset:35840
    ds_write_b128 v234, a[176:179] offset:36864
    ds_write_b128 v234, a[180:183] offset:37888
    ds_write_b128 v234, a[184:187] offset:38912
    ds_write_b128 v234, a[188:191] offset:39936
    s_waitcnt lgkmcnt(4)
    ds_write_b128 v235, a[192:195] offset:0
    ds_write_b128 v235, a[196:199] offset:1024
    ds_write_b128 v235, a[200:203] offset:2048
    ds_write_b128 v235, a[204:207] offset:3072
    ds_write_b128 v235, a[208:211] offset:4096
    ds_write_b128 v235, a[212:215] offset:5120
    ds_write_b128 v235, a[216:219] offset:6144
    ds_write_b128 v235, a[220:223] offset:7168
    s_waitcnt lgkmcnt(4)
    s_lshl_b32 s35, s3, 13
    v_bfe_u32 v234, v237, 2, 3
    v_lshrrev_b32 v235, 5, v237
    v_lshl_add_u32 v234, v235, 4, v234
    v_lshlrev_b32 v234, 5, v234
    v_and_b32 v236, 3, v237
    v_lshl_add_u32 v234, v236, 3, v234
    v_add_u32 v217, s35, v234
    v_lshlrev_b32 v235, 5, v235
    v_bfe_u32 v236, v237, 4, 1
    v_lshl_add_u32 v235, v236, 3, v235
    v_and_b32 v236, 1, v237
    v_lshl_add_u32 v235, v236, 11, v235
    s_lshl_b32 s32, s3, 9
    s_add_u32 s32, s32, 98304
    v_add_u32 v218, s32, v235
    v_lshlrev_b32 v234, 4, v230
    v_add_u32 v220, 106752, v234
    v_add_u32 v221, 106752, v228
    v_lshrrev_b32 v236, 2, v237
    v_lshlrev_b32 v236, 7, v236
    v_and_b32 v234, 3, v237
    v_lshl_add_u32 v236, v234, 3, v236
    s_add_u32 s32, s35, 65536
    v_add_u32 v219, s32, v236
    s_lshl_b32 s32, s3, 12
    s_add_u32 s32, s32, 114944
    v_and_b32 v234, 15, v237
    v_min_u32 v234, 2, v234
    v_lshlrev_b32 v234, 10, v234
    v_lshrrev_b32 v235, 4, v237
    v_lshl_add_u32 v234, v235, 4, v234
    v_add_u32 v222, s32, v234
    v_add_u32 v223, s32, v228
    s_waitcnt vmcnt(0)
    s_barrier
    s_cmp_lg_u32 s3, 0
    s_cbranch_scc1 kc_a1
    s_lshl_b32 s32, s52, 7
    s_add_u32 s32, s32, 0x38a0000
    v_mov_b32 v235, 1
    buffer_atomic_add v235, v243, s[8:11], s32 offen sc0 sc1
    v_lshlrev_b32 v234, 7, v237
    v_cmp_gt_u32 vcc, 8, v237
    v_mov_b32 v236, 0x40000000
    s_mov_b32 s34, 0x38a0400
    v_cndmask_b32 v234, v236, v234, vcc
    s_waitcnt vmcnt(0)
    v_readfirstlane_b32 s36, v235
    s_cmp_lg_u32 s36, 31
    s_cbranch_scc1 kc_a1
    buffer_atomic_add v233, v234, s[8:11], s34 offen sc1
kc_a1:
    s_waitcnt lgkmcnt(0)
    ds_read_b64_tr_b16 a[0:1], v217 offset:0
    ds_read_b64_tr_b16 a[2:3], v217 offset:256
    ds_read_b64_tr_b16 a[32:33], v217 offset:32768
    ds_read_b64_tr_b16 a[34:35], v217 offset:33024
    ds_read_b64_tr_b16 a[4:5], v217 offset:1024
    ds_read_b64_tr_b16 a[6:7], v217 offset:1280
    ds_read_b64_tr_b16 a[36:37], v217 offset:33792
    ds_read_b64_tr_b16 a[38:39], v217 offset:34048
    s_waitcnt lgkmcnt(6)
    ds_read_b64_tr_b16 a[8:9], v217 offset:2048
    ds_read_b64_tr_b16 a[10:11], v217 offset:2304
    ds_read_b64_tr_b16 a[40:41], v217 offset:34816
    ds_read_b64_tr_b16 a[42:43], v217 offset:35072
    ds_read_b64_tr_b16 a[12:13], v217 offset:3072
    ds_read_b64_tr_b16 a[14:15], v217 offset:3328
    ds_read_b64_tr_b16 a[44:45], v217 offset:35840
    ds_read_b64_tr_b16 a[46:47], v217 offset:36096
    s_waitcnt lgkmcnt(6)
    ds_read_b64_tr_b16 a[16:17], v217 offset:4096
    ds_read_b64_tr_b16 a[18:19], v217 offset:4352
    ds_read_b64_tr_b16 a[48:49], v217 offset:36864
    ds_read_b64_tr_b16 a[50:51], v217 offset:37120
    ds_read_b64_tr_b16 a[20:21], v217 offset:5120
    ds_read_b64_tr_b16 a[22:23], v217 offset:5376
    ds_read_b64_tr_b16 a[52:53], v217 offset:37888
    ds_read_b64_tr_b16 a[54:55], v217 offset:38144
    s_waitcnt lgkmcnt(6)
    ds_read_b64_tr_b16 a[24:25], v217 offset:6144
    ds_read_b64_tr_b16 a[26:27], v217 offset:6400
    ds_read_b64_tr_b16 a[56:57], v217 offset:38912
    ds_read_b64_tr_b16 a[58:59], v217 offset:39168
    ds_read_b64_tr_b16 a[28:29], v217 offset:7168
    ds_read_b64_tr_b16 a[30:31], v217 offset:7424
    ds_read_b64_tr_b16 a[60:61], v217 offset:39936
    ds_read_b64_tr_b16 a[62:63], v217 offset:40192
    s_waitcnt lgkmcnt(6)
    ds_read_b64_tr_b16 a[64:65], v219 offset:0
    ds_read_b64_tr_b16 a[66:67], v219 offset:32
    ds_read_b64_tr_b16 a[68:69], v219 offset:64
    ds_read_b64_tr_b16 a[70:71], v219 offset:96
    ds_read_b64_tr_b16 a[72:73], v219 offset:2048
    ds_read_b64_tr_b16 a[74:75], v219 offset:2080
    ds_read_b64_tr_b16 a[76:77], v219 offset:2112
    ds_read_b64_tr_b16 a[78:79], v219 offset:2144
    s_waitcnt lgkmcnt(6)
    ds_read_b64_tr_b16 a[80:81], v219 offset:4096
    ds_read_b64_tr_b16 a[82:83], v219 offset:4128
    ds_read_b64_tr_b16 a[84:85], v219 offset:4160
    ds_read_b64_tr_b16 a[86:87], v219 offset:4192
    ds_read_b64_tr_b16 a[88:89], v219 offset:6144
    ds_read_b64_tr_b16 a[90:91], v219 offset:6176
    ds_read_b64_tr_b16 a[92:93], v219 offset:6208
    ds_read_b64_tr_b16 a[94:95], v219 offset:6240
    s_waitcnt lgkmcnt(6)
    v_mov_b32 v130, 0x3a800000
    v_mov_b32 v131, 0x3a800000
    v_mov_b32 v132, 0x3727c5ac
    v_mov_b32 v133, 0x3727c5ac
    s_mov_b32 s33, 0xfffff800
    s_lshl_b32 s39, s3, 11
    v_add_u32 v238, s39, v228
    v_lshlrev_b32 v239, 2, v242
    s_lshl_b32 s39, s3, 3
    s_add_u32 s7, s39, 106512
    v_lshlrev_b32 v141, 5, v237
    v_or_b32 v141, s39, v141
    s_cmp_lg_u32 s3, 0
    s_cbranch_scc1 kc_b12
    s_lshl_b32 s32, s52, 7
    s_add_u32 s32, s32, 0x38a0400
    s_mov_b32 s34, 0x400000
    s_branch kc_b11
kc_b10:
    s_sleep 2
kc_b11:
    buffer_load_dword v235, off, s[8:11], s32 sc1
    s_waitcnt vmcnt(0)
    v_cmp_ne_u32 vcc, 8, v235
    s_sub_u32 s34, s34, 1
    s_cbranch_scc1 kc_b12
    s_cbranch_vccnz kc_b10
kc_b12:
    s_barrier
    s_add_u32 s32, s48, 24576
    buffer_load_dword v128, off, s[8:11], s32 sc1
    buffer_load_dwordx4 v[32:35], v238, s[8:11], s48 offen offset:0 sc1
    buffer_load_dwordx4 v[40:43], v238, s[8:11], s49 offen offset:0 sc1
    buffer_load_dwordx4 v[48:51], v238, s[8:11], s50 offen offset:0 sc1
    buffer_load_dwordx4 v[36:39], v238, s[8:11], s48 offen offset:1024 sc1
    buffer_load_dwordx4 v[44:47], v238, s[8:11], s49 offen offset:1024 sc1
    buffer_load_dwordx4 v[52:55], v238, s[8:11], s50 offen offset:1024 sc1
    buffer_load_dword v0, v239, s[8:11], s48 offen offset:0 sc1
    buffer_load_dword v4, v239, s[8:11], s49 offen offset:0 sc1
    buffer_load_dword v1, v239, s[8:11], s48 offen offset:32 sc1
    buffer_load_dword v5, v239, s[8:11], s49 offen offset:32 sc1
    buffer_load_dword v2, v239, s[8:11], s48 offen offset:64 sc1
    buffer_load_dword v6, v239, s[8:11], s49 offen offset:64 sc1
    buffer_load_dword v3, v239, s[8:11], s48 offen offset:96 sc1
    buffer_load_dword v7, v239, s[8:11], s49 offen offset:96 sc1
    s_waitcnt vmcnt(8)
    v_mov_b32 v129, v128
    v_pk_mul_f32 v[32:33], v[32:33], v[130:131]
    v_pk_mul_f32 v[34:35], v[34:35], v[130:131]
    v_pk_mul_f32 v[36:37], v[36:37], v[130:131]
    v_pk_mul_f32 v[38:39], v[38:39], v[130:131]
    v_pk_fma_f32 v[40:41], v[40:41], v[130:131], v[132:133]
    v_pk_fma_f32 v[42:43], v[42:43], v[130:131], v[132:133]
    v_pk_fma_f32 v[44:45], v[44:45], v[130:131], v[132:133]
    v_pk_fma_f32 v[46:47], v[46:47], v[130:131], v[132:133]
    v_pk_fma_f32 v[40:41], v[32:33], v[32:33], v[40:41] neg_lo:[1,0,0] neg_hi:[1,0,0]
    v_pk_fma_f32 v[42:43], v[34:35], v[34:35], v[42:43] neg_lo:[1,0,0] neg_hi:[1,0,0]
    v_pk_fma_f32 v[44:45], v[36:37], v[36:37], v[44:45] neg_lo:[1,0,0] neg_hi:[1,0,0]
    v_pk_fma_f32 v[46:47], v[38:39], v[38:39], v[46:47] neg_lo:[1,0,0] neg_hi:[1,0,0]
    v_pk_fma_f32 v[48:49], v[32:33], v[128:129], v[48:49] neg_lo:[1,0,0] neg_hi:[1,0,0]
    v_pk_fma_f32 v[50:51], v[34:35], v[128:129], v[50:51] neg_lo:[1,0,0] neg_hi:[1,0,0]
    v_pk_fma_f32 v[52:53], v[36:37], v[128:129], v[52:53] neg_lo:[1,0,0] neg_hi:[1,0,0]
    v_pk_fma_f32 v[54:55], v[38:39], v[128:129], v[54:55] neg_lo:[1,0,0] neg_hi:[1,0,0]
    v_max_f32 v40, v40, v132
    v_max_f32 v42, v42, v132
    v_max_f32 v44, v44, v132
    v_max_f32 v46, v46, v132
    v_max_f32 v41, v41, v132
    v_max_f32 v43, v43, v132
    v_max_f32 v45, v45, v132
    v_max_f32 v47, v47, v132
    v_rsq_f32 v40, v40
    v_rsq_f32 v42, v42
    v_rsq_f32 v44, v44
    v_rsq_f32 v46, v46
    v_rsq_f32 v41, v41
    v_rsq_f32 v43, v43
    v_rsq_f32 v45, v45
    v_rsq_f32 v47, v47
    v_pk_mul_f32 v[48:49], v[48:49], v[40:41]
    v_pk_mul_f32 v[50:51], v[50:51], v[42:43]
    v_pk_mul_f32 v[52:53], v[52:53], v[44:45]
    v_pk_mul_f32 v[54:55], v[54:55], v[46:47]
    v_and_or_b32 v48, v48, s33, 0
    v_and_or_b32 v50, v50, s33, 2
    v_and_or_b32 v52, v52, s33, 4
    v_and_or_b32 v54, v54, s33, 6
    v_and_or_b32 v49, v49, s33, 1
    v_and_or_b32 v51, v51, s33, 3
    v_and_or_b32 v53, v53, s33, 5
    v_and_or_b32 v55, v55, s33, 7
    v_max_f32 v136, v48, v49
    v_min_f32 v137, v48, v49
    v_med3_f32 v137, v136, v50, v137
    v_max_f32 v136, v136, v50
    v_med3_f32 v137, v136, v51, v137
    v_max_f32 v136, v136, v51
    v_med3_f32 v137, v136, v52, v137
    v_max_f32 v136, v136, v52
    v_med3_f32 v137, v136, v53, v137
    v_max_f32 v136, v136, v53
    v_med3_f32 v137, v136, v54, v137
    v_max_f32 v136, v136, v54
    v_med3_f32 v137, v136, v55, v137
    v_max_f32 v136, v136, v55
    v_or_b32 v136, v141, v136
    v_or_b32 v137, v141, v137
    s_nop 1
    v_mov_b32_dpp v138, v136 quad_perm:[1,0,3,2] row_mask:0xf bank_mask:0xf
    v_mov_b32_dpp v139, v137 quad_perm:[1,0,3,2] row_mask:0xf bank_mask:0xf
    v_min_f32 v140, v136, v138
    v_max_f32 v136, v136, v138
    v_max3_f32 v137, v140, v137, v139
    s_nop 1
    v_mov_b32_dpp v138, v136 quad_perm:[2,3,0,1] row_mask:0xf bank_mask:0xf
    v_mov_b32_dpp v139, v137 quad_perm:[2,3,0,1] row_mask:0xf bank_mask:0xf
    v_min_f32 v140, v136, v138
    v_max_f32 v136, v136, v138
    v_max3_f32 v137, v140, v137, v139
    s_nop 1
    v_mov_b32_dpp v138, v136 row_half_mirror row_mask:0xf bank_mask:0xf
    v_mov_b32_dpp v139, v137 row_half_mirror row_mask:0xf bank_mask:0xf
    v_min_f32 v140, v136, v138
    v_max_f32 v136, v136, v138
    v_max3_f32 v137, v140, v137, v139
    s_nop 1
    v_mov_b32_dpp v138, v136 row_mirror row_mask:0xf bank_mask:0xf
    v_mov_b32_dpp v139, v137 row_mirror row_mask:0xf bank_mask:0xf
    v_min_f32 v140, v136, v138
    v_max_f32 v136, v136, v138
    v_max3_f32 v137, v140, v137, v139
    v_mov_b32 v138, v136
    v_mov_b32 v139, v137
    s_nop 1
    v_permlane16_swap_b32 v136, v138
    v_permlane16_swap_b32 v137, v139
    s_nop 0
    v_min_f32 v140, v136, v138
    v_max_f32 v136, v136, v138
    v_max3_f32 v137, v140, v137, v139
    v_mov_b32 v138, v136
    v_mov_b32 v139, v137
    s_nop 1
    v_permlane32_swap_b32 v136, v138
    v_permlane32_swap_b32 v137, v139
    s_nop 0
    v_min_f32 v140, v136, v138
    v_max_f32 v136, v136, v138
    v_max3_f32 v137, v140, v137, v139
    v_mov_b32 v234, s7
    ds_write_b64 v234, v[136:137]
    v_mov_b32 v234, 106512
    s_waitcnt lgkmcnt(0)
    s_barrier
    ds_read_b128 v[56:59], v234
    ds_read_b128 v[60:63], v234 offset:16
    s_waitcnt lgkmcnt(0)
    v_min_f32 v140, v56, v58
    v_max_f32 v56, v56, v58
    v_max3_f32 v57, v140, v57, v59
    v_min_f32 v140, v60, v62
    v_max_f32 v60, v60, v62
    v_max3_f32 v61, v140, v61, v63
    v_min_f32 v140, v56, v60
    v_max_f32 v56, v56, v60
    v_max3_f32 v57, v140, v57, v61
    v_bfe_u32 v234, v56, 5, 6
    v_bfe_u32 v235, v56, 2, 3
    v_and_b32 v8, 3, v56
    v_lshl_add_u32 v8, v234, 2, v8
    v_lshl_add_u32 v8, v235, 8, v8
    v_bfe_u32 v234, v57, 5, 6
    v_bfe_u32 v235, v57, 2, 3
    v_and_b32 v10, 3, v57
    v_lshl_add_u32 v10, v234, 2, v10
    v_lshl_add_u32 v10, v235, 8, v10
    s_cmp_lt_u32 s3, 2
    s_cselect_b64 vcc, -1, 0
    v_lshlrev_b32 v236, 4, v230
    v_cndmask_b32 v142, v10, v8, vcc
    v_lshlrev_b32 v234, 2, v142
    v_and_b32 v235, 2047, v236
    v_lshl_add_u32 v235, v142, 11, v235
    s_mov_b32 s32, 0x3400000
    buffer_load_dwordx4 v[32:35], v235, s[8:11], s32 offen sc1
    buffer_load_dword v144, v234, s[8:11], s48 offen sc1
    buffer_load_dword v145, v234, s[8:11], s49 offen sc1
    buffer_load_dword v146, v234, s[8:11], s50 offen sc1
    v_add_u32 v236, 98304, v236
    s_lshr_b32 s32, s3, 1
    s_lshl_b32 s32, s32, 2
    s_add_u32 s32, s32, 106496
    v_mov_b32 v234, s32
    s_waitcnt vmcnt(4)
    v_mul_f32 v0, 0x3a800000, v0
    v_mul_f32 v1, 0x3a800000, v1
    v_mul_f32 v2, 0x3a800000, v2
    v_mul_f32 v3, 0x3a800000, v3
    v_mul_f32 v4, 0x3a800000, v4
    v_mul_f32 v5, 0x3a800000, v5
    v_mul_f32 v6, 0x3a800000, v6
    v_mul_f32 v7, 0x3a800000, v7
    v_fma_f32 v4, -v0, v0, v4
    v_fma_f32 v5, -v1, v1, v5
    v_fma_f32 v6, -v2, v2, v6
    v_fma_f32 v7, -v3, v3, v7
    v_max_f32 v4, 0, v4
    v_max_f32 v5, 0, v5
    v_max_f32 v6, 0, v6
    v_max_f32 v7, 0, v7
    v_cvt_pk_bf16_f32 v12, v0, v4
    v_cvt_pk_bf16_f32 v13, v1, v5
    v_cvt_pk_bf16_f32 v14, v2, v6
    v_cvt_pk_bf16_f32 v15, v3, v7
    v_lshlrev_b32 v0, 16, v12
    v_lshlrev_b32 v1, 16, v13
    v_lshlrev_b32 v2, 16, v14
    v_lshlrev_b32 v3, 16, v15
    v_and_b32 v4, 0xffff0000, v12
    v_and_b32 v5, 0xffff0000, v13
    v_and_b32 v6, 0xffff0000, v14
    v_and_b32 v7, 0xffff0000, v15
    v_add_f32 v4, 0x3727c5ac, v4
    v_add_f32 v5, 0x3727c5ac, v5
    v_add_f32 v6, 0x3727c5ac, v6
    v_add_f32 v7, 0x3727c5ac, v7
    v_cvt_pk_bf16_f32 v4, v4, v4
    v_cvt_pk_bf16_f32 v5, v5, v5
    v_cvt_pk_bf16_f32 v6, v6, v6
    v_cvt_pk_bf16_f32 v7, v7, v7
    v_lshlrev_b32 v4, 16, v4
    v_lshlrev_b32 v5, 16, v5
    v_lshlrev_b32 v6, 16, v6
    v_lshlrev_b32 v7, 16, v7
    v_sqrt_f32 v4, v4
    v_sqrt_f32 v5, v5
    v_sqrt_f32 v6, v6
    v_sqrt_f32 v7, v7
    v_cvt_pk_bf16_f32 v4, v4, v4
    v_cvt_pk_bf16_f32 v5, v5, v5
    v_cvt_pk_bf16_f32 v6, v6, v6
    v_cvt_pk_bf16_f32 v7, v7, v7
    v_lshlrev_b32 v4, 16, v4
    v_lshlrev_b32 v5, 16, v5
    v_lshlrev_b32 v6, 16, v6
    v_lshlrev_b32 v7, 16, v7
    v_rcp_f32 v4, v4
    v_rcp_f32 v5, v5
    v_rcp_f32 v6, v6
    v_rcp_f32 v7, v7
    s_waitcnt vmcnt(0)
    v_mul_f32 v144, 0x3a800000, v144
    v_mul_f32 v145, 0x3a800000, v145
    v_fma_f32 v145, -v144, v144, v145
    v_max_f32 v145, 0, v145
    v_cvt_pk_bf16_f32 v140, v144, v145
    v_lshlrev_b32 v144, 16, v140
    v_and_b32 v145, 0xffff0000, v140
    v_add_f32 v145, 0x3727c5ac, v145
    v_cvt_pk_bf16_f32 v145, v145, v145
    v_lshlrev_b32 v145, 16, v145
    v_sqrt_f32 v145, v145
    s_nop 0
    v_cvt_pk_bf16_f32 v145, v145, v145
    v_lshlrev_b32 v145, 16, v145
    v_rcp_f32 v145, v145
    s_nop 0
    v_lshlrev_b32 v64, 16, v32
    v_lshlrev_b32 v66, 16, v33
    v_lshlrev_b32 v68, 16, v34
    v_lshlrev_b32 v70, 16, v35
    v_and_b32 v65, 0xffff0000, v32
    v_and_b32 v67, 0xffff0000, v33
    v_and_b32 v69, 0xffff0000, v34
    v_and_b32 v71, 0xffff0000, v35
    v_sub_f32 v64, v64, v144
    v_sub_f32 v66, v66, v144
    v_sub_f32 v68, v68, v144
    v_sub_f32 v70, v70, v144
    v_sub_f32 v65, v65, v144
    v_sub_f32 v67, v67, v144
    v_sub_f32 v69, v69, v144
    v_sub_f32 v71, v71, v144
    v_cvt_pk_bf16_f32 v65, v64, v65
    v_cvt_pk_bf16_f32 v67, v66, v67
    v_cvt_pk_bf16_f32 v69, v68, v69
    v_cvt_pk_bf16_f32 v71, v70, v71
    v_lshlrev_b32 v64, 16, v65
    v_lshlrev_b32 v66, 16, v67
    v_lshlrev_b32 v68, 16, v69
    v_lshlrev_b32 v70, 16, v71
    v_and_b32 v65, 0xffff0000, v65
    v_and_b32 v67, 0xffff0000, v67
    v_and_b32 v69, 0xffff0000, v69
    v_and_b32 v71, 0xffff0000, v71
    v_mul_f32 v64, v64, v145
    v_mul_f32 v66, v66, v145
    v_mul_f32 v68, v68, v145
    v_mul_f32 v70, v70, v145
    v_mul_f32 v65, v65, v145
    v_mul_f32 v67, v67, v145
    v_mul_f32 v69, v69, v145
    v_mul_f32 v71, v71, v145
    v_cvt_pk_bf16_f32 v48, v64, v65
    v_cvt_pk_bf16_f32 v49, v66, v67
    v_cvt_pk_bf16_f32 v50, v68, v69
    v_cvt_pk_bf16_f32 v51, v70, v71
    ds_write_b128 v236, v[48:51]
    ds_write_b128 v236, v[32:35] offset:4096
    v_fma_f32 v143, -v144, v128, v146
    v_mul_f32 v143, v143, v145
    ds_write_b32 v234, v143
    s_waitcnt lgkmcnt(0)
kc_com:
    s_barrier
    s_cmp_ge_u32 s53, 28
    s_cbranch_scc1 kc_red
    ds_read_b64 v[96:97], v218 offset:0
    ds_read_b64 v[98:99], v218 offset:16
    ds_read_b64 v[100:101], v218 offset:64
    ds_read_b64 v[102:103], v218 offset:80
    ds_read_b64 v[104:105], v218 offset:128
    ds_read_b64 v[106:107], v218 offset:144
    ds_read_b64 v[108:109], v218 offset:192
    ds_read_b64 v[110:111], v218 offset:208
    ds_read_b64 v[112:113], v218 offset:256
    ds_read_b64 v[114:115], v218 offset:272
    ds_read_b64 v[116:117], v218 offset:320
    ds_read_b64 v[118:119], v218 offset:336
    ds_read_b64 v[120:121], v218 offset:384
    ds_read_b64 v[122:123], v218 offset:400
    s_waitcnt lgkmcnt(12)
    ds_read_b64 v[124:125], v218 offset:448
    ds_read_b64 v[126:127], v218 offset:464
    v_mfma_f32_16x16x32_bf16 v[128:131], a[0:3], v[96:99], 0
    v_mfma_f32_16x16x32_bf16 v[132:135], a[32:35], v[96:99], 0
    s_waitcnt lgkmcnt(12)
    v_mfma_f32_16x16x32_bf16 v[128:131], a[4:7], v[100:103], v[128:131]
    v_mfma_f32_16x16x32_bf16 v[132:135], a[36:39], v[100:103], v[132:135]
    s_waitcnt lgkmcnt(10)
    v_mfma_f32_16x16x32_bf16 v[128:131], a[8:11], v[104:107], v[128:131]
    v_mfma_f32_16x16x32_bf16 v[132:135], a[40:43], v[104:107], v[132:135]
    s_waitcnt lgkmcnt(8)
    v_mfma_f32_16x16x32_bf16 v[128:131], a[12:15], v[108:111], v[128:131]
    v_mfma_f32_16x16x32_bf16 v[132:135], a[44:47], v[108:111], v[132:135]
    s_waitcnt lgkmcnt(6)
    v_mfma_f32_16x16x32_bf16 v[128:131], a[16:19], v[112:115], v[128:131]
    v_mfma_f32_16x16x32_bf16 v[132:135], a[48:51], v[112:115], v[132:135]
    s_waitcnt lgkmcnt(4)
    v_mfma_f32_16x16x32_bf16 v[128:131], a[20:23], v[116:119], v[128:131]
    v_mfma_f32_16x16x32_bf16 v[132:135], a[52:55], v[116:119], v[132:135]
    s_waitcnt lgkmcnt(2)
    v_mfma_f32_16x16x32_bf16 v[128:131], a[24:27], v[120:123], v[128:131]
    v_mfma_f32_16x16x32_bf16 v[132:135], a[56:59], v[120:123], v[132:135]
    s_waitcnt lgkmcnt(0)
    v_mfma_f32_16x16x32_bf16 v[128:131], a[28:31], v[124:127], v[128:131]
    v_mfma_f32_16x16x32_bf16 v[132:135], a[60:63], v[124:127], v[132:135]
    s_nop 6
    ds_write_b128 v220, v[128:131]
    ds_write_b128 v220, v[132:135] offset:4096
    s_waitcnt lgkmcnt(0)
    s_barrier
    ds_read_b128 v[32:35], v221 offset:0
    ds_read_b128 v[48:51], v221 offset:4096
    ds_read_b128 v[36:39], v221 offset:1024
    ds_read_b128 v[52:55], v221 offset:5120
    ds_read_b128 v[40:43], v221 offset:2048
    ds_read_b128 v[56:59], v221 offset:6144
    ds_read_b128 v[44:47], v221 offset:3072
    ds_read_b128 v[60:63], v221 offset:7168
    s_waitcnt lgkmcnt(0)
    v_add_f32 v32, v32, v36
    v_add_f32 v33, v33, v37
    v_add_f32 v34, v34, v38
    v_add_f32 v35, v35, v39
    v_add_f32 v40, v40, v44
    v_add_f32 v41, v41, v45
    v_add_f32 v42, v42, v46
    v_add_f32 v43, v43, v47
    v_add_f32 v48, v48, v52
    v_add_f32 v49, v49, v53
    v_add_f32 v50, v50, v54
    v_add_f32 v51, v51, v55
    v_add_f32 v56, v56, v60
    v_add_f32 v57, v57, v61
    v_add_f32 v58, v58, v62
    v_add_f32 v59, v59, v63
    v_add_f32 v32, v32, v40
    v_add_f32 v33, v33, v41
    v_add_f32 v34, v34, v42
    v_add_f32 v35, v35, v43
    v_add_f32 v48, v48, v56
    v_add_f32 v49, v49, v57
    v_add_f32 v50, v50, v58
    v_add_f32 v51, v51, v59
    v_cvt_pk_bf16_f32 v48, v32, v48
    v_cvt_pk_bf16_f32 v49, v33, v49
    v_cvt_pk_bf16_f32 v50, v34, v50
    v_cvt_pk_bf16_f32 v51, v35, v51
    v_lshlrev_b32 v32, 16, v48
    v_lshlrev_b32 v33, 16, v49
    v_lshlrev_b32 v34, 16, v50
    v_lshlrev_b32 v35, 16, v51
    v_and_b32 v48, 0xffff0000, v48
    v_and_b32 v49, 0xffff0000, v49
    v_and_b32 v50, 0xffff0000, v50
    v_and_b32 v51, 0xffff0000, v51
    v_mul_f32 v136, 0xbfb8aa3b, v32
    v_mul_f32 v137, 0xbfb8aa3b, v33
    v_mul_f32 v138, 0xbfb8aa3b, v34
    v_mul_f32 v139, 0xbfb8aa3b, v35
    v_exp_f32 v136, v136
    v_exp_f32 v137, v137
    v_exp_f32 v138, v138
    v_exp_f32 v139, v139
    v_add_f32 v136, 1.0, v136
    v_add_f32 v137, 1.0, v137
    v_add_f32 v138, 1.0, v138
    v_add_f32 v139, 1.0, v139
    v_rcp_f32 v136, v136
    v_rcp_f32 v137, v137
    v_rcp_f32 v138, v138
    v_rcp_f32 v139, v139
    v_mul_f32 v32, v32, v136
    v_mul_f32 v33, v33, v137
    v_mul_f32 v34, v34, v138
    v_mul_f32 v35, v35, v139
    v_cvt_pk_bf16_f32 v32, v32, v32
    v_cvt_pk_bf16_f32 v33, v33, v33
    v_cvt_pk_bf16_f32 v34, v34, v34
    v_cvt_pk_bf16_f32 v35, v35, v35
    v_lshlrev_b32 v32, 16, v32
    v_lshlrev_b32 v33, 16, v33
    v_lshlrev_b32 v34, 16, v34
    v_lshlrev_b32 v35, 16, v35
    v_mul_f32 v32, v32, v48
    v_mul_f32 v33, v33, v49
    v_mul_f32 v34, v34, v50
    v_mul_f32 v35, v35, v51
    v_cvt_pk_bf16_f32 v128, v32, v33
    v_cvt_pk_bf16_f32 v129, v34, v35
    s_nop 1
    v_mfma_f32_16x16x16_bf16 v[64:67], a[64:65], v[128:129], 0
    v_mfma_f32_16x16x16_bf16 v[68:71], a[66:67], v[128:129], 0
    v_mfma_f32_16x16x16_bf16 v[72:75], a[68:69], v[128:129], 0
    v_mfma_f32_16x16x16_bf16 v[76:79], a[70:71], v[128:129], 0
    v_mfma_f32_16x16x16_bf16 v[80:83], a[72:73], v[128:129], 0
    v_mfma_f32_16x16x16_bf16 v[84:87], a[74:75], v[128:129], 0
    v_mfma_f32_16x16x16_bf16 v[88:91], a[76:77], v[128:129], 0
    v_mfma_f32_16x16x16_bf16 v[92:95], a[78:79], v[128:129], 0
    v_mfma_f32_16x16x16_bf16 v[96:99], a[80:81], v[128:129], 0
    ds_write_b128 v222, v[64:67] offset:0
    v_mfma_f32_16x16x16_bf16 v[100:103], a[82:83], v[128:129], 0
    ds_write_b128 v222, v[68:71] offset:64
    v_mfma_f32_16x16x16_bf16 v[104:107], a[84:85], v[128:129], 0
    ds_write_b128 v222, v[72:75] offset:128
    v_mfma_f32_16x16x16_bf16 v[108:111], a[86:87], v[128:129], 0
    ds_write_b128 v222, v[76:79] offset:192
    v_mfma_f32_16x16x16_bf16 v[112:115], a[88:89], v[128:129], 0
    ds_write_b128 v222, v[80:83] offset:256
    v_mfma_f32_16x16x16_bf16 v[116:119], a[90:91], v[128:129], 0
    ds_write_b128 v222, v[84:87] offset:320
    v_mfma_f32_16x16x16_bf16 v[120:123], a[92:93], v[128:129], 0
    ds_write_b128 v222, v[88:91] offset:384
    v_mfma_f32_16x16x16_bf16 v[124:127], a[94:95], v[128:129], 0
    ds_write_b128 v222, v[92:95] offset:448
    s_waitcnt lgkmcnt(4)
    ds_write_b128 v222, v[96:99] offset:512
    ds_write_b128 v222, v[100:103] offset:576
    ds_write_b128 v222, v[104:107] offset:640
    ds_write_b128 v222, v[108:111] offset:704
    ds_write_b128 v222, v[112:115] offset:768
    ds_write_b128 v222, v[116:119] offset:832
    ds_write_b128 v222, v[120:123] offset:896
    ds_write_b128 v222, v[124:127] offset:960
    s_lshl_b32 s32, s54, 13
    s_lshl_b32 s33, s3, 10
    s_add_u32 s32, s32, s33
    s_add_u32 s32, s32, 0x3900000
    s_add_u32 s33, s32, 4096
    s_waitcnt lgkmcnt(0)
    ds_read_b128 v[32:35], v223
    ds_read_b128 v[36:39], v223 offset:1024
    s_waitcnt lgkmcnt(1)
    buffer_store_dwordx4 v[32:35], v228, s[8:11], s32 offen sc1
    s_waitcnt lgkmcnt(0)
    buffer_store_dwordx4 v[36:39], v228, s[8:11], s33 offen sc1
    v_lshlrev_b32 v144, 16, v16
    v_lshlrev_b32 v148, 16, v17
    v_lshlrev_b32 v152, 16, v18
    v_lshlrev_b32 v156, 16, v19
    v_and_b32 v145, 0xffff0000, v16
    v_and_b32 v149, 0xffff0000, v17
    v_and_b32 v153, 0xffff0000, v18
    v_and_b32 v157, 0xffff0000, v19
    v_sub_f32 v144, v144, v0
    v_sub_f32 v148, v148, v0
    v_sub_f32 v152, v152, v0
    v_sub_f32 v156, v156, v0
    v_sub_f32 v145, v145, v0
    v_sub_f32 v149, v149, v0
    v_sub_f32 v153, v153, v0
    v_sub_f32 v157, v157, v0
    v_cvt_pk_bf16_f32 v145, v144, v145
    v_cvt_pk_bf16_f32 v149, v148, v149
    v_cvt_pk_bf16_f32 v153, v152, v153
    v_cvt_pk_bf16_f32 v157, v156, v157
    v_lshlrev_b32 v144, 16, v145
    v_lshlrev_b32 v148, 16, v149
    v_lshlrev_b32 v152, 16, v153
    v_lshlrev_b32 v156, 16, v157
    v_and_b32 v145, 0xffff0000, v145
    v_and_b32 v149, 0xffff0000, v149
    v_and_b32 v153, 0xffff0000, v153
    v_and_b32 v157, 0xffff0000, v157
    v_mul_f32 v144, v144, v4
    v_mul_f32 v148, v148, v4
    v_mul_f32 v152, v152, v4
    v_mul_f32 v156, v156, v4
    v_mul_f32 v145, v145, v4
    v_mul_f32 v149, v149, v4
    v_mul_f32 v153, v153, v4
    v_mul_f32 v157, v157, v4
    v_cvt_pk_bf16_f32 v146, v144, v145
    v_cvt_pk_bf16_f32 v150, v148, v149
    v_cvt_pk_bf16_f32 v154, v152, v153
    v_cvt_pk_bf16_f32 v158, v156, v157
    v_lshlrev_b32 v144, 16, v146
    v_lshlrev_b32 v148, 16, v150
    v_lshlrev_b32 v152, 16, v154
    v_lshlrev_b32 v156, 16, v158
    v_and_b32 v145, 0xffff0000, v146
    v_and_b32 v149, 0xffff0000, v150
    v_and_b32 v153, 0xffff0000, v154
    v_and_b32 v157, 0xffff0000, v158
    v_lshlrev_b32 v146, 16, v16
    v_lshlrev_b32 v150, 16, v17
    v_lshlrev_b32 v154, 16, v18
    v_lshlrev_b32 v158, 16, v19
    v_and_b32 v147, 0xffff0000, v16
    v_and_b32 v151, 0xffff0000, v17
    v_and_b32 v155, 0xffff0000, v18
    v_and_b32 v159, 0xffff0000, v19
    v_pk_add_f32 v[144:145], v[144:145], v[146:147]
    v_pk_add_f32 v[148:149], v[148:149], v[150:151]
    v_pk_add_f32 v[152:153], v[152:153], v[154:155]
    v_pk_add_f32 v[156:157], v[156:157], v[158:159]
    v_cvt_pk_bf16_f32 v16, v144, v145
    v_cvt_pk_bf16_f32 v17, v148, v149
    v_cvt_pk_bf16_f32 v18, v152, v153
    v_cvt_pk_bf16_f32 v19, v156, v157
    v_add_u32 v160, 0, v242
    v_cmp_eq_u32 vcc, v160, v8
    v_cmp_eq_u32 s[60:61], v160, v10
    v_mov_b32 v161, 0x40000000
    s_or_b64 vcc, vcc, s[60:61]
    v_cndmask_b32 v12, v229, v161, vcc
    v_lshlrev_b32 v144, 16, v20
    v_lshlrev_b32 v148, 16, v21
    v_lshlrev_b32 v152, 16, v22
    v_lshlrev_b32 v156, 16, v23
    v_and_b32 v145, 0xffff0000, v20
    v_and_b32 v149, 0xffff0000, v21
    v_and_b32 v153, 0xffff0000, v22
    v_and_b32 v157, 0xffff0000, v23
    v_sub_f32 v144, v144, v1
    v_sub_f32 v148, v148, v1
    v_sub_f32 v152, v152, v1
    v_sub_f32 v156, v156, v1
    v_sub_f32 v145, v145, v1
    v_sub_f32 v149, v149, v1
    v_sub_f32 v153, v153, v1
    v_sub_f32 v157, v157, v1
    v_cvt_pk_bf16_f32 v145, v144, v145
    v_cvt_pk_bf16_f32 v149, v148, v149
    v_cvt_pk_bf16_f32 v153, v152, v153
    v_cvt_pk_bf16_f32 v157, v156, v157
    v_lshlrev_b32 v144, 16, v145
    v_lshlrev_b32 v148, 16, v149
    v_lshlrev_b32 v152, 16, v153
    v_lshlrev_b32 v156, 16, v157
    v_and_b32 v145, 0xffff0000, v145
    v_and_b32 v149, 0xffff0000, v149
    v_and_b32 v153, 0xffff0000, v153
    v_and_b32 v157, 0xffff0000, v157
    v_mul_f32 v144, v144, v5
    v_mul_f32 v148, v148, v5
    v_mul_f32 v152, v152, v5
    v_mul_f32 v156, v156, v5
    v_mul_f32 v145, v145, v5
    v_mul_f32 v149, v149, v5
    v_mul_f32 v153, v153, v5
    v_mul_f32 v157, v157, v5
    v_cvt_pk_bf16_f32 v146, v144, v145
    v_cvt_pk_bf16_f32 v150, v148, v149
    v_cvt_pk_bf16_f32 v154, v152, v153
    v_cvt_pk_bf16_f32 v158, v156, v157
    v_lshlrev_b32 v144, 16, v146
    v_lshlrev_b32 v148, 16, v150
    v_lshlrev_b32 v152, 16, v154
    v_lshlrev_b32 v156, 16, v158
    v_and_b32 v145, 0xffff0000, v146
    v_and_b32 v149, 0xffff0000, v150
    v_and_b32 v153, 0xffff0000, v154
    v_and_b32 v157, 0xffff0000, v158
    v_lshlrev_b32 v146, 16, v20
    v_lshlrev_b32 v150, 16, v21
    v_lshlrev_b32 v154, 16, v22
    v_lshlrev_b32 v158, 16, v23
    v_and_b32 v147, 0xffff0000, v20
    v_and_b32 v151, 0xffff0000, v21
    v_and_b32 v155, 0xffff0000, v22
    v_and_b32 v159, 0xffff0000, v23
    v_pk_add_f32 v[144:145], v[144:145], v[146:147]
    v_pk_add_f32 v[148:149], v[148:149], v[150:151]
    v_pk_add_f32 v[152:153], v[152:153], v[154:155]
    v_pk_add_f32 v[156:157], v[156:157], v[158:159]
    v_cvt_pk_bf16_f32 v20, v144, v145
    v_cvt_pk_bf16_f32 v21, v148, v149
    v_cvt_pk_bf16_f32 v22, v152, v153
    v_cvt_pk_bf16_f32 v23, v156, v157
    v_add_u32 v160, 8, v242
    v_cmp_eq_u32 vcc, v160, v8
    v_cmp_eq_u32 s[60:61], v160, v10
    v_mov_b32 v161, 0x40000000
    s_or_b64 vcc, vcc, s[60:61]
    v_cndmask_b32 v13, v229, v161, vcc
    s_waitcnt vmcnt(0)
    s_barrier
    s_cmp_lg_u32 s3, 0
    s_cbranch_scc1 kc_a2
    s_lshl_b32 s32, s52, 7
    s_add_u32 s32, s32, 0x38a0800
    v_mov_b32 v235, 1
    buffer_atomic_add v235, v243, s[8:11], s32 offen sc0 sc1
    v_lshlrev_b32 v234, 7, v237
    v_cmp_gt_u32 vcc, 8, v237
    v_mov_b32 v236, 0x40000000
    s_mov_b32 s34, 0x38a0c00
    v_cndmask_b32 v234, v236, v234, vcc
    s_waitcnt vmcnt(0)
    v_readfirstlane_b32 s36, v235
    s_cmp_lg_u32 s36, 27
    s_cbranch_scc1 kc_a2
    buffer_atomic_add v233, v234, s[8:11], s34 offen sc1
kc_a2:
    v_lshlrev_b32 v144, 16, v24
    v_lshlrev_b32 v148, 16, v25
    v_lshlrev_b32 v152, 16, v26
    v_lshlrev_b32 v156, 16, v27
    v_and_b32 v145, 0xffff0000, v24
    v_and_b32 v149, 0xffff0000, v25
    v_and_b32 v153, 0xffff0000, v26
    v_and_b32 v157, 0xffff0000, v27
    v_sub_f32 v144, v144, v2
    v_sub_f32 v148, v148, v2
    v_sub_f32 v152, v152, v2
    v_sub_f32 v156, v156, v2
    v_sub_f32 v145, v145, v2
    v_sub_f32 v149, v149, v2
    v_sub_f32 v153, v153, v2
    v_sub_f32 v157, v157, v2
    v_cvt_pk_bf16_f32 v145, v144, v145
    v_cvt_pk_bf16_f32 v149, v148, v149
    v_cvt_pk_bf16_f32 v153, v152, v153
    v_cvt_pk_bf16_f32 v157, v156, v157
    v_lshlrev_b32 v144, 16, v145
    v_lshlrev_b32 v148, 16, v149
    v_lshlrev_b32 v152, 16, v153
    v_lshlrev_b32 v156, 16, v157
    v_and_b32 v145, 0xffff0000, v145
    v_and_b32 v149, 0xffff0000, v149
    v_and_b32 v153, 0xffff0000, v153
    v_and_b32 v157, 0xffff0000, v157
    v_mul_f32 v144, v144, v6
    v_mul_f32 v148, v148, v6
    v_mul_f32 v152, v152, v6
    v_mul_f32 v156, v156, v6
    v_mul_f32 v145, v145, v6
    v_mul_f32 v149, v149, v6
    v_mul_f32 v153, v153, v6
    v_mul_f32 v157, v157, v6
    v_cvt_pk_bf16_f32 v146, v144, v145
    v_cvt_pk_bf16_f32 v150, v148, v149
    v_cvt_pk_bf16_f32 v154, v152, v153
    v_cvt_pk_bf16_f32 v158, v156, v157
    v_lshlrev_b32 v144, 16, v146
    v_lshlrev_b32 v148, 16, v150
    v_lshlrev_b32 v152, 16, v154
    v_lshlrev_b32 v156, 16, v158
    v_and_b32 v145, 0xffff0000, v146
    v_and_b32 v149, 0xffff0000, v150
    v_and_b32 v153, 0xffff0000, v154
    v_and_b32 v157, 0xffff0000, v158
    v_lshlrev_b32 v146, 16, v24
    v_lshlrev_b32 v150, 16, v25
    v_lshlrev_b32 v154, 16, v26
    v_lshlrev_b32 v158, 16, v27
    v_and_b32 v147, 0xffff0000, v24
    v_and_b32 v151, 0xffff0000, v25
    v_and_b32 v155, 0xffff0000, v26
    v_and_b32 v159, 0xffff0000, v27
    v_pk_add_f32 v[144:145], v[144:145], v[146:147]
    v_pk_add_f32 v[148:149], v[148:149], v[150:151]
    v_pk_add_f32 v[152:153], v[152:153], v[154:155]
    v_pk_add_f32 v[156:157], v[156:157], v[158:159]
    v_cvt_pk_bf16_f32 v24, v144, v145
    v_cvt_pk_bf16_f32 v25, v148, v149
    v_cvt_pk_bf16_f32 v26, v152, v153
    v_cvt_pk_bf16_f32 v27, v156, v157
    v_add_u32 v160, 16, v242
    v_cmp_eq_u32 vcc, v160, v8
    v_cmp_eq_u32 s[60:61], v160, v10
    v_mov_b32 v161, 0x40000000
    s_or_b64 vcc, vcc, s[60:61]
    v_cndmask_b32 v14, v229, v161, vcc
    v_lshlrev_b32 v144, 16, v28
    v_lshlrev_b32 v148, 16, v29
    v_lshlrev_b32 v152, 16, v30
    v_lshlrev_b32 v156, 16, v31
    v_and_b32 v145, 0xffff0000, v28
    v_and_b32 v149, 0xffff0000, v29
    v_and_b32 v153, 0xffff0000, v30
    v_and_b32 v157, 0xffff0000, v31
    v_sub_f32 v144, v144, v3
    v_sub_f32 v148, v148, v3
    v_sub_f32 v152, v152, v3
    v_sub_f32 v156, v156, v3
    v_sub_f32 v145, v145, v3
    v_sub_f32 v149, v149, v3
    v_sub_f32 v153, v153, v3
    v_sub_f32 v157, v157, v3
    v_cvt_pk_bf16_f32 v145, v144, v145
    v_cvt_pk_bf16_f32 v149, v148, v149
    v_cvt_pk_bf16_f32 v153, v152, v153
    v_cvt_pk_bf16_f32 v157, v156, v157
    v_lshlrev_b32 v144, 16, v145
    v_lshlrev_b32 v148, 16, v149
    v_lshlrev_b32 v152, 16, v153
    v_lshlrev_b32 v156, 16, v157
    v_and_b32 v145, 0xffff0000, v145
    v_and_b32 v149, 0xffff0000, v149
    v_and_b32 v153, 0xffff0000, v153
    v_and_b32 v157, 0xffff0000, v157
    v_mul_f32 v144, v144, v7
    v_mul_f32 v148, v148, v7
    v_mul_f32 v152, v152, v7
    v_mul_f32 v156, v156, v7
    v_mul_f32 v145, v145, v7
    v_mul_f32 v149, v149, v7
    v_mul_f32 v153, v153, v7
    v_mul_f32 v157, v157, v7
    v_cvt_pk_bf16_f32 v146, v144, v145
    v_cvt_pk_bf16_f32 v150, v148, v149
    v_cvt_pk_bf16_f32 v154, v152, v153
    v_cvt_pk_bf16_f32 v158, v156, v157
    v_lshlrev_b32 v144, 16, v146
    v_lshlrev_b32 v148, 16, v150
    v_lshlrev_b32 v152, 16, v154
    v_lshlrev_b32 v156, 16, v158
    v_and_b32 v145, 0xffff0000, v146
    v_and_b32 v149, 0xffff0000, v150
    v_and_b32 v153, 0xffff0000, v154
    v_and_b32 v157, 0xffff0000, v158
    v_lshlrev_b32 v146, 16, v28
    v_lshlrev_b32 v150, 16, v29
    v_lshlrev_b32 v154, 16, v30
    v_lshlrev_b32 v158, 16, v31
    v_and_b32 v147, 0xffff0000, v28
    v_and_b32 v151, 0xffff0000, v29
    v_and_b32 v155, 0xffff0000, v30
    v_and_b32 v159, 0xffff0000, v31
    v_pk_add_f32 v[144:145], v[144:145], v[146:147]
    v_pk_add_f32 v[148:149], v[148:149], v[150:151]
    v_pk_add_f32 v[152:153], v[152:153], v[154:155]
    v_pk_add_f32 v[156:157], v[156:157], v[158:159]
    v_cvt_pk_bf16_f32 v28, v144, v145
    v_cvt_pk_bf16_f32 v29, v148, v149
    v_cvt_pk_bf16_f32 v30, v152, v153
    v_cvt_pk_bf16_f32 v31, v156, v157
    v_add_u32 v160, 24, v242
    v_cmp_eq_u32 vcc, v160, v8
    v_cmp_eq_u32 s[60:61], v160, v10
    v_mov_b32 v161, 0x40000000
    s_or_b64 vcc, vcc, s[60:61]
    v_cndmask_b32 v15, v229, v161, vcc
    s_mov_b32 s32, 0
    buffer_store_dwordx4 v[16:19], v12, s[28:31], s32 offen nt
    s_mov_b32 s32, 16384
    buffer_store_dwordx4 v[20:23], v13, s[28:31], s32 offen nt
    s_mov_b32 s32, 32768
    buffer_store_dwordx4 v[24:27], v14, s[28:31], s32 offen nt
    s_mov_b32 s32, 49152
    buffer_store_dwordx4 v[28:31], v15, s[28:31], s32 offen nt
    s_branch kc_fin
kc_red:
    v_lshlrev_b32 v144, 16, v16
    v_lshlrev_b32 v148, 16, v17
    v_lshlrev_b32 v152, 16, v18
    v_lshlrev_b32 v156, 16, v19
    v_and_b32 v145, 0xffff0000, v16
    v_and_b32 v149, 0xffff0000, v17
    v_and_b32 v153, 0xffff0000, v18
    v_and_b32 v157, 0xffff0000, v19
    v_sub_f32 v144, v144, v0
    v_sub_f32 v148, v148, v0
    v_sub_f32 v152, v152, v0
    v_sub_f32 v156, v156, v0
    v_sub_f32 v145, v145, v0
    v_sub_f32 v149, v149, v0
    v_sub_f32 v153, v153, v0
    v_sub_f32 v157, v157, v0
    v_cvt_pk_bf16_f32 v145, v144, v145
    v_cvt_pk_bf16_f32 v149, v148, v149
    v_cvt_pk_bf16_f32 v153, v152, v153
    v_cvt_pk_bf16_f32 v157, v156, v157
    v_lshlrev_b32 v144, 16, v145
    v_lshlrev_b32 v148, 16, v149
    v_lshlrev_b32 v152, 16, v153
    v_lshlrev_b32 v156, 16, v157
    v_and_b32 v145, 0xffff0000, v145
    v_and_b32 v149, 0xffff0000, v149
    v_and_b32 v153, 0xffff0000, v153
    v_and_b32 v157, 0xffff0000, v157
    v_mul_f32 v144, v144, v4
    v_mul_f32 v148, v148, v4
    v_mul_f32 v152, v152, v4
    v_mul_f32 v156, v156, v4
    v_mul_f32 v145, v145, v4
    v_mul_f32 v149, v149, v4
    v_mul_f32 v153, v153, v4
    v_mul_f32 v157, v157, v4
    v_cvt_pk_bf16_f32 v146, v144, v145
    v_cvt_pk_bf16_f32 v150, v148, v149
    v_cvt_pk_bf16_f32 v154, v152, v153
    v_cvt_pk_bf16_f32 v158, v156, v157
    v_lshlrev_b32 v144, 16, v146
    v_lshlrev_b32 v148, 16, v150
    v_lshlrev_b32 v152, 16, v154
    v_lshlrev_b32 v156, 16, v158
    v_and_b32 v145, 0xffff0000, v146
    v_and_b32 v149, 0xffff0000, v150
    v_and_b32 v153, 0xffff0000, v154
    v_and_b32 v157, 0xffff0000, v158
    v_lshlrev_b32 v146, 16, v16
    v_lshlrev_b32 v150, 16, v17
    v_lshlrev_b32 v154, 16, v18
    v_lshlrev_b32 v158, 16, v19
    v_and_b32 v147, 0xffff0000, v16
    v_and_b32 v151, 0xffff0000, v17
    v_and_b32 v155, 0xffff0000, v18
    v_and_b32 v159, 0xffff0000, v19
    v_pk_add_f32 v[144:145], v[144:145], v[146:147]
    v_pk_add_f32 v[148:149], v[148:149], v[150:151]
    v_pk_add_f32 v[152:153], v[152:153], v[154:155]
    v_pk_add_f32 v[156:157], v[156:157], v[158:159]
    v_cvt_pk_bf16_f32 v16, v144, v145
    v_cvt_pk_bf16_f32 v17, v148, v149
    v_cvt_pk_bf16_f32 v18, v152, v153
    v_cvt_pk_bf16_f32 v19, v156, v157
    v_add_u32 v160, 0, v242
    v_cmp_eq_u32 vcc, v160, v8
    v_cmp_eq_u32 s[60:61], v160, v10
    v_mov_b32 v161, 0x40000000
    s_or_b64 vcc, vcc, s[60:61]
    v_cndmask_b32 v12, v229, v161, vcc
    v_lshlrev_b32 v144, 16, v20
    v_lshlrev_b32 v148, 16, v21
    v_lshlrev_b32 v152, 16, v22
    v_lshlrev_b32 v156, 16, v23
    v_and_b32 v145, 0xffff0000, v20
    v_and_b32 v149, 0xffff0000, v21
    v_and_b32 v153, 0xffff0000, v22
    v_and_b32 v157, 0xffff0000, v23
    v_sub_f32 v144, v144, v1
    v_sub_f32 v148, v148, v1
    v_sub_f32 v152, v152, v1
    v_sub_f32 v156, v156, v1
    v_sub_f32 v145, v145, v1
    v_sub_f32 v149, v149, v1
    v_sub_f32 v153, v153, v1
    v_sub_f32 v157, v157, v1
    v_cvt_pk_bf16_f32 v145, v144, v145
    v_cvt_pk_bf16_f32 v149, v148, v149
    v_cvt_pk_bf16_f32 v153, v152, v153
    v_cvt_pk_bf16_f32 v157, v156, v157
    v_lshlrev_b32 v144, 16, v145
    v_lshlrev_b32 v148, 16, v149
    v_lshlrev_b32 v152, 16, v153
    v_lshlrev_b32 v156, 16, v157
    v_and_b32 v145, 0xffff0000, v145
    v_and_b32 v149, 0xffff0000, v149
    v_and_b32 v153, 0xffff0000, v153
    v_and_b32 v157, 0xffff0000, v157
    v_mul_f32 v144, v144, v5
    v_mul_f32 v148, v148, v5
    v_mul_f32 v152, v152, v5
    v_mul_f32 v156, v156, v5
    v_mul_f32 v145, v145, v5
    v_mul_f32 v149, v149, v5
    v_mul_f32 v153, v153, v5
    v_mul_f32 v157, v157, v5
    v_cvt_pk_bf16_f32 v146, v144, v145
    v_cvt_pk_bf16_f32 v150, v148, v149
    v_cvt_pk_bf16_f32 v154, v152, v153
    v_cvt_pk_bf16_f32 v158, v156, v157
    v_lshlrev_b32 v144, 16, v146
    v_lshlrev_b32 v148, 16, v150
    v_lshlrev_b32 v152, 16, v154
    v_lshlrev_b32 v156, 16, v158
    v_and_b32 v145, 0xffff0000, v146
    v_and_b32 v149, 0xffff0000, v150
    v_and_b32 v153, 0xffff0000, v154
    v_and_b32 v157, 0xffff0000, v158
    v_lshlrev_b32 v146, 16, v20
    v_lshlrev_b32 v150, 16, v21
    v_lshlrev_b32 v154, 16, v22
    v_lshlrev_b32 v158, 16, v23
    v_and_b32 v147, 0xffff0000, v20
    v_and_b32 v151, 0xffff0000, v21
    v_and_b32 v155, 0xffff0000, v22
    v_and_b32 v159, 0xffff0000, v23
    v_pk_add_f32 v[144:145], v[144:145], v[146:147]
    v_pk_add_f32 v[148:149], v[148:149], v[150:151]
    v_pk_add_f32 v[152:153], v[152:153], v[154:155]
    v_pk_add_f32 v[156:157], v[156:157], v[158:159]
    v_cvt_pk_bf16_f32 v20, v144, v145
    v_cvt_pk_bf16_f32 v21, v148, v149
    v_cvt_pk_bf16_f32 v22, v152, v153
    v_cvt_pk_bf16_f32 v23, v156, v157
    v_add_u32 v160, 8, v242
    v_cmp_eq_u32 vcc, v160, v8
    v_cmp_eq_u32 s[60:61], v160, v10
    v_mov_b32 v161, 0x40000000
    s_or_b64 vcc, vcc, s[60:61]
    v_cndmask_b32 v13, v229, v161, vcc
    v_lshlrev_b32 v144, 16, v24
    v_lshlrev_b32 v148, 16, v25
    v_lshlrev_b32 v152, 16, v26
    v_lshlrev_b32 v156, 16, v27
    v_and_b32 v145, 0xffff0000, v24
    v_and_b32 v149, 0xffff0000, v25
    v_and_b32 v153, 0xffff0000, v26
    v_and_b32 v157, 0xffff0000, v27
    v_sub_f32 v144, v144, v2
    v_sub_f32 v148, v148, v2
    v_sub_f32 v152, v152, v2
    v_sub_f32 v156, v156, v2
    v_sub_f32 v145, v145, v2
    v_sub_f32 v149, v149, v2
    v_sub_f32 v153, v153, v2
    v_sub_f32 v157, v157, v2
    v_cvt_pk_bf16_f32 v145, v144, v145
    v_cvt_pk_bf16_f32 v149, v148, v149
    v_cvt_pk_bf16_f32 v153, v152, v153
    v_cvt_pk_bf16_f32 v157, v156, v157
    v_lshlrev_b32 v144, 16, v145
    v_lshlrev_b32 v148, 16, v149
    v_lshlrev_b32 v152, 16, v153
    v_lshlrev_b32 v156, 16, v157
    v_and_b32 v145, 0xffff0000, v145
    v_and_b32 v149, 0xffff0000, v149
    v_and_b32 v153, 0xffff0000, v153
    v_and_b32 v157, 0xffff0000, v157
    v_mul_f32 v144, v144, v6
    v_mul_f32 v148, v148, v6
    v_mul_f32 v152, v152, v6
    v_mul_f32 v156, v156, v6
    v_mul_f32 v145, v145, v6
    v_mul_f32 v149, v149, v6
    v_mul_f32 v153, v153, v6
    v_mul_f32 v157, v157, v6
    v_cvt_pk_bf16_f32 v146, v144, v145
    v_cvt_pk_bf16_f32 v150, v148, v149
    v_cvt_pk_bf16_f32 v154, v152, v153
    v_cvt_pk_bf16_f32 v158, v156, v157
    v_lshlrev_b32 v144, 16, v146
    v_lshlrev_b32 v148, 16, v150
    v_lshlrev_b32 v152, 16, v154
    v_lshlrev_b32 v156, 16, v158
    v_and_b32 v145, 0xffff0000, v146
    v_and_b32 v149, 0xffff0000, v150
    v_and_b32 v153, 0xffff0000, v154
    v_and_b32 v157, 0xffff0000, v158
    v_lshlrev_b32 v146, 16, v24
    v_lshlrev_b32 v150, 16, v25
    v_lshlrev_b32 v154, 16, v26
    v_lshlrev_b32 v158, 16, v27
    v_and_b32 v147, 0xffff0000, v24
    v_and_b32 v151, 0xffff0000, v25
    v_and_b32 v155, 0xffff0000, v26
    v_and_b32 v159, 0xffff0000, v27
    v_pk_add_f32 v[144:145], v[144:145], v[146:147]
    v_pk_add_f32 v[148:149], v[148:149], v[150:151]
    v_pk_add_f32 v[152:153], v[152:153], v[154:155]
    v_pk_add_f32 v[156:157], v[156:157], v[158:159]
    v_cvt_pk_bf16_f32 v24, v144, v145
    v_cvt_pk_bf16_f32 v25, v148, v149
    v_cvt_pk_bf16_f32 v26, v152, v153
    v_cvt_pk_bf16_f32 v27, v156, v157
    v_add_u32 v160, 16, v242
    v_cmp_eq_u32 vcc, v160, v8
    v_cmp_eq_u32 s[60:61], v160, v10
    v_mov_b32 v161, 0x40000000
    s_or_b64 vcc, vcc, s[60:61]
    v_cndmask_b32 v14, v229, v161, vcc
    v_lshlrev_b32 v144, 16, v28
    v_lshlrev_b32 v148, 16, v29
    v_lshlrev_b32 v152, 16, v30
    v_lshlrev_b32 v156, 16, v31
    v_and_b32 v145, 0xffff0000, v28
    v_and_b32 v149, 0xffff0000, v29
    v_and_b32 v153, 0xffff0000, v30
    v_and_b32 v157, 0xffff0000, v31
    v_sub_f32 v144, v144, v3
    v_sub_f32 v148, v148, v3
    v_sub_f32 v152, v152, v3
    v_sub_f32 v156, v156, v3
    v_sub_f32 v145, v145, v3
    v_sub_f32 v149, v149, v3
    v_sub_f32 v153, v153, v3
    v_sub_f32 v157, v157, v3
    v_cvt_pk_bf16_f32 v145, v144, v145
    v_cvt_pk_bf16_f32 v149, v148, v149
    v_cvt_pk_bf16_f32 v153, v152, v153
    v_cvt_pk_bf16_f32 v157, v156, v157
    v_lshlrev_b32 v144, 16, v145
    v_lshlrev_b32 v148, 16, v149
    v_lshlrev_b32 v152, 16, v153
    v_lshlrev_b32 v156, 16, v157
    v_and_b32 v145, 0xffff0000, v145
    v_and_b32 v149, 0xffff0000, v149
    v_and_b32 v153, 0xffff0000, v153
    v_and_b32 v157, 0xffff0000, v157
    v_mul_f32 v144, v144, v7
    v_mul_f32 v148, v148, v7
    v_mul_f32 v152, v152, v7
    v_mul_f32 v156, v156, v7
    v_mul_f32 v145, v145, v7
    v_mul_f32 v149, v149, v7
    v_mul_f32 v153, v153, v7
    v_mul_f32 v157, v157, v7
    v_cvt_pk_bf16_f32 v146, v144, v145
    v_cvt_pk_bf16_f32 v150, v148, v149
    v_cvt_pk_bf16_f32 v154, v152, v153
    v_cvt_pk_bf16_f32 v158, v156, v157
    v_lshlrev_b32 v144, 16, v146
    v_lshlrev_b32 v148, 16, v150
    v_lshlrev_b32 v152, 16, v154
    v_lshlrev_b32 v156, 16, v158
    v_and_b32 v145, 0xffff0000, v146
    v_and_b32 v149, 0xffff0000, v150
    v_and_b32 v153, 0xffff0000, v154
    v_and_b32 v157, 0xffff0000, v158
    v_lshlrev_b32 v146, 16, v28
    v_lshlrev_b32 v150, 16, v29
    v_lshlrev_b32 v154, 16, v30
    v_lshlrev_b32 v158, 16, v31
    v_and_b32 v147, 0xffff0000, v28
    v_and_b32 v151, 0xffff0000, v29
    v_and_b32 v155, 0xffff0000, v30
    v_and_b32 v159, 0xffff0000, v31
    v_pk_add_f32 v[144:145], v[144:145], v[146:147]
    v_pk_add_f32 v[148:149], v[148:149], v[150:151]
    v_pk_add_f32 v[152:153], v[152:153], v[154:155]
    v_pk_add_f32 v[156:157], v[156:157], v[158:159]
    v_cvt_pk_bf16_f32 v28, v144, v145
    v_cvt_pk_bf16_f32 v29, v148, v149
    v_cvt_pk_bf16_f32 v30, v152, v153
    v_cvt_pk_bf16_f32 v31, v156, v157
    v_add_u32 v160, 24, v242
    v_cmp_eq_u32 vcc, v160, v8
    v_cmp_eq_u32 s[60:61], v160, v10
    v_mov_b32 v161, 0x40000000
    s_or_b64 vcc, vcc, s[60:61]
    v_cndmask_b32 v15, v229, v161, vcc
    s_mov_b32 s32, 0
    buffer_store_dwordx4 v[16:19], v12, s[28:31], s32 offen nt
    s_mov_b32 s32, 16384
    buffer_store_dwordx4 v[20:23], v13, s[28:31], s32 offen nt
    s_mov_b32 s32, 32768
    buffer_store_dwordx4 v[24:27], v14, s[28:31], s32 offen nt
    s_mov_b32 s32, 49152
    buffer_store_dwordx4 v[28:31], v15, s[28:31], s32 offen nt
    s_sub_u32 s54, s2, 224
    v_lshrrev_b32 v234, 4, v230
    v_lshlrev_b32 v234, 13, v234
    v_and_b32 v235, 15, v237
    v_lshl_add_u32 v217, v235, 4, v234
    s_lshl_b32 s35, s54, 8
    s_add_u32 s35, s35, 0x3900000
    v_bfe_u32 v234, v237, 4, 1
    v_lshrrev_b32 v236, 5, v237
    v_lshl_add_u32 v234, v234, 1, v236
    v_lshl_add_u32 v234, v235, 2, v234
    s_lshl_b32 s32, s54, 6
    v_add_u32 v234, s32, v234
    v_lshlrev_b32 v218, 1, v234
    v_add_u32 v234, 98304, v218
    ds_read_u16 v100, v234
    ds_read_u16 v101, v234 offset:4096
    s_cmp_lt_u32 s54, 16
    s_cselect_b64 vcc, -1, 0
    v_cndmask_b32 v102, v10, v8, vcc
    s_cselect_b32 s32, 0, 4
    s_add_u32 s32, s32, 106496
    v_mov_b32 v234, s32
    ds_read_b32 v103, v234
    s_waitcnt lgkmcnt(0)
    v_cvt_pk_bf16_f32 v103, v103, v103
    v_lshlrev_b32 v103, 16, v103
    v_mul_f32 v103, 0xbfb8aa3b, v103
    v_exp_f32 v103, v103
    s_nop 0
    v_add_f32 v103, 1.0, v103
    v_rcp_f32 v103, v103
    s_nop 0
    v_cvt_pk_bf16_f32 v103, v103, v103
    v_lshlrev_b32 v103, 16, v103
    v_and_b32 v218, 2047, v218
    v_lshl_add_u32 v218, v102, 11, v218
    v_lshlrev_b32 v220, 2, v230
    v_add_u32 v220, 106752, v220
    v_lshlrev_b32 v221, 2, v237
    v_add_u32 v221, 106752, v221
    s_cmp_lg_u32 s3, 0
    s_cbranch_scc1 kc_b22
    s_lshl_b32 s32, s52, 7
    s_add_u32 s32, s32, 0x38a0c00
    s_mov_b32 s34, 0x400000
    s_branch kc_b21
kc_b20:
    s_sleep 2
kc_b21:
    buffer_load_dword v235, off, s[8:11], s32 sc1
    s_waitcnt vmcnt(0)
    v_cmp_ne_u32 vcc, 8, v235
    s_sub_u32 s34, s34, 1
    s_cbranch_scc1 kc_b22
    s_cbranch_vccnz kc_b20
kc_b22:
    s_barrier
    s_add_u32 s32, s35, 0
    buffer_load_dwordx4 v[32:35], v217, s[8:11], s32 offen sc1
    s_add_u32 s32, s35, 131072
    buffer_load_dwordx4 v[36:39], v217, s[8:11], s32 offen sc1
    s_add_u32 s32, s35, 262144
    buffer_load_dwordx4 v[40:43], v217, s[8:11], s32 offen sc1
    s_add_u32 s32, s35, 393216
    buffer_load_dwordx4 v[44:47], v217, s[8:11], s32 offen sc1
    s_add_u32 s32, s35, 524288
    buffer_load_dwordx4 v[48:51], v217, s[8:11], s32 offen sc1
    s_add_u32 s32, s35, 655360
    buffer_load_dwordx4 v[52:55], v217, s[8:11], s32 offen sc1
    s_add_u32 s32, s35, 786432
    buffer_load_dwordx4 v[56:59], v217, s[8:11], s32 offen sc1
    s_add_u32 s32, s35, 917504
    buffer_load_dwordx4 v[60:63], v217, s[8:11], s32 offen sc1
    s_add_u32 s32, s35, 1048576
    buffer_load_dwordx4 v[64:67], v217, s[8:11], s32 offen sc1
    s_add_u32 s32, s35, 1179648
    buffer_load_dwordx4 v[68:71], v217, s[8:11], s32 offen sc1
    s_add_u32 s32, s35, 1310720
    buffer_load_dwordx4 v[72:75], v217, s[8:11], s32 offen sc1
    s_add_u32 s32, s35, 1441792
    buffer_load_dwordx4 v[76:79], v217, s[8:11], s32 offen sc1
    s_add_u32 s32, s35, 1572864
    buffer_load_dwordx4 v[80:83], v217, s[8:11], s32 offen sc1
    s_add_u32 s32, s35, 1703936
    buffer_load_dwordx4 v[84:87], v217, s[8:11], s32 offen sc1
    s_waitcnt vmcnt(12)
    v_pk_add_f32 v[32:33], v[32:33], v[36:37]
    v_pk_add_f32 v[34:35], v[34:35], v[38:39]
    s_waitcnt vmcnt(11)
    v_pk_add_f32 v[32:33], v[32:33], v[40:41]
    v_pk_add_f32 v[34:35], v[34:35], v[42:43]
    s_waitcnt vmcnt(10)
    v_pk_add_f32 v[32:33], v[32:33], v[44:45]
    v_pk_add_f32 v[34:35], v[34:35], v[46:47]
    s_waitcnt vmcnt(9)
    v_pk_add_f32 v[32:33], v[32:33], v[48:49]
    v_pk_add_f32 v[34:35], v[34:35], v[50:51]
    s_waitcnt vmcnt(8)
    v_pk_add_f32 v[32:33], v[32:33], v[52:53]
    v_pk_add_f32 v[34:35], v[34:35], v[54:55]
    s_waitcnt vmcnt(7)
    v_pk_add_f32 v[32:33], v[32:33], v[56:57]
    v_pk_add_f32 v[34:35], v[34:35], v[58:59]
    s_waitcnt vmcnt(6)
    v_pk_add_f32 v[32:33], v[32:33], v[60:61]
    v_pk_add_f32 v[34:35], v[34:35], v[62:63]
    s_waitcnt vmcnt(5)
    v_pk_add_f32 v[32:33], v[32:33], v[64:65]
    v_pk_add_f32 v[34:35], v[34:35], v[66:67]
    s_waitcnt vmcnt(4)
    v_pk_add_f32 v[32:33], v[32:33], v[68:69]
    v_pk_add_f32 v[34:35], v[34:35], v[70:71]
    s_waitcnt vmcnt(3)
    v_pk_add_f32 v[32:33], v[32:33], v[72:73]
    v_pk_add_f32 v[34:35], v[34:35], v[74:75]
    s_waitcnt vmcnt(2)
    v_pk_add_f32 v[32:33], v[32:33], v[76:77]
    v_pk_add_f32 v[34:35], v[34:35], v[78:79]
    s_waitcnt vmcnt(1)
    v_pk_add_f32 v[32:33], v[32:33], v[80:81]
    v_pk_add_f32 v[34:35], v[34:35], v[82:83]
    s_waitcnt vmcnt(0)
    v_pk_add_f32 v[32:33], v[32:33], v[84:85]
    v_pk_add_f32 v[34:35], v[34:35], v[86:87]
    s_nop 1
    v_permlane32_swap_b32 v32, v33
    v_permlane32_swap_b32 v34, v35
    s_nop 0
    v_add_f32 v32, v32, v33
    v_add_f32 v34, v34, v35
    s_nop 1
    v_permlane16_swap_b32 v32, v34
    s_nop 0
    v_add_f32 v32, v32, v34
    ds_write_b32 v220, v32
    s_waitcnt lgkmcnt(0)
    s_barrier
    s_cmp_lg_u32 s3, 0
    s_cbranch_scc1 kc_fin
    ds_read_b32 v32, v221
    ds_read_b32 v33, v221 offset:256
    ds_read_b32 v34, v221 offset:512
    ds_read_b32 v35, v221 offset:768
    v_lshlrev_b32 v100, 16, v100
    v_lshlrev_b32 v101, 16, v101
    s_waitcnt lgkmcnt(0)
    v_add_f32 v32, v32, v33
    v_add_f32 v34, v34, v35
    v_add_f32 v32, v32, v34
    v_cvt_pk_bf16_f32 v32, v32, v32
    v_lshlrev_b32 v32, 16, v32
    v_mul_f32 v32, v32, v103
    v_cvt_pk_bf16_f32 v32, v32, v32
    v_lshlrev_b32 v32, 16, v32
    v_add_f32 v32, v32, v100
    v_cvt_pk_bf16_f32 v32, v32, v32
    v_lshlrev_b32 v32, 16, v32
    v_add_f32 v32, v32, v101
    v_cvt_pk_bf16_f32 v32, v32, v32
    buffer_store_short v32, v218, s[28:31], 0 offen
kc_fin:
    s_endpgm
kc_r3:
    s_mov_b32 s34, 0x400000
kc_r3l:
    s_sleep 4
    buffer_load_dwordx4 v[176:179], v228, s[8:11], s7 offen offset:0 sc1
    buffer_load_dwordx4 v[180:183], v228, s[8:11], s7 offen offset:1024 sc1
    buffer_load_dwordx4 v[184:187], v228, s[8:11], s7 offen offset:2048 sc1
    buffer_load_dwordx4 v[188:191], v228, s[8:11], s7 offen offset:3072 sc1
    s_waitcnt vmcnt(0)
    v_max3_u32 v235, v176, v177, v178
    v_max3_u32 v235, v235, v179, v180
    v_max3_u32 v235, v235, v181, v182
    v_max3_u32 v235, v235, v183, v184
    v_max3_u32 v235, v235, v185, v186
    v_max3_u32 v235, v235, v187, v188
    v_max3_u32 v235, v235, v189, v190
    v_max_u32 v235, v235, v191
    v_cmp_eq_u32 vcc, -1, v235
    s_sub_u32 s34, s34, 1
    s_cbranch_scc1 kc_r3o
    s_cbranch_vccnz kc_r3l
    s_branch kc_r3o
kc_r1:
    s_mov_b32 s34, 0x400000
kc_r1l:
    s_sleep 4
    buffer_load_dwordx4 v[96:99], v228, s[8:11], s37 offen offset:0 sc1
    buffer_load_dwordx4 v[100:103], v228, s[8:11], s37 offen offset:1024 sc1
    buffer_load_dwordx4 v[104:107], v228, s[8:11], s37 offen offset:2048 sc1
    buffer_load_dwordx4 v[108:111], v228, s[8:11], s37 offen offset:3072 sc1
    s_waitcnt vmcnt(0)
    v_max3_u32 v235, v96, v97, v98
    v_max3_u32 v235, v235, v99, v100
    v_max3_u32 v235, v235, v101, v102
    v_max3_u32 v235, v235, v103, v104
    v_max3_u32 v235, v235, v105, v106
    v_max3_u32 v235, v235, v107, v108
    v_max3_u32 v235, v235, v109, v110
    v_max_u32 v235, v235, v111
    v_cmp_eq_u32 vcc, -1, v235
    s_sub_u32 s34, s34, 1
    s_cbranch_scc1 kc_r1o
    s_cbranch_vccnz kc_r1l
    s_branch kc_r1o
kc_r2:
    s_mov_b32 s34, 0x400000
kc_r2l:
    s_sleep 4
    buffer_load_dwordx4 v[160:163], v228, s[8:11], s38 offen offset:0 sc1
    buffer_load_dwordx4 v[164:167], v228, s[8:11], s38 offen offset:1024 sc1
    buffer_load_dwordx4 v[168:171], v228, s[8:11], s38 offen offset:2048 sc1
    buffer_load_dwordx4 v[172:175], v228, s[8:11], s38 offen offset:3072 sc1
    s_waitcnt vmcnt(0)
    v_max3_u32 v235, v160, v161, v162
    v_max3_u32 v235, v235, v163, v164
    v_max3_u32 v235, v235, v165, v166
    v_max3_u32 v235, v235, v167, v168
    v_max3_u32 v235, v235, v169, v170
    v_max3_u32 v235, v235, v171, v172
    v_max3_u32 v235, v235, v173, v174
    v_max_u32 v235, v235, v175
    v_cmp_eq_u32 vcc, -1, v235
    s_sub_u32 s34, s34, 1
    s_cbranch_scc1 kc_r2o
    s_cbranch_vccnz kc_r2l
    s_branch kc_r2o
kc_g:
    s_mov_b32 s34, 0x400000
    s_branch kc_gs1
kc_gs0:
    s_sleep 2
kc_gs1:
    buffer_load_dword v235, off, s[8:11], s45 sc1
    s_waitcnt vmcnt(0)
    v_cmp_ne_u32 vcc, 8, v235
    s_sub_u32 s34, s34, 1
    s_cbranch_scc1 kc_gs2
    s_cbranch_vccnz kc_gs0
kc_gs2:
    s_branch kc_gr
kc_end:
ka_done:
    s_endpgm
kf_fix1:
    s_cmp_eq_u32 s33, 0
    s_cselect_b32 s24, 0, 0x74000000
    s_cselect_b32 s36, 0, 0x1000
    s_mov_b32 s33, 1
    v_subrev_f32 v230, s24, v243
    v_add_f32 v231, 0, v230
    v_min_f32 v64, v224, v231
    v_add_f32 v232, 0xf1800000, v230
    v_min_f32 v65, v224, v232
    v_add_f32 v231, 0xf2000000, v230
    v_min_f32 v66, v224, v231
    v_add_f32 v232, 0xf2400000, v230
    v_min_f32 v67, v224, v232
    v_add_f32 v231, 0xf3000000, v230
    v_min_f32 v68, v224, v231
    v_add_f32 v232, 0xf3100000, v230
    v_min_f32 v69, v224, v232
    v_add_f32 v231, 0xf3200000, v230
    v_min_f32 v70, v224, v231
    v_add_f32 v232, 0xf3300000, v230
    v_min_f32 v71, v224, v232
    v_add_f32 v231, 0x73800000, v230
    v_min_f32 v72, v225, v231
    v_add_f32 v232, 0x73700000, v230
    v_min_f32 v73, v225, v232
    v_add_f32 v231, 0x73600000, v230
    v_min_f32 v74, v225, v231
    v_add_f32 v232, 0x73500000, v230
    v_min_f32 v75, v225, v232
    v_add_f32 v231, 0x73000000, v230
    v_min_f32 v76, v225, v231
    v_add_f32 v232, 0x72e00000, v230
    v_min_f32 v77, v225, v232
    v_add_f32 v231, 0x72c00000, v230
    v_min_f32 v78, v225, v231
    v_add_f32 v232, 0x72a00000, v230
    v_min_f32 v79, v225, v232
    s_nop 1
    s_branch kf_fixr2
kf_fix3:
    s_cmp_eq_u32 s33, 0
    s_cselect_b32 s24, 0, 0x74000000
    s_cselect_b32 s36, 0, 0x1000
    s_mov_b32 s33, 1
    v_subrev_f32 v230, s24, v243
    v_add_f32 v231, 0, v230
    v_min_f32 v64, v224, v231
    v_add_f32 v232, 0xf1800000, v230
    v_min_f32 v65, v224, v232
    v_add_f32 v231, 0xf2000000, v230
    v_min_f32 v66, v224, v231
    v_add_f32 v232, 0xf2400000, v230
    v_min_f32 v67, v224, v232
    v_add_f32 v231, 0xf3000000, v230
    v_min_f32 v68, v224, v231
    v_add_f32 v232, 0xf3100000, v230
    v_min_f32 v69, v224, v232
    v_add_f32 v231, 0xf3200000, v230
    v_min_f32 v70, v224, v231
    v_add_f32 v232, 0xf3300000, v230
    v_min_f32 v71, v224, v232
    v_add_f32 v231, 0x73800000, v230
    v_min_f32 v72, v225, v231
    v_add_f32 v232, 0x73700000, v230
    v_min_f32 v73, v225, v232
    v_add_f32 v231, 0x73600000, v230
    v_min_f32 v74, v225, v231
    v_add_f32 v232, 0x73500000, v230
    v_min_f32 v75, v225, v232
    v_add_f32 v231, 0x73000000, v230
    v_min_f32 v76, v225, v231
    v_add_f32 v232, 0x72e00000, v230
    v_min_f32 v77, v225, v232
    v_add_f32 v231, 0x72c00000, v230
    v_min_f32 v78, v225, v231
    v_add_f32 v232, 0x72a00000, v230
    v_min_f32 v79, v225, v232
    s_nop 1
    s_branch kf_fixr4
kf_rare6:
    s_nop 15
    v_max3_f32 v230, v32, v33, v34
    v_max3_f32 v230, v230, v35, v36
    v_max3_f32 v230, v230, v37, v38
    v_max_f32 v230, v230, v39
    v_mov_b32 v231, v230
    s_nop 1
    v_permlane16_swap_b32 v230, v231
    s_nop 0
    v_max_f32 v230, v230, v231
    v_mov_b32 v231, v230
    s_nop 1
    v_permlane32_swap_b32 v230, v231
    s_nop 0
    v_max_f32 v230, v230, v231
    v_add_f32 v230, 0x41800000, v230
    v_max_f32 v230, 0, v230
    v_sub_f32 v232, 0, v230
    v_exp_f32 v232, v232
    v_sub_f32 v224, v224, v230
    v_sub_f32 v64, v64, v230
    v_sub_f32 v0, v0, v230
    v_sub_f32 v32, v32, v230
    v_sub_f32 v65, v65, v230
    v_sub_f32 v1, v1, v230
    v_sub_f32 v33, v33, v230
    v_sub_f32 v66, v66, v230
    v_sub_f32 v2, v2, v230
    v_sub_f32 v34, v34, v230
    v_sub_f32 v67, v67, v230
    v_sub_f32 v3, v3, v230
    v_sub_f32 v35, v35, v230
    v_sub_f32 v68, v68, v230
    v_sub_f32 v4, v4, v230
    v_sub_f32 v36, v36, v230
    v_sub_f32 v69, v69, v230
    v_sub_f32 v5, v5, v230
    v_sub_f32 v37, v37, v230
    v_sub_f32 v70, v70, v230
    v_sub_f32 v6, v6, v230
    v_sub_f32 v38, v38, v230
    v_sub_f32 v71, v71, v230
    v_sub_f32 v7, v7, v230
    v_sub_f32 v39, v39, v230
    v_mul_f32 v144, v144, v232
    v_mul_f32 v145, v145, v232
    v_mul_f32 v146, v146, v232
    v_mul_f32 v147, v147, v232
    v_accvgpr_read_b32 v233, a0
    v_mul_f32 v233, v233, v232
    v_accvgpr_write_b32 a0, v233
    v_accvgpr_read_b32 v234, a1
    v_mul_f32 v234, v234, v232
    v_accvgpr_write_b32 a1, v234
    v_accvgpr_read_b32 v235, a2
    v_mul_f32 v235, v235, v232
    v_accvgpr_write_b32 a2, v235
    v_accvgpr_read_b32 v236, a3
    v_mul_f32 v236, v236, v232
    v_accvgpr_write_b32 a3, v236
    v_accvgpr_read_b32 v233, a4
    v_mul_f32 v233, v233, v232
    v_accvgpr_write_b32 a4, v233
    v_accvgpr_read_b32 v234, a5
    v_mul_f32 v234, v234, v232
    v_accvgpr_write_b32 a5, v234
    v_accvgpr_read_b32 v235, a6
    v_mul_f32 v235, v235, v232
    v_accvgpr_write_b32 a6, v235
    v_accvgpr_read_b32 v236, a7
    v_mul_f32 v236, v236, v232
    v_accvgpr_write_b32 a7, v236
    v_accvgpr_read_b32 v233, a8
    v_mul_f32 v233, v233, v232
    v_accvgpr_write_b32 a8, v233
    v_accvgpr_read_b32 v234, a9
    v_mul_f32 v234, v234, v232
    v_accvgpr_write_b32 a9, v234
    v_accvgpr_read_b32 v235, a10
    v_mul_f32 v235, v235, v232
    v_accvgpr_write_b32 a10, v235
    v_accvgpr_read_b32 v236, a11
    v_mul_f32 v236, v236, v232
    v_accvgpr_write_b32 a11, v236
    v_accvgpr_read_b32 v233, a12
    v_mul_f32 v233, v233, v232
    v_accvgpr_write_b32 a12, v233
    v_accvgpr_read_b32 v234, a13
    v_mul_f32 v234, v234, v232
    v_accvgpr_write_b32 a13, v234
    v_accvgpr_read_b32 v235, a14
    v_mul_f32 v235, v235, v232
    v_accvgpr_write_b32 a14, v235
    v_accvgpr_read_b32 v236, a15
    v_mul_f32 v236, v236, v232
    v_accvgpr_write_b32 a15, v236
    v_accvgpr_read_b32 v233, a16
    v_mul_f32 v233, v233, v232
    v_accvgpr_write_b32 a16, v233
    v_accvgpr_read_b32 v234, a17
    v_mul_f32 v234, v234, v232
    v_accvgpr_write_b32 a17, v234
    v_accvgpr_read_b32 v235, a18
    v_mul_f32 v235, v235, v232
    v_accvgpr_write_b32 a18, v235
    v_accvgpr_read_b32 v236, a19
    v_mul_f32 v236, v236, v232
    v_accvgpr_write_b32 a19, v236
    v_accvgpr_read_b32 v233, a20
    v_mul_f32 v233, v233, v232
    v_accvgpr_write_b32 a20, v233
    v_accvgpr_read_b32 v234, a21
    v_mul_f32 v234, v234, v232
    v_accvgpr_write_b32 a21, v234
    v_accvgpr_read_b32 v235, a22
    v_mul_f32 v235, v235, v232
    v_accvgpr_write_b32 a22, v235
    v_accvgpr_read_b32 v236, a23
    v_mul_f32 v236, v236, v232
    v_accvgpr_write_b32 a23, v236
    v_accvgpr_read_b32 v233, a24
    v_mul_f32 v233, v233, v232
    v_accvgpr_write_b32 a24, v233
    v_accvgpr_read_b32 v234, a25
    v_mul_f32 v234, v234, v232
    v_accvgpr_write_b32 a25, v234
    v_accvgpr_read_b32 v235, a26
    v_mul_f32 v235, v235, v232
    v_accvgpr_write_b32 a26, v235
    v_accvgpr_read_b32 v236, a27
    v_mul_f32 v236, v236, v232
    v_accvgpr_write_b32 a27, v236
    v_accvgpr_read_b32 v233, a28
    v_mul_f32 v233, v233, v232
    v_accvgpr_write_b32 a28, v233
    v_accvgpr_read_b32 v234, a29
    v_mul_f32 v234, v234, v232
    v_accvgpr_write_b32 a29, v234
    v_accvgpr_read_b32 v235, a30
    v_mul_f32 v235, v235, v232
    v_accvgpr_write_b32 a30, v235
    v_accvgpr_read_b32 v236, a31
    v_mul_f32 v236, v236, v232
    v_accvgpr_write_b32 a31, v236
    v_exp_f32 v128, v32
    v_exp_f32 v129, v33
    v_exp_f32 v130, v34
    v_exp_f32 v131, v35
    v_exp_f32 v132, v36
    v_exp_f32 v133, v37
    v_exp_f32 v134, v38
    v_exp_f32 v135, v39
    s_nop 0
    v_cvt_pk_bf16_f32 v112, v128, v129
    v_cvt_pk_bf16_f32 v113, v130, v131
    v_cvt_pk_bf16_f32 v114, v132, v133
    v_cvt_pk_bf16_f32 v115, v134, v135
    v_max3_f32 v230, v40, v41, v42
    v_max3_f32 v230, v230, v43, v44
    v_max3_f32 v230, v230, v45, v46
    v_max_f32 v230, v230, v47
    v_mov_b32 v231, v230
    s_nop 1
    v_permlane16_swap_b32 v230, v231
    s_nop 0
    v_max_f32 v230, v230, v231
    v_mov_b32 v231, v230
    s_nop 1
    v_permlane32_swap_b32 v230, v231
    s_nop 0
    v_max_f32 v230, v230, v231
    v_add_f32 v230, 0x41800000, v230
    v_max_f32 v230, 0, v230
    v_sub_f32 v232, 0, v230
    v_exp_f32 v232, v232
    v_sub_f32 v225, v225, v230
    v_sub_f32 v72, v72, v230
    v_sub_f32 v8, v8, v230
    v_sub_f32 v40, v40, v230
    v_sub_f32 v73, v73, v230
    v_sub_f32 v9, v9, v230
    v_sub_f32 v41, v41, v230
    v_sub_f32 v74, v74, v230
    v_sub_f32 v10, v10, v230
    v_sub_f32 v42, v42, v230
    v_sub_f32 v75, v75, v230
    v_sub_f32 v11, v11, v230
    v_sub_f32 v43, v43, v230
    v_sub_f32 v76, v76, v230
    v_sub_f32 v12, v12, v230
    v_sub_f32 v44, v44, v230
    v_sub_f32 v77, v77, v230
    v_sub_f32 v13, v13, v230
    v_sub_f32 v45, v45, v230
    v_sub_f32 v78, v78, v230
    v_sub_f32 v14, v14, v230
    v_sub_f32 v46, v46, v230
    v_sub_f32 v79, v79, v230
    v_sub_f32 v15, v15, v230
    v_sub_f32 v47, v47, v230
    v_mul_f32 v148, v148, v232
    v_mul_f32 v149, v149, v232
    v_mul_f32 v150, v150, v232
    v_mul_f32 v151, v151, v232
    v_accvgpr_read_b32 v233, a32
    v_mul_f32 v233, v233, v232
    v_accvgpr_write_b32 a32, v233
    v_accvgpr_read_b32 v234, a33
    v_mul_f32 v234, v234, v232
    v_accvgpr_write_b32 a33, v234
    v_accvgpr_read_b32 v235, a34
    v_mul_f32 v235, v235, v232
    v_accvgpr_write_b32 a34, v235
    v_accvgpr_read_b32 v236, a35
    v_mul_f32 v236, v236, v232
    v_accvgpr_write_b32 a35, v236
    v_accvgpr_read_b32 v233, a36
    v_mul_f32 v233, v233, v232
    v_accvgpr_write_b32 a36, v233
    v_accvgpr_read_b32 v234, a37
    v_mul_f32 v234, v234, v232
    v_accvgpr_write_b32 a37, v234
    v_accvgpr_read_b32 v235, a38
    v_mul_f32 v235, v235, v232
    v_accvgpr_write_b32 a38, v235
    v_accvgpr_read_b32 v236, a39
    v_mul_f32 v236, v236, v232
    v_accvgpr_write_b32 a39, v236
    v_accvgpr_read_b32 v233, a40
    v_mul_f32 v233, v233, v232
    v_accvgpr_write_b32 a40, v233
    v_accvgpr_read_b32 v234, a41
    v_mul_f32 v234, v234, v232
    v_accvgpr_write_b32 a41, v234
    v_accvgpr_read_b32 v235, a42
    v_mul_f32 v235, v235, v232
    v_accvgpr_write_b32 a42, v235
    v_accvgpr_read_b32 v236, a43
    v_mul_f32 v236, v236, v232
    v_accvgpr_write_b32 a43, v236
    v_accvgpr_read_b32 v233, a44
    v_mul_f32 v233, v233, v232
    v_accvgpr_write_b32 a44, v233
    v_accvgpr_read_b32 v234, a45
    v_mul_f32 v234, v234, v232
    v_accvgpr_write_b32 a45, v234
    v_accvgpr_read_b32 v235, a46
    v_mul_f32 v235, v235, v232
    v_accvgpr_write_b32 a46, v235
    v_accvgpr_read_b32 v236, a47
    v_mul_f32 v236, v236, v232
    v_accvgpr_write_b32 a47, v236
    v_accvgpr_read_b32 v233, a48
    v_mul_f32 v233, v233, v232
    v_accvgpr_write_b32 a48, v233
    v_accvgpr_read_b32 v234, a49
    v_mul_f32 v234, v234, v232
    v_accvgpr_write_b32 a49, v234
    v_accvgpr_read_b32 v235, a50
    v_mul_f32 v235, v235, v232
    v_accvgpr_write_b32 a50, v235
    v_accvgpr_read_b32 v236, a51
    v_mul_f32 v236, v236, v232
    v_accvgpr_write_b32 a51, v236
    v_accvgpr_read_b32 v233, a52
    v_mul_f32 v233, v233, v232
    v_accvgpr_write_b32 a52, v233
    v_accvgpr_read_b32 v234, a53
    v_mul_f32 v234, v234, v232
    v_accvgpr_write_b32 a53, v234
    v_accvgpr_read_b32 v235, a54
    v_mul_f32 v235, v235, v232
    v_accvgpr_write_b32 a54, v235
    v_accvgpr_read_b32 v236, a55
    v_mul_f32 v236, v236, v232
    v_accvgpr_write_b32 a55, v236
    v_accvgpr_read_b32 v233, a56
    v_mul_f32 v233, v233, v232
    v_accvgpr_write_b32 a56, v233
    v_accvgpr_read_b32 v234, a57
    v_mul_f32 v234, v234, v232
    v_accvgpr_write_b32 a57, v234
    v_accvgpr_read_b32 v235, a58
    v_mul_f32 v235, v235, v232
    v_accvgpr_write_b32 a58, v235
    v_accvgpr_read_b32 v236, a59
    v_mul_f32 v236, v236, v232
    v_accvgpr_write_b32 a59, v236
    v_accvgpr_read_b32 v233, a60
    v_mul_f32 v233, v233, v232
    v_accvgpr_write_b32 a60, v233
    v_accvgpr_read_b32 v234, a61
    v_mul_f32 v234, v234, v232
    v_accvgpr_write_b32 a61, v234
    v_accvgpr_read_b32 v235, a62
    v_mul_f32 v235, v235, v232
    v_accvgpr_write_b32 a62, v235
    v_accvgpr_read_b32 v236, a63
    v_mul_f32 v236, v236, v232
    v_accvgpr_write_b32 a63, v236
    v_exp_f32 v128, v40
    v_exp_f32 v129, v41
    v_exp_f32 v130, v42
    v_exp_f32 v131, v43
    v_exp_f32 v132, v44
    v_exp_f32 v133, v45
    v_exp_f32 v134, v46
    v_exp_f32 v135, v47
    s_nop 0
    v_cvt_pk_bf16_f32 v116, v128, v129
    v_cvt_pk_bf16_f32 v117, v130, v131
    v_cvt_pk_bf16_f32 v118, v132, v133
    v_cvt_pk_bf16_f32 v119, v134, v135
    v_max3_f32 v230, v48, v49, v50
    v_max3_f32 v230, v230, v51, v52
    v_max3_f32 v230, v230, v53, v54
    v_max_f32 v230, v230, v55
    v_mov_b32 v231, v230
    s_nop 1
    v_permlane16_swap_b32 v230, v231
    s_nop 0
    v_max_f32 v230, v230, v231
    v_mov_b32 v231, v230
    s_nop 1
    v_permlane32_swap_b32 v230, v231
    s_nop 0
    v_max_f32 v230, v230, v231
    v_add_f32 v230, 0x41800000, v230
    v_max_f32 v230, 0, v230
    v_sub_f32 v232, 0, v230
    v_exp_f32 v232, v232
    v_sub_f32 v226, v226, v230
    v_sub_f32 v80, v80, v230
    v_sub_f32 v16, v16, v230
    v_sub_f32 v48, v48, v230
    v_sub_f32 v81, v81, v230
    v_sub_f32 v17, v17, v230
    v_sub_f32 v49, v49, v230
    v_sub_f32 v82, v82, v230
    v_sub_f32 v18, v18, v230
    v_sub_f32 v50, v50, v230
    v_sub_f32 v83, v83, v230
    v_sub_f32 v19, v19, v230
    v_sub_f32 v51, v51, v230
    v_sub_f32 v84, v84, v230
    v_sub_f32 v20, v20, v230
    v_sub_f32 v52, v52, v230
    v_sub_f32 v85, v85, v230
    v_sub_f32 v21, v21, v230
    v_sub_f32 v53, v53, v230
    v_sub_f32 v86, v86, v230
    v_sub_f32 v22, v22, v230
    v_sub_f32 v54, v54, v230
    v_sub_f32 v87, v87, v230
    v_sub_f32 v23, v23, v230
    v_sub_f32 v55, v55, v230
    v_mul_f32 v152, v152, v232
    v_mul_f32 v153, v153, v232
    v_mul_f32 v154, v154, v232
    v_mul_f32 v155, v155, v232
    v_accvgpr_read_b32 v233, a64
    v_mul_f32 v233, v233, v232
    v_accvgpr_write_b32 a64, v233
    v_accvgpr_read_b32 v234, a65
    v_mul_f32 v234, v234, v232
    v_accvgpr_write_b32 a65, v234
    v_accvgpr_read_b32 v235, a66
    v_mul_f32 v235, v235, v232
    v_accvgpr_write_b32 a66, v235
    v_accvgpr_read_b32 v236, a67
    v_mul_f32 v236, v236, v232
    v_accvgpr_write_b32 a67, v236
    v_accvgpr_read_b32 v233, a68
    v_mul_f32 v233, v233, v232
    v_accvgpr_write_b32 a68, v233
    v_accvgpr_read_b32 v234, a69
    v_mul_f32 v234, v234, v232
    v_accvgpr_write_b32 a69, v234
    v_accvgpr_read_b32 v235, a70
    v_mul_f32 v235, v235, v232
    v_accvgpr_write_b32 a70, v235
    v_accvgpr_read_b32 v236, a71
    v_mul_f32 v236, v236, v232
    v_accvgpr_write_b32 a71, v236
    v_accvgpr_read_b32 v233, a72
    v_mul_f32 v233, v233, v232
    v_accvgpr_write_b32 a72, v233
    v_accvgpr_read_b32 v234, a73
    v_mul_f32 v234, v234, v232
    v_accvgpr_write_b32 a73, v234
    v_accvgpr_read_b32 v235, a74
    v_mul_f32 v235, v235, v232
    v_accvgpr_write_b32 a74, v235
    v_accvgpr_read_b32 v236, a75
    v_mul_f32 v236, v236, v232
    v_accvgpr_write_b32 a75, v236
    v_accvgpr_read_b32 v233, a76
    v_mul_f32 v233, v233, v232
    v_accvgpr_write_b32 a76, v233
    v_accvgpr_read_b32 v234, a77
    v_mul_f32 v234, v234, v232
    v_accvgpr_write_b32 a77, v234
    v_accvgpr_read_b32 v235, a78
    v_mul_f32 v235, v235, v232
    v_accvgpr_write_b32 a78, v235
    v_accvgpr_read_b32 v236, a79
    v_mul_f32 v236, v236, v232
    v_accvgpr_write_b32 a79, v236
    v_accvgpr_read_b32 v233, a80
    v_mul_f32 v233, v233, v232
    v_accvgpr_write_b32 a80, v233
    v_accvgpr_read_b32 v234, a81
    v_mul_f32 v234, v234, v232
    v_accvgpr_write_b32 a81, v234
    v_accvgpr_read_b32 v235, a82
    v_mul_f32 v235, v235, v232
    v_accvgpr_write_b32 a82, v235
    v_accvgpr_read_b32 v236, a83
    v_mul_f32 v236, v236, v232
    v_accvgpr_write_b32 a83, v236
    v_accvgpr_read_b32 v233, a84
    v_mul_f32 v233, v233, v232
    v_accvgpr_write_b32 a84, v233
    v_accvgpr_read_b32 v234, a85
    v_mul_f32 v234, v234, v232
    v_accvgpr_write_b32 a85, v234
    v_accvgpr_read_b32 v235, a86
    v_mul_f32 v235, v235, v232
    v_accvgpr_write_b32 a86, v235
    v_accvgpr_read_b32 v236, a87
    v_mul_f32 v236, v236, v232
    v_accvgpr_write_b32 a87, v236
    v_accvgpr_read_b32 v233, a88
    v_mul_f32 v233, v233, v232
    v_accvgpr_write_b32 a88, v233
    v_accvgpr_read_b32 v234, a89
    v_mul_f32 v234, v234, v232
    v_accvgpr_write_b32 a89, v234
    v_accvgpr_read_b32 v235, a90
    v_mul_f32 v235, v235, v232
    v_accvgpr_write_b32 a90, v235
    v_accvgpr_read_b32 v236, a91
    v_mul_f32 v236, v236, v232
    v_accvgpr_write_b32 a91, v236
    v_accvgpr_read_b32 v233, a92
    v_mul_f32 v233, v233, v232
    v_accvgpr_write_b32 a92, v233
    v_accvgpr_read_b32 v234, a93
    v_mul_f32 v234, v234, v232
    v_accvgpr_write_b32 a93, v234
    v_accvgpr_read_b32 v235, a94
    v_mul_f32 v235, v235, v232
    v_accvgpr_write_b32 a94, v235
    v_accvgpr_read_b32 v236, a95
    v_mul_f32 v236, v236, v232
    v_accvgpr_write_b32 a95, v236
    v_exp_f32 v128, v48
    v_exp_f32 v129, v49
    v_exp_f32 v130, v50
    v_exp_f32 v131, v51
    v_exp_f32 v132, v52
    v_exp_f32 v133, v53
    v_exp_f32 v134, v54
    v_exp_f32 v135, v55
    s_nop 0
    v_cvt_pk_bf16_f32 v120, v128, v129
    v_cvt_pk_bf16_f32 v121, v130, v131
    v_cvt_pk_bf16_f32 v122, v132, v133
    v_cvt_pk_bf16_f32 v123, v134, v135
    v_max3_f32 v230, v56, v57, v58
    v_max3_f32 v230, v230, v59, v60
    v_max3_f32 v230, v230, v61, v62
    v_max_f32 v230, v230, v63
    v_mov_b32 v231, v230
    s_nop 1
    v_permlane16_swap_b32 v230, v231
    s_nop 0
    v_max_f32 v230, v230, v231
    v_mov_b32 v231, v230
    s_nop 1
    v_permlane32_swap_b32 v230, v231
    s_nop 0
    v_max_f32 v230, v230, v231
    v_add_f32 v230, 0x41800000, v230
    v_max_f32 v230, 0, v230
    v_sub_f32 v232, 0, v230
    v_exp_f32 v232, v232
    v_sub_f32 v227, v227, v230
    v_sub_f32 v88, v88, v230
    v_sub_f32 v24, v24, v230
    v_sub_f32 v56, v56, v230
    v_sub_f32 v89, v89, v230
    v_sub_f32 v25, v25, v230
    v_sub_f32 v57, v57, v230
    v_sub_f32 v90, v90, v230
    v_sub_f32 v26, v26, v230
    v_sub_f32 v58, v58, v230
    v_sub_f32 v91, v91, v230
    v_sub_f32 v27, v27, v230
    v_sub_f32 v59, v59, v230
    v_sub_f32 v92, v92, v230
    v_sub_f32 v28, v28, v230
    v_sub_f32 v60, v60, v230
    v_sub_f32 v93, v93, v230
    v_sub_f32 v29, v29, v230
    v_sub_f32 v61, v61, v230
    v_sub_f32 v94, v94, v230
    v_sub_f32 v30, v30, v230
    v_sub_f32 v62, v62, v230
    v_sub_f32 v95, v95, v230
    v_sub_f32 v31, v31, v230
    v_sub_f32 v63, v63, v230
    v_mul_f32 v156, v156, v232
    v_mul_f32 v157, v157, v232
    v_mul_f32 v158, v158, v232
    v_mul_f32 v159, v159, v232
    v_accvgpr_read_b32 v233, a96
    v_mul_f32 v233, v233, v232
    v_accvgpr_write_b32 a96, v233
    v_accvgpr_read_b32 v234, a97
    v_mul_f32 v234, v234, v232
    v_accvgpr_write_b32 a97, v234
    v_accvgpr_read_b32 v235, a98
    v_mul_f32 v235, v235, v232
    v_accvgpr_write_b32 a98, v235
    v_accvgpr_read_b32 v236, a99
    v_mul_f32 v236, v236, v232
    v_accvgpr_write_b32 a99, v236
    v_accvgpr_read_b32 v233, a100
    v_mul_f32 v233, v233, v232
    v_accvgpr_write_b32 a100, v233
    v_accvgpr_read_b32 v234, a101
    v_mul_f32 v234, v234, v232
    v_accvgpr_write_b32 a101, v234
    v_accvgpr_read_b32 v235, a102
    v_mul_f32 v235, v235, v232
    v_accvgpr_write_b32 a102, v235
    v_accvgpr_read_b32 v236, a103
    v_mul_f32 v236, v236, v232
    v_accvgpr_write_b32 a103, v236
    v_accvgpr_read_b32 v233, a104
    v_mul_f32 v233, v233, v232
    v_accvgpr_write_b32 a104, v233
    v_accvgpr_read_b32 v234, a105
    v_mul_f32 v234, v234, v232
    v_accvgpr_write_b32 a105, v234
    v_accvgpr_read_b32 v235, a106
    v_mul_f32 v235, v235, v232
    v_accvgpr_write_b32 a106, v235
    v_accvgpr_read_b32 v236, a107
    v_mul_f32 v236, v236, v232
    v_accvgpr_write_b32 a107, v236
    v_accvgpr_read_b32 v233, a108
    v_mul_f32 v233, v233, v232
    v_accvgpr_write_b32 a108, v233
    v_accvgpr_read_b32 v234, a109
    v_mul_f32 v234, v234, v232
    v_accvgpr_write_b32 a109, v234
    v_accvgpr_read_b32 v235, a110
    v_mul_f32 v235, v235, v232
    v_accvgpr_write_b32 a110, v235
    v_accvgpr_read_b32 v236, a111
    v_mul_f32 v236, v236, v232
    v_accvgpr_write_b32 a111, v236
    v_accvgpr_read_b32 v233, a112
    v_mul_f32 v233, v233, v232
    v_accvgpr_write_b32 a112, v233
    v_accvgpr_read_b32 v234, a113
    v_mul_f32 v234, v234, v232
    v_accvgpr_write_b32 a113, v234
    v_accvgpr_read_b32 v235, a114
    v_mul_f32 v235, v235, v232
    v_accvgpr_write_b32 a114, v235
    v_accvgpr_read_b32 v236, a115
    v_mul_f32 v236, v236, v232
    v_accvgpr_write_b32 a115, v236
    v_accvgpr_read_b32 v233, a116
    v_mul_f32 v233, v233, v232
    v_accvgpr_write_b32 a116, v233
    v_accvgpr_read_b32 v234, a117
    v_mul_f32 v234, v234, v232
    v_accvgpr_write_b32 a117, v234
    v_accvgpr_read_b32 v235, a118
    v_mul_f32 v235, v235, v232
    v_accvgpr_write_b32 a118, v235
    v_accvgpr_read_b32 v236, a119
    v_mul_f32 v236, v236, v232
    v_accvgpr_write_b32 a119, v236
    v_accvgpr_read_b32 v233, a120
    v_mul_f32 v233, v233, v232
    v_accvgpr_write_b32 a120, v233
    v_accvgpr_read_b32 v234, a121
    v_mul_f32 v234, v234, v232
    v_accvgpr_write_b32 a121, v234
    v_accvgpr_read_b32 v235, a122
    v_mul_f32 v235, v235, v232
    v_accvgpr_write_b32 a122, v235
    v_accvgpr_read_b32 v236, a123
    v_mul_f32 v236, v236, v232
    v_accvgpr_write_b32 a123, v236
    v_accvgpr_read_b32 v233, a124
    v_mul_f32 v233, v233, v232
    v_accvgpr_write_b32 a124, v233
    v_accvgpr_read_b32 v234, a125
    v_mul_f32 v234, v234, v232
    v_accvgpr_write_b32 a125, v234
    v_accvgpr_read_b32 v235, a126
    v_mul_f32 v235, v235, v232
    v_accvgpr_write_b32 a126, v235
    v_accvgpr_read_b32 v236, a127
    v_mul_f32 v236, v236, v232
    v_accvgpr_write_b32 a127, v236
    v_exp_f32 v128, v56
    v_exp_f32 v129, v57
    v_exp_f32 v130, v58
    v_exp_f32 v131, v59
    v_exp_f32 v132, v60
    v_exp_f32 v133, v61
    v_exp_f32 v134, v62
    v_exp_f32 v135, v63
    s_nop 0
    v_cvt_pk_bf16_f32 v124, v128, v129
    v_cvt_pk_bf16_f32 v125, v130, v131
    v_cvt_pk_bf16_f32 v126, v132, v133
    v_cvt_pk_bf16_f32 v127, v134, v135
    s_nop 1
    s_branch kf_rr5
kf_rare10:
    s_nop 15
    v_max3_f32 v230, v0, v1, v2
    v_max3_f32 v230, v230, v3, v4
    v_max3_f32 v230, v230, v5, v6
    v_max_f32 v230, v230, v7
    v_mov_b32 v231, v230
    s_nop 1
    v_permlane16_swap_b32 v230, v231
    s_nop 0
    v_max_f32 v230, v230, v231
    v_mov_b32 v231, v230
    s_nop 1
    v_permlane32_swap_b32 v230, v231
    s_nop 0
    v_max_f32 v230, v230, v231
    v_add_f32 v230, 0x41800000, v230
    v_max_f32 v230, 0, v230
    v_sub_f32 v232, 0, v230
    v_exp_f32 v232, v232
    v_sub_f32 v224, v224, v230
    v_sub_f32 v64, v64, v230
    v_sub_f32 v32, v32, v230
    v_sub_f32 v0, v0, v230
    v_sub_f32 v65, v65, v230
    v_sub_f32 v33, v33, v230
    v_sub_f32 v1, v1, v230
    v_sub_f32 v66, v66, v230
    v_sub_f32 v34, v34, v230
    v_sub_f32 v2, v2, v230
    v_sub_f32 v67, v67, v230
    v_sub_f32 v35, v35, v230
    v_sub_f32 v3, v3, v230
    v_sub_f32 v68, v68, v230
    v_sub_f32 v36, v36, v230
    v_sub_f32 v4, v4, v230
    v_sub_f32 v69, v69, v230
    v_sub_f32 v37, v37, v230
    v_sub_f32 v5, v5, v230
    v_sub_f32 v70, v70, v230
    v_sub_f32 v38, v38, v230
    v_sub_f32 v6, v6, v230
    v_sub_f32 v71, v71, v230
    v_sub_f32 v39, v39, v230
    v_sub_f32 v7, v7, v230
    v_mul_f32 v144, v144, v232
    v_mul_f32 v145, v145, v232
    v_mul_f32 v146, v146, v232
    v_mul_f32 v147, v147, v232
    v_accvgpr_read_b32 v233, a0
    v_mul_f32 v233, v233, v232
    v_accvgpr_write_b32 a0, v233
    v_accvgpr_read_b32 v234, a1
    v_mul_f32 v234, v234, v232
    v_accvgpr_write_b32 a1, v234
    v_accvgpr_read_b32 v235, a2
    v_mul_f32 v235, v235, v232
    v_accvgpr_write_b32 a2, v235
    v_accvgpr_read_b32 v236, a3
    v_mul_f32 v236, v236, v232
    v_accvgpr_write_b32 a3, v236
    v_accvgpr_read_b32 v233, a4
    v_mul_f32 v233, v233, v232
    v_accvgpr_write_b32 a4, v233
    v_accvgpr_read_b32 v234, a5
    v_mul_f32 v234, v234, v232
    v_accvgpr_write_b32 a5, v234
    v_accvgpr_read_b32 v235, a6
    v_mul_f32 v235, v235, v232
    v_accvgpr_write_b32 a6, v235
    v_accvgpr_read_b32 v236, a7
    v_mul_f32 v236, v236, v232
    v_accvgpr_write_b32 a7, v236
    v_accvgpr_read_b32 v233, a8
    v_mul_f32 v233, v233, v232
    v_accvgpr_write_b32 a8, v233
    v_accvgpr_read_b32 v234, a9
    v_mul_f32 v234, v234, v232
    v_accvgpr_write_b32 a9, v234
    v_accvgpr_read_b32 v235, a10
    v_mul_f32 v235, v235, v232
    v_accvgpr_write_b32 a10, v235
    v_accvgpr_read_b32 v236, a11
    v_mul_f32 v236, v236, v232
    v_accvgpr_write_b32 a11, v236
    v_accvgpr_read_b32 v233, a12
    v_mul_f32 v233, v233, v232
    v_accvgpr_write_b32 a12, v233
    v_accvgpr_read_b32 v234, a13
    v_mul_f32 v234, v234, v232
    v_accvgpr_write_b32 a13, v234
    v_accvgpr_read_b32 v235, a14
    v_mul_f32 v235, v235, v232
    v_accvgpr_write_b32 a14, v235
    v_accvgpr_read_b32 v236, a15
    v_mul_f32 v236, v236, v232
    v_accvgpr_write_b32 a15, v236
    v_accvgpr_read_b32 v233, a16
    v_mul_f32 v233, v233, v232
    v_accvgpr_write_b32 a16, v233
    v_accvgpr_read_b32 v234, a17
    v_mul_f32 v234, v234, v232
    v_accvgpr_write_b32 a17, v234
    v_accvgpr_read_b32 v235, a18
    v_mul_f32 v235, v235, v232
    v_accvgpr_write_b32 a18, v235
    v_accvgpr_read_b32 v236, a19
    v_mul_f32 v236, v236, v232
    v_accvgpr_write_b32 a19, v236
    v_accvgpr_read_b32 v233, a20
    v_mul_f32 v233, v233, v232
    v_accvgpr_write_b32 a20, v233
    v_accvgpr_read_b32 v234, a21
    v_mul_f32 v234, v234, v232
    v_accvgpr_write_b32 a21, v234
    v_accvgpr_read_b32 v235, a22
    v_mul_f32 v235, v235, v232
    v_accvgpr_write_b32 a22, v235
    v_accvgpr_read_b32 v236, a23
    v_mul_f32 v236, v236, v232
    v_accvgpr_write_b32 a23, v236
    v_accvgpr_read_b32 v233, a24
    v_mul_f32 v233, v233, v232
    v_accvgpr_write_b32 a24, v233
    v_accvgpr_read_b32 v234, a25
    v_mul_f32 v234, v234, v232
    v_accvgpr_write_b32 a25, v234
    v_accvgpr_read_b32 v235, a26
    v_mul_f32 v235, v235, v232
    v_accvgpr_write_b32 a26, v235
    v_accvgpr_read_b32 v236, a27
    v_mul_f32 v236, v236, v232
    v_accvgpr_write_b32 a27, v236
    v_accvgpr_read_b32 v233, a28
    v_mul_f32 v233, v233, v232
    v_accvgpr_write_b32 a28, v233
    v_accvgpr_read_b32 v234, a29
    v_mul_f32 v234, v234, v232
    v_accvgpr_write_b32 a29, v234
    v_accvgpr_read_b32 v235, a30
    v_mul_f32 v235, v235, v232
    v_accvgpr_write_b32 a30, v235
    v_accvgpr_read_b32 v236, a31
    v_mul_f32 v236, v236, v232
    v_accvgpr_write_b32 a31, v236
    v_exp_f32 v128, v0
    v_exp_f32 v129, v1
    v_exp_f32 v130, v2
    v_exp_f32 v131, v3
    v_exp_f32 v132, v4
    v_exp_f32 v133, v5
    v_exp_f32 v134, v6
    v_exp_f32 v135, v7
    s_nop 0
    v_cvt_pk_bf16_f32 v96, v128, v129
    v_cvt_pk_bf16_f32 v97, v130, v131
    v_cvt_pk_bf16_f32 v98, v132, v133
    v_cvt_pk_bf16_f32 v99, v134, v135
    v_max3_f32 v230, v8, v9, v10
    v_max3_f32 v230, v230, v11, v12
    v_max3_f32 v230, v230, v13, v14
    v_max_f32 v230, v230, v15
    v_mov_b32 v231, v230
    s_nop 1
    v_permlane16_swap_b32 v230, v231
    s_nop 0
    v_max_f32 v230, v230, v231
    v_mov_b32 v231, v230
    s_nop 1
    v_permlane32_swap_b32 v230, v231
    s_nop 0
    v_max_f32 v230, v230, v231
    v_add_f32 v230, 0x41800000, v230
    v_max_f32 v230, 0, v230
    v_sub_f32 v232, 0, v230
    v_exp_f32 v232, v232
    v_sub_f32 v225, v225, v230
    v_sub_f32 v72, v72, v230
    v_sub_f32 v40, v40, v230
    v_sub_f32 v8, v8, v230
    v_sub_f32 v73, v73, v230
    v_sub_f32 v41, v41, v230
    v_sub_f32 v9, v9, v230
    v_sub_f32 v74, v74, v230
    v_sub_f32 v42, v42, v230
    v_sub_f32 v10, v10, v230
    v_sub_f32 v75, v75, v230
    v_sub_f32 v43, v43, v230
    v_sub_f32 v11, v11, v230
    v_sub_f32 v76, v76, v230
    v_sub_f32 v44, v44, v230
    v_sub_f32 v12, v12, v230
    v_sub_f32 v77, v77, v230
    v_sub_f32 v45, v45, v230
    v_sub_f32 v13, v13, v230
    v_sub_f32 v78, v78, v230
    v_sub_f32 v46, v46, v230
    v_sub_f32 v14, v14, v230
    v_sub_f32 v79, v79, v230
    v_sub_f32 v47, v47, v230
    v_sub_f32 v15, v15, v230
    v_mul_f32 v148, v148, v232
    v_mul_f32 v149, v149, v232
    v_mul_f32 v150, v150, v232
    v_mul_f32 v151, v151, v232
    v_accvgpr_read_b32 v233, a32
    v_mul_f32 v233, v233, v232
    v_accvgpr_write_b32 a32, v233
    v_accvgpr_read_b32 v234, a33
    v_mul_f32 v234, v234, v232
    v_accvgpr_write_b32 a33, v234
    v_accvgpr_read_b32 v235, a34
    v_mul_f32 v235, v235, v232
    v_accvgpr_write_b32 a34, v235
    v_accvgpr_read_b32 v236, a35
    v_mul_f32 v236, v236, v232
    v_accvgpr_write_b32 a35, v236
    v_accvgpr_read_b32 v233, a36
    v_mul_f32 v233, v233, v232
    v_accvgpr_write_b32 a36, v233
    v_accvgpr_read_b32 v234, a37
    v_mul_f32 v234, v234, v232
    v_accvgpr_write_b32 a37, v234
    v_accvgpr_read_b32 v235, a38
    v_mul_f32 v235, v235, v232
    v_accvgpr_write_b32 a38, v235
    v_accvgpr_read_b32 v236, a39
    v_mul_f32 v236, v236, v232
    v_accvgpr_write_b32 a39, v236
    v_accvgpr_read_b32 v233, a40
    v_mul_f32 v233, v233, v232
    v_accvgpr_write_b32 a40, v233
    v_accvgpr_read_b32 v234, a41
    v_mul_f32 v234, v234, v232
    v_accvgpr_write_b32 a41, v234
    v_accvgpr_read_b32 v235, a42
    v_mul_f32 v235, v235, v232
    v_accvgpr_write_b32 a42, v235
    v_accvgpr_read_b32 v236, a43
    v_mul_f32 v236, v236, v232
    v_accvgpr_write_b32 a43, v236
    v_accvgpr_read_b32 v233, a44
    v_mul_f32 v233, v233, v232
    v_accvgpr_write_b32 a44, v233
    v_accvgpr_read_b32 v234, a45
    v_mul_f32 v234, v234, v232
    v_accvgpr_write_b32 a45, v234
    v_accvgpr_read_b32 v235, a46
    v_mul_f32 v235, v235, v232
    v_accvgpr_write_b32 a46, v235
    v_accvgpr_read_b32 v236, a47
    v_mul_f32 v236, v236, v232
    v_accvgpr_write_b32 a47, v236
    v_accvgpr_read_b32 v233, a48
    v_mul_f32 v233, v233, v232
    v_accvgpr_write_b32 a48, v233
    v_accvgpr_read_b32 v234, a49
    v_mul_f32 v234, v234, v232
    v_accvgpr_write_b32 a49, v234
    v_accvgpr_read_b32 v235, a50
    v_mul_f32 v235, v235, v232
    v_accvgpr_write_b32 a50, v235
    v_accvgpr_read_b32 v236, a51
    v_mul_f32 v236, v236, v232
    v_accvgpr_write_b32 a51, v236
    v_accvgpr_read_b32 v233, a52
    v_mul_f32 v233, v233, v232
    v_accvgpr_write_b32 a52, v233
    v_accvgpr_read_b32 v234, a53
    v_mul_f32 v234, v234, v232
    v_accvgpr_write_b32 a53, v234
    v_accvgpr_read_b32 v235, a54
    v_mul_f32 v235, v235, v232
    v_accvgpr_write_b32 a54, v235
    v_accvgpr_read_b32 v236, a55
    v_mul_f32 v236, v236, v232
    v_accvgpr_write_b32 a55, v236
    v_accvgpr_read_b32 v233, a56
    v_mul_f32 v233, v233, v232
    v_accvgpr_write_b32 a56, v233
    v_accvgpr_read_b32 v234, a57
    v_mul_f32 v234, v234, v232
    v_accvgpr_write_b32 a57, v234
    v_accvgpr_read_b32 v235, a58
    v_mul_f32 v235, v235, v232
    v_accvgpr_write_b32 a58, v235
    v_accvgpr_read_b32 v236, a59
    v_mul_f32 v236, v236, v232
    v_accvgpr_write_b32 a59, v236
    v_accvgpr_read_b32 v233, a60
    v_mul_f32 v233, v233, v232
    v_accvgpr_write_b32 a60, v233
    v_accvgpr_read_b32 v234, a61
    v_mul_f32 v234, v234, v232
    v_accvgpr_write_b32 a61, v234
    v_accvgpr_read_b32 v235, a62
    v_mul_f32 v235, v235, v232
    v_accvgpr_write_b32 a62, v235
    v_accvgpr_read_b32 v236, a63
    v_mul_f32 v236, v236, v232
    v_accvgpr_write_b32 a63, v236
    v_exp_f32 v128, v8
    v_exp_f32 v129, v9
    v_exp_f32 v130, v10
    v_exp_f32 v131, v11
    v_exp_f32 v132, v12
    v_exp_f32 v133, v13
    v_exp_f32 v134, v14
    v_exp_f32 v135, v15
    s_nop 0
    v_cvt_pk_bf16_f32 v100, v128, v129
    v_cvt_pk_bf16_f32 v101, v130, v131
    v_cvt_pk_bf16_f32 v102, v132, v133
    v_cvt_pk_bf16_f32 v103, v134, v135
    v_max3_f32 v230, v16, v17, v18
    v_max3_f32 v230, v230, v19, v20
    v_max3_f32 v230, v230, v21, v22
    v_max_f32 v230, v230, v23
    v_mov_b32 v231, v230
    s_nop 1
    v_permlane16_swap_b32 v230, v231
    s_nop 0
    v_max_f32 v230, v230, v231
    v_mov_b32 v231, v230
    s_nop 1
    v_permlane32_swap_b32 v230, v231
    s_nop 0
    v_max_f32 v230, v230, v231
    v_add_f32 v230, 0x41800000, v230
    v_max_f32 v230, 0, v230
    v_sub_f32 v232, 0, v230
    v_exp_f32 v232, v232
    v_sub_f32 v226, v226, v230
    v_sub_f32 v80, v80, v230
    v_sub_f32 v48, v48, v230
    v_sub_f32 v16, v16, v230
    v_sub_f32 v81, v81, v230
    v_sub_f32 v49, v49, v230
    v_sub_f32 v17, v17, v230
    v_sub_f32 v82, v82, v230
    v_sub_f32 v50, v50, v230
    v_sub_f32 v18, v18, v230
    v_sub_f32 v83, v83, v230
    v_sub_f32 v51, v51, v230
    v_sub_f32 v19, v19, v230
    v_sub_f32 v84, v84, v230
    v_sub_f32 v52, v52, v230
    v_sub_f32 v20, v20, v230
    v_sub_f32 v85, v85, v230
    v_sub_f32 v53, v53, v230
    v_sub_f32 v21, v21, v230
    v_sub_f32 v86, v86, v230
    v_sub_f32 v54, v54, v230
    v_sub_f32 v22, v22, v230
    v_sub_f32 v87, v87, v230
    v_sub_f32 v55, v55, v230
    v_sub_f32 v23, v23, v230
    v_mul_f32 v152, v152, v232
    v_mul_f32 v153, v153, v232
    v_mul_f32 v154, v154, v232
    v_mul_f32 v155, v155, v232
    v_accvgpr_read_b32 v233, a64
    v_mul_f32 v233, v233, v232
    v_accvgpr_write_b32 a64, v233
    v_accvgpr_read_b32 v234, a65
    v_mul_f32 v234, v234, v232
    v_accvgpr_write_b32 a65, v234
    v_accvgpr_read_b32 v235, a66
    v_mul_f32 v235, v235, v232
    v_accvgpr_write_b32 a66, v235
    v_accvgpr_read_b32 v236, a67
    v_mul_f32 v236, v236, v232
    v_accvgpr_write_b32 a67, v236
    v_accvgpr_read_b32 v233, a68
    v_mul_f32 v233, v233, v232
    v_accvgpr_write_b32 a68, v233
    v_accvgpr_read_b32 v234, a69
    v_mul_f32 v234, v234, v232
    v_accvgpr_write_b32 a69, v234
    v_accvgpr_read_b32 v235, a70
    v_mul_f32 v235, v235, v232
    v_accvgpr_write_b32 a70, v235
    v_accvgpr_read_b32 v236, a71
    v_mul_f32 v236, v236, v232
    v_accvgpr_write_b32 a71, v236
    v_accvgpr_read_b32 v233, a72
    v_mul_f32 v233, v233, v232
    v_accvgpr_write_b32 a72, v233
    v_accvgpr_read_b32 v234, a73
    v_mul_f32 v234, v234, v232
    v_accvgpr_write_b32 a73, v234
    v_accvgpr_read_b32 v235, a74
    v_mul_f32 v235, v235, v232
    v_accvgpr_write_b32 a74, v235
    v_accvgpr_read_b32 v236, a75
    v_mul_f32 v236, v236, v232
    v_accvgpr_write_b32 a75, v236
    v_accvgpr_read_b32 v233, a76
    v_mul_f32 v233, v233, v232
    v_accvgpr_write_b32 a76, v233
    v_accvgpr_read_b32 v234, a77
    v_mul_f32 v234, v234, v232
    v_accvgpr_write_b32 a77, v234
    v_accvgpr_read_b32 v235, a78
    v_mul_f32 v235, v235, v232
    v_accvgpr_write_b32 a78, v235
    v_accvgpr_read_b32 v236, a79
    v_mul_f32 v236, v236, v232
    v_accvgpr_write_b32 a79, v236
    v_accvgpr_read_b32 v233, a80
    v_mul_f32 v233, v233, v232
    v_accvgpr_write_b32 a80, v233
    v_accvgpr_read_b32 v234, a81
    v_mul_f32 v234, v234, v232
    v_accvgpr_write_b32 a81, v234
    v_accvgpr_read_b32 v235, a82
    v_mul_f32 v235, v235, v232
    v_accvgpr_write_b32 a82, v235
    v_accvgpr_read_b32 v236, a83
    v_mul_f32 v236, v236, v232
    v_accvgpr_write_b32 a83, v236
    v_accvgpr_read_b32 v233, a84
    v_mul_f32 v233, v233, v232
    v_accvgpr_write_b32 a84, v233
    v_accvgpr_read_b32 v234, a85
    v_mul_f32 v234, v234, v232
    v_accvgpr_write_b32 a85, v234
    v_accvgpr_read_b32 v235, a86
    v_mul_f32 v235, v235, v232
    v_accvgpr_write_b32 a86, v235
    v_accvgpr_read_b32 v236, a87
    v_mul_f32 v236, v236, v232
    v_accvgpr_write_b32 a87, v236
    v_accvgpr_read_b32 v233, a88
    v_mul_f32 v233, v233, v232
    v_accvgpr_write_b32 a88, v233
    v_accvgpr_read_b32 v234, a89
    v_mul_f32 v234, v234, v232
    v_accvgpr_write_b32 a89, v234
    v_accvgpr_read_b32 v235, a90
    v_mul_f32 v235, v235, v232
    v_accvgpr_write_b32 a90, v235
    v_accvgpr_read_b32 v236, a91
    v_mul_f32 v236, v236, v232
    v_accvgpr_write_b32 a91, v236
    v_accvgpr_read_b32 v233, a92
    v_mul_f32 v233, v233, v232
    v_accvgpr_write_b32 a92, v233
    v_accvgpr_read_b32 v234, a93
    v_mul_f32 v234, v234, v232
    v_accvgpr_write_b32 a93, v234
    v_accvgpr_read_b32 v235, a94
    v_mul_f32 v235, v235, v232
    v_accvgpr_write_b32 a94, v235
    v_accvgpr_read_b32 v236, a95
    v_mul_f32 v236, v236, v232
    v_accvgpr_write_b32 a95, v236
    v_exp_f32 v128, v16
    v_exp_f32 v129, v17
    v_exp_f32 v130, v18
    v_exp_f32 v131, v19
    v_exp_f32 v132, v20
    v_exp_f32 v133, v21
    v_exp_f32 v134, v22
    v_exp_f32 v135, v23
    s_nop 0
    v_cvt_pk_bf16_f32 v104, v128, v129
    v_cvt_pk_bf16_f32 v105, v130, v131
    v_cvt_pk_bf16_f32 v106, v132, v133
    v_cvt_pk_bf16_f32 v107, v134, v135
    v_max3_f32 v230, v24, v25, v26
    v_max3_f32 v230, v230, v27, v28
    v_max3_f32 v230, v230, v29, v30
    v_max_f32 v230, v230, v31
    v_mov_b32 v231, v230
    s_nop 1
    v_permlane16_swap_b32 v230, v231
    s_nop 0
    v_max_f32 v230, v230, v231
    v_mov_b32 v231, v230
    s_nop 1
    v_permlane32_swap_b32 v230, v231
    s_nop 0
    v_max_f32 v230, v230, v231
    v_add_f32 v230, 0x41800000, v230
    v_max_f32 v230, 0, v230
    v_sub_f32 v232, 0, v230
    v_exp_f32 v232, v232
    v_sub_f32 v227, v227, v230
    v_sub_f32 v88, v88, v230
    v_sub_f32 v56, v56, v230
    v_sub_f32 v24, v24, v230
    v_sub_f32 v89, v89, v230
    v_sub_f32 v57, v57, v230
    v_sub_f32 v25, v25, v230
    v_sub_f32 v90, v90, v230
    v_sub_f32 v58, v58, v230
    v_sub_f32 v26, v26, v230
    v_sub_f32 v91, v91, v230
    v_sub_f32 v59, v59, v230
    v_sub_f32 v27, v27, v230
    v_sub_f32 v92, v92, v230
    v_sub_f32 v60, v60, v230
    v_sub_f32 v28, v28, v230
    v_sub_f32 v93, v93, v230
    v_sub_f32 v61, v61, v230
    v_sub_f32 v29, v29, v230
    v_sub_f32 v94, v94, v230
    v_sub_f32 v62, v62, v230
    v_sub_f32 v30, v30, v230
    v_sub_f32 v95, v95, v230
    v_sub_f32 v63, v63, v230
    v_sub_f32 v31, v31, v230
    v_mul_f32 v156, v156, v232
    v_mul_f32 v157, v157, v232
    v_mul_f32 v158, v158, v232
    v_mul_f32 v159, v159, v232
    v_accvgpr_read_b32 v233, a96
    v_mul_f32 v233, v233, v232
    v_accvgpr_write_b32 a96, v233
    v_accvgpr_read_b32 v234, a97
    v_mul_f32 v234, v234, v232
    v_accvgpr_write_b32 a97, v234
    v_accvgpr_read_b32 v235, a98
    v_mul_f32 v235, v235, v232
    v_accvgpr_write_b32 a98, v235
    v_accvgpr_read_b32 v236, a99
    v_mul_f32 v236, v236, v232
    v_accvgpr_write_b32 a99, v236
    v_accvgpr_read_b32 v233, a100
    v_mul_f32 v233, v233, v232
    v_accvgpr_write_b32 a100, v233
    v_accvgpr_read_b32 v234, a101
    v_mul_f32 v234, v234, v232
    v_accvgpr_write_b32 a101, v234
    v_accvgpr_read_b32 v235, a102
    v_mul_f32 v235, v235, v232
    v_accvgpr_write_b32 a102, v235
    v_accvgpr_read_b32 v236, a103
    v_mul_f32 v236, v236, v232
    v_accvgpr_write_b32 a103, v236
    v_accvgpr_read_b32 v233, a104
    v_mul_f32 v233, v233, v232
    v_accvgpr_write_b32 a104, v233
    v_accvgpr_read_b32 v234, a105
    v_mul_f32 v234, v234, v232
    v_accvgpr_write_b32 a105, v234
    v_accvgpr_read_b32 v235, a106
    v_mul_f32 v235, v235, v232
    v_accvgpr_write_b32 a106, v235
    v_accvgpr_read_b32 v236, a107
    v_mul_f32 v236, v236, v232
    v_accvgpr_write_b32 a107, v236
    v_accvgpr_read_b32 v233, a108
    v_mul_f32 v233, v233, v232
    v_accvgpr_write_b32 a108, v233
    v_accvgpr_read_b32 v234, a109
    v_mul_f32 v234, v234, v232
    v_accvgpr_write_b32 a109, v234
    v_accvgpr_read_b32 v235, a110
    v_mul_f32 v235, v235, v232
    v_accvgpr_write_b32 a110, v235
    v_accvgpr_read_b32 v236, a111
    v_mul_f32 v236, v236, v232
    v_accvgpr_write_b32 a111, v236
    v_accvgpr_read_b32 v233, a112
    v_mul_f32 v233, v233, v232
    v_accvgpr_write_b32 a112, v233
    v_accvgpr_read_b32 v234, a113
    v_mul_f32 v234, v234, v232
    v_accvgpr_write_b32 a113, v234
    v_accvgpr_read_b32 v235, a114
    v_mul_f32 v235, v235, v232
    v_accvgpr_write_b32 a114, v235
    v_accvgpr_read_b32 v236, a115
    v_mul_f32 v236, v236, v232
    v_accvgpr_write_b32 a115, v236
    v_accvgpr_read_b32 v233, a116
    v_mul_f32 v233, v233, v232
    v_accvgpr_write_b32 a116, v233
    v_accvgpr_read_b32 v234, a117
    v_mul_f32 v234, v234, v232
    v_accvgpr_write_b32 a117, v234
    v_accvgpr_read_b32 v235, a118
    v_mul_f32 v235, v235, v232
    v_accvgpr_write_b32 a118, v235
    v_accvgpr_read_b32 v236, a119
    v_mul_f32 v236, v236, v232
    v_accvgpr_write_b32 a119, v236
    v_accvgpr_read_b32 v233, a120
    v_mul_f32 v233, v233, v232
    v_accvgpr_write_b32 a120, v233
    v_accvgpr_read_b32 v234, a121
    v_mul_f32 v234, v234, v232
    v_accvgpr_write_b32 a121, v234
    v_accvgpr_read_b32 v235, a122
    v_mul_f32 v235, v235, v232
    v_accvgpr_write_b32 a122, v235
    v_accvgpr_read_b32 v236, a123
    v_mul_f32 v236, v236, v232
    v_accvgpr_write_b32 a123, v236
    v_accvgpr_read_b32 v233, a124
    v_mul_f32 v233, v233, v232
    v_accvgpr_write_b32 a124, v233
    v_accvgpr_read_b32 v234, a125
    v_mul_f32 v234, v234, v232
    v_accvgpr_write_b32 a125, v234
    v_accvgpr_read_b32 v235, a126
    v_mul_f32 v235, v235, v232
    v_accvgpr_write_b32 a126, v235
    v_accvgpr_read_b32 v236, a127
    v_mul_f32 v236, v236, v232
    v_accvgpr_write_b32 a127, v236
    v_exp_f32 v128, v24
    v_exp_f32 v129, v25
    v_exp_f32 v130, v26
    v_exp_f32 v131, v27
    v_exp_f32 v132, v28
    v_exp_f32 v133, v29
    v_exp_f32 v134, v30
    v_exp_f32 v135, v31
    s_nop 0
    v_cvt_pk_bf16_f32 v108, v128, v129
    v_cvt_pk_bf16_f32 v109, v130, v131
    v_cvt_pk_bf16_f32 v110, v132, v133
    v_cvt_pk_bf16_f32 v111, v134, v135
    s_nop 1
    s_branch kf_rr9
kf_rare14:
    s_nop 15
    v_max3_f32 v230, v32, v33, v34
    v_max3_f32 v230, v230, v35, v36
    v_max3_f32 v230, v230, v37, v38
    v_max_f32 v230, v230, v39
    v_mov_b32 v231, v230
    s_nop 1
    v_permlane16_swap_b32 v230, v231
    s_nop 0
    v_max_f32 v230, v230, v231
    v_mov_b32 v231, v230
    s_nop 1
    v_permlane32_swap_b32 v230, v231
    s_nop 0
    v_max_f32 v230, v230, v231
    v_add_f32 v230, 0x41800000, v230
    v_max_f32 v230, 0, v230
    v_sub_f32 v232, 0, v230
    v_exp_f32 v232, v232
    v_sub_f32 v224, v224, v230
    v_sub_f32 v64, v64, v230
    v_sub_f32 v0, v0, v230
    v_sub_f32 v32, v32, v230
    v_sub_f32 v65, v65, v230
    v_sub_f32 v1, v1, v230
    v_sub_f32 v33, v33, v230
    v_sub_f32 v66, v66, v230
    v_sub_f32 v2, v2, v230
    v_sub_f32 v34, v34, v230
    v_sub_f32 v67, v67, v230
    v_sub_f32 v3, v3, v230
    v_sub_f32 v35, v35, v230
    v_sub_f32 v68, v68, v230
    v_sub_f32 v4, v4, v230
    v_sub_f32 v36, v36, v230
    v_sub_f32 v69, v69, v230
    v_sub_f32 v5, v5, v230
    v_sub_f32 v37, v37, v230
    v_sub_f32 v70, v70, v230
    v_sub_f32 v6, v6, v230
    v_sub_f32 v38, v38, v230
    v_sub_f32 v71, v71, v230
    v_sub_f32 v7, v7, v230
    v_sub_f32 v39, v39, v230
    v_mul_f32 v144, v144, v232
    v_mul_f32 v145, v145, v232
    v_mul_f32 v146, v146, v232
    v_mul_f32 v147, v147, v232
    v_accvgpr_read_b32 v233, a0
    v_mul_f32 v233, v233, v232
    v_accvgpr_write_b32 a0, v233
    v_accvgpr_read_b32 v234, a1
    v_mul_f32 v234, v234, v232
    v_accvgpr_write_b32 a1, v234
    v_accvgpr_read_b32 v235, a2
    v_mul_f32 v235, v235, v232
    v_accvgpr_write_b32 a2, v235
    v_accvgpr_read_b32 v236, a3
    v_mul_f32 v236, v236, v232
    v_accvgpr_write_b32 a3, v236
    v_accvgpr_read_b32 v233, a4
    v_mul_f32 v233, v233, v232
    v_accvgpr_write_b32 a4, v233
    v_accvgpr_read_b32 v234, a5
    v_mul_f32 v234, v234, v232
    v_accvgpr_write_b32 a5, v234
    v_accvgpr_read_b32 v235, a6
    v_mul_f32 v235, v235, v232
    v_accvgpr_write_b32 a6, v235
    v_accvgpr_read_b32 v236, a7
    v_mul_f32 v236, v236, v232
    v_accvgpr_write_b32 a7, v236
    v_accvgpr_read_b32 v233, a8
    v_mul_f32 v233, v233, v232
    v_accvgpr_write_b32 a8, v233
    v_accvgpr_read_b32 v234, a9
    v_mul_f32 v234, v234, v232
    v_accvgpr_write_b32 a9, v234
    v_accvgpr_read_b32 v235, a10
    v_mul_f32 v235, v235, v232
    v_accvgpr_write_b32 a10, v235
    v_accvgpr_read_b32 v236, a11
    v_mul_f32 v236, v236, v232
    v_accvgpr_write_b32 a11, v236
    v_accvgpr_read_b32 v233, a12
    v_mul_f32 v233, v233, v232
    v_accvgpr_write_b32 a12, v233
    v_accvgpr_read_b32 v234, a13
    v_mul_f32 v234, v234, v232
    v_accvgpr_write_b32 a13, v234
    v_accvgpr_read_b32 v235, a14
    v_mul_f32 v235, v235, v232
    v_accvgpr_write_b32 a14, v235
    v_accvgpr_read_b32 v236, a15
    v_mul_f32 v236, v236, v232
    v_accvgpr_write_b32 a15, v236
    v_accvgpr_read_b32 v233, a16
    v_mul_f32 v233, v233, v232
    v_accvgpr_write_b32 a16, v233
    v_accvgpr_read_b32 v234, a17
    v_mul_f32 v234, v234, v232
    v_accvgpr_write_b32 a17, v234
    v_accvgpr_read_b32 v235, a18
    v_mul_f32 v235, v235, v232
    v_accvgpr_write_b32 a18, v235
    v_accvgpr_read_b32 v236, a19
    v_mul_f32 v236, v236, v232
    v_accvgpr_write_b32 a19, v236
    v_accvgpr_read_b32 v233, a20
    v_mul_f32 v233, v233, v232
    v_accvgpr_write_b32 a20, v233
    v_accvgpr_read_b32 v234, a21
    v_mul_f32 v234, v234, v232
    v_accvgpr_write_b32 a21, v234
    v_accvgpr_read_b32 v235, a22
    v_mul_f32 v235, v235, v232
    v_accvgpr_write_b32 a22, v235
    v_accvgpr_read_b32 v236, a23
    v_mul_f32 v236, v236, v232
    v_accvgpr_write_b32 a23, v236
    v_accvgpr_read_b32 v233, a24
    v_mul_f32 v233, v233, v232
    v_accvgpr_write_b32 a24, v233
    v_accvgpr_read_b32 v234, a25
    v_mul_f32 v234, v234, v232
    v_accvgpr_write_b32 a25, v234
    v_accvgpr_read_b32 v235, a26
    v_mul_f32 v235, v235, v232
    v_accvgpr_write_b32 a26, v235
    v_accvgpr_read_b32 v236, a27
    v_mul_f32 v236, v236, v232
    v_accvgpr_write_b32 a27, v236
    v_accvgpr_read_b32 v233, a28
    v_mul_f32 v233, v233, v232
    v_accvgpr_write_b32 a28, v233
    v_accvgpr_read_b32 v234, a29
    v_mul_f32 v234, v234, v232
    v_accvgpr_write_b32 a29, v234
    v_accvgpr_read_b32 v235, a30
    v_mul_f32 v235, v235, v232
    v_accvgpr_write_b32 a30, v235
    v_accvgpr_read_b32 v236, a31
    v_mul_f32 v236, v236, v232
    v_accvgpr_write_b32 a31, v236
    v_exp_f32 v128, v32
    v_exp_f32 v129, v33
    v_exp_f32 v130, v34
    v_exp_f32 v131, v35
    v_exp_f32 v132, v36
    v_exp_f32 v133, v37
    v_exp_f32 v134, v38
    v_exp_f32 v135, v39
    s_nop 0
    v_cvt_pk_bf16_f32 v112, v128, v129
    v_cvt_pk_bf16_f32 v113, v130, v131
    v_cvt_pk_bf16_f32 v114, v132, v133
    v_cvt_pk_bf16_f32 v115, v134, v135
    v_max3_f32 v230, v40, v41, v42
    v_max3_f32 v230, v230, v43, v44
    v_max3_f32 v230, v230, v45, v46
    v_max_f32 v230, v230, v47
    v_mov_b32 v231, v230
    s_nop 1
    v_permlane16_swap_b32 v230, v231
    s_nop 0
    v_max_f32 v230, v230, v231
    v_mov_b32 v231, v230
    s_nop 1
    v_permlane32_swap_b32 v230, v231
    s_nop 0
    v_max_f32 v230, v230, v231
    v_add_f32 v230, 0x41800000, v230
    v_max_f32 v230, 0, v230
    v_sub_f32 v232, 0, v230
    v_exp_f32 v232, v232
    v_sub_f32 v225, v225, v230
    v_sub_f32 v72, v72, v230
    v_sub_f32 v8, v8, v230
    v_sub_f32 v40, v40, v230
    v_sub_f32 v73, v73, v230
    v_sub_f32 v9, v9, v230
    v_sub_f32 v41, v41, v230
    v_sub_f32 v74, v74, v230
    v_sub_f32 v10, v10, v230
    v_sub_f32 v42, v42, v230
    v_sub_f32 v75, v75, v230
    v_sub_f32 v11, v11, v230
    v_sub_f32 v43, v43, v230
    v_sub_f32 v76, v76, v230
    v_sub_f32 v12, v12, v230
    v_sub_f32 v44, v44, v230
    v_sub_f32 v77, v77, v230
    v_sub_f32 v13, v13, v230
    v_sub_f32 v45, v45, v230
    v_sub_f32 v78, v78, v230
    v_sub_f32 v14, v14, v230
    v_sub_f32 v46, v46, v230
    v_sub_f32 v79, v79, v230
    v_sub_f32 v15, v15, v230
    v_sub_f32 v47, v47, v230
    v_mul_f32 v148, v148, v232
    v_mul_f32 v149, v149, v232
    v_mul_f32 v150, v150, v232
    v_mul_f32 v151, v151, v232
    v_accvgpr_read_b32 v233, a32
    v_mul_f32 v233, v233, v232
    v_accvgpr_write_b32 a32, v233
    v_accvgpr_read_b32 v234, a33
    v_mul_f32 v234, v234, v232
    v_accvgpr_write_b32 a33, v234
    v_accvgpr_read_b32 v235, a34
    v_mul_f32 v235, v235, v232
    v_accvgpr_write_b32 a34, v235
    v_accvgpr_read_b32 v236, a35
    v_mul_f32 v236, v236, v232
    v_accvgpr_write_b32 a35, v236
    v_accvgpr_read_b32 v233, a36
    v_mul_f32 v233, v233, v232
    v_accvgpr_write_b32 a36, v233
    v_accvgpr_read_b32 v234, a37
    v_mul_f32 v234, v234, v232
    v_accvgpr_write_b32 a37, v234
    v_accvgpr_read_b32 v235, a38
    v_mul_f32 v235, v235, v232
    v_accvgpr_write_b32 a38, v235
    v_accvgpr_read_b32 v236, a39
    v_mul_f32 v236, v236, v232
    v_accvgpr_write_b32 a39, v236
    v_accvgpr_read_b32 v233, a40
    v_mul_f32 v233, v233, v232
    v_accvgpr_write_b32 a40, v233
    v_accvgpr_read_b32 v234, a41
    v_mul_f32 v234, v234, v232
    v_accvgpr_write_b32 a41, v234
    v_accvgpr_read_b32 v235, a42
    v_mul_f32 v235, v235, v232
    v_accvgpr_write_b32 a42, v235
    v_accvgpr_read_b32 v236, a43
    v_mul_f32 v236, v236, v232
    v_accvgpr_write_b32 a43, v236
    v_accvgpr_read_b32 v233, a44
    v_mul_f32 v233, v233, v232
    v_accvgpr_write_b32 a44, v233
    v_accvgpr_read_b32 v234, a45
    v_mul_f32 v234, v234, v232
    v_accvgpr_write_b32 a45, v234
    v_accvgpr_read_b32 v235, a46
    v_mul_f32 v235, v235, v232
    v_accvgpr_write_b32 a46, v235
    v_accvgpr_read_b32 v236, a47
    v_mul_f32 v236, v236, v232
    v_accvgpr_write_b32 a47, v236
    v_accvgpr_read_b32 v233, a48
    v_mul_f32 v233, v233, v232
    v_accvgpr_write_b32 a48, v233
    v_accvgpr_read_b32 v234, a49
    v_mul_f32 v234, v234, v232
    v_accvgpr_write_b32 a49, v234
    v_accvgpr_read_b32 v235, a50
    v_mul_f32 v235, v235, v232
    v_accvgpr_write_b32 a50, v235
    v_accvgpr_read_b32 v236, a51
    v_mul_f32 v236, v236, v232
    v_accvgpr_write_b32 a51, v236
    v_accvgpr_read_b32 v233, a52
    v_mul_f32 v233, v233, v232
    v_accvgpr_write_b32 a52, v233
    v_accvgpr_read_b32 v234, a53
    v_mul_f32 v234, v234, v232
    v_accvgpr_write_b32 a53, v234
    v_accvgpr_read_b32 v235, a54
    v_mul_f32 v235, v235, v232
    v_accvgpr_write_b32 a54, v235
    v_accvgpr_read_b32 v236, a55
    v_mul_f32 v236, v236, v232
    v_accvgpr_write_b32 a55, v236
    v_accvgpr_read_b32 v233, a56
    v_mul_f32 v233, v233, v232
    v_accvgpr_write_b32 a56, v233
    v_accvgpr_read_b32 v234, a57
    v_mul_f32 v234, v234, v232
    v_accvgpr_write_b32 a57, v234
    v_accvgpr_read_b32 v235, a58
    v_mul_f32 v235, v235, v232
    v_accvgpr_write_b32 a58, v235
    v_accvgpr_read_b32 v236, a59
    v_mul_f32 v236, v236, v232
    v_accvgpr_write_b32 a59, v236
    v_accvgpr_read_b32 v233, a60
    v_mul_f32 v233, v233, v232
    v_accvgpr_write_b32 a60, v233
    v_accvgpr_read_b32 v234, a61
    v_mul_f32 v234, v234, v232
    v_accvgpr_write_b32 a61, v234
    v_accvgpr_read_b32 v235, a62
    v_mul_f32 v235, v235, v232
    v_accvgpr_write_b32 a62, v235
    v_accvgpr_read_b32 v236, a63
    v_mul_f32 v236, v236, v232
    v_accvgpr_write_b32 a63, v236
    v_exp_f32 v128, v40
    v_exp_f32 v129, v41
    v_exp_f32 v130, v42
    v_exp_f32 v131, v43
    v_exp_f32 v132, v44
    v_exp_f32 v133, v45
    v_exp_f32 v134, v46
    v_exp_f32 v135, v47
    s_nop 0
    v_cvt_pk_bf16_f32 v116, v128, v129
    v_cvt_pk_bf16_f32 v117, v130, v131
    v_cvt_pk_bf16_f32 v118, v132, v133
    v_cvt_pk_bf16_f32 v119, v134, v135
    v_max3_f32 v230, v48, v49, v50
    v_max3_f32 v230, v230, v51, v52
    v_max3_f32 v230, v230, v53, v54
    v_max_f32 v230, v230, v55
    v_mov_b32 v231, v230
    s_nop 1
    v_permlane16_swap_b32 v230, v231
    s_nop 0
    v_max_f32 v230, v230, v231
    v_mov_b32 v231, v230
    s_nop 1
    v_permlane32_swap_b32 v230, v231
    s_nop 0
    v_max_f32 v230, v230, v231
    v_add_f32 v230, 0x41800000, v230
    v_max_f32 v230, 0, v230
    v_sub_f32 v232, 0, v230
    v_exp_f32 v232, v232
    v_sub_f32 v226, v226, v230
    v_sub_f32 v80, v80, v230
    v_sub_f32 v16, v16, v230
    v_sub_f32 v48, v48, v230
    v_sub_f32 v81, v81, v230
    v_sub_f32 v17, v17, v230
    v_sub_f32 v49, v49, v230
    v_sub_f32 v82, v82, v230
    v_sub_f32 v18, v18, v230
    v_sub_f32 v50, v50, v230
    v_sub_f32 v83, v83, v230
    v_sub_f32 v19, v19, v230
    v_sub_f32 v51, v51, v230
    v_sub_f32 v84, v84, v230
    v_sub_f32 v20, v20, v230
    v_sub_f32 v52, v52, v230
    v_sub_f32 v85, v85, v230
    v_sub_f32 v21, v21, v230
    v_sub_f32 v53, v53, v230
    v_sub_f32 v86, v86, v230
    v_sub_f32 v22, v22, v230
    v_sub_f32 v54, v54, v230
    v_sub_f32 v87, v87, v230
    v_sub_f32 v23, v23, v230
    v_sub_f32 v55, v55, v230
    v_mul_f32 v152, v152, v232
    v_mul_f32 v153, v153, v232
    v_mul_f32 v154, v154, v232
    v_mul_f32 v155, v155, v232
    v_accvgpr_read_b32 v233, a64
    v_mul_f32 v233, v233, v232
    v_accvgpr_write_b32 a64, v233
    v_accvgpr_read_b32 v234, a65
    v_mul_f32 v234, v234, v232
    v_accvgpr_write_b32 a65, v234
    v_accvgpr_read_b32 v235, a66
    v_mul_f32 v235, v235, v232
    v_accvgpr_write_b32 a66, v235
    v_accvgpr_read_b32 v236, a67
    v_mul_f32 v236, v236, v232
    v_accvgpr_write_b32 a67, v236
    v_accvgpr_read_b32 v233, a68
    v_mul_f32 v233, v233, v232
    v_accvgpr_write_b32 a68, v233
    v_accvgpr_read_b32 v234, a69
    v_mul_f32 v234, v234, v232
    v_accvgpr_write_b32 a69, v234
    v_accvgpr_read_b32 v235, a70
    v_mul_f32 v235, v235, v232
    v_accvgpr_write_b32 a70, v235
    v_accvgpr_read_b32 v236, a71
    v_mul_f32 v236, v236, v232
    v_accvgpr_write_b32 a71, v236
    v_accvgpr_read_b32 v233, a72
    v_mul_f32 v233, v233, v232
    v_accvgpr_write_b32 a72, v233
    v_accvgpr_read_b32 v234, a73
    v_mul_f32 v234, v234, v232
    v_accvgpr_write_b32 a73, v234
    v_accvgpr_read_b32 v235, a74
    v_mul_f32 v235, v235, v232
    v_accvgpr_write_b32 a74, v235
    v_accvgpr_read_b32 v236, a75
    v_mul_f32 v236, v236, v232
    v_accvgpr_write_b32 a75, v236
    v_accvgpr_read_b32 v233, a76
    v_mul_f32 v233, v233, v232
    v_accvgpr_write_b32 a76, v233
    v_accvgpr_read_b32 v234, a77
    v_mul_f32 v234, v234, v232
    v_accvgpr_write_b32 a77, v234
    v_accvgpr_read_b32 v235, a78
    v_mul_f32 v235, v235, v232
    v_accvgpr_write_b32 a78, v235
    v_accvgpr_read_b32 v236, a79
    v_mul_f32 v236, v236, v232
    v_accvgpr_write_b32 a79, v236
    v_accvgpr_read_b32 v233, a80
    v_mul_f32 v233, v233, v232
    v_accvgpr_write_b32 a80, v233
    v_accvgpr_read_b32 v234, a81
    v_mul_f32 v234, v234, v232
    v_accvgpr_write_b32 a81, v234
    v_accvgpr_read_b32 v235, a82
    v_mul_f32 v235, v235, v232
    v_accvgpr_write_b32 a82, v235
    v_accvgpr_read_b32 v236, a83
    v_mul_f32 v236, v236, v232
    v_accvgpr_write_b32 a83, v236
    v_accvgpr_read_b32 v233, a84
    v_mul_f32 v233, v233, v232
    v_accvgpr_write_b32 a84, v233
    v_accvgpr_read_b32 v234, a85
    v_mul_f32 v234, v234, v232
    v_accvgpr_write_b32 a85, v234
    v_accvgpr_read_b32 v235, a86
    v_mul_f32 v235, v235, v232
    v_accvgpr_write_b32 a86, v235
    v_accvgpr_read_b32 v236, a87
    v_mul_f32 v236, v236, v232
    v_accvgpr_write_b32 a87, v236
    v_accvgpr_read_b32 v233, a88
    v_mul_f32 v233, v233, v232
    v_accvgpr_write_b32 a88, v233
    v_accvgpr_read_b32 v234, a89
    v_mul_f32 v234, v234, v232
    v_accvgpr_write_b32 a89, v234
    v_accvgpr_read_b32 v235, a90
    v_mul_f32 v235, v235, v232
    v_accvgpr_write_b32 a90, v235
    v_accvgpr_read_b32 v236, a91
    v_mul_f32 v236, v236, v232
    v_accvgpr_write_b32 a91, v236
    v_accvgpr_read_b32 v233, a92
    v_mul_f32 v233, v233, v232
    v_accvgpr_write_b32 a92, v233
    v_accvgpr_read_b32 v234, a93
    v_mul_f32 v234, v234, v232
    v_accvgpr_write_b32 a93, v234
    v_accvgpr_read_b32 v235, a94
    v_mul_f32 v235, v235, v232
    v_accvgpr_write_b32 a94, v235
    v_accvgpr_read_b32 v236, a95
    v_mul_f32 v236, v236, v232
    v_accvgpr_write_b32 a95, v236
    v_exp_f32 v128, v48
    v_exp_f32 v129, v49
    v_exp_f32 v130, v50
    v_exp_f32 v131, v51
    v_exp_f32 v132, v52
    v_exp_f32 v133, v53
    v_exp_f32 v134, v54
    v_exp_f32 v135, v55
    s_nop 0
    v_cvt_pk_bf16_f32 v120, v128, v129
    v_cvt_pk_bf16_f32 v121, v130, v131
    v_cvt_pk_bf16_f32 v122, v132, v133
    v_cvt_pk_bf16_f32 v123, v134, v135
    v_max3_f32 v230, v56, v57, v58
    v_max3_f32 v230, v230, v59, v60
    v_max3_f32 v230, v230, v61, v62
    v_max_f32 v230, v230, v63
    v_mov_b32 v231, v230
    s_nop 1
    v_permlane16_swap_b32 v230, v231
    s_nop 0
    v_max_f32 v230, v230, v231
    v_mov_b32 v231, v230
    s_nop 1
    v_permlane32_swap_b32 v230, v231
    s_nop 0
    v_max_f32 v230, v230, v231
    v_add_f32 v230, 0x41800000, v230
    v_max_f32 v230, 0, v230
    v_sub_f32 v232, 0, v230
    v_exp_f32 v232, v232
    v_sub_f32 v227, v227, v230
    v_sub_f32 v88, v88, v230
    v_sub_f32 v24, v24, v230
    v_sub_f32 v56, v56, v230
    v_sub_f32 v89, v89, v230
    v_sub_f32 v25, v25, v230
    v_sub_f32 v57, v57, v230
    v_sub_f32 v90, v90, v230
    v_sub_f32 v26, v26, v230
    v_sub_f32 v58, v58, v230
    v_sub_f32 v91, v91, v230
    v_sub_f32 v27, v27, v230
    v_sub_f32 v59, v59, v230
    v_sub_f32 v92, v92, v230
    v_sub_f32 v28, v28, v230
    v_sub_f32 v60, v60, v230
    v_sub_f32 v93, v93, v230
    v_sub_f32 v29, v29, v230
    v_sub_f32 v61, v61, v230
    v_sub_f32 v94, v94, v230
    v_sub_f32 v30, v30, v230
    v_sub_f32 v62, v62, v230
    v_sub_f32 v95, v95, v230
    v_sub_f32 v31, v31, v230
    v_sub_f32 v63, v63, v230
    v_mul_f32 v156, v156, v232
    v_mul_f32 v157, v157, v232
    v_mul_f32 v158, v158, v232
    v_mul_f32 v159, v159, v232
    v_accvgpr_read_b32 v233, a96
    v_mul_f32 v233, v233, v232
    v_accvgpr_write_b32 a96, v233
    v_accvgpr_read_b32 v234, a97
    v_mul_f32 v234, v234, v232
    v_accvgpr_write_b32 a97, v234
    v_accvgpr_read_b32 v235, a98
    v_mul_f32 v235, v235, v232
    v_accvgpr_write_b32 a98, v235
    v_accvgpr_read_b32 v236, a99
    v_mul_f32 v236, v236, v232
    v_accvgpr_write_b32 a99, v236
    v_accvgpr_read_b32 v233, a100
    v_mul_f32 v233, v233, v232
    v_accvgpr_write_b32 a100, v233
    v_accvgpr_read_b32 v234, a101
    v_mul_f32 v234, v234, v232
    v_accvgpr_write_b32 a101, v234
    v_accvgpr_read_b32 v235, a102
    v_mul_f32 v235, v235, v232
    v_accvgpr_write_b32 a102, v235
    v_accvgpr_read_b32 v236, a103
    v_mul_f32 v236, v236, v232
    v_accvgpr_write_b32 a103, v236
    v_accvgpr_read_b32 v233, a104
    v_mul_f32 v233, v233, v232
    v_accvgpr_write_b32 a104, v233
    v_accvgpr_read_b32 v234, a105
    v_mul_f32 v234, v234, v232
    v_accvgpr_write_b32 a105, v234
    v_accvgpr_read_b32 v235, a106
    v_mul_f32 v235, v235, v232
    v_accvgpr_write_b32 a106, v235
    v_accvgpr_read_b32 v236, a107
    v_mul_f32 v236, v236, v232
    v_accvgpr_write_b32 a107, v236
    v_accvgpr_read_b32 v233, a108
    v_mul_f32 v233, v233, v232
    v_accvgpr_write_b32 a108, v233
    v_accvgpr_read_b32 v234, a109
    v_mul_f32 v234, v234, v232
    v_accvgpr_write_b32 a109, v234
    v_accvgpr_read_b32 v235, a110
    v_mul_f32 v235, v235, v232
    v_accvgpr_write_b32 a110, v235
    v_accvgpr_read_b32 v236, a111
    v_mul_f32 v236, v236, v232
    v_accvgpr_write_b32 a111, v236
    v_accvgpr_read_b32 v233, a112
    v_mul_f32 v233, v233, v232
    v_accvgpr_write_b32 a112, v233
    v_accvgpr_read_b32 v234, a113
    v_mul_f32 v234, v234, v232
    v_accvgpr_write_b32 a113, v234
    v_accvgpr_read_b32 v235, a114
    v_mul_f32 v235, v235, v232
    v_accvgpr_write_b32 a114, v235
    v_accvgpr_read_b32 v236, a115
    v_mul_f32 v236, v236, v232
    v_accvgpr_write_b32 a115, v236
    v_accvgpr_read_b32 v233, a116
    v_mul_f32 v233, v233, v232
    v_accvgpr_write_b32 a116, v233
    v_accvgpr_read_b32 v234, a117
    v_mul_f32 v234, v234, v232
    v_accvgpr_write_b32 a117, v234
    v_accvgpr_read_b32 v235, a118
    v_mul_f32 v235, v235, v232
    v_accvgpr_write_b32 a118, v235
    v_accvgpr_read_b32 v236, a119
    v_mul_f32 v236, v236, v232
    v_accvgpr_write_b32 a119, v236
    v_accvgpr_read_b32 v233, a120
    v_mul_f32 v233, v233, v232
    v_accvgpr_write_b32 a120, v233
    v_accvgpr_read_b32 v234, a121
    v_mul_f32 v234, v234, v232
    v_accvgpr_write_b32 a121, v234
    v_accvgpr_read_b32 v235, a122
    v_mul_f32 v235, v235, v232
    v_accvgpr_write_b32 a122, v235
    v_accvgpr_read_b32 v236, a123
    v_mul_f32 v236, v236, v232
    v_accvgpr_write_b32 a123, v236
    v_accvgpr_read_b32 v233, a124
    v_mul_f32 v233, v233, v232
    v_accvgpr_write_b32 a124, v233
    v_accvgpr_read_b32 v234, a125
    v_mul_f32 v234, v234, v232
    v_accvgpr_write_b32 a125, v234
    v_accvgpr_read_b32 v235, a126
    v_mul_f32 v235, v235, v232
    v_accvgpr_write_b32 a126, v235
    v_accvgpr_read_b32 v236, a127
    v_mul_f32 v236, v236, v232
    v_accvgpr_write_b32 a127, v236
    v_exp_f32 v128, v56
    v_exp_f32 v129, v57
    v_exp_f32 v130, v58
    v_exp_f32 v131, v59
    v_exp_f32 v132, v60
    v_exp_f32 v133, v61
    v_exp_f32 v134, v62
    v_exp_f32 v135, v63
    s_nop 0
    v_cvt_pk_bf16_f32 v124, v128, v129
    v_cvt_pk_bf16_f32 v125, v130, v131
    v_cvt_pk_bf16_f32 v126, v132, v133
    v_cvt_pk_bf16_f32 v127, v134, v135
    s_nop 1
    s_branch kf_rr13
kf_rare18:
    s_nop 15
    v_max3_f32 v230, v16, v17, v18
    v_max3_f32 v230, v230, v19, v20
    v_max3_f32 v230, v230, v21, v22
    v_max_f32 v230, v230, v23
    v_mov_b32 v231, v230
    s_nop 1
    v_permlane16_swap_b32 v230, v231
    s_nop 0
    v_max_f32 v230, v230, v231
    v_mov_b32 v231, v230
    s_nop 1
    v_permlane32_swap_b32 v230, v231
    s_nop 0
    v_max_f32 v230, v230, v231
    v_add_f32 v230, 0x41800000, v230
    v_max_f32 v230, 0, v230
    v_sub_f32 v232, 0, v230
    v_exp_f32 v232, v232
    v_sub_f32 v226, v226, v230
    v_sub_f32 v80, v80, v230
    v_sub_f32 v48, v48, v230
    v_sub_f32 v16, v16, v230
    v_sub_f32 v81, v81, v230
    v_sub_f32 v49, v49, v230
    v_sub_f32 v17, v17, v230
    v_sub_f32 v82, v82, v230
    v_sub_f32 v50, v50, v230
    v_sub_f32 v18, v18, v230
    v_sub_f32 v83, v83, v230
    v_sub_f32 v51, v51, v230
    v_sub_f32 v19, v19, v230
    v_sub_f32 v84, v84, v230
    v_sub_f32 v52, v52, v230
    v_sub_f32 v20, v20, v230
    v_sub_f32 v85, v85, v230
    v_sub_f32 v53, v53, v230
    v_sub_f32 v21, v21, v230
    v_sub_f32 v86, v86, v230
    v_sub_f32 v54, v54, v230
    v_sub_f32 v22, v22, v230
    v_sub_f32 v87, v87, v230
    v_sub_f32 v55, v55, v230
    v_sub_f32 v23, v23, v230
    v_mul_f32 v152, v152, v232
    v_mul_f32 v153, v153, v232
    v_mul_f32 v154, v154, v232
    v_mul_f32 v155, v155, v232
    v_accvgpr_read_b32 v233, a64
    v_mul_f32 v233, v233, v232
    v_accvgpr_write_b32 a64, v233
    v_accvgpr_read_b32 v234, a65
    v_mul_f32 v234, v234, v232
    v_accvgpr_write_b32 a65, v234
    v_accvgpr_read_b32 v235, a66
    v_mul_f32 v235, v235, v232
    v_accvgpr_write_b32 a66, v235
    v_accvgpr_read_b32 v236, a67
    v_mul_f32 v236, v236, v232
    v_accvgpr_write_b32 a67, v236
    v_accvgpr_read_b32 v233, a68
    v_mul_f32 v233, v233, v232
    v_accvgpr_write_b32 a68, v233
    v_accvgpr_read_b32 v234, a69
    v_mul_f32 v234, v234, v232
    v_accvgpr_write_b32 a69, v234
    v_accvgpr_read_b32 v235, a70
    v_mul_f32 v235, v235, v232
    v_accvgpr_write_b32 a70, v235
    v_accvgpr_read_b32 v236, a71
    v_mul_f32 v236, v236, v232
    v_accvgpr_write_b32 a71, v236
    v_accvgpr_read_b32 v233, a72
    v_mul_f32 v233, v233, v232
    v_accvgpr_write_b32 a72, v233
    v_accvgpr_read_b32 v234, a73
    v_mul_f32 v234, v234, v232
    v_accvgpr_write_b32 a73, v234
    v_accvgpr_read_b32 v235, a74
    v_mul_f32 v235, v235, v232
    v_accvgpr_write_b32 a74, v235
    v_accvgpr_read_b32 v236, a75
    v_mul_f32 v236, v236, v232
    v_accvgpr_write_b32 a75, v236
    v_accvgpr_read_b32 v233, a76
    v_mul_f32 v233, v233, v232
    v_accvgpr_write_b32 a76, v233
    v_accvgpr_read_b32 v234, a77
    v_mul_f32 v234, v234, v232
    v_accvgpr_write_b32 a77, v234
    v_accvgpr_read_b32 v235, a78
    v_mul_f32 v235, v235, v232
    v_accvgpr_write_b32 a78, v235
    v_accvgpr_read_b32 v236, a79
    v_mul_f32 v236, v236, v232
    v_accvgpr_write_b32 a79, v236
    v_accvgpr_read_b32 v233, a80
    v_mul_f32 v233, v233, v232
    v_accvgpr_write_b32 a80, v233
    v_accvgpr_read_b32 v234, a81
    v_mul_f32 v234, v234, v232
    v_accvgpr_write_b32 a81, v234
    v_accvgpr_read_b32 v235, a82
    v_mul_f32 v235, v235, v232
    v_accvgpr_write_b32 a82, v235
    v_accvgpr_read_b32 v236, a83
    v_mul_f32 v236, v236, v232
    v_accvgpr_write_b32 a83, v236
    v_accvgpr_read_b32 v233, a84
    v_mul_f32 v233, v233, v232
    v_accvgpr_write_b32 a84, v233
    v_accvgpr_read_b32 v234, a85
    v_mul_f32 v234, v234, v232
    v_accvgpr_write_b32 a85, v234
    v_accvgpr_read_b32 v235, a86
    v_mul_f32 v235, v235, v232
    v_accvgpr_write_b32 a86, v235
    v_accvgpr_read_b32 v236, a87
    v_mul_f32 v236, v236, v232
    v_accvgpr_write_b32 a87, v236
    v_accvgpr_read_b32 v233, a88
    v_mul_f32 v233, v233, v232
    v_accvgpr_write_b32 a88, v233
    v_accvgpr_read_b32 v234, a89
    v_mul_f32 v234, v234, v232
    v_accvgpr_write_b32 a89, v234
    v_accvgpr_read_b32 v235, a90
    v_mul_f32 v235, v235, v232
    v_accvgpr_write_b32 a90, v235
    v_accvgpr_read_b32 v236, a91
    v_mul_f32 v236, v236, v232
    v_accvgpr_write_b32 a91, v236
    v_accvgpr_read_b32 v233, a92
    v_mul_f32 v233, v233, v232
    v_accvgpr_write_b32 a92, v233
    v_accvgpr_read_b32 v234, a93
    v_mul_f32 v234, v234, v232
    v_accvgpr_write_b32 a93, v234
    v_accvgpr_read_b32 v235, a94
    v_mul_f32 v235, v235, v232
    v_accvgpr_write_b32 a94, v235
    v_accvgpr_read_b32 v236, a95
    v_mul_f32 v236, v236, v232
    v_accvgpr_write_b32 a95, v236
    v_exp_f32 v128, v16
    v_exp_f32 v129, v17
    v_exp_f32 v130, v18
    v_exp_f32 v131, v19
    v_exp_f32 v132, v20
    v_exp_f32 v133, v21
    v_exp_f32 v134, v22
    v_exp_f32 v135, v23
    s_nop 0
    v_cvt_pk_bf16_f32 v104, v128, v129
    v_cvt_pk_bf16_f32 v105, v130, v131
    v_cvt_pk_bf16_f32 v106, v132, v133
    v_cvt_pk_bf16_f32 v107, v134, v135
    v_max3_f32 v230, v24, v25, v26
    v_max3_f32 v230, v230, v27, v28
    v_max3_f32 v230, v230, v29, v30
    v_max_f32 v230, v230, v31
    v_mov_b32 v231, v230
    s_nop 1
    v_permlane16_swap_b32 v230, v231
    s_nop 0
    v_max_f32 v230, v230, v231
    v_mov_b32 v231, v230
    s_nop 1
    v_permlane32_swap_b32 v230, v231
    s_nop 0
    v_max_f32 v230, v230, v231
    v_add_f32 v230, 0x41800000, v230
    v_max_f32 v230, 0, v230
    v_sub_f32 v232, 0, v230
    v_exp_f32 v232, v232
    v_sub_f32 v227, v227, v230
    v_sub_f32 v88, v88, v230
    v_sub_f32 v56, v56, v230
    v_sub_f32 v24, v24, v230
    v_sub_f32 v89, v89, v230
    v_sub_f32 v57, v57, v230
    v_sub_f32 v25, v25, v230
    v_sub_f32 v90, v90, v230
    v_sub_f32 v58, v58, v230
    v_sub_f32 v26, v26, v230
    v_sub_f32 v91, v91, v230
    v_sub_f32 v59, v59, v230
    v_sub_f32 v27, v27, v230
    v_sub_f32 v92, v92, v230
    v_sub_f32 v60, v60, v230
    v_sub_f32 v28, v28, v230
    v_sub_f32 v93, v93, v230
    v_sub_f32 v61, v61, v230
    v_sub_f32 v29, v29, v230
    v_sub_f32 v94, v94, v230
    v_sub_f32 v62, v62, v230
    v_sub_f32 v30, v30, v230
    v_sub_f32 v95, v95, v230
    v_sub_f32 v63, v63, v230
    v_sub_f32 v31, v31, v230
    v_mul_f32 v156, v156, v232
    v_mul_f32 v157, v157, v232
    v_mul_f32 v158, v158, v232
    v_mul_f32 v159, v159, v232
    v_accvgpr_read_b32 v233, a96
    v_mul_f32 v233, v233, v232
    v_accvgpr_write_b32 a96, v233
    v_accvgpr_read_b32 v234, a97
    v_mul_f32 v234, v234, v232
    v_accvgpr_write_b32 a97, v234
    v_accvgpr_read_b32 v235, a98
    v_mul_f32 v235, v235, v232
    v_accvgpr_write_b32 a98, v235
    v_accvgpr_read_b32 v236, a99
    v_mul_f32 v236, v236, v232
    v_accvgpr_write_b32 a99, v236
    v_accvgpr_read_b32 v233, a100
    v_mul_f32 v233, v233, v232
    v_accvgpr_write_b32 a100, v233
    v_accvgpr_read_b32 v234, a101
    v_mul_f32 v234, v234, v232
    v_accvgpr_write_b32 a101, v234
    v_accvgpr_read_b32 v235, a102
    v_mul_f32 v235, v235, v232
    v_accvgpr_write_b32 a102, v235
    v_accvgpr_read_b32 v236, a103
    v_mul_f32 v236, v236, v232
    v_accvgpr_write_b32 a103, v236
    v_accvgpr_read_b32 v233, a104
    v_mul_f32 v233, v233, v232
    v_accvgpr_write_b32 a104, v233
    v_accvgpr_read_b32 v234, a105
    v_mul_f32 v234, v234, v232
    v_accvgpr_write_b32 a105, v234
    v_accvgpr_read_b32 v235, a106
    v_mul_f32 v235, v235, v232
    v_accvgpr_write_b32 a106, v235
    v_accvgpr_read_b32 v236, a107
    v_mul_f32 v236, v236, v232
    v_accvgpr_write_b32 a107, v236
    v_accvgpr_read_b32 v233, a108
    v_mul_f32 v233, v233, v232
    v_accvgpr_write_b32 a108, v233
    v_accvgpr_read_b32 v234, a109
    v_mul_f32 v234, v234, v232
    v_accvgpr_write_b32 a109, v234
    v_accvgpr_read_b32 v235, a110
    v_mul_f32 v235, v235, v232
    v_accvgpr_write_b32 a110, v235
    v_accvgpr_read_b32 v236, a111
    v_mul_f32 v236, v236, v232
    v_accvgpr_write_b32 a111, v236
    v_accvgpr_read_b32 v233, a112
    v_mul_f32 v233, v233, v232
    v_accvgpr_write_b32 a112, v233
    v_accvgpr_read_b32 v234, a113
    v_mul_f32 v234, v234, v232
    v_accvgpr_write_b32 a113, v234
    v_accvgpr_read_b32 v235, a114
    v_mul_f32 v235, v235, v232
    v_accvgpr_write_b32 a114, v235
    v_accvgpr_read_b32 v236, a115
    v_mul_f32 v236, v236, v232
    v_accvgpr_write_b32 a115, v236
    v_accvgpr_read_b32 v233, a116
    v_mul_f32 v233, v233, v232
    v_accvgpr_write_b32 a116, v233
    v_accvgpr_read_b32 v234, a117
    v_mul_f32 v234, v234, v232
    v_accvgpr_write_b32 a117, v234
    v_accvgpr_read_b32 v235, a118
    v_mul_f32 v235, v235, v232
    v_accvgpr_write_b32 a118, v235
    v_accvgpr_read_b32 v236, a119
    v_mul_f32 v236, v236, v232
    v_accvgpr_write_b32 a119, v236
    v_accvgpr_read_b32 v233, a120
    v_mul_f32 v233, v233, v232
    v_accvgpr_write_b32 a120, v233
    v_accvgpr_read_b32 v234, a121
    v_mul_f32 v234, v234, v232
    v_accvgpr_write_b32 a121, v234
    v_accvgpr_read_b32 v235, a122
    v_mul_f32 v235, v235, v232
    v_accvgpr_write_b32 a122, v235
    v_accvgpr_read_b32 v236, a123
    v_mul_f32 v236, v236, v232
    v_accvgpr_write_b32 a123, v236
    v_accvgpr_read_b32 v233, a124
    v_mul_f32 v233, v233, v232
    v_accvgpr_write_b32 a124, v233
    v_accvgpr_read_b32 v234, a125
    v_mul_f32 v234, v234, v232
    v_accvgpr_write_b32 a125, v234
    v_accvgpr_read_b32 v235, a126
    v_mul_f32 v235, v235, v232
    v_accvgpr_write_b32 a126, v235
    v_accvgpr_read_b32 v236, a127
    v_mul_f32 v236, v236, v232
    v_accvgpr_write_b32 a127, v236
    v_exp_f32 v128, v24
    v_exp_f32 v129, v25
    v_exp_f32 v130, v26
    v_exp_f32 v131, v27
    v_exp_f32 v132, v28
    v_exp_f32 v133, v29
    v_exp_f32 v134, v30
    v_exp_f32 v135, v31
    s_nop 0
    v_cvt_pk_bf16_f32 v108, v128, v129
    v_cvt_pk_bf16_f32 v109, v130, v131
    v_cvt_pk_bf16_f32 v110, v132, v133
    v_cvt_pk_bf16_f32 v111, v134, v135
    s_nop 1
    s_branch kf_rr17
kf_rare22:
    s_nop 15
    v_max3_f32 v230, v48, v49, v50
    v_max3_f32 v230, v230, v51, v52
    v_max3_f32 v230, v230, v53, v54
    v_max_f32 v230, v230, v55
    v_mov_b32 v231, v230
    s_nop 1
    v_permlane16_swap_b32 v230, v231
    s_nop 0
    v_max_f32 v230, v230, v231
    v_mov_b32 v231, v230
    s_nop 1
    v_permlane32_swap_b32 v230, v231
    s_nop 0
    v_max_f32 v230, v230, v231
    v_add_f32 v230, 0x41800000, v230
    v_max_f32 v230, 0, v230
    v_sub_f32 v232, 0, v230
    v_exp_f32 v232, v232
    v_sub_f32 v226, v226, v230
    v_sub_f32 v80, v80, v230
    v_sub_f32 v16, v16, v230
    v_sub_f32 v48, v48, v230
    v_sub_f32 v81, v81, v230
    v_sub_f32 v17, v17, v230
    v_sub_f32 v49, v49, v230
    v_sub_f32 v82, v82, v230
    v_sub_f32 v18, v18, v230
    v_sub_f32 v50, v50, v230
    v_sub_f32 v83, v83, v230
    v_sub_f32 v19, v19, v230
    v_sub_f32 v51, v51, v230
    v_sub_f32 v84, v84, v230
    v_sub_f32 v20, v20, v230
    v_sub_f32 v52, v52, v230
    v_sub_f32 v85, v85, v230
    v_sub_f32 v21, v21, v230
    v_sub_f32 v53, v53, v230
    v_sub_f32 v86, v86, v230
    v_sub_f32 v22, v22, v230
    v_sub_f32 v54, v54, v230
    v_sub_f32 v87, v87, v230
    v_sub_f32 v23, v23, v230
    v_sub_f32 v55, v55, v230
    v_mul_f32 v152, v152, v232
    v_mul_f32 v153, v153, v232
    v_mul_f32 v154, v154, v232
    v_mul_f32 v155, v155, v232
    v_accvgpr_read_b32 v233, a64
    v_mul_f32 v233, v233, v232
    v_accvgpr_write_b32 a64, v233
    v_accvgpr_read_b32 v234, a65
    v_mul_f32 v234, v234, v232
    v_accvgpr_write_b32 a65, v234
    v_accvgpr_read_b32 v235, a66
    v_mul_f32 v235, v235, v232
    v_accvgpr_write_b32 a66, v235
    v_accvgpr_read_b32 v236, a67
    v_mul_f32 v236, v236, v232
    v_accvgpr_write_b32 a67, v236
    v_accvgpr_read_b32 v233, a68
    v_mul_f32 v233, v233, v232
    v_accvgpr_write_b32 a68, v233
    v_accvgpr_read_b32 v234, a69
    v_mul_f32 v234, v234, v232
    v_accvgpr_write_b32 a69, v234
    v_accvgpr_read_b32 v235, a70
    v_mul_f32 v235, v235, v232
    v_accvgpr_write_b32 a70, v235
    v_accvgpr_read_b32 v236, a71
    v_mul_f32 v236, v236, v232
    v_accvgpr_write_b32 a71, v236
    v_accvgpr_read_b32 v233, a72
    v_mul_f32 v233, v233, v232
    v_accvgpr_write_b32 a72, v233
    v_accvgpr_read_b32 v234, a73
    v_mul_f32 v234, v234, v232
    v_accvgpr_write_b32 a73, v234
    v_accvgpr_read_b32 v235, a74
    v_mul_f32 v235, v235, v232
    v_accvgpr_write_b32 a74, v235
    v_accvgpr_read_b32 v236, a75
    v_mul_f32 v236, v236, v232
    v_accvgpr_write_b32 a75, v236
    v_accvgpr_read_b32 v233, a76
    v_mul_f32 v233, v233, v232
    v_accvgpr_write_b32 a76, v233
    v_accvgpr_read_b32 v234, a77
    v_mul_f32 v234, v234, v232
    v_accvgpr_write_b32 a77, v234
    v_accvgpr_read_b32 v235, a78
    v_mul_f32 v235, v235, v232
    v_accvgpr_write_b32 a78, v235
    v_accvgpr_read_b32 v236, a79
    v_mul_f32 v236, v236, v232
    v_accvgpr_write_b32 a79, v236
    v_accvgpr_read_b32 v233, a80
    v_mul_f32 v233, v233, v232
    v_accvgpr_write_b32 a80, v233
    v_accvgpr_read_b32 v234, a81
    v_mul_f32 v234, v234, v232
    v_accvgpr_write_b32 a81, v234
    v_accvgpr_read_b32 v235, a82
    v_mul_f32 v235, v235, v232
    v_accvgpr_write_b32 a82, v235
    v_accvgpr_read_b32 v236, a83
    v_mul_f32 v236, v236, v232
    v_accvgpr_write_b32 a83, v236
    v_accvgpr_read_b32 v233, a84
    v_mul_f32 v233, v233, v232
    v_accvgpr_write_b32 a84, v233
    v_accvgpr_read_b32 v234, a85
    v_mul_f32 v234, v234, v232
    v_accvgpr_write_b32 a85, v234
    v_accvgpr_read_b32 v235, a86
    v_mul_f32 v235, v235, v232
    v_accvgpr_write_b32 a86, v235
    v_accvgpr_read_b32 v236, a87
    v_mul_f32 v236, v236, v232
    v_accvgpr_write_b32 a87, v236
    v_accvgpr_read_b32 v233, a88
    v_mul_f32 v233, v233, v232
    v_accvgpr_write_b32 a88, v233
    v_accvgpr_read_b32 v234, a89
    v_mul_f32 v234, v234, v232
    v_accvgpr_write_b32 a89, v234
    v_accvgpr_read_b32 v235, a90
    v_mul_f32 v235, v235, v232
    v_accvgpr_write_b32 a90, v235
    v_accvgpr_read_b32 v236, a91
    v_mul_f32 v236, v236, v232
    v_accvgpr_write_b32 a91, v236
    v_accvgpr_read_b32 v233, a92
    v_mul_f32 v233, v233, v232
    v_accvgpr_write_b32 a92, v233
    v_accvgpr_read_b32 v234, a93
    v_mul_f32 v234, v234, v232
    v_accvgpr_write_b32 a93, v234
    v_accvgpr_read_b32 v235, a94
    v_mul_f32 v235, v235, v232
    v_accvgpr_write_b32 a94, v235
    v_accvgpr_read_b32 v236, a95
    v_mul_f32 v236, v236, v232
    v_accvgpr_write_b32 a95, v236
    v_exp_f32 v128, v48
    v_exp_f32 v129, v49
    v_exp_f32 v130, v50
    v_exp_f32 v131, v51
    v_exp_f32 v132, v52
    v_exp_f32 v133, v53
    v_exp_f32 v134, v54
    v_exp_f32 v135, v55
    s_nop 0
    v_cvt_pk_bf16_f32 v120, v128, v129
    v_cvt_pk_bf16_f32 v121, v130, v131
    v_cvt_pk_bf16_f32 v122, v132, v133
    v_cvt_pk_bf16_f32 v123, v134, v135
    v_max3_f32 v230, v56, v57, v58
    v_max3_f32 v230, v230, v59, v60
    v_max3_f32 v230, v230, v61, v62
    v_max_f32 v230, v230, v63
    v_mov_b32 v231, v230
    s_nop 1
    v_permlane16_swap_b32 v230, v231
    s_nop 0
    v_max_f32 v230, v230, v231
    v_mov_b32 v231, v230
    s_nop 1
    v_permlane32_swap_b32 v230, v231
    s_nop 0
    v_max_f32 v230, v230, v231
    v_add_f32 v230, 0x41800000, v230
    v_max_f32 v230, 0, v230
    v_sub_f32 v232, 0, v230
    v_exp_f32 v232, v232
    v_sub_f32 v227, v227, v230
    v_sub_f32 v88, v88, v230
    v_sub_f32 v24, v24, v230
    v_sub_f32 v56, v56, v230
    v_sub_f32 v89, v89, v230
    v_sub_f32 v25, v25, v230
    v_sub_f32 v57, v57, v230
    v_sub_f32 v90, v90, v230
    v_sub_f32 v26, v26, v230
    v_sub_f32 v58, v58, v230
    v_sub_f32 v91, v91, v230
    v_sub_f32 v27, v27, v230
    v_sub_f32 v59, v59, v230
    v_sub_f32 v92, v92, v230
    v_sub_f32 v28, v28, v230
    v_sub_f32 v60, v60, v230
    v_sub_f32 v93, v93, v230
    v_sub_f32 v29, v29, v230
    v_sub_f32 v61, v61, v230
    v_sub_f32 v94, v94, v230
    v_sub_f32 v30, v30, v230
    v_sub_f32 v62, v62, v230
    v_sub_f32 v95, v95, v230
    v_sub_f32 v31, v31, v230
    v_sub_f32 v63, v63, v230
    v_mul_f32 v156, v156, v232
    v_mul_f32 v157, v157, v232
    v_mul_f32 v158, v158, v232
    v_mul_f32 v159, v159, v232
    v_accvgpr_read_b32 v233, a96
    v_mul_f32 v233, v233, v232
    v_accvgpr_write_b32 a96, v233
    v_accvgpr_read_b32 v234, a97
    v_mul_f32 v234, v234, v232
    v_accvgpr_write_b32 a97, v234
    v_accvgpr_read_b32 v235, a98
    v_mul_f32 v235, v235, v232
    v_accvgpr_write_b32 a98, v235
    v_accvgpr_read_b32 v236, a99
    v_mul_f32 v236, v236, v232
    v_accvgpr_write_b32 a99, v236
    v_accvgpr_read_b32 v233, a100
    v_mul_f32 v233, v233, v232
    v_accvgpr_write_b32 a100, v233
    v_accvgpr_read_b32 v234, a101
    v_mul_f32 v234, v234, v232
    v_accvgpr_write_b32 a101, v234
    v_accvgpr_read_b32 v235, a102
    v_mul_f32 v235, v235, v232
    v_accvgpr_write_b32 a102, v235
    v_accvgpr_read_b32 v236, a103
    v_mul_f32 v236, v236, v232
    v_accvgpr_write_b32 a103, v236
    v_accvgpr_read_b32 v233, a104
    v_mul_f32 v233, v233, v232
    v_accvgpr_write_b32 a104, v233
    v_accvgpr_read_b32 v234, a105
    v_mul_f32 v234, v234, v232
    v_accvgpr_write_b32 a105, v234
    v_accvgpr_read_b32 v235, a106
    v_mul_f32 v235, v235, v232
    v_accvgpr_write_b32 a106, v235
    v_accvgpr_read_b32 v236, a107
    v_mul_f32 v236, v236, v232
    v_accvgpr_write_b32 a107, v236
    v_accvgpr_read_b32 v233, a108
    v_mul_f32 v233, v233, v232
    v_accvgpr_write_b32 a108, v233
    v_accvgpr_read_b32 v234, a109
    v_mul_f32 v234, v234, v232
    v_accvgpr_write_b32 a109, v234
    v_accvgpr_read_b32 v235, a110
    v_mul_f32 v235, v235, v232
    v_accvgpr_write_b32 a110, v235
    v_accvgpr_read_b32 v236, a111
    v_mul_f32 v236, v236, v232
    v_accvgpr_write_b32 a111, v236
    v_accvgpr_read_b32 v233, a112
    v_mul_f32 v233, v233, v232
    v_accvgpr_write_b32 a112, v233
    v_accvgpr_read_b32 v234, a113
    v_mul_f32 v234, v234, v232
    v_accvgpr_write_b32 a113, v234
    v_accvgpr_read_b32 v235, a114
    v_mul_f32 v235, v235, v232
    v_accvgpr_write_b32 a114, v235
    v_accvgpr_read_b32 v236, a115
    v_mul_f32 v236, v236, v232
    v_accvgpr_write_b32 a115, v236
    v_accvgpr_read_b32 v233, a116
    v_mul_f32 v233, v233, v232
    v_accvgpr_write_b32 a116, v233
    v_accvgpr_read_b32 v234, a117
    v_mul_f32 v234, v234, v232
    v_accvgpr_write_b32 a117, v234
    v_accvgpr_read_b32 v235, a118
    v_mul_f32 v235, v235, v232
    v_accvgpr_write_b32 a118, v235
    v_accvgpr_read_b32 v236, a119
    v_mul_f32 v236, v236, v232
    v_accvgpr_write_b32 a119, v236
    v_accvgpr_read_b32 v233, a120
    v_mul_f32 v233, v233, v232
    v_accvgpr_write_b32 a120, v233
    v_accvgpr_read_b32 v234, a121
    v_mul_f32 v234, v234, v232
    v_accvgpr_write_b32 a121, v234
    v_accvgpr_read_b32 v235, a122
    v_mul_f32 v235, v235, v232
    v_accvgpr_write_b32 a122, v235
    v_accvgpr_read_b32 v236, a123
    v_mul_f32 v236, v236, v232
    v_accvgpr_write_b32 a123, v236
    v_accvgpr_read_b32 v233, a124
    v_mul_f32 v233, v233, v232
    v_accvgpr_write_b32 a124, v233
    v_accvgpr_read_b32 v234, a125
    v_mul_f32 v234, v234, v232
    v_accvgpr_write_b32 a125, v234
    v_accvgpr_read_b32 v235, a126
    v_mul_f32 v235, v235, v232
    v_accvgpr_write_b32 a126, v235
    v_accvgpr_read_b32 v236, a127
    v_mul_f32 v236, v236, v232
    v_accvgpr_write_b32 a127, v236
    v_exp_f32 v128, v56
    v_exp_f32 v129, v57
    v_exp_f32 v130, v58
    v_exp_f32 v131, v59
    v_exp_f32 v132, v60
    v_exp_f32 v133, v61
    v_exp_f32 v134, v62
    v_exp_f32 v135, v63
    s_nop 0
    v_cvt_pk_bf16_f32 v124, v128, v129
    v_cvt_pk_bf16_f32 v125, v130, v131
    v_cvt_pk_bf16_f32 v126, v132, v133
    v_cvt_pk_bf16_f32 v127, v134, v135
    s_nop 1
    s_branch kf_rr21
kf_rare26:
    s_nop 15
    v_max3_f32 v230, v16, v17, v18
    v_max3_f32 v230, v230, v19, v20
    v_max3_f32 v230, v230, v21, v22
    v_max_f32 v230, v230, v23
    v_mov_b32 v231, v230
    s_nop 1
    v_permlane16_swap_b32 v230, v231
    s_nop 0
    v_max_f32 v230, v230, v231
    v_mov_b32 v231, v230
    s_nop 1
    v_permlane32_swap_b32 v230, v231
    s_nop 0
    v_max_f32 v230, v230, v231
    v_add_f32 v230, 0x41800000, v230
    v_max_f32 v230, 0, v230
    v_sub_f32 v232, 0, v230
    v_exp_f32 v232, v232
    v_sub_f32 v226, v226, v230
    v_sub_f32 v80, v80, v230
    v_sub_f32 v48, v48, v230
    v_sub_f32 v16, v16, v230
    v_sub_f32 v81, v81, v230
    v_sub_f32 v49, v49, v230
    v_sub_f32 v17, v17, v230
    v_sub_f32 v82, v82, v230
    v_sub_f32 v50, v50, v230
    v_sub_f32 v18, v18, v230
    v_sub_f32 v83, v83, v230
    v_sub_f32 v51, v51, v230
    v_sub_f32 v19, v19, v230
    v_sub_f32 v84, v84, v230
    v_sub_f32 v52, v52, v230
    v_sub_f32 v20, v20, v230
    v_sub_f32 v85, v85, v230
    v_sub_f32 v53, v53, v230
    v_sub_f32 v21, v21, v230
    v_sub_f32 v86, v86, v230
    v_sub_f32 v54, v54, v230
    v_sub_f32 v22, v22, v230
    v_sub_f32 v87, v87, v230
    v_sub_f32 v55, v55, v230
    v_sub_f32 v23, v23, v230
    v_mul_f32 v152, v152, v232
    v_mul_f32 v153, v153, v232
    v_mul_f32 v154, v154, v232
    v_mul_f32 v155, v155, v232
    v_accvgpr_read_b32 v233, a64
    v_mul_f32 v233, v233, v232
    v_accvgpr_write_b32 a64, v233
    v_accvgpr_read_b32 v234, a65
    v_mul_f32 v234, v234, v232
    v_accvgpr_write_b32 a65, v234
    v_accvgpr_read_b32 v235, a66
    v_mul_f32 v235, v235, v232
    v_accvgpr_write_b32 a66, v235
    v_accvgpr_read_b32 v236, a67
    v_mul_f32 v236, v236, v232
    v_accvgpr_write_b32 a67, v236
    v_accvgpr_read_b32 v233, a68
    v_mul_f32 v233, v233, v232
    v_accvgpr_write_b32 a68, v233
    v_accvgpr_read_b32 v234, a69
    v_mul_f32 v234, v234, v232
    v_accvgpr_write_b32 a69, v234
    v_accvgpr_read_b32 v235, a70
    v_mul_f32 v235, v235, v232
    v_accvgpr_write_b32 a70, v235
    v_accvgpr_read_b32 v236, a71
    v_mul_f32 v236, v236, v232
    v_accvgpr_write_b32 a71, v236
    v_accvgpr_read_b32 v233, a72
    v_mul_f32 v233, v233, v232
    v_accvgpr_write_b32 a72, v233
    v_accvgpr_read_b32 v234, a73
    v_mul_f32 v234, v234, v232
    v_accvgpr_write_b32 a73, v234
    v_accvgpr_read_b32 v235, a74
    v_mul_f32 v235, v235, v232
    v_accvgpr_write_b32 a74, v235
    v_accvgpr_read_b32 v236, a75
    v_mul_f32 v236, v236, v232
    v_accvgpr_write_b32 a75, v236
    v_accvgpr_read_b32 v233, a76
    v_mul_f32 v233, v233, v232
    v_accvgpr_write_b32 a76, v233
    v_accvgpr_read_b32 v234, a77
    v_mul_f32 v234, v234, v232
    v_accvgpr_write_b32 a77, v234
    v_accvgpr_read_b32 v235, a78
    v_mul_f32 v235, v235, v232
    v_accvgpr_write_b32 a78, v235
    v_accvgpr_read_b32 v236, a79
    v_mul_f32 v236, v236, v232
    v_accvgpr_write_b32 a79, v236
    v_accvgpr_read_b32 v233, a80
    v_mul_f32 v233, v233, v232
    v_accvgpr_write_b32 a80, v233
    v_accvgpr_read_b32 v234, a81
    v_mul_f32 v234, v234, v232
    v_accvgpr_write_b32 a81, v234
    v_accvgpr_read_b32 v235, a82
    v_mul_f32 v235, v235, v232
    v_accvgpr_write_b32 a82, v235
    v_accvgpr_read_b32 v236, a83
    v_mul_f32 v236, v236, v232
    v_accvgpr_write_b32 a83, v236
    v_accvgpr_read_b32 v233, a84
    v_mul_f32 v233, v233, v232
    v_accvgpr_write_b32 a84, v233
    v_accvgpr_read_b32 v234, a85
    v_mul_f32 v234, v234, v232
    v_accvgpr_write_b32 a85, v234
    v_accvgpr_read_b32 v235, a86
    v_mul_f32 v235, v235, v232
    v_accvgpr_write_b32 a86, v235
    v_accvgpr_read_b32 v236, a87
    v_mul_f32 v236, v236, v232
    v_accvgpr_write_b32 a87, v236
    v_accvgpr_read_b32 v233, a88
    v_mul_f32 v233, v233, v232
    v_accvgpr_write_b32 a88, v233
    v_accvgpr_read_b32 v234, a89
    v_mul_f32 v234, v234, v232
    v_accvgpr_write_b32 a89, v234
    v_accvgpr_read_b32 v235, a90
    v_mul_f32 v235, v235, v232
    v_accvgpr_write_b32 a90, v235
    v_accvgpr_read_b32 v236, a91
    v_mul_f32 v236, v236, v232
    v_accvgpr_write_b32 a91, v236
    v_accvgpr_read_b32 v233, a92
    v_mul_f32 v233, v233, v232
    v_accvgpr_write_b32 a92, v233
    v_accvgpr_read_b32 v234, a93
    v_mul_f32 v234, v234, v232
    v_accvgpr_write_b32 a93, v234
    v_accvgpr_read_b32 v235, a94
    v_mul_f32 v235, v235, v232
    v_accvgpr_write_b32 a94, v235
    v_accvgpr_read_b32 v236, a95
    v_mul_f32 v236, v236, v232
    v_accvgpr_write_b32 a95, v236
    v_exp_f32 v128, v16
    v_exp_f32 v129, v17
    v_exp_f32 v130, v18
    v_exp_f32 v131, v19
    v_exp_f32 v132, v20
    v_exp_f32 v133, v21
    v_exp_f32 v134, v22
    v_exp_f32 v135, v23
    s_nop 0
    v_cvt_pk_bf16_f32 v104, v128, v129
    v_cvt_pk_bf16_f32 v105, v130, v131
    v_cvt_pk_bf16_f32 v106, v132, v133
    v_cvt_pk_bf16_f32 v107, v134, v135
    v_max3_f32 v230, v24, v25, v26
    v_max3_f32 v230, v230, v27, v28
    v_max3_f32 v230, v230, v29, v30
    v_max_f32 v230, v230, v31
    v_mov_b32 v231, v230
    s_nop 1
    v_permlane16_swap_b32 v230, v231
    s_nop 0
    v_max_f32 v230, v230, v231
    v_mov_b32 v231, v230
    s_nop 1
    v_permlane32_swap_b32 v230, v231
    s_nop 0
    v_max_f32 v230, v230, v231
    v_add_f32 v230, 0x41800000, v230
    v_max_f32 v230, 0, v230
    v_sub_f32 v232, 0, v230
    v_exp_f32 v232, v232
    v_sub_f32 v227, v227, v230
    v_sub_f32 v88, v88, v230
    v_sub_f32 v56, v56, v230
    v_sub_f32 v24, v24, v230
    v_sub_f32 v89, v89, v230
    v_sub_f32 v57, v57, v230
    v_sub_f32 v25, v25, v230
    v_sub_f32 v90, v90, v230
    v_sub_f32 v58, v58, v230
    v_sub_f32 v26, v26, v230
    v_sub_f32 v91, v91, v230
    v_sub_f32 v59, v59, v230
    v_sub_f32 v27, v27, v230
    v_sub_f32 v92, v92, v230
    v_sub_f32 v60, v60, v230
    v_sub_f32 v28, v28, v230
    v_sub_f32 v93, v93, v230
    v_sub_f32 v61, v61, v230
    v_sub_f32 v29, v29, v230
    v_sub_f32 v94, v94, v230
    v_sub_f32 v62, v62, v230
    v_sub_f32 v30, v30, v230
    v_sub_f32 v95, v95, v230
    v_sub_f32 v63, v63, v230
    v_sub_f32 v31, v31, v230
    v_mul_f32 v156, v156, v232
    v_mul_f32 v157, v157, v232
    v_mul_f32 v158, v158, v232
    v_mul_f32 v159, v159, v232
    v_accvgpr_read_b32 v233, a96
    v_mul_f32 v233, v233, v232
    v_accvgpr_write_b32 a96, v233
    v_accvgpr_read_b32 v234, a97
    v_mul_f32 v234, v234, v232
    v_accvgpr_write_b32 a97, v234
    v_accvgpr_read_b32 v235, a98
    v_mul_f32 v235, v235, v232
    v_accvgpr_write_b32 a98, v235
    v_accvgpr_read_b32 v236, a99
    v_mul_f32 v236, v236, v232
    v_accvgpr_write_b32 a99, v236
    v_accvgpr_read_b32 v233, a100
    v_mul_f32 v233, v233, v232
    v_accvgpr_write_b32 a100, v233
    v_accvgpr_read_b32 v234, a101
    v_mul_f32 v234, v234, v232
    v_accvgpr_write_b32 a101, v234
    v_accvgpr_read_b32 v235, a102
    v_mul_f32 v235, v235, v232
    v_accvgpr_write_b32 a102, v235
    v_accvgpr_read_b32 v236, a103
    v_mul_f32 v236, v236, v232
    v_accvgpr_write_b32 a103, v236
    v_accvgpr_read_b32 v233, a104
    v_mul_f32 v233, v233, v232
    v_accvgpr_write_b32 a104, v233
    v_accvgpr_read_b32 v234, a105
    v_mul_f32 v234, v234, v232
    v_accvgpr_write_b32 a105, v234
    v_accvgpr_read_b32 v235, a106
    v_mul_f32 v235, v235, v232
    v_accvgpr_write_b32 a106, v235
    v_accvgpr_read_b32 v236, a107
    v_mul_f32 v236, v236, v232
    v_accvgpr_write_b32 a107, v236
    v_accvgpr_read_b32 v233, a108
    v_mul_f32 v233, v233, v232
    v_accvgpr_write_b32 a108, v233
    v_accvgpr_read_b32 v234, a109
    v_mul_f32 v234, v234, v232
    v_accvgpr_write_b32 a109, v234
    v_accvgpr_read_b32 v235, a110
    v_mul_f32 v235, v235, v232
    v_accvgpr_write_b32 a110, v235
    v_accvgpr_read_b32 v236, a111
    v_mul_f32 v236, v236, v232
    v_accvgpr_write_b32 a111, v236
    v_accvgpr_read_b32 v233, a112
    v_mul_f32 v233, v233, v232
    v_accvgpr_write_b32 a112, v233
    v_accvgpr_read_b32 v234, a113
    v_mul_f32 v234, v234, v232
    v_accvgpr_write_b32 a113, v234
    v_accvgpr_read_b32 v235, a114
    v_mul_f32 v235, v235, v232
    v_accvgpr_write_b32 a114, v235
    v_accvgpr_read_b32 v236, a115
    v_mul_f32 v236, v236, v232
    v_accvgpr_write_b32 a115, v236
    v_accvgpr_read_b32 v233, a116
    v_mul_f32 v233, v233, v232
    v_accvgpr_write_b32 a116, v233
    v_accvgpr_read_b32 v234, a117
    v_mul_f32 v234, v234, v232
    v_accvgpr_write_b32 a117, v234
    v_accvgpr_read_b32 v235, a118
    v_mul_f32 v235, v235, v232
    v_accvgpr_write_b32 a118, v235
    v_accvgpr_read_b32 v236, a119
    v_mul_f32 v236, v236, v232
    v_accvgpr_write_b32 a119, v236
    v_accvgpr_read_b32 v233, a120
    v_mul_f32 v233, v233, v232
    v_accvgpr_write_b32 a120, v233
    v_accvgpr_read_b32 v234, a121
    v_mul_f32 v234, v234, v232
    v_accvgpr_write_b32 a121, v234
    v_accvgpr_read_b32 v235, a122
    v_mul_f32 v235, v235, v232
    v_accvgpr_write_b32 a122, v235
    v_accvgpr_read_b32 v236, a123
    v_mul_f32 v236, v236, v232
    v_accvgpr_write_b32 a123, v236
    v_accvgpr_read_b32 v233, a124
    v_mul_f32 v233, v233, v232
    v_accvgpr_write_b32 a124, v233
    v_accvgpr_read_b32 v234, a125
    v_mul_f32 v234, v234, v232
    v_accvgpr_write_b32 a125, v234
    v_accvgpr_read_b32 v235, a126
    v_mul_f32 v235, v235, v232
    v_accvgpr_write_b32 a126, v235
    v_accvgpr_read_b32 v236, a127
    v_mul_f32 v236, v236, v232
    v_accvgpr_write_b32 a127, v236
    v_exp_f32 v128, v24
    v_exp_f32 v129, v25
    v_exp_f32 v130, v26
    v_exp_f32 v131, v27
    v_exp_f32 v132, v28
    v_exp_f32 v133, v29
    v_exp_f32 v134, v30
    v_exp_f32 v135, v31
    s_nop 0
    v_cvt_pk_bf16_f32 v108, v128, v129
    v_cvt_pk_bf16_f32 v109, v130, v131
    v_cvt_pk_bf16_f32 v110, v132, v133
    v_cvt_pk_bf16_f32 v111, v134, v135
    s_nop 1
    s_branch kf_rr25
kf_rare30:
    s_nop 15
    v_max3_f32 v230, v48, v49, v50
    v_max3_f32 v230, v230, v51, v52
    v_max3_f32 v230, v230, v53, v54
    v_max_f32 v230, v230, v55
    v_mov_b32 v231, v230
    s_nop 1
    v_permlane16_swap_b32 v230, v231
    s_nop 0
    v_max_f32 v230, v230, v231
    v_mov_b32 v231, v230
    s_nop 1
    v_permlane32_swap_b32 v230, v231
    s_nop 0
    v_max_f32 v230, v230, v231
    v_add_f32 v230, 0x41800000, v230
    v_max_f32 v230, 0, v230
    v_sub_f32 v232, 0, v230
    v_exp_f32 v232, v232
    v_sub_f32 v226, v226, v230
    v_sub_f32 v80, v80, v230
    v_sub_f32 v16, v16, v230
    v_sub_f32 v48, v48, v230
    v_sub_f32 v81, v81, v230
    v_sub_f32 v17, v17, v230
    v_sub_f32 v49, v49, v230
    v_sub_f32 v82, v82, v230
    v_sub_f32 v18, v18, v230
    v_sub_f32 v50, v50, v230
    v_sub_f32 v83, v83, v230
    v_sub_f32 v19, v19, v230
    v_sub_f32 v51, v51, v230
    v_sub_f32 v84, v84, v230
    v_sub_f32 v20, v20, v230
    v_sub_f32 v52, v52, v230
    v_sub_f32 v85, v85, v230
    v_sub_f32 v21, v21, v230
    v_sub_f32 v53, v53, v230
    v_sub_f32 v86, v86, v230
    v_sub_f32 v22, v22, v230
    v_sub_f32 v54, v54, v230
    v_sub_f32 v87, v87, v230
    v_sub_f32 v23, v23, v230
    v_sub_f32 v55, v55, v230
    v_mul_f32 v152, v152, v232
    v_mul_f32 v153, v153, v232
    v_mul_f32 v154, v154, v232
    v_mul_f32 v155, v155, v232
    v_accvgpr_read_b32 v233, a64
    v_mul_f32 v233, v233, v232
    v_accvgpr_write_b32 a64, v233
    v_accvgpr_read_b32 v234, a65
    v_mul_f32 v234, v234, v232
    v_accvgpr_write_b32 a65, v234
    v_accvgpr_read_b32 v235, a66
    v_mul_f32 v235, v235, v232
    v_accvgpr_write_b32 a66, v235
    v_accvgpr_read_b32 v236, a67
    v_mul_f32 v236, v236, v232
    v_accvgpr_write_b32 a67, v236
    v_accvgpr_read_b32 v233, a68
    v_mul_f32 v233, v233, v232
    v_accvgpr_write_b32 a68, v233
    v_accvgpr_read_b32 v234, a69
    v_mul_f32 v234, v234, v232
    v_accvgpr_write_b32 a69, v234
    v_accvgpr_read_b32 v235, a70
    v_mul_f32 v235, v235, v232
    v_accvgpr_write_b32 a70, v235
    v_accvgpr_read_b32 v236, a71
    v_mul_f32 v236, v236, v232
    v_accvgpr_write_b32 a71, v236
    v_accvgpr_read_b32 v233, a72
    v_mul_f32 v233, v233, v232
    v_accvgpr_write_b32 a72, v233
    v_accvgpr_read_b32 v234, a73
    v_mul_f32 v234, v234, v232
    v_accvgpr_write_b32 a73, v234
    v_accvgpr_read_b32 v235, a74
    v_mul_f32 v235, v235, v232
    v_accvgpr_write_b32 a74, v235
    v_accvgpr_read_b32 v236, a75
    v_mul_f32 v236, v236, v232
    v_accvgpr_write_b32 a75, v236
    v_accvgpr_read_b32 v233, a76
    v_mul_f32 v233, v233, v232
    v_accvgpr_write_b32 a76, v233
    v_accvgpr_read_b32 v234, a77
    v_mul_f32 v234, v234, v232
    v_accvgpr_write_b32 a77, v234
    v_accvgpr_read_b32 v235, a78
    v_mul_f32 v235, v235, v232
    v_accvgpr_write_b32 a78, v235
    v_accvgpr_read_b32 v236, a79
    v_mul_f32 v236, v236, v232
    v_accvgpr_write_b32 a79, v236
    v_accvgpr_read_b32 v233, a80
    v_mul_f32 v233, v233, v232
    v_accvgpr_write_b32 a80, v233
    v_accvgpr_read_b32 v234, a81
    v_mul_f32 v234, v234, v232
    v_accvgpr_write_b32 a81, v234
    v_accvgpr_read_b32 v235, a82
    v_mul_f32 v235, v235, v232
    v_accvgpr_write_b32 a82, v235
    v_accvgpr_read_b32 v236, a83
    v_mul_f32 v236, v236, v232
    v_accvgpr_write_b32 a83, v236
    v_accvgpr_read_b32 v233, a84
    v_mul_f32 v233, v233, v232
    v_accvgpr_write_b32 a84, v233
    v_accvgpr_read_b32 v234, a85
    v_mul_f32 v234, v234, v232
    v_accvgpr_write_b32 a85, v234
    v_accvgpr_read_b32 v235, a86
    v_mul_f32 v235, v235, v232
    v_accvgpr_write_b32 a86, v235
    v_accvgpr_read_b32 v236, a87
    v_mul_f32 v236, v236, v232
    v_accvgpr_write_b32 a87, v236
    v_accvgpr_read_b32 v233, a88
    v_mul_f32 v233, v233, v232
    v_accvgpr_write_b32 a88, v233
    v_accvgpr_read_b32 v234, a89
    v_mul_f32 v234, v234, v232
    v_accvgpr_write_b32 a89, v234
    v_accvgpr_read_b32 v235, a90
    v_mul_f32 v235, v235, v232
    v_accvgpr_write_b32 a90, v235
    v_accvgpr_read_b32 v236, a91
    v_mul_f32 v236, v236, v232
    v_accvgpr_write_b32 a91, v236
    v_accvgpr_read_b32 v233, a92
    v_mul_f32 v233, v233, v232
    v_accvgpr_write_b32 a92, v233
    v_accvgpr_read_b32 v234, a93
    v_mul_f32 v234, v234, v232
    v_accvgpr_write_b32 a93, v234
    v_accvgpr_read_b32 v235, a94
    v_mul_f32 v235, v235, v232
    v_accvgpr_write_b32 a94, v235
    v_accvgpr_read_b32 v236, a95
    v_mul_f32 v236, v236, v232
    v_accvgpr_write_b32 a95, v236
    v_exp_f32 v128, v48
    v_exp_f32 v129, v49
    v_exp_f32 v130, v50
    v_exp_f32 v131, v51
    v_exp_f32 v132, v52
    v_exp_f32 v133, v53
    v_exp_f32 v134, v54
    v_exp_f32 v135, v55
    s_nop 0
    v_cvt_pk_bf16_f32 v120, v128, v129
    v_cvt_pk_bf16_f32 v121, v130, v131
    v_cvt_pk_bf16_f32 v122, v132, v133
    v_cvt_pk_bf16_f32 v123, v134, v135
    v_max3_f32 v230, v56, v57, v58
    v_max3_f32 v230, v230, v59, v60
    v_max3_f32 v230, v230, v61, v62
    v_max_f32 v230, v230, v63
    v_mov_b32 v231, v230
    s_nop 1
    v_permlane16_swap_b32 v230, v231
    s_nop 0
    v_max_f32 v230, v230, v231
    v_mov_b32 v231, v230
    s_nop 1
    v_permlane32_swap_b32 v230, v231
    s_nop 0
    v_max_f32 v230, v230, v231
    v_add_f32 v230, 0x41800000, v230
    v_max_f32 v230, 0, v230
    v_sub_f32 v232, 0, v230
    v_exp_f32 v232, v232
    v_sub_f32 v227, v227, v230
    v_sub_f32 v88, v88, v230
    v_sub_f32 v24, v24, v230
    v_sub_f32 v56, v56, v230
    v_sub_f32 v89, v89, v230
    v_sub_f32 v25, v25, v230
    v_sub_f32 v57, v57, v230
    v_sub_f32 v90, v90, v230
    v_sub_f32 v26, v26, v230
    v_sub_f32 v58, v58, v230
    v_sub_f32 v91, v91, v230
    v_sub_f32 v27, v27, v230
    v_sub_f32 v59, v59, v230
    v_sub_f32 v92, v92, v230
    v_sub_f32 v28, v28, v230
    v_sub_f32 v60, v60, v230
    v_sub_f32 v93, v93, v230
    v_sub_f32 v29, v29, v230
    v_sub_f32 v61, v61, v230
    v_sub_f32 v94, v94, v230
    v_sub_f32 v30, v30, v230
    v_sub_f32 v62, v62, v230
    v_sub_f32 v95, v95, v230
    v_sub_f32 v31, v31, v230
    v_sub_f32 v63, v63, v230
    v_mul_f32 v156, v156, v232
    v_mul_f32 v157, v157, v232
    v_mul_f32 v158, v158, v232
    v_mul_f32 v159, v159, v232
    v_accvgpr_read_b32 v233, a96
    v_mul_f32 v233, v233, v232
    v_accvgpr_write_b32 a96, v233
    v_accvgpr_read_b32 v234, a97
    v_mul_f32 v234, v234, v232
    v_accvgpr_write_b32 a97, v234
    v_accvgpr_read_b32 v235, a98
    v_mul_f32 v235, v235, v232
    v_accvgpr_write_b32 a98, v235
    v_accvgpr_read_b32 v236, a99
    v_mul_f32 v236, v236, v232
    v_accvgpr_write_b32 a99, v236
    v_accvgpr_read_b32 v233, a100
    v_mul_f32 v233, v233, v232
    v_accvgpr_write_b32 a100, v233
    v_accvgpr_read_b32 v234, a101
    v_mul_f32 v234, v234, v232
    v_accvgpr_write_b32 a101, v234
    v_accvgpr_read_b32 v235, a102
    v_mul_f32 v235, v235, v232
    v_accvgpr_write_b32 a102, v235
    v_accvgpr_read_b32 v236, a103
    v_mul_f32 v236, v236, v232
    v_accvgpr_write_b32 a103, v236
    v_accvgpr_read_b32 v233, a104
    v_mul_f32 v233, v233, v232
    v_accvgpr_write_b32 a104, v233
    v_accvgpr_read_b32 v234, a105
    v_mul_f32 v234, v234, v232
    v_accvgpr_write_b32 a105, v234
    v_accvgpr_read_b32 v235, a106
    v_mul_f32 v235, v235, v232
    v_accvgpr_write_b32 a106, v235
    v_accvgpr_read_b32 v236, a107
    v_mul_f32 v236, v236, v232
    v_accvgpr_write_b32 a107, v236
    v_accvgpr_read_b32 v233, a108
    v_mul_f32 v233, v233, v232
    v_accvgpr_write_b32 a108, v233
    v_accvgpr_read_b32 v234, a109
    v_mul_f32 v234, v234, v232
    v_accvgpr_write_b32 a109, v234
    v_accvgpr_read_b32 v235, a110
    v_mul_f32 v235, v235, v232
    v_accvgpr_write_b32 a110, v235
    v_accvgpr_read_b32 v236, a111
    v_mul_f32 v236, v236, v232
    v_accvgpr_write_b32 a111, v236
    v_accvgpr_read_b32 v233, a112
    v_mul_f32 v233, v233, v232
    v_accvgpr_write_b32 a112, v233
    v_accvgpr_read_b32 v234, a113
    v_mul_f32 v234, v234, v232
    v_accvgpr_write_b32 a113, v234
    v_accvgpr_read_b32 v235, a114
    v_mul_f32 v235, v235, v232
    v_accvgpr_write_b32 a114, v235
    v_accvgpr_read_b32 v236, a115
    v_mul_f32 v236, v236, v232
    v_accvgpr_write_b32 a115, v236
    v_accvgpr_read_b32 v233, a116
    v_mul_f32 v233, v233, v232
    v_accvgpr_write_b32 a116, v233
    v_accvgpr_read_b32 v234, a117
    v_mul_f32 v234, v234, v232
    v_accvgpr_write_b32 a117, v234
    v_accvgpr_read_b32 v235, a118
    v_mul_f32 v235, v235, v232
    v_accvgpr_write_b32 a118, v235
    v_accvgpr_read_b32 v236, a119
    v_mul_f32 v236, v236, v232
    v_accvgpr_write_b32 a119, v236
    v_accvgpr_read_b32 v233, a120
    v_mul_f32 v233, v233, v232
    v_accvgpr_write_b32 a120, v233
    v_accvgpr_read_b32 v234, a121
    v_mul_f32 v234, v234, v232
    v_accvgpr_write_b32 a121, v234
    v_accvgpr_read_b32 v235, a122
    v_mul_f32 v235, v235, v232
    v_accvgpr_write_b32 a122, v235
    v_accvgpr_read_b32 v236, a123
    v_mul_f32 v236, v236, v232
    v_accvgpr_write_b32 a123, v236
    v_accvgpr_read_b32 v233, a124
    v_mul_f32 v233, v233, v232
    v_accvgpr_write_b32 a124, v233
    v_accvgpr_read_b32 v234, a125
    v_mul_f32 v234, v234, v232
    v_accvgpr_write_b32 a125, v234
    v_accvgpr_read_b32 v235, a126
    v_mul_f32 v235, v235, v232
    v_accvgpr_write_b32 a126, v235
    v_accvgpr_read_b32 v236, a127
    v_mul_f32 v236, v236, v232
    v_accvgpr_write_b32 a127, v236
    v_exp_f32 v128, v56
    v_exp_f32 v129, v57
    v_exp_f32 v130, v58
    v_exp_f32 v131, v59
    v_exp_f32 v132, v60
    v_exp_f32 v133, v61
    v_exp_f32 v134, v62
    v_exp_f32 v135, v63
    s_nop 0
    v_cvt_pk_bf16_f32 v124, v128, v129
    v_cvt_pk_bf16_f32 v125, v130, v131
    v_cvt_pk_bf16_f32 v126, v132, v133
    v_cvt_pk_bf16_f32 v127, v134, v135
    s_nop 1
    s_branch kf_rr29
kf_spin31:
    s_mov_b32 s25, 0x400000
kf_spin31_l:
    s_sleep 2
    buffer_load_dword v254, off, s[88:91], s97 sc1
    s_waitcnt vmcnt(0)
    v_readfirstlane_b32 s24, v254
    s_sub_u32 s25, s25, 1
    s_cbranch_scc1 kf_spinr32
    s_cmp_ge_u32 s24, 1
    s_cbranch_scc0 kf_spin31_l
    s_branch kf_spinr32
kf_spin33:
    s_mov_b32 s25, 0x400000
kf_spin33_l:
    s_sleep 2
    buffer_load_dword v254, off, s[88:91], s39 sc1
    s_waitcnt vmcnt(0)
    v_readfirstlane_b32 s24, v254
    s_sub_u32 s25, s25, 1
    s_cbranch_scc1 kf_spinr34
    s_cmp_ge_u32 s24, 32
    s_cbranch_scc0 kf_spin33_l
    s_branch kf_spinr34
kf_spin35:
    s_mov_b32 s25, 0x400000
kf_spin35_l:
    s_sleep 2
    buffer_load_dword v254, off, s[88:91], s97 sc1
    s_waitcnt vmcnt(0)
    v_readfirstlane_b32 s24, v254
    s_sub_u32 s25, s25, 1
    s_cbranch_scc1 kf_spinr36
    s_cmp_ge_u32 s24, 1
    s_cbranch_scc0 kf_spin35_l
    s_branch kf_spinr36
kf_spin37:
    s_mov_b32 s25, 0x400000
kf_spin37_l:
    s_sleep 2
    buffer_load_dword v254, off, s[88:91], s39 sc1
    s_waitcnt vmcnt(0)
    v_readfirstlane_b32 s24, v254
    s_sub_u32 s25, s25, 1
    s_cbranch_scc1 kf_spinr38
    s_cmp_ge_u32 s24, 32
    s_cbranch_scc0 kf_spin37_l
    s_branch kf_spinr38
kf_spin39:
    s_mov_b32 s25, 0x400000
kf_spin39_l:
    s_sleep 2
    buffer_load_dword v254, off, s[88:91], s35 sc1
    s_waitcnt vmcnt(0)
    v_readfirstlane_b32 s24, v254
    s_sub_u32 s25, s25, 1
    s_cbranch_scc1 kf_spinr40
    s_cmp_ge_u32 s24, 8
    s_cbranch_scc0 kf_spin39_l
    s_branch kf_spinr40

code_end:
.section .rodata,"a"
.p2align 6
.amdhsa_kernel sequential_preLN__compressed_kv_cla__moe_arch_mod__prompt_kernel
  .amdhsa_next_free_vgpr 512
  .amdhsa_next_free_sgpr 102
  .amdhsa_accum_offset 256
  .amdhsa_group_segment_fixed_size 0
  .amdhsa_kernarg_size 112
  .amdhsa_user_sgpr_count 2
  .amdhsa_user_sgpr_kernarg_segment_ptr 1
  .amdhsa_system_sgpr_workgroup_id_x 1
  .amdhsa_float_denorm_mode_32 3
.end_amdhsa_kernel
```

```asm
; @launch grid=(256,1,1) block=(256,1,1) lds=163840
.amdgcn_target "amdgcn-amd-amdhsa--gfx950"
.text
.globl sequential_preLN__compressed_kv_cla__moe_arch_mod__prompt_kernel
.p2align 8
.type sequential_preLN__compressed_kv_cla__moe_arch_mod__prompt_kernel,@function
sequential_preLN__compressed_kv_cla__moe_arch_mod__prompt_kernel:
    s_cmp_ge_u32 s2, 256
    s_cbranch_scc1 ka_done
    s_load_dwordx8 s[64:71], s[0:1], 0
    s_load_dwordx4 s[72:75], s[0:1], 32
    s_load_dwordx4 s[76:79], s[0:1], 64
    s_load_dwordx8 s[8:15], s[0:1], 80
    v_lshrrev_b32 v1, 6, v0
    v_and_b32 v2, 63, v0
    v_readfirstlane_b32 s3, v1
    v_mov_b32_e64 v253, v0
    s_and_b32 s4, s2, 7
    s_lshl_b32 s4, s4, 2
    s_lshr_b32 s24, s2, 3
    s_and_b32 s24, s24, 3
    s_add_u32 s4, s4, s24
    s_lshr_b32 s5, s2, 5
    s_lshl2_add_u32 s6, s5, s3
    s_getpc_b64 s[56:57]
ka_pc:
    s_mov_b32 s58, code_end-ka_pc
    s_mov_b32 s59, 0x00020000
    s_lshr_b32 s24, s2, 3
    s_xor_b32 s24, s24, 31
    s_lshl2_add_u32 s24, s24, s3
    s_lshl_b32 s24, s24, 13
    v_lshlrev_b32_e64 v3, 7, v2
    buffer_load_dword v252, v3, s[56:59], s24 offen
    v_mov_b32 v192, v2
    v_lshrrev_b32 v198, 3, v192
    v_and_b32 v199, 7, v192
    s_lshr_b32 s24, s3, 1
    s_lshl_b32 s24, s24, 5
    s_and_b32 s25, s3, 1
    s_lshl_b32 s26, s25, 3
    s_add_u32 s24, s24, s26
    v_add_u32 v194, s24, v198
    v_lshlrev_b32 v194, 10, v194
    v_lshrrev_b32 v195, 1, v198
    v_xor_b32 v195, v199, v195
    v_lshl_add_u32 v232, v195, 4, v194
    v_xor_b32_e64 v195, 4, v195
    v_lshl_add_u32 v233, v195, 4, v194
    v_add_u32 v233, 15360, v233
    s_lshl_b32 s24, s4, 8
    s_lshl_b32 s26, s25, 7
    s_add_u32 s24, s24, s26
    v_lshlrev_b32 v194, 13, v198
    v_add_u32_e64 v194, s24, v194
    v_bfe_u32 v195, v198, 1, 1
    v_xor_b32_e64 v195, v199, v195
    v_lshl_add_u32 v234, v195, 4, v194
    v_xor_b32_e64 v195, 4, v195
    v_lshl_add_u32 v235, v195, 4, v194
    v_add_u32 v235, 64512, v235
    s_lshl_b32 s34, s3, 11
    s_mul_i32 s35, s3, 24576
    s_add_u32 s35, s35, 65536
    s_lshl_b32 s32, s5, 18
    s_and_b32 s7, s4, 3
    s_lshl1_add_u32 s7, s7, s5
    s_add_u32 s80, s7, 0
    s_and_b32 s80, s80, 7
    s_lshl_b32 s80, s80, 7
    s_add_u32 s80, s80, s32
    s_add_u32 s81, s7, 1
    s_and_b32 s81, s81, 7
    s_lshl_b32 s81, s81, 7
    s_add_u32 s81, s81, s32
    s_add_u32 s82, s7, 2
    s_and_b32 s82, s82, 7
    s_lshl_b32 s82, s82, 7
    s_add_u32 s82, s82, s32
    s_add_u32 s83, s7, 3
    s_and_b32 s83, s83, 7
    s_lshl_b32 s83, s83, 7
    s_add_u32 s83, s83, s32
    s_add_u32 s84, s7, 4
    s_and_b32 s84, s84, 7
    s_lshl_b32 s84, s84, 7
    s_add_u32 s84, s84, s32
    s_add_u32 s85, s7, 5
    s_and_b32 s85, s85, 7
    s_lshl_b32 s85, s85, 7
    s_add_u32 s85, s85, s32
    s_add_u32 s86, s7, 6
    s_and_b32 s86, s86, 7
    s_lshl_b32 s86, s86, 7
    s_add_u32 s86, s86, s32
    s_add_u32 s87, s7, 7
    s_and_b32 s87, s87, 7
    s_lshl_b32 s87, s87, 7
    s_add_u32 s87, s87, s32
    s_waitcnt lgkmcnt(0)
    s_cmp_lt_u32 s3, 2
    s_cselect_b32 s48, s70, s72
    s_cselect_b32 s49, s71, s73
    s_mov_b32 s50, 0x400000
    s_mov_b32 s51, 0x00020000
    s_mov_b32 s44, s66
    s_mov_b32 s45, s67
    s_mov_b32 s46, 0x200000
    s_mov_b32 s47, 0x00020000
    s_add_u32 m0, s35, 0
    s_and_b32 s33, s80, 1023
    s_lshl_b32 s33, s33, 12
    buffer_load_dwordx4 v234, s[48:51], s33 offen lds
    buffer_load_dwordx4 v235, s[48:51], s33 offen offset:1024 lds
    s_add_u32 m0, s35, 2048
    s_add_u32 s33, s33, 131072
    buffer_load_dwordx4 v234, s[48:51], s33 offen lds
    buffer_load_dwordx4 v235, s[48:51], s33 offen offset:1024 lds
    s_add_u32 m0, s34, 0
    s_add_u32 s37, s80, 0
    buffer_load_dwordx4 v232, s[44:47], s37 offen lds
    buffer_load_dwordx4 v233, s[44:47], s37 offen offset:1024 lds
    s_add_u32 m0, s34, 8192
    s_add_u32 s37, s80, 65536
    buffer_load_dwordx4 v232, s[44:47], s37 offen lds
    buffer_load_dwordx4 v233, s[44:47], s37 offen offset:1024 lds
    s_add_u32 m0, s35, 4096
    s_add_u32 s33, s33, 131072
    buffer_load_dwordx4 v234, s[48:51], s33 offen lds
    buffer_load_dwordx4 v235, s[48:51], s33 offen offset:1024 lds
    s_add_u32 m0, s35, 6144
    s_add_u32 s33, s33, 131072
    buffer_load_dwordx4 v234, s[48:51], s33 offen lds
    buffer_load_dwordx4 v235, s[48:51], s33 offen offset:1024 lds
    s_mov_b32 s52, s64
    s_mov_b32 s53, s65
    s_mov_b32 s54, 0x400000
    s_mov_b32 s55, 0x00020000
    s_add_u32 s16, s14, 0x5c00000
    s_addc_u32 s17, s15, 0
    s_mov_b32 s18, 0x2140000
    s_mov_b32 s19, 0x00020000
    s_add_u32 s56, s14, 0x3800000
    s_addc_u32 s57, s15, 0
    s_mov_b32 s58, 0x6040
    s_mov_b32 s59, 0x00020000
    s_add_u32 s20, s14, 0x2400000
    s_addc_u32 s21, s15, 0
    s_mov_b32 s22, 0x1000000
    s_mov_b32 s23, 0x00020000
    s_mov_b32 s88, s12
    s_mov_b32 s89, s13
    s_mov_b32 s90, 0x100
    s_mov_b32 s91, 0x00020000
    s_cmp_lt_u32 s3, 2
    s_cselect_b32 s60, s8, s74
    s_cselect_b32 s61, s9, s75
    s_mov_b32 s62, 0x800000
    s_cselect_b32 s62, 0x700000, s62
    s_mov_b32 s63, 0x00020000
    s_cselect_b32 s41, s76, s78
    s_cselect_b32 s42, s77, s79
    s_mov_b32 s8, s14
    s_mov_b32 s9, s15
    s_mov_b32 s10, 0x400000
    s_mov_b32 s11, 0x00020000
    s_mov_b32 s12, s68
    s_mov_b32 s13, s69
    s_mov_b32 s14, 0x800000
    s_mov_b32 s15, 0x00020000
    s_cmp_eq_u32 s2, 200
    s_mov_b32 s97, 0x40000000
    s_cselect_b32 s97, 0xa0000, s97
    s_mov_b32 s58, 0xa5000
    v_lshlrev_b32 v194, 7, v253
    v_mov_b32_e64 v195, 0
    buffer_store_dword v195, v194, s[56:59], s97 offen sc1
    s_cselect_b32 s97, 0, 0x40000000
    s_mov_b32 s58, 0x6040
    s_add_u32 m0, s35, 8192
    s_and_b32 s33, s81, 1023
    s_lshl_b32 s33, s33, 12
    buffer_load_dwordx4 v234, s[48:51], s33 offen lds
    buffer_load_dwordx4 v235, s[48:51], s33 offen offset:1024 lds
    s_add_u32 m0, s35, 10240
    s_add_u32 s33, s33, 131072
    buffer_load_dwordx4 v234, s[48:51], s33 offen lds
    buffer_load_dwordx4 v235, s[48:51], s33 offen offset:1024 lds
    s_add_u32 m0, s35, 12288
    s_add_u32 s33, s33, 131072
    buffer_load_dwordx4 v234, s[48:51], s33 offen lds
    buffer_load_dwordx4 v235, s[48:51], s33 offen offset:1024 lds
    s_add_u32 m0, s35, 14336
    s_add_u32 s33, s33, 131072
    buffer_load_dwordx4 v234, s[48:51], s33 offen lds
    buffer_load_dwordx4 v235, s[48:51], s33 offen offset:1024 lds
    s_add_u32 m0, s34, 16384
    s_add_u32 s37, s81, 0
    buffer_load_dwordx4 v232, s[44:47], s37 offen lds
    buffer_load_dwordx4 v233, s[44:47], s37 offen offset:1024 lds
    s_add_u32 m0, s34, 24576
    s_add_u32 s37, s81, 65536
    buffer_load_dwordx4 v232, s[44:47], s37 offen lds
    buffer_load_dwordx4 v233, s[44:47], s37 offen offset:1024 lds
    v_and_b32 v200, 15, v192
    v_lshrrev_b32 v201, 4, v192
    v_lshrrev_b32 v194, 1, v200
    v_xor_b32 v194, v201, v194
    v_lshlrev_b32 v194, 4, v194
    v_lshl_add_u32 v224, v200, 7, v194
    v_xor_b32 v225, 64, v224
    v_lshrrev_b32 v194, 2, v200
    v_lshl_add_u32 v195, v201, 3, v194
    v_lshlrev_b32 v195, 7, v195
    v_add_u32 v195, s35, v195
    v_and_b32_e64 v196, 1, v200
    v_lshl_add_u32 v195, v196, 3, v195
    v_lshrrev_b32 v194, 1, v194
    v_and_b32 v196, 1, v201
    v_lshl_or_b32 v194, v196, 2, v194
    v_and_b32 v196, 2, v200
    v_xor_b32 v194, v194, v196
    v_xor_b32_e64 v196, 0, v194
    v_lshl_add_u32 v228, v196, 4, v195
    v_xor_b32_e64 v196, 1, v194
    v_lshl_add_u32 v229, v196, 4, v195
    v_xor_b32_e64 v196, 4, v194
    v_lshl_add_u32 v230, v196, 4, v195
    v_xor_b32_e64 v196, 5, v194
    v_lshl_add_u32 v231, v196, 4, v195
    s_mul_i32 s36, s4, 1089536
    s_mul_i32 s24, s5, 136192
    s_add_u32 s36, s36, s24
    s_and_b32 s24, s3, 1
    s_lshl_b32 s24, s24, 12
    s_and_b32 s26, s3, 2
    s_lshl_b32 s26, s26, 13
    s_add_u32 s36, s36, s24
    s_add_u32 s36, s36, s26
    s_lshl_b32 s24, s5, 7
    s_sub_u32 s26, 1792, s24
    s_cmp_lt_u32 s4, 16
    s_cselect_b32 s24, s24, s26
    s_lshl_b32 s26, s4, 3
    s_add_u32 s24, s24, s26
    v_lshrrev_b32 v194, 5, v253
    v_add_u32 v196, s24, v194
    v_and_b32 v195, 31, v192
    v_lshlrev_b32 v196, 11, v196
    v_lshl_add_u32 v236, v195, 4, v196
    v_xor_b32 v194, v194, v199
    v_lshlrev_b32 v194, 4, v194
    v_lshl_add_u32 v194, v195, 7, v194
    v_add_u32 v237, 81920, v194
    s_lshr_b32 s26, s24, 4
    s_lshl_b32 s26, s26, 15
    s_and_b32 s24, s24, 15
    s_lshl_b32 s24, s24, 4
    s_add_u32 s24, s24, s26
    v_lshrrev_b32 v194, 3, v253
    v_lshlrev_b32 v194, 8, v194
    v_xor_b32 v195, v199, v198
    v_lshl_add_u32 v194, v195, 4, v194
    v_add_u32 v238, s24, v194
    v_lshlrev_b32 v240, 4, v192
    s_lshl_b32 s24, s3, 12
    v_add_u32 v242, s24, v240
    s_lshl_b32 s24, s6, 16
    v_add_u32 v248, s24, v240
    s_sub_u32 s25, 63, s6
    s_lshl_b32 s24, s25, 16
    v_add_u32_e64 v249, s24, v240
    v_bfe_u32 v194, v192, 2, 2
    v_lshlrev_b32_e64 v194, 13, v194
    v_lshl_add_u32 v194, v201, 6, v194
    v_and_b32_e64 v195, 3, v192
    v_lshl_add_u32 v194, v195, 4, v194
    s_lshl_b32 s24, s4, 8
    s_lshl_b32 s25, s3, 18
    s_add_u32 s24, s24, s25
    v_add_u32_e64 v245, s24, v194
    s_lshl_b32 s31, s3, 13
    s_add_u32 s31, s31, 65536
    s_lshl_b32 s27, s5, 20
    s_mov_b32 s7, s27
    s_mov_b32 s43, 0x40000000
    s_lshr_b32 s28, s27, 8
    s_add_u32 s29, s28, 32768
    s_nop 0
    v_lshlrev_b32 v194, 11, v201
    v_bfe_u32 v195, v192, 2, 2
    v_lshl_add_u32 v194, v195, 6, v194
    v_bfe_u32 v195, v192, 4, 1
    v_lshl_add_u32 v194, v195, 4, v194
    v_and_b32_e64 v195, 1, v192
    v_lshl_add_u32 v194, v195, 3, v194
    v_bfe_u32 v195, v192, 1, 1
    v_lshl_add_u32 v247, v195, 5, v194
    s_mov_b32 s30, 65536
    v_add_u32 v246, s30, v247
    v_lshrrev_b32 v195, 5, v192
    v_lshlrev_b32 v195, 4, v195
    v_sub_u32 v194, v200, v195
    v_bfe_u32 v195, v192, 4, 1
    v_lshlrev_b32 v195, 2, v195
    v_sub_u32 v194, v194, v195
    v_cvt_f32_i32 v194, v194
    v_add_f32 v194, 0.5, v194
    v_mul_f32 v243, 0x71800000, v194
    v_add_u32 v244, 0x20000, v240
    v_lshlrev_b32 v251, 7, v192
    v_cmp_gt_u32 vcc, 16, v192
    v_mov_b32 v194, 0x40000000
    v_mov_b32 v255, 1
    v_cndmask_b32 v251, v194, v251, vcc
    v_cmp_eq_u32 vcc, 0, v253
    s_nop 1
    v_cndmask_b32 v250, v194, v253, vcc
    s_waitcnt vmcnt(19)
    s_barrier
    ds_read_b128 v[64:67], v224 offset:0
    ds_read_b128 v[68:71], v224 offset:2048
    ds_read_b128 v[72:75], v224 offset:4096
    ds_read_b128 v[76:79], v224 offset:6144
    ds_read_b64_tr_b16 a[0:1], v228 offset:0
    ds_read_b64_tr_b16 a[2:3], v228 offset:512
    ds_read_b64_tr_b16 a[4:5], v229 offset:0
    ds_read_b64_tr_b16 a[6:7], v229 offset:512
    ds_read_b64_tr_b16 a[8:9], v230 offset:0
    ds_read_b64_tr_b16 a[10:11], v230 offset:512
    ds_read_b64_tr_b16 a[12:13], v231 offset:0
    ds_read_b64_tr_b16 a[14:15], v231 offset:512
    s_waitcnt vmcnt(12)
    s_barrier
    buffer_store_dword v255, v250, s[88:91], s97 offen sc1
    s_cmp_eq_u32 s3, 0
    s_cselect_b32 s97, 0, s43
    s_cmp_lt_u32 s3, 2
    s_cbranch_scc0 ka_V
    s_waitcnt lgkmcnt(0)
    v_mfma_f32_16x16x32_bf16 v[96:99], a[0:3], v[64:67], 0
    ds_read_b128 v[80:83], v224 offset:8192
    v_mfma_f32_16x16x32_bf16 v[100:103], a[4:7], v[64:67], 0
    ds_read_b128 v[84:87], v224 offset:10240
    v_mfma_f32_16x16x32_bf16 v[104:107], a[8:11], v[64:67], 0
    ds_read_b128 v[88:91], v224 offset:12288
    v_mfma_f32_16x16x32_bf16 v[108:111], a[12:15], v[64:67], 0
    ds_read_b128 v[92:95], v224 offset:14336
    v_mfma_f32_16x16x32_bf16 v[112:115], a[0:3], v[68:71], 0
    ds_read_b64_tr_b16 a[16:17], v228 offset:4096
    v_mfma_f32_16x16x32_bf16 v[116:119], a[4:7], v[68:71], 0
    ds_read_b64_tr_b16 a[18:19], v228 offset:4608
    v_mfma_f32_16x16x32_bf16 v[120:123], a[8:11], v[68:71], 0
    ds_read_b64_tr_b16 a[20:21], v229 offset:4096
    v_mfma_f32_16x16x32_bf16 v[124:127], a[12:15], v[68:71], 0
    ds_read_b64_tr_b16 a[22:23], v229 offset:4608
    v_mfma_f32_16x16x32_bf16 v[128:131], a[0:3], v[72:75], 0
    s_add_u32 m0, s35, 16384
    s_and_b32 s33, s82, 1023
    s_lshl_b32 s33, s33, 12
    buffer_load_dwordx4 v234, s[48:51], s33 offen lds
    v_mfma_f32_16x16x32_bf16 v[132:135], a[4:7], v[72:75], 0
    v_mfma_f32_16x16x32_bf16 v[136:139], a[8:11], v[72:75], 0
    buffer_load_dwordx4 v235, s[48:51], s33 offen offset:1024 lds
    v_mfma_f32_16x16x32_bf16 v[140:143], a[12:15], v[72:75], 0
    v_mfma_f32_16x16x32_bf16 v[144:147], a[0:3], v[76:79], 0
    s_add_u32 m0, s35, 18432
    s_add_u32 s33, s33, 131072
    buffer_load_dwordx4 v234, s[48:51], s33 offen lds
    v_mfma_f32_16x16x32_bf16 v[148:151], a[4:7], v[76:79], 0
    v_mfma_f32_16x16x32_bf16 v[152:155], a[8:11], v[76:79], 0
    buffer_load_dwordx4 v235, s[48:51], s33 offen offset:1024 lds
    v_mfma_f32_16x16x32_bf16 v[156:159], a[12:15], v[76:79], 0
    s_waitcnt lgkmcnt(0)
    v_mfma_f32_16x16x32_bf16 v[160:163], a[0:3], v[80:83], 0
    ds_read_b128 v[64:67], v225 offset:0
    v_mfma_f32_16x16x32_bf16 v[164:167], a[4:7], v[80:83], 0
    ds_read_b128 v[68:71], v225 offset:2048
    v_mfma_f32_16x16x32_bf16 v[168:171], a[8:11], v[80:83], 0
    ds_read_b128 v[72:75], v225 offset:4096
    v_mfma_f32_16x16x32_bf16 v[172:175], a[12:15], v[80:83], 0
    ds_read_b128 v[76:79], v225 offset:6144
    v_mfma_f32_16x16x32_bf16 v[176:179], a[0:3], v[84:87], 0
    ds_read_b64_tr_b16 a[24:25], v230 offset:4096
    v_mfma_f32_16x16x32_bf16 v[180:183], a[4:7], v[84:87], 0
    ds_read_b64_tr_b16 a[26:27], v230 offset:4608
    v_mfma_f32_16x16x32_bf16 v[184:187], a[8:11], v[84:87], 0
    ds_read_b64_tr_b16 a[28:29], v231 offset:4096
    v_mfma_f32_16x16x32_bf16 v[188:191], a[12:15], v[84:87], 0
    ds_read_b64_tr_b16 a[30:31], v231 offset:4608
    v_mfma_f32_16x16x32_bf16 v[192:195], a[0:3], v[88:91], 0
    s_add_u32 m0, s35, 20480
    s_add_u32 s33, s33, 131072
    buffer_load_dwordx4 v234, s[48:51], s33 offen lds
    v_mfma_f32_16x16x32_bf16 v[196:199], a[4:7], v[88:91], 0
    v_mfma_f32_16x16x32_bf16 v[200:203], a[8:11], v[88:91], 0
    buffer_load_dwordx4 v235, s[48:51], s33 offen offset:1024 lds
    v_mfma_f32_16x16x32_bf16 v[204:207], a[12:15], v[88:91], 0
    v_mfma_f32_16x16x32_bf16 v[208:211], a[0:3], v[92:95], 0
    s_add_u32 m0, s35, 22528
    s_add_u32 s33, s33, 131072
    buffer_load_dwordx4 v234, s[48:51], s33 offen lds
    v_mfma_f32_16x16x32_bf16 v[212:215], a[4:7], v[92:95], 0
    v_mfma_f32_16x16x32_bf16 v[216:219], a[8:11], v[92:95], 0
    buffer_load_dwordx4 v235, s[48:51], s33 offen offset:1024 lds
    v_mfma_f32_16x16x32_bf16 v[220:223], a[12:15], v[92:95], 0
    s_waitcnt vmcnt(13) lgkmcnt(0)
    v_mfma_f32_16x16x32_bf16 v[96:99], a[16:19], v[64:67], v[96:99]
    ds_read_b128 v[80:83], v225 offset:8192
    v_mfma_f32_16x16x32_bf16 v[100:103], a[20:23], v[64:67], v[100:103]
    ds_read_b128 v[84:87], v225 offset:10240
    v_mfma_f32_16x16x32_bf16 v[104:107], a[24:27], v[64:67], v[104:107]
    ds_read_b128 v[88:91], v225 offset:12288
    v_mfma_f32_16x16x32_bf16 v[108:111], a[28:31], v[64:67], v[108:111]
    ds_read_b128 v[92:95], v225 offset:14336
    v_mfma_f32_16x16x32_bf16 v[112:115], a[16:19], v[68:71], v[112:115]
    ds_read_b64_tr_b16 a[32:33], v228 offset:8192
    v_mfma_f32_16x16x32_bf16 v[116:119], a[20:23], v[68:71], v[116:119]
    ds_read_b64_tr_b16 a[34:35], v228 offset:8704
    v_mfma_f32_16x16x32_bf16 v[120:123], a[24:27], v[68:71], v[120:123]
    ds_read_b64_tr_b16 a[36:37], v229 offset:8192
    v_mfma_f32_16x16x32_bf16 v[124:127], a[28:31], v[68:71], v[124:127]
    ds_read_b64_tr_b16 a[38:39], v229 offset:8704
    v_mfma_f32_16x16x32_bf16 v[128:131], a[16:19], v[72:75], v[128:131]
    s_add_u32 m0, s34, 32768
    s_add_u32 s37, s82, 0
    buffer_load_dwordx4 v232, s[44:47], s37 offen lds
    v_mfma_f32_16x16x32_bf16 v[132:135], a[20:23], v[72:75], v[132:135]
    buffer_load_dwordx4 v233, s[44:47], s37 offen offset:1024 lds
    v_mfma_f32_16x16x32_bf16 v[136:139], a[24:27], v[72:75], v[136:139]
    s_add_u32 m0, s34, 40960
    s_add_u32 s37, s82, 65536
    buffer_load_dwordx4 v232, s[44:47], s37 offen lds
    v_mfma_f32_16x16x32_bf16 v[140:143], a[28:31], v[72:75], v[140:143]
    buffer_load_dwordx4 v233, s[44:47], s37 offen offset:1024 lds
    v_mfma_f32_16x16x32_bf16 v[144:147], a[16:19], v[76:79], v[144:147]
    s_add_u32 m0, s35, 0
    s_and_b32 s33, s83, 1023
    s_lshl_b32 s33, s33, 12
    buffer_load_dwordx4 v234, s[48:51], s33 offen lds
    v_mfma_f32_16x16x32_bf16 v[148:151], a[20:23], v[76:79], v[148:151]
    buffer_load_dwordx4 v235, s[48:51], s33 offen offset:1024 lds
    v_mfma_f32_16x16x32_bf16 v[152:155], a[24:27], v[76:79], v[152:155]
    s_add_u32 m0, s35, 2048
    s_add_u32 s33, s33, 131072
    buffer_load_dwordx4 v234, s[48:51], s33 offen lds
    v_mfma_f32_16x16x32_bf16 v[156:159], a[28:31], v[76:79], v[156:159]
    buffer_load_dwordx4 v235, s[48:51], s33 offen offset:1024 lds
    s_waitcnt vmcnt(17) lgkmcnt(0)
    s_barrier
    v_mfma_f32_16x16x32_bf16 v[160:163], a[16:19], v[80:83], v[160:163]
    ds_read_b128 v[64:67], v224 offset:16384
    v_mfma_f32_16x16x32_bf16 v[164:167], a[20:23], v[80:83], v[164:167]
    ds_read_b128 v[68:71], v224 offset:18432
    v_mfma_f32_16x16x32_bf16 v[168:171], a[24:27], v[80:83], v[168:171]
    ds_read_b128 v[72:75], v224 offset:20480
    v_mfma_f32_16x16x32_bf16 v[172:175], a[28:31], v[80:83], v[172:175]
    ds_read_b128 v[76:79], v224 offset:22528
    v_mfma_f32_16x16x32_bf16 v[176:179], a[16:19], v[84:87], v[176:179]
    ds_read_b64_tr_b16 a[40:41], v230 offset:8192
    s_add_u32 m0, s34, 49152
    s_add_u32 s37, s83, 0
    buffer_load_dwordx4 v232, s[44:47], s37 offen lds
    v_mfma_f32_16x16x32_bf16 v[180:183], a[20:23], v[84:87], v[180:183]
    ds_read_b64_tr_b16 a[42:43], v230 offset:8704
    buffer_load_dwordx4 v233, s[44:47], s37 offen offset:1024 lds
    v_mfma_f32_16x16x32_bf16 v[184:187], a[24:27], v[84:87], v[184:187]
    ds_read_b64_tr_b16 a[44:45], v231 offset:8192
    s_add_u32 m0, s34, 57344
    s_add_u32 s37, s83, 65536
    buffer_load_dwordx4 v232, s[44:47], s37 offen lds
    v_mfma_f32_16x16x32_bf16 v[188:191], a[28:31], v[84:87], v[188:191]
    ds_read_b64_tr_b16 a[46:47], v231 offset:8704
    buffer_load_dwordx4 v233, s[44:47], s37 offen offset:1024 lds
    v_mfma_f32_16x16x32_bf16 v[192:195], a[16:19], v[88:91], v[192:195]
    s_add_u32 m0, s34, 0
    s_add_u32 s37, s84, 0
    buffer_load_dwordx4 v232, s[44:47], s37 offen lds
    v_mfma_f32_16x16x32_bf16 v[196:199], a[20:23], v[88:91], v[196:199]
    v_mfma_f32_16x16x32_bf16 v[200:203], a[24:27], v[88:91], v[200:203]
    buffer_load_dwordx4 v233, s[44:47], s37 offen offset:1024 lds
    v_mfma_f32_16x16x32_bf16 v[204:207], a[28:31], v[88:91], v[204:207]
    buffer_load_dwordx4 v[0:3], v236, s[52:55], 0 offen offset:0
    v_mfma_f32_16x16x32_bf16 v[208:211], a[16:19], v[92:95], v[208:211]
    buffer_load_dwordx4 v[4:7], v236, s[52:55], 0 offen offset:512
    v_mfma_f32_16x16x32_bf16 v[212:215], a[20:23], v[92:95], v[212:215]
    buffer_load_dwordx4 v[8:11], v236, s[52:55], 0 offen offset:1024
    v_mfma_f32_16x16x32_bf16 v[216:219], a[24:27], v[92:95], v[216:219]
    buffer_load_dwordx4 v[12:15], v236, s[52:55], 0 offen offset:1536
    v_mfma_f32_16x16x32_bf16 v[220:223], a[28:31], v[92:95], v[220:223]
    s_waitcnt lgkmcnt(0)
    v_mfma_f32_16x16x32_bf16 v[96:99], a[32:35], v[64:67], v[96:99]
    ds_read_b128 v[80:83], v224 offset:24576
    v_mfma_f32_16x16x32_bf16 v[100:103], a[36:39], v[64:67], v[100:103]
    ds_read_b128 v[84:87], v224 offset:26624
    v_mfma_f32_16x16x32_bf16 v[104:107], a[40:43], v[64:67], v[104:107]
    ds_read_b128 v[88:91], v224 offset:28672
    v_mfma_f32_16x16x32_bf16 v[108:111], a[44:47], v[64:67], v[108:111]
    ds_read_b128 v[92:95], v224 offset:30720
    v_mfma_f32_16x16x32_bf16 v[112:115], a[32:35], v[68:71], v[112:115]
    ds_read_b64_tr_b16 a[48:49], v228 offset:12288
    v_mfma_f32_16x16x32_bf16 v[116:119], a[36:39], v[68:71], v[116:119]
    ds_read_b64_tr_b16 a[50:51], v228 offset:12800
    v_mfma_f32_16x16x32_bf16 v[120:123], a[40:43], v[68:71], v[120:123]
    ds_read_b64_tr_b16 a[52:53], v229 offset:12288
    v_mfma_f32_16x16x32_bf16 v[124:127], a[44:47], v[68:71], v[124:127]
    ds_read_b64_tr_b16 a[54:55], v229 offset:12800
    v_mfma_f32_16x16x32_bf16 v[128:131], a[32:35], v[72:75], v[128:131]
    s_add_u32 m0, s35, 4096
    s_add_u32 s33, s33, 131072
    buffer_load_dwordx4 v234, s[48:51], s33 offen lds
    v_mfma_f32_16x16x32_bf16 v[132:135], a[36:39], v[72:75], v[132:135]
    v_mfma_f32_16x16x32_bf16 v[136:139], a[40:43], v[72:75], v[136:139]
    buffer_load_dwordx4 v235, s[48:51], s33 offen offset:1024 lds
    v_mfma_f32_16x16x32_bf16 v[140:143], a[44:47], v[72:75], v[140:143]
    v_mfma_f32_16x16x32_bf16 v[144:147], a[32:35], v[76:79], v[144:147]
    s_add_u32 m0, s35, 6144
    s_add_u32 s33, s33, 131072
    buffer_load_dwordx4 v234, s[48:51], s33 offen lds
    v_mfma_f32_16x16x32_bf16 v[148:151], a[36:39], v[76:79], v[148:151]
    v_mfma_f32_16x16x32_bf16 v[152:155], a[40:43], v[76:79], v[152:155]
    buffer_load_dwordx4 v235, s[48:51], s33 offen offset:1024 lds
    v_mfma_f32_16x16x32_bf16 v[156:159], a[44:47], v[76:79], v[156:159]
    s_waitcnt lgkmcnt(0)
    v_mfma_f32_16x16x32_bf16 v[160:163], a[32:35], v[80:83], v[160:163]
    ds_read_b128 v[64:67], v225 offset:16384
    v_mfma_f32_16x16x32_bf16 v[164:167], a[36:39], v[80:83], v[164:167]
    ds_read_b128 v[68:71], v225 offset:18432
    v_mfma_f32_16x16x32_bf16 v[168:171], a[40:43], v[80:83], v[168:171]
    ds_read_b128 v[72:75], v225 offset:20480
    v_mfma_f32_16x16x32_bf16 v[172:175], a[44:47], v[80:83], v[172:175]
    ds_read_b128 v[76:79], v225 offset:22528
    v_mfma_f32_16x16x32_bf16 v[176:179], a[32:35], v[84:87], v[176:179]
    ds_read_b64_tr_b16 a[56:57], v230 offset:12288
    v_mfma_f32_16x16x32_bf16 v[180:183], a[36:39], v[84:87], v[180:183]
    ds_read_b64_tr_b16 a[58:59], v230 offset:12800
    v_mfma_f32_16x16x32_bf16 v[184:187], a[40:43], v[84:87], v[184:187]
    ds_read_b64_tr_b16 a[60:61], v231 offset:12288
    v_mfma_f32_16x16x32_bf16 v[188:191], a[44:47], v[84:87], v[188:191]
    ds_read_b64_tr_b16 a[62:63], v231 offset:12800
    v_mfma_f32_16x16x32_bf16 v[192:195], a[32:35], v[88:91], v[192:195]
    s_add_u32 m0, s34, 8192
    s_add_u32 s37, s84, 65536
    buffer_load_dwordx4 v232, s[44:47], s37 offen lds
    v_mfma_f32_16x16x32_bf16 v[196:199], a[36:39], v[88:91], v[196:199]
    v_mfma_f32_16x16x32_bf16 v[200:203], a[40:43], v[88:91], v[200:203]
    v_mfma_f32_16x16x32_bf16 v[204:207], a[44:47], v[88:91], v[204:207]
    v_mfma_f32_16x16x32_bf16 v[208:211], a[32:35], v[92:95], v[208:211]
    buffer_load_dwordx4 v233, s[44:47], s37 offen offset:1024 lds
    v_mfma_f32_16x16x32_bf16 v[212:215], a[36:39], v[92:95], v[212:215]
    v_mfma_f32_16x16x32_bf16 v[216:219], a[40:43], v[92:95], v[216:219]
    v_mfma_f32_16x16x32_bf16 v[220:223], a[44:47], v[92:95], v[220:223]
    s_waitcnt vmcnt(24) lgkmcnt(0)
    v_mfma_f32_16x16x32_bf16 v[96:99], a[48:51], v[64:67], v[96:99]
    ds_read_b128 v[80:83], v225 offset:24576
    v_mfma_f32_16x16x32_bf16 v[100:103], a[52:55], v[64:67], v[100:103]
    ds_read_b128 v[84:87], v225 offset:26624
    v_mfma_f32_16x16x32_bf16 v[104:107], a[56:59], v[64:67], v[104:107]
    ds_read_b128 v[88:91], v225 offset:28672
    v_mfma_f32_16x16x32_bf16 v[108:111], a[60:63], v[64:67], v[108:111]
    ds_read_b128 v[92:95], v225 offset:30720
    v_mfma_f32_16x16x32_bf16 v[112:115], a[48:51], v[68:71], v[112:115]
    ds_read_b64_tr_b16 a[64:65], v228 offset:16384
    v_mfma_f32_16x16x32_bf16 v[116:119], a[52:55], v[68:71], v[116:119]
    ds_read_b64_tr_b16 a[66:67], v228 offset:16896
    v_mfma_f32_16x16x32_bf16 v[120:123], a[56:59], v[68:71], v[120:123]
    ds_read_b64_tr_b16 a[68:69], v229 offset:16384
    v_mfma_f32_16x16x32_bf16 v[124:127], a[60:63], v[68:71], v[124:127]
    ds_read_b64_tr_b16 a[70:71], v229 offset:16896
    v_mfma_f32_16x16x32_bf16 v[128:131], a[48:51], v[72:75], v[128:131]
    s_add_u32 m0, s35, 8192
    s_and_b32 s33, s84, 1023
    s_lshl_b32 s33, s33, 12
    buffer_load_dwordx4 v234, s[48:51], s33 offen lds
    v_mfma_f32_16x16x32_bf16 v[132:135], a[52:55], v[72:75], v[132:135]
    v_mfma_f32_16x16x32_bf16 v[136:139], a[56:59], v[72:75], v[136:139]
    buffer_load_dwordx4 v235, s[48:51], s33 offen offset:1024 lds
    v_mfma_f32_16x16x32_bf16 v[140:143], a[60:63], v[72:75], v[140:143]
    v_mfma_f32_16x16x32_bf16 v[144:147], a[48:51], v[76:79], v[144:147]
    s_add_u32 m0, s35, 10240
    s_add_u32 s33, s33, 131072
    buffer_load_dwordx4 v234, s[48:51], s33 offen lds
    v_mfma_f32_16x16x32_bf16 v[148:151], a[52:55], v[76:79], v[148:151]
    v_mfma_f32_16x16x32_bf16 v[152:155], a[56:59], v[76:79], v[152:155]
    buffer_load_dwordx4 v235, s[48:51], s33 offen offset:1024 lds
    v_mfma_f32_16x16x32_bf16 v[156:159], a[60:63], v[76:79], v[156:159]
    s_waitcnt vmcnt(24) lgkmcnt(0)
    s_barrier
    v_mfma_f32_16x16x32_bf16 v[160:163], a[48:51], v[80:83], v[160:163]
    ds_read_b128 v[64:67], v224 offset:32768
    v_mfma_f32_16x16x32_bf16 v[164:167], a[52:55], v[80:83], v[164:167]
    ds_read_b128 v[68:71], v224 offset:34816
    v_mfma_f32_16x16x32_bf16 v[168:171], a[56:59], v[80:83], v[168:171]
    ds_read_b128 v[72:75], v224 offset:36864
    v_mfma_f32_16x16x32_bf16 v[172:175], a[60:63], v[80:83], v[172:175]
    ds_read_b128 v[76:79], v224 offset:38912
    v_mfma_f32_16x16x32_bf16 v[176:179], a[48:51], v[84:87], v[176:179]
    ds_read_b64_tr_b16 a[72:73], v230 offset:16384
    v_mfma_f32_16x16x32_bf16 v[180:183], a[52:55], v[84:87], v[180:183]
    ds_read_b64_tr_b16 a[74:75], v230 offset:16896
    v_mfma_f32_16x16x32_bf16 v[184:187], a[56:59], v[84:87], v[184:187]
    ds_read_b64_tr_b16 a[76:77], v231 offset:16384
    v_mfma_f32_16x16x32_bf16 v[188:191], a[60:63], v[84:87], v[188:191]
    ds_read_b64_tr_b16 a[78:79], v231 offset:16896
    v_mfma_f32_16x16x32_bf16 v[192:195], a[48:51], v[88:91], v[192:195]
    s_add_u32 m0, s34, 16384
    s_add_u32 s37, s85, 0
    buffer_load_dwordx4 v232, s[44:47], s37 offen lds
    v_mfma_f32_16x16x32_bf16 v[196:199], a[52:55], v[88:91], v[196:199]
    v_mfma_f32_16x16x32_bf16 v[200:203], a[56:59], v[88:91], v[200:203]
    v_mfma_f32_16x16x32_bf16 v[204:207], a[60:63], v[88:91], v[204:207]
    v_mfma_f32_16x16x32_bf16 v[208:211], a[48:51], v[92:95], v[208:211]
    buffer_load_dwordx4 v233, s[44:47], s37 offen offset:1024 lds
    v_mfma_f32_16x16x32_bf16 v[212:215], a[52:55], v[92:95], v[212:215]
    v_mfma_f32_16x16x32_bf16 v[216:219], a[56:59], v[92:95], v[216:219]
    v_mfma_f32_16x16x32_bf16 v[220:223], a[60:63], v[92:95], v[220:223]
    s_waitcnt lgkmcnt(0)
    v_mfma_f32_16x16x32_bf16 v[96:99], a[64:67], v[64:67], v[96:99]
    ds_read_b128 v[80:83], v224 offset:40960
    v_mfma_f32_16x16x32_bf16 v[100:103], a[68:71], v[64:67], v[100:103]
    ds_read_b128 v[84:87], v224 offset:43008
    v_mfma_f32_16x16x32_bf16 v[104:107], a[72:75], v[64:67], v[104:107]
    ds_read_b128 v[88:91], v224 offset:45056
    v_mfma_f32_16x16x32_bf16 v[108:111], a[76:79], v[64:67], v[108:111]
    ds_read_b128 v[92:95], v224 offset:47104
    v_mfma_f32_16x16x32_bf16 v[112:115], a[64:67], v[68:71], v[112:115]
    ds_read_b64_tr_b16 a[80:81], v228 offset:20480
    v_mfma_f32_16x16x32_bf16 v[116:119], a[68:71], v[68:71], v[116:119]
    ds_read_b64_tr_b16 a[82:83], v228 offset:20992
    v_mfma_f32_16x16x32_bf16 v[120:123], a[72:75], v[68:71], v[120:123]
    ds_read_b64_tr_b16 a[84:85], v229 offset:20480
    v_mfma_f32_16x16x32_bf16 v[124:127], a[76:79], v[68:71], v[124:127]
    ds_read_b64_tr_b16 a[86:87], v229 offset:20992
    v_mfma_f32_16x16x32_bf16 v[128:131], a[64:67], v[72:75], v[128:131]
    s_add_u32 m0, s35, 12288
    s_add_u32 s33, s33, 131072
    buffer_load_dwordx4 v234, s[48:51], s33 offen lds
    v_mfma_f32_16x16x32_bf16 v[132:135], a[68:71], v[72:75], v[132:135]
    v_mfma_f32_16x16x32_bf16 v[136:139], a[72:75], v[72:75], v[136:139]
    buffer_load_dwordx4 v235, s[48:51], s33 offen offset:1024 lds
    v_mfma_f32_16x16x32_bf16 v[140:143], a[76:79], v[72:75], v[140:143]
    v_mfma_f32_16x16x32_bf16 v[144:147], a[64:67], v[76:79], v[144:147]
    s_add_u32 m0, s35, 14336
    s_add_u32 s33, s33, 131072
    buffer_load_dwordx4 v234, s[48:51], s33 offen lds
    v_mfma_f32_16x16x32_bf16 v[148:151], a[68:71], v[76:79], v[148:151]
    v_mfma_f32_16x16x32_bf16 v[152:155], a[72:75], v[76:79], v[152:155]
    buffer_load_dwordx4 v235, s[48:51], s33 offen offset:1024 lds
    v_mfma_f32_16x16x32_bf16 v[156:159], a[76:79], v[76:79], v[156:159]
    s_waitcnt lgkmcnt(0)
    v_mfma_f32_16x16x32_bf16 v[160:163], a[64:67], v[80:83], v[160:163]
    ds_read_b128 v[64:67], v225 offset:32768
    v_mfma_f32_16x16x32_bf16 v[164:167], a[68:71], v[80:83], v[164:167]
    ds_read_b128 v[68:71], v225 offset:34816
    v_mfma_f32_16x16x32_bf16 v[168:171], a[72:75], v[80:83], v[168:171]
    ds_read_b128 v[72:75], v225 offset:36864
    v_mfma_f32_16x16x32_bf16 v[172:175], a[76:79], v[80:83], v[172:175]
    ds_read_b128 v[76:79], v225 offset:38912
    v_mfma_f32_16x16x32_bf16 v[176:179], a[64:67], v[84:87], v[176:179]
    ds_read_b64_tr_b16 a[88:89], v230 offset:20480
    v_mfma_f32_16x16x32_bf16 v[180:183], a[68:71], v[84:87], v[180:183]
    ds_read_b64_tr_b16 a[90:91], v230 offset:20992
    v_mfma_f32_16x16x32_bf16 v[184:187], a[72:75], v[84:87], v[184:187]
    ds_read_b64_tr_b16 a[92:93], v231 offset:20480
    v_mfma_f32_16x16x32_bf16 v[188:191], a[76:79], v[84:87], v[188:191]
    ds_read_b64_tr_b16 a[94:95], v231 offset:20992
    v_mfma_f32_16x16x32_bf16 v[192:195], a[64:67], v[88:91], v[192:195]
    s_add_u32 m0, s34, 24576
    s_add_u32 s37, s85, 65536
    buffer_load_dwordx4 v232, s[44:47], s37 offen lds
    v_mfma_f32_16x16x32_bf16 v[196:199], a[68:71], v[88:91], v[196:199]
    v_mfma_f32_16x16x32_bf16 v[200:203], a[72:75], v[88:91], v[200:203]
    v_mfma_f32_16x16x32_bf16 v[204:207], a[76:79], v[88:91], v[204:207]
    v_mfma_f32_16x16x32_bf16 v[208:211], a[64:67], v[92:95], v[208:211]
    buffer_load_dwordx4 v233, s[44:47], s37 offen offset:1024 lds
    v_mfma_f32_16x16x32_bf16 v[212:215], a[68:71], v[92:95], v[212:215]
    v_mfma_f32_16x16x32_bf16 v[216:219], a[72:75], v[92:95], v[216:219]
    v_mfma_f32_16x16x32_bf16 v[220:223], a[76:79], v[92:95], v[220:223]
    s_waitcnt vmcnt(14) lgkmcnt(0)
    v_mfma_f32_16x16x32_bf16 v[96:99], a[80:83], v[64:67], v[96:99]
    ds_read_b128 v[80:83], v225 offset:40960
    s_waitcnt vmcnt(18)
    v_mfma_f32_16x16x32_bf16 v[100:103], a[84:87], v[64:67], v[100:103]
    ds_read_b128 v[84:87], v225 offset:43008
    v_lshlrev_b32 v16, 16, v0
    v_mfma_f32_16x16x32_bf16 v[104:107], a[88:91], v[64:67], v[104:107]
    ds_read_b128 v[88:91], v225 offset:45056
    v_and_b32 v17, 0xffff0000, v0
    v_lshlrev_b32_e64 v18, 16, v1
    v_mfma_f32_16x16x32_bf16 v[108:111], a[92:95], v[64:67], v[108:111]
    ds_read_b128 v[92:95], v225 offset:47104
    v_and_b32 v19, 0xffff0000, v1
    v_mfma_f32_16x16x32_bf16 v[112:115], a[80:83], v[68:71], v[112:115]
    ds_read_b64_tr_b16 a[96:97], v228 offset:0
    v_lshlrev_b32_e64 v20, 16, v2
    v_mfma_f32_16x16x32_bf16 v[116:119], a[84:87], v[68:71], v[116:119]
    ds_read_b64_tr_b16 a[98:99], v228 offset:512
    v_and_b32 v21, 0xffff0000, v2
    v_mfma_f32_16x16x32_bf16 v[120:123], a[88:91], v[68:71], v[120:123]
    ds_read_b64_tr_b16 a[100:101], v229 offset:0
    v_lshlrev_b32_e64 v22, 16, v3
    v_mfma_f32_16x16x32_bf16 v[124:127], a[92:95], v[68:71], v[124:127]
    ds_read_b64_tr_b16 a[102:103], v229 offset:512
    v_and_b32 v23, 0xffff0000, v3
    v_lshlrev_b32_e64 v24, 16, v4
    v_mfma_f32_16x16x32_bf16 v[128:131], a[80:83], v[72:75], v[128:131]
    s_add_u32 m0, s35, 16384
    s_and_b32 s33, s85, 1023
    s_lshl_b32 s33, s33, 12
    buffer_load_dwordx4 v234, s[48:51], s33 offen lds
    v_mfma_f32_16x16x32_bf16 v[132:135], a[84:87], v[72:75], v[132:135]
    buffer_load_dwordx4 v235, s[48:51], s33 offen offset:1024 lds
    v_and_b32 v25, 0xffff0000, v4
    v_mfma_f32_16x16x32_bf16 v[136:139], a[88:91], v[72:75], v[136:139]
    s_add_u32 m0, s35, 18432
    s_add_u32 s33, s33, 131072
    buffer_load_dwordx4 v234, s[48:51], s33 offen lds
    v_mfma_f32_16x16x32_bf16 v[140:143], a[92:95], v[72:75], v[140:143]
    v_lshlrev_b32 v26, 16, v5
    v_and_b32 v27, 0xffff0000, v5
    v_mfma_f32_16x16x32_bf16 v[144:147], a[80:83], v[76:79], v[144:147]
    buffer_load_dwordx4 v235, s[48:51], s33 offen offset:1024 lds
    v_lshlrev_b32_e64 v28, 16, v6
    v_mfma_f32_16x16x32_bf16 v[148:151], a[84:87], v[76:79], v[148:151]
    s_lshl2_add_u32 s26, s4, s3
    s_lshl_b32 s26, s26, 10
    s_add_u32 s26, s26, s32
    s_add_u32 s26, s26, 131072
    v_mfma_f32_16x16x32_bf16 v[152:155], a[88:91], v[76:79], v[152:155]
    v_and_b32 v226, 0x40000380, v251
    buffer_load_dword v241, v226, s[44:47], s26 offen
    v_mfma_f32_16x16x32_bf16 v[156:159], a[92:95], v[76:79], v[156:159]
    s_waitcnt vmcnt(29) lgkmcnt(0)
    s_barrier
    v_mfma_f32_16x16x32_bf16 v[160:163], a[80:83], v[80:83], v[160:163]
    ds_read_b128 v[64:67], v224 offset:49152
    v_and_b32 v29, 0xffff0000, v6
    v_lshlrev_b32 v30, 16, v7
    v_mfma_f32_16x16x32_bf16 v[164:167], a[84:87], v[80:83], v[164:167]
    ds_read_b128 v[68:71], v224 offset:51200
    v_and_b32 v31, 0xffff0000, v7
    v_mfma_f32_16x16x32_bf16 v[168:171], a[88:91], v[80:83], v[168:171]
    ds_read_b128 v[72:75], v224 offset:53248
    v_lshlrev_b32_e64 v32, 16, v8
    v_mfma_f32_16x16x32_bf16 v[172:175], a[92:95], v[80:83], v[172:175]
    ds_read_b128 v[76:79], v224 offset:55296
    v_and_b32 v33, 0xffff0000, v8
    v_mfma_f32_16x16x32_bf16 v[176:179], a[80:83], v[84:87], v[176:179]
    ds_read_b64_tr_b16 a[104:105], v230 offset:0
    v_lshlrev_b32_e64 v34, 16, v9
    v_mfma_f32_16x16x32_bf16 v[180:183], a[84:87], v[84:87], v[180:183]
    ds_read_b64_tr_b16 a[106:107], v230 offset:512
    v_and_b32 v35, 0xffff0000, v9
    v_lshlrev_b32_e64 v36, 16, v10
    v_mfma_f32_16x16x32_bf16 v[184:187], a[88:91], v[84:87], v[184:187]
    ds_read_b64_tr_b16 a[108:109], v231 offset:0
    v_and_b32 v37, 0xffff0000, v10
    v_mfma_f32_16x16x32_bf16 v[188:191], a[92:95], v[84:87], v[188:191]
    ds_read_b64_tr_b16 a[110:111], v231 offset:512
    v_lshlrev_b32_e64 v38, 16, v11
    v_mfma_f32_16x16x32_bf16 v[192:195], a[80:83], v[88:91], v[192:195]
    s_add_u32 m0, s34, 32768
    s_add_u32 s37, s86, 0
    buffer_load_dwordx4 v232, s[44:47], s37 offen lds
    v_mfma_f32_16x16x32_bf16 v[196:199], a[84:87], v[88:91], v[196:199]
    v_and_b32 v39, 0xffff0000, v11
    v_lshlrev_b32 v40, 16, v12
    v_mfma_f32_16x16x32_bf16 v[200:203], a[88:91], v[88:91], v[200:203]
    v_and_b32 v41, 0xffff0000, v12
    v_lshlrev_b32_e64 v42, 16, v13
    v_and_b32 v43, 0xffff0000, v13
    v_mfma_f32_16x16x32_bf16 v[204:207], a[92:95], v[88:91], v[204:207]
    v_lshlrev_b32_e64 v44, 16, v14
    v_and_b32 v45, 0xffff0000, v14
    v_mfma_f32_16x16x32_bf16 v[208:211], a[80:83], v[92:95], v[208:211]
    buffer_load_dwordx4 v233, s[44:47], s37 offen offset:1024 lds
    v_lshlrev_b32_e64 v46, 16, v15
    v_mfma_f32_16x16x32_bf16 v[212:215], a[84:87], v[92:95], v[212:215]
    v_and_b32 v47, 0xffff0000, v15
    v_add_f32 v52, v16, v20
    v_add_f32 v53, v17, v21
    v_mfma_f32_16x16x32_bf16 v[216:219], a[88:91], v[92:95], v[216:219]
    v_add_f32 v54, v18, v22
    v_add_f32 v55, v19, v23
    v_mfma_f32_16x16x32_bf16 v[220:223], a[92:95], v[92:95], v[220:223]
    v_add_f32 v52, v52, v24
    s_waitcnt lgkmcnt(0)
    v_mfma_f32_16x16x32_bf16 v[96:99], a[96:99], v[64:67], v[96:99]
    ds_read_b128 v[80:83], v224 offset:57344
    v_add_f32 v53, v53, v25
    v_add_f32 v54, v54, v26
    v_mfma_f32_16x16x32_bf16 v[100:103], a[100:103], v[64:67], v[100:103]
    ds_read_b128 v[84:87], v224 offset:59392
    v_add_f32_e64 v55, v55, v27
    v_mfma_f32_16x16x32_bf16 v[104:107], a[104:107], v[64:67], v[104:107]
    ds_read_b128 v[88:91], v224 offset:61440
    v_add_f32_e64 v52, v52, v28
    v_mfma_f32_16x16x32_bf16 v[108:111], a[108:111], v[64:67], v[108:111]
    ds_read_b128 v[92:95], v224 offset:63488
    v_add_f32_e64 v53, v53, v29
    v_mfma_f32_16x16x32_bf16 v[112:115], a[96:99], v[68:71], v[112:115]
    ds_read_b64_tr_b16 a[112:113], v228 offset:4096
    v_add_f32_e64 v54, v54, v30
    v_mfma_f32_16x16x32_bf16 v[116:119], a[100:103], v[68:71], v[116:119]
    ds_read_b64_tr_b16 a[114:115], v228 offset:4608
    v_add_f32 v55, v55, v31
    v_add_f32 v52, v52, v32
    v_mfma_f32_16x16x32_bf16 v[120:123], a[104:107], v[68:71], v[120:123]
    ds_read_b64_tr_b16 a[116:117], v229 offset:4096
    v_add_f32_e64 v53, v53, v33
    v_mfma_f32_16x16x32_bf16 v[124:127], a[108:111], v[68:71], v[124:127]
    ds_read_b64_tr_b16 a[118:119], v229 offset:4608
    v_add_f32_e64 v54, v54, v34
    v_mfma_f32_16x16x32_bf16 v[128:131], a[96:99], v[72:75], v[128:131]
    s_add_u32 m0, s35, 20480
    s_add_u32 s33, s33, 131072
    buffer_load_dwordx4 v234, s[48:51], s33 offen lds
    v_mfma_f32_16x16x32_bf16 v[132:135], a[100:103], v[72:75], v[132:135]
    v_add_f32 v55, v55, v35
    v_add_f32 v52, v52, v36
    v_mfma_f32_16x16x32_bf16 v[136:139], a[104:107], v[72:75], v[136:139]
    buffer_load_dwordx4 v235, s[48:51], s33 offen offset:1024 lds
    v_add_f32 v53, v53, v37
    v_add_f32 v54, v54, v38
    v_mfma_f32_16x16x32_bf16 v[140:143], a[108:111], v[72:75], v[140:143]
    v_add_f32 v55, v55, v39
    v_add_f32 v52, v52, v40
    v_mfma_f32_16x16x32_bf16 v[144:147], a[96:99], v[76:79], v[144:147]
    s_add_u32 m0, s35, 22528
    s_add_u32 s33, s33, 131072
    buffer_load_dwordx4 v234, s[48:51], s33 offen lds
    v_mfma_f32_16x16x32_bf16 v[148:151], a[100:103], v[76:79], v[148:151]
    v_add_f32 v53, v53, v41
    v_add_f32 v54, v54, v42
    v_mfma_f32_16x16x32_bf16 v[152:155], a[104:107], v[76:79], v[152:155]
    buffer_load_dwordx4 v235, s[48:51], s33 offen offset:1024 lds
    v_add_f32 v55, v55, v43
    v_add_f32 v52, v52, v44
    v_mfma_f32_16x16x32_bf16 v[156:159], a[108:111], v[76:79], v[156:159]
    v_add_f32 v53, v53, v45
    s_waitcnt lgkmcnt(0)
    v_mfma_f32_16x16x32_bf16 v[160:163], a[96:99], v[80:83], v[160:163]
    ds_read_b128 v[64:67], v225 offset:49152
    v_add_f32_e64 v54, v54, v46
    v_mfma_f32_16x16x32_bf16 v[164:167], a[100:103], v[80:83], v[164:167]
    ds_read_b128 v[68:71], v225 offset:51200
    v_add_f32_e64 v55, v55, v47
    v_mfma_f32_16x16x32_bf16 v[168:171], a[104:107], v[80:83], v[168:171]
    ds_read_b128 v[72:75], v225 offset:53248
    v_add_f32_e64 v52, v52, v53
    v_mfma_f32_16x16x32_bf16 v[172:175], a[108:111], v[80:83], v[172:175]
    ds_read_b128 v[76:79], v225 offset:55296
    v_add_f32 v54, v54, v55
    v_add_f32 v48, v52, v54
    v_mfma_f32_16x16x32_bf16 v[176:179], a[96:99], v[84:87], v[176:179]
    ds_read_b64_tr_b16 a[120:121], v230 offset:4096
    s_nop 1
    v_mfma_f32_16x16x32_bf16 v[180:183], a[100:103], v[84:87], v[180:183]
    ds_read_b64_tr_b16 a[122:123], v230 offset:4608
    v_add_f32_dpp v48, v48, v48 quad_perm:[1,0,3,2] row_mask:0xf bank_mask:0xf
    v_mfma_f32_16x16x32_bf16 v[184:187], a[104:107], v[84:87], v[184:187]
    ds_read_b64_tr_b16 a[124:125], v231 offset:4096
    s_nop 1
    v_mfma_f32_16x16x32_bf16 v[188:191], a[108:111], v[84:87], v[188:191]
    ds_read_b64_tr_b16 a[126:127], v231 offset:4608
    v_add_f32_dpp v48, v48, v48 quad_perm:[2,3,0,1] row_mask:0xf bank_mask:0xf
    v_mfma_f32_16x16x32_bf16 v[192:195], a[96:99], v[88:91], v[192:195]
    s_add_u32 m0, s34, 40960
    s_add_u32 s37, s86, 65536
    buffer_load_dwordx4 v232, s[44:47], s37 offen lds
    v_mfma_f32_16x16x32_bf16 v[196:199], a[100:103], v[88:91], v[196:199]
    s_nop 1
    v_add_f32_dpp v48, v48, v48 row_half_mirror row_mask:0xf bank_mask:0xf
    s_nop 1
    v_mfma_f32_16x16x32_bf16 v[200:203], a[104:107], v[88:91], v[200:203]
    buffer_load_dwordx4 v233, s[44:47], s37 offen offset:1024 lds
    v_add_f32_dpp v48, v48, v48 row_mirror row_mask:0xf bank_mask:0xf
    v_mfma_f32_16x16x32_bf16 v[204:207], a[108:111], v[88:91], v[204:207]
    s_nop 0
    v_mov_b32 v49, v48
    v_mfma_f32_16x16x32_bf16 v[208:211], a[96:99], v[92:95], v[208:211]
    v_lshlrev_b32_e64 v227, 3, v240
    v_min_u32 v227, 1920, v227
    s_lshl2_add_u32 s25, s2, s3
    v_mfma_f32_16x16x32_bf16 v[212:215], a[100:103], v[92:95], v[212:215]
    s_nop 1
    v_permlane16_swap_b32 v48, v49
    s_nop 0
    v_mfma_f32_16x16x32_bf16 v[216:219], a[104:107], v[92:95], v[216:219]
    s_lshl_b32 s25, s25, 13
    s_add_u32 s25, s25, 0
    buffer_load_dword v241, v227, s[12:15], s25 offen
    v_mfma_f32_16x16x32_bf16 v[220:223], a[108:111], v[92:95], v[220:223]
    v_add_f32 v48, v48, v49
    s_waitcnt vmcnt(16) lgkmcnt(0)
    v_mfma_f32_16x16x32_bf16 v[96:99], a[112:115], v[64:67], v[96:99]
    ds_read_b128 v[80:83], v225 offset:57344
    v_mul_f32 v48, 0x3a800000, v48
    v_mfma_f32_16x16x32_bf16 v[100:103], a[116:119], v[64:67], v[100:103]
    ds_read_b128 v[84:87], v225 offset:59392
    v_sub_f32 v56, v16, v48
    v_mul_f32 v52, v56, v56
    v_mfma_f32_16x16x32_bf16 v[104:107], a[120:123], v[64:67], v[104:107]
    ds_read_b128 v[88:91], v225 offset:61440
    v_sub_f32_e64 v57, v17, v48
    v_mfma_f32_16x16x32_bf16 v[108:111], a[124:127], v[64:67], v[108:111]
    ds_read_b128 v[92:95], v225 offset:63488
    v_mul_f32_e64 v53, v57, v57
    v_mfma_f32_16x16x32_bf16 v[112:115], a[112:115], v[68:71], v[112:115]
    ds_read_b64_tr_b16 a[128:129], v228 offset:8192
    v_sub_f32_e64 v58, v18, v48
    v_mfma_f32_16x16x32_bf16 v[116:119], a[116:119], v[68:71], v[116:119]
    ds_read_b64_tr_b16 a[130:131], v228 offset:8704
    v_mul_f32_e64 v54, v58, v58
    v_mfma_f32_16x16x32_bf16 v[120:123], a[120:123], v[68:71], v[120:123]
    ds_read_b64_tr_b16 a[132:133], v229 offset:8192
    v_sub_f32 v59, v19, v48
    v_mul_f32 v55, v59, v59
    v_mfma_f32_16x16x32_bf16 v[124:127], a[124:127], v[68:71], v[124:127]
    ds_read_b64_tr_b16 a[134:135], v229 offset:8704
    v_sub_f32_e64 v56, v20, v48
    v_mfma_f32_16x16x32_bf16 v[128:131], a[112:115], v[72:75], v[128:131]
    s_add_u32 m0, s35, 0
    s_and_b32 s33, s86, 1023
    s_lshl_b32 s33, s33, 12
    buffer_load_dwordx4 v234, s[48:51], s33 offen lds
    v_mfma_f32_16x16x32_bf16 v[132:135], a[116:119], v[72:75], v[132:135]
    v_fmac_f32 v52, v56, v56
    v_sub_f32 v57, v21, v48
    v_mfma_f32_16x16x32_bf16 v[136:139], a[120:123], v[72:75], v[136:139]
    buffer_load_dwordx4 v235, s[48:51], s33 offen offset:1024 lds
    v_fmac_f32_e64 v53, v57, v57
    v_mfma_f32_16x16x32_bf16 v[140:143], a[124:127], v[72:75], v[140:143]
    v_sub_f32 v58, v22, v48
    v_fmac_f32 v54, v58, v58
    v_sub_f32_e64 v59, v23, v48
    v_mfma_f32_16x16x32_bf16 v[144:147], a[112:115], v[76:79], v[144:147]
    s_add_u32 m0, s35, 2048
    s_add_u32 s33, s33, 131072
    buffer_load_dwordx4 v234, s[48:51], s33 offen lds
    v_mfma_f32_16x16x32_bf16 v[148:151], a[116:119], v[76:79], v[148:151]
    v_fmac_f32 v55, v59, v59
    v_sub_f32 v56, v24, v48
    v_mfma_f32_16x16x32_bf16 v[152:155], a[120:123], v[76:79], v[152:155]
    buffer_load_dwordx4 v235, s[48:51], s33 offen offset:1024 lds
    v_fmac_f32_e64 v52, v56, v56
    v_mfma_f32_16x16x32_bf16 v[156:159], a[124:127], v[76:79], v[156:159]
    s_waitcnt vmcnt(30) lgkmcnt(0)
    s_barrier
    v_mfma_f32_16x16x32_bf16 v[160:163], a[112:115], v[80:83], v[160:163]
    ds_read_b128 v[64:67], v224 offset:0
    v_sub_f32 v57, v25, v48
    v_fmac_f32 v53, v57, v57
    v_mfma_f32_16x16x32_bf16 v[164:167], a[116:119], v[80:83], v[164:167]
    ds_read_b128 v[68:71], v224 offset:2048
    v_sub_f32_e64 v58, v26, v48
    v_mfma_f32_16x16x32_bf16 v[168:171], a[120:123], v[80:83], v[168:171]
    ds_read_b128 v[72:75], v224 offset:4096
    v_fmac_f32_e64 v54, v58, v58
    v_mfma_f32_16x16x32_bf16 v[172:175], a[124:127], v[80:83], v[172:175]
    ds_read_b128 v[76:79], v224 offset:6144
    v_sub_f32_e64 v59, v27, v48
    v_mfma_f32_16x16x32_bf16 v[176:179], a[112:115], v[84:87], v[176:179]
    ds_read_b64_tr_b16 a[136:137], v230 offset:8192
    v_fmac_f32_e64 v55, v59, v59
    v_mfma_f32_16x16x32_bf16 v[180:183], a[116:119], v[84:87], v[180:183]
    ds_read_b64_tr_b16 a[138:139], v230 offset:8704
    v_sub_f32 v56, v28, v48
    v_fmac_f32 v52, v56, v56
    v_mfma_f32_16x16x32_bf16 v[184:187], a[120:123], v[84:87], v[184:187]
    ds_read_b64_tr_b16 a[140:141], v231 offset:8192
    v_sub_f32_e64 v57, v29, v48
    v_mfma_f32_16x16x32_bf16 v[188:191], a[124:127], v[84:87], v[188:191]
    ds_read_b64_tr_b16 a[142:143], v231 offset:8704
    v_fmac_f32_e64 v53, v57, v57
    v_mfma_f32_16x16x32_bf16 v[192:195], a[112:115], v[88:91], v[192:195]
    s_add_u32 m0, s34, 49152
    s_add_u32 s37, s87, 0
    buffer_load_dwordx4 v232, s[44:47], s37 offen lds
    v_mfma_f32_16x16x32_bf16 v[196:199], a[116:119], v[88:91], v[196:199]
    v_sub_f32 v58, v30, v48
    v_fmac_f32_e64 v54, v58, v58
    v_mfma_f32_16x16x32_bf16 v[200:203], a[120:123], v[88:91], v[200:203]
    v_sub_f32 v59, v31, v48
    v_fmac_f32 v55, v59, v59
    v_sub_f32_e64 v56, v32, v48
    v_mfma_f32_16x16x32_bf16 v[204:207], a[124:127], v[88:91], v[204:207]
    v_fmac_f32 v52, v56, v56
    v_sub_f32 v57, v33, v48
    v_mfma_f32_16x16x32_bf16 v[208:211], a[112:115], v[92:95], v[208:211]
    buffer_load_dwordx4 v233, s[44:47], s37 offen offset:1024 lds
    v_fmac_f32_e64 v53, v57, v57
    v_mfma_f32_16x16x32_bf16 v[212:215], a[116:119], v[92:95], v[212:215]
    v_sub_f32 v58, v34, v48
    v_fmac_f32 v54, v58, v58
    v_sub_f32_e64 v59, v35, v48
    v_mfma_f32_16x16x32_bf16 v[216:219], a[120:123], v[92:95], v[216:219]
    v_fmac_f32 v55, v59, v59
    v_sub_f32 v56, v36, v48
    v_mfma_f32_16x16x32_bf16 v[220:223], a[124:127], v[92:95], v[220:223]
    v_fmac_f32 v52, v56, v56
    s_waitcnt lgkmcnt(0)
    v_mfma_f32_16x16x32_bf16 v[96:99], a[128:131], v[64:67], v[96:99]
    ds_read_b128 v[80:83], v224 offset:8192
    v_sub_f32 v57, v37, v48
    v_fmac_f32 v53, v57, v57
    v_mfma_f32_16x16x32_bf16 v[100:103], a[132:135], v[64:67], v[100:103]
    ds_read_b128 v[84:87], v224 offset:10240
    v_sub_f32_e64 v58, v38, v48
    v_mfma_f32_16x16x32_bf16 v[104:107], a[136:139], v[64:67], v[104:107]
    ds_read_b128 v[88:91], v224 offset:12288
    v_fmac_f32_e64 v54, v58, v58
    v_mfma_f32_16x16x32_bf16 v[108:111], a[140:143], v[64:67], v[108:111]
    ds_read_b128 v[92:95], v224 offset:14336
    v_sub_f32_e64 v59, v39, v48
    v_mfma_f32_16x16x32_bf16 v[112:115], a[128:131], v[68:71], v[112:115]
    ds_read_b64_tr_b16 a[144:145], v228 offset:12288
    v_fmac_f32_e64 v55, v59, v59
    v_mfma_f32_16x16x32_bf16 v[116:119], a[132:135], v[68:71], v[116:119]
    ds_read_b64_tr_b16 a[146:147], v228 offset:12800
    v_sub_f32 v56, v40, v48
    v_fmac_f32 v52, v56, v56
    v_mfma_f32_16x16x32_bf16 v[120:123], a[136:139], v[68:71], v[120:123]
    ds_read_b64_tr_b16 a[148:149], v229 offset:12288
    v_sub_f32_e64 v57, v41, v48
    v_mfma_f32_16x16x32_bf16 v[124:127], a[140:143], v[68:71], v[124:127]
    ds_read_b64_tr_b16 a[150:151], v229 offset:12800
    v_fmac_f32_e64 v53, v57, v57
    v_mfma_f32_16x16x32_bf16 v[128:131], a[128:131], v[72:75], v[128:131]
    s_add_u32 m0, s35, 4096
    s_add_u32 s33, s33, 131072
    buffer_load_dwordx4 v234, s[48:51], s33 offen lds
    v_mfma_f32_16x16x32_bf16 v[132:135], a[132:135], v[72:75], v[132:135]
    v_sub_f32 v58, v42, v48
    v_fmac_f32 v54, v58, v58
    v_mfma_f32_16x16x32_bf16 v[136:139], a[136:139], v[72:75], v[136:139]
    buffer_load_dwordx4 v235, s[48:51], s33 offen offset:1024 lds
    v_sub_f32 v59, v43, v48
    v_fmac_f32 v55, v59, v59
    v_mfma_f32_16x16x32_bf16 v[140:143], a[140:143], v[72:75], v[140:143]
    v_sub_f32 v56, v44, v48
    v_fmac_f32 v52, v56, v56
    v_mfma_f32_16x16x32_bf16 v[144:147], a[128:131], v[76:79], v[144:147]
    s_add_u32 m0, s35, 6144
    s_add_u32 s33, s33, 131072
    buffer_load_dwordx4 v234, s[48:51], s33 offen lds
    v_mfma_f32_16x16x32_bf16 v[148:151], a[132:135], v[76:79], v[148:151]
    v_sub_f32 v57, v45, v48
    v_fmac_f32 v53, v57, v57
    v_mfma_f32_16x16x32_bf16 v[152:155], a[136:139], v[76:79], v[152:155]
    buffer_load_dwordx4 v235, s[48:51], s33 offen offset:1024 lds
    v_sub_f32 v58, v46, v48
    v_fmac_f32 v54, v58, v58
    v_mfma_f32_16x16x32_bf16 v[156:159], a[140:143], v[76:79], v[156:159]
    v_sub_f32 v59, v47, v48
    s_waitcnt lgkmcnt(0)
    v_mfma_f32_16x16x32_bf16 v[160:163], a[128:131], v[80:83], v[160:163]
    ds_read_b128 v[64:67], v225 offset:0
    v_fmac_f32_e64 v55, v59, v59
    v_mfma_f32_16x16x32_bf16 v[164:167], a[132:135], v[80:83], v[164:167]
    ds_read_b128 v[68:71], v225 offset:2048
    v_add_f32_e64 v52, v52, v53
    v_mfma_f32_16x16x32_bf16 v[168:171], a[136:139], v[80:83], v[168:171]
    ds_read_b128 v[72:75], v225 offset:4096
    v_add_f32_e64 v54, v54, v55
    v_mfma_f32_16x16x32_bf16 v[172:175], a[140:143], v[80:83], v[172:175]
    ds_read_b128 v[76:79], v225 offset:6144
    v_add_f32 v51, v52, v54
    s_nop 1
    v_mfma_f32_16x16x32_bf16 v[176:179], a[128:131], v[84:87], v[176:179]
    ds_read_b64_tr_b16 a[152:153], v230 offset:12288
    v_add_f32_dpp v51, v51, v51 quad_perm:[1,0,3,2] row_mask:0xf bank_mask:0xf
    v_mfma_f32_16x16x32_bf16 v[180:183], a[132:135], v[84:87], v[180:183]
    ds_read_b64_tr_b16 a[154:155], v230 offset:12800
    s_nop 1
    v_mfma_f32_16x16x32_bf16 v[184:187], a[136:139], v[84:87], v[184:187]
    ds_read_b64_tr_b16 a[156:157], v231 offset:12288
    v_add_f32_dpp v51, v51, v51 quad_perm:[2,3,0,1] row_mask:0xf bank_mask:0xf
    v_mfma_f32_16x16x32_bf16 v[188:191], a[140:143], v[84:87], v[188:191]
    ds_read_b64_tr_b16 a[158:159], v231 offset:12800
    s_nop 1
    v_mfma_f32_16x16x32_bf16 v[192:195], a[128:131], v[88:91], v[192:195]
    s_add_u32 m0, s34, 57344
    s_add_u32 s37, s87, 65536
    buffer_load_dwordx4 v232, s[44:47], s37 offen lds
    v_mfma_f32_16x16x32_bf16 v[196:199], a[132:135], v[88:91], v[196:199]
    v_add_f32_dpp v51, v51, v51 row_half_mirror row_mask:0xf bank_mask:0xf
    s_nop 1
    v_add_f32_dpp v51, v51, v51 row_mirror row_mask:0xf bank_mask:0xf
    v_mfma_f32_16x16x32_bf16 v[200:203], a[136:139], v[88:91], v[200:203]
    buffer_load_dwordx4 v233, s[44:47], s37 offen offset:1024 lds
    s_nop 0
    v_mfma_f32_16x16x32_bf16 v[204:207], a[140:143], v[88:91], v[204:207]
    v_mov_b32 v49, v51
    s_nop 1
    v_mfma_f32_16x16x32_bf16 v[208:211], a[128:131], v[92:95], v[208:211]
    v_lshlrev_b32_e64 v227, 3, v240
    v_min_u32 v227, 1920, v227
    s_lshl2_add_u32 s25, s2, s3
    v_mfma_f32_16x16x32_bf16 v[212:215], a[132:135], v[92:95], v[212:215]
    v_permlane16_swap_b32 v51, v49
    s_nop 0
    v_add_f32 v51, v51, v49
    v_mfma_f32_16x16x32_bf16 v[216:219], a[136:139], v[92:95], v[216:219]
    s_lshl_b32 s25, s25, 13
    s_add_u32 s25, s25, 2048
    buffer_load_dword v241, v227, s[12:15], s25 offen
    v_mfma_f32_16x16x32_bf16 v[220:223], a[140:143], v[92:95], v[220:223]
    v_mul_f32 v51, 0x3a800000, v51
    s_waitcnt vmcnt(16) lgkmcnt(0)
    v_mfma_f32_16x16x32_bf16 v[96:99], a[144:147], v[64:67], v[96:99]
    ds_read_b128 v[80:83], v225 offset:8192
    v_cvt_pk_bf16_f32 v50, v48, v51
    v_mfma_f32_16x16x32_bf16 v[100:103], a[148:151], v[64:67], v[100:103]
    ds_read_b128 v[84:87], v225 offset:10240
    v_and_b32 v51, 0xffff0000, v50
    v_mfma_f32_16x16x32_bf16 v[104:107], a[152:155], v[64:67], v[104:107]
    ds_read_b128 v[88:91], v225 offset:12288
    v_lshlrev_b32_e64 v50, 16, v50
    v_add_f32 v51, 0x3727c5ac, v51
    v_mfma_f32_16x16x32_bf16 v[108:111], a[156:159], v[64:67], v[108:111]
    ds_read_b128 v[92:95], v225 offset:14336
    v_cvt_pk_bf16_f32 v51, v51, v51
    v_mfma_f32_16x16x32_bf16 v[112:115], a[144:147], v[68:71], v[112:115]
    ds_read_b64_tr_b16 a[160:161], v228 offset:16384
    v_lshlrev_b32_e64 v51, 16, v51
    v_mfma_f32_16x16x32_bf16 v[116:119], a[148:151], v[68:71], v[116:119]
    ds_read_b64_tr_b16 a[162:163], v228 offset:16896
    v_sqrt_f32 v51, v51
    v_mfma_f32_16x16x32_bf16 v[120:123], a[152:155], v[68:71], v[120:123]
    ds_read_b64_tr_b16 a[164:165], v229 offset:16384
    v_mfma_f32_16x16x32_bf16 v[124:127], a[156:159], v[68:71], v[124:127]
    ds_read_b64_tr_b16 a[166:167], v229 offset:16896
    s_nop 0
    v_cvt_pk_bf16_f32 v51, v51, v51
    v_mfma_f32_16x16x32_bf16 v[128:131], a[144:147], v[72:75], v[128:131]
    s_add_u32 m0, s35, 8192
    s_and_b32 s33, s87, 1023
    s_lshl_b32 s33, s33, 12
    buffer_load_dwordx4 v234, s[48:51], s33 offen lds
    v_mfma_f32_16x16x32_bf16 v[132:135], a[148:151], v[72:75], v[132:135]
    v_lshlrev_b32 v51, 16, v51
    v_rcp_f32_e64 v51, v51
    v_mfma_f32_16x16x32_bf16 v[136:139], a[152:155], v[72:75], v[136:139]
    buffer_load_dwordx4 v235, s[48:51], s33 offen offset:1024 lds
    v_mfma_f32_16x16x32_bf16 v[140:143], a[156:159], v[72:75], v[140:143]
    s_nop 0
    v_mul_f32 v51, 0x3e0293ee, v51
    v_sub_f32 v16, v16, v50
    v_mfma_f32_16x16x32_bf16 v[144:147], a[144:147], v[76:79], v[144:147]
    s_add_u32 m0, s35, 10240
    s_add_u32 s33, s33, 131072
    buffer_load_dwordx4 v234, s[48:51], s33 offen lds
    v_mfma_f32_16x16x32_bf16 v[148:151], a[148:151], v[76:79], v[148:151]
    v_sub_f32_e64 v17, v17, v50
    v_cvt_pk_bf16_f32 v17, v16, v17
    v_mfma_f32_16x16x32_bf16 v[152:155], a[152:155], v[76:79], v[152:155]
    buffer_load_dwordx4 v235, s[48:51], s33 offen offset:1024 lds
    v_lshlrev_b32_e64 v16, 16, v17
    v_mfma_f32_16x16x32_bf16 v[156:159], a[156:159], v[76:79], v[156:159]
    s_waitcnt vmcnt(31) lgkmcnt(0)
    s_barrier
    v_mfma_f32_16x16x32_bf16 v[160:163], a[144:147], v[80:83], v[160:163]
    ds_read_b128 v[64:67], v224 offset:16384
    v_and_b32 v17, 0xffff0000, v17
    v_mfma_f32_16x16x32_bf16 v[164:167], a[148:151], v[80:83], v[164:167]
    ds_read_b128 v[68:71], v224 offset:18432
    v_mul_f32 v16, v16, v51
    v_mul_f32 v17, v17, v51
    v_mfma_f32_16x16x32_bf16 v[168:171], a[152:155], v[80:83], v[168:171]
    ds_read_b128 v[72:75], v224 offset:20480
    v_cvt_pk_bf16_f32 v0, v16, v17
    v_mfma_f32_16x16x32_bf16 v[172:175], a[156:159], v[80:83], v[172:175]
    ds_read_b128 v[76:79], v224 offset:22528
    v_sub_f32_e64 v18, v18, v50
    v_mfma_f32_16x16x32_bf16 v[176:179], a[144:147], v[84:87], v[176:179]
    ds_read_b64_tr_b16 a[168:169], v230 offset:16384
    v_sub_f32_e64 v19, v19, v50
    v_mfma_f32_16x16x32_bf16 v[180:183], a[148:151], v[84:87], v[180:183]
    ds_read_b64_tr_b16 a[170:171], v230 offset:16896
    v_cvt_pk_bf16_f32 v19, v18, v19
    v_mfma_f32_16x16x32_bf16 v[184:187], a[152:155], v[84:87], v[184:187]
    ds_read_b64_tr_b16 a[172:173], v231 offset:16384
    v_lshlrev_b32_e64 v18, 16, v19
    v_and_b32 v19, 0xffff0000, v19
    v_mfma_f32_16x16x32_bf16 v[188:191], a[156:159], v[84:87], v[188:191]
    ds_read_b64_tr_b16 a[174:175], v231 offset:16896
    v_mul_f32_e64 v18, v18, v51
    v_mfma_f32_16x16x32_bf16 v[192:195], a[144:147], v[88:91], v[192:195]
    s_add_u32 m0, s34, 0
    s_add_u32 s37, s80, 131072
    buffer_load_dwordx4 v232, s[44:47], s37 offen lds
    v_mfma_f32_16x16x32_bf16 v[196:199], a[148:151], v[88:91], v[196:199]
    v_mul_f32 v19, v19, v51
    v_cvt_pk_bf16_f32 v1, v18, v19
    v_mfma_f32_16x16x32_bf16 v[200:203], a[152:155], v[88:91], v[200:203]
    v_sub_f32 v20, v20, v50
    v_sub_f32 v21, v21, v50
    v_cvt_pk_bf16_f32 v21, v20, v21
    v_mfma_f32_16x16x32_bf16 v[204:207], a[156:159], v[88:91], v[204:207]
    v_lshlrev_b32_e64 v20, 16, v21
    v_and_b32 v21, 0xffff0000, v21
    v_mfma_f32_16x16x32_bf16 v[208:211], a[144:147], v[92:95], v[208:211]
    buffer_load_dwordx4 v233, s[44:47], s37 offen offset:1024 lds
    v_mul_f32_e64 v20, v20, v51
    v_mfma_f32_16x16x32_bf16 v[212:215], a[148:151], v[92:95], v[212:215]
    v_mul_f32_e64 v21, v21, v51
    v_cvt_pk_bf16_f32 v2, v20, v21
    v_sub_f32_e64 v22, v22, v50
    v_mfma_f32_16x16x32_bf16 v[216:219], a[152:155], v[92:95], v[216:219]
    v_sub_f32_e64 v23, v23, v50
    v_cvt_pk_bf16_f32 v23, v22, v23
    v_mfma_f32_16x16x32_bf16 v[220:223], a[156:159], v[92:95], v[220:223]
    v_lshlrev_b32 v22, 16, v23
    s_waitcnt lgkmcnt(0)
    v_mfma_f32_16x16x32_bf16 v[96:99], a[160:163], v[64:67], v[96:99]
    ds_read_b128 v[80:83], v224 offset:24576
    v_and_b32 v23, 0xffff0000, v23
    v_mfma_f32_16x16x32_bf16 v[100:103], a[164:167], v[64:67], v[100:103]
    ds_read_b128 v[84:87], v224 offset:26624
    v_mul_f32 v22, v22, v51
    v_mul_f32 v23, v23, v51
    v_mfma_f32_16x16x32_bf16 v[104:107], a[168:171], v[64:67], v[104:107]
    ds_read_b128 v[88:91], v224 offset:28672
    v_cvt_pk_bf16_f32 v3, v22, v23
    v_mfma_f32_16x16x32_bf16 v[108:111], a[172:175], v[64:67], v[108:111]
    ds_read_b128 v[92:95], v224 offset:30720
    v_sub_f32_e64 v24, v24, v50
    v_mfma_f32_16x16x32_bf16 v[112:115], a[160:163], v[68:71], v[112:115]
    ds_read_b64_tr_b16 a[176:177], v228 offset:20480
    v_sub_f32_e64 v25, v25, v50
    v_mfma_f32_16x16x32_bf16 v[116:119], a[164:167], v[68:71], v[116:119]
    ds_read_b64_tr_b16 a[178:179], v228 offset:20992
    v_cvt_pk_bf16_f32 v25, v24, v25
    v_mfma_f32_16x16x32_bf16 v[120:123], a[168:171], v[68:71], v[120:123]
    ds_read_b64_tr_b16 a[180:181], v229 offset:20480
    v_lshlrev_b32_e64 v24, 16, v25
    v_and_b32 v25, 0xffff0000, v25
    v_mfma_f32_16x16x32_bf16 v[124:127], a[172:175], v[68:71], v[124:127]
    ds_read_b64_tr_b16 a[182:183], v229 offset:20992
    v_mul_f32_e64 v24, v24, v51
    v_mfma_f32_16x16x32_bf16 v[128:131], a[160:163], v[72:75], v[128:131]
    s_add_u32 m0, s35, 12288
    s_add_u32 s33, s33, 131072
    buffer_load_dwordx4 v234, s[48:51], s33 offen lds
    v_mfma_f32_16x16x32_bf16 v[132:135], a[164:167], v[72:75], v[132:135]
    v_mul_f32_e64 v25, v25, v51
    v_cvt_pk_bf16_f32 v4, v24, v25
    v_mfma_f32_16x16x32_bf16 v[136:139], a[168:171], v[72:75], v[136:139]
    buffer_load_dwordx4 v235, s[48:51], s33 offen offset:1024 lds
    v_sub_f32_e64 v26, v26, v50
    v_mfma_f32_16x16x32_bf16 v[140:143], a[172:175], v[72:75], v[140:143]
    v_sub_f32_e64 v27, v27, v50
    v_cvt_pk_bf16_f32 v27, v26, v27
    v_lshlrev_b32_e64 v26, 16, v27
    v_mfma_f32_16x16x32_bf16 v[144:147], a[160:163], v[76:79], v[144:147]
    s_add_u32 m0, s35, 14336
    s_add_u32 s33, s33, 131072
    buffer_load_dwordx4 v234, s[48:51], s33 offen lds
    v_mfma_f32_16x16x32_bf16 v[148:151], a[164:167], v[76:79], v[148:151]
    v_and_b32 v27, 0xffff0000, v27
    v_mul_f32_e64 v26, v26, v51
    v_mfma_f32_16x16x32_bf16 v[152:155], a[168:171], v[76:79], v[152:155]
    buffer_load_dwordx4 v235, s[48:51], s33 offen offset:1024 lds
    v_mul_f32_e64 v27, v27, v51
    v_mfma_f32_16x16x32_bf16 v[156:159], a[172:175], v[76:79], v[156:159]
    v_cvt_pk_bf16_f32 v5, v26, v27
    v_sub_f32 v28, v28, v50
    s_waitcnt lgkmcnt(0)
    v_mfma_f32_16x16x32_bf16 v[160:163], a[160:163], v[80:83], v[160:163]
    ds_read_b128 v[64:67], v225 offset:16384
    v_sub_f32_e64 v29, v29, v50
    v_mfma_f32_16x16x32_bf16 v[164:167], a[164:167], v[80:83], v[164:167]
    ds_read_b128 v[68:71], v225 offset:18432
    v_cvt_pk_bf16_f32 v29, v28, v29
    v_mfma_f32_16x16x32_bf16 v[168:171], a[168:171], v[80:83], v[168:171]
    ds_read_b128 v[72:75], v225 offset:20480
    v_lshlrev_b32_e64 v28, 16, v29
    v_mfma_f32_16x16x32_bf16 v[172:175], a[172:175], v[80:83], v[172:175]
    ds_read_b128 v[76:79], v225 offset:22528
    v_and_b32 v29, 0xffff0000, v29
    v_mul_f32_e64 v28, v28, v51
    v_mfma_f32_16x16x32_bf16 v[176:179], a[160:163], v[84:87], v[176:179]
    ds_read_b64_tr_b16 a[184:185], v230 offset:20480
    v_mul_f32_e64 v29, v29, v51
    v_mfma_f32_16x16x32_bf16 v[180:183], a[164:167], v[84:87], v[180:183]
    ds_read_b64_tr_b16 a[186:187], v230 offset:20992
    v_cvt_pk_bf16_f32 v6, v28, v29
    v_mfma_f32_16x16x32_bf16 v[184:187], a[168:171], v[84:87], v[184:187]
    ds_read_b64_tr_b16 a[188:189], v231 offset:20480
    v_sub_f32_e64 v30, v30, v50
    v_mfma_f32_16x16x32_bf16 v[188:191], a[172:175], v[84:87], v[188:191]
    ds_read_b64_tr_b16 a[190:191], v231 offset:20992
    v_sub_f32_e64 v31, v31, v50
    v_mfma_f32_16x16x32_bf16 v[192:195], a[160:163], v[88:91], v[192:195]
    s_add_u32 m0, s34, 8192
    s_add_u32 s37, s81, 131072
    buffer_load_dwordx4 v232, s[44:47], s37 offen lds
    v_mfma_f32_16x16x32_bf16 v[196:199], a[164:167], v[88:91], v[196:199]
    v_cvt_pk_bf16_f32 v31, v30, v31
    v_lshlrev_b32_e64 v30, 16, v31
    v_and_b32 v31, 0xffff0000, v31
    v_mfma_f32_16x16x32_bf16 v[200:203], a[168:171], v[88:91], v[200:203]
    buffer_load_dwordx4 v233, s[44:47], s37 offen offset:1024 lds
    v_mul_f32_e64 v30, v30, v51
    v_mfma_f32_16x16x32_bf16 v[204:207], a[172:175], v[88:91], v[204:207]
    v_mul_f32_e64 v31, v31, v51
    v_cvt_pk_bf16_f32 v7, v30, v31
    v_mfma_f32_16x16x32_bf16 v[208:211], a[160:163], v[92:95], v[208:211]
    v_lshlrev_b32_e64 v227, 3, v240
    v_min_u32 v227, 1920, v227
    s_lshl2_add_u32 s25, s2, s3
    v_mfma_f32_16x16x32_bf16 v[212:215], a[164:167], v[92:95], v[212:215]
    v_sub_f32 v32, v32, v50
    v_sub_f32_e64 v33, v33, v50
    v_cvt_pk_bf16_f32 v33, v32, v33
    v_mfma_f32_16x16x32_bf16 v[216:219], a[168:171], v[92:95], v[216:219]
    s_lshl_b32 s25, s25, 13
    s_add_u32 s25, s25, 4096
    buffer_load_dword v241, v227, s[12:15], s25 offen
    v_mfma_f32_16x16x32_bf16 v[220:223], a[172:175], v[92:95], v[220:223]
    v_lshlrev_b32_e64 v32, 16, v33
    s_waitcnt vmcnt(16) lgkmcnt(0)
    v_mfma_f32_16x16x32_bf16 v[96:99], a[176:179], v[64:67], v[96:99]
    ds_read_b128 v[80:83], v225 offset:24576
    v_and_b32 v33, 0xffff0000, v33
    v_mfma_f32_16x16x32_bf16 v[100:103], a[180:183], v[64:67], v[100:103]
    ds_read_b128 v[84:87], v225 offset:26624
    v_mul_f32_e64 v32, v32, v51
    v_mfma_f32_16x16x32_bf16 v[104:107], a[184:187], v[64:67], v[104:107]
    ds_read_b128 v[88:91], v225 offset:28672
    v_mul_f32_e64 v33, v33, v51
    v_cvt_pk_bf16_f32 v8, v32, v33
    v_mfma_f32_16x16x32_bf16 v[108:111], a[188:191], v[64:67], v[108:111]
    ds_read_b128 v[92:95], v225 offset:30720
    v_sub_f32_e64 v34, v34, v50
    v_mfma_f32_16x16x32_bf16 v[112:115], a[176:179], v[68:71], v[112:115]
    ds_read_b64_tr_b16 a[192:193], v228 offset:0
    v_sub_f32_e64 v35, v35, v50
    v_mfma_f32_16x16x32_bf16 v[116:119], a[180:183], v[68:71], v[116:119]
    ds_read_b64_tr_b16 a[194:195], v228 offset:512
    v_cvt_pk_bf16_f32 v35, v34, v35
    v_mfma_f32_16x16x32_bf16 v[120:123], a[184:187], v[68:71], v[120:123]
    ds_read_b64_tr_b16 a[196:197], v229 offset:0
    v_lshlrev_b32_e64 v34, 16, v35
    v_mfma_f32_16x16x32_bf16 v[124:127], a[188:191], v[68:71], v[124:127]
    ds_read_b64_tr_b16 a[198:199], v229 offset:512
    v_and_b32 v35, 0xffff0000, v35
    v_mul_f32_e64 v34, v34, v51
    v_mfma_f32_16x16x32_bf16 v[128:131], a[176:179], v[72:75], v[128:131]
    v_mul_f32_e64 v35, v35, v51
    v_cvt_pk_bf16_f32 v9, v34, v35
    v_mfma_f32_16x16x32_bf16 v[132:135], a[180:183], v[72:75], v[132:135]
    v_sub_f32 v36, v36, v50
    v_sub_f32 v37, v37, v50
    v_mfma_f32_16x16x32_bf16 v[136:139], a[184:187], v[72:75], v[136:139]
    v_cvt_pk_bf16_f32 v37, v36, v37
    v_lshlrev_b32_e64 v36, 16, v37
    v_and_b32 v37, 0xffff0000, v37
    v_mfma_f32_16x16x32_bf16 v[140:143], a[188:191], v[72:75], v[140:143]
    v_mul_f32 v36, v36, v51
    v_mul_f32 v37, v37, v51
    v_mfma_f32_16x16x32_bf16 v[144:147], a[176:179], v[76:79], v[144:147]
    v_cvt_pk_bf16_f32 v10, v36, v37
    v_sub_f32 v38, v38, v50
    v_sub_f32 v39, v39, v50
    v_mfma_f32_16x16x32_bf16 v[148:151], a[180:183], v[76:79], v[148:151]
    v_cvt_pk_bf16_f32 v39, v38, v39
    v_lshlrev_b32_e64 v38, 16, v39
    v_mfma_f32_16x16x32_bf16 v[152:155], a[184:187], v[76:79], v[152:155]
    v_and_b32 v39, 0xffff0000, v39
    v_mul_f32_e64 v38, v38, v51
    v_mfma_f32_16x16x32_bf16 v[156:159], a[188:191], v[76:79], v[156:159]
    s_waitcnt vmcnt(27) lgkmcnt(0)
    s_barrier
    v_mfma_f32_16x16x32_bf16 v[160:163], a[176:179], v[80:83], v[160:163]
    ds_read_b128 v[64:67], v224 offset:32768
    v_mul_f32_e64 v39, v39, v51
    v_cvt_pk_bf16_f32 v11, v38, v39
    v_mfma_f32_16x16x32_bf16 v[164:167], a[180:183], v[80:83], v[164:167]
    ds_read_b128 v[68:71], v224 offset:34816
    v_sub_f32_e64 v40, v40, v50
    v_mfma_f32_16x16x32_bf16 v[168:171], a[184:187], v[80:83], v[168:171]
    ds_read_b128 v[72:75], v224 offset:36864
    v_sub_f32_e64 v41, v41, v50
    v_mfma_f32_16x16x32_bf16 v[172:175], a[188:191], v[80:83], v[172:175]
    ds_read_b128 v[76:79], v224 offset:38912
    v_cvt_pk_bf16_f32 v41, v40, v41
    v_mfma_f32_16x16x32_bf16 v[176:179], a[176:179], v[84:87], v[176:179]
    ds_read_b64_tr_b16 a[200:201], v230 offset:0
    v_lshlrev_b32_e64 v40, 16, v41
    v_mfma_f32_16x16x32_bf16 v[180:183], a[180:183], v[84:87], v[180:183]
    ds_read_b64_tr_b16 a[202:203], v230 offset:512
    v_and_b32 v41, 0xffff0000, v41
    v_mul_f32_e64 v40, v40, v51
    v_mfma_f32_16x16x32_bf16 v[184:187], a[184:187], v[84:87], v[184:187]
    ds_read_b64_tr_b16 a[204:205], v231 offset:0
    v_mul_f32_e64 v41, v41, v51
    v_mfma_f32_16x16x32_bf16 v[188:191], a[188:191], v[84:87], v[188:191]
    ds_read_b64_tr_b16 a[206:207], v231 offset:512
    v_cvt_pk_bf16_f32 v12, v40, v41
    v_mfma_f32_16x16x32_bf16 v[192:195], a[176:179], v[88:91], v[192:195]
    s_add_u32 m0, s34, 16384
    s_add_u32 s37, s82, 131072
    buffer_load_dwordx4 v232, s[44:47], s37 offen lds
    v_mfma_f32_16x16x32_bf16 v[196:199], a[180:183], v[88:91], v[196:199]
    v_sub_f32 v42, v42, v50
    v_sub_f32 v43, v43, v50
    v_mfma_f32_16x16x32_bf16 v[200:203], a[184:187], v[88:91], v[200:203]
    v_cvt_pk_bf16_f32 v43, v42, v43
    v_lshlrev_b32_e64 v42, 16, v43
    v_and_b32 v43, 0xffff0000, v43
    v_mfma_f32_16x16x32_bf16 v[204:207], a[188:191], v[88:91], v[204:207]
    v_mul_f32 v42, v42, v51
    v_mul_f32 v43, v43, v51
    v_mfma_f32_16x16x32_bf16 v[208:211], a[176:179], v[92:95], v[208:211]
    buffer_load_dwordx4 v233, s[44:47], s37 offen offset:1024 lds
    v_cvt_pk_bf16_f32 v13, v42, v43
    v_mfma_f32_16x16x32_bf16 v[212:215], a[180:183], v[92:95], v[212:215]
    v_sub_f32 v44, v44, v50
    v_sub_f32 v45, v45, v50
    v_cvt_pk_bf16_f32 v45, v44, v45
    v_mfma_f32_16x16x32_bf16 v[216:219], a[184:187], v[92:95], v[216:219]
    v_lshlrev_b32_e64 v44, 16, v45
    v_and_b32 v45, 0xffff0000, v45
    v_mfma_f32_16x16x32_bf16 v[220:223], a[188:191], v[92:95], v[220:223]
    v_mul_f32 v44, v44, v51
    s_waitcnt lgkmcnt(0)
    v_mfma_f32_16x16x32_bf16 v[96:99], a[192:195], v[64:67], v[96:99]
    ds_read_b128 v[80:83], v224 offset:40960
    v_mul_f32_e64 v45, v45, v51
    v_cvt_pk_bf16_f32 v14, v44, v45
    v_mfma_f32_16x16x32_bf16 v[100:103], a[196:199], v[64:67], v[100:103]
    ds_read_b128 v[84:87], v224 offset:43008
    v_sub_f32_e64 v46, v46, v50
    v_mfma_f32_16x16x32_bf16 v[104:107], a[200:203], v[64:67], v[104:107]
    ds_read_b128 v[88:91], v224 offset:45056
    v_sub_f32_e64 v47, v47, v50
    v_mfma_f32_16x16x32_bf16 v[108:111], a[204:207], v[64:67], v[108:111]
    ds_read_b128 v[92:95], v224 offset:47104
    v_cvt_pk_bf16_f32 v47, v46, v47
    v_mfma_f32_16x16x32_bf16 v[112:115], a[192:195], v[68:71], v[112:115]
    ds_read_b64_tr_b16 a[208:209], v228 offset:4096
    v_lshlrev_b32_e64 v46, 16, v47
    v_mfma_f32_16x16x32_bf16 v[116:119], a[196:199], v[68:71], v[116:119]
    ds_read_b64_tr_b16 a[210:211], v228 offset:4608
    v_and_b32 v47, 0xffff0000, v47
    v_mul_f32_e64 v46, v46, v51
    v_mfma_f32_16x16x32_bf16 v[120:123], a[200:203], v[68:71], v[120:123]
    ds_read_b64_tr_b16 a[212:213], v229 offset:4096
    v_mul_f32_e64 v47, v47, v51
    v_mfma_f32_16x16x32_bf16 v[124:127], a[204:207], v[68:71], v[124:127]
    ds_read_b64_tr_b16 a[214:215], v229 offset:4608
    v_cvt_pk_bf16_f32 v15, v46, v47
    v_mfma_f32_16x16x32_bf16 v[128:131], a[192:195], v[72:75], v[128:131]
    v_mfma_f32_16x16x32_bf16 v[132:135], a[196:199], v[72:75], v[132:135]
    ds_write_b128 v237, v[0:3] offset:0
    v_mfma_f32_16x16x32_bf16 v[136:139], a[200:203], v[72:75], v[136:139]
    ds_write_b128 v237, v[4:7] offset:4096
    v_mfma_f32_16x16x32_bf16 v[140:143], a[204:207], v[72:75], v[140:143]
    ds_write_b128 v237, v[8:11] offset:24576
    v_mfma_f32_16x16x32_bf16 v[144:147], a[192:195], v[76:79], v[144:147]
    ds_write_b128 v237, v[12:15] offset:28672
    v_mfma_f32_16x16x32_bf16 v[148:151], a[196:199], v[76:79], v[148:151]
    v_mfma_f32_16x16x32_bf16 v[152:155], a[200:203], v[76:79], v[152:155]
    v_mfma_f32_16x16x32_bf16 v[156:159], a[204:207], v[76:79], v[156:159]
    s_waitcnt lgkmcnt(0)
    v_mfma_f32_16x16x32_bf16 v[160:163], a[192:195], v[80:83], v[160:163]
    ds_read_b128 v[64:67], v225 offset:32768
    v_mfma_f32_16x16x32_bf16 v[164:167], a[196:199], v[80:83], v[164:167]
    ds_read_b128 v[68:71], v225 offset:34816
    v_mfma_f32_16x16x32_bf16 v[168:171], a[200:203], v[80:83], v[168:171]
    ds_read_b128 v[72:75], v225 offset:36864
    v_mfma_f32_16x16x32_bf16 v[172:175], a[204:207], v[80:83], v[172:175]
    ds_read_b128 v[76:79], v225 offset:38912
    v_mfma_f32_16x16x32_bf16 v[176:179], a[192:195], v[84:87], v[176:179]
    ds_read_b64_tr_b16 a[216:217], v230 offset:4096
    v_mfma_f32_16x16x32_bf16 v[180:183], a[196:199], v[84:87], v[180:183]
    ds_read_b64_tr_b16 a[218:219], v230 offset:4608
    v_mfma_f32_16x16x32_bf16 v[184:187], a[200:203], v[84:87], v[184:187]
    ds_read_b64_tr_b16 a[220:221], v231 offset:4096
    v_mfma_f32_16x16x32_bf16 v[188:191], a[204:207], v[84:87], v[188:191]
    ds_read_b64_tr_b16 a[222:223], v231 offset:4608
    v_mfma_f32_16x16x32_bf16 v[192:195], a[192:195], v[88:91], v[192:195]
    s_add_u32 m0, s34, 24576
    s_add_u32 s37, s83, 131072
    buffer_load_dwordx4 v232, s[44:47], s37 offen lds
    v_mfma_f32_16x16x32_bf16 v[196:199], a[196:199], v[88:91], v[196:199]
    buffer_load_dwordx4 v233, s[44:47], s37 offen offset:1024 lds
    v_mfma_f32_16x16x32_bf16 v[200:203], a[200:203], v[88:91], v[200:203]
    v_mfma_f32_16x16x32_bf16 v[204:207], a[204:207], v[88:91], v[204:207]
    v_lshlrev_b32 v227, 3, v240
    v_min_u32 v227, 1920, v227
    s_lshl2_add_u32 s25, s2, s3
    v_mfma_f32_16x16x32_bf16 v[208:211], a[192:195], v[92:95], v[208:211]
    s_lshl_b32 s25, s25, 13
    s_add_u32 s25, s25, 6144
    buffer_load_dword v241, v227, s[12:15], s25 offen
    v_mfma_f32_16x16x32_bf16 v[212:215], a[196:199], v[92:95], v[212:215]
    v_mfma_f32_16x16x32_bf16 v[216:219], a[200:203], v[92:95], v[216:219]
    buffer_load_dword v254, off, s[88:91], s97 sc1
    v_mfma_f32_16x16x32_bf16 v[220:223], a[204:207], v[92:95], v[220:223]
    s_waitcnt vmcnt(9) lgkmcnt(0)
    v_mfma_f32_16x16x32_bf16 v[96:99], a[208:211], v[64:67], v[96:99]
    ds_read_b128 v[80:83], v225 offset:40960
    v_mfma_f32_16x16x32_bf16 v[100:103], a[212:215], v[64:67], v[100:103]
    ds_read_b128 v[84:87], v225 offset:43008
    s_mul_i32 s38, s2, 100
    v_mfma_f32_16x16x32_bf16 v[104:107], a[216:219], v[64:67], v[104:107]
    ds_read_b128 v[88:91], v225 offset:45056
    v_mfma_f32_16x16x32_bf16 v[108:111], a[220:223], v[64:67], v[108:111]
    ds_read_b128 v[92:95], v225 offset:47104
    v_mfma_f32_16x16x32_bf16 v[112:115], a[208:211], v[68:71], v[112:115]
    ds_read_b64_tr_b16 a[224:225], v228 offset:8192
    v_lshl_add_u32 v60, v253, 2, s38
    v_mfma_f32_16x16x32_bf16 v[116:119], a[212:215], v[68:71], v[116:119]
    ds_read_b64_tr_b16 a[226:227], v228 offset:8704
    v_mfma_f32_16x16x32_bf16 v[120:123], a[216:219], v[68:71], v[120:123]
    ds_read_b64_tr_b16 a[228:229], v229 offset:8192
    v_mfma_f32_16x16x32_bf16 v[124:127], a[220:223], v[68:71], v[124:127]
    ds_read_b64_tr_b16 a[230:231], v229 offset:8704
    v_cmp_gt_u32 vcc, 25, v253
    v_mfma_f32_16x16x32_bf16 v[128:131], a[208:211], v[72:75], v[128:131]
    v_mov_b32_e64 v61, 0
    v_mfma_f32_16x16x32_bf16 v[132:135], a[212:215], v[72:75], v[132:135]
    v_mfma_f32_16x16x32_bf16 v[136:139], a[216:219], v[72:75], v[136:139]
    v_mov_b32 v62, 0x7ffffff0
    v_mfma_f32_16x16x32_bf16 v[140:143], a[220:223], v[72:75], v[140:143]
    v_cndmask_b32 v60, v62, v60, vcc
    v_mfma_f32_16x16x32_bf16 v[144:147], a[208:211], v[76:79], v[144:147]
    v_mfma_f32_16x16x32_bf16 v[148:151], a[212:215], v[76:79], v[148:151]
    buffer_store_dword v61, v60, s[56:59], 0 offen sc1
    v_mfma_f32_16x16x32_bf16 v[152:155], a[216:219], v[76:79], v[152:155]
    v_mfma_f32_16x16x32_bf16 v[156:159], a[220:223], v[76:79], v[156:159]
    s_waitcnt vmcnt(21) lgkmcnt(0)
    s_barrier
    v_mfma_f32_16x16x32_bf16 v[160:163], a[208:211], v[80:83], v[160:163]
    ds_read_b128 v[64:67], v224 offset:49152
    v_mfma_f32_16x16x32_bf16 v[164:167], a[212:215], v[80:83], v[164:167]
    ds_read_b128 v[68:71], v224 offset:51200
    v_mfma_f32_16x16x32_bf16 v[168:171], a[216:219], v[80:83], v[168:171]
    ds_read_b128 v[72:75], v224 offset:53248
    v_mfma_f32_16x16x32_bf16 v[172:175], a[220:223], v[80:83], v[172:175]
    ds_read_b128 v[76:79], v224 offset:55296
    v_mfma_f32_16x16x32_bf16 v[176:179], a[208:211], v[84:87], v[176:179]
    ds_read_b64_tr_b16 a[232:233], v230 offset:8192
    v_mfma_f32_16x16x32_bf16 v[180:183], a[212:215], v[84:87], v[180:183]
    ds_read_b64_tr_b16 a[234:235], v230 offset:8704
    v_mfma_f32_16x16x32_bf16 v[184:187], a[216:219], v[84:87], v[184:187]
    ds_read_b64_tr_b16 a[236:237], v231 offset:8192
    v_mfma_f32_16x16x32_bf16 v[188:191], a[220:223], v[84:87], v[188:191]
    ds_read_b64_tr_b16 a[238:239], v231 offset:8704
    v_mfma_f32_16x16x32_bf16 v[192:195], a[208:211], v[88:91], v[192:195]
    v_lshlrev_b32 v237, 4, v253
    v_add_u32 v237, 81920, v237
    ds_read_b128 v[16:19], v237 offset:0
    ds_read_b128 v[20:23], v237 offset:4096
    ds_read_b128 v[24:27], v237 offset:24576
    ds_read_b128 v[28:31], v237 offset:28672
    s_add_u32 m0, s34, 32768
    s_add_u32 s37, s84, 131072
    buffer_load_dwordx4 v232, s[44:47], s37 offen lds
    v_mfma_f32_16x16x32_bf16 v[196:199], a[212:215], v[88:91], v[196:199]
    v_mfma_f32_16x16x32_bf16 v[200:203], a[216:219], v[88:91], v[200:203]
    v_mfma_f32_16x16x32_bf16 v[204:207], a[220:223], v[88:91], v[204:207]
    v_mfma_f32_16x16x32_bf16 v[208:211], a[208:211], v[92:95], v[208:211]
    buffer_load_dwordx4 v233, s[44:47], s37 offen offset:1024 lds
    v_mfma_f32_16x16x32_bf16 v[212:215], a[212:215], v[92:95], v[212:215]
    v_mfma_f32_16x16x32_bf16 v[216:219], a[216:219], v[92:95], v[216:219]
    v_mfma_f32_16x16x32_bf16 v[220:223], a[220:223], v[92:95], v[220:223]
    s_waitcnt lgkmcnt(0)
    v_mfma_f32_16x16x32_bf16 v[96:99], a[224:227], v[64:67], v[96:99]
    ds_read_b128 v[80:83], v224 offset:57344
    v_mfma_f32_16x16x32_bf16 v[100:103], a[228:231], v[64:67], v[100:103]
    ds_read_b128 v[84:87], v224 offset:59392
    v_mfma_f32_16x16x32_bf16 v[104:107], a[232:235], v[64:67], v[104:107]
    ds_read_b128 v[88:91], v224 offset:61440
    v_mfma_f32_16x16x32_bf16 v[108:111], a[236:239], v[64:67], v[108:111]
    ds_read_b128 v[92:95], v224 offset:63488
    v_mfma_f32_16x16x32_bf16 v[112:115], a[224:227], v[68:71], v[112:115]
    ds_read_b64_tr_b16 a[240:241], v228 offset:12288
    v_mfma_f32_16x16x32_bf16 v[116:119], a[228:231], v[68:71], v[116:119]
    ds_read_b64_tr_b16 a[242:243], v228 offset:12800
    s_mov_b32 s39, 0
    buffer_store_dwordx4 v[16:19], v238, s[8:11], s39 offen sc1
    v_mfma_f32_16x16x32_bf16 v[120:123], a[232:235], v[68:71], v[120:123]
    ds_read_b64_tr_b16 a[244:245], v229 offset:12288
    v_mfma_f32_16x16x32_bf16 v[124:127], a[236:239], v[68:71], v[124:127]
    ds_read_b64_tr_b16 a[246:247], v229 offset:12800
    v_mfma_f32_16x16x32_bf16 v[128:131], a[224:227], v[72:75], v[128:131]
    v_mfma_f32_16x16x32_bf16 v[132:135], a[228:231], v[72:75], v[132:135]
    v_mfma_f32_16x16x32_bf16 v[136:139], a[232:235], v[72:75], v[136:139]
    v_mfma_f32_16x16x32_bf16 v[140:143], a[236:239], v[72:75], v[140:143]
    v_mfma_f32_16x16x32_bf16 v[144:147], a[224:227], v[76:79], v[144:147]
    v_mfma_f32_16x16x32_bf16 v[148:151], a[228:231], v[76:79], v[148:151]
    s_mov_b32 s39, 8192
    buffer_store_dwordx4 v[20:23], v238, s[8:11], s39 offen sc1
    v_mfma_f32_16x16x32_bf16 v[152:155], a[232:235], v[76:79], v[152:155]
    v_mfma_f32_16x16x32_bf16 v[156:159], a[236:239], v[76:79], v[156:159]
    s_waitcnt lgkmcnt(0)
    v_mfma_f32_16x16x32_bf16 v[160:163], a[224:227], v[80:83], v[160:163]
    ds_read_b128 v[64:67], v225 offset:49152
    v_mfma_f32_16x16x32_bf16 v[164:167], a[228:231], v[80:83], v[164:167]
    ds_read_b128 v[68:71], v225 offset:51200
    v_mfma_f32_16x16x32_bf16 v[168:171], a[232:235], v[80:83], v[168:171]
    ds_read_b128 v[72:75], v225 offset:53248
    v_mfma_f32_16x16x32_bf16 v[172:175], a[236:239], v[80:83], v[172:175]
    ds_read_b128 v[76:79], v225 offset:55296
    v_mfma_f32_16x16x32_bf16 v[176:179], a[224:227], v[84:87], v[176:179]
    ds_read_b64_tr_b16 a[248:249], v230 offset:12288
    v_mfma_f32_16x16x32_bf16 v[180:183], a[228:231], v[84:87], v[180:183]
    ds_read_b64_tr_b16 a[250:251], v230 offset:12800
    s_mov_b32 s39, 16384
    buffer_store_dwordx4 v[24:27], v238, s[8:11], s39 offen sc1
    v_mfma_f32_16x16x32_bf16 v[184:187], a[232:235], v[84:87], v[184:187]
    ds_read_b64_tr_b16 a[252:253], v231 offset:12288
    v_mfma_f32_16x16x32_bf16 v[188:191], a[236:239], v[84:87], v[188:191]
    ds_read_b64_tr_b16 a[254:255], v231 offset:12800
    v_mfma_f32_16x16x32_bf16 v[192:195], a[224:227], v[88:91], v[192:195]
    s_add_u32 m0, s34, 40960
    s_add_u32 s37, s85, 131072
    buffer_load_dwordx4 v232, s[44:47], s37 offen lds
    v_mfma_f32_16x16x32_bf16 v[196:199], a[228:231], v[88:91], v[196:199]
    v_mfma_f32_16x16x32_bf16 v[200:203], a[232:235], v[88:91], v[200:203]
    v_mfma_f32_16x16x32_bf16 v[204:207], a[236:239], v[88:91], v[204:207]
    v_mfma_f32_16x16x32_bf16 v[208:211], a[224:227], v[92:95], v[208:211]
    buffer_load_dwordx4 v233, s[44:47], s37 offen offset:1024 lds
    v_mfma_f32_16x16x32_bf16 v[212:215], a[228:231], v[92:95], v[212:215]
    s_mov_b32 s39, 24576
    buffer_store_dwordx4 v[28:31], v238, s[8:11], s39 offen sc1
    v_mfma_f32_16x16x32_bf16 v[216:219], a[232:235], v[92:95], v[216:219]
    v_mfma_f32_16x16x32_bf16 v[220:223], a[236:239], v[92:95], v[220:223]
    s_waitcnt lgkmcnt(0)
    v_mfma_f32_16x16x32_bf16 v[96:99], a[240:243], v[64:67], v[96:99]
    ds_read_b128 v[80:83], v225 offset:57344
    v_mfma_f32_16x16x32_bf16 v[100:103], a[244:247], v[64:67], v[100:103]
    ds_read_b128 v[84:87], v225 offset:59392
    v_mfma_f32_16x16x32_bf16 v[104:107], a[248:251], v[64:67], v[104:107]
    ds_read_b128 v[88:91], v225 offset:61440
    v_mfma_f32_16x16x32_bf16 v[108:111], a[252:255], v[64:67], v[108:111]
    ds_read_b128 v[92:95], v225 offset:63488
    v_mfma_f32_16x16x32_bf16 v[112:115], a[240:243], v[68:71], v[112:115]
    v_mfma_f32_16x16x32_bf16 v[116:119], a[244:247], v[68:71], v[116:119]
    v_mfma_f32_16x16x32_bf16 v[120:123], a[248:251], v[68:71], v[120:123]
    v_mfma_f32_16x16x32_bf16 v[124:127], a[252:255], v[68:71], v[124:127]
    v_mfma_f32_16x16x32_bf16 v[128:131], a[240:243], v[72:75], v[128:131]
    v_mfma_f32_16x16x32_bf16 v[132:135], a[244:247], v[72:75], v[132:135]
    v_cvt_pk_bf16_f32 v0, v96, v97
    v_cvt_pk_bf16_f32 v1, v98, v99
    v_mfma_f32_16x16x32_bf16 v[136:139], a[248:251], v[72:75], v[136:139]
    v_cvt_pk_bf16_f32 v2, v100, v101
    v_cvt_pk_bf16_f32 v3, v102, v103
    v_mfma_f32_16x16x32_bf16 v[140:143], a[252:255], v[72:75], v[140:143]
    v_cvt_pk_bf16_f32 v4, v104, v105
    v_cvt_pk_bf16_f32 v5, v106, v107
    v_mfma_f32_16x16x32_bf16 v[144:147], a[240:243], v[76:79], v[144:147]
    v_cvt_pk_bf16_f32 v6, v108, v109
    v_cvt_pk_bf16_f32 v7, v110, v111
    v_mfma_f32_16x16x32_bf16 v[148:151], a[244:247], v[76:79], v[148:151]
    v_cvt_pk_bf16_f32 v8, v112, v113
    v_cvt_pk_bf16_f32 v9, v114, v115
    v_mfma_f32_16x16x32_bf16 v[152:155], a[248:251], v[76:79], v[152:155]
    v_cvt_pk_bf16_f32 v10, v116, v117
    v_cvt_pk_bf16_f32 v11, v118, v119
    v_mfma_f32_16x16x32_bf16 v[156:159], a[252:255], v[76:79], v[156:159]
    v_cvt_pk_bf16_f32 v12, v120, v121
    v_cvt_pk_bf16_f32 v13, v122, v123
    s_waitcnt vmcnt(16) lgkmcnt(0)
    s_barrier
    v_mfma_f32_16x16x32_bf16 v[160:163], a[240:243], v[80:83], v[160:163]
    ds_read_b128 v[64:67], v224 offset:0
    v_cvt_pk_bf16_f32 v14, v124, v125
    v_cvt_pk_bf16_f32 v15, v126, v127
    v_mfma_f32_16x16x32_bf16 v[164:167], a[244:247], v[80:83], v[164:167]
    ds_read_b128 v[68:71], v224 offset:2048
    v_cvt_pk_bf16_f32 v16, v128, v129
    v_cvt_pk_bf16_f32 v17, v130, v131
    v_mfma_f32_16x16x32_bf16 v[168:171], a[248:251], v[80:83], v[168:171]
    ds_read_b128 v[72:75], v224 offset:4096
    v_cvt_pk_bf16_f32 v18, v132, v133
    v_cvt_pk_bf16_f32 v19, v134, v135
    v_mfma_f32_16x16x32_bf16 v[172:175], a[252:255], v[80:83], v[172:175]
    ds_read_b128 v[76:79], v224 offset:6144
    v_cvt_pk_bf16_f32 v20, v136, v137
    v_cvt_pk_bf16_f32 v21, v138, v139
    v_mfma_f32_16x16x32_bf16 v[176:179], a[240:243], v[84:87], v[176:179]
    v_cvt_pk_bf16_f32 v22, v140, v141
    v_cvt_pk_bf16_f32 v23, v142, v143
    v_mfma_f32_16x16x32_bf16 v[180:183], a[244:247], v[84:87], v[180:183]
    v_cvt_pk_bf16_f32 v24, v144, v145
    v_cvt_pk_bf16_f32 v25, v146, v147
    v_mfma_f32_16x16x32_bf16 v[184:187], a[248:251], v[84:87], v[184:187]
    v_cvt_pk_bf16_f32 v26, v148, v149
    v_cvt_pk_bf16_f32 v27, v150, v151
    v_mfma_f32_16x16x32_bf16 v[188:191], a[252:255], v[84:87], v[188:191]
    v_cvt_pk_bf16_f32 v28, v152, v153
    v_cvt_pk_bf16_f32 v29, v154, v155
    v_mfma_f32_16x16x32_bf16 v[192:195], a[240:243], v[88:91], v[192:195]
    s_add_u32 m0, s34, 49152
    s_add_u32 s37, s86, 131072
    buffer_load_dwordx4 v232, s[44:47], s37 offen lds
    v_cvt_pk_bf16_f32 v30, v156, v157
    v_cvt_pk_bf16_f32 v31, v158, v159
    v_mfma_f32_16x16x32_bf16 v[196:199], a[244:247], v[88:91], v[196:199]
    v_cvt_pk_bf16_f32 v32, v160, v161
    v_cvt_pk_bf16_f32 v33, v162, v163
    v_mfma_f32_16x16x32_bf16 v[200:203], a[248:251], v[88:91], v[200:203]
    v_cvt_pk_bf16_f32 v34, v164, v165
    v_cvt_pk_bf16_f32 v35, v166, v167
    v_mfma_f32_16x16x32_bf16 v[204:207], a[252:255], v[88:91], v[204:207]
    v_cvt_pk_bf16_f32 v36, v168, v169
    v_cvt_pk_bf16_f32 v37, v170, v171
    v_mfma_f32_16x16x32_bf16 v[208:211], a[240:243], v[92:95], v[208:211]
    buffer_load_dwordx4 v233, s[44:47], s37 offen offset:1024 lds
    v_cvt_pk_bf16_f32 v38, v172, v173
    v_cvt_pk_bf16_f32 v39, v174, v175
    v_mfma_f32_16x16x32_bf16 v[212:215], a[244:247], v[92:95], v[212:215]
    v_cvt_pk_bf16_f32 v40, v176, v177
    v_cvt_pk_bf16_f32 v41, v178, v179
    v_mfma_f32_16x16x32_bf16 v[216:219], a[248:251], v[92:95], v[216:219]
    v_cvt_pk_bf16_f32 v42, v180, v181
    v_cvt_pk_bf16_f32 v43, v182, v183
    v_mfma_f32_16x16x32_bf16 v[220:223], a[252:255], v[92:95], v[220:223]
    v_cvt_pk_bf16_f32 v44, v184, v185
    v_cvt_pk_bf16_f32 v45, v186, v187
    s_waitcnt lgkmcnt(0)
    v_mfma_f32_16x16x32_bf16 v[96:99], a[0:3], v[64:67], 0
    ds_read_b128 v[80:83], v225 offset:0
    v_cvt_pk_bf16_f32 v46, v188, v189
    v_cvt_pk_bf16_f32 v47, v190, v191
    v_mfma_f32_16x16x32_bf16 v[100:103], a[4:7], v[64:67], 0
    ds_read_b128 v[84:87], v225 offset:2048
    v_cvt_pk_bf16_f32 v48, v192, v193
    v_cvt_pk_bf16_f32 v49, v194, v195
    v_mfma_f32_16x16x32_bf16 v[104:107], a[8:11], v[64:67], 0
    ds_read_b128 v[88:91], v225 offset:4096
    v_cvt_pk_bf16_f32 v50, v196, v197
    v_cvt_pk_bf16_f32 v51, v198, v199
    v_mfma_f32_16x16x32_bf16 v[108:111], a[12:15], v[64:67], 0
    ds_read_b128 v[92:95], v225 offset:6144
    v_cvt_pk_bf16_f32 v52, v200, v201
    v_cvt_pk_bf16_f32 v53, v202, v203
    v_mfma_f32_16x16x32_bf16 v[112:115], a[0:3], v[68:71], 0
    v_cvt_pk_bf16_f32 v54, v204, v205
    v_cvt_pk_bf16_f32 v55, v206, v207
    s_add_u32 s38, s36, 0
    buffer_store_dwordx4 v[0:3], v240, s[16:19], s38 offen offset:0 sc1
    v_mfma_f32_16x16x32_bf16 v[116:119], a[4:7], v[68:71], 0
    v_cvt_pk_bf16_f32 v56, v208, v209
    v_cvt_pk_bf16_f32 v57, v210, v211
    v_mfma_f32_16x16x32_bf16 v[120:123], a[8:11], v[68:71], 0
    v_cvt_pk_bf16_f32 v58, v212, v213
    v_cvt_pk_bf16_f32 v59, v214, v215
    v_mfma_f32_16x16x32_bf16 v[124:127], a[12:15], v[68:71], 0
    v_cvt_pk_bf16_f32 v60, v216, v217
    v_cvt_pk_bf16_f32 v61, v218, v219
    v_mfma_f32_16x16x32_bf16 v[128:131], a[0:3], v[72:75], 0
    v_xor_b32 v237, 16, v245
    v_xor_b32 v238, 16, v246
    v_cvt_pk_bf16_f32 v62, v220, v221
    v_cvt_pk_bf16_f32 v63, v222, v223
    v_mfma_f32_16x16x32_bf16 v[132:135], a[4:7], v[72:75], 0
    v_mfma_f32_16x16x32_bf16 v[136:139], a[8:11], v[72:75], 0
    v_mfma_f32_16x16x32_bf16 v[140:143], a[12:15], v[72:75], 0
    v_mfma_f32_16x16x32_bf16 v[144:147], a[0:3], v[76:79], 0
    v_mfma_f32_16x16x32_bf16 v[148:151], a[4:7], v[76:79], 0
    v_mfma_f32_16x16x32_bf16 v[152:155], a[8:11], v[76:79], 0
    v_mfma_f32_16x16x32_bf16 v[156:159], a[12:15], v[76:79], 0
    s_waitcnt lgkmcnt(0)
    v_mfma_f32_16x16x32_bf16 v[96:99], a[16:19], v[80:83], v[96:99]
    ds_read_b128 v[64:67], v224 offset:8192
    v_mfma_f32_16x16x32_bf16 v[100:103], a[20:23], v[80:83], v[100:103]
    ds_read_b128 v[68:71], v224 offset:10240
    v_mfma_f32_16x16x32_bf16 v[104:107], a[24:27], v[80:83], v[104:107]
    ds_read_b128 v[72:75], v224 offset:12288
    v_mfma_f32_16x16x32_bf16 v[108:111], a[28:31], v[80:83], v[108:111]
    ds_read_b128 v[76:79], v224 offset:14336
    v_mfma_f32_16x16x32_bf16 v[112:115], a[16:19], v[84:87], v[112:115]
    v_mfma_f32_16x16x32_bf16 v[116:119], a[20:23], v[84:87], v[116:119]
    v_mfma_f32_16x16x32_bf16 v[120:123], a[24:27], v[84:87], v[120:123]
    v_mfma_f32_16x16x32_bf16 v[124:127], a[28:31], v[84:87], v[124:127]
    v_mfma_f32_16x16x32_bf16 v[128:131], a[16:19], v[88:91], v[128:131]
    s_add_u32 m0, s34, 57344
    s_add_u32 s37, s87, 131072
    buffer_load_dwordx4 v232, s[44:47], s37 offen lds
    v_mfma_f32_16x16x32_bf16 v[132:135], a[20:23], v[88:91], v[132:135]
    s_add_u32 s38, s36, 0
    buffer_store_dwordx4 v[4:7], v240, s[16:19], s38 offen offset:2048 sc1
    v_mfma_f32_16x16x32_bf16 v[136:139], a[24:27], v[88:91], v[136:139]
    v_mfma_f32_16x16x32_bf16 v[140:143], a[28:31], v[88:91], v[140:143]
    v_mfma_f32_16x16x32_bf16 v[144:147], a[16:19], v[92:95], v[144:147]
    buffer_load_dwordx4 v233, s[44:47], s37 offen offset:1024 lds
    v_mfma_f32_16x16x32_bf16 v[148:151], a[20:23], v[92:95], v[148:151]
    v_mfma_f32_16x16x32_bf16 v[152:155], a[24:27], v[92:95], v[152:155]
    v_mfma_f32_16x16x32_bf16 v[156:159], a[28:31], v[92:95], v[156:159]
    s_waitcnt lgkmcnt(0)
    v_mfma_f32_16x16x32_bf16 v[96:99], a[32:35], v[64:67], v[96:99]
    ds_read_b128 v[80:83], v225 offset:8192
    v_mfma_f32_16x16x32_bf16 v[100:103], a[36:39], v[64:67], v[100:103]
    ds_read_b128 v[84:87], v225 offset:10240
    v_mfma_f32_16x16x32_bf16 v[104:107], a[40:43], v[64:67], v[104:107]
    ds_read_b128 v[88:91], v225 offset:12288
    v_mfma_f32_16x16x32_bf16 v[108:111], a[44:47], v[64:67], v[108:111]
    ds_read_b128 v[92:95], v225 offset:14336
    v_mfma_f32_16x16x32_bf16 v[112:115], a[32:35], v[68:71], v[112:115]
    v_mfma_f32_16x16x32_bf16 v[116:119], a[36:39], v[68:71], v[116:119]
    v_mfma_f32_16x16x32_bf16 v[120:123], a[40:43], v[68:71], v[120:123]
    v_mfma_f32_16x16x32_bf16 v[124:127], a[44:47], v[68:71], v[124:127]
    v_mfma_f32_16x16x32_bf16 v[128:131], a[32:35], v[72:75], v[128:131]
    s_waitcnt vmcnt(15)
    v_readfirstlane_b32 s24, v254
    s_lshl_b32 s25, s3, 16
    s_add_u32 s24, s24, s25
    s_cmp_ge_u32 s24, 1
    s_cbranch_scc0 kf_spin31
kf_spinr32:
    v_mfma_f32_16x16x32_bf16 v[132:135], a[36:39], v[72:75], v[132:135]
    v_mfma_f32_16x16x32_bf16 v[136:139], a[40:43], v[72:75], v[136:139]
    v_mfma_f32_16x16x32_bf16 v[140:143], a[44:47], v[72:75], v[140:143]
    v_mfma_f32_16x16x32_bf16 v[144:147], a[32:35], v[76:79], v[144:147]
    s_add_u32 s88, s20, 0x14a0000
    s_addc_u32 s89, s21, 0
    s_mov_b32 s90, 20480
    v_mfma_f32_16x16x32_bf16 v[148:151], a[36:39], v[76:79], v[148:151]
    v_mfma_f32_16x16x32_bf16 v[152:155], a[40:43], v[76:79], v[152:155]
    v_mfma_f32_16x16x32_bf16 v[156:159], a[44:47], v[76:79], v[156:159]
    s_add_u32 s38, s36, 0
    buffer_store_dwordx4 v[8:11], v240, s[16:19], s38 offen offset:1024 sc1
    s_waitcnt vmcnt(7) lgkmcnt(0)
    s_barrier
    v_mfma_f32_16x16x32_bf16 v[96:99], a[48:51], v[80:83], v[96:99]
    ds_read_b128 v[64:67], v224 offset:16384
    v_mfma_f32_16x16x32_bf16 v[100:103], a[52:55], v[80:83], v[100:103]
    ds_read_b128 v[68:71], v224 offset:18432
    v_mfma_f32_16x16x32_bf16 v[104:107], a[56:59], v[80:83], v[104:107]
    ds_read_b128 v[72:75], v224 offset:20480
    v_mfma_f32_16x16x32_bf16 v[108:111], a[60:63], v[80:83], v[108:111]
    ds_read_b128 v[76:79], v224 offset:22528
    v_mfma_f32_16x16x32_bf16 v[112:115], a[48:51], v[84:87], v[112:115]
    v_mfma_f32_16x16x32_bf16 v[116:119], a[52:55], v[84:87], v[116:119]
    v_mfma_f32_16x16x32_bf16 v[120:123], a[56:59], v[84:87], v[120:123]
    v_mfma_f32_16x16x32_bf16 v[124:127], a[60:63], v[84:87], v[124:127]
    v_mfma_f32_16x16x32_bf16 v[128:131], a[48:51], v[88:91], v[128:131]
    s_add_u32 m0, s34, 0
    s_add_u32 s37, s80, 196608
    buffer_load_dwordx4 v232, s[44:47], s37 offen lds
    v_mfma_f32_16x16x32_bf16 v[132:135], a[52:55], v[88:91], v[132:135]
    v_mfma_f32_16x16x32_bf16 v[136:139], a[56:59], v[88:91], v[136:139]
    buffer_load_dwordx4 v233, s[44:47], s37 offen offset:1024 lds
    v_mfma_f32_16x16x32_bf16 v[140:143], a[60:63], v[88:91], v[140:143]
    v_mfma_f32_16x16x32_bf16 v[144:147], a[48:51], v[92:95], v[144:147]
    v_mfma_f32_16x16x32_bf16 v[148:151], a[52:55], v[92:95], v[148:151]
    s_lshl_b32 s39, s5, 7
    s_add_u32 s39, s39, 8192
    buffer_atomic_add v255, v250, s[88:91], s39 offen sc1
    s_cmp_eq_u32 s3, 0
    s_cselect_b32 s39, s39, s43
    v_mfma_f32_16x16x32_bf16 v[152:155], a[56:59], v[92:95], v[152:155]
    v_mfma_f32_16x16x32_bf16 v[156:159], a[60:63], v[92:95], v[156:159]
    s_waitcnt lgkmcnt(0)
    v_mfma_f32_16x16x32_bf16 v[96:99], a[64:67], v[64:67], v[96:99]
    ds_read_b128 v[80:83], v225 offset:16384
    v_mfma_f32_16x16x32_bf16 v[100:103], a[68:71], v[64:67], v[100:103]
    ds_read_b128 v[84:87], v225 offset:18432
    v_mfma_f32_16x16x32_bf16 v[104:107], a[72:75], v[64:67], v[104:107]
    ds_read_b128 v[88:91], v225 offset:20480
    v_mfma_f32_16x16x32_bf16 v[108:111], a[76:79], v[64:67], v[108:111]
    ds_read_b128 v[92:95], v225 offset:22528
    v_mfma_f32_16x16x32_bf16 v[112:115], a[64:67], v[68:71], v[112:115]
    s_add_u32 s38, s36, 0
    buffer_store_dwordx4 v[12:15], v240, s[16:19], s38 offen offset:3072 sc1
    v_mfma_f32_16x16x32_bf16 v[116:119], a[68:71], v[68:71], v[116:119]
    v_mfma_f32_16x16x32_bf16 v[120:123], a[72:75], v[68:71], v[120:123]
    v_mfma_f32_16x16x32_bf16 v[124:127], a[76:79], v[68:71], v[124:127]
    v_mfma_f32_16x16x32_bf16 v[128:131], a[64:67], v[72:75], v[128:131]
    s_add_u32 m0, s31, 0
    s_add_u32 s24, s27, 0
    buffer_load_dwordx4 v245, s[12:15], s24 offen lds
    v_mfma_f32_16x16x32_bf16 v[132:135], a[68:71], v[72:75], v[132:135]
    v_mfma_f32_16x16x32_bf16 v[136:139], a[72:75], v[72:75], v[136:139]
    v_mfma_f32_16x16x32_bf16 v[140:143], a[76:79], v[72:75], v[140:143]
    v_mfma_f32_16x16x32_bf16 v[144:147], a[64:67], v[76:79], v[144:147]
    v_mfma_f32_16x16x32_bf16 v[148:151], a[68:71], v[76:79], v[148:151]
    v_mfma_f32_16x16x32_bf16 v[152:155], a[72:75], v[76:79], v[152:155]
    v_mfma_f32_16x16x32_bf16 v[156:159], a[76:79], v[76:79], v[156:159]
    s_waitcnt lgkmcnt(0)
    v_mfma_f32_16x16x32_bf16 v[96:99], a[80:83], v[80:83], v[96:99]
    ds_read_b128 v[64:67], v224 offset:24576
    v_mfma_f32_16x16x32_bf16 v[100:103], a[84:87], v[80:83], v[100:103]
    ds_read_b128 v[68:71], v224 offset:26624
    v_mfma_f32_16x16x32_bf16 v[104:107], a[88:91], v[80:83], v[104:107]
    ds_read_b128 v[72:75], v224 offset:28672
    v_mfma_f32_16x16x32_bf16 v[108:111], a[92:95], v[80:83], v[108:111]
    ds_read_b128 v[76:79], v224 offset:30720
    v_mfma_f32_16x16x32_bf16 v[112:115], a[80:83], v[84:87], v[112:115]
    v_mfma_f32_16x16x32_bf16 v[116:119], a[84:87], v[84:87], v[116:119]
    v_mfma_f32_16x16x32_bf16 v[120:123], a[88:91], v[84:87], v[120:123]
    v_mfma_f32_16x16x32_bf16 v[124:127], a[92:95], v[84:87], v[124:127]
    v_mfma_f32_16x16x32_bf16 v[128:131], a[80:83], v[88:91], v[128:131]
    s_add_u32 m0, s34, 8192
    s_add_u32 s37, s81, 196608
    buffer_load_dwordx4 v232, s[44:47], s37 offen lds
    v_mfma_f32_16x16x32_bf16 v[132:135], a[84:87], v[88:91], v[132:135]
    v_mfma_f32_16x16x32_bf16 v[136:139], a[88:91], v[88:91], v[136:139]
    buffer_load_dwordx4 v233, s[44:47], s37 offen offset:1024 lds
    s_add_u32 s38, s36, 8192
    buffer_store_dwordx4 v[16:19], v240, s[16:19], s38 offen offset:0 sc1
    v_mfma_f32_16x16x32_bf16 v[140:143], a[92:95], v[88:91], v[140:143]
    v_mfma_f32_16x16x32_bf16 v[144:147], a[80:83], v[92:95], v[144:147]
    v_mfma_f32_16x16x32_bf16 v[148:151], a[84:87], v[92:95], v[148:151]
    s_add_u32 m0, s31, 1024
    s_add_u32 s24, s27, 32768
    buffer_load_dwordx4 v245, s[12:15], s24 offen lds
    v_mfma_f32_16x16x32_bf16 v[152:155], a[88:91], v[92:95], v[152:155]
    v_mfma_f32_16x16x32_bf16 v[156:159], a[92:95], v[92:95], v[156:159]
    s_waitcnt lgkmcnt(0)
    v_mfma_f32_16x16x32_bf16 v[96:99], a[96:99], v[64:67], v[96:99]
    ds_read_b128 v[80:83], v225 offset:24576
    v_mfma_f32_16x16x32_bf16 v[100:103], a[100:103], v[64:67], v[100:103]
    ds_read_b128 v[84:87], v225 offset:26624
    v_mfma_f32_16x16x32_bf16 v[104:107], a[104:107], v[64:67], v[104:107]
    ds_read_b128 v[88:91], v225 offset:28672
    v_mfma_f32_16x16x32_bf16 v[108:111], a[108:111], v[64:67], v[108:111]
    ds_read_b128 v[92:95], v225 offset:30720
    v_mfma_f32_16x16x32_bf16 v[112:115], a[96:99], v[68:71], v[112:115]
    v_mfma_f32_16x16x32_bf16 v[116:119], a[100:103], v[68:71], v[116:119]
    v_mfma_f32_16x16x32_bf16 v[120:123], a[104:107], v[68:71], v[120:123]
    v_mfma_f32_16x16x32_bf16 v[124:127], a[108:111], v[68:71], v[124:127]
    v_mfma_f32_16x16x32_bf16 v[128:131], a[96:99], v[72:75], v[128:131]
    s_add_u32 m0, s31, 2048
    s_add_u32 s24, s27, 65536
    buffer_load_dwordx4 v237, s[12:15], s24 offen lds
    v_mfma_f32_16x16x32_bf16 v[132:135], a[100:103], v[72:75], v[132:135]
    v_mfma_f32_16x16x32_bf16 v[136:139], a[104:107], v[72:75], v[136:139]
    v_mfma_f32_16x16x32_bf16 v[140:143], a[108:111], v[72:75], v[140:143]
    v_mfma_f32_16x16x32_bf16 v[144:147], a[96:99], v[76:79], v[144:147]
    v_mfma_f32_16x16x32_bf16 v[148:151], a[100:103], v[76:79], v[148:151]
    v_mfma_f32_16x16x32_bf16 v[152:155], a[104:107], v[76:79], v[152:155]
    v_mfma_f32_16x16x32_bf16 v[156:159], a[108:111], v[76:79], v[156:159]
    s_add_u32 s38, s36, 8192
    buffer_store_dwordx4 v[20:23], v240, s[16:19], s38 offen offset:2048 sc1
    s_waitcnt vmcnt(19) lgkmcnt(0)
    s_barrier
    v_mfma_f32_16x16x32_bf16 v[96:99], a[112:115], v[80:83], v[96:99]
    ds_read_b128 v[64:67], v224 offset:32768
    v_mfma_f32_16x16x32_bf16 v[100:103], a[116:119], v[80:83], v[100:103]
    ds_read_b128 v[68:71], v224 offset:34816
    v_mfma_f32_16x16x32_bf16 v[104:107], a[120:123], v[80:83], v[104:107]
    ds_read_b128 v[72:75], v224 offset:36864
    v_mfma_f32_16x16x32_bf16 v[108:111], a[124:127], v[80:83], v[108:111]
    ds_read_b128 v[76:79], v224 offset:38912
    v_mfma_f32_16x16x32_bf16 v[112:115], a[112:115], v[84:87], v[112:115]
    v_mfma_f32_16x16x32_bf16 v[116:119], a[116:119], v[84:87], v[116:119]
    v_mfma_f32_16x16x32_bf16 v[120:123], a[120:123], v[84:87], v[120:123]
    v_mfma_f32_16x16x32_bf16 v[124:127], a[124:127], v[84:87], v[124:127]
    v_mfma_f32_16x16x32_bf16 v[128:131], a[112:115], v[88:91], v[128:131]
    s_add_u32 m0, s34, 16384
    s_add_u32 s37, s82, 196608
    buffer_load_dwordx4 v232, s[44:47], s37 offen lds
    v_mfma_f32_16x16x32_bf16 v[132:135], a[116:119], v[88:91], v[132:135]
    v_mfma_f32_16x16x32_bf16 v[136:139], a[120:123], v[88:91], v[136:139]
    buffer_load_dwordx4 v233, s[44:47], s37 offen offset:1024 lds
    v_mfma_f32_16x16x32_bf16 v[140:143], a[124:127], v[88:91], v[140:143]
    v_mfma_f32_16x16x32_bf16 v[144:147], a[112:115], v[92:95], v[144:147]
    v_mfma_f32_16x16x32_bf16 v[148:151], a[116:119], v[92:95], v[148:151]
    s_add_u32 m0, s31, 3072
    s_add_u32 s24, s27, 98304
    buffer_load_dwordx4 v237, s[12:15], s24 offen lds
    v_mfma_f32_16x16x32_bf16 v[152:155], a[120:123], v[92:95], v[152:155]
    v_mfma_f32_16x16x32_bf16 v[156:159], a[124:127], v[92:95], v[156:159]
    s_waitcnt lgkmcnt(0)
    v_mfma_f32_16x16x32_bf16 v[96:99], a[128:131], v[64:67], v[96:99]
    ds_read_b128 v[80:83], v225 offset:32768
    v_mfma_f32_16x16x32_bf16 v[100:103], a[132:135], v[64:67], v[100:103]
    ds_read_b128 v[84:87], v225 offset:34816
    v_mfma_f32_16x16x32_bf16 v[104:107], a[136:139], v[64:67], v[104:107]
    ds_read_b128 v[88:91], v225 offset:36864
    v_mfma_f32_16x16x32_bf16 v[108:111], a[140:143], v[64:67], v[108:111]
    ds_read_b128 v[92:95], v225 offset:38912
    v_mfma_f32_16x16x32_bf16 v[112:115], a[128:131], v[68:71], v[112:115]
    v_mfma_f32_16x16x32_bf16 v[116:119], a[132:135], v[68:71], v[116:119]
    s_add_u32 s38, s36, 8192
    buffer_store_dwordx4 v[24:27], v240, s[16:19], s38 offen offset:1024 sc1
    v_mfma_f32_16x16x32_bf16 v[120:123], a[136:139], v[68:71], v[120:123]
    v_mfma_f32_16x16x32_bf16 v[124:127], a[140:143], v[68:71], v[124:127]
    v_mfma_f32_16x16x32_bf16 v[128:131], a[128:131], v[72:75], v[128:131]
    s_add_u32 m0, s31, 4096
    s_add_u32 s24, s27, 131072
    buffer_load_dwordx4 v245, s[12:15], s24 offen lds
    v_mfma_f32_16x16x32_bf16 v[132:135], a[132:135], v[72:75], v[132:135]
    v_mfma_f32_16x16x32_bf16 v[136:139], a[136:139], v[72:75], v[136:139]
    v_mfma_f32_16x16x32_bf16 v[140:143], a[140:143], v[72:75], v[140:143]
    v_mfma_f32_16x16x32_bf16 v[144:147], a[128:131], v[76:79], v[144:147]
    v_mfma_f32_16x16x32_bf16 v[148:151], a[132:135], v[76:79], v[148:151]
    v_mfma_f32_16x16x32_bf16 v[152:155], a[136:139], v[76:79], v[152:155]
    v_mfma_f32_16x16x32_bf16 v[156:159], a[140:143], v[76:79], v[156:159]
    s_waitcnt lgkmcnt(0)
    v_mfma_f32_16x16x32_bf16 v[96:99], a[144:147], v[80:83], v[96:99]
    ds_read_b128 v[64:67], v224 offset:40960
    v_mfma_f32_16x16x32_bf16 v[100:103], a[148:151], v[80:83], v[100:103]
    ds_read_b128 v[68:71], v224 offset:43008
    v_mfma_f32_16x16x32_bf16 v[104:107], a[152:155], v[80:83], v[104:107]
    ds_read_b128 v[72:75], v224 offset:45056
    v_mfma_f32_16x16x32_bf16 v[108:111], a[156:159], v[80:83], v[108:111]
    ds_read_b128 v[76:79], v224 offset:47104
    v_mfma_f32_16x16x32_bf16 v[112:115], a[144:147], v[84:87], v[112:115]
    v_mfma_f32_16x16x32_bf16 v[116:119], a[148:151], v[84:87], v[116:119]
    v_mfma_f32_16x16x32_bf16 v[120:123], a[152:155], v[84:87], v[120:123]
    v_mfma_f32_16x16x32_bf16 v[124:127], a[156:159], v[84:87], v[124:127]
    v_mfma_f32_16x16x32_bf16 v[128:131], a[144:147], v[88:91], v[128:131]
    s_add_u32 m0, s34, 24576
    s_add_u32 s37, s83, 196608
    buffer_load_dwordx4 v232, s[44:47], s37 offen lds
    v_mfma_f32_16x16x32_bf16 v[132:135], a[148:151], v[88:91], v[132:135]
    v_mfma_f32_16x16x32_bf16 v[136:139], a[152:155], v[88:91], v[136:139]
    buffer_load_dwordx4 v233, s[44:47], s37 offen offset:1024 lds
    s_add_u32 s38, s36, 8192
    buffer_store_dwordx4 v[28:31], v240, s[16:19], s38 offen offset:3072 sc1
    v_mfma_f32_16x16x32_bf16 v[140:143], a[156:159], v[88:91], v[140:143]
    v_mfma_f32_16x16x32_bf16 v[144:147], a[144:147], v[92:95], v[144:147]
    v_mfma_f32_16x16x32_bf16 v[148:151], a[148:151], v[92:95], v[148:151]
    s_add_u32 m0, s31, 5120
    s_add_u32 s24, s27, 163840
    buffer_load_dwordx4 v245, s[12:15], s24 offen lds
    v_mfma_f32_16x16x32_bf16 v[152:155], a[152:155], v[92:95], v[152:155]
    v_mfma_f32_16x16x32_bf16 v[156:159], a[156:159], v[92:95], v[156:159]
    s_waitcnt lgkmcnt(0)
    v_mfma_f32_16x16x32_bf16 v[96:99], a[160:163], v[64:67], v[96:99]
    ds_read_b128 v[80:83], v225 offset:40960
    v_mfma_f32_16x16x32_bf16 v[100:103], a[164:167], v[64:67], v[100:103]
    ds_read_b128 v[84:87], v225 offset:43008
    v_mfma_f32_16x16x32_bf16 v[104:107], a[168:171], v[64:67], v[104:107]
    ds_read_b128 v[88:91], v225 offset:45056
    v_mfma_f32_16x16x32_bf16 v[108:111], a[172:175], v[64:67], v[108:111]
    ds_read_b128 v[92:95], v225 offset:47104
    v_mfma_f32_16x16x32_bf16 v[112:115], a[160:163], v[68:71], v[112:115]
    v_mfma_f32_16x16x32_bf16 v[116:119], a[164:167], v[68:71], v[116:119]
    v_mfma_f32_16x16x32_bf16 v[120:123], a[168:171], v[68:71], v[120:123]
    v_mfma_f32_16x16x32_bf16 v[124:127], a[172:175], v[68:71], v[124:127]
    v_mfma_f32_16x16x32_bf16 v[128:131], a[160:163], v[72:75], v[128:131]
    s_add_u32 m0, s31, 6144
    s_add_u32 s24, s27, 196608
    buffer_load_dwordx4 v237, s[12:15], s24 offen lds
    v_mfma_f32_16x16x32_bf16 v[132:135], a[164:167], v[72:75], v[132:135]
    v_mfma_f32_16x16x32_bf16 v[136:139], a[168:171], v[72:75], v[136:139]
    v_mfma_f32_16x16x32_bf16 v[140:143], a[172:175], v[72:75], v[140:143]
    v_mfma_f32_16x16x32_bf16 v[144:147], a[160:163], v[76:79], v[144:147]
    v_mfma_f32_16x16x32_bf16 v[148:151], a[164:167], v[76:79], v[148:151]
    v_mfma_f32_16x16x32_bf16 v[152:155], a[168:171], v[76:79], v[152:155]
    v_mfma_f32_16x16x32_bf16 v[156:159], a[172:175], v[76:79], v[156:159]
    s_waitcnt vmcnt(22) lgkmcnt(0)
    s_barrier
    v_mfma_f32_16x16x32_bf16 v[96:99], a[176:179], v[80:83], v[96:99]
    ds_read_b128 v[64:67], v224 offset:49152
    s_add_u32 s38, s36, 32768
    buffer_store_dwordx4 v[32:35], v240, s[16:19], s38 offen offset:1280 sc1
    v_mfma_f32_16x16x32_bf16 v[100:103], a[180:183], v[80:83], v[100:103]
    ds_read_b128 v[68:71], v224 offset:51200
    v_mfma_f32_16x16x32_bf16 v[104:107], a[184:187], v[80:83], v[104:107]
    ds_read_b128 v[72:75], v224 offset:53248
    v_mfma_f32_16x16x32_bf16 v[108:111], a[188:191], v[80:83], v[108:111]
    ds_read_b128 v[76:79], v224 offset:55296
    v_mfma_f32_16x16x32_bf16 v[112:115], a[176:179], v[84:87], v[112:115]
    v_mfma_f32_16x16x32_bf16 v[116:119], a[180:183], v[84:87], v[116:119]
    v_mfma_f32_16x16x32_bf16 v[120:123], a[184:187], v[84:87], v[120:123]
    v_mfma_f32_16x16x32_bf16 v[124:127], a[188:191], v[84:87], v[124:127]
    v_mfma_f32_16x16x32_bf16 v[128:131], a[176:179], v[88:91], v[128:131]
    s_add_u32 m0, s34, 32768
    s_add_u32 s37, s84, 196608
    buffer_load_dwordx4 v232, s[44:47], s37 offen lds
    v_mfma_f32_16x16x32_bf16 v[132:135], a[180:183], v[88:91], v[132:135]
    buffer_load_dwordx4 v233, s[44:47], s37 offen offset:1024 lds
    v_mfma_f32_16x16x32_bf16 v[136:139], a[184:187], v[88:91], v[136:139]
    v_mfma_f32_16x16x32_bf16 v[140:143], a[188:191], v[88:91], v[140:143]
    s_add_u32 m0, s31, 7168
    s_add_u32 s24, s27, 229376
    buffer_load_dwordx4 v237, s[12:15], s24 offen lds
    v_mfma_f32_16x16x32_bf16 v[144:147], a[176:179], v[92:95], v[144:147]
    s_add_u32 s27, s27, 1048576
    s_and_b32 s27, s27, 0x407fffff
    s_cmp_eq_u32 s27, s7
    s_cselect_b32 s27, s43, s27
    v_mfma_f32_16x16x32_bf16 v[148:151], a[180:183], v[92:95], v[148:151]
    v_mfma_f32_16x16x32_bf16 v[152:155], a[184:187], v[92:95], v[152:155]
    s_add_u32 s31, s31, 32768
    s_cmp_ge_u32 s31, 163840
    s_cselect_b32 s24, 98304, 0
    s_sub_u32 s31, s31, s24
    v_mfma_f32_16x16x32_bf16 v[156:159], a[188:191], v[92:95], v[156:159]
    s_waitcnt lgkmcnt(0)
    v_mfma_f32_16x16x32_bf16 v[96:99], a[192:195], v[64:67], v[96:99]
    ds_read_b128 v[80:83], v225 offset:49152
    v_mfma_f32_16x16x32_bf16 v[100:103], a[196:199], v[64:67], v[100:103]
    ds_read_b128 v[84:87], v225 offset:51200
    v_mfma_f32_16x16x32_bf16 v[104:107], a[200:203], v[64:67], v[104:107]
    ds_read_b128 v[88:91], v225 offset:53248
    v_mfma_f32_16x16x32_bf16 v[108:111], a[204:207], v[64:67], v[108:111]
    ds_read_b128 v[92:95], v225 offset:55296
    v_mfma_f32_16x16x32_bf16 v[112:115], a[192:195], v[68:71], v[112:115]
    v_mfma_f32_16x16x32_bf16 v[116:119], a[196:199], v[68:71], v[116:119]
    v_mfma_f32_16x16x32_bf16 v[120:123], a[200:203], v[68:71], v[120:123]
    s_add_u32 s38, s36, 32768
    buffer_store_dwordx4 v[36:39], v240, s[16:19], s38 offen offset:3328 sc1
    v_mfma_f32_16x16x32_bf16 v[124:127], a[204:207], v[68:71], v[124:127]
    v_mfma_f32_16x16x32_bf16 v[128:131], a[192:195], v[72:75], v[128:131]
    v_mfma_f32_16x16x32_bf16 v[132:135], a[196:199], v[72:75], v[132:135]
    v_mfma_f32_16x16x32_bf16 v[136:139], a[200:203], v[72:75], v[136:139]
    v_mfma_f32_16x16x32_bf16 v[140:143], a[204:207], v[72:75], v[140:143]
    v_mfma_f32_16x16x32_bf16 v[144:147], a[192:195], v[76:79], v[144:147]
    v_mfma_f32_16x16x32_bf16 v[148:151], a[196:199], v[76:79], v[148:151]
    v_mfma_f32_16x16x32_bf16 v[152:155], a[200:203], v[76:79], v[152:155]
    v_mfma_f32_16x16x32_bf16 v[156:159], a[204:207], v[76:79], v[156:159]
    s_waitcnt lgkmcnt(0)
    v_mfma_f32_16x16x32_bf16 v[96:99], a[208:211], v[80:83], v[96:99]
    ds_read_b128 v[64:67], v224 offset:57344
    v_mfma_f32_16x16x32_bf16 v[100:103], a[212:215], v[80:83], v[100:103]
    ds_read_b128 v[68:71], v224 offset:59392
    v_mfma_f32_16x16x32_bf16 v[104:107], a[216:219], v[80:83], v[104:107]
    ds_read_b128 v[72:75], v224 offset:61440
    v_mfma_f32_16x16x32_bf16 v[108:111], a[220:223], v[80:83], v[108:111]
    ds_read_b128 v[76:79], v224 offset:63488
    v_mfma_f32_16x16x32_bf16 v[112:115], a[208:211], v[84:87], v[112:115]
    v_mfma_f32_16x16x32_bf16 v[116:119], a[212:215], v[84:87], v[116:119]
    v_mfma_f32_16x16x32_bf16 v[120:123], a[216:219], v[84:87], v[120:123]
    v_mfma_f32_16x16x32_bf16 v[124:127], a[220:223], v[84:87], v[124:127]
    v_mfma_f32_16x16x32_bf16 v[128:131], a[208:211], v[88:91], v[128:131]
    s_add_u32 m0, s34, 40960
    s_add_u32 s37, s85, 196608
    buffer_load_dwordx4 v232, s[44:47], s37 offen lds
    v_mfma_f32_16x16x32_bf16 v[132:135], a[212:215], v[88:91], v[132:135]
    v_mfma_f32_16x16x32_bf16 v[136:139], a[216:219], v[88:91], v[136:139]
    v_mfma_f32_16x16x32_bf16 v[140:143], a[220:223], v[88:91], v[140:143]
    s_add_u32 s38, s36, 32768
    buffer_store_dwordx4 v[40:43], v240, s[16:19], s38 offen offset:2304 sc1
    v_mfma_f32_16x16x32_bf16 v[144:147], a[208:211], v[92:95], v[144:147]
    buffer_load_dwordx4 v233, s[44:47], s37 offen offset:1024 lds
    v_mfma_f32_16x16x32_bf16 v[148:151], a[212:215], v[92:95], v[148:151]
    v_mfma_f32_16x16x32_bf16 v[152:155], a[216:219], v[92:95], v[152:155]
    v_mfma_f32_16x16x32_bf16 v[156:159], a[220:223], v[92:95], v[156:159]
    s_waitcnt lgkmcnt(0)
    v_mfma_f32_16x16x32_bf16 v[96:99], a[224:227], v[64:67], v[96:99]
    ds_read_b128 v[80:83], v225 offset:57344
    v_mfma_f32_16x16x32_bf16 v[100:103], a[228:231], v[64:67], v[100:103]
    ds_read_b128 v[84:87], v225 offset:59392
    v_mfma_f32_16x16x32_bf16 v[104:107], a[232:235], v[64:67], v[104:107]
    ds_read_b128 v[88:91], v225 offset:61440
    v_mfma_f32_16x16x32_bf16 v[108:111], a[236:239], v[64:67], v[108:111]
    ds_read_b128 v[92:95], v225 offset:63488
    v_mfma_f32_16x16x32_bf16 v[112:115], a[224:227], v[68:71], v[112:115]
    v_mfma_f32_16x16x32_bf16 v[116:119], a[228:231], v[68:71], v[116:119]
    v_mfma_f32_16x16x32_bf16 v[120:123], a[232:235], v[68:71], v[120:123]
    v_mfma_f32_16x16x32_bf16 v[124:127], a[236:239], v[68:71], v[124:127]
    v_mfma_f32_16x16x32_bf16 v[128:131], a[224:227], v[72:75], v[128:131]
    s_add_u32 m0, s31, 0
    s_add_u32 s24, s27, 0
    buffer_load_dwordx4 v245, s[12:15], s24 offen lds
    v_mfma_f32_16x16x32_bf16 v[132:135], a[228:231], v[72:75], v[132:135]
    v_mfma_f32_16x16x32_bf16 v[136:139], a[232:235], v[72:75], v[136:139]
    v_mfma_f32_16x16x32_bf16 v[140:143], a[236:239], v[72:75], v[140:143]
    v_mfma_f32_16x16x32_bf16 v[144:147], a[224:227], v[76:79], v[144:147]
    v_mfma_f32_16x16x32_bf16 v[148:151], a[228:231], v[76:79], v[148:151]
    v_mfma_f32_16x16x32_bf16 v[152:155], a[232:235], v[76:79], v[152:155]
    v_mfma_f32_16x16x32_bf16 v[156:159], a[236:239], v[76:79], v[156:159]
    s_waitcnt vmcnt(23) lgkmcnt(0)
    s_barrier
    v_mfma_f32_16x16x32_bf16 v[96:99], a[240:243], v[80:83], v[96:99]
    ds_read_b128 v[64:67], v224 offset:0
    v_mfma_f32_16x16x32_bf16 v[100:103], a[244:247], v[80:83], v[100:103]
    ds_read_b128 v[68:71], v224 offset:2048
    s_add_u32 s38, s36, 36864
    buffer_store_dwordx4 v[44:47], v240, s[16:19], s38 offen offset:256 sc1
    v_mfma_f32_16x16x32_bf16 v[104:107], a[248:251], v[80:83], v[104:107]
    ds_read_b128 v[72:75], v224 offset:4096
    v_mfma_f32_16x16x32_bf16 v[108:111], a[252:255], v[80:83], v[108:111]
    ds_read_b128 v[76:79], v224 offset:6144
    v_mfma_f32_16x16x32_bf16 v[112:115], a[240:243], v[84:87], v[112:115]
    v_mfma_f32_16x16x32_bf16 v[116:119], a[244:247], v[84:87], v[116:119]
    v_mfma_f32_16x16x32_bf16 v[120:123], a[248:251], v[84:87], v[120:123]
    v_mfma_f32_16x16x32_bf16 v[124:127], a[252:255], v[84:87], v[124:127]
    v_mfma_f32_16x16x32_bf16 v[128:131], a[240:243], v[88:91], v[128:131]
    s_add_u32 m0, s34, 49152
    s_add_u32 s37, s86, 196608
    buffer_load_dwordx4 v232, s[44:47], s37 offen lds
    v_mfma_f32_16x16x32_bf16 v[132:135], a[244:247], v[88:91], v[132:135]
    v_mfma_f32_16x16x32_bf16 v[136:139], a[248:251], v[88:91], v[136:139]
    buffer_load_dwordx4 v233, s[44:47], s37 offen offset:1024 lds
    v_mfma_f32_16x16x32_bf16 v[140:143], a[252:255], v[88:91], v[140:143]
    v_mfma_f32_16x16x32_bf16 v[144:147], a[240:243], v[92:95], v[144:147]
    v_mfma_f32_16x16x32_bf16 v[148:151], a[244:247], v[92:95], v[148:151]
    s_add_u32 m0, s31, 1024
    s_add_u32 s24, s27, 32768
    buffer_load_dwordx4 v245, s[12:15], s24 offen lds
    v_mfma_f32_16x16x32_bf16 v[152:155], a[248:251], v[92:95], v[152:155]
    v_mfma_f32_16x16x32_bf16 v[156:159], a[252:255], v[92:95], v[156:159]
    s_waitcnt lgkmcnt(0)
    v_mfma_f32_16x16x32_bf16 v[160:163], a[0:3], v[64:67], 0
    ds_read_b128 v[80:83], v225 offset:0
    v_mfma_f32_16x16x32_bf16 v[164:167], a[4:7], v[64:67], 0
    ds_read_b128 v[84:87], v225 offset:2048
    v_mfma_f32_16x16x32_bf16 v[168:171], a[8:11], v[64:67], 0
    ds_read_b128 v[88:91], v225 offset:4096
    v_mfma_f32_16x16x32_bf16 v[172:175], a[12:15], v[64:67], 0
    ds_read_b128 v[92:95], v225 offset:6144
    v_mfma_f32_16x16x32_bf16 v[176:179], a[0:3], v[68:71], 0
    v_cvt_pk_bf16_f32 v0, v96, v97
    v_cvt_pk_bf16_f32 v1, v98, v99
    v_mfma_f32_16x16x32_bf16 v[180:183], a[4:7], v[68:71], 0
    v_mfma_f32_16x16x32_bf16 v[184:187], a[8:11], v[68:71], 0
    v_cvt_pk_bf16_f32 v2, v100, v101
    v_cvt_pk_bf16_f32 v3, v102, v103
    s_add_u32 s38, s36, 40960
    buffer_store_dwordx4 v[48:51], v240, s[16:19], s38 offen offset:1280 sc1
    v_mfma_f32_16x16x32_bf16 v[188:191], a[12:15], v[68:71], 0
    v_mfma_f32_16x16x32_bf16 v[192:195], a[0:3], v[72:75], 0
    s_add_u32 m0, s31, 2048
    s_add_u32 s24, s27, 65536
    buffer_load_dwordx4 v237, s[12:15], s24 offen lds
    v_cvt_pk_bf16_f32 v4, v104, v105
    v_cvt_pk_bf16_f32 v5, v106, v107
    v_mfma_f32_16x16x32_bf16 v[196:199], a[4:7], v[72:75], 0
    v_mfma_f32_16x16x32_bf16 v[200:203], a[8:11], v[72:75], 0
    v_cvt_pk_bf16_f32 v6, v108, v109
    v_cvt_pk_bf16_f32 v7, v110, v111
    v_mfma_f32_16x16x32_bf16 v[204:207], a[12:15], v[72:75], 0
    v_mfma_f32_16x16x32_bf16 v[208:211], a[0:3], v[76:79], 0
    v_cvt_pk_bf16_f32 v8, v112, v113
    v_cvt_pk_bf16_f32 v9, v114, v115
    v_mfma_f32_16x16x32_bf16 v[212:215], a[4:7], v[76:79], 0
    v_mfma_f32_16x16x32_bf16 v[216:219], a[8:11], v[76:79], 0
    v_cvt_pk_bf16_f32 v10, v116, v117
    v_cvt_pk_bf16_f32 v11, v118, v119
    v_mfma_f32_16x16x32_bf16 v[220:223], a[12:15], v[76:79], 0
    s_waitcnt lgkmcnt(0)
    v_mfma_f32_16x16x32_bf16 v[160:163], a[16:19], v[80:83], v[160:163]
    ds_read_b128 v[64:67], v224 offset:8192
    v_cvt_pk_bf16_f32 v12, v120, v121
    v_cvt_pk_bf16_f32 v13, v122, v123
    v_mfma_f32_16x16x32_bf16 v[164:167], a[20:23], v[80:83], v[164:167]
    ds_read_b128 v[68:71], v224 offset:10240
    v_mfma_f32_16x16x32_bf16 v[168:171], a[24:27], v[80:83], v[168:171]
    ds_read_b128 v[72:75], v224 offset:12288
    v_cvt_pk_bf16_f32 v14, v124, v125
    v_cvt_pk_bf16_f32 v15, v126, v127
    v_mfma_f32_16x16x32_bf16 v[172:175], a[28:31], v[80:83], v[172:175]
    ds_read_b128 v[76:79], v224 offset:14336
    v_mfma_f32_16x16x32_bf16 v[176:179], a[16:19], v[84:87], v[176:179]
    v_cvt_pk_bf16_f32 v16, v128, v129
    v_cvt_pk_bf16_f32 v17, v130, v131
    v_mfma_f32_16x16x32_bf16 v[180:183], a[20:23], v[84:87], v[180:183]
    v_mfma_f32_16x16x32_bf16 v[184:187], a[24:27], v[84:87], v[184:187]
    v_cvt_pk_bf16_f32 v18, v132, v133
    v_cvt_pk_bf16_f32 v19, v134, v135
    v_mfma_f32_16x16x32_bf16 v[188:191], a[28:31], v[84:87], v[188:191]
    v_mfma_f32_16x16x32_bf16 v[192:195], a[16:19], v[88:91], v[192:195]
    s_add_u32 m0, s34, 57344
    s_add_u32 s37, s87, 196608
    buffer_load_dwordx4 v232, s[44:47], s37 offen lds
    v_cvt_pk_bf16_f32 v20, v136, v137
    v_cvt_pk_bf16_f32 v21, v138, v139
    v_mfma_f32_16x16x32_bf16 v[196:199], a[20:23], v[88:91], v[196:199]
    v_mfma_f32_16x16x32_bf16 v[200:203], a[24:27], v[88:91], v[200:203]
    buffer_load_dwordx4 v233, s[44:47], s37 offen offset:1024 lds
    v_cvt_pk_bf16_f32 v22, v140, v141
    v_cvt_pk_bf16_f32 v23, v142, v143
    v_mfma_f32_16x16x32_bf16 v[204:207], a[28:31], v[88:91], v[204:207]
    v_mfma_f32_16x16x32_bf16 v[208:211], a[16:19], v[92:95], v[208:211]
    v_cvt_pk_bf16_f32 v24, v144, v145
    v_cvt_pk_bf16_f32 v25, v146, v147
    s_add_u32 s38, s36, 40960
    buffer_store_dwordx4 v[52:55], v240, s[16:19], s38 offen offset:3328 sc1
    v_mfma_f32_16x16x32_bf16 v[212:215], a[20:23], v[92:95], v[212:215]
    s_add_u32 m0, s31, 3072
    s_add_u32 s24, s27, 98304
    buffer_load_dwordx4 v237, s[12:15], s24 offen lds
    v_mfma_f32_16x16x32_bf16 v[216:219], a[24:27], v[92:95], v[216:219]
    v_cvt_pk_bf16_f32 v26, v148, v149
    v_cvt_pk_bf16_f32 v27, v150, v151
    v_mfma_f32_16x16x32_bf16 v[220:223], a[28:31], v[92:95], v[220:223]
    s_waitcnt lgkmcnt(0)
    v_mfma_f32_16x16x32_bf16 v[160:163], a[32:35], v[64:67], v[160:163]
    ds_read_b128 v[80:83], v225 offset:8192
    v_cvt_pk_bf16_f32 v28, v152, v153
    v_cvt_pk_bf16_f32 v29, v154, v155
    v_mfma_f32_16x16x32_bf16 v[164:167], a[36:39], v[64:67], v[164:167]
    ds_read_b128 v[84:87], v225 offset:10240
    v_mfma_f32_16x16x32_bf16 v[168:171], a[40:43], v[64:67], v[168:171]
    ds_read_b128 v[88:91], v225 offset:12288
    v_cvt_pk_bf16_f32 v30, v156, v157
    v_cvt_pk_bf16_f32 v31, v158, v159
    v_mfma_f32_16x16x32_bf16 v[172:175], a[44:47], v[64:67], v[172:175]
    ds_read_b128 v[92:95], v225 offset:14336
    v_mfma_f32_16x16x32_bf16 v[176:179], a[32:35], v[68:71], v[176:179]
    v_mfma_f32_16x16x32_bf16 v[180:183], a[36:39], v[68:71], v[180:183]
    v_mfma_f32_16x16x32_bf16 v[184:187], a[40:43], v[68:71], v[184:187]
    v_mfma_f32_16x16x32_bf16 v[188:191], a[44:47], v[68:71], v[188:191]
    v_mfma_f32_16x16x32_bf16 v[192:195], a[32:35], v[72:75], v[192:195]
    s_add_u32 m0, s31, 4096
    s_add_u32 s24, s27, 131072
    buffer_load_dwordx4 v245, s[12:15], s24 offen lds
    v_mfma_f32_16x16x32_bf16 v[196:199], a[36:39], v[72:75], v[196:199]
    v_mfma_f32_16x16x32_bf16 v[200:203], a[40:43], v[72:75], v[200:203]
    v_mfma_f32_16x16x32_bf16 v[204:207], a[44:47], v[72:75], v[204:207]
    v_mfma_f32_16x16x32_bf16 v[208:211], a[32:35], v[76:79], v[208:211]
    v_mfma_f32_16x16x32_bf16 v[212:215], a[36:39], v[76:79], v[212:215]
    v_mfma_f32_16x16x32_bf16 v[216:219], a[40:43], v[76:79], v[216:219]
    v_mfma_f32_16x16x32_bf16 v[220:223], a[44:47], v[76:79], v[220:223]
    s_waitcnt vmcnt(23) lgkmcnt(0)
    s_barrier
    v_mfma_f32_16x16x32_bf16 v[160:163], a[48:51], v[80:83], v[160:163]
    ds_read_b128 v[64:67], v224 offset:16384
    v_mfma_f32_16x16x32_bf16 v[164:167], a[52:55], v[80:83], v[164:167]
    ds_read_b128 v[68:71], v224 offset:18432
    s_add_u32 s38, s36, 40960
    buffer_store_dwordx4 v[56:59], v240, s[16:19], s38 offen offset:2304 sc1
    v_mfma_f32_16x16x32_bf16 v[168:171], a[56:59], v[80:83], v[168:171]
    ds_read_b128 v[72:75], v224 offset:20480
    v_mfma_f32_16x16x32_bf16 v[172:175], a[60:63], v[80:83], v[172:175]
    ds_read_b128 v[76:79], v224 offset:22528
    v_mfma_f32_16x16x32_bf16 v[176:179], a[48:51], v[84:87], v[176:179]
    v_mfma_f32_16x16x32_bf16 v[180:183], a[52:55], v[84:87], v[180:183]
    v_mfma_f32_16x16x32_bf16 v[184:187], a[56:59], v[84:87], v[184:187]
    v_mfma_f32_16x16x32_bf16 v[188:191], a[60:63], v[84:87], v[188:191]
    v_mfma_f32_16x16x32_bf16 v[192:195], a[48:51], v[88:91], v[192:195]
    s_add_u32 m0, s31, 5120
    s_add_u32 s24, s27, 163840
    buffer_load_dwordx4 v245, s[12:15], s24 offen lds
    v_mfma_f32_16x16x32_bf16 v[196:199], a[52:55], v[88:91], v[196:199]
    v_mfma_f32_16x16x32_bf16 v[200:203], a[56:59], v[88:91], v[200:203]
    v_mfma_f32_16x16x32_bf16 v[204:207], a[60:63], v[88:91], v[204:207]
    v_mfma_f32_16x16x32_bf16 v[208:211], a[48:51], v[92:95], v[208:211]
    v_mfma_f32_16x16x32_bf16 v[212:215], a[52:55], v[92:95], v[212:215]
    v_mfma_f32_16x16x32_bf16 v[216:219], a[56:59], v[92:95], v[216:219]
    v_mfma_f32_16x16x32_bf16 v[220:223], a[60:63], v[92:95], v[220:223]
    s_waitcnt lgkmcnt(0)
    v_mfma_f32_16x16x32_bf16 v[160:163], a[64:67], v[64:67], v[160:163]
    ds_read_b128 v[80:83], v225 offset:16384
    v_mfma_f32_16x16x32_bf16 v[164:167], a[68:71], v[64:67], v[164:167]
    ds_read_b128 v[84:87], v225 offset:18432
    v_mfma_f32_16x16x32_bf16 v[168:171], a[72:75], v[64:67], v[168:171]
    ds_read_b128 v[88:91], v225 offset:20480
    v_mfma_f32_16x16x32_bf16 v[172:175], a[76:79], v[64:67], v[172:175]
    ds_read_b128 v[92:95], v225 offset:22528
    v_mfma_f32_16x16x32_bf16 v[176:179], a[64:67], v[68:71], v[176:179]
    v_mfma_f32_16x16x32_bf16 v[180:183], a[68:71], v[68:71], v[180:183]
    v_mfma_f32_16x16x32_bf16 v[184:187], a[72:75], v[68:71], v[184:187]
    v_mfma_f32_16x16x32_bf16 v[188:191], a[76:79], v[68:71], v[188:191]
    s_add_u32 s38, s36, 45056
    buffer_store_dwordx4 v[60:63], v240, s[16:19], s38 offen offset:256 sc1
    v_mfma_f32_16x16x32_bf16 v[192:195], a[64:67], v[72:75], v[192:195]
    s_add_u32 m0, s31, 6144
    s_add_u32 s24, s27, 196608
    buffer_load_dwordx4 v237, s[12:15], s24 offen lds
    v_mfma_f32_16x16x32_bf16 v[196:199], a[68:71], v[72:75], v[196:199]
    v_mfma_f32_16x16x32_bf16 v[200:203], a[72:75], v[72:75], v[200:203]
    v_mfma_f32_16x16x32_bf16 v[204:207], a[76:79], v[72:75], v[204:207]
    v_mfma_f32_16x16x32_bf16 v[208:211], a[64:67], v[76:79], v[208:211]
    v_mfma_f32_16x16x32_bf16 v[212:215], a[68:71], v[76:79], v[212:215]
    v_mfma_f32_16x16x32_bf16 v[216:219], a[72:75], v[76:79], v[216:219]
    v_mfma_f32_16x16x32_bf16 v[220:223], a[76:79], v[76:79], v[220:223]
    s_waitcnt lgkmcnt(0)
    v_mfma_f32_16x16x32_bf16 v[160:163], a[80:83], v[80:83], v[160:163]
    ds_read_b128 v[64:67], v224 offset:24576
    v_mfma_f32_16x16x32_bf16 v[164:167], a[84:87], v[80:83], v[164:167]
    ds_read_b128 v[68:71], v224 offset:26624
    v_mfma_f32_16x16x32_bf16 v[168:171], a[88:91], v[80:83], v[168:171]
    ds_read_b128 v[72:75], v224 offset:28672
    v_mfma_f32_16x16x32_bf16 v[172:175], a[92:95], v[80:83], v[172:175]
    ds_read_b128 v[76:79], v224 offset:30720
    v_mfma_f32_16x16x32_bf16 v[176:179], a[80:83], v[84:87], v[176:179]
    v_mfma_f32_16x16x32_bf16 v[180:183], a[84:87], v[84:87], v[180:183]
    v_mfma_f32_16x16x32_bf16 v[184:187], a[88:91], v[84:87], v[184:187]
    v_mfma_f32_16x16x32_bf16 v[188:191], a[92:95], v[84:87], v[188:191]
    v_mfma_f32_16x16x32_bf16 v[192:195], a[80:83], v[88:91], v[192:195]
    s_add_u32 m0, s31, 7168
    s_add_u32 s24, s27, 229376
    buffer_load_dwordx4 v237, s[12:15], s24 offen lds
    v_mfma_f32_16x16x32_bf16 v[196:199], a[84:87], v[88:91], v[196:199]
    v_mfma_f32_16x16x32_bf16 v[200:203], a[88:91], v[88:91], v[200:203]
    s_add_u32 s27, s27, 1048576
    s_and_b32 s27, s27, 0x407fffff
    s_cmp_eq_u32 s27, s7
    s_cselect_b32 s27, s43, s27
    v_mfma_f32_16x16x32_bf16 v[204:207], a[92:95], v[88:91], v[204:207]
    v_mfma_f32_16x16x32_bf16 v[208:211], a[80:83], v[92:95], v[208:211]
    v_mfma_f32_16x16x32_bf16 v[212:215], a[84:87], v[92:95], v[212:215]
    s_add_u32 s31, s31, 32768
    s_cmp_ge_u32 s31, 163840
    s_cselect_b32 s24, 98304, 0
    s_sub_u32 s31, s31, s24
    s_add_u32 s38, s36, 65536
    buffer_store_dwordx4 v[0:3], v240, s[16:19], s38 offen offset:2560 sc1
    v_mfma_f32_16x16x32_bf16 v[216:219], a[88:91], v[92:95], v[216:219]
    v_mfma_f32_16x16x32_bf16 v[220:223], a[92:95], v[92:95], v[220:223]
    s_waitcnt lgkmcnt(0)
    v_mfma_f32_16x16x32_bf16 v[160:163], a[96:99], v[64:67], v[160:163]
    ds_read_b128 v[80:83], v225 offset:24576
    v_mfma_f32_16x16x32_bf16 v[164:167], a[100:103], v[64:67], v[164:167]
    ds_read_b128 v[84:87], v225 offset:26624
    v_mfma_f32_16x16x32_bf16 v[168:171], a[104:107], v[64:67], v[168:171]
    ds_read_b128 v[88:91], v225 offset:28672
    v_mfma_f32_16x16x32_bf16 v[172:175], a[108:111], v[64:67], v[172:175]
    ds_read_b128 v[92:95], v225 offset:30720
    v_mfma_f32_16x16x32_bf16 v[176:179], a[96:99], v[68:71], v[176:179]
    v_mfma_f32_16x16x32_bf16 v[180:183], a[100:103], v[68:71], v[180:183]
    v_mfma_f32_16x16x32_bf16 v[184:187], a[104:107], v[68:71], v[184:187]
    v_mfma_f32_16x16x32_bf16 v[188:191], a[108:111], v[68:71], v[188:191]
    v_mfma_f32_16x16x32_bf16 v[192:195], a[96:99], v[72:75], v[192:195]
    v_mfma_f32_16x16x32_bf16 v[196:199], a[100:103], v[72:75], v[196:199]
    v_mfma_f32_16x16x32_bf16 v[200:203], a[104:107], v[72:75], v[200:203]
    v_mfma_f32_16x16x32_bf16 v[204:207], a[108:111], v[72:75], v[204:207]
    v_mfma_f32_16x16x32_bf16 v[208:211], a[96:99], v[76:79], v[208:211]
    v_mfma_f32_16x16x32_bf16 v[212:215], a[100:103], v[76:79], v[212:215]
    v_mfma_f32_16x16x32_bf16 v[216:219], a[104:107], v[76:79], v[216:219]
    v_mfma_f32_16x16x32_bf16 v[220:223], a[108:111], v[76:79], v[220:223]
    s_waitcnt vmcnt(9) lgkmcnt(0)
    s_barrier
    v_mfma_f32_16x16x32_bf16 v[160:163], a[112:115], v[80:83], v[160:163]
    ds_read_b128 v[64:67], v224 offset:32768
    v_mfma_f32_16x16x32_bf16 v[164:167], a[116:119], v[80:83], v[164:167]
    ds_read_b128 v[68:71], v224 offset:34816
    v_mfma_f32_16x16x32_bf16 v[168:171], a[120:123], v[80:83], v[168:171]
    ds_read_b128 v[72:75], v224 offset:36864
    s_add_u32 s38, s36, 69632
    buffer_store_dwordx4 v[4:7], v240, s[16:19], s38 offen offset:512 sc1
    v_mfma_f32_16x16x32_bf16 v[172:175], a[124:127], v[80:83], v[172:175]
    ds_read_b128 v[76:79], v224 offset:38912
    v_mfma_f32_16x16x32_bf16 v[176:179], a[112:115], v[84:87], v[176:179]
    v_mfma_f32_16x16x32_bf16 v[180:183], a[116:119], v[84:87], v[180:183]
    v_mfma_f32_16x16x32_bf16 v[184:187], a[120:123], v[84:87], v[184:187]
    v_mfma_f32_16x16x32_bf16 v[188:191], a[124:127], v[84:87], v[188:191]
    v_mfma_f32_16x16x32_bf16 v[192:195], a[112:115], v[88:91], v[192:195]
    v_mfma_f32_16x16x32_bf16 v[196:199], a[116:119], v[88:91], v[196:199]
    v_mfma_f32_16x16x32_bf16 v[200:203], a[120:123], v[88:91], v[200:203]
    v_mfma_f32_16x16x32_bf16 v[204:207], a[124:127], v[88:91], v[204:207]
    v_mfma_f32_16x16x32_bf16 v[208:211], a[112:115], v[92:95], v[208:211]
    v_mfma_f32_16x16x32_bf16 v[212:215], a[116:119], v[92:95], v[212:215]
    v_mfma_f32_16x16x32_bf16 v[216:219], a[120:123], v[92:95], v[216:219]
    v_mfma_f32_16x16x32_bf16 v[220:223], a[124:127], v[92:95], v[220:223]
    s_waitcnt lgkmcnt(0)
    v_mfma_f32_16x16x32_bf16 v[160:163], a[128:131], v[64:67], v[160:163]
    ds_read_b128 v[80:83], v225 offset:32768
    v_mfma_f32_16x16x32_bf16 v[164:167], a[132:135], v[64:67], v[164:167]
    ds_read_b128 v[84:87], v225 offset:34816
    v_mfma_f32_16x16x32_bf16 v[168:171], a[136:139], v[64:67], v[168:171]
    ds_read_b128 v[88:91], v225 offset:36864
    v_mfma_f32_16x16x32_bf16 v[172:175], a[140:143], v[64:67], v[172:175]
    ds_read_b128 v[92:95], v225 offset:38912
    v_mfma_f32_16x16x32_bf16 v[176:179], a[128:131], v[68:71], v[176:179]
    v_mfma_f32_16x16x32_bf16 v[180:183], a[132:135], v[68:71], v[180:183]
    v_mfma_f32_16x16x32_bf16 v[184:187], a[136:139], v[68:71], v[184:187]
    v_mfma_f32_16x16x32_bf16 v[188:191], a[140:143], v[68:71], v[188:191]
    v_mfma_f32_16x16x32_bf16 v[192:195], a[128:131], v[72:75], v[192:195]
    buffer_load_dword v254, off, s[88:91], s39 sc1
    s_add_u32 s38, s36, 65536
    buffer_store_dwordx4 v[8:11], v240, s[16:19], s38 offen offset:3584 sc1
    v_mfma_f32_16x16x32_bf16 v[196:199], a[132:135], v[72:75], v[196:199]
    v_mfma_f32_16x16x32_bf16 v[200:203], a[136:139], v[72:75], v[200:203]
    v_mfma_f32_16x16x32_bf16 v[204:207], a[140:143], v[72:75], v[204:207]
    v_mfma_f32_16x16x32_bf16 v[208:211], a[128:131], v[76:79], v[208:211]
    v_mfma_f32_16x16x32_bf16 v[212:215], a[132:135], v[76:79], v[212:215]
    v_mfma_f32_16x16x32_bf16 v[216:219], a[136:139], v[76:79], v[216:219]
    v_mfma_f32_16x16x32_bf16 v[220:223], a[140:143], v[76:79], v[220:223]
    s_waitcnt lgkmcnt(0)
    v_mfma_f32_16x16x32_bf16 v[160:163], a[144:147], v[80:83], v[160:163]
    ds_read_b128 v[64:67], v224 offset:40960
    v_mfma_f32_16x16x32_bf16 v[164:167], a[148:151], v[80:83], v[164:167]
    ds_read_b128 v[68:71], v224 offset:43008
    v_mfma_f32_16x16x32_bf16 v[168:171], a[152:155], v[80:83], v[168:171]
    ds_read_b128 v[72:75], v224 offset:45056
    v_mfma_f32_16x16x32_bf16 v[172:175], a[156:159], v[80:83], v[172:175]
    ds_read_b128 v[76:79], v224 offset:47104
    v_mfma_f32_16x16x32_bf16 v[176:179], a[144:147], v[84:87], v[176:179]
    v_mfma_f32_16x16x32_bf16 v[180:183], a[148:151], v[84:87], v[180:183]
    v_mfma_f32_16x16x32_bf16 v[184:187], a[152:155], v[84:87], v[184:187]
    v_mfma_f32_16x16x32_bf16 v[188:191], a[156:159], v[84:87], v[188:191]
    v_mfma_f32_16x16x32_bf16 v[192:195], a[144:147], v[88:91], v[192:195]
    v_mfma_f32_16x16x32_bf16 v[196:199], a[148:151], v[88:91], v[196:199]
    v_mfma_f32_16x16x32_bf16 v[200:203], a[152:155], v[88:91], v[200:203]
    v_mfma_f32_16x16x32_bf16 v[204:207], a[156:159], v[88:91], v[204:207]
    v_mfma_f32_16x16x32_bf16 v[208:211], a[144:147], v[92:95], v[208:211]
    v_mfma_f32_16x16x32_bf16 v[212:215], a[148:151], v[92:95], v[212:215]
    s_add_u32 s38, s36, 69632
    buffer_store_dwordx4 v[12:15], v240, s[16:19], s38 offen offset:1536 sc1
    v_mfma_f32_16x16x32_bf16 v[216:219], a[152:155], v[92:95], v[216:219]
    v_mfma_f32_16x16x32_bf16 v[220:223], a[156:159], v[92:95], v[220:223]
    s_waitcnt lgkmcnt(0)
    v_mfma_f32_16x16x32_bf16 v[160:163], a[160:163], v[64:67], v[160:163]
    ds_read_b128 v[80:83], v225 offset:40960
    v_mfma_f32_16x16x32_bf16 v[164:167], a[164:167], v[64:67], v[164:167]
    ds_read_b128 v[84:87], v225 offset:43008
    v_mfma_f32_16x16x32_bf16 v[168:171], a[168:171], v[64:67], v[168:171]
    ds_read_b128 v[88:91], v225 offset:45056
    v_mfma_f32_16x16x32_bf16 v[172:175], a[172:175], v[64:67], v[172:175]
    ds_read_b128 v[92:95], v225 offset:47104
    v_mfma_f32_16x16x32_bf16 v[176:179], a[160:163], v[68:71], v[176:179]
    v_mfma_f32_16x16x32_bf16 v[180:183], a[164:167], v[68:71], v[180:183]
    v_mfma_f32_16x16x32_bf16 v[184:187], a[168:171], v[68:71], v[184:187]
    v_mfma_f32_16x16x32_bf16 v[188:191], a[172:175], v[68:71], v[188:191]
    v_mfma_f32_16x16x32_bf16 v[192:195], a[160:163], v[72:75], v[192:195]
    v_mfma_f32_16x16x32_bf16 v[196:199], a[164:167], v[72:75], v[196:199]
    v_mfma_f32_16x16x32_bf16 v[200:203], a[168:171], v[72:75], v[200:203]
    v_mfma_f32_16x16x32_bf16 v[204:207], a[172:175], v[72:75], v[204:207]
    v_mfma_f32_16x16x32_bf16 v[208:211], a[160:163], v[76:79], v[208:211]
    v_mfma_f32_16x16x32_bf16 v[212:215], a[164:167], v[76:79], v[212:215]
    v_mfma_f32_16x16x32_bf16 v[216:219], a[168:171], v[76:79], v[216:219]
    v_mfma_f32_16x16x32_bf16 v[220:223], a[172:175], v[76:79], v[220:223]
    s_waitcnt lgkmcnt(0)
    v_mfma_f32_16x16x32_bf16 v[160:163], a[176:179], v[80:83], v[160:163]
    ds_read_b128 v[64:67], v224 offset:49152
    v_mfma_f32_16x16x32_bf16 v[164:167], a[180:183], v[80:83], v[164:167]
    ds_read_b128 v[68:71], v224 offset:51200
    v_mfma_f32_16x16x32_bf16 v[168:171], a[184:187], v[80:83], v[168:171]
    ds_read_b128 v[72:75], v224 offset:53248
    v_mfma_f32_16x16x32_bf16 v[172:175], a[188:191], v[80:83], v[172:175]
    ds_read_b128 v[76:79], v224 offset:55296
    s_add_u32 s38, s36, 73728
    buffer_store_dwordx4 v[16:19], v240, s[16:19], s38 offen offset:2560 sc1
    v_mfma_f32_16x16x32_bf16 v[176:179], a[176:179], v[84:87], v[176:179]
    v_mfma_f32_16x16x32_bf16 v[180:183], a[180:183], v[84:87], v[180:183]
    v_mfma_f32_16x16x32_bf16 v[184:187], a[184:187], v[84:87], v[184:187]
    v_mfma_f32_16x16x32_bf16 v[188:191], a[188:191], v[84:87], v[188:191]
    v_mfma_f32_16x16x32_bf16 v[192:195], a[176:179], v[88:91], v[192:195]
    v_mfma_f32_16x16x32_bf16 v[196:199], a[180:183], v[88:91], v[196:199]
    v_mfma_f32_16x16x32_bf16 v[200:203], a[184:187], v[88:91], v[200:203]
    v_mfma_f32_16x16x32_bf16 v[204:207], a[188:191], v[88:91], v[204:207]
    v_mfma_f32_16x16x32_bf16 v[208:211], a[176:179], v[92:95], v[208:211]
    v_mfma_f32_16x16x32_bf16 v[212:215], a[180:183], v[92:95], v[212:215]
    v_mfma_f32_16x16x32_bf16 v[216:219], a[184:187], v[92:95], v[216:219]
    v_mfma_f32_16x16x32_bf16 v[220:223], a[188:191], v[92:95], v[220:223]
    s_waitcnt vmcnt(3)
    v_readfirstlane_b32 s24, v254
    s_lshl_b32 s25, s3, 16
    s_add_u32 s24, s24, s25
    s_cmp_ge_u32 s24, 32
    s_cbranch_scc0 kf_spin33
kf_spinr34:
    s_waitcnt lgkmcnt(0)
    s_barrier
    v_mfma_f32_16x16x32_bf16 v[160:163], a[192:195], v[64:67], v[160:163]
    ds_read_b128 v[80:83], v225 offset:49152
    v_mfma_f32_16x16x32_bf16 v[164:167], a[196:199], v[64:67], v[164:167]
    ds_read_b128 v[84:87], v225 offset:51200
    v_mfma_f32_16x16x32_bf16 v[168:171], a[200:203], v[64:67], v[168:171]
    ds_read_b128 v[88:91], v225 offset:53248
    v_mfma_f32_16x16x32_bf16 v[172:175], a[204:207], v[64:67], v[172:175]
    ds_read_b128 v[92:95], v225 offset:55296
    v_mfma_f32_16x16x32_bf16 v[176:179], a[192:195], v[68:71], v[176:179]
    v_mfma_f32_16x16x32_bf16 v[180:183], a[196:199], v[68:71], v[180:183]
    v_mfma_f32_16x16x32_bf16 v[184:187], a[200:203], v[68:71], v[184:187]
    v_mfma_f32_16x16x32_bf16 v[188:191], a[204:207], v[68:71], v[188:191]
    v_mfma_f32_16x16x32_bf16 v[192:195], a[192:195], v[72:75], v[192:195]
    buffer_load_dwordx4 a[128:131], v248, s[8:11], s28 offen offset:0 sc1
    s_add_u32 s38, s36, 77824
    buffer_store_dwordx4 v[20:23], v240, s[16:19], s38 offen offset:512 sc1
    v_mfma_f32_16x16x32_bf16 v[196:199], a[196:199], v[72:75], v[196:199]
    v_mfma_f32_16x16x32_bf16 v[200:203], a[200:203], v[72:75], v[200:203]
    buffer_load_dwordx4 a[132:135], v248, s[8:11], s29 offen offset:0 sc1
    v_mfma_f32_16x16x32_bf16 v[204:207], a[204:207], v[72:75], v[204:207]
    v_mfma_f32_16x16x32_bf16 v[208:211], a[192:195], v[76:79], v[208:211]
    v_mfma_f32_16x16x32_bf16 v[212:215], a[196:199], v[76:79], v[212:215]
    buffer_load_dwordx4 a[136:139], v249, s[8:11], s28 offen offset:0 sc1
    v_mfma_f32_16x16x32_bf16 v[216:219], a[200:203], v[76:79], v[216:219]
    v_mfma_f32_16x16x32_bf16 v[220:223], a[204:207], v[76:79], v[220:223]
    s_waitcnt lgkmcnt(0)
    v_mfma_f32_16x16x32_bf16 v[160:163], a[208:211], v[80:83], v[160:163]
    ds_read_b128 v[64:67], v224 offset:57344
    v_mfma_f32_16x16x32_bf16 v[164:167], a[212:215], v[80:83], v[164:167]
    ds_read_b128 v[68:71], v224 offset:59392
    v_mfma_f32_16x16x32_bf16 v[168:171], a[216:219], v[80:83], v[168:171]
    ds_read_b128 v[72:75], v224 offset:61440
    v_mfma_f32_16x16x32_bf16 v[172:175], a[220:223], v[80:83], v[172:175]
    ds_read_b128 v[76:79], v224 offset:63488
    v_mfma_f32_16x16x32_bf16 v[176:179], a[208:211], v[84:87], v[176:179]
    v_mfma_f32_16x16x32_bf16 v[180:183], a[212:215], v[84:87], v[180:183]
    v_mfma_f32_16x16x32_bf16 v[184:187], a[216:219], v[84:87], v[184:187]
    v_mfma_f32_16x16x32_bf16 v[188:191], a[220:223], v[84:87], v[188:191]
    v_mfma_f32_16x16x32_bf16 v[192:195], a[208:211], v[88:91], v[192:195]
    buffer_load_dwordx4 a[140:143], v249, s[8:11], s29 offen offset:0 sc1
    v_mfma_f32_16x16x32_bf16 v[196:199], a[212:215], v[88:91], v[196:199]
    v_mfma_f32_16x16x32_bf16 v[200:203], a[216:219], v[88:91], v[200:203]
    buffer_load_dwordx4 a[144:147], v248, s[8:11], s28 offen offset:1024 sc1
    v_mfma_f32_16x16x32_bf16 v[204:207], a[220:223], v[88:91], v[204:207]
    v_mfma_f32_16x16x32_bf16 v[208:211], a[208:211], v[92:95], v[208:211]
    v_mfma_f32_16x16x32_bf16 v[212:215], a[212:215], v[92:95], v[212:215]
    buffer_load_dwordx4 a[148:151], v248, s[8:11], s29 offen offset:1024 sc1
    v_mfma_f32_16x16x32_bf16 v[216:219], a[216:219], v[92:95], v[216:219]
    s_add_u32 s38, s36, 73728
    buffer_store_dwordx4 v[24:27], v240, s[16:19], s38 offen offset:3584 sc1
    v_mfma_f32_16x16x32_bf16 v[220:223], a[220:223], v[92:95], v[220:223]
    s_waitcnt lgkmcnt(0)
    v_mfma_f32_16x16x32_bf16 v[160:163], a[224:227], v[64:67], v[160:163]
    ds_read_b128 v[80:83], v225 offset:57344
    v_mfma_f32_16x16x32_bf16 v[164:167], a[228:231], v[64:67], v[164:167]
    ds_read_b128 v[84:87], v225 offset:59392
    v_mfma_f32_16x16x32_bf16 v[168:171], a[232:235], v[64:67], v[168:171]
    ds_read_b128 v[88:91], v225 offset:61440
    v_mfma_f32_16x16x32_bf16 v[172:175], a[236:239], v[64:67], v[172:175]
    ds_read_b128 v[92:95], v225 offset:63488
    v_mfma_f32_16x16x32_bf16 v[176:179], a[224:227], v[68:71], v[176:179]
    v_mfma_f32_16x16x32_bf16 v[180:183], a[228:231], v[68:71], v[180:183]
    v_mfma_f32_16x16x32_bf16 v[184:187], a[232:235], v[68:71], v[184:187]
    v_mfma_f32_16x16x32_bf16 v[188:191], a[236:239], v[68:71], v[188:191]
    v_mfma_f32_16x16x32_bf16 v[192:195], a[224:227], v[72:75], v[192:195]
    buffer_load_dwordx4 a[152:155], v249, s[8:11], s28 offen offset:1024 sc1
    v_mfma_f32_16x16x32_bf16 v[196:199], a[228:231], v[72:75], v[196:199]
    v_mfma_f32_16x16x32_bf16 v[200:203], a[232:235], v[72:75], v[200:203]
    buffer_load_dwordx4 a[156:159], v249, s[8:11], s29 offen offset:1024 sc1
    v_mfma_f32_16x16x32_bf16 v[204:207], a[236:239], v[72:75], v[204:207]
    v_mfma_f32_16x16x32_bf16 v[208:211], a[224:227], v[76:79], v[208:211]
    v_mfma_f32_16x16x32_bf16 v[212:215], a[228:231], v[76:79], v[212:215]
    buffer_load_dwordx4 a[160:163], v248, s[8:11], s28 offen offset:2048 sc1
    v_mfma_f32_16x16x32_bf16 v[216:219], a[232:235], v[76:79], v[216:219]
    v_mfma_f32_16x16x32_bf16 v[220:223], a[236:239], v[76:79], v[220:223]
    s_waitcnt vmcnt(38) lgkmcnt(0)
    s_barrier
    v_mfma_f32_16x16x32_bf16 v[160:163], a[240:243], v[80:83], v[160:163]
    ds_read_b64_tr_b16 a[192:193], v246 offset:0
    v_mfma_f32_16x16x32_bf16 v[164:167], a[244:247], v[80:83], v[164:167]
    ds_read_b64_tr_b16 a[194:195], v246 offset:1024
    v_mfma_f32_16x16x32_bf16 v[168:171], a[248:251], v[80:83], v[168:171]
    ds_read_b64_tr_b16 a[196:197], v238 offset:0
    v_mfma_f32_16x16x32_bf16 v[172:175], a[252:255], v[80:83], v[172:175]
    ds_read_b64_tr_b16 a[198:199], v238 offset:1024
    v_mfma_f32_16x16x32_bf16 v[176:179], a[240:243], v[84:87], v[176:179]
    ds_read_b64_tr_b16 a[200:201], v246 offset:256
    s_add_u32 s38, s36, 77824
    buffer_store_dwordx4 v[28:31], v240, s[16:19], s38 offen offset:1536 sc1
    v_mfma_f32_16x16x32_bf16 v[180:183], a[244:247], v[84:87], v[180:183]
    ds_read_b64_tr_b16 a[202:203], v246 offset:1280
    v_mfma_f32_16x16x32_bf16 v[184:187], a[248:251], v[84:87], v[184:187]
    ds_read_b64_tr_b16 a[204:205], v238 offset:256
    v_mfma_f32_16x16x32_bf16 v[188:191], a[252:255], v[84:87], v[188:191]
    ds_read_b64_tr_b16 a[206:207], v238 offset:1280
    v_mfma_f32_16x16x32_bf16 v[192:195], a[240:243], v[88:91], v[192:195]
    buffer_load_dwordx4 a[164:167], v248, s[8:11], s29 offen offset:2048 sc1
    v_mfma_f32_16x16x32_bf16 v[196:199], a[244:247], v[88:91], v[196:199]
    v_cvt_pk_bf16_f32 v32, v160, v161
    v_cvt_pk_bf16_f32 v33, v162, v163
    v_mfma_f32_16x16x32_bf16 v[200:203], a[248:251], v[88:91], v[200:203]
    buffer_load_dwordx4 a[168:171], v249, s[8:11], s28 offen offset:2048 sc1
    v_cvt_pk_bf16_f32 v34, v164, v165
    v_cvt_pk_bf16_f32 v35, v166, v167
    v_mfma_f32_16x16x32_bf16 v[204:207], a[252:255], v[88:91], v[204:207]
    v_cvt_pk_bf16_f32 v36, v168, v169
    v_cvt_pk_bf16_f32 v37, v170, v171
    v_mfma_f32_16x16x32_bf16 v[208:211], a[240:243], v[92:95], v[208:211]
    v_cvt_pk_bf16_f32 v38, v172, v173
    v_cvt_pk_bf16_f32 v39, v174, v175
    v_mfma_f32_16x16x32_bf16 v[212:215], a[244:247], v[92:95], v[212:215]
    buffer_load_dwordx4 a[172:175], v249, s[8:11], s29 offen offset:2048 sc1
    v_cvt_pk_bf16_f32 v40, v176, v177
    v_cvt_pk_bf16_f32 v41, v178, v179
    v_mfma_f32_16x16x32_bf16 v[216:219], a[248:251], v[92:95], v[216:219]
    v_cvt_pk_bf16_f32 v42, v180, v181
    v_cvt_pk_bf16_f32 v43, v182, v183
    v_mfma_f32_16x16x32_bf16 v[220:223], a[252:255], v[92:95], v[220:223]
    v_cvt_pk_bf16_f32 v44, v184, v185
    v_cvt_pk_bf16_f32 v45, v186, v187
    s_nop 3
    v_cvt_pk_bf16_f32 v46, v188, v189
    v_cvt_pk_bf16_f32 v47, v190, v191
    v_cvt_pk_bf16_f32 v48, v192, v193
    v_cvt_pk_bf16_f32 v49, v194, v195
    v_cvt_pk_bf16_f32 v50, v196, v197
    v_cvt_pk_bf16_f32 v51, v198, v199
    v_cvt_pk_bf16_f32 v52, v200, v201
    v_cvt_pk_bf16_f32 v53, v202, v203
    v_cvt_pk_bf16_f32 v54, v204, v205
    v_cvt_pk_bf16_f32 v55, v206, v207
    v_cvt_pk_bf16_f32 v56, v208, v209
    v_cvt_pk_bf16_f32 v57, v210, v211
    v_cvt_pk_bf16_f32 v58, v212, v213
    v_cvt_pk_bf16_f32 v59, v214, v215
    v_cvt_pk_bf16_f32 v60, v216, v217
    v_cvt_pk_bf16_f32 v61, v218, v219
    v_cvt_pk_bf16_f32 v62, v220, v221
    v_cvt_pk_bf16_f32 v63, v222, v223
    s_add_u32 s80, s36, 102144
    s_add_u32 s81, s36, 104192
    s_add_u32 s82, s36, 103168
    s_add_u32 s83, s36, 105216
    s_add_u32 s84, s36, 110336
    s_add_u32 s85, s36, 112384
    s_add_u32 s86, s36, 111360
    s_add_u32 s87, s36, 113408
    s_branch ka_Q
ka_V:
    s_waitcnt lgkmcnt(0)
    v_mfma_f32_16x16x32_bf16 v[96:99], v[64:67], a[0:3], 0
    ds_read_b128 v[80:83], v224 offset:8192
    v_mfma_f32_16x16x32_bf16 v[100:103], v[68:71], a[0:3], 0
    ds_read_b128 v[84:87], v224 offset:10240
    v_mfma_f32_16x16x32_bf16 v[104:107], v[64:67], a[4:7], 0
    ds_read_b128 v[88:91], v224 offset:12288
    v_mfma_f32_16x16x32_bf16 v[108:111], v[68:71], a[4:7], 0
    ds_read_b128 v[92:95], v224 offset:14336
    v_mfma_f32_16x16x32_bf16 v[112:115], v[64:67], a[8:11], 0
    ds_read_b64_tr_b16 a[16:17], v228 offset:4096
    v_mfma_f32_16x16x32_bf16 v[116:119], v[68:71], a[8:11], 0
    ds_read_b64_tr_b16 a[18:19], v228 offset:4608
    v_mfma_f32_16x16x32_bf16 v[120:123], v[64:67], a[12:15], 0
    ds_read_b64_tr_b16 a[20:21], v229 offset:4096
    v_mfma_f32_16x16x32_bf16 v[124:127], v[68:71], a[12:15], 0
    ds_read_b64_tr_b16 a[22:23], v229 offset:4608
    v_mfma_f32_16x16x32_bf16 v[128:131], v[72:75], a[0:3], 0
    s_add_u32 m0, s35, 16384
    s_and_b32 s33, s82, 1023
    s_lshl_b32 s33, s33, 12
    buffer_load_dwordx4 v234, s[48:51], s33 offen lds
    v_mfma_f32_16x16x32_bf16 v[132:135], v[76:79], a[0:3], 0
    v_mfma_f32_16x16x32_bf16 v[136:139], v[72:75], a[4:7], 0
    buffer_load_dwordx4 v235, s[48:51], s33 offen offset:1024 lds
    v_mfma_f32_16x16x32_bf16 v[140:143], v[76:79], a[4:7], 0
    v_mfma_f32_16x16x32_bf16 v[144:147], v[72:75], a[8:11], 0
    s_add_u32 m0, s35, 18432
    s_add_u32 s33, s33, 131072
    buffer_load_dwordx4 v234, s[48:51], s33 offen lds
    v_mfma_f32_16x16x32_bf16 v[148:151], v[76:79], a[8:11], 0
    v_mfma_f32_16x16x32_bf16 v[152:155], v[72:75], a[12:15], 0
    buffer_load_dwordx4 v235, s[48:51], s33 offen offset:1024 lds
    v_mfma_f32_16x16x32_bf16 v[156:159], v[76:79], a[12:15], 0
    s_waitcnt lgkmcnt(0)
    v_mfma_f32_16x16x32_bf16 v[160:163], v[80:83], a[0:3], 0
    ds_read_b128 v[64:67], v225 offset:0
    v_mfma_f32_16x16x32_bf16 v[164:167], v[84:87], a[0:3], 0
    ds_read_b128 v[68:71], v225 offset:2048
    v_mfma_f32_16x16x32_bf16 v[168:171], v[80:83], a[4:7], 0
    ds_read_b128 v[72:75], v225 offset:4096
    v_mfma_f32_16x16x32_bf16 v[172:175], v[84:87], a[4:7], 0
    ds_read_b128 v[76:79], v225 offset:6144
    v_mfma_f32_16x16x32_bf16 v[176:179], v[80:83], a[8:11], 0
    ds_read_b64_tr_b16 a[24:25], v230 offset:4096
    v_mfma_f32_16x16x32_bf16 v[180:183], v[84:87], a[8:11], 0
    ds_read_b64_tr_b16 a[26:27], v230 offset:4608
    v_mfma_f32_16x16x32_bf16 v[184:187], v[80:83], a[12:15], 0
    ds_read_b64_tr_b16 a[28:29], v231 offset:4096
    v_mfma_f32_16x16x32_bf16 v[188:191], v[84:87], a[12:15], 0
    ds_read_b64_tr_b16 a[30:31], v231 offset:4608
    v_mfma_f32_16x16x32_bf16 v[192:195], v[88:91], a[0:3], 0
    s_add_u32 m0, s35, 20480
    s_add_u32 s33, s33, 131072
    buffer_load_dwordx4 v234, s[48:51], s33 offen lds
    v_mfma_f32_16x16x32_bf16 v[196:199], v[92:95], a[0:3], 0
    v_mfma_f32_16x16x32_bf16 v[200:203], v[88:91], a[4:7], 0
    buffer_load_dwordx4 v235, s[48:51], s33 offen offset:1024 lds
    v_mfma_f32_16x16x32_bf16 v[204:207], v[92:95], a[4:7], 0
    v_mfma_f32_16x16x32_bf16 v[208:211], v[88:91], a[8:11], 0
    s_add_u32 m0, s35, 22528
    s_add_u32 s33, s33, 131072
    buffer_load_dwordx4 v234, s[48:51], s33 offen lds
    v_mfma_f32_16x16x32_bf16 v[212:215], v[92:95], a[8:11], 0
    v_mfma_f32_16x16x32_bf16 v[216:219], v[88:91], a[12:15], 0
    buffer_load_dwordx4 v235, s[48:51], s33 offen offset:1024 lds
    v_mfma_f32_16x16x32_bf16 v[220:223], v[92:95], a[12:15], 0
    s_waitcnt vmcnt(13) lgkmcnt(0)
    v_mfma_f32_16x16x32_bf16 v[96:99], v[64:67], a[16:19], v[96:99]
    ds_read_b128 v[80:83], v225 offset:8192
    v_mfma_f32_16x16x32_bf16 v[100:103], v[68:71], a[16:19], v[100:103]
    ds_read_b128 v[84:87], v225 offset:10240
    v_mfma_f32_16x16x32_bf16 v[104:107], v[64:67], a[20:23], v[104:107]
    ds_read_b128 v[88:91], v225 offset:12288
    v_mfma_f32_16x16x32_bf16 v[108:111], v[68:71], a[20:23], v[108:111]
    ds_read_b128 v[92:95], v225 offset:14336
    v_mfma_f32_16x16x32_bf16 v[112:115], v[64:67], a[24:27], v[112:115]
    ds_read_b64_tr_b16 a[32:33], v228 offset:8192
    v_mfma_f32_16x16x32_bf16 v[116:119], v[68:71], a[24:27], v[116:119]
    ds_read_b64_tr_b16 a[34:35], v228 offset:8704
    v_mfma_f32_16x16x32_bf16 v[120:123], v[64:67], a[28:31], v[120:123]
    ds_read_b64_tr_b16 a[36:37], v229 offset:8192
    v_mfma_f32_16x16x32_bf16 v[124:127], v[68:71], a[28:31], v[124:127]
    ds_read_b64_tr_b16 a[38:39], v229 offset:8704
    v_mfma_f32_16x16x32_bf16 v[128:131], v[72:75], a[16:19], v[128:131]
    s_add_u32 m0, s34, 32768
    s_add_u32 s37, s82, 0
    buffer_load_dwordx4 v232, s[44:47], s37 offen lds
    v_mfma_f32_16x16x32_bf16 v[132:135], v[76:79], a[16:19], v[132:135]
    buffer_load_dwordx4 v233, s[44:47], s37 offen offset:1024 lds
    v_mfma_f32_16x16x32_bf16 v[136:139], v[72:75], a[20:23], v[136:139]
    s_add_u32 m0, s34, 40960
    s_add_u32 s37, s82, 65536
    buffer_load_dwordx4 v232, s[44:47], s37 offen lds
    v_mfma_f32_16x16x32_bf16 v[140:143], v[76:79], a[20:23], v[140:143]
    buffer_load_dwordx4 v233, s[44:47], s37 offen offset:1024 lds
    v_mfma_f32_16x16x32_bf16 v[144:147], v[72:75], a[24:27], v[144:147]
    s_add_u32 m0, s35, 0
    s_and_b32 s33, s83, 1023
    s_lshl_b32 s33, s33, 12
    buffer_load_dwordx4 v234, s[48:51], s33 offen lds
    v_mfma_f32_16x16x32_bf16 v[148:151], v[76:79], a[24:27], v[148:151]
    buffer_load_dwordx4 v235, s[48:51], s33 offen offset:1024 lds
    v_mfma_f32_16x16x32_bf16 v[152:155], v[72:75], a[28:31], v[152:155]
    s_add_u32 m0, s35, 2048
    s_add_u32 s33, s33, 131072
    buffer_load_dwordx4 v234, s[48:51], s33 offen lds
    v_mfma_f32_16x16x32_bf16 v[156:159], v[76:79], a[28:31], v[156:159]
    buffer_load_dwordx4 v235, s[48:51], s33 offen offset:1024 lds
    s_waitcnt vmcnt(17) lgkmcnt(0)
    s_barrier
    v_mfma_f32_16x16x32_bf16 v[160:163], v[80:83], a[16:19], v[160:163]
    ds_read_b128 v[64:67], v224 offset:16384
    v_mfma_f32_16x16x32_bf16 v[164:167], v[84:87], a[16:19], v[164:167]
    ds_read_b128 v[68:71], v224 offset:18432
    v_mfma_f32_16x16x32_bf16 v[168:171], v[80:83], a[20:23], v[168:171]
    ds_read_b128 v[72:75], v224 offset:20480
    v_mfma_f32_16x16x32_bf16 v[172:175], v[84:87], a[20:23], v[172:175]
    ds_read_b128 v[76:79], v224 offset:22528
    v_mfma_f32_16x16x32_bf16 v[176:179], v[80:83], a[24:27], v[176:179]
    ds_read_b64_tr_b16 a[40:41], v230 offset:8192
    s_add_u32 m0, s34, 49152
    s_add_u32 s37, s83, 0
    buffer_load_dwordx4 v232, s[44:47], s37 offen lds
    v_mfma_f32_16x16x32_bf16 v[180:183], v[84:87], a[24:27], v[180:183]
    ds_read_b64_tr_b16 a[42:43], v230 offset:8704
    buffer_load_dwordx4 v233, s[44:47], s37 offen offset:1024 lds
    v_mfma_f32_16x16x32_bf16 v[184:187], v[80:83], a[28:31], v[184:187]
    ds_read_b64_tr_b16 a[44:45], v231 offset:8192
    s_add_u32 m0, s34, 57344
    s_add_u32 s37, s83, 65536
    buffer_load_dwordx4 v232, s[44:47], s37 offen lds
    v_mfma_f32_16x16x32_bf16 v[188:191], v[84:87], a[28:31], v[188:191]
    ds_read_b64_tr_b16 a[46:47], v231 offset:8704
    buffer_load_dwordx4 v233, s[44:47], s37 offen offset:1024 lds
    v_mfma_f32_16x16x32_bf16 v[192:195], v[88:91], a[16:19], v[192:195]
    s_add_u32 m0, s34, 0
    s_add_u32 s37, s84, 0
    buffer_load_dwordx4 v232, s[44:47], s37 offen lds
    v_mfma_f32_16x16x32_bf16 v[196:199], v[92:95], a[16:19], v[196:199]
    v_mfma_f32_16x16x32_bf16 v[200:203], v[88:91], a[20:23], v[200:203]
    buffer_load_dwordx4 v233, s[44:47], s37 offen offset:1024 lds
    v_mfma_f32_16x16x32_bf16 v[204:207], v[92:95], a[20:23], v[204:207]
    buffer_load_dwordx4 v[0:3], v236, s[52:55], 0 offen offset:0
    v_mfma_f32_16x16x32_bf16 v[208:211], v[88:91], a[24:27], v[208:211]
    buffer_load_dwordx4 v[4:7], v236, s[52:55], 0 offen offset:512
    v_mfma_f32_16x16x32_bf16 v[212:215], v[92:95], a[24:27], v[212:215]
    buffer_load_dwordx4 v[8:11], v236, s[52:55], 0 offen offset:1024
    v_mfma_f32_16x16x32_bf16 v[216:219], v[88:91], a[28:31], v[216:219]
    buffer_load_dwordx4 v[12:15], v236, s[52:55], 0 offen offset:1536
    v_mfma_f32_16x16x32_bf16 v[220:223], v[92:95], a[28:31], v[220:223]
    s_waitcnt lgkmcnt(0)
    v_mfma_f32_16x16x32_bf16 v[96:99], v[64:67], a[32:35], v[96:99]
    ds_read_b128 v[80:83], v224 offset:24576
    v_mfma_f32_16x16x32_bf16 v[100:103], v[68:71], a[32:35], v[100:103]
    ds_read_b128 v[84:87], v224 offset:26624
    v_mfma_f32_16x16x32_bf16 v[104:107], v[64:67], a[36:39], v[104:107]
    ds_read_b128 v[88:91], v224 offset:28672
    v_mfma_f32_16x16x32_bf16 v[108:111], v[68:71], a[36:39], v[108:111]
    ds_read_b128 v[92:95], v224 offset:30720
    v_mfma_f32_16x16x32_bf16 v[112:115], v[64:67], a[40:43], v[112:115]
    ds_read_b64_tr_b16 a[48:49], v228 offset:12288
    v_mfma_f32_16x16x32_bf16 v[116:119], v[68:71], a[40:43], v[116:119]
    ds_read_b64_tr_b16 a[50:51], v228 offset:12800
    v_mfma_f32_16x16x32_bf16 v[120:123], v[64:67], a[44:47], v[120:123]
    ds_read_b64_tr_b16 a[52:53], v229 offset:12288
    v_mfma_f32_16x16x32_bf16 v[124:127], v[68:71], a[44:47], v[124:127]
    ds_read_b64_tr_b16 a[54:55], v229 offset:12800
    v_mfma_f32_16x16x32_bf16 v[128:131], v[72:75], a[32:35], v[128:131]
    s_add_u32 m0, s35, 4096
    s_add_u32 s33, s33, 131072
    buffer_load_dwordx4 v234, s[48:51], s33 offen lds
    v_mfma_f32_16x16x32_bf16 v[132:135], v[76:79], a[32:35], v[132:135]
    v_mfma_f32_16x16x32_bf16 v[136:139], v[72:75], a[36:39], v[136:139]
    buffer_load_dwordx4 v235, s[48:51], s33 offen offset:1024 lds
    v_mfma_f32_16x16x32_bf16 v[140:143], v[76:79], a[36:39], v[140:143]
    v_mfma_f32_16x16x32_bf16 v[144:147], v[72:75], a[40:43], v[144:147]
    s_add_u32 m0, s35, 6144
    s_add_u32 s33, s33, 131072
    buffer_load_dwordx4 v234, s[48:51], s33 offen lds
    v_mfma_f32_16x16x32_bf16 v[148:151], v[76:79], a[40:43], v[148:151]
    v_mfma_f32_16x16x32_bf16 v[152:155], v[72:75], a[44:47], v[152:155]
    buffer_load_dwordx4 v235, s[48:51], s33 offen offset:1024 lds
    v_mfma_f32_16x16x32_bf16 v[156:159], v[76:79], a[44:47], v[156:159]
    s_waitcnt lgkmcnt(0)
    v_mfma_f32_16x16x32_bf16 v[160:163], v[80:83], a[32:35], v[160:163]
    ds_read_b128 v[64:67], v225 offset:16384
    v_mfma_f32_16x16x32_bf16 v[164:167], v[84:87], a[32:35], v[164:167]
    ds_read_b128 v[68:71], v225 offset:18432
    v_mfma_f32_16x16x32_bf16 v[168:171], v[80:83], a[36:39], v[168:171]
    ds_read_b128 v[72:75], v225 offset:20480
    v_mfma_f32_16x16x32_bf16 v[172:175], v[84:87], a[36:39], v[172:175]
    ds_read_b128 v[76:79], v225 offset:22528
    v_mfma_f32_16x16x32_bf16 v[176:179], v[80:83], a[40:43], v[176:179]
    ds_read_b64_tr_b16 a[56:57], v230 offset:12288
    v_mfma_f32_16x16x32_bf16 v[180:183], v[84:87], a[40:43], v[180:183]
    ds_read_b64_tr_b16 a[58:59], v230 offset:12800
    v_mfma_f32_16x16x32_bf16 v[184:187], v[80:83], a[44:47], v[184:187]
    ds_read_b64_tr_b16 a[60:61], v231 offset:12288
    v_mfma_f32_16x16x32_bf16 v[188:191], v[84:87], a[44:47], v[188:191]
    ds_read_b64_tr_b16 a[62:63], v231 offset:12800
    v_mfma_f32_16x16x32_bf16 v[192:195], v[88:91], a[32:35], v[192:195]
    s_add_u32 m0, s34, 8192
    s_add_u32 s37, s84, 65536
    buffer_load_dwordx4 v232, s[44:47], s37 offen lds
    v_mfma_f32_16x16x32_bf16 v[196:199], v[92:95], a[32:35], v[196:199]
    v_mfma_f32_16x16x32_bf16 v[200:203], v[88:91], a[36:39], v[200:203]
    v_mfma_f32_16x16x32_bf16 v[204:207], v[92:95], a[36:39], v[204:207]
    v_mfma_f32_16x16x32_bf16 v[208:211], v[88:91], a[40:43], v[208:211]
    buffer_load_dwordx4 v233, s[44:47], s37 offen offset:1024 lds
    v_mfma_f32_16x16x32_bf16 v[212:215], v[92:95], a[40:43], v[212:215]
    v_mfma_f32_16x16x32_bf16 v[216:219], v[88:91], a[44:47], v[216:219]
    v_mfma_f32_16x16x32_bf16 v[220:223], v[92:95], a[44:47], v[220:223]
    s_waitcnt vmcnt(24) lgkmcnt(0)
    v_mfma_f32_16x16x32_bf16 v[96:99], v[64:67], a[48:51], v[96:99]
    ds_read_b128 v[80:83], v225 offset:24576
    v_mfma_f32_16x16x32_bf16 v[100:103], v[68:71], a[48:51], v[100:103]
    ds_read_b128 v[84:87], v225 offset:26624
    v_mfma_f32_16x16x32_bf16 v[104:107], v[64:67], a[52:55], v[104:107]
    ds_read_b128 v[88:91], v225 offset:28672
    v_mfma_f32_16x16x32_bf16 v[108:111], v[68:71], a[52:55], v[108:111]
    ds_read_b128 v[92:95], v225 offset:30720
    v_mfma_f32_16x16x32_bf16 v[112:115], v[64:67], a[56:59], v[112:115]
    ds_read_b64_tr_b16 a[64:65], v228 offset:16384
    v_mfma_f32_16x16x32_bf16 v[116:119], v[68:71], a[56:59], v[116:119]
    ds_read_b64_tr_b16 a[66:67], v228 offset:16896
    v_mfma_f32_16x16x32_bf16 v[120:123], v[64:67], a[60:63], v[120:123]
    ds_read_b64_tr_b16 a[68:69], v229 offset:16384
    v_mfma_f32_16x16x32_bf16 v[124:127], v[68:71], a[60:63], v[124:127]
    ds_read_b64_tr_b16 a[70:71], v229 offset:16896
    v_mfma_f32_16x16x32_bf16 v[128:131], v[72:75], a[48:51], v[128:131]
    s_add_u32 m0, s35, 8192
    s_and_b32 s33, s84, 1023
    s_lshl_b32 s33, s33, 12
    buffer_load_dwordx4 v234, s[48:51], s33 offen lds
    v_mfma_f32_16x16x32_bf16 v[132:135], v[76:79], a[48:51], v[132:135]
    v_mfma_f32_16x16x32_bf16 v[136:139], v[72:75], a[52:55], v[136:139]
    buffer_load_dwordx4 v235, s[48:51], s33 offen offset:1024 lds
    v_mfma_f32_16x16x32_bf16 v[140:143], v[76:79], a[52:55], v[140:143]
    v_mfma_f32_16x16x32_bf16 v[144:147], v[72:75], a[56:59], v[144:147]
    s_add_u32 m0, s35, 10240
    s_add_u32 s33, s33, 131072
    buffer_load_dwordx4 v234, s[48:51], s33 offen lds
    v_mfma_f32_16x16x32_bf16 v[148:151], v[76:79], a[56:59], v[148:151]
    v_mfma_f32_16x16x32_bf16 v[152:155], v[72:75], a[60:63], v[152:155]
    buffer_load_dwordx4 v235, s[48:51], s33 offen offset:1024 lds
    v_mfma_f32_16x16x32_bf16 v[156:159], v[76:79], a[60:63], v[156:159]
    s_waitcnt vmcnt(24) lgkmcnt(0)
    s_barrier
    v_mfma_f32_16x16x32_bf16 v[160:163], v[80:83], a[48:51], v[160:163]
    ds_read_b128 v[64:67], v224 offset:32768
    v_mfma_f32_16x16x32_bf16 v[164:167], v[84:87], a[48:51], v[164:167]
    ds_read_b128 v[68:71], v224 offset:34816
    v_mfma_f32_16x16x32_bf16 v[168:171], v[80:83], a[52:55], v[168:171]
    ds_read_b128 v[72:75], v224 offset:36864
    v_mfma_f32_16x16x32_bf16 v[172:175], v[84:87], a[52:55], v[172:175]
    ds_read_b128 v[76:79], v224 offset:38912
    v_mfma_f32_16x16x32_bf16 v[176:179], v[80:83], a[56:59], v[176:179]
    ds_read_b64_tr_b16 a[72:73], v230 offset:16384
    v_mfma_f32_16x16x32_bf16 v[180:183], v[84:87], a[56:59], v[180:183]
    ds_read_b64_tr_b16 a[74:75], v230 offset:16896
    v_mfma_f32_16x16x32_bf16 v[184:187], v[80:83], a[60:63], v[184:187]
    ds_read_b64_tr_b16 a[76:77], v231 offset:16384
    v_mfma_f32_16x16x32_bf16 v[188:191], v[84:87], a[60:63], v[188:191]
    ds_read_b64_tr_b16 a[78:79], v231 offset:16896
    v_mfma_f32_16x16x32_bf16 v[192:195], v[88:91], a[48:51], v[192:195]
    s_add_u32 m0, s34, 16384
    s_add_u32 s37, s85, 0
    buffer_load_dwordx4 v232, s[44:47], s37 offen lds
    v_mfma_f32_16x16x32_bf16 v[196:199], v[92:95], a[48:51], v[196:199]
    v_mfma_f32_16x16x32_bf16 v[200:203], v[88:91], a[52:55], v[200:203]
    v_mfma_f32_16x16x32_bf16 v[204:207], v[92:95], a[52:55], v[204:207]
    v_mfma_f32_16x16x32_bf16 v[208:211], v[88:91], a[56:59], v[208:211]
    buffer_load_dwordx4 v233, s[44:47], s37 offen offset:1024 lds
    v_mfma_f32_16x16x32_bf16 v[212:215], v[92:95], a[56:59], v[212:215]
    v_mfma_f32_16x16x32_bf16 v[216:219], v[88:91], a[60:63], v[216:219]
    v_mfma_f32_16x16x32_bf16 v[220:223], v[92:95], a[60:63], v[220:223]
    s_waitcnt lgkmcnt(0)
    v_mfma_f32_16x16x32_bf16 v[96:99], v[64:67], a[64:67], v[96:99]
    ds_read_b128 v[80:83], v224 offset:40960
    v_mfma_f32_16x16x32_bf16 v[100:103], v[68:71], a[64:67], v[100:103]
    ds_read_b128 v[84:87], v224 offset:43008
    v_mfma_f32_16x16x32_bf16 v[104:107], v[64:67], a[68:71], v[104:107]
    ds_read_b128 v[88:91], v224 offset:45056
    v_mfma_f32_16x16x32_bf16 v[108:111], v[68:71], a[68:71], v[108:111]
    ds_read_b128 v[92:95], v224 offset:47104
    v_mfma_f32_16x16x32_bf16 v[112:115], v[64:67], a[72:75], v[112:115]
    ds_read_b64_tr_b16 a[80:81], v228 offset:20480
    v_mfma_f32_16x16x32_bf16 v[116:119], v[68:71], a[72:75], v[116:119]
    ds_read_b64_tr_b16 a[82:83], v228 offset:20992
    v_mfma_f32_16x16x32_bf16 v[120:123], v[64:67], a[76:79], v[120:123]
    ds_read_b64_tr_b16 a[84:85], v229 offset:20480
    v_mfma_f32_16x16x32_bf16 v[124:127], v[68:71], a[76:79], v[124:127]
    ds_read_b64_tr_b16 a[86:87], v229 offset:20992
    v_mfma_f32_16x16x32_bf16 v[128:131], v[72:75], a[64:67], v[128:131]
    s_add_u32 m0, s35, 12288
    s_add_u32 s33, s33, 131072
    buffer_load_dwordx4 v234, s[48:51], s33 offen lds
    v_mfma_f32_16x16x32_bf16 v[132:135], v[76:79], a[64:67], v[132:135]
    v_mfma_f32_16x16x32_bf16 v[136:139], v[72:75], a[68:71], v[136:139]
    buffer_load_dwordx4 v235, s[48:51], s33 offen offset:1024 lds
    v_mfma_f32_16x16x32_bf16 v[140:143], v[76:79], a[68:71], v[140:143]
    v_mfma_f32_16x16x32_bf16 v[144:147], v[72:75], a[72:75], v[144:147]
    s_add_u32 m0, s35, 14336
    s_add_u32 s33, s33, 131072
    buffer_load_dwordx4 v234, s[48:51], s33 offen lds
    v_mfma_f32_16x16x32_bf16 v[148:151], v[76:79], a[72:75], v[148:151]
    v_mfma_f32_16x16x32_bf16 v[152:155], v[72:75], a[76:79], v[152:155]
    buffer_load_dwordx4 v235, s[48:51], s33 offen offset:1024 lds
    v_mfma_f32_16x16x32_bf16 v[156:159], v[76:79], a[76:79], v[156:159]
    s_waitcnt lgkmcnt(0)
    v_mfma_f32_16x16x32_bf16 v[160:163], v[80:83], a[64:67], v[160:163]
    ds_read_b128 v[64:67], v225 offset:32768
    v_mfma_f32_16x16x32_bf16 v[164:167], v[84:87], a[64:67], v[164:167]
    ds_read_b128 v[68:71], v225 offset:34816
    v_mfma_f32_16x16x32_bf16 v[168:171], v[80:83], a[68:71], v[168:171]
    ds_read_b128 v[72:75], v225 offset:36864
    v_mfma_f32_16x16x32_bf16 v[172:175], v[84:87], a[68:71], v[172:175]
    ds_read_b128 v[76:79], v225 offset:38912
    v_mfma_f32_16x16x32_bf16 v[176:179], v[80:83], a[72:75], v[176:179]
    ds_read_b64_tr_b16 a[88:89], v230 offset:20480
    v_mfma_f32_16x16x32_bf16 v[180:183], v[84:87], a[72:75], v[180:183]
    ds_read_b64_tr_b16 a[90:91], v230 offset:20992
    v_mfma_f32_16x16x32_bf16 v[184:187], v[80:83], a[76:79], v[184:187]
    ds_read_b64_tr_b16 a[92:93], v231 offset:20480
    v_mfma_f32_16x16x32_bf16 v[188:191], v[84:87], a[76:79], v[188:191]
    ds_read_b64_tr_b16 a[94:95], v231 offset:20992
    v_mfma_f32_16x16x32_bf16 v[192:195], v[88:91], a[64:67], v[192:195]
    s_add_u32 m0, s34, 24576
    s_add_u32 s37, s85, 65536
    buffer_load_dwordx4 v232, s[44:47], s37 offen lds
    v_mfma_f32_16x16x32_bf16 v[196:199], v[92:95], a[64:67], v[196:199]
    v_mfma_f32_16x16x32_bf16 v[200:203], v[88:91], a[68:71], v[200:203]
    v_mfma_f32_16x16x32_bf16 v[204:207], v[92:95], a[68:71], v[204:207]
    v_mfma_f32_16x16x32_bf16 v[208:211], v[88:91], a[72:75], v[208:211]
    buffer_load_dwordx4 v233, s[44:47], s37 offen offset:1024 lds
    v_mfma_f32_16x16x32_bf16 v[212:215], v[92:95], a[72:75], v[212:215]
    v_mfma_f32_16x16x32_bf16 v[216:219], v[88:91], a[76:79], v[216:219]
    v_mfma_f32_16x16x32_bf16 v[220:223], v[92:95], a[76:79], v[220:223]
    s_waitcnt vmcnt(14) lgkmcnt(0)
    v_mfma_f32_16x16x32_bf16 v[96:99], v[64:67], a[80:83], v[96:99]
    ds_read_b128 v[80:83], v225 offset:40960
    s_waitcnt vmcnt(18)
    v_mfma_f32_16x16x32_bf16 v[100:103], v[68:71], a[80:83], v[100:103]
    ds_read_b128 v[84:87], v225 offset:43008
    v_lshlrev_b32_e64 v16, 16, v0
    v_mfma_f32_16x16x32_bf16 v[104:107], v[64:67], a[84:87], v[104:107]
    ds_read_b128 v[88:91], v225 offset:45056
    v_and_b32 v17, 0xffff0000, v0
    v_lshlrev_b32_e64 v18, 16, v1
    v_mfma_f32_16x16x32_bf16 v[108:111], v[68:71], a[84:87], v[108:111]
    ds_read_b128 v[92:95], v225 offset:47104
    v_and_b32 v19, 0xffff0000, v1
    v_mfma_f32_16x16x32_bf16 v[112:115], v[64:67], a[88:91], v[112:115]
    ds_read_b64_tr_b16 a[96:97], v228 offset:0
    v_lshlrev_b32_e64 v20, 16, v2
    v_mfma_f32_16x16x32_bf16 v[116:119], v[68:71], a[88:91], v[116:119]
    ds_read_b64_tr_b16 a[98:99], v228 offset:512
    v_and_b32 v21, 0xffff0000, v2
    v_mfma_f32_16x16x32_bf16 v[120:123], v[64:67], a[92:95], v[120:123]
    ds_read_b64_tr_b16 a[100:101], v229 offset:0
    v_lshlrev_b32_e64 v22, 16, v3
    v_mfma_f32_16x16x32_bf16 v[124:127], v[68:71], a[92:95], v[124:127]
    ds_read_b64_tr_b16 a[102:103], v229 offset:512
    v_and_b32 v23, 0xffff0000, v3
    v_lshlrev_b32_e64 v24, 16, v4
    v_mfma_f32_16x16x32_bf16 v[128:131], v[72:75], a[80:83], v[128:131]
    s_add_u32 m0, s35, 16384
    s_and_b32 s33, s85, 1023
    s_lshl_b32 s33, s33, 12
    buffer_load_dwordx4 v234, s[48:51], s33 offen lds
    v_mfma_f32_16x16x32_bf16 v[132:135], v[76:79], a[80:83], v[132:135]
    buffer_load_dwordx4 v235, s[48:51], s33 offen offset:1024 lds
    v_and_b32 v25, 0xffff0000, v4
    v_mfma_f32_16x16x32_bf16 v[136:139], v[72:75], a[84:87], v[136:139]
    s_add_u32 m0, s35, 18432
    s_add_u32 s33, s33, 131072
    buffer_load_dwordx4 v234, s[48:51], s33 offen lds
    v_mfma_f32_16x16x32_bf16 v[140:143], v[76:79], a[84:87], v[140:143]
    v_lshlrev_b32 v26, 16, v5
    v_and_b32 v27, 0xffff0000, v5
    v_mfma_f32_16x16x32_bf16 v[144:147], v[72:75], a[88:91], v[144:147]
    buffer_load_dwordx4 v235, s[48:51], s33 offen offset:1024 lds
    v_lshlrev_b32_e64 v28, 16, v6
    v_mfma_f32_16x16x32_bf16 v[148:151], v[76:79], a[88:91], v[148:151]
    s_lshl2_add_u32 s26, s4, s3
    s_lshl_b32 s26, s26, 10
    s_add_u32 s26, s26, s32
    s_add_u32 s26, s26, 131072
    v_mfma_f32_16x16x32_bf16 v[152:155], v[72:75], a[92:95], v[152:155]
    v_and_b32 v226, 0x40000380, v251
    buffer_load_dword v241, v226, s[44:47], s26 offen
    v_mfma_f32_16x16x32_bf16 v[156:159], v[76:79], a[92:95], v[156:159]
    s_waitcnt vmcnt(29) lgkmcnt(0)
    s_barrier
    v_mfma_f32_16x16x32_bf16 v[160:163], v[80:83], a[80:83], v[160:163]
    ds_read_b128 v[64:67], v224 offset:49152
    v_and_b32 v29, 0xffff0000, v6
    v_lshlrev_b32 v30, 16, v7
    v_mfma_f32_16x16x32_bf16 v[164:167], v[84:87], a[80:83], v[164:167]
    ds_read_b128 v[68:71], v224 offset:51200
    v_and_b32 v31, 0xffff0000, v7
    v_mfma_f32_16x16x32_bf16 v[168:171], v[80:83], a[84:87], v[168:171]
    ds_read_b128 v[72:75], v224 offset:53248
    v_lshlrev_b32_e64 v32, 16, v8
    v_mfma_f32_16x16x32_bf16 v[172:175], v[84:87], a[84:87], v[172:175]
    ds_read_b128 v[76:79], v224 offset:55296
    v_and_b32 v33, 0xffff0000, v8
    v_mfma_f32_16x16x32_bf16 v[176:179], v[80:83], a[88:91], v[176:179]
    ds_read_b64_tr_b16 a[104:105], v230 offset:0
    v_lshlrev_b32_e64 v34, 16, v9
    v_mfma_f32_16x16x32_bf16 v[180:183], v[84:87], a[88:91], v[180:183]
    ds_read_b64_tr_b16 a[106:107], v230 offset:512
    v_and_b32 v35, 0xffff0000, v9
    v_lshlrev_b32_e64 v36, 16, v10
    v_mfma_f32_16x16x32_bf16 v[184:187], v[80:83], a[92:95], v[184:187]
    ds_read_b64_tr_b16 a[108:109], v231 offset:0
    v_and_b32 v37, 0xffff0000, v10
    v_mfma_f32_16x16x32_bf16 v[188:191], v[84:87], a[92:95], v[188:191]
    ds_read_b64_tr_b16 a[110:111], v231 offset:512
    v_lshlrev_b32_e64 v38, 16, v11
    v_mfma_f32_16x16x32_bf16 v[192:195], v[88:91], a[80:83], v[192:195]
    s_add_u32 m0, s34, 32768
    s_add_u32 s37, s86, 0
    buffer_load_dwordx4 v232, s[44:47], s37 offen lds
    v_mfma_f32_16x16x32_bf16 v[196:199], v[92:95], a[80:83], v[196:199]
    v_and_b32 v39, 0xffff0000, v11
    v_lshlrev_b32 v40, 16, v12
    v_mfma_f32_16x16x32_bf16 v[200:203], v[88:91], a[84:87], v[200:203]
    v_and_b32 v41, 0xffff0000, v12
    v_lshlrev_b32_e64 v42, 16, v13
    v_and_b32 v43, 0xffff0000, v13
    v_mfma_f32_16x16x32_bf16 v[204:207], v[92:95], a[84:87], v[204:207]
    v_lshlrev_b32_e64 v44, 16, v14
    v_and_b32 v45, 0xffff0000, v14
    v_mfma_f32_16x16x32_bf16 v[208:211], v[88:91], a[88:91], v[208:211]
    buffer_load_dwordx4 v233, s[44:47], s37 offen offset:1024 lds
    v_lshlrev_b32_e64 v46, 16, v15
    v_mfma_f32_16x16x32_bf16 v[212:215], v[92:95], a[88:91], v[212:215]
    v_and_b32 v47, 0xffff0000, v15
    v_add_f32 v52, v16, v20
    v_add_f32 v53, v17, v21
    v_mfma_f32_16x16x32_bf16 v[216:219], v[88:91], a[92:95], v[216:219]
    v_add_f32 v54, v18, v22
    v_add_f32 v55, v19, v23
    v_mfma_f32_16x16x32_bf16 v[220:223], v[92:95], a[92:95], v[220:223]
    v_add_f32 v52, v52, v24
    s_waitcnt lgkmcnt(0)
    v_mfma_f32_16x16x32_bf16 v[96:99], v[64:67], a[96:99], v[96:99]
    ds_read_b128 v[80:83], v224 offset:57344
    v_add_f32 v53, v53, v25
    v_add_f32 v54, v54, v26
    v_mfma_f32_16x16x32_bf16 v[100:103], v[68:71], a[96:99], v[100:103]
    ds_read_b128 v[84:87], v224 offset:59392
    v_add_f32_e64 v55, v55, v27
    v_mfma_f32_16x16x32_bf16 v[104:107], v[64:67], a[100:103], v[104:107]
    ds_read_b128 v[88:91], v224 offset:61440
    v_add_f32_e64 v52, v52, v28
    v_mfma_f32_16x16x32_bf16 v[108:111], v[68:71], a[100:103], v[108:111]
    ds_read_b128 v[92:95], v224 offset:63488
    v_add_f32_e64 v53, v53, v29
    v_mfma_f32_16x16x32_bf16 v[112:115], v[64:67], a[104:107], v[112:115]
    ds_read_b64_tr_b16 a[112:113], v228 offset:4096
    v_add_f32_e64 v54, v54, v30
    v_mfma_f32_16x16x32_bf16 v[116:119], v[68:71], a[104:107], v[116:119]
    ds_read_b64_tr_b16 a[114:115], v228 offset:4608
    v_add_f32 v55, v55, v31
    v_add_f32 v52, v52, v32
    v_mfma_f32_16x16x32_bf16 v[120:123], v[64:67], a[108:111], v[120:123]
    ds_read_b64_tr_b16 a[116:117], v229 offset:4096
    v_add_f32_e64 v53, v53, v33
    v_mfma_f32_16x16x32_bf16 v[124:127], v[68:71], a[108:111], v[124:127]
    ds_read_b64_tr_b16 a[118:119], v229 offset:4608
    v_add_f32_e64 v54, v54, v34
    v_mfma_f32_16x16x32_bf16 v[128:131], v[72:75], a[96:99], v[128:131]
    s_add_u32 m0, s35, 20480
    s_add_u32 s33, s33, 131072
    buffer_load_dwordx4 v234, s[48:51], s33 offen lds
    v_mfma_f32_16x16x32_bf16 v[132:135], v[76:79], a[96:99], v[132:135]
    v_add_f32 v55, v55, v35
    v_add_f32 v52, v52, v36
    v_mfma_f32_16x16x32_bf16 v[136:139], v[72:75], a[100:103], v[136:139]
    buffer_load_dwordx4 v235, s[48:51], s33 offen offset:1024 lds
    v_add_f32 v53, v53, v37
    v_add_f32 v54, v54, v38
    v_mfma_f32_16x16x32_bf16 v[140:143], v[76:79], a[100:103], v[140:143]
    v_add_f32 v55, v55, v39
    v_add_f32 v52, v52, v40
    v_mfma_f32_16x16x32_bf16 v[144:147], v[72:75], a[104:107], v[144:147]
    s_add_u32 m0, s35, 22528
    s_add_u32 s33, s33, 131072
    buffer_load_dwordx4 v234, s[48:51], s33 offen lds
    v_mfma_f32_16x16x32_bf16 v[148:151], v[76:79], a[104:107], v[148:151]
    v_add_f32 v53, v53, v41
    v_add_f32 v54, v54, v42
    v_mfma_f32_16x16x32_bf16 v[152:155], v[72:75], a[108:111], v[152:155]
    buffer_load_dwordx4 v235, s[48:51], s33 offen offset:1024 lds
    v_add_f32 v55, v55, v43
    v_add_f32 v52, v52, v44
    v_mfma_f32_16x16x32_bf16 v[156:159], v[76:79], a[108:111], v[156:159]
    v_add_f32 v53, v53, v45
    s_waitcnt lgkmcnt(0)
    v_mfma_f32_16x16x32_bf16 v[160:163], v[80:83], a[96:99], v[160:163]
    ds_read_b128 v[64:67], v225 offset:49152
    v_add_f32_e64 v54, v54, v46
    v_mfma_f32_16x16x32_bf16 v[164:167], v[84:87], a[96:99], v[164:167]
    ds_read_b128 v[68:71], v225 offset:51200
    v_add_f32_e64 v55, v55, v47
    v_mfma_f32_16x16x32_bf16 v[168:171], v[80:83], a[100:103], v[168:171]
    ds_read_b128 v[72:75], v225 offset:53248
    v_add_f32_e64 v52, v52, v53
    v_mfma_f32_16x16x32_bf16 v[172:175], v[84:87], a[100:103], v[172:175]
    ds_read_b128 v[76:79], v225 offset:55296
    v_add_f32 v54, v54, v55
    v_add_f32 v48, v52, v54
    v_mfma_f32_16x16x32_bf16 v[176:179], v[80:83], a[104:107], v[176:179]
    ds_read_b64_tr_b16 a[120:121], v230 offset:4096
    s_nop 1
    v_mfma_f32_16x16x32_bf16 v[180:183], v[84:87], a[104:107], v[180:183]
    ds_read_b64_tr_b16 a[122:123], v230 offset:4608
    v_add_f32_dpp v48, v48, v48 quad_perm:[1,0,3,2] row_mask:0xf bank_mask:0xf
    v_mfma_f32_16x16x32_bf16 v[184:187], v[80:83], a[108:111], v[184:187]
    ds_read_b64_tr_b16 a[124:125], v231 offset:4096
    s_nop 1
    v_mfma_f32_16x16x32_bf16 v[188:191], v[84:87], a[108:111], v[188:191]
    ds_read_b64_tr_b16 a[126:127], v231 offset:4608
    v_add_f32_dpp v48, v48, v48 quad_perm:[2,3,0,1] row_mask:0xf bank_mask:0xf
    v_mfma_f32_16x16x32_bf16 v[192:195], v[88:91], a[96:99], v[192:195]
    s_add_u32 m0, s34, 40960
    s_add_u32 s37, s86, 65536
    buffer_load_dwordx4 v232, s[44:47], s37 offen lds
    v_mfma_f32_16x16x32_bf16 v[196:199], v[92:95], a[96:99], v[196:199]
    s_nop 1
    v_add_f32_dpp v48, v48, v48 row_half_mirror row_mask:0xf bank_mask:0xf
    s_nop 1
    v_mfma_f32_16x16x32_bf16 v[200:203], v[88:91], a[100:103], v[200:203]
    buffer_load_dwordx4 v233, s[44:47], s37 offen offset:1024 lds
    v_add_f32_dpp v48, v48, v48 row_mirror row_mask:0xf bank_mask:0xf
    v_mfma_f32_16x16x32_bf16 v[204:207], v[92:95], a[100:103], v[204:207]
    s_nop 0
    v_mov_b32 v49, v48
    v_mfma_f32_16x16x32_bf16 v[208:211], v[88:91], a[104:107], v[208:211]
    v_lshlrev_b32_e64 v227, 3, v240
    v_min_u32 v227, 1920, v227
    s_lshl2_add_u32 s25, s2, s3
    v_mfma_f32_16x16x32_bf16 v[212:215], v[92:95], a[104:107], v[212:215]
    s_nop 1
    v_permlane16_swap_b32 v48, v49
    s_nop 0
    v_mfma_f32_16x16x32_bf16 v[216:219], v[88:91], a[108:111], v[216:219]
    s_lshl_b32 s25, s25, 13
    s_add_u32 s25, s25, 0
    buffer_load_dword v241, v227, s[12:15], s25 offen
    v_mfma_f32_16x16x32_bf16 v[220:223], v[92:95], a[108:111], v[220:223]
    v_add_f32 v48, v48, v49
    s_waitcnt vmcnt(16) lgkmcnt(0)
    v_mfma_f32_16x16x32_bf16 v[96:99], v[64:67], a[112:115], v[96:99]
    ds_read_b128 v[80:83], v225 offset:57344
    v_mul_f32 v48, 0x3a800000, v48
    v_mfma_f32_16x16x32_bf16 v[100:103], v[68:71], a[112:115], v[100:103]
    ds_read_b128 v[84:87], v225 offset:59392
    v_sub_f32 v56, v16, v48
    v_mul_f32 v52, v56, v56
    v_mfma_f32_16x16x32_bf16 v[104:107], v[64:67], a[116:119], v[104:107]
    ds_read_b128 v[88:91], v225 offset:61440
    v_sub_f32_e64 v57, v17, v48
    v_mfma_f32_16x16x32_bf16 v[108:111], v[68:71], a[116:119], v[108:111]
    ds_read_b128 v[92:95], v225 offset:63488
    v_mul_f32_e64 v53, v57, v57
    v_mfma_f32_16x16x32_bf16 v[112:115], v[64:67], a[120:123], v[112:115]
    ds_read_b64_tr_b16 a[128:129], v228 offset:8192
    v_sub_f32_e64 v58, v18, v48
    v_mfma_f32_16x16x32_bf16 v[116:119], v[68:71], a[120:123], v[116:119]
    ds_read_b64_tr_b16 a[130:131], v228 offset:8704
    v_mul_f32_e64 v54, v58, v58
    v_mfma_f32_16x16x32_bf16 v[120:123], v[64:67], a[124:127], v[120:123]
    ds_read_b64_tr_b16 a[132:133], v229 offset:8192
    v_sub_f32 v59, v19, v48
    v_mul_f32 v55, v59, v59
    v_mfma_f32_16x16x32_bf16 v[124:127], v[68:71], a[124:127], v[124:127]
    ds_read_b64_tr_b16 a[134:135], v229 offset:8704
    v_sub_f32_e64 v56, v20, v48
    v_mfma_f32_16x16x32_bf16 v[128:131], v[72:75], a[112:115], v[128:131]
    s_add_u32 m0, s35, 0
    s_and_b32 s33, s86, 1023
    s_lshl_b32 s33, s33, 12
    buffer_load_dwordx4 v234, s[48:51], s33 offen lds
    v_mfma_f32_16x16x32_bf16 v[132:135], v[76:79], a[112:115], v[132:135]
    v_fmac_f32 v52, v56, v56
    v_sub_f32 v57, v21, v48
    v_mfma_f32_16x16x32_bf16 v[136:139], v[72:75], a[116:119], v[136:139]
    buffer_load_dwordx4 v235, s[48:51], s33 offen offset:1024 lds
    v_fmac_f32_e64 v53, v57, v57
    v_mfma_f32_16x16x32_bf16 v[140:143], v[76:79], a[116:119], v[140:143]
    v_sub_f32 v58, v22, v48
    v_fmac_f32 v54, v58, v58
    v_sub_f32_e64 v59, v23, v48
    v_mfma_f32_16x16x32_bf16 v[144:147], v[72:75], a[120:123], v[144:147]
    s_add_u32 m0, s35, 2048
    s_add_u32 s33, s33, 131072
    buffer_load_dwordx4 v234, s[48:51], s33 offen lds
    v_mfma_f32_16x16x32_bf16 v[148:151], v[76:79], a[120:123], v[148:151]
    v_fmac_f32 v55, v59, v59
    v_sub_f32 v56, v24, v48
    v_mfma_f32_16x16x32_bf16 v[152:155], v[72:75], a[124:127], v[152:155]
    buffer_load_dwordx4 v235, s[48:51], s33 offen offset:1024 lds
    v_fmac_f32_e64 v52, v56, v56
    v_mfma_f32_16x16x32_bf16 v[156:159], v[76:79], a[124:127], v[156:159]
    s_waitcnt vmcnt(30) lgkmcnt(0)
    s_barrier
    v_mfma_f32_16x16x32_bf16 v[160:163], v[80:83], a[112:115], v[160:163]
    ds_read_b128 v[64:67], v224 offset:0
    v_sub_f32 v57, v25, v48
    v_fmac_f32 v53, v57, v57
    v_mfma_f32_16x16x32_bf16 v[164:167], v[84:87], a[112:115], v[164:167]
    ds_read_b128 v[68:71], v224 offset:2048
    v_sub_f32_e64 v58, v26, v48
    v_mfma_f32_16x16x32_bf16 v[168:171], v[80:83], a[116:119], v[168:171]
    ds_read_b128 v[72:75], v224 offset:4096
    v_fmac_f32_e64 v54, v58, v58
    v_mfma_f32_16x16x32_bf16 v[172:175], v[84:87], a[116:119], v[172:175]
    ds_read_b128 v[76:79], v224 offset:6144
    v_sub_f32_e64 v59, v27, v48
    v_mfma_f32_16x16x32_bf16 v[176:179], v[80:83], a[120:123], v[176:179]
    ds_read_b64_tr_b16 a[136:137], v230 offset:8192
    v_fmac_f32_e64 v55, v59, v59
    v_mfma_f32_16x16x32_bf16 v[180:183], v[84:87], a[120:123], v[180:183]
    ds_read_b64_tr_b16 a[138:139], v230 offset:8704
    v_sub_f32 v56, v28, v48
    v_fmac_f32 v52, v56, v56
    v_mfma_f32_16x16x32_bf16 v[184:187], v[80:83], a[124:127], v[184:187]
    ds_read_b64_tr_b16 a[140:141], v231 offset:8192
    v_sub_f32_e64 v57, v29, v48
    v_mfma_f32_16x16x32_bf16 v[188:191], v[84:87], a[124:127], v[188:191]
    ds_read_b64_tr_b16 a[142:143], v231 offset:8704
    v_fmac_f32_e64 v53, v57, v57
    v_mfma_f32_16x16x32_bf16 v[192:195], v[88:91], a[112:115], v[192:195]
    s_add_u32 m0, s34, 49152
    s_add_u32 s37, s87, 0
    buffer_load_dwordx4 v232, s[44:47], s37 offen lds
    v_mfma_f32_16x16x32_bf16 v[196:199], v[92:95], a[112:115], v[196:199]
    v_sub_f32 v58, v30, v48
    v_fmac_f32_e64 v54, v58, v58
    v_mfma_f32_16x16x32_bf16 v[200:203], v[88:91], a[116:119], v[200:203]
    v_sub_f32 v59, v31, v48
    v_fmac_f32 v55, v59, v59
    v_sub_f32_e64 v56, v32, v48
    v_mfma_f32_16x16x32_bf16 v[204:207], v[92:95], a[116:119], v[204:207]
    v_fmac_f32 v52, v56, v56
    v_sub_f32 v57, v33, v48
    v_mfma_f32_16x16x32_bf16 v[208:211], v[88:91], a[120:123], v[208:211]
    buffer_load_dwordx4 v233, s[44:47], s37 offen offset:1024 lds
    v_fmac_f32_e64 v53, v57, v57
    v_mfma_f32_16x16x32_bf16 v[212:215], v[92:95], a[120:123], v[212:215]
    v_sub_f32 v58, v34, v48
    v_fmac_f32 v54, v58, v58
    v_sub_f32_e64 v59, v35, v48
    v_mfma_f32_16x16x32_bf16 v[216:219], v[88:91], a[124:127], v[216:219]
    v_fmac_f32 v55, v59, v59
    v_sub_f32 v56, v36, v48
    v_mfma_f32_16x16x32_bf16 v[220:223], v[92:95], a[124:127], v[220:223]
    v_fmac_f32 v52, v56, v56
    s_waitcnt lgkmcnt(0)
    v_mfma_f32_16x16x32_bf16 v[96:99], v[64:67], a[128:131], v[96:99]
    ds_read_b128 v[80:83], v224 offset:8192
    v_sub_f32 v57, v37, v48
    v_fmac_f32 v53, v57, v57
    v_mfma_f32_16x16x32_bf16 v[100:103], v[68:71], a[128:131], v[100:103]
    ds_read_b128 v[84:87], v224 offset:10240
    v_sub_f32_e64 v58, v38, v48
    v_mfma_f32_16x16x32_bf16 v[104:107], v[64:67], a[132:135], v[104:107]
    ds_read_b128 v[88:91], v224 offset:12288
    v_fmac_f32_e64 v54, v58, v58
    v_mfma_f32_16x16x32_bf16 v[108:111], v[68:71], a[132:135], v[108:111]
    ds_read_b128 v[92:95], v224 offset:14336
    v_sub_f32_e64 v59, v39, v48
    v_mfma_f32_16x16x32_bf16 v[112:115], v[64:67], a[136:139], v[112:115]
    ds_read_b64_tr_b16 a[144:145], v228 offset:12288
    v_fmac_f32_e64 v55, v59, v59
    v_mfma_f32_16x16x32_bf16 v[116:119], v[68:71], a[136:139], v[116:119]
    ds_read_b64_tr_b16 a[146:147], v228 offset:12800
    v_sub_f32 v56, v40, v48
    v_fmac_f32 v52, v56, v56
    v_mfma_f32_16x16x32_bf16 v[120:123], v[64:67], a[140:143], v[120:123]
    ds_read_b64_tr_b16 a[148:149], v229 offset:12288
    v_sub_f32_e64 v57, v41, v48
    v_mfma_f32_16x16x32_bf16 v[124:127], v[68:71], a[140:143], v[124:127]
    ds_read_b64_tr_b16 a[150:151], v229 offset:12800
    v_fmac_f32_e64 v53, v57, v57
    v_mfma_f32_16x16x32_bf16 v[128:131], v[72:75], a[128:131], v[128:131]
    s_add_u32 m0, s35, 4096
    s_add_u32 s33, s33, 131072
    buffer_load_dwordx4 v234, s[48:51], s33 offen lds
    v_mfma_f32_16x16x32_bf16 v[132:135], v[76:79], a[128:131], v[132:135]
    v_sub_f32 v58, v42, v48
    v_fmac_f32 v54, v58, v58
    v_mfma_f32_16x16x32_bf16 v[136:139], v[72:75], a[132:135], v[136:139]
    buffer_load_dwordx4 v235, s[48:51], s33 offen offset:1024 lds
    v_sub_f32 v59, v43, v48
    v_fmac_f32 v55, v59, v59
    v_mfma_f32_16x16x32_bf16 v[140:143], v[76:79], a[132:135], v[140:143]
    v_sub_f32 v56, v44, v48
    v_fmac_f32 v52, v56, v56
    v_mfma_f32_16x16x32_bf16 v[144:147], v[72:75], a[136:139], v[144:147]
    s_add_u32 m0, s35, 6144
    s_add_u32 s33, s33, 131072
    buffer_load_dwordx4 v234, s[48:51], s33 offen lds
    v_mfma_f32_16x16x32_bf16 v[148:151], v[76:79], a[136:139], v[148:151]
    v_sub_f32 v57, v45, v48
    v_fmac_f32 v53, v57, v57
    v_mfma_f32_16x16x32_bf16 v[152:155], v[72:75], a[140:143], v[152:155]
    buffer_load_dwordx4 v235, s[48:51], s33 offen offset:1024 lds
    v_sub_f32 v58, v46, v48
    v_fmac_f32 v54, v58, v58
    v_mfma_f32_16x16x32_bf16 v[156:159], v[76:79], a[140:143], v[156:159]
    v_sub_f32 v59, v47, v48
    s_waitcnt lgkmcnt(0)
    v_mfma_f32_16x16x32_bf16 v[160:163], v[80:83], a[128:131], v[160:163]
    ds_read_b128 v[64:67], v225 offset:0
    v_fmac_f32_e64 v55, v59, v59
    v_mfma_f32_16x16x32_bf16 v[164:167], v[84:87], a[128:131], v[164:167]
    ds_read_b128 v[68:71], v225 offset:2048
    v_add_f32_e64 v52, v52, v53
    v_mfma_f32_16x16x32_bf16 v[168:171], v[80:83], a[132:135], v[168:171]
    ds_read_b128 v[72:75], v225 offset:4096
    v_add_f32_e64 v54, v54, v55
    v_mfma_f32_16x16x32_bf16 v[172:175], v[84:87], a[132:135], v[172:175]
    ds_read_b128 v[76:79], v225 offset:6144
    v_add_f32 v51, v52, v54
    s_nop 1
    v_mfma_f32_16x16x32_bf16 v[176:179], v[80:83], a[136:139], v[176:179]
    ds_read_b64_tr_b16 a[152:153], v230 offset:12288
    v_add_f32_dpp v51, v51, v51 quad_perm:[1,0,3,2] row_mask:0xf bank_mask:0xf
    v_mfma_f32_16x16x32_bf16 v[180:183], v[84:87], a[136:139], v[180:183]
    ds_read_b64_tr_b16 a[154:155], v230 offset:12800
    s_nop 1
    v_mfma_f32_16x16x32_bf16 v[184:187], v[80:83], a[140:143], v[184:187]
    ds_read_b64_tr_b16 a[156:157], v231 offset:12288
    v_add_f32_dpp v51, v51, v51 quad_perm:[2,3,0,1] row_mask:0xf bank_mask:0xf
    v_mfma_f32_16x16x32_bf16 v[188:191], v[84:87], a[140:143], v[188:191]
    ds_read_b64_tr_b16 a[158:159], v231 offset:12800
    s_nop 1
    v_mfma_f32_16x16x32_bf16 v[192:195], v[88:91], a[128:131], v[192:195]
    s_add_u32 m0, s34, 57344
    s_add_u32 s37, s87, 65536
    buffer_load_dwordx4 v232, s[44:47], s37 offen lds
    v_mfma_f32_16x16x32_bf16 v[196:199], v[92:95], a[128:131], v[196:199]
    v_add_f32_dpp v51, v51, v51 row_half_mirror row_mask:0xf bank_mask:0xf
    s_nop 1
    v_add_f32_dpp v51, v51, v51 row_mirror row_mask:0xf bank_mask:0xf
    v_mfma_f32_16x16x32_bf16 v[200:203], v[88:91], a[132:135], v[200:203]
    buffer_load_dwordx4 v233, s[44:47], s37 offen offset:1024 lds
    s_nop 0
    v_mfma_f32_16x16x32_bf16 v[204:207], v[92:95], a[132:135], v[204:207]
    v_mov_b32 v49, v51
    s_nop 1
    v_mfma_f32_16x16x32_bf16 v[208:211], v[88:91], a[136:139], v[208:211]
    v_lshlrev_b32_e64 v227, 3, v240
    v_min_u32 v227, 1920, v227
    s_lshl2_add_u32 s25, s2, s3
    v_mfma_f32_16x16x32_bf16 v[212:215], v[92:95], a[136:139], v[212:215]
    v_permlane16_swap_b32 v51, v49
    s_nop 0
    v_add_f32 v51, v51, v49
    v_mfma_f32_16x16x32_bf16 v[216:219], v[88:91], a[140:143], v[216:219]
    s_lshl_b32 s25, s25, 13
    s_add_u32 s25, s25, 2048
    buffer_load_dword v241, v227, s[12:15], s25 offen
    v_mfma_f32_16x16x32_bf16 v[220:223], v[92:95], a[140:143], v[220:223]
    v_mul_f32 v51, 0x3a800000, v51
    s_waitcnt vmcnt(16) lgkmcnt(0)
    v_mfma_f32_16x16x32_bf16 v[96:99], v[64:67], a[144:147], v[96:99]
    ds_read_b128 v[80:83], v225 offset:8192
    v_cvt_pk_bf16_f32 v50, v48, v51
    v_mfma_f32_16x16x32_bf16 v[100:103], v[68:71], a[144:147], v[100:103]
    ds_read_b128 v[84:87], v225 offset:10240
    v_and_b32 v51, 0xffff0000, v50
    v_mfma_f32_16x16x32_bf16 v[104:107], v[64:67], a[148:151], v[104:107]
    ds_read_b128 v[88:91], v225 offset:12288
    v_lshlrev_b32_e64 v50, 16, v50
    v_add_f32 v51, 0x3727c5ac, v51
    v_mfma_f32_16x16x32_bf16 v[108:111], v[68:71], a[148:151], v[108:111]
    ds_read_b128 v[92:95], v225 offset:14336
    v_cvt_pk_bf16_f32 v51, v51, v51
    v_mfma_f32_16x16x32_bf16 v[112:115], v[64:67], a[152:155], v[112:115]
    ds_read_b64_tr_b16 a[160:161], v228 offset:16384
    v_lshlrev_b32_e64 v51, 16, v51
    v_mfma_f32_16x16x32_bf16 v[116:119], v[68:71], a[152:155], v[116:119]
    ds_read_b64_tr_b16 a[162:163], v228 offset:16896
    v_sqrt_f32 v51, v51
    v_mfma_f32_16x16x32_bf16 v[120:123], v[64:67], a[156:159], v[120:123]
    ds_read_b64_tr_b16 a[164:165], v229 offset:16384
    v_mfma_f32_16x16x32_bf16 v[124:127], v[68:71], a[156:159], v[124:127]
    ds_read_b64_tr_b16 a[166:167], v229 offset:16896
    s_nop 0
    v_cvt_pk_bf16_f32 v51, v51, v51
    v_mfma_f32_16x16x32_bf16 v[128:131], v[72:75], a[144:147], v[128:131]
    s_add_u32 m0, s35, 8192
    s_and_b32 s33, s87, 1023
    s_lshl_b32 s33, s33, 12
    buffer_load_dwordx4 v234, s[48:51], s33 offen lds
    v_mfma_f32_16x16x32_bf16 v[132:135], v[76:79], a[144:147], v[132:135]
    v_lshlrev_b32 v51, 16, v51
    v_rcp_f32_e64 v51, v51
    v_mfma_f32_16x16x32_bf16 v[136:139], v[72:75], a[148:151], v[136:139]
    buffer_load_dwordx4 v235, s[48:51], s33 offen offset:1024 lds
    v_mfma_f32_16x16x32_bf16 v[140:143], v[76:79], a[148:151], v[140:143]
    s_nop 0
    v_mul_f32 v51, 0x3e0293ee, v51
    v_sub_f32 v16, v16, v50
    v_mfma_f32_16x16x32_bf16 v[144:147], v[72:75], a[152:155], v[144:147]
    s_add_u32 m0, s35, 10240
    s_add_u32 s33, s33, 131072
    buffer_load_dwordx4 v234, s[48:51], s33 offen lds
    v_mfma_f32_16x16x32_bf16 v[148:151], v[76:79], a[152:155], v[148:151]
    v_sub_f32_e64 v17, v17, v50
    v_cvt_pk_bf16_f32 v17, v16, v17
    v_mfma_f32_16x16x32_bf16 v[152:155], v[72:75], a[156:159], v[152:155]
    buffer_load_dwordx4 v235, s[48:51], s33 offen offset:1024 lds
    v_lshlrev_b32_e64 v16, 16, v17
    v_mfma_f32_16x16x32_bf16 v[156:159], v[76:79], a[156:159], v[156:159]
    s_waitcnt vmcnt(31) lgkmcnt(0)
    s_barrier
    v_mfma_f32_16x16x32_bf16 v[160:163], v[80:83], a[144:147], v[160:163]
    ds_read_b128 v[64:67], v224 offset:16384
    v_and_b32 v17, 0xffff0000, v17
    v_mfma_f32_16x16x32_bf16 v[164:167], v[84:87], a[144:147], v[164:167]
    ds_read_b128 v[68:71], v224 offset:18432
    v_mul_f32 v16, v16, v51
    v_mul_f32 v17, v17, v51
    v_mfma_f32_16x16x32_bf16 v[168:171], v[80:83], a[148:151], v[168:171]
    ds_read_b128 v[72:75], v224 offset:20480
    v_cvt_pk_bf16_f32 v0, v16, v17
    v_mfma_f32_16x16x32_bf16 v[172:175], v[84:87], a[148:151], v[172:175]
    ds_read_b128 v[76:79], v224 offset:22528
    v_sub_f32_e64 v18, v18, v50
    v_mfma_f32_16x16x32_bf16 v[176:179], v[80:83], a[152:155], v[176:179]
    ds_read_b64_tr_b16 a[168:169], v230 offset:16384
    v_sub_f32_e64 v19, v19, v50
    v_mfma_f32_16x16x32_bf16 v[180:183], v[84:87], a[152:155], v[180:183]
    ds_read_b64_tr_b16 a[170:171], v230 offset:16896
    v_cvt_pk_bf16_f32 v19, v18, v19
    v_mfma_f32_16x16x32_bf16 v[184:187], v[80:83], a[156:159], v[184:187]
    ds_read_b64_tr_b16 a[172:173], v231 offset:16384
    v_lshlrev_b32_e64 v18, 16, v19
    v_and_b32 v19, 0xffff0000, v19
    v_mfma_f32_16x16x32_bf16 v[188:191], v[84:87], a[156:159], v[188:191]
    ds_read_b64_tr_b16 a[174:175], v231 offset:16896
    v_mul_f32_e64 v18, v18, v51
    v_mfma_f32_16x16x32_bf16 v[192:195], v[88:91], a[144:147], v[192:195]
    s_add_u32 m0, s34, 0
    s_add_u32 s37, s80, 131072
    buffer_load_dwordx4 v232, s[44:47], s37 offen lds
    v_mfma_f32_16x16x32_bf16 v[196:199], v[92:95], a[144:147], v[196:199]
    v_mul_f32 v19, v19, v51
    v_cvt_pk_bf16_f32 v1, v18, v19
    v_mfma_f32_16x16x32_bf16 v[200:203], v[88:91], a[148:151], v[200:203]
    v_sub_f32 v20, v20, v50
    v_sub_f32 v21, v21, v50
    v_cvt_pk_bf16_f32 v21, v20, v21
    v_mfma_f32_16x16x32_bf16 v[204:207], v[92:95], a[148:151], v[204:207]
    v_lshlrev_b32_e64 v20, 16, v21
    v_and_b32 v21, 0xffff0000, v21
    v_mfma_f32_16x16x32_bf16 v[208:211], v[88:91], a[152:155], v[208:211]
    buffer_load_dwordx4 v233, s[44:47], s37 offen offset:1024 lds
    v_mul_f32_e64 v20, v20, v51
    v_mfma_f32_16x16x32_bf16 v[212:215], v[92:95], a[152:155], v[212:215]
    v_mul_f32_e64 v21, v21, v51
    v_cvt_pk_bf16_f32 v2, v20, v21
    v_sub_f32_e64 v22, v22, v50
    v_mfma_f32_16x16x32_bf16 v[216:219], v[88:91], a[156:159], v[216:219]
    v_sub_f32_e64 v23, v23, v50
    v_cvt_pk_bf16_f32 v23, v22, v23
    v_mfma_f32_16x16x32_bf16 v[220:223], v[92:95], a[156:159], v[220:223]
    v_lshlrev_b32 v22, 16, v23
    s_waitcnt lgkmcnt(0)
    v_mfma_f32_16x16x32_bf16 v[96:99], v[64:67], a[160:163], v[96:99]
    ds_read_b128 v[80:83], v224 offset:24576
    v_and_b32 v23, 0xffff0000, v23
    v_mfma_f32_16x16x32_bf16 v[100:103], v[68:71], a[160:163], v[100:103]
    ds_read_b128 v[84:87], v224 offset:26624
    v_mul_f32 v22, v22, v51
    v_mul_f32 v23, v23, v51
    v_mfma_f32_16x16x32_bf16 v[104:107], v[64:67], a[164:167], v[104:107]
    ds_read_b128 v[88:91], v224 offset:28672
    v_cvt_pk_bf16_f32 v3, v22, v23
    v_mfma_f32_16x16x32_bf16 v[108:111], v[68:71], a[164:167], v[108:111]
    ds_read_b128 v[92:95], v224 offset:30720
    v_sub_f32_e64 v24, v24, v50
    v_mfma_f32_16x16x32_bf16 v[112:115], v[64:67], a[168:171], v[112:115]
    ds_read_b64_tr_b16 a[176:177], v228 offset:20480
    v_sub_f32_e64 v25, v25, v50
    v_mfma_f32_16x16x32_bf16 v[116:119], v[68:71], a[168:171], v[116:119]
    ds_read_b64_tr_b16 a[178:179], v228 offset:20992
    v_cvt_pk_bf16_f32 v25, v24, v25
    v_mfma_f32_16x16x32_bf16 v[120:123], v[64:67], a[172:175], v[120:123]
    ds_read_b64_tr_b16 a[180:181], v229 offset:20480
    v_lshlrev_b32_e64 v24, 16, v25
    v_and_b32 v25, 0xffff0000, v25
    v_mfma_f32_16x16x32_bf16 v[124:127], v[68:71], a[172:175], v[124:127]
    ds_read_b64_tr_b16 a[182:183], v229 offset:20992
    v_mul_f32_e64 v24, v24, v51
    v_mfma_f32_16x16x32_bf16 v[128:131], v[72:75], a[160:163], v[128:131]
    s_add_u32 m0, s35, 12288
    s_add_u32 s33, s33, 131072
    buffer_load_dwordx4 v234, s[48:51], s33 offen lds
    v_mfma_f32_16x16x32_bf16 v[132:135], v[76:79], a[160:163], v[132:135]
    v_mul_f32_e64 v25, v25, v51
    v_cvt_pk_bf16_f32 v4, v24, v25
    v_mfma_f32_16x16x32_bf16 v[136:139], v[72:75], a[164:167], v[136:139]
    buffer_load_dwordx4 v235, s[48:51], s33 offen offset:1024 lds
    v_sub_f32_e64 v26, v26, v50
    v_mfma_f32_16x16x32_bf16 v[140:143], v[76:79], a[164:167], v[140:143]
    v_sub_f32_e64 v27, v27, v50
    v_cvt_pk_bf16_f32 v27, v26, v27
    v_lshlrev_b32_e64 v26, 16, v27
    v_mfma_f32_16x16x32_bf16 v[144:147], v[72:75], a[168:171], v[144:147]
    s_add_u32 m0, s35, 14336
    s_add_u32 s33, s33, 131072
    buffer_load_dwordx4 v234, s[48:51], s33 offen lds
    v_mfma_f32_16x16x32_bf16 v[148:151], v[76:79], a[168:171], v[148:151]
    v_and_b32 v27, 0xffff0000, v27
    v_mul_f32_e64 v26, v26, v51
    v_mfma_f32_16x16x32_bf16 v[152:155], v[72:75], a[172:175], v[152:155]
    buffer_load_dwordx4 v235, s[48:51], s33 offen offset:1024 lds
    v_mul_f32_e64 v27, v27, v51
    v_mfma_f32_16x16x32_bf16 v[156:159], v[76:79], a[172:175], v[156:159]
    v_cvt_pk_bf16_f32 v5, v26, v27
    v_sub_f32 v28, v28, v50
    s_waitcnt lgkmcnt(0)
    v_mfma_f32_16x16x32_bf16 v[160:163], v[80:83], a[160:163], v[160:163]
    ds_read_b128 v[64:67], v225 offset:16384
    v_sub_f32_e64 v29, v29, v50
    v_mfma_f32_16x16x32_bf16 v[164:167], v[84:87], a[160:163], v[164:167]
    ds_read_b128 v[68:71], v225 offset:18432
    v_cvt_pk_bf16_f32 v29, v28, v29
    v_mfma_f32_16x16x32_bf16 v[168:171], v[80:83], a[164:167], v[168:171]
    ds_read_b128 v[72:75], v225 offset:20480
    v_lshlrev_b32_e64 v28, 16, v29
    v_mfma_f32_16x16x32_bf16 v[172:175], v[84:87], a[164:167], v[172:175]
    ds_read_b128 v[76:79], v225 offset:22528
    v_and_b32 v29, 0xffff0000, v29
    v_mul_f32_e64 v28, v28, v51
    v_mfma_f32_16x16x32_bf16 v[176:179], v[80:83], a[168:171], v[176:179]
    ds_read_b64_tr_b16 a[184:185], v230 offset:20480
    v_mul_f32_e64 v29, v29, v51
    v_mfma_f32_16x16x32_bf16 v[180:183], v[84:87], a[168:171], v[180:183]
    ds_read_b64_tr_b16 a[186:187], v230 offset:20992
    v_cvt_pk_bf16_f32 v6, v28, v29
    v_mfma_f32_16x16x32_bf16 v[184:187], v[80:83], a[172:175], v[184:187]
    ds_read_b64_tr_b16 a[188:189], v231 offset:20480
    v_sub_f32_e64 v30, v30, v50
    v_mfma_f32_16x16x32_bf16 v[188:191], v[84:87], a[172:175], v[188:191]
    ds_read_b64_tr_b16 a[190:191], v231 offset:20992
    v_sub_f32_e64 v31, v31, v50
    v_mfma_f32_16x16x32_bf16 v[192:195], v[88:91], a[160:163], v[192:195]
    s_add_u32 m0, s34, 8192
    s_add_u32 s37, s81, 131072
    buffer_load_dwordx4 v232, s[44:47], s37 offen lds
    v_mfma_f32_16x16x32_bf16 v[196:199], v[92:95], a[160:163], v[196:199]
    v_cvt_pk_bf16_f32 v31, v30, v31
    v_lshlrev_b32_e64 v30, 16, v31
    v_and_b32 v31, 0xffff0000, v31
    v_mfma_f32_16x16x32_bf16 v[200:203], v[88:91], a[164:167], v[200:203]
    buffer_load_dwordx4 v233, s[44:47], s37 offen offset:1024 lds
    v_mul_f32_e64 v30, v30, v51
    v_mfma_f32_16x16x32_bf16 v[204:207], v[92:95], a[164:167], v[204:207]
    v_mul_f32_e64 v31, v31, v51
    v_cvt_pk_bf16_f32 v7, v30, v31
    v_mfma_f32_16x16x32_bf16 v[208:211], v[88:91], a[168:171], v[208:211]
    v_lshlrev_b32_e64 v227, 3, v240
    v_min_u32 v227, 1920, v227
    s_lshl2_add_u32 s25, s2, s3
    v_mfma_f32_16x16x32_bf16 v[212:215], v[92:95], a[168:171], v[212:215]
    v_sub_f32 v32, v32, v50
    v_sub_f32_e64 v33, v33, v50
    v_cvt_pk_bf16_f32 v33, v32, v33
    v_mfma_f32_16x16x32_bf16 v[216:219], v[88:91], a[172:175], v[216:219]
    s_lshl_b32 s25, s25, 13
    s_add_u32 s25, s25, 4096
    buffer_load_dword v241, v227, s[12:15], s25 offen
    v_mfma_f32_16x16x32_bf16 v[220:223], v[92:95], a[172:175], v[220:223]
    v_lshlrev_b32_e64 v32, 16, v33
    s_waitcnt vmcnt(16) lgkmcnt(0)
    v_mfma_f32_16x16x32_bf16 v[96:99], v[64:67], a[176:179], v[96:99]
    ds_read_b128 v[80:83], v225 offset:24576
    v_and_b32 v33, 0xffff0000, v33
    v_mfma_f32_16x16x32_bf16 v[100:103], v[68:71], a[176:179], v[100:103]
    ds_read_b128 v[84:87], v225 offset:26624
    v_mul_f32_e64 v32, v32, v51
    v_mfma_f32_16x16x32_bf16 v[104:107], v[64:67], a[180:183], v[104:107]
    ds_read_b128 v[88:91], v225 offset:28672
    v_mul_f32_e64 v33, v33, v51
    v_cvt_pk_bf16_f32 v8, v32, v33
    v_mfma_f32_16x16x32_bf16 v[108:111], v[68:71], a[180:183], v[108:111]
    ds_read_b128 v[92:95], v225 offset:30720
    v_sub_f32_e64 v34, v34, v50
    v_mfma_f32_16x16x32_bf16 v[112:115], v[64:67], a[184:187], v[112:115]
    ds_read_b64_tr_b16 a[192:193], v228 offset:0
    v_sub_f32_e64 v35, v35, v50
    v_mfma_f32_16x16x32_bf16 v[116:119], v[68:71], a[184:187], v[116:119]
    ds_read_b64_tr_b16 a[194:195], v228 offset:512
    v_cvt_pk_bf16_f32 v35, v34, v35
    v_mfma_f32_16x16x32_bf16 v[120:123], v[64:67], a[188:191], v[120:123]
    ds_read_b64_tr_b16 a[196:197], v229 offset:0
    v_lshlrev_b32_e64 v34, 16, v35
    v_mfma_f32_16x16x32_bf16 v[124:127], v[68:71], a[188:191], v[124:127]
    ds_read_b64_tr_b16 a[198:199], v229 offset:512
    v_and_b32 v35, 0xffff0000, v35
    v_mul_f32_e64 v34, v34, v51
    v_mfma_f32_16x16x32_bf16 v[128:131], v[72:75], a[176:179], v[128:131]
    v_mul_f32_e64 v35, v35, v51
    v_cvt_pk_bf16_f32 v9, v34, v35
    v_mfma_f32_16x16x32_bf16 v[132:135], v[76:79], a[176:179], v[132:135]
    v_sub_f32 v36, v36, v50
    v_sub_f32 v37, v37, v50
    v_mfma_f32_16x16x32_bf16 v[136:139], v[72:75], a[180:183], v[136:139]
    v_cvt_pk_bf16_f32 v37, v36, v37
    v_lshlrev_b32_e64 v36, 16, v37
    v_and_b32 v37, 0xffff0000, v37
    v_mfma_f32_16x16x32_bf16 v[140:143], v[76:79], a[180:183], v[140:143]
    v_mul_f32 v36, v36, v51
    v_mul_f32 v37, v37, v51
    v_mfma_f32_16x16x32_bf16 v[144:147], v[72:75], a[184:187], v[144:147]
    v_cvt_pk_bf16_f32 v10, v36, v37
    v_sub_f32 v38, v38, v50
    v_sub_f32 v39, v39, v50
    v_mfma_f32_16x16x32_bf16 v[148:151], v[76:79], a[184:187], v[148:151]
    v_cvt_pk_bf16_f32 v39, v38, v39
    v_lshlrev_b32_e64 v38, 16, v39
    v_mfma_f32_16x16x32_bf16 v[152:155], v[72:75], a[188:191], v[152:155]
    v_and_b32 v39, 0xffff0000, v39
    v_mul_f32_e64 v38, v38, v51
    v_mfma_f32_16x16x32_bf16 v[156:159], v[76:79], a[188:191], v[156:159]
    s_waitcnt vmcnt(27) lgkmcnt(0)
    s_barrier
    v_mfma_f32_16x16x32_bf16 v[160:163], v[80:83], a[176:179], v[160:163]
    ds_read_b128 v[64:67], v224 offset:32768
    v_mul_f32_e64 v39, v39, v51
    v_cvt_pk_bf16_f32 v11, v38, v39
    v_mfma_f32_16x16x32_bf16 v[164:167], v[84:87], a[176:179], v[164:167]
    ds_read_b128 v[68:71], v224 offset:34816
    v_sub_f32_e64 v40, v40, v50
    v_mfma_f32_16x16x32_bf16 v[168:171], v[80:83], a[180:183], v[168:171]
    ds_read_b128 v[72:75], v224 offset:36864
    v_sub_f32_e64 v41, v41, v50
    v_mfma_f32_16x16x32_bf16 v[172:175], v[84:87], a[180:183], v[172:175]
    ds_read_b128 v[76:79], v224 offset:38912
    v_cvt_pk_bf16_f32 v41, v40, v41
    v_mfma_f32_16x16x32_bf16 v[176:179], v[80:83], a[184:187], v[176:179]
    ds_read_b64_tr_b16 a[200:201], v230 offset:0
    v_lshlrev_b32_e64 v40, 16, v41
    v_mfma_f32_16x16x32_bf16 v[180:183], v[84:87], a[184:187], v[180:183]
    ds_read_b64_tr_b16 a[202:203], v230 offset:512
    v_and_b32 v41, 0xffff0000, v41
    v_mul_f32_e64 v40, v40, v51
    v_mfma_f32_16x16x32_bf16 v[184:187], v[80:83], a[188:191], v[184:187]
    ds_read_b64_tr_b16 a[204:205], v231 offset:0
    v_mul_f32_e64 v41, v41, v51
    v_mfma_f32_16x16x32_bf16 v[188:191], v[84:87], a[188:191], v[188:191]
    ds_read_b64_tr_b16 a[206:207], v231 offset:512
    v_cvt_pk_bf16_f32 v12, v40, v41
    v_mfma_f32_16x16x32_bf16 v[192:195], v[88:91], a[176:179], v[192:195]
    s_add_u32 m0, s34, 16384
    s_add_u32 s37, s82, 131072
    buffer_load_dwordx4 v232, s[44:47], s37 offen lds
    v_mfma_f32_16x16x32_bf16 v[196:199], v[92:95], a[176:179], v[196:199]
    v_sub_f32 v42, v42, v50
    v_sub_f32 v43, v43, v50
    v_mfma_f32_16x16x32_bf16 v[200:203], v[88:91], a[180:183], v[200:203]
    v_cvt_pk_bf16_f32 v43, v42, v43
    v_lshlrev_b32_e64 v42, 16, v43
    v_and_b32 v43, 0xffff0000, v43
    v_mfma_f32_16x16x32_bf16 v[204:207], v[92:95], a[180:183], v[204:207]
    v_mul_f32 v42, v42, v51
    v_mul_f32 v43, v43, v51
    v_mfma_f32_16x16x32_bf16 v[208:211], v[88:91], a[184:187], v[208:211]
    buffer_load_dwordx4 v233, s[44:47], s37 offen offset:1024 lds
    v_cvt_pk_bf16_f32 v13, v42, v43
    v_mfma_f32_16x16x32_bf16 v[212:215], v[92:95], a[184:187], v[212:215]
    v_sub_f32 v44, v44, v50
    v_sub_f32 v45, v45, v50
    v_cvt_pk_bf16_f32 v45, v44, v45
    v_mfma_f32_16x16x32_bf16 v[216:219], v[88:91], a[188:191], v[216:219]
    v_lshlrev_b32_e64 v44, 16, v45
    v_and_b32 v45, 0xffff0000, v45
    v_mfma_f32_16x16x32_bf16 v[220:223], v[92:95], a[188:191], v[220:223]
    v_mul_f32 v44, v44, v51
    s_waitcnt lgkmcnt(0)
    v_mfma_f32_16x16x32_bf16 v[96:99], v[64:67], a[192:195], v[96:99]
    ds_read_b128 v[80:83], v224 offset:40960
    v_mul_f32_e64 v45, v45, v51
    v_cvt_pk_bf16_f32 v14, v44, v45
    v_mfma_f32_16x16x32_bf16 v[100:103], v[68:71], a[192:195], v[100:103]
    ds_read_b128 v[84:87], v224 offset:43008
    v_sub_f32_e64 v46, v46, v50
    v_mfma_f32_16x16x32_bf16 v[104:107], v[64:67], a[196:199], v[104:107]
    ds_read_b128 v[88:91], v224 offset:45056
    v_sub_f32_e64 v47, v47, v50
    v_mfma_f32_16x16x32_bf16 v[108:111], v[68:71], a[196:199], v[108:111]
    ds_read_b128 v[92:95], v224 offset:47104
    v_cvt_pk_bf16_f32 v47, v46, v47
    v_mfma_f32_16x16x32_bf16 v[112:115], v[64:67], a[200:203], v[112:115]
    ds_read_b64_tr_b16 a[208:209], v228 offset:4096
    v_lshlrev_b32_e64 v46, 16, v47
    v_mfma_f32_16x16x32_bf16 v[116:119], v[68:71], a[200:203], v[116:119]
    ds_read_b64_tr_b16 a[210:211], v228 offset:4608
    v_and_b32 v47, 0xffff0000, v47
    v_mul_f32_e64 v46, v46, v51
    v_mfma_f32_16x16x32_bf16 v[120:123], v[64:67], a[204:207], v[120:123]
    ds_read_b64_tr_b16 a[212:213], v229 offset:4096
    v_mul_f32_e64 v47, v47, v51
    v_mfma_f32_16x16x32_bf16 v[124:127], v[68:71], a[204:207], v[124:127]
    ds_read_b64_tr_b16 a[214:215], v229 offset:4608
    v_cvt_pk_bf16_f32 v15, v46, v47
    v_mfma_f32_16x16x32_bf16 v[128:131], v[72:75], a[192:195], v[128:131]
    v_mfma_f32_16x16x32_bf16 v[132:135], v[76:79], a[192:195], v[132:135]
    ds_write_b128 v237, v[0:3] offset:0
    v_mfma_f32_16x16x32_bf16 v[136:139], v[72:75], a[196:199], v[136:139]
    ds_write_b128 v237, v[4:7] offset:4096
    v_mfma_f32_16x16x32_bf16 v[140:143], v[76:79], a[196:199], v[140:143]
    ds_write_b128 v237, v[8:11] offset:24576
    v_mfma_f32_16x16x32_bf16 v[144:147], v[72:75], a[200:203], v[144:147]
    ds_write_b128 v237, v[12:15] offset:28672
    v_mfma_f32_16x16x32_bf16 v[148:151], v[76:79], a[200:203], v[148:151]
    v_mfma_f32_16x16x32_bf16 v[152:155], v[72:75], a[204:207], v[152:155]
    v_mfma_f32_16x16x32_bf16 v[156:159], v[76:79], a[204:207], v[156:159]
    s_waitcnt lgkmcnt(0)
    v_mfma_f32_16x16x32_bf16 v[160:163], v[80:83], a[192:195], v[160:163]
    ds_read_b128 v[64:67], v225 offset:32768
    v_mfma_f32_16x16x32_bf16 v[164:167], v[84:87], a[192:195], v[164:167]
    ds_read_b128 v[68:71], v225 offset:34816
    v_mfma_f32_16x16x32_bf16 v[168:171], v[80:83], a[196:199], v[168:171]
    ds_read_b128 v[72:75], v225 offset:36864
    v_mfma_f32_16x16x32_bf16 v[172:175], v[84:87], a[196:199], v[172:175]
    ds_read_b128 v[76:79], v225 offset:38912
    v_mfma_f32_16x16x32_bf16 v[176:179], v[80:83], a[200:203], v[176:179]
    ds_read_b64_tr_b16 a[216:217], v230 offset:4096
    v_mfma_f32_16x16x32_bf16 v[180:183], v[84:87], a[200:203], v[180:183]
    ds_read_b64_tr_b16 a[218:219], v230 offset:4608
    v_mfma_f32_16x16x32_bf16 v[184:187], v[80:83], a[204:207], v[184:187]
    ds_read_b64_tr_b16 a[220:221], v231 offset:4096
    v_mfma_f32_16x16x32_bf16 v[188:191], v[84:87], a[204:207], v[188:191]
    ds_read_b64_tr_b16 a[222:223], v231 offset:4608
    v_mfma_f32_16x16x32_bf16 v[192:195], v[88:91], a[192:195], v[192:195]
    s_add_u32 m0, s34, 24576
    s_add_u32 s37, s83, 131072
    buffer_load_dwordx4 v232, s[44:47], s37 offen lds
    v_mfma_f32_16x16x32_bf16 v[196:199], v[92:95], a[192:195], v[196:199]
    buffer_load_dwordx4 v233, s[44:47], s37 offen offset:1024 lds
    v_mfma_f32_16x16x32_bf16 v[200:203], v[88:91], a[196:199], v[200:203]
    v_mfma_f32_16x16x32_bf16 v[204:207], v[92:95], a[196:199], v[204:207]
    v_lshlrev_b32 v227, 3, v240
    v_min_u32 v227, 1920, v227
    s_lshl2_add_u32 s25, s2, s3
    v_mfma_f32_16x16x32_bf16 v[208:211], v[88:91], a[200:203], v[208:211]
    s_lshl_b32 s25, s25, 13
    s_add_u32 s25, s25, 6144
    buffer_load_dword v241, v227, s[12:15], s25 offen
    v_mfma_f32_16x16x32_bf16 v[212:215], v[92:95], a[200:203], v[212:215]
    v_mfma_f32_16x16x32_bf16 v[216:219], v[88:91], a[204:207], v[216:219]
    buffer_load_dword v254, off, s[88:91], s97 sc1
    v_mfma_f32_16x16x32_bf16 v[220:223], v[92:95], a[204:207], v[220:223]
    s_waitcnt vmcnt(9) lgkmcnt(0)
    v_mfma_f32_16x16x32_bf16 v[96:99], v[64:67], a[208:211], v[96:99]
    ds_read_b128 v[80:83], v225 offset:40960
    v_mfma_f32_16x16x32_bf16 v[100:103], v[68:71], a[208:211], v[100:103]
    ds_read_b128 v[84:87], v225 offset:43008
    s_mul_i32 s38, s2, 100
    v_mfma_f32_16x16x32_bf16 v[104:107], v[64:67], a[212:215], v[104:107]
    ds_read_b128 v[88:91], v225 offset:45056
    v_mfma_f32_16x16x32_bf16 v[108:111], v[68:71], a[212:215], v[108:111]
    ds_read_b128 v[92:95], v225 offset:47104
    v_mfma_f32_16x16x32_bf16 v[112:115], v[64:67], a[216:219], v[112:115]
    ds_read_b64_tr_b16 a[224:225], v228 offset:8192
    v_lshl_add_u32 v60, v253, 2, s38
    v_mfma_f32_16x16x32_bf16 v[116:119], v[68:71], a[216:219], v[116:119]
    ds_read_b64_tr_b16 a[226:227], v228 offset:8704
    v_mfma_f32_16x16x32_bf16 v[120:123], v[64:67], a[220:223], v[120:123]
    ds_read_b64_tr_b16 a[228:229], v229 offset:8192
    v_mfma_f32_16x16x32_bf16 v[124:127], v[68:71], a[220:223], v[124:127]
    ds_read_b64_tr_b16 a[230:231], v229 offset:8704
    v_cmp_gt_u32 vcc, 25, v253
    v_mfma_f32_16x16x32_bf16 v[128:131], v[72:75], a[208:211], v[128:131]
    v_mov_b32_e64 v61, 0
    v_mfma_f32_16x16x32_bf16 v[132:135], v[76:79], a[208:211], v[132:135]
    v_mfma_f32_16x16x32_bf16 v[136:139], v[72:75], a[212:215], v[136:139]
    v_mov_b32 v62, 0x7ffffff0
    v_mfma_f32_16x16x32_bf16 v[140:143], v[76:79], a[212:215], v[140:143]
    v_cndmask_b32 v60, v62, v60, vcc
    v_mfma_f32_16x16x32_bf16 v[144:147], v[72:75], a[216:219], v[144:147]
    v_mfma_f32_16x16x32_bf16 v[148:151], v[76:79], a[216:219], v[148:151]
    buffer_store_dword v61, v60, s[56:59], 0 offen sc1
    v_mfma_f32_16x16x32_bf16 v[152:155], v[72:75], a[220:223], v[152:155]
    v_mfma_f32_16x16x32_bf16 v[156:159], v[76:79], a[220:223], v[156:159]
    s_waitcnt vmcnt(21) lgkmcnt(0)
    s_barrier
    v_mfma_f32_16x16x32_bf16 v[160:163], v[80:83], a[208:211], v[160:163]
    ds_read_b128 v[64:67], v224 offset:49152
    v_mfma_f32_16x16x32_bf16 v[164:167], v[84:87], a[208:211], v[164:167]
    ds_read_b128 v[68:71], v224 offset:51200
    v_mfma_f32_16x16x32_bf16 v[168:171], v[80:83], a[212:215], v[168:171]
    ds_read_b128 v[72:75], v224 offset:53248
    v_mfma_f32_16x16x32_bf16 v[172:175], v[84:87], a[212:215], v[172:175]
    ds_read_b128 v[76:79], v224 offset:55296
    v_mfma_f32_16x16x32_bf16 v[176:179], v[80:83], a[216:219], v[176:179]
    ds_read_b64_tr_b16 a[232:233], v230 offset:8192
    v_mfma_f32_16x16x32_bf16 v[180:183], v[84:87], a[216:219], v[180:183]
    ds_read_b64_tr_b16 a[234:235], v230 offset:8704
    v_mfma_f32_16x16x32_bf16 v[184:187], v[80:83], a[220:223], v[184:187]
    ds_read_b64_tr_b16 a[236:237], v231 offset:8192
    v_mfma_f32_16x16x32_bf16 v[188:191], v[84:87], a[220:223], v[188:191]
    ds_read_b64_tr_b16 a[238:239], v231 offset:8704
    v_mfma_f32_16x16x32_bf16 v[192:195], v[88:91], a[208:211], v[192:195]
    v_lshlrev_b32 v237, 4, v253
    v_add_u32 v237, 81920, v237
    ds_read_b128 v[16:19], v237 offset:0
    ds_read_b128 v[20:23], v237 offset:4096
    ds_read_b128 v[24:27], v237 offset:24576
    ds_read_b128 v[28:31], v237 offset:28672
    s_add_u32 m0, s34, 32768
    s_add_u32 s37, s84, 131072
    buffer_load_dwordx4 v232, s[44:47], s37 offen lds
    v_mfma_f32_16x16x32_bf16 v[196:199], v[92:95], a[208:211], v[196:199]
    v_mfma_f32_16x16x32_bf16 v[200:203], v[88:91], a[212:215], v[200:203]
    v_mfma_f32_16x16x32_bf16 v[204:207], v[92:95], a[212:215], v[204:207]
    v_mfma_f32_16x16x32_bf16 v[208:211], v[88:91], a[216:219], v[208:211]
    buffer_load_dwordx4 v233, s[44:47], s37 offen offset:1024 lds
    v_mfma_f32_16x16x32_bf16 v[212:215], v[92:95], a[216:219], v[212:215]
    v_mfma_f32_16x16x32_bf16 v[216:219], v[88:91], a[220:223], v[216:219]
    v_mfma_f32_16x16x32_bf16 v[220:223], v[92:95], a[220:223], v[220:223]
    s_waitcnt lgkmcnt(0)
    v_mfma_f32_16x16x32_bf16 v[96:99], v[64:67], a[224:227], v[96:99]
    ds_read_b128 v[80:83], v224 offset:57344
    v_mfma_f32_16x16x32_bf16 v[100:103], v[68:71], a[224:227], v[100:103]
    ds_read_b128 v[84:87], v224 offset:59392
    v_mfma_f32_16x16x32_bf16 v[104:107], v[64:67], a[228:231], v[104:107]
    ds_read_b128 v[88:91], v224 offset:61440
    v_mfma_f32_16x16x32_bf16 v[108:111], v[68:71], a[228:231], v[108:111]
    ds_read_b128 v[92:95], v224 offset:63488
    v_mfma_f32_16x16x32_bf16 v[112:115], v[64:67], a[232:235], v[112:115]
    ds_read_b64_tr_b16 a[240:241], v228 offset:12288
    v_mfma_f32_16x16x32_bf16 v[116:119], v[68:71], a[232:235], v[116:119]
    ds_read_b64_tr_b16 a[242:243], v228 offset:12800
    s_mov_b32 s39, 0
    buffer_store_dwordx4 v[16:19], v238, s[8:11], s39 offen sc1
    v_mfma_f32_16x16x32_bf16 v[120:123], v[64:67], a[236:239], v[120:123]
    ds_read_b64_tr_b16 a[244:245], v229 offset:12288
    v_mfma_f32_16x16x32_bf16 v[124:127], v[68:71], a[236:239], v[124:127]
    ds_read_b64_tr_b16 a[246:247], v229 offset:12800
    v_mfma_f32_16x16x32_bf16 v[128:131], v[72:75], a[224:227], v[128:131]
    v_mfma_f32_16x16x32_bf16 v[132:135], v[76:79], a[224:227], v[132:135]
    v_mfma_f32_16x16x32_bf16 v[136:139], v[72:75], a[228:231], v[136:139]
    v_mfma_f32_16x16x32_bf16 v[140:143], v[76:79], a[228:231], v[140:143]
    v_mfma_f32_16x16x32_bf16 v[144:147], v[72:75], a[232:235], v[144:147]
    v_mfma_f32_16x16x32_bf16 v[148:151], v[76:79], a[232:235], v[148:151]
    s_mov_b32 s39, 8192
    buffer_store_dwordx4 v[20:23], v238, s[8:11], s39 offen sc1
    v_mfma_f32_16x16x32_bf16 v[152:155], v[72:75], a[236:239], v[152:155]
    v_mfma_f32_16x16x32_bf16 v[156:159], v[76:79], a[236:239], v[156:159]
    s_waitcnt lgkmcnt(0)
    v_mfma_f32_16x16x32_bf16 v[160:163], v[80:83], a[224:227], v[160:163]
    ds_read_b128 v[64:67], v225 offset:49152
    v_mfma_f32_16x16x32_bf16 v[164:167], v[84:87], a[224:227], v[164:167]
    ds_read_b128 v[68:71], v225 offset:51200
    v_mfma_f32_16x16x32_bf16 v[168:171], v[80:83], a[228:231], v[168:171]
    ds_read_b128 v[72:75], v225 offset:53248
    v_mfma_f32_16x16x32_bf16 v[172:175], v[84:87], a[228:231], v[172:175]
    ds_read_b128 v[76:79], v225 offset:55296
    v_mfma_f32_16x16x32_bf16 v[176:179], v[80:83], a[232:235], v[176:179]
    ds_read_b64_tr_b16 a[248:249], v230 offset:12288
    v_mfma_f32_16x16x32_bf16 v[180:183], v[84:87], a[232:235], v[180:183]
    ds_read_b64_tr_b16 a[250:251], v230 offset:12800
    s_mov_b32 s39, 16384
    buffer_store_dwordx4 v[24:27], v238, s[8:11], s39 offen sc1
    v_mfma_f32_16x16x32_bf16 v[184:187], v[80:83], a[236:239], v[184:187]
    ds_read_b64_tr_b16 a[252:253], v231 offset:12288
    v_mfma_f32_16x16x32_bf16 v[188:191], v[84:87], a[236:239], v[188:191]
    ds_read_b64_tr_b16 a[254:255], v231 offset:12800
    v_mfma_f32_16x16x32_bf16 v[192:195], v[88:91], a[224:227], v[192:195]
    s_add_u32 m0, s34, 40960
    s_add_u32 s37, s85, 131072
    buffer_load_dwordx4 v232, s[44:47], s37 offen lds
    v_mfma_f32_16x16x32_bf16 v[196:199], v[92:95], a[224:227], v[196:199]
    v_mfma_f32_16x16x32_bf16 v[200:203], v[88:91], a[228:231], v[200:203]
    v_mfma_f32_16x16x32_bf16 v[204:207], v[92:95], a[228:231], v[204:207]
    v_mfma_f32_16x16x32_bf16 v[208:211], v[88:91], a[232:235], v[208:211]
    buffer_load_dwordx4 v233, s[44:47], s37 offen offset:1024 lds
    v_mfma_f32_16x16x32_bf16 v[212:215], v[92:95], a[232:235], v[212:215]
    s_mov_b32 s39, 24576
    buffer_store_dwordx4 v[28:31], v238, s[8:11], s39 offen sc1
    v_mfma_f32_16x16x32_bf16 v[216:219], v[88:91], a[236:239], v[216:219]
    v_mfma_f32_16x16x32_bf16 v[220:223], v[92:95], a[236:239], v[220:223]
    s_waitcnt lgkmcnt(0)
    v_mfma_f32_16x16x32_bf16 v[96:99], v[64:67], a[240:243], v[96:99]
    ds_read_b128 v[80:83], v225 offset:57344
    v_mfma_f32_16x16x32_bf16 v[100:103], v[68:71], a[240:243], v[100:103]
    ds_read_b128 v[84:87], v225 offset:59392
    v_mfma_f32_16x16x32_bf16 v[104:107], v[64:67], a[244:247], v[104:107]
    ds_read_b128 v[88:91], v225 offset:61440
    v_mfma_f32_16x16x32_bf16 v[108:111], v[68:71], a[244:247], v[108:111]
    ds_read_b128 v[92:95], v225 offset:63488
    v_mfma_f32_16x16x32_bf16 v[112:115], v[64:67], a[248:251], v[112:115]
    v_mfma_f32_16x16x32_bf16 v[116:119], v[68:71], a[248:251], v[116:119]
    v_mfma_f32_16x16x32_bf16 v[120:123], v[64:67], a[252:255], v[120:123]
    v_mfma_f32_16x16x32_bf16 v[124:127], v[68:71], a[252:255], v[124:127]
    v_mfma_f32_16x16x32_bf16 v[128:131], v[72:75], a[240:243], v[128:131]
    v_mfma_f32_16x16x32_bf16 v[132:135], v[76:79], a[240:243], v[132:135]
    v_cvt_pk_bf16_f32 v0, v96, v97
    v_cvt_pk_bf16_f32 v1, v98, v99
    v_mfma_f32_16x16x32_bf16 v[136:139], v[72:75], a[244:247], v[136:139]
    v_cvt_pk_bf16_f32 v2, v100, v101
    v_cvt_pk_bf16_f32 v3, v102, v103
    v_mfma_f32_16x16x32_bf16 v[140:143], v[76:79], a[244:247], v[140:143]
    v_cvt_pk_bf16_f32 v4, v104, v105
    v_cvt_pk_bf16_f32 v5, v106, v107
    v_mfma_f32_16x16x32_bf16 v[144:147], v[72:75], a[248:251], v[144:147]
    v_cvt_pk_bf16_f32 v6, v108, v109
    v_cvt_pk_bf16_f32 v7, v110, v111
    v_mfma_f32_16x16x32_bf16 v[148:151], v[76:79], a[248:251], v[148:151]
    v_cvt_pk_bf16_f32 v8, v112, v113
    v_cvt_pk_bf16_f32 v9, v114, v115
    v_mfma_f32_16x16x32_bf16 v[152:155], v[72:75], a[252:255], v[152:155]
    v_cvt_pk_bf16_f32 v10, v116, v117
    v_cvt_pk_bf16_f32 v11, v118, v119
    v_mfma_f32_16x16x32_bf16 v[156:159], v[76:79], a[252:255], v[156:159]
    v_cvt_pk_bf16_f32 v12, v120, v121
    v_cvt_pk_bf16_f32 v13, v122, v123
    s_waitcnt vmcnt(16) lgkmcnt(0)
    s_barrier
    v_mfma_f32_16x16x32_bf16 v[160:163], v[80:83], a[240:243], v[160:163]
    ds_read_b128 v[64:67], v224 offset:0
    v_cvt_pk_bf16_f32 v14, v124, v125
    v_cvt_pk_bf16_f32 v15, v126, v127
    v_mfma_f32_16x16x32_bf16 v[164:167], v[84:87], a[240:243], v[164:167]
    ds_read_b128 v[68:71], v224 offset:2048
    v_cvt_pk_bf16_f32 v16, v128, v129
    v_cvt_pk_bf16_f32 v17, v130, v131
    v_mfma_f32_16x16x32_bf16 v[168:171], v[80:83], a[244:247], v[168:171]
    ds_read_b128 v[72:75], v224 offset:4096
    v_cvt_pk_bf16_f32 v18, v132, v133
    v_cvt_pk_bf16_f32 v19, v134, v135
    v_mfma_f32_16x16x32_bf16 v[172:175], v[84:87], a[244:247], v[172:175]
    ds_read_b128 v[76:79], v224 offset:6144
    v_cvt_pk_bf16_f32 v20, v136, v137
    v_cvt_pk_bf16_f32 v21, v138, v139
    v_mfma_f32_16x16x32_bf16 v[176:179], v[80:83], a[248:251], v[176:179]
    v_cvt_pk_bf16_f32 v22, v140, v141
    v_cvt_pk_bf16_f32 v23, v142, v143
    v_mfma_f32_16x16x32_bf16 v[180:183], v[84:87], a[248:251], v[180:183]
    v_cvt_pk_bf16_f32 v24, v144, v145
    v_cvt_pk_bf16_f32 v25, v146, v147
    v_mfma_f32_16x16x32_bf16 v[184:187], v[80:83], a[252:255], v[184:187]
    v_cvt_pk_bf16_f32 v26, v148, v149
    v_cvt_pk_bf16_f32 v27, v150, v151
    v_mfma_f32_16x16x32_bf16 v[188:191], v[84:87], a[252:255], v[188:191]
    v_cvt_pk_bf16_f32 v28, v152, v153
    v_cvt_pk_bf16_f32 v29, v154, v155
    v_mfma_f32_16x16x32_bf16 v[192:195], v[88:91], a[240:243], v[192:195]
    s_add_u32 m0, s34, 49152
    s_add_u32 s37, s86, 131072
    buffer_load_dwordx4 v232, s[44:47], s37 offen lds
    v_cvt_pk_bf16_f32 v30, v156, v157
    v_cvt_pk_bf16_f32 v31, v158, v159
    v_mfma_f32_16x16x32_bf16 v[196:199], v[92:95], a[240:243], v[196:199]
    v_cvt_pk_bf16_f32 v32, v160, v161
    v_cvt_pk_bf16_f32 v33, v162, v163
    v_mfma_f32_16x16x32_bf16 v[200:203], v[88:91], a[244:247], v[200:203]
    v_cvt_pk_bf16_f32 v34, v164, v165
    v_cvt_pk_bf16_f32 v35, v166, v167
    v_mfma_f32_16x16x32_bf16 v[204:207], v[92:95], a[244:247], v[204:207]
    v_cvt_pk_bf16_f32 v36, v168, v169
    v_cvt_pk_bf16_f32 v37, v170, v171
    v_mfma_f32_16x16x32_bf16 v[208:211], v[88:91], a[248:251], v[208:211]
    buffer_load_dwordx4 v233, s[44:47], s37 offen offset:1024 lds
    v_cvt_pk_bf16_f32 v38, v172, v173
    v_cvt_pk_bf16_f32 v39, v174, v175
    v_mfma_f32_16x16x32_bf16 v[212:215], v[92:95], a[248:251], v[212:215]
    v_cvt_pk_bf16_f32 v40, v176, v177
    v_cvt_pk_bf16_f32 v41, v178, v179
    v_mfma_f32_16x16x32_bf16 v[216:219], v[88:91], a[252:255], v[216:219]
    v_cvt_pk_bf16_f32 v42, v180, v181
    v_cvt_pk_bf16_f32 v43, v182, v183
    v_mfma_f32_16x16x32_bf16 v[220:223], v[92:95], a[252:255], v[220:223]
    v_cvt_pk_bf16_f32 v44, v184, v185
    v_cvt_pk_bf16_f32 v45, v186, v187
    s_waitcnt lgkmcnt(0)
    v_mfma_f32_16x16x32_bf16 v[96:99], v[64:67], a[0:3], 0
    ds_read_b128 v[80:83], v225 offset:0
    v_cvt_pk_bf16_f32 v46, v188, v189
    v_cvt_pk_bf16_f32 v47, v190, v191
    v_mfma_f32_16x16x32_bf16 v[100:103], v[68:71], a[0:3], 0
    ds_read_b128 v[84:87], v225 offset:2048
    v_cvt_pk_bf16_f32 v48, v192, v193
    v_cvt_pk_bf16_f32 v49, v194, v195
    v_mfma_f32_16x16x32_bf16 v[104:107], v[64:67], a[4:7], 0
    ds_read_b128 v[88:91], v225 offset:4096
    v_cvt_pk_bf16_f32 v50, v196, v197
    v_cvt_pk_bf16_f32 v51, v198, v199
    v_mfma_f32_16x16x32_bf16 v[108:111], v[68:71], a[4:7], 0
    ds_read_b128 v[92:95], v225 offset:6144
    v_cvt_pk_bf16_f32 v52, v200, v201
    v_cvt_pk_bf16_f32 v53, v202, v203
    v_mfma_f32_16x16x32_bf16 v[112:115], v[64:67], a[8:11], 0
    v_cvt_pk_bf16_f32 v54, v204, v205
    v_cvt_pk_bf16_f32 v55, v206, v207
    s_add_u32 s38, s36, 0
    buffer_store_dwordx4 v[0:3], v240, s[16:19], s38 offen offset:0 sc1
    v_mfma_f32_16x16x32_bf16 v[116:119], v[68:71], a[8:11], 0
    v_cvt_pk_bf16_f32 v56, v208, v209
    v_cvt_pk_bf16_f32 v57, v210, v211
    v_mfma_f32_16x16x32_bf16 v[120:123], v[64:67], a[12:15], 0
    v_cvt_pk_bf16_f32 v58, v212, v213
    v_cvt_pk_bf16_f32 v59, v214, v215
    v_mfma_f32_16x16x32_bf16 v[124:127], v[68:71], a[12:15], 0
    v_cvt_pk_bf16_f32 v60, v216, v217
    v_cvt_pk_bf16_f32 v61, v218, v219
    v_mfma_f32_16x16x32_bf16 v[128:131], v[72:75], a[0:3], 0
    v_xor_b32 v237, 16, v245
    v_xor_b32 v238, 16, v246
    v_cvt_pk_bf16_f32 v62, v220, v221
    v_cvt_pk_bf16_f32 v63, v222, v223
    v_mfma_f32_16x16x32_bf16 v[132:135], v[76:79], a[0:3], 0
    v_mfma_f32_16x16x32_bf16 v[136:139], v[72:75], a[4:7], 0
    v_mfma_f32_16x16x32_bf16 v[140:143], v[76:79], a[4:7], 0
    v_mfma_f32_16x16x32_bf16 v[144:147], v[72:75], a[8:11], 0
    v_mfma_f32_16x16x32_bf16 v[148:151], v[76:79], a[8:11], 0
    v_mfma_f32_16x16x32_bf16 v[152:155], v[72:75], a[12:15], 0
    v_mfma_f32_16x16x32_bf16 v[156:159], v[76:79], a[12:15], 0
    s_waitcnt lgkmcnt(0)
    v_mfma_f32_16x16x32_bf16 v[96:99], v[80:83], a[16:19], v[96:99]
    ds_read_b128 v[64:67], v224 offset:8192
    v_mfma_f32_16x16x32_bf16 v[100:103], v[84:87], a[16:19], v[100:103]
    ds_read_b128 v[68:71], v224 offset:10240
    v_mfma_f32_16x16x32_bf16 v[104:107], v[80:83], a[20:23], v[104:107]
    ds_read_b128 v[72:75], v224 offset:12288
    v_mfma_f32_16x16x32_bf16 v[108:111], v[84:87], a[20:23], v[108:111]
    ds_read_b128 v[76:79], v224 offset:14336
    v_mfma_f32_16x16x32_bf16 v[112:115], v[80:83], a[24:27], v[112:115]
    v_mfma_f32_16x16x32_bf16 v[116:119], v[84:87], a[24:27], v[116:119]
    v_mfma_f32_16x16x32_bf16 v[120:123], v[80:83], a[28:31], v[120:123]
    v_mfma_f32_16x16x32_bf16 v[124:127], v[84:87], a[28:31], v[124:127]
    v_mfma_f32_16x16x32_bf16 v[128:131], v[88:91], a[16:19], v[128:131]
    s_add_u32 m0, s34, 57344
    s_add_u32 s37, s87, 131072
    buffer_load_dwordx4 v232, s[44:47], s37 offen lds
    v_mfma_f32_16x16x32_bf16 v[132:135], v[92:95], a[16:19], v[132:135]
    s_add_u32 s38, s36, 0
    buffer_store_dwordx4 v[4:7], v240, s[16:19], s38 offen offset:1024 sc1
    v_mfma_f32_16x16x32_bf16 v[136:139], v[88:91], a[20:23], v[136:139]
    v_mfma_f32_16x16x32_bf16 v[140:143], v[92:95], a[20:23], v[140:143]
    v_mfma_f32_16x16x32_bf16 v[144:147], v[88:91], a[24:27], v[144:147]
    buffer_load_dwordx4 v233, s[44:47], s37 offen offset:1024 lds
    v_mfma_f32_16x16x32_bf16 v[148:151], v[92:95], a[24:27], v[148:151]
    v_mfma_f32_16x16x32_bf16 v[152:155], v[88:91], a[28:31], v[152:155]
    v_mfma_f32_16x16x32_bf16 v[156:159], v[92:95], a[28:31], v[156:159]
    s_waitcnt lgkmcnt(0)
    v_mfma_f32_16x16x32_bf16 v[96:99], v[64:67], a[32:35], v[96:99]
    ds_read_b128 v[80:83], v225 offset:8192
    v_mfma_f32_16x16x32_bf16 v[100:103], v[68:71], a[32:35], v[100:103]
    ds_read_b128 v[84:87], v225 offset:10240
    v_mfma_f32_16x16x32_bf16 v[104:107], v[64:67], a[36:39], v[104:107]
    ds_read_b128 v[88:91], v225 offset:12288
    v_mfma_f32_16x16x32_bf16 v[108:111], v[68:71], a[36:39], v[108:111]
    ds_read_b128 v[92:95], v225 offset:14336
    v_mfma_f32_16x16x32_bf16 v[112:115], v[64:67], a[40:43], v[112:115]
    v_mfma_f32_16x16x32_bf16 v[116:119], v[68:71], a[40:43], v[116:119]
    v_mfma_f32_16x16x32_bf16 v[120:123], v[64:67], a[44:47], v[120:123]
    v_mfma_f32_16x16x32_bf16 v[124:127], v[68:71], a[44:47], v[124:127]
    v_mfma_f32_16x16x32_bf16 v[128:131], v[72:75], a[32:35], v[128:131]
    s_waitcnt vmcnt(15)
    v_readfirstlane_b32 s24, v254
    s_lshl_b32 s25, s3, 16
    s_add_u32 s24, s24, s25
    s_cmp_ge_u32 s24, 1
    s_cbranch_scc0 kf_spin35
kf_spinr36:
    v_mfma_f32_16x16x32_bf16 v[132:135], v[76:79], a[32:35], v[132:135]
    v_mfma_f32_16x16x32_bf16 v[136:139], v[72:75], a[36:39], v[136:139]
    v_mfma_f32_16x16x32_bf16 v[140:143], v[76:79], a[36:39], v[140:143]
    v_mfma_f32_16x16x32_bf16 v[144:147], v[72:75], a[40:43], v[144:147]
    s_add_u32 s88, s20, 0x14a0000
    s_addc_u32 s89, s21, 0
    s_mov_b32 s90, 20480
    v_mfma_f32_16x16x32_bf16 v[148:151], v[76:79], a[40:43], v[148:151]
    v_mfma_f32_16x16x32_bf16 v[152:155], v[72:75], a[44:47], v[152:155]
    v_mfma_f32_16x16x32_bf16 v[156:159], v[76:79], a[44:47], v[156:159]
    s_add_u32 s38, s36, 0
    buffer_store_dwordx4 v[8:11], v240, s[16:19], s38 offen offset:2048 sc1
    s_waitcnt vmcnt(7) lgkmcnt(0)
    s_barrier
    v_mfma_f32_16x16x32_bf16 v[96:99], v[80:83], a[48:51], v[96:99]
    ds_read_b128 v[64:67], v224 offset:16384
    v_mfma_f32_16x16x32_bf16 v[100:103], v[84:87], a[48:51], v[100:103]
    ds_read_b128 v[68:71], v224 offset:18432
    v_mfma_f32_16x16x32_bf16 v[104:107], v[80:83], a[52:55], v[104:107]
    ds_read_b128 v[72:75], v224 offset:20480
    v_mfma_f32_16x16x32_bf16 v[108:111], v[84:87], a[52:55], v[108:111]
    ds_read_b128 v[76:79], v224 offset:22528
    v_mfma_f32_16x16x32_bf16 v[112:115], v[80:83], a[56:59], v[112:115]
    v_mfma_f32_16x16x32_bf16 v[116:119], v[84:87], a[56:59], v[116:119]
    v_mfma_f32_16x16x32_bf16 v[120:123], v[80:83], a[60:63], v[120:123]
    v_mfma_f32_16x16x32_bf16 v[124:127], v[84:87], a[60:63], v[124:127]
    v_mfma_f32_16x16x32_bf16 v[128:131], v[88:91], a[48:51], v[128:131]
    s_add_u32 m0, s34, 0
    s_add_u32 s37, s80, 196608
    buffer_load_dwordx4 v232, s[44:47], s37 offen lds
    v_mfma_f32_16x16x32_bf16 v[132:135], v[92:95], a[48:51], v[132:135]
    v_mfma_f32_16x16x32_bf16 v[136:139], v[88:91], a[52:55], v[136:139]
    buffer_load_dwordx4 v233, s[44:47], s37 offen offset:1024 lds
    v_mfma_f32_16x16x32_bf16 v[140:143], v[92:95], a[52:55], v[140:143]
    v_mfma_f32_16x16x32_bf16 v[144:147], v[88:91], a[56:59], v[144:147]
    v_mfma_f32_16x16x32_bf16 v[148:151], v[92:95], a[56:59], v[148:151]
    s_lshl_b32 s39, s5, 7
    s_add_u32 s39, s39, 8192
    buffer_atomic_add v255, v250, s[88:91], s39 offen sc1
    s_cmp_eq_u32 s3, 0
    s_cselect_b32 s39, s39, s43
    v_mfma_f32_16x16x32_bf16 v[152:155], v[88:91], a[60:63], v[152:155]
    v_mfma_f32_16x16x32_bf16 v[156:159], v[92:95], a[60:63], v[156:159]
    s_waitcnt lgkmcnt(0)
    v_mfma_f32_16x16x32_bf16 v[96:99], v[64:67], a[64:67], v[96:99]
    ds_read_b128 v[80:83], v225 offset:16384
    v_mfma_f32_16x16x32_bf16 v[100:103], v[68:71], a[64:67], v[100:103]
    ds_read_b128 v[84:87], v225 offset:18432
    v_mfma_f32_16x16x32_bf16 v[104:107], v[64:67], a[68:71], v[104:107]
    ds_read_b128 v[88:91], v225 offset:20480
    v_mfma_f32_16x16x32_bf16 v[108:111], v[68:71], a[68:71], v[108:111]
    ds_read_b128 v[92:95], v225 offset:22528
    v_mfma_f32_16x16x32_bf16 v[112:115], v[64:67], a[72:75], v[112:115]
    s_add_u32 s38, s36, 0
    buffer_store_dwordx4 v[12:15], v240, s[16:19], s38 offen offset:3072 sc1
    v_mfma_f32_16x16x32_bf16 v[116:119], v[68:71], a[72:75], v[116:119]
    v_mfma_f32_16x16x32_bf16 v[120:123], v[64:67], a[76:79], v[120:123]
    v_mfma_f32_16x16x32_bf16 v[124:127], v[68:71], a[76:79], v[124:127]
    v_mfma_f32_16x16x32_bf16 v[128:131], v[72:75], a[64:67], v[128:131]
    s_add_u32 m0, s31, 0
    s_add_u32 s24, s27, 0
    buffer_load_dwordx4 v245, s[12:15], s24 offen lds
    v_mfma_f32_16x16x32_bf16 v[132:135], v[76:79], a[64:67], v[132:135]
    v_mfma_f32_16x16x32_bf16 v[136:139], v[72:75], a[68:71], v[136:139]
    v_mfma_f32_16x16x32_bf16 v[140:143], v[76:79], a[68:71], v[140:143]
    v_mfma_f32_16x16x32_bf16 v[144:147], v[72:75], a[72:75], v[144:147]
    v_mfma_f32_16x16x32_bf16 v[148:151], v[76:79], a[72:75], v[148:151]
    v_mfma_f32_16x16x32_bf16 v[152:155], v[72:75], a[76:79], v[152:155]
    v_mfma_f32_16x16x32_bf16 v[156:159], v[76:79], a[76:79], v[156:159]
    s_waitcnt lgkmcnt(0)
    v_mfma_f32_16x16x32_bf16 v[96:99], v[80:83], a[80:83], v[96:99]
    ds_read_b128 v[64:67], v224 offset:24576
    v_mfma_f32_16x16x32_bf16 v[100:103], v[84:87], a[80:83], v[100:103]
    ds_read_b128 v[68:71], v224 offset:26624
    v_mfma_f32_16x16x32_bf16 v[104:107], v[80:83], a[84:87], v[104:107]
    ds_read_b128 v[72:75], v224 offset:28672
    v_mfma_f32_16x16x32_bf16 v[108:111], v[84:87], a[84:87], v[108:111]
    ds_read_b128 v[76:79], v224 offset:30720
    v_mfma_f32_16x16x32_bf16 v[112:115], v[80:83], a[88:91], v[112:115]
    v_mfma_f32_16x16x32_bf16 v[116:119], v[84:87], a[88:91], v[116:119]
    v_mfma_f32_16x16x32_bf16 v[120:123], v[80:83], a[92:95], v[120:123]
    v_mfma_f32_16x16x32_bf16 v[124:127], v[84:87], a[92:95], v[124:127]
    v_mfma_f32_16x16x32_bf16 v[128:131], v[88:91], a[80:83], v[128:131]
    s_add_u32 m0, s34, 8192
    s_add_u32 s37, s81, 196608
    buffer_load_dwordx4 v232, s[44:47], s37 offen lds
    v_mfma_f32_16x16x32_bf16 v[132:135], v[92:95], a[80:83], v[132:135]
    v_mfma_f32_16x16x32_bf16 v[136:139], v[88:91], a[84:87], v[136:139]
    buffer_load_dwordx4 v233, s[44:47], s37 offen offset:1024 lds
    s_add_u32 s38, s36, 8192
    buffer_store_dwordx4 v[16:19], v240, s[16:19], s38 offen offset:0 sc1
    v_mfma_f32_16x16x32_bf16 v[140:143], v[92:95], a[84:87], v[140:143]
    v_mfma_f32_16x16x32_bf16 v[144:147], v[88:91], a[88:91], v[144:147]
    v_mfma_f32_16x16x32_bf16 v[148:151], v[92:95], a[88:91], v[148:151]
    s_add_u32 m0, s31, 1024
    s_add_u32 s24, s27, 32768
    buffer_load_dwordx4 v245, s[12:15], s24 offen lds
    v_mfma_f32_16x16x32_bf16 v[152:155], v[88:91], a[92:95], v[152:155]
    v_mfma_f32_16x16x32_bf16 v[156:159], v[92:95], a[92:95], v[156:159]
    s_waitcnt lgkmcnt(0)
    v_mfma_f32_16x16x32_bf16 v[96:99], v[64:67], a[96:99], v[96:99]
    ds_read_b128 v[80:83], v225 offset:24576
    v_mfma_f32_16x16x32_bf16 v[100:103], v[68:71], a[96:99], v[100:103]
    ds_read_b128 v[84:87], v225 offset:26624
    v_mfma_f32_16x16x32_bf16 v[104:107], v[64:67], a[100:103], v[104:107]
    ds_read_b128 v[88:91], v225 offset:28672
    v_mfma_f32_16x16x32_bf16 v[108:111], v[68:71], a[100:103], v[108:111]
    ds_read_b128 v[92:95], v225 offset:30720
    v_mfma_f32_16x16x32_bf16 v[112:115], v[64:67], a[104:107], v[112:115]
    v_mfma_f32_16x16x32_bf16 v[116:119], v[68:71], a[104:107], v[116:119]
    v_mfma_f32_16x16x32_bf16 v[120:123], v[64:67], a[108:111], v[120:123]
    v_mfma_f32_16x16x32_bf16 v[124:127], v[68:71], a[108:111], v[124:127]
    v_mfma_f32_16x16x32_bf16 v[128:131], v[72:75], a[96:99], v[128:131]
    s_add_u32 m0, s31, 2048
    s_add_u32 s24, s27, 65536
    buffer_load_dwordx4 v237, s[12:15], s24 offen lds
    v_mfma_f32_16x16x32_bf16 v[132:135], v[76:79], a[96:99], v[132:135]
    v_mfma_f32_16x16x32_bf16 v[136:139], v[72:75], a[100:103], v[136:139]
    v_mfma_f32_16x16x32_bf16 v[140:143], v[76:79], a[100:103], v[140:143]
    v_mfma_f32_16x16x32_bf16 v[144:147], v[72:75], a[104:107], v[144:147]
    v_mfma_f32_16x16x32_bf16 v[148:151], v[76:79], a[104:107], v[148:151]
    v_mfma_f32_16x16x32_bf16 v[152:155], v[72:75], a[108:111], v[152:155]
    v_mfma_f32_16x16x32_bf16 v[156:159], v[76:79], a[108:111], v[156:159]
    s_add_u32 s38, s36, 8192
    buffer_store_dwordx4 v[20:23], v240, s[16:19], s38 offen offset:1024 sc1
    s_waitcnt vmcnt(19) lgkmcnt(0)
    s_barrier
    v_mfma_f32_16x16x32_bf16 v[96:99], v[80:83], a[112:115], v[96:99]
    ds_read_b128 v[64:67], v224 offset:32768
    v_mfma_f32_16x16x32_bf16 v[100:103], v[84:87], a[112:115], v[100:103]
    ds_read_b128 v[68:71], v224 offset:34816
    v_mfma_f32_16x16x32_bf16 v[104:107], v[80:83], a[116:119], v[104:107]
    ds_read_b128 v[72:75], v224 offset:36864
    v_mfma_f32_16x16x32_bf16 v[108:111], v[84:87], a[116:119], v[108:111]
    ds_read_b128 v[76:79], v224 offset:38912
    v_mfma_f32_16x16x32_bf16 v[112:115], v[80:83], a[120:123], v[112:115]
    v_mfma_f32_16x16x32_bf16 v[116:119], v[84:87], a[120:123], v[116:119]
    v_mfma_f32_16x16x32_bf16 v[120:123], v[80:83], a[124:127], v[120:123]
    v_mfma_f32_16x16x32_bf16 v[124:127], v[84:87], a[124:127], v[124:127]
    v_mfma_f32_16x16x32_bf16 v[128:131], v[88:91], a[112:115], v[128:131]
    s_add_u32 m0, s34, 16384
    s_add_u32 s37, s82, 196608
    buffer_load_dwordx4 v232, s[44:47], s37 offen lds
    v_mfma_f32_16x16x32_bf16 v[132:135], v[92:95], a[112:115], v[132:135]
    v_mfma_f32_16x16x32_bf16 v[136:139], v[88:91], a[116:119], v[136:139]
    buffer_load_dwordx4 v233, s[44:47], s37 offen offset:1024 lds
    v_mfma_f32_16x16x32_bf16 v[140:143], v[92:95], a[116:119], v[140:143]
    v_mfma_f32_16x16x32_bf16 v[144:147], v[88:91], a[120:123], v[144:147]
    v_mfma_f32_16x16x32_bf16 v[148:151], v[92:95], a[120:123], v[148:151]
    s_add_u32 m0, s31, 3072
    s_add_u32 s24, s27, 98304
    buffer_load_dwordx4 v237, s[12:15], s24 offen lds
    v_mfma_f32_16x16x32_bf16 v[152:155], v[88:91], a[124:127], v[152:155]
    v_mfma_f32_16x16x32_bf16 v[156:159], v[92:95], a[124:127], v[156:159]
    s_waitcnt lgkmcnt(0)
    v_mfma_f32_16x16x32_bf16 v[96:99], v[64:67], a[128:131], v[96:99]
    ds_read_b128 v[80:83], v225 offset:32768
    v_mfma_f32_16x16x32_bf16 v[100:103], v[68:71], a[128:131], v[100:103]
    ds_read_b128 v[84:87], v225 offset:34816
    v_mfma_f32_16x16x32_bf16 v[104:107], v[64:67], a[132:135], v[104:107]
    ds_read_b128 v[88:91], v225 offset:36864
    v_mfma_f32_16x16x32_bf16 v[108:111], v[68:71], a[132:135], v[108:111]
    ds_read_b128 v[92:95], v225 offset:38912
    v_mfma_f32_16x16x32_bf16 v[112:115], v[64:67], a[136:139], v[112:115]
    v_mfma_f32_16x16x32_bf16 v[116:119], v[68:71], a[136:139], v[116:119]
    s_add_u32 s38, s36, 8192
    buffer_store_dwordx4 v[24:27], v240, s[16:19], s38 offen offset:2048 sc1
    v_mfma_f32_16x16x32_bf16 v[120:123], v[64:67], a[140:143], v[120:123]
    v_mfma_f32_16x16x32_bf16 v[124:127], v[68:71], a[140:143], v[124:127]
    v_mfma_f32_16x16x32_bf16 v[128:131], v[72:75], a[128:131], v[128:131]
    s_add_u32 m0, s31, 4096
    s_add_u32 s24, s27, 131072
    buffer_load_dwordx4 v245, s[12:15], s24 offen lds
    v_mfma_f32_16x16x32_bf16 v[132:135], v[76:79], a[128:131], v[132:135]
    v_mfma_f32_16x16x32_bf16 v[136:139], v[72:75], a[132:135], v[136:139]
    v_mfma_f32_16x16x32_bf16 v[140:143], v[76:79], a[132:135], v[140:143]
    v_mfma_f32_16x16x32_bf16 v[144:147], v[72:75], a[136:139], v[144:147]
    v_mfma_f32_16x16x32_bf16 v[148:151], v[76:79], a[136:139], v[148:151]
    v_mfma_f32_16x16x32_bf16 v[152:155], v[72:75], a[140:143], v[152:155]
    v_mfma_f32_16x16x32_bf16 v[156:159], v[76:79], a[140:143], v[156:159]
    s_waitcnt lgkmcnt(0)
    v_mfma_f32_16x16x32_bf16 v[96:99], v[80:83], a[144:147], v[96:99]
    ds_read_b128 v[64:67], v224 offset:40960
    v_mfma_f32_16x16x32_bf16 v[100:103], v[84:87], a[144:147], v[100:103]
    ds_read_b128 v[68:71], v224 offset:43008
    v_mfma_f32_16x16x32_bf16 v[104:107], v[80:83], a[148:151], v[104:107]
    ds_read_b128 v[72:75], v224 offset:45056
    v_mfma_f32_16x16x32_bf16 v[108:111], v[84:87], a[148:151], v[108:111]
    ds_read_b128 v[76:79], v224 offset:47104
    v_mfma_f32_16x16x32_bf16 v[112:115], v[80:83], a[152:155], v[112:115]
    v_mfma_f32_16x16x32_bf16 v[116:119], v[84:87], a[152:155], v[116:119]
    v_mfma_f32_16x16x32_bf16 v[120:123], v[80:83], a[156:159], v[120:123]
    v_mfma_f32_16x16x32_bf16 v[124:127], v[84:87], a[156:159], v[124:127]
    v_mfma_f32_16x16x32_bf16 v[128:131], v[88:91], a[144:147], v[128:131]
    s_add_u32 m0, s34, 24576
    s_add_u32 s37, s83, 196608
    buffer_load_dwordx4 v232, s[44:47], s37 offen lds
    v_mfma_f32_16x16x32_bf16 v[132:135], v[92:95], a[144:147], v[132:135]
    v_mfma_f32_16x16x32_bf16 v[136:139], v[88:91], a[148:151], v[136:139]
    buffer_load_dwordx4 v233, s[44:47], s37 offen offset:1024 lds
    s_add_u32 s38, s36, 8192
    buffer_store_dwordx4 v[28:31], v240, s[16:19], s38 offen offset:3072 sc1
    v_mfma_f32_16x16x32_bf16 v[140:143], v[92:95], a[148:151], v[140:143]
    v_mfma_f32_16x16x32_bf16 v[144:147], v[88:91], a[152:155], v[144:147]
    v_mfma_f32_16x16x32_bf16 v[148:151], v[92:95], a[152:155], v[148:151]
    s_add_u32 m0, s31, 5120
    s_add_u32 s24, s27, 163840
    buffer_load_dwordx4 v245, s[12:15], s24 offen lds
    v_mfma_f32_16x16x32_bf16 v[152:155], v[88:91], a[156:159], v[152:155]
    v_mfma_f32_16x16x32_bf16 v[156:159], v[92:95], a[156:159], v[156:159]
    s_waitcnt lgkmcnt(0)
    v_mfma_f32_16x16x32_bf16 v[96:99], v[64:67], a[160:163], v[96:99]
    ds_read_b128 v[80:83], v225 offset:40960
    v_mfma_f32_16x16x32_bf16 v[100:103], v[68:71], a[160:163], v[100:103]
    ds_read_b128 v[84:87], v225 offset:43008
    v_mfma_f32_16x16x32_bf16 v[104:107], v[64:67], a[164:167], v[104:107]
    ds_read_b128 v[88:91], v225 offset:45056
    v_mfma_f32_16x16x32_bf16 v[108:111], v[68:71], a[164:167], v[108:111]
    ds_read_b128 v[92:95], v225 offset:47104
    v_mfma_f32_16x16x32_bf16 v[112:115], v[64:67], a[168:171], v[112:115]
    v_mfma_f32_16x16x32_bf16 v[116:119], v[68:71], a[168:171], v[116:119]
    v_mfma_f32_16x16x32_bf16 v[120:123], v[64:67], a[172:175], v[120:123]
    v_mfma_f32_16x16x32_bf16 v[124:127], v[68:71], a[172:175], v[124:127]
    v_mfma_f32_16x16x32_bf16 v[128:131], v[72:75], a[160:163], v[128:131]
    s_add_u32 m0, s31, 6144
    s_add_u32 s24, s27, 196608
    buffer_load_dwordx4 v237, s[12:15], s24 offen lds
    v_mfma_f32_16x16x32_bf16 v[132:135], v[76:79], a[160:163], v[132:135]
    v_mfma_f32_16x16x32_bf16 v[136:139], v[72:75], a[164:167], v[136:139]
    v_mfma_f32_16x16x32_bf16 v[140:143], v[76:79], a[164:167], v[140:143]
    v_mfma_f32_16x16x32_bf16 v[144:147], v[72:75], a[168:171], v[144:147]
    v_mfma_f32_16x16x32_bf16 v[148:151], v[76:79], a[168:171], v[148:151]
    v_mfma_f32_16x16x32_bf16 v[152:155], v[72:75], a[172:175], v[152:155]
    v_mfma_f32_16x16x32_bf16 v[156:159], v[76:79], a[172:175], v[156:159]
    s_waitcnt vmcnt(22) lgkmcnt(0)
    s_barrier
    v_mfma_f32_16x16x32_bf16 v[96:99], v[80:83], a[176:179], v[96:99]
    ds_read_b128 v[64:67], v224 offset:49152
    s_add_u32 s38, s36, 32768
    buffer_store_dwordx4 v[32:35], v240, s[16:19], s38 offen offset:1280 sc1
    v_mfma_f32_16x16x32_bf16 v[100:103], v[84:87], a[176:179], v[100:103]
    ds_read_b128 v[68:71], v224 offset:51200
    v_mfma_f32_16x16x32_bf16 v[104:107], v[80:83], a[180:183], v[104:107]
    ds_read_b128 v[72:75], v224 offset:53248
    v_mfma_f32_16x16x32_bf16 v[108:111], v[84:87], a[180:183], v[108:111]
    ds_read_b128 v[76:79], v224 offset:55296
    v_mfma_f32_16x16x32_bf16 v[112:115], v[80:83], a[184:187], v[112:115]
    v_mfma_f32_16x16x32_bf16 v[116:119], v[84:87], a[184:187], v[116:119]
    v_mfma_f32_16x16x32_bf16 v[120:123], v[80:83], a[188:191], v[120:123]
    v_mfma_f32_16x16x32_bf16 v[124:127], v[84:87], a[188:191], v[124:127]
    v_mfma_f32_16x16x32_bf16 v[128:131], v[88:91], a[176:179], v[128:131]
    s_add_u32 m0, s34, 32768
    s_add_u32 s37, s84, 196608
    buffer_load_dwordx4 v232, s[44:47], s37 offen lds
    v_mfma_f32_16x16x32_bf16 v[132:135], v[92:95], a[176:179], v[132:135]
    buffer_load_dwordx4 v233, s[44:47], s37 offen offset:1024 lds
    v_mfma_f32_16x16x32_bf16 v[136:139], v[88:91], a[180:183], v[136:139]
    v_mfma_f32_16x16x32_bf16 v[140:143], v[92:95], a[180:183], v[140:143]
    s_add_u32 m0, s31, 7168
    s_add_u32 s24, s27, 229376
    buffer_load_dwordx4 v237, s[12:15], s24 offen lds
    v_mfma_f32_16x16x32_bf16 v[144:147], v[88:91], a[184:187], v[144:147]
    s_add_u32 s27, s27, 1048576
    s_and_b32 s27, s27, 0x407fffff
    s_cmp_eq_u32 s27, s7
    s_cselect_b32 s27, s43, s27
    v_mfma_f32_16x16x32_bf16 v[148:151], v[92:95], a[184:187], v[148:151]
    v_mfma_f32_16x16x32_bf16 v[152:155], v[88:91], a[188:191], v[152:155]
    s_add_u32 s31, s31, 32768
    s_cmp_ge_u32 s31, 163840
    s_cselect_b32 s24, 98304, 0
    s_sub_u32 s31, s31, s24
    v_mfma_f32_16x16x32_bf16 v[156:159], v[92:95], a[188:191], v[156:159]
    s_waitcnt lgkmcnt(0)
    v_mfma_f32_16x16x32_bf16 v[96:99], v[64:67], a[192:195], v[96:99]
    ds_read_b128 v[80:83], v225 offset:49152
    v_mfma_f32_16x16x32_bf16 v[100:103], v[68:71], a[192:195], v[100:103]
    ds_read_b128 v[84:87], v225 offset:51200
    v_mfma_f32_16x16x32_bf16 v[104:107], v[64:67], a[196:199], v[104:107]
    ds_read_b128 v[88:91], v225 offset:53248
    v_mfma_f32_16x16x32_bf16 v[108:111], v[68:71], a[196:199], v[108:111]
    ds_read_b128 v[92:95], v225 offset:55296
    v_mfma_f32_16x16x32_bf16 v[112:115], v[64:67], a[200:203], v[112:115]
    v_mfma_f32_16x16x32_bf16 v[116:119], v[68:71], a[200:203], v[116:119]
    v_mfma_f32_16x16x32_bf16 v[120:123], v[64:67], a[204:207], v[120:123]
    s_add_u32 s38, s36, 32768
    buffer_store_dwordx4 v[36:39], v240, s[16:19], s38 offen offset:2304 sc1
    v_mfma_f32_16x16x32_bf16 v[124:127], v[68:71], a[204:207], v[124:127]
    v_mfma_f32_16x16x32_bf16 v[128:131], v[72:75], a[192:195], v[128:131]
    v_mfma_f32_16x16x32_bf16 v[132:135], v[76:79], a[192:195], v[132:135]
    v_mfma_f32_16x16x32_bf16 v[136:139], v[72:75], a[196:199], v[136:139]
    v_mfma_f32_16x16x32_bf16 v[140:143], v[76:79], a[196:199], v[140:143]
    v_mfma_f32_16x16x32_bf16 v[144:147], v[72:75], a[200:203], v[144:147]
    v_mfma_f32_16x16x32_bf16 v[148:151], v[76:79], a[200:203], v[148:151]
    v_mfma_f32_16x16x32_bf16 v[152:155], v[72:75], a[204:207], v[152:155]
    v_mfma_f32_16x16x32_bf16 v[156:159], v[76:79], a[204:207], v[156:159]
    s_waitcnt lgkmcnt(0)
    v_mfma_f32_16x16x32_bf16 v[96:99], v[80:83], a[208:211], v[96:99]
    ds_read_b128 v[64:67], v224 offset:57344
    v_mfma_f32_16x16x32_bf16 v[100:103], v[84:87], a[208:211], v[100:103]
    ds_read_b128 v[68:71], v224 offset:59392
    v_mfma_f32_16x16x32_bf16 v[104:107], v[80:83], a[212:215], v[104:107]
    ds_read_b128 v[72:75], v224 offset:61440
    v_mfma_f32_16x16x32_bf16 v[108:111], v[84:87], a[212:215], v[108:111]
    ds_read_b128 v[76:79], v224 offset:63488
    v_mfma_f32_16x16x32_bf16 v[112:115], v[80:83], a[216:219], v[112:115]
    v_mfma_f32_16x16x32_bf16 v[116:119], v[84:87], a[216:219], v[116:119]
    v_mfma_f32_16x16x32_bf16 v[120:123], v[80:83], a[220:223], v[120:123]
    v_mfma_f32_16x16x32_bf16 v[124:127], v[84:87], a[220:223], v[124:127]
    v_mfma_f32_16x16x32_bf16 v[128:131], v[88:91], a[208:211], v[128:131]
    s_add_u32 m0, s34, 40960
    s_add_u32 s37, s85, 196608
    buffer_load_dwordx4 v232, s[44:47], s37 offen lds
    v_mfma_f32_16x16x32_bf16 v[132:135], v[92:95], a[208:211], v[132:135]
    v_mfma_f32_16x16x32_bf16 v[136:139], v[88:91], a[212:215], v[136:139]
    v_mfma_f32_16x16x32_bf16 v[140:143], v[92:95], a[212:215], v[140:143]
    s_add_u32 s38, s36, 32768
    buffer_store_dwordx4 v[40:43], v240, s[16:19], s38 offen offset:3328 sc1
    v_mfma_f32_16x16x32_bf16 v[144:147], v[88:91], a[216:219], v[144:147]
    buffer_load_dwordx4 v233, s[44:47], s37 offen offset:1024 lds
    v_mfma_f32_16x16x32_bf16 v[148:151], v[92:95], a[216:219], v[148:151]
    v_mfma_f32_16x16x32_bf16 v[152:155], v[88:91], a[220:223], v[152:155]
    v_mfma_f32_16x16x32_bf16 v[156:159], v[92:95], a[220:223], v[156:159]
    s_waitcnt lgkmcnt(0)
    v_mfma_f32_16x16x32_bf16 v[96:99], v[64:67], a[224:227], v[96:99]
    ds_read_b128 v[80:83], v225 offset:57344
    v_mfma_f32_16x16x32_bf16 v[100:103], v[68:71], a[224:227], v[100:103]
    ds_read_b128 v[84:87], v225 offset:59392
    v_mfma_f32_16x16x32_bf16 v[104:107], v[64:67], a[228:231], v[104:107]
    ds_read_b128 v[88:91], v225 offset:61440
    v_mfma_f32_16x16x32_bf16 v[108:111], v[68:71], a[228:231], v[108:111]
    ds_read_b128 v[92:95], v225 offset:63488
    v_mfma_f32_16x16x32_bf16 v[112:115], v[64:67], a[232:235], v[112:115]
    v_mfma_f32_16x16x32_bf16 v[116:119], v[68:71], a[232:235], v[116:119]
    v_mfma_f32_16x16x32_bf16 v[120:123], v[64:67], a[236:239], v[120:123]
    v_mfma_f32_16x16x32_bf16 v[124:127], v[68:71], a[236:239], v[124:127]
    v_mfma_f32_16x16x32_bf16 v[128:131], v[72:75], a[224:227], v[128:131]
    s_add_u32 m0, s31, 0
    s_add_u32 s24, s27, 0
    buffer_load_dwordx4 v245, s[12:15], s24 offen lds
    v_mfma_f32_16x16x32_bf16 v[132:135], v[76:79], a[224:227], v[132:135]
    v_mfma_f32_16x16x32_bf16 v[136:139], v[72:75], a[228:231], v[136:139]
    v_mfma_f32_16x16x32_bf16 v[140:143], v[76:79], a[228:231], v[140:143]
    v_mfma_f32_16x16x32_bf16 v[144:147], v[72:75], a[232:235], v[144:147]
    v_mfma_f32_16x16x32_bf16 v[148:151], v[76:79], a[232:235], v[148:151]
    v_mfma_f32_16x16x32_bf16 v[152:155], v[72:75], a[236:239], v[152:155]
    v_mfma_f32_16x16x32_bf16 v[156:159], v[76:79], a[236:239], v[156:159]
    s_waitcnt vmcnt(23) lgkmcnt(0)
    s_barrier
    v_mfma_f32_16x16x32_bf16 v[96:99], v[80:83], a[240:243], v[96:99]
    ds_read_b128 v[64:67], v224 offset:0
    v_mfma_f32_16x16x32_bf16 v[100:103], v[84:87], a[240:243], v[100:103]
    ds_read_b128 v[68:71], v224 offset:2048
    s_add_u32 s38, s36, 36864
    buffer_store_dwordx4 v[44:47], v240, s[16:19], s38 offen offset:256 sc1
    v_mfma_f32_16x16x32_bf16 v[104:107], v[80:83], a[244:247], v[104:107]
    ds_read_b128 v[72:75], v224 offset:4096
    v_mfma_f32_16x16x32_bf16 v[108:111], v[84:87], a[244:247], v[108:111]
    ds_read_b128 v[76:79], v224 offset:6144
    v_mfma_f32_16x16x32_bf16 v[112:115], v[80:83], a[248:251], v[112:115]
    v_mfma_f32_16x16x32_bf16 v[116:119], v[84:87], a[248:251], v[116:119]
    v_mfma_f32_16x16x32_bf16 v[120:123], v[80:83], a[252:255], v[120:123]
    v_mfma_f32_16x16x32_bf16 v[124:127], v[84:87], a[252:255], v[124:127]
    v_mfma_f32_16x16x32_bf16 v[128:131], v[88:91], a[240:243], v[128:131]
    s_add_u32 m0, s34, 49152
    s_add_u32 s37, s86, 196608
    buffer_load_dwordx4 v232, s[44:47], s37 offen lds
    v_mfma_f32_16x16x32_bf16 v[132:135], v[92:95], a[240:243], v[132:135]
    v_mfma_f32_16x16x32_bf16 v[136:139], v[88:91], a[244:247], v[136:139]
    buffer_load_dwordx4 v233, s[44:47], s37 offen offset:1024 lds
    v_mfma_f32_16x16x32_bf16 v[140:143], v[92:95], a[244:247], v[140:143]
    v_mfma_f32_16x16x32_bf16 v[144:147], v[88:91], a[248:251], v[144:147]
    v_mfma_f32_16x16x32_bf16 v[148:151], v[92:95], a[248:251], v[148:151]
    s_add_u32 m0, s31, 1024
    s_add_u32 s24, s27, 32768
    buffer_load_dwordx4 v245, s[12:15], s24 offen lds
    v_mfma_f32_16x16x32_bf16 v[152:155], v[88:91], a[252:255], v[152:155]
    v_mfma_f32_16x16x32_bf16 v[156:159], v[92:95], a[252:255], v[156:159]
    s_waitcnt lgkmcnt(0)
    v_mfma_f32_16x16x32_bf16 v[160:163], v[64:67], a[0:3], 0
    ds_read_b128 v[80:83], v225 offset:0
    v_mfma_f32_16x16x32_bf16 v[164:167], v[68:71], a[0:3], 0
    ds_read_b128 v[84:87], v225 offset:2048
    v_mfma_f32_16x16x32_bf16 v[168:171], v[64:67], a[4:7], 0
    ds_read_b128 v[88:91], v225 offset:4096
    v_mfma_f32_16x16x32_bf16 v[172:175], v[68:71], a[4:7], 0
    ds_read_b128 v[92:95], v225 offset:6144
    v_mfma_f32_16x16x32_bf16 v[176:179], v[64:67], a[8:11], 0
    v_cvt_pk_bf16_f32 v0, v96, v97
    v_cvt_pk_bf16_f32 v1, v98, v99
    v_mfma_f32_16x16x32_bf16 v[180:183], v[68:71], a[8:11], 0
    v_mfma_f32_16x16x32_bf16 v[184:187], v[64:67], a[12:15], 0
    v_cvt_pk_bf16_f32 v2, v100, v101
    v_cvt_pk_bf16_f32 v3, v102, v103
    s_add_u32 s38, s36, 40960
    buffer_store_dwordx4 v[48:51], v240, s[16:19], s38 offen offset:1280 sc1
    v_mfma_f32_16x16x32_bf16 v[188:191], v[68:71], a[12:15], 0
    v_mfma_f32_16x16x32_bf16 v[192:195], v[72:75], a[0:3], 0
    s_add_u32 m0, s31, 2048
    s_add_u32 s24, s27, 65536
    buffer_load_dwordx4 v237, s[12:15], s24 offen lds
    v_cvt_pk_bf16_f32 v4, v104, v105
    v_cvt_pk_bf16_f32 v5, v106, v107
    v_mfma_f32_16x16x32_bf16 v[196:199], v[76:79], a[0:3], 0
    v_mfma_f32_16x16x32_bf16 v[200:203], v[72:75], a[4:7], 0
    v_cvt_pk_bf16_f32 v6, v108, v109
    v_cvt_pk_bf16_f32 v7, v110, v111
    v_mfma_f32_16x16x32_bf16 v[204:207], v[76:79], a[4:7], 0
    v_mfma_f32_16x16x32_bf16 v[208:211], v[72:75], a[8:11], 0
    v_cvt_pk_bf16_f32 v8, v112, v113
    v_cvt_pk_bf16_f32 v9, v114, v115
    v_mfma_f32_16x16x32_bf16 v[212:215], v[76:79], a[8:11], 0
    v_mfma_f32_16x16x32_bf16 v[216:219], v[72:75], a[12:15], 0
    v_cvt_pk_bf16_f32 v10, v116, v117
    v_cvt_pk_bf16_f32 v11, v118, v119
    v_mfma_f32_16x16x32_bf16 v[220:223], v[76:79], a[12:15], 0
    s_waitcnt lgkmcnt(0)
    v_mfma_f32_16x16x32_bf16 v[160:163], v[80:83], a[16:19], v[160:163]
    ds_read_b128 v[64:67], v224 offset:8192
    v_cvt_pk_bf16_f32 v12, v120, v121
    v_cvt_pk_bf16_f32 v13, v122, v123
    v_mfma_f32_16x16x32_bf16 v[164:167], v[84:87], a[16:19], v[164:167]
    ds_read_b128 v[68:71], v224 offset:10240
    v_mfma_f32_16x16x32_bf16 v[168:171], v[80:83], a[20:23], v[168:171]
    ds_read_b128 v[72:75], v224 offset:12288
    v_cvt_pk_bf16_f32 v14, v124, v125
    v_cvt_pk_bf16_f32 v15, v126, v127
    v_mfma_f32_16x16x32_bf16 v[172:175], v[84:87], a[20:23], v[172:175]
    ds_read_b128 v[76:79], v224 offset:14336
    v_mfma_f32_16x16x32_bf16 v[176:179], v[80:83], a[24:27], v[176:179]
    v_cvt_pk_bf16_f32 v16, v128, v129
    v_cvt_pk_bf16_f32 v17, v130, v131
    v_mfma_f32_16x16x32_bf16 v[180:183], v[84:87], a[24:27], v[180:183]
    v_mfma_f32_16x16x32_bf16 v[184:187], v[80:83], a[28:31], v[184:187]
    v_cvt_pk_bf16_f32 v18, v132, v133
    v_cvt_pk_bf16_f32 v19, v134, v135
    v_mfma_f32_16x16x32_bf16 v[188:191], v[84:87], a[28:31], v[188:191]
    v_mfma_f32_16x16x32_bf16 v[192:195], v[88:91], a[16:19], v[192:195]
    s_add_u32 m0, s34, 57344
    s_add_u32 s37, s87, 196608
    buffer_load_dwordx4 v232, s[44:47], s37 offen lds
    v_cvt_pk_bf16_f32 v20, v136, v137
    v_cvt_pk_bf16_f32 v21, v138, v139
    v_mfma_f32_16x16x32_bf16 v[196:199], v[92:95], a[16:19], v[196:199]
    v_mfma_f32_16x16x32_bf16 v[200:203], v[88:91], a[20:23], v[200:203]
    buffer_load_dwordx4 v233, s[44:47], s37 offen offset:1024 lds
    v_cvt_pk_bf16_f32 v22, v140, v141
    v_cvt_pk_bf16_f32 v23, v142, v143
    v_mfma_f32_16x16x32_bf16 v[204:207], v[92:95], a[20:23], v[204:207]
    v_mfma_f32_16x16x32_bf16 v[208:211], v[88:91], a[24:27], v[208:211]
    v_cvt_pk_bf16_f32 v24, v144, v145
    v_cvt_pk_bf16_f32 v25, v146, v147
    s_add_u32 s38, s36, 40960
    buffer_store_dwordx4 v[52:55], v240, s[16:19], s38 offen offset:2304 sc1
    v_mfma_f32_16x16x32_bf16 v[212:215], v[92:95], a[24:27], v[212:215]
    s_add_u32 m0, s31, 3072
    s_add_u32 s24, s27, 98304
    buffer_load_dwordx4 v237, s[12:15], s24 offen lds
    v_mfma_f32_16x16x32_bf16 v[216:219], v[88:91], a[28:31], v[216:219]
    v_cvt_pk_bf16_f32 v26, v148, v149
    v_cvt_pk_bf16_f32 v27, v150, v151
    v_mfma_f32_16x16x32_bf16 v[220:223], v[92:95], a[28:31], v[220:223]
    s_waitcnt lgkmcnt(0)
    v_mfma_f32_16x16x32_bf16 v[160:163], v[64:67], a[32:35], v[160:163]
    ds_read_b128 v[80:83], v225 offset:8192
    v_cvt_pk_bf16_f32 v28, v152, v153
    v_cvt_pk_bf16_f32 v29, v154, v155
    v_mfma_f32_16x16x32_bf16 v[164:167], v[68:71], a[32:35], v[164:167]
    ds_read_b128 v[84:87], v225 offset:10240
    v_mfma_f32_16x16x32_bf16 v[168:171], v[64:67], a[36:39], v[168:171]
    ds_read_b128 v[88:91], v225 offset:12288
    v_cvt_pk_bf16_f32 v30, v156, v157
    v_cvt_pk_bf16_f32 v31, v158, v159
    v_mfma_f32_16x16x32_bf16 v[172:175], v[68:71], a[36:39], v[172:175]
    ds_read_b128 v[92:95], v225 offset:14336
    v_mfma_f32_16x16x32_bf16 v[176:179], v[64:67], a[40:43], v[176:179]
    v_mfma_f32_16x16x32_bf16 v[180:183], v[68:71], a[40:43], v[180:183]
    v_mfma_f32_16x16x32_bf16 v[184:187], v[64:67], a[44:47], v[184:187]
    v_mfma_f32_16x16x32_bf16 v[188:191], v[68:71], a[44:47], v[188:191]
    v_mfma_f32_16x16x32_bf16 v[192:195], v[72:75], a[32:35], v[192:195]
    s_add_u32 m0, s31, 4096
    s_add_u32 s24, s27, 131072
    buffer_load_dwordx4 v245, s[12:15], s24 offen lds
    v_mfma_f32_16x16x32_bf16 v[196:199], v[76:79], a[32:35], v[196:199]
    v_mfma_f32_16x16x32_bf16 v[200:203], v[72:75], a[36:39], v[200:203]
    v_mfma_f32_16x16x32_bf16 v[204:207], v[76:79], a[36:39], v[204:207]
    v_mfma_f32_16x16x32_bf16 v[208:211], v[72:75], a[40:43], v[208:211]
    v_mfma_f32_16x16x32_bf16 v[212:215], v[76:79], a[40:43], v[212:215]
    v_mfma_f32_16x16x32_bf16 v[216:219], v[72:75], a[44:47], v[216:219]
    v_mfma_f32_16x16x32_bf16 v[220:223], v[76:79], a[44:47], v[220:223]
    s_waitcnt vmcnt(23) lgkmcnt(0)
    s_barrier
    v_mfma_f32_16x16x32_bf16 v[160:163], v[80:83], a[48:51], v[160:163]
    ds_read_b128 v[64:67], v224 offset:16384
    v_mfma_f32_16x16x32_bf16 v[164:167], v[84:87], a[48:51], v[164:167]
    ds_read_b128 v[68:71], v224 offset:18432
    s_add_u32 s38, s36, 40960
    buffer_store_dwordx4 v[56:59], v240, s[16:19], s38 offen offset:3328 sc1
    v_mfma_f32_16x16x32_bf16 v[168:171], v[80:83], a[52:55], v[168:171]
    ds_read_b128 v[72:75], v224 offset:20480
    v_mfma_f32_16x16x32_bf16 v[172:175], v[84:87], a[52:55], v[172:175]
    ds_read_b128 v[76:79], v224 offset:22528
    v_mfma_f32_16x16x32_bf16 v[176:179], v[80:83], a[56:59], v[176:179]
    v_mfma_f32_16x16x32_bf16 v[180:183], v[84:87], a[56:59], v[180:183]
    v_mfma_f32_16x16x32_bf16 v[184:187], v[80:83], a[60:63], v[184:187]
    v_mfma_f32_16x16x32_bf16 v[188:191], v[84:87], a[60:63], v[188:191]
    v_mfma_f32_16x16x32_bf16 v[192:195], v[88:91], a[48:51], v[192:195]
    s_add_u32 m0, s31, 5120
    s_add_u32 s24, s27, 163840
    buffer_load_dwordx4 v245, s[12:15], s24 offen lds
    v_mfma_f32_16x16x32_bf16 v[196:199], v[92:95], a[48:51], v[196:199]
    v_mfma_f32_16x16x32_bf16 v[200:203], v[88:91], a[52:55], v[200:203]
    v_mfma_f32_16x16x32_bf16 v[204:207], v[92:95], a[52:55], v[204:207]
    v_mfma_f32_16x16x32_bf16 v[208:211], v[88:91], a[56:59], v[208:211]
    v_mfma_f32_16x16x32_bf16 v[212:215], v[92:95], a[56:59], v[212:215]
    v_mfma_f32_16x16x32_bf16 v[216:219], v[88:91], a[60:63], v[216:219]
    v_mfma_f32_16x16x32_bf16 v[220:223], v[92:95], a[60:63], v[220:223]
    s_waitcnt lgkmcnt(0)
    v_mfma_f32_16x16x32_bf16 v[160:163], v[64:67], a[64:67], v[160:163]
    ds_read_b128 v[80:83], v225 offset:16384
    v_mfma_f32_16x16x32_bf16 v[164:167], v[68:71], a[64:67], v[164:167]
    ds_read_b128 v[84:87], v225 offset:18432
    v_mfma_f32_16x16x32_bf16 v[168:171], v[64:67], a[68:71], v[168:171]
    ds_read_b128 v[88:91], v225 offset:20480
    v_mfma_f32_16x16x32_bf16 v[172:175], v[68:71], a[68:71], v[172:175]
    ds_read_b128 v[92:95], v225 offset:22528
    v_mfma_f32_16x16x32_bf16 v[176:179], v[64:67], a[72:75], v[176:179]
    v_mfma_f32_16x16x32_bf16 v[180:183], v[68:71], a[72:75], v[180:183]
    v_mfma_f32_16x16x32_bf16 v[184:187], v[64:67], a[76:79], v[184:187]
    v_mfma_f32_16x16x32_bf16 v[188:191], v[68:71], a[76:79], v[188:191]
    s_add_u32 s38, s36, 45056
    buffer_store_dwordx4 v[60:63], v240, s[16:19], s38 offen offset:256 sc1
    v_mfma_f32_16x16x32_bf16 v[192:195], v[72:75], a[64:67], v[192:195]
    s_add_u32 m0, s31, 6144
    s_add_u32 s24, s27, 196608
    buffer_load_dwordx4 v237, s[12:15], s24 offen lds
    v_mfma_f32_16x16x32_bf16 v[196:199], v[76:79], a[64:67], v[196:199]
    v_mfma_f32_16x16x32_bf16 v[200:203], v[72:75], a[68:71], v[200:203]
    v_mfma_f32_16x16x32_bf16 v[204:207], v[76:79], a[68:71], v[204:207]
    v_mfma_f32_16x16x32_bf16 v[208:211], v[72:75], a[72:75], v[208:211]
    v_mfma_f32_16x16x32_bf16 v[212:215], v[76:79], a[72:75], v[212:215]
    v_mfma_f32_16x16x32_bf16 v[216:219], v[72:75], a[76:79], v[216:219]
    v_mfma_f32_16x16x32_bf16 v[220:223], v[76:79], a[76:79], v[220:223]
    s_waitcnt lgkmcnt(0)
    v_mfma_f32_16x16x32_bf16 v[160:163], v[80:83], a[80:83], v[160:163]
    ds_read_b128 v[64:67], v224 offset:24576
    v_mfma_f32_16x16x32_bf16 v[164:167], v[84:87], a[80:83], v[164:167]
    ds_read_b128 v[68:71], v224 offset:26624
    v_mfma_f32_16x16x32_bf16 v[168:171], v[80:83], a[84:87], v[168:171]
    ds_read_b128 v[72:75], v224 offset:28672
    v_mfma_f32_16x16x32_bf16 v[172:175], v[84:87], a[84:87], v[172:175]
    ds_read_b128 v[76:79], v224 offset:30720
    v_mfma_f32_16x16x32_bf16 v[176:179], v[80:83], a[88:91], v[176:179]
    v_mfma_f32_16x16x32_bf16 v[180:183], v[84:87], a[88:91], v[180:183]
    v_mfma_f32_16x16x32_bf16 v[184:187], v[80:83], a[92:95], v[184:187]
    v_mfma_f32_16x16x32_bf16 v[188:191], v[84:87], a[92:95], v[188:191]
    v_mfma_f32_16x16x32_bf16 v[192:195], v[88:91], a[80:83], v[192:195]
    s_add_u32 m0, s31, 7168
    s_add_u32 s24, s27, 229376
    buffer_load_dwordx4 v237, s[12:15], s24 offen lds
    v_mfma_f32_16x16x32_bf16 v[196:199], v[92:95], a[80:83], v[196:199]
    v_mfma_f32_16x16x32_bf16 v[200:203], v[88:91], a[84:87], v[200:203]
    s_add_u32 s27, s27, 1048576
    s_and_b32 s27, s27, 0x407fffff
    s_cmp_eq_u32 s27, s7
    s_cselect_b32 s27, s43, s27
    v_mfma_f32_16x16x32_bf16 v[204:207], v[92:95], a[84:87], v[204:207]
    v_mfma_f32_16x16x32_bf16 v[208:211], v[88:91], a[88:91], v[208:211]
    v_mfma_f32_16x16x32_bf16 v[212:215], v[92:95], a[88:91], v[212:215]
    s_add_u32 s31, s31, 32768
    s_cmp_ge_u32 s31, 163840
    s_cselect_b32 s24, 98304, 0
    s_sub_u32 s31, s31, s24
    s_add_u32 s38, s36, 65536
    buffer_store_dwordx4 v[0:3], v240, s[16:19], s38 offen offset:2560 sc1
    v_mfma_f32_16x16x32_bf16 v[216:219], v[88:91], a[92:95], v[216:219]
    v_mfma_f32_16x16x32_bf16 v[220:223], v[92:95], a[92:95], v[220:223]
    s_waitcnt lgkmcnt(0)
    v_mfma_f32_16x16x32_bf16 v[160:163], v[64:67], a[96:99], v[160:163]
    ds_read_b128 v[80:83], v225 offset:24576
    v_mfma_f32_16x16x32_bf16 v[164:167], v[68:71], a[96:99], v[164:167]
    ds_read_b128 v[84:87], v225 offset:26624
    v_mfma_f32_16x16x32_bf16 v[168:171], v[64:67], a[100:103], v[168:171]
    ds_read_b128 v[88:91], v225 offset:28672
    v_mfma_f32_16x16x32_bf16 v[172:175], v[68:71], a[100:103], v[172:175]
    ds_read_b128 v[92:95], v225 offset:30720
    v_mfma_f32_16x16x32_bf16 v[176:179], v[64:67], a[104:107], v[176:179]
    v_mfma_f32_16x16x32_bf16 v[180:183], v[68:71], a[104:107], v[180:183]
    v_mfma_f32_16x16x32_bf16 v[184:187], v[64:67], a[108:111], v[184:187]
    v_mfma_f32_16x16x32_bf16 v[188:191], v[68:71], a[108:111], v[188:191]
    v_mfma_f32_16x16x32_bf16 v[192:195], v[72:75], a[96:99], v[192:195]
    v_mfma_f32_16x16x32_bf16 v[196:199], v[76:79], a[96:99], v[196:199]
    v_mfma_f32_16x16x32_bf16 v[200:203], v[72:75], a[100:103], v[200:203]
    v_mfma_f32_16x16x32_bf16 v[204:207], v[76:79], a[100:103], v[204:207]
    v_mfma_f32_16x16x32_bf16 v[208:211], v[72:75], a[104:107], v[208:211]
    v_mfma_f32_16x16x32_bf16 v[212:215], v[76:79], a[104:107], v[212:215]
    v_mfma_f32_16x16x32_bf16 v[216:219], v[72:75], a[108:111], v[216:219]
    v_mfma_f32_16x16x32_bf16 v[220:223], v[76:79], a[108:111], v[220:223]
    s_waitcnt vmcnt(9) lgkmcnt(0)
    s_barrier
    v_mfma_f32_16x16x32_bf16 v[160:163], v[80:83], a[112:115], v[160:163]
    ds_read_b128 v[64:67], v224 offset:32768
    v_mfma_f32_16x16x32_bf16 v[164:167], v[84:87], a[112:115], v[164:167]
    ds_read_b128 v[68:71], v224 offset:34816
    v_mfma_f32_16x16x32_bf16 v[168:171], v[80:83], a[116:119], v[168:171]
    ds_read_b128 v[72:75], v224 offset:36864
    s_add_u32 s38, s36, 65536
    buffer_store_dwordx4 v[4:7], v240, s[16:19], s38 offen offset:3584 sc1
    v_mfma_f32_16x16x32_bf16 v[172:175], v[84:87], a[116:119], v[172:175]
    ds_read_b128 v[76:79], v224 offset:38912
    v_mfma_f32_16x16x32_bf16 v[176:179], v[80:83], a[120:123], v[176:179]
    v_mfma_f32_16x16x32_bf16 v[180:183], v[84:87], a[120:123], v[180:183]
    v_mfma_f32_16x16x32_bf16 v[184:187], v[80:83], a[124:127], v[184:187]
    v_mfma_f32_16x16x32_bf16 v[188:191], v[84:87], a[124:127], v[188:191]
    v_mfma_f32_16x16x32_bf16 v[192:195], v[88:91], a[112:115], v[192:195]
    v_mfma_f32_16x16x32_bf16 v[196:199], v[92:95], a[112:115], v[196:199]
    v_mfma_f32_16x16x32_bf16 v[200:203], v[88:91], a[116:119], v[200:203]
    v_mfma_f32_16x16x32_bf16 v[204:207], v[92:95], a[116:119], v[204:207]
    v_mfma_f32_16x16x32_bf16 v[208:211], v[88:91], a[120:123], v[208:211]
    v_mfma_f32_16x16x32_bf16 v[212:215], v[92:95], a[120:123], v[212:215]
    v_mfma_f32_16x16x32_bf16 v[216:219], v[88:91], a[124:127], v[216:219]
    v_mfma_f32_16x16x32_bf16 v[220:223], v[92:95], a[124:127], v[220:223]
    s_waitcnt lgkmcnt(0)
    v_mfma_f32_16x16x32_bf16 v[160:163], v[64:67], a[128:131], v[160:163]
    ds_read_b128 v[80:83], v225 offset:32768
    v_mfma_f32_16x16x32_bf16 v[164:167], v[68:71], a[128:131], v[164:167]
    ds_read_b128 v[84:87], v225 offset:34816
    v_mfma_f32_16x16x32_bf16 v[168:171], v[64:67], a[132:135], v[168:171]
    ds_read_b128 v[88:91], v225 offset:36864
    v_mfma_f32_16x16x32_bf16 v[172:175], v[68:71], a[132:135], v[172:175]
    ds_read_b128 v[92:95], v225 offset:38912
    v_mfma_f32_16x16x32_bf16 v[176:179], v[64:67], a[136:139], v[176:179]
    v_mfma_f32_16x16x32_bf16 v[180:183], v[68:71], a[136:139], v[180:183]
    v_mfma_f32_16x16x32_bf16 v[184:187], v[64:67], a[140:143], v[184:187]
    v_mfma_f32_16x16x32_bf16 v[188:191], v[68:71], a[140:143], v[188:191]
    v_mfma_f32_16x16x32_bf16 v[192:195], v[72:75], a[128:131], v[192:195]
    buffer_load_dword v254, off, s[88:91], s39 sc1
    s_add_u32 s38, s36, 69632
    buffer_store_dwordx4 v[8:11], v240, s[16:19], s38 offen offset:512 sc1
    v_mfma_f32_16x16x32_bf16 v[196:199], v[76:79], a[128:131], v[196:199]
    v_mfma_f32_16x16x32_bf16 v[200:203], v[72:75], a[132:135], v[200:203]
    v_mfma_f32_16x16x32_bf16 v[204:207], v[76:79], a[132:135], v[204:207]
    v_mfma_f32_16x16x32_bf16 v[208:211], v[72:75], a[136:139], v[208:211]
    v_mfma_f32_16x16x32_bf16 v[212:215], v[76:79], a[136:139], v[212:215]
    v_mfma_f32_16x16x32_bf16 v[216:219], v[72:75], a[140:143], v[216:219]
    v_mfma_f32_16x16x32_bf16 v[220:223], v[76:79], a[140:143], v[220:223]
    s_waitcnt lgkmcnt(0)
    v_mfma_f32_16x16x32_bf16 v[160:163], v[80:83], a[144:147], v[160:163]
    ds_read_b128 v[64:67], v224 offset:40960
    v_mfma_f32_16x16x32_bf16 v[164:167], v[84:87], a[144:147], v[164:167]
    ds_read_b128 v[68:71], v224 offset:43008
    v_mfma_f32_16x16x32_bf16 v[168:171], v[80:83], a[148:151], v[168:171]
    ds_read_b128 v[72:75], v224 offset:45056
    v_mfma_f32_16x16x32_bf16 v[172:175], v[84:87], a[148:151], v[172:175]
    ds_read_b128 v[76:79], v224 offset:47104
    v_mfma_f32_16x16x32_bf16 v[176:179], v[80:83], a[152:155], v[176:179]
    v_mfma_f32_16x16x32_bf16 v[180:183], v[84:87], a[152:155], v[180:183]
    v_mfma_f32_16x16x32_bf16 v[184:187], v[80:83], a[156:159], v[184:187]
    v_mfma_f32_16x16x32_bf16 v[188:191], v[84:87], a[156:159], v[188:191]
    v_mfma_f32_16x16x32_bf16 v[192:195], v[88:91], a[144:147], v[192:195]
    v_mfma_f32_16x16x32_bf16 v[196:199], v[92:95], a[144:147], v[196:199]
    v_mfma_f32_16x16x32_bf16 v[200:203], v[88:91], a[148:151], v[200:203]
    v_mfma_f32_16x16x32_bf16 v[204:207], v[92:95], a[148:151], v[204:207]
    v_mfma_f32_16x16x32_bf16 v[208:211], v[88:91], a[152:155], v[208:211]
    v_mfma_f32_16x16x32_bf16 v[212:215], v[92:95], a[152:155], v[212:215]
    s_add_u32 s38, s36, 69632
    buffer_store_dwordx4 v[12:15], v240, s[16:19], s38 offen offset:1536 sc1
    v_mfma_f32_16x16x32_bf16 v[216:219], v[88:91], a[156:159], v[216:219]
    v_mfma_f32_16x16x32_bf16 v[220:223], v[92:95], a[156:159], v[220:223]
    s_waitcnt lgkmcnt(0)
    v_mfma_f32_16x16x32_bf16 v[160:163], v[64:67], a[160:163], v[160:163]
    ds_read_b128 v[80:83], v225 offset:40960
    v_mfma_f32_16x16x32_bf16 v[164:167], v[68:71], a[160:163], v[164:167]
    ds_read_b128 v[84:87], v225 offset:43008
    v_mfma_f32_16x16x32_bf16 v[168:171], v[64:67], a[164:167], v[168:171]
    ds_read_b128 v[88:91], v225 offset:45056
    v_mfma_f32_16x16x32_bf16 v[172:175], v[68:71], a[164:167], v[172:175]
    ds_read_b128 v[92:95], v225 offset:47104
    v_mfma_f32_16x16x32_bf16 v[176:179], v[64:67], a[168:171], v[176:179]
    v_mfma_f32_16x16x32_bf16 v[180:183], v[68:71], a[168:171], v[180:183]
    v_mfma_f32_16x16x32_bf16 v[184:187], v[64:67], a[172:175], v[184:187]
    v_mfma_f32_16x16x32_bf16 v[188:191], v[68:71], a[172:175], v[188:191]
    v_mfma_f32_16x16x32_bf16 v[192:195], v[72:75], a[160:163], v[192:195]
    v_mfma_f32_16x16x32_bf16 v[196:199], v[76:79], a[160:163], v[196:199]
    v_mfma_f32_16x16x32_bf16 v[200:203], v[72:75], a[164:167], v[200:203]
    v_mfma_f32_16x16x32_bf16 v[204:207], v[76:79], a[164:167], v[204:207]
    v_mfma_f32_16x16x32_bf16 v[208:211], v[72:75], a[168:171], v[208:211]
    v_mfma_f32_16x16x32_bf16 v[212:215], v[76:79], a[168:171], v[212:215]
    v_mfma_f32_16x16x32_bf16 v[216:219], v[72:75], a[172:175], v[216:219]
    v_mfma_f32_16x16x32_bf16 v[220:223], v[76:79], a[172:175], v[220:223]
    s_waitcnt lgkmcnt(0)
    v_mfma_f32_16x16x32_bf16 v[160:163], v[80:83], a[176:179], v[160:163]
    ds_read_b128 v[64:67], v224 offset:49152
    v_mfma_f32_16x16x32_bf16 v[164:167], v[84:87], a[176:179], v[164:167]
    ds_read_b128 v[68:71], v224 offset:51200
    v_mfma_f32_16x16x32_bf16 v[168:171], v[80:83], a[180:183], v[168:171]
    ds_read_b128 v[72:75], v224 offset:53248
    v_mfma_f32_16x16x32_bf16 v[172:175], v[84:87], a[180:183], v[172:175]
    ds_read_b128 v[76:79], v224 offset:55296
    s_add_u32 s38, s36, 73728
    buffer_store_dwordx4 v[16:19], v240, s[16:19], s38 offen offset:2560 sc1
    v_mfma_f32_16x16x32_bf16 v[176:179], v[80:83], a[184:187], v[176:179]
    v_mfma_f32_16x16x32_bf16 v[180:183], v[84:87], a[184:187], v[180:183]
    v_mfma_f32_16x16x32_bf16 v[184:187], v[80:83], a[188:191], v[184:187]
    v_mfma_f32_16x16x32_bf16 v[188:191], v[84:87], a[188:191], v[188:191]
    v_mfma_f32_16x16x32_bf16 v[192:195], v[88:91], a[176:179], v[192:195]
    v_mfma_f32_16x16x32_bf16 v[196:199], v[92:95], a[176:179], v[196:199]
    v_mfma_f32_16x16x32_bf16 v[200:203], v[88:91], a[180:183], v[200:203]
    v_mfma_f32_16x16x32_bf16 v[204:207], v[92:95], a[180:183], v[204:207]
    v_mfma_f32_16x16x32_bf16 v[208:211], v[88:91], a[184:187], v[208:211]
    v_mfma_f32_16x16x32_bf16 v[212:215], v[92:95], a[184:187], v[212:215]
    v_mfma_f32_16x16x32_bf16 v[216:219], v[88:91], a[188:191], v[216:219]
    v_mfma_f32_16x16x32_bf16 v[220:223], v[92:95], a[188:191], v[220:223]
    s_waitcnt vmcnt(3)
    v_readfirstlane_b32 s24, v254
    s_lshl_b32 s25, s3, 16
    s_add_u32 s24, s24, s25
    s_cmp_ge_u32 s24, 32
    s_cbranch_scc0 kf_spin37
kf_spinr38:
    s_waitcnt lgkmcnt(0)
    s_barrier
    v_mfma_f32_16x16x32_bf16 v[160:163], v[64:67], a[192:195], v[160:163]
    ds_read_b128 v[80:83], v225 offset:49152
    v_mfma_f32_16x16x32_bf16 v[164:167], v[68:71], a[192:195], v[164:167]
    ds_read_b128 v[84:87], v225 offset:51200
    v_mfma_f32_16x16x32_bf16 v[168:171], v[64:67], a[196:199], v[168:171]
    ds_read_b128 v[88:91], v225 offset:53248
    v_mfma_f32_16x16x32_bf16 v[172:175], v[68:71], a[196:199], v[172:175]
    ds_read_b128 v[92:95], v225 offset:55296
    v_mfma_f32_16x16x32_bf16 v[176:179], v[64:67], a[200:203], v[176:179]
    v_mfma_f32_16x16x32_bf16 v[180:183], v[68:71], a[200:203], v[180:183]
    v_mfma_f32_16x16x32_bf16 v[184:187], v[64:67], a[204:207], v[184:187]
    v_mfma_f32_16x16x32_bf16 v[188:191], v[68:71], a[204:207], v[188:191]
    v_mfma_f32_16x16x32_bf16 v[192:195], v[72:75], a[192:195], v[192:195]
    buffer_load_dwordx4 a[128:131], v248, s[8:11], s28 offen offset:0 sc1
    s_add_u32 s38, s36, 73728
    buffer_store_dwordx4 v[20:23], v240, s[16:19], s38 offen offset:3584 sc1
    v_mfma_f32_16x16x32_bf16 v[196:199], v[76:79], a[192:195], v[196:199]
    v_mfma_f32_16x16x32_bf16 v[200:203], v[72:75], a[196:199], v[200:203]
    buffer_load_dwordx4 a[132:135], v248, s[8:11], s29 offen offset:0 sc1
    v_mfma_f32_16x16x32_bf16 v[204:207], v[76:79], a[196:199], v[204:207]
    v_mfma_f32_16x16x32_bf16 v[208:211], v[72:75], a[200:203], v[208:211]
    v_mfma_f32_16x16x32_bf16 v[212:215], v[76:79], a[200:203], v[212:215]
    buffer_load_dwordx4 a[136:139], v249, s[8:11], s28 offen offset:0 sc1
    v_mfma_f32_16x16x32_bf16 v[216:219], v[72:75], a[204:207], v[216:219]
    v_mfma_f32_16x16x32_bf16 v[220:223], v[76:79], a[204:207], v[220:223]
    s_waitcnt lgkmcnt(0)
    v_mfma_f32_16x16x32_bf16 v[160:163], v[80:83], a[208:211], v[160:163]
    ds_read_b128 v[64:67], v224 offset:57344
    v_mfma_f32_16x16x32_bf16 v[164:167], v[84:87], a[208:211], v[164:167]
    ds_read_b128 v[68:71], v224 offset:59392
    v_mfma_f32_16x16x32_bf16 v[168:171], v[80:83], a[212:215], v[168:171]
    ds_read_b128 v[72:75], v224 offset:61440
    v_mfma_f32_16x16x32_bf16 v[172:175], v[84:87], a[212:215], v[172:175]
    ds_read_b128 v[76:79], v224 offset:63488
    v_mfma_f32_16x16x32_bf16 v[176:179], v[80:83], a[216:219], v[176:179]
    v_mfma_f32_16x16x32_bf16 v[180:183], v[84:87], a[216:219], v[180:183]
    v_mfma_f32_16x16x32_bf16 v[184:187], v[80:83], a[220:223], v[184:187]
    v_mfma_f32_16x16x32_bf16 v[188:191], v[84:87], a[220:223], v[188:191]
    v_mfma_f32_16x16x32_bf16 v[192:195], v[88:91], a[208:211], v[192:195]
    buffer_load_dwordx4 a[140:143], v249, s[8:11], s29 offen offset:0 sc1
    v_mfma_f32_16x16x32_bf16 v[196:199], v[92:95], a[208:211], v[196:199]
    v_mfma_f32_16x16x32_bf16 v[200:203], v[88:91], a[212:215], v[200:203]
    buffer_load_dwordx4 a[144:147], v248, s[8:11], s28 offen offset:1024 sc1
    v_mfma_f32_16x16x32_bf16 v[204:207], v[92:95], a[212:215], v[204:207]
    v_mfma_f32_16x16x32_bf16 v[208:211], v[88:91], a[216:219], v[208:211]
    v_mfma_f32_16x16x32_bf16 v[212:215], v[92:95], a[216:219], v[212:215]
    buffer_load_dwordx4 a[148:151], v248, s[8:11], s29 offen offset:1024 sc1
    v_mfma_f32_16x16x32_bf16 v[216:219], v[88:91], a[220:223], v[216:219]
    s_add_u32 s38, s36, 77824
    buffer_store_dwordx4 v[24:27], v240, s[16:19], s38 offen offset:512 sc1
    v_mfma_f32_16x16x32_bf16 v[220:223], v[92:95], a[220:223], v[220:223]
    s_waitcnt lgkmcnt(0)
    v_mfma_f32_16x16x32_bf16 v[160:163], v[64:67], a[224:227], v[160:163]
    ds_read_b128 v[80:83], v225 offset:57344
    v_mfma_f32_16x16x32_bf16 v[164:167], v[68:71], a[224:227], v[164:167]
    ds_read_b128 v[84:87], v225 offset:59392
    v_mfma_f32_16x16x32_bf16 v[168:171], v[64:67], a[228:231], v[168:171]
    ds_read_b128 v[88:91], v225 offset:61440
    v_mfma_f32_16x16x32_bf16 v[172:175], v[68:71], a[228:231], v[172:175]
    ds_read_b128 v[92:95], v225 offset:63488
    v_mfma_f32_16x16x32_bf16 v[176:179], v[64:67], a[232:235], v[176:179]
    v_mfma_f32_16x16x32_bf16 v[180:183], v[68:71], a[232:235], v[180:183]
    v_mfma_f32_16x16x32_bf16 v[184:187], v[64:67], a[236:239], v[184:187]
    v_mfma_f32_16x16x32_bf16 v[188:191], v[68:71], a[236:239], v[188:191]
    v_mfma_f32_16x16x32_bf16 v[192:195], v[72:75], a[224:227], v[192:195]
    buffer_load_dwordx4 a[152:155], v249, s[8:11], s28 offen offset:1024 sc1
    v_mfma_f32_16x16x32_bf16 v[196:199], v[76:79], a[224:227], v[196:199]
    v_mfma_f32_16x16x32_bf16 v[200:203], v[72:75], a[228:231], v[200:203]
    buffer_load_dwordx4 a[156:159], v249, s[8:11], s29 offen offset:1024 sc1
    v_mfma_f32_16x16x32_bf16 v[204:207], v[76:79], a[228:231], v[204:207]
    v_mfma_f32_16x16x32_bf16 v[208:211], v[72:75], a[232:235], v[208:211]
    v_mfma_f32_16x16x32_bf16 v[212:215], v[76:79], a[232:235], v[212:215]
    buffer_load_dwordx4 a[160:163], v248, s[8:11], s28 offen offset:2048 sc1
    v_mfma_f32_16x16x32_bf16 v[216:219], v[72:75], a[236:239], v[216:219]
    v_mfma_f32_16x16x32_bf16 v[220:223], v[76:79], a[236:239], v[220:223]
    s_waitcnt vmcnt(38) lgkmcnt(0)
    s_barrier
    v_mfma_f32_16x16x32_bf16 v[160:163], v[80:83], a[240:243], v[160:163]
    ds_read_b64_tr_b16 a[192:193], v246 offset:0
    v_mfma_f32_16x16x32_bf16 v[164:167], v[84:87], a[240:243], v[164:167]
    ds_read_b64_tr_b16 a[194:195], v246 offset:1024
    v_mfma_f32_16x16x32_bf16 v[168:171], v[80:83], a[244:247], v[168:171]
    ds_read_b64_tr_b16 a[196:197], v238 offset:0
    v_mfma_f32_16x16x32_bf16 v[172:175], v[84:87], a[244:247], v[172:175]
    ds_read_b64_tr_b16 a[198:199], v238 offset:1024
    v_mfma_f32_16x16x32_bf16 v[176:179], v[80:83], a[248:251], v[176:179]
    ds_read_b64_tr_b16 a[200:201], v246 offset:256
    s_add_u32 s38, s36, 77824
    buffer_store_dwordx4 v[28:31], v240, s[16:19], s38 offen offset:1536 sc1
    v_mfma_f32_16x16x32_bf16 v[180:183], v[84:87], a[248:251], v[180:183]
    ds_read_b64_tr_b16 a[202:203], v246 offset:1280
    v_mfma_f32_16x16x32_bf16 v[184:187], v[80:83], a[252:255], v[184:187]
    ds_read_b64_tr_b16 a[204:205], v238 offset:256
    v_mfma_f32_16x16x32_bf16 v[188:191], v[84:87], a[252:255], v[188:191]
    ds_read_b64_tr_b16 a[206:207], v238 offset:1280
    v_mfma_f32_16x16x32_bf16 v[192:195], v[88:91], a[240:243], v[192:195]
    buffer_load_dwordx4 a[164:167], v248, s[8:11], s29 offen offset:2048 sc1
    v_mfma_f32_16x16x32_bf16 v[196:199], v[92:95], a[240:243], v[196:199]
    v_cvt_pk_bf16_f32 v32, v160, v161
    v_cvt_pk_bf16_f32 v33, v162, v163
    v_mfma_f32_16x16x32_bf16 v[200:203], v[88:91], a[244:247], v[200:203]
    buffer_load_dwordx4 a[168:171], v249, s[8:11], s28 offen offset:2048 sc1
    v_cvt_pk_bf16_f32 v34, v164, v165
    v_cvt_pk_bf16_f32 v35, v166, v167
    v_mfma_f32_16x16x32_bf16 v[204:207], v[92:95], a[244:247], v[204:207]
    v_cvt_pk_bf16_f32 v36, v168, v169
    v_cvt_pk_bf16_f32 v37, v170, v171
    v_mfma_f32_16x16x32_bf16 v[208:211], v[88:91], a[248:251], v[208:211]
    v_cvt_pk_bf16_f32 v38, v172, v173
    v_cvt_pk_bf16_f32 v39, v174, v175
    v_mfma_f32_16x16x32_bf16 v[212:215], v[92:95], a[248:251], v[212:215]
    buffer_load_dwordx4 a[172:175], v249, s[8:11], s29 offen offset:2048 sc1
    v_cvt_pk_bf16_f32 v40, v176, v177
    v_cvt_pk_bf16_f32 v41, v178, v179
    v_mfma_f32_16x16x32_bf16 v[216:219], v[88:91], a[252:255], v[216:219]
    v_cvt_pk_bf16_f32 v42, v180, v181
    v_cvt_pk_bf16_f32 v43, v182, v183
    v_mfma_f32_16x16x32_bf16 v[220:223], v[92:95], a[252:255], v[220:223]
    v_cvt_pk_bf16_f32 v44, v184, v185
    v_cvt_pk_bf16_f32 v45, v186, v187
    s_nop 3
    v_cvt_pk_bf16_f32 v46, v188, v189
    v_cvt_pk_bf16_f32 v47, v190, v191
    v_cvt_pk_bf16_f32 v48, v192, v193
    v_cvt_pk_bf16_f32 v49, v194, v195
    v_cvt_pk_bf16_f32 v50, v196, v197
    v_cvt_pk_bf16_f32 v51, v198, v199
    v_cvt_pk_bf16_f32 v52, v200, v201
    v_cvt_pk_bf16_f32 v53, v202, v203
    v_cvt_pk_bf16_f32 v54, v204, v205
    v_cvt_pk_bf16_f32 v55, v206, v207
    v_cvt_pk_bf16_f32 v56, v208, v209
    v_cvt_pk_bf16_f32 v57, v210, v211
    v_cvt_pk_bf16_f32 v58, v212, v213
    v_cvt_pk_bf16_f32 v59, v214, v215
    v_cvt_pk_bf16_f32 v60, v216, v217
    v_cvt_pk_bf16_f32 v61, v218, v219
    v_cvt_pk_bf16_f32 v62, v220, v221
    v_cvt_pk_bf16_f32 v63, v222, v223
    s_add_u32 s80, s36, 102144
    s_add_u32 s81, s36, 103168
    s_add_u32 s82, s36, 104192
    s_add_u32 s83, s36, 105216
    s_add_u32 s84, s36, 110336
    s_add_u32 s85, s36, 111360
    s_add_u32 s86, s36, 112384
    s_add_u32 s87, s36, 113408
ka_Q:
    s_waitcnt vmcnt(10) lgkmcnt(0)
    v_mfma_f32_16x16x32_bf16 v[96:99], a[192:195], a[128:131], 0
    ds_read_b64_tr_b16 a[208:209], v246 offset:512
    s_lshl_b32 s97, s4, 7
    v_mfma_f32_16x16x32_bf16 v[100:103], a[192:195], a[132:135], 0
    ds_read_b64_tr_b16 a[210:211], v246 offset:1536
    s_add_u32 s97, s97, 12288
    s_cmp_eq_u32 s3, 0
    s_cselect_b32 s35, s97, s43
    v_mfma_f32_16x16x32_bf16 v[104:107], a[192:195], a[136:139], 0
    ds_read_b64_tr_b16 a[212:213], v238 offset:512
    s_lshl_b32 s37, s3, 12
    v_mfma_f32_16x16x32_bf16 v[108:111], a[192:195], a[140:143], 0
    ds_read_b64_tr_b16 a[214:215], v238 offset:1536
    s_mov_b32 s34, s37
    s_mul_i32 s32, s4, 1089536
    v_mfma_f32_16x16x32_bf16 v[112:115], a[196:199], a[128:131], 0
    ds_read_b64_tr_b16 a[216:217], v246 offset:768
    s_mov_b32 s33, 0
    v_mfma_f32_16x16x32_bf16 v[116:119], a[196:199], a[132:135], 0
    ds_read_b64_tr_b16 a[218:219], v246 offset:1792
    s_lshl_b32 s39, s6, 18
    v_mfma_f32_16x16x32_bf16 v[120:123], a[196:199], a[136:139], 0
    ds_read_b64_tr_b16 a[220:221], v238 offset:768
    s_sub_u32 s25, 63, s6
    s_lshl_b32 s40, s25, 18
    v_mfma_f32_16x16x32_bf16 v[124:127], a[196:199], a[140:143], 0
    ds_read_b64_tr_b16 a[222:223], v238 offset:1792
    s_lshl_b32 s25, s4, 12
    v_mfma_f32_16x16x32_bf16 v[128:131], a[200:203], a[128:131], 0
    buffer_load_dwordx4 a[176:179], v248, s[8:11], s28 offen offset:3072 sc1
    s_add_u32 s39, s39, s25
    s_add_u32 s40, s40, s25
    v_mfma_f32_16x16x32_bf16 v[132:135], a[200:203], a[132:135], 0
    s_mov_b32 s38, 0x40004000
    s_mov_b32 s36, s6
    v_mfma_f32_16x16x32_bf16 v[136:139], a[200:203], a[136:139], 0
    buffer_load_dwordx4 a[180:183], v248, s[8:11], s29 offen offset:3072 sc1
    s_mov_b32 s26, 6
    v_mfma_f32_16x16x32_bf16 v[140:143], a[200:203], a[140:143], 0
    s_add_u32 m0, s31, 0
    s_add_u32 s24, s27, 0
    s_mov_b32 s52, s41
    v_mfma_f32_16x16x32_bf16 v[144:147], a[204:207], a[128:131], 0
    buffer_load_dwordx4 v245, s[12:15], s24 offen lds
    s_mov_b32 s53, s42
    v_mfma_f32_16x16x32_bf16 v[148:151], a[204:207], a[132:135], 0
    s_mov_b32 s54, 0x700000
    s_add_u32 s48, s20, 0x1c00000
    s_addc_u32 s49, s21, 0
    v_mfma_f32_16x16x32_bf16 v[152:155], a[204:207], a[136:139], 0
    buffer_store_dwordx4 v[32:35], v240, s[16:19], s80 offen sc1
    s_mov_b32 s50, 0x1c00000
    s_and_b32 s25, s3, 1
    v_mfma_f32_16x16x32_bf16 v[156:159], a[204:207], a[140:143], 0
    s_lshl1_add_u32 s47, s4, s25
    s_waitcnt lgkmcnt(0)
    v_mfma_f32_16x16x32_bf16 v[160:163], a[208:211], a[128:131], 0
    ds_read_b64_tr_b16 a[192:193], v246 offset:8192
    s_lshr_b32 s101, s3, 1
    v_mfma_f32_16x16x32_bf16 v[164:167], a[208:211], a[132:135], 0
    ds_read_b64_tr_b16 a[194:195], v246 offset:9216
    s_add_u32 s45, s5, s101
    s_sub_u32 s45, s45, 1
    v_mfma_f32_16x16x32_bf16 v[168:171], a[208:211], a[136:139], 0
    ds_read_b64_tr_b16 a[196:197], v238 offset:8192
    s_mul_i32 s45, s45, s5
    v_mfma_f32_16x16x32_bf16 v[172:175], a[208:211], a[140:143], 0
    ds_read_b64_tr_b16 a[198:199], v238 offset:9216
    s_lshl_b32 s100, s101, 14
    s_add_u32 s100, s100, 114688
    v_mfma_f32_16x16x32_bf16 v[176:179], a[212:215], a[128:131], 0
    ds_read_b64_tr_b16 a[200:201], v246 offset:8448
    s_mul_i32 s100, s100, s47
    v_mfma_f32_16x16x32_bf16 v[180:183], a[212:215], a[132:135], 0
    ds_read_b64_tr_b16 a[202:203], v246 offset:9472
    s_lshl_b32 s25, s45, 11
    v_mfma_f32_16x16x32_bf16 v[184:187], a[212:215], a[136:139], 0
    ds_read_b64_tr_b16 a[204:205], v238 offset:8448
    s_add_u32 s100, s100, s25
    s_lshl_b32 s46, s47, 9
    v_mfma_f32_16x16x32_bf16 v[188:191], a[212:215], a[140:143], 0
    ds_read_b64_tr_b16 a[206:207], v238 offset:9472
    s_mul_i32 s44, s47, 114688
    v_mfma_f32_16x16x32_bf16 v[192:195], a[216:219], a[128:131], 0
    buffer_load_dwordx4 a[184:187], v249, s[8:11], s28 offen offset:3072 sc1
    s_add_u32 s47, s44, 7168
    s_lshl_b32 s25, s45, 7
    v_mfma_f32_16x16x32_bf16 v[196:199], a[216:219], a[132:135], 0
    s_add_u32 s44, s44, s25
    s_lshl_b32 s45, s45, 18
    v_mfma_f32_16x16x32_bf16 v[200:203], a[216:219], a[136:139], 0
    buffer_load_dwordx4 a[188:191], v249, s[8:11], s29 offen offset:3072 sc1
    s_add_u32 s46, s46, s45
    v_mfma_f32_16x16x32_bf16 v[204:207], a[216:219], a[140:143], 0
    s_add_u32 m0, s31, 1024
    s_add_u32 s24, s27, 32768
    s_lshr_b32 s25, s3, 1
    v_mfma_f32_16x16x32_bf16 v[208:211], a[220:223], a[128:131], 0
    buffer_load_dwordx4 v245, s[12:15], s24 offen lds
    s_lshl_b32 s25, s25, 15
    v_mfma_f32_16x16x32_bf16 v[212:215], a[220:223], a[132:135], 0
    s_add_u32 s46, s46, s25
    s_mov_b32 s45, s43
    v_mfma_f32_16x16x32_bf16 v[216:219], a[220:223], a[136:139], 0
    s_add_u32 s28, s28, 4096
    s_and_b32 s28, s28, 32767
    buffer_store_dwordx4 v[36:39], v240, s[16:19], s81 offen sc1
    v_mfma_f32_16x16x32_bf16 v[220:223], a[220:223], a[140:143], 0
    s_add_u32 s29, s28, 32768
    v_accvgpr_write_b32 a0, 0
    s_waitcnt vmcnt(13) lgkmcnt(0)
    v_mfma_f32_16x16x32_bf16 v[96:99], a[192:195], a[144:147], v[96:99]
    ds_read_b64_tr_b16 a[208:209], v246 offset:8704
    s_load_dwordx2 s[56:57], s[0:1], 40
    v_accvgpr_write_b32 a1, 0
    v_mfma_f32_16x16x32_bf16 v[100:103], a[192:195], a[148:151], v[100:103]
    ds_read_b64_tr_b16 a[210:211], v246 offset:9728
    v_accvgpr_write_b32 a2, 0
    v_mfma_f32_16x16x32_bf16 v[104:107], a[192:195], a[152:155], v[104:107]
    ds_read_b64_tr_b16 a[212:213], v238 offset:8704
    v_accvgpr_write_b32 a3, 0
    v_mfma_f32_16x16x32_bf16 v[108:111], a[192:195], a[156:159], v[108:111]
    ds_read_b64_tr_b16 a[214:215], v238 offset:9728
    v_accvgpr_write_b32 a4, 0
    v_accvgpr_write_b32 a5, 0
    v_mfma_f32_16x16x32_bf16 v[112:115], a[196:199], a[144:147], v[112:115]
    ds_read_b64_tr_b16 a[216:217], v246 offset:8960
    v_accvgpr_write_b32 a6, 0
    v_mfma_f32_16x16x32_bf16 v[116:119], a[196:199], a[148:151], v[116:119]
    ds_read_b64_tr_b16 a[218:219], v246 offset:9984
    v_accvgpr_write_b32 a7, 0
    v_accvgpr_write_b32 a8, 0
    v_mfma_f32_16x16x32_bf16 v[120:123], a[196:199], a[152:155], v[120:123]
    ds_read_b64_tr_b16 a[220:221], v238 offset:8960
    v_accvgpr_write_b32 a9, 0
    v_mfma_f32_16x16x32_bf16 v[124:127], a[196:199], a[156:159], v[124:127]
    ds_read_b64_tr_b16 a[222:223], v238 offset:9984
    v_accvgpr_write_b32 a10, 0
    v_mfma_f32_16x16x32_bf16 v[128:131], a[200:203], a[144:147], v[128:131]
    buffer_load_dwordx4 a[128:131], v248, s[8:11], s28 offen offset:0 sc1
    v_accvgpr_write_b32 a11, 0
    v_accvgpr_write_b32 a12, 0
    v_mfma_f32_16x16x32_bf16 v[132:135], a[200:203], a[148:151], v[132:135]
    v_accvgpr_write_b32 a13, 0
    v_accvgpr_write_b32 a14, 0
    v_mfma_f32_16x16x32_bf16 v[136:139], a[200:203], a[152:155], v[136:139]
    buffer_load_dwordx4 a[132:135], v248, s[8:11], s29 offen offset:0 sc1
    v_accvgpr_write_b32 a15, 0
    v_mfma_f32_16x16x32_bf16 v[140:143], a[200:203], a[156:159], v[140:143]
    s_add_u32 m0, s31, 2048
    s_add_u32 s24, s27, 65536
    v_accvgpr_write_b32 a16, 0
    v_mfma_f32_16x16x32_bf16 v[144:147], a[204:207], a[144:147], v[144:147]
    buffer_load_dwordx4 v237, s[12:15], s24 offen lds
    v_accvgpr_write_b32 a17, 0
    v_mfma_f32_16x16x32_bf16 v[148:151], a[204:207], a[148:151], v[148:151]
    v_accvgpr_write_b32 a18, 0
    v_accvgpr_write_b32 a19, 0
    v_accvgpr_write_b32 a20, 0
    v_mfma_f32_16x16x32_bf16 v[152:155], a[204:207], a[152:155], v[152:155]
    buffer_store_dwordx4 v[40:43], v240, s[16:19], s82 offen sc1
    v_accvgpr_write_b32 a21, 0
    v_mfma_f32_16x16x32_bf16 v[156:159], a[204:207], a[156:159], v[156:159]
    v_accvgpr_write_b32 a22, 0
    s_waitcnt lgkmcnt(0)
    v_mfma_f32_16x16x32_bf16 v[160:163], a[208:211], a[144:147], v[160:163]
    ds_read_b64_tr_b16 a[192:193], v246 offset:16384
    v_accvgpr_write_b32 a23, 0
    v_accvgpr_write_b32 a24, 0
    v_mfma_f32_16x16x32_bf16 v[164:167], a[208:211], a[148:151], v[164:167]
    ds_read_b64_tr_b16 a[194:195], v246 offset:17408
    v_accvgpr_write_b32 a25, 0
    v_mfma_f32_16x16x32_bf16 v[168:171], a[208:211], a[152:155], v[168:171]
    ds_read_b64_tr_b16 a[196:197], v238 offset:16384
    v_accvgpr_write_b32 a26, 0
    v_mfma_f32_16x16x32_bf16 v[172:175], a[208:211], a[156:159], v[172:175]
    ds_read_b64_tr_b16 a[198:199], v238 offset:17408
    v_accvgpr_write_b32 a27, 0
    v_accvgpr_write_b32 a28, 0
    v_mfma_f32_16x16x32_bf16 v[176:179], a[212:215], a[144:147], v[176:179]
    ds_read_b64_tr_b16 a[200:201], v246 offset:16640
    v_accvgpr_write_b32 a29, 0
    v_mfma_f32_16x16x32_bf16 v[180:183], a[212:215], a[148:151], v[180:183]
    ds_read_b64_tr_b16 a[202:203], v246 offset:17664
    v_accvgpr_write_b32 a30, 0
    v_accvgpr_write_b32 a31, 0
    v_mfma_f32_16x16x32_bf16 v[184:187], a[212:215], a[152:155], v[184:187]
    ds_read_b64_tr_b16 a[204:205], v238 offset:16640
    v_accvgpr_write_b32 a32, 0
    v_mfma_f32_16x16x32_bf16 v[188:191], a[212:215], a[156:159], v[188:191]
    ds_read_b64_tr_b16 a[206:207], v238 offset:17664
    v_accvgpr_write_b32 a33, 0
    v_mfma_f32_16x16x32_bf16 v[192:195], a[216:219], a[144:147], v[192:195]
    buffer_load_dwordx4 a[136:139], v249, s[8:11], s28 offen offset:0 sc1
    v_accvgpr_write_b32 a34, 0
    v_accvgpr_write_b32 a35, 0
    v_mfma_f32_16x16x32_bf16 v[196:199], a[216:219], a[148:151], v[196:199]
    v_accvgpr_write_b32 a36, 0
    v_accvgpr_write_b32 a37, 0
    v_mfma_f32_16x16x32_bf16 v[200:203], a[216:219], a[152:155], v[200:203]
    buffer_load_dwordx4 a[140:143], v249, s[8:11], s29 offen offset:0 sc1
    v_accvgpr_write_b32 a38, 0
    v_mfma_f32_16x16x32_bf16 v[204:207], a[216:219], a[156:159], v[204:207]
    s_add_u32 m0, s31, 3072
    s_add_u32 s24, s27, 98304
    v_accvgpr_write_b32 a39, 0
    v_mfma_f32_16x16x32_bf16 v[208:211], a[220:223], a[144:147], v[208:211]
    buffer_load_dwordx4 v237, s[12:15], s24 offen lds
    v_accvgpr_write_b32 a40, 0
    v_mfma_f32_16x16x32_bf16 v[212:215], a[220:223], a[148:151], v[212:215]
    v_accvgpr_write_b32 a41, 0
    v_accvgpr_write_b32 a42, 0
    v_accvgpr_write_b32 a43, 0
    v_mfma_f32_16x16x32_bf16 v[216:219], a[220:223], a[152:155], v[216:219]
    buffer_store_dwordx4 v[44:47], v240, s[16:19], s83 offen sc1
    v_accvgpr_write_b32 a44, 0
    v_mfma_f32_16x16x32_bf16 v[220:223], a[220:223], a[156:159], v[220:223]
    v_accvgpr_write_b32 a45, 0
    s_waitcnt vmcnt(16) lgkmcnt(0)
    v_mfma_f32_16x16x32_bf16 v[96:99], a[192:195], a[160:163], v[96:99]
    ds_read_b64_tr_b16 a[208:209], v246 offset:16896
    v_accvgpr_write_b32 a46, 0
    v_accvgpr_write_b32 a47, 0
    v_mfma_f32_16x16x32_bf16 v[100:103], a[192:195], a[164:167], v[100:103]
    ds_read_b64_tr_b16 a[210:211], v246 offset:17920
    v_accvgpr_write_b32 a48, 0
    v_mfma_f32_16x16x32_bf16 v[104:107], a[192:195], a[168:171], v[104:107]
    ds_read_b64_tr_b16 a[212:213], v238 offset:16896
    v_accvgpr_write_b32 a49, 0
    v_accvgpr_write_b32 a50, 0
    v_mfma_f32_16x16x32_bf16 v[108:111], a[192:195], a[172:175], v[108:111]
    ds_read_b64_tr_b16 a[214:215], v238 offset:17920
    v_accvgpr_write_b32 a51, 0
    v_mfma_f32_16x16x32_bf16 v[112:115], a[196:199], a[160:163], v[112:115]
    ds_read_b64_tr_b16 a[216:217], v246 offset:17152
    v_accvgpr_write_b32 a52, 0
    v_mfma_f32_16x16x32_bf16 v[116:119], a[196:199], a[164:167], v[116:119]
    ds_read_b64_tr_b16 a[218:219], v246 offset:18176
    v_accvgpr_write_b32 a53, 0
    v_accvgpr_write_b32 a54, 0
    v_mfma_f32_16x16x32_bf16 v[120:123], a[196:199], a[168:171], v[120:123]
    ds_read_b64_tr_b16 a[220:221], v238 offset:17152
    v_accvgpr_write_b32 a55, 0
    v_mfma_f32_16x16x32_bf16 v[124:127], a[196:199], a[172:175], v[124:127]
    ds_read_b64_tr_b16 a[222:223], v238 offset:18176
    v_accvgpr_write_b32 a56, 0
    v_accvgpr_write_b32 a57, 0
    v_mfma_f32_16x16x32_bf16 v[128:131], a[200:203], a[160:163], v[128:131]
    buffer_load_dwordx4 a[144:147], v248, s[8:11], s28 offen offset:1024 sc1
    v_accvgpr_write_b32 a58, 0
    v_mfma_f32_16x16x32_bf16 v[132:135], a[200:203], a[164:167], v[132:135]
    v_accvgpr_write_b32 a59, 0
    v_accvgpr_write_b32 a60, 0
    v_mfma_f32_16x16x32_bf16 v[136:139], a[200:203], a[168:171], v[136:139]
    buffer_load_dwordx4 a[148:151], v248, s[8:11], s29 offen offset:1024 sc1
    v_accvgpr_write_b32 a61, 0
    v_mfma_f32_16x16x32_bf16 v[140:143], a[200:203], a[172:175], v[140:143]
    s_add_u32 m0, s31, 4096
    s_add_u32 s24, s27, 131072
    v_accvgpr_write_b32 a62, 0
    v_mfma_f32_16x16x32_bf16 v[144:147], a[204:207], a[160:163], v[144:147]
    buffer_load_dwordx4 v245, s[12:15], s24 offen lds
    v_accvgpr_write_b32 a63, 0
    v_mfma_f32_16x16x32_bf16 v[148:151], a[204:207], a[164:167], v[148:151]
    v_accvgpr_write_b32 a64, 0
    v_accvgpr_write_b32 a65, 0
    v_accvgpr_write_b32 a66, 0
    v_mfma_f32_16x16x32_bf16 v[152:155], a[204:207], a[168:171], v[152:155]
    buffer_store_dwordx4 v[48:51], v240, s[16:19], s84 offen sc1
    v_accvgpr_write_b32 a67, 0
    v_mfma_f32_16x16x32_bf16 v[156:159], a[204:207], a[172:175], v[156:159]
    v_accvgpr_write_b32 a68, 0
    s_waitcnt lgkmcnt(0)
    v_mfma_f32_16x16x32_bf16 v[160:163], a[208:211], a[160:163], v[160:163]
    ds_read_b64_tr_b16 a[192:193], v246 offset:24576
    v_accvgpr_write_b32 a69, 0
    v_accvgpr_write_b32 a70, 0
    v_mfma_f32_16x16x32_bf16 v[164:167], a[208:211], a[164:167], v[164:167]
    ds_read_b64_tr_b16 a[194:195], v246 offset:25600
    v_accvgpr_write_b32 a71, 0
    v_mfma_f32_16x16x32_bf16 v[168:171], a[208:211], a[168:171], v[168:171]
    ds_read_b64_tr_b16 a[196:197], v238 offset:24576
    v_accvgpr_write_b32 a72, 0
    v_accvgpr_write_b32 a73, 0
    v_mfma_f32_16x16x32_bf16 v[172:175], a[208:211], a[172:175], v[172:175]
    ds_read_b64_tr_b16 a[198:199], v238 offset:25600
    v_accvgpr_write_b32 a74, 0
    v_mfma_f32_16x16x32_bf16 v[176:179], a[212:215], a[160:163], v[176:179]
    ds_read_b64_tr_b16 a[200:201], v246 offset:24832
    v_accvgpr_write_b32 a75, 0
    v_mfma_f32_16x16x32_bf16 v[180:183], a[212:215], a[164:167], v[180:183]
    ds_read_b64_tr_b16 a[202:203], v246 offset:25856
    v_accvgpr_write_b32 a76, 0
    v_accvgpr_write_b32 a77, 0
    v_mfma_f32_16x16x32_bf16 v[184:187], a[212:215], a[168:171], v[184:187]
    ds_read_b64_tr_b16 a[204:205], v238 offset:24832
    v_accvgpr_write_b32 a78, 0
    v_mfma_f32_16x16x32_bf16 v[188:191], a[212:215], a[172:175], v[188:191]
    ds_read_b64_tr_b16 a[206:207], v238 offset:25856
    v_accvgpr_write_b32 a79, 0
    v_accvgpr_write_b32 a80, 0
    v_mfma_f32_16x16x32_bf16 v[192:195], a[216:219], a[160:163], v[192:195]
    buffer_load_dwordx4 a[152:155], v249, s[8:11], s28 offen offset:1024 sc1
    v_accvgpr_write_b32 a81, 0
    v_mfma_f32_16x16x32_bf16 v[196:199], a[216:219], a[164:167], v[196:199]
    v_accvgpr_write_b32 a82, 0
    v_accvgpr_write_b32 a83, 0
    v_mfma_f32_16x16x32_bf16 v[200:203], a[216:219], a[168:171], v[200:203]
    buffer_load_dwordx4 a[156:159], v249, s[8:11], s29 offen offset:1024 sc1
    v_accvgpr_write_b32 a84, 0
    v_mfma_f32_16x16x32_bf16 v[204:207], a[216:219], a[172:175], v[204:207]
    s_add_u32 m0, s31, 5120
    s_add_u32 s24, s27, 163840
    v_accvgpr_write_b32 a85, 0
    v_mfma_f32_16x16x32_bf16 v[208:211], a[220:223], a[160:163], v[208:211]
    buffer_load_dwordx4 v245, s[12:15], s24 offen lds
    v_accvgpr_write_b32 a86, 0
    v_accvgpr_write_b32 a87, 0
    v_mfma_f32_16x16x32_bf16 v[212:215], a[220:223], a[164:167], v[212:215]
    v_accvgpr_write_b32 a88, 0
    v_accvgpr_write_b32 a89, 0
    v_mfma_f32_16x16x32_bf16 v[216:219], a[220:223], a[168:171], v[216:219]
    s_add_u32 s30, s30, 32768
    buffer_store_dwordx4 v[52:55], v240, s[16:19], s85 offen sc1
    v_mfma_f32_16x16x32_bf16 v[220:223], a[220:223], a[172:175], v[220:223]
    s_cmp_ge_u32 s30, 163840
    s_cselect_b32 s30, 65536, s30
    s_waitcnt vmcnt(18) lgkmcnt(0)
    v_mfma_f32_16x16x32_bf16 v[96:99], a[192:195], a[176:179], v[96:99]
    ds_read_b64_tr_b16 a[208:209], v246 offset:25088
    v_accvgpr_write_b32 a90, 0
    v_accvgpr_write_b32 a91, 0
    v_mfma_f32_16x16x32_bf16 v[100:103], a[192:195], a[180:183], v[100:103]
    ds_read_b64_tr_b16 a[210:211], v246 offset:26112
    v_accvgpr_write_b32 a92, 0
    v_mfma_f32_16x16x32_bf16 v[104:107], a[192:195], a[184:187], v[104:107]
    ds_read_b64_tr_b16 a[212:213], v238 offset:25088
    v_accvgpr_write_b32 a93, 0
    v_mfma_f32_16x16x32_bf16 v[108:111], a[192:195], a[188:191], v[108:111]
    ds_read_b64_tr_b16 a[214:215], v238 offset:26112
    v_accvgpr_write_b32 a94, 0
    v_accvgpr_write_b32 a95, 0
    v_mfma_f32_16x16x32_bf16 v[112:115], a[196:199], a[176:179], v[112:115]
    ds_read_b64_tr_b16 a[216:217], v246 offset:25344
    v_accvgpr_write_b32 a96, 0
    v_mfma_f32_16x16x32_bf16 v[116:119], a[196:199], a[180:183], v[116:119]
    ds_read_b64_tr_b16 a[218:219], v246 offset:26368
    v_accvgpr_write_b32 a97, 0
    v_accvgpr_write_b32 a98, 0
    v_mfma_f32_16x16x32_bf16 v[120:123], a[196:199], a[184:187], v[120:123]
    ds_read_b64_tr_b16 a[220:221], v238 offset:25344
    v_accvgpr_write_b32 a99, 0
    v_mfma_f32_16x16x32_bf16 v[124:127], a[196:199], a[188:191], v[124:127]
    ds_read_b64_tr_b16 a[222:223], v238 offset:26368
    v_accvgpr_write_b32 a100, 0
    v_mfma_f32_16x16x32_bf16 v[128:131], a[200:203], a[176:179], v[128:131]
    buffer_load_dwordx4 a[160:163], v248, s[8:11], s28 offen offset:2048 sc1
    v_accvgpr_write_b32 a101, 0
    v_accvgpr_write_b32 a102, 0
    v_mfma_f32_16x16x32_bf16 v[132:135], a[200:203], a[180:183], v[132:135]
    v_accvgpr_write_b32 a103, 0
    v_accvgpr_write_b32 a104, 0
    v_mfma_f32_16x16x32_bf16 v[136:139], a[200:203], a[184:187], v[136:139]
    buffer_load_dwordx4 a[164:167], v248, s[8:11], s29 offen offset:2048 sc1
    v_accvgpr_write_b32 a105, 0
    v_mfma_f32_16x16x32_bf16 v[140:143], a[200:203], a[188:191], v[140:143]
    s_add_u32 m0, s31, 6144
    s_add_u32 s24, s27, 196608
    v_accvgpr_write_b32 a106, 0
    v_mfma_f32_16x16x32_bf16 v[144:147], a[204:207], a[176:179], v[144:147]
    buffer_load_dwordx4 v237, s[12:15], s24 offen lds
    v_accvgpr_write_b32 a107, 0
    v_mfma_f32_16x16x32_bf16 v[148:151], a[204:207], a[180:183], v[148:151]
    v_accvgpr_write_b32 a108, 0
    v_accvgpr_write_b32 a109, 0
    v_accvgpr_write_b32 a110, 0
    v_mfma_f32_16x16x32_bf16 v[152:155], a[204:207], a[184:187], v[152:155]
    buffer_store_dwordx4 v[56:59], v240, s[16:19], s86 offen sc1
    v_accvgpr_write_b32 a111, 0
    v_mfma_f32_16x16x32_bf16 v[156:159], a[204:207], a[188:191], v[156:159]
    s_waitcnt vmcnt(49) lgkmcnt(0)
    s_barrier
    v_add_u32 v246, s30, v247
    v_mfma_f32_16x16x32_bf16 v[160:163], a[208:211], a[176:179], v[160:163]
    v_xor_b32_e64 v238, 16, v246
    ds_read_b64_tr_b16 a[192:193], v246 offset:0
    v_accvgpr_write_b32 a112, 0
    v_mfma_f32_16x16x32_bf16 v[164:167], a[208:211], a[180:183], v[164:167]
    ds_read_b64_tr_b16 a[194:195], v246 offset:1024
    v_accvgpr_write_b32 a113, 0
    v_mfma_f32_16x16x32_bf16 v[168:171], a[208:211], a[184:187], v[168:171]
    ds_read_b64_tr_b16 a[196:197], v238 offset:0
    v_accvgpr_write_b32 a114, 0
    v_mfma_f32_16x16x32_bf16 v[172:175], a[208:211], a[188:191], v[172:175]
    ds_read_b64_tr_b16 a[198:199], v238 offset:1024
    v_accvgpr_write_b32 a115, 0
    v_accvgpr_write_b32 a116, 0
    v_mfma_f32_16x16x32_bf16 v[176:179], a[212:215], a[176:179], v[176:179]
    ds_read_b64_tr_b16 a[200:201], v246 offset:256
    v_accvgpr_write_b32 a117, 0
    v_mfma_f32_16x16x32_bf16 v[180:183], a[212:215], a[180:183], v[180:183]
    ds_read_b64_tr_b16 a[202:203], v246 offset:1280
    v_accvgpr_write_b32 a118, 0
    v_accvgpr_write_b32 a119, 0
    v_mfma_f32_16x16x32_bf16 v[184:187], a[212:215], a[184:187], v[184:187]
    ds_read_b64_tr_b16 a[204:205], v238 offset:256
    buffer_store_dwordx4 v[60:63], v240, s[16:19], s87 offen sc1
    v_mfma_f32_16x16x32_bf16 v[188:191], a[212:215], a[188:191], v[188:191]
    ds_read_b64_tr_b16 a[206:207], v238 offset:1280
    v_accvgpr_write_b32 a120, 0
    v_accvgpr_write_b32 a121, 0
    v_mfma_f32_16x16x32_bf16 v[192:195], a[216:219], a[176:179], v[192:195]
    buffer_load_dwordx4 a[168:171], v249, s[8:11], s28 offen offset:2048 sc1
    v_accvgpr_write_b32 a122, 0
    v_mfma_f32_16x16x32_bf16 v[196:199], a[216:219], a[180:183], v[196:199]
    s_lshl2_add_u32 s80, s2, s3
    s_mul_i32 s80, s80, 12288
    s_add_u32 s80, s80, 0x1000000
    v_mov_b32 v0, -1
    v_mov_b32 v1, -1
    v_mov_b32 v2, -1
    v_mov_b32_e64 v3, -1
    v_mfma_f32_16x16x32_bf16 v[200:203], a[216:219], a[184:187], v[200:203]
    buffer_load_dwordx4 a[172:175], v249, s[8:11], s29 offen offset:2048 sc1
    v_accvgpr_write_b32 a123, 0
    v_accvgpr_write_b32 a124, 0
    v_mfma_f32_16x16x32_bf16 v[204:207], a[216:219], a[188:191], v[204:207]
    s_add_u32 m0, s31, 7168
    s_add_u32 s24, s27, 229376
    v_mfma_f32_16x16x32_bf16 v[208:211], a[220:223], a[176:179], v[208:211]
    buffer_load_dwordx4 v237, s[12:15], s24 offen lds
    v_accvgpr_write_b32 a125, 0
    v_accvgpr_write_b32 a126, 0
    v_mfma_f32_16x16x32_bf16 v[212:215], a[220:223], a[180:183], v[212:215]
    s_add_u32 s27, s27, 1048576
    s_and_b32 s27, s27, 0x407fffff
    v_mfma_f32_16x16x32_bf16 v[216:219], a[220:223], a[184:187], v[216:219]
    s_cmp_eq_u32 s27, s7
    s_cselect_b32 s27, s43, s27
    v_accvgpr_write_b32 a127, 0
    v_mfma_f32_16x16x32_bf16 v[220:223], a[220:223], a[188:191], v[220:223]
    s_add_u32 s31, s31, 32768
    s_cmp_ge_u32 s31, 163840
    s_cselect_b32 s24, 98304, 0
    s_sub_u32 s31, s31, s24
.p2align 3
ka_qp:
    s_waitcnt vmcnt(15) lgkmcnt(0)
    v_mfma_f32_16x16x32_bf16 v[96:99], a[192:195], a[128:131], v[96:99]
    ds_read_b64_tr_b16 a[208:209], v246 offset:512
    v_mfma_f32_16x16x32_bf16 v[100:103], a[192:195], a[132:135], v[100:103]
    ds_read_b64_tr_b16 a[210:211], v246 offset:1536
    v_mfma_f32_16x16x32_bf16 v[104:107], a[192:195], a[136:139], v[104:107]
    ds_read_b64_tr_b16 a[212:213], v238 offset:512
    v_mfma_f32_16x16x32_bf16 v[108:111], a[192:195], a[140:143], v[108:111]
    ds_read_b64_tr_b16 a[214:215], v238 offset:1536
    v_mfma_f32_16x16x32_bf16 v[112:115], a[196:199], a[128:131], v[112:115]
    ds_read_b64_tr_b16 a[216:217], v246 offset:768
    v_mfma_f32_16x16x32_bf16 v[116:119], a[196:199], a[132:135], v[116:119]
    ds_read_b64_tr_b16 a[218:219], v246 offset:1792
    v_mfma_f32_16x16x32_bf16 v[120:123], a[196:199], a[136:139], v[120:123]
    ds_read_b64_tr_b16 a[220:221], v238 offset:768
    v_mfma_f32_16x16x32_bf16 v[124:127], a[196:199], a[140:143], v[124:127]
    ds_read_b64_tr_b16 a[222:223], v238 offset:1792
    v_mfma_f32_16x16x32_bf16 v[128:131], a[200:203], a[128:131], v[128:131]
    buffer_load_dwordx4 a[176:179], v248, s[8:11], s28 offen offset:3072 sc1
    s_cmp_eq_u32 s26, 1
    s_cselect_b32 s41, s35, s43
    buffer_load_dword v254, off, s[88:91], s41 sc1
    v_mfma_f32_16x16x32_bf16 v[132:135], a[200:203], a[132:135], v[132:135]
    v_mfma_f32_16x16x32_bf16 v[136:139], a[200:203], a[136:139], v[136:139]
    buffer_load_dwordx4 a[180:183], v248, s[8:11], s29 offen offset:3072 sc1
    v_mfma_f32_16x16x32_bf16 v[140:143], a[200:203], a[140:143], v[140:143]
    s_add_u32 m0, s31, 0
    s_add_u32 s24, s27, 0
    v_mfma_f32_16x16x32_bf16 v[144:147], a[204:207], a[128:131], v[144:147]
    buffer_load_dwordx4 v245, s[12:15], s24 offen lds
    v_mfma_f32_16x16x32_bf16 v[148:151], a[204:207], a[132:135], v[148:151]
    v_mfma_f32_16x16x32_bf16 v[152:155], a[204:207], a[136:139], v[152:155]
    v_mfma_f32_16x16x32_bf16 v[156:159], a[204:207], a[140:143], v[156:159]
    s_waitcnt lgkmcnt(0)
    v_mfma_f32_16x16x32_bf16 v[160:163], a[208:211], a[128:131], v[160:163]
    ds_read_b64_tr_b16 a[192:193], v246 offset:8192
    v_mfma_f32_16x16x32_bf16 v[164:167], a[208:211], a[132:135], v[164:167]
    ds_read_b64_tr_b16 a[194:195], v246 offset:9216
    v_mfma_f32_16x16x32_bf16 v[168:171], a[208:211], a[136:139], v[168:171]
    ds_read_b64_tr_b16 a[196:197], v238 offset:8192
    v_mfma_f32_16x16x32_bf16 v[172:175], a[208:211], a[140:143], v[172:175]
    ds_read_b64_tr_b16 a[198:199], v238 offset:9216
    v_mfma_f32_16x16x32_bf16 v[176:179], a[212:215], a[128:131], v[176:179]
    ds_read_b64_tr_b16 a[200:201], v246 offset:8448
    v_mfma_f32_16x16x32_bf16 v[180:183], a[212:215], a[132:135], v[180:183]
    ds_read_b64_tr_b16 a[202:203], v246 offset:9472
    v_mfma_f32_16x16x32_bf16 v[184:187], a[212:215], a[136:139], v[184:187]
    ds_read_b64_tr_b16 a[204:205], v238 offset:8448
    v_mfma_f32_16x16x32_bf16 v[188:191], a[212:215], a[140:143], v[188:191]
    ds_read_b64_tr_b16 a[206:207], v238 offset:9472
    v_mfma_f32_16x16x32_bf16 v[192:195], a[216:219], a[128:131], v[192:195]
    buffer_load_dwordx4 a[184:187], v249, s[8:11], s28 offen offset:3072 sc1
    v_mfma_f32_16x16x32_bf16 v[196:199], a[216:219], a[132:135], v[196:199]
    v_mfma_f32_16x16x32_bf16 v[200:203], a[216:219], a[136:139], v[200:203]
    buffer_load_dwordx4 a[188:191], v249, s[8:11], s29 offen offset:3072 sc1
    v_mfma_f32_16x16x32_bf16 v[204:207], a[216:219], a[140:143], v[204:207]
    s_add_u32 m0, s31, 1024
    s_add_u32 s24, s27, 32768
    v_mfma_f32_16x16x32_bf16 v[208:211], a[220:223], a[128:131], v[208:211]
    buffer_load_dwordx4 v245, s[12:15], s24 offen lds
    v_mfma_f32_16x16x32_bf16 v[212:215], a[220:223], a[132:135], v[212:215]
    v_mfma_f32_16x16x32_bf16 v[216:219], a[220:223], a[136:139], v[216:219]
    s_add_u32 s28, s28, 4096
    s_and_b32 s28, s28, 32767
    v_mfma_f32_16x16x32_bf16 v[220:223], a[220:223], a[140:143], v[220:223]
    s_add_u32 s29, s28, 32768
    s_waitcnt vmcnt(16) lgkmcnt(0)
    v_mfma_f32_16x16x32_bf16 v[96:99], a[192:195], a[144:147], v[96:99]
    ds_read_b64_tr_b16 a[208:209], v246 offset:8704
    v_mfma_f32_16x16x32_bf16 v[100:103], a[192:195], a[148:151], v[100:103]
    ds_read_b64_tr_b16 a[210:211], v246 offset:9728
    v_mfma_f32_16x16x32_bf16 v[104:107], a[192:195], a[152:155], v[104:107]
    ds_read_b64_tr_b16 a[212:213], v238 offset:8704
    v_mfma_f32_16x16x32_bf16 v[108:111], a[192:195], a[156:159], v[108:111]
    ds_read_b64_tr_b16 a[214:215], v238 offset:9728
    v_mfma_f32_16x16x32_bf16 v[112:115], a[196:199], a[144:147], v[112:115]
    ds_read_b64_tr_b16 a[216:217], v246 offset:8960
    v_mfma_f32_16x16x32_bf16 v[116:119], a[196:199], a[148:151], v[116:119]
    ds_read_b64_tr_b16 a[218:219], v246 offset:9984
    v_mfma_f32_16x16x32_bf16 v[120:123], a[196:199], a[152:155], v[120:123]
    ds_read_b64_tr_b16 a[220:221], v238 offset:8960
    v_mfma_f32_16x16x32_bf16 v[124:127], a[196:199], a[156:159], v[124:127]
    ds_read_b64_tr_b16 a[222:223], v238 offset:9984
    v_mfma_f32_16x16x32_bf16 v[128:131], a[200:203], a[144:147], v[128:131]
    buffer_load_dwordx4 a[128:131], v248, s[8:11], s28 offen offset:0 sc1
    v_mfma_f32_16x16x32_bf16 v[132:135], a[200:203], a[148:151], v[132:135]
    v_mfma_f32_16x16x32_bf16 v[136:139], a[200:203], a[152:155], v[136:139]
    buffer_load_dwordx4 a[132:135], v248, s[8:11], s29 offen offset:0 sc1
    v_mfma_f32_16x16x32_bf16 v[140:143], a[200:203], a[156:159], v[140:143]
    s_add_u32 m0, s31, 2048
    s_add_u32 s24, s27, 65536
    v_mfma_f32_16x16x32_bf16 v[144:147], a[204:207], a[144:147], v[144:147]
    buffer_load_dwordx4 v237, s[12:15], s24 offen lds
    v_mfma_f32_16x16x32_bf16 v[148:151], a[204:207], a[148:151], v[148:151]
    buffer_store_dwordx4 v[0:3], v240, s[48:51], s80 offen sc1
    s_add_u32 s80, s80, 1024
    v_mfma_f32_16x16x32_bf16 v[152:155], a[204:207], a[152:155], v[152:155]
    v_mfma_f32_16x16x32_bf16 v[156:159], a[204:207], a[156:159], v[156:159]
    s_waitcnt lgkmcnt(0)
    v_mfma_f32_16x16x32_bf16 v[160:163], a[208:211], a[144:147], v[160:163]
    ds_read_b64_tr_b16 a[192:193], v246 offset:16384
    v_mfma_f32_16x16x32_bf16 v[164:167], a[208:211], a[148:151], v[164:167]
    ds_read_b64_tr_b16 a[194:195], v246 offset:17408
    v_mfma_f32_16x16x32_bf16 v[168:171], a[208:211], a[152:155], v[168:171]
    ds_read_b64_tr_b16 a[196:197], v238 offset:16384
    v_mfma_f32_16x16x32_bf16 v[172:175], a[208:211], a[156:159], v[172:175]
    ds_read_b64_tr_b16 a[198:199], v238 offset:17408
    v_mfma_f32_16x16x32_bf16 v[176:179], a[212:215], a[144:147], v[176:179]
    ds_read_b64_tr_b16 a[200:201], v246 offset:16640
    v_mfma_f32_16x16x32_bf16 v[180:183], a[212:215], a[148:151], v[180:183]
    ds_read_b64_tr_b16 a[202:203], v246 offset:17664
    v_mfma_f32_16x16x32_bf16 v[184:187], a[212:215], a[152:155], v[184:187]
    ds_read_b64_tr_b16 a[204:205], v238 offset:16640
    v_mfma_f32_16x16x32_bf16 v[188:191], a[212:215], a[156:159], v[188:191]
    ds_read_b64_tr_b16 a[206:207], v238 offset:17664
    v_mfma_f32_16x16x32_bf16 v[192:195], a[216:219], a[144:147], v[192:195]
    buffer_load_dwordx4 a[136:139], v249, s[8:11], s28 offen offset:0 sc1
    v_mfma_f32_16x16x32_bf16 v[196:199], a[216:219], a[148:151], v[196:199]
    v_mfma_f32_16x16x32_bf16 v[200:203], a[216:219], a[152:155], v[200:203]
    buffer_load_dwordx4 a[140:143], v249, s[8:11], s29 offen offset:0 sc1
    v_mfma_f32_16x16x32_bf16 v[204:207], a[216:219], a[156:159], v[204:207]
    s_add_u32 m0, s31, 3072
    s_add_u32 s24, s27, 98304
    v_mfma_f32_16x16x32_bf16 v[208:211], a[220:223], a[144:147], v[208:211]
    buffer_load_dwordx4 v237, s[12:15], s24 offen lds
    v_mfma_f32_16x16x32_bf16 v[212:215], a[220:223], a[148:151], v[212:215]
    v_mfma_f32_16x16x32_bf16 v[216:219], a[220:223], a[152:155], v[216:219]
    v_mfma_f32_16x16x32_bf16 v[220:223], a[220:223], a[156:159], v[220:223]
    s_waitcnt vmcnt(15) lgkmcnt(0)
    v_mfma_f32_16x16x32_bf16 v[96:99], a[192:195], a[160:163], v[96:99]
    ds_read_b64_tr_b16 a[208:209], v246 offset:16896
    v_mfma_f32_16x16x32_bf16 v[100:103], a[192:195], a[164:167], v[100:103]
    ds_read_b64_tr_b16 a[210:211], v246 offset:17920
    v_mfma_f32_16x16x32_bf16 v[104:107], a[192:195], a[168:171], v[104:107]
    ds_read_b64_tr_b16 a[212:213], v238 offset:16896
    v_mfma_f32_16x16x32_bf16 v[108:111], a[192:195], a[172:175], v[108:111]
    ds_read_b64_tr_b16 a[214:215], v238 offset:17920
    v_mfma_f32_16x16x32_bf16 v[112:115], a[196:199], a[160:163], v[112:115]
    ds_read_b64_tr_b16 a[216:217], v246 offset:17152
    v_mfma_f32_16x16x32_bf16 v[116:119], a[196:199], a[164:167], v[116:119]
    ds_read_b64_tr_b16 a[218:219], v246 offset:18176
    v_mfma_f32_16x16x32_bf16 v[120:123], a[196:199], a[168:171], v[120:123]
    ds_read_b64_tr_b16 a[220:221], v238 offset:17152
    v_mfma_f32_16x16x32_bf16 v[124:127], a[196:199], a[172:175], v[124:127]
    ds_read_b64_tr_b16 a[222:223], v238 offset:18176
    v_mfma_f32_16x16x32_bf16 v[128:131], a[200:203], a[160:163], v[128:131]
    buffer_load_dwordx4 a[144:147], v248, s[8:11], s28 offen offset:1024 sc1
    v_mfma_f32_16x16x32_bf16 v[132:135], a[200:203], a[164:167], v[132:135]
    v_mfma_f32_16x16x32_bf16 v[136:139], a[200:203], a[168:171], v[136:139]
    buffer_load_dwordx4 a[148:151], v248, s[8:11], s29 offen offset:1024 sc1
    v_mfma_f32_16x16x32_bf16 v[140:143], a[200:203], a[172:175], v[140:143]
    s_add_u32 m0, s31, 4096
    s_add_u32 s24, s27, 131072
    v_mfma_f32_16x16x32_bf16 v[144:147], a[204:207], a[160:163], v[144:147]
    buffer_load_dwordx4 v245, s[12:15], s24 offen lds
    v_mfma_f32_16x16x32_bf16 v[148:151], a[204:207], a[164:167], v[148:151]
    v_mfma_f32_16x16x32_bf16 v[152:155], a[204:207], a[168:171], v[152:155]
    v_mfma_f32_16x16x32_bf16 v[156:159], a[204:207], a[172:175], v[156:159]
    s_waitcnt lgkmcnt(0)
    v_mfma_f32_16x16x32_bf16 v[160:163], a[208:211], a[160:163], v[160:163]
    ds_read_b64_tr_b16 a[192:193], v246 offset:24576
    v_mfma_f32_16x16x32_bf16 v[164:167], a[208:211], a[164:167], v[164:167]
    ds_read_b64_tr_b16 a[194:195], v246 offset:25600
    v_mfma_f32_16x16x32_bf16 v[168:171], a[208:211], a[168:171], v[168:171]
    ds_read_b64_tr_b16 a[196:197], v238 offset:24576
    v_mfma_f32_16x16x32_bf16 v[172:175], a[208:211], a[172:175], v[172:175]
    ds_read_b64_tr_b16 a[198:199], v238 offset:25600
    v_mfma_f32_16x16x32_bf16 v[176:179], a[212:215], a[160:163], v[176:179]
    ds_read_b64_tr_b16 a[200:201], v246 offset:24832
    v_mfma_f32_16x16x32_bf16 v[180:183], a[212:215], a[164:167], v[180:183]
    ds_read_b64_tr_b16 a[202:203], v246 offset:25856
    v_mfma_f32_16x16x32_bf16 v[184:187], a[212:215], a[168:171], v[184:187]
    ds_read_b64_tr_b16 a[204:205], v238 offset:24832
    v_mfma_f32_16x16x32_bf16 v[188:191], a[212:215], a[172:175], v[188:191]
    ds_read_b64_tr_b16 a[206:207], v238 offset:25856
    v_mfma_f32_16x16x32_bf16 v[192:195], a[216:219], a[160:163], v[192:195]
    buffer_load_dwordx4 a[152:155], v249, s[8:11], s28 offen offset:1024 sc1
    v_mfma_f32_16x16x32_bf16 v[196:199], a[216:219], a[164:167], v[196:199]
    v_mfma_f32_16x16x32_bf16 v[200:203], a[216:219], a[168:171], v[200:203]
    buffer_load_dwordx4 a[156:159], v249, s[8:11], s29 offen offset:1024 sc1
    v_mfma_f32_16x16x32_bf16 v[204:207], a[216:219], a[172:175], v[204:207]
    s_add_u32 m0, s31, 5120
    s_add_u32 s24, s27, 163840
    v_mfma_f32_16x16x32_bf16 v[208:211], a[220:223], a[160:163], v[208:211]
    buffer_load_dwordx4 v245, s[12:15], s24 offen lds
    v_mfma_f32_16x16x32_bf16 v[212:215], a[220:223], a[164:167], v[212:215]
    buffer_store_dwordx4 v[0:3], v240, s[48:51], s80 offen sc1
    s_add_u32 s80, s80, 1024
    v_mfma_f32_16x16x32_bf16 v[216:219], a[220:223], a[168:171], v[216:219]
    s_add_u32 s30, s30, 32768
    v_mfma_f32_16x16x32_bf16 v[220:223], a[220:223], a[172:175], v[220:223]
    s_cmp_ge_u32 s30, 163840
    s_cselect_b32 s30, 65536, s30
    s_waitcnt vmcnt(15) lgkmcnt(0)
    v_mfma_f32_16x16x32_bf16 v[96:99], a[192:195], a[176:179], v[96:99]
    ds_read_b64_tr_b16 a[208:209], v246 offset:25088
    v_mfma_f32_16x16x32_bf16 v[100:103], a[192:195], a[180:183], v[100:103]
    ds_read_b64_tr_b16 a[210:211], v246 offset:26112
    v_mfma_f32_16x16x32_bf16 v[104:107], a[192:195], a[184:187], v[104:107]
    ds_read_b64_tr_b16 a[212:213], v238 offset:25088
    v_mfma_f32_16x16x32_bf16 v[108:111], a[192:195], a[188:191], v[108:111]
    ds_read_b64_tr_b16 a[214:215], v238 offset:26112
    v_mfma_f32_16x16x32_bf16 v[112:115], a[196:199], a[176:179], v[112:115]
    ds_read_b64_tr_b16 a[216:217], v246 offset:25344
    v_mfma_f32_16x16x32_bf16 v[116:119], a[196:199], a[180:183], v[116:119]
    ds_read_b64_tr_b16 a[218:219], v246 offset:26368
    v_mfma_f32_16x16x32_bf16 v[120:123], a[196:199], a[184:187], v[120:123]
    ds_read_b64_tr_b16 a[220:221], v238 offset:25344
    v_mfma_f32_16x16x32_bf16 v[124:127], a[196:199], a[188:191], v[124:127]
    ds_read_b64_tr_b16 a[222:223], v238 offset:26368
    v_mfma_f32_16x16x32_bf16 v[128:131], a[200:203], a[176:179], v[128:131]
    buffer_load_dwordx4 a[160:163], v248, s[8:11], s28 offen offset:2048 sc1
    v_mfma_f32_16x16x32_bf16 v[132:135], a[200:203], a[180:183], v[132:135]
    v_mfma_f32_16x16x32_bf16 v[136:139], a[200:203], a[184:187], v[136:139]
    buffer_load_dwordx4 a[164:167], v248, s[8:11], s29 offen offset:2048 sc1
    v_mfma_f32_16x16x32_bf16 v[140:143], a[200:203], a[188:191], v[140:143]
    s_add_u32 m0, s31, 6144
    s_add_u32 s24, s27, 196608
    v_mfma_f32_16x16x32_bf16 v[144:147], a[204:207], a[176:179], v[144:147]
    buffer_load_dwordx4 v237, s[12:15], s24 offen lds
    v_mfma_f32_16x16x32_bf16 v[148:151], a[204:207], a[180:183], v[148:151]
    v_mfma_f32_16x16x32_bf16 v[152:155], a[204:207], a[184:187], v[152:155]
    s_cmp_eq_u32 s26, 1
    s_cbranch_scc0 ka_nopk
    s_waitcnt vmcnt(22)
    v_readfirstlane_b32 s24, v254
    s_lshl_b32 s25, s3, 16
    s_add_u32 s24, s24, s25
    s_cmp_ge_u32 s24, 8
    s_cbranch_scc0 kf_spin39
kf_spinr40:
ka_nopk:
    v_mfma_f32_16x16x32_bf16 v[156:159], a[204:207], a[188:191], v[156:159]
    s_waitcnt vmcnt(24) lgkmcnt(0)
    s_barrier
    v_add_u32 v246, s30, v247
    v_mfma_f32_16x16x32_bf16 v[160:163], a[208:211], a[176:179], v[160:163]
    v_xor_b32_e64 v238, 16, v246
    ds_read_b64_tr_b16 a[192:193], v246 offset:0
    v_mfma_f32_16x16x32_bf16 v[164:167], a[208:211], a[180:183], v[164:167]
    ds_read_b64_tr_b16 a[194:195], v246 offset:1024
    v_mfma_f32_16x16x32_bf16 v[168:171], a[208:211], a[184:187], v[168:171]
    ds_read_b64_tr_b16 a[196:197], v238 offset:0
    v_mfma_f32_16x16x32_bf16 v[172:175], a[208:211], a[188:191], v[172:175]
    ds_read_b64_tr_b16 a[198:199], v238 offset:1024
    v_mfma_f32_16x16x32_bf16 v[176:179], a[212:215], a[176:179], v[176:179]
    ds_read_b64_tr_b16 a[200:201], v246 offset:256
    v_mfma_f32_16x16x32_bf16 v[180:183], a[212:215], a[180:183], v[180:183]
    ds_read_b64_tr_b16 a[202:203], v246 offset:1280
    v_mfma_f32_16x16x32_bf16 v[184:187], a[212:215], a[184:187], v[184:187]
    ds_read_b64_tr_b16 a[204:205], v238 offset:256
    buffer_atomic_add v255, v250, s[88:91], s97 offen sc1
    s_mov_b32 s97, s43
    v_mfma_f32_16x16x32_bf16 v[188:191], a[212:215], a[188:191], v[188:191]
    ds_read_b64_tr_b16 a[206:207], v238 offset:1280
    v_mfma_f32_16x16x32_bf16 v[192:195], a[216:219], a[176:179], v[192:195]
    buffer_load_dwordx4 a[168:171], v249, s[8:11], s28 offen offset:2048 sc1
    v_mfma_f32_16x16x32_bf16 v[196:199], a[216:219], a[180:183], v[196:199]
    v_mfma_f32_16x16x32_bf16 v[200:203], a[216:219], a[184:187], v[200:203]
    buffer_load_dwordx4 a[172:175], v249, s[8:11], s29 offen offset:2048 sc1
    v_mfma_f32_16x16x32_bf16 v[204:207], a[216:219], a[188:191], v[204:207]
    s_add_u32 m0, s31, 7168
    s_add_u32 s24, s27, 229376
    v_mfma_f32_16x16x32_bf16 v[208:211], a[220:223], a[176:179], v[208:211]
    buffer_load_dwordx4 v237, s[12:15], s24 offen lds
    v_mfma_f32_16x16x32_bf16 v[212:215], a[220:223], a[180:183], v[212:215]
    s_add_u32 s27, s27, 1048576
    s_and_b32 s27, s27, 0x407fffff
    v_mfma_f32_16x16x32_bf16 v[216:219], a[220:223], a[184:187], v[216:219]
    s_cmp_eq_u32 s27, s7
    s_cselect_b32 s27, s43, s27
    v_mfma_f32_16x16x32_bf16 v[220:223], a[220:223], a[188:191], v[220:223]
    s_add_u32 s31, s31, 32768
    s_cmp_ge_u32 s31, 163840
    s_cselect_b32 s24, 98304, 0
    s_sub_u32 s31, s31, s24
    s_sub_u32 s26, s26, 1
    s_cmp_lg_u32 s26, 0
    s_cbranch_scc1 ka_qp
    s_waitcnt vmcnt(15) lgkmcnt(0)
    v_mfma_f32_16x16x32_bf16 v[96:99], a[192:195], a[128:131], v[96:99]
    ds_read_b64_tr_b16 a[208:209], v246 offset:512
    s_sub_u32 s42, s32, 17664
    v_mfma_f32_16x16x32_bf16 v[100:103], a[192:195], a[132:135], v[100:103]
    ds_read_b64_tr_b16 a[210:211], v246 offset:1536
    v_mfma_f32_16x16x32_bf16 v[104:107], a[192:195], a[136:139], v[104:107]
    ds_read_b64_tr_b16 a[212:213], v238 offset:512
    s_mov_b32 m0, s34
    s_add_u32 s41, s42, 17664
    v_mfma_f32_16x16x32_bf16 v[108:111], a[192:195], a[140:143], v[108:111]
    ds_read_b64_tr_b16 a[214:215], v238 offset:1536
    v_mfma_f32_16x16x32_bf16 v[112:115], a[196:199], a[128:131], v[112:115]
    ds_read_b64_tr_b16 a[216:217], v246 offset:768
    v_mfma_f32_16x16x32_bf16 v[116:119], a[196:199], a[132:135], v[116:119]
    ds_read_b64_tr_b16 a[218:219], v246 offset:1792
    buffer_load_dwordx4 v242, s[16:19], s41 offen offset:0 sc1 lds
    v_mfma_f32_16x16x32_bf16 v[120:123], a[196:199], a[136:139], v[120:123]
    ds_read_b64_tr_b16 a[220:221], v238 offset:768
    v_mfma_f32_16x16x32_bf16 v[124:127], a[196:199], a[140:143], v[124:127]
    ds_read_b64_tr_b16 a[222:223], v238 offset:1792
    v_mfma_f32_16x16x32_bf16 v[128:131], a[200:203], a[128:131], v[128:131]
    buffer_load_dwordx4 a[176:179], v248, s[8:11], s28 offen offset:3072 sc1
    buffer_load_dwordx4 v242, s[16:19], s41 offen offset:1024 sc1 lds
    v_mfma_f32_16x16x32_bf16 v[132:135], a[200:203], a[132:135], v[132:135]
    v_mfma_f32_16x16x32_bf16 v[136:139], a[200:203], a[136:139], v[136:139]
    buffer_load_dwordx4 a[180:183], v248, s[8:11], s29 offen offset:3072 sc1
    v_mfma_f32_16x16x32_bf16 v[140:143], a[200:203], a[140:143], v[140:143]
    buffer_load_dwordx4 v242, s[16:19], s41 offen offset:2048 sc1 lds
    v_mfma_f32_16x16x32_bf16 v[144:147], a[204:207], a[128:131], v[144:147]
    v_mfma_f32_16x16x32_bf16 v[148:151], a[204:207], a[132:135], v[148:151]
    v_mfma_f32_16x16x32_bf16 v[152:155], a[204:207], a[136:139], v[152:155]
    buffer_load_dwordx4 v242, s[16:19], s41 offen offset:3072 sc1 lds
    v_mfma_f32_16x16x32_bf16 v[156:159], a[204:207], a[140:143], v[156:159]
    s_waitcnt lgkmcnt(0)
    v_mfma_f32_16x16x32_bf16 v[160:163], a[208:211], a[128:131], v[160:163]
    ds_read_b64_tr_b16 a[192:193], v246 offset:8192
    v_mfma_f32_16x16x32_bf16 v[164:167], a[208:211], a[132:135], v[164:167]
    ds_read_b64_tr_b16 a[194:195], v246 offset:9216
    v_mfma_f32_16x16x32_bf16 v[168:171], a[208:211], a[136:139], v[168:171]
    ds_read_b64_tr_b16 a[196:197], v238 offset:8192
    s_add_u32 s34, s34, 32768
    s_cmp_ge_u32 s34, 163840
    s_cselect_b32 s34, s37, s34
    s_add_u32 s42, s42, 34048
    v_mfma_f32_16x16x32_bf16 v[172:175], a[208:211], a[140:143], v[172:175]
    ds_read_b64_tr_b16 a[198:199], v238 offset:9216
    v_mfma_f32_16x16x32_bf16 v[176:179], a[212:215], a[128:131], v[176:179]
    ds_read_b64_tr_b16 a[200:201], v246 offset:8448
    v_mfma_f32_16x16x32_bf16 v[180:183], a[212:215], a[132:135], v[180:183]
    ds_read_b64_tr_b16 a[202:203], v246 offset:9472
    s_mov_b32 m0, s34
    s_add_u32 s41, s42, 17664
    v_mfma_f32_16x16x32_bf16 v[184:187], a[212:215], a[136:139], v[184:187]
    ds_read_b64_tr_b16 a[204:205], v238 offset:8448
    v_mfma_f32_16x16x32_bf16 v[188:191], a[212:215], a[140:143], v[188:191]
    ds_read_b64_tr_b16 a[206:207], v238 offset:9472
    v_mfma_f32_16x16x32_bf16 v[192:195], a[216:219], a[128:131], v[192:195]
    buffer_load_dwordx4 a[184:187], v249, s[8:11], s28 offen offset:3072 sc1
    buffer_load_dwordx4 v242, s[16:19], s41 offen offset:0 sc1 lds
    v_mfma_f32_16x16x32_bf16 v[196:199], a[216:219], a[132:135], v[196:199]
    v_mfma_f32_16x16x32_bf16 v[200:203], a[216:219], a[136:139], v[200:203]
    buffer_load_dwordx4 a[188:191], v249, s[8:11], s29 offen offset:3072 sc1
    v_mfma_f32_16x16x32_bf16 v[204:207], a[216:219], a[140:143], v[204:207]
    buffer_load_dwordx4 v242, s[16:19], s41 offen offset:1024 sc1 lds
    v_mfma_f32_16x16x32_bf16 v[208:211], a[220:223], a[128:131], v[208:211]
    v_mfma_f32_16x16x32_bf16 v[212:215], a[220:223], a[132:135], v[212:215]
    v_mfma_f32_16x16x32_bf16 v[216:219], a[220:223], a[136:139], v[216:219]
    s_add_u32 s28, s28, 4096
    s_and_b32 s28, s28, 32767
    v_mfma_f32_16x16x32_bf16 v[220:223], a[220:223], a[140:143], v[220:223]
    s_add_u32 s29, s28, 32768
    buffer_load_dwordx4 v242, s[16:19], s41 offen offset:2048 sc1 lds
    s_waitcnt vmcnt(20) lgkmcnt(0)
    v_mfma_f32_16x16x32_bf16 v[96:99], a[192:195], a[144:147], v[96:99]
    ds_read_b64_tr_b16 a[208:209], v246 offset:8704
    s_load_dwordx2 s[80:81], s[0:1], 0
    s_load_dwordx2 s[82:83], s[0:1], 56
    s_load_dwordx4 s[84:87], s[0:1], 80
    v_mfma_f32_16x16x32_bf16 v[100:103], a[192:195], a[148:151], v[100:103]
    ds_read_b64_tr_b16 a[210:211], v246 offset:9728
    v_mfma_f32_16x16x32_bf16 v[104:107], a[192:195], a[152:155], v[104:107]
    ds_read_b64_tr_b16 a[212:213], v238 offset:8704
    buffer_load_dwordx4 v242, s[16:19], s41 offen offset:3072 sc1 lds
    v_mfma_f32_16x16x32_bf16 v[108:111], a[192:195], a[156:159], v[108:111]
    ds_read_b64_tr_b16 a[214:215], v238 offset:9728
    v_mfma_f32_16x16x32_bf16 v[112:115], a[196:199], a[144:147], v[112:115]
    ds_read_b64_tr_b16 a[216:217], v246 offset:8960
    v_mfma_f32_16x16x32_bf16 v[116:119], a[196:199], a[148:151], v[116:119]
    ds_read_b64_tr_b16 a[218:219], v246 offset:9984
    s_add_u32 m0, s34, 16384
    s_add_u32 s34, s34, 32768
    s_cmp_ge_u32 s34, 163840
    s_cselect_b32 s34, s37, s34
    v_mfma_f32_16x16x32_bf16 v[120:123], a[196:199], a[152:155], v[120:123]
    ds_read_b64_tr_b16 a[220:221], v238 offset:8960
    v_mfma_f32_16x16x32_bf16 v[124:127], a[196:199], a[156:159], v[124:127]
    ds_read_b64_tr_b16 a[222:223], v238 offset:9984
    v_mfma_f32_16x16x32_bf16 v[128:131], a[200:203], a[144:147], v[128:131]
    buffer_load_dwordx4 v242, s[16:19], s42 offen offset:0 sc1 lds
    v_mov_b32_e64 v241, v240
    v_mfma_f32_16x16x32_bf16 v[132:135], a[200:203], a[148:151], v[132:135]
    v_lshrrev_b32_e64 v230, 7, v240
    v_mfma_f32_16x16x32_bf16 v[136:139], a[200:203], a[152:155], v[136:139]
    v_mul_u32_u24 v253, 7168, v230
    v_mfma_f32_16x16x32_bf16 v[140:143], a[200:203], a[156:159], v[140:143]
    v_and_b32 v231, 0x70, v240
    v_mfma_f32_16x16x32_bf16 v[144:147], a[204:207], a[144:147], v[144:147]
    buffer_load_dwordx4 v242, s[16:19], s42 offen offset:1024 sc1 lds
    v_mfma_f32_16x16x32_bf16 v[148:151], a[204:207], a[148:151], v[148:151]
    v_add_u32_e64 v253, v253, v231
    v_mfma_f32_16x16x32_bf16 v[152:155], a[204:207], a[152:155], v[152:155]
    v_lshlrev_b32_e64 v255, 5, v230
    v_mfma_f32_16x16x32_bf16 v[156:159], a[204:207], a[156:159], v[156:159]
    buffer_load_dwordx4 v242, s[16:19], s42 offen offset:2048 sc1 lds
    s_waitcnt lgkmcnt(0)
    v_mfma_f32_16x16x32_bf16 v[160:163], a[208:211], a[144:147], v[160:163]
    ds_read_b64_tr_b16 a[192:193], v246 offset:16384
    v_and_b32 v230, 16, v240
    v_mfma_f32_16x16x32_bf16 v[164:167], a[208:211], a[148:151], v[164:167]
    ds_read_b64_tr_b16 a[194:195], v246 offset:17408
    v_mfma_f32_16x16x32_bf16 v[168:171], a[208:211], a[152:155], v[168:171]
    ds_read_b64_tr_b16 a[196:197], v238 offset:16384
    buffer_load_dwordx4 v242, s[16:19], s42 offen offset:3072 sc1 lds
    s_add_u32 s42, s42, 34048
    v_mfma_f32_16x16x32_bf16 v[172:175], a[208:211], a[156:159], v[172:175]
    ds_read_b64_tr_b16 a[198:199], v238 offset:17408
    v_add_u32_e64 v255, v255, v230
    v_mfma_f32_16x16x32_bf16 v[176:179], a[212:215], a[144:147], v[176:179]
    ds_read_b64_tr_b16 a[200:201], v246 offset:16640
    v_mfma_f32_16x16x32_bf16 v[180:183], a[212:215], a[148:151], v[180:183]
    ds_read_b64_tr_b16 a[202:203], v246 offset:17664
    s_mov_b32 m0, s34
    s_add_u32 s41, s42, 17664
    v_mfma_f32_16x16x32_bf16 v[184:187], a[212:215], a[152:155], v[184:187]
    ds_read_b64_tr_b16 a[204:205], v238 offset:16640
    v_lshrrev_b32 v231, 5, v231
    v_mfma_f32_16x16x32_bf16 v[188:191], a[212:215], a[156:159], v[188:191]
    ds_read_b64_tr_b16 a[206:207], v238 offset:17664
    v_mfma_f32_16x16x32_bf16 v[192:195], a[216:219], a[144:147], v[192:195]
    buffer_load_dwordx4 v242, s[16:19], s41 offen offset:0 sc1 lds
    v_lshl_add_u32 v255, v231, 16, v255
    v_mfma_f32_16x16x32_bf16 v[196:199], a[216:219], a[148:151], v[196:199]
    v_mov_b32_e64 v64, 0
    v_mfma_f32_16x16x32_bf16 v[200:203], a[216:219], a[152:155], v[200:203]
    v_mov_b32_e64 v65, 0
    v_mfma_f32_16x16x32_bf16 v[204:207], a[216:219], a[156:159], v[204:207]
    v_mov_b32_e64 v66, 0
    v_mfma_f32_16x16x32_bf16 v[208:211], a[220:223], a[144:147], v[208:211]
    buffer_load_dwordx4 v242, s[16:19], s41 offen offset:1024 sc1 lds
    v_mfma_f32_16x16x32_bf16 v[212:215], a[220:223], a[148:151], v[212:215]
    v_mov_b32_e64 v67, 0
    v_mfma_f32_16x16x32_bf16 v[216:219], a[220:223], a[152:155], v[216:219]
    v_mov_b32_e64 v68, 0
    v_mfma_f32_16x16x32_bf16 v[220:223], a[220:223], a[156:159], v[220:223]
    buffer_load_dwordx4 v242, s[16:19], s41 offen offset:2048 sc1 lds
    s_waitcnt vmcnt(20) lgkmcnt(0)
    v_mfma_f32_16x16x32_bf16 v[96:99], a[192:195], a[160:163], v[96:99]
    ds_read_b64_tr_b16 a[208:209], v246 offset:16896
    v_mov_b32 v69, 0
    v_mfma_f32_16x16x32_bf16 v[100:103], a[192:195], a[164:167], v[100:103]
    ds_read_b64_tr_b16 a[210:211], v246 offset:17920
    v_mfma_f32_16x16x32_bf16 v[104:107], a[192:195], a[168:171], v[104:107]
    ds_read_b64_tr_b16 a[212:213], v238 offset:16896
    buffer_load_dwordx4 v242, s[16:19], s41 offen offset:3072 sc1 lds
    v_mfma_f32_16x16x32_bf16 v[108:111], a[192:195], a[172:175], v[108:111]
    ds_read_b64_tr_b16 a[214:215], v238 offset:17920
    v_mov_b32_e64 v70, 0
    v_mfma_f32_16x16x32_bf16 v[112:115], a[196:199], a[160:163], v[112:115]
    ds_read_b64_tr_b16 a[216:217], v246 offset:17152
    v_mfma_f32_16x16x32_bf16 v[116:119], a[196:199], a[164:167], v[116:119]
    ds_read_b64_tr_b16 a[218:219], v246 offset:18176
    s_add_u32 m0, s34, 16384
    s_add_u32 s34, s34, 32768
    s_cmp_ge_u32 s34, 163840
    s_cselect_b32 s34, s37, s34
    v_mfma_f32_16x16x32_bf16 v[120:123], a[196:199], a[168:171], v[120:123]
    ds_read_b64_tr_b16 a[220:221], v238 offset:17152
    v_mov_b32 v71, 0
    v_mfma_f32_16x16x32_bf16 v[124:127], a[196:199], a[172:175], v[124:127]
    ds_read_b64_tr_b16 a[222:223], v238 offset:18176
    v_mfma_f32_16x16x32_bf16 v[128:131], a[200:203], a[160:163], v[128:131]
    v_mov_b32_e64 v72, 0
    v_mfma_f32_16x16x32_bf16 v[132:135], a[200:203], a[164:167], v[132:135]
    buffer_load_dwordx4 v242, s[16:19], s42 offen offset:0 sc1 lds
    v_mov_b32_e64 v73, 0
    v_mfma_f32_16x16x32_bf16 v[136:139], a[200:203], a[168:171], v[136:139]
    v_mov_b32_e64 v74, 0
    v_mfma_f32_16x16x32_bf16 v[140:143], a[200:203], a[172:175], v[140:143]
    v_mov_b32_e64 v75, 0
    v_mfma_f32_16x16x32_bf16 v[144:147], a[204:207], a[160:163], v[144:147]
    buffer_load_dwordx4 v242, s[16:19], s42 offen offset:1024 sc1 lds
    v_mfma_f32_16x16x32_bf16 v[148:151], a[204:207], a[164:167], v[148:151]
    v_mov_b32_e64 v76, 0
    v_mfma_f32_16x16x32_bf16 v[152:155], a[204:207], a[168:171], v[152:155]
    v_mov_b32_e64 v77, 0
    v_mfma_f32_16x16x32_bf16 v[156:159], a[204:207], a[172:175], v[156:159]
    buffer_load_dwordx4 v242, s[16:19], s42 offen offset:2048 sc1 lds
    s_waitcnt lgkmcnt(0)
    v_mfma_f32_16x16x32_bf16 v[160:163], a[208:211], a[160:163], v[160:163]
    ds_read_b64_tr_b16 a[192:193], v246 offset:24576
    v_mov_b32 v78, 0
    v_mfma_f32_16x16x32_bf16 v[164:167], a[208:211], a[164:167], v[164:167]
    ds_read_b64_tr_b16 a[194:195], v246 offset:25600
    v_mfma_f32_16x16x32_bf16 v[168:171], a[208:211], a[168:171], v[168:171]
    ds_read_b64_tr_b16 a[196:197], v238 offset:24576
    buffer_load_dwordx4 v242, s[16:19], s42 offen offset:3072 sc1 lds
    s_add_u32 s42, s42, 34048
    v_mfma_f32_16x16x32_bf16 v[172:175], a[208:211], a[172:175], v[172:175]
    ds_read_b64_tr_b16 a[198:199], v238 offset:25600
    v_mov_b32_e64 v79, 0
    v_mfma_f32_16x16x32_bf16 v[176:179], a[212:215], a[160:163], v[176:179]
    ds_read_b64_tr_b16 a[200:201], v246 offset:24832
    v_mfma_f32_16x16x32_bf16 v[180:183], a[212:215], a[164:167], v[180:183]
    ds_read_b64_tr_b16 a[202:203], v246 offset:25856
    v_mov_b32_e64 v80, 0
    v_mfma_f32_16x16x32_bf16 v[184:187], a[212:215], a[168:171], v[184:187]
    ds_read_b64_tr_b16 a[204:205], v238 offset:24832
    v_mfma_f32_16x16x32_bf16 v[188:191], a[212:215], a[172:175], v[188:191]
    ds_read_b64_tr_b16 a[206:207], v238 offset:25856
    v_mov_b32_e64 v81, 0
    v_mfma_f32_16x16x32_bf16 v[192:195], a[216:219], a[160:163], v[192:195]
    v_mov_b32_e64 v82, 0
    v_mfma_f32_16x16x32_bf16 v[196:199], a[216:219], a[164:167], v[196:199]
    v_mov_b32_e64 v83, 0
    v_mfma_f32_16x16x32_bf16 v[200:203], a[216:219], a[168:171], v[200:203]
    v_mov_b32_e64 v84, 0
    v_mfma_f32_16x16x32_bf16 v[204:207], a[216:219], a[172:175], v[204:207]
    v_mov_b32_e64 v85, 0
    v_mfma_f32_16x16x32_bf16 v[208:211], a[220:223], a[160:163], v[208:211]
    v_mov_b32_e64 v86, 0
    v_mfma_f32_16x16x32_bf16 v[212:215], a[220:223], a[164:167], v[212:215]
    v_mov_b32_e64 v87, 0
    v_mfma_f32_16x16x32_bf16 v[216:219], a[220:223], a[168:171], v[216:219]
    v_mov_b32_e64 v88, 0
    v_mfma_f32_16x16x32_bf16 v[220:223], a[220:223], a[172:175], v[220:223]
    s_waitcnt vmcnt(15) lgkmcnt(0)
    v_mfma_f32_16x16x32_bf16 v[96:99], a[192:195], a[176:179], v[96:99]
    ds_read_b64_tr_b16 a[208:209], v246 offset:25088
    v_mov_b32 v89, 0
    v_mfma_f32_16x16x32_bf16 v[100:103], a[192:195], a[180:183], v[100:103]
    ds_read_b64_tr_b16 a[210:211], v246 offset:26112
    v_mfma_f32_16x16x32_bf16 v[104:107], a[192:195], a[184:187], v[104:107]
    ds_read_b64_tr_b16 a[212:213], v238 offset:25088
    v_mov_b32_e64 v90, 0
    v_mfma_f32_16x16x32_bf16 v[108:111], a[192:195], a[188:191], v[108:111]
    ds_read_b64_tr_b16 a[214:215], v238 offset:26112
    v_mfma_f32_16x16x32_bf16 v[112:115], a[196:199], a[176:179], v[112:115]
    ds_read_b64_tr_b16 a[216:217], v246 offset:25344
    v_mov_b32_e64 v91, 0
    v_mfma_f32_16x16x32_bf16 v[116:119], a[196:199], a[180:183], v[116:119]
    ds_read_b64_tr_b16 a[218:219], v246 offset:26368
    v_mfma_f32_16x16x32_bf16 v[120:123], a[196:199], a[184:187], v[120:123]
    ds_read_b64_tr_b16 a[220:221], v238 offset:25344
    v_mov_b32_e64 v92, 0
    v_mfma_f32_16x16x32_bf16 v[124:127], a[196:199], a[188:191], v[124:127]
    ds_read_b64_tr_b16 a[222:223], v238 offset:26368
    v_mfma_f32_16x16x32_bf16 v[128:131], a[200:203], a[176:179], v[128:131]
    v_mov_b32_e64 v93, 0
    v_mfma_f32_16x16x32_bf16 v[132:135], a[200:203], a[180:183], v[132:135]
    v_mov_b32_e64 v94, 0
    v_mfma_f32_16x16x32_bf16 v[136:139], a[200:203], a[184:187], v[136:139]
    v_mov_b32_e64 v95, 0
    v_mfma_f32_16x16x32_bf16 v[140:143], a[200:203], a[188:191], v[140:143]
    v_mov_b32_e64 v224, 0
    v_mfma_f32_16x16x32_bf16 v[144:147], a[204:207], a[176:179], v[144:147]
    v_mov_b32_e64 v225, 0
    v_mfma_f32_16x16x32_bf16 v[148:151], a[204:207], a[180:183], v[148:151]
    v_mov_b32_e64 v226, 0
    v_mfma_f32_16x16x32_bf16 v[152:155], a[204:207], a[184:187], v[152:155]
    v_mov_b32_e64 v227, 0
    v_mfma_f32_16x16x32_bf16 v[156:159], a[204:207], a[188:191], v[156:159]
    s_waitcnt vmcnt(8) lgkmcnt(0)
    s_barrier
    v_mfma_f32_16x16x32_bf16 v[160:163], a[208:211], a[176:179], v[160:163]
    ds_read_b128 a[192:195], v241 offset:0
    s_mov_b32 m0, s34
    s_add_u32 s41, s42, 17664
    v_mfma_f32_16x16x32_bf16 v[164:167], a[208:211], a[180:183], v[164:167]
    ds_read_b128 a[196:199], v241 offset:1024
    buffer_load_dwordx4 v242, s[16:19], s41 offen offset:0 sc1 lds
    v_mfma_f32_16x16x32_bf16 v[168:171], a[208:211], a[184:187], v[168:171]
    ds_read_b128 a[200:203], v241 offset:2048
    v_mfma_f32_16x16x32_bf16 v[172:175], a[208:211], a[188:191], v[172:175]
    ds_read_b128 a[204:207], v241 offset:3072
    buffer_load_dwordx4 v242, s[16:19], s41 offen offset:1024 sc1 lds
    v_mfma_f32_16x16x32_bf16 v[176:179], a[212:215], a[176:179], v[176:179]
    ds_read_b128 a[224:227], v241 offset:8192
    buffer_load_dwordx4 v242, s[16:19], s41 offen offset:2048 sc1 lds
    v_mfma_f32_16x16x32_bf16 v[180:183], a[212:215], a[180:183], v[180:183]
    ds_read_b128 a[228:231], v241 offset:9216
    v_mfma_f32_16x16x32_bf16 v[184:187], a[212:215], a[184:187], v[184:187]
    ds_read_b128 a[232:235], v241 offset:10240
    buffer_load_dwordx4 v242, s[16:19], s41 offen offset:3072 sc1 lds
    v_mfma_f32_16x16x32_bf16 v[188:191], a[212:215], a[188:191], v[188:191]
    ds_read_b128 a[236:239], v241 offset:11264
    v_mfma_f32_16x16x32_bf16 v[192:195], a[216:219], a[176:179], v[192:195]
    ds_read_b128 a[240:243], v241 offset:12288
    s_add_u32 m0, s34, 16384
    s_add_u32 s34, s34, 32768
    s_cmp_ge_u32 s34, 163840
    s_cselect_b32 s34, s37, s34
    v_mfma_f32_16x16x32_bf16 v[196:199], a[216:219], a[180:183], v[196:199]
    ds_read_b128 a[244:247], v241 offset:13312
    buffer_load_dwordx4 v242, s[16:19], s42 offen offset:0 sc1 lds
    v_mfma_f32_16x16x32_bf16 v[200:203], a[216:219], a[184:187], v[200:203]
    ds_read_b128 a[248:251], v241 offset:14336
    v_mfma_f32_16x16x32_bf16 v[204:207], a[216:219], a[188:191], v[204:207]
    ds_read_b128 a[252:255], v241 offset:15360
    buffer_load_dwordx4 v242, s[16:19], s42 offen offset:1024 sc1 lds
    v_mfma_f32_16x16x32_bf16 v[208:211], a[220:223], a[176:179], v[208:211]
    buffer_load_dwordx4 v242, s[16:19], s42 offen offset:2048 sc1 lds
    v_mfma_f32_16x16x32_bf16 v[212:215], a[220:223], a[180:183], v[212:215]
    v_mfma_f32_16x16x32_bf16 v[216:219], a[220:223], a[184:187], v[216:219]
    buffer_load_dwordx4 v242, s[16:19], s42 offen offset:3072 sc1 lds
    s_add_u32 s42, s42, 34048
    v_mfma_f32_16x16x32_bf16 v[220:223], a[220:223], a[188:191], v[220:223]
    s_waitcnt lgkmcnt(8)
    ds_read_b128 a[208:211], v241 offset:4096
    ds_read_b128 a[212:215], v241 offset:5120
    ds_read_b128 a[216:219], v241 offset:6144
    ds_read_b128 a[220:223], v241 offset:7168
    s_sub_u32 s36, s36, 1
    s_cbranch_scc1 kf_fix1
kf_fixr2:
    v_cvt_pk_bf16_f32 v96, v96, v97
    v_cvt_pk_bf16_f32 v97, v98, v99
    v_cvt_pk_bf16_f32 v98, v112, v113
    v_cvt_pk_bf16_f32 v99, v114, v115
    v_accvgpr_write_b32 a128, v96
    v_accvgpr_write_b32 a129, v97
    v_accvgpr_write_b32 a130, v98
    v_accvgpr_write_b32 a131, v99
    v_cvt_pk_bf16_f32 v100, v100, v101
    v_cvt_pk_bf16_f32 v101, v102, v103
    v_cvt_pk_bf16_f32 v102, v116, v117
    v_cvt_pk_bf16_f32 v103, v118, v119
    v_accvgpr_write_b32 a144, v100
    v_accvgpr_write_b32 a145, v101
    v_accvgpr_write_b32 a146, v102
    v_accvgpr_write_b32 a147, v103
    v_cvt_pk_bf16_f32 v104, v104, v105
    v_cvt_pk_bf16_f32 v105, v106, v107
    v_cvt_pk_bf16_f32 v106, v120, v121
    v_cvt_pk_bf16_f32 v107, v122, v123
    v_accvgpr_write_b32 a160, v104
    v_accvgpr_write_b32 a161, v105
    v_accvgpr_write_b32 a162, v106
    v_accvgpr_write_b32 a163, v107
    v_cvt_pk_bf16_f32 v108, v108, v109
    v_cvt_pk_bf16_f32 v109, v110, v111
    v_cvt_pk_bf16_f32 v110, v124, v125
    v_cvt_pk_bf16_f32 v111, v126, v127
    v_accvgpr_write_b32 a176, v108
    v_accvgpr_write_b32 a177, v109
    v_accvgpr_write_b32 a178, v110
    v_accvgpr_write_b32 a179, v111
    s_nop 1
    v_mfma_f32_16x16x32_bf16 v[0:3], a[192:195], a[128:131], v[64:67]
    v_cvt_pk_bf16_f32 v128, v128, v129
    v_cvt_pk_bf16_f32 v129, v130, v131
    v_cvt_pk_bf16_f32 v130, v144, v145
    v_cvt_pk_bf16_f32 v131, v146, v147
    v_mfma_f32_16x16x32_bf16 v[8:11], a[192:195], a[144:147], v[72:75]
    v_accvgpr_write_b32 a132, v128
    v_accvgpr_write_b32 a133, v129
    v_accvgpr_write_b32 a134, v130
    v_accvgpr_write_b32 a135, v131
    v_mfma_f32_16x16x32_bf16 v[16:19], a[192:195], a[160:163], v[80:83]
    v_cvt_pk_bf16_f32 v132, v132, v133
    v_cvt_pk_bf16_f32 v133, v134, v135
    v_cvt_pk_bf16_f32 v134, v148, v149
    v_cvt_pk_bf16_f32 v135, v150, v151
    v_mfma_f32_16x16x32_bf16 v[24:27], a[192:195], a[176:179], v[88:91]
    v_accvgpr_write_b32 a148, v132
    v_accvgpr_write_b32 a149, v133
    v_accvgpr_write_b32 a150, v134
    v_accvgpr_write_b32 a151, v135
    v_mfma_f32_16x16x32_bf16 v[4:7], a[196:199], a[128:131], v[68:71]
    v_cvt_pk_bf16_f32 v136, v136, v137
    v_cvt_pk_bf16_f32 v137, v138, v139
    v_cvt_pk_bf16_f32 v138, v152, v153
    v_cvt_pk_bf16_f32 v139, v154, v155
    v_mfma_f32_16x16x32_bf16 v[12:15], a[196:199], a[144:147], v[76:79]
    v_accvgpr_write_b32 a164, v136
    v_accvgpr_write_b32 a165, v137
    v_accvgpr_write_b32 a166, v138
    v_accvgpr_write_b32 a167, v139
    v_mfma_f32_16x16x32_bf16 v[20:23], a[196:199], a[160:163], v[84:87]
    v_cvt_pk_bf16_f32 v140, v140, v141
    v_cvt_pk_bf16_f32 v141, v142, v143
    v_cvt_pk_bf16_f32 v142, v156, v157
    v_cvt_pk_bf16_f32 v143, v158, v159
    v_mfma_f32_16x16x32_bf16 v[28:31], a[196:199], a[176:179], v[92:95]
    v_accvgpr_write_b32 a180, v140
    v_accvgpr_write_b32 a181, v141
    v_accvgpr_write_b32 a182, v142
    v_accvgpr_write_b32 a183, v143
    s_nop 1
    v_mfma_f32_16x16x32_bf16 v[0:3], a[200:203], a[132:135], v[0:3]
    v_cvt_pk_bf16_f32 v160, v160, v161
    v_cvt_pk_bf16_f32 v161, v162, v163
    v_cvt_pk_bf16_f32 v162, v176, v177
    v_cvt_pk_bf16_f32 v163, v178, v179
    v_mfma_f32_16x16x32_bf16 v[8:11], a[200:203], a[148:151], v[8:11]
    v_accvgpr_write_b32 a136, v160
    v_accvgpr_write_b32 a137, v161
    v_accvgpr_write_b32 a138, v162
    v_accvgpr_write_b32 a139, v163
    v_mfma_f32_16x16x32_bf16 v[16:19], a[200:203], a[164:167], v[16:19]
    v_cvt_pk_bf16_f32 v164, v164, v165
    v_cvt_pk_bf16_f32 v165, v166, v167
    v_cvt_pk_bf16_f32 v166, v180, v181
    v_cvt_pk_bf16_f32 v167, v182, v183
    v_mfma_f32_16x16x32_bf16 v[24:27], a[200:203], a[180:183], v[24:27]
    v_accvgpr_write_b32 a152, v164
    v_accvgpr_write_b32 a153, v165
    v_accvgpr_write_b32 a154, v166
    v_accvgpr_write_b32 a155, v167
    v_mfma_f32_16x16x32_bf16 v[4:7], a[204:207], a[132:135], v[4:7]
    v_cvt_pk_bf16_f32 v168, v168, v169
    v_cvt_pk_bf16_f32 v169, v170, v171
    v_cvt_pk_bf16_f32 v170, v184, v185
    v_cvt_pk_bf16_f32 v171, v186, v187
    v_mfma_f32_16x16x32_bf16 v[12:15], a[204:207], a[148:151], v[12:15]
    v_accvgpr_write_b32 a168, v168
    v_accvgpr_write_b32 a169, v169
    v_accvgpr_write_b32 a170, v170
    v_accvgpr_write_b32 a171, v171
    v_mfma_f32_16x16x32_bf16 v[20:23], a[204:207], a[164:167], v[20:23]
    v_cvt_pk_bf16_f32 v172, v172, v173
    v_cvt_pk_bf16_f32 v173, v174, v175
    v_cvt_pk_bf16_f32 v174, v188, v189
    v_cvt_pk_bf16_f32 v175, v190, v191
    v_mfma_f32_16x16x32_bf16 v[28:31], a[204:207], a[180:183], v[28:31]
    v_accvgpr_write_b32 a184, v172
    v_accvgpr_write_b32 a185, v173
    v_accvgpr_write_b32 a186, v174
    v_accvgpr_write_b32 a187, v175
    s_nop 1
    s_waitcnt lgkmcnt(0)
    v_mfma_f32_16x16x32_bf16 v[0:3], a[208:211], a[136:139], v[0:3]
    v_cvt_pk_bf16_f32 v192, v192, v193
    v_cvt_pk_bf16_f32 v193, v194, v195
    v_cvt_pk_bf16_f32 v194, v208, v209
    v_cvt_pk_bf16_f32 v195, v210, v211
    v_mfma_f32_16x16x32_bf16 v[8:11], a[208:211], a[152:155], v[8:11]
    v_accvgpr_write_b32 a140, v192
    v_accvgpr_write_b32 a141, v193
    v_accvgpr_write_b32 a142, v194
    v_accvgpr_write_b32 a143, v195
    v_mfma_f32_16x16x32_bf16 v[16:19], a[208:211], a[168:171], v[16:19]
    v_cvt_pk_bf16_f32 v196, v196, v197
    v_cvt_pk_bf16_f32 v197, v198, v199
    v_cvt_pk_bf16_f32 v198, v212, v213
    v_cvt_pk_bf16_f32 v199, v214, v215
    v_mfma_f32_16x16x32_bf16 v[24:27], a[208:211], a[184:187], v[24:27]
    v_accvgpr_write_b32 a156, v196
    v_accvgpr_write_b32 a157, v197
    v_accvgpr_write_b32 a158, v198
    v_accvgpr_write_b32 a159, v199
    v_mfma_f32_16x16x32_bf16 v[4:7], a[212:215], a[136:139], v[4:7]
    v_cvt_pk_bf16_f32 v200, v200, v201
    v_cvt_pk_bf16_f32 v201, v202, v203
    v_cvt_pk_bf16_f32 v202, v216, v217
    v_cvt_pk_bf16_f32 v203, v218, v219
    v_mfma_f32_16x16x32_bf16 v[12:15], a[212:215], a[152:155], v[12:15]
    v_accvgpr_write_b32 a172, v200
    v_accvgpr_write_b32 a173, v201
    v_accvgpr_write_b32 a174, v202
    v_accvgpr_write_b32 a175, v203
    v_mfma_f32_16x16x32_bf16 v[20:23], a[212:215], a[168:171], v[20:23]
    v_cvt_pk_bf16_f32 v204, v204, v205
    v_cvt_pk_bf16_f32 v205, v206, v207
    v_cvt_pk_bf16_f32 v206, v220, v221
    v_cvt_pk_bf16_f32 v207, v222, v223
    v_mfma_f32_16x16x32_bf16 v[28:31], a[212:215], a[184:187], v[28:31]
    v_accvgpr_write_b32 a188, v204
    v_accvgpr_write_b32 a189, v205
    v_accvgpr_write_b32 a190, v206
    v_accvgpr_write_b32 a191, v207
    s_nop 1
    v_mfma_f32_16x16x32_bf16 v[0:3], a[216:219], a[140:143], v[0:3]
    v_mov_b32 v144, 0
    v_mov_b32 v145, 0
    v_mov_b32_e64 v146, 0
    v_mfma_f32_16x16x32_bf16 v[8:11], a[216:219], a[156:159], v[8:11]
    v_mov_b32 v147, 0
    v_mov_b32 v148, 0
    v_mfma_f32_16x16x32_bf16 v[16:19], a[216:219], a[172:175], v[16:19]
    v_mov_b32 v149, 0
    v_mov_b32 v150, 0
    v_mov_b32_e64 v151, 0
    v_mfma_f32_16x16x32_bf16 v[24:27], a[216:219], a[188:191], v[24:27]
    v_mov_b32 v152, 0
    v_mov_b32 v153, 0
    v_mfma_f32_16x16x32_bf16 v[4:7], a[220:223], a[140:143], v[4:7]
    v_mov_b32 v154, 0
    v_mov_b32 v155, 0
    v_mov_b32_e64 v156, 0
    v_mfma_f32_16x16x32_bf16 v[12:15], a[220:223], a[156:159], v[12:15]
    v_mov_b32 v157, 0
    v_mov_b32 v158, 0
    v_mfma_f32_16x16x32_bf16 v[20:23], a[220:223], a[172:175], v[20:23]
    v_mov_b32_e64 v159, 0
    v_mov_b32 v204, 0x3f803f80
    v_mov_b32 v205, 0x3f803f80
    v_mfma_f32_16x16x32_bf16 v[28:31], a[220:223], a[188:191], v[28:31]
    v_mov_b32 v206, 0x3f803f80
    v_mov_b32 v207, 0x3f803f80
    s_nop 4
    v_max3_f32 v128, v0, v1, v2
    v_max3_f32 v130, v8, v9, v10
    v_max3_f32 v132, v16, v17, v18
    v_max3_f32 v134, v24, v25, v26
    v_max3_f32 v128, v128, v3, v4
    v_max3_f32 v130, v130, v11, v12
    v_max3_f32 v132, v132, v19, v20
    v_max3_f32 v134, v134, v27, v28
    v_max3_f32 v128, v128, v5, v6
    v_max3_f32 v130, v130, v13, v14
    v_max3_f32 v132, v132, v21, v22
    v_max3_f32 v134, v134, v29, v30
    v_max_f32 v128, v128, v7
    v_max_f32 v130, v130, v15
    v_max_f32 v132, v132, v23
    v_max_f32 v134, v134, v31
    v_mov_b32 v129, v128
    v_mov_b32 v131, v130
    v_mov_b32 v133, v132
    v_mov_b32 v135, v134
    v_permlane16_swap_b32 v128, v129
    v_permlane16_swap_b32 v130, v131
    v_permlane16_swap_b32 v132, v133
    v_permlane16_swap_b32 v134, v135
    v_max_f32 v128, v128, v129
    v_max_f32 v130, v130, v131
    v_max_f32 v132, v132, v133
    v_max_f32 v134, v134, v135
    v_mov_b32 v129, v128
    v_mov_b32 v131, v130
    v_mov_b32 v133, v132
    v_mov_b32 v135, v134
    v_permlane32_swap_b32 v128, v129
    v_permlane32_swap_b32 v130, v131
    v_permlane32_swap_b32 v132, v133
    v_permlane32_swap_b32 v134, v135
    v_max_f32 v128, v128, v129
    v_max_f32 v130, v130, v131
    v_max_f32 v132, v132, v133
    v_max_f32_e64 v134, v134, v135
    v_add_f32 v128, 0x41800000, v128
    v_add_f32 v130, 0x41800000, v130
    v_add_f32 v132, 0x41800000, v132
    v_add_f32 v134, 0x41800000, v134
    v_sub_f32 v224, 0, v128
    v_sub_f32 v64, v64, v128
    v_sub_f32 v65, v65, v128
    v_sub_f32 v66, v66, v128
    v_sub_f32 v67, v67, v128
    v_sub_f32 v68, v68, v128
    v_sub_f32 v69, v69, v128
    v_sub_f32 v70, v70, v128
    v_sub_f32 v71, v71, v128
    v_sub_f32 v225, 0, v130
    v_sub_f32 v72, v72, v130
    v_sub_f32 v73, v73, v130
    v_sub_f32 v74, v74, v130
    v_sub_f32 v75, v75, v130
    v_sub_f32 v76, v76, v130
    v_sub_f32 v77, v77, v130
    v_sub_f32 v78, v78, v130
    v_sub_f32 v79, v79, v130
    v_sub_f32 v226, 0, v132
    v_sub_f32 v80, v80, v132
    v_sub_f32 v81, v81, v132
    v_sub_f32 v82, v82, v132
    v_sub_f32 v83, v83, v132
    v_sub_f32 v84, v84, v132
    v_sub_f32 v85, v85, v132
    v_sub_f32 v86, v86, v132
    v_sub_f32 v87, v87, v132
    v_sub_f32 v227, 0, v134
    v_sub_f32 v88, v88, v134
    v_sub_f32 v89, v89, v134
    v_sub_f32 v90, v90, v134
    v_sub_f32 v91, v91, v134
    v_sub_f32 v92, v92, v134
    v_sub_f32 v93, v93, v134
    v_sub_f32 v94, v94, v134
    v_sub_f32 v95, v95, v134
    v_sub_f32 v0, v0, v128
    v_sub_f32 v1, v1, v128
    v_sub_f32 v2, v2, v128
    v_sub_f32 v3, v3, v128
    v_sub_f32 v4, v4, v128
    v_sub_f32 v5, v5, v128
    v_sub_f32 v6, v6, v128
    v_sub_f32 v7, v7, v128
    v_sub_f32 v8, v8, v130
    v_sub_f32 v9, v9, v130
    v_sub_f32 v10, v10, v130
    v_sub_f32 v11, v11, v130
    v_sub_f32 v12, v12, v130
    v_sub_f32 v13, v13, v130
    v_sub_f32 v14, v14, v130
    v_sub_f32 v15, v15, v130
    v_sub_f32 v16, v16, v132
    v_sub_f32 v17, v17, v132
    v_sub_f32 v18, v18, v132
    v_sub_f32 v19, v19, v132
    v_sub_f32 v20, v20, v132
    v_sub_f32 v21, v21, v132
    v_sub_f32 v22, v22, v132
    v_sub_f32 v23, v23, v132
    v_sub_f32 v24, v24, v134
    v_sub_f32 v25, v25, v134
    v_sub_f32 v26, v26, v134
    v_sub_f32 v27, v27, v134
    v_sub_f32 v28, v28, v134
    v_sub_f32 v29, v29, v134
    v_sub_f32 v30, v30, v134
    v_sub_f32 v31, v31, v134
    s_mov_b32 s35, 32768
    v_add_u32_e64 v241, s35, v240
    s_sub_u32 s36, s36, 1
    s_cbranch_scc1 kf_fix3
kf_fixr4:
    v_mfma_f32_16x16x32_bf16 v[32:35], a[224:227], a[128:131], v[64:67]
    ds_read_b128 a[192:195], v241 offset:0
    v_exp_f32_e64 v128, v0
    v_mfma_f32_16x16x32_bf16 v[40:43], a[224:227], a[144:147], v[72:75]
    v_exp_f32_e64 v129, v1
    v_mfma_f32_16x16x32_bf16 v[48:51], a[224:227], a[160:163], v[80:83]
    v_exp_f32_e64 v130, v2
    v_cvt_pk_bf16_f32 v96, v128, v129
    v_mfma_f32_16x16x32_bf16 v[56:59], a[224:227], a[176:179], v[88:91]
    v_exp_f32_e64 v131, v3
    v_mfma_f32_16x16x32_bf16 v[36:39], a[228:231], a[128:131], v[68:71]
    ds_read_b128 a[196:199], v241 offset:1024
    v_exp_f32_e64 v132, v4
    v_mfma_f32_16x16x32_bf16 v[44:47], a[228:231], a[144:147], v[76:79]
    v_exp_f32_e64 v133, v5
    v_cvt_pk_bf16_f32 v97, v130, v131
    v_mfma_f32_16x16x32_bf16 v[52:55], a[228:231], a[160:163], v[84:87]
    v_exp_f32_e64 v134, v6
    v_cvt_pk_bf16_f32 v98, v132, v133
    v_mfma_f32_16x16x32_bf16 v[60:63], a[228:231], a[176:179], v[92:95]
    v_exp_f32_e64 v135, v7
    v_mfma_f32_16x16x32_bf16 v[32:35], a[232:235], a[132:135], v[32:35]
    ds_read_b128 a[200:203], v241 offset:2048
    v_exp_f32_e64 v136, v8
    v_mfma_f32_16x16x32_bf16 v[40:43], a[232:235], a[148:151], v[40:43]
    v_exp_f32_e64 v137, v9
    v_cvt_pk_bf16_f32 v99, v134, v135
    v_mfma_f32_16x16x32_bf16 v[48:51], a[232:235], a[164:167], v[48:51]
    v_exp_f32 v138, v10
    v_exp_f32 v139, v11
    v_mfma_f32_16x16x32_bf16 v[56:59], a[232:235], a[180:183], v[56:59]
    v_exp_f32_e64 v140, v12
    v_cvt_pk_bf16_f32 v100, v136, v137
    v_mfma_f32_16x16x32_bf16 v[36:39], a[236:239], a[132:135], v[36:39]
    ds_read_b128 a[204:207], v241 offset:3072
    v_exp_f32_e64 v141, v13
    v_mfma_f32_16x16x32_bf16 v[44:47], a[236:239], a[148:151], v[44:47]
    v_exp_f32_e64 v142, v14
    v_cvt_pk_bf16_f32 v101, v138, v139
    v_mfma_f32_16x16x32_bf16 v[52:55], a[236:239], a[164:167], v[52:55]
    v_exp_f32_e64 v143, v15
    v_cvt_pk_bf16_f32 v102, v140, v141
    v_mfma_f32_16x16x32_bf16 v[60:63], a[236:239], a[180:183], v[60:63]
    v_exp_f32_e64 v128, v16
    v_cvt_pk_bf16_f32 v103, v142, v143
    v_mfma_f32_16x16x32_bf16 v[32:35], a[240:243], a[136:139], v[32:35]
    ds_read_b128 a[208:211], v241 offset:4096
    v_exp_f32_e64 v129, v17
    v_mfma_f32_16x16x32_bf16 v[40:43], a[240:243], a[152:155], v[40:43]
    v_exp_f32_e64 v130, v18
    v_cvt_pk_bf16_f32 v104, v128, v129
    v_mfma_f32_16x16x32_bf16 v[48:51], a[240:243], a[168:171], v[48:51]
    v_exp_f32_e64 v131, v19
    v_mfma_f32_16x16x32_bf16 v[56:59], a[240:243], a[184:187], v[56:59]
    v_exp_f32_e64 v132, v20
    v_cvt_pk_bf16_f32 v105, v130, v131
    v_mfma_f32_16x16x32_bf16 v[36:39], a[244:247], a[136:139], v[36:39]
    ds_read_b128 a[212:215], v241 offset:5120
    v_exp_f32_e64 v133, v21
    v_mfma_f32_16x16x32_bf16 v[44:47], a[244:247], a[152:155], v[44:47]
    v_exp_f32 v134, v22
    v_exp_f32 v135, v23
    v_mfma_f32_16x16x32_bf16 v[52:55], a[244:247], a[168:171], v[52:55]
    v_exp_f32_e64 v136, v24
    v_cvt_pk_bf16_f32 v106, v132, v133
    v_mfma_f32_16x16x32_bf16 v[60:63], a[244:247], a[184:187], v[60:63]
    v_exp_f32_e64 v137, v25
    v_cvt_pk_bf16_f32 v107, v134, v135
    v_mfma_f32_16x16x32_bf16 v[32:35], a[248:251], a[140:143], v[32:35]
    ds_read_b128 a[216:219], v241 offset:6144
    v_exp_f32_e64 v138, v26
    v_mfma_f32_16x16x32_bf16 v[40:43], a[248:251], a[156:159], v[40:43]
    v_exp_f32_e64 v139, v27
    v_cvt_pk_bf16_f32 v108, v136, v137
    v_mfma_f32_16x16x32_bf16 v[48:51], a[248:251], a[172:175], v[48:51]
    v_exp_f32_e64 v140, v28
    v_cvt_pk_bf16_f32 v109, v138, v139
    v_mfma_f32_16x16x32_bf16 v[56:59], a[248:251], a[188:191], v[56:59]
    v_exp_f32_e64 v141, v29
    v_mfma_f32_16x16x32_bf16 v[36:39], a[252:255], a[140:143], v[36:39]
    ds_read_b128 a[220:223], v241 offset:7168
    v_exp_f32_e64 v142, v30
    v_mfma_f32_16x16x32_bf16 v[44:47], a[252:255], a[156:159], v[44:47]
    v_exp_f32_e64 v143, v31
    v_cvt_pk_bf16_f32 v110, v140, v141
    v_mfma_f32_16x16x32_bf16 v[52:55], a[252:255], a[172:175], v[52:55]
    v_cvt_pk_bf16_f32 v111, v142, v143
    v_mfma_f32_16x16x32_bf16 v[60:63], a[252:255], a[188:191], v[60:63]
    v_add_f32 v200, 0, v243
    v_min_f32 v200, 0, v200
    v_add_f32 v201, 0xf1800000, v243
    v_min_f32_e64 v201, 0, v201
    v_add_f32 v202, 0xf2000000, v243
    v_min_f32_e64 v202, 0, v202
    v_add_f32 v203, 0xf2400000, v243
    v_min_f32_e64 v203, 0, v203
    v_add_f32 v209, 0xf3000000, v243
    v_min_f32_e64 v209, 0, v209
    v_add_f32 v210, 0xf3100000, v243
    v_min_f32_e64 v210, 0, v210
    v_add_f32 v211, 0xf3200000, v243
    v_min_f32_e64 v211, 0, v211
    v_add_f32 v212, 0xf3300000, v243
    v_min_f32_e64 v212, 0, v212
    v_add_f32 v213, 0x73800000, v243
    v_min_f32_e64 v213, 0, v213
    v_add_f32 v214, 0x73700000, v243
    v_min_f32_e64 v214, 0, v214
    v_add_f32 v215, 0x73600000, v243
    v_min_f32_e64 v215, 0, v215
    v_add_f32 v216, 0x73500000, v243
    v_min_f32_e64 v216, 0, v216
    v_add_f32 v217, 0x73000000, v243
    v_min_f32_e64 v217, 0, v217
    v_add_f32 v218, 0x72e00000, v243
    v_min_f32_e64 v218, 0, v218
    v_add_f32 v219, 0x72c00000, v243
    v_min_f32_e64 v219, 0, v219
    v_add_f32 v220, 0x72a00000, v243
    v_min_f32_e64 v220, 0, v220
    ds_read_b128 a[224:227], v241 offset:16384
    ds_read_b128 a[228:231], v241 offset:17408
    ds_read_b128 a[232:235], v241 offset:18432
    ds_read_b128 a[236:239], v241 offset:19456
    s_mul_i32 s27, s5, 68096
    s_sub_u32 s27, s32, s27
    s_add_u32 s18, s27, 1089536
    s_mov_b32 s31, s101
    v_mul_u32_u24 v245, 448, v240
    v_and_b32 v230, 0x40000000, v251
    v_or_b32 v245, v245, v230
    s_lshl1_add_u32 s26, s5, s31
    s_branch ka_p1_e
.p2align 5
ka_p1:
    s_sub_u32 s36, s36, 1
    s_cbranch_scc1 kf_fix7
kf_fixr8:
    s_waitcnt lgkmcnt(8)
    v_mfma_f32_16x16x32_bf16 v[0:3], a[192:195], a[128:131], v[64:67]
    ds_read_b128 a[240:243], v241 offset:20480
    s_waitcnt vmcnt(11)
    v_mfma_f32_16x16x32_bf16 v[8:11], a[192:195], a[144:147], v[72:75]
    v_exp_f32_e64 v128, v32
    v_mfma_f32_16x16x32_bf16 v[16:19], a[192:195], a[160:163], v[80:83]
    v_exp_f32_e64 v129, v33
    v_mfma_f32_16x16x32_bf16 v[24:27], a[192:195], a[176:179], v[88:91]
    v_exp_f32_e64 v130, v34
    v_mfma_f32_16x16x32_bf16 v[4:7], a[196:199], a[128:131], v[68:71]
    ds_read_b128 a[244:247], v241 offset:21504
    buffer_store_dwordx4 v[192:195], v255, s[48:51], s45 offen offset:0 sc1
    v_mfma_f32_16x16x32_bf16 v[12:15], a[196:199], a[144:147], v[76:79]
    s_cmp_lt_u32 s44, s47
    s_cselect_b32 s101, s44, s43
    v_mfma_f32_16x16x32_bf16 v[20:23], a[196:199], a[160:163], v[84:87]
    buffer_load_dwordx4 v[192:195], v253, s[52:55], s101 offen
    v_cvt_pk_bf16_f32 v112, v128, v129
    v_mfma_f32_16x16x32_bf16 v[28:31], a[196:199], a[176:179], v[92:95]
    v_exp_f32_e64 v131, v35
    v_mfma_f32_16x16x32_bf16 v[0:3], a[200:203], a[132:135], v[0:3]
    ds_read_b128 a[248:251], v241 offset:22528
    v_cvt_pk_bf16_f32 v113, v130, v131
    v_mfma_f32_16x16x32_bf16 v[8:11], a[200:203], a[148:151], v[8:11]
    v_exp_f32_e64 v132, v36
    v_mfma_f32_16x16x32_bf16 v[16:19], a[200:203], a[164:167], v[16:19]
    v_exp_f32_e64 v133, v37
    v_mfma_f32_16x16x32_bf16 v[24:27], a[200:203], a[180:183], v[24:27]
    v_exp_f32_e64 v134, v38
    v_mfma_f32_16x16x32_bf16 v[4:7], a[204:207], a[132:135], v[4:7]
    ds_read_b128 a[252:255], v241 offset:23552
    s_mov_b32 m0, s34
    v_mfma_f32_16x16x32_bf16 v[12:15], a[204:207], a[148:151], v[12:15]
    s_add_u32 s41, s42, 17664
    v_cvt_pk_bf16_f32 v114, v132, v133
    v_mfma_f32_16x16x32_bf16 v[20:23], a[204:207], a[164:167], v[20:23]
    v_exp_f32 v135, v39
    v_mfma_f32_16x16x32_bf16 v[28:31], a[204:207], a[180:183], v[28:31]
    v_or3_b32 v208, v112, v113, v114
    s_waitcnt lgkmcnt(8)
    v_mfma_f32_16x16x32_bf16 v[0:3], a[208:211], a[136:139], v[0:3]
    ds_read_b128 a[192:195], v241 offset:8192
    v_cvt_pk_bf16_f32 v115, v134, v135
    v_mfma_f32_16x16x32_bf16 v[8:11], a[208:211], a[152:155], v[8:11]
    v_exp_f32 v136, v40
    v_mfma_f32_16x16x32_bf16 v[16:19], a[208:211], a[168:171], v[16:19]
    v_exp_f32_e64 v137, v41
    v_mfma_f32_16x16x32_bf16 v[24:27], a[208:211], a[184:187], v[24:27]
    v_exp_f32_e64 v138, v42
    v_mfma_f32_16x16x32_bf16 v[4:7], a[212:215], a[136:139], v[4:7]
    ds_read_b128 a[196:199], v241 offset:9216
    buffer_load_dwordx4 v242, s[16:19], s41 offen offset:0 sc1 lds
    v_mfma_f32_16x16x32_bf16 v[12:15], a[212:215], a[152:155], v[12:15]
    v_exp_f32_e64 v139, v43
    v_mfma_f32_16x16x32_bf16 v[20:23], a[212:215], a[168:171], v[20:23]
    v_exp_f32_e64 v140, v44
    v_mfma_f32_16x16x32_bf16 v[28:31], a[212:215], a[184:187], v[28:31]
    v_exp_f32_e64 v141, v45
    v_mfma_f32_16x16x32_bf16 v[0:3], a[216:219], a[140:143], v[0:3]
    ds_read_b128 a[200:203], v241 offset:10240
    v_cvt_pk_bf16_f32 v116, v136, v137
    v_mfma_f32_16x16x32_bf16 v[8:11], a[216:219], a[156:159], v[8:11]
    v_exp_f32_e64 v142, v46
    v_mfma_f32_16x16x32_bf16 v[16:19], a[216:219], a[172:175], v[16:19]
    v_exp_f32_e64 v143, v47
    v_mfma_f32_16x16x32_bf16 v[24:27], a[216:219], a[188:191], v[24:27]
    v_or3_b32 v208, v208, v115, v116
    v_cvt_pk_bf16_f32 v117, v138, v139
    v_mfma_f32_16x16x32_bf16 v[4:7], a[220:223], a[140:143], v[4:7]
    ds_read_b128 a[204:207], v241 offset:11264
    buffer_load_dwordx4 v242, s[16:19], s41 offen offset:1024 sc1 lds
    v_mfma_f32_16x16x32_bf16 v[12:15], a[220:223], a[156:159], v[12:15]
    v_exp_f32_e64 v128, v48
    v_mfma_f32_16x16x32_bf16 v[20:23], a[220:223], a[172:175], v[20:23]
    v_exp_f32_e64 v129, v49
    v_mfma_f32_16x16x32_bf16 v[28:31], a[220:223], a[188:191], v[28:31]
    v_cvt_pk_bf16_f32 v118, v140, v141
    s_waitcnt lgkmcnt(8)
    v_mfma_f32_16x16x32_bf16 a[0:3], a[224:227], v[96:99], a[0:3]
    ds_read_b128 a[208:211], v241 offset:12288
    v_or3_b32 v208, v208, v117, v118
    v_mfma_f32_16x16x32_bf16 a[32:35], a[224:227], v[100:103], a[32:35]
    v_exp_f32 v130, v50
    v_mfma_f32_16x16x32_bf16 a[64:67], a[224:227], v[104:107], a[64:67]
    v_exp_f32_e64 v131, v51
    v_mfma_f32_16x16x32_bf16 a[96:99], a[224:227], v[108:111], a[96:99]
    v_exp_f32_e64 v132, v52
    v_mfma_f32_16x16x32_bf16 a[4:7], a[228:231], v[96:99], a[4:7]
    ds_read_b128 a[212:215], v241 offset:13312
    v_cvt_pk_bf16_f32 v119, v142, v143
    v_mfma_f32_16x16x32_bf16 a[36:39], a[228:231], v[100:103], a[36:39]
    buffer_load_dwordx4 v242, s[16:19], s41 offen offset:2048 sc1 lds
    v_cvt_pk_bf16_f32 v120, v128, v129
    v_mfma_f32_16x16x32_bf16 a[68:71], a[228:231], v[104:107], a[68:71]
    v_exp_f32_e64 v133, v53
    v_mfma_f32_16x16x32_bf16 a[100:103], a[228:231], v[108:111], a[100:103]
    v_exp_f32_e64 v134, v54
    v_mfma_f32_16x16x32_bf16 a[8:11], a[232:235], v[96:99], a[8:11]
    ds_read_b128 a[216:219], v241 offset:14336
    v_or3_b32 v208, v208, v119, v120
    v_mfma_f32_16x16x32_bf16 a[40:43], a[232:235], v[100:103], a[40:43]
    v_exp_f32_e64 v135, v55
    v_mfma_f32_16x16x32_bf16 a[72:75], a[232:235], v[104:107], a[72:75]
    v_exp_f32_e64 v136, v56
    v_mfma_f32_16x16x32_bf16 a[104:107], a[232:235], v[108:111], a[104:107]
    v_exp_f32_e64 v137, v57
    v_mfma_f32_16x16x32_bf16 a[12:15], a[236:239], v[96:99], a[12:15]
    ds_read_b128 a[220:223], v241 offset:15360
    v_cvt_pk_bf16_f32 v121, v130, v131
    v_mfma_f32_16x16x32_bf16 a[44:47], a[236:239], v[100:103], a[44:47]
    v_cvt_pk_bf16_f32 v122, v132, v133
    v_or3_b32 v208, v208, v121, v122
    v_mfma_f32_16x16x32_bf16 a[76:79], a[236:239], v[104:107], a[76:79]
    buffer_load_dwordx4 v242, s[16:19], s41 offen offset:3072 sc1 lds
    v_cvt_pk_bf16_f32 v123, v134, v135
    v_mfma_f32_16x16x32_bf16 a[108:111], a[236:239], v[108:111], a[108:111]
    v_cvt_pk_bf16_f32 v124, v136, v137
    s_waitcnt lgkmcnt(8)
    v_mfma_f32_16x16x32_bf16 a[16:19], a[240:243], v[96:99], a[16:19]
    ds_read_b128 a[224:227], v241 offset:24576
    v_or3_b32 v208, v208, v123, v124
    v_mfma_f32_16x16x32_bf16 a[48:51], a[240:243], v[100:103], a[48:51]
    v_exp_f32 v138, v58
    v_mfma_f32_16x16x32_bf16 a[80:83], a[240:243], v[104:107], a[80:83]
    v_exp_f32_e64 v139, v59
    v_mfma_f32_16x16x32_bf16 a[112:115], a[240:243], v[108:111], a[112:115]
    v_exp_f32_e64 v140, v60
    v_mfma_f32_16x16x32_bf16 a[20:23], a[244:247], v[96:99], a[20:23]
    ds_read_b128 a[228:231], v241 offset:25600
    v_cvt_pk_bf16_f32 v125, v138, v139
    v_mfma_f32_16x16x32_bf16 a[52:55], a[244:247], v[100:103], a[52:55]
    v_exp_f32_e64 v141, v61
    v_mfma_f32_16x16x32_bf16 a[84:87], a[244:247], v[104:107], a[84:87]
    v_exp_f32_e64 v142, v62
    v_mfma_f32_16x16x32_bf16 a[116:119], a[244:247], v[108:111], a[116:119]
    s_add_u32 s35, s35, 32768
    v_cvt_pk_bf16_f32 v126, v140, v141
    v_mfma_f32_16x16x32_bf16 a[24:27], a[248:251], v[96:99], a[24:27]
    ds_read_b128 a[232:235], v241 offset:26624
    v_or3_b32 v208, v208, v125, v126
    v_mfma_f32_16x16x32_bf16 a[56:59], a[248:251], v[100:103], a[56:59]
    s_cmp_ge_u32 s35, 163840
    s_cselect_b32 s35, 0, s35
    v_mfma_f32_16x16x32_bf16 a[88:91], a[248:251], v[104:107], a[88:91]
    v_exp_f32 v143, v63
    v_mfma_f32_16x16x32_bf16 a[120:123], a[248:251], v[108:111], a[120:123]
    v_cvt_pk_bf16_f32 v127, v142, v143
    v_or_b32_e64 v208, v208, v127
    v_mfma_f32_16x16x32_bf16 a[28:31], a[252:255], v[96:99], a[28:31]
    ds_read_b128 a[236:239], v241 offset:27648
    v_and_b32_e64 v208, s38, v208
    v_mfma_f32_16x16x32_bf16 a[60:63], a[252:255], v[100:103], a[60:63]
    v_cmp_ne_u32_e64 vcc, 0, v208
    v_mfma_f32_16x16x32_bf16 a[92:95], a[252:255], v[104:107], a[92:95]
    v_mfma_f32_16x16x32_bf16 a[124:127], a[252:255], v[108:111], a[124:127]
    v_mfma_f32_16x16x32_bf16 v[144:147], v[204:207], v[96:99], v[144:147]
    v_mfma_f32_16x16x32_bf16 v[148:151], v[204:207], v[100:103], v[148:151]
    v_mfma_f32_16x16x32_bf16 v[152:155], v[204:207], v[104:107], v[152:155]
    v_mfma_f32_16x16x32_bf16 v[156:159], v[204:207], v[108:111], v[156:159]
    s_cbranch_vccnz kf_rare6
kf_rr5:
    s_sub_u32 s36, s36, 1
    s_cbranch_scc1 kf_fix11
kf_fixr12:
    s_waitcnt lgkmcnt(8)
    v_mfma_f32_16x16x32_bf16 v[32:35], a[192:195], a[128:131], v[64:67]
    ds_read_b128 a[240:243], v241 offset:28672
    s_waitcnt vmcnt(11)
    v_mfma_f32_16x16x32_bf16 v[40:43], a[192:195], a[144:147], v[72:75]
    v_exp_f32 v128, v0
    v_mfma_f32_16x16x32_bf16 v[48:51], a[192:195], a[160:163], v[80:83]
    v_exp_f32_e64 v129, v1
    v_mfma_f32_16x16x32_bf16 v[56:59], a[192:195], a[176:179], v[88:91]
    v_exp_f32_e64 v130, v2
    v_mfma_f32_16x16x32_bf16 v[36:39], a[196:199], a[128:131], v[68:71]
    ds_read_b128 a[244:247], v241 offset:29696
    buffer_store_dwordx4 v[196:199], v255, s[48:51], s45 offen offset:256 sc1
    v_mfma_f32_16x16x32_bf16 v[44:47], a[196:199], a[144:147], v[76:79]
    s_add_u32 s101, s101, 57344
    buffer_load_dwordx4 v[196:199], v253, s[52:55], s101 offen
    v_mfma_f32_16x16x32_bf16 v[52:55], a[196:199], a[160:163], v[84:87]
    v_exp_f32_e64 v131, v3
    v_mfma_f32_16x16x32_bf16 v[60:63], a[196:199], a[176:179], v[92:95]
    v_exp_f32_e64 v132, v4
    v_mfma_f32_16x16x32_bf16 v[32:35], a[200:203], a[132:135], v[32:35]
    ds_read_b128 a[248:251], v241 offset:30720
    v_cvt_pk_bf16_f32 v96, v128, v129
    v_mfma_f32_16x16x32_bf16 v[40:43], a[200:203], a[148:151], v[40:43]
    s_cmp_lt_u32 s44, s47
    s_cselect_b32 s45, s46, s43
    v_mfma_f32_16x16x32_bf16 v[48:51], a[200:203], a[164:167], v[48:51]
    v_exp_f32_e64 v133, v5
    v_mfma_f32_16x16x32_bf16 v[56:59], a[200:203], a[180:183], v[56:59]
    v_exp_f32_e64 v134, v6
    v_mfma_f32_16x16x32_bf16 v[36:39], a[204:207], a[132:135], v[36:39]
    ds_read_b128 a[252:255], v241 offset:31744
    s_add_u32 s44, s44, 128
    v_mfma_f32_16x16x32_bf16 v[44:47], a[204:207], a[148:151], v[44:47]
    s_add_u32 s46, s46, 262144
    v_cvt_pk_bf16_f32 v97, v130, v131
    v_mfma_f32_16x16x32_bf16 v[52:55], a[204:207], a[164:167], v[52:55]
    v_exp_f32_e64 v135, v7
    v_mfma_f32_16x16x32_bf16 v[60:63], a[204:207], a[180:183], v[60:63]
    v_cvt_pk_bf16_f32 v98, v132, v133
    s_waitcnt lgkmcnt(8)
    v_mfma_f32_16x16x32_bf16 v[32:35], a[208:211], a[136:139], v[32:35]
    s_waitcnt vmcnt(16)
    s_barrier
    v_add_u32 v241, s35, v240
    ds_read_b128 a[192:195], v241 offset:0
    v_mfma_f32_16x16x32_bf16 v[40:43], a[208:211], a[152:155], v[40:43]
    v_exp_f32_e64 v136, v8
    v_mfma_f32_16x16x32_bf16 v[48:51], a[208:211], a[168:171], v[48:51]
    v_exp_f32_e64 v137, v9
    v_mfma_f32_16x16x32_bf16 v[56:59], a[208:211], a[184:187], v[56:59]
    v_exp_f32_e64 v138, v10
    v_mfma_f32_16x16x32_bf16 v[36:39], a[212:215], a[136:139], v[36:39]
    ds_read_b128 a[196:199], v241 offset:1024
    s_add_u32 m0, s34, 16384
    v_mfma_f32_16x16x32_bf16 v[44:47], a[212:215], a[152:155], v[44:47]
    s_add_u32 s34, s34, 32768
    v_or3_b32 v208, v96, v97, v98
    v_mfma_f32_16x16x32_bf16 v[52:55], a[212:215], a[168:171], v[52:55]
    s_cmp_ge_u32 s34, 163840
    s_cselect_b32 s34, s37, s34
    v_mfma_f32_16x16x32_bf16 v[60:63], a[212:215], a[184:187], v[60:63]
    v_exp_f32 v139, v11
    v_mfma_f32_16x16x32_bf16 v[32:35], a[216:219], a[140:143], v[32:35]
    ds_read_b128 a[200:203], v241 offset:2048
    v_cvt_pk_bf16_f32 v99, v134, v135
    v_mfma_f32_16x16x32_bf16 v[40:43], a[216:219], a[156:159], v[40:43]
    v_exp_f32_e64 v140, v12
    v_mfma_f32_16x16x32_bf16 v[48:51], a[216:219], a[172:175], v[48:51]
    v_exp_f32_e64 v141, v13
    v_mfma_f32_16x16x32_bf16 v[56:59], a[216:219], a[188:191], v[56:59]
    v_cvt_pk_bf16_f32 v100, v136, v137
    buffer_load_dwordx4 v242, s[16:19], s42 offen offset:0 sc1 lds
    v_mfma_f32_16x16x32_bf16 v[36:39], a[220:223], a[140:143], v[36:39]
    ds_read_b128 a[204:207], v241 offset:3072
    v_or3_b32 v208, v208, v99, v100
    v_mfma_f32_16x16x32_bf16 v[44:47], a[220:223], a[156:159], v[44:47]
    v_exp_f32_e64 v142, v14
    v_mfma_f32_16x16x32_bf16 v[52:55], a[220:223], a[172:175], v[52:55]
    v_exp_f32_e64 v143, v15
    v_mfma_f32_16x16x32_bf16 v[60:63], a[220:223], a[188:191], v[60:63]
    v_cvt_pk_bf16_f32 v101, v138, v139
    s_waitcnt lgkmcnt(8)
    v_mfma_f32_16x16x32_bf16 a[0:3], a[224:227], v[112:115], a[0:3]
    ds_read_b128 a[208:211], v241 offset:4096
    v_cvt_pk_bf16_f32 v102, v140, v141
    v_mfma_f32_16x16x32_bf16 a[32:35], a[224:227], v[116:119], a[32:35]
    v_exp_f32 v128, v16
    v_mfma_f32_16x16x32_bf16 a[64:67], a[224:227], v[120:123], a[64:67]
    v_exp_f32_e64 v129, v17
    v_mfma_f32_16x16x32_bf16 a[96:99], a[224:227], v[124:127], a[96:99]
    v_exp_f32_e64 v130, v18
    v_mfma_f32_16x16x32_bf16 a[4:7], a[228:231], v[112:115], a[4:7]
    ds_read_b128 a[212:215], v241 offset:5120
    buffer_load_dwordx4 v242, s[16:19], s42 offen offset:1024 sc1 lds
    v_mfma_f32_16x16x32_bf16 a[36:39], a[228:231], v[116:119], a[36:39]
    v_exp_f32_e64 v131, v19
    v_mfma_f32_16x16x32_bf16 a[68:71], a[228:231], v[120:123], a[68:71]
    v_or3_b32 v208, v208, v101, v102
    v_cvt_pk_bf16_f32 v103, v142, v143
    v_mfma_f32_16x16x32_bf16 a[100:103], a[228:231], v[124:127], a[100:103]
    v_exp_f32_e64 v132, v20
    v_mfma_f32_16x16x32_bf16 a[8:11], a[232:235], v[112:115], a[8:11]
    ds_read_b128 a[216:219], v241 offset:6144
    v_cvt_pk_bf16_f32 v104, v128, v129
    v_mfma_f32_16x16x32_bf16 a[40:43], a[232:235], v[116:119], a[40:43]
    v_exp_f32_e64 v133, v21
    v_mfma_f32_16x16x32_bf16 a[72:75], a[232:235], v[120:123], a[72:75]
    v_exp_f32_e64 v134, v22
    v_mfma_f32_16x16x32_bf16 a[104:107], a[232:235], v[124:127], a[104:107]
    v_exp_f32_e64 v135, v23
    v_mfma_f32_16x16x32_bf16 a[12:15], a[236:239], v[112:115], a[12:15]
    ds_read_b128 a[220:223], v241 offset:7168
    buffer_load_dwordx4 v242, s[16:19], s42 offen offset:2048 sc1 lds
    v_mfma_f32_16x16x32_bf16 a[44:47], a[236:239], v[116:119], a[44:47]
    v_or3_b32 v208, v208, v103, v104
    v_cvt_pk_bf16_f32 v105, v130, v131
    v_mfma_f32_16x16x32_bf16 a[76:79], a[236:239], v[120:123], a[76:79]
    v_exp_f32_e64 v136, v24
    v_mfma_f32_16x16x32_bf16 a[108:111], a[236:239], v[124:127], a[108:111]
    v_cvt_pk_bf16_f32 v106, v132, v133
    s_waitcnt lgkmcnt(8)
    v_mfma_f32_16x16x32_bf16 a[16:19], a[240:243], v[112:115], a[16:19]
    ds_read_b128 a[224:227], v241 offset:16384
    v_or3_b32 v208, v208, v105, v106
    v_mfma_f32_16x16x32_bf16 a[48:51], a[240:243], v[116:119], a[48:51]
    v_exp_f32 v137, v25
    v_mfma_f32_16x16x32_bf16 a[80:83], a[240:243], v[120:123], a[80:83]
    v_exp_f32_e64 v138, v26
    v_mfma_f32_16x16x32_bf16 a[112:115], a[240:243], v[124:127], a[112:115]
    v_exp_f32_e64 v139, v27
    v_mfma_f32_16x16x32_bf16 a[20:23], a[244:247], v[112:115], a[20:23]
    ds_read_b128 a[228:231], v241 offset:17408
    buffer_load_dwordx4 v242, s[16:19], s42 offen offset:3072 sc1 lds
    v_mfma_f32_16x16x32_bf16 a[52:55], a[244:247], v[116:119], a[52:55]
    s_add_u32 s42, s42, 34048
    v_cvt_pk_bf16_f32 v107, v134, v135
    v_mfma_f32_16x16x32_bf16 a[84:87], a[244:247], v[120:123], a[84:87]
    v_exp_f32_e64 v140, v28
    v_mfma_f32_16x16x32_bf16 a[116:119], a[244:247], v[124:127], a[116:119]
    v_exp_f32_e64 v141, v29
    v_mfma_f32_16x16x32_bf16 a[24:27], a[248:251], v[112:115], a[24:27]
    ds_read_b128 a[232:235], v241 offset:18432
    v_cvt_pk_bf16_f32 v108, v136, v137
    v_mfma_f32_16x16x32_bf16 a[56:59], a[248:251], v[116:119], a[56:59]
    v_exp_f32_e64 v142, v30
    v_mfma_f32_16x16x32_bf16 a[88:91], a[248:251], v[120:123], a[88:91]
    v_exp_f32_e64 v143, v31
    v_mfma_f32_16x16x32_bf16 a[120:123], a[248:251], v[124:127], a[120:123]
    buffer_load_dword v252, v251, s[60:63], s100 offen
    s_add_u32 s100, s100, 2048
    v_mfma_f32_16x16x32_bf16 a[28:31], a[252:255], v[112:115], a[28:31]
    ds_read_b128 a[236:239], v241 offset:19456
    v_or3_b32 v208, v208, v107, v108
    v_mfma_f32_16x16x32_bf16 a[60:63], a[252:255], v[116:119], a[60:63]
    v_cvt_pk_bf16_f32 v109, v138, v139
    v_cvt_pk_bf16_f32 v110, v140, v141
    v_mfma_f32_16x16x32_bf16 a[92:95], a[252:255], v[120:123], a[92:95]
    v_or3_b32 v208, v208, v109, v110
    v_cvt_pk_bf16_f32 v111, v142, v143
    v_mfma_f32_16x16x32_bf16 a[124:127], a[252:255], v[124:127], a[124:127]
    v_or_b32 v208, v208, v111
    v_and_b32 v208, s38, v208
    v_mfma_f32_16x16x32_bf16 v[144:147], v[204:207], v[112:115], v[144:147]
    v_cmp_ne_u32_e64 vcc, 0, v208
    v_mfma_f32_16x16x32_bf16 v[148:151], v[204:207], v[116:119], v[148:151]
    v_mfma_f32_16x16x32_bf16 v[152:155], v[204:207], v[120:123], v[152:155]
    v_mfma_f32_16x16x32_bf16 v[156:159], v[204:207], v[124:127], v[156:159]
    s_cbranch_vccnz kf_rare10
kf_rr9:
ka_p1_e:
    s_sub_u32 s26, s26, 1
    s_cbranch_scc0 ka_p1
    s_branch ka_p1_x
kf_fix7:
    s_mov_b32 s24, 0
    s_branch kf_fix7c
kf_fix11:
    s_mov_b32 s24, 1
kf_fix7c:
    s_cmp_eq_u32 s33, 0
    s_cbranch_scc0 kf_fix7f
    s_mov_b32 s36, 0
    s_mov_b32 s33, 1
    v_add_f32 v64, v224, v200
    v_add_f32 v65, v224, v201
    v_add_f32 v66, v224, v202
    v_add_f32 v67, v224, v203
    v_add_f32 v68, v224, v209
    v_add_f32 v69, v224, v210
    v_add_f32 v70, v224, v211
    v_add_f32 v71, v224, v212
    v_add_f32 v72, v225, v213
    v_add_f32 v73, v225, v214
    v_add_f32 v74, v225, v215
    v_add_f32 v75, v225, v216
    v_add_f32 v76, v225, v217
    v_add_f32 v77, v225, v218
    v_add_f32 v78, v225, v219
    v_add_f32 v79, v225, v220
    s_cmp_eq_u32 s24, 0
    s_cbranch_scc1 kf_fixr8
    s_branch kf_fixr12
kf_fix7f:
    s_mov_b32 s36, 0x1000
    v_mov_b32 v64, 0xf1800000
    v_mov_b32 v65, v64
    v_mov_b32 v66, v64
    v_mov_b32 v67, v64
    v_mov_b32 v68, v64
    v_mov_b32 v69, v64
    v_mov_b32 v70, v64
    v_mov_b32 v71, v64
    v_mov_b32 v72, v64
    v_mov_b32 v73, v64
    v_mov_b32 v74, v64
    v_mov_b32 v75, v64
    v_mov_b32 v76, v64
    v_mov_b32 v77, v64
    v_mov_b32 v78, v64
    v_mov_b32 v79, v64
    s_cmp_eq_u32 s24, 0
    s_cbranch_scc1 kf_fixr8
    s_branch kf_fixr12
kf_fix15:
    s_mov_b32 s24, 0
    s_branch kf_fix15c
kf_fix19:
    s_mov_b32 s24, 1
kf_fix15c:
    s_cmp_eq_u32 s33, 0
    s_cbranch_scc0 kf_fix15f
    s_mov_b32 s36, 0
    s_mov_b32 s33, 1
    v_add_f32 v80, v226, v200
    v_add_f32 v81, v226, v201
    v_add_f32 v82, v226, v202
    v_add_f32 v83, v226, v203
    v_add_f32 v84, v226, v209
    v_add_f32 v85, v226, v210
    v_add_f32 v86, v226, v211
    v_add_f32 v87, v226, v212
    v_add_f32 v88, v227, v213
    v_add_f32 v89, v227, v214
    v_add_f32 v90, v227, v215
    v_add_f32 v91, v227, v216
    v_add_f32 v92, v227, v217
    v_add_f32 v93, v227, v218
    v_add_f32 v94, v227, v219
    v_add_f32 v95, v227, v220
    s_cmp_eq_u32 s24, 0
    s_cbranch_scc1 kf_fixr16
    s_branch kf_fixr20
kf_fix15f:
    s_mov_b32 s36, 0x1000
    v_mov_b32 v80, 0xf1800000
    v_mov_b32 v81, v80
    v_mov_b32 v82, v80
    v_mov_b32 v83, v80
    v_mov_b32 v84, v80
    v_mov_b32 v85, v80
    v_mov_b32 v86, v80
    v_mov_b32 v87, v80
    v_mov_b32 v88, v80
    v_mov_b32 v89, v80
    v_mov_b32 v90, v80
    v_mov_b32 v91, v80
    v_mov_b32 v92, v80
    v_mov_b32 v93, v80
    v_mov_b32 v94, v80
    v_mov_b32_e64 v95, v80
    s_cmp_eq_u32 s24, 0
    s_cbranch_scc1 kf_fixr16
    s_branch kf_fixr20
ka_p1_x:
    s_lshl2_add_u32 s36, s5, s6
    s_lshl1_add_u32 s36, s31, s36
    s_sub_u32 s36, 61, s36
    s_mov_b32 s33, 0
    s_sub_u32 s36, s36, 1
    s_cbranch_scc1 kf_fix15
kf_fixr16:
    s_waitcnt lgkmcnt(8)
    v_mfma_f32_16x16x32_bf16 v[16:19], a[192:195], a[160:163], v[80:83]
    ds_read_b128 a[240:243], v241 offset:20480
    ds_read_b128 a[244:247], v241 offset:21504
    v_mfma_f32_16x16x32_bf16 v[24:27], a[192:195], a[176:179], v[88:91]
    s_waitcnt vmcnt(11)
    v_exp_f32 v128, v32
    v_mfma_f32_16x16x32_bf16 v[20:23], a[196:199], a[160:163], v[84:87]
    v_exp_f32_e64 v129, v33
    v_mfma_f32_16x16x32_bf16 v[28:31], a[196:199], a[176:179], v[92:95]
    buffer_store_dwordx4 v[192:195], v255, s[48:51], s45 offen offset:0 sc1
    v_exp_f32_e64 v130, v34
    v_mfma_f32_16x16x32_bf16 v[16:19], a[200:203], a[164:167], v[16:19]
    ds_read_b128 a[248:251], v241 offset:22528
    ds_read_b128 a[252:255], v241 offset:23552
    v_mfma_f32_16x16x32_bf16 v[24:27], a[200:203], a[180:183], v[24:27]
    v_exp_f32_e64 v131, v35
    v_mfma_f32_16x16x32_bf16 v[20:23], a[204:207], a[164:167], v[20:23]
    v_exp_f32_e64 v132, v36
    v_cvt_pk_bf16_f32 v112, v128, v129
    v_mfma_f32_16x16x32_bf16 v[28:31], a[204:207], a[180:183], v[28:31]
    s_mov_b32 m0, s34
    s_waitcnt lgkmcnt(8)
    v_mfma_f32_16x16x32_bf16 v[16:19], a[208:211], a[168:171], v[16:19]
    ds_read_b128 a[192:195], v241 offset:8192
    ds_read_b128 a[196:199], v241 offset:9216
    v_mfma_f32_16x16x32_bf16 v[24:27], a[208:211], a[184:187], v[24:27]
    s_add_u32 s41, s42, 17664
    v_exp_f32_e64 v133, v37
    v_mfma_f32_16x16x32_bf16 v[20:23], a[212:215], a[168:171], v[20:23]
    v_exp_f32_e64 v134, v38
    v_mfma_f32_16x16x32_bf16 v[28:31], a[212:215], a[184:187], v[28:31]
    v_exp_f32_e64 v135, v39
    v_mfma_f32_16x16x32_bf16 v[16:19], a[216:219], a[172:175], v[16:19]
    ds_read_b128 a[200:203], v241 offset:10240
    ds_read_b128 a[204:207], v241 offset:11264
    v_cvt_pk_bf16_f32 v113, v130, v131
    v_mfma_f32_16x16x32_bf16 v[24:27], a[216:219], a[188:191], v[24:27]
    v_exp_f32_e64 v136, v40
    v_mfma_f32_16x16x32_bf16 v[20:23], a[220:223], a[172:175], v[20:23]
    v_exp_f32_e64 v137, v41
    v_mfma_f32_16x16x32_bf16 v[28:31], a[220:223], a[188:191], v[28:31]
    v_cvt_pk_bf16_f32 v114, v132, v133
    buffer_load_dwordx4 v242, s[16:19], s41 offen offset:0 sc1 lds
    s_waitcnt lgkmcnt(8)
    v_mfma_f32_16x16x32_bf16 a[0:3], a[224:227], v[96:99], a[0:3]
    ds_read_b128 a[208:211], v241 offset:12288
    v_or3_b32 v208, v112, v113, v114
    v_mfma_f32_16x16x32_bf16 a[32:35], a[224:227], v[100:103], a[32:35]
    v_exp_f32 v138, v42
    v_mfma_f32_16x16x32_bf16 a[64:67], a[224:227], v[104:107], a[64:67]
    v_exp_f32_e64 v139, v43
    v_cvt_pk_bf16_f32 v115, v134, v135
    v_mfma_f32_16x16x32_bf16 a[96:99], a[224:227], v[108:111], a[96:99]
    v_exp_f32_e64 v140, v44
    v_mfma_f32_16x16x32_bf16 a[4:7], a[228:231], v[96:99], a[4:7]
    ds_read_b128 a[212:215], v241 offset:13312
    v_cvt_pk_bf16_f32 v116, v136, v137
    v_mfma_f32_16x16x32_bf16 a[36:39], a[228:231], v[100:103], a[36:39]
    buffer_load_dwordx4 v242, s[16:19], s41 offen offset:1024 sc1 lds
    v_exp_f32_e64 v141, v45
    v_mfma_f32_16x16x32_bf16 a[68:71], a[228:231], v[104:107], a[68:71]
    v_exp_f32_e64 v142, v46
    v_mfma_f32_16x16x32_bf16 a[100:103], a[228:231], v[108:111], a[100:103]
    v_exp_f32_e64 v143, v47
    v_mfma_f32_16x16x32_bf16 a[8:11], a[232:235], v[96:99], a[8:11]
    ds_read_b128 a[216:219], v241 offset:14336
    v_or3_b32 v208, v208, v115, v116
    v_cvt_pk_bf16_f32 v117, v138, v139
    v_mfma_f32_16x16x32_bf16 a[40:43], a[232:235], v[100:103], a[40:43]
    v_exp_f32_e64 v128, v48
    v_mfma_f32_16x16x32_bf16 a[72:75], a[232:235], v[104:107], a[72:75]
    v_exp_f32_e64 v129, v49
    v_mfma_f32_16x16x32_bf16 a[104:107], a[232:235], v[108:111], a[104:107]
    v_cvt_pk_bf16_f32 v118, v140, v141
    v_exp_f32_e64 v130, v50
    v_mfma_f32_16x16x32_bf16 a[12:15], a[236:239], v[96:99], a[12:15]
    ds_read_b128 a[220:223], v241 offset:15360
    buffer_load_dwordx4 v242, s[16:19], s41 offen offset:2048 sc1 lds
    v_mfma_f32_16x16x32_bf16 a[44:47], a[236:239], v[100:103], a[44:47]
    v_exp_f32_e64 v131, v51
    v_or3_b32 v208, v208, v117, v118
    v_mfma_f32_16x16x32_bf16 a[76:79], a[236:239], v[104:107], a[76:79]
    v_exp_f32_e64 v132, v52
    v_mfma_f32_16x16x32_bf16 a[108:111], a[236:239], v[108:111], a[108:111]
    v_cvt_pk_bf16_f32 v119, v142, v143
    s_waitcnt lgkmcnt(8)
    v_mfma_f32_16x16x32_bf16 a[16:19], a[240:243], v[96:99], a[16:19]
    ds_read_b128 a[224:227], v241 offset:24576
    v_exp_f32 v133, v53
    v_mfma_f32_16x16x32_bf16 a[48:51], a[240:243], v[100:103], a[48:51]
    v_cvt_pk_bf16_f32 v120, v128, v129
    v_or3_b32 v208, v208, v119, v120
    v_mfma_f32_16x16x32_bf16 a[80:83], a[240:243], v[104:107], a[80:83]
    v_exp_f32_e64 v134, v54
    v_mfma_f32_16x16x32_bf16 a[112:115], a[240:243], v[108:111], a[112:115]
    buffer_load_dwordx4 v242, s[16:19], s41 offen offset:3072 sc1 lds
    v_exp_f32_e64 v135, v55
    v_mfma_f32_16x16x32_bf16 a[20:23], a[244:247], v[96:99], a[20:23]
    ds_read_b128 a[228:231], v241 offset:25600
    v_cvt_pk_bf16_f32 v121, v130, v131
    v_mfma_f32_16x16x32_bf16 a[52:55], a[244:247], v[100:103], a[52:55]
    v_exp_f32_e64 v136, v56
    v_mfma_f32_16x16x32_bf16 a[84:87], a[244:247], v[104:107], a[84:87]
    v_exp_f32_e64 v137, v57
    v_cvt_pk_bf16_f32 v122, v132, v133
    v_mfma_f32_16x16x32_bf16 a[116:119], a[244:247], v[108:111], a[116:119]
    v_exp_f32_e64 v138, v58
    v_mfma_f32_16x16x32_bf16 a[24:27], a[248:251], v[96:99], a[24:27]
    ds_read_b128 a[232:235], v241 offset:26624
    v_or3_b32 v208, v208, v121, v122
    v_mfma_f32_16x16x32_bf16 a[56:59], a[248:251], v[100:103], a[56:59]
    v_exp_f32_e64 v139, v59
    v_cvt_pk_bf16_f32 v123, v134, v135
    v_mfma_f32_16x16x32_bf16 a[88:91], a[248:251], v[104:107], a[88:91]
    v_exp_f32_e64 v140, v60
    v_mfma_f32_16x16x32_bf16 a[120:123], a[248:251], v[108:111], a[120:123]
    v_exp_f32_e64 v141, v61
    v_mfma_f32_16x16x32_bf16 a[28:31], a[252:255], v[96:99], a[28:31]
    ds_read_b128 a[236:239], v241 offset:27648
    v_cvt_pk_bf16_f32 v124, v136, v137
    s_add_u32 s35, s35, 32768
    v_mfma_f32_16x16x32_bf16 a[60:63], a[252:255], v[100:103], a[60:63]
    s_cmp_ge_u32 s35, 163840
    s_cselect_b32 s35, 0, s35
    v_mfma_f32_16x16x32_bf16 a[92:95], a[252:255], v[104:107], a[92:95]
    v_exp_f32 v142, v62
    v_mfma_f32_16x16x32_bf16 a[124:127], a[252:255], v[108:111], a[124:127]
    v_exp_f32_e64 v143, v63
    v_or3_b32 v208, v208, v123, v124
    v_mfma_f32_16x16x32_bf16 v[144:147], v[204:207], v[96:99], v[144:147]
    v_cvt_pk_bf16_f32 v125, v138, v139
    v_cvt_pk_bf16_f32 v126, v140, v141
    v_mfma_f32_16x16x32_bf16 v[148:151], v[204:207], v[100:103], v[148:151]
    v_or3_b32 v208, v208, v125, v126
    v_cvt_pk_bf16_f32 v127, v142, v143
    v_mfma_f32_16x16x32_bf16 v[152:155], v[204:207], v[104:107], v[152:155]
    v_or_b32 v208, v208, v127
    v_and_b32 v208, s38, v208
    v_cmp_ne_u32_e64 vcc, 0, v208
    v_mfma_f32_16x16x32_bf16 v[156:159], v[204:207], v[108:111], v[156:159]
    s_cbranch_vccnz kf_rare14
kf_rr13:
    s_sub_u32 s36, s36, 1
    s_cbranch_scc1 kf_fix19
kf_fixr20:
    s_waitcnt lgkmcnt(8)
    v_mfma_f32_16x16x32_bf16 v[48:51], a[192:195], a[160:163], v[80:83]
    ds_read_b128 a[240:243], v241 offset:28672
    ds_read_b128 a[244:247], v241 offset:29696
    v_mfma_f32_16x16x32_bf16 v[56:59], a[192:195], a[176:179], v[88:91]
    v_exp_f32_e64 v128, v16
    v_mfma_f32_16x16x32_bf16 v[52:55], a[196:199], a[160:163], v[84:87]
    v_exp_f32_e64 v129, v17
    v_mfma_f32_16x16x32_bf16 v[60:63], a[196:199], a[176:179], v[92:95]
    s_waitcnt vmcnt(10)
    buffer_store_dwordx4 v[196:199], v255, s[48:51], s45 offen offset:256 sc1
    v_mfma_f32_16x16x32_bf16 v[48:51], a[200:203], a[164:167], v[48:51]
    ds_read_b128 a[248:251], v241 offset:30720
    ds_read_b128 a[252:255], v241 offset:31744
    v_mfma_f32_16x16x32_bf16 v[56:59], a[200:203], a[180:183], v[56:59]
    v_exp_f32 v130, v18
    v_mfma_f32_16x16x32_bf16 v[52:55], a[204:207], a[164:167], v[52:55]
    v_exp_f32_e64 v131, v19
    v_mfma_f32_16x16x32_bf16 v[60:63], a[204:207], a[180:183], v[60:63]
    v_cvt_pk_bf16_f32 v104, v128, v129
    s_waitcnt lgkmcnt(8)
    v_mfma_f32_16x16x32_bf16 v[48:51], a[208:211], a[168:171], v[48:51]
    s_waitcnt vmcnt(14)
    s_barrier
    v_add_u32 v241, s35, v240
    ds_read_b128 a[192:195], v241 offset:0
    v_mfma_f32_16x16x32_bf16 v[56:59], a[208:211], a[184:187], v[56:59]
    s_add_u32 m0, s34, 16384
    s_add_u32 s34, s34, 32768
    v_mfma_f32_16x16x32_bf16 v[52:55], a[212:215], a[168:171], v[52:55]
    ds_read_b128 a[196:199], v241 offset:1024
    v_cvt_pk_bf16_f32 v105, v130, v131
    v_mfma_f32_16x16x32_bf16 v[60:63], a[212:215], a[184:187], v[60:63]
    s_cmp_ge_u32 s34, 163840
    s_cselect_b32 s34, s37, s34
    v_mfma_f32_16x16x32_bf16 v[48:51], a[216:219], a[172:175], v[48:51]
    ds_read_b128 a[200:203], v241 offset:2048
    ds_read_b128 a[204:207], v241 offset:3072
    v_mfma_f32_16x16x32_bf16 v[56:59], a[216:219], a[188:191], v[56:59]
    v_exp_f32 v132, v20
    v_mfma_f32_16x16x32_bf16 v[52:55], a[220:223], a[172:175], v[52:55]
    v_exp_f32_e64 v133, v21
    v_mfma_f32_16x16x32_bf16 v[60:63], a[220:223], a[188:191], v[60:63]
    v_cvt_pk_bf16_f32 v106, v132, v133
    s_waitcnt lgkmcnt(8)
    v_mfma_f32_16x16x32_bf16 a[0:3], a[224:227], v[112:115], a[0:3]
    ds_read_b128 a[208:211], v241 offset:4096
    v_or3_b32 v208, v104, v105, v106
    v_mfma_f32_16x16x32_bf16 a[32:35], a[224:227], v[116:119], a[32:35]
    v_exp_f32 v134, v22
    v_mfma_f32_16x16x32_bf16 a[64:67], a[224:227], v[120:123], a[64:67]
    buffer_load_dwordx4 v242, s[16:19], s42 offen offset:0 sc1 lds
    v_mfma_f32_16x16x32_bf16 a[96:99], a[224:227], v[124:127], a[96:99]
    v_exp_f32_e64 v135, v23
    v_mfma_f32_16x16x32_bf16 a[4:7], a[228:231], v[112:115], a[4:7]
    ds_read_b128 a[212:215], v241 offset:5120
    v_cvt_pk_bf16_f32 v107, v134, v135
    v_mfma_f32_16x16x32_bf16 a[36:39], a[228:231], v[116:119], a[36:39]
    v_exp_f32_e64 v136, v24
    v_mfma_f32_16x16x32_bf16 a[68:71], a[228:231], v[120:123], a[68:71]
    v_exp_f32_e64 v137, v25
    v_mfma_f32_16x16x32_bf16 a[100:103], a[228:231], v[124:127], a[100:103]
    v_exp_f32_e64 v138, v26
    v_mfma_f32_16x16x32_bf16 a[8:11], a[232:235], v[112:115], a[8:11]
    ds_read_b128 a[216:219], v241 offset:6144
    v_cvt_pk_bf16_f32 v108, v136, v137
    v_mfma_f32_16x16x32_bf16 a[40:43], a[232:235], v[116:119], a[40:43]
    buffer_load_dwordx4 v242, s[16:19], s42 offen offset:1024 sc1 lds
    v_or3_b32 v208, v208, v107, v108
    v_mfma_f32_16x16x32_bf16 a[72:75], a[232:235], v[120:123], a[72:75]
    v_exp_f32_e64 v139, v27
    v_mfma_f32_16x16x32_bf16 a[104:107], a[232:235], v[124:127], a[104:107]
    v_exp_f32_e64 v140, v28
    v_mfma_f32_16x16x32_bf16 a[12:15], a[236:239], v[112:115], a[12:15]
    ds_read_b128 a[220:223], v241 offset:7168
    v_cvt_pk_bf16_f32 v109, v138, v139
    v_mfma_f32_16x16x32_bf16 a[44:47], a[236:239], v[116:119], a[44:47]
    v_exp_f32_e64 v141, v29
    v_mfma_f32_16x16x32_bf16 a[76:79], a[236:239], v[120:123], a[76:79]
    v_exp_f32_e64 v142, v30
    v_mfma_f32_16x16x32_bf16 a[108:111], a[236:239], v[124:127], a[108:111]
    v_cvt_pk_bf16_f32 v110, v140, v141
    s_waitcnt lgkmcnt(8)
    v_mfma_f32_16x16x32_bf16 a[16:19], a[240:243], v[112:115], a[16:19]
    ds_read_b128 a[224:227], v241 offset:16384
    v_or3_b32 v208, v208, v109, v110
    v_mfma_f32_16x16x32_bf16 a[48:51], a[240:243], v[116:119], a[48:51]
    buffer_load_dwordx4 v242, s[16:19], s42 offen offset:2048 sc1 lds
    v_mfma_f32_16x16x32_bf16 a[80:83], a[240:243], v[120:123], a[80:83]
    v_exp_f32 v143, v31
    v_mfma_f32_16x16x32_bf16 a[112:115], a[240:243], v[124:127], a[112:115]
    v_cvt_pk_bf16_f32 v111, v142, v143
    v_or_b32_e64 v208, v208, v111
    v_mfma_f32_16x16x32_bf16 a[20:23], a[244:247], v[112:115], a[20:23]
    ds_read_b128 a[228:231], v241 offset:17408
    v_and_b32_e64 v208, s38, v208
    v_mfma_f32_16x16x32_bf16 a[52:55], a[244:247], v[116:119], a[52:55]
    v_cmp_ne_u32_e64 vcc, 0, v208
    buffer_load_dwordx4 v242, s[16:19], s42 offen offset:3072 sc1 lds
    v_mfma_f32_16x16x32_bf16 a[84:87], a[244:247], v[120:123], a[84:87]
    s_add_u32 s42, s42, 34048
    v_mfma_f32_16x16x32_bf16 a[116:119], a[244:247], v[124:127], a[116:119]
    v_mfma_f32_16x16x32_bf16 a[24:27], a[248:251], v[112:115], a[24:27]
    ds_read_b128 a[232:235], v241 offset:18432
    v_mfma_f32_16x16x32_bf16 a[56:59], a[248:251], v[116:119], a[56:59]
    v_mfma_f32_16x16x32_bf16 a[88:91], a[248:251], v[120:123], a[88:91]
    v_mfma_f32_16x16x32_bf16 a[120:123], a[248:251], v[124:127], a[120:123]
    v_mfma_f32_16x16x32_bf16 a[28:31], a[252:255], v[112:115], a[28:31]
    ds_read_b128 a[236:239], v241 offset:19456
    v_mfma_f32_16x16x32_bf16 a[60:63], a[252:255], v[116:119], a[60:63]
    v_mfma_f32_16x16x32_bf16 a[92:95], a[252:255], v[120:123], a[92:95]
    v_mfma_f32_16x16x32_bf16 a[124:127], a[252:255], v[124:127], a[124:127]
    v_mfma_f32_16x16x32_bf16 v[144:147], v[204:207], v[112:115], v[144:147]
    v_mfma_f32_16x16x32_bf16 v[148:151], v[204:207], v[116:119], v[148:151]
    v_mfma_f32_16x16x32_bf16 v[152:155], v[204:207], v[120:123], v[152:155]
    v_mfma_f32_16x16x32_bf16 v[156:159], v[204:207], v[124:127], v[156:159]
    s_cbranch_vccnz kf_rare18
kf_rr17:
    s_nop 6
    v_rcp_f32 v230, v144
    v_rcp_f32 v231, v148
    v_accvgpr_read_b32 v160, a0
    v_accvgpr_read_b32 v161, a1
    v_accvgpr_read_b32 v162, a2
    v_accvgpr_read_b32 v163, a3
    v_accvgpr_read_b32 v164, a4
    v_accvgpr_read_b32 v165, a5
    v_accvgpr_read_b32 v166, a6
    v_accvgpr_read_b32 v167, a7
    v_mul_f32 v160, v160, v230
    v_mul_f32 v161, v161, v230
    v_mul_f32 v162, v162, v230
    v_mul_f32 v163, v163, v230
    v_mul_f32 v164, v164, v230
    v_mul_f32 v165, v165, v230
    v_mul_f32 v166, v166, v230
    v_mul_f32 v167, v167, v230
    v_cvt_pk_bf16_f32 v176, v160, v161
    v_cvt_pk_bf16_f32 v177, v162, v163
    v_cvt_pk_bf16_f32 v178, v164, v165
    v_cvt_pk_bf16_f32 v179, v166, v167
    buffer_store_dwordx4 v[176:179], v240, s[20:23], s39 offen offset:0 sc1
    v_accvgpr_read_b32 v168, a8
    v_accvgpr_read_b32 v169, a9
    v_accvgpr_read_b32 v170, a10
    v_accvgpr_read_b32 v171, a11
    v_accvgpr_read_b32 v172, a12
    v_accvgpr_read_b32 v173, a13
    v_accvgpr_read_b32 v174, a14
    v_accvgpr_read_b32 v175, a15
    v_mul_f32 v168, v168, v230
    v_mul_f32 v169, v169, v230
    v_mul_f32 v170, v170, v230
    v_mul_f32 v171, v171, v230
    v_mul_f32 v172, v172, v230
    v_mul_f32 v173, v173, v230
    v_mul_f32 v174, v174, v230
    v_mul_f32 v175, v175, v230
    v_cvt_pk_bf16_f32 v180, v168, v169
    v_cvt_pk_bf16_f32 v181, v170, v171
    v_cvt_pk_bf16_f32 v182, v172, v173
    v_cvt_pk_bf16_f32 v183, v174, v175
    buffer_store_dwordx4 v[180:183], v240, s[20:23], s39 offen offset:1024 sc1
    v_accvgpr_read_b32 v160, a16
    v_accvgpr_read_b32 v161, a17
    v_accvgpr_read_b32 v162, a18
    v_accvgpr_read_b32 v163, a19
    v_accvgpr_read_b32 v164, a20
    v_accvgpr_read_b32 v165, a21
    v_accvgpr_read_b32 v166, a22
    v_accvgpr_read_b32 v167, a23
    v_mul_f32 v160, v160, v230
    v_mul_f32 v161, v161, v230
    v_mul_f32 v162, v162, v230
    v_mul_f32 v163, v163, v230
    v_mul_f32 v164, v164, v230
    v_mul_f32 v165, v165, v230
    v_mul_f32 v166, v166, v230
    v_mul_f32 v167, v167, v230
    v_cvt_pk_bf16_f32 v184, v160, v161
    v_cvt_pk_bf16_f32 v185, v162, v163
    v_cvt_pk_bf16_f32 v186, v164, v165
    v_cvt_pk_bf16_f32 v187, v166, v167
    buffer_store_dwordx4 v[184:187], v240, s[20:23], s39 offen offset:2048 sc1
    v_accvgpr_read_b32 v168, a24
    v_accvgpr_read_b32 v169, a25
    v_accvgpr_read_b32 v170, a26
    v_accvgpr_read_b32 v171, a27
    v_accvgpr_read_b32 v172, a28
    v_accvgpr_read_b32 v173, a29
    v_accvgpr_read_b32 v174, a30
    v_accvgpr_read_b32 v175, a31
    v_mul_f32 v168, v168, v230
    v_mul_f32 v169, v169, v230
    v_mul_f32 v170, v170, v230
    v_mul_f32 v171, v171, v230
    v_mul_f32 v172, v172, v230
    v_mul_f32 v173, v173, v230
    v_mul_f32 v174, v174, v230
    v_mul_f32 v175, v175, v230
    v_cvt_pk_bf16_f32 v188, v168, v169
    v_cvt_pk_bf16_f32 v189, v170, v171
    v_cvt_pk_bf16_f32 v190, v172, v173
    v_cvt_pk_bf16_f32 v191, v174, v175
    buffer_store_dwordx4 v[188:191], v240, s[20:23], s39 offen offset:3072 sc1
    v_accvgpr_read_b32 v160, a32
    v_accvgpr_read_b32 v161, a33
    v_accvgpr_read_b32 v162, a34
    v_accvgpr_read_b32 v163, a35
    v_accvgpr_read_b32 v164, a36
    v_accvgpr_read_b32 v165, a37
    v_accvgpr_read_b32 v166, a38
    v_accvgpr_read_b32 v167, a39
    v_mul_f32 v160, v160, v231
    v_mul_f32 v161, v161, v231
    v_mul_f32 v162, v162, v231
    v_mul_f32 v163, v163, v231
    v_mul_f32 v164, v164, v231
    v_mul_f32 v165, v165, v231
    v_mul_f32 v166, v166, v231
    v_mul_f32 v167, v167, v231
    v_cvt_pk_bf16_f32 v176, v160, v161
    v_cvt_pk_bf16_f32 v177, v162, v163
    v_cvt_pk_bf16_f32 v178, v164, v165
    v_cvt_pk_bf16_f32 v179, v166, v167
    buffer_store_dwordx4 v[176:179], v244, s[20:23], s39 offen offset:0 sc1
    v_accvgpr_read_b32 v168, a40
    v_accvgpr_read_b32 v169, a41
    v_accvgpr_read_b32 v170, a42
    v_accvgpr_read_b32 v171, a43
    v_accvgpr_read_b32 v172, a44
    v_accvgpr_read_b32 v173, a45
    v_accvgpr_read_b32 v174, a46
    v_accvgpr_read_b32 v175, a47
    v_mul_f32 v168, v168, v231
    v_mul_f32 v169, v169, v231
    v_mul_f32 v170, v170, v231
    v_mul_f32 v171, v171, v231
    v_mul_f32 v172, v172, v231
    v_mul_f32 v173, v173, v231
    v_mul_f32 v174, v174, v231
    v_mul_f32 v175, v175, v231
    v_cvt_pk_bf16_f32 v180, v168, v169
    v_cvt_pk_bf16_f32 v181, v170, v171
    v_cvt_pk_bf16_f32 v182, v172, v173
    v_cvt_pk_bf16_f32 v183, v174, v175
    buffer_store_dwordx4 v[180:183], v244, s[20:23], s39 offen offset:1024 sc1
    v_accvgpr_read_b32 v160, a48
    v_accvgpr_read_b32 v161, a49
    v_accvgpr_read_b32 v162, a50
    v_accvgpr_read_b32 v163, a51
    v_accvgpr_read_b32 v164, a52
    v_accvgpr_read_b32 v165, a53
    v_accvgpr_read_b32 v166, a54
    v_accvgpr_read_b32 v167, a55
    v_mul_f32 v160, v160, v231
    v_mul_f32 v161, v161, v231
    v_mul_f32 v162, v162, v231
    v_mul_f32 v163, v163, v231
    v_mul_f32 v164, v164, v231
    v_mul_f32 v165, v165, v231
    v_mul_f32 v166, v166, v231
    v_mul_f32 v167, v167, v231
    v_cvt_pk_bf16_f32 v184, v160, v161
    v_cvt_pk_bf16_f32 v185, v162, v163
    v_cvt_pk_bf16_f32 v186, v164, v165
    v_cvt_pk_bf16_f32 v187, v166, v167
    buffer_store_dwordx4 v[184:187], v244, s[20:23], s39 offen offset:2048 sc1
    v_accvgpr_read_b32 v168, a56
    v_accvgpr_read_b32 v169, a57
    v_accvgpr_read_b32 v170, a58
    v_accvgpr_read_b32 v171, a59
    v_accvgpr_read_b32 v172, a60
    v_accvgpr_read_b32 v173, a61
    v_accvgpr_read_b32 v174, a62
    v_accvgpr_read_b32 v175, a63
    v_mul_f32 v168, v168, v231
    v_mul_f32 v169, v169, v231
    v_mul_f32 v170, v170, v231
    v_mul_f32 v171, v171, v231
    v_mul_f32 v172, v172, v231
    v_mul_f32 v173, v173, v231
    v_mul_f32 v174, v174, v231
    v_mul_f32 v175, v175, v231
    v_cvt_pk_bf16_f32 v188, v168, v169
    v_cvt_pk_bf16_f32 v189, v170, v171
    v_cvt_pk_bf16_f32 v190, v172, v173
    v_cvt_pk_bf16_f32 v191, v174, v175
    buffer_store_dwordx4 v[188:191], v244, s[20:23], s39 offen offset:3072 sc1
ka_noe0:
    s_lshl1_add_u32 s26, s5, s31
    s_lshl_b32 s26, s26, 1
    s_sub_u32 s26, 30, s26
    s_branch ka_p2_e
.p2align 5
ka_p2:
    s_sub_u32 s36, s36, 1
    s_cbranch_scc1 kf_fix23
kf_fixr24:
    s_waitcnt lgkmcnt(8)
    v_mfma_f32_16x16x32_bf16 v[16:19], a[192:195], a[160:163], v[80:83]
    ds_read_b128 a[240:243], v241 offset:20480
    ds_read_b128 a[244:247], v241 offset:21504
    v_mfma_f32_16x16x32_bf16 v[24:27], a[192:195], a[176:179], v[88:91]
    v_exp_f32 v128, v48
    v_mfma_f32_16x16x32_bf16 v[20:23], a[196:199], a[160:163], v[84:87]
    s_mov_b32 m0, s34
    v_exp_f32 v129, v49
    v_mfma_f32_16x16x32_bf16 v[28:31], a[196:199], a[176:179], v[92:95]
    v_exp_f32_e64 v130, v50
    v_mfma_f32_16x16x32_bf16 v[16:19], a[200:203], a[164:167], v[16:19]
    ds_read_b128 a[248:251], v241 offset:22528
    ds_read_b128 a[252:255], v241 offset:23552
    v_mfma_f32_16x16x32_bf16 v[24:27], a[200:203], a[180:183], v[24:27]
    s_add_u32 s41, s42, 17664
    v_cvt_pk_bf16_f32 v120, v128, v129
    v_mfma_f32_16x16x32_bf16 v[20:23], a[204:207], a[164:167], v[20:23]
    buffer_load_dwordx4 v242, s[16:19], s41 offen offset:0 sc1 lds
    v_exp_f32_e64 v131, v51
    v_mfma_f32_16x16x32_bf16 v[28:31], a[204:207], a[180:183], v[28:31]
    v_cvt_pk_bf16_f32 v121, v130, v131
    s_waitcnt lgkmcnt(8)
    v_mfma_f32_16x16x32_bf16 v[16:19], a[208:211], a[168:171], v[16:19]
    ds_read_b128 a[192:195], v241 offset:8192
    ds_read_b128 a[196:199], v241 offset:9216
    v_mfma_f32_16x16x32_bf16 v[24:27], a[208:211], a[184:187], v[24:27]
    v_exp_f32 v132, v52
    v_mfma_f32_16x16x32_bf16 v[20:23], a[212:215], a[168:171], v[20:23]
    v_exp_f32_e64 v133, v53
    buffer_load_dwordx4 v242, s[16:19], s41 offen offset:1024 sc1 lds
    v_mfma_f32_16x16x32_bf16 v[28:31], a[212:215], a[184:187], v[28:31]
    v_exp_f32_e64 v134, v54
    v_mfma_f32_16x16x32_bf16 v[16:19], a[216:219], a[172:175], v[16:19]
    ds_read_b128 a[200:203], v241 offset:10240
    ds_read_b128 a[204:207], v241 offset:11264
    v_mfma_f32_16x16x32_bf16 v[24:27], a[216:219], a[188:191], v[24:27]
    v_exp_f32_e64 v135, v55
    v_mfma_f32_16x16x32_bf16 v[20:23], a[220:223], a[172:175], v[20:23]
    v_exp_f32_e64 v136, v56
    v_cvt_pk_bf16_f32 v122, v132, v133
    v_mfma_f32_16x16x32_bf16 v[28:31], a[220:223], a[188:191], v[28:31]
    v_or3_b32 v208, v120, v121, v122
    s_waitcnt lgkmcnt(8)
    v_mfma_f32_16x16x32_bf16 a[64:67], a[224:227], v[104:107], a[64:67]
    ds_read_b128 a[208:211], v241 offset:12288
    ds_read_b128 a[212:215], v241 offset:13312
    v_mfma_f32_16x16x32_bf16 a[96:99], a[224:227], v[108:111], a[96:99]
    v_exp_f32 v137, v57
    v_mfma_f32_16x16x32_bf16 a[68:71], a[228:231], v[104:107], a[68:71]
    v_exp_f32_e64 v138, v58
    v_mfma_f32_16x16x32_bf16 a[100:103], a[228:231], v[108:111], a[100:103]
    buffer_load_dwordx4 v242, s[16:19], s41 offen offset:2048 sc1 lds
    v_exp_f32_e64 v139, v59
    v_mfma_f32_16x16x32_bf16 a[72:75], a[232:235], v[104:107], a[72:75]
    ds_read_b128 a[216:219], v241 offset:14336
    ds_read_b128 a[220:223], v241 offset:15360
    v_mfma_f32_16x16x32_bf16 a[104:107], a[232:235], v[108:111], a[104:107]
    v_exp_f32_e64 v140, v60
    v_mfma_f32_16x16x32_bf16 a[76:79], a[236:239], v[104:107], a[76:79]
    buffer_load_dwordx4 v242, s[16:19], s41 offen offset:3072 sc1 lds
    v_cvt_pk_bf16_f32 v123, v134, v135
    v_mfma_f32_16x16x32_bf16 a[108:111], a[236:239], v[108:111], a[108:111]
    v_exp_f32 v141, v61
    s_waitcnt lgkmcnt(8)
    v_mfma_f32_16x16x32_bf16 a[80:83], a[240:243], v[104:107], a[80:83]
    ds_read_b128 a[224:227], v241 offset:24576
    ds_read_b128 a[228:231], v241 offset:25600
    v_mfma_f32_16x16x32_bf16 a[112:115], a[240:243], v[108:111], a[112:115]
    v_cvt_pk_bf16_f32 v124, v136, v137
    v_or3_b32 v208, v208, v123, v124
    v_mfma_f32_16x16x32_bf16 a[84:87], a[244:247], v[104:107], a[84:87]
    v_exp_f32_e64 v142, v62
    v_mfma_f32_16x16x32_bf16 a[116:119], a[244:247], v[108:111], a[116:119]
    s_add_u32 s35, s35, 32768
    s_cmp_ge_u32 s35, 163840
    s_cselect_b32 s35, 0, s35
    v_mfma_f32_16x16x32_bf16 a[88:91], a[248:251], v[104:107], a[88:91]
    ds_read_b128 a[232:235], v241 offset:26624
    ds_read_b128 a[236:239], v241 offset:27648
    v_mfma_f32_16x16x32_bf16 a[120:123], a[248:251], v[108:111], a[120:123]
    v_exp_f32 v143, v63
    v_mfma_f32_16x16x32_bf16 a[92:95], a[252:255], v[104:107], a[92:95]
    v_cvt_pk_bf16_f32 v125, v138, v139
    v_cvt_pk_bf16_f32 v126, v140, v141
    v_mfma_f32_16x16x32_bf16 a[124:127], a[252:255], v[108:111], a[124:127]
    v_or3_b32 v208, v208, v125, v126
    v_cvt_pk_bf16_f32 v127, v142, v143
    v_or_b32_e64 v208, v208, v127
    v_mfma_f32_16x16x32_bf16 v[152:155], v[204:207], v[104:107], v[152:155]
    v_and_b32 v208, s38, v208
    v_cmp_ne_u32 vcc, 0, v208
    v_mfma_f32_16x16x32_bf16 v[156:159], v[204:207], v[108:111], v[156:159]
    s_cbranch_vccnz kf_rare22
kf_rr21:
    s_sub_u32 s36, s36, 1
    s_cbranch_scc1 kf_fix27
kf_fixr28:
    s_waitcnt lgkmcnt(8)
    v_mfma_f32_16x16x32_bf16 v[48:51], a[192:195], a[160:163], v[80:83]
    ds_read_b128 a[240:243], v241 offset:28672
    ds_read_b128 a[244:247], v241 offset:29696
    v_mfma_f32_16x16x32_bf16 v[56:59], a[192:195], a[176:179], v[88:91]
    s_add_u32 m0, s34, 16384
    v_exp_f32_e64 v128, v16
    v_mfma_f32_16x16x32_bf16 v[52:55], a[196:199], a[160:163], v[84:87]
    v_exp_f32_e64 v129, v17
    v_mfma_f32_16x16x32_bf16 v[60:63], a[196:199], a[176:179], v[92:95]
    v_exp_f32_e64 v130, v18
    v_mfma_f32_16x16x32_bf16 v[48:51], a[200:203], a[164:167], v[48:51]
    ds_read_b128 a[248:251], v241 offset:30720
    ds_read_b128 a[252:255], v241 offset:31744
    s_add_u32 s34, s34, 32768
    v_mfma_f32_16x16x32_bf16 v[56:59], a[200:203], a[180:183], v[56:59]
    s_cmp_ge_u32 s34, 163840
    s_cselect_b32 s34, s37, s34
    v_mfma_f32_16x16x32_bf16 v[52:55], a[204:207], a[164:167], v[52:55]
    v_exp_f32 v131, v19
    v_mfma_f32_16x16x32_bf16 v[60:63], a[204:207], a[180:183], v[60:63]
    v_exp_f32 v132, v20
    s_waitcnt lgkmcnt(8)
    v_mfma_f32_16x16x32_bf16 v[48:51], a[208:211], a[168:171], v[48:51]
    s_waitcnt vmcnt(12)
    s_barrier
    v_add_u32_e64 v241, s35, v240
    ds_read_b128 a[192:195], v241 offset:0
    v_mfma_f32_16x16x32_bf16 v[56:59], a[208:211], a[184:187], v[56:59]
    v_exp_f32_e64 v133, v21
    v_mfma_f32_16x16x32_bf16 v[52:55], a[212:215], a[168:171], v[52:55]
    ds_read_b128 a[196:199], v241 offset:1024
    buffer_load_dwordx4 v242, s[16:19], s42 offen offset:0 sc1 lds
    v_mfma_f32_16x16x32_bf16 v[60:63], a[212:215], a[184:187], v[60:63]
    v_exp_f32_e64 v134, v22
    v_cvt_pk_bf16_f32 v104, v128, v129
    v_mfma_f32_16x16x32_bf16 v[48:51], a[216:219], a[172:175], v[48:51]
    ds_read_b128 a[200:203], v241 offset:2048
    ds_read_b128 a[204:207], v241 offset:3072
    v_mfma_f32_16x16x32_bf16 v[56:59], a[216:219], a[188:191], v[56:59]
    v_exp_f32_e64 v135, v23
    v_mfma_f32_16x16x32_bf16 v[52:55], a[220:223], a[172:175], v[52:55]
    buffer_load_dwordx4 v242, s[16:19], s42 offen offset:1024 sc1 lds
    v_exp_f32_e64 v136, v24
    v_mfma_f32_16x16x32_bf16 v[60:63], a[220:223], a[188:191], v[60:63]
    v_cvt_pk_bf16_f32 v105, v130, v131
    s_waitcnt lgkmcnt(8)
    v_mfma_f32_16x16x32_bf16 a[64:67], a[224:227], v[120:123], a[64:67]
    ds_read_b128 a[208:211], v241 offset:4096
    ds_read_b128 a[212:215], v241 offset:5120
    v_mfma_f32_16x16x32_bf16 a[96:99], a[224:227], v[124:127], a[96:99]
    v_exp_f32 v137, v25
    v_mfma_f32_16x16x32_bf16 a[68:71], a[228:231], v[120:123], a[68:71]
    v_cvt_pk_bf16_f32 v106, v132, v133
    v_exp_f32_e64 v138, v26
    v_mfma_f32_16x16x32_bf16 a[100:103], a[228:231], v[124:127], a[100:103]
    v_exp_f32_e64 v139, v27
    v_mfma_f32_16x16x32_bf16 a[72:75], a[232:235], v[120:123], a[72:75]
    ds_read_b128 a[216:219], v241 offset:6144
    ds_read_b128 a[220:223], v241 offset:7168
    v_mfma_f32_16x16x32_bf16 a[104:107], a[232:235], v[124:127], a[104:107]
    buffer_load_dwordx4 v242, s[16:19], s42 offen offset:2048 sc1 lds
    v_or3_b32 v208, v104, v105, v106
    v_cvt_pk_bf16_f32 v107, v134, v135
    v_mfma_f32_16x16x32_bf16 a[76:79], a[236:239], v[120:123], a[76:79]
    v_exp_f32_e64 v140, v28
    v_mfma_f32_16x16x32_bf16 a[108:111], a[236:239], v[124:127], a[108:111]
    v_cvt_pk_bf16_f32 v108, v136, v137
    s_waitcnt lgkmcnt(8)
    v_mfma_f32_16x16x32_bf16 a[80:83], a[240:243], v[120:123], a[80:83]
    ds_read_b128 a[224:227], v241 offset:16384
    ds_read_b128 a[228:231], v241 offset:17408
    v_or3_b32 v208, v208, v107, v108
    v_mfma_f32_16x16x32_bf16 a[112:115], a[240:243], v[124:127], a[112:115]
    v_exp_f32 v141, v29
    v_mfma_f32_16x16x32_bf16 a[84:87], a[244:247], v[120:123], a[84:87]
    v_exp_f32_e64 v142, v30
    v_mfma_f32_16x16x32_bf16 a[116:119], a[244:247], v[124:127], a[116:119]
    v_exp_f32_e64 v143, v31
    v_mfma_f32_16x16x32_bf16 a[88:91], a[248:251], v[120:123], a[88:91]
    ds_read_b128 a[232:235], v241 offset:18432
    ds_read_b128 a[236:239], v241 offset:19456
    buffer_load_dwordx4 v242, s[16:19], s42 offen offset:3072 sc1 lds
    v_mfma_f32_16x16x32_bf16 a[120:123], a[248:251], v[124:127], a[120:123]
    s_add_u32 s42, s42, 34048
    v_cvt_pk_bf16_f32 v109, v138, v139
    v_mfma_f32_16x16x32_bf16 a[92:95], a[252:255], v[120:123], a[92:95]
    v_cvt_pk_bf16_f32 v110, v140, v141
    v_or3_b32 v208, v208, v109, v110
    v_mfma_f32_16x16x32_bf16 a[124:127], a[252:255], v[124:127], a[124:127]
    v_cvt_pk_bf16_f32 v111, v142, v143
    v_or_b32 v208, v208, v111
    v_and_b32 v208, s38, v208
    v_mfma_f32_16x16x32_bf16 v[152:155], v[204:207], v[120:123], v[152:155]
    v_cmp_ne_u32_e64 vcc, 0, v208
    v_mfma_f32_16x16x32_bf16 v[156:159], v[204:207], v[124:127], v[156:159]
    s_cbranch_vccnz kf_rare26
kf_rr25:
ka_p2_e:
    s_sub_u32 s26, s26, 1
    s_cbranch_scc0 ka_p2
    s_branch ka_p2_x
kf_fix23:
    s_mov_b32 s24, 0
    s_branch kf_fix23c
kf_fix27:
    s_mov_b32 s24, 1
kf_fix23c:
    s_cmp_eq_u32 s33, 0
    s_cbranch_scc0 kf_fix23f
    s_mov_b32 s36, 0
    s_mov_b32 s33, 1
    v_add_f32 v80, v226, v200
    v_add_f32 v81, v226, v201
    v_add_f32 v82, v226, v202
    v_add_f32 v83, v226, v203
    v_add_f32 v84, v226, v209
    v_add_f32 v85, v226, v210
    v_add_f32 v86, v226, v211
    v_add_f32 v87, v226, v212
    v_add_f32 v88, v227, v213
    v_add_f32 v89, v227, v214
    v_add_f32 v90, v227, v215
    v_add_f32 v91, v227, v216
    v_add_f32 v92, v227, v217
    v_add_f32 v93, v227, v218
    v_add_f32 v94, v227, v219
    v_add_f32 v95, v227, v220
    s_cmp_eq_u32 s24, 0
    s_cbranch_scc1 kf_fixr24
    s_branch kf_fixr28
kf_fix23f:
    s_mov_b32 s36, 0x1000
    v_mov_b32 v80, 0xf1800000
    v_mov_b32 v81, v80
    v_mov_b32 v82, v80
    v_mov_b32 v83, v80
    v_mov_b32 v84, v80
    v_mov_b32 v85, v80
    v_mov_b32 v86, v80
    v_mov_b32 v87, v80
    v_mov_b32 v88, v80
    v_mov_b32 v89, v80
    v_mov_b32 v90, v80
    v_mov_b32 v91, v80
    v_mov_b32 v92, v80
    v_mov_b32 v93, v80
    v_mov_b32 v94, v80
    v_mov_b32_e64 v95, v80
    s_cmp_eq_u32 s24, 0
    s_cbranch_scc1 kf_fixr24
    s_branch kf_fixr28
ka_p2_x:
    s_waitcnt lgkmcnt(0)
    ds_read_b128 a[224:227], v241 offset:16384
    ds_read_b128 a[228:231], v241 offset:17408
    ds_read_b128 a[232:235], v241 offset:18432
    ds_read_b128 a[236:239], v241 offset:19456
    ds_read_b128 a[240:243], v241 offset:20480
    ds_read_b128 a[244:247], v241 offset:21504
    ds_read_b128 a[248:251], v241 offset:22528
    ds_read_b128 a[252:255], v241 offset:23552
    ds_read_b128 a[192:195], v241 offset:24576
    ds_read_b128 a[196:199], v241 offset:25600
    ds_read_b128 a[200:203], v241 offset:26624
    ds_read_b128 a[204:207], v241 offset:27648
    ds_read_b128 a[208:211], v241 offset:28672
    ds_read_b128 a[212:215], v241 offset:29696
    ds_read_b128 a[216:219], v241 offset:30720
    s_waitcnt lgkmcnt(7)
    ds_read_b128 a[220:223], v241 offset:31744
    v_mfma_f32_16x16x32_bf16 a[64:67], a[224:227], v[104:107], a[64:67]
    v_exp_f32 v128, v48
    v_exp_f32_e64 v129, v49
    v_mfma_f32_16x16x32_bf16 a[96:99], a[224:227], v[108:111], a[96:99]
    v_exp_f32_e64 v130, v50
    v_cvt_pk_bf16_f32 v120, v128, v129
    v_mfma_f32_16x16x32_bf16 a[68:71], a[228:231], v[104:107], a[68:71]
    v_exp_f32_e64 v131, v51
    v_mfma_f32_16x16x32_bf16 a[100:103], a[228:231], v[108:111], a[100:103]
    v_exp_f32_e64 v132, v52
    v_cvt_pk_bf16_f32 v121, v130, v131
    v_mfma_f32_16x16x32_bf16 a[72:75], a[232:235], v[104:107], a[72:75]
    v_exp_f32_e64 v133, v53
    v_mfma_f32_16x16x32_bf16 a[104:107], a[232:235], v[108:111], a[104:107]
    v_exp_f32_e64 v134, v54
    v_cvt_pk_bf16_f32 v122, v132, v133
    v_mfma_f32_16x16x32_bf16 a[76:79], a[236:239], v[104:107], a[76:79]
    v_exp_f32_e64 v135, v55
    v_or3_b32 v208, v120, v121, v122
    v_mfma_f32_16x16x32_bf16 a[108:111], a[236:239], v[108:111], a[108:111]
    v_exp_f32_e64 v136, v56
    v_cvt_pk_bf16_f32 v123, v134, v135
    v_mfma_f32_16x16x32_bf16 a[80:83], a[240:243], v[104:107], a[80:83]
    v_exp_f32_e64 v137, v57
    v_mfma_f32_16x16x32_bf16 a[112:115], a[240:243], v[108:111], a[112:115]
    v_exp_f32_e64 v138, v58
    v_cvt_pk_bf16_f32 v124, v136, v137
    v_mfma_f32_16x16x32_bf16 a[84:87], a[244:247], v[104:107], a[84:87]
    v_exp_f32_e64 v139, v59
    v_or3_b32 v208, v208, v123, v124
    v_mfma_f32_16x16x32_bf16 a[116:119], a[244:247], v[108:111], a[116:119]
    v_exp_f32_e64 v140, v60
    v_cvt_pk_bf16_f32 v125, v138, v139
    v_mfma_f32_16x16x32_bf16 a[88:91], a[248:251], v[104:107], a[88:91]
    v_exp_f32_e64 v141, v61
    v_mfma_f32_16x16x32_bf16 a[120:123], a[248:251], v[108:111], a[120:123]
    v_exp_f32_e64 v142, v62
    v_cvt_pk_bf16_f32 v126, v140, v141
    v_mfma_f32_16x16x32_bf16 a[92:95], a[252:255], v[104:107], a[92:95]
    v_exp_f32_e64 v143, v63
    v_or3_b32 v208, v208, v125, v126
    v_mfma_f32_16x16x32_bf16 a[124:127], a[252:255], v[108:111], a[124:127]
    v_cvt_pk_bf16_f32 v127, v142, v143
    v_or_b32 v208, v208, v127
    v_and_b32 v208, s38, v208
    v_mfma_f32_16x16x32_bf16 v[152:155], v[204:207], v[104:107], v[152:155]
    v_cmp_ne_u32_e64 vcc, 0, v208
    v_mfma_f32_16x16x32_bf16 v[156:159], v[204:207], v[108:111], v[156:159]
    s_cbranch_vccnz kf_rare30
kf_rr29:
    s_waitcnt lgkmcnt(0)
    s_nop 0
    v_mfma_f32_16x16x32_bf16 a[64:67], a[192:195], v[120:123], a[64:67]
    v_mfma_f32_16x16x32_bf16 a[96:99], a[192:195], v[124:127], a[96:99]
    v_mfma_f32_16x16x32_bf16 a[68:71], a[196:199], v[120:123], a[68:71]
    v_mfma_f32_16x16x32_bf16 a[100:103], a[196:199], v[124:127], a[100:103]
    v_mfma_f32_16x16x32_bf16 a[72:75], a[200:203], v[120:123], a[72:75]
    v_mfma_f32_16x16x32_bf16 a[104:107], a[200:203], v[124:127], a[104:107]
    v_mfma_f32_16x16x32_bf16 a[76:79], a[204:207], v[120:123], a[76:79]
    v_mfma_f32_16x16x32_bf16 a[108:111], a[204:207], v[124:127], a[108:111]
    v_mfma_f32_16x16x32_bf16 a[80:83], a[208:211], v[120:123], a[80:83]
    v_mfma_f32_16x16x32_bf16 a[112:115], a[208:211], v[124:127], a[112:115]
    v_mfma_f32_16x16x32_bf16 a[84:87], a[212:215], v[120:123], a[84:87]
    v_mfma_f32_16x16x32_bf16 a[116:119], a[212:215], v[124:127], a[116:119]
    v_mfma_f32_16x16x32_bf16 a[88:91], a[216:219], v[120:123], a[88:91]
    v_mfma_f32_16x16x32_bf16 a[120:123], a[216:219], v[124:127], a[120:123]
    v_mfma_f32_16x16x32_bf16 a[92:95], a[220:223], v[120:123], a[92:95]
    v_mfma_f32_16x16x32_bf16 a[124:127], a[220:223], v[124:127], a[124:127]
    v_mfma_f32_16x16x32_bf16 v[152:155], v[204:207], v[120:123], v[152:155]
    v_mfma_f32_16x16x32_bf16 v[156:159], v[204:207], v[124:127], v[156:159]
    s_cmp_eq_u32 s31, 0
    s_cbranch_scc1 ka_nox
    s_waitcnt vmcnt(8)
    s_barrier
ka_nox:
    s_nop 6
    v_rcp_f32 v230, v152
    v_rcp_f32 v231, v156
    v_accvgpr_read_b32 v160, a64
    v_accvgpr_read_b32 v161, a65
    v_accvgpr_read_b32 v162, a66
    v_accvgpr_read_b32 v163, a67
    v_accvgpr_read_b32 v164, a68
    v_accvgpr_read_b32 v165, a69
    v_accvgpr_read_b32 v166, a70
    v_accvgpr_read_b32 v167, a71
    v_mul_f32 v160, v160, v230
    v_mul_f32 v161, v161, v230
    v_mul_f32 v162, v162, v230
    v_mul_f32 v163, v163, v230
    v_mul_f32 v164, v164, v230
    v_mul_f32 v165, v165, v230
    v_mul_f32 v166, v166, v230
    v_mul_f32 v167, v167, v230
    v_cvt_pk_bf16_f32 v176, v160, v161
    v_cvt_pk_bf16_f32 v177, v162, v163
    v_cvt_pk_bf16_f32 v178, v164, v165
    v_cvt_pk_bf16_f32 v179, v166, v167
    buffer_store_dwordx4 v[176:179], v240, s[20:23], s40 offen offset:0 sc1
    v_accvgpr_read_b32 v168, a72
    v_accvgpr_read_b32 v169, a73
    v_accvgpr_read_b32 v170, a74
    v_accvgpr_read_b32 v171, a75
    v_accvgpr_read_b32 v172, a76
    v_accvgpr_read_b32 v173, a77
    v_accvgpr_read_b32 v174, a78
    v_accvgpr_read_b32 v175, a79
    v_mul_f32 v168, v168, v230
    v_mul_f32 v169, v169, v230
    v_mul_f32 v170, v170, v230
    v_mul_f32 v171, v171, v230
    v_mul_f32 v172, v172, v230
    v_mul_f32 v173, v173, v230
    v_mul_f32 v174, v174, v230
    v_mul_f32 v175, v175, v230
    v_cvt_pk_bf16_f32 v180, v168, v169
    v_cvt_pk_bf16_f32 v181, v170, v171
    v_cvt_pk_bf16_f32 v182, v172, v173
    v_cvt_pk_bf16_f32 v183, v174, v175
    buffer_store_dwordx4 v[180:183], v240, s[20:23], s40 offen offset:1024 sc1
    v_accvgpr_read_b32 v160, a80
    v_accvgpr_read_b32 v161, a81
    v_accvgpr_read_b32 v162, a82
    v_accvgpr_read_b32 v163, a83
    v_accvgpr_read_b32 v164, a84
    v_accvgpr_read_b32 v165, a85
    v_accvgpr_read_b32 v166, a86
    v_accvgpr_read_b32 v167, a87
    v_mul_f32 v160, v160, v230
    v_mul_f32 v161, v161, v230
    v_mul_f32 v162, v162, v230
    v_mul_f32 v163, v163, v230
    v_mul_f32 v164, v164, v230
    v_mul_f32 v165, v165, v230
    v_mul_f32 v166, v166, v230
    v_mul_f32 v167, v167, v230
    v_cvt_pk_bf16_f32 v184, v160, v161
    v_cvt_pk_bf16_f32 v185, v162, v163
    v_cvt_pk_bf16_f32 v186, v164, v165
    v_cvt_pk_bf16_f32 v187, v166, v167
    buffer_store_dwordx4 v[184:187], v240, s[20:23], s40 offen offset:2048 sc1
    v_accvgpr_read_b32 v168, a88
    v_accvgpr_read_b32 v169, a89
    v_accvgpr_read_b32 v170, a90
    v_accvgpr_read_b32 v171, a91
    v_accvgpr_read_b32 v172, a92
    v_accvgpr_read_b32 v173, a93
    v_accvgpr_read_b32 v174, a94
    v_accvgpr_read_b32 v175, a95
    v_mul_f32 v168, v168, v230
    v_mul_f32 v169, v169, v230
    v_mul_f32 v170, v170, v230
    v_mul_f32 v171, v171, v230
    v_mul_f32 v172, v172, v230
    v_mul_f32 v173, v173, v230
    v_mul_f32 v174, v174, v230
    v_mul_f32 v175, v175, v230
    v_cvt_pk_bf16_f32 v188, v168, v169
    v_cvt_pk_bf16_f32 v189, v170, v171
    v_cvt_pk_bf16_f32 v190, v172, v173
    v_cvt_pk_bf16_f32 v191, v174, v175
    buffer_store_dwordx4 v[188:191], v240, s[20:23], s40 offen offset:3072 sc1
    v_accvgpr_read_b32 v160, a96
    v_accvgpr_read_b32 v161, a97
    v_accvgpr_read_b32 v162, a98
    v_accvgpr_read_b32 v163, a99
    v_accvgpr_read_b32 v164, a100
    v_accvgpr_read_b32 v165, a101
    v_accvgpr_read_b32 v166, a102
    v_accvgpr_read_b32 v167, a103
    v_mul_f32 v160, v160, v231
    v_mul_f32 v161, v161, v231
    v_mul_f32 v162, v162, v231
    v_mul_f32 v163, v163, v231
    v_mul_f32 v164, v164, v231
    v_mul_f32 v165, v165, v231
    v_mul_f32 v166, v166, v231
    v_mul_f32 v167, v167, v231
    v_cvt_pk_bf16_f32 v176, v160, v161
    v_cvt_pk_bf16_f32 v177, v162, v163
    v_cvt_pk_bf16_f32 v178, v164, v165
    v_cvt_pk_bf16_f32 v179, v166, v167
    buffer_store_dwordx4 v[176:179], v244, s[20:23], s40 offen offset:0 sc1
    v_accvgpr_read_b32 v168, a104
    v_accvgpr_read_b32 v169, a105
    v_accvgpr_read_b32 v170, a106
    v_accvgpr_read_b32 v171, a107
    v_accvgpr_read_b32 v172, a108
    v_accvgpr_read_b32 v173, a109
    v_accvgpr_read_b32 v174, a110
    v_accvgpr_read_b32 v175, a111
    v_mul_f32 v168, v168, v231
    v_mul_f32 v169, v169, v231
    v_mul_f32 v170, v170, v231
    v_mul_f32 v171, v171, v231
    v_mul_f32 v172, v172, v231
    v_mul_f32 v173, v173, v231
    v_mul_f32 v174, v174, v231
    v_mul_f32 v175, v175, v231
    v_cvt_pk_bf16_f32 v180, v168, v169
    v_cvt_pk_bf16_f32 v181, v170, v171
    v_cvt_pk_bf16_f32 v182, v172, v173
    v_cvt_pk_bf16_f32 v183, v174, v175
    buffer_store_dwordx4 v[180:183], v244, s[20:23], s40 offen offset:1024 sc1
    v_accvgpr_read_b32 v160, a112
    v_accvgpr_read_b32 v161, a113
    v_accvgpr_read_b32 v162, a114
    v_accvgpr_read_b32 v163, a115
    v_accvgpr_read_b32 v164, a116
    v_accvgpr_read_b32 v165, a117
    v_accvgpr_read_b32 v166, a118
    v_accvgpr_read_b32 v167, a119
    v_mul_f32 v160, v160, v231
    v_mul_f32 v161, v161, v231
    v_mul_f32 v162, v162, v231
    v_mul_f32 v163, v163, v231
    v_mul_f32 v164, v164, v231
    v_mul_f32 v165, v165, v231
    v_mul_f32 v166, v166, v231
    v_mul_f32 v167, v167, v231
    v_cvt_pk_bf16_f32 v184, v160, v161
    v_cvt_pk_bf16_f32 v185, v162, v163
    v_cvt_pk_bf16_f32 v186, v164, v165
    v_cvt_pk_bf16_f32 v187, v166, v167
    buffer_store_dwordx4 v[184:187], v244, s[20:23], s40 offen offset:2048 sc1
    v_accvgpr_read_b32 v168, a120
    v_accvgpr_read_b32 v169, a121
    v_accvgpr_read_b32 v170, a122
    v_accvgpr_read_b32 v171, a123
    v_accvgpr_read_b32 v172, a124
    v_accvgpr_read_b32 v173, a125
    v_accvgpr_read_b32 v174, a126
    v_accvgpr_read_b32 v175, a127
    v_mul_f32 v168, v168, v231
    v_mul_f32 v169, v169, v231
    v_mul_f32 v170, v170, v231
    v_mul_f32 v171, v171, v231
    v_mul_f32 v172, v172, v231
    v_mul_f32 v173, v173, v231
    v_mul_f32 v174, v174, v231
    v_mul_f32 v175, v175, v231
    v_cvt_pk_bf16_f32 v188, v168, v169
    v_cvt_pk_bf16_f32 v189, v170, v171
    v_cvt_pk_bf16_f32 v190, v172, v173
    v_cvt_pk_bf16_f32 v191, v174, v175
    buffer_store_dwordx4 v[188:191], v244, s[20:23], s40 offen offset:3072 sc1
    s_sub_u32 s46, s20, 0x2400000
    s_subb_u32 s47, s21, 0
    s_mov_b64 s[42:43], s[56:57]
    s_mov_b64 s[40:41], s[80:81]
    s_mov_b64 s[44:45], s[82:83]
    s_mov_b64 s[60:61], s[84:85]
    s_mov_b64 s[62:63], s[86:87]
    v_mbcnt_lo_u32_b32 v237, -1, 0
    v_mbcnt_hi_u32_b32 v237, -1, v237
    s_lshl_b32 s32, s3, 6
    v_add_u32 v230, s32, v237
    s_lshr_b32 s53, s2, 3
    s_lshr_b32 s6, s2, 1
    s_and_b32 s6, s6, 3
    s_and_b32 s4, s2, 1
    s_lshl_b32 s4, s4, 2
    s_and_b32 s33, s53, 3
    s_add_u32 s4, s4, s33
    s_lshr_b32 s5, s53, 2
    v_lshlrev_b32 v228, 4, v237
    v_lshrrev_b32 v234, 4, v237
    v_and_b32 v235, 15, v237
    v_lshlrev_b32 v236, 1, v234
    v_xor_b32 v235, v235, v236
    v_lshlrev_b32 v234, 11, v234
    s_lshl_b32 s32, s3, 14
    s_lshl_b32 s33, s5, 8
    s_add_u32 s32, s32, s33
    v_add_u32 v234, s32, v234
    v_lshl_add_u32 v224, v235, 4, v234
    v_xor_b32_e64 v235, 8, v235
    v_lshl_add_u32 v225, v235, 4, v234
    v_add_u32 v225, 7168, v225
    s_lshl_b32 s37, s6, 21
    s_lshl_b32 s38, s3, 11
    s_lshl2_add_u32 s4, s4, s3
    s_sub_u32 s32, 63, s4
    s_cmp_lt_u32 s6, 2
    s_cselect_b32 s4, s4, s32
    s_lshl_b32 s32, s4, 18
    v_add_u32 v226, s32, v228
    v_add_u32 v227, 0x20000, v226
    v_xor_b32 v245, 0xfc0000, v226
    v_xor_b32 v246, 0xfc0000, v227
    s_lshl_b32 s35, s6, 15
    s_add_u32 s35, s35, 0x2400000
    s_getpc_b64 s[56:57]
kc_pc0:
    s_mov_b32 s58, kc_end-kc_pc0
    s_mov_b32 s59, 0x00020000
    v_lshlrev_b32_e64 v234, 7, v230
    buffer_load_dword v241, v234, s[56:59], 0 offen
    s_waitcnt lgkmcnt(0)
    s_mov_b32 s8, s46
    s_mov_b32 s9, s47
    s_mov_b32 s10, 0x10000000
    s_mov_b32 s11, 0x00020000
    s_mov_b32 s12, s42
    s_mov_b32 s13, s43
    s_mov_b32 s14, 0x800000
    s_mov_b32 s15, 0x00020000
    s_mov_b32 s16, s40
    s_mov_b32 s17, s41
    s_mov_b32 s18, 0x400000
    s_mov_b32 s19, 0x00020000
    s_mov_b32 s20, s44
    s_mov_b32 s21, s45
    s_mov_b32 s22, 0x800
    s_mov_b32 s23, 0x00020000
    s_mov_b32 s24, s60
    s_mov_b32 s25, s61
    s_mov_b32 s26, 0x700000
    s_mov_b32 s27, 0x00020000
    s_mov_b32 s28, s62
    s_mov_b32 s29, s63
    s_mov_b32 s30, 0x400000
    s_mov_b32 s31, 0x00020000
    s_lshr_b32 s44, s6, 1
    s_and_b32 s6, s6, 1
    v_bfe_u32 v234, v237, 2, 3
    v_lshrrev_b32 v235, 5, v237
    v_lshl_add_u32 v235, v235, 4, v234
    v_lshlrev_b32 v235, 8, v235
    v_and_b32 v236, 1, v237
    v_lshl_add_u32 v235, v236, 3, v235
    v_lshlrev_b32_e64 v234, 1, v234
    v_bfe_u32 v236, v237, 1, 1
    v_or_b32 v234, v234, v236
    s_lshl_b32 s32, s6, 3
    v_xor_b32 v234, s32, v234
    v_xor_b32 v236, 0, v234
    v_lshl_add_u32 v216, v236, 4, v235
    v_xor_b32_e64 v236, 2, v234
    v_lshl_add_u32 v217, v236, 4, v235
    v_xor_b32_e64 v236, 4, v234
    v_lshl_add_u32 v218, v236, 4, v235
    v_xor_b32_e64 v236, 6, v234
    v_lshl_add_u32 v219, v236, 4, v235
    v_xor_b32_e64 v236, 8, v234
    v_lshl_add_u32 v220, v236, 4, v235
    v_xor_b32_e64 v236, 10, v234
    v_lshl_add_u32 v221, v236, 4, v235
    v_xor_b32_e64 v236, 12, v234
    v_lshl_add_u32 v222, v236, 4, v235
    v_xor_b32_e64 v236, 14, v234
    v_lshl_add_u32 v223, v236, 4, v235
    s_lshl_b32 s44, s4, 5
    v_lshrrev_b32 v234, 3, v237
    v_add_u32 v242, s44, v234
    v_and_b32 v235, 7, v237
    s_lshl1_add_u32 s33, s5, s6
    s_lshl_b32 s33, s33, 7
    v_lshl_add_u32 v240, v235, 4, s33
    v_lshl_add_u32 v229, v242, 11, v240
    s_mul_i32 s32, s3, 4608
    s_add_u32 s32, s32, 131072
    v_mul_u32_u24 v234, 144, v234
    v_lshl_add_u32 v234, v235, 4, v234
    v_add_u32 v239, s32, v234
    v_and_b32 v234, 15, v237
    v_mul_u32_u24 v234, 144, v234
    v_lshrrev_b32_e64 v236, 4, v237
    v_lshl_add_u32 v234, v236, 3, v234
    v_add_u32 v238, s32, v234
    v_and_b32 v234, 3, v237
    v_lshl_add_u32 v234, v234, 3, v242
    v_lshlrev_b32 v234, 2, v234
    v_lshrrev_b32 v235, 2, v235
    v_lshl_add_u32 v231, v235, 13, v234
    v_lshlrev_b32_e64 v235, 30, v235
    v_add_u32 v235, 16384, v235
    v_add_u32 v232, v235, v234
    s_cmp_eq_u32 s44, 0
    s_cselect_b32 s32, 4, 64
    v_cmp_eq_u32 vcc, s32, v237
    v_mov_b32 v235, 24576
    v_mov_b32 v233, 1
    v_cndmask_b32 v232, v232, v235, vcc
    v_and_b32_e64 v234, 1, v237
    v_cmp_ne_u32 s[60:61], 0, v234
    v_and_b32_e64 v234, 2, v237
    v_cmp_ne_u32 s[62:63], 0, v234
    v_and_b32_e64 v234, 4, v237
    v_cmp_ne_u32 s[40:41], 0, v234
    v_cmp_eq_u32 vcc, 0, v237
    v_mov_b32_e64 v235, 0x40000000
    s_nop 0
    v_cndmask_b32 v243, v235, v237, vcc
    s_lshl2_add_u32 s39, s2, s3
    s_mov_b32 s48, 0x3800000
    s_mov_b32 s49, 0x3802000
    s_mov_b32 s50, 0x3804000
    s_and_b32 s52, s2, 7
    s_mul_i32 s54, s52, 28
    s_add_u32 s54, s54, s53
    v_lshrrev_b32 v234, 3, v237
    v_lshlrev_b32 v234, 11, v234
    v_and_b32 v235, 7, v237
    v_lshl_add_u32 v244, v235, 4, v234
    s_lshl_b32 s55, s54, 16
    s_lshl_b32 s32, s3, 13
    s_add_u32 s55, s55, s32
    s_add_u32 s55, s55, 0x4000000
    s_lshl_b32 s51, s54, 15
    s_lshl_b32 s32, s3, 9
    s_add_u32 s51, s51, s32
    s_cmp_ge_u32 s53, 28
    s_cselect_b32 s55, 0x40000000, s55
    s_cselect_b32 s51, 0x40000000, s51
    s_lshr_b32 s32, s2, 5
    s_lshl_b32 s32, s32, 9
    s_and_b32 s33, s2, 6
    s_lshl_b32 s33, s33, 6
    s_add_u32 s32, s32, s33
    s_add_u32 s32, s32, 0x38a4000
    s_waitcnt vmcnt(0)
    s_barrier
    s_cmp_lg_u32 s3, 0
    s_cbranch_scc1 kc_a0
    buffer_atomic_add v233, v243, s[8:11], s32 offen sc1
    s_lshl_b32 s32, s52, 7
    s_add_u32 s32, s32, 0x38a1000
    v_mov_b32 v235, 1
    buffer_atomic_add v235, v243, s[8:11], s32 offen sc0 sc1
    v_lshlrev_b32 v234, 7, v237
    v_cmp_gt_u32 vcc, 8, v237
    v_mov_b32_e64 v236, 0x40000000
    s_mov_b32 s34, 0x38a1400
    v_cndmask_b32 v234, v236, v234, vcc
    s_waitcnt vmcnt(0)
    v_readfirstlane_b32 s36, v235
    s_cmp_lg_u32 s36, 31
    s_cbranch_scc1 kc_a0
    buffer_atomic_add v233, v234, s[8:11], s34 offen sc1
kc_a0:
    s_add_u32 m0, s38, 0
    s_add_u32 s32, s37, 0
    buffer_load_dwordx4 v224, s[12:15], s32 offen lds
    buffer_load_dwordx4 v225, s[12:15], s32 offen offset:1024 lds
    s_add_u32 m0, s38, 8192
    s_add_u32 s32, s37, 65536
    buffer_load_dwordx4 v224, s[12:15], s32 offen lds
    buffer_load_dwordx4 v225, s[12:15], s32 offen offset:1024 lds
    s_add_u32 m0, s38, 16384
    s_add_u32 s32, s37, 131072
    buffer_load_dwordx4 v224, s[12:15], s32 offen lds
    buffer_load_dwordx4 v225, s[12:15], s32 offen offset:1024 lds
    s_add_u32 m0, s38, 24576
    s_add_u32 s32, s37, 196608
    buffer_load_dwordx4 v224, s[12:15], s32 offen lds
    buffer_load_dwordx4 v225, s[12:15], s32 offen offset:1024 lds
    s_add_u32 m0, s38, 32768
    s_add_u32 s32, s37, 262144
    buffer_load_dwordx4 v224, s[12:15], s32 offen lds
    buffer_load_dwordx4 v225, s[12:15], s32 offen offset:1024 lds
    s_add_u32 m0, s38, 40960
    s_add_u32 s32, s37, 327680
    buffer_load_dwordx4 v224, s[12:15], s32 offen lds
    buffer_load_dwordx4 v225, s[12:15], s32 offen offset:1024 lds
    s_add_u32 m0, s38, 49152
    s_add_u32 s32, s37, 393216
    buffer_load_dwordx4 v224, s[12:15], s32 offen lds
    buffer_load_dwordx4 v225, s[12:15], s32 offen offset:1024 lds
    s_add_u32 m0, s38, 57344
    s_add_u32 s32, s37, 458752
    buffer_load_dwordx4 v224, s[12:15], s32 offen lds
    buffer_load_dwordx4 v225, s[12:15], s32 offen offset:1024 lds
    s_add_u32 m0, s38, 65536
    s_add_u32 s32, s37, 524288
    buffer_load_dwordx4 v224, s[12:15], s32 offen lds
    buffer_load_dwordx4 v225, s[12:15], s32 offen offset:1024 lds
    s_add_u32 m0, s38, 73728
    s_add_u32 s32, s37, 589824
    buffer_load_dwordx4 v224, s[12:15], s32 offen lds
    buffer_load_dwordx4 v225, s[12:15], s32 offen offset:1024 lds
    s_add_u32 m0, s38, 81920
    s_add_u32 s32, s37, 655360
    buffer_load_dwordx4 v224, s[12:15], s32 offen lds
    buffer_load_dwordx4 v225, s[12:15], s32 offen offset:1024 lds
    s_add_u32 m0, s38, 90112
    s_add_u32 s32, s37, 720896
    buffer_load_dwordx4 v224, s[12:15], s32 offen lds
    buffer_load_dwordx4 v225, s[12:15], s32 offen offset:1024 lds
    s_add_u32 m0, s38, 98304
    s_add_u32 s32, s37, 786432
    buffer_load_dwordx4 v224, s[12:15], s32 offen lds
    buffer_load_dwordx4 v225, s[12:15], s32 offen offset:1024 lds
    s_add_u32 m0, s38, 106496
    s_add_u32 s32, s37, 851968
    buffer_load_dwordx4 v224, s[12:15], s32 offen lds
    buffer_load_dwordx4 v225, s[12:15], s32 offen offset:1024 lds
    s_add_u32 m0, s38, 114688
    s_add_u32 s32, s37, 917504
    buffer_load_dwordx4 v224, s[12:15], s32 offen lds
    buffer_load_dwordx4 v225, s[12:15], s32 offen offset:1024 lds
    s_add_u32 m0, s38, 122880
    s_add_u32 s32, s37, 983040
    buffer_load_dwordx4 v224, s[12:15], s32 offen lds
    buffer_load_dwordx4 v225, s[12:15], s32 offen offset:1024 lds
    s_add_u32 s33, s51, 0
    buffer_load_dwordx4 a[192:195], v244, s[24:27], s33 offen offset:0
    s_add_u32 s33, s51, 16384
    buffer_load_dwordx4 a[196:199], v244, s[24:27], s33 offen offset:0
    s_add_u32 s33, s51, 0
    buffer_load_dwordx4 a[200:203], v244, s[24:27], s33 offen offset:128
    s_add_u32 s33, s51, 16384
    buffer_load_dwordx4 a[204:207], v244, s[24:27], s33 offen offset:128
    s_add_u32 s33, s51, 0
    buffer_load_dwordx4 a[208:211], v244, s[24:27], s33 offen offset:256
    s_add_u32 s33, s51, 16384
    buffer_load_dwordx4 a[212:215], v244, s[24:27], s33 offen offset:256
    s_add_u32 s33, s51, 0
    buffer_load_dwordx4 a[216:219], v244, s[24:27], s33 offen offset:384
    s_add_u32 s33, s51, 16384
    buffer_load_dwordx4 a[220:223], v244, s[24:27], s33 offen offset:384
    s_cmp_lg_u32 s3, 0
    s_cbranch_scc1 kc_b03
    s_and_b32 s32, s2, 1
    s_lshl_b32 s32, s32, 2
    s_and_b32 s33, s53, 3
    s_add_u32 s32, s32, s33
    s_lshl_b32 s32, s32, 9
    s_and_b32 s33, s2, 6
    s_lshl_b32 s33, s33, 6
    s_add_u32 s32, s32, s33
    s_add_u32 s32, s32, 0x38a4000
    s_mov_b32 s34, 0x400000
    s_branch kc_b01
kc_b00:
    s_sleep 2
kc_b01:
    buffer_load_dword v235, off, s[8:11], s32 sc1
    s_waitcnt vmcnt(0)
    v_cmp_ne_u32 vcc, 8, v235
    s_sub_u32 s34, s34, 1
    s_cbranch_scc1 kc_b02
    s_cbranch_vccnz kc_b00
kc_b02:
kc_b03:
    s_waitcnt vmcnt(8)
    s_barrier
    buffer_load_dwordx4 a[0:3], v226, s[8:11], s35 offen offset:0 sc1
    buffer_load_dwordx4 a[4:7], v227, s[8:11], s35 offen offset:0 sc1
    buffer_load_dwordx4 a[8:11], v245, s[8:11], s35 offen offset:0 sc1
    buffer_load_dwordx4 a[12:15], v246, s[8:11], s35 offen offset:0 sc1
    buffer_load_dwordx4 a[16:19], v226, s[8:11], s35 offen offset:1024 sc1
    buffer_load_dwordx4 a[20:23], v227, s[8:11], s35 offen offset:1024 sc1
    buffer_load_dwordx4 a[24:27], v245, s[8:11], s35 offen offset:1024 sc1
    buffer_load_dwordx4 a[28:31], v246, s[8:11], s35 offen offset:1024 sc1
    buffer_load_dwordx4 a[32:35], v226, s[8:11], s35 offen offset:2048 sc1
    buffer_load_dwordx4 a[36:39], v227, s[8:11], s35 offen offset:2048 sc1
    buffer_load_dwordx4 a[40:43], v245, s[8:11], s35 offen offset:2048 sc1
    buffer_load_dwordx4 a[44:47], v246, s[8:11], s35 offen offset:2048 sc1
    buffer_load_dwordx4 a[48:51], v226, s[8:11], s35 offen offset:3072 sc1
    buffer_load_dwordx4 a[52:55], v227, s[8:11], s35 offen offset:3072 sc1
    buffer_load_dwordx4 a[56:59], v245, s[8:11], s35 offen offset:3072 sc1
    buffer_load_dwordx4 a[60:63], v246, s[8:11], s35 offen offset:3072 sc1
    ds_read_b64_tr_b16 v[128:129], v216 offset:0
    ds_read_b64_tr_b16 v[130:131], v216 offset:2048
    ds_read_b64_tr_b16 v[132:133], v217 offset:0
    ds_read_b64_tr_b16 v[134:135], v217 offset:2048
    ds_read_b64_tr_b16 v[136:137], v218 offset:0
    ds_read_b64_tr_b16 v[138:139], v218 offset:2048
    ds_read_b64_tr_b16 v[140:141], v219 offset:0
    ds_read_b64_tr_b16 v[142:143], v219 offset:2048
    s_waitcnt vmcnt(12) lgkmcnt(0)
    v_mfma_f32_16x16x32_bf16 v[32:35], v[128:131], a[0:3], 0
    ds_read_b64_tr_b16 v[144:145], v220 offset:0
    v_mfma_f32_16x16x32_bf16 v[36:39], v[128:131], a[4:7], 0
    ds_read_b64_tr_b16 v[146:147], v220 offset:2048
    v_mfma_f32_16x16x32_bf16 v[64:67], v[128:131], a[8:11], 0
    ds_read_b64_tr_b16 v[148:149], v221 offset:0
    v_mfma_f32_16x16x32_bf16 v[68:71], v[128:131], a[12:15], 0
    ds_read_b64_tr_b16 v[150:151], v221 offset:2048
    v_mfma_f32_16x16x32_bf16 v[40:43], v[132:135], a[0:3], 0
    ds_read_b64_tr_b16 v[152:153], v222 offset:0
    v_mfma_f32_16x16x32_bf16 v[44:47], v[132:135], a[4:7], 0
    ds_read_b64_tr_b16 v[154:155], v222 offset:2048
    v_mfma_f32_16x16x32_bf16 v[72:75], v[132:135], a[8:11], 0
    ds_read_b64_tr_b16 v[156:157], v223 offset:0
    v_mfma_f32_16x16x32_bf16 v[76:79], v[132:135], a[12:15], 0
    ds_read_b64_tr_b16 v[158:159], v223 offset:2048
    v_mfma_f32_16x16x32_bf16 v[48:51], v[136:139], a[0:3], 0
    s_add_u32 s35, s35, 4096
    buffer_load_dwordx4 a[64:67], v226, s[8:11], s35 offen offset:0 sc1
    v_mfma_f32_16x16x32_bf16 v[52:55], v[136:139], a[4:7], 0
    v_mfma_f32_16x16x32_bf16 v[80:83], v[136:139], a[8:11], 0
    v_mfma_f32_16x16x32_bf16 v[84:87], v[136:139], a[12:15], 0
    buffer_load_dwordx4 a[68:71], v227, s[8:11], s35 offen offset:0 sc1
    v_mfma_f32_16x16x32_bf16 v[56:59], v[140:143], a[0:3], 0
    v_mfma_f32_16x16x32_bf16 v[60:63], v[140:143], a[4:7], 0
    v_mfma_f32_16x16x32_bf16 v[88:91], v[140:143], a[8:11], 0
    v_mfma_f32_16x16x32_bf16 v[92:95], v[140:143], a[12:15], 0
    s_waitcnt lgkmcnt(0)
    v_mfma_f32_16x16x32_bf16 v[0:3], v[144:147], a[0:3], 0
    ds_read_b64_tr_b16 v[128:129], v216 offset:8192
    v_mfma_f32_16x16x32_bf16 v[4:7], v[144:147], a[4:7], 0
    ds_read_b64_tr_b16 v[130:131], v216 offset:10240
    v_mfma_f32_16x16x32_bf16 v[96:99], v[144:147], a[8:11], 0
    ds_read_b64_tr_b16 v[132:133], v217 offset:8192
    v_mfma_f32_16x16x32_bf16 v[100:103], v[144:147], a[12:15], 0
    ds_read_b64_tr_b16 v[134:135], v217 offset:10240
    v_mfma_f32_16x16x32_bf16 v[8:11], v[148:151], a[0:3], 0
    ds_read_b64_tr_b16 v[136:137], v218 offset:8192
    v_mfma_f32_16x16x32_bf16 v[12:15], v[148:151], a[4:7], 0
    ds_read_b64_tr_b16 v[138:139], v218 offset:10240
    v_mfma_f32_16x16x32_bf16 v[104:107], v[148:151], a[8:11], 0
    ds_read_b64_tr_b16 v[140:141], v219 offset:8192
    v_mfma_f32_16x16x32_bf16 v[108:111], v[148:151], a[12:15], 0
    ds_read_b64_tr_b16 v[142:143], v219 offset:10240
    v_mfma_f32_16x16x32_bf16 v[16:19], v[152:155], a[0:3], 0
    buffer_load_dwordx4 a[72:75], v245, s[8:11], s35 offen offset:0 sc1
    v_mfma_f32_16x16x32_bf16 v[20:23], v[152:155], a[4:7], 0
    v_mfma_f32_16x16x32_bf16 v[112:115], v[152:155], a[8:11], 0
    v_mfma_f32_16x16x32_bf16 v[116:119], v[152:155], a[12:15], 0
    v_mfma_f32_16x16x32_bf16 v[24:27], v[156:159], a[0:3], 0
    buffer_load_dwordx4 a[76:79], v246, s[8:11], s35 offen offset:0 sc1
    v_mfma_f32_16x16x32_bf16 v[28:31], v[156:159], a[4:7], 0
    v_mfma_f32_16x16x32_bf16 v[120:123], v[156:159], a[8:11], 0
    v_mfma_f32_16x16x32_bf16 v[124:127], v[156:159], a[12:15], 0
    buffer_load_dwordx4 a[80:83], v226, s[8:11], s35 offen offset:1024 sc1
    s_waitcnt vmcnt(13) lgkmcnt(0)
    v_mfma_f32_16x16x32_bf16 v[32:35], v[128:131], a[16:19], v[32:35]
    ds_read_b64_tr_b16 v[144:145], v220 offset:8192
    v_mfma_f32_16x16x32_bf16 v[36:39], v[128:131], a[20:23], v[36:39]
    ds_read_b64_tr_b16 v[146:147], v220 offset:10240
    v_mfma_f32_16x16x32_bf16 v[64:67], v[128:131], a[24:27], v[64:67]
    ds_read_b64_tr_b16 v[148:149], v221 offset:8192
    v_mfma_f32_16x16x32_bf16 v[68:71], v[128:131], a[28:31], v[68:71]
    ds_read_b64_tr_b16 v[150:151], v221 offset:10240
    v_mfma_f32_16x16x32_bf16 v[40:43], v[132:135], a[16:19], v[40:43]
    ds_read_b64_tr_b16 v[152:153], v222 offset:8192
    v_mfma_f32_16x16x32_bf16 v[44:47], v[132:135], a[20:23], v[44:47]
    ds_read_b64_tr_b16 v[154:155], v222 offset:10240
    v_mfma_f32_16x16x32_bf16 v[72:75], v[132:135], a[24:27], v[72:75]
    ds_read_b64_tr_b16 v[156:157], v223 offset:8192
    v_mfma_f32_16x16x32_bf16 v[76:79], v[132:135], a[28:31], v[76:79]
    ds_read_b64_tr_b16 v[158:159], v223 offset:10240
    v_mfma_f32_16x16x32_bf16 v[48:51], v[136:139], a[16:19], v[48:51]
    buffer_load_dwordx4 a[84:87], v227, s[8:11], s35 offen offset:1024 sc1
    v_mfma_f32_16x16x32_bf16 v[52:55], v[136:139], a[20:23], v[52:55]
    v_mfma_f32_16x16x32_bf16 v[80:83], v[136:139], a[24:27], v[80:83]
    v_mfma_f32_16x16x32_bf16 v[84:87], v[136:139], a[28:31], v[84:87]
    buffer_load_dwordx4 a[88:91], v245, s[8:11], s35 offen offset:1024 sc1
    v_mfma_f32_16x16x32_bf16 v[56:59], v[140:143], a[16:19], v[56:59]
    v_mfma_f32_16x16x32_bf16 v[60:63], v[140:143], a[20:23], v[60:63]
    v_mfma_f32_16x16x32_bf16 v[88:91], v[140:143], a[24:27], v[88:91]
    v_mfma_f32_16x16x32_bf16 v[92:95], v[140:143], a[28:31], v[92:95]
    s_waitcnt lgkmcnt(0)
    v_mfma_f32_16x16x32_bf16 v[0:3], v[144:147], a[16:19], v[0:3]
    ds_read_b64_tr_b16 v[128:129], v216 offset:16384
    v_mfma_f32_16x16x32_bf16 v[4:7], v[144:147], a[20:23], v[4:7]
    ds_read_b64_tr_b16 v[130:131], v216 offset:18432
    v_mfma_f32_16x16x32_bf16 v[96:99], v[144:147], a[24:27], v[96:99]
    ds_read_b64_tr_b16 v[132:133], v217 offset:16384
    v_mfma_f32_16x16x32_bf16 v[100:103], v[144:147], a[28:31], v[100:103]
    ds_read_b64_tr_b16 v[134:135], v217 offset:18432
    v_mfma_f32_16x16x32_bf16 v[8:11], v[148:151], a[16:19], v[8:11]
    ds_read_b64_tr_b16 v[136:137], v218 offset:16384
    v_mfma_f32_16x16x32_bf16 v[12:15], v[148:151], a[20:23], v[12:15]
    ds_read_b64_tr_b16 v[138:139], v218 offset:18432
    v_mfma_f32_16x16x32_bf16 v[104:107], v[148:151], a[24:27], v[104:107]
    ds_read_b64_tr_b16 v[140:141], v219 offset:16384
    v_mfma_f32_16x16x32_bf16 v[108:111], v[148:151], a[28:31], v[108:111]
    ds_read_b64_tr_b16 v[142:143], v219 offset:18432
    v_mfma_f32_16x16x32_bf16 v[16:19], v[152:155], a[16:19], v[16:19]
    buffer_load_dwordx4 a[92:95], v246, s[8:11], s35 offen offset:1024 sc1
    v_mfma_f32_16x16x32_bf16 v[20:23], v[152:155], a[20:23], v[20:23]
    v_mfma_f32_16x16x32_bf16 v[112:115], v[152:155], a[24:27], v[112:115]
    v_mfma_f32_16x16x32_bf16 v[116:119], v[152:155], a[28:31], v[116:119]
    v_mfma_f32_16x16x32_bf16 v[24:27], v[156:159], a[16:19], v[24:27]
    buffer_load_dwordx4 a[96:99], v226, s[8:11], s35 offen offset:2048 sc1
    v_mfma_f32_16x16x32_bf16 v[28:31], v[156:159], a[20:23], v[28:31]
    v_mfma_f32_16x16x32_bf16 v[120:123], v[156:159], a[24:27], v[120:123]
    v_mfma_f32_16x16x32_bf16 v[124:127], v[156:159], a[28:31], v[124:127]
    s_waitcnt vmcnt(13) lgkmcnt(0)
    v_mfma_f32_16x16x32_bf16 v[32:35], v[128:131], a[32:35], v[32:35]
    ds_read_b64_tr_b16 v[144:145], v220 offset:16384
    v_mfma_f32_16x16x32_bf16 v[36:39], v[128:131], a[36:39], v[36:39]
    ds_read_b64_tr_b16 v[146:147], v220 offset:18432
    v_mfma_f32_16x16x32_bf16 v[64:67], v[128:131], a[40:43], v[64:67]
    ds_read_b64_tr_b16 v[148:149], v221 offset:16384
    v_mfma_f32_16x16x32_bf16 v[68:71], v[128:131], a[44:47], v[68:71]
    ds_read_b64_tr_b16 v[150:151], v221 offset:18432
    v_mfma_f32_16x16x32_bf16 v[40:43], v[132:135], a[32:35], v[40:43]
    ds_read_b64_tr_b16 v[152:153], v222 offset:16384
    v_mfma_f32_16x16x32_bf16 v[44:47], v[132:135], a[36:39], v[44:47]
    ds_read_b64_tr_b16 v[154:155], v222 offset:18432
    v_mfma_f32_16x16x32_bf16 v[72:75], v[132:135], a[40:43], v[72:75]
    ds_read_b64_tr_b16 v[156:157], v223 offset:16384
    v_mfma_f32_16x16x32_bf16 v[76:79], v[132:135], a[44:47], v[76:79]
    ds_read_b64_tr_b16 v[158:159], v223 offset:18432
    v_mfma_f32_16x16x32_bf16 v[48:51], v[136:139], a[32:35], v[48:51]
    buffer_load_dwordx4 a[100:103], v227, s[8:11], s35 offen offset:2048 sc1
    v_mfma_f32_16x16x32_bf16 v[52:55], v[136:139], a[36:39], v[52:55]
    v_mfma_f32_16x16x32_bf16 v[80:83], v[136:139], a[40:43], v[80:83]
    v_mfma_f32_16x16x32_bf16 v[84:87], v[136:139], a[44:47], v[84:87]
    buffer_load_dwordx4 a[104:107], v245, s[8:11], s35 offen offset:2048 sc1
    v_mfma_f32_16x16x32_bf16 v[56:59], v[140:143], a[32:35], v[56:59]
    v_mfma_f32_16x16x32_bf16 v[60:63], v[140:143], a[36:39], v[60:63]
    v_mfma_f32_16x16x32_bf16 v[88:91], v[140:143], a[40:43], v[88:91]
    v_mfma_f32_16x16x32_bf16 v[92:95], v[140:143], a[44:47], v[92:95]
    s_waitcnt lgkmcnt(0)
    v_mfma_f32_16x16x32_bf16 v[0:3], v[144:147], a[32:35], v[0:3]
    ds_read_b64_tr_b16 v[128:129], v216 offset:24576
    v_mfma_f32_16x16x32_bf16 v[4:7], v[144:147], a[36:39], v[4:7]
    ds_read_b64_tr_b16 v[130:131], v216 offset:26624
    v_mfma_f32_16x16x32_bf16 v[96:99], v[144:147], a[40:43], v[96:99]
    ds_read_b64_tr_b16 v[132:133], v217 offset:24576
    v_mfma_f32_16x16x32_bf16 v[100:103], v[144:147], a[44:47], v[100:103]
    ds_read_b64_tr_b16 v[134:135], v217 offset:26624
    v_mfma_f32_16x16x32_bf16 v[8:11], v[148:151], a[32:35], v[8:11]
    ds_read_b64_tr_b16 v[136:137], v218 offset:24576
    v_mfma_f32_16x16x32_bf16 v[12:15], v[148:151], a[36:39], v[12:15]
    ds_read_b64_tr_b16 v[138:139], v218 offset:26624
    v_mfma_f32_16x16x32_bf16 v[104:107], v[148:151], a[40:43], v[104:107]
    ds_read_b64_tr_b16 v[140:141], v219 offset:24576
    v_mfma_f32_16x16x32_bf16 v[108:111], v[148:151], a[44:47], v[108:111]
    ds_read_b64_tr_b16 v[142:143], v219 offset:26624
    v_mfma_f32_16x16x32_bf16 v[16:19], v[152:155], a[32:35], v[16:19]
    buffer_load_dwordx4 a[108:111], v246, s[8:11], s35 offen offset:2048 sc1
    v_mfma_f32_16x16x32_bf16 v[20:23], v[152:155], a[36:39], v[20:23]
    v_mfma_f32_16x16x32_bf16 v[112:115], v[152:155], a[40:43], v[112:115]
    v_mfma_f32_16x16x32_bf16 v[116:119], v[152:155], a[44:47], v[116:119]
    v_mfma_f32_16x16x32_bf16 v[24:27], v[156:159], a[32:35], v[24:27]
    buffer_load_dwordx4 a[112:115], v226, s[8:11], s35 offen offset:3072 sc1
    v_mfma_f32_16x16x32_bf16 v[28:31], v[156:159], a[36:39], v[28:31]
    v_mfma_f32_16x16x32_bf16 v[120:123], v[156:159], a[40:43], v[120:123]
    v_mfma_f32_16x16x32_bf16 v[124:127], v[156:159], a[44:47], v[124:127]
    buffer_load_dwordx4 a[116:119], v227, s[8:11], s35 offen offset:3072 sc1
    s_waitcnt vmcnt(14) lgkmcnt(0)
    v_mfma_f32_16x16x32_bf16 v[32:35], v[128:131], a[48:51], v[32:35]
    ds_read_b64_tr_b16 v[144:145], v220 offset:24576
    v_mfma_f32_16x16x32_bf16 v[36:39], v[128:131], a[52:55], v[36:39]
    ds_read_b64_tr_b16 v[146:147], v220 offset:26624
    v_mfma_f32_16x16x32_bf16 v[64:67], v[128:131], a[56:59], v[64:67]
    ds_read_b64_tr_b16 v[148:149], v221 offset:24576
    v_mfma_f32_16x16x32_bf16 v[68:71], v[128:131], a[60:63], v[68:71]
    ds_read_b64_tr_b16 v[150:151], v221 offset:26624
    v_mfma_f32_16x16x32_bf16 v[40:43], v[132:135], a[48:51], v[40:43]
    ds_read_b64_tr_b16 v[152:153], v222 offset:24576
    v_mfma_f32_16x16x32_bf16 v[44:47], v[132:135], a[52:55], v[44:47]
    ds_read_b64_tr_b16 v[154:155], v222 offset:26624
    v_mfma_f32_16x16x32_bf16 v[72:75], v[132:135], a[56:59], v[72:75]
    ds_read_b64_tr_b16 v[156:157], v223 offset:24576
    v_mfma_f32_16x16x32_bf16 v[76:79], v[132:135], a[60:63], v[76:79]
    ds_read_b64_tr_b16 v[158:159], v223 offset:26624
    v_mfma_f32_16x16x32_bf16 v[48:51], v[136:139], a[48:51], v[48:51]
    buffer_load_dwordx4 a[120:123], v245, s[8:11], s35 offen offset:3072 sc1
    v_mfma_f32_16x16x32_bf16 v[52:55], v[136:139], a[52:55], v[52:55]
    v_mfma_f32_16x16x32_bf16 v[80:83], v[136:139], a[56:59], v[80:83]
    v_mfma_f32_16x16x32_bf16 v[84:87], v[136:139], a[60:63], v[84:87]
    buffer_load_dwordx4 a[124:127], v246, s[8:11], s35 offen offset:3072 sc1
    v_mfma_f32_16x16x32_bf16 v[56:59], v[140:143], a[48:51], v[56:59]
    v_mfma_f32_16x16x32_bf16 v[60:63], v[140:143], a[52:55], v[60:63]
    v_mfma_f32_16x16x32_bf16 v[88:91], v[140:143], a[56:59], v[88:91]
    v_mfma_f32_16x16x32_bf16 v[92:95], v[140:143], a[60:63], v[92:95]
    s_waitcnt lgkmcnt(0)
    s_barrier
    v_mfma_f32_16x16x32_bf16 v[0:3], v[144:147], a[48:51], v[0:3]
    ds_read_b64_tr_b16 v[128:129], v216 offset:32768
    v_mfma_f32_16x16x32_bf16 v[4:7], v[144:147], a[52:55], v[4:7]
    ds_read_b64_tr_b16 v[130:131], v216 offset:34816
    v_mfma_f32_16x16x32_bf16 v[96:99], v[144:147], a[56:59], v[96:99]
    ds_read_b64_tr_b16 v[132:133], v217 offset:32768
    v_mfma_f32_16x16x32_bf16 v[100:103], v[144:147], a[60:63], v[100:103]
    ds_read_b64_tr_b16 v[134:135], v217 offset:34816
    v_mfma_f32_16x16x32_bf16 v[8:11], v[148:151], a[48:51], v[8:11]
    ds_read_b64_tr_b16 v[136:137], v218 offset:32768
    v_mfma_f32_16x16x32_bf16 v[12:15], v[148:151], a[52:55], v[12:15]
    ds_read_b64_tr_b16 v[138:139], v218 offset:34816
    v_mfma_f32_16x16x32_bf16 v[104:107], v[148:151], a[56:59], v[104:107]
    ds_read_b64_tr_b16 v[140:141], v219 offset:32768
    v_mfma_f32_16x16x32_bf16 v[108:111], v[148:151], a[60:63], v[108:111]
    ds_read_b64_tr_b16 v[142:143], v219 offset:34816
    v_mfma_f32_16x16x32_bf16 v[16:19], v[152:155], a[48:51], v[16:19]
    s_add_u32 s35, s35, 4096
    buffer_load_dwordx4 a[0:3], v226, s[8:11], s35 offen offset:0 sc1
    v_mfma_f32_16x16x32_bf16 v[20:23], v[152:155], a[52:55], v[20:23]
    v_mfma_f32_16x16x32_bf16 v[112:115], v[152:155], a[56:59], v[112:115]
    v_mfma_f32_16x16x32_bf16 v[116:119], v[152:155], a[60:63], v[116:119]
    v_mfma_f32_16x16x32_bf16 v[24:27], v[156:159], a[48:51], v[24:27]
    buffer_load_dwordx4 a[4:7], v227, s[8:11], s35 offen offset:0 sc1
    v_mfma_f32_16x16x32_bf16 v[28:31], v[156:159], a[52:55], v[28:31]
    v_mfma_f32_16x16x32_bf16 v[120:123], v[156:159], a[56:59], v[120:123]
    v_mfma_f32_16x16x32_bf16 v[124:127], v[156:159], a[60:63], v[124:127]
    s_waitcnt vmcnt(14) lgkmcnt(0)
    v_mfma_f32_16x16x32_bf16 v[32:35], v[128:131], a[64:67], v[32:35]
    ds_read_b64_tr_b16 v[144:145], v220 offset:32768
    v_mfma_f32_16x16x32_bf16 v[36:39], v[128:131], a[68:71], v[36:39]
    ds_read_b64_tr_b16 v[146:147], v220 offset:34816
    v_mfma_f32_16x16x32_bf16 v[64:67], v[128:131], a[72:75], v[64:67]
    ds_read_b64_tr_b16 v[148:149], v221 offset:32768
    v_mfma_f32_16x16x32_bf16 v[68:71], v[128:131], a[76:79], v[68:71]
    ds_read_b64_tr_b16 v[150:151], v221 offset:34816
    v_mfma_f32_16x16x32_bf16 v[40:43], v[132:135], a[64:67], v[40:43]
    ds_read_b64_tr_b16 v[152:153], v222 offset:32768
    v_mfma_f32_16x16x32_bf16 v[44:47], v[132:135], a[68:71], v[44:47]
    ds_read_b64_tr_b16 v[154:155], v222 offset:34816
    v_mfma_f32_16x16x32_bf16 v[72:75], v[132:135], a[72:75], v[72:75]
    ds_read_b64_tr_b16 v[156:157], v223 offset:32768
    v_mfma_f32_16x16x32_bf16 v[76:79], v[132:135], a[76:79], v[76:79]
    ds_read_b64_tr_b16 v[158:159], v223 offset:34816
    v_mfma_f32_16x16x32_bf16 v[48:51], v[136:139], a[64:67], v[48:51]
    buffer_load_dwordx4 a[8:11], v245, s[8:11], s35 offen offset:0 sc1
    v_mfma_f32_16x16x32_bf16 v[52:55], v[136:139], a[68:71], v[52:55]
    s_add_u32 m0, s38, 0
    s_add_u32 s32, s37, 1048576
    v_mfma_f32_16x16x32_bf16 v[80:83], v[136:139], a[72:75], v[80:83]
    buffer_load_dwordx4 v224, s[12:15], s32 offen lds
    v_mfma_f32_16x16x32_bf16 v[84:87], v[136:139], a[76:79], v[84:87]
    buffer_load_dwordx4 a[12:15], v246, s[8:11], s35 offen offset:0 sc1
    v_mfma_f32_16x16x32_bf16 v[56:59], v[140:143], a[64:67], v[56:59]
    v_mfma_f32_16x16x32_bf16 v[60:63], v[140:143], a[68:71], v[60:63]
    buffer_load_dwordx4 v225, s[12:15], s32 offen offset:1024 lds
    v_mfma_f32_16x16x32_bf16 v[88:91], v[140:143], a[72:75], v[88:91]
    v_mfma_f32_16x16x32_bf16 v[92:95], v[140:143], a[76:79], v[92:95]
    s_waitcnt lgkmcnt(0)
    v_mfma_f32_16x16x32_bf16 v[0:3], v[144:147], a[64:67], v[0:3]
    ds_read_b64_tr_b16 v[128:129], v216 offset:40960
    v_mfma_f32_16x16x32_bf16 v[4:7], v[144:147], a[68:71], v[4:7]
    ds_read_b64_tr_b16 v[130:131], v216 offset:43008
    v_mfma_f32_16x16x32_bf16 v[96:99], v[144:147], a[72:75], v[96:99]
    ds_read_b64_tr_b16 v[132:133], v217 offset:40960
    v_mfma_f32_16x16x32_bf16 v[100:103], v[144:147], a[76:79], v[100:103]
    ds_read_b64_tr_b16 v[134:135], v217 offset:43008
    v_mfma_f32_16x16x32_bf16 v[8:11], v[148:151], a[64:67], v[8:11]
    ds_read_b64_tr_b16 v[136:137], v218 offset:40960
    v_mfma_f32_16x16x32_bf16 v[12:15], v[148:151], a[68:71], v[12:15]
    ds_read_b64_tr_b16 v[138:139], v218 offset:43008
    v_mfma_f32_16x16x32_bf16 v[104:107], v[148:151], a[72:75], v[104:107]
    ds_read_b64_tr_b16 v[140:141], v219 offset:40960
    v_mfma_f32_16x16x32_bf16 v[108:111], v[148:151], a[76:79], v[108:111]
    ds_read_b64_tr_b16 v[142:143], v219 offset:43008
    v_mfma_f32_16x16x32_bf16 v[16:19], v[152:155], a[64:67], v[16:19]
    buffer_load_dwordx4 a[16:19], v226, s[8:11], s35 offen offset:1024 sc1
    v_mfma_f32_16x16x32_bf16 v[20:23], v[152:155], a[68:71], v[20:23]
    v_mfma_f32_16x16x32_bf16 v[112:115], v[152:155], a[72:75], v[112:115]
    v_mfma_f32_16x16x32_bf16 v[116:119], v[152:155], a[76:79], v[116:119]
    v_mfma_f32_16x16x32_bf16 v[24:27], v[156:159], a[64:67], v[24:27]
    buffer_load_dwordx4 a[20:23], v227, s[8:11], s35 offen offset:1024 sc1
    v_mfma_f32_16x16x32_bf16 v[28:31], v[156:159], a[68:71], v[28:31]
    v_mfma_f32_16x16x32_bf16 v[120:123], v[156:159], a[72:75], v[120:123]
    v_mfma_f32_16x16x32_bf16 v[124:127], v[156:159], a[76:79], v[124:127]
    buffer_load_dwordx4 a[24:27], v245, s[8:11], s35 offen offset:1024 sc1
    s_waitcnt vmcnt(17) lgkmcnt(0)
    v_mfma_f32_16x16x32_bf16 v[32:35], v[128:131], a[80:83], v[32:35]
    ds_read_b64_tr_b16 v[144:145], v220 offset:40960
    v_mfma_f32_16x16x32_bf16 v[36:39], v[128:131], a[84:87], v[36:39]
    ds_read_b64_tr_b16 v[146:147], v220 offset:43008
    v_mfma_f32_16x16x32_bf16 v[64:67], v[128:131], a[88:91], v[64:67]
    ds_read_b64_tr_b16 v[148:149], v221 offset:40960
    v_mfma_f32_16x16x32_bf16 v[68:71], v[128:131], a[92:95], v[68:71]
    ds_read_b64_tr_b16 v[150:151], v221 offset:43008
    v_mfma_f32_16x16x32_bf16 v[40:43], v[132:135], a[80:83], v[40:43]
    ds_read_b64_tr_b16 v[152:153], v222 offset:40960
    v_mfma_f32_16x16x32_bf16 v[44:47], v[132:135], a[84:87], v[44:47]
    ds_read_b64_tr_b16 v[154:155], v222 offset:43008
    v_mfma_f32_16x16x32_bf16 v[72:75], v[132:135], a[88:91], v[72:75]
    ds_read_b64_tr_b16 v[156:157], v223 offset:40960
    v_mfma_f32_16x16x32_bf16 v[76:79], v[132:135], a[92:95], v[76:79]
    ds_read_b64_tr_b16 v[158:159], v223 offset:43008
    v_mfma_f32_16x16x32_bf16 v[48:51], v[136:139], a[80:83], v[48:51]
    buffer_load_dwordx4 a[28:31], v246, s[8:11], s35 offen offset:1024 sc1
    v_mfma_f32_16x16x32_bf16 v[52:55], v[136:139], a[84:87], v[52:55]
    s_add_u32 m0, s38, 8192
    s_add_u32 s32, s37, 1114112
    v_mfma_f32_16x16x32_bf16 v[80:83], v[136:139], a[88:91], v[80:83]
    buffer_load_dwordx4 v224, s[12:15], s32 offen lds
    v_mfma_f32_16x16x32_bf16 v[84:87], v[136:139], a[92:95], v[84:87]
    buffer_load_dwordx4 a[32:35], v226, s[8:11], s35 offen offset:2048 sc1
    v_mfma_f32_16x16x32_bf16 v[56:59], v[140:143], a[80:83], v[56:59]
    v_mfma_f32_16x16x32_bf16 v[60:63], v[140:143], a[84:87], v[60:63]
    buffer_load_dwordx4 v225, s[12:15], s32 offen offset:1024 lds
    v_mfma_f32_16x16x32_bf16 v[88:91], v[140:143], a[88:91], v[88:91]
    v_mfma_f32_16x16x32_bf16 v[92:95], v[140:143], a[92:95], v[92:95]
    s_waitcnt lgkmcnt(0)
    v_mfma_f32_16x16x32_bf16 v[0:3], v[144:147], a[80:83], v[0:3]
    ds_read_b64_tr_b16 v[128:129], v216 offset:49152
    v_mfma_f32_16x16x32_bf16 v[4:7], v[144:147], a[84:87], v[4:7]
    ds_read_b64_tr_b16 v[130:131], v216 offset:51200
    v_mfma_f32_16x16x32_bf16 v[96:99], v[144:147], a[88:91], v[96:99]
    ds_read_b64_tr_b16 v[132:133], v217 offset:49152
    v_mfma_f32_16x16x32_bf16 v[100:103], v[144:147], a[92:95], v[100:103]
    ds_read_b64_tr_b16 v[134:135], v217 offset:51200
    v_mfma_f32_16x16x32_bf16 v[8:11], v[148:151], a[80:83], v[8:11]
    ds_read_b64_tr_b16 v[136:137], v218 offset:49152
    v_mfma_f32_16x16x32_bf16 v[12:15], v[148:151], a[84:87], v[12:15]
    ds_read_b64_tr_b16 v[138:139], v218 offset:51200
    v_mfma_f32_16x16x32_bf16 v[104:107], v[148:151], a[88:91], v[104:107]
    ds_read_b64_tr_b16 v[140:141], v219 offset:49152
    v_mfma_f32_16x16x32_bf16 v[108:111], v[148:151], a[92:95], v[108:111]
    ds_read_b64_tr_b16 v[142:143], v219 offset:51200
    v_mfma_f32_16x16x32_bf16 v[16:19], v[152:155], a[80:83], v[16:19]
    buffer_load_dwordx4 a[36:39], v227, s[8:11], s35 offen offset:2048 sc1
    v_mfma_f32_16x16x32_bf16 v[20:23], v[152:155], a[84:87], v[20:23]
    v_mfma_f32_16x16x32_bf16 v[112:115], v[152:155], a[88:91], v[112:115]
    v_mfma_f32_16x16x32_bf16 v[116:119], v[152:155], a[92:95], v[116:119]
    v_mfma_f32_16x16x32_bf16 v[24:27], v[156:159], a[80:83], v[24:27]
    buffer_load_dwordx4 a[40:43], v245, s[8:11], s35 offen offset:2048 sc1
    v_mfma_f32_16x16x32_bf16 v[28:31], v[156:159], a[84:87], v[28:31]
    v_mfma_f32_16x16x32_bf16 v[120:123], v[156:159], a[88:91], v[120:123]
    v_mfma_f32_16x16x32_bf16 v[124:127], v[156:159], a[92:95], v[124:127]
    s_waitcnt vmcnt(19) lgkmcnt(0)
    v_mfma_f32_16x16x32_bf16 v[32:35], v[128:131], a[96:99], v[32:35]
    ds_read_b64_tr_b16 v[144:145], v220 offset:49152
    v_mfma_f32_16x16x32_bf16 v[36:39], v[128:131], a[100:103], v[36:39]
    ds_read_b64_tr_b16 v[146:147], v220 offset:51200
    v_mfma_f32_16x16x32_bf16 v[64:67], v[128:131], a[104:107], v[64:67]
    ds_read_b64_tr_b16 v[148:149], v221 offset:49152
    v_mfma_f32_16x16x32_bf16 v[68:71], v[128:131], a[108:111], v[68:71]
    ds_read_b64_tr_b16 v[150:151], v221 offset:51200
    v_mfma_f32_16x16x32_bf16 v[40:43], v[132:135], a[96:99], v[40:43]
    ds_read_b64_tr_b16 v[152:153], v222 offset:49152
    v_mfma_f32_16x16x32_bf16 v[44:47], v[132:135], a[100:103], v[44:47]
    ds_read_b64_tr_b16 v[154:155], v222 offset:51200
    v_mfma_f32_16x16x32_bf16 v[72:75], v[132:135], a[104:107], v[72:75]
    ds_read_b64_tr_b16 v[156:157], v223 offset:49152
    v_mfma_f32_16x16x32_bf16 v[76:79], v[132:135], a[108:111], v[76:79]
    ds_read_b64_tr_b16 v[158:159], v223 offset:51200
    v_mfma_f32_16x16x32_bf16 v[48:51], v[136:139], a[96:99], v[48:51]
    buffer_load_dwordx4 a[44:47], v246, s[8:11], s35 offen offset:2048 sc1
    v_mfma_f32_16x16x32_bf16 v[52:55], v[136:139], a[100:103], v[52:55]
    s_add_u32 m0, s38, 16384
    s_add_u32 s32, s37, 1179648
    v_mfma_f32_16x16x32_bf16 v[80:83], v[136:139], a[104:107], v[80:83]
    buffer_load_dwordx4 v224, s[12:15], s32 offen lds
    v_mfma_f32_16x16x32_bf16 v[84:87], v[136:139], a[108:111], v[84:87]
    buffer_load_dwordx4 a[48:51], v226, s[8:11], s35 offen offset:3072 sc1
    v_mfma_f32_16x16x32_bf16 v[56:59], v[140:143], a[96:99], v[56:59]
    v_mfma_f32_16x16x32_bf16 v[60:63], v[140:143], a[100:103], v[60:63]
    buffer_load_dwordx4 v225, s[12:15], s32 offen offset:1024 lds
    v_mfma_f32_16x16x32_bf16 v[88:91], v[140:143], a[104:107], v[88:91]
    v_mfma_f32_16x16x32_bf16 v[92:95], v[140:143], a[108:111], v[92:95]
    s_waitcnt lgkmcnt(0)
    v_mfma_f32_16x16x32_bf16 v[0:3], v[144:147], a[96:99], v[0:3]
    ds_read_b64_tr_b16 v[128:129], v216 offset:57344
    v_mfma_f32_16x16x32_bf16 v[4:7], v[144:147], a[100:103], v[4:7]
    ds_read_b64_tr_b16 v[130:131], v216 offset:59392
    v_mfma_f32_16x16x32_bf16 v[96:99], v[144:147], a[104:107], v[96:99]
    ds_read_b64_tr_b16 v[132:133], v217 offset:57344
    v_mfma_f32_16x16x32_bf16 v[100:103], v[144:147], a[108:111], v[100:103]
    ds_read_b64_tr_b16 v[134:135], v217 offset:59392
    v_mfma_f32_16x16x32_bf16 v[8:11], v[148:151], a[96:99], v[8:11]
    ds_read_b64_tr_b16 v[136:137], v218 offset:57344
    v_mfma_f32_16x16x32_bf16 v[12:15], v[148:151], a[100:103], v[12:15]
    ds_read_b64_tr_b16 v[138:139], v218 offset:59392
    v_mfma_f32_16x16x32_bf16 v[104:107], v[148:151], a[104:107], v[104:107]
    ds_read_b64_tr_b16 v[140:141], v219 offset:57344
    v_mfma_f32_16x16x32_bf16 v[108:111], v[148:151], a[108:111], v[108:111]
    ds_read_b64_tr_b16 v[142:143], v219 offset:59392
    v_mfma_f32_16x16x32_bf16 v[16:19], v[152:155], a[96:99], v[16:19]
    buffer_load_dwordx4 a[52:55], v227, s[8:11], s35 offen offset:3072 sc1
    v_mfma_f32_16x16x32_bf16 v[20:23], v[152:155], a[100:103], v[20:23]
    v_mfma_f32_16x16x32_bf16 v[112:115], v[152:155], a[104:107], v[112:115]
    v_mfma_f32_16x16x32_bf16 v[116:119], v[152:155], a[108:111], v[116:119]
    v_mfma_f32_16x16x32_bf16 v[24:27], v[156:159], a[96:99], v[24:27]
    buffer_load_dwordx4 a[56:59], v245, s[8:11], s35 offen offset:3072 sc1
    v_mfma_f32_16x16x32_bf16 v[28:31], v[156:159], a[100:103], v[28:31]
    v_mfma_f32_16x16x32_bf16 v[120:123], v[156:159], a[104:107], v[120:123]
    v_mfma_f32_16x16x32_bf16 v[124:127], v[156:159], a[108:111], v[124:127]
    buffer_load_dwordx4 a[60:63], v246, s[8:11], s35 offen offset:3072 sc1
    s_waitcnt vmcnt(22) lgkmcnt(0)
    v_mfma_f32_16x16x32_bf16 v[32:35], v[128:131], a[112:115], v[32:35]
    ds_read_b64_tr_b16 v[144:145], v220 offset:57344
    v_mfma_f32_16x16x32_bf16 v[36:39], v[128:131], a[116:119], v[36:39]
    ds_read_b64_tr_b16 v[146:147], v220 offset:59392
    v_mfma_f32_16x16x32_bf16 v[64:67], v[128:131], a[120:123], v[64:67]
    ds_read_b64_tr_b16 v[148:149], v221 offset:57344
    v_mfma_f32_16x16x32_bf16 v[68:71], v[128:131], a[124:127], v[68:71]
    ds_read_b64_tr_b16 v[150:151], v221 offset:59392
    v_mfma_f32_16x16x32_bf16 v[40:43], v[132:135], a[112:115], v[40:43]
    ds_read_b64_tr_b16 v[152:153], v222 offset:57344
    v_mfma_f32_16x16x32_bf16 v[44:47], v[132:135], a[116:119], v[44:47]
    ds_read_b64_tr_b16 v[154:155], v222 offset:59392
    v_mfma_f32_16x16x32_bf16 v[72:75], v[132:135], a[120:123], v[72:75]
    ds_read_b64_tr_b16 v[156:157], v223 offset:57344
    v_mfma_f32_16x16x32_bf16 v[76:79], v[132:135], a[124:127], v[76:79]
    ds_read_b64_tr_b16 v[158:159], v223 offset:59392
    v_mfma_f32_16x16x32_bf16 v[48:51], v[136:139], a[112:115], v[48:51]
    s_add_u32 s35, s35, 4096
    buffer_load_dwordx4 a[64:67], v226, s[8:11], s35 offen offset:0 sc1
    v_mfma_f32_16x16x32_bf16 v[52:55], v[136:139], a[116:119], v[52:55]
    s_add_u32 m0, s38, 24576
    s_add_u32 s32, s37, 1245184
    v_mfma_f32_16x16x32_bf16 v[80:83], v[136:139], a[120:123], v[80:83]
    buffer_load_dwordx4 v224, s[12:15], s32 offen lds
    v_mfma_f32_16x16x32_bf16 v[84:87], v[136:139], a[124:127], v[84:87]
    buffer_load_dwordx4 a[68:71], v227, s[8:11], s35 offen offset:0 sc1
    v_mfma_f32_16x16x32_bf16 v[56:59], v[140:143], a[112:115], v[56:59]
    v_mfma_f32_16x16x32_bf16 v[60:63], v[140:143], a[116:119], v[60:63]
    buffer_load_dwordx4 v225, s[12:15], s32 offen offset:1024 lds
    v_mfma_f32_16x16x32_bf16 v[88:91], v[140:143], a[120:123], v[88:91]
    v_mfma_f32_16x16x32_bf16 v[92:95], v[140:143], a[124:127], v[92:95]
    s_waitcnt lgkmcnt(0)
    s_barrier
    v_mfma_f32_16x16x32_bf16 v[0:3], v[144:147], a[112:115], v[0:3]
    v_xor_b32 v216, 0x10000, v216
    ds_read_b64_tr_b16 v[128:129], v216 offset:0
    v_mfma_f32_16x16x32_bf16 v[4:7], v[144:147], a[116:119], v[4:7]
    ds_read_b64_tr_b16 v[130:131], v216 offset:2048
    v_mfma_f32_16x16x32_bf16 v[96:99], v[144:147], a[120:123], v[96:99]
    v_xor_b32 v217, 0x10000, v217
    ds_read_b64_tr_b16 v[132:133], v217 offset:0
    v_mfma_f32_16x16x32_bf16 v[100:103], v[144:147], a[124:127], v[100:103]
    ds_read_b64_tr_b16 v[134:135], v217 offset:2048
    v_mfma_f32_16x16x32_bf16 v[8:11], v[148:151], a[112:115], v[8:11]
    v_xor_b32 v218, 0x10000, v218
    ds_read_b64_tr_b16 v[136:137], v218 offset:0
    v_mfma_f32_16x16x32_bf16 v[12:15], v[148:151], a[116:119], v[12:15]
    ds_read_b64_tr_b16 v[138:139], v218 offset:2048
    v_mfma_f32_16x16x32_bf16 v[104:107], v[148:151], a[120:123], v[104:107]
    v_xor_b32 v219, 0x10000, v219
    ds_read_b64_tr_b16 v[140:141], v219 offset:0
    v_mfma_f32_16x16x32_bf16 v[108:111], v[148:151], a[124:127], v[108:111]
    ds_read_b64_tr_b16 v[142:143], v219 offset:2048
    v_mfma_f32_16x16x32_bf16 v[16:19], v[152:155], a[112:115], v[16:19]
    buffer_load_dwordx4 a[72:75], v245, s[8:11], s35 offen offset:0 sc1
    v_mfma_f32_16x16x32_bf16 v[20:23], v[152:155], a[116:119], v[20:23]
    v_mfma_f32_16x16x32_bf16 v[112:115], v[152:155], a[120:123], v[112:115]
    v_mfma_f32_16x16x32_bf16 v[116:119], v[152:155], a[124:127], v[116:119]
    v_mfma_f32_16x16x32_bf16 v[24:27], v[156:159], a[112:115], v[24:27]
    buffer_load_dwordx4 a[76:79], v246, s[8:11], s35 offen offset:0 sc1
    v_mfma_f32_16x16x32_bf16 v[28:31], v[156:159], a[116:119], v[28:31]
    v_mfma_f32_16x16x32_bf16 v[120:123], v[156:159], a[120:123], v[120:123]
    v_mfma_f32_16x16x32_bf16 v[124:127], v[156:159], a[124:127], v[124:127]
    s_waitcnt vmcnt(23) lgkmcnt(0)
    v_mfma_f32_16x16x32_bf16 v[32:35], v[128:131], a[0:3], v[32:35]
    v_xor_b32 v220, 0x10000, v220
    ds_read_b64_tr_b16 v[144:145], v220 offset:0
    v_mfma_f32_16x16x32_bf16 v[36:39], v[128:131], a[4:7], v[36:39]
    ds_read_b64_tr_b16 v[146:147], v220 offset:2048
    v_mfma_f32_16x16x32_bf16 v[64:67], v[128:131], a[8:11], v[64:67]
    v_xor_b32 v221, 0x10000, v221
    ds_read_b64_tr_b16 v[148:149], v221 offset:0
    v_mfma_f32_16x16x32_bf16 v[68:71], v[128:131], a[12:15], v[68:71]
    ds_read_b64_tr_b16 v[150:151], v221 offset:2048
    v_mfma_f32_16x16x32_bf16 v[40:43], v[132:135], a[0:3], v[40:43]
    v_xor_b32 v222, 0x10000, v222
    ds_read_b64_tr_b16 v[152:153], v222 offset:0
    v_mfma_f32_16x16x32_bf16 v[44:47], v[132:135], a[4:7], v[44:47]
    ds_read_b64_tr_b16 v[154:155], v222 offset:2048
    v_mfma_f32_16x16x32_bf16 v[72:75], v[132:135], a[8:11], v[72:75]
    v_xor_b32 v223, 0x10000, v223
    ds_read_b64_tr_b16 v[156:157], v223 offset:0
    v_mfma_f32_16x16x32_bf16 v[76:79], v[132:135], a[12:15], v[76:79]
    ds_read_b64_tr_b16 v[158:159], v223 offset:2048
    v_mfma_f32_16x16x32_bf16 v[48:51], v[136:139], a[0:3], v[48:51]
    buffer_load_dwordx4 a[80:83], v226, s[8:11], s35 offen offset:1024 sc1
    v_mfma_f32_16x16x32_bf16 v[52:55], v[136:139], a[4:7], v[52:55]
    s_add_u32 m0, s38, 32768
    s_add_u32 s32, s37, 1310720
    v_mfma_f32_16x16x32_bf16 v[80:83], v[136:139], a[8:11], v[80:83]
    buffer_load_dwordx4 v224, s[12:15], s32 offen lds
    v_mfma_f32_16x16x32_bf16 v[84:87], v[136:139], a[12:15], v[84:87]
    buffer_load_dwordx4 a[84:87], v227, s[8:11], s35 offen offset:1024 sc1
    v_mfma_f32_16x16x32_bf16 v[56:59], v[140:143], a[0:3], v[56:59]
    v_mfma_f32_16x16x32_bf16 v[60:63], v[140:143], a[4:7], v[60:63]
    buffer_load_dwordx4 v225, s[12:15], s32 offen offset:1024 lds
    v_mfma_f32_16x16x32_bf16 v[88:91], v[140:143], a[8:11], v[88:91]
    s_lshl_b32 s45, s52, 7
    s_add_u32 s45, s45, 0x38a1400
    v_mfma_f32_16x16x32_bf16 v[92:95], v[140:143], a[12:15], v[92:95]
    s_waitcnt lgkmcnt(0)
    v_mfma_f32_16x16x32_bf16 v[0:3], v[144:147], a[0:3], v[0:3]
    ds_read_b64_tr_b16 v[128:129], v216 offset:8192
    v_mfma_f32_16x16x32_bf16 v[4:7], v[144:147], a[4:7], v[4:7]
    ds_read_b64_tr_b16 v[130:131], v216 offset:10240
    v_mfma_f32_16x16x32_bf16 v[96:99], v[144:147], a[8:11], v[96:99]
    ds_read_b64_tr_b16 v[132:133], v217 offset:8192
    v_mfma_f32_16x16x32_bf16 v[100:103], v[144:147], a[12:15], v[100:103]
    ds_read_b64_tr_b16 v[134:135], v217 offset:10240
    v_mfma_f32_16x16x32_bf16 v[8:11], v[148:151], a[0:3], v[8:11]
    ds_read_b64_tr_b16 v[136:137], v218 offset:8192
    v_mfma_f32_16x16x32_bf16 v[12:15], v[148:151], a[4:7], v[12:15]
    ds_read_b64_tr_b16 v[138:139], v218 offset:10240
    v_mfma_f32_16x16x32_bf16 v[104:107], v[148:151], a[8:11], v[104:107]
    ds_read_b64_tr_b16 v[140:141], v219 offset:8192
    v_mfma_f32_16x16x32_bf16 v[108:111], v[148:151], a[12:15], v[108:111]
    ds_read_b64_tr_b16 v[142:143], v219 offset:10240
    v_mfma_f32_16x16x32_bf16 v[16:19], v[152:155], a[0:3], v[16:19]
    buffer_load_dwordx4 a[88:91], v245, s[8:11], s35 offen offset:1024 sc1
    v_mfma_f32_16x16x32_bf16 v[20:23], v[152:155], a[4:7], v[20:23]
    s_cmp_eq_u32 s3, 0
    s_cselect_b32 s45, s45, 0x40000000
    v_mfma_f32_16x16x32_bf16 v[112:115], v[152:155], a[8:11], v[112:115]
    buffer_load_dword v235, off, s[8:11], s45 sc1
    v_mfma_f32_16x16x32_bf16 v[116:119], v[152:155], a[12:15], v[116:119]
    v_mfma_f32_16x16x32_bf16 v[24:27], v[156:159], a[0:3], v[24:27]
    buffer_load_dwordx4 a[92:95], v246, s[8:11], s35 offen offset:1024 sc1
    v_mfma_f32_16x16x32_bf16 v[28:31], v[156:159], a[4:7], v[28:31]
    v_mfma_f32_16x16x32_bf16 v[120:123], v[156:159], a[8:11], v[120:123]
    v_mfma_f32_16x16x32_bf16 v[124:127], v[156:159], a[12:15], v[124:127]
    buffer_load_dwordx4 a[96:99], v226, s[8:11], s35 offen offset:2048 sc1
    s_waitcnt vmcnt(26) lgkmcnt(0)
    v_mfma_f32_16x16x32_bf16 v[32:35], v[128:131], a[16:19], v[32:35]
    ds_read_b64_tr_b16 v[144:145], v220 offset:8192
    v_mfma_f32_16x16x32_bf16 v[36:39], v[128:131], a[20:23], v[36:39]
    ds_read_b64_tr_b16 v[146:147], v220 offset:10240
    v_mfma_f32_16x16x32_bf16 v[64:67], v[128:131], a[24:27], v[64:67]
    ds_read_b64_tr_b16 v[148:149], v221 offset:8192
    v_mfma_f32_16x16x32_bf16 v[68:71], v[128:131], a[28:31], v[68:71]
    ds_read_b64_tr_b16 v[150:151], v221 offset:10240
    v_mfma_f32_16x16x32_bf16 v[40:43], v[132:135], a[16:19], v[40:43]
    ds_read_b64_tr_b16 v[152:153], v222 offset:8192
    v_mfma_f32_16x16x32_bf16 v[44:47], v[132:135], a[20:23], v[44:47]
    ds_read_b64_tr_b16 v[154:155], v222 offset:10240
    v_mfma_f32_16x16x32_bf16 v[72:75], v[132:135], a[24:27], v[72:75]
    ds_read_b64_tr_b16 v[156:157], v223 offset:8192
    v_mfma_f32_16x16x32_bf16 v[76:79], v[132:135], a[28:31], v[76:79]
    ds_read_b64_tr_b16 v[158:159], v223 offset:10240
    v_mfma_f32_16x16x32_bf16 v[48:51], v[136:139], a[16:19], v[48:51]
    buffer_load_dwordx4 a[100:103], v227, s[8:11], s35 offen offset:2048 sc1
    v_mfma_f32_16x16x32_bf16 v[52:55], v[136:139], a[20:23], v[52:55]
    s_add_u32 m0, s38, 40960
    s_add_u32 s32, s37, 1376256
    v_mfma_f32_16x16x32_bf16 v[80:83], v[136:139], a[24:27], v[80:83]
    buffer_load_dwordx4 v224, s[12:15], s32 offen lds
    v_mfma_f32_16x16x32_bf16 v[84:87], v[136:139], a[28:31], v[84:87]
    buffer_load_dwordx4 a[104:107], v245, s[8:11], s35 offen offset:2048 sc1
    v_mfma_f32_16x16x32_bf16 v[56:59], v[140:143], a[16:19], v[56:59]
    v_mfma_f32_16x16x32_bf16 v[60:63], v[140:143], a[20:23], v[60:63]
    buffer_load_dwordx4 v225, s[12:15], s32 offen offset:1024 lds
    v_mfma_f32_16x16x32_bf16 v[88:91], v[140:143], a[24:27], v[88:91]
    v_mfma_f32_16x16x32_bf16 v[92:95], v[140:143], a[28:31], v[92:95]
    s_waitcnt lgkmcnt(0)
    v_mfma_f32_16x16x32_bf16 v[0:3], v[144:147], a[16:19], v[0:3]
    ds_read_b64_tr_b16 v[128:129], v216 offset:16384
    v_mfma_f32_16x16x32_bf16 v[4:7], v[144:147], a[20:23], v[4:7]
    ds_read_b64_tr_b16 v[130:131], v216 offset:18432
    v_mfma_f32_16x16x32_bf16 v[96:99], v[144:147], a[24:27], v[96:99]
    ds_read_b64_tr_b16 v[132:133], v217 offset:16384
    v_mfma_f32_16x16x32_bf16 v[100:103], v[144:147], a[28:31], v[100:103]
    ds_read_b64_tr_b16 v[134:135], v217 offset:18432
    v_mfma_f32_16x16x32_bf16 v[8:11], v[148:151], a[16:19], v[8:11]
    ds_read_b64_tr_b16 v[136:137], v218 offset:16384
    v_mfma_f32_16x16x32_bf16 v[12:15], v[148:151], a[20:23], v[12:15]
    ds_read_b64_tr_b16 v[138:139], v218 offset:18432
    v_mfma_f32_16x16x32_bf16 v[104:107], v[148:151], a[24:27], v[104:107]
    ds_read_b64_tr_b16 v[140:141], v219 offset:16384
    v_mfma_f32_16x16x32_bf16 v[108:111], v[148:151], a[28:31], v[108:111]
    ds_read_b64_tr_b16 v[142:143], v219 offset:18432
    v_mfma_f32_16x16x32_bf16 v[16:19], v[152:155], a[16:19], v[16:19]
    buffer_load_dwordx4 a[108:111], v246, s[8:11], s35 offen offset:2048 sc1
    v_mfma_f32_16x16x32_bf16 v[20:23], v[152:155], a[20:23], v[20:23]
    v_mfma_f32_16x16x32_bf16 v[112:115], v[152:155], a[24:27], v[112:115]
    v_mfma_f32_16x16x32_bf16 v[116:119], v[152:155], a[28:31], v[116:119]
    v_mfma_f32_16x16x32_bf16 v[24:27], v[156:159], a[16:19], v[24:27]
    buffer_load_dwordx4 a[112:115], v226, s[8:11], s35 offen offset:3072 sc1
    v_mfma_f32_16x16x32_bf16 v[28:31], v[156:159], a[20:23], v[28:31]
    v_mfma_f32_16x16x32_bf16 v[120:123], v[156:159], a[24:27], v[120:123]
    v_mfma_f32_16x16x32_bf16 v[124:127], v[156:159], a[28:31], v[124:127]
    s_waitcnt vmcnt(26) lgkmcnt(0)
    v_mfma_f32_16x16x32_bf16 v[32:35], v[128:131], a[32:35], v[32:35]
    ds_read_b64_tr_b16 v[144:145], v220 offset:16384
    v_mfma_f32_16x16x32_bf16 v[36:39], v[128:131], a[36:39], v[36:39]
    ds_read_b64_tr_b16 v[146:147], v220 offset:18432
    v_mfma_f32_16x16x32_bf16 v[64:67], v[128:131], a[40:43], v[64:67]
    ds_read_b64_tr_b16 v[148:149], v221 offset:16384
    v_mfma_f32_16x16x32_bf16 v[68:71], v[128:131], a[44:47], v[68:71]
    ds_read_b64_tr_b16 v[150:151], v221 offset:18432
    v_mfma_f32_16x16x32_bf16 v[40:43], v[132:135], a[32:35], v[40:43]
    ds_read_b64_tr_b16 v[152:153], v222 offset:16384
    v_mfma_f32_16x16x32_bf16 v[44:47], v[132:135], a[36:39], v[44:47]
    ds_read_b64_tr_b16 v[154:155], v222 offset:18432
    v_mfma_f32_16x16x32_bf16 v[72:75], v[132:135], a[40:43], v[72:75]
    ds_read_b64_tr_b16 v[156:157], v223 offset:16384
    v_mfma_f32_16x16x32_bf16 v[76:79], v[132:135], a[44:47], v[76:79]
    ds_read_b64_tr_b16 v[158:159], v223 offset:18432
    v_mfma_f32_16x16x32_bf16 v[48:51], v[136:139], a[32:35], v[48:51]
    buffer_load_dwordx4 a[116:119], v227, s[8:11], s35 offen offset:3072 sc1
    v_mfma_f32_16x16x32_bf16 v[52:55], v[136:139], a[36:39], v[52:55]
    s_add_u32 m0, s38, 49152
    s_add_u32 s32, s37, 1441792
    v_mfma_f32_16x16x32_bf16 v[80:83], v[136:139], a[40:43], v[80:83]
    buffer_load_dwordx4 v224, s[12:15], s32 offen lds
    v_mfma_f32_16x16x32_bf16 v[84:87], v[136:139], a[44:47], v[84:87]
    buffer_load_dwordx4 a[120:123], v245, s[8:11], s35 offen offset:3072 sc1
    v_mfma_f32_16x16x32_bf16 v[56:59], v[140:143], a[32:35], v[56:59]
    v_mfma_f32_16x16x32_bf16 v[60:63], v[140:143], a[36:39], v[60:63]
    buffer_load_dwordx4 v225, s[12:15], s32 offen offset:1024 lds
    v_mfma_f32_16x16x32_bf16 v[88:91], v[140:143], a[40:43], v[88:91]
    v_mfma_f32_16x16x32_bf16 v[92:95], v[140:143], a[44:47], v[92:95]
    s_waitcnt lgkmcnt(0)
    v_mfma_f32_16x16x32_bf16 v[0:3], v[144:147], a[32:35], v[0:3]
    ds_read_b64_tr_b16 v[128:129], v216 offset:24576
    v_mfma_f32_16x16x32_bf16 v[4:7], v[144:147], a[36:39], v[4:7]
    ds_read_b64_tr_b16 v[130:131], v216 offset:26624
    v_mfma_f32_16x16x32_bf16 v[96:99], v[144:147], a[40:43], v[96:99]
    ds_read_b64_tr_b16 v[132:133], v217 offset:24576
    v_mfma_f32_16x16x32_bf16 v[100:103], v[144:147], a[44:47], v[100:103]
    ds_read_b64_tr_b16 v[134:135], v217 offset:26624
    v_mfma_f32_16x16x32_bf16 v[8:11], v[148:151], a[32:35], v[8:11]
    ds_read_b64_tr_b16 v[136:137], v218 offset:24576
    v_mfma_f32_16x16x32_bf16 v[12:15], v[148:151], a[36:39], v[12:15]
    ds_read_b64_tr_b16 v[138:139], v218 offset:26624
    v_mfma_f32_16x16x32_bf16 v[104:107], v[148:151], a[40:43], v[104:107]
    ds_read_b64_tr_b16 v[140:141], v219 offset:24576
    v_mfma_f32_16x16x32_bf16 v[108:111], v[148:151], a[44:47], v[108:111]
    ds_read_b64_tr_b16 v[142:143], v219 offset:26624
    v_mfma_f32_16x16x32_bf16 v[16:19], v[152:155], a[32:35], v[16:19]
    buffer_load_dwordx4 a[124:127], v246, s[8:11], s35 offen offset:3072 sc1
    v_mfma_f32_16x16x32_bf16 v[20:23], v[152:155], a[36:39], v[20:23]
    v_mfma_f32_16x16x32_bf16 v[112:115], v[152:155], a[40:43], v[112:115]
    v_mfma_f32_16x16x32_bf16 v[116:119], v[152:155], a[44:47], v[116:119]
    v_mfma_f32_16x16x32_bf16 v[24:27], v[156:159], a[32:35], v[24:27]
    s_add_u32 s35, s35, 4096
    buffer_load_dwordx4 a[0:3], v226, s[8:11], s35 offen offset:0 sc1
    v_mfma_f32_16x16x32_bf16 v[28:31], v[156:159], a[36:39], v[28:31]
    v_mfma_f32_16x16x32_bf16 v[120:123], v[156:159], a[40:43], v[120:123]
    v_mfma_f32_16x16x32_bf16 v[124:127], v[156:159], a[44:47], v[124:127]
    buffer_load_dwordx4 a[4:7], v227, s[8:11], s35 offen offset:0 sc1
    s_waitcnt vmcnt(27) lgkmcnt(0)
    v_mfma_f32_16x16x32_bf16 v[32:35], v[128:131], a[48:51], v[32:35]
    ds_read_b64_tr_b16 v[144:145], v220 offset:24576
    v_mfma_f32_16x16x32_bf16 v[36:39], v[128:131], a[52:55], v[36:39]
    ds_read_b64_tr_b16 v[146:147], v220 offset:26624
    v_mfma_f32_16x16x32_bf16 v[64:67], v[128:131], a[56:59], v[64:67]
    ds_read_b64_tr_b16 v[148:149], v221 offset:24576
    v_mfma_f32_16x16x32_bf16 v[68:71], v[128:131], a[60:63], v[68:71]
    ds_read_b64_tr_b16 v[150:151], v221 offset:26624
    v_mfma_f32_16x16x32_bf16 v[40:43], v[132:135], a[48:51], v[40:43]
    ds_read_b64_tr_b16 v[152:153], v222 offset:24576
    v_mfma_f32_16x16x32_bf16 v[44:47], v[132:135], a[52:55], v[44:47]
    ds_read_b64_tr_b16 v[154:155], v222 offset:26624
    v_mfma_f32_16x16x32_bf16 v[72:75], v[132:135], a[56:59], v[72:75]
    ds_read_b64_tr_b16 v[156:157], v223 offset:24576
    v_mfma_f32_16x16x32_bf16 v[76:79], v[132:135], a[60:63], v[76:79]
    ds_read_b64_tr_b16 v[158:159], v223 offset:26624
    v_mfma_f32_16x16x32_bf16 v[48:51], v[136:139], a[48:51], v[48:51]
    buffer_load_dwordx4 a[8:11], v245, s[8:11], s35 offen offset:0 sc1
    v_mfma_f32_16x16x32_bf16 v[52:55], v[136:139], a[52:55], v[52:55]
    s_add_u32 m0, s38, 57344
    s_add_u32 s32, s37, 1507328
    v_mfma_f32_16x16x32_bf16 v[80:83], v[136:139], a[56:59], v[80:83]
    buffer_load_dwordx4 v224, s[12:15], s32 offen lds
    v_mfma_f32_16x16x32_bf16 v[84:87], v[136:139], a[60:63], v[84:87]
    buffer_load_dwordx4 a[12:15], v246, s[8:11], s35 offen offset:0 sc1
    v_mfma_f32_16x16x32_bf16 v[56:59], v[140:143], a[48:51], v[56:59]
    v_mfma_f32_16x16x32_bf16 v[60:63], v[140:143], a[52:55], v[60:63]
    buffer_load_dwordx4 v225, s[12:15], s32 offen offset:1024 lds
    v_mfma_f32_16x16x32_bf16 v[88:91], v[140:143], a[56:59], v[88:91]
    s_waitcnt vmcnt(19)
    v_readfirstlane_b32 s36, v235
    s_lshl_b32 s34, s3, 8
    s_add_u32 s36, s36, s34
    s_cmp_ge_u32 s36, 8
    s_cbranch_scc0 kc_g
kc_gr:
    v_mfma_f32_16x16x32_bf16 v[92:95], v[140:143], a[60:63], v[92:95]
    s_waitcnt lgkmcnt(0)
    s_barrier
    v_mfma_f32_16x16x32_bf16 v[0:3], v[144:147], a[48:51], v[0:3]
    ds_read_b64_tr_b16 v[128:129], v216 offset:32768
    v_mfma_f32_16x16x32_bf16 v[4:7], v[144:147], a[52:55], v[4:7]
    ds_read_b64_tr_b16 v[130:131], v216 offset:34816
    v_mfma_f32_16x16x32_bf16 v[96:99], v[144:147], a[56:59], v[96:99]
    ds_read_b64_tr_b16 v[132:133], v217 offset:32768
    v_mfma_f32_16x16x32_bf16 v[100:103], v[144:147], a[60:63], v[100:103]
    ds_read_b64_tr_b16 v[134:135], v217 offset:34816
    v_mfma_f32_16x16x32_bf16 v[8:11], v[148:151], a[48:51], v[8:11]
    ds_read_b64_tr_b16 v[136:137], v218 offset:32768
    v_mfma_f32_16x16x32_bf16 v[12:15], v[148:151], a[52:55], v[12:15]
    ds_read_b64_tr_b16 v[138:139], v218 offset:34816
    v_mfma_f32_16x16x32_bf16 v[104:107], v[148:151], a[56:59], v[104:107]
    ds_read_b64_tr_b16 v[140:141], v219 offset:32768
    v_mfma_f32_16x16x32_bf16 v[108:111], v[148:151], a[60:63], v[108:111]
    ds_read_b64_tr_b16 v[142:143], v219 offset:34816
    v_mfma_f32_16x16x32_bf16 v[16:19], v[152:155], a[48:51], v[16:19]
    buffer_load_dwordx4 a[16:19], v226, s[8:11], s35 offen offset:1024 sc1
    v_mfma_f32_16x16x32_bf16 v[20:23], v[152:155], a[52:55], v[20:23]
    v_mfma_f32_16x16x32_bf16 v[112:115], v[152:155], a[56:59], v[112:115]
    v_mfma_f32_16x16x32_bf16 v[116:119], v[152:155], a[60:63], v[116:119]
    v_mfma_f32_16x16x32_bf16 v[24:27], v[156:159], a[48:51], v[24:27]
    buffer_load_dwordx4 a[20:23], v227, s[8:11], s35 offen offset:1024 sc1
    v_mfma_f32_16x16x32_bf16 v[28:31], v[156:159], a[52:55], v[28:31]
    v_mfma_f32_16x16x32_bf16 v[120:123], v[156:159], a[56:59], v[120:123]
    v_mfma_f32_16x16x32_bf16 v[124:127], v[156:159], a[60:63], v[124:127]
    s_waitcnt vmcnt(27) lgkmcnt(0)
    v_mfma_f32_16x16x32_bf16 v[32:35], v[128:131], a[64:67], v[32:35]
    ds_read_b64_tr_b16 v[144:145], v220 offset:32768
    v_mfma_f32_16x16x32_bf16 v[36:39], v[128:131], a[68:71], v[36:39]
    ds_read_b64_tr_b16 v[146:147], v220 offset:34816
    v_mfma_f32_16x16x32_bf16 v[64:67], v[128:131], a[72:75], v[64:67]
    ds_read_b64_tr_b16 v[148:149], v221 offset:32768
    v_mfma_f32_16x16x32_bf16 v[68:71], v[128:131], a[76:79], v[68:71]
    ds_read_b64_tr_b16 v[150:151], v221 offset:34816
    v_mfma_f32_16x16x32_bf16 v[40:43], v[132:135], a[64:67], v[40:43]
    ds_read_b64_tr_b16 v[152:153], v222 offset:32768
    v_mfma_f32_16x16x32_bf16 v[44:47], v[132:135], a[68:71], v[44:47]
    ds_read_b64_tr_b16 v[154:155], v222 offset:34816
    v_mfma_f32_16x16x32_bf16 v[72:75], v[132:135], a[72:75], v[72:75]
    ds_read_b64_tr_b16 v[156:157], v223 offset:32768
    v_mfma_f32_16x16x32_bf16 v[76:79], v[132:135], a[76:79], v[76:79]
    ds_read_b64_tr_b16 v[158:159], v223 offset:34816
    v_mfma_f32_16x16x32_bf16 v[48:51], v[136:139], a[64:67], v[48:51]
    buffer_load_dwordx4 a[24:27], v245, s[8:11], s35 offen offset:1024 sc1
    v_mfma_f32_16x16x32_bf16 v[52:55], v[136:139], a[68:71], v[52:55]
    s_add_u32 m0, s38, 65536
    s_add_u32 s32, s37, 1572864
    v_mfma_f32_16x16x32_bf16 v[80:83], v[136:139], a[72:75], v[80:83]
    buffer_load_dwordx4 v224, s[12:15], s32 offen lds
    v_mfma_f32_16x16x32_bf16 v[84:87], v[136:139], a[76:79], v[84:87]
    buffer_load_dwordx4 a[28:31], v246, s[8:11], s35 offen offset:1024 sc1
    v_mfma_f32_16x16x32_bf16 v[56:59], v[140:143], a[64:67], v[56:59]
    v_mfma_f32_16x16x32_bf16 v[60:63], v[140:143], a[68:71], v[60:63]
    buffer_load_dwordx4 v225, s[12:15], s32 offen offset:1024 lds
    v_mfma_f32_16x16x32_bf16 v[88:91], v[140:143], a[72:75], v[88:91]
    s_add_u32 s33, s55, 0
    buffer_load_dwordx4 a[128:131], v228, s[8:11], s33 offen offset:0 sc1
    v_mfma_f32_16x16x32_bf16 v[92:95], v[140:143], a[76:79], v[92:95]
    s_waitcnt lgkmcnt(0)
    v_mfma_f32_16x16x32_bf16 v[0:3], v[144:147], a[64:67], v[0:3]
    ds_read_b64_tr_b16 v[128:129], v216 offset:40960
    v_mfma_f32_16x16x32_bf16 v[4:7], v[144:147], a[68:71], v[4:7]
    ds_read_b64_tr_b16 v[130:131], v216 offset:43008
    v_mfma_f32_16x16x32_bf16 v[96:99], v[144:147], a[72:75], v[96:99]
    ds_read_b64_tr_b16 v[132:133], v217 offset:40960
    v_mfma_f32_16x16x32_bf16 v[100:103], v[144:147], a[76:79], v[100:103]
    ds_read_b64_tr_b16 v[134:135], v217 offset:43008
    v_mfma_f32_16x16x32_bf16 v[8:11], v[148:151], a[64:67], v[8:11]
    ds_read_b64_tr_b16 v[136:137], v218 offset:40960
    v_mfma_f32_16x16x32_bf16 v[12:15], v[148:151], a[68:71], v[12:15]
    ds_read_b64_tr_b16 v[138:139], v218 offset:43008
    v_mfma_f32_16x16x32_bf16 v[104:107], v[148:151], a[72:75], v[104:107]
    ds_read_b64_tr_b16 v[140:141], v219 offset:40960
    v_mfma_f32_16x16x32_bf16 v[108:111], v[148:151], a[76:79], v[108:111]
    ds_read_b64_tr_b16 v[142:143], v219 offset:43008
    v_mfma_f32_16x16x32_bf16 v[16:19], v[152:155], a[64:67], v[16:19]
    buffer_load_dwordx4 a[32:35], v226, s[8:11], s35 offen offset:2048 sc1
    v_mfma_f32_16x16x32_bf16 v[20:23], v[152:155], a[68:71], v[20:23]
    v_mfma_f32_16x16x32_bf16 v[112:115], v[152:155], a[72:75], v[112:115]
    v_mfma_f32_16x16x32_bf16 v[116:119], v[152:155], a[76:79], v[116:119]
    v_mfma_f32_16x16x32_bf16 v[24:27], v[156:159], a[64:67], v[24:27]
    buffer_load_dwordx4 a[36:39], v227, s[8:11], s35 offen offset:2048 sc1
    v_mfma_f32_16x16x32_bf16 v[28:31], v[156:159], a[68:71], v[28:31]
    v_mfma_f32_16x16x32_bf16 v[120:123], v[156:159], a[72:75], v[120:123]
    buffer_load_dwordx4 a[132:135], v228, s[8:11], s33 offen offset:1024 sc1
    v_mfma_f32_16x16x32_bf16 v[124:127], v[156:159], a[76:79], v[124:127]
    buffer_load_dwordx4 a[40:43], v245, s[8:11], s35 offen offset:2048 sc1
    s_waitcnt vmcnt(29) lgkmcnt(0)
    v_mfma_f32_16x16x32_bf16 v[32:35], v[128:131], a[80:83], v[32:35]
    ds_read_b64_tr_b16 v[144:145], v220 offset:40960
    v_mfma_f32_16x16x32_bf16 v[36:39], v[128:131], a[84:87], v[36:39]
    ds_read_b64_tr_b16 v[146:147], v220 offset:43008
    v_mfma_f32_16x16x32_bf16 v[64:67], v[128:131], a[88:91], v[64:67]
    ds_read_b64_tr_b16 v[148:149], v221 offset:40960
    v_mfma_f32_16x16x32_bf16 v[68:71], v[128:131], a[92:95], v[68:71]
    ds_read_b64_tr_b16 v[150:151], v221 offset:43008
    v_mfma_f32_16x16x32_bf16 v[40:43], v[132:135], a[80:83], v[40:43]
    ds_read_b64_tr_b16 v[152:153], v222 offset:40960
    v_mfma_f32_16x16x32_bf16 v[44:47], v[132:135], a[84:87], v[44:47]
    ds_read_b64_tr_b16 v[154:155], v222 offset:43008
    v_mfma_f32_16x16x32_bf16 v[72:75], v[132:135], a[88:91], v[72:75]
    ds_read_b64_tr_b16 v[156:157], v223 offset:40960
    v_mfma_f32_16x16x32_bf16 v[76:79], v[132:135], a[92:95], v[76:79]
    ds_read_b64_tr_b16 v[158:159], v223 offset:43008
    v_mfma_f32_16x16x32_bf16 v[48:51], v[136:139], a[80:83], v[48:51]
    buffer_load_dwordx4 a[44:47], v246, s[8:11], s35 offen offset:2048 sc1
    v_mfma_f32_16x16x32_bf16 v[52:55], v[136:139], a[84:87], v[52:55]
    s_add_u32 m0, s38, 73728
    s_add_u32 s32, s37, 1638400
    v_mfma_f32_16x16x32_bf16 v[80:83], v[136:139], a[88:91], v[80:83]
    buffer_load_dwordx4 v224, s[12:15], s32 offen lds
    v_mfma_f32_16x16x32_bf16 v[84:87], v[136:139], a[92:95], v[84:87]
    buffer_load_dwordx4 a[48:51], v226, s[8:11], s35 offen offset:3072 sc1
    v_mfma_f32_16x16x32_bf16 v[56:59], v[140:143], a[80:83], v[56:59]
    v_mfma_f32_16x16x32_bf16 v[60:63], v[140:143], a[84:87], v[60:63]
    buffer_load_dwordx4 v225, s[12:15], s32 offen offset:1024 lds
    v_mfma_f32_16x16x32_bf16 v[88:91], v[140:143], a[88:91], v[88:91]
    buffer_load_dwordx4 a[136:139], v228, s[8:11], s33 offen offset:2048 sc1
    v_mfma_f32_16x16x32_bf16 v[92:95], v[140:143], a[92:95], v[92:95]
    s_waitcnt lgkmcnt(0)
    v_mfma_f32_16x16x32_bf16 v[0:3], v[144:147], a[80:83], v[0:3]
    ds_read_b64_tr_b16 v[128:129], v216 offset:49152
    v_mfma_f32_16x16x32_bf16 v[4:7], v[144:147], a[84:87], v[4:7]
    ds_read_b64_tr_b16 v[130:131], v216 offset:51200
    v_mfma_f32_16x16x32_bf16 v[96:99], v[144:147], a[88:91], v[96:99]
    ds_read_b64_tr_b16 v[132:133], v217 offset:49152
    v_mfma_f32_16x16x32_bf16 v[100:103], v[144:147], a[92:95], v[100:103]
    ds_read_b64_tr_b16 v[134:135], v217 offset:51200
    v_mfma_f32_16x16x32_bf16 v[8:11], v[148:151], a[80:83], v[8:11]
    ds_read_b64_tr_b16 v[136:137], v218 offset:49152
    v_mfma_f32_16x16x32_bf16 v[12:15], v[148:151], a[84:87], v[12:15]
    ds_read_b64_tr_b16 v[138:139], v218 offset:51200
    v_mfma_f32_16x16x32_bf16 v[104:107], v[148:151], a[88:91], v[104:107]
    ds_read_b64_tr_b16 v[140:141], v219 offset:49152
    v_mfma_f32_16x16x32_bf16 v[108:111], v[148:151], a[92:95], v[108:111]
    ds_read_b64_tr_b16 v[142:143], v219 offset:51200
    v_mfma_f32_16x16x32_bf16 v[16:19], v[152:155], a[80:83], v[16:19]
    buffer_load_dwordx4 a[52:55], v227, s[8:11], s35 offen offset:3072 sc1
    v_mfma_f32_16x16x32_bf16 v[20:23], v[152:155], a[84:87], v[20:23]
    v_mfma_f32_16x16x32_bf16 v[112:115], v[152:155], a[88:91], v[112:115]
    v_mfma_f32_16x16x32_bf16 v[116:119], v[152:155], a[92:95], v[116:119]
    v_mfma_f32_16x16x32_bf16 v[24:27], v[156:159], a[80:83], v[24:27]
    buffer_load_dwordx4 a[56:59], v245, s[8:11], s35 offen offset:3072 sc1
    v_mfma_f32_16x16x32_bf16 v[28:31], v[156:159], a[84:87], v[28:31]
    v_mfma_f32_16x16x32_bf16 v[120:123], v[156:159], a[88:91], v[120:123]
    buffer_load_dwordx4 a[140:143], v228, s[8:11], s33 offen offset:3072 sc1
    v_mfma_f32_16x16x32_bf16 v[124:127], v[156:159], a[92:95], v[124:127]
    s_waitcnt vmcnt(31) lgkmcnt(0)
    v_mfma_f32_16x16x32_bf16 v[32:35], v[128:131], a[96:99], v[32:35]
    ds_read_b64_tr_b16 v[144:145], v220 offset:49152
    v_mfma_f32_16x16x32_bf16 v[36:39], v[128:131], a[100:103], v[36:39]
    ds_read_b64_tr_b16 v[146:147], v220 offset:51200
    v_mfma_f32_16x16x32_bf16 v[64:67], v[128:131], a[104:107], v[64:67]
    ds_read_b64_tr_b16 v[148:149], v221 offset:49152
    v_mfma_f32_16x16x32_bf16 v[68:71], v[128:131], a[108:111], v[68:71]
    ds_read_b64_tr_b16 v[150:151], v221 offset:51200
    v_mfma_f32_16x16x32_bf16 v[40:43], v[132:135], a[96:99], v[40:43]
    ds_read_b64_tr_b16 v[152:153], v222 offset:49152
    v_mfma_f32_16x16x32_bf16 v[44:47], v[132:135], a[100:103], v[44:47]
    ds_read_b64_tr_b16 v[154:155], v222 offset:51200
    v_mfma_f32_16x16x32_bf16 v[72:75], v[132:135], a[104:107], v[72:75]
    ds_read_b64_tr_b16 v[156:157], v223 offset:49152
    v_mfma_f32_16x16x32_bf16 v[76:79], v[132:135], a[108:111], v[76:79]
    ds_read_b64_tr_b16 v[158:159], v223 offset:51200
    v_mfma_f32_16x16x32_bf16 v[48:51], v[136:139], a[96:99], v[48:51]
    buffer_load_dwordx4 a[60:63], v246, s[8:11], s35 offen offset:3072 sc1
    v_mfma_f32_16x16x32_bf16 v[52:55], v[136:139], a[100:103], v[52:55]
    s_add_u32 m0, s38, 81920
    s_add_u32 s32, s37, 1703936
    v_mfma_f32_16x16x32_bf16 v[80:83], v[136:139], a[104:107], v[80:83]
    buffer_load_dwordx4 v224, s[12:15], s32 offen lds
    v_mfma_f32_16x16x32_bf16 v[84:87], v[136:139], a[108:111], v[84:87]
    s_add_u32 s35, s35, 4096
    buffer_load_dwordx4 a[64:67], v226, s[8:11], s35 offen offset:0 sc1
    v_mfma_f32_16x16x32_bf16 v[56:59], v[140:143], a[96:99], v[56:59]
    v_mfma_f32_16x16x32_bf16 v[60:63], v[140:143], a[100:103], v[60:63]
    buffer_load_dwordx4 v225, s[12:15], s32 offen offset:1024 lds
    v_mfma_f32_16x16x32_bf16 v[88:91], v[140:143], a[104:107], v[88:91]
    s_add_u32 s33, s55, 4096
    buffer_load_dwordx4 a[144:147], v228, s[8:11], s33 offen offset:0 sc1
    v_mfma_f32_16x16x32_bf16 v[92:95], v[140:143], a[108:111], v[92:95]
    s_waitcnt lgkmcnt(0)
    v_mfma_f32_16x16x32_bf16 v[0:3], v[144:147], a[96:99], v[0:3]
    ds_read_b64_tr_b16 v[128:129], v216 offset:57344
    v_mfma_f32_16x16x32_bf16 v[4:7], v[144:147], a[100:103], v[4:7]
    ds_read_b64_tr_b16 v[130:131], v216 offset:59392
    v_mfma_f32_16x16x32_bf16 v[96:99], v[144:147], a[104:107], v[96:99]
    ds_read_b64_tr_b16 v[132:133], v217 offset:57344
    v_mfma_f32_16x16x32_bf16 v[100:103], v[144:147], a[108:111], v[100:103]
    ds_read_b64_tr_b16 v[134:135], v217 offset:59392
    v_mfma_f32_16x16x32_bf16 v[8:11], v[148:151], a[96:99], v[8:11]
    ds_read_b64_tr_b16 v[136:137], v218 offset:57344
    v_mfma_f32_16x16x32_bf16 v[12:15], v[148:151], a[100:103], v[12:15]
    ds_read_b64_tr_b16 v[138:139], v218 offset:59392
    v_mfma_f32_16x16x32_bf16 v[104:107], v[148:151], a[104:107], v[104:107]
    ds_read_b64_tr_b16 v[140:141], v219 offset:57344
    v_mfma_f32_16x16x32_bf16 v[108:111], v[148:151], a[108:111], v[108:111]
    ds_read_b64_tr_b16 v[142:143], v219 offset:59392
    v_mfma_f32_16x16x32_bf16 v[16:19], v[152:155], a[96:99], v[16:19]
    buffer_load_dwordx4 a[68:71], v227, s[8:11], s35 offen offset:0 sc1
    v_mfma_f32_16x16x32_bf16 v[20:23], v[152:155], a[100:103], v[20:23]
    v_mfma_f32_16x16x32_bf16 v[112:115], v[152:155], a[104:107], v[112:115]
    v_mfma_f32_16x16x32_bf16 v[116:119], v[152:155], a[108:111], v[116:119]
    v_mfma_f32_16x16x32_bf16 v[24:27], v[156:159], a[96:99], v[24:27]
    buffer_load_dwordx4 a[72:75], v245, s[8:11], s35 offen offset:0 sc1
    v_mfma_f32_16x16x32_bf16 v[28:31], v[156:159], a[100:103], v[28:31]
    v_mfma_f32_16x16x32_bf16 v[120:123], v[156:159], a[104:107], v[120:123]
    buffer_load_dwordx4 a[148:151], v228, s[8:11], s33 offen offset:1024 sc1
    v_mfma_f32_16x16x32_bf16 v[124:127], v[156:159], a[108:111], v[124:127]
    buffer_load_dwordx4 a[76:79], v246, s[8:11], s35 offen offset:0 sc1
    s_waitcnt vmcnt(34) lgkmcnt(0)
    v_mfma_f32_16x16x32_bf16 v[32:35], v[128:131], a[112:115], v[32:35]
    ds_read_b64_tr_b16 v[144:145], v220 offset:57344
    v_mfma_f32_16x16x32_bf16 v[36:39], v[128:131], a[116:119], v[36:39]
    ds_read_b64_tr_b16 v[146:147], v220 offset:59392
    v_mfma_f32_16x16x32_bf16 v[64:67], v[128:131], a[120:123], v[64:67]
    ds_read_b64_tr_b16 v[148:149], v221 offset:57344
    v_mfma_f32_16x16x32_bf16 v[68:71], v[128:131], a[124:127], v[68:71]
    ds_read_b64_tr_b16 v[150:151], v221 offset:59392
    v_mfma_f32_16x16x32_bf16 v[40:43], v[132:135], a[112:115], v[40:43]
    ds_read_b64_tr_b16 v[152:153], v222 offset:57344
    v_mfma_f32_16x16x32_bf16 v[44:47], v[132:135], a[116:119], v[44:47]
    ds_read_b64_tr_b16 v[154:155], v222 offset:59392
    v_mfma_f32_16x16x32_bf16 v[72:75], v[132:135], a[120:123], v[72:75]
    ds_read_b64_tr_b16 v[156:157], v223 offset:57344
    v_mfma_f32_16x16x32_bf16 v[76:79], v[132:135], a[124:127], v[76:79]
    ds_read_b64_tr_b16 v[158:159], v223 offset:59392
    v_mfma_f32_16x16x32_bf16 v[48:51], v[136:139], a[112:115], v[48:51]
    buffer_load_dwordx4 a[80:83], v226, s[8:11], s35 offen offset:1024 sc1
    v_mfma_f32_16x16x32_bf16 v[52:55], v[136:139], a[116:119], v[52:55]
    s_add_u32 m0, s38, 90112
    s_add_u32 s32, s37, 1769472
    v_mfma_f32_16x16x32_bf16 v[80:83], v[136:139], a[120:123], v[80:83]
    buffer_load_dwordx4 v224, s[12:15], s32 offen lds
    v_mfma_f32_16x16x32_bf16 v[84:87], v[136:139], a[124:127], v[84:87]
    buffer_load_dwordx4 a[84:87], v227, s[8:11], s35 offen offset:1024 sc1
    v_mfma_f32_16x16x32_bf16 v[56:59], v[140:143], a[112:115], v[56:59]
    v_mfma_f32_16x16x32_bf16 v[60:63], v[140:143], a[116:119], v[60:63]
    buffer_load_dwordx4 v225, s[12:15], s32 offen offset:1024 lds
    v_mfma_f32_16x16x32_bf16 v[88:91], v[140:143], a[120:123], v[88:91]
    buffer_load_dwordx4 a[152:155], v228, s[8:11], s33 offen offset:2048 sc1
    v_mfma_f32_16x16x32_bf16 v[92:95], v[140:143], a[124:127], v[92:95]
    s_waitcnt vmcnt(60) lgkmcnt(0)
    s_barrier
    v_mfma_f32_16x16x32_bf16 v[0:3], v[144:147], a[112:115], v[0:3]
    v_xor_b32 v216, 0x10000, v216
    ds_read_b64_tr_b16 v[128:129], v216 offset:0
    v_mfma_f32_16x16x32_bf16 v[4:7], v[144:147], a[116:119], v[4:7]
    ds_read_b64_tr_b16 v[130:131], v216 offset:2048
    v_mfma_f32_16x16x32_bf16 v[96:99], v[144:147], a[120:123], v[96:99]
    v_xor_b32 v217, 0x10000, v217
    ds_read_b64_tr_b16 v[132:133], v217 offset:0
    v_mfma_f32_16x16x32_bf16 v[100:103], v[144:147], a[124:127], v[100:103]
    ds_read_b64_tr_b16 v[134:135], v217 offset:2048
    v_mfma_f32_16x16x32_bf16 v[8:11], v[148:151], a[112:115], v[8:11]
    v_xor_b32 v218, 0x10000, v218
    ds_read_b64_tr_b16 v[136:137], v218 offset:0
    v_mfma_f32_16x16x32_bf16 v[12:15], v[148:151], a[116:119], v[12:15]
    ds_read_b64_tr_b16 v[138:139], v218 offset:2048
    v_mfma_f32_16x16x32_bf16 v[104:107], v[148:151], a[120:123], v[104:107]
    v_xor_b32 v219, 0x10000, v219
    ds_read_b64_tr_b16 v[140:141], v219 offset:0
    v_mfma_f32_16x16x32_bf16 v[108:111], v[148:151], a[124:127], v[108:111]
    ds_read_b64_tr_b16 v[142:143], v219 offset:2048
    v_mfma_f32_16x16x32_bf16 v[16:19], v[152:155], a[112:115], v[16:19]
    buffer_load_dwordx4 a[88:91], v245, s[8:11], s35 offen offset:1024 sc1
    v_mfma_f32_16x16x32_bf16 v[20:23], v[152:155], a[116:119], v[20:23]
    v_mfma_f32_16x16x32_bf16 v[112:115], v[152:155], a[120:123], v[112:115]
    v_mfma_f32_16x16x32_bf16 v[116:119], v[152:155], a[124:127], v[116:119]
    v_mfma_f32_16x16x32_bf16 v[24:27], v[156:159], a[112:115], v[24:27]
    buffer_load_dwordx4 a[92:95], v246, s[8:11], s35 offen offset:1024 sc1
    v_mfma_f32_16x16x32_bf16 v[28:31], v[156:159], a[116:119], v[28:31]
    v_mfma_f32_16x16x32_bf16 v[120:123], v[156:159], a[120:123], v[120:123]
    buffer_load_dwordx4 a[156:159], v228, s[8:11], s33 offen offset:3072 sc1
    v_mfma_f32_16x16x32_bf16 v[124:127], v[156:159], a[124:127], v[124:127]
    s_waitcnt vmcnt(37) lgkmcnt(0)
    v_mfma_f32_16x16x32_bf16 v[32:35], v[128:131], a[0:3], v[32:35]
    v_xor_b32 v220, 0x10000, v220
    ds_read_b64_tr_b16 v[144:145], v220 offset:0
    v_mfma_f32_16x16x32_bf16 v[36:39], v[128:131], a[4:7], v[36:39]
    ds_read_b64_tr_b16 v[146:147], v220 offset:2048
    v_mfma_f32_16x16x32_bf16 v[64:67], v[128:131], a[8:11], v[64:67]
    v_xor_b32 v221, 0x10000, v221
    ds_read_b64_tr_b16 v[148:149], v221 offset:0
    v_mfma_f32_16x16x32_bf16 v[68:71], v[128:131], a[12:15], v[68:71]
    ds_read_b64_tr_b16 v[150:151], v221 offset:2048
    v_mfma_f32_16x16x32_bf16 v[40:43], v[132:135], a[0:3], v[40:43]
    v_xor_b32 v222, 0x10000, v222
    ds_read_b64_tr_b16 v[152:153], v222 offset:0
    v_mfma_f32_16x16x32_bf16 v[44:47], v[132:135], a[4:7], v[44:47]
    ds_read_b64_tr_b16 v[154:155], v222 offset:2048
    v_mfma_f32_16x16x32_bf16 v[72:75], v[132:135], a[8:11], v[72:75]
    v_xor_b32 v223, 0x10000, v223
    ds_read_b64_tr_b16 v[156:157], v223 offset:0
    v_mfma_f32_16x16x32_bf16 v[76:79], v[132:135], a[12:15], v[76:79]
    ds_read_b64_tr_b16 v[158:159], v223 offset:2048
    v_mfma_f32_16x16x32_bf16 v[48:51], v[136:139], a[0:3], v[48:51]
    buffer_load_dwordx4 a[96:99], v226, s[8:11], s35 offen offset:2048 sc1
    v_mfma_f32_16x16x32_bf16 v[52:55], v[136:139], a[4:7], v[52:55]
    s_add_u32 m0, s38, 98304
    s_add_u32 s32, s37, 1835008
    v_mfma_f32_16x16x32_bf16 v[80:83], v[136:139], a[8:11], v[80:83]
    buffer_load_dwordx4 v224, s[12:15], s32 offen lds
    v_mfma_f32_16x16x32_bf16 v[84:87], v[136:139], a[12:15], v[84:87]
    buffer_load_dwordx4 a[100:103], v227, s[8:11], s35 offen offset:2048 sc1
    v_mfma_f32_16x16x32_bf16 v[56:59], v[140:143], a[0:3], v[56:59]
    v_mfma_f32_16x16x32_bf16 v[60:63], v[140:143], a[4:7], v[60:63]
    buffer_load_dwordx4 v225, s[12:15], s32 offen offset:1024 lds
    v_mfma_f32_16x16x32_bf16 v[88:91], v[140:143], a[8:11], v[88:91]
    s_add_u32 s33, s55, 32768
    buffer_load_dwordx4 a[160:163], v228, s[8:11], s33 offen offset:0 sc1
    v_mfma_f32_16x16x32_bf16 v[92:95], v[140:143], a[12:15], v[92:95]
    s_waitcnt lgkmcnt(0)
    v_mfma_f32_16x16x32_bf16 v[0:3], v[144:147], a[0:3], v[0:3]
    ds_read_b64_tr_b16 v[128:129], v216 offset:8192
    v_mfma_f32_16x16x32_bf16 v[4:7], v[144:147], a[4:7], v[4:7]
    ds_read_b64_tr_b16 v[130:131], v216 offset:10240
    v_mfma_f32_16x16x32_bf16 v[96:99], v[144:147], a[8:11], v[96:99]
    ds_read_b64_tr_b16 v[132:133], v217 offset:8192
    v_mfma_f32_16x16x32_bf16 v[100:103], v[144:147], a[12:15], v[100:103]
    ds_read_b64_tr_b16 v[134:135], v217 offset:10240
    v_mfma_f32_16x16x32_bf16 v[8:11], v[148:151], a[0:3], v[8:11]
    ds_read_b64_tr_b16 v[136:137], v218 offset:8192
    v_mfma_f32_16x16x32_bf16 v[12:15], v[148:151], a[4:7], v[12:15]
    ds_read_b64_tr_b16 v[138:139], v218 offset:10240
    v_mfma_f32_16x16x32_bf16 v[104:107], v[148:151], a[8:11], v[104:107]
    ds_read_b64_tr_b16 v[140:141], v219 offset:8192
    v_mfma_f32_16x16x32_bf16 v[108:111], v[148:151], a[12:15], v[108:111]
    ds_read_b64_tr_b16 v[142:143], v219 offset:10240
    v_mfma_f32_16x16x32_bf16 v[16:19], v[152:155], a[0:3], v[16:19]
    buffer_load_dwordx4 a[104:107], v245, s[8:11], s35 offen offset:2048 sc1
    v_mfma_f32_16x16x32_bf16 v[20:23], v[152:155], a[4:7], v[20:23]
    v_mfma_f32_16x16x32_bf16 v[112:115], v[152:155], a[8:11], v[112:115]
    v_mfma_f32_16x16x32_bf16 v[116:119], v[152:155], a[12:15], v[116:119]
    v_mfma_f32_16x16x32_bf16 v[24:27], v[156:159], a[0:3], v[24:27]
    buffer_load_dwordx4 a[108:111], v246, s[8:11], s35 offen offset:2048 sc1
    v_mfma_f32_16x16x32_bf16 v[28:31], v[156:159], a[4:7], v[28:31]
    v_mfma_f32_16x16x32_bf16 v[120:123], v[156:159], a[8:11], v[120:123]
    buffer_load_dwordx4 a[164:167], v228, s[8:11], s33 offen offset:1024 sc1
    v_mfma_f32_16x16x32_bf16 v[124:127], v[156:159], a[12:15], v[124:127]
    buffer_load_dwordx4 a[112:115], v226, s[8:11], s35 offen offset:3072 sc1
    s_waitcnt vmcnt(40) lgkmcnt(0)
    v_mfma_f32_16x16x32_bf16 v[32:35], v[128:131], a[16:19], v[32:35]
    ds_read_b64_tr_b16 v[144:145], v220 offset:8192
    v_mfma_f32_16x16x32_bf16 v[36:39], v[128:131], a[20:23], v[36:39]
    ds_read_b64_tr_b16 v[146:147], v220 offset:10240
    v_mfma_f32_16x16x32_bf16 v[64:67], v[128:131], a[24:27], v[64:67]
    ds_read_b64_tr_b16 v[148:149], v221 offset:8192
    v_mfma_f32_16x16x32_bf16 v[68:71], v[128:131], a[28:31], v[68:71]
    ds_read_b64_tr_b16 v[150:151], v221 offset:10240
    v_mfma_f32_16x16x32_bf16 v[40:43], v[132:135], a[16:19], v[40:43]
    ds_read_b64_tr_b16 v[152:153], v222 offset:8192
    v_mfma_f32_16x16x32_bf16 v[44:47], v[132:135], a[20:23], v[44:47]
    ds_read_b64_tr_b16 v[154:155], v222 offset:10240
    v_mfma_f32_16x16x32_bf16 v[72:75], v[132:135], a[24:27], v[72:75]
    ds_read_b64_tr_b16 v[156:157], v223 offset:8192
    v_mfma_f32_16x16x32_bf16 v[76:79], v[132:135], a[28:31], v[76:79]
    ds_read_b64_tr_b16 v[158:159], v223 offset:10240
    v_mfma_f32_16x16x32_bf16 v[48:51], v[136:139], a[16:19], v[48:51]
    buffer_load_dwordx4 a[116:119], v227, s[8:11], s35 offen offset:3072 sc1
    v_mfma_f32_16x16x32_bf16 v[52:55], v[136:139], a[20:23], v[52:55]
    s_add_u32 m0, s38, 106496
    s_add_u32 s32, s37, 1900544
    v_mfma_f32_16x16x32_bf16 v[80:83], v[136:139], a[24:27], v[80:83]
    buffer_load_dwordx4 v224, s[12:15], s32 offen lds
    v_mfma_f32_16x16x32_bf16 v[84:87], v[136:139], a[28:31], v[84:87]
    buffer_load_dwordx4 a[120:123], v245, s[8:11], s35 offen offset:3072 sc1
    v_mfma_f32_16x16x32_bf16 v[56:59], v[140:143], a[16:19], v[56:59]
    v_mfma_f32_16x16x32_bf16 v[60:63], v[140:143], a[20:23], v[60:63]
    buffer_load_dwordx4 v225, s[12:15], s32 offen offset:1024 lds
    v_mfma_f32_16x16x32_bf16 v[88:91], v[140:143], a[24:27], v[88:91]
    buffer_load_dwordx4 a[168:171], v228, s[8:11], s33 offen offset:2048 sc1
    v_mfma_f32_16x16x32_bf16 v[92:95], v[140:143], a[28:31], v[92:95]
    s_waitcnt lgkmcnt(0)
    v_mfma_f32_16x16x32_bf16 v[0:3], v[144:147], a[16:19], v[0:3]
    ds_read_b64_tr_b16 v[128:129], v216 offset:16384
    v_mfma_f32_16x16x32_bf16 v[4:7], v[144:147], a[20:23], v[4:7]
    ds_read_b64_tr_b16 v[130:131], v216 offset:18432
    v_mfma_f32_16x16x32_bf16 v[96:99], v[144:147], a[24:27], v[96:99]
    ds_read_b64_tr_b16 v[132:133], v217 offset:16384
    v_mfma_f32_16x16x32_bf16 v[100:103], v[144:147], a[28:31], v[100:103]
    ds_read_b64_tr_b16 v[134:135], v217 offset:18432
    v_mfma_f32_16x16x32_bf16 v[8:11], v[148:151], a[16:19], v[8:11]
    ds_read_b64_tr_b16 v[136:137], v218 offset:16384
    v_mfma_f32_16x16x32_bf16 v[12:15], v[148:151], a[20:23], v[12:15]
    ds_read_b64_tr_b16 v[138:139], v218 offset:18432
    v_mfma_f32_16x16x32_bf16 v[104:107], v[148:151], a[24:27], v[104:107]
    ds_read_b64_tr_b16 v[140:141], v219 offset:16384
    v_mfma_f32_16x16x32_bf16 v[108:111], v[148:151], a[28:31], v[108:111]
    ds_read_b64_tr_b16 v[142:143], v219 offset:18432
    v_mfma_f32_16x16x32_bf16 v[16:19], v[152:155], a[16:19], v[16:19]
    buffer_load_dwordx4 a[124:127], v246, s[8:11], s35 offen offset:3072 sc1
    v_mfma_f32_16x16x32_bf16 v[20:23], v[152:155], a[20:23], v[20:23]
    v_mfma_f32_16x16x32_bf16 v[112:115], v[152:155], a[24:27], v[112:115]
    v_mfma_f32_16x16x32_bf16 v[116:119], v[152:155], a[28:31], v[116:119]
    v_mfma_f32_16x16x32_bf16 v[24:27], v[156:159], a[16:19], v[24:27]
    s_add_u32 s35, s35, 4096
    buffer_load_dwordx4 a[0:3], v226, s[8:11], s35 offen offset:0 sc1
    v_mfma_f32_16x16x32_bf16 v[28:31], v[156:159], a[20:23], v[28:31]
    v_mfma_f32_16x16x32_bf16 v[120:123], v[156:159], a[24:27], v[120:123]
    buffer_load_dwordx4 a[172:175], v228, s[8:11], s33 offen offset:3072 sc1
    v_mfma_f32_16x16x32_bf16 v[124:127], v[156:159], a[28:31], v[124:127]
    s_waitcnt vmcnt(41) lgkmcnt(0)
    v_mfma_f32_16x16x32_bf16 v[32:35], v[128:131], a[32:35], v[32:35]
    ds_read_b64_tr_b16 v[144:145], v220 offset:16384
    v_mfma_f32_16x16x32_bf16 v[36:39], v[128:131], a[36:39], v[36:39]
    ds_read_b64_tr_b16 v[146:147], v220 offset:18432
    v_mfma_f32_16x16x32_bf16 v[64:67], v[128:131], a[40:43], v[64:67]
    ds_read_b64_tr_b16 v[148:149], v221 offset:16384
    v_mfma_f32_16x16x32_bf16 v[68:71], v[128:131], a[44:47], v[68:71]
    ds_read_b64_tr_b16 v[150:151], v221 offset:18432
    v_mfma_f32_16x16x32_bf16 v[40:43], v[132:135], a[32:35], v[40:43]
    ds_read_b64_tr_b16 v[152:153], v222 offset:16384
    v_mfma_f32_16x16x32_bf16 v[44:47], v[132:135], a[36:39], v[44:47]
    ds_read_b64_tr_b16 v[154:155], v222 offset:18432
    v_mfma_f32_16x16x32_bf16 v[72:75], v[132:135], a[40:43], v[72:75]
    ds_read_b64_tr_b16 v[156:157], v223 offset:16384
    v_mfma_f32_16x16x32_bf16 v[76:79], v[132:135], a[44:47], v[76:79]
    ds_read_b64_tr_b16 v[158:159], v223 offset:18432
    v_mfma_f32_16x16x32_bf16 v[48:51], v[136:139], a[32:35], v[48:51]
    buffer_load_dwordx4 a[4:7], v227, s[8:11], s35 offen offset:0 sc1
    v_mfma_f32_16x16x32_bf16 v[52:55], v[136:139], a[36:39], v[52:55]
    s_add_u32 m0, s38, 114688
    s_add_u32 s32, s37, 1966080
    v_mfma_f32_16x16x32_bf16 v[80:83], v[136:139], a[40:43], v[80:83]
    buffer_load_dwordx4 v224, s[12:15], s32 offen lds
    v_mfma_f32_16x16x32_bf16 v[84:87], v[136:139], a[44:47], v[84:87]
    buffer_load_dwordx4 a[8:11], v245, s[8:11], s35 offen offset:0 sc1
    v_mfma_f32_16x16x32_bf16 v[56:59], v[140:143], a[32:35], v[56:59]
    v_mfma_f32_16x16x32_bf16 v[60:63], v[140:143], a[36:39], v[60:63]
    buffer_load_dwordx4 v225, s[12:15], s32 offen offset:1024 lds
    v_mfma_f32_16x16x32_bf16 v[88:91], v[140:143], a[40:43], v[88:91]
    s_add_u32 s33, s55, 36864
    buffer_load_dwordx4 a[176:179], v228, s[8:11], s33 offen offset:0 sc1
    v_mfma_f32_16x16x32_bf16 v[92:95], v[140:143], a[44:47], v[92:95]
    s_waitcnt lgkmcnt(0)
    v_mfma_f32_16x16x32_bf16 v[0:3], v[144:147], a[32:35], v[0:3]
    ds_read_b64_tr_b16 v[128:129], v216 offset:24576
    v_mfma_f32_16x16x32_bf16 v[4:7], v[144:147], a[36:39], v[4:7]
    ds_read_b64_tr_b16 v[130:131], v216 offset:26624
    v_mfma_f32_16x16x32_bf16 v[96:99], v[144:147], a[40:43], v[96:99]
    ds_read_b64_tr_b16 v[132:133], v217 offset:24576
    v_mfma_f32_16x16x32_bf16 v[100:103], v[144:147], a[44:47], v[100:103]
    ds_read_b64_tr_b16 v[134:135], v217 offset:26624
    v_mfma_f32_16x16x32_bf16 v[8:11], v[148:151], a[32:35], v[8:11]
    ds_read_b64_tr_b16 v[136:137], v218 offset:24576
    v_mfma_f32_16x16x32_bf16 v[12:15], v[148:151], a[36:39], v[12:15]
    ds_read_b64_tr_b16 v[138:139], v218 offset:26624
    v_mfma_f32_16x16x32_bf16 v[104:107], v[148:151], a[40:43], v[104:107]
    ds_read_b64_tr_b16 v[140:141], v219 offset:24576
    v_mfma_f32_16x16x32_bf16 v[108:111], v[148:151], a[44:47], v[108:111]
    ds_read_b64_tr_b16 v[142:143], v219 offset:26624
    v_mfma_f32_16x16x32_bf16 v[16:19], v[152:155], a[32:35], v[16:19]
    buffer_load_dwordx4 a[12:15], v246, s[8:11], s35 offen offset:0 sc1
    v_mfma_f32_16x16x32_bf16 v[20:23], v[152:155], a[36:39], v[20:23]
    v_mfma_f32_16x16x32_bf16 v[112:115], v[152:155], a[40:43], v[112:115]
    v_mfma_f32_16x16x32_bf16 v[116:119], v[152:155], a[44:47], v[116:119]
    v_mfma_f32_16x16x32_bf16 v[24:27], v[156:159], a[32:35], v[24:27]
    buffer_load_dwordx4 a[16:19], v226, s[8:11], s35 offen offset:1024 sc1
    v_mfma_f32_16x16x32_bf16 v[28:31], v[156:159], a[36:39], v[28:31]
    v_mfma_f32_16x16x32_bf16 v[120:123], v[156:159], a[40:43], v[120:123]
    buffer_load_dwordx4 a[180:183], v228, s[8:11], s33 offen offset:1024 sc1
    v_mfma_f32_16x16x32_bf16 v[124:127], v[156:159], a[44:47], v[124:127]
    buffer_load_dwordx4 a[20:23], v227, s[8:11], s35 offen offset:1024 sc1
    s_waitcnt vmcnt(42) lgkmcnt(0)
    v_mfma_f32_16x16x32_bf16 v[32:35], v[128:131], a[48:51], v[32:35]
    ds_read_b64_tr_b16 v[144:145], v220 offset:24576
    v_mfma_f32_16x16x32_bf16 v[36:39], v[128:131], a[52:55], v[36:39]
    ds_read_b64_tr_b16 v[146:147], v220 offset:26624
    v_mfma_f32_16x16x32_bf16 v[64:67], v[128:131], a[56:59], v[64:67]
    ds_read_b64_tr_b16 v[148:149], v221 offset:24576
    v_mfma_f32_16x16x32_bf16 v[68:71], v[128:131], a[60:63], v[68:71]
    ds_read_b64_tr_b16 v[150:151], v221 offset:26624
    v_mfma_f32_16x16x32_bf16 v[40:43], v[132:135], a[48:51], v[40:43]
    ds_read_b64_tr_b16 v[152:153], v222 offset:24576
    v_mfma_f32_16x16x32_bf16 v[44:47], v[132:135], a[52:55], v[44:47]
    ds_read_b64_tr_b16 v[154:155], v222 offset:26624
    v_mfma_f32_16x16x32_bf16 v[72:75], v[132:135], a[56:59], v[72:75]
    ds_read_b64_tr_b16 v[156:157], v223 offset:24576
    v_mfma_f32_16x16x32_bf16 v[76:79], v[132:135], a[60:63], v[76:79]
    ds_read_b64_tr_b16 v[158:159], v223 offset:26624
    v_mfma_f32_16x16x32_bf16 v[48:51], v[136:139], a[48:51], v[48:51]
    buffer_load_dwordx4 a[24:27], v245, s[8:11], s35 offen offset:1024 sc1
    v_mfma_f32_16x16x32_bf16 v[52:55], v[136:139], a[52:55], v[52:55]
    s_add_u32 m0, s38, 122880
    s_add_u32 s32, s37, 2031616
    v_mfma_f32_16x16x32_bf16 v[80:83], v[136:139], a[56:59], v[80:83]
    buffer_load_dwordx4 v224, s[12:15], s32 offen lds
    v_mfma_f32_16x16x32_bf16 v[84:87], v[136:139], a[60:63], v[84:87]
    buffer_load_dwordx4 a[28:31], v246, s[8:11], s35 offen offset:1024 sc1
    v_mfma_f32_16x16x32_bf16 v[56:59], v[140:143], a[48:51], v[56:59]
    v_mfma_f32_16x16x32_bf16 v[60:63], v[140:143], a[52:55], v[60:63]
    buffer_load_dwordx4 v225, s[12:15], s32 offen offset:1024 lds
    v_mfma_f32_16x16x32_bf16 v[88:91], v[140:143], a[56:59], v[88:91]
    buffer_load_dwordx4 a[184:187], v228, s[8:11], s33 offen offset:2048 sc1
    v_mfma_f32_16x16x32_bf16 v[92:95], v[140:143], a[60:63], v[92:95]
    s_waitcnt vmcnt(63) lgkmcnt(0)
    s_barrier
    v_mfma_f32_16x16x32_bf16 v[0:3], v[144:147], a[48:51], v[0:3]
    ds_read_b64_tr_b16 v[128:129], v216 offset:32768
    v_mfma_f32_16x16x32_bf16 v[4:7], v[144:147], a[52:55], v[4:7]
    ds_read_b64_tr_b16 v[130:131], v216 offset:34816
    v_mfma_f32_16x16x32_bf16 v[96:99], v[144:147], a[56:59], v[96:99]
    ds_read_b64_tr_b16 v[132:133], v217 offset:32768
    v_mfma_f32_16x16x32_bf16 v[100:103], v[144:147], a[60:63], v[100:103]
    ds_read_b64_tr_b16 v[134:135], v217 offset:34816
    v_mfma_f32_16x16x32_bf16 v[8:11], v[148:151], a[48:51], v[8:11]
    ds_read_b64_tr_b16 v[136:137], v218 offset:32768
    v_mfma_f32_16x16x32_bf16 v[12:15], v[148:151], a[52:55], v[12:15]
    ds_read_b64_tr_b16 v[138:139], v218 offset:34816
    v_mfma_f32_16x16x32_bf16 v[104:107], v[148:151], a[56:59], v[104:107]
    ds_read_b64_tr_b16 v[140:141], v219 offset:32768
    v_mfma_f32_16x16x32_bf16 v[108:111], v[148:151], a[60:63], v[108:111]
    ds_read_b64_tr_b16 v[142:143], v219 offset:34816
    v_mfma_f32_16x16x32_bf16 v[16:19], v[152:155], a[48:51], v[16:19]
    buffer_load_dwordx4 a[32:35], v226, s[8:11], s35 offen offset:2048 sc1
    v_mfma_f32_16x16x32_bf16 v[20:23], v[152:155], a[52:55], v[20:23]
    v_mfma_f32_16x16x32_bf16 v[112:115], v[152:155], a[56:59], v[112:115]
    v_mfma_f32_16x16x32_bf16 v[116:119], v[152:155], a[60:63], v[116:119]
    v_mfma_f32_16x16x32_bf16 v[24:27], v[156:159], a[48:51], v[24:27]
    buffer_load_dwordx4 a[36:39], v227, s[8:11], s35 offen offset:2048 sc1
    v_mfma_f32_16x16x32_bf16 v[28:31], v[156:159], a[52:55], v[28:31]
    v_mfma_f32_16x16x32_bf16 v[120:123], v[156:159], a[56:59], v[120:123]
    buffer_load_dwordx4 a[188:191], v228, s[8:11], s33 offen offset:3072 sc1
    v_mfma_f32_16x16x32_bf16 v[124:127], v[156:159], a[60:63], v[124:127]
    s_waitcnt vmcnt(42) lgkmcnt(0)
    v_mfma_f32_16x16x32_bf16 v[32:35], v[128:131], a[64:67], v[32:35]
    ds_read_b64_tr_b16 v[144:145], v220 offset:32768
    v_mfma_f32_16x16x32_bf16 v[36:39], v[128:131], a[68:71], v[36:39]
    ds_read_b64_tr_b16 v[146:147], v220 offset:34816
    v_mfma_f32_16x16x32_bf16 v[64:67], v[128:131], a[72:75], v[64:67]
    ds_read_b64_tr_b16 v[148:149], v221 offset:32768
    v_mfma_f32_16x16x32_bf16 v[68:71], v[128:131], a[76:79], v[68:71]
    ds_read_b64_tr_b16 v[150:151], v221 offset:34816
    v_mfma_f32_16x16x32_bf16 v[40:43], v[132:135], a[64:67], v[40:43]
    ds_read_b64_tr_b16 v[152:153], v222 offset:32768
    v_mfma_f32_16x16x32_bf16 v[44:47], v[132:135], a[68:71], v[44:47]
    ds_read_b64_tr_b16 v[154:155], v222 offset:34816
    v_mfma_f32_16x16x32_bf16 v[72:75], v[132:135], a[72:75], v[72:75]
    ds_read_b64_tr_b16 v[156:157], v223 offset:32768
    v_mfma_f32_16x16x32_bf16 v[76:79], v[132:135], a[76:79], v[76:79]
    ds_read_b64_tr_b16 v[158:159], v223 offset:34816
    v_mfma_f32_16x16x32_bf16 v[48:51], v[136:139], a[64:67], v[48:51]
    buffer_load_dwordx4 a[40:43], v245, s[8:11], s35 offen offset:2048 sc1
    v_mfma_f32_16x16x32_bf16 v[52:55], v[136:139], a[68:71], v[52:55]
    v_mfma_f32_16x16x32_bf16 v[80:83], v[136:139], a[72:75], v[80:83]
    v_mfma_f32_16x16x32_bf16 v[84:87], v[136:139], a[76:79], v[84:87]
    buffer_load_dwordx4 a[44:47], v246, s[8:11], s35 offen offset:2048 sc1
    v_mfma_f32_16x16x32_bf16 v[56:59], v[140:143], a[64:67], v[56:59]
    v_mfma_f32_16x16x32_bf16 v[60:63], v[140:143], a[68:71], v[60:63]
    s_mov_b32 s32, 0
    buffer_load_dwordx4 v[192:195], v229, s[16:19], s32 offen
    v_mfma_f32_16x16x32_bf16 v[88:91], v[140:143], a[72:75], v[88:91]
    v_mfma_f32_16x16x32_bf16 v[92:95], v[140:143], a[76:79], v[92:95]
    s_waitcnt lgkmcnt(0)
    v_mfma_f32_16x16x32_bf16 v[0:3], v[144:147], a[64:67], v[0:3]
    ds_read_b64_tr_b16 v[128:129], v216 offset:40960
    v_mfma_f32_16x16x32_bf16 v[4:7], v[144:147], a[68:71], v[4:7]
    ds_read_b64_tr_b16 v[130:131], v216 offset:43008
    v_mfma_f32_16x16x32_bf16 v[96:99], v[144:147], a[72:75], v[96:99]
    ds_read_b64_tr_b16 v[132:133], v217 offset:40960
    v_mfma_f32_16x16x32_bf16 v[100:103], v[144:147], a[76:79], v[100:103]
    ds_read_b64_tr_b16 v[134:135], v217 offset:43008
    v_mfma_f32_16x16x32_bf16 v[8:11], v[148:151], a[64:67], v[8:11]
    ds_read_b64_tr_b16 v[136:137], v218 offset:40960
    v_mfma_f32_16x16x32_bf16 v[12:15], v[148:151], a[68:71], v[12:15]
    ds_read_b64_tr_b16 v[138:139], v218 offset:43008
    v_mfma_f32_16x16x32_bf16 v[104:107], v[148:151], a[72:75], v[104:107]
    ds_read_b64_tr_b16 v[140:141], v219 offset:40960
    v_mfma_f32_16x16x32_bf16 v[108:111], v[148:151], a[76:79], v[108:111]
    ds_read_b64_tr_b16 v[142:143], v219 offset:43008
    v_mfma_f32_16x16x32_bf16 v[16:19], v[152:155], a[64:67], v[16:19]
    buffer_load_dwordx4 a[48:51], v226, s[8:11], s35 offen offset:3072 sc1
    v_mfma_f32_16x16x32_bf16 v[20:23], v[152:155], a[68:71], v[20:23]
    v_mfma_f32_16x16x32_bf16 v[112:115], v[152:155], a[72:75], v[112:115]
    v_mfma_f32_16x16x32_bf16 v[116:119], v[152:155], a[76:79], v[116:119]
    v_mfma_f32_16x16x32_bf16 v[24:27], v[156:159], a[64:67], v[24:27]
    buffer_load_dwordx4 a[52:55], v227, s[8:11], s35 offen offset:3072 sc1
    v_mfma_f32_16x16x32_bf16 v[28:31], v[156:159], a[68:71], v[28:31]
    s_mov_b32 s32, 16384
    buffer_load_dwordx4 v[196:199], v229, s[16:19], s32 offen
    v_mfma_f32_16x16x32_bf16 v[120:123], v[156:159], a[72:75], v[120:123]
    v_mfma_f32_16x16x32_bf16 v[124:127], v[156:159], a[76:79], v[124:127]
    buffer_load_dwordx4 a[56:59], v245, s[8:11], s35 offen offset:3072 sc1
    s_waitcnt vmcnt(42) lgkmcnt(0)
    v_mfma_f32_16x16x32_bf16 v[32:35], v[128:131], a[80:83], v[32:35]
    ds_read_b64_tr_b16 v[144:145], v220 offset:40960
    v_mfma_f32_16x16x32_bf16 v[36:39], v[128:131], a[84:87], v[36:39]
    ds_read_b64_tr_b16 v[146:147], v220 offset:43008
    v_mfma_f32_16x16x32_bf16 v[64:67], v[128:131], a[88:91], v[64:67]
    ds_read_b64_tr_b16 v[148:149], v221 offset:40960
    v_mfma_f32_16x16x32_bf16 v[68:71], v[128:131], a[92:95], v[68:71]
    ds_read_b64_tr_b16 v[150:151], v221 offset:43008
    v_mfma_f32_16x16x32_bf16 v[40:43], v[132:135], a[80:83], v[40:43]
    ds_read_b64_tr_b16 v[152:153], v222 offset:40960
    v_mfma_f32_16x16x32_bf16 v[44:47], v[132:135], a[84:87], v[44:47]
    ds_read_b64_tr_b16 v[154:155], v222 offset:43008
    v_mfma_f32_16x16x32_bf16 v[72:75], v[132:135], a[88:91], v[72:75]
    ds_read_b64_tr_b16 v[156:157], v223 offset:40960
    v_mfma_f32_16x16x32_bf16 v[76:79], v[132:135], a[92:95], v[76:79]
    ds_read_b64_tr_b16 v[158:159], v223 offset:43008
    v_mfma_f32_16x16x32_bf16 v[48:51], v[136:139], a[80:83], v[48:51]
    buffer_load_dwordx4 a[60:63], v246, s[8:11], s35 offen offset:3072 sc1
    v_mfma_f32_16x16x32_bf16 v[52:55], v[136:139], a[84:87], v[52:55]
    v_mfma_f32_16x16x32_bf16 v[80:83], v[136:139], a[88:91], v[80:83]
    v_mfma_f32_16x16x32_bf16 v[84:87], v[136:139], a[92:95], v[84:87]
    s_add_u32 s35, s35, 4096
    buffer_load_dwordx4 a[64:67], v226, s[8:11], s35 offen offset:0 sc1
    v_mfma_f32_16x16x32_bf16 v[56:59], v[140:143], a[80:83], v[56:59]
    v_mfma_f32_16x16x32_bf16 v[60:63], v[140:143], a[84:87], v[60:63]
    s_mov_b32 s32, 32768
    buffer_load_dwordx4 v[200:203], v229, s[16:19], s32 offen
    v_mfma_f32_16x16x32_bf16 v[88:91], v[140:143], a[88:91], v[88:91]
    v_mfma_f32_16x16x32_bf16 v[92:95], v[140:143], a[92:95], v[92:95]
    s_waitcnt lgkmcnt(0)
    v_mfma_f32_16x16x32_bf16 v[0:3], v[144:147], a[80:83], v[0:3]
    ds_read_b64_tr_b16 v[128:129], v216 offset:49152
    v_mfma_f32_16x16x32_bf16 v[4:7], v[144:147], a[84:87], v[4:7]
    ds_read_b64_tr_b16 v[130:131], v216 offset:51200
    v_mfma_f32_16x16x32_bf16 v[96:99], v[144:147], a[88:91], v[96:99]
    ds_read_b64_tr_b16 v[132:133], v217 offset:49152
    v_mfma_f32_16x16x32_bf16 v[100:103], v[144:147], a[92:95], v[100:103]
    ds_read_b64_tr_b16 v[134:135], v217 offset:51200
    v_mfma_f32_16x16x32_bf16 v[8:11], v[148:151], a[80:83], v[8:11]
    ds_read_b64_tr_b16 v[136:137], v218 offset:49152
    v_mfma_f32_16x16x32_bf16 v[12:15], v[148:151], a[84:87], v[12:15]
    ds_read_b64_tr_b16 v[138:139], v218 offset:51200
    v_mfma_f32_16x16x32_bf16 v[104:107], v[148:151], a[88:91], v[104:107]
    ds_read_b64_tr_b16 v[140:141], v219 offset:49152
    v_mfma_f32_16x16x32_bf16 v[108:111], v[148:151], a[92:95], v[108:111]
    ds_read_b64_tr_b16 v[142:143], v219 offset:51200
    v_mfma_f32_16x16x32_bf16 v[16:19], v[152:155], a[80:83], v[16:19]
    buffer_load_dwordx4 a[68:71], v227, s[8:11], s35 offen offset:0 sc1
    v_mfma_f32_16x16x32_bf16 v[20:23], v[152:155], a[84:87], v[20:23]
    v_mfma_f32_16x16x32_bf16 v[112:115], v[152:155], a[88:91], v[112:115]
    v_mfma_f32_16x16x32_bf16 v[116:119], v[152:155], a[92:95], v[116:119]
    v_mfma_f32_16x16x32_bf16 v[24:27], v[156:159], a[80:83], v[24:27]
    buffer_load_dwordx4 a[72:75], v245, s[8:11], s35 offen offset:0 sc1
    v_mfma_f32_16x16x32_bf16 v[28:31], v[156:159], a[84:87], v[28:31]
    s_mov_b32 s32, 49152
    buffer_load_dwordx4 v[204:207], v229, s[16:19], s32 offen
    v_mfma_f32_16x16x32_bf16 v[120:123], v[156:159], a[88:91], v[120:123]
    v_mfma_f32_16x16x32_bf16 v[124:127], v[156:159], a[92:95], v[124:127]
    s_waitcnt vmcnt(40) lgkmcnt(0)
    v_mfma_f32_16x16x32_bf16 v[32:35], v[128:131], a[96:99], v[32:35]
    ds_read_b64_tr_b16 v[144:145], v220 offset:49152
    v_mfma_f32_16x16x32_bf16 v[36:39], v[128:131], a[100:103], v[36:39]
    ds_read_b64_tr_b16 v[146:147], v220 offset:51200
    v_mfma_f32_16x16x32_bf16 v[64:67], v[128:131], a[104:107], v[64:67]
    ds_read_b64_tr_b16 v[148:149], v221 offset:49152
    v_mfma_f32_16x16x32_bf16 v[68:71], v[128:131], a[108:111], v[68:71]
    ds_read_b64_tr_b16 v[150:151], v221 offset:51200
    v_mfma_f32_16x16x32_bf16 v[40:43], v[132:135], a[96:99], v[40:43]
    ds_read_b64_tr_b16 v[152:153], v222 offset:49152
    v_mfma_f32_16x16x32_bf16 v[44:47], v[132:135], a[100:103], v[44:47]
    ds_read_b64_tr_b16 v[154:155], v222 offset:51200
    v_mfma_f32_16x16x32_bf16 v[72:75], v[132:135], a[104:107], v[72:75]
    ds_read_b64_tr_b16 v[156:157], v223 offset:49152
    v_mfma_f32_16x16x32_bf16 v[76:79], v[132:135], a[108:111], v[76:79]
    ds_read_b64_tr_b16 v[158:159], v223 offset:51200
    v_mfma_f32_16x16x32_bf16 v[48:51], v[136:139], a[96:99], v[48:51]
    buffer_load_dwordx4 a[76:79], v246, s[8:11], s35 offen offset:0 sc1
    v_mfma_f32_16x16x32_bf16 v[52:55], v[136:139], a[100:103], v[52:55]
    v_mfma_f32_16x16x32_bf16 v[80:83], v[136:139], a[104:107], v[80:83]
    v_mfma_f32_16x16x32_bf16 v[84:87], v[136:139], a[108:111], v[84:87]
    buffer_load_dwordx4 a[80:83], v226, s[8:11], s35 offen offset:1024 sc1
    v_mfma_f32_16x16x32_bf16 v[56:59], v[140:143], a[96:99], v[56:59]
    v_mfma_f32_16x16x32_bf16 v[60:63], v[140:143], a[100:103], v[60:63]
    buffer_load_dwordx4 v[208:211], v240, s[20:23], 0 offen
    v_mfma_f32_16x16x32_bf16 v[88:91], v[140:143], a[104:107], v[88:91]
    v_mfma_f32_16x16x32_bf16 v[92:95], v[140:143], a[108:111], v[92:95]
    s_waitcnt lgkmcnt(0)
    v_mfma_f32_16x16x32_bf16 v[0:3], v[144:147], a[96:99], v[0:3]
    ds_read_b64_tr_b16 v[128:129], v216 offset:57344
    v_mfma_f32_16x16x32_bf16 v[4:7], v[144:147], a[100:103], v[4:7]
    ds_read_b64_tr_b16 v[130:131], v216 offset:59392
    v_mfma_f32_16x16x32_bf16 v[96:99], v[144:147], a[104:107], v[96:99]
    ds_read_b64_tr_b16 v[132:133], v217 offset:57344
    v_mfma_f32_16x16x32_bf16 v[100:103], v[144:147], a[108:111], v[100:103]
    ds_read_b64_tr_b16 v[134:135], v217 offset:59392
    v_mfma_f32_16x16x32_bf16 v[8:11], v[148:151], a[96:99], v[8:11]
    ds_read_b64_tr_b16 v[136:137], v218 offset:57344
    v_mfma_f32_16x16x32_bf16 v[12:15], v[148:151], a[100:103], v[12:15]
    ds_read_b64_tr_b16 v[138:139], v218 offset:59392
    v_mfma_f32_16x16x32_bf16 v[104:107], v[148:151], a[104:107], v[104:107]
    ds_read_b64_tr_b16 v[140:141], v219 offset:57344
    v_mfma_f32_16x16x32_bf16 v[108:111], v[148:151], a[108:111], v[108:111]
    ds_read_b64_tr_b16 v[142:143], v219 offset:59392
    v_mfma_f32_16x16x32_bf16 v[16:19], v[152:155], a[96:99], v[16:19]
    buffer_load_dwordx4 a[84:87], v227, s[8:11], s35 offen offset:1024 sc1
    v_mfma_f32_16x16x32_bf16 v[20:23], v[152:155], a[100:103], v[20:23]
    v_mfma_f32_16x16x32_bf16 v[112:115], v[152:155], a[104:107], v[112:115]
    v_mfma_f32_16x16x32_bf16 v[116:119], v[152:155], a[108:111], v[116:119]
    v_mfma_f32_16x16x32_bf16 v[24:27], v[156:159], a[96:99], v[24:27]
    buffer_load_dwordx4 a[88:91], v245, s[8:11], s35 offen offset:1024 sc1
    v_mfma_f32_16x16x32_bf16 v[28:31], v[156:159], a[100:103], v[28:31]
    s_mov_b32 s32, kc_tail-kc_pc0
    v_lshlrev_b32 v234, 7, v230
    buffer_load_dword v241, v234, s[56:59], s32 offen
    v_mfma_f32_16x16x32_bf16 v[120:123], v[156:159], a[104:107], v[120:123]
    v_mfma_f32_16x16x32_bf16 v[124:127], v[156:159], a[108:111], v[124:127]
    buffer_load_dwordx4 a[92:95], v246, s[8:11], s35 offen offset:1024 sc1
    s_waitcnt vmcnt(39) lgkmcnt(0)
    v_mfma_f32_16x16x32_bf16 v[32:35], v[128:131], a[112:115], v[32:35]
    ds_read_b64_tr_b16 v[144:145], v220 offset:57344
    v_mfma_f32_16x16x32_bf16 v[36:39], v[128:131], a[116:119], v[36:39]
    ds_read_b64_tr_b16 v[146:147], v220 offset:59392
    v_mfma_f32_16x16x32_bf16 v[64:67], v[128:131], a[120:123], v[64:67]
    ds_read_b64_tr_b16 v[148:149], v221 offset:57344
    v_mfma_f32_16x16x32_bf16 v[68:71], v[128:131], a[124:127], v[68:71]
    ds_read_b64_tr_b16 v[150:151], v221 offset:59392
    v_mfma_f32_16x16x32_bf16 v[40:43], v[132:135], a[112:115], v[40:43]
    ds_read_b64_tr_b16 v[152:153], v222 offset:57344
    v_mfma_f32_16x16x32_bf16 v[44:47], v[132:135], a[116:119], v[44:47]
    ds_read_b64_tr_b16 v[154:155], v222 offset:59392
    v_mfma_f32_16x16x32_bf16 v[72:75], v[132:135], a[120:123], v[72:75]
    ds_read_b64_tr_b16 v[156:157], v223 offset:57344
    v_mfma_f32_16x16x32_bf16 v[76:79], v[132:135], a[124:127], v[76:79]
    ds_read_b64_tr_b16 v[158:159], v223 offset:59392
    v_mfma_f32_16x16x32_bf16 v[48:51], v[136:139], a[112:115], v[48:51]
    buffer_load_dwordx4 a[96:99], v226, s[8:11], s35 offen offset:2048 sc1
    v_mfma_f32_16x16x32_bf16 v[52:55], v[136:139], a[116:119], v[52:55]
    v_mfma_f32_16x16x32_bf16 v[80:83], v[136:139], a[120:123], v[80:83]
    v_mfma_f32_16x16x32_bf16 v[84:87], v[136:139], a[124:127], v[84:87]
    buffer_load_dwordx4 a[100:103], v227, s[8:11], s35 offen offset:2048 sc1
    v_mfma_f32_16x16x32_bf16 v[56:59], v[140:143], a[112:115], v[56:59]
    v_mfma_f32_16x16x32_bf16 v[60:63], v[140:143], a[116:119], v[60:63]
    v_mfma_f32_16x16x32_bf16 v[88:91], v[140:143], a[120:123], v[88:91]
    v_mfma_f32_16x16x32_bf16 v[92:95], v[140:143], a[124:127], v[92:95]
    s_waitcnt vmcnt(26) lgkmcnt(0)
    s_barrier
    v_mfma_f32_16x16x32_bf16 v[0:3], v[144:147], a[112:115], v[0:3]
    v_xor_b32 v220, 0x10000, v220
    ds_read_b64_tr_b16 v[128:129], v220 offset:0
    v_mfma_f32_16x16x32_bf16 v[4:7], v[144:147], a[116:119], v[4:7]
    ds_read_b64_tr_b16 v[130:131], v220 offset:2048
    v_mfma_f32_16x16x32_bf16 v[96:99], v[144:147], a[120:123], v[96:99]
    v_xor_b32 v221, 0x10000, v221
    ds_read_b64_tr_b16 v[132:133], v221 offset:0
    v_mfma_f32_16x16x32_bf16 v[100:103], v[144:147], a[124:127], v[100:103]
    ds_read_b64_tr_b16 v[134:135], v221 offset:2048
    v_mfma_f32_16x16x32_bf16 v[8:11], v[148:151], a[112:115], v[8:11]
    v_xor_b32 v222, 0x10000, v222
    ds_read_b64_tr_b16 v[136:137], v222 offset:0
    v_mfma_f32_16x16x32_bf16 v[12:15], v[148:151], a[116:119], v[12:15]
    ds_read_b64_tr_b16 v[138:139], v222 offset:2048
    v_mfma_f32_16x16x32_bf16 v[104:107], v[148:151], a[120:123], v[104:107]
    v_xor_b32 v223, 0x10000, v223
    ds_read_b64_tr_b16 v[140:141], v223 offset:0
    v_mfma_f32_16x16x32_bf16 v[108:111], v[148:151], a[124:127], v[108:111]
    ds_read_b64_tr_b16 v[142:143], v223 offset:2048
    v_mfma_f32_16x16x32_bf16 v[16:19], v[152:155], a[112:115], v[16:19]
    buffer_load_dwordx4 a[104:107], v245, s[8:11], s35 offen offset:2048 sc1
    v_mfma_f32_16x16x32_bf16 v[20:23], v[152:155], a[116:119], v[20:23]
    v_xor_b32 v216, 0x10000, v216
    v_mfma_f32_16x16x32_bf16 v[112:115], v[152:155], a[120:123], v[112:115]
    v_xor_b32 v217, 0x10000, v217
    v_mfma_f32_16x16x32_bf16 v[116:119], v[152:155], a[124:127], v[116:119]
    v_xor_b32 v218, 0x10000, v218
    v_mfma_f32_16x16x32_bf16 v[24:27], v[156:159], a[112:115], v[24:27]
    v_xor_b32 v219, 0x10000, v219
    buffer_load_dwordx4 a[108:111], v246, s[8:11], s35 offen offset:2048 sc1
    v_mfma_f32_16x16x32_bf16 v[28:31], v[156:159], a[116:119], v[28:31]
    v_mfma_f32_16x16x32_bf16 v[120:123], v[156:159], a[120:123], v[120:123]
    v_mfma_f32_16x16x32_bf16 v[124:127], v[156:159], a[124:127], v[124:127]
    s_waitcnt vmcnt(35) lgkmcnt(4)
    v_mfma_f32_16x16x32_bf16 v[96:99], v[128:131], a[8:11], v[96:99]
    ds_read_b64_tr_b16 v[144:145], v220 offset:8192
    v_mfma_f32_16x16x32_bf16 v[100:103], v[128:131], a[12:15], v[100:103]
    ds_read_b64_tr_b16 v[146:147], v220 offset:10240
    v_mfma_f32_16x16x32_bf16 v[104:107], v[132:135], a[8:11], v[104:107]
    ds_read_b64_tr_b16 v[148:149], v221 offset:8192
    buffer_load_dwordx4 a[112:115], v226, s[8:11], s35 offen offset:3072 sc1
    v_mfma_f32_16x16x32_bf16 v[108:111], v[132:135], a[12:15], v[108:111]
    ds_read_b64_tr_b16 v[150:151], v221 offset:10240
    s_waitcnt lgkmcnt(4)
    v_mfma_f32_16x16x32_bf16 v[112:115], v[136:139], a[8:11], v[112:115]
    ds_read_b64_tr_b16 v[152:153], v222 offset:8192
    v_mfma_f32_16x16x32_bf16 v[116:119], v[136:139], a[12:15], v[116:119]
    ds_read_b64_tr_b16 v[154:155], v222 offset:10240
    v_mfma_f32_16x16x32_bf16 v[120:123], v[140:143], a[8:11], v[120:123]
    ds_read_b64_tr_b16 v[156:157], v223 offset:8192
    buffer_load_dwordx4 a[116:119], v227, s[8:11], s35 offen offset:3072 sc1
    v_mfma_f32_16x16x32_bf16 v[124:127], v[140:143], a[12:15], v[124:127]
    ds_read_b64_tr_b16 v[158:159], v223 offset:10240
    s_waitcnt vmcnt(31) lgkmcnt(4)
    v_mfma_f32_16x16x32_bf16 v[96:99], v[144:147], a[24:27], v[96:99]
    ds_read_b64_tr_b16 v[128:129], v220 offset:16384
    v_mfma_f32_16x16x32_bf16 v[100:103], v[144:147], a[28:31], v[100:103]
    ds_read_b64_tr_b16 v[130:131], v220 offset:18432
    v_mfma_f32_16x16x32_bf16 v[104:107], v[148:151], a[24:27], v[104:107]
    ds_read_b64_tr_b16 v[132:133], v221 offset:16384
    buffer_load_dwordx4 a[120:123], v245, s[8:11], s35 offen offset:3072 sc1
    v_mfma_f32_16x16x32_bf16 v[108:111], v[148:151], a[28:31], v[108:111]
    ds_read_b64_tr_b16 v[134:135], v221 offset:18432
    s_waitcnt lgkmcnt(4)
    v_mfma_f32_16x16x32_bf16 v[112:115], v[152:155], a[24:27], v[112:115]
    ds_read_b64_tr_b16 v[136:137], v222 offset:16384
    v_mfma_f32_16x16x32_bf16 v[116:119], v[152:155], a[28:31], v[116:119]
    ds_read_b64_tr_b16 v[138:139], v222 offset:18432
    v_mfma_f32_16x16x32_bf16 v[120:123], v[156:159], a[24:27], v[120:123]
    ds_read_b64_tr_b16 v[140:141], v223 offset:16384
    buffer_load_dwordx4 a[124:127], v246, s[8:11], s35 offen offset:3072 sc1
    v_mfma_f32_16x16x32_bf16 v[124:127], v[156:159], a[28:31], v[124:127]
    ds_read_b64_tr_b16 v[142:143], v223 offset:18432
    s_waitcnt vmcnt(26) lgkmcnt(4)
    v_mfma_f32_16x16x32_bf16 v[96:99], v[128:131], a[40:43], v[96:99]
    ds_read_b64_tr_b16 v[144:145], v220 offset:24576
    v_mfma_f32_16x16x32_bf16 v[100:103], v[128:131], a[44:47], v[100:103]
    ds_read_b64_tr_b16 v[146:147], v220 offset:26624
    v_mfma_f32_16x16x32_bf16 v[104:107], v[132:135], a[40:43], v[104:107]
    ds_read_b64_tr_b16 v[148:149], v221 offset:24576
    v_mfma_f32_16x16x32_bf16 v[108:111], v[132:135], a[44:47], v[108:111]
    ds_read_b64_tr_b16 v[150:151], v221 offset:26624
    s_waitcnt lgkmcnt(4)
    v_mfma_f32_16x16x32_bf16 v[112:115], v[136:139], a[40:43], v[112:115]
    ds_read_b64_tr_b16 v[152:153], v222 offset:24576
    v_mfma_f32_16x16x32_bf16 v[116:119], v[136:139], a[44:47], v[116:119]
    ds_read_b64_tr_b16 v[154:155], v222 offset:26624
    v_mfma_f32_16x16x32_bf16 v[120:123], v[140:143], a[40:43], v[120:123]
    ds_read_b64_tr_b16 v[156:157], v223 offset:24576
    v_mfma_f32_16x16x32_bf16 v[124:127], v[140:143], a[44:47], v[124:127]
    ds_read_b64_tr_b16 v[158:159], v223 offset:26624
    s_waitcnt vmcnt(20) lgkmcnt(4)
    v_mfma_f32_16x16x32_bf16 v[96:99], v[144:147], a[56:59], v[96:99]
    ds_read_b64_tr_b16 v[128:129], v220 offset:32768
    v_mfma_f32_16x16x32_bf16 v[100:103], v[144:147], a[60:63], v[100:103]
    ds_read_b64_tr_b16 v[130:131], v220 offset:34816
    v_mfma_f32_16x16x32_bf16 v[104:107], v[148:151], a[56:59], v[104:107]
    ds_read_b64_tr_b16 v[132:133], v221 offset:32768
    v_mfma_f32_16x16x32_bf16 v[108:111], v[148:151], a[60:63], v[108:111]
    ds_read_b64_tr_b16 v[134:135], v221 offset:34816
    s_waitcnt lgkmcnt(4)
    v_mfma_f32_16x16x32_bf16 v[112:115], v[152:155], a[56:59], v[112:115]
    ds_read_b64_tr_b16 v[136:137], v222 offset:32768
    v_mfma_f32_16x16x32_bf16 v[116:119], v[152:155], a[60:63], v[116:119]
    ds_read_b64_tr_b16 v[138:139], v222 offset:34816
    v_mfma_f32_16x16x32_bf16 v[120:123], v[156:159], a[56:59], v[120:123]
    ds_read_b64_tr_b16 v[140:141], v223 offset:32768
    v_mfma_f32_16x16x32_bf16 v[124:127], v[156:159], a[60:63], v[124:127]
    ds_read_b64_tr_b16 v[142:143], v223 offset:34816
    s_waitcnt vmcnt(14) lgkmcnt(4)
    v_mfma_f32_16x16x32_bf16 v[96:99], v[128:131], a[72:75], v[96:99]
    ds_read_b64_tr_b16 v[144:145], v220 offset:40960
    v_mfma_f32_16x16x32_bf16 v[100:103], v[128:131], a[76:79], v[100:103]
    ds_read_b64_tr_b16 v[146:147], v220 offset:43008
    s_xor_b32 s7, s39, 24
    v_mfma_f32_16x16x32_bf16 v[104:107], v[132:135], a[72:75], v[104:107]
    ds_read_b64_tr_b16 v[148:149], v221 offset:40960
    v_mfma_f32_16x16x32_bf16 v[108:111], v[132:135], a[76:79], v[108:111]
    ds_read_b64_tr_b16 v[150:151], v221 offset:43008
    s_waitcnt lgkmcnt(4)
    v_mfma_f32_16x16x32_bf16 v[112:115], v[136:139], a[72:75], v[112:115]
    ds_read_b64_tr_b16 v[152:153], v222 offset:40960
    v_mfma_f32_16x16x32_bf16 v[116:119], v[136:139], a[76:79], v[116:119]
    ds_read_b64_tr_b16 v[154:155], v222 offset:43008
    s_mul_i32 s7, s7, 12288
    v_mfma_f32_16x16x32_bf16 v[120:123], v[140:143], a[72:75], v[120:123]
    ds_read_b64_tr_b16 v[156:157], v223 offset:40960
    s_add_u32 s7, s7, 0x5002000
    v_mfma_f32_16x16x32_bf16 v[124:127], v[140:143], a[76:79], v[124:127]
    ds_read_b64_tr_b16 v[158:159], v223 offset:43008
    s_waitcnt vmcnt(8) lgkmcnt(4)
    v_mfma_f32_16x16x32_bf16 v[96:99], v[144:147], a[88:91], v[96:99]
    ds_read_b64_tr_b16 v[128:129], v220 offset:49152
    v_mfma_f32_16x16x32_bf16 v[100:103], v[144:147], a[92:95], v[100:103]
    ds_read_b64_tr_b16 v[130:131], v220 offset:51200
    s_xor_b32 s37, s39, 8
    v_mfma_f32_16x16x32_bf16 v[104:107], v[148:151], a[88:91], v[104:107]
    ds_read_b64_tr_b16 v[132:133], v221 offset:49152
    v_mfma_f32_16x16x32_bf16 v[108:111], v[148:151], a[92:95], v[108:111]
    ds_read_b64_tr_b16 v[134:135], v221 offset:51200
    s_waitcnt lgkmcnt(4)
    v_mfma_f32_16x16x32_bf16 v[112:115], v[152:155], a[88:91], v[112:115]
    ds_read_b64_tr_b16 v[136:137], v222 offset:49152
    v_mfma_f32_16x16x32_bf16 v[116:119], v[152:155], a[92:95], v[116:119]
    ds_read_b64_tr_b16 v[138:139], v222 offset:51200
    s_mul_i32 s37, s37, 12288
    v_mfma_f32_16x16x32_bf16 v[120:123], v[156:159], a[88:91], v[120:123]
    ds_read_b64_tr_b16 v[140:141], v223 offset:49152
    s_add_u32 s37, s37, 0x5000000
    v_mfma_f32_16x16x32_bf16 v[124:127], v[156:159], a[92:95], v[124:127]
    ds_read_b64_tr_b16 v[142:143], v223 offset:51200
    s_waitcnt vmcnt(4) lgkmcnt(4)
    v_mfma_f32_16x16x32_bf16 v[96:99], v[128:131], a[104:107], v[96:99]
    ds_read_b64_tr_b16 v[144:145], v220 offset:57344
    v_mfma_f32_16x16x32_bf16 v[100:103], v[128:131], a[108:111], v[100:103]
    ds_read_b64_tr_b16 v[146:147], v220 offset:59392
    s_xor_b32 s38, s39, 16
    v_mfma_f32_16x16x32_bf16 v[104:107], v[132:135], a[104:107], v[104:107]
    ds_read_b64_tr_b16 v[148:149], v221 offset:57344
    v_mfma_f32_16x16x32_bf16 v[108:111], v[132:135], a[108:111], v[108:111]
    ds_read_b64_tr_b16 v[150:151], v221 offset:59392
    s_waitcnt lgkmcnt(4)
    v_mfma_f32_16x16x32_bf16 v[112:115], v[136:139], a[104:107], v[112:115]
    ds_read_b64_tr_b16 v[152:153], v222 offset:57344
    v_mfma_f32_16x16x32_bf16 v[116:119], v[136:139], a[108:111], v[116:119]
    ds_read_b64_tr_b16 v[154:155], v222 offset:59392
    s_mul_i32 s38, s38, 12288
    v_mfma_f32_16x16x32_bf16 v[120:123], v[140:143], a[104:107], v[120:123]
    ds_read_b64_tr_b16 v[156:157], v223 offset:57344
    s_add_u32 s38, s38, 0x5001000
    v_mfma_f32_16x16x32_bf16 v[124:127], v[140:143], a[108:111], v[124:127]
    ds_read_b64_tr_b16 v[158:159], v223 offset:59392
    s_waitcnt vmcnt(0) lgkmcnt(4)
    v_mfma_f32_16x16x32_bf16 v[96:99], v[144:147], a[120:123], v[96:99]
    ds_read_b64_tr_b16 v[128:129], v220 offset:0
    v_mfma_f32_16x16x32_bf16 v[100:103], v[144:147], a[124:127], v[100:103]
    ds_read_b64_tr_b16 v[130:131], v220 offset:2048
    v_mfma_f32_16x16x32_bf16 v[104:107], v[148:151], a[120:123], v[104:107]
    ds_read_b64_tr_b16 v[132:133], v221 offset:0
    v_mfma_f32_16x16x32_bf16 v[108:111], v[148:151], a[124:127], v[108:111]
    ds_read_b64_tr_b16 v[134:135], v221 offset:2048
    s_waitcnt lgkmcnt(4)
    v_mfma_f32_16x16x32_bf16 v[112:115], v[152:155], a[120:123], v[112:115]
    ds_read_b64_tr_b16 v[136:137], v222 offset:0
    v_mfma_f32_16x16x32_bf16 v[116:119], v[152:155], a[124:127], v[116:119]
    ds_read_b64_tr_b16 v[138:139], v222 offset:2048
    v_mfma_f32_16x16x32_bf16 v[120:123], v[156:159], a[120:123], v[120:123]
    ds_read_b64_tr_b16 v[140:141], v223 offset:0
    v_mfma_f32_16x16x32_bf16 v[124:127], v[156:159], a[124:127], v[124:127]
    ds_read_b64_tr_b16 v[142:143], v223 offset:2048
    s_waitcnt lgkmcnt(4)
    v_mfma_f32_16x16x32_bf16 v[0:3], v[128:131], a[0:3], v[0:3]
    ds_read_b64_tr_b16 v[144:145], v220 offset:8192
    v_mfma_f32_16x16x32_bf16 v[4:7], v[128:131], a[4:7], v[4:7]
    ds_read_b64_tr_b16 v[146:147], v220 offset:10240
    v_mfma_f32_16x16x32_bf16 v[8:11], v[132:135], a[0:3], v[8:11]
    ds_read_b64_tr_b16 v[148:149], v221 offset:8192
    v_mfma_f32_16x16x32_bf16 v[12:15], v[132:135], a[4:7], v[12:15]
    ds_read_b64_tr_b16 v[150:151], v221 offset:10240
    s_waitcnt lgkmcnt(4)
    v_mfma_f32_16x16x32_bf16 v[16:19], v[136:139], a[0:3], v[16:19]
    ds_read_b64_tr_b16 v[152:153], v222 offset:8192
    v_mfma_f32_16x16x32_bf16 v[20:23], v[136:139], a[4:7], v[20:23]
    ds_read_b64_tr_b16 v[154:155], v222 offset:10240
    v_mfma_f32_16x16x32_bf16 v[24:27], v[140:143], a[0:3], v[24:27]
    ds_read_b64_tr_b16 v[156:157], v223 offset:8192
    v_mfma_f32_16x16x32_bf16 v[28:31], v[140:143], a[4:7], v[28:31]
    ds_read_b64_tr_b16 v[158:159], v223 offset:10240
    s_waitcnt lgkmcnt(4)
    v_mfma_f32_16x16x32_bf16 v[0:3], v[144:147], a[16:19], v[0:3]
    ds_read_b64_tr_b16 v[128:129], v220 offset:16384
    s_mul_i32 s33, s39, 12288
    s_add_u32 s33, s33, 0x5002000
    v_mfma_f32_16x16x32_bf16 v[4:7], v[144:147], a[20:23], v[4:7]
    ds_read_b64_tr_b16 v[130:131], v220 offset:18432
    v_mfma_f32_16x16x32_bf16 v[8:11], v[148:151], a[16:19], v[8:11]
    ds_read_b64_tr_b16 v[132:133], v221 offset:16384
    v_cvt_pk_bf16_f32 v96, v96, v97
    v_mfma_f32_16x16x32_bf16 v[12:15], v[148:151], a[20:23], v[12:15]
    ds_read_b64_tr_b16 v[134:135], v221 offset:18432
    v_cvt_pk_bf16_f32 v97, v98, v99
    s_waitcnt lgkmcnt(4)
    v_mfma_f32_16x16x32_bf16 v[16:19], v[152:155], a[16:19], v[16:19]
    ds_read_b64_tr_b16 v[136:137], v222 offset:16384
    v_cvt_pk_bf16_f32 v98, v100, v101
    v_mfma_f32_16x16x32_bf16 v[20:23], v[152:155], a[20:23], v[20:23]
    ds_read_b64_tr_b16 v[138:139], v222 offset:18432
    v_cvt_pk_bf16_f32 v99, v102, v103
    v_mfma_f32_16x16x32_bf16 v[24:27], v[156:159], a[16:19], v[24:27]
    ds_read_b64_tr_b16 v[140:141], v223 offset:16384
    v_min_u32_e64 v96, -2, v96
    v_mfma_f32_16x16x32_bf16 v[28:31], v[156:159], a[20:23], v[28:31]
    ds_read_b64_tr_b16 v[142:143], v223 offset:18432
    v_min_u32 v97, -2, v97
    s_waitcnt lgkmcnt(4)
    v_mfma_f32_16x16x32_bf16 v[0:3], v[128:131], a[32:35], v[0:3]
    ds_read_b64_tr_b16 v[144:145], v220 offset:24576
    v_min_u32_e64 v98, -2, v98
    v_mfma_f32_16x16x32_bf16 v[4:7], v[128:131], a[36:39], v[4:7]
    ds_read_b64_tr_b16 v[146:147], v220 offset:26624
    v_min_u32_e64 v99, -2, v99
    v_mfma_f32_16x16x32_bf16 v[8:11], v[132:135], a[32:35], v[8:11]
    ds_read_b64_tr_b16 v[148:149], v221 offset:24576
    buffer_store_dwordx4 v[96:99], v228, s[8:11], s33 offen offset:0 sc1
    v_mfma_f32_16x16x32_bf16 v[12:15], v[132:135], a[36:39], v[12:15]
    ds_read_b64_tr_b16 v[150:151], v221 offset:26624
    s_waitcnt lgkmcnt(4)
    v_mfma_f32_16x16x32_bf16 v[16:19], v[136:139], a[32:35], v[16:19]
    ds_read_b64_tr_b16 v[152:153], v222 offset:24576
    v_mfma_f32_16x16x32_bf16 v[20:23], v[136:139], a[36:39], v[20:23]
    ds_read_b64_tr_b16 v[154:155], v222 offset:26624
    v_mfma_f32_16x16x32_bf16 v[24:27], v[140:143], a[32:35], v[24:27]
    ds_read_b64_tr_b16 v[156:157], v223 offset:24576
    v_cvt_pk_bf16_f32 v100, v104, v105
    v_mfma_f32_16x16x32_bf16 v[28:31], v[140:143], a[36:39], v[28:31]
    ds_read_b64_tr_b16 v[158:159], v223 offset:26624
    v_cvt_pk_bf16_f32 v101, v106, v107
    s_waitcnt lgkmcnt(4)
    v_mfma_f32_16x16x32_bf16 v[0:3], v[144:147], a[48:51], v[0:3]
    ds_read_b64_tr_b16 v[128:129], v220 offset:32768
    v_cvt_pk_bf16_f32 v102, v108, v109
    v_mfma_f32_16x16x32_bf16 v[4:7], v[144:147], a[52:55], v[4:7]
    ds_read_b64_tr_b16 v[130:131], v220 offset:34816
    v_cvt_pk_bf16_f32 v103, v110, v111
    v_mfma_f32_16x16x32_bf16 v[8:11], v[148:151], a[48:51], v[8:11]
    ds_read_b64_tr_b16 v[132:133], v221 offset:32768
    v_min_u32_e64 v100, -2, v100
    v_mfma_f32_16x16x32_bf16 v[12:15], v[148:151], a[52:55], v[12:15]
    ds_read_b64_tr_b16 v[134:135], v221 offset:34816
    v_min_u32 v101, -2, v101
    s_waitcnt lgkmcnt(4)
    v_mfma_f32_16x16x32_bf16 v[16:19], v[152:155], a[48:51], v[16:19]
    ds_read_b64_tr_b16 v[136:137], v222 offset:32768
    v_min_u32_e64 v102, -2, v102
    v_mfma_f32_16x16x32_bf16 v[20:23], v[152:155], a[52:55], v[20:23]
    ds_read_b64_tr_b16 v[138:139], v222 offset:34816
    v_min_u32_e64 v103, -2, v103
    v_mfma_f32_16x16x32_bf16 v[24:27], v[156:159], a[48:51], v[24:27]
    ds_read_b64_tr_b16 v[140:141], v223 offset:32768
    buffer_store_dwordx4 v[100:103], v228, s[8:11], s33 offen offset:1024 sc1
    v_mfma_f32_16x16x32_bf16 v[28:31], v[156:159], a[52:55], v[28:31]
    ds_read_b64_tr_b16 v[142:143], v223 offset:34816
    s_waitcnt lgkmcnt(4)
    v_mfma_f32_16x16x32_bf16 v[0:3], v[128:131], a[64:67], v[0:3]
    ds_read_b64_tr_b16 v[144:145], v220 offset:40960
    v_mfma_f32_16x16x32_bf16 v[4:7], v[128:131], a[68:71], v[4:7]
    ds_read_b64_tr_b16 v[146:147], v220 offset:43008
    v_mfma_f32_16x16x32_bf16 v[8:11], v[132:135], a[64:67], v[8:11]
    ds_read_b64_tr_b16 v[148:149], v221 offset:40960
    v_cvt_pk_bf16_f32 v104, v112, v113
    v_mfma_f32_16x16x32_bf16 v[12:15], v[132:135], a[68:71], v[12:15]
    ds_read_b64_tr_b16 v[150:151], v221 offset:43008
    v_cvt_pk_bf16_f32 v105, v114, v115
    s_waitcnt lgkmcnt(4)
    v_mfma_f32_16x16x32_bf16 v[16:19], v[136:139], a[64:67], v[16:19]
    ds_read_b64_tr_b16 v[152:153], v222 offset:40960
    v_cvt_pk_bf16_f32 v106, v116, v117
    v_mfma_f32_16x16x32_bf16 v[20:23], v[136:139], a[68:71], v[20:23]
    ds_read_b64_tr_b16 v[154:155], v222 offset:43008
    v_cvt_pk_bf16_f32 v107, v118, v119
    v_mfma_f32_16x16x32_bf16 v[24:27], v[140:143], a[64:67], v[24:27]
    ds_read_b64_tr_b16 v[156:157], v223 offset:40960
    v_min_u32_e64 v104, -2, v104
    v_mfma_f32_16x16x32_bf16 v[28:31], v[140:143], a[68:71], v[28:31]
    ds_read_b64_tr_b16 v[158:159], v223 offset:43008
    v_min_u32 v105, -2, v105
    s_waitcnt lgkmcnt(4)
    v_mfma_f32_16x16x32_bf16 v[0:3], v[144:147], a[80:83], v[0:3]
    ds_read_b64_tr_b16 v[128:129], v220 offset:49152
    v_min_u32_e64 v106, -2, v106
    v_mfma_f32_16x16x32_bf16 v[4:7], v[144:147], a[84:87], v[4:7]
    ds_read_b64_tr_b16 v[130:131], v220 offset:51200
    v_min_u32_e64 v107, -2, v107
    v_mfma_f32_16x16x32_bf16 v[8:11], v[148:151], a[80:83], v[8:11]
    ds_read_b64_tr_b16 v[132:133], v221 offset:49152
    buffer_store_dwordx4 v[104:107], v228, s[8:11], s33 offen offset:2048 sc1
    v_mfma_f32_16x16x32_bf16 v[12:15], v[148:151], a[84:87], v[12:15]
    ds_read_b64_tr_b16 v[134:135], v221 offset:51200
    s_waitcnt lgkmcnt(4)
    v_mfma_f32_16x16x32_bf16 v[16:19], v[152:155], a[80:83], v[16:19]
    ds_read_b64_tr_b16 v[136:137], v222 offset:49152
    v_mfma_f32_16x16x32_bf16 v[20:23], v[152:155], a[84:87], v[20:23]
    ds_read_b64_tr_b16 v[138:139], v222 offset:51200
    v_mfma_f32_16x16x32_bf16 v[24:27], v[156:159], a[80:83], v[24:27]
    ds_read_b64_tr_b16 v[140:141], v223 offset:49152
    v_cvt_pk_bf16_f32 v108, v120, v121
    v_mfma_f32_16x16x32_bf16 v[28:31], v[156:159], a[84:87], v[28:31]
    ds_read_b64_tr_b16 v[142:143], v223 offset:51200
    v_cvt_pk_bf16_f32 v109, v122, v123
    s_waitcnt lgkmcnt(4)
    v_mfma_f32_16x16x32_bf16 v[0:3], v[128:131], a[96:99], v[0:3]
    ds_read_b64_tr_b16 v[144:145], v220 offset:57344
    v_cvt_pk_bf16_f32 v110, v124, v125
    v_mfma_f32_16x16x32_bf16 v[4:7], v[128:131], a[100:103], v[4:7]
    ds_read_b64_tr_b16 v[146:147], v220 offset:59392
    v_cvt_pk_bf16_f32 v111, v126, v127
    v_mfma_f32_16x16x32_bf16 v[8:11], v[132:135], a[96:99], v[8:11]
    ds_read_b64_tr_b16 v[148:149], v221 offset:57344
    v_min_u32_e64 v108, -2, v108
    v_mfma_f32_16x16x32_bf16 v[12:15], v[132:135], a[100:103], v[12:15]
    ds_read_b64_tr_b16 v[150:151], v221 offset:59392
    v_min_u32 v109, -2, v109
    s_waitcnt lgkmcnt(4)
    v_mfma_f32_16x16x32_bf16 v[16:19], v[136:139], a[96:99], v[16:19]
    ds_read_b64_tr_b16 v[152:153], v222 offset:57344
    v_min_u32_e64 v110, -2, v110
    v_mfma_f32_16x16x32_bf16 v[20:23], v[136:139], a[100:103], v[20:23]
    ds_read_b64_tr_b16 v[154:155], v222 offset:59392
    v_min_u32_e64 v111, -2, v111
    v_mfma_f32_16x16x32_bf16 v[24:27], v[140:143], a[96:99], v[24:27]
    ds_read_b64_tr_b16 v[156:157], v223 offset:57344
    buffer_store_dwordx4 v[108:111], v228, s[8:11], s33 offen offset:3072 sc1
    v_mfma_f32_16x16x32_bf16 v[28:31], v[140:143], a[100:103], v[28:31]
    ds_read_b64_tr_b16 v[158:159], v223 offset:59392
    s_waitcnt lgkmcnt(4)
    v_mfma_f32_16x16x32_bf16 v[0:3], v[144:147], a[112:115], v[0:3]
    ds_read_b64_tr_b16 v[128:129], v216 offset:0
    v_mfma_f32_16x16x32_bf16 v[4:7], v[144:147], a[116:119], v[4:7]
    ds_read_b64_tr_b16 v[130:131], v216 offset:2048
    v_mfma_f32_16x16x32_bf16 v[8:11], v[148:151], a[112:115], v[8:11]
    ds_read_b64_tr_b16 v[132:133], v217 offset:0
    v_mfma_f32_16x16x32_bf16 v[12:15], v[148:151], a[116:119], v[12:15]
    ds_read_b64_tr_b16 v[134:135], v217 offset:2048
    s_waitcnt lgkmcnt(4)
    v_mfma_f32_16x16x32_bf16 v[16:19], v[152:155], a[112:115], v[16:19]
    ds_read_b64_tr_b16 v[136:137], v218 offset:0
    v_mfma_f32_16x16x32_bf16 v[20:23], v[152:155], a[116:119], v[20:23]
    ds_read_b64_tr_b16 v[138:139], v218 offset:2048
    v_mfma_f32_16x16x32_bf16 v[24:27], v[156:159], a[112:115], v[24:27]
    ds_read_b64_tr_b16 v[140:141], v219 offset:0
    v_mfma_f32_16x16x32_bf16 v[28:31], v[156:159], a[116:119], v[28:31]
    ds_read_b64_tr_b16 v[142:143], v219 offset:2048
    s_waitcnt lgkmcnt(4)
    v_mfma_f32_16x16x32_bf16 v[64:67], v[128:131], a[8:11], v[64:67]
    ds_read_b64_tr_b16 v[144:145], v216 offset:8192
    v_mfma_f32_16x16x32_bf16 v[68:71], v[128:131], a[12:15], v[68:71]
    ds_read_b64_tr_b16 v[146:147], v216 offset:10240
    v_mfma_f32_16x16x32_bf16 v[72:75], v[132:135], a[8:11], v[72:75]
    ds_read_b64_tr_b16 v[148:149], v217 offset:8192
    v_mfma_f32_16x16x32_bf16 v[76:79], v[132:135], a[12:15], v[76:79]
    ds_read_b64_tr_b16 v[150:151], v217 offset:10240
    s_waitcnt lgkmcnt(4)
    v_mfma_f32_16x16x32_bf16 v[80:83], v[136:139], a[8:11], v[80:83]
    ds_read_b64_tr_b16 v[152:153], v218 offset:8192
    v_mfma_f32_16x16x32_bf16 v[84:87], v[136:139], a[12:15], v[84:87]
    ds_read_b64_tr_b16 v[154:155], v218 offset:10240
    v_mfma_f32_16x16x32_bf16 v[88:91], v[140:143], a[8:11], v[88:91]
    ds_read_b64_tr_b16 v[156:157], v219 offset:8192
    v_mfma_f32_16x16x32_bf16 v[92:95], v[140:143], a[12:15], v[92:95]
    ds_read_b64_tr_b16 v[158:159], v219 offset:10240
    s_waitcnt lgkmcnt(4)
    v_mfma_f32_16x16x32_bf16 v[64:67], v[144:147], a[24:27], v[64:67]
    ds_read_b64_tr_b16 v[128:129], v216 offset:16384
    s_mul_i32 s33, s39, 12288
    s_add_u32 s33, s33, 0x5000000
    v_mfma_f32_16x16x32_bf16 v[68:71], v[144:147], a[28:31], v[68:71]
    ds_read_b64_tr_b16 v[130:131], v216 offset:18432
    v_mfma_f32_16x16x32_bf16 v[72:75], v[148:151], a[24:27], v[72:75]
    ds_read_b64_tr_b16 v[132:133], v217 offset:16384
    v_cvt_pk_bf16_f32 v0, v0, v1
    v_mfma_f32_16x16x32_bf16 v[76:79], v[148:151], a[28:31], v[76:79]
    ds_read_b64_tr_b16 v[134:135], v217 offset:18432
    v_cvt_pk_bf16_f32 v1, v2, v3
    s_waitcnt lgkmcnt(4)
    v_mfma_f32_16x16x32_bf16 v[80:83], v[152:155], a[24:27], v[80:83]
    ds_read_b64_tr_b16 v[136:137], v218 offset:16384
    v_cvt_pk_bf16_f32 v2, v4, v5
    v_mfma_f32_16x16x32_bf16 v[84:87], v[152:155], a[28:31], v[84:87]
    ds_read_b64_tr_b16 v[138:139], v218 offset:18432
    v_cvt_pk_bf16_f32 v3, v6, v7
    v_mfma_f32_16x16x32_bf16 v[88:91], v[156:159], a[24:27], v[88:91]
    ds_read_b64_tr_b16 v[140:141], v219 offset:16384
    v_min_u32_e64 v0, -2, v0
    v_mfma_f32_16x16x32_bf16 v[92:95], v[156:159], a[28:31], v[92:95]
    ds_read_b64_tr_b16 v[142:143], v219 offset:18432
    v_min_u32 v1, -2, v1
    s_waitcnt lgkmcnt(4)
    v_mfma_f32_16x16x32_bf16 v[64:67], v[128:131], a[40:43], v[64:67]
    ds_read_b64_tr_b16 v[144:145], v216 offset:24576
    v_min_u32_e64 v2, -2, v2
    v_mfma_f32_16x16x32_bf16 v[68:71], v[128:131], a[44:47], v[68:71]
    ds_read_b64_tr_b16 v[146:147], v216 offset:26624
    v_min_u32_e64 v3, -2, v3
    v_mfma_f32_16x16x32_bf16 v[72:75], v[132:135], a[40:43], v[72:75]
    ds_read_b64_tr_b16 v[148:149], v217 offset:24576
    buffer_store_dwordx4 v[0:3], v228, s[8:11], s33 offen offset:0 sc1
    v_mfma_f32_16x16x32_bf16 v[76:79], v[132:135], a[44:47], v[76:79]
    ds_read_b64_tr_b16 v[150:151], v217 offset:26624
    s_waitcnt lgkmcnt(4)
    v_mfma_f32_16x16x32_bf16 v[80:83], v[136:139], a[40:43], v[80:83]
    ds_read_b64_tr_b16 v[152:153], v218 offset:24576
    v_mfma_f32_16x16x32_bf16 v[84:87], v[136:139], a[44:47], v[84:87]
    ds_read_b64_tr_b16 v[154:155], v218 offset:26624
    v_mfma_f32_16x16x32_bf16 v[88:91], v[140:143], a[40:43], v[88:91]
    ds_read_b64_tr_b16 v[156:157], v219 offset:24576
    v_cvt_pk_bf16_f32 v4, v8, v9
    v_mfma_f32_16x16x32_bf16 v[92:95], v[140:143], a[44:47], v[92:95]
    ds_read_b64_tr_b16 v[158:159], v219 offset:26624
    v_cvt_pk_bf16_f32 v5, v10, v11
    s_waitcnt lgkmcnt(4)
    v_mfma_f32_16x16x32_bf16 v[64:67], v[144:147], a[56:59], v[64:67]
    ds_read_b64_tr_b16 v[128:129], v216 offset:32768
    v_cvt_pk_bf16_f32 v6, v12, v13
    v_mfma_f32_16x16x32_bf16 v[68:71], v[144:147], a[60:63], v[68:71]
    ds_read_b64_tr_b16 v[130:131], v216 offset:34816
    v_cvt_pk_bf16_f32 v7, v14, v15
    v_mfma_f32_16x16x32_bf16 v[72:75], v[148:151], a[56:59], v[72:75]
    ds_read_b64_tr_b16 v[132:133], v217 offset:32768
    v_min_u32_e64 v4, -2, v4
    v_mfma_f32_16x16x32_bf16 v[76:79], v[148:151], a[60:63], v[76:79]
    ds_read_b64_tr_b16 v[134:135], v217 offset:34816
    v_min_u32 v5, -2, v5
    s_waitcnt lgkmcnt(4)
    v_mfma_f32_16x16x32_bf16 v[80:83], v[152:155], a[56:59], v[80:83]
    ds_read_b64_tr_b16 v[136:137], v218 offset:32768
    v_min_u32_e64 v6, -2, v6
    v_mfma_f32_16x16x32_bf16 v[84:87], v[152:155], a[60:63], v[84:87]
    ds_read_b64_tr_b16 v[138:139], v218 offset:34816
    v_min_u32_e64 v7, -2, v7
    v_mfma_f32_16x16x32_bf16 v[88:91], v[156:159], a[56:59], v[88:91]
    ds_read_b64_tr_b16 v[140:141], v219 offset:32768
    buffer_store_dwordx4 v[4:7], v228, s[8:11], s33 offen offset:1024 sc1
    v_mfma_f32_16x16x32_bf16 v[92:95], v[156:159], a[60:63], v[92:95]
    ds_read_b64_tr_b16 v[142:143], v219 offset:34816
    s_waitcnt lgkmcnt(4)
    v_mfma_f32_16x16x32_bf16 v[64:67], v[128:131], a[72:75], v[64:67]
    ds_read_b64_tr_b16 v[144:145], v216 offset:40960
    v_mfma_f32_16x16x32_bf16 v[68:71], v[128:131], a[76:79], v[68:71]
    ds_read_b64_tr_b16 v[146:147], v216 offset:43008
    v_mfma_f32_16x16x32_bf16 v[72:75], v[132:135], a[72:75], v[72:75]
    ds_read_b64_tr_b16 v[148:149], v217 offset:40960
    v_cvt_pk_bf16_f32 v8, v16, v17
    v_mfma_f32_16x16x32_bf16 v[76:79], v[132:135], a[76:79], v[76:79]
    ds_read_b64_tr_b16 v[150:151], v217 offset:43008
    v_cvt_pk_bf16_f32 v9, v18, v19
    s_waitcnt lgkmcnt(4)
    v_mfma_f32_16x16x32_bf16 v[80:83], v[136:139], a[72:75], v[80:83]
    ds_read_b64_tr_b16 v[152:153], v218 offset:40960
    v_cvt_pk_bf16_f32 v10, v20, v21
    v_mfma_f32_16x16x32_bf16 v[84:87], v[136:139], a[76:79], v[84:87]
    ds_read_b64_tr_b16 v[154:155], v218 offset:43008
    v_cvt_pk_bf16_f32 v11, v22, v23
    v_mfma_f32_16x16x32_bf16 v[88:91], v[140:143], a[72:75], v[88:91]
    ds_read_b64_tr_b16 v[156:157], v219 offset:40960
    v_min_u32_e64 v8, -2, v8
    v_mfma_f32_16x16x32_bf16 v[92:95], v[140:143], a[76:79], v[92:95]
    ds_read_b64_tr_b16 v[158:159], v219 offset:43008
    v_min_u32 v9, -2, v9
    s_waitcnt lgkmcnt(4)
    v_mfma_f32_16x16x32_bf16 v[64:67], v[144:147], a[88:91], v[64:67]
    ds_read_b64_tr_b16 v[128:129], v216 offset:49152
    v_min_u32_e64 v10, -2, v10
    v_mfma_f32_16x16x32_bf16 v[68:71], v[144:147], a[92:95], v[68:71]
    ds_read_b64_tr_b16 v[130:131], v216 offset:51200
    v_min_u32_e64 v11, -2, v11
    v_mfma_f32_16x16x32_bf16 v[72:75], v[148:151], a[88:91], v[72:75]
    ds_read_b64_tr_b16 v[132:133], v217 offset:49152
    buffer_store_dwordx4 v[8:11], v228, s[8:11], s33 offen offset:2048 sc1
    v_mfma_f32_16x16x32_bf16 v[76:79], v[148:151], a[92:95], v[76:79]
    ds_read_b64_tr_b16 v[134:135], v217 offset:51200
    s_waitcnt lgkmcnt(4)
    v_mfma_f32_16x16x32_bf16 v[80:83], v[152:155], a[88:91], v[80:83]
    ds_read_b64_tr_b16 v[136:137], v218 offset:49152
    v_mfma_f32_16x16x32_bf16 v[84:87], v[152:155], a[92:95], v[84:87]
    ds_read_b64_tr_b16 v[138:139], v218 offset:51200
    v_mfma_f32_16x16x32_bf16 v[88:91], v[156:159], a[88:91], v[88:91]
    ds_read_b64_tr_b16 v[140:141], v219 offset:49152
    v_cvt_pk_bf16_f32 v12, v24, v25
    v_mfma_f32_16x16x32_bf16 v[92:95], v[156:159], a[92:95], v[92:95]
    ds_read_b64_tr_b16 v[142:143], v219 offset:51200
    v_cvt_pk_bf16_f32 v13, v26, v27
    s_waitcnt lgkmcnt(4)
    v_mfma_f32_16x16x32_bf16 v[64:67], v[128:131], a[104:107], v[64:67]
    ds_read_b64_tr_b16 v[144:145], v216 offset:57344
    v_cvt_pk_bf16_f32 v14, v28, v29
    v_mfma_f32_16x16x32_bf16 v[68:71], v[128:131], a[108:111], v[68:71]
    ds_read_b64_tr_b16 v[146:147], v216 offset:59392
    v_cvt_pk_bf16_f32 v15, v30, v31
    v_mfma_f32_16x16x32_bf16 v[72:75], v[132:135], a[104:107], v[72:75]
    ds_read_b64_tr_b16 v[148:149], v217 offset:57344
    v_min_u32_e64 v12, -2, v12
    v_mfma_f32_16x16x32_bf16 v[76:79], v[132:135], a[108:111], v[76:79]
    ds_read_b64_tr_b16 v[150:151], v217 offset:59392
    v_min_u32 v13, -2, v13
    s_waitcnt lgkmcnt(4)
    v_mfma_f32_16x16x32_bf16 v[80:83], v[136:139], a[104:107], v[80:83]
    ds_read_b64_tr_b16 v[152:153], v218 offset:57344
    v_min_u32_e64 v14, -2, v14
    v_mfma_f32_16x16x32_bf16 v[84:87], v[136:139], a[108:111], v[84:87]
    ds_read_b64_tr_b16 v[154:155], v218 offset:59392
    v_min_u32_e64 v15, -2, v15
    v_mfma_f32_16x16x32_bf16 v[88:91], v[140:143], a[104:107], v[88:91]
    ds_read_b64_tr_b16 v[156:157], v219 offset:57344
    buffer_store_dwordx4 v[12:15], v228, s[8:11], s33 offen offset:3072 sc1
    v_mfma_f32_16x16x32_bf16 v[92:95], v[140:143], a[108:111], v[92:95]
    ds_read_b64_tr_b16 v[158:159], v219 offset:59392
    s_waitcnt lgkmcnt(4)
    v_mfma_f32_16x16x32_bf16 v[64:67], v[144:147], a[120:123], v[64:67]
    ds_read_b64_tr_b16 v[128:129], v216 offset:0
    v_mfma_f32_16x16x32_bf16 v[68:71], v[144:147], a[124:127], v[68:71]
    ds_read_b64_tr_b16 v[130:131], v216 offset:2048
    v_mfma_f32_16x16x32_bf16 v[72:75], v[148:151], a[120:123], v[72:75]
    ds_read_b64_tr_b16 v[132:133], v217 offset:0
    v_mfma_f32_16x16x32_bf16 v[76:79], v[148:151], a[124:127], v[76:79]
    ds_read_b64_tr_b16 v[134:135], v217 offset:2048
    s_waitcnt lgkmcnt(4)
    v_mfma_f32_16x16x32_bf16 v[80:83], v[152:155], a[120:123], v[80:83]
    ds_read_b64_tr_b16 v[136:137], v218 offset:0
    v_mfma_f32_16x16x32_bf16 v[84:87], v[152:155], a[124:127], v[84:87]
    ds_read_b64_tr_b16 v[138:139], v218 offset:2048
    v_mfma_f32_16x16x32_bf16 v[88:91], v[156:159], a[120:123], v[88:91]
    ds_read_b64_tr_b16 v[140:141], v219 offset:0
    v_mfma_f32_16x16x32_bf16 v[92:95], v[156:159], a[124:127], v[92:95]
    ds_read_b64_tr_b16 v[142:143], v219 offset:2048
    s_waitcnt lgkmcnt(4)
    v_mfma_f32_16x16x32_bf16 v[32:35], v[128:131], a[0:3], v[32:35]
    ds_read_b64_tr_b16 v[144:145], v216 offset:8192
    v_mfma_f32_16x16x32_bf16 v[36:39], v[128:131], a[4:7], v[36:39]
    ds_read_b64_tr_b16 v[146:147], v216 offset:10240
    buffer_load_dwordx4 v[176:179], v228, s[8:11], s7 offen offset:0 sc1
    v_mfma_f32_16x16x32_bf16 v[40:43], v[132:135], a[0:3], v[40:43]
    ds_read_b64_tr_b16 v[148:149], v217 offset:8192
    v_mfma_f32_16x16x32_bf16 v[44:47], v[132:135], a[4:7], v[44:47]
    ds_read_b64_tr_b16 v[150:151], v217 offset:10240
    buffer_load_dwordx4 v[180:183], v228, s[8:11], s7 offen offset:1024 sc1
    s_waitcnt lgkmcnt(4)
    v_mfma_f32_16x16x32_bf16 v[48:51], v[136:139], a[0:3], v[48:51]
    ds_read_b64_tr_b16 v[152:153], v218 offset:8192
    v_mfma_f32_16x16x32_bf16 v[52:55], v[136:139], a[4:7], v[52:55]
    ds_read_b64_tr_b16 v[154:155], v218 offset:10240
    buffer_load_dwordx4 v[184:187], v228, s[8:11], s7 offen offset:2048 sc1
    v_mfma_f32_16x16x32_bf16 v[56:59], v[140:143], a[0:3], v[56:59]
    ds_read_b64_tr_b16 v[156:157], v219 offset:8192
    v_mfma_f32_16x16x32_bf16 v[60:63], v[140:143], a[4:7], v[60:63]
    ds_read_b64_tr_b16 v[158:159], v219 offset:10240
    buffer_load_dwordx4 v[188:191], v228, s[8:11], s7 offen offset:3072 sc1
    s_waitcnt lgkmcnt(4)
    v_mfma_f32_16x16x32_bf16 v[32:35], v[144:147], a[16:19], v[32:35]
    ds_read_b64_tr_b16 v[128:129], v216 offset:16384
    s_mul_i32 s33, s39, 12288
    s_add_u32 s33, s33, 0x5001000
    v_mfma_f32_16x16x32_bf16 v[36:39], v[144:147], a[20:23], v[36:39]
    ds_read_b64_tr_b16 v[130:131], v216 offset:18432
    v_mfma_f32_16x16x32_bf16 v[40:43], v[148:151], a[16:19], v[40:43]
    ds_read_b64_tr_b16 v[132:133], v217 offset:16384
    v_cvt_pk_bf16_f32 v64, v64, v65
    v_mfma_f32_16x16x32_bf16 v[44:47], v[148:151], a[20:23], v[44:47]
    ds_read_b64_tr_b16 v[134:135], v217 offset:18432
    v_cvt_pk_bf16_f32 v65, v66, v67
    s_waitcnt lgkmcnt(4)
    v_mfma_f32_16x16x32_bf16 v[48:51], v[152:155], a[16:19], v[48:51]
    ds_read_b64_tr_b16 v[136:137], v218 offset:16384
    v_cvt_pk_bf16_f32 v66, v68, v69
    v_mfma_f32_16x16x32_bf16 v[52:55], v[152:155], a[20:23], v[52:55]
    ds_read_b64_tr_b16 v[138:139], v218 offset:18432
    v_cvt_pk_bf16_f32 v67, v70, v71
    v_mfma_f32_16x16x32_bf16 v[56:59], v[156:159], a[16:19], v[56:59]
    ds_read_b64_tr_b16 v[140:141], v219 offset:16384
    v_min_u32_e64 v64, -2, v64
    v_mfma_f32_16x16x32_bf16 v[60:63], v[156:159], a[20:23], v[60:63]
    ds_read_b64_tr_b16 v[142:143], v219 offset:18432
    v_min_u32 v65, -2, v65
    s_waitcnt lgkmcnt(4)
    v_mfma_f32_16x16x32_bf16 v[32:35], v[128:131], a[32:35], v[32:35]
    ds_read_b64_tr_b16 v[144:145], v216 offset:24576
    v_min_u32_e64 v66, -2, v66
    v_mfma_f32_16x16x32_bf16 v[36:39], v[128:131], a[36:39], v[36:39]
    ds_read_b64_tr_b16 v[146:147], v216 offset:26624
    v_min_u32_e64 v67, -2, v67
    v_mfma_f32_16x16x32_bf16 v[40:43], v[132:135], a[32:35], v[40:43]
    ds_read_b64_tr_b16 v[148:149], v217 offset:24576
    buffer_store_dwordx4 v[64:67], v228, s[8:11], s33 offen offset:0 sc1
    v_mfma_f32_16x16x32_bf16 v[44:47], v[132:135], a[36:39], v[44:47]
    ds_read_b64_tr_b16 v[150:151], v217 offset:26624
    s_waitcnt lgkmcnt(4)
    v_mfma_f32_16x16x32_bf16 v[48:51], v[136:139], a[32:35], v[48:51]
    ds_read_b64_tr_b16 v[152:153], v218 offset:24576
    v_mfma_f32_16x16x32_bf16 v[52:55], v[136:139], a[36:39], v[52:55]
    ds_read_b64_tr_b16 v[154:155], v218 offset:26624
    v_mfma_f32_16x16x32_bf16 v[56:59], v[140:143], a[32:35], v[56:59]
    ds_read_b64_tr_b16 v[156:157], v219 offset:24576
    v_cvt_pk_bf16_f32 v68, v72, v73
    v_mfma_f32_16x16x32_bf16 v[60:63], v[140:143], a[36:39], v[60:63]
    ds_read_b64_tr_b16 v[158:159], v219 offset:26624
    v_cvt_pk_bf16_f32 v69, v74, v75
    s_waitcnt lgkmcnt(4)
    v_mfma_f32_16x16x32_bf16 v[32:35], v[144:147], a[48:51], v[32:35]
    ds_read_b64_tr_b16 v[128:129], v216 offset:32768
    v_cvt_pk_bf16_f32 v70, v76, v77
    v_mfma_f32_16x16x32_bf16 v[36:39], v[144:147], a[52:55], v[36:39]
    ds_read_b64_tr_b16 v[130:131], v216 offset:34816
    v_cvt_pk_bf16_f32 v71, v78, v79
    v_mfma_f32_16x16x32_bf16 v[40:43], v[148:151], a[48:51], v[40:43]
    ds_read_b64_tr_b16 v[132:133], v217 offset:32768
    v_min_u32_e64 v68, -2, v68
    v_mfma_f32_16x16x32_bf16 v[44:47], v[148:151], a[52:55], v[44:47]
    ds_read_b64_tr_b16 v[134:135], v217 offset:34816
    v_min_u32 v69, -2, v69
    s_waitcnt lgkmcnt(4)
    v_mfma_f32_16x16x32_bf16 v[48:51], v[152:155], a[48:51], v[48:51]
    ds_read_b64_tr_b16 v[136:137], v218 offset:32768
    v_min_u32_e64 v70, -2, v70
    v_mfma_f32_16x16x32_bf16 v[52:55], v[152:155], a[52:55], v[52:55]
    ds_read_b64_tr_b16 v[138:139], v218 offset:34816
    v_min_u32_e64 v71, -2, v71
    v_mfma_f32_16x16x32_bf16 v[56:59], v[156:159], a[48:51], v[56:59]
    ds_read_b64_tr_b16 v[140:141], v219 offset:32768
    buffer_store_dwordx4 v[68:71], v228, s[8:11], s33 offen offset:1024 sc1
    v_mfma_f32_16x16x32_bf16 v[60:63], v[156:159], a[52:55], v[60:63]
    ds_read_b64_tr_b16 v[142:143], v219 offset:34816
    s_waitcnt lgkmcnt(4)
    v_mfma_f32_16x16x32_bf16 v[32:35], v[128:131], a[64:67], v[32:35]
    ds_read_b64_tr_b16 v[144:145], v216 offset:40960
    v_mfma_f32_16x16x32_bf16 v[36:39], v[128:131], a[68:71], v[36:39]
    ds_read_b64_tr_b16 v[146:147], v216 offset:43008
    v_mfma_f32_16x16x32_bf16 v[40:43], v[132:135], a[64:67], v[40:43]
    ds_read_b64_tr_b16 v[148:149], v217 offset:40960
    v_cvt_pk_bf16_f32 v72, v80, v81
    v_mfma_f32_16x16x32_bf16 v[44:47], v[132:135], a[68:71], v[44:47]
    ds_read_b64_tr_b16 v[150:151], v217 offset:43008
    v_cvt_pk_bf16_f32 v73, v82, v83
    s_waitcnt lgkmcnt(4)
    v_mfma_f32_16x16x32_bf16 v[48:51], v[136:139], a[64:67], v[48:51]
    ds_read_b64_tr_b16 v[152:153], v218 offset:40960
    v_cvt_pk_bf16_f32 v74, v84, v85
    v_mfma_f32_16x16x32_bf16 v[52:55], v[136:139], a[68:71], v[52:55]
    ds_read_b64_tr_b16 v[154:155], v218 offset:43008
    v_cvt_pk_bf16_f32 v75, v86, v87
    v_mfma_f32_16x16x32_bf16 v[56:59], v[140:143], a[64:67], v[56:59]
    ds_read_b64_tr_b16 v[156:157], v219 offset:40960
    v_min_u32_e64 v72, -2, v72
    v_mfma_f32_16x16x32_bf16 v[60:63], v[140:143], a[68:71], v[60:63]
    ds_read_b64_tr_b16 v[158:159], v219 offset:43008
    v_min_u32 v73, -2, v73
    s_waitcnt lgkmcnt(4)
    v_mfma_f32_16x16x32_bf16 v[32:35], v[144:147], a[80:83], v[32:35]
    ds_read_b64_tr_b16 v[128:129], v216 offset:49152
    v_min_u32_e64 v74, -2, v74
    v_mfma_f32_16x16x32_bf16 v[36:39], v[144:147], a[84:87], v[36:39]
    ds_read_b64_tr_b16 v[130:131], v216 offset:51200
    v_min_u32_e64 v75, -2, v75
    v_mfma_f32_16x16x32_bf16 v[40:43], v[148:151], a[80:83], v[40:43]
    ds_read_b64_tr_b16 v[132:133], v217 offset:49152
    buffer_store_dwordx4 v[72:75], v228, s[8:11], s33 offen offset:2048 sc1
    v_mfma_f32_16x16x32_bf16 v[44:47], v[148:151], a[84:87], v[44:47]
    ds_read_b64_tr_b16 v[134:135], v217 offset:51200
    s_waitcnt lgkmcnt(4)
    v_mfma_f32_16x16x32_bf16 v[48:51], v[152:155], a[80:83], v[48:51]
    ds_read_b64_tr_b16 v[136:137], v218 offset:49152
    v_mfma_f32_16x16x32_bf16 v[52:55], v[152:155], a[84:87], v[52:55]
    ds_read_b64_tr_b16 v[138:139], v218 offset:51200
    v_mfma_f32_16x16x32_bf16 v[56:59], v[156:159], a[80:83], v[56:59]
    ds_read_b64_tr_b16 v[140:141], v219 offset:49152
    v_cvt_pk_bf16_f32 v76, v88, v89
    v_mfma_f32_16x16x32_bf16 v[60:63], v[156:159], a[84:87], v[60:63]
    ds_read_b64_tr_b16 v[142:143], v219 offset:51200
    v_cvt_pk_bf16_f32 v77, v90, v91
    s_waitcnt lgkmcnt(4)
    v_mfma_f32_16x16x32_bf16 v[32:35], v[128:131], a[96:99], v[32:35]
    ds_read_b64_tr_b16 v[144:145], v216 offset:57344
    v_cvt_pk_bf16_f32 v78, v92, v93
    v_mfma_f32_16x16x32_bf16 v[36:39], v[128:131], a[100:103], v[36:39]
    ds_read_b64_tr_b16 v[146:147], v216 offset:59392
    v_cvt_pk_bf16_f32 v79, v94, v95
    v_mfma_f32_16x16x32_bf16 v[40:43], v[132:135], a[96:99], v[40:43]
    ds_read_b64_tr_b16 v[148:149], v217 offset:57344
    v_min_u32_e64 v76, -2, v76
    v_mfma_f32_16x16x32_bf16 v[44:47], v[132:135], a[100:103], v[44:47]
    ds_read_b64_tr_b16 v[150:151], v217 offset:59392
    v_min_u32 v77, -2, v77
    s_waitcnt lgkmcnt(4)
    v_mfma_f32_16x16x32_bf16 v[48:51], v[136:139], a[96:99], v[48:51]
    ds_read_b64_tr_b16 v[152:153], v218 offset:57344
    v_min_u32_e64 v78, -2, v78
    v_mfma_f32_16x16x32_bf16 v[52:55], v[136:139], a[100:103], v[52:55]
    ds_read_b64_tr_b16 v[154:155], v218 offset:59392
    v_min_u32_e64 v79, -2, v79
    v_mfma_f32_16x16x32_bf16 v[56:59], v[140:143], a[96:99], v[56:59]
    ds_read_b64_tr_b16 v[156:157], v219 offset:57344
    buffer_store_dwordx4 v[76:79], v228, s[8:11], s33 offen offset:3072 sc1
    v_mfma_f32_16x16x32_bf16 v[60:63], v[140:143], a[100:103], v[60:63]
    ds_read_b64_tr_b16 v[158:159], v219 offset:59392
    s_waitcnt lgkmcnt(4)
    v_mfma_f32_16x16x32_bf16 v[32:35], v[144:147], a[112:115], v[32:35]
    buffer_load_dwordx4 v[96:99], v228, s[8:11], s37 offen offset:0 sc1
    v_mfma_f32_16x16x32_bf16 v[36:39], v[144:147], a[116:119], v[36:39]
    v_mfma_f32_16x16x32_bf16 v[40:43], v[148:151], a[112:115], v[40:43]
    buffer_load_dwordx4 v[100:103], v228, s[8:11], s37 offen offset:1024 sc1
    v_mfma_f32_16x16x32_bf16 v[44:47], v[148:151], a[116:119], v[44:47]
    s_waitcnt lgkmcnt(0)
    v_mfma_f32_16x16x32_bf16 v[48:51], v[152:155], a[112:115], v[48:51]
    buffer_load_dwordx4 v[104:107], v228, s[8:11], s37 offen offset:2048 sc1
    v_mfma_f32_16x16x32_bf16 v[52:55], v[152:155], a[116:119], v[52:55]
    v_mfma_f32_16x16x32_bf16 v[56:59], v[156:159], a[112:115], v[56:59]
    buffer_load_dwordx4 v[108:111], v228, s[8:11], s37 offen offset:3072 sc1
    v_mfma_f32_16x16x32_bf16 v[60:63], v[156:159], a[116:119], v[60:63]
kc_tail:
    buffer_load_dwordx4 v[160:163], v228, s[8:11], s38 offen offset:0 sc1
    buffer_load_dwordx4 v[164:167], v228, s[8:11], s38 offen offset:1024 sc1
    buffer_load_dwordx4 v[168:171], v228, s[8:11], s38 offen offset:2048 sc1
    buffer_load_dwordx4 v[172:175], v228, s[8:11], s38 offen offset:3072 sc1
    v_lshlrev_b32_e64 v128, 16, v192
    v_and_b32 v129, 0xffff0000, v192
    v_lshlrev_b32_e64 v130, 16, v193
    v_and_b32 v131, 0xffff0000, v193
    v_lshlrev_b32_e64 v132, 16, v194
    v_and_b32 v133, 0xffff0000, v194
    v_lshlrev_b32_e64 v134, 16, v195
    v_and_b32 v135, 0xffff0000, v195
    v_lshlrev_b32_e64 v136, 16, v196
    v_and_b32 v137, 0xffff0000, v196
    v_lshlrev_b32_e64 v138, 16, v197
    v_and_b32 v139, 0xffff0000, v197
    v_lshlrev_b32_e64 v140, 16, v198
    v_and_b32 v141, 0xffff0000, v198
    v_lshlrev_b32_e64 v142, 16, v199
    v_and_b32 v143, 0xffff0000, v199
    v_lshlrev_b32_e64 v144, 16, v200
    v_and_b32 v145, 0xffff0000, v200
    v_lshlrev_b32_e64 v146, 16, v201
    v_and_b32 v147, 0xffff0000, v201
    v_lshlrev_b32_e64 v148, 16, v202
    v_and_b32 v149, 0xffff0000, v202
    v_lshlrev_b32_e64 v150, 16, v203
    v_and_b32 v151, 0xffff0000, v203
    v_lshlrev_b32_e64 v152, 16, v204
    v_and_b32 v153, 0xffff0000, v204
    v_lshlrev_b32_e64 v154, 16, v205
    v_and_b32 v155, 0xffff0000, v205
    v_lshlrev_b32_e64 v156, 16, v206
    v_and_b32 v157, 0xffff0000, v206
    v_lshlrev_b32_e64 v158, 16, v207
    v_and_b32 v159, 0xffff0000, v207
    v_lshlrev_b32_e64 v112, 16, v208
    v_and_b32 v113, 0xffff0000, v208
    v_lshlrev_b32_e64 v114, 16, v209
    v_and_b32 v115, 0xffff0000, v209
    v_lshlrev_b32_e64 v116, 16, v210
    v_and_b32 v117, 0xffff0000, v210
    v_lshlrev_b32_e64 v118, 16, v211
    v_and_b32 v119, 0xffff0000, v211
    v_pk_add_f32 v[120:121], v[112:113], v[114:115]
    v_pk_add_f32 v[122:123], v[116:117], v[118:119]
    v_pk_add_f32 v[120:121], v[120:121], v[122:123]
    v_add_f32_e64 v196, v120, v121
    s_barrier
    s_waitcnt vmcnt(12)
    v_max3_u32 v235, v176, v177, v178
    v_max3_u32 v235, v235, v179, v180
    v_max3_u32 v235, v235, v181, v182
    v_max3_u32 v235, v235, v183, v184
    v_max3_u32 v235, v235, v185, v186
    v_max3_u32 v235, v235, v187, v188
    v_max3_u32 v235, v235, v189, v190
    v_max_u32 v235, v235, v191
    v_cmp_eq_u32 vcc, -1, v235
    s_cbranch_vccnz kc_r3
kc_r3o:
    v_lshlrev_b32 v64, 16, v176
    v_and_b32 v65, 0xffff0000, v176
    v_lshlrev_b32_e64 v66, 16, v177
    v_and_b32 v67, 0xffff0000, v177
    v_pk_add_f32 v[32:33], v[32:33], v[64:65]
    v_pk_add_f32 v[34:35], v[34:35], v[66:67]
    v_lshlrev_b32_e64 v68, 16, v178
    v_and_b32 v69, 0xffff0000, v178
    v_lshlrev_b32_e64 v70, 16, v179
    v_and_b32 v71, 0xffff0000, v179
    v_pk_add_f32 v[36:37], v[36:37], v[68:69]
    v_pk_add_f32 v[38:39], v[38:39], v[70:71]
    v_lshlrev_b32_e64 v72, 16, v180
    v_and_b32 v73, 0xffff0000, v180
    v_lshlrev_b32_e64 v74, 16, v181
    v_and_b32 v75, 0xffff0000, v181
    v_pk_add_f32 v[40:41], v[40:41], v[72:73]
    v_pk_add_f32 v[42:43], v[42:43], v[74:75]
    v_lshlrev_b32_e64 v76, 16, v182
    v_and_b32 v77, 0xffff0000, v182
    v_lshlrev_b32_e64 v78, 16, v183
    v_and_b32 v79, 0xffff0000, v183
    v_pk_add_f32 v[44:45], v[44:45], v[76:77]
    v_pk_add_f32 v[46:47], v[46:47], v[78:79]
    v_lshlrev_b32_e64 v80, 16, v184
    v_and_b32 v81, 0xffff0000, v184
    v_lshlrev_b32_e64 v82, 16, v185
    v_and_b32 v83, 0xffff0000, v185
    v_pk_add_f32 v[48:49], v[48:49], v[80:81]
    v_pk_add_f32 v[50:51], v[50:51], v[82:83]
    v_lshlrev_b32_e64 v84, 16, v186
    v_and_b32 v85, 0xffff0000, v186
    v_lshlrev_b32_e64 v86, 16, v187
    v_and_b32 v87, 0xffff0000, v187
    v_pk_add_f32 v[52:53], v[52:53], v[84:85]
    v_pk_add_f32 v[54:55], v[54:55], v[86:87]
    v_lshlrev_b32_e64 v88, 16, v188
    v_and_b32 v89, 0xffff0000, v188
    v_lshlrev_b32_e64 v90, 16, v189
    v_and_b32 v91, 0xffff0000, v189
    v_pk_add_f32 v[56:57], v[56:57], v[88:89]
    v_pk_add_f32 v[58:59], v[58:59], v[90:91]
    v_lshlrev_b32_e64 v92, 16, v190
    v_and_b32 v93, 0xffff0000, v190
    v_lshlrev_b32_e64 v94, 16, v191
    v_and_b32 v95, 0xffff0000, v191
    v_pk_add_f32 v[60:61], v[60:61], v[92:93]
    v_pk_add_f32 v[62:63], v[62:63], v[94:95]
    s_waitcnt vmcnt(4)
    v_max3_u32 v235, v96, v97, v98
    v_max3_u32 v235, v235, v99, v100
    v_max3_u32 v235, v235, v101, v102
    v_max3_u32 v235, v235, v103, v104
    v_max3_u32 v235, v235, v105, v106
    v_max3_u32 v235, v235, v107, v108
    v_max3_u32 v235, v235, v109, v110
    v_max_u32 v235, v235, v111
    v_cmp_eq_u32 vcc, -1, v235
    s_cbranch_vccnz kc_r1
kc_r1o:
    v_lshlrev_b32_e64 v64, 16, v96
    v_and_b32 v65, 0xffff0000, v96
    v_lshlrev_b32_e64 v66, 16, v97
    v_and_b32 v67, 0xffff0000, v97
    v_pk_add_f32 v[32:33], v[32:33], v[64:65]
    v_pk_add_f32 v[34:35], v[34:35], v[66:67]
    v_lshlrev_b32_e64 v68, 16, v98
    v_and_b32 v69, 0xffff0000, v98
    v_lshlrev_b32_e64 v70, 16, v99
    v_and_b32 v71, 0xffff0000, v99
    v_pk_add_f32 v[36:37], v[36:37], v[68:69]
    v_pk_add_f32 v[38:39], v[38:39], v[70:71]
    v_lshlrev_b32_e64 v72, 16, v100
    v_and_b32 v73, 0xffff0000, v100
    v_lshlrev_b32_e64 v74, 16, v101
    v_and_b32 v75, 0xffff0000, v101
    v_pk_add_f32 v[40:41], v[40:41], v[72:73]
    v_pk_add_f32 v[42:43], v[42:43], v[74:75]
    v_lshlrev_b32_e64 v76, 16, v102
    v_and_b32 v77, 0xffff0000, v102
    v_lshlrev_b32_e64 v78, 16, v103
    v_and_b32 v79, 0xffff0000, v103
    v_pk_add_f32 v[44:45], v[44:45], v[76:77]
    v_pk_add_f32 v[46:47], v[46:47], v[78:79]
    v_lshlrev_b32_e64 v80, 16, v104
    v_and_b32 v81, 0xffff0000, v104
    v_lshlrev_b32_e64 v82, 16, v105
    v_and_b32 v83, 0xffff0000, v105
    v_pk_add_f32 v[48:49], v[48:49], v[80:81]
    v_pk_add_f32 v[50:51], v[50:51], v[82:83]
    v_lshlrev_b32_e64 v84, 16, v106
    v_and_b32 v85, 0xffff0000, v106
    v_lshlrev_b32_e64 v86, 16, v107
    v_and_b32 v87, 0xffff0000, v107
    v_pk_add_f32 v[52:53], v[52:53], v[84:85]
    v_pk_add_f32 v[54:55], v[54:55], v[86:87]
    v_lshlrev_b32_e64 v88, 16, v108
    v_and_b32 v89, 0xffff0000, v108
    v_lshlrev_b32_e64 v90, 16, v109
    v_and_b32 v91, 0xffff0000, v109
    v_pk_add_f32 v[56:57], v[56:57], v[88:89]
    v_pk_add_f32 v[58:59], v[58:59], v[90:91]
    v_lshlrev_b32_e64 v92, 16, v110
    v_and_b32 v93, 0xffff0000, v110
    v_lshlrev_b32_e64 v94, 16, v111
    v_and_b32 v95, 0xffff0000, v111
    v_pk_add_f32 v[60:61], v[60:61], v[92:93]
    v_pk_add_f32 v[62:63], v[62:63], v[94:95]
    s_waitcnt vmcnt(0)
    v_max3_u32 v235, v160, v161, v162
    v_max3_u32 v235, v235, v163, v164
    v_max3_u32 v235, v235, v165, v166
    v_max3_u32 v235, v235, v167, v168
    v_max3_u32 v235, v235, v169, v170
    v_max3_u32 v235, v235, v171, v172
    v_max3_u32 v235, v235, v173, v174
    v_max_u32 v235, v235, v175
    v_cmp_eq_u32 vcc, -1, v235
    s_cbranch_vccnz kc_r2
kc_r2o:
    v_lshlrev_b32_e64 v64, 16, v160
    v_and_b32 v65, 0xffff0000, v160
    v_lshlrev_b32_e64 v66, 16, v161
    v_and_b32 v67, 0xffff0000, v161
    v_pk_add_f32 v[32:33], v[32:33], v[64:65]
    v_pk_add_f32 v[34:35], v[34:35], v[66:67]
    v_cvt_pk_bf16_f32 v0, v32, v33
    v_cvt_pk_bf16_f32 v1, v34, v35
    ds_write_b64 v238, v[0:1] offset:0
    v_lshlrev_b32_e64 v68, 16, v162
    v_and_b32 v69, 0xffff0000, v162
    v_lshlrev_b32_e64 v70, 16, v163
    v_and_b32 v71, 0xffff0000, v163
    v_pk_add_f32 v[36:37], v[36:37], v[68:69]
    v_pk_add_f32 v[38:39], v[38:39], v[70:71]
    v_cvt_pk_bf16_f32 v2, v36, v37
    v_cvt_pk_bf16_f32 v3, v38, v39
    ds_write_b64 v238, v[2:3] offset:2304
    v_lshlrev_b32_e64 v72, 16, v164
    v_and_b32 v73, 0xffff0000, v164
    v_lshlrev_b32_e64 v74, 16, v165
    v_and_b32 v75, 0xffff0000, v165
    v_pk_add_f32 v[40:41], v[40:41], v[72:73]
    v_pk_add_f32 v[42:43], v[42:43], v[74:75]
    v_cvt_pk_bf16_f32 v4, v40, v41
    v_cvt_pk_bf16_f32 v5, v42, v43
    ds_write_b64 v238, v[4:5] offset:32
    v_lshlrev_b32_e64 v76, 16, v166
    v_and_b32 v77, 0xffff0000, v166
    v_lshlrev_b32_e64 v78, 16, v167
    v_and_b32 v79, 0xffff0000, v167
    v_pk_add_f32 v[44:45], v[44:45], v[76:77]
    v_pk_add_f32 v[46:47], v[46:47], v[78:79]
    v_cvt_pk_bf16_f32 v6, v44, v45
    v_cvt_pk_bf16_f32 v7, v46, v47
    ds_write_b64 v238, v[6:7] offset:2336
    v_lshlrev_b32_e64 v80, 16, v168
    v_and_b32 v81, 0xffff0000, v168
    v_lshlrev_b32_e64 v82, 16, v169
    v_and_b32 v83, 0xffff0000, v169
    v_pk_add_f32 v[48:49], v[48:49], v[80:81]
    v_pk_add_f32 v[50:51], v[50:51], v[82:83]
    v_cvt_pk_bf16_f32 v8, v48, v49
    v_cvt_pk_bf16_f32 v9, v50, v51
    ds_write_b64 v238, v[8:9] offset:64
    v_lshlrev_b32_e64 v84, 16, v170
    v_and_b32 v85, 0xffff0000, v170
    v_lshlrev_b32_e64 v86, 16, v171
    v_and_b32 v87, 0xffff0000, v171
    v_pk_add_f32 v[52:53], v[52:53], v[84:85]
    v_pk_add_f32 v[54:55], v[54:55], v[86:87]
    v_cvt_pk_bf16_f32 v10, v52, v53
    v_cvt_pk_bf16_f32 v11, v54, v55
    ds_write_b64 v238, v[10:11] offset:2368
    v_lshlrev_b32_e64 v88, 16, v172
    v_and_b32 v89, 0xffff0000, v172
    v_lshlrev_b32_e64 v90, 16, v173
    v_and_b32 v91, 0xffff0000, v173
    v_pk_add_f32 v[56:57], v[56:57], v[88:89]
    v_pk_add_f32 v[58:59], v[58:59], v[90:91]
    v_cvt_pk_bf16_f32 v12, v56, v57
    v_cvt_pk_bf16_f32 v13, v58, v59
    ds_write_b64 v238, v[12:13] offset:96
    v_lshlrev_b32_e64 v92, 16, v174
    v_and_b32 v93, 0xffff0000, v174
    v_lshlrev_b32_e64 v94, 16, v175
    v_and_b32 v95, 0xffff0000, v175
    v_pk_add_f32 v[60:61], v[60:61], v[92:93]
    v_pk_add_f32 v[62:63], v[62:63], v[94:95]
    v_cvt_pk_bf16_f32 v14, v60, v61
    v_cvt_pk_bf16_f32 v15, v62, v63
    ds_write_b64 v238, v[14:15] offset:2400
    s_waitcnt lgkmcnt(0)
    ds_read_b128 v[16:19], v239 offset:0
    ds_read_b128 v[20:23], v239 offset:1152
    ds_read_b128 v[24:27], v239 offset:2304
    ds_read_b128 v[28:31], v239 offset:3456
    s_waitcnt lgkmcnt(3)
    v_lshlrev_b32 v64, 16, v16
    v_lshlrev_b32 v66, 16, v17
    v_lshlrev_b32 v68, 16, v18
    v_lshlrev_b32 v70, 16, v19
    v_and_b32 v65, 0xffff0000, v16
    v_and_b32 v67, 0xffff0000, v17
    v_and_b32 v69, 0xffff0000, v18
    v_and_b32 v71, 0xffff0000, v19
    v_pk_add_f32 v[64:65], v[64:65], v[128:129]
    v_pk_add_f32 v[66:67], v[66:67], v[130:131]
    v_pk_add_f32 v[68:69], v[68:69], v[132:133]
    v_pk_add_f32 v[70:71], v[70:71], v[134:135]
    v_cvt_pk_bf16_f32 v16, v64, v65
    v_cvt_pk_bf16_f32 v17, v66, v67
    v_cvt_pk_bf16_f32 v18, v68, v69
    v_cvt_pk_bf16_f32 v19, v70, v71
    v_lshlrev_b32 v64, 16, v16
    v_lshlrev_b32 v66, 16, v17
    v_lshlrev_b32 v68, 16, v18
    v_lshlrev_b32 v70, 16, v19
    v_and_b32 v65, 0xffff0000, v16
    v_and_b32 v67, 0xffff0000, v17
    v_and_b32 v69, 0xffff0000, v18
    v_and_b32 v71, 0xffff0000, v19
    s_mov_b32 s32, 0x3400000
    buffer_store_dwordx4 v[16:19], v229, s[8:11], s32 offen sc1
    v_pk_add_f32 v[160:161], v[64:65], v[66:67]
    v_pk_mul_f32 v[162:163], v[64:65], v[64:65]
    v_pk_mul_f32 v[164:165], v[64:65], v[112:113]
    v_pk_fma_f32 v[162:163], v[66:67], v[66:67], v[162:163]
    v_pk_fma_f32 v[164:165], v[66:67], v[114:115], v[164:165]
    v_pk_add_f32 v[160:161], v[160:161], v[68:69]
    v_pk_fma_f32 v[162:163], v[68:69], v[68:69], v[162:163]
    v_pk_fma_f32 v[164:165], v[68:69], v[116:117], v[164:165]
    v_pk_add_f32 v[160:161], v[160:161], v[70:71]
    v_pk_fma_f32 v[162:163], v[70:71], v[70:71], v[162:163]
    v_pk_fma_f32 v[164:165], v[70:71], v[118:119], v[164:165]
    v_add_f32 v184, v160, v161
    v_add_f32 v185, v162, v163
    v_add_f32 v186, v164, v165
    s_waitcnt lgkmcnt(2)
    v_lshlrev_b32 v72, 16, v20
    v_lshlrev_b32 v74, 16, v21
    v_lshlrev_b32 v76, 16, v22
    v_lshlrev_b32 v78, 16, v23
    v_and_b32 v73, 0xffff0000, v20
    v_and_b32 v75, 0xffff0000, v21
    v_and_b32 v77, 0xffff0000, v22
    v_and_b32 v79, 0xffff0000, v23
    v_pk_add_f32 v[72:73], v[72:73], v[136:137]
    v_pk_add_f32 v[74:75], v[74:75], v[138:139]
    v_pk_add_f32 v[76:77], v[76:77], v[140:141]
    v_pk_add_f32 v[78:79], v[78:79], v[142:143]
    v_cvt_pk_bf16_f32 v20, v72, v73
    v_cvt_pk_bf16_f32 v21, v74, v75
    v_cvt_pk_bf16_f32 v22, v76, v77
    v_cvt_pk_bf16_f32 v23, v78, v79
    v_lshlrev_b32 v72, 16, v20
    v_lshlrev_b32 v74, 16, v21
    v_lshlrev_b32 v76, 16, v22
    v_lshlrev_b32 v78, 16, v23
    v_and_b32 v73, 0xffff0000, v20
    v_and_b32 v75, 0xffff0000, v21
    v_and_b32 v77, 0xffff0000, v22
    v_and_b32 v79, 0xffff0000, v23
    s_mov_b32 s32, 0x3404000
    buffer_store_dwordx4 v[20:23], v229, s[8:11], s32 offen sc1
    v_pk_add_f32 v[166:167], v[72:73], v[74:75]
    v_pk_mul_f32 v[168:169], v[72:73], v[72:73]
    v_pk_mul_f32 v[170:171], v[72:73], v[112:113]
    v_pk_fma_f32 v[168:169], v[74:75], v[74:75], v[168:169]
    v_pk_fma_f32 v[170:171], v[74:75], v[114:115], v[170:171]
    v_pk_add_f32 v[166:167], v[166:167], v[76:77]
    v_pk_fma_f32 v[168:169], v[76:77], v[76:77], v[168:169]
    v_pk_fma_f32 v[170:171], v[76:77], v[116:117], v[170:171]
    v_pk_add_f32 v[166:167], v[166:167], v[78:79]
    v_pk_fma_f32 v[168:169], v[78:79], v[78:79], v[168:169]
    v_pk_fma_f32 v[170:171], v[78:79], v[118:119], v[170:171]
    v_add_f32 v187, v166, v167
    v_add_f32 v188, v168, v169
    v_add_f32 v189, v170, v171
    s_waitcnt lgkmcnt(1)
    v_lshlrev_b32 v80, 16, v24
    v_lshlrev_b32 v82, 16, v25
    v_lshlrev_b32 v84, 16, v26
    v_lshlrev_b32 v86, 16, v27
    v_and_b32 v81, 0xffff0000, v24
    v_and_b32 v83, 0xffff0000, v25
    v_and_b32 v85, 0xffff0000, v26
    v_and_b32 v87, 0xffff0000, v27
    v_pk_add_f32 v[80:81], v[80:81], v[144:145]
    v_pk_add_f32 v[82:83], v[82:83], v[146:147]
    v_pk_add_f32 v[84:85], v[84:85], v[148:149]
    v_pk_add_f32 v[86:87], v[86:87], v[150:151]
    v_cvt_pk_bf16_f32 v24, v80, v81
    v_cvt_pk_bf16_f32 v25, v82, v83
    v_cvt_pk_bf16_f32 v26, v84, v85
    v_cvt_pk_bf16_f32 v27, v86, v87
    v_lshlrev_b32 v80, 16, v24
    v_lshlrev_b32 v82, 16, v25
    v_lshlrev_b32 v84, 16, v26
    v_lshlrev_b32 v86, 16, v27
    v_and_b32 v81, 0xffff0000, v24
    v_and_b32 v83, 0xffff0000, v25
    v_and_b32 v85, 0xffff0000, v26
    v_and_b32 v87, 0xffff0000, v27
    s_mov_b32 s32, 0x3408000
    buffer_store_dwordx4 v[24:27], v229, s[8:11], s32 offen sc1
    v_pk_add_f32 v[172:173], v[80:81], v[82:83]
    v_pk_mul_f32 v[174:175], v[80:81], v[80:81]
    v_pk_mul_f32 v[176:177], v[80:81], v[112:113]
    v_pk_fma_f32 v[174:175], v[82:83], v[82:83], v[174:175]
    v_pk_fma_f32 v[176:177], v[82:83], v[114:115], v[176:177]
    v_pk_add_f32 v[172:173], v[172:173], v[84:85]
    v_pk_fma_f32 v[174:175], v[84:85], v[84:85], v[174:175]
    v_pk_fma_f32 v[176:177], v[84:85], v[116:117], v[176:177]
    v_pk_add_f32 v[172:173], v[172:173], v[86:87]
    v_pk_fma_f32 v[174:175], v[86:87], v[86:87], v[174:175]
    v_pk_fma_f32 v[176:177], v[86:87], v[118:119], v[176:177]
    v_add_f32 v190, v172, v173
    v_add_f32 v191, v174, v175
    v_add_f32 v192, v176, v177
    s_waitcnt lgkmcnt(0)
    v_lshlrev_b32 v88, 16, v28
    v_lshlrev_b32 v90, 16, v29
    v_lshlrev_b32 v92, 16, v30
    v_lshlrev_b32 v94, 16, v31
    v_and_b32 v89, 0xffff0000, v28
    v_and_b32 v91, 0xffff0000, v29
    v_and_b32 v93, 0xffff0000, v30
    v_and_b32 v95, 0xffff0000, v31
    v_pk_add_f32 v[88:89], v[88:89], v[152:153]
    v_pk_add_f32 v[90:91], v[90:91], v[154:155]
    v_pk_add_f32 v[92:93], v[92:93], v[156:157]
    v_pk_add_f32 v[94:95], v[94:95], v[158:159]
    v_cvt_pk_bf16_f32 v28, v88, v89
    v_cvt_pk_bf16_f32 v29, v90, v91
    v_cvt_pk_bf16_f32 v30, v92, v93
    v_cvt_pk_bf16_f32 v31, v94, v95
    v_lshlrev_b32 v88, 16, v28
    v_lshlrev_b32 v90, 16, v29
    v_lshlrev_b32 v92, 16, v30
    v_lshlrev_b32 v94, 16, v31
    v_and_b32 v89, 0xffff0000, v28
    v_and_b32 v91, 0xffff0000, v29
    v_and_b32 v93, 0xffff0000, v30
    v_and_b32 v95, 0xffff0000, v31
    s_mov_b32 s32, 0x340c000
    buffer_store_dwordx4 v[28:31], v229, s[8:11], s32 offen sc1
    v_pk_add_f32 v[178:179], v[88:89], v[90:91]
    v_pk_mul_f32 v[180:181], v[88:89], v[88:89]
    v_pk_mul_f32 v[182:183], v[88:89], v[112:113]
    v_pk_fma_f32 v[180:181], v[90:91], v[90:91], v[180:181]
    v_pk_fma_f32 v[182:183], v[90:91], v[114:115], v[182:183]
    v_pk_add_f32 v[178:179], v[178:179], v[92:93]
    v_pk_fma_f32 v[180:181], v[92:93], v[92:93], v[180:181]
    v_pk_fma_f32 v[182:183], v[92:93], v[116:117], v[182:183]
    v_pk_add_f32 v[178:179], v[178:179], v[94:95]
    v_pk_fma_f32 v[180:181], v[94:95], v[94:95], v[180:181]
    v_pk_fma_f32 v[182:183], v[94:95], v[118:119], v[182:183]
    v_add_f32 v193, v178, v179
    v_add_f32 v194, v180, v181
    v_add_f32_e64 v195, v182, v183
    v_add_f32_dpp v196, v196, v196 quad_perm:[1,0,3,2] row_mask:0xf bank_mask:0xf
    v_add_f32_dpp v184, v184, v184 quad_perm:[1,0,3,2] row_mask:0xf bank_mask:0xf
    v_add_f32_dpp v185, v185, v185 quad_perm:[1,0,3,2] row_mask:0xf bank_mask:0xf
    v_add_f32_dpp v186, v186, v186 quad_perm:[1,0,3,2] row_mask:0xf bank_mask:0xf
    v_add_f32_dpp v187, v187, v187 quad_perm:[1,0,3,2] row_mask:0xf bank_mask:0xf
    v_add_f32_dpp v188, v188, v188 quad_perm:[1,0,3,2] row_mask:0xf bank_mask:0xf
    v_add_f32_dpp v189, v189, v189 quad_perm:[1,0,3,2] row_mask:0xf bank_mask:0xf
    v_add_f32_dpp v190, v190, v190 quad_perm:[1,0,3,2] row_mask:0xf bank_mask:0xf
    v_add_f32_dpp v191, v191, v191 quad_perm:[1,0,3,2] row_mask:0xf bank_mask:0xf
    v_add_f32_dpp v192, v192, v192 quad_perm:[1,0,3,2] row_mask:0xf bank_mask:0xf
    v_add_f32_dpp v193, v193, v193 quad_perm:[1,0,3,2] row_mask:0xf bank_mask:0xf
    v_add_f32_dpp v194, v194, v194 quad_perm:[1,0,3,2] row_mask:0xf bank_mask:0xf
    v_add_f32_dpp v195, v195, v195 quad_perm:[1,0,3,2] row_mask:0xf bank_mask:0xf
    v_add_f32_dpp v196, v196, v196 quad_perm:[2,3,0,1] row_mask:0xf bank_mask:0xf
    v_add_f32_dpp v184, v184, v184 quad_perm:[2,3,0,1] row_mask:0xf bank_mask:0xf
    v_add_f32_dpp v185, v185, v185 quad_perm:[2,3,0,1] row_mask:0xf bank_mask:0xf
    v_add_f32_dpp v186, v186, v186 quad_perm:[2,3,0,1] row_mask:0xf bank_mask:0xf
    v_add_f32_dpp v187, v187, v187 quad_perm:[2,3,0,1] row_mask:0xf bank_mask:0xf
    v_add_f32_dpp v188, v188, v188 quad_perm:[2,3,0,1] row_mask:0xf bank_mask:0xf
    v_add_f32_dpp v189, v189, v189 quad_perm:[2,3,0,1] row_mask:0xf bank_mask:0xf
    v_add_f32_dpp v190, v190, v190 quad_perm:[2,3,0,1] row_mask:0xf bank_mask:0xf
    v_add_f32_dpp v191, v191, v191 quad_perm:[2,3,0,1] row_mask:0xf bank_mask:0xf
    v_add_f32_dpp v192, v192, v192 quad_perm:[2,3,0,1] row_mask:0xf bank_mask:0xf
    v_add_f32_dpp v193, v193, v193 quad_perm:[2,3,0,1] row_mask:0xf bank_mask:0xf
    v_add_f32_dpp v194, v194, v194 quad_perm:[2,3,0,1] row_mask:0xf bank_mask:0xf
    v_add_f32_dpp v195, v195, v195 quad_perm:[2,3,0,1] row_mask:0xf bank_mask:0xf
    v_add_f32_dpp v196, v196, v196 row_half_mirror row_mask:0xf bank_mask:0xf
    v_add_f32_dpp v184, v184, v184 row_half_mirror row_mask:0xf bank_mask:0xf
    v_add_f32_dpp v185, v185, v185 row_half_mirror row_mask:0xf bank_mask:0xf
    v_add_f32_dpp v186, v186, v186 row_half_mirror row_mask:0xf bank_mask:0xf
    v_add_f32_dpp v187, v187, v187 row_half_mirror row_mask:0xf bank_mask:0xf
    v_add_f32_dpp v188, v188, v188 row_half_mirror row_mask:0xf bank_mask:0xf
    v_add_f32_dpp v189, v189, v189 row_half_mirror row_mask:0xf bank_mask:0xf
    v_add_f32_dpp v190, v190, v190 row_half_mirror row_mask:0xf bank_mask:0xf
    v_add_f32_dpp v191, v191, v191 row_half_mirror row_mask:0xf bank_mask:0xf
    v_add_f32_dpp v192, v192, v192 row_half_mirror row_mask:0xf bank_mask:0xf
    v_add_f32_dpp v193, v193, v193 row_half_mirror row_mask:0xf bank_mask:0xf
    v_add_f32_dpp v194, v194, v194 row_half_mirror row_mask:0xf bank_mask:0xf
    v_add_f32_dpp v195, v195, v195 row_half_mirror row_mask:0xf bank_mask:0xf
    v_cndmask_b32 v184, v184, v187, s[60:61]
    v_cndmask_b32 v190, v190, v193, s[60:61]
    v_cndmask_b32 v185, v185, v188, s[60:61]
    v_cndmask_b32 v191, v191, v194, s[60:61]
    v_cndmask_b32 v186, v186, v189, s[60:61]
    v_cndmask_b32 v192, v192, v195, s[60:61]
    v_cndmask_b32 v184, v184, v190, s[62:63]
    v_cndmask_b32 v185, v185, v191, s[62:63]
    v_cndmask_b32 v186, v186, v192, s[62:63]
    v_cndmask_b32 v184, v184, v185, s[40:41]
    v_cndmask_b32 v186, v186, v196, s[40:41]
    buffer_atomic_add_f32 v184, v231, s[8:11], s48 offen
    buffer_atomic_add_f32 v186, v232, s[8:11], s48 offen
    s_lshl_b32 s32, s3, 13
    v_add_u32 v234, s32, v228
    v_add_u32 v235, 65536, v234
    ds_write_b128 v234, a[128:131] offset:0
    ds_write_b128 v234, a[132:135] offset:1024
    ds_write_b128 v234, a[136:139] offset:2048
    ds_write_b128 v234, a[140:143] offset:3072
    ds_write_b128 v234, a[144:147] offset:4096
    ds_write_b128 v234, a[148:151] offset:5120
    ds_write_b128 v234, a[152:155] offset:6144
    ds_write_b128 v234, a[156:159] offset:7168
    s_waitcnt lgkmcnt(4)
    ds_write_b128 v234, a[160:163] offset:32768
    ds_write_b128 v234, a[164:167] offset:33792
    ds_write_b128 v234, a[168:171] offset:34816
    ds_write_b128 v234, a[172:175] offset:35840
    ds_write_b128 v234, a[176:179] offset:36864
    ds_write_b128 v234, a[180:183] offset:37888
    ds_write_b128 v234, a[184:187] offset:38912
    ds_write_b128 v234, a[188:191] offset:39936
    s_waitcnt lgkmcnt(4)
    ds_write_b128 v235, a[192:195] offset:0
    ds_write_b128 v235, a[196:199] offset:1024
    ds_write_b128 v235, a[200:203] offset:2048
    ds_write_b128 v235, a[204:207] offset:3072
    ds_write_b128 v235, a[208:211] offset:4096
    ds_write_b128 v235, a[212:215] offset:5120
    ds_write_b128 v235, a[216:219] offset:6144
    ds_write_b128 v235, a[220:223] offset:7168
    s_waitcnt lgkmcnt(4)
    s_lshl_b32 s35, s3, 13
    v_bfe_u32 v234, v237, 2, 3
    v_lshrrev_b32_e64 v235, 5, v237
    v_lshl_add_u32 v234, v235, 4, v234
    v_lshlrev_b32 v234, 5, v234
    v_and_b32 v236, 3, v237
    v_lshl_add_u32 v234, v236, 3, v234
    v_add_u32 v217, s35, v234
    v_lshlrev_b32 v235, 5, v235
    v_bfe_u32 v236, v237, 4, 1
    v_lshl_add_u32 v235, v236, 3, v235
    v_and_b32_e64 v236, 1, v237
    v_lshl_add_u32 v235, v236, 11, v235
    s_lshl_b32 s32, s3, 9
    s_add_u32 s32, s32, 98304
    v_add_u32 v218, s32, v235
    v_lshlrev_b32_e64 v234, 4, v230
    v_add_u32 v220, 106752, v234
    v_add_u32 v221, 106752, v228
    v_lshrrev_b32 v236, 2, v237
    v_lshlrev_b32 v236, 7, v236
    v_and_b32_e64 v234, 3, v237
    v_lshl_add_u32 v236, v234, 3, v236
    s_add_u32 s32, s35, 65536
    v_add_u32 v219, s32, v236
    s_lshl_b32 s32, s3, 12
    s_add_u32 s32, s32, 114944
    v_and_b32 v234, 15, v237
    v_min_u32 v234, 2, v234
    v_lshlrev_b32 v234, 10, v234
    v_lshrrev_b32 v235, 4, v237
    v_lshl_add_u32 v234, v235, 4, v234
    v_add_u32 v222, s32, v234
    v_add_u32_e64 v223, s32, v228
    s_waitcnt vmcnt(0)
    s_barrier
    s_cmp_lg_u32 s3, 0
    s_cbranch_scc1 kc_a1
    s_lshl_b32 s32, s52, 7
    s_add_u32 s32, s32, 0x38a0000
    v_mov_b32_e64 v235, 1
    buffer_atomic_add v235, v243, s[8:11], s32 offen sc0 sc1
    v_lshlrev_b32 v234, 7, v237
    v_cmp_gt_u32 vcc, 8, v237
    v_mov_b32_e64 v236, 0x40000000
    s_mov_b32 s34, 0x38a0400
    v_cndmask_b32 v234, v236, v234, vcc
    s_waitcnt vmcnt(0)
    v_readfirstlane_b32 s36, v235
    s_cmp_lg_u32 s36, 31
    s_cbranch_scc1 kc_a1
    buffer_atomic_add v233, v234, s[8:11], s34 offen sc1
kc_a1:
    s_waitcnt lgkmcnt(0)
    ds_read_b64_tr_b16 a[0:1], v217 offset:0
    ds_read_b64_tr_b16 a[2:3], v217 offset:256
    ds_read_b64_tr_b16 a[32:33], v217 offset:32768
    ds_read_b64_tr_b16 a[34:35], v217 offset:33024
    ds_read_b64_tr_b16 a[4:5], v217 offset:1024
    ds_read_b64_tr_b16 a[6:7], v217 offset:1280
    ds_read_b64_tr_b16 a[36:37], v217 offset:33792
    ds_read_b64_tr_b16 a[38:39], v217 offset:34048
    s_waitcnt lgkmcnt(6)
    ds_read_b64_tr_b16 a[8:9], v217 offset:2048
    ds_read_b64_tr_b16 a[10:11], v217 offset:2304
    ds_read_b64_tr_b16 a[40:41], v217 offset:34816
    ds_read_b64_tr_b16 a[42:43], v217 offset:35072
    ds_read_b64_tr_b16 a[12:13], v217 offset:3072
    ds_read_b64_tr_b16 a[14:15], v217 offset:3328
    ds_read_b64_tr_b16 a[44:45], v217 offset:35840
    ds_read_b64_tr_b16 a[46:47], v217 offset:36096
    s_waitcnt lgkmcnt(6)
    ds_read_b64_tr_b16 a[16:17], v217 offset:4096
    ds_read_b64_tr_b16 a[18:19], v217 offset:4352
    ds_read_b64_tr_b16 a[48:49], v217 offset:36864
    ds_read_b64_tr_b16 a[50:51], v217 offset:37120
    ds_read_b64_tr_b16 a[20:21], v217 offset:5120
    ds_read_b64_tr_b16 a[22:23], v217 offset:5376
    ds_read_b64_tr_b16 a[52:53], v217 offset:37888
    ds_read_b64_tr_b16 a[54:55], v217 offset:38144
    s_waitcnt lgkmcnt(6)
    ds_read_b64_tr_b16 a[24:25], v217 offset:6144
    ds_read_b64_tr_b16 a[26:27], v217 offset:6400
    ds_read_b64_tr_b16 a[56:57], v217 offset:38912
    ds_read_b64_tr_b16 a[58:59], v217 offset:39168
    ds_read_b64_tr_b16 a[28:29], v217 offset:7168
    ds_read_b64_tr_b16 a[30:31], v217 offset:7424
    ds_read_b64_tr_b16 a[60:61], v217 offset:39936
    ds_read_b64_tr_b16 a[62:63], v217 offset:40192
    s_waitcnt lgkmcnt(6)
    ds_read_b64_tr_b16 a[64:65], v219 offset:0
    ds_read_b64_tr_b16 a[66:67], v219 offset:32
    ds_read_b64_tr_b16 a[68:69], v219 offset:64
    ds_read_b64_tr_b16 a[70:71], v219 offset:96
    ds_read_b64_tr_b16 a[72:73], v219 offset:2048
    ds_read_b64_tr_b16 a[74:75], v219 offset:2080
    ds_read_b64_tr_b16 a[76:77], v219 offset:2112
    ds_read_b64_tr_b16 a[78:79], v219 offset:2144
    s_waitcnt lgkmcnt(6)
    ds_read_b64_tr_b16 a[80:81], v219 offset:4096
    ds_read_b64_tr_b16 a[82:83], v219 offset:4128
    ds_read_b64_tr_b16 a[84:85], v219 offset:4160
    ds_read_b64_tr_b16 a[86:87], v219 offset:4192
    ds_read_b64_tr_b16 a[88:89], v219 offset:6144
    ds_read_b64_tr_b16 a[90:91], v219 offset:6176
    ds_read_b64_tr_b16 a[92:93], v219 offset:6208
    ds_read_b64_tr_b16 a[94:95], v219 offset:6240
    s_waitcnt lgkmcnt(6)
    v_mov_b32 v130, 0x3a800000
    v_mov_b32 v131, 0x3a800000
    v_mov_b32 v132, 0x3727c5ac
    v_mov_b32 v133, 0x3727c5ac
    s_mov_b32 s33, 0xfffff800
    s_lshl_b32 s39, s3, 11
    v_add_u32 v238, s39, v228
    v_lshlrev_b32 v239, 2, v242
    s_lshl_b32 s39, s3, 3
    s_add_u32 s7, s39, 106512
    v_lshlrev_b32 v141, 5, v237
    v_or_b32_e64 v141, s39, v141
    s_cmp_lg_u32 s3, 0
    s_cbranch_scc1 kc_b12
    s_lshl_b32 s32, s52, 7
    s_add_u32 s32, s32, 0x38a0400
    s_mov_b32 s34, 0x400000
    s_branch kc_b11
kc_b10:
    s_sleep 2
kc_b11:
    buffer_load_dword v235, off, s[8:11], s32 sc1
    s_waitcnt vmcnt(0)
    v_cmp_ne_u32 vcc, 8, v235
    s_sub_u32 s34, s34, 1
    s_cbranch_scc1 kc_b12
    s_cbranch_vccnz kc_b10
kc_b12:
    s_barrier
    s_add_u32 s32, s48, 24576
    buffer_load_dword v128, off, s[8:11], s32 sc1
    buffer_load_dwordx4 v[32:35], v238, s[8:11], s48 offen offset:0 sc1
    buffer_load_dwordx4 v[40:43], v238, s[8:11], s49 offen offset:0 sc1
    buffer_load_dwordx4 v[48:51], v238, s[8:11], s50 offen offset:0 sc1
    buffer_load_dwordx4 v[36:39], v238, s[8:11], s48 offen offset:1024 sc1
    buffer_load_dwordx4 v[44:47], v238, s[8:11], s49 offen offset:1024 sc1
    buffer_load_dwordx4 v[52:55], v238, s[8:11], s50 offen offset:1024 sc1
    buffer_load_dword v0, v239, s[8:11], s48 offen offset:0 sc1
    buffer_load_dword v4, v239, s[8:11], s49 offen offset:0 sc1
    buffer_load_dword v1, v239, s[8:11], s48 offen offset:32 sc1
    buffer_load_dword v5, v239, s[8:11], s49 offen offset:32 sc1
    buffer_load_dword v2, v239, s[8:11], s48 offen offset:64 sc1
    buffer_load_dword v6, v239, s[8:11], s49 offen offset:64 sc1
    buffer_load_dword v3, v239, s[8:11], s48 offen offset:96 sc1
    buffer_load_dword v7, v239, s[8:11], s49 offen offset:96 sc1
    s_waitcnt vmcnt(8)
    v_mov_b32 v129, v128
    v_pk_mul_f32 v[32:33], v[32:33], v[130:131]
    v_pk_mul_f32 v[34:35], v[34:35], v[130:131]
    v_pk_mul_f32 v[36:37], v[36:37], v[130:131]
    v_pk_mul_f32 v[38:39], v[38:39], v[130:131]
    v_pk_fma_f32 v[40:41], v[40:41], v[130:131], v[132:133]
    v_pk_fma_f32 v[42:43], v[42:43], v[130:131], v[132:133]
    v_pk_fma_f32 v[44:45], v[44:45], v[130:131], v[132:133]
    v_pk_fma_f32 v[46:47], v[46:47], v[130:131], v[132:133]
    v_pk_fma_f32 v[40:41], v[32:33], v[32:33], v[40:41] neg_lo:[1,0,0] neg_hi:[1,0,0]
    v_pk_fma_f32 v[42:43], v[34:35], v[34:35], v[42:43] neg_lo:[1,0,0] neg_hi:[1,0,0]
    v_pk_fma_f32 v[44:45], v[36:37], v[36:37], v[44:45] neg_lo:[1,0,0] neg_hi:[1,0,0]
    v_pk_fma_f32 v[46:47], v[38:39], v[38:39], v[46:47] neg_lo:[1,0,0] neg_hi:[1,0,0]
    v_pk_fma_f32 v[48:49], v[32:33], v[128:129], v[48:49] neg_lo:[1,0,0] neg_hi:[1,0,0]
    v_pk_fma_f32 v[50:51], v[34:35], v[128:129], v[50:51] neg_lo:[1,0,0] neg_hi:[1,0,0]
    v_pk_fma_f32 v[52:53], v[36:37], v[128:129], v[52:53] neg_lo:[1,0,0] neg_hi:[1,0,0]
    v_pk_fma_f32 v[54:55], v[38:39], v[128:129], v[54:55] neg_lo:[1,0,0] neg_hi:[1,0,0]
    v_max_f32 v40, v40, v132
    v_max_f32 v42, v42, v132
    v_max_f32 v44, v44, v132
    v_max_f32 v46, v46, v132
    v_max_f32 v41, v41, v132
    v_max_f32 v43, v43, v132
    v_max_f32 v45, v45, v132
    v_max_f32 v47, v47, v132
    v_rsq_f32 v40, v40
    v_rsq_f32 v42, v42
    v_rsq_f32 v44, v44
    v_rsq_f32 v46, v46
    v_rsq_f32 v41, v41
    v_rsq_f32 v43, v43
    v_rsq_f32 v45, v45
    v_rsq_f32 v47, v47
    v_pk_mul_f32 v[48:49], v[48:49], v[40:41]
    v_pk_mul_f32 v[50:51], v[50:51], v[42:43]
    v_pk_mul_f32 v[52:53], v[52:53], v[44:45]
    v_pk_mul_f32 v[54:55], v[54:55], v[46:47]
    v_and_or_b32 v48, v48, s33, 0
    v_and_or_b32 v50, v50, s33, 2
    v_and_or_b32 v52, v52, s33, 4
    v_and_or_b32 v54, v54, s33, 6
    v_and_or_b32 v49, v49, s33, 1
    v_and_or_b32 v51, v51, s33, 3
    v_and_or_b32 v53, v53, s33, 5
    v_and_or_b32 v55, v55, s33, 7
    v_max_f32 v136, v48, v49
    v_min_f32 v137, v48, v49
    v_med3_f32 v137, v136, v50, v137
    v_max_f32_e64 v136, v136, v50
    v_med3_f32 v137, v136, v51, v137
    v_max_f32_e64 v136, v136, v51
    v_med3_f32 v137, v136, v52, v137
    v_max_f32_e64 v136, v136, v52
    v_med3_f32 v137, v136, v53, v137
    v_max_f32_e64 v136, v136, v53
    v_med3_f32 v137, v136, v54, v137
    v_max_f32_e64 v136, v136, v54
    v_med3_f32 v137, v136, v55, v137
    v_max_f32 v136, v136, v55
    v_or_b32 v136, v141, v136
    v_or_b32 v137, v141, v137
    s_nop 1
    v_mov_b32_dpp v138, v136 quad_perm:[1,0,3,2] row_mask:0xf bank_mask:0xf
    v_mov_b32_dpp v139, v137 quad_perm:[1,0,3,2] row_mask:0xf bank_mask:0xf
    v_min_f32 v140, v136, v138
    v_max_f32 v136, v136, v138
    v_max3_f32 v137, v140, v137, v139
    s_nop 1
    v_mov_b32_dpp v138, v136 quad_perm:[2,3,0,1] row_mask:0xf bank_mask:0xf
    v_mov_b32_dpp v139, v137 quad_perm:[2,3,0,1] row_mask:0xf bank_mask:0xf
    v_min_f32 v140, v136, v138
    v_max_f32_e64 v136, v136, v138
    v_max3_f32 v137, v140, v137, v139
    s_nop 1
    v_mov_b32_dpp v138, v136 row_half_mirror row_mask:0xf bank_mask:0xf
    v_mov_b32_dpp v139, v137 row_half_mirror row_mask:0xf bank_mask:0xf
    v_min_f32 v140, v136, v138
    v_max_f32_e64 v136, v136, v138
    v_max3_f32 v137, v140, v137, v139
    s_nop 1
    v_mov_b32_dpp v138, v136 row_mirror row_mask:0xf bank_mask:0xf
    v_mov_b32_dpp v139, v137 row_mirror row_mask:0xf bank_mask:0xf
    v_min_f32 v140, v136, v138
    v_max_f32_e64 v136, v136, v138
    v_max3_f32 v137, v140, v137, v139
    v_mov_b32 v138, v136
    v_mov_b32 v139, v137
    s_nop 1
    v_permlane16_swap_b32 v136, v138
    v_permlane16_swap_b32 v137, v139
    s_nop 0
    v_min_f32 v140, v136, v138
    v_max_f32 v136, v136, v138
    v_max3_f32 v137, v140, v137, v139
    v_mov_b32 v138, v136
    v_mov_b32 v139, v137
    s_nop 1
    v_permlane32_swap_b32 v136, v138
    v_permlane32_swap_b32 v137, v139
    s_nop 0
    v_min_f32 v140, v136, v138
    v_max_f32 v136, v136, v138
    v_max3_f32 v137, v140, v137, v139
    v_mov_b32_e64 v234, s7
    ds_write_b64 v234, v[136:137]
    v_mov_b32 v234, 106512
    s_waitcnt lgkmcnt(0)
    s_barrier
    ds_read_b128 v[56:59], v234
    ds_read_b128 v[60:63], v234 offset:16
    s_waitcnt lgkmcnt(0)
    v_min_f32 v140, v56, v58
    v_max_f32_e64 v56, v56, v58
    v_max3_f32 v57, v140, v57, v59
    v_min_f32 v140, v60, v62
    v_max_f32 v60, v60, v62
    v_max3_f32 v61, v140, v61, v63
    v_min_f32 v140, v56, v60
    v_max_f32 v56, v56, v60
    v_max3_f32 v57, v140, v57, v61
    v_bfe_u32 v234, v56, 5, 6
    v_bfe_u32 v235, v56, 2, 3
    v_and_b32_e64 v8, 3, v56
    v_lshl_add_u32 v8, v234, 2, v8
    v_lshl_add_u32 v8, v235, 8, v8
    v_bfe_u32 v234, v57, 5, 6
    v_bfe_u32 v235, v57, 2, 3
    v_and_b32_e64 v10, 3, v57
    v_lshl_add_u32 v10, v234, 2, v10
    v_lshl_add_u32 v10, v235, 8, v10
    s_cmp_lt_u32 s3, 2
    s_cselect_b64 vcc, -1, 0
    v_lshlrev_b32 v236, 4, v230
    v_cndmask_b32 v142, v10, v8, vcc
    v_lshlrev_b32_e64 v234, 2, v142
    v_and_b32 v235, 2047, v236
    v_lshl_add_u32 v235, v142, 11, v235
    s_mov_b32 s32, 0x3400000
    buffer_load_dwordx4 v[32:35], v235, s[8:11], s32 offen sc1
    buffer_load_dword v144, v234, s[8:11], s48 offen sc1
    buffer_load_dword v145, v234, s[8:11], s49 offen sc1
    buffer_load_dword v146, v234, s[8:11], s50 offen sc1
    v_add_u32 v236, 98304, v236
    s_lshr_b32 s32, s3, 1
    s_lshl_b32 s32, s32, 2
    s_add_u32 s32, s32, 106496
    v_mov_b32 v234, s32
    s_waitcnt vmcnt(4)
    v_mul_f32 v0, 0x3a800000, v0
    v_mul_f32 v1, 0x3a800000, v1
    v_mul_f32 v2, 0x3a800000, v2
    v_mul_f32 v3, 0x3a800000, v3
    v_mul_f32 v4, 0x3a800000, v4
    v_mul_f32 v5, 0x3a800000, v5
    v_mul_f32 v6, 0x3a800000, v6
    v_mul_f32 v7, 0x3a800000, v7
    v_fma_f32 v4, -v0, v0, v4
    v_fma_f32 v5, -v1, v1, v5
    v_fma_f32 v6, -v2, v2, v6
    v_fma_f32 v7, -v3, v3, v7
    v_max_f32 v4, 0, v4
    v_max_f32 v5, 0, v5
    v_max_f32 v6, 0, v6
    v_max_f32 v7, 0, v7
    v_cvt_pk_bf16_f32 v12, v0, v4
    v_cvt_pk_bf16_f32 v13, v1, v5
    v_cvt_pk_bf16_f32 v14, v2, v6
    v_cvt_pk_bf16_f32 v15, v3, v7
    v_lshlrev_b32 v0, 16, v12
    v_lshlrev_b32 v1, 16, v13
    v_lshlrev_b32 v2, 16, v14
    v_lshlrev_b32 v3, 16, v15
    v_and_b32 v4, 0xffff0000, v12
    v_and_b32 v5, 0xffff0000, v13
    v_and_b32 v6, 0xffff0000, v14
    v_and_b32 v7, 0xffff0000, v15
    v_add_f32 v4, 0x3727c5ac, v4
    v_add_f32 v5, 0x3727c5ac, v5
    v_add_f32 v6, 0x3727c5ac, v6
    v_add_f32 v7, 0x3727c5ac, v7
    v_cvt_pk_bf16_f32 v4, v4, v4
    v_cvt_pk_bf16_f32 v5, v5, v5
    v_cvt_pk_bf16_f32 v6, v6, v6
    v_cvt_pk_bf16_f32 v7, v7, v7
    v_lshlrev_b32 v4, 16, v4
    v_lshlrev_b32 v5, 16, v5
    v_lshlrev_b32 v6, 16, v6
    v_lshlrev_b32 v7, 16, v7
    v_sqrt_f32 v4, v4
    v_sqrt_f32 v5, v5
    v_sqrt_f32 v6, v6
    v_sqrt_f32 v7, v7
    v_cvt_pk_bf16_f32 v4, v4, v4
    v_cvt_pk_bf16_f32 v5, v5, v5
    v_cvt_pk_bf16_f32 v6, v6, v6
    v_cvt_pk_bf16_f32 v7, v7, v7
    v_lshlrev_b32 v4, 16, v4
    v_lshlrev_b32 v5, 16, v5
    v_lshlrev_b32 v6, 16, v6
    v_lshlrev_b32 v7, 16, v7
    v_rcp_f32 v4, v4
    v_rcp_f32 v5, v5
    v_rcp_f32 v6, v6
    v_rcp_f32_e64 v7, v7
    s_waitcnt vmcnt(0)
    v_mul_f32 v144, 0x3a800000, v144
    v_mul_f32 v145, 0x3a800000, v145
    v_fma_f32 v145, -v144, v144, v145
    v_max_f32_e64 v145, 0, v145
    v_cvt_pk_bf16_f32 v140, v144, v145
    v_lshlrev_b32_e64 v144, 16, v140
    v_and_b32 v145, 0xffff0000, v140
    v_add_f32 v145, 0x3727c5ac, v145
    v_cvt_pk_bf16_f32 v145, v145, v145
    v_lshlrev_b32_e64 v145, 16, v145
    v_sqrt_f32 v145, v145
    s_nop 0
    v_cvt_pk_bf16_f32 v145, v145, v145
    v_lshlrev_b32 v145, 16, v145
    v_rcp_f32 v145, v145
    s_nop 0
    v_lshlrev_b32 v64, 16, v32
    v_lshlrev_b32 v66, 16, v33
    v_lshlrev_b32 v68, 16, v34
    v_lshlrev_b32_e64 v70, 16, v35
    v_and_b32 v65, 0xffff0000, v32
    v_and_b32 v67, 0xffff0000, v33
    v_and_b32 v69, 0xffff0000, v34
    v_and_b32 v71, 0xffff0000, v35
    v_sub_f32 v64, v64, v144
    v_sub_f32 v66, v66, v144
    v_sub_f32 v68, v68, v144
    v_sub_f32 v70, v70, v144
    v_sub_f32 v65, v65, v144
    v_sub_f32 v67, v67, v144
    v_sub_f32 v69, v69, v144
    v_sub_f32 v71, v71, v144
    v_cvt_pk_bf16_f32 v65, v64, v65
    v_cvt_pk_bf16_f32 v67, v66, v67
    v_cvt_pk_bf16_f32 v69, v68, v69
    v_cvt_pk_bf16_f32 v71, v70, v71
    v_lshlrev_b32 v64, 16, v65
    v_lshlrev_b32 v66, 16, v67
    v_lshlrev_b32 v68, 16, v69
    v_lshlrev_b32 v70, 16, v71
    v_and_b32 v65, 0xffff0000, v65
    v_and_b32 v67, 0xffff0000, v67
    v_and_b32 v69, 0xffff0000, v69
    v_and_b32 v71, 0xffff0000, v71
    v_mul_f32 v64, v64, v145
    v_mul_f32 v66, v66, v145
    v_mul_f32 v68, v68, v145
    v_mul_f32 v70, v70, v145
    v_mul_f32 v65, v65, v145
    v_mul_f32 v67, v67, v145
    v_mul_f32 v69, v69, v145
    v_mul_f32 v71, v71, v145
    v_cvt_pk_bf16_f32 v48, v64, v65
    v_cvt_pk_bf16_f32 v49, v66, v67
    v_cvt_pk_bf16_f32 v50, v68, v69
    v_cvt_pk_bf16_f32 v51, v70, v71
    ds_write_b128 v236, v[48:51]
    ds_write_b128 v236, v[32:35] offset:4096
    v_fma_f32 v143, -v144, v128, v146
    v_mul_f32_e64 v143, v143, v145
    ds_write_b32 v234, v143
    s_waitcnt lgkmcnt(0)
kc_com:
    s_barrier
    s_cmp_ge_u32 s53, 28
    s_cbranch_scc1 kc_red
    ds_read_b64 v[96:97], v218 offset:0
    ds_read_b64 v[98:99], v218 offset:16
    ds_read_b64 v[100:101], v218 offset:64
    ds_read_b64 v[102:103], v218 offset:80
    ds_read_b64 v[104:105], v218 offset:128
    ds_read_b64 v[106:107], v218 offset:144
    ds_read_b64 v[108:109], v218 offset:192
    ds_read_b64 v[110:111], v218 offset:208
    ds_read_b64 v[112:113], v218 offset:256
    ds_read_b64 v[114:115], v218 offset:272
    ds_read_b64 v[116:117], v218 offset:320
    ds_read_b64 v[118:119], v218 offset:336
    ds_read_b64 v[120:121], v218 offset:384
    ds_read_b64 v[122:123], v218 offset:400
    s_waitcnt lgkmcnt(12)
    ds_read_b64 v[124:125], v218 offset:448
    ds_read_b64 v[126:127], v218 offset:464
    v_mfma_f32_16x16x32_bf16 v[128:131], a[0:3], v[96:99], 0
    v_mfma_f32_16x16x32_bf16 v[132:135], a[32:35], v[96:99], 0
    s_waitcnt lgkmcnt(12)
    v_mfma_f32_16x16x32_bf16 v[128:131], a[4:7], v[100:103], v[128:131]
    v_mfma_f32_16x16x32_bf16 v[132:135], a[36:39], v[100:103], v[132:135]
    s_waitcnt lgkmcnt(10)
    v_mfma_f32_16x16x32_bf16 v[128:131], a[8:11], v[104:107], v[128:131]
    v_mfma_f32_16x16x32_bf16 v[132:135], a[40:43], v[104:107], v[132:135]
    s_waitcnt lgkmcnt(8)
    v_mfma_f32_16x16x32_bf16 v[128:131], a[12:15], v[108:111], v[128:131]
    v_mfma_f32_16x16x32_bf16 v[132:135], a[44:47], v[108:111], v[132:135]
    s_waitcnt lgkmcnt(6)
    v_mfma_f32_16x16x32_bf16 v[128:131], a[16:19], v[112:115], v[128:131]
    v_mfma_f32_16x16x32_bf16 v[132:135], a[48:51], v[112:115], v[132:135]
    s_waitcnt lgkmcnt(4)
    v_mfma_f32_16x16x32_bf16 v[128:131], a[20:23], v[116:119], v[128:131]
    v_mfma_f32_16x16x32_bf16 v[132:135], a[52:55], v[116:119], v[132:135]
    s_waitcnt lgkmcnt(2)
    v_mfma_f32_16x16x32_bf16 v[128:131], a[24:27], v[120:123], v[128:131]
    v_mfma_f32_16x16x32_bf16 v[132:135], a[56:59], v[120:123], v[132:135]
    s_waitcnt lgkmcnt(0)
    v_mfma_f32_16x16x32_bf16 v[128:131], a[28:31], v[124:127], v[128:131]
    v_mfma_f32_16x16x32_bf16 v[132:135], a[60:63], v[124:127], v[132:135]
    s_nop 6
    ds_write_b128 v220, v[128:131]
    ds_write_b128 v220, v[132:135] offset:4096
    s_waitcnt lgkmcnt(0)
    s_barrier
    ds_read_b128 v[32:35], v221 offset:0
    ds_read_b128 v[48:51], v221 offset:4096
    ds_read_b128 v[36:39], v221 offset:1024
    ds_read_b128 v[52:55], v221 offset:5120
    ds_read_b128 v[40:43], v221 offset:2048
    ds_read_b128 v[56:59], v221 offset:6144
    ds_read_b128 v[44:47], v221 offset:3072
    ds_read_b128 v[60:63], v221 offset:7168
    s_waitcnt lgkmcnt(0)
    v_add_f32 v32, v32, v36
    v_add_f32 v33, v33, v37
    v_add_f32 v34, v34, v38
    v_add_f32 v35, v35, v39
    v_add_f32 v40, v40, v44
    v_add_f32 v41, v41, v45
    v_add_f32 v42, v42, v46
    v_add_f32 v43, v43, v47
    v_add_f32 v48, v48, v52
    v_add_f32 v49, v49, v53
    v_add_f32 v50, v50, v54
    v_add_f32 v51, v51, v55
    v_add_f32 v56, v56, v60
    v_add_f32 v57, v57, v61
    v_add_f32 v58, v58, v62
    v_add_f32 v59, v59, v63
    v_add_f32 v32, v32, v40
    v_add_f32 v33, v33, v41
    v_add_f32 v34, v34, v42
    v_add_f32 v35, v35, v43
    v_add_f32 v48, v48, v56
    v_add_f32 v49, v49, v57
    v_add_f32 v50, v50, v58
    v_add_f32 v51, v51, v59
    v_cvt_pk_bf16_f32 v48, v32, v48
    v_cvt_pk_bf16_f32 v49, v33, v49
    v_cvt_pk_bf16_f32 v50, v34, v50
    v_cvt_pk_bf16_f32 v51, v35, v51
    v_lshlrev_b32 v32, 16, v48
    v_lshlrev_b32 v33, 16, v49
    v_lshlrev_b32 v34, 16, v50
    v_lshlrev_b32 v35, 16, v51
    v_and_b32 v48, 0xffff0000, v48
    v_and_b32 v49, 0xffff0000, v49
    v_and_b32 v50, 0xffff0000, v50
    v_and_b32 v51, 0xffff0000, v51
    v_mul_f32 v136, 0xbfb8aa3b, v32
    v_mul_f32 v137, 0xbfb8aa3b, v33
    v_mul_f32 v138, 0xbfb8aa3b, v34
    v_mul_f32 v139, 0xbfb8aa3b, v35
    v_exp_f32 v136, v136
    v_exp_f32 v137, v137
    v_exp_f32 v138, v138
    v_exp_f32 v139, v139
    v_add_f32 v136, 1.0, v136
    v_add_f32 v137, 1.0, v137
    v_add_f32 v138, 1.0, v138
    v_add_f32 v139, 1.0, v139
    v_rcp_f32 v136, v136
    v_rcp_f32 v137, v137
    v_rcp_f32 v138, v138
    v_rcp_f32 v139, v139
    v_mul_f32 v32, v32, v136
    v_mul_f32 v33, v33, v137
    v_mul_f32 v34, v34, v138
    v_mul_f32 v35, v35, v139
    v_cvt_pk_bf16_f32 v32, v32, v32
    v_cvt_pk_bf16_f32 v33, v33, v33
    v_cvt_pk_bf16_f32 v34, v34, v34
    v_cvt_pk_bf16_f32 v35, v35, v35
    v_lshlrev_b32 v32, 16, v32
    v_lshlrev_b32 v33, 16, v33
    v_lshlrev_b32 v34, 16, v34
    v_lshlrev_b32 v35, 16, v35
    v_mul_f32 v32, v32, v48
    v_mul_f32 v33, v33, v49
    v_mul_f32 v34, v34, v50
    v_mul_f32 v35, v35, v51
    v_cvt_pk_bf16_f32 v128, v32, v33
    v_cvt_pk_bf16_f32 v129, v34, v35
    s_nop 1
    v_mfma_f32_16x16x16_bf16 v[64:67], a[64:65], v[128:129], 0
    v_mfma_f32_16x16x16_bf16 v[68:71], a[66:67], v[128:129], 0
    v_mfma_f32_16x16x16_bf16 v[72:75], a[68:69], v[128:129], 0
    v_mfma_f32_16x16x16_bf16 v[76:79], a[70:71], v[128:129], 0
    v_mfma_f32_16x16x16_bf16 v[80:83], a[72:73], v[128:129], 0
    v_mfma_f32_16x16x16_bf16 v[84:87], a[74:75], v[128:129], 0
    v_mfma_f32_16x16x16_bf16 v[88:91], a[76:77], v[128:129], 0
    v_mfma_f32_16x16x16_bf16 v[92:95], a[78:79], v[128:129], 0
    v_mfma_f32_16x16x16_bf16 v[96:99], a[80:81], v[128:129], 0
    ds_write_b128 v222, v[64:67] offset:0
    v_mfma_f32_16x16x16_bf16 v[100:103], a[82:83], v[128:129], 0
    ds_write_b128 v222, v[68:71] offset:64
    v_mfma_f32_16x16x16_bf16 v[104:107], a[84:85], v[128:129], 0
    ds_write_b128 v222, v[72:75] offset:128
    v_mfma_f32_16x16x16_bf16 v[108:111], a[86:87], v[128:129], 0
    ds_write_b128 v222, v[76:79] offset:192
    v_mfma_f32_16x16x16_bf16 v[112:115], a[88:89], v[128:129], 0
    ds_write_b128 v222, v[80:83] offset:256
    v_mfma_f32_16x16x16_bf16 v[116:119], a[90:91], v[128:129], 0
    ds_write_b128 v222, v[84:87] offset:320
    v_mfma_f32_16x16x16_bf16 v[120:123], a[92:93], v[128:129], 0
    ds_write_b128 v222, v[88:91] offset:384
    v_mfma_f32_16x16x16_bf16 v[124:127], a[94:95], v[128:129], 0
    ds_write_b128 v222, v[92:95] offset:448
    s_waitcnt lgkmcnt(4)
    ds_write_b128 v222, v[96:99] offset:512
    ds_write_b128 v222, v[100:103] offset:576
    ds_write_b128 v222, v[104:107] offset:640
    ds_write_b128 v222, v[108:111] offset:704
    ds_write_b128 v222, v[112:115] offset:768
    ds_write_b128 v222, v[116:119] offset:832
    ds_write_b128 v222, v[120:123] offset:896
    ds_write_b128 v222, v[124:127] offset:960
    s_lshl_b32 s32, s54, 13
    s_lshl_b32 s33, s3, 10
    s_add_u32 s32, s32, s33
    s_add_u32 s32, s32, 0x3900000
    s_add_u32 s33, s32, 4096
    s_waitcnt lgkmcnt(0)
    ds_read_b128 v[32:35], v223
    ds_read_b128 v[36:39], v223 offset:1024
    s_waitcnt lgkmcnt(1)
    buffer_store_dwordx4 v[32:35], v228, s[8:11], s32 offen sc1
    s_waitcnt lgkmcnt(0)
    buffer_store_dwordx4 v[36:39], v228, s[8:11], s33 offen sc1
    v_lshlrev_b32 v144, 16, v16
    v_lshlrev_b32 v148, 16, v17
    v_lshlrev_b32 v152, 16, v18
    v_lshlrev_b32 v156, 16, v19
    v_and_b32 v145, 0xffff0000, v16
    v_and_b32 v149, 0xffff0000, v17
    v_and_b32 v153, 0xffff0000, v18
    v_and_b32 v157, 0xffff0000, v19
    v_sub_f32 v144, v144, v0
    v_sub_f32 v148, v148, v0
    v_sub_f32 v152, v152, v0
    v_sub_f32 v156, v156, v0
    v_sub_f32 v145, v145, v0
    v_sub_f32 v149, v149, v0
    v_sub_f32 v153, v153, v0
    v_sub_f32 v157, v157, v0
    v_cvt_pk_bf16_f32 v145, v144, v145
    v_cvt_pk_bf16_f32 v149, v148, v149
    v_cvt_pk_bf16_f32 v153, v152, v153
    v_cvt_pk_bf16_f32 v157, v156, v157
    v_lshlrev_b32 v144, 16, v145
    v_lshlrev_b32 v148, 16, v149
    v_lshlrev_b32 v152, 16, v153
    v_lshlrev_b32 v156, 16, v157
    v_and_b32 v145, 0xffff0000, v145
    v_and_b32 v149, 0xffff0000, v149
    v_and_b32 v153, 0xffff0000, v153
    v_and_b32 v157, 0xffff0000, v157
    v_mul_f32 v144, v144, v4
    v_mul_f32 v148, v148, v4
    v_mul_f32 v152, v152, v4
    v_mul_f32 v156, v156, v4
    v_mul_f32 v145, v145, v4
    v_mul_f32 v149, v149, v4
    v_mul_f32 v153, v153, v4
    v_mul_f32 v157, v157, v4
    v_cvt_pk_bf16_f32 v146, v144, v145
    v_cvt_pk_bf16_f32 v150, v148, v149
    v_cvt_pk_bf16_f32 v154, v152, v153
    v_cvt_pk_bf16_f32 v158, v156, v157
    v_lshlrev_b32 v144, 16, v146
    v_lshlrev_b32 v148, 16, v150
    v_lshlrev_b32 v152, 16, v154
    v_lshlrev_b32 v156, 16, v158
    v_and_b32 v145, 0xffff0000, v146
    v_and_b32 v149, 0xffff0000, v150
    v_and_b32 v153, 0xffff0000, v154
    v_and_b32 v157, 0xffff0000, v158
    v_lshlrev_b32 v146, 16, v16
    v_lshlrev_b32 v150, 16, v17
    v_lshlrev_b32 v154, 16, v18
    v_lshlrev_b32 v158, 16, v19
    v_and_b32 v147, 0xffff0000, v16
    v_and_b32 v151, 0xffff0000, v17
    v_and_b32 v155, 0xffff0000, v18
    v_and_b32 v159, 0xffff0000, v19
    v_pk_add_f32 v[144:145], v[144:145], v[146:147]
    v_pk_add_f32 v[148:149], v[148:149], v[150:151]
    v_pk_add_f32 v[152:153], v[152:153], v[154:155]
    v_pk_add_f32 v[156:157], v[156:157], v[158:159]
    v_cvt_pk_bf16_f32 v16, v144, v145
    v_cvt_pk_bf16_f32 v17, v148, v149
    v_cvt_pk_bf16_f32 v18, v152, v153
    v_cvt_pk_bf16_f32 v19, v156, v157
    v_add_u32 v160, 0, v242
    v_cmp_eq_u32 vcc, v160, v8
    v_cmp_eq_u32 s[60:61], v160, v10
    v_mov_b32 v161, 0x40000000
    s_or_b64 vcc, vcc, s[60:61]
    v_cndmask_b32 v12, v229, v161, vcc
    v_lshlrev_b32 v144, 16, v20
    v_lshlrev_b32 v148, 16, v21
    v_lshlrev_b32 v152, 16, v22
    v_lshlrev_b32_e64 v156, 16, v23
    v_and_b32 v145, 0xffff0000, v20
    v_and_b32 v149, 0xffff0000, v21
    v_and_b32 v153, 0xffff0000, v22
    v_and_b32 v157, 0xffff0000, v23
    v_sub_f32 v144, v144, v1
    v_sub_f32 v148, v148, v1
    v_sub_f32 v152, v152, v1
    v_sub_f32 v156, v156, v1
    v_sub_f32 v145, v145, v1
    v_sub_f32 v149, v149, v1
    v_sub_f32 v153, v153, v1
    v_sub_f32 v157, v157, v1
    v_cvt_pk_bf16_f32 v145, v144, v145
    v_cvt_pk_bf16_f32 v149, v148, v149
    v_cvt_pk_bf16_f32 v153, v152, v153
    v_cvt_pk_bf16_f32 v157, v156, v157
    v_lshlrev_b32 v144, 16, v145
    v_lshlrev_b32 v148, 16, v149
    v_lshlrev_b32 v152, 16, v153
    v_lshlrev_b32 v156, 16, v157
    v_and_b32 v145, 0xffff0000, v145
    v_and_b32 v149, 0xffff0000, v149
    v_and_b32 v153, 0xffff0000, v153
    v_and_b32 v157, 0xffff0000, v157
    v_mul_f32 v144, v144, v5
    v_mul_f32 v148, v148, v5
    v_mul_f32 v152, v152, v5
    v_mul_f32 v156, v156, v5
    v_mul_f32 v145, v145, v5
    v_mul_f32 v149, v149, v5
    v_mul_f32 v153, v153, v5
    v_mul_f32 v157, v157, v5
    v_cvt_pk_bf16_f32 v146, v144, v145
    v_cvt_pk_bf16_f32 v150, v148, v149
    v_cvt_pk_bf16_f32 v154, v152, v153
    v_cvt_pk_bf16_f32 v158, v156, v157
    v_lshlrev_b32 v144, 16, v146
    v_lshlrev_b32 v148, 16, v150
    v_lshlrev_b32 v152, 16, v154
    v_lshlrev_b32 v156, 16, v158
    v_and_b32 v145, 0xffff0000, v146
    v_and_b32 v149, 0xffff0000, v150
    v_and_b32 v153, 0xffff0000, v154
    v_and_b32 v157, 0xffff0000, v158
    v_lshlrev_b32 v146, 16, v20
    v_lshlrev_b32 v150, 16, v21
    v_lshlrev_b32 v154, 16, v22
    v_lshlrev_b32 v158, 16, v23
    v_and_b32 v147, 0xffff0000, v20
    v_and_b32 v151, 0xffff0000, v21
    v_and_b32 v155, 0xffff0000, v22
    v_and_b32 v159, 0xffff0000, v23
    v_pk_add_f32 v[144:145], v[144:145], v[146:147]
    v_pk_add_f32 v[148:149], v[148:149], v[150:151]
    v_pk_add_f32 v[152:153], v[152:153], v[154:155]
    v_pk_add_f32 v[156:157], v[156:157], v[158:159]
    v_cvt_pk_bf16_f32 v20, v144, v145
    v_cvt_pk_bf16_f32 v21, v148, v149
    v_cvt_pk_bf16_f32 v22, v152, v153
    v_cvt_pk_bf16_f32 v23, v156, v157
    v_add_u32 v160, 8, v242
    v_cmp_eq_u32 vcc, v160, v8
    v_cmp_eq_u32 s[60:61], v160, v10
    v_mov_b32 v161, 0x40000000
    s_or_b64 vcc, vcc, s[60:61]
    v_cndmask_b32 v13, v229, v161, vcc
    s_waitcnt vmcnt(0)
    s_barrier
    s_cmp_lg_u32 s3, 0
    s_cbranch_scc1 kc_a2
    s_lshl_b32 s32, s52, 7
    s_add_u32 s32, s32, 0x38a0800
    v_mov_b32_e64 v235, 1
    buffer_atomic_add v235, v243, s[8:11], s32 offen sc0 sc1
    v_lshlrev_b32 v234, 7, v237
    v_cmp_gt_u32 vcc, 8, v237
    v_mov_b32_e64 v236, 0x40000000
    s_mov_b32 s34, 0x38a0c00
    v_cndmask_b32 v234, v236, v234, vcc
    s_waitcnt vmcnt(0)
    v_readfirstlane_b32 s36, v235
    s_cmp_lg_u32 s36, 27
    s_cbranch_scc1 kc_a2
    buffer_atomic_add v233, v234, s[8:11], s34 offen sc1
kc_a2:
    v_lshlrev_b32 v144, 16, v24
    v_lshlrev_b32 v148, 16, v25
    v_lshlrev_b32 v152, 16, v26
    v_lshlrev_b32_e64 v156, 16, v27
    v_and_b32 v145, 0xffff0000, v24
    v_and_b32 v149, 0xffff0000, v25
    v_and_b32 v153, 0xffff0000, v26
    v_and_b32 v157, 0xffff0000, v27
    v_sub_f32 v144, v144, v2
    v_sub_f32 v148, v148, v2
    v_sub_f32 v152, v152, v2
    v_sub_f32 v156, v156, v2
    v_sub_f32 v145, v145, v2
    v_sub_f32 v149, v149, v2
    v_sub_f32 v153, v153, v2
    v_sub_f32 v157, v157, v2
    v_cvt_pk_bf16_f32 v145, v144, v145
    v_cvt_pk_bf16_f32 v149, v148, v149
    v_cvt_pk_bf16_f32 v153, v152, v153
    v_cvt_pk_bf16_f32 v157, v156, v157
    v_lshlrev_b32 v144, 16, v145
    v_lshlrev_b32 v148, 16, v149
    v_lshlrev_b32 v152, 16, v153
    v_lshlrev_b32 v156, 16, v157
    v_and_b32 v145, 0xffff0000, v145
    v_and_b32 v149, 0xffff0000, v149
    v_and_b32 v153, 0xffff0000, v153
    v_and_b32 v157, 0xffff0000, v157
    v_mul_f32 v144, v144, v6
    v_mul_f32 v148, v148, v6
    v_mul_f32 v152, v152, v6
    v_mul_f32 v156, v156, v6
    v_mul_f32 v145, v145, v6
    v_mul_f32 v149, v149, v6
    v_mul_f32 v153, v153, v6
    v_mul_f32 v157, v157, v6
    v_cvt_pk_bf16_f32 v146, v144, v145
    v_cvt_pk_bf16_f32 v150, v148, v149
    v_cvt_pk_bf16_f32 v154, v152, v153
    v_cvt_pk_bf16_f32 v158, v156, v157
    v_lshlrev_b32 v144, 16, v146
    v_lshlrev_b32 v148, 16, v150
    v_lshlrev_b32 v152, 16, v154
    v_lshlrev_b32 v156, 16, v158
    v_and_b32 v145, 0xffff0000, v146
    v_and_b32 v149, 0xffff0000, v150
    v_and_b32 v153, 0xffff0000, v154
    v_and_b32 v157, 0xffff0000, v158
    v_lshlrev_b32 v146, 16, v24
    v_lshlrev_b32 v150, 16, v25
    v_lshlrev_b32 v154, 16, v26
    v_lshlrev_b32 v158, 16, v27
    v_and_b32 v147, 0xffff0000, v24
    v_and_b32 v151, 0xffff0000, v25
    v_and_b32 v155, 0xffff0000, v26
    v_and_b32 v159, 0xffff0000, v27
    v_pk_add_f32 v[144:145], v[144:145], v[146:147]
    v_pk_add_f32 v[148:149], v[148:149], v[150:151]
    v_pk_add_f32 v[152:153], v[152:153], v[154:155]
    v_pk_add_f32 v[156:157], v[156:157], v[158:159]
    v_cvt_pk_bf16_f32 v24, v144, v145
    v_cvt_pk_bf16_f32 v25, v148, v149
    v_cvt_pk_bf16_f32 v26, v152, v153
    v_cvt_pk_bf16_f32 v27, v156, v157
    v_add_u32 v160, 16, v242
    v_cmp_eq_u32 vcc, v160, v8
    v_cmp_eq_u32 s[60:61], v160, v10
    v_mov_b32 v161, 0x40000000
    s_or_b64 vcc, vcc, s[60:61]
    v_cndmask_b32 v14, v229, v161, vcc
    v_lshlrev_b32 v144, 16, v28
    v_lshlrev_b32 v148, 16, v29
    v_lshlrev_b32 v152, 16, v30
    v_lshlrev_b32_e64 v156, 16, v31
    v_and_b32 v145, 0xffff0000, v28
    v_and_b32 v149, 0xffff0000, v29
    v_and_b32 v153, 0xffff0000, v30
    v_and_b32 v157, 0xffff0000, v31
    v_sub_f32 v144, v144, v3
    v_sub_f32 v148, v148, v3
    v_sub_f32 v152, v152, v3
    v_sub_f32 v156, v156, v3
    v_sub_f32 v145, v145, v3
    v_sub_f32 v149, v149, v3
    v_sub_f32 v153, v153, v3
    v_sub_f32 v157, v157, v3
    v_cvt_pk_bf16_f32 v145, v144, v145
    v_cvt_pk_bf16_f32 v149, v148, v149
    v_cvt_pk_bf16_f32 v153, v152, v153
    v_cvt_pk_bf16_f32 v157, v156, v157
    v_lshlrev_b32 v144, 16, v145
    v_lshlrev_b32 v148, 16, v149
    v_lshlrev_b32 v152, 16, v153
    v_lshlrev_b32 v156, 16, v157
    v_and_b32 v145, 0xffff0000, v145
    v_and_b32 v149, 0xffff0000, v149
    v_and_b32 v153, 0xffff0000, v153
    v_and_b32 v157, 0xffff0000, v157
    v_mul_f32 v144, v144, v7
    v_mul_f32 v148, v148, v7
    v_mul_f32 v152, v152, v7
    v_mul_f32 v156, v156, v7
    v_mul_f32 v145, v145, v7
    v_mul_f32 v149, v149, v7
    v_mul_f32 v153, v153, v7
    v_mul_f32 v157, v157, v7
    v_cvt_pk_bf16_f32 v146, v144, v145
    v_cvt_pk_bf16_f32 v150, v148, v149
    v_cvt_pk_bf16_f32 v154, v152, v153
    v_cvt_pk_bf16_f32 v158, v156, v157
    v_lshlrev_b32 v144, 16, v146
    v_lshlrev_b32 v148, 16, v150
    v_lshlrev_b32 v152, 16, v154
    v_lshlrev_b32 v156, 16, v158
    v_and_b32 v145, 0xffff0000, v146
    v_and_b32 v149, 0xffff0000, v150
    v_and_b32 v153, 0xffff0000, v154
    v_and_b32 v157, 0xffff0000, v158
    v_lshlrev_b32 v146, 16, v28
    v_lshlrev_b32 v150, 16, v29
    v_lshlrev_b32 v154, 16, v30
    v_lshlrev_b32 v158, 16, v31
    v_and_b32 v147, 0xffff0000, v28
    v_and_b32 v151, 0xffff0000, v29
    v_and_b32 v155, 0xffff0000, v30
    v_and_b32 v159, 0xffff0000, v31
    v_pk_add_f32 v[144:145], v[144:145], v[146:147]
    v_pk_add_f32 v[148:149], v[148:149], v[150:151]
    v_pk_add_f32 v[152:153], v[152:153], v[154:155]
    v_pk_add_f32 v[156:157], v[156:157], v[158:159]
    v_cvt_pk_bf16_f32 v28, v144, v145
    v_cvt_pk_bf16_f32 v29, v148, v149
    v_cvt_pk_bf16_f32 v30, v152, v153
    v_cvt_pk_bf16_f32 v31, v156, v157
    v_add_u32 v160, 24, v242
    v_cmp_eq_u32 vcc, v160, v8
    v_cmp_eq_u32 s[60:61], v160, v10
    v_mov_b32 v161, 0x40000000
    s_or_b64 vcc, vcc, s[60:61]
    v_cndmask_b32 v15, v229, v161, vcc
    s_mov_b32 s32, 0
    buffer_store_dwordx4 v[16:19], v12, s[28:31], s32 offen nt
    s_mov_b32 s32, 16384
    buffer_store_dwordx4 v[20:23], v13, s[28:31], s32 offen nt
    s_mov_b32 s32, 32768
    buffer_store_dwordx4 v[24:27], v14, s[28:31], s32 offen nt
    s_mov_b32 s32, 49152
    buffer_store_dwordx4 v[28:31], v15, s[28:31], s32 offen nt
    s_branch kc_fin
kc_red:
    v_lshlrev_b32 v144, 16, v16
    v_lshlrev_b32 v148, 16, v17
    v_lshlrev_b32 v152, 16, v18
    v_lshlrev_b32_e64 v156, 16, v19
    v_and_b32 v145, 0xffff0000, v16
    v_and_b32 v149, 0xffff0000, v17
    v_and_b32 v153, 0xffff0000, v18
    v_and_b32 v157, 0xffff0000, v19
    v_sub_f32 v144, v144, v0
    v_sub_f32 v148, v148, v0
    v_sub_f32 v152, v152, v0
    v_sub_f32 v156, v156, v0
    v_sub_f32 v145, v145, v0
    v_sub_f32 v149, v149, v0
    v_sub_f32 v153, v153, v0
    v_sub_f32 v157, v157, v0
    v_cvt_pk_bf16_f32 v145, v144, v145
    v_cvt_pk_bf16_f32 v149, v148, v149
    v_cvt_pk_bf16_f32 v153, v152, v153
    v_cvt_pk_bf16_f32 v157, v156, v157
    v_lshlrev_b32 v144, 16, v145
    v_lshlrev_b32 v148, 16, v149
    v_lshlrev_b32 v152, 16, v153
    v_lshlrev_b32 v156, 16, v157
    v_and_b32 v145, 0xffff0000, v145
    v_and_b32 v149, 0xffff0000, v149
    v_and_b32 v153, 0xffff0000, v153
    v_and_b32 v157, 0xffff0000, v157
    v_mul_f32 v144, v144, v4
    v_mul_f32 v148, v148, v4
    v_mul_f32 v152, v152, v4
    v_mul_f32 v156, v156, v4
    v_mul_f32 v145, v145, v4
    v_mul_f32 v149, v149, v4
    v_mul_f32 v153, v153, v4
    v_mul_f32 v157, v157, v4
    v_cvt_pk_bf16_f32 v146, v144, v145
    v_cvt_pk_bf16_f32 v150, v148, v149
    v_cvt_pk_bf16_f32 v154, v152, v153
    v_cvt_pk_bf16_f32 v158, v156, v157
    v_lshlrev_b32 v144, 16, v146
    v_lshlrev_b32 v148, 16, v150
    v_lshlrev_b32 v152, 16, v154
    v_lshlrev_b32 v156, 16, v158
    v_and_b32 v145, 0xffff0000, v146
    v_and_b32 v149, 0xffff0000, v150
    v_and_b32 v153, 0xffff0000, v154
    v_and_b32 v157, 0xffff0000, v158
    v_lshlrev_b32 v146, 16, v16
    v_lshlrev_b32 v150, 16, v17
    v_lshlrev_b32 v154, 16, v18
    v_lshlrev_b32 v158, 16, v19
    v_and_b32 v147, 0xffff0000, v16
    v_and_b32 v151, 0xffff0000, v17
    v_and_b32 v155, 0xffff0000, v18
    v_and_b32 v159, 0xffff0000, v19
    v_pk_add_f32 v[144:145], v[144:145], v[146:147]
    v_pk_add_f32 v[148:149], v[148:149], v[150:151]
    v_pk_add_f32 v[152:153], v[152:153], v[154:155]
    v_pk_add_f32 v[156:157], v[156:157], v[158:159]
    v_cvt_pk_bf16_f32 v16, v144, v145
    v_cvt_pk_bf16_f32 v17, v148, v149
    v_cvt_pk_bf16_f32 v18, v152, v153
    v_cvt_pk_bf16_f32 v19, v156, v157
    v_add_u32 v160, 0, v242
    v_cmp_eq_u32 vcc, v160, v8
    v_cmp_eq_u32 s[60:61], v160, v10
    v_mov_b32 v161, 0x40000000
    s_or_b64 vcc, vcc, s[60:61]
    v_cndmask_b32 v12, v229, v161, vcc
    v_lshlrev_b32 v144, 16, v20
    v_lshlrev_b32 v148, 16, v21
    v_lshlrev_b32 v152, 16, v22
    v_lshlrev_b32_e64 v156, 16, v23
    v_and_b32 v145, 0xffff0000, v20
    v_and_b32 v149, 0xffff0000, v21
    v_and_b32 v153, 0xffff0000, v22
    v_and_b32 v157, 0xffff0000, v23
    v_sub_f32 v144, v144, v1
    v_sub_f32 v148, v148, v1
    v_sub_f32 v152, v152, v1
    v_sub_f32 v156, v156, v1
    v_sub_f32 v145, v145, v1
    v_sub_f32 v149, v149, v1
    v_sub_f32 v153, v153, v1
    v_sub_f32 v157, v157, v1
    v_cvt_pk_bf16_f32 v145, v144, v145
    v_cvt_pk_bf16_f32 v149, v148, v149
    v_cvt_pk_bf16_f32 v153, v152, v153
    v_cvt_pk_bf16_f32 v157, v156, v157
    v_lshlrev_b32 v144, 16, v145
    v_lshlrev_b32 v148, 16, v149
    v_lshlrev_b32 v152, 16, v153
    v_lshlrev_b32 v156, 16, v157
    v_and_b32 v145, 0xffff0000, v145
    v_and_b32 v149, 0xffff0000, v149
    v_and_b32 v153, 0xffff0000, v153
    v_and_b32 v157, 0xffff0000, v157
    v_mul_f32 v144, v144, v5
    v_mul_f32 v148, v148, v5
    v_mul_f32 v152, v152, v5
    v_mul_f32 v156, v156, v5
    v_mul_f32 v145, v145, v5
    v_mul_f32 v149, v149, v5
    v_mul_f32 v153, v153, v5
    v_mul_f32 v157, v157, v5
    v_cvt_pk_bf16_f32 v146, v144, v145
    v_cvt_pk_bf16_f32 v150, v148, v149
    v_cvt_pk_bf16_f32 v154, v152, v153
    v_cvt_pk_bf16_f32 v158, v156, v157
    v_lshlrev_b32 v144, 16, v146
    v_lshlrev_b32 v148, 16, v150
    v_lshlrev_b32 v152, 16, v154
    v_lshlrev_b32 v156, 16, v158
    v_and_b32 v145, 0xffff0000, v146
    v_and_b32 v149, 0xffff0000, v150
    v_and_b32 v153, 0xffff0000, v154
    v_and_b32 v157, 0xffff0000, v158
    v_lshlrev_b32 v146, 16, v20
    v_lshlrev_b32 v150, 16, v21
    v_lshlrev_b32 v154, 16, v22
    v_lshlrev_b32 v158, 16, v23
    v_and_b32 v147, 0xffff0000, v20
    v_and_b32 v151, 0xffff0000, v21
    v_and_b32 v155, 0xffff0000, v22
    v_and_b32 v159, 0xffff0000, v23
    v_pk_add_f32 v[144:145], v[144:145], v[146:147]
    v_pk_add_f32 v[148:149], v[148:149], v[150:151]
    v_pk_add_f32 v[152:153], v[152:153], v[154:155]
    v_pk_add_f32 v[156:157], v[156:157], v[158:159]
    v_cvt_pk_bf16_f32 v20, v144, v145
    v_cvt_pk_bf16_f32 v21, v148, v149
    v_cvt_pk_bf16_f32 v22, v152, v153
    v_cvt_pk_bf16_f32 v23, v156, v157
    v_add_u32 v160, 8, v242
    v_cmp_eq_u32 vcc, v160, v8
    v_cmp_eq_u32 s[60:61], v160, v10
    v_mov_b32 v161, 0x40000000
    s_or_b64 vcc, vcc, s[60:61]
    v_cndmask_b32 v13, v229, v161, vcc
    v_lshlrev_b32 v144, 16, v24
    v_lshlrev_b32 v148, 16, v25
    v_lshlrev_b32 v152, 16, v26
    v_lshlrev_b32_e64 v156, 16, v27
    v_and_b32 v145, 0xffff0000, v24
    v_and_b32 v149, 0xffff0000, v25
    v_and_b32 v153, 0xffff0000, v26
    v_and_b32 v157, 0xffff0000, v27
    v_sub_f32 v144, v144, v2
    v_sub_f32 v148, v148, v2
    v_sub_f32 v152, v152, v2
    v_sub_f32 v156, v156, v2
    v_sub_f32 v145, v145, v2
    v_sub_f32 v149, v149, v2
    v_sub_f32 v153, v153, v2
    v_sub_f32 v157, v157, v2
    v_cvt_pk_bf16_f32 v145, v144, v145
    v_cvt_pk_bf16_f32 v149, v148, v149
    v_cvt_pk_bf16_f32 v153, v152, v153
    v_cvt_pk_bf16_f32 v157, v156, v157
    v_lshlrev_b32 v144, 16, v145
    v_lshlrev_b32 v148, 16, v149
    v_lshlrev_b32 v152, 16, v153
    v_lshlrev_b32 v156, 16, v157
    v_and_b32 v145, 0xffff0000, v145
    v_and_b32 v149, 0xffff0000, v149
    v_and_b32 v153, 0xffff0000, v153
    v_and_b32 v157, 0xffff0000, v157
    v_mul_f32 v144, v144, v6
    v_mul_f32 v148, v148, v6
    v_mul_f32 v152, v152, v6
    v_mul_f32 v156, v156, v6
    v_mul_f32 v145, v145, v6
    v_mul_f32 v149, v149, v6
    v_mul_f32 v153, v153, v6
    v_mul_f32 v157, v157, v6
    v_cvt_pk_bf16_f32 v146, v144, v145
    v_cvt_pk_bf16_f32 v150, v148, v149
    v_cvt_pk_bf16_f32 v154, v152, v153
    v_cvt_pk_bf16_f32 v158, v156, v157
    v_lshlrev_b32 v144, 16, v146
    v_lshlrev_b32 v148, 16, v150
    v_lshlrev_b32 v152, 16, v154
    v_lshlrev_b32 v156, 16, v158
    v_and_b32 v145, 0xffff0000, v146
    v_and_b32 v149, 0xffff0000, v150
    v_and_b32 v153, 0xffff0000, v154
    v_and_b32 v157, 0xffff0000, v158
    v_lshlrev_b32 v146, 16, v24
    v_lshlrev_b32 v150, 16, v25
    v_lshlrev_b32 v154, 16, v26
    v_lshlrev_b32 v158, 16, v27
    v_and_b32 v147, 0xffff0000, v24
    v_and_b32 v151, 0xffff0000, v25
    v_and_b32 v155, 0xffff0000, v26
    v_and_b32 v159, 0xffff0000, v27
    v_pk_add_f32 v[144:145], v[144:145], v[146:147]
    v_pk_add_f32 v[148:149], v[148:149], v[150:151]
    v_pk_add_f32 v[152:153], v[152:153], v[154:155]
    v_pk_add_f32 v[156:157], v[156:157], v[158:159]
    v_cvt_pk_bf16_f32 v24, v144, v145
    v_cvt_pk_bf16_f32 v25, v148, v149
    v_cvt_pk_bf16_f32 v26, v152, v153
    v_cvt_pk_bf16_f32 v27, v156, v157
    v_add_u32 v160, 16, v242
    v_cmp_eq_u32 vcc, v160, v8
    v_cmp_eq_u32 s[60:61], v160, v10
    v_mov_b32 v161, 0x40000000
    s_or_b64 vcc, vcc, s[60:61]
    v_cndmask_b32 v14, v229, v161, vcc
    v_lshlrev_b32 v144, 16, v28
    v_lshlrev_b32 v148, 16, v29
    v_lshlrev_b32 v152, 16, v30
    v_lshlrev_b32_e64 v156, 16, v31
    v_and_b32 v145, 0xffff0000, v28
    v_and_b32 v149, 0xffff0000, v29
    v_and_b32 v153, 0xffff0000, v30
    v_and_b32 v157, 0xffff0000, v31
    v_sub_f32 v144, v144, v3
    v_sub_f32 v148, v148, v3
    v_sub_f32 v152, v152, v3
    v_sub_f32 v156, v156, v3
    v_sub_f32 v145, v145, v3
    v_sub_f32 v149, v149, v3
    v_sub_f32 v153, v153, v3
    v_sub_f32 v157, v157, v3
    v_cvt_pk_bf16_f32 v145, v144, v145
    v_cvt_pk_bf16_f32 v149, v148, v149
    v_cvt_pk_bf16_f32 v153, v152, v153
    v_cvt_pk_bf16_f32 v157, v156, v157
    v_lshlrev_b32 v144, 16, v145
    v_lshlrev_b32 v148, 16, v149
    v_lshlrev_b32 v152, 16, v153
    v_lshlrev_b32 v156, 16, v157
    v_and_b32 v145, 0xffff0000, v145
    v_and_b32 v149, 0xffff0000, v149
    v_and_b32 v153, 0xffff0000, v153
    v_and_b32 v157, 0xffff0000, v157
    v_mul_f32 v144, v144, v7
    v_mul_f32 v148, v148, v7
    v_mul_f32 v152, v152, v7
    v_mul_f32 v156, v156, v7
    v_mul_f32 v145, v145, v7
    v_mul_f32 v149, v149, v7
    v_mul_f32 v153, v153, v7
    v_mul_f32 v157, v157, v7
    v_cvt_pk_bf16_f32 v146, v144, v145
    v_cvt_pk_bf16_f32 v150, v148, v149
    v_cvt_pk_bf16_f32 v154, v152, v153
    v_cvt_pk_bf16_f32 v158, v156, v157
    v_lshlrev_b32 v144, 16, v146
    v_lshlrev_b32 v148, 16, v150
    v_lshlrev_b32 v152, 16, v154
    v_lshlrev_b32 v156, 16, v158
    v_and_b32 v145, 0xffff0000, v146
    v_and_b32 v149, 0xffff0000, v150
    v_and_b32 v153, 0xffff0000, v154
    v_and_b32 v157, 0xffff0000, v158
    v_lshlrev_b32 v146, 16, v28
    v_lshlrev_b32 v150, 16, v29
    v_lshlrev_b32 v154, 16, v30
    v_lshlrev_b32 v158, 16, v31
    v_and_b32 v147, 0xffff0000, v28
    v_and_b32 v151, 0xffff0000, v29
    v_and_b32 v155, 0xffff0000, v30
    v_and_b32 v159, 0xffff0000, v31
    v_pk_add_f32 v[144:145], v[144:145], v[146:147]
    v_pk_add_f32 v[148:149], v[148:149], v[150:151]
    v_pk_add_f32 v[152:153], v[152:153], v[154:155]
    v_pk_add_f32 v[156:157], v[156:157], v[158:159]
    v_cvt_pk_bf16_f32 v28, v144, v145
    v_cvt_pk_bf16_f32 v29, v148, v149
    v_cvt_pk_bf16_f32 v30, v152, v153
    v_cvt_pk_bf16_f32 v31, v156, v157
    v_add_u32 v160, 24, v242
    v_cmp_eq_u32 vcc, v160, v8
    v_cmp_eq_u32 s[60:61], v160, v10
    v_mov_b32 v161, 0x40000000
    s_or_b64 vcc, vcc, s[60:61]
    v_cndmask_b32 v15, v229, v161, vcc
    s_mov_b32 s32, 0
    buffer_store_dwordx4 v[16:19], v12, s[28:31], s32 offen nt
    s_mov_b32 s32, 16384
    buffer_store_dwordx4 v[20:23], v13, s[28:31], s32 offen nt
    s_mov_b32 s32, 32768
    buffer_store_dwordx4 v[24:27], v14, s[28:31], s32 offen nt
    s_mov_b32 s32, 49152
    buffer_store_dwordx4 v[28:31], v15, s[28:31], s32 offen nt
    s_sub_u32 s54, s2, 224
    v_lshrrev_b32 v234, 4, v230
    v_lshlrev_b32 v234, 13, v234
    v_and_b32_e64 v235, 15, v237
    v_lshl_add_u32 v217, v235, 4, v234
    s_lshl_b32 s35, s54, 8
    s_add_u32 s35, s35, 0x3900000
    v_bfe_u32 v234, v237, 4, 1
    v_lshrrev_b32 v236, 5, v237
    v_lshl_add_u32 v234, v234, 1, v236
    v_lshl_add_u32 v234, v235, 2, v234
    s_lshl_b32 s32, s54, 6
    v_add_u32 v234, s32, v234
    v_lshlrev_b32_e64 v218, 1, v234
    v_add_u32 v234, 98304, v218
    ds_read_u16 v100, v234
    ds_read_u16 v101, v234 offset:4096
    s_cmp_lt_u32 s54, 16
    s_cselect_b64 vcc, -1, 0
    v_cndmask_b32 v102, v10, v8, vcc
    s_cselect_b32 s32, 0, 4
    s_add_u32 s32, s32, 106496
    v_mov_b32_e64 v234, s32
    ds_read_b32 v103, v234
    s_waitcnt lgkmcnt(0)
    v_cvt_pk_bf16_f32 v103, v103, v103
    v_lshlrev_b32 v103, 16, v103
    v_mul_f32 v103, 0xbfb8aa3b, v103
    v_exp_f32 v103, v103
    s_nop 0
    v_add_f32 v103, 1.0, v103
    v_rcp_f32_e64 v103, v103
    s_nop 0
    v_cvt_pk_bf16_f32 v103, v103, v103
    v_lshlrev_b32_e64 v103, 16, v103
    v_and_b32 v218, 2047, v218
    v_lshl_add_u32 v218, v102, 11, v218
    v_lshlrev_b32_e64 v220, 2, v230
    v_add_u32 v220, 106752, v220
    v_lshlrev_b32_e64 v221, 2, v237
    v_add_u32 v221, 106752, v221
    s_cmp_lg_u32 s3, 0
    s_cbranch_scc1 kc_b22
    s_lshl_b32 s32, s52, 7
    s_add_u32 s32, s32, 0x38a0c00
    s_mov_b32 s34, 0x400000
    s_branch kc_b21
kc_b20:
    s_sleep 2
kc_b21:
    buffer_load_dword v235, off, s[8:11], s32 sc1
    s_waitcnt vmcnt(0)
    v_cmp_ne_u32 vcc, 8, v235
    s_sub_u32 s34, s34, 1
    s_cbranch_scc1 kc_b22
    s_cbranch_vccnz kc_b20
kc_b22:
    s_barrier
    s_add_u32 s32, s35, 0
    buffer_load_dwordx4 v[32:35], v217, s[8:11], s32 offen sc1
    s_add_u32 s32, s35, 131072
    buffer_load_dwordx4 v[36:39], v217, s[8:11], s32 offen sc1
    s_add_u32 s32, s35, 262144
    buffer_load_dwordx4 v[40:43], v217, s[8:11], s32 offen sc1
    s_add_u32 s32, s35, 393216
    buffer_load_dwordx4 v[44:47], v217, s[8:11], s32 offen sc1
    s_add_u32 s32, s35, 524288
    buffer_load_dwordx4 v[48:51], v217, s[8:11], s32 offen sc1
    s_add_u32 s32, s35, 655360
    buffer_load_dwordx4 v[52:55], v217, s[8:11], s32 offen sc1
    s_add_u32 s32, s35, 786432
    buffer_load_dwordx4 v[56:59], v217, s[8:11], s32 offen sc1
    s_add_u32 s32, s35, 917504
    buffer_load_dwordx4 v[60:63], v217, s[8:11], s32 offen sc1
    s_add_u32 s32, s35, 1048576
    buffer_load_dwordx4 v[64:67], v217, s[8:11], s32 offen sc1
    s_add_u32 s32, s35, 1179648
    buffer_load_dwordx4 v[68:71], v217, s[8:11], s32 offen sc1
    s_add_u32 s32, s35, 1310720
    buffer_load_dwordx4 v[72:75], v217, s[8:11], s32 offen sc1
    s_add_u32 s32, s35, 1441792
    buffer_load_dwordx4 v[76:79], v217, s[8:11], s32 offen sc1
    s_add_u32 s32, s35, 1572864
    buffer_load_dwordx4 v[80:83], v217, s[8:11], s32 offen sc1
    s_add_u32 s32, s35, 1703936
    buffer_load_dwordx4 v[84:87], v217, s[8:11], s32 offen sc1
    s_waitcnt vmcnt(12)
    v_pk_add_f32 v[32:33], v[32:33], v[36:37]
    v_pk_add_f32 v[34:35], v[34:35], v[38:39]
    s_waitcnt vmcnt(11)
    v_pk_add_f32 v[32:33], v[32:33], v[40:41]
    v_pk_add_f32 v[34:35], v[34:35], v[42:43]
    s_waitcnt vmcnt(10)
    v_pk_add_f32 v[32:33], v[32:33], v[44:45]
    v_pk_add_f32 v[34:35], v[34:35], v[46:47]
    s_waitcnt vmcnt(9)
    v_pk_add_f32 v[32:33], v[32:33], v[48:49]
    v_pk_add_f32 v[34:35], v[34:35], v[50:51]
    s_waitcnt vmcnt(8)
    v_pk_add_f32 v[32:33], v[32:33], v[52:53]
    v_pk_add_f32 v[34:35], v[34:35], v[54:55]
    s_waitcnt vmcnt(7)
    v_pk_add_f32 v[32:33], v[32:33], v[56:57]
    v_pk_add_f32 v[34:35], v[34:35], v[58:59]
    s_waitcnt vmcnt(6)
    v_pk_add_f32 v[32:33], v[32:33], v[60:61]
    v_pk_add_f32 v[34:35], v[34:35], v[62:63]
    s_waitcnt vmcnt(5)
    v_pk_add_f32 v[32:33], v[32:33], v[64:65]
    v_pk_add_f32 v[34:35], v[34:35], v[66:67]
    s_waitcnt vmcnt(4)
    v_pk_add_f32 v[32:33], v[32:33], v[68:69]
    v_pk_add_f32 v[34:35], v[34:35], v[70:71]
    s_waitcnt vmcnt(3)
    v_pk_add_f32 v[32:33], v[32:33], v[72:73]
    v_pk_add_f32 v[34:35], v[34:35], v[74:75]
    s_waitcnt vmcnt(2)
    v_pk_add_f32 v[32:33], v[32:33], v[76:77]
    v_pk_add_f32 v[34:35], v[34:35], v[78:79]
    s_waitcnt vmcnt(1)
    v_pk_add_f32 v[32:33], v[32:33], v[80:81]
    v_pk_add_f32 v[34:35], v[34:35], v[82:83]
    s_waitcnt vmcnt(0)
    v_pk_add_f32 v[32:33], v[32:33], v[84:85]
    v_pk_add_f32 v[34:35], v[34:35], v[86:87]
    s_nop 1
    v_permlane32_swap_b32 v32, v33
    v_permlane32_swap_b32 v34, v35
    s_nop 0
    v_add_f32 v32, v32, v33
    v_add_f32 v34, v34, v35
    s_nop 1
    v_permlane16_swap_b32 v32, v34
    s_nop 0
    v_add_f32_e64 v32, v32, v34
    ds_write_b32 v220, v32
    s_waitcnt lgkmcnt(0)
    s_barrier
    s_cmp_lg_u32 s3, 0
    s_cbranch_scc1 kc_fin
    ds_read_b32 v32, v221
    ds_read_b32 v33, v221 offset:256
    ds_read_b32 v34, v221 offset:512
    ds_read_b32 v35, v221 offset:768
    v_lshlrev_b32 v100, 16, v100
    v_lshlrev_b32 v101, 16, v101
    s_waitcnt lgkmcnt(0)
    v_add_f32 v32, v32, v33
    v_add_f32 v34, v34, v35
    v_add_f32 v32, v32, v34
    v_cvt_pk_bf16_f32 v32, v32, v32
    v_lshlrev_b32 v32, 16, v32
    v_mul_f32 v32, v32, v103
    v_cvt_pk_bf16_f32 v32, v32, v32
    v_lshlrev_b32 v32, 16, v32
    v_add_f32 v32, v32, v100
    v_cvt_pk_bf16_f32 v32, v32, v32
    v_lshlrev_b32 v32, 16, v32
    v_add_f32 v32, v32, v101
    v_cvt_pk_bf16_f32 v32, v32, v32
    buffer_store_short v32, v218, s[28:31], 0 offen
kc_fin:
    s_endpgm
kc_r3:
    s_mov_b32 s34, 0x400000
kc_r3l:
    s_sleep 4
    buffer_load_dwordx4 v[176:179], v228, s[8:11], s7 offen offset:0 sc1
    buffer_load_dwordx4 v[180:183], v228, s[8:11], s7 offen offset:1024 sc1
    buffer_load_dwordx4 v[184:187], v228, s[8:11], s7 offen offset:2048 sc1
    buffer_load_dwordx4 v[188:191], v228, s[8:11], s7 offen offset:3072 sc1
    s_waitcnt vmcnt(0)
    v_max3_u32 v235, v176, v177, v178
    v_max3_u32 v235, v235, v179, v180
    v_max3_u32 v235, v235, v181, v182
    v_max3_u32 v235, v235, v183, v184
    v_max3_u32 v235, v235, v185, v186
    v_max3_u32 v235, v235, v187, v188
    v_max3_u32 v235, v235, v189, v190
    v_max_u32 v235, v235, v191
    v_cmp_eq_u32 vcc, -1, v235
    s_sub_u32 s34, s34, 1
    s_cbranch_scc1 kc_r3o
    s_cbranch_vccnz kc_r3l
    s_branch kc_r3o
kc_r1:
    s_mov_b32 s34, 0x400000
kc_r1l:
    s_sleep 4
    buffer_load_dwordx4 v[96:99], v228, s[8:11], s37 offen offset:0 sc1
    buffer_load_dwordx4 v[100:103], v228, s[8:11], s37 offen offset:1024 sc1
    buffer_load_dwordx4 v[104:107], v228, s[8:11], s37 offen offset:2048 sc1
    buffer_load_dwordx4 v[108:111], v228, s[8:11], s37 offen offset:3072 sc1
    s_waitcnt vmcnt(0)
    v_max3_u32 v235, v96, v97, v98
    v_max3_u32 v235, v235, v99, v100
    v_max3_u32 v235, v235, v101, v102
    v_max3_u32 v235, v235, v103, v104
    v_max3_u32 v235, v235, v105, v106
    v_max3_u32 v235, v235, v107, v108
    v_max3_u32 v235, v235, v109, v110
    v_max_u32 v235, v235, v111
    v_cmp_eq_u32 vcc, -1, v235
    s_sub_u32 s34, s34, 1
    s_cbranch_scc1 kc_r1o
    s_cbranch_vccnz kc_r1l
    s_branch kc_r1o
kc_r2:
    s_mov_b32 s34, 0x400000
kc_r2l:
    s_sleep 4
    buffer_load_dwordx4 v[160:163], v228, s[8:11], s38 offen offset:0 sc1
    buffer_load_dwordx4 v[164:167], v228, s[8:11], s38 offen offset:1024 sc1
    buffer_load_dwordx4 v[168:171], v228, s[8:11], s38 offen offset:2048 sc1
    buffer_load_dwordx4 v[172:175], v228, s[8:11], s38 offen offset:3072 sc1
    s_waitcnt vmcnt(0)
    v_max3_u32 v235, v160, v161, v162
    v_max3_u32 v235, v235, v163, v164
    v_max3_u32 v235, v235, v165, v166
    v_max3_u32 v235, v235, v167, v168
    v_max3_u32 v235, v235, v169, v170
    v_max3_u32 v235, v235, v171, v172
    v_max3_u32 v235, v235, v173, v174
    v_max_u32 v235, v235, v175
    v_cmp_eq_u32 vcc, -1, v235
    s_sub_u32 s34, s34, 1
    s_cbranch_scc1 kc_r2o
    s_cbranch_vccnz kc_r2l
    s_branch kc_r2o
kc_g:
    s_mov_b32 s34, 0x400000
    s_branch kc_gs1
kc_gs0:
    s_sleep 2
kc_gs1:
    buffer_load_dword v235, off, s[8:11], s45 sc1
    s_waitcnt vmcnt(0)
    v_cmp_ne_u32_e64 vcc, 8, v235
    s_sub_u32 s34, s34, 1
    s_cbranch_scc1 kc_gs2
    s_cbranch_vccnz kc_gs0
kc_gs2:
    s_branch kc_gr
kc_end:
ka_done:
    s_endpgm
kf_fix1:
    s_cmp_eq_u32 s33, 0
    s_cselect_b32 s24, 0, 0x74000000
    s_cselect_b32 s36, 0, 0x1000
    s_mov_b32 s33, 1
    v_subrev_f32 v230, s24, v243
    v_add_f32 v231, 0, v230
    v_min_f32 v64, v224, v231
    v_add_f32 v232, 0xf1800000, v230
    v_min_f32_e64 v65, v224, v232
    v_add_f32 v231, 0xf2000000, v230
    v_min_f32_e64 v66, v224, v231
    v_add_f32 v232, 0xf2400000, v230
    v_min_f32_e64 v67, v224, v232
    v_add_f32 v231, 0xf3000000, v230
    v_min_f32_e64 v68, v224, v231
    v_add_f32 v232, 0xf3100000, v230
    v_min_f32_e64 v69, v224, v232
    v_add_f32 v231, 0xf3200000, v230
    v_min_f32_e64 v70, v224, v231
    v_add_f32 v232, 0xf3300000, v230
    v_min_f32_e64 v71, v224, v232
    v_add_f32 v231, 0x73800000, v230
    v_min_f32_e64 v72, v225, v231
    v_add_f32 v232, 0x73700000, v230
    v_min_f32_e64 v73, v225, v232
    v_add_f32 v231, 0x73600000, v230
    v_min_f32_e64 v74, v225, v231
    v_add_f32 v232, 0x73500000, v230
    v_min_f32_e64 v75, v225, v232
    v_add_f32 v231, 0x73000000, v230
    v_min_f32_e64 v76, v225, v231
    v_add_f32 v232, 0x72e00000, v230
    v_min_f32_e64 v77, v225, v232
    v_add_f32 v231, 0x72c00000, v230
    v_min_f32_e64 v78, v225, v231
    v_add_f32 v232, 0x72a00000, v230
    v_min_f32 v79, v225, v232
    s_nop 1
    s_branch kf_fixr2
kf_fix3:
    s_cmp_eq_u32 s33, 0
    s_cselect_b32 s24, 0, 0x74000000
    s_cselect_b32 s36, 0, 0x1000
    s_mov_b32 s33, 1
    v_subrev_f32 v230, s24, v243
    v_add_f32 v231, 0, v230
    v_min_f32 v64, v224, v231
    v_add_f32 v232, 0xf1800000, v230
    v_min_f32_e64 v65, v224, v232
    v_add_f32 v231, 0xf2000000, v230
    v_min_f32_e64 v66, v224, v231
    v_add_f32 v232, 0xf2400000, v230
    v_min_f32_e64 v67, v224, v232
    v_add_f32 v231, 0xf3000000, v230
    v_min_f32_e64 v68, v224, v231
    v_add_f32 v232, 0xf3100000, v230
    v_min_f32_e64 v69, v224, v232
    v_add_f32 v231, 0xf3200000, v230
    v_min_f32_e64 v70, v224, v231
    v_add_f32 v232, 0xf3300000, v230
    v_min_f32_e64 v71, v224, v232
    v_add_f32 v231, 0x73800000, v230
    v_min_f32_e64 v72, v225, v231
    v_add_f32 v232, 0x73700000, v230
    v_min_f32_e64 v73, v225, v232
    v_add_f32 v231, 0x73600000, v230
    v_min_f32_e64 v74, v225, v231
    v_add_f32 v232, 0x73500000, v230
    v_min_f32_e64 v75, v225, v232
    v_add_f32 v231, 0x73000000, v230
    v_min_f32_e64 v76, v225, v231
    v_add_f32 v232, 0x72e00000, v230
    v_min_f32_e64 v77, v225, v232
    v_add_f32 v231, 0x72c00000, v230
    v_min_f32_e64 v78, v225, v231
    v_add_f32 v232, 0x72a00000, v230
    v_min_f32 v79, v225, v232
    s_nop 1
    s_branch kf_fixr4
kf_rare6:
    s_nop 15
    v_max3_f32 v230, v32, v33, v34
    v_max3_f32 v230, v230, v35, v36
    v_max3_f32 v230, v230, v37, v38
    v_max_f32 v230, v230, v39
    v_mov_b32 v231, v230
    s_nop 1
    v_permlane16_swap_b32 v230, v231
    s_nop 0
    v_max_f32 v230, v230, v231
    v_mov_b32 v231, v230
    s_nop 1
    v_permlane32_swap_b32 v230, v231
    s_nop 0
    v_max_f32_e64 v230, v230, v231
    v_add_f32 v230, 0x41800000, v230
    v_max_f32 v230, 0, v230
    v_sub_f32 v232, 0, v230
    v_exp_f32 v232, v232
    v_sub_f32 v224, v224, v230
    v_sub_f32 v64, v64, v230
    v_sub_f32 v0, v0, v230
    v_sub_f32 v32, v32, v230
    v_sub_f32 v65, v65, v230
    v_sub_f32 v1, v1, v230
    v_sub_f32 v33, v33, v230
    v_sub_f32 v66, v66, v230
    v_sub_f32 v2, v2, v230
    v_sub_f32 v34, v34, v230
    v_sub_f32 v67, v67, v230
    v_sub_f32 v3, v3, v230
    v_sub_f32 v35, v35, v230
    v_sub_f32 v68, v68, v230
    v_sub_f32 v4, v4, v230
    v_sub_f32 v36, v36, v230
    v_sub_f32 v69, v69, v230
    v_sub_f32 v5, v5, v230
    v_sub_f32 v37, v37, v230
    v_sub_f32 v70, v70, v230
    v_sub_f32 v6, v6, v230
    v_sub_f32 v38, v38, v230
    v_sub_f32 v71, v71, v230
    v_sub_f32 v7, v7, v230
    v_sub_f32 v39, v39, v230
    v_mul_f32 v144, v144, v232
    v_mul_f32 v145, v145, v232
    v_mul_f32 v146, v146, v232
    v_mul_f32 v147, v147, v232
    v_accvgpr_read_b32 v233, a0
    v_mul_f32_e64 v233, v233, v232
    v_accvgpr_write_b32 a0, v233
    v_accvgpr_read_b32 v234, a1
    v_mul_f32_e64 v234, v234, v232
    v_accvgpr_write_b32 a1, v234
    v_accvgpr_read_b32 v235, a2
    v_mul_f32_e64 v235, v235, v232
    v_accvgpr_write_b32 a2, v235
    v_accvgpr_read_b32 v236, a3
    v_mul_f32_e64 v236, v236, v232
    v_accvgpr_write_b32 a3, v236
    v_accvgpr_read_b32 v233, a4
    v_mul_f32_e64 v233, v233, v232
    v_accvgpr_write_b32 a4, v233
    v_accvgpr_read_b32 v234, a5
    v_mul_f32_e64 v234, v234, v232
    v_accvgpr_write_b32 a5, v234
    v_accvgpr_read_b32 v235, a6
    v_mul_f32_e64 v235, v235, v232
    v_accvgpr_write_b32 a6, v235
    v_accvgpr_read_b32 v236, a7
    v_mul_f32_e64 v236, v236, v232
    v_accvgpr_write_b32 a7, v236
    v_accvgpr_read_b32 v233, a8
    v_mul_f32_e64 v233, v233, v232
    v_accvgpr_write_b32 a8, v233
    v_accvgpr_read_b32 v234, a9
    v_mul_f32_e64 v234, v234, v232
    v_accvgpr_write_b32 a9, v234
    v_accvgpr_read_b32 v235, a10
    v_mul_f32_e64 v235, v235, v232
    v_accvgpr_write_b32 a10, v235
    v_accvgpr_read_b32 v236, a11
    v_mul_f32_e64 v236, v236, v232
    v_accvgpr_write_b32 a11, v236
    v_accvgpr_read_b32 v233, a12
    v_mul_f32_e64 v233, v233, v232
    v_accvgpr_write_b32 a12, v233
    v_accvgpr_read_b32 v234, a13
    v_mul_f32_e64 v234, v234, v232
    v_accvgpr_write_b32 a13, v234
    v_accvgpr_read_b32 v235, a14
    v_mul_f32_e64 v235, v235, v232
    v_accvgpr_write_b32 a14, v235
    v_accvgpr_read_b32 v236, a15
    v_mul_f32_e64 v236, v236, v232
    v_accvgpr_write_b32 a15, v236
    v_accvgpr_read_b32 v233, a16
    v_mul_f32_e64 v233, v233, v232
    v_accvgpr_write_b32 a16, v233
    v_accvgpr_read_b32 v234, a17
    v_mul_f32_e64 v234, v234, v232
    v_accvgpr_write_b32 a17, v234
    v_accvgpr_read_b32 v235, a18
    v_mul_f32_e64 v235, v235, v232
    v_accvgpr_write_b32 a18, v235
    v_accvgpr_read_b32 v236, a19
    v_mul_f32_e64 v236, v236, v232
    v_accvgpr_write_b32 a19, v236
    v_accvgpr_read_b32 v233, a20
    v_mul_f32_e64 v233, v233, v232
    v_accvgpr_write_b32 a20, v233
    v_accvgpr_read_b32 v234, a21
    v_mul_f32_e64 v234, v234, v232
    v_accvgpr_write_b32 a21, v234
    v_accvgpr_read_b32 v235, a22
    v_mul_f32_e64 v235, v235, v232
    v_accvgpr_write_b32 a22, v235
    v_accvgpr_read_b32 v236, a23
    v_mul_f32_e64 v236, v236, v232
    v_accvgpr_write_b32 a23, v236
    v_accvgpr_read_b32 v233, a24
    v_mul_f32_e64 v233, v233, v232
    v_accvgpr_write_b32 a24, v233
    v_accvgpr_read_b32 v234, a25
    v_mul_f32_e64 v234, v234, v232
    v_accvgpr_write_b32 a25, v234
    v_accvgpr_read_b32 v235, a26
    v_mul_f32_e64 v235, v235, v232
    v_accvgpr_write_b32 a26, v235
    v_accvgpr_read_b32 v236, a27
    v_mul_f32_e64 v236, v236, v232
    v_accvgpr_write_b32 a27, v236
    v_accvgpr_read_b32 v233, a28
    v_mul_f32_e64 v233, v233, v232
    v_accvgpr_write_b32 a28, v233
    v_accvgpr_read_b32 v234, a29
    v_mul_f32_e64 v234, v234, v232
    v_accvgpr_write_b32 a29, v234
    v_accvgpr_read_b32 v235, a30
    v_mul_f32_e64 v235, v235, v232
    v_accvgpr_write_b32 a30, v235
    v_accvgpr_read_b32 v236, a31
    v_mul_f32_e64 v236, v236, v232
    v_accvgpr_write_b32 a31, v236
    v_exp_f32 v128, v32
    v_exp_f32 v129, v33
    v_exp_f32 v130, v34
    v_exp_f32 v131, v35
    v_exp_f32 v132, v36
    v_exp_f32 v133, v37
    v_exp_f32 v134, v38
    v_exp_f32_e64 v135, v39
    s_nop 0
    v_cvt_pk_bf16_f32 v112, v128, v129
    v_cvt_pk_bf16_f32 v113, v130, v131
    v_cvt_pk_bf16_f32 v114, v132, v133
    v_cvt_pk_bf16_f32 v115, v134, v135
    v_max3_f32 v230, v40, v41, v42
    v_max3_f32 v230, v230, v43, v44
    v_max3_f32 v230, v230, v45, v46
    v_max_f32 v230, v230, v47
    v_mov_b32 v231, v230
    s_nop 1
    v_permlane16_swap_b32 v230, v231
    s_nop 0
    v_max_f32 v230, v230, v231
    v_mov_b32 v231, v230
    s_nop 1
    v_permlane32_swap_b32 v230, v231
    s_nop 0
    v_max_f32_e64 v230, v230, v231
    v_add_f32 v230, 0x41800000, v230
    v_max_f32 v230, 0, v230
    v_sub_f32 v232, 0, v230
    v_exp_f32 v232, v232
    v_sub_f32 v225, v225, v230
    v_sub_f32 v72, v72, v230
    v_sub_f32 v8, v8, v230
    v_sub_f32 v40, v40, v230
    v_sub_f32 v73, v73, v230
    v_sub_f32 v9, v9, v230
    v_sub_f32 v41, v41, v230
    v_sub_f32 v74, v74, v230
    v_sub_f32 v10, v10, v230
    v_sub_f32 v42, v42, v230
    v_sub_f32 v75, v75, v230
    v_sub_f32 v11, v11, v230
    v_sub_f32 v43, v43, v230
    v_sub_f32 v76, v76, v230
    v_sub_f32 v12, v12, v230
    v_sub_f32 v44, v44, v230
    v_sub_f32 v77, v77, v230
    v_sub_f32 v13, v13, v230
    v_sub_f32 v45, v45, v230
    v_sub_f32 v78, v78, v230
    v_sub_f32 v14, v14, v230
    v_sub_f32 v46, v46, v230
    v_sub_f32 v79, v79, v230
    v_sub_f32 v15, v15, v230
    v_sub_f32 v47, v47, v230
    v_mul_f32 v148, v148, v232
    v_mul_f32 v149, v149, v232
    v_mul_f32 v150, v150, v232
    v_mul_f32 v151, v151, v232
    v_accvgpr_read_b32 v233, a32
    v_mul_f32_e64 v233, v233, v232
    v_accvgpr_write_b32 a32, v233
    v_accvgpr_read_b32 v234, a33
    v_mul_f32_e64 v234, v234, v232
    v_accvgpr_write_b32 a33, v234
    v_accvgpr_read_b32 v235, a34
    v_mul_f32_e64 v235, v235, v232
    v_accvgpr_write_b32 a34, v235
    v_accvgpr_read_b32 v236, a35
    v_mul_f32_e64 v236, v236, v232
    v_accvgpr_write_b32 a35, v236
    v_accvgpr_read_b32 v233, a36
    v_mul_f32_e64 v233, v233, v232
    v_accvgpr_write_b32 a36, v233
    v_accvgpr_read_b32 v234, a37
    v_mul_f32_e64 v234, v234, v232
    v_accvgpr_write_b32 a37, v234
    v_accvgpr_read_b32 v235, a38
    v_mul_f32_e64 v235, v235, v232
    v_accvgpr_write_b32 a38, v235
    v_accvgpr_read_b32 v236, a39
    v_mul_f32_e64 v236, v236, v232
    v_accvgpr_write_b32 a39, v236
    v_accvgpr_read_b32 v233, a40
    v_mul_f32_e64 v233, v233, v232
    v_accvgpr_write_b32 a40, v233
    v_accvgpr_read_b32 v234, a41
    v_mul_f32_e64 v234, v234, v232
    v_accvgpr_write_b32 a41, v234
    v_accvgpr_read_b32 v235, a42
    v_mul_f32_e64 v235, v235, v232
    v_accvgpr_write_b32 a42, v235
    v_accvgpr_read_b32 v236, a43
    v_mul_f32_e64 v236, v236, v232
    v_accvgpr_write_b32 a43, v236
    v_accvgpr_read_b32 v233, a44
    v_mul_f32_e64 v233, v233, v232
    v_accvgpr_write_b32 a44, v233
    v_accvgpr_read_b32 v234, a45
    v_mul_f32_e64 v234, v234, v232
    v_accvgpr_write_b32 a45, v234
    v_accvgpr_read_b32 v235, a46
    v_mul_f32_e64 v235, v235, v232
    v_accvgpr_write_b32 a46, v235
    v_accvgpr_read_b32 v236, a47
    v_mul_f32_e64 v236, v236, v232
    v_accvgpr_write_b32 a47, v236
    v_accvgpr_read_b32 v233, a48
    v_mul_f32_e64 v233, v233, v232
    v_accvgpr_write_b32 a48, v233
    v_accvgpr_read_b32 v234, a49
    v_mul_f32_e64 v234, v234, v232
    v_accvgpr_write_b32 a49, v234
    v_accvgpr_read_b32 v235, a50
    v_mul_f32_e64 v235, v235, v232
    v_accvgpr_write_b32 a50, v235
    v_accvgpr_read_b32 v236, a51
    v_mul_f32_e64 v236, v236, v232
    v_accvgpr_write_b32 a51, v236
    v_accvgpr_read_b32 v233, a52
    v_mul_f32_e64 v233, v233, v232
    v_accvgpr_write_b32 a52, v233
    v_accvgpr_read_b32 v234, a53
    v_mul_f32_e64 v234, v234, v232
    v_accvgpr_write_b32 a53, v234
    v_accvgpr_read_b32 v235, a54
    v_mul_f32_e64 v235, v235, v232
    v_accvgpr_write_b32 a54, v235
    v_accvgpr_read_b32 v236, a55
    v_mul_f32_e64 v236, v236, v232
    v_accvgpr_write_b32 a55, v236
    v_accvgpr_read_b32 v233, a56
    v_mul_f32_e64 v233, v233, v232
    v_accvgpr_write_b32 a56, v233
    v_accvgpr_read_b32 v234, a57
    v_mul_f32_e64 v234, v234, v232
    v_accvgpr_write_b32 a57, v234
    v_accvgpr_read_b32 v235, a58
    v_mul_f32_e64 v235, v235, v232
    v_accvgpr_write_b32 a58, v235
    v_accvgpr_read_b32 v236, a59
    v_mul_f32_e64 v236, v236, v232
    v_accvgpr_write_b32 a59, v236
    v_accvgpr_read_b32 v233, a60
    v_mul_f32_e64 v233, v233, v232
    v_accvgpr_write_b32 a60, v233
    v_accvgpr_read_b32 v234, a61
    v_mul_f32_e64 v234, v234, v232
    v_accvgpr_write_b32 a61, v234
    v_accvgpr_read_b32 v235, a62
    v_mul_f32_e64 v235, v235, v232
    v_accvgpr_write_b32 a62, v235
    v_accvgpr_read_b32 v236, a63
    v_mul_f32_e64 v236, v236, v232
    v_accvgpr_write_b32 a63, v236
    v_exp_f32 v128, v40
    v_exp_f32 v129, v41
    v_exp_f32 v130, v42
    v_exp_f32 v131, v43
    v_exp_f32 v132, v44
    v_exp_f32 v133, v45
    v_exp_f32 v134, v46
    v_exp_f32_e64 v135, v47
    s_nop 0
    v_cvt_pk_bf16_f32 v116, v128, v129
    v_cvt_pk_bf16_f32 v117, v130, v131
    v_cvt_pk_bf16_f32 v118, v132, v133
    v_cvt_pk_bf16_f32 v119, v134, v135
    v_max3_f32 v230, v48, v49, v50
    v_max3_f32 v230, v230, v51, v52
    v_max3_f32 v230, v230, v53, v54
    v_max_f32 v230, v230, v55
    v_mov_b32 v231, v230
    s_nop 1
    v_permlane16_swap_b32 v230, v231
    s_nop 0
    v_max_f32 v230, v230, v231
    v_mov_b32 v231, v230
    s_nop 1
    v_permlane32_swap_b32 v230, v231
    s_nop 0
    v_max_f32_e64 v230, v230, v231
    v_add_f32 v230, 0x41800000, v230
    v_max_f32 v230, 0, v230
    v_sub_f32 v232, 0, v230
    v_exp_f32 v232, v232
    v_sub_f32 v226, v226, v230
    v_sub_f32 v80, v80, v230
    v_sub_f32 v16, v16, v230
    v_sub_f32 v48, v48, v230
    v_sub_f32 v81, v81, v230
    v_sub_f32 v17, v17, v230
    v_sub_f32 v49, v49, v230
    v_sub_f32 v82, v82, v230
    v_sub_f32 v18, v18, v230
    v_sub_f32 v50, v50, v230
    v_sub_f32 v83, v83, v230
    v_sub_f32 v19, v19, v230
    v_sub_f32 v51, v51, v230
    v_sub_f32 v84, v84, v230
    v_sub_f32 v20, v20, v230
    v_sub_f32 v52, v52, v230
    v_sub_f32 v85, v85, v230
    v_sub_f32 v21, v21, v230
    v_sub_f32 v53, v53, v230
    v_sub_f32 v86, v86, v230
    v_sub_f32 v22, v22, v230
    v_sub_f32 v54, v54, v230
    v_sub_f32 v87, v87, v230
    v_sub_f32 v23, v23, v230
    v_sub_f32 v55, v55, v230
    v_mul_f32 v152, v152, v232
    v_mul_f32 v153, v153, v232
    v_mul_f32 v154, v154, v232
    v_mul_f32 v155, v155, v232
    v_accvgpr_read_b32 v233, a64
    v_mul_f32_e64 v233, v233, v232
    v_accvgpr_write_b32 a64, v233
    v_accvgpr_read_b32 v234, a65
    v_mul_f32_e64 v234, v234, v232
    v_accvgpr_write_b32 a65, v234
    v_accvgpr_read_b32 v235, a66
    v_mul_f32_e64 v235, v235, v232
    v_accvgpr_write_b32 a66, v235
    v_accvgpr_read_b32 v236, a67
    v_mul_f32_e64 v236, v236, v232
    v_accvgpr_write_b32 a67, v236
    v_accvgpr_read_b32 v233, a68
    v_mul_f32_e64 v233, v233, v232
    v_accvgpr_write_b32 a68, v233
    v_accvgpr_read_b32 v234, a69
    v_mul_f32_e64 v234, v234, v232
    v_accvgpr_write_b32 a69, v234
    v_accvgpr_read_b32 v235, a70
    v_mul_f32_e64 v235, v235, v232
    v_accvgpr_write_b32 a70, v235
    v_accvgpr_read_b32 v236, a71
    v_mul_f32_e64 v236, v236, v232
    v_accvgpr_write_b32 a71, v236
    v_accvgpr_read_b32 v233, a72
    v_mul_f32_e64 v233, v233, v232
    v_accvgpr_write_b32 a72, v233
    v_accvgpr_read_b32 v234, a73
    v_mul_f32_e64 v234, v234, v232
    v_accvgpr_write_b32 a73, v234
    v_accvgpr_read_b32 v235, a74
    v_mul_f32_e64 v235, v235, v232
    v_accvgpr_write_b32 a74, v235
    v_accvgpr_read_b32 v236, a75
    v_mul_f32_e64 v236, v236, v232
    v_accvgpr_write_b32 a75, v236
    v_accvgpr_read_b32 v233, a76
    v_mul_f32_e64 v233, v233, v232
    v_accvgpr_write_b32 a76, v233
    v_accvgpr_read_b32 v234, a77
    v_mul_f32_e64 v234, v234, v232
    v_accvgpr_write_b32 a77, v234
    v_accvgpr_read_b32 v235, a78
    v_mul_f32_e64 v235, v235, v232
    v_accvgpr_write_b32 a78, v235
    v_accvgpr_read_b32 v236, a79
    v_mul_f32_e64 v236, v236, v232
    v_accvgpr_write_b32 a79, v236
    v_accvgpr_read_b32 v233, a80
    v_mul_f32_e64 v233, v233, v232
    v_accvgpr_write_b32 a80, v233
    v_accvgpr_read_b32 v234, a81
    v_mul_f32_e64 v234, v234, v232
    v_accvgpr_write_b32 a81, v234
    v_accvgpr_read_b32 v235, a82
    v_mul_f32_e64 v235, v235, v232
    v_accvgpr_write_b32 a82, v235
    v_accvgpr_read_b32 v236, a83
    v_mul_f32_e64 v236, v236, v232
    v_accvgpr_write_b32 a83, v236
    v_accvgpr_read_b32 v233, a84
    v_mul_f32_e64 v233, v233, v232
    v_accvgpr_write_b32 a84, v233
    v_accvgpr_read_b32 v234, a85
    v_mul_f32_e64 v234, v234, v232
    v_accvgpr_write_b32 a85, v234
    v_accvgpr_read_b32 v235, a86
    v_mul_f32_e64 v235, v235, v232
    v_accvgpr_write_b32 a86, v235
    v_accvgpr_read_b32 v236, a87
    v_mul_f32_e64 v236, v236, v232
    v_accvgpr_write_b32 a87, v236
    v_accvgpr_read_b32 v233, a88
    v_mul_f32_e64 v233, v233, v232
    v_accvgpr_write_b32 a88, v233
    v_accvgpr_read_b32 v234, a89
    v_mul_f32_e64 v234, v234, v232
    v_accvgpr_write_b32 a89, v234
    v_accvgpr_read_b32 v235, a90
    v_mul_f32_e64 v235, v235, v232
    v_accvgpr_write_b32 a90, v235
    v_accvgpr_read_b32 v236, a91
    v_mul_f32_e64 v236, v236, v232
    v_accvgpr_write_b32 a91, v236
    v_accvgpr_read_b32 v233, a92
    v_mul_f32_e64 v233, v233, v232
    v_accvgpr_write_b32 a92, v233
    v_accvgpr_read_b32 v234, a93
    v_mul_f32_e64 v234, v234, v232
    v_accvgpr_write_b32 a93, v234
    v_accvgpr_read_b32 v235, a94
    v_mul_f32_e64 v235, v235, v232
    v_accvgpr_write_b32 a94, v235
    v_accvgpr_read_b32 v236, a95
    v_mul_f32_e64 v236, v236, v232
    v_accvgpr_write_b32 a95, v236
    v_exp_f32 v128, v48
    v_exp_f32 v129, v49
    v_exp_f32 v130, v50
    v_exp_f32 v131, v51
    v_exp_f32 v132, v52
    v_exp_f32 v133, v53
    v_exp_f32 v134, v54
    v_exp_f32_e64 v135, v55
    s_nop 0
    v_cvt_pk_bf16_f32 v120, v128, v129
    v_cvt_pk_bf16_f32 v121, v130, v131
    v_cvt_pk_bf16_f32 v122, v132, v133
    v_cvt_pk_bf16_f32 v123, v134, v135
    v_max3_f32 v230, v56, v57, v58
    v_max3_f32 v230, v230, v59, v60
    v_max3_f32 v230, v230, v61, v62
    v_max_f32 v230, v230, v63
    v_mov_b32 v231, v230
    s_nop 1
    v_permlane16_swap_b32 v230, v231
    s_nop 0
    v_max_f32 v230, v230, v231
    v_mov_b32 v231, v230
    s_nop 1
    v_permlane32_swap_b32 v230, v231
    s_nop 0
    v_max_f32_e64 v230, v230, v231
    v_add_f32 v230, 0x41800000, v230
    v_max_f32 v230, 0, v230
    v_sub_f32 v232, 0, v230
    v_exp_f32 v232, v232
    v_sub_f32 v227, v227, v230
    v_sub_f32 v88, v88, v230
    v_sub_f32 v24, v24, v230
    v_sub_f32 v56, v56, v230
    v_sub_f32 v89, v89, v230
    v_sub_f32 v25, v25, v230
    v_sub_f32 v57, v57, v230
    v_sub_f32 v90, v90, v230
    v_sub_f32 v26, v26, v230
    v_sub_f32 v58, v58, v230
    v_sub_f32 v91, v91, v230
    v_sub_f32 v27, v27, v230
    v_sub_f32 v59, v59, v230
    v_sub_f32 v92, v92, v230
    v_sub_f32 v28, v28, v230
    v_sub_f32 v60, v60, v230
    v_sub_f32 v93, v93, v230
    v_sub_f32 v29, v29, v230
    v_sub_f32 v61, v61, v230
    v_sub_f32 v94, v94, v230
    v_sub_f32 v30, v30, v230
    v_sub_f32 v62, v62, v230
    v_sub_f32 v95, v95, v230
    v_sub_f32 v31, v31, v230
    v_sub_f32 v63, v63, v230
    v_mul_f32 v156, v156, v232
    v_mul_f32 v157, v157, v232
    v_mul_f32 v158, v158, v232
    v_mul_f32 v159, v159, v232
    v_accvgpr_read_b32 v233, a96
    v_mul_f32_e64 v233, v233, v232
    v_accvgpr_write_b32 a96, v233
    v_accvgpr_read_b32 v234, a97
    v_mul_f32_e64 v234, v234, v232
    v_accvgpr_write_b32 a97, v234
    v_accvgpr_read_b32 v235, a98
    v_mul_f32_e64 v235, v235, v232
    v_accvgpr_write_b32 a98, v235
    v_accvgpr_read_b32 v236, a99
    v_mul_f32_e64 v236, v236, v232
    v_accvgpr_write_b32 a99, v236
    v_accvgpr_read_b32 v233, a100
    v_mul_f32_e64 v233, v233, v232
    v_accvgpr_write_b32 a100, v233
    v_accvgpr_read_b32 v234, a101
    v_mul_f32_e64 v234, v234, v232
    v_accvgpr_write_b32 a101, v234
    v_accvgpr_read_b32 v235, a102
    v_mul_f32_e64 v235, v235, v232
    v_accvgpr_write_b32 a102, v235
    v_accvgpr_read_b32 v236, a103
    v_mul_f32_e64 v236, v236, v232
    v_accvgpr_write_b32 a103, v236
    v_accvgpr_read_b32 v233, a104
    v_mul_f32_e64 v233, v233, v232
    v_accvgpr_write_b32 a104, v233
    v_accvgpr_read_b32 v234, a105
    v_mul_f32_e64 v234, v234, v232
    v_accvgpr_write_b32 a105, v234
    v_accvgpr_read_b32 v235, a106
    v_mul_f32_e64 v235, v235, v232
    v_accvgpr_write_b32 a106, v235
    v_accvgpr_read_b32 v236, a107
    v_mul_f32_e64 v236, v236, v232
    v_accvgpr_write_b32 a107, v236
    v_accvgpr_read_b32 v233, a108
    v_mul_f32_e64 v233, v233, v232
    v_accvgpr_write_b32 a108, v233
    v_accvgpr_read_b32 v234, a109
    v_mul_f32_e64 v234, v234, v232
    v_accvgpr_write_b32 a109, v234
    v_accvgpr_read_b32 v235, a110
    v_mul_f32_e64 v235, v235, v232
    v_accvgpr_write_b32 a110, v235
    v_accvgpr_read_b32 v236, a111
    v_mul_f32_e64 v236, v236, v232
    v_accvgpr_write_b32 a111, v236
    v_accvgpr_read_b32 v233, a112
    v_mul_f32_e64 v233, v233, v232
    v_accvgpr_write_b32 a112, v233
    v_accvgpr_read_b32 v234, a113
    v_mul_f32_e64 v234, v234, v232
    v_accvgpr_write_b32 a113, v234
    v_accvgpr_read_b32 v235, a114
    v_mul_f32_e64 v235, v235, v232
    v_accvgpr_write_b32 a114, v235
    v_accvgpr_read_b32 v236, a115
    v_mul_f32_e64 v236, v236, v232
    v_accvgpr_write_b32 a115, v236
    v_accvgpr_read_b32 v233, a116
    v_mul_f32_e64 v233, v233, v232
    v_accvgpr_write_b32 a116, v233
    v_accvgpr_read_b32 v234, a117
    v_mul_f32_e64 v234, v234, v232
    v_accvgpr_write_b32 a117, v234
    v_accvgpr_read_b32 v235, a118
    v_mul_f32_e64 v235, v235, v232
    v_accvgpr_write_b32 a118, v235
    v_accvgpr_read_b32 v236, a119
    v_mul_f32_e64 v236, v236, v232
    v_accvgpr_write_b32 a119, v236
    v_accvgpr_read_b32 v233, a120
    v_mul_f32_e64 v233, v233, v232
    v_accvgpr_write_b32 a120, v233
    v_accvgpr_read_b32 v234, a121
    v_mul_f32_e64 v234, v234, v232
    v_accvgpr_write_b32 a121, v234
    v_accvgpr_read_b32 v235, a122
    v_mul_f32_e64 v235, v235, v232
    v_accvgpr_write_b32 a122, v235
    v_accvgpr_read_b32 v236, a123
    v_mul_f32_e64 v236, v236, v232
    v_accvgpr_write_b32 a123, v236
    v_accvgpr_read_b32 v233, a124
    v_mul_f32_e64 v233, v233, v232
    v_accvgpr_write_b32 a124, v233
    v_accvgpr_read_b32 v234, a125
    v_mul_f32_e64 v234, v234, v232
    v_accvgpr_write_b32 a125, v234
    v_accvgpr_read_b32 v235, a126
    v_mul_f32_e64 v235, v235, v232
    v_accvgpr_write_b32 a126, v235
    v_accvgpr_read_b32 v236, a127
    v_mul_f32_e64 v236, v236, v232
    v_accvgpr_write_b32 a127, v236
    v_exp_f32 v128, v56
    v_exp_f32 v129, v57
    v_exp_f32 v130, v58
    v_exp_f32 v131, v59
    v_exp_f32 v132, v60
    v_exp_f32 v133, v61
    v_exp_f32 v134, v62
    v_exp_f32_e64 v135, v63
    s_nop 0
    v_cvt_pk_bf16_f32 v124, v128, v129
    v_cvt_pk_bf16_f32 v125, v130, v131
    v_cvt_pk_bf16_f32 v126, v132, v133
    v_cvt_pk_bf16_f32 v127, v134, v135
    s_nop 1
    s_branch kf_rr5
kf_rare10:
    s_nop 15
    v_max3_f32 v230, v0, v1, v2
    v_max3_f32 v230, v230, v3, v4
    v_max3_f32 v230, v230, v5, v6
    v_max_f32 v230, v230, v7
    v_mov_b32 v231, v230
    s_nop 1
    v_permlane16_swap_b32 v230, v231
    s_nop 0
    v_max_f32 v230, v230, v231
    v_mov_b32 v231, v230
    s_nop 1
    v_permlane32_swap_b32 v230, v231
    s_nop 0
    v_max_f32 v230, v230, v231
    v_add_f32 v230, 0x41800000, v230
    v_max_f32 v230, 0, v230
    v_sub_f32 v232, 0, v230
    v_exp_f32 v232, v232
    v_sub_f32 v224, v224, v230
    v_sub_f32 v64, v64, v230
    v_sub_f32 v32, v32, v230
    v_sub_f32 v0, v0, v230
    v_sub_f32 v65, v65, v230
    v_sub_f32 v33, v33, v230
    v_sub_f32 v1, v1, v230
    v_sub_f32 v66, v66, v230
    v_sub_f32 v34, v34, v230
    v_sub_f32 v2, v2, v230
    v_sub_f32 v67, v67, v230
    v_sub_f32 v35, v35, v230
    v_sub_f32 v3, v3, v230
    v_sub_f32 v68, v68, v230
    v_sub_f32 v36, v36, v230
    v_sub_f32 v4, v4, v230
    v_sub_f32 v69, v69, v230
    v_sub_f32 v37, v37, v230
    v_sub_f32 v5, v5, v230
    v_sub_f32 v70, v70, v230
    v_sub_f32 v38, v38, v230
    v_sub_f32 v6, v6, v230
    v_sub_f32 v71, v71, v230
    v_sub_f32 v39, v39, v230
    v_sub_f32 v7, v7, v230
    v_mul_f32 v144, v144, v232
    v_mul_f32 v145, v145, v232
    v_mul_f32 v146, v146, v232
    v_mul_f32 v147, v147, v232
    v_accvgpr_read_b32 v233, a0
    v_mul_f32_e64 v233, v233, v232
    v_accvgpr_write_b32 a0, v233
    v_accvgpr_read_b32 v234, a1
    v_mul_f32_e64 v234, v234, v232
    v_accvgpr_write_b32 a1, v234
    v_accvgpr_read_b32 v235, a2
    v_mul_f32_e64 v235, v235, v232
    v_accvgpr_write_b32 a2, v235
    v_accvgpr_read_b32 v236, a3
    v_mul_f32_e64 v236, v236, v232
    v_accvgpr_write_b32 a3, v236
    v_accvgpr_read_b32 v233, a4
    v_mul_f32_e64 v233, v233, v232
    v_accvgpr_write_b32 a4, v233
    v_accvgpr_read_b32 v234, a5
    v_mul_f32_e64 v234, v234, v232
    v_accvgpr_write_b32 a5, v234
    v_accvgpr_read_b32 v235, a6
    v_mul_f32_e64 v235, v235, v232
    v_accvgpr_write_b32 a6, v235
    v_accvgpr_read_b32 v236, a7
    v_mul_f32_e64 v236, v236, v232
    v_accvgpr_write_b32 a7, v236
    v_accvgpr_read_b32 v233, a8
    v_mul_f32_e64 v233, v233, v232
    v_accvgpr_write_b32 a8, v233
    v_accvgpr_read_b32 v234, a9
    v_mul_f32_e64 v234, v234, v232
    v_accvgpr_write_b32 a9, v234
    v_accvgpr_read_b32 v235, a10
    v_mul_f32_e64 v235, v235, v232
    v_accvgpr_write_b32 a10, v235
    v_accvgpr_read_b32 v236, a11
    v_mul_f32_e64 v236, v236, v232
    v_accvgpr_write_b32 a11, v236
    v_accvgpr_read_b32 v233, a12
    v_mul_f32_e64 v233, v233, v232
    v_accvgpr_write_b32 a12, v233
    v_accvgpr_read_b32 v234, a13
    v_mul_f32_e64 v234, v234, v232
    v_accvgpr_write_b32 a13, v234
    v_accvgpr_read_b32 v235, a14
    v_mul_f32_e64 v235, v235, v232
    v_accvgpr_write_b32 a14, v235
    v_accvgpr_read_b32 v236, a15
    v_mul_f32_e64 v236, v236, v232
    v_accvgpr_write_b32 a15, v236
    v_accvgpr_read_b32 v233, a16
    v_mul_f32_e64 v233, v233, v232
    v_accvgpr_write_b32 a16, v233
    v_accvgpr_read_b32 v234, a17
    v_mul_f32_e64 v234, v234, v232
    v_accvgpr_write_b32 a17, v234
    v_accvgpr_read_b32 v235, a18
    v_mul_f32_e64 v235, v235, v232
    v_accvgpr_write_b32 a18, v235
    v_accvgpr_read_b32 v236, a19
    v_mul_f32_e64 v236, v236, v232
    v_accvgpr_write_b32 a19, v236
    v_accvgpr_read_b32 v233, a20
    v_mul_f32_e64 v233, v233, v232
    v_accvgpr_write_b32 a20, v233
    v_accvgpr_read_b32 v234, a21
    v_mul_f32_e64 v234, v234, v232
    v_accvgpr_write_b32 a21, v234
    v_accvgpr_read_b32 v235, a22
    v_mul_f32_e64 v235, v235, v232
    v_accvgpr_write_b32 a22, v235
    v_accvgpr_read_b32 v236, a23
    v_mul_f32_e64 v236, v236, v232
    v_accvgpr_write_b32 a23, v236
    v_accvgpr_read_b32 v233, a24
    v_mul_f32_e64 v233, v233, v232
    v_accvgpr_write_b32 a24, v233
    v_accvgpr_read_b32 v234, a25
    v_mul_f32_e64 v234, v234, v232
    v_accvgpr_write_b32 a25, v234
    v_accvgpr_read_b32 v235, a26
    v_mul_f32_e64 v235, v235, v232
    v_accvgpr_write_b32 a26, v235
    v_accvgpr_read_b32 v236, a27
    v_mul_f32_e64 v236, v236, v232
    v_accvgpr_write_b32 a27, v236
    v_accvgpr_read_b32 v233, a28
    v_mul_f32_e64 v233, v233, v232
    v_accvgpr_write_b32 a28, v233
    v_accvgpr_read_b32 v234, a29
    v_mul_f32_e64 v234, v234, v232
    v_accvgpr_write_b32 a29, v234
    v_accvgpr_read_b32 v235, a30
    v_mul_f32_e64 v235, v235, v232
    v_accvgpr_write_b32 a30, v235
    v_accvgpr_read_b32 v236, a31
    v_mul_f32_e64 v236, v236, v232
    v_accvgpr_write_b32 a31, v236
    v_exp_f32 v128, v0
    v_exp_f32 v129, v1
    v_exp_f32 v130, v2
    v_exp_f32 v131, v3
    v_exp_f32 v132, v4
    v_exp_f32 v133, v5
    v_exp_f32 v134, v6
    v_exp_f32_e64 v135, v7
    s_nop 0
    v_cvt_pk_bf16_f32 v96, v128, v129
    v_cvt_pk_bf16_f32 v97, v130, v131
    v_cvt_pk_bf16_f32 v98, v132, v133
    v_cvt_pk_bf16_f32 v99, v134, v135
    v_max3_f32 v230, v8, v9, v10
    v_max3_f32 v230, v230, v11, v12
    v_max3_f32 v230, v230, v13, v14
    v_max_f32 v230, v230, v15
    v_mov_b32 v231, v230
    s_nop 1
    v_permlane16_swap_b32 v230, v231
    s_nop 0
    v_max_f32 v230, v230, v231
    v_mov_b32 v231, v230
    s_nop 1
    v_permlane32_swap_b32 v230, v231
    s_nop 0
    v_max_f32_e64 v230, v230, v231
    v_add_f32 v230, 0x41800000, v230
    v_max_f32 v230, 0, v230
    v_sub_f32 v232, 0, v230
    v_exp_f32 v232, v232
    v_sub_f32 v225, v225, v230
    v_sub_f32 v72, v72, v230
    v_sub_f32 v40, v40, v230
    v_sub_f32 v8, v8, v230
    v_sub_f32 v73, v73, v230
    v_sub_f32 v41, v41, v230
    v_sub_f32 v9, v9, v230
    v_sub_f32 v74, v74, v230
    v_sub_f32 v42, v42, v230
    v_sub_f32 v10, v10, v230
    v_sub_f32 v75, v75, v230
    v_sub_f32 v43, v43, v230
    v_sub_f32 v11, v11, v230
    v_sub_f32 v76, v76, v230
    v_sub_f32 v44, v44, v230
    v_sub_f32 v12, v12, v230
    v_sub_f32 v77, v77, v230
    v_sub_f32 v45, v45, v230
    v_sub_f32 v13, v13, v230
    v_sub_f32 v78, v78, v230
    v_sub_f32 v46, v46, v230
    v_sub_f32 v14, v14, v230
    v_sub_f32 v79, v79, v230
    v_sub_f32 v47, v47, v230
    v_sub_f32 v15, v15, v230
    v_mul_f32 v148, v148, v232
    v_mul_f32 v149, v149, v232
    v_mul_f32 v150, v150, v232
    v_mul_f32 v151, v151, v232
    v_accvgpr_read_b32 v233, a32
    v_mul_f32_e64 v233, v233, v232
    v_accvgpr_write_b32 a32, v233
    v_accvgpr_read_b32 v234, a33
    v_mul_f32_e64 v234, v234, v232
    v_accvgpr_write_b32 a33, v234
    v_accvgpr_read_b32 v235, a34
    v_mul_f32_e64 v235, v235, v232
    v_accvgpr_write_b32 a34, v235
    v_accvgpr_read_b32 v236, a35
    v_mul_f32_e64 v236, v236, v232
    v_accvgpr_write_b32 a35, v236
    v_accvgpr_read_b32 v233, a36
    v_mul_f32_e64 v233, v233, v232
    v_accvgpr_write_b32 a36, v233
    v_accvgpr_read_b32 v234, a37
    v_mul_f32_e64 v234, v234, v232
    v_accvgpr_write_b32 a37, v234
    v_accvgpr_read_b32 v235, a38
    v_mul_f32_e64 v235, v235, v232
    v_accvgpr_write_b32 a38, v235
    v_accvgpr_read_b32 v236, a39
    v_mul_f32_e64 v236, v236, v232
    v_accvgpr_write_b32 a39, v236
    v_accvgpr_read_b32 v233, a40
    v_mul_f32_e64 v233, v233, v232
    v_accvgpr_write_b32 a40, v233
    v_accvgpr_read_b32 v234, a41
    v_mul_f32_e64 v234, v234, v232
    v_accvgpr_write_b32 a41, v234
    v_accvgpr_read_b32 v235, a42
    v_mul_f32_e64 v235, v235, v232
    v_accvgpr_write_b32 a42, v235
    v_accvgpr_read_b32 v236, a43
    v_mul_f32_e64 v236, v236, v232
    v_accvgpr_write_b32 a43, v236
    v_accvgpr_read_b32 v233, a44
    v_mul_f32_e64 v233, v233, v232
    v_accvgpr_write_b32 a44, v233
    v_accvgpr_read_b32 v234, a45
    v_mul_f32_e64 v234, v234, v232
    v_accvgpr_write_b32 a45, v234
    v_accvgpr_read_b32 v235, a46
    v_mul_f32_e64 v235, v235, v232
    v_accvgpr_write_b32 a46, v235
    v_accvgpr_read_b32 v236, a47
    v_mul_f32_e64 v236, v236, v232
    v_accvgpr_write_b32 a47, v236
    v_accvgpr_read_b32 v233, a48
    v_mul_f32_e64 v233, v233, v232
    v_accvgpr_write_b32 a48, v233
    v_accvgpr_read_b32 v234, a49
    v_mul_f32_e64 v234, v234, v232
    v_accvgpr_write_b32 a49, v234
    v_accvgpr_read_b32 v235, a50
    v_mul_f32_e64 v235, v235, v232
    v_accvgpr_write_b32 a50, v235
    v_accvgpr_read_b32 v236, a51
    v_mul_f32_e64 v236, v236, v232
    v_accvgpr_write_b32 a51, v236
    v_accvgpr_read_b32 v233, a52
    v_mul_f32_e64 v233, v233, v232
    v_accvgpr_write_b32 a52, v233
    v_accvgpr_read_b32 v234, a53
    v_mul_f32_e64 v234, v234, v232
    v_accvgpr_write_b32 a53, v234
    v_accvgpr_read_b32 v235, a54
    v_mul_f32_e64 v235, v235, v232
    v_accvgpr_write_b32 a54, v235
    v_accvgpr_read_b32 v236, a55
    v_mul_f32_e64 v236, v236, v232
    v_accvgpr_write_b32 a55, v236
    v_accvgpr_read_b32 v233, a56
    v_mul_f32_e64 v233, v233, v232
    v_accvgpr_write_b32 a56, v233
    v_accvgpr_read_b32 v234, a57
    v_mul_f32_e64 v234, v234, v232
    v_accvgpr_write_b32 a57, v234
    v_accvgpr_read_b32 v235, a58
    v_mul_f32_e64 v235, v235, v232
    v_accvgpr_write_b32 a58, v235
    v_accvgpr_read_b32 v236, a59
    v_mul_f32_e64 v236, v236, v232
    v_accvgpr_write_b32 a59, v236
    v_accvgpr_read_b32 v233, a60
    v_mul_f32_e64 v233, v233, v232
    v_accvgpr_write_b32 a60, v233
    v_accvgpr_read_b32 v234, a61
    v_mul_f32_e64 v234, v234, v232
    v_accvgpr_write_b32 a61, v234
    v_accvgpr_read_b32 v235, a62
    v_mul_f32_e64 v235, v235, v232
    v_accvgpr_write_b32 a62, v235
    v_accvgpr_read_b32 v236, a63
    v_mul_f32_e64 v236, v236, v232
    v_accvgpr_write_b32 a63, v236
    v_exp_f32 v128, v8
    v_exp_f32 v129, v9
    v_exp_f32 v130, v10
    v_exp_f32 v131, v11
    v_exp_f32 v132, v12
    v_exp_f32 v133, v13
    v_exp_f32 v134, v14
    v_exp_f32_e64 v135, v15
    s_nop 0
    v_cvt_pk_bf16_f32 v100, v128, v129
    v_cvt_pk_bf16_f32 v101, v130, v131
    v_cvt_pk_bf16_f32 v102, v132, v133
    v_cvt_pk_bf16_f32 v103, v134, v135
    v_max3_f32 v230, v16, v17, v18
    v_max3_f32 v230, v230, v19, v20
    v_max3_f32 v230, v230, v21, v22
    v_max_f32 v230, v230, v23
    v_mov_b32 v231, v230
    s_nop 1
    v_permlane16_swap_b32 v230, v231
    s_nop 0
    v_max_f32 v230, v230, v231
    v_mov_b32 v231, v230
    s_nop 1
    v_permlane32_swap_b32 v230, v231
    s_nop 0
    v_max_f32_e64 v230, v230, v231
    v_add_f32 v230, 0x41800000, v230
    v_max_f32 v230, 0, v230
    v_sub_f32 v232, 0, v230
    v_exp_f32 v232, v232
    v_sub_f32 v226, v226, v230
    v_sub_f32 v80, v80, v230
    v_sub_f32 v48, v48, v230
    v_sub_f32 v16, v16, v230
    v_sub_f32 v81, v81, v230
    v_sub_f32 v49, v49, v230
    v_sub_f32 v17, v17, v230
    v_sub_f32 v82, v82, v230
    v_sub_f32 v50, v50, v230
    v_sub_f32 v18, v18, v230
    v_sub_f32 v83, v83, v230
    v_sub_f32 v51, v51, v230
    v_sub_f32 v19, v19, v230
    v_sub_f32 v84, v84, v230
    v_sub_f32 v52, v52, v230
    v_sub_f32 v20, v20, v230
    v_sub_f32 v85, v85, v230
    v_sub_f32 v53, v53, v230
    v_sub_f32 v21, v21, v230
    v_sub_f32 v86, v86, v230
    v_sub_f32 v54, v54, v230
    v_sub_f32 v22, v22, v230
    v_sub_f32 v87, v87, v230
    v_sub_f32 v55, v55, v230
    v_sub_f32 v23, v23, v230
    v_mul_f32 v152, v152, v232
    v_mul_f32 v153, v153, v232
    v_mul_f32 v154, v154, v232
    v_mul_f32 v155, v155, v232
    v_accvgpr_read_b32 v233, a64
    v_mul_f32_e64 v233, v233, v232
    v_accvgpr_write_b32 a64, v233
    v_accvgpr_read_b32 v234, a65
    v_mul_f32_e64 v234, v234, v232
    v_accvgpr_write_b32 a65, v234
    v_accvgpr_read_b32 v235, a66
    v_mul_f32_e64 v235, v235, v232
    v_accvgpr_write_b32 a66, v235
    v_accvgpr_read_b32 v236, a67
    v_mul_f32_e64 v236, v236, v232
    v_accvgpr_write_b32 a67, v236
    v_accvgpr_read_b32 v233, a68
    v_mul_f32_e64 v233, v233, v232
    v_accvgpr_write_b32 a68, v233
    v_accvgpr_read_b32 v234, a69
    v_mul_f32_e64 v234, v234, v232
    v_accvgpr_write_b32 a69, v234
    v_accvgpr_read_b32 v235, a70
    v_mul_f32_e64 v235, v235, v232
    v_accvgpr_write_b32 a70, v235
    v_accvgpr_read_b32 v236, a71
    v_mul_f32_e64 v236, v236, v232
    v_accvgpr_write_b32 a71, v236
    v_accvgpr_read_b32 v233, a72
    v_mul_f32_e64 v233, v233, v232
    v_accvgpr_write_b32 a72, v233
    v_accvgpr_read_b32 v234, a73
    v_mul_f32_e64 v234, v234, v232
    v_accvgpr_write_b32 a73, v234
    v_accvgpr_read_b32 v235, a74
    v_mul_f32_e64 v235, v235, v232
    v_accvgpr_write_b32 a74, v235
    v_accvgpr_read_b32 v236, a75
    v_mul_f32_e64 v236, v236, v232
    v_accvgpr_write_b32 a75, v236
    v_accvgpr_read_b32 v233, a76
    v_mul_f32_e64 v233, v233, v232
    v_accvgpr_write_b32 a76, v233
    v_accvgpr_read_b32 v234, a77
    v_mul_f32_e64 v234, v234, v232
    v_accvgpr_write_b32 a77, v234
    v_accvgpr_read_b32 v235, a78
    v_mul_f32_e64 v235, v235, v232
    v_accvgpr_write_b32 a78, v235
    v_accvgpr_read_b32 v236, a79
    v_mul_f32_e64 v236, v236, v232
    v_accvgpr_write_b32 a79, v236
    v_accvgpr_read_b32 v233, a80
    v_mul_f32_e64 v233, v233, v232
    v_accvgpr_write_b32 a80, v233
    v_accvgpr_read_b32 v234, a81
    v_mul_f32_e64 v234, v234, v232
    v_accvgpr_write_b32 a81, v234
    v_accvgpr_read_b32 v235, a82
    v_mul_f32_e64 v235, v235, v232
    v_accvgpr_write_b32 a82, v235
    v_accvgpr_read_b32 v236, a83
    v_mul_f32_e64 v236, v236, v232
    v_accvgpr_write_b32 a83, v236
    v_accvgpr_read_b32 v233, a84
    v_mul_f32_e64 v233, v233, v232
    v_accvgpr_write_b32 a84, v233
    v_accvgpr_read_b32 v234, a85
    v_mul_f32_e64 v234, v234, v232
    v_accvgpr_write_b32 a85, v234
    v_accvgpr_read_b32 v235, a86
    v_mul_f32_e64 v235, v235, v232
    v_accvgpr_write_b32 a86, v235
    v_accvgpr_read_b32 v236, a87
    v_mul_f32_e64 v236, v236, v232
    v_accvgpr_write_b32 a87, v236
    v_accvgpr_read_b32 v233, a88
    v_mul_f32_e64 v233, v233, v232
    v_accvgpr_write_b32 a88, v233
    v_accvgpr_read_b32 v234, a89
    v_mul_f32_e64 v234, v234, v232
    v_accvgpr_write_b32 a89, v234
    v_accvgpr_read_b32 v235, a90
    v_mul_f32_e64 v235, v235, v232
    v_accvgpr_write_b32 a90, v235
    v_accvgpr_read_b32 v236, a91
    v_mul_f32_e64 v236, v236, v232
    v_accvgpr_write_b32 a91, v236
    v_accvgpr_read_b32 v233, a92
    v_mul_f32_e64 v233, v233, v232
    v_accvgpr_write_b32 a92, v233
    v_accvgpr_read_b32 v234, a93
    v_mul_f32_e64 v234, v234, v232
    v_accvgpr_write_b32 a93, v234
    v_accvgpr_read_b32 v235, a94
    v_mul_f32_e64 v235, v235, v232
    v_accvgpr_write_b32 a94, v235
    v_accvgpr_read_b32 v236, a95
    v_mul_f32_e64 v236, v236, v232
    v_accvgpr_write_b32 a95, v236
    v_exp_f32 v128, v16
    v_exp_f32 v129, v17
    v_exp_f32 v130, v18
    v_exp_f32 v131, v19
    v_exp_f32 v132, v20
    v_exp_f32 v133, v21
    v_exp_f32 v134, v22
    v_exp_f32_e64 v135, v23
    s_nop 0
    v_cvt_pk_bf16_f32 v104, v128, v129
    v_cvt_pk_bf16_f32 v105, v130, v131
    v_cvt_pk_bf16_f32 v106, v132, v133
    v_cvt_pk_bf16_f32 v107, v134, v135
    v_max3_f32 v230, v24, v25, v26
    v_max3_f32 v230, v230, v27, v28
    v_max3_f32 v230, v230, v29, v30
    v_max_f32 v230, v230, v31
    v_mov_b32 v231, v230
    s_nop 1
    v_permlane16_swap_b32 v230, v231
    s_nop 0
    v_max_f32 v230, v230, v231
    v_mov_b32 v231, v230
    s_nop 1
    v_permlane32_swap_b32 v230, v231
    s_nop 0
    v_max_f32_e64 v230, v230, v231
    v_add_f32 v230, 0x41800000, v230
    v_max_f32 v230, 0, v230
    v_sub_f32 v232, 0, v230
    v_exp_f32 v232, v232
    v_sub_f32 v227, v227, v230
    v_sub_f32 v88, v88, v230
    v_sub_f32 v56, v56, v230
    v_sub_f32 v24, v24, v230
    v_sub_f32 v89, v89, v230
    v_sub_f32 v57, v57, v230
    v_sub_f32 v25, v25, v230
    v_sub_f32 v90, v90, v230
    v_sub_f32 v58, v58, v230
    v_sub_f32 v26, v26, v230
    v_sub_f32 v91, v91, v230
    v_sub_f32 v59, v59, v230
    v_sub_f32 v27, v27, v230
    v_sub_f32 v92, v92, v230
    v_sub_f32 v60, v60, v230
    v_sub_f32 v28, v28, v230
    v_sub_f32 v93, v93, v230
    v_sub_f32 v61, v61, v230
    v_sub_f32 v29, v29, v230
    v_sub_f32 v94, v94, v230
    v_sub_f32 v62, v62, v230
    v_sub_f32 v30, v30, v230
    v_sub_f32 v95, v95, v230
    v_sub_f32 v63, v63, v230
    v_sub_f32 v31, v31, v230
    v_mul_f32 v156, v156, v232
    v_mul_f32 v157, v157, v232
    v_mul_f32 v158, v158, v232
    v_mul_f32 v159, v159, v232
    v_accvgpr_read_b32 v233, a96
    v_mul_f32_e64 v233, v233, v232
    v_accvgpr_write_b32 a96, v233
    v_accvgpr_read_b32 v234, a97
    v_mul_f32_e64 v234, v234, v232
    v_accvgpr_write_b32 a97, v234
    v_accvgpr_read_b32 v235, a98
    v_mul_f32_e64 v235, v235, v232
    v_accvgpr_write_b32 a98, v235
    v_accvgpr_read_b32 v236, a99
    v_mul_f32_e64 v236, v236, v232
    v_accvgpr_write_b32 a99, v236
    v_accvgpr_read_b32 v233, a100
    v_mul_f32_e64 v233, v233, v232
    v_accvgpr_write_b32 a100, v233
    v_accvgpr_read_b32 v234, a101
    v_mul_f32_e64 v234, v234, v232
    v_accvgpr_write_b32 a101, v234
    v_accvgpr_read_b32 v235, a102
    v_mul_f32_e64 v235, v235, v232
    v_accvgpr_write_b32 a102, v235
    v_accvgpr_read_b32 v236, a103
    v_mul_f32_e64 v236, v236, v232
    v_accvgpr_write_b32 a103, v236
    v_accvgpr_read_b32 v233, a104
    v_mul_f32_e64 v233, v233, v232
    v_accvgpr_write_b32 a104, v233
    v_accvgpr_read_b32 v234, a105
    v_mul_f32_e64 v234, v234, v232
    v_accvgpr_write_b32 a105, v234
    v_accvgpr_read_b32 v235, a106
    v_mul_f32_e64 v235, v235, v232
    v_accvgpr_write_b32 a106, v235
    v_accvgpr_read_b32 v236, a107
    v_mul_f32_e64 v236, v236, v232
    v_accvgpr_write_b32 a107, v236
    v_accvgpr_read_b32 v233, a108
    v_mul_f32_e64 v233, v233, v232
    v_accvgpr_write_b32 a108, v233
    v_accvgpr_read_b32 v234, a109
    v_mul_f32_e64 v234, v234, v232
    v_accvgpr_write_b32 a109, v234
    v_accvgpr_read_b32 v235, a110
    v_mul_f32_e64 v235, v235, v232
    v_accvgpr_write_b32 a110, v235
    v_accvgpr_read_b32 v236, a111
    v_mul_f32_e64 v236, v236, v232
    v_accvgpr_write_b32 a111, v236
    v_accvgpr_read_b32 v233, a112
    v_mul_f32_e64 v233, v233, v232
    v_accvgpr_write_b32 a112, v233
    v_accvgpr_read_b32 v234, a113
    v_mul_f32_e64 v234, v234, v232
    v_accvgpr_write_b32 a113, v234
    v_accvgpr_read_b32 v235, a114
    v_mul_f32_e64 v235, v235, v232
    v_accvgpr_write_b32 a114, v235
    v_accvgpr_read_b32 v236, a115
    v_mul_f32_e64 v236, v236, v232
    v_accvgpr_write_b32 a115, v236
    v_accvgpr_read_b32 v233, a116
    v_mul_f32_e64 v233, v233, v232
    v_accvgpr_write_b32 a116, v233
    v_accvgpr_read_b32 v234, a117
    v_mul_f32_e64 v234, v234, v232
    v_accvgpr_write_b32 a117, v234
    v_accvgpr_read_b32 v235, a118
    v_mul_f32_e64 v235, v235, v232
    v_accvgpr_write_b32 a118, v235
    v_accvgpr_read_b32 v236, a119
    v_mul_f32_e64 v236, v236, v232
    v_accvgpr_write_b32 a119, v236
    v_accvgpr_read_b32 v233, a120
    v_mul_f32_e64 v233, v233, v232
    v_accvgpr_write_b32 a120, v233
    v_accvgpr_read_b32 v234, a121
    v_mul_f32_e64 v234, v234, v232
    v_accvgpr_write_b32 a121, v234
    v_accvgpr_read_b32 v235, a122
    v_mul_f32_e64 v235, v235, v232
    v_accvgpr_write_b32 a122, v235
    v_accvgpr_read_b32 v236, a123
    v_mul_f32_e64 v236, v236, v232
    v_accvgpr_write_b32 a123, v236
    v_accvgpr_read_b32 v233, a124
    v_mul_f32_e64 v233, v233, v232
    v_accvgpr_write_b32 a124, v233
    v_accvgpr_read_b32 v234, a125
    v_mul_f32_e64 v234, v234, v232
    v_accvgpr_write_b32 a125, v234
    v_accvgpr_read_b32 v235, a126
    v_mul_f32_e64 v235, v235, v232
    v_accvgpr_write_b32 a126, v235
    v_accvgpr_read_b32 v236, a127
    v_mul_f32_e64 v236, v236, v232
    v_accvgpr_write_b32 a127, v236
    v_exp_f32 v128, v24
    v_exp_f32 v129, v25
    v_exp_f32 v130, v26
    v_exp_f32 v131, v27
    v_exp_f32 v132, v28
    v_exp_f32 v133, v29
    v_exp_f32 v134, v30
    v_exp_f32_e64 v135, v31
    s_nop 0
    v_cvt_pk_bf16_f32 v108, v128, v129
    v_cvt_pk_bf16_f32 v109, v130, v131
    v_cvt_pk_bf16_f32 v110, v132, v133
    v_cvt_pk_bf16_f32 v111, v134, v135
    s_nop 1
    s_branch kf_rr9
kf_rare14:
    s_nop 15
    v_max3_f32 v230, v32, v33, v34
    v_max3_f32 v230, v230, v35, v36
    v_max3_f32 v230, v230, v37, v38
    v_max_f32 v230, v230, v39
    v_mov_b32 v231, v230
    s_nop 1
    v_permlane16_swap_b32 v230, v231
    s_nop 0
    v_max_f32 v230, v230, v231
    v_mov_b32 v231, v230
    s_nop 1
    v_permlane32_swap_b32 v230, v231
    s_nop 0
    v_max_f32 v230, v230, v231
    v_add_f32 v230, 0x41800000, v230
    v_max_f32 v230, 0, v230
    v_sub_f32 v232, 0, v230
    v_exp_f32 v232, v232
    v_sub_f32 v224, v224, v230
    v_sub_f32 v64, v64, v230
    v_sub_f32 v0, v0, v230
    v_sub_f32 v32, v32, v230
    v_sub_f32 v65, v65, v230
    v_sub_f32 v1, v1, v230
    v_sub_f32 v33, v33, v230
    v_sub_f32 v66, v66, v230
    v_sub_f32 v2, v2, v230
    v_sub_f32 v34, v34, v230
    v_sub_f32 v67, v67, v230
    v_sub_f32 v3, v3, v230
    v_sub_f32 v35, v35, v230
    v_sub_f32 v68, v68, v230
    v_sub_f32 v4, v4, v230
    v_sub_f32 v36, v36, v230
    v_sub_f32 v69, v69, v230
    v_sub_f32 v5, v5, v230
    v_sub_f32 v37, v37, v230
    v_sub_f32 v70, v70, v230
    v_sub_f32 v6, v6, v230
    v_sub_f32 v38, v38, v230
    v_sub_f32 v71, v71, v230
    v_sub_f32 v7, v7, v230
    v_sub_f32 v39, v39, v230
    v_mul_f32 v144, v144, v232
    v_mul_f32 v145, v145, v232
    v_mul_f32 v146, v146, v232
    v_mul_f32 v147, v147, v232
    v_accvgpr_read_b32 v233, a0
    v_mul_f32_e64 v233, v233, v232
    v_accvgpr_write_b32 a0, v233
    v_accvgpr_read_b32 v234, a1
    v_mul_f32_e64 v234, v234, v232
    v_accvgpr_write_b32 a1, v234
    v_accvgpr_read_b32 v235, a2
    v_mul_f32_e64 v235, v235, v232
    v_accvgpr_write_b32 a2, v235
    v_accvgpr_read_b32 v236, a3
    v_mul_f32_e64 v236, v236, v232
    v_accvgpr_write_b32 a3, v236
    v_accvgpr_read_b32 v233, a4
    v_mul_f32_e64 v233, v233, v232
    v_accvgpr_write_b32 a4, v233
    v_accvgpr_read_b32 v234, a5
    v_mul_f32_e64 v234, v234, v232
    v_accvgpr_write_b32 a5, v234
    v_accvgpr_read_b32 v235, a6
    v_mul_f32_e64 v235, v235, v232
    v_accvgpr_write_b32 a6, v235
    v_accvgpr_read_b32 v236, a7
    v_mul_f32_e64 v236, v236, v232
    v_accvgpr_write_b32 a7, v236
    v_accvgpr_read_b32 v233, a8
    v_mul_f32_e64 v233, v233, v232
    v_accvgpr_write_b32 a8, v233
    v_accvgpr_read_b32 v234, a9
    v_mul_f32_e64 v234, v234, v232
    v_accvgpr_write_b32 a9, v234
    v_accvgpr_read_b32 v235, a10
    v_mul_f32_e64 v235, v235, v232
    v_accvgpr_write_b32 a10, v235
    v_accvgpr_read_b32 v236, a11
    v_mul_f32_e64 v236, v236, v232
    v_accvgpr_write_b32 a11, v236
    v_accvgpr_read_b32 v233, a12
    v_mul_f32_e64 v233, v233, v232
    v_accvgpr_write_b32 a12, v233
    v_accvgpr_read_b32 v234, a13
    v_mul_f32_e64 v234, v234, v232
    v_accvgpr_write_b32 a13, v234
    v_accvgpr_read_b32 v235, a14
    v_mul_f32_e64 v235, v235, v232
    v_accvgpr_write_b32 a14, v235
    v_accvgpr_read_b32 v236, a15
    v_mul_f32_e64 v236, v236, v232
    v_accvgpr_write_b32 a15, v236
    v_accvgpr_read_b32 v233, a16
    v_mul_f32_e64 v233, v233, v232
    v_accvgpr_write_b32 a16, v233
    v_accvgpr_read_b32 v234, a17
    v_mul_f32_e64 v234, v234, v232
    v_accvgpr_write_b32 a17, v234
    v_accvgpr_read_b32 v235, a18
    v_mul_f32_e64 v235, v235, v232
    v_accvgpr_write_b32 a18, v235
    v_accvgpr_read_b32 v236, a19
    v_mul_f32_e64 v236, v236, v232
    v_accvgpr_write_b32 a19, v236
    v_accvgpr_read_b32 v233, a20
    v_mul_f32_e64 v233, v233, v232
    v_accvgpr_write_b32 a20, v233
    v_accvgpr_read_b32 v234, a21
    v_mul_f32_e64 v234, v234, v232
    v_accvgpr_write_b32 a21, v234
    v_accvgpr_read_b32 v235, a22
    v_mul_f32_e64 v235, v235, v232
    v_accvgpr_write_b32 a22, v235
    v_accvgpr_read_b32 v236, a23
    v_mul_f32_e64 v236, v236, v232
    v_accvgpr_write_b32 a23, v236
    v_accvgpr_read_b32 v233, a24
    v_mul_f32_e64 v233, v233, v232
    v_accvgpr_write_b32 a24, v233
    v_accvgpr_read_b32 v234, a25
    v_mul_f32_e64 v234, v234, v232
    v_accvgpr_write_b32 a25, v234
    v_accvgpr_read_b32 v235, a26
    v_mul_f32_e64 v235, v235, v232
    v_accvgpr_write_b32 a26, v235
    v_accvgpr_read_b32 v236, a27
    v_mul_f32_e64 v236, v236, v232
    v_accvgpr_write_b32 a27, v236
    v_accvgpr_read_b32 v233, a28
    v_mul_f32_e64 v233, v233, v232
    v_accvgpr_write_b32 a28, v233
    v_accvgpr_read_b32 v234, a29
    v_mul_f32_e64 v234, v234, v232
    v_accvgpr_write_b32 a29, v234
    v_accvgpr_read_b32 v235, a30
    v_mul_f32_e64 v235, v235, v232
    v_accvgpr_write_b32 a30, v235
    v_accvgpr_read_b32 v236, a31
    v_mul_f32_e64 v236, v236, v232
    v_accvgpr_write_b32 a31, v236
    v_exp_f32 v128, v32
    v_exp_f32 v129, v33
    v_exp_f32 v130, v34
    v_exp_f32 v131, v35
    v_exp_f32 v132, v36
    v_exp_f32 v133, v37
    v_exp_f32 v134, v38
    v_exp_f32_e64 v135, v39
    s_nop 0
    v_cvt_pk_bf16_f32 v112, v128, v129
    v_cvt_pk_bf16_f32 v113, v130, v131
    v_cvt_pk_bf16_f32 v114, v132, v133
    v_cvt_pk_bf16_f32 v115, v134, v135
    v_max3_f32 v230, v40, v41, v42
    v_max3_f32 v230, v230, v43, v44
    v_max3_f32 v230, v230, v45, v46
    v_max_f32 v230, v230, v47
    v_mov_b32 v231, v230
    s_nop 1
    v_permlane16_swap_b32 v230, v231
    s_nop 0
    v_max_f32 v230, v230, v231
    v_mov_b32 v231, v230
    s_nop 1
    v_permlane32_swap_b32 v230, v231
    s_nop 0
    v_max_f32_e64 v230, v230, v231
    v_add_f32 v230, 0x41800000, v230
    v_max_f32 v230, 0, v230
    v_sub_f32 v232, 0, v230
    v_exp_f32 v232, v232
    v_sub_f32 v225, v225, v230
    v_sub_f32 v72, v72, v230
    v_sub_f32 v8, v8, v230
    v_sub_f32 v40, v40, v230
    v_sub_f32 v73, v73, v230
    v_sub_f32 v9, v9, v230
    v_sub_f32 v41, v41, v230
    v_sub_f32 v74, v74, v230
    v_sub_f32 v10, v10, v230
    v_sub_f32 v42, v42, v230
    v_sub_f32 v75, v75, v230
    v_sub_f32 v11, v11, v230
    v_sub_f32 v43, v43, v230
    v_sub_f32 v76, v76, v230
    v_sub_f32 v12, v12, v230
    v_sub_f32 v44, v44, v230
    v_sub_f32 v77, v77, v230
    v_sub_f32 v13, v13, v230
    v_sub_f32 v45, v45, v230
    v_sub_f32 v78, v78, v230
    v_sub_f32 v14, v14, v230
    v_sub_f32 v46, v46, v230
    v_sub_f32 v79, v79, v230
    v_sub_f32 v15, v15, v230
    v_sub_f32 v47, v47, v230
    v_mul_f32 v148, v148, v232
    v_mul_f32 v149, v149, v232
    v_mul_f32 v150, v150, v232
    v_mul_f32 v151, v151, v232
    v_accvgpr_read_b32 v233, a32
    v_mul_f32_e64 v233, v233, v232
    v_accvgpr_write_b32 a32, v233
    v_accvgpr_read_b32 v234, a33
    v_mul_f32_e64 v234, v234, v232
    v_accvgpr_write_b32 a33, v234
    v_accvgpr_read_b32 v235, a34
    v_mul_f32_e64 v235, v235, v232
    v_accvgpr_write_b32 a34, v235
    v_accvgpr_read_b32 v236, a35
    v_mul_f32_e64 v236, v236, v232
    v_accvgpr_write_b32 a35, v236
    v_accvgpr_read_b32 v233, a36
    v_mul_f32_e64 v233, v233, v232
    v_accvgpr_write_b32 a36, v233
    v_accvgpr_read_b32 v234, a37
    v_mul_f32_e64 v234, v234, v232
    v_accvgpr_write_b32 a37, v234
    v_accvgpr_read_b32 v235, a38
    v_mul_f32_e64 v235, v235, v232
    v_accvgpr_write_b32 a38, v235
    v_accvgpr_read_b32 v236, a39
    v_mul_f32_e64 v236, v236, v232
    v_accvgpr_write_b32 a39, v236
    v_accvgpr_read_b32 v233, a40
    v_mul_f32_e64 v233, v233, v232
    v_accvgpr_write_b32 a40, v233
    v_accvgpr_read_b32 v234, a41
    v_mul_f32_e64 v234, v234, v232
    v_accvgpr_write_b32 a41, v234
    v_accvgpr_read_b32 v235, a42
    v_mul_f32_e64 v235, v235, v232
    v_accvgpr_write_b32 a42, v235
    v_accvgpr_read_b32 v236, a43
    v_mul_f32_e64 v236, v236, v232
    v_accvgpr_write_b32 a43, v236
    v_accvgpr_read_b32 v233, a44
    v_mul_f32_e64 v233, v233, v232
    v_accvgpr_write_b32 a44, v233
    v_accvgpr_read_b32 v234, a45
    v_mul_f32_e64 v234, v234, v232
    v_accvgpr_write_b32 a45, v234
    v_accvgpr_read_b32 v235, a46
    v_mul_f32_e64 v235, v235, v232
    v_accvgpr_write_b32 a46, v235
    v_accvgpr_read_b32 v236, a47
    v_mul_f32_e64 v236, v236, v232
    v_accvgpr_write_b32 a47, v236
    v_accvgpr_read_b32 v233, a48
    v_mul_f32_e64 v233, v233, v232
    v_accvgpr_write_b32 a48, v233
    v_accvgpr_read_b32 v234, a49
    v_mul_f32_e64 v234, v234, v232
    v_accvgpr_write_b32 a49, v234
    v_accvgpr_read_b32 v235, a50
    v_mul_f32_e64 v235, v235, v232
    v_accvgpr_write_b32 a50, v235
    v_accvgpr_read_b32 v236, a51
    v_mul_f32_e64 v236, v236, v232
    v_accvgpr_write_b32 a51, v236
    v_accvgpr_read_b32 v233, a52
    v_mul_f32_e64 v233, v233, v232
    v_accvgpr_write_b32 a52, v233
    v_accvgpr_read_b32 v234, a53
    v_mul_f32_e64 v234, v234, v232
    v_accvgpr_write_b32 a53, v234
    v_accvgpr_read_b32 v235, a54
    v_mul_f32_e64 v235, v235, v232
    v_accvgpr_write_b32 a54, v235
    v_accvgpr_read_b32 v236, a55
    v_mul_f32_e64 v236, v236, v232
    v_accvgpr_write_b32 a55, v236
    v_accvgpr_read_b32 v233, a56
    v_mul_f32_e64 v233, v233, v232
    v_accvgpr_write_b32 a56, v233
    v_accvgpr_read_b32 v234, a57
    v_mul_f32_e64 v234, v234, v232
    v_accvgpr_write_b32 a57, v234
    v_accvgpr_read_b32 v235, a58
    v_mul_f32_e64 v235, v235, v232
    v_accvgpr_write_b32 a58, v235
    v_accvgpr_read_b32 v236, a59
    v_mul_f32_e64 v236, v236, v232
    v_accvgpr_write_b32 a59, v236
    v_accvgpr_read_b32 v233, a60
    v_mul_f32_e64 v233, v233, v232
    v_accvgpr_write_b32 a60, v233
    v_accvgpr_read_b32 v234, a61
    v_mul_f32_e64 v234, v234, v232
    v_accvgpr_write_b32 a61, v234
    v_accvgpr_read_b32 v235, a62
    v_mul_f32_e64 v235, v235, v232
    v_accvgpr_write_b32 a62, v235
    v_accvgpr_read_b32 v236, a63
    v_mul_f32_e64 v236, v236, v232
    v_accvgpr_write_b32 a63, v236
    v_exp_f32 v128, v40
    v_exp_f32 v129, v41
    v_exp_f32 v130, v42
    v_exp_f32 v131, v43
    v_exp_f32 v132, v44
    v_exp_f32 v133, v45
    v_exp_f32 v134, v46
    v_exp_f32_e64 v135, v47
    s_nop 0
    v_cvt_pk_bf16_f32 v116, v128, v129
    v_cvt_pk_bf16_f32 v117, v130, v131
    v_cvt_pk_bf16_f32 v118, v132, v133
    v_cvt_pk_bf16_f32 v119, v134, v135
    v_max3_f32 v230, v48, v49, v50
    v_max3_f32 v230, v230, v51, v52
    v_max3_f32 v230, v230, v53, v54
    v_max_f32 v230, v230, v55
    v_mov_b32 v231, v230
    s_nop 1
    v_permlane16_swap_b32 v230, v231
    s_nop 0
    v_max_f32 v230, v230, v231
    v_mov_b32 v231, v230
    s_nop 1
    v_permlane32_swap_b32 v230, v231
    s_nop 0
    v_max_f32_e64 v230, v230, v231
    v_add_f32 v230, 0x41800000, v230
    v_max_f32 v230, 0, v230
    v_sub_f32 v232, 0, v230
    v_exp_f32 v232, v232
    v_sub_f32 v226, v226, v230
    v_sub_f32 v80, v80, v230
    v_sub_f32 v16, v16, v230
    v_sub_f32 v48, v48, v230
    v_sub_f32 v81, v81, v230
    v_sub_f32 v17, v17, v230
    v_sub_f32 v49, v49, v230
    v_sub_f32 v82, v82, v230
    v_sub_f32 v18, v18, v230
    v_sub_f32 v50, v50, v230
    v_sub_f32 v83, v83, v230
    v_sub_f32 v19, v19, v230
    v_sub_f32 v51, v51, v230
    v_sub_f32 v84, v84, v230
    v_sub_f32 v20, v20, v230
    v_sub_f32 v52, v52, v230
    v_sub_f32 v85, v85, v230
    v_sub_f32 v21, v21, v230
    v_sub_f32 v53, v53, v230
    v_sub_f32 v86, v86, v230
    v_sub_f32 v22, v22, v230
    v_sub_f32 v54, v54, v230
    v_sub_f32 v87, v87, v230
    v_sub_f32 v23, v23, v230
    v_sub_f32 v55, v55, v230
    v_mul_f32 v152, v152, v232
    v_mul_f32 v153, v153, v232
    v_mul_f32 v154, v154, v232
    v_mul_f32 v155, v155, v232
    v_accvgpr_read_b32 v233, a64
    v_mul_f32_e64 v233, v233, v232
    v_accvgpr_write_b32 a64, v233
    v_accvgpr_read_b32 v234, a65
    v_mul_f32_e64 v234, v234, v232
    v_accvgpr_write_b32 a65, v234
    v_accvgpr_read_b32 v235, a66
    v_mul_f32_e64 v235, v235, v232
    v_accvgpr_write_b32 a66, v235
    v_accvgpr_read_b32 v236, a67
    v_mul_f32_e64 v236, v236, v232
    v_accvgpr_write_b32 a67, v236
    v_accvgpr_read_b32 v233, a68
    v_mul_f32_e64 v233, v233, v232
    v_accvgpr_write_b32 a68, v233
    v_accvgpr_read_b32 v234, a69
    v_mul_f32_e64 v234, v234, v232
    v_accvgpr_write_b32 a69, v234
    v_accvgpr_read_b32 v235, a70
    v_mul_f32_e64 v235, v235, v232
    v_accvgpr_write_b32 a70, v235
    v_accvgpr_read_b32 v236, a71
    v_mul_f32_e64 v236, v236, v232
    v_accvgpr_write_b32 a71, v236
    v_accvgpr_read_b32 v233, a72
    v_mul_f32_e64 v233, v233, v232
    v_accvgpr_write_b32 a72, v233
    v_accvgpr_read_b32 v234, a73
    v_mul_f32_e64 v234, v234, v232
    v_accvgpr_write_b32 a73, v234
    v_accvgpr_read_b32 v235, a74
    v_mul_f32_e64 v235, v235, v232
    v_accvgpr_write_b32 a74, v235
    v_accvgpr_read_b32 v236, a75
    v_mul_f32_e64 v236, v236, v232
    v_accvgpr_write_b32 a75, v236
    v_accvgpr_read_b32 v233, a76
    v_mul_f32_e64 v233, v233, v232
    v_accvgpr_write_b32 a76, v233
    v_accvgpr_read_b32 v234, a77
    v_mul_f32_e64 v234, v234, v232
    v_accvgpr_write_b32 a77, v234
    v_accvgpr_read_b32 v235, a78
    v_mul_f32_e64 v235, v235, v232
    v_accvgpr_write_b32 a78, v235
    v_accvgpr_read_b32 v236, a79
    v_mul_f32_e64 v236, v236, v232
    v_accvgpr_write_b32 a79, v236
    v_accvgpr_read_b32 v233, a80
    v_mul_f32_e64 v233, v233, v232
    v_accvgpr_write_b32 a80, v233
    v_accvgpr_read_b32 v234, a81
    v_mul_f32_e64 v234, v234, v232
    v_accvgpr_write_b32 a81, v234
    v_accvgpr_read_b32 v235, a82
    v_mul_f32_e64 v235, v235, v232
    v_accvgpr_write_b32 a82, v235
    v_accvgpr_read_b32 v236, a83
    v_mul_f32_e64 v236, v236, v232
    v_accvgpr_write_b32 a83, v236
    v_accvgpr_read_b32 v233, a84
    v_mul_f32_e64 v233, v233, v232
    v_accvgpr_write_b32 a84, v233
    v_accvgpr_read_b32 v234, a85
    v_mul_f32_e64 v234, v234, v232
    v_accvgpr_write_b32 a85, v234
    v_accvgpr_read_b32 v235, a86
    v_mul_f32_e64 v235, v235, v232
    v_accvgpr_write_b32 a86, v235
    v_accvgpr_read_b32 v236, a87
    v_mul_f32_e64 v236, v236, v232
    v_accvgpr_write_b32 a87, v236
    v_accvgpr_read_b32 v233, a88
    v_mul_f32_e64 v233, v233, v232
    v_accvgpr_write_b32 a88, v233
    v_accvgpr_read_b32 v234, a89
    v_mul_f32_e64 v234, v234, v232
    v_accvgpr_write_b32 a89, v234
    v_accvgpr_read_b32 v235, a90
    v_mul_f32_e64 v235, v235, v232
    v_accvgpr_write_b32 a90, v235
    v_accvgpr_read_b32 v236, a91
    v_mul_f32_e64 v236, v236, v232
    v_accvgpr_write_b32 a91, v236
    v_accvgpr_read_b32 v233, a92
    v_mul_f32_e64 v233, v233, v232
    v_accvgpr_write_b32 a92, v233
    v_accvgpr_read_b32 v234, a93
    v_mul_f32_e64 v234, v234, v232
    v_accvgpr_write_b32 a93, v234
    v_accvgpr_read_b32 v235, a94
    v_mul_f32_e64 v235, v235, v232
    v_accvgpr_write_b32 a94, v235
    v_accvgpr_read_b32 v236, a95
    v_mul_f32_e64 v236, v236, v232
    v_accvgpr_write_b32 a95, v236
    v_exp_f32 v128, v48
    v_exp_f32 v129, v49
    v_exp_f32 v130, v50
    v_exp_f32 v131, v51
    v_exp_f32 v132, v52
    v_exp_f32 v133, v53
    v_exp_f32 v134, v54
    v_exp_f32_e64 v135, v55
    s_nop 0
    v_cvt_pk_bf16_f32 v120, v128, v129
    v_cvt_pk_bf16_f32 v121, v130, v131
    v_cvt_pk_bf16_f32 v122, v132, v133
    v_cvt_pk_bf16_f32 v123, v134, v135
    v_max3_f32 v230, v56, v57, v58
    v_max3_f32 v230, v230, v59, v60
    v_max3_f32 v230, v230, v61, v62
    v_max_f32 v230, v230, v63
    v_mov_b32 v231, v230
    s_nop 1
    v_permlane16_swap_b32 v230, v231
    s_nop 0
    v_max_f32 v230, v230, v231
    v_mov_b32 v231, v230
    s_nop 1
    v_permlane32_swap_b32 v230, v231
    s_nop 0
    v_max_f32_e64 v230, v230, v231
    v_add_f32 v230, 0x41800000, v230
    v_max_f32 v230, 0, v230
    v_sub_f32 v232, 0, v230
    v_exp_f32 v232, v232
    v_sub_f32 v227, v227, v230
    v_sub_f32 v88, v88, v230
    v_sub_f32 v24, v24, v230
    v_sub_f32 v56, v56, v230
    v_sub_f32 v89, v89, v230
    v_sub_f32 v25, v25, v230
    v_sub_f32 v57, v57, v230
    v_sub_f32 v90, v90, v230
    v_sub_f32 v26, v26, v230
    v_sub_f32 v58, v58, v230
    v_sub_f32 v91, v91, v230
    v_sub_f32 v27, v27, v230
    v_sub_f32 v59, v59, v230
    v_sub_f32 v92, v92, v230
    v_sub_f32 v28, v28, v230
    v_sub_f32 v60, v60, v230
    v_sub_f32 v93, v93, v230
    v_sub_f32 v29, v29, v230
    v_sub_f32 v61, v61, v230
    v_sub_f32 v94, v94, v230
    v_sub_f32 v30, v30, v230
    v_sub_f32 v62, v62, v230
    v_sub_f32 v95, v95, v230
    v_sub_f32 v31, v31, v230
    v_sub_f32 v63, v63, v230
    v_mul_f32 v156, v156, v232
    v_mul_f32 v157, v157, v232
    v_mul_f32 v158, v158, v232
    v_mul_f32 v159, v159, v232
    v_accvgpr_read_b32 v233, a96
    v_mul_f32_e64 v233, v233, v232
    v_accvgpr_write_b32 a96, v233
    v_accvgpr_read_b32 v234, a97
    v_mul_f32_e64 v234, v234, v232
    v_accvgpr_write_b32 a97, v234
    v_accvgpr_read_b32 v235, a98
    v_mul_f32_e64 v235, v235, v232
    v_accvgpr_write_b32 a98, v235
    v_accvgpr_read_b32 v236, a99
    v_mul_f32_e64 v236, v236, v232
    v_accvgpr_write_b32 a99, v236
    v_accvgpr_read_b32 v233, a100
    v_mul_f32_e64 v233, v233, v232
    v_accvgpr_write_b32 a100, v233
    v_accvgpr_read_b32 v234, a101
    v_mul_f32_e64 v234, v234, v232
    v_accvgpr_write_b32 a101, v234
    v_accvgpr_read_b32 v235, a102
    v_mul_f32_e64 v235, v235, v232
    v_accvgpr_write_b32 a102, v235
    v_accvgpr_read_b32 v236, a103
    v_mul_f32_e64 v236, v236, v232
    v_accvgpr_write_b32 a103, v236
    v_accvgpr_read_b32 v233, a104
    v_mul_f32_e64 v233, v233, v232
    v_accvgpr_write_b32 a104, v233
    v_accvgpr_read_b32 v234, a105
    v_mul_f32_e64 v234, v234, v232
    v_accvgpr_write_b32 a105, v234
    v_accvgpr_read_b32 v235, a106
    v_mul_f32_e64 v235, v235, v232
    v_accvgpr_write_b32 a106, v235
    v_accvgpr_read_b32 v236, a107
    v_mul_f32_e64 v236, v236, v232
    v_accvgpr_write_b32 a107, v236
    v_accvgpr_read_b32 v233, a108
    v_mul_f32_e64 v233, v233, v232
    v_accvgpr_write_b32 a108, v233
    v_accvgpr_read_b32 v234, a109
    v_mul_f32_e64 v234, v234, v232
    v_accvgpr_write_b32 a109, v234
    v_accvgpr_read_b32 v235, a110
    v_mul_f32_e64 v235, v235, v232
    v_accvgpr_write_b32 a110, v235
    v_accvgpr_read_b32 v236, a111
    v_mul_f32_e64 v236, v236, v232
    v_accvgpr_write_b32 a111, v236
    v_accvgpr_read_b32 v233, a112
    v_mul_f32_e64 v233, v233, v232
    v_accvgpr_write_b32 a112, v233
    v_accvgpr_read_b32 v234, a113
    v_mul_f32_e64 v234, v234, v232
    v_accvgpr_write_b32 a113, v234
    v_accvgpr_read_b32 v235, a114
    v_mul_f32_e64 v235, v235, v232
    v_accvgpr_write_b32 a114, v235
    v_accvgpr_read_b32 v236, a115
    v_mul_f32_e64 v236, v236, v232
    v_accvgpr_write_b32 a115, v236
    v_accvgpr_read_b32 v233, a116
    v_mul_f32_e64 v233, v233, v232
    v_accvgpr_write_b32 a116, v233
    v_accvgpr_read_b32 v234, a117
    v_mul_f32_e64 v234, v234, v232
    v_accvgpr_write_b32 a117, v234
    v_accvgpr_read_b32 v235, a118
    v_mul_f32_e64 v235, v235, v232
    v_accvgpr_write_b32 a118, v235
    v_accvgpr_read_b32 v236, a119
    v_mul_f32_e64 v236, v236, v232
    v_accvgpr_write_b32 a119, v236
    v_accvgpr_read_b32 v233, a120
    v_mul_f32_e64 v233, v233, v232
    v_accvgpr_write_b32 a120, v233
    v_accvgpr_read_b32 v234, a121
    v_mul_f32_e64 v234, v234, v232
    v_accvgpr_write_b32 a121, v234
    v_accvgpr_read_b32 v235, a122
    v_mul_f32_e64 v235, v235, v232
    v_accvgpr_write_b32 a122, v235
    v_accvgpr_read_b32 v236, a123
    v_mul_f32_e64 v236, v236, v232
    v_accvgpr_write_b32 a123, v236
    v_accvgpr_read_b32 v233, a124
    v_mul_f32_e64 v233, v233, v232
    v_accvgpr_write_b32 a124, v233
    v_accvgpr_read_b32 v234, a125
    v_mul_f32_e64 v234, v234, v232
    v_accvgpr_write_b32 a125, v234
    v_accvgpr_read_b32 v235, a126
    v_mul_f32_e64 v235, v235, v232
    v_accvgpr_write_b32 a126, v235
    v_accvgpr_read_b32 v236, a127
    v_mul_f32_e64 v236, v236, v232
    v_accvgpr_write_b32 a127, v236
    v_exp_f32 v128, v56
    v_exp_f32 v129, v57
    v_exp_f32 v130, v58
    v_exp_f32 v131, v59
    v_exp_f32 v132, v60
    v_exp_f32 v133, v61
    v_exp_f32 v134, v62
    v_exp_f32_e64 v135, v63
    s_nop 0
    v_cvt_pk_bf16_f32 v124, v128, v129
    v_cvt_pk_bf16_f32 v125, v130, v131
    v_cvt_pk_bf16_f32 v126, v132, v133
    v_cvt_pk_bf16_f32 v127, v134, v135
    s_nop 1
    s_branch kf_rr13
kf_rare18:
    s_nop 15
    v_max3_f32 v230, v16, v17, v18
    v_max3_f32 v230, v230, v19, v20
    v_max3_f32 v230, v230, v21, v22
    v_max_f32 v230, v230, v23
    v_mov_b32 v231, v230
    s_nop 1
    v_permlane16_swap_b32 v230, v231
    s_nop 0
    v_max_f32 v230, v230, v231
    v_mov_b32 v231, v230
    s_nop 1
    v_permlane32_swap_b32 v230, v231
    s_nop 0
    v_max_f32 v230, v230, v231
    v_add_f32 v230, 0x41800000, v230
    v_max_f32 v230, 0, v230
    v_sub_f32 v232, 0, v230
    v_exp_f32 v232, v232
    v_sub_f32 v226, v226, v230
    v_sub_f32 v80, v80, v230
    v_sub_f32 v48, v48, v230
    v_sub_f32 v16, v16, v230
    v_sub_f32 v81, v81, v230
    v_sub_f32 v49, v49, v230
    v_sub_f32 v17, v17, v230
    v_sub_f32 v82, v82, v230
    v_sub_f32 v50, v50, v230
    v_sub_f32 v18, v18, v230
    v_sub_f32 v83, v83, v230
    v_sub_f32 v51, v51, v230
    v_sub_f32 v19, v19, v230
    v_sub_f32 v84, v84, v230
    v_sub_f32 v52, v52, v230
    v_sub_f32 v20, v20, v230
    v_sub_f32 v85, v85, v230
    v_sub_f32 v53, v53, v230
    v_sub_f32 v21, v21, v230
    v_sub_f32 v86, v86, v230
    v_sub_f32 v54, v54, v230
    v_sub_f32 v22, v22, v230
    v_sub_f32 v87, v87, v230
    v_sub_f32 v55, v55, v230
    v_sub_f32 v23, v23, v230
    v_mul_f32 v152, v152, v232
    v_mul_f32 v153, v153, v232
    v_mul_f32 v154, v154, v232
    v_mul_f32 v155, v155, v232
    v_accvgpr_read_b32 v233, a64
    v_mul_f32_e64 v233, v233, v232
    v_accvgpr_write_b32 a64, v233
    v_accvgpr_read_b32 v234, a65
    v_mul_f32_e64 v234, v234, v232
    v_accvgpr_write_b32 a65, v234
    v_accvgpr_read_b32 v235, a66
    v_mul_f32_e64 v235, v235, v232
    v_accvgpr_write_b32 a66, v235
    v_accvgpr_read_b32 v236, a67
    v_mul_f32_e64 v236, v236, v232
    v_accvgpr_write_b32 a67, v236
    v_accvgpr_read_b32 v233, a68
    v_mul_f32_e64 v233, v233, v232
    v_accvgpr_write_b32 a68, v233
    v_accvgpr_read_b32 v234, a69
    v_mul_f32_e64 v234, v234, v232
    v_accvgpr_write_b32 a69, v234
    v_accvgpr_read_b32 v235, a70
    v_mul_f32_e64 v235, v235, v232
    v_accvgpr_write_b32 a70, v235
    v_accvgpr_read_b32 v236, a71
    v_mul_f32_e64 v236, v236, v232
    v_accvgpr_write_b32 a71, v236
    v_accvgpr_read_b32 v233, a72
    v_mul_f32_e64 v233, v233, v232
    v_accvgpr_write_b32 a72, v233
    v_accvgpr_read_b32 v234, a73
    v_mul_f32_e64 v234, v234, v232
    v_accvgpr_write_b32 a73, v234
    v_accvgpr_read_b32 v235, a74
    v_mul_f32_e64 v235, v235, v232
    v_accvgpr_write_b32 a74, v235
    v_accvgpr_read_b32 v236, a75
    v_mul_f32_e64 v236, v236, v232
    v_accvgpr_write_b32 a75, v236
    v_accvgpr_read_b32 v233, a76
    v_mul_f32_e64 v233, v233, v232
    v_accvgpr_write_b32 a76, v233
    v_accvgpr_read_b32 v234, a77
    v_mul_f32_e64 v234, v234, v232
    v_accvgpr_write_b32 a77, v234
    v_accvgpr_read_b32 v235, a78
    v_mul_f32_e64 v235, v235, v232
    v_accvgpr_write_b32 a78, v235
    v_accvgpr_read_b32 v236, a79
    v_mul_f32_e64 v236, v236, v232
    v_accvgpr_write_b32 a79, v236
    v_accvgpr_read_b32 v233, a80
    v_mul_f32_e64 v233, v233, v232
    v_accvgpr_write_b32 a80, v233
    v_accvgpr_read_b32 v234, a81
    v_mul_f32_e64 v234, v234, v232
    v_accvgpr_write_b32 a81, v234
    v_accvgpr_read_b32 v235, a82
    v_mul_f32_e64 v235, v235, v232
    v_accvgpr_write_b32 a82, v235
    v_accvgpr_read_b32 v236, a83
    v_mul_f32_e64 v236, v236, v232
    v_accvgpr_write_b32 a83, v236
    v_accvgpr_read_b32 v233, a84
    v_mul_f32_e64 v233, v233, v232
    v_accvgpr_write_b32 a84, v233
    v_accvgpr_read_b32 v234, a85
    v_mul_f32_e64 v234, v234, v232
    v_accvgpr_write_b32 a85, v234
    v_accvgpr_read_b32 v235, a86
    v_mul_f32_e64 v235, v235, v232
    v_accvgpr_write_b32 a86, v235
    v_accvgpr_read_b32 v236, a87
    v_mul_f32_e64 v236, v236, v232
    v_accvgpr_write_b32 a87, v236
    v_accvgpr_read_b32 v233, a88
    v_mul_f32_e64 v233, v233, v232
    v_accvgpr_write_b32 a88, v233
    v_accvgpr_read_b32 v234, a89
    v_mul_f32_e64 v234, v234, v232
    v_accvgpr_write_b32 a89, v234
    v_accvgpr_read_b32 v235, a90
    v_mul_f32_e64 v235, v235, v232
    v_accvgpr_write_b32 a90, v235
    v_accvgpr_read_b32 v236, a91
    v_mul_f32_e64 v236, v236, v232
    v_accvgpr_write_b32 a91, v236
    v_accvgpr_read_b32 v233, a92
    v_mul_f32_e64 v233, v233, v232
    v_accvgpr_write_b32 a92, v233
    v_accvgpr_read_b32 v234, a93
    v_mul_f32_e64 v234, v234, v232
    v_accvgpr_write_b32 a93, v234
    v_accvgpr_read_b32 v235, a94
    v_mul_f32_e64 v235, v235, v232
    v_accvgpr_write_b32 a94, v235
    v_accvgpr_read_b32 v236, a95
    v_mul_f32_e64 v236, v236, v232
    v_accvgpr_write_b32 a95, v236
    v_exp_f32 v128, v16
    v_exp_f32 v129, v17
    v_exp_f32 v130, v18
    v_exp_f32 v131, v19
    v_exp_f32 v132, v20
    v_exp_f32 v133, v21
    v_exp_f32 v134, v22
    v_exp_f32_e64 v135, v23
    s_nop 0
    v_cvt_pk_bf16_f32 v104, v128, v129
    v_cvt_pk_bf16_f32 v105, v130, v131
    v_cvt_pk_bf16_f32 v106, v132, v133
    v_cvt_pk_bf16_f32 v107, v134, v135
    v_max3_f32 v230, v24, v25, v26
    v_max3_f32 v230, v230, v27, v28
    v_max3_f32 v230, v230, v29, v30
    v_max_f32 v230, v230, v31
    v_mov_b32 v231, v230
    s_nop 1
    v_permlane16_swap_b32 v230, v231
    s_nop 0
    v_max_f32 v230, v230, v231
    v_mov_b32 v231, v230
    s_nop 1
    v_permlane32_swap_b32 v230, v231
    s_nop 0
    v_max_f32_e64 v230, v230, v231
    v_add_f32 v230, 0x41800000, v230
    v_max_f32 v230, 0, v230
    v_sub_f32 v232, 0, v230
    v_exp_f32 v232, v232
    v_sub_f32 v227, v227, v230
    v_sub_f32 v88, v88, v230
    v_sub_f32 v56, v56, v230
    v_sub_f32 v24, v24, v230
    v_sub_f32 v89, v89, v230
    v_sub_f32 v57, v57, v230
    v_sub_f32 v25, v25, v230
    v_sub_f32 v90, v90, v230
    v_sub_f32 v58, v58, v230
    v_sub_f32 v26, v26, v230
    v_sub_f32 v91, v91, v230
    v_sub_f32 v59, v59, v230
    v_sub_f32 v27, v27, v230
    v_sub_f32 v92, v92, v230
    v_sub_f32 v60, v60, v230
    v_sub_f32 v28, v28, v230
    v_sub_f32 v93, v93, v230
    v_sub_f32 v61, v61, v230
    v_sub_f32 v29, v29, v230
    v_sub_f32 v94, v94, v230
    v_sub_f32 v62, v62, v230
    v_sub_f32 v30, v30, v230
    v_sub_f32 v95, v95, v230
    v_sub_f32 v63, v63, v230
    v_sub_f32 v31, v31, v230
    v_mul_f32 v156, v156, v232
    v_mul_f32 v157, v157, v232
    v_mul_f32 v158, v158, v232
    v_mul_f32 v159, v159, v232
    v_accvgpr_read_b32 v233, a96
    v_mul_f32_e64 v233, v233, v232
    v_accvgpr_write_b32 a96, v233
    v_accvgpr_read_b32 v234, a97
    v_mul_f32_e64 v234, v234, v232
    v_accvgpr_write_b32 a97, v234
    v_accvgpr_read_b32 v235, a98
    v_mul_f32_e64 v235, v235, v232
    v_accvgpr_write_b32 a98, v235
    v_accvgpr_read_b32 v236, a99
    v_mul_f32_e64 v236, v236, v232
    v_accvgpr_write_b32 a99, v236
    v_accvgpr_read_b32 v233, a100
    v_mul_f32_e64 v233, v233, v232
    v_accvgpr_write_b32 a100, v233
    v_accvgpr_read_b32 v234, a101
    v_mul_f32_e64 v234, v234, v232
    v_accvgpr_write_b32 a101, v234
    v_accvgpr_read_b32 v235, a102
    v_mul_f32_e64 v235, v235, v232
    v_accvgpr_write_b32 a102, v235
    v_accvgpr_read_b32 v236, a103
    v_mul_f32_e64 v236, v236, v232
    v_accvgpr_write_b32 a103, v236
    v_accvgpr_read_b32 v233, a104
    v_mul_f32_e64 v233, v233, v232
    v_accvgpr_write_b32 a104, v233
    v_accvgpr_read_b32 v234, a105
    v_mul_f32_e64 v234, v234, v232
    v_accvgpr_write_b32 a105, v234
    v_accvgpr_read_b32 v235, a106
    v_mul_f32_e64 v235, v235, v232
    v_accvgpr_write_b32 a106, v235
    v_accvgpr_read_b32 v236, a107
    v_mul_f32_e64 v236, v236, v232
    v_accvgpr_write_b32 a107, v236
    v_accvgpr_read_b32 v233, a108
    v_mul_f32_e64 v233, v233, v232
    v_accvgpr_write_b32 a108, v233
    v_accvgpr_read_b32 v234, a109
    v_mul_f32_e64 v234, v234, v232
    v_accvgpr_write_b32 a109, v234
    v_accvgpr_read_b32 v235, a110
    v_mul_f32_e64 v235, v235, v232
    v_accvgpr_write_b32 a110, v235
    v_accvgpr_read_b32 v236, a111
    v_mul_f32_e64 v236, v236, v232
    v_accvgpr_write_b32 a111, v236
    v_accvgpr_read_b32 v233, a112
    v_mul_f32_e64 v233, v233, v232
    v_accvgpr_write_b32 a112, v233
    v_accvgpr_read_b32 v234, a113
    v_mul_f32_e64 v234, v234, v232
    v_accvgpr_write_b32 a113, v234
    v_accvgpr_read_b32 v235, a114
    v_mul_f32_e64 v235, v235, v232
    v_accvgpr_write_b32 a114, v235
    v_accvgpr_read_b32 v236, a115
    v_mul_f32_e64 v236, v236, v232
    v_accvgpr_write_b32 a115, v236
    v_accvgpr_read_b32 v233, a116
    v_mul_f32_e64 v233, v233, v232
    v_accvgpr_write_b32 a116, v233
    v_accvgpr_read_b32 v234, a117
    v_mul_f32_e64 v234, v234, v232
    v_accvgpr_write_b32 a117, v234
    v_accvgpr_read_b32 v235, a118
    v_mul_f32_e64 v235, v235, v232
    v_accvgpr_write_b32 a118, v235
    v_accvgpr_read_b32 v236, a119
    v_mul_f32_e64 v236, v236, v232
    v_accvgpr_write_b32 a119, v236
    v_accvgpr_read_b32 v233, a120
    v_mul_f32_e64 v233, v233, v232
    v_accvgpr_write_b32 a120, v233
    v_accvgpr_read_b32 v234, a121
    v_mul_f32_e64 v234, v234, v232
    v_accvgpr_write_b32 a121, v234
    v_accvgpr_read_b32 v235, a122
    v_mul_f32_e64 v235, v235, v232
    v_accvgpr_write_b32 a122, v235
    v_accvgpr_read_b32 v236, a123
    v_mul_f32_e64 v236, v236, v232
    v_accvgpr_write_b32 a123, v236
    v_accvgpr_read_b32 v233, a124
    v_mul_f32_e64 v233, v233, v232
    v_accvgpr_write_b32 a124, v233
    v_accvgpr_read_b32 v234, a125
    v_mul_f32_e64 v234, v234, v232
    v_accvgpr_write_b32 a125, v234
    v_accvgpr_read_b32 v235, a126
    v_mul_f32_e64 v235, v235, v232
    v_accvgpr_write_b32 a126, v235
    v_accvgpr_read_b32 v236, a127
    v_mul_f32_e64 v236, v236, v232
    v_accvgpr_write_b32 a127, v236
    v_exp_f32 v128, v24
    v_exp_f32 v129, v25
    v_exp_f32 v130, v26
    v_exp_f32 v131, v27
    v_exp_f32 v132, v28
    v_exp_f32 v133, v29
    v_exp_f32 v134, v30
    v_exp_f32_e64 v135, v31
    s_nop 0
    v_cvt_pk_bf16_f32 v108, v128, v129
    v_cvt_pk_bf16_f32 v109, v130, v131
    v_cvt_pk_bf16_f32 v110, v132, v133
    v_cvt_pk_bf16_f32 v111, v134, v135
    s_nop 1
    s_branch kf_rr17
kf_rare22:
    s_nop 15
    v_max3_f32 v230, v48, v49, v50
    v_max3_f32 v230, v230, v51, v52
    v_max3_f32 v230, v230, v53, v54
    v_max_f32 v230, v230, v55
    v_mov_b32 v231, v230
    s_nop 1
    v_permlane16_swap_b32 v230, v231
    s_nop 0
    v_max_f32 v230, v230, v231
    v_mov_b32 v231, v230
    s_nop 1
    v_permlane32_swap_b32 v230, v231
    s_nop 0
    v_max_f32 v230, v230, v231
    v_add_f32 v230, 0x41800000, v230
    v_max_f32 v230, 0, v230
    v_sub_f32 v232, 0, v230
    v_exp_f32 v232, v232
    v_sub_f32 v226, v226, v230
    v_sub_f32 v80, v80, v230
    v_sub_f32 v16, v16, v230
    v_sub_f32 v48, v48, v230
    v_sub_f32 v81, v81, v230
    v_sub_f32 v17, v17, v230
    v_sub_f32 v49, v49, v230
    v_sub_f32 v82, v82, v230
    v_sub_f32 v18, v18, v230
    v_sub_f32 v50, v50, v230
    v_sub_f32 v83, v83, v230
    v_sub_f32 v19, v19, v230
    v_sub_f32 v51, v51, v230
    v_sub_f32 v84, v84, v230
    v_sub_f32 v20, v20, v230
    v_sub_f32 v52, v52, v230
    v_sub_f32 v85, v85, v230
    v_sub_f32 v21, v21, v230
    v_sub_f32 v53, v53, v230
    v_sub_f32 v86, v86, v230
    v_sub_f32 v22, v22, v230
    v_sub_f32 v54, v54, v230
    v_sub_f32 v87, v87, v230
    v_sub_f32 v23, v23, v230
    v_sub_f32 v55, v55, v230
    v_mul_f32 v152, v152, v232
    v_mul_f32 v153, v153, v232
    v_mul_f32 v154, v154, v232
    v_mul_f32 v155, v155, v232
    v_accvgpr_read_b32 v233, a64
    v_mul_f32_e64 v233, v233, v232
    v_accvgpr_write_b32 a64, v233
    v_accvgpr_read_b32 v234, a65
    v_mul_f32_e64 v234, v234, v232
    v_accvgpr_write_b32 a65, v234
    v_accvgpr_read_b32 v235, a66
    v_mul_f32_e64 v235, v235, v232
    v_accvgpr_write_b32 a66, v235
    v_accvgpr_read_b32 v236, a67
    v_mul_f32_e64 v236, v236, v232
    v_accvgpr_write_b32 a67, v236
    v_accvgpr_read_b32 v233, a68
    v_mul_f32_e64 v233, v233, v232
    v_accvgpr_write_b32 a68, v233
    v_accvgpr_read_b32 v234, a69
    v_mul_f32_e64 v234, v234, v232
    v_accvgpr_write_b32 a69, v234
    v_accvgpr_read_b32 v235, a70
    v_mul_f32_e64 v235, v235, v232
    v_accvgpr_write_b32 a70, v235
    v_accvgpr_read_b32 v236, a71
    v_mul_f32_e64 v236, v236, v232
    v_accvgpr_write_b32 a71, v236
    v_accvgpr_read_b32 v233, a72
    v_mul_f32_e64 v233, v233, v232
    v_accvgpr_write_b32 a72, v233
    v_accvgpr_read_b32 v234, a73
    v_mul_f32_e64 v234, v234, v232
    v_accvgpr_write_b32 a73, v234
    v_accvgpr_read_b32 v235, a74
    v_mul_f32_e64 v235, v235, v232
    v_accvgpr_write_b32 a74, v235
    v_accvgpr_read_b32 v236, a75
    v_mul_f32_e64 v236, v236, v232
    v_accvgpr_write_b32 a75, v236
    v_accvgpr_read_b32 v233, a76
    v_mul_f32_e64 v233, v233, v232
    v_accvgpr_write_b32 a76, v233
    v_accvgpr_read_b32 v234, a77
    v_mul_f32_e64 v234, v234, v232
    v_accvgpr_write_b32 a77, v234
    v_accvgpr_read_b32 v235, a78
    v_mul_f32_e64 v235, v235, v232
    v_accvgpr_write_b32 a78, v235
    v_accvgpr_read_b32 v236, a79
    v_mul_f32_e64 v236, v236, v232
    v_accvgpr_write_b32 a79, v236
    v_accvgpr_read_b32 v233, a80
    v_mul_f32_e64 v233, v233, v232
    v_accvgpr_write_b32 a80, v233
    v_accvgpr_read_b32 v234, a81
    v_mul_f32_e64 v234, v234, v232
    v_accvgpr_write_b32 a81, v234
    v_accvgpr_read_b32 v235, a82
    v_mul_f32_e64 v235, v235, v232
    v_accvgpr_write_b32 a82, v235
    v_accvgpr_read_b32 v236, a83
    v_mul_f32_e64 v236, v236, v232
    v_accvgpr_write_b32 a83, v236
    v_accvgpr_read_b32 v233, a84
    v_mul_f32_e64 v233, v233, v232
    v_accvgpr_write_b32 a84, v233
    v_accvgpr_read_b32 v234, a85
    v_mul_f32_e64 v234, v234, v232
    v_accvgpr_write_b32 a85, v234
    v_accvgpr_read_b32 v235, a86
    v_mul_f32_e64 v235, v235, v232
    v_accvgpr_write_b32 a86, v235
    v_accvgpr_read_b32 v236, a87
    v_mul_f32_e64 v236, v236, v232
    v_accvgpr_write_b32 a87, v236
    v_accvgpr_read_b32 v233, a88
    v_mul_f32_e64 v233, v233, v232
    v_accvgpr_write_b32 a88, v233
    v_accvgpr_read_b32 v234, a89
    v_mul_f32_e64 v234, v234, v232
    v_accvgpr_write_b32 a89, v234
    v_accvgpr_read_b32 v235, a90
    v_mul_f32_e64 v235, v235, v232
    v_accvgpr_write_b32 a90, v235
    v_accvgpr_read_b32 v236, a91
    v_mul_f32_e64 v236, v236, v232
    v_accvgpr_write_b32 a91, v236
    v_accvgpr_read_b32 v233, a92
    v_mul_f32_e64 v233, v233, v232
    v_accvgpr_write_b32 a92, v233
    v_accvgpr_read_b32 v234, a93
    v_mul_f32_e64 v234, v234, v232
    v_accvgpr_write_b32 a93, v234
    v_accvgpr_read_b32 v235, a94
    v_mul_f32_e64 v235, v235, v232
    v_accvgpr_write_b32 a94, v235
    v_accvgpr_read_b32 v236, a95
    v_mul_f32_e64 v236, v236, v232
    v_accvgpr_write_b32 a95, v236
    v_exp_f32 v128, v48
    v_exp_f32 v129, v49
    v_exp_f32 v130, v50
    v_exp_f32 v131, v51
    v_exp_f32 v132, v52
    v_exp_f32 v133, v53
    v_exp_f32 v134, v54
    v_exp_f32_e64 v135, v55
    s_nop 0
    v_cvt_pk_bf16_f32 v120, v128, v129
    v_cvt_pk_bf16_f32 v121, v130, v131
    v_cvt_pk_bf16_f32 v122, v132, v133
    v_cvt_pk_bf16_f32 v123, v134, v135
    v_max3_f32 v230, v56, v57, v58
    v_max3_f32 v230, v230, v59, v60
    v_max3_f32 v230, v230, v61, v62
    v_max_f32 v230, v230, v63
    v_mov_b32 v231, v230
    s_nop 1
    v_permlane16_swap_b32 v230, v231
    s_nop 0
    v_max_f32 v230, v230, v231
    v_mov_b32 v231, v230
    s_nop 1
    v_permlane32_swap_b32 v230, v231
    s_nop 0
    v_max_f32_e64 v230, v230, v231
    v_add_f32 v230, 0x41800000, v230
    v_max_f32 v230, 0, v230
    v_sub_f32 v232, 0, v230
    v_exp_f32 v232, v232
    v_sub_f32 v227, v227, v230
    v_sub_f32 v88, v88, v230
    v_sub_f32 v24, v24, v230
    v_sub_f32 v56, v56, v230
    v_sub_f32 v89, v89, v230
    v_sub_f32 v25, v25, v230
    v_sub_f32 v57, v57, v230
    v_sub_f32 v90, v90, v230
    v_sub_f32 v26, v26, v230
    v_sub_f32 v58, v58, v230
    v_sub_f32 v91, v91, v230
    v_sub_f32 v27, v27, v230
    v_sub_f32 v59, v59, v230
    v_sub_f32 v92, v92, v230
    v_sub_f32 v28, v28, v230
    v_sub_f32 v60, v60, v230
    v_sub_f32 v93, v93, v230
    v_sub_f32 v29, v29, v230
    v_sub_f32 v61, v61, v230
    v_sub_f32 v94, v94, v230
    v_sub_f32 v30, v30, v230
    v_sub_f32 v62, v62, v230
    v_sub_f32 v95, v95, v230
    v_sub_f32 v31, v31, v230
    v_sub_f32 v63, v63, v230
    v_mul_f32 v156, v156, v232
    v_mul_f32 v157, v157, v232
    v_mul_f32 v158, v158, v232
    v_mul_f32 v159, v159, v232
    v_accvgpr_read_b32 v233, a96
    v_mul_f32_e64 v233, v233, v232
    v_accvgpr_write_b32 a96, v233
    v_accvgpr_read_b32 v234, a97
    v_mul_f32_e64 v234, v234, v232
    v_accvgpr_write_b32 a97, v234
    v_accvgpr_read_b32 v235, a98
    v_mul_f32_e64 v235, v235, v232
    v_accvgpr_write_b32 a98, v235
    v_accvgpr_read_b32 v236, a99
    v_mul_f32_e64 v236, v236, v232
    v_accvgpr_write_b32 a99, v236
    v_accvgpr_read_b32 v233, a100
    v_mul_f32_e64 v233, v233, v232
    v_accvgpr_write_b32 a100, v233
    v_accvgpr_read_b32 v234, a101
    v_mul_f32_e64 v234, v234, v232
    v_accvgpr_write_b32 a101, v234
    v_accvgpr_read_b32 v235, a102
    v_mul_f32_e64 v235, v235, v232
    v_accvgpr_write_b32 a102, v235
    v_accvgpr_read_b32 v236, a103
    v_mul_f32_e64 v236, v236, v232
    v_accvgpr_write_b32 a103, v236
    v_accvgpr_read_b32 v233, a104
    v_mul_f32_e64 v233, v233, v232
    v_accvgpr_write_b32 a104, v233
    v_accvgpr_read_b32 v234, a105
    v_mul_f32_e64 v234, v234, v232
    v_accvgpr_write_b32 a105, v234
    v_accvgpr_read_b32 v235, a106
    v_mul_f32_e64 v235, v235, v232
    v_accvgpr_write_b32 a106, v235
    v_accvgpr_read_b32 v236, a107
    v_mul_f32_e64 v236, v236, v232
    v_accvgpr_write_b32 a107, v236
    v_accvgpr_read_b32 v233, a108
    v_mul_f32_e64 v233, v233, v232
    v_accvgpr_write_b32 a108, v233
    v_accvgpr_read_b32 v234, a109
    v_mul_f32_e64 v234, v234, v232
    v_accvgpr_write_b32 a109, v234
    v_accvgpr_read_b32 v235, a110
    v_mul_f32_e64 v235, v235, v232
    v_accvgpr_write_b32 a110, v235
    v_accvgpr_read_b32 v236, a111
    v_mul_f32_e64 v236, v236, v232
    v_accvgpr_write_b32 a111, v236
    v_accvgpr_read_b32 v233, a112
    v_mul_f32_e64 v233, v233, v232
    v_accvgpr_write_b32 a112, v233
    v_accvgpr_read_b32 v234, a113
    v_mul_f32_e64 v234, v234, v232
    v_accvgpr_write_b32 a113, v234
    v_accvgpr_read_b32 v235, a114
    v_mul_f32_e64 v235, v235, v232
    v_accvgpr_write_b32 a114, v235
    v_accvgpr_read_b32 v236, a115
    v_mul_f32_e64 v236, v236, v232
    v_accvgpr_write_b32 a115, v236
    v_accvgpr_read_b32 v233, a116
    v_mul_f32_e64 v233, v233, v232
    v_accvgpr_write_b32 a116, v233
    v_accvgpr_read_b32 v234, a117
    v_mul_f32_e64 v234, v234, v232
    v_accvgpr_write_b32 a117, v234
    v_accvgpr_read_b32 v235, a118
    v_mul_f32_e64 v235, v235, v232
    v_accvgpr_write_b32 a118, v235
    v_accvgpr_read_b32 v236, a119
    v_mul_f32_e64 v236, v236, v232
    v_accvgpr_write_b32 a119, v236
    v_accvgpr_read_b32 v233, a120
    v_mul_f32_e64 v233, v233, v232
    v_accvgpr_write_b32 a120, v233
    v_accvgpr_read_b32 v234, a121
    v_mul_f32_e64 v234, v234, v232
    v_accvgpr_write_b32 a121, v234
    v_accvgpr_read_b32 v235, a122
    v_mul_f32_e64 v235, v235, v232
    v_accvgpr_write_b32 a122, v235
    v_accvgpr_read_b32 v236, a123
    v_mul_f32_e64 v236, v236, v232
    v_accvgpr_write_b32 a123, v236
    v_accvgpr_read_b32 v233, a124
    v_mul_f32_e64 v233, v233, v232
    v_accvgpr_write_b32 a124, v233
    v_accvgpr_read_b32 v234, a125
    v_mul_f32_e64 v234, v234, v232
    v_accvgpr_write_b32 a125, v234
    v_accvgpr_read_b32 v235, a126
    v_mul_f32_e64 v235, v235, v232
    v_accvgpr_write_b32 a126, v235
    v_accvgpr_read_b32 v236, a127
    v_mul_f32_e64 v236, v236, v232
    v_accvgpr_write_b32 a127, v236
    v_exp_f32 v128, v56
    v_exp_f32 v129, v57
    v_exp_f32 v130, v58
    v_exp_f32 v131, v59
    v_exp_f32 v132, v60
    v_exp_f32 v133, v61
    v_exp_f32 v134, v62
    v_exp_f32_e64 v135, v63
    s_nop 0
    v_cvt_pk_bf16_f32 v124, v128, v129
    v_cvt_pk_bf16_f32 v125, v130, v131
    v_cvt_pk_bf16_f32 v126, v132, v133
    v_cvt_pk_bf16_f32 v127, v134, v135
    s_nop 1
    s_branch kf_rr21
kf_rare26:
    s_nop 15
    v_max3_f32 v230, v16, v17, v18
    v_max3_f32 v230, v230, v19, v20
    v_max3_f32 v230, v230, v21, v22
    v_max_f32 v230, v230, v23
    v_mov_b32 v231, v230
    s_nop 1
    v_permlane16_swap_b32 v230, v231
    s_nop 0
    v_max_f32 v230, v230, v231
    v_mov_b32 v231, v230
    s_nop 1
    v_permlane32_swap_b32 v230, v231
    s_nop 0
    v_max_f32 v230, v230, v231
    v_add_f32 v230, 0x41800000, v230
    v_max_f32 v230, 0, v230
    v_sub_f32 v232, 0, v230
    v_exp_f32 v232, v232
    v_sub_f32 v226, v226, v230
    v_sub_f32 v80, v80, v230
    v_sub_f32 v48, v48, v230
    v_sub_f32 v16, v16, v230
    v_sub_f32 v81, v81, v230
    v_sub_f32 v49, v49, v230
    v_sub_f32 v17, v17, v230
    v_sub_f32 v82, v82, v230
    v_sub_f32 v50, v50, v230
    v_sub_f32 v18, v18, v230
    v_sub_f32 v83, v83, v230
    v_sub_f32 v51, v51, v230
    v_sub_f32 v19, v19, v230
    v_sub_f32 v84, v84, v230
    v_sub_f32 v52, v52, v230
    v_sub_f32 v20, v20, v230
    v_sub_f32 v85, v85, v230
    v_sub_f32 v53, v53, v230
    v_sub_f32 v21, v21, v230
    v_sub_f32 v86, v86, v230
    v_sub_f32 v54, v54, v230
    v_sub_f32 v22, v22, v230
    v_sub_f32 v87, v87, v230
    v_sub_f32 v55, v55, v230
    v_sub_f32 v23, v23, v230
    v_mul_f32 v152, v152, v232
    v_mul_f32 v153, v153, v232
    v_mul_f32 v154, v154, v232
    v_mul_f32 v155, v155, v232
    v_accvgpr_read_b32 v233, a64
    v_mul_f32_e64 v233, v233, v232
    v_accvgpr_write_b32 a64, v233
    v_accvgpr_read_b32 v234, a65
    v_mul_f32_e64 v234, v234, v232
    v_accvgpr_write_b32 a65, v234
    v_accvgpr_read_b32 v235, a66
    v_mul_f32_e64 v235, v235, v232
    v_accvgpr_write_b32 a66, v235
    v_accvgpr_read_b32 v236, a67
    v_mul_f32_e64 v236, v236, v232
    v_accvgpr_write_b32 a67, v236
    v_accvgpr_read_b32 v233, a68
    v_mul_f32_e64 v233, v233, v232
    v_accvgpr_write_b32 a68, v233
    v_accvgpr_read_b32 v234, a69
    v_mul_f32_e64 v234, v234, v232
    v_accvgpr_write_b32 a69, v234
    v_accvgpr_read_b32 v235, a70
    v_mul_f32_e64 v235, v235, v232
    v_accvgpr_write_b32 a70, v235
    v_accvgpr_read_b32 v236, a71
    v_mul_f32_e64 v236, v236, v232
    v_accvgpr_write_b32 a71, v236
    v_accvgpr_read_b32 v233, a72
    v_mul_f32_e64 v233, v233, v232
    v_accvgpr_write_b32 a72, v233
    v_accvgpr_read_b32 v234, a73
    v_mul_f32_e64 v234, v234, v232
    v_accvgpr_write_b32 a73, v234
    v_accvgpr_read_b32 v235, a74
    v_mul_f32_e64 v235, v235, v232
    v_accvgpr_write_b32 a74, v235
    v_accvgpr_read_b32 v236, a75
    v_mul_f32_e64 v236, v236, v232
    v_accvgpr_write_b32 a75, v236
    v_accvgpr_read_b32 v233, a76
    v_mul_f32_e64 v233, v233, v232
    v_accvgpr_write_b32 a76, v233
    v_accvgpr_read_b32 v234, a77
    v_mul_f32_e64 v234, v234, v232
    v_accvgpr_write_b32 a77, v234
    v_accvgpr_read_b32 v235, a78
    v_mul_f32_e64 v235, v235, v232
    v_accvgpr_write_b32 a78, v235
    v_accvgpr_read_b32 v236, a79
    v_mul_f32_e64 v236, v236, v232
    v_accvgpr_write_b32 a79, v236
    v_accvgpr_read_b32 v233, a80
    v_mul_f32_e64 v233, v233, v232
    v_accvgpr_write_b32 a80, v233
    v_accvgpr_read_b32 v234, a81
    v_mul_f32_e64 v234, v234, v232
    v_accvgpr_write_b32 a81, v234
    v_accvgpr_read_b32 v235, a82
    v_mul_f32_e64 v235, v235, v232
    v_accvgpr_write_b32 a82, v235
    v_accvgpr_read_b32 v236, a83
    v_mul_f32_e64 v236, v236, v232
    v_accvgpr_write_b32 a83, v236
    v_accvgpr_read_b32 v233, a84
    v_mul_f32_e64 v233, v233, v232
    v_accvgpr_write_b32 a84, v233
    v_accvgpr_read_b32 v234, a85
    v_mul_f32_e64 v234, v234, v232
    v_accvgpr_write_b32 a85, v234
    v_accvgpr_read_b32 v235, a86
    v_mul_f32_e64 v235, v235, v232
    v_accvgpr_write_b32 a86, v235
    v_accvgpr_read_b32 v236, a87
    v_mul_f32_e64 v236, v236, v232
    v_accvgpr_write_b32 a87, v236
    v_accvgpr_read_b32 v233, a88
    v_mul_f32_e64 v233, v233, v232
    v_accvgpr_write_b32 a88, v233
    v_accvgpr_read_b32 v234, a89
    v_mul_f32_e64 v234, v234, v232
    v_accvgpr_write_b32 a89, v234
    v_accvgpr_read_b32 v235, a90
    v_mul_f32_e64 v235, v235, v232
    v_accvgpr_write_b32 a90, v235
    v_accvgpr_read_b32 v236, a91
    v_mul_f32_e64 v236, v236, v232
    v_accvgpr_write_b32 a91, v236
    v_accvgpr_read_b32 v233, a92
    v_mul_f32_e64 v233, v233, v232
    v_accvgpr_write_b32 a92, v233
    v_accvgpr_read_b32 v234, a93
    v_mul_f32_e64 v234, v234, v232
    v_accvgpr_write_b32 a93, v234
    v_accvgpr_read_b32 v235, a94
    v_mul_f32_e64 v235, v235, v232
    v_accvgpr_write_b32 a94, v235
    v_accvgpr_read_b32 v236, a95
    v_mul_f32_e64 v236, v236, v232
    v_accvgpr_write_b32 a95, v236
    v_exp_f32 v128, v16
    v_exp_f32 v129, v17
    v_exp_f32 v130, v18
    v_exp_f32 v131, v19
    v_exp_f32 v132, v20
    v_exp_f32 v133, v21
    v_exp_f32 v134, v22
    v_exp_f32_e64 v135, v23
    s_nop 0
    v_cvt_pk_bf16_f32 v104, v128, v129
    v_cvt_pk_bf16_f32 v105, v130, v131
    v_cvt_pk_bf16_f32 v106, v132, v133
    v_cvt_pk_bf16_f32 v107, v134, v135
    v_max3_f32 v230, v24, v25, v26
    v_max3_f32 v230, v230, v27, v28
    v_max3_f32 v230, v230, v29, v30
    v_max_f32 v230, v230, v31
    v_mov_b32 v231, v230
    s_nop 1
    v_permlane16_swap_b32 v230, v231
    s_nop 0
    v_max_f32 v230, v230, v231
    v_mov_b32 v231, v230
    s_nop 1
    v_permlane32_swap_b32 v230, v231
    s_nop 0
    v_max_f32_e64 v230, v230, v231
    v_add_f32 v230, 0x41800000, v230
    v_max_f32 v230, 0, v230
    v_sub_f32 v232, 0, v230
    v_exp_f32 v232, v232
    v_sub_f32 v227, v227, v230
    v_sub_f32 v88, v88, v230
    v_sub_f32 v56, v56, v230
    v_sub_f32 v24, v24, v230
    v_sub_f32 v89, v89, v230
    v_sub_f32 v57, v57, v230
    v_sub_f32 v25, v25, v230
    v_sub_f32 v90, v90, v230
    v_sub_f32 v58, v58, v230
    v_sub_f32 v26, v26, v230
    v_sub_f32 v91, v91, v230
    v_sub_f32 v59, v59, v230
    v_sub_f32 v27, v27, v230
    v_sub_f32 v92, v92, v230
    v_sub_f32 v60, v60, v230
    v_sub_f32 v28, v28, v230
    v_sub_f32 v93, v93, v230
    v_sub_f32 v61, v61, v230
    v_sub_f32 v29, v29, v230
    v_sub_f32 v94, v94, v230
    v_sub_f32 v62, v62, v230
    v_sub_f32 v30, v30, v230
    v_sub_f32 v95, v95, v230
    v_sub_f32 v63, v63, v230
    v_sub_f32 v31, v31, v230
    v_mul_f32 v156, v156, v232
    v_mul_f32 v157, v157, v232
    v_mul_f32 v158, v158, v232
    v_mul_f32 v159, v159, v232
    v_accvgpr_read_b32 v233, a96
    v_mul_f32_e64 v233, v233, v232
    v_accvgpr_write_b32 a96, v233
    v_accvgpr_read_b32 v234, a97
    v_mul_f32_e64 v234, v234, v232
    v_accvgpr_write_b32 a97, v234
    v_accvgpr_read_b32 v235, a98
    v_mul_f32_e64 v235, v235, v232
    v_accvgpr_write_b32 a98, v235
    v_accvgpr_read_b32 v236, a99
    v_mul_f32_e64 v236, v236, v232
    v_accvgpr_write_b32 a99, v236
    v_accvgpr_read_b32 v233, a100
    v_mul_f32_e64 v233, v233, v232
    v_accvgpr_write_b32 a100, v233
    v_accvgpr_read_b32 v234, a101
    v_mul_f32_e64 v234, v234, v232
    v_accvgpr_write_b32 a101, v234
    v_accvgpr_read_b32 v235, a102
    v_mul_f32_e64 v235, v235, v232
    v_accvgpr_write_b32 a102, v235
    v_accvgpr_read_b32 v236, a103
    v_mul_f32_e64 v236, v236, v232
    v_accvgpr_write_b32 a103, v236
    v_accvgpr_read_b32 v233, a104
    v_mul_f32_e64 v233, v233, v232
    v_accvgpr_write_b32 a104, v233
    v_accvgpr_read_b32 v234, a105
    v_mul_f32_e64 v234, v234, v232
    v_accvgpr_write_b32 a105, v234
    v_accvgpr_read_b32 v235, a106
    v_mul_f32_e64 v235, v235, v232
    v_accvgpr_write_b32 a106, v235
    v_accvgpr_read_b32 v236, a107
    v_mul_f32_e64 v236, v236, v232
    v_accvgpr_write_b32 a107, v236
    v_accvgpr_read_b32 v233, a108
    v_mul_f32_e64 v233, v233, v232
    v_accvgpr_write_b32 a108, v233
    v_accvgpr_read_b32 v234, a109
    v_mul_f32_e64 v234, v234, v232
    v_accvgpr_write_b32 a109, v234
    v_accvgpr_read_b32 v235, a110
    v_mul_f32_e64 v235, v235, v232
    v_accvgpr_write_b32 a110, v235
    v_accvgpr_read_b32 v236, a111
    v_mul_f32_e64 v236, v236, v232
    v_accvgpr_write_b32 a111, v236
    v_accvgpr_read_b32 v233, a112
    v_mul_f32_e64 v233, v233, v232
    v_accvgpr_write_b32 a112, v233
    v_accvgpr_read_b32 v234, a113
    v_mul_f32_e64 v234, v234, v232
    v_accvgpr_write_b32 a113, v234
    v_accvgpr_read_b32 v235, a114
    v_mul_f32_e64 v235, v235, v232
    v_accvgpr_write_b32 a114, v235
    v_accvgpr_read_b32 v236, a115
    v_mul_f32_e64 v236, v236, v232
    v_accvgpr_write_b32 a115, v236
    v_accvgpr_read_b32 v233, a116
    v_mul_f32_e64 v233, v233, v232
    v_accvgpr_write_b32 a116, v233
    v_accvgpr_read_b32 v234, a117
    v_mul_f32_e64 v234, v234, v232
    v_accvgpr_write_b32 a117, v234
    v_accvgpr_read_b32 v235, a118
    v_mul_f32_e64 v235, v235, v232
    v_accvgpr_write_b32 a118, v235
    v_accvgpr_read_b32 v236, a119
    v_mul_f32_e64 v236, v236, v232
    v_accvgpr_write_b32 a119, v236
    v_accvgpr_read_b32 v233, a120
    v_mul_f32_e64 v233, v233, v232
    v_accvgpr_write_b32 a120, v233
    v_accvgpr_read_b32 v234, a121
    v_mul_f32_e64 v234, v234, v232
    v_accvgpr_write_b32 a121, v234
    v_accvgpr_read_b32 v235, a122
    v_mul_f32_e64 v235, v235, v232
    v_accvgpr_write_b32 a122, v235
    v_accvgpr_read_b32 v236, a123
    v_mul_f32_e64 v236, v236, v232
    v_accvgpr_write_b32 a123, v236
    v_accvgpr_read_b32 v233, a124
    v_mul_f32_e64 v233, v233, v232
    v_accvgpr_write_b32 a124, v233
    v_accvgpr_read_b32 v234, a125
    v_mul_f32_e64 v234, v234, v232
    v_accvgpr_write_b32 a125, v234
    v_accvgpr_read_b32 v235, a126
    v_mul_f32_e64 v235, v235, v232
    v_accvgpr_write_b32 a126, v235
    v_accvgpr_read_b32 v236, a127
    v_mul_f32_e64 v236, v236, v232
    v_accvgpr_write_b32 a127, v236
    v_exp_f32 v128, v24
    v_exp_f32 v129, v25
    v_exp_f32 v130, v26
    v_exp_f32 v131, v27
    v_exp_f32 v132, v28
    v_exp_f32 v133, v29
    v_exp_f32 v134, v30
    v_exp_f32_e64 v135, v31
    s_nop 0
    v_cvt_pk_bf16_f32 v108, v128, v129
    v_cvt_pk_bf16_f32 v109, v130, v131
    v_cvt_pk_bf16_f32 v110, v132, v133
    v_cvt_pk_bf16_f32 v111, v134, v135
    s_nop 1
    s_branch kf_rr25
kf_rare30:
    s_nop 15
    v_max3_f32 v230, v48, v49, v50
    v_max3_f32 v230, v230, v51, v52
    v_max3_f32 v230, v230, v53, v54
    v_max_f32 v230, v230, v55
    v_mov_b32 v231, v230
    s_nop 1
    v_permlane16_swap_b32 v230, v231
    s_nop 0
    v_max_f32 v230, v230, v231
    v_mov_b32 v231, v230
    s_nop 1
    v_permlane32_swap_b32 v230, v231
    s_nop 0
    v_max_f32 v230, v230, v231
    v_add_f32 v230, 0x41800000, v230
    v_max_f32 v230, 0, v230
    v_sub_f32 v232, 0, v230
    v_exp_f32 v232, v232
    v_sub_f32 v226, v226, v230
    v_sub_f32 v80, v80, v230
    v_sub_f32 v16, v16, v230
    v_sub_f32 v48, v48, v230
    v_sub_f32 v81, v81, v230
    v_sub_f32 v17, v17, v230
    v_sub_f32 v49, v49, v230
    v_sub_f32 v82, v82, v230
    v_sub_f32 v18, v18, v230
    v_sub_f32 v50, v50, v230
    v_sub_f32 v83, v83, v230
    v_sub_f32 v19, v19, v230
    v_sub_f32 v51, v51, v230
    v_sub_f32 v84, v84, v230
    v_sub_f32 v20, v20, v230
    v_sub_f32 v52, v52, v230
    v_sub_f32 v85, v85, v230
    v_sub_f32 v21, v21, v230
    v_sub_f32 v53, v53, v230
    v_sub_f32 v86, v86, v230
    v_sub_f32 v22, v22, v230
    v_sub_f32 v54, v54, v230
    v_sub_f32 v87, v87, v230
    v_sub_f32 v23, v23, v230
    v_sub_f32 v55, v55, v230
    v_mul_f32 v152, v152, v232
    v_mul_f32 v153, v153, v232
    v_mul_f32 v154, v154, v232
    v_mul_f32 v155, v155, v232
    v_accvgpr_read_b32 v233, a64
    v_mul_f32_e64 v233, v233, v232
    v_accvgpr_write_b32 a64, v233
    v_accvgpr_read_b32 v234, a65
    v_mul_f32_e64 v234, v234, v232
    v_accvgpr_write_b32 a65, v234
    v_accvgpr_read_b32 v235, a66
    v_mul_f32_e64 v235, v235, v232
    v_accvgpr_write_b32 a66, v235
    v_accvgpr_read_b32 v236, a67
    v_mul_f32_e64 v236, v236, v232
    v_accvgpr_write_b32 a67, v236
    v_accvgpr_read_b32 v233, a68
    v_mul_f32_e64 v233, v233, v232
    v_accvgpr_write_b32 a68, v233
    v_accvgpr_read_b32 v234, a69
    v_mul_f32_e64 v234, v234, v232
    v_accvgpr_write_b32 a69, v234
    v_accvgpr_read_b32 v235, a70
    v_mul_f32_e64 v235, v235, v232
    v_accvgpr_write_b32 a70, v235
    v_accvgpr_read_b32 v236, a71
    v_mul_f32_e64 v236, v236, v232
    v_accvgpr_write_b32 a71, v236
    v_accvgpr_read_b32 v233, a72
    v_mul_f32_e64 v233, v233, v232
    v_accvgpr_write_b32 a72, v233
    v_accvgpr_read_b32 v234, a73
    v_mul_f32_e64 v234, v234, v232
    v_accvgpr_write_b32 a73, v234
    v_accvgpr_read_b32 v235, a74
    v_mul_f32_e64 v235, v235, v232
    v_accvgpr_write_b32 a74, v235
    v_accvgpr_read_b32 v236, a75
    v_mul_f32_e64 v236, v236, v232
    v_accvgpr_write_b32 a75, v236
    v_accvgpr_read_b32 v233, a76
    v_mul_f32_e64 v233, v233, v232
    v_accvgpr_write_b32 a76, v233
    v_accvgpr_read_b32 v234, a77
    v_mul_f32_e64 v234, v234, v232
    v_accvgpr_write_b32 a77, v234
    v_accvgpr_read_b32 v235, a78
    v_mul_f32_e64 v235, v235, v232
    v_accvgpr_write_b32 a78, v235
    v_accvgpr_read_b32 v236, a79
    v_mul_f32_e64 v236, v236, v232
    v_accvgpr_write_b32 a79, v236
    v_accvgpr_read_b32 v233, a80
    v_mul_f32_e64 v233, v233, v232
    v_accvgpr_write_b32 a80, v233
    v_accvgpr_read_b32 v234, a81
    v_mul_f32_e64 v234, v234, v232
    v_accvgpr_write_b32 a81, v234
    v_accvgpr_read_b32 v235, a82
    v_mul_f32_e64 v235, v235, v232
    v_accvgpr_write_b32 a82, v235
    v_accvgpr_read_b32 v236, a83
    v_mul_f32_e64 v236, v236, v232
    v_accvgpr_write_b32 a83, v236
    v_accvgpr_read_b32 v233, a84
    v_mul_f32_e64 v233, v233, v232
    v_accvgpr_write_b32 a84, v233
    v_accvgpr_read_b32 v234, a85
    v_mul_f32_e64 v234, v234, v232
    v_accvgpr_write_b32 a85, v234
    v_accvgpr_read_b32 v235, a86
    v_mul_f32_e64 v235, v235, v232
    v_accvgpr_write_b32 a86, v235
    v_accvgpr_read_b32 v236, a87
    v_mul_f32_e64 v236, v236, v232
    v_accvgpr_write_b32 a87, v236
    v_accvgpr_read_b32 v233, a88
    v_mul_f32_e64 v233, v233, v232
    v_accvgpr_write_b32 a88, v233
    v_accvgpr_read_b32 v234, a89
    v_mul_f32_e64 v234, v234, v232
    v_accvgpr_write_b32 a89, v234
    v_accvgpr_read_b32 v235, a90
    v_mul_f32_e64 v235, v235, v232
    v_accvgpr_write_b32 a90, v235
    v_accvgpr_read_b32 v236, a91
    v_mul_f32_e64 v236, v236, v232
    v_accvgpr_write_b32 a91, v236
    v_accvgpr_read_b32 v233, a92
    v_mul_f32_e64 v233, v233, v232
    v_accvgpr_write_b32 a92, v233
    v_accvgpr_read_b32 v234, a93
    v_mul_f32_e64 v234, v234, v232
    v_accvgpr_write_b32 a93, v234
    v_accvgpr_read_b32 v235, a94
    v_mul_f32_e64 v235, v235, v232
    v_accvgpr_write_b32 a94, v235
    v_accvgpr_read_b32 v236, a95
    v_mul_f32_e64 v236, v236, v232
    v_accvgpr_write_b32 a95, v236
    v_exp_f32 v128, v48
    v_exp_f32 v129, v49
    v_exp_f32 v130, v50
    v_exp_f32 v131, v51
    v_exp_f32 v132, v52
    v_exp_f32 v133, v53
    v_exp_f32 v134, v54
    v_exp_f32_e64 v135, v55
    s_nop 0
    v_cvt_pk_bf16_f32 v120, v128, v129
    v_cvt_pk_bf16_f32 v121, v130, v131
    v_cvt_pk_bf16_f32 v122, v132, v133
    v_cvt_pk_bf16_f32 v123, v134, v135
    v_max3_f32 v230, v56, v57, v58
    v_max3_f32 v230, v230, v59, v60
    v_max3_f32 v230, v230, v61, v62
    v_max_f32 v230, v230, v63
    v_mov_b32 v231, v230
    s_nop 1
    v_permlane16_swap_b32 v230, v231
    s_nop 0
    v_max_f32 v230, v230, v231
    v_mov_b32 v231, v230
    s_nop 1
    v_permlane32_swap_b32 v230, v231
    s_nop 0
    v_max_f32_e64 v230, v230, v231
    v_add_f32 v230, 0x41800000, v230
    v_max_f32 v230, 0, v230
    v_sub_f32 v232, 0, v230
    v_exp_f32 v232, v232
    v_sub_f32 v227, v227, v230
    v_sub_f32 v88, v88, v230
    v_sub_f32 v24, v24, v230
    v_sub_f32 v56, v56, v230
    v_sub_f32 v89, v89, v230
    v_sub_f32 v25, v25, v230
    v_sub_f32 v57, v57, v230
    v_sub_f32 v90, v90, v230
    v_sub_f32 v26, v26, v230
    v_sub_f32 v58, v58, v230
    v_sub_f32 v91, v91, v230
    v_sub_f32 v27, v27, v230
    v_sub_f32 v59, v59, v230
    v_sub_f32 v92, v92, v230
    v_sub_f32 v28, v28, v230
    v_sub_f32 v60, v60, v230
    v_sub_f32 v93, v93, v230
    v_sub_f32 v29, v29, v230
    v_sub_f32 v61, v61, v230
    v_sub_f32 v94, v94, v230
    v_sub_f32 v30, v30, v230
    v_sub_f32 v62, v62, v230
    v_sub_f32 v95, v95, v230
    v_sub_f32 v31, v31, v230
    v_sub_f32 v63, v63, v230
    v_mul_f32 v156, v156, v232
    v_mul_f32 v157, v157, v232
    v_mul_f32 v158, v158, v232
    v_mul_f32 v159, v159, v232
    v_accvgpr_read_b32 v233, a96
    v_mul_f32_e64 v233, v233, v232
    v_accvgpr_write_b32 a96, v233
    v_accvgpr_read_b32 v234, a97
    v_mul_f32_e64 v234, v234, v232
    v_accvgpr_write_b32 a97, v234
    v_accvgpr_read_b32 v235, a98
    v_mul_f32_e64 v235, v235, v232
    v_accvgpr_write_b32 a98, v235
    v_accvgpr_read_b32 v236, a99
    v_mul_f32_e64 v236, v236, v232
    v_accvgpr_write_b32 a99, v236
    v_accvgpr_read_b32 v233, a100
    v_mul_f32_e64 v233, v233, v232
    v_accvgpr_write_b32 a100, v233
    v_accvgpr_read_b32 v234, a101
    v_mul_f32_e64 v234, v234, v232
    v_accvgpr_write_b32 a101, v234
    v_accvgpr_read_b32 v235, a102
    v_mul_f32_e64 v235, v235, v232
    v_accvgpr_write_b32 a102, v235
    v_accvgpr_read_b32 v236, a103
    v_mul_f32_e64 v236, v236, v232
    v_accvgpr_write_b32 a103, v236
    v_accvgpr_read_b32 v233, a104
    v_mul_f32_e64 v233, v233, v232
    v_accvgpr_write_b32 a104, v233
    v_accvgpr_read_b32 v234, a105
    v_mul_f32_e64 v234, v234, v232
    v_accvgpr_write_b32 a105, v234
    v_accvgpr_read_b32 v235, a106
    v_mul_f32_e64 v235, v235, v232
    v_accvgpr_write_b32 a106, v235
    v_accvgpr_read_b32 v236, a107
    v_mul_f32_e64 v236, v236, v232
    v_accvgpr_write_b32 a107, v236
    v_accvgpr_read_b32 v233, a108
    v_mul_f32_e64 v233, v233, v232
    v_accvgpr_write_b32 a108, v233
    v_accvgpr_read_b32 v234, a109
    v_mul_f32_e64 v234, v234, v232
    v_accvgpr_write_b32 a109, v234
    v_accvgpr_read_b32 v235, a110
    v_mul_f32_e64 v235, v235, v232
    v_accvgpr_write_b32 a110, v235
    v_accvgpr_read_b32 v236, a111
    v_mul_f32_e64 v236, v236, v232
    v_accvgpr_write_b32 a111, v236
    v_accvgpr_read_b32 v233, a112
    v_mul_f32_e64 v233, v233, v232
    v_accvgpr_write_b32 a112, v233
    v_accvgpr_read_b32 v234, a113
    v_mul_f32_e64 v234, v234, v232
    v_accvgpr_write_b32 a113, v234
    v_accvgpr_read_b32 v235, a114
    v_mul_f32_e64 v235, v235, v232
    v_accvgpr_write_b32 a114, v235
    v_accvgpr_read_b32 v236, a115
    v_mul_f32_e64 v236, v236, v232
    v_accvgpr_write_b32 a115, v236
    v_accvgpr_read_b32 v233, a116
    v_mul_f32_e64 v233, v233, v232
    v_accvgpr_write_b32 a116, v233
    v_accvgpr_read_b32 v234, a117
    v_mul_f32_e64 v234, v234, v232
    v_accvgpr_write_b32 a117, v234
    v_accvgpr_read_b32 v235, a118
    v_mul_f32_e64 v235, v235, v232
    v_accvgpr_write_b32 a118, v235
    v_accvgpr_read_b32 v236, a119
    v_mul_f32_e64 v236, v236, v232
    v_accvgpr_write_b32 a119, v236
    v_accvgpr_read_b32 v233, a120
    v_mul_f32_e64 v233, v233, v232
    v_accvgpr_write_b32 a120, v233
    v_accvgpr_read_b32 v234, a121
    v_mul_f32_e64 v234, v234, v232
    v_accvgpr_write_b32 a121, v234
    v_accvgpr_read_b32 v235, a122
    v_mul_f32_e64 v235, v235, v232
    v_accvgpr_write_b32 a122, v235
    v_accvgpr_read_b32 v236, a123
    v_mul_f32_e64 v236, v236, v232
    v_accvgpr_write_b32 a123, v236
    v_accvgpr_read_b32 v233, a124
    v_mul_f32_e64 v233, v233, v232
    v_accvgpr_write_b32 a124, v233
    v_accvgpr_read_b32 v234, a125
    v_mul_f32_e64 v234, v234, v232
    v_accvgpr_write_b32 a125, v234
    v_accvgpr_read_b32 v235, a126
    v_mul_f32_e64 v235, v235, v232
    v_accvgpr_write_b32 a126, v235
    v_accvgpr_read_b32 v236, a127
    v_mul_f32_e64 v236, v236, v232
    v_accvgpr_write_b32 a127, v236
    v_exp_f32 v128, v56
    v_exp_f32 v129, v57
    v_exp_f32 v130, v58
    v_exp_f32 v131, v59
    v_exp_f32 v132, v60
    v_exp_f32 v133, v61
    v_exp_f32 v134, v62
    v_exp_f32_e64 v135, v63
    s_nop 0
    v_cvt_pk_bf16_f32 v124, v128, v129
    v_cvt_pk_bf16_f32 v125, v130, v131
    v_cvt_pk_bf16_f32 v126, v132, v133
    v_cvt_pk_bf16_f32 v127, v134, v135
    s_nop 1
    s_branch kf_rr29
kf_spin31:
    s_mov_b32 s25, 0x400000
kf_spin31_l:
    s_sleep 2
    buffer_load_dword v254, off, s[88:91], s97 sc1
    s_waitcnt vmcnt(0)
    v_readfirstlane_b32 s24, v254
    s_sub_u32 s25, s25, 1
    s_cbranch_scc1 kf_spinr32
    s_cmp_ge_u32 s24, 1
    s_cbranch_scc0 kf_spin31_l
    s_branch kf_spinr32
kf_spin33:
    s_mov_b32 s25, 0x400000
kf_spin33_l:
    s_sleep 2
    buffer_load_dword v254, off, s[88:91], s39 sc1
    s_waitcnt vmcnt(0)
    v_readfirstlane_b32 s24, v254
    s_sub_u32 s25, s25, 1
    s_cbranch_scc1 kf_spinr34
    s_cmp_ge_u32 s24, 32
    s_cbranch_scc0 kf_spin33_l
    s_branch kf_spinr34
kf_spin35:
    s_mov_b32 s25, 0x400000
kf_spin35_l:
    s_sleep 2
    buffer_load_dword v254, off, s[88:91], s97 sc1
    s_waitcnt vmcnt(0)
    v_readfirstlane_b32 s24, v254
    s_sub_u32 s25, s25, 1
    s_cbranch_scc1 kf_spinr36
    s_cmp_ge_u32 s24, 1
    s_cbranch_scc0 kf_spin35_l
    s_branch kf_spinr36
kf_spin37:
    s_mov_b32 s25, 0x400000
kf_spin37_l:
    s_sleep 2
    buffer_load_dword v254, off, s[88:91], s39 sc1
    s_waitcnt vmcnt(0)
    v_readfirstlane_b32 s24, v254
    s_sub_u32 s25, s25, 1
    s_cbranch_scc1 kf_spinr38
    s_cmp_ge_u32 s24, 32
    s_cbranch_scc0 kf_spin37_l
    s_branch kf_spinr38
kf_spin39:
    s_mov_b32 s25, 0x400000
kf_spin39_l:
    s_sleep 2
    buffer_load_dword v254, off, s[88:91], s35 sc1
    s_waitcnt vmcnt(0)
    v_readfirstlane_b32 s24, v254
    s_sub_u32 s25, s25, 1
    s_cbranch_scc1 kf_spinr40
    s_cmp_ge_u32 s24, 8
    s_cbranch_scc0 kf_spin39_l
    s_branch kf_spinr40

code_end:
.section .rodata,"a"
.p2align 6
.amdhsa_kernel sequential_preLN__compressed_kv_cla__moe_arch_mod__prompt_kernel
  .amdhsa_next_free_vgpr 512
  .amdhsa_next_free_sgpr 102
  .amdhsa_accum_offset 256
  .amdhsa_group_segment_fixed_size 0
  .amdhsa_kernarg_size 112
  .amdhsa_user_sgpr_count 2
  .amdhsa_user_sgpr_kernarg_segment_ptr 1
  .amdhsa_system_sgpr_workgroup_id_x 1
  .amdhsa_float_denorm_mode_32 3
.end_amdhsa_kernel
```

```asm
; @launch grid=(256,1,1) block=(256,1,1) lds=163840
.amdgcn_target "amdgcn-amd-amdhsa--gfx950"
.text
.globl sequential_preLN__compressed_kv_cla__moe_arch_mod__prompt_kernel
.p2align 8
.type sequential_preLN__compressed_kv_cla__moe_arch_mod__prompt_kernel,@function
sequential_preLN__compressed_kv_cla__moe_arch_mod__prompt_kernel:
    s_cmp_ge_u32 s2, 256
    s_cbranch_scc1 ka_done
    s_load_dwordx8 s[64:71], s[0:1], 0
    s_load_dwordx4 s[72:75], s[0:1], 32
    s_load_dwordx4 s[76:79], s[0:1], 64
    s_load_dwordx8 s[8:15], s[0:1], 80
    v_lshrrev_b32 v1, 6, v0
    v_and_b32 v2, 63, v0
    v_readfirstlane_b32 s3, v1
    v_mov_b32_e64 v253, v0
    s_and_b32 s4, s2, 7
    s_lshl_b32 s4, s4, 2
    s_lshr_b32 s24, s2, 3
    s_and_b32 s24, s24, 3
    s_add_u32 s4, s4, s24
    s_lshr_b32 s5, s2, 5
    s_lshl2_add_u32 s6, s5, s3
    s_getpc_b64 s[56:57]
ka_pc:
    s_mov_b32 s58, code_end-ka_pc
    s_mov_b32 s59, 0x00020000
    s_lshr_b32 s24, s2, 3
    s_xor_b32 s24, s24, 31
    s_lshl2_add_u32 s24, s24, s3
    s_lshl_b32 s24, s24, 13
    v_lshlrev_b32_e64 v3, 7, v2
    buffer_load_dword v252, v3, s[56:59], s24 offen
    v_mov_b32 v192, v2
    v_lshrrev_b32 v198, 3, v192
    v_and_b32 v199, 7, v192
    s_lshr_b32 s24, s3, 1
    s_lshl_b32 s24, s24, 5
    s_and_b32 s25, s3, 1
    s_lshl_b32 s26, s25, 3
    s_add_u32 s24, s24, s26
    v_add_u32 v194, s24, v198
    v_lshlrev_b32 v194, 10, v194
    v_lshrrev_b32 v195, 1, v198
    v_xor_b32 v195, v199, v195
    v_lshl_add_u32 v232, v195, 4, v194
    v_xor_b32_e64 v195, 4, v195
    v_lshl_add_u32 v233, v195, 4, v194
    v_add_u32 v233, 15360, v233
    s_lshl_b32 s24, s4, 8
    s_lshl_b32 s26, s25, 7
    s_add_u32 s24, s24, s26
    v_lshlrev_b32 v194, 13, v198
    v_add_u32_e64 v194, s24, v194
    v_bfe_u32 v195, v198, 1, 1
    v_xor_b32_e64 v195, v199, v195
    v_lshl_add_u32 v234, v195, 4, v194
    v_xor_b32_e64 v195, 4, v195
    v_lshl_add_u32 v235, v195, 4, v194
    v_add_u32 v235, 64512, v235
    s_lshl_b32 s34, s3, 11
    s_mul_i32 s35, s3, 24576
    s_add_u32 s35, s35, 65536
    s_lshl_b32 s32, s5, 18
    s_and_b32 s7, s4, 3
    s_lshl1_add_u32 s7, s7, s5
    s_add_u32 s80, s7, 0
    s_and_b32 s80, s80, 7
    s_lshl_b32 s80, s80, 7
    s_add_u32 s80, s80, s32
    s_add_u32 s81, s7, 1
    s_and_b32 s81, s81, 7
    s_lshl_b32 s81, s81, 7
    s_add_u32 s81, s81, s32
    s_add_u32 s82, s7, 2
    s_and_b32 s82, s82, 7
    s_lshl_b32 s82, s82, 7
    s_add_u32 s82, s82, s32
    s_add_u32 s83, s7, 3
    s_and_b32 s83, s83, 7
    s_lshl_b32 s83, s83, 7
    s_add_u32 s83, s83, s32
    s_add_u32 s84, s7, 4
    s_and_b32 s84, s84, 7
    s_lshl_b32 s84, s84, 7
    s_add_u32 s84, s84, s32
    s_add_u32 s85, s7, 5
    s_and_b32 s85, s85, 7
    s_lshl_b32 s85, s85, 7
    s_add_u32 s85, s85, s32
    s_add_u32 s86, s7, 6
    s_and_b32 s86, s86, 7
    s_lshl_b32 s86, s86, 7
    s_add_u32 s86, s86, s32
    s_add_u32 s87, s7, 7
    s_and_b32 s87, s87, 7
    s_lshl_b32 s87, s87, 7
    s_add_u32 s87, s87, s32
    s_waitcnt lgkmcnt(0)
    s_cmp_lt_u32 s3, 2
    s_cselect_b32 s48, s70, s72
    s_cselect_b32 s49, s71, s73
    s_mov_b32 s50, 0x400000
    s_mov_b32 s51, 0x00020000
    s_mov_b32 s44, s66
    s_mov_b32 s45, s67
    s_mov_b32 s46, 0x200000
    s_mov_b32 s47, 0x00020000
    s_add_u32 m0, s35, 0
    s_and_b32 s33, s80, 1023
    s_lshl_b32 s33, s33, 12
    buffer_load_dwordx4 v234, s[48:51], s33 offen lds
    buffer_load_dwordx4 v235, s[48:51], s33 offen offset:1024 lds
    s_add_u32 m0, s35, 2048
    s_add_u32 s33, s33, 131072
    buffer_load_dwordx4 v234, s[48:51], s33 offen lds
    buffer_load_dwordx4 v235, s[48:51], s33 offen offset:1024 lds
    s_add_u32 m0, s34, 0
    s_add_u32 s37, s80, 0
    buffer_load_dwordx4 v232, s[44:47], s37 offen lds
    buffer_load_dwordx4 v233, s[44:47], s37 offen offset:1024 lds
    s_add_u32 m0, s34, 8192
    s_add_u32 s37, s80, 65536
    buffer_load_dwordx4 v232, s[44:47], s37 offen lds
    buffer_load_dwordx4 v233, s[44:47], s37 offen offset:1024 lds
    s_add_u32 m0, s35, 4096
    s_add_u32 s33, s33, 131072
    buffer_load_dwordx4 v234, s[48:51], s33 offen lds
    buffer_load_dwordx4 v235, s[48:51], s33 offen offset:1024 lds
    s_add_u32 m0, s35, 6144
    s_add_u32 s33, s33, 131072
    buffer_load_dwordx4 v234, s[48:51], s33 offen lds
    buffer_load_dwordx4 v235, s[48:51], s33 offen offset:1024 lds
    s_mov_b32 s52, s64
    s_mov_b32 s53, s65
    s_mov_b32 s54, 0x400000
    s_mov_b32 s55, 0x00020000
    s_add_u32 s16, s14, 0x5c00000
    s_addc_u32 s17, s15, 0
    s_mov_b32 s18, 0x2140000
    s_mov_b32 s19, 0x00020000
    s_add_u32 s56, s14, 0x3800000
    s_addc_u32 s57, s15, 0
    s_mov_b32 s58, 0x6040
    s_mov_b32 s59, 0x00020000
    s_add_u32 s20, s14, 0x2400000
    s_addc_u32 s21, s15, 0
    s_mov_b32 s22, 0x1000000
    s_mov_b32 s23, 0x00020000
    s_mov_b32 s88, s12
    s_mov_b32 s89, s13
    s_mov_b32 s90, 0x100
    s_mov_b32 s91, 0x00020000
    s_cmp_lt_u32 s3, 2
    s_cselect_b32 s60, s8, s74
    s_cselect_b32 s61, s9, s75
    s_mov_b32 s62, 0x800000
    s_cselect_b32 s62, 0x700000, s62
    s_mov_b32 s63, 0x00020000
    s_cselect_b32 s41, s76, s78
    s_cselect_b32 s42, s77, s79
    s_mov_b32 s8, s14
    s_mov_b32 s9, s15
    s_mov_b32 s10, 0x400000
    s_mov_b32 s11, 0x00020000
    s_mov_b32 s12, s68
    s_mov_b32 s13, s69
    s_mov_b32 s14, 0x800000
    s_mov_b32 s15, 0x00020000
    s_cmp_eq_u32 s2, 200
    s_mov_b32 s97, 0x40000000
    s_cselect_b32 s97, 0xa0000, s97
    s_mov_b32 s58, 0xa5000
    v_lshlrev_b32 v194, 7, v253
    v_mov_b32_e64 v195, 0
    buffer_store_dword v195, v194, s[56:59], s97 offen sc1
    s_cselect_b32 s97, 0, 0x40000000
    s_mov_b32 s58, 0x6040
    s_add_u32 m0, s35, 8192
    s_and_b32 s33, s81, 1023
    s_lshl_b32 s33, s33, 12
    buffer_load_dwordx4 v234, s[48:51], s33 offen lds
    buffer_load_dwordx4 v235, s[48:51], s33 offen offset:1024 lds
    s_add_u32 m0, s35, 10240
    s_add_u32 s33, s33, 131072
    buffer_load_dwordx4 v234, s[48:51], s33 offen lds
    buffer_load_dwordx4 v235, s[48:51], s33 offen offset:1024 lds
    s_add_u32 m0, s35, 12288
    s_add_u32 s33, s33, 131072
    buffer_load_dwordx4 v234, s[48:51], s33 offen lds
    buffer_load_dwordx4 v235, s[48:51], s33 offen offset:1024 lds
    s_add_u32 m0, s35, 14336
    s_add_u32 s33, s33, 131072
    buffer_load_dwordx4 v234, s[48:51], s33 offen lds
    buffer_load_dwordx4 v235, s[48:51], s33 offen offset:1024 lds
    s_add_u32 m0, s34, 16384
    s_add_u32 s37, s81, 0
    buffer_load_dwordx4 v232, s[44:47], s37 offen lds
    buffer_load_dwordx4 v233, s[44:47], s37 offen offset:1024 lds
    s_add_u32 m0, s34, 24576
    s_add_u32 s37, s81, 65536
    buffer_load_dwordx4 v232, s[44:47], s37 offen lds
    buffer_load_dwordx4 v233, s[44:47], s37 offen offset:1024 lds
    v_and_b32 v200, 15, v192
    v_lshrrev_b32 v201, 4, v192
    v_lshrrev_b32 v194, 1, v200
    v_xor_b32 v194, v201, v194
    v_lshlrev_b32 v194, 4, v194
    v_lshl_add_u32 v224, v200, 7, v194
    v_xor_b32 v225, 64, v224
    v_lshrrev_b32 v194, 2, v200
    v_lshl_add_u32 v195, v201, 3, v194
    v_lshlrev_b32 v195, 7, v195
    v_add_u32 v195, s35, v195
    v_and_b32_e64 v196, 1, v200
    v_lshl_add_u32 v195, v196, 3, v195
    v_lshrrev_b32 v194, 1, v194
    v_and_b32 v196, 1, v201
    v_lshl_or_b32 v194, v196, 2, v194
    v_and_b32 v196, 2, v200
    v_xor_b32 v194, v194, v196
    v_xor_b32_e64 v196, 0, v194
    v_lshl_add_u32 v228, v196, 4, v195
    v_xor_b32_e64 v196, 1, v194
    v_lshl_add_u32 v229, v196, 4, v195
    v_xor_b32_e64 v196, 4, v194
    v_lshl_add_u32 v230, v196, 4, v195
    v_xor_b32_e64 v196, 5, v194
    v_lshl_add_u32 v231, v196, 4, v195
    s_mul_i32 s36, s4, 1089536
    s_mul_i32 s24, s5, 136192
    s_add_u32 s36, s36, s24
    s_and_b32 s24, s3, 1
    s_lshl_b32 s24, s24, 12
    s_and_b32 s26, s3, 2
    s_lshl_b32 s26, s26, 13
    s_add_u32 s36, s36, s24
    s_add_u32 s36, s36, s26
    s_lshl_b32 s24, s5, 7
    s_sub_u32 s26, 1792, s24
    s_cmp_lt_u32 s4, 16
    s_cselect_b32 s24, s24, s26
    s_lshl_b32 s26, s4, 3
    s_add_u32 s24, s24, s26
    v_lshrrev_b32 v194, 5, v253
    v_add_u32 v196, s24, v194
    v_and_b32 v195, 31, v192
    v_lshlrev_b32 v196, 11, v196
    v_lshl_add_u32 v236, v195, 4, v196
    v_xor_b32 v194, v194, v199
    v_lshlrev_b32 v194, 4, v194
    v_lshl_add_u32 v194, v195, 7, v194
    v_add_u32 v237, 81920, v194
    s_lshr_b32 s26, s24, 4
    s_lshl_b32 s26, s26, 15
    s_and_b32 s24, s24, 15
    s_lshl_b32 s24, s24, 4
    s_add_u32 s24, s24, s26
    v_lshrrev_b32 v194, 3, v253
    v_lshlrev_b32 v194, 8, v194
    v_xor_b32 v195, v199, v198
    v_lshl_add_u32 v194, v195, 4, v194
    v_add_u32 v238, s24, v194
    v_lshlrev_b32 v240, 4, v192
    s_lshl_b32 s24, s3, 12
    v_add_u32 v242, s24, v240
    s_lshl_b32 s24, s6, 16
    v_add_u32 v248, s24, v240
    s_sub_u32 s25, 63, s6
    s_lshl_b32 s24, s25, 16
    v_add_u32_e64 v249, s24, v240
    v_bfe_u32 v194, v192, 2, 2
    v_lshlrev_b32_e64 v194, 13, v194
    v_lshl_add_u32 v194, v201, 6, v194
    v_and_b32_e64 v195, 3, v192
    v_lshl_add_u32 v194, v195, 4, v194
    s_lshl_b32 s24, s4, 8
    s_lshl_b32 s25, s3, 18
    s_add_u32 s24, s24, s25
    v_add_u32_e64 v245, s24, v194
    s_lshl_b32 s31, s3, 13
    s_add_u32 s31, s31, 65536
    s_lshl_b32 s27, s5, 20
    s_mov_b32 s7, s27
    s_mov_b32 s43, 0x40000000
    s_lshr_b32 s28, s27, 8
    s_add_u32 s29, s28, 32768
    s_nop 0
    v_lshlrev_b32 v194, 11, v201
    v_bfe_u32 v195, v192, 2, 2
    v_lshl_add_u32 v194, v195, 6, v194
    v_bfe_u32 v195, v192, 4, 1
    v_lshl_add_u32 v194, v195, 4, v194
    v_and_b32_e64 v195, 1, v192
    v_lshl_add_u32 v194, v195, 3, v194
    v_bfe_u32 v195, v192, 1, 1
    v_lshl_add_u32 v247, v195, 5, v194
    s_mov_b32 s30, 65536
    v_add_u32 v246, s30, v247
    v_lshrrev_b32 v195, 5, v192
    v_lshlrev_b32 v195, 4, v195
    v_sub_u32 v194, v200, v195
    v_bfe_u32 v195, v192, 4, 1
    v_lshlrev_b32 v195, 2, v195
    v_sub_u32 v194, v194, v195
    v_cvt_f32_i32 v194, v194
    v_add_f32 v194, 0.5, v194
    v_mul_f32 v243, 0x71800000, v194
    v_add_u32 v244, 0x20000, v240
    v_lshlrev_b32 v251, 7, v192
    v_cmp_gt_u32 vcc, 16, v192
    v_mov_b32 v194, 0x40000000
    v_mov_b32 v255, 1
    v_cndmask_b32 v251, v194, v251, vcc
    v_cmp_eq_u32 vcc, 0, v253
    s_nop 1
    v_cndmask_b32 v250, v194, v253, vcc
    s_waitcnt vmcnt(19)
    s_barrier
    ds_read_b128 v[64:67], v224 offset:0
    ds_read_b128 v[68:71], v224 offset:2048
    ds_read_b128 v[72:75], v224 offset:4096
    ds_read_b128 v[76:79], v224 offset:6144
    ds_read_b64_tr_b16 a[0:1], v228 offset:0
    ds_read_b64_tr_b16 a[2:3], v228 offset:512
    ds_read_b64_tr_b16 a[4:5], v229 offset:0
    ds_read_b64_tr_b16 a[6:7], v229 offset:512
    ds_read_b64_tr_b16 a[8:9], v230 offset:0
    ds_read_b64_tr_b16 a[10:11], v230 offset:512
    ds_read_b64_tr_b16 a[12:13], v231 offset:0
    ds_read_b64_tr_b16 a[14:15], v231 offset:512
    s_waitcnt vmcnt(12)
    s_barrier
    buffer_store_dword v255, v250, s[88:91], s97 offen sc1
    s_cmp_eq_u32 s3, 0
    s_cselect_b32 s97, 0, s43
    s_cmp_lt_u32 s3, 2
    s_cbranch_scc0 ka_V
    s_waitcnt lgkmcnt(0)
    v_mfma_f32_16x16x32_bf16 v[96:99], a[0:3], v[64:67], 0
    ds_read_b128 v[80:83], v224 offset:8192
    v_mfma_f32_16x16x32_bf16 v[100:103], a[4:7], v[64:67], 0
    ds_read_b128 v[84:87], v224 offset:10240
    v_mfma_f32_16x16x32_bf16 v[104:107], a[8:11], v[64:67], 0
    ds_read_b128 v[88:91], v224 offset:12288
    v_mfma_f32_16x16x32_bf16 v[108:111], a[12:15], v[64:67], 0
    ds_read_b128 v[92:95], v224 offset:14336
    v_mfma_f32_16x16x32_bf16 v[112:115], a[0:3], v[68:71], 0
    ds_read_b64_tr_b16 a[16:17], v228 offset:4096
    v_mfma_f32_16x16x32_bf16 v[116:119], a[4:7], v[68:71], 0
    ds_read_b64_tr_b16 a[18:19], v228 offset:4608
    v_mfma_f32_16x16x32_bf16 v[120:123], a[8:11], v[68:71], 0
    ds_read_b64_tr_b16 a[20:21], v229 offset:4096
    v_mfma_f32_16x16x32_bf16 v[124:127], a[12:15], v[68:71], 0
    ds_read_b64_tr_b16 a[22:23], v229 offset:4608
    v_mfma_f32_16x16x32_bf16 v[128:131], a[0:3], v[72:75], 0
    s_add_u32 m0, s35, 16384
    s_and_b32 s33, s82, 1023
    s_lshl_b32 s33, s33, 12
    buffer_load_dwordx4 v234, s[48:51], s33 offen lds
    v_mfma_f32_16x16x32_bf16 v[132:135], a[4:7], v[72:75], 0
    v_mfma_f32_16x16x32_bf16 v[136:139], a[8:11], v[72:75], 0
    buffer_load_dwordx4 v235, s[48:51], s33 offen offset:1024 lds
    v_mfma_f32_16x16x32_bf16 v[140:143], a[12:15], v[72:75], 0
    v_mfma_f32_16x16x32_bf16 v[144:147], a[0:3], v[76:79], 0
    s_add_u32 m0, s35, 18432
    s_add_u32 s33, s33, 131072
    buffer_load_dwordx4 v234, s[48:51], s33 offen lds
    v_mfma_f32_16x16x32_bf16 v[148:151], a[4:7], v[76:79], 0
    v_mfma_f32_16x16x32_bf16 v[152:155], a[8:11], v[76:79], 0
    buffer_load_dwordx4 v235, s[48:51], s33 offen offset:1024 lds
    v_mfma_f32_16x16x32_bf16 v[156:159], a[12:15], v[76:79], 0
    s_waitcnt lgkmcnt(0)
    v_mfma_f32_16x16x32_bf16 v[160:163], a[0:3], v[80:83], 0
    ds_read_b128 v[64:67], v225 offset:0
    v_mfma_f32_16x16x32_bf16 v[164:167], a[4:7], v[80:83], 0
    ds_read_b128 v[68:71], v225 offset:2048
    v_mfma_f32_16x16x32_bf16 v[168:171], a[8:11], v[80:83], 0
    ds_read_b128 v[72:75], v225 offset:4096
    v_mfma_f32_16x16x32_bf16 v[172:175], a[12:15], v[80:83], 0
    ds_read_b128 v[76:79], v225 offset:6144
    v_mfma_f32_16x16x32_bf16 v[176:179], a[0:3], v[84:87], 0
    ds_read_b64_tr_b16 a[24:25], v230 offset:4096
    v_mfma_f32_16x16x32_bf16 v[180:183], a[4:7], v[84:87], 0
    ds_read_b64_tr_b16 a[26:27], v230 offset:4608
    v_mfma_f32_16x16x32_bf16 v[184:187], a[8:11], v[84:87], 0
    ds_read_b64_tr_b16 a[28:29], v231 offset:4096
    v_mfma_f32_16x16x32_bf16 v[188:191], a[12:15], v[84:87], 0
    ds_read_b64_tr_b16 a[30:31], v231 offset:4608
    v_mfma_f32_16x16x32_bf16 v[192:195], a[0:3], v[88:91], 0
    s_add_u32 m0, s35, 20480
    s_add_u32 s33, s33, 131072
    buffer_load_dwordx4 v234, s[48:51], s33 offen lds
    v_mfma_f32_16x16x32_bf16 v[196:199], a[4:7], v[88:91], 0
    v_mfma_f32_16x16x32_bf16 v[200:203], a[8:11], v[88:91], 0
    buffer_load_dwordx4 v235, s[48:51], s33 offen offset:1024 lds
    v_mfma_f32_16x16x32_bf16 v[204:207], a[12:15], v[88:91], 0
    v_mfma_f32_16x16x32_bf16 v[208:211], a[0:3], v[92:95], 0
    s_add_u32 m0, s35, 22528
    s_add_u32 s33, s33, 131072
    buffer_load_dwordx4 v234, s[48:51], s33 offen lds
    v_mfma_f32_16x16x32_bf16 v[212:215], a[4:7], v[92:95], 0
    v_mfma_f32_16x16x32_bf16 v[216:219], a[8:11], v[92:95], 0
    buffer_load_dwordx4 v235, s[48:51], s33 offen offset:1024 lds
    v_mfma_f32_16x16x32_bf16 v[220:223], a[12:15], v[92:95], 0
    s_waitcnt vmcnt(13) lgkmcnt(0)
    v_mfma_f32_16x16x32_bf16 v[96:99], a[16:19], v[64:67], v[96:99]
    ds_read_b128 v[80:83], v225 offset:8192
    v_mfma_f32_16x16x32_bf16 v[100:103], a[20:23], v[64:67], v[100:103]
    ds_read_b128 v[84:87], v225 offset:10240
    v_mfma_f32_16x16x32_bf16 v[104:107], a[24:27], v[64:67], v[104:107]
    ds_read_b128 v[88:91], v225 offset:12288
    v_mfma_f32_16x16x32_bf16 v[108:111], a[28:31], v[64:67], v[108:111]
    ds_read_b128 v[92:95], v225 offset:14336
    v_mfma_f32_16x16x32_bf16 v[112:115], a[16:19], v[68:71], v[112:115]
    ds_read_b64_tr_b16 a[32:33], v228 offset:8192
    v_mfma_f32_16x16x32_bf16 v[116:119], a[20:23], v[68:71], v[116:119]
    ds_read_b64_tr_b16 a[34:35], v228 offset:8704
    v_mfma_f32_16x16x32_bf16 v[120:123], a[24:27], v[68:71], v[120:123]
    ds_read_b64_tr_b16 a[36:37], v229 offset:8192
    v_mfma_f32_16x16x32_bf16 v[124:127], a[28:31], v[68:71], v[124:127]
    ds_read_b64_tr_b16 a[38:39], v229 offset:8704
    v_mfma_f32_16x16x32_bf16 v[128:131], a[16:19], v[72:75], v[128:131]
    ds_read_b64_tr_b16 a[40:41], v230 offset:8192
    s_add_u32 m0, s34, 32768
    s_add_u32 s37, s82, 0
    buffer_load_dwordx4 v232, s[44:47], s37 offen lds
    v_mfma_f32_16x16x32_bf16 v[132:135], a[20:23], v[72:75], v[132:135]
    ds_read_b64_tr_b16 a[42:43], v230 offset:8704
    buffer_load_dwordx4 v233, s[44:47], s37 offen offset:1024 lds
    v_mfma_f32_16x16x32_bf16 v[136:139], a[24:27], v[72:75], v[136:139]
    ds_read_b64_tr_b16 a[44:45], v231 offset:8192
    s_add_u32 m0, s34, 40960
    s_add_u32 s37, s82, 65536
    buffer_load_dwordx4 v232, s[44:47], s37 offen lds
    v_mfma_f32_16x16x32_bf16 v[140:143], a[28:31], v[72:75], v[140:143]
    ds_read_b64_tr_b16 a[46:47], v231 offset:8704
    buffer_load_dwordx4 v233, s[44:47], s37 offen offset:1024 lds
    v_mfma_f32_16x16x32_bf16 v[144:147], a[16:19], v[76:79], v[144:147]
    s_add_u32 m0, s35, 0
    s_and_b32 s33, s83, 1023
    s_lshl_b32 s33, s33, 12
    buffer_load_dwordx4 v234, s[48:51], s33 offen lds
    v_mfma_f32_16x16x32_bf16 v[148:151], a[20:23], v[76:79], v[148:151]
    buffer_load_dwordx4 v235, s[48:51], s33 offen offset:1024 lds
    v_mfma_f32_16x16x32_bf16 v[152:155], a[24:27], v[76:79], v[152:155]
    s_add_u32 m0, s35, 2048
    s_add_u32 s33, s33, 131072
    buffer_load_dwordx4 v234, s[48:51], s33 offen lds
    v_mfma_f32_16x16x32_bf16 v[156:159], a[28:31], v[76:79], v[156:159]
    buffer_load_dwordx4 v235, s[48:51], s33 offen offset:1024 lds
    s_waitcnt vmcnt(17) lgkmcnt(0)
    s_barrier
    v_mfma_f32_16x16x32_bf16 v[160:163], a[16:19], v[80:83], v[160:163]
    ds_read_b128 v[64:67], v224 offset:16384
    v_mfma_f32_16x16x32_bf16 v[164:167], a[20:23], v[80:83], v[164:167]
    ds_read_b128 v[68:71], v225 offset:16384
    v_mfma_f32_16x16x32_bf16 v[168:171], a[24:27], v[80:83], v[168:171]
    ds_read_b128 v[72:75], v224 offset:18432
    v_mfma_f32_16x16x32_bf16 v[172:175], a[28:31], v[80:83], v[172:175]
    ds_read_b128 v[76:79], v225 offset:18432
    v_mfma_f32_16x16x32_bf16 v[176:179], a[16:19], v[84:87], v[176:179]
    ds_read_b64_tr_b16 a[48:49], v228 offset:12288
    s_add_u32 m0, s34, 49152
    s_add_u32 s37, s83, 0
    buffer_load_dwordx4 v232, s[44:47], s37 offen lds
    v_mfma_f32_16x16x32_bf16 v[180:183], a[20:23], v[84:87], v[180:183]
    ds_read_b64_tr_b16 a[50:51], v228 offset:12800
    buffer_load_dwordx4 v233, s[44:47], s37 offen offset:1024 lds
    v_mfma_f32_16x16x32_bf16 v[184:187], a[24:27], v[84:87], v[184:187]
    ds_read_b64_tr_b16 a[52:53], v229 offset:12288
    s_add_u32 m0, s34, 57344
    s_add_u32 s37, s83, 65536
    buffer_load_dwordx4 v232, s[44:47], s37 offen lds
    v_mfma_f32_16x16x32_bf16 v[188:191], a[28:31], v[84:87], v[188:191]
    ds_read_b64_tr_b16 a[54:55], v229 offset:12800
    buffer_load_dwordx4 v233, s[44:47], s37 offen offset:1024 lds
    v_mfma_f32_16x16x32_bf16 v[192:195], a[16:19], v[88:91], v[192:195]
    ds_read_b64_tr_b16 a[56:57], v230 offset:12288
    s_add_u32 m0, s34, 0
    s_add_u32 s37, s84, 0
    buffer_load_dwordx4 v232, s[44:47], s37 offen lds
    v_mfma_f32_16x16x32_bf16 v[196:199], a[20:23], v[88:91], v[196:199]
    ds_read_b64_tr_b16 a[58:59], v230 offset:12800
    v_mfma_f32_16x16x32_bf16 v[200:203], a[24:27], v[88:91], v[200:203]
    ds_read_b64_tr_b16 a[60:61], v231 offset:12288
    buffer_load_dwordx4 v233, s[44:47], s37 offen offset:1024 lds
    v_mfma_f32_16x16x32_bf16 v[204:207], a[28:31], v[88:91], v[204:207]
    ds_read_b64_tr_b16 a[62:63], v231 offset:12800
    buffer_load_dwordx4 v[0:3], v236, s[52:55], 0 offen offset:0
    v_mfma_f32_16x16x32_bf16 v[208:211], a[16:19], v[92:95], v[208:211]
    buffer_load_dwordx4 v[4:7], v236, s[52:55], 0 offen offset:512
    v_mfma_f32_16x16x32_bf16 v[212:215], a[20:23], v[92:95], v[212:215]
    buffer_load_dwordx4 v[8:11], v236, s[52:55], 0 offen offset:1024
    v_mfma_f32_16x16x32_bf16 v[216:219], a[24:27], v[92:95], v[216:219]
    buffer_load_dwordx4 v[12:15], v236, s[52:55], 0 offen offset:1536
    v_mfma_f32_16x16x32_bf16 v[220:223], a[28:31], v[92:95], v[220:223]
    s_waitcnt lgkmcnt(0)
    v_mfma_f32_16x16x32_bf16 v[96:99], a[32:35], v[64:67], v[96:99]
    ds_read_b128 v[80:83], v224 offset:20480
    v_mfma_f32_16x16x32_bf16 v[96:99], a[48:51], v[68:71], v[96:99]
    ds_read_b128 v[84:87], v225 offset:20480
    v_mfma_f32_16x16x32_bf16 v[100:103], a[36:39], v[64:67], v[100:103]
    ds_read_b128 v[88:91], v224 offset:22528
    v_mfma_f32_16x16x32_bf16 v[100:103], a[52:55], v[68:71], v[100:103]
    ds_read_b128 v[92:95], v225 offset:22528
    v_mfma_f32_16x16x32_bf16 v[104:107], a[40:43], v[64:67], v[104:107]
    v_mfma_f32_16x16x32_bf16 v[104:107], a[56:59], v[68:71], v[104:107]
    v_mfma_f32_16x16x32_bf16 v[108:111], a[44:47], v[64:67], v[108:111]
    v_mfma_f32_16x16x32_bf16 v[108:111], a[60:63], v[68:71], v[108:111]
    v_mfma_f32_16x16x32_bf16 v[112:115], a[32:35], v[72:75], v[112:115]
    s_add_u32 m0, s35, 4096
    s_add_u32 s33, s33, 131072
    buffer_load_dwordx4 v234, s[48:51], s33 offen lds
    v_mfma_f32_16x16x32_bf16 v[112:115], a[48:51], v[76:79], v[112:115]
    v_mfma_f32_16x16x32_bf16 v[116:119], a[36:39], v[72:75], v[116:119]
    buffer_load_dwordx4 v235, s[48:51], s33 offen offset:1024 lds
    v_mfma_f32_16x16x32_bf16 v[116:119], a[52:55], v[76:79], v[116:119]
    v_mfma_f32_16x16x32_bf16 v[120:123], a[40:43], v[72:75], v[120:123]
    s_add_u32 m0, s35, 6144
    s_add_u32 s33, s33, 131072
    buffer_load_dwordx4 v234, s[48:51], s33 offen lds
    v_mfma_f32_16x16x32_bf16 v[120:123], a[56:59], v[76:79], v[120:123]
    v_mfma_f32_16x16x32_bf16 v[124:127], a[44:47], v[72:75], v[124:127]
    buffer_load_dwordx4 v235, s[48:51], s33 offen offset:1024 lds
    v_mfma_f32_16x16x32_bf16 v[124:127], a[60:63], v[76:79], v[124:127]
    s_waitcnt lgkmcnt(0)
    v_mfma_f32_16x16x32_bf16 v[128:131], a[32:35], v[80:83], v[128:131]
    ds_read_b128 v[64:67], v224 offset:24576
    v_mfma_f32_16x16x32_bf16 v[128:131], a[48:51], v[84:87], v[128:131]
    ds_read_b128 v[68:71], v225 offset:24576
    v_mfma_f32_16x16x32_bf16 v[132:135], a[36:39], v[80:83], v[132:135]
    ds_read_b128 v[72:75], v224 offset:26624
    v_mfma_f32_16x16x32_bf16 v[132:135], a[52:55], v[84:87], v[132:135]
    ds_read_b128 v[76:79], v225 offset:26624
    v_mfma_f32_16x16x32_bf16 v[136:139], a[40:43], v[80:83], v[136:139]
    v_mfma_f32_16x16x32_bf16 v[136:139], a[56:59], v[84:87], v[136:139]
    v_mfma_f32_16x16x32_bf16 v[140:143], a[44:47], v[80:83], v[140:143]
    v_mfma_f32_16x16x32_bf16 v[140:143], a[60:63], v[84:87], v[140:143]
    v_mfma_f32_16x16x32_bf16 v[144:147], a[32:35], v[88:91], v[144:147]
    s_add_u32 m0, s34, 8192
    s_add_u32 s37, s84, 65536
    buffer_load_dwordx4 v232, s[44:47], s37 offen lds
    v_mfma_f32_16x16x32_bf16 v[144:147], a[48:51], v[92:95], v[144:147]
    v_mfma_f32_16x16x32_bf16 v[148:151], a[36:39], v[88:91], v[148:151]
    v_mfma_f32_16x16x32_bf16 v[148:151], a[52:55], v[92:95], v[148:151]
    v_mfma_f32_16x16x32_bf16 v[152:155], a[40:43], v[88:91], v[152:155]
    buffer_load_dwordx4 v233, s[44:47], s37 offen offset:1024 lds
    v_mfma_f32_16x16x32_bf16 v[152:155], a[56:59], v[92:95], v[152:155]
    v_mfma_f32_16x16x32_bf16 v[156:159], a[44:47], v[88:91], v[156:159]
    v_mfma_f32_16x16x32_bf16 v[156:159], a[60:63], v[92:95], v[156:159]
    s_waitcnt vmcnt(24) lgkmcnt(0)
    v_mfma_f32_16x16x32_bf16 v[160:163], a[32:35], v[64:67], v[160:163]
    ds_read_b128 v[80:83], v224 offset:28672
    v_mfma_f32_16x16x32_bf16 v[160:163], a[48:51], v[68:71], v[160:163]
    ds_read_b128 v[84:87], v225 offset:28672
    v_mfma_f32_16x16x32_bf16 v[164:167], a[36:39], v[64:67], v[164:167]
    ds_read_b128 v[88:91], v224 offset:30720
    v_mfma_f32_16x16x32_bf16 v[164:167], a[52:55], v[68:71], v[164:167]
    ds_read_b128 v[92:95], v225 offset:30720
    v_mfma_f32_16x16x32_bf16 v[168:171], a[40:43], v[64:67], v[168:171]
    ds_read_b64_tr_b16 a[64:65], v228 offset:16384
    v_mfma_f32_16x16x32_bf16 v[168:171], a[56:59], v[68:71], v[168:171]
    ds_read_b64_tr_b16 a[66:67], v228 offset:16896
    v_mfma_f32_16x16x32_bf16 v[172:175], a[44:47], v[64:67], v[172:175]
    ds_read_b64_tr_b16 a[68:69], v229 offset:16384
    v_mfma_f32_16x16x32_bf16 v[172:175], a[60:63], v[68:71], v[172:175]
    ds_read_b64_tr_b16 a[70:71], v229 offset:16896
    v_mfma_f32_16x16x32_bf16 v[176:179], a[32:35], v[72:75], v[176:179]
    ds_read_b64_tr_b16 a[72:73], v230 offset:16384
    s_add_u32 m0, s35, 8192
    s_and_b32 s33, s84, 1023
    s_lshl_b32 s33, s33, 12
    buffer_load_dwordx4 v234, s[48:51], s33 offen lds
    v_mfma_f32_16x16x32_bf16 v[176:179], a[48:51], v[76:79], v[176:179]
    ds_read_b64_tr_b16 a[74:75], v230 offset:16896
    v_mfma_f32_16x16x32_bf16 v[180:183], a[36:39], v[72:75], v[180:183]
    ds_read_b64_tr_b16 a[76:77], v231 offset:16384
    buffer_load_dwordx4 v235, s[48:51], s33 offen offset:1024 lds
    v_mfma_f32_16x16x32_bf16 v[180:183], a[52:55], v[76:79], v[180:183]
    ds_read_b64_tr_b16 a[78:79], v231 offset:16896
    v_mfma_f32_16x16x32_bf16 v[184:187], a[40:43], v[72:75], v[184:187]
    s_add_u32 m0, s35, 10240
    s_add_u32 s33, s33, 131072
    buffer_load_dwordx4 v234, s[48:51], s33 offen lds
    v_mfma_f32_16x16x32_bf16 v[184:187], a[56:59], v[76:79], v[184:187]
    v_mfma_f32_16x16x32_bf16 v[188:191], a[44:47], v[72:75], v[188:191]
    buffer_load_dwordx4 v235, s[48:51], s33 offen offset:1024 lds
    v_mfma_f32_16x16x32_bf16 v[188:191], a[60:63], v[76:79], v[188:191]
    s_waitcnt vmcnt(24) lgkmcnt(0)
    s_barrier
    v_mfma_f32_16x16x32_bf16 v[192:195], a[32:35], v[80:83], v[192:195]
    ds_read_b128 v[64:67], v224 offset:32768
    v_mfma_f32_16x16x32_bf16 v[192:195], a[48:51], v[84:87], v[192:195]
    ds_read_b128 v[68:71], v225 offset:32768
    v_mfma_f32_16x16x32_bf16 v[196:199], a[36:39], v[80:83], v[196:199]
    ds_read_b128 v[72:75], v224 offset:34816
    v_mfma_f32_16x16x32_bf16 v[196:199], a[52:55], v[84:87], v[196:199]
    ds_read_b128 v[76:79], v225 offset:34816
    v_mfma_f32_16x16x32_bf16 v[200:203], a[40:43], v[80:83], v[200:203]
    ds_read_b64_tr_b16 a[80:81], v228 offset:20480
    v_mfma_f32_16x16x32_bf16 v[200:203], a[56:59], v[84:87], v[200:203]
    ds_read_b64_tr_b16 a[82:83], v228 offset:20992
    v_mfma_f32_16x16x32_bf16 v[204:207], a[44:47], v[80:83], v[204:207]
    ds_read_b64_tr_b16 a[84:85], v229 offset:20480
    v_mfma_f32_16x16x32_bf16 v[204:207], a[60:63], v[84:87], v[204:207]
    ds_read_b64_tr_b16 a[86:87], v229 offset:20992
    v_mfma_f32_16x16x32_bf16 v[208:211], a[32:35], v[88:91], v[208:211]
    ds_read_b64_tr_b16 a[88:89], v230 offset:20480
    s_add_u32 m0, s34, 16384
    s_add_u32 s37, s85, 0
    buffer_load_dwordx4 v232, s[44:47], s37 offen lds
    v_mfma_f32_16x16x32_bf16 v[208:211], a[48:51], v[92:95], v[208:211]
    ds_read_b64_tr_b16 a[90:91], v230 offset:20992
    v_mfma_f32_16x16x32_bf16 v[212:215], a[36:39], v[88:91], v[212:215]
    ds_read_b64_tr_b16 a[92:93], v231 offset:20480
    v_mfma_f32_16x16x32_bf16 v[212:215], a[52:55], v[92:95], v[212:215]
    ds_read_b64_tr_b16 a[94:95], v231 offset:20992
    v_mfma_f32_16x16x32_bf16 v[216:219], a[40:43], v[88:91], v[216:219]
    buffer_load_dwordx4 v233, s[44:47], s37 offen offset:1024 lds
    v_mfma_f32_16x16x32_bf16 v[216:219], a[56:59], v[92:95], v[216:219]
    v_mfma_f32_16x16x32_bf16 v[220:223], a[44:47], v[88:91], v[220:223]
    v_mfma_f32_16x16x32_bf16 v[220:223], a[60:63], v[92:95], v[220:223]
    s_waitcnt lgkmcnt(0)
    v_mfma_f32_16x16x32_bf16 v[96:99], a[64:67], v[64:67], v[96:99]
    ds_read_b128 v[80:83], v224 offset:36864
    v_mfma_f32_16x16x32_bf16 v[96:99], a[80:83], v[68:71], v[96:99]
    ds_read_b128 v[84:87], v225 offset:36864
    v_mfma_f32_16x16x32_bf16 v[100:103], a[68:71], v[64:67], v[100:103]
    ds_read_b128 v[88:91], v224 offset:38912
    v_mfma_f32_16x16x32_bf16 v[100:103], a[84:87], v[68:71], v[100:103]
    ds_read_b128 v[92:95], v225 offset:38912
    v_mfma_f32_16x16x32_bf16 v[104:107], a[72:75], v[64:67], v[104:107]
    v_mfma_f32_16x16x32_bf16 v[104:107], a[88:91], v[68:71], v[104:107]
    v_mfma_f32_16x16x32_bf16 v[108:111], a[76:79], v[64:67], v[108:111]
    v_mfma_f32_16x16x32_bf16 v[108:111], a[92:95], v[68:71], v[108:111]
    v_mfma_f32_16x16x32_bf16 v[112:115], a[64:67], v[72:75], v[112:115]
    s_add_u32 m0, s35, 12288
    s_add_u32 s33, s33, 131072
    buffer_load_dwordx4 v234, s[48:51], s33 offen lds
    v_mfma_f32_16x16x32_bf16 v[112:115], a[80:83], v[76:79], v[112:115]
    v_mfma_f32_16x16x32_bf16 v[116:119], a[68:71], v[72:75], v[116:119]
    buffer_load_dwordx4 v235, s[48:51], s33 offen offset:1024 lds
    v_mfma_f32_16x16x32_bf16 v[116:119], a[84:87], v[76:79], v[116:119]
    v_mfma_f32_16x16x32_bf16 v[120:123], a[72:75], v[72:75], v[120:123]
    s_add_u32 m0, s35, 14336
    s_add_u32 s33, s33, 131072
    buffer_load_dwordx4 v234, s[48:51], s33 offen lds
    v_mfma_f32_16x16x32_bf16 v[120:123], a[88:91], v[76:79], v[120:123]
    v_mfma_f32_16x16x32_bf16 v[124:127], a[76:79], v[72:75], v[124:127]
    buffer_load_dwordx4 v235, s[48:51], s33 offen offset:1024 lds
    v_mfma_f32_16x16x32_bf16 v[124:127], a[92:95], v[76:79], v[124:127]
    s_waitcnt lgkmcnt(0)
    v_mfma_f32_16x16x32_bf16 v[128:131], a[64:67], v[80:83], v[128:131]
    ds_read_b128 v[64:67], v224 offset:40960
    v_mfma_f32_16x16x32_bf16 v[128:131], a[80:83], v[84:87], v[128:131]
    ds_read_b128 v[68:71], v225 offset:40960
    v_mfma_f32_16x16x32_bf16 v[132:135], a[68:71], v[80:83], v[132:135]
    ds_read_b128 v[72:75], v224 offset:43008
    v_mfma_f32_16x16x32_bf16 v[132:135], a[84:87], v[84:87], v[132:135]
    ds_read_b128 v[76:79], v225 offset:43008
    v_mfma_f32_16x16x32_bf16 v[136:139], a[72:75], v[80:83], v[136:139]
    v_mfma_f32_16x16x32_bf16 v[136:139], a[88:91], v[84:87], v[136:139]
    v_mfma_f32_16x16x32_bf16 v[140:143], a[76:79], v[80:83], v[140:143]
    v_mfma_f32_16x16x32_bf16 v[140:143], a[92:95], v[84:87], v[140:143]
    v_mfma_f32_16x16x32_bf16 v[144:147], a[64:67], v[88:91], v[144:147]
    s_add_u32 m0, s34, 24576
    s_add_u32 s37, s85, 65536
    buffer_load_dwordx4 v232, s[44:47], s37 offen lds
    v_mfma_f32_16x16x32_bf16 v[144:147], a[80:83], v[92:95], v[144:147]
    v_mfma_f32_16x16x32_bf16 v[148:151], a[68:71], v[88:91], v[148:151]
    v_mfma_f32_16x16x32_bf16 v[148:151], a[84:87], v[92:95], v[148:151]
    v_mfma_f32_16x16x32_bf16 v[152:155], a[72:75], v[88:91], v[152:155]
    buffer_load_dwordx4 v233, s[44:47], s37 offen offset:1024 lds
    v_mfma_f32_16x16x32_bf16 v[152:155], a[88:91], v[92:95], v[152:155]
    v_mfma_f32_16x16x32_bf16 v[156:159], a[76:79], v[88:91], v[156:159]
    v_mfma_f32_16x16x32_bf16 v[156:159], a[92:95], v[92:95], v[156:159]
    s_waitcnt vmcnt(14) lgkmcnt(0)
    v_mfma_f32_16x16x32_bf16 v[160:163], a[64:67], v[64:67], v[160:163]
    ds_read_b128 v[80:83], v224 offset:45056
    s_waitcnt vmcnt(18)
    v_mfma_f32_16x16x32_bf16 v[160:163], a[80:83], v[68:71], v[160:163]
    ds_read_b128 v[84:87], v225 offset:45056
    v_lshlrev_b32 v16, 16, v0
    v_mfma_f32_16x16x32_bf16 v[164:167], a[68:71], v[64:67], v[164:167]
    ds_read_b128 v[88:91], v224 offset:47104
    v_and_b32 v17, 0xffff0000, v0
    v_lshlrev_b32_e64 v18, 16, v1
    v_mfma_f32_16x16x32_bf16 v[164:167], a[84:87], v[68:71], v[164:167]
    ds_read_b128 v[92:95], v225 offset:47104
    v_and_b32 v19, 0xffff0000, v1
    v_mfma_f32_16x16x32_bf16 v[168:171], a[72:75], v[64:67], v[168:171]
    ds_read_b64_tr_b16 a[96:97], v228 offset:0
    v_lshlrev_b32_e64 v20, 16, v2
    v_mfma_f32_16x16x32_bf16 v[168:171], a[88:91], v[68:71], v[168:171]
    ds_read_b64_tr_b16 a[98:99], v228 offset:512
    v_and_b32 v21, 0xffff0000, v2
    v_mfma_f32_16x16x32_bf16 v[172:175], a[76:79], v[64:67], v[172:175]
    ds_read_b64_tr_b16 a[100:101], v229 offset:0
    v_lshlrev_b32_e64 v22, 16, v3
    v_mfma_f32_16x16x32_bf16 v[172:175], a[92:95], v[68:71], v[172:175]
    ds_read_b64_tr_b16 a[102:103], v229 offset:512
    v_and_b32 v23, 0xffff0000, v3
    v_mfma_f32_16x16x32_bf16 v[176:179], a[64:67], v[72:75], v[176:179]
    ds_read_b64_tr_b16 a[104:105], v230 offset:0
    s_add_u32 m0, s35, 16384
    s_and_b32 s33, s85, 1023
    s_lshl_b32 s33, s33, 12
    buffer_load_dwordx4 v234, s[48:51], s33 offen lds
    v_mfma_f32_16x16x32_bf16 v[176:179], a[80:83], v[76:79], v[176:179]
    ds_read_b64_tr_b16 a[106:107], v230 offset:512
    buffer_load_dwordx4 v235, s[48:51], s33 offen offset:1024 lds
    v_mfma_f32_16x16x32_bf16 v[180:183], a[68:71], v[72:75], v[180:183]
    ds_read_b64_tr_b16 a[108:109], v231 offset:0
    s_add_u32 m0, s35, 18432
    s_add_u32 s33, s33, 131072
    buffer_load_dwordx4 v234, s[48:51], s33 offen lds
    v_mfma_f32_16x16x32_bf16 v[180:183], a[84:87], v[76:79], v[180:183]
    ds_read_b64_tr_b16 a[110:111], v231 offset:512
    v_lshlrev_b32 v24, 16, v4
    v_and_b32 v25, 0xffff0000, v4
    v_mfma_f32_16x16x32_bf16 v[184:187], a[72:75], v[72:75], v[184:187]
    buffer_load_dwordx4 v235, s[48:51], s33 offen offset:1024 lds
    v_lshlrev_b32_e64 v26, 16, v5
    v_mfma_f32_16x16x32_bf16 v[184:187], a[88:91], v[76:79], v[184:187]
    s_lshl2_add_u32 s26, s4, s3
    s_lshl_b32 s26, s26, 10
    s_add_u32 s26, s26, s32
    s_add_u32 s26, s26, 131072
    v_mfma_f32_16x16x32_bf16 v[188:191], a[76:79], v[72:75], v[188:191]
    v_and_b32 v226, 0x40000380, v251
    buffer_load_dword v241, v226, s[44:47], s26 offen
    v_mfma_f32_16x16x32_bf16 v[188:191], a[92:95], v[76:79], v[188:191]
    s_waitcnt vmcnt(29) lgkmcnt(0)
    s_barrier
    v_mfma_f32_16x16x32_bf16 v[192:195], a[64:67], v[80:83], v[192:195]
    ds_read_b128 v[64:67], v224 offset:49152
    v_and_b32 v27, 0xffff0000, v5
    v_mfma_f32_16x16x32_bf16 v[192:195], a[80:83], v[84:87], v[192:195]
    ds_read_b128 v[68:71], v225 offset:49152
    v_lshlrev_b32 v28, 16, v6
    v_mfma_f32_16x16x32_bf16 v[196:199], a[68:71], v[80:83], v[196:199]
    ds_read_b128 v[72:75], v224 offset:51200
    v_and_b32 v29, 0xffff0000, v6
    v_mfma_f32_16x16x32_bf16 v[196:199], a[84:87], v[84:87], v[196:199]
    ds_read_b128 v[76:79], v225 offset:51200
    v_lshlrev_b32_e64 v30, 16, v7
    v_and_b32 v31, 0xffff0000, v7
    v_mfma_f32_16x16x32_bf16 v[200:203], a[72:75], v[80:83], v[200:203]
    ds_read_b64_tr_b16 a[112:113], v228 offset:4096
    v_lshlrev_b32_e64 v32, 16, v8
    v_mfma_f32_16x16x32_bf16 v[200:203], a[88:91], v[84:87], v[200:203]
    ds_read_b64_tr_b16 a[114:115], v228 offset:4608
    v_and_b32 v33, 0xffff0000, v8
    v_mfma_f32_16x16x32_bf16 v[204:207], a[76:79], v[80:83], v[204:207]
    ds_read_b64_tr_b16 a[116:117], v229 offset:4096
    v_lshlrev_b32_e64 v34, 16, v9
    v_mfma_f32_16x16x32_bf16 v[204:207], a[92:95], v[84:87], v[204:207]
    ds_read_b64_tr_b16 a[118:119], v229 offset:4608
    v_and_b32 v35, 0xffff0000, v9
    v_mfma_f32_16x16x32_bf16 v[208:211], a[64:67], v[88:91], v[208:211]
    ds_read_b64_tr_b16 a[120:121], v230 offset:4096
    s_add_u32 m0, s34, 32768
    s_add_u32 s37, s86, 0
    buffer_load_dwordx4 v232, s[44:47], s37 offen lds
    v_mfma_f32_16x16x32_bf16 v[208:211], a[80:83], v[92:95], v[208:211]
    ds_read_b64_tr_b16 a[122:123], v230 offset:4608
    v_lshlrev_b32 v36, 16, v10
    v_mfma_f32_16x16x32_bf16 v[212:215], a[68:71], v[88:91], v[212:215]
    ds_read_b64_tr_b16 a[124:125], v231 offset:4096
    v_and_b32 v37, 0xffff0000, v10
    v_lshlrev_b32_e64 v38, 16, v11
    v_mfma_f32_16x16x32_bf16 v[212:215], a[84:87], v[92:95], v[212:215]
    ds_read_b64_tr_b16 a[126:127], v231 offset:4608
    v_and_b32 v39, 0xffff0000, v11
    v_mfma_f32_16x16x32_bf16 v[216:219], a[72:75], v[88:91], v[216:219]
    buffer_load_dwordx4 v233, s[44:47], s37 offen offset:1024 lds
    v_lshlrev_b32_e64 v40, 16, v12
    v_mfma_f32_16x16x32_bf16 v[216:219], a[88:91], v[92:95], v[216:219]
    v_and_b32 v41, 0xffff0000, v12
    v_lshlrev_b32_e64 v42, 16, v13
    v_mfma_f32_16x16x32_bf16 v[220:223], a[76:79], v[88:91], v[220:223]
    v_and_b32 v43, 0xffff0000, v13
    v_lshlrev_b32_e64 v44, 16, v14
    v_and_b32 v45, 0xffff0000, v14
    v_mfma_f32_16x16x32_bf16 v[220:223], a[92:95], v[92:95], v[220:223]
    v_lshlrev_b32 v46, 16, v15
    s_waitcnt lgkmcnt(0)
    v_mfma_f32_16x16x32_bf16 v[96:99], a[96:99], v[64:67], v[96:99]
    ds_read_b128 v[80:83], v224 offset:53248
    v_and_b32 v47, 0xffff0000, v15
    v_mfma_f32_16x16x32_bf16 v[96:99], a[112:115], v[68:71], v[96:99]
    ds_read_b128 v[84:87], v225 offset:53248
    v_add_f32_e64 v52, v16, v20
    v_mfma_f32_16x16x32_bf16 v[100:103], a[100:103], v[64:67], v[100:103]
    ds_read_b128 v[88:91], v224 offset:55296
    v_add_f32_e64 v53, v17, v21
    v_mfma_f32_16x16x32_bf16 v[100:103], a[116:119], v[68:71], v[100:103]
    ds_read_b128 v[92:95], v225 offset:55296
    v_add_f32 v54, v18, v22
    v_add_f32 v55, v19, v23
    v_mfma_f32_16x16x32_bf16 v[104:107], a[104:107], v[64:67], v[104:107]
    v_add_f32 v52, v52, v24
    v_add_f32 v53, v53, v25
    v_mfma_f32_16x16x32_bf16 v[104:107], a[120:123], v[68:71], v[104:107]
    v_add_f32 v54, v54, v26
    v_add_f32 v55, v55, v27
    v_mfma_f32_16x16x32_bf16 v[108:111], a[108:111], v[64:67], v[108:111]
    v_add_f32 v52, v52, v28
    v_add_f32 v53, v53, v29
    v_add_f32_e64 v54, v54, v30
    v_mfma_f32_16x16x32_bf16 v[108:111], a[124:127], v[68:71], v[108:111]
    v_add_f32 v55, v55, v31
    v_add_f32 v52, v52, v32
    v_mfma_f32_16x16x32_bf16 v[112:115], a[96:99], v[72:75], v[112:115]
    s_add_u32 m0, s35, 20480
    s_add_u32 s33, s33, 131072
    buffer_load_dwordx4 v234, s[48:51], s33 offen lds
    v_mfma_f32_16x16x32_bf16 v[112:115], a[112:115], v[76:79], v[112:115]
    v_add_f32 v53, v53, v33
    v_add_f32 v54, v54, v34
    v_mfma_f32_16x16x32_bf16 v[116:119], a[100:103], v[72:75], v[116:119]
    buffer_load_dwordx4 v235, s[48:51], s33 offen offset:1024 lds
    v_add_f32 v55, v55, v35
    v_add_f32 v52, v52, v36
    v_mfma_f32_16x16x32_bf16 v[116:119], a[116:119], v[76:79], v[116:119]
    v_add_f32 v53, v53, v37
    v_add_f32 v54, v54, v38
    v_mfma_f32_16x16x32_bf16 v[120:123], a[104:107], v[72:75], v[120:123]
    s_add_u32 m0, s35, 22528
    s_add_u32 s33, s33, 131072
    buffer_load_dwordx4 v234, s[48:51], s33 offen lds
    v_mfma_f32_16x16x32_bf16 v[120:123], a[120:123], v[76:79], v[120:123]
    v_add_f32 v55, v55, v39
    v_add_f32 v52, v52, v40
    v_mfma_f32_16x16x32_bf16 v[124:127], a[108:111], v[72:75], v[124:127]
    buffer_load_dwordx4 v235, s[48:51], s33 offen offset:1024 lds
    v_add_f32 v53, v53, v41
    v_add_f32 v54, v54, v42
    v_mfma_f32_16x16x32_bf16 v[124:127], a[124:127], v[76:79], v[124:127]
    v_add_f32 v55, v55, v43
    s_waitcnt lgkmcnt(0)
    v_mfma_f32_16x16x32_bf16 v[128:131], a[96:99], v[80:83], v[128:131]
    ds_read_b128 v[64:67], v224 offset:57344
    v_add_f32_e64 v52, v52, v44
    v_mfma_f32_16x16x32_bf16 v[128:131], a[112:115], v[84:87], v[128:131]
    ds_read_b128 v[68:71], v225 offset:57344
    v_add_f32_e64 v53, v53, v45
    v_mfma_f32_16x16x32_bf16 v[132:135], a[100:103], v[80:83], v[132:135]
    ds_read_b128 v[72:75], v224 offset:59392
    v_add_f32_e64 v54, v54, v46
    v_mfma_f32_16x16x32_bf16 v[132:135], a[116:119], v[84:87], v[132:135]
    ds_read_b128 v[76:79], v225 offset:59392
    v_add_f32 v55, v55, v47
    v_add_f32 v52, v52, v53
    v_mfma_f32_16x16x32_bf16 v[136:139], a[104:107], v[80:83], v[136:139]
    v_add_f32 v54, v54, v55
    v_add_f32 v48, v52, v54
    v_mfma_f32_16x16x32_bf16 v[136:139], a[120:123], v[84:87], v[136:139]
    s_nop 1
    v_add_f32_dpp v48, v48, v48 quad_perm:[1,0,3,2] row_mask:0xf bank_mask:0xf
    v_mfma_f32_16x16x32_bf16 v[140:143], a[108:111], v[80:83], v[140:143]
    s_nop 1
    v_add_f32_dpp v48, v48, v48 quad_perm:[2,3,0,1] row_mask:0xf bank_mask:0xf
    s_nop 1
    v_mfma_f32_16x16x32_bf16 v[140:143], a[124:127], v[84:87], v[140:143]
    v_add_f32_dpp v48, v48, v48 row_half_mirror row_mask:0xf bank_mask:0xf
    s_nop 1
    v_mfma_f32_16x16x32_bf16 v[144:147], a[96:99], v[88:91], v[144:147]
    s_add_u32 m0, s34, 40960
    s_add_u32 s37, s86, 65536
    buffer_load_dwordx4 v232, s[44:47], s37 offen lds
    v_mfma_f32_16x16x32_bf16 v[144:147], a[112:115], v[92:95], v[144:147]
    v_add_f32_dpp v48, v48, v48 row_mirror row_mask:0xf bank_mask:0xf
    s_nop 0
    v_mfma_f32_16x16x32_bf16 v[148:151], a[100:103], v[88:91], v[148:151]
    buffer_load_dwordx4 v233, s[44:47], s37 offen offset:1024 lds
    v_mov_b32_e64 v49, v48
    s_nop 1
    v_mfma_f32_16x16x32_bf16 v[148:151], a[116:119], v[92:95], v[148:151]
    v_permlane16_swap_b32 v48, v49
    s_nop 0
    v_mfma_f32_16x16x32_bf16 v[152:155], a[104:107], v[88:91], v[152:155]
    v_lshlrev_b32_e64 v227, 3, v240
    v_min_u32 v227, 1920, v227
    s_lshl2_add_u32 s25, s2, s3
    v_mfma_f32_16x16x32_bf16 v[152:155], a[120:123], v[92:95], v[152:155]
    v_add_f32 v48, v48, v49
    v_mul_f32 v48, 0x3a800000, v48
    v_mfma_f32_16x16x32_bf16 v[156:159], a[108:111], v[88:91], v[156:159]
    s_lshl_b32 s25, s25, 13
    s_add_u32 s25, s25, 0
    buffer_load_dword v241, v227, s[12:15], s25 offen
    v_mfma_f32_16x16x32_bf16 v[156:159], a[124:127], v[92:95], v[156:159]
    v_sub_f32 v56, v16, v48
    s_waitcnt vmcnt(16) lgkmcnt(0)
    v_mfma_f32_16x16x32_bf16 v[160:163], a[96:99], v[64:67], v[160:163]
    ds_read_b128 v[80:83], v224 offset:61440
    v_mul_f32 v52, v56, v56
    v_sub_f32 v57, v17, v48
    v_mfma_f32_16x16x32_bf16 v[160:163], a[112:115], v[68:71], v[160:163]
    ds_read_b128 v[84:87], v225 offset:61440
    v_mul_f32_e64 v53, v57, v57
    v_mfma_f32_16x16x32_bf16 v[164:167], a[100:103], v[64:67], v[164:167]
    ds_read_b128 v[88:91], v224 offset:63488
    v_sub_f32_e64 v58, v18, v48
    v_mfma_f32_16x16x32_bf16 v[164:167], a[116:119], v[68:71], v[164:167]
    ds_read_b128 v[92:95], v225 offset:63488
    v_mul_f32_e64 v54, v58, v58
    v_mfma_f32_16x16x32_bf16 v[168:171], a[104:107], v[64:67], v[168:171]
    ds_read_b64_tr_b16 a[128:129], v228 offset:8192
    v_sub_f32_e64 v59, v19, v48
    v_mfma_f32_16x16x32_bf16 v[168:171], a[120:123], v[68:71], v[168:171]
    ds_read_b64_tr_b16 a[130:131], v228 offset:8704
    v_mul_f32 v55, v59, v59
    v_sub_f32 v56, v20, v48
    v_mfma_f32_16x16x32_bf16 v[172:175], a[108:111], v[64:67], v[172:175]
    ds_read_b64_tr_b16 a[132:133], v229 offset:8192
    v_fmac_f32_e64 v52, v56, v56
    v_mfma_f32_16x16x32_bf16 v[172:175], a[124:127], v[68:71], v[172:175]
    ds_read_b64_tr_b16 a[134:135], v229 offset:8704
    v_sub_f32_e64 v57, v21, v48
    v_mfma_f32_16x16x32_bf16 v[176:179], a[96:99], v[72:75], v[176:179]
    ds_read_b64_tr_b16 a[136:137], v230 offset:8192
    s_add_u32 m0, s35, 0
    s_and_b32 s33, s86, 1023
    s_lshl_b32 s33, s33, 12
    buffer_load_dwordx4 v234, s[48:51], s33 offen lds
    v_mfma_f32_16x16x32_bf16 v[176:179], a[112:115], v[76:79], v[176:179]
    ds_read_b64_tr_b16 a[138:139], v230 offset:8704
    v_fmac_f32_e64 v53, v57, v57
    v_mfma_f32_16x16x32_bf16 v[180:183], a[100:103], v[72:75], v[180:183]
    ds_read_b64_tr_b16 a[140:141], v231 offset:8192
    buffer_load_dwordx4 v235, s[48:51], s33 offen offset:1024 lds
    v_mfma_f32_16x16x32_bf16 v[180:183], a[116:119], v[76:79], v[180:183]
    ds_read_b64_tr_b16 a[142:143], v231 offset:8704
    v_sub_f32_e64 v58, v22, v48
    v_mfma_f32_16x16x32_bf16 v[184:187], a[104:107], v[72:75], v[184:187]
    s_add_u32 m0, s35, 2048
    s_add_u32 s33, s33, 131072
    buffer_load_dwordx4 v234, s[48:51], s33 offen lds
    v_mfma_f32_16x16x32_bf16 v[184:187], a[120:123], v[76:79], v[184:187]
    v_fmac_f32 v54, v58, v58
    v_sub_f32 v59, v23, v48
    v_fmac_f32_e64 v55, v59, v59
    v_mfma_f32_16x16x32_bf16 v[188:191], a[108:111], v[72:75], v[188:191]
    buffer_load_dwordx4 v235, s[48:51], s33 offen offset:1024 lds
    v_sub_f32_e64 v56, v24, v48
    v_mfma_f32_16x16x32_bf16 v[188:191], a[124:127], v[76:79], v[188:191]
    s_waitcnt vmcnt(30) lgkmcnt(0)
    s_barrier
    v_mfma_f32_16x16x32_bf16 v[192:195], a[96:99], v[80:83], v[192:195]
    ds_read_b128 v[64:67], v224 offset:0
    v_fmac_f32_e64 v52, v56, v56
    v_mfma_f32_16x16x32_bf16 v[192:195], a[112:115], v[84:87], v[192:195]
    ds_read_b128 v[68:71], v225 offset:0
    v_sub_f32_e64 v57, v25, v48
    v_mfma_f32_16x16x32_bf16 v[196:199], a[100:103], v[80:83], v[196:199]
    ds_read_b128 v[72:75], v224 offset:2048
    v_fmac_f32_e64 v53, v57, v57
    v_mfma_f32_16x16x32_bf16 v[196:199], a[116:119], v[84:87], v[196:199]
    ds_read_b128 v[76:79], v225 offset:2048
    v_sub_f32 v58, v26, v48
    v_fmac_f32 v54, v58, v58
    v_mfma_f32_16x16x32_bf16 v[200:203], a[104:107], v[80:83], v[200:203]
    ds_read_b64_tr_b16 a[144:145], v228 offset:12288
    v_sub_f32_e64 v59, v27, v48
    v_mfma_f32_16x16x32_bf16 v[200:203], a[120:123], v[84:87], v[200:203]
    ds_read_b64_tr_b16 a[146:147], v228 offset:12800
    v_fmac_f32_e64 v55, v59, v59
    v_mfma_f32_16x16x32_bf16 v[204:207], a[108:111], v[80:83], v[204:207]
    ds_read_b64_tr_b16 a[148:149], v229 offset:12288
    v_sub_f32_e64 v56, v28, v48
    v_mfma_f32_16x16x32_bf16 v[204:207], a[124:127], v[84:87], v[204:207]
    ds_read_b64_tr_b16 a[150:151], v229 offset:12800
    v_fmac_f32_e64 v52, v56, v56
    v_mfma_f32_16x16x32_bf16 v[208:211], a[96:99], v[88:91], v[208:211]
    ds_read_b64_tr_b16 a[152:153], v230 offset:12288
    s_add_u32 m0, s34, 49152
    s_add_u32 s37, s87, 0
    buffer_load_dwordx4 v232, s[44:47], s37 offen lds
    v_mfma_f32_16x16x32_bf16 v[208:211], a[112:115], v[92:95], v[208:211]
    ds_read_b64_tr_b16 a[154:155], v230 offset:12800
    v_sub_f32 v57, v29, v48
    v_mfma_f32_16x16x32_bf16 v[212:215], a[100:103], v[88:91], v[212:215]
    ds_read_b64_tr_b16 a[156:157], v231 offset:12288
    v_fmac_f32 v53, v57, v57
    v_sub_f32 v58, v30, v48
    v_mfma_f32_16x16x32_bf16 v[212:215], a[116:119], v[92:95], v[212:215]
    ds_read_b64_tr_b16 a[158:159], v231 offset:12800
    v_fmac_f32_e64 v54, v58, v58
    v_mfma_f32_16x16x32_bf16 v[216:219], a[104:107], v[88:91], v[216:219]
    buffer_load_dwordx4 v233, s[44:47], s37 offen offset:1024 lds
    v_sub_f32_e64 v59, v31, v48
    v_mfma_f32_16x16x32_bf16 v[216:219], a[120:123], v[92:95], v[216:219]
    v_fmac_f32 v55, v59, v59
    v_sub_f32 v56, v32, v48
    v_mfma_f32_16x16x32_bf16 v[220:223], a[108:111], v[88:91], v[220:223]
    v_fmac_f32 v52, v56, v56
    v_sub_f32 v57, v33, v48
    v_fmac_f32_e64 v53, v57, v57
    v_mfma_f32_16x16x32_bf16 v[220:223], a[124:127], v[92:95], v[220:223]
    v_sub_f32 v58, v34, v48
    s_waitcnt lgkmcnt(0)
    v_mfma_f32_16x16x32_bf16 v[96:99], a[128:131], v[64:67], v[96:99]
    ds_read_b128 v[80:83], v224 offset:4096
    v_fmac_f32_e64 v54, v58, v58
    v_mfma_f32_16x16x32_bf16 v[96:99], a[144:147], v[68:71], v[96:99]
    ds_read_b128 v[84:87], v225 offset:4096
    v_sub_f32_e64 v59, v35, v48
    v_mfma_f32_16x16x32_bf16 v[100:103], a[132:135], v[64:67], v[100:103]
    ds_read_b128 v[88:91], v224 offset:6144
    v_fmac_f32_e64 v55, v59, v59
    v_mfma_f32_16x16x32_bf16 v[100:103], a[148:151], v[68:71], v[100:103]
    ds_read_b128 v[92:95], v225 offset:6144
    v_sub_f32 v56, v36, v48
    v_fmac_f32 v52, v56, v56
    v_mfma_f32_16x16x32_bf16 v[104:107], a[136:139], v[64:67], v[104:107]
    v_sub_f32 v57, v37, v48
    v_fmac_f32 v53, v57, v57
    v_mfma_f32_16x16x32_bf16 v[104:107], a[152:155], v[68:71], v[104:107]
    v_sub_f32 v58, v38, v48
    v_fmac_f32 v54, v58, v58
    v_mfma_f32_16x16x32_bf16 v[108:111], a[140:143], v[64:67], v[108:111]
    v_sub_f32 v59, v39, v48
    v_fmac_f32 v55, v59, v59
    v_sub_f32_e64 v56, v40, v48
    v_mfma_f32_16x16x32_bf16 v[108:111], a[156:159], v[68:71], v[108:111]
    v_fmac_f32 v52, v56, v56
    v_sub_f32 v57, v41, v48
    v_mfma_f32_16x16x32_bf16 v[112:115], a[128:131], v[72:75], v[112:115]
    s_add_u32 m0, s35, 4096
    s_add_u32 s33, s33, 131072
    buffer_load_dwordx4 v234, s[48:51], s33 offen lds
    v_mfma_f32_16x16x32_bf16 v[112:115], a[144:147], v[76:79], v[112:115]
    v_fmac_f32 v53, v57, v57
    v_sub_f32 v58, v42, v48
    v_mfma_f32_16x16x32_bf16 v[116:119], a[132:135], v[72:75], v[116:119]
    buffer_load_dwordx4 v235, s[48:51], s33 offen offset:1024 lds
    v_fmac_f32 v54, v58, v58
    v_sub_f32 v59, v43, v48
    v_mfma_f32_16x16x32_bf16 v[116:119], a[148:151], v[76:79], v[116:119]
    v_fmac_f32 v55, v59, v59
    v_sub_f32 v56, v44, v48
    v_mfma_f32_16x16x32_bf16 v[120:123], a[136:139], v[72:75], v[120:123]
    s_add_u32 m0, s35, 6144
    s_add_u32 s33, s33, 131072
    buffer_load_dwordx4 v234, s[48:51], s33 offen lds
    v_mfma_f32_16x16x32_bf16 v[120:123], a[152:155], v[76:79], v[120:123]
    v_fmac_f32 v52, v56, v56
    v_sub_f32 v57, v45, v48
    v_mfma_f32_16x16x32_bf16 v[124:127], a[140:143], v[72:75], v[124:127]
    buffer_load_dwordx4 v235, s[48:51], s33 offen offset:1024 lds
    v_fmac_f32 v53, v57, v57
    v_sub_f32 v58, v46, v48
    v_mfma_f32_16x16x32_bf16 v[124:127], a[156:159], v[76:79], v[124:127]
    v_fmac_f32 v54, v58, v58
    s_waitcnt lgkmcnt(0)
    v_mfma_f32_16x16x32_bf16 v[128:131], a[128:131], v[80:83], v[128:131]
    ds_read_b128 v[64:67], v224 offset:8192
    v_sub_f32_e64 v59, v47, v48
    v_mfma_f32_16x16x32_bf16 v[128:131], a[144:147], v[84:87], v[128:131]
    ds_read_b128 v[68:71], v225 offset:8192
    v_fmac_f32_e64 v55, v59, v59
    v_mfma_f32_16x16x32_bf16 v[132:135], a[132:135], v[80:83], v[132:135]
    ds_read_b128 v[72:75], v224 offset:10240
    v_add_f32_e64 v52, v52, v53
    v_mfma_f32_16x16x32_bf16 v[132:135], a[148:151], v[84:87], v[132:135]
    ds_read_b128 v[76:79], v225 offset:10240
    v_add_f32_e64 v54, v54, v55
    v_mfma_f32_16x16x32_bf16 v[136:139], a[136:139], v[80:83], v[136:139]
    v_add_f32 v51, v52, v54
    s_nop 1
    v_add_f32_dpp v51, v51, v51 quad_perm:[1,0,3,2] row_mask:0xf bank_mask:0xf
    v_mfma_f32_16x16x32_bf16 v[136:139], a[152:155], v[84:87], v[136:139]
    s_nop 1
    v_add_f32_dpp v51, v51, v51 quad_perm:[2,3,0,1] row_mask:0xf bank_mask:0xf
    v_mfma_f32_16x16x32_bf16 v[140:143], a[140:143], v[80:83], v[140:143]
    s_nop 1
    v_add_f32_dpp v51, v51, v51 row_half_mirror row_mask:0xf bank_mask:0xf
    s_nop 1
    v_mfma_f32_16x16x32_bf16 v[140:143], a[156:159], v[84:87], v[140:143]
    v_add_f32_dpp v51, v51, v51 row_mirror row_mask:0xf bank_mask:0xf
    s_nop 0
    v_mfma_f32_16x16x32_bf16 v[144:147], a[128:131], v[88:91], v[144:147]
    s_add_u32 m0, s34, 57344
    s_add_u32 s37, s87, 65536
    buffer_load_dwordx4 v232, s[44:47], s37 offen lds
    v_mfma_f32_16x16x32_bf16 v[144:147], a[144:147], v[92:95], v[144:147]
    v_mov_b32 v49, v51
    s_nop 1
    v_mfma_f32_16x16x32_bf16 v[148:151], a[132:135], v[88:91], v[148:151]
    buffer_load_dwordx4 v233, s[44:47], s37 offen offset:1024 lds
    v_permlane16_swap_b32 v51, v49
    s_nop 0
    v_mfma_f32_16x16x32_bf16 v[148:151], a[148:151], v[92:95], v[148:151]
    v_add_f32_e64 v51, v51, v49
    v_mul_f32 v51, 0x3a800000, v51
    v_mfma_f32_16x16x32_bf16 v[152:155], a[136:139], v[88:91], v[152:155]
    v_lshlrev_b32_e64 v227, 3, v240
    v_min_u32 v227, 1920, v227
    s_lshl2_add_u32 s25, s2, s3
    v_mfma_f32_16x16x32_bf16 v[152:155], a[152:155], v[92:95], v[152:155]
    v_cvt_pk_bf16_f32 v50, v48, v51
    v_and_b32 v51, 0xffff0000, v50
    v_mfma_f32_16x16x32_bf16 v[156:159], a[140:143], v[88:91], v[156:159]
    s_lshl_b32 s25, s25, 13
    s_add_u32 s25, s25, 2048
    buffer_load_dword v241, v227, s[12:15], s25 offen
    v_mfma_f32_16x16x32_bf16 v[156:159], a[156:159], v[92:95], v[156:159]
    v_lshlrev_b32 v50, 16, v50
    s_waitcnt vmcnt(16) lgkmcnt(0)
    v_mfma_f32_16x16x32_bf16 v[160:163], a[128:131], v[64:67], v[160:163]
    ds_read_b128 v[80:83], v224 offset:12288
    v_add_f32 v51, 0x3727c5ac, v51
    v_cvt_pk_bf16_f32 v51, v51, v51
    v_mfma_f32_16x16x32_bf16 v[160:163], a[144:147], v[68:71], v[160:163]
    ds_read_b128 v[84:87], v225 offset:12288
    v_lshlrev_b32_e64 v51, 16, v51
    v_mfma_f32_16x16x32_bf16 v[164:167], a[132:135], v[64:67], v[164:167]
    ds_read_b128 v[88:91], v224 offset:14336
    v_mfma_f32_16x16x32_bf16 v[164:167], a[148:151], v[68:71], v[164:167]
    ds_read_b128 v[92:95], v225 offset:14336
    v_sqrt_f32 v51, v51
    v_mfma_f32_16x16x32_bf16 v[168:171], a[136:139], v[64:67], v[168:171]
    ds_read_b64_tr_b16 a[160:161], v228 offset:16384
    s_nop 0
    v_mfma_f32_16x16x32_bf16 v[168:171], a[152:155], v[68:71], v[168:171]
    ds_read_b64_tr_b16 a[162:163], v228 offset:16896
    v_cvt_pk_bf16_f32 v51, v51, v51
    v_lshlrev_b32_e64 v51, 16, v51
    v_mfma_f32_16x16x32_bf16 v[172:175], a[140:143], v[64:67], v[172:175]
    ds_read_b64_tr_b16 a[164:165], v229 offset:16384
    v_mfma_f32_16x16x32_bf16 v[172:175], a[156:159], v[68:71], v[172:175]
    ds_read_b64_tr_b16 a[166:167], v229 offset:16896
    v_rcp_f32_e64 v51, v51
    v_mfma_f32_16x16x32_bf16 v[176:179], a[128:131], v[72:75], v[176:179]
    ds_read_b64_tr_b16 a[168:169], v230 offset:16384
    s_add_u32 m0, s35, 8192
    s_and_b32 s33, s87, 1023
    s_lshl_b32 s33, s33, 12
    buffer_load_dwordx4 v234, s[48:51], s33 offen lds
    v_mfma_f32_16x16x32_bf16 v[176:179], a[144:147], v[76:79], v[176:179]
    ds_read_b64_tr_b16 a[170:171], v230 offset:16896
    s_nop 0
    v_mfma_f32_16x16x32_bf16 v[180:183], a[132:135], v[72:75], v[180:183]
    ds_read_b64_tr_b16 a[172:173], v231 offset:16384
    buffer_load_dwordx4 v235, s[48:51], s33 offen offset:1024 lds
    v_mfma_f32_16x16x32_bf16 v[180:183], a[148:151], v[76:79], v[180:183]
    ds_read_b64_tr_b16 a[174:175], v231 offset:16896
    v_mul_f32 v51, 0x3e0293ee, v51
    v_mfma_f32_16x16x32_bf16 v[184:187], a[136:139], v[72:75], v[184:187]
    s_add_u32 m0, s35, 10240
    s_add_u32 s33, s33, 131072
    buffer_load_dwordx4 v234, s[48:51], s33 offen lds
    v_mfma_f32_16x16x32_bf16 v[184:187], a[152:155], v[76:79], v[184:187]
    v_sub_f32 v16, v16, v50
    v_sub_f32 v17, v17, v50
    v_cvt_pk_bf16_f32 v17, v16, v17
    v_mfma_f32_16x16x32_bf16 v[188:191], a[140:143], v[72:75], v[188:191]
    buffer_load_dwordx4 v235, s[48:51], s33 offen offset:1024 lds
    v_lshlrev_b32_e64 v16, 16, v17
    v_mfma_f32_16x16x32_bf16 v[188:191], a[156:159], v[76:79], v[188:191]
    s_waitcnt vmcnt(31) lgkmcnt(0)
    s_barrier
    v_mfma_f32_16x16x32_bf16 v[192:195], a[128:131], v[80:83], v[192:195]
    ds_read_b128 v[64:67], v224 offset:16384
    v_and_b32 v17, 0xffff0000, v17
    v_mfma_f32_16x16x32_bf16 v[192:195], a[144:147], v[84:87], v[192:195]
    ds_read_b128 v[68:71], v225 offset:16384
    v_mul_f32_e64 v16, v16, v51
    v_mfma_f32_16x16x32_bf16 v[196:199], a[132:135], v[80:83], v[196:199]
    ds_read_b128 v[72:75], v224 offset:18432
    v_mul_f32_e64 v17, v17, v51
    v_mfma_f32_16x16x32_bf16 v[196:199], a[148:151], v[84:87], v[196:199]
    ds_read_b128 v[76:79], v225 offset:18432
    v_cvt_pk_bf16_f32 v0, v16, v17
    v_sub_f32_e64 v18, v18, v50
    v_mfma_f32_16x16x32_bf16 v[200:203], a[136:139], v[80:83], v[200:203]
    ds_read_b64_tr_b16 a[176:177], v228 offset:20480
    v_sub_f32_e64 v19, v19, v50
    v_mfma_f32_16x16x32_bf16 v[200:203], a[152:155], v[84:87], v[200:203]
    ds_read_b64_tr_b16 a[178:179], v228 offset:20992
    v_cvt_pk_bf16_f32 v19, v18, v19
    v_mfma_f32_16x16x32_bf16 v[204:207], a[140:143], v[80:83], v[204:207]
    ds_read_b64_tr_b16 a[180:181], v229 offset:20480
    v_lshlrev_b32_e64 v18, 16, v19
    v_mfma_f32_16x16x32_bf16 v[204:207], a[156:159], v[84:87], v[204:207]
    ds_read_b64_tr_b16 a[182:183], v229 offset:20992
    v_and_b32 v19, 0xffff0000, v19
    v_mfma_f32_16x16x32_bf16 v[208:211], a[128:131], v[88:91], v[208:211]
    ds_read_b64_tr_b16 a[184:185], v230 offset:20480
    s_add_u32 m0, s34, 0
    s_add_u32 s37, s80, 131072
    buffer_load_dwordx4 v232, s[44:47], s37 offen lds
    v_mfma_f32_16x16x32_bf16 v[208:211], a[144:147], v[92:95], v[208:211]
    ds_read_b64_tr_b16 a[186:187], v230 offset:20992
    v_mul_f32 v18, v18, v51
    v_mfma_f32_16x16x32_bf16 v[212:215], a[132:135], v[88:91], v[212:215]
    ds_read_b64_tr_b16 a[188:189], v231 offset:20480
    v_mul_f32_e64 v19, v19, v51
    v_cvt_pk_bf16_f32 v1, v18, v19
    v_mfma_f32_16x16x32_bf16 v[212:215], a[148:151], v[92:95], v[212:215]
    ds_read_b64_tr_b16 a[190:191], v231 offset:20992
    v_sub_f32_e64 v20, v20, v50
    v_mfma_f32_16x16x32_bf16 v[216:219], a[136:139], v[88:91], v[216:219]
    buffer_load_dwordx4 v233, s[44:47], s37 offen offset:1024 lds
    v_sub_f32_e64 v21, v21, v50
    v_mfma_f32_16x16x32_bf16 v[216:219], a[152:155], v[92:95], v[216:219]
    v_cvt_pk_bf16_f32 v21, v20, v21
    v_lshlrev_b32_e64 v20, 16, v21
    v_mfma_f32_16x16x32_bf16 v[220:223], a[140:143], v[88:91], v[220:223]
    v_and_b32 v21, 0xffff0000, v21
    v_mul_f32 v20, v20, v51
    v_mul_f32 v21, v21, v51
    v_mfma_f32_16x16x32_bf16 v[220:223], a[156:159], v[92:95], v[220:223]
    v_cvt_pk_bf16_f32 v2, v20, v21
    s_waitcnt lgkmcnt(0)
    v_mfma_f32_16x16x32_bf16 v[96:99], a[160:163], v[64:67], v[96:99]
    ds_read_b128 v[80:83], v224 offset:20480
    v_sub_f32 v22, v22, v50
    v_mfma_f32_16x16x32_bf16 v[96:99], a[176:179], v[68:71], v[96:99]
    ds_read_b128 v[84:87], v225 offset:20480
    v_sub_f32_e64 v23, v23, v50
    v_mfma_f32_16x16x32_bf16 v[100:103], a[164:167], v[64:67], v[100:103]
    ds_read_b128 v[88:91], v224 offset:22528
    v_cvt_pk_bf16_f32 v23, v22, v23
    v_mfma_f32_16x16x32_bf16 v[100:103], a[180:183], v[68:71], v[100:103]
    ds_read_b128 v[92:95], v225 offset:22528
    v_lshlrev_b32_e64 v22, 16, v23
    v_and_b32 v23, 0xffff0000, v23
    v_mfma_f32_16x16x32_bf16 v[104:107], a[168:171], v[64:67], v[104:107]
    v_mul_f32 v22, v22, v51
    v_mul_f32 v23, v23, v51
    v_mfma_f32_16x16x32_bf16 v[104:107], a[184:187], v[68:71], v[104:107]
    v_cvt_pk_bf16_f32 v3, v22, v23
    v_sub_f32_e64 v24, v24, v50
    v_mfma_f32_16x16x32_bf16 v[108:111], a[172:175], v[64:67], v[108:111]
    v_sub_f32_e64 v25, v25, v50
    v_cvt_pk_bf16_f32 v25, v24, v25
    v_lshlrev_b32_e64 v24, 16, v25
    v_mfma_f32_16x16x32_bf16 v[108:111], a[188:191], v[68:71], v[108:111]
    v_and_b32 v25, 0xffff0000, v25
    v_mul_f32_e64 v24, v24, v51
    v_mfma_f32_16x16x32_bf16 v[112:115], a[160:163], v[72:75], v[112:115]
    s_add_u32 m0, s35, 12288
    s_add_u32 s33, s33, 131072
    buffer_load_dwordx4 v234, s[48:51], s33 offen lds
    v_mfma_f32_16x16x32_bf16 v[112:115], a[176:179], v[76:79], v[112:115]
    v_mul_f32_e64 v25, v25, v51
    v_cvt_pk_bf16_f32 v4, v24, v25
    v_mfma_f32_16x16x32_bf16 v[116:119], a[164:167], v[72:75], v[116:119]
    buffer_load_dwordx4 v235, s[48:51], s33 offen offset:1024 lds
    v_sub_f32 v26, v26, v50
    v_sub_f32 v27, v27, v50
    v_mfma_f32_16x16x32_bf16 v[116:119], a[180:183], v[76:79], v[116:119]
    v_cvt_pk_bf16_f32 v27, v26, v27
    v_lshlrev_b32_e64 v26, 16, v27
    v_mfma_f32_16x16x32_bf16 v[120:123], a[168:171], v[72:75], v[120:123]
    s_add_u32 m0, s35, 14336
    s_add_u32 s33, s33, 131072
    buffer_load_dwordx4 v234, s[48:51], s33 offen lds
    v_mfma_f32_16x16x32_bf16 v[120:123], a[184:187], v[76:79], v[120:123]
    v_and_b32 v27, 0xffff0000, v27
    v_mul_f32_e64 v26, v26, v51
    v_mfma_f32_16x16x32_bf16 v[124:127], a[172:175], v[72:75], v[124:127]
    buffer_load_dwordx4 v235, s[48:51], s33 offen offset:1024 lds
    v_mul_f32_e64 v27, v27, v51
    v_cvt_pk_bf16_f32 v5, v26, v27
    v_mfma_f32_16x16x32_bf16 v[124:127], a[188:191], v[76:79], v[124:127]
    v_sub_f32 v28, v28, v50
    s_waitcnt lgkmcnt(0)
    v_mfma_f32_16x16x32_bf16 v[128:131], a[160:163], v[80:83], v[128:131]
    ds_read_b128 v[64:67], v224 offset:24576
    v_sub_f32_e64 v29, v29, v50
    v_mfma_f32_16x16x32_bf16 v[128:131], a[176:179], v[84:87], v[128:131]
    ds_read_b128 v[68:71], v225 offset:24576
    v_cvt_pk_bf16_f32 v29, v28, v29
    v_mfma_f32_16x16x32_bf16 v[132:135], a[164:167], v[80:83], v[132:135]
    ds_read_b128 v[72:75], v224 offset:26624
    v_lshlrev_b32_e64 v28, 16, v29
    v_mfma_f32_16x16x32_bf16 v[132:135], a[180:183], v[84:87], v[132:135]
    ds_read_b128 v[76:79], v225 offset:26624
    v_and_b32 v29, 0xffff0000, v29
    v_mfma_f32_16x16x32_bf16 v[136:139], a[168:171], v[80:83], v[136:139]
    v_mul_f32 v28, v28, v51
    v_mul_f32 v29, v29, v51
    v_cvt_pk_bf16_f32 v6, v28, v29
    v_mfma_f32_16x16x32_bf16 v[136:139], a[184:187], v[84:87], v[136:139]
    v_sub_f32 v30, v30, v50
    v_sub_f32 v31, v31, v50
    v_mfma_f32_16x16x32_bf16 v[140:143], a[172:175], v[80:83], v[140:143]
    v_cvt_pk_bf16_f32 v31, v30, v31
    v_lshlrev_b32_e64 v30, 16, v31
    v_and_b32 v31, 0xffff0000, v31
    v_mfma_f32_16x16x32_bf16 v[140:143], a[188:191], v[84:87], v[140:143]
    v_mul_f32 v30, v30, v51
    v_mul_f32 v31, v31, v51
    v_mfma_f32_16x16x32_bf16 v[144:147], a[160:163], v[88:91], v[144:147]
    s_add_u32 m0, s34, 8192
    s_add_u32 s37, s81, 131072
    buffer_load_dwordx4 v232, s[44:47], s37 offen lds
    v_mfma_f32_16x16x32_bf16 v[144:147], a[176:179], v[92:95], v[144:147]
    v_cvt_pk_bf16_f32 v7, v30, v31
    v_sub_f32_e64 v32, v32, v50
    v_mfma_f32_16x16x32_bf16 v[148:151], a[164:167], v[88:91], v[148:151]
    buffer_load_dwordx4 v233, s[44:47], s37 offen offset:1024 lds
    v_sub_f32_e64 v33, v33, v50
    v_mfma_f32_16x16x32_bf16 v[148:151], a[180:183], v[92:95], v[148:151]
    v_cvt_pk_bf16_f32 v33, v32, v33
    v_lshlrev_b32_e64 v32, 16, v33
    v_and_b32 v33, 0xffff0000, v33
    v_mfma_f32_16x16x32_bf16 v[152:155], a[168:171], v[88:91], v[152:155]
    v_lshlrev_b32_e64 v227, 3, v240
    v_min_u32 v227, 1920, v227
    s_lshl2_add_u32 s25, s2, s3
    v_mfma_f32_16x16x32_bf16 v[152:155], a[184:187], v[92:95], v[152:155]
    v_mul_f32 v32, v32, v51
    v_mul_f32_e64 v33, v33, v51
    v_mfma_f32_16x16x32_bf16 v[156:159], a[172:175], v[88:91], v[156:159]
    s_lshl_b32 s25, s25, 13
    s_add_u32 s25, s25, 4096
    buffer_load_dword v241, v227, s[12:15], s25 offen
    v_mfma_f32_16x16x32_bf16 v[156:159], a[188:191], v[92:95], v[156:159]
    v_cvt_pk_bf16_f32 v8, v32, v33
    s_waitcnt vmcnt(16) lgkmcnt(0)
    v_mfma_f32_16x16x32_bf16 v[160:163], a[160:163], v[64:67], v[160:163]
    ds_read_b128 v[80:83], v224 offset:28672
    v_sub_f32 v34, v34, v50
    v_sub_f32 v35, v35, v50
    v_mfma_f32_16x16x32_bf16 v[160:163], a[176:179], v[68:71], v[160:163]
    ds_read_b128 v[84:87], v225 offset:28672
    v_cvt_pk_bf16_f32 v35, v34, v35
    v_mfma_f32_16x16x32_bf16 v[164:167], a[164:167], v[64:67], v[164:167]
    ds_read_b128 v[88:91], v224 offset:30720
    v_lshlrev_b32_e64 v34, 16, v35
    v_mfma_f32_16x16x32_bf16 v[164:167], a[180:183], v[68:71], v[164:167]
    ds_read_b128 v[92:95], v225 offset:30720
    v_and_b32 v35, 0xffff0000, v35
    v_mfma_f32_16x16x32_bf16 v[168:171], a[168:171], v[64:67], v[168:171]
    ds_read_b64_tr_b16 a[192:193], v228 offset:0
    v_mul_f32_e64 v34, v34, v51
    v_mfma_f32_16x16x32_bf16 v[168:171], a[184:187], v[68:71], v[168:171]
    ds_read_b64_tr_b16 a[194:195], v228 offset:512
    v_mul_f32_e64 v35, v35, v51
    v_cvt_pk_bf16_f32 v9, v34, v35
    v_mfma_f32_16x16x32_bf16 v[172:175], a[172:175], v[64:67], v[172:175]
    ds_read_b64_tr_b16 a[196:197], v229 offset:0
    v_sub_f32_e64 v36, v36, v50
    v_mfma_f32_16x16x32_bf16 v[172:175], a[188:191], v[68:71], v[172:175]
    ds_read_b64_tr_b16 a[198:199], v229 offset:512
    v_sub_f32_e64 v37, v37, v50
    v_mfma_f32_16x16x32_bf16 v[176:179], a[160:163], v[72:75], v[176:179]
    ds_read_b64_tr_b16 a[200:201], v230 offset:0
    v_cvt_pk_bf16_f32 v37, v36, v37
    v_mfma_f32_16x16x32_bf16 v[176:179], a[176:179], v[76:79], v[176:179]
    ds_read_b64_tr_b16 a[202:203], v230 offset:512
    v_lshlrev_b32_e64 v36, 16, v37
    v_mfma_f32_16x16x32_bf16 v[180:183], a[164:167], v[72:75], v[180:183]
    ds_read_b64_tr_b16 a[204:205], v231 offset:0
    v_and_b32 v37, 0xffff0000, v37
    v_mfma_f32_16x16x32_bf16 v[180:183], a[180:183], v[76:79], v[180:183]
    ds_read_b64_tr_b16 a[206:207], v231 offset:512
    v_mul_f32 v36, v36, v51
    v_mul_f32 v37, v37, v51
    v_mfma_f32_16x16x32_bf16 v[184:187], a[168:171], v[72:75], v[184:187]
    v_cvt_pk_bf16_f32 v10, v36, v37
    v_sub_f32_e64 v38, v38, v50
    v_mfma_f32_16x16x32_bf16 v[184:187], a[184:187], v[76:79], v[184:187]
    v_sub_f32_e64 v39, v39, v50
    v_cvt_pk_bf16_f32 v39, v38, v39
    v_mfma_f32_16x16x32_bf16 v[188:191], a[172:175], v[72:75], v[188:191]
    v_lshlrev_b32_e64 v38, 16, v39
    v_and_b32 v39, 0xffff0000, v39
    v_mul_f32_e64 v38, v38, v51
    v_mfma_f32_16x16x32_bf16 v[188:191], a[188:191], v[76:79], v[188:191]
    s_waitcnt vmcnt(27) lgkmcnt(0)
    s_barrier
    v_mfma_f32_16x16x32_bf16 v[192:195], a[160:163], v[80:83], v[192:195]
    ds_read_b128 v[64:67], v224 offset:32768
    v_mul_f32_e64 v39, v39, v51
    v_mfma_f32_16x16x32_bf16 v[192:195], a[176:179], v[84:87], v[192:195]
    ds_read_b128 v[68:71], v225 offset:32768
    v_cvt_pk_bf16_f32 v11, v38, v39
    v_mfma_f32_16x16x32_bf16 v[196:199], a[164:167], v[80:83], v[196:199]
    ds_read_b128 v[72:75], v224 offset:34816
    v_sub_f32_e64 v40, v40, v50
    v_mfma_f32_16x16x32_bf16 v[196:199], a[180:183], v[84:87], v[196:199]
    ds_read_b128 v[76:79], v225 offset:34816
    v_sub_f32_e64 v41, v41, v50
    v_mfma_f32_16x16x32_bf16 v[200:203], a[168:171], v[80:83], v[200:203]
    ds_read_b64_tr_b16 a[208:209], v228 offset:4096
    v_cvt_pk_bf16_f32 v41, v40, v41
    v_lshlrev_b32_e64 v40, 16, v41
    v_mfma_f32_16x16x32_bf16 v[200:203], a[184:187], v[84:87], v[200:203]
    ds_read_b64_tr_b16 a[210:211], v228 offset:4608
    v_and_b32 v41, 0xffff0000, v41
    v_mfma_f32_16x16x32_bf16 v[204:207], a[172:175], v[80:83], v[204:207]
    ds_read_b64_tr_b16 a[212:213], v229 offset:4096
    v_mul_f32_e64 v40, v40, v51
    v_mfma_f32_16x16x32_bf16 v[204:207], a[188:191], v[84:87], v[204:207]
    ds_read_b64_tr_b16 a[214:215], v229 offset:4608
    v_mul_f32_e64 v41, v41, v51
    v_mfma_f32_16x16x32_bf16 v[208:211], a[160:163], v[88:91], v[208:211]
    ds_read_b64_tr_b16 a[216:217], v230 offset:4096
    s_add_u32 m0, s34, 16384
    s_add_u32 s37, s82, 131072
    buffer_load_dwordx4 v232, s[44:47], s37 offen lds
    v_mfma_f32_16x16x32_bf16 v[208:211], a[176:179], v[92:95], v[208:211]
    ds_read_b64_tr_b16 a[218:219], v230 offset:4608
    v_cvt_pk_bf16_f32 v12, v40, v41
    v_mfma_f32_16x16x32_bf16 v[212:215], a[164:167], v[88:91], v[212:215]
    ds_read_b64_tr_b16 a[220:221], v231 offset:4096
    v_sub_f32 v42, v42, v50
    v_sub_f32 v43, v43, v50
    v_mfma_f32_16x16x32_bf16 v[212:215], a[180:183], v[92:95], v[212:215]
    ds_read_b64_tr_b16 a[222:223], v231 offset:4608
    v_cvt_pk_bf16_f32 v43, v42, v43
    v_mfma_f32_16x16x32_bf16 v[216:219], a[168:171], v[88:91], v[216:219]
    buffer_load_dwordx4 v233, s[44:47], s37 offen offset:1024 lds
    v_lshlrev_b32_e64 v42, 16, v43
    v_mfma_f32_16x16x32_bf16 v[216:219], a[184:187], v[92:95], v[216:219]
    v_and_b32 v43, 0xffff0000, v43
    v_mul_f32_e64 v42, v42, v51
    v_mfma_f32_16x16x32_bf16 v[220:223], a[172:175], v[88:91], v[220:223]
    v_mul_f32_e64 v43, v43, v51
    v_cvt_pk_bf16_f32 v13, v42, v43
    v_sub_f32_e64 v44, v44, v50
    v_mfma_f32_16x16x32_bf16 v[220:223], a[188:191], v[92:95], v[220:223]
    v_sub_f32 v45, v45, v50
    s_waitcnt lgkmcnt(0)
    v_mfma_f32_16x16x32_bf16 v[96:99], a[192:195], v[64:67], v[96:99]
    ds_read_b128 v[80:83], v224 offset:36864
    v_cvt_pk_bf16_f32 v45, v44, v45
    v_mfma_f32_16x16x32_bf16 v[96:99], a[208:211], v[68:71], v[96:99]
    ds_read_b128 v[84:87], v225 offset:36864
    v_lshlrev_b32_e64 v44, 16, v45
    v_mfma_f32_16x16x32_bf16 v[100:103], a[196:199], v[64:67], v[100:103]
    ds_read_b128 v[88:91], v224 offset:38912
    v_and_b32 v45, 0xffff0000, v45
    v_mfma_f32_16x16x32_bf16 v[100:103], a[212:215], v[68:71], v[100:103]
    ds_read_b128 v[92:95], v225 offset:38912
    v_mul_f32 v44, v44, v51
    v_mul_f32 v45, v45, v51
    v_mfma_f32_16x16x32_bf16 v[104:107], a[200:203], v[64:67], v[104:107]
    v_cvt_pk_bf16_f32 v14, v44, v45
    v_sub_f32_e64 v46, v46, v50
    v_mfma_f32_16x16x32_bf16 v[104:107], a[216:219], v[68:71], v[104:107]
    v_sub_f32_e64 v47, v47, v50
    v_cvt_pk_bf16_f32 v47, v46, v47
    v_mfma_f32_16x16x32_bf16 v[108:111], a[204:207], v[64:67], v[108:111]
    v_lshlrev_b32_e64 v46, 16, v47
    v_and_b32 v47, 0xffff0000, v47
    v_mul_f32_e64 v46, v46, v51
    v_mfma_f32_16x16x32_bf16 v[108:111], a[220:223], v[68:71], v[108:111]
    v_mul_f32_e64 v47, v47, v51
    v_cvt_pk_bf16_f32 v15, v46, v47
    v_mfma_f32_16x16x32_bf16 v[112:115], a[192:195], v[72:75], v[112:115]
    v_mfma_f32_16x16x32_bf16 v[112:115], a[208:211], v[76:79], v[112:115]
    ds_write_b128 v237, v[0:3] offset:0
    v_mfma_f32_16x16x32_bf16 v[116:119], a[196:199], v[72:75], v[116:119]
    ds_write_b128 v237, v[4:7] offset:4096
    v_mfma_f32_16x16x32_bf16 v[116:119], a[212:215], v[76:79], v[116:119]
    ds_write_b128 v237, v[8:11] offset:24576
    v_mfma_f32_16x16x32_bf16 v[120:123], a[200:203], v[72:75], v[120:123]
    ds_write_b128 v237, v[12:15] offset:28672
    v_mfma_f32_16x16x32_bf16 v[120:123], a[216:219], v[76:79], v[120:123]
    v_mfma_f32_16x16x32_bf16 v[124:127], a[204:207], v[72:75], v[124:127]
    v_mfma_f32_16x16x32_bf16 v[124:127], a[220:223], v[76:79], v[124:127]
    s_waitcnt lgkmcnt(0)
    v_mfma_f32_16x16x32_bf16 v[128:131], a[192:195], v[80:83], v[128:131]
    ds_read_b128 v[64:67], v224 offset:40960
    v_mfma_f32_16x16x32_bf16 v[128:131], a[208:211], v[84:87], v[128:131]
    ds_read_b128 v[68:71], v225 offset:40960
    v_mfma_f32_16x16x32_bf16 v[132:135], a[196:199], v[80:83], v[132:135]
    ds_read_b128 v[72:75], v224 offset:43008
    v_mfma_f32_16x16x32_bf16 v[132:135], a[212:215], v[84:87], v[132:135]
    ds_read_b128 v[76:79], v225 offset:43008
    v_mfma_f32_16x16x32_bf16 v[136:139], a[200:203], v[80:83], v[136:139]
    v_mfma_f32_16x16x32_bf16 v[136:139], a[216:219], v[84:87], v[136:139]
    v_mfma_f32_16x16x32_bf16 v[140:143], a[204:207], v[80:83], v[140:143]
    v_mfma_f32_16x16x32_bf16 v[140:143], a[220:223], v[84:87], v[140:143]
    v_mfma_f32_16x16x32_bf16 v[144:147], a[192:195], v[88:91], v[144:147]
    s_add_u32 m0, s34, 24576
    s_add_u32 s37, s83, 131072
    buffer_load_dwordx4 v232, s[44:47], s37 offen lds
    v_mfma_f32_16x16x32_bf16 v[144:147], a[208:211], v[92:95], v[144:147]
    buffer_load_dwordx4 v233, s[44:47], s37 offen offset:1024 lds
    v_mfma_f32_16x16x32_bf16 v[148:151], a[196:199], v[88:91], v[148:151]
    v_mfma_f32_16x16x32_bf16 v[148:151], a[212:215], v[92:95], v[148:151]
    v_lshlrev_b32 v227, 3, v240
    v_min_u32 v227, 1920, v227
    s_lshl2_add_u32 s25, s2, s3
    v_mfma_f32_16x16x32_bf16 v[152:155], a[200:203], v[88:91], v[152:155]
    s_lshl_b32 s25, s25, 13
    s_add_u32 s25, s25, 6144
    buffer_load_dword v241, v227, s[12:15], s25 offen
    v_mfma_f32_16x16x32_bf16 v[152:155], a[216:219], v[92:95], v[152:155]
    v_mfma_f32_16x16x32_bf16 v[156:159], a[204:207], v[88:91], v[156:159]
    buffer_load_dword v254, off, s[88:91], s97 sc1
    v_mfma_f32_16x16x32_bf16 v[156:159], a[220:223], v[92:95], v[156:159]
    s_waitcnt vmcnt(9) lgkmcnt(0)
    v_mfma_f32_16x16x32_bf16 v[160:163], a[192:195], v[64:67], v[160:163]
    ds_read_b128 v[80:83], v224 offset:45056
    v_mfma_f32_16x16x32_bf16 v[160:163], a[208:211], v[68:71], v[160:163]
    ds_read_b128 v[84:87], v225 offset:45056
    s_mul_i32 s38, s2, 100
    v_mfma_f32_16x16x32_bf16 v[164:167], a[196:199], v[64:67], v[164:167]
    ds_read_b128 v[88:91], v224 offset:47104
    v_mfma_f32_16x16x32_bf16 v[164:167], a[212:215], v[68:71], v[164:167]
    ds_read_b128 v[92:95], v225 offset:47104
    v_lshl_add_u32 v60, v253, 2, s38
    v_mfma_f32_16x16x32_bf16 v[168:171], a[200:203], v[64:67], v[168:171]
    ds_read_b64_tr_b16 a[224:225], v228 offset:8192
    v_mfma_f32_16x16x32_bf16 v[168:171], a[216:219], v[68:71], v[168:171]
    ds_read_b64_tr_b16 a[226:227], v228 offset:8704
    v_cmp_gt_u32 vcc, 25, v253
    v_mfma_f32_16x16x32_bf16 v[172:175], a[204:207], v[64:67], v[172:175]
    ds_read_b64_tr_b16 a[228:229], v229 offset:8192
    v_mfma_f32_16x16x32_bf16 v[172:175], a[220:223], v[68:71], v[172:175]
    ds_read_b64_tr_b16 a[230:231], v229 offset:8704
    v_mov_b32_e64 v61, 0
    v_mfma_f32_16x16x32_bf16 v[176:179], a[192:195], v[72:75], v[176:179]
    ds_read_b64_tr_b16 a[232:233], v230 offset:8192
    v_mfma_f32_16x16x32_bf16 v[176:179], a[208:211], v[76:79], v[176:179]
    ds_read_b64_tr_b16 a[234:235], v230 offset:8704
    v_mfma_f32_16x16x32_bf16 v[180:183], a[196:199], v[72:75], v[180:183]
    ds_read_b64_tr_b16 a[236:237], v231 offset:8192
    v_mov_b32 v62, 0x7ffffff0
    v_mfma_f32_16x16x32_bf16 v[180:183], a[212:215], v[76:79], v[180:183]
    ds_read_b64_tr_b16 a[238:239], v231 offset:8704
    v_mfma_f32_16x16x32_bf16 v[184:187], a[200:203], v[72:75], v[184:187]
    v_cndmask_b32 v60, v62, v60, vcc
    v_mfma_f32_16x16x32_bf16 v[184:187], a[216:219], v[76:79], v[184:187]
    buffer_store_dword v61, v60, s[56:59], 0 offen sc1
    v_mfma_f32_16x16x32_bf16 v[188:191], a[204:207], v[72:75], v[188:191]
    v_mfma_f32_16x16x32_bf16 v[188:191], a[220:223], v[76:79], v[188:191]
    s_waitcnt vmcnt(21) lgkmcnt(0)
    s_barrier
    v_mfma_f32_16x16x32_bf16 v[192:195], a[192:195], v[80:83], v[192:195]
    ds_read_b128 v[64:67], v224 offset:49152
    v_mfma_f32_16x16x32_bf16 v[192:195], a[208:211], v[84:87], v[192:195]
    ds_read_b128 v[68:71], v225 offset:49152
    v_mfma_f32_16x16x32_bf16 v[196:199], a[196:199], v[80:83], v[196:199]
    ds_read_b128 v[72:75], v224 offset:51200
    v_mfma_f32_16x16x32_bf16 v[196:199], a[212:215], v[84:87], v[196:199]
    ds_read_b128 v[76:79], v225 offset:51200
    v_mfma_f32_16x16x32_bf16 v[200:203], a[200:203], v[80:83], v[200:203]
    ds_read_b64_tr_b16 a[240:241], v228 offset:12288
    v_mfma_f32_16x16x32_bf16 v[200:203], a[216:219], v[84:87], v[200:203]
    ds_read_b64_tr_b16 a[242:243], v228 offset:12800
    v_mfma_f32_16x16x32_bf16 v[204:207], a[204:207], v[80:83], v[204:207]
    ds_read_b64_tr_b16 a[244:245], v229 offset:12288
    v_mfma_f32_16x16x32_bf16 v[204:207], a[220:223], v[84:87], v[204:207]
    ds_read_b64_tr_b16 a[246:247], v229 offset:12800
    v_mfma_f32_16x16x32_bf16 v[208:211], a[192:195], v[88:91], v[208:211]
    ds_read_b64_tr_b16 a[248:249], v230 offset:12288
    v_lshlrev_b32 v237, 4, v253
    v_add_u32 v237, 81920, v237
    ds_read_b128 v[16:19], v237 offset:0
    ds_read_b128 v[20:23], v237 offset:4096
    ds_read_b128 v[24:27], v237 offset:24576
    ds_read_b128 v[28:31], v237 offset:28672
    s_add_u32 m0, s34, 32768
    s_add_u32 s37, s84, 131072
    buffer_load_dwordx4 v232, s[44:47], s37 offen lds
    v_mfma_f32_16x16x32_bf16 v[208:211], a[208:211], v[92:95], v[208:211]
    ds_read_b64_tr_b16 a[250:251], v230 offset:12800
    v_mfma_f32_16x16x32_bf16 v[212:215], a[196:199], v[88:91], v[212:215]
    ds_read_b64_tr_b16 a[252:253], v231 offset:12288
    v_mfma_f32_16x16x32_bf16 v[212:215], a[212:215], v[92:95], v[212:215]
    ds_read_b64_tr_b16 a[254:255], v231 offset:12800
    v_mfma_f32_16x16x32_bf16 v[216:219], a[200:203], v[88:91], v[216:219]
    buffer_load_dwordx4 v233, s[44:47], s37 offen offset:1024 lds
    v_mfma_f32_16x16x32_bf16 v[216:219], a[216:219], v[92:95], v[216:219]
    v_mfma_f32_16x16x32_bf16 v[220:223], a[204:207], v[88:91], v[220:223]
    v_mfma_f32_16x16x32_bf16 v[220:223], a[220:223], v[92:95], v[220:223]
    s_waitcnt lgkmcnt(0)
    v_mfma_f32_16x16x32_bf16 v[96:99], a[224:227], v[64:67], v[96:99]
    ds_read_b128 v[80:83], v224 offset:53248
    v_mfma_f32_16x16x32_bf16 v[96:99], a[240:243], v[68:71], v[96:99]
    ds_read_b128 v[84:87], v225 offset:53248
    v_mfma_f32_16x16x32_bf16 v[100:103], a[228:231], v[64:67], v[100:103]
    ds_read_b128 v[88:91], v224 offset:55296
    v_mfma_f32_16x16x32_bf16 v[100:103], a[244:247], v[68:71], v[100:103]
    ds_read_b128 v[92:95], v225 offset:55296
    v_mfma_f32_16x16x32_bf16 v[104:107], a[232:235], v[64:67], v[104:107]
    v_mfma_f32_16x16x32_bf16 v[104:107], a[248:251], v[68:71], v[104:107]
    s_mov_b32 s39, 0
    buffer_store_dwordx4 v[16:19], v238, s[8:11], s39 offen sc1
    v_mfma_f32_16x16x32_bf16 v[108:111], a[236:239], v[64:67], v[108:111]
    v_mfma_f32_16x16x32_bf16 v[108:111], a[252:255], v[68:71], v[108:111]
    v_mfma_f32_16x16x32_bf16 v[112:115], a[224:227], v[72:75], v[112:115]
    v_mfma_f32_16x16x32_bf16 v[112:115], a[240:243], v[76:79], v[112:115]
    v_mfma_f32_16x16x32_bf16 v[116:119], a[228:231], v[72:75], v[116:119]
    v_mfma_f32_16x16x32_bf16 v[116:119], a[244:247], v[76:79], v[116:119]
    v_mfma_f32_16x16x32_bf16 v[120:123], a[232:235], v[72:75], v[120:123]
    v_mfma_f32_16x16x32_bf16 v[120:123], a[248:251], v[76:79], v[120:123]
    s_mov_b32 s39, 8192
    buffer_store_dwordx4 v[20:23], v238, s[8:11], s39 offen sc1
    v_mfma_f32_16x16x32_bf16 v[124:127], a[236:239], v[72:75], v[124:127]
    v_mfma_f32_16x16x32_bf16 v[124:127], a[252:255], v[76:79], v[124:127]
    s_waitcnt lgkmcnt(0)
    v_mfma_f32_16x16x32_bf16 v[128:131], a[224:227], v[80:83], v[128:131]
    ds_read_b128 v[64:67], v224 offset:57344
    v_mfma_f32_16x16x32_bf16 v[128:131], a[240:243], v[84:87], v[128:131]
    ds_read_b128 v[68:71], v225 offset:57344
    v_mfma_f32_16x16x32_bf16 v[132:135], a[228:231], v[80:83], v[132:135]
    ds_read_b128 v[72:75], v224 offset:59392
    v_mfma_f32_16x16x32_bf16 v[132:135], a[244:247], v[84:87], v[132:135]
    ds_read_b128 v[76:79], v225 offset:59392
    v_mfma_f32_16x16x32_bf16 v[136:139], a[232:235], v[80:83], v[136:139]
    v_mfma_f32_16x16x32_bf16 v[136:139], a[248:251], v[84:87], v[136:139]
    s_mov_b32 s39, 16384
    buffer_store_dwordx4 v[24:27], v238, s[8:11], s39 offen sc1
    v_mfma_f32_16x16x32_bf16 v[140:143], a[236:239], v[80:83], v[140:143]
    v_mfma_f32_16x16x32_bf16 v[140:143], a[252:255], v[84:87], v[140:143]
    v_mfma_f32_16x16x32_bf16 v[144:147], a[224:227], v[88:91], v[144:147]
    s_add_u32 m0, s34, 40960
    s_add_u32 s37, s85, 131072
    buffer_load_dwordx4 v232, s[44:47], s37 offen lds
    v_mfma_f32_16x16x32_bf16 v[144:147], a[240:243], v[92:95], v[144:147]
    v_mfma_f32_16x16x32_bf16 v[148:151], a[228:231], v[88:91], v[148:151]
    v_mfma_f32_16x16x32_bf16 v[148:151], a[244:247], v[92:95], v[148:151]
    v_mfma_f32_16x16x32_bf16 v[152:155], a[232:235], v[88:91], v[152:155]
    buffer_load_dwordx4 v233, s[44:47], s37 offen offset:1024 lds
    v_mfma_f32_16x16x32_bf16 v[152:155], a[248:251], v[92:95], v[152:155]
    s_mov_b32 s39, 24576
    buffer_store_dwordx4 v[28:31], v238, s[8:11], s39 offen sc1
    v_mfma_f32_16x16x32_bf16 v[156:159], a[236:239], v[88:91], v[156:159]
    v_mfma_f32_16x16x32_bf16 v[156:159], a[252:255], v[92:95], v[156:159]
    s_waitcnt lgkmcnt(0)
    v_mfma_f32_16x16x32_bf16 v[160:163], a[224:227], v[64:67], v[160:163]
    ds_read_b128 v[80:83], v224 offset:61440
    v_mfma_f32_16x16x32_bf16 v[160:163], a[240:243], v[68:71], v[160:163]
    ds_read_b128 v[84:87], v225 offset:61440
    v_mfma_f32_16x16x32_bf16 v[164:167], a[228:231], v[64:67], v[164:167]
    ds_read_b128 v[88:91], v224 offset:63488
    v_mfma_f32_16x16x32_bf16 v[164:167], a[244:247], v[68:71], v[164:167]
    ds_read_b128 v[92:95], v225 offset:63488
    v_mfma_f32_16x16x32_bf16 v[168:171], a[232:235], v[64:67], v[168:171]
    v_mfma_f32_16x16x32_bf16 v[168:171], a[248:251], v[68:71], v[168:171]
    v_mfma_f32_16x16x32_bf16 v[172:175], a[236:239], v[64:67], v[172:175]
    v_mfma_f32_16x16x32_bf16 v[172:175], a[252:255], v[68:71], v[172:175]
    v_mfma_f32_16x16x32_bf16 v[176:179], a[224:227], v[72:75], v[176:179]
    v_mfma_f32_16x16x32_bf16 v[176:179], a[240:243], v[76:79], v[176:179]
    v_cvt_pk_bf16_f32 v0, v96, v97
    v_cvt_pk_bf16_f32 v1, v98, v99
    v_mfma_f32_16x16x32_bf16 v[180:183], a[228:231], v[72:75], v[180:183]
    v_cvt_pk_bf16_f32 v2, v100, v101
    v_cvt_pk_bf16_f32 v3, v102, v103
    v_mfma_f32_16x16x32_bf16 v[180:183], a[244:247], v[76:79], v[180:183]
    v_cvt_pk_bf16_f32 v4, v104, v105
    v_cvt_pk_bf16_f32 v5, v106, v107
    v_mfma_f32_16x16x32_bf16 v[184:187], a[232:235], v[72:75], v[184:187]
    v_cvt_pk_bf16_f32 v6, v108, v109
    v_cvt_pk_bf16_f32 v7, v110, v111
    v_mfma_f32_16x16x32_bf16 v[184:187], a[248:251], v[76:79], v[184:187]
    v_cvt_pk_bf16_f32 v8, v112, v113
    v_cvt_pk_bf16_f32 v9, v114, v115
    v_mfma_f32_16x16x32_bf16 v[188:191], a[236:239], v[72:75], v[188:191]
    v_cvt_pk_bf16_f32 v10, v116, v117
    v_cvt_pk_bf16_f32 v11, v118, v119
    v_mfma_f32_16x16x32_bf16 v[188:191], a[252:255], v[76:79], v[188:191]
    v_cvt_pk_bf16_f32 v12, v120, v121
    v_cvt_pk_bf16_f32 v13, v122, v123
    s_waitcnt vmcnt(16) lgkmcnt(0)
    s_barrier
    v_mfma_f32_16x16x32_bf16 v[192:195], a[224:227], v[80:83], v[192:195]
    ds_read_b128 v[64:67], v224 offset:0
    v_cvt_pk_bf16_f32 v14, v124, v125
    v_cvt_pk_bf16_f32 v15, v126, v127
    v_mfma_f32_16x16x32_bf16 v[192:195], a[240:243], v[84:87], v[192:195]
    ds_read_b128 v[68:71], v225 offset:0
    v_cvt_pk_bf16_f32 v16, v128, v129
    v_cvt_pk_bf16_f32 v17, v130, v131
    v_mfma_f32_16x16x32_bf16 v[196:199], a[228:231], v[80:83], v[196:199]
    ds_read_b128 v[72:75], v224 offset:8192
    v_cvt_pk_bf16_f32 v18, v132, v133
    v_cvt_pk_bf16_f32 v19, v134, v135
    v_mfma_f32_16x16x32_bf16 v[196:199], a[244:247], v[84:87], v[196:199]
    ds_read_b128 v[76:79], v225 offset:8192
    v_cvt_pk_bf16_f32 v20, v136, v137
    v_cvt_pk_bf16_f32 v21, v138, v139
    v_mfma_f32_16x16x32_bf16 v[200:203], a[232:235], v[80:83], v[200:203]
    v_cvt_pk_bf16_f32 v22, v140, v141
    v_cvt_pk_bf16_f32 v23, v142, v143
    v_mfma_f32_16x16x32_bf16 v[200:203], a[248:251], v[84:87], v[200:203]
    v_cvt_pk_bf16_f32 v24, v144, v145
    v_cvt_pk_bf16_f32 v25, v146, v147
    v_mfma_f32_16x16x32_bf16 v[204:207], a[236:239], v[80:83], v[204:207]
    v_cvt_pk_bf16_f32 v26, v148, v149
    v_cvt_pk_bf16_f32 v27, v150, v151
    v_mfma_f32_16x16x32_bf16 v[204:207], a[252:255], v[84:87], v[204:207]
    v_cvt_pk_bf16_f32 v28, v152, v153
    v_cvt_pk_bf16_f32 v29, v154, v155
    v_mfma_f32_16x16x32_bf16 v[208:211], a[224:227], v[88:91], v[208:211]
    s_add_u32 m0, s34, 49152
    s_add_u32 s37, s86, 131072
    buffer_load_dwordx4 v232, s[44:47], s37 offen lds
    v_cvt_pk_bf16_f32 v30, v156, v157
    v_cvt_pk_bf16_f32 v31, v158, v159
    v_mfma_f32_16x16x32_bf16 v[208:211], a[240:243], v[92:95], v[208:211]
    v_cvt_pk_bf16_f32 v32, v160, v161
    v_cvt_pk_bf16_f32 v33, v162, v163
    v_mfma_f32_16x16x32_bf16 v[212:215], a[228:231], v[88:91], v[212:215]
    v_cvt_pk_bf16_f32 v34, v164, v165
    v_cvt_pk_bf16_f32 v35, v166, v167
    v_mfma_f32_16x16x32_bf16 v[212:215], a[244:247], v[92:95], v[212:215]
    v_cvt_pk_bf16_f32 v36, v168, v169
    v_cvt_pk_bf16_f32 v37, v170, v171
    v_mfma_f32_16x16x32_bf16 v[216:219], a[232:235], v[88:91], v[216:219]
    buffer_load_dwordx4 v233, s[44:47], s37 offen offset:1024 lds
    v_cvt_pk_bf16_f32 v38, v172, v173
    v_cvt_pk_bf16_f32 v39, v174, v175
    v_mfma_f32_16x16x32_bf16 v[216:219], a[248:251], v[92:95], v[216:219]
    v_cvt_pk_bf16_f32 v40, v176, v177
    v_cvt_pk_bf16_f32 v41, v178, v179
    v_mfma_f32_16x16x32_bf16 v[220:223], a[236:239], v[88:91], v[220:223]
    v_cvt_pk_bf16_f32 v42, v180, v181
    v_cvt_pk_bf16_f32 v43, v182, v183
    v_mfma_f32_16x16x32_bf16 v[220:223], a[252:255], v[92:95], v[220:223]
    v_cvt_pk_bf16_f32 v44, v184, v185
    v_cvt_pk_bf16_f32 v45, v186, v187
    s_waitcnt lgkmcnt(0)
    v_mfma_f32_16x16x32_bf16 v[96:99], a[0:3], v[64:67], 0
    ds_read_b128 v[80:83], v224 offset:2048
    v_cvt_pk_bf16_f32 v46, v188, v189
    v_cvt_pk_bf16_f32 v47, v190, v191
    v_mfma_f32_16x16x32_bf16 v[96:99], a[16:19], v[68:71], v[96:99]
    ds_read_b128 v[84:87], v225 offset:2048
    v_cvt_pk_bf16_f32 v48, v192, v193
    v_cvt_pk_bf16_f32 v49, v194, v195
    v_mfma_f32_16x16x32_bf16 v[96:99], a[32:35], v[72:75], v[96:99]
    ds_read_b128 v[88:91], v224 offset:10240
    v_cvt_pk_bf16_f32 v50, v196, v197
    v_cvt_pk_bf16_f32 v51, v198, v199
    v_mfma_f32_16x16x32_bf16 v[96:99], a[48:51], v[76:79], v[96:99]
    ds_read_b128 v[92:95], v225 offset:10240
    v_cvt_pk_bf16_f32 v52, v200, v201
    v_cvt_pk_bf16_f32 v53, v202, v203
    v_mfma_f32_16x16x32_bf16 v[100:103], a[4:7], v[64:67], 0
    v_cvt_pk_bf16_f32 v54, v204, v205
    v_cvt_pk_bf16_f32 v55, v206, v207
    s_add_u32 s38, s36, 0
    buffer_store_dwordx4 v[0:3], v240, s[16:19], s38 offen offset:0 sc1
    v_mfma_f32_16x16x32_bf16 v[100:103], a[20:23], v[68:71], v[100:103]
    v_cvt_pk_bf16_f32 v56, v208, v209
    v_cvt_pk_bf16_f32 v57, v210, v211
    v_mfma_f32_16x16x32_bf16 v[100:103], a[36:39], v[72:75], v[100:103]
    v_cvt_pk_bf16_f32 v58, v212, v213
    v_cvt_pk_bf16_f32 v59, v214, v215
    v_mfma_f32_16x16x32_bf16 v[100:103], a[52:55], v[76:79], v[100:103]
    v_cvt_pk_bf16_f32 v60, v216, v217
    v_cvt_pk_bf16_f32 v61, v218, v219
    v_mfma_f32_16x16x32_bf16 v[104:107], a[8:11], v[64:67], 0
    v_xor_b32 v237, 16, v245
    v_xor_b32 v238, 16, v246
    v_cvt_pk_bf16_f32 v62, v220, v221
    v_cvt_pk_bf16_f32 v63, v222, v223
    v_mfma_f32_16x16x32_bf16 v[104:107], a[24:27], v[68:71], v[104:107]
    v_mfma_f32_16x16x32_bf16 v[104:107], a[40:43], v[72:75], v[104:107]
    v_mfma_f32_16x16x32_bf16 v[104:107], a[56:59], v[76:79], v[104:107]
    v_mfma_f32_16x16x32_bf16 v[108:111], a[12:15], v[64:67], 0
    v_mfma_f32_16x16x32_bf16 v[108:111], a[28:31], v[68:71], v[108:111]
    v_mfma_f32_16x16x32_bf16 v[108:111], a[44:47], v[72:75], v[108:111]
    v_mfma_f32_16x16x32_bf16 v[108:111], a[60:63], v[76:79], v[108:111]
    s_waitcnt lgkmcnt(0)
    v_mfma_f32_16x16x32_bf16 v[112:115], a[0:3], v[80:83], 0
    ds_read_b128 v[64:67], v224 offset:4096
    v_mfma_f32_16x16x32_bf16 v[112:115], a[16:19], v[84:87], v[112:115]
    ds_read_b128 v[68:71], v225 offset:4096
    v_mfma_f32_16x16x32_bf16 v[112:115], a[32:35], v[88:91], v[112:115]
    ds_read_b128 v[72:75], v224 offset:12288
    v_mfma_f32_16x16x32_bf16 v[112:115], a[48:51], v[92:95], v[112:115]
    ds_read_b128 v[76:79], v225 offset:12288
    v_mfma_f32_16x16x32_bf16 v[116:119], a[4:7], v[80:83], 0
    v_mfma_f32_16x16x32_bf16 v[116:119], a[20:23], v[84:87], v[116:119]
    v_mfma_f32_16x16x32_bf16 v[116:119], a[36:39], v[88:91], v[116:119]
    v_mfma_f32_16x16x32_bf16 v[116:119], a[52:55], v[92:95], v[116:119]
    v_mfma_f32_16x16x32_bf16 v[120:123], a[8:11], v[80:83], 0
    s_add_u32 m0, s34, 57344
    s_add_u32 s37, s87, 131072
    buffer_load_dwordx4 v232, s[44:47], s37 offen lds
    v_mfma_f32_16x16x32_bf16 v[120:123], a[24:27], v[84:87], v[120:123]
    s_add_u32 s38, s36, 0
    buffer_store_dwordx4 v[4:7], v240, s[16:19], s38 offen offset:2048 sc1
    v_mfma_f32_16x16x32_bf16 v[120:123], a[40:43], v[88:91], v[120:123]
    v_mfma_f32_16x16x32_bf16 v[120:123], a[56:59], v[92:95], v[120:123]
    v_mfma_f32_16x16x32_bf16 v[124:127], a[12:15], v[80:83], 0
    buffer_load_dwordx4 v233, s[44:47], s37 offen offset:1024 lds
    v_mfma_f32_16x16x32_bf16 v[124:127], a[28:31], v[84:87], v[124:127]
    v_mfma_f32_16x16x32_bf16 v[124:127], a[44:47], v[88:91], v[124:127]
    v_mfma_f32_16x16x32_bf16 v[124:127], a[60:63], v[92:95], v[124:127]
    s_waitcnt lgkmcnt(0)
    v_mfma_f32_16x16x32_bf16 v[128:131], a[0:3], v[64:67], 0
    ds_read_b128 v[80:83], v224 offset:6144
    v_mfma_f32_16x16x32_bf16 v[128:131], a[16:19], v[68:71], v[128:131]
    ds_read_b128 v[84:87], v225 offset:6144
    v_mfma_f32_16x16x32_bf16 v[128:131], a[32:35], v[72:75], v[128:131]
    ds_read_b128 v[88:91], v224 offset:14336
    v_mfma_f32_16x16x32_bf16 v[128:131], a[48:51], v[76:79], v[128:131]
    ds_read_b128 v[92:95], v225 offset:14336
    v_mfma_f32_16x16x32_bf16 v[132:135], a[4:7], v[64:67], 0
    v_mfma_f32_16x16x32_bf16 v[132:135], a[20:23], v[68:71], v[132:135]
    v_mfma_f32_16x16x32_bf16 v[132:135], a[36:39], v[72:75], v[132:135]
    v_mfma_f32_16x16x32_bf16 v[132:135], a[52:55], v[76:79], v[132:135]
    v_mfma_f32_16x16x32_bf16 v[136:139], a[8:11], v[64:67], 0
    s_waitcnt vmcnt(15)
    v_readfirstlane_b32 s24, v254
    s_lshl_b32 s25, s3, 16
    s_add_u32 s24, s24, s25
    s_cmp_ge_u32 s24, 1
    s_cbranch_scc0 kf_spin31
kf_spinr32:
    v_mfma_f32_16x16x32_bf16 v[136:139], a[24:27], v[68:71], v[136:139]
    v_mfma_f32_16x16x32_bf16 v[136:139], a[40:43], v[72:75], v[136:139]
    v_mfma_f32_16x16x32_bf16 v[136:139], a[56:59], v[76:79], v[136:139]
    v_mfma_f32_16x16x32_bf16 v[140:143], a[12:15], v[64:67], 0
    s_add_u32 s88, s20, 0x14a0000
    s_addc_u32 s89, s21, 0
    s_mov_b32 s90, 20480
    v_mfma_f32_16x16x32_bf16 v[140:143], a[28:31], v[68:71], v[140:143]
    v_mfma_f32_16x16x32_bf16 v[140:143], a[44:47], v[72:75], v[140:143]
    v_mfma_f32_16x16x32_bf16 v[140:143], a[60:63], v[76:79], v[140:143]
    s_add_u32 s38, s36, 0
    buffer_store_dwordx4 v[8:11], v240, s[16:19], s38 offen offset:1024 sc1
    s_waitcnt vmcnt(7) lgkmcnt(0)
    s_barrier
    v_mfma_f32_16x16x32_bf16 v[144:147], a[0:3], v[80:83], 0
    ds_read_b128 v[64:67], v224 offset:16384
    v_mfma_f32_16x16x32_bf16 v[144:147], a[16:19], v[84:87], v[144:147]
    ds_read_b128 v[68:71], v225 offset:16384
    v_mfma_f32_16x16x32_bf16 v[144:147], a[32:35], v[88:91], v[144:147]
    ds_read_b128 v[72:75], v224 offset:24576
    v_mfma_f32_16x16x32_bf16 v[144:147], a[48:51], v[92:95], v[144:147]
    ds_read_b128 v[76:79], v225 offset:24576
    v_mfma_f32_16x16x32_bf16 v[148:151], a[4:7], v[80:83], 0
    v_mfma_f32_16x16x32_bf16 v[148:151], a[20:23], v[84:87], v[148:151]
    v_mfma_f32_16x16x32_bf16 v[148:151], a[36:39], v[88:91], v[148:151]
    v_mfma_f32_16x16x32_bf16 v[148:151], a[52:55], v[92:95], v[148:151]
    v_mfma_f32_16x16x32_bf16 v[152:155], a[8:11], v[80:83], 0
    s_add_u32 m0, s34, 0
    s_add_u32 s37, s80, 196608
    buffer_load_dwordx4 v232, s[44:47], s37 offen lds
    v_mfma_f32_16x16x32_bf16 v[152:155], a[24:27], v[84:87], v[152:155]
    v_mfma_f32_16x16x32_bf16 v[152:155], a[40:43], v[88:91], v[152:155]
    buffer_load_dwordx4 v233, s[44:47], s37 offen offset:1024 lds
    v_mfma_f32_16x16x32_bf16 v[152:155], a[56:59], v[92:95], v[152:155]
    v_mfma_f32_16x16x32_bf16 v[156:159], a[12:15], v[80:83], 0
    v_mfma_f32_16x16x32_bf16 v[156:159], a[28:31], v[84:87], v[156:159]
    s_lshl_b32 s39, s5, 7
    s_add_u32 s39, s39, 8192
    buffer_atomic_add v255, v250, s[88:91], s39 offen sc1
    s_cmp_eq_u32 s3, 0
    s_cselect_b32 s39, s39, s43
    v_mfma_f32_16x16x32_bf16 v[156:159], a[44:47], v[88:91], v[156:159]
    v_mfma_f32_16x16x32_bf16 v[156:159], a[60:63], v[92:95], v[156:159]
    s_waitcnt lgkmcnt(0)
    v_mfma_f32_16x16x32_bf16 v[96:99], a[64:67], v[64:67], v[96:99]
    ds_read_b128 v[80:83], v224 offset:18432
    v_mfma_f32_16x16x32_bf16 v[96:99], a[80:83], v[68:71], v[96:99]
    ds_read_b128 v[84:87], v225 offset:18432
    v_mfma_f32_16x16x32_bf16 v[96:99], a[96:99], v[72:75], v[96:99]
    ds_read_b128 v[88:91], v224 offset:26624
    v_mfma_f32_16x16x32_bf16 v[96:99], a[112:115], v[76:79], v[96:99]
    ds_read_b128 v[92:95], v225 offset:26624
    v_mfma_f32_16x16x32_bf16 v[100:103], a[68:71], v[64:67], v[100:103]
    s_add_u32 s38, s36, 0
    buffer_store_dwordx4 v[12:15], v240, s[16:19], s38 offen offset:3072 sc1
    v_mfma_f32_16x16x32_bf16 v[100:103], a[84:87], v[68:71], v[100:103]
    v_mfma_f32_16x16x32_bf16 v[100:103], a[100:103], v[72:75], v[100:103]
    v_mfma_f32_16x16x32_bf16 v[100:103], a[116:119], v[76:79], v[100:103]
    v_mfma_f32_16x16x32_bf16 v[104:107], a[72:75], v[64:67], v[104:107]
    s_add_u32 m0, s31, 0
    s_add_u32 s24, s27, 0
    buffer_load_dwordx4 v245, s[12:15], s24 offen lds
    v_mfma_f32_16x16x32_bf16 v[104:107], a[88:91], v[68:71], v[104:107]
    v_mfma_f32_16x16x32_bf16 v[104:107], a[104:107], v[72:75], v[104:107]
    v_mfma_f32_16x16x32_bf16 v[104:107], a[120:123], v[76:79], v[104:107]
    v_mfma_f32_16x16x32_bf16 v[108:111], a[76:79], v[64:67], v[108:111]
    v_mfma_f32_16x16x32_bf16 v[108:111], a[92:95], v[68:71], v[108:111]
    v_mfma_f32_16x16x32_bf16 v[108:111], a[108:111], v[72:75], v[108:111]
    v_mfma_f32_16x16x32_bf16 v[108:111], a[124:127], v[76:79], v[108:111]
    s_waitcnt lgkmcnt(0)
    v_mfma_f32_16x16x32_bf16 v[112:115], a[64:67], v[80:83], v[112:115]
    ds_read_b128 v[64:67], v224 offset:20480
    v_mfma_f32_16x16x32_bf16 v[112:115], a[80:83], v[84:87], v[112:115]
    ds_read_b128 v[68:71], v225 offset:20480
    v_mfma_f32_16x16x32_bf16 v[112:115], a[96:99], v[88:91], v[112:115]
    ds_read_b128 v[72:75], v224 offset:28672
    v_mfma_f32_16x16x32_bf16 v[112:115], a[112:115], v[92:95], v[112:115]
    ds_read_b128 v[76:79], v225 offset:28672
    v_mfma_f32_16x16x32_bf16 v[116:119], a[68:71], v[80:83], v[116:119]
    v_mfma_f32_16x16x32_bf16 v[116:119], a[84:87], v[84:87], v[116:119]
    v_mfma_f32_16x16x32_bf16 v[116:119], a[100:103], v[88:91], v[116:119]
    v_mfma_f32_16x16x32_bf16 v[116:119], a[116:119], v[92:95], v[116:119]
    v_mfma_f32_16x16x32_bf16 v[120:123], a[72:75], v[80:83], v[120:123]
    s_add_u32 m0, s34, 8192
    s_add_u32 s37, s81, 196608
    buffer_load_dwordx4 v232, s[44:47], s37 offen lds
    v_mfma_f32_16x16x32_bf16 v[120:123], a[88:91], v[84:87], v[120:123]
    v_mfma_f32_16x16x32_bf16 v[120:123], a[104:107], v[88:91], v[120:123]
    buffer_load_dwordx4 v233, s[44:47], s37 offen offset:1024 lds
    s_add_u32 s38, s36, 8192
    buffer_store_dwordx4 v[16:19], v240, s[16:19], s38 offen offset:0 sc1
    v_mfma_f32_16x16x32_bf16 v[120:123], a[120:123], v[92:95], v[120:123]
    v_mfma_f32_16x16x32_bf16 v[124:127], a[76:79], v[80:83], v[124:127]
    v_mfma_f32_16x16x32_bf16 v[124:127], a[92:95], v[84:87], v[124:127]
    s_add_u32 m0, s31, 1024
    s_add_u32 s24, s27, 32768
    buffer_load_dwordx4 v245, s[12:15], s24 offen lds
    v_mfma_f32_16x16x32_bf16 v[124:127], a[108:111], v[88:91], v[124:127]
    v_mfma_f32_16x16x32_bf16 v[124:127], a[124:127], v[92:95], v[124:127]
    s_waitcnt lgkmcnt(0)
    v_mfma_f32_16x16x32_bf16 v[128:131], a[64:67], v[64:67], v[128:131]
    ds_read_b128 v[80:83], v224 offset:22528
    v_mfma_f32_16x16x32_bf16 v[128:131], a[80:83], v[68:71], v[128:131]
    ds_read_b128 v[84:87], v225 offset:22528
    v_mfma_f32_16x16x32_bf16 v[128:131], a[96:99], v[72:75], v[128:131]
    ds_read_b128 v[88:91], v224 offset:30720
    v_mfma_f32_16x16x32_bf16 v[128:131], a[112:115], v[76:79], v[128:131]
    ds_read_b128 v[92:95], v225 offset:30720
    v_mfma_f32_16x16x32_bf16 v[132:135], a[68:71], v[64:67], v[132:135]
    v_mfma_f32_16x16x32_bf16 v[132:135], a[84:87], v[68:71], v[132:135]
    v_mfma_f32_16x16x32_bf16 v[132:135], a[100:103], v[72:75], v[132:135]
    v_mfma_f32_16x16x32_bf16 v[132:135], a[116:119], v[76:79], v[132:135]
    v_mfma_f32_16x16x32_bf16 v[136:139], a[72:75], v[64:67], v[136:139]
    s_add_u32 m0, s31, 2048
    s_add_u32 s24, s27, 65536
    buffer_load_dwordx4 v237, s[12:15], s24 offen lds
    v_mfma_f32_16x16x32_bf16 v[136:139], a[88:91], v[68:71], v[136:139]
    v_mfma_f32_16x16x32_bf16 v[136:139], a[104:107], v[72:75], v[136:139]
    v_mfma_f32_16x16x32_bf16 v[136:139], a[120:123], v[76:79], v[136:139]
    v_mfma_f32_16x16x32_bf16 v[140:143], a[76:79], v[64:67], v[140:143]
    v_mfma_f32_16x16x32_bf16 v[140:143], a[92:95], v[68:71], v[140:143]
    v_mfma_f32_16x16x32_bf16 v[140:143], a[108:111], v[72:75], v[140:143]
    v_mfma_f32_16x16x32_bf16 v[140:143], a[124:127], v[76:79], v[140:143]
    s_add_u32 s38, s36, 8192
    buffer_store_dwordx4 v[20:23], v240, s[16:19], s38 offen offset:2048 sc1
    s_waitcnt vmcnt(19) lgkmcnt(0)
    s_barrier
    v_mfma_f32_16x16x32_bf16 v[144:147], a[64:67], v[80:83], v[144:147]
    ds_read_b128 v[64:67], v224 offset:32768
    v_mfma_f32_16x16x32_bf16 v[144:147], a[80:83], v[84:87], v[144:147]
    ds_read_b128 v[68:71], v225 offset:32768
    v_mfma_f32_16x16x32_bf16 v[144:147], a[96:99], v[88:91], v[144:147]
    ds_read_b128 v[72:75], v224 offset:40960
    v_mfma_f32_16x16x32_bf16 v[144:147], a[112:115], v[92:95], v[144:147]
    ds_read_b128 v[76:79], v225 offset:40960
    v_mfma_f32_16x16x32_bf16 v[148:151], a[68:71], v[80:83], v[148:151]
    v_mfma_f32_16x16x32_bf16 v[148:151], a[84:87], v[84:87], v[148:151]
    v_mfma_f32_16x16x32_bf16 v[148:151], a[100:103], v[88:91], v[148:151]
    v_mfma_f32_16x16x32_bf16 v[148:151], a[116:119], v[92:95], v[148:151]
    v_mfma_f32_16x16x32_bf16 v[152:155], a[72:75], v[80:83], v[152:155]
    s_add_u32 m0, s34, 16384
    s_add_u32 s37, s82, 196608
    buffer_load_dwordx4 v232, s[44:47], s37 offen lds
    v_mfma_f32_16x16x32_bf16 v[152:155], a[88:91], v[84:87], v[152:155]
    v_mfma_f32_16x16x32_bf16 v[152:155], a[104:107], v[88:91], v[152:155]
    buffer_load_dwordx4 v233, s[44:47], s37 offen offset:1024 lds
    v_mfma_f32_16x16x32_bf16 v[152:155], a[120:123], v[92:95], v[152:155]
    v_mfma_f32_16x16x32_bf16 v[156:159], a[76:79], v[80:83], v[156:159]
    v_mfma_f32_16x16x32_bf16 v[156:159], a[92:95], v[84:87], v[156:159]
    s_add_u32 m0, s31, 3072
    s_add_u32 s24, s27, 98304
    buffer_load_dwordx4 v237, s[12:15], s24 offen lds
    v_mfma_f32_16x16x32_bf16 v[156:159], a[108:111], v[88:91], v[156:159]
    v_mfma_f32_16x16x32_bf16 v[156:159], a[124:127], v[92:95], v[156:159]
    s_waitcnt lgkmcnt(0)
    v_mfma_f32_16x16x32_bf16 v[96:99], a[128:131], v[64:67], v[96:99]
    ds_read_b128 v[80:83], v224 offset:34816
    v_mfma_f32_16x16x32_bf16 v[96:99], a[144:147], v[68:71], v[96:99]
    ds_read_b128 v[84:87], v225 offset:34816
    v_mfma_f32_16x16x32_bf16 v[96:99], a[160:163], v[72:75], v[96:99]
    ds_read_b128 v[88:91], v224 offset:43008
    v_mfma_f32_16x16x32_bf16 v[96:99], a[176:179], v[76:79], v[96:99]
    ds_read_b128 v[92:95], v225 offset:43008
    v_mfma_f32_16x16x32_bf16 v[100:103], a[132:135], v[64:67], v[100:103]
    v_mfma_f32_16x16x32_bf16 v[100:103], a[148:151], v[68:71], v[100:103]
    s_add_u32 s38, s36, 8192
    buffer_store_dwordx4 v[24:27], v240, s[16:19], s38 offen offset:1024 sc1
    v_mfma_f32_16x16x32_bf16 v[100:103], a[164:167], v[72:75], v[100:103]
    v_mfma_f32_16x16x32_bf16 v[100:103], a[180:183], v[76:79], v[100:103]
    v_mfma_f32_16x16x32_bf16 v[104:107], a[136:139], v[64:67], v[104:107]
    s_add_u32 m0, s31, 4096
    s_add_u32 s24, s27, 131072
    buffer_load_dwordx4 v245, s[12:15], s24 offen lds
    v_mfma_f32_16x16x32_bf16 v[104:107], a[152:155], v[68:71], v[104:107]
    v_mfma_f32_16x16x32_bf16 v[104:107], a[168:171], v[72:75], v[104:107]
    v_mfma_f32_16x16x32_bf16 v[104:107], a[184:187], v[76:79], v[104:107]
    v_mfma_f32_16x16x32_bf16 v[108:111], a[140:143], v[64:67], v[108:111]
    v_mfma_f32_16x16x32_bf16 v[108:111], a[156:159], v[68:71], v[108:111]
    v_mfma_f32_16x16x32_bf16 v[108:111], a[172:175], v[72:75], v[108:111]
    v_mfma_f32_16x16x32_bf16 v[108:111], a[188:191], v[76:79], v[108:111]
    s_waitcnt lgkmcnt(0)
    v_mfma_f32_16x16x32_bf16 v[112:115], a[128:131], v[80:83], v[112:115]
    ds_read_b128 v[64:67], v224 offset:36864
    v_mfma_f32_16x16x32_bf16 v[112:115], a[144:147], v[84:87], v[112:115]
    ds_read_b128 v[68:71], v225 offset:36864
    v_mfma_f32_16x16x32_bf16 v[112:115], a[160:163], v[88:91], v[112:115]
    ds_read_b128 v[72:75], v224 offset:45056
    v_mfma_f32_16x16x32_bf16 v[112:115], a[176:179], v[92:95], v[112:115]
    ds_read_b128 v[76:79], v225 offset:45056
    v_mfma_f32_16x16x32_bf16 v[116:119], a[132:135], v[80:83], v[116:119]
    v_mfma_f32_16x16x32_bf16 v[116:119], a[148:151], v[84:87], v[116:119]
    v_mfma_f32_16x16x32_bf16 v[116:119], a[164:167], v[88:91], v[116:119]
    v_mfma_f32_16x16x32_bf16 v[116:119], a[180:183], v[92:95], v[116:119]
    v_mfma_f32_16x16x32_bf16 v[120:123], a[136:139], v[80:83], v[120:123]
    s_add_u32 m0, s34, 24576
    s_add_u32 s37, s83, 196608
    buffer_load_dwordx4 v232, s[44:47], s37 offen lds
    v_mfma_f32_16x16x32_bf16 v[120:123], a[152:155], v[84:87], v[120:123]
    v_mfma_f32_16x16x32_bf16 v[120:123], a[168:171], v[88:91], v[120:123]
    buffer_load_dwordx4 v233, s[44:47], s37 offen offset:1024 lds
    s_add_u32 s38, s36, 8192
    buffer_store_dwordx4 v[28:31], v240, s[16:19], s38 offen offset:3072 sc1
    v_mfma_f32_16x16x32_bf16 v[120:123], a[184:187], v[92:95], v[120:123]
    v_mfma_f32_16x16x32_bf16 v[124:127], a[140:143], v[80:83], v[124:127]
    v_mfma_f32_16x16x32_bf16 v[124:127], a[156:159], v[84:87], v[124:127]
    s_add_u32 m0, s31, 5120
    s_add_u32 s24, s27, 163840
    buffer_load_dwordx4 v245, s[12:15], s24 offen lds
    v_mfma_f32_16x16x32_bf16 v[124:127], a[172:175], v[88:91], v[124:127]
    v_mfma_f32_16x16x32_bf16 v[124:127], a[188:191], v[92:95], v[124:127]
    s_waitcnt lgkmcnt(0)
    v_mfma_f32_16x16x32_bf16 v[128:131], a[128:131], v[64:67], v[128:131]
    ds_read_b128 v[80:83], v224 offset:38912
    v_mfma_f32_16x16x32_bf16 v[128:131], a[144:147], v[68:71], v[128:131]
    ds_read_b128 v[84:87], v225 offset:38912
    v_mfma_f32_16x16x32_bf16 v[128:131], a[160:163], v[72:75], v[128:131]
    ds_read_b128 v[88:91], v224 offset:47104
    v_mfma_f32_16x16x32_bf16 v[128:131], a[176:179], v[76:79], v[128:131]
    ds_read_b128 v[92:95], v225 offset:47104
    v_mfma_f32_16x16x32_bf16 v[132:135], a[132:135], v[64:67], v[132:135]
    v_mfma_f32_16x16x32_bf16 v[132:135], a[148:151], v[68:71], v[132:135]
    v_mfma_f32_16x16x32_bf16 v[132:135], a[164:167], v[72:75], v[132:135]
    v_mfma_f32_16x16x32_bf16 v[132:135], a[180:183], v[76:79], v[132:135]
    v_mfma_f32_16x16x32_bf16 v[136:139], a[136:139], v[64:67], v[136:139]
    s_add_u32 m0, s31, 6144
    s_add_u32 s24, s27, 196608
    buffer_load_dwordx4 v237, s[12:15], s24 offen lds
    v_mfma_f32_16x16x32_bf16 v[136:139], a[152:155], v[68:71], v[136:139]
    v_mfma_f32_16x16x32_bf16 v[136:139], a[168:171], v[72:75], v[136:139]
    v_mfma_f32_16x16x32_bf16 v[136:139], a[184:187], v[76:79], v[136:139]
    v_mfma_f32_16x16x32_bf16 v[140:143], a[140:143], v[64:67], v[140:143]
    v_mfma_f32_16x16x32_bf16 v[140:143], a[156:159], v[68:71], v[140:143]
    v_mfma_f32_16x16x32_bf16 v[140:143], a[172:175], v[72:75], v[140:143]
    v_mfma_f32_16x16x32_bf16 v[140:143], a[188:191], v[76:79], v[140:143]
    s_waitcnt vmcnt(22) lgkmcnt(0)
    s_barrier
    v_mfma_f32_16x16x32_bf16 v[144:147], a[128:131], v[80:83], v[144:147]
    ds_read_b128 v[64:67], v224 offset:49152
    s_add_u32 s38, s36, 32768
    buffer_store_dwordx4 v[32:35], v240, s[16:19], s38 offen offset:1280 sc1
    v_mfma_f32_16x16x32_bf16 v[144:147], a[144:147], v[84:87], v[144:147]
    ds_read_b128 v[68:71], v225 offset:49152
    v_mfma_f32_16x16x32_bf16 v[144:147], a[160:163], v[88:91], v[144:147]
    ds_read_b128 v[72:75], v224 offset:57344
    v_mfma_f32_16x16x32_bf16 v[144:147], a[176:179], v[92:95], v[144:147]
    ds_read_b128 v[76:79], v225 offset:57344
    v_mfma_f32_16x16x32_bf16 v[148:151], a[132:135], v[80:83], v[148:151]
    v_mfma_f32_16x16x32_bf16 v[148:151], a[148:151], v[84:87], v[148:151]
    v_mfma_f32_16x16x32_bf16 v[148:151], a[164:167], v[88:91], v[148:151]
    v_mfma_f32_16x16x32_bf16 v[148:151], a[180:183], v[92:95], v[148:151]
    v_mfma_f32_16x16x32_bf16 v[152:155], a[136:139], v[80:83], v[152:155]
    s_add_u32 m0, s34, 32768
    s_add_u32 s37, s84, 196608
    buffer_load_dwordx4 v232, s[44:47], s37 offen lds
    v_mfma_f32_16x16x32_bf16 v[152:155], a[152:155], v[84:87], v[152:155]
    buffer_load_dwordx4 v233, s[44:47], s37 offen offset:1024 lds
    v_mfma_f32_16x16x32_bf16 v[152:155], a[168:171], v[88:91], v[152:155]
    v_mfma_f32_16x16x32_bf16 v[152:155], a[184:187], v[92:95], v[152:155]
    s_add_u32 m0, s31, 7168
    s_add_u32 s24, s27, 229376
    buffer_load_dwordx4 v237, s[12:15], s24 offen lds
    v_mfma_f32_16x16x32_bf16 v[156:159], a[140:143], v[80:83], v[156:159]
    s_add_u32 s27, s27, 1048576
    s_and_b32 s27, s27, 0x407fffff
    s_cmp_eq_u32 s27, s7
    s_cselect_b32 s27, s43, s27
    v_mfma_f32_16x16x32_bf16 v[156:159], a[156:159], v[84:87], v[156:159]
    v_mfma_f32_16x16x32_bf16 v[156:159], a[172:175], v[88:91], v[156:159]
    s_add_u32 s31, s31, 32768
    s_cmp_ge_u32 s31, 163840
    s_cselect_b32 s24, 98304, 0
    s_sub_u32 s31, s31, s24
    v_mfma_f32_16x16x32_bf16 v[156:159], a[188:191], v[92:95], v[156:159]
    s_waitcnt lgkmcnt(0)
    v_mfma_f32_16x16x32_bf16 v[96:99], a[192:195], v[64:67], v[96:99]
    ds_read_b128 v[80:83], v224 offset:51200
    v_mfma_f32_16x16x32_bf16 v[96:99], a[208:211], v[68:71], v[96:99]
    ds_read_b128 v[84:87], v225 offset:51200
    v_mfma_f32_16x16x32_bf16 v[96:99], a[224:227], v[72:75], v[96:99]
    ds_read_b128 v[88:91], v224 offset:59392
    v_mfma_f32_16x16x32_bf16 v[96:99], a[240:243], v[76:79], v[96:99]
    ds_read_b128 v[92:95], v225 offset:59392
    v_mfma_f32_16x16x32_bf16 v[100:103], a[196:199], v[64:67], v[100:103]
    v_mfma_f32_16x16x32_bf16 v[100:103], a[212:215], v[68:71], v[100:103]
    v_mfma_f32_16x16x32_bf16 v[100:103], a[228:231], v[72:75], v[100:103]
    s_add_u32 s38, s36, 32768
    buffer_store_dwordx4 v[36:39], v240, s[16:19], s38 offen offset:3328 sc1
    v_mfma_f32_16x16x32_bf16 v[100:103], a[244:247], v[76:79], v[100:103]
    v_mfma_f32_16x16x32_bf16 v[104:107], a[200:203], v[64:67], v[104:107]
    v_mfma_f32_16x16x32_bf16 v[104:107], a[216:219], v[68:71], v[104:107]
    v_mfma_f32_16x16x32_bf16 v[104:107], a[232:235], v[72:75], v[104:107]
    v_mfma_f32_16x16x32_bf16 v[104:107], a[248:251], v[76:79], v[104:107]
    v_mfma_f32_16x16x32_bf16 v[108:111], a[204:207], v[64:67], v[108:111]
    v_mfma_f32_16x16x32_bf16 v[108:111], a[220:223], v[68:71], v[108:111]
    v_mfma_f32_16x16x32_bf16 v[108:111], a[236:239], v[72:75], v[108:111]
    v_mfma_f32_16x16x32_bf16 v[108:111], a[252:255], v[76:79], v[108:111]
    s_waitcnt lgkmcnt(0)
    v_mfma_f32_16x16x32_bf16 v[112:115], a[192:195], v[80:83], v[112:115]
    ds_read_b128 v[64:67], v224 offset:53248
    v_mfma_f32_16x16x32_bf16 v[112:115], a[208:211], v[84:87], v[112:115]
    ds_read_b128 v[68:71], v225 offset:53248
    v_mfma_f32_16x16x32_bf16 v[112:115], a[224:227], v[88:91], v[112:115]
    ds_read_b128 v[72:75], v224 offset:61440
    v_mfma_f32_16x16x32_bf16 v[112:115], a[240:243], v[92:95], v[112:115]
    ds_read_b128 v[76:79], v225 offset:61440
    v_mfma_f32_16x16x32_bf16 v[116:119], a[196:199], v[80:83], v[116:119]
    v_mfma_f32_16x16x32_bf16 v[116:119], a[212:215], v[84:87], v[116:119]
    v_mfma_f32_16x16x32_bf16 v[116:119], a[228:231], v[88:91], v[116:119]
    v_mfma_f32_16x16x32_bf16 v[116:119], a[244:247], v[92:95], v[116:119]
    v_mfma_f32_16x16x32_bf16 v[120:123], a[200:203], v[80:83], v[120:123]
    s_add_u32 m0, s34, 40960
    s_add_u32 s37, s85, 196608
    buffer_load_dwordx4 v232, s[44:47], s37 offen lds
    v_mfma_f32_16x16x32_bf16 v[120:123], a[216:219], v[84:87], v[120:123]
    v_mfma_f32_16x16x32_bf16 v[120:123], a[232:235], v[88:91], v[120:123]
    v_mfma_f32_16x16x32_bf16 v[120:123], a[248:251], v[92:95], v[120:123]
    s_add_u32 s38, s36, 32768
    buffer_store_dwordx4 v[40:43], v240, s[16:19], s38 offen offset:2304 sc1
    v_mfma_f32_16x16x32_bf16 v[124:127], a[204:207], v[80:83], v[124:127]
    buffer_load_dwordx4 v233, s[44:47], s37 offen offset:1024 lds
    v_mfma_f32_16x16x32_bf16 v[124:127], a[220:223], v[84:87], v[124:127]
    v_mfma_f32_16x16x32_bf16 v[124:127], a[236:239], v[88:91], v[124:127]
    v_mfma_f32_16x16x32_bf16 v[124:127], a[252:255], v[92:95], v[124:127]
    s_waitcnt lgkmcnt(0)
    v_mfma_f32_16x16x32_bf16 v[128:131], a[192:195], v[64:67], v[128:131]
    ds_read_b128 v[80:83], v224 offset:55296
    v_mfma_f32_16x16x32_bf16 v[128:131], a[208:211], v[68:71], v[128:131]
    ds_read_b128 v[84:87], v225 offset:55296
    v_mfma_f32_16x16x32_bf16 v[128:131], a[224:227], v[72:75], v[128:131]
    ds_read_b128 v[88:91], v224 offset:63488
    v_mfma_f32_16x16x32_bf16 v[128:131], a[240:243], v[76:79], v[128:131]
    ds_read_b128 v[92:95], v225 offset:63488
    v_mfma_f32_16x16x32_bf16 v[132:135], a[196:199], v[64:67], v[132:135]
    v_mfma_f32_16x16x32_bf16 v[132:135], a[212:215], v[68:71], v[132:135]
    v_mfma_f32_16x16x32_bf16 v[132:135], a[228:231], v[72:75], v[132:135]
    v_mfma_f32_16x16x32_bf16 v[132:135], a[244:247], v[76:79], v[132:135]
    v_mfma_f32_16x16x32_bf16 v[136:139], a[200:203], v[64:67], v[136:139]
    s_add_u32 m0, s31, 0
    s_add_u32 s24, s27, 0
    buffer_load_dwordx4 v245, s[12:15], s24 offen lds
    v_mfma_f32_16x16x32_bf16 v[136:139], a[216:219], v[68:71], v[136:139]
    v_mfma_f32_16x16x32_bf16 v[136:139], a[232:235], v[72:75], v[136:139]
    v_mfma_f32_16x16x32_bf16 v[136:139], a[248:251], v[76:79], v[136:139]
    v_mfma_f32_16x16x32_bf16 v[140:143], a[204:207], v[64:67], v[140:143]
    v_mfma_f32_16x16x32_bf16 v[140:143], a[220:223], v[68:71], v[140:143]
    v_mfma_f32_16x16x32_bf16 v[140:143], a[236:239], v[72:75], v[140:143]
    v_mfma_f32_16x16x32_bf16 v[140:143], a[252:255], v[76:79], v[140:143]
    s_waitcnt vmcnt(23) lgkmcnt(0)
    s_barrier
    v_mfma_f32_16x16x32_bf16 v[144:147], a[192:195], v[80:83], v[144:147]
    ds_read_b128 v[64:67], v224 offset:0
    v_mfma_f32_16x16x32_bf16 v[144:147], a[208:211], v[84:87], v[144:147]
    ds_read_b128 v[68:71], v225 offset:0
    s_add_u32 s38, s36, 36864
    buffer_store_dwordx4 v[44:47], v240, s[16:19], s38 offen offset:256 sc1
    v_mfma_f32_16x16x32_bf16 v[144:147], a[224:227], v[88:91], v[144:147]
    ds_read_b128 v[72:75], v224 offset:8192
    v_mfma_f32_16x16x32_bf16 v[144:147], a[240:243], v[92:95], v[144:147]
    ds_read_b128 v[76:79], v225 offset:8192
    v_mfma_f32_16x16x32_bf16 v[148:151], a[196:199], v[80:83], v[148:151]
    v_mfma_f32_16x16x32_bf16 v[148:151], a[212:215], v[84:87], v[148:151]
    v_mfma_f32_16x16x32_bf16 v[148:151], a[228:231], v[88:91], v[148:151]
    v_mfma_f32_16x16x32_bf16 v[148:151], a[244:247], v[92:95], v[148:151]
    v_mfma_f32_16x16x32_bf16 v[152:155], a[200:203], v[80:83], v[152:155]
    s_add_u32 m0, s34, 49152
    s_add_u32 s37, s86, 196608
    buffer_load_dwordx4 v232, s[44:47], s37 offen lds
    v_mfma_f32_16x16x32_bf16 v[152:155], a[216:219], v[84:87], v[152:155]
    v_mfma_f32_16x16x32_bf16 v[152:155], a[232:235], v[88:91], v[152:155]
    buffer_load_dwordx4 v233, s[44:47], s37 offen offset:1024 lds
    v_mfma_f32_16x16x32_bf16 v[152:155], a[248:251], v[92:95], v[152:155]
    v_mfma_f32_16x16x32_bf16 v[156:159], a[204:207], v[80:83], v[156:159]
    v_mfma_f32_16x16x32_bf16 v[156:159], a[220:223], v[84:87], v[156:159]
    s_add_u32 m0, s31, 1024
    s_add_u32 s24, s27, 32768
    buffer_load_dwordx4 v245, s[12:15], s24 offen lds
    v_mfma_f32_16x16x32_bf16 v[156:159], a[236:239], v[88:91], v[156:159]
    v_mfma_f32_16x16x32_bf16 v[156:159], a[252:255], v[92:95], v[156:159]
    s_waitcnt lgkmcnt(0)
    v_mfma_f32_16x16x32_bf16 v[160:163], a[0:3], v[64:67], 0
    ds_read_b128 v[80:83], v224 offset:2048
    v_mfma_f32_16x16x32_bf16 v[160:163], a[16:19], v[68:71], v[160:163]
    ds_read_b128 v[84:87], v225 offset:2048
    v_mfma_f32_16x16x32_bf16 v[160:163], a[32:35], v[72:75], v[160:163]
    ds_read_b128 v[88:91], v224 offset:10240
    v_mfma_f32_16x16x32_bf16 v[160:163], a[48:51], v[76:79], v[160:163]
    ds_read_b128 v[92:95], v225 offset:10240
    v_mfma_f32_16x16x32_bf16 v[164:167], a[4:7], v[64:67], 0
    v_cvt_pk_bf16_f32 v0, v96, v97
    v_cvt_pk_bf16_f32 v1, v98, v99
    v_mfma_f32_16x16x32_bf16 v[164:167], a[20:23], v[68:71], v[164:167]
    v_mfma_f32_16x16x32_bf16 v[164:167], a[36:39], v[72:75], v[164:167]
    v_cvt_pk_bf16_f32 v2, v100, v101
    v_cvt_pk_bf16_f32 v3, v102, v103
    s_add_u32 s38, s36, 40960
    buffer_store_dwordx4 v[48:51], v240, s[16:19], s38 offen offset:1280 sc1
    v_mfma_f32_16x16x32_bf16 v[164:167], a[52:55], v[76:79], v[164:167]
    v_mfma_f32_16x16x32_bf16 v[168:171], a[8:11], v[64:67], 0
    s_add_u32 m0, s31, 2048
    s_add_u32 s24, s27, 65536
    buffer_load_dwordx4 v237, s[12:15], s24 offen lds
    v_cvt_pk_bf16_f32 v4, v104, v105
    v_cvt_pk_bf16_f32 v5, v106, v107
    v_mfma_f32_16x16x32_bf16 v[168:171], a[24:27], v[68:71], v[168:171]
    v_mfma_f32_16x16x32_bf16 v[168:171], a[40:43], v[72:75], v[168:171]
    v_cvt_pk_bf16_f32 v6, v108, v109
    v_cvt_pk_bf16_f32 v7, v110, v111
    v_mfma_f32_16x16x32_bf16 v[168:171], a[56:59], v[76:79], v[168:171]
    v_mfma_f32_16x16x32_bf16 v[172:175], a[12:15], v[64:67], 0
    v_cvt_pk_bf16_f32 v8, v112, v113
    v_cvt_pk_bf16_f32 v9, v114, v115
    v_mfma_f32_16x16x32_bf16 v[172:175], a[28:31], v[68:71], v[172:175]
    v_mfma_f32_16x16x32_bf16 v[172:175], a[44:47], v[72:75], v[172:175]
    v_cvt_pk_bf16_f32 v10, v116, v117
    v_cvt_pk_bf16_f32 v11, v118, v119
    v_mfma_f32_16x16x32_bf16 v[172:175], a[60:63], v[76:79], v[172:175]
    s_waitcnt lgkmcnt(0)
    v_mfma_f32_16x16x32_bf16 v[176:179], a[0:3], v[80:83], 0
    ds_read_b128 v[64:67], v224 offset:4096
    v_cvt_pk_bf16_f32 v12, v120, v121
    v_cvt_pk_bf16_f32 v13, v122, v123
    v_mfma_f32_16x16x32_bf16 v[176:179], a[16:19], v[84:87], v[176:179]
    ds_read_b128 v[68:71], v225 offset:4096
    v_mfma_f32_16x16x32_bf16 v[176:179], a[32:35], v[88:91], v[176:179]
    ds_read_b128 v[72:75], v224 offset:12288
    v_cvt_pk_bf16_f32 v14, v124, v125
    v_cvt_pk_bf16_f32 v15, v126, v127
    v_mfma_f32_16x16x32_bf16 v[176:179], a[48:51], v[92:95], v[176:179]
    ds_read_b128 v[76:79], v225 offset:12288
    v_mfma_f32_16x16x32_bf16 v[180:183], a[4:7], v[80:83], 0
    v_cvt_pk_bf16_f32 v16, v128, v129
    v_cvt_pk_bf16_f32 v17, v130, v131
    v_mfma_f32_16x16x32_bf16 v[180:183], a[20:23], v[84:87], v[180:183]
    v_mfma_f32_16x16x32_bf16 v[180:183], a[36:39], v[88:91], v[180:183]
    v_cvt_pk_bf16_f32 v18, v132, v133
    v_cvt_pk_bf16_f32 v19, v134, v135
    v_mfma_f32_16x16x32_bf16 v[180:183], a[52:55], v[92:95], v[180:183]
    v_mfma_f32_16x16x32_bf16 v[184:187], a[8:11], v[80:83], 0
    s_add_u32 m0, s34, 57344
    s_add_u32 s37, s87, 196608
    buffer_load_dwordx4 v232, s[44:47], s37 offen lds
    v_cvt_pk_bf16_f32 v20, v136, v137
    v_cvt_pk_bf16_f32 v21, v138, v139
    v_mfma_f32_16x16x32_bf16 v[184:187], a[24:27], v[84:87], v[184:187]
    v_mfma_f32_16x16x32_bf16 v[184:187], a[40:43], v[88:91], v[184:187]
    buffer_load_dwordx4 v233, s[44:47], s37 offen offset:1024 lds
    v_cvt_pk_bf16_f32 v22, v140, v141
    v_cvt_pk_bf16_f32 v23, v142, v143
    v_mfma_f32_16x16x32_bf16 v[184:187], a[56:59], v[92:95], v[184:187]
    v_mfma_f32_16x16x32_bf16 v[188:191], a[12:15], v[80:83], 0
    v_cvt_pk_bf16_f32 v24, v144, v145
    v_cvt_pk_bf16_f32 v25, v146, v147
    s_add_u32 s38, s36, 40960
    buffer_store_dwordx4 v[52:55], v240, s[16:19], s38 offen offset:3328 sc1
    v_mfma_f32_16x16x32_bf16 v[188:191], a[28:31], v[84:87], v[188:191]
    s_add_u32 m0, s31, 3072
    s_add_u32 s24, s27, 98304
    buffer_load_dwordx4 v237, s[12:15], s24 offen lds
    v_mfma_f32_16x16x32_bf16 v[188:191], a[44:47], v[88:91], v[188:191]
    v_cvt_pk_bf16_f32 v26, v148, v149
    v_cvt_pk_bf16_f32 v27, v150, v151
    v_mfma_f32_16x16x32_bf16 v[188:191], a[60:63], v[92:95], v[188:191]
    s_waitcnt lgkmcnt(0)
    v_mfma_f32_16x16x32_bf16 v[192:195], a[0:3], v[64:67], 0
    ds_read_b128 v[80:83], v224 offset:6144
    v_cvt_pk_bf16_f32 v28, v152, v153
    v_cvt_pk_bf16_f32 v29, v154, v155
    v_mfma_f32_16x16x32_bf16 v[192:195], a[16:19], v[68:71], v[192:195]
    ds_read_b128 v[84:87], v225 offset:6144
    v_mfma_f32_16x16x32_bf16 v[192:195], a[32:35], v[72:75], v[192:195]
    ds_read_b128 v[88:91], v224 offset:14336
    v_cvt_pk_bf16_f32 v30, v156, v157
    v_cvt_pk_bf16_f32 v31, v158, v159
    v_mfma_f32_16x16x32_bf16 v[192:195], a[48:51], v[76:79], v[192:195]
    ds_read_b128 v[92:95], v225 offset:14336
    v_mfma_f32_16x16x32_bf16 v[196:199], a[4:7], v[64:67], 0
    v_mfma_f32_16x16x32_bf16 v[196:199], a[20:23], v[68:71], v[196:199]
    v_mfma_f32_16x16x32_bf16 v[196:199], a[36:39], v[72:75], v[196:199]
    v_mfma_f32_16x16x32_bf16 v[196:199], a[52:55], v[76:79], v[196:199]
    v_mfma_f32_16x16x32_bf16 v[200:203], a[8:11], v[64:67], 0
    s_add_u32 m0, s31, 4096
    s_add_u32 s24, s27, 131072
    buffer_load_dwordx4 v245, s[12:15], s24 offen lds
    v_mfma_f32_16x16x32_bf16 v[200:203], a[24:27], v[68:71], v[200:203]
    v_mfma_f32_16x16x32_bf16 v[200:203], a[40:43], v[72:75], v[200:203]
    v_mfma_f32_16x16x32_bf16 v[200:203], a[56:59], v[76:79], v[200:203]
    v_mfma_f32_16x16x32_bf16 v[204:207], a[12:15], v[64:67], 0
    v_mfma_f32_16x16x32_bf16 v[204:207], a[28:31], v[68:71], v[204:207]
    v_mfma_f32_16x16x32_bf16 v[204:207], a[44:47], v[72:75], v[204:207]
    v_mfma_f32_16x16x32_bf16 v[204:207], a[60:63], v[76:79], v[204:207]
    s_waitcnt vmcnt(23) lgkmcnt(0)
    s_barrier
    v_mfma_f32_16x16x32_bf16 v[208:211], a[0:3], v[80:83], 0
    ds_read_b128 v[64:67], v224 offset:16384
    v_mfma_f32_16x16x32_bf16 v[208:211], a[16:19], v[84:87], v[208:211]
    ds_read_b128 v[68:71], v225 offset:16384
    s_add_u32 s38, s36, 40960
    buffer_store_dwordx4 v[56:59], v240, s[16:19], s38 offen offset:2304 sc1
    v_mfma_f32_16x16x32_bf16 v[208:211], a[32:35], v[88:91], v[208:211]
    ds_read_b128 v[72:75], v224 offset:24576
    v_mfma_f32_16x16x32_bf16 v[208:211], a[48:51], v[92:95], v[208:211]
    ds_read_b128 v[76:79], v225 offset:24576
    v_mfma_f32_16x16x32_bf16 v[212:215], a[4:7], v[80:83], 0
    v_mfma_f32_16x16x32_bf16 v[212:215], a[20:23], v[84:87], v[212:215]
    v_mfma_f32_16x16x32_bf16 v[212:215], a[36:39], v[88:91], v[212:215]
    v_mfma_f32_16x16x32_bf16 v[212:215], a[52:55], v[92:95], v[212:215]
    v_mfma_f32_16x16x32_bf16 v[216:219], a[8:11], v[80:83], 0
    s_add_u32 m0, s31, 5120
    s_add_u32 s24, s27, 163840
    buffer_load_dwordx4 v245, s[12:15], s24 offen lds
    v_mfma_f32_16x16x32_bf16 v[216:219], a[24:27], v[84:87], v[216:219]
    v_mfma_f32_16x16x32_bf16 v[216:219], a[40:43], v[88:91], v[216:219]
    v_mfma_f32_16x16x32_bf16 v[216:219], a[56:59], v[92:95], v[216:219]
    v_mfma_f32_16x16x32_bf16 v[220:223], a[12:15], v[80:83], 0
    v_mfma_f32_16x16x32_bf16 v[220:223], a[28:31], v[84:87], v[220:223]
    v_mfma_f32_16x16x32_bf16 v[220:223], a[44:47], v[88:91], v[220:223]
    v_mfma_f32_16x16x32_bf16 v[220:223], a[60:63], v[92:95], v[220:223]
    s_waitcnt lgkmcnt(0)
    v_mfma_f32_16x16x32_bf16 v[160:163], a[64:67], v[64:67], v[160:163]
    ds_read_b128 v[80:83], v224 offset:18432
    v_mfma_f32_16x16x32_bf16 v[160:163], a[80:83], v[68:71], v[160:163]
    ds_read_b128 v[84:87], v225 offset:18432
    v_mfma_f32_16x16x32_bf16 v[160:163], a[96:99], v[72:75], v[160:163]
    ds_read_b128 v[88:91], v224 offset:26624
    v_mfma_f32_16x16x32_bf16 v[160:163], a[112:115], v[76:79], v[160:163]
    ds_read_b128 v[92:95], v225 offset:26624
    v_mfma_f32_16x16x32_bf16 v[164:167], a[68:71], v[64:67], v[164:167]
    v_mfma_f32_16x16x32_bf16 v[164:167], a[84:87], v[68:71], v[164:167]
    v_mfma_f32_16x16x32_bf16 v[164:167], a[100:103], v[72:75], v[164:167]
    v_mfma_f32_16x16x32_bf16 v[164:167], a[116:119], v[76:79], v[164:167]
    s_add_u32 s38, s36, 45056
    buffer_store_dwordx4 v[60:63], v240, s[16:19], s38 offen offset:256 sc1
    v_mfma_f32_16x16x32_bf16 v[168:171], a[72:75], v[64:67], v[168:171]
    s_add_u32 m0, s31, 6144
    s_add_u32 s24, s27, 196608
    buffer_load_dwordx4 v237, s[12:15], s24 offen lds
    v_mfma_f32_16x16x32_bf16 v[168:171], a[88:91], v[68:71], v[168:171]
    v_mfma_f32_16x16x32_bf16 v[168:171], a[104:107], v[72:75], v[168:171]
    v_mfma_f32_16x16x32_bf16 v[168:171], a[120:123], v[76:79], v[168:171]
    v_mfma_f32_16x16x32_bf16 v[172:175], a[76:79], v[64:67], v[172:175]
    v_mfma_f32_16x16x32_bf16 v[172:175], a[92:95], v[68:71], v[172:175]
    v_mfma_f32_16x16x32_bf16 v[172:175], a[108:111], v[72:75], v[172:175]
    v_mfma_f32_16x16x32_bf16 v[172:175], a[124:127], v[76:79], v[172:175]
    s_waitcnt lgkmcnt(0)
    v_mfma_f32_16x16x32_bf16 v[176:179], a[64:67], v[80:83], v[176:179]
    ds_read_b128 v[64:67], v224 offset:20480
    v_mfma_f32_16x16x32_bf16 v[176:179], a[80:83], v[84:87], v[176:179]
    ds_read_b128 v[68:71], v225 offset:20480
    v_mfma_f32_16x16x32_bf16 v[176:179], a[96:99], v[88:91], v[176:179]
    ds_read_b128 v[72:75], v224 offset:28672
    v_mfma_f32_16x16x32_bf16 v[176:179], a[112:115], v[92:95], v[176:179]
    ds_read_b128 v[76:79], v225 offset:28672
    v_mfma_f32_16x16x32_bf16 v[180:183], a[68:71], v[80:83], v[180:183]
    v_mfma_f32_16x16x32_bf16 v[180:183], a[84:87], v[84:87], v[180:183]
    v_mfma_f32_16x16x32_bf16 v[180:183], a[100:103], v[88:91], v[180:183]
    v_mfma_f32_16x16x32_bf16 v[180:183], a[116:119], v[92:95], v[180:183]
    v_mfma_f32_16x16x32_bf16 v[184:187], a[72:75], v[80:83], v[184:187]
    s_add_u32 m0, s31, 7168
    s_add_u32 s24, s27, 229376
    buffer_load_dwordx4 v237, s[12:15], s24 offen lds
    v_mfma_f32_16x16x32_bf16 v[184:187], a[88:91], v[84:87], v[184:187]
    v_mfma_f32_16x16x32_bf16 v[184:187], a[104:107], v[88:91], v[184:187]
    s_add_u32 s27, s27, 1048576
    s_and_b32 s27, s27, 0x407fffff
    s_cmp_eq_u32 s27, s7
    s_cselect_b32 s27, s43, s27
    v_mfma_f32_16x16x32_bf16 v[184:187], a[120:123], v[92:95], v[184:187]
    v_mfma_f32_16x16x32_bf16 v[188:191], a[76:79], v[80:83], v[188:191]
    v_mfma_f32_16x16x32_bf16 v[188:191], a[92:95], v[84:87], v[188:191]
    s_add_u32 s31, s31, 32768
    s_cmp_ge_u32 s31, 163840
    s_cselect_b32 s24, 98304, 0
    s_sub_u32 s31, s31, s24
    s_add_u32 s38, s36, 65536
    buffer_store_dwordx4 v[0:3], v240, s[16:19], s38 offen offset:2560 sc1
    v_mfma_f32_16x16x32_bf16 v[188:191], a[108:111], v[88:91], v[188:191]
    v_mfma_f32_16x16x32_bf16 v[188:191], a[124:127], v[92:95], v[188:191]
    s_waitcnt lgkmcnt(0)
    v_mfma_f32_16x16x32_bf16 v[192:195], a[64:67], v[64:67], v[192:195]
    ds_read_b128 v[80:83], v224 offset:22528
    v_mfma_f32_16x16x32_bf16 v[192:195], a[80:83], v[68:71], v[192:195]
    ds_read_b128 v[84:87], v225 offset:22528
    v_mfma_f32_16x16x32_bf16 v[192:195], a[96:99], v[72:75], v[192:195]
    ds_read_b128 v[88:91], v224 offset:30720
    v_mfma_f32_16x16x32_bf16 v[192:195], a[112:115], v[76:79], v[192:195]
    ds_read_b128 v[92:95], v225 offset:30720
    v_mfma_f32_16x16x32_bf16 v[196:199], a[68:71], v[64:67], v[196:199]
    v_mfma_f32_16x16x32_bf16 v[196:199], a[84:87], v[68:71], v[196:199]
    v_mfma_f32_16x16x32_bf16 v[196:199], a[100:103], v[72:75], v[196:199]
    v_mfma_f32_16x16x32_bf16 v[196:199], a[116:119], v[76:79], v[196:199]
    v_mfma_f32_16x16x32_bf16 v[200:203], a[72:75], v[64:67], v[200:203]
    v_mfma_f32_16x16x32_bf16 v[200:203], a[88:91], v[68:71], v[200:203]
    v_mfma_f32_16x16x32_bf16 v[200:203], a[104:107], v[72:75], v[200:203]
    v_mfma_f32_16x16x32_bf16 v[200:203], a[120:123], v[76:79], v[200:203]
    v_mfma_f32_16x16x32_bf16 v[204:207], a[76:79], v[64:67], v[204:207]
    v_mfma_f32_16x16x32_bf16 v[204:207], a[92:95], v[68:71], v[204:207]
    v_mfma_f32_16x16x32_bf16 v[204:207], a[108:111], v[72:75], v[204:207]
    v_mfma_f32_16x16x32_bf16 v[204:207], a[124:127], v[76:79], v[204:207]
    s_waitcnt vmcnt(9) lgkmcnt(0)
    s_barrier
    v_mfma_f32_16x16x32_bf16 v[208:211], a[64:67], v[80:83], v[208:211]
    ds_read_b128 v[64:67], v224 offset:32768
    v_mfma_f32_16x16x32_bf16 v[208:211], a[80:83], v[84:87], v[208:211]
    ds_read_b128 v[68:71], v225 offset:32768
    v_mfma_f32_16x16x32_bf16 v[208:211], a[96:99], v[88:91], v[208:211]
    ds_read_b128 v[72:75], v224 offset:40960
    s_add_u32 s38, s36, 69632
    buffer_store_dwordx4 v[4:7], v240, s[16:19], s38 offen offset:512 sc1
    v_mfma_f32_16x16x32_bf16 v[208:211], a[112:115], v[92:95], v[208:211]
    ds_read_b128 v[76:79], v225 offset:40960
    v_mfma_f32_16x16x32_bf16 v[212:215], a[68:71], v[80:83], v[212:215]
    v_mfma_f32_16x16x32_bf16 v[212:215], a[84:87], v[84:87], v[212:215]
    v_mfma_f32_16x16x32_bf16 v[212:215], a[100:103], v[88:91], v[212:215]
    v_mfma_f32_16x16x32_bf16 v[212:215], a[116:119], v[92:95], v[212:215]
    v_mfma_f32_16x16x32_bf16 v[216:219], a[72:75], v[80:83], v[216:219]
    v_mfma_f32_16x16x32_bf16 v[216:219], a[88:91], v[84:87], v[216:219]
    v_mfma_f32_16x16x32_bf16 v[216:219], a[104:107], v[88:91], v[216:219]
    v_mfma_f32_16x16x32_bf16 v[216:219], a[120:123], v[92:95], v[216:219]
    v_mfma_f32_16x16x32_bf16 v[220:223], a[76:79], v[80:83], v[220:223]
    v_mfma_f32_16x16x32_bf16 v[220:223], a[92:95], v[84:87], v[220:223]
    v_mfma_f32_16x16x32_bf16 v[220:223], a[108:111], v[88:91], v[220:223]
    v_mfma_f32_16x16x32_bf16 v[220:223], a[124:127], v[92:95], v[220:223]
    s_waitcnt lgkmcnt(0)
    v_mfma_f32_16x16x32_bf16 v[160:163], a[128:131], v[64:67], v[160:163]
    ds_read_b128 v[80:83], v224 offset:34816
    v_mfma_f32_16x16x32_bf16 v[160:163], a[144:147], v[68:71], v[160:163]
    ds_read_b128 v[84:87], v225 offset:34816
    v_mfma_f32_16x16x32_bf16 v[160:163], a[160:163], v[72:75], v[160:163]
    ds_read_b128 v[88:91], v224 offset:43008
    v_mfma_f32_16x16x32_bf16 v[160:163], a[176:179], v[76:79], v[160:163]
    ds_read_b128 v[92:95], v225 offset:43008
    v_mfma_f32_16x16x32_bf16 v[164:167], a[132:135], v[64:67], v[164:167]
    v_mfma_f32_16x16x32_bf16 v[164:167], a[148:151], v[68:71], v[164:167]
    v_mfma_f32_16x16x32_bf16 v[164:167], a[164:167], v[72:75], v[164:167]
    v_mfma_f32_16x16x32_bf16 v[164:167], a[180:183], v[76:79], v[164:167]
    v_mfma_f32_16x16x32_bf16 v[168:171], a[136:139], v[64:67], v[168:171]
    buffer_load_dword v254, off, s[88:91], s39 sc1
    s_add_u32 s38, s36, 65536
    buffer_store_dwordx4 v[8:11], v240, s[16:19], s38 offen offset:3584 sc1
    v_mfma_f32_16x16x32_bf16 v[168:171], a[152:155], v[68:71], v[168:171]
    v_mfma_f32_16x16x32_bf16 v[168:171], a[168:171], v[72:75], v[168:171]
    v_mfma_f32_16x16x32_bf16 v[168:171], a[184:187], v[76:79], v[168:171]
    v_mfma_f32_16x16x32_bf16 v[172:175], a[140:143], v[64:67], v[172:175]
    v_mfma_f32_16x16x32_bf16 v[172:175], a[156:159], v[68:71], v[172:175]
    v_mfma_f32_16x16x32_bf16 v[172:175], a[172:175], v[72:75], v[172:175]
    v_mfma_f32_16x16x32_bf16 v[172:175], a[188:191], v[76:79], v[172:175]
    s_waitcnt lgkmcnt(0)
    v_mfma_f32_16x16x32_bf16 v[176:179], a[128:131], v[80:83], v[176:179]
    ds_read_b128 v[64:67], v224 offset:36864
    v_mfma_f32_16x16x32_bf16 v[176:179], a[144:147], v[84:87], v[176:179]
    ds_read_b128 v[68:71], v225 offset:36864
    v_mfma_f32_16x16x32_bf16 v[176:179], a[160:163], v[88:91], v[176:179]
    ds_read_b128 v[72:75], v224 offset:45056
    v_mfma_f32_16x16x32_bf16 v[176:179], a[176:179], v[92:95], v[176:179]
    ds_read_b128 v[76:79], v225 offset:45056
    v_mfma_f32_16x16x32_bf16 v[180:183], a[132:135], v[80:83], v[180:183]
    v_mfma_f32_16x16x32_bf16 v[180:183], a[148:151], v[84:87], v[180:183]
    v_mfma_f32_16x16x32_bf16 v[180:183], a[164:167], v[88:91], v[180:183]
    v_mfma_f32_16x16x32_bf16 v[180:183], a[180:183], v[92:95], v[180:183]
    v_mfma_f32_16x16x32_bf16 v[184:187], a[136:139], v[80:83], v[184:187]
    v_mfma_f32_16x16x32_bf16 v[184:187], a[152:155], v[84:87], v[184:187]
    v_mfma_f32_16x16x32_bf16 v[184:187], a[168:171], v[88:91], v[184:187]
    v_mfma_f32_16x16x32_bf16 v[184:187], a[184:187], v[92:95], v[184:187]
    v_mfma_f32_16x16x32_bf16 v[188:191], a[140:143], v[80:83], v[188:191]
    v_mfma_f32_16x16x32_bf16 v[188:191], a[156:159], v[84:87], v[188:191]
    s_add_u32 s38, s36, 69632
    buffer_store_dwordx4 v[12:15], v240, s[16:19], s38 offen offset:1536 sc1
    v_mfma_f32_16x16x32_bf16 v[188:191], a[172:175], v[88:91], v[188:191]
    v_mfma_f32_16x16x32_bf16 v[188:191], a[188:191], v[92:95], v[188:191]
    s_waitcnt lgkmcnt(0)
    v_mfma_f32_16x16x32_bf16 v[192:195], a[128:131], v[64:67], v[192:195]
    ds_read_b128 v[80:83], v224 offset:38912
    v_mfma_f32_16x16x32_bf16 v[192:195], a[144:147], v[68:71], v[192:195]
    ds_read_b128 v[84:87], v225 offset:38912
    v_mfma_f32_16x16x32_bf16 v[192:195], a[160:163], v[72:75], v[192:195]
    ds_read_b128 v[88:91], v224 offset:47104
    v_mfma_f32_16x16x32_bf16 v[192:195], a[176:179], v[76:79], v[192:195]
    ds_read_b128 v[92:95], v225 offset:47104
    v_mfma_f32_16x16x32_bf16 v[196:199], a[132:135], v[64:67], v[196:199]
    v_mfma_f32_16x16x32_bf16 v[196:199], a[148:151], v[68:71], v[196:199]
    v_mfma_f32_16x16x32_bf16 v[196:199], a[164:167], v[72:75], v[196:199]
    v_mfma_f32_16x16x32_bf16 v[196:199], a[180:183], v[76:79], v[196:199]
    v_mfma_f32_16x16x32_bf16 v[200:203], a[136:139], v[64:67], v[200:203]
    v_mfma_f32_16x16x32_bf16 v[200:203], a[152:155], v[68:71], v[200:203]
    v_mfma_f32_16x16x32_bf16 v[200:203], a[168:171], v[72:75], v[200:203]
    v_mfma_f32_16x16x32_bf16 v[200:203], a[184:187], v[76:79], v[200:203]
    v_mfma_f32_16x16x32_bf16 v[204:207], a[140:143], v[64:67], v[204:207]
    v_mfma_f32_16x16x32_bf16 v[204:207], a[156:159], v[68:71], v[204:207]
    v_mfma_f32_16x16x32_bf16 v[204:207], a[172:175], v[72:75], v[204:207]
    v_mfma_f32_16x16x32_bf16 v[204:207], a[188:191], v[76:79], v[204:207]
    s_waitcnt lgkmcnt(0)
    v_mfma_f32_16x16x32_bf16 v[208:211], a[128:131], v[80:83], v[208:211]
    ds_read_b128 v[64:67], v224 offset:49152
    v_mfma_f32_16x16x32_bf16 v[208:211], a[144:147], v[84:87], v[208:211]
    ds_read_b128 v[68:71], v224 offset:51200
    v_mfma_f32_16x16x32_bf16 v[208:211], a[160:163], v[88:91], v[208:211]
    ds_read_b128 v[72:75], v224 offset:53248
    v_mfma_f32_16x16x32_bf16 v[208:211], a[176:179], v[92:95], v[208:211]
    ds_read_b128 v[76:79], v224 offset:55296
    s_add_u32 s38, s36, 73728
    buffer_store_dwordx4 v[16:19], v240, s[16:19], s38 offen offset:2560 sc1
    v_mfma_f32_16x16x32_bf16 v[212:215], a[132:135], v[80:83], v[212:215]
    v_mfma_f32_16x16x32_bf16 v[212:215], a[148:151], v[84:87], v[212:215]
    v_mfma_f32_16x16x32_bf16 v[212:215], a[164:167], v[88:91], v[212:215]
    v_mfma_f32_16x16x32_bf16 v[212:215], a[180:183], v[92:95], v[212:215]
    v_mfma_f32_16x16x32_bf16 v[216:219], a[136:139], v[80:83], v[216:219]
    v_mfma_f32_16x16x32_bf16 v[216:219], a[152:155], v[84:87], v[216:219]
    v_mfma_f32_16x16x32_bf16 v[216:219], a[168:171], v[88:91], v[216:219]
    v_mfma_f32_16x16x32_bf16 v[216:219], a[184:187], v[92:95], v[216:219]
    v_mfma_f32_16x16x32_bf16 v[220:223], a[140:143], v[80:83], v[220:223]
    v_mfma_f32_16x16x32_bf16 v[220:223], a[156:159], v[84:87], v[220:223]
    v_mfma_f32_16x16x32_bf16 v[220:223], a[172:175], v[88:91], v[220:223]
    v_mfma_f32_16x16x32_bf16 v[220:223], a[188:191], v[92:95], v[220:223]
    s_waitcnt vmcnt(3)
    v_readfirstlane_b32 s24, v254
    s_lshl_b32 s25, s3, 16
    s_add_u32 s24, s24, s25
    s_cmp_ge_u32 s24, 32
    s_cbranch_scc0 kf_spin33
kf_spinr34:
    s_waitcnt lgkmcnt(0)
    s_barrier
    v_mfma_f32_16x16x32_bf16 v[160:163], a[192:195], v[64:67], v[160:163]
    ds_read_b128 v[80:83], v225 offset:49152
    v_mfma_f32_16x16x32_bf16 v[164:167], a[196:199], v[64:67], v[164:167]
    ds_read_b128 v[84:87], v225 offset:51200
    v_mfma_f32_16x16x32_bf16 v[168:171], a[200:203], v[64:67], v[168:171]
    ds_read_b128 v[88:91], v225 offset:53248
    v_mfma_f32_16x16x32_bf16 v[172:175], a[204:207], v[64:67], v[172:175]
    ds_read_b128 v[92:95], v225 offset:55296
    v_mfma_f32_16x16x32_bf16 v[176:179], a[192:195], v[68:71], v[176:179]
    v_mfma_f32_16x16x32_bf16 v[180:183], a[196:199], v[68:71], v[180:183]
    v_mfma_f32_16x16x32_bf16 v[184:187], a[200:203], v[68:71], v[184:187]
    v_mfma_f32_16x16x32_bf16 v[188:191], a[204:207], v[68:71], v[188:191]
    v_mfma_f32_16x16x32_bf16 v[192:195], a[192:195], v[72:75], v[192:195]
    buffer_load_dwordx4 a[128:131], v248, s[8:11], s28 offen offset:0 sc1
    s_add_u32 s38, s36, 77824
    buffer_store_dwordx4 v[20:23], v240, s[16:19], s38 offen offset:512 sc1
    v_mfma_f32_16x16x32_bf16 v[196:199], a[196:199], v[72:75], v[196:199]
    v_mfma_f32_16x16x32_bf16 v[200:203], a[200:203], v[72:75], v[200:203]
    buffer_load_dwordx4 a[132:135], v248, s[8:11], s29 offen offset:0 sc1
    v_mfma_f32_16x16x32_bf16 v[204:207], a[204:207], v[72:75], v[204:207]
    v_mfma_f32_16x16x32_bf16 v[208:211], a[192:195], v[76:79], v[208:211]
    v_mfma_f32_16x16x32_bf16 v[212:215], a[196:199], v[76:79], v[212:215]
    buffer_load_dwordx4 a[136:139], v249, s[8:11], s28 offen offset:0 sc1
    v_mfma_f32_16x16x32_bf16 v[216:219], a[200:203], v[76:79], v[216:219]
    v_mfma_f32_16x16x32_bf16 v[220:223], a[204:207], v[76:79], v[220:223]
    s_waitcnt lgkmcnt(0)
    v_mfma_f32_16x16x32_bf16 v[160:163], a[208:211], v[80:83], v[160:163]
    ds_read_b128 v[64:67], v224 offset:57344
    v_mfma_f32_16x16x32_bf16 v[164:167], a[212:215], v[80:83], v[164:167]
    ds_read_b128 v[68:71], v224 offset:59392
    v_mfma_f32_16x16x32_bf16 v[168:171], a[216:219], v[80:83], v[168:171]
    ds_read_b128 v[72:75], v224 offset:61440
    v_mfma_f32_16x16x32_bf16 v[172:175], a[220:223], v[80:83], v[172:175]
    ds_read_b128 v[76:79], v224 offset:63488
    v_mfma_f32_16x16x32_bf16 v[176:179], a[208:211], v[84:87], v[176:179]
    v_mfma_f32_16x16x32_bf16 v[180:183], a[212:215], v[84:87], v[180:183]
    v_mfma_f32_16x16x32_bf16 v[184:187], a[216:219], v[84:87], v[184:187]
    v_mfma_f32_16x16x32_bf16 v[188:191], a[220:223], v[84:87], v[188:191]
    v_mfma_f32_16x16x32_bf16 v[192:195], a[208:211], v[88:91], v[192:195]
    buffer_load_dwordx4 a[140:143], v249, s[8:11], s29 offen offset:0 sc1
    v_mfma_f32_16x16x32_bf16 v[196:199], a[212:215], v[88:91], v[196:199]
    v_mfma_f32_16x16x32_bf16 v[200:203], a[216:219], v[88:91], v[200:203]
    buffer_load_dwordx4 a[144:147], v248, s[8:11], s28 offen offset:1024 sc1
    v_mfma_f32_16x16x32_bf16 v[204:207], a[220:223], v[88:91], v[204:207]
    v_mfma_f32_16x16x32_bf16 v[208:211], a[208:211], v[92:95], v[208:211]
    v_mfma_f32_16x16x32_bf16 v[212:215], a[212:215], v[92:95], v[212:215]
    buffer_load_dwordx4 a[148:151], v248, s[8:11], s29 offen offset:1024 sc1
    v_mfma_f32_16x16x32_bf16 v[216:219], a[216:219], v[92:95], v[216:219]
    s_add_u32 s38, s36, 73728
    buffer_store_dwordx4 v[24:27], v240, s[16:19], s38 offen offset:3584 sc1
    v_mfma_f32_16x16x32_bf16 v[220:223], a[220:223], v[92:95], v[220:223]
    s_waitcnt lgkmcnt(0)
    v_mfma_f32_16x16x32_bf16 v[160:163], a[224:227], v[64:67], v[160:163]
    ds_read_b128 v[80:83], v225 offset:57344
    v_mfma_f32_16x16x32_bf16 v[164:167], a[228:231], v[64:67], v[164:167]
    ds_read_b128 v[84:87], v225 offset:59392
    v_mfma_f32_16x16x32_bf16 v[168:171], a[232:235], v[64:67], v[168:171]
    ds_read_b128 v[88:91], v225 offset:61440
    v_mfma_f32_16x16x32_bf16 v[172:175], a[236:239], v[64:67], v[172:175]
    ds_read_b128 v[92:95], v225 offset:63488
    v_mfma_f32_16x16x32_bf16 v[176:179], a[224:227], v[68:71], v[176:179]
    v_mfma_f32_16x16x32_bf16 v[180:183], a[228:231], v[68:71], v[180:183]
    v_mfma_f32_16x16x32_bf16 v[184:187], a[232:235], v[68:71], v[184:187]
    v_mfma_f32_16x16x32_bf16 v[188:191], a[236:239], v[68:71], v[188:191]
    v_mfma_f32_16x16x32_bf16 v[192:195], a[224:227], v[72:75], v[192:195]
    buffer_load_dwordx4 a[152:155], v249, s[8:11], s28 offen offset:1024 sc1
    v_mfma_f32_16x16x32_bf16 v[196:199], a[228:231], v[72:75], v[196:199]
    v_mfma_f32_16x16x32_bf16 v[200:203], a[232:235], v[72:75], v[200:203]
    buffer_load_dwordx4 a[156:159], v249, s[8:11], s29 offen offset:1024 sc1
    v_mfma_f32_16x16x32_bf16 v[204:207], a[236:239], v[72:75], v[204:207]
    v_mfma_f32_16x16x32_bf16 v[208:211], a[224:227], v[76:79], v[208:211]
    v_mfma_f32_16x16x32_bf16 v[212:215], a[228:231], v[76:79], v[212:215]
    buffer_load_dwordx4 a[160:163], v248, s[8:11], s28 offen offset:2048 sc1
    v_mfma_f32_16x16x32_bf16 v[216:219], a[232:235], v[76:79], v[216:219]
    v_mfma_f32_16x16x32_bf16 v[220:223], a[236:239], v[76:79], v[220:223]
    s_waitcnt vmcnt(38) lgkmcnt(0)
    s_barrier
    v_mfma_f32_16x16x32_bf16 v[160:163], a[240:243], v[80:83], v[160:163]
    ds_read_b64_tr_b16 a[192:193], v246 offset:0
    v_mfma_f32_16x16x32_bf16 v[164:167], a[244:247], v[80:83], v[164:167]
    ds_read_b64_tr_b16 a[194:195], v246 offset:1024
    v_mfma_f32_16x16x32_bf16 v[168:171], a[248:251], v[80:83], v[168:171]
    ds_read_b64_tr_b16 a[196:197], v238 offset:0
    v_mfma_f32_16x16x32_bf16 v[172:175], a[252:255], v[80:83], v[172:175]
    ds_read_b64_tr_b16 a[198:199], v238 offset:1024
    v_mfma_f32_16x16x32_bf16 v[176:179], a[240:243], v[84:87], v[176:179]
    ds_read_b64_tr_b16 a[200:201], v246 offset:256
    s_add_u32 s38, s36, 77824
    buffer_store_dwordx4 v[28:31], v240, s[16:19], s38 offen offset:1536 sc1
    v_mfma_f32_16x16x32_bf16 v[180:183], a[244:247], v[84:87], v[180:183]
    ds_read_b64_tr_b16 a[202:203], v246 offset:1280
    v_mfma_f32_16x16x32_bf16 v[184:187], a[248:251], v[84:87], v[184:187]
    ds_read_b64_tr_b16 a[204:205], v238 offset:256
    v_mfma_f32_16x16x32_bf16 v[188:191], a[252:255], v[84:87], v[188:191]
    ds_read_b64_tr_b16 a[206:207], v238 offset:1280
    v_mfma_f32_16x16x32_bf16 v[192:195], a[240:243], v[88:91], v[192:195]
    buffer_load_dwordx4 a[164:167], v248, s[8:11], s29 offen offset:2048 sc1
    v_mfma_f32_16x16x32_bf16 v[196:199], a[244:247], v[88:91], v[196:199]
    v_cvt_pk_bf16_f32 v32, v160, v161
    v_cvt_pk_bf16_f32 v33, v162, v163
    v_mfma_f32_16x16x32_bf16 v[200:203], a[248:251], v[88:91], v[200:203]
    buffer_load_dwordx4 a[168:171], v249, s[8:11], s28 offen offset:2048 sc1
    v_cvt_pk_bf16_f32 v34, v164, v165
    v_cvt_pk_bf16_f32 v35, v166, v167
    v_mfma_f32_16x16x32_bf16 v[204:207], a[252:255], v[88:91], v[204:207]
    v_cvt_pk_bf16_f32 v36, v168, v169
    v_cvt_pk_bf16_f32 v37, v170, v171
    v_mfma_f32_16x16x32_bf16 v[208:211], a[240:243], v[92:95], v[208:211]
    v_cvt_pk_bf16_f32 v38, v172, v173
    v_cvt_pk_bf16_f32 v39, v174, v175
    v_mfma_f32_16x16x32_bf16 v[212:215], a[244:247], v[92:95], v[212:215]
    buffer_load_dwordx4 a[172:175], v249, s[8:11], s29 offen offset:2048 sc1
    v_cvt_pk_bf16_f32 v40, v176, v177
    v_cvt_pk_bf16_f32 v41, v178, v179
    v_mfma_f32_16x16x32_bf16 v[216:219], a[248:251], v[92:95], v[216:219]
    v_cvt_pk_bf16_f32 v42, v180, v181
    v_cvt_pk_bf16_f32 v43, v182, v183
    v_mfma_f32_16x16x32_bf16 v[220:223], a[252:255], v[92:95], v[220:223]
    v_cvt_pk_bf16_f32 v44, v184, v185
    v_cvt_pk_bf16_f32 v45, v186, v187
    s_nop 3
    v_cvt_pk_bf16_f32 v46, v188, v189
    v_cvt_pk_bf16_f32 v47, v190, v191
    v_cvt_pk_bf16_f32 v48, v192, v193
    v_cvt_pk_bf16_f32 v49, v194, v195
    v_cvt_pk_bf16_f32 v50, v196, v197
    v_cvt_pk_bf16_f32 v51, v198, v199
    v_cvt_pk_bf16_f32 v52, v200, v201
    v_cvt_pk_bf16_f32 v53, v202, v203
    v_cvt_pk_bf16_f32 v54, v204, v205
    v_cvt_pk_bf16_f32 v55, v206, v207
    v_cvt_pk_bf16_f32 v56, v208, v209
    v_cvt_pk_bf16_f32 v57, v210, v211
    v_cvt_pk_bf16_f32 v58, v212, v213
    v_cvt_pk_bf16_f32 v59, v214, v215
    v_cvt_pk_bf16_f32 v60, v216, v217
    v_cvt_pk_bf16_f32 v61, v218, v219
    v_cvt_pk_bf16_f32 v62, v220, v221
    v_cvt_pk_bf16_f32 v63, v222, v223
    s_add_u32 s80, s36, 102144
    s_add_u32 s81, s36, 104192
    s_add_u32 s82, s36, 103168
    s_add_u32 s83, s36, 105216
    s_add_u32 s84, s36, 110336
    s_add_u32 s85, s36, 112384
    s_add_u32 s86, s36, 111360
    s_add_u32 s87, s36, 113408
    s_branch ka_Q
ka_V:
    s_waitcnt lgkmcnt(0)
    v_mfma_f32_16x16x32_bf16 v[96:99], v[64:67], a[0:3], 0
    ds_read_b128 v[80:83], v224 offset:8192
    v_mfma_f32_16x16x32_bf16 v[100:103], v[68:71], a[0:3], 0
    ds_read_b128 v[84:87], v224 offset:10240
    v_mfma_f32_16x16x32_bf16 v[104:107], v[64:67], a[4:7], 0
    ds_read_b128 v[88:91], v224 offset:12288
    v_mfma_f32_16x16x32_bf16 v[108:111], v[68:71], a[4:7], 0
    ds_read_b128 v[92:95], v224 offset:14336
    v_mfma_f32_16x16x32_bf16 v[112:115], v[64:67], a[8:11], 0
    ds_read_b64_tr_b16 a[16:17], v228 offset:4096
    v_mfma_f32_16x16x32_bf16 v[116:119], v[68:71], a[8:11], 0
    ds_read_b64_tr_b16 a[18:19], v228 offset:4608
    v_mfma_f32_16x16x32_bf16 v[120:123], v[64:67], a[12:15], 0
    ds_read_b64_tr_b16 a[20:21], v229 offset:4096
    v_mfma_f32_16x16x32_bf16 v[124:127], v[68:71], a[12:15], 0
    ds_read_b64_tr_b16 a[22:23], v229 offset:4608
    v_mfma_f32_16x16x32_bf16 v[128:131], v[72:75], a[0:3], 0
    s_add_u32 m0, s35, 16384
    s_and_b32 s33, s82, 1023
    s_lshl_b32 s33, s33, 12
    buffer_load_dwordx4 v234, s[48:51], s33 offen lds
    v_mfma_f32_16x16x32_bf16 v[132:135], v[76:79], a[0:3], 0
    v_mfma_f32_16x16x32_bf16 v[136:139], v[72:75], a[4:7], 0
    buffer_load_dwordx4 v235, s[48:51], s33 offen offset:1024 lds
    v_mfma_f32_16x16x32_bf16 v[140:143], v[76:79], a[4:7], 0
    v_mfma_f32_16x16x32_bf16 v[144:147], v[72:75], a[8:11], 0
    s_add_u32 m0, s35, 18432
    s_add_u32 s33, s33, 131072
    buffer_load_dwordx4 v234, s[48:51], s33 offen lds
    v_mfma_f32_16x16x32_bf16 v[148:151], v[76:79], a[8:11], 0
    v_mfma_f32_16x16x32_bf16 v[152:155], v[72:75], a[12:15], 0
    buffer_load_dwordx4 v235, s[48:51], s33 offen offset:1024 lds
    v_mfma_f32_16x16x32_bf16 v[156:159], v[76:79], a[12:15], 0
    s_waitcnt lgkmcnt(0)
    v_mfma_f32_16x16x32_bf16 v[160:163], v[80:83], a[0:3], 0
    ds_read_b128 v[64:67], v225 offset:0
    v_mfma_f32_16x16x32_bf16 v[164:167], v[84:87], a[0:3], 0
    ds_read_b128 v[68:71], v225 offset:2048
    v_mfma_f32_16x16x32_bf16 v[168:171], v[80:83], a[4:7], 0
    ds_read_b128 v[72:75], v225 offset:4096
    v_mfma_f32_16x16x32_bf16 v[172:175], v[84:87], a[4:7], 0
    ds_read_b128 v[76:79], v225 offset:6144
    v_mfma_f32_16x16x32_bf16 v[176:179], v[80:83], a[8:11], 0
    ds_read_b64_tr_b16 a[24:25], v230 offset:4096
    v_mfma_f32_16x16x32_bf16 v[180:183], v[84:87], a[8:11], 0
    ds_read_b64_tr_b16 a[26:27], v230 offset:4608
    v_mfma_f32_16x16x32_bf16 v[184:187], v[80:83], a[12:15], 0
    ds_read_b64_tr_b16 a[28:29], v231 offset:4096
    v_mfma_f32_16x16x32_bf16 v[188:191], v[84:87], a[12:15], 0
    ds_read_b64_tr_b16 a[30:31], v231 offset:4608
    v_mfma_f32_16x16x32_bf16 v[192:195], v[88:91], a[0:3], 0
    s_add_u32 m0, s35, 20480
    s_add_u32 s33, s33, 131072
    buffer_load_dwordx4 v234, s[48:51], s33 offen lds
    v_mfma_f32_16x16x32_bf16 v[196:199], v[92:95], a[0:3], 0
    v_mfma_f32_16x16x32_bf16 v[200:203], v[88:91], a[4:7], 0
    buffer_load_dwordx4 v235, s[48:51], s33 offen offset:1024 lds
    v_mfma_f32_16x16x32_bf16 v[204:207], v[92:95], a[4:7], 0
    v_mfma_f32_16x16x32_bf16 v[208:211], v[88:91], a[8:11], 0
    s_add_u32 m0, s35, 22528
    s_add_u32 s33, s33, 131072
    buffer_load_dwordx4 v234, s[48:51], s33 offen lds
    v_mfma_f32_16x16x32_bf16 v[212:215], v[92:95], a[8:11], 0
    v_mfma_f32_16x16x32_bf16 v[216:219], v[88:91], a[12:15], 0
    buffer_load_dwordx4 v235, s[48:51], s33 offen offset:1024 lds
    v_mfma_f32_16x16x32_bf16 v[220:223], v[92:95], a[12:15], 0
    s_waitcnt vmcnt(13) lgkmcnt(0)
    v_mfma_f32_16x16x32_bf16 v[96:99], v[64:67], a[16:19], v[96:99]
    ds_read_b128 v[80:83], v225 offset:8192
    v_mfma_f32_16x16x32_bf16 v[100:103], v[68:71], a[16:19], v[100:103]
    ds_read_b128 v[84:87], v225 offset:10240
    v_mfma_f32_16x16x32_bf16 v[104:107], v[64:67], a[20:23], v[104:107]
    ds_read_b128 v[88:91], v225 offset:12288
    v_mfma_f32_16x16x32_bf16 v[108:111], v[68:71], a[20:23], v[108:111]
    ds_read_b128 v[92:95], v225 offset:14336
    v_mfma_f32_16x16x32_bf16 v[112:115], v[64:67], a[24:27], v[112:115]
    ds_read_b64_tr_b16 a[32:33], v228 offset:8192
    v_mfma_f32_16x16x32_bf16 v[116:119], v[68:71], a[24:27], v[116:119]
    ds_read_b64_tr_b16 a[34:35], v228 offset:8704
    v_mfma_f32_16x16x32_bf16 v[120:123], v[64:67], a[28:31], v[120:123]
    ds_read_b64_tr_b16 a[36:37], v229 offset:8192
    v_mfma_f32_16x16x32_bf16 v[124:127], v[68:71], a[28:31], v[124:127]
    ds_read_b64_tr_b16 a[38:39], v229 offset:8704
    v_mfma_f32_16x16x32_bf16 v[128:131], v[72:75], a[16:19], v[128:131]
    ds_read_b64_tr_b16 a[40:41], v230 offset:8192
    s_add_u32 m0, s34, 32768
    s_add_u32 s37, s82, 0
    buffer_load_dwordx4 v232, s[44:47], s37 offen lds
    v_mfma_f32_16x16x32_bf16 v[132:135], v[76:79], a[16:19], v[132:135]
    ds_read_b64_tr_b16 a[42:43], v230 offset:8704
    buffer_load_dwordx4 v233, s[44:47], s37 offen offset:1024 lds
    v_mfma_f32_16x16x32_bf16 v[136:139], v[72:75], a[20:23], v[136:139]
    ds_read_b64_tr_b16 a[44:45], v231 offset:8192
    s_add_u32 m0, s34, 40960
    s_add_u32 s37, s82, 65536
    buffer_load_dwordx4 v232, s[44:47], s37 offen lds
    v_mfma_f32_16x16x32_bf16 v[140:143], v[76:79], a[20:23], v[140:143]
    ds_read_b64_tr_b16 a[46:47], v231 offset:8704
    buffer_load_dwordx4 v233, s[44:47], s37 offen offset:1024 lds
    v_mfma_f32_16x16x32_bf16 v[144:147], v[72:75], a[24:27], v[144:147]
    s_add_u32 m0, s35, 0
    s_and_b32 s33, s83, 1023
    s_lshl_b32 s33, s33, 12
    buffer_load_dwordx4 v234, s[48:51], s33 offen lds
    v_mfma_f32_16x16x32_bf16 v[148:151], v[76:79], a[24:27], v[148:151]
    buffer_load_dwordx4 v235, s[48:51], s33 offen offset:1024 lds
    v_mfma_f32_16x16x32_bf16 v[152:155], v[72:75], a[28:31], v[152:155]
    s_add_u32 m0, s35, 2048
    s_add_u32 s33, s33, 131072
    buffer_load_dwordx4 v234, s[48:51], s33 offen lds
    v_mfma_f32_16x16x32_bf16 v[156:159], v[76:79], a[28:31], v[156:159]
    buffer_load_dwordx4 v235, s[48:51], s33 offen offset:1024 lds
    s_waitcnt vmcnt(17) lgkmcnt(0)
    s_barrier
    v_mfma_f32_16x16x32_bf16 v[160:163], v[80:83], a[16:19], v[160:163]
    ds_read_b128 v[64:67], v224 offset:16384
    v_mfma_f32_16x16x32_bf16 v[164:167], v[84:87], a[16:19], v[164:167]
    ds_read_b128 v[68:71], v225 offset:16384
    v_mfma_f32_16x16x32_bf16 v[168:171], v[80:83], a[20:23], v[168:171]
    ds_read_b128 v[72:75], v224 offset:18432
    v_mfma_f32_16x16x32_bf16 v[172:175], v[84:87], a[20:23], v[172:175]
    ds_read_b128 v[76:79], v225 offset:18432
    v_mfma_f32_16x16x32_bf16 v[176:179], v[80:83], a[24:27], v[176:179]
    ds_read_b64_tr_b16 a[48:49], v228 offset:12288
    s_add_u32 m0, s34, 49152
    s_add_u32 s37, s83, 0
    buffer_load_dwordx4 v232, s[44:47], s37 offen lds
    v_mfma_f32_16x16x32_bf16 v[180:183], v[84:87], a[24:27], v[180:183]
    ds_read_b64_tr_b16 a[50:51], v228 offset:12800
    buffer_load_dwordx4 v233, s[44:47], s37 offen offset:1024 lds
    v_mfma_f32_16x16x32_bf16 v[184:187], v[80:83], a[28:31], v[184:187]
    ds_read_b64_tr_b16 a[52:53], v229 offset:12288
    s_add_u32 m0, s34, 57344
    s_add_u32 s37, s83, 65536
    buffer_load_dwordx4 v232, s[44:47], s37 offen lds
    v_mfma_f32_16x16x32_bf16 v[188:191], v[84:87], a[28:31], v[188:191]
    ds_read_b64_tr_b16 a[54:55], v229 offset:12800
    buffer_load_dwordx4 v233, s[44:47], s37 offen offset:1024 lds
    v_mfma_f32_16x16x32_bf16 v[192:195], v[88:91], a[16:19], v[192:195]
    ds_read_b64_tr_b16 a[56:57], v230 offset:12288
    s_add_u32 m0, s34, 0
    s_add_u32 s37, s84, 0
    buffer_load_dwordx4 v232, s[44:47], s37 offen lds
    v_mfma_f32_16x16x32_bf16 v[196:199], v[92:95], a[16:19], v[196:199]
    ds_read_b64_tr_b16 a[58:59], v230 offset:12800
    v_mfma_f32_16x16x32_bf16 v[200:203], v[88:91], a[20:23], v[200:203]
    ds_read_b64_tr_b16 a[60:61], v231 offset:12288
    buffer_load_dwordx4 v233, s[44:47], s37 offen offset:1024 lds
    v_mfma_f32_16x16x32_bf16 v[204:207], v[92:95], a[20:23], v[204:207]
    ds_read_b64_tr_b16 a[62:63], v231 offset:12800
    buffer_load_dwordx4 v[0:3], v236, s[52:55], 0 offen offset:0
    v_mfma_f32_16x16x32_bf16 v[208:211], v[88:91], a[24:27], v[208:211]
    buffer_load_dwordx4 v[4:7], v236, s[52:55], 0 offen offset:512
    v_mfma_f32_16x16x32_bf16 v[212:215], v[92:95], a[24:27], v[212:215]
    buffer_load_dwordx4 v[8:11], v236, s[52:55], 0 offen offset:1024
    v_mfma_f32_16x16x32_bf16 v[216:219], v[88:91], a[28:31], v[216:219]
    buffer_load_dwordx4 v[12:15], v236, s[52:55], 0 offen offset:1536
    v_mfma_f32_16x16x32_bf16 v[220:223], v[92:95], a[28:31], v[220:223]
    s_waitcnt lgkmcnt(0)
    v_mfma_f32_16x16x32_bf16 v[96:99], v[64:67], a[32:35], v[96:99]
    ds_read_b128 v[80:83], v224 offset:20480
    v_mfma_f32_16x16x32_bf16 v[96:99], v[68:71], a[48:51], v[96:99]
    ds_read_b128 v[84:87], v225 offset:20480
    v_mfma_f32_16x16x32_bf16 v[100:103], v[72:75], a[32:35], v[100:103]
    ds_read_b128 v[88:91], v224 offset:22528
    v_mfma_f32_16x16x32_bf16 v[100:103], v[76:79], a[48:51], v[100:103]
    ds_read_b128 v[92:95], v225 offset:22528
    v_mfma_f32_16x16x32_bf16 v[104:107], v[64:67], a[36:39], v[104:107]
    v_mfma_f32_16x16x32_bf16 v[104:107], v[68:71], a[52:55], v[104:107]
    v_mfma_f32_16x16x32_bf16 v[108:111], v[72:75], a[36:39], v[108:111]
    v_mfma_f32_16x16x32_bf16 v[108:111], v[76:79], a[52:55], v[108:111]
    v_mfma_f32_16x16x32_bf16 v[112:115], v[64:67], a[40:43], v[112:115]
    s_add_u32 m0, s35, 4096
    s_add_u32 s33, s33, 131072
    buffer_load_dwordx4 v234, s[48:51], s33 offen lds
    v_mfma_f32_16x16x32_bf16 v[112:115], v[68:71], a[56:59], v[112:115]
    v_mfma_f32_16x16x32_bf16 v[116:119], v[72:75], a[40:43], v[116:119]
    buffer_load_dwordx4 v235, s[48:51], s33 offen offset:1024 lds
    v_mfma_f32_16x16x32_bf16 v[116:119], v[76:79], a[56:59], v[116:119]
    v_mfma_f32_16x16x32_bf16 v[120:123], v[64:67], a[44:47], v[120:123]
    s_add_u32 m0, s35, 6144
    s_add_u32 s33, s33, 131072
    buffer_load_dwordx4 v234, s[48:51], s33 offen lds
    v_mfma_f32_16x16x32_bf16 v[120:123], v[68:71], a[60:63], v[120:123]
    v_mfma_f32_16x16x32_bf16 v[124:127], v[72:75], a[44:47], v[124:127]
    buffer_load_dwordx4 v235, s[48:51], s33 offen offset:1024 lds
    v_mfma_f32_16x16x32_bf16 v[124:127], v[76:79], a[60:63], v[124:127]
    s_waitcnt lgkmcnt(0)
    v_mfma_f32_16x16x32_bf16 v[128:131], v[80:83], a[32:35], v[128:131]
    ds_read_b128 v[64:67], v224 offset:24576
    v_mfma_f32_16x16x32_bf16 v[128:131], v[84:87], a[48:51], v[128:131]
    ds_read_b128 v[68:71], v225 offset:24576
    v_mfma_f32_16x16x32_bf16 v[132:135], v[88:91], a[32:35], v[132:135]
    ds_read_b128 v[72:75], v224 offset:26624
    v_mfma_f32_16x16x32_bf16 v[132:135], v[92:95], a[48:51], v[132:135]
    ds_read_b128 v[76:79], v225 offset:26624
    v_mfma_f32_16x16x32_bf16 v[136:139], v[80:83], a[36:39], v[136:139]
    v_mfma_f32_16x16x32_bf16 v[136:139], v[84:87], a[52:55], v[136:139]
    v_mfma_f32_16x16x32_bf16 v[140:143], v[88:91], a[36:39], v[140:143]
    v_mfma_f32_16x16x32_bf16 v[140:143], v[92:95], a[52:55], v[140:143]
    v_mfma_f32_16x16x32_bf16 v[144:147], v[80:83], a[40:43], v[144:147]
    s_add_u32 m0, s34, 8192
    s_add_u32 s37, s84, 65536
    buffer_load_dwordx4 v232, s[44:47], s37 offen lds
    v_mfma_f32_16x16x32_bf16 v[144:147], v[84:87], a[56:59], v[144:147]
    v_mfma_f32_16x16x32_bf16 v[148:151], v[88:91], a[40:43], v[148:151]
    v_mfma_f32_16x16x32_bf16 v[148:151], v[92:95], a[56:59], v[148:151]
    v_mfma_f32_16x16x32_bf16 v[152:155], v[80:83], a[44:47], v[152:155]
    buffer_load_dwordx4 v233, s[44:47], s37 offen offset:1024 lds
    v_mfma_f32_16x16x32_bf16 v[152:155], v[84:87], a[60:63], v[152:155]
    v_mfma_f32_16x16x32_bf16 v[156:159], v[88:91], a[44:47], v[156:159]
    v_mfma_f32_16x16x32_bf16 v[156:159], v[92:95], a[60:63], v[156:159]
    s_waitcnt vmcnt(24) lgkmcnt(0)
    v_mfma_f32_16x16x32_bf16 v[160:163], v[64:67], a[32:35], v[160:163]
    ds_read_b128 v[80:83], v224 offset:28672
    v_mfma_f32_16x16x32_bf16 v[160:163], v[68:71], a[48:51], v[160:163]
    ds_read_b128 v[84:87], v225 offset:28672
    v_mfma_f32_16x16x32_bf16 v[164:167], v[72:75], a[32:35], v[164:167]
    ds_read_b128 v[88:91], v224 offset:30720
    v_mfma_f32_16x16x32_bf16 v[164:167], v[76:79], a[48:51], v[164:167]
    ds_read_b128 v[92:95], v225 offset:30720
    v_mfma_f32_16x16x32_bf16 v[168:171], v[64:67], a[36:39], v[168:171]
    ds_read_b64_tr_b16 a[64:65], v228 offset:16384
    v_mfma_f32_16x16x32_bf16 v[168:171], v[68:71], a[52:55], v[168:171]
    ds_read_b64_tr_b16 a[66:67], v228 offset:16896
    v_mfma_f32_16x16x32_bf16 v[172:175], v[72:75], a[36:39], v[172:175]
    ds_read_b64_tr_b16 a[68:69], v229 offset:16384
    v_mfma_f32_16x16x32_bf16 v[172:175], v[76:79], a[52:55], v[172:175]
    ds_read_b64_tr_b16 a[70:71], v229 offset:16896
    v_mfma_f32_16x16x32_bf16 v[176:179], v[64:67], a[40:43], v[176:179]
    ds_read_b64_tr_b16 a[72:73], v230 offset:16384
    s_add_u32 m0, s35, 8192
    s_and_b32 s33, s84, 1023
    s_lshl_b32 s33, s33, 12
    buffer_load_dwordx4 v234, s[48:51], s33 offen lds
    v_mfma_f32_16x16x32_bf16 v[176:179], v[68:71], a[56:59], v[176:179]
    ds_read_b64_tr_b16 a[74:75], v230 offset:16896
    v_mfma_f32_16x16x32_bf16 v[180:183], v[72:75], a[40:43], v[180:183]
    ds_read_b64_tr_b16 a[76:77], v231 offset:16384
    buffer_load_dwordx4 v235, s[48:51], s33 offen offset:1024 lds
    v_mfma_f32_16x16x32_bf16 v[180:183], v[76:79], a[56:59], v[180:183]
    ds_read_b64_tr_b16 a[78:79], v231 offset:16896
    v_mfma_f32_16x16x32_bf16 v[184:187], v[64:67], a[44:47], v[184:187]
    s_add_u32 m0, s35, 10240
    s_add_u32 s33, s33, 131072
    buffer_load_dwordx4 v234, s[48:51], s33 offen lds
    v_mfma_f32_16x16x32_bf16 v[184:187], v[68:71], a[60:63], v[184:187]
    v_mfma_f32_16x16x32_bf16 v[188:191], v[72:75], a[44:47], v[188:191]
    buffer_load_dwordx4 v235, s[48:51], s33 offen offset:1024 lds
    v_mfma_f32_16x16x32_bf16 v[188:191], v[76:79], a[60:63], v[188:191]
    s_waitcnt vmcnt(24) lgkmcnt(0)
    s_barrier
    v_mfma_f32_16x16x32_bf16 v[192:195], v[80:83], a[32:35], v[192:195]
    ds_read_b128 v[64:67], v224 offset:32768
    v_mfma_f32_16x16x32_bf16 v[192:195], v[84:87], a[48:51], v[192:195]
    ds_read_b128 v[68:71], v225 offset:32768
    v_mfma_f32_16x16x32_bf16 v[196:199], v[88:91], a[32:35], v[196:199]
    ds_read_b128 v[72:75], v224 offset:34816
    v_mfma_f32_16x16x32_bf16 v[196:199], v[92:95], a[48:51], v[196:199]
    ds_read_b128 v[76:79], v225 offset:34816
    v_mfma_f32_16x16x32_bf16 v[200:203], v[80:83], a[36:39], v[200:203]
    ds_read_b64_tr_b16 a[80:81], v228 offset:20480
    v_mfma_f32_16x16x32_bf16 v[200:203], v[84:87], a[52:55], v[200:203]
    ds_read_b64_tr_b16 a[82:83], v228 offset:20992
    v_mfma_f32_16x16x32_bf16 v[204:207], v[88:91], a[36:39], v[204:207]
    ds_read_b64_tr_b16 a[84:85], v229 offset:20480
    v_mfma_f32_16x16x32_bf16 v[204:207], v[92:95], a[52:55], v[204:207]
    ds_read_b64_tr_b16 a[86:87], v229 offset:20992
    v_mfma_f32_16x16x32_bf16 v[208:211], v[80:83], a[40:43], v[208:211]
    ds_read_b64_tr_b16 a[88:89], v230 offset:20480
    s_add_u32 m0, s34, 16384
    s_add_u32 s37, s85, 0
    buffer_load_dwordx4 v232, s[44:47], s37 offen lds
    v_mfma_f32_16x16x32_bf16 v[208:211], v[84:87], a[56:59], v[208:211]
    ds_read_b64_tr_b16 a[90:91], v230 offset:20992
    v_mfma_f32_16x16x32_bf16 v[212:215], v[88:91], a[40:43], v[212:215]
    ds_read_b64_tr_b16 a[92:93], v231 offset:20480
    v_mfma_f32_16x16x32_bf16 v[212:215], v[92:95], a[56:59], v[212:215]
    ds_read_b64_tr_b16 a[94:95], v231 offset:20992
    v_mfma_f32_16x16x32_bf16 v[216:219], v[80:83], a[44:47], v[216:219]
    buffer_load_dwordx4 v233, s[44:47], s37 offen offset:1024 lds
    v_mfma_f32_16x16x32_bf16 v[216:219], v[84:87], a[60:63], v[216:219]
    v_mfma_f32_16x16x32_bf16 v[220:223], v[88:91], a[44:47], v[220:223]
    v_mfma_f32_16x16x32_bf16 v[220:223], v[92:95], a[60:63], v[220:223]
    s_waitcnt lgkmcnt(0)
    v_mfma_f32_16x16x32_bf16 v[96:99], v[64:67], a[64:67], v[96:99]
    ds_read_b128 v[80:83], v224 offset:36864
    v_mfma_f32_16x16x32_bf16 v[96:99], v[68:71], a[80:83], v[96:99]
    ds_read_b128 v[84:87], v225 offset:36864
    v_mfma_f32_16x16x32_bf16 v[100:103], v[72:75], a[64:67], v[100:103]
    ds_read_b128 v[88:91], v224 offset:38912
    v_mfma_f32_16x16x32_bf16 v[100:103], v[76:79], a[80:83], v[100:103]
    ds_read_b128 v[92:95], v225 offset:38912
    v_mfma_f32_16x16x32_bf16 v[104:107], v[64:67], a[68:71], v[104:107]
    v_mfma_f32_16x16x32_bf16 v[104:107], v[68:71], a[84:87], v[104:107]
    v_mfma_f32_16x16x32_bf16 v[108:111], v[72:75], a[68:71], v[108:111]
    v_mfma_f32_16x16x32_bf16 v[108:111], v[76:79], a[84:87], v[108:111]
    v_mfma_f32_16x16x32_bf16 v[112:115], v[64:67], a[72:75], v[112:115]
    s_add_u32 m0, s35, 12288
    s_add_u32 s33, s33, 131072
    buffer_load_dwordx4 v234, s[48:51], s33 offen lds
    v_mfma_f32_16x16x32_bf16 v[112:115], v[68:71], a[88:91], v[112:115]
    v_mfma_f32_16x16x32_bf16 v[116:119], v[72:75], a[72:75], v[116:119]
    buffer_load_dwordx4 v235, s[48:51], s33 offen offset:1024 lds
    v_mfma_f32_16x16x32_bf16 v[116:119], v[76:79], a[88:91], v[116:119]
    v_mfma_f32_16x16x32_bf16 v[120:123], v[64:67], a[76:79], v[120:123]
    s_add_u32 m0, s35, 14336
    s_add_u32 s33, s33, 131072
    buffer_load_dwordx4 v234, s[48:51], s33 offen lds
    v_mfma_f32_16x16x32_bf16 v[120:123], v[68:71], a[92:95], v[120:123]
    v_mfma_f32_16x16x32_bf16 v[124:127], v[72:75], a[76:79], v[124:127]
    buffer_load_dwordx4 v235, s[48:51], s33 offen offset:1024 lds
    v_mfma_f32_16x16x32_bf16 v[124:127], v[76:79], a[92:95], v[124:127]
    s_waitcnt lgkmcnt(0)
    v_mfma_f32_16x16x32_bf16 v[128:131], v[80:83], a[64:67], v[128:131]
    ds_read_b128 v[64:67], v224 offset:40960
    v_mfma_f32_16x16x32_bf16 v[128:131], v[84:87], a[80:83], v[128:131]
    ds_read_b128 v[68:71], v225 offset:40960
    v_mfma_f32_16x16x32_bf16 v[132:135], v[88:91], a[64:67], v[132:135]
    ds_read_b128 v[72:75], v224 offset:43008
    v_mfma_f32_16x16x32_bf16 v[132:135], v[92:95], a[80:83], v[132:135]
    ds_read_b128 v[76:79], v225 offset:43008
    v_mfma_f32_16x16x32_bf16 v[136:139], v[80:83], a[68:71], v[136:139]
    v_mfma_f32_16x16x32_bf16 v[136:139], v[84:87], a[84:87], v[136:139]
    v_mfma_f32_16x16x32_bf16 v[140:143], v[88:91], a[68:71], v[140:143]
    v_mfma_f32_16x16x32_bf16 v[140:143], v[92:95], a[84:87], v[140:143]
    v_mfma_f32_16x16x32_bf16 v[144:147], v[80:83], a[72:75], v[144:147]
    s_add_u32 m0, s34, 24576
    s_add_u32 s37, s85, 65536
    buffer_load_dwordx4 v232, s[44:47], s37 offen lds
    v_mfma_f32_16x16x32_bf16 v[144:147], v[84:87], a[88:91], v[144:147]
    v_mfma_f32_16x16x32_bf16 v[148:151], v[88:91], a[72:75], v[148:151]
    v_mfma_f32_16x16x32_bf16 v[148:151], v[92:95], a[88:91], v[148:151]
    v_mfma_f32_16x16x32_bf16 v[152:155], v[80:83], a[76:79], v[152:155]
    buffer_load_dwordx4 v233, s[44:47], s37 offen offset:1024 lds
    v_mfma_f32_16x16x32_bf16 v[152:155], v[84:87], a[92:95], v[152:155]
    v_mfma_f32_16x16x32_bf16 v[156:159], v[88:91], a[76:79], v[156:159]
    v_mfma_f32_16x16x32_bf16 v[156:159], v[92:95], a[92:95], v[156:159]
    s_waitcnt vmcnt(14) lgkmcnt(0)
    v_mfma_f32_16x16x32_bf16 v[160:163], v[64:67], a[64:67], v[160:163]
    ds_read_b128 v[80:83], v224 offset:45056
    s_waitcnt vmcnt(18)
    v_mfma_f32_16x16x32_bf16 v[160:163], v[68:71], a[80:83], v[160:163]
    ds_read_b128 v[84:87], v225 offset:45056
    v_lshlrev_b32_e64 v16, 16, v0
    v_mfma_f32_16x16x32_bf16 v[164:167], v[72:75], a[64:67], v[164:167]
    ds_read_b128 v[88:91], v224 offset:47104
    v_and_b32 v17, 0xffff0000, v0
    v_lshlrev_b32_e64 v18, 16, v1
    v_mfma_f32_16x16x32_bf16 v[164:167], v[76:79], a[80:83], v[164:167]
    ds_read_b128 v[92:95], v225 offset:47104
    v_and_b32 v19, 0xffff0000, v1
    v_mfma_f32_16x16x32_bf16 v[168:171], v[64:67], a[68:71], v[168:171]
    ds_read_b64_tr_b16 a[96:97], v228 offset:0
    v_lshlrev_b32_e64 v20, 16, v2
    v_mfma_f32_16x16x32_bf16 v[168:171], v[68:71], a[84:87], v[168:171]
    ds_read_b64_tr_b16 a[98:99], v228 offset:512
    v_and_b32 v21, 0xffff0000, v2
    v_mfma_f32_16x16x32_bf16 v[172:175], v[72:75], a[68:71], v[172:175]
    ds_read_b64_tr_b16 a[100:101], v229 offset:0
    v_lshlrev_b32_e64 v22, 16, v3
    v_mfma_f32_16x16x32_bf16 v[172:175], v[76:79], a[84:87], v[172:175]
    ds_read_b64_tr_b16 a[102:103], v229 offset:512
    v_and_b32 v23, 0xffff0000, v3
    v_mfma_f32_16x16x32_bf16 v[176:179], v[64:67], a[72:75], v[176:179]
    ds_read_b64_tr_b16 a[104:105], v230 offset:0
    s_add_u32 m0, s35, 16384
    s_and_b32 s33, s85, 1023
    s_lshl_b32 s33, s33, 12
    buffer_load_dwordx4 v234, s[48:51], s33 offen lds
    v_mfma_f32_16x16x32_bf16 v[176:179], v[68:71], a[88:91], v[176:179]
    ds_read_b64_tr_b16 a[106:107], v230 offset:512
    buffer_load_dwordx4 v235, s[48:51], s33 offen offset:1024 lds
    v_mfma_f32_16x16x32_bf16 v[180:183], v[72:75], a[72:75], v[180:183]
    ds_read_b64_tr_b16 a[108:109], v231 offset:0
    s_add_u32 m0, s35, 18432
    s_add_u32 s33, s33, 131072
    buffer_load_dwordx4 v234, s[48:51], s33 offen lds
    v_mfma_f32_16x16x32_bf16 v[180:183], v[76:79], a[88:91], v[180:183]
    ds_read_b64_tr_b16 a[110:111], v231 offset:512
    v_lshlrev_b32 v24, 16, v4
    v_and_b32 v25, 0xffff0000, v4
    v_mfma_f32_16x16x32_bf16 v[184:187], v[64:67], a[76:79], v[184:187]
    buffer_load_dwordx4 v235, s[48:51], s33 offen offset:1024 lds
    v_lshlrev_b32_e64 v26, 16, v5
    v_mfma_f32_16x16x32_bf16 v[184:187], v[68:71], a[92:95], v[184:187]
    s_lshl2_add_u32 s26, s4, s3
    s_lshl_b32 s26, s26, 10
    s_add_u32 s26, s26, s32
    s_add_u32 s26, s26, 131072
    v_mfma_f32_16x16x32_bf16 v[188:191], v[72:75], a[76:79], v[188:191]
    v_and_b32 v226, 0x40000380, v251
    buffer_load_dword v241, v226, s[44:47], s26 offen
    v_mfma_f32_16x16x32_bf16 v[188:191], v[76:79], a[92:95], v[188:191]
    s_waitcnt vmcnt(29) lgkmcnt(0)
    s_barrier
    v_mfma_f32_16x16x32_bf16 v[192:195], v[80:83], a[64:67], v[192:195]
    ds_read_b128 v[64:67], v224 offset:49152
    v_and_b32 v27, 0xffff0000, v5
    v_mfma_f32_16x16x32_bf16 v[192:195], v[84:87], a[80:83], v[192:195]
    ds_read_b128 v[68:71], v225 offset:49152
    v_lshlrev_b32 v28, 16, v6
    v_mfma_f32_16x16x32_bf16 v[196:199], v[88:91], a[64:67], v[196:199]
    ds_read_b128 v[72:75], v224 offset:51200
    v_and_b32 v29, 0xffff0000, v6
    v_mfma_f32_16x16x32_bf16 v[196:199], v[92:95], a[80:83], v[196:199]
    ds_read_b128 v[76:79], v225 offset:51200
    v_lshlrev_b32_e64 v30, 16, v7
    v_and_b32 v31, 0xffff0000, v7
    v_mfma_f32_16x16x32_bf16 v[200:203], v[80:83], a[68:71], v[200:203]
    ds_read_b64_tr_b16 a[112:113], v228 offset:4096
    v_lshlrev_b32_e64 v32, 16, v8
    v_mfma_f32_16x16x32_bf16 v[200:203], v[84:87], a[84:87], v[200:203]
    ds_read_b64_tr_b16 a[114:115], v228 offset:4608
    v_and_b32 v33, 0xffff0000, v8
    v_mfma_f32_16x16x32_bf16 v[204:207], v[88:91], a[68:71], v[204:207]
    ds_read_b64_tr_b16 a[116:117], v229 offset:4096
    v_lshlrev_b32_e64 v34, 16, v9
    v_mfma_f32_16x16x32_bf16 v[204:207], v[92:95], a[84:87], v[204:207]
    ds_read_b64_tr_b16 a[118:119], v229 offset:4608
    v_and_b32 v35, 0xffff0000, v9
    v_mfma_f32_16x16x32_bf16 v[208:211], v[80:83], a[72:75], v[208:211]
    ds_read_b64_tr_b16 a[120:121], v230 offset:4096
    s_add_u32 m0, s34, 32768
    s_add_u32 s37, s86, 0
    buffer_load_dwordx4 v232, s[44:47], s37 offen lds
    v_mfma_f32_16x16x32_bf16 v[208:211], v[84:87], a[88:91], v[208:211]
    ds_read_b64_tr_b16 a[122:123], v230 offset:4608
    v_lshlrev_b32 v36, 16, v10
    v_mfma_f32_16x16x32_bf16 v[212:215], v[88:91], a[72:75], v[212:215]
    ds_read_b64_tr_b16 a[124:125], v231 offset:4096
    v_and_b32 v37, 0xffff0000, v10
    v_lshlrev_b32_e64 v38, 16, v11
    v_mfma_f32_16x16x32_bf16 v[212:215], v[92:95], a[88:91], v[212:215]
    ds_read_b64_tr_b16 a[126:127], v231 offset:4608
    v_and_b32 v39, 0xffff0000, v11
    v_mfma_f32_16x16x32_bf16 v[216:219], v[80:83], a[76:79], v[216:219]
    buffer_load_dwordx4 v233, s[44:47], s37 offen offset:1024 lds
    v_lshlrev_b32_e64 v40, 16, v12
    v_mfma_f32_16x16x32_bf16 v[216:219], v[84:87], a[92:95], v[216:219]
    v_and_b32 v41, 0xffff0000, v12
    v_lshlrev_b32_e64 v42, 16, v13
    v_mfma_f32_16x16x32_bf16 v[220:223], v[88:91], a[76:79], v[220:223]
    v_and_b32 v43, 0xffff0000, v13
    v_lshlrev_b32_e64 v44, 16, v14
    v_and_b32 v45, 0xffff0000, v14
    v_mfma_f32_16x16x32_bf16 v[220:223], v[92:95], a[92:95], v[220:223]
    v_lshlrev_b32 v46, 16, v15
    s_waitcnt lgkmcnt(0)
    v_mfma_f32_16x16x32_bf16 v[96:99], v[64:67], a[96:99], v[96:99]
    ds_read_b128 v[80:83], v224 offset:53248
    v_and_b32 v47, 0xffff0000, v15
    v_mfma_f32_16x16x32_bf16 v[96:99], v[68:71], a[112:115], v[96:99]
    ds_read_b128 v[84:87], v225 offset:53248
    v_add_f32_e64 v52, v16, v20
    v_mfma_f32_16x16x32_bf16 v[100:103], v[72:75], a[96:99], v[100:103]
    ds_read_b128 v[88:91], v224 offset:55296
    v_add_f32_e64 v53, v17, v21
    v_mfma_f32_16x16x32_bf16 v[100:103], v[76:79], a[112:115], v[100:103]
    ds_read_b128 v[92:95], v225 offset:55296
    v_add_f32 v54, v18, v22
    v_add_f32 v55, v19, v23
    v_mfma_f32_16x16x32_bf16 v[104:107], v[64:67], a[100:103], v[104:107]
    v_add_f32 v52, v52, v24
    v_add_f32 v53, v53, v25
    v_mfma_f32_16x16x32_bf16 v[104:107], v[68:71], a[116:119], v[104:107]
    v_add_f32 v54, v54, v26
    v_add_f32 v55, v55, v27
    v_mfma_f32_16x16x32_bf16 v[108:111], v[72:75], a[100:103], v[108:111]
    v_add_f32 v52, v52, v28
    v_add_f32 v53, v53, v29
    v_add_f32_e64 v54, v54, v30
    v_mfma_f32_16x16x32_bf16 v[108:111], v[76:79], a[116:119], v[108:111]
    v_add_f32 v55, v55, v31
    v_add_f32 v52, v52, v32
    v_mfma_f32_16x16x32_bf16 v[112:115], v[64:67], a[104:107], v[112:115]
    s_add_u32 m0, s35, 20480
    s_add_u32 s33, s33, 131072
    buffer_load_dwordx4 v234, s[48:51], s33 offen lds
    v_mfma_f32_16x16x32_bf16 v[112:115], v[68:71], a[120:123], v[112:115]
    v_add_f32 v53, v53, v33
    v_add_f32 v54, v54, v34
    v_mfma_f32_16x16x32_bf16 v[116:119], v[72:75], a[104:107], v[116:119]
    buffer_load_dwordx4 v235, s[48:51], s33 offen offset:1024 lds
    v_add_f32 v55, v55, v35
    v_add_f32 v52, v52, v36
    v_mfma_f32_16x16x32_bf16 v[116:119], v[76:79], a[120:123], v[116:119]
    v_add_f32 v53, v53, v37
    v_add_f32 v54, v54, v38
    v_mfma_f32_16x16x32_bf16 v[120:123], v[64:67], a[108:111], v[120:123]
    s_add_u32 m0, s35, 22528
    s_add_u32 s33, s33, 131072
    buffer_load_dwordx4 v234, s[48:51], s33 offen lds
    v_mfma_f32_16x16x32_bf16 v[120:123], v[68:71], a[124:127], v[120:123]
    v_add_f32 v55, v55, v39
    v_add_f32 v52, v52, v40
    v_mfma_f32_16x16x32_bf16 v[124:127], v[72:75], a[108:111], v[124:127]
    buffer_load_dwordx4 v235, s[48:51], s33 offen offset:1024 lds
    v_add_f32 v53, v53, v41
    v_add_f32 v54, v54, v42
    v_mfma_f32_16x16x32_bf16 v[124:127], v[76:79], a[124:127], v[124:127]
    v_add_f32 v55, v55, v43
    s_waitcnt lgkmcnt(0)
    v_mfma_f32_16x16x32_bf16 v[128:131], v[80:83], a[96:99], v[128:131]
    ds_read_b128 v[64:67], v224 offset:57344
    v_add_f32_e64 v52, v52, v44
    v_mfma_f32_16x16x32_bf16 v[128:131], v[84:87], a[112:115], v[128:131]
    ds_read_b128 v[68:71], v225 offset:57344
    v_add_f32_e64 v53, v53, v45
    v_mfma_f32_16x16x32_bf16 v[132:135], v[88:91], a[96:99], v[132:135]
    ds_read_b128 v[72:75], v224 offset:59392
    v_add_f32_e64 v54, v54, v46
    v_mfma_f32_16x16x32_bf16 v[132:135], v[92:95], a[112:115], v[132:135]
    ds_read_b128 v[76:79], v225 offset:59392
    v_add_f32 v55, v55, v47
    v_add_f32 v52, v52, v53
    v_mfma_f32_16x16x32_bf16 v[136:139], v[80:83], a[100:103], v[136:139]
    v_add_f32 v54, v54, v55
    v_add_f32 v48, v52, v54
    v_mfma_f32_16x16x32_bf16 v[136:139], v[84:87], a[116:119], v[136:139]
    s_nop 1
    v_add_f32_dpp v48, v48, v48 quad_perm:[1,0,3,2] row_mask:0xf bank_mask:0xf
    v_mfma_f32_16x16x32_bf16 v[140:143], v[88:91], a[100:103], v[140:143]
    s_nop 1
    v_add_f32_dpp v48, v48, v48 quad_perm:[2,3,0,1] row_mask:0xf bank_mask:0xf
    s_nop 1
    v_mfma_f32_16x16x32_bf16 v[140:143], v[92:95], a[116:119], v[140:143]
    v_add_f32_dpp v48, v48, v48 row_half_mirror row_mask:0xf bank_mask:0xf
    s_nop 1
    v_mfma_f32_16x16x32_bf16 v[144:147], v[80:83], a[104:107], v[144:147]
    s_add_u32 m0, s34, 40960
    s_add_u32 s37, s86, 65536
    buffer_load_dwordx4 v232, s[44:47], s37 offen lds
    v_mfma_f32_16x16x32_bf16 v[144:147], v[84:87], a[120:123], v[144:147]
    v_add_f32_dpp v48, v48, v48 row_mirror row_mask:0xf bank_mask:0xf
    s_nop 0
    v_mfma_f32_16x16x32_bf16 v[148:151], v[88:91], a[104:107], v[148:151]
    buffer_load_dwordx4 v233, s[44:47], s37 offen offset:1024 lds
    v_mov_b32_e64 v49, v48
    s_nop 1
    v_mfma_f32_16x16x32_bf16 v[148:151], v[92:95], a[120:123], v[148:151]
    v_permlane16_swap_b32 v48, v49
    s_nop 0
    v_mfma_f32_16x16x32_bf16 v[152:155], v[80:83], a[108:111], v[152:155]
    v_lshlrev_b32_e64 v227, 3, v240
    v_min_u32 v227, 1920, v227
    s_lshl2_add_u32 s25, s2, s3
    v_mfma_f32_16x16x32_bf16 v[152:155], v[84:87], a[124:127], v[152:155]
    v_add_f32 v48, v48, v49
    v_mul_f32 v48, 0x3a800000, v48
    v_mfma_f32_16x16x32_bf16 v[156:159], v[88:91], a[108:111], v[156:159]
    s_lshl_b32 s25, s25, 13
    s_add_u32 s25, s25, 0
    buffer_load_dword v241, v227, s[12:15], s25 offen
    v_mfma_f32_16x16x32_bf16 v[156:159], v[92:95], a[124:127], v[156:159]
    v_sub_f32 v56, v16, v48
    s_waitcnt vmcnt(16) lgkmcnt(0)
    v_mfma_f32_16x16x32_bf16 v[160:163], v[64:67], a[96:99], v[160:163]
    ds_read_b128 v[80:83], v224 offset:61440
    v_mul_f32 v52, v56, v56
    v_sub_f32 v57, v17, v48
    v_mfma_f32_16x16x32_bf16 v[160:163], v[68:71], a[112:115], v[160:163]
    ds_read_b128 v[84:87], v225 offset:61440
    v_mul_f32_e64 v53, v57, v57
    v_mfma_f32_16x16x32_bf16 v[164:167], v[72:75], a[96:99], v[164:167]
    ds_read_b128 v[88:91], v224 offset:63488
    v_sub_f32_e64 v58, v18, v48
    v_mfma_f32_16x16x32_bf16 v[164:167], v[76:79], a[112:115], v[164:167]
    ds_read_b128 v[92:95], v225 offset:63488
    v_mul_f32_e64 v54, v58, v58
    v_mfma_f32_16x16x32_bf16 v[168:171], v[64:67], a[100:103], v[168:171]
    ds_read_b64_tr_b16 a[128:129], v228 offset:8192
    v_sub_f32_e64 v59, v19, v48
    v_mfma_f32_16x16x32_bf16 v[168:171], v[68:71], a[116:119], v[168:171]
    ds_read_b64_tr_b16 a[130:131], v228 offset:8704
    v_mul_f32 v55, v59, v59
    v_sub_f32 v56, v20, v48
    v_mfma_f32_16x16x32_bf16 v[172:175], v[72:75], a[100:103], v[172:175]
    ds_read_b64_tr_b16 a[132:133], v229 offset:8192
    v_fmac_f32_e64 v52, v56, v56
    v_mfma_f32_16x16x32_bf16 v[172:175], v[76:79], a[116:119], v[172:175]
    ds_read_b64_tr_b16 a[134:135], v229 offset:8704
    v_sub_f32_e64 v57, v21, v48
    v_mfma_f32_16x16x32_bf16 v[176:179], v[64:67], a[104:107], v[176:179]
    ds_read_b64_tr_b16 a[136:137], v230 offset:8192
    s_add_u32 m0, s35, 0
    s_and_b32 s33, s86, 1023
    s_lshl_b32 s33, s33, 12
    buffer_load_dwordx4 v234, s[48:51], s33 offen lds
    v_mfma_f32_16x16x32_bf16 v[176:179], v[68:71], a[120:123], v[176:179]
    ds_read_b64_tr_b16 a[138:139], v230 offset:8704
    v_fmac_f32_e64 v53, v57, v57
    v_mfma_f32_16x16x32_bf16 v[180:183], v[72:75], a[104:107], v[180:183]
    ds_read_b64_tr_b16 a[140:141], v231 offset:8192
    buffer_load_dwordx4 v235, s[48:51], s33 offen offset:1024 lds
    v_mfma_f32_16x16x32_bf16 v[180:183], v[76:79], a[120:123], v[180:183]
    ds_read_b64_tr_b16 a[142:143], v231 offset:8704
    v_sub_f32_e64 v58, v22, v48
    v_mfma_f32_16x16x32_bf16 v[184:187], v[64:67], a[108:111], v[184:187]
    s_add_u32 m0, s35, 2048
    s_add_u32 s33, s33, 131072
    buffer_load_dwordx4 v234, s[48:51], s33 offen lds
    v_mfma_f32_16x16x32_bf16 v[184:187], v[68:71], a[124:127], v[184:187]
    v_fmac_f32 v54, v58, v58
    v_sub_f32 v59, v23, v48
    v_fmac_f32_e64 v55, v59, v59
    v_mfma_f32_16x16x32_bf16 v[188:191], v[72:75], a[108:111], v[188:191]
    buffer_load_dwordx4 v235, s[48:51], s33 offen offset:1024 lds
    v_sub_f32_e64 v56, v24, v48
    v_mfma_f32_16x16x32_bf16 v[188:191], v[76:79], a[124:127], v[188:191]
    s_waitcnt vmcnt(30) lgkmcnt(0)
    s_barrier
    v_mfma_f32_16x16x32_bf16 v[192:195], v[80:83], a[96:99], v[192:195]
    ds_read_b128 v[64:67], v224 offset:0
    v_fmac_f32_e64 v52, v56, v56
    v_mfma_f32_16x16x32_bf16 v[192:195], v[84:87], a[112:115], v[192:195]
    ds_read_b128 v[68:71], v225 offset:0
    v_sub_f32_e64 v57, v25, v48
    v_mfma_f32_16x16x32_bf16 v[196:199], v[88:91], a[96:99], v[196:199]
    ds_read_b128 v[72:75], v224 offset:2048
    v_fmac_f32_e64 v53, v57, v57
    v_mfma_f32_16x16x32_bf16 v[196:199], v[92:95], a[112:115], v[196:199]
    ds_read_b128 v[76:79], v225 offset:2048
    v_sub_f32 v58, v26, v48
    v_fmac_f32 v54, v58, v58
    v_mfma_f32_16x16x32_bf16 v[200:203], v[80:83], a[100:103], v[200:203]
    ds_read_b64_tr_b16 a[144:145], v228 offset:12288
    v_sub_f32_e64 v59, v27, v48
    v_mfma_f32_16x16x32_bf16 v[200:203], v[84:87], a[116:119], v[200:203]
    ds_read_b64_tr_b16 a[146:147], v228 offset:12800
    v_fmac_f32_e64 v55, v59, v59
    v_mfma_f32_16x16x32_bf16 v[204:207], v[88:91], a[100:103], v[204:207]
    ds_read_b64_tr_b16 a[148:149], v229 offset:12288
    v_sub_f32_e64 v56, v28, v48
    v_mfma_f32_16x16x32_bf16 v[204:207], v[92:95], a[116:119], v[204:207]
    ds_read_b64_tr_b16 a[150:151], v229 offset:12800
    v_fmac_f32_e64 v52, v56, v56
    v_mfma_f32_16x16x32_bf16 v[208:211], v[80:83], a[104:107], v[208:211]
    ds_read_b64_tr_b16 a[152:153], v230 offset:12288
    s_add_u32 m0, s34, 49152
    s_add_u32 s37, s87, 0
    buffer_load_dwordx4 v232, s[44:47], s37 offen lds
    v_mfma_f32_16x16x32_bf16 v[208:211], v[84:87], a[120:123], v[208:211]
    ds_read_b64_tr_b16 a[154:155], v230 offset:12800
    v_sub_f32 v57, v29, v48
    v_mfma_f32_16x16x32_bf16 v[212:215], v[88:91], a[104:107], v[212:215]
    ds_read_b64_tr_b16 a[156:157], v231 offset:12288
    v_fmac_f32 v53, v57, v57
    v_sub_f32 v58, v30, v48
    v_mfma_f32_16x16x32_bf16 v[212:215], v[92:95], a[120:123], v[212:215]
    ds_read_b64_tr_b16 a[158:159], v231 offset:12800
    v_fmac_f32_e64 v54, v58, v58
    v_mfma_f32_16x16x32_bf16 v[216:219], v[80:83], a[108:111], v[216:219]
    buffer_load_dwordx4 v233, s[44:47], s37 offen offset:1024 lds
    v_sub_f32_e64 v59, v31, v48
    v_mfma_f32_16x16x32_bf16 v[216:219], v[84:87], a[124:127], v[216:219]
    v_fmac_f32 v55, v59, v59
    v_sub_f32 v56, v32, v48
    v_mfma_f32_16x16x32_bf16 v[220:223], v[88:91], a[108:111], v[220:223]
    v_fmac_f32 v52, v56, v56
    v_sub_f32 v57, v33, v48
    v_fmac_f32_e64 v53, v57, v57
    v_mfma_f32_16x16x32_bf16 v[220:223], v[92:95], a[124:127], v[220:223]
    v_sub_f32 v58, v34, v48
    s_waitcnt lgkmcnt(0)
    v_mfma_f32_16x16x32_bf16 v[96:99], v[64:67], a[128:131], v[96:99]
    ds_read_b128 v[80:83], v224 offset:4096
    v_fmac_f32_e64 v54, v58, v58
    v_mfma_f32_16x16x32_bf16 v[96:99], v[68:71], a[144:147], v[96:99]
    ds_read_b128 v[84:87], v225 offset:4096
    v_sub_f32_e64 v59, v35, v48
    v_mfma_f32_16x16x32_bf16 v[100:103], v[72:75], a[128:131], v[100:103]
    ds_read_b128 v[88:91], v224 offset:6144
    v_fmac_f32_e64 v55, v59, v59
    v_mfma_f32_16x16x32_bf16 v[100:103], v[76:79], a[144:147], v[100:103]
    ds_read_b128 v[92:95], v225 offset:6144
    v_sub_f32 v56, v36, v48
    v_fmac_f32 v52, v56, v56
    v_mfma_f32_16x16x32_bf16 v[104:107], v[64:67], a[132:135], v[104:107]
    v_sub_f32 v57, v37, v48
    v_fmac_f32 v53, v57, v57
    v_mfma_f32_16x16x32_bf16 v[104:107], v[68:71], a[148:151], v[104:107]
    v_sub_f32 v58, v38, v48
    v_fmac_f32 v54, v58, v58
    v_mfma_f32_16x16x32_bf16 v[108:111], v[72:75], a[132:135], v[108:111]
    v_sub_f32 v59, v39, v48
    v_fmac_f32 v55, v59, v59
    v_sub_f32_e64 v56, v40, v48
    v_mfma_f32_16x16x32_bf16 v[108:111], v[76:79], a[148:151], v[108:111]
    v_fmac_f32 v52, v56, v56
    v_sub_f32 v57, v41, v48
    v_mfma_f32_16x16x32_bf16 v[112:115], v[64:67], a[136:139], v[112:115]
    s_add_u32 m0, s35, 4096
    s_add_u32 s33, s33, 131072
    buffer_load_dwordx4 v234, s[48:51], s33 offen lds
    v_mfma_f32_16x16x32_bf16 v[112:115], v[68:71], a[152:155], v[112:115]
    v_fmac_f32 v53, v57, v57
    v_sub_f32 v58, v42, v48
    v_mfma_f32_16x16x32_bf16 v[116:119], v[72:75], a[136:139], v[116:119]
    buffer_load_dwordx4 v235, s[48:51], s33 offen offset:1024 lds
    v_fmac_f32 v54, v58, v58
    v_sub_f32 v59, v43, v48
    v_mfma_f32_16x16x32_bf16 v[116:119], v[76:79], a[152:155], v[116:119]
    v_fmac_f32 v55, v59, v59
    v_sub_f32 v56, v44, v48
    v_mfma_f32_16x16x32_bf16 v[120:123], v[64:67], a[140:143], v[120:123]
    s_add_u32 m0, s35, 6144
    s_add_u32 s33, s33, 131072
    buffer_load_dwordx4 v234, s[48:51], s33 offen lds
    v_mfma_f32_16x16x32_bf16 v[120:123], v[68:71], a[156:159], v[120:123]
    v_fmac_f32 v52, v56, v56
    v_sub_f32 v57, v45, v48
    v_mfma_f32_16x16x32_bf16 v[124:127], v[72:75], a[140:143], v[124:127]
    buffer_load_dwordx4 v235, s[48:51], s33 offen offset:1024 lds
    v_fmac_f32 v53, v57, v57
    v_sub_f32 v58, v46, v48
    v_mfma_f32_16x16x32_bf16 v[124:127], v[76:79], a[156:159], v[124:127]
    v_fmac_f32 v54, v58, v58
    s_waitcnt lgkmcnt(0)
    v_mfma_f32_16x16x32_bf16 v[128:131], v[80:83], a[128:131], v[128:131]
    ds_read_b128 v[64:67], v224 offset:8192
    v_sub_f32_e64 v59, v47, v48
    v_mfma_f32_16x16x32_bf16 v[128:131], v[84:87], a[144:147], v[128:131]
    ds_read_b128 v[68:71], v225 offset:8192
    v_fmac_f32_e64 v55, v59, v59
    v_mfma_f32_16x16x32_bf16 v[132:135], v[88:91], a[128:131], v[132:135]
    ds_read_b128 v[72:75], v224 offset:10240
    v_add_f32_e64 v52, v52, v53
    v_mfma_f32_16x16x32_bf16 v[132:135], v[92:95], a[144:147], v[132:135]
    ds_read_b128 v[76:79], v225 offset:10240
    v_add_f32_e64 v54, v54, v55
    v_mfma_f32_16x16x32_bf16 v[136:139], v[80:83], a[132:135], v[136:139]
    v_add_f32 v51, v52, v54
    s_nop 1
    v_add_f32_dpp v51, v51, v51 quad_perm:[1,0,3,2] row_mask:0xf bank_mask:0xf
    v_mfma_f32_16x16x32_bf16 v[136:139], v[84:87], a[148:151], v[136:139]
    s_nop 1
    v_add_f32_dpp v51, v51, v51 quad_perm:[2,3,0,1] row_mask:0xf bank_mask:0xf
    v_mfma_f32_16x16x32_bf16 v[140:143], v[88:91], a[132:135], v[140:143]
    s_nop 1
    v_add_f32_dpp v51, v51, v51 row_half_mirror row_mask:0xf bank_mask:0xf
    s_nop 1
    v_mfma_f32_16x16x32_bf16 v[140:143], v[92:95], a[148:151], v[140:143]
    v_add_f32_dpp v51, v51, v51 row_mirror row_mask:0xf bank_mask:0xf
    s_nop 0
    v_mfma_f32_16x16x32_bf16 v[144:147], v[80:83], a[136:139], v[144:147]
    s_add_u32 m0, s34, 57344
    s_add_u32 s37, s87, 65536
    buffer_load_dwordx4 v232, s[44:47], s37 offen lds
    v_mfma_f32_16x16x32_bf16 v[144:147], v[84:87], a[152:155], v[144:147]
    v_mov_b32 v49, v51
    s_nop 1
    v_mfma_f32_16x16x32_bf16 v[148:151], v[88:91], a[136:139], v[148:151]
    buffer_load_dwordx4 v233, s[44:47], s37 offen offset:1024 lds
    v_permlane16_swap_b32 v51, v49
    s_nop 0
    v_mfma_f32_16x16x32_bf16 v[148:151], v[92:95], a[152:155], v[148:151]
    v_add_f32_e64 v51, v51, v49
    v_mul_f32 v51, 0x3a800000, v51
    v_mfma_f32_16x16x32_bf16 v[152:155], v[80:83], a[140:143], v[152:155]
    v_lshlrev_b32_e64 v227, 3, v240
    v_min_u32 v227, 1920, v227
    s_lshl2_add_u32 s25, s2, s3
    v_mfma_f32_16x16x32_bf16 v[152:155], v[84:87], a[156:159], v[152:155]
    v_cvt_pk_bf16_f32 v50, v48, v51
    v_and_b32 v51, 0xffff0000, v50
    v_mfma_f32_16x16x32_bf16 v[156:159], v[88:91], a[140:143], v[156:159]
    s_lshl_b32 s25, s25, 13
    s_add_u32 s25, s25, 2048
    buffer_load_dword v241, v227, s[12:15], s25 offen
    v_mfma_f32_16x16x32_bf16 v[156:159], v[92:95], a[156:159], v[156:159]
    v_lshlrev_b32 v50, 16, v50
    s_waitcnt vmcnt(16) lgkmcnt(0)
    v_mfma_f32_16x16x32_bf16 v[160:163], v[64:67], a[128:131], v[160:163]
    ds_read_b128 v[80:83], v224 offset:12288
    v_add_f32 v51, 0x3727c5ac, v51
    v_cvt_pk_bf16_f32 v51, v51, v51
    v_mfma_f32_16x16x32_bf16 v[160:163], v[68:71], a[144:147], v[160:163]
    ds_read_b128 v[84:87], v225 offset:12288
    v_lshlrev_b32_e64 v51, 16, v51
    v_mfma_f32_16x16x32_bf16 v[164:167], v[72:75], a[128:131], v[164:167]
    ds_read_b128 v[88:91], v224 offset:14336
    v_mfma_f32_16x16x32_bf16 v[164:167], v[76:79], a[144:147], v[164:167]
    ds_read_b128 v[92:95], v225 offset:14336
    v_sqrt_f32 v51, v51
    v_mfma_f32_16x16x32_bf16 v[168:171], v[64:67], a[132:135], v[168:171]
    ds_read_b64_tr_b16 a[160:161], v228 offset:16384
    s_nop 0
    v_mfma_f32_16x16x32_bf16 v[168:171], v[68:71], a[148:151], v[168:171]
    ds_read_b64_tr_b16 a[162:163], v228 offset:16896
    v_cvt_pk_bf16_f32 v51, v51, v51
    v_lshlrev_b32_e64 v51, 16, v51
    v_mfma_f32_16x16x32_bf16 v[172:175], v[72:75], a[132:135], v[172:175]
    ds_read_b64_tr_b16 a[164:165], v229 offset:16384
    v_mfma_f32_16x16x32_bf16 v[172:175], v[76:79], a[148:151], v[172:175]
    ds_read_b64_tr_b16 a[166:167], v229 offset:16896
    v_rcp_f32_e64 v51, v51
    v_mfma_f32_16x16x32_bf16 v[176:179], v[64:67], a[136:139], v[176:179]
    ds_read_b64_tr_b16 a[168:169], v230 offset:16384
    s_add_u32 m0, s35, 8192
    s_and_b32 s33, s87, 1023
    s_lshl_b32 s33, s33, 12
    buffer_load_dwordx4 v234, s[48:51], s33 offen lds
    v_mfma_f32_16x16x32_bf16 v[176:179], v[68:71], a[152:155], v[176:179]
    ds_read_b64_tr_b16 a[170:171], v230 offset:16896
    s_nop 0
    v_mfma_f32_16x16x32_bf16 v[180:183], v[72:75], a[136:139], v[180:183]
    ds_read_b64_tr_b16 a[172:173], v231 offset:16384
    buffer_load_dwordx4 v235, s[48:51], s33 offen offset:1024 lds
    v_mfma_f32_16x16x32_bf16 v[180:183], v[76:79], a[152:155], v[180:183]
    ds_read_b64_tr_b16 a[174:175], v231 offset:16896
    v_mul_f32 v51, 0x3e0293ee, v51
    v_mfma_f32_16x16x32_bf16 v[184:187], v[64:67], a[140:143], v[184:187]
    s_add_u32 m0, s35, 10240
    s_add_u32 s33, s33, 131072
    buffer_load_dwordx4 v234, s[48:51], s33 offen lds
    v_mfma_f32_16x16x32_bf16 v[184:187], v[68:71], a[156:159], v[184:187]
    v_sub_f32 v16, v16, v50
    v_sub_f32 v17, v17, v50
    v_cvt_pk_bf16_f32 v17, v16, v17
    v_mfma_f32_16x16x32_bf16 v[188:191], v[72:75], a[140:143], v[188:191]
    buffer_load_dwordx4 v235, s[48:51], s33 offen offset:1024 lds
    v_lshlrev_b32_e64 v16, 16, v17
    v_mfma_f32_16x16x32_bf16 v[188:191], v[76:79], a[156:159], v[188:191]
    s_waitcnt vmcnt(31) lgkmcnt(0)
    s_barrier
    v_mfma_f32_16x16x32_bf16 v[192:195], v[80:83], a[128:131], v[192:195]
    ds_read_b128 v[64:67], v224 offset:16384
    v_and_b32 v17, 0xffff0000, v17
    v_mfma_f32_16x16x32_bf16 v[192:195], v[84:87], a[144:147], v[192:195]
    ds_read_b128 v[68:71], v225 offset:16384
    v_mul_f32_e64 v16, v16, v51
    v_mfma_f32_16x16x32_bf16 v[196:199], v[88:91], a[128:131], v[196:199]
    ds_read_b128 v[72:75], v224 offset:18432
    v_mul_f32_e64 v17, v17, v51
    v_mfma_f32_16x16x32_bf16 v[196:199], v[92:95], a[144:147], v[196:199]
    ds_read_b128 v[76:79], v225 offset:18432
    v_cvt_pk_bf16_f32 v0, v16, v17
    v_sub_f32_e64 v18, v18, v50
    v_mfma_f32_16x16x32_bf16 v[200:203], v[80:83], a[132:135], v[200:203]
    ds_read_b64_tr_b16 a[176:177], v228 offset:20480
    v_sub_f32_e64 v19, v19, v50
    v_mfma_f32_16x16x32_bf16 v[200:203], v[84:87], a[148:151], v[200:203]
    ds_read_b64_tr_b16 a[178:179], v228 offset:20992
    v_cvt_pk_bf16_f32 v19, v18, v19
    v_mfma_f32_16x16x32_bf16 v[204:207], v[88:91], a[132:135], v[204:207]
    ds_read_b64_tr_b16 a[180:181], v229 offset:20480
    v_lshlrev_b32_e64 v18, 16, v19
    v_mfma_f32_16x16x32_bf16 v[204:207], v[92:95], a[148:151], v[204:207]
    ds_read_b64_tr_b16 a[182:183], v229 offset:20992
    v_and_b32 v19, 0xffff0000, v19
    v_mfma_f32_16x16x32_bf16 v[208:211], v[80:83], a[136:139], v[208:211]
    ds_read_b64_tr_b16 a[184:185], v230 offset:20480
    s_add_u32 m0, s34, 0
    s_add_u32 s37, s80, 131072
    buffer_load_dwordx4 v232, s[44:47], s37 offen lds
    v_mfma_f32_16x16x32_bf16 v[208:211], v[84:87], a[152:155], v[208:211]
    ds_read_b64_tr_b16 a[186:187], v230 offset:20992
    v_mul_f32 v18, v18, v51
    v_mfma_f32_16x16x32_bf16 v[212:215], v[88:91], a[136:139], v[212:215]
    ds_read_b64_tr_b16 a[188:189], v231 offset:20480
    v_mul_f32_e64 v19, v19, v51
    v_cvt_pk_bf16_f32 v1, v18, v19
    v_mfma_f32_16x16x32_bf16 v[212:215], v[92:95], a[152:155], v[212:215]
    ds_read_b64_tr_b16 a[190:191], v231 offset:20992
    v_sub_f32_e64 v20, v20, v50
    v_mfma_f32_16x16x32_bf16 v[216:219], v[80:83], a[140:143], v[216:219]
    buffer_load_dwordx4 v233, s[44:47], s37 offen offset:1024 lds
    v_sub_f32_e64 v21, v21, v50
    v_mfma_f32_16x16x32_bf16 v[216:219], v[84:87], a[156:159], v[216:219]
    v_cvt_pk_bf16_f32 v21, v20, v21
    v_lshlrev_b32_e64 v20, 16, v21
    v_mfma_f32_16x16x32_bf16 v[220:223], v[88:91], a[140:143], v[220:223]
    v_and_b32 v21, 0xffff0000, v21
    v_mul_f32 v20, v20, v51
    v_mul_f32 v21, v21, v51
    v_mfma_f32_16x16x32_bf16 v[220:223], v[92:95], a[156:159], v[220:223]
    v_cvt_pk_bf16_f32 v2, v20, v21
    s_waitcnt lgkmcnt(0)
    v_mfma_f32_16x16x32_bf16 v[96:99], v[64:67], a[160:163], v[96:99]
    ds_read_b128 v[80:83], v224 offset:20480
    v_sub_f32 v22, v22, v50
    v_mfma_f32_16x16x32_bf16 v[96:99], v[68:71], a[176:179], v[96:99]
    ds_read_b128 v[84:87], v225 offset:20480
    v_sub_f32_e64 v23, v23, v50
    v_mfma_f32_16x16x32_bf16 v[100:103], v[72:75], a[160:163], v[100:103]
    ds_read_b128 v[88:91], v224 offset:22528
    v_cvt_pk_bf16_f32 v23, v22, v23
    v_mfma_f32_16x16x32_bf16 v[100:103], v[76:79], a[176:179], v[100:103]
    ds_read_b128 v[92:95], v225 offset:22528
    v_lshlrev_b32_e64 v22, 16, v23
    v_and_b32 v23, 0xffff0000, v23
    v_mfma_f32_16x16x32_bf16 v[104:107], v[64:67], a[164:167], v[104:107]
    v_mul_f32 v22, v22, v51
    v_mul_f32 v23, v23, v51
    v_mfma_f32_16x16x32_bf16 v[104:107], v[68:71], a[180:183], v[104:107]
    v_cvt_pk_bf16_f32 v3, v22, v23
    v_sub_f32_e64 v24, v24, v50
    v_mfma_f32_16x16x32_bf16 v[108:111], v[72:75], a[164:167], v[108:111]
    v_sub_f32_e64 v25, v25, v50
    v_cvt_pk_bf16_f32 v25, v24, v25
    v_lshlrev_b32_e64 v24, 16, v25
    v_mfma_f32_16x16x32_bf16 v[108:111], v[76:79], a[180:183], v[108:111]
    v_and_b32 v25, 0xffff0000, v25
    v_mul_f32_e64 v24, v24, v51
    v_mfma_f32_16x16x32_bf16 v[112:115], v[64:67], a[168:171], v[112:115]
    s_add_u32 m0, s35, 12288
    s_add_u32 s33, s33, 131072
    buffer_load_dwordx4 v234, s[48:51], s33 offen lds
    v_mfma_f32_16x16x32_bf16 v[112:115], v[68:71], a[184:187], v[112:115]
    v_mul_f32_e64 v25, v25, v51
    v_cvt_pk_bf16_f32 v4, v24, v25
    v_mfma_f32_16x16x32_bf16 v[116:119], v[72:75], a[168:171], v[116:119]
    buffer_load_dwordx4 v235, s[48:51], s33 offen offset:1024 lds
    v_sub_f32 v26, v26, v50
    v_sub_f32 v27, v27, v50
    v_mfma_f32_16x16x32_bf16 v[116:119], v[76:79], a[184:187], v[116:119]
    v_cvt_pk_bf16_f32 v27, v26, v27
    v_lshlrev_b32_e64 v26, 16, v27
    v_mfma_f32_16x16x32_bf16 v[120:123], v[64:67], a[172:175], v[120:123]
    s_add_u32 m0, s35, 14336
    s_add_u32 s33, s33, 131072
    buffer_load_dwordx4 v234, s[48:51], s33 offen lds
    v_mfma_f32_16x16x32_bf16 v[120:123], v[68:71], a[188:191], v[120:123]
    v_and_b32 v27, 0xffff0000, v27
    v_mul_f32_e64 v26, v26, v51
    v_mfma_f32_16x16x32_bf16 v[124:127], v[72:75], a[172:175], v[124:127]
    buffer_load_dwordx4 v235, s[48:51], s33 offen offset:1024 lds
    v_mul_f32_e64 v27, v27, v51
    v_cvt_pk_bf16_f32 v5, v26, v27
    v_mfma_f32_16x16x32_bf16 v[124:127], v[76:79], a[188:191], v[124:127]
    v_sub_f32 v28, v28, v50
    s_waitcnt lgkmcnt(0)
    v_mfma_f32_16x16x32_bf16 v[128:131], v[80:83], a[160:163], v[128:131]
    ds_read_b128 v[64:67], v224 offset:24576
    v_sub_f32_e64 v29, v29, v50
    v_mfma_f32_16x16x32_bf16 v[128:131], v[84:87], a[176:179], v[128:131]
    ds_read_b128 v[68:71], v225 offset:24576
    v_cvt_pk_bf16_f32 v29, v28, v29
    v_mfma_f32_16x16x32_bf16 v[132:135], v[88:91], a[160:163], v[132:135]
    ds_read_b128 v[72:75], v224 offset:26624
    v_lshlrev_b32_e64 v28, 16, v29
    v_mfma_f32_16x16x32_bf16 v[132:135], v[92:95], a[176:179], v[132:135]
    ds_read_b128 v[76:79], v225 offset:26624
    v_and_b32 v29, 0xffff0000, v29
    v_mfma_f32_16x16x32_bf16 v[136:139], v[80:83], a[164:167], v[136:139]
    v_mul_f32 v28, v28, v51
    v_mul_f32 v29, v29, v51
    v_cvt_pk_bf16_f32 v6, v28, v29
    v_mfma_f32_16x16x32_bf16 v[136:139], v[84:87], a[180:183], v[136:139]
    v_sub_f32 v30, v30, v50
    v_sub_f32 v31, v31, v50
    v_mfma_f32_16x16x32_bf16 v[140:143], v[88:91], a[164:167], v[140:143]
    v_cvt_pk_bf16_f32 v31, v30, v31
    v_lshlrev_b32_e64 v30, 16, v31
    v_and_b32 v31, 0xffff0000, v31
    v_mfma_f32_16x16x32_bf16 v[140:143], v[92:95], a[180:183], v[140:143]
    v_mul_f32 v30, v30, v51
    v_mul_f32 v31, v31, v51
    v_mfma_f32_16x16x32_bf16 v[144:147], v[80:83], a[168:171], v[144:147]
    s_add_u32 m0, s34, 8192
    s_add_u32 s37, s81, 131072
    buffer_load_dwordx4 v232, s[44:47], s37 offen lds
    v_mfma_f32_16x16x32_bf16 v[144:147], v[84:87], a[184:187], v[144:147]
    v_cvt_pk_bf16_f32 v7, v30, v31
    v_sub_f32_e64 v32, v32, v50
    v_mfma_f32_16x16x32_bf16 v[148:151], v[88:91], a[168:171], v[148:151]
    buffer_load_dwordx4 v233, s[44:47], s37 offen offset:1024 lds
    v_sub_f32_e64 v33, v33, v50
    v_mfma_f32_16x16x32_bf16 v[148:151], v[92:95], a[184:187], v[148:151]
    v_cvt_pk_bf16_f32 v33, v32, v33
    v_lshlrev_b32_e64 v32, 16, v33
    v_and_b32 v33, 0xffff0000, v33
    v_mfma_f32_16x16x32_bf16 v[152:155], v[80:83], a[172:175], v[152:155]
    v_lshlrev_b32_e64 v227, 3, v240
    v_min_u32 v227, 1920, v227
    s_lshl2_add_u32 s25, s2, s3
    v_mfma_f32_16x16x32_bf16 v[152:155], v[84:87], a[188:191], v[152:155]
    v_mul_f32 v32, v32, v51
    v_mul_f32_e64 v33, v33, v51
    v_mfma_f32_16x16x32_bf16 v[156:159], v[88:91], a[172:175], v[156:159]
    s_lshl_b32 s25, s25, 13
    s_add_u32 s25, s25, 4096
    buffer_load_dword v241, v227, s[12:15], s25 offen
    v_mfma_f32_16x16x32_bf16 v[156:159], v[92:95], a[188:191], v[156:159]
    v_cvt_pk_bf16_f32 v8, v32, v33
    s_waitcnt vmcnt(16) lgkmcnt(0)
    v_mfma_f32_16x16x32_bf16 v[160:163], v[64:67], a[160:163], v[160:163]
    ds_read_b128 v[80:83], v224 offset:28672
    v_sub_f32 v34, v34, v50
    v_sub_f32 v35, v35, v50
    v_mfma_f32_16x16x32_bf16 v[160:163], v[68:71], a[176:179], v[160:163]
    ds_read_b128 v[84:87], v225 offset:28672
    v_cvt_pk_bf16_f32 v35, v34, v35
    v_mfma_f32_16x16x32_bf16 v[164:167], v[72:75], a[160:163], v[164:167]
    ds_read_b128 v[88:91], v224 offset:30720
    v_lshlrev_b32_e64 v34, 16, v35
    v_mfma_f32_16x16x32_bf16 v[164:167], v[76:79], a[176:179], v[164:167]
    ds_read_b128 v[92:95], v225 offset:30720
    v_and_b32 v35, 0xffff0000, v35
    v_mfma_f32_16x16x32_bf16 v[168:171], v[64:67], a[164:167], v[168:171]
    ds_read_b64_tr_b16 a[192:193], v228 offset:0
    v_mul_f32_e64 v34, v34, v51
    v_mfma_f32_16x16x32_bf16 v[168:171], v[68:71], a[180:183], v[168:171]
    ds_read_b64_tr_b16 a[194:195], v228 offset:512
    v_mul_f32_e64 v35, v35, v51
    v_cvt_pk_bf16_f32 v9, v34, v35
    v_mfma_f32_16x16x32_bf16 v[172:175], v[72:75], a[164:167], v[172:175]
    ds_read_b64_tr_b16 a[196:197], v229 offset:0
    v_sub_f32_e64 v36, v36, v50
    v_mfma_f32_16x16x32_bf16 v[172:175], v[76:79], a[180:183], v[172:175]
    ds_read_b64_tr_b16 a[198:199], v229 offset:512
    v_sub_f32_e64 v37, v37, v50
    v_mfma_f32_16x16x32_bf16 v[176:179], v[64:67], a[168:171], v[176:179]
    ds_read_b64_tr_b16 a[200:201], v230 offset:0
    v_cvt_pk_bf16_f32 v37, v36, v37
    v_mfma_f32_16x16x32_bf16 v[176:179], v[68:71], a[184:187], v[176:179]
    ds_read_b64_tr_b16 a[202:203], v230 offset:512
    v_lshlrev_b32_e64 v36, 16, v37
    v_mfma_f32_16x16x32_bf16 v[180:183], v[72:75], a[168:171], v[180:183]
    ds_read_b64_tr_b16 a[204:205], v231 offset:0
    v_and_b32 v37, 0xffff0000, v37
    v_mfma_f32_16x16x32_bf16 v[180:183], v[76:79], a[184:187], v[180:183]
    ds_read_b64_tr_b16 a[206:207], v231 offset:512
    v_mul_f32 v36, v36, v51
    v_mul_f32 v37, v37, v51
    v_mfma_f32_16x16x32_bf16 v[184:187], v[64:67], a[172:175], v[184:187]
    v_cvt_pk_bf16_f32 v10, v36, v37
    v_sub_f32_e64 v38, v38, v50
    v_mfma_f32_16x16x32_bf16 v[184:187], v[68:71], a[188:191], v[184:187]
    v_sub_f32_e64 v39, v39, v50
    v_cvt_pk_bf16_f32 v39, v38, v39
    v_mfma_f32_16x16x32_bf16 v[188:191], v[72:75], a[172:175], v[188:191]
    v_lshlrev_b32_e64 v38, 16, v39
    v_and_b32 v39, 0xffff0000, v39
    v_mul_f32_e64 v38, v38, v51
    v_mfma_f32_16x16x32_bf16 v[188:191], v[76:79], a[188:191], v[188:191]
    s_waitcnt vmcnt(27) lgkmcnt(0)
    s_barrier
    v_mfma_f32_16x16x32_bf16 v[192:195], v[80:83], a[160:163], v[192:195]
    ds_read_b128 v[64:67], v224 offset:32768
    v_mul_f32_e64 v39, v39, v51
    v_mfma_f32_16x16x32_bf16 v[192:195], v[84:87], a[176:179], v[192:195]
    ds_read_b128 v[68:71], v225 offset:32768
    v_cvt_pk_bf16_f32 v11, v38, v39
    v_mfma_f32_16x16x32_bf16 v[196:199], v[88:91], a[160:163], v[196:199]
    ds_read_b128 v[72:75], v224 offset:34816
    v_sub_f32_e64 v40, v40, v50
    v_mfma_f32_16x16x32_bf16 v[196:199], v[92:95], a[176:179], v[196:199]
    ds_read_b128 v[76:79], v225 offset:34816
    v_sub_f32_e64 v41, v41, v50
    v_mfma_f32_16x16x32_bf16 v[200:203], v[80:83], a[164:167], v[200:203]
    ds_read_b64_tr_b16 a[208:209], v228 offset:4096
    v_cvt_pk_bf16_f32 v41, v40, v41
    v_lshlrev_b32_e64 v40, 16, v41
    v_mfma_f32_16x16x32_bf16 v[200:203], v[84:87], a[180:183], v[200:203]
    ds_read_b64_tr_b16 a[210:211], v228 offset:4608
    v_and_b32 v41, 0xffff0000, v41
    v_mfma_f32_16x16x32_bf16 v[204:207], v[88:91], a[164:167], v[204:207]
    ds_read_b64_tr_b16 a[212:213], v229 offset:4096
    v_mul_f32_e64 v40, v40, v51
    v_mfma_f32_16x16x32_bf16 v[204:207], v[92:95], a[180:183], v[204:207]
    ds_read_b64_tr_b16 a[214:215], v229 offset:4608
    v_mul_f32_e64 v41, v41, v51
    v_mfma_f32_16x16x32_bf16 v[208:211], v[80:83], a[168:171], v[208:211]
    ds_read_b64_tr_b16 a[216:217], v230 offset:4096
    s_add_u32 m0, s34, 16384
    s_add_u32 s37, s82, 131072
    buffer_load_dwordx4 v232, s[44:47], s37 offen lds
    v_mfma_f32_16x16x32_bf16 v[208:211], v[84:87], a[184:187], v[208:211]
    ds_read_b64_tr_b16 a[218:219], v230 offset:4608
    v_cvt_pk_bf16_f32 v12, v40, v41
    v_mfma_f32_16x16x32_bf16 v[212:215], v[88:91], a[168:171], v[212:215]
    ds_read_b64_tr_b16 a[220:221], v231 offset:4096
    v_sub_f32 v42, v42, v50
    v_sub_f32 v43, v43, v50
    v_mfma_f32_16x16x32_bf16 v[212:215], v[92:95], a[184:187], v[212:215]
    ds_read_b64_tr_b16 a[222:223], v231 offset:4608
    v_cvt_pk_bf16_f32 v43, v42, v43
    v_mfma_f32_16x16x32_bf16 v[216:219], v[80:83], a[172:175], v[216:219]
    buffer_load_dwordx4 v233, s[44:47], s37 offen offset:1024 lds
    v_lshlrev_b32_e64 v42, 16, v43
    v_mfma_f32_16x16x32_bf16 v[216:219], v[84:87], a[188:191], v[216:219]
    v_and_b32 v43, 0xffff0000, v43
    v_mul_f32_e64 v42, v42, v51
    v_mfma_f32_16x16x32_bf16 v[220:223], v[88:91], a[172:175], v[220:223]
    v_mul_f32_e64 v43, v43, v51
    v_cvt_pk_bf16_f32 v13, v42, v43
    v_sub_f32_e64 v44, v44, v50
    v_mfma_f32_16x16x32_bf16 v[220:223], v[92:95], a[188:191], v[220:223]
    v_sub_f32 v45, v45, v50
    s_waitcnt lgkmcnt(0)
    v_mfma_f32_16x16x32_bf16 v[96:99], v[64:67], a[192:195], v[96:99]
    ds_read_b128 v[80:83], v224 offset:36864
    v_cvt_pk_bf16_f32 v45, v44, v45
    v_mfma_f32_16x16x32_bf16 v[96:99], v[68:71], a[208:211], v[96:99]
    ds_read_b128 v[84:87], v225 offset:36864
    v_lshlrev_b32_e64 v44, 16, v45
    v_mfma_f32_16x16x32_bf16 v[100:103], v[72:75], a[192:195], v[100:103]
    ds_read_b128 v[88:91], v224 offset:38912
    v_and_b32 v45, 0xffff0000, v45
    v_mfma_f32_16x16x32_bf16 v[100:103], v[76:79], a[208:211], v[100:103]
    ds_read_b128 v[92:95], v225 offset:38912
    v_mul_f32 v44, v44, v51
    v_mul_f32 v45, v45, v51
    v_mfma_f32_16x16x32_bf16 v[104:107], v[64:67], a[196:199], v[104:107]
    v_cvt_pk_bf16_f32 v14, v44, v45
    v_sub_f32_e64 v46, v46, v50
    v_mfma_f32_16x16x32_bf16 v[104:107], v[68:71], a[212:215], v[104:107]
    v_sub_f32_e64 v47, v47, v50
    v_cvt_pk_bf16_f32 v47, v46, v47
    v_mfma_f32_16x16x32_bf16 v[108:111], v[72:75], a[196:199], v[108:111]
    v_lshlrev_b32_e64 v46, 16, v47
    v_and_b32 v47, 0xffff0000, v47
    v_mul_f32_e64 v46, v46, v51
    v_mfma_f32_16x16x32_bf16 v[108:111], v[76:79], a[212:215], v[108:111]
    v_mul_f32_e64 v47, v47, v51
    v_cvt_pk_bf16_f32 v15, v46, v47
    v_mfma_f32_16x16x32_bf16 v[112:115], v[64:67], a[200:203], v[112:115]
    v_mfma_f32_16x16x32_bf16 v[112:115], v[68:71], a[216:219], v[112:115]
    ds_write_b128 v237, v[0:3] offset:0
    v_mfma_f32_16x16x32_bf16 v[116:119], v[72:75], a[200:203], v[116:119]
    ds_write_b128 v237, v[4:7] offset:4096
    v_mfma_f32_16x16x32_bf16 v[116:119], v[76:79], a[216:219], v[116:119]
    ds_write_b128 v237, v[8:11] offset:24576
    v_mfma_f32_16x16x32_bf16 v[120:123], v[64:67], a[204:207], v[120:123]
    ds_write_b128 v237, v[12:15] offset:28672
    v_mfma_f32_16x16x32_bf16 v[120:123], v[68:71], a[220:223], v[120:123]
    v_mfma_f32_16x16x32_bf16 v[124:127], v[72:75], a[204:207], v[124:127]
    v_mfma_f32_16x16x32_bf16 v[124:127], v[76:79], a[220:223], v[124:127]
    s_waitcnt lgkmcnt(0)
    v_mfma_f32_16x16x32_bf16 v[128:131], v[80:83], a[192:195], v[128:131]
    ds_read_b128 v[64:67], v224 offset:40960
    v_mfma_f32_16x16x32_bf16 v[128:131], v[84:87], a[208:211], v[128:131]
    ds_read_b128 v[68:71], v225 offset:40960
    v_mfma_f32_16x16x32_bf16 v[132:135], v[88:91], a[192:195], v[132:135]
    ds_read_b128 v[72:75], v224 offset:43008
    v_mfma_f32_16x16x32_bf16 v[132:135], v[92:95], a[208:211], v[132:135]
    ds_read_b128 v[76:79], v225 offset:43008
    v_mfma_f32_16x16x32_bf16 v[136:139], v[80:83], a[196:199], v[136:139]
    v_mfma_f32_16x16x32_bf16 v[136:139], v[84:87], a[212:215], v[136:139]
    v_mfma_f32_16x16x32_bf16 v[140:143], v[88:91], a[196:199], v[140:143]
    v_mfma_f32_16x16x32_bf16 v[140:143], v[92:95], a[212:215], v[140:143]
    v_mfma_f32_16x16x32_bf16 v[144:147], v[80:83], a[200:203], v[144:147]
    s_add_u32 m0, s34, 24576
    s_add_u32 s37, s83, 131072
    buffer_load_dwordx4 v232, s[44:47], s37 offen lds
    v_mfma_f32_16x16x32_bf16 v[144:147], v[84:87], a[216:219], v[144:147]
    buffer_load_dwordx4 v233, s[44:47], s37 offen offset:1024 lds
    v_mfma_f32_16x16x32_bf16 v[148:151], v[88:91], a[200:203], v[148:151]
    v_mfma_f32_16x16x32_bf16 v[148:151], v[92:95], a[216:219], v[148:151]
    v_lshlrev_b32 v227, 3, v240
    v_min_u32 v227, 1920, v227
    s_lshl2_add_u32 s25, s2, s3
    v_mfma_f32_16x16x32_bf16 v[152:155], v[80:83], a[204:207], v[152:155]
    s_lshl_b32 s25, s25, 13
    s_add_u32 s25, s25, 6144
    buffer_load_dword v241, v227, s[12:15], s25 offen
    v_mfma_f32_16x16x32_bf16 v[152:155], v[84:87], a[220:223], v[152:155]
    v_mfma_f32_16x16x32_bf16 v[156:159], v[88:91], a[204:207], v[156:159]
    buffer_load_dword v254, off, s[88:91], s97 sc1
    v_mfma_f32_16x16x32_bf16 v[156:159], v[92:95], a[220:223], v[156:159]
    s_waitcnt vmcnt(9) lgkmcnt(0)
    v_mfma_f32_16x16x32_bf16 v[160:163], v[64:67], a[192:195], v[160:163]
    ds_read_b128 v[80:83], v224 offset:45056
    v_mfma_f32_16x16x32_bf16 v[160:163], v[68:71], a[208:211], v[160:163]
    ds_read_b128 v[84:87], v225 offset:45056
    s_mul_i32 s38, s2, 100
    v_mfma_f32_16x16x32_bf16 v[164:167], v[72:75], a[192:195], v[164:167]
    ds_read_b128 v[88:91], v224 offset:47104
    v_mfma_f32_16x16x32_bf16 v[164:167], v[76:79], a[208:211], v[164:167]
    ds_read_b128 v[92:95], v225 offset:47104
    v_lshl_add_u32 v60, v253, 2, s38
    v_mfma_f32_16x16x32_bf16 v[168:171], v[64:67], a[196:199], v[168:171]
    ds_read_b64_tr_b16 a[224:225], v228 offset:8192
    v_mfma_f32_16x16x32_bf16 v[168:171], v[68:71], a[212:215], v[168:171]
    ds_read_b64_tr_b16 a[226:227], v228 offset:8704
    v_cmp_gt_u32 vcc, 25, v253
    v_mfma_f32_16x16x32_bf16 v[172:175], v[72:75], a[196:199], v[172:175]
    ds_read_b64_tr_b16 a[228:229], v229 offset:8192
    v_mfma_f32_16x16x32_bf16 v[172:175], v[76:79], a[212:215], v[172:175]
    ds_read_b64_tr_b16 a[230:231], v229 offset:8704
    v_mov_b32_e64 v61, 0
    v_mfma_f32_16x16x32_bf16 v[176:179], v[64:67], a[200:203], v[176:179]
    ds_read_b64_tr_b16 a[232:233], v230 offset:8192
    v_mfma_f32_16x16x32_bf16 v[176:179], v[68:71], a[216:219], v[176:179]
    ds_read_b64_tr_b16 a[234:235], v230 offset:8704
    v_mfma_f32_16x16x32_bf16 v[180:183], v[72:75], a[200:203], v[180:183]
    ds_read_b64_tr_b16 a[236:237], v231 offset:8192
    v_mov_b32 v62, 0x7ffffff0
    v_mfma_f32_16x16x32_bf16 v[180:183], v[76:79], a[216:219], v[180:183]
    ds_read_b64_tr_b16 a[238:239], v231 offset:8704
    v_mfma_f32_16x16x32_bf16 v[184:187], v[64:67], a[204:207], v[184:187]
    v_cndmask_b32 v60, v62, v60, vcc
    v_mfma_f32_16x16x32_bf16 v[184:187], v[68:71], a[220:223], v[184:187]
    buffer_store_dword v61, v60, s[56:59], 0 offen sc1
    v_mfma_f32_16x16x32_bf16 v[188:191], v[72:75], a[204:207], v[188:191]
    v_mfma_f32_16x16x32_bf16 v[188:191], v[76:79], a[220:223], v[188:191]
    s_waitcnt vmcnt(21) lgkmcnt(0)
    s_barrier
    v_mfma_f32_16x16x32_bf16 v[192:195], v[80:83], a[192:195], v[192:195]
    ds_read_b128 v[64:67], v224 offset:49152
    v_mfma_f32_16x16x32_bf16 v[192:195], v[84:87], a[208:211], v[192:195]
    ds_read_b128 v[68:71], v225 offset:49152
    v_mfma_f32_16x16x32_bf16 v[196:199], v[88:91], a[192:195], v[196:199]
    ds_read_b128 v[72:75], v224 offset:51200
    v_mfma_f32_16x16x32_bf16 v[196:199], v[92:95], a[208:211], v[196:199]
    ds_read_b128 v[76:79], v225 offset:51200
    v_mfma_f32_16x16x32_bf16 v[200:203], v[80:83], a[196:199], v[200:203]
    ds_read_b64_tr_b16 a[240:241], v228 offset:12288
    v_mfma_f32_16x16x32_bf16 v[200:203], v[84:87], a[212:215], v[200:203]
    ds_read_b64_tr_b16 a[242:243], v228 offset:12800
    v_mfma_f32_16x16x32_bf16 v[204:207], v[88:91], a[196:199], v[204:207]
    ds_read_b64_tr_b16 a[244:245], v229 offset:12288
    v_mfma_f32_16x16x32_bf16 v[204:207], v[92:95], a[212:215], v[204:207]
    ds_read_b64_tr_b16 a[246:247], v229 offset:12800
    v_mfma_f32_16x16x32_bf16 v[208:211], v[80:83], a[200:203], v[208:211]
    ds_read_b64_tr_b16 a[248:249], v230 offset:12288
    v_lshlrev_b32 v237, 4, v253
    v_add_u32 v237, 81920, v237
    ds_read_b128 v[16:19], v237 offset:0
    ds_read_b128 v[20:23], v237 offset:4096
    ds_read_b128 v[24:27], v237 offset:24576
    ds_read_b128 v[28:31], v237 offset:28672
    s_add_u32 m0, s34, 32768
    s_add_u32 s37, s84, 131072
    buffer_load_dwordx4 v232, s[44:47], s37 offen lds
    v_mfma_f32_16x16x32_bf16 v[208:211], v[84:87], a[216:219], v[208:211]
    ds_read_b64_tr_b16 a[250:251], v230 offset:12800
    v_mfma_f32_16x16x32_bf16 v[212:215], v[88:91], a[200:203], v[212:215]
    ds_read_b64_tr_b16 a[252:253], v231 offset:12288
    v_mfma_f32_16x16x32_bf16 v[212:215], v[92:95], a[216:219], v[212:215]
    ds_read_b64_tr_b16 a[254:255], v231 offset:12800
    v_mfma_f32_16x16x32_bf16 v[216:219], v[80:83], a[204:207], v[216:219]
    buffer_load_dwordx4 v233, s[44:47], s37 offen offset:1024 lds
    v_mfma_f32_16x16x32_bf16 v[216:219], v[84:87], a[220:223], v[216:219]
    v_mfma_f32_16x16x32_bf16 v[220:223], v[88:91], a[204:207], v[220:223]
    v_mfma_f32_16x16x32_bf16 v[220:223], v[92:95], a[220:223], v[220:223]
    s_waitcnt lgkmcnt(0)
    v_mfma_f32_16x16x32_bf16 v[96:99], v[64:67], a[224:227], v[96:99]
    ds_read_b128 v[80:83], v224 offset:53248
    v_mfma_f32_16x16x32_bf16 v[96:99], v[68:71], a[240:243], v[96:99]
    ds_read_b128 v[84:87], v225 offset:53248
    v_mfma_f32_16x16x32_bf16 v[100:103], v[72:75], a[224:227], v[100:103]
    ds_read_b128 v[88:91], v224 offset:55296
    v_mfma_f32_16x16x32_bf16 v[100:103], v[76:79], a[240:243], v[100:103]
    ds_read_b128 v[92:95], v225 offset:55296
    v_mfma_f32_16x16x32_bf16 v[104:107], v[64:67], a[228:231], v[104:107]
    v_mfma_f32_16x16x32_bf16 v[104:107], v[68:71], a[244:247], v[104:107]
    s_mov_b32 s39, 0
    buffer_store_dwordx4 v[16:19], v238, s[8:11], s39 offen sc1
    v_mfma_f32_16x16x32_bf16 v[108:111], v[72:75], a[228:231], v[108:111]
    v_mfma_f32_16x16x32_bf16 v[108:111], v[76:79], a[244:247], v[108:111]
    v_mfma_f32_16x16x32_bf16 v[112:115], v[64:67], a[232:235], v[112:115]
    v_mfma_f32_16x16x32_bf16 v[112:115], v[68:71], a[248:251], v[112:115]
    v_mfma_f32_16x16x32_bf16 v[116:119], v[72:75], a[232:235], v[116:119]
    v_mfma_f32_16x16x32_bf16 v[116:119], v[76:79], a[248:251], v[116:119]
    v_mfma_f32_16x16x32_bf16 v[120:123], v[64:67], a[236:239], v[120:123]
    v_mfma_f32_16x16x32_bf16 v[120:123], v[68:71], a[252:255], v[120:123]
    s_mov_b32 s39, 8192
    buffer_store_dwordx4 v[20:23], v238, s[8:11], s39 offen sc1
    v_mfma_f32_16x16x32_bf16 v[124:127], v[72:75], a[236:239], v[124:127]
    v_mfma_f32_16x16x32_bf16 v[124:127], v[76:79], a[252:255], v[124:127]
    s_waitcnt lgkmcnt(0)
    v_mfma_f32_16x16x32_bf16 v[128:131], v[80:83], a[224:227], v[128:131]
    ds_read_b128 v[64:67], v224 offset:57344
    v_mfma_f32_16x16x32_bf16 v[128:131], v[84:87], a[240:243], v[128:131]
    ds_read_b128 v[68:71], v225 offset:57344
    v_mfma_f32_16x16x32_bf16 v[132:135], v[88:91], a[224:227], v[132:135]
    ds_read_b128 v[72:75], v224 offset:59392
    v_mfma_f32_16x16x32_bf16 v[132:135], v[92:95], a[240:243], v[132:135]
    ds_read_b128 v[76:79], v225 offset:59392
    v_mfma_f32_16x16x32_bf16 v[136:139], v[80:83], a[228:231], v[136:139]
    v_mfma_f32_16x16x32_bf16 v[136:139], v[84:87], a[244:247], v[136:139]
    s_mov_b32 s39, 16384
    buffer_store_dwordx4 v[24:27], v238, s[8:11], s39 offen sc1
    v_mfma_f32_16x16x32_bf16 v[140:143], v[88:91], a[228:231], v[140:143]
    v_mfma_f32_16x16x32_bf16 v[140:143], v[92:95], a[244:247], v[140:143]
    v_mfma_f32_16x16x32_bf16 v[144:147], v[80:83], a[232:235], v[144:147]
    s_add_u32 m0, s34, 40960
    s_add_u32 s37, s85, 131072
    buffer_load_dwordx4 v232, s[44:47], s37 offen lds
    v_mfma_f32_16x16x32_bf16 v[144:147], v[84:87], a[248:251], v[144:147]
    v_mfma_f32_16x16x32_bf16 v[148:151], v[88:91], a[232:235], v[148:151]
    v_mfma_f32_16x16x32_bf16 v[148:151], v[92:95], a[248:251], v[148:151]
    v_mfma_f32_16x16x32_bf16 v[152:155], v[80:83], a[236:239], v[152:155]
    buffer_load_dwordx4 v233, s[44:47], s37 offen offset:1024 lds
    v_mfma_f32_16x16x32_bf16 v[152:155], v[84:87], a[252:255], v[152:155]
    s_mov_b32 s39, 24576
    buffer_store_dwordx4 v[28:31], v238, s[8:11], s39 offen sc1
    v_mfma_f32_16x16x32_bf16 v[156:159], v[88:91], a[236:239], v[156:159]
    v_mfma_f32_16x16x32_bf16 v[156:159], v[92:95], a[252:255], v[156:159]
    s_waitcnt lgkmcnt(0)
    v_mfma_f32_16x16x32_bf16 v[160:163], v[64:67], a[224:227], v[160:163]
    ds_read_b128 v[80:83], v224 offset:61440
    v_mfma_f32_16x16x32_bf16 v[160:163], v[68:71], a[240:243], v[160:163]
    ds_read_b128 v[84:87], v225 offset:61440
    v_mfma_f32_16x16x32_bf16 v[164:167], v[72:75], a[224:227], v[164:167]
    ds_read_b128 v[88:91], v224 offset:63488
    v_mfma_f32_16x16x32_bf16 v[164:167], v[76:79], a[240:243], v[164:167]
    ds_read_b128 v[92:95], v225 offset:63488
    v_mfma_f32_16x16x32_bf16 v[168:171], v[64:67], a[228:231], v[168:171]
    v_mfma_f32_16x16x32_bf16 v[168:171], v[68:71], a[244:247], v[168:171]
    v_mfma_f32_16x16x32_bf16 v[172:175], v[72:75], a[228:231], v[172:175]
    v_mfma_f32_16x16x32_bf16 v[172:175], v[76:79], a[244:247], v[172:175]
    v_mfma_f32_16x16x32_bf16 v[176:179], v[64:67], a[232:235], v[176:179]
    v_mfma_f32_16x16x32_bf16 v[176:179], v[68:71], a[248:251], v[176:179]
    v_cvt_pk_bf16_f32 v0, v96, v97
    v_cvt_pk_bf16_f32 v1, v98, v99
    v_mfma_f32_16x16x32_bf16 v[180:183], v[72:75], a[232:235], v[180:183]
    v_cvt_pk_bf16_f32 v2, v100, v101
    v_cvt_pk_bf16_f32 v3, v102, v103
    v_mfma_f32_16x16x32_bf16 v[180:183], v[76:79], a[248:251], v[180:183]
    v_cvt_pk_bf16_f32 v4, v104, v105
    v_cvt_pk_bf16_f32 v5, v106, v107
    v_mfma_f32_16x16x32_bf16 v[184:187], v[64:67], a[236:239], v[184:187]
    v_cvt_pk_bf16_f32 v6, v108, v109
    v_cvt_pk_bf16_f32 v7, v110, v111
    v_mfma_f32_16x16x32_bf16 v[184:187], v[68:71], a[252:255], v[184:187]
    v_cvt_pk_bf16_f32 v8, v112, v113
    v_cvt_pk_bf16_f32 v9, v114, v115
    v_mfma_f32_16x16x32_bf16 v[188:191], v[72:75], a[236:239], v[188:191]
    v_cvt_pk_bf16_f32 v10, v116, v117
    v_cvt_pk_bf16_f32 v11, v118, v119
    v_mfma_f32_16x16x32_bf16 v[188:191], v[76:79], a[252:255], v[188:191]
    v_cvt_pk_bf16_f32 v12, v120, v121
    v_cvt_pk_bf16_f32 v13, v122, v123
    s_waitcnt vmcnt(16) lgkmcnt(0)
    s_barrier
    v_mfma_f32_16x16x32_bf16 v[192:195], v[80:83], a[224:227], v[192:195]
    ds_read_b128 v[64:67], v224 offset:0
    v_cvt_pk_bf16_f32 v14, v124, v125
    v_cvt_pk_bf16_f32 v15, v126, v127
    v_mfma_f32_16x16x32_bf16 v[192:195], v[84:87], a[240:243], v[192:195]
    ds_read_b128 v[68:71], v225 offset:0
    v_cvt_pk_bf16_f32 v16, v128, v129
    v_cvt_pk_bf16_f32 v17, v130, v131
    v_mfma_f32_16x16x32_bf16 v[196:199], v[88:91], a[224:227], v[196:199]
    ds_read_b128 v[72:75], v224 offset:8192
    v_cvt_pk_bf16_f32 v18, v132, v133
    v_cvt_pk_bf16_f32 v19, v134, v135
    v_mfma_f32_16x16x32_bf16 v[196:199], v[92:95], a[240:243], v[196:199]
    ds_read_b128 v[76:79], v225 offset:8192
    v_cvt_pk_bf16_f32 v20, v136, v137
    v_cvt_pk_bf16_f32 v21, v138, v139
    v_mfma_f32_16x16x32_bf16 v[200:203], v[80:83], a[228:231], v[200:203]
    v_cvt_pk_bf16_f32 v22, v140, v141
    v_cvt_pk_bf16_f32 v23, v142, v143
    v_mfma_f32_16x16x32_bf16 v[200:203], v[84:87], a[244:247], v[200:203]
    v_cvt_pk_bf16_f32 v24, v144, v145
    v_cvt_pk_bf16_f32 v25, v146, v147
    v_mfma_f32_16x16x32_bf16 v[204:207], v[88:91], a[228:231], v[204:207]
    v_cvt_pk_bf16_f32 v26, v148, v149
    v_cvt_pk_bf16_f32 v27, v150, v151
    v_mfma_f32_16x16x32_bf16 v[204:207], v[92:95], a[244:247], v[204:207]
    v_cvt_pk_bf16_f32 v28, v152, v153
    v_cvt_pk_bf16_f32 v29, v154, v155
    v_mfma_f32_16x16x32_bf16 v[208:211], v[80:83], a[232:235], v[208:211]
    s_add_u32 m0, s34, 49152
    s_add_u32 s37, s86, 131072
    buffer_load_dwordx4 v232, s[44:47], s37 offen lds
    v_cvt_pk_bf16_f32 v30, v156, v157
    v_cvt_pk_bf16_f32 v31, v158, v159
    v_mfma_f32_16x16x32_bf16 v[208:211], v[84:87], a[248:251], v[208:211]
    v_cvt_pk_bf16_f32 v32, v160, v161
    v_cvt_pk_bf16_f32 v33, v162, v163
    v_mfma_f32_16x16x32_bf16 v[212:215], v[88:91], a[232:235], v[212:215]
    v_cvt_pk_bf16_f32 v34, v164, v165
    v_cvt_pk_bf16_f32 v35, v166, v167
    v_mfma_f32_16x16x32_bf16 v[212:215], v[92:95], a[248:251], v[212:215]
    v_cvt_pk_bf16_f32 v36, v168, v169
    v_cvt_pk_bf16_f32 v37, v170, v171
    v_mfma_f32_16x16x32_bf16 v[216:219], v[80:83], a[236:239], v[216:219]
    buffer_load_dwordx4 v233, s[44:47], s37 offen offset:1024 lds
    v_cvt_pk_bf16_f32 v38, v172, v173
    v_cvt_pk_bf16_f32 v39, v174, v175
    v_mfma_f32_16x16x32_bf16 v[216:219], v[84:87], a[252:255], v[216:219]
    v_cvt_pk_bf16_f32 v40, v176, v177
    v_cvt_pk_bf16_f32 v41, v178, v179
    v_mfma_f32_16x16x32_bf16 v[220:223], v[88:91], a[236:239], v[220:223]
    v_cvt_pk_bf16_f32 v42, v180, v181
    v_cvt_pk_bf16_f32 v43, v182, v183
    v_mfma_f32_16x16x32_bf16 v[220:223], v[92:95], a[252:255], v[220:223]
    v_cvt_pk_bf16_f32 v44, v184, v185
    v_cvt_pk_bf16_f32 v45, v186, v187
    s_waitcnt lgkmcnt(0)
    v_mfma_f32_16x16x32_bf16 v[96:99], v[64:67], a[0:3], 0
    ds_read_b128 v[80:83], v224 offset:2048
    v_cvt_pk_bf16_f32 v46, v188, v189
    v_cvt_pk_bf16_f32 v47, v190, v191
    v_mfma_f32_16x16x32_bf16 v[96:99], v[68:71], a[16:19], v[96:99]
    ds_read_b128 v[84:87], v225 offset:2048
    v_cvt_pk_bf16_f32 v48, v192, v193
    v_cvt_pk_bf16_f32 v49, v194, v195
    v_mfma_f32_16x16x32_bf16 v[96:99], v[72:75], a[32:35], v[96:99]
    ds_read_b128 v[88:91], v224 offset:10240
    v_cvt_pk_bf16_f32 v50, v196, v197
    v_cvt_pk_bf16_f32 v51, v198, v199
    v_mfma_f32_16x16x32_bf16 v[96:99], v[76:79], a[48:51], v[96:99]
    ds_read_b128 v[92:95], v225 offset:10240
    v_cvt_pk_bf16_f32 v52, v200, v201
    v_cvt_pk_bf16_f32 v53, v202, v203
    v_mfma_f32_16x16x32_bf16 v[104:107], v[64:67], a[4:7], 0
    v_cvt_pk_bf16_f32 v54, v204, v205
    v_cvt_pk_bf16_f32 v55, v206, v207
    s_add_u32 s38, s36, 0
    buffer_store_dwordx4 v[0:3], v240, s[16:19], s38 offen offset:0 sc1
    v_mfma_f32_16x16x32_bf16 v[104:107], v[68:71], a[20:23], v[104:107]
    v_cvt_pk_bf16_f32 v56, v208, v209
    v_cvt_pk_bf16_f32 v57, v210, v211
    v_mfma_f32_16x16x32_bf16 v[104:107], v[72:75], a[36:39], v[104:107]
    v_cvt_pk_bf16_f32 v58, v212, v213
    v_cvt_pk_bf16_f32 v59, v214, v215
    v_mfma_f32_16x16x32_bf16 v[104:107], v[76:79], a[52:55], v[104:107]
    v_cvt_pk_bf16_f32 v60, v216, v217
    v_cvt_pk_bf16_f32 v61, v218, v219
    v_mfma_f32_16x16x32_bf16 v[112:115], v[64:67], a[8:11], 0
    v_xor_b32 v237, 16, v245
    v_xor_b32 v238, 16, v246
    v_cvt_pk_bf16_f32 v62, v220, v221
    v_cvt_pk_bf16_f32 v63, v222, v223
    v_mfma_f32_16x16x32_bf16 v[112:115], v[68:71], a[24:27], v[112:115]
    v_mfma_f32_16x16x32_bf16 v[112:115], v[72:75], a[40:43], v[112:115]
    v_mfma_f32_16x16x32_bf16 v[112:115], v[76:79], a[56:59], v[112:115]
    v_mfma_f32_16x16x32_bf16 v[120:123], v[64:67], a[12:15], 0
    v_mfma_f32_16x16x32_bf16 v[120:123], v[68:71], a[28:31], v[120:123]
    v_mfma_f32_16x16x32_bf16 v[120:123], v[72:75], a[44:47], v[120:123]
    v_mfma_f32_16x16x32_bf16 v[120:123], v[76:79], a[60:63], v[120:123]
    s_waitcnt lgkmcnt(0)
    v_mfma_f32_16x16x32_bf16 v[100:103], v[80:83], a[0:3], 0
    ds_read_b128 v[64:67], v224 offset:4096
    v_mfma_f32_16x16x32_bf16 v[100:103], v[84:87], a[16:19], v[100:103]
    ds_read_b128 v[68:71], v225 offset:4096
    v_mfma_f32_16x16x32_bf16 v[100:103], v[88:91], a[32:35], v[100:103]
    ds_read_b128 v[72:75], v224 offset:12288
    v_mfma_f32_16x16x32_bf16 v[100:103], v[92:95], a[48:51], v[100:103]
    ds_read_b128 v[76:79], v225 offset:12288
    v_mfma_f32_16x16x32_bf16 v[108:111], v[80:83], a[4:7], 0
    v_mfma_f32_16x16x32_bf16 v[108:111], v[84:87], a[20:23], v[108:111]
    v_mfma_f32_16x16x32_bf16 v[108:111], v[88:91], a[36:39], v[108:111]
    v_mfma_f32_16x16x32_bf16 v[108:111], v[92:95], a[52:55], v[108:111]
    v_mfma_f32_16x16x32_bf16 v[116:119], v[80:83], a[8:11], 0
    s_add_u32 m0, s34, 57344
    s_add_u32 s37, s87, 131072
    buffer_load_dwordx4 v232, s[44:47], s37 offen lds
    v_mfma_f32_16x16x32_bf16 v[116:119], v[84:87], a[24:27], v[116:119]
    s_add_u32 s38, s36, 0
    buffer_store_dwordx4 v[4:7], v240, s[16:19], s38 offen offset:1024 sc1
    v_mfma_f32_16x16x32_bf16 v[116:119], v[88:91], a[40:43], v[116:119]
    v_mfma_f32_16x16x32_bf16 v[116:119], v[92:95], a[56:59], v[116:119]
    v_mfma_f32_16x16x32_bf16 v[124:127], v[80:83], a[12:15], 0
    buffer_load_dwordx4 v233, s[44:47], s37 offen offset:1024 lds
    v_mfma_f32_16x16x32_bf16 v[124:127], v[84:87], a[28:31], v[124:127]
    v_mfma_f32_16x16x32_bf16 v[124:127], v[88:91], a[44:47], v[124:127]
    v_mfma_f32_16x16x32_bf16 v[124:127], v[92:95], a[60:63], v[124:127]
    s_waitcnt lgkmcnt(0)
    v_mfma_f32_16x16x32_bf16 v[128:131], v[64:67], a[0:3], 0
    ds_read_b128 v[80:83], v224 offset:6144
    v_mfma_f32_16x16x32_bf16 v[128:131], v[68:71], a[16:19], v[128:131]
    ds_read_b128 v[84:87], v225 offset:6144
    v_mfma_f32_16x16x32_bf16 v[128:131], v[72:75], a[32:35], v[128:131]
    ds_read_b128 v[88:91], v224 offset:14336
    v_mfma_f32_16x16x32_bf16 v[128:131], v[76:79], a[48:51], v[128:131]
    ds_read_b128 v[92:95], v225 offset:14336
    v_mfma_f32_16x16x32_bf16 v[136:139], v[64:67], a[4:7], 0
    v_mfma_f32_16x16x32_bf16 v[136:139], v[68:71], a[20:23], v[136:139]
    v_mfma_f32_16x16x32_bf16 v[136:139], v[72:75], a[36:39], v[136:139]
    v_mfma_f32_16x16x32_bf16 v[136:139], v[76:79], a[52:55], v[136:139]
    v_mfma_f32_16x16x32_bf16 v[144:147], v[64:67], a[8:11], 0
    s_waitcnt vmcnt(15)
    v_readfirstlane_b32 s24, v254
    s_lshl_b32 s25, s3, 16
    s_add_u32 s24, s24, s25
    s_cmp_ge_u32 s24, 1
    s_cbranch_scc0 kf_spin35
kf_spinr36:
    v_mfma_f32_16x16x32_bf16 v[144:147], v[68:71], a[24:27], v[144:147]
    v_mfma_f32_16x16x32_bf16 v[144:147], v[72:75], a[40:43], v[144:147]
    v_mfma_f32_16x16x32_bf16 v[144:147], v[76:79], a[56:59], v[144:147]
    v_mfma_f32_16x16x32_bf16 v[152:155], v[64:67], a[12:15], 0
    s_add_u32 s88, s20, 0x14a0000
    s_addc_u32 s89, s21, 0
    s_mov_b32 s90, 20480
    v_mfma_f32_16x16x32_bf16 v[152:155], v[68:71], a[28:31], v[152:155]
    v_mfma_f32_16x16x32_bf16 v[152:155], v[72:75], a[44:47], v[152:155]
    v_mfma_f32_16x16x32_bf16 v[152:155], v[76:79], a[60:63], v[152:155]
    s_add_u32 s38, s36, 0
    buffer_store_dwordx4 v[8:11], v240, s[16:19], s38 offen offset:2048 sc1
    s_waitcnt vmcnt(7) lgkmcnt(0)
    s_barrier
    v_mfma_f32_16x16x32_bf16 v[132:135], v[80:83], a[0:3], 0
    ds_read_b128 v[64:67], v224 offset:16384
    v_mfma_f32_16x16x32_bf16 v[132:135], v[84:87], a[16:19], v[132:135]
    ds_read_b128 v[68:71], v225 offset:16384
    v_mfma_f32_16x16x32_bf16 v[132:135], v[88:91], a[32:35], v[132:135]
    ds_read_b128 v[72:75], v224 offset:24576
    v_mfma_f32_16x16x32_bf16 v[132:135], v[92:95], a[48:51], v[132:135]
    ds_read_b128 v[76:79], v225 offset:24576
    v_mfma_f32_16x16x32_bf16 v[140:143], v[80:83], a[4:7], 0
    v_mfma_f32_16x16x32_bf16 v[140:143], v[84:87], a[20:23], v[140:143]
    v_mfma_f32_16x16x32_bf16 v[140:143], v[88:91], a[36:39], v[140:143]
    v_mfma_f32_16x16x32_bf16 v[140:143], v[92:95], a[52:55], v[140:143]
    v_mfma_f32_16x16x32_bf16 v[148:151], v[80:83], a[8:11], 0
    s_add_u32 m0, s34, 0
    s_add_u32 s37, s80, 196608
    buffer_load_dwordx4 v232, s[44:47], s37 offen lds
    v_mfma_f32_16x16x32_bf16 v[148:151], v[84:87], a[24:27], v[148:151]
    v_mfma_f32_16x16x32_bf16 v[148:151], v[88:91], a[40:43], v[148:151]
    buffer_load_dwordx4 v233, s[44:47], s37 offen offset:1024 lds
    v_mfma_f32_16x16x32_bf16 v[148:151], v[92:95], a[56:59], v[148:151]
    v_mfma_f32_16x16x32_bf16 v[156:159], v[80:83], a[12:15], 0
    v_mfma_f32_16x16x32_bf16 v[156:159], v[84:87], a[28:31], v[156:159]
    s_lshl_b32 s39, s5, 7
    s_add_u32 s39, s39, 8192
    buffer_atomic_add v255, v250, s[88:91], s39 offen sc1
    s_cmp_eq_u32 s3, 0
    s_cselect_b32 s39, s39, s43
    v_mfma_f32_16x16x32_bf16 v[156:159], v[88:91], a[44:47], v[156:159]
    v_mfma_f32_16x16x32_bf16 v[156:159], v[92:95], a[60:63], v[156:159]
    s_waitcnt lgkmcnt(0)
    v_mfma_f32_16x16x32_bf16 v[96:99], v[64:67], a[64:67], v[96:99]
    ds_read_b128 v[80:83], v224 offset:18432
    v_mfma_f32_16x16x32_bf16 v[96:99], v[68:71], a[80:83], v[96:99]
    ds_read_b128 v[84:87], v225 offset:18432
    v_mfma_f32_16x16x32_bf16 v[96:99], v[72:75], a[96:99], v[96:99]
    ds_read_b128 v[88:91], v224 offset:26624
    v_mfma_f32_16x16x32_bf16 v[96:99], v[76:79], a[112:115], v[96:99]
    ds_read_b128 v[92:95], v225 offset:26624
    v_mfma_f32_16x16x32_bf16 v[104:107], v[64:67], a[68:71], v[104:107]
    s_add_u32 s38, s36, 0
    buffer_store_dwordx4 v[12:15], v240, s[16:19], s38 offen offset:3072 sc1
    v_mfma_f32_16x16x32_bf16 v[104:107], v[68:71], a[84:87], v[104:107]
    v_mfma_f32_16x16x32_bf16 v[104:107], v[72:75], a[100:103], v[104:107]
    v_mfma_f32_16x16x32_bf16 v[104:107], v[76:79], a[116:119], v[104:107]
    v_mfma_f32_16x16x32_bf16 v[112:115], v[64:67], a[72:75], v[112:115]
    s_add_u32 m0, s31, 0
    s_add_u32 s24, s27, 0
    buffer_load_dwordx4 v245, s[12:15], s24 offen lds
    v_mfma_f32_16x16x32_bf16 v[112:115], v[68:71], a[88:91], v[112:115]
    v_mfma_f32_16x16x32_bf16 v[112:115], v[72:75], a[104:107], v[112:115]
    v_mfma_f32_16x16x32_bf16 v[112:115], v[76:79], a[120:123], v[112:115]
    v_mfma_f32_16x16x32_bf16 v[120:123], v[64:67], a[76:79], v[120:123]
    v_mfma_f32_16x16x32_bf16 v[120:123], v[68:71], a[92:95], v[120:123]
    v_mfma_f32_16x16x32_bf16 v[120:123], v[72:75], a[108:111], v[120:123]
    v_mfma_f32_16x16x32_bf16 v[120:123], v[76:79], a[124:127], v[120:123]
    s_waitcnt lgkmcnt(0)
    v_mfma_f32_16x16x32_bf16 v[100:103], v[80:83], a[64:67], v[100:103]
    ds_read_b128 v[64:67], v224 offset:20480
    v_mfma_f32_16x16x32_bf16 v[100:103], v[84:87], a[80:83], v[100:103]
    ds_read_b128 v[68:71], v225 offset:20480
    v_mfma_f32_16x16x32_bf16 v[100:103], v[88:91], a[96:99], v[100:103]
    ds_read_b128 v[72:75], v224 offset:28672
    v_mfma_f32_16x16x32_bf16 v[100:103], v[92:95], a[112:115], v[100:103]
    ds_read_b128 v[76:79], v225 offset:28672
    v_mfma_f32_16x16x32_bf16 v[108:111], v[80:83], a[68:71], v[108:111]
    v_mfma_f32_16x16x32_bf16 v[108:111], v[84:87], a[84:87], v[108:111]
    v_mfma_f32_16x16x32_bf16 v[108:111], v[88:91], a[100:103], v[108:111]
    v_mfma_f32_16x16x32_bf16 v[108:111], v[92:95], a[116:119], v[108:111]
    v_mfma_f32_16x16x32_bf16 v[116:119], v[80:83], a[72:75], v[116:119]
    s_add_u32 m0, s34, 8192
    s_add_u32 s37, s81, 196608
    buffer_load_dwordx4 v232, s[44:47], s37 offen lds
    v_mfma_f32_16x16x32_bf16 v[116:119], v[84:87], a[88:91], v[116:119]
    v_mfma_f32_16x16x32_bf16 v[116:119], v[88:91], a[104:107], v[116:119]
    buffer_load_dwordx4 v233, s[44:47], s37 offen offset:1024 lds
    s_add_u32 s38, s36, 8192
    buffer_store_dwordx4 v[16:19], v240, s[16:19], s38 offen offset:0 sc1
    v_mfma_f32_16x16x32_bf16 v[116:119], v[92:95], a[120:123], v[116:119]
    v_mfma_f32_16x16x32_bf16 v[124:127], v[80:83], a[76:79], v[124:127]
    v_mfma_f32_16x16x32_bf16 v[124:127], v[84:87], a[92:95], v[124:127]
    s_add_u32 m0, s31, 1024
    s_add_u32 s24, s27, 32768
    buffer_load_dwordx4 v245, s[12:15], s24 offen lds
    v_mfma_f32_16x16x32_bf16 v[124:127], v[88:91], a[108:111], v[124:127]
    v_mfma_f32_16x16x32_bf16 v[124:127], v[92:95], a[124:127], v[124:127]
    s_waitcnt lgkmcnt(0)
    v_mfma_f32_16x16x32_bf16 v[128:131], v[64:67], a[64:67], v[128:131]
    ds_read_b128 v[80:83], v224 offset:22528
    v_mfma_f32_16x16x32_bf16 v[128:131], v[68:71], a[80:83], v[128:131]
    ds_read_b128 v[84:87], v225 offset:22528
    v_mfma_f32_16x16x32_bf16 v[128:131], v[72:75], a[96:99], v[128:131]
    ds_read_b128 v[88:91], v224 offset:30720
    v_mfma_f32_16x16x32_bf16 v[128:131], v[76:79], a[112:115], v[128:131]
    ds_read_b128 v[92:95], v225 offset:30720
    v_mfma_f32_16x16x32_bf16 v[136:139], v[64:67], a[68:71], v[136:139]
    v_mfma_f32_16x16x32_bf16 v[136:139], v[68:71], a[84:87], v[136:139]
    v_mfma_f32_16x16x32_bf16 v[136:139], v[72:75], a[100:103], v[136:139]
    v_mfma_f32_16x16x32_bf16 v[136:139], v[76:79], a[116:119], v[136:139]
    v_mfma_f32_16x16x32_bf16 v[144:147], v[64:67], a[72:75], v[144:147]
    s_add_u32 m0, s31, 2048
    s_add_u32 s24, s27, 65536
    buffer_load_dwordx4 v237, s[12:15], s24 offen lds
    v_mfma_f32_16x16x32_bf16 v[144:147], v[68:71], a[88:91], v[144:147]
    v_mfma_f32_16x16x32_bf16 v[144:147], v[72:75], a[104:107], v[144:147]
    v_mfma_f32_16x16x32_bf16 v[144:147], v[76:79], a[120:123], v[144:147]
    v_mfma_f32_16x16x32_bf16 v[152:155], v[64:67], a[76:79], v[152:155]
    v_mfma_f32_16x16x32_bf16 v[152:155], v[68:71], a[92:95], v[152:155]
    v_mfma_f32_16x16x32_bf16 v[152:155], v[72:75], a[108:111], v[152:155]
    v_mfma_f32_16x16x32_bf16 v[152:155], v[76:79], a[124:127], v[152:155]
    s_add_u32 s38, s36, 8192
    buffer_store_dwordx4 v[20:23], v240, s[16:19], s38 offen offset:1024 sc1
    s_waitcnt vmcnt(19) lgkmcnt(0)
    s_barrier
    v_mfma_f32_16x16x32_bf16 v[132:135], v[80:83], a[64:67], v[132:135]
    ds_read_b128 v[64:67], v224 offset:32768
    v_mfma_f32_16x16x32_bf16 v[132:135], v[84:87], a[80:83], v[132:135]
    ds_read_b128 v[68:71], v225 offset:32768
    v_mfma_f32_16x16x32_bf16 v[132:135], v[88:91], a[96:99], v[132:135]
    ds_read_b128 v[72:75], v224 offset:40960
    v_mfma_f32_16x16x32_bf16 v[132:135], v[92:95], a[112:115], v[132:135]
    ds_read_b128 v[76:79], v225 offset:40960
    v_mfma_f32_16x16x32_bf16 v[140:143], v[80:83], a[68:71], v[140:143]
    v_mfma_f32_16x16x32_bf16 v[140:143], v[84:87], a[84:87], v[140:143]
    v_mfma_f32_16x16x32_bf16 v[140:143], v[88:91], a[100:103], v[140:143]
    v_mfma_f32_16x16x32_bf16 v[140:143], v[92:95], a[116:119], v[140:143]
    v_mfma_f32_16x16x32_bf16 v[148:151], v[80:83], a[72:75], v[148:151]
    s_add_u32 m0, s34, 16384
    s_add_u32 s37, s82, 196608
    buffer_load_dwordx4 v232, s[44:47], s37 offen lds
    v_mfma_f32_16x16x32_bf16 v[148:151], v[84:87], a[88:91], v[148:151]
    v_mfma_f32_16x16x32_bf16 v[148:151], v[88:91], a[104:107], v[148:151]
    buffer_load_dwordx4 v233, s[44:47], s37 offen offset:1024 lds
    v_mfma_f32_16x16x32_bf16 v[148:151], v[92:95], a[120:123], v[148:151]
    v_mfma_f32_16x16x32_bf16 v[156:159], v[80:83], a[76:79], v[156:159]
    v_mfma_f32_16x16x32_bf16 v[156:159], v[84:87], a[92:95], v[156:159]
    s_add_u32 m0, s31, 3072
    s_add_u32 s24, s27, 98304
    buffer_load_dwordx4 v237, s[12:15], s24 offen lds
    v_mfma_f32_16x16x32_bf16 v[156:159], v[88:91], a[108:111], v[156:159]
    v_mfma_f32_16x16x32_bf16 v[156:159], v[92:95], a[124:127], v[156:159]
    s_waitcnt lgkmcnt(0)
    v_mfma_f32_16x16x32_bf16 v[96:99], v[64:67], a[128:131], v[96:99]
    ds_read_b128 v[80:83], v224 offset:34816
    v_mfma_f32_16x16x32_bf16 v[96:99], v[68:71], a[144:147], v[96:99]
    ds_read_b128 v[84:87], v225 offset:34816
    v_mfma_f32_16x16x32_bf16 v[96:99], v[72:75], a[160:163], v[96:99]
    ds_read_b128 v[88:91], v224 offset:43008
    v_mfma_f32_16x16x32_bf16 v[96:99], v[76:79], a[176:179], v[96:99]
    ds_read_b128 v[92:95], v225 offset:43008
    v_mfma_f32_16x16x32_bf16 v[104:107], v[64:67], a[132:135], v[104:107]
    v_mfma_f32_16x16x32_bf16 v[104:107], v[68:71], a[148:151], v[104:107]
    s_add_u32 s38, s36, 8192
    buffer_store_dwordx4 v[24:27], v240, s[16:19], s38 offen offset:2048 sc1
    v_mfma_f32_16x16x32_bf16 v[104:107], v[72:75], a[164:167], v[104:107]
    v_mfma_f32_16x16x32_bf16 v[104:107], v[76:79], a[180:183], v[104:107]
    v_mfma_f32_16x16x32_bf16 v[112:115], v[64:67], a[136:139], v[112:115]
    s_add_u32 m0, s31, 4096
    s_add_u32 s24, s27, 131072
    buffer_load_dwordx4 v245, s[12:15], s24 offen lds
    v_mfma_f32_16x16x32_bf16 v[112:115], v[68:71], a[152:155], v[112:115]
    v_mfma_f32_16x16x32_bf16 v[112:115], v[72:75], a[168:171], v[112:115]
    v_mfma_f32_16x16x32_bf16 v[112:115], v[76:79], a[184:187], v[112:115]
    v_mfma_f32_16x16x32_bf16 v[120:123], v[64:67], a[140:143], v[120:123]
    v_mfma_f32_16x16x32_bf16 v[120:123], v[68:71], a[156:159], v[120:123]
    v_mfma_f32_16x16x32_bf16 v[120:123], v[72:75], a[172:175], v[120:123]
    v_mfma_f32_16x16x32_bf16 v[120:123], v[76:79], a[188:191], v[120:123]
    s_waitcnt lgkmcnt(0)
    v_mfma_f32_16x16x32_bf16 v[100:103], v[80:83], a[128:131], v[100:103]
    ds_read_b128 v[64:67], v224 offset:36864
    v_mfma_f32_16x16x32_bf16 v[100:103], v[84:87], a[144:147], v[100:103]
    ds_read_b128 v[68:71], v225 offset:36864
    v_mfma_f32_16x16x32_bf16 v[100:103], v[88:91], a[160:163], v[100:103]
    ds_read_b128 v[72:75], v224 offset:45056
    v_mfma_f32_16x16x32_bf16 v[100:103], v[92:95], a[176:179], v[100:103]
    ds_read_b128 v[76:79], v225 offset:45056
    v_mfma_f32_16x16x32_bf16 v[108:111], v[80:83], a[132:135], v[108:111]
    v_mfma_f32_16x16x32_bf16 v[108:111], v[84:87], a[148:151], v[108:111]
    v_mfma_f32_16x16x32_bf16 v[108:111], v[88:91], a[164:167], v[108:111]
    v_mfma_f32_16x16x32_bf16 v[108:111], v[92:95], a[180:183], v[108:111]
    v_mfma_f32_16x16x32_bf16 v[116:119], v[80:83], a[136:139], v[116:119]
    s_add_u32 m0, s34, 24576
    s_add_u32 s37, s83, 196608
    buffer_load_dwordx4 v232, s[44:47], s37 offen lds
    v_mfma_f32_16x16x32_bf16 v[116:119], v[84:87], a[152:155], v[116:119]
    v_mfma_f32_16x16x32_bf16 v[116:119], v[88:91], a[168:171], v[116:119]
    buffer_load_dwordx4 v233, s[44:47], s37 offen offset:1024 lds
    s_add_u32 s38, s36, 8192
    buffer_store_dwordx4 v[28:31], v240, s[16:19], s38 offen offset:3072 sc1
    v_mfma_f32_16x16x32_bf16 v[116:119], v[92:95], a[184:187], v[116:119]
    v_mfma_f32_16x16x32_bf16 v[124:127], v[80:83], a[140:143], v[124:127]
    v_mfma_f32_16x16x32_bf16 v[124:127], v[84:87], a[156:159], v[124:127]
    s_add_u32 m0, s31, 5120
    s_add_u32 s24, s27, 163840
    buffer_load_dwordx4 v245, s[12:15], s24 offen lds
    v_mfma_f32_16x16x32_bf16 v[124:127], v[88:91], a[172:175], v[124:127]
    v_mfma_f32_16x16x32_bf16 v[124:127], v[92:95], a[188:191], v[124:127]
    s_waitcnt lgkmcnt(0)
    v_mfma_f32_16x16x32_bf16 v[128:131], v[64:67], a[128:131], v[128:131]
    ds_read_b128 v[80:83], v224 offset:38912
    v_mfma_f32_16x16x32_bf16 v[128:131], v[68:71], a[144:147], v[128:131]
    ds_read_b128 v[84:87], v225 offset:38912
    v_mfma_f32_16x16x32_bf16 v[128:131], v[72:75], a[160:163], v[128:131]
    ds_read_b128 v[88:91], v224 offset:47104
    v_mfma_f32_16x16x32_bf16 v[128:131], v[76:79], a[176:179], v[128:131]
    ds_read_b128 v[92:95], v225 offset:47104
    v_mfma_f32_16x16x32_bf16 v[136:139], v[64:67], a[132:135], v[136:139]
    v_mfma_f32_16x16x32_bf16 v[136:139], v[68:71], a[148:151], v[136:139]
    v_mfma_f32_16x16x32_bf16 v[136:139], v[72:75], a[164:167], v[136:139]
    v_mfma_f32_16x16x32_bf16 v[136:139], v[76:79], a[180:183], v[136:139]
    v_mfma_f32_16x16x32_bf16 v[144:147], v[64:67], a[136:139], v[144:147]
    s_add_u32 m0, s31, 6144
    s_add_u32 s24, s27, 196608
    buffer_load_dwordx4 v237, s[12:15], s24 offen lds
    v_mfma_f32_16x16x32_bf16 v[144:147], v[68:71], a[152:155], v[144:147]
    v_mfma_f32_16x16x32_bf16 v[144:147], v[72:75], a[168:171], v[144:147]
    v_mfma_f32_16x16x32_bf16 v[144:147], v[76:79], a[184:187], v[144:147]
    v_mfma_f32_16x16x32_bf16 v[152:155], v[64:67], a[140:143], v[152:155]
    v_mfma_f32_16x16x32_bf16 v[152:155], v[68:71], a[156:159], v[152:155]
    v_mfma_f32_16x16x32_bf16 v[152:155], v[72:75], a[172:175], v[152:155]
    v_mfma_f32_16x16x32_bf16 v[152:155], v[76:79], a[188:191], v[152:155]
    s_waitcnt vmcnt(22) lgkmcnt(0)
    s_barrier
    v_mfma_f32_16x16x32_bf16 v[132:135], v[80:83], a[128:131], v[132:135]
    ds_read_b128 v[64:67], v224 offset:49152
    s_add_u32 s38, s36, 32768
    buffer_store_dwordx4 v[32:35], v240, s[16:19], s38 offen offset:1280 sc1
    v_mfma_f32_16x16x32_bf16 v[132:135], v[84:87], a[144:147], v[132:135]
    ds_read_b128 v[68:71], v225 offset:49152
    v_mfma_f32_16x16x32_bf16 v[132:135], v[88:91], a[160:163], v[132:135]
    ds_read_b128 v[72:75], v224 offset:57344
    v_mfma_f32_16x16x32_bf16 v[132:135], v[92:95], a[176:179], v[132:135]
    ds_read_b128 v[76:79], v225 offset:57344
    v_mfma_f32_16x16x32_bf16 v[140:143], v[80:83], a[132:135], v[140:143]
    v_mfma_f32_16x16x32_bf16 v[140:143], v[84:87], a[148:151], v[140:143]
    v_mfma_f32_16x16x32_bf16 v[140:143], v[88:91], a[164:167], v[140:143]
    v_mfma_f32_16x16x32_bf16 v[140:143], v[92:95], a[180:183], v[140:143]
    v_mfma_f32_16x16x32_bf16 v[148:151], v[80:83], a[136:139], v[148:151]
    s_add_u32 m0, s34, 32768
    s_add_u32 s37, s84, 196608
    buffer_load_dwordx4 v232, s[44:47], s37 offen lds
    v_mfma_f32_16x16x32_bf16 v[148:151], v[84:87], a[152:155], v[148:151]
    buffer_load_dwordx4 v233, s[44:47], s37 offen offset:1024 lds
    v_mfma_f32_16x16x32_bf16 v[148:151], v[88:91], a[168:171], v[148:151]
    v_mfma_f32_16x16x32_bf16 v[148:151], v[92:95], a[184:187], v[148:151]
    s_add_u32 m0, s31, 7168
    s_add_u32 s24, s27, 229376
    buffer_load_dwordx4 v237, s[12:15], s24 offen lds
    v_mfma_f32_16x16x32_bf16 v[156:159], v[80:83], a[140:143], v[156:159]
    s_add_u32 s27, s27, 1048576
    s_and_b32 s27, s27, 0x407fffff
    s_cmp_eq_u32 s27, s7
    s_cselect_b32 s27, s43, s27
    v_mfma_f32_16x16x32_bf16 v[156:159], v[84:87], a[156:159], v[156:159]
    v_mfma_f32_16x16x32_bf16 v[156:159], v[88:91], a[172:175], v[156:159]
    s_add_u32 s31, s31, 32768
    s_cmp_ge_u32 s31, 163840
    s_cselect_b32 s24, 98304, 0
    s_sub_u32 s31, s31, s24
    v_mfma_f32_16x16x32_bf16 v[156:159], v[92:95], a[188:191], v[156:159]
    s_waitcnt lgkmcnt(0)
    v_mfma_f32_16x16x32_bf16 v[96:99], v[64:67], a[192:195], v[96:99]
    ds_read_b128 v[80:83], v224 offset:51200
    v_mfma_f32_16x16x32_bf16 v[96:99], v[68:71], a[208:211], v[96:99]
    ds_read_b128 v[84:87], v225 offset:51200
    v_mfma_f32_16x16x32_bf16 v[96:99], v[72:75], a[224:227], v[96:99]
    ds_read_b128 v[88:91], v224 offset:59392
    v_mfma_f32_16x16x32_bf16 v[96:99], v[76:79], a[240:243], v[96:99]
    ds_read_b128 v[92:95], v225 offset:59392
    v_mfma_f32_16x16x32_bf16 v[104:107], v[64:67], a[196:199], v[104:107]
    v_mfma_f32_16x16x32_bf16 v[104:107], v[68:71], a[212:215], v[104:107]
    v_mfma_f32_16x16x32_bf16 v[104:107], v[72:75], a[228:231], v[104:107]
    s_add_u32 s38, s36, 32768
    buffer_store_dwordx4 v[36:39], v240, s[16:19], s38 offen offset:2304 sc1
    v_mfma_f32_16x16x32_bf16 v[104:107], v[76:79], a[244:247], v[104:107]
    v_mfma_f32_16x16x32_bf16 v[112:115], v[64:67], a[200:203], v[112:115]
    v_mfma_f32_16x16x32_bf16 v[112:115], v[68:71], a[216:219], v[112:115]
    v_mfma_f32_16x16x32_bf16 v[112:115], v[72:75], a[232:235], v[112:115]
    v_mfma_f32_16x16x32_bf16 v[112:115], v[76:79], a[248:251], v[112:115]
    v_mfma_f32_16x16x32_bf16 v[120:123], v[64:67], a[204:207], v[120:123]
    v_mfma_f32_16x16x32_bf16 v[120:123], v[68:71], a[220:223], v[120:123]
    v_mfma_f32_16x16x32_bf16 v[120:123], v[72:75], a[236:239], v[120:123]
    v_mfma_f32_16x16x32_bf16 v[120:123], v[76:79], a[252:255], v[120:123]
    s_waitcnt lgkmcnt(0)
    v_mfma_f32_16x16x32_bf16 v[100:103], v[80:83], a[192:195], v[100:103]
    ds_read_b128 v[64:67], v224 offset:53248
    v_mfma_f32_16x16x32_bf16 v[100:103], v[84:87], a[208:211], v[100:103]
    ds_read_b128 v[68:71], v225 offset:53248
    v_mfma_f32_16x16x32_bf16 v[100:103], v[88:91], a[224:227], v[100:103]
    ds_read_b128 v[72:75], v224 offset:61440
    v_mfma_f32_16x16x32_bf16 v[100:103], v[92:95], a[240:243], v[100:103]
    ds_read_b128 v[76:79], v225 offset:61440
    v_mfma_f32_16x16x32_bf16 v[108:111], v[80:83], a[196:199], v[108:111]
    v_mfma_f32_16x16x32_bf16 v[108:111], v[84:87], a[212:215], v[108:111]
    v_mfma_f32_16x16x32_bf16 v[108:111], v[88:91], a[228:231], v[108:111]
    v_mfma_f32_16x16x32_bf16 v[108:111], v[92:95], a[244:247], v[108:111]
    v_mfma_f32_16x16x32_bf16 v[116:119], v[80:83], a[200:203], v[116:119]
    s_add_u32 m0, s34, 40960
    s_add_u32 s37, s85, 196608
    buffer_load_dwordx4 v232, s[44:47], s37 offen lds
    v_mfma_f32_16x16x32_bf16 v[116:119], v[84:87], a[216:219], v[116:119]
    v_mfma_f32_16x16x32_bf16 v[116:119], v[88:91], a[232:235], v[116:119]
    v_mfma_f32_16x16x32_bf16 v[116:119], v[92:95], a[248:251], v[116:119]
    s_add_u32 s38, s36, 32768
    buffer_store_dwordx4 v[40:43], v240, s[16:19], s38 offen offset:3328 sc1
    v_mfma_f32_16x16x32_bf16 v[124:127], v[80:83], a[204:207], v[124:127]
    buffer_load_dwordx4 v233, s[44:47], s37 offen offset:1024 lds
    v_mfma_f32_16x16x32_bf16 v[124:127], v[84:87], a[220:223], v[124:127]
    v_mfma_f32_16x16x32_bf16 v[124:127], v[88:91], a[236:239], v[124:127]
    v_mfma_f32_16x16x32_bf16 v[124:127], v[92:95], a[252:255], v[124:127]
    s_waitcnt lgkmcnt(0)
    v_mfma_f32_16x16x32_bf16 v[128:131], v[64:67], a[192:195], v[128:131]
    ds_read_b128 v[80:83], v224 offset:55296
    v_mfma_f32_16x16x32_bf16 v[128:131], v[68:71], a[208:211], v[128:131]
    ds_read_b128 v[84:87], v225 offset:55296
    v_mfma_f32_16x16x32_bf16 v[128:131], v[72:75], a[224:227], v[128:131]
    ds_read_b128 v[88:91], v224 offset:63488
    v_mfma_f32_16x16x32_bf16 v[128:131], v[76:79], a[240:243], v[128:131]
    ds_read_b128 v[92:95], v225 offset:63488
    v_mfma_f32_16x16x32_bf16 v[136:139], v[64:67], a[196:199], v[136:139]
    v_mfma_f32_16x16x32_bf16 v[136:139], v[68:71], a[212:215], v[136:139]
    v_mfma_f32_16x16x32_bf16 v[136:139], v[72:75], a[228:231], v[136:139]
    v_mfma_f32_16x16x32_bf16 v[136:139], v[76:79], a[244:247], v[136:139]
    v_mfma_f32_16x16x32_bf16 v[144:147], v[64:67], a[200:203], v[144:147]
    s_add_u32 m0, s31, 0
    s_add_u32 s24, s27, 0
    buffer_load_dwordx4 v245, s[12:15], s24 offen lds
    v_mfma_f32_16x16x32_bf16 v[144:147], v[68:71], a[216:219], v[144:147]
    v_mfma_f32_16x16x32_bf16 v[144:147], v[72:75], a[232:235], v[144:147]
    v_mfma_f32_16x16x32_bf16 v[144:147], v[76:79], a[248:251], v[144:147]
    v_mfma_f32_16x16x32_bf16 v[152:155], v[64:67], a[204:207], v[152:155]
    v_mfma_f32_16x16x32_bf16 v[152:155], v[68:71], a[220:223], v[152:155]
    v_mfma_f32_16x16x32_bf16 v[152:155], v[72:75], a[236:239], v[152:155]
    v_mfma_f32_16x16x32_bf16 v[152:155], v[76:79], a[252:255], v[152:155]
    s_waitcnt vmcnt(23) lgkmcnt(0)
    s_barrier
    v_mfma_f32_16x16x32_bf16 v[132:135], v[80:83], a[192:195], v[132:135]
    ds_read_b128 v[64:67], v224 offset:0
    v_mfma_f32_16x16x32_bf16 v[132:135], v[84:87], a[208:211], v[132:135]
    ds_read_b128 v[68:71], v225 offset:0
    s_add_u32 s38, s36, 36864
    buffer_store_dwordx4 v[44:47], v240, s[16:19], s38 offen offset:256 sc1
    v_mfma_f32_16x16x32_bf16 v[132:135], v[88:91], a[224:227], v[132:135]
    ds_read_b128 v[72:75], v224 offset:8192
    v_mfma_f32_16x16x32_bf16 v[132:135], v[92:95], a[240:243], v[132:135]
    ds_read_b128 v[76:79], v225 offset:8192
    v_mfma_f32_16x16x32_bf16 v[140:143], v[80:83], a[196:199], v[140:143]
    v_mfma_f32_16x16x32_bf16 v[140:143], v[84:87], a[212:215], v[140:143]
    v_mfma_f32_16x16x32_bf16 v[140:143], v[88:91], a[228:231], v[140:143]
    v_mfma_f32_16x16x32_bf16 v[140:143], v[92:95], a[244:247], v[140:143]
    v_mfma_f32_16x16x32_bf16 v[148:151], v[80:83], a[200:203], v[148:151]
    s_add_u32 m0, s34, 49152
    s_add_u32 s37, s86, 196608
    buffer_load_dwordx4 v232, s[44:47], s37 offen lds
    v_mfma_f32_16x16x32_bf16 v[148:151], v[84:87], a[216:219], v[148:151]
    v_mfma_f32_16x16x32_bf16 v[148:151], v[88:91], a[232:235], v[148:151]
    buffer_load_dwordx4 v233, s[44:47], s37 offen offset:1024 lds
    v_mfma_f32_16x16x32_bf16 v[148:151], v[92:95], a[248:251], v[148:151]
    v_mfma_f32_16x16x32_bf16 v[156:159], v[80:83], a[204:207], v[156:159]
    v_mfma_f32_16x16x32_bf16 v[156:159], v[84:87], a[220:223], v[156:159]
    s_add_u32 m0, s31, 1024
    s_add_u32 s24, s27, 32768
    buffer_load_dwordx4 v245, s[12:15], s24 offen lds
    v_mfma_f32_16x16x32_bf16 v[156:159], v[88:91], a[236:239], v[156:159]
    v_mfma_f32_16x16x32_bf16 v[156:159], v[92:95], a[252:255], v[156:159]
    s_waitcnt lgkmcnt(0)
    v_mfma_f32_16x16x32_bf16 v[160:163], v[64:67], a[0:3], 0
    ds_read_b128 v[80:83], v224 offset:2048
    v_mfma_f32_16x16x32_bf16 v[160:163], v[68:71], a[16:19], v[160:163]
    ds_read_b128 v[84:87], v225 offset:2048
    v_mfma_f32_16x16x32_bf16 v[160:163], v[72:75], a[32:35], v[160:163]
    ds_read_b128 v[88:91], v224 offset:10240
    v_mfma_f32_16x16x32_bf16 v[160:163], v[76:79], a[48:51], v[160:163]
    ds_read_b128 v[92:95], v225 offset:10240
    v_mfma_f32_16x16x32_bf16 v[168:171], v[64:67], a[4:7], 0
    v_cvt_pk_bf16_f32 v0, v96, v97
    v_cvt_pk_bf16_f32 v1, v98, v99
    v_mfma_f32_16x16x32_bf16 v[168:171], v[68:71], a[20:23], v[168:171]
    v_mfma_f32_16x16x32_bf16 v[168:171], v[72:75], a[36:39], v[168:171]
    v_cvt_pk_bf16_f32 v2, v100, v101
    v_cvt_pk_bf16_f32 v3, v102, v103
    s_add_u32 s38, s36, 40960
    buffer_store_dwordx4 v[48:51], v240, s[16:19], s38 offen offset:1280 sc1
    v_mfma_f32_16x16x32_bf16 v[168:171], v[76:79], a[52:55], v[168:171]
    v_mfma_f32_16x16x32_bf16 v[176:179], v[64:67], a[8:11], 0
    s_add_u32 m0, s31, 2048
    s_add_u32 s24, s27, 65536
    buffer_load_dwordx4 v237, s[12:15], s24 offen lds
    v_cvt_pk_bf16_f32 v4, v104, v105
    v_cvt_pk_bf16_f32 v5, v106, v107
    v_mfma_f32_16x16x32_bf16 v[176:179], v[68:71], a[24:27], v[176:179]
    v_mfma_f32_16x16x32_bf16 v[176:179], v[72:75], a[40:43], v[176:179]
    v_cvt_pk_bf16_f32 v6, v108, v109
    v_cvt_pk_bf16_f32 v7, v110, v111
    v_mfma_f32_16x16x32_bf16 v[176:179], v[76:79], a[56:59], v[176:179]
    v_mfma_f32_16x16x32_bf16 v[184:187], v[64:67], a[12:15], 0
    v_cvt_pk_bf16_f32 v8, v112, v113
    v_cvt_pk_bf16_f32 v9, v114, v115
    v_mfma_f32_16x16x32_bf16 v[184:187], v[68:71], a[28:31], v[184:187]
    v_mfma_f32_16x16x32_bf16 v[184:187], v[72:75], a[44:47], v[184:187]
    v_cvt_pk_bf16_f32 v10, v116, v117
    v_cvt_pk_bf16_f32 v11, v118, v119
    v_mfma_f32_16x16x32_bf16 v[184:187], v[76:79], a[60:63], v[184:187]
    s_waitcnt lgkmcnt(0)
    v_mfma_f32_16x16x32_bf16 v[164:167], v[80:83], a[0:3], 0
    ds_read_b128 v[64:67], v224 offset:4096
    v_cvt_pk_bf16_f32 v12, v120, v121
    v_cvt_pk_bf16_f32 v13, v122, v123
    v_mfma_f32_16x16x32_bf16 v[164:167], v[84:87], a[16:19], v[164:167]
    ds_read_b128 v[68:71], v225 offset:4096
    v_mfma_f32_16x16x32_bf16 v[164:167], v[88:91], a[32:35], v[164:167]
    ds_read_b128 v[72:75], v224 offset:12288
    v_cvt_pk_bf16_f32 v14, v124, v125
    v_cvt_pk_bf16_f32 v15, v126, v127
    v_mfma_f32_16x16x32_bf16 v[164:167], v[92:95], a[48:51], v[164:167]
    ds_read_b128 v[76:79], v225 offset:12288
    v_mfma_f32_16x16x32_bf16 v[172:175], v[80:83], a[4:7], 0
    v_cvt_pk_bf16_f32 v16, v128, v129
    v_cvt_pk_bf16_f32 v17, v130, v131
    v_mfma_f32_16x16x32_bf16 v[172:175], v[84:87], a[20:23], v[172:175]
    v_mfma_f32_16x16x32_bf16 v[172:175], v[88:91], a[36:39], v[172:175]
    v_cvt_pk_bf16_f32 v18, v132, v133
    v_cvt_pk_bf16_f32 v19, v134, v135
    v_mfma_f32_16x16x32_bf16 v[172:175], v[92:95], a[52:55], v[172:175]
    v_mfma_f32_16x16x32_bf16 v[180:183], v[80:83], a[8:11], 0
    s_add_u32 m0, s34, 57344
    s_add_u32 s37, s87, 196608
    buffer_load_dwordx4 v232, s[44:47], s37 offen lds
    v_cvt_pk_bf16_f32 v20, v136, v137
    v_cvt_pk_bf16_f32 v21, v138, v139
    v_mfma_f32_16x16x32_bf16 v[180:183], v[84:87], a[24:27], v[180:183]
    v_mfma_f32_16x16x32_bf16 v[180:183], v[88:91], a[40:43], v[180:183]
    buffer_load_dwordx4 v233, s[44:47], s37 offen offset:1024 lds
    v_cvt_pk_bf16_f32 v22, v140, v141
    v_cvt_pk_bf16_f32 v23, v142, v143
    v_mfma_f32_16x16x32_bf16 v[180:183], v[92:95], a[56:59], v[180:183]
    v_mfma_f32_16x16x32_bf16 v[188:191], v[80:83], a[12:15], 0
    v_cvt_pk_bf16_f32 v24, v144, v145
    v_cvt_pk_bf16_f32 v25, v146, v147
    s_add_u32 s38, s36, 40960
    buffer_store_dwordx4 v[52:55], v240, s[16:19], s38 offen offset:2304 sc1
    v_mfma_f32_16x16x32_bf16 v[188:191], v[84:87], a[28:31], v[188:191]
    s_add_u32 m0, s31, 3072
    s_add_u32 s24, s27, 98304
    buffer_load_dwordx4 v237, s[12:15], s24 offen lds
    v_mfma_f32_16x16x32_bf16 v[188:191], v[88:91], a[44:47], v[188:191]
    v_cvt_pk_bf16_f32 v26, v148, v149
    v_cvt_pk_bf16_f32 v27, v150, v151
    v_mfma_f32_16x16x32_bf16 v[188:191], v[92:95], a[60:63], v[188:191]
    s_waitcnt lgkmcnt(0)
    v_mfma_f32_16x16x32_bf16 v[192:195], v[64:67], a[0:3], 0
    ds_read_b128 v[80:83], v224 offset:6144
    v_cvt_pk_bf16_f32 v28, v152, v153
    v_cvt_pk_bf16_f32 v29, v154, v155
    v_mfma_f32_16x16x32_bf16 v[192:195], v[68:71], a[16:19], v[192:195]
    ds_read_b128 v[84:87], v225 offset:6144
    v_mfma_f32_16x16x32_bf16 v[192:195], v[72:75], a[32:35], v[192:195]
    ds_read_b128 v[88:91], v224 offset:14336
    v_cvt_pk_bf16_f32 v30, v156, v157
    v_cvt_pk_bf16_f32 v31, v158, v159
    v_mfma_f32_16x16x32_bf16 v[192:195], v[76:79], a[48:51], v[192:195]
    ds_read_b128 v[92:95], v225 offset:14336
    v_mfma_f32_16x16x32_bf16 v[200:203], v[64:67], a[4:7], 0
    v_mfma_f32_16x16x32_bf16 v[200:203], v[68:71], a[20:23], v[200:203]
    v_mfma_f32_16x16x32_bf16 v[200:203], v[72:75], a[36:39], v[200:203]
    v_mfma_f32_16x16x32_bf16 v[200:203], v[76:79], a[52:55], v[200:203]
    v_mfma_f32_16x16x32_bf16 v[208:211], v[64:67], a[8:11], 0
    s_add_u32 m0, s31, 4096
    s_add_u32 s24, s27, 131072
    buffer_load_dwordx4 v245, s[12:15], s24 offen lds
    v_mfma_f32_16x16x32_bf16 v[208:211], v[68:71], a[24:27], v[208:211]
    v_mfma_f32_16x16x32_bf16 v[208:211], v[72:75], a[40:43], v[208:211]
    v_mfma_f32_16x16x32_bf16 v[208:211], v[76:79], a[56:59], v[208:211]
    v_mfma_f32_16x16x32_bf16 v[216:219], v[64:67], a[12:15], 0
    v_mfma_f32_16x16x32_bf16 v[216:219], v[68:71], a[28:31], v[216:219]
    v_mfma_f32_16x16x32_bf16 v[216:219], v[72:75], a[44:47], v[216:219]
    v_mfma_f32_16x16x32_bf16 v[216:219], v[76:79], a[60:63], v[216:219]
    s_waitcnt vmcnt(23) lgkmcnt(0)
    s_barrier
    v_mfma_f32_16x16x32_bf16 v[196:199], v[80:83], a[0:3], 0
    ds_read_b128 v[64:67], v224 offset:16384
    v_mfma_f32_16x16x32_bf16 v[196:199], v[84:87], a[16:19], v[196:199]
    ds_read_b128 v[68:71], v225 offset:16384
    s_add_u32 s38, s36, 40960
    buffer_store_dwordx4 v[56:59], v240, s[16:19], s38 offen offset:3328 sc1
    v_mfma_f32_16x16x32_bf16 v[196:199], v[88:91], a[32:35], v[196:199]
    ds_read_b128 v[72:75], v224 offset:24576
    v_mfma_f32_16x16x32_bf16 v[196:199], v[92:95], a[48:51], v[196:199]
    ds_read_b128 v[76:79], v225 offset:24576
    v_mfma_f32_16x16x32_bf16 v[204:207], v[80:83], a[4:7], 0
    v_mfma_f32_16x16x32_bf16 v[204:207], v[84:87], a[20:23], v[204:207]
    v_mfma_f32_16x16x32_bf16 v[204:207], v[88:91], a[36:39], v[204:207]
    v_mfma_f32_16x16x32_bf16 v[204:207], v[92:95], a[52:55], v[204:207]
    v_mfma_f32_16x16x32_bf16 v[212:215], v[80:83], a[8:11], 0
    s_add_u32 m0, s31, 5120
    s_add_u32 s24, s27, 163840
    buffer_load_dwordx4 v245, s[12:15], s24 offen lds
    v_mfma_f32_16x16x32_bf16 v[212:215], v[84:87], a[24:27], v[212:215]
    v_mfma_f32_16x16x32_bf16 v[212:215], v[88:91], a[40:43], v[212:215]
    v_mfma_f32_16x16x32_bf16 v[212:215], v[92:95], a[56:59], v[212:215]
    v_mfma_f32_16x16x32_bf16 v[220:223], v[80:83], a[12:15], 0
    v_mfma_f32_16x16x32_bf16 v[220:223], v[84:87], a[28:31], v[220:223]
    v_mfma_f32_16x16x32_bf16 v[220:223], v[88:91], a[44:47], v[220:223]
    v_mfma_f32_16x16x32_bf16 v[220:223], v[92:95], a[60:63], v[220:223]
    s_waitcnt lgkmcnt(0)
    v_mfma_f32_16x16x32_bf16 v[160:163], v[64:67], a[64:67], v[160:163]
    ds_read_b128 v[80:83], v224 offset:18432
    v_mfma_f32_16x16x32_bf16 v[160:163], v[68:71], a[80:83], v[160:163]
    ds_read_b128 v[84:87], v225 offset:18432
    v_mfma_f32_16x16x32_bf16 v[160:163], v[72:75], a[96:99], v[160:163]
    ds_read_b128 v[88:91], v224 offset:26624
    v_mfma_f32_16x16x32_bf16 v[160:163], v[76:79], a[112:115], v[160:163]
    ds_read_b128 v[92:95], v225 offset:26624
    v_mfma_f32_16x16x32_bf16 v[168:171], v[64:67], a[68:71], v[168:171]
    v_mfma_f32_16x16x32_bf16 v[168:171], v[68:71], a[84:87], v[168:171]
    v_mfma_f32_16x16x32_bf16 v[168:171], v[72:75], a[100:103], v[168:171]
    v_mfma_f32_16x16x32_bf16 v[168:171], v[76:79], a[116:119], v[168:171]
    s_add_u32 s38, s36, 45056
    buffer_store_dwordx4 v[60:63], v240, s[16:19], s38 offen offset:256 sc1
    v_mfma_f32_16x16x32_bf16 v[176:179], v[64:67], a[72:75], v[176:179]
    s_add_u32 m0, s31, 6144
    s_add_u32 s24, s27, 196608
    buffer_load_dwordx4 v237, s[12:15], s24 offen lds
    v_mfma_f32_16x16x32_bf16 v[176:179], v[68:71], a[88:91], v[176:179]
    v_mfma_f32_16x16x32_bf16 v[176:179], v[72:75], a[104:107], v[176:179]
    v_mfma_f32_16x16x32_bf16 v[176:179], v[76:79], a[120:123], v[176:179]
    v_mfma_f32_16x16x32_bf16 v[184:187], v[64:67], a[76:79], v[184:187]
    v_mfma_f32_16x16x32_bf16 v[184:187], v[68:71], a[92:95], v[184:187]
    v_mfma_f32_16x16x32_bf16 v[184:187], v[72:75], a[108:111], v[184:187]
    v_mfma_f32_16x16x32_bf16 v[184:187], v[76:79], a[124:127], v[184:187]
    s_waitcnt lgkmcnt(0)
    v_mfma_f32_16x16x32_bf16 v[164:167], v[80:83], a[64:67], v[164:167]
    ds_read_b128 v[64:67], v224 offset:20480
    v_mfma_f32_16x16x32_bf16 v[164:167], v[84:87], a[80:83], v[164:167]
    ds_read_b128 v[68:71], v225 offset:20480
    v_mfma_f32_16x16x32_bf16 v[164:167], v[88:91], a[96:99], v[164:167]
    ds_read_b128 v[72:75], v224 offset:28672
    v_mfma_f32_16x16x32_bf16 v[164:167], v[92:95], a[112:115], v[164:167]
    ds_read_b128 v[76:79], v225 offset:28672
    v_mfma_f32_16x16x32_bf16 v[172:175], v[80:83], a[68:71], v[172:175]
    v_mfma_f32_16x16x32_bf16 v[172:175], v[84:87], a[84:87], v[172:175]
    v_mfma_f32_16x16x32_bf16 v[172:175], v[88:91], a[100:103], v[172:175]
    v_mfma_f32_16x16x32_bf16 v[172:175], v[92:95], a[116:119], v[172:175]
    v_mfma_f32_16x16x32_bf16 v[180:183], v[80:83], a[72:75], v[180:183]
    s_add_u32 m0, s31, 7168
    s_add_u32 s24, s27, 229376
    buffer_load_dwordx4 v237, s[12:15], s24 offen lds
    v_mfma_f32_16x16x32_bf16 v[180:183], v[84:87], a[88:91], v[180:183]
    v_mfma_f32_16x16x32_bf16 v[180:183], v[88:91], a[104:107], v[180:183]
    s_add_u32 s27, s27, 1048576
    s_and_b32 s27, s27, 0x407fffff
    s_cmp_eq_u32 s27, s7
    s_cselect_b32 s27, s43, s27
    v_mfma_f32_16x16x32_bf16 v[180:183], v[92:95], a[120:123], v[180:183]
    v_mfma_f32_16x16x32_bf16 v[188:191], v[80:83], a[76:79], v[188:191]
    v_mfma_f32_16x16x32_bf16 v[188:191], v[84:87], a[92:95], v[188:191]
    s_add_u32 s31, s31, 32768
    s_cmp_ge_u32 s31, 163840
    s_cselect_b32 s24, 98304, 0
    s_sub_u32 s31, s31, s24
    s_add_u32 s38, s36, 65536
    buffer_store_dwordx4 v[0:3], v240, s[16:19], s38 offen offset:2560 sc1
    v_mfma_f32_16x16x32_bf16 v[188:191], v[88:91], a[108:111], v[188:191]
    v_mfma_f32_16x16x32_bf16 v[188:191], v[92:95], a[124:127], v[188:191]
    s_waitcnt lgkmcnt(0)
    v_mfma_f32_16x16x32_bf16 v[192:195], v[64:67], a[64:67], v[192:195]
    ds_read_b128 v[80:83], v224 offset:22528
    v_mfma_f32_16x16x32_bf16 v[192:195], v[68:71], a[80:83], v[192:195]
    ds_read_b128 v[84:87], v225 offset:22528
    v_mfma_f32_16x16x32_bf16 v[192:195], v[72:75], a[96:99], v[192:195]
    ds_read_b128 v[88:91], v224 offset:30720
    v_mfma_f32_16x16x32_bf16 v[192:195], v[76:79], a[112:115], v[192:195]
    ds_read_b128 v[92:95], v225 offset:30720
    v_mfma_f32_16x16x32_bf16 v[200:203], v[64:67], a[68:71], v[200:203]
    v_mfma_f32_16x16x32_bf16 v[200:203], v[68:71], a[84:87], v[200:203]
    v_mfma_f32_16x16x32_bf16 v[200:203], v[72:75], a[100:103], v[200:203]
    v_mfma_f32_16x16x32_bf16 v[200:203], v[76:79], a[116:119], v[200:203]
    v_mfma_f32_16x16x32_bf16 v[208:211], v[64:67], a[72:75], v[208:211]
    v_mfma_f32_16x16x32_bf16 v[208:211], v[68:71], a[88:91], v[208:211]
    v_mfma_f32_16x16x32_bf16 v[208:211], v[72:75], a[104:107], v[208:211]
    v_mfma_f32_16x16x32_bf16 v[208:211], v[76:79], a[120:123], v[208:211]
    v_mfma_f32_16x16x32_bf16 v[216:219], v[64:67], a[76:79], v[216:219]
    v_mfma_f32_16x16x32_bf16 v[216:219], v[68:71], a[92:95], v[216:219]
    v_mfma_f32_16x16x32_bf16 v[216:219], v[72:75], a[108:111], v[216:219]
    v_mfma_f32_16x16x32_bf16 v[216:219], v[76:79], a[124:127], v[216:219]
    s_waitcnt vmcnt(9) lgkmcnt(0)
    s_barrier
    v_mfma_f32_16x16x32_bf16 v[196:199], v[80:83], a[64:67], v[196:199]
    ds_read_b128 v[64:67], v224 offset:32768
    v_mfma_f32_16x16x32_bf16 v[196:199], v[84:87], a[80:83], v[196:199]
    ds_read_b128 v[68:71], v225 offset:32768
    v_mfma_f32_16x16x32_bf16 v[196:199], v[88:91], a[96:99], v[196:199]
    ds_read_b128 v[72:75], v224 offset:40960
    s_add_u32 s38, s36, 65536
    buffer_store_dwordx4 v[4:7], v240, s[16:19], s38 offen offset:3584 sc1
    v_mfma_f32_16x16x32_bf16 v[196:199], v[92:95], a[112:115], v[196:199]
    ds_read_b128 v[76:79], v225 offset:40960
    v_mfma_f32_16x16x32_bf16 v[204:207], v[80:83], a[68:71], v[204:207]
    v_mfma_f32_16x16x32_bf16 v[204:207], v[84:87], a[84:87], v[204:207]
    v_mfma_f32_16x16x32_bf16 v[204:207], v[88:91], a[100:103], v[204:207]
    v_mfma_f32_16x16x32_bf16 v[204:207], v[92:95], a[116:119], v[204:207]
    v_mfma_f32_16x16x32_bf16 v[212:215], v[80:83], a[72:75], v[212:215]
    v_mfma_f32_16x16x32_bf16 v[212:215], v[84:87], a[88:91], v[212:215]
    v_mfma_f32_16x16x32_bf16 v[212:215], v[88:91], a[104:107], v[212:215]
    v_mfma_f32_16x16x32_bf16 v[212:215], v[92:95], a[120:123], v[212:215]
    v_mfma_f32_16x16x32_bf16 v[220:223], v[80:83], a[76:79], v[220:223]
    v_mfma_f32_16x16x32_bf16 v[220:223], v[84:87], a[92:95], v[220:223]
    v_mfma_f32_16x16x32_bf16 v[220:223], v[88:91], a[108:111], v[220:223]
    v_mfma_f32_16x16x32_bf16 v[220:223], v[92:95], a[124:127], v[220:223]
    s_waitcnt lgkmcnt(0)
    v_mfma_f32_16x16x32_bf16 v[160:163], v[64:67], a[128:131], v[160:163]
    ds_read_b128 v[80:83], v224 offset:34816
    v_mfma_f32_16x16x32_bf16 v[160:163], v[68:71], a[144:147], v[160:163]
    ds_read_b128 v[84:87], v225 offset:34816
    v_mfma_f32_16x16x32_bf16 v[160:163], v[72:75], a[160:163], v[160:163]
    ds_read_b128 v[88:91], v224 offset:43008
    v_mfma_f32_16x16x32_bf16 v[160:163], v[76:79], a[176:179], v[160:163]
    ds_read_b128 v[92:95], v225 offset:43008
    v_mfma_f32_16x16x32_bf16 v[168:171], v[64:67], a[132:135], v[168:171]
    v_mfma_f32_16x16x32_bf16 v[168:171], v[68:71], a[148:151], v[168:171]
    v_mfma_f32_16x16x32_bf16 v[168:171], v[72:75], a[164:167], v[168:171]
    v_mfma_f32_16x16x32_bf16 v[168:171], v[76:79], a[180:183], v[168:171]
    v_mfma_f32_16x16x32_bf16 v[176:179], v[64:67], a[136:139], v[176:179]
    buffer_load_dword v254, off, s[88:91], s39 sc1
    s_add_u32 s38, s36, 69632
    buffer_store_dwordx4 v[8:11], v240, s[16:19], s38 offen offset:512 sc1
    v_mfma_f32_16x16x32_bf16 v[176:179], v[68:71], a[152:155], v[176:179]
    v_mfma_f32_16x16x32_bf16 v[176:179], v[72:75], a[168:171], v[176:179]
    v_mfma_f32_16x16x32_bf16 v[176:179], v[76:79], a[184:187], v[176:179]
    v_mfma_f32_16x16x32_bf16 v[184:187], v[64:67], a[140:143], v[184:187]
    v_mfma_f32_16x16x32_bf16 v[184:187], v[68:71], a[156:159], v[184:187]
    v_mfma_f32_16x16x32_bf16 v[184:187], v[72:75], a[172:175], v[184:187]
    v_mfma_f32_16x16x32_bf16 v[184:187], v[76:79], a[188:191], v[184:187]
    s_waitcnt lgkmcnt(0)
    v_mfma_f32_16x16x32_bf16 v[164:167], v[80:83], a[128:131], v[164:167]
    ds_read_b128 v[64:67], v224 offset:36864
    v_mfma_f32_16x16x32_bf16 v[164:167], v[84:87], a[144:147], v[164:167]
    ds_read_b128 v[68:71], v225 offset:36864
    v_mfma_f32_16x16x32_bf16 v[164:167], v[88:91], a[160:163], v[164:167]
    ds_read_b128 v[72:75], v224 offset:45056
    v_mfma_f32_16x16x32_bf16 v[164:167], v[92:95], a[176:179], v[164:167]
    ds_read_b128 v[76:79], v225 offset:45056
    v_mfma_f32_16x16x32_bf16 v[172:175], v[80:83], a[132:135], v[172:175]
    v_mfma_f32_16x16x32_bf16 v[172:175], v[84:87], a[148:151], v[172:175]
    v_mfma_f32_16x16x32_bf16 v[172:175], v[88:91], a[164:167], v[172:175]
    v_mfma_f32_16x16x32_bf16 v[172:175], v[92:95], a[180:183], v[172:175]
    v_mfma_f32_16x16x32_bf16 v[180:183], v[80:83], a[136:139], v[180:183]
    v_mfma_f32_16x16x32_bf16 v[180:183], v[84:87], a[152:155], v[180:183]
    v_mfma_f32_16x16x32_bf16 v[180:183], v[88:91], a[168:171], v[180:183]
    v_mfma_f32_16x16x32_bf16 v[180:183], v[92:95], a[184:187], v[180:183]
    v_mfma_f32_16x16x32_bf16 v[188:191], v[80:83], a[140:143], v[188:191]
    v_mfma_f32_16x16x32_bf16 v[188:191], v[84:87], a[156:159], v[188:191]
    s_add_u32 s38, s36, 69632
    buffer_store_dwordx4 v[12:15], v240, s[16:19], s38 offen offset:1536 sc1
    v_mfma_f32_16x16x32_bf16 v[188:191], v[88:91], a[172:175], v[188:191]
    v_mfma_f32_16x16x32_bf16 v[188:191], v[92:95], a[188:191], v[188:191]
    s_waitcnt lgkmcnt(0)
    v_mfma_f32_16x16x32_bf16 v[192:195], v[64:67], a[128:131], v[192:195]
    ds_read_b128 v[80:83], v224 offset:38912
    v_mfma_f32_16x16x32_bf16 v[192:195], v[68:71], a[144:147], v[192:195]
    ds_read_b128 v[84:87], v225 offset:38912
    v_mfma_f32_16x16x32_bf16 v[192:195], v[72:75], a[160:163], v[192:195]
    ds_read_b128 v[88:91], v224 offset:47104
    v_mfma_f32_16x16x32_bf16 v[192:195], v[76:79], a[176:179], v[192:195]
    ds_read_b128 v[92:95], v225 offset:47104
    v_mfma_f32_16x16x32_bf16 v[200:203], v[64:67], a[132:135], v[200:203]
    v_mfma_f32_16x16x32_bf16 v[200:203], v[68:71], a[148:151], v[200:203]
    v_mfma_f32_16x16x32_bf16 v[200:203], v[72:75], a[164:167], v[200:203]
    v_mfma_f32_16x16x32_bf16 v[200:203], v[76:79], a[180:183], v[200:203]
    v_mfma_f32_16x16x32_bf16 v[208:211], v[64:67], a[136:139], v[208:211]
    v_mfma_f32_16x16x32_bf16 v[208:211], v[68:71], a[152:155], v[208:211]
    v_mfma_f32_16x16x32_bf16 v[208:211], v[72:75], a[168:171], v[208:211]
    v_mfma_f32_16x16x32_bf16 v[208:211], v[76:79], a[184:187], v[208:211]
    v_mfma_f32_16x16x32_bf16 v[216:219], v[64:67], a[140:143], v[216:219]
    v_mfma_f32_16x16x32_bf16 v[216:219], v[68:71], a[156:159], v[216:219]
    v_mfma_f32_16x16x32_bf16 v[216:219], v[72:75], a[172:175], v[216:219]
    v_mfma_f32_16x16x32_bf16 v[216:219], v[76:79], a[188:191], v[216:219]
    s_waitcnt lgkmcnt(0)
    v_mfma_f32_16x16x32_bf16 v[196:199], v[80:83], a[128:131], v[196:199]
    ds_read_b128 v[64:67], v224 offset:49152
    v_mfma_f32_16x16x32_bf16 v[196:199], v[84:87], a[144:147], v[196:199]
    ds_read_b128 v[68:71], v224 offset:51200
    v_mfma_f32_16x16x32_bf16 v[196:199], v[88:91], a[160:163], v[196:199]
    ds_read_b128 v[72:75], v224 offset:53248
    v_mfma_f32_16x16x32_bf16 v[196:199], v[92:95], a[176:179], v[196:199]
    ds_read_b128 v[76:79], v224 offset:55296
    s_add_u32 s38, s36, 73728
    buffer_store_dwordx4 v[16:19], v240, s[16:19], s38 offen offset:2560 sc1
    v_mfma_f32_16x16x32_bf16 v[204:207], v[80:83], a[132:135], v[204:207]
    v_mfma_f32_16x16x32_bf16 v[204:207], v[84:87], a[148:151], v[204:207]
    v_mfma_f32_16x16x32_bf16 v[204:207], v[88:91], a[164:167], v[204:207]
    v_mfma_f32_16x16x32_bf16 v[204:207], v[92:95], a[180:183], v[204:207]
    v_mfma_f32_16x16x32_bf16 v[212:215], v[80:83], a[136:139], v[212:215]
    v_mfma_f32_16x16x32_bf16 v[212:215], v[84:87], a[152:155], v[212:215]
    v_mfma_f32_16x16x32_bf16 v[212:215], v[88:91], a[168:171], v[212:215]
    v_mfma_f32_16x16x32_bf16 v[212:215], v[92:95], a[184:187], v[212:215]
    v_mfma_f32_16x16x32_bf16 v[220:223], v[80:83], a[140:143], v[220:223]
    v_mfma_f32_16x16x32_bf16 v[220:223], v[84:87], a[156:159], v[220:223]
    v_mfma_f32_16x16x32_bf16 v[220:223], v[88:91], a[172:175], v[220:223]
    v_mfma_f32_16x16x32_bf16 v[220:223], v[92:95], a[188:191], v[220:223]
    s_waitcnt vmcnt(3)
    v_readfirstlane_b32 s24, v254
    s_lshl_b32 s25, s3, 16
    s_add_u32 s24, s24, s25
    s_cmp_ge_u32 s24, 32
    s_cbranch_scc0 kf_spin37
kf_spinr38:
    s_waitcnt lgkmcnt(0)
    s_barrier
    v_mfma_f32_16x16x32_bf16 v[160:163], v[64:67], a[192:195], v[160:163]
    ds_read_b128 v[80:83], v225 offset:49152
    v_mfma_f32_16x16x32_bf16 v[164:167], v[68:71], a[192:195], v[164:167]
    ds_read_b128 v[84:87], v225 offset:51200
    v_mfma_f32_16x16x32_bf16 v[168:171], v[64:67], a[196:199], v[168:171]
    ds_read_b128 v[88:91], v225 offset:53248
    v_mfma_f32_16x16x32_bf16 v[172:175], v[68:71], a[196:199], v[172:175]
    ds_read_b128 v[92:95], v225 offset:55296
    v_mfma_f32_16x16x32_bf16 v[176:179], v[64:67], a[200:203], v[176:179]
    v_mfma_f32_16x16x32_bf16 v[180:183], v[68:71], a[200:203], v[180:183]
    v_mfma_f32_16x16x32_bf16 v[184:187], v[64:67], a[204:207], v[184:187]
    v_mfma_f32_16x16x32_bf16 v[188:191], v[68:71], a[204:207], v[188:191]
    v_mfma_f32_16x16x32_bf16 v[192:195], v[72:75], a[192:195], v[192:195]
    buffer_load_dwordx4 a[128:131], v248, s[8:11], s28 offen offset:0 sc1
    s_add_u32 s38, s36, 73728
    buffer_store_dwordx4 v[20:23], v240, s[16:19], s38 offen offset:3584 sc1
    v_mfma_f32_16x16x32_bf16 v[196:199], v[76:79], a[192:195], v[196:199]
    v_mfma_f32_16x16x32_bf16 v[200:203], v[72:75], a[196:199], v[200:203]
    buffer_load_dwordx4 a[132:135], v248, s[8:11], s29 offen offset:0 sc1
    v_mfma_f32_16x16x32_bf16 v[204:207], v[76:79], a[196:199], v[204:207]
    v_mfma_f32_16x16x32_bf16 v[208:211], v[72:75], a[200:203], v[208:211]
    v_mfma_f32_16x16x32_bf16 v[212:215], v[76:79], a[200:203], v[212:215]
    buffer_load_dwordx4 a[136:139], v249, s[8:11], s28 offen offset:0 sc1
    v_mfma_f32_16x16x32_bf16 v[216:219], v[72:75], a[204:207], v[216:219]
    v_mfma_f32_16x16x32_bf16 v[220:223], v[76:79], a[204:207], v[220:223]
    s_waitcnt lgkmcnt(0)
    v_mfma_f32_16x16x32_bf16 v[160:163], v[80:83], a[208:211], v[160:163]
    ds_read_b128 v[64:67], v224 offset:57344
    v_mfma_f32_16x16x32_bf16 v[164:167], v[84:87], a[208:211], v[164:167]
    ds_read_b128 v[68:71], v224 offset:59392
    v_mfma_f32_16x16x32_bf16 v[168:171], v[80:83], a[212:215], v[168:171]
    ds_read_b128 v[72:75], v224 offset:61440
    v_mfma_f32_16x16x32_bf16 v[172:175], v[84:87], a[212:215], v[172:175]
    ds_read_b128 v[76:79], v224 offset:63488
    v_mfma_f32_16x16x32_bf16 v[176:179], v[80:83], a[216:219], v[176:179]
    v_mfma_f32_16x16x32_bf16 v[180:183], v[84:87], a[216:219], v[180:183]
    v_mfma_f32_16x16x32_bf16 v[184:187], v[80:83], a[220:223], v[184:187]
    v_mfma_f32_16x16x32_bf16 v[188:191], v[84:87], a[220:223], v[188:191]
    v_mfma_f32_16x16x32_bf16 v[192:195], v[88:91], a[208:211], v[192:195]
    buffer_load_dwordx4 a[140:143], v249, s[8:11], s29 offen offset:0 sc1
    v_mfma_f32_16x16x32_bf16 v[196:199], v[92:95], a[208:211], v[196:199]
    v_mfma_f32_16x16x32_bf16 v[200:203], v[88:91], a[212:215], v[200:203]
    buffer_load_dwordx4 a[144:147], v248, s[8:11], s28 offen offset:1024 sc1
    v_mfma_f32_16x16x32_bf16 v[204:207], v[92:95], a[212:215], v[204:207]
    v_mfma_f32_16x16x32_bf16 v[208:211], v[88:91], a[216:219], v[208:211]
    v_mfma_f32_16x16x32_bf16 v[212:215], v[92:95], a[216:219], v[212:215]
    buffer_load_dwordx4 a[148:151], v248, s[8:11], s29 offen offset:1024 sc1
    v_mfma_f32_16x16x32_bf16 v[216:219], v[88:91], a[220:223], v[216:219]
    s_add_u32 s38, s36, 77824
    buffer_store_dwordx4 v[24:27], v240, s[16:19], s38 offen offset:512 sc1
    v_mfma_f32_16x16x32_bf16 v[220:223], v[92:95], a[220:223], v[220:223]
    s_waitcnt lgkmcnt(0)
    v_mfma_f32_16x16x32_bf16 v[160:163], v[64:67], a[224:227], v[160:163]
    ds_read_b128 v[80:83], v225 offset:57344
    v_mfma_f32_16x16x32_bf16 v[164:167], v[68:71], a[224:227], v[164:167]
    ds_read_b128 v[84:87], v225 offset:59392
    v_mfma_f32_16x16x32_bf16 v[168:171], v[64:67], a[228:231], v[168:171]
    ds_read_b128 v[88:91], v225 offset:61440
    v_mfma_f32_16x16x32_bf16 v[172:175], v[68:71], a[228:231], v[172:175]
    ds_read_b128 v[92:95], v225 offset:63488
    v_mfma_f32_16x16x32_bf16 v[176:179], v[64:67], a[232:235], v[176:179]
    v_mfma_f32_16x16x32_bf16 v[180:183], v[68:71], a[232:235], v[180:183]
    v_mfma_f32_16x16x32_bf16 v[184:187], v[64:67], a[236:239], v[184:187]
    v_mfma_f32_16x16x32_bf16 v[188:191], v[68:71], a[236:239], v[188:191]
    v_mfma_f32_16x16x32_bf16 v[192:195], v[72:75], a[224:227], v[192:195]
    buffer_load_dwordx4 a[152:155], v249, s[8:11], s28 offen offset:1024 sc1
    v_mfma_f32_16x16x32_bf16 v[196:199], v[76:79], a[224:227], v[196:199]
    v_mfma_f32_16x16x32_bf16 v[200:203], v[72:75], a[228:231], v[200:203]
    buffer_load_dwordx4 a[156:159], v249, s[8:11], s29 offen offset:1024 sc1
    v_mfma_f32_16x16x32_bf16 v[204:207], v[76:79], a[228:231], v[204:207]
    v_mfma_f32_16x16x32_bf16 v[208:211], v[72:75], a[232:235], v[208:211]
    v_mfma_f32_16x16x32_bf16 v[212:215], v[76:79], a[232:235], v[212:215]
    buffer_load_dwordx4 a[160:163], v248, s[8:11], s28 offen offset:2048 sc1
    v_mfma_f32_16x16x32_bf16 v[216:219], v[72:75], a[236:239], v[216:219]
    v_mfma_f32_16x16x32_bf16 v[220:223], v[76:79], a[236:239], v[220:223]
    s_waitcnt vmcnt(38) lgkmcnt(0)
    s_barrier
    v_mfma_f32_16x16x32_bf16 v[160:163], v[80:83], a[240:243], v[160:163]
    ds_read_b64_tr_b16 a[192:193], v246 offset:0
    v_mfma_f32_16x16x32_bf16 v[164:167], v[84:87], a[240:243], v[164:167]
    ds_read_b64_tr_b16 a[194:195], v246 offset:1024
    v_mfma_f32_16x16x32_bf16 v[168:171], v[80:83], a[244:247], v[168:171]
    ds_read_b64_tr_b16 a[196:197], v238 offset:0
    v_mfma_f32_16x16x32_bf16 v[172:175], v[84:87], a[244:247], v[172:175]
    ds_read_b64_tr_b16 a[198:199], v238 offset:1024
    v_mfma_f32_16x16x32_bf16 v[176:179], v[80:83], a[248:251], v[176:179]
    ds_read_b64_tr_b16 a[200:201], v246 offset:256
    s_add_u32 s38, s36, 77824
    buffer_store_dwordx4 v[28:31], v240, s[16:19], s38 offen offset:1536 sc1
    v_mfma_f32_16x16x32_bf16 v[180:183], v[84:87], a[248:251], v[180:183]
    ds_read_b64_tr_b16 a[202:203], v246 offset:1280
    v_mfma_f32_16x16x32_bf16 v[184:187], v[80:83], a[252:255], v[184:187]
    ds_read_b64_tr_b16 a[204:205], v238 offset:256
    v_mfma_f32_16x16x32_bf16 v[188:191], v[84:87], a[252:255], v[188:191]
    ds_read_b64_tr_b16 a[206:207], v238 offset:1280
    v_mfma_f32_16x16x32_bf16 v[192:195], v[88:91], a[240:243], v[192:195]
    buffer_load_dwordx4 a[164:167], v248, s[8:11], s29 offen offset:2048 sc1
    v_mfma_f32_16x16x32_bf16 v[196:199], v[92:95], a[240:243], v[196:199]
    v_cvt_pk_bf16_f32 v32, v160, v161
    v_cvt_pk_bf16_f32 v33, v162, v163
    v_mfma_f32_16x16x32_bf16 v[200:203], v[88:91], a[244:247], v[200:203]
    buffer_load_dwordx4 a[168:171], v249, s[8:11], s28 offen offset:2048 sc1
    v_cvt_pk_bf16_f32 v34, v164, v165
    v_cvt_pk_bf16_f32 v35, v166, v167
    v_mfma_f32_16x16x32_bf16 v[204:207], v[92:95], a[244:247], v[204:207]
    v_cvt_pk_bf16_f32 v36, v168, v169
    v_cvt_pk_bf16_f32 v37, v170, v171
    v_mfma_f32_16x16x32_bf16 v[208:211], v[88:91], a[248:251], v[208:211]
    v_cvt_pk_bf16_f32 v38, v172, v173
    v_cvt_pk_bf16_f32 v39, v174, v175
    v_mfma_f32_16x16x32_bf16 v[212:215], v[92:95], a[248:251], v[212:215]
    buffer_load_dwordx4 a[172:175], v249, s[8:11], s29 offen offset:2048 sc1
    v_cvt_pk_bf16_f32 v40, v176, v177
    v_cvt_pk_bf16_f32 v41, v178, v179
    v_mfma_f32_16x16x32_bf16 v[216:219], v[88:91], a[252:255], v[216:219]
    v_cvt_pk_bf16_f32 v42, v180, v181
    v_cvt_pk_bf16_f32 v43, v182, v183
    v_mfma_f32_16x16x32_bf16 v[220:223], v[92:95], a[252:255], v[220:223]
    v_cvt_pk_bf16_f32 v44, v184, v185
    v_cvt_pk_bf16_f32 v45, v186, v187
    s_nop 3
    v_cvt_pk_bf16_f32 v46, v188, v189
    v_cvt_pk_bf16_f32 v47, v190, v191
    v_cvt_pk_bf16_f32 v48, v192, v193
    v_cvt_pk_bf16_f32 v49, v194, v195
    v_cvt_pk_bf16_f32 v50, v196, v197
    v_cvt_pk_bf16_f32 v51, v198, v199
    v_cvt_pk_bf16_f32 v52, v200, v201
    v_cvt_pk_bf16_f32 v53, v202, v203
    v_cvt_pk_bf16_f32 v54, v204, v205
    v_cvt_pk_bf16_f32 v55, v206, v207
    v_cvt_pk_bf16_f32 v56, v208, v209
    v_cvt_pk_bf16_f32 v57, v210, v211
    v_cvt_pk_bf16_f32 v58, v212, v213
    v_cvt_pk_bf16_f32 v59, v214, v215
    v_cvt_pk_bf16_f32 v60, v216, v217
    v_cvt_pk_bf16_f32 v61, v218, v219
    v_cvt_pk_bf16_f32 v62, v220, v221
    v_cvt_pk_bf16_f32 v63, v222, v223
    s_add_u32 s80, s36, 102144
    s_add_u32 s81, s36, 103168
    s_add_u32 s82, s36, 104192
    s_add_u32 s83, s36, 105216
    s_add_u32 s84, s36, 110336
    s_add_u32 s85, s36, 111360
    s_add_u32 s86, s36, 112384
    s_add_u32 s87, s36, 113408
ka_Q:
    s_waitcnt vmcnt(10) lgkmcnt(0)
    v_mfma_f32_16x16x32_bf16 v[96:99], a[192:195], a[128:131], 0
    ds_read_b64_tr_b16 a[208:209], v246 offset:512
    s_lshl_b32 s97, s4, 7
    v_mfma_f32_16x16x32_bf16 v[100:103], a[192:195], a[132:135], 0
    ds_read_b64_tr_b16 a[210:211], v246 offset:1536
    s_add_u32 s97, s97, 12288
    s_cmp_eq_u32 s3, 0
    s_cselect_b32 s35, s97, s43
    v_mfma_f32_16x16x32_bf16 v[104:107], a[192:195], a[136:139], 0
    ds_read_b64_tr_b16 a[212:213], v238 offset:512
    s_lshl_b32 s37, s3, 12
    v_mfma_f32_16x16x32_bf16 v[108:111], a[192:195], a[140:143], 0
    ds_read_b64_tr_b16 a[214:215], v238 offset:1536
    s_mov_b32 s34, s37
    s_mul_i32 s32, s4, 1089536
    v_mfma_f32_16x16x32_bf16 v[112:115], a[196:199], a[128:131], 0
    ds_read_b64_tr_b16 a[216:217], v246 offset:768
    s_mov_b32 s33, 0
    v_mfma_f32_16x16x32_bf16 v[116:119], a[196:199], a[132:135], 0
    ds_read_b64_tr_b16 a[218:219], v246 offset:1792
    s_lshl_b32 s39, s6, 18
    v_mfma_f32_16x16x32_bf16 v[120:123], a[196:199], a[136:139], 0
    ds_read_b64_tr_b16 a[220:221], v238 offset:768
    s_sub_u32 s25, 63, s6
    s_lshl_b32 s40, s25, 18
    v_mfma_f32_16x16x32_bf16 v[124:127], a[196:199], a[140:143], 0
    ds_read_b64_tr_b16 a[222:223], v238 offset:1792
    s_lshl_b32 s25, s4, 12
    v_mfma_f32_16x16x32_bf16 v[128:131], a[200:203], a[128:131], 0
    buffer_load_dwordx4 a[176:179], v248, s[8:11], s28 offen offset:3072 sc1
    s_add_u32 s39, s39, s25
    s_add_u32 s40, s40, s25
    v_mfma_f32_16x16x32_bf16 v[132:135], a[200:203], a[132:135], 0
    s_mov_b32 s38, 0x40004000
    s_mov_b32 s36, s6
    v_mfma_f32_16x16x32_bf16 v[136:139], a[200:203], a[136:139], 0
    buffer_load_dwordx4 a[180:183], v248, s[8:11], s29 offen offset:3072 sc1
    s_mov_b32 s26, 6
    v_mfma_f32_16x16x32_bf16 v[140:143], a[200:203], a[140:143], 0
    s_add_u32 m0, s31, 0
    s_add_u32 s24, s27, 0
    s_mov_b32 s52, s41
    v_mfma_f32_16x16x32_bf16 v[144:147], a[204:207], a[128:131], 0
    buffer_load_dwordx4 v245, s[12:15], s24 offen lds
    s_mov_b32 s53, s42
    v_mfma_f32_16x16x32_bf16 v[148:151], a[204:207], a[132:135], 0
    s_mov_b32 s54, 0x700000
    s_add_u32 s48, s20, 0x1c00000
    s_addc_u32 s49, s21, 0
    v_mfma_f32_16x16x32_bf16 v[152:155], a[204:207], a[136:139], 0
    buffer_store_dwordx4 v[32:35], v240, s[16:19], s80 offen sc1
    s_mov_b32 s50, 0x1c00000
    s_and_b32 s25, s3, 1
    v_mfma_f32_16x16x32_bf16 v[156:159], a[204:207], a[140:143], 0
    s_lshl1_add_u32 s47, s4, s25
    s_waitcnt lgkmcnt(0)
    v_mfma_f32_16x16x32_bf16 v[160:163], a[208:211], a[128:131], 0
    ds_read_b64_tr_b16 a[192:193], v246 offset:8192
    s_lshr_b32 s101, s3, 1
    v_mfma_f32_16x16x32_bf16 v[164:167], a[208:211], a[132:135], 0
    ds_read_b64_tr_b16 a[194:195], v246 offset:9216
    s_add_u32 s45, s5, s101
    s_sub_u32 s45, s45, 1
    v_mfma_f32_16x16x32_bf16 v[168:171], a[208:211], a[136:139], 0
    ds_read_b64_tr_b16 a[196:197], v238 offset:8192
    s_mul_i32 s45, s45, s5
    v_mfma_f32_16x16x32_bf16 v[172:175], a[208:211], a[140:143], 0
    ds_read_b64_tr_b16 a[198:199], v238 offset:9216
    s_lshl_b32 s100, s101, 14
    s_add_u32 s100, s100, 114688
    v_mfma_f32_16x16x32_bf16 v[176:179], a[212:215], a[128:131], 0
    ds_read_b64_tr_b16 a[200:201], v246 offset:8448
    s_mul_i32 s100, s100, s47
    v_mfma_f32_16x16x32_bf16 v[180:183], a[212:215], a[132:135], 0
    ds_read_b64_tr_b16 a[202:203], v246 offset:9472
    s_lshl_b32 s25, s45, 11
    v_mfma_f32_16x16x32_bf16 v[184:187], a[212:215], a[136:139], 0
    ds_read_b64_tr_b16 a[204:205], v238 offset:8448
    s_add_u32 s100, s100, s25
    s_lshl_b32 s46, s47, 9
    v_mfma_f32_16x16x32_bf16 v[188:191], a[212:215], a[140:143], 0
    ds_read_b64_tr_b16 a[206:207], v238 offset:9472
    s_mul_i32 s44, s47, 114688
    v_mfma_f32_16x16x32_bf16 v[192:195], a[216:219], a[128:131], 0
    buffer_load_dwordx4 a[184:187], v249, s[8:11], s28 offen offset:3072 sc1
    s_add_u32 s47, s44, 7168
    s_lshl_b32 s25, s45, 7
    v_mfma_f32_16x16x32_bf16 v[196:199], a[216:219], a[132:135], 0
    s_add_u32 s44, s44, s25
    s_lshl_b32 s45, s45, 18
    v_mfma_f32_16x16x32_bf16 v[200:203], a[216:219], a[136:139], 0
    buffer_load_dwordx4 a[188:191], v249, s[8:11], s29 offen offset:3072 sc1
    s_add_u32 s46, s46, s45
    v_mfma_f32_16x16x32_bf16 v[204:207], a[216:219], a[140:143], 0
    s_add_u32 m0, s31, 1024
    s_add_u32 s24, s27, 32768
    s_lshr_b32 s25, s3, 1
    v_mfma_f32_16x16x32_bf16 v[208:211], a[220:223], a[128:131], 0
    buffer_load_dwordx4 v245, s[12:15], s24 offen lds
    s_lshl_b32 s25, s25, 15
    v_mfma_f32_16x16x32_bf16 v[212:215], a[220:223], a[132:135], 0
    s_add_u32 s46, s46, s25
    s_mov_b32 s45, s43
    v_mfma_f32_16x16x32_bf16 v[216:219], a[220:223], a[136:139], 0
    s_add_u32 s28, s28, 4096
    s_and_b32 s28, s28, 32767
    buffer_store_dwordx4 v[36:39], v240, s[16:19], s81 offen sc1
    v_mfma_f32_16x16x32_bf16 v[220:223], a[220:223], a[140:143], 0
    s_add_u32 s29, s28, 32768
    v_accvgpr_write_b32 a0, 0
    s_waitcnt vmcnt(13) lgkmcnt(0)
    v_mfma_f32_16x16x32_bf16 v[96:99], a[192:195], a[144:147], v[96:99]
    ds_read_b64_tr_b16 a[208:209], v246 offset:8704
    s_load_dwordx2 s[56:57], s[0:1], 40
    v_accvgpr_write_b32 a1, 0
    v_mfma_f32_16x16x32_bf16 v[100:103], a[192:195], a[148:151], v[100:103]
    ds_read_b64_tr_b16 a[210:211], v246 offset:9728
    v_accvgpr_write_b32 a2, 0
    v_mfma_f32_16x16x32_bf16 v[104:107], a[192:195], a[152:155], v[104:107]
    ds_read_b64_tr_b16 a[212:213], v238 offset:8704
    v_accvgpr_write_b32 a3, 0
    v_mfma_f32_16x16x32_bf16 v[108:111], a[192:195], a[156:159], v[108:111]
    ds_read_b64_tr_b16 a[214:215], v238 offset:9728
    v_accvgpr_write_b32 a4, 0
    v_accvgpr_write_b32 a5, 0
    v_mfma_f32_16x16x32_bf16 v[112:115], a[196:199], a[144:147], v[112:115]
    ds_read_b64_tr_b16 a[216:217], v246 offset:8960
    v_accvgpr_write_b32 a6, 0
    v_mfma_f32_16x16x32_bf16 v[116:119], a[196:199], a[148:151], v[116:119]
    ds_read_b64_tr_b16 a[218:219], v246 offset:9984
    v_accvgpr_write_b32 a7, 0
    v_accvgpr_write_b32 a8, 0
    v_mfma_f32_16x16x32_bf16 v[120:123], a[196:199], a[152:155], v[120:123]
    ds_read_b64_tr_b16 a[220:221], v238 offset:8960
    v_accvgpr_write_b32 a9, 0
    v_mfma_f32_16x16x32_bf16 v[124:127], a[196:199], a[156:159], v[124:127]
    ds_read_b64_tr_b16 a[222:223], v238 offset:9984
    v_accvgpr_write_b32 a10, 0
    v_mfma_f32_16x16x32_bf16 v[128:131], a[200:203], a[144:147], v[128:131]
    buffer_load_dwordx4 a[128:131], v248, s[8:11], s28 offen offset:0 sc1
    v_accvgpr_write_b32 a11, 0
    v_accvgpr_write_b32 a12, 0
    v_mfma_f32_16x16x32_bf16 v[132:135], a[200:203], a[148:151], v[132:135]
    v_accvgpr_write_b32 a13, 0
    v_accvgpr_write_b32 a14, 0
    v_mfma_f32_16x16x32_bf16 v[136:139], a[200:203], a[152:155], v[136:139]
    buffer_load_dwordx4 a[132:135], v248, s[8:11], s29 offen offset:0 sc1
    v_accvgpr_write_b32 a15, 0
    v_mfma_f32_16x16x32_bf16 v[140:143], a[200:203], a[156:159], v[140:143]
    s_add_u32 m0, s31, 2048
    s_add_u32 s24, s27, 65536
    v_accvgpr_write_b32 a16, 0
    v_mfma_f32_16x16x32_bf16 v[144:147], a[204:207], a[144:147], v[144:147]
    buffer_load_dwordx4 v237, s[12:15], s24 offen lds
    v_accvgpr_write_b32 a17, 0
    v_mfma_f32_16x16x32_bf16 v[148:151], a[204:207], a[148:151], v[148:151]
    v_accvgpr_write_b32 a18, 0
    v_accvgpr_write_b32 a19, 0
    v_accvgpr_write_b32 a20, 0
    v_mfma_f32_16x16x32_bf16 v[152:155], a[204:207], a[152:155], v[152:155]
    buffer_store_dwordx4 v[40:43], v240, s[16:19], s82 offen sc1
    v_accvgpr_write_b32 a21, 0
    v_mfma_f32_16x16x32_bf16 v[156:159], a[204:207], a[156:159], v[156:159]
    v_accvgpr_write_b32 a22, 0
    s_waitcnt lgkmcnt(0)
    v_mfma_f32_16x16x32_bf16 v[160:163], a[208:211], a[144:147], v[160:163]
    ds_read_b64_tr_b16 a[192:193], v246 offset:16384
    v_accvgpr_write_b32 a23, 0
    v_accvgpr_write_b32 a24, 0
    v_mfma_f32_16x16x32_bf16 v[164:167], a[208:211], a[148:151], v[164:167]
    ds_read_b64_tr_b16 a[194:195], v246 offset:17408
    v_accvgpr_write_b32 a25, 0
    v_mfma_f32_16x16x32_bf16 v[168:171], a[208:211], a[152:155], v[168:171]
    ds_read_b64_tr_b16 a[196:197], v238 offset:16384
    v_accvgpr_write_b32 a26, 0
    v_mfma_f32_16x16x32_bf16 v[172:175], a[208:211], a[156:159], v[172:175]
    ds_read_b64_tr_b16 a[198:199], v238 offset:17408
    v_accvgpr_write_b32 a27, 0
    v_accvgpr_write_b32 a28, 0
    v_mfma_f32_16x16x32_bf16 v[176:179], a[212:215], a[144:147], v[176:179]
    ds_read_b64_tr_b16 a[200:201], v246 offset:16640
    v_accvgpr_write_b32 a29, 0
    v_mfma_f32_16x16x32_bf16 v[180:183], a[212:215], a[148:151], v[180:183]
    ds_read_b64_tr_b16 a[202:203], v246 offset:17664
    v_accvgpr_write_b32 a30, 0
    v_accvgpr_write_b32 a31, 0
    v_mfma_f32_16x16x32_bf16 v[184:187], a[212:215], a[152:155], v[184:187]
    ds_read_b64_tr_b16 a[204:205], v238 offset:16640
    v_accvgpr_write_b32 a32, 0
    v_mfma_f32_16x16x32_bf16 v[188:191], a[212:215], a[156:159], v[188:191]
    ds_read_b64_tr_b16 a[206:207], v238 offset:17664
    v_accvgpr_write_b32 a33, 0
    v_mfma_f32_16x16x32_bf16 v[192:195], a[216:219], a[144:147], v[192:195]
    buffer_load_dwordx4 a[136:139], v249, s[8:11], s28 offen offset:0 sc1
    v_accvgpr_write_b32 a34, 0
    v_accvgpr_write_b32 a35, 0
    v_mfma_f32_16x16x32_bf16 v[196:199], a[216:219], a[148:151], v[196:199]
    v_accvgpr_write_b32 a36, 0
    v_accvgpr_write_b32 a37, 0
    v_mfma_f32_16x16x32_bf16 v[200:203], a[216:219], a[152:155], v[200:203]
    buffer_load_dwordx4 a[140:143], v249, s[8:11], s29 offen offset:0 sc1
    v_accvgpr_write_b32 a38, 0
    v_mfma_f32_16x16x32_bf16 v[204:207], a[216:219], a[156:159], v[204:207]
    s_add_u32 m0, s31, 3072
    s_add_u32 s24, s27, 98304
    v_accvgpr_write_b32 a39, 0
    v_mfma_f32_16x16x32_bf16 v[208:211], a[220:223], a[144:147], v[208:211]
    buffer_load_dwordx4 v237, s[12:15], s24 offen lds
    v_accvgpr_write_b32 a40, 0
    v_mfma_f32_16x16x32_bf16 v[212:215], a[220:223], a[148:151], v[212:215]
    v_accvgpr_write_b32 a41, 0
    v_accvgpr_write_b32 a42, 0
    v_accvgpr_write_b32 a43, 0
    v_mfma_f32_16x16x32_bf16 v[216:219], a[220:223], a[152:155], v[216:219]
    buffer_store_dwordx4 v[44:47], v240, s[16:19], s83 offen sc1
    v_accvgpr_write_b32 a44, 0
    v_mfma_f32_16x16x32_bf16 v[220:223], a[220:223], a[156:159], v[220:223]
    v_accvgpr_write_b32 a45, 0
    s_waitcnt vmcnt(16) lgkmcnt(0)
    v_mfma_f32_16x16x32_bf16 v[96:99], a[192:195], a[160:163], v[96:99]
    ds_read_b64_tr_b16 a[208:209], v246 offset:16896
    v_accvgpr_write_b32 a46, 0
    v_accvgpr_write_b32 a47, 0
    v_mfma_f32_16x16x32_bf16 v[100:103], a[192:195], a[164:167], v[100:103]
    ds_read_b64_tr_b16 a[210:211], v246 offset:17920
    v_accvgpr_write_b32 a48, 0
    v_mfma_f32_16x16x32_bf16 v[104:107], a[192:195], a[168:171], v[104:107]
    ds_read_b64_tr_b16 a[212:213], v238 offset:16896
    v_accvgpr_write_b32 a49, 0
    v_accvgpr_write_b32 a50, 0
    v_mfma_f32_16x16x32_bf16 v[108:111], a[192:195], a[172:175], v[108:111]
    ds_read_b64_tr_b16 a[214:215], v238 offset:17920
    v_accvgpr_write_b32 a51, 0
    v_mfma_f32_16x16x32_bf16 v[112:115], a[196:199], a[160:163], v[112:115]
    ds_read_b64_tr_b16 a[216:217], v246 offset:17152
    v_accvgpr_write_b32 a52, 0
    v_mfma_f32_16x16x32_bf16 v[116:119], a[196:199], a[164:167], v[116:119]
    ds_read_b64_tr_b16 a[218:219], v246 offset:18176
    v_accvgpr_write_b32 a53, 0
    v_accvgpr_write_b32 a54, 0
    v_mfma_f32_16x16x32_bf16 v[120:123], a[196:199], a[168:171], v[120:123]
    ds_read_b64_tr_b16 a[220:221], v238 offset:17152
    v_accvgpr_write_b32 a55, 0
    v_mfma_f32_16x16x32_bf16 v[124:127], a[196:199], a[172:175], v[124:127]
    ds_read_b64_tr_b16 a[222:223], v238 offset:18176
    v_accvgpr_write_b32 a56, 0
    v_accvgpr_write_b32 a57, 0
    v_mfma_f32_16x16x32_bf16 v[128:131], a[200:203], a[160:163], v[128:131]
    buffer_load_dwordx4 a[144:147], v248, s[8:11], s28 offen offset:1024 sc1
    v_accvgpr_write_b32 a58, 0
    v_mfma_f32_16x16x32_bf16 v[132:135], a[200:203], a[164:167], v[132:135]
    v_accvgpr_write_b32 a59, 0
    v_accvgpr_write_b32 a60, 0
    v_mfma_f32_16x16x32_bf16 v[136:139], a[200:203], a[168:171], v[136:139]
    buffer_load_dwordx4 a[148:151], v248, s[8:11], s29 offen offset:1024 sc1
    v_accvgpr_write_b32 a61, 0
    v_mfma_f32_16x16x32_bf16 v[140:143], a[200:203], a[172:175], v[140:143]
    s_add_u32 m0, s31, 4096
    s_add_u32 s24, s27, 131072
    v_accvgpr_write_b32 a62, 0
    v_mfma_f32_16x16x32_bf16 v[144:147], a[204:207], a[160:163], v[144:147]
    buffer_load_dwordx4 v245, s[12:15], s24 offen lds
    v_accvgpr_write_b32 a63, 0
    v_mfma_f32_16x16x32_bf16 v[148:151], a[204:207], a[164:167], v[148:151]
    v_accvgpr_write_b32 a64, 0
    v_accvgpr_write_b32 a65, 0
    v_accvgpr_write_b32 a66, 0
    v_mfma_f32_16x16x32_bf16 v[152:155], a[204:207], a[168:171], v[152:155]
    buffer_store_dwordx4 v[48:51], v240, s[16:19], s84 offen sc1
    v_accvgpr_write_b32 a67, 0
    v_mfma_f32_16x16x32_bf16 v[156:159], a[204:207], a[172:175], v[156:159]
    v_accvgpr_write_b32 a68, 0
    s_waitcnt lgkmcnt(0)
    v_mfma_f32_16x16x32_bf16 v[160:163], a[208:211], a[160:163], v[160:163]
    ds_read_b64_tr_b16 a[192:193], v246 offset:24576
    v_accvgpr_write_b32 a69, 0
    v_accvgpr_write_b32 a70, 0
    v_mfma_f32_16x16x32_bf16 v[164:167], a[208:211], a[164:167], v[164:167]
    ds_read_b64_tr_b16 a[194:195], v246 offset:25600
    v_accvgpr_write_b32 a71, 0
    v_mfma_f32_16x16x32_bf16 v[168:171], a[208:211], a[168:171], v[168:171]
    ds_read_b64_tr_b16 a[196:197], v238 offset:24576
    v_accvgpr_write_b32 a72, 0
    v_accvgpr_write_b32 a73, 0
    v_mfma_f32_16x16x32_bf16 v[172:175], a[208:211], a[172:175], v[172:175]
    ds_read_b64_tr_b16 a[198:199], v238 offset:25600
    v_accvgpr_write_b32 a74, 0
    v_mfma_f32_16x16x32_bf16 v[176:179], a[212:215], a[160:163], v[176:179]
    ds_read_b64_tr_b16 a[200:201], v246 offset:24832
    v_accvgpr_write_b32 a75, 0
    v_mfma_f32_16x16x32_bf16 v[180:183], a[212:215], a[164:167], v[180:183]
    ds_read_b64_tr_b16 a[202:203], v246 offset:25856
    v_accvgpr_write_b32 a76, 0
    v_accvgpr_write_b32 a77, 0
    v_mfma_f32_16x16x32_bf16 v[184:187], a[212:215], a[168:171], v[184:187]
    ds_read_b64_tr_b16 a[204:205], v238 offset:24832
    v_accvgpr_write_b32 a78, 0
    v_mfma_f32_16x16x32_bf16 v[188:191], a[212:215], a[172:175], v[188:191]
    ds_read_b64_tr_b16 a[206:207], v238 offset:25856
    v_accvgpr_write_b32 a79, 0
    v_accvgpr_write_b32 a80, 0
    v_mfma_f32_16x16x32_bf16 v[192:195], a[216:219], a[160:163], v[192:195]
    buffer_load_dwordx4 a[152:155], v249, s[8:11], s28 offen offset:1024 sc1
    v_accvgpr_write_b32 a81, 0
    v_mfma_f32_16x16x32_bf16 v[196:199], a[216:219], a[164:167], v[196:199]
    v_accvgpr_write_b32 a82, 0
    v_accvgpr_write_b32 a83, 0
    v_mfma_f32_16x16x32_bf16 v[200:203], a[216:219], a[168:171], v[200:203]
    buffer_load_dwordx4 a[156:159], v249, s[8:11], s29 offen offset:1024 sc1
    v_accvgpr_write_b32 a84, 0
    v_mfma_f32_16x16x32_bf16 v[204:207], a[216:219], a[172:175], v[204:207]
    s_add_u32 m0, s31, 5120
    s_add_u32 s24, s27, 163840
    v_accvgpr_write_b32 a85, 0
    v_mfma_f32_16x16x32_bf16 v[208:211], a[220:223], a[160:163], v[208:211]
    buffer_load_dwordx4 v245, s[12:15], s24 offen lds
    v_accvgpr_write_b32 a86, 0
    v_accvgpr_write_b32 a87, 0
    v_mfma_f32_16x16x32_bf16 v[212:215], a[220:223], a[164:167], v[212:215]
    v_accvgpr_write_b32 a88, 0
    v_accvgpr_write_b32 a89, 0
    v_mfma_f32_16x16x32_bf16 v[216:219], a[220:223], a[168:171], v[216:219]
    s_add_u32 s30, s30, 32768
    buffer_store_dwordx4 v[52:55], v240, s[16:19], s85 offen sc1
    v_mfma_f32_16x16x32_bf16 v[220:223], a[220:223], a[172:175], v[220:223]
    s_cmp_ge_u32 s30, 163840
    s_cselect_b32 s30, 65536, s30
    s_waitcnt vmcnt(18) lgkmcnt(0)
    v_mfma_f32_16x16x32_bf16 v[96:99], a[192:195], a[176:179], v[96:99]
    ds_read_b64_tr_b16 a[208:209], v246 offset:25088
    v_accvgpr_write_b32 a90, 0
    v_accvgpr_write_b32 a91, 0
    v_mfma_f32_16x16x32_bf16 v[100:103], a[192:195], a[180:183], v[100:103]
    ds_read_b64_tr_b16 a[210:211], v246 offset:26112
    v_accvgpr_write_b32 a92, 0
    v_mfma_f32_16x16x32_bf16 v[104:107], a[192:195], a[184:187], v[104:107]
    ds_read_b64_tr_b16 a[212:213], v238 offset:25088
    v_accvgpr_write_b32 a93, 0
    v_mfma_f32_16x16x32_bf16 v[108:111], a[192:195], a[188:191], v[108:111]
    ds_read_b64_tr_b16 a[214:215], v238 offset:26112
    v_accvgpr_write_b32 a94, 0
    v_accvgpr_write_b32 a95, 0
    v_mfma_f32_16x16x32_bf16 v[112:115], a[196:199], a[176:179], v[112:115]
    ds_read_b64_tr_b16 a[216:217], v246 offset:25344
    v_accvgpr_write_b32 a96, 0
    v_mfma_f32_16x16x32_bf16 v[116:119], a[196:199], a[180:183], v[116:119]
    ds_read_b64_tr_b16 a[218:219], v246 offset:26368
    v_accvgpr_write_b32 a97, 0
    v_accvgpr_write_b32 a98, 0
    v_mfma_f32_16x16x32_bf16 v[120:123], a[196:199], a[184:187], v[120:123]
    ds_read_b64_tr_b16 a[220:221], v238 offset:25344
    v_accvgpr_write_b32 a99, 0
    v_mfma_f32_16x16x32_bf16 v[124:127], a[196:199], a[188:191], v[124:127]
    ds_read_b64_tr_b16 a[222:223], v238 offset:26368
    v_accvgpr_write_b32 a100, 0
    v_mfma_f32_16x16x32_bf16 v[128:131], a[200:203], a[176:179], v[128:131]
    buffer_load_dwordx4 a[160:163], v248, s[8:11], s28 offen offset:2048 sc1
    v_accvgpr_write_b32 a101, 0
    v_accvgpr_write_b32 a102, 0
    v_mfma_f32_16x16x32_bf16 v[132:135], a[200:203], a[180:183], v[132:135]
    v_accvgpr_write_b32 a103, 0
    v_accvgpr_write_b32 a104, 0
    v_mfma_f32_16x16x32_bf16 v[136:139], a[200:203], a[184:187], v[136:139]
    buffer_load_dwordx4 a[164:167], v248, s[8:11], s29 offen offset:2048 sc1
    v_accvgpr_write_b32 a105, 0
    v_mfma_f32_16x16x32_bf16 v[140:143], a[200:203], a[188:191], v[140:143]
    s_add_u32 m0, s31, 6144
    s_add_u32 s24, s27, 196608
    v_accvgpr_write_b32 a106, 0
    v_mfma_f32_16x16x32_bf16 v[144:147], a[204:207], a[176:179], v[144:147]
    buffer_load_dwordx4 v237, s[12:15], s24 offen lds
    v_accvgpr_write_b32 a107, 0
    v_mfma_f32_16x16x32_bf16 v[148:151], a[204:207], a[180:183], v[148:151]
    v_accvgpr_write_b32 a108, 0
    v_accvgpr_write_b32 a109, 0
    v_accvgpr_write_b32 a110, 0
    v_mfma_f32_16x16x32_bf16 v[152:155], a[204:207], a[184:187], v[152:155]
    buffer_store_dwordx4 v[56:59], v240, s[16:19], s86 offen sc1
    v_accvgpr_write_b32 a111, 0
    v_mfma_f32_16x16x32_bf16 v[156:159], a[204:207], a[188:191], v[156:159]
    s_waitcnt vmcnt(49) lgkmcnt(0)
    s_barrier
    v_add_u32 v246, s30, v247
    v_mfma_f32_16x16x32_bf16 v[160:163], a[208:211], a[176:179], v[160:163]
    v_xor_b32_e64 v238, 16, v246
    ds_read_b64_tr_b16 a[192:193], v246 offset:0
    v_accvgpr_write_b32 a112, 0
    v_mfma_f32_16x16x32_bf16 v[164:167], a[208:211], a[180:183], v[164:167]
    ds_read_b64_tr_b16 a[194:195], v246 offset:1024
    v_accvgpr_write_b32 a113, 0
    v_mfma_f32_16x16x32_bf16 v[168:171], a[208:211], a[184:187], v[168:171]
    ds_read_b64_tr_b16 a[196:197], v238 offset:0
    v_accvgpr_write_b32 a114, 0
    v_mfma_f32_16x16x32_bf16 v[172:175], a[208:211], a[188:191], v[172:175]
    ds_read_b64_tr_b16 a[198:199], v238 offset:1024
    v_accvgpr_write_b32 a115, 0
    v_accvgpr_write_b32 a116, 0
    v_mfma_f32_16x16x32_bf16 v[176:179], a[212:215], a[176:179], v[176:179]
    ds_read_b64_tr_b16 a[200:201], v246 offset:256
    v_accvgpr_write_b32 a117, 0
    v_mfma_f32_16x16x32_bf16 v[180:183], a[212:215], a[180:183], v[180:183]
    ds_read_b64_tr_b16 a[202:203], v246 offset:1280
    v_accvgpr_write_b32 a118, 0
    v_accvgpr_write_b32 a119, 0
    v_mfma_f32_16x16x32_bf16 v[184:187], a[212:215], a[184:187], v[184:187]
    ds_read_b64_tr_b16 a[204:205], v238 offset:256
    buffer_store_dwordx4 v[60:63], v240, s[16:19], s87 offen sc1
    v_mfma_f32_16x16x32_bf16 v[188:191], a[212:215], a[188:191], v[188:191]
    ds_read_b64_tr_b16 a[206:207], v238 offset:1280
    v_accvgpr_write_b32 a120, 0
    v_accvgpr_write_b32 a121, 0
    v_mfma_f32_16x16x32_bf16 v[192:195], a[216:219], a[176:179], v[192:195]
    buffer_load_dwordx4 a[168:171], v249, s[8:11], s28 offen offset:2048 sc1
    v_accvgpr_write_b32 a122, 0
    v_mfma_f32_16x16x32_bf16 v[196:199], a[216:219], a[180:183], v[196:199]
    s_lshl2_add_u32 s80, s2, s3
    s_mul_i32 s80, s80, 12288
    s_add_u32 s80, s80, 0x1000000
    v_mov_b32 v0, -1
    v_mov_b32 v1, -1
    v_mov_b32 v2, -1
    v_mov_b32_e64 v3, -1
    v_mfma_f32_16x16x32_bf16 v[200:203], a[216:219], a[184:187], v[200:203]
    buffer_load_dwordx4 a[172:175], v249, s[8:11], s29 offen offset:2048 sc1
    v_accvgpr_write_b32 a123, 0
    v_accvgpr_write_b32 a124, 0
    v_mfma_f32_16x16x32_bf16 v[204:207], a[216:219], a[188:191], v[204:207]
    s_add_u32 m0, s31, 7168
    s_add_u32 s24, s27, 229376
    v_mfma_f32_16x16x32_bf16 v[208:211], a[220:223], a[176:179], v[208:211]
    buffer_load_dwordx4 v237, s[12:15], s24 offen lds
    v_accvgpr_write_b32 a125, 0
    v_accvgpr_write_b32 a126, 0
    v_mfma_f32_16x16x32_bf16 v[212:215], a[220:223], a[180:183], v[212:215]
    s_add_u32 s27, s27, 1048576
    s_and_b32 s27, s27, 0x407fffff
    v_mfma_f32_16x16x32_bf16 v[216:219], a[220:223], a[184:187], v[216:219]
    s_cmp_eq_u32 s27, s7
    s_cselect_b32 s27, s43, s27
    v_accvgpr_write_b32 a127, 0
    v_mfma_f32_16x16x32_bf16 v[220:223], a[220:223], a[188:191], v[220:223]
    s_add_u32 s31, s31, 32768
    s_cmp_ge_u32 s31, 163840
    s_cselect_b32 s24, 98304, 0
    s_sub_u32 s31, s31, s24
.p2align 3
ka_qp:
    s_waitcnt vmcnt(15) lgkmcnt(0)
    v_mfma_f32_16x16x32_bf16 v[96:99], a[192:195], a[128:131], v[96:99]
    ds_read_b64_tr_b16 a[208:209], v246 offset:512
    v_mfma_f32_16x16x32_bf16 v[100:103], a[192:195], a[132:135], v[100:103]
    ds_read_b64_tr_b16 a[210:211], v246 offset:1536
    v_mfma_f32_16x16x32_bf16 v[104:107], a[192:195], a[136:139], v[104:107]
    ds_read_b64_tr_b16 a[212:213], v238 offset:512
    v_mfma_f32_16x16x32_bf16 v[108:111], a[192:195], a[140:143], v[108:111]
    ds_read_b64_tr_b16 a[214:215], v238 offset:1536
    v_mfma_f32_16x16x32_bf16 v[112:115], a[196:199], a[128:131], v[112:115]
    ds_read_b64_tr_b16 a[216:217], v246 offset:768
    v_mfma_f32_16x16x32_bf16 v[116:119], a[196:199], a[132:135], v[116:119]
    ds_read_b64_tr_b16 a[218:219], v246 offset:1792
    v_mfma_f32_16x16x32_bf16 v[120:123], a[196:199], a[136:139], v[120:123]
    ds_read_b64_tr_b16 a[220:221], v238 offset:768
    v_mfma_f32_16x16x32_bf16 v[124:127], a[196:199], a[140:143], v[124:127]
    ds_read_b64_tr_b16 a[222:223], v238 offset:1792
    v_mfma_f32_16x16x32_bf16 v[128:131], a[200:203], a[128:131], v[128:131]
    buffer_load_dwordx4 a[176:179], v248, s[8:11], s28 offen offset:3072 sc1
    s_cmp_eq_u32 s26, 1
    s_cselect_b32 s41, s35, s43
    buffer_load_dword v254, off, s[88:91], s41 sc1
    v_mfma_f32_16x16x32_bf16 v[132:135], a[200:203], a[132:135], v[132:135]
    v_mfma_f32_16x16x32_bf16 v[136:139], a[200:203], a[136:139], v[136:139]
    buffer_load_dwordx4 a[180:183], v248, s[8:11], s29 offen offset:3072 sc1
    v_mfma_f32_16x16x32_bf16 v[140:143], a[200:203], a[140:143], v[140:143]
    s_add_u32 m0, s31, 0
    s_add_u32 s24, s27, 0
    v_mfma_f32_16x16x32_bf16 v[144:147], a[204:207], a[128:131], v[144:147]
    buffer_load_dwordx4 v245, s[12:15], s24 offen lds
    v_mfma_f32_16x16x32_bf16 v[148:151], a[204:207], a[132:135], v[148:151]
    v_mfma_f32_16x16x32_bf16 v[152:155], a[204:207], a[136:139], v[152:155]
    v_mfma_f32_16x16x32_bf16 v[156:159], a[204:207], a[140:143], v[156:159]
    s_waitcnt lgkmcnt(0)
    v_mfma_f32_16x16x32_bf16 v[160:163], a[208:211], a[128:131], v[160:163]
    ds_read_b64_tr_b16 a[192:193], v246 offset:8192
    v_mfma_f32_16x16x32_bf16 v[164:167], a[208:211], a[132:135], v[164:167]
    ds_read_b64_tr_b16 a[194:195], v246 offset:9216
    v_mfma_f32_16x16x32_bf16 v[168:171], a[208:211], a[136:139], v[168:171]
    ds_read_b64_tr_b16 a[196:197], v238 offset:8192
    v_mfma_f32_16x16x32_bf16 v[172:175], a[208:211], a[140:143], v[172:175]
    ds_read_b64_tr_b16 a[198:199], v238 offset:9216
    v_mfma_f32_16x16x32_bf16 v[176:179], a[212:215], a[128:131], v[176:179]
    ds_read_b64_tr_b16 a[200:201], v246 offset:8448
    v_mfma_f32_16x16x32_bf16 v[180:183], a[212:215], a[132:135], v[180:183]
    ds_read_b64_tr_b16 a[202:203], v246 offset:9472
    v_mfma_f32_16x16x32_bf16 v[184:187], a[212:215], a[136:139], v[184:187]
    ds_read_b64_tr_b16 a[204:205], v238 offset:8448
    v_mfma_f32_16x16x32_bf16 v[188:191], a[212:215], a[140:143], v[188:191]
    ds_read_b64_tr_b16 a[206:207], v238 offset:9472
    v_mfma_f32_16x16x32_bf16 v[192:195], a[216:219], a[128:131], v[192:195]
    buffer_load_dwordx4 a[184:187], v249, s[8:11], s28 offen offset:3072 sc1
    v_mfma_f32_16x16x32_bf16 v[196:199], a[216:219], a[132:135], v[196:199]
    v_mfma_f32_16x16x32_bf16 v[200:203], a[216:219], a[136:139], v[200:203]
    buffer_load_dwordx4 a[188:191], v249, s[8:11], s29 offen offset:3072 sc1
    v_mfma_f32_16x16x32_bf16 v[204:207], a[216:219], a[140:143], v[204:207]
    s_add_u32 m0, s31, 1024
    s_add_u32 s24, s27, 32768
    v_mfma_f32_16x16x32_bf16 v[208:211], a[220:223], a[128:131], v[208:211]
    buffer_load_dwordx4 v245, s[12:15], s24 offen lds
    v_mfma_f32_16x16x32_bf16 v[212:215], a[220:223], a[132:135], v[212:215]
    v_mfma_f32_16x16x32_bf16 v[216:219], a[220:223], a[136:139], v[216:219]
    s_add_u32 s28, s28, 4096
    s_and_b32 s28, s28, 32767
    v_mfma_f32_16x16x32_bf16 v[220:223], a[220:223], a[140:143], v[220:223]
    s_add_u32 s29, s28, 32768
    s_waitcnt vmcnt(16) lgkmcnt(0)
    v_mfma_f32_16x16x32_bf16 v[96:99], a[192:195], a[144:147], v[96:99]
    ds_read_b64_tr_b16 a[208:209], v246 offset:8704
    v_mfma_f32_16x16x32_bf16 v[100:103], a[192:195], a[148:151], v[100:103]
    ds_read_b64_tr_b16 a[210:211], v246 offset:9728
    v_mfma_f32_16x16x32_bf16 v[104:107], a[192:195], a[152:155], v[104:107]
    ds_read_b64_tr_b16 a[212:213], v238 offset:8704
    v_mfma_f32_16x16x32_bf16 v[108:111], a[192:195], a[156:159], v[108:111]
    ds_read_b64_tr_b16 a[214:215], v238 offset:9728
    v_mfma_f32_16x16x32_bf16 v[112:115], a[196:199], a[144:147], v[112:115]
    ds_read_b64_tr_b16 a[216:217], v246 offset:8960
    v_mfma_f32_16x16x32_bf16 v[116:119], a[196:199], a[148:151], v[116:119]
    ds_read_b64_tr_b16 a[218:219], v246 offset:9984
    v_mfma_f32_16x16x32_bf16 v[120:123], a[196:199], a[152:155], v[120:123]
    ds_read_b64_tr_b16 a[220:221], v238 offset:8960
    v_mfma_f32_16x16x32_bf16 v[124:127], a[196:199], a[156:159], v[124:127]
    ds_read_b64_tr_b16 a[222:223], v238 offset:9984
    v_mfma_f32_16x16x32_bf16 v[128:131], a[200:203], a[144:147], v[128:131]
    buffer_load_dwordx4 a[128:131], v248, s[8:11], s28 offen offset:0 sc1
    v_mfma_f32_16x16x32_bf16 v[132:135], a[200:203], a[148:151], v[132:135]
    v_mfma_f32_16x16x32_bf16 v[136:139], a[200:203], a[152:155], v[136:139]
    buffer_load_dwordx4 a[132:135], v248, s[8:11], s29 offen offset:0 sc1
    v_mfma_f32_16x16x32_bf16 v[140:143], a[200:203], a[156:159], v[140:143]
    s_add_u32 m0, s31, 2048
    s_add_u32 s24, s27, 65536
    v_mfma_f32_16x16x32_bf16 v[144:147], a[204:207], a[144:147], v[144:147]
    buffer_load_dwordx4 v237, s[12:15], s24 offen lds
    v_mfma_f32_16x16x32_bf16 v[148:151], a[204:207], a[148:151], v[148:151]
    buffer_store_dwordx4 v[0:3], v240, s[48:51], s80 offen sc1
    s_add_u32 s80, s80, 1024
    v_mfma_f32_16x16x32_bf16 v[152:155], a[204:207], a[152:155], v[152:155]
    v_mfma_f32_16x16x32_bf16 v[156:159], a[204:207], a[156:159], v[156:159]
    s_waitcnt lgkmcnt(0)
    v_mfma_f32_16x16x32_bf16 v[160:163], a[208:211], a[144:147], v[160:163]
    ds_read_b64_tr_b16 a[192:193], v246 offset:16384
    v_mfma_f32_16x16x32_bf16 v[164:167], a[208:211], a[148:151], v[164:167]
    ds_read_b64_tr_b16 a[194:195], v246 offset:17408
    v_mfma_f32_16x16x32_bf16 v[168:171], a[208:211], a[152:155], v[168:171]
    ds_read_b64_tr_b16 a[196:197], v238 offset:16384
    v_mfma_f32_16x16x32_bf16 v[172:175], a[208:211], a[156:159], v[172:175]
    ds_read_b64_tr_b16 a[198:199], v238 offset:17408
    v_mfma_f32_16x16x32_bf16 v[176:179], a[212:215], a[144:147], v[176:179]
    ds_read_b64_tr_b16 a[200:201], v246 offset:16640
    v_mfma_f32_16x16x32_bf16 v[180:183], a[212:215], a[148:151], v[180:183]
    ds_read_b64_tr_b16 a[202:203], v246 offset:17664
    v_mfma_f32_16x16x32_bf16 v[184:187], a[212:215], a[152:155], v[184:187]
    ds_read_b64_tr_b16 a[204:205], v238 offset:16640
    v_mfma_f32_16x16x32_bf16 v[188:191], a[212:215], a[156:159], v[188:191]
    ds_read_b64_tr_b16 a[206:207], v238 offset:17664
    v_mfma_f32_16x16x32_bf16 v[192:195], a[216:219], a[144:147], v[192:195]
    buffer_load_dwordx4 a[136:139], v249, s[8:11], s28 offen offset:0 sc1
    v_mfma_f32_16x16x32_bf16 v[196:199], a[216:219], a[148:151], v[196:199]
    v_mfma_f32_16x16x32_bf16 v[200:203], a[216:219], a[152:155], v[200:203]
    buffer_load_dwordx4 a[140:143], v249, s[8:11], s29 offen offset:0 sc1
    v_mfma_f32_16x16x32_bf16 v[204:207], a[216:219], a[156:159], v[204:207]
    s_add_u32 m0, s31, 3072
    s_add_u32 s24, s27, 98304
    v_mfma_f32_16x16x32_bf16 v[208:211], a[220:223], a[144:147], v[208:211]
    buffer_load_dwordx4 v237, s[12:15], s24 offen lds
    v_mfma_f32_16x16x32_bf16 v[212:215], a[220:223], a[148:151], v[212:215]
    v_mfma_f32_16x16x32_bf16 v[216:219], a[220:223], a[152:155], v[216:219]
    v_mfma_f32_16x16x32_bf16 v[220:223], a[220:223], a[156:159], v[220:223]
    s_waitcnt vmcnt(15) lgkmcnt(0)
    v_mfma_f32_16x16x32_bf16 v[96:99], a[192:195], a[160:163], v[96:99]
    ds_read_b64_tr_b16 a[208:209], v246 offset:16896
    v_mfma_f32_16x16x32_bf16 v[100:103], a[192:195], a[164:167], v[100:103]
    ds_read_b64_tr_b16 a[210:211], v246 offset:17920
    v_mfma_f32_16x16x32_bf16 v[104:107], a[192:195], a[168:171], v[104:107]
    ds_read_b64_tr_b16 a[212:213], v238 offset:16896
    v_mfma_f32_16x16x32_bf16 v[108:111], a[192:195], a[172:175], v[108:111]
    ds_read_b64_tr_b16 a[214:215], v238 offset:17920
    v_mfma_f32_16x16x32_bf16 v[112:115], a[196:199], a[160:163], v[112:115]
    ds_read_b64_tr_b16 a[216:217], v246 offset:17152
    v_mfma_f32_16x16x32_bf16 v[116:119], a[196:199], a[164:167], v[116:119]
    ds_read_b64_tr_b16 a[218:219], v246 offset:18176
    v_mfma_f32_16x16x32_bf16 v[120:123], a[196:199], a[168:171], v[120:123]
    ds_read_b64_tr_b16 a[220:221], v238 offset:17152
    v_mfma_f32_16x16x32_bf16 v[124:127], a[196:199], a[172:175], v[124:127]
    ds_read_b64_tr_b16 a[222:223], v238 offset:18176
    v_mfma_f32_16x16x32_bf16 v[128:131], a[200:203], a[160:163], v[128:131]
    buffer_load_dwordx4 a[144:147], v248, s[8:11], s28 offen offset:1024 sc1
    v_mfma_f32_16x16x32_bf16 v[132:135], a[200:203], a[164:167], v[132:135]
    v_mfma_f32_16x16x32_bf16 v[136:139], a[200:203], a[168:171], v[136:139]
    buffer_load_dwordx4 a[148:151], v248, s[8:11], s29 offen offset:1024 sc1
    v_mfma_f32_16x16x32_bf16 v[140:143], a[200:203], a[172:175], v[140:143]
    s_add_u32 m0, s31, 4096
    s_add_u32 s24, s27, 131072
    v_mfma_f32_16x16x32_bf16 v[144:147], a[204:207], a[160:163], v[144:147]
    buffer_load_dwordx4 v245, s[12:15], s24 offen lds
    v_mfma_f32_16x16x32_bf16 v[148:151], a[204:207], a[164:167], v[148:151]
    v_mfma_f32_16x16x32_bf16 v[152:155], a[204:207], a[168:171], v[152:155]
    v_mfma_f32_16x16x32_bf16 v[156:159], a[204:207], a[172:175], v[156:159]
    s_waitcnt lgkmcnt(0)
    v_mfma_f32_16x16x32_bf16 v[160:163], a[208:211], a[160:163], v[160:163]
    ds_read_b64_tr_b16 a[192:193], v246 offset:24576
    v_mfma_f32_16x16x32_bf16 v[164:167], a[208:211], a[164:167], v[164:167]
    ds_read_b64_tr_b16 a[194:195], v246 offset:25600
    v_mfma_f32_16x16x32_bf16 v[168:171], a[208:211], a[168:171], v[168:171]
    ds_read_b64_tr_b16 a[196:197], v238 offset:24576
    v_mfma_f32_16x16x32_bf16 v[172:175], a[208:211], a[172:175], v[172:175]
    ds_read_b64_tr_b16 a[198:199], v238 offset:25600
    v_mfma_f32_16x16x32_bf16 v[176:179], a[212:215], a[160:163], v[176:179]
    ds_read_b64_tr_b16 a[200:201], v246 offset:24832
    v_mfma_f32_16x16x32_bf16 v[180:183], a[212:215], a[164:167], v[180:183]
    ds_read_b64_tr_b16 a[202:203], v246 offset:25856
    v_mfma_f32_16x16x32_bf16 v[184:187], a[212:215], a[168:171], v[184:187]
    ds_read_b64_tr_b16 a[204:205], v238 offset:24832
    v_mfma_f32_16x16x32_bf16 v[188:191], a[212:215], a[172:175], v[188:191]
    ds_read_b64_tr_b16 a[206:207], v238 offset:25856
    v_mfma_f32_16x16x32_bf16 v[192:195], a[216:219], a[160:163], v[192:195]
    buffer_load_dwordx4 a[152:155], v249, s[8:11], s28 offen offset:1024 sc1
    v_mfma_f32_16x16x32_bf16 v[196:199], a[216:219], a[164:167], v[196:199]
    v_mfma_f32_16x16x32_bf16 v[200:203], a[216:219], a[168:171], v[200:203]
    buffer_load_dwordx4 a[156:159], v249, s[8:11], s29 offen offset:1024 sc1
    v_mfma_f32_16x16x32_bf16 v[204:207], a[216:219], a[172:175], v[204:207]
    s_add_u32 m0, s31, 5120
    s_add_u32 s24, s27, 163840
    v_mfma_f32_16x16x32_bf16 v[208:211], a[220:223], a[160:163], v[208:211]
    buffer_load_dwordx4 v245, s[12:15], s24 offen lds
    v_mfma_f32_16x16x32_bf16 v[212:215], a[220:223], a[164:167], v[212:215]
    buffer_store_dwordx4 v[0:3], v240, s[48:51], s80 offen sc1
    s_add_u32 s80, s80, 1024
    v_mfma_f32_16x16x32_bf16 v[216:219], a[220:223], a[168:171], v[216:219]
    s_add_u32 s30, s30, 32768
    v_mfma_f32_16x16x32_bf16 v[220:223], a[220:223], a[172:175], v[220:223]
    s_cmp_ge_u32 s30, 163840
    s_cselect_b32 s30, 65536, s30
    s_waitcnt vmcnt(15) lgkmcnt(0)
    v_mfma_f32_16x16x32_bf16 v[96:99], a[192:195], a[176:179], v[96:99]
    ds_read_b64_tr_b16 a[208:209], v246 offset:25088
    v_mfma_f32_16x16x32_bf16 v[100:103], a[192:195], a[180:183], v[100:103]
    ds_read_b64_tr_b16 a[210:211], v246 offset:26112
    v_mfma_f32_16x16x32_bf16 v[104:107], a[192:195], a[184:187], v[104:107]
    ds_read_b64_tr_b16 a[212:213], v238 offset:25088
    v_mfma_f32_16x16x32_bf16 v[108:111], a[192:195], a[188:191], v[108:111]
    ds_read_b64_tr_b16 a[214:215], v238 offset:26112
    v_mfma_f32_16x16x32_bf16 v[112:115], a[196:199], a[176:179], v[112:115]
    ds_read_b64_tr_b16 a[216:217], v246 offset:25344
    v_mfma_f32_16x16x32_bf16 v[116:119], a[196:199], a[180:183], v[116:119]
    ds_read_b64_tr_b16 a[218:219], v246 offset:26368
    v_mfma_f32_16x16x32_bf16 v[120:123], a[196:199], a[184:187], v[120:123]
    ds_read_b64_tr_b16 a[220:221], v238 offset:25344
    v_mfma_f32_16x16x32_bf16 v[124:127], a[196:199], a[188:191], v[124:127]
    ds_read_b64_tr_b16 a[222:223], v238 offset:26368
    v_mfma_f32_16x16x32_bf16 v[128:131], a[200:203], a[176:179], v[128:131]
    buffer_load_dwordx4 a[160:163], v248, s[8:11], s28 offen offset:2048 sc1
    v_mfma_f32_16x16x32_bf16 v[132:135], a[200:203], a[180:183], v[132:135]
    v_mfma_f32_16x16x32_bf16 v[136:139], a[200:203], a[184:187], v[136:139]
    buffer_load_dwordx4 a[164:167], v248, s[8:11], s29 offen offset:2048 sc1
    v_mfma_f32_16x16x32_bf16 v[140:143], a[200:203], a[188:191], v[140:143]
    s_add_u32 m0, s31, 6144
    s_add_u32 s24, s27, 196608
    v_mfma_f32_16x16x32_bf16 v[144:147], a[204:207], a[176:179], v[144:147]
    buffer_load_dwordx4 v237, s[12:15], s24 offen lds
    v_mfma_f32_16x16x32_bf16 v[148:151], a[204:207], a[180:183], v[148:151]
    v_mfma_f32_16x16x32_bf16 v[152:155], a[204:207], a[184:187], v[152:155]
    s_cmp_eq_u32 s26, 1
    s_cbranch_scc0 ka_nopk
    s_waitcnt vmcnt(22)
    v_readfirstlane_b32 s24, v254
    s_lshl_b32 s25, s3, 16
    s_add_u32 s24, s24, s25
    s_cmp_ge_u32 s24, 8
    s_cbranch_scc0 kf_spin39
kf_spinr40:
ka_nopk:
    v_mfma_f32_16x16x32_bf16 v[156:159], a[204:207], a[188:191], v[156:159]
    s_waitcnt vmcnt(24) lgkmcnt(0)
    s_barrier
    v_add_u32 v246, s30, v247
    v_mfma_f32_16x16x32_bf16 v[160:163], a[208:211], a[176:179], v[160:163]
    v_xor_b32_e64 v238, 16, v246
    ds_read_b64_tr_b16 a[192:193], v246 offset:0
    v_mfma_f32_16x16x32_bf16 v[164:167], a[208:211], a[180:183], v[164:167]
    ds_read_b64_tr_b16 a[194:195], v246 offset:1024
    v_mfma_f32_16x16x32_bf16 v[168:171], a[208:211], a[184:187], v[168:171]
    ds_read_b64_tr_b16 a[196:197], v238 offset:0
    v_mfma_f32_16x16x32_bf16 v[172:175], a[208:211], a[188:191], v[172:175]
    ds_read_b64_tr_b16 a[198:199], v238 offset:1024
    v_mfma_f32_16x16x32_bf16 v[176:179], a[212:215], a[176:179], v[176:179]
    ds_read_b64_tr_b16 a[200:201], v246 offset:256
    v_mfma_f32_16x16x32_bf16 v[180:183], a[212:215], a[180:183], v[180:183]
    ds_read_b64_tr_b16 a[202:203], v246 offset:1280
    v_mfma_f32_16x16x32_bf16 v[184:187], a[212:215], a[184:187], v[184:187]
    ds_read_b64_tr_b16 a[204:205], v238 offset:256
    buffer_atomic_add v255, v250, s[88:91], s97 offen sc1
    s_mov_b32 s97, s43
    v_mfma_f32_16x16x32_bf16 v[188:191], a[212:215], a[188:191], v[188:191]
    ds_read_b64_tr_b16 a[206:207], v238 offset:1280
    v_mfma_f32_16x16x32_bf16 v[192:195], a[216:219], a[176:179], v[192:195]
    buffer_load_dwordx4 a[168:171], v249, s[8:11], s28 offen offset:2048 sc1
    v_mfma_f32_16x16x32_bf16 v[196:199], a[216:219], a[180:183], v[196:199]
    v_mfma_f32_16x16x32_bf16 v[200:203], a[216:219], a[184:187], v[200:203]
    buffer_load_dwordx4 a[172:175], v249, s[8:11], s29 offen offset:2048 sc1
    v_mfma_f32_16x16x32_bf16 v[204:207], a[216:219], a[188:191], v[204:207]
    s_add_u32 m0, s31, 7168
    s_add_u32 s24, s27, 229376
    v_mfma_f32_16x16x32_bf16 v[208:211], a[220:223], a[176:179], v[208:211]
    buffer_load_dwordx4 v237, s[12:15], s24 offen lds
    v_mfma_f32_16x16x32_bf16 v[212:215], a[220:223], a[180:183], v[212:215]
    s_add_u32 s27, s27, 1048576
    s_and_b32 s27, s27, 0x407fffff
    v_mfma_f32_16x16x32_bf16 v[216:219], a[220:223], a[184:187], v[216:219]
    s_cmp_eq_u32 s27, s7
    s_cselect_b32 s27, s43, s27
    v_mfma_f32_16x16x32_bf16 v[220:223], a[220:223], a[188:191], v[220:223]
    s_add_u32 s31, s31, 32768
    s_cmp_ge_u32 s31, 163840
    s_cselect_b32 s24, 98304, 0
    s_sub_u32 s31, s31, s24
    s_sub_u32 s26, s26, 1
    s_cmp_lg_u32 s26, 0
    s_cbranch_scc1 ka_qp
    s_waitcnt vmcnt(15) lgkmcnt(0)
    v_mfma_f32_16x16x32_bf16 v[96:99], a[192:195], a[128:131], v[96:99]
    ds_read_b64_tr_b16 a[208:209], v246 offset:512
    s_sub_u32 s42, s32, 17664
    v_mfma_f32_16x16x32_bf16 v[100:103], a[192:195], a[132:135], v[100:103]
    ds_read_b64_tr_b16 a[210:211], v246 offset:1536
    v_mfma_f32_16x16x32_bf16 v[104:107], a[192:195], a[136:139], v[104:107]
    ds_read_b64_tr_b16 a[212:213], v238 offset:512
    s_mov_b32 m0, s34
    s_add_u32 s41, s42, 17664
    v_mfma_f32_16x16x32_bf16 v[108:111], a[192:195], a[140:143], v[108:111]
    ds_read_b64_tr_b16 a[214:215], v238 offset:1536
    v_mfma_f32_16x16x32_bf16 v[112:115], a[196:199], a[128:131], v[112:115]
    ds_read_b64_tr_b16 a[216:217], v246 offset:768
    v_mfma_f32_16x16x32_bf16 v[116:119], a[196:199], a[132:135], v[116:119]
    ds_read_b64_tr_b16 a[218:219], v246 offset:1792
    buffer_load_dwordx4 v242, s[16:19], s41 offen offset:0 sc1 lds
    v_mfma_f32_16x16x32_bf16 v[120:123], a[196:199], a[136:139], v[120:123]
    ds_read_b64_tr_b16 a[220:221], v238 offset:768
    v_mfma_f32_16x16x32_bf16 v[124:127], a[196:199], a[140:143], v[124:127]
    ds_read_b64_tr_b16 a[222:223], v238 offset:1792
    v_mfma_f32_16x16x32_bf16 v[128:131], a[200:203], a[128:131], v[128:131]
    buffer_load_dwordx4 a[176:179], v248, s[8:11], s28 offen offset:3072 sc1
    buffer_load_dwordx4 v242, s[16:19], s41 offen offset:1024 sc1 lds
    v_mfma_f32_16x16x32_bf16 v[132:135], a[200:203], a[132:135], v[132:135]
    v_mfma_f32_16x16x32_bf16 v[136:139], a[200:203], a[136:139], v[136:139]
    buffer_load_dwordx4 a[180:183], v248, s[8:11], s29 offen offset:3072 sc1
    v_mfma_f32_16x16x32_bf16 v[140:143], a[200:203], a[140:143], v[140:143]
    buffer_load_dwordx4 v242, s[16:19], s41 offen offset:2048 sc1 lds
    v_mfma_f32_16x16x32_bf16 v[144:147], a[204:207], a[128:131], v[144:147]
    v_mfma_f32_16x16x32_bf16 v[148:151], a[204:207], a[132:135], v[148:151]
    v_mfma_f32_16x16x32_bf16 v[152:155], a[204:207], a[136:139], v[152:155]
    buffer_load_dwordx4 v242, s[16:19], s41 offen offset:3072 sc1 lds
    v_mfma_f32_16x16x32_bf16 v[156:159], a[204:207], a[140:143], v[156:159]
    s_waitcnt lgkmcnt(0)
    v_mfma_f32_16x16x32_bf16 v[160:163], a[208:211], a[128:131], v[160:163]
    ds_read_b64_tr_b16 a[192:193], v246 offset:8192
    v_mfma_f32_16x16x32_bf16 v[164:167], a[208:211], a[132:135], v[164:167]
    ds_read_b64_tr_b16 a[194:195], v246 offset:9216
    v_mfma_f32_16x16x32_bf16 v[168:171], a[208:211], a[136:139], v[168:171]
    ds_read_b64_tr_b16 a[196:197], v238 offset:8192
    s_add_u32 s34, s34, 32768
    s_cmp_ge_u32 s34, 163840
    s_cselect_b32 s34, s37, s34
    s_add_u32 s42, s42, 34048
    v_mfma_f32_16x16x32_bf16 v[172:175], a[208:211], a[140:143], v[172:175]
    ds_read_b64_tr_b16 a[198:199], v238 offset:9216
    v_mfma_f32_16x16x32_bf16 v[176:179], a[212:215], a[128:131], v[176:179]
    ds_read_b64_tr_b16 a[200:201], v246 offset:8448
    v_mfma_f32_16x16x32_bf16 v[180:183], a[212:215], a[132:135], v[180:183]
    ds_read_b64_tr_b16 a[202:203], v246 offset:9472
    s_mov_b32 m0, s34
    s_add_u32 s41, s42, 17664
    v_mfma_f32_16x16x32_bf16 v[184:187], a[212:215], a[136:139], v[184:187]
    ds_read_b64_tr_b16 a[204:205], v238 offset:8448
    v_mfma_f32_16x16x32_bf16 v[188:191], a[212:215], a[140:143], v[188:191]
    ds_read_b64_tr_b16 a[206:207], v238 offset:9472
    v_mfma_f32_16x16x32_bf16 v[192:195], a[216:219], a[128:131], v[192:195]
    buffer_load_dwordx4 a[184:187], v249, s[8:11], s28 offen offset:3072 sc1
    buffer_load_dwordx4 v242, s[16:19], s41 offen offset:0 sc1 lds
    v_mfma_f32_16x16x32_bf16 v[196:199], a[216:219], a[132:135], v[196:199]
    v_mfma_f32_16x16x32_bf16 v[200:203], a[216:219], a[136:139], v[200:203]
    buffer_load_dwordx4 a[188:191], v249, s[8:11], s29 offen offset:3072 sc1
    v_mfma_f32_16x16x32_bf16 v[204:207], a[216:219], a[140:143], v[204:207]
    buffer_load_dwordx4 v242, s[16:19], s41 offen offset:1024 sc1 lds
    v_mfma_f32_16x16x32_bf16 v[208:211], a[220:223], a[128:131], v[208:211]
    v_mfma_f32_16x16x32_bf16 v[212:215], a[220:223], a[132:135], v[212:215]
    v_mfma_f32_16x16x32_bf16 v[216:219], a[220:223], a[136:139], v[216:219]
    s_add_u32 s28, s28, 4096
    s_and_b32 s28, s28, 32767
    v_mfma_f32_16x16x32_bf16 v[220:223], a[220:223], a[140:143], v[220:223]
    s_add_u32 s29, s28, 32768
    buffer_load_dwordx4 v242, s[16:19], s41 offen offset:2048 sc1 lds
    s_waitcnt vmcnt(20) lgkmcnt(0)
    v_mfma_f32_16x16x32_bf16 v[96:99], a[192:195], a[144:147], v[96:99]
    ds_read_b64_tr_b16 a[208:209], v246 offset:8704
    s_load_dwordx2 s[80:81], s[0:1], 0
    s_load_dwordx2 s[82:83], s[0:1], 56
    s_load_dwordx4 s[84:87], s[0:1], 80
    v_mfma_f32_16x16x32_bf16 v[100:103], a[192:195], a[148:151], v[100:103]
    ds_read_b64_tr_b16 a[210:211], v246 offset:9728
    v_mfma_f32_16x16x32_bf16 v[104:107], a[192:195], a[152:155], v[104:107]
    ds_read_b64_tr_b16 a[212:213], v238 offset:8704
    buffer_load_dwordx4 v242, s[16:19], s41 offen offset:3072 sc1 lds
    v_mfma_f32_16x16x32_bf16 v[108:111], a[192:195], a[156:159], v[108:111]
    ds_read_b64_tr_b16 a[214:215], v238 offset:9728
    v_mfma_f32_16x16x32_bf16 v[112:115], a[196:199], a[144:147], v[112:115]
    ds_read_b64_tr_b16 a[216:217], v246 offset:8960
    v_mfma_f32_16x16x32_bf16 v[116:119], a[196:199], a[148:151], v[116:119]
    ds_read_b64_tr_b16 a[218:219], v246 offset:9984
    s_add_u32 m0, s34, 16384
    s_add_u32 s34, s34, 32768
    s_cmp_ge_u32 s34, 163840
    s_cselect_b32 s34, s37, s34
    v_mfma_f32_16x16x32_bf16 v[120:123], a[196:199], a[152:155], v[120:123]
    ds_read_b64_tr_b16 a[220:221], v238 offset:8960
    v_mfma_f32_16x16x32_bf16 v[124:127], a[196:199], a[156:159], v[124:127]
    ds_read_b64_tr_b16 a[222:223], v238 offset:9984
    v_mfma_f32_16x16x32_bf16 v[128:131], a[200:203], a[144:147], v[128:131]
    buffer_load_dwordx4 v242, s[16:19], s42 offen offset:0 sc1 lds
    v_mov_b32_e64 v241, v240
    v_mfma_f32_16x16x32_bf16 v[132:135], a[200:203], a[148:151], v[132:135]
    v_lshrrev_b32_e64 v230, 7, v240
    v_mfma_f32_16x16x32_bf16 v[136:139], a[200:203], a[152:155], v[136:139]
    v_mul_u32_u24 v253, 7168, v230
    v_mfma_f32_16x16x32_bf16 v[140:143], a[200:203], a[156:159], v[140:143]
    v_and_b32 v231, 0x70, v240
    v_mfma_f32_16x16x32_bf16 v[144:147], a[204:207], a[144:147], v[144:147]
    buffer_load_dwordx4 v242, s[16:19], s42 offen offset:1024 sc1 lds
    v_mfma_f32_16x16x32_bf16 v[148:151], a[204:207], a[148:151], v[148:151]
    v_add_u32_e64 v253, v253, v231
    v_mfma_f32_16x16x32_bf16 v[152:155], a[204:207], a[152:155], v[152:155]
    v_lshlrev_b32_e64 v255, 5, v230
    v_mfma_f32_16x16x32_bf16 v[156:159], a[204:207], a[156:159], v[156:159]
    buffer_load_dwordx4 v242, s[16:19], s42 offen offset:2048 sc1 lds
    s_waitcnt lgkmcnt(0)
    v_mfma_f32_16x16x32_bf16 v[160:163], a[208:211], a[144:147], v[160:163]
    ds_read_b64_tr_b16 a[192:193], v246 offset:16384
    v_and_b32 v230, 16, v240
    v_mfma_f32_16x16x32_bf16 v[164:167], a[208:211], a[148:151], v[164:167]
    ds_read_b64_tr_b16 a[194:195], v246 offset:17408
    v_mfma_f32_16x16x32_bf16 v[168:171], a[208:211], a[152:155], v[168:171]
    ds_read_b64_tr_b16 a[196:197], v238 offset:16384
    buffer_load_dwordx4 v242, s[16:19], s42 offen offset:3072 sc1 lds
    s_add_u32 s42, s42, 34048
    v_mfma_f32_16x16x32_bf16 v[172:175], a[208:211], a[156:159], v[172:175]
    ds_read_b64_tr_b16 a[198:199], v238 offset:17408
    v_add_u32_e64 v255, v255, v230
    v_mfma_f32_16x16x32_bf16 v[176:179], a[212:215], a[144:147], v[176:179]
    ds_read_b64_tr_b16 a[200:201], v246 offset:16640
    v_mfma_f32_16x16x32_bf16 v[180:183], a[212:215], a[148:151], v[180:183]
    ds_read_b64_tr_b16 a[202:203], v246 offset:17664
    s_mov_b32 m0, s34
    s_add_u32 s41, s42, 17664
    v_mfma_f32_16x16x32_bf16 v[184:187], a[212:215], a[152:155], v[184:187]
    ds_read_b64_tr_b16 a[204:205], v238 offset:16640
    v_lshrrev_b32 v231, 5, v231
    v_mfma_f32_16x16x32_bf16 v[188:191], a[212:215], a[156:159], v[188:191]
    ds_read_b64_tr_b16 a[206:207], v238 offset:17664
    v_mfma_f32_16x16x32_bf16 v[192:195], a[216:219], a[144:147], v[192:195]
    buffer_load_dwordx4 v242, s[16:19], s41 offen offset:0 sc1 lds
    v_lshl_add_u32 v255, v231, 16, v255
    v_mfma_f32_16x16x32_bf16 v[196:199], a[216:219], a[148:151], v[196:199]
    v_mov_b32_e64 v64, 0
    v_mfma_f32_16x16x32_bf16 v[200:203], a[216:219], a[152:155], v[200:203]
    v_mov_b32_e64 v65, 0
    v_mfma_f32_16x16x32_bf16 v[204:207], a[216:219], a[156:159], v[204:207]
    v_mov_b32_e64 v66, 0
    v_mfma_f32_16x16x32_bf16 v[208:211], a[220:223], a[144:147], v[208:211]
    buffer_load_dwordx4 v242, s[16:19], s41 offen offset:1024 sc1 lds
    v_mfma_f32_16x16x32_bf16 v[212:215], a[220:223], a[148:151], v[212:215]
    v_mov_b32_e64 v67, 0
    v_mfma_f32_16x16x32_bf16 v[216:219], a[220:223], a[152:155], v[216:219]
    v_mov_b32_e64 v68, 0
    v_mfma_f32_16x16x32_bf16 v[220:223], a[220:223], a[156:159], v[220:223]
    buffer_load_dwordx4 v242, s[16:19], s41 offen offset:2048 sc1 lds
    s_waitcnt vmcnt(20) lgkmcnt(0)
    v_mfma_f32_16x16x32_bf16 v[96:99], a[192:195], a[160:163], v[96:99]
    ds_read_b64_tr_b16 a[208:209], v246 offset:16896
    v_mov_b32 v69, 0
    v_mfma_f32_16x16x32_bf16 v[100:103], a[192:195], a[164:167], v[100:103]
    ds_read_b64_tr_b16 a[210:211], v246 offset:17920
    v_mfma_f32_16x16x32_bf16 v[104:107], a[192:195], a[168:171], v[104:107]
    ds_read_b64_tr_b16 a[212:213], v238 offset:16896
    buffer_load_dwordx4 v242, s[16:19], s41 offen offset:3072 sc1 lds
    v_mfma_f32_16x16x32_bf16 v[108:111], a[192:195], a[172:175], v[108:111]
    ds_read_b64_tr_b16 a[214:215], v238 offset:17920
    v_mov_b32_e64 v70, 0
    v_mfma_f32_16x16x32_bf16 v[112:115], a[196:199], a[160:163], v[112:115]
    ds_read_b64_tr_b16 a[216:217], v246 offset:17152
    v_mfma_f32_16x16x32_bf16 v[116:119], a[196:199], a[164:167], v[116:119]
    ds_read_b64_tr_b16 a[218:219], v246 offset:18176
    s_add_u32 m0, s34, 16384
    s_add_u32 s34, s34, 32768
    s_cmp_ge_u32 s34, 163840
    s_cselect_b32 s34, s37, s34
    v_mfma_f32_16x16x32_bf16 v[120:123], a[196:199], a[168:171], v[120:123]
    ds_read_b64_tr_b16 a[220:221], v238 offset:17152
    v_mov_b32 v71, 0
    v_mfma_f32_16x16x32_bf16 v[124:127], a[196:199], a[172:175], v[124:127]
    ds_read_b64_tr_b16 a[222:223], v238 offset:18176
    v_mfma_f32_16x16x32_bf16 v[128:131], a[200:203], a[160:163], v[128:131]
    v_mov_b32_e64 v72, 0
    v_mfma_f32_16x16x32_bf16 v[132:135], a[200:203], a[164:167], v[132:135]
    buffer_load_dwordx4 v242, s[16:19], s42 offen offset:0 sc1 lds
    v_mov_b32_e64 v73, 0
    v_mfma_f32_16x16x32_bf16 v[136:139], a[200:203], a[168:171], v[136:139]
    v_mov_b32_e64 v74, 0
    v_mfma_f32_16x16x32_bf16 v[140:143], a[200:203], a[172:175], v[140:143]
    v_mov_b32_e64 v75, 0
    v_mfma_f32_16x16x32_bf16 v[144:147], a[204:207], a[160:163], v[144:147]
    buffer_load_dwordx4 v242, s[16:19], s42 offen offset:1024 sc1 lds
    v_mfma_f32_16x16x32_bf16 v[148:151], a[204:207], a[164:167], v[148:151]
    v_mov_b32_e64 v76, 0
    v_mfma_f32_16x16x32_bf16 v[152:155], a[204:207], a[168:171], v[152:155]
    v_mov_b32_e64 v77, 0
    v_mfma_f32_16x16x32_bf16 v[156:159], a[204:207], a[172:175], v[156:159]
    buffer_load_dwordx4 v242, s[16:19], s42 offen offset:2048 sc1 lds
    s_waitcnt lgkmcnt(0)
    v_mfma_f32_16x16x32_bf16 v[160:163], a[208:211], a[160:163], v[160:163]
    ds_read_b64_tr_b16 a[192:193], v246 offset:24576
    v_mov_b32 v78, 0
    v_mfma_f32_16x16x32_bf16 v[164:167], a[208:211], a[164:167], v[164:167]
    ds_read_b64_tr_b16 a[194:195], v246 offset:25600
    v_mfma_f32_16x16x32_bf16 v[168:171], a[208:211], a[168:171], v[168:171]
    ds_read_b64_tr_b16 a[196:197], v238 offset:24576
    buffer_load_dwordx4 v242, s[16:19], s42 offen offset:3072 sc1 lds
    s_add_u32 s42, s42, 34048
    v_mfma_f32_16x16x32_bf16 v[172:175], a[208:211], a[172:175], v[172:175]
    ds_read_b64_tr_b16 a[198:199], v238 offset:25600
    v_mov_b32_e64 v79, 0
    v_mfma_f32_16x16x32_bf16 v[176:179], a[212:215], a[160:163], v[176:179]
    ds_read_b64_tr_b16 a[200:201], v246 offset:24832
    v_mfma_f32_16x16x32_bf16 v[180:183], a[212:215], a[164:167], v[180:183]
    ds_read_b64_tr_b16 a[202:203], v246 offset:25856
    v_mov_b32_e64 v80, 0
    v_mfma_f32_16x16x32_bf16 v[184:187], a[212:215], a[168:171], v[184:187]
    ds_read_b64_tr_b16 a[204:205], v238 offset:24832
    v_mfma_f32_16x16x32_bf16 v[188:191], a[212:215], a[172:175], v[188:191]
    ds_read_b64_tr_b16 a[206:207], v238 offset:25856
    v_mov_b32_e64 v81, 0
    v_mfma_f32_16x16x32_bf16 v[192:195], a[216:219], a[160:163], v[192:195]
    v_mov_b32_e64 v82, 0
    v_mfma_f32_16x16x32_bf16 v[196:199], a[216:219], a[164:167], v[196:199]
    v_mov_b32_e64 v83, 0
    v_mfma_f32_16x16x32_bf16 v[200:203], a[216:219], a[168:171], v[200:203]
    v_mov_b32_e64 v84, 0
    v_mfma_f32_16x16x32_bf16 v[204:207], a[216:219], a[172:175], v[204:207]
    v_mov_b32_e64 v85, 0
    v_mfma_f32_16x16x32_bf16 v[208:211], a[220:223], a[160:163], v[208:211]
    v_mov_b32_e64 v86, 0
    v_mfma_f32_16x16x32_bf16 v[212:215], a[220:223], a[164:167], v[212:215]
    v_mov_b32_e64 v87, 0
    v_mfma_f32_16x16x32_bf16 v[216:219], a[220:223], a[168:171], v[216:219]
    v_mov_b32_e64 v88, 0
    v_mfma_f32_16x16x32_bf16 v[220:223], a[220:223], a[172:175], v[220:223]
    s_waitcnt vmcnt(15) lgkmcnt(0)
    v_mfma_f32_16x16x32_bf16 v[96:99], a[192:195], a[176:179], v[96:99]
    ds_read_b64_tr_b16 a[208:209], v246 offset:25088
    v_mov_b32 v89, 0
    v_mfma_f32_16x16x32_bf16 v[100:103], a[192:195], a[180:183], v[100:103]
    ds_read_b64_tr_b16 a[210:211], v246 offset:26112
    v_mfma_f32_16x16x32_bf16 v[104:107], a[192:195], a[184:187], v[104:107]
    ds_read_b64_tr_b16 a[212:213], v238 offset:25088
    v_mov_b32_e64 v90, 0
    v_mfma_f32_16x16x32_bf16 v[108:111], a[192:195], a[188:191], v[108:111]
    ds_read_b64_tr_b16 a[214:215], v238 offset:26112
    v_mfma_f32_16x16x32_bf16 v[112:115], a[196:199], a[176:179], v[112:115]
    ds_read_b64_tr_b16 a[216:217], v246 offset:25344
    v_mov_b32_e64 v91, 0
    v_mfma_f32_16x16x32_bf16 v[116:119], a[196:199], a[180:183], v[116:119]
    ds_read_b64_tr_b16 a[218:219], v246 offset:26368
    v_mfma_f32_16x16x32_bf16 v[120:123], a[196:199], a[184:187], v[120:123]
    ds_read_b64_tr_b16 a[220:221], v238 offset:25344
    v_mov_b32_e64 v92, 0
    v_mfma_f32_16x16x32_bf16 v[124:127], a[196:199], a[188:191], v[124:127]
    ds_read_b64_tr_b16 a[222:223], v238 offset:26368
    v_mfma_f32_16x16x32_bf16 v[128:131], a[200:203], a[176:179], v[128:131]
    v_mov_b32_e64 v93, 0
    v_mfma_f32_16x16x32_bf16 v[132:135], a[200:203], a[180:183], v[132:135]
    v_mov_b32_e64 v94, 0
    v_mfma_f32_16x16x32_bf16 v[136:139], a[200:203], a[184:187], v[136:139]
    v_mov_b32_e64 v95, 0
    v_mfma_f32_16x16x32_bf16 v[140:143], a[200:203], a[188:191], v[140:143]
    v_mov_b32_e64 v224, 0
    v_mfma_f32_16x16x32_bf16 v[144:147], a[204:207], a[176:179], v[144:147]
    v_mov_b32_e64 v225, 0
    v_mfma_f32_16x16x32_bf16 v[148:151], a[204:207], a[180:183], v[148:151]
    v_mov_b32_e64 v226, 0
    v_mfma_f32_16x16x32_bf16 v[152:155], a[204:207], a[184:187], v[152:155]
    v_mov_b32_e64 v227, 0
    v_mfma_f32_16x16x32_bf16 v[156:159], a[204:207], a[188:191], v[156:159]
    s_waitcnt vmcnt(8) lgkmcnt(0)
    s_barrier
    v_mfma_f32_16x16x32_bf16 v[160:163], a[208:211], a[176:179], v[160:163]
    ds_read_b128 a[192:195], v241 offset:0
    s_mov_b32 m0, s34
    s_add_u32 s41, s42, 17664
    v_mfma_f32_16x16x32_bf16 v[164:167], a[208:211], a[180:183], v[164:167]
    ds_read_b128 a[196:199], v241 offset:2048
    buffer_load_dwordx4 v242, s[16:19], s41 offen offset:0 sc1 lds
    v_mfma_f32_16x16x32_bf16 v[168:171], a[208:211], a[184:187], v[168:171]
    ds_read_b128 a[200:203], v241 offset:4096
    v_mfma_f32_16x16x32_bf16 v[172:175], a[208:211], a[188:191], v[172:175]
    ds_read_b128 a[204:207], v241 offset:6144
    buffer_load_dwordx4 v242, s[16:19], s41 offen offset:1024 sc1 lds
    v_mfma_f32_16x16x32_bf16 v[176:179], a[212:215], a[176:179], v[176:179]
    ds_read_b128 a[224:227], v241 offset:8192
    buffer_load_dwordx4 v242, s[16:19], s41 offen offset:2048 sc1 lds
    v_mfma_f32_16x16x32_bf16 v[180:183], a[212:215], a[180:183], v[180:183]
    ds_read_b128 a[228:231], v241 offset:10240
    v_mfma_f32_16x16x32_bf16 v[184:187], a[212:215], a[184:187], v[184:187]
    ds_read_b128 a[232:235], v241 offset:12288
    buffer_load_dwordx4 v242, s[16:19], s41 offen offset:3072 sc1 lds
    v_mfma_f32_16x16x32_bf16 v[188:191], a[212:215], a[188:191], v[188:191]
    ds_read_b128 a[236:239], v241 offset:14336
    v_mfma_f32_16x16x32_bf16 v[192:195], a[216:219], a[176:179], v[192:195]
    ds_read_b128 a[240:243], v241 offset:9216
    s_add_u32 m0, s34, 16384
    s_add_u32 s34, s34, 32768
    s_cmp_ge_u32 s34, 163840
    s_cselect_b32 s34, s37, s34
    v_mfma_f32_16x16x32_bf16 v[196:199], a[216:219], a[180:183], v[196:199]
    ds_read_b128 a[244:247], v241 offset:11264
    buffer_load_dwordx4 v242, s[16:19], s42 offen offset:0 sc1 lds
    v_mfma_f32_16x16x32_bf16 v[200:203], a[216:219], a[184:187], v[200:203]
    ds_read_b128 a[248:251], v241 offset:13312
    v_mfma_f32_16x16x32_bf16 v[204:207], a[216:219], a[188:191], v[204:207]
    ds_read_b128 a[252:255], v241 offset:15360
    buffer_load_dwordx4 v242, s[16:19], s42 offen offset:1024 sc1 lds
    v_mfma_f32_16x16x32_bf16 v[208:211], a[220:223], a[176:179], v[208:211]
    buffer_load_dwordx4 v242, s[16:19], s42 offen offset:2048 sc1 lds
    v_mfma_f32_16x16x32_bf16 v[212:215], a[220:223], a[180:183], v[212:215]
    v_mfma_f32_16x16x32_bf16 v[216:219], a[220:223], a[184:187], v[216:219]
    buffer_load_dwordx4 v242, s[16:19], s42 offen offset:3072 sc1 lds
    s_add_u32 s42, s42, 34048
    v_mfma_f32_16x16x32_bf16 v[220:223], a[220:223], a[188:191], v[220:223]
    s_waitcnt lgkmcnt(8)
    ds_read_b128 a[208:211], v241 offset:1024
    ds_read_b128 a[212:215], v241 offset:3072
    ds_read_b128 a[216:219], v241 offset:5120
    ds_read_b128 a[220:223], v241 offset:7168
    s_sub_u32 s36, s36, 1
    s_cbranch_scc1 kf_fix1
kf_fixr2:
    v_cvt_pk_bf16_f32 v96, v96, v97
    v_cvt_pk_bf16_f32 v97, v98, v99
    v_cvt_pk_bf16_f32 v98, v112, v113
    v_cvt_pk_bf16_f32 v99, v114, v115
    v_accvgpr_write_b32 a128, v96
    v_accvgpr_write_b32 a129, v97
    v_accvgpr_write_b32 a130, v98
    v_accvgpr_write_b32 a131, v99
    v_cvt_pk_bf16_f32 v100, v100, v101
    v_cvt_pk_bf16_f32 v101, v102, v103
    v_cvt_pk_bf16_f32 v102, v116, v117
    v_cvt_pk_bf16_f32 v103, v118, v119
    v_accvgpr_write_b32 a144, v100
    v_accvgpr_write_b32 a145, v101
    v_accvgpr_write_b32 a146, v102
    v_accvgpr_write_b32 a147, v103
    v_cvt_pk_bf16_f32 v104, v104, v105
    v_cvt_pk_bf16_f32 v105, v106, v107
    v_cvt_pk_bf16_f32 v106, v120, v121
    v_cvt_pk_bf16_f32 v107, v122, v123
    v_accvgpr_write_b32 a160, v104
    v_accvgpr_write_b32 a161, v105
    v_accvgpr_write_b32 a162, v106
    v_accvgpr_write_b32 a163, v107
    v_cvt_pk_bf16_f32 v108, v108, v109
    v_cvt_pk_bf16_f32 v109, v110, v111
    v_cvt_pk_bf16_f32 v110, v124, v125
    v_cvt_pk_bf16_f32 v111, v126, v127
    v_accvgpr_write_b32 a176, v108
    v_accvgpr_write_b32 a177, v109
    v_accvgpr_write_b32 a178, v110
    v_accvgpr_write_b32 a179, v111
    s_nop 1
    s_waitcnt lgkmcnt(0)
    v_mfma_f32_16x16x32_bf16 v[0:3], a[192:195], a[128:131], v[64:67]
    v_cvt_pk_bf16_f32 v128, v128, v129
    v_cvt_pk_bf16_f32 v129, v130, v131
    v_cvt_pk_bf16_f32 v130, v144, v145
    v_cvt_pk_bf16_f32 v131, v146, v147
    v_mfma_f32_16x16x32_bf16 v[8:11], a[192:195], a[144:147], v[72:75]
    v_accvgpr_write_b32 a132, v128
    v_accvgpr_write_b32 a133, v129
    v_accvgpr_write_b32 a134, v130
    v_accvgpr_write_b32 a135, v131
    v_mfma_f32_16x16x32_bf16 v[16:19], a[192:195], a[160:163], v[80:83]
    v_cvt_pk_bf16_f32 v132, v132, v133
    v_cvt_pk_bf16_f32 v133, v134, v135
    v_cvt_pk_bf16_f32 v134, v148, v149
    v_cvt_pk_bf16_f32 v135, v150, v151
    v_mfma_f32_16x16x32_bf16 v[24:27], a[192:195], a[176:179], v[88:91]
    v_accvgpr_write_b32 a148, v132
    v_accvgpr_write_b32 a149, v133
    v_accvgpr_write_b32 a150, v134
    v_accvgpr_write_b32 a151, v135
    v_mfma_f32_16x16x32_bf16 v[4:7], a[208:211], a[128:131], v[68:71]
    v_cvt_pk_bf16_f32 v136, v136, v137
    v_cvt_pk_bf16_f32 v137, v138, v139
    v_cvt_pk_bf16_f32 v138, v152, v153
    v_cvt_pk_bf16_f32 v139, v154, v155
    v_mfma_f32_16x16x32_bf16 v[12:15], a[208:211], a[144:147], v[76:79]
    v_accvgpr_write_b32 a164, v136
    v_accvgpr_write_b32 a165, v137
    v_accvgpr_write_b32 a166, v138
    v_accvgpr_write_b32 a167, v139
    v_mfma_f32_16x16x32_bf16 v[20:23], a[208:211], a[160:163], v[84:87]
    v_cvt_pk_bf16_f32 v140, v140, v141
    v_cvt_pk_bf16_f32 v141, v142, v143
    v_cvt_pk_bf16_f32 v142, v156, v157
    v_cvt_pk_bf16_f32 v143, v158, v159
    v_mfma_f32_16x16x32_bf16 v[28:31], a[208:211], a[176:179], v[92:95]
    v_accvgpr_write_b32 a180, v140
    v_accvgpr_write_b32 a181, v141
    v_accvgpr_write_b32 a182, v142
    v_accvgpr_write_b32 a183, v143
    s_nop 1
    v_mfma_f32_16x16x32_bf16 v[0:3], a[196:199], a[132:135], v[0:3]
    v_cvt_pk_bf16_f32 v160, v160, v161
    v_cvt_pk_bf16_f32 v161, v162, v163
    v_cvt_pk_bf16_f32 v162, v176, v177
    v_cvt_pk_bf16_f32 v163, v178, v179
    v_mfma_f32_16x16x32_bf16 v[8:11], a[196:199], a[148:151], v[8:11]
    v_accvgpr_write_b32 a136, v160
    v_accvgpr_write_b32 a137, v161
    v_accvgpr_write_b32 a138, v162
    v_accvgpr_write_b32 a139, v163
    v_mfma_f32_16x16x32_bf16 v[16:19], a[196:199], a[164:167], v[16:19]
    v_cvt_pk_bf16_f32 v164, v164, v165
    v_cvt_pk_bf16_f32 v165, v166, v167
    v_cvt_pk_bf16_f32 v166, v180, v181
    v_cvt_pk_bf16_f32 v167, v182, v183
    v_mfma_f32_16x16x32_bf16 v[24:27], a[196:199], a[180:183], v[24:27]
    v_accvgpr_write_b32 a152, v164
    v_accvgpr_write_b32 a153, v165
    v_accvgpr_write_b32 a154, v166
    v_accvgpr_write_b32 a155, v167
    v_mfma_f32_16x16x32_bf16 v[4:7], a[212:215], a[132:135], v[4:7]
    v_cvt_pk_bf16_f32 v168, v168, v169
    v_cvt_pk_bf16_f32 v169, v170, v171
    v_cvt_pk_bf16_f32 v170, v184, v185
    v_cvt_pk_bf16_f32 v171, v186, v187
    v_mfma_f32_16x16x32_bf16 v[12:15], a[212:215], a[148:151], v[12:15]
    v_accvgpr_write_b32 a168, v168
    v_accvgpr_write_b32 a169, v169
    v_accvgpr_write_b32 a170, v170
    v_accvgpr_write_b32 a171, v171
    v_mfma_f32_16x16x32_bf16 v[20:23], a[212:215], a[164:167], v[20:23]
    v_cvt_pk_bf16_f32 v172, v172, v173
    v_cvt_pk_bf16_f32 v173, v174, v175
    v_cvt_pk_bf16_f32 v174, v188, v189
    v_cvt_pk_bf16_f32 v175, v190, v191
    v_mfma_f32_16x16x32_bf16 v[28:31], a[212:215], a[180:183], v[28:31]
    v_accvgpr_write_b32 a184, v172
    v_accvgpr_write_b32 a185, v173
    v_accvgpr_write_b32 a186, v174
    v_accvgpr_write_b32 a187, v175
    s_nop 1
    s_waitcnt lgkmcnt(0)
    v_mfma_f32_16x16x32_bf16 v[0:3], a[200:203], a[136:139], v[0:3]
    v_cvt_pk_bf16_f32 v192, v192, v193
    v_cvt_pk_bf16_f32 v193, v194, v195
    v_cvt_pk_bf16_f32 v194, v208, v209
    v_cvt_pk_bf16_f32 v195, v210, v211
    v_mfma_f32_16x16x32_bf16 v[8:11], a[200:203], a[152:155], v[8:11]
    v_accvgpr_write_b32 a140, v192
    v_accvgpr_write_b32 a141, v193
    v_accvgpr_write_b32 a142, v194
    v_accvgpr_write_b32 a143, v195
    v_mfma_f32_16x16x32_bf16 v[16:19], a[200:203], a[168:171], v[16:19]
    v_cvt_pk_bf16_f32 v196, v196, v197
    v_cvt_pk_bf16_f32 v197, v198, v199
    v_cvt_pk_bf16_f32 v198, v212, v213
    v_cvt_pk_bf16_f32 v199, v214, v215
    v_mfma_f32_16x16x32_bf16 v[24:27], a[200:203], a[184:187], v[24:27]
    v_accvgpr_write_b32 a156, v196
    v_accvgpr_write_b32 a157, v197
    v_accvgpr_write_b32 a158, v198
    v_accvgpr_write_b32 a159, v199
    v_mfma_f32_16x16x32_bf16 v[4:7], a[216:219], a[136:139], v[4:7]
    v_cvt_pk_bf16_f32 v200, v200, v201
    v_cvt_pk_bf16_f32 v201, v202, v203
    v_cvt_pk_bf16_f32 v202, v216, v217
    v_cvt_pk_bf16_f32 v203, v218, v219
    v_mfma_f32_16x16x32_bf16 v[12:15], a[216:219], a[152:155], v[12:15]
    v_accvgpr_write_b32 a172, v200
    v_accvgpr_write_b32 a173, v201
    v_accvgpr_write_b32 a174, v202
    v_accvgpr_write_b32 a175, v203
    v_mfma_f32_16x16x32_bf16 v[20:23], a[216:219], a[168:171], v[20:23]
    v_cvt_pk_bf16_f32 v204, v204, v205
    v_cvt_pk_bf16_f32 v205, v206, v207
    v_cvt_pk_bf16_f32 v206, v220, v221
    v_cvt_pk_bf16_f32 v207, v222, v223
    v_mfma_f32_16x16x32_bf16 v[28:31], a[216:219], a[184:187], v[28:31]
    v_accvgpr_write_b32 a188, v204
    v_accvgpr_write_b32 a189, v205
    v_accvgpr_write_b32 a190, v206
    v_accvgpr_write_b32 a191, v207
    s_nop 1
    v_mfma_f32_16x16x32_bf16 v[0:3], a[204:207], a[140:143], v[0:3]
    v_mov_b32 v144, 0
    v_mov_b32 v145, 0
    v_mov_b32 v146, 0
    v_mfma_f32_16x16x32_bf16 v[8:11], a[204:207], a[156:159], v[8:11]
    v_mov_b32 v147, 0
    v_mov_b32 v148, 0
    v_mfma_f32_16x16x32_bf16 v[16:19], a[204:207], a[172:175], v[16:19]
    v_mov_b32 v149, 0
    v_mov_b32 v150, 0
    v_mov_b32_e64 v151, 0
    v_mfma_f32_16x16x32_bf16 v[24:27], a[204:207], a[188:191], v[24:27]
    v_mov_b32 v152, 0
    v_mov_b32 v153, 0
    v_mfma_f32_16x16x32_bf16 v[4:7], a[220:223], a[140:143], v[4:7]
    v_mov_b32 v154, 0
    v_mov_b32 v155, 0
    v_mov_b32_e64 v156, 0
    v_mfma_f32_16x16x32_bf16 v[12:15], a[220:223], a[156:159], v[12:15]
    v_mov_b32 v157, 0
    v_mov_b32 v158, 0
    v_mfma_f32_16x16x32_bf16 v[20:23], a[220:223], a[172:175], v[20:23]
    v_mov_b32_e64 v159, 0
    v_mov_b32 v204, 0x3f803f80
    v_mov_b32 v205, 0x3f803f80
    v_mfma_f32_16x16x32_bf16 v[28:31], a[220:223], a[188:191], v[28:31]
    v_mov_b32 v206, 0x3f803f80
    v_mov_b32 v207, 0x3f803f80
    s_nop 4
    v_max3_f32 v128, v0, v1, v2
    v_max3_f32 v130, v8, v9, v10
    v_max3_f32 v132, v16, v17, v18
    v_max3_f32 v134, v24, v25, v26
    v_max3_f32 v128, v128, v3, v4
    v_max3_f32 v130, v130, v11, v12
    v_max3_f32 v132, v132, v19, v20
    v_max3_f32 v134, v134, v27, v28
    v_max3_f32 v128, v128, v5, v6
    v_max3_f32 v130, v130, v13, v14
    v_max3_f32 v132, v132, v21, v22
    v_max3_f32 v134, v134, v29, v30
    v_max_f32 v128, v128, v7
    v_max_f32 v130, v130, v15
    v_max_f32 v132, v132, v23
    v_max_f32 v134, v134, v31
    v_mov_b32 v129, v128
    v_mov_b32 v131, v130
    v_mov_b32 v133, v132
    v_mov_b32 v135, v134
    v_permlane16_swap_b32 v128, v129
    v_permlane16_swap_b32 v130, v131
    v_permlane16_swap_b32 v132, v133
    v_permlane16_swap_b32 v134, v135
    v_max_f32 v128, v128, v129
    v_max_f32 v130, v130, v131
    v_max_f32 v132, v132, v133
    v_max_f32 v134, v134, v135
    v_mov_b32 v129, v128
    v_mov_b32 v131, v130
    v_mov_b32 v133, v132
    v_mov_b32 v135, v134
    v_permlane32_swap_b32 v128, v129
    v_permlane32_swap_b32 v130, v131
    v_permlane32_swap_b32 v132, v133
    v_permlane32_swap_b32 v134, v135
    v_max_f32 v128, v128, v129
    v_max_f32 v130, v130, v131
    v_max_f32 v132, v132, v133
    v_max_f32_e64 v134, v134, v135
    v_add_f32 v128, 0x41800000, v128
    v_add_f32 v130, 0x41800000, v130
    v_add_f32 v132, 0x41800000, v132
    v_add_f32 v134, 0x41800000, v134
    v_sub_f32 v224, 0, v128
    v_sub_f32 v64, v64, v128
    v_sub_f32 v65, v65, v128
    v_sub_f32 v66, v66, v128
    v_sub_f32 v67, v67, v128
    v_sub_f32 v68, v68, v128
    v_sub_f32 v69, v69, v128
    v_sub_f32 v70, v70, v128
    v_sub_f32 v71, v71, v128
    v_sub_f32 v225, 0, v130
    v_sub_f32 v72, v72, v130
    v_sub_f32 v73, v73, v130
    v_sub_f32 v74, v74, v130
    v_sub_f32 v75, v75, v130
    v_sub_f32 v76, v76, v130
    v_sub_f32 v77, v77, v130
    v_sub_f32 v78, v78, v130
    v_sub_f32 v79, v79, v130
    v_sub_f32 v226, 0, v132
    v_sub_f32 v80, v80, v132
    v_sub_f32 v81, v81, v132
    v_sub_f32 v82, v82, v132
    v_sub_f32 v83, v83, v132
    v_sub_f32 v84, v84, v132
    v_sub_f32 v85, v85, v132
    v_sub_f32 v86, v86, v132
    v_sub_f32 v87, v87, v132
    v_sub_f32 v227, 0, v134
    v_sub_f32 v88, v88, v134
    v_sub_f32 v89, v89, v134
    v_sub_f32 v90, v90, v134
    v_sub_f32 v91, v91, v134
    v_sub_f32 v92, v92, v134
    v_sub_f32 v93, v93, v134
    v_sub_f32 v94, v94, v134
    v_sub_f32 v95, v95, v134
    v_sub_f32 v0, v0, v128
    v_sub_f32 v1, v1, v128
    v_sub_f32 v2, v2, v128
    v_sub_f32 v3, v3, v128
    v_sub_f32 v4, v4, v128
    v_sub_f32 v5, v5, v128
    v_sub_f32 v6, v6, v128
    v_sub_f32 v7, v7, v128
    v_sub_f32 v8, v8, v130
    v_sub_f32 v9, v9, v130
    v_sub_f32 v10, v10, v130
    v_sub_f32 v11, v11, v130
    v_sub_f32 v12, v12, v130
    v_sub_f32 v13, v13, v130
    v_sub_f32 v14, v14, v130
    v_sub_f32 v15, v15, v130
    v_sub_f32 v16, v16, v132
    v_sub_f32 v17, v17, v132
    v_sub_f32 v18, v18, v132
    v_sub_f32 v19, v19, v132
    v_sub_f32 v20, v20, v132
    v_sub_f32 v21, v21, v132
    v_sub_f32 v22, v22, v132
    v_sub_f32 v23, v23, v132
    v_sub_f32 v24, v24, v134
    v_sub_f32 v25, v25, v134
    v_sub_f32 v26, v26, v134
    v_sub_f32 v27, v27, v134
    v_sub_f32 v28, v28, v134
    v_sub_f32 v29, v29, v134
    v_sub_f32 v30, v30, v134
    v_sub_f32 v31, v31, v134
    s_mov_b32 s35, 32768
    v_add_u32_e64 v241, s35, v240
    s_sub_u32 s36, s36, 1
    s_cbranch_scc1 kf_fix3
kf_fixr4:
    v_mfma_f32_16x16x32_bf16 v[32:35], a[224:227], a[128:131], v[64:67]
    ds_read_b128 a[192:195], v241 offset:0
    v_exp_f32_e64 v128, v0
    v_mfma_f32_16x16x32_bf16 v[32:35], a[228:231], a[132:135], v[32:35]
    v_exp_f32_e64 v129, v1
    v_mfma_f32_16x16x32_bf16 v[32:35], a[232:235], a[136:139], v[32:35]
    v_exp_f32_e64 v130, v2
    v_cvt_pk_bf16_f32 v96, v128, v129
    v_mfma_f32_16x16x32_bf16 v[32:35], a[236:239], a[140:143], v[32:35]
    v_exp_f32_e64 v131, v3
    v_mfma_f32_16x16x32_bf16 v[40:43], a[224:227], a[144:147], v[72:75]
    ds_read_b128 a[196:199], v241 offset:2048
    v_exp_f32_e64 v132, v4
    v_mfma_f32_16x16x32_bf16 v[40:43], a[228:231], a[148:151], v[40:43]
    v_exp_f32_e64 v133, v5
    v_cvt_pk_bf16_f32 v97, v130, v131
    v_mfma_f32_16x16x32_bf16 v[40:43], a[232:235], a[152:155], v[40:43]
    v_exp_f32_e64 v134, v6
    v_cvt_pk_bf16_f32 v98, v132, v133
    v_mfma_f32_16x16x32_bf16 v[40:43], a[236:239], a[156:159], v[40:43]
    v_exp_f32_e64 v135, v7
    v_mfma_f32_16x16x32_bf16 v[48:51], a[224:227], a[160:163], v[80:83]
    ds_read_b128 a[200:203], v241 offset:4096
    v_exp_f32_e64 v136, v8
    v_mfma_f32_16x16x32_bf16 v[48:51], a[228:231], a[164:167], v[48:51]
    v_exp_f32_e64 v137, v9
    v_cvt_pk_bf16_f32 v99, v134, v135
    v_mfma_f32_16x16x32_bf16 v[48:51], a[232:235], a[168:171], v[48:51]
    v_exp_f32 v138, v10
    v_exp_f32 v139, v11
    v_mfma_f32_16x16x32_bf16 v[48:51], a[236:239], a[172:175], v[48:51]
    v_exp_f32_e64 v140, v12
    v_cvt_pk_bf16_f32 v100, v136, v137
    v_mfma_f32_16x16x32_bf16 v[56:59], a[224:227], a[176:179], v[88:91]
    ds_read_b128 a[204:207], v241 offset:6144
    v_exp_f32_e64 v141, v13
    v_mfma_f32_16x16x32_bf16 v[56:59], a[228:231], a[180:183], v[56:59]
    v_exp_f32_e64 v142, v14
    v_cvt_pk_bf16_f32 v101, v138, v139
    v_mfma_f32_16x16x32_bf16 v[56:59], a[232:235], a[184:187], v[56:59]
    v_exp_f32_e64 v143, v15
    v_cvt_pk_bf16_f32 v102, v140, v141
    v_mfma_f32_16x16x32_bf16 v[56:59], a[236:239], a[188:191], v[56:59]
    v_exp_f32_e64 v128, v16
    v_cvt_pk_bf16_f32 v103, v142, v143
    v_mfma_f32_16x16x32_bf16 v[36:39], a[240:243], a[128:131], v[68:71]
    ds_read_b128 a[208:211], v241 offset:1024
    v_exp_f32_e64 v129, v17
    v_mfma_f32_16x16x32_bf16 v[36:39], a[244:247], a[132:135], v[36:39]
    v_exp_f32_e64 v130, v18
    v_cvt_pk_bf16_f32 v104, v128, v129
    v_mfma_f32_16x16x32_bf16 v[36:39], a[248:251], a[136:139], v[36:39]
    v_exp_f32_e64 v131, v19
    v_mfma_f32_16x16x32_bf16 v[36:39], a[252:255], a[140:143], v[36:39]
    v_exp_f32_e64 v132, v20
    v_cvt_pk_bf16_f32 v105, v130, v131
    v_mfma_f32_16x16x32_bf16 v[44:47], a[240:243], a[144:147], v[76:79]
    ds_read_b128 a[212:215], v241 offset:3072
    v_exp_f32_e64 v133, v21
    v_mfma_f32_16x16x32_bf16 v[44:47], a[244:247], a[148:151], v[44:47]
    v_exp_f32 v134, v22
    v_exp_f32 v135, v23
    v_mfma_f32_16x16x32_bf16 v[44:47], a[248:251], a[152:155], v[44:47]
    v_exp_f32_e64 v136, v24
    v_cvt_pk_bf16_f32 v106, v132, v133
    v_mfma_f32_16x16x32_bf16 v[44:47], a[252:255], a[156:159], v[44:47]
    v_exp_f32_e64 v137, v25
    v_cvt_pk_bf16_f32 v107, v134, v135
    v_mfma_f32_16x16x32_bf16 v[52:55], a[240:243], a[160:163], v[84:87]
    ds_read_b128 a[216:219], v241 offset:5120
    v_exp_f32_e64 v138, v26
    v_mfma_f32_16x16x32_bf16 v[52:55], a[244:247], a[164:167], v[52:55]
    v_exp_f32_e64 v139, v27
    v_cvt_pk_bf16_f32 v108, v136, v137
    v_mfma_f32_16x16x32_bf16 v[52:55], a[248:251], a[168:171], v[52:55]
    v_exp_f32_e64 v140, v28
    v_cvt_pk_bf16_f32 v109, v138, v139
    v_mfma_f32_16x16x32_bf16 v[52:55], a[252:255], a[172:175], v[52:55]
    v_exp_f32_e64 v141, v29
    v_mfma_f32_16x16x32_bf16 v[60:63], a[240:243], a[176:179], v[92:95]
    ds_read_b128 a[220:223], v241 offset:7168
    v_exp_f32_e64 v142, v30
    v_mfma_f32_16x16x32_bf16 v[60:63], a[244:247], a[180:183], v[60:63]
    v_exp_f32_e64 v143, v31
    v_cvt_pk_bf16_f32 v110, v140, v141
    v_mfma_f32_16x16x32_bf16 v[60:63], a[248:251], a[184:187], v[60:63]
    v_cvt_pk_bf16_f32 v111, v142, v143
    v_mfma_f32_16x16x32_bf16 v[60:63], a[252:255], a[188:191], v[60:63]
    v_add_f32 v200, 0, v243
    v_min_f32 v200, 0, v200
    v_add_f32 v201, 0xf1800000, v243
    v_min_f32_e64 v201, 0, v201
    v_add_f32 v202, 0xf2000000, v243
    v_min_f32_e64 v202, 0, v202
    v_add_f32 v203, 0xf2400000, v243
    v_min_f32_e64 v203, 0, v203
    v_add_f32 v209, 0xf3000000, v243
    v_min_f32_e64 v209, 0, v209
    v_add_f32 v210, 0xf3100000, v243
    v_min_f32_e64 v210, 0, v210
    v_add_f32 v211, 0xf3200000, v243
    v_min_f32_e64 v211, 0, v211
    v_add_f32 v212, 0xf3300000, v243
    v_min_f32_e64 v212, 0, v212
    v_add_f32 v213, 0x73800000, v243
    v_min_f32_e64 v213, 0, v213
    v_add_f32 v214, 0x73700000, v243
    v_min_f32_e64 v214, 0, v214
    v_add_f32 v215, 0x73600000, v243
    v_min_f32_e64 v215, 0, v215
    v_add_f32 v216, 0x73500000, v243
    v_min_f32_e64 v216, 0, v216
    v_add_f32 v217, 0x73000000, v243
    v_min_f32_e64 v217, 0, v217
    v_add_f32 v218, 0x72e00000, v243
    v_min_f32_e64 v218, 0, v218
    v_add_f32 v219, 0x72c00000, v243
    v_min_f32_e64 v219, 0, v219
    v_add_f32 v220, 0x72a00000, v243
    v_min_f32_e64 v220, 0, v220
    ds_read_b128 a[224:227], v241 offset:16384
    ds_read_b128 a[228:231], v241 offset:17408
    ds_read_b128 a[232:235], v241 offset:18432
    ds_read_b128 a[236:239], v241 offset:19456
    s_mul_i32 s27, s5, 68096
    s_sub_u32 s27, s32, s27
    s_add_u32 s18, s27, 1089536
    s_mov_b32 s31, s101
    v_mul_u32_u24 v245, 448, v240
    v_and_b32 v230, 0x40000000, v251
    v_or_b32 v245, v245, v230
    s_lshl1_add_u32 s26, s5, s31
    s_branch ka_p1_e
.p2align 5
ka_p1:
    s_sub_u32 s36, s36, 1
    s_cbranch_scc1 kf_fix7
kf_fixr8:
    s_waitcnt lgkmcnt(8)
    v_mfma_f32_16x16x32_bf16 v[0:3], a[192:195], a[128:131], v[64:67]
    ds_read_b128 a[240:243], v241 offset:20480
    s_waitcnt vmcnt(11)
    v_mfma_f32_16x16x32_bf16 v[0:3], a[196:199], a[132:135], v[0:3]
    v_exp_f32_e64 v128, v32
    v_mfma_f32_16x16x32_bf16 v[0:3], a[200:203], a[136:139], v[0:3]
    v_exp_f32_e64 v129, v33
    v_mfma_f32_16x16x32_bf16 v[0:3], a[204:207], a[140:143], v[0:3]
    v_exp_f32_e64 v130, v34
    v_mfma_f32_16x16x32_bf16 v[8:11], a[192:195], a[144:147], v[72:75]
    ds_read_b128 a[244:247], v241 offset:21504
    buffer_store_dwordx4 v[192:195], v255, s[48:51], s45 offen offset:0 sc1
    v_mfma_f32_16x16x32_bf16 v[8:11], a[196:199], a[148:151], v[8:11]
    s_cmp_lt_u32 s44, s47
    s_cselect_b32 s101, s44, s43
    v_mfma_f32_16x16x32_bf16 v[8:11], a[200:203], a[152:155], v[8:11]
    buffer_load_dwordx4 v[192:195], v253, s[52:55], s101 offen
    v_cvt_pk_bf16_f32 v112, v128, v129
    v_mfma_f32_16x16x32_bf16 v[8:11], a[204:207], a[156:159], v[8:11]
    v_exp_f32_e64 v131, v35
    v_mfma_f32_16x16x32_bf16 v[16:19], a[192:195], a[160:163], v[80:83]
    ds_read_b128 a[248:251], v241 offset:22528
    v_cvt_pk_bf16_f32 v113, v130, v131
    v_mfma_f32_16x16x32_bf16 v[16:19], a[196:199], a[164:167], v[16:19]
    v_exp_f32_e64 v132, v36
    v_mfma_f32_16x16x32_bf16 v[16:19], a[200:203], a[168:171], v[16:19]
    v_exp_f32_e64 v133, v37
    v_mfma_f32_16x16x32_bf16 v[16:19], a[204:207], a[172:175], v[16:19]
    v_exp_f32_e64 v134, v38
    v_mfma_f32_16x16x32_bf16 v[24:27], a[192:195], a[176:179], v[88:91]
    ds_read_b128 a[252:255], v241 offset:23552
    s_mov_b32 m0, s34
    v_mfma_f32_16x16x32_bf16 v[24:27], a[196:199], a[180:183], v[24:27]
    s_add_u32 s41, s42, 17664
    v_cvt_pk_bf16_f32 v114, v132, v133
    v_mfma_f32_16x16x32_bf16 v[24:27], a[200:203], a[184:187], v[24:27]
    v_exp_f32 v135, v39
    v_mfma_f32_16x16x32_bf16 v[24:27], a[204:207], a[188:191], v[24:27]
    v_or3_b32 v208, v112, v113, v114
    s_waitcnt lgkmcnt(8)
    v_mfma_f32_16x16x32_bf16 v[4:7], a[208:211], a[128:131], v[68:71]
    ds_read_b128 a[192:195], v241 offset:8192
    v_cvt_pk_bf16_f32 v115, v134, v135
    v_mfma_f32_16x16x32_bf16 v[4:7], a[212:215], a[132:135], v[4:7]
    v_exp_f32 v136, v40
    v_mfma_f32_16x16x32_bf16 v[4:7], a[216:219], a[136:139], v[4:7]
    v_exp_f32_e64 v137, v41
    v_mfma_f32_16x16x32_bf16 v[4:7], a[220:223], a[140:143], v[4:7]
    v_exp_f32_e64 v138, v42
    v_mfma_f32_16x16x32_bf16 v[12:15], a[208:211], a[144:147], v[76:79]
    ds_read_b128 a[196:199], v241 offset:10240
    buffer_load_dwordx4 v242, s[16:19], s41 offen offset:0 sc1 lds
    v_mfma_f32_16x16x32_bf16 v[12:15], a[212:215], a[148:151], v[12:15]
    v_exp_f32_e64 v139, v43
    v_mfma_f32_16x16x32_bf16 v[12:15], a[216:219], a[152:155], v[12:15]
    v_exp_f32_e64 v140, v44
    v_mfma_f32_16x16x32_bf16 v[12:15], a[220:223], a[156:159], v[12:15]
    v_exp_f32_e64 v141, v45
    v_mfma_f32_16x16x32_bf16 v[20:23], a[208:211], a[160:163], v[84:87]
    ds_read_b128 a[200:203], v241 offset:12288
    v_cvt_pk_bf16_f32 v116, v136, v137
    v_mfma_f32_16x16x32_bf16 v[20:23], a[212:215], a[164:167], v[20:23]
    v_exp_f32_e64 v142, v46
    v_mfma_f32_16x16x32_bf16 v[20:23], a[216:219], a[168:171], v[20:23]
    v_exp_f32_e64 v143, v47
    v_mfma_f32_16x16x32_bf16 v[20:23], a[220:223], a[172:175], v[20:23]
    v_or3_b32 v208, v208, v115, v116
    v_cvt_pk_bf16_f32 v117, v138, v139
    v_mfma_f32_16x16x32_bf16 v[28:31], a[208:211], a[176:179], v[92:95]
    ds_read_b128 a[204:207], v241 offset:14336
    buffer_load_dwordx4 v242, s[16:19], s41 offen offset:1024 sc1 lds
    v_mfma_f32_16x16x32_bf16 v[28:31], a[212:215], a[180:183], v[28:31]
    v_exp_f32_e64 v128, v48
    v_mfma_f32_16x16x32_bf16 v[28:31], a[216:219], a[184:187], v[28:31]
    v_exp_f32_e64 v129, v49
    v_mfma_f32_16x16x32_bf16 v[28:31], a[220:223], a[188:191], v[28:31]
    v_cvt_pk_bf16_f32 v118, v140, v141
    s_waitcnt lgkmcnt(8)
    v_mfma_f32_16x16x32_bf16 a[0:3], a[224:227], v[96:99], a[0:3]
    ds_read_b128 a[208:211], v241 offset:9216
    v_or3_b32 v208, v208, v117, v118
    v_mfma_f32_16x16x32_bf16 a[32:35], a[224:227], v[100:103], a[32:35]
    v_exp_f32 v130, v50
    v_mfma_f32_16x16x32_bf16 a[64:67], a[224:227], v[104:107], a[64:67]
    v_exp_f32_e64 v131, v51
    v_mfma_f32_16x16x32_bf16 a[96:99], a[224:227], v[108:111], a[96:99]
    v_exp_f32_e64 v132, v52
    v_mfma_f32_16x16x32_bf16 a[4:7], a[228:231], v[96:99], a[4:7]
    ds_read_b128 a[212:215], v241 offset:11264
    v_cvt_pk_bf16_f32 v119, v142, v143
    v_mfma_f32_16x16x32_bf16 a[36:39], a[228:231], v[100:103], a[36:39]
    buffer_load_dwordx4 v242, s[16:19], s41 offen offset:2048 sc1 lds
    v_cvt_pk_bf16_f32 v120, v128, v129
    v_mfma_f32_16x16x32_bf16 a[68:71], a[228:231], v[104:107], a[68:71]
    v_exp_f32_e64 v133, v53
    v_mfma_f32_16x16x32_bf16 a[100:103], a[228:231], v[108:111], a[100:103]
    v_exp_f32_e64 v134, v54
    v_mfma_f32_16x16x32_bf16 a[8:11], a[232:235], v[96:99], a[8:11]
    ds_read_b128 a[216:219], v241 offset:13312
    v_or3_b32 v208, v208, v119, v120
    v_mfma_f32_16x16x32_bf16 a[40:43], a[232:235], v[100:103], a[40:43]
    v_exp_f32_e64 v135, v55
    v_mfma_f32_16x16x32_bf16 a[72:75], a[232:235], v[104:107], a[72:75]
    v_exp_f32_e64 v136, v56
    v_mfma_f32_16x16x32_bf16 a[104:107], a[232:235], v[108:111], a[104:107]
    v_exp_f32_e64 v137, v57
    v_mfma_f32_16x16x32_bf16 a[12:15], a[236:239], v[96:99], a[12:15]
    ds_read_b128 a[220:223], v241 offset:15360
    v_cvt_pk_bf16_f32 v121, v130, v131
    v_mfma_f32_16x16x32_bf16 a[44:47], a[236:239], v[100:103], a[44:47]
    v_cvt_pk_bf16_f32 v122, v132, v133
    v_or3_b32 v208, v208, v121, v122
    v_mfma_f32_16x16x32_bf16 a[76:79], a[236:239], v[104:107], a[76:79]
    buffer_load_dwordx4 v242, s[16:19], s41 offen offset:3072 sc1 lds
    v_cvt_pk_bf16_f32 v123, v134, v135
    v_mfma_f32_16x16x32_bf16 a[108:111], a[236:239], v[108:111], a[108:111]
    v_cvt_pk_bf16_f32 v124, v136, v137
    s_waitcnt lgkmcnt(8)
    v_mfma_f32_16x16x32_bf16 a[16:19], a[240:243], v[96:99], a[16:19]
    ds_read_b128 a[224:227], v241 offset:24576
    v_or3_b32 v208, v208, v123, v124
    v_mfma_f32_16x16x32_bf16 a[48:51], a[240:243], v[100:103], a[48:51]
    v_exp_f32 v138, v58
    v_mfma_f32_16x16x32_bf16 a[80:83], a[240:243], v[104:107], a[80:83]
    v_exp_f32_e64 v139, v59
    v_mfma_f32_16x16x32_bf16 a[112:115], a[240:243], v[108:111], a[112:115]
    v_exp_f32_e64 v140, v60
    v_mfma_f32_16x16x32_bf16 a[20:23], a[244:247], v[96:99], a[20:23]
    ds_read_b128 a[228:231], v241 offset:25600
    v_cvt_pk_bf16_f32 v125, v138, v139
    v_mfma_f32_16x16x32_bf16 a[52:55], a[244:247], v[100:103], a[52:55]
    v_exp_f32_e64 v141, v61
    v_mfma_f32_16x16x32_bf16 a[84:87], a[244:247], v[104:107], a[84:87]
    v_exp_f32_e64 v142, v62
    v_mfma_f32_16x16x32_bf16 a[116:119], a[244:247], v[108:111], a[116:119]
    s_add_u32 s35, s35, 32768
    v_cvt_pk_bf16_f32 v126, v140, v141
    v_mfma_f32_16x16x32_bf16 a[24:27], a[248:251], v[96:99], a[24:27]
    ds_read_b128 a[232:235], v241 offset:26624
    v_or3_b32 v208, v208, v125, v126
    v_mfma_f32_16x16x32_bf16 a[56:59], a[248:251], v[100:103], a[56:59]
    s_cmp_ge_u32 s35, 163840
    s_cselect_b32 s35, 0, s35
    v_mfma_f32_16x16x32_bf16 a[88:91], a[248:251], v[104:107], a[88:91]
    v_exp_f32 v143, v63
    v_mfma_f32_16x16x32_bf16 a[120:123], a[248:251], v[108:111], a[120:123]
    v_cvt_pk_bf16_f32 v127, v142, v143
    v_or_b32_e64 v208, v208, v127
    v_mfma_f32_16x16x32_bf16 a[28:31], a[252:255], v[96:99], a[28:31]
    ds_read_b128 a[236:239], v241 offset:27648
    v_and_b32_e64 v208, s38, v208
    v_mfma_f32_16x16x32_bf16 a[60:63], a[252:255], v[100:103], a[60:63]
    v_cmp_ne_u32_e64 vcc, 0, v208
    v_mfma_f32_16x16x32_bf16 a[92:95], a[252:255], v[104:107], a[92:95]
    v_mfma_f32_16x16x32_bf16 a[124:127], a[252:255], v[108:111], a[124:127]
    v_mfma_f32_16x16x32_bf16 v[144:147], v[204:207], v[96:99], v[144:147]
    v_mfma_f32_16x16x32_bf16 v[148:151], v[204:207], v[100:103], v[148:151]
    v_mfma_f32_16x16x32_bf16 v[152:155], v[204:207], v[104:107], v[152:155]
    v_mfma_f32_16x16x32_bf16 v[156:159], v[204:207], v[108:111], v[156:159]
    s_cbranch_vccnz kf_rare6
kf_rr5:
    s_sub_u32 s36, s36, 1
    s_cbranch_scc1 kf_fix11
kf_fixr12:
    s_waitcnt lgkmcnt(8)
    v_mfma_f32_16x16x32_bf16 v[32:35], a[192:195], a[128:131], v[64:67]
    ds_read_b128 a[240:243], v241 offset:28672
    s_waitcnt vmcnt(11)
    v_mfma_f32_16x16x32_bf16 v[32:35], a[196:199], a[132:135], v[32:35]
    v_exp_f32 v128, v0
    v_mfma_f32_16x16x32_bf16 v[32:35], a[200:203], a[136:139], v[32:35]
    v_exp_f32_e64 v129, v1
    v_mfma_f32_16x16x32_bf16 v[32:35], a[204:207], a[140:143], v[32:35]
    v_exp_f32_e64 v130, v2
    v_mfma_f32_16x16x32_bf16 v[40:43], a[192:195], a[144:147], v[72:75]
    ds_read_b128 a[244:247], v241 offset:29696
    buffer_store_dwordx4 v[196:199], v255, s[48:51], s45 offen offset:256 sc1
    v_mfma_f32_16x16x32_bf16 v[40:43], a[196:199], a[148:151], v[40:43]
    s_add_u32 s101, s101, 57344
    buffer_load_dwordx4 v[196:199], v253, s[52:55], s101 offen
    v_mfma_f32_16x16x32_bf16 v[40:43], a[200:203], a[152:155], v[40:43]
    v_exp_f32_e64 v131, v3
    v_mfma_f32_16x16x32_bf16 v[40:43], a[204:207], a[156:159], v[40:43]
    v_exp_f32_e64 v132, v4
    v_mfma_f32_16x16x32_bf16 v[48:51], a[192:195], a[160:163], v[80:83]
    ds_read_b128 a[248:251], v241 offset:30720
    v_cvt_pk_bf16_f32 v96, v128, v129
    v_mfma_f32_16x16x32_bf16 v[48:51], a[196:199], a[164:167], v[48:51]
    s_cmp_lt_u32 s44, s47
    s_cselect_b32 s45, s46, s43
    v_mfma_f32_16x16x32_bf16 v[48:51], a[200:203], a[168:171], v[48:51]
    v_exp_f32_e64 v133, v5
    v_mfma_f32_16x16x32_bf16 v[48:51], a[204:207], a[172:175], v[48:51]
    v_exp_f32_e64 v134, v6
    v_mfma_f32_16x16x32_bf16 v[56:59], a[192:195], a[176:179], v[88:91]
    ds_read_b128 a[252:255], v241 offset:31744
    s_add_u32 s44, s44, 128
    v_mfma_f32_16x16x32_bf16 v[56:59], a[196:199], a[180:183], v[56:59]
    s_add_u32 s46, s46, 262144
    v_cvt_pk_bf16_f32 v97, v130, v131
    v_mfma_f32_16x16x32_bf16 v[56:59], a[200:203], a[184:187], v[56:59]
    v_exp_f32_e64 v135, v7
    v_mfma_f32_16x16x32_bf16 v[56:59], a[204:207], a[188:191], v[56:59]
    v_cvt_pk_bf16_f32 v98, v132, v133
    s_waitcnt lgkmcnt(8)
    v_mfma_f32_16x16x32_bf16 v[36:39], a[208:211], a[128:131], v[68:71]
    s_waitcnt vmcnt(16)
    s_barrier
    v_add_u32 v241, s35, v240
    ds_read_b128 a[192:195], v241 offset:0
    v_mfma_f32_16x16x32_bf16 v[36:39], a[212:215], a[132:135], v[36:39]
    v_exp_f32_e64 v136, v8
    v_mfma_f32_16x16x32_bf16 v[36:39], a[216:219], a[136:139], v[36:39]
    v_exp_f32_e64 v137, v9
    v_mfma_f32_16x16x32_bf16 v[36:39], a[220:223], a[140:143], v[36:39]
    v_exp_f32_e64 v138, v10
    v_mfma_f32_16x16x32_bf16 v[44:47], a[208:211], a[144:147], v[76:79]
    ds_read_b128 a[196:199], v241 offset:2048
    s_add_u32 m0, s34, 16384
    v_mfma_f32_16x16x32_bf16 v[44:47], a[212:215], a[148:151], v[44:47]
    s_add_u32 s34, s34, 32768
    v_or3_b32 v208, v96, v97, v98
    v_mfma_f32_16x16x32_bf16 v[44:47], a[216:219], a[152:155], v[44:47]
    s_cmp_ge_u32 s34, 163840
    s_cselect_b32 s34, s37, s34
    v_mfma_f32_16x16x32_bf16 v[44:47], a[220:223], a[156:159], v[44:47]
    v_exp_f32 v139, v11
    v_mfma_f32_16x16x32_bf16 v[52:55], a[208:211], a[160:163], v[84:87]
    ds_read_b128 a[200:203], v241 offset:4096
    v_cvt_pk_bf16_f32 v99, v134, v135
    v_mfma_f32_16x16x32_bf16 v[52:55], a[212:215], a[164:167], v[52:55]
    v_exp_f32_e64 v140, v12
    v_mfma_f32_16x16x32_bf16 v[52:55], a[216:219], a[168:171], v[52:55]
    v_exp_f32_e64 v141, v13
    v_mfma_f32_16x16x32_bf16 v[52:55], a[220:223], a[172:175], v[52:55]
    v_cvt_pk_bf16_f32 v100, v136, v137
    buffer_load_dwordx4 v242, s[16:19], s42 offen offset:0 sc1 lds
    v_mfma_f32_16x16x32_bf16 v[60:63], a[208:211], a[176:179], v[92:95]
    ds_read_b128 a[204:207], v241 offset:6144
    v_or3_b32 v208, v208, v99, v100
    v_mfma_f32_16x16x32_bf16 v[60:63], a[212:215], a[180:183], v[60:63]
    v_exp_f32_e64 v142, v14
    v_mfma_f32_16x16x32_bf16 v[60:63], a[216:219], a[184:187], v[60:63]
    v_exp_f32_e64 v143, v15
    v_mfma_f32_16x16x32_bf16 v[60:63], a[220:223], a[188:191], v[60:63]
    v_cvt_pk_bf16_f32 v101, v138, v139
    s_waitcnt lgkmcnt(8)
    v_mfma_f32_16x16x32_bf16 a[0:3], a[224:227], v[112:115], a[0:3]
    ds_read_b128 a[208:211], v241 offset:1024
    v_cvt_pk_bf16_f32 v102, v140, v141
    v_mfma_f32_16x16x32_bf16 a[32:35], a[224:227], v[116:119], a[32:35]
    v_exp_f32 v128, v16
    v_mfma_f32_16x16x32_bf16 a[64:67], a[224:227], v[120:123], a[64:67]
    v_exp_f32_e64 v129, v17
    v_mfma_f32_16x16x32_bf16 a[96:99], a[224:227], v[124:127], a[96:99]
    v_exp_f32_e64 v130, v18
    v_mfma_f32_16x16x32_bf16 a[4:7], a[228:231], v[112:115], a[4:7]
    ds_read_b128 a[212:215], v241 offset:3072
    buffer_load_dwordx4 v242, s[16:19], s42 offen offset:1024 sc1 lds
    v_mfma_f32_16x16x32_bf16 a[36:39], a[228:231], v[116:119], a[36:39]
    v_exp_f32_e64 v131, v19
    v_mfma_f32_16x16x32_bf16 a[68:71], a[228:231], v[120:123], a[68:71]
    v_or3_b32 v208, v208, v101, v102
    v_cvt_pk_bf16_f32 v103, v142, v143
    v_mfma_f32_16x16x32_bf16 a[100:103], a[228:231], v[124:127], a[100:103]
    v_exp_f32_e64 v132, v20
    v_mfma_f32_16x16x32_bf16 a[8:11], a[232:235], v[112:115], a[8:11]
    ds_read_b128 a[216:219], v241 offset:5120
    v_cvt_pk_bf16_f32 v104, v128, v129
    v_mfma_f32_16x16x32_bf16 a[40:43], a[232:235], v[116:119], a[40:43]
    v_exp_f32_e64 v133, v21
    v_mfma_f32_16x16x32_bf16 a[72:75], a[232:235], v[120:123], a[72:75]
    v_exp_f32_e64 v134, v22
    v_mfma_f32_16x16x32_bf16 a[104:107], a[232:235], v[124:127], a[104:107]
    v_exp_f32_e64 v135, v23
    v_mfma_f32_16x16x32_bf16 a[12:15], a[236:239], v[112:115], a[12:15]
    ds_read_b128 a[220:223], v241 offset:7168
    buffer_load_dwordx4 v242, s[16:19], s42 offen offset:2048 sc1 lds
    v_mfma_f32_16x16x32_bf16 a[44:47], a[236:239], v[116:119], a[44:47]
    v_or3_b32 v208, v208, v103, v104
    v_cvt_pk_bf16_f32 v105, v130, v131
    v_mfma_f32_16x16x32_bf16 a[76:79], a[236:239], v[120:123], a[76:79]
    v_exp_f32_e64 v136, v24
    v_mfma_f32_16x16x32_bf16 a[108:111], a[236:239], v[124:127], a[108:111]
    v_cvt_pk_bf16_f32 v106, v132, v133
    s_waitcnt lgkmcnt(8)
    v_mfma_f32_16x16x32_bf16 a[16:19], a[240:243], v[112:115], a[16:19]
    ds_read_b128 a[224:227], v241 offset:16384
    v_or3_b32 v208, v208, v105, v106
    v_mfma_f32_16x16x32_bf16 a[48:51], a[240:243], v[116:119], a[48:51]
    v_exp_f32 v137, v25
    v_mfma_f32_16x16x32_bf16 a[80:83], a[240:243], v[120:123], a[80:83]
    v_exp_f32_e64 v138, v26
    v_mfma_f32_16x16x32_bf16 a[112:115], a[240:243], v[124:127], a[112:115]
    v_exp_f32_e64 v139, v27
    v_mfma_f32_16x16x32_bf16 a[20:23], a[244:247], v[112:115], a[20:23]
    ds_read_b128 a[228:231], v241 offset:17408
    buffer_load_dwordx4 v242, s[16:19], s42 offen offset:3072 sc1 lds
    v_mfma_f32_16x16x32_bf16 a[52:55], a[244:247], v[116:119], a[52:55]
    s_add_u32 s42, s42, 34048
    v_cvt_pk_bf16_f32 v107, v134, v135
    v_mfma_f32_16x16x32_bf16 a[84:87], a[244:247], v[120:123], a[84:87]
    v_exp_f32_e64 v140, v28
    v_mfma_f32_16x16x32_bf16 a[116:119], a[244:247], v[124:127], a[116:119]
    v_exp_f32_e64 v141, v29
    v_mfma_f32_16x16x32_bf16 a[24:27], a[248:251], v[112:115], a[24:27]
    ds_read_b128 a[232:235], v241 offset:18432
    v_cvt_pk_bf16_f32 v108, v136, v137
    v_mfma_f32_16x16x32_bf16 a[56:59], a[248:251], v[116:119], a[56:59]
    v_exp_f32_e64 v142, v30
    v_mfma_f32_16x16x32_bf16 a[88:91], a[248:251], v[120:123], a[88:91]
    v_exp_f32_e64 v143, v31
    v_mfma_f32_16x16x32_bf16 a[120:123], a[248:251], v[124:127], a[120:123]
    buffer_load_dword v252, v251, s[60:63], s100 offen
    s_add_u32 s100, s100, 2048
    v_mfma_f32_16x16x32_bf16 a[28:31], a[252:255], v[112:115], a[28:31]
    ds_read_b128 a[236:239], v241 offset:19456
    v_or3_b32 v208, v208, v107, v108
    v_mfma_f32_16x16x32_bf16 a[60:63], a[252:255], v[116:119], a[60:63]
    v_cvt_pk_bf16_f32 v109, v138, v139
    v_cvt_pk_bf16_f32 v110, v140, v141
    v_mfma_f32_16x16x32_bf16 a[92:95], a[252:255], v[120:123], a[92:95]
    v_or3_b32 v208, v208, v109, v110
    v_cvt_pk_bf16_f32 v111, v142, v143
    v_mfma_f32_16x16x32_bf16 a[124:127], a[252:255], v[124:127], a[124:127]
    v_or_b32 v208, v208, v111
    v_and_b32 v208, s38, v208
    v_mfma_f32_16x16x32_bf16 v[144:147], v[204:207], v[112:115], v[144:147]
    v_cmp_ne_u32_e64 vcc, 0, v208
    v_mfma_f32_16x16x32_bf16 v[148:151], v[204:207], v[116:119], v[148:151]
    v_mfma_f32_16x16x32_bf16 v[152:155], v[204:207], v[120:123], v[152:155]
    v_mfma_f32_16x16x32_bf16 v[156:159], v[204:207], v[124:127], v[156:159]
    s_cbranch_vccnz kf_rare10
kf_rr9:
ka_p1_e:
    s_sub_u32 s26, s26, 1
    s_cbranch_scc0 ka_p1
    s_branch ka_p1_x
kf_fix7:
    s_mov_b32 s24, 0
    s_branch kf_fix7c
kf_fix11:
    s_mov_b32 s24, 1
kf_fix7c:
    s_cmp_eq_u32 s33, 0
    s_cbranch_scc0 kf_fix7f
    s_mov_b32 s36, 0
    s_mov_b32 s33, 1
    v_add_f32 v64, v224, v200
    v_add_f32 v65, v224, v201
    v_add_f32 v66, v224, v202
    v_add_f32 v67, v224, v203
    v_add_f32 v68, v224, v209
    v_add_f32 v69, v224, v210
    v_add_f32 v70, v224, v211
    v_add_f32 v71, v224, v212
    v_add_f32 v72, v225, v213
    v_add_f32 v73, v225, v214
    v_add_f32 v74, v225, v215
    v_add_f32 v75, v225, v216
    v_add_f32 v76, v225, v217
    v_add_f32 v77, v225, v218
    v_add_f32 v78, v225, v219
    v_add_f32 v79, v225, v220
    s_cmp_eq_u32 s24, 0
    s_cbranch_scc1 kf_fixr8
    s_branch kf_fixr12
kf_fix7f:
    s_mov_b32 s36, 0x1000
    v_mov_b32 v64, 0xf1800000
    v_mov_b32 v65, v64
    v_mov_b32 v66, v64
    v_mov_b32 v67, v64
    v_mov_b32 v68, v64
    v_mov_b32 v69, v64
    v_mov_b32 v70, v64
    v_mov_b32 v71, v64
    v_mov_b32 v72, v64
    v_mov_b32 v73, v64
    v_mov_b32 v74, v64
    v_mov_b32 v75, v64
    v_mov_b32 v76, v64
    v_mov_b32 v77, v64
    v_mov_b32 v78, v64
    v_mov_b32 v79, v64
    s_cmp_eq_u32 s24, 0
    s_cbranch_scc1 kf_fixr8
    s_branch kf_fixr12
kf_fix15:
    s_mov_b32 s24, 0
    s_branch kf_fix15c
kf_fix19:
    s_mov_b32 s24, 1
kf_fix15c:
    s_cmp_eq_u32 s33, 0
    s_cbranch_scc0 kf_fix15f
    s_mov_b32 s36, 0
    s_mov_b32 s33, 1
    v_add_f32 v80, v226, v200
    v_add_f32 v81, v226, v201
    v_add_f32 v82, v226, v202
    v_add_f32 v83, v226, v203
    v_add_f32 v84, v226, v209
    v_add_f32 v85, v226, v210
    v_add_f32 v86, v226, v211
    v_add_f32 v87, v226, v212
    v_add_f32 v88, v227, v213
    v_add_f32 v89, v227, v214
    v_add_f32 v90, v227, v215
    v_add_f32 v91, v227, v216
    v_add_f32 v92, v227, v217
    v_add_f32 v93, v227, v218
    v_add_f32 v94, v227, v219
    v_add_f32 v95, v227, v220
    s_cmp_eq_u32 s24, 0
    s_cbranch_scc1 kf_fixr16
    s_branch kf_fixr20
kf_fix15f:
    s_mov_b32 s36, 0x1000
    v_mov_b32 v80, 0xf1800000
    v_mov_b32 v81, v80
    v_mov_b32 v82, v80
    v_mov_b32 v83, v80
    v_mov_b32 v84, v80
    v_mov_b32 v85, v80
    v_mov_b32 v86, v80
    v_mov_b32 v87, v80
    v_mov_b32 v88, v80
    v_mov_b32 v89, v80
    v_mov_b32 v90, v80
    v_mov_b32 v91, v80
    v_mov_b32 v92, v80
    v_mov_b32 v93, v80
    v_mov_b32 v94, v80
    v_mov_b32_e64 v95, v80
    s_cmp_eq_u32 s24, 0
    s_cbranch_scc1 kf_fixr16
    s_branch kf_fixr20
ka_p1_x:
    s_lshl2_add_u32 s36, s5, s6
    s_lshl1_add_u32 s36, s31, s36
    s_sub_u32 s36, 61, s36
    s_mov_b32 s33, 0
    s_sub_u32 s36, s36, 1
    s_cbranch_scc1 kf_fix15
kf_fixr16:
    s_waitcnt lgkmcnt(8)
    v_mfma_f32_16x16x32_bf16 v[16:19], a[192:195], a[160:163], v[80:83]
    ds_read_b128 a[240:243], v241 offset:20480
    ds_read_b128 a[244:247], v241 offset:21504
    v_mfma_f32_16x16x32_bf16 v[16:19], a[196:199], a[164:167], v[16:19]
    s_waitcnt vmcnt(11)
    v_exp_f32 v128, v32
    v_mfma_f32_16x16x32_bf16 v[16:19], a[200:203], a[168:171], v[16:19]
    v_exp_f32_e64 v129, v33
    v_mfma_f32_16x16x32_bf16 v[16:19], a[204:207], a[172:175], v[16:19]
    buffer_store_dwordx4 v[192:195], v255, s[48:51], s45 offen offset:0 sc1
    v_exp_f32_e64 v130, v34
    v_mfma_f32_16x16x32_bf16 v[24:27], a[192:195], a[176:179], v[88:91]
    ds_read_b128 a[248:251], v241 offset:22528
    ds_read_b128 a[252:255], v241 offset:23552
    v_mfma_f32_16x16x32_bf16 v[24:27], a[196:199], a[180:183], v[24:27]
    v_exp_f32_e64 v131, v35
    v_mfma_f32_16x16x32_bf16 v[24:27], a[200:203], a[184:187], v[24:27]
    v_exp_f32_e64 v132, v36
    v_cvt_pk_bf16_f32 v112, v128, v129
    v_mfma_f32_16x16x32_bf16 v[24:27], a[204:207], a[188:191], v[24:27]
    s_mov_b32 m0, s34
    s_waitcnt lgkmcnt(8)
    v_mfma_f32_16x16x32_bf16 v[20:23], a[208:211], a[160:163], v[84:87]
    ds_read_b128 a[192:195], v241 offset:8192
    ds_read_b128 a[196:199], v241 offset:10240
    v_mfma_f32_16x16x32_bf16 v[20:23], a[212:215], a[164:167], v[20:23]
    s_add_u32 s41, s42, 17664
    v_exp_f32_e64 v133, v37
    v_mfma_f32_16x16x32_bf16 v[20:23], a[216:219], a[168:171], v[20:23]
    v_exp_f32_e64 v134, v38
    v_mfma_f32_16x16x32_bf16 v[20:23], a[220:223], a[172:175], v[20:23]
    v_exp_f32_e64 v135, v39
    v_mfma_f32_16x16x32_bf16 v[28:31], a[208:211], a[176:179], v[92:95]
    ds_read_b128 a[200:203], v241 offset:12288
    ds_read_b128 a[204:207], v241 offset:14336
    v_cvt_pk_bf16_f32 v113, v130, v131
    v_mfma_f32_16x16x32_bf16 v[28:31], a[212:215], a[180:183], v[28:31]
    v_exp_f32_e64 v136, v40
    v_mfma_f32_16x16x32_bf16 v[28:31], a[216:219], a[184:187], v[28:31]
    v_exp_f32_e64 v137, v41
    v_mfma_f32_16x16x32_bf16 v[28:31], a[220:223], a[188:191], v[28:31]
    v_cvt_pk_bf16_f32 v114, v132, v133
    buffer_load_dwordx4 v242, s[16:19], s41 offen offset:0 sc1 lds
    s_waitcnt lgkmcnt(8)
    v_mfma_f32_16x16x32_bf16 a[0:3], a[224:227], v[96:99], a[0:3]
    ds_read_b128 a[208:211], v241 offset:9216
    v_or3_b32 v208, v112, v113, v114
    v_mfma_f32_16x16x32_bf16 a[32:35], a[224:227], v[100:103], a[32:35]
    v_exp_f32 v138, v42
    v_mfma_f32_16x16x32_bf16 a[64:67], a[224:227], v[104:107], a[64:67]
    v_exp_f32_e64 v139, v43
    v_cvt_pk_bf16_f32 v115, v134, v135
    v_mfma_f32_16x16x32_bf16 a[96:99], a[224:227], v[108:111], a[96:99]
    v_exp_f32_e64 v140, v44
    v_mfma_f32_16x16x32_bf16 a[4:7], a[228:231], v[96:99], a[4:7]
    ds_read_b128 a[212:215], v241 offset:11264
    v_cvt_pk_bf16_f32 v116, v136, v137
    v_mfma_f32_16x16x32_bf16 a[36:39], a[228:231], v[100:103], a[36:39]
    buffer_load_dwordx4 v242, s[16:19], s41 offen offset:1024 sc1 lds
    v_exp_f32_e64 v141, v45
    v_mfma_f32_16x16x32_bf16 a[68:71], a[228:231], v[104:107], a[68:71]
    v_exp_f32_e64 v142, v46
    v_mfma_f32_16x16x32_bf16 a[100:103], a[228:231], v[108:111], a[100:103]
    v_exp_f32_e64 v143, v47
    v_mfma_f32_16x16x32_bf16 a[8:11], a[232:235], v[96:99], a[8:11]
    ds_read_b128 a[216:219], v241 offset:13312
    v_or3_b32 v208, v208, v115, v116
    v_cvt_pk_bf16_f32 v117, v138, v139
    v_mfma_f32_16x16x32_bf16 a[40:43], a[232:235], v[100:103], a[40:43]
    v_exp_f32_e64 v128, v48
    v_mfma_f32_16x16x32_bf16 a[72:75], a[232:235], v[104:107], a[72:75]
    v_exp_f32_e64 v129, v49
    v_mfma_f32_16x16x32_bf16 a[104:107], a[232:235], v[108:111], a[104:107]
    v_cvt_pk_bf16_f32 v118, v140, v141
    v_exp_f32_e64 v130, v50
    v_mfma_f32_16x16x32_bf16 a[12:15], a[236:239], v[96:99], a[12:15]
    ds_read_b128 a[220:223], v241 offset:15360
    buffer_load_dwordx4 v242, s[16:19], s41 offen offset:2048 sc1 lds
    v_mfma_f32_16x16x32_bf16 a[44:47], a[236:239], v[100:103], a[44:47]
    v_exp_f32_e64 v131, v51
    v_or3_b32 v208, v208, v117, v118
    v_mfma_f32_16x16x32_bf16 a[76:79], a[236:239], v[104:107], a[76:79]
    v_exp_f32_e64 v132, v52
    v_mfma_f32_16x16x32_bf16 a[108:111], a[236:239], v[108:111], a[108:111]
    v_cvt_pk_bf16_f32 v119, v142, v143
    s_waitcnt lgkmcnt(8)
    v_mfma_f32_16x16x32_bf16 a[16:19], a[240:243], v[96:99], a[16:19]
    ds_read_b128 a[224:227], v241 offset:24576
    v_exp_f32 v133, v53
    v_mfma_f32_16x16x32_bf16 a[48:51], a[240:243], v[100:103], a[48:51]
    v_cvt_pk_bf16_f32 v120, v128, v129
    v_or3_b32 v208, v208, v119, v120
    v_mfma_f32_16x16x32_bf16 a[80:83], a[240:243], v[104:107], a[80:83]
    v_exp_f32_e64 v134, v54
    v_mfma_f32_16x16x32_bf16 a[112:115], a[240:243], v[108:111], a[112:115]
    buffer_load_dwordx4 v242, s[16:19], s41 offen offset:3072 sc1 lds
    v_exp_f32_e64 v135, v55
    v_mfma_f32_16x16x32_bf16 a[20:23], a[244:247], v[96:99], a[20:23]
    ds_read_b128 a[228:231], v241 offset:25600
    v_cvt_pk_bf16_f32 v121, v130, v131
    v_mfma_f32_16x16x32_bf16 a[52:55], a[244:247], v[100:103], a[52:55]
    v_exp_f32_e64 v136, v56
    v_mfma_f32_16x16x32_bf16 a[84:87], a[244:247], v[104:107], a[84:87]
    v_exp_f32_e64 v137, v57
    v_cvt_pk_bf16_f32 v122, v132, v133
    v_mfma_f32_16x16x32_bf16 a[116:119], a[244:247], v[108:111], a[116:119]
    v_exp_f32_e64 v138, v58
    v_mfma_f32_16x16x32_bf16 a[24:27], a[248:251], v[96:99], a[24:27]
    ds_read_b128 a[232:235], v241 offset:26624
    v_or3_b32 v208, v208, v121, v122
    v_mfma_f32_16x16x32_bf16 a[56:59], a[248:251], v[100:103], a[56:59]
    v_exp_f32_e64 v139, v59
    v_cvt_pk_bf16_f32 v123, v134, v135
    v_mfma_f32_16x16x32_bf16 a[88:91], a[248:251], v[104:107], a[88:91]
    v_exp_f32_e64 v140, v60
    v_mfma_f32_16x16x32_bf16 a[120:123], a[248:251], v[108:111], a[120:123]
    v_exp_f32_e64 v141, v61
    v_mfma_f32_16x16x32_bf16 a[28:31], a[252:255], v[96:99], a[28:31]
    ds_read_b128 a[236:239], v241 offset:27648
    v_cvt_pk_bf16_f32 v124, v136, v137
    s_add_u32 s35, s35, 32768
    v_mfma_f32_16x16x32_bf16 a[60:63], a[252:255], v[100:103], a[60:63]
    s_cmp_ge_u32 s35, 163840
    s_cselect_b32 s35, 0, s35
    v_mfma_f32_16x16x32_bf16 a[92:95], a[252:255], v[104:107], a[92:95]
    v_exp_f32 v142, v62
    v_mfma_f32_16x16x32_bf16 a[124:127], a[252:255], v[108:111], a[124:127]
    v_exp_f32_e64 v143, v63
    v_or3_b32 v208, v208, v123, v124
    v_mfma_f32_16x16x32_bf16 v[144:147], v[204:207], v[96:99], v[144:147]
    v_cvt_pk_bf16_f32 v125, v138, v139
    v_cvt_pk_bf16_f32 v126, v140, v141
    v_mfma_f32_16x16x32_bf16 v[148:151], v[204:207], v[100:103], v[148:151]
    v_or3_b32 v208, v208, v125, v126
    v_cvt_pk_bf16_f32 v127, v142, v143
    v_mfma_f32_16x16x32_bf16 v[152:155], v[204:207], v[104:107], v[152:155]
    v_or_b32 v208, v208, v127
    v_and_b32 v208, s38, v208
    v_cmp_ne_u32_e64 vcc, 0, v208
    v_mfma_f32_16x16x32_bf16 v[156:159], v[204:207], v[108:111], v[156:159]
    s_cbranch_vccnz kf_rare14
kf_rr13:
    s_sub_u32 s36, s36, 1
    s_cbranch_scc1 kf_fix19
kf_fixr20:
    s_waitcnt lgkmcnt(8)
    v_mfma_f32_16x16x32_bf16 v[48:51], a[192:195], a[160:163], v[80:83]
    ds_read_b128 a[240:243], v241 offset:28672
    ds_read_b128 a[244:247], v241 offset:29696
    v_mfma_f32_16x16x32_bf16 v[48:51], a[196:199], a[164:167], v[48:51]
    v_exp_f32_e64 v128, v16
    v_mfma_f32_16x16x32_bf16 v[48:51], a[200:203], a[168:171], v[48:51]
    v_exp_f32_e64 v129, v17
    v_mfma_f32_16x16x32_bf16 v[48:51], a[204:207], a[172:175], v[48:51]
    s_waitcnt vmcnt(10)
    buffer_store_dwordx4 v[196:199], v255, s[48:51], s45 offen offset:256 sc1
    v_mfma_f32_16x16x32_bf16 v[56:59], a[192:195], a[176:179], v[88:91]
    ds_read_b128 a[248:251], v241 offset:30720
    ds_read_b128 a[252:255], v241 offset:31744
    v_mfma_f32_16x16x32_bf16 v[56:59], a[196:199], a[180:183], v[56:59]
    v_exp_f32 v130, v18
    v_mfma_f32_16x16x32_bf16 v[56:59], a[200:203], a[184:187], v[56:59]
    v_exp_f32_e64 v131, v19
    v_mfma_f32_16x16x32_bf16 v[56:59], a[204:207], a[188:191], v[56:59]
    v_cvt_pk_bf16_f32 v104, v128, v129
    s_waitcnt lgkmcnt(8)
    v_mfma_f32_16x16x32_bf16 v[52:55], a[208:211], a[160:163], v[84:87]
    s_waitcnt vmcnt(14)
    s_barrier
    v_add_u32 v241, s35, v240
    ds_read_b128 a[192:195], v241 offset:0
    v_mfma_f32_16x16x32_bf16 v[52:55], a[212:215], a[164:167], v[52:55]
    s_add_u32 m0, s34, 16384
    s_add_u32 s34, s34, 32768
    v_mfma_f32_16x16x32_bf16 v[52:55], a[216:219], a[168:171], v[52:55]
    ds_read_b128 a[196:199], v241 offset:2048
    v_cvt_pk_bf16_f32 v105, v130, v131
    v_mfma_f32_16x16x32_bf16 v[52:55], a[220:223], a[172:175], v[52:55]
    s_cmp_ge_u32 s34, 163840
    s_cselect_b32 s34, s37, s34
    v_mfma_f32_16x16x32_bf16 v[60:63], a[208:211], a[176:179], v[92:95]
    ds_read_b128 a[200:203], v241 offset:4096
    ds_read_b128 a[204:207], v241 offset:6144
    v_mfma_f32_16x16x32_bf16 v[60:63], a[212:215], a[180:183], v[60:63]
    v_exp_f32 v132, v20
    v_mfma_f32_16x16x32_bf16 v[60:63], a[216:219], a[184:187], v[60:63]
    v_exp_f32_e64 v133, v21
    v_mfma_f32_16x16x32_bf16 v[60:63], a[220:223], a[188:191], v[60:63]
    v_cvt_pk_bf16_f32 v106, v132, v133
    s_waitcnt lgkmcnt(8)
    v_mfma_f32_16x16x32_bf16 a[0:3], a[224:227], v[112:115], a[0:3]
    ds_read_b128 a[208:211], v241 offset:1024
    v_or3_b32 v208, v104, v105, v106
    v_mfma_f32_16x16x32_bf16 a[32:35], a[224:227], v[116:119], a[32:35]
    v_exp_f32 v134, v22
    v_mfma_f32_16x16x32_bf16 a[64:67], a[224:227], v[120:123], a[64:67]
    buffer_load_dwordx4 v242, s[16:19], s42 offen offset:0 sc1 lds
    v_mfma_f32_16x16x32_bf16 a[96:99], a[224:227], v[124:127], a[96:99]
    v_exp_f32_e64 v135, v23
    v_mfma_f32_16x16x32_bf16 a[4:7], a[228:231], v[112:115], a[4:7]
    ds_read_b128 a[212:215], v241 offset:3072
    v_cvt_pk_bf16_f32 v107, v134, v135
    v_mfma_f32_16x16x32_bf16 a[36:39], a[228:231], v[116:119], a[36:39]
    v_exp_f32_e64 v136, v24
    v_mfma_f32_16x16x32_bf16 a[68:71], a[228:231], v[120:123], a[68:71]
    v_exp_f32_e64 v137, v25
    v_mfma_f32_16x16x32_bf16 a[100:103], a[228:231], v[124:127], a[100:103]
    v_exp_f32_e64 v138, v26
    v_mfma_f32_16x16x32_bf16 a[8:11], a[232:235], v[112:115], a[8:11]
    ds_read_b128 a[216:219], v241 offset:5120
    v_cvt_pk_bf16_f32 v108, v136, v137
    v_mfma_f32_16x16x32_bf16 a[40:43], a[232:235], v[116:119], a[40:43]
    buffer_load_dwordx4 v242, s[16:19], s42 offen offset:1024 sc1 lds
    v_or3_b32 v208, v208, v107, v108
    v_mfma_f32_16x16x32_bf16 a[72:75], a[232:235], v[120:123], a[72:75]
    v_exp_f32_e64 v139, v27
    v_mfma_f32_16x16x32_bf16 a[104:107], a[232:235], v[124:127], a[104:107]
    v_exp_f32_e64 v140, v28
    v_mfma_f32_16x16x32_bf16 a[12:15], a[236:239], v[112:115], a[12:15]
    ds_read_b128 a[220:223], v241 offset:7168
    v_cvt_pk_bf16_f32 v109, v138, v139
    v_mfma_f32_16x16x32_bf16 a[44:47], a[236:239], v[116:119], a[44:47]
    v_exp_f32_e64 v141, v29
    v_mfma_f32_16x16x32_bf16 a[76:79], a[236:239], v[120:123], a[76:79]
    v_exp_f32_e64 v142, v30
    v_mfma_f32_16x16x32_bf16 a[108:111], a[236:239], v[124:127], a[108:111]
    v_cvt_pk_bf16_f32 v110, v140, v141
    s_waitcnt lgkmcnt(8)
    v_mfma_f32_16x16x32_bf16 a[16:19], a[240:243], v[112:115], a[16:19]
    ds_read_b128 a[224:227], v241 offset:16384
    v_or3_b32 v208, v208, v109, v110
    v_mfma_f32_16x16x32_bf16 a[48:51], a[240:243], v[116:119], a[48:51]
    buffer_load_dwordx4 v242, s[16:19], s42 offen offset:2048 sc1 lds
    v_mfma_f32_16x16x32_bf16 a[80:83], a[240:243], v[120:123], a[80:83]
    v_exp_f32 v143, v31
    v_mfma_f32_16x16x32_bf16 a[112:115], a[240:243], v[124:127], a[112:115]
    v_cvt_pk_bf16_f32 v111, v142, v143
    v_or_b32_e64 v208, v208, v111
    v_mfma_f32_16x16x32_bf16 a[20:23], a[244:247], v[112:115], a[20:23]
    ds_read_b128 a[228:231], v241 offset:17408
    v_and_b32_e64 v208, s38, v208
    v_mfma_f32_16x16x32_bf16 a[52:55], a[244:247], v[116:119], a[52:55]
    v_cmp_ne_u32_e64 vcc, 0, v208
    buffer_load_dwordx4 v242, s[16:19], s42 offen offset:3072 sc1 lds
    v_mfma_f32_16x16x32_bf16 a[84:87], a[244:247], v[120:123], a[84:87]
    s_add_u32 s42, s42, 34048
    v_mfma_f32_16x16x32_bf16 a[116:119], a[244:247], v[124:127], a[116:119]
    v_mfma_f32_16x16x32_bf16 a[24:27], a[248:251], v[112:115], a[24:27]
    ds_read_b128 a[232:235], v241 offset:18432
    v_mfma_f32_16x16x32_bf16 a[56:59], a[248:251], v[116:119], a[56:59]
    v_mfma_f32_16x16x32_bf16 a[88:91], a[248:251], v[120:123], a[88:91]
    v_mfma_f32_16x16x32_bf16 a[120:123], a[248:251], v[124:127], a[120:123]
    v_mfma_f32_16x16x32_bf16 a[28:31], a[252:255], v[112:115], a[28:31]
    ds_read_b128 a[236:239], v241 offset:19456
    v_mfma_f32_16x16x32_bf16 a[60:63], a[252:255], v[116:119], a[60:63]
    v_mfma_f32_16x16x32_bf16 a[92:95], a[252:255], v[120:123], a[92:95]
    v_mfma_f32_16x16x32_bf16 a[124:127], a[252:255], v[124:127], a[124:127]
    v_mfma_f32_16x16x32_bf16 v[144:147], v[204:207], v[112:115], v[144:147]
    v_mfma_f32_16x16x32_bf16 v[148:151], v[204:207], v[116:119], v[148:151]
    v_mfma_f32_16x16x32_bf16 v[152:155], v[204:207], v[120:123], v[152:155]
    v_mfma_f32_16x16x32_bf16 v[156:159], v[204:207], v[124:127], v[156:159]
    s_cbranch_vccnz kf_rare18
kf_rr17:
    s_nop 6
    v_rcp_f32 v230, v144
    v_rcp_f32 v231, v148
    v_accvgpr_read_b32 v160, a0
    v_accvgpr_read_b32 v161, a1
    v_accvgpr_read_b32 v162, a2
    v_accvgpr_read_b32 v163, a3
    v_accvgpr_read_b32 v164, a4
    v_accvgpr_read_b32 v165, a5
    v_accvgpr_read_b32 v166, a6
    v_accvgpr_read_b32 v167, a7
    v_mul_f32 v160, v160, v230
    v_mul_f32 v161, v161, v230
    v_mul_f32 v162, v162, v230
    v_mul_f32 v163, v163, v230
    v_mul_f32 v164, v164, v230
    v_mul_f32 v165, v165, v230
    v_mul_f32 v166, v166, v230
    v_mul_f32 v167, v167, v230
    v_cvt_pk_bf16_f32 v176, v160, v161
    v_cvt_pk_bf16_f32 v177, v162, v163
    v_cvt_pk_bf16_f32 v178, v164, v165
    v_cvt_pk_bf16_f32 v179, v166, v167
    buffer_store_dwordx4 v[176:179], v240, s[20:23], s39 offen offset:0 sc1
    v_accvgpr_read_b32 v168, a8
    v_accvgpr_read_b32 v169, a9
    v_accvgpr_read_b32 v170, a10
    v_accvgpr_read_b32 v171, a11
    v_accvgpr_read_b32 v172, a12
    v_accvgpr_read_b32 v173, a13
    v_accvgpr_read_b32 v174, a14
    v_accvgpr_read_b32 v175, a15
    v_mul_f32 v168, v168, v230
    v_mul_f32 v169, v169, v230
    v_mul_f32 v170, v170, v230
    v_mul_f32 v171, v171, v230
    v_mul_f32 v172, v172, v230
    v_mul_f32 v173, v173, v230
    v_mul_f32 v174, v174, v230
    v_mul_f32 v175, v175, v230
    v_cvt_pk_bf16_f32 v180, v168, v169
    v_cvt_pk_bf16_f32 v181, v170, v171
    v_cvt_pk_bf16_f32 v182, v172, v173
    v_cvt_pk_bf16_f32 v183, v174, v175
    buffer_store_dwordx4 v[180:183], v240, s[20:23], s39 offen offset:1024 sc1
    v_accvgpr_read_b32 v160, a16
    v_accvgpr_read_b32 v161, a17
    v_accvgpr_read_b32 v162, a18
    v_accvgpr_read_b32 v163, a19
    v_accvgpr_read_b32 v164, a20
    v_accvgpr_read_b32 v165, a21
    v_accvgpr_read_b32 v166, a22
    v_accvgpr_read_b32 v167, a23
    v_mul_f32 v160, v160, v230
    v_mul_f32 v161, v161, v230
    v_mul_f32 v162, v162, v230
    v_mul_f32 v163, v163, v230
    v_mul_f32 v164, v164, v230
    v_mul_f32 v165, v165, v230
    v_mul_f32 v166, v166, v230
    v_mul_f32 v167, v167, v230
    v_cvt_pk_bf16_f32 v184, v160, v161
    v_cvt_pk_bf16_f32 v185, v162, v163
    v_cvt_pk_bf16_f32 v186, v164, v165
    v_cvt_pk_bf16_f32 v187, v166, v167
    buffer_store_dwordx4 v[184:187], v240, s[20:23], s39 offen offset:2048 sc1
    v_accvgpr_read_b32 v168, a24
    v_accvgpr_read_b32 v169, a25
    v_accvgpr_read_b32 v170, a26
    v_accvgpr_read_b32 v171, a27
    v_accvgpr_read_b32 v172, a28
    v_accvgpr_read_b32 v173, a29
    v_accvgpr_read_b32 v174, a30
    v_accvgpr_read_b32 v175, a31
    v_mul_f32 v168, v168, v230
    v_mul_f32 v169, v169, v230
    v_mul_f32 v170, v170, v230
    v_mul_f32 v171, v171, v230
    v_mul_f32 v172, v172, v230
    v_mul_f32 v173, v173, v230
    v_mul_f32 v174, v174, v230
    v_mul_f32 v175, v175, v230
    v_cvt_pk_bf16_f32 v188, v168, v169
    v_cvt_pk_bf16_f32 v189, v170, v171
    v_cvt_pk_bf16_f32 v190, v172, v173
    v_cvt_pk_bf16_f32 v191, v174, v175
    buffer_store_dwordx4 v[188:191], v240, s[20:23], s39 offen offset:3072 sc1
    v_accvgpr_read_b32 v160, a32
    v_accvgpr_read_b32 v161, a33
    v_accvgpr_read_b32 v162, a34
    v_accvgpr_read_b32 v163, a35
    v_accvgpr_read_b32 v164, a36
    v_accvgpr_read_b32 v165, a37
    v_accvgpr_read_b32 v166, a38
    v_accvgpr_read_b32 v167, a39
    v_mul_f32 v160, v160, v231
    v_mul_f32 v161, v161, v231
    v_mul_f32 v162, v162, v231
    v_mul_f32 v163, v163, v231
    v_mul_f32 v164, v164, v231
    v_mul_f32 v165, v165, v231
    v_mul_f32 v166, v166, v231
    v_mul_f32 v167, v167, v231
    v_cvt_pk_bf16_f32 v176, v160, v161
    v_cvt_pk_bf16_f32 v177, v162, v163
    v_cvt_pk_bf16_f32 v178, v164, v165
    v_cvt_pk_bf16_f32 v179, v166, v167
    buffer_store_dwordx4 v[176:179], v244, s[20:23], s39 offen offset:0 sc1
    v_accvgpr_read_b32 v168, a40
    v_accvgpr_read_b32 v169, a41
    v_accvgpr_read_b32 v170, a42
    v_accvgpr_read_b32 v171, a43
    v_accvgpr_read_b32 v172, a44
    v_accvgpr_read_b32 v173, a45
    v_accvgpr_read_b32 v174, a46
    v_accvgpr_read_b32 v175, a47
    v_mul_f32 v168, v168, v231
    v_mul_f32 v169, v169, v231
    v_mul_f32 v170, v170, v231
    v_mul_f32 v171, v171, v231
    v_mul_f32 v172, v172, v231
    v_mul_f32 v173, v173, v231
    v_mul_f32 v174, v174, v231
    v_mul_f32 v175, v175, v231
    v_cvt_pk_bf16_f32 v180, v168, v169
    v_cvt_pk_bf16_f32 v181, v170, v171
    v_cvt_pk_bf16_f32 v182, v172, v173
    v_cvt_pk_bf16_f32 v183, v174, v175
    buffer_store_dwordx4 v[180:183], v244, s[20:23], s39 offen offset:1024 sc1
    v_accvgpr_read_b32 v160, a48
    v_accvgpr_read_b32 v161, a49
    v_accvgpr_read_b32 v162, a50
    v_accvgpr_read_b32 v163, a51
    v_accvgpr_read_b32 v164, a52
    v_accvgpr_read_b32 v165, a53
    v_accvgpr_read_b32 v166, a54
    v_accvgpr_read_b32 v167, a55
    v_mul_f32 v160, v160, v231
    v_mul_f32 v161, v161, v231
    v_mul_f32 v162, v162, v231
    v_mul_f32 v163, v163, v231
    v_mul_f32 v164, v164, v231
    v_mul_f32 v165, v165, v231
    v_mul_f32 v166, v166, v231
    v_mul_f32 v167, v167, v231
    v_cvt_pk_bf16_f32 v184, v160, v161
    v_cvt_pk_bf16_f32 v185, v162, v163
    v_cvt_pk_bf16_f32 v186, v164, v165
    v_cvt_pk_bf16_f32 v187, v166, v167
    buffer_store_dwordx4 v[184:187], v244, s[20:23], s39 offen offset:2048 sc1
    v_accvgpr_read_b32 v168, a56
    v_accvgpr_read_b32 v169, a57
    v_accvgpr_read_b32 v170, a58
    v_accvgpr_read_b32 v171, a59
    v_accvgpr_read_b32 v172, a60
    v_accvgpr_read_b32 v173, a61
    v_accvgpr_read_b32 v174, a62
    v_accvgpr_read_b32 v175, a63
    v_mul_f32 v168, v168, v231
    v_mul_f32 v169, v169, v231
    v_mul_f32 v170, v170, v231
    v_mul_f32 v171, v171, v231
    v_mul_f32 v172, v172, v231
    v_mul_f32 v173, v173, v231
    v_mul_f32 v174, v174, v231
    v_mul_f32 v175, v175, v231
    v_cvt_pk_bf16_f32 v188, v168, v169
    v_cvt_pk_bf16_f32 v189, v170, v171
    v_cvt_pk_bf16_f32 v190, v172, v173
    v_cvt_pk_bf16_f32 v191, v174, v175
    buffer_store_dwordx4 v[188:191], v244, s[20:23], s39 offen offset:3072 sc1
ka_noe0:
    s_lshl1_add_u32 s26, s5, s31
    s_lshl_b32 s26, s26, 1
    s_sub_u32 s26, 30, s26
    s_branch ka_p2_e
.p2align 5
ka_p2:
    s_sub_u32 s36, s36, 1
    s_cbranch_scc1 kf_fix23
kf_fixr24:
    s_waitcnt lgkmcnt(8)
    v_mfma_f32_16x16x32_bf16 v[16:19], a[192:195], a[160:163], v[80:83]
    ds_read_b128 a[240:243], v241 offset:20480
    ds_read_b128 a[244:247], v241 offset:21504
    v_mfma_f32_16x16x32_bf16 v[16:19], a[196:199], a[164:167], v[16:19]
    v_exp_f32 v128, v48
    v_mfma_f32_16x16x32_bf16 v[16:19], a[200:203], a[168:171], v[16:19]
    s_mov_b32 m0, s34
    v_exp_f32 v129, v49
    v_mfma_f32_16x16x32_bf16 v[16:19], a[204:207], a[172:175], v[16:19]
    v_exp_f32_e64 v130, v50
    v_mfma_f32_16x16x32_bf16 v[24:27], a[192:195], a[176:179], v[88:91]
    ds_read_b128 a[248:251], v241 offset:22528
    ds_read_b128 a[252:255], v241 offset:23552
    v_mfma_f32_16x16x32_bf16 v[24:27], a[196:199], a[180:183], v[24:27]
    s_add_u32 s41, s42, 17664
    v_cvt_pk_bf16_f32 v120, v128, v129
    v_mfma_f32_16x16x32_bf16 v[24:27], a[200:203], a[184:187], v[24:27]
    buffer_load_dwordx4 v242, s[16:19], s41 offen offset:0 sc1 lds
    v_exp_f32_e64 v131, v51
    v_mfma_f32_16x16x32_bf16 v[24:27], a[204:207], a[188:191], v[24:27]
    v_cvt_pk_bf16_f32 v121, v130, v131
    s_waitcnt lgkmcnt(8)
    v_mfma_f32_16x16x32_bf16 v[20:23], a[208:211], a[160:163], v[84:87]
    ds_read_b128 a[192:195], v241 offset:8192
    ds_read_b128 a[196:199], v241 offset:10240
    v_mfma_f32_16x16x32_bf16 v[20:23], a[212:215], a[164:167], v[20:23]
    v_exp_f32 v132, v52
    v_mfma_f32_16x16x32_bf16 v[20:23], a[216:219], a[168:171], v[20:23]
    v_exp_f32_e64 v133, v53
    buffer_load_dwordx4 v242, s[16:19], s41 offen offset:1024 sc1 lds
    v_mfma_f32_16x16x32_bf16 v[20:23], a[220:223], a[172:175], v[20:23]
    v_exp_f32_e64 v134, v54
    v_mfma_f32_16x16x32_bf16 v[28:31], a[208:211], a[176:179], v[92:95]
    ds_read_b128 a[200:203], v241 offset:12288
    ds_read_b128 a[204:207], v241 offset:14336
    v_mfma_f32_16x16x32_bf16 v[28:31], a[212:215], a[180:183], v[28:31]
    v_exp_f32_e64 v135, v55
    v_mfma_f32_16x16x32_bf16 v[28:31], a[216:219], a[184:187], v[28:31]
    v_exp_f32_e64 v136, v56
    v_cvt_pk_bf16_f32 v122, v132, v133
    v_mfma_f32_16x16x32_bf16 v[28:31], a[220:223], a[188:191], v[28:31]
    v_or3_b32 v208, v120, v121, v122
    s_waitcnt lgkmcnt(8)
    v_mfma_f32_16x16x32_bf16 a[64:67], a[224:227], v[104:107], a[64:67]
    ds_read_b128 a[208:211], v241 offset:9216
    ds_read_b128 a[212:215], v241 offset:11264
    v_mfma_f32_16x16x32_bf16 a[96:99], a[224:227], v[108:111], a[96:99]
    v_exp_f32 v137, v57
    v_mfma_f32_16x16x32_bf16 a[68:71], a[228:231], v[104:107], a[68:71]
    v_exp_f32_e64 v138, v58
    v_mfma_f32_16x16x32_bf16 a[100:103], a[228:231], v[108:111], a[100:103]
    buffer_load_dwordx4 v242, s[16:19], s41 offen offset:2048 sc1 lds
    v_exp_f32_e64 v139, v59
    v_mfma_f32_16x16x32_bf16 a[72:75], a[232:235], v[104:107], a[72:75]
    ds_read_b128 a[216:219], v241 offset:13312
    ds_read_b128 a[220:223], v241 offset:15360
    v_mfma_f32_16x16x32_bf16 a[104:107], a[232:235], v[108:111], a[104:107]
    v_exp_f32_e64 v140, v60
    v_mfma_f32_16x16x32_bf16 a[76:79], a[236:239], v[104:107], a[76:79]
    buffer_load_dwordx4 v242, s[16:19], s41 offen offset:3072 sc1 lds
    v_cvt_pk_bf16_f32 v123, v134, v135
    v_mfma_f32_16x16x32_bf16 a[108:111], a[236:239], v[108:111], a[108:111]
    v_exp_f32 v141, v61
    s_waitcnt lgkmcnt(8)
    v_mfma_f32_16x16x32_bf16 a[80:83], a[240:243], v[104:107], a[80:83]
    ds_read_b128 a[224:227], v241 offset:24576
    ds_read_b128 a[228:231], v241 offset:25600
    v_mfma_f32_16x16x32_bf16 a[112:115], a[240:243], v[108:111], a[112:115]
    v_cvt_pk_bf16_f32 v124, v136, v137
    v_or3_b32 v208, v208, v123, v124
    v_mfma_f32_16x16x32_bf16 a[84:87], a[244:247], v[104:107], a[84:87]
    v_exp_f32_e64 v142, v62
    v_mfma_f32_16x16x32_bf16 a[116:119], a[244:247], v[108:111], a[116:119]
    s_add_u32 s35, s35, 32768
    s_cmp_ge_u32 s35, 163840
    s_cselect_b32 s35, 0, s35
    v_mfma_f32_16x16x32_bf16 a[88:91], a[248:251], v[104:107], a[88:91]
    ds_read_b128 a[232:235], v241 offset:26624
    ds_read_b128 a[236:239], v241 offset:27648
    v_mfma_f32_16x16x32_bf16 a[120:123], a[248:251], v[108:111], a[120:123]
    v_exp_f32 v143, v63
    v_mfma_f32_16x16x32_bf16 a[92:95], a[252:255], v[104:107], a[92:95]
    v_cvt_pk_bf16_f32 v125, v138, v139
    v_cvt_pk_bf16_f32 v126, v140, v141
    v_mfma_f32_16x16x32_bf16 a[124:127], a[252:255], v[108:111], a[124:127]
    v_or3_b32 v208, v208, v125, v126
    v_cvt_pk_bf16_f32 v127, v142, v143
    v_or_b32_e64 v208, v208, v127
    v_mfma_f32_16x16x32_bf16 v[152:155], v[204:207], v[104:107], v[152:155]
    v_and_b32 v208, s38, v208
    v_cmp_ne_u32 vcc, 0, v208
    v_mfma_f32_16x16x32_bf16 v[156:159], v[204:207], v[108:111], v[156:159]
    s_cbranch_vccnz kf_rare22
kf_rr21:
    s_sub_u32 s36, s36, 1
    s_cbranch_scc1 kf_fix27
kf_fixr28:
    s_waitcnt lgkmcnt(8)
    v_mfma_f32_16x16x32_bf16 v[48:51], a[192:195], a[160:163], v[80:83]
    ds_read_b128 a[240:243], v241 offset:28672
    ds_read_b128 a[244:247], v241 offset:29696
    v_mfma_f32_16x16x32_bf16 v[48:51], a[196:199], a[164:167], v[48:51]
    s_add_u32 m0, s34, 16384
    v_exp_f32_e64 v128, v16
    v_mfma_f32_16x16x32_bf16 v[48:51], a[200:203], a[168:171], v[48:51]
    v_exp_f32_e64 v129, v17
    v_mfma_f32_16x16x32_bf16 v[48:51], a[204:207], a[172:175], v[48:51]
    v_exp_f32_e64 v130, v18
    v_mfma_f32_16x16x32_bf16 v[56:59], a[192:195], a[176:179], v[88:91]
    ds_read_b128 a[248:251], v241 offset:30720
    ds_read_b128 a[252:255], v241 offset:31744
    s_add_u32 s34, s34, 32768
    v_mfma_f32_16x16x32_bf16 v[56:59], a[196:199], a[180:183], v[56:59]
    s_cmp_ge_u32 s34, 163840
    s_cselect_b32 s34, s37, s34
    v_mfma_f32_16x16x32_bf16 v[56:59], a[200:203], a[184:187], v[56:59]
    v_exp_f32 v131, v19
    v_mfma_f32_16x16x32_bf16 v[56:59], a[204:207], a[188:191], v[56:59]
    v_exp_f32 v132, v20
    s_waitcnt lgkmcnt(8)
    v_mfma_f32_16x16x32_bf16 v[52:55], a[208:211], a[160:163], v[84:87]
    s_waitcnt vmcnt(12)
    s_barrier
    v_add_u32_e64 v241, s35, v240
    ds_read_b128 a[192:195], v241 offset:0
    v_mfma_f32_16x16x32_bf16 v[52:55], a[212:215], a[164:167], v[52:55]
    v_exp_f32_e64 v133, v21
    v_mfma_f32_16x16x32_bf16 v[52:55], a[216:219], a[168:171], v[52:55]
    ds_read_b128 a[196:199], v241 offset:2048
    buffer_load_dwordx4 v242, s[16:19], s42 offen offset:0 sc1 lds
    v_mfma_f32_16x16x32_bf16 v[52:55], a[220:223], a[172:175], v[52:55]
    v_exp_f32_e64 v134, v22
    v_cvt_pk_bf16_f32 v104, v128, v129
    v_mfma_f32_16x16x32_bf16 v[60:63], a[208:211], a[176:179], v[92:95]
    ds_read_b128 a[200:203], v241 offset:4096
    ds_read_b128 a[204:207], v241 offset:6144
    v_mfma_f32_16x16x32_bf16 v[60:63], a[212:215], a[180:183], v[60:63]
    v_exp_f32_e64 v135, v23
    v_mfma_f32_16x16x32_bf16 v[60:63], a[216:219], a[184:187], v[60:63]
    buffer_load_dwordx4 v242, s[16:19], s42 offen offset:1024 sc1 lds
    v_exp_f32_e64 v136, v24
    v_mfma_f32_16x16x32_bf16 v[60:63], a[220:223], a[188:191], v[60:63]
    v_cvt_pk_bf16_f32 v105, v130, v131
    s_waitcnt lgkmcnt(8)
    v_mfma_f32_16x16x32_bf16 a[64:67], a[224:227], v[120:123], a[64:67]
    ds_read_b128 a[208:211], v241 offset:1024
    ds_read_b128 a[212:215], v241 offset:3072
    v_mfma_f32_16x16x32_bf16 a[96:99], a[224:227], v[124:127], a[96:99]
    v_exp_f32 v137, v25
    v_mfma_f32_16x16x32_bf16 a[68:71], a[228:231], v[120:123], a[68:71]
    v_cvt_pk_bf16_f32 v106, v132, v133
    v_exp_f32_e64 v138, v26
    v_mfma_f32_16x16x32_bf16 a[100:103], a[228:231], v[124:127], a[100:103]
    v_exp_f32_e64 v139, v27
    v_mfma_f32_16x16x32_bf16 a[72:75], a[232:235], v[120:123], a[72:75]
    ds_read_b128 a[216:219], v241 offset:5120
    ds_read_b128 a[220:223], v241 offset:7168
    v_mfma_f32_16x16x32_bf16 a[104:107], a[232:235], v[124:127], a[104:107]
    buffer_load_dwordx4 v242, s[16:19], s42 offen offset:2048 sc1 lds
    v_or3_b32 v208, v104, v105, v106
    v_cvt_pk_bf16_f32 v107, v134, v135
    v_mfma_f32_16x16x32_bf16 a[76:79], a[236:239], v[120:123], a[76:79]
    v_exp_f32_e64 v140, v28
    v_mfma_f32_16x16x32_bf16 a[108:111], a[236:239], v[124:127], a[108:111]
    v_cvt_pk_bf16_f32 v108, v136, v137
    s_waitcnt lgkmcnt(8)
    v_mfma_f32_16x16x32_bf16 a[80:83], a[240:243], v[120:123], a[80:83]
    ds_read_b128 a[224:227], v241 offset:16384
    ds_read_b128 a[228:231], v241 offset:17408
    v_or3_b32 v208, v208, v107, v108
    v_mfma_f32_16x16x32_bf16 a[112:115], a[240:243], v[124:127], a[112:115]
    v_exp_f32 v141, v29
    v_mfma_f32_16x16x32_bf16 a[84:87], a[244:247], v[120:123], a[84:87]
    v_exp_f32_e64 v142, v30
    v_mfma_f32_16x16x32_bf16 a[116:119], a[244:247], v[124:127], a[116:119]
    v_exp_f32_e64 v143, v31
    v_mfma_f32_16x16x32_bf16 a[88:91], a[248:251], v[120:123], a[88:91]
    ds_read_b128 a[232:235], v241 offset:18432
    ds_read_b128 a[236:239], v241 offset:19456
    buffer_load_dwordx4 v242, s[16:19], s42 offen offset:3072 sc1 lds
    v_mfma_f32_16x16x32_bf16 a[120:123], a[248:251], v[124:127], a[120:123]
    s_add_u32 s42, s42, 34048
    v_cvt_pk_bf16_f32 v109, v138, v139
    v_mfma_f32_16x16x32_bf16 a[92:95], a[252:255], v[120:123], a[92:95]
    v_cvt_pk_bf16_f32 v110, v140, v141
    v_or3_b32 v208, v208, v109, v110
    v_mfma_f32_16x16x32_bf16 a[124:127], a[252:255], v[124:127], a[124:127]
    v_cvt_pk_bf16_f32 v111, v142, v143
    v_or_b32 v208, v208, v111
    v_and_b32 v208, s38, v208
    v_mfma_f32_16x16x32_bf16 v[152:155], v[204:207], v[120:123], v[152:155]
    v_cmp_ne_u32_e64 vcc, 0, v208
    v_mfma_f32_16x16x32_bf16 v[156:159], v[204:207], v[124:127], v[156:159]
    s_cbranch_vccnz kf_rare26
kf_rr25:
ka_p2_e:
    s_sub_u32 s26, s26, 1
    s_cbranch_scc0 ka_p2
    s_branch ka_p2_x
kf_fix23:
    s_mov_b32 s24, 0
    s_branch kf_fix23c
kf_fix27:
    s_mov_b32 s24, 1
kf_fix23c:
    s_cmp_eq_u32 s33, 0
    s_cbranch_scc0 kf_fix23f
    s_mov_b32 s36, 0
    s_mov_b32 s33, 1
    v_add_f32 v80, v226, v200
    v_add_f32 v81, v226, v201
    v_add_f32 v82, v226, v202
    v_add_f32 v83, v226, v203
    v_add_f32 v84, v226, v209
    v_add_f32 v85, v226, v210
    v_add_f32 v86, v226, v211
    v_add_f32 v87, v226, v212
    v_add_f32 v88, v227, v213
    v_add_f32 v89, v227, v214
    v_add_f32 v90, v227, v215
    v_add_f32 v91, v227, v216
    v_add_f32 v92, v227, v217
    v_add_f32 v93, v227, v218
    v_add_f32 v94, v227, v219
    v_add_f32 v95, v227, v220
    s_cmp_eq_u32 s24, 0
    s_cbranch_scc1 kf_fixr24
    s_branch kf_fixr28
kf_fix23f:
    s_mov_b32 s36, 0x1000
    v_mov_b32 v80, 0xf1800000
    v_mov_b32 v81, v80
    v_mov_b32 v82, v80
    v_mov_b32 v83, v80
    v_mov_b32 v84, v80
    v_mov_b32 v85, v80
    v_mov_b32 v86, v80
    v_mov_b32 v87, v80
    v_mov_b32 v88, v80
    v_mov_b32 v89, v80
    v_mov_b32 v90, v80
    v_mov_b32 v91, v80
    v_mov_b32 v92, v80
    v_mov_b32 v93, v80
    v_mov_b32 v94, v80
    v_mov_b32_e64 v95, v80
    s_cmp_eq_u32 s24, 0
    s_cbranch_scc1 kf_fixr24
    s_branch kf_fixr28
ka_p2_x:
    s_waitcnt lgkmcnt(0)
    ds_read_b128 a[224:227], v241 offset:16384
    ds_read_b128 a[228:231], v241 offset:17408
    ds_read_b128 a[232:235], v241 offset:18432
    ds_read_b128 a[236:239], v241 offset:19456
    ds_read_b128 a[240:243], v241 offset:20480
    ds_read_b128 a[244:247], v241 offset:21504
    ds_read_b128 a[248:251], v241 offset:22528
    ds_read_b128 a[252:255], v241 offset:23552
    ds_read_b128 a[192:195], v241 offset:24576
    ds_read_b128 a[196:199], v241 offset:25600
    ds_read_b128 a[200:203], v241 offset:26624
    ds_read_b128 a[204:207], v241 offset:27648
    ds_read_b128 a[208:211], v241 offset:28672
    ds_read_b128 a[212:215], v241 offset:29696
    ds_read_b128 a[216:219], v241 offset:30720
    s_waitcnt lgkmcnt(7)
    ds_read_b128 a[220:223], v241 offset:31744
    v_mfma_f32_16x16x32_bf16 a[64:67], a[224:227], v[104:107], a[64:67]
    v_exp_f32 v128, v48
    v_exp_f32_e64 v129, v49
    v_mfma_f32_16x16x32_bf16 a[96:99], a[224:227], v[108:111], a[96:99]
    v_exp_f32_e64 v130, v50
    v_cvt_pk_bf16_f32 v120, v128, v129
    v_mfma_f32_16x16x32_bf16 a[68:71], a[228:231], v[104:107], a[68:71]
    v_exp_f32_e64 v131, v51
    v_mfma_f32_16x16x32_bf16 a[100:103], a[228:231], v[108:111], a[100:103]
    v_exp_f32_e64 v132, v52
    v_cvt_pk_bf16_f32 v121, v130, v131
    v_mfma_f32_16x16x32_bf16 a[72:75], a[232:235], v[104:107], a[72:75]
    v_exp_f32_e64 v133, v53
    v_mfma_f32_16x16x32_bf16 a[104:107], a[232:235], v[108:111], a[104:107]
    v_exp_f32_e64 v134, v54
    v_cvt_pk_bf16_f32 v122, v132, v133
    v_mfma_f32_16x16x32_bf16 a[76:79], a[236:239], v[104:107], a[76:79]
    v_exp_f32_e64 v135, v55
    v_or3_b32 v208, v120, v121, v122
    v_mfma_f32_16x16x32_bf16 a[108:111], a[236:239], v[108:111], a[108:111]
    v_exp_f32_e64 v136, v56
    v_cvt_pk_bf16_f32 v123, v134, v135
    v_mfma_f32_16x16x32_bf16 a[80:83], a[240:243], v[104:107], a[80:83]
    v_exp_f32_e64 v137, v57
    v_mfma_f32_16x16x32_bf16 a[112:115], a[240:243], v[108:111], a[112:115]
    v_exp_f32_e64 v138, v58
    v_cvt_pk_bf16_f32 v124, v136, v137
    v_mfma_f32_16x16x32_bf16 a[84:87], a[244:247], v[104:107], a[84:87]
    v_exp_f32_e64 v139, v59
    v_or3_b32 v208, v208, v123, v124
    v_mfma_f32_16x16x32_bf16 a[116:119], a[244:247], v[108:111], a[116:119]
    v_exp_f32_e64 v140, v60
    v_cvt_pk_bf16_f32 v125, v138, v139
    v_mfma_f32_16x16x32_bf16 a[88:91], a[248:251], v[104:107], a[88:91]
    v_exp_f32_e64 v141, v61
    v_mfma_f32_16x16x32_bf16 a[120:123], a[248:251], v[108:111], a[120:123]
    v_exp_f32_e64 v142, v62
    v_cvt_pk_bf16_f32 v126, v140, v141
    v_mfma_f32_16x16x32_bf16 a[92:95], a[252:255], v[104:107], a[92:95]
    v_exp_f32_e64 v143, v63
    v_or3_b32 v208, v208, v125, v126
    v_mfma_f32_16x16x32_bf16 a[124:127], a[252:255], v[108:111], a[124:127]
    v_cvt_pk_bf16_f32 v127, v142, v143
    v_or_b32 v208, v208, v127
    v_and_b32 v208, s38, v208
    v_mfma_f32_16x16x32_bf16 v[152:155], v[204:207], v[104:107], v[152:155]
    v_cmp_ne_u32_e64 vcc, 0, v208
    v_mfma_f32_16x16x32_bf16 v[156:159], v[204:207], v[108:111], v[156:159]
    s_cbranch_vccnz kf_rare30
kf_rr29:
    s_waitcnt lgkmcnt(0)
    s_nop 0
    v_mfma_f32_16x16x32_bf16 a[64:67], a[192:195], v[120:123], a[64:67]
    v_mfma_f32_16x16x32_bf16 a[96:99], a[192:195], v[124:127], a[96:99]
    v_mfma_f32_16x16x32_bf16 a[68:71], a[196:199], v[120:123], a[68:71]
    v_mfma_f32_16x16x32_bf16 a[100:103], a[196:199], v[124:127], a[100:103]
    v_mfma_f32_16x16x32_bf16 a[72:75], a[200:203], v[120:123], a[72:75]
    v_mfma_f32_16x16x32_bf16 a[104:107], a[200:203], v[124:127], a[104:107]
    v_mfma_f32_16x16x32_bf16 a[76:79], a[204:207], v[120:123], a[76:79]
    v_mfma_f32_16x16x32_bf16 a[108:111], a[204:207], v[124:127], a[108:111]
    v_mfma_f32_16x16x32_bf16 a[80:83], a[208:211], v[120:123], a[80:83]
    v_mfma_f32_16x16x32_bf16 a[112:115], a[208:211], v[124:127], a[112:115]
    v_mfma_f32_16x16x32_bf16 a[84:87], a[212:215], v[120:123], a[84:87]
    v_mfma_f32_16x16x32_bf16 a[116:119], a[212:215], v[124:127], a[116:119]
    v_mfma_f32_16x16x32_bf16 a[88:91], a[216:219], v[120:123], a[88:91]
    v_mfma_f32_16x16x32_bf16 a[120:123], a[216:219], v[124:127], a[120:123]
    v_mfma_f32_16x16x32_bf16 a[92:95], a[220:223], v[120:123], a[92:95]
    v_mfma_f32_16x16x32_bf16 a[124:127], a[220:223], v[124:127], a[124:127]
    v_mfma_f32_16x16x32_bf16 v[152:155], v[204:207], v[120:123], v[152:155]
    v_mfma_f32_16x16x32_bf16 v[156:159], v[204:207], v[124:127], v[156:159]
    s_cmp_eq_u32 s31, 0
    s_cbranch_scc1 ka_nox
    s_waitcnt vmcnt(8)
    s_barrier
ka_nox:
    s_nop 6
    v_rcp_f32 v230, v152
    v_rcp_f32 v231, v156
    v_accvgpr_read_b32 v160, a64
    v_accvgpr_read_b32 v161, a65
    v_accvgpr_read_b32 v162, a66
    v_accvgpr_read_b32 v163, a67
    v_accvgpr_read_b32 v164, a68
    v_accvgpr_read_b32 v165, a69
    v_accvgpr_read_b32 v166, a70
    v_accvgpr_read_b32 v167, a71
    v_mul_f32 v160, v160, v230
    v_mul_f32 v161, v161, v230
    v_mul_f32 v162, v162, v230
    v_mul_f32 v163, v163, v230
    v_mul_f32 v164, v164, v230
    v_mul_f32 v165, v165, v230
    v_mul_f32 v166, v166, v230
    v_mul_f32 v167, v167, v230
    v_cvt_pk_bf16_f32 v176, v160, v161
    v_cvt_pk_bf16_f32 v177, v162, v163
    v_cvt_pk_bf16_f32 v178, v164, v165
    v_cvt_pk_bf16_f32 v179, v166, v167
    buffer_store_dwordx4 v[176:179], v240, s[20:23], s40 offen offset:0 sc1
    v_accvgpr_read_b32 v168, a72
    v_accvgpr_read_b32 v169, a73
    v_accvgpr_read_b32 v170, a74
    v_accvgpr_read_b32 v171, a75
    v_accvgpr_read_b32 v172, a76
    v_accvgpr_read_b32 v173, a77
    v_accvgpr_read_b32 v174, a78
    v_accvgpr_read_b32 v175, a79
    v_mul_f32 v168, v168, v230
    v_mul_f32 v169, v169, v230
    v_mul_f32 v170, v170, v230
    v_mul_f32 v171, v171, v230
    v_mul_f32 v172, v172, v230
    v_mul_f32 v173, v173, v230
    v_mul_f32 v174, v174, v230
    v_mul_f32 v175, v175, v230
    v_cvt_pk_bf16_f32 v180, v168, v169
    v_cvt_pk_bf16_f32 v181, v170, v171
    v_cvt_pk_bf16_f32 v182, v172, v173
    v_cvt_pk_bf16_f32 v183, v174, v175
    buffer_store_dwordx4 v[180:183], v240, s[20:23], s40 offen offset:1024 sc1
    v_accvgpr_read_b32 v160, a80
    v_accvgpr_read_b32 v161, a81
    v_accvgpr_read_b32 v162, a82
    v_accvgpr_read_b32 v163, a83
    v_accvgpr_read_b32 v164, a84
    v_accvgpr_read_b32 v165, a85
    v_accvgpr_read_b32 v166, a86
    v_accvgpr_read_b32 v167, a87
    v_mul_f32 v160, v160, v230
    v_mul_f32 v161, v161, v230
    v_mul_f32 v162, v162, v230
    v_mul_f32 v163, v163, v230
    v_mul_f32 v164, v164, v230
    v_mul_f32 v165, v165, v230
    v_mul_f32 v166, v166, v230
    v_mul_f32 v167, v167, v230
    v_cvt_pk_bf16_f32 v184, v160, v161
    v_cvt_pk_bf16_f32 v185, v162, v163
    v_cvt_pk_bf16_f32 v186, v164, v165
    v_cvt_pk_bf16_f32 v187, v166, v167
    buffer_store_dwordx4 v[184:187], v240, s[20:23], s40 offen offset:2048 sc1
    v_accvgpr_read_b32 v168, a88
    v_accvgpr_read_b32 v169, a89
    v_accvgpr_read_b32 v170, a90
    v_accvgpr_read_b32 v171, a91
    v_accvgpr_read_b32 v172, a92
    v_accvgpr_read_b32 v173, a93
    v_accvgpr_read_b32 v174, a94
    v_accvgpr_read_b32 v175, a95
    v_mul_f32 v168, v168, v230
    v_mul_f32 v169, v169, v230
    v_mul_f32 v170, v170, v230
    v_mul_f32 v171, v171, v230
    v_mul_f32 v172, v172, v230
    v_mul_f32 v173, v173, v230
    v_mul_f32 v174, v174, v230
    v_mul_f32 v175, v175, v230
    v_cvt_pk_bf16_f32 v188, v168, v169
    v_cvt_pk_bf16_f32 v189, v170, v171
    v_cvt_pk_bf16_f32 v190, v172, v173
    v_cvt_pk_bf16_f32 v191, v174, v175
    buffer_store_dwordx4 v[188:191], v240, s[20:23], s40 offen offset:3072 sc1
    v_accvgpr_read_b32 v160, a96
    v_accvgpr_read_b32 v161, a97
    v_accvgpr_read_b32 v162, a98
    v_accvgpr_read_b32 v163, a99
    v_accvgpr_read_b32 v164, a100
    v_accvgpr_read_b32 v165, a101
    v_accvgpr_read_b32 v166, a102
    v_accvgpr_read_b32 v167, a103
    v_mul_f32 v160, v160, v231
    v_mul_f32 v161, v161, v231
    v_mul_f32 v162, v162, v231
    v_mul_f32 v163, v163, v231
    v_mul_f32 v164, v164, v231
    v_mul_f32 v165, v165, v231
    v_mul_f32 v166, v166, v231
    v_mul_f32 v167, v167, v231
    v_cvt_pk_bf16_f32 v176, v160, v161
    v_cvt_pk_bf16_f32 v177, v162, v163
    v_cvt_pk_bf16_f32 v178, v164, v165
    v_cvt_pk_bf16_f32 v179, v166, v167
    buffer_store_dwordx4 v[176:179], v244, s[20:23], s40 offen offset:0 sc1
    v_accvgpr_read_b32 v168, a104
    v_accvgpr_read_b32 v169, a105
    v_accvgpr_read_b32 v170, a106
    v_accvgpr_read_b32 v171, a107
    v_accvgpr_read_b32 v172, a108
    v_accvgpr_read_b32 v173, a109
    v_accvgpr_read_b32 v174, a110
    v_accvgpr_read_b32 v175, a111
    v_mul_f32 v168, v168, v231
    v_mul_f32 v169, v169, v231
    v_mul_f32 v170, v170, v231
    v_mul_f32 v171, v171, v231
    v_mul_f32 v172, v172, v231
    v_mul_f32 v173, v173, v231
    v_mul_f32 v174, v174, v231
    v_mul_f32 v175, v175, v231
    v_cvt_pk_bf16_f32 v180, v168, v169
    v_cvt_pk_bf16_f32 v181, v170, v171
    v_cvt_pk_bf16_f32 v182, v172, v173
    v_cvt_pk_bf16_f32 v183, v174, v175
    buffer_store_dwordx4 v[180:183], v244, s[20:23], s40 offen offset:1024 sc1
    v_accvgpr_read_b32 v160, a112
    v_accvgpr_read_b32 v161, a113
    v_accvgpr_read_b32 v162, a114
    v_accvgpr_read_b32 v163, a115
    v_accvgpr_read_b32 v164, a116
    v_accvgpr_read_b32 v165, a117
    v_accvgpr_read_b32 v166, a118
    v_accvgpr_read_b32 v167, a119
    v_mul_f32 v160, v160, v231
    v_mul_f32 v161, v161, v231
    v_mul_f32 v162, v162, v231
    v_mul_f32 v163, v163, v231
    v_mul_f32 v164, v164, v231
    v_mul_f32 v165, v165, v231
    v_mul_f32 v166, v166, v231
    v_mul_f32 v167, v167, v231
    v_cvt_pk_bf16_f32 v184, v160, v161
    v_cvt_pk_bf16_f32 v185, v162, v163
    v_cvt_pk_bf16_f32 v186, v164, v165
    v_cvt_pk_bf16_f32 v187, v166, v167
    buffer_store_dwordx4 v[184:187], v244, s[20:23], s40 offen offset:2048 sc1
    v_accvgpr_read_b32 v168, a120
    v_accvgpr_read_b32 v169, a121
    v_accvgpr_read_b32 v170, a122
    v_accvgpr_read_b32 v171, a123
    v_accvgpr_read_b32 v172, a124
    v_accvgpr_read_b32 v173, a125
    v_accvgpr_read_b32 v174, a126
    v_accvgpr_read_b32 v175, a127
    v_mul_f32 v168, v168, v231
    v_mul_f32 v169, v169, v231
    v_mul_f32 v170, v170, v231
    v_mul_f32 v171, v171, v231
    v_mul_f32 v172, v172, v231
    v_mul_f32 v173, v173, v231
    v_mul_f32 v174, v174, v231
    v_mul_f32 v175, v175, v231
    v_cvt_pk_bf16_f32 v188, v168, v169
    v_cvt_pk_bf16_f32 v189, v170, v171
    v_cvt_pk_bf16_f32 v190, v172, v173
    v_cvt_pk_bf16_f32 v191, v174, v175
    buffer_store_dwordx4 v[188:191], v244, s[20:23], s40 offen offset:3072 sc1
    s_sub_u32 s46, s20, 0x2400000
    s_subb_u32 s47, s21, 0
    s_mov_b64 s[42:43], s[56:57]
    s_mov_b64 s[40:41], s[80:81]
    s_mov_b64 s[44:45], s[82:83]
    s_mov_b64 s[60:61], s[84:85]
    s_mov_b64 s[62:63], s[86:87]
    v_mbcnt_lo_u32_b32 v237, -1, 0
    v_mbcnt_hi_u32_b32 v237, -1, v237
    s_lshl_b32 s32, s3, 6
    v_add_u32 v230, s32, v237
    s_lshr_b32 s53, s2, 3
    s_lshr_b32 s6, s2, 1
    s_and_b32 s6, s6, 3
    s_and_b32 s4, s2, 1
    s_lshl_b32 s4, s4, 2
    s_and_b32 s33, s53, 3
    s_add_u32 s4, s4, s33
    s_lshr_b32 s5, s53, 2
    v_lshlrev_b32 v228, 4, v237
    v_lshrrev_b32 v234, 4, v237
    v_and_b32 v235, 15, v237
    v_lshlrev_b32 v236, 1, v234
    v_xor_b32 v235, v235, v236
    v_lshlrev_b32 v234, 11, v234
    s_lshl_b32 s32, s3, 14
    s_lshl_b32 s33, s5, 8
    s_add_u32 s32, s32, s33
    v_add_u32 v234, s32, v234
    v_lshl_add_u32 v224, v235, 4, v234
    v_xor_b32_e64 v235, 8, v235
    v_lshl_add_u32 v225, v235, 4, v234
    v_add_u32 v225, 7168, v225
    s_lshl_b32 s37, s6, 21
    s_lshl_b32 s38, s3, 11
    s_lshl2_add_u32 s4, s4, s3
    s_sub_u32 s32, 63, s4
    s_cmp_lt_u32 s6, 2
    s_cselect_b32 s4, s4, s32
    s_lshl_b32 s32, s4, 18
    v_add_u32 v226, s32, v228
    v_add_u32 v227, 0x20000, v226
    v_xor_b32 v245, 0xfc0000, v226
    v_xor_b32 v246, 0xfc0000, v227
    s_lshl_b32 s35, s6, 15
    s_add_u32 s35, s35, 0x2400000
    s_getpc_b64 s[56:57]
kc_pc0:
    s_mov_b32 s58, kc_end-kc_pc0
    s_mov_b32 s59, 0x00020000
    v_lshlrev_b32_e64 v234, 7, v230
    buffer_load_dword v241, v234, s[56:59], 0 offen
    s_waitcnt lgkmcnt(0)
    s_mov_b32 s8, s46
    s_mov_b32 s9, s47
    s_mov_b32 s10, 0x10000000
    s_mov_b32 s11, 0x00020000
    s_mov_b32 s12, s42
    s_mov_b32 s13, s43
    s_mov_b32 s14, 0x800000
    s_mov_b32 s15, 0x00020000
    s_mov_b32 s16, s40
    s_mov_b32 s17, s41
    s_mov_b32 s18, 0x400000
    s_mov_b32 s19, 0x00020000
    s_mov_b32 s20, s44
    s_mov_b32 s21, s45
    s_mov_b32 s22, 0x800
    s_mov_b32 s23, 0x00020000
    s_mov_b32 s24, s60
    s_mov_b32 s25, s61
    s_mov_b32 s26, 0x700000
    s_mov_b32 s27, 0x00020000
    s_mov_b32 s28, s62
    s_mov_b32 s29, s63
    s_mov_b32 s30, 0x400000
    s_mov_b32 s31, 0x00020000
    s_lshr_b32 s44, s6, 1
    s_and_b32 s6, s6, 1
    v_bfe_u32 v234, v237, 2, 3
    v_lshrrev_b32 v235, 5, v237
    v_lshl_add_u32 v235, v235, 4, v234
    v_lshlrev_b32 v235, 8, v235
    v_and_b32 v236, 1, v237
    v_lshl_add_u32 v235, v236, 3, v235
    v_lshlrev_b32_e64 v234, 1, v234
    v_bfe_u32 v236, v237, 1, 1
    v_or_b32 v234, v234, v236
    s_lshl_b32 s32, s6, 3
    v_xor_b32 v234, s32, v234
    v_xor_b32 v236, 0, v234
    v_lshl_add_u32 v216, v236, 4, v235
    v_xor_b32_e64 v236, 2, v234
    v_lshl_add_u32 v217, v236, 4, v235
    v_xor_b32_e64 v236, 4, v234
    v_lshl_add_u32 v218, v236, 4, v235
    v_xor_b32_e64 v236, 6, v234
    v_lshl_add_u32 v219, v236, 4, v235
    v_xor_b32_e64 v236, 8, v234
    v_lshl_add_u32 v220, v236, 4, v235
    v_xor_b32_e64 v236, 10, v234
    v_lshl_add_u32 v221, v236, 4, v235
    v_xor_b32_e64 v236, 12, v234
    v_lshl_add_u32 v222, v236, 4, v235
    v_xor_b32_e64 v236, 14, v234
    v_lshl_add_u32 v223, v236, 4, v235
    s_lshl_b32 s44, s4, 5
    v_lshrrev_b32 v234, 3, v237
    v_add_u32 v242, s44, v234
    v_and_b32 v235, 7, v237
    s_lshl1_add_u32 s33, s5, s6
    s_lshl_b32 s33, s33, 7
    v_lshl_add_u32 v240, v235, 4, s33
    v_lshl_add_u32 v229, v242, 11, v240
    s_mul_i32 s32, s3, 4608
    s_add_u32 s32, s32, 131072
    v_mul_u32_u24 v234, 144, v234
    v_lshl_add_u32 v234, v235, 4, v234
    v_add_u32 v239, s32, v234
    v_and_b32 v234, 15, v237
    v_mul_u32_u24 v234, 144, v234
    v_lshrrev_b32_e64 v236, 4, v237
    v_lshl_add_u32 v234, v236, 3, v234
    v_add_u32 v238, s32, v234
    v_and_b32 v234, 3, v237
    v_lshl_add_u32 v234, v234, 3, v242
    v_lshlrev_b32 v234, 2, v234
    v_lshrrev_b32 v235, 2, v235
    v_lshl_add_u32 v231, v235, 13, v234
    v_lshlrev_b32_e64 v235, 30, v235
    v_add_u32 v235, 16384, v235
    v_add_u32 v232, v235, v234
    s_cmp_eq_u32 s44, 0
    s_cselect_b32 s32, 4, 64
    v_cmp_eq_u32 vcc, s32, v237
    v_mov_b32 v235, 24576
    v_mov_b32 v233, 1
    v_cndmask_b32 v232, v232, v235, vcc
    v_and_b32_e64 v234, 1, v237
    v_cmp_ne_u32 s[60:61], 0, v234
    v_and_b32_e64 v234, 2, v237
    v_cmp_ne_u32 s[62:63], 0, v234
    v_and_b32_e64 v234, 4, v237
    v_cmp_ne_u32 s[40:41], 0, v234
    v_cmp_eq_u32 vcc, 0, v237
    v_mov_b32_e64 v235, 0x40000000
    s_nop 0
    v_cndmask_b32 v243, v235, v237, vcc
    s_lshl2_add_u32 s39, s2, s3
    s_mov_b32 s48, 0x3800000
    s_mov_b32 s49, 0x3802000
    s_mov_b32 s50, 0x3804000
    s_and_b32 s52, s2, 7
    s_mul_i32 s54, s52, 28
    s_add_u32 s54, s54, s53
    v_lshrrev_b32 v234, 3, v237
    v_lshlrev_b32 v234, 11, v234
    v_and_b32 v235, 7, v237
    v_lshl_add_u32 v244, v235, 4, v234
    s_lshl_b32 s55, s54, 16
    s_lshl_b32 s32, s3, 13
    s_add_u32 s55, s55, s32
    s_add_u32 s55, s55, 0x4000000
    s_lshl_b32 s51, s54, 15
    s_lshl_b32 s32, s3, 9
    s_add_u32 s51, s51, s32
    s_cmp_ge_u32 s53, 28
    s_cselect_b32 s55, 0x40000000, s55
    s_cselect_b32 s51, 0x40000000, s51
    s_lshr_b32 s32, s2, 5
    s_lshl_b32 s32, s32, 9
    s_and_b32 s33, s2, 6
    s_lshl_b32 s33, s33, 6
    s_add_u32 s32, s32, s33
    s_add_u32 s32, s32, 0x38a4000
    s_waitcnt vmcnt(0)
    s_barrier
    s_cmp_lg_u32 s3, 0
    s_cbranch_scc1 kc_a0
    buffer_atomic_add v233, v243, s[8:11], s32 offen sc1
    s_lshl_b32 s32, s52, 7
    s_add_u32 s32, s32, 0x38a1000
    v_mov_b32 v235, 1
    buffer_atomic_add v235, v243, s[8:11], s32 offen sc0 sc1
    v_lshlrev_b32 v234, 7, v237
    v_cmp_gt_u32 vcc, 8, v237
    v_mov_b32_e64 v236, 0x40000000
    s_mov_b32 s34, 0x38a1400
    v_cndmask_b32 v234, v236, v234, vcc
    s_waitcnt vmcnt(0)
    v_readfirstlane_b32 s36, v235
    s_cmp_lg_u32 s36, 31
    s_cbranch_scc1 kc_a0
    buffer_atomic_add v233, v234, s[8:11], s34 offen sc1
kc_a0:
    s_add_u32 m0, s38, 0
    s_add_u32 s32, s37, 0
    buffer_load_dwordx4 v224, s[12:15], s32 offen lds
    buffer_load_dwordx4 v225, s[12:15], s32 offen offset:1024 lds
    s_add_u32 m0, s38, 8192
    s_add_u32 s32, s37, 65536
    buffer_load_dwordx4 v224, s[12:15], s32 offen lds
    buffer_load_dwordx4 v225, s[12:15], s32 offen offset:1024 lds
    s_add_u32 m0, s38, 16384
    s_add_u32 s32, s37, 131072
    buffer_load_dwordx4 v224, s[12:15], s32 offen lds
    buffer_load_dwordx4 v225, s[12:15], s32 offen offset:1024 lds
    s_add_u32 m0, s38, 24576
    s_add_u32 s32, s37, 196608
    buffer_load_dwordx4 v224, s[12:15], s32 offen lds
    buffer_load_dwordx4 v225, s[12:15], s32 offen offset:1024 lds
    s_add_u32 m0, s38, 32768
    s_add_u32 s32, s37, 262144
    buffer_load_dwordx4 v224, s[12:15], s32 offen lds
    buffer_load_dwordx4 v225, s[12:15], s32 offen offset:1024 lds
    s_add_u32 m0, s38, 40960
    s_add_u32 s32, s37, 327680
    buffer_load_dwordx4 v224, s[12:15], s32 offen lds
    buffer_load_dwordx4 v225, s[12:15], s32 offen offset:1024 lds
    s_add_u32 m0, s38, 49152
    s_add_u32 s32, s37, 393216
    buffer_load_dwordx4 v224, s[12:15], s32 offen lds
    buffer_load_dwordx4 v225, s[12:15], s32 offen offset:1024 lds
    s_add_u32 m0, s38, 57344
    s_add_u32 s32, s37, 458752
    buffer_load_dwordx4 v224, s[12:15], s32 offen lds
    buffer_load_dwordx4 v225, s[12:15], s32 offen offset:1024 lds
    s_add_u32 m0, s38, 65536
    s_add_u32 s32, s37, 524288
    buffer_load_dwordx4 v224, s[12:15], s32 offen lds
    buffer_load_dwordx4 v225, s[12:15], s32 offen offset:1024 lds
    s_add_u32 m0, s38, 73728
    s_add_u32 s32, s37, 589824
    buffer_load_dwordx4 v224, s[12:15], s32 offen lds
    buffer_load_dwordx4 v225, s[12:15], s32 offen offset:1024 lds
    s_add_u32 m0, s38, 81920
    s_add_u32 s32, s37, 655360
    buffer_load_dwordx4 v224, s[12:15], s32 offen lds
    buffer_load_dwordx4 v225, s[12:15], s32 offen offset:1024 lds
    s_add_u32 m0, s38, 90112
    s_add_u32 s32, s37, 720896
    buffer_load_dwordx4 v224, s[12:15], s32 offen lds
    buffer_load_dwordx4 v225, s[12:15], s32 offen offset:1024 lds
    s_add_u32 m0, s38, 98304
    s_add_u32 s32, s37, 786432
    buffer_load_dwordx4 v224, s[12:15], s32 offen lds
    buffer_load_dwordx4 v225, s[12:15], s32 offen offset:1024 lds
    s_add_u32 m0, s38, 106496
    s_add_u32 s32, s37, 851968
    buffer_load_dwordx4 v224, s[12:15], s32 offen lds
    buffer_load_dwordx4 v225, s[12:15], s32 offen offset:1024 lds
    s_add_u32 m0, s38, 114688
    s_add_u32 s32, s37, 917504
    buffer_load_dwordx4 v224, s[12:15], s32 offen lds
    buffer_load_dwordx4 v225, s[12:15], s32 offen offset:1024 lds
    s_add_u32 m0, s38, 122880
    s_add_u32 s32, s37, 983040
    buffer_load_dwordx4 v224, s[12:15], s32 offen lds
    buffer_load_dwordx4 v225, s[12:15], s32 offen offset:1024 lds
    s_add_u32 s33, s51, 0
    buffer_load_dwordx4 a[192:195], v244, s[24:27], s33 offen offset:0
    s_add_u32 s33, s51, 16384
    buffer_load_dwordx4 a[196:199], v244, s[24:27], s33 offen offset:0
    s_add_u32 s33, s51, 0
    buffer_load_dwordx4 a[200:203], v244, s[24:27], s33 offen offset:128
    s_add_u32 s33, s51, 16384
    buffer_load_dwordx4 a[204:207], v244, s[24:27], s33 offen offset:128
    s_add_u32 s33, s51, 0
    buffer_load_dwordx4 a[208:211], v244, s[24:27], s33 offen offset:256
    s_add_u32 s33, s51, 16384
    buffer_load_dwordx4 a[212:215], v244, s[24:27], s33 offen offset:256
    s_add_u32 s33, s51, 0
    buffer_load_dwordx4 a[216:219], v244, s[24:27], s33 offen offset:384
    s_add_u32 s33, s51, 16384
    buffer_load_dwordx4 a[220:223], v244, s[24:27], s33 offen offset:384
    s_cmp_lg_u32 s3, 0
    s_cbranch_scc1 kc_b03
    s_and_b32 s32, s2, 1
    s_lshl_b32 s32, s32, 2
    s_and_b32 s33, s53, 3
    s_add_u32 s32, s32, s33
    s_lshl_b32 s32, s32, 9
    s_and_b32 s33, s2, 6
    s_lshl_b32 s33, s33, 6
    s_add_u32 s32, s32, s33
    s_add_u32 s32, s32, 0x38a4000
    s_mov_b32 s34, 0x400000
    s_branch kc_b01
kc_b00:
    s_sleep 2
kc_b01:
    buffer_load_dword v235, off, s[8:11], s32 sc1
    s_waitcnt vmcnt(0)
    v_cmp_ne_u32 vcc, 8, v235
    s_sub_u32 s34, s34, 1
    s_cbranch_scc1 kc_b02
    s_cbranch_vccnz kc_b00
kc_b02:
kc_b03:
    s_waitcnt vmcnt(8)
    s_barrier
    buffer_load_dwordx4 a[0:3], v226, s[8:11], s35 offen offset:0 sc1
    buffer_load_dwordx4 a[4:7], v227, s[8:11], s35 offen offset:0 sc1
    buffer_load_dwordx4 a[8:11], v245, s[8:11], s35 offen offset:0 sc1
    buffer_load_dwordx4 a[12:15], v246, s[8:11], s35 offen offset:0 sc1
    buffer_load_dwordx4 a[16:19], v226, s[8:11], s35 offen offset:1024 sc1
    buffer_load_dwordx4 a[20:23], v227, s[8:11], s35 offen offset:1024 sc1
    buffer_load_dwordx4 a[24:27], v245, s[8:11], s35 offen offset:1024 sc1
    buffer_load_dwordx4 a[28:31], v246, s[8:11], s35 offen offset:1024 sc1
    buffer_load_dwordx4 a[32:35], v226, s[8:11], s35 offen offset:2048 sc1
    buffer_load_dwordx4 a[36:39], v227, s[8:11], s35 offen offset:2048 sc1
    buffer_load_dwordx4 a[40:43], v245, s[8:11], s35 offen offset:2048 sc1
    buffer_load_dwordx4 a[44:47], v246, s[8:11], s35 offen offset:2048 sc1
    buffer_load_dwordx4 a[48:51], v226, s[8:11], s35 offen offset:3072 sc1
    buffer_load_dwordx4 a[52:55], v227, s[8:11], s35 offen offset:3072 sc1
    buffer_load_dwordx4 a[56:59], v245, s[8:11], s35 offen offset:3072 sc1
    buffer_load_dwordx4 a[60:63], v246, s[8:11], s35 offen offset:3072 sc1
    ds_read_b64_tr_b16 v[128:129], v216 offset:0
    ds_read_b64_tr_b16 v[130:131], v216 offset:2048
    ds_read_b64_tr_b16 v[132:133], v217 offset:0
    ds_read_b64_tr_b16 v[134:135], v217 offset:2048
    ds_read_b64_tr_b16 v[136:137], v218 offset:0
    ds_read_b64_tr_b16 v[138:139], v218 offset:2048
    ds_read_b64_tr_b16 v[140:141], v219 offset:0
    ds_read_b64_tr_b16 v[142:143], v219 offset:2048
    s_waitcnt vmcnt(12) lgkmcnt(0)
    v_mfma_f32_16x16x32_bf16 v[32:35], v[128:131], a[0:3], 0
    ds_read_b64_tr_b16 v[144:145], v220 offset:0
    v_mfma_f32_16x16x32_bf16 v[36:39], v[128:131], a[4:7], 0
    ds_read_b64_tr_b16 v[146:147], v220 offset:2048
    v_mfma_f32_16x16x32_bf16 v[64:67], v[128:131], a[8:11], 0
    ds_read_b64_tr_b16 v[148:149], v221 offset:0
    v_mfma_f32_16x16x32_bf16 v[68:71], v[128:131], a[12:15], 0
    ds_read_b64_tr_b16 v[150:151], v221 offset:2048
    v_mfma_f32_16x16x32_bf16 v[40:43], v[132:135], a[0:3], 0
    ds_read_b64_tr_b16 v[152:153], v222 offset:0
    v_mfma_f32_16x16x32_bf16 v[44:47], v[132:135], a[4:7], 0
    ds_read_b64_tr_b16 v[154:155], v222 offset:2048
    v_mfma_f32_16x16x32_bf16 v[72:75], v[132:135], a[8:11], 0
    ds_read_b64_tr_b16 v[156:157], v223 offset:0
    v_mfma_f32_16x16x32_bf16 v[76:79], v[132:135], a[12:15], 0
    ds_read_b64_tr_b16 v[158:159], v223 offset:2048
    v_mfma_f32_16x16x32_bf16 v[48:51], v[136:139], a[0:3], 0
    s_add_u32 s35, s35, 4096
    buffer_load_dwordx4 a[64:67], v226, s[8:11], s35 offen offset:0 sc1
    v_mfma_f32_16x16x32_bf16 v[52:55], v[136:139], a[4:7], 0
    v_mfma_f32_16x16x32_bf16 v[80:83], v[136:139], a[8:11], 0
    v_mfma_f32_16x16x32_bf16 v[84:87], v[136:139], a[12:15], 0
    buffer_load_dwordx4 a[68:71], v227, s[8:11], s35 offen offset:0 sc1
    v_mfma_f32_16x16x32_bf16 v[56:59], v[140:143], a[0:3], 0
    v_mfma_f32_16x16x32_bf16 v[60:63], v[140:143], a[4:7], 0
    v_mfma_f32_16x16x32_bf16 v[88:91], v[140:143], a[8:11], 0
    v_mfma_f32_16x16x32_bf16 v[92:95], v[140:143], a[12:15], 0
    buffer_load_dwordx4 a[72:75], v245, s[8:11], s35 offen offset:0 sc1
    s_waitcnt lgkmcnt(0)
    v_mfma_f32_16x16x32_bf16 v[0:3], v[144:147], a[0:3], 0
    ds_read_b64_tr_b16 v[128:129], v216 offset:8192
    v_mfma_f32_16x16x32_bf16 v[4:7], v[144:147], a[4:7], 0
    ds_read_b64_tr_b16 v[130:131], v216 offset:10240
    v_mfma_f32_16x16x32_bf16 v[96:99], v[144:147], a[8:11], 0
    ds_read_b64_tr_b16 v[132:133], v217 offset:8192
    v_mfma_f32_16x16x32_bf16 v[100:103], v[144:147], a[12:15], 0
    ds_read_b64_tr_b16 v[134:135], v217 offset:10240
    v_mfma_f32_16x16x32_bf16 v[8:11], v[148:151], a[0:3], 0
    ds_read_b64_tr_b16 v[136:137], v218 offset:8192
    v_mfma_f32_16x16x32_bf16 v[12:15], v[148:151], a[4:7], 0
    ds_read_b64_tr_b16 v[138:139], v218 offset:10240
    v_mfma_f32_16x16x32_bf16 v[104:107], v[148:151], a[8:11], 0
    ds_read_b64_tr_b16 v[140:141], v219 offset:8192
    v_mfma_f32_16x16x32_bf16 v[108:111], v[148:151], a[12:15], 0
    ds_read_b64_tr_b16 v[142:143], v219 offset:10240
    v_mfma_f32_16x16x32_bf16 v[16:19], v[152:155], a[0:3], 0
    buffer_load_dwordx4 a[76:79], v246, s[8:11], s35 offen offset:0 sc1
    v_mfma_f32_16x16x32_bf16 v[20:23], v[152:155], a[4:7], 0
    v_mfma_f32_16x16x32_bf16 v[112:115], v[152:155], a[8:11], 0
    v_mfma_f32_16x16x32_bf16 v[116:119], v[152:155], a[12:15], 0
    v_mfma_f32_16x16x32_bf16 v[24:27], v[156:159], a[0:3], 0
    buffer_load_dwordx4 a[80:83], v226, s[8:11], s35 offen offset:1024 sc1
    v_mfma_f32_16x16x32_bf16 v[28:31], v[156:159], a[4:7], 0
    v_mfma_f32_16x16x32_bf16 v[120:123], v[156:159], a[8:11], 0
    v_mfma_f32_16x16x32_bf16 v[124:127], v[156:159], a[12:15], 0
    s_waitcnt vmcnt(13) lgkmcnt(0)
    v_mfma_f32_16x16x32_bf16 v[32:35], v[128:131], a[16:19], v[32:35]
    ds_read_b64_tr_b16 v[144:145], v220 offset:8192
    v_mfma_f32_16x16x32_bf16 v[36:39], v[128:131], a[20:23], v[36:39]
    ds_read_b64_tr_b16 v[146:147], v220 offset:10240
    v_mfma_f32_16x16x32_bf16 v[64:67], v[128:131], a[24:27], v[64:67]
    ds_read_b64_tr_b16 v[148:149], v221 offset:8192
    v_mfma_f32_16x16x32_bf16 v[68:71], v[128:131], a[28:31], v[68:71]
    ds_read_b64_tr_b16 v[150:151], v221 offset:10240
    v_mfma_f32_16x16x32_bf16 v[40:43], v[132:135], a[16:19], v[40:43]
    ds_read_b64_tr_b16 v[152:153], v222 offset:8192
    v_mfma_f32_16x16x32_bf16 v[44:47], v[132:135], a[20:23], v[44:47]
    ds_read_b64_tr_b16 v[154:155], v222 offset:10240
    v_mfma_f32_16x16x32_bf16 v[72:75], v[132:135], a[24:27], v[72:75]
    ds_read_b64_tr_b16 v[156:157], v223 offset:8192
    v_mfma_f32_16x16x32_bf16 v[76:79], v[132:135], a[28:31], v[76:79]
    ds_read_b64_tr_b16 v[158:159], v223 offset:10240
    v_mfma_f32_16x16x32_bf16 v[48:51], v[136:139], a[16:19], v[48:51]
    buffer_load_dwordx4 a[84:87], v227, s[8:11], s35 offen offset:1024 sc1
    v_mfma_f32_16x16x32_bf16 v[52:55], v[136:139], a[20:23], v[52:55]
    v_mfma_f32_16x16x32_bf16 v[80:83], v[136:139], a[24:27], v[80:83]
    v_mfma_f32_16x16x32_bf16 v[84:87], v[136:139], a[28:31], v[84:87]
    buffer_load_dwordx4 a[88:91], v245, s[8:11], s35 offen offset:1024 sc1
    v_mfma_f32_16x16x32_bf16 v[56:59], v[140:143], a[16:19], v[56:59]
    v_mfma_f32_16x16x32_bf16 v[60:63], v[140:143], a[20:23], v[60:63]
    v_mfma_f32_16x16x32_bf16 v[88:91], v[140:143], a[24:27], v[88:91]
    v_mfma_f32_16x16x32_bf16 v[92:95], v[140:143], a[28:31], v[92:95]
    s_waitcnt lgkmcnt(0)
    v_mfma_f32_16x16x32_bf16 v[0:3], v[144:147], a[16:19], v[0:3]
    ds_read_b64_tr_b16 v[128:129], v216 offset:16384
    v_mfma_f32_16x16x32_bf16 v[4:7], v[144:147], a[20:23], v[4:7]
    ds_read_b64_tr_b16 v[130:131], v216 offset:18432
    v_mfma_f32_16x16x32_bf16 v[96:99], v[144:147], a[24:27], v[96:99]
    ds_read_b64_tr_b16 v[132:133], v217 offset:16384
    v_mfma_f32_16x16x32_bf16 v[100:103], v[144:147], a[28:31], v[100:103]
    ds_read_b64_tr_b16 v[134:135], v217 offset:18432
    v_mfma_f32_16x16x32_bf16 v[8:11], v[148:151], a[16:19], v[8:11]
    ds_read_b64_tr_b16 v[136:137], v218 offset:16384
    v_mfma_f32_16x16x32_bf16 v[12:15], v[148:151], a[20:23], v[12:15]
    ds_read_b64_tr_b16 v[138:139], v218 offset:18432
    v_mfma_f32_16x16x32_bf16 v[104:107], v[148:151], a[24:27], v[104:107]
    ds_read_b64_tr_b16 v[140:141], v219 offset:16384
    v_mfma_f32_16x16x32_bf16 v[108:111], v[148:151], a[28:31], v[108:111]
    ds_read_b64_tr_b16 v[142:143], v219 offset:18432
    v_mfma_f32_16x16x32_bf16 v[16:19], v[152:155], a[16:19], v[16:19]
    buffer_load_dwordx4 a[92:95], v246, s[8:11], s35 offen offset:1024 sc1
    v_mfma_f32_16x16x32_bf16 v[20:23], v[152:155], a[20:23], v[20:23]
    v_mfma_f32_16x16x32_bf16 v[112:115], v[152:155], a[24:27], v[112:115]
    buffer_load_dwordx4 a[96:99], v226, s[8:11], s35 offen offset:2048 sc1
    v_mfma_f32_16x16x32_bf16 v[116:119], v[152:155], a[28:31], v[116:119]
    v_mfma_f32_16x16x32_bf16 v[24:27], v[156:159], a[16:19], v[24:27]
    v_mfma_f32_16x16x32_bf16 v[28:31], v[156:159], a[20:23], v[28:31]
    v_mfma_f32_16x16x32_bf16 v[120:123], v[156:159], a[24:27], v[120:123]
    v_mfma_f32_16x16x32_bf16 v[124:127], v[156:159], a[28:31], v[124:127]
    buffer_load_dwordx4 a[100:103], v227, s[8:11], s35 offen offset:2048 sc1
    s_waitcnt vmcnt(14) lgkmcnt(0)
    v_mfma_f32_16x16x32_bf16 v[32:35], v[128:131], a[32:35], v[32:35]
    ds_read_b64_tr_b16 v[144:145], v220 offset:16384
    v_mfma_f32_16x16x32_bf16 v[36:39], v[128:131], a[36:39], v[36:39]
    ds_read_b64_tr_b16 v[146:147], v220 offset:18432
    v_mfma_f32_16x16x32_bf16 v[64:67], v[128:131], a[40:43], v[64:67]
    ds_read_b64_tr_b16 v[148:149], v221 offset:16384
    v_mfma_f32_16x16x32_bf16 v[68:71], v[128:131], a[44:47], v[68:71]
    ds_read_b64_tr_b16 v[150:151], v221 offset:18432
    v_mfma_f32_16x16x32_bf16 v[40:43], v[132:135], a[32:35], v[40:43]
    ds_read_b64_tr_b16 v[152:153], v222 offset:16384
    v_mfma_f32_16x16x32_bf16 v[44:47], v[132:135], a[36:39], v[44:47]
    ds_read_b64_tr_b16 v[154:155], v222 offset:18432
    v_mfma_f32_16x16x32_bf16 v[72:75], v[132:135], a[40:43], v[72:75]
    ds_read_b64_tr_b16 v[156:157], v223 offset:16384
    v_mfma_f32_16x16x32_bf16 v[76:79], v[132:135], a[44:47], v[76:79]
    ds_read_b64_tr_b16 v[158:159], v223 offset:18432
    v_mfma_f32_16x16x32_bf16 v[48:51], v[136:139], a[32:35], v[48:51]
    buffer_load_dwordx4 a[104:107], v245, s[8:11], s35 offen offset:2048 sc1
    v_mfma_f32_16x16x32_bf16 v[52:55], v[136:139], a[36:39], v[52:55]
    v_mfma_f32_16x16x32_bf16 v[80:83], v[136:139], a[40:43], v[80:83]
    v_mfma_f32_16x16x32_bf16 v[84:87], v[136:139], a[44:47], v[84:87]
    buffer_load_dwordx4 a[108:111], v246, s[8:11], s35 offen offset:2048 sc1
    v_mfma_f32_16x16x32_bf16 v[56:59], v[140:143], a[32:35], v[56:59]
    v_mfma_f32_16x16x32_bf16 v[60:63], v[140:143], a[36:39], v[60:63]
    v_mfma_f32_16x16x32_bf16 v[88:91], v[140:143], a[40:43], v[88:91]
    v_mfma_f32_16x16x32_bf16 v[92:95], v[140:143], a[44:47], v[92:95]
    s_waitcnt lgkmcnt(0)
    v_mfma_f32_16x16x32_bf16 v[0:3], v[144:147], a[32:35], v[0:3]
    ds_read_b64_tr_b16 v[128:129], v216 offset:24576
    v_mfma_f32_16x16x32_bf16 v[4:7], v[144:147], a[36:39], v[4:7]
    ds_read_b64_tr_b16 v[130:131], v216 offset:26624
    v_mfma_f32_16x16x32_bf16 v[96:99], v[144:147], a[40:43], v[96:99]
    ds_read_b64_tr_b16 v[132:133], v217 offset:24576
    v_mfma_f32_16x16x32_bf16 v[100:103], v[144:147], a[44:47], v[100:103]
    ds_read_b64_tr_b16 v[134:135], v217 offset:26624
    v_mfma_f32_16x16x32_bf16 v[8:11], v[148:151], a[32:35], v[8:11]
    ds_read_b64_tr_b16 v[136:137], v218 offset:24576
    v_mfma_f32_16x16x32_bf16 v[12:15], v[148:151], a[36:39], v[12:15]
    ds_read_b64_tr_b16 v[138:139], v218 offset:26624
    v_mfma_f32_16x16x32_bf16 v[104:107], v[148:151], a[40:43], v[104:107]
    ds_read_b64_tr_b16 v[140:141], v219 offset:24576
    v_mfma_f32_16x16x32_bf16 v[108:111], v[148:151], a[44:47], v[108:111]
    ds_read_b64_tr_b16 v[142:143], v219 offset:26624
    v_mfma_f32_16x16x32_bf16 v[16:19], v[152:155], a[32:35], v[16:19]
    buffer_load_dwordx4 a[112:115], v226, s[8:11], s35 offen offset:3072 sc1
    v_mfma_f32_16x16x32_bf16 v[20:23], v[152:155], a[36:39], v[20:23]
    v_mfma_f32_16x16x32_bf16 v[112:115], v[152:155], a[40:43], v[112:115]
    buffer_load_dwordx4 a[116:119], v227, s[8:11], s35 offen offset:3072 sc1
    v_mfma_f32_16x16x32_bf16 v[116:119], v[152:155], a[44:47], v[116:119]
    v_mfma_f32_16x16x32_bf16 v[24:27], v[156:159], a[32:35], v[24:27]
    v_mfma_f32_16x16x32_bf16 v[28:31], v[156:159], a[36:39], v[28:31]
    v_mfma_f32_16x16x32_bf16 v[120:123], v[156:159], a[40:43], v[120:123]
    v_mfma_f32_16x16x32_bf16 v[124:127], v[156:159], a[44:47], v[124:127]
    s_waitcnt vmcnt(14) lgkmcnt(0)
    v_mfma_f32_16x16x32_bf16 v[32:35], v[128:131], a[48:51], v[32:35]
    ds_read_b64_tr_b16 v[144:145], v220 offset:24576
    v_mfma_f32_16x16x32_bf16 v[36:39], v[128:131], a[52:55], v[36:39]
    ds_read_b64_tr_b16 v[146:147], v220 offset:26624
    v_mfma_f32_16x16x32_bf16 v[64:67], v[128:131], a[56:59], v[64:67]
    ds_read_b64_tr_b16 v[148:149], v221 offset:24576
    v_mfma_f32_16x16x32_bf16 v[68:71], v[128:131], a[60:63], v[68:71]
    ds_read_b64_tr_b16 v[150:151], v221 offset:26624
    v_mfma_f32_16x16x32_bf16 v[40:43], v[132:135], a[48:51], v[40:43]
    ds_read_b64_tr_b16 v[152:153], v222 offset:24576
    v_mfma_f32_16x16x32_bf16 v[44:47], v[132:135], a[52:55], v[44:47]
    ds_read_b64_tr_b16 v[154:155], v222 offset:26624
    v_mfma_f32_16x16x32_bf16 v[72:75], v[132:135], a[56:59], v[72:75]
    ds_read_b64_tr_b16 v[156:157], v223 offset:24576
    v_mfma_f32_16x16x32_bf16 v[76:79], v[132:135], a[60:63], v[76:79]
    ds_read_b64_tr_b16 v[158:159], v223 offset:26624
    v_mfma_f32_16x16x32_bf16 v[48:51], v[136:139], a[48:51], v[48:51]
    buffer_load_dwordx4 a[120:123], v245, s[8:11], s35 offen offset:3072 sc1
    v_mfma_f32_16x16x32_bf16 v[52:55], v[136:139], a[52:55], v[52:55]
    v_mfma_f32_16x16x32_bf16 v[80:83], v[136:139], a[56:59], v[80:83]
    v_mfma_f32_16x16x32_bf16 v[84:87], v[136:139], a[60:63], v[84:87]
    buffer_load_dwordx4 a[124:127], v246, s[8:11], s35 offen offset:3072 sc1
    v_mfma_f32_16x16x32_bf16 v[56:59], v[140:143], a[48:51], v[56:59]
    v_mfma_f32_16x16x32_bf16 v[60:63], v[140:143], a[52:55], v[60:63]
    v_mfma_f32_16x16x32_bf16 v[88:91], v[140:143], a[56:59], v[88:91]
    v_mfma_f32_16x16x32_bf16 v[92:95], v[140:143], a[60:63], v[92:95]
    s_add_u32 s35, s35, 4096
    buffer_load_dwordx4 a[0:3], v226, s[8:11], s35 offen offset:0 sc1
    s_waitcnt lgkmcnt(0)
    s_barrier
    v_mfma_f32_16x16x32_bf16 v[0:3], v[144:147], a[48:51], v[0:3]
    ds_read_b64_tr_b16 v[128:129], v216 offset:32768
    v_mfma_f32_16x16x32_bf16 v[4:7], v[144:147], a[52:55], v[4:7]
    ds_read_b64_tr_b16 v[130:131], v216 offset:34816
    v_mfma_f32_16x16x32_bf16 v[96:99], v[144:147], a[56:59], v[96:99]
    ds_read_b64_tr_b16 v[132:133], v216 offset:40960
    v_mfma_f32_16x16x32_bf16 v[100:103], v[144:147], a[60:63], v[100:103]
    ds_read_b64_tr_b16 v[134:135], v216 offset:43008
    v_mfma_f32_16x16x32_bf16 v[8:11], v[148:151], a[48:51], v[8:11]
    ds_read_b64_tr_b16 v[136:137], v217 offset:32768
    v_mfma_f32_16x16x32_bf16 v[12:15], v[148:151], a[52:55], v[12:15]
    ds_read_b64_tr_b16 v[138:139], v217 offset:34816
    v_mfma_f32_16x16x32_bf16 v[104:107], v[148:151], a[56:59], v[104:107]
    ds_read_b64_tr_b16 v[140:141], v217 offset:40960
    v_mfma_f32_16x16x32_bf16 v[108:111], v[148:151], a[60:63], v[108:111]
    ds_read_b64_tr_b16 v[142:143], v217 offset:43008
    v_mfma_f32_16x16x32_bf16 v[16:19], v[152:155], a[48:51], v[16:19]
    buffer_load_dwordx4 a[4:7], v227, s[8:11], s35 offen offset:0 sc1
    v_mfma_f32_16x16x32_bf16 v[20:23], v[152:155], a[52:55], v[20:23]
    v_mfma_f32_16x16x32_bf16 v[112:115], v[152:155], a[56:59], v[112:115]
    v_mfma_f32_16x16x32_bf16 v[116:119], v[152:155], a[60:63], v[116:119]
    v_mfma_f32_16x16x32_bf16 v[24:27], v[156:159], a[48:51], v[24:27]
    buffer_load_dwordx4 a[8:11], v245, s[8:11], s35 offen offset:0 sc1
    v_mfma_f32_16x16x32_bf16 v[28:31], v[156:159], a[52:55], v[28:31]
    v_mfma_f32_16x16x32_bf16 v[120:123], v[156:159], a[56:59], v[120:123]
    v_mfma_f32_16x16x32_bf16 v[124:127], v[156:159], a[60:63], v[124:127]
    s_waitcnt vmcnt(11) lgkmcnt(0)
    v_mfma_f32_16x16x32_bf16 v[32:35], v[128:131], a[64:67], v[32:35]
    ds_read_b64_tr_b16 v[144:145], v218 offset:32768
    v_mfma_f32_16x16x32_bf16 v[32:35], v[132:135], a[80:83], v[32:35]
    ds_read_b64_tr_b16 v[146:147], v218 offset:34816
    v_mfma_f32_16x16x32_bf16 v[36:39], v[128:131], a[68:71], v[36:39]
    ds_read_b64_tr_b16 v[148:149], v218 offset:40960
    v_mfma_f32_16x16x32_bf16 v[36:39], v[132:135], a[84:87], v[36:39]
    ds_read_b64_tr_b16 v[150:151], v218 offset:43008
    v_mfma_f32_16x16x32_bf16 v[64:67], v[128:131], a[72:75], v[64:67]
    ds_read_b64_tr_b16 v[152:153], v219 offset:32768
    v_mfma_f32_16x16x32_bf16 v[64:67], v[132:135], a[88:91], v[64:67]
    ds_read_b64_tr_b16 v[154:155], v219 offset:34816
    v_mfma_f32_16x16x32_bf16 v[68:71], v[128:131], a[76:79], v[68:71]
    ds_read_b64_tr_b16 v[156:157], v219 offset:40960
    v_mfma_f32_16x16x32_bf16 v[68:71], v[132:135], a[92:95], v[68:71]
    ds_read_b64_tr_b16 v[158:159], v219 offset:43008
    v_mfma_f32_16x16x32_bf16 v[40:43], v[136:139], a[64:67], v[40:43]
    buffer_load_dwordx4 a[12:15], v246, s[8:11], s35 offen offset:0 sc1
    v_mfma_f32_16x16x32_bf16 v[40:43], v[140:143], a[80:83], v[40:43]
    s_add_u32 m0, s38, 0
    s_add_u32 s32, s37, 1048576
    v_mfma_f32_16x16x32_bf16 v[44:47], v[136:139], a[68:71], v[44:47]
    buffer_load_dwordx4 v224, s[12:15], s32 offen lds
    v_mfma_f32_16x16x32_bf16 v[44:47], v[140:143], a[84:87], v[44:47]
    buffer_load_dwordx4 a[16:19], v226, s[8:11], s35 offen offset:1024 sc1
    v_mfma_f32_16x16x32_bf16 v[72:75], v[136:139], a[72:75], v[72:75]
    v_mfma_f32_16x16x32_bf16 v[72:75], v[140:143], a[88:91], v[72:75]
    buffer_load_dwordx4 v225, s[12:15], s32 offen offset:1024 lds
    v_mfma_f32_16x16x32_bf16 v[76:79], v[136:139], a[76:79], v[76:79]
    v_mfma_f32_16x16x32_bf16 v[76:79], v[140:143], a[92:95], v[76:79]
    s_waitcnt lgkmcnt(0)
    v_mfma_f32_16x16x32_bf16 v[48:51], v[144:147], a[64:67], v[48:51]
    ds_read_b64_tr_b16 v[128:129], v220 offset:32768
    v_mfma_f32_16x16x32_bf16 v[48:51], v[148:151], a[80:83], v[48:51]
    ds_read_b64_tr_b16 v[130:131], v220 offset:34816
    v_mfma_f32_16x16x32_bf16 v[52:55], v[144:147], a[68:71], v[52:55]
    ds_read_b64_tr_b16 v[132:133], v220 offset:40960
    v_mfma_f32_16x16x32_bf16 v[52:55], v[148:151], a[84:87], v[52:55]
    ds_read_b64_tr_b16 v[134:135], v220 offset:43008
    v_mfma_f32_16x16x32_bf16 v[80:83], v[144:147], a[72:75], v[80:83]
    ds_read_b64_tr_b16 v[136:137], v221 offset:32768
    v_mfma_f32_16x16x32_bf16 v[80:83], v[148:151], a[88:91], v[80:83]
    ds_read_b64_tr_b16 v[138:139], v221 offset:34816
    v_mfma_f32_16x16x32_bf16 v[84:87], v[144:147], a[76:79], v[84:87]
    ds_read_b64_tr_b16 v[140:141], v221 offset:40960
    v_mfma_f32_16x16x32_bf16 v[84:87], v[148:151], a[92:95], v[84:87]
    ds_read_b64_tr_b16 v[142:143], v221 offset:43008
    v_mfma_f32_16x16x32_bf16 v[56:59], v[152:155], a[64:67], v[56:59]
    buffer_load_dwordx4 a[20:23], v227, s[8:11], s35 offen offset:1024 sc1
    v_mfma_f32_16x16x32_bf16 v[56:59], v[156:159], a[80:83], v[56:59]
    v_mfma_f32_16x16x32_bf16 v[60:63], v[152:155], a[68:71], v[60:63]
    buffer_load_dwordx4 a[24:27], v245, s[8:11], s35 offen offset:1024 sc1
    v_mfma_f32_16x16x32_bf16 v[60:63], v[156:159], a[84:87], v[60:63]
    v_mfma_f32_16x16x32_bf16 v[88:91], v[152:155], a[72:75], v[88:91]
    v_mfma_f32_16x16x32_bf16 v[88:91], v[156:159], a[88:91], v[88:91]
    v_mfma_f32_16x16x32_bf16 v[92:95], v[152:155], a[76:79], v[92:95]
    v_mfma_f32_16x16x32_bf16 v[92:95], v[156:159], a[92:95], v[92:95]
    buffer_load_dwordx4 a[28:31], v246, s[8:11], s35 offen offset:1024 sc1
    s_waitcnt lgkmcnt(0)
    v_mfma_f32_16x16x32_bf16 v[0:3], v[128:131], a[64:67], v[0:3]
    ds_read_b64_tr_b16 v[144:145], v222 offset:32768
    v_mfma_f32_16x16x32_bf16 v[0:3], v[132:135], a[80:83], v[0:3]
    ds_read_b64_tr_b16 v[146:147], v222 offset:34816
    v_mfma_f32_16x16x32_bf16 v[4:7], v[128:131], a[68:71], v[4:7]
    ds_read_b64_tr_b16 v[148:149], v222 offset:40960
    v_mfma_f32_16x16x32_bf16 v[4:7], v[132:135], a[84:87], v[4:7]
    ds_read_b64_tr_b16 v[150:151], v222 offset:43008
    v_mfma_f32_16x16x32_bf16 v[96:99], v[128:131], a[72:75], v[96:99]
    ds_read_b64_tr_b16 v[152:153], v223 offset:32768
    v_mfma_f32_16x16x32_bf16 v[96:99], v[132:135], a[88:91], v[96:99]
    ds_read_b64_tr_b16 v[154:155], v223 offset:34816
    v_mfma_f32_16x16x32_bf16 v[100:103], v[128:131], a[76:79], v[100:103]
    ds_read_b64_tr_b16 v[156:157], v223 offset:40960
    v_mfma_f32_16x16x32_bf16 v[100:103], v[132:135], a[92:95], v[100:103]
    ds_read_b64_tr_b16 v[158:159], v223 offset:43008
    v_mfma_f32_16x16x32_bf16 v[8:11], v[136:139], a[64:67], v[8:11]
    buffer_load_dwordx4 a[32:35], v226, s[8:11], s35 offen offset:2048 sc1
    v_mfma_f32_16x16x32_bf16 v[8:11], v[140:143], a[80:83], v[8:11]
    s_add_u32 m0, s38, 8192
    s_add_u32 s32, s37, 1114112
    v_mfma_f32_16x16x32_bf16 v[12:15], v[136:139], a[68:71], v[12:15]
    buffer_load_dwordx4 v224, s[12:15], s32 offen lds
    v_mfma_f32_16x16x32_bf16 v[12:15], v[140:143], a[84:87], v[12:15]
    buffer_load_dwordx4 a[36:39], v227, s[8:11], s35 offen offset:2048 sc1
    v_mfma_f32_16x16x32_bf16 v[104:107], v[136:139], a[72:75], v[104:107]
    v_mfma_f32_16x16x32_bf16 v[104:107], v[140:143], a[88:91], v[104:107]
    buffer_load_dwordx4 v225, s[12:15], s32 offen offset:1024 lds
    v_mfma_f32_16x16x32_bf16 v[108:111], v[136:139], a[76:79], v[108:111]
    v_mfma_f32_16x16x32_bf16 v[108:111], v[140:143], a[92:95], v[108:111]
    s_waitcnt lgkmcnt(0)
    v_mfma_f32_16x16x32_bf16 v[16:19], v[144:147], a[64:67], v[16:19]
    ds_read_b64_tr_b16 v[128:129], v216 offset:49152
    v_mfma_f32_16x16x32_bf16 v[16:19], v[148:151], a[80:83], v[16:19]
    ds_read_b64_tr_b16 v[130:131], v216 offset:51200
    v_mfma_f32_16x16x32_bf16 v[20:23], v[144:147], a[68:71], v[20:23]
    ds_read_b64_tr_b16 v[132:133], v216 offset:57344
    v_mfma_f32_16x16x32_bf16 v[20:23], v[148:151], a[84:87], v[20:23]
    ds_read_b64_tr_b16 v[134:135], v216 offset:59392
    v_mfma_f32_16x16x32_bf16 v[112:115], v[144:147], a[72:75], v[112:115]
    ds_read_b64_tr_b16 v[136:137], v217 offset:49152
    v_mfma_f32_16x16x32_bf16 v[112:115], v[148:151], a[88:91], v[112:115]
    ds_read_b64_tr_b16 v[138:139], v217 offset:51200
    v_mfma_f32_16x16x32_bf16 v[116:119], v[144:147], a[76:79], v[116:119]
    ds_read_b64_tr_b16 v[140:141], v217 offset:57344
    v_mfma_f32_16x16x32_bf16 v[116:119], v[148:151], a[92:95], v[116:119]
    ds_read_b64_tr_b16 v[142:143], v217 offset:59392
    v_mfma_f32_16x16x32_bf16 v[24:27], v[152:155], a[64:67], v[24:27]
    buffer_load_dwordx4 a[40:43], v245, s[8:11], s35 offen offset:2048 sc1
    v_mfma_f32_16x16x32_bf16 v[24:27], v[156:159], a[80:83], v[24:27]
    v_mfma_f32_16x16x32_bf16 v[28:31], v[152:155], a[68:71], v[28:31]
    buffer_load_dwordx4 a[44:47], v246, s[8:11], s35 offen offset:2048 sc1
    v_mfma_f32_16x16x32_bf16 v[28:31], v[156:159], a[84:87], v[28:31]
    v_mfma_f32_16x16x32_bf16 v[120:123], v[152:155], a[72:75], v[120:123]
    v_mfma_f32_16x16x32_bf16 v[120:123], v[156:159], a[88:91], v[120:123]
    v_mfma_f32_16x16x32_bf16 v[124:127], v[152:155], a[76:79], v[124:127]
    v_mfma_f32_16x16x32_bf16 v[124:127], v[156:159], a[92:95], v[124:127]
    s_waitcnt vmcnt(16) lgkmcnt(0)
    v_mfma_f32_16x16x32_bf16 v[32:35], v[128:131], a[96:99], v[32:35]
    ds_read_b64_tr_b16 v[144:145], v218 offset:49152
    v_mfma_f32_16x16x32_bf16 v[32:35], v[132:135], a[112:115], v[32:35]
    ds_read_b64_tr_b16 v[146:147], v218 offset:51200
    v_mfma_f32_16x16x32_bf16 v[36:39], v[128:131], a[100:103], v[36:39]
    ds_read_b64_tr_b16 v[148:149], v218 offset:57344
    v_mfma_f32_16x16x32_bf16 v[36:39], v[132:135], a[116:119], v[36:39]
    ds_read_b64_tr_b16 v[150:151], v218 offset:59392
    v_mfma_f32_16x16x32_bf16 v[64:67], v[128:131], a[104:107], v[64:67]
    ds_read_b64_tr_b16 v[152:153], v219 offset:49152
    v_mfma_f32_16x16x32_bf16 v[64:67], v[132:135], a[120:123], v[64:67]
    ds_read_b64_tr_b16 v[154:155], v219 offset:51200
    v_mfma_f32_16x16x32_bf16 v[68:71], v[128:131], a[108:111], v[68:71]
    ds_read_b64_tr_b16 v[156:157], v219 offset:57344
    v_mfma_f32_16x16x32_bf16 v[68:71], v[132:135], a[124:127], v[68:71]
    ds_read_b64_tr_b16 v[158:159], v219 offset:59392
    v_mfma_f32_16x16x32_bf16 v[40:43], v[136:139], a[96:99], v[40:43]
    buffer_load_dwordx4 a[48:51], v226, s[8:11], s35 offen offset:3072 sc1
    v_mfma_f32_16x16x32_bf16 v[40:43], v[140:143], a[112:115], v[40:43]
    s_add_u32 m0, s38, 16384
    s_add_u32 s32, s37, 1179648
    v_mfma_f32_16x16x32_bf16 v[44:47], v[136:139], a[100:103], v[44:47]
    buffer_load_dwordx4 v224, s[12:15], s32 offen lds
    v_mfma_f32_16x16x32_bf16 v[44:47], v[140:143], a[116:119], v[44:47]
    buffer_load_dwordx4 a[52:55], v227, s[8:11], s35 offen offset:3072 sc1
    v_mfma_f32_16x16x32_bf16 v[72:75], v[136:139], a[104:107], v[72:75]
    v_mfma_f32_16x16x32_bf16 v[72:75], v[140:143], a[120:123], v[72:75]
    buffer_load_dwordx4 v225, s[12:15], s32 offen offset:1024 lds
    v_mfma_f32_16x16x32_bf16 v[76:79], v[136:139], a[108:111], v[76:79]
    v_mfma_f32_16x16x32_bf16 v[76:79], v[140:143], a[124:127], v[76:79]
    buffer_load_dwordx4 a[56:59], v245, s[8:11], s35 offen offset:3072 sc1
    s_waitcnt lgkmcnt(0)
    v_mfma_f32_16x16x32_bf16 v[48:51], v[144:147], a[96:99], v[48:51]
    ds_read_b64_tr_b16 v[128:129], v220 offset:49152
    v_mfma_f32_16x16x32_bf16 v[48:51], v[148:151], a[112:115], v[48:51]
    ds_read_b64_tr_b16 v[130:131], v220 offset:51200
    v_mfma_f32_16x16x32_bf16 v[52:55], v[144:147], a[100:103], v[52:55]
    ds_read_b64_tr_b16 v[132:133], v220 offset:57344
    v_mfma_f32_16x16x32_bf16 v[52:55], v[148:151], a[116:119], v[52:55]
    ds_read_b64_tr_b16 v[134:135], v220 offset:59392
    v_mfma_f32_16x16x32_bf16 v[80:83], v[144:147], a[104:107], v[80:83]
    ds_read_b64_tr_b16 v[136:137], v221 offset:49152
    v_mfma_f32_16x16x32_bf16 v[80:83], v[148:151], a[120:123], v[80:83]
    ds_read_b64_tr_b16 v[138:139], v221 offset:51200
    v_mfma_f32_16x16x32_bf16 v[84:87], v[144:147], a[108:111], v[84:87]
    ds_read_b64_tr_b16 v[140:141], v221 offset:57344
    v_mfma_f32_16x16x32_bf16 v[84:87], v[148:151], a[124:127], v[84:87]
    ds_read_b64_tr_b16 v[142:143], v221 offset:59392
    v_mfma_f32_16x16x32_bf16 v[56:59], v[152:155], a[96:99], v[56:59]
    buffer_load_dwordx4 a[60:63], v246, s[8:11], s35 offen offset:3072 sc1
    v_mfma_f32_16x16x32_bf16 v[56:59], v[156:159], a[112:115], v[56:59]
    v_mfma_f32_16x16x32_bf16 v[60:63], v[152:155], a[100:103], v[60:63]
    v_mfma_f32_16x16x32_bf16 v[60:63], v[156:159], a[116:119], v[60:63]
    v_mfma_f32_16x16x32_bf16 v[88:91], v[152:155], a[104:107], v[88:91]
    s_add_u32 s35, s35, 4096
    buffer_load_dwordx4 a[64:67], v226, s[8:11], s35 offen offset:0 sc1
    v_mfma_f32_16x16x32_bf16 v[88:91], v[156:159], a[120:123], v[88:91]
    v_mfma_f32_16x16x32_bf16 v[92:95], v[152:155], a[108:111], v[92:95]
    v_mfma_f32_16x16x32_bf16 v[92:95], v[156:159], a[124:127], v[92:95]
    s_waitcnt lgkmcnt(0)
    v_mfma_f32_16x16x32_bf16 v[0:3], v[128:131], a[96:99], v[0:3]
    ds_read_b64_tr_b16 v[144:145], v222 offset:49152
    v_mfma_f32_16x16x32_bf16 v[0:3], v[132:135], a[112:115], v[0:3]
    ds_read_b64_tr_b16 v[146:147], v222 offset:51200
    v_mfma_f32_16x16x32_bf16 v[4:7], v[128:131], a[100:103], v[4:7]
    ds_read_b64_tr_b16 v[148:149], v222 offset:57344
    v_mfma_f32_16x16x32_bf16 v[4:7], v[132:135], a[116:119], v[4:7]
    ds_read_b64_tr_b16 v[150:151], v222 offset:59392
    v_mfma_f32_16x16x32_bf16 v[96:99], v[128:131], a[104:107], v[96:99]
    ds_read_b64_tr_b16 v[152:153], v223 offset:49152
    v_mfma_f32_16x16x32_bf16 v[96:99], v[132:135], a[120:123], v[96:99]
    ds_read_b64_tr_b16 v[154:155], v223 offset:51200
    v_mfma_f32_16x16x32_bf16 v[100:103], v[128:131], a[108:111], v[100:103]
    ds_read_b64_tr_b16 v[156:157], v223 offset:57344
    v_mfma_f32_16x16x32_bf16 v[100:103], v[132:135], a[124:127], v[100:103]
    ds_read_b64_tr_b16 v[158:159], v223 offset:59392
    v_mfma_f32_16x16x32_bf16 v[8:11], v[136:139], a[96:99], v[8:11]
    buffer_load_dwordx4 a[68:71], v227, s[8:11], s35 offen offset:0 sc1
    v_mfma_f32_16x16x32_bf16 v[8:11], v[140:143], a[112:115], v[8:11]
    s_add_u32 m0, s38, 24576
    s_add_u32 s32, s37, 1245184
    v_mfma_f32_16x16x32_bf16 v[12:15], v[136:139], a[100:103], v[12:15]
    buffer_load_dwordx4 v224, s[12:15], s32 offen lds
    v_mfma_f32_16x16x32_bf16 v[12:15], v[140:143], a[116:119], v[12:15]
    buffer_load_dwordx4 a[72:75], v245, s[8:11], s35 offen offset:0 sc1
    v_mfma_f32_16x16x32_bf16 v[104:107], v[136:139], a[104:107], v[104:107]
    v_mfma_f32_16x16x32_bf16 v[104:107], v[140:143], a[120:123], v[104:107]
    buffer_load_dwordx4 v225, s[12:15], s32 offen offset:1024 lds
    v_mfma_f32_16x16x32_bf16 v[108:111], v[136:139], a[108:111], v[108:111]
    v_mfma_f32_16x16x32_bf16 v[108:111], v[140:143], a[124:127], v[108:111]
    s_waitcnt lgkmcnt(0)
    s_barrier
    v_mfma_f32_16x16x32_bf16 v[16:19], v[144:147], a[96:99], v[16:19]
    v_xor_b32 v216, 0x10000, v216
    ds_read_b64_tr_b16 v[128:129], v216 offset:0
    v_mfma_f32_16x16x32_bf16 v[16:19], v[148:151], a[112:115], v[16:19]
    ds_read_b64_tr_b16 v[130:131], v216 offset:2048
    v_mfma_f32_16x16x32_bf16 v[20:23], v[144:147], a[100:103], v[20:23]
    ds_read_b64_tr_b16 v[132:133], v216 offset:8192
    v_mfma_f32_16x16x32_bf16 v[20:23], v[148:151], a[116:119], v[20:23]
    ds_read_b64_tr_b16 v[134:135], v216 offset:10240
    v_mfma_f32_16x16x32_bf16 v[112:115], v[144:147], a[104:107], v[112:115]
    v_xor_b32 v217, 0x10000, v217
    ds_read_b64_tr_b16 v[136:137], v217 offset:0
    v_mfma_f32_16x16x32_bf16 v[112:115], v[148:151], a[120:123], v[112:115]
    ds_read_b64_tr_b16 v[138:139], v217 offset:2048
    v_mfma_f32_16x16x32_bf16 v[116:119], v[144:147], a[108:111], v[116:119]
    ds_read_b64_tr_b16 v[140:141], v217 offset:8192
    v_mfma_f32_16x16x32_bf16 v[116:119], v[148:151], a[124:127], v[116:119]
    ds_read_b64_tr_b16 v[142:143], v217 offset:10240
    v_mfma_f32_16x16x32_bf16 v[24:27], v[152:155], a[96:99], v[24:27]
    buffer_load_dwordx4 a[76:79], v246, s[8:11], s35 offen offset:0 sc1
    v_mfma_f32_16x16x32_bf16 v[24:27], v[156:159], a[112:115], v[24:27]
    v_mfma_f32_16x16x32_bf16 v[28:31], v[152:155], a[100:103], v[28:31]
    buffer_load_dwordx4 a[80:83], v226, s[8:11], s35 offen offset:1024 sc1
    v_mfma_f32_16x16x32_bf16 v[28:31], v[156:159], a[116:119], v[28:31]
    v_mfma_f32_16x16x32_bf16 v[120:123], v[152:155], a[104:107], v[120:123]
    v_mfma_f32_16x16x32_bf16 v[120:123], v[156:159], a[120:123], v[120:123]
    v_mfma_f32_16x16x32_bf16 v[124:127], v[152:155], a[108:111], v[124:127]
    v_mfma_f32_16x16x32_bf16 v[124:127], v[156:159], a[124:127], v[124:127]
    buffer_load_dwordx4 a[84:87], v227, s[8:11], s35 offen offset:1024 sc1
    s_waitcnt vmcnt(20) lgkmcnt(0)
    v_mfma_f32_16x16x32_bf16 v[32:35], v[128:131], a[0:3], v[32:35]
    v_xor_b32 v218, 0x10000, v218
    ds_read_b64_tr_b16 v[144:145], v218 offset:0
    v_mfma_f32_16x16x32_bf16 v[32:35], v[132:135], a[16:19], v[32:35]
    ds_read_b64_tr_b16 v[146:147], v218 offset:2048
    v_mfma_f32_16x16x32_bf16 v[36:39], v[128:131], a[4:7], v[36:39]
    ds_read_b64_tr_b16 v[148:149], v218 offset:8192
    v_mfma_f32_16x16x32_bf16 v[36:39], v[132:135], a[20:23], v[36:39]
    ds_read_b64_tr_b16 v[150:151], v218 offset:10240
    v_mfma_f32_16x16x32_bf16 v[64:67], v[128:131], a[8:11], v[64:67]
    v_xor_b32 v219, 0x10000, v219
    ds_read_b64_tr_b16 v[152:153], v219 offset:0
    v_mfma_f32_16x16x32_bf16 v[64:67], v[132:135], a[24:27], v[64:67]
    ds_read_b64_tr_b16 v[154:155], v219 offset:2048
    v_mfma_f32_16x16x32_bf16 v[68:71], v[128:131], a[12:15], v[68:71]
    ds_read_b64_tr_b16 v[156:157], v219 offset:8192
    v_mfma_f32_16x16x32_bf16 v[68:71], v[132:135], a[28:31], v[68:71]
    ds_read_b64_tr_b16 v[158:159], v219 offset:10240
    v_mfma_f32_16x16x32_bf16 v[40:43], v[136:139], a[0:3], v[40:43]
    buffer_load_dwordx4 a[88:91], v245, s[8:11], s35 offen offset:1024 sc1
    v_mfma_f32_16x16x32_bf16 v[40:43], v[140:143], a[16:19], v[40:43]
    s_add_u32 m0, s38, 32768
    s_add_u32 s32, s37, 1310720
    v_mfma_f32_16x16x32_bf16 v[44:47], v[136:139], a[4:7], v[44:47]
    buffer_load_dwordx4 v224, s[12:15], s32 offen lds
    v_mfma_f32_16x16x32_bf16 v[44:47], v[140:143], a[20:23], v[44:47]
    buffer_load_dwordx4 a[92:95], v246, s[8:11], s35 offen offset:1024 sc1
    v_mfma_f32_16x16x32_bf16 v[72:75], v[136:139], a[8:11], v[72:75]
    v_mfma_f32_16x16x32_bf16 v[72:75], v[140:143], a[24:27], v[72:75]
    buffer_load_dwordx4 v225, s[12:15], s32 offen offset:1024 lds
    v_mfma_f32_16x16x32_bf16 v[76:79], v[136:139], a[12:15], v[76:79]
    s_lshl_b32 s45, s52, 7
    s_add_u32 s45, s45, 0x38a1400
    v_mfma_f32_16x16x32_bf16 v[76:79], v[140:143], a[28:31], v[76:79]
    s_waitcnt lgkmcnt(0)
    v_mfma_f32_16x16x32_bf16 v[48:51], v[144:147], a[0:3], v[48:51]
    v_xor_b32 v220, 0x10000, v220
    ds_read_b64_tr_b16 v[128:129], v220 offset:0
    v_mfma_f32_16x16x32_bf16 v[48:51], v[148:151], a[16:19], v[48:51]
    ds_read_b64_tr_b16 v[130:131], v220 offset:2048
    v_mfma_f32_16x16x32_bf16 v[52:55], v[144:147], a[4:7], v[52:55]
    ds_read_b64_tr_b16 v[132:133], v220 offset:8192
    v_mfma_f32_16x16x32_bf16 v[52:55], v[148:151], a[20:23], v[52:55]
    ds_read_b64_tr_b16 v[134:135], v220 offset:10240
    v_mfma_f32_16x16x32_bf16 v[80:83], v[144:147], a[8:11], v[80:83]
    v_xor_b32 v221, 0x10000, v221
    ds_read_b64_tr_b16 v[136:137], v221 offset:0
    v_mfma_f32_16x16x32_bf16 v[80:83], v[148:151], a[24:27], v[80:83]
    ds_read_b64_tr_b16 v[138:139], v221 offset:2048
    v_mfma_f32_16x16x32_bf16 v[84:87], v[144:147], a[12:15], v[84:87]
    ds_read_b64_tr_b16 v[140:141], v221 offset:8192
    v_mfma_f32_16x16x32_bf16 v[84:87], v[148:151], a[28:31], v[84:87]
    ds_read_b64_tr_b16 v[142:143], v221 offset:10240
    v_mfma_f32_16x16x32_bf16 v[56:59], v[152:155], a[0:3], v[56:59]
    buffer_load_dwordx4 a[96:99], v226, s[8:11], s35 offen offset:2048 sc1
    v_mfma_f32_16x16x32_bf16 v[56:59], v[156:159], a[16:19], v[56:59]
    s_cmp_eq_u32 s3, 0
    s_cselect_b32 s45, s45, 0x40000000
    v_mfma_f32_16x16x32_bf16 v[60:63], v[152:155], a[4:7], v[60:63]
    buffer_load_dwordx4 a[100:103], v227, s[8:11], s35 offen offset:2048 sc1
    buffer_load_dword v235, off, s[8:11], s45 sc1
    v_mfma_f32_16x16x32_bf16 v[60:63], v[156:159], a[20:23], v[60:63]
    v_mfma_f32_16x16x32_bf16 v[88:91], v[152:155], a[8:11], v[88:91]
    v_mfma_f32_16x16x32_bf16 v[88:91], v[156:159], a[24:27], v[88:91]
    v_mfma_f32_16x16x32_bf16 v[92:95], v[152:155], a[12:15], v[92:95]
    v_mfma_f32_16x16x32_bf16 v[92:95], v[156:159], a[28:31], v[92:95]
    s_waitcnt lgkmcnt(0)
    v_mfma_f32_16x16x32_bf16 v[0:3], v[128:131], a[0:3], v[0:3]
    v_xor_b32 v222, 0x10000, v222
    ds_read_b64_tr_b16 v[144:145], v222 offset:0
    v_mfma_f32_16x16x32_bf16 v[0:3], v[132:135], a[16:19], v[0:3]
    ds_read_b64_tr_b16 v[146:147], v222 offset:2048
    v_mfma_f32_16x16x32_bf16 v[4:7], v[128:131], a[4:7], v[4:7]
    ds_read_b64_tr_b16 v[148:149], v222 offset:8192
    v_mfma_f32_16x16x32_bf16 v[4:7], v[132:135], a[20:23], v[4:7]
    ds_read_b64_tr_b16 v[150:151], v222 offset:10240
    v_mfma_f32_16x16x32_bf16 v[96:99], v[128:131], a[8:11], v[96:99]
    v_xor_b32 v223, 0x10000, v223
    ds_read_b64_tr_b16 v[152:153], v223 offset:0
    v_mfma_f32_16x16x32_bf16 v[96:99], v[132:135], a[24:27], v[96:99]
    ds_read_b64_tr_b16 v[154:155], v223 offset:2048
    v_mfma_f32_16x16x32_bf16 v[100:103], v[128:131], a[12:15], v[100:103]
    ds_read_b64_tr_b16 v[156:157], v223 offset:8192
    v_mfma_f32_16x16x32_bf16 v[100:103], v[132:135], a[28:31], v[100:103]
    ds_read_b64_tr_b16 v[158:159], v223 offset:10240
    v_mfma_f32_16x16x32_bf16 v[8:11], v[136:139], a[0:3], v[8:11]
    buffer_load_dwordx4 a[104:107], v245, s[8:11], s35 offen offset:2048 sc1
    v_mfma_f32_16x16x32_bf16 v[8:11], v[140:143], a[16:19], v[8:11]
    s_add_u32 m0, s38, 40960
    s_add_u32 s32, s37, 1376256
    v_mfma_f32_16x16x32_bf16 v[12:15], v[136:139], a[4:7], v[12:15]
    buffer_load_dwordx4 v224, s[12:15], s32 offen lds
    v_mfma_f32_16x16x32_bf16 v[12:15], v[140:143], a[20:23], v[12:15]
    buffer_load_dwordx4 a[108:111], v246, s[8:11], s35 offen offset:2048 sc1
    v_mfma_f32_16x16x32_bf16 v[104:107], v[136:139], a[8:11], v[104:107]
    v_mfma_f32_16x16x32_bf16 v[104:107], v[140:143], a[24:27], v[104:107]
    buffer_load_dwordx4 v225, s[12:15], s32 offen offset:1024 lds
    v_mfma_f32_16x16x32_bf16 v[108:111], v[136:139], a[12:15], v[108:111]
    v_mfma_f32_16x16x32_bf16 v[108:111], v[140:143], a[28:31], v[108:111]
    buffer_load_dwordx4 a[112:115], v226, s[8:11], s35 offen offset:3072 sc1
    s_waitcnt lgkmcnt(0)
    v_mfma_f32_16x16x32_bf16 v[16:19], v[144:147], a[0:3], v[16:19]
    ds_read_b64_tr_b16 v[128:129], v216 offset:16384
    v_mfma_f32_16x16x32_bf16 v[16:19], v[148:151], a[16:19], v[16:19]
    ds_read_b64_tr_b16 v[130:131], v216 offset:18432
    v_mfma_f32_16x16x32_bf16 v[20:23], v[144:147], a[4:7], v[20:23]
    ds_read_b64_tr_b16 v[132:133], v216 offset:24576
    v_mfma_f32_16x16x32_bf16 v[20:23], v[148:151], a[20:23], v[20:23]
    ds_read_b64_tr_b16 v[134:135], v216 offset:26624
    v_mfma_f32_16x16x32_bf16 v[112:115], v[144:147], a[8:11], v[112:115]
    ds_read_b64_tr_b16 v[136:137], v217 offset:16384
    v_mfma_f32_16x16x32_bf16 v[112:115], v[148:151], a[24:27], v[112:115]
    ds_read_b64_tr_b16 v[138:139], v217 offset:18432
    v_mfma_f32_16x16x32_bf16 v[116:119], v[144:147], a[12:15], v[116:119]
    ds_read_b64_tr_b16 v[140:141], v217 offset:24576
    v_mfma_f32_16x16x32_bf16 v[116:119], v[148:151], a[28:31], v[116:119]
    ds_read_b64_tr_b16 v[142:143], v217 offset:26624
    v_mfma_f32_16x16x32_bf16 v[24:27], v[152:155], a[0:3], v[24:27]
    buffer_load_dwordx4 a[116:119], v227, s[8:11], s35 offen offset:3072 sc1
    v_mfma_f32_16x16x32_bf16 v[24:27], v[156:159], a[16:19], v[24:27]
    v_mfma_f32_16x16x32_bf16 v[28:31], v[152:155], a[4:7], v[28:31]
    v_mfma_f32_16x16x32_bf16 v[28:31], v[156:159], a[20:23], v[28:31]
    v_mfma_f32_16x16x32_bf16 v[120:123], v[152:155], a[8:11], v[120:123]
    buffer_load_dwordx4 a[120:123], v245, s[8:11], s35 offen offset:3072 sc1
    v_mfma_f32_16x16x32_bf16 v[120:123], v[156:159], a[24:27], v[120:123]
    v_mfma_f32_16x16x32_bf16 v[124:127], v[152:155], a[12:15], v[124:127]
    v_mfma_f32_16x16x32_bf16 v[124:127], v[156:159], a[28:31], v[124:127]
    s_waitcnt vmcnt(22) lgkmcnt(0)
    v_mfma_f32_16x16x32_bf16 v[32:35], v[128:131], a[32:35], v[32:35]
    ds_read_b64_tr_b16 v[144:145], v218 offset:16384
    v_mfma_f32_16x16x32_bf16 v[32:35], v[132:135], a[48:51], v[32:35]
    ds_read_b64_tr_b16 v[146:147], v218 offset:18432
    v_mfma_f32_16x16x32_bf16 v[36:39], v[128:131], a[36:39], v[36:39]
    ds_read_b64_tr_b16 v[148:149], v218 offset:24576
    v_mfma_f32_16x16x32_bf16 v[36:39], v[132:135], a[52:55], v[36:39]
    ds_read_b64_tr_b16 v[150:151], v218 offset:26624
    v_mfma_f32_16x16x32_bf16 v[64:67], v[128:131], a[40:43], v[64:67]
    ds_read_b64_tr_b16 v[152:153], v219 offset:16384
    v_mfma_f32_16x16x32_bf16 v[64:67], v[132:135], a[56:59], v[64:67]
    ds_read_b64_tr_b16 v[154:155], v219 offset:18432
    v_mfma_f32_16x16x32_bf16 v[68:71], v[128:131], a[44:47], v[68:71]
    ds_read_b64_tr_b16 v[156:157], v219 offset:24576
    v_mfma_f32_16x16x32_bf16 v[68:71], v[132:135], a[60:63], v[68:71]
    ds_read_b64_tr_b16 v[158:159], v219 offset:26624
    v_mfma_f32_16x16x32_bf16 v[40:43], v[136:139], a[32:35], v[40:43]
    buffer_load_dwordx4 a[124:127], v246, s[8:11], s35 offen offset:3072 sc1
    v_mfma_f32_16x16x32_bf16 v[40:43], v[140:143], a[48:51], v[40:43]
    s_add_u32 m0, s38, 49152
    s_add_u32 s32, s37, 1441792
    v_mfma_f32_16x16x32_bf16 v[44:47], v[136:139], a[36:39], v[44:47]
    buffer_load_dwordx4 v224, s[12:15], s32 offen lds
    v_mfma_f32_16x16x32_bf16 v[44:47], v[140:143], a[52:55], v[44:47]
    s_add_u32 s35, s35, 4096
    buffer_load_dwordx4 a[0:3], v226, s[8:11], s35 offen offset:0 sc1
    v_mfma_f32_16x16x32_bf16 v[72:75], v[136:139], a[40:43], v[72:75]
    v_mfma_f32_16x16x32_bf16 v[72:75], v[140:143], a[56:59], v[72:75]
    buffer_load_dwordx4 v225, s[12:15], s32 offen offset:1024 lds
    v_mfma_f32_16x16x32_bf16 v[76:79], v[136:139], a[44:47], v[76:79]
    v_mfma_f32_16x16x32_bf16 v[76:79], v[140:143], a[60:63], v[76:79]
    s_waitcnt lgkmcnt(0)
    v_mfma_f32_16x16x32_bf16 v[48:51], v[144:147], a[32:35], v[48:51]
    ds_read_b64_tr_b16 v[128:129], v220 offset:16384
    v_mfma_f32_16x16x32_bf16 v[48:51], v[148:151], a[48:51], v[48:51]
    ds_read_b64_tr_b16 v[130:131], v220 offset:18432
    v_mfma_f32_16x16x32_bf16 v[52:55], v[144:147], a[36:39], v[52:55]
    ds_read_b64_tr_b16 v[132:133], v220 offset:24576
    v_mfma_f32_16x16x32_bf16 v[52:55], v[148:151], a[52:55], v[52:55]
    ds_read_b64_tr_b16 v[134:135], v220 offset:26624
    v_mfma_f32_16x16x32_bf16 v[80:83], v[144:147], a[40:43], v[80:83]
    ds_read_b64_tr_b16 v[136:137], v221 offset:16384
    v_mfma_f32_16x16x32_bf16 v[80:83], v[148:151], a[56:59], v[80:83]
    ds_read_b64_tr_b16 v[138:139], v221 offset:18432
    v_mfma_f32_16x16x32_bf16 v[84:87], v[144:147], a[44:47], v[84:87]
    ds_read_b64_tr_b16 v[140:141], v221 offset:24576
    v_mfma_f32_16x16x32_bf16 v[84:87], v[148:151], a[60:63], v[84:87]
    ds_read_b64_tr_b16 v[142:143], v221 offset:26624
    v_mfma_f32_16x16x32_bf16 v[56:59], v[152:155], a[32:35], v[56:59]
    buffer_load_dwordx4 a[4:7], v227, s[8:11], s35 offen offset:0 sc1
    v_mfma_f32_16x16x32_bf16 v[56:59], v[156:159], a[48:51], v[56:59]
    v_mfma_f32_16x16x32_bf16 v[60:63], v[152:155], a[36:39], v[60:63]
    buffer_load_dwordx4 a[8:11], v245, s[8:11], s35 offen offset:0 sc1
    v_mfma_f32_16x16x32_bf16 v[60:63], v[156:159], a[52:55], v[60:63]
    v_mfma_f32_16x16x32_bf16 v[88:91], v[152:155], a[40:43], v[88:91]
    v_mfma_f32_16x16x32_bf16 v[88:91], v[156:159], a[56:59], v[88:91]
    v_mfma_f32_16x16x32_bf16 v[92:95], v[152:155], a[44:47], v[92:95]
    v_mfma_f32_16x16x32_bf16 v[92:95], v[156:159], a[60:63], v[92:95]
    buffer_load_dwordx4 a[12:15], v246, s[8:11], s35 offen offset:0 sc1
    s_waitcnt lgkmcnt(0)
    v_mfma_f32_16x16x32_bf16 v[0:3], v[128:131], a[32:35], v[0:3]
    ds_read_b64_tr_b16 v[144:145], v222 offset:16384
    v_mfma_f32_16x16x32_bf16 v[0:3], v[132:135], a[48:51], v[0:3]
    ds_read_b64_tr_b16 v[146:147], v222 offset:18432
    v_mfma_f32_16x16x32_bf16 v[4:7], v[128:131], a[36:39], v[4:7]
    ds_read_b64_tr_b16 v[148:149], v222 offset:24576
    v_mfma_f32_16x16x32_bf16 v[4:7], v[132:135], a[52:55], v[4:7]
    ds_read_b64_tr_b16 v[150:151], v222 offset:26624
    v_mfma_f32_16x16x32_bf16 v[96:99], v[128:131], a[40:43], v[96:99]
    ds_read_b64_tr_b16 v[152:153], v223 offset:16384
    v_mfma_f32_16x16x32_bf16 v[96:99], v[132:135], a[56:59], v[96:99]
    ds_read_b64_tr_b16 v[154:155], v223 offset:18432
    v_mfma_f32_16x16x32_bf16 v[100:103], v[128:131], a[44:47], v[100:103]
    ds_read_b64_tr_b16 v[156:157], v223 offset:24576
    v_mfma_f32_16x16x32_bf16 v[100:103], v[132:135], a[60:63], v[100:103]
    ds_read_b64_tr_b16 v[158:159], v223 offset:26624
    v_mfma_f32_16x16x32_bf16 v[8:11], v[136:139], a[32:35], v[8:11]
    buffer_load_dwordx4 a[16:19], v226, s[8:11], s35 offen offset:1024 sc1
    v_mfma_f32_16x16x32_bf16 v[8:11], v[140:143], a[48:51], v[8:11]
    s_add_u32 m0, s38, 57344
    s_add_u32 s32, s37, 1507328
    v_mfma_f32_16x16x32_bf16 v[12:15], v[136:139], a[36:39], v[12:15]
    buffer_load_dwordx4 v224, s[12:15], s32 offen lds
    v_mfma_f32_16x16x32_bf16 v[12:15], v[140:143], a[52:55], v[12:15]
    buffer_load_dwordx4 a[20:23], v227, s[8:11], s35 offen offset:1024 sc1
    v_mfma_f32_16x16x32_bf16 v[104:107], v[136:139], a[40:43], v[104:107]
    v_mfma_f32_16x16x32_bf16 v[104:107], v[140:143], a[56:59], v[104:107]
    buffer_load_dwordx4 v225, s[12:15], s32 offen offset:1024 lds
    v_mfma_f32_16x16x32_bf16 v[108:111], v[136:139], a[44:47], v[108:111]
    s_waitcnt vmcnt(18)
    v_readfirstlane_b32 s36, v235
    s_lshl_b32 s34, s3, 8
    s_add_u32 s36, s36, s34
    s_cmp_ge_u32 s36, 8
    s_cbranch_scc0 kc_g
kc_gr:
    v_mfma_f32_16x16x32_bf16 v[108:111], v[140:143], a[60:63], v[108:111]
    s_waitcnt lgkmcnt(0)
    s_barrier
    v_mfma_f32_16x16x32_bf16 v[16:19], v[144:147], a[32:35], v[16:19]
    ds_read_b64_tr_b16 v[128:129], v216 offset:32768
    v_mfma_f32_16x16x32_bf16 v[16:19], v[148:151], a[48:51], v[16:19]
    ds_read_b64_tr_b16 v[130:131], v216 offset:34816
    v_mfma_f32_16x16x32_bf16 v[20:23], v[144:147], a[36:39], v[20:23]
    ds_read_b64_tr_b16 v[132:133], v216 offset:40960
    v_mfma_f32_16x16x32_bf16 v[20:23], v[148:151], a[52:55], v[20:23]
    ds_read_b64_tr_b16 v[134:135], v216 offset:43008
    v_mfma_f32_16x16x32_bf16 v[112:115], v[144:147], a[40:43], v[112:115]
    ds_read_b64_tr_b16 v[136:137], v217 offset:32768
    v_mfma_f32_16x16x32_bf16 v[112:115], v[148:151], a[56:59], v[112:115]
    ds_read_b64_tr_b16 v[138:139], v217 offset:34816
    v_mfma_f32_16x16x32_bf16 v[116:119], v[144:147], a[44:47], v[116:119]
    ds_read_b64_tr_b16 v[140:141], v217 offset:40960
    v_mfma_f32_16x16x32_bf16 v[116:119], v[148:151], a[60:63], v[116:119]
    ds_read_b64_tr_b16 v[142:143], v217 offset:43008
    v_mfma_f32_16x16x32_bf16 v[24:27], v[152:155], a[32:35], v[24:27]
    buffer_load_dwordx4 a[24:27], v245, s[8:11], s35 offen offset:1024 sc1
    v_mfma_f32_16x16x32_bf16 v[24:27], v[156:159], a[48:51], v[24:27]
    v_mfma_f32_16x16x32_bf16 v[28:31], v[152:155], a[36:39], v[28:31]
    buffer_load_dwordx4 a[28:31], v246, s[8:11], s35 offen offset:1024 sc1
    v_mfma_f32_16x16x32_bf16 v[28:31], v[156:159], a[52:55], v[28:31]
    v_mfma_f32_16x16x32_bf16 v[120:123], v[152:155], a[40:43], v[120:123]
    v_mfma_f32_16x16x32_bf16 v[120:123], v[156:159], a[56:59], v[120:123]
    v_mfma_f32_16x16x32_bf16 v[124:127], v[152:155], a[44:47], v[124:127]
    v_mfma_f32_16x16x32_bf16 v[124:127], v[156:159], a[60:63], v[124:127]
    s_waitcnt vmcnt(24) lgkmcnt(0)
    v_mfma_f32_16x16x32_bf16 v[32:35], v[128:131], a[64:67], v[32:35]
    ds_read_b64_tr_b16 v[144:145], v218 offset:32768
    v_mfma_f32_16x16x32_bf16 v[32:35], v[132:135], a[80:83], v[32:35]
    ds_read_b64_tr_b16 v[146:147], v218 offset:34816
    v_mfma_f32_16x16x32_bf16 v[36:39], v[128:131], a[68:71], v[36:39]
    ds_read_b64_tr_b16 v[148:149], v218 offset:40960
    v_mfma_f32_16x16x32_bf16 v[36:39], v[132:135], a[84:87], v[36:39]
    ds_read_b64_tr_b16 v[150:151], v218 offset:43008
    v_mfma_f32_16x16x32_bf16 v[64:67], v[128:131], a[72:75], v[64:67]
    ds_read_b64_tr_b16 v[152:153], v219 offset:32768
    v_mfma_f32_16x16x32_bf16 v[64:67], v[132:135], a[88:91], v[64:67]
    ds_read_b64_tr_b16 v[154:155], v219 offset:34816
    v_mfma_f32_16x16x32_bf16 v[68:71], v[128:131], a[76:79], v[68:71]
    ds_read_b64_tr_b16 v[156:157], v219 offset:40960
    v_mfma_f32_16x16x32_bf16 v[68:71], v[132:135], a[92:95], v[68:71]
    ds_read_b64_tr_b16 v[158:159], v219 offset:43008
    v_mfma_f32_16x16x32_bf16 v[40:43], v[136:139], a[64:67], v[40:43]
    buffer_load_dwordx4 a[32:35], v226, s[8:11], s35 offen offset:2048 sc1
    v_mfma_f32_16x16x32_bf16 v[40:43], v[140:143], a[80:83], v[40:43]
    s_add_u32 m0, s38, 65536
    s_add_u32 s32, s37, 1572864
    v_mfma_f32_16x16x32_bf16 v[44:47], v[136:139], a[68:71], v[44:47]
    buffer_load_dwordx4 v224, s[12:15], s32 offen lds
    v_mfma_f32_16x16x32_bf16 v[44:47], v[140:143], a[84:87], v[44:47]
    buffer_load_dwordx4 a[36:39], v227, s[8:11], s35 offen offset:2048 sc1
    v_mfma_f32_16x16x32_bf16 v[72:75], v[136:139], a[72:75], v[72:75]
    v_mfma_f32_16x16x32_bf16 v[72:75], v[140:143], a[88:91], v[72:75]
    buffer_load_dwordx4 v225, s[12:15], s32 offen offset:1024 lds
    v_mfma_f32_16x16x32_bf16 v[76:79], v[136:139], a[76:79], v[76:79]
    s_add_u32 s33, s55, 0
    buffer_load_dwordx4 a[128:131], v228, s[8:11], s33 offen offset:0 sc1
    v_mfma_f32_16x16x32_bf16 v[76:79], v[140:143], a[92:95], v[76:79]
    buffer_load_dwordx4 a[40:43], v245, s[8:11], s35 offen offset:2048 sc1
    s_waitcnt lgkmcnt(0)
    v_mfma_f32_16x16x32_bf16 v[48:51], v[144:147], a[64:67], v[48:51]
    ds_read_b64_tr_b16 v[128:129], v220 offset:32768
    v_mfma_f32_16x16x32_bf16 v[48:51], v[148:151], a[80:83], v[48:51]
    ds_read_b64_tr_b16 v[130:131], v220 offset:34816
    v_mfma_f32_16x16x32_bf16 v[52:55], v[144:147], a[68:71], v[52:55]
    ds_read_b64_tr_b16 v[132:133], v220 offset:40960
    v_mfma_f32_16x16x32_bf16 v[52:55], v[148:151], a[84:87], v[52:55]
    ds_read_b64_tr_b16 v[134:135], v220 offset:43008
    v_mfma_f32_16x16x32_bf16 v[80:83], v[144:147], a[72:75], v[80:83]
    ds_read_b64_tr_b16 v[136:137], v221 offset:32768
    v_mfma_f32_16x16x32_bf16 v[80:83], v[148:151], a[88:91], v[80:83]
    ds_read_b64_tr_b16 v[138:139], v221 offset:34816
    v_mfma_f32_16x16x32_bf16 v[84:87], v[144:147], a[76:79], v[84:87]
    ds_read_b64_tr_b16 v[140:141], v221 offset:40960
    v_mfma_f32_16x16x32_bf16 v[84:87], v[148:151], a[92:95], v[84:87]
    ds_read_b64_tr_b16 v[142:143], v221 offset:43008
    v_mfma_f32_16x16x32_bf16 v[56:59], v[152:155], a[64:67], v[56:59]
    buffer_load_dwordx4 a[44:47], v246, s[8:11], s35 offen offset:2048 sc1
    v_mfma_f32_16x16x32_bf16 v[56:59], v[156:159], a[80:83], v[56:59]
    v_mfma_f32_16x16x32_bf16 v[60:63], v[152:155], a[68:71], v[60:63]
    v_mfma_f32_16x16x32_bf16 v[60:63], v[156:159], a[84:87], v[60:63]
    v_mfma_f32_16x16x32_bf16 v[88:91], v[152:155], a[72:75], v[88:91]
    buffer_load_dwordx4 a[48:51], v226, s[8:11], s35 offen offset:3072 sc1
    v_mfma_f32_16x16x32_bf16 v[88:91], v[156:159], a[88:91], v[88:91]
    v_mfma_f32_16x16x32_bf16 v[92:95], v[152:155], a[76:79], v[92:95]
    buffer_load_dwordx4 a[132:135], v228, s[8:11], s33 offen offset:1024 sc1
    v_mfma_f32_16x16x32_bf16 v[92:95], v[156:159], a[92:95], v[92:95]
    s_waitcnt lgkmcnt(0)
    v_mfma_f32_16x16x32_bf16 v[0:3], v[128:131], a[64:67], v[0:3]
    ds_read_b64_tr_b16 v[144:145], v222 offset:32768
    v_mfma_f32_16x16x32_bf16 v[0:3], v[132:135], a[80:83], v[0:3]
    ds_read_b64_tr_b16 v[146:147], v222 offset:34816
    v_mfma_f32_16x16x32_bf16 v[4:7], v[128:131], a[68:71], v[4:7]
    ds_read_b64_tr_b16 v[148:149], v222 offset:40960
    v_mfma_f32_16x16x32_bf16 v[4:7], v[132:135], a[84:87], v[4:7]
    ds_read_b64_tr_b16 v[150:151], v222 offset:43008
    v_mfma_f32_16x16x32_bf16 v[96:99], v[128:131], a[72:75], v[96:99]
    ds_read_b64_tr_b16 v[152:153], v223 offset:32768
    v_mfma_f32_16x16x32_bf16 v[96:99], v[132:135], a[88:91], v[96:99]
    ds_read_b64_tr_b16 v[154:155], v223 offset:34816
    v_mfma_f32_16x16x32_bf16 v[100:103], v[128:131], a[76:79], v[100:103]
    ds_read_b64_tr_b16 v[156:157], v223 offset:40960
    v_mfma_f32_16x16x32_bf16 v[100:103], v[132:135], a[92:95], v[100:103]
    ds_read_b64_tr_b16 v[158:159], v223 offset:43008
    v_mfma_f32_16x16x32_bf16 v[8:11], v[136:139], a[64:67], v[8:11]
    buffer_load_dwordx4 a[52:55], v227, s[8:11], s35 offen offset:3072 sc1
    v_mfma_f32_16x16x32_bf16 v[8:11], v[140:143], a[80:83], v[8:11]
    s_add_u32 m0, s38, 73728
    s_add_u32 s32, s37, 1638400
    v_mfma_f32_16x16x32_bf16 v[12:15], v[136:139], a[68:71], v[12:15]
    buffer_load_dwordx4 v224, s[12:15], s32 offen lds
    v_mfma_f32_16x16x32_bf16 v[12:15], v[140:143], a[84:87], v[12:15]
    buffer_load_dwordx4 a[56:59], v245, s[8:11], s35 offen offset:3072 sc1
    v_mfma_f32_16x16x32_bf16 v[104:107], v[136:139], a[72:75], v[104:107]
    v_mfma_f32_16x16x32_bf16 v[104:107], v[140:143], a[88:91], v[104:107]
    buffer_load_dwordx4 v225, s[12:15], s32 offen offset:1024 lds
    v_mfma_f32_16x16x32_bf16 v[108:111], v[136:139], a[76:79], v[108:111]
    buffer_load_dwordx4 a[136:139], v228, s[8:11], s33 offen offset:2048 sc1
    v_mfma_f32_16x16x32_bf16 v[108:111], v[140:143], a[92:95], v[108:111]
    s_waitcnt lgkmcnt(0)
    v_mfma_f32_16x16x32_bf16 v[16:19], v[144:147], a[64:67], v[16:19]
    ds_read_b64_tr_b16 v[128:129], v216 offset:49152
    v_mfma_f32_16x16x32_bf16 v[16:19], v[148:151], a[80:83], v[16:19]
    ds_read_b64_tr_b16 v[130:131], v216 offset:51200
    v_mfma_f32_16x16x32_bf16 v[20:23], v[144:147], a[68:71], v[20:23]
    ds_read_b64_tr_b16 v[132:133], v216 offset:57344
    v_mfma_f32_16x16x32_bf16 v[20:23], v[148:151], a[84:87], v[20:23]
    ds_read_b64_tr_b16 v[134:135], v216 offset:59392
    v_mfma_f32_16x16x32_bf16 v[112:115], v[144:147], a[72:75], v[112:115]
    ds_read_b64_tr_b16 v[136:137], v217 offset:49152
    v_mfma_f32_16x16x32_bf16 v[112:115], v[148:151], a[88:91], v[112:115]
    ds_read_b64_tr_b16 v[138:139], v217 offset:51200
    v_mfma_f32_16x16x32_bf16 v[116:119], v[144:147], a[76:79], v[116:119]
    ds_read_b64_tr_b16 v[140:141], v217 offset:57344
    v_mfma_f32_16x16x32_bf16 v[116:119], v[148:151], a[92:95], v[116:119]
    ds_read_b64_tr_b16 v[142:143], v217 offset:59392
    v_mfma_f32_16x16x32_bf16 v[24:27], v[152:155], a[64:67], v[24:27]
    buffer_load_dwordx4 a[60:63], v246, s[8:11], s35 offen offset:3072 sc1
    v_mfma_f32_16x16x32_bf16 v[24:27], v[156:159], a[80:83], v[24:27]
    v_mfma_f32_16x16x32_bf16 v[28:31], v[152:155], a[68:71], v[28:31]
    v_mfma_f32_16x16x32_bf16 v[28:31], v[156:159], a[84:87], v[28:31]
    v_mfma_f32_16x16x32_bf16 v[120:123], v[152:155], a[72:75], v[120:123]
    v_mfma_f32_16x16x32_bf16 v[120:123], v[156:159], a[88:91], v[120:123]
    v_mfma_f32_16x16x32_bf16 v[124:127], v[152:155], a[76:79], v[124:127]
    buffer_load_dwordx4 a[140:143], v228, s[8:11], s33 offen offset:3072 sc1
    v_mfma_f32_16x16x32_bf16 v[124:127], v[156:159], a[92:95], v[124:127]
    s_add_u32 s35, s35, 4096
    buffer_load_dwordx4 a[64:67], v226, s[8:11], s35 offen offset:0 sc1
    s_waitcnt vmcnt(29) lgkmcnt(0)
    v_mfma_f32_16x16x32_bf16 v[32:35], v[128:131], a[96:99], v[32:35]
    ds_read_b64_tr_b16 v[144:145], v218 offset:49152
    v_mfma_f32_16x16x32_bf16 v[32:35], v[132:135], a[112:115], v[32:35]
    ds_read_b64_tr_b16 v[146:147], v218 offset:51200
    v_mfma_f32_16x16x32_bf16 v[36:39], v[128:131], a[100:103], v[36:39]
    ds_read_b64_tr_b16 v[148:149], v218 offset:57344
    v_mfma_f32_16x16x32_bf16 v[36:39], v[132:135], a[116:119], v[36:39]
    ds_read_b64_tr_b16 v[150:151], v218 offset:59392
    v_mfma_f32_16x16x32_bf16 v[64:67], v[128:131], a[104:107], v[64:67]
    ds_read_b64_tr_b16 v[152:153], v219 offset:49152
    v_mfma_f32_16x16x32_bf16 v[64:67], v[132:135], a[120:123], v[64:67]
    ds_read_b64_tr_b16 v[154:155], v219 offset:51200
    v_mfma_f32_16x16x32_bf16 v[68:71], v[128:131], a[108:111], v[68:71]
    ds_read_b64_tr_b16 v[156:157], v219 offset:57344
    v_mfma_f32_16x16x32_bf16 v[68:71], v[132:135], a[124:127], v[68:71]
    ds_read_b64_tr_b16 v[158:159], v219 offset:59392
    v_mfma_f32_16x16x32_bf16 v[40:43], v[136:139], a[96:99], v[40:43]
    buffer_load_dwordx4 a[68:71], v227, s[8:11], s35 offen offset:0 sc1
    v_mfma_f32_16x16x32_bf16 v[40:43], v[140:143], a[112:115], v[40:43]
    s_add_u32 m0, s38, 81920
    s_add_u32 s32, s37, 1703936
    v_mfma_f32_16x16x32_bf16 v[44:47], v[136:139], a[100:103], v[44:47]
    buffer_load_dwordx4 v224, s[12:15], s32 offen lds
    v_mfma_f32_16x16x32_bf16 v[44:47], v[140:143], a[116:119], v[44:47]
    buffer_load_dwordx4 a[72:75], v245, s[8:11], s35 offen offset:0 sc1
    v_mfma_f32_16x16x32_bf16 v[72:75], v[136:139], a[104:107], v[72:75]
    v_mfma_f32_16x16x32_bf16 v[72:75], v[140:143], a[120:123], v[72:75]
    buffer_load_dwordx4 v225, s[12:15], s32 offen offset:1024 lds
    v_mfma_f32_16x16x32_bf16 v[76:79], v[136:139], a[108:111], v[76:79]
    s_add_u32 s33, s55, 4096
    buffer_load_dwordx4 a[144:147], v228, s[8:11], s33 offen offset:0 sc1
    v_mfma_f32_16x16x32_bf16 v[76:79], v[140:143], a[124:127], v[76:79]
    buffer_load_dwordx4 a[76:79], v246, s[8:11], s35 offen offset:0 sc1
    s_waitcnt lgkmcnt(0)
    v_mfma_f32_16x16x32_bf16 v[48:51], v[144:147], a[96:99], v[48:51]
    ds_read_b64_tr_b16 v[128:129], v220 offset:49152
    v_mfma_f32_16x16x32_bf16 v[48:51], v[148:151], a[112:115], v[48:51]
    ds_read_b64_tr_b16 v[130:131], v220 offset:51200
    v_mfma_f32_16x16x32_bf16 v[52:55], v[144:147], a[100:103], v[52:55]
    ds_read_b64_tr_b16 v[132:133], v220 offset:57344
    v_mfma_f32_16x16x32_bf16 v[52:55], v[148:151], a[116:119], v[52:55]
    ds_read_b64_tr_b16 v[134:135], v220 offset:59392
    v_mfma_f32_16x16x32_bf16 v[80:83], v[144:147], a[104:107], v[80:83]
    ds_read_b64_tr_b16 v[136:137], v221 offset:49152
    v_mfma_f32_16x16x32_bf16 v[80:83], v[148:151], a[120:123], v[80:83]
    ds_read_b64_tr_b16 v[138:139], v221 offset:51200
    v_mfma_f32_16x16x32_bf16 v[84:87], v[144:147], a[108:111], v[84:87]
    ds_read_b64_tr_b16 v[140:141], v221 offset:57344
    v_mfma_f32_16x16x32_bf16 v[84:87], v[148:151], a[124:127], v[84:87]
    ds_read_b64_tr_b16 v[142:143], v221 offset:59392
    v_mfma_f32_16x16x32_bf16 v[56:59], v[152:155], a[96:99], v[56:59]
    buffer_load_dwordx4 a[80:83], v226, s[8:11], s35 offen offset:1024 sc1
    v_mfma_f32_16x16x32_bf16 v[56:59], v[156:159], a[112:115], v[56:59]
    v_mfma_f32_16x16x32_bf16 v[60:63], v[152:155], a[100:103], v[60:63]
    buffer_load_dwordx4 a[84:87], v227, s[8:11], s35 offen offset:1024 sc1
    v_mfma_f32_16x16x32_bf16 v[60:63], v[156:159], a[116:119], v[60:63]
    v_mfma_f32_16x16x32_bf16 v[88:91], v[152:155], a[104:107], v[88:91]
    v_mfma_f32_16x16x32_bf16 v[88:91], v[156:159], a[120:123], v[88:91]
    v_mfma_f32_16x16x32_bf16 v[92:95], v[152:155], a[108:111], v[92:95]
    buffer_load_dwordx4 a[148:151], v228, s[8:11], s33 offen offset:1024 sc1
    v_mfma_f32_16x16x32_bf16 v[92:95], v[156:159], a[124:127], v[92:95]
    s_waitcnt lgkmcnt(0)
    v_mfma_f32_16x16x32_bf16 v[0:3], v[128:131], a[96:99], v[0:3]
    ds_read_b64_tr_b16 v[144:145], v222 offset:49152
    v_mfma_f32_16x16x32_bf16 v[0:3], v[132:135], a[112:115], v[0:3]
    ds_read_b64_tr_b16 v[146:147], v222 offset:51200
    v_mfma_f32_16x16x32_bf16 v[4:7], v[128:131], a[100:103], v[4:7]
    ds_read_b64_tr_b16 v[148:149], v222 offset:57344
    v_mfma_f32_16x16x32_bf16 v[4:7], v[132:135], a[116:119], v[4:7]
    ds_read_b64_tr_b16 v[150:151], v222 offset:59392
    v_mfma_f32_16x16x32_bf16 v[96:99], v[128:131], a[104:107], v[96:99]
    ds_read_b64_tr_b16 v[152:153], v223 offset:49152
    v_mfma_f32_16x16x32_bf16 v[96:99], v[132:135], a[120:123], v[96:99]
    ds_read_b64_tr_b16 v[154:155], v223 offset:51200
    v_mfma_f32_16x16x32_bf16 v[100:103], v[128:131], a[108:111], v[100:103]
    ds_read_b64_tr_b16 v[156:157], v223 offset:57344
    v_mfma_f32_16x16x32_bf16 v[100:103], v[132:135], a[124:127], v[100:103]
    ds_read_b64_tr_b16 v[158:159], v223 offset:59392
    v_mfma_f32_16x16x32_bf16 v[8:11], v[136:139], a[96:99], v[8:11]
    buffer_load_dwordx4 a[88:91], v245, s[8:11], s35 offen offset:1024 sc1
    v_mfma_f32_16x16x32_bf16 v[8:11], v[140:143], a[112:115], v[8:11]
    s_add_u32 m0, s38, 90112
    s_add_u32 s32, s37, 1769472
    v_mfma_f32_16x16x32_bf16 v[12:15], v[136:139], a[100:103], v[12:15]
    buffer_load_dwordx4 v224, s[12:15], s32 offen lds
    v_mfma_f32_16x16x32_bf16 v[12:15], v[140:143], a[116:119], v[12:15]
    buffer_load_dwordx4 a[92:95], v246, s[8:11], s35 offen offset:1024 sc1
    v_mfma_f32_16x16x32_bf16 v[104:107], v[136:139], a[104:107], v[104:107]
    v_mfma_f32_16x16x32_bf16 v[104:107], v[140:143], a[120:123], v[104:107]
    buffer_load_dwordx4 v225, s[12:15], s32 offen offset:1024 lds
    v_mfma_f32_16x16x32_bf16 v[108:111], v[136:139], a[108:111], v[108:111]
    buffer_load_dwordx4 a[152:155], v228, s[8:11], s33 offen offset:2048 sc1
    v_mfma_f32_16x16x32_bf16 v[108:111], v[140:143], a[124:127], v[108:111]
    s_waitcnt vmcnt(61) lgkmcnt(0)
    s_barrier
    v_mfma_f32_16x16x32_bf16 v[16:19], v[144:147], a[96:99], v[16:19]
    v_xor_b32 v216, 0x10000, v216
    ds_read_b64_tr_b16 v[128:129], v216 offset:0
    v_mfma_f32_16x16x32_bf16 v[16:19], v[148:151], a[112:115], v[16:19]
    ds_read_b64_tr_b16 v[130:131], v216 offset:2048
    v_mfma_f32_16x16x32_bf16 v[20:23], v[144:147], a[100:103], v[20:23]
    ds_read_b64_tr_b16 v[132:133], v216 offset:8192
    v_mfma_f32_16x16x32_bf16 v[20:23], v[148:151], a[116:119], v[20:23]
    ds_read_b64_tr_b16 v[134:135], v216 offset:10240
    v_mfma_f32_16x16x32_bf16 v[112:115], v[144:147], a[104:107], v[112:115]
    v_xor_b32 v217, 0x10000, v217
    ds_read_b64_tr_b16 v[136:137], v217 offset:0
    v_mfma_f32_16x16x32_bf16 v[112:115], v[148:151], a[120:123], v[112:115]
    ds_read_b64_tr_b16 v[138:139], v217 offset:2048
    v_mfma_f32_16x16x32_bf16 v[116:119], v[144:147], a[108:111], v[116:119]
    ds_read_b64_tr_b16 v[140:141], v217 offset:8192
    v_mfma_f32_16x16x32_bf16 v[116:119], v[148:151], a[124:127], v[116:119]
    ds_read_b64_tr_b16 v[142:143], v217 offset:10240
    v_mfma_f32_16x16x32_bf16 v[24:27], v[152:155], a[96:99], v[24:27]
    v_mfma_f32_16x16x32_bf16 v[24:27], v[156:159], a[112:115], v[24:27]
    v_mfma_f32_16x16x32_bf16 v[28:31], v[152:155], a[100:103], v[28:31]
    v_mfma_f32_16x16x32_bf16 v[28:31], v[156:159], a[116:119], v[28:31]
    v_mfma_f32_16x16x32_bf16 v[120:123], v[152:155], a[104:107], v[120:123]
    v_mfma_f32_16x16x32_bf16 v[120:123], v[156:159], a[120:123], v[120:123]
    v_mfma_f32_16x16x32_bf16 v[124:127], v[152:155], a[108:111], v[124:127]
    buffer_load_dwordx4 a[156:159], v228, s[8:11], s33 offen offset:3072 sc1
    v_mfma_f32_16x16x32_bf16 v[124:127], v[156:159], a[124:127], v[124:127]
    buffer_load_dwordx4 a[96:99], v226, s[8:11], s35 offen offset:2048 sc1
    s_waitcnt vmcnt(33) lgkmcnt(0)
    v_mfma_f32_16x16x32_bf16 v[32:35], v[128:131], a[0:3], v[32:35]
    v_xor_b32 v218, 0x10000, v218
    ds_read_b64_tr_b16 v[144:145], v218 offset:0
    v_mfma_f32_16x16x32_bf16 v[32:35], v[132:135], a[16:19], v[32:35]
    ds_read_b64_tr_b16 v[146:147], v218 offset:2048
    v_mfma_f32_16x16x32_bf16 v[36:39], v[128:131], a[4:7], v[36:39]
    ds_read_b64_tr_b16 v[148:149], v218 offset:8192
    v_mfma_f32_16x16x32_bf16 v[36:39], v[132:135], a[20:23], v[36:39]
    ds_read_b64_tr_b16 v[150:151], v218 offset:10240
    v_mfma_f32_16x16x32_bf16 v[64:67], v[128:131], a[8:11], v[64:67]
    v_xor_b32 v219, 0x10000, v219
    ds_read_b64_tr_b16 v[152:153], v219 offset:0
    v_mfma_f32_16x16x32_bf16 v[64:67], v[132:135], a[24:27], v[64:67]
    ds_read_b64_tr_b16 v[154:155], v219 offset:2048
    v_mfma_f32_16x16x32_bf16 v[68:71], v[128:131], a[12:15], v[68:71]
    ds_read_b64_tr_b16 v[156:157], v219 offset:8192
    v_mfma_f32_16x16x32_bf16 v[68:71], v[132:135], a[28:31], v[68:71]
    ds_read_b64_tr_b16 v[158:159], v219 offset:10240
    v_mfma_f32_16x16x32_bf16 v[40:43], v[136:139], a[0:3], v[40:43]
    buffer_load_dwordx4 a[100:103], v227, s[8:11], s35 offen offset:2048 sc1
    v_mfma_f32_16x16x32_bf16 v[40:43], v[140:143], a[16:19], v[40:43]
    s_add_u32 m0, s38, 98304
    s_add_u32 s32, s37, 1835008
    v_mfma_f32_16x16x32_bf16 v[44:47], v[136:139], a[4:7], v[44:47]
    buffer_load_dwordx4 v224, s[12:15], s32 offen lds
    v_mfma_f32_16x16x32_bf16 v[44:47], v[140:143], a[20:23], v[44:47]
    buffer_load_dwordx4 a[104:107], v245, s[8:11], s35 offen offset:2048 sc1
    v_mfma_f32_16x16x32_bf16 v[72:75], v[136:139], a[8:11], v[72:75]
    v_mfma_f32_16x16x32_bf16 v[72:75], v[140:143], a[24:27], v[72:75]
    buffer_load_dwordx4 v225, s[12:15], s32 offen offset:1024 lds
    v_mfma_f32_16x16x32_bf16 v[76:79], v[136:139], a[12:15], v[76:79]
    s_add_u32 s33, s55, 32768
    buffer_load_dwordx4 a[160:163], v228, s[8:11], s33 offen offset:0 sc1
    v_mfma_f32_16x16x32_bf16 v[76:79], v[140:143], a[28:31], v[76:79]
    buffer_load_dwordx4 a[108:111], v246, s[8:11], s35 offen offset:2048 sc1
    s_waitcnt lgkmcnt(0)
    v_mfma_f32_16x16x32_bf16 v[48:51], v[144:147], a[0:3], v[48:51]
    v_xor_b32 v220, 0x10000, v220
    ds_read_b64_tr_b16 v[128:129], v220 offset:0
    v_mfma_f32_16x16x32_bf16 v[48:51], v[148:151], a[16:19], v[48:51]
    ds_read_b64_tr_b16 v[130:131], v220 offset:2048
    v_mfma_f32_16x16x32_bf16 v[52:55], v[144:147], a[4:7], v[52:55]
    ds_read_b64_tr_b16 v[132:133], v220 offset:8192
    v_mfma_f32_16x16x32_bf16 v[52:55], v[148:151], a[20:23], v[52:55]
    ds_read_b64_tr_b16 v[134:135], v220 offset:10240
    v_mfma_f32_16x16x32_bf16 v[80:83], v[144:147], a[8:11], v[80:83]
    v_xor_b32 v221, 0x10000, v221
    ds_read_b64_tr_b16 v[136:137], v221 offset:0
    v_mfma_f32_16x16x32_bf16 v[80:83], v[148:151], a[24:27], v[80:83]
    ds_read_b64_tr_b16 v[138:139], v221 offset:2048
    v_mfma_f32_16x16x32_bf16 v[84:87], v[144:147], a[12:15], v[84:87]
    ds_read_b64_tr_b16 v[140:141], v221 offset:8192
    v_mfma_f32_16x16x32_bf16 v[84:87], v[148:151], a[28:31], v[84:87]
    ds_read_b64_tr_b16 v[142:143], v221 offset:10240
    v_mfma_f32_16x16x32_bf16 v[56:59], v[152:155], a[0:3], v[56:59]
    buffer_load_dwordx4 a[112:115], v226, s[8:11], s35 offen offset:3072 sc1
    v_mfma_f32_16x16x32_bf16 v[56:59], v[156:159], a[16:19], v[56:59]
    v_mfma_f32_16x16x32_bf16 v[60:63], v[152:155], a[4:7], v[60:63]
    buffer_load_dwordx4 a[116:119], v227, s[8:11], s35 offen offset:3072 sc1
    v_mfma_f32_16x16x32_bf16 v[60:63], v[156:159], a[20:23], v[60:63]
    v_mfma_f32_16x16x32_bf16 v[88:91], v[152:155], a[8:11], v[88:91]
    buffer_load_dwordx4 a[120:123], v245, s[8:11], s35 offen offset:3072 sc1
    v_mfma_f32_16x16x32_bf16 v[88:91], v[156:159], a[24:27], v[88:91]
    v_mfma_f32_16x16x32_bf16 v[92:95], v[152:155], a[12:15], v[92:95]
    buffer_load_dwordx4 a[164:167], v228, s[8:11], s33 offen offset:1024 sc1
    v_mfma_f32_16x16x32_bf16 v[92:95], v[156:159], a[28:31], v[92:95]
    buffer_load_dwordx4 a[124:127], v246, s[8:11], s35 offen offset:3072 sc1
    s_waitcnt lgkmcnt(0)
    v_mfma_f32_16x16x32_bf16 v[0:3], v[128:131], a[0:3], v[0:3]
    v_xor_b32 v222, 0x10000, v222
    ds_read_b64_tr_b16 v[144:145], v222 offset:0
    v_mfma_f32_16x16x32_bf16 v[0:3], v[132:135], a[16:19], v[0:3]
    ds_read_b64_tr_b16 v[146:147], v222 offset:2048
    v_mfma_f32_16x16x32_bf16 v[4:7], v[128:131], a[4:7], v[4:7]
    ds_read_b64_tr_b16 v[148:149], v222 offset:8192
    v_mfma_f32_16x16x32_bf16 v[4:7], v[132:135], a[20:23], v[4:7]
    ds_read_b64_tr_b16 v[150:151], v222 offset:10240
    v_mfma_f32_16x16x32_bf16 v[96:99], v[128:131], a[8:11], v[96:99]
    v_xor_b32 v223, 0x10000, v223
    ds_read_b64_tr_b16 v[152:153], v223 offset:0
    v_mfma_f32_16x16x32_bf16 v[96:99], v[132:135], a[24:27], v[96:99]
    ds_read_b64_tr_b16 v[154:155], v223 offset:2048
    v_mfma_f32_16x16x32_bf16 v[100:103], v[128:131], a[12:15], v[100:103]
    ds_read_b64_tr_b16 v[156:157], v223 offset:8192
    v_mfma_f32_16x16x32_bf16 v[100:103], v[132:135], a[28:31], v[100:103]
    ds_read_b64_tr_b16 v[158:159], v223 offset:10240
    v_mfma_f32_16x16x32_bf16 v[8:11], v[136:139], a[0:3], v[8:11]
    v_mfma_f32_16x16x32_bf16 v[8:11], v[140:143], a[16:19], v[8:11]
    s_add_u32 m0, s38, 106496
    s_add_u32 s32, s37, 1900544
    v_mfma_f32_16x16x32_bf16 v[12:15], v[136:139], a[4:7], v[12:15]
    buffer_load_dwordx4 v224, s[12:15], s32 offen lds
    v_mfma_f32_16x16x32_bf16 v[12:15], v[140:143], a[20:23], v[12:15]
    v_mfma_f32_16x16x32_bf16 v[104:107], v[136:139], a[8:11], v[104:107]
    v_mfma_f32_16x16x32_bf16 v[104:107], v[140:143], a[24:27], v[104:107]
    buffer_load_dwordx4 v225, s[12:15], s32 offen offset:1024 lds
    v_mfma_f32_16x16x32_bf16 v[108:111], v[136:139], a[12:15], v[108:111]
    buffer_load_dwordx4 a[168:171], v228, s[8:11], s33 offen offset:2048 sc1
    v_mfma_f32_16x16x32_bf16 v[108:111], v[140:143], a[28:31], v[108:111]
    s_waitcnt lgkmcnt(0)
    v_mfma_f32_16x16x32_bf16 v[16:19], v[144:147], a[0:3], v[16:19]
    ds_read_b64_tr_b16 v[128:129], v216 offset:16384
    v_mfma_f32_16x16x32_bf16 v[16:19], v[148:151], a[16:19], v[16:19]
    ds_read_b64_tr_b16 v[130:131], v216 offset:18432
    v_mfma_f32_16x16x32_bf16 v[20:23], v[144:147], a[4:7], v[20:23]
    ds_read_b64_tr_b16 v[132:133], v216 offset:24576
    v_mfma_f32_16x16x32_bf16 v[20:23], v[148:151], a[20:23], v[20:23]
    ds_read_b64_tr_b16 v[134:135], v216 offset:26624
    v_mfma_f32_16x16x32_bf16 v[112:115], v[144:147], a[8:11], v[112:115]
    ds_read_b64_tr_b16 v[136:137], v217 offset:16384
    v_mfma_f32_16x16x32_bf16 v[112:115], v[148:151], a[24:27], v[112:115]
    ds_read_b64_tr_b16 v[138:139], v217 offset:18432
    v_mfma_f32_16x16x32_bf16 v[116:119], v[144:147], a[12:15], v[116:119]
    ds_read_b64_tr_b16 v[140:141], v217 offset:24576
    v_mfma_f32_16x16x32_bf16 v[116:119], v[148:151], a[28:31], v[116:119]
    ds_read_b64_tr_b16 v[142:143], v217 offset:26624
    v_mfma_f32_16x16x32_bf16 v[24:27], v[152:155], a[0:3], v[24:27]
    v_mfma_f32_16x16x32_bf16 v[24:27], v[156:159], a[16:19], v[24:27]
    v_mfma_f32_16x16x32_bf16 v[28:31], v[152:155], a[4:7], v[28:31]
    v_mfma_f32_16x16x32_bf16 v[28:31], v[156:159], a[20:23], v[28:31]
    v_mfma_f32_16x16x32_bf16 v[120:123], v[152:155], a[8:11], v[120:123]
    v_mfma_f32_16x16x32_bf16 v[120:123], v[156:159], a[24:27], v[120:123]
    v_mfma_f32_16x16x32_bf16 v[124:127], v[152:155], a[12:15], v[124:127]
    buffer_load_dwordx4 a[172:175], v228, s[8:11], s33 offen offset:3072 sc1
    v_mfma_f32_16x16x32_bf16 v[124:127], v[156:159], a[28:31], v[124:127]
    s_add_u32 s35, s35, 4096
    buffer_load_dwordx4 a[0:3], v226, s[8:11], s35 offen offset:0 sc1
    s_waitcnt vmcnt(34) lgkmcnt(0)
    v_mfma_f32_16x16x32_bf16 v[32:35], v[128:131], a[32:35], v[32:35]
    ds_read_b64_tr_b16 v[144:145], v218 offset:16384
    v_mfma_f32_16x16x32_bf16 v[32:35], v[132:135], a[48:51], v[32:35]
    ds_read_b64_tr_b16 v[146:147], v218 offset:18432
    v_mfma_f32_16x16x32_bf16 v[36:39], v[128:131], a[36:39], v[36:39]
    ds_read_b64_tr_b16 v[148:149], v218 offset:24576
    v_mfma_f32_16x16x32_bf16 v[36:39], v[132:135], a[52:55], v[36:39]
    ds_read_b64_tr_b16 v[150:151], v218 offset:26624
    v_mfma_f32_16x16x32_bf16 v[64:67], v[128:131], a[40:43], v[64:67]
    ds_read_b64_tr_b16 v[152:153], v219 offset:16384
    v_mfma_f32_16x16x32_bf16 v[64:67], v[132:135], a[56:59], v[64:67]
    ds_read_b64_tr_b16 v[154:155], v219 offset:18432
    v_mfma_f32_16x16x32_bf16 v[68:71], v[128:131], a[44:47], v[68:71]
    ds_read_b64_tr_b16 v[156:157], v219 offset:24576
    v_mfma_f32_16x16x32_bf16 v[68:71], v[132:135], a[60:63], v[68:71]
    ds_read_b64_tr_b16 v[158:159], v219 offset:26624
    v_mfma_f32_16x16x32_bf16 v[40:43], v[136:139], a[32:35], v[40:43]
    buffer_load_dwordx4 a[4:7], v227, s[8:11], s35 offen offset:0 sc1
    v_mfma_f32_16x16x32_bf16 v[40:43], v[140:143], a[48:51], v[40:43]
    s_add_u32 m0, s38, 114688
    s_add_u32 s32, s37, 1966080
    v_mfma_f32_16x16x32_bf16 v[44:47], v[136:139], a[36:39], v[44:47]
    buffer_load_dwordx4 v224, s[12:15], s32 offen lds
    v_mfma_f32_16x16x32_bf16 v[44:47], v[140:143], a[52:55], v[44:47]
    buffer_load_dwordx4 a[8:11], v245, s[8:11], s35 offen offset:0 sc1
    v_mfma_f32_16x16x32_bf16 v[72:75], v[136:139], a[40:43], v[72:75]
    v_mfma_f32_16x16x32_bf16 v[72:75], v[140:143], a[56:59], v[72:75]
    buffer_load_dwordx4 v225, s[12:15], s32 offen offset:1024 lds
    v_mfma_f32_16x16x32_bf16 v[76:79], v[136:139], a[44:47], v[76:79]
    s_add_u32 s33, s55, 36864
    buffer_load_dwordx4 a[176:179], v228, s[8:11], s33 offen offset:0 sc1
    v_mfma_f32_16x16x32_bf16 v[76:79], v[140:143], a[60:63], v[76:79]
    buffer_load_dwordx4 a[12:15], v246, s[8:11], s35 offen offset:0 sc1
    s_waitcnt lgkmcnt(0)
    v_mfma_f32_16x16x32_bf16 v[48:51], v[144:147], a[32:35], v[48:51]
    ds_read_b64_tr_b16 v[128:129], v220 offset:16384
    v_mfma_f32_16x16x32_bf16 v[48:51], v[148:151], a[48:51], v[48:51]
    ds_read_b64_tr_b16 v[130:131], v220 offset:18432
    v_mfma_f32_16x16x32_bf16 v[52:55], v[144:147], a[36:39], v[52:55]
    ds_read_b64_tr_b16 v[132:133], v220 offset:24576
    v_mfma_f32_16x16x32_bf16 v[52:55], v[148:151], a[52:55], v[52:55]
    ds_read_b64_tr_b16 v[134:135], v220 offset:26624
    v_mfma_f32_16x16x32_bf16 v[80:83], v[144:147], a[40:43], v[80:83]
    ds_read_b64_tr_b16 v[136:137], v221 offset:16384
    v_mfma_f32_16x16x32_bf16 v[80:83], v[148:151], a[56:59], v[80:83]
    ds_read_b64_tr_b16 v[138:139], v221 offset:18432
    v_mfma_f32_16x16x32_bf16 v[84:87], v[144:147], a[44:47], v[84:87]
    ds_read_b64_tr_b16 v[140:141], v221 offset:24576
    v_mfma_f32_16x16x32_bf16 v[84:87], v[148:151], a[60:63], v[84:87]
    ds_read_b64_tr_b16 v[142:143], v221 offset:26624
    v_mfma_f32_16x16x32_bf16 v[56:59], v[152:155], a[32:35], v[56:59]
    buffer_load_dwordx4 a[16:19], v226, s[8:11], s35 offen offset:1024 sc1
    v_mfma_f32_16x16x32_bf16 v[56:59], v[156:159], a[48:51], v[56:59]
    v_mfma_f32_16x16x32_bf16 v[60:63], v[152:155], a[36:39], v[60:63]
    buffer_load_dwordx4 a[20:23], v227, s[8:11], s35 offen offset:1024 sc1
    v_mfma_f32_16x16x32_bf16 v[60:63], v[156:159], a[52:55], v[60:63]
    v_mfma_f32_16x16x32_bf16 v[88:91], v[152:155], a[40:43], v[88:91]
    buffer_load_dwordx4 a[24:27], v245, s[8:11], s35 offen offset:1024 sc1
    v_mfma_f32_16x16x32_bf16 v[88:91], v[156:159], a[56:59], v[88:91]
    v_mfma_f32_16x16x32_bf16 v[92:95], v[152:155], a[44:47], v[92:95]
    buffer_load_dwordx4 a[180:183], v228, s[8:11], s33 offen offset:1024 sc1
    v_mfma_f32_16x16x32_bf16 v[92:95], v[156:159], a[60:63], v[92:95]
    buffer_load_dwordx4 a[28:31], v246, s[8:11], s35 offen offset:1024 sc1
    s_waitcnt lgkmcnt(0)
    v_mfma_f32_16x16x32_bf16 v[0:3], v[128:131], a[32:35], v[0:3]
    ds_read_b64_tr_b16 v[144:145], v222 offset:16384
    v_mfma_f32_16x16x32_bf16 v[0:3], v[132:135], a[48:51], v[0:3]
    ds_read_b64_tr_b16 v[146:147], v222 offset:18432
    v_mfma_f32_16x16x32_bf16 v[4:7], v[128:131], a[36:39], v[4:7]
    ds_read_b64_tr_b16 v[148:149], v222 offset:24576
    v_mfma_f32_16x16x32_bf16 v[4:7], v[132:135], a[52:55], v[4:7]
    ds_read_b64_tr_b16 v[150:151], v222 offset:26624
    v_mfma_f32_16x16x32_bf16 v[96:99], v[128:131], a[40:43], v[96:99]
    ds_read_b64_tr_b16 v[152:153], v223 offset:16384
    v_mfma_f32_16x16x32_bf16 v[96:99], v[132:135], a[56:59], v[96:99]
    ds_read_b64_tr_b16 v[154:155], v223 offset:18432
    v_mfma_f32_16x16x32_bf16 v[100:103], v[128:131], a[44:47], v[100:103]
    ds_read_b64_tr_b16 v[156:157], v223 offset:24576
    v_mfma_f32_16x16x32_bf16 v[100:103], v[132:135], a[60:63], v[100:103]
    ds_read_b64_tr_b16 v[158:159], v223 offset:26624
    v_mfma_f32_16x16x32_bf16 v[8:11], v[136:139], a[32:35], v[8:11]
    v_mfma_f32_16x16x32_bf16 v[8:11], v[140:143], a[48:51], v[8:11]
    s_add_u32 m0, s38, 122880
    s_add_u32 s32, s37, 2031616
    v_mfma_f32_16x16x32_bf16 v[12:15], v[136:139], a[36:39], v[12:15]
    buffer_load_dwordx4 v224, s[12:15], s32 offen lds
    v_mfma_f32_16x16x32_bf16 v[12:15], v[140:143], a[52:55], v[12:15]
    v_mfma_f32_16x16x32_bf16 v[104:107], v[136:139], a[40:43], v[104:107]
    v_mfma_f32_16x16x32_bf16 v[104:107], v[140:143], a[56:59], v[104:107]
    buffer_load_dwordx4 v225, s[12:15], s32 offen offset:1024 lds
    v_mfma_f32_16x16x32_bf16 v[108:111], v[136:139], a[44:47], v[108:111]
    buffer_load_dwordx4 a[184:187], v228, s[8:11], s33 offen offset:2048 sc1
    v_mfma_f32_16x16x32_bf16 v[108:111], v[140:143], a[60:63], v[108:111]
    s_waitcnt vmcnt(63) lgkmcnt(0)
    s_barrier
    v_mfma_f32_16x16x32_bf16 v[16:19], v[144:147], a[32:35], v[16:19]
    ds_read_b64_tr_b16 v[128:129], v216 offset:32768
    v_mfma_f32_16x16x32_bf16 v[16:19], v[148:151], a[48:51], v[16:19]
    ds_read_b64_tr_b16 v[130:131], v216 offset:34816
    v_mfma_f32_16x16x32_bf16 v[20:23], v[144:147], a[36:39], v[20:23]
    ds_read_b64_tr_b16 v[132:133], v216 offset:40960
    v_mfma_f32_16x16x32_bf16 v[20:23], v[148:151], a[52:55], v[20:23]
    ds_read_b64_tr_b16 v[134:135], v216 offset:43008
    v_mfma_f32_16x16x32_bf16 v[112:115], v[144:147], a[40:43], v[112:115]
    ds_read_b64_tr_b16 v[136:137], v217 offset:32768
    v_mfma_f32_16x16x32_bf16 v[112:115], v[148:151], a[56:59], v[112:115]
    ds_read_b64_tr_b16 v[138:139], v217 offset:34816
    v_mfma_f32_16x16x32_bf16 v[116:119], v[144:147], a[44:47], v[116:119]
    ds_read_b64_tr_b16 v[140:141], v217 offset:40960
    v_mfma_f32_16x16x32_bf16 v[116:119], v[148:151], a[60:63], v[116:119]
    ds_read_b64_tr_b16 v[142:143], v217 offset:43008
    v_mfma_f32_16x16x32_bf16 v[24:27], v[152:155], a[32:35], v[24:27]
    v_mfma_f32_16x16x32_bf16 v[24:27], v[156:159], a[48:51], v[24:27]
    v_mfma_f32_16x16x32_bf16 v[28:31], v[152:155], a[36:39], v[28:31]
    v_mfma_f32_16x16x32_bf16 v[28:31], v[156:159], a[52:55], v[28:31]
    v_mfma_f32_16x16x32_bf16 v[120:123], v[152:155], a[40:43], v[120:123]
    v_mfma_f32_16x16x32_bf16 v[120:123], v[156:159], a[56:59], v[120:123]
    v_mfma_f32_16x16x32_bf16 v[124:127], v[152:155], a[44:47], v[124:127]
    buffer_load_dwordx4 a[188:191], v228, s[8:11], s33 offen offset:3072 sc1
    v_mfma_f32_16x16x32_bf16 v[124:127], v[156:159], a[60:63], v[124:127]
    buffer_load_dwordx4 a[32:35], v226, s[8:11], s35 offen offset:2048 sc1
    s_waitcnt vmcnt(36) lgkmcnt(0)
    v_mfma_f32_16x16x32_bf16 v[32:35], v[128:131], a[64:67], v[32:35]
    ds_read_b64_tr_b16 v[144:145], v218 offset:32768
    v_mfma_f32_16x16x32_bf16 v[32:35], v[132:135], a[80:83], v[32:35]
    ds_read_b64_tr_b16 v[146:147], v218 offset:34816
    v_mfma_f32_16x16x32_bf16 v[36:39], v[128:131], a[68:71], v[36:39]
    ds_read_b64_tr_b16 v[148:149], v218 offset:40960
    v_mfma_f32_16x16x32_bf16 v[36:39], v[132:135], a[84:87], v[36:39]
    ds_read_b64_tr_b16 v[150:151], v218 offset:43008
    v_mfma_f32_16x16x32_bf16 v[64:67], v[128:131], a[72:75], v[64:67]
    ds_read_b64_tr_b16 v[152:153], v219 offset:32768
    v_mfma_f32_16x16x32_bf16 v[64:67], v[132:135], a[88:91], v[64:67]
    ds_read_b64_tr_b16 v[154:155], v219 offset:34816
    v_mfma_f32_16x16x32_bf16 v[68:71], v[128:131], a[76:79], v[68:71]
    ds_read_b64_tr_b16 v[156:157], v219 offset:40960
    v_mfma_f32_16x16x32_bf16 v[68:71], v[132:135], a[92:95], v[68:71]
    ds_read_b64_tr_b16 v[158:159], v219 offset:43008
    v_mfma_f32_16x16x32_bf16 v[40:43], v[136:139], a[64:67], v[40:43]
    buffer_load_dwordx4 a[36:39], v227, s[8:11], s35 offen offset:2048 sc1
    v_mfma_f32_16x16x32_bf16 v[40:43], v[140:143], a[80:83], v[40:43]
    v_mfma_f32_16x16x32_bf16 v[44:47], v[136:139], a[68:71], v[44:47]
    v_mfma_f32_16x16x32_bf16 v[44:47], v[140:143], a[84:87], v[44:47]
    buffer_load_dwordx4 a[40:43], v245, s[8:11], s35 offen offset:2048 sc1
    v_mfma_f32_16x16x32_bf16 v[72:75], v[136:139], a[72:75], v[72:75]
    v_mfma_f32_16x16x32_bf16 v[72:75], v[140:143], a[88:91], v[72:75]
    s_mov_b32 s32, 0
    buffer_load_dwordx4 v[192:195], v229, s[16:19], s32 offen
    v_mfma_f32_16x16x32_bf16 v[76:79], v[136:139], a[76:79], v[76:79]
    v_mfma_f32_16x16x32_bf16 v[76:79], v[140:143], a[92:95], v[76:79]
    buffer_load_dwordx4 a[44:47], v246, s[8:11], s35 offen offset:2048 sc1
    s_waitcnt lgkmcnt(0)
    v_mfma_f32_16x16x32_bf16 v[48:51], v[144:147], a[64:67], v[48:51]
    ds_read_b64_tr_b16 v[128:129], v220 offset:32768
    v_mfma_f32_16x16x32_bf16 v[48:51], v[148:151], a[80:83], v[48:51]
    ds_read_b64_tr_b16 v[130:131], v220 offset:34816
    v_mfma_f32_16x16x32_bf16 v[52:55], v[144:147], a[68:71], v[52:55]
    ds_read_b64_tr_b16 v[132:133], v220 offset:40960
    v_mfma_f32_16x16x32_bf16 v[52:55], v[148:151], a[84:87], v[52:55]
    ds_read_b64_tr_b16 v[134:135], v220 offset:43008
    v_mfma_f32_16x16x32_bf16 v[80:83], v[144:147], a[72:75], v[80:83]
    ds_read_b64_tr_b16 v[136:137], v221 offset:32768
    v_mfma_f32_16x16x32_bf16 v[80:83], v[148:151], a[88:91], v[80:83]
    ds_read_b64_tr_b16 v[138:139], v221 offset:34816
    v_mfma_f32_16x16x32_bf16 v[84:87], v[144:147], a[76:79], v[84:87]
    ds_read_b64_tr_b16 v[140:141], v221 offset:40960
    v_mfma_f32_16x16x32_bf16 v[84:87], v[148:151], a[92:95], v[84:87]
    ds_read_b64_tr_b16 v[142:143], v221 offset:43008
    v_mfma_f32_16x16x32_bf16 v[56:59], v[152:155], a[64:67], v[56:59]
    buffer_load_dwordx4 a[48:51], v226, s[8:11], s35 offen offset:3072 sc1
    v_mfma_f32_16x16x32_bf16 v[56:59], v[156:159], a[80:83], v[56:59]
    v_mfma_f32_16x16x32_bf16 v[60:63], v[152:155], a[68:71], v[60:63]
    buffer_load_dwordx4 a[52:55], v227, s[8:11], s35 offen offset:3072 sc1
    v_mfma_f32_16x16x32_bf16 v[60:63], v[156:159], a[84:87], v[60:63]
    v_mfma_f32_16x16x32_bf16 v[88:91], v[152:155], a[72:75], v[88:91]
    buffer_load_dwordx4 a[56:59], v245, s[8:11], s35 offen offset:3072 sc1
    v_mfma_f32_16x16x32_bf16 v[88:91], v[156:159], a[88:91], v[88:91]
    s_mov_b32 s32, 16384
    buffer_load_dwordx4 v[196:199], v229, s[16:19], s32 offen
    v_mfma_f32_16x16x32_bf16 v[92:95], v[152:155], a[76:79], v[92:95]
    v_mfma_f32_16x16x32_bf16 v[92:95], v[156:159], a[92:95], v[92:95]
    buffer_load_dwordx4 a[60:63], v246, s[8:11], s35 offen offset:3072 sc1
    s_waitcnt lgkmcnt(0)
    v_mfma_f32_16x16x32_bf16 v[0:3], v[128:131], a[64:67], v[0:3]
    ds_read_b64_tr_b16 v[144:145], v222 offset:32768
    v_mfma_f32_16x16x32_bf16 v[0:3], v[132:135], a[80:83], v[0:3]
    ds_read_b64_tr_b16 v[146:147], v222 offset:34816
    v_mfma_f32_16x16x32_bf16 v[4:7], v[128:131], a[68:71], v[4:7]
    ds_read_b64_tr_b16 v[148:149], v222 offset:40960
    v_mfma_f32_16x16x32_bf16 v[4:7], v[132:135], a[84:87], v[4:7]
    ds_read_b64_tr_b16 v[150:151], v222 offset:43008
    v_mfma_f32_16x16x32_bf16 v[96:99], v[128:131], a[72:75], v[96:99]
    ds_read_b64_tr_b16 v[152:153], v223 offset:32768
    v_mfma_f32_16x16x32_bf16 v[96:99], v[132:135], a[88:91], v[96:99]
    ds_read_b64_tr_b16 v[154:155], v223 offset:34816
    v_mfma_f32_16x16x32_bf16 v[100:103], v[128:131], a[76:79], v[100:103]
    ds_read_b64_tr_b16 v[156:157], v223 offset:40960
    v_mfma_f32_16x16x32_bf16 v[100:103], v[132:135], a[92:95], v[100:103]
    ds_read_b64_tr_b16 v[158:159], v223 offset:43008
    v_mfma_f32_16x16x32_bf16 v[8:11], v[136:139], a[64:67], v[8:11]
    v_mfma_f32_16x16x32_bf16 v[8:11], v[140:143], a[80:83], v[8:11]
    v_mfma_f32_16x16x32_bf16 v[12:15], v[136:139], a[68:71], v[12:15]
    v_mfma_f32_16x16x32_bf16 v[12:15], v[140:143], a[84:87], v[12:15]
    v_mfma_f32_16x16x32_bf16 v[104:107], v[136:139], a[72:75], v[104:107]
    v_mfma_f32_16x16x32_bf16 v[104:107], v[140:143], a[88:91], v[104:107]
    s_mov_b32 s32, 32768
    buffer_load_dwordx4 v[200:203], v229, s[16:19], s32 offen
    v_mfma_f32_16x16x32_bf16 v[108:111], v[136:139], a[76:79], v[108:111]
    v_mfma_f32_16x16x32_bf16 v[108:111], v[140:143], a[92:95], v[108:111]
    s_waitcnt lgkmcnt(0)
    v_mfma_f32_16x16x32_bf16 v[16:19], v[144:147], a[64:67], v[16:19]
    ds_read_b64_tr_b16 v[128:129], v216 offset:49152
    v_mfma_f32_16x16x32_bf16 v[16:19], v[148:151], a[80:83], v[16:19]
    ds_read_b64_tr_b16 v[130:131], v216 offset:51200
    v_mfma_f32_16x16x32_bf16 v[20:23], v[144:147], a[68:71], v[20:23]
    ds_read_b64_tr_b16 v[132:133], v216 offset:57344
    v_mfma_f32_16x16x32_bf16 v[20:23], v[148:151], a[84:87], v[20:23]
    ds_read_b64_tr_b16 v[134:135], v216 offset:59392
    v_mfma_f32_16x16x32_bf16 v[112:115], v[144:147], a[72:75], v[112:115]
    ds_read_b64_tr_b16 v[136:137], v217 offset:49152
    v_mfma_f32_16x16x32_bf16 v[112:115], v[148:151], a[88:91], v[112:115]
    ds_read_b64_tr_b16 v[138:139], v217 offset:51200
    v_mfma_f32_16x16x32_bf16 v[116:119], v[144:147], a[76:79], v[116:119]
    ds_read_b64_tr_b16 v[140:141], v217 offset:57344
    v_mfma_f32_16x16x32_bf16 v[116:119], v[148:151], a[92:95], v[116:119]
    ds_read_b64_tr_b16 v[142:143], v217 offset:59392
    v_mfma_f32_16x16x32_bf16 v[24:27], v[152:155], a[64:67], v[24:27]
    v_mfma_f32_16x16x32_bf16 v[24:27], v[156:159], a[80:83], v[24:27]
    v_mfma_f32_16x16x32_bf16 v[28:31], v[152:155], a[68:71], v[28:31]
    v_mfma_f32_16x16x32_bf16 v[28:31], v[156:159], a[84:87], v[28:31]
    v_mfma_f32_16x16x32_bf16 v[120:123], v[152:155], a[72:75], v[120:123]
    v_mfma_f32_16x16x32_bf16 v[120:123], v[156:159], a[88:91], v[120:123]
    s_mov_b32 s32, 49152
    buffer_load_dwordx4 v[204:207], v229, s[16:19], s32 offen
    v_mfma_f32_16x16x32_bf16 v[124:127], v[152:155], a[76:79], v[124:127]
    v_mfma_f32_16x16x32_bf16 v[124:127], v[156:159], a[92:95], v[124:127]
    s_add_u32 s35, s35, 4096
    buffer_load_dwordx4 a[64:67], v226, s[8:11], s35 offen offset:0 sc1
    s_waitcnt vmcnt(33) lgkmcnt(0)
    v_mfma_f32_16x16x32_bf16 v[32:35], v[128:131], a[96:99], v[32:35]
    ds_read_b64_tr_b16 v[144:145], v218 offset:49152
    v_mfma_f32_16x16x32_bf16 v[32:35], v[132:135], a[112:115], v[32:35]
    ds_read_b64_tr_b16 v[146:147], v218 offset:51200
    v_mfma_f32_16x16x32_bf16 v[36:39], v[128:131], a[100:103], v[36:39]
    ds_read_b64_tr_b16 v[148:149], v218 offset:57344
    v_mfma_f32_16x16x32_bf16 v[36:39], v[132:135], a[116:119], v[36:39]
    ds_read_b64_tr_b16 v[150:151], v218 offset:59392
    v_mfma_f32_16x16x32_bf16 v[64:67], v[128:131], a[104:107], v[64:67]
    ds_read_b64_tr_b16 v[152:153], v219 offset:49152
    v_mfma_f32_16x16x32_bf16 v[64:67], v[132:135], a[120:123], v[64:67]
    ds_read_b64_tr_b16 v[154:155], v219 offset:51200
    v_mfma_f32_16x16x32_bf16 v[68:71], v[128:131], a[108:111], v[68:71]
    ds_read_b64_tr_b16 v[156:157], v219 offset:57344
    v_mfma_f32_16x16x32_bf16 v[68:71], v[132:135], a[124:127], v[68:71]
    ds_read_b64_tr_b16 v[158:159], v219 offset:59392
    v_mfma_f32_16x16x32_bf16 v[40:43], v[136:139], a[96:99], v[40:43]
    buffer_load_dwordx4 a[68:71], v227, s[8:11], s35 offen offset:0 sc1
    v_mfma_f32_16x16x32_bf16 v[40:43], v[140:143], a[112:115], v[40:43]
    v_mfma_f32_16x16x32_bf16 v[44:47], v[136:139], a[100:103], v[44:47]
    v_mfma_f32_16x16x32_bf16 v[44:47], v[140:143], a[116:119], v[44:47]
    buffer_load_dwordx4 a[72:75], v245, s[8:11], s35 offen offset:0 sc1
    v_mfma_f32_16x16x32_bf16 v[72:75], v[136:139], a[104:107], v[72:75]
    v_mfma_f32_16x16x32_bf16 v[72:75], v[140:143], a[120:123], v[72:75]
    buffer_load_dwordx4 v[208:211], v240, s[20:23], 0 offen
    v_mfma_f32_16x16x32_bf16 v[76:79], v[136:139], a[108:111], v[76:79]
    v_mfma_f32_16x16x32_bf16 v[76:79], v[140:143], a[124:127], v[76:79]
    buffer_load_dwordx4 a[76:79], v246, s[8:11], s35 offen offset:0 sc1
    s_waitcnt lgkmcnt(0)
    v_mfma_f32_16x16x32_bf16 v[48:51], v[144:147], a[96:99], v[48:51]
    ds_read_b64_tr_b16 v[128:129], v220 offset:49152
    v_mfma_f32_16x16x32_bf16 v[48:51], v[148:151], a[112:115], v[48:51]
    ds_read_b64_tr_b16 v[130:131], v220 offset:51200
    v_mfma_f32_16x16x32_bf16 v[52:55], v[144:147], a[100:103], v[52:55]
    ds_read_b64_tr_b16 v[132:133], v220 offset:57344
    v_mfma_f32_16x16x32_bf16 v[52:55], v[148:151], a[116:119], v[52:55]
    ds_read_b64_tr_b16 v[134:135], v220 offset:59392
    v_mfma_f32_16x16x32_bf16 v[80:83], v[144:147], a[104:107], v[80:83]
    ds_read_b64_tr_b16 v[136:137], v221 offset:49152
    v_mfma_f32_16x16x32_bf16 v[80:83], v[148:151], a[120:123], v[80:83]
    ds_read_b64_tr_b16 v[138:139], v221 offset:51200
    v_mfma_f32_16x16x32_bf16 v[84:87], v[144:147], a[108:111], v[84:87]
    ds_read_b64_tr_b16 v[140:141], v221 offset:57344
    v_mfma_f32_16x16x32_bf16 v[84:87], v[148:151], a[124:127], v[84:87]
    ds_read_b64_tr_b16 v[142:143], v221 offset:59392
    v_mfma_f32_16x16x32_bf16 v[56:59], v[152:155], a[96:99], v[56:59]
    buffer_load_dwordx4 a[80:83], v226, s[8:11], s35 offen offset:1024 sc1
    v_mfma_f32_16x16x32_bf16 v[56:59], v[156:159], a[112:115], v[56:59]
    v_mfma_f32_16x16x32_bf16 v[60:63], v[152:155], a[100:103], v[60:63]
    buffer_load_dwordx4 a[84:87], v227, s[8:11], s35 offen offset:1024 sc1
    v_mfma_f32_16x16x32_bf16 v[60:63], v[156:159], a[116:119], v[60:63]
    v_mfma_f32_16x16x32_bf16 v[88:91], v[152:155], a[104:107], v[88:91]
    buffer_load_dwordx4 a[88:91], v245, s[8:11], s35 offen offset:1024 sc1
    v_mfma_f32_16x16x32_bf16 v[88:91], v[156:159], a[120:123], v[88:91]
    s_mov_b32 s32, kc_tail-kc_pc0
    v_lshlrev_b32 v234, 7, v230
    buffer_load_dword v241, v234, s[56:59], s32 offen
    v_mfma_f32_16x16x32_bf16 v[92:95], v[152:155], a[108:111], v[92:95]
    v_mfma_f32_16x16x32_bf16 v[92:95], v[156:159], a[124:127], v[92:95]
    buffer_load_dwordx4 a[92:95], v246, s[8:11], s35 offen offset:1024 sc1
    s_waitcnt lgkmcnt(0)
    v_mfma_f32_16x16x32_bf16 v[0:3], v[128:131], a[96:99], v[0:3]
    ds_read_b64_tr_b16 v[144:145], v222 offset:49152
    v_mfma_f32_16x16x32_bf16 v[0:3], v[132:135], a[112:115], v[0:3]
    ds_read_b64_tr_b16 v[146:147], v222 offset:51200
    v_mfma_f32_16x16x32_bf16 v[4:7], v[128:131], a[100:103], v[4:7]
    ds_read_b64_tr_b16 v[148:149], v222 offset:57344
    v_mfma_f32_16x16x32_bf16 v[4:7], v[132:135], a[116:119], v[4:7]
    ds_read_b64_tr_b16 v[150:151], v222 offset:59392
    v_mfma_f32_16x16x32_bf16 v[96:99], v[128:131], a[104:107], v[96:99]
    ds_read_b64_tr_b16 v[152:153], v223 offset:49152
    v_mfma_f32_16x16x32_bf16 v[96:99], v[132:135], a[120:123], v[96:99]
    ds_read_b64_tr_b16 v[154:155], v223 offset:51200
    v_mfma_f32_16x16x32_bf16 v[100:103], v[128:131], a[108:111], v[100:103]
    ds_read_b64_tr_b16 v[156:157], v223 offset:57344
    v_mfma_f32_16x16x32_bf16 v[100:103], v[132:135], a[124:127], v[100:103]
    ds_read_b64_tr_b16 v[158:159], v223 offset:59392
    v_mfma_f32_16x16x32_bf16 v[8:11], v[136:139], a[96:99], v[8:11]
    v_mfma_f32_16x16x32_bf16 v[8:11], v[140:143], a[112:115], v[8:11]
    v_mfma_f32_16x16x32_bf16 v[12:15], v[136:139], a[100:103], v[12:15]
    v_mfma_f32_16x16x32_bf16 v[12:15], v[140:143], a[116:119], v[12:15]
    v_mfma_f32_16x16x32_bf16 v[104:107], v[136:139], a[104:107], v[104:107]
    v_mfma_f32_16x16x32_bf16 v[104:107], v[140:143], a[120:123], v[104:107]
    v_mfma_f32_16x16x32_bf16 v[108:111], v[136:139], a[108:111], v[108:111]
    v_mfma_f32_16x16x32_bf16 v[108:111], v[140:143], a[124:127], v[108:111]
    s_waitcnt vmcnt(24) lgkmcnt(0)
    s_barrier
    v_mfma_f32_16x16x32_bf16 v[16:19], v[144:147], a[96:99], v[16:19]
    v_xor_b32 v220, 0x10000, v220
    ds_read_b64_tr_b16 v[128:129], v220 offset:0
    v_mfma_f32_16x16x32_bf16 v[16:19], v[148:151], a[112:115], v[16:19]
    ds_read_b64_tr_b16 v[130:131], v220 offset:2048
    v_mfma_f32_16x16x32_bf16 v[20:23], v[144:147], a[100:103], v[20:23]
    ds_read_b64_tr_b16 v[132:133], v220 offset:8192
    v_mfma_f32_16x16x32_bf16 v[20:23], v[148:151], a[116:119], v[20:23]
    ds_read_b64_tr_b16 v[134:135], v220 offset:10240
    v_mfma_f32_16x16x32_bf16 v[112:115], v[144:147], a[104:107], v[112:115]
    v_xor_b32 v221, 0x10000, v221
    ds_read_b64_tr_b16 v[136:137], v221 offset:0
    v_mfma_f32_16x16x32_bf16 v[112:115], v[148:151], a[120:123], v[112:115]
    ds_read_b64_tr_b16 v[138:139], v221 offset:2048
    v_mfma_f32_16x16x32_bf16 v[116:119], v[144:147], a[108:111], v[116:119]
    ds_read_b64_tr_b16 v[140:141], v221 offset:8192
    v_mfma_f32_16x16x32_bf16 v[116:119], v[148:151], a[124:127], v[116:119]
    ds_read_b64_tr_b16 v[142:143], v221 offset:10240
    v_mfma_f32_16x16x32_bf16 v[24:27], v[152:155], a[96:99], v[24:27]
    v_mfma_f32_16x16x32_bf16 v[24:27], v[156:159], a[112:115], v[24:27]
    v_mfma_f32_16x16x32_bf16 v[28:31], v[152:155], a[100:103], v[28:31]
    v_mfma_f32_16x16x32_bf16 v[28:31], v[156:159], a[116:119], v[28:31]
    v_mfma_f32_16x16x32_bf16 v[120:123], v[152:155], a[104:107], v[120:123]
    v_mfma_f32_16x16x32_bf16 v[120:123], v[156:159], a[120:123], v[120:123]
    v_mfma_f32_16x16x32_bf16 v[124:127], v[152:155], a[108:111], v[124:127]
    v_mfma_f32_16x16x32_bf16 v[124:127], v[156:159], a[124:127], v[124:127]
    buffer_load_dwordx4 a[96:99], v226, s[8:11], s35 offen offset:2048 sc1
    s_waitcnt vmcnt(27) lgkmcnt(4)
    v_mfma_f32_16x16x32_bf16 v[96:99], v[128:131], a[8:11], v[96:99]
    v_xor_b32 v222, 0x10000, v222
    ds_read_b64_tr_b16 v[144:145], v222 offset:0
    v_mfma_f32_16x16x32_bf16 v[96:99], v[132:135], a[24:27], v[96:99]
    ds_read_b64_tr_b16 v[146:147], v222 offset:2048
    v_mfma_f32_16x16x32_bf16 v[100:103], v[128:131], a[12:15], v[100:103]
    ds_read_b64_tr_b16 v[148:149], v222 offset:8192
    buffer_load_dwordx4 a[100:103], v227, s[8:11], s35 offen offset:2048 sc1
    v_mfma_f32_16x16x32_bf16 v[100:103], v[132:135], a[28:31], v[100:103]
    ds_read_b64_tr_b16 v[150:151], v222 offset:10240
    s_waitcnt lgkmcnt(4)
    v_mfma_f32_16x16x32_bf16 v[104:107], v[136:139], a[8:11], v[104:107]
    v_xor_b32 v223, 0x10000, v223
    ds_read_b64_tr_b16 v[152:153], v223 offset:0
    v_mfma_f32_16x16x32_bf16 v[104:107], v[140:143], a[24:27], v[104:107]
    ds_read_b64_tr_b16 v[154:155], v223 offset:2048
    v_mfma_f32_16x16x32_bf16 v[108:111], v[136:139], a[12:15], v[108:111]
    ds_read_b64_tr_b16 v[156:157], v223 offset:8192
    buffer_load_dwordx4 a[104:107], v245, s[8:11], s35 offen offset:2048 sc1
    v_mfma_f32_16x16x32_bf16 v[108:111], v[140:143], a[28:31], v[108:111]
    ds_read_b64_tr_b16 v[158:159], v223 offset:10240
    s_waitcnt lgkmcnt(4)
    v_mfma_f32_16x16x32_bf16 v[112:115], v[144:147], a[8:11], v[112:115]
    ds_read_b64_tr_b16 v[128:129], v220 offset:16384
    v_mfma_f32_16x16x32_bf16 v[112:115], v[148:151], a[24:27], v[112:115]
    ds_read_b64_tr_b16 v[130:131], v220 offset:18432
    v_mfma_f32_16x16x32_bf16 v[116:119], v[144:147], a[12:15], v[116:119]
    ds_read_b64_tr_b16 v[132:133], v220 offset:24576
    buffer_load_dwordx4 a[108:111], v246, s[8:11], s35 offen offset:2048 sc1
    v_mfma_f32_16x16x32_bf16 v[116:119], v[148:151], a[28:31], v[116:119]
    ds_read_b64_tr_b16 v[134:135], v220 offset:26624
    s_waitcnt lgkmcnt(4)
    v_mfma_f32_16x16x32_bf16 v[120:123], v[152:155], a[8:11], v[120:123]
    ds_read_b64_tr_b16 v[136:137], v221 offset:16384
    v_mfma_f32_16x16x32_bf16 v[120:123], v[156:159], a[24:27], v[120:123]
    ds_read_b64_tr_b16 v[138:139], v221 offset:18432
    v_mfma_f32_16x16x32_bf16 v[124:127], v[152:155], a[12:15], v[124:127]
    ds_read_b64_tr_b16 v[140:141], v221 offset:24576
    buffer_load_dwordx4 a[112:115], v226, s[8:11], s35 offen offset:3072 sc1
    v_mfma_f32_16x16x32_bf16 v[124:127], v[156:159], a[28:31], v[124:127]
    ds_read_b64_tr_b16 v[142:143], v221 offset:26624
    s_waitcnt vmcnt(17) lgkmcnt(4)
    v_mfma_f32_16x16x32_bf16 v[96:99], v[128:131], a[40:43], v[96:99]
    ds_read_b64_tr_b16 v[144:145], v222 offset:16384
    v_mfma_f32_16x16x32_bf16 v[96:99], v[132:135], a[56:59], v[96:99]
    ds_read_b64_tr_b16 v[146:147], v222 offset:18432
    v_mfma_f32_16x16x32_bf16 v[100:103], v[128:131], a[44:47], v[100:103]
    ds_read_b64_tr_b16 v[148:149], v222 offset:24576
    buffer_load_dwordx4 a[116:119], v227, s[8:11], s35 offen offset:3072 sc1
    v_mfma_f32_16x16x32_bf16 v[100:103], v[132:135], a[60:63], v[100:103]
    ds_read_b64_tr_b16 v[150:151], v222 offset:26624
    s_waitcnt lgkmcnt(4)
    v_mfma_f32_16x16x32_bf16 v[104:107], v[136:139], a[40:43], v[104:107]
    ds_read_b64_tr_b16 v[152:153], v223 offset:16384
    v_mfma_f32_16x16x32_bf16 v[104:107], v[140:143], a[56:59], v[104:107]
    ds_read_b64_tr_b16 v[154:155], v223 offset:18432
    v_mfma_f32_16x16x32_bf16 v[108:111], v[136:139], a[44:47], v[108:111]
    ds_read_b64_tr_b16 v[156:157], v223 offset:24576
    buffer_load_dwordx4 a[120:123], v245, s[8:11], s35 offen offset:3072 sc1
    v_mfma_f32_16x16x32_bf16 v[108:111], v[140:143], a[60:63], v[108:111]
    ds_read_b64_tr_b16 v[158:159], v223 offset:26624
    s_waitcnt lgkmcnt(4)
    v_mfma_f32_16x16x32_bf16 v[112:115], v[144:147], a[40:43], v[112:115]
    ds_read_b64_tr_b16 v[128:129], v220 offset:32768
    v_mfma_f32_16x16x32_bf16 v[112:115], v[148:151], a[56:59], v[112:115]
    ds_read_b64_tr_b16 v[130:131], v220 offset:34816
    v_mfma_f32_16x16x32_bf16 v[116:119], v[144:147], a[44:47], v[116:119]
    ds_read_b64_tr_b16 v[132:133], v220 offset:40960
    buffer_load_dwordx4 a[124:127], v246, s[8:11], s35 offen offset:3072 sc1
    v_mfma_f32_16x16x32_bf16 v[116:119], v[148:151], a[60:63], v[116:119]
    ds_read_b64_tr_b16 v[134:135], v220 offset:43008
    s_waitcnt lgkmcnt(4)
    v_mfma_f32_16x16x32_bf16 v[120:123], v[152:155], a[40:43], v[120:123]
    ds_read_b64_tr_b16 v[136:137], v221 offset:32768
    v_mfma_f32_16x16x32_bf16 v[120:123], v[156:159], a[56:59], v[120:123]
    ds_read_b64_tr_b16 v[138:139], v221 offset:34816
    v_mfma_f32_16x16x32_bf16 v[124:127], v[152:155], a[44:47], v[124:127]
    ds_read_b64_tr_b16 v[140:141], v221 offset:40960
    v_mfma_f32_16x16x32_bf16 v[124:127], v[156:159], a[60:63], v[124:127]
    ds_read_b64_tr_b16 v[142:143], v221 offset:43008
    s_waitcnt vmcnt(8) lgkmcnt(4)
    v_mfma_f32_16x16x32_bf16 v[96:99], v[128:131], a[72:75], v[96:99]
    ds_read_b64_tr_b16 v[144:145], v222 offset:32768
    v_mfma_f32_16x16x32_bf16 v[96:99], v[132:135], a[88:91], v[96:99]
    ds_read_b64_tr_b16 v[146:147], v222 offset:34816
    s_xor_b32 s7, s39, 24
    v_mfma_f32_16x16x32_bf16 v[100:103], v[128:131], a[76:79], v[100:103]
    ds_read_b64_tr_b16 v[148:149], v222 offset:40960
    v_mfma_f32_16x16x32_bf16 v[100:103], v[132:135], a[92:95], v[100:103]
    ds_read_b64_tr_b16 v[150:151], v222 offset:43008
    s_waitcnt lgkmcnt(4)
    v_mfma_f32_16x16x32_bf16 v[104:107], v[136:139], a[72:75], v[104:107]
    ds_read_b64_tr_b16 v[152:153], v223 offset:32768
    v_mfma_f32_16x16x32_bf16 v[104:107], v[140:143], a[88:91], v[104:107]
    ds_read_b64_tr_b16 v[154:155], v223 offset:34816
    s_mul_i32 s7, s7, 12288
    v_mfma_f32_16x16x32_bf16 v[108:111], v[136:139], a[76:79], v[108:111]
    ds_read_b64_tr_b16 v[156:157], v223 offset:40960
    s_add_u32 s7, s7, 0x5002000
    v_mfma_f32_16x16x32_bf16 v[108:111], v[140:143], a[92:95], v[108:111]
    ds_read_b64_tr_b16 v[158:159], v223 offset:43008
    s_waitcnt lgkmcnt(4)
    v_mfma_f32_16x16x32_bf16 v[112:115], v[144:147], a[72:75], v[112:115]
    ds_read_b64_tr_b16 v[128:129], v220 offset:49152
    v_mfma_f32_16x16x32_bf16 v[112:115], v[148:151], a[88:91], v[112:115]
    ds_read_b64_tr_b16 v[130:131], v220 offset:51200
    s_xor_b32 s37, s39, 8
    v_mfma_f32_16x16x32_bf16 v[116:119], v[144:147], a[76:79], v[116:119]
    ds_read_b64_tr_b16 v[132:133], v220 offset:57344
    v_mfma_f32_16x16x32_bf16 v[116:119], v[148:151], a[92:95], v[116:119]
    ds_read_b64_tr_b16 v[134:135], v220 offset:59392
    s_waitcnt lgkmcnt(4)
    v_mfma_f32_16x16x32_bf16 v[120:123], v[152:155], a[72:75], v[120:123]
    ds_read_b64_tr_b16 v[136:137], v221 offset:49152
    v_mfma_f32_16x16x32_bf16 v[120:123], v[156:159], a[88:91], v[120:123]
    ds_read_b64_tr_b16 v[138:139], v221 offset:51200
    s_mul_i32 s37, s37, 12288
    v_mfma_f32_16x16x32_bf16 v[124:127], v[152:155], a[76:79], v[124:127]
    ds_read_b64_tr_b16 v[140:141], v221 offset:57344
    s_add_u32 s37, s37, 0x5000000
    v_mfma_f32_16x16x32_bf16 v[124:127], v[156:159], a[92:95], v[124:127]
    ds_read_b64_tr_b16 v[142:143], v221 offset:59392
    s_waitcnt vmcnt(0) lgkmcnt(4)
    v_mfma_f32_16x16x32_bf16 v[96:99], v[128:131], a[104:107], v[96:99]
    ds_read_b64_tr_b16 v[144:145], v222 offset:49152
    v_mfma_f32_16x16x32_bf16 v[96:99], v[132:135], a[120:123], v[96:99]
    ds_read_b64_tr_b16 v[146:147], v222 offset:51200
    s_xor_b32 s38, s39, 16
    v_mfma_f32_16x16x32_bf16 v[100:103], v[128:131], a[108:111], v[100:103]
    ds_read_b64_tr_b16 v[148:149], v222 offset:57344
    v_mfma_f32_16x16x32_bf16 v[100:103], v[132:135], a[124:127], v[100:103]
    ds_read_b64_tr_b16 v[150:151], v222 offset:59392
    s_waitcnt lgkmcnt(4)
    v_mfma_f32_16x16x32_bf16 v[104:107], v[136:139], a[104:107], v[104:107]
    ds_read_b64_tr_b16 v[152:153], v223 offset:49152
    v_mfma_f32_16x16x32_bf16 v[104:107], v[140:143], a[120:123], v[104:107]
    ds_read_b64_tr_b16 v[154:155], v223 offset:51200
    s_mul_i32 s38, s38, 12288
    v_mfma_f32_16x16x32_bf16 v[108:111], v[136:139], a[108:111], v[108:111]
    ds_read_b64_tr_b16 v[156:157], v223 offset:57344
    s_add_u32 s38, s38, 0x5001000
    v_mfma_f32_16x16x32_bf16 v[108:111], v[140:143], a[124:127], v[108:111]
    ds_read_b64_tr_b16 v[158:159], v223 offset:59392
    s_waitcnt lgkmcnt(4)
    v_mfma_f32_16x16x32_bf16 v[112:115], v[144:147], a[104:107], v[112:115]
    ds_read_b64_tr_b16 v[128:129], v220 offset:0
    v_mfma_f32_16x16x32_bf16 v[112:115], v[148:151], a[120:123], v[112:115]
    ds_read_b64_tr_b16 v[130:131], v220 offset:2048
    v_mfma_f32_16x16x32_bf16 v[116:119], v[144:147], a[108:111], v[116:119]
    ds_read_b64_tr_b16 v[132:133], v220 offset:8192
    v_mfma_f32_16x16x32_bf16 v[116:119], v[148:151], a[124:127], v[116:119]
    ds_read_b64_tr_b16 v[134:135], v220 offset:10240
    s_waitcnt lgkmcnt(4)
    v_mfma_f32_16x16x32_bf16 v[120:123], v[152:155], a[104:107], v[120:123]
    ds_read_b64_tr_b16 v[136:137], v221 offset:0
    v_mfma_f32_16x16x32_bf16 v[120:123], v[156:159], a[120:123], v[120:123]
    ds_read_b64_tr_b16 v[138:139], v221 offset:2048
    v_mfma_f32_16x16x32_bf16 v[124:127], v[152:155], a[108:111], v[124:127]
    ds_read_b64_tr_b16 v[140:141], v221 offset:8192
    v_mfma_f32_16x16x32_bf16 v[124:127], v[156:159], a[124:127], v[124:127]
    ds_read_b64_tr_b16 v[142:143], v221 offset:10240
    s_waitcnt lgkmcnt(4)
    v_mfma_f32_16x16x32_bf16 v[0:3], v[128:131], a[0:3], v[0:3]
    ds_read_b64_tr_b16 v[144:145], v222 offset:0
    v_mfma_f32_16x16x32_bf16 v[0:3], v[132:135], a[16:19], v[0:3]
    ds_read_b64_tr_b16 v[146:147], v222 offset:2048
    v_mfma_f32_16x16x32_bf16 v[4:7], v[128:131], a[4:7], v[4:7]
    ds_read_b64_tr_b16 v[148:149], v222 offset:8192
    v_mfma_f32_16x16x32_bf16 v[4:7], v[132:135], a[20:23], v[4:7]
    ds_read_b64_tr_b16 v[150:151], v222 offset:10240
    s_waitcnt lgkmcnt(4)
    v_mfma_f32_16x16x32_bf16 v[8:11], v[136:139], a[0:3], v[8:11]
    ds_read_b64_tr_b16 v[152:153], v223 offset:0
    v_mfma_f32_16x16x32_bf16 v[8:11], v[140:143], a[16:19], v[8:11]
    ds_read_b64_tr_b16 v[154:155], v223 offset:2048
    v_mfma_f32_16x16x32_bf16 v[12:15], v[136:139], a[4:7], v[12:15]
    ds_read_b64_tr_b16 v[156:157], v223 offset:8192
    v_mfma_f32_16x16x32_bf16 v[12:15], v[140:143], a[20:23], v[12:15]
    ds_read_b64_tr_b16 v[158:159], v223 offset:10240
    s_waitcnt lgkmcnt(4)
    v_mfma_f32_16x16x32_bf16 v[16:19], v[144:147], a[0:3], v[16:19]
    ds_read_b64_tr_b16 v[128:129], v220 offset:16384
    s_mul_i32 s33, s39, 12288
    s_add_u32 s33, s33, 0x5002000
    v_mfma_f32_16x16x32_bf16 v[16:19], v[148:151], a[16:19], v[16:19]
    ds_read_b64_tr_b16 v[130:131], v220 offset:18432
    v_mfma_f32_16x16x32_bf16 v[20:23], v[144:147], a[4:7], v[20:23]
    ds_read_b64_tr_b16 v[132:133], v220 offset:24576
    v_cvt_pk_bf16_f32 v96, v96, v97
    v_mfma_f32_16x16x32_bf16 v[20:23], v[148:151], a[20:23], v[20:23]
    ds_read_b64_tr_b16 v[134:135], v220 offset:26624
    v_cvt_pk_bf16_f32 v97, v98, v99
    s_waitcnt lgkmcnt(4)
    v_mfma_f32_16x16x32_bf16 v[24:27], v[152:155], a[0:3], v[24:27]
    ds_read_b64_tr_b16 v[136:137], v221 offset:16384
    v_cvt_pk_bf16_f32 v98, v100, v101
    v_mfma_f32_16x16x32_bf16 v[24:27], v[156:159], a[16:19], v[24:27]
    ds_read_b64_tr_b16 v[138:139], v221 offset:18432
    v_cvt_pk_bf16_f32 v99, v102, v103
    v_mfma_f32_16x16x32_bf16 v[28:31], v[152:155], a[4:7], v[28:31]
    ds_read_b64_tr_b16 v[140:141], v221 offset:24576
    v_min_u32_e64 v96, -2, v96
    v_mfma_f32_16x16x32_bf16 v[28:31], v[156:159], a[20:23], v[28:31]
    ds_read_b64_tr_b16 v[142:143], v221 offset:26624
    v_min_u32 v97, -2, v97
    s_waitcnt lgkmcnt(4)
    v_mfma_f32_16x16x32_bf16 v[0:3], v[128:131], a[32:35], v[0:3]
    ds_read_b64_tr_b16 v[144:145], v222 offset:16384
    v_min_u32_e64 v98, -2, v98
    v_mfma_f32_16x16x32_bf16 v[0:3], v[132:135], a[48:51], v[0:3]
    ds_read_b64_tr_b16 v[146:147], v222 offset:18432
    v_min_u32_e64 v99, -2, v99
    v_mfma_f32_16x16x32_bf16 v[4:7], v[128:131], a[36:39], v[4:7]
    ds_read_b64_tr_b16 v[148:149], v222 offset:24576
    buffer_store_dwordx4 v[96:99], v228, s[8:11], s33 offen offset:0 sc1
    v_mfma_f32_16x16x32_bf16 v[4:7], v[132:135], a[52:55], v[4:7]
    ds_read_b64_tr_b16 v[150:151], v222 offset:26624
    s_waitcnt lgkmcnt(4)
    v_mfma_f32_16x16x32_bf16 v[8:11], v[136:139], a[32:35], v[8:11]
    ds_read_b64_tr_b16 v[152:153], v223 offset:16384
    v_mfma_f32_16x16x32_bf16 v[8:11], v[140:143], a[48:51], v[8:11]
    ds_read_b64_tr_b16 v[154:155], v223 offset:18432
    v_mfma_f32_16x16x32_bf16 v[12:15], v[136:139], a[36:39], v[12:15]
    ds_read_b64_tr_b16 v[156:157], v223 offset:24576
    v_cvt_pk_bf16_f32 v100, v104, v105
    v_mfma_f32_16x16x32_bf16 v[12:15], v[140:143], a[52:55], v[12:15]
    ds_read_b64_tr_b16 v[158:159], v223 offset:26624
    v_cvt_pk_bf16_f32 v101, v106, v107
    s_waitcnt lgkmcnt(4)
    v_mfma_f32_16x16x32_bf16 v[16:19], v[144:147], a[32:35], v[16:19]
    ds_read_b64_tr_b16 v[128:129], v220 offset:32768
    v_cvt_pk_bf16_f32 v102, v108, v109
    v_mfma_f32_16x16x32_bf16 v[16:19], v[148:151], a[48:51], v[16:19]
    ds_read_b64_tr_b16 v[130:131], v220 offset:34816
    v_cvt_pk_bf16_f32 v103, v110, v111
    v_mfma_f32_16x16x32_bf16 v[20:23], v[144:147], a[36:39], v[20:23]
    ds_read_b64_tr_b16 v[132:133], v220 offset:40960
    v_min_u32_e64 v100, -2, v100
    v_mfma_f32_16x16x32_bf16 v[20:23], v[148:151], a[52:55], v[20:23]
    ds_read_b64_tr_b16 v[134:135], v220 offset:43008
    v_min_u32 v101, -2, v101
    s_waitcnt lgkmcnt(4)
    v_mfma_f32_16x16x32_bf16 v[24:27], v[152:155], a[32:35], v[24:27]
    ds_read_b64_tr_b16 v[136:137], v221 offset:32768
    v_min_u32_e64 v102, -2, v102
    v_mfma_f32_16x16x32_bf16 v[24:27], v[156:159], a[48:51], v[24:27]
    ds_read_b64_tr_b16 v[138:139], v221 offset:34816
    v_min_u32_e64 v103, -2, v103
    v_mfma_f32_16x16x32_bf16 v[28:31], v[152:155], a[36:39], v[28:31]
    ds_read_b64_tr_b16 v[140:141], v221 offset:40960
    buffer_store_dwordx4 v[100:103], v228, s[8:11], s33 offen offset:1024 sc1
    v_mfma_f32_16x16x32_bf16 v[28:31], v[156:159], a[52:55], v[28:31]
    ds_read_b64_tr_b16 v[142:143], v221 offset:43008
    s_waitcnt lgkmcnt(4)
    v_mfma_f32_16x16x32_bf16 v[0:3], v[128:131], a[64:67], v[0:3]
    ds_read_b64_tr_b16 v[144:145], v222 offset:32768
    v_mfma_f32_16x16x32_bf16 v[0:3], v[132:135], a[80:83], v[0:3]
    ds_read_b64_tr_b16 v[146:147], v222 offset:34816
    v_mfma_f32_16x16x32_bf16 v[4:7], v[128:131], a[68:71], v[4:7]
    ds_read_b64_tr_b16 v[148:149], v222 offset:40960
    v_cvt_pk_bf16_f32 v104, v112, v113
    v_mfma_f32_16x16x32_bf16 v[4:7], v[132:135], a[84:87], v[4:7]
    ds_read_b64_tr_b16 v[150:151], v222 offset:43008
    v_cvt_pk_bf16_f32 v105, v114, v115
    s_waitcnt lgkmcnt(4)
    v_mfma_f32_16x16x32_bf16 v[8:11], v[136:139], a[64:67], v[8:11]
    ds_read_b64_tr_b16 v[152:153], v223 offset:32768
    v_cvt_pk_bf16_f32 v106, v116, v117
    v_mfma_f32_16x16x32_bf16 v[8:11], v[140:143], a[80:83], v[8:11]
    ds_read_b64_tr_b16 v[154:155], v223 offset:34816
    v_cvt_pk_bf16_f32 v107, v118, v119
    v_mfma_f32_16x16x32_bf16 v[12:15], v[136:139], a[68:71], v[12:15]
    ds_read_b64_tr_b16 v[156:157], v223 offset:40960
    v_min_u32_e64 v104, -2, v104
    v_mfma_f32_16x16x32_bf16 v[12:15], v[140:143], a[84:87], v[12:15]
    ds_read_b64_tr_b16 v[158:159], v223 offset:43008
    v_min_u32 v105, -2, v105
    s_waitcnt lgkmcnt(4)
    v_mfma_f32_16x16x32_bf16 v[16:19], v[144:147], a[64:67], v[16:19]
    ds_read_b64_tr_b16 v[128:129], v220 offset:49152
    v_min_u32_e64 v106, -2, v106
    v_mfma_f32_16x16x32_bf16 v[16:19], v[148:151], a[80:83], v[16:19]
    ds_read_b64_tr_b16 v[130:131], v220 offset:51200
    v_min_u32_e64 v107, -2, v107
    v_mfma_f32_16x16x32_bf16 v[20:23], v[144:147], a[68:71], v[20:23]
    ds_read_b64_tr_b16 v[132:133], v220 offset:57344
    buffer_store_dwordx4 v[104:107], v228, s[8:11], s33 offen offset:2048 sc1
    v_mfma_f32_16x16x32_bf16 v[20:23], v[148:151], a[84:87], v[20:23]
    ds_read_b64_tr_b16 v[134:135], v220 offset:59392
    s_waitcnt lgkmcnt(4)
    v_mfma_f32_16x16x32_bf16 v[24:27], v[152:155], a[64:67], v[24:27]
    ds_read_b64_tr_b16 v[136:137], v221 offset:49152
    v_mfma_f32_16x16x32_bf16 v[24:27], v[156:159], a[80:83], v[24:27]
    ds_read_b64_tr_b16 v[138:139], v221 offset:51200
    v_mfma_f32_16x16x32_bf16 v[28:31], v[152:155], a[68:71], v[28:31]
    ds_read_b64_tr_b16 v[140:141], v221 offset:57344
    v_cvt_pk_bf16_f32 v108, v120, v121
    v_mfma_f32_16x16x32_bf16 v[28:31], v[156:159], a[84:87], v[28:31]
    ds_read_b64_tr_b16 v[142:143], v221 offset:59392
    v_cvt_pk_bf16_f32 v109, v122, v123
    s_waitcnt lgkmcnt(4)
    v_mfma_f32_16x16x32_bf16 v[0:3], v[128:131], a[96:99], v[0:3]
    ds_read_b64_tr_b16 v[144:145], v222 offset:49152
    v_cvt_pk_bf16_f32 v110, v124, v125
    v_mfma_f32_16x16x32_bf16 v[0:3], v[132:135], a[112:115], v[0:3]
    ds_read_b64_tr_b16 v[146:147], v222 offset:51200
    v_cvt_pk_bf16_f32 v111, v126, v127
    v_mfma_f32_16x16x32_bf16 v[4:7], v[128:131], a[100:103], v[4:7]
    ds_read_b64_tr_b16 v[148:149], v222 offset:57344
    v_min_u32_e64 v108, -2, v108
    v_mfma_f32_16x16x32_bf16 v[4:7], v[132:135], a[116:119], v[4:7]
    ds_read_b64_tr_b16 v[150:151], v222 offset:59392
    v_min_u32 v109, -2, v109
    s_waitcnt lgkmcnt(4)
    v_mfma_f32_16x16x32_bf16 v[8:11], v[136:139], a[96:99], v[8:11]
    ds_read_b64_tr_b16 v[152:153], v223 offset:49152
    v_min_u32_e64 v110, -2, v110
    v_mfma_f32_16x16x32_bf16 v[8:11], v[140:143], a[112:115], v[8:11]
    ds_read_b64_tr_b16 v[154:155], v223 offset:51200
    v_min_u32_e64 v111, -2, v111
    v_mfma_f32_16x16x32_bf16 v[12:15], v[136:139], a[100:103], v[12:15]
    ds_read_b64_tr_b16 v[156:157], v223 offset:57344
    buffer_store_dwordx4 v[108:111], v228, s[8:11], s33 offen offset:3072 sc1
    v_mfma_f32_16x16x32_bf16 v[12:15], v[140:143], a[116:119], v[12:15]
    ds_read_b64_tr_b16 v[158:159], v223 offset:59392
    s_waitcnt lgkmcnt(4)
    v_mfma_f32_16x16x32_bf16 v[16:19], v[144:147], a[96:99], v[16:19]
    v_xor_b32 v216, 0x10000, v216
    ds_read_b64_tr_b16 v[128:129], v216 offset:0
    v_mfma_f32_16x16x32_bf16 v[16:19], v[148:151], a[112:115], v[16:19]
    ds_read_b64_tr_b16 v[130:131], v216 offset:2048
    v_mfma_f32_16x16x32_bf16 v[20:23], v[144:147], a[100:103], v[20:23]
    ds_read_b64_tr_b16 v[132:133], v216 offset:8192
    v_mfma_f32_16x16x32_bf16 v[20:23], v[148:151], a[116:119], v[20:23]
    ds_read_b64_tr_b16 v[134:135], v216 offset:10240
    s_waitcnt lgkmcnt(4)
    v_mfma_f32_16x16x32_bf16 v[24:27], v[152:155], a[96:99], v[24:27]
    v_xor_b32 v217, 0x10000, v217
    ds_read_b64_tr_b16 v[136:137], v217 offset:0
    v_mfma_f32_16x16x32_bf16 v[24:27], v[156:159], a[112:115], v[24:27]
    ds_read_b64_tr_b16 v[138:139], v217 offset:2048
    v_mfma_f32_16x16x32_bf16 v[28:31], v[152:155], a[100:103], v[28:31]
    ds_read_b64_tr_b16 v[140:141], v217 offset:8192
    v_mfma_f32_16x16x32_bf16 v[28:31], v[156:159], a[116:119], v[28:31]
    ds_read_b64_tr_b16 v[142:143], v217 offset:10240
    s_waitcnt lgkmcnt(4)
    v_mfma_f32_16x16x32_bf16 v[64:67], v[128:131], a[8:11], v[64:67]
    v_xor_b32 v218, 0x10000, v218
    ds_read_b64_tr_b16 v[144:145], v218 offset:0
    v_mfma_f32_16x16x32_bf16 v[64:67], v[132:135], a[24:27], v[64:67]
    ds_read_b64_tr_b16 v[146:147], v218 offset:2048
    v_mfma_f32_16x16x32_bf16 v[68:71], v[128:131], a[12:15], v[68:71]
    ds_read_b64_tr_b16 v[148:149], v218 offset:8192
    v_mfma_f32_16x16x32_bf16 v[68:71], v[132:135], a[28:31], v[68:71]
    ds_read_b64_tr_b16 v[150:151], v218 offset:10240
    s_waitcnt lgkmcnt(4)
    v_mfma_f32_16x16x32_bf16 v[72:75], v[136:139], a[8:11], v[72:75]
    v_xor_b32 v219, 0x10000, v219
    ds_read_b64_tr_b16 v[152:153], v219 offset:0
    v_mfma_f32_16x16x32_bf16 v[72:75], v[140:143], a[24:27], v[72:75]
    ds_read_b64_tr_b16 v[154:155], v219 offset:2048
    v_mfma_f32_16x16x32_bf16 v[76:79], v[136:139], a[12:15], v[76:79]
    ds_read_b64_tr_b16 v[156:157], v219 offset:8192
    v_mfma_f32_16x16x32_bf16 v[76:79], v[140:143], a[28:31], v[76:79]
    ds_read_b64_tr_b16 v[158:159], v219 offset:10240
    s_waitcnt lgkmcnt(4)
    v_mfma_f32_16x16x32_bf16 v[80:83], v[144:147], a[8:11], v[80:83]
    ds_read_b64_tr_b16 v[128:129], v216 offset:16384
    s_mul_i32 s33, s39, 12288
    s_add_u32 s33, s33, 0x5000000
    v_mfma_f32_16x16x32_bf16 v[80:83], v[148:151], a[24:27], v[80:83]
    ds_read_b64_tr_b16 v[130:131], v216 offset:18432
    v_mfma_f32_16x16x32_bf16 v[84:87], v[144:147], a[12:15], v[84:87]
    ds_read_b64_tr_b16 v[132:133], v216 offset:24576
    v_cvt_pk_bf16_f32 v0, v0, v1
    v_mfma_f32_16x16x32_bf16 v[84:87], v[148:151], a[28:31], v[84:87]
    ds_read_b64_tr_b16 v[134:135], v216 offset:26624
    v_cvt_pk_bf16_f32 v1, v2, v3
    s_waitcnt lgkmcnt(4)
    v_mfma_f32_16x16x32_bf16 v[88:91], v[152:155], a[8:11], v[88:91]
    ds_read_b64_tr_b16 v[136:137], v217 offset:16384
    v_cvt_pk_bf16_f32 v2, v4, v5
    v_mfma_f32_16x16x32_bf16 v[88:91], v[156:159], a[24:27], v[88:91]
    ds_read_b64_tr_b16 v[138:139], v217 offset:18432
    v_cvt_pk_bf16_f32 v3, v6, v7
    v_mfma_f32_16x16x32_bf16 v[92:95], v[152:155], a[12:15], v[92:95]
    ds_read_b64_tr_b16 v[140:141], v217 offset:24576
    v_min_u32_e64 v0, -2, v0
    v_mfma_f32_16x16x32_bf16 v[92:95], v[156:159], a[28:31], v[92:95]
    ds_read_b64_tr_b16 v[142:143], v217 offset:26624
    v_min_u32 v1, -2, v1
    s_waitcnt lgkmcnt(4)
    v_mfma_f32_16x16x32_bf16 v[64:67], v[128:131], a[40:43], v[64:67]
    ds_read_b64_tr_b16 v[144:145], v218 offset:16384
    v_min_u32_e64 v2, -2, v2
    v_mfma_f32_16x16x32_bf16 v[64:67], v[132:135], a[56:59], v[64:67]
    ds_read_b64_tr_b16 v[146:147], v218 offset:18432
    v_min_u32_e64 v3, -2, v3
    v_mfma_f32_16x16x32_bf16 v[68:71], v[128:131], a[44:47], v[68:71]
    ds_read_b64_tr_b16 v[148:149], v218 offset:24576
    buffer_store_dwordx4 v[0:3], v228, s[8:11], s33 offen offset:0 sc1
    v_mfma_f32_16x16x32_bf16 v[68:71], v[132:135], a[60:63], v[68:71]
    ds_read_b64_tr_b16 v[150:151], v218 offset:26624
    s_waitcnt lgkmcnt(4)
    v_mfma_f32_16x16x32_bf16 v[72:75], v[136:139], a[40:43], v[72:75]
    ds_read_b64_tr_b16 v[152:153], v219 offset:16384
    v_mfma_f32_16x16x32_bf16 v[72:75], v[140:143], a[56:59], v[72:75]
    ds_read_b64_tr_b16 v[154:155], v219 offset:18432
    v_mfma_f32_16x16x32_bf16 v[76:79], v[136:139], a[44:47], v[76:79]
    ds_read_b64_tr_b16 v[156:157], v219 offset:24576
    v_cvt_pk_bf16_f32 v4, v8, v9
    v_mfma_f32_16x16x32_bf16 v[76:79], v[140:143], a[60:63], v[76:79]
    ds_read_b64_tr_b16 v[158:159], v219 offset:26624
    v_cvt_pk_bf16_f32 v5, v10, v11
    s_waitcnt lgkmcnt(4)
    v_mfma_f32_16x16x32_bf16 v[80:83], v[144:147], a[40:43], v[80:83]
    ds_read_b64_tr_b16 v[128:129], v216 offset:32768
    v_cvt_pk_bf16_f32 v6, v12, v13
    v_mfma_f32_16x16x32_bf16 v[80:83], v[148:151], a[56:59], v[80:83]
    ds_read_b64_tr_b16 v[130:131], v216 offset:34816
    v_cvt_pk_bf16_f32 v7, v14, v15
    v_mfma_f32_16x16x32_bf16 v[84:87], v[144:147], a[44:47], v[84:87]
    ds_read_b64_tr_b16 v[132:133], v216 offset:40960
    v_min_u32_e64 v4, -2, v4
    v_mfma_f32_16x16x32_bf16 v[84:87], v[148:151], a[60:63], v[84:87]
    ds_read_b64_tr_b16 v[134:135], v216 offset:43008
    v_min_u32 v5, -2, v5
    s_waitcnt lgkmcnt(4)
    v_mfma_f32_16x16x32_bf16 v[88:91], v[152:155], a[40:43], v[88:91]
    ds_read_b64_tr_b16 v[136:137], v217 offset:32768
    v_min_u32_e64 v6, -2, v6
    v_mfma_f32_16x16x32_bf16 v[88:91], v[156:159], a[56:59], v[88:91]
    ds_read_b64_tr_b16 v[138:139], v217 offset:34816
    v_min_u32_e64 v7, -2, v7
    v_mfma_f32_16x16x32_bf16 v[92:95], v[152:155], a[44:47], v[92:95]
    ds_read_b64_tr_b16 v[140:141], v217 offset:40960
    buffer_store_dwordx4 v[4:7], v228, s[8:11], s33 offen offset:1024 sc1
    v_mfma_f32_16x16x32_bf16 v[92:95], v[156:159], a[60:63], v[92:95]
    ds_read_b64_tr_b16 v[142:143], v217 offset:43008
    s_waitcnt lgkmcnt(4)
    v_mfma_f32_16x16x32_bf16 v[64:67], v[128:131], a[72:75], v[64:67]
    ds_read_b64_tr_b16 v[144:145], v218 offset:32768
    v_mfma_f32_16x16x32_bf16 v[64:67], v[132:135], a[88:91], v[64:67]
    ds_read_b64_tr_b16 v[146:147], v218 offset:34816
    v_mfma_f32_16x16x32_bf16 v[68:71], v[128:131], a[76:79], v[68:71]
    ds_read_b64_tr_b16 v[148:149], v218 offset:40960
    v_cvt_pk_bf16_f32 v8, v16, v17
    v_mfma_f32_16x16x32_bf16 v[68:71], v[132:135], a[92:95], v[68:71]
    ds_read_b64_tr_b16 v[150:151], v218 offset:43008
    v_cvt_pk_bf16_f32 v9, v18, v19
    s_waitcnt lgkmcnt(4)
    v_mfma_f32_16x16x32_bf16 v[72:75], v[136:139], a[72:75], v[72:75]
    ds_read_b64_tr_b16 v[152:153], v219 offset:32768
    v_cvt_pk_bf16_f32 v10, v20, v21
    v_mfma_f32_16x16x32_bf16 v[72:75], v[140:143], a[88:91], v[72:75]
    ds_read_b64_tr_b16 v[154:155], v219 offset:34816
    v_cvt_pk_bf16_f32 v11, v22, v23
    v_mfma_f32_16x16x32_bf16 v[76:79], v[136:139], a[76:79], v[76:79]
    ds_read_b64_tr_b16 v[156:157], v219 offset:40960
    v_min_u32_e64 v8, -2, v8
    v_mfma_f32_16x16x32_bf16 v[76:79], v[140:143], a[92:95], v[76:79]
    ds_read_b64_tr_b16 v[158:159], v219 offset:43008
    v_min_u32 v9, -2, v9
    s_waitcnt lgkmcnt(4)
    v_mfma_f32_16x16x32_bf16 v[80:83], v[144:147], a[72:75], v[80:83]
    ds_read_b64_tr_b16 v[128:129], v216 offset:49152
    v_min_u32_e64 v10, -2, v10
    v_mfma_f32_16x16x32_bf16 v[80:83], v[148:151], a[88:91], v[80:83]
    ds_read_b64_tr_b16 v[130:131], v216 offset:51200
    v_min_u32_e64 v11, -2, v11
    v_mfma_f32_16x16x32_bf16 v[84:87], v[144:147], a[76:79], v[84:87]
    ds_read_b64_tr_b16 v[132:133], v216 offset:57344
    buffer_store_dwordx4 v[8:11], v228, s[8:11], s33 offen offset:2048 sc1
    v_mfma_f32_16x16x32_bf16 v[84:87], v[148:151], a[92:95], v[84:87]
    ds_read_b64_tr_b16 v[134:135], v216 offset:59392
    s_waitcnt lgkmcnt(4)
    v_mfma_f32_16x16x32_bf16 v[88:91], v[152:155], a[72:75], v[88:91]
    ds_read_b64_tr_b16 v[136:137], v217 offset:49152
    v_mfma_f32_16x16x32_bf16 v[88:91], v[156:159], a[88:91], v[88:91]
    ds_read_b64_tr_b16 v[138:139], v217 offset:51200
    v_mfma_f32_16x16x32_bf16 v[92:95], v[152:155], a[76:79], v[92:95]
    ds_read_b64_tr_b16 v[140:141], v217 offset:57344
    v_cvt_pk_bf16_f32 v12, v24, v25
    v_mfma_f32_16x16x32_bf16 v[92:95], v[156:159], a[92:95], v[92:95]
    ds_read_b64_tr_b16 v[142:143], v217 offset:59392
    v_cvt_pk_bf16_f32 v13, v26, v27
    s_waitcnt lgkmcnt(4)
    v_mfma_f32_16x16x32_bf16 v[64:67], v[128:131], a[104:107], v[64:67]
    ds_read_b64_tr_b16 v[144:145], v218 offset:49152
    v_cvt_pk_bf16_f32 v14, v28, v29
    v_mfma_f32_16x16x32_bf16 v[64:67], v[132:135], a[120:123], v[64:67]
    ds_read_b64_tr_b16 v[146:147], v218 offset:51200
    v_cvt_pk_bf16_f32 v15, v30, v31
    v_mfma_f32_16x16x32_bf16 v[68:71], v[128:131], a[108:111], v[68:71]
    ds_read_b64_tr_b16 v[148:149], v218 offset:57344
    v_min_u32_e64 v12, -2, v12
    v_mfma_f32_16x16x32_bf16 v[68:71], v[132:135], a[124:127], v[68:71]
    ds_read_b64_tr_b16 v[150:151], v218 offset:59392
    v_min_u32 v13, -2, v13
    s_waitcnt lgkmcnt(4)
    v_mfma_f32_16x16x32_bf16 v[72:75], v[136:139], a[104:107], v[72:75]
    ds_read_b64_tr_b16 v[152:153], v219 offset:49152
    v_min_u32_e64 v14, -2, v14
    v_mfma_f32_16x16x32_bf16 v[72:75], v[140:143], a[120:123], v[72:75]
    ds_read_b64_tr_b16 v[154:155], v219 offset:51200
    v_min_u32_e64 v15, -2, v15
    v_mfma_f32_16x16x32_bf16 v[76:79], v[136:139], a[108:111], v[76:79]
    ds_read_b64_tr_b16 v[156:157], v219 offset:57344
    buffer_store_dwordx4 v[12:15], v228, s[8:11], s33 offen offset:3072 sc1
    v_mfma_f32_16x16x32_bf16 v[76:79], v[140:143], a[124:127], v[76:79]
    ds_read_b64_tr_b16 v[158:159], v219 offset:59392
    s_waitcnt lgkmcnt(4)
    v_mfma_f32_16x16x32_bf16 v[80:83], v[144:147], a[104:107], v[80:83]
    ds_read_b64_tr_b16 v[128:129], v216 offset:0
    v_mfma_f32_16x16x32_bf16 v[80:83], v[148:151], a[120:123], v[80:83]
    ds_read_b64_tr_b16 v[130:131], v216 offset:2048
    v_mfma_f32_16x16x32_bf16 v[84:87], v[144:147], a[108:111], v[84:87]
    ds_read_b64_tr_b16 v[132:133], v216 offset:8192
    v_mfma_f32_16x16x32_bf16 v[84:87], v[148:151], a[124:127], v[84:87]
    ds_read_b64_tr_b16 v[134:135], v216 offset:10240
    s_waitcnt lgkmcnt(4)
    v_mfma_f32_16x16x32_bf16 v[88:91], v[152:155], a[104:107], v[88:91]
    ds_read_b64_tr_b16 v[136:137], v217 offset:0
    v_mfma_f32_16x16x32_bf16 v[88:91], v[156:159], a[120:123], v[88:91]
    ds_read_b64_tr_b16 v[138:139], v217 offset:2048
    v_mfma_f32_16x16x32_bf16 v[92:95], v[152:155], a[108:111], v[92:95]
    ds_read_b64_tr_b16 v[140:141], v217 offset:8192
    v_mfma_f32_16x16x32_bf16 v[92:95], v[156:159], a[124:127], v[92:95]
    ds_read_b64_tr_b16 v[142:143], v217 offset:10240
    s_waitcnt lgkmcnt(4)
    v_mfma_f32_16x16x32_bf16 v[32:35], v[128:131], a[0:3], v[32:35]
    ds_read_b64_tr_b16 v[144:145], v218 offset:0
    v_mfma_f32_16x16x32_bf16 v[32:35], v[132:135], a[16:19], v[32:35]
    ds_read_b64_tr_b16 v[146:147], v218 offset:2048
    buffer_load_dwordx4 v[176:179], v228, s[8:11], s7 offen offset:0 sc1
    v_mfma_f32_16x16x32_bf16 v[36:39], v[128:131], a[4:7], v[36:39]
    ds_read_b64_tr_b16 v[148:149], v218 offset:8192
    v_mfma_f32_16x16x32_bf16 v[36:39], v[132:135], a[20:23], v[36:39]
    ds_read_b64_tr_b16 v[150:151], v218 offset:10240
    buffer_load_dwordx4 v[180:183], v228, s[8:11], s7 offen offset:1024 sc1
    s_waitcnt lgkmcnt(4)
    v_mfma_f32_16x16x32_bf16 v[40:43], v[136:139], a[0:3], v[40:43]
    ds_read_b64_tr_b16 v[152:153], v219 offset:0
    v_mfma_f32_16x16x32_bf16 v[40:43], v[140:143], a[16:19], v[40:43]
    ds_read_b64_tr_b16 v[154:155], v219 offset:2048
    buffer_load_dwordx4 v[184:187], v228, s[8:11], s7 offen offset:2048 sc1
    v_mfma_f32_16x16x32_bf16 v[44:47], v[136:139], a[4:7], v[44:47]
    ds_read_b64_tr_b16 v[156:157], v219 offset:8192
    v_mfma_f32_16x16x32_bf16 v[44:47], v[140:143], a[20:23], v[44:47]
    ds_read_b64_tr_b16 v[158:159], v219 offset:10240
    buffer_load_dwordx4 v[188:191], v228, s[8:11], s7 offen offset:3072 sc1
    s_waitcnt lgkmcnt(4)
    v_mfma_f32_16x16x32_bf16 v[48:51], v[144:147], a[0:3], v[48:51]
    ds_read_b64_tr_b16 v[128:129], v216 offset:16384
    s_mul_i32 s33, s39, 12288
    s_add_u32 s33, s33, 0x5001000
    v_mfma_f32_16x16x32_bf16 v[48:51], v[148:151], a[16:19], v[48:51]
    ds_read_b64_tr_b16 v[130:131], v216 offset:18432
    v_mfma_f32_16x16x32_bf16 v[52:55], v[144:147], a[4:7], v[52:55]
    ds_read_b64_tr_b16 v[132:133], v216 offset:24576
    v_cvt_pk_bf16_f32 v64, v64, v65
    v_mfma_f32_16x16x32_bf16 v[52:55], v[148:151], a[20:23], v[52:55]
    ds_read_b64_tr_b16 v[134:135], v216 offset:26624
    v_cvt_pk_bf16_f32 v65, v66, v67
    s_waitcnt lgkmcnt(4)
    v_mfma_f32_16x16x32_bf16 v[56:59], v[152:155], a[0:3], v[56:59]
    ds_read_b64_tr_b16 v[136:137], v217 offset:16384
    v_cvt_pk_bf16_f32 v66, v68, v69
    v_mfma_f32_16x16x32_bf16 v[56:59], v[156:159], a[16:19], v[56:59]
    ds_read_b64_tr_b16 v[138:139], v217 offset:18432
    v_cvt_pk_bf16_f32 v67, v70, v71
    v_mfma_f32_16x16x32_bf16 v[60:63], v[152:155], a[4:7], v[60:63]
    ds_read_b64_tr_b16 v[140:141], v217 offset:24576
    v_min_u32_e64 v64, -2, v64
    v_mfma_f32_16x16x32_bf16 v[60:63], v[156:159], a[20:23], v[60:63]
    ds_read_b64_tr_b16 v[142:143], v217 offset:26624
    v_min_u32 v65, -2, v65
    s_waitcnt lgkmcnt(4)
    v_mfma_f32_16x16x32_bf16 v[32:35], v[128:131], a[32:35], v[32:35]
    ds_read_b64_tr_b16 v[144:145], v218 offset:16384
    v_min_u32_e64 v66, -2, v66
    v_mfma_f32_16x16x32_bf16 v[32:35], v[132:135], a[48:51], v[32:35]
    ds_read_b64_tr_b16 v[146:147], v218 offset:18432
    v_min_u32_e64 v67, -2, v67
    v_mfma_f32_16x16x32_bf16 v[36:39], v[128:131], a[36:39], v[36:39]
    ds_read_b64_tr_b16 v[148:149], v218 offset:24576
    buffer_store_dwordx4 v[64:67], v228, s[8:11], s33 offen offset:0 sc1
    v_mfma_f32_16x16x32_bf16 v[36:39], v[132:135], a[52:55], v[36:39]
    ds_read_b64_tr_b16 v[150:151], v218 offset:26624
    s_waitcnt lgkmcnt(4)
    v_mfma_f32_16x16x32_bf16 v[40:43], v[136:139], a[32:35], v[40:43]
    ds_read_b64_tr_b16 v[152:153], v219 offset:16384
    v_mfma_f32_16x16x32_bf16 v[40:43], v[140:143], a[48:51], v[40:43]
    ds_read_b64_tr_b16 v[154:155], v219 offset:18432
    v_mfma_f32_16x16x32_bf16 v[44:47], v[136:139], a[36:39], v[44:47]
    ds_read_b64_tr_b16 v[156:157], v219 offset:24576
    v_cvt_pk_bf16_f32 v68, v72, v73
    v_mfma_f32_16x16x32_bf16 v[44:47], v[140:143], a[52:55], v[44:47]
    ds_read_b64_tr_b16 v[158:159], v219 offset:26624
    v_cvt_pk_bf16_f32 v69, v74, v75
    s_waitcnt lgkmcnt(4)
    v_mfma_f32_16x16x32_bf16 v[48:51], v[144:147], a[32:35], v[48:51]
    ds_read_b64_tr_b16 v[128:129], v216 offset:32768
    v_cvt_pk_bf16_f32 v70, v76, v77
    v_mfma_f32_16x16x32_bf16 v[48:51], v[148:151], a[48:51], v[48:51]
    ds_read_b64_tr_b16 v[130:131], v216 offset:34816
    v_cvt_pk_bf16_f32 v71, v78, v79
    v_mfma_f32_16x16x32_bf16 v[52:55], v[144:147], a[36:39], v[52:55]
    ds_read_b64_tr_b16 v[132:133], v216 offset:40960
    v_min_u32_e64 v68, -2, v68
    v_mfma_f32_16x16x32_bf16 v[52:55], v[148:151], a[52:55], v[52:55]
    ds_read_b64_tr_b16 v[134:135], v216 offset:43008
    v_min_u32 v69, -2, v69
    s_waitcnt lgkmcnt(4)
    v_mfma_f32_16x16x32_bf16 v[56:59], v[152:155], a[32:35], v[56:59]
    ds_read_b64_tr_b16 v[136:137], v217 offset:32768
    v_min_u32_e64 v70, -2, v70
    v_mfma_f32_16x16x32_bf16 v[56:59], v[156:159], a[48:51], v[56:59]
    ds_read_b64_tr_b16 v[138:139], v217 offset:34816
    v_min_u32_e64 v71, -2, v71
    v_mfma_f32_16x16x32_bf16 v[60:63], v[152:155], a[36:39], v[60:63]
    ds_read_b64_tr_b16 v[140:141], v217 offset:40960
    buffer_store_dwordx4 v[68:71], v228, s[8:11], s33 offen offset:1024 sc1
    v_mfma_f32_16x16x32_bf16 v[60:63], v[156:159], a[52:55], v[60:63]
    ds_read_b64_tr_b16 v[142:143], v217 offset:43008
    s_waitcnt lgkmcnt(4)
    v_mfma_f32_16x16x32_bf16 v[32:35], v[128:131], a[64:67], v[32:35]
    ds_read_b64_tr_b16 v[144:145], v218 offset:32768
    v_mfma_f32_16x16x32_bf16 v[32:35], v[132:135], a[80:83], v[32:35]
    ds_read_b64_tr_b16 v[146:147], v218 offset:34816
    v_mfma_f32_16x16x32_bf16 v[36:39], v[128:131], a[68:71], v[36:39]
    ds_read_b64_tr_b16 v[148:149], v218 offset:40960
    v_cvt_pk_bf16_f32 v72, v80, v81
    v_mfma_f32_16x16x32_bf16 v[36:39], v[132:135], a[84:87], v[36:39]
    ds_read_b64_tr_b16 v[150:151], v218 offset:43008
    v_cvt_pk_bf16_f32 v73, v82, v83
    s_waitcnt lgkmcnt(4)
    v_mfma_f32_16x16x32_bf16 v[40:43], v[136:139], a[64:67], v[40:43]
    ds_read_b64_tr_b16 v[152:153], v219 offset:32768
    v_cvt_pk_bf16_f32 v74, v84, v85
    v_mfma_f32_16x16x32_bf16 v[40:43], v[140:143], a[80:83], v[40:43]
    ds_read_b64_tr_b16 v[154:155], v219 offset:34816
    v_cvt_pk_bf16_f32 v75, v86, v87
    v_mfma_f32_16x16x32_bf16 v[44:47], v[136:139], a[68:71], v[44:47]
    ds_read_b64_tr_b16 v[156:157], v219 offset:40960
    v_min_u32_e64 v72, -2, v72
    v_mfma_f32_16x16x32_bf16 v[44:47], v[140:143], a[84:87], v[44:47]
    ds_read_b64_tr_b16 v[158:159], v219 offset:43008
    v_min_u32 v73, -2, v73
    s_waitcnt lgkmcnt(4)
    v_mfma_f32_16x16x32_bf16 v[48:51], v[144:147], a[64:67], v[48:51]
    ds_read_b64_tr_b16 v[128:129], v216 offset:49152
    v_min_u32_e64 v74, -2, v74
    v_mfma_f32_16x16x32_bf16 v[48:51], v[148:151], a[80:83], v[48:51]
    ds_read_b64_tr_b16 v[130:131], v216 offset:51200
    v_min_u32_e64 v75, -2, v75
    v_mfma_f32_16x16x32_bf16 v[52:55], v[144:147], a[68:71], v[52:55]
    ds_read_b64_tr_b16 v[132:133], v216 offset:57344
    buffer_store_dwordx4 v[72:75], v228, s[8:11], s33 offen offset:2048 sc1
    v_mfma_f32_16x16x32_bf16 v[52:55], v[148:151], a[84:87], v[52:55]
    ds_read_b64_tr_b16 v[134:135], v216 offset:59392
    s_waitcnt lgkmcnt(4)
    v_mfma_f32_16x16x32_bf16 v[56:59], v[152:155], a[64:67], v[56:59]
    ds_read_b64_tr_b16 v[136:137], v217 offset:49152
    v_mfma_f32_16x16x32_bf16 v[56:59], v[156:159], a[80:83], v[56:59]
    ds_read_b64_tr_b16 v[138:139], v217 offset:51200
    v_mfma_f32_16x16x32_bf16 v[60:63], v[152:155], a[68:71], v[60:63]
    ds_read_b64_tr_b16 v[140:141], v217 offset:57344
    v_cvt_pk_bf16_f32 v76, v88, v89
    v_mfma_f32_16x16x32_bf16 v[60:63], v[156:159], a[84:87], v[60:63]
    ds_read_b64_tr_b16 v[142:143], v217 offset:59392
    v_cvt_pk_bf16_f32 v77, v90, v91
    s_waitcnt lgkmcnt(4)
    v_mfma_f32_16x16x32_bf16 v[32:35], v[128:131], a[96:99], v[32:35]
    ds_read_b64_tr_b16 v[144:145], v218 offset:49152
    v_cvt_pk_bf16_f32 v78, v92, v93
    v_mfma_f32_16x16x32_bf16 v[32:35], v[132:135], a[112:115], v[32:35]
    ds_read_b64_tr_b16 v[146:147], v218 offset:51200
    v_cvt_pk_bf16_f32 v79, v94, v95
    v_mfma_f32_16x16x32_bf16 v[36:39], v[128:131], a[100:103], v[36:39]
    ds_read_b64_tr_b16 v[148:149], v218 offset:57344
    v_min_u32_e64 v76, -2, v76
    v_mfma_f32_16x16x32_bf16 v[36:39], v[132:135], a[116:119], v[36:39]
    ds_read_b64_tr_b16 v[150:151], v218 offset:59392
    v_min_u32 v77, -2, v77
    s_waitcnt lgkmcnt(4)
    v_mfma_f32_16x16x32_bf16 v[40:43], v[136:139], a[96:99], v[40:43]
    ds_read_b64_tr_b16 v[152:153], v219 offset:49152
    v_min_u32_e64 v78, -2, v78
    v_mfma_f32_16x16x32_bf16 v[40:43], v[140:143], a[112:115], v[40:43]
    ds_read_b64_tr_b16 v[154:155], v219 offset:51200
    v_min_u32_e64 v79, -2, v79
    v_mfma_f32_16x16x32_bf16 v[44:47], v[136:139], a[100:103], v[44:47]
    ds_read_b64_tr_b16 v[156:157], v219 offset:57344
    buffer_store_dwordx4 v[76:79], v228, s[8:11], s33 offen offset:3072 sc1
    v_mfma_f32_16x16x32_bf16 v[44:47], v[140:143], a[116:119], v[44:47]
    ds_read_b64_tr_b16 v[158:159], v219 offset:59392
    s_waitcnt lgkmcnt(4)
    v_mfma_f32_16x16x32_bf16 v[48:51], v[144:147], a[96:99], v[48:51]
    buffer_load_dwordx4 v[96:99], v228, s[8:11], s37 offen offset:0 sc1
    v_mfma_f32_16x16x32_bf16 v[48:51], v[148:151], a[112:115], v[48:51]
    v_mfma_f32_16x16x32_bf16 v[52:55], v[144:147], a[100:103], v[52:55]
    buffer_load_dwordx4 v[100:103], v228, s[8:11], s37 offen offset:1024 sc1
    v_mfma_f32_16x16x32_bf16 v[52:55], v[148:151], a[116:119], v[52:55]
    s_waitcnt lgkmcnt(0)
    v_mfma_f32_16x16x32_bf16 v[56:59], v[152:155], a[96:99], v[56:59]
    buffer_load_dwordx4 v[104:107], v228, s[8:11], s37 offen offset:2048 sc1
    v_mfma_f32_16x16x32_bf16 v[56:59], v[156:159], a[112:115], v[56:59]
    v_mfma_f32_16x16x32_bf16 v[60:63], v[152:155], a[100:103], v[60:63]
    buffer_load_dwordx4 v[108:111], v228, s[8:11], s37 offen offset:3072 sc1
    v_mfma_f32_16x16x32_bf16 v[60:63], v[156:159], a[116:119], v[60:63]
kc_tail:
    buffer_load_dwordx4 v[160:163], v228, s[8:11], s38 offen offset:0 sc1
    buffer_load_dwordx4 v[164:167], v228, s[8:11], s38 offen offset:1024 sc1
    buffer_load_dwordx4 v[168:171], v228, s[8:11], s38 offen offset:2048 sc1
    buffer_load_dwordx4 v[172:175], v228, s[8:11], s38 offen offset:3072 sc1
    v_lshlrev_b32_e64 v128, 16, v192
    v_and_b32 v129, 0xffff0000, v192
    v_lshlrev_b32_e64 v130, 16, v193
    v_and_b32 v131, 0xffff0000, v193
    v_lshlrev_b32_e64 v132, 16, v194
    v_and_b32 v133, 0xffff0000, v194
    v_lshlrev_b32_e64 v134, 16, v195
    v_and_b32 v135, 0xffff0000, v195
    v_lshlrev_b32_e64 v136, 16, v196
    v_and_b32 v137, 0xffff0000, v196
    v_lshlrev_b32_e64 v138, 16, v197
    v_and_b32 v139, 0xffff0000, v197
    v_lshlrev_b32_e64 v140, 16, v198
    v_and_b32 v141, 0xffff0000, v198
    v_lshlrev_b32_e64 v142, 16, v199
    v_and_b32 v143, 0xffff0000, v199
    v_lshlrev_b32_e64 v144, 16, v200
    v_and_b32 v145, 0xffff0000, v200
    v_lshlrev_b32_e64 v146, 16, v201
    v_and_b32 v147, 0xffff0000, v201
    v_lshlrev_b32_e64 v148, 16, v202
    v_and_b32 v149, 0xffff0000, v202
    v_lshlrev_b32_e64 v150, 16, v203
    v_and_b32 v151, 0xffff0000, v203
    v_lshlrev_b32_e64 v152, 16, v204
    v_and_b32 v153, 0xffff0000, v204
    v_lshlrev_b32_e64 v154, 16, v205
    v_and_b32 v155, 0xffff0000, v205
    v_lshlrev_b32_e64 v156, 16, v206
    v_and_b32 v157, 0xffff0000, v206
    v_lshlrev_b32_e64 v158, 16, v207
    v_and_b32 v159, 0xffff0000, v207
    v_lshlrev_b32_e64 v112, 16, v208
    v_and_b32 v113, 0xffff0000, v208
    v_lshlrev_b32_e64 v114, 16, v209
    v_and_b32 v115, 0xffff0000, v209
    v_lshlrev_b32_e64 v116, 16, v210
    v_and_b32 v117, 0xffff0000, v210
    v_lshlrev_b32_e64 v118, 16, v211
    v_and_b32 v119, 0xffff0000, v211
    v_pk_add_f32 v[120:121], v[112:113], v[114:115]
    v_pk_add_f32 v[122:123], v[116:117], v[118:119]
    v_pk_add_f32 v[120:121], v[120:121], v[122:123]
    v_add_f32_e64 v196, v120, v121
    s_barrier
    s_waitcnt vmcnt(12)
    v_max3_u32 v235, v176, v177, v178
    v_max3_u32 v235, v235, v179, v180
    v_max3_u32 v235, v235, v181, v182
    v_max3_u32 v235, v235, v183, v184
    v_max3_u32 v235, v235, v185, v186
    v_max3_u32 v235, v235, v187, v188
    v_max3_u32 v235, v235, v189, v190
    v_max_u32 v235, v235, v191
    v_cmp_eq_u32 vcc, -1, v235
    s_cbranch_vccnz kc_r3
kc_r3o:
    v_lshlrev_b32 v64, 16, v176
    v_and_b32 v65, 0xffff0000, v176
    v_lshlrev_b32_e64 v66, 16, v177
    v_and_b32 v67, 0xffff0000, v177
    v_pk_add_f32 v[32:33], v[32:33], v[64:65]
    v_pk_add_f32 v[34:35], v[34:35], v[66:67]
    v_lshlrev_b32_e64 v68, 16, v178
    v_and_b32 v69, 0xffff0000, v178
    v_lshlrev_b32_e64 v70, 16, v179
    v_and_b32 v71, 0xffff0000, v179
    v_pk_add_f32 v[36:37], v[36:37], v[68:69]
    v_pk_add_f32 v[38:39], v[38:39], v[70:71]
    v_lshlrev_b32_e64 v72, 16, v180
    v_and_b32 v73, 0xffff0000, v180
    v_lshlrev_b32_e64 v74, 16, v181
    v_and_b32 v75, 0xffff0000, v181
    v_pk_add_f32 v[40:41], v[40:41], v[72:73]
    v_pk_add_f32 v[42:43], v[42:43], v[74:75]
    v_lshlrev_b32_e64 v76, 16, v182
    v_and_b32 v77, 0xffff0000, v182
    v_lshlrev_b32_e64 v78, 16, v183
    v_and_b32 v79, 0xffff0000, v183
    v_pk_add_f32 v[44:45], v[44:45], v[76:77]
    v_pk_add_f32 v[46:47], v[46:47], v[78:79]
    v_lshlrev_b32_e64 v80, 16, v184
    v_and_b32 v81, 0xffff0000, v184
    v_lshlrev_b32_e64 v82, 16, v185
    v_and_b32 v83, 0xffff0000, v185
    v_pk_add_f32 v[48:49], v[48:49], v[80:81]
    v_pk_add_f32 v[50:51], v[50:51], v[82:83]
    v_lshlrev_b32_e64 v84, 16, v186
    v_and_b32 v85, 0xffff0000, v186
    v_lshlrev_b32_e64 v86, 16, v187
    v_and_b32 v87, 0xffff0000, v187
    v_pk_add_f32 v[52:53], v[52:53], v[84:85]
    v_pk_add_f32 v[54:55], v[54:55], v[86:87]
    v_lshlrev_b32_e64 v88, 16, v188
    v_and_b32 v89, 0xffff0000, v188
    v_lshlrev_b32_e64 v90, 16, v189
    v_and_b32 v91, 0xffff0000, v189
    v_pk_add_f32 v[56:57], v[56:57], v[88:89]
    v_pk_add_f32 v[58:59], v[58:59], v[90:91]
    v_lshlrev_b32_e64 v92, 16, v190
    v_and_b32 v93, 0xffff0000, v190
    v_lshlrev_b32_e64 v94, 16, v191
    v_and_b32 v95, 0xffff0000, v191
    v_pk_add_f32 v[60:61], v[60:61], v[92:93]
    v_pk_add_f32 v[62:63], v[62:63], v[94:95]
    s_waitcnt vmcnt(4)
    v_max3_u32 v235, v96, v97, v98
    v_max3_u32 v235, v235, v99, v100
    v_max3_u32 v235, v235, v101, v102
    v_max3_u32 v235, v235, v103, v104
    v_max3_u32 v235, v235, v105, v106
    v_max3_u32 v235, v235, v107, v108
    v_max3_u32 v235, v235, v109, v110
    v_max_u32 v235, v235, v111
    v_cmp_eq_u32 vcc, -1, v235
    s_cbranch_vccnz kc_r1
kc_r1o:
    v_lshlrev_b32_e64 v64, 16, v96
    v_and_b32 v65, 0xffff0000, v96
    v_lshlrev_b32_e64 v66, 16, v97
    v_and_b32 v67, 0xffff0000, v97
    v_pk_add_f32 v[32:33], v[32:33], v[64:65]
    v_pk_add_f32 v[34:35], v[34:35], v[66:67]
    v_lshlrev_b32_e64 v68, 16, v98
    v_and_b32 v69, 0xffff0000, v98
    v_lshlrev_b32_e64 v70, 16, v99
    v_and_b32 v71, 0xffff0000, v99
    v_pk_add_f32 v[36:37], v[36:37], v[68:69]
    v_pk_add_f32 v[38:39], v[38:39], v[70:71]
    v_lshlrev_b32_e64 v72, 16, v100
    v_and_b32 v73, 0xffff0000, v100
    v_lshlrev_b32_e64 v74, 16, v101
    v_and_b32 v75, 0xffff0000, v101
    v_pk_add_f32 v[40:41], v[40:41], v[72:73]
    v_pk_add_f32 v[42:43], v[42:43], v[74:75]
    v_lshlrev_b32_e64 v76, 16, v102
    v_and_b32 v77, 0xffff0000, v102
    v_lshlrev_b32_e64 v78, 16, v103
    v_and_b32 v79, 0xffff0000, v103
    v_pk_add_f32 v[44:45], v[44:45], v[76:77]
    v_pk_add_f32 v[46:47], v[46:47], v[78:79]
    v_lshlrev_b32_e64 v80, 16, v104
    v_and_b32 v81, 0xffff0000, v104
    v_lshlrev_b32_e64 v82, 16, v105
    v_and_b32 v83, 0xffff0000, v105
    v_pk_add_f32 v[48:49], v[48:49], v[80:81]
    v_pk_add_f32 v[50:51], v[50:51], v[82:83]
    v_lshlrev_b32_e64 v84, 16, v106
    v_and_b32 v85, 0xffff0000, v106
    v_lshlrev_b32_e64 v86, 16, v107
    v_and_b32 v87, 0xffff0000, v107
    v_pk_add_f32 v[52:53], v[52:53], v[84:85]
    v_pk_add_f32 v[54:55], v[54:55], v[86:87]
    v_lshlrev_b32_e64 v88, 16, v108
    v_and_b32 v89, 0xffff0000, v108
    v_lshlrev_b32_e64 v90, 16, v109
    v_and_b32 v91, 0xffff0000, v109
    v_pk_add_f32 v[56:57], v[56:57], v[88:89]
    v_pk_add_f32 v[58:59], v[58:59], v[90:91]
    v_lshlrev_b32_e64 v92, 16, v110
    v_and_b32 v93, 0xffff0000, v110
    v_lshlrev_b32_e64 v94, 16, v111
    v_and_b32 v95, 0xffff0000, v111
    v_pk_add_f32 v[60:61], v[60:61], v[92:93]
    v_pk_add_f32 v[62:63], v[62:63], v[94:95]
    s_waitcnt vmcnt(0)
    v_max3_u32 v235, v160, v161, v162
    v_max3_u32 v235, v235, v163, v164
    v_max3_u32 v235, v235, v165, v166
    v_max3_u32 v235, v235, v167, v168
    v_max3_u32 v235, v235, v169, v170
    v_max3_u32 v235, v235, v171, v172
    v_max3_u32 v235, v235, v173, v174
    v_max_u32 v235, v235, v175
    v_cmp_eq_u32 vcc, -1, v235
    s_cbranch_vccnz kc_r2
kc_r2o:
    v_lshlrev_b32_e64 v64, 16, v160
    v_and_b32 v65, 0xffff0000, v160
    v_lshlrev_b32_e64 v66, 16, v161
    v_and_b32 v67, 0xffff0000, v161
    v_pk_add_f32 v[32:33], v[32:33], v[64:65]
    v_pk_add_f32 v[34:35], v[34:35], v[66:67]
    v_cvt_pk_bf16_f32 v0, v32, v33
    v_cvt_pk_bf16_f32 v1, v34, v35
    ds_write_b64 v238, v[0:1] offset:0
    v_lshlrev_b32_e64 v68, 16, v162
    v_and_b32 v69, 0xffff0000, v162
    v_lshlrev_b32_e64 v70, 16, v163
    v_and_b32 v71, 0xffff0000, v163
    v_pk_add_f32 v[36:37], v[36:37], v[68:69]
    v_pk_add_f32 v[38:39], v[38:39], v[70:71]
    v_cvt_pk_bf16_f32 v2, v36, v37
    v_cvt_pk_bf16_f32 v3, v38, v39
    ds_write_b64 v238, v[2:3] offset:2304
    v_lshlrev_b32_e64 v72, 16, v164
    v_and_b32 v73, 0xffff0000, v164
    v_lshlrev_b32_e64 v74, 16, v165
    v_and_b32 v75, 0xffff0000, v165
    v_pk_add_f32 v[40:41], v[40:41], v[72:73]
    v_pk_add_f32 v[42:43], v[42:43], v[74:75]
    v_cvt_pk_bf16_f32 v4, v40, v41
    v_cvt_pk_bf16_f32 v5, v42, v43
    ds_write_b64 v238, v[4:5] offset:32
    v_lshlrev_b32_e64 v76, 16, v166
    v_and_b32 v77, 0xffff0000, v166
    v_lshlrev_b32_e64 v78, 16, v167
    v_and_b32 v79, 0xffff0000, v167
    v_pk_add_f32 v[44:45], v[44:45], v[76:77]
    v_pk_add_f32 v[46:47], v[46:47], v[78:79]
    v_cvt_pk_bf16_f32 v6, v44, v45
    v_cvt_pk_bf16_f32 v7, v46, v47
    ds_write_b64 v238, v[6:7] offset:2336
    v_lshlrev_b32_e64 v80, 16, v168
    v_and_b32 v81, 0xffff0000, v168
    v_lshlrev_b32_e64 v82, 16, v169
    v_and_b32 v83, 0xffff0000, v169
    v_pk_add_f32 v[48:49], v[48:49], v[80:81]
    v_pk_add_f32 v[50:51], v[50:51], v[82:83]
    v_cvt_pk_bf16_f32 v8, v48, v49
    v_cvt_pk_bf16_f32 v9, v50, v51
    ds_write_b64 v238, v[8:9] offset:64
    v_lshlrev_b32_e64 v84, 16, v170
    v_and_b32 v85, 0xffff0000, v170
    v_lshlrev_b32_e64 v86, 16, v171
    v_and_b32 v87, 0xffff0000, v171
    v_pk_add_f32 v[52:53], v[52:53], v[84:85]
    v_pk_add_f32 v[54:55], v[54:55], v[86:87]
    v_cvt_pk_bf16_f32 v10, v52, v53
    v_cvt_pk_bf16_f32 v11, v54, v55
    ds_write_b64 v238, v[10:11] offset:2368
    v_lshlrev_b32_e64 v88, 16, v172
    v_and_b32 v89, 0xffff0000, v172
    v_lshlrev_b32_e64 v90, 16, v173
    v_and_b32 v91, 0xffff0000, v173
    v_pk_add_f32 v[56:57], v[56:57], v[88:89]
    v_pk_add_f32 v[58:59], v[58:59], v[90:91]
    v_cvt_pk_bf16_f32 v12, v56, v57
    v_cvt_pk_bf16_f32 v13, v58, v59
    ds_write_b64 v238, v[12:13] offset:96
    v_lshlrev_b32_e64 v92, 16, v174
    v_and_b32 v93, 0xffff0000, v174
    v_lshlrev_b32_e64 v94, 16, v175
    v_and_b32 v95, 0xffff0000, v175
    v_pk_add_f32 v[60:61], v[60:61], v[92:93]
    v_pk_add_f32 v[62:63], v[62:63], v[94:95]
    v_cvt_pk_bf16_f32 v14, v60, v61
    v_cvt_pk_bf16_f32 v15, v62, v63
    ds_write_b64 v238, v[14:15] offset:2400
    s_waitcnt lgkmcnt(0)
    ds_read_b128 v[16:19], v239 offset:0
    ds_read_b128 v[20:23], v239 offset:1152
    ds_read_b128 v[24:27], v239 offset:2304
    ds_read_b128 v[28:31], v239 offset:3456
    s_waitcnt lgkmcnt(3)
    v_lshlrev_b32 v64, 16, v16
    v_lshlrev_b32 v66, 16, v17
    v_lshlrev_b32 v68, 16, v18
    v_lshlrev_b32 v70, 16, v19
    v_and_b32 v65, 0xffff0000, v16
    v_and_b32 v67, 0xffff0000, v17
    v_and_b32 v69, 0xffff0000, v18
    v_and_b32 v71, 0xffff0000, v19
    v_pk_add_f32 v[64:65], v[64:65], v[128:129]
    v_pk_add_f32 v[66:67], v[66:67], v[130:131]
    v_pk_add_f32 v[68:69], v[68:69], v[132:133]
    v_pk_add_f32 v[70:71], v[70:71], v[134:135]
    v_cvt_pk_bf16_f32 v16, v64, v65
    v_cvt_pk_bf16_f32 v17, v66, v67
    v_cvt_pk_bf16_f32 v18, v68, v69
    v_cvt_pk_bf16_f32 v19, v70, v71
    v_lshlrev_b32 v64, 16, v16
    v_lshlrev_b32 v66, 16, v17
    v_lshlrev_b32 v68, 16, v18
    v_lshlrev_b32 v70, 16, v19
    v_and_b32 v65, 0xffff0000, v16
    v_and_b32 v67, 0xffff0000, v17
    v_and_b32 v69, 0xffff0000, v18
    v_and_b32 v71, 0xffff0000, v19
    s_mov_b32 s32, 0x3400000
    buffer_store_dwordx4 v[16:19], v229, s[8:11], s32 offen sc1
    v_pk_add_f32 v[160:161], v[64:65], v[66:67]
    v_pk_mul_f32 v[162:163], v[64:65], v[64:65]
    v_pk_mul_f32 v[164:165], v[64:65], v[112:113]
    v_pk_fma_f32 v[162:163], v[66:67], v[66:67], v[162:163]
    v_pk_fma_f32 v[164:165], v[66:67], v[114:115], v[164:165]
    v_pk_add_f32 v[160:161], v[160:161], v[68:69]
    v_pk_fma_f32 v[162:163], v[68:69], v[68:69], v[162:163]
    v_pk_fma_f32 v[164:165], v[68:69], v[116:117], v[164:165]
    v_pk_add_f32 v[160:161], v[160:161], v[70:71]
    v_pk_fma_f32 v[162:163], v[70:71], v[70:71], v[162:163]
    v_pk_fma_f32 v[164:165], v[70:71], v[118:119], v[164:165]
    v_add_f32 v184, v160, v161
    v_add_f32 v185, v162, v163
    v_add_f32 v186, v164, v165
    s_waitcnt lgkmcnt(2)
    v_lshlrev_b32 v72, 16, v20
    v_lshlrev_b32 v74, 16, v21
    v_lshlrev_b32 v76, 16, v22
    v_lshlrev_b32 v78, 16, v23
    v_and_b32 v73, 0xffff0000, v20
    v_and_b32 v75, 0xffff0000, v21
    v_and_b32 v77, 0xffff0000, v22
    v_and_b32 v79, 0xffff0000, v23
    v_pk_add_f32 v[72:73], v[72:73], v[136:137]
    v_pk_add_f32 v[74:75], v[74:75], v[138:139]
    v_pk_add_f32 v[76:77], v[76:77], v[140:141]
    v_pk_add_f32 v[78:79], v[78:79], v[142:143]
    v_cvt_pk_bf16_f32 v20, v72, v73
    v_cvt_pk_bf16_f32 v21, v74, v75
    v_cvt_pk_bf16_f32 v22, v76, v77
    v_cvt_pk_bf16_f32 v23, v78, v79
    v_lshlrev_b32 v72, 16, v20
    v_lshlrev_b32 v74, 16, v21
    v_lshlrev_b32 v76, 16, v22
    v_lshlrev_b32 v78, 16, v23
    v_and_b32 v73, 0xffff0000, v20
    v_and_b32 v75, 0xffff0000, v21
    v_and_b32 v77, 0xffff0000, v22
    v_and_b32 v79, 0xffff0000, v23
    s_mov_b32 s32, 0x3404000
    buffer_store_dwordx4 v[20:23], v229, s[8:11], s32 offen sc1
    v_pk_add_f32 v[166:167], v[72:73], v[74:75]
    v_pk_mul_f32 v[168:169], v[72:73], v[72:73]
    v_pk_mul_f32 v[170:171], v[72:73], v[112:113]
    v_pk_fma_f32 v[168:169], v[74:75], v[74:75], v[168:169]
    v_pk_fma_f32 v[170:171], v[74:75], v[114:115], v[170:171]
    v_pk_add_f32 v[166:167], v[166:167], v[76:77]
    v_pk_fma_f32 v[168:169], v[76:77], v[76:77], v[168:169]
    v_pk_fma_f32 v[170:171], v[76:77], v[116:117], v[170:171]
    v_pk_add_f32 v[166:167], v[166:167], v[78:79]
    v_pk_fma_f32 v[168:169], v[78:79], v[78:79], v[168:169]
    v_pk_fma_f32 v[170:171], v[78:79], v[118:119], v[170:171]
    v_add_f32 v187, v166, v167
    v_add_f32 v188, v168, v169
    v_add_f32 v189, v170, v171
    s_waitcnt lgkmcnt(1)
    v_lshlrev_b32 v80, 16, v24
    v_lshlrev_b32 v82, 16, v25
    v_lshlrev_b32 v84, 16, v26
    v_lshlrev_b32 v86, 16, v27
    v_and_b32 v81, 0xffff0000, v24
    v_and_b32 v83, 0xffff0000, v25
    v_and_b32 v85, 0xffff0000, v26
    v_and_b32 v87, 0xffff0000, v27
    v_pk_add_f32 v[80:81], v[80:81], v[144:145]
    v_pk_add_f32 v[82:83], v[82:83], v[146:147]
    v_pk_add_f32 v[84:85], v[84:85], v[148:149]
    v_pk_add_f32 v[86:87], v[86:87], v[150:151]
    v_cvt_pk_bf16_f32 v24, v80, v81
    v_cvt_pk_bf16_f32 v25, v82, v83
    v_cvt_pk_bf16_f32 v26, v84, v85
    v_cvt_pk_bf16_f32 v27, v86, v87
    v_lshlrev_b32 v80, 16, v24
    v_lshlrev_b32 v82, 16, v25
    v_lshlrev_b32 v84, 16, v26
    v_lshlrev_b32 v86, 16, v27
    v_and_b32 v81, 0xffff0000, v24
    v_and_b32 v83, 0xffff0000, v25
    v_and_b32 v85, 0xffff0000, v26
    v_and_b32 v87, 0xffff0000, v27
    s_mov_b32 s32, 0x3408000
    buffer_store_dwordx4 v[24:27], v229, s[8:11], s32 offen sc1
    v_pk_add_f32 v[172:173], v[80:81], v[82:83]
    v_pk_mul_f32 v[174:175], v[80:81], v[80:81]
    v_pk_mul_f32 v[176:177], v[80:81], v[112:113]
    v_pk_fma_f32 v[174:175], v[82:83], v[82:83], v[174:175]
    v_pk_fma_f32 v[176:177], v[82:83], v[114:115], v[176:177]
    v_pk_add_f32 v[172:173], v[172:173], v[84:85]
    v_pk_fma_f32 v[174:175], v[84:85], v[84:85], v[174:175]
    v_pk_fma_f32 v[176:177], v[84:85], v[116:117], v[176:177]
    v_pk_add_f32 v[172:173], v[172:173], v[86:87]
    v_pk_fma_f32 v[174:175], v[86:87], v[86:87], v[174:175]
    v_pk_fma_f32 v[176:177], v[86:87], v[118:119], v[176:177]
    v_add_f32 v190, v172, v173
    v_add_f32 v191, v174, v175
    v_add_f32 v192, v176, v177
    s_waitcnt lgkmcnt(0)
    v_lshlrev_b32 v88, 16, v28
    v_lshlrev_b32 v90, 16, v29
    v_lshlrev_b32 v92, 16, v30
    v_lshlrev_b32 v94, 16, v31
    v_and_b32 v89, 0xffff0000, v28
    v_and_b32 v91, 0xffff0000, v29
    v_and_b32 v93, 0xffff0000, v30
    v_and_b32 v95, 0xffff0000, v31
    v_pk_add_f32 v[88:89], v[88:89], v[152:153]
    v_pk_add_f32 v[90:91], v[90:91], v[154:155]
    v_pk_add_f32 v[92:93], v[92:93], v[156:157]
    v_pk_add_f32 v[94:95], v[94:95], v[158:159]
    v_cvt_pk_bf16_f32 v28, v88, v89
    v_cvt_pk_bf16_f32 v29, v90, v91
    v_cvt_pk_bf16_f32 v30, v92, v93
    v_cvt_pk_bf16_f32 v31, v94, v95
    v_lshlrev_b32 v88, 16, v28
    v_lshlrev_b32 v90, 16, v29
    v_lshlrev_b32 v92, 16, v30
    v_lshlrev_b32 v94, 16, v31
    v_and_b32 v89, 0xffff0000, v28
    v_and_b32 v91, 0xffff0000, v29
    v_and_b32 v93, 0xffff0000, v30
    v_and_b32 v95, 0xffff0000, v31
    s_mov_b32 s32, 0x340c000
    buffer_store_dwordx4 v[28:31], v229, s[8:11], s32 offen sc1
    v_pk_add_f32 v[178:179], v[88:89], v[90:91]
    v_pk_mul_f32 v[180:181], v[88:89], v[88:89]
    v_pk_mul_f32 v[182:183], v[88:89], v[112:113]
    v_pk_fma_f32 v[180:181], v[90:91], v[90:91], v[180:181]
    v_pk_fma_f32 v[182:183], v[90:91], v[114:115], v[182:183]
    v_pk_add_f32 v[178:179], v[178:179], v[92:93]
    v_pk_fma_f32 v[180:181], v[92:93], v[92:93], v[180:181]
    v_pk_fma_f32 v[182:183], v[92:93], v[116:117], v[182:183]
    v_pk_add_f32 v[178:179], v[178:179], v[94:95]
    v_pk_fma_f32 v[180:181], v[94:95], v[94:95], v[180:181]
    v_pk_fma_f32 v[182:183], v[94:95], v[118:119], v[182:183]
    v_add_f32 v193, v178, v179
    v_add_f32 v194, v180, v181
    v_add_f32_e64 v195, v182, v183
    v_add_f32_dpp v196, v196, v196 quad_perm:[1,0,3,2] row_mask:0xf bank_mask:0xf
    v_add_f32_dpp v184, v184, v184 quad_perm:[1,0,3,2] row_mask:0xf bank_mask:0xf
    v_add_f32_dpp v185, v185, v185 quad_perm:[1,0,3,2] row_mask:0xf bank_mask:0xf
    v_add_f32_dpp v186, v186, v186 quad_perm:[1,0,3,2] row_mask:0xf bank_mask:0xf
    v_add_f32_dpp v187, v187, v187 quad_perm:[1,0,3,2] row_mask:0xf bank_mask:0xf
    v_add_f32_dpp v188, v188, v188 quad_perm:[1,0,3,2] row_mask:0xf bank_mask:0xf
    v_add_f32_dpp v189, v189, v189 quad_perm:[1,0,3,2] row_mask:0xf bank_mask:0xf
    v_add_f32_dpp v190, v190, v190 quad_perm:[1,0,3,2] row_mask:0xf bank_mask:0xf
    v_add_f32_dpp v191, v191, v191 quad_perm:[1,0,3,2] row_mask:0xf bank_mask:0xf
    v_add_f32_dpp v192, v192, v192 quad_perm:[1,0,3,2] row_mask:0xf bank_mask:0xf
    v_add_f32_dpp v193, v193, v193 quad_perm:[1,0,3,2] row_mask:0xf bank_mask:0xf
    v_add_f32_dpp v194, v194, v194 quad_perm:[1,0,3,2] row_mask:0xf bank_mask:0xf
    v_add_f32_dpp v195, v195, v195 quad_perm:[1,0,3,2] row_mask:0xf bank_mask:0xf
    v_add_f32_dpp v196, v196, v196 quad_perm:[2,3,0,1] row_mask:0xf bank_mask:0xf
    v_add_f32_dpp v184, v184, v184 quad_perm:[2,3,0,1] row_mask:0xf bank_mask:0xf
    v_add_f32_dpp v185, v185, v185 quad_perm:[2,3,0,1] row_mask:0xf bank_mask:0xf
    v_add_f32_dpp v186, v186, v186 quad_perm:[2,3,0,1] row_mask:0xf bank_mask:0xf
    v_add_f32_dpp v187, v187, v187 quad_perm:[2,3,0,1] row_mask:0xf bank_mask:0xf
    v_add_f32_dpp v188, v188, v188 quad_perm:[2,3,0,1] row_mask:0xf bank_mask:0xf
    v_add_f32_dpp v189, v189, v189 quad_perm:[2,3,0,1] row_mask:0xf bank_mask:0xf
    v_add_f32_dpp v190, v190, v190 quad_perm:[2,3,0,1] row_mask:0xf bank_mask:0xf
    v_add_f32_dpp v191, v191, v191 quad_perm:[2,3,0,1] row_mask:0xf bank_mask:0xf
    v_add_f32_dpp v192, v192, v192 quad_perm:[2,3,0,1] row_mask:0xf bank_mask:0xf
    v_add_f32_dpp v193, v193, v193 quad_perm:[2,3,0,1] row_mask:0xf bank_mask:0xf
    v_add_f32_dpp v194, v194, v194 quad_perm:[2,3,0,1] row_mask:0xf bank_mask:0xf
    v_add_f32_dpp v195, v195, v195 quad_perm:[2,3,0,1] row_mask:0xf bank_mask:0xf
    v_add_f32_dpp v196, v196, v196 row_half_mirror row_mask:0xf bank_mask:0xf
    v_add_f32_dpp v184, v184, v184 row_half_mirror row_mask:0xf bank_mask:0xf
    v_add_f32_dpp v185, v185, v185 row_half_mirror row_mask:0xf bank_mask:0xf
    v_add_f32_dpp v186, v186, v186 row_half_mirror row_mask:0xf bank_mask:0xf
    v_add_f32_dpp v187, v187, v187 row_half_mirror row_mask:0xf bank_mask:0xf
    v_add_f32_dpp v188, v188, v188 row_half_mirror row_mask:0xf bank_mask:0xf
    v_add_f32_dpp v189, v189, v189 row_half_mirror row_mask:0xf bank_mask:0xf
    v_add_f32_dpp v190, v190, v190 row_half_mirror row_mask:0xf bank_mask:0xf
    v_add_f32_dpp v191, v191, v191 row_half_mirror row_mask:0xf bank_mask:0xf
    v_add_f32_dpp v192, v192, v192 row_half_mirror row_mask:0xf bank_mask:0xf
    v_add_f32_dpp v193, v193, v193 row_half_mirror row_mask:0xf bank_mask:0xf
    v_add_f32_dpp v194, v194, v194 row_half_mirror row_mask:0xf bank_mask:0xf
    v_add_f32_dpp v195, v195, v195 row_half_mirror row_mask:0xf bank_mask:0xf
    v_cndmask_b32 v184, v184, v187, s[60:61]
    v_cndmask_b32 v190, v190, v193, s[60:61]
    v_cndmask_b32 v185, v185, v188, s[60:61]
    v_cndmask_b32 v191, v191, v194, s[60:61]
    v_cndmask_b32 v186, v186, v189, s[60:61]
    v_cndmask_b32 v192, v192, v195, s[60:61]
    v_cndmask_b32 v184, v184, v190, s[62:63]
    v_cndmask_b32 v185, v185, v191, s[62:63]
    v_cndmask_b32 v186, v186, v192, s[62:63]
    v_cndmask_b32 v184, v184, v185, s[40:41]
    v_cndmask_b32 v186, v186, v196, s[40:41]
    buffer_atomic_add_f32 v184, v231, s[8:11], s48 offen
    buffer_atomic_add_f32 v186, v232, s[8:11], s48 offen
    s_lshl_b32 s32, s3, 13
    v_add_u32 v234, s32, v228
    v_add_u32 v235, 65536, v234
    ds_write_b128 v234, a[128:131] offset:0
    ds_write_b128 v234, a[132:135] offset:1024
    ds_write_b128 v234, a[136:139] offset:2048
    ds_write_b128 v234, a[140:143] offset:3072
    ds_write_b128 v234, a[144:147] offset:4096
    ds_write_b128 v234, a[148:151] offset:5120
    ds_write_b128 v234, a[152:155] offset:6144
    ds_write_b128 v234, a[156:159] offset:7168
    s_waitcnt lgkmcnt(4)
    ds_write_b128 v234, a[160:163] offset:32768
    ds_write_b128 v234, a[164:167] offset:33792
    ds_write_b128 v234, a[168:171] offset:34816
    ds_write_b128 v234, a[172:175] offset:35840
    ds_write_b128 v234, a[176:179] offset:36864
    ds_write_b128 v234, a[180:183] offset:37888
    ds_write_b128 v234, a[184:187] offset:38912
    ds_write_b128 v234, a[188:191] offset:39936
    s_waitcnt lgkmcnt(4)
    ds_write_b128 v235, a[192:195] offset:0
    ds_write_b128 v235, a[196:199] offset:1024
    ds_write_b128 v235, a[200:203] offset:2048
    ds_write_b128 v235, a[204:207] offset:3072
    ds_write_b128 v235, a[208:211] offset:4096
    ds_write_b128 v235, a[212:215] offset:5120
    ds_write_b128 v235, a[216:219] offset:6144
    ds_write_b128 v235, a[220:223] offset:7168
    s_waitcnt lgkmcnt(4)
    s_lshl_b32 s35, s3, 13
    v_bfe_u32 v234, v237, 2, 3
    v_lshrrev_b32_e64 v235, 5, v237
    v_lshl_add_u32 v234, v235, 4, v234
    v_lshlrev_b32 v234, 5, v234
    v_and_b32 v236, 3, v237
    v_lshl_add_u32 v234, v236, 3, v234
    v_add_u32 v217, s35, v234
    v_lshlrev_b32 v235, 5, v235
    v_bfe_u32 v236, v237, 4, 1
    v_lshl_add_u32 v235, v236, 3, v235
    v_and_b32_e64 v236, 1, v237
    v_lshl_add_u32 v235, v236, 11, v235
    s_lshl_b32 s32, s3, 9
    s_add_u32 s32, s32, 98304
    v_add_u32 v218, s32, v235
    v_lshlrev_b32_e64 v234, 4, v230
    v_add_u32 v220, 106752, v234
    v_add_u32 v221, 106752, v228
    v_lshrrev_b32 v236, 2, v237
    v_lshlrev_b32 v236, 7, v236
    v_and_b32_e64 v234, 3, v237
    v_lshl_add_u32 v236, v234, 3, v236
    s_add_u32 s32, s35, 65536
    v_add_u32 v219, s32, v236
    s_lshl_b32 s32, s3, 12
    s_add_u32 s32, s32, 114944
    v_and_b32 v234, 15, v237
    v_min_u32 v234, 2, v234
    v_lshlrev_b32 v234, 10, v234
    v_lshrrev_b32 v235, 4, v237
    v_lshl_add_u32 v234, v235, 4, v234
    v_add_u32 v222, s32, v234
    v_add_u32_e64 v223, s32, v228
    s_waitcnt vmcnt(0)
    s_barrier
    s_cmp_lg_u32 s3, 0
    s_cbranch_scc1 kc_a1
    s_lshl_b32 s32, s52, 7
    s_add_u32 s32, s32, 0x38a0000
    v_mov_b32_e64 v235, 1
    buffer_atomic_add v235, v243, s[8:11], s32 offen sc0 sc1
    v_lshlrev_b32 v234, 7, v237
    v_cmp_gt_u32 vcc, 8, v237
    v_mov_b32_e64 v236, 0x40000000
    s_mov_b32 s34, 0x38a0400
    v_cndmask_b32 v234, v236, v234, vcc
    s_waitcnt vmcnt(0)
    v_readfirstlane_b32 s36, v235
    s_cmp_lg_u32 s36, 31
    s_cbranch_scc1 kc_a1
    buffer_atomic_add v233, v234, s[8:11], s34 offen sc1
kc_a1:
    s_waitcnt lgkmcnt(0)
    ds_read_b64_tr_b16 a[0:1], v217 offset:0
    ds_read_b64_tr_b16 a[2:3], v217 offset:256
    ds_read_b64_tr_b16 a[32:33], v217 offset:32768
    ds_read_b64_tr_b16 a[34:35], v217 offset:33024
    ds_read_b64_tr_b16 a[4:5], v217 offset:1024
    ds_read_b64_tr_b16 a[6:7], v217 offset:1280
    ds_read_b64_tr_b16 a[36:37], v217 offset:33792
    ds_read_b64_tr_b16 a[38:39], v217 offset:34048
    s_waitcnt lgkmcnt(6)
    ds_read_b64_tr_b16 a[8:9], v217 offset:2048
    ds_read_b64_tr_b16 a[10:11], v217 offset:2304
    ds_read_b64_tr_b16 a[40:41], v217 offset:34816
    ds_read_b64_tr_b16 a[42:43], v217 offset:35072
    ds_read_b64_tr_b16 a[12:13], v217 offset:3072
    ds_read_b64_tr_b16 a[14:15], v217 offset:3328
    ds_read_b64_tr_b16 a[44:45], v217 offset:35840
    ds_read_b64_tr_b16 a[46:47], v217 offset:36096
    s_waitcnt lgkmcnt(6)
    ds_read_b64_tr_b16 a[16:17], v217 offset:4096
    ds_read_b64_tr_b16 a[18:19], v217 offset:4352
    ds_read_b64_tr_b16 a[48:49], v217 offset:36864
    ds_read_b64_tr_b16 a[50:51], v217 offset:37120
    ds_read_b64_tr_b16 a[20:21], v217 offset:5120
    ds_read_b64_tr_b16 a[22:23], v217 offset:5376
    ds_read_b64_tr_b16 a[52:53], v217 offset:37888
    ds_read_b64_tr_b16 a[54:55], v217 offset:38144
    s_waitcnt lgkmcnt(6)
    ds_read_b64_tr_b16 a[24:25], v217 offset:6144
    ds_read_b64_tr_b16 a[26:27], v217 offset:6400
    ds_read_b64_tr_b16 a[56:57], v217 offset:38912
    ds_read_b64_tr_b16 a[58:59], v217 offset:39168
    ds_read_b64_tr_b16 a[28:29], v217 offset:7168
    ds_read_b64_tr_b16 a[30:31], v217 offset:7424
    ds_read_b64_tr_b16 a[60:61], v217 offset:39936
    ds_read_b64_tr_b16 a[62:63], v217 offset:40192
    s_waitcnt lgkmcnt(6)
    ds_read_b64_tr_b16 a[64:65], v219 offset:0
    ds_read_b64_tr_b16 a[66:67], v219 offset:32
    ds_read_b64_tr_b16 a[68:69], v219 offset:64
    ds_read_b64_tr_b16 a[70:71], v219 offset:96
    ds_read_b64_tr_b16 a[72:73], v219 offset:2048
    ds_read_b64_tr_b16 a[74:75], v219 offset:2080
    ds_read_b64_tr_b16 a[76:77], v219 offset:2112
    ds_read_b64_tr_b16 a[78:79], v219 offset:2144
    s_waitcnt lgkmcnt(6)
    ds_read_b64_tr_b16 a[80:81], v219 offset:4096
    ds_read_b64_tr_b16 a[82:83], v219 offset:4128
    ds_read_b64_tr_b16 a[84:85], v219 offset:4160
    ds_read_b64_tr_b16 a[86:87], v219 offset:4192
    ds_read_b64_tr_b16 a[88:89], v219 offset:6144
    ds_read_b64_tr_b16 a[90:91], v219 offset:6176
    ds_read_b64_tr_b16 a[92:93], v219 offset:6208
    ds_read_b64_tr_b16 a[94:95], v219 offset:6240
    s_waitcnt lgkmcnt(6)
    v_mov_b32 v130, 0x3a800000
    v_mov_b32 v131, 0x3a800000
    v_mov_b32 v132, 0x3727c5ac
    v_mov_b32 v133, 0x3727c5ac
    s_mov_b32 s33, 0xfffff800
    s_lshl_b32 s39, s3, 11
    v_add_u32 v238, s39, v228
    v_lshlrev_b32 v239, 2, v242
    s_lshl_b32 s39, s3, 3
    s_add_u32 s7, s39, 106512
    v_lshlrev_b32 v141, 5, v237
    v_or_b32_e64 v141, s39, v141
    s_cmp_lg_u32 s3, 0
    s_cbranch_scc1 kc_b12
    s_lshl_b32 s32, s52, 7
    s_add_u32 s32, s32, 0x38a0400
    s_mov_b32 s34, 0x400000
    s_branch kc_b11
kc_b10:
    s_sleep 2
kc_b11:
    buffer_load_dword v235, off, s[8:11], s32 sc1
    s_waitcnt vmcnt(0)
    v_cmp_ne_u32 vcc, 8, v235
    s_sub_u32 s34, s34, 1
    s_cbranch_scc1 kc_b12
    s_cbranch_vccnz kc_b10
kc_b12:
    s_barrier
    s_add_u32 s32, s48, 24576
    buffer_load_dword v128, off, s[8:11], s32 sc1
    buffer_load_dwordx4 v[32:35], v238, s[8:11], s48 offen offset:0 sc1
    buffer_load_dwordx4 v[40:43], v238, s[8:11], s49 offen offset:0 sc1
    buffer_load_dwordx4 v[48:51], v238, s[8:11], s50 offen offset:0 sc1
    buffer_load_dwordx4 v[36:39], v238, s[8:11], s48 offen offset:1024 sc1
    buffer_load_dwordx4 v[44:47], v238, s[8:11], s49 offen offset:1024 sc1
    buffer_load_dwordx4 v[52:55], v238, s[8:11], s50 offen offset:1024 sc1
    buffer_load_dword v0, v239, s[8:11], s48 offen offset:0 sc1
    buffer_load_dword v4, v239, s[8:11], s49 offen offset:0 sc1
    buffer_load_dword v1, v239, s[8:11], s48 offen offset:32 sc1
    buffer_load_dword v5, v239, s[8:11], s49 offen offset:32 sc1
    buffer_load_dword v2, v239, s[8:11], s48 offen offset:64 sc1
    buffer_load_dword v6, v239, s[8:11], s49 offen offset:64 sc1
    buffer_load_dword v3, v239, s[8:11], s48 offen offset:96 sc1
    buffer_load_dword v7, v239, s[8:11], s49 offen offset:96 sc1
    s_waitcnt vmcnt(8)
    v_mov_b32 v129, v128
    v_pk_mul_f32 v[32:33], v[32:33], v[130:131]
    v_pk_mul_f32 v[34:35], v[34:35], v[130:131]
    v_pk_mul_f32 v[36:37], v[36:37], v[130:131]
    v_pk_mul_f32 v[38:39], v[38:39], v[130:131]
    v_pk_fma_f32 v[40:41], v[40:41], v[130:131], v[132:133]
    v_pk_fma_f32 v[42:43], v[42:43], v[130:131], v[132:133]
    v_pk_fma_f32 v[44:45], v[44:45], v[130:131], v[132:133]
    v_pk_fma_f32 v[46:47], v[46:47], v[130:131], v[132:133]
    v_pk_fma_f32 v[40:41], v[32:33], v[32:33], v[40:41] neg_lo:[1,0,0] neg_hi:[1,0,0]
    v_pk_fma_f32 v[42:43], v[34:35], v[34:35], v[42:43] neg_lo:[1,0,0] neg_hi:[1,0,0]
    v_pk_fma_f32 v[44:45], v[36:37], v[36:37], v[44:45] neg_lo:[1,0,0] neg_hi:[1,0,0]
    v_pk_fma_f32 v[46:47], v[38:39], v[38:39], v[46:47] neg_lo:[1,0,0] neg_hi:[1,0,0]
    v_pk_fma_f32 v[48:49], v[32:33], v[128:129], v[48:49] neg_lo:[1,0,0] neg_hi:[1,0,0]
    v_pk_fma_f32 v[50:51], v[34:35], v[128:129], v[50:51] neg_lo:[1,0,0] neg_hi:[1,0,0]
    v_pk_fma_f32 v[52:53], v[36:37], v[128:129], v[52:53] neg_lo:[1,0,0] neg_hi:[1,0,0]
    v_pk_fma_f32 v[54:55], v[38:39], v[128:129], v[54:55] neg_lo:[1,0,0] neg_hi:[1,0,0]
    v_max_f32 v40, v40, v132
    v_max_f32 v42, v42, v132
    v_max_f32 v44, v44, v132
    v_max_f32 v46, v46, v132
    v_max_f32 v41, v41, v132
    v_max_f32 v43, v43, v132
    v_max_f32 v45, v45, v132
    v_max_f32 v47, v47, v132
    v_rsq_f32 v40, v40
    v_rsq_f32 v42, v42
    v_rsq_f32 v44, v44
    v_rsq_f32 v46, v46
    v_rsq_f32 v41, v41
    v_rsq_f32 v43, v43
    v_rsq_f32 v45, v45
    v_rsq_f32 v47, v47
    v_pk_mul_f32 v[48:49], v[48:49], v[40:41]
    v_pk_mul_f32 v[50:51], v[50:51], v[42:43]
    v_pk_mul_f32 v[52:53], v[52:53], v[44:45]
    v_pk_mul_f32 v[54:55], v[54:55], v[46:47]
    v_and_or_b32 v48, v48, s33, 0
    v_and_or_b32 v50, v50, s33, 2
    v_and_or_b32 v52, v52, s33, 4
    v_and_or_b32 v54, v54, s33, 6
    v_and_or_b32 v49, v49, s33, 1
    v_and_or_b32 v51, v51, s33, 3
    v_and_or_b32 v53, v53, s33, 5
    v_and_or_b32 v55, v55, s33, 7
    v_max_f32 v136, v48, v49
    v_min_f32 v137, v48, v49
    v_med3_f32 v137, v136, v50, v137
    v_max_f32_e64 v136, v136, v50
    v_med3_f32 v137, v136, v51, v137
    v_max_f32_e64 v136, v136, v51
    v_med3_f32 v137, v136, v52, v137
    v_max_f32_e64 v136, v136, v52
    v_med3_f32 v137, v136, v53, v137
    v_max_f32_e64 v136, v136, v53
    v_med3_f32 v137, v136, v54, v137
    v_max_f32_e64 v136, v136, v54
    v_med3_f32 v137, v136, v55, v137
    v_max_f32 v136, v136, v55
    v_or_b32 v136, v141, v136
    v_or_b32 v137, v141, v137
    s_nop 1
    v_mov_b32_dpp v138, v136 quad_perm:[1,0,3,2] row_mask:0xf bank_mask:0xf
    v_mov_b32_dpp v139, v137 quad_perm:[1,0,3,2] row_mask:0xf bank_mask:0xf
    v_min_f32 v140, v136, v138
    v_max_f32 v136, v136, v138
    v_max3_f32 v137, v140, v137, v139
    s_nop 1
    v_mov_b32_dpp v138, v136 quad_perm:[2,3,0,1] row_mask:0xf bank_mask:0xf
    v_mov_b32_dpp v139, v137 quad_perm:[2,3,0,1] row_mask:0xf bank_mask:0xf
    v_min_f32 v140, v136, v138
    v_max_f32_e64 v136, v136, v138
    v_max3_f32 v137, v140, v137, v139
    s_nop 1
    v_mov_b32_dpp v138, v136 row_half_mirror row_mask:0xf bank_mask:0xf
    v_mov_b32_dpp v139, v137 row_half_mirror row_mask:0xf bank_mask:0xf
    v_min_f32 v140, v136, v138
    v_max_f32_e64 v136, v136, v138
    v_max3_f32 v137, v140, v137, v139
    s_nop 1
    v_mov_b32_dpp v138, v136 row_mirror row_mask:0xf bank_mask:0xf
    v_mov_b32_dpp v139, v137 row_mirror row_mask:0xf bank_mask:0xf
    v_min_f32 v140, v136, v138
    v_max_f32_e64 v136, v136, v138
    v_max3_f32 v137, v140, v137, v139
    v_mov_b32 v138, v136
    v_mov_b32 v139, v137
    s_nop 1
    v_permlane16_swap_b32 v136, v138
    v_permlane16_swap_b32 v137, v139
    s_nop 0
    v_min_f32 v140, v136, v138
    v_max_f32 v136, v136, v138
    v_max3_f32 v137, v140, v137, v139
    v_mov_b32 v138, v136
    v_mov_b32 v139, v137
    s_nop 1
    v_permlane32_swap_b32 v136, v138
    v_permlane32_swap_b32 v137, v139
    s_nop 0
    v_min_f32 v140, v136, v138
    v_max_f32 v136, v136, v138
    v_max3_f32 v137, v140, v137, v139
    v_mov_b32_e64 v234, s7
    ds_write_b64 v234, v[136:137]
    v_mov_b32 v234, 106512
    s_waitcnt lgkmcnt(0)
    s_barrier
    ds_read_b128 v[56:59], v234
    ds_read_b128 v[60:63], v234 offset:16
    s_waitcnt lgkmcnt(0)
    v_min_f32 v140, v56, v58
    v_max_f32_e64 v56, v56, v58
    v_max3_f32 v57, v140, v57, v59
    v_min_f32 v140, v60, v62
    v_max_f32 v60, v60, v62
    v_max3_f32 v61, v140, v61, v63
    v_min_f32 v140, v56, v60
    v_max_f32 v56, v56, v60
    v_max3_f32 v57, v140, v57, v61
    v_bfe_u32 v234, v56, 5, 6
    v_bfe_u32 v235, v56, 2, 3
    v_and_b32_e64 v8, 3, v56
    v_lshl_add_u32 v8, v234, 2, v8
    v_lshl_add_u32 v8, v235, 8, v8
    v_bfe_u32 v234, v57, 5, 6
    v_bfe_u32 v235, v57, 2, 3
    v_and_b32_e64 v10, 3, v57
    v_lshl_add_u32 v10, v234, 2, v10
    v_lshl_add_u32 v10, v235, 8, v10
    s_cmp_lt_u32 s3, 2
    s_cselect_b64 vcc, -1, 0
    v_lshlrev_b32 v236, 4, v230
    v_cndmask_b32 v142, v10, v8, vcc
    v_lshlrev_b32_e64 v234, 2, v142
    v_and_b32 v235, 2047, v236
    v_lshl_add_u32 v235, v142, 11, v235
    s_mov_b32 s32, 0x3400000
    buffer_load_dwordx4 v[32:35], v235, s[8:11], s32 offen sc1
    buffer_load_dword v144, v234, s[8:11], s48 offen sc1
    buffer_load_dword v145, v234, s[8:11], s49 offen sc1
    buffer_load_dword v146, v234, s[8:11], s50 offen sc1
    v_add_u32 v236, 98304, v236
    s_lshr_b32 s32, s3, 1
    s_lshl_b32 s32, s32, 2
    s_add_u32 s32, s32, 106496
    v_mov_b32 v234, s32
    s_waitcnt vmcnt(4)
    v_mul_f32 v0, 0x3a800000, v0
    v_mul_f32 v1, 0x3a800000, v1
    v_mul_f32 v2, 0x3a800000, v2
    v_mul_f32 v3, 0x3a800000, v3
    v_mul_f32 v4, 0x3a800000, v4
    v_mul_f32 v5, 0x3a800000, v5
    v_mul_f32 v6, 0x3a800000, v6
    v_mul_f32 v7, 0x3a800000, v7
    v_fma_f32 v4, -v0, v0, v4
    v_fma_f32 v5, -v1, v1, v5
    v_fma_f32 v6, -v2, v2, v6
    v_fma_f32 v7, -v3, v3, v7
    v_max_f32 v4, 0, v4
    v_max_f32 v5, 0, v5
    v_max_f32 v6, 0, v6
    v_max_f32 v7, 0, v7
    v_cvt_pk_bf16_f32 v12, v0, v4
    v_cvt_pk_bf16_f32 v13, v1, v5
    v_cvt_pk_bf16_f32 v14, v2, v6
    v_cvt_pk_bf16_f32 v15, v3, v7
    v_lshlrev_b32 v0, 16, v12
    v_lshlrev_b32 v1, 16, v13
    v_lshlrev_b32 v2, 16, v14
    v_lshlrev_b32 v3, 16, v15
    v_and_b32 v4, 0xffff0000, v12
    v_and_b32 v5, 0xffff0000, v13
    v_and_b32 v6, 0xffff0000, v14
    v_and_b32 v7, 0xffff0000, v15
    v_add_f32 v4, 0x3727c5ac, v4
    v_add_f32 v5, 0x3727c5ac, v5
    v_add_f32 v6, 0x3727c5ac, v6
    v_add_f32 v7, 0x3727c5ac, v7
    v_cvt_pk_bf16_f32 v4, v4, v4
    v_cvt_pk_bf16_f32 v5, v5, v5
    v_cvt_pk_bf16_f32 v6, v6, v6
    v_cvt_pk_bf16_f32 v7, v7, v7
    v_lshlrev_b32 v4, 16, v4
    v_lshlrev_b32 v5, 16, v5
    v_lshlrev_b32 v6, 16, v6
    v_lshlrev_b32 v7, 16, v7
    v_sqrt_f32 v4, v4
    v_sqrt_f32 v5, v5
    v_sqrt_f32 v6, v6
    v_sqrt_f32 v7, v7
    v_cvt_pk_bf16_f32 v4, v4, v4
    v_cvt_pk_bf16_f32 v5, v5, v5
    v_cvt_pk_bf16_f32 v6, v6, v6
    v_cvt_pk_bf16_f32 v7, v7, v7
    v_lshlrev_b32 v4, 16, v4
    v_lshlrev_b32 v5, 16, v5
    v_lshlrev_b32 v6, 16, v6
    v_lshlrev_b32 v7, 16, v7
    v_rcp_f32 v4, v4
    v_rcp_f32 v5, v5
    v_rcp_f32 v6, v6
    v_rcp_f32_e64 v7, v7
    s_waitcnt vmcnt(0)
    v_mul_f32 v144, 0x3a800000, v144
    v_mul_f32 v145, 0x3a800000, v145
    v_fma_f32 v145, -v144, v144, v145
    v_max_f32_e64 v145, 0, v145
    v_cvt_pk_bf16_f32 v140, v144, v145
    v_lshlrev_b32_e64 v144, 16, v140
    v_and_b32 v145, 0xffff0000, v140
    v_add_f32 v145, 0x3727c5ac, v145
    v_cvt_pk_bf16_f32 v145, v145, v145
    v_lshlrev_b32_e64 v145, 16, v145
    v_sqrt_f32 v145, v145
    s_nop 0
    v_cvt_pk_bf16_f32 v145, v145, v145
    v_lshlrev_b32 v145, 16, v145
    v_rcp_f32 v145, v145
    s_nop 0
    v_lshlrev_b32 v64, 16, v32
    v_lshlrev_b32 v66, 16, v33
    v_lshlrev_b32 v68, 16, v34
    v_lshlrev_b32_e64 v70, 16, v35
    v_and_b32 v65, 0xffff0000, v32
    v_and_b32 v67, 0xffff0000, v33
    v_and_b32 v69, 0xffff0000, v34
    v_and_b32 v71, 0xffff0000, v35
    v_sub_f32 v64, v64, v144
    v_sub_f32 v66, v66, v144
    v_sub_f32 v68, v68, v144
    v_sub_f32 v70, v70, v144
    v_sub_f32 v65, v65, v144
    v_sub_f32 v67, v67, v144
    v_sub_f32 v69, v69, v144
    v_sub_f32 v71, v71, v144
    v_cvt_pk_bf16_f32 v65, v64, v65
    v_cvt_pk_bf16_f32 v67, v66, v67
    v_cvt_pk_bf16_f32 v69, v68, v69
    v_cvt_pk_bf16_f32 v71, v70, v71
    v_lshlrev_b32 v64, 16, v65
    v_lshlrev_b32 v66, 16, v67
    v_lshlrev_b32 v68, 16, v69
    v_lshlrev_b32 v70, 16, v71
    v_and_b32 v65, 0xffff0000, v65
    v_and_b32 v67, 0xffff0000, v67
    v_and_b32 v69, 0xffff0000, v69
    v_and_b32 v71, 0xffff0000, v71
    v_mul_f32 v64, v64, v145
    v_mul_f32 v66, v66, v145
    v_mul_f32 v68, v68, v145
    v_mul_f32 v70, v70, v145
    v_mul_f32 v65, v65, v145
    v_mul_f32 v67, v67, v145
    v_mul_f32 v69, v69, v145
    v_mul_f32 v71, v71, v145
    v_cvt_pk_bf16_f32 v48, v64, v65
    v_cvt_pk_bf16_f32 v49, v66, v67
    v_cvt_pk_bf16_f32 v50, v68, v69
    v_cvt_pk_bf16_f32 v51, v70, v71
    ds_write_b128 v236, v[48:51]
    ds_write_b128 v236, v[32:35] offset:4096
    v_fma_f32 v143, -v144, v128, v146
    v_mul_f32_e64 v143, v143, v145
    ds_write_b32 v234, v143
    s_waitcnt lgkmcnt(0)
kc_com:
    s_barrier
    s_cmp_ge_u32 s53, 28
    s_cbranch_scc1 kc_red
    ds_read_b64 v[96:97], v218 offset:0
    ds_read_b64 v[98:99], v218 offset:16
    ds_read_b64 v[100:101], v218 offset:64
    ds_read_b64 v[102:103], v218 offset:80
    ds_read_b64 v[104:105], v218 offset:128
    ds_read_b64 v[106:107], v218 offset:144
    ds_read_b64 v[108:109], v218 offset:192
    ds_read_b64 v[110:111], v218 offset:208
    ds_read_b64 v[112:113], v218 offset:256
    ds_read_b64 v[114:115], v218 offset:272
    ds_read_b64 v[116:117], v218 offset:320
    ds_read_b64 v[118:119], v218 offset:336
    ds_read_b64 v[120:121], v218 offset:384
    ds_read_b64 v[122:123], v218 offset:400
    s_waitcnt lgkmcnt(12)
    ds_read_b64 v[124:125], v218 offset:448
    ds_read_b64 v[126:127], v218 offset:464
    v_mfma_f32_16x16x32_bf16 v[128:131], a[0:3], v[96:99], 0
    v_mfma_f32_16x16x32_bf16 v[132:135], a[32:35], v[96:99], 0
    s_waitcnt lgkmcnt(12)
    v_mfma_f32_16x16x32_bf16 v[128:131], a[4:7], v[100:103], v[128:131]
    v_mfma_f32_16x16x32_bf16 v[132:135], a[36:39], v[100:103], v[132:135]
    s_waitcnt lgkmcnt(10)
    v_mfma_f32_16x16x32_bf16 v[128:131], a[8:11], v[104:107], v[128:131]
    v_mfma_f32_16x16x32_bf16 v[132:135], a[40:43], v[104:107], v[132:135]
    s_waitcnt lgkmcnt(8)
    v_mfma_f32_16x16x32_bf16 v[128:131], a[12:15], v[108:111], v[128:131]
    v_mfma_f32_16x16x32_bf16 v[132:135], a[44:47], v[108:111], v[132:135]
    s_waitcnt lgkmcnt(6)
    v_mfma_f32_16x16x32_bf16 v[128:131], a[16:19], v[112:115], v[128:131]
    v_mfma_f32_16x16x32_bf16 v[132:135], a[48:51], v[112:115], v[132:135]
    s_waitcnt lgkmcnt(4)
    v_mfma_f32_16x16x32_bf16 v[128:131], a[20:23], v[116:119], v[128:131]
    v_mfma_f32_16x16x32_bf16 v[132:135], a[52:55], v[116:119], v[132:135]
    s_waitcnt lgkmcnt(2)
    v_mfma_f32_16x16x32_bf16 v[128:131], a[24:27], v[120:123], v[128:131]
    v_mfma_f32_16x16x32_bf16 v[132:135], a[56:59], v[120:123], v[132:135]
    s_waitcnt lgkmcnt(0)
    v_mfma_f32_16x16x32_bf16 v[128:131], a[28:31], v[124:127], v[128:131]
    v_mfma_f32_16x16x32_bf16 v[132:135], a[60:63], v[124:127], v[132:135]
    s_nop 6
    ds_write_b128 v220, v[128:131]
    ds_write_b128 v220, v[132:135] offset:4096
    s_waitcnt lgkmcnt(0)
    s_barrier
    ds_read_b128 v[32:35], v221 offset:0
    ds_read_b128 v[48:51], v221 offset:4096
    ds_read_b128 v[36:39], v221 offset:1024
    ds_read_b128 v[52:55], v221 offset:5120
    ds_read_b128 v[40:43], v221 offset:2048
    ds_read_b128 v[56:59], v221 offset:6144
    ds_read_b128 v[44:47], v221 offset:3072
    ds_read_b128 v[60:63], v221 offset:7168
    s_waitcnt lgkmcnt(0)
    v_add_f32 v32, v32, v36
    v_add_f32 v33, v33, v37
    v_add_f32 v34, v34, v38
    v_add_f32 v35, v35, v39
    v_add_f32 v40, v40, v44
    v_add_f32 v41, v41, v45
    v_add_f32 v42, v42, v46
    v_add_f32 v43, v43, v47
    v_add_f32 v48, v48, v52
    v_add_f32 v49, v49, v53
    v_add_f32 v50, v50, v54
    v_add_f32 v51, v51, v55
    v_add_f32 v56, v56, v60
    v_add_f32 v57, v57, v61
    v_add_f32 v58, v58, v62
    v_add_f32 v59, v59, v63
    v_add_f32 v32, v32, v40
    v_add_f32 v33, v33, v41
    v_add_f32 v34, v34, v42
    v_add_f32 v35, v35, v43
    v_add_f32 v48, v48, v56
    v_add_f32 v49, v49, v57
    v_add_f32 v50, v50, v58
    v_add_f32 v51, v51, v59
    v_cvt_pk_bf16_f32 v48, v32, v48
    v_cvt_pk_bf16_f32 v49, v33, v49
    v_cvt_pk_bf16_f32 v50, v34, v50
    v_cvt_pk_bf16_f32 v51, v35, v51
    v_lshlrev_b32 v32, 16, v48
    v_lshlrev_b32 v33, 16, v49
    v_lshlrev_b32 v34, 16, v50
    v_lshlrev_b32 v35, 16, v51
    v_and_b32 v48, 0xffff0000, v48
    v_and_b32 v49, 0xffff0000, v49
    v_and_b32 v50, 0xffff0000, v50
    v_and_b32 v51, 0xffff0000, v51
    v_mul_f32 v136, 0xbfb8aa3b, v32
    v_mul_f32 v137, 0xbfb8aa3b, v33
    v_mul_f32 v138, 0xbfb8aa3b, v34
    v_mul_f32 v139, 0xbfb8aa3b, v35
    v_exp_f32 v136, v136
    v_exp_f32 v137, v137
    v_exp_f32 v138, v138
    v_exp_f32 v139, v139
    v_add_f32 v136, 1.0, v136
    v_add_f32 v137, 1.0, v137
    v_add_f32 v138, 1.0, v138
    v_add_f32 v139, 1.0, v139
    v_rcp_f32 v136, v136
    v_rcp_f32 v137, v137
    v_rcp_f32 v138, v138
    v_rcp_f32 v139, v139
    v_mul_f32 v32, v32, v136
    v_mul_f32 v33, v33, v137
    v_mul_f32 v34, v34, v138
    v_mul_f32 v35, v35, v139
    v_cvt_pk_bf16_f32 v32, v32, v32
    v_cvt_pk_bf16_f32 v33, v33, v33
    v_cvt_pk_bf16_f32 v34, v34, v34
    v_cvt_pk_bf16_f32 v35, v35, v35
    v_lshlrev_b32 v32, 16, v32
    v_lshlrev_b32 v33, 16, v33
    v_lshlrev_b32 v34, 16, v34
    v_lshlrev_b32 v35, 16, v35
    v_mul_f32 v32, v32, v48
    v_mul_f32 v33, v33, v49
    v_mul_f32 v34, v34, v50
    v_mul_f32 v35, v35, v51
    v_cvt_pk_bf16_f32 v128, v32, v33
    v_cvt_pk_bf16_f32 v129, v34, v35
    s_nop 1
    v_mfma_f32_16x16x16_bf16 v[64:67], a[64:65], v[128:129], 0
    v_mfma_f32_16x16x16_bf16 v[68:71], a[66:67], v[128:129], 0
    v_mfma_f32_16x16x16_bf16 v[72:75], a[68:69], v[128:129], 0
    v_mfma_f32_16x16x16_bf16 v[76:79], a[70:71], v[128:129], 0
    v_mfma_f32_16x16x16_bf16 v[80:83], a[72:73], v[128:129], 0
    v_mfma_f32_16x16x16_bf16 v[84:87], a[74:75], v[128:129], 0
    v_mfma_f32_16x16x16_bf16 v[88:91], a[76:77], v[128:129], 0
    v_mfma_f32_16x16x16_bf16 v[92:95], a[78:79], v[128:129], 0
    v_mfma_f32_16x16x16_bf16 v[96:99], a[80:81], v[128:129], 0
    ds_write_b128 v222, v[64:67] offset:0
    v_mfma_f32_16x16x16_bf16 v[100:103], a[82:83], v[128:129], 0
    ds_write_b128 v222, v[68:71] offset:64
    v_mfma_f32_16x16x16_bf16 v[104:107], a[84:85], v[128:129], 0
    ds_write_b128 v222, v[72:75] offset:128
    v_mfma_f32_16x16x16_bf16 v[108:111], a[86:87], v[128:129], 0
    ds_write_b128 v222, v[76:79] offset:192
    v_mfma_f32_16x16x16_bf16 v[112:115], a[88:89], v[128:129], 0
    ds_write_b128 v222, v[80:83] offset:256
    v_mfma_f32_16x16x16_bf16 v[116:119], a[90:91], v[128:129], 0
    ds_write_b128 v222, v[84:87] offset:320
    v_mfma_f32_16x16x16_bf16 v[120:123], a[92:93], v[128:129], 0
    ds_write_b128 v222, v[88:91] offset:384
    v_mfma_f32_16x16x16_bf16 v[124:127], a[94:95], v[128:129], 0
    ds_write_b128 v222, v[92:95] offset:448
    s_waitcnt lgkmcnt(4)
    ds_write_b128 v222, v[96:99] offset:512
    ds_write_b128 v222, v[100:103] offset:576
    ds_write_b128 v222, v[104:107] offset:640
    ds_write_b128 v222, v[108:111] offset:704
    ds_write_b128 v222, v[112:115] offset:768
    ds_write_b128 v222, v[116:119] offset:832
    ds_write_b128 v222, v[120:123] offset:896
    ds_write_b128 v222, v[124:127] offset:960
    s_lshl_b32 s32, s54, 13
    s_lshl_b32 s33, s3, 10
    s_add_u32 s32, s32, s33
    s_add_u32 s32, s32, 0x3900000
    s_add_u32 s33, s32, 4096
    s_waitcnt lgkmcnt(0)
    ds_read_b128 v[32:35], v223
    ds_read_b128 v[36:39], v223 offset:1024
    s_waitcnt lgkmcnt(1)
    buffer_store_dwordx4 v[32:35], v228, s[8:11], s32 offen sc1
    s_waitcnt lgkmcnt(0)
    buffer_store_dwordx4 v[36:39], v228, s[8:11], s33 offen sc1
    v_lshlrev_b32 v144, 16, v16
    v_lshlrev_b32 v148, 16, v17
    v_lshlrev_b32 v152, 16, v18
    v_lshlrev_b32 v156, 16, v19
    v_and_b32 v145, 0xffff0000, v16
    v_and_b32 v149, 0xffff0000, v17
    v_and_b32 v153, 0xffff0000, v18
    v_and_b32 v157, 0xffff0000, v19
    v_sub_f32 v144, v144, v0
    v_sub_f32 v148, v148, v0
    v_sub_f32 v152, v152, v0
    v_sub_f32 v156, v156, v0
    v_sub_f32 v145, v145, v0
    v_sub_f32 v149, v149, v0
    v_sub_f32 v153, v153, v0
    v_sub_f32 v157, v157, v0
    v_cvt_pk_bf16_f32 v145, v144, v145
    v_cvt_pk_bf16_f32 v149, v148, v149
    v_cvt_pk_bf16_f32 v153, v152, v153
    v_cvt_pk_bf16_f32 v157, v156, v157
    v_lshlrev_b32 v144, 16, v145
    v_lshlrev_b32 v148, 16, v149
    v_lshlrev_b32 v152, 16, v153
    v_lshlrev_b32 v156, 16, v157
    v_and_b32 v145, 0xffff0000, v145
    v_and_b32 v149, 0xffff0000, v149
    v_and_b32 v153, 0xffff0000, v153
    v_and_b32 v157, 0xffff0000, v157
    v_mul_f32 v144, v144, v4
    v_mul_f32 v148, v148, v4
    v_mul_f32 v152, v152, v4
    v_mul_f32 v156, v156, v4
    v_mul_f32 v145, v145, v4
    v_mul_f32 v149, v149, v4
    v_mul_f32 v153, v153, v4
    v_mul_f32 v157, v157, v4
    v_cvt_pk_bf16_f32 v146, v144, v145
    v_cvt_pk_bf16_f32 v150, v148, v149
    v_cvt_pk_bf16_f32 v154, v152, v153
    v_cvt_pk_bf16_f32 v158, v156, v157
    v_lshlrev_b32 v144, 16, v146
    v_lshlrev_b32 v148, 16, v150
    v_lshlrev_b32 v152, 16, v154
    v_lshlrev_b32 v156, 16, v158
    v_and_b32 v145, 0xffff0000, v146
    v_and_b32 v149, 0xffff0000, v150
    v_and_b32 v153, 0xffff0000, v154
    v_and_b32 v157, 0xffff0000, v158
    v_lshlrev_b32 v146, 16, v16
    v_lshlrev_b32 v150, 16, v17
    v_lshlrev_b32 v154, 16, v18
    v_lshlrev_b32 v158, 16, v19
    v_and_b32 v147, 0xffff0000, v16
    v_and_b32 v151, 0xffff0000, v17
    v_and_b32 v155, 0xffff0000, v18
    v_and_b32 v159, 0xffff0000, v19
    v_pk_add_f32 v[144:145], v[144:145], v[146:147]
    v_pk_add_f32 v[148:149], v[148:149], v[150:151]
    v_pk_add_f32 v[152:153], v[152:153], v[154:155]
    v_pk_add_f32 v[156:157], v[156:157], v[158:159]
    v_cvt_pk_bf16_f32 v16, v144, v145
    v_cvt_pk_bf16_f32 v17, v148, v149
    v_cvt_pk_bf16_f32 v18, v152, v153
    v_cvt_pk_bf16_f32 v19, v156, v157
    v_add_u32 v160, 0, v242
    v_cmp_eq_u32 vcc, v160, v8
    v_cmp_eq_u32 s[60:61], v160, v10
    v_mov_b32 v161, 0x40000000
    s_or_b64 vcc, vcc, s[60:61]
    v_cndmask_b32 v12, v229, v161, vcc
    v_lshlrev_b32 v144, 16, v20
    v_lshlrev_b32 v148, 16, v21
    v_lshlrev_b32 v152, 16, v22
    v_lshlrev_b32_e64 v156, 16, v23
    v_and_b32 v145, 0xffff0000, v20
    v_and_b32 v149, 0xffff0000, v21
    v_and_b32 v153, 0xffff0000, v22
    v_and_b32 v157, 0xffff0000, v23
    v_sub_f32 v144, v144, v1
    v_sub_f32 v148, v148, v1
    v_sub_f32 v152, v152, v1
    v_sub_f32 v156, v156, v1
    v_sub_f32 v145, v145, v1
    v_sub_f32 v149, v149, v1
    v_sub_f32 v153, v153, v1
    v_sub_f32 v157, v157, v1
    v_cvt_pk_bf16_f32 v145, v144, v145
    v_cvt_pk_bf16_f32 v149, v148, v149
    v_cvt_pk_bf16_f32 v153, v152, v153
    v_cvt_pk_bf16_f32 v157, v156, v157
    v_lshlrev_b32 v144, 16, v145
    v_lshlrev_b32 v148, 16, v149
    v_lshlrev_b32 v152, 16, v153
    v_lshlrev_b32 v156, 16, v157
    v_and_b32 v145, 0xffff0000, v145
    v_and_b32 v149, 0xffff0000, v149
    v_and_b32 v153, 0xffff0000, v153
    v_and_b32 v157, 0xffff0000, v157
    v_mul_f32 v144, v144, v5
    v_mul_f32 v148, v148, v5
    v_mul_f32 v152, v152, v5
    v_mul_f32 v156, v156, v5
    v_mul_f32 v145, v145, v5
    v_mul_f32 v149, v149, v5
    v_mul_f32 v153, v153, v5
    v_mul_f32 v157, v157, v5
    v_cvt_pk_bf16_f32 v146, v144, v145
    v_cvt_pk_bf16_f32 v150, v148, v149
    v_cvt_pk_bf16_f32 v154, v152, v153
    v_cvt_pk_bf16_f32 v158, v156, v157
    v_lshlrev_b32 v144, 16, v146
    v_lshlrev_b32 v148, 16, v150
    v_lshlrev_b32 v152, 16, v154
    v_lshlrev_b32 v156, 16, v158
    v_and_b32 v145, 0xffff0000, v146
    v_and_b32 v149, 0xffff0000, v150
    v_and_b32 v153, 0xffff0000, v154
    v_and_b32 v157, 0xffff0000, v158
    v_lshlrev_b32 v146, 16, v20
    v_lshlrev_b32 v150, 16, v21
    v_lshlrev_b32 v154, 16, v22
    v_lshlrev_b32 v158, 16, v23
    v_and_b32 v147, 0xffff0000, v20
    v_and_b32 v151, 0xffff0000, v21
    v_and_b32 v155, 0xffff0000, v22
    v_and_b32 v159, 0xffff0000, v23
    v_pk_add_f32 v[144:145], v[144:145], v[146:147]
    v_pk_add_f32 v[148:149], v[148:149], v[150:151]
    v_pk_add_f32 v[152:153], v[152:153], v[154:155]
    v_pk_add_f32 v[156:157], v[156:157], v[158:159]
    v_cvt_pk_bf16_f32 v20, v144, v145
    v_cvt_pk_bf16_f32 v21, v148, v149
    v_cvt_pk_bf16_f32 v22, v152, v153
    v_cvt_pk_bf16_f32 v23, v156, v157
    v_add_u32 v160, 8, v242
    v_cmp_eq_u32 vcc, v160, v8
    v_cmp_eq_u32 s[60:61], v160, v10
    v_mov_b32 v161, 0x40000000
    s_or_b64 vcc, vcc, s[60:61]
    v_cndmask_b32 v13, v229, v161, vcc
    s_waitcnt vmcnt(0)
    s_barrier
    s_cmp_lg_u32 s3, 0
    s_cbranch_scc1 kc_a2
    s_lshl_b32 s32, s52, 7
    s_add_u32 s32, s32, 0x38a0800
    v_mov_b32_e64 v235, 1
    buffer_atomic_add v235, v243, s[8:11], s32 offen sc0 sc1
    v_lshlrev_b32 v234, 7, v237
    v_cmp_gt_u32 vcc, 8, v237
    v_mov_b32_e64 v236, 0x40000000
    s_mov_b32 s34, 0x38a0c00
    v_cndmask_b32 v234, v236, v234, vcc
    s_waitcnt vmcnt(0)
    v_readfirstlane_b32 s36, v235
    s_cmp_lg_u32 s36, 27
    s_cbranch_scc1 kc_a2
    buffer_atomic_add v233, v234, s[8:11], s34 offen sc1
kc_a2:
    v_lshlrev_b32 v144, 16, v24
    v_lshlrev_b32 v148, 16, v25
    v_lshlrev_b32 v152, 16, v26
    v_lshlrev_b32_e64 v156, 16, v27
    v_and_b32 v145, 0xffff0000, v24
    v_and_b32 v149, 0xffff0000, v25
    v_and_b32 v153, 0xffff0000, v26
    v_and_b32 v157, 0xffff0000, v27
    v_sub_f32 v144, v144, v2
    v_sub_f32 v148, v148, v2
    v_sub_f32 v152, v152, v2
    v_sub_f32 v156, v156, v2
    v_sub_f32 v145, v145, v2
    v_sub_f32 v149, v149, v2
    v_sub_f32 v153, v153, v2
    v_sub_f32 v157, v157, v2
    v_cvt_pk_bf16_f32 v145, v144, v145
    v_cvt_pk_bf16_f32 v149, v148, v149
    v_cvt_pk_bf16_f32 v153, v152, v153
    v_cvt_pk_bf16_f32 v157, v156, v157
    v_lshlrev_b32 v144, 16, v145
    v_lshlrev_b32 v148, 16, v149
    v_lshlrev_b32 v152, 16, v153
    v_lshlrev_b32 v156, 16, v157
    v_and_b32 v145, 0xffff0000, v145
    v_and_b32 v149, 0xffff0000, v149
    v_and_b32 v153, 0xffff0000, v153
    v_and_b32 v157, 0xffff0000, v157
    v_mul_f32 v144, v144, v6
    v_mul_f32 v148, v148, v6
    v_mul_f32 v152, v152, v6
    v_mul_f32 v156, v156, v6
    v_mul_f32 v145, v145, v6
    v_mul_f32 v149, v149, v6
    v_mul_f32 v153, v153, v6
    v_mul_f32 v157, v157, v6
    v_cvt_pk_bf16_f32 v146, v144, v145
    v_cvt_pk_bf16_f32 v150, v148, v149
    v_cvt_pk_bf16_f32 v154, v152, v153
    v_cvt_pk_bf16_f32 v158, v156, v157
    v_lshlrev_b32 v144, 16, v146
    v_lshlrev_b32 v148, 16, v150
    v_lshlrev_b32 v152, 16, v154
    v_lshlrev_b32 v156, 16, v158
    v_and_b32 v145, 0xffff0000, v146
    v_and_b32 v149, 0xffff0000, v150
    v_and_b32 v153, 0xffff0000, v154
    v_and_b32 v157, 0xffff0000, v158
    v_lshlrev_b32 v146, 16, v24
    v_lshlrev_b32 v150, 16, v25
    v_lshlrev_b32 v154, 16, v26
    v_lshlrev_b32 v158, 16, v27
    v_and_b32 v147, 0xffff0000, v24
    v_and_b32 v151, 0xffff0000, v25
    v_and_b32 v155, 0xffff0000, v26
    v_and_b32 v159, 0xffff0000, v27
    v_pk_add_f32 v[144:145], v[144:145], v[146:147]
    v_pk_add_f32 v[148:149], v[148:149], v[150:151]
    v_pk_add_f32 v[152:153], v[152:153], v[154:155]
    v_pk_add_f32 v[156:157], v[156:157], v[158:159]
    v_cvt_pk_bf16_f32 v24, v144, v145
    v_cvt_pk_bf16_f32 v25, v148, v149
    v_cvt_pk_bf16_f32 v26, v152, v153
    v_cvt_pk_bf16_f32 v27, v156, v157
    v_add_u32 v160, 16, v242
    v_cmp_eq_u32 vcc, v160, v8
    v_cmp_eq_u32 s[60:61], v160, v10
    v_mov_b32 v161, 0x40000000
    s_or_b64 vcc, vcc, s[60:61]
    v_cndmask_b32 v14, v229, v161, vcc
    v_lshlrev_b32 v144, 16, v28
    v_lshlrev_b32 v148, 16, v29
    v_lshlrev_b32 v152, 16, v30
    v_lshlrev_b32_e64 v156, 16, v31
    v_and_b32 v145, 0xffff0000, v28
    v_and_b32 v149, 0xffff0000, v29
    v_and_b32 v153, 0xffff0000, v30
    v_and_b32 v157, 0xffff0000, v31
    v_sub_f32 v144, v144, v3
    v_sub_f32 v148, v148, v3
    v_sub_f32 v152, v152, v3
    v_sub_f32 v156, v156, v3
    v_sub_f32 v145, v145, v3
    v_sub_f32 v149, v149, v3
    v_sub_f32 v153, v153, v3
    v_sub_f32 v157, v157, v3
    v_cvt_pk_bf16_f32 v145, v144, v145
    v_cvt_pk_bf16_f32 v149, v148, v149
    v_cvt_pk_bf16_f32 v153, v152, v153
    v_cvt_pk_bf16_f32 v157, v156, v157
    v_lshlrev_b32 v144, 16, v145
    v_lshlrev_b32 v148, 16, v149
    v_lshlrev_b32 v152, 16, v153
    v_lshlrev_b32 v156, 16, v157
    v_and_b32 v145, 0xffff0000, v145
    v_and_b32 v149, 0xffff0000, v149
    v_and_b32 v153, 0xffff0000, v153
    v_and_b32 v157, 0xffff0000, v157
    v_mul_f32 v144, v144, v7
    v_mul_f32 v148, v148, v7
    v_mul_f32 v152, v152, v7
    v_mul_f32 v156, v156, v7
    v_mul_f32 v145, v145, v7
    v_mul_f32 v149, v149, v7
    v_mul_f32 v153, v153, v7
    v_mul_f32 v157, v157, v7
    v_cvt_pk_bf16_f32 v146, v144, v145
    v_cvt_pk_bf16_f32 v150, v148, v149
    v_cvt_pk_bf16_f32 v154, v152, v153
    v_cvt_pk_bf16_f32 v158, v156, v157
    v_lshlrev_b32 v144, 16, v146
    v_lshlrev_b32 v148, 16, v150
    v_lshlrev_b32 v152, 16, v154
    v_lshlrev_b32 v156, 16, v158
    v_and_b32 v145, 0xffff0000, v146
    v_and_b32 v149, 0xffff0000, v150
    v_and_b32 v153, 0xffff0000, v154
    v_and_b32 v157, 0xffff0000, v158
    v_lshlrev_b32 v146, 16, v28
    v_lshlrev_b32 v150, 16, v29
    v_lshlrev_b32 v154, 16, v30
    v_lshlrev_b32 v158, 16, v31
    v_and_b32 v147, 0xffff0000, v28
    v_and_b32 v151, 0xffff0000, v29
    v_and_b32 v155, 0xffff0000, v30
    v_and_b32 v159, 0xffff0000, v31
    v_pk_add_f32 v[144:145], v[144:145], v[146:147]
    v_pk_add_f32 v[148:149], v[148:149], v[150:151]
    v_pk_add_f32 v[152:153], v[152:153], v[154:155]
    v_pk_add_f32 v[156:157], v[156:157], v[158:159]
    v_cvt_pk_bf16_f32 v28, v144, v145
    v_cvt_pk_bf16_f32 v29, v148, v149
    v_cvt_pk_bf16_f32 v30, v152, v153
    v_cvt_pk_bf16_f32 v31, v156, v157
    v_add_u32 v160, 24, v242
    v_cmp_eq_u32 vcc, v160, v8
    v_cmp_eq_u32 s[60:61], v160, v10
    v_mov_b32 v161, 0x40000000
    s_or_b64 vcc, vcc, s[60:61]
    v_cndmask_b32 v15, v229, v161, vcc
    s_mov_b32 s32, 0
    buffer_store_dwordx4 v[16:19], v12, s[28:31], s32 offen nt
    s_mov_b32 s32, 16384
    buffer_store_dwordx4 v[20:23], v13, s[28:31], s32 offen nt
    s_mov_b32 s32, 32768
    buffer_store_dwordx4 v[24:27], v14, s[28:31], s32 offen nt
    s_mov_b32 s32, 49152
    buffer_store_dwordx4 v[28:31], v15, s[28:31], s32 offen nt
    s_branch kc_fin
kc_red:
    v_lshlrev_b32 v144, 16, v16
    v_lshlrev_b32 v148, 16, v17
    v_lshlrev_b32 v152, 16, v18
    v_lshlrev_b32_e64 v156, 16, v19
    v_and_b32 v145, 0xffff0000, v16
    v_and_b32 v149, 0xffff0000, v17
    v_and_b32 v153, 0xffff0000, v18
    v_and_b32 v157, 0xffff0000, v19
    v_sub_f32 v144, v144, v0
    v_sub_f32 v148, v148, v0
    v_sub_f32 v152, v152, v0
    v_sub_f32 v156, v156, v0
    v_sub_f32 v145, v145, v0
    v_sub_f32 v149, v149, v0
    v_sub_f32 v153, v153, v0
    v_sub_f32 v157, v157, v0
    v_cvt_pk_bf16_f32 v145, v144, v145
    v_cvt_pk_bf16_f32 v149, v148, v149
    v_cvt_pk_bf16_f32 v153, v152, v153
    v_cvt_pk_bf16_f32 v157, v156, v157
    v_lshlrev_b32 v144, 16, v145
    v_lshlrev_b32 v148, 16, v149
    v_lshlrev_b32 v152, 16, v153
    v_lshlrev_b32 v156, 16, v157
    v_and_b32 v145, 0xffff0000, v145
    v_and_b32 v149, 0xffff0000, v149
    v_and_b32 v153, 0xffff0000, v153
    v_and_b32 v157, 0xffff0000, v157
    v_mul_f32 v144, v144, v4
    v_mul_f32 v148, v148, v4
    v_mul_f32 v152, v152, v4
    v_mul_f32 v156, v156, v4
    v_mul_f32 v145, v145, v4
    v_mul_f32 v149, v149, v4
    v_mul_f32 v153, v153, v4
    v_mul_f32 v157, v157, v4
    v_cvt_pk_bf16_f32 v146, v144, v145
    v_cvt_pk_bf16_f32 v150, v148, v149
    v_cvt_pk_bf16_f32 v154, v152, v153
    v_cvt_pk_bf16_f32 v158, v156, v157
    v_lshlrev_b32 v144, 16, v146
    v_lshlrev_b32 v148, 16, v150
    v_lshlrev_b32 v152, 16, v154
    v_lshlrev_b32 v156, 16, v158
    v_and_b32 v145, 0xffff0000, v146
    v_and_b32 v149, 0xffff0000, v150
    v_and_b32 v153, 0xffff0000, v154
    v_and_b32 v157, 0xffff0000, v158
    v_lshlrev_b32 v146, 16, v16
    v_lshlrev_b32 v150, 16, v17
    v_lshlrev_b32 v154, 16, v18
    v_lshlrev_b32 v158, 16, v19
    v_and_b32 v147, 0xffff0000, v16
    v_and_b32 v151, 0xffff0000, v17
    v_and_b32 v155, 0xffff0000, v18
    v_and_b32 v159, 0xffff0000, v19
    v_pk_add_f32 v[144:145], v[144:145], v[146:147]
    v_pk_add_f32 v[148:149], v[148:149], v[150:151]
    v_pk_add_f32 v[152:153], v[152:153], v[154:155]
    v_pk_add_f32 v[156:157], v[156:157], v[158:159]
    v_cvt_pk_bf16_f32 v16, v144, v145
    v_cvt_pk_bf16_f32 v17, v148, v149
    v_cvt_pk_bf16_f32 v18, v152, v153
    v_cvt_pk_bf16_f32 v19, v156, v157
    v_add_u32 v160, 0, v242
    v_cmp_eq_u32 vcc, v160, v8
    v_cmp_eq_u32 s[60:61], v160, v10
    v_mov_b32 v161, 0x40000000
    s_or_b64 vcc, vcc, s[60:61]
    v_cndmask_b32 v12, v229, v161, vcc
    v_lshlrev_b32 v144, 16, v20
    v_lshlrev_b32 v148, 16, v21
    v_lshlrev_b32 v152, 16, v22
    v_lshlrev_b32_e64 v156, 16, v23
    v_and_b32 v145, 0xffff0000, v20
    v_and_b32 v149, 0xffff0000, v21
    v_and_b32 v153, 0xffff0000, v22
    v_and_b32 v157, 0xffff0000, v23
    v_sub_f32 v144, v144, v1
    v_sub_f32 v148, v148, v1
    v_sub_f32 v152, v152, v1
    v_sub_f32 v156, v156, v1
    v_sub_f32 v145, v145, v1
    v_sub_f32 v149, v149, v1
    v_sub_f32 v153, v153, v1
    v_sub_f32 v157, v157, v1
    v_cvt_pk_bf16_f32 v145, v144, v145
    v_cvt_pk_bf16_f32 v149, v148, v149
    v_cvt_pk_bf16_f32 v153, v152, v153
    v_cvt_pk_bf16_f32 v157, v156, v157
    v_lshlrev_b32 v144, 16, v145
    v_lshlrev_b32 v148, 16, v149
    v_lshlrev_b32 v152, 16, v153
    v_lshlrev_b32 v156, 16, v157
    v_and_b32 v145, 0xffff0000, v145
    v_and_b32 v149, 0xffff0000, v149
    v_and_b32 v153, 0xffff0000, v153
    v_and_b32 v157, 0xffff0000, v157
    v_mul_f32 v144, v144, v5
    v_mul_f32 v148, v148, v5
    v_mul_f32 v152, v152, v5
    v_mul_f32 v156, v156, v5
    v_mul_f32 v145, v145, v5
    v_mul_f32 v149, v149, v5
    v_mul_f32 v153, v153, v5
    v_mul_f32 v157, v157, v5
    v_cvt_pk_bf16_f32 v146, v144, v145
    v_cvt_pk_bf16_f32 v150, v148, v149
    v_cvt_pk_bf16_f32 v154, v152, v153
    v_cvt_pk_bf16_f32 v158, v156, v157
    v_lshlrev_b32 v144, 16, v146
    v_lshlrev_b32 v148, 16, v150
    v_lshlrev_b32 v152, 16, v154
    v_lshlrev_b32 v156, 16, v158
    v_and_b32 v145, 0xffff0000, v146
    v_and_b32 v149, 0xffff0000, v150
    v_and_b32 v153, 0xffff0000, v154
    v_and_b32 v157, 0xffff0000, v158
    v_lshlrev_b32 v146, 16, v20
    v_lshlrev_b32 v150, 16, v21
    v_lshlrev_b32 v154, 16, v22
    v_lshlrev_b32 v158, 16, v23
    v_and_b32 v147, 0xffff0000, v20
    v_and_b32 v151, 0xffff0000, v21
    v_and_b32 v155, 0xffff0000, v22
    v_and_b32 v159, 0xffff0000, v23
    v_pk_add_f32 v[144:145], v[144:145], v[146:147]
    v_pk_add_f32 v[148:149], v[148:149], v[150:151]
    v_pk_add_f32 v[152:153], v[152:153], v[154:155]
    v_pk_add_f32 v[156:157], v[156:157], v[158:159]
    v_cvt_pk_bf16_f32 v20, v144, v145
    v_cvt_pk_bf16_f32 v21, v148, v149
    v_cvt_pk_bf16_f32 v22, v152, v153
    v_cvt_pk_bf16_f32 v23, v156, v157
    v_add_u32 v160, 8, v242
    v_cmp_eq_u32 vcc, v160, v8
    v_cmp_eq_u32 s[60:61], v160, v10
    v_mov_b32 v161, 0x40000000
    s_or_b64 vcc, vcc, s[60:61]
    v_cndmask_b32 v13, v229, v161, vcc
    v_lshlrev_b32 v144, 16, v24
    v_lshlrev_b32 v148, 16, v25
    v_lshlrev_b32 v152, 16, v26
    v_lshlrev_b32_e64 v156, 16, v27
    v_and_b32 v145, 0xffff0000, v24
    v_and_b32 v149, 0xffff0000, v25
    v_and_b32 v153, 0xffff0000, v26
    v_and_b32 v157, 0xffff0000, v27
    v_sub_f32 v144, v144, v2
    v_sub_f32 v148, v148, v2
    v_sub_f32 v152, v152, v2
    v_sub_f32 v156, v156, v2
    v_sub_f32 v145, v145, v2
    v_sub_f32 v149, v149, v2
    v_sub_f32 v153, v153, v2
    v_sub_f32 v157, v157, v2
    v_cvt_pk_bf16_f32 v145, v144, v145
    v_cvt_pk_bf16_f32 v149, v148, v149
    v_cvt_pk_bf16_f32 v153, v152, v153
    v_cvt_pk_bf16_f32 v157, v156, v157
    v_lshlrev_b32 v144, 16, v145
    v_lshlrev_b32 v148, 16, v149
    v_lshlrev_b32 v152, 16, v153
    v_lshlrev_b32 v156, 16, v157
    v_and_b32 v145, 0xffff0000, v145
    v_and_b32 v149, 0xffff0000, v149
    v_and_b32 v153, 0xffff0000, v153
    v_and_b32 v157, 0xffff0000, v157
    v_mul_f32 v144, v144, v6
    v_mul_f32 v148, v148, v6
    v_mul_f32 v152, v152, v6
    v_mul_f32 v156, v156, v6
    v_mul_f32 v145, v145, v6
    v_mul_f32 v149, v149, v6
    v_mul_f32 v153, v153, v6
    v_mul_f32 v157, v157, v6
    v_cvt_pk_bf16_f32 v146, v144, v145
    v_cvt_pk_bf16_f32 v150, v148, v149
    v_cvt_pk_bf16_f32 v154, v152, v153
    v_cvt_pk_bf16_f32 v158, v156, v157
    v_lshlrev_b32 v144, 16, v146
    v_lshlrev_b32 v148, 16, v150
    v_lshlrev_b32 v152, 16, v154
    v_lshlrev_b32 v156, 16, v158
    v_and_b32 v145, 0xffff0000, v146
    v_and_b32 v149, 0xffff0000, v150
    v_and_b32 v153, 0xffff0000, v154
    v_and_b32 v157, 0xffff0000, v158
    v_lshlrev_b32 v146, 16, v24
    v_lshlrev_b32 v150, 16, v25
    v_lshlrev_b32 v154, 16, v26
    v_lshlrev_b32 v158, 16, v27
    v_and_b32 v147, 0xffff0000, v24
    v_and_b32 v151, 0xffff0000, v25
    v_and_b32 v155, 0xffff0000, v26
    v_and_b32 v159, 0xffff0000, v27
    v_pk_add_f32 v[144:145], v[144:145], v[146:147]
    v_pk_add_f32 v[148:149], v[148:149], v[150:151]
    v_pk_add_f32 v[152:153], v[152:153], v[154:155]
    v_pk_add_f32 v[156:157], v[156:157], v[158:159]
    v_cvt_pk_bf16_f32 v24, v144, v145
    v_cvt_pk_bf16_f32 v25, v148, v149
    v_cvt_pk_bf16_f32 v26, v152, v153
    v_cvt_pk_bf16_f32 v27, v156, v157
    v_add_u32 v160, 16, v242
    v_cmp_eq_u32 vcc, v160, v8
    v_cmp_eq_u32 s[60:61], v160, v10
    v_mov_b32 v161, 0x40000000
    s_or_b64 vcc, vcc, s[60:61]
    v_cndmask_b32 v14, v229, v161, vcc
    v_lshlrev_b32 v144, 16, v28
    v_lshlrev_b32 v148, 16, v29
    v_lshlrev_b32 v152, 16, v30
    v_lshlrev_b32_e64 v156, 16, v31
    v_and_b32 v145, 0xffff0000, v28
    v_and_b32 v149, 0xffff0000, v29
    v_and_b32 v153, 0xffff0000, v30
    v_and_b32 v157, 0xffff0000, v31
    v_sub_f32 v144, v144, v3
    v_sub_f32 v148, v148, v3
    v_sub_f32 v152, v152, v3
    v_sub_f32 v156, v156, v3
    v_sub_f32 v145, v145, v3
    v_sub_f32 v149, v149, v3
    v_sub_f32 v153, v153, v3
    v_sub_f32 v157, v157, v3
    v_cvt_pk_bf16_f32 v145, v144, v145
    v_cvt_pk_bf16_f32 v149, v148, v149
    v_cvt_pk_bf16_f32 v153, v152, v153
    v_cvt_pk_bf16_f32 v157, v156, v157
    v_lshlrev_b32 v144, 16, v145
    v_lshlrev_b32 v148, 16, v149
    v_lshlrev_b32 v152, 16, v153
    v_lshlrev_b32 v156, 16, v157
    v_and_b32 v145, 0xffff0000, v145
    v_and_b32 v149, 0xffff0000, v149
    v_and_b32 v153, 0xffff0000, v153
    v_and_b32 v157, 0xffff0000, v157
    v_mul_f32 v144, v144, v7
    v_mul_f32 v148, v148, v7
    v_mul_f32 v152, v152, v7
    v_mul_f32 v156, v156, v7
    v_mul_f32 v145, v145, v7
    v_mul_f32 v149, v149, v7
    v_mul_f32 v153, v153, v7
    v_mul_f32 v157, v157, v7
    v_cvt_pk_bf16_f32 v146, v144, v145
    v_cvt_pk_bf16_f32 v150, v148, v149
    v_cvt_pk_bf16_f32 v154, v152, v153
    v_cvt_pk_bf16_f32 v158, v156, v157
    v_lshlrev_b32 v144, 16, v146
    v_lshlrev_b32 v148, 16, v150
    v_lshlrev_b32 v152, 16, v154
    v_lshlrev_b32 v156, 16, v158
    v_and_b32 v145, 0xffff0000, v146
    v_and_b32 v149, 0xffff0000, v150
    v_and_b32 v153, 0xffff0000, v154
    v_and_b32 v157, 0xffff0000, v158
    v_lshlrev_b32 v146, 16, v28
    v_lshlrev_b32 v150, 16, v29
    v_lshlrev_b32 v154, 16, v30
    v_lshlrev_b32 v158, 16, v31
    v_and_b32 v147, 0xffff0000, v28
    v_and_b32 v151, 0xffff0000, v29
    v_and_b32 v155, 0xffff0000, v30
    v_and_b32 v159, 0xffff0000, v31
    v_pk_add_f32 v[144:145], v[144:145], v[146:147]
    v_pk_add_f32 v[148:149], v[148:149], v[150:151]
    v_pk_add_f32 v[152:153], v[152:153], v[154:155]
    v_pk_add_f32 v[156:157], v[156:157], v[158:159]
    v_cvt_pk_bf16_f32 v28, v144, v145
    v_cvt_pk_bf16_f32 v29, v148, v149
    v_cvt_pk_bf16_f32 v30, v152, v153
    v_cvt_pk_bf16_f32 v31, v156, v157
    v_add_u32 v160, 24, v242
    v_cmp_eq_u32 vcc, v160, v8
    v_cmp_eq_u32 s[60:61], v160, v10
    v_mov_b32 v161, 0x40000000
    s_or_b64 vcc, vcc, s[60:61]
    v_cndmask_b32 v15, v229, v161, vcc
    s_mov_b32 s32, 0
    buffer_store_dwordx4 v[16:19], v12, s[28:31], s32 offen nt
    s_mov_b32 s32, 16384
    buffer_store_dwordx4 v[20:23], v13, s[28:31], s32 offen nt
    s_mov_b32 s32, 32768
    buffer_store_dwordx4 v[24:27], v14, s[28:31], s32 offen nt
    s_mov_b32 s32, 49152
    buffer_store_dwordx4 v[28:31], v15, s[28:31], s32 offen nt
    s_sub_u32 s54, s2, 224
    v_lshrrev_b32 v234, 4, v230
    v_lshlrev_b32 v234, 13, v234
    v_and_b32_e64 v235, 15, v237
    v_lshl_add_u32 v217, v235, 4, v234
    s_lshl_b32 s35, s54, 8
    s_add_u32 s35, s35, 0x3900000
    v_bfe_u32 v234, v237, 4, 1
    v_lshrrev_b32 v236, 5, v237
    v_lshl_add_u32 v234, v234, 1, v236
    v_lshl_add_u32 v234, v235, 2, v234
    s_lshl_b32 s32, s54, 6
    v_add_u32 v234, s32, v234
    v_lshlrev_b32_e64 v218, 1, v234
    v_add_u32 v234, 98304, v218
    ds_read_u16 v100, v234
    ds_read_u16 v101, v234 offset:4096
    s_cmp_lt_u32 s54, 16
    s_cselect_b64 vcc, -1, 0
    v_cndmask_b32 v102, v10, v8, vcc
    s_cselect_b32 s32, 0, 4
    s_add_u32 s32, s32, 106496
    v_mov_b32_e64 v234, s32
    ds_read_b32 v103, v234
    s_waitcnt lgkmcnt(0)
    v_cvt_pk_bf16_f32 v103, v103, v103
    v_lshlrev_b32 v103, 16, v103
    v_mul_f32 v103, 0xbfb8aa3b, v103
    v_exp_f32 v103, v103
    s_nop 0
    v_add_f32 v103, 1.0, v103
    v_rcp_f32_e64 v103, v103
    s_nop 0
    v_cvt_pk_bf16_f32 v103, v103, v103
    v_lshlrev_b32_e64 v103, 16, v103
    v_and_b32 v218, 2047, v218
    v_lshl_add_u32 v218, v102, 11, v218
    v_lshlrev_b32_e64 v220, 2, v230
    v_add_u32 v220, 106752, v220
    v_lshlrev_b32_e64 v221, 2, v237
    v_add_u32 v221, 106752, v221
    s_cmp_lg_u32 s3, 0
    s_cbranch_scc1 kc_b22
    s_lshl_b32 s32, s52, 7
    s_add_u32 s32, s32, 0x38a0c00
    s_mov_b32 s34, 0x400000
    s_branch kc_b21
kc_b20:
    s_sleep 2
kc_b21:
    buffer_load_dword v235, off, s[8:11], s32 sc1
    s_waitcnt vmcnt(0)
    v_cmp_ne_u32 vcc, 8, v235
    s_sub_u32 s34, s34, 1
    s_cbranch_scc1 kc_b22
    s_cbranch_vccnz kc_b20
kc_b22:
    s_barrier
    s_add_u32 s32, s35, 0
    buffer_load_dwordx4 v[32:35], v217, s[8:11], s32 offen sc1
    s_add_u32 s32, s35, 131072
    buffer_load_dwordx4 v[36:39], v217, s[8:11], s32 offen sc1
    s_add_u32 s32, s35, 262144
    buffer_load_dwordx4 v[40:43], v217, s[8:11], s32 offen sc1
    s_add_u32 s32, s35, 393216
    buffer_load_dwordx4 v[44:47], v217, s[8:11], s32 offen sc1
    s_add_u32 s32, s35, 524288
    buffer_load_dwordx4 v[48:51], v217, s[8:11], s32 offen sc1
    s_add_u32 s32, s35, 655360
    buffer_load_dwordx4 v[52:55], v217, s[8:11], s32 offen sc1
    s_add_u32 s32, s35, 786432
    buffer_load_dwordx4 v[56:59], v217, s[8:11], s32 offen sc1
    s_add_u32 s32, s35, 917504
    buffer_load_dwordx4 v[60:63], v217, s[8:11], s32 offen sc1
    s_add_u32 s32, s35, 1048576
    buffer_load_dwordx4 v[64:67], v217, s[8:11], s32 offen sc1
    s_add_u32 s32, s35, 1179648
    buffer_load_dwordx4 v[68:71], v217, s[8:11], s32 offen sc1
    s_add_u32 s32, s35, 1310720
    buffer_load_dwordx4 v[72:75], v217, s[8:11], s32 offen sc1
    s_add_u32 s32, s35, 1441792
    buffer_load_dwordx4 v[76:79], v217, s[8:11], s32 offen sc1
    s_add_u32 s32, s35, 1572864
    buffer_load_dwordx4 v[80:83], v217, s[8:11], s32 offen sc1
    s_add_u32 s32, s35, 1703936
    buffer_load_dwordx4 v[84:87], v217, s[8:11], s32 offen sc1
    s_waitcnt vmcnt(12)
    v_pk_add_f32 v[32:33], v[32:33], v[36:37]
    v_pk_add_f32 v[34:35], v[34:35], v[38:39]
    s_waitcnt vmcnt(11)
    v_pk_add_f32 v[32:33], v[32:33], v[40:41]
    v_pk_add_f32 v[34:35], v[34:35], v[42:43]
    s_waitcnt vmcnt(10)
    v_pk_add_f32 v[32:33], v[32:33], v[44:45]
    v_pk_add_f32 v[34:35], v[34:35], v[46:47]
    s_waitcnt vmcnt(9)
    v_pk_add_f32 v[32:33], v[32:33], v[48:49]
    v_pk_add_f32 v[34:35], v[34:35], v[50:51]
    s_waitcnt vmcnt(8)
    v_pk_add_f32 v[32:33], v[32:33], v[52:53]
    v_pk_add_f32 v[34:35], v[34:35], v[54:55]
    s_waitcnt vmcnt(7)
    v_pk_add_f32 v[32:33], v[32:33], v[56:57]
    v_pk_add_f32 v[34:35], v[34:35], v[58:59]
    s_waitcnt vmcnt(6)
    v_pk_add_f32 v[32:33], v[32:33], v[60:61]
    v_pk_add_f32 v[34:35], v[34:35], v[62:63]
    s_waitcnt vmcnt(5)
    v_pk_add_f32 v[32:33], v[32:33], v[64:65]
    v_pk_add_f32 v[34:35], v[34:35], v[66:67]
    s_waitcnt vmcnt(4)
    v_pk_add_f32 v[32:33], v[32:33], v[68:69]
    v_pk_add_f32 v[34:35], v[34:35], v[70:71]
    s_waitcnt vmcnt(3)
    v_pk_add_f32 v[32:33], v[32:33], v[72:73]
    v_pk_add_f32 v[34:35], v[34:35], v[74:75]
    s_waitcnt vmcnt(2)
    v_pk_add_f32 v[32:33], v[32:33], v[76:77]
    v_pk_add_f32 v[34:35], v[34:35], v[78:79]
    s_waitcnt vmcnt(1)
    v_pk_add_f32 v[32:33], v[32:33], v[80:81]
    v_pk_add_f32 v[34:35], v[34:35], v[82:83]
    s_waitcnt vmcnt(0)
    v_pk_add_f32 v[32:33], v[32:33], v[84:85]
    v_pk_add_f32 v[34:35], v[34:35], v[86:87]
    s_nop 1
    v_permlane32_swap_b32 v32, v33
    v_permlane32_swap_b32 v34, v35
    s_nop 0
    v_add_f32 v32, v32, v33
    v_add_f32 v34, v34, v35
    s_nop 1
    v_permlane16_swap_b32 v32, v34
    s_nop 0
    v_add_f32_e64 v32, v32, v34
    ds_write_b32 v220, v32
    s_waitcnt lgkmcnt(0)
    s_barrier
    s_cmp_lg_u32 s3, 0
    s_cbranch_scc1 kc_fin
    ds_read_b32 v32, v221
    ds_read_b32 v33, v221 offset:256
    ds_read_b32 v34, v221 offset:512
    ds_read_b32 v35, v221 offset:768
    v_lshlrev_b32 v100, 16, v100
    v_lshlrev_b32 v101, 16, v101
    s_waitcnt lgkmcnt(0)
    v_add_f32 v32, v32, v33
    v_add_f32 v34, v34, v35
    v_add_f32 v32, v32, v34
    v_cvt_pk_bf16_f32 v32, v32, v32
    v_lshlrev_b32 v32, 16, v32
    v_mul_f32 v32, v32, v103
    v_cvt_pk_bf16_f32 v32, v32, v32
    v_lshlrev_b32 v32, 16, v32
    v_add_f32 v32, v32, v100
    v_cvt_pk_bf16_f32 v32, v32, v32
    v_lshlrev_b32 v32, 16, v32
    v_add_f32 v32, v32, v101
    v_cvt_pk_bf16_f32 v32, v32, v32
    buffer_store_short v32, v218, s[28:31], 0 offen
kc_fin:
    s_endpgm
kc_r3:
    s_mov_b32 s34, 0x400000
kc_r3l:
    s_sleep 4
    buffer_load_dwordx4 v[176:179], v228, s[8:11], s7 offen offset:0 sc1
    buffer_load_dwordx4 v[180:183], v228, s[8:11], s7 offen offset:1024 sc1
    buffer_load_dwordx4 v[184:187], v228, s[8:11], s7 offen offset:2048 sc1
    buffer_load_dwordx4 v[188:191], v228, s[8:11], s7 offen offset:3072 sc1
    s_waitcnt vmcnt(0)
    v_max3_u32 v235, v176, v177, v178
    v_max3_u32 v235, v235, v179, v180
    v_max3_u32 v235, v235, v181, v182
    v_max3_u32 v235, v235, v183, v184
    v_max3_u32 v235, v235, v185, v186
    v_max3_u32 v235, v235, v187, v188
    v_max3_u32 v235, v235, v189, v190
    v_max_u32 v235, v235, v191
    v_cmp_eq_u32 vcc, -1, v235
    s_sub_u32 s34, s34, 1
    s_cbranch_scc1 kc_r3o
    s_cbranch_vccnz kc_r3l
    s_branch kc_r3o
kc_r1:
    s_mov_b32 s34, 0x400000
kc_r1l:
    s_sleep 4
    buffer_load_dwordx4 v[96:99], v228, s[8:11], s37 offen offset:0 sc1
    buffer_load_dwordx4 v[100:103], v228, s[8:11], s37 offen offset:1024 sc1
    buffer_load_dwordx4 v[104:107], v228, s[8:11], s37 offen offset:2048 sc1
    buffer_load_dwordx4 v[108:111], v228, s[8:11], s37 offen offset:3072 sc1
    s_waitcnt vmcnt(0)
    v_max3_u32 v235, v96, v97, v98
    v_max3_u32 v235, v235, v99, v100
    v_max3_u32 v235, v235, v101, v102
    v_max3_u32 v235, v235, v103, v104
    v_max3_u32 v235, v235, v105, v106
    v_max3_u32 v235, v235, v107, v108
    v_max3_u32 v235, v235, v109, v110
    v_max_u32 v235, v235, v111
    v_cmp_eq_u32 vcc, -1, v235
    s_sub_u32 s34, s34, 1
    s_cbranch_scc1 kc_r1o
    s_cbranch_vccnz kc_r1l
    s_branch kc_r1o
kc_r2:
    s_mov_b32 s34, 0x400000
kc_r2l:
    s_sleep 4
    buffer_load_dwordx4 v[160:163], v228, s[8:11], s38 offen offset:0 sc1
    buffer_load_dwordx4 v[164:167], v228, s[8:11], s38 offen offset:1024 sc1
    buffer_load_dwordx4 v[168:171], v228, s[8:11], s38 offen offset:2048 sc1
    buffer_load_dwordx4 v[172:175], v228, s[8:11], s38 offen offset:3072 sc1
    s_waitcnt vmcnt(0)
    v_max3_u32 v235, v160, v161, v162
    v_max3_u32 v235, v235, v163, v164
    v_max3_u32 v235, v235, v165, v166
    v_max3_u32 v235, v235, v167, v168
    v_max3_u32 v235, v235, v169, v170
    v_max3_u32 v235, v235, v171, v172
    v_max3_u32 v235, v235, v173, v174
    v_max_u32 v235, v235, v175
    v_cmp_eq_u32 vcc, -1, v235
    s_sub_u32 s34, s34, 1
    s_cbranch_scc1 kc_r2o
    s_cbranch_vccnz kc_r2l
    s_branch kc_r2o
kc_g:
    s_mov_b32 s34, 0x400000
    s_branch kc_gs1
kc_gs0:
    s_sleep 2
kc_gs1:
    buffer_load_dword v235, off, s[8:11], s45 sc1
    s_waitcnt vmcnt(0)
    v_cmp_ne_u32_e64 vcc, 8, v235
    s_sub_u32 s34, s34, 1
    s_cbranch_scc1 kc_gs2
    s_cbranch_vccnz kc_gs0
kc_gs2:
    s_branch kc_gr
kc_end:
ka_done:
    s_endpgm
kf_fix1:
    s_cmp_eq_u32 s33, 0
    s_cselect_b32 s24, 0, 0x74000000
    s_cselect_b32 s36, 0, 0x1000
    s_mov_b32 s33, 1
    v_subrev_f32 v230, s24, v243
    v_add_f32 v231, 0, v230
    v_min_f32 v64, v224, v231
    v_add_f32 v232, 0xf1800000, v230
    v_min_f32_e64 v65, v224, v232
    v_add_f32 v231, 0xf2000000, v230
    v_min_f32_e64 v66, v224, v231
    v_add_f32 v232, 0xf2400000, v230
    v_min_f32_e64 v67, v224, v232
    v_add_f32 v231, 0xf3000000, v230
    v_min_f32_e64 v68, v224, v231
    v_add_f32 v232, 0xf3100000, v230
    v_min_f32_e64 v69, v224, v232
    v_add_f32 v231, 0xf3200000, v230
    v_min_f32_e64 v70, v224, v231
    v_add_f32 v232, 0xf3300000, v230
    v_min_f32_e64 v71, v224, v232
    v_add_f32 v231, 0x73800000, v230
    v_min_f32_e64 v72, v225, v231
    v_add_f32 v232, 0x73700000, v230
    v_min_f32_e64 v73, v225, v232
    v_add_f32 v231, 0x73600000, v230
    v_min_f32_e64 v74, v225, v231
    v_add_f32 v232, 0x73500000, v230
    v_min_f32_e64 v75, v225, v232
    v_add_f32 v231, 0x73000000, v230
    v_min_f32_e64 v76, v225, v231
    v_add_f32 v232, 0x72e00000, v230
    v_min_f32_e64 v77, v225, v232
    v_add_f32 v231, 0x72c00000, v230
    v_min_f32_e64 v78, v225, v231
    v_add_f32 v232, 0x72a00000, v230
    v_min_f32 v79, v225, v232
    s_nop 1
    s_branch kf_fixr2
kf_fix3:
    s_cmp_eq_u32 s33, 0
    s_cselect_b32 s24, 0, 0x74000000
    s_cselect_b32 s36, 0, 0x1000
    s_mov_b32 s33, 1
    v_subrev_f32 v230, s24, v243
    v_add_f32 v231, 0, v230
    v_min_f32 v64, v224, v231
    v_add_f32 v232, 0xf1800000, v230
    v_min_f32_e64 v65, v224, v232
    v_add_f32 v231, 0xf2000000, v230
    v_min_f32_e64 v66, v224, v231
    v_add_f32 v232, 0xf2400000, v230
    v_min_f32_e64 v67, v224, v232
    v_add_f32 v231, 0xf3000000, v230
    v_min_f32_e64 v68, v224, v231
    v_add_f32 v232, 0xf3100000, v230
    v_min_f32_e64 v69, v224, v232
    v_add_f32 v231, 0xf3200000, v230
    v_min_f32_e64 v70, v224, v231
    v_add_f32 v232, 0xf3300000, v230
    v_min_f32_e64 v71, v224, v232
    v_add_f32 v231, 0x73800000, v230
    v_min_f32_e64 v72, v225, v231
    v_add_f32 v232, 0x73700000, v230
    v_min_f32_e64 v73, v225, v232
    v_add_f32 v231, 0x73600000, v230
    v_min_f32_e64 v74, v225, v231
    v_add_f32 v232, 0x73500000, v230
    v_min_f32_e64 v75, v225, v232
    v_add_f32 v231, 0x73000000, v230
    v_min_f32_e64 v76, v225, v231
    v_add_f32 v232, 0x72e00000, v230
    v_min_f32_e64 v77, v225, v232
    v_add_f32 v231, 0x72c00000, v230
    v_min_f32_e64 v78, v225, v231
    v_add_f32 v232, 0x72a00000, v230
    v_min_f32 v79, v225, v232
    s_nop 1
    s_branch kf_fixr4
kf_rare6:
    s_nop 15
    v_max3_f32 v230, v32, v33, v34
    v_max3_f32 v230, v230, v35, v36
    v_max3_f32 v230, v230, v37, v38
    v_max_f32 v230, v230, v39
    v_mov_b32 v231, v230
    s_nop 1
    v_permlane16_swap_b32 v230, v231
    s_nop 0
    v_max_f32 v230, v230, v231
    v_mov_b32 v231, v230
    s_nop 1
    v_permlane32_swap_b32 v230, v231
    s_nop 0
    v_max_f32_e64 v230, v230, v231
    v_add_f32 v230, 0x41800000, v230
    v_max_f32 v230, 0, v230
    v_sub_f32 v232, 0, v230
    v_exp_f32 v232, v232
    v_sub_f32 v224, v224, v230
    v_sub_f32 v64, v64, v230
    v_sub_f32 v0, v0, v230
    v_sub_f32 v32, v32, v230
    v_sub_f32 v65, v65, v230
    v_sub_f32 v1, v1, v230
    v_sub_f32 v33, v33, v230
    v_sub_f32 v66, v66, v230
    v_sub_f32 v2, v2, v230
    v_sub_f32 v34, v34, v230
    v_sub_f32 v67, v67, v230
    v_sub_f32 v3, v3, v230
    v_sub_f32 v35, v35, v230
    v_sub_f32 v68, v68, v230
    v_sub_f32 v4, v4, v230
    v_sub_f32 v36, v36, v230
    v_sub_f32 v69, v69, v230
    v_sub_f32 v5, v5, v230
    v_sub_f32 v37, v37, v230
    v_sub_f32 v70, v70, v230
    v_sub_f32 v6, v6, v230
    v_sub_f32 v38, v38, v230
    v_sub_f32 v71, v71, v230
    v_sub_f32 v7, v7, v230
    v_sub_f32 v39, v39, v230
    v_mul_f32 v144, v144, v232
    v_mul_f32 v145, v145, v232
    v_mul_f32 v146, v146, v232
    v_mul_f32 v147, v147, v232
    v_accvgpr_read_b32 v233, a0
    v_mul_f32_e64 v233, v233, v232
    v_accvgpr_write_b32 a0, v233
    v_accvgpr_read_b32 v234, a1
    v_mul_f32_e64 v234, v234, v232
    v_accvgpr_write_b32 a1, v234
    v_accvgpr_read_b32 v235, a2
    v_mul_f32_e64 v235, v235, v232
    v_accvgpr_write_b32 a2, v235
    v_accvgpr_read_b32 v236, a3
    v_mul_f32_e64 v236, v236, v232
    v_accvgpr_write_b32 a3, v236
    v_accvgpr_read_b32 v233, a4
    v_mul_f32_e64 v233, v233, v232
    v_accvgpr_write_b32 a4, v233
    v_accvgpr_read_b32 v234, a5
    v_mul_f32_e64 v234, v234, v232
    v_accvgpr_write_b32 a5, v234
    v_accvgpr_read_b32 v235, a6
    v_mul_f32_e64 v235, v235, v232
    v_accvgpr_write_b32 a6, v235
    v_accvgpr_read_b32 v236, a7
    v_mul_f32_e64 v236, v236, v232
    v_accvgpr_write_b32 a7, v236
    v_accvgpr_read_b32 v233, a8
    v_mul_f32_e64 v233, v233, v232
    v_accvgpr_write_b32 a8, v233
    v_accvgpr_read_b32 v234, a9
    v_mul_f32_e64 v234, v234, v232
    v_accvgpr_write_b32 a9, v234
    v_accvgpr_read_b32 v235, a10
    v_mul_f32_e64 v235, v235, v232
    v_accvgpr_write_b32 a10, v235
    v_accvgpr_read_b32 v236, a11
    v_mul_f32_e64 v236, v236, v232
    v_accvgpr_write_b32 a11, v236
    v_accvgpr_read_b32 v233, a12
    v_mul_f32_e64 v233, v233, v232
    v_accvgpr_write_b32 a12, v233
    v_accvgpr_read_b32 v234, a13
    v_mul_f32_e64 v234, v234, v232
    v_accvgpr_write_b32 a13, v234
    v_accvgpr_read_b32 v235, a14
    v_mul_f32_e64 v235, v235, v232
    v_accvgpr_write_b32 a14, v235
    v_accvgpr_read_b32 v236, a15
    v_mul_f32_e64 v236, v236, v232
    v_accvgpr_write_b32 a15, v236
    v_accvgpr_read_b32 v233, a16
    v_mul_f32_e64 v233, v233, v232
    v_accvgpr_write_b32 a16, v233
    v_accvgpr_read_b32 v234, a17
    v_mul_f32_e64 v234, v234, v232
    v_accvgpr_write_b32 a17, v234
    v_accvgpr_read_b32 v235, a18
    v_mul_f32_e64 v235, v235, v232
    v_accvgpr_write_b32 a18, v235
    v_accvgpr_read_b32 v236, a19
    v_mul_f32_e64 v236, v236, v232
    v_accvgpr_write_b32 a19, v236
    v_accvgpr_read_b32 v233, a20
    v_mul_f32_e64 v233, v233, v232
    v_accvgpr_write_b32 a20, v233
    v_accvgpr_read_b32 v234, a21
    v_mul_f32_e64 v234, v234, v232
    v_accvgpr_write_b32 a21, v234
    v_accvgpr_read_b32 v235, a22
    v_mul_f32_e64 v235, v235, v232
    v_accvgpr_write_b32 a22, v235
    v_accvgpr_read_b32 v236, a23
    v_mul_f32_e64 v236, v236, v232
    v_accvgpr_write_b32 a23, v236
    v_accvgpr_read_b32 v233, a24
    v_mul_f32_e64 v233, v233, v232
    v_accvgpr_write_b32 a24, v233
    v_accvgpr_read_b32 v234, a25
    v_mul_f32_e64 v234, v234, v232
    v_accvgpr_write_b32 a25, v234
    v_accvgpr_read_b32 v235, a26
    v_mul_f32_e64 v235, v235, v232
    v_accvgpr_write_b32 a26, v235
    v_accvgpr_read_b32 v236, a27
    v_mul_f32_e64 v236, v236, v232
    v_accvgpr_write_b32 a27, v236
    v_accvgpr_read_b32 v233, a28
    v_mul_f32_e64 v233, v233, v232
    v_accvgpr_write_b32 a28, v233
    v_accvgpr_read_b32 v234, a29
    v_mul_f32_e64 v234, v234, v232
    v_accvgpr_write_b32 a29, v234
    v_accvgpr_read_b32 v235, a30
    v_mul_f32_e64 v235, v235, v232
    v_accvgpr_write_b32 a30, v235
    v_accvgpr_read_b32 v236, a31
    v_mul_f32_e64 v236, v236, v232
    v_accvgpr_write_b32 a31, v236
    v_exp_f32 v128, v32
    v_exp_f32 v129, v33
    v_exp_f32 v130, v34
    v_exp_f32 v131, v35
    v_exp_f32 v132, v36
    v_exp_f32 v133, v37
    v_exp_f32 v134, v38
    v_exp_f32_e64 v135, v39
    s_nop 0
    v_cvt_pk_bf16_f32 v112, v128, v129
    v_cvt_pk_bf16_f32 v113, v130, v131
    v_cvt_pk_bf16_f32 v114, v132, v133
    v_cvt_pk_bf16_f32 v115, v134, v135
    v_max3_f32 v230, v40, v41, v42
    v_max3_f32 v230, v230, v43, v44
    v_max3_f32 v230, v230, v45, v46
    v_max_f32 v230, v230, v47
    v_mov_b32 v231, v230
    s_nop 1
    v_permlane16_swap_b32 v230, v231
    s_nop 0
    v_max_f32 v230, v230, v231
    v_mov_b32 v231, v230
    s_nop 1
    v_permlane32_swap_b32 v230, v231
    s_nop 0
    v_max_f32_e64 v230, v230, v231
    v_add_f32 v230, 0x41800000, v230
    v_max_f32 v230, 0, v230
    v_sub_f32 v232, 0, v230
    v_exp_f32 v232, v232
    v_sub_f32 v225, v225, v230
    v_sub_f32 v72, v72, v230
    v_sub_f32 v8, v8, v230
    v_sub_f32 v40, v40, v230
    v_sub_f32 v73, v73, v230
    v_sub_f32 v9, v9, v230
    v_sub_f32 v41, v41, v230
    v_sub_f32 v74, v74, v230
    v_sub_f32 v10, v10, v230
    v_sub_f32 v42, v42, v230
    v_sub_f32 v75, v75, v230
    v_sub_f32 v11, v11, v230
    v_sub_f32 v43, v43, v230
    v_sub_f32 v76, v76, v230
    v_sub_f32 v12, v12, v230
    v_sub_f32 v44, v44, v230
    v_sub_f32 v77, v77, v230
    v_sub_f32 v13, v13, v230
    v_sub_f32 v45, v45, v230
    v_sub_f32 v78, v78, v230
    v_sub_f32 v14, v14, v230
    v_sub_f32 v46, v46, v230
    v_sub_f32 v79, v79, v230
    v_sub_f32 v15, v15, v230
    v_sub_f32 v47, v47, v230
    v_mul_f32 v148, v148, v232
    v_mul_f32 v149, v149, v232
    v_mul_f32 v150, v150, v232
    v_mul_f32 v151, v151, v232
    v_accvgpr_read_b32 v233, a32
    v_mul_f32_e64 v233, v233, v232
    v_accvgpr_write_b32 a32, v233
    v_accvgpr_read_b32 v234, a33
    v_mul_f32_e64 v234, v234, v232
    v_accvgpr_write_b32 a33, v234
    v_accvgpr_read_b32 v235, a34
    v_mul_f32_e64 v235, v235, v232
    v_accvgpr_write_b32 a34, v235
    v_accvgpr_read_b32 v236, a35
    v_mul_f32_e64 v236, v236, v232
    v_accvgpr_write_b32 a35, v236
    v_accvgpr_read_b32 v233, a36
    v_mul_f32_e64 v233, v233, v232
    v_accvgpr_write_b32 a36, v233
    v_accvgpr_read_b32 v234, a37
    v_mul_f32_e64 v234, v234, v232
    v_accvgpr_write_b32 a37, v234
    v_accvgpr_read_b32 v235, a38
    v_mul_f32_e64 v235, v235, v232
    v_accvgpr_write_b32 a38, v235
    v_accvgpr_read_b32 v236, a39
    v_mul_f32_e64 v236, v236, v232
    v_accvgpr_write_b32 a39, v236
    v_accvgpr_read_b32 v233, a40
    v_mul_f32_e64 v233, v233, v232
    v_accvgpr_write_b32 a40, v233
    v_accvgpr_read_b32 v234, a41
    v_mul_f32_e64 v234, v234, v232
    v_accvgpr_write_b32 a41, v234
    v_accvgpr_read_b32 v235, a42
    v_mul_f32_e64 v235, v235, v232
    v_accvgpr_write_b32 a42, v235
    v_accvgpr_read_b32 v236, a43
    v_mul_f32_e64 v236, v236, v232
    v_accvgpr_write_b32 a43, v236
    v_accvgpr_read_b32 v233, a44
    v_mul_f32_e64 v233, v233, v232
    v_accvgpr_write_b32 a44, v233
    v_accvgpr_read_b32 v234, a45
    v_mul_f32_e64 v234, v234, v232
    v_accvgpr_write_b32 a45, v234
    v_accvgpr_read_b32 v235, a46
    v_mul_f32_e64 v235, v235, v232
    v_accvgpr_write_b32 a46, v235
    v_accvgpr_read_b32 v236, a47
    v_mul_f32_e64 v236, v236, v232
    v_accvgpr_write_b32 a47, v236
    v_accvgpr_read_b32 v233, a48
    v_mul_f32_e64 v233, v233, v232
    v_accvgpr_write_b32 a48, v233
    v_accvgpr_read_b32 v234, a49
    v_mul_f32_e64 v234, v234, v232
    v_accvgpr_write_b32 a49, v234
    v_accvgpr_read_b32 v235, a50
    v_mul_f32_e64 v235, v235, v232
    v_accvgpr_write_b32 a50, v235
    v_accvgpr_read_b32 v236, a51
    v_mul_f32_e64 v236, v236, v232
    v_accvgpr_write_b32 a51, v236
    v_accvgpr_read_b32 v233, a52
    v_mul_f32_e64 v233, v233, v232
    v_accvgpr_write_b32 a52, v233
    v_accvgpr_read_b32 v234, a53
    v_mul_f32_e64 v234, v234, v232
    v_accvgpr_write_b32 a53, v234
    v_accvgpr_read_b32 v235, a54
    v_mul_f32_e64 v235, v235, v232
    v_accvgpr_write_b32 a54, v235
    v_accvgpr_read_b32 v236, a55
    v_mul_f32_e64 v236, v236, v232
    v_accvgpr_write_b32 a55, v236
    v_accvgpr_read_b32 v233, a56
    v_mul_f32_e64 v233, v233, v232
    v_accvgpr_write_b32 a56, v233
    v_accvgpr_read_b32 v234, a57
    v_mul_f32_e64 v234, v234, v232
    v_accvgpr_write_b32 a57, v234
    v_accvgpr_read_b32 v235, a58
    v_mul_f32_e64 v235, v235, v232
    v_accvgpr_write_b32 a58, v235
    v_accvgpr_read_b32 v236, a59
    v_mul_f32_e64 v236, v236, v232
    v_accvgpr_write_b32 a59, v236
    v_accvgpr_read_b32 v233, a60
    v_mul_f32_e64 v233, v233, v232
    v_accvgpr_write_b32 a60, v233
    v_accvgpr_read_b32 v234, a61
    v_mul_f32_e64 v234, v234, v232
    v_accvgpr_write_b32 a61, v234
    v_accvgpr_read_b32 v235, a62
    v_mul_f32_e64 v235, v235, v232
    v_accvgpr_write_b32 a62, v235
    v_accvgpr_read_b32 v236, a63
    v_mul_f32_e64 v236, v236, v232
    v_accvgpr_write_b32 a63, v236
    v_exp_f32 v128, v40
    v_exp_f32 v129, v41
    v_exp_f32 v130, v42
    v_exp_f32 v131, v43
    v_exp_f32 v132, v44
    v_exp_f32 v133, v45
    v_exp_f32 v134, v46
    v_exp_f32_e64 v135, v47
    s_nop 0
    v_cvt_pk_bf16_f32 v116, v128, v129
    v_cvt_pk_bf16_f32 v117, v130, v131
    v_cvt_pk_bf16_f32 v118, v132, v133
    v_cvt_pk_bf16_f32 v119, v134, v135
    v_max3_f32 v230, v48, v49, v50
    v_max3_f32 v230, v230, v51, v52
    v_max3_f32 v230, v230, v53, v54
    v_max_f32 v230, v230, v55
    v_mov_b32 v231, v230
    s_nop 1
    v_permlane16_swap_b32 v230, v231
    s_nop 0
    v_max_f32 v230, v230, v231
    v_mov_b32 v231, v230
    s_nop 1
    v_permlane32_swap_b32 v230, v231
    s_nop 0
    v_max_f32_e64 v230, v230, v231
    v_add_f32 v230, 0x41800000, v230
    v_max_f32 v230, 0, v230
    v_sub_f32 v232, 0, v230
    v_exp_f32 v232, v232
    v_sub_f32 v226, v226, v230
    v_sub_f32 v80, v80, v230
    v_sub_f32 v16, v16, v230
    v_sub_f32 v48, v48, v230
    v_sub_f32 v81, v81, v230
    v_sub_f32 v17, v17, v230
    v_sub_f32 v49, v49, v230
    v_sub_f32 v82, v82, v230
    v_sub_f32 v18, v18, v230
    v_sub_f32 v50, v50, v230
    v_sub_f32 v83, v83, v230
    v_sub_f32 v19, v19, v230
    v_sub_f32 v51, v51, v230
    v_sub_f32 v84, v84, v230
    v_sub_f32 v20, v20, v230
    v_sub_f32 v52, v52, v230
    v_sub_f32 v85, v85, v230
    v_sub_f32 v21, v21, v230
    v_sub_f32 v53, v53, v230
    v_sub_f32 v86, v86, v230
    v_sub_f32 v22, v22, v230
    v_sub_f32 v54, v54, v230
    v_sub_f32 v87, v87, v230
    v_sub_f32 v23, v23, v230
    v_sub_f32 v55, v55, v230
    v_mul_f32 v152, v152, v232
    v_mul_f32 v153, v153, v232
    v_mul_f32 v154, v154, v232
    v_mul_f32 v155, v155, v232
    v_accvgpr_read_b32 v233, a64
    v_mul_f32_e64 v233, v233, v232
    v_accvgpr_write_b32 a64, v233
    v_accvgpr_read_b32 v234, a65
    v_mul_f32_e64 v234, v234, v232
    v_accvgpr_write_b32 a65, v234
    v_accvgpr_read_b32 v235, a66
    v_mul_f32_e64 v235, v235, v232
    v_accvgpr_write_b32 a66, v235
    v_accvgpr_read_b32 v236, a67
    v_mul_f32_e64 v236, v236, v232
    v_accvgpr_write_b32 a67, v236
    v_accvgpr_read_b32 v233, a68
    v_mul_f32_e64 v233, v233, v232
    v_accvgpr_write_b32 a68, v233
    v_accvgpr_read_b32 v234, a69
    v_mul_f32_e64 v234, v234, v232
    v_accvgpr_write_b32 a69, v234
    v_accvgpr_read_b32 v235, a70
    v_mul_f32_e64 v235, v235, v232
    v_accvgpr_write_b32 a70, v235
    v_accvgpr_read_b32 v236, a71
    v_mul_f32_e64 v236, v236, v232
    v_accvgpr_write_b32 a71, v236
    v_accvgpr_read_b32 v233, a72
    v_mul_f32_e64 v233, v233, v232
    v_accvgpr_write_b32 a72, v233
    v_accvgpr_read_b32 v234, a73
    v_mul_f32_e64 v234, v234, v232
    v_accvgpr_write_b32 a73, v234
    v_accvgpr_read_b32 v235, a74
    v_mul_f32_e64 v235, v235, v232
    v_accvgpr_write_b32 a74, v235
    v_accvgpr_read_b32 v236, a75
    v_mul_f32_e64 v236, v236, v232
    v_accvgpr_write_b32 a75, v236
    v_accvgpr_read_b32 v233, a76
    v_mul_f32_e64 v233, v233, v232
    v_accvgpr_write_b32 a76, v233
    v_accvgpr_read_b32 v234, a77
    v_mul_f32_e64 v234, v234, v232
    v_accvgpr_write_b32 a77, v234
    v_accvgpr_read_b32 v235, a78
    v_mul_f32_e64 v235, v235, v232
    v_accvgpr_write_b32 a78, v235
    v_accvgpr_read_b32 v236, a79
    v_mul_f32_e64 v236, v236, v232
    v_accvgpr_write_b32 a79, v236
    v_accvgpr_read_b32 v233, a80
    v_mul_f32_e64 v233, v233, v232
    v_accvgpr_write_b32 a80, v233
    v_accvgpr_read_b32 v234, a81
    v_mul_f32_e64 v234, v234, v232
    v_accvgpr_write_b32 a81, v234
    v_accvgpr_read_b32 v235, a82
    v_mul_f32_e64 v235, v235, v232
    v_accvgpr_write_b32 a82, v235
    v_accvgpr_read_b32 v236, a83
    v_mul_f32_e64 v236, v236, v232
    v_accvgpr_write_b32 a83, v236
    v_accvgpr_read_b32 v233, a84
    v_mul_f32_e64 v233, v233, v232
    v_accvgpr_write_b32 a84, v233
    v_accvgpr_read_b32 v234, a85
    v_mul_f32_e64 v234, v234, v232
    v_accvgpr_write_b32 a85, v234
    v_accvgpr_read_b32 v235, a86
    v_mul_f32_e64 v235, v235, v232
    v_accvgpr_write_b32 a86, v235
    v_accvgpr_read_b32 v236, a87
    v_mul_f32_e64 v236, v236, v232
    v_accvgpr_write_b32 a87, v236
    v_accvgpr_read_b32 v233, a88
    v_mul_f32_e64 v233, v233, v232
    v_accvgpr_write_b32 a88, v233
    v_accvgpr_read_b32 v234, a89
    v_mul_f32_e64 v234, v234, v232
    v_accvgpr_write_b32 a89, v234
    v_accvgpr_read_b32 v235, a90
    v_mul_f32_e64 v235, v235, v232
    v_accvgpr_write_b32 a90, v235
    v_accvgpr_read_b32 v236, a91
    v_mul_f32_e64 v236, v236, v232
    v_accvgpr_write_b32 a91, v236
    v_accvgpr_read_b32 v233, a92
    v_mul_f32_e64 v233, v233, v232
    v_accvgpr_write_b32 a92, v233
    v_accvgpr_read_b32 v234, a93
    v_mul_f32_e64 v234, v234, v232
    v_accvgpr_write_b32 a93, v234
    v_accvgpr_read_b32 v235, a94
    v_mul_f32_e64 v235, v235, v232
    v_accvgpr_write_b32 a94, v235
    v_accvgpr_read_b32 v236, a95
    v_mul_f32_e64 v236, v236, v232
    v_accvgpr_write_b32 a95, v236
    v_exp_f32 v128, v48
    v_exp_f32 v129, v49
    v_exp_f32 v130, v50
    v_exp_f32 v131, v51
    v_exp_f32 v132, v52
    v_exp_f32 v133, v53
    v_exp_f32 v134, v54
    v_exp_f32_e64 v135, v55
    s_nop 0
    v_cvt_pk_bf16_f32 v120, v128, v129
    v_cvt_pk_bf16_f32 v121, v130, v131
    v_cvt_pk_bf16_f32 v122, v132, v133
    v_cvt_pk_bf16_f32 v123, v134, v135
    v_max3_f32 v230, v56, v57, v58
    v_max3_f32 v230, v230, v59, v60
    v_max3_f32 v230, v230, v61, v62
    v_max_f32 v230, v230, v63
    v_mov_b32 v231, v230
    s_nop 1
    v_permlane16_swap_b32 v230, v231
    s_nop 0
    v_max_f32 v230, v230, v231
    v_mov_b32 v231, v230
    s_nop 1
    v_permlane32_swap_b32 v230, v231
    s_nop 0
    v_max_f32_e64 v230, v230, v231
    v_add_f32 v230, 0x41800000, v230
    v_max_f32 v230, 0, v230
    v_sub_f32 v232, 0, v230
    v_exp_f32 v232, v232
    v_sub_f32 v227, v227, v230
    v_sub_f32 v88, v88, v230
    v_sub_f32 v24, v24, v230
    v_sub_f32 v56, v56, v230
    v_sub_f32 v89, v89, v230
    v_sub_f32 v25, v25, v230
    v_sub_f32 v57, v57, v230
    v_sub_f32 v90, v90, v230
    v_sub_f32 v26, v26, v230
    v_sub_f32 v58, v58, v230
    v_sub_f32 v91, v91, v230
    v_sub_f32 v27, v27, v230
    v_sub_f32 v59, v59, v230
    v_sub_f32 v92, v92, v230
    v_sub_f32 v28, v28, v230
    v_sub_f32 v60, v60, v230
    v_sub_f32 v93, v93, v230
    v_sub_f32 v29, v29, v230
    v_sub_f32 v61, v61, v230
    v_sub_f32 v94, v94, v230
    v_sub_f32 v30, v30, v230
    v_sub_f32 v62, v62, v230
    v_sub_f32 v95, v95, v230
    v_sub_f32 v31, v31, v230
    v_sub_f32 v63, v63, v230
    v_mul_f32 v156, v156, v232
    v_mul_f32 v157, v157, v232
    v_mul_f32 v158, v158, v232
    v_mul_f32 v159, v159, v232
    v_accvgpr_read_b32 v233, a96
    v_mul_f32_e64 v233, v233, v232
    v_accvgpr_write_b32 a96, v233
    v_accvgpr_read_b32 v234, a97
    v_mul_f32_e64 v234, v234, v232
    v_accvgpr_write_b32 a97, v234
    v_accvgpr_read_b32 v235, a98
    v_mul_f32_e64 v235, v235, v232
    v_accvgpr_write_b32 a98, v235
    v_accvgpr_read_b32 v236, a99
    v_mul_f32_e64 v236, v236, v232
    v_accvgpr_write_b32 a99, v236
    v_accvgpr_read_b32 v233, a100
    v_mul_f32_e64 v233, v233, v232
    v_accvgpr_write_b32 a100, v233
    v_accvgpr_read_b32 v234, a101
    v_mul_f32_e64 v234, v234, v232
    v_accvgpr_write_b32 a101, v234
    v_accvgpr_read_b32 v235, a102
    v_mul_f32_e64 v235, v235, v232
    v_accvgpr_write_b32 a102, v235
    v_accvgpr_read_b32 v236, a103
    v_mul_f32_e64 v236, v236, v232
    v_accvgpr_write_b32 a103, v236
    v_accvgpr_read_b32 v233, a104
    v_mul_f32_e64 v233, v233, v232
    v_accvgpr_write_b32 a104, v233
    v_accvgpr_read_b32 v234, a105
    v_mul_f32_e64 v234, v234, v232
    v_accvgpr_write_b32 a105, v234
    v_accvgpr_read_b32 v235, a106
    v_mul_f32_e64 v235, v235, v232
    v_accvgpr_write_b32 a106, v235
    v_accvgpr_read_b32 v236, a107
    v_mul_f32_e64 v236, v236, v232
    v_accvgpr_write_b32 a107, v236
    v_accvgpr_read_b32 v233, a108
    v_mul_f32_e64 v233, v233, v232
    v_accvgpr_write_b32 a108, v233
    v_accvgpr_read_b32 v234, a109
    v_mul_f32_e64 v234, v234, v232
    v_accvgpr_write_b32 a109, v234
    v_accvgpr_read_b32 v235, a110
    v_mul_f32_e64 v235, v235, v232
    v_accvgpr_write_b32 a110, v235
    v_accvgpr_read_b32 v236, a111
    v_mul_f32_e64 v236, v236, v232
    v_accvgpr_write_b32 a111, v236
    v_accvgpr_read_b32 v233, a112
    v_mul_f32_e64 v233, v233, v232
    v_accvgpr_write_b32 a112, v233
    v_accvgpr_read_b32 v234, a113
    v_mul_f32_e64 v234, v234, v232
    v_accvgpr_write_b32 a113, v234
    v_accvgpr_read_b32 v235, a114
    v_mul_f32_e64 v235, v235, v232
    v_accvgpr_write_b32 a114, v235
    v_accvgpr_read_b32 v236, a115
    v_mul_f32_e64 v236, v236, v232
    v_accvgpr_write_b32 a115, v236
    v_accvgpr_read_b32 v233, a116
    v_mul_f32_e64 v233, v233, v232
    v_accvgpr_write_b32 a116, v233
    v_accvgpr_read_b32 v234, a117
    v_mul_f32_e64 v234, v234, v232
    v_accvgpr_write_b32 a117, v234
    v_accvgpr_read_b32 v235, a118
    v_mul_f32_e64 v235, v235, v232
    v_accvgpr_write_b32 a118, v235
    v_accvgpr_read_b32 v236, a119
    v_mul_f32_e64 v236, v236, v232
    v_accvgpr_write_b32 a119, v236
    v_accvgpr_read_b32 v233, a120
    v_mul_f32_e64 v233, v233, v232
    v_accvgpr_write_b32 a120, v233
    v_accvgpr_read_b32 v234, a121
    v_mul_f32_e64 v234, v234, v232
    v_accvgpr_write_b32 a121, v234
    v_accvgpr_read_b32 v235, a122
    v_mul_f32_e64 v235, v235, v232
    v_accvgpr_write_b32 a122, v235
    v_accvgpr_read_b32 v236, a123
    v_mul_f32_e64 v236, v236, v232
    v_accvgpr_write_b32 a123, v236
    v_accvgpr_read_b32 v233, a124
    v_mul_f32_e64 v233, v233, v232
    v_accvgpr_write_b32 a124, v233
    v_accvgpr_read_b32 v234, a125
    v_mul_f32_e64 v234, v234, v232
    v_accvgpr_write_b32 a125, v234
    v_accvgpr_read_b32 v235, a126
    v_mul_f32_e64 v235, v235, v232
    v_accvgpr_write_b32 a126, v235
    v_accvgpr_read_b32 v236, a127
    v_mul_f32_e64 v236, v236, v232
    v_accvgpr_write_b32 a127, v236
    v_exp_f32 v128, v56
    v_exp_f32 v129, v57
    v_exp_f32 v130, v58
    v_exp_f32 v131, v59
    v_exp_f32 v132, v60
    v_exp_f32 v133, v61
    v_exp_f32 v134, v62
    v_exp_f32_e64 v135, v63
    s_nop 0
    v_cvt_pk_bf16_f32 v124, v128, v129
    v_cvt_pk_bf16_f32 v125, v130, v131
    v_cvt_pk_bf16_f32 v126, v132, v133
    v_cvt_pk_bf16_f32 v127, v134, v135
    s_nop 1
    s_branch kf_rr5
kf_rare10:
    s_nop 15
    v_max3_f32 v230, v0, v1, v2
    v_max3_f32 v230, v230, v3, v4
    v_max3_f32 v230, v230, v5, v6
    v_max_f32 v230, v230, v7
    v_mov_b32 v231, v230
    s_nop 1
    v_permlane16_swap_b32 v230, v231
    s_nop 0
    v_max_f32 v230, v230, v231
    v_mov_b32 v231, v230
    s_nop 1
    v_permlane32_swap_b32 v230, v231
    s_nop 0
    v_max_f32 v230, v230, v231
    v_add_f32 v230, 0x41800000, v230
    v_max_f32 v230, 0, v230
    v_sub_f32 v232, 0, v230
    v_exp_f32 v232, v232
    v_sub_f32 v224, v224, v230
    v_sub_f32 v64, v64, v230
    v_sub_f32 v32, v32, v230
    v_sub_f32 v0, v0, v230
    v_sub_f32 v65, v65, v230
    v_sub_f32 v33, v33, v230
    v_sub_f32 v1, v1, v230
    v_sub_f32 v66, v66, v230
    v_sub_f32 v34, v34, v230
    v_sub_f32 v2, v2, v230
    v_sub_f32 v67, v67, v230
    v_sub_f32 v35, v35, v230
    v_sub_f32 v3, v3, v230
    v_sub_f32 v68, v68, v230
    v_sub_f32 v36, v36, v230
    v_sub_f32 v4, v4, v230
    v_sub_f32 v69, v69, v230
    v_sub_f32 v37, v37, v230
    v_sub_f32 v5, v5, v230
    v_sub_f32 v70, v70, v230
    v_sub_f32 v38, v38, v230
    v_sub_f32 v6, v6, v230
    v_sub_f32 v71, v71, v230
    v_sub_f32 v39, v39, v230
    v_sub_f32 v7, v7, v230
    v_mul_f32 v144, v144, v232
    v_mul_f32 v145, v145, v232
    v_mul_f32 v146, v146, v232
    v_mul_f32 v147, v147, v232
    v_accvgpr_read_b32 v233, a0
    v_mul_f32_e64 v233, v233, v232
    v_accvgpr_write_b32 a0, v233
    v_accvgpr_read_b32 v234, a1
    v_mul_f32_e64 v234, v234, v232
    v_accvgpr_write_b32 a1, v234
    v_accvgpr_read_b32 v235, a2
    v_mul_f32_e64 v235, v235, v232
    v_accvgpr_write_b32 a2, v235
    v_accvgpr_read_b32 v236, a3
    v_mul_f32_e64 v236, v236, v232
    v_accvgpr_write_b32 a3, v236
    v_accvgpr_read_b32 v233, a4
    v_mul_f32_e64 v233, v233, v232
    v_accvgpr_write_b32 a4, v233
    v_accvgpr_read_b32 v234, a5
    v_mul_f32_e64 v234, v234, v232
    v_accvgpr_write_b32 a5, v234
    v_accvgpr_read_b32 v235, a6
    v_mul_f32_e64 v235, v235, v232
    v_accvgpr_write_b32 a6, v235
    v_accvgpr_read_b32 v236, a7
    v_mul_f32_e64 v236, v236, v232
    v_accvgpr_write_b32 a7, v236
    v_accvgpr_read_b32 v233, a8
    v_mul_f32_e64 v233, v233, v232
    v_accvgpr_write_b32 a8, v233
    v_accvgpr_read_b32 v234, a9
    v_mul_f32_e64 v234, v234, v232
    v_accvgpr_write_b32 a9, v234
    v_accvgpr_read_b32 v235, a10
    v_mul_f32_e64 v235, v235, v232
    v_accvgpr_write_b32 a10, v235
    v_accvgpr_read_b32 v236, a11
    v_mul_f32_e64 v236, v236, v232
    v_accvgpr_write_b32 a11, v236
    v_accvgpr_read_b32 v233, a12
    v_mul_f32_e64 v233, v233, v232
    v_accvgpr_write_b32 a12, v233
    v_accvgpr_read_b32 v234, a13
    v_mul_f32_e64 v234, v234, v232
    v_accvgpr_write_b32 a13, v234
    v_accvgpr_read_b32 v235, a14
    v_mul_f32_e64 v235, v235, v232
    v_accvgpr_write_b32 a14, v235
    v_accvgpr_read_b32 v236, a15
    v_mul_f32_e64 v236, v236, v232
    v_accvgpr_write_b32 a15, v236
    v_accvgpr_read_b32 v233, a16
    v_mul_f32_e64 v233, v233, v232
    v_accvgpr_write_b32 a16, v233
    v_accvgpr_read_b32 v234, a17
    v_mul_f32_e64 v234, v234, v232
    v_accvgpr_write_b32 a17, v234
    v_accvgpr_read_b32 v235, a18
    v_mul_f32_e64 v235, v235, v232
    v_accvgpr_write_b32 a18, v235
    v_accvgpr_read_b32 v236, a19
    v_mul_f32_e64 v236, v236, v232
    v_accvgpr_write_b32 a19, v236
    v_accvgpr_read_b32 v233, a20
    v_mul_f32_e64 v233, v233, v232
    v_accvgpr_write_b32 a20, v233
    v_accvgpr_read_b32 v234, a21
    v_mul_f32_e64 v234, v234, v232
    v_accvgpr_write_b32 a21, v234
    v_accvgpr_read_b32 v235, a22
    v_mul_f32_e64 v235, v235, v232
    v_accvgpr_write_b32 a22, v235
    v_accvgpr_read_b32 v236, a23
    v_mul_f32_e64 v236, v236, v232
    v_accvgpr_write_b32 a23, v236
    v_accvgpr_read_b32 v233, a24
    v_mul_f32_e64 v233, v233, v232
    v_accvgpr_write_b32 a24, v233
    v_accvgpr_read_b32 v234, a25
    v_mul_f32_e64 v234, v234, v232
    v_accvgpr_write_b32 a25, v234
    v_accvgpr_read_b32 v235, a26
    v_mul_f32_e64 v235, v235, v232
    v_accvgpr_write_b32 a26, v235
    v_accvgpr_read_b32 v236, a27
    v_mul_f32_e64 v236, v236, v232
    v_accvgpr_write_b32 a27, v236
    v_accvgpr_read_b32 v233, a28
    v_mul_f32_e64 v233, v233, v232
    v_accvgpr_write_b32 a28, v233
    v_accvgpr_read_b32 v234, a29
    v_mul_f32_e64 v234, v234, v232
    v_accvgpr_write_b32 a29, v234
    v_accvgpr_read_b32 v235, a30
    v_mul_f32_e64 v235, v235, v232
    v_accvgpr_write_b32 a30, v235
    v_accvgpr_read_b32 v236, a31
    v_mul_f32_e64 v236, v236, v232
    v_accvgpr_write_b32 a31, v236
    v_exp_f32 v128, v0
    v_exp_f32 v129, v1
    v_exp_f32 v130, v2
    v_exp_f32 v131, v3
    v_exp_f32 v132, v4
    v_exp_f32 v133, v5
    v_exp_f32 v134, v6
    v_exp_f32_e64 v135, v7
    s_nop 0
    v_cvt_pk_bf16_f32 v96, v128, v129
    v_cvt_pk_bf16_f32 v97, v130, v131
    v_cvt_pk_bf16_f32 v98, v132, v133
    v_cvt_pk_bf16_f32 v99, v134, v135
    v_max3_f32 v230, v8, v9, v10
    v_max3_f32 v230, v230, v11, v12
    v_max3_f32 v230, v230, v13, v14
    v_max_f32 v230, v230, v15
    v_mov_b32 v231, v230
    s_nop 1
    v_permlane16_swap_b32 v230, v231
    s_nop 0
    v_max_f32 v230, v230, v231
    v_mov_b32 v231, v230
    s_nop 1
    v_permlane32_swap_b32 v230, v231
    s_nop 0
    v_max_f32_e64 v230, v230, v231
    v_add_f32 v230, 0x41800000, v230
    v_max_f32 v230, 0, v230
    v_sub_f32 v232, 0, v230
    v_exp_f32 v232, v232
    v_sub_f32 v225, v225, v230
    v_sub_f32 v72, v72, v230
    v_sub_f32 v40, v40, v230
    v_sub_f32 v8, v8, v230
    v_sub_f32 v73, v73, v230
    v_sub_f32 v41, v41, v230
    v_sub_f32 v9, v9, v230
    v_sub_f32 v74, v74, v230
    v_sub_f32 v42, v42, v230
    v_sub_f32 v10, v10, v230
    v_sub_f32 v75, v75, v230
    v_sub_f32 v43, v43, v230
    v_sub_f32 v11, v11, v230
    v_sub_f32 v76, v76, v230
    v_sub_f32 v44, v44, v230
    v_sub_f32 v12, v12, v230
    v_sub_f32 v77, v77, v230
    v_sub_f32 v45, v45, v230
    v_sub_f32 v13, v13, v230
    v_sub_f32 v78, v78, v230
    v_sub_f32 v46, v46, v230
    v_sub_f32 v14, v14, v230
    v_sub_f32 v79, v79, v230
    v_sub_f32 v47, v47, v230
    v_sub_f32 v15, v15, v230
    v_mul_f32 v148, v148, v232
    v_mul_f32 v149, v149, v232
    v_mul_f32 v150, v150, v232
    v_mul_f32 v151, v151, v232
    v_accvgpr_read_b32 v233, a32
    v_mul_f32_e64 v233, v233, v232
    v_accvgpr_write_b32 a32, v233
    v_accvgpr_read_b32 v234, a33
    v_mul_f32_e64 v234, v234, v232
    v_accvgpr_write_b32 a33, v234
    v_accvgpr_read_b32 v235, a34
    v_mul_f32_e64 v235, v235, v232
    v_accvgpr_write_b32 a34, v235
    v_accvgpr_read_b32 v236, a35
    v_mul_f32_e64 v236, v236, v232
    v_accvgpr_write_b32 a35, v236
    v_accvgpr_read_b32 v233, a36
    v_mul_f32_e64 v233, v233, v232
    v_accvgpr_write_b32 a36, v233
    v_accvgpr_read_b32 v234, a37
    v_mul_f32_e64 v234, v234, v232
    v_accvgpr_write_b32 a37, v234
    v_accvgpr_read_b32 v235, a38
    v_mul_f32_e64 v235, v235, v232
    v_accvgpr_write_b32 a38, v235
    v_accvgpr_read_b32 v236, a39
    v_mul_f32_e64 v236, v236, v232
    v_accvgpr_write_b32 a39, v236
    v_accvgpr_read_b32 v233, a40
    v_mul_f32_e64 v233, v233, v232
    v_accvgpr_write_b32 a40, v233
    v_accvgpr_read_b32 v234, a41
    v_mul_f32_e64 v234, v234, v232
    v_accvgpr_write_b32 a41, v234
    v_accvgpr_read_b32 v235, a42
    v_mul_f32_e64 v235, v235, v232
    v_accvgpr_write_b32 a42, v235
    v_accvgpr_read_b32 v236, a43
    v_mul_f32_e64 v236, v236, v232
    v_accvgpr_write_b32 a43, v236
    v_accvgpr_read_b32 v233, a44
    v_mul_f32_e64 v233, v233, v232
    v_accvgpr_write_b32 a44, v233
    v_accvgpr_read_b32 v234, a45
    v_mul_f32_e64 v234, v234, v232
    v_accvgpr_write_b32 a45, v234
    v_accvgpr_read_b32 v235, a46
    v_mul_f32_e64 v235, v235, v232
    v_accvgpr_write_b32 a46, v235
    v_accvgpr_read_b32 v236, a47
    v_mul_f32_e64 v236, v236, v232
    v_accvgpr_write_b32 a47, v236
    v_accvgpr_read_b32 v233, a48
    v_mul_f32_e64 v233, v233, v232
    v_accvgpr_write_b32 a48, v233
    v_accvgpr_read_b32 v234, a49
    v_mul_f32_e64 v234, v234, v232
    v_accvgpr_write_b32 a49, v234
    v_accvgpr_read_b32 v235, a50
    v_mul_f32_e64 v235, v235, v232
    v_accvgpr_write_b32 a50, v235
    v_accvgpr_read_b32 v236, a51
    v_mul_f32_e64 v236, v236, v232
    v_accvgpr_write_b32 a51, v236
    v_accvgpr_read_b32 v233, a52
    v_mul_f32_e64 v233, v233, v232
    v_accvgpr_write_b32 a52, v233
    v_accvgpr_read_b32 v234, a53
    v_mul_f32_e64 v234, v234, v232
    v_accvgpr_write_b32 a53, v234
    v_accvgpr_read_b32 v235, a54
    v_mul_f32_e64 v235, v235, v232
    v_accvgpr_write_b32 a54, v235
    v_accvgpr_read_b32 v236, a55
    v_mul_f32_e64 v236, v236, v232
    v_accvgpr_write_b32 a55, v236
    v_accvgpr_read_b32 v233, a56
    v_mul_f32_e64 v233, v233, v232
    v_accvgpr_write_b32 a56, v233
    v_accvgpr_read_b32 v234, a57
    v_mul_f32_e64 v234, v234, v232
    v_accvgpr_write_b32 a57, v234
    v_accvgpr_read_b32 v235, a58
    v_mul_f32_e64 v235, v235, v232
    v_accvgpr_write_b32 a58, v235
    v_accvgpr_read_b32 v236, a59
    v_mul_f32_e64 v236, v236, v232
    v_accvgpr_write_b32 a59, v236
    v_accvgpr_read_b32 v233, a60
    v_mul_f32_e64 v233, v233, v232
    v_accvgpr_write_b32 a60, v233
    v_accvgpr_read_b32 v234, a61
    v_mul_f32_e64 v234, v234, v232
    v_accvgpr_write_b32 a61, v234
    v_accvgpr_read_b32 v235, a62
    v_mul_f32_e64 v235, v235, v232
    v_accvgpr_write_b32 a62, v235
    v_accvgpr_read_b32 v236, a63
    v_mul_f32_e64 v236, v236, v232
    v_accvgpr_write_b32 a63, v236
    v_exp_f32 v128, v8
    v_exp_f32 v129, v9
    v_exp_f32 v130, v10
    v_exp_f32 v131, v11
    v_exp_f32 v132, v12
    v_exp_f32 v133, v13
    v_exp_f32 v134, v14
    v_exp_f32_e64 v135, v15
    s_nop 0
    v_cvt_pk_bf16_f32 v100, v128, v129
    v_cvt_pk_bf16_f32 v101, v130, v131
    v_cvt_pk_bf16_f32 v102, v132, v133
    v_cvt_pk_bf16_f32 v103, v134, v135
    v_max3_f32 v230, v16, v17, v18
    v_max3_f32 v230, v230, v19, v20
    v_max3_f32 v230, v230, v21, v22
    v_max_f32 v230, v230, v23
    v_mov_b32 v231, v230
    s_nop 1
    v_permlane16_swap_b32 v230, v231
    s_nop 0
    v_max_f32 v230, v230, v231
    v_mov_b32 v231, v230
    s_nop 1
    v_permlane32_swap_b32 v230, v231
    s_nop 0
    v_max_f32_e64 v230, v230, v231
    v_add_f32 v230, 0x41800000, v230
    v_max_f32 v230, 0, v230
    v_sub_f32 v232, 0, v230
    v_exp_f32 v232, v232
    v_sub_f32 v226, v226, v230
    v_sub_f32 v80, v80, v230
    v_sub_f32 v48, v48, v230
    v_sub_f32 v16, v16, v230
    v_sub_f32 v81, v81, v230
    v_sub_f32 v49, v49, v230
    v_sub_f32 v17, v17, v230
    v_sub_f32 v82, v82, v230
    v_sub_f32 v50, v50, v230
    v_sub_f32 v18, v18, v230
    v_sub_f32 v83, v83, v230
    v_sub_f32 v51, v51, v230
    v_sub_f32 v19, v19, v230
    v_sub_f32 v84, v84, v230
    v_sub_f32 v52, v52, v230
    v_sub_f32 v20, v20, v230
    v_sub_f32 v85, v85, v230
    v_sub_f32 v53, v53, v230
    v_sub_f32 v21, v21, v230
    v_sub_f32 v86, v86, v230
    v_sub_f32 v54, v54, v230
    v_sub_f32 v22, v22, v230
    v_sub_f32 v87, v87, v230
    v_sub_f32 v55, v55, v230
    v_sub_f32 v23, v23, v230
    v_mul_f32 v152, v152, v232
    v_mul_f32 v153, v153, v232
    v_mul_f32 v154, v154, v232
    v_mul_f32 v155, v155, v232
    v_accvgpr_read_b32 v233, a64
    v_mul_f32_e64 v233, v233, v232
    v_accvgpr_write_b32 a64, v233
    v_accvgpr_read_b32 v234, a65
    v_mul_f32_e64 v234, v234, v232
    v_accvgpr_write_b32 a65, v234
    v_accvgpr_read_b32 v235, a66
    v_mul_f32_e64 v235, v235, v232
    v_accvgpr_write_b32 a66, v235
    v_accvgpr_read_b32 v236, a67
    v_mul_f32_e64 v236, v236, v232
    v_accvgpr_write_b32 a67, v236
    v_accvgpr_read_b32 v233, a68
    v_mul_f32_e64 v233, v233, v232
    v_accvgpr_write_b32 a68, v233
    v_accvgpr_read_b32 v234, a69
    v_mul_f32_e64 v234, v234, v232
    v_accvgpr_write_b32 a69, v234
    v_accvgpr_read_b32 v235, a70
    v_mul_f32_e64 v235, v235, v232
    v_accvgpr_write_b32 a70, v235
    v_accvgpr_read_b32 v236, a71
    v_mul_f32_e64 v236, v236, v232
    v_accvgpr_write_b32 a71, v236
    v_accvgpr_read_b32 v233, a72
    v_mul_f32_e64 v233, v233, v232
    v_accvgpr_write_b32 a72, v233
    v_accvgpr_read_b32 v234, a73
    v_mul_f32_e64 v234, v234, v232
    v_accvgpr_write_b32 a73, v234
    v_accvgpr_read_b32 v235, a74
    v_mul_f32_e64 v235, v235, v232
    v_accvgpr_write_b32 a74, v235
    v_accvgpr_read_b32 v236, a75
    v_mul_f32_e64 v236, v236, v232
    v_accvgpr_write_b32 a75, v236
    v_accvgpr_read_b32 v233, a76
    v_mul_f32_e64 v233, v233, v232
    v_accvgpr_write_b32 a76, v233
    v_accvgpr_read_b32 v234, a77
    v_mul_f32_e64 v234, v234, v232
    v_accvgpr_write_b32 a77, v234
    v_accvgpr_read_b32 v235, a78
    v_mul_f32_e64 v235, v235, v232
    v_accvgpr_write_b32 a78, v235
    v_accvgpr_read_b32 v236, a79
    v_mul_f32_e64 v236, v236, v232
    v_accvgpr_write_b32 a79, v236
    v_accvgpr_read_b32 v233, a80
    v_mul_f32_e64 v233, v233, v232
    v_accvgpr_write_b32 a80, v233
    v_accvgpr_read_b32 v234, a81
    v_mul_f32_e64 v234, v234, v232
    v_accvgpr_write_b32 a81, v234
    v_accvgpr_read_b32 v235, a82
    v_mul_f32_e64 v235, v235, v232
    v_accvgpr_write_b32 a82, v235
    v_accvgpr_read_b32 v236, a83
    v_mul_f32_e64 v236, v236, v232
    v_accvgpr_write_b32 a83, v236
    v_accvgpr_read_b32 v233, a84
    v_mul_f32_e64 v233, v233, v232
    v_accvgpr_write_b32 a84, v233
    v_accvgpr_read_b32 v234, a85
    v_mul_f32_e64 v234, v234, v232
    v_accvgpr_write_b32 a85, v234
    v_accvgpr_read_b32 v235, a86
    v_mul_f32_e64 v235, v235, v232
    v_accvgpr_write_b32 a86, v235
    v_accvgpr_read_b32 v236, a87
    v_mul_f32_e64 v236, v236, v232
    v_accvgpr_write_b32 a87, v236
    v_accvgpr_read_b32 v233, a88
    v_mul_f32_e64 v233, v233, v232
    v_accvgpr_write_b32 a88, v233
    v_accvgpr_read_b32 v234, a89
    v_mul_f32_e64 v234, v234, v232
    v_accvgpr_write_b32 a89, v234
    v_accvgpr_read_b32 v235, a90
    v_mul_f32_e64 v235, v235, v232
    v_accvgpr_write_b32 a90, v235
    v_accvgpr_read_b32 v236, a91
    v_mul_f32_e64 v236, v236, v232
    v_accvgpr_write_b32 a91, v236
    v_accvgpr_read_b32 v233, a92
    v_mul_f32_e64 v233, v233, v232
    v_accvgpr_write_b32 a92, v233
    v_accvgpr_read_b32 v234, a93
    v_mul_f32_e64 v234, v234, v232
    v_accvgpr_write_b32 a93, v234
    v_accvgpr_read_b32 v235, a94
    v_mul_f32_e64 v235, v235, v232
    v_accvgpr_write_b32 a94, v235
    v_accvgpr_read_b32 v236, a95
    v_mul_f32_e64 v236, v236, v232
    v_accvgpr_write_b32 a95, v236
    v_exp_f32 v128, v16
    v_exp_f32 v129, v17
    v_exp_f32 v130, v18
    v_exp_f32 v131, v19
    v_exp_f32 v132, v20
    v_exp_f32 v133, v21
    v_exp_f32 v134, v22
    v_exp_f32_e64 v135, v23
    s_nop 0
    v_cvt_pk_bf16_f32 v104, v128, v129
    v_cvt_pk_bf16_f32 v105, v130, v131
    v_cvt_pk_bf16_f32 v106, v132, v133
    v_cvt_pk_bf16_f32 v107, v134, v135
    v_max3_f32 v230, v24, v25, v26
    v_max3_f32 v230, v230, v27, v28
    v_max3_f32 v230, v230, v29, v30
    v_max_f32 v230, v230, v31
    v_mov_b32 v231, v230
    s_nop 1
    v_permlane16_swap_b32 v230, v231
    s_nop 0
    v_max_f32 v230, v230, v231
    v_mov_b32 v231, v230
    s_nop 1
    v_permlane32_swap_b32 v230, v231
    s_nop 0
    v_max_f32_e64 v230, v230, v231
    v_add_f32 v230, 0x41800000, v230
    v_max_f32 v230, 0, v230
    v_sub_f32 v232, 0, v230
    v_exp_f32 v232, v232
    v_sub_f32 v227, v227, v230
    v_sub_f32 v88, v88, v230
    v_sub_f32 v56, v56, v230
    v_sub_f32 v24, v24, v230
    v_sub_f32 v89, v89, v230
    v_sub_f32 v57, v57, v230
    v_sub_f32 v25, v25, v230
    v_sub_f32 v90, v90, v230
    v_sub_f32 v58, v58, v230
    v_sub_f32 v26, v26, v230
    v_sub_f32 v91, v91, v230
    v_sub_f32 v59, v59, v230
    v_sub_f32 v27, v27, v230
    v_sub_f32 v92, v92, v230
    v_sub_f32 v60, v60, v230
    v_sub_f32 v28, v28, v230
    v_sub_f32 v93, v93, v230
    v_sub_f32 v61, v61, v230
    v_sub_f32 v29, v29, v230
    v_sub_f32 v94, v94, v230
    v_sub_f32 v62, v62, v230
    v_sub_f32 v30, v30, v230
    v_sub_f32 v95, v95, v230
    v_sub_f32 v63, v63, v230
    v_sub_f32 v31, v31, v230
    v_mul_f32 v156, v156, v232
    v_mul_f32 v157, v157, v232
    v_mul_f32 v158, v158, v232
    v_mul_f32 v159, v159, v232
    v_accvgpr_read_b32 v233, a96
    v_mul_f32_e64 v233, v233, v232
    v_accvgpr_write_b32 a96, v233
    v_accvgpr_read_b32 v234, a97
    v_mul_f32_e64 v234, v234, v232
    v_accvgpr_write_b32 a97, v234
    v_accvgpr_read_b32 v235, a98
    v_mul_f32_e64 v235, v235, v232
    v_accvgpr_write_b32 a98, v235
    v_accvgpr_read_b32 v236, a99
    v_mul_f32_e64 v236, v236, v232
    v_accvgpr_write_b32 a99, v236
    v_accvgpr_read_b32 v233, a100
    v_mul_f32_e64 v233, v233, v232
    v_accvgpr_write_b32 a100, v233
    v_accvgpr_read_b32 v234, a101
    v_mul_f32_e64 v234, v234, v232
    v_accvgpr_write_b32 a101, v234
    v_accvgpr_read_b32 v235, a102
    v_mul_f32_e64 v235, v235, v232
    v_accvgpr_write_b32 a102, v235
    v_accvgpr_read_b32 v236, a103
    v_mul_f32_e64 v236, v236, v232
    v_accvgpr_write_b32 a103, v236
    v_accvgpr_read_b32 v233, a104
    v_mul_f32_e64 v233, v233, v232
    v_accvgpr_write_b32 a104, v233
    v_accvgpr_read_b32 v234, a105
    v_mul_f32_e64 v234, v234, v232
    v_accvgpr_write_b32 a105, v234
    v_accvgpr_read_b32 v235, a106
    v_mul_f32_e64 v235, v235, v232
    v_accvgpr_write_b32 a106, v235
    v_accvgpr_read_b32 v236, a107
    v_mul_f32_e64 v236, v236, v232
    v_accvgpr_write_b32 a107, v236
    v_accvgpr_read_b32 v233, a108
    v_mul_f32_e64 v233, v233, v232
    v_accvgpr_write_b32 a108, v233
    v_accvgpr_read_b32 v234, a109
    v_mul_f32_e64 v234, v234, v232
    v_accvgpr_write_b32 a109, v234
    v_accvgpr_read_b32 v235, a110
    v_mul_f32_e64 v235, v235, v232
    v_accvgpr_write_b32 a110, v235
    v_accvgpr_read_b32 v236, a111
    v_mul_f32_e64 v236, v236, v232
    v_accvgpr_write_b32 a111, v236
    v_accvgpr_read_b32 v233, a112
    v_mul_f32_e64 v233, v233, v232
    v_accvgpr_write_b32 a112, v233
    v_accvgpr_read_b32 v234, a113
    v_mul_f32_e64 v234, v234, v232
    v_accvgpr_write_b32 a113, v234
    v_accvgpr_read_b32 v235, a114
    v_mul_f32_e64 v235, v235, v232
    v_accvgpr_write_b32 a114, v235
    v_accvgpr_read_b32 v236, a115
    v_mul_f32_e64 v236, v236, v232
    v_accvgpr_write_b32 a115, v236
    v_accvgpr_read_b32 v233, a116
    v_mul_f32_e64 v233, v233, v232
    v_accvgpr_write_b32 a116, v233
    v_accvgpr_read_b32 v234, a117
    v_mul_f32_e64 v234, v234, v232
    v_accvgpr_write_b32 a117, v234
    v_accvgpr_read_b32 v235, a118
    v_mul_f32_e64 v235, v235, v232
    v_accvgpr_write_b32 a118, v235
    v_accvgpr_read_b32 v236, a119
    v_mul_f32_e64 v236, v236, v232
    v_accvgpr_write_b32 a119, v236
    v_accvgpr_read_b32 v233, a120
    v_mul_f32_e64 v233, v233, v232
    v_accvgpr_write_b32 a120, v233
    v_accvgpr_read_b32 v234, a121
    v_mul_f32_e64 v234, v234, v232
    v_accvgpr_write_b32 a121, v234
    v_accvgpr_read_b32 v235, a122
    v_mul_f32_e64 v235, v235, v232
    v_accvgpr_write_b32 a122, v235
    v_accvgpr_read_b32 v236, a123
    v_mul_f32_e64 v236, v236, v232
    v_accvgpr_write_b32 a123, v236
    v_accvgpr_read_b32 v233, a124
    v_mul_f32_e64 v233, v233, v232
    v_accvgpr_write_b32 a124, v233
    v_accvgpr_read_b32 v234, a125
    v_mul_f32_e64 v234, v234, v232
    v_accvgpr_write_b32 a125, v234
    v_accvgpr_read_b32 v235, a126
    v_mul_f32_e64 v235, v235, v232
    v_accvgpr_write_b32 a126, v235
    v_accvgpr_read_b32 v236, a127
    v_mul_f32_e64 v236, v236, v232
    v_accvgpr_write_b32 a127, v236
    v_exp_f32 v128, v24
    v_exp_f32 v129, v25
    v_exp_f32 v130, v26
    v_exp_f32 v131, v27
    v_exp_f32 v132, v28
    v_exp_f32 v133, v29
    v_exp_f32 v134, v30
    v_exp_f32_e64 v135, v31
    s_nop 0
    v_cvt_pk_bf16_f32 v108, v128, v129
    v_cvt_pk_bf16_f32 v109, v130, v131
    v_cvt_pk_bf16_f32 v110, v132, v133
    v_cvt_pk_bf16_f32 v111, v134, v135
    s_nop 1
    s_branch kf_rr9
kf_rare14:
    s_nop 15
    v_max3_f32 v230, v32, v33, v34
    v_max3_f32 v230, v230, v35, v36
    v_max3_f32 v230, v230, v37, v38
    v_max_f32 v230, v230, v39
    v_mov_b32 v231, v230
    s_nop 1
    v_permlane16_swap_b32 v230, v231
    s_nop 0
    v_max_f32 v230, v230, v231
    v_mov_b32 v231, v230
    s_nop 1
    v_permlane32_swap_b32 v230, v231
    s_nop 0
    v_max_f32 v230, v230, v231
    v_add_f32 v230, 0x41800000, v230
    v_max_f32 v230, 0, v230
    v_sub_f32 v232, 0, v230
    v_exp_f32 v232, v232
    v_sub_f32 v224, v224, v230
    v_sub_f32 v64, v64, v230
    v_sub_f32 v0, v0, v230
    v_sub_f32 v32, v32, v230
    v_sub_f32 v65, v65, v230
    v_sub_f32 v1, v1, v230
    v_sub_f32 v33, v33, v230
    v_sub_f32 v66, v66, v230
    v_sub_f32 v2, v2, v230
    v_sub_f32 v34, v34, v230
    v_sub_f32 v67, v67, v230
    v_sub_f32 v3, v3, v230
    v_sub_f32 v35, v35, v230
    v_sub_f32 v68, v68, v230
    v_sub_f32 v4, v4, v230
    v_sub_f32 v36, v36, v230
    v_sub_f32 v69, v69, v230
    v_sub_f32 v5, v5, v230
    v_sub_f32 v37, v37, v230
    v_sub_f32 v70, v70, v230
    v_sub_f32 v6, v6, v230
    v_sub_f32 v38, v38, v230
    v_sub_f32 v71, v71, v230
    v_sub_f32 v7, v7, v230
    v_sub_f32 v39, v39, v230
    v_mul_f32 v144, v144, v232
    v_mul_f32 v145, v145, v232
    v_mul_f32 v146, v146, v232
    v_mul_f32 v147, v147, v232
    v_accvgpr_read_b32 v233, a0
    v_mul_f32_e64 v233, v233, v232
    v_accvgpr_write_b32 a0, v233
    v_accvgpr_read_b32 v234, a1
    v_mul_f32_e64 v234, v234, v232
    v_accvgpr_write_b32 a1, v234
    v_accvgpr_read_b32 v235, a2
    v_mul_f32_e64 v235, v235, v232
    v_accvgpr_write_b32 a2, v235
    v_accvgpr_read_b32 v236, a3
    v_mul_f32_e64 v236, v236, v232
    v_accvgpr_write_b32 a3, v236
    v_accvgpr_read_b32 v233, a4
    v_mul_f32_e64 v233, v233, v232
    v_accvgpr_write_b32 a4, v233
    v_accvgpr_read_b32 v234, a5
    v_mul_f32_e64 v234, v234, v232
    v_accvgpr_write_b32 a5, v234
    v_accvgpr_read_b32 v235, a6
    v_mul_f32_e64 v235, v235, v232
    v_accvgpr_write_b32 a6, v235
    v_accvgpr_read_b32 v236, a7
    v_mul_f32_e64 v236, v236, v232
    v_accvgpr_write_b32 a7, v236
    v_accvgpr_read_b32 v233, a8
    v_mul_f32_e64 v233, v233, v232
    v_accvgpr_write_b32 a8, v233
    v_accvgpr_read_b32 v234, a9
    v_mul_f32_e64 v234, v234, v232
    v_accvgpr_write_b32 a9, v234
    v_accvgpr_read_b32 v235, a10
    v_mul_f32_e64 v235, v235, v232
    v_accvgpr_write_b32 a10, v235
    v_accvgpr_read_b32 v236, a11
    v_mul_f32_e64 v236, v236, v232
    v_accvgpr_write_b32 a11, v236
    v_accvgpr_read_b32 v233, a12
    v_mul_f32_e64 v233, v233, v232
    v_accvgpr_write_b32 a12, v233
    v_accvgpr_read_b32 v234, a13
    v_mul_f32_e64 v234, v234, v232
    v_accvgpr_write_b32 a13, v234
    v_accvgpr_read_b32 v235, a14
    v_mul_f32_e64 v235, v235, v232
    v_accvgpr_write_b32 a14, v235
    v_accvgpr_read_b32 v236, a15
    v_mul_f32_e64 v236, v236, v232
    v_accvgpr_write_b32 a15, v236
    v_accvgpr_read_b32 v233, a16
    v_mul_f32_e64 v233, v233, v232
    v_accvgpr_write_b32 a16, v233
    v_accvgpr_read_b32 v234, a17
    v_mul_f32_e64 v234, v234, v232
    v_accvgpr_write_b32 a17, v234
    v_accvgpr_read_b32 v235, a18
    v_mul_f32_e64 v235, v235, v232
    v_accvgpr_write_b32 a18, v235
    v_accvgpr_read_b32 v236, a19
    v_mul_f32_e64 v236, v236, v232
    v_accvgpr_write_b32 a19, v236
    v_accvgpr_read_b32 v233, a20
    v_mul_f32_e64 v233, v233, v232
    v_accvgpr_write_b32 a20, v233
    v_accvgpr_read_b32 v234, a21
    v_mul_f32_e64 v234, v234, v232
    v_accvgpr_write_b32 a21, v234
    v_accvgpr_read_b32 v235, a22
    v_mul_f32_e64 v235, v235, v232
    v_accvgpr_write_b32 a22, v235
    v_accvgpr_read_b32 v236, a23
    v_mul_f32_e64 v236, v236, v232
    v_accvgpr_write_b32 a23, v236
    v_accvgpr_read_b32 v233, a24
    v_mul_f32_e64 v233, v233, v232
    v_accvgpr_write_b32 a24, v233
    v_accvgpr_read_b32 v234, a25
    v_mul_f32_e64 v234, v234, v232
    v_accvgpr_write_b32 a25, v234
    v_accvgpr_read_b32 v235, a26
    v_mul_f32_e64 v235, v235, v232
    v_accvgpr_write_b32 a26, v235
    v_accvgpr_read_b32 v236, a27
    v_mul_f32_e64 v236, v236, v232
    v_accvgpr_write_b32 a27, v236
    v_accvgpr_read_b32 v233, a28
    v_mul_f32_e64 v233, v233, v232
    v_accvgpr_write_b32 a28, v233
    v_accvgpr_read_b32 v234, a29
    v_mul_f32_e64 v234, v234, v232
    v_accvgpr_write_b32 a29, v234
    v_accvgpr_read_b32 v235, a30
    v_mul_f32_e64 v235, v235, v232
    v_accvgpr_write_b32 a30, v235
    v_accvgpr_read_b32 v236, a31
    v_mul_f32_e64 v236, v236, v232
    v_accvgpr_write_b32 a31, v236
    v_exp_f32 v128, v32
    v_exp_f32 v129, v33
    v_exp_f32 v130, v34
    v_exp_f32 v131, v35
    v_exp_f32 v132, v36
    v_exp_f32 v133, v37
    v_exp_f32 v134, v38
    v_exp_f32_e64 v135, v39
    s_nop 0
    v_cvt_pk_bf16_f32 v112, v128, v129
    v_cvt_pk_bf16_f32 v113, v130, v131
    v_cvt_pk_bf16_f32 v114, v132, v133
    v_cvt_pk_bf16_f32 v115, v134, v135
    v_max3_f32 v230, v40, v41, v42
    v_max3_f32 v230, v230, v43, v44
    v_max3_f32 v230, v230, v45, v46
    v_max_f32 v230, v230, v47
    v_mov_b32 v231, v230
    s_nop 1
    v_permlane16_swap_b32 v230, v231
    s_nop 0
    v_max_f32 v230, v230, v231
    v_mov_b32 v231, v230
    s_nop 1
    v_permlane32_swap_b32 v230, v231
    s_nop 0
    v_max_f32_e64 v230, v230, v231
    v_add_f32 v230, 0x41800000, v230
    v_max_f32 v230, 0, v230
    v_sub_f32 v232, 0, v230
    v_exp_f32 v232, v232
    v_sub_f32 v225, v225, v230
    v_sub_f32 v72, v72, v230
    v_sub_f32 v8, v8, v230
    v_sub_f32 v40, v40, v230
    v_sub_f32 v73, v73, v230
    v_sub_f32 v9, v9, v230
    v_sub_f32 v41, v41, v230
    v_sub_f32 v74, v74, v230
    v_sub_f32 v10, v10, v230
    v_sub_f32 v42, v42, v230
    v_sub_f32 v75, v75, v230
    v_sub_f32 v11, v11, v230
    v_sub_f32 v43, v43, v230
    v_sub_f32 v76, v76, v230
    v_sub_f32 v12, v12, v230
    v_sub_f32 v44, v44, v230
    v_sub_f32 v77, v77, v230
    v_sub_f32 v13, v13, v230
    v_sub_f32 v45, v45, v230
    v_sub_f32 v78, v78, v230
    v_sub_f32 v14, v14, v230
    v_sub_f32 v46, v46, v230
    v_sub_f32 v79, v79, v230
    v_sub_f32 v15, v15, v230
    v_sub_f32 v47, v47, v230
    v_mul_f32 v148, v148, v232
    v_mul_f32 v149, v149, v232
    v_mul_f32 v150, v150, v232
    v_mul_f32 v151, v151, v232
    v_accvgpr_read_b32 v233, a32
    v_mul_f32_e64 v233, v233, v232
    v_accvgpr_write_b32 a32, v233
    v_accvgpr_read_b32 v234, a33
    v_mul_f32_e64 v234, v234, v232
    v_accvgpr_write_b32 a33, v234
    v_accvgpr_read_b32 v235, a34
    v_mul_f32_e64 v235, v235, v232
    v_accvgpr_write_b32 a34, v235
    v_accvgpr_read_b32 v236, a35
    v_mul_f32_e64 v236, v236, v232
    v_accvgpr_write_b32 a35, v236
    v_accvgpr_read_b32 v233, a36
    v_mul_f32_e64 v233, v233, v232
    v_accvgpr_write_b32 a36, v233
    v_accvgpr_read_b32 v234, a37
    v_mul_f32_e64 v234, v234, v232
    v_accvgpr_write_b32 a37, v234
    v_accvgpr_read_b32 v235, a38
    v_mul_f32_e64 v235, v235, v232
    v_accvgpr_write_b32 a38, v235
    v_accvgpr_read_b32 v236, a39
    v_mul_f32_e64 v236, v236, v232
    v_accvgpr_write_b32 a39, v236
    v_accvgpr_read_b32 v233, a40
    v_mul_f32_e64 v233, v233, v232
    v_accvgpr_write_b32 a40, v233
    v_accvgpr_read_b32 v234, a41
    v_mul_f32_e64 v234, v234, v232
    v_accvgpr_write_b32 a41, v234
    v_accvgpr_read_b32 v235, a42
    v_mul_f32_e64 v235, v235, v232
    v_accvgpr_write_b32 a42, v235
    v_accvgpr_read_b32 v236, a43
    v_mul_f32_e64 v236, v236, v232
    v_accvgpr_write_b32 a43, v236
    v_accvgpr_read_b32 v233, a44
    v_mul_f32_e64 v233, v233, v232
    v_accvgpr_write_b32 a44, v233
    v_accvgpr_read_b32 v234, a45
    v_mul_f32_e64 v234, v234, v232
    v_accvgpr_write_b32 a45, v234
    v_accvgpr_read_b32 v235, a46
    v_mul_f32_e64 v235, v235, v232
    v_accvgpr_write_b32 a46, v235
    v_accvgpr_read_b32 v236, a47
    v_mul_f32_e64 v236, v236, v232
    v_accvgpr_write_b32 a47, v236
    v_accvgpr_read_b32 v233, a48
    v_mul_f32_e64 v233, v233, v232
    v_accvgpr_write_b32 a48, v233
    v_accvgpr_read_b32 v234, a49
    v_mul_f32_e64 v234, v234, v232
    v_accvgpr_write_b32 a49, v234
    v_accvgpr_read_b32 v235, a50
    v_mul_f32_e64 v235, v235, v232
    v_accvgpr_write_b32 a50, v235
    v_accvgpr_read_b32 v236, a51
    v_mul_f32_e64 v236, v236, v232
    v_accvgpr_write_b32 a51, v236
    v_accvgpr_read_b32 v233, a52
    v_mul_f32_e64 v233, v233, v232
    v_accvgpr_write_b32 a52, v233
    v_accvgpr_read_b32 v234, a53
    v_mul_f32_e64 v234, v234, v232
    v_accvgpr_write_b32 a53, v234
    v_accvgpr_read_b32 v235, a54
    v_mul_f32_e64 v235, v235, v232
    v_accvgpr_write_b32 a54, v235
    v_accvgpr_read_b32 v236, a55
    v_mul_f32_e64 v236, v236, v232
    v_accvgpr_write_b32 a55, v236
    v_accvgpr_read_b32 v233, a56
    v_mul_f32_e64 v233, v233, v232
    v_accvgpr_write_b32 a56, v233
    v_accvgpr_read_b32 v234, a57
    v_mul_f32_e64 v234, v234, v232
    v_accvgpr_write_b32 a57, v234
    v_accvgpr_read_b32 v235, a58
    v_mul_f32_e64 v235, v235, v232
    v_accvgpr_write_b32 a58, v235
    v_accvgpr_read_b32 v236, a59
    v_mul_f32_e64 v236, v236, v232
    v_accvgpr_write_b32 a59, v236
    v_accvgpr_read_b32 v233, a60
    v_mul_f32_e64 v233, v233, v232
    v_accvgpr_write_b32 a60, v233
    v_accvgpr_read_b32 v234, a61
    v_mul_f32_e64 v234, v234, v232
    v_accvgpr_write_b32 a61, v234
    v_accvgpr_read_b32 v235, a62
    v_mul_f32_e64 v235, v235, v232
    v_accvgpr_write_b32 a62, v235
    v_accvgpr_read_b32 v236, a63
    v_mul_f32_e64 v236, v236, v232
    v_accvgpr_write_b32 a63, v236
    v_exp_f32 v128, v40
    v_exp_f32 v129, v41
    v_exp_f32 v130, v42
    v_exp_f32 v131, v43
    v_exp_f32 v132, v44
    v_exp_f32 v133, v45
    v_exp_f32 v134, v46
    v_exp_f32_e64 v135, v47
    s_nop 0
    v_cvt_pk_bf16_f32 v116, v128, v129
    v_cvt_pk_bf16_f32 v117, v130, v131
    v_cvt_pk_bf16_f32 v118, v132, v133
    v_cvt_pk_bf16_f32 v119, v134, v135
    v_max3_f32 v230, v48, v49, v50
    v_max3_f32 v230, v230, v51, v52
    v_max3_f32 v230, v230, v53, v54
    v_max_f32 v230, v230, v55
    v_mov_b32 v231, v230
    s_nop 1
    v_permlane16_swap_b32 v230, v231
    s_nop 0
    v_max_f32 v230, v230, v231
    v_mov_b32 v231, v230
    s_nop 1
    v_permlane32_swap_b32 v230, v231
    s_nop 0
    v_max_f32_e64 v230, v230, v231
    v_add_f32 v230, 0x41800000, v230
    v_max_f32 v230, 0, v230
    v_sub_f32 v232, 0, v230
    v_exp_f32 v232, v232
    v_sub_f32 v226, v226, v230
    v_sub_f32 v80, v80, v230
    v_sub_f32 v16, v16, v230
    v_sub_f32 v48, v48, v230
    v_sub_f32 v81, v81, v230
    v_sub_f32 v17, v17, v230
    v_sub_f32 v49, v49, v230
    v_sub_f32 v82, v82, v230
    v_sub_f32 v18, v18, v230
    v_sub_f32 v50, v50, v230
    v_sub_f32 v83, v83, v230
    v_sub_f32 v19, v19, v230
    v_sub_f32 v51, v51, v230
    v_sub_f32 v84, v84, v230
    v_sub_f32 v20, v20, v230
    v_sub_f32 v52, v52, v230
    v_sub_f32 v85, v85, v230
    v_sub_f32 v21, v21, v230
    v_sub_f32 v53, v53, v230
    v_sub_f32 v86, v86, v230
    v_sub_f32 v22, v22, v230
    v_sub_f32 v54, v54, v230
    v_sub_f32 v87, v87, v230
    v_sub_f32 v23, v23, v230
    v_sub_f32 v55, v55, v230
    v_mul_f32 v152, v152, v232
    v_mul_f32 v153, v153, v232
    v_mul_f32 v154, v154, v232
    v_mul_f32 v155, v155, v232
    v_accvgpr_read_b32 v233, a64
    v_mul_f32_e64 v233, v233, v232
    v_accvgpr_write_b32 a64, v233
    v_accvgpr_read_b32 v234, a65
    v_mul_f32_e64 v234, v234, v232
    v_accvgpr_write_b32 a65, v234
    v_accvgpr_read_b32 v235, a66
    v_mul_f32_e64 v235, v235, v232
    v_accvgpr_write_b32 a66, v235
    v_accvgpr_read_b32 v236, a67
    v_mul_f32_e64 v236, v236, v232
    v_accvgpr_write_b32 a67, v236
    v_accvgpr_read_b32 v233, a68
    v_mul_f32_e64 v233, v233, v232
    v_accvgpr_write_b32 a68, v233
    v_accvgpr_read_b32 v234, a69
    v_mul_f32_e64 v234, v234, v232
    v_accvgpr_write_b32 a69, v234
    v_accvgpr_read_b32 v235, a70
    v_mul_f32_e64 v235, v235, v232
    v_accvgpr_write_b32 a70, v235
    v_accvgpr_read_b32 v236, a71
    v_mul_f32_e64 v236, v236, v232
    v_accvgpr_write_b32 a71, v236
    v_accvgpr_read_b32 v233, a72
    v_mul_f32_e64 v233, v233, v232
    v_accvgpr_write_b32 a72, v233
    v_accvgpr_read_b32 v234, a73
    v_mul_f32_e64 v234, v234, v232
    v_accvgpr_write_b32 a73, v234
    v_accvgpr_read_b32 v235, a74
    v_mul_f32_e64 v235, v235, v232
    v_accvgpr_write_b32 a74, v235
    v_accvgpr_read_b32 v236, a75
    v_mul_f32_e64 v236, v236, v232
    v_accvgpr_write_b32 a75, v236
    v_accvgpr_read_b32 v233, a76
    v_mul_f32_e64 v233, v233, v232
    v_accvgpr_write_b32 a76, v233
    v_accvgpr_read_b32 v234, a77
    v_mul_f32_e64 v234, v234, v232
    v_accvgpr_write_b32 a77, v234
    v_accvgpr_read_b32 v235, a78
    v_mul_f32_e64 v235, v235, v232
    v_accvgpr_write_b32 a78, v235
    v_accvgpr_read_b32 v236, a79
    v_mul_f32_e64 v236, v236, v232
    v_accvgpr_write_b32 a79, v236
    v_accvgpr_read_b32 v233, a80
    v_mul_f32_e64 v233, v233, v232
    v_accvgpr_write_b32 a80, v233
    v_accvgpr_read_b32 v234, a81
    v_mul_f32_e64 v234, v234, v232
    v_accvgpr_write_b32 a81, v234
    v_accvgpr_read_b32 v235, a82
    v_mul_f32_e64 v235, v235, v232
    v_accvgpr_write_b32 a82, v235
    v_accvgpr_read_b32 v236, a83
    v_mul_f32_e64 v236, v236, v232
    v_accvgpr_write_b32 a83, v236
    v_accvgpr_read_b32 v233, a84
    v_mul_f32_e64 v233, v233, v232
    v_accvgpr_write_b32 a84, v233
    v_accvgpr_read_b32 v234, a85
    v_mul_f32_e64 v234, v234, v232
    v_accvgpr_write_b32 a85, v234
    v_accvgpr_read_b32 v235, a86
    v_mul_f32_e64 v235, v235, v232
    v_accvgpr_write_b32 a86, v235
    v_accvgpr_read_b32 v236, a87
    v_mul_f32_e64 v236, v236, v232
    v_accvgpr_write_b32 a87, v236
    v_accvgpr_read_b32 v233, a88
    v_mul_f32_e64 v233, v233, v232
    v_accvgpr_write_b32 a88, v233
    v_accvgpr_read_b32 v234, a89
    v_mul_f32_e64 v234, v234, v232
    v_accvgpr_write_b32 a89, v234
    v_accvgpr_read_b32 v235, a90
    v_mul_f32_e64 v235, v235, v232
    v_accvgpr_write_b32 a90, v235
    v_accvgpr_read_b32 v236, a91
    v_mul_f32_e64 v236, v236, v232
    v_accvgpr_write_b32 a91, v236
    v_accvgpr_read_b32 v233, a92
    v_mul_f32_e64 v233, v233, v232
    v_accvgpr_write_b32 a92, v233
    v_accvgpr_read_b32 v234, a93
    v_mul_f32_e64 v234, v234, v232
    v_accvgpr_write_b32 a93, v234
    v_accvgpr_read_b32 v235, a94
    v_mul_f32_e64 v235, v235, v232
    v_accvgpr_write_b32 a94, v235
    v_accvgpr_read_b32 v236, a95
    v_mul_f32_e64 v236, v236, v232
    v_accvgpr_write_b32 a95, v236
    v_exp_f32 v128, v48
    v_exp_f32 v129, v49
    v_exp_f32 v130, v50
    v_exp_f32 v131, v51
    v_exp_f32 v132, v52
    v_exp_f32 v133, v53
    v_exp_f32 v134, v54
    v_exp_f32_e64 v135, v55
    s_nop 0
    v_cvt_pk_bf16_f32 v120, v128, v129
    v_cvt_pk_bf16_f32 v121, v130, v131
    v_cvt_pk_bf16_f32 v122, v132, v133
    v_cvt_pk_bf16_f32 v123, v134, v135
    v_max3_f32 v230, v56, v57, v58
    v_max3_f32 v230, v230, v59, v60
    v_max3_f32 v230, v230, v61, v62
    v_max_f32 v230, v230, v63
    v_mov_b32 v231, v230
    s_nop 1
    v_permlane16_swap_b32 v230, v231
    s_nop 0
    v_max_f32 v230, v230, v231
    v_mov_b32 v231, v230
    s_nop 1
    v_permlane32_swap_b32 v230, v231
    s_nop 0
    v_max_f32_e64 v230, v230, v231
    v_add_f32 v230, 0x41800000, v230
    v_max_f32 v230, 0, v230
    v_sub_f32 v232, 0, v230
    v_exp_f32 v232, v232
    v_sub_f32 v227, v227, v230
    v_sub_f32 v88, v88, v230
    v_sub_f32 v24, v24, v230
    v_sub_f32 v56, v56, v230
    v_sub_f32 v89, v89, v230
    v_sub_f32 v25, v25, v230
    v_sub_f32 v57, v57, v230
    v_sub_f32 v90, v90, v230
    v_sub_f32 v26, v26, v230
    v_sub_f32 v58, v58, v230
    v_sub_f32 v91, v91, v230
    v_sub_f32 v27, v27, v230
    v_sub_f32 v59, v59, v230
    v_sub_f32 v92, v92, v230
    v_sub_f32 v28, v28, v230
    v_sub_f32 v60, v60, v230
    v_sub_f32 v93, v93, v230
    v_sub_f32 v29, v29, v230
    v_sub_f32 v61, v61, v230
    v_sub_f32 v94, v94, v230
    v_sub_f32 v30, v30, v230
    v_sub_f32 v62, v62, v230
    v_sub_f32 v95, v95, v230
    v_sub_f32 v31, v31, v230
    v_sub_f32 v63, v63, v230
    v_mul_f32 v156, v156, v232
    v_mul_f32 v157, v157, v232
    v_mul_f32 v158, v158, v232
    v_mul_f32 v159, v159, v232
    v_accvgpr_read_b32 v233, a96
    v_mul_f32_e64 v233, v233, v232
    v_accvgpr_write_b32 a96, v233
    v_accvgpr_read_b32 v234, a97
    v_mul_f32_e64 v234, v234, v232
    v_accvgpr_write_b32 a97, v234
    v_accvgpr_read_b32 v235, a98
    v_mul_f32_e64 v235, v235, v232
    v_accvgpr_write_b32 a98, v235
    v_accvgpr_read_b32 v236, a99
    v_mul_f32_e64 v236, v236, v232
    v_accvgpr_write_b32 a99, v236
    v_accvgpr_read_b32 v233, a100
    v_mul_f32_e64 v233, v233, v232
    v_accvgpr_write_b32 a100, v233
    v_accvgpr_read_b32 v234, a101
    v_mul_f32_e64 v234, v234, v232
    v_accvgpr_write_b32 a101, v234
    v_accvgpr_read_b32 v235, a102
    v_mul_f32_e64 v235, v235, v232
    v_accvgpr_write_b32 a102, v235
    v_accvgpr_read_b32 v236, a103
    v_mul_f32_e64 v236, v236, v232
    v_accvgpr_write_b32 a103, v236
    v_accvgpr_read_b32 v233, a104
    v_mul_f32_e64 v233, v233, v232
    v_accvgpr_write_b32 a104, v233
    v_accvgpr_read_b32 v234, a105
    v_mul_f32_e64 v234, v234, v232
    v_accvgpr_write_b32 a105, v234
    v_accvgpr_read_b32 v235, a106
    v_mul_f32_e64 v235, v235, v232
    v_accvgpr_write_b32 a106, v235
    v_accvgpr_read_b32 v236, a107
    v_mul_f32_e64 v236, v236, v232
    v_accvgpr_write_b32 a107, v236
    v_accvgpr_read_b32 v233, a108
    v_mul_f32_e64 v233, v233, v232
    v_accvgpr_write_b32 a108, v233
    v_accvgpr_read_b32 v234, a109
    v_mul_f32_e64 v234, v234, v232
    v_accvgpr_write_b32 a109, v234
    v_accvgpr_read_b32 v235, a110
    v_mul_f32_e64 v235, v235, v232
    v_accvgpr_write_b32 a110, v235
    v_accvgpr_read_b32 v236, a111
    v_mul_f32_e64 v236, v236, v232
    v_accvgpr_write_b32 a111, v236
    v_accvgpr_read_b32 v233, a112
    v_mul_f32_e64 v233, v233, v232
    v_accvgpr_write_b32 a112, v233
    v_accvgpr_read_b32 v234, a113
    v_mul_f32_e64 v234, v234, v232
    v_accvgpr_write_b32 a113, v234
    v_accvgpr_read_b32 v235, a114
    v_mul_f32_e64 v235, v235, v232
    v_accvgpr_write_b32 a114, v235
    v_accvgpr_read_b32 v236, a115
    v_mul_f32_e64 v236, v236, v232
    v_accvgpr_write_b32 a115, v236
    v_accvgpr_read_b32 v233, a116
    v_mul_f32_e64 v233, v233, v232
    v_accvgpr_write_b32 a116, v233
    v_accvgpr_read_b32 v234, a117
    v_mul_f32_e64 v234, v234, v232
    v_accvgpr_write_b32 a117, v234
    v_accvgpr_read_b32 v235, a118
    v_mul_f32_e64 v235, v235, v232
    v_accvgpr_write_b32 a118, v235
    v_accvgpr_read_b32 v236, a119
    v_mul_f32_e64 v236, v236, v232
    v_accvgpr_write_b32 a119, v236
    v_accvgpr_read_b32 v233, a120
    v_mul_f32_e64 v233, v233, v232
    v_accvgpr_write_b32 a120, v233
    v_accvgpr_read_b32 v234, a121
    v_mul_f32_e64 v234, v234, v232
    v_accvgpr_write_b32 a121, v234
    v_accvgpr_read_b32 v235, a122
    v_mul_f32_e64 v235, v235, v232
    v_accvgpr_write_b32 a122, v235
    v_accvgpr_read_b32 v236, a123
    v_mul_f32_e64 v236, v236, v232
    v_accvgpr_write_b32 a123, v236
    v_accvgpr_read_b32 v233, a124
    v_mul_f32_e64 v233, v233, v232
    v_accvgpr_write_b32 a124, v233
    v_accvgpr_read_b32 v234, a125
    v_mul_f32_e64 v234, v234, v232
    v_accvgpr_write_b32 a125, v234
    v_accvgpr_read_b32 v235, a126
    v_mul_f32_e64 v235, v235, v232
    v_accvgpr_write_b32 a126, v235
    v_accvgpr_read_b32 v236, a127
    v_mul_f32_e64 v236, v236, v232
    v_accvgpr_write_b32 a127, v236
    v_exp_f32 v128, v56
    v_exp_f32 v129, v57
    v_exp_f32 v130, v58
    v_exp_f32 v131, v59
    v_exp_f32 v132, v60
    v_exp_f32 v133, v61
    v_exp_f32 v134, v62
    v_exp_f32_e64 v135, v63
    s_nop 0
    v_cvt_pk_bf16_f32 v124, v128, v129
    v_cvt_pk_bf16_f32 v125, v130, v131
    v_cvt_pk_bf16_f32 v126, v132, v133
    v_cvt_pk_bf16_f32 v127, v134, v135
    s_nop 1
    s_branch kf_rr13
kf_rare18:
    s_nop 15
    v_max3_f32 v230, v16, v17, v18
    v_max3_f32 v230, v230, v19, v20
    v_max3_f32 v230, v230, v21, v22
    v_max_f32 v230, v230, v23
    v_mov_b32 v231, v230
    s_nop 1
    v_permlane16_swap_b32 v230, v231
    s_nop 0
    v_max_f32 v230, v230, v231
    v_mov_b32 v231, v230
    s_nop 1
    v_permlane32_swap_b32 v230, v231
    s_nop 0
    v_max_f32 v230, v230, v231
    v_add_f32 v230, 0x41800000, v230
    v_max_f32 v230, 0, v230
    v_sub_f32 v232, 0, v230
    v_exp_f32 v232, v232
    v_sub_f32 v226, v226, v230
    v_sub_f32 v80, v80, v230
    v_sub_f32 v48, v48, v230
    v_sub_f32 v16, v16, v230
    v_sub_f32 v81, v81, v230
    v_sub_f32 v49, v49, v230
    v_sub_f32 v17, v17, v230
    v_sub_f32 v82, v82, v230
    v_sub_f32 v50, v50, v230
    v_sub_f32 v18, v18, v230
    v_sub_f32 v83, v83, v230
    v_sub_f32 v51, v51, v230
    v_sub_f32 v19, v19, v230
    v_sub_f32 v84, v84, v230
    v_sub_f32 v52, v52, v230
    v_sub_f32 v20, v20, v230
    v_sub_f32 v85, v85, v230
    v_sub_f32 v53, v53, v230
    v_sub_f32 v21, v21, v230
    v_sub_f32 v86, v86, v230
    v_sub_f32 v54, v54, v230
    v_sub_f32 v22, v22, v230
    v_sub_f32 v87, v87, v230
    v_sub_f32 v55, v55, v230
    v_sub_f32 v23, v23, v230
    v_mul_f32 v152, v152, v232
    v_mul_f32 v153, v153, v232
    v_mul_f32 v154, v154, v232
    v_mul_f32 v155, v155, v232
    v_accvgpr_read_b32 v233, a64
    v_mul_f32_e64 v233, v233, v232
    v_accvgpr_write_b32 a64, v233
    v_accvgpr_read_b32 v234, a65
    v_mul_f32_e64 v234, v234, v232
    v_accvgpr_write_b32 a65, v234
    v_accvgpr_read_b32 v235, a66
    v_mul_f32_e64 v235, v235, v232
    v_accvgpr_write_b32 a66, v235
    v_accvgpr_read_b32 v236, a67
    v_mul_f32_e64 v236, v236, v232
    v_accvgpr_write_b32 a67, v236
    v_accvgpr_read_b32 v233, a68
    v_mul_f32_e64 v233, v233, v232
    v_accvgpr_write_b32 a68, v233
    v_accvgpr_read_b32 v234, a69
    v_mul_f32_e64 v234, v234, v232
    v_accvgpr_write_b32 a69, v234
    v_accvgpr_read_b32 v235, a70
    v_mul_f32_e64 v235, v235, v232
    v_accvgpr_write_b32 a70, v235
    v_accvgpr_read_b32 v236, a71
    v_mul_f32_e64 v236, v236, v232
    v_accvgpr_write_b32 a71, v236
    v_accvgpr_read_b32 v233, a72
    v_mul_f32_e64 v233, v233, v232
    v_accvgpr_write_b32 a72, v233
    v_accvgpr_read_b32 v234, a73
    v_mul_f32_e64 v234, v234, v232
    v_accvgpr_write_b32 a73, v234
    v_accvgpr_read_b32 v235, a74
    v_mul_f32_e64 v235, v235, v232
    v_accvgpr_write_b32 a74, v235
    v_accvgpr_read_b32 v236, a75
    v_mul_f32_e64 v236, v236, v232
    v_accvgpr_write_b32 a75, v236
    v_accvgpr_read_b32 v233, a76
    v_mul_f32_e64 v233, v233, v232
    v_accvgpr_write_b32 a76, v233
    v_accvgpr_read_b32 v234, a77
    v_mul_f32_e64 v234, v234, v232
    v_accvgpr_write_b32 a77, v234
    v_accvgpr_read_b32 v235, a78
    v_mul_f32_e64 v235, v235, v232
    v_accvgpr_write_b32 a78, v235
    v_accvgpr_read_b32 v236, a79
    v_mul_f32_e64 v236, v236, v232
    v_accvgpr_write_b32 a79, v236
    v_accvgpr_read_b32 v233, a80
    v_mul_f32_e64 v233, v233, v232
    v_accvgpr_write_b32 a80, v233
    v_accvgpr_read_b32 v234, a81
    v_mul_f32_e64 v234, v234, v232
    v_accvgpr_write_b32 a81, v234
    v_accvgpr_read_b32 v235, a82
    v_mul_f32_e64 v235, v235, v232
    v_accvgpr_write_b32 a82, v235
    v_accvgpr_read_b32 v236, a83
    v_mul_f32_e64 v236, v236, v232
    v_accvgpr_write_b32 a83, v236
    v_accvgpr_read_b32 v233, a84
    v_mul_f32_e64 v233, v233, v232
    v_accvgpr_write_b32 a84, v233
    v_accvgpr_read_b32 v234, a85
    v_mul_f32_e64 v234, v234, v232
    v_accvgpr_write_b32 a85, v234
    v_accvgpr_read_b32 v235, a86
    v_mul_f32_e64 v235, v235, v232
    v_accvgpr_write_b32 a86, v235
    v_accvgpr_read_b32 v236, a87
    v_mul_f32_e64 v236, v236, v232
    v_accvgpr_write_b32 a87, v236
    v_accvgpr_read_b32 v233, a88
    v_mul_f32_e64 v233, v233, v232
    v_accvgpr_write_b32 a88, v233
    v_accvgpr_read_b32 v234, a89
    v_mul_f32_e64 v234, v234, v232
    v_accvgpr_write_b32 a89, v234
    v_accvgpr_read_b32 v235, a90
    v_mul_f32_e64 v235, v235, v232
    v_accvgpr_write_b32 a90, v235
    v_accvgpr_read_b32 v236, a91
    v_mul_f32_e64 v236, v236, v232
    v_accvgpr_write_b32 a91, v236
    v_accvgpr_read_b32 v233, a92
    v_mul_f32_e64 v233, v233, v232
    v_accvgpr_write_b32 a92, v233
    v_accvgpr_read_b32 v234, a93
    v_mul_f32_e64 v234, v234, v232
    v_accvgpr_write_b32 a93, v234
    v_accvgpr_read_b32 v235, a94
    v_mul_f32_e64 v235, v235, v232
    v_accvgpr_write_b32 a94, v235
    v_accvgpr_read_b32 v236, a95
    v_mul_f32_e64 v236, v236, v232
    v_accvgpr_write_b32 a95, v236
    v_exp_f32 v128, v16
    v_exp_f32 v129, v17
    v_exp_f32 v130, v18
    v_exp_f32 v131, v19
    v_exp_f32 v132, v20
    v_exp_f32 v133, v21
    v_exp_f32 v134, v22
    v_exp_f32_e64 v135, v23
    s_nop 0
    v_cvt_pk_bf16_f32 v104, v128, v129
    v_cvt_pk_bf16_f32 v105, v130, v131
    v_cvt_pk_bf16_f32 v106, v132, v133
    v_cvt_pk_bf16_f32 v107, v134, v135
    v_max3_f32 v230, v24, v25, v26
    v_max3_f32 v230, v230, v27, v28
    v_max3_f32 v230, v230, v29, v30
    v_max_f32 v230, v230, v31
    v_mov_b32 v231, v230
    s_nop 1
    v_permlane16_swap_b32 v230, v231
    s_nop 0
    v_max_f32 v230, v230, v231
    v_mov_b32 v231, v230
    s_nop 1
    v_permlane32_swap_b32 v230, v231
    s_nop 0
    v_max_f32_e64 v230, v230, v231
    v_add_f32 v230, 0x41800000, v230
    v_max_f32 v230, 0, v230
    v_sub_f32 v232, 0, v230
    v_exp_f32 v232, v232
    v_sub_f32 v227, v227, v230
    v_sub_f32 v88, v88, v230
    v_sub_f32 v56, v56, v230
    v_sub_f32 v24, v24, v230
    v_sub_f32 v89, v89, v230
    v_sub_f32 v57, v57, v230
    v_sub_f32 v25, v25, v230
    v_sub_f32 v90, v90, v230
    v_sub_f32 v58, v58, v230
    v_sub_f32 v26, v26, v230
    v_sub_f32 v91, v91, v230
    v_sub_f32 v59, v59, v230
    v_sub_f32 v27, v27, v230
    v_sub_f32 v92, v92, v230
    v_sub_f32 v60, v60, v230
    v_sub_f32 v28, v28, v230
    v_sub_f32 v93, v93, v230
    v_sub_f32 v61, v61, v230
    v_sub_f32 v29, v29, v230
    v_sub_f32 v94, v94, v230
    v_sub_f32 v62, v62, v230
    v_sub_f32 v30, v30, v230
    v_sub_f32 v95, v95, v230
    v_sub_f32 v63, v63, v230
    v_sub_f32 v31, v31, v230
    v_mul_f32 v156, v156, v232
    v_mul_f32 v157, v157, v232
    v_mul_f32 v158, v158, v232
    v_mul_f32 v159, v159, v232
    v_accvgpr_read_b32 v233, a96
    v_mul_f32_e64 v233, v233, v232
    v_accvgpr_write_b32 a96, v233
    v_accvgpr_read_b32 v234, a97
    v_mul_f32_e64 v234, v234, v232
    v_accvgpr_write_b32 a97, v234
    v_accvgpr_read_b32 v235, a98
    v_mul_f32_e64 v235, v235, v232
    v_accvgpr_write_b32 a98, v235
    v_accvgpr_read_b32 v236, a99
    v_mul_f32_e64 v236, v236, v232
    v_accvgpr_write_b32 a99, v236
    v_accvgpr_read_b32 v233, a100
    v_mul_f32_e64 v233, v233, v232
    v_accvgpr_write_b32 a100, v233
    v_accvgpr_read_b32 v234, a101
    v_mul_f32_e64 v234, v234, v232
    v_accvgpr_write_b32 a101, v234
    v_accvgpr_read_b32 v235, a102
    v_mul_f32_e64 v235, v235, v232
    v_accvgpr_write_b32 a102, v235
    v_accvgpr_read_b32 v236, a103
    v_mul_f32_e64 v236, v236, v232
    v_accvgpr_write_b32 a103, v236
    v_accvgpr_read_b32 v233, a104
    v_mul_f32_e64 v233, v233, v232
    v_accvgpr_write_b32 a104, v233
    v_accvgpr_read_b32 v234, a105
    v_mul_f32_e64 v234, v234, v232
    v_accvgpr_write_b32 a105, v234
    v_accvgpr_read_b32 v235, a106
    v_mul_f32_e64 v235, v235, v232
    v_accvgpr_write_b32 a106, v235
    v_accvgpr_read_b32 v236, a107
    v_mul_f32_e64 v236, v236, v232
    v_accvgpr_write_b32 a107, v236
    v_accvgpr_read_b32 v233, a108
    v_mul_f32_e64 v233, v233, v232
    v_accvgpr_write_b32 a108, v233
    v_accvgpr_read_b32 v234, a109
    v_mul_f32_e64 v234, v234, v232
    v_accvgpr_write_b32 a109, v234
    v_accvgpr_read_b32 v235, a110
    v_mul_f32_e64 v235, v235, v232
    v_accvgpr_write_b32 a110, v235
    v_accvgpr_read_b32 v236, a111
    v_mul_f32_e64 v236, v236, v232
    v_accvgpr_write_b32 a111, v236
    v_accvgpr_read_b32 v233, a112
    v_mul_f32_e64 v233, v233, v232
    v_accvgpr_write_b32 a112, v233
    v_accvgpr_read_b32 v234, a113
    v_mul_f32_e64 v234, v234, v232
    v_accvgpr_write_b32 a113, v234
    v_accvgpr_read_b32 v235, a114
    v_mul_f32_e64 v235, v235, v232
    v_accvgpr_write_b32 a114, v235
    v_accvgpr_read_b32 v236, a115
    v_mul_f32_e64 v236, v236, v232
    v_accvgpr_write_b32 a115, v236
    v_accvgpr_read_b32 v233, a116
    v_mul_f32_e64 v233, v233, v232
    v_accvgpr_write_b32 a116, v233
    v_accvgpr_read_b32 v234, a117
    v_mul_f32_e64 v234, v234, v232
    v_accvgpr_write_b32 a117, v234
    v_accvgpr_read_b32 v235, a118
    v_mul_f32_e64 v235, v235, v232
    v_accvgpr_write_b32 a118, v235
    v_accvgpr_read_b32 v236, a119
    v_mul_f32_e64 v236, v236, v232
    v_accvgpr_write_b32 a119, v236
    v_accvgpr_read_b32 v233, a120
    v_mul_f32_e64 v233, v233, v232
    v_accvgpr_write_b32 a120, v233
    v_accvgpr_read_b32 v234, a121
    v_mul_f32_e64 v234, v234, v232
    v_accvgpr_write_b32 a121, v234
    v_accvgpr_read_b32 v235, a122
    v_mul_f32_e64 v235, v235, v232
    v_accvgpr_write_b32 a122, v235
    v_accvgpr_read_b32 v236, a123
    v_mul_f32_e64 v236, v236, v232
    v_accvgpr_write_b32 a123, v236
    v_accvgpr_read_b32 v233, a124
    v_mul_f32_e64 v233, v233, v232
    v_accvgpr_write_b32 a124, v233
    v_accvgpr_read_b32 v234, a125
    v_mul_f32_e64 v234, v234, v232
    v_accvgpr_write_b32 a125, v234
    v_accvgpr_read_b32 v235, a126
    v_mul_f32_e64 v235, v235, v232
    v_accvgpr_write_b32 a126, v235
    v_accvgpr_read_b32 v236, a127
    v_mul_f32_e64 v236, v236, v232
    v_accvgpr_write_b32 a127, v236
    v_exp_f32 v128, v24
    v_exp_f32 v129, v25
    v_exp_f32 v130, v26
    v_exp_f32 v131, v27
    v_exp_f32 v132, v28
    v_exp_f32 v133, v29
    v_exp_f32 v134, v30
    v_exp_f32_e64 v135, v31
    s_nop 0
    v_cvt_pk_bf16_f32 v108, v128, v129
    v_cvt_pk_bf16_f32 v109, v130, v131
    v_cvt_pk_bf16_f32 v110, v132, v133
    v_cvt_pk_bf16_f32 v111, v134, v135
    s_nop 1
    s_branch kf_rr17
kf_rare22:
    s_nop 15
    v_max3_f32 v230, v48, v49, v50
    v_max3_f32 v230, v230, v51, v52
    v_max3_f32 v230, v230, v53, v54
    v_max_f32 v230, v230, v55
    v_mov_b32 v231, v230
    s_nop 1
    v_permlane16_swap_b32 v230, v231
    s_nop 0
    v_max_f32 v230, v230, v231
    v_mov_b32 v231, v230
    s_nop 1
    v_permlane32_swap_b32 v230, v231
    s_nop 0
    v_max_f32 v230, v230, v231
    v_add_f32 v230, 0x41800000, v230
    v_max_f32 v230, 0, v230
    v_sub_f32 v232, 0, v230
    v_exp_f32 v232, v232
    v_sub_f32 v226, v226, v230
    v_sub_f32 v80, v80, v230
    v_sub_f32 v16, v16, v230
    v_sub_f32 v48, v48, v230
    v_sub_f32 v81, v81, v230
    v_sub_f32 v17, v17, v230
    v_sub_f32 v49, v49, v230
    v_sub_f32 v82, v82, v230
    v_sub_f32 v18, v18, v230
    v_sub_f32 v50, v50, v230
    v_sub_f32 v83, v83, v230
    v_sub_f32 v19, v19, v230
    v_sub_f32 v51, v51, v230
    v_sub_f32 v84, v84, v230
    v_sub_f32 v20, v20, v230
    v_sub_f32 v52, v52, v230
    v_sub_f32 v85, v85, v230
    v_sub_f32 v21, v21, v230
    v_sub_f32 v53, v53, v230
    v_sub_f32 v86, v86, v230
    v_sub_f32 v22, v22, v230
    v_sub_f32 v54, v54, v230
    v_sub_f32 v87, v87, v230
    v_sub_f32 v23, v23, v230
    v_sub_f32 v55, v55, v230
    v_mul_f32 v152, v152, v232
    v_mul_f32 v153, v153, v232
    v_mul_f32 v154, v154, v232
    v_mul_f32 v155, v155, v232
    v_accvgpr_read_b32 v233, a64
    v_mul_f32_e64 v233, v233, v232
    v_accvgpr_write_b32 a64, v233
    v_accvgpr_read_b32 v234, a65
    v_mul_f32_e64 v234, v234, v232
    v_accvgpr_write_b32 a65, v234
    v_accvgpr_read_b32 v235, a66
    v_mul_f32_e64 v235, v235, v232
    v_accvgpr_write_b32 a66, v235
    v_accvgpr_read_b32 v236, a67
    v_mul_f32_e64 v236, v236, v232
    v_accvgpr_write_b32 a67, v236
    v_accvgpr_read_b32 v233, a68
    v_mul_f32_e64 v233, v233, v232
    v_accvgpr_write_b32 a68, v233
    v_accvgpr_read_b32 v234, a69
    v_mul_f32_e64 v234, v234, v232
    v_accvgpr_write_b32 a69, v234
    v_accvgpr_read_b32 v235, a70
    v_mul_f32_e64 v235, v235, v232
    v_accvgpr_write_b32 a70, v235
    v_accvgpr_read_b32 v236, a71
    v_mul_f32_e64 v236, v236, v232
    v_accvgpr_write_b32 a71, v236
    v_accvgpr_read_b32 v233, a72
    v_mul_f32_e64 v233, v233, v232
    v_accvgpr_write_b32 a72, v233
    v_accvgpr_read_b32 v234, a73
    v_mul_f32_e64 v234, v234, v232
    v_accvgpr_write_b32 a73, v234
    v_accvgpr_read_b32 v235, a74
    v_mul_f32_e64 v235, v235, v232
    v_accvgpr_write_b32 a74, v235
    v_accvgpr_read_b32 v236, a75
    v_mul_f32_e64 v236, v236, v232
    v_accvgpr_write_b32 a75, v236
    v_accvgpr_read_b32 v233, a76
    v_mul_f32_e64 v233, v233, v232
    v_accvgpr_write_b32 a76, v233
    v_accvgpr_read_b32 v234, a77
    v_mul_f32_e64 v234, v234, v232
    v_accvgpr_write_b32 a77, v234
    v_accvgpr_read_b32 v235, a78
    v_mul_f32_e64 v235, v235, v232
    v_accvgpr_write_b32 a78, v235
    v_accvgpr_read_b32 v236, a79
    v_mul_f32_e64 v236, v236, v232
    v_accvgpr_write_b32 a79, v236
    v_accvgpr_read_b32 v233, a80
    v_mul_f32_e64 v233, v233, v232
    v_accvgpr_write_b32 a80, v233
    v_accvgpr_read_b32 v234, a81
    v_mul_f32_e64 v234, v234, v232
    v_accvgpr_write_b32 a81, v234
    v_accvgpr_read_b32 v235, a82
    v_mul_f32_e64 v235, v235, v232
    v_accvgpr_write_b32 a82, v235
    v_accvgpr_read_b32 v236, a83
    v_mul_f32_e64 v236, v236, v232
    v_accvgpr_write_b32 a83, v236
    v_accvgpr_read_b32 v233, a84
    v_mul_f32_e64 v233, v233, v232
    v_accvgpr_write_b32 a84, v233
    v_accvgpr_read_b32 v234, a85
    v_mul_f32_e64 v234, v234, v232
    v_accvgpr_write_b32 a85, v234
    v_accvgpr_read_b32 v235, a86
    v_mul_f32_e64 v235, v235, v232
    v_accvgpr_write_b32 a86, v235
    v_accvgpr_read_b32 v236, a87
    v_mul_f32_e64 v236, v236, v232
    v_accvgpr_write_b32 a87, v236
    v_accvgpr_read_b32 v233, a88
    v_mul_f32_e64 v233, v233, v232
    v_accvgpr_write_b32 a88, v233
    v_accvgpr_read_b32 v234, a89
    v_mul_f32_e64 v234, v234, v232
    v_accvgpr_write_b32 a89, v234
    v_accvgpr_read_b32 v235, a90
    v_mul_f32_e64 v235, v235, v232
    v_accvgpr_write_b32 a90, v235
    v_accvgpr_read_b32 v236, a91
    v_mul_f32_e64 v236, v236, v232
    v_accvgpr_write_b32 a91, v236
    v_accvgpr_read_b32 v233, a92
    v_mul_f32_e64 v233, v233, v232
    v_accvgpr_write_b32 a92, v233
    v_accvgpr_read_b32 v234, a93
    v_mul_f32_e64 v234, v234, v232
    v_accvgpr_write_b32 a93, v234
    v_accvgpr_read_b32 v235, a94
    v_mul_f32_e64 v235, v235, v232
    v_accvgpr_write_b32 a94, v235
    v_accvgpr_read_b32 v236, a95
    v_mul_f32_e64 v236, v236, v232
    v_accvgpr_write_b32 a95, v236
    v_exp_f32 v128, v48
    v_exp_f32 v129, v49
    v_exp_f32 v130, v50
    v_exp_f32 v131, v51
    v_exp_f32 v132, v52
    v_exp_f32 v133, v53
    v_exp_f32 v134, v54
    v_exp_f32_e64 v135, v55
    s_nop 0
    v_cvt_pk_bf16_f32 v120, v128, v129
    v_cvt_pk_bf16_f32 v121, v130, v131
    v_cvt_pk_bf16_f32 v122, v132, v133
    v_cvt_pk_bf16_f32 v123, v134, v135
    v_max3_f32 v230, v56, v57, v58
    v_max3_f32 v230, v230, v59, v60
    v_max3_f32 v230, v230, v61, v62
    v_max_f32 v230, v230, v63
    v_mov_b32 v231, v230
    s_nop 1
    v_permlane16_swap_b32 v230, v231
    s_nop 0
    v_max_f32 v230, v230, v231
    v_mov_b32 v231, v230
    s_nop 1
    v_permlane32_swap_b32 v230, v231
    s_nop 0
    v_max_f32_e64 v230, v230, v231
    v_add_f32 v230, 0x41800000, v230
    v_max_f32 v230, 0, v230
    v_sub_f32 v232, 0, v230
    v_exp_f32 v232, v232
    v_sub_f32 v227, v227, v230
    v_sub_f32 v88, v88, v230
    v_sub_f32 v24, v24, v230
    v_sub_f32 v56, v56, v230
    v_sub_f32 v89, v89, v230
    v_sub_f32 v25, v25, v230
    v_sub_f32 v57, v57, v230
    v_sub_f32 v90, v90, v230
    v_sub_f32 v26, v26, v230
    v_sub_f32 v58, v58, v230
    v_sub_f32 v91, v91, v230
    v_sub_f32 v27, v27, v230
    v_sub_f32 v59, v59, v230
    v_sub_f32 v92, v92, v230
    v_sub_f32 v28, v28, v230
    v_sub_f32 v60, v60, v230
    v_sub_f32 v93, v93, v230
    v_sub_f32 v29, v29, v230
    v_sub_f32 v61, v61, v230
    v_sub_f32 v94, v94, v230
    v_sub_f32 v30, v30, v230
    v_sub_f32 v62, v62, v230
    v_sub_f32 v95, v95, v230
    v_sub_f32 v31, v31, v230
    v_sub_f32 v63, v63, v230
    v_mul_f32 v156, v156, v232
    v_mul_f32 v157, v157, v232
    v_mul_f32 v158, v158, v232
    v_mul_f32 v159, v159, v232
    v_accvgpr_read_b32 v233, a96
    v_mul_f32_e64 v233, v233, v232
    v_accvgpr_write_b32 a96, v233
    v_accvgpr_read_b32 v234, a97
    v_mul_f32_e64 v234, v234, v232
    v_accvgpr_write_b32 a97, v234
    v_accvgpr_read_b32 v235, a98
    v_mul_f32_e64 v235, v235, v232
    v_accvgpr_write_b32 a98, v235
    v_accvgpr_read_b32 v236, a99
    v_mul_f32_e64 v236, v236, v232
    v_accvgpr_write_b32 a99, v236
    v_accvgpr_read_b32 v233, a100
    v_mul_f32_e64 v233, v233, v232
    v_accvgpr_write_b32 a100, v233
    v_accvgpr_read_b32 v234, a101
    v_mul_f32_e64 v234, v234, v232
    v_accvgpr_write_b32 a101, v234
    v_accvgpr_read_b32 v235, a102
    v_mul_f32_e64 v235, v235, v232
    v_accvgpr_write_b32 a102, v235
    v_accvgpr_read_b32 v236, a103
    v_mul_f32_e64 v236, v236, v232
    v_accvgpr_write_b32 a103, v236
    v_accvgpr_read_b32 v233, a104
    v_mul_f32_e64 v233, v233, v232
    v_accvgpr_write_b32 a104, v233
    v_accvgpr_read_b32 v234, a105
    v_mul_f32_e64 v234, v234, v232
    v_accvgpr_write_b32 a105, v234
    v_accvgpr_read_b32 v235, a106
    v_mul_f32_e64 v235, v235, v232
    v_accvgpr_write_b32 a106, v235
    v_accvgpr_read_b32 v236, a107
    v_mul_f32_e64 v236, v236, v232
    v_accvgpr_write_b32 a107, v236
    v_accvgpr_read_b32 v233, a108
    v_mul_f32_e64 v233, v233, v232
    v_accvgpr_write_b32 a108, v233
    v_accvgpr_read_b32 v234, a109
    v_mul_f32_e64 v234, v234, v232
    v_accvgpr_write_b32 a109, v234
    v_accvgpr_read_b32 v235, a110
    v_mul_f32_e64 v235, v235, v232
    v_accvgpr_write_b32 a110, v235
    v_accvgpr_read_b32 v236, a111
    v_mul_f32_e64 v236, v236, v232
    v_accvgpr_write_b32 a111, v236
    v_accvgpr_read_b32 v233, a112
    v_mul_f32_e64 v233, v233, v232
    v_accvgpr_write_b32 a112, v233
    v_accvgpr_read_b32 v234, a113
    v_mul_f32_e64 v234, v234, v232
    v_accvgpr_write_b32 a113, v234
    v_accvgpr_read_b32 v235, a114
    v_mul_f32_e64 v235, v235, v232
    v_accvgpr_write_b32 a114, v235
    v_accvgpr_read_b32 v236, a115
    v_mul_f32_e64 v236, v236, v232
    v_accvgpr_write_b32 a115, v236
    v_accvgpr_read_b32 v233, a116
    v_mul_f32_e64 v233, v233, v232
    v_accvgpr_write_b32 a116, v233
    v_accvgpr_read_b32 v234, a117
    v_mul_f32_e64 v234, v234, v232
    v_accvgpr_write_b32 a117, v234
    v_accvgpr_read_b32 v235, a118
    v_mul_f32_e64 v235, v235, v232
    v_accvgpr_write_b32 a118, v235
    v_accvgpr_read_b32 v236, a119
    v_mul_f32_e64 v236, v236, v232
    v_accvgpr_write_b32 a119, v236
    v_accvgpr_read_b32 v233, a120
    v_mul_f32_e64 v233, v233, v232
    v_accvgpr_write_b32 a120, v233
    v_accvgpr_read_b32 v234, a121
    v_mul_f32_e64 v234, v234, v232
    v_accvgpr_write_b32 a121, v234
    v_accvgpr_read_b32 v235, a122
    v_mul_f32_e64 v235, v235, v232
    v_accvgpr_write_b32 a122, v235
    v_accvgpr_read_b32 v236, a123
    v_mul_f32_e64 v236, v236, v232
    v_accvgpr_write_b32 a123, v236
    v_accvgpr_read_b32 v233, a124
    v_mul_f32_e64 v233, v233, v232
    v_accvgpr_write_b32 a124, v233
    v_accvgpr_read_b32 v234, a125
    v_mul_f32_e64 v234, v234, v232
    v_accvgpr_write_b32 a125, v234
    v_accvgpr_read_b32 v235, a126
    v_mul_f32_e64 v235, v235, v232
    v_accvgpr_write_b32 a126, v235
    v_accvgpr_read_b32 v236, a127
    v_mul_f32_e64 v236, v236, v232
    v_accvgpr_write_b32 a127, v236
    v_exp_f32 v128, v56
    v_exp_f32 v129, v57
    v_exp_f32 v130, v58
    v_exp_f32 v131, v59
    v_exp_f32 v132, v60
    v_exp_f32 v133, v61
    v_exp_f32 v134, v62
    v_exp_f32_e64 v135, v63
    s_nop 0
    v_cvt_pk_bf16_f32 v124, v128, v129
    v_cvt_pk_bf16_f32 v125, v130, v131
    v_cvt_pk_bf16_f32 v126, v132, v133
    v_cvt_pk_bf16_f32 v127, v134, v135
    s_nop 1
    s_branch kf_rr21
kf_rare26:
    s_nop 15
    v_max3_f32 v230, v16, v17, v18
    v_max3_f32 v230, v230, v19, v20
    v_max3_f32 v230, v230, v21, v22
    v_max_f32 v230, v230, v23
    v_mov_b32 v231, v230
    s_nop 1
    v_permlane16_swap_b32 v230, v231
    s_nop 0
    v_max_f32 v230, v230, v231
    v_mov_b32 v231, v230
    s_nop 1
    v_permlane32_swap_b32 v230, v231
    s_nop 0
    v_max_f32 v230, v230, v231
    v_add_f32 v230, 0x41800000, v230
    v_max_f32 v230, 0, v230
    v_sub_f32 v232, 0, v230
    v_exp_f32 v232, v232
    v_sub_f32 v226, v226, v230
    v_sub_f32 v80, v80, v230
    v_sub_f32 v48, v48, v230
    v_sub_f32 v16, v16, v230
    v_sub_f32 v81, v81, v230
    v_sub_f32 v49, v49, v230
    v_sub_f32 v17, v17, v230
    v_sub_f32 v82, v82, v230
    v_sub_f32 v50, v50, v230
    v_sub_f32 v18, v18, v230
    v_sub_f32 v83, v83, v230
    v_sub_f32 v51, v51, v230
    v_sub_f32 v19, v19, v230
    v_sub_f32 v84, v84, v230
    v_sub_f32 v52, v52, v230
    v_sub_f32 v20, v20, v230
    v_sub_f32 v85, v85, v230
    v_sub_f32 v53, v53, v230
    v_sub_f32 v21, v21, v230
    v_sub_f32 v86, v86, v230
    v_sub_f32 v54, v54, v230
    v_sub_f32 v22, v22, v230
    v_sub_f32 v87, v87, v230
    v_sub_f32 v55, v55, v230
    v_sub_f32 v23, v23, v230
    v_mul_f32 v152, v152, v232
    v_mul_f32 v153, v153, v232
    v_mul_f32 v154, v154, v232
    v_mul_f32 v155, v155, v232
    v_accvgpr_read_b32 v233, a64
    v_mul_f32_e64 v233, v233, v232
    v_accvgpr_write_b32 a64, v233
    v_accvgpr_read_b32 v234, a65
    v_mul_f32_e64 v234, v234, v232
    v_accvgpr_write_b32 a65, v234
    v_accvgpr_read_b32 v235, a66
    v_mul_f32_e64 v235, v235, v232
    v_accvgpr_write_b32 a66, v235
    v_accvgpr_read_b32 v236, a67
    v_mul_f32_e64 v236, v236, v232
    v_accvgpr_write_b32 a67, v236
    v_accvgpr_read_b32 v233, a68
    v_mul_f32_e64 v233, v233, v232
    v_accvgpr_write_b32 a68, v233
    v_accvgpr_read_b32 v234, a69
    v_mul_f32_e64 v234, v234, v232
    v_accvgpr_write_b32 a69, v234
    v_accvgpr_read_b32 v235, a70
    v_mul_f32_e64 v235, v235, v232
    v_accvgpr_write_b32 a70, v235
    v_accvgpr_read_b32 v236, a71
    v_mul_f32_e64 v236, v236, v232
    v_accvgpr_write_b32 a71, v236
    v_accvgpr_read_b32 v233, a72
    v_mul_f32_e64 v233, v233, v232
    v_accvgpr_write_b32 a72, v233
    v_accvgpr_read_b32 v234, a73
    v_mul_f32_e64 v234, v234, v232
    v_accvgpr_write_b32 a73, v234
    v_accvgpr_read_b32 v235, a74
    v_mul_f32_e64 v235, v235, v232
    v_accvgpr_write_b32 a74, v235
    v_accvgpr_read_b32 v236, a75
    v_mul_f32_e64 v236, v236, v232
    v_accvgpr_write_b32 a75, v236
    v_accvgpr_read_b32 v233, a76
    v_mul_f32_e64 v233, v233, v232
    v_accvgpr_write_b32 a76, v233
    v_accvgpr_read_b32 v234, a77
    v_mul_f32_e64 v234, v234, v232
    v_accvgpr_write_b32 a77, v234
    v_accvgpr_read_b32 v235, a78
    v_mul_f32_e64 v235, v235, v232
    v_accvgpr_write_b32 a78, v235
    v_accvgpr_read_b32 v236, a79
    v_mul_f32_e64 v236, v236, v232
    v_accvgpr_write_b32 a79, v236
    v_accvgpr_read_b32 v233, a80
    v_mul_f32_e64 v233, v233, v232
    v_accvgpr_write_b32 a80, v233
    v_accvgpr_read_b32 v234, a81
    v_mul_f32_e64 v234, v234, v232
    v_accvgpr_write_b32 a81, v234
    v_accvgpr_read_b32 v235, a82
    v_mul_f32_e64 v235, v235, v232
    v_accvgpr_write_b32 a82, v235
    v_accvgpr_read_b32 v236, a83
    v_mul_f32_e64 v236, v236, v232
    v_accvgpr_write_b32 a83, v236
    v_accvgpr_read_b32 v233, a84
    v_mul_f32_e64 v233, v233, v232
    v_accvgpr_write_b32 a84, v233
    v_accvgpr_read_b32 v234, a85
    v_mul_f32_e64 v234, v234, v232
    v_accvgpr_write_b32 a85, v234
    v_accvgpr_read_b32 v235, a86
    v_mul_f32_e64 v235, v235, v232
    v_accvgpr_write_b32 a86, v235
    v_accvgpr_read_b32 v236, a87
    v_mul_f32_e64 v236, v236, v232
    v_accvgpr_write_b32 a87, v236
    v_accvgpr_read_b32 v233, a88
    v_mul_f32_e64 v233, v233, v232
    v_accvgpr_write_b32 a88, v233
    v_accvgpr_read_b32 v234, a89
    v_mul_f32_e64 v234, v234, v232
    v_accvgpr_write_b32 a89, v234
    v_accvgpr_read_b32 v235, a90
    v_mul_f32_e64 v235, v235, v232
    v_accvgpr_write_b32 a90, v235
    v_accvgpr_read_b32 v236, a91
    v_mul_f32_e64 v236, v236, v232
    v_accvgpr_write_b32 a91, v236
    v_accvgpr_read_b32 v233, a92
    v_mul_f32_e64 v233, v233, v232
    v_accvgpr_write_b32 a92, v233
    v_accvgpr_read_b32 v234, a93
    v_mul_f32_e64 v234, v234, v232
    v_accvgpr_write_b32 a93, v234
    v_accvgpr_read_b32 v235, a94
    v_mul_f32_e64 v235, v235, v232
    v_accvgpr_write_b32 a94, v235
    v_accvgpr_read_b32 v236, a95
    v_mul_f32_e64 v236, v236, v232
    v_accvgpr_write_b32 a95, v236
    v_exp_f32 v128, v16
    v_exp_f32 v129, v17
    v_exp_f32 v130, v18
    v_exp_f32 v131, v19
    v_exp_f32 v132, v20
    v_exp_f32 v133, v21
    v_exp_f32 v134, v22
    v_exp_f32_e64 v135, v23
    s_nop 0
    v_cvt_pk_bf16_f32 v104, v128, v129
    v_cvt_pk_bf16_f32 v105, v130, v131
    v_cvt_pk_bf16_f32 v106, v132, v133
    v_cvt_pk_bf16_f32 v107, v134, v135
    v_max3_f32 v230, v24, v25, v26
    v_max3_f32 v230, v230, v27, v28
    v_max3_f32 v230, v230, v29, v30
    v_max_f32 v230, v230, v31
    v_mov_b32 v231, v230
    s_nop 1
    v_permlane16_swap_b32 v230, v231
    s_nop 0
    v_max_f32 v230, v230, v231
    v_mov_b32 v231, v230
    s_nop 1
    v_permlane32_swap_b32 v230, v231
    s_nop 0
    v_max_f32_e64 v230, v230, v231
    v_add_f32 v230, 0x41800000, v230
    v_max_f32 v230, 0, v230
    v_sub_f32 v232, 0, v230
    v_exp_f32 v232, v232
    v_sub_f32 v227, v227, v230
    v_sub_f32 v88, v88, v230
    v_sub_f32 v56, v56, v230
    v_sub_f32 v24, v24, v230
    v_sub_f32 v89, v89, v230
    v_sub_f32 v57, v57, v230
    v_sub_f32 v25, v25, v230
    v_sub_f32 v90, v90, v230
    v_sub_f32 v58, v58, v230
    v_sub_f32 v26, v26, v230
    v_sub_f32 v91, v91, v230
    v_sub_f32 v59, v59, v230
    v_sub_f32 v27, v27, v230
    v_sub_f32 v92, v92, v230
    v_sub_f32 v60, v60, v230
    v_sub_f32 v28, v28, v230
    v_sub_f32 v93, v93, v230
    v_sub_f32 v61, v61, v230
    v_sub_f32 v29, v29, v230
    v_sub_f32 v94, v94, v230
    v_sub_f32 v62, v62, v230
    v_sub_f32 v30, v30, v230
    v_sub_f32 v95, v95, v230
    v_sub_f32 v63, v63, v230
    v_sub_f32 v31, v31, v230
    v_mul_f32 v156, v156, v232
    v_mul_f32 v157, v157, v232
    v_mul_f32 v158, v158, v232
    v_mul_f32 v159, v159, v232
    v_accvgpr_read_b32 v233, a96
    v_mul_f32_e64 v233, v233, v232
    v_accvgpr_write_b32 a96, v233
    v_accvgpr_read_b32 v234, a97
    v_mul_f32_e64 v234, v234, v232
    v_accvgpr_write_b32 a97, v234
    v_accvgpr_read_b32 v235, a98
    v_mul_f32_e64 v235, v235, v232
    v_accvgpr_write_b32 a98, v235
    v_accvgpr_read_b32 v236, a99
    v_mul_f32_e64 v236, v236, v232
    v_accvgpr_write_b32 a99, v236
    v_accvgpr_read_b32 v233, a100
    v_mul_f32_e64 v233, v233, v232
    v_accvgpr_write_b32 a100, v233
    v_accvgpr_read_b32 v234, a101
    v_mul_f32_e64 v234, v234, v232
    v_accvgpr_write_b32 a101, v234
    v_accvgpr_read_b32 v235, a102
    v_mul_f32_e64 v235, v235, v232
    v_accvgpr_write_b32 a102, v235
    v_accvgpr_read_b32 v236, a103
    v_mul_f32_e64 v236, v236, v232
    v_accvgpr_write_b32 a103, v236
    v_accvgpr_read_b32 v233, a104
    v_mul_f32_e64 v233, v233, v232
    v_accvgpr_write_b32 a104, v233
    v_accvgpr_read_b32 v234, a105
    v_mul_f32_e64 v234, v234, v232
    v_accvgpr_write_b32 a105, v234
    v_accvgpr_read_b32 v235, a106
    v_mul_f32_e64 v235, v235, v232
    v_accvgpr_write_b32 a106, v235
    v_accvgpr_read_b32 v236, a107
    v_mul_f32_e64 v236, v236, v232
    v_accvgpr_write_b32 a107, v236
    v_accvgpr_read_b32 v233, a108
    v_mul_f32_e64 v233, v233, v232
    v_accvgpr_write_b32 a108, v233
    v_accvgpr_read_b32 v234, a109
    v_mul_f32_e64 v234, v234, v232
    v_accvgpr_write_b32 a109, v234
    v_accvgpr_read_b32 v235, a110
    v_mul_f32_e64 v235, v235, v232
    v_accvgpr_write_b32 a110, v235
    v_accvgpr_read_b32 v236, a111
    v_mul_f32_e64 v236, v236, v232
    v_accvgpr_write_b32 a111, v236
    v_accvgpr_read_b32 v233, a112
    v_mul_f32_e64 v233, v233, v232
    v_accvgpr_write_b32 a112, v233
    v_accvgpr_read_b32 v234, a113
    v_mul_f32_e64 v234, v234, v232
    v_accvgpr_write_b32 a113, v234
    v_accvgpr_read_b32 v235, a114
    v_mul_f32_e64 v235, v235, v232
    v_accvgpr_write_b32 a114, v235
    v_accvgpr_read_b32 v236, a115
    v_mul_f32_e64 v236, v236, v232
    v_accvgpr_write_b32 a115, v236
    v_accvgpr_read_b32 v233, a116
    v_mul_f32_e64 v233, v233, v232
    v_accvgpr_write_b32 a116, v233
    v_accvgpr_read_b32 v234, a117
    v_mul_f32_e64 v234, v234, v232
    v_accvgpr_write_b32 a117, v234
    v_accvgpr_read_b32 v235, a118
    v_mul_f32_e64 v235, v235, v232
    v_accvgpr_write_b32 a118, v235
    v_accvgpr_read_b32 v236, a119
    v_mul_f32_e64 v236, v236, v232
    v_accvgpr_write_b32 a119, v236
    v_accvgpr_read_b32 v233, a120
    v_mul_f32_e64 v233, v233, v232
    v_accvgpr_write_b32 a120, v233
    v_accvgpr_read_b32 v234, a121
    v_mul_f32_e64 v234, v234, v232
    v_accvgpr_write_b32 a121, v234
    v_accvgpr_read_b32 v235, a122
    v_mul_f32_e64 v235, v235, v232
    v_accvgpr_write_b32 a122, v235
    v_accvgpr_read_b32 v236, a123
    v_mul_f32_e64 v236, v236, v232
    v_accvgpr_write_b32 a123, v236
    v_accvgpr_read_b32 v233, a124
    v_mul_f32_e64 v233, v233, v232
    v_accvgpr_write_b32 a124, v233
    v_accvgpr_read_b32 v234, a125
    v_mul_f32_e64 v234, v234, v232
    v_accvgpr_write_b32 a125, v234
    v_accvgpr_read_b32 v235, a126
    v_mul_f32_e64 v235, v235, v232
    v_accvgpr_write_b32 a126, v235
    v_accvgpr_read_b32 v236, a127
    v_mul_f32_e64 v236, v236, v232
    v_accvgpr_write_b32 a127, v236
    v_exp_f32 v128, v24
    v_exp_f32 v129, v25
    v_exp_f32 v130, v26
    v_exp_f32 v131, v27
    v_exp_f32 v132, v28
    v_exp_f32 v133, v29
    v_exp_f32 v134, v30
    v_exp_f32_e64 v135, v31
    s_nop 0
    v_cvt_pk_bf16_f32 v108, v128, v129
    v_cvt_pk_bf16_f32 v109, v130, v131
    v_cvt_pk_bf16_f32 v110, v132, v133
    v_cvt_pk_bf16_f32 v111, v134, v135
    s_nop 1
    s_branch kf_rr25
kf_rare30:
    s_nop 15
    v_max3_f32 v230, v48, v49, v50
    v_max3_f32 v230, v230, v51, v52
    v_max3_f32 v230, v230, v53, v54
    v_max_f32 v230, v230, v55
    v_mov_b32 v231, v230
    s_nop 1
    v_permlane16_swap_b32 v230, v231
    s_nop 0
    v_max_f32 v230, v230, v231
    v_mov_b32 v231, v230
    s_nop 1
    v_permlane32_swap_b32 v230, v231
    s_nop 0
    v_max_f32 v230, v230, v231
    v_add_f32 v230, 0x41800000, v230
    v_max_f32 v230, 0, v230
    v_sub_f32 v232, 0, v230
    v_exp_f32 v232, v232
    v_sub_f32 v226, v226, v230
    v_sub_f32 v80, v80, v230
    v_sub_f32 v16, v16, v230
    v_sub_f32 v48, v48, v230
    v_sub_f32 v81, v81, v230
    v_sub_f32 v17, v17, v230
    v_sub_f32 v49, v49, v230
    v_sub_f32 v82, v82, v230
    v_sub_f32 v18, v18, v230
    v_sub_f32 v50, v50, v230
    v_sub_f32 v83, v83, v230
    v_sub_f32 v19, v19, v230
    v_sub_f32 v51, v51, v230
    v_sub_f32 v84, v84, v230
    v_sub_f32 v20, v20, v230
    v_sub_f32 v52, v52, v230
    v_sub_f32 v85, v85, v230
    v_sub_f32 v21, v21, v230
    v_sub_f32 v53, v53, v230
    v_sub_f32 v86, v86, v230
    v_sub_f32 v22, v22, v230
    v_sub_f32 v54, v54, v230
    v_sub_f32 v87, v87, v230
    v_sub_f32 v23, v23, v230
    v_sub_f32 v55, v55, v230
    v_mul_f32 v152, v152, v232
    v_mul_f32 v153, v153, v232
    v_mul_f32 v154, v154, v232
    v_mul_f32 v155, v155, v232
    v_accvgpr_read_b32 v233, a64
    v_mul_f32_e64 v233, v233, v232
    v_accvgpr_write_b32 a64, v233
    v_accvgpr_read_b32 v234, a65
    v_mul_f32_e64 v234, v234, v232
    v_accvgpr_write_b32 a65, v234
    v_accvgpr_read_b32 v235, a66
    v_mul_f32_e64 v235, v235, v232
    v_accvgpr_write_b32 a66, v235
    v_accvgpr_read_b32 v236, a67
    v_mul_f32_e64 v236, v236, v232
    v_accvgpr_write_b32 a67, v236
    v_accvgpr_read_b32 v233, a68
    v_mul_f32_e64 v233, v233, v232
    v_accvgpr_write_b32 a68, v233
    v_accvgpr_read_b32 v234, a69
    v_mul_f32_e64 v234, v234, v232
    v_accvgpr_write_b32 a69, v234
    v_accvgpr_read_b32 v235, a70
    v_mul_f32_e64 v235, v235, v232
    v_accvgpr_write_b32 a70, v235
    v_accvgpr_read_b32 v236, a71
    v_mul_f32_e64 v236, v236, v232
    v_accvgpr_write_b32 a71, v236
    v_accvgpr_read_b32 v233, a72
    v_mul_f32_e64 v233, v233, v232
    v_accvgpr_write_b32 a72, v233
    v_accvgpr_read_b32 v234, a73
    v_mul_f32_e64 v234, v234, v232
    v_accvgpr_write_b32 a73, v234
    v_accvgpr_read_b32 v235, a74
    v_mul_f32_e64 v235, v235, v232
    v_accvgpr_write_b32 a74, v235
    v_accvgpr_read_b32 v236, a75
    v_mul_f32_e64 v236, v236, v232
    v_accvgpr_write_b32 a75, v236
    v_accvgpr_read_b32 v233, a76
    v_mul_f32_e64 v233, v233, v232
    v_accvgpr_write_b32 a76, v233
    v_accvgpr_read_b32 v234, a77
    v_mul_f32_e64 v234, v234, v232
    v_accvgpr_write_b32 a77, v234
    v_accvgpr_read_b32 v235, a78
    v_mul_f32_e64 v235, v235, v232
    v_accvgpr_write_b32 a78, v235
    v_accvgpr_read_b32 v236, a79
    v_mul_f32_e64 v236, v236, v232
    v_accvgpr_write_b32 a79, v236
    v_accvgpr_read_b32 v233, a80
    v_mul_f32_e64 v233, v233, v232
    v_accvgpr_write_b32 a80, v233
    v_accvgpr_read_b32 v234, a81
    v_mul_f32_e64 v234, v234, v232
    v_accvgpr_write_b32 a81, v234
    v_accvgpr_read_b32 v235, a82
    v_mul_f32_e64 v235, v235, v232
    v_accvgpr_write_b32 a82, v235
    v_accvgpr_read_b32 v236, a83
    v_mul_f32_e64 v236, v236, v232
    v_accvgpr_write_b32 a83, v236
    v_accvgpr_read_b32 v233, a84
    v_mul_f32_e64 v233, v233, v232
    v_accvgpr_write_b32 a84, v233
    v_accvgpr_read_b32 v234, a85
    v_mul_f32_e64 v234, v234, v232
    v_accvgpr_write_b32 a85, v234
    v_accvgpr_read_b32 v235, a86
    v_mul_f32_e64 v235, v235, v232
    v_accvgpr_write_b32 a86, v235
    v_accvgpr_read_b32 v236, a87
    v_mul_f32_e64 v236, v236, v232
    v_accvgpr_write_b32 a87, v236
    v_accvgpr_read_b32 v233, a88
    v_mul_f32_e64 v233, v233, v232
    v_accvgpr_write_b32 a88, v233
    v_accvgpr_read_b32 v234, a89
    v_mul_f32_e64 v234, v234, v232
    v_accvgpr_write_b32 a89, v234
    v_accvgpr_read_b32 v235, a90
    v_mul_f32_e64 v235, v235, v232
    v_accvgpr_write_b32 a90, v235
    v_accvgpr_read_b32 v236, a91
    v_mul_f32_e64 v236, v236, v232
    v_accvgpr_write_b32 a91, v236
    v_accvgpr_read_b32 v233, a92
    v_mul_f32_e64 v233, v233, v232
    v_accvgpr_write_b32 a92, v233
    v_accvgpr_read_b32 v234, a93
    v_mul_f32_e64 v234, v234, v232
    v_accvgpr_write_b32 a93, v234
    v_accvgpr_read_b32 v235, a94
    v_mul_f32_e64 v235, v235, v232
    v_accvgpr_write_b32 a94, v235
    v_accvgpr_read_b32 v236, a95
    v_mul_f32_e64 v236, v236, v232
    v_accvgpr_write_b32 a95, v236
    v_exp_f32 v128, v48
    v_exp_f32 v129, v49
    v_exp_f32 v130, v50
    v_exp_f32 v131, v51
    v_exp_f32 v132, v52
    v_exp_f32 v133, v53
    v_exp_f32 v134, v54
    v_exp_f32_e64 v135, v55
    s_nop 0
    v_cvt_pk_bf16_f32 v120, v128, v129
    v_cvt_pk_bf16_f32 v121, v130, v131
    v_cvt_pk_bf16_f32 v122, v132, v133
    v_cvt_pk_bf16_f32 v123, v134, v135
    v_max3_f32 v230, v56, v57, v58
    v_max3_f32 v230, v230, v59, v60
    v_max3_f32 v230, v230, v61, v62
    v_max_f32 v230, v230, v63
    v_mov_b32 v231, v230
    s_nop 1
    v_permlane16_swap_b32 v230, v231
    s_nop 0
    v_max_f32 v230, v230, v231
    v_mov_b32 v231, v230
    s_nop 1
    v_permlane32_swap_b32 v230, v231
    s_nop 0
    v_max_f32_e64 v230, v230, v231
    v_add_f32 v230, 0x41800000, v230
    v_max_f32 v230, 0, v230
    v_sub_f32 v232, 0, v230
    v_exp_f32 v232, v232
    v_sub_f32 v227, v227, v230
    v_sub_f32 v88, v88, v230
    v_sub_f32 v24, v24, v230
    v_sub_f32 v56, v56, v230
    v_sub_f32 v89, v89, v230
    v_sub_f32 v25, v25, v230
    v_sub_f32 v57, v57, v230
    v_sub_f32 v90, v90, v230
    v_sub_f32 v26, v26, v230
    v_sub_f32 v58, v58, v230
    v_sub_f32 v91, v91, v230
    v_sub_f32 v27, v27, v230
    v_sub_f32 v59, v59, v230
    v_sub_f32 v92, v92, v230
    v_sub_f32 v28, v28, v230
    v_sub_f32 v60, v60, v230
    v_sub_f32 v93, v93, v230
    v_sub_f32 v29, v29, v230
    v_sub_f32 v61, v61, v230
    v_sub_f32 v94, v94, v230
    v_sub_f32 v30, v30, v230
    v_sub_f32 v62, v62, v230
    v_sub_f32 v95, v95, v230
    v_sub_f32 v31, v31, v230
    v_sub_f32 v63, v63, v230
    v_mul_f32 v156, v156, v232
    v_mul_f32 v157, v157, v232
    v_mul_f32 v158, v158, v232
    v_mul_f32 v159, v159, v232
    v_accvgpr_read_b32 v233, a96
    v_mul_f32_e64 v233, v233, v232
    v_accvgpr_write_b32 a96, v233
    v_accvgpr_read_b32 v234, a97
    v_mul_f32_e64 v234, v234, v232
    v_accvgpr_write_b32 a97, v234
    v_accvgpr_read_b32 v235, a98
    v_mul_f32_e64 v235, v235, v232
    v_accvgpr_write_b32 a98, v235
    v_accvgpr_read_b32 v236, a99
    v_mul_f32_e64 v236, v236, v232
    v_accvgpr_write_b32 a99, v236
    v_accvgpr_read_b32 v233, a100
    v_mul_f32_e64 v233, v233, v232
    v_accvgpr_write_b32 a100, v233
    v_accvgpr_read_b32 v234, a101
    v_mul_f32_e64 v234, v234, v232
    v_accvgpr_write_b32 a101, v234
    v_accvgpr_read_b32 v235, a102
    v_mul_f32_e64 v235, v235, v232
    v_accvgpr_write_b32 a102, v235
    v_accvgpr_read_b32 v236, a103
    v_mul_f32_e64 v236, v236, v232
    v_accvgpr_write_b32 a103, v236
    v_accvgpr_read_b32 v233, a104
    v_mul_f32_e64 v233, v233, v232
    v_accvgpr_write_b32 a104, v233
    v_accvgpr_read_b32 v234, a105
    v_mul_f32_e64 v234, v234, v232
    v_accvgpr_write_b32 a105, v234
    v_accvgpr_read_b32 v235, a106
    v_mul_f32_e64 v235, v235, v232
    v_accvgpr_write_b32 a106, v235
    v_accvgpr_read_b32 v236, a107
    v_mul_f32_e64 v236, v236, v232
    v_accvgpr_write_b32 a107, v236
    v_accvgpr_read_b32 v233, a108
    v_mul_f32_e64 v233, v233, v232
    v_accvgpr_write_b32 a108, v233
    v_accvgpr_read_b32 v234, a109
    v_mul_f32_e64 v234, v234, v232
    v_accvgpr_write_b32 a109, v234
    v_accvgpr_read_b32 v235, a110
    v_mul_f32_e64 v235, v235, v232
    v_accvgpr_write_b32 a110, v235
    v_accvgpr_read_b32 v236, a111
    v_mul_f32_e64 v236, v236, v232
    v_accvgpr_write_b32 a111, v236
    v_accvgpr_read_b32 v233, a112
    v_mul_f32_e64 v233, v233, v232
    v_accvgpr_write_b32 a112, v233
    v_accvgpr_read_b32 v234, a113
    v_mul_f32_e64 v234, v234, v232
    v_accvgpr_write_b32 a113, v234
    v_accvgpr_read_b32 v235, a114
    v_mul_f32_e64 v235, v235, v232
    v_accvgpr_write_b32 a114, v235
    v_accvgpr_read_b32 v236, a115
    v_mul_f32_e64 v236, v236, v232
    v_accvgpr_write_b32 a115, v236
    v_accvgpr_read_b32 v233, a116
    v_mul_f32_e64 v233, v233, v232
    v_accvgpr_write_b32 a116, v233
    v_accvgpr_read_b32 v234, a117
    v_mul_f32_e64 v234, v234, v232
    v_accvgpr_write_b32 a117, v234
    v_accvgpr_read_b32 v235, a118
    v_mul_f32_e64 v235, v235, v232
    v_accvgpr_write_b32 a118, v235
    v_accvgpr_read_b32 v236, a119
    v_mul_f32_e64 v236, v236, v232
    v_accvgpr_write_b32 a119, v236
    v_accvgpr_read_b32 v233, a120
    v_mul_f32_e64 v233, v233, v232
    v_accvgpr_write_b32 a120, v233
    v_accvgpr_read_b32 v234, a121
    v_mul_f32_e64 v234, v234, v232
    v_accvgpr_write_b32 a121, v234
    v_accvgpr_read_b32 v235, a122
    v_mul_f32_e64 v235, v235, v232
    v_accvgpr_write_b32 a122, v235
    v_accvgpr_read_b32 v236, a123
    v_mul_f32_e64 v236, v236, v232
    v_accvgpr_write_b32 a123, v236
    v_accvgpr_read_b32 v233, a124
    v_mul_f32_e64 v233, v233, v232
    v_accvgpr_write_b32 a124, v233
    v_accvgpr_read_b32 v234, a125
    v_mul_f32_e64 v234, v234, v232
    v_accvgpr_write_b32 a125, v234
    v_accvgpr_read_b32 v235, a126
    v_mul_f32_e64 v235, v235, v232
    v_accvgpr_write_b32 a126, v235
    v_accvgpr_read_b32 v236, a127
    v_mul_f32_e64 v236, v236, v232
    v_accvgpr_write_b32 a127, v236
    v_exp_f32 v128, v56
    v_exp_f32 v129, v57
    v_exp_f32 v130, v58
    v_exp_f32 v131, v59
    v_exp_f32 v132, v60
    v_exp_f32 v133, v61
    v_exp_f32 v134, v62
    v_exp_f32_e64 v135, v63
    s_nop 0
    v_cvt_pk_bf16_f32 v124, v128, v129
    v_cvt_pk_bf16_f32 v125, v130, v131
    v_cvt_pk_bf16_f32 v126, v132, v133
    v_cvt_pk_bf16_f32 v127, v134, v135
    s_nop 1
    s_branch kf_rr29
kf_spin31:
    s_mov_b32 s25, 0x400000
kf_spin31_l:
    s_sleep 2
    buffer_load_dword v254, off, s[88:91], s97 sc1
    s_waitcnt vmcnt(0)
    v_readfirstlane_b32 s24, v254
    s_sub_u32 s25, s25, 1
    s_cbranch_scc1 kf_spinr32
    s_cmp_ge_u32 s24, 1
    s_cbranch_scc0 kf_spin31_l
    s_branch kf_spinr32
kf_spin33:
    s_mov_b32 s25, 0x400000
kf_spin33_l:
    s_sleep 2
    buffer_load_dword v254, off, s[88:91], s39 sc1
    s_waitcnt vmcnt(0)
    v_readfirstlane_b32 s24, v254
    s_sub_u32 s25, s25, 1
    s_cbranch_scc1 kf_spinr34
    s_cmp_ge_u32 s24, 32
    s_cbranch_scc0 kf_spin33_l
    s_branch kf_spinr34
kf_spin35:
    s_mov_b32 s25, 0x400000
kf_spin35_l:
    s_sleep 2
    buffer_load_dword v254, off, s[88:91], s97 sc1
    s_waitcnt vmcnt(0)
    v_readfirstlane_b32 s24, v254
    s_sub_u32 s25, s25, 1
    s_cbranch_scc1 kf_spinr36
    s_cmp_ge_u32 s24, 1
    s_cbranch_scc0 kf_spin35_l
    s_branch kf_spinr36
kf_spin37:
    s_mov_b32 s25, 0x400000
kf_spin37_l:
    s_sleep 2
    buffer_load_dword v254, off, s[88:91], s39 sc1
    s_waitcnt vmcnt(0)
    v_readfirstlane_b32 s24, v254
    s_sub_u32 s25, s25, 1
    s_cbranch_scc1 kf_spinr38
    s_cmp_ge_u32 s24, 32
    s_cbranch_scc0 kf_spin37_l
    s_branch kf_spinr38
kf_spin39:
    s_mov_b32 s25, 0x400000
kf_spin39_l:
    s_sleep 2
    buffer_load_dword v254, off, s[88:91], s35 sc1
    s_waitcnt vmcnt(0)
    v_readfirstlane_b32 s24, v254
    s_sub_u32 s25, s25, 1
    s_cbranch_scc1 kf_spinr40
    s_cmp_ge_u32 s24, 8
    s_cbranch_scc0 kf_spin39_l
    s_branch kf_spinr40

code_end:
.section .rodata,"a"
.p2align 6
.amdhsa_kernel sequential_preLN__compressed_kv_cla__moe_arch_mod__prompt_kernel
  .amdhsa_next_free_vgpr 512
  .amdhsa_next_free_sgpr 102
  .amdhsa_accum_offset 256
  .amdhsa_group_segment_fixed_size 0
  .amdhsa_kernarg_size 112
  .amdhsa_user_sgpr_count 2
  .amdhsa_user_sgpr_kernarg_segment_ptr 1
  .amdhsa_system_sgpr_workgroup_id_x 1
  .amdhsa_float_denorm_mode_32 3
.end_amdhsa_kernel
```

```asm
; @launch grid=(256,1,1) block=(256,1,1) lds=163840
.amdgcn_target "amdgcn-amd-amdhsa--gfx950"
.text
.globl sequential_preLN__compressed_kv_cla__moe_arch_mod__prompt_kernel
.p2align 8
.type sequential_preLN__compressed_kv_cla__moe_arch_mod__prompt_kernel,@function
sequential_preLN__compressed_kv_cla__moe_arch_mod__prompt_kernel:
    s_cmp_ge_u32 s2, 256
    s_cbranch_scc1 ka_done
    s_load_dwordx8 s[64:71], s[0:1], 0
    s_load_dwordx4 s[72:75], s[0:1], 32
    s_load_dwordx4 s[76:79], s[0:1], 64
    s_load_dwordx8 s[8:15], s[0:1], 80
    v_lshrrev_b32 v1, 6, v0
    v_and_b32 v2, 63, v0
    v_readfirstlane_b32 s3, v1
    v_mov_b32_e64 v253, v0
    s_and_b32 s4, s2, 7
    s_lshl_b32 s4, s4, 2
    s_lshr_b32 s24, s2, 3
    s_and_b32 s24, s24, 3
    s_add_u32 s4, s4, s24
    s_lshr_b32 s5, s2, 5
    s_lshl2_add_u32 s6, s5, s3
    s_getpc_b64 s[56:57]
ka_pc:
    s_mov_b32 s58, code_end-ka_pc
    s_mov_b32 s59, 0x00020000
    s_lshr_b32 s24, s2, 3
    s_xor_b32 s24, s24, 31
    s_lshl2_add_u32 s24, s24, s3
    s_lshl_b32 s24, s24, 13
    v_lshlrev_b32_e64 v3, 7, v2
    buffer_load_dword v252, v3, s[56:59], s24 offen
    v_mov_b32 v192, v2
    v_lshrrev_b32 v198, 3, v192
    v_and_b32 v199, 7, v192
    s_lshr_b32 s24, s3, 1
    s_lshl_b32 s24, s24, 5
    s_and_b32 s25, s3, 1
    s_lshl_b32 s26, s25, 3
    s_add_u32 s24, s24, s26
    v_add_u32 v194, s24, v198
    v_lshlrev_b32 v194, 10, v194
    v_lshrrev_b32 v195, 1, v198
    v_xor_b32 v195, v199, v195
    v_lshl_add_u32 v232, v195, 4, v194
    v_xor_b32_e64 v195, 4, v195
    v_lshl_add_u32 v233, v195, 4, v194
    v_add_u32 v233, 15360, v233
    s_lshl_b32 s24, s4, 8
    s_lshl_b32 s26, s25, 7
    s_add_u32 s24, s24, s26
    v_lshlrev_b32 v194, 13, v198
    v_add_u32_e64 v194, s24, v194
    v_bfe_u32 v195, v198, 1, 1
    v_xor_b32_e64 v195, v199, v195
    v_lshl_add_u32 v234, v195, 4, v194
    v_xor_b32_e64 v195, 4, v195
    v_lshl_add_u32 v235, v195, 4, v194
    v_add_u32 v235, 64512, v235
    s_lshl_b32 s34, s3, 11
    s_mul_i32 s35, s3, 24576
    s_add_u32 s35, s35, 65536
    s_lshl_b32 s32, s5, 18
    s_and_b32 s7, s4, 3
    s_lshl1_add_u32 s7, s7, s5
    s_add_u32 s80, s7, 0
    s_and_b32 s80, s80, 7
    s_lshl_b32 s80, s80, 7
    s_add_u32 s80, s80, s32
    s_add_u32 s81, s7, 1
    s_and_b32 s81, s81, 7
    s_lshl_b32 s81, s81, 7
    s_add_u32 s81, s81, s32
    s_add_u32 s82, s7, 2
    s_and_b32 s82, s82, 7
    s_lshl_b32 s82, s82, 7
    s_add_u32 s82, s82, s32
    s_add_u32 s83, s7, 3
    s_and_b32 s83, s83, 7
    s_lshl_b32 s83, s83, 7
    s_add_u32 s83, s83, s32
    s_add_u32 s84, s7, 4
    s_and_b32 s84, s84, 7
    s_lshl_b32 s84, s84, 7
    s_add_u32 s84, s84, s32
    s_add_u32 s85, s7, 5
    s_and_b32 s85, s85, 7
    s_lshl_b32 s85, s85, 7
    s_add_u32 s85, s85, s32
    s_add_u32 s86, s7, 6
    s_and_b32 s86, s86, 7
    s_lshl_b32 s86, s86, 7
    s_add_u32 s86, s86, s32
    s_add_u32 s87, s7, 7
    s_and_b32 s87, s87, 7
    s_lshl_b32 s87, s87, 7
    s_add_u32 s87, s87, s32
    s_waitcnt lgkmcnt(0)
    s_cmp_lt_u32 s3, 2
    s_cselect_b32 s48, s70, s72
    s_cselect_b32 s49, s71, s73
    s_mov_b32 s50, 0x400000
    s_mov_b32 s51, 0x00020000
    s_mov_b32 s44, s66
    s_mov_b32 s45, s67
    s_mov_b32 s46, 0x200000
    s_mov_b32 s47, 0x00020000
    s_add_u32 m0, s35, 0
    s_and_b32 s33, s80, 1023
    s_lshl_b32 s33, s33, 12
    buffer_load_dwordx4 v234, s[48:51], s33 offen lds
    buffer_load_dwordx4 v235, s[48:51], s33 offen offset:1024 lds
    s_add_u32 m0, s35, 2048
    s_add_u32 s33, s33, 131072
    buffer_load_dwordx4 v234, s[48:51], s33 offen lds
    buffer_load_dwordx4 v235, s[48:51], s33 offen offset:1024 lds
    s_add_u32 m0, s34, 0
    s_add_u32 s37, s80, 0
    buffer_load_dwordx4 v232, s[44:47], s37 offen lds
    buffer_load_dwordx4 v233, s[44:47], s37 offen offset:1024 lds
    s_add_u32 m0, s34, 8192
    s_add_u32 s37, s80, 65536
    buffer_load_dwordx4 v232, s[44:47], s37 offen lds
    buffer_load_dwordx4 v233, s[44:47], s37 offen offset:1024 lds
    s_add_u32 m0, s35, 4096
    s_add_u32 s33, s33, 131072
    buffer_load_dwordx4 v234, s[48:51], s33 offen lds
    buffer_load_dwordx4 v235, s[48:51], s33 offen offset:1024 lds
    s_add_u32 m0, s35, 6144
    s_add_u32 s33, s33, 131072
    buffer_load_dwordx4 v234, s[48:51], s33 offen lds
    buffer_load_dwordx4 v235, s[48:51], s33 offen offset:1024 lds
    s_mov_b32 s52, s64
    s_mov_b32 s53, s65
    s_mov_b32 s54, 0x400000
    s_mov_b32 s55, 0x00020000
    s_add_u32 s16, s14, 0x5c00000
    s_addc_u32 s17, s15, 0
    s_mov_b32 s18, 0x2140000
    s_mov_b32 s19, 0x00020000
    s_add_u32 s56, s14, 0x3800000
    s_addc_u32 s57, s15, 0
    s_mov_b32 s58, 0x6040
    s_mov_b32 s59, 0x00020000
    s_add_u32 s20, s14, 0x2400000
    s_addc_u32 s21, s15, 0
    s_mov_b32 s22, 0x1000000
    s_mov_b32 s23, 0x00020000
    s_mov_b32 s88, s12
    s_mov_b32 s89, s13
    s_mov_b32 s90, 0x100
    s_mov_b32 s91, 0x00020000
    s_cmp_lt_u32 s3, 2
    s_cselect_b32 s60, s8, s74
    s_cselect_b32 s61, s9, s75
    s_mov_b32 s62, 0x800000
    s_cselect_b32 s62, 0x700000, s62
    s_mov_b32 s63, 0x00020000
    s_cselect_b32 s41, s76, s78
    s_cselect_b32 s42, s77, s79
    s_mov_b32 s8, s14
    s_mov_b32 s9, s15
    s_mov_b32 s10, 0x400000
    s_mov_b32 s11, 0x00020000
    s_mov_b32 s12, s68
    s_mov_b32 s13, s69
    s_mov_b32 s14, 0x800000
    s_mov_b32 s15, 0x00020000
    s_cmp_eq_u32 s2, 200
    s_mov_b32 s97, 0x40000000
    s_cselect_b32 s97, 0xa0000, s97
    s_mov_b32 s58, 0xa5000
    v_lshlrev_b32 v194, 7, v253
    v_mov_b32_e64 v195, 0
    buffer_store_dword v195, v194, s[56:59], s97 offen sc1
    s_cselect_b32 s97, 0, 0x40000000
    s_mov_b32 s58, 0x6040
    s_add_u32 m0, s35, 8192
    s_and_b32 s33, s81, 1023
    s_lshl_b32 s33, s33, 12
    buffer_load_dwordx4 v234, s[48:51], s33 offen lds
    buffer_load_dwordx4 v235, s[48:51], s33 offen offset:1024 lds
    s_add_u32 m0, s35, 10240
    s_add_u32 s33, s33, 131072
    buffer_load_dwordx4 v234, s[48:51], s33 offen lds
    buffer_load_dwordx4 v235, s[48:51], s33 offen offset:1024 lds
    s_add_u32 m0, s35, 12288
    s_add_u32 s33, s33, 131072
    buffer_load_dwordx4 v234, s[48:51], s33 offen lds
    buffer_load_dwordx4 v235, s[48:51], s33 offen offset:1024 lds
    s_add_u32 m0, s35, 14336
    s_add_u32 s33, s33, 131072
    buffer_load_dwordx4 v234, s[48:51], s33 offen lds
    buffer_load_dwordx4 v235, s[48:51], s33 offen offset:1024 lds
    s_add_u32 m0, s34, 16384
    s_add_u32 s37, s81, 0
    buffer_load_dwordx4 v232, s[44:47], s37 offen lds
    buffer_load_dwordx4 v233, s[44:47], s37 offen offset:1024 lds
    s_add_u32 m0, s34, 24576
    s_add_u32 s37, s81, 65536
    buffer_load_dwordx4 v232, s[44:47], s37 offen lds
    buffer_load_dwordx4 v233, s[44:47], s37 offen offset:1024 lds
    v_and_b32 v200, 15, v192
    v_lshrrev_b32 v201, 4, v192
    v_lshrrev_b32 v194, 1, v200
    v_xor_b32 v194, v201, v194
    v_lshlrev_b32 v194, 4, v194
    v_lshl_add_u32 v224, v200, 7, v194
    v_xor_b32 v225, 64, v224
    v_lshrrev_b32 v194, 2, v200
    v_lshl_add_u32 v195, v201, 3, v194
    v_lshlrev_b32 v195, 7, v195
    v_add_u32 v195, s35, v195
    v_and_b32_e64 v196, 1, v200
    v_lshl_add_u32 v195, v196, 3, v195
    v_lshrrev_b32 v194, 1, v194
    v_and_b32 v196, 1, v201
    v_lshl_or_b32 v194, v196, 2, v194
    v_and_b32 v196, 2, v200
    v_xor_b32 v194, v194, v196
    v_xor_b32_e64 v196, 0, v194
    v_lshl_add_u32 v228, v196, 4, v195
    v_xor_b32_e64 v196, 1, v194
    v_lshl_add_u32 v229, v196, 4, v195
    v_xor_b32_e64 v196, 4, v194
    v_lshl_add_u32 v230, v196, 4, v195
    v_xor_b32_e64 v196, 5, v194
    v_lshl_add_u32 v231, v196, 4, v195
    s_mul_i32 s36, s4, 1089536
    s_mul_i32 s24, s5, 136192
    s_add_u32 s36, s36, s24
    s_and_b32 s24, s3, 1
    s_lshl_b32 s24, s24, 12
    s_and_b32 s26, s3, 2
    s_lshl_b32 s26, s26, 13
    s_add_u32 s36, s36, s24
    s_add_u32 s36, s36, s26
    s_lshl_b32 s24, s5, 7
    s_sub_u32 s26, 1792, s24
    s_cmp_lt_u32 s4, 16
    s_cselect_b32 s24, s24, s26
    s_lshl_b32 s26, s4, 3
    s_add_u32 s24, s24, s26
    v_lshrrev_b32 v194, 5, v253
    v_add_u32 v196, s24, v194
    v_and_b32 v195, 31, v192
    v_lshlrev_b32 v196, 11, v196
    v_lshl_add_u32 v236, v195, 4, v196
    v_xor_b32 v194, v194, v199
    v_lshlrev_b32 v194, 4, v194
    v_lshl_add_u32 v194, v195, 7, v194
    v_add_u32 v237, 81920, v194
    s_lshr_b32 s26, s24, 4
    s_lshl_b32 s26, s26, 15
    s_and_b32 s24, s24, 15
    s_lshl_b32 s24, s24, 4
    s_add_u32 s24, s24, s26
    v_lshrrev_b32 v194, 3, v253
    v_lshlrev_b32 v194, 8, v194
    v_xor_b32 v195, v199, v198
    v_lshl_add_u32 v194, v195, 4, v194
    v_add_u32 v238, s24, v194
    v_lshlrev_b32 v240, 4, v192
    s_lshl_b32 s24, s3, 12
    v_add_u32 v242, s24, v240
    s_lshl_b32 s24, s6, 16
    v_add_u32 v248, s24, v240
    s_sub_u32 s25, 63, s6
    s_lshl_b32 s24, s25, 16
    v_add_u32_e64 v249, s24, v240
    v_bfe_u32 v194, v192, 2, 2
    v_lshlrev_b32_e64 v194, 13, v194
    v_lshl_add_u32 v194, v201, 6, v194
    v_and_b32_e64 v195, 3, v192
    v_lshl_add_u32 v194, v195, 4, v194
    s_lshl_b32 s24, s4, 8
    s_lshl_b32 s25, s3, 18
    s_add_u32 s24, s24, s25
    v_add_u32_e64 v245, s24, v194
    s_lshl_b32 s31, s3, 13
    s_add_u32 s31, s31, 65536
    s_lshl_b32 s27, s5, 20
    s_mov_b32 s7, s27
    s_mov_b32 s43, 0x40000000
    s_lshr_b32 s28, s27, 8
    s_add_u32 s29, s28, 32768
    s_nop 0
    v_lshlrev_b32 v194, 11, v201
    v_bfe_u32 v195, v192, 2, 2
    v_lshl_add_u32 v194, v195, 6, v194
    v_bfe_u32 v195, v192, 4, 1
    v_lshl_add_u32 v194, v195, 4, v194
    v_and_b32_e64 v195, 1, v192
    v_lshl_add_u32 v194, v195, 3, v194
    v_bfe_u32 v195, v192, 1, 1
    v_lshl_add_u32 v247, v195, 5, v194
    s_mov_b32 s30, 65536
    v_add_u32 v246, s30, v247
    v_lshrrev_b32 v195, 5, v192
    v_lshlrev_b32 v195, 4, v195
    v_sub_u32 v194, v200, v195
    v_bfe_u32 v195, v192, 4, 1
    v_lshlrev_b32 v195, 2, v195
    v_sub_u32 v194, v194, v195
    v_cvt_f32_i32 v194, v194
    v_add_f32 v194, 0.5, v194
    v_mul_f32 v243, 0x71800000, v194
    v_add_u32 v244, 0x20000, v240
    v_lshlrev_b32 v251, 7, v192
    v_cmp_gt_u32 vcc, 16, v192
    v_mov_b32 v194, 0x40000000
    v_mov_b32 v255, 1
    v_cndmask_b32 v251, v194, v251, vcc
    v_cmp_eq_u32 vcc, 0, v253
    s_nop 1
    v_cndmask_b32 v250, v194, v253, vcc
    s_waitcnt vmcnt(19)
    s_barrier
    ds_read_b128 v[64:67], v224 offset:0
    ds_read_b128 v[68:71], v224 offset:2048
    ds_read_b128 v[72:75], v224 offset:4096
    ds_read_b128 v[76:79], v224 offset:6144
    ds_read_b64_tr_b16 a[0:1], v228 offset:0
    ds_read_b64_tr_b16 a[2:3], v228 offset:512
    ds_read_b64_tr_b16 a[4:5], v229 offset:0
    ds_read_b64_tr_b16 a[6:7], v229 offset:512
    ds_read_b64_tr_b16 a[8:9], v230 offset:0
    ds_read_b64_tr_b16 a[10:11], v230 offset:512
    ds_read_b64_tr_b16 a[12:13], v231 offset:0
    ds_read_b64_tr_b16 a[14:15], v231 offset:512
    s_waitcnt vmcnt(12)
    s_barrier
    buffer_store_dword v255, v250, s[88:91], s97 offen sc1
    s_cmp_eq_u32 s3, 0
    s_cselect_b32 s97, 0, s43
    s_cmp_lt_u32 s3, 2
    s_cbranch_scc0 ka_V
    s_waitcnt lgkmcnt(0)
    v_mfma_f32_16x16x32_bf16 v[96:99], a[0:3], v[64:67], 0
    ds_read_b128 v[80:83], v224 offset:8192
    v_mfma_f32_16x16x32_bf16 v[100:103], a[4:7], v[64:67], 0
    ds_read_b128 v[84:87], v224 offset:10240
    v_mfma_f32_16x16x32_bf16 v[104:107], a[8:11], v[64:67], 0
    ds_read_b128 v[88:91], v224 offset:12288
    v_mfma_f32_16x16x32_bf16 v[108:111], a[12:15], v[64:67], 0
    ds_read_b128 v[92:95], v224 offset:14336
    v_mfma_f32_16x16x32_bf16 v[112:115], a[0:3], v[68:71], 0
    ds_read_b64_tr_b16 a[16:17], v228 offset:4096
    v_mfma_f32_16x16x32_bf16 v[116:119], a[4:7], v[68:71], 0
    ds_read_b64_tr_b16 a[18:19], v228 offset:4608
    v_mfma_f32_16x16x32_bf16 v[120:123], a[8:11], v[68:71], 0
    ds_read_b64_tr_b16 a[20:21], v229 offset:4096
    v_mfma_f32_16x16x32_bf16 v[124:127], a[12:15], v[68:71], 0
    ds_read_b64_tr_b16 a[22:23], v229 offset:4608
    v_mfma_f32_16x16x32_bf16 v[128:131], a[0:3], v[72:75], 0
    s_add_u32 m0, s35, 16384
    s_and_b32 s33, s82, 1023
    s_lshl_b32 s33, s33, 12
    buffer_load_dwordx4 v234, s[48:51], s33 offen lds
    v_mfma_f32_16x16x32_bf16 v[132:135], a[4:7], v[72:75], 0
    v_mfma_f32_16x16x32_bf16 v[136:139], a[8:11], v[72:75], 0
    buffer_load_dwordx4 v235, s[48:51], s33 offen offset:1024 lds
    v_mfma_f32_16x16x32_bf16 v[140:143], a[12:15], v[72:75], 0
    v_mfma_f32_16x16x32_bf16 v[144:147], a[0:3], v[76:79], 0
    s_add_u32 m0, s35, 18432
    s_add_u32 s33, s33, 131072
    buffer_load_dwordx4 v234, s[48:51], s33 offen lds
    v_mfma_f32_16x16x32_bf16 v[148:151], a[4:7], v[76:79], 0
    v_mfma_f32_16x16x32_bf16 v[152:155], a[8:11], v[76:79], 0
    buffer_load_dwordx4 v235, s[48:51], s33 offen offset:1024 lds
    v_mfma_f32_16x16x32_bf16 v[156:159], a[12:15], v[76:79], 0
    s_waitcnt lgkmcnt(0)
    v_mfma_f32_16x16x32_bf16 v[160:163], a[0:3], v[80:83], 0
    ds_read_b128 v[64:67], v225 offset:0
    v_mfma_f32_16x16x32_bf16 v[164:167], a[4:7], v[80:83], 0
    ds_read_b128 v[68:71], v225 offset:2048
    v_mfma_f32_16x16x32_bf16 v[168:171], a[8:11], v[80:83], 0
    ds_read_b128 v[72:75], v225 offset:4096
    v_mfma_f32_16x16x32_bf16 v[172:175], a[12:15], v[80:83], 0
    ds_read_b128 v[76:79], v225 offset:6144
    v_mfma_f32_16x16x32_bf16 v[176:179], a[0:3], v[84:87], 0
    ds_read_b64_tr_b16 a[24:25], v230 offset:4096
    v_mfma_f32_16x16x32_bf16 v[180:183], a[4:7], v[84:87], 0
    ds_read_b64_tr_b16 a[26:27], v230 offset:4608
    v_mfma_f32_16x16x32_bf16 v[184:187], a[8:11], v[84:87], 0
    ds_read_b64_tr_b16 a[28:29], v231 offset:4096
    v_mfma_f32_16x16x32_bf16 v[188:191], a[12:15], v[84:87], 0
    ds_read_b64_tr_b16 a[30:31], v231 offset:4608
    v_mfma_f32_16x16x32_bf16 v[192:195], a[0:3], v[88:91], 0
    s_add_u32 m0, s35, 20480
    s_add_u32 s33, s33, 131072
    buffer_load_dwordx4 v234, s[48:51], s33 offen lds
    v_mfma_f32_16x16x32_bf16 v[196:199], a[4:7], v[88:91], 0
    v_mfma_f32_16x16x32_bf16 v[200:203], a[8:11], v[88:91], 0
    buffer_load_dwordx4 v235, s[48:51], s33 offen offset:1024 lds
    v_mfma_f32_16x16x32_bf16 v[204:207], a[12:15], v[88:91], 0
    v_mfma_f32_16x16x32_bf16 v[208:211], a[0:3], v[92:95], 0
    s_add_u32 m0, s35, 22528
    s_add_u32 s33, s33, 131072
    buffer_load_dwordx4 v234, s[48:51], s33 offen lds
    v_mfma_f32_16x16x32_bf16 v[212:215], a[4:7], v[92:95], 0
    v_mfma_f32_16x16x32_bf16 v[216:219], a[8:11], v[92:95], 0
    buffer_load_dwordx4 v235, s[48:51], s33 offen offset:1024 lds
    v_mfma_f32_16x16x32_bf16 v[220:223], a[12:15], v[92:95], 0
    s_waitcnt vmcnt(13) lgkmcnt(0)
    v_mfma_f32_16x16x32_bf16 v[96:99], a[16:19], v[64:67], v[96:99]
    ds_read_b128 v[80:83], v225 offset:8192
    v_mfma_f32_16x16x32_bf16 v[100:103], a[20:23], v[64:67], v[100:103]
    ds_read_b128 v[84:87], v225 offset:10240
    v_mfma_f32_16x16x32_bf16 v[104:107], a[24:27], v[64:67], v[104:107]
    ds_read_b128 v[88:91], v225 offset:12288
    v_mfma_f32_16x16x32_bf16 v[108:111], a[28:31], v[64:67], v[108:111]
    ds_read_b128 v[92:95], v225 offset:14336
    v_mfma_f32_16x16x32_bf16 v[112:115], a[16:19], v[68:71], v[112:115]
    ds_read_b64_tr_b16 a[32:33], v228 offset:8192
    v_mfma_f32_16x16x32_bf16 v[116:119], a[20:23], v[68:71], v[116:119]
    ds_read_b64_tr_b16 a[34:35], v228 offset:8704
    v_mfma_f32_16x16x32_bf16 v[120:123], a[24:27], v[68:71], v[120:123]
    ds_read_b64_tr_b16 a[36:37], v229 offset:8192
    v_mfma_f32_16x16x32_bf16 v[124:127], a[28:31], v[68:71], v[124:127]
    ds_read_b64_tr_b16 a[38:39], v229 offset:8704
    v_mfma_f32_16x16x32_bf16 v[128:131], a[16:19], v[72:75], v[128:131]
    ds_read_b64_tr_b16 a[40:41], v230 offset:8192
    s_add_u32 m0, s34, 32768
    s_add_u32 s37, s82, 0
    buffer_load_dwordx4 v232, s[44:47], s37 offen lds
    v_mfma_f32_16x16x32_bf16 v[132:135], a[20:23], v[72:75], v[132:135]
    ds_read_b64_tr_b16 a[42:43], v230 offset:8704
    buffer_load_dwordx4 v233, s[44:47], s37 offen offset:1024 lds
    v_mfma_f32_16x16x32_bf16 v[136:139], a[24:27], v[72:75], v[136:139]
    ds_read_b64_tr_b16 a[44:45], v231 offset:8192
    s_add_u32 m0, s34, 40960
    s_add_u32 s37, s82, 65536
    buffer_load_dwordx4 v232, s[44:47], s37 offen lds
    v_mfma_f32_16x16x32_bf16 v[140:143], a[28:31], v[72:75], v[140:143]
    ds_read_b64_tr_b16 a[46:47], v231 offset:8704
    buffer_load_dwordx4 v233, s[44:47], s37 offen offset:1024 lds
    v_mfma_f32_16x16x32_bf16 v[144:147], a[16:19], v[76:79], v[144:147]
    s_add_u32 m0, s35, 0
    s_and_b32 s33, s83, 1023
    s_lshl_b32 s33, s33, 12
    buffer_load_dwordx4 v234, s[48:51], s33 offen lds
    v_mfma_f32_16x16x32_bf16 v[148:151], a[20:23], v[76:79], v[148:151]
    buffer_load_dwordx4 v235, s[48:51], s33 offen offset:1024 lds
    v_mfma_f32_16x16x32_bf16 v[152:155], a[24:27], v[76:79], v[152:155]
    s_add_u32 m0, s35, 2048
    s_add_u32 s33, s33, 131072
    buffer_load_dwordx4 v234, s[48:51], s33 offen lds
    v_mfma_f32_16x16x32_bf16 v[156:159], a[28:31], v[76:79], v[156:159]
    buffer_load_dwordx4 v235, s[48:51], s33 offen offset:1024 lds
    s_waitcnt vmcnt(17) lgkmcnt(0)
    s_barrier
    v_mfma_f32_16x16x32_bf16 v[160:163], a[16:19], v[80:83], v[160:163]
    ds_read_b128 v[64:67], v224 offset:16384
    v_mfma_f32_16x16x32_bf16 v[164:167], a[20:23], v[80:83], v[164:167]
    ds_read_b128 v[68:71], v225 offset:16384
    v_mfma_f32_16x16x32_bf16 v[168:171], a[24:27], v[80:83], v[168:171]
    ds_read_b128 v[72:75], v224 offset:18432
    v_mfma_f32_16x16x32_bf16 v[172:175], a[28:31], v[80:83], v[172:175]
    ds_read_b128 v[76:79], v225 offset:18432
    v_mfma_f32_16x16x32_bf16 v[176:179], a[16:19], v[84:87], v[176:179]
    ds_read_b64_tr_b16 a[48:49], v228 offset:12288
    s_add_u32 m0, s34, 49152
    s_add_u32 s37, s83, 0
    buffer_load_dwordx4 v232, s[44:47], s37 offen lds
    v_mfma_f32_16x16x32_bf16 v[180:183], a[20:23], v[84:87], v[180:183]
    ds_read_b64_tr_b16 a[50:51], v228 offset:12800
    buffer_load_dwordx4 v233, s[44:47], s37 offen offset:1024 lds
    v_mfma_f32_16x16x32_bf16 v[184:187], a[24:27], v[84:87], v[184:187]
    ds_read_b64_tr_b16 a[52:53], v229 offset:12288
    s_add_u32 m0, s34, 57344
    s_add_u32 s37, s83, 65536
    buffer_load_dwordx4 v232, s[44:47], s37 offen lds
    v_mfma_f32_16x16x32_bf16 v[188:191], a[28:31], v[84:87], v[188:191]
    ds_read_b64_tr_b16 a[54:55], v229 offset:12800
    buffer_load_dwordx4 v233, s[44:47], s37 offen offset:1024 lds
    v_mfma_f32_16x16x32_bf16 v[192:195], a[16:19], v[88:91], v[192:195]
    ds_read_b64_tr_b16 a[56:57], v230 offset:12288
    s_add_u32 m0, s34, 0
    s_add_u32 s37, s84, 0
    buffer_load_dwordx4 v232, s[44:47], s37 offen lds
    v_mfma_f32_16x16x32_bf16 v[196:199], a[20:23], v[88:91], v[196:199]
    ds_read_b64_tr_b16 a[58:59], v230 offset:12800
    v_mfma_f32_16x16x32_bf16 v[200:203], a[24:27], v[88:91], v[200:203]
    ds_read_b64_tr_b16 a[60:61], v231 offset:12288
    buffer_load_dwordx4 v233, s[44:47], s37 offen offset:1024 lds
    v_mfma_f32_16x16x32_bf16 v[204:207], a[28:31], v[88:91], v[204:207]
    ds_read_b64_tr_b16 a[62:63], v231 offset:12800
    buffer_load_dwordx4 v[0:3], v236, s[52:55], 0 offen offset:0
    v_mfma_f32_16x16x32_bf16 v[208:211], a[16:19], v[92:95], v[208:211]
    buffer_load_dwordx4 v[4:7], v236, s[52:55], 0 offen offset:512
    v_mfma_f32_16x16x32_bf16 v[212:215], a[20:23], v[92:95], v[212:215]
    buffer_load_dwordx4 v[8:11], v236, s[52:55], 0 offen offset:1024
    v_mfma_f32_16x16x32_bf16 v[216:219], a[24:27], v[92:95], v[216:219]
    buffer_load_dwordx4 v[12:15], v236, s[52:55], 0 offen offset:1536
    v_mfma_f32_16x16x32_bf16 v[220:223], a[28:31], v[92:95], v[220:223]
    s_waitcnt lgkmcnt(0)
    v_mfma_f32_16x16x32_bf16 v[96:99], a[32:35], v[64:67], v[96:99]
    ds_read_b128 v[80:83], v224 offset:20480
    v_mfma_f32_16x16x32_bf16 v[96:99], a[48:51], v[68:71], v[96:99]
    ds_read_b128 v[84:87], v225 offset:20480
    v_mfma_f32_16x16x32_bf16 v[100:103], a[36:39], v[64:67], v[100:103]
    ds_read_b128 v[88:91], v224 offset:22528
    v_mfma_f32_16x16x32_bf16 v[100:103], a[52:55], v[68:71], v[100:103]
    ds_read_b128 v[92:95], v225 offset:22528
    v_mfma_f32_16x16x32_bf16 v[104:107], a[40:43], v[64:67], v[104:107]
    v_mfma_f32_16x16x32_bf16 v[104:107], a[56:59], v[68:71], v[104:107]
    v_mfma_f32_16x16x32_bf16 v[108:111], a[44:47], v[64:67], v[108:111]
    v_mfma_f32_16x16x32_bf16 v[108:111], a[60:63], v[68:71], v[108:111]
    v_mfma_f32_16x16x32_bf16 v[112:115], a[32:35], v[72:75], v[112:115]
    s_add_u32 m0, s35, 4096
    s_add_u32 s33, s33, 131072
    buffer_load_dwordx4 v234, s[48:51], s33 offen lds
    v_mfma_f32_16x16x32_bf16 v[112:115], a[48:51], v[76:79], v[112:115]
    v_mfma_f32_16x16x32_bf16 v[116:119], a[36:39], v[72:75], v[116:119]
    buffer_load_dwordx4 v235, s[48:51], s33 offen offset:1024 lds
    v_mfma_f32_16x16x32_bf16 v[116:119], a[52:55], v[76:79], v[116:119]
    v_mfma_f32_16x16x32_bf16 v[120:123], a[40:43], v[72:75], v[120:123]
    s_add_u32 m0, s35, 6144
    s_add_u32 s33, s33, 131072
    buffer_load_dwordx4 v234, s[48:51], s33 offen lds
    v_mfma_f32_16x16x32_bf16 v[120:123], a[56:59], v[76:79], v[120:123]
    v_mfma_f32_16x16x32_bf16 v[124:127], a[44:47], v[72:75], v[124:127]
    buffer_load_dwordx4 v235, s[48:51], s33 offen offset:1024 lds
    v_mfma_f32_16x16x32_bf16 v[124:127], a[60:63], v[76:79], v[124:127]
    s_waitcnt lgkmcnt(0)
    v_mfma_f32_16x16x32_bf16 v[128:131], a[32:35], v[80:83], v[128:131]
    ds_read_b128 v[64:67], v224 offset:24576
    v_mfma_f32_16x16x32_bf16 v[128:131], a[48:51], v[84:87], v[128:131]
    ds_read_b128 v[68:71], v225 offset:24576
    v_mfma_f32_16x16x32_bf16 v[132:135], a[36:39], v[80:83], v[132:135]
    ds_read_b128 v[72:75], v224 offset:26624
    v_mfma_f32_16x16x32_bf16 v[132:135], a[52:55], v[84:87], v[132:135]
    ds_read_b128 v[76:79], v225 offset:26624
    v_mfma_f32_16x16x32_bf16 v[136:139], a[40:43], v[80:83], v[136:139]
    v_mfma_f32_16x16x32_bf16 v[136:139], a[56:59], v[84:87], v[136:139]
    v_mfma_f32_16x16x32_bf16 v[140:143], a[44:47], v[80:83], v[140:143]
    v_mfma_f32_16x16x32_bf16 v[140:143], a[60:63], v[84:87], v[140:143]
    v_mfma_f32_16x16x32_bf16 v[144:147], a[32:35], v[88:91], v[144:147]
    s_add_u32 m0, s34, 8192
    s_add_u32 s37, s84, 65536
    buffer_load_dwordx4 v232, s[44:47], s37 offen lds
    v_mfma_f32_16x16x32_bf16 v[144:147], a[48:51], v[92:95], v[144:147]
    v_mfma_f32_16x16x32_bf16 v[148:151], a[36:39], v[88:91], v[148:151]
    v_mfma_f32_16x16x32_bf16 v[148:151], a[52:55], v[92:95], v[148:151]
    v_mfma_f32_16x16x32_bf16 v[152:155], a[40:43], v[88:91], v[152:155]
    buffer_load_dwordx4 v233, s[44:47], s37 offen offset:1024 lds
    v_mfma_f32_16x16x32_bf16 v[152:155], a[56:59], v[92:95], v[152:155]
    v_mfma_f32_16x16x32_bf16 v[156:159], a[44:47], v[88:91], v[156:159]
    v_mfma_f32_16x16x32_bf16 v[156:159], a[60:63], v[92:95], v[156:159]
    s_waitcnt vmcnt(24) lgkmcnt(0)
    v_mfma_f32_16x16x32_bf16 v[160:163], a[32:35], v[64:67], v[160:163]
    ds_read_b128 v[80:83], v224 offset:28672
    v_mfma_f32_16x16x32_bf16 v[160:163], a[48:51], v[68:71], v[160:163]
    ds_read_b128 v[84:87], v225 offset:28672
    v_mfma_f32_16x16x32_bf16 v[164:167], a[36:39], v[64:67], v[164:167]
    ds_read_b128 v[88:91], v224 offset:30720
    v_mfma_f32_16x16x32_bf16 v[164:167], a[52:55], v[68:71], v[164:167]
    ds_read_b128 v[92:95], v225 offset:30720
    v_mfma_f32_16x16x32_bf16 v[168:171], a[40:43], v[64:67], v[168:171]
    ds_read_b64_tr_b16 a[64:65], v228 offset:16384
    v_mfma_f32_16x16x32_bf16 v[168:171], a[56:59], v[68:71], v[168:171]
    ds_read_b64_tr_b16 a[66:67], v228 offset:16896
    v_mfma_f32_16x16x32_bf16 v[172:175], a[44:47], v[64:67], v[172:175]
    ds_read_b64_tr_b16 a[68:69], v229 offset:16384
    v_mfma_f32_16x16x32_bf16 v[172:175], a[60:63], v[68:71], v[172:175]
    ds_read_b64_tr_b16 a[70:71], v229 offset:16896
    v_mfma_f32_16x16x32_bf16 v[176:179], a[32:35], v[72:75], v[176:179]
    ds_read_b64_tr_b16 a[72:73], v230 offset:16384
    s_add_u32 m0, s35, 8192
    s_and_b32 s33, s84, 1023
    s_lshl_b32 s33, s33, 12
    buffer_load_dwordx4 v234, s[48:51], s33 offen lds
    v_mfma_f32_16x16x32_bf16 v[176:179], a[48:51], v[76:79], v[176:179]
    ds_read_b64_tr_b16 a[74:75], v230 offset:16896
    v_mfma_f32_16x16x32_bf16 v[180:183], a[36:39], v[72:75], v[180:183]
    ds_read_b64_tr_b16 a[76:77], v231 offset:16384
    buffer_load_dwordx4 v235, s[48:51], s33 offen offset:1024 lds
    v_mfma_f32_16x16x32_bf16 v[180:183], a[52:55], v[76:79], v[180:183]
    ds_read_b64_tr_b16 a[78:79], v231 offset:16896
    v_mfma_f32_16x16x32_bf16 v[184:187], a[40:43], v[72:75], v[184:187]
    s_add_u32 m0, s35, 10240
    s_add_u32 s33, s33, 131072
    buffer_load_dwordx4 v234, s[48:51], s33 offen lds
    v_mfma_f32_16x16x32_bf16 v[184:187], a[56:59], v[76:79], v[184:187]
    v_mfma_f32_16x16x32_bf16 v[188:191], a[44:47], v[72:75], v[188:191]
    buffer_load_dwordx4 v235, s[48:51], s33 offen offset:1024 lds
    v_mfma_f32_16x16x32_bf16 v[188:191], a[60:63], v[76:79], v[188:191]
    s_waitcnt vmcnt(24) lgkmcnt(0)
    s_barrier
    v_mfma_f32_16x16x32_bf16 v[192:195], a[32:35], v[80:83], v[192:195]
    ds_read_b128 v[64:67], v224 offset:32768
    v_mfma_f32_16x16x32_bf16 v[192:195], a[48:51], v[84:87], v[192:195]
    ds_read_b128 v[68:71], v225 offset:32768
    v_mfma_f32_16x16x32_bf16 v[196:199], a[36:39], v[80:83], v[196:199]
    ds_read_b128 v[72:75], v224 offset:34816
    v_mfma_f32_16x16x32_bf16 v[196:199], a[52:55], v[84:87], v[196:199]
    ds_read_b128 v[76:79], v225 offset:34816
    v_mfma_f32_16x16x32_bf16 v[200:203], a[40:43], v[80:83], v[200:203]
    ds_read_b64_tr_b16 a[80:81], v228 offset:20480
    v_mfma_f32_16x16x32_bf16 v[200:203], a[56:59], v[84:87], v[200:203]
    ds_read_b64_tr_b16 a[82:83], v228 offset:20992
    v_mfma_f32_16x16x32_bf16 v[204:207], a[44:47], v[80:83], v[204:207]
    ds_read_b64_tr_b16 a[84:85], v229 offset:20480
    v_mfma_f32_16x16x32_bf16 v[204:207], a[60:63], v[84:87], v[204:207]
    ds_read_b64_tr_b16 a[86:87], v229 offset:20992
    v_mfma_f32_16x16x32_bf16 v[208:211], a[32:35], v[88:91], v[208:211]
    ds_read_b64_tr_b16 a[88:89], v230 offset:20480
    s_add_u32 m0, s34, 16384
    s_add_u32 s37, s85, 0
    buffer_load_dwordx4 v232, s[44:47], s37 offen lds
    v_mfma_f32_16x16x32_bf16 v[208:211], a[48:51], v[92:95], v[208:211]
    ds_read_b64_tr_b16 a[90:91], v230 offset:20992
    v_mfma_f32_16x16x32_bf16 v[212:215], a[36:39], v[88:91], v[212:215]
    ds_read_b64_tr_b16 a[92:93], v231 offset:20480
    v_mfma_f32_16x16x32_bf16 v[212:215], a[52:55], v[92:95], v[212:215]
    ds_read_b64_tr_b16 a[94:95], v231 offset:20992
    v_mfma_f32_16x16x32_bf16 v[216:219], a[40:43], v[88:91], v[216:219]
    buffer_load_dwordx4 v233, s[44:47], s37 offen offset:1024 lds
    v_mfma_f32_16x16x32_bf16 v[216:219], a[56:59], v[92:95], v[216:219]
    v_mfma_f32_16x16x32_bf16 v[220:223], a[44:47], v[88:91], v[220:223]
    v_mfma_f32_16x16x32_bf16 v[220:223], a[60:63], v[92:95], v[220:223]
    s_waitcnt lgkmcnt(0)
    v_mfma_f32_16x16x32_bf16 v[96:99], a[64:67], v[64:67], v[96:99]
    ds_read_b128 v[80:83], v224 offset:36864
    v_mfma_f32_16x16x32_bf16 v[96:99], a[80:83], v[68:71], v[96:99]
    ds_read_b128 v[84:87], v225 offset:36864
    v_mfma_f32_16x16x32_bf16 v[100:103], a[68:71], v[64:67], v[100:103]
    ds_read_b128 v[88:91], v224 offset:38912
    v_mfma_f32_16x16x32_bf16 v[100:103], a[84:87], v[68:71], v[100:103]
    ds_read_b128 v[92:95], v225 offset:38912
    v_mfma_f32_16x16x32_bf16 v[104:107], a[72:75], v[64:67], v[104:107]
    v_mfma_f32_16x16x32_bf16 v[104:107], a[88:91], v[68:71], v[104:107]
    v_mfma_f32_16x16x32_bf16 v[108:111], a[76:79], v[64:67], v[108:111]
    v_mfma_f32_16x16x32_bf16 v[108:111], a[92:95], v[68:71], v[108:111]
    v_mfma_f32_16x16x32_bf16 v[112:115], a[64:67], v[72:75], v[112:115]
    s_add_u32 m0, s35, 12288
    s_add_u32 s33, s33, 131072
    buffer_load_dwordx4 v234, s[48:51], s33 offen lds
    v_mfma_f32_16x16x32_bf16 v[112:115], a[80:83], v[76:79], v[112:115]
    v_mfma_f32_16x16x32_bf16 v[116:119], a[68:71], v[72:75], v[116:119]
    buffer_load_dwordx4 v235, s[48:51], s33 offen offset:1024 lds
    v_mfma_f32_16x16x32_bf16 v[116:119], a[84:87], v[76:79], v[116:119]
    v_mfma_f32_16x16x32_bf16 v[120:123], a[72:75], v[72:75], v[120:123]
    s_add_u32 m0, s35, 14336
    s_add_u32 s33, s33, 131072
    buffer_load_dwordx4 v234, s[48:51], s33 offen lds
    v_mfma_f32_16x16x32_bf16 v[120:123], a[88:91], v[76:79], v[120:123]
    v_mfma_f32_16x16x32_bf16 v[124:127], a[76:79], v[72:75], v[124:127]
    buffer_load_dwordx4 v235, s[48:51], s33 offen offset:1024 lds
    v_mfma_f32_16x16x32_bf16 v[124:127], a[92:95], v[76:79], v[124:127]
    s_waitcnt lgkmcnt(0)
    v_mfma_f32_16x16x32_bf16 v[128:131], a[64:67], v[80:83], v[128:131]
    ds_read_b128 v[64:67], v224 offset:40960
    v_mfma_f32_16x16x32_bf16 v[128:131], a[80:83], v[84:87], v[128:131]
    ds_read_b128 v[68:71], v225 offset:40960
    v_mfma_f32_16x16x32_bf16 v[132:135], a[68:71], v[80:83], v[132:135]
    ds_read_b128 v[72:75], v224 offset:43008
    v_mfma_f32_16x16x32_bf16 v[132:135], a[84:87], v[84:87], v[132:135]
    ds_read_b128 v[76:79], v225 offset:43008
    v_mfma_f32_16x16x32_bf16 v[136:139], a[72:75], v[80:83], v[136:139]
    v_mfma_f32_16x16x32_bf16 v[136:139], a[88:91], v[84:87], v[136:139]
    v_mfma_f32_16x16x32_bf16 v[140:143], a[76:79], v[80:83], v[140:143]
    v_mfma_f32_16x16x32_bf16 v[140:143], a[92:95], v[84:87], v[140:143]
    v_mfma_f32_16x16x32_bf16 v[144:147], a[64:67], v[88:91], v[144:147]
    s_add_u32 m0, s34, 24576
    s_add_u32 s37, s85, 65536
    buffer_load_dwordx4 v232, s[44:47], s37 offen lds
    v_mfma_f32_16x16x32_bf16 v[144:147], a[80:83], v[92:95], v[144:147]
    v_mfma_f32_16x16x32_bf16 v[148:151], a[68:71], v[88:91], v[148:151]
    v_mfma_f32_16x16x32_bf16 v[148:151], a[84:87], v[92:95], v[148:151]
    v_mfma_f32_16x16x32_bf16 v[152:155], a[72:75], v[88:91], v[152:155]
    buffer_load_dwordx4 v233, s[44:47], s37 offen offset:1024 lds
    v_mfma_f32_16x16x32_bf16 v[152:155], a[88:91], v[92:95], v[152:155]
    v_mfma_f32_16x16x32_bf16 v[156:159], a[76:79], v[88:91], v[156:159]
    v_mfma_f32_16x16x32_bf16 v[156:159], a[92:95], v[92:95], v[156:159]
    s_waitcnt vmcnt(14) lgkmcnt(0)
    v_mfma_f32_16x16x32_bf16 v[160:163], a[64:67], v[64:67], v[160:163]
    ds_read_b128 v[80:83], v224 offset:45056
    s_waitcnt vmcnt(18)
    v_mfma_f32_16x16x32_bf16 v[160:163], a[80:83], v[68:71], v[160:163]
    ds_read_b128 v[84:87], v225 offset:45056
    v_lshlrev_b32 v16, 16, v0
    v_mfma_f32_16x16x32_bf16 v[164:167], a[68:71], v[64:67], v[164:167]
    ds_read_b128 v[88:91], v224 offset:47104
    v_and_b32 v17, 0xffff0000, v0
    v_lshlrev_b32_e64 v18, 16, v1
    v_mfma_f32_16x16x32_bf16 v[164:167], a[84:87], v[68:71], v[164:167]
    ds_read_b128 v[92:95], v225 offset:47104
    v_and_b32 v19, 0xffff0000, v1
    v_mfma_f32_16x16x32_bf16 v[168:171], a[72:75], v[64:67], v[168:171]
    ds_read_b64_tr_b16 a[96:97], v228 offset:0
    v_lshlrev_b32_e64 v20, 16, v2
    v_mfma_f32_16x16x32_bf16 v[168:171], a[88:91], v[68:71], v[168:171]
    ds_read_b64_tr_b16 a[98:99], v228 offset:512
    v_and_b32 v21, 0xffff0000, v2
    v_mfma_f32_16x16x32_bf16 v[172:175], a[76:79], v[64:67], v[172:175]
    ds_read_b64_tr_b16 a[100:101], v229 offset:0
    v_lshlrev_b32_e64 v22, 16, v3
    v_mfma_f32_16x16x32_bf16 v[172:175], a[92:95], v[68:71], v[172:175]
    ds_read_b64_tr_b16 a[102:103], v229 offset:512
    v_and_b32 v23, 0xffff0000, v3
    v_mfma_f32_16x16x32_bf16 v[176:179], a[64:67], v[72:75], v[176:179]
    ds_read_b64_tr_b16 a[104:105], v230 offset:0
    s_add_u32 m0, s35, 16384
    s_and_b32 s33, s85, 1023
    s_lshl_b32 s33, s33, 12
    buffer_load_dwordx4 v234, s[48:51], s33 offen lds
    v_mfma_f32_16x16x32_bf16 v[176:179], a[80:83], v[76:79], v[176:179]
    ds_read_b64_tr_b16 a[106:107], v230 offset:512
    buffer_load_dwordx4 v235, s[48:51], s33 offen offset:1024 lds
    v_mfma_f32_16x16x32_bf16 v[180:183], a[68:71], v[72:75], v[180:183]
    ds_read_b64_tr_b16 a[108:109], v231 offset:0
    s_add_u32 m0, s35, 18432
    s_add_u32 s33, s33, 131072
    buffer_load_dwordx4 v234, s[48:51], s33 offen lds
    v_mfma_f32_16x16x32_bf16 v[180:183], a[84:87], v[76:79], v[180:183]
    ds_read_b64_tr_b16 a[110:111], v231 offset:512
    v_lshlrev_b32 v24, 16, v4
    v_and_b32 v25, 0xffff0000, v4
    v_mfma_f32_16x16x32_bf16 v[184:187], a[72:75], v[72:75], v[184:187]
    buffer_load_dwordx4 v235, s[48:51], s33 offen offset:1024 lds
    v_lshlrev_b32_e64 v26, 16, v5
    v_mfma_f32_16x16x32_bf16 v[184:187], a[88:91], v[76:79], v[184:187]
    s_lshl2_add_u32 s26, s4, s3
    s_lshl_b32 s26, s26, 10
    s_add_u32 s26, s26, s32
    s_add_u32 s26, s26, 131072
    v_mfma_f32_16x16x32_bf16 v[188:191], a[76:79], v[72:75], v[188:191]
    v_and_b32 v226, 0x40000380, v251
    buffer_load_dword v241, v226, s[44:47], s26 offen
    v_mfma_f32_16x16x32_bf16 v[188:191], a[92:95], v[76:79], v[188:191]
    s_waitcnt vmcnt(29) lgkmcnt(0)
    s_barrier
    v_mfma_f32_16x16x32_bf16 v[192:195], a[64:67], v[80:83], v[192:195]
    ds_read_b128 v[64:67], v224 offset:49152
    v_and_b32 v27, 0xffff0000, v5
    v_mfma_f32_16x16x32_bf16 v[192:195], a[80:83], v[84:87], v[192:195]
    ds_read_b128 v[68:71], v225 offset:49152
    v_lshlrev_b32 v28, 16, v6
    v_mfma_f32_16x16x32_bf16 v[196:199], a[68:71], v[80:83], v[196:199]
    ds_read_b128 v[72:75], v224 offset:51200
    v_and_b32 v29, 0xffff0000, v6
    v_mfma_f32_16x16x32_bf16 v[196:199], a[84:87], v[84:87], v[196:199]
    ds_read_b128 v[76:79], v225 offset:51200
    v_lshlrev_b32_e64 v30, 16, v7
    v_and_b32 v31, 0xffff0000, v7
    v_mfma_f32_16x16x32_bf16 v[200:203], a[72:75], v[80:83], v[200:203]
    ds_read_b64_tr_b16 a[112:113], v228 offset:4096
    v_lshlrev_b32_e64 v32, 16, v8
    v_mfma_f32_16x16x32_bf16 v[200:203], a[88:91], v[84:87], v[200:203]
    ds_read_b64_tr_b16 a[114:115], v228 offset:4608
    v_and_b32 v33, 0xffff0000, v8
    v_mfma_f32_16x16x32_bf16 v[204:207], a[76:79], v[80:83], v[204:207]
    ds_read_b64_tr_b16 a[116:117], v229 offset:4096
    v_lshlrev_b32_e64 v34, 16, v9
    v_mfma_f32_16x16x32_bf16 v[204:207], a[92:95], v[84:87], v[204:207]
    ds_read_b64_tr_b16 a[118:119], v229 offset:4608
    v_and_b32 v35, 0xffff0000, v9
    v_mfma_f32_16x16x32_bf16 v[208:211], a[64:67], v[88:91], v[208:211]
    ds_read_b64_tr_b16 a[120:121], v230 offset:4096
    s_add_u32 m0, s34, 32768
    s_add_u32 s37, s86, 0
    buffer_load_dwordx4 v232, s[44:47], s37 offen lds
    v_mfma_f32_16x16x32_bf16 v[208:211], a[80:83], v[92:95], v[208:211]
    ds_read_b64_tr_b16 a[122:123], v230 offset:4608
    v_lshlrev_b32 v36, 16, v10
    v_mfma_f32_16x16x32_bf16 v[212:215], a[68:71], v[88:91], v[212:215]
    ds_read_b64_tr_b16 a[124:125], v231 offset:4096
    v_and_b32 v37, 0xffff0000, v10
    v_lshlrev_b32_e64 v38, 16, v11
    v_mfma_f32_16x16x32_bf16 v[212:215], a[84:87], v[92:95], v[212:215]
    ds_read_b64_tr_b16 a[126:127], v231 offset:4608
    v_and_b32 v39, 0xffff0000, v11
    v_mfma_f32_16x16x32_bf16 v[216:219], a[72:75], v[88:91], v[216:219]
    buffer_load_dwordx4 v233, s[44:47], s37 offen offset:1024 lds
    v_lshlrev_b32_e64 v40, 16, v12
    v_mfma_f32_16x16x32_bf16 v[216:219], a[88:91], v[92:95], v[216:219]
    v_and_b32 v41, 0xffff0000, v12
    v_lshlrev_b32_e64 v42, 16, v13
    v_mfma_f32_16x16x32_bf16 v[220:223], a[76:79], v[88:91], v[220:223]
    v_and_b32 v43, 0xffff0000, v13
    v_lshlrev_b32_e64 v44, 16, v14
    v_and_b32 v45, 0xffff0000, v14
    v_mfma_f32_16x16x32_bf16 v[220:223], a[92:95], v[92:95], v[220:223]
    v_lshlrev_b32 v46, 16, v15
    s_waitcnt lgkmcnt(0)
    v_mfma_f32_16x16x32_bf16 v[96:99], a[96:99], v[64:67], v[96:99]
    ds_read_b128 v[80:83], v224 offset:53248
    v_and_b32 v47, 0xffff0000, v15
    v_mfma_f32_16x16x32_bf16 v[96:99], a[112:115], v[68:71], v[96:99]
    ds_read_b128 v[84:87], v225 offset:53248
    v_add_f32_e64 v52, v16, v20
    v_mfma_f32_16x16x32_bf16 v[100:103], a[100:103], v[64:67], v[100:103]
    ds_read_b128 v[88:91], v224 offset:55296
    v_add_f32_e64 v53, v17, v21
    v_mfma_f32_16x16x32_bf16 v[100:103], a[116:119], v[68:71], v[100:103]
    ds_read_b128 v[92:95], v225 offset:55296
    v_add_f32 v54, v18, v22
    v_add_f32 v55, v19, v23
    v_mfma_f32_16x16x32_bf16 v[104:107], a[104:107], v[64:67], v[104:107]
    v_add_f32 v52, v52, v24
    v_add_f32 v53, v53, v25
    v_mfma_f32_16x16x32_bf16 v[104:107], a[120:123], v[68:71], v[104:107]
    v_add_f32 v54, v54, v26
    v_add_f32 v55, v55, v27
    v_mfma_f32_16x16x32_bf16 v[108:111], a[108:111], v[64:67], v[108:111]
    v_add_f32 v52, v52, v28
    v_add_f32 v53, v53, v29
    v_add_f32_e64 v54, v54, v30
    v_mfma_f32_16x16x32_bf16 v[108:111], a[124:127], v[68:71], v[108:111]
    v_add_f32 v55, v55, v31
    v_add_f32 v52, v52, v32
    v_mfma_f32_16x16x32_bf16 v[112:115], a[96:99], v[72:75], v[112:115]
    s_add_u32 m0, s35, 20480
    s_add_u32 s33, s33, 131072
    buffer_load_dwordx4 v234, s[48:51], s33 offen lds
    v_mfma_f32_16x16x32_bf16 v[112:115], a[112:115], v[76:79], v[112:115]
    v_add_f32 v53, v53, v33
    v_add_f32 v54, v54, v34
    v_mfma_f32_16x16x32_bf16 v[116:119], a[100:103], v[72:75], v[116:119]
    buffer_load_dwordx4 v235, s[48:51], s33 offen offset:1024 lds
    v_add_f32 v55, v55, v35
    v_add_f32 v52, v52, v36
    v_mfma_f32_16x16x32_bf16 v[116:119], a[116:119], v[76:79], v[116:119]
    v_add_f32 v53, v53, v37
    v_add_f32 v54, v54, v38
    v_mfma_f32_16x16x32_bf16 v[120:123], a[104:107], v[72:75], v[120:123]
    s_add_u32 m0, s35, 22528
    s_add_u32 s33, s33, 131072
    buffer_load_dwordx4 v234, s[48:51], s33 offen lds
    v_mfma_f32_16x16x32_bf16 v[120:123], a[120:123], v[76:79], v[120:123]
    v_add_f32 v55, v55, v39
    v_add_f32 v52, v52, v40
    v_mfma_f32_16x16x32_bf16 v[124:127], a[108:111], v[72:75], v[124:127]
    buffer_load_dwordx4 v235, s[48:51], s33 offen offset:1024 lds
    v_add_f32 v53, v53, v41
    v_add_f32 v54, v54, v42
    v_mfma_f32_16x16x32_bf16 v[124:127], a[124:127], v[76:79], v[124:127]
    v_add_f32 v55, v55, v43
    s_waitcnt lgkmcnt(0)
    v_mfma_f32_16x16x32_bf16 v[128:131], a[96:99], v[80:83], v[128:131]
    ds_read_b128 v[64:67], v224 offset:57344
    v_add_f32_e64 v52, v52, v44
    v_mfma_f32_16x16x32_bf16 v[128:131], a[112:115], v[84:87], v[128:131]
    ds_read_b128 v[68:71], v225 offset:57344
    v_add_f32_e64 v53, v53, v45
    v_mfma_f32_16x16x32_bf16 v[132:135], a[100:103], v[80:83], v[132:135]
    ds_read_b128 v[72:75], v224 offset:59392
    v_add_f32_e64 v54, v54, v46
    v_mfma_f32_16x16x32_bf16 v[132:135], a[116:119], v[84:87], v[132:135]
    ds_read_b128 v[76:79], v225 offset:59392
    v_add_f32 v55, v55, v47
    v_add_f32 v52, v52, v53
    v_mfma_f32_16x16x32_bf16 v[136:139], a[104:107], v[80:83], v[136:139]
    v_add_f32 v54, v54, v55
    v_add_f32 v48, v52, v54
    v_mfma_f32_16x16x32_bf16 v[136:139], a[120:123], v[84:87], v[136:139]
    s_nop 1
    v_add_f32_dpp v48, v48, v48 quad_perm:[1,0,3,2] row_mask:0xf bank_mask:0xf
    v_mfma_f32_16x16x32_bf16 v[140:143], a[108:111], v[80:83], v[140:143]
    s_nop 1
    v_add_f32_dpp v48, v48, v48 quad_perm:[2,3,0,1] row_mask:0xf bank_mask:0xf
    s_nop 1
    v_mfma_f32_16x16x32_bf16 v[140:143], a[124:127], v[84:87], v[140:143]
    v_add_f32_dpp v48, v48, v48 row_half_mirror row_mask:0xf bank_mask:0xf
    s_nop 1
    v_mfma_f32_16x16x32_bf16 v[144:147], a[96:99], v[88:91], v[144:147]
    s_add_u32 m0, s34, 40960
    s_add_u32 s37, s86, 65536
    buffer_load_dwordx4 v232, s[44:47], s37 offen lds
    v_mfma_f32_16x16x32_bf16 v[144:147], a[112:115], v[92:95], v[144:147]
    v_add_f32_dpp v48, v48, v48 row_mirror row_mask:0xf bank_mask:0xf
    s_nop 0
    v_mfma_f32_16x16x32_bf16 v[148:151], a[100:103], v[88:91], v[148:151]
    buffer_load_dwordx4 v233, s[44:47], s37 offen offset:1024 lds
    v_mov_b32_e64 v49, v48
    s_nop 1
    v_mfma_f32_16x16x32_bf16 v[148:151], a[116:119], v[92:95], v[148:151]
    v_permlane16_swap_b32 v48, v49
    s_nop 0
    v_mfma_f32_16x16x32_bf16 v[152:155], a[104:107], v[88:91], v[152:155]
    v_lshlrev_b32_e64 v227, 3, v240
    v_min_u32 v227, 1920, v227
    s_lshl2_add_u32 s25, s2, s3
    v_mfma_f32_16x16x32_bf16 v[152:155], a[120:123], v[92:95], v[152:155]
    v_add_f32 v48, v48, v49
    v_mul_f32 v48, 0x3a800000, v48
    v_mfma_f32_16x16x32_bf16 v[156:159], a[108:111], v[88:91], v[156:159]
    s_lshl_b32 s25, s25, 13
    s_add_u32 s25, s25, 0
    buffer_load_dword v241, v227, s[12:15], s25 offen
    v_mfma_f32_16x16x32_bf16 v[156:159], a[124:127], v[92:95], v[156:159]
    v_sub_f32 v56, v16, v48
    s_waitcnt vmcnt(16) lgkmcnt(0)
    v_mfma_f32_16x16x32_bf16 v[160:163], a[96:99], v[64:67], v[160:163]
    ds_read_b128 v[80:83], v224 offset:61440
    v_mul_f32 v52, v56, v56
    v_sub_f32 v57, v17, v48
    v_mfma_f32_16x16x32_bf16 v[160:163], a[112:115], v[68:71], v[160:163]
    ds_read_b128 v[84:87], v225 offset:61440
    v_mul_f32_e64 v53, v57, v57
    v_mfma_f32_16x16x32_bf16 v[164:167], a[100:103], v[64:67], v[164:167]
    ds_read_b128 v[88:91], v224 offset:63488
    v_sub_f32_e64 v58, v18, v48
    v_mfma_f32_16x16x32_bf16 v[164:167], a[116:119], v[68:71], v[164:167]
    ds_read_b128 v[92:95], v225 offset:63488
    v_mul_f32_e64 v54, v58, v58
    v_mfma_f32_16x16x32_bf16 v[168:171], a[104:107], v[64:67], v[168:171]
    ds_read_b64_tr_b16 a[128:129], v228 offset:8192
    v_sub_f32_e64 v59, v19, v48
    v_mfma_f32_16x16x32_bf16 v[168:171], a[120:123], v[68:71], v[168:171]
    ds_read_b64_tr_b16 a[130:131], v228 offset:8704
    v_mul_f32 v55, v59, v59
    v_sub_f32 v56, v20, v48
    v_mfma_f32_16x16x32_bf16 v[172:175], a[108:111], v[64:67], v[172:175]
    ds_read_b64_tr_b16 a[132:133], v229 offset:8192
    v_fmac_f32_e64 v52, v56, v56
    v_mfma_f32_16x16x32_bf16 v[172:175], a[124:127], v[68:71], v[172:175]
    ds_read_b64_tr_b16 a[134:135], v229 offset:8704
    v_sub_f32_e64 v57, v21, v48
    v_mfma_f32_16x16x32_bf16 v[176:179], a[96:99], v[72:75], v[176:179]
    ds_read_b64_tr_b16 a[136:137], v230 offset:8192
    s_add_u32 m0, s35, 0
    s_and_b32 s33, s86, 1023
    s_lshl_b32 s33, s33, 12
    buffer_load_dwordx4 v234, s[48:51], s33 offen lds
    v_mfma_f32_16x16x32_bf16 v[176:179], a[112:115], v[76:79], v[176:179]
    ds_read_b64_tr_b16 a[138:139], v230 offset:8704
    v_fmac_f32_e64 v53, v57, v57
    v_mfma_f32_16x16x32_bf16 v[180:183], a[100:103], v[72:75], v[180:183]
    ds_read_b64_tr_b16 a[140:141], v231 offset:8192
    buffer_load_dwordx4 v235, s[48:51], s33 offen offset:1024 lds
    v_mfma_f32_16x16x32_bf16 v[180:183], a[116:119], v[76:79], v[180:183]
    ds_read_b64_tr_b16 a[142:143], v231 offset:8704
    v_sub_f32_e64 v58, v22, v48
    v_mfma_f32_16x16x32_bf16 v[184:187], a[104:107], v[72:75], v[184:187]
    s_add_u32 m0, s35, 2048
    s_add_u32 s33, s33, 131072
    buffer_load_dwordx4 v234, s[48:51], s33 offen lds
    v_mfma_f32_16x16x32_bf16 v[184:187], a[120:123], v[76:79], v[184:187]
    v_fmac_f32 v54, v58, v58
    v_sub_f32 v59, v23, v48
    v_fmac_f32_e64 v55, v59, v59
    v_mfma_f32_16x16x32_bf16 v[188:191], a[108:111], v[72:75], v[188:191]
    buffer_load_dwordx4 v235, s[48:51], s33 offen offset:1024 lds
    v_sub_f32_e64 v56, v24, v48
    v_mfma_f32_16x16x32_bf16 v[188:191], a[124:127], v[76:79], v[188:191]
    s_waitcnt vmcnt(30) lgkmcnt(0)
    s_barrier
    v_mfma_f32_16x16x32_bf16 v[192:195], a[96:99], v[80:83], v[192:195]
    ds_read_b128 v[64:67], v224 offset:0
    v_fmac_f32_e64 v52, v56, v56
    v_mfma_f32_16x16x32_bf16 v[192:195], a[112:115], v[84:87], v[192:195]
    ds_read_b128 v[68:71], v225 offset:0
    v_sub_f32_e64 v57, v25, v48
    v_mfma_f32_16x16x32_bf16 v[196:199], a[100:103], v[80:83], v[196:199]
    ds_read_b128 v[72:75], v224 offset:2048
    v_fmac_f32_e64 v53, v57, v57
    v_mfma_f32_16x16x32_bf16 v[196:199], a[116:119], v[84:87], v[196:199]
    ds_read_b128 v[76:79], v225 offset:2048
    v_sub_f32 v58, v26, v48
    v_fmac_f32 v54, v58, v58
    v_mfma_f32_16x16x32_bf16 v[200:203], a[104:107], v[80:83], v[200:203]
    ds_read_b64_tr_b16 a[144:145], v228 offset:12288
    v_sub_f32_e64 v59, v27, v48
    v_mfma_f32_16x16x32_bf16 v[200:203], a[120:123], v[84:87], v[200:203]
    ds_read_b64_tr_b16 a[146:147], v228 offset:12800
    v_fmac_f32_e64 v55, v59, v59
    v_mfma_f32_16x16x32_bf16 v[204:207], a[108:111], v[80:83], v[204:207]
    ds_read_b64_tr_b16 a[148:149], v229 offset:12288
    v_sub_f32_e64 v56, v28, v48
    v_mfma_f32_16x16x32_bf16 v[204:207], a[124:127], v[84:87], v[204:207]
    ds_read_b64_tr_b16 a[150:151], v229 offset:12800
    v_fmac_f32_e64 v52, v56, v56
    v_mfma_f32_16x16x32_bf16 v[208:211], a[96:99], v[88:91], v[208:211]
    ds_read_b64_tr_b16 a[152:153], v230 offset:12288
    s_add_u32 m0, s34, 49152
    s_add_u32 s37, s87, 0
    buffer_load_dwordx4 v232, s[44:47], s37 offen lds
    v_mfma_f32_16x16x32_bf16 v[208:211], a[112:115], v[92:95], v[208:211]
    ds_read_b64_tr_b16 a[154:155], v230 offset:12800
    v_sub_f32 v57, v29, v48
    v_mfma_f32_16x16x32_bf16 v[212:215], a[100:103], v[88:91], v[212:215]
    ds_read_b64_tr_b16 a[156:157], v231 offset:12288
    v_fmac_f32 v53, v57, v57
    v_sub_f32 v58, v30, v48
    v_mfma_f32_16x16x32_bf16 v[212:215], a[116:119], v[92:95], v[212:215]
    ds_read_b64_tr_b16 a[158:159], v231 offset:12800
    v_fmac_f32_e64 v54, v58, v58
    v_mfma_f32_16x16x32_bf16 v[216:219], a[104:107], v[88:91], v[216:219]
    buffer_load_dwordx4 v233, s[44:47], s37 offen offset:1024 lds
    v_sub_f32_e64 v59, v31, v48
    v_mfma_f32_16x16x32_bf16 v[216:219], a[120:123], v[92:95], v[216:219]
    v_fmac_f32 v55, v59, v59
    v_sub_f32 v56, v32, v48
    v_mfma_f32_16x16x32_bf16 v[220:223], a[108:111], v[88:91], v[220:223]
    v_fmac_f32 v52, v56, v56
    v_sub_f32 v57, v33, v48
    v_fmac_f32_e64 v53, v57, v57
    v_mfma_f32_16x16x32_bf16 v[220:223], a[124:127], v[92:95], v[220:223]
    v_sub_f32 v58, v34, v48
    s_waitcnt lgkmcnt(0)
    v_mfma_f32_16x16x32_bf16 v[96:99], a[128:131], v[64:67], v[96:99]
    ds_read_b128 v[80:83], v224 offset:4096
    v_fmac_f32_e64 v54, v58, v58
    v_mfma_f32_16x16x32_bf16 v[96:99], a[144:147], v[68:71], v[96:99]
    ds_read_b128 v[84:87], v225 offset:4096
    v_sub_f32_e64 v59, v35, v48
    v_mfma_f32_16x16x32_bf16 v[100:103], a[132:135], v[64:67], v[100:103]
    ds_read_b128 v[88:91], v224 offset:6144
    v_fmac_f32_e64 v55, v59, v59
    v_mfma_f32_16x16x32_bf16 v[100:103], a[148:151], v[68:71], v[100:103]
    ds_read_b128 v[92:95], v225 offset:6144
    v_sub_f32 v56, v36, v48
    v_fmac_f32 v52, v56, v56
    v_mfma_f32_16x16x32_bf16 v[104:107], a[136:139], v[64:67], v[104:107]
    v_sub_f32 v57, v37, v48
    v_fmac_f32 v53, v57, v57
    v_mfma_f32_16x16x32_bf16 v[104:107], a[152:155], v[68:71], v[104:107]
    v_sub_f32 v58, v38, v48
    v_fmac_f32 v54, v58, v58
    v_mfma_f32_16x16x32_bf16 v[108:111], a[140:143], v[64:67], v[108:111]
    v_sub_f32 v59, v39, v48
    v_fmac_f32 v55, v59, v59
    v_sub_f32_e64 v56, v40, v48
    v_mfma_f32_16x16x32_bf16 v[108:111], a[156:159], v[68:71], v[108:111]
    v_fmac_f32 v52, v56, v56
    v_sub_f32 v57, v41, v48
    v_mfma_f32_16x16x32_bf16 v[112:115], a[128:131], v[72:75], v[112:115]
    s_add_u32 m0, s35, 4096
    s_add_u32 s33, s33, 131072
    buffer_load_dwordx4 v234, s[48:51], s33 offen lds
    v_mfma_f32_16x16x32_bf16 v[112:115], a[144:147], v[76:79], v[112:115]
    v_fmac_f32 v53, v57, v57
    v_sub_f32 v58, v42, v48
    v_mfma_f32_16x16x32_bf16 v[116:119], a[132:135], v[72:75], v[116:119]
    buffer_load_dwordx4 v235, s[48:51], s33 offen offset:1024 lds
    v_fmac_f32 v54, v58, v58
    v_sub_f32 v59, v43, v48
    v_mfma_f32_16x16x32_bf16 v[116:119], a[148:151], v[76:79], v[116:119]
    v_fmac_f32 v55, v59, v59
    v_sub_f32 v56, v44, v48
    v_mfma_f32_16x16x32_bf16 v[120:123], a[136:139], v[72:75], v[120:123]
    s_add_u32 m0, s35, 6144
    s_add_u32 s33, s33, 131072
    buffer_load_dwordx4 v234, s[48:51], s33 offen lds
    v_mfma_f32_16x16x32_bf16 v[120:123], a[152:155], v[76:79], v[120:123]
    v_fmac_f32 v52, v56, v56
    v_sub_f32 v57, v45, v48
    v_mfma_f32_16x16x32_bf16 v[124:127], a[140:143], v[72:75], v[124:127]
    buffer_load_dwordx4 v235, s[48:51], s33 offen offset:1024 lds
    v_fmac_f32 v53, v57, v57
    v_sub_f32 v58, v46, v48
    v_mfma_f32_16x16x32_bf16 v[124:127], a[156:159], v[76:79], v[124:127]
    v_fmac_f32 v54, v58, v58
    s_waitcnt lgkmcnt(0)
    v_mfma_f32_16x16x32_bf16 v[128:131], a[128:131], v[80:83], v[128:131]
    ds_read_b128 v[64:67], v224 offset:8192
    v_sub_f32_e64 v59, v47, v48
    v_mfma_f32_16x16x32_bf16 v[128:131], a[144:147], v[84:87], v[128:131]
    ds_read_b128 v[68:71], v225 offset:8192
    v_fmac_f32_e64 v55, v59, v59
    v_mfma_f32_16x16x32_bf16 v[132:135], a[132:135], v[80:83], v[132:135]
    ds_read_b128 v[72:75], v224 offset:10240
    v_add_f32_e64 v52, v52, v53
    v_mfma_f32_16x16x32_bf16 v[132:135], a[148:151], v[84:87], v[132:135]
    ds_read_b128 v[76:79], v225 offset:10240
    v_add_f32_e64 v54, v54, v55
    v_mfma_f32_16x16x32_bf16 v[136:139], a[136:139], v[80:83], v[136:139]
    v_add_f32 v51, v52, v54
    s_nop 1
    v_add_f32_dpp v51, v51, v51 quad_perm:[1,0,3,2] row_mask:0xf bank_mask:0xf
    v_mfma_f32_16x16x32_bf16 v[136:139], a[152:155], v[84:87], v[136:139]
    s_nop 1
    v_add_f32_dpp v51, v51, v51 quad_perm:[2,3,0,1] row_mask:0xf bank_mask:0xf
    v_mfma_f32_16x16x32_bf16 v[140:143], a[140:143], v[80:83], v[140:143]
    s_nop 1
    v_add_f32_dpp v51, v51, v51 row_half_mirror row_mask:0xf bank_mask:0xf
    s_nop 1
    v_mfma_f32_16x16x32_bf16 v[140:143], a[156:159], v[84:87], v[140:143]
    v_add_f32_dpp v51, v51, v51 row_mirror row_mask:0xf bank_mask:0xf
    s_nop 0
    v_mfma_f32_16x16x32_bf16 v[144:147], a[128:131], v[88:91], v[144:147]
    s_add_u32 m0, s34, 57344
    s_add_u32 s37, s87, 65536
    buffer_load_dwordx4 v232, s[44:47], s37 offen lds
    v_mfma_f32_16x16x32_bf16 v[144:147], a[144:147], v[92:95], v[144:147]
    v_mov_b32 v49, v51
    s_nop 1
    v_mfma_f32_16x16x32_bf16 v[148:151], a[132:135], v[88:91], v[148:151]
    buffer_load_dwordx4 v233, s[44:47], s37 offen offset:1024 lds
    v_permlane16_swap_b32 v51, v49
    s_nop 0
    v_mfma_f32_16x16x32_bf16 v[148:151], a[148:151], v[92:95], v[148:151]
    v_add_f32_e64 v51, v51, v49
    v_mul_f32 v51, 0x3a800000, v51
    v_mfma_f32_16x16x32_bf16 v[152:155], a[136:139], v[88:91], v[152:155]
    v_lshlrev_b32_e64 v227, 3, v240
    v_min_u32 v227, 1920, v227
    s_lshl2_add_u32 s25, s2, s3
    v_mfma_f32_16x16x32_bf16 v[152:155], a[152:155], v[92:95], v[152:155]
    v_cvt_pk_bf16_f32 v50, v48, v51
    v_and_b32 v51, 0xffff0000, v50
    v_mfma_f32_16x16x32_bf16 v[156:159], a[140:143], v[88:91], v[156:159]
    s_lshl_b32 s25, s25, 13
    s_add_u32 s25, s25, 2048
    buffer_load_dword v241, v227, s[12:15], s25 offen
    v_mfma_f32_16x16x32_bf16 v[156:159], a[156:159], v[92:95], v[156:159]
    v_lshlrev_b32 v50, 16, v50
    s_waitcnt vmcnt(16) lgkmcnt(0)
    v_mfma_f32_16x16x32_bf16 v[160:163], a[128:131], v[64:67], v[160:163]
    ds_read_b128 v[80:83], v224 offset:12288
    v_add_f32 v51, 0x3727c5ac, v51
    v_cvt_pk_bf16_f32 v51, v51, v51
    v_mfma_f32_16x16x32_bf16 v[160:163], a[144:147], v[68:71], v[160:163]
    ds_read_b128 v[84:87], v225 offset:12288
    v_lshlrev_b32_e64 v51, 16, v51
    v_mfma_f32_16x16x32_bf16 v[164:167], a[132:135], v[64:67], v[164:167]
    ds_read_b128 v[88:91], v224 offset:14336
    v_mfma_f32_16x16x32_bf16 v[164:167], a[148:151], v[68:71], v[164:167]
    ds_read_b128 v[92:95], v225 offset:14336
    v_sqrt_f32 v51, v51
    v_mfma_f32_16x16x32_bf16 v[168:171], a[136:139], v[64:67], v[168:171]
    ds_read_b64_tr_b16 a[160:161], v228 offset:16384
    s_nop 0
    v_mfma_f32_16x16x32_bf16 v[168:171], a[152:155], v[68:71], v[168:171]
    ds_read_b64_tr_b16 a[162:163], v228 offset:16896
    v_cvt_pk_bf16_f32 v51, v51, v51
    v_lshlrev_b32_e64 v51, 16, v51
    v_mfma_f32_16x16x32_bf16 v[172:175], a[140:143], v[64:67], v[172:175]
    ds_read_b64_tr_b16 a[164:165], v229 offset:16384
    v_mfma_f32_16x16x32_bf16 v[172:175], a[156:159], v[68:71], v[172:175]
    ds_read_b64_tr_b16 a[166:167], v229 offset:16896
    v_rcp_f32_e64 v51, v51
    v_mfma_f32_16x16x32_bf16 v[176:179], a[128:131], v[72:75], v[176:179]
    ds_read_b64_tr_b16 a[168:169], v230 offset:16384
    s_add_u32 m0, s35, 8192
    s_and_b32 s33, s87, 1023
    s_lshl_b32 s33, s33, 12
    buffer_load_dwordx4 v234, s[48:51], s33 offen lds
    v_mfma_f32_16x16x32_bf16 v[176:179], a[144:147], v[76:79], v[176:179]
    ds_read_b64_tr_b16 a[170:171], v230 offset:16896
    s_nop 0
    v_mfma_f32_16x16x32_bf16 v[180:183], a[132:135], v[72:75], v[180:183]
    ds_read_b64_tr_b16 a[172:173], v231 offset:16384
    buffer_load_dwordx4 v235, s[48:51], s33 offen offset:1024 lds
    v_mfma_f32_16x16x32_bf16 v[180:183], a[148:151], v[76:79], v[180:183]
    ds_read_b64_tr_b16 a[174:175], v231 offset:16896
    v_mul_f32 v51, 0x3e0293ee, v51
    v_mfma_f32_16x16x32_bf16 v[184:187], a[136:139], v[72:75], v[184:187]
    s_add_u32 m0, s35, 10240
    s_add_u32 s33, s33, 131072
    buffer_load_dwordx4 v234, s[48:51], s33 offen lds
    v_mfma_f32_16x16x32_bf16 v[184:187], a[152:155], v[76:79], v[184:187]
    v_sub_f32 v16, v16, v50
    v_sub_f32 v17, v17, v50
    v_cvt_pk_bf16_f32 v17, v16, v17
    v_mfma_f32_16x16x32_bf16 v[188:191], a[140:143], v[72:75], v[188:191]
    buffer_load_dwordx4 v235, s[48:51], s33 offen offset:1024 lds
    v_lshlrev_b32_e64 v16, 16, v17
    v_mfma_f32_16x16x32_bf16 v[188:191], a[156:159], v[76:79], v[188:191]
    s_waitcnt vmcnt(31) lgkmcnt(0)
    s_barrier
    v_mfma_f32_16x16x32_bf16 v[192:195], a[128:131], v[80:83], v[192:195]
    ds_read_b128 v[64:67], v224 offset:16384
    v_and_b32 v17, 0xffff0000, v17
    v_mfma_f32_16x16x32_bf16 v[192:195], a[144:147], v[84:87], v[192:195]
    ds_read_b128 v[68:71], v225 offset:16384
    v_mul_f32_e64 v16, v16, v51
    v_mfma_f32_16x16x32_bf16 v[196:199], a[132:135], v[80:83], v[196:199]
    ds_read_b128 v[72:75], v224 offset:18432
    v_mul_f32_e64 v17, v17, v51
    v_mfma_f32_16x16x32_bf16 v[196:199], a[148:151], v[84:87], v[196:199]
    ds_read_b128 v[76:79], v225 offset:18432
    v_cvt_pk_bf16_f32 v0, v16, v17
    v_sub_f32_e64 v18, v18, v50
    v_mfma_f32_16x16x32_bf16 v[200:203], a[136:139], v[80:83], v[200:203]
    ds_read_b64_tr_b16 a[176:177], v228 offset:20480
    v_sub_f32_e64 v19, v19, v50
    v_mfma_f32_16x16x32_bf16 v[200:203], a[152:155], v[84:87], v[200:203]
    ds_read_b64_tr_b16 a[178:179], v228 offset:20992
    v_cvt_pk_bf16_f32 v19, v18, v19
    v_mfma_f32_16x16x32_bf16 v[204:207], a[140:143], v[80:83], v[204:207]
    ds_read_b64_tr_b16 a[180:181], v229 offset:20480
    v_lshlrev_b32_e64 v18, 16, v19
    v_mfma_f32_16x16x32_bf16 v[204:207], a[156:159], v[84:87], v[204:207]
    ds_read_b64_tr_b16 a[182:183], v229 offset:20992
    v_and_b32 v19, 0xffff0000, v19
    v_mfma_f32_16x16x32_bf16 v[208:211], a[128:131], v[88:91], v[208:211]
    ds_read_b64_tr_b16 a[184:185], v230 offset:20480
    s_add_u32 m0, s34, 0
    s_add_u32 s37, s80, 131072
    buffer_load_dwordx4 v232, s[44:47], s37 offen lds
    v_mfma_f32_16x16x32_bf16 v[208:211], a[144:147], v[92:95], v[208:211]
    ds_read_b64_tr_b16 a[186:187], v230 offset:20992
    v_mul_f32 v18, v18, v51
    v_mfma_f32_16x16x32_bf16 v[212:215], a[132:135], v[88:91], v[212:215]
    ds_read_b64_tr_b16 a[188:189], v231 offset:20480
    v_mul_f32_e64 v19, v19, v51
    v_cvt_pk_bf16_f32 v1, v18, v19
    v_mfma_f32_16x16x32_bf16 v[212:215], a[148:151], v[92:95], v[212:215]
    ds_read_b64_tr_b16 a[190:191], v231 offset:20992
    v_sub_f32_e64 v20, v20, v50
    v_mfma_f32_16x16x32_bf16 v[216:219], a[136:139], v[88:91], v[216:219]
    buffer_load_dwordx4 v233, s[44:47], s37 offen offset:1024 lds
    v_sub_f32_e64 v21, v21, v50
    v_mfma_f32_16x16x32_bf16 v[216:219], a[152:155], v[92:95], v[216:219]
    v_cvt_pk_bf16_f32 v21, v20, v21
    v_lshlrev_b32_e64 v20, 16, v21
    v_mfma_f32_16x16x32_bf16 v[220:223], a[140:143], v[88:91], v[220:223]
    v_and_b32 v21, 0xffff0000, v21
    v_mul_f32 v20, v20, v51
    v_mul_f32 v21, v21, v51
    v_mfma_f32_16x16x32_bf16 v[220:223], a[156:159], v[92:95], v[220:223]
    v_cvt_pk_bf16_f32 v2, v20, v21
    s_waitcnt lgkmcnt(0)
    v_mfma_f32_16x16x32_bf16 v[96:99], a[160:163], v[64:67], v[96:99]
    ds_read_b128 v[80:83], v224 offset:20480
    v_sub_f32 v22, v22, v50
    v_mfma_f32_16x16x32_bf16 v[96:99], a[176:179], v[68:71], v[96:99]
    ds_read_b128 v[84:87], v225 offset:20480
    v_sub_f32_e64 v23, v23, v50
    v_mfma_f32_16x16x32_bf16 v[100:103], a[164:167], v[64:67], v[100:103]
    ds_read_b128 v[88:91], v224 offset:22528
    v_cvt_pk_bf16_f32 v23, v22, v23
    v_mfma_f32_16x16x32_bf16 v[100:103], a[180:183], v[68:71], v[100:103]
    ds_read_b128 v[92:95], v225 offset:22528
    v_lshlrev_b32_e64 v22, 16, v23
    v_and_b32 v23, 0xffff0000, v23
    v_mfma_f32_16x16x32_bf16 v[104:107], a[168:171], v[64:67], v[104:107]
    v_mul_f32 v22, v22, v51
    v_mul_f32 v23, v23, v51
    v_mfma_f32_16x16x32_bf16 v[104:107], a[184:187], v[68:71], v[104:107]
    v_cvt_pk_bf16_f32 v3, v22, v23
    v_sub_f32_e64 v24, v24, v50
    v_mfma_f32_16x16x32_bf16 v[108:111], a[172:175], v[64:67], v[108:111]
    v_sub_f32_e64 v25, v25, v50
    v_cvt_pk_bf16_f32 v25, v24, v25
    v_lshlrev_b32_e64 v24, 16, v25
    v_mfma_f32_16x16x32_bf16 v[108:111], a[188:191], v[68:71], v[108:111]
    v_and_b32 v25, 0xffff0000, v25
    v_mul_f32_e64 v24, v24, v51
    v_mfma_f32_16x16x32_bf16 v[112:115], a[160:163], v[72:75], v[112:115]
    s_add_u32 m0, s35, 12288
    s_add_u32 s33, s33, 131072
    buffer_load_dwordx4 v234, s[48:51], s33 offen lds
    v_mfma_f32_16x16x32_bf16 v[112:115], a[176:179], v[76:79], v[112:115]
    v_mul_f32_e64 v25, v25, v51
    v_cvt_pk_bf16_f32 v4, v24, v25
    v_mfma_f32_16x16x32_bf16 v[116:119], a[164:167], v[72:75], v[116:119]
    buffer_load_dwordx4 v235, s[48:51], s33 offen offset:1024 lds
    v_sub_f32 v26, v26, v50
    v_sub_f32 v27, v27, v50
    v_mfma_f32_16x16x32_bf16 v[116:119], a[180:183], v[76:79], v[116:119]
    v_cvt_pk_bf16_f32 v27, v26, v27
    v_lshlrev_b32_e64 v26, 16, v27
    v_mfma_f32_16x16x32_bf16 v[120:123], a[168:171], v[72:75], v[120:123]
    s_add_u32 m0, s35, 14336
    s_add_u32 s33, s33, 131072
    buffer_load_dwordx4 v234, s[48:51], s33 offen lds
    v_mfma_f32_16x16x32_bf16 v[120:123], a[184:187], v[76:79], v[120:123]
    v_and_b32 v27, 0xffff0000, v27
    v_mul_f32_e64 v26, v26, v51
    v_mfma_f32_16x16x32_bf16 v[124:127], a[172:175], v[72:75], v[124:127]
    buffer_load_dwordx4 v235, s[48:51], s33 offen offset:1024 lds
    v_mul_f32_e64 v27, v27, v51
    v_cvt_pk_bf16_f32 v5, v26, v27
    v_mfma_f32_16x16x32_bf16 v[124:127], a[188:191], v[76:79], v[124:127]
    v_sub_f32 v28, v28, v50
    s_waitcnt lgkmcnt(0)
    v_mfma_f32_16x16x32_bf16 v[128:131], a[160:163], v[80:83], v[128:131]
    ds_read_b128 v[64:67], v224 offset:24576
    v_sub_f32_e64 v29, v29, v50
    v_mfma_f32_16x16x32_bf16 v[128:131], a[176:179], v[84:87], v[128:131]
    ds_read_b128 v[68:71], v225 offset:24576
    v_cvt_pk_bf16_f32 v29, v28, v29
    v_mfma_f32_16x16x32_bf16 v[132:135], a[164:167], v[80:83], v[132:135]
    ds_read_b128 v[72:75], v224 offset:26624
    v_lshlrev_b32_e64 v28, 16, v29
    v_mfma_f32_16x16x32_bf16 v[132:135], a[180:183], v[84:87], v[132:135]
    ds_read_b128 v[76:79], v225 offset:26624
    v_and_b32 v29, 0xffff0000, v29
    v_mfma_f32_16x16x32_bf16 v[136:139], a[168:171], v[80:83], v[136:139]
    v_mul_f32 v28, v28, v51
    v_mul_f32 v29, v29, v51
    v_cvt_pk_bf16_f32 v6, v28, v29
    v_mfma_f32_16x16x32_bf16 v[136:139], a[184:187], v[84:87], v[136:139]
    v_sub_f32 v30, v30, v50
    v_sub_f32 v31, v31, v50
    v_mfma_f32_16x16x32_bf16 v[140:143], a[172:175], v[80:83], v[140:143]
    v_cvt_pk_bf16_f32 v31, v30, v31
    v_lshlrev_b32_e64 v30, 16, v31
    v_and_b32 v31, 0xffff0000, v31
    v_mfma_f32_16x16x32_bf16 v[140:143], a[188:191], v[84:87], v[140:143]
    v_mul_f32 v30, v30, v51
    v_mul_f32 v31, v31, v51
    v_mfma_f32_16x16x32_bf16 v[144:147], a[160:163], v[88:91], v[144:147]
    s_add_u32 m0, s34, 8192
    s_add_u32 s37, s81, 131072
    buffer_load_dwordx4 v232, s[44:47], s37 offen lds
    v_mfma_f32_16x16x32_bf16 v[144:147], a[176:179], v[92:95], v[144:147]
    v_cvt_pk_bf16_f32 v7, v30, v31
    v_sub_f32_e64 v32, v32, v50
    v_mfma_f32_16x16x32_bf16 v[148:151], a[164:167], v[88:91], v[148:151]
    buffer_load_dwordx4 v233, s[44:47], s37 offen offset:1024 lds
    v_sub_f32_e64 v33, v33, v50
    v_mfma_f32_16x16x32_bf16 v[148:151], a[180:183], v[92:95], v[148:151]
    v_cvt_pk_bf16_f32 v33, v32, v33
    v_lshlrev_b32_e64 v32, 16, v33
    v_and_b32 v33, 0xffff0000, v33
    v_mfma_f32_16x16x32_bf16 v[152:155], a[168:171], v[88:91], v[152:155]
    v_lshlrev_b32_e64 v227, 3, v240
    v_min_u32 v227, 1920, v227
    s_lshl2_add_u32 s25, s2, s3
    v_mfma_f32_16x16x32_bf16 v[152:155], a[184:187], v[92:95], v[152:155]
    v_mul_f32 v32, v32, v51
    v_mul_f32_e64 v33, v33, v51
    v_mfma_f32_16x16x32_bf16 v[156:159], a[172:175], v[88:91], v[156:159]
    s_lshl_b32 s25, s25, 13
    s_add_u32 s25, s25, 4096
    buffer_load_dword v241, v227, s[12:15], s25 offen
    v_mfma_f32_16x16x32_bf16 v[156:159], a[188:191], v[92:95], v[156:159]
    v_cvt_pk_bf16_f32 v8, v32, v33
    s_waitcnt vmcnt(16) lgkmcnt(0)
    v_mfma_f32_16x16x32_bf16 v[160:163], a[160:163], v[64:67], v[160:163]
    ds_read_b128 v[80:83], v224 offset:28672
    v_sub_f32 v34, v34, v50
    v_sub_f32 v35, v35, v50
    v_mfma_f32_16x16x32_bf16 v[160:163], a[176:179], v[68:71], v[160:163]
    ds_read_b128 v[84:87], v225 offset:28672
    v_cvt_pk_bf16_f32 v35, v34, v35
    v_mfma_f32_16x16x32_bf16 v[164:167], a[164:167], v[64:67], v[164:167]
    ds_read_b128 v[88:91], v224 offset:30720
    v_lshlrev_b32_e64 v34, 16, v35
    v_mfma_f32_16x16x32_bf16 v[164:167], a[180:183], v[68:71], v[164:167]
    ds_read_b128 v[92:95], v225 offset:30720
    v_and_b32 v35, 0xffff0000, v35
    v_mfma_f32_16x16x32_bf16 v[168:171], a[168:171], v[64:67], v[168:171]
    ds_read_b64_tr_b16 a[192:193], v228 offset:0
    v_mul_f32_e64 v34, v34, v51
    v_mfma_f32_16x16x32_bf16 v[168:171], a[184:187], v[68:71], v[168:171]
    ds_read_b64_tr_b16 a[194:195], v228 offset:512
    v_mul_f32_e64 v35, v35, v51
    v_cvt_pk_bf16_f32 v9, v34, v35
    v_mfma_f32_16x16x32_bf16 v[172:175], a[172:175], v[64:67], v[172:175]
    ds_read_b64_tr_b16 a[196:197], v229 offset:0
    v_sub_f32_e64 v36, v36, v50
    v_mfma_f32_16x16x32_bf16 v[172:175], a[188:191], v[68:71], v[172:175]
    ds_read_b64_tr_b16 a[198:199], v229 offset:512
    v_sub_f32_e64 v37, v37, v50
    v_mfma_f32_16x16x32_bf16 v[176:179], a[160:163], v[72:75], v[176:179]
    ds_read_b64_tr_b16 a[200:201], v230 offset:0
    v_cvt_pk_bf16_f32 v37, v36, v37
    v_mfma_f32_16x16x32_bf16 v[176:179], a[176:179], v[76:79], v[176:179]
    ds_read_b64_tr_b16 a[202:203], v230 offset:512
    v_lshlrev_b32_e64 v36, 16, v37
    v_mfma_f32_16x16x32_bf16 v[180:183], a[164:167], v[72:75], v[180:183]
    ds_read_b64_tr_b16 a[204:205], v231 offset:0
    v_and_b32 v37, 0xffff0000, v37
    v_mfma_f32_16x16x32_bf16 v[180:183], a[180:183], v[76:79], v[180:183]
    ds_read_b64_tr_b16 a[206:207], v231 offset:512
    v_mul_f32 v36, v36, v51
    v_mul_f32 v37, v37, v51
    v_mfma_f32_16x16x32_bf16 v[184:187], a[168:171], v[72:75], v[184:187]
    v_cvt_pk_bf16_f32 v10, v36, v37
    v_sub_f32_e64 v38, v38, v50
    v_mfma_f32_16x16x32_bf16 v[184:187], a[184:187], v[76:79], v[184:187]
    v_sub_f32_e64 v39, v39, v50
    v_cvt_pk_bf16_f32 v39, v38, v39
    v_mfma_f32_16x16x32_bf16 v[188:191], a[172:175], v[72:75], v[188:191]
    v_lshlrev_b32_e64 v38, 16, v39
    v_and_b32 v39, 0xffff0000, v39
    v_mul_f32_e64 v38, v38, v51
    v_mfma_f32_16x16x32_bf16 v[188:191], a[188:191], v[76:79], v[188:191]
    s_waitcnt vmcnt(27) lgkmcnt(0)
    s_barrier
    v_mfma_f32_16x16x32_bf16 v[192:195], a[160:163], v[80:83], v[192:195]
    ds_read_b128 v[64:67], v224 offset:32768
    v_mul_f32_e64 v39, v39, v51
    v_mfma_f32_16x16x32_bf16 v[192:195], a[176:179], v[84:87], v[192:195]
    ds_read_b128 v[68:71], v225 offset:32768
    v_cvt_pk_bf16_f32 v11, v38, v39
    v_mfma_f32_16x16x32_bf16 v[196:199], a[164:167], v[80:83], v[196:199]
    ds_read_b128 v[72:75], v224 offset:34816
    v_sub_f32_e64 v40, v40, v50
    v_mfma_f32_16x16x32_bf16 v[196:199], a[180:183], v[84:87], v[196:199]
    ds_read_b128 v[76:79], v225 offset:34816
    v_sub_f32_e64 v41, v41, v50
    v_mfma_f32_16x16x32_bf16 v[200:203], a[168:171], v[80:83], v[200:203]
    ds_read_b64_tr_b16 a[208:209], v228 offset:4096
    v_cvt_pk_bf16_f32 v41, v40, v41
    v_lshlrev_b32_e64 v40, 16, v41
    v_mfma_f32_16x16x32_bf16 v[200:203], a[184:187], v[84:87], v[200:203]
    ds_read_b64_tr_b16 a[210:211], v228 offset:4608
    v_and_b32 v41, 0xffff0000, v41
    v_mfma_f32_16x16x32_bf16 v[204:207], a[172:175], v[80:83], v[204:207]
    ds_read_b64_tr_b16 a[212:213], v229 offset:4096
    v_mul_f32_e64 v40, v40, v51
    v_mfma_f32_16x16x32_bf16 v[204:207], a[188:191], v[84:87], v[204:207]
    ds_read_b64_tr_b16 a[214:215], v229 offset:4608
    v_mul_f32_e64 v41, v41, v51
    v_mfma_f32_16x16x32_bf16 v[208:211], a[160:163], v[88:91], v[208:211]
    ds_read_b64_tr_b16 a[216:217], v230 offset:4096
    s_add_u32 m0, s34, 16384
    s_add_u32 s37, s82, 131072
    buffer_load_dwordx4 v232, s[44:47], s37 offen lds
    v_mfma_f32_16x16x32_bf16 v[208:211], a[176:179], v[92:95], v[208:211]
    ds_read_b64_tr_b16 a[218:219], v230 offset:4608
    v_cvt_pk_bf16_f32 v12, v40, v41
    v_mfma_f32_16x16x32_bf16 v[212:215], a[164:167], v[88:91], v[212:215]
    ds_read_b64_tr_b16 a[220:221], v231 offset:4096
    v_sub_f32 v42, v42, v50
    v_sub_f32 v43, v43, v50
    v_mfma_f32_16x16x32_bf16 v[212:215], a[180:183], v[92:95], v[212:215]
    ds_read_b64_tr_b16 a[222:223], v231 offset:4608
    v_cvt_pk_bf16_f32 v43, v42, v43
    v_mfma_f32_16x16x32_bf16 v[216:219], a[168:171], v[88:91], v[216:219]
    buffer_load_dwordx4 v233, s[44:47], s37 offen offset:1024 lds
    v_lshlrev_b32_e64 v42, 16, v43
    v_mfma_f32_16x16x32_bf16 v[216:219], a[184:187], v[92:95], v[216:219]
    v_and_b32 v43, 0xffff0000, v43
    v_mul_f32_e64 v42, v42, v51
    v_mfma_f32_16x16x32_bf16 v[220:223], a[172:175], v[88:91], v[220:223]
    v_mul_f32_e64 v43, v43, v51
    v_cvt_pk_bf16_f32 v13, v42, v43
    v_sub_f32_e64 v44, v44, v50
    v_mfma_f32_16x16x32_bf16 v[220:223], a[188:191], v[92:95], v[220:223]
    v_sub_f32 v45, v45, v50
    s_waitcnt lgkmcnt(0)
    v_mfma_f32_16x16x32_bf16 v[96:99], a[192:195], v[64:67], v[96:99]
    ds_read_b128 v[80:83], v224 offset:36864
    v_cvt_pk_bf16_f32 v45, v44, v45
    v_mfma_f32_16x16x32_bf16 v[96:99], a[208:211], v[68:71], v[96:99]
    ds_read_b128 v[84:87], v225 offset:36864
    v_lshlrev_b32_e64 v44, 16, v45
    v_mfma_f32_16x16x32_bf16 v[100:103], a[196:199], v[64:67], v[100:103]
    ds_read_b128 v[88:91], v224 offset:38912
    v_and_b32 v45, 0xffff0000, v45
    v_mfma_f32_16x16x32_bf16 v[100:103], a[212:215], v[68:71], v[100:103]
    ds_read_b128 v[92:95], v225 offset:38912
    v_mul_f32 v44, v44, v51
    v_mul_f32 v45, v45, v51
    v_mfma_f32_16x16x32_bf16 v[104:107], a[200:203], v[64:67], v[104:107]
    v_cvt_pk_bf16_f32 v14, v44, v45
    v_sub_f32_e64 v46, v46, v50
    v_mfma_f32_16x16x32_bf16 v[104:107], a[216:219], v[68:71], v[104:107]
    v_sub_f32_e64 v47, v47, v50
    v_cvt_pk_bf16_f32 v47, v46, v47
    v_mfma_f32_16x16x32_bf16 v[108:111], a[204:207], v[64:67], v[108:111]
    v_lshlrev_b32_e64 v46, 16, v47
    v_and_b32 v47, 0xffff0000, v47
    v_mul_f32_e64 v46, v46, v51
    v_mfma_f32_16x16x32_bf16 v[108:111], a[220:223], v[68:71], v[108:111]
    v_mul_f32_e64 v47, v47, v51
    v_cvt_pk_bf16_f32 v15, v46, v47
    v_mfma_f32_16x16x32_bf16 v[112:115], a[192:195], v[72:75], v[112:115]
    v_mfma_f32_16x16x32_bf16 v[112:115], a[208:211], v[76:79], v[112:115]
    ds_write_b128 v237, v[0:3] offset:0
    v_mfma_f32_16x16x32_bf16 v[116:119], a[196:199], v[72:75], v[116:119]
    ds_write_b128 v237, v[4:7] offset:4096
    v_mfma_f32_16x16x32_bf16 v[116:119], a[212:215], v[76:79], v[116:119]
    ds_write_b128 v237, v[8:11] offset:24576
    v_mfma_f32_16x16x32_bf16 v[120:123], a[200:203], v[72:75], v[120:123]
    ds_write_b128 v237, v[12:15] offset:28672
    v_mfma_f32_16x16x32_bf16 v[120:123], a[216:219], v[76:79], v[120:123]
    v_mfma_f32_16x16x32_bf16 v[124:127], a[204:207], v[72:75], v[124:127]
    v_mfma_f32_16x16x32_bf16 v[124:127], a[220:223], v[76:79], v[124:127]
    s_waitcnt lgkmcnt(0)
    v_mfma_f32_16x16x32_bf16 v[128:131], a[192:195], v[80:83], v[128:131]
    ds_read_b128 v[64:67], v224 offset:40960
    v_mfma_f32_16x16x32_bf16 v[128:131], a[208:211], v[84:87], v[128:131]
    ds_read_b128 v[68:71], v225 offset:40960
    v_mfma_f32_16x16x32_bf16 v[132:135], a[196:199], v[80:83], v[132:135]
    ds_read_b128 v[72:75], v224 offset:43008
    v_mfma_f32_16x16x32_bf16 v[132:135], a[212:215], v[84:87], v[132:135]
    ds_read_b128 v[76:79], v225 offset:43008
    v_mfma_f32_16x16x32_bf16 v[136:139], a[200:203], v[80:83], v[136:139]
    v_mfma_f32_16x16x32_bf16 v[136:139], a[216:219], v[84:87], v[136:139]
    v_mfma_f32_16x16x32_bf16 v[140:143], a[204:207], v[80:83], v[140:143]
    v_mfma_f32_16x16x32_bf16 v[140:143], a[220:223], v[84:87], v[140:143]
    v_mfma_f32_16x16x32_bf16 v[144:147], a[192:195], v[88:91], v[144:147]
    s_add_u32 m0, s34, 24576
    s_add_u32 s37, s83, 131072
    buffer_load_dwordx4 v232, s[44:47], s37 offen lds
    v_mfma_f32_16x16x32_bf16 v[144:147], a[208:211], v[92:95], v[144:147]
    buffer_load_dwordx4 v233, s[44:47], s37 offen offset:1024 lds
    v_mfma_f32_16x16x32_bf16 v[148:151], a[196:199], v[88:91], v[148:151]
    v_mfma_f32_16x16x32_bf16 v[148:151], a[212:215], v[92:95], v[148:151]
    v_lshlrev_b32 v227, 3, v240
    v_min_u32 v227, 1920, v227
    s_lshl2_add_u32 s25, s2, s3
    v_mfma_f32_16x16x32_bf16 v[152:155], a[200:203], v[88:91], v[152:155]
    s_lshl_b32 s25, s25, 13
    s_add_u32 s25, s25, 6144
    buffer_load_dword v241, v227, s[12:15], s25 offen
    v_mfma_f32_16x16x32_bf16 v[152:155], a[216:219], v[92:95], v[152:155]
    v_mfma_f32_16x16x32_bf16 v[156:159], a[204:207], v[88:91], v[156:159]
    buffer_load_dword v254, off, s[88:91], s97 sc1
    v_mfma_f32_16x16x32_bf16 v[156:159], a[220:223], v[92:95], v[156:159]
    s_waitcnt vmcnt(9) lgkmcnt(0)
    v_mfma_f32_16x16x32_bf16 v[160:163], a[192:195], v[64:67], v[160:163]
    ds_read_b128 v[80:83], v224 offset:45056
    v_mfma_f32_16x16x32_bf16 v[160:163], a[208:211], v[68:71], v[160:163]
    ds_read_b128 v[84:87], v225 offset:45056
    s_mul_i32 s38, s2, 100
    v_mfma_f32_16x16x32_bf16 v[164:167], a[196:199], v[64:67], v[164:167]
    ds_read_b128 v[88:91], v224 offset:47104
    v_mfma_f32_16x16x32_bf16 v[164:167], a[212:215], v[68:71], v[164:167]
    ds_read_b128 v[92:95], v225 offset:47104
    v_lshl_add_u32 v60, v253, 2, s38
    v_mfma_f32_16x16x32_bf16 v[168:171], a[200:203], v[64:67], v[168:171]
    ds_read_b64_tr_b16 a[224:225], v228 offset:8192
    v_mfma_f32_16x16x32_bf16 v[168:171], a[216:219], v[68:71], v[168:171]
    ds_read_b64_tr_b16 a[226:227], v228 offset:8704
    v_cmp_gt_u32 vcc, 25, v253
    v_mfma_f32_16x16x32_bf16 v[172:175], a[204:207], v[64:67], v[172:175]
    ds_read_b64_tr_b16 a[228:229], v229 offset:8192
    v_mfma_f32_16x16x32_bf16 v[172:175], a[220:223], v[68:71], v[172:175]
    ds_read_b64_tr_b16 a[230:231], v229 offset:8704
    v_mov_b32_e64 v61, 0
    v_mfma_f32_16x16x32_bf16 v[176:179], a[192:195], v[72:75], v[176:179]
    ds_read_b64_tr_b16 a[232:233], v230 offset:8192
    v_mfma_f32_16x16x32_bf16 v[176:179], a[208:211], v[76:79], v[176:179]
    ds_read_b64_tr_b16 a[234:235], v230 offset:8704
    v_mfma_f32_16x16x32_bf16 v[180:183], a[196:199], v[72:75], v[180:183]
    ds_read_b64_tr_b16 a[236:237], v231 offset:8192
    v_mov_b32 v62, 0x7ffffff0
    v_mfma_f32_16x16x32_bf16 v[180:183], a[212:215], v[76:79], v[180:183]
    ds_read_b64_tr_b16 a[238:239], v231 offset:8704
    v_mfma_f32_16x16x32_bf16 v[184:187], a[200:203], v[72:75], v[184:187]
    v_cndmask_b32 v60, v62, v60, vcc
    v_mfma_f32_16x16x32_bf16 v[184:187], a[216:219], v[76:79], v[184:187]
    buffer_store_dword v61, v60, s[56:59], 0 offen sc1
    v_mfma_f32_16x16x32_bf16 v[188:191], a[204:207], v[72:75], v[188:191]
    v_mfma_f32_16x16x32_bf16 v[188:191], a[220:223], v[76:79], v[188:191]
    s_waitcnt vmcnt(21) lgkmcnt(0)
    s_barrier
    v_mfma_f32_16x16x32_bf16 v[192:195], a[192:195], v[80:83], v[192:195]
    ds_read_b128 v[64:67], v224 offset:49152
    v_mfma_f32_16x16x32_bf16 v[192:195], a[208:211], v[84:87], v[192:195]
    ds_read_b128 v[68:71], v225 offset:49152
    v_mfma_f32_16x16x32_bf16 v[196:199], a[196:199], v[80:83], v[196:199]
    ds_read_b128 v[72:75], v224 offset:51200
    v_mfma_f32_16x16x32_bf16 v[196:199], a[212:215], v[84:87], v[196:199]
    ds_read_b128 v[76:79], v225 offset:51200
    v_mfma_f32_16x16x32_bf16 v[200:203], a[200:203], v[80:83], v[200:203]
    ds_read_b64_tr_b16 a[240:241], v228 offset:12288
    v_mfma_f32_16x16x32_bf16 v[200:203], a[216:219], v[84:87], v[200:203]
    ds_read_b64_tr_b16 a[242:243], v228 offset:12800
    v_mfma_f32_16x16x32_bf16 v[204:207], a[204:207], v[80:83], v[204:207]
    ds_read_b64_tr_b16 a[244:245], v229 offset:12288
    v_mfma_f32_16x16x32_bf16 v[204:207], a[220:223], v[84:87], v[204:207]
    ds_read_b64_tr_b16 a[246:247], v229 offset:12800
    v_mfma_f32_16x16x32_bf16 v[208:211], a[192:195], v[88:91], v[208:211]
    ds_read_b64_tr_b16 a[248:249], v230 offset:12288
    v_lshlrev_b32 v237, 4, v253
    v_add_u32 v237, 81920, v237
    ds_read_b128 v[16:19], v237 offset:0
    ds_read_b128 v[20:23], v237 offset:4096
    ds_read_b128 v[24:27], v237 offset:24576
    ds_read_b128 v[28:31], v237 offset:28672
    s_add_u32 m0, s34, 32768
    s_add_u32 s37, s84, 131072
    buffer_load_dwordx4 v232, s[44:47], s37 offen lds
    v_mfma_f32_16x16x32_bf16 v[208:211], a[208:211], v[92:95], v[208:211]
    ds_read_b64_tr_b16 a[250:251], v230 offset:12800
    v_mfma_f32_16x16x32_bf16 v[212:215], a[196:199], v[88:91], v[212:215]
    ds_read_b64_tr_b16 a[252:253], v231 offset:12288
    v_mfma_f32_16x16x32_bf16 v[212:215], a[212:215], v[92:95], v[212:215]
    ds_read_b64_tr_b16 a[254:255], v231 offset:12800
    v_mfma_f32_16x16x32_bf16 v[216:219], a[200:203], v[88:91], v[216:219]
    buffer_load_dwordx4 v233, s[44:47], s37 offen offset:1024 lds
    v_mfma_f32_16x16x32_bf16 v[216:219], a[216:219], v[92:95], v[216:219]
    v_mfma_f32_16x16x32_bf16 v[220:223], a[204:207], v[88:91], v[220:223]
    v_mfma_f32_16x16x32_bf16 v[220:223], a[220:223], v[92:95], v[220:223]
    s_waitcnt lgkmcnt(0)
    v_mfma_f32_16x16x32_bf16 v[96:99], a[224:227], v[64:67], v[96:99]
    ds_read_b128 v[80:83], v224 offset:53248
    v_mfma_f32_16x16x32_bf16 v[96:99], a[240:243], v[68:71], v[96:99]
    ds_read_b128 v[84:87], v225 offset:53248
    v_mfma_f32_16x16x32_bf16 v[100:103], a[228:231], v[64:67], v[100:103]
    ds_read_b128 v[88:91], v224 offset:55296
    v_mfma_f32_16x16x32_bf16 v[100:103], a[244:247], v[68:71], v[100:103]
    ds_read_b128 v[92:95], v225 offset:55296
    v_mfma_f32_16x16x32_bf16 v[104:107], a[232:235], v[64:67], v[104:107]
    v_mfma_f32_16x16x32_bf16 v[104:107], a[248:251], v[68:71], v[104:107]
    s_mov_b32 s39, 0
    buffer_store_dwordx4 v[16:19], v238, s[8:11], s39 offen sc1
    v_mfma_f32_16x16x32_bf16 v[108:111], a[236:239], v[64:67], v[108:111]
    v_mfma_f32_16x16x32_bf16 v[108:111], a[252:255], v[68:71], v[108:111]
    v_mfma_f32_16x16x32_bf16 v[112:115], a[224:227], v[72:75], v[112:115]
    v_mfma_f32_16x16x32_bf16 v[112:115], a[240:243], v[76:79], v[112:115]
    v_mfma_f32_16x16x32_bf16 v[116:119], a[228:231], v[72:75], v[116:119]
    v_mfma_f32_16x16x32_bf16 v[116:119], a[244:247], v[76:79], v[116:119]
    v_mfma_f32_16x16x32_bf16 v[120:123], a[232:235], v[72:75], v[120:123]
    v_mfma_f32_16x16x32_bf16 v[120:123], a[248:251], v[76:79], v[120:123]
    s_mov_b32 s39, 8192
    buffer_store_dwordx4 v[20:23], v238, s[8:11], s39 offen sc1
    v_mfma_f32_16x16x32_bf16 v[124:127], a[236:239], v[72:75], v[124:127]
    v_mfma_f32_16x16x32_bf16 v[124:127], a[252:255], v[76:79], v[124:127]
    s_waitcnt lgkmcnt(0)
    v_mfma_f32_16x16x32_bf16 v[128:131], a[224:227], v[80:83], v[128:131]
    ds_read_b128 v[64:67], v224 offset:57344
    v_mfma_f32_16x16x32_bf16 v[128:131], a[240:243], v[84:87], v[128:131]
    ds_read_b128 v[68:71], v225 offset:57344
    v_mfma_f32_16x16x32_bf16 v[132:135], a[228:231], v[80:83], v[132:135]
    ds_read_b128 v[72:75], v224 offset:59392
    v_mfma_f32_16x16x32_bf16 v[132:135], a[244:247], v[84:87], v[132:135]
    ds_read_b128 v[76:79], v225 offset:59392
    v_mfma_f32_16x16x32_bf16 v[136:139], a[232:235], v[80:83], v[136:139]
    v_mfma_f32_16x16x32_bf16 v[136:139], a[248:251], v[84:87], v[136:139]
    s_mov_b32 s39, 16384
    buffer_store_dwordx4 v[24:27], v238, s[8:11], s39 offen sc1
    v_mfma_f32_16x16x32_bf16 v[140:143], a[236:239], v[80:83], v[140:143]
    v_mfma_f32_16x16x32_bf16 v[140:143], a[252:255], v[84:87], v[140:143]
    v_mfma_f32_16x16x32_bf16 v[144:147], a[224:227], v[88:91], v[144:147]
    s_add_u32 m0, s34, 40960
    s_add_u32 s37, s85, 131072
    buffer_load_dwordx4 v232, s[44:47], s37 offen lds
    v_mfma_f32_16x16x32_bf16 v[144:147], a[240:243], v[92:95], v[144:147]
    v_mfma_f32_16x16x32_bf16 v[148:151], a[228:231], v[88:91], v[148:151]
    v_mfma_f32_16x16x32_bf16 v[148:151], a[244:247], v[92:95], v[148:151]
    v_mfma_f32_16x16x32_bf16 v[152:155], a[232:235], v[88:91], v[152:155]
    buffer_load_dwordx4 v233, s[44:47], s37 offen offset:1024 lds
    v_mfma_f32_16x16x32_bf16 v[152:155], a[248:251], v[92:95], v[152:155]
    s_mov_b32 s39, 24576
    buffer_store_dwordx4 v[28:31], v238, s[8:11], s39 offen sc1
    v_mfma_f32_16x16x32_bf16 v[156:159], a[236:239], v[88:91], v[156:159]
    v_mfma_f32_16x16x32_bf16 v[156:159], a[252:255], v[92:95], v[156:159]
    s_waitcnt lgkmcnt(0)
    v_mfma_f32_16x16x32_bf16 v[160:163], a[224:227], v[64:67], v[160:163]
    ds_read_b128 v[80:83], v224 offset:61440
    v_mfma_f32_16x16x32_bf16 v[160:163], a[240:243], v[68:71], v[160:163]
    ds_read_b128 v[84:87], v225 offset:61440
    v_mfma_f32_16x16x32_bf16 v[164:167], a[228:231], v[64:67], v[164:167]
    ds_read_b128 v[88:91], v224 offset:63488
    v_mfma_f32_16x16x32_bf16 v[164:167], a[244:247], v[68:71], v[164:167]
    ds_read_b128 v[92:95], v225 offset:63488
    v_mfma_f32_16x16x32_bf16 v[168:171], a[232:235], v[64:67], v[168:171]
    v_mfma_f32_16x16x32_bf16 v[168:171], a[248:251], v[68:71], v[168:171]
    v_mfma_f32_16x16x32_bf16 v[172:175], a[236:239], v[64:67], v[172:175]
    v_mfma_f32_16x16x32_bf16 v[172:175], a[252:255], v[68:71], v[172:175]
    v_mfma_f32_16x16x32_bf16 v[176:179], a[224:227], v[72:75], v[176:179]
    v_mfma_f32_16x16x32_bf16 v[176:179], a[240:243], v[76:79], v[176:179]
    v_cvt_pk_bf16_f32 v0, v96, v97
    v_cvt_pk_bf16_f32 v1, v98, v99
    v_mfma_f32_16x16x32_bf16 v[180:183], a[228:231], v[72:75], v[180:183]
    v_cvt_pk_bf16_f32 v2, v100, v101
    v_cvt_pk_bf16_f32 v3, v102, v103
    v_mfma_f32_16x16x32_bf16 v[180:183], a[244:247], v[76:79], v[180:183]
    v_cvt_pk_bf16_f32 v4, v104, v105
    v_cvt_pk_bf16_f32 v5, v106, v107
    v_mfma_f32_16x16x32_bf16 v[184:187], a[232:235], v[72:75], v[184:187]
    v_cvt_pk_bf16_f32 v6, v108, v109
    v_cvt_pk_bf16_f32 v7, v110, v111
    v_mfma_f32_16x16x32_bf16 v[184:187], a[248:251], v[76:79], v[184:187]
    v_cvt_pk_bf16_f32 v8, v112, v113
    v_cvt_pk_bf16_f32 v9, v114, v115
    v_mfma_f32_16x16x32_bf16 v[188:191], a[236:239], v[72:75], v[188:191]
    v_cvt_pk_bf16_f32 v10, v116, v117
    v_cvt_pk_bf16_f32 v11, v118, v119
    v_mfma_f32_16x16x32_bf16 v[188:191], a[252:255], v[76:79], v[188:191]
    v_cvt_pk_bf16_f32 v12, v120, v121
    v_cvt_pk_bf16_f32 v13, v122, v123
    s_waitcnt vmcnt(16) lgkmcnt(0)
    s_barrier
    v_mfma_f32_16x16x32_bf16 v[192:195], a[224:227], v[80:83], v[192:195]
    ds_read_b128 v[64:67], v224 offset:0
    v_cvt_pk_bf16_f32 v14, v124, v125
    v_cvt_pk_bf16_f32 v15, v126, v127
    v_mfma_f32_16x16x32_bf16 v[192:195], a[240:243], v[84:87], v[192:195]
    ds_read_b128 v[68:71], v225 offset:0
    v_cvt_pk_bf16_f32 v16, v128, v129
    v_cvt_pk_bf16_f32 v17, v130, v131
    v_mfma_f32_16x16x32_bf16 v[196:199], a[228:231], v[80:83], v[196:199]
    ds_read_b128 v[72:75], v224 offset:8192
    v_cvt_pk_bf16_f32 v18, v132, v133
    v_cvt_pk_bf16_f32 v19, v134, v135
    v_mfma_f32_16x16x32_bf16 v[196:199], a[244:247], v[84:87], v[196:199]
    ds_read_b128 v[76:79], v225 offset:8192
    v_cvt_pk_bf16_f32 v20, v136, v137
    v_cvt_pk_bf16_f32 v21, v138, v139
    v_mfma_f32_16x16x32_bf16 v[200:203], a[232:235], v[80:83], v[200:203]
    v_cvt_pk_bf16_f32 v22, v140, v141
    v_cvt_pk_bf16_f32 v23, v142, v143
    v_mfma_f32_16x16x32_bf16 v[200:203], a[248:251], v[84:87], v[200:203]
    v_cvt_pk_bf16_f32 v24, v144, v145
    v_cvt_pk_bf16_f32 v25, v146, v147
    v_mfma_f32_16x16x32_bf16 v[204:207], a[236:239], v[80:83], v[204:207]
    v_cvt_pk_bf16_f32 v26, v148, v149
    v_cvt_pk_bf16_f32 v27, v150, v151
    v_mfma_f32_16x16x32_bf16 v[204:207], a[252:255], v[84:87], v[204:207]
    v_cvt_pk_bf16_f32 v28, v152, v153
    v_cvt_pk_bf16_f32 v29, v154, v155
    v_mfma_f32_16x16x32_bf16 v[208:211], a[224:227], v[88:91], v[208:211]
    s_add_u32 m0, s34, 49152
    s_add_u32 s37, s86, 131072
    buffer_load_dwordx4 v232, s[44:47], s37 offen lds
    v_cvt_pk_bf16_f32 v30, v156, v157
    v_cvt_pk_bf16_f32 v31, v158, v159
    v_mfma_f32_16x16x32_bf16 v[208:211], a[240:243], v[92:95], v[208:211]
    v_cvt_pk_bf16_f32 v32, v160, v161
    v_cvt_pk_bf16_f32 v33, v162, v163
    v_mfma_f32_16x16x32_bf16 v[212:215], a[228:231], v[88:91], v[212:215]
    v_cvt_pk_bf16_f32 v34, v164, v165
    v_cvt_pk_bf16_f32 v35, v166, v167
    v_mfma_f32_16x16x32_bf16 v[212:215], a[244:247], v[92:95], v[212:215]
    v_cvt_pk_bf16_f32 v36, v168, v169
    v_cvt_pk_bf16_f32 v37, v170, v171
    v_mfma_f32_16x16x32_bf16 v[216:219], a[232:235], v[88:91], v[216:219]
    buffer_load_dwordx4 v233, s[44:47], s37 offen offset:1024 lds
    v_cvt_pk_bf16_f32 v38, v172, v173
    v_cvt_pk_bf16_f32 v39, v174, v175
    v_mfma_f32_16x16x32_bf16 v[216:219], a[248:251], v[92:95], v[216:219]
    v_cvt_pk_bf16_f32 v40, v176, v177
    v_cvt_pk_bf16_f32 v41, v178, v179
    v_mfma_f32_16x16x32_bf16 v[220:223], a[236:239], v[88:91], v[220:223]
    v_cvt_pk_bf16_f32 v42, v180, v181
    v_cvt_pk_bf16_f32 v43, v182, v183
    v_mfma_f32_16x16x32_bf16 v[220:223], a[252:255], v[92:95], v[220:223]
    v_cvt_pk_bf16_f32 v44, v184, v185
    v_cvt_pk_bf16_f32 v45, v186, v187
    s_waitcnt lgkmcnt(0)
    v_mfma_f32_16x16x32_bf16 v[96:99], a[0:3], v[64:67], 0
    ds_read_b128 v[80:83], v224 offset:2048
    v_cvt_pk_bf16_f32 v46, v188, v189
    v_cvt_pk_bf16_f32 v47, v190, v191
    v_mfma_f32_16x16x32_bf16 v[96:99], a[16:19], v[68:71], v[96:99]
    ds_read_b128 v[84:87], v225 offset:2048
    v_cvt_pk_bf16_f32 v48, v192, v193
    v_cvt_pk_bf16_f32 v49, v194, v195
    v_mfma_f32_16x16x32_bf16 v[96:99], a[32:35], v[72:75], v[96:99]
    ds_read_b128 v[88:91], v224 offset:10240
    v_cvt_pk_bf16_f32 v50, v196, v197
    v_cvt_pk_bf16_f32 v51, v198, v199
    v_mfma_f32_16x16x32_bf16 v[96:99], a[48:51], v[76:79], v[96:99]
    ds_read_b128 v[92:95], v225 offset:10240
    v_cvt_pk_bf16_f32 v52, v200, v201
    v_cvt_pk_bf16_f32 v53, v202, v203
    v_mfma_f32_16x16x32_bf16 v[100:103], a[4:7], v[64:67], 0
    v_cvt_pk_bf16_f32 v54, v204, v205
    v_cvt_pk_bf16_f32 v55, v206, v207
    s_add_u32 s38, s36, 0
    buffer_store_dwordx4 v[0:3], v240, s[16:19], s38 offen offset:0 sc1
    v_mfma_f32_16x16x32_bf16 v[100:103], a[20:23], v[68:71], v[100:103]
    v_cvt_pk_bf16_f32 v56, v208, v209
    v_cvt_pk_bf16_f32 v57, v210, v211
    v_mfma_f32_16x16x32_bf16 v[100:103], a[36:39], v[72:75], v[100:103]
    v_cvt_pk_bf16_f32 v58, v212, v213
    v_cvt_pk_bf16_f32 v59, v214, v215
    v_mfma_f32_16x16x32_bf16 v[100:103], a[52:55], v[76:79], v[100:103]
    v_cvt_pk_bf16_f32 v60, v216, v217
    v_cvt_pk_bf16_f32 v61, v218, v219
    v_mfma_f32_16x16x32_bf16 v[104:107], a[8:11], v[64:67], 0
    v_xor_b32 v237, 16, v245
    v_xor_b32 v238, 16, v246
    v_cvt_pk_bf16_f32 v62, v220, v221
    v_cvt_pk_bf16_f32 v63, v222, v223
    v_mfma_f32_16x16x32_bf16 v[104:107], a[24:27], v[68:71], v[104:107]
    v_mfma_f32_16x16x32_bf16 v[104:107], a[40:43], v[72:75], v[104:107]
    v_mfma_f32_16x16x32_bf16 v[104:107], a[56:59], v[76:79], v[104:107]
    v_mfma_f32_16x16x32_bf16 v[108:111], a[12:15], v[64:67], 0
    v_mfma_f32_16x16x32_bf16 v[108:111], a[28:31], v[68:71], v[108:111]
    v_mfma_f32_16x16x32_bf16 v[108:111], a[44:47], v[72:75], v[108:111]
    v_mfma_f32_16x16x32_bf16 v[108:111], a[60:63], v[76:79], v[108:111]
    s_waitcnt lgkmcnt(0)
    v_mfma_f32_16x16x32_bf16 v[112:115], a[0:3], v[80:83], 0
    ds_read_b128 v[64:67], v224 offset:4096
    v_mfma_f32_16x16x32_bf16 v[112:115], a[16:19], v[84:87], v[112:115]
    ds_read_b128 v[68:71], v225 offset:4096
    v_mfma_f32_16x16x32_bf16 v[112:115], a[32:35], v[88:91], v[112:115]
    ds_read_b128 v[72:75], v224 offset:12288
    v_mfma_f32_16x16x32_bf16 v[112:115], a[48:51], v[92:95], v[112:115]
    ds_read_b128 v[76:79], v225 offset:12288
    v_mfma_f32_16x16x32_bf16 v[116:119], a[4:7], v[80:83], 0
    v_mfma_f32_16x16x32_bf16 v[116:119], a[20:23], v[84:87], v[116:119]
    v_mfma_f32_16x16x32_bf16 v[116:119], a[36:39], v[88:91], v[116:119]
    v_mfma_f32_16x16x32_bf16 v[116:119], a[52:55], v[92:95], v[116:119]
    v_mfma_f32_16x16x32_bf16 v[120:123], a[8:11], v[80:83], 0
    s_add_u32 m0, s34, 57344
    s_add_u32 s37, s87, 131072
    buffer_load_dwordx4 v232, s[44:47], s37 offen lds
    v_mfma_f32_16x16x32_bf16 v[120:123], a[24:27], v[84:87], v[120:123]
    s_add_u32 s38, s36, 0
    buffer_store_dwordx4 v[4:7], v240, s[16:19], s38 offen offset:2048 sc1
    v_mfma_f32_16x16x32_bf16 v[120:123], a[40:43], v[88:91], v[120:123]
    v_mfma_f32_16x16x32_bf16 v[120:123], a[56:59], v[92:95], v[120:123]
    v_mfma_f32_16x16x32_bf16 v[124:127], a[12:15], v[80:83], 0
    buffer_load_dwordx4 v233, s[44:47], s37 offen offset:1024 lds
    v_mfma_f32_16x16x32_bf16 v[124:127], a[28:31], v[84:87], v[124:127]
    v_mfma_f32_16x16x32_bf16 v[124:127], a[44:47], v[88:91], v[124:127]
    v_mfma_f32_16x16x32_bf16 v[124:127], a[60:63], v[92:95], v[124:127]
    s_waitcnt lgkmcnt(0)
    v_mfma_f32_16x16x32_bf16 v[128:131], a[0:3], v[64:67], 0
    ds_read_b128 v[80:83], v224 offset:6144
    v_mfma_f32_16x16x32_bf16 v[128:131], a[16:19], v[68:71], v[128:131]
    ds_read_b128 v[84:87], v225 offset:6144
    v_mfma_f32_16x16x32_bf16 v[128:131], a[32:35], v[72:75], v[128:131]
    ds_read_b128 v[88:91], v224 offset:14336
    v_mfma_f32_16x16x32_bf16 v[128:131], a[48:51], v[76:79], v[128:131]
    ds_read_b128 v[92:95], v225 offset:14336
    v_mfma_f32_16x16x32_bf16 v[132:135], a[4:7], v[64:67], 0
    v_mfma_f32_16x16x32_bf16 v[132:135], a[20:23], v[68:71], v[132:135]
    v_mfma_f32_16x16x32_bf16 v[132:135], a[36:39], v[72:75], v[132:135]
    v_mfma_f32_16x16x32_bf16 v[132:135], a[52:55], v[76:79], v[132:135]
    v_mfma_f32_16x16x32_bf16 v[136:139], a[8:11], v[64:67], 0
    s_waitcnt vmcnt(15)
    v_readfirstlane_b32 s24, v254
    s_lshl_b32 s25, s3, 16
    s_add_u32 s24, s24, s25
    s_cmp_ge_u32 s24, 1
    s_cbranch_scc0 kf_spin31
kf_spinr32:
    v_mfma_f32_16x16x32_bf16 v[136:139], a[24:27], v[68:71], v[136:139]
    v_mfma_f32_16x16x32_bf16 v[136:139], a[40:43], v[72:75], v[136:139]
    v_mfma_f32_16x16x32_bf16 v[136:139], a[56:59], v[76:79], v[136:139]
    v_mfma_f32_16x16x32_bf16 v[140:143], a[12:15], v[64:67], 0
    s_add_u32 s88, s20, 0x14a0000
    s_addc_u32 s89, s21, 0
    s_mov_b32 s90, 20480
    v_mfma_f32_16x16x32_bf16 v[140:143], a[28:31], v[68:71], v[140:143]
    v_mfma_f32_16x16x32_bf16 v[140:143], a[44:47], v[72:75], v[140:143]
    v_mfma_f32_16x16x32_bf16 v[140:143], a[60:63], v[76:79], v[140:143]
    s_add_u32 s38, s36, 0
    buffer_store_dwordx4 v[8:11], v240, s[16:19], s38 offen offset:1024 sc1
    s_waitcnt vmcnt(7) lgkmcnt(0)
    s_barrier
    v_mfma_f32_16x16x32_bf16 v[144:147], a[0:3], v[80:83], 0
    ds_read_b128 v[64:67], v224 offset:16384
    v_mfma_f32_16x16x32_bf16 v[144:147], a[16:19], v[84:87], v[144:147]
    ds_read_b128 v[68:71], v225 offset:16384
    v_mfma_f32_16x16x32_bf16 v[144:147], a[32:35], v[88:91], v[144:147]
    ds_read_b128 v[72:75], v224 offset:24576
    v_mfma_f32_16x16x32_bf16 v[144:147], a[48:51], v[92:95], v[144:147]
    ds_read_b128 v[76:79], v225 offset:24576
    v_mfma_f32_16x16x32_bf16 v[148:151], a[4:7], v[80:83], 0
    v_mfma_f32_16x16x32_bf16 v[148:151], a[20:23], v[84:87], v[148:151]
    v_mfma_f32_16x16x32_bf16 v[148:151], a[36:39], v[88:91], v[148:151]
    v_mfma_f32_16x16x32_bf16 v[148:151], a[52:55], v[92:95], v[148:151]
    v_mfma_f32_16x16x32_bf16 v[152:155], a[8:11], v[80:83], 0
    s_add_u32 m0, s34, 0
    s_add_u32 s37, s80, 196608
    buffer_load_dwordx4 v232, s[44:47], s37 offen lds
    v_mfma_f32_16x16x32_bf16 v[152:155], a[24:27], v[84:87], v[152:155]
    v_mfma_f32_16x16x32_bf16 v[152:155], a[40:43], v[88:91], v[152:155]
    buffer_load_dwordx4 v233, s[44:47], s37 offen offset:1024 lds
    v_mfma_f32_16x16x32_bf16 v[152:155], a[56:59], v[92:95], v[152:155]
    v_mfma_f32_16x16x32_bf16 v[156:159], a[12:15], v[80:83], 0
    v_mfma_f32_16x16x32_bf16 v[156:159], a[28:31], v[84:87], v[156:159]
    s_lshl_b32 s39, s5, 7
    s_add_u32 s39, s39, 8192
    buffer_atomic_add v255, v250, s[88:91], s39 offen sc1
    s_cmp_eq_u32 s3, 0
    s_cselect_b32 s39, s39, s43
    v_mfma_f32_16x16x32_bf16 v[156:159], a[44:47], v[88:91], v[156:159]
    v_mfma_f32_16x16x32_bf16 v[156:159], a[60:63], v[92:95], v[156:159]
    s_waitcnt lgkmcnt(0)
    v_mfma_f32_16x16x32_bf16 v[96:99], a[64:67], v[64:67], v[96:99]
    ds_read_b128 v[80:83], v224 offset:18432
    v_mfma_f32_16x16x32_bf16 v[96:99], a[80:83], v[68:71], v[96:99]
    ds_read_b128 v[84:87], v225 offset:18432
    v_mfma_f32_16x16x32_bf16 v[96:99], a[96:99], v[72:75], v[96:99]
    ds_read_b128 v[88:91], v224 offset:26624
    v_mfma_f32_16x16x32_bf16 v[96:99], a[112:115], v[76:79], v[96:99]
    ds_read_b128 v[92:95], v225 offset:26624
    v_mfma_f32_16x16x32_bf16 v[100:103], a[68:71], v[64:67], v[100:103]
    s_add_u32 s38, s36, 0
    buffer_store_dwordx4 v[12:15], v240, s[16:19], s38 offen offset:3072 sc1
    v_mfma_f32_16x16x32_bf16 v[100:103], a[84:87], v[68:71], v[100:103]
    v_mfma_f32_16x16x32_bf16 v[100:103], a[100:103], v[72:75], v[100:103]
    v_mfma_f32_16x16x32_bf16 v[100:103], a[116:119], v[76:79], v[100:103]
    v_mfma_f32_16x16x32_bf16 v[104:107], a[72:75], v[64:67], v[104:107]
    s_add_u32 m0, s31, 0
    s_add_u32 s24, s27, 0
    buffer_load_dwordx4 v245, s[12:15], s24 offen lds
    v_mfma_f32_16x16x32_bf16 v[104:107], a[88:91], v[68:71], v[104:107]
    v_mfma_f32_16x16x32_bf16 v[104:107], a[104:107], v[72:75], v[104:107]
    v_mfma_f32_16x16x32_bf16 v[104:107], a[120:123], v[76:79], v[104:107]
    v_mfma_f32_16x16x32_bf16 v[108:111], a[76:79], v[64:67], v[108:111]
    v_mfma_f32_16x16x32_bf16 v[108:111], a[92:95], v[68:71], v[108:111]
    v_mfma_f32_16x16x32_bf16 v[108:111], a[108:111], v[72:75], v[108:111]
    v_mfma_f32_16x16x32_bf16 v[108:111], a[124:127], v[76:79], v[108:111]
    s_waitcnt lgkmcnt(0)
    v_mfma_f32_16x16x32_bf16 v[112:115], a[64:67], v[80:83], v[112:115]
    ds_read_b128 v[64:67], v224 offset:20480
    v_mfma_f32_16x16x32_bf16 v[112:115], a[80:83], v[84:87], v[112:115]
    ds_read_b128 v[68:71], v225 offset:20480
    v_mfma_f32_16x16x32_bf16 v[112:115], a[96:99], v[88:91], v[112:115]
    ds_read_b128 v[72:75], v224 offset:28672
    v_mfma_f32_16x16x32_bf16 v[112:115], a[112:115], v[92:95], v[112:115]
    ds_read_b128 v[76:79], v225 offset:28672
    v_mfma_f32_16x16x32_bf16 v[116:119], a[68:71], v[80:83], v[116:119]
    v_mfma_f32_16x16x32_bf16 v[116:119], a[84:87], v[84:87], v[116:119]
    v_mfma_f32_16x16x32_bf16 v[116:119], a[100:103], v[88:91], v[116:119]
    v_mfma_f32_16x16x32_bf16 v[116:119], a[116:119], v[92:95], v[116:119]
    v_mfma_f32_16x16x32_bf16 v[120:123], a[72:75], v[80:83], v[120:123]
    s_add_u32 m0, s34, 8192
    s_add_u32 s37, s81, 196608
    buffer_load_dwordx4 v232, s[44:47], s37 offen lds
    v_mfma_f32_16x16x32_bf16 v[120:123], a[88:91], v[84:87], v[120:123]
    v_mfma_f32_16x16x32_bf16 v[120:123], a[104:107], v[88:91], v[120:123]
    buffer_load_dwordx4 v233, s[44:47], s37 offen offset:1024 lds
    s_add_u32 s38, s36, 8192
    buffer_store_dwordx4 v[16:19], v240, s[16:19], s38 offen offset:0 sc1
    v_mfma_f32_16x16x32_bf16 v[120:123], a[120:123], v[92:95], v[120:123]
    v_mfma_f32_16x16x32_bf16 v[124:127], a[76:79], v[80:83], v[124:127]
    v_mfma_f32_16x16x32_bf16 v[124:127], a[92:95], v[84:87], v[124:127]
    s_add_u32 m0, s31, 1024
    s_add_u32 s24, s27, 32768
    buffer_load_dwordx4 v245, s[12:15], s24 offen lds
    v_mfma_f32_16x16x32_bf16 v[124:127], a[108:111], v[88:91], v[124:127]
    v_mfma_f32_16x16x32_bf16 v[124:127], a[124:127], v[92:95], v[124:127]
    s_waitcnt lgkmcnt(0)
    v_mfma_f32_16x16x32_bf16 v[128:131], a[64:67], v[64:67], v[128:131]
    ds_read_b128 v[80:83], v224 offset:22528
    v_mfma_f32_16x16x32_bf16 v[128:131], a[80:83], v[68:71], v[128:131]
    ds_read_b128 v[84:87], v225 offset:22528
    v_mfma_f32_16x16x32_bf16 v[128:131], a[96:99], v[72:75], v[128:131]
    ds_read_b128 v[88:91], v224 offset:30720
    v_mfma_f32_16x16x32_bf16 v[128:131], a[112:115], v[76:79], v[128:131]
    ds_read_b128 v[92:95], v225 offset:30720
    v_mfma_f32_16x16x32_bf16 v[132:135], a[68:71], v[64:67], v[132:135]
    v_mfma_f32_16x16x32_bf16 v[132:135], a[84:87], v[68:71], v[132:135]
    v_mfma_f32_16x16x32_bf16 v[132:135], a[100:103], v[72:75], v[132:135]
    v_mfma_f32_16x16x32_bf16 v[132:135], a[116:119], v[76:79], v[132:135]
    v_mfma_f32_16x16x32_bf16 v[136:139], a[72:75], v[64:67], v[136:139]
    s_add_u32 m0, s31, 2048
    s_add_u32 s24, s27, 65536
    buffer_load_dwordx4 v237, s[12:15], s24 offen lds
    v_mfma_f32_16x16x32_bf16 v[136:139], a[88:91], v[68:71], v[136:139]
    v_mfma_f32_16x16x32_bf16 v[136:139], a[104:107], v[72:75], v[136:139]
    v_mfma_f32_16x16x32_bf16 v[136:139], a[120:123], v[76:79], v[136:139]
    v_mfma_f32_16x16x32_bf16 v[140:143], a[76:79], v[64:67], v[140:143]
    v_mfma_f32_16x16x32_bf16 v[140:143], a[92:95], v[68:71], v[140:143]
    v_mfma_f32_16x16x32_bf16 v[140:143], a[108:111], v[72:75], v[140:143]
    v_mfma_f32_16x16x32_bf16 v[140:143], a[124:127], v[76:79], v[140:143]
    s_add_u32 s38, s36, 8192
    buffer_store_dwordx4 v[20:23], v240, s[16:19], s38 offen offset:2048 sc1
    s_waitcnt vmcnt(19) lgkmcnt(0)
    s_barrier
    v_mfma_f32_16x16x32_bf16 v[144:147], a[64:67], v[80:83], v[144:147]
    ds_read_b128 v[64:67], v224 offset:32768
    v_mfma_f32_16x16x32_bf16 v[144:147], a[80:83], v[84:87], v[144:147]
    ds_read_b128 v[68:71], v225 offset:32768
    v_mfma_f32_16x16x32_bf16 v[144:147], a[96:99], v[88:91], v[144:147]
    ds_read_b128 v[72:75], v224 offset:40960
    v_mfma_f32_16x16x32_bf16 v[144:147], a[112:115], v[92:95], v[144:147]
    ds_read_b128 v[76:79], v225 offset:40960
    v_mfma_f32_16x16x32_bf16 v[148:151], a[68:71], v[80:83], v[148:151]
    v_mfma_f32_16x16x32_bf16 v[148:151], a[84:87], v[84:87], v[148:151]
    v_mfma_f32_16x16x32_bf16 v[148:151], a[100:103], v[88:91], v[148:151]
    v_mfma_f32_16x16x32_bf16 v[148:151], a[116:119], v[92:95], v[148:151]
    v_mfma_f32_16x16x32_bf16 v[152:155], a[72:75], v[80:83], v[152:155]
    s_add_u32 m0, s34, 16384
    s_add_u32 s37, s82, 196608
    buffer_load_dwordx4 v232, s[44:47], s37 offen lds
    v_mfma_f32_16x16x32_bf16 v[152:155], a[88:91], v[84:87], v[152:155]
    v_mfma_f32_16x16x32_bf16 v[152:155], a[104:107], v[88:91], v[152:155]
    buffer_load_dwordx4 v233, s[44:47], s37 offen offset:1024 lds
    v_mfma_f32_16x16x32_bf16 v[152:155], a[120:123], v[92:95], v[152:155]
    v_mfma_f32_16x16x32_bf16 v[156:159], a[76:79], v[80:83], v[156:159]
    v_mfma_f32_16x16x32_bf16 v[156:159], a[92:95], v[84:87], v[156:159]
    s_add_u32 m0, s31, 3072
    s_add_u32 s24, s27, 98304
    buffer_load_dwordx4 v237, s[12:15], s24 offen lds
    v_mfma_f32_16x16x32_bf16 v[156:159], a[108:111], v[88:91], v[156:159]
    v_mfma_f32_16x16x32_bf16 v[156:159], a[124:127], v[92:95], v[156:159]
    s_waitcnt lgkmcnt(0)
    v_mfma_f32_16x16x32_bf16 v[96:99], a[128:131], v[64:67], v[96:99]
    ds_read_b128 v[80:83], v224 offset:34816
    v_mfma_f32_16x16x32_bf16 v[96:99], a[144:147], v[68:71], v[96:99]
    ds_read_b128 v[84:87], v225 offset:34816
    v_mfma_f32_16x16x32_bf16 v[96:99], a[160:163], v[72:75], v[96:99]
    ds_read_b128 v[88:91], v224 offset:43008
    v_mfma_f32_16x16x32_bf16 v[96:99], a[176:179], v[76:79], v[96:99]
    ds_read_b128 v[92:95], v225 offset:43008
    v_mfma_f32_16x16x32_bf16 v[100:103], a[132:135], v[64:67], v[100:103]
    v_mfma_f32_16x16x32_bf16 v[100:103], a[148:151], v[68:71], v[100:103]
    s_add_u32 s38, s36, 8192
    buffer_store_dwordx4 v[24:27], v240, s[16:19], s38 offen offset:1024 sc1
    v_mfma_f32_16x16x32_bf16 v[100:103], a[164:167], v[72:75], v[100:103]
    v_mfma_f32_16x16x32_bf16 v[100:103], a[180:183], v[76:79], v[100:103]
    v_mfma_f32_16x16x32_bf16 v[104:107], a[136:139], v[64:67], v[104:107]
    s_add_u32 m0, s31, 4096
    s_add_u32 s24, s27, 131072
    buffer_load_dwordx4 v245, s[12:15], s24 offen lds
    v_mfma_f32_16x16x32_bf16 v[104:107], a[152:155], v[68:71], v[104:107]
    v_mfma_f32_16x16x32_bf16 v[104:107], a[168:171], v[72:75], v[104:107]
    v_mfma_f32_16x16x32_bf16 v[104:107], a[184:187], v[76:79], v[104:107]
    v_mfma_f32_16x16x32_bf16 v[108:111], a[140:143], v[64:67], v[108:111]
    v_mfma_f32_16x16x32_bf16 v[108:111], a[156:159], v[68:71], v[108:111]
    v_mfma_f32_16x16x32_bf16 v[108:111], a[172:175], v[72:75], v[108:111]
    v_mfma_f32_16x16x32_bf16 v[108:111], a[188:191], v[76:79], v[108:111]
    s_waitcnt lgkmcnt(0)
    v_mfma_f32_16x16x32_bf16 v[112:115], a[128:131], v[80:83], v[112:115]
    ds_read_b128 v[64:67], v224 offset:36864
    v_mfma_f32_16x16x32_bf16 v[112:115], a[144:147], v[84:87], v[112:115]
    ds_read_b128 v[68:71], v225 offset:36864
    v_mfma_f32_16x16x32_bf16 v[112:115], a[160:163], v[88:91], v[112:115]
    ds_read_b128 v[72:75], v224 offset:45056
    v_mfma_f32_16x16x32_bf16 v[112:115], a[176:179], v[92:95], v[112:115]
    ds_read_b128 v[76:79], v225 offset:45056
    v_mfma_f32_16x16x32_bf16 v[116:119], a[132:135], v[80:83], v[116:119]
    v_mfma_f32_16x16x32_bf16 v[116:119], a[148:151], v[84:87], v[116:119]
    v_mfma_f32_16x16x32_bf16 v[116:119], a[164:167], v[88:91], v[116:119]
    v_mfma_f32_16x16x32_bf16 v[116:119], a[180:183], v[92:95], v[116:119]
    v_mfma_f32_16x16x32_bf16 v[120:123], a[136:139], v[80:83], v[120:123]
    s_add_u32 m0, s34, 24576
    s_add_u32 s37, s83, 196608
    buffer_load_dwordx4 v232, s[44:47], s37 offen lds
    v_mfma_f32_16x16x32_bf16 v[120:123], a[152:155], v[84:87], v[120:123]
    v_mfma_f32_16x16x32_bf16 v[120:123], a[168:171], v[88:91], v[120:123]
    buffer_load_dwordx4 v233, s[44:47], s37 offen offset:1024 lds
    s_add_u32 s38, s36, 8192
    buffer_store_dwordx4 v[28:31], v240, s[16:19], s38 offen offset:3072 sc1
    v_mfma_f32_16x16x32_bf16 v[120:123], a[184:187], v[92:95], v[120:123]
    v_mfma_f32_16x16x32_bf16 v[124:127], a[140:143], v[80:83], v[124:127]
    v_mfma_f32_16x16x32_bf16 v[124:127], a[156:159], v[84:87], v[124:127]
    s_add_u32 m0, s31, 5120
    s_add_u32 s24, s27, 163840
    buffer_load_dwordx4 v245, s[12:15], s24 offen lds
    v_mfma_f32_16x16x32_bf16 v[124:127], a[172:175], v[88:91], v[124:127]
    v_mfma_f32_16x16x32_bf16 v[124:127], a[188:191], v[92:95], v[124:127]
    s_waitcnt lgkmcnt(0)
    v_mfma_f32_16x16x32_bf16 v[128:131], a[128:131], v[64:67], v[128:131]
    ds_read_b128 v[80:83], v224 offset:38912
    v_mfma_f32_16x16x32_bf16 v[128:131], a[144:147], v[68:71], v[128:131]
    ds_read_b128 v[84:87], v225 offset:38912
    v_mfma_f32_16x16x32_bf16 v[128:131], a[160:163], v[72:75], v[128:131]
    ds_read_b128 v[88:91], v224 offset:47104
    v_mfma_f32_16x16x32_bf16 v[128:131], a[176:179], v[76:79], v[128:131]
    ds_read_b128 v[92:95], v225 offset:47104
    v_mfma_f32_16x16x32_bf16 v[132:135], a[132:135], v[64:67], v[132:135]
    v_mfma_f32_16x16x32_bf16 v[132:135], a[148:151], v[68:71], v[132:135]
    v_mfma_f32_16x16x32_bf16 v[132:135], a[164:167], v[72:75], v[132:135]
    v_mfma_f32_16x16x32_bf16 v[132:135], a[180:183], v[76:79], v[132:135]
    v_mfma_f32_16x16x32_bf16 v[136:139], a[136:139], v[64:67], v[136:139]
    s_add_u32 m0, s31, 6144
    s_add_u32 s24, s27, 196608
    buffer_load_dwordx4 v237, s[12:15], s24 offen lds
    v_mfma_f32_16x16x32_bf16 v[136:139], a[152:155], v[68:71], v[136:139]
    v_mfma_f32_16x16x32_bf16 v[136:139], a[168:171], v[72:75], v[136:139]
    v_mfma_f32_16x16x32_bf16 v[136:139], a[184:187], v[76:79], v[136:139]
    v_mfma_f32_16x16x32_bf16 v[140:143], a[140:143], v[64:67], v[140:143]
    v_mfma_f32_16x16x32_bf16 v[140:143], a[156:159], v[68:71], v[140:143]
    v_mfma_f32_16x16x32_bf16 v[140:143], a[172:175], v[72:75], v[140:143]
    v_mfma_f32_16x16x32_bf16 v[140:143], a[188:191], v[76:79], v[140:143]
    s_waitcnt vmcnt(22) lgkmcnt(0)
    s_barrier
    v_mfma_f32_16x16x32_bf16 v[144:147], a[128:131], v[80:83], v[144:147]
    ds_read_b128 v[64:67], v224 offset:49152
    s_add_u32 s38, s36, 32768
    buffer_store_dwordx4 v[32:35], v240, s[16:19], s38 offen offset:1280 sc1
    v_mfma_f32_16x16x32_bf16 v[144:147], a[144:147], v[84:87], v[144:147]
    ds_read_b128 v[68:71], v225 offset:49152
    v_mfma_f32_16x16x32_bf16 v[144:147], a[160:163], v[88:91], v[144:147]
    ds_read_b128 v[72:75], v224 offset:57344
    v_mfma_f32_16x16x32_bf16 v[144:147], a[176:179], v[92:95], v[144:147]
    ds_read_b128 v[76:79], v225 offset:57344
    v_mfma_f32_16x16x32_bf16 v[148:151], a[132:135], v[80:83], v[148:151]
    v_mfma_f32_16x16x32_bf16 v[148:151], a[148:151], v[84:87], v[148:151]
    v_mfma_f32_16x16x32_bf16 v[148:151], a[164:167], v[88:91], v[148:151]
    v_mfma_f32_16x16x32_bf16 v[148:151], a[180:183], v[92:95], v[148:151]
    v_mfma_f32_16x16x32_bf16 v[152:155], a[136:139], v[80:83], v[152:155]
    s_add_u32 m0, s34, 32768
    s_add_u32 s37, s84, 196608
    buffer_load_dwordx4 v232, s[44:47], s37 offen lds
    v_mfma_f32_16x16x32_bf16 v[152:155], a[152:155], v[84:87], v[152:155]
    buffer_load_dwordx4 v233, s[44:47], s37 offen offset:1024 lds
    v_mfma_f32_16x16x32_bf16 v[152:155], a[168:171], v[88:91], v[152:155]
    v_mfma_f32_16x16x32_bf16 v[152:155], a[184:187], v[92:95], v[152:155]
    s_add_u32 m0, s31, 7168
    s_add_u32 s24, s27, 229376
    buffer_load_dwordx4 v237, s[12:15], s24 offen lds
    v_mfma_f32_16x16x32_bf16 v[156:159], a[140:143], v[80:83], v[156:159]
    s_add_u32 s27, s27, 1048576
    s_and_b32 s27, s27, 0x407fffff
    s_cmp_eq_u32 s27, s7
    s_cselect_b32 s27, s43, s27
    v_mfma_f32_16x16x32_bf16 v[156:159], a[156:159], v[84:87], v[156:159]
    v_mfma_f32_16x16x32_bf16 v[156:159], a[172:175], v[88:91], v[156:159]
    s_add_u32 s31, s31, 32768
    s_cmp_ge_u32 s31, 163840
    s_cselect_b32 s24, 98304, 0
    s_sub_u32 s31, s31, s24
    v_mfma_f32_16x16x32_bf16 v[156:159], a[188:191], v[92:95], v[156:159]
    s_waitcnt lgkmcnt(0)
    v_mfma_f32_16x16x32_bf16 v[96:99], a[192:195], v[64:67], v[96:99]
    ds_read_b128 v[80:83], v224 offset:51200
    v_mfma_f32_16x16x32_bf16 v[96:99], a[208:211], v[68:71], v[96:99]
    ds_read_b128 v[84:87], v225 offset:51200
    v_mfma_f32_16x16x32_bf16 v[96:99], a[224:227], v[72:75], v[96:99]
    ds_read_b128 v[88:91], v224 offset:59392
    v_mfma_f32_16x16x32_bf16 v[96:99], a[240:243], v[76:79], v[96:99]
    ds_read_b128 v[92:95], v225 offset:59392
    v_mfma_f32_16x16x32_bf16 v[100:103], a[196:199], v[64:67], v[100:103]
    v_mfma_f32_16x16x32_bf16 v[100:103], a[212:215], v[68:71], v[100:103]
    v_mfma_f32_16x16x32_bf16 v[100:103], a[228:231], v[72:75], v[100:103]
    s_add_u32 s38, s36, 32768
    buffer_store_dwordx4 v[36:39], v240, s[16:19], s38 offen offset:3328 sc1
    v_mfma_f32_16x16x32_bf16 v[100:103], a[244:247], v[76:79], v[100:103]
    v_mfma_f32_16x16x32_bf16 v[104:107], a[200:203], v[64:67], v[104:107]
    v_mfma_f32_16x16x32_bf16 v[104:107], a[216:219], v[68:71], v[104:107]
    v_mfma_f32_16x16x32_bf16 v[104:107], a[232:235], v[72:75], v[104:107]
    v_mfma_f32_16x16x32_bf16 v[104:107], a[248:251], v[76:79], v[104:107]
    v_mfma_f32_16x16x32_bf16 v[108:111], a[204:207], v[64:67], v[108:111]
    v_mfma_f32_16x16x32_bf16 v[108:111], a[220:223], v[68:71], v[108:111]
    v_mfma_f32_16x16x32_bf16 v[108:111], a[236:239], v[72:75], v[108:111]
    v_mfma_f32_16x16x32_bf16 v[108:111], a[252:255], v[76:79], v[108:111]
    s_waitcnt lgkmcnt(0)
    v_mfma_f32_16x16x32_bf16 v[112:115], a[192:195], v[80:83], v[112:115]
    ds_read_b128 v[64:67], v224 offset:53248
    v_mfma_f32_16x16x32_bf16 v[112:115], a[208:211], v[84:87], v[112:115]
    ds_read_b128 v[68:71], v225 offset:53248
    v_mfma_f32_16x16x32_bf16 v[112:115], a[224:227], v[88:91], v[112:115]
    ds_read_b128 v[72:75], v224 offset:61440
    v_mfma_f32_16x16x32_bf16 v[112:115], a[240:243], v[92:95], v[112:115]
    ds_read_b128 v[76:79], v225 offset:61440
    v_mfma_f32_16x16x32_bf16 v[116:119], a[196:199], v[80:83], v[116:119]
    v_mfma_f32_16x16x32_bf16 v[116:119], a[212:215], v[84:87], v[116:119]
    v_mfma_f32_16x16x32_bf16 v[116:119], a[228:231], v[88:91], v[116:119]
    v_mfma_f32_16x16x32_bf16 v[116:119], a[244:247], v[92:95], v[116:119]
    v_mfma_f32_16x16x32_bf16 v[120:123], a[200:203], v[80:83], v[120:123]
    s_add_u32 m0, s34, 40960
    s_add_u32 s37, s85, 196608
    buffer_load_dwordx4 v232, s[44:47], s37 offen lds
    v_mfma_f32_16x16x32_bf16 v[120:123], a[216:219], v[84:87], v[120:123]
    v_mfma_f32_16x16x32_bf16 v[120:123], a[232:235], v[88:91], v[120:123]
    v_mfma_f32_16x16x32_bf16 v[120:123], a[248:251], v[92:95], v[120:123]
    s_add_u32 s38, s36, 32768
    buffer_store_dwordx4 v[40:43], v240, s[16:19], s38 offen offset:2304 sc1
    v_mfma_f32_16x16x32_bf16 v[124:127], a[204:207], v[80:83], v[124:127]
    buffer_load_dwordx4 v233, s[44:47], s37 offen offset:1024 lds
    v_mfma_f32_16x16x32_bf16 v[124:127], a[220:223], v[84:87], v[124:127]
    v_mfma_f32_16x16x32_bf16 v[124:127], a[236:239], v[88:91], v[124:127]
    v_mfma_f32_16x16x32_bf16 v[124:127], a[252:255], v[92:95], v[124:127]
    s_waitcnt lgkmcnt(0)
    v_mfma_f32_16x16x32_bf16 v[128:131], a[192:195], v[64:67], v[128:131]
    ds_read_b128 v[80:83], v224 offset:55296
    v_mfma_f32_16x16x32_bf16 v[128:131], a[208:211], v[68:71], v[128:131]
    ds_read_b128 v[84:87], v225 offset:55296
    v_mfma_f32_16x16x32_bf16 v[128:131], a[224:227], v[72:75], v[128:131]
    ds_read_b128 v[88:91], v224 offset:63488
    v_mfma_f32_16x16x32_bf16 v[128:131], a[240:243], v[76:79], v[128:131]
    ds_read_b128 v[92:95], v225 offset:63488
    v_mfma_f32_16x16x32_bf16 v[132:135], a[196:199], v[64:67], v[132:135]
    v_mfma_f32_16x16x32_bf16 v[132:135], a[212:215], v[68:71], v[132:135]
    v_mfma_f32_16x16x32_bf16 v[132:135], a[228:231], v[72:75], v[132:135]
    v_mfma_f32_16x16x32_bf16 v[132:135], a[244:247], v[76:79], v[132:135]
    v_mfma_f32_16x16x32_bf16 v[136:139], a[200:203], v[64:67], v[136:139]
    s_add_u32 m0, s31, 0
    s_add_u32 s24, s27, 0
    buffer_load_dwordx4 v245, s[12:15], s24 offen lds
    v_mfma_f32_16x16x32_bf16 v[136:139], a[216:219], v[68:71], v[136:139]
    v_mfma_f32_16x16x32_bf16 v[136:139], a[232:235], v[72:75], v[136:139]
    v_mfma_f32_16x16x32_bf16 v[136:139], a[248:251], v[76:79], v[136:139]
    v_mfma_f32_16x16x32_bf16 v[140:143], a[204:207], v[64:67], v[140:143]
    v_mfma_f32_16x16x32_bf16 v[140:143], a[220:223], v[68:71], v[140:143]
    v_mfma_f32_16x16x32_bf16 v[140:143], a[236:239], v[72:75], v[140:143]
    v_mfma_f32_16x16x32_bf16 v[140:143], a[252:255], v[76:79], v[140:143]
    s_waitcnt vmcnt(23) lgkmcnt(0)
    s_barrier
    v_mfma_f32_16x16x32_bf16 v[144:147], a[192:195], v[80:83], v[144:147]
    ds_read_b128 v[64:67], v224 offset:0
    v_mfma_f32_16x16x32_bf16 v[144:147], a[208:211], v[84:87], v[144:147]
    ds_read_b128 v[68:71], v225 offset:0
    s_add_u32 s38, s36, 36864
    buffer_store_dwordx4 v[44:47], v240, s[16:19], s38 offen offset:256 sc1
    v_mfma_f32_16x16x32_bf16 v[144:147], a[224:227], v[88:91], v[144:147]
    ds_read_b128 v[72:75], v224 offset:8192
    v_mfma_f32_16x16x32_bf16 v[144:147], a[240:243], v[92:95], v[144:147]
    ds_read_b128 v[76:79], v225 offset:8192
    v_mfma_f32_16x16x32_bf16 v[148:151], a[196:199], v[80:83], v[148:151]
    v_mfma_f32_16x16x32_bf16 v[148:151], a[212:215], v[84:87], v[148:151]
    v_mfma_f32_16x16x32_bf16 v[148:151], a[228:231], v[88:91], v[148:151]
    v_mfma_f32_16x16x32_bf16 v[148:151], a[244:247], v[92:95], v[148:151]
    v_mfma_f32_16x16x32_bf16 v[152:155], a[200:203], v[80:83], v[152:155]
    s_add_u32 m0, s34, 49152
    s_add_u32 s37, s86, 196608
    buffer_load_dwordx4 v232, s[44:47], s37 offen lds
    v_mfma_f32_16x16x32_bf16 v[152:155], a[216:219], v[84:87], v[152:155]
    v_mfma_f32_16x16x32_bf16 v[152:155], a[232:235], v[88:91], v[152:155]
    buffer_load_dwordx4 v233, s[44:47], s37 offen offset:1024 lds
    v_mfma_f32_16x16x32_bf16 v[152:155], a[248:251], v[92:95], v[152:155]
    v_mfma_f32_16x16x32_bf16 v[156:159], a[204:207], v[80:83], v[156:159]
    v_mfma_f32_16x16x32_bf16 v[156:159], a[220:223], v[84:87], v[156:159]
    s_add_u32 m0, s31, 1024
    s_add_u32 s24, s27, 32768
    buffer_load_dwordx4 v245, s[12:15], s24 offen lds
    v_mfma_f32_16x16x32_bf16 v[156:159], a[236:239], v[88:91], v[156:159]
    v_mfma_f32_16x16x32_bf16 v[156:159], a[252:255], v[92:95], v[156:159]
    s_waitcnt lgkmcnt(0)
    v_mfma_f32_16x16x32_bf16 v[160:163], a[0:3], v[64:67], 0
    ds_read_b128 v[80:83], v224 offset:2048
    v_mfma_f32_16x16x32_bf16 v[160:163], a[16:19], v[68:71], v[160:163]
    ds_read_b128 v[84:87], v225 offset:2048
    v_mfma_f32_16x16x32_bf16 v[160:163], a[32:35], v[72:75], v[160:163]
    ds_read_b128 v[88:91], v224 offset:10240
    v_mfma_f32_16x16x32_bf16 v[160:163], a[48:51], v[76:79], v[160:163]
    ds_read_b128 v[92:95], v225 offset:10240
    v_mfma_f32_16x16x32_bf16 v[164:167], a[4:7], v[64:67], 0
    v_cvt_pk_bf16_f32 v0, v96, v97
    v_cvt_pk_bf16_f32 v1, v98, v99
    v_mfma_f32_16x16x32_bf16 v[164:167], a[20:23], v[68:71], v[164:167]
    v_mfma_f32_16x16x32_bf16 v[164:167], a[36:39], v[72:75], v[164:167]
    v_cvt_pk_bf16_f32 v2, v100, v101
    v_cvt_pk_bf16_f32 v3, v102, v103
    s_add_u32 s38, s36, 40960
    buffer_store_dwordx4 v[48:51], v240, s[16:19], s38 offen offset:1280 sc1
    v_mfma_f32_16x16x32_bf16 v[164:167], a[52:55], v[76:79], v[164:167]
    v_mfma_f32_16x16x32_bf16 v[168:171], a[8:11], v[64:67], 0
    s_add_u32 m0, s31, 2048
    s_add_u32 s24, s27, 65536
    buffer_load_dwordx4 v237, s[12:15], s24 offen lds
    v_cvt_pk_bf16_f32 v4, v104, v105
    v_cvt_pk_bf16_f32 v5, v106, v107
    v_mfma_f32_16x16x32_bf16 v[168:171], a[24:27], v[68:71], v[168:171]
    v_mfma_f32_16x16x32_bf16 v[168:171], a[40:43], v[72:75], v[168:171]
    v_cvt_pk_bf16_f32 v6, v108, v109
    v_cvt_pk_bf16_f32 v7, v110, v111
    v_mfma_f32_16x16x32_bf16 v[168:171], a[56:59], v[76:79], v[168:171]
    v_mfma_f32_16x16x32_bf16 v[172:175], a[12:15], v[64:67], 0
    v_cvt_pk_bf16_f32 v8, v112, v113
    v_cvt_pk_bf16_f32 v9, v114, v115
    v_mfma_f32_16x16x32_bf16 v[172:175], a[28:31], v[68:71], v[172:175]
    v_mfma_f32_16x16x32_bf16 v[172:175], a[44:47], v[72:75], v[172:175]
    v_cvt_pk_bf16_f32 v10, v116, v117
    v_cvt_pk_bf16_f32 v11, v118, v119
    v_mfma_f32_16x16x32_bf16 v[172:175], a[60:63], v[76:79], v[172:175]
    s_waitcnt lgkmcnt(0)
    v_mfma_f32_16x16x32_bf16 v[176:179], a[0:3], v[80:83], 0
    ds_read_b128 v[64:67], v224 offset:4096
    v_cvt_pk_bf16_f32 v12, v120, v121
    v_cvt_pk_bf16_f32 v13, v122, v123
    v_mfma_f32_16x16x32_bf16 v[176:179], a[16:19], v[84:87], v[176:179]
    ds_read_b128 v[68:71], v225 offset:4096
    v_mfma_f32_16x16x32_bf16 v[176:179], a[32:35], v[88:91], v[176:179]
    ds_read_b128 v[72:75], v224 offset:12288
    v_cvt_pk_bf16_f32 v14, v124, v125
    v_cvt_pk_bf16_f32 v15, v126, v127
    v_mfma_f32_16x16x32_bf16 v[176:179], a[48:51], v[92:95], v[176:179]
    ds_read_b128 v[76:79], v225 offset:12288
    v_mfma_f32_16x16x32_bf16 v[180:183], a[4:7], v[80:83], 0
    v_cvt_pk_bf16_f32 v16, v128, v129
    v_cvt_pk_bf16_f32 v17, v130, v131
    v_mfma_f32_16x16x32_bf16 v[180:183], a[20:23], v[84:87], v[180:183]
    v_mfma_f32_16x16x32_bf16 v[180:183], a[36:39], v[88:91], v[180:183]
    v_cvt_pk_bf16_f32 v18, v132, v133
    v_cvt_pk_bf16_f32 v19, v134, v135
    v_mfma_f32_16x16x32_bf16 v[180:183], a[52:55], v[92:95], v[180:183]
    v_mfma_f32_16x16x32_bf16 v[184:187], a[8:11], v[80:83], 0
    s_add_u32 m0, s34, 57344
    s_add_u32 s37, s87, 196608
    buffer_load_dwordx4 v232, s[44:47], s37 offen lds
    v_cvt_pk_bf16_f32 v20, v136, v137
    v_cvt_pk_bf16_f32 v21, v138, v139
    v_mfma_f32_16x16x32_bf16 v[184:187], a[24:27], v[84:87], v[184:187]
    v_mfma_f32_16x16x32_bf16 v[184:187], a[40:43], v[88:91], v[184:187]
    buffer_load_dwordx4 v233, s[44:47], s37 offen offset:1024 lds
    v_cvt_pk_bf16_f32 v22, v140, v141
    v_cvt_pk_bf16_f32 v23, v142, v143
    v_mfma_f32_16x16x32_bf16 v[184:187], a[56:59], v[92:95], v[184:187]
    v_mfma_f32_16x16x32_bf16 v[188:191], a[12:15], v[80:83], 0
    v_cvt_pk_bf16_f32 v24, v144, v145
    v_cvt_pk_bf16_f32 v25, v146, v147
    s_add_u32 s38, s36, 40960
    buffer_store_dwordx4 v[52:55], v240, s[16:19], s38 offen offset:3328 sc1
    v_mfma_f32_16x16x32_bf16 v[188:191], a[28:31], v[84:87], v[188:191]
    s_add_u32 m0, s31, 3072
    s_add_u32 s24, s27, 98304
    buffer_load_dwordx4 v237, s[12:15], s24 offen lds
    v_mfma_f32_16x16x32_bf16 v[188:191], a[44:47], v[88:91], v[188:191]
    v_cvt_pk_bf16_f32 v26, v148, v149
    v_cvt_pk_bf16_f32 v27, v150, v151
    v_mfma_f32_16x16x32_bf16 v[188:191], a[60:63], v[92:95], v[188:191]
    s_waitcnt lgkmcnt(0)
    v_mfma_f32_16x16x32_bf16 v[192:195], a[0:3], v[64:67], 0
    ds_read_b128 v[80:83], v224 offset:6144
    v_cvt_pk_bf16_f32 v28, v152, v153
    v_cvt_pk_bf16_f32 v29, v154, v155
    v_mfma_f32_16x16x32_bf16 v[192:195], a[16:19], v[68:71], v[192:195]
    ds_read_b128 v[84:87], v225 offset:6144
    v_mfma_f32_16x16x32_bf16 v[192:195], a[32:35], v[72:75], v[192:195]
    ds_read_b128 v[88:91], v224 offset:14336
    v_cvt_pk_bf16_f32 v30, v156, v157
    v_cvt_pk_bf16_f32 v31, v158, v159
    v_mfma_f32_16x16x32_bf16 v[192:195], a[48:51], v[76:79], v[192:195]
    ds_read_b128 v[92:95], v225 offset:14336
    v_mfma_f32_16x16x32_bf16 v[196:199], a[4:7], v[64:67], 0
    v_mfma_f32_16x16x32_bf16 v[196:199], a[20:23], v[68:71], v[196:199]
    v_mfma_f32_16x16x32_bf16 v[196:199], a[36:39], v[72:75], v[196:199]
    v_mfma_f32_16x16x32_bf16 v[196:199], a[52:55], v[76:79], v[196:199]
    v_mfma_f32_16x16x32_bf16 v[200:203], a[8:11], v[64:67], 0
    s_add_u32 m0, s31, 4096
    s_add_u32 s24, s27, 131072
    buffer_load_dwordx4 v245, s[12:15], s24 offen lds
    v_mfma_f32_16x16x32_bf16 v[200:203], a[24:27], v[68:71], v[200:203]
    v_mfma_f32_16x16x32_bf16 v[200:203], a[40:43], v[72:75], v[200:203]
    v_mfma_f32_16x16x32_bf16 v[200:203], a[56:59], v[76:79], v[200:203]
    v_mfma_f32_16x16x32_bf16 v[204:207], a[12:15], v[64:67], 0
    v_mfma_f32_16x16x32_bf16 v[204:207], a[28:31], v[68:71], v[204:207]
    v_mfma_f32_16x16x32_bf16 v[204:207], a[44:47], v[72:75], v[204:207]
    v_mfma_f32_16x16x32_bf16 v[204:207], a[60:63], v[76:79], v[204:207]
    s_waitcnt vmcnt(23) lgkmcnt(0)
    s_barrier
    v_mfma_f32_16x16x32_bf16 v[208:211], a[0:3], v[80:83], 0
    ds_read_b128 v[64:67], v224 offset:16384
    v_mfma_f32_16x16x32_bf16 v[208:211], a[16:19], v[84:87], v[208:211]
    ds_read_b128 v[68:71], v225 offset:16384
    s_add_u32 s38, s36, 40960
    buffer_store_dwordx4 v[56:59], v240, s[16:19], s38 offen offset:2304 sc1
    v_mfma_f32_16x16x32_bf16 v[208:211], a[32:35], v[88:91], v[208:211]
    ds_read_b128 v[72:75], v224 offset:24576
    v_mfma_f32_16x16x32_bf16 v[208:211], a[48:51], v[92:95], v[208:211]
    ds_read_b128 v[76:79], v225 offset:24576
    v_mfma_f32_16x16x32_bf16 v[212:215], a[4:7], v[80:83], 0
    v_mfma_f32_16x16x32_bf16 v[212:215], a[20:23], v[84:87], v[212:215]
    v_mfma_f32_16x16x32_bf16 v[212:215], a[36:39], v[88:91], v[212:215]
    v_mfma_f32_16x16x32_bf16 v[212:215], a[52:55], v[92:95], v[212:215]
    v_mfma_f32_16x16x32_bf16 v[216:219], a[8:11], v[80:83], 0
    s_add_u32 m0, s31, 5120
    s_add_u32 s24, s27, 163840
    buffer_load_dwordx4 v245, s[12:15], s24 offen lds
    v_mfma_f32_16x16x32_bf16 v[216:219], a[24:27], v[84:87], v[216:219]
    v_mfma_f32_16x16x32_bf16 v[216:219], a[40:43], v[88:91], v[216:219]
    v_mfma_f32_16x16x32_bf16 v[216:219], a[56:59], v[92:95], v[216:219]
    v_mfma_f32_16x16x32_bf16 v[220:223], a[12:15], v[80:83], 0
    v_mfma_f32_16x16x32_bf16 v[220:223], a[28:31], v[84:87], v[220:223]
    v_mfma_f32_16x16x32_bf16 v[220:223], a[44:47], v[88:91], v[220:223]
    v_mfma_f32_16x16x32_bf16 v[220:223], a[60:63], v[92:95], v[220:223]
    s_waitcnt lgkmcnt(0)
    v_mfma_f32_16x16x32_bf16 v[160:163], a[64:67], v[64:67], v[160:163]
    ds_read_b128 v[80:83], v224 offset:18432
    v_mfma_f32_16x16x32_bf16 v[160:163], a[80:83], v[68:71], v[160:163]
    ds_read_b128 v[84:87], v225 offset:18432
    v_mfma_f32_16x16x32_bf16 v[160:163], a[96:99], v[72:75], v[160:163]
    ds_read_b128 v[88:91], v224 offset:26624
    v_mfma_f32_16x16x32_bf16 v[160:163], a[112:115], v[76:79], v[160:163]
    ds_read_b128 v[92:95], v225 offset:26624
    v_mfma_f32_16x16x32_bf16 v[164:167], a[68:71], v[64:67], v[164:167]
    v_mfma_f32_16x16x32_bf16 v[164:167], a[84:87], v[68:71], v[164:167]
    v_mfma_f32_16x16x32_bf16 v[164:167], a[100:103], v[72:75], v[164:167]
    v_mfma_f32_16x16x32_bf16 v[164:167], a[116:119], v[76:79], v[164:167]
    s_add_u32 s38, s36, 45056
    buffer_store_dwordx4 v[60:63], v240, s[16:19], s38 offen offset:256 sc1
    v_mfma_f32_16x16x32_bf16 v[168:171], a[72:75], v[64:67], v[168:171]
    s_add_u32 m0, s31, 6144
    s_add_u32 s24, s27, 196608
    buffer_load_dwordx4 v237, s[12:15], s24 offen lds
    v_mfma_f32_16x16x32_bf16 v[168:171], a[88:91], v[68:71], v[168:171]
    v_mfma_f32_16x16x32_bf16 v[168:171], a[104:107], v[72:75], v[168:171]
    v_mfma_f32_16x16x32_bf16 v[168:171], a[120:123], v[76:79], v[168:171]
    v_mfma_f32_16x16x32_bf16 v[172:175], a[76:79], v[64:67], v[172:175]
    v_mfma_f32_16x16x32_bf16 v[172:175], a[92:95], v[68:71], v[172:175]
    v_mfma_f32_16x16x32_bf16 v[172:175], a[108:111], v[72:75], v[172:175]
    v_mfma_f32_16x16x32_bf16 v[172:175], a[124:127], v[76:79], v[172:175]
    s_waitcnt lgkmcnt(0)
    v_mfma_f32_16x16x32_bf16 v[176:179], a[64:67], v[80:83], v[176:179]
    ds_read_b128 v[64:67], v224 offset:20480
    v_mfma_f32_16x16x32_bf16 v[176:179], a[80:83], v[84:87], v[176:179]
    ds_read_b128 v[68:71], v225 offset:20480
    v_mfma_f32_16x16x32_bf16 v[176:179], a[96:99], v[88:91], v[176:179]
    ds_read_b128 v[72:75], v224 offset:28672
    v_mfma_f32_16x16x32_bf16 v[176:179], a[112:115], v[92:95], v[176:179]
    ds_read_b128 v[76:79], v225 offset:28672
    v_mfma_f32_16x16x32_bf16 v[180:183], a[68:71], v[80:83], v[180:183]
    v_mfma_f32_16x16x32_bf16 v[180:183], a[84:87], v[84:87], v[180:183]
    v_mfma_f32_16x16x32_bf16 v[180:183], a[100:103], v[88:91], v[180:183]
    v_mfma_f32_16x16x32_bf16 v[180:183], a[116:119], v[92:95], v[180:183]
    v_mfma_f32_16x16x32_bf16 v[184:187], a[72:75], v[80:83], v[184:187]
    s_add_u32 m0, s31, 7168
    s_add_u32 s24, s27, 229376
    buffer_load_dwordx4 v237, s[12:15], s24 offen lds
    v_mfma_f32_16x16x32_bf16 v[184:187], a[88:91], v[84:87], v[184:187]
    v_mfma_f32_16x16x32_bf16 v[184:187], a[104:107], v[88:91], v[184:187]
    s_add_u32 s27, s27, 1048576
    s_and_b32 s27, s27, 0x407fffff
    s_cmp_eq_u32 s27, s7
    s_cselect_b32 s27, s43, s27
    v_mfma_f32_16x16x32_bf16 v[184:187], a[120:123], v[92:95], v[184:187]
    v_mfma_f32_16x16x32_bf16 v[188:191], a[76:79], v[80:83], v[188:191]
    v_mfma_f32_16x16x32_bf16 v[188:191], a[92:95], v[84:87], v[188:191]
    s_add_u32 s31, s31, 32768
    s_cmp_ge_u32 s31, 163840
    s_cselect_b32 s24, 98304, 0
    s_sub_u32 s31, s31, s24
    s_add_u32 s38, s36, 65536
    buffer_store_dwordx4 v[0:3], v240, s[16:19], s38 offen offset:2560 sc1
    v_mfma_f32_16x16x32_bf16 v[188:191], a[108:111], v[88:91], v[188:191]
    v_mfma_f32_16x16x32_bf16 v[188:191], a[124:127], v[92:95], v[188:191]
    s_waitcnt lgkmcnt(0)
    v_mfma_f32_16x16x32_bf16 v[192:195], a[64:67], v[64:67], v[192:195]
    ds_read_b128 v[80:83], v224 offset:22528
    v_mfma_f32_16x16x32_bf16 v[192:195], a[80:83], v[68:71], v[192:195]
    ds_read_b128 v[84:87], v225 offset:22528
    v_mfma_f32_16x16x32_bf16 v[192:195], a[96:99], v[72:75], v[192:195]
    ds_read_b128 v[88:91], v224 offset:30720
    v_mfma_f32_16x16x32_bf16 v[192:195], a[112:115], v[76:79], v[192:195]
    ds_read_b128 v[92:95], v225 offset:30720
    v_mfma_f32_16x16x32_bf16 v[196:199], a[68:71], v[64:67], v[196:199]
    v_mfma_f32_16x16x32_bf16 v[196:199], a[84:87], v[68:71], v[196:199]
    v_mfma_f32_16x16x32_bf16 v[196:199], a[100:103], v[72:75], v[196:199]
    v_mfma_f32_16x16x32_bf16 v[196:199], a[116:119], v[76:79], v[196:199]
    v_mfma_f32_16x16x32_bf16 v[200:203], a[72:75], v[64:67], v[200:203]
    v_mfma_f32_16x16x32_bf16 v[200:203], a[88:91], v[68:71], v[200:203]
    v_mfma_f32_16x16x32_bf16 v[200:203], a[104:107], v[72:75], v[200:203]
    v_mfma_f32_16x16x32_bf16 v[200:203], a[120:123], v[76:79], v[200:203]
    v_mfma_f32_16x16x32_bf16 v[204:207], a[76:79], v[64:67], v[204:207]
    v_mfma_f32_16x16x32_bf16 v[204:207], a[92:95], v[68:71], v[204:207]
    v_mfma_f32_16x16x32_bf16 v[204:207], a[108:111], v[72:75], v[204:207]
    v_mfma_f32_16x16x32_bf16 v[204:207], a[124:127], v[76:79], v[204:207]
    s_waitcnt vmcnt(9) lgkmcnt(0)
    s_barrier
    v_mfma_f32_16x16x32_bf16 v[208:211], a[64:67], v[80:83], v[208:211]
    ds_read_b128 v[64:67], v224 offset:32768
    v_mfma_f32_16x16x32_bf16 v[208:211], a[80:83], v[84:87], v[208:211]
    ds_read_b128 v[68:71], v225 offset:32768
    v_mfma_f32_16x16x32_bf16 v[208:211], a[96:99], v[88:91], v[208:211]
    ds_read_b128 v[72:75], v224 offset:40960
    s_add_u32 s38, s36, 69632
    buffer_store_dwordx4 v[4:7], v240, s[16:19], s38 offen offset:512 sc1
    v_mfma_f32_16x16x32_bf16 v[208:211], a[112:115], v[92:95], v[208:211]
    ds_read_b128 v[76:79], v225 offset:40960
    v_mfma_f32_16x16x32_bf16 v[212:215], a[68:71], v[80:83], v[212:215]
    v_mfma_f32_16x16x32_bf16 v[212:215], a[84:87], v[84:87], v[212:215]
    v_mfma_f32_16x16x32_bf16 v[212:215], a[100:103], v[88:91], v[212:215]
    v_mfma_f32_16x16x32_bf16 v[212:215], a[116:119], v[92:95], v[212:215]
    v_mfma_f32_16x16x32_bf16 v[216:219], a[72:75], v[80:83], v[216:219]
    v_mfma_f32_16x16x32_bf16 v[216:219], a[88:91], v[84:87], v[216:219]
    v_mfma_f32_16x16x32_bf16 v[216:219], a[104:107], v[88:91], v[216:219]
    v_mfma_f32_16x16x32_bf16 v[216:219], a[120:123], v[92:95], v[216:219]
    v_mfma_f32_16x16x32_bf16 v[220:223], a[76:79], v[80:83], v[220:223]
    v_mfma_f32_16x16x32_bf16 v[220:223], a[92:95], v[84:87], v[220:223]
    v_mfma_f32_16x16x32_bf16 v[220:223], a[108:111], v[88:91], v[220:223]
    v_mfma_f32_16x16x32_bf16 v[220:223], a[124:127], v[92:95], v[220:223]
    s_waitcnt lgkmcnt(0)
    v_mfma_f32_16x16x32_bf16 v[160:163], a[128:131], v[64:67], v[160:163]
    ds_read_b128 v[80:83], v224 offset:34816
    v_mfma_f32_16x16x32_bf16 v[160:163], a[144:147], v[68:71], v[160:163]
    ds_read_b128 v[84:87], v225 offset:34816
    v_mfma_f32_16x16x32_bf16 v[160:163], a[160:163], v[72:75], v[160:163]
    ds_read_b128 v[88:91], v224 offset:43008
    v_mfma_f32_16x16x32_bf16 v[160:163], a[176:179], v[76:79], v[160:163]
    ds_read_b128 v[92:95], v225 offset:43008
    v_mfma_f32_16x16x32_bf16 v[164:167], a[132:135], v[64:67], v[164:167]
    v_mfma_f32_16x16x32_bf16 v[164:167], a[148:151], v[68:71], v[164:167]
    v_mfma_f32_16x16x32_bf16 v[164:167], a[164:167], v[72:75], v[164:167]
    v_mfma_f32_16x16x32_bf16 v[164:167], a[180:183], v[76:79], v[164:167]
    v_mfma_f32_16x16x32_bf16 v[168:171], a[136:139], v[64:67], v[168:171]
    buffer_load_dword v254, off, s[88:91], s39 sc1
    s_add_u32 s38, s36, 65536
    buffer_store_dwordx4 v[8:11], v240, s[16:19], s38 offen offset:3584 sc1
    v_mfma_f32_16x16x32_bf16 v[168:171], a[152:155], v[68:71], v[168:171]
    v_mfma_f32_16x16x32_bf16 v[168:171], a[168:171], v[72:75], v[168:171]
    v_mfma_f32_16x16x32_bf16 v[168:171], a[184:187], v[76:79], v[168:171]
    v_mfma_f32_16x16x32_bf16 v[172:175], a[140:143], v[64:67], v[172:175]
    v_mfma_f32_16x16x32_bf16 v[172:175], a[156:159], v[68:71], v[172:175]
    v_mfma_f32_16x16x32_bf16 v[172:175], a[172:175], v[72:75], v[172:175]
    v_mfma_f32_16x16x32_bf16 v[172:175], a[188:191], v[76:79], v[172:175]
    s_waitcnt lgkmcnt(0)
    v_mfma_f32_16x16x32_bf16 v[176:179], a[128:131], v[80:83], v[176:179]
    ds_read_b128 v[64:67], v224 offset:36864
    v_mfma_f32_16x16x32_bf16 v[176:179], a[144:147], v[84:87], v[176:179]
    ds_read_b128 v[68:71], v225 offset:36864
    v_mfma_f32_16x16x32_bf16 v[176:179], a[160:163], v[88:91], v[176:179]
    ds_read_b128 v[72:75], v224 offset:45056
    v_mfma_f32_16x16x32_bf16 v[176:179], a[176:179], v[92:95], v[176:179]
    ds_read_b128 v[76:79], v225 offset:45056
    v_mfma_f32_16x16x32_bf16 v[180:183], a[132:135], v[80:83], v[180:183]
    v_mfma_f32_16x16x32_bf16 v[180:183], a[148:151], v[84:87], v[180:183]
    v_mfma_f32_16x16x32_bf16 v[180:183], a[164:167], v[88:91], v[180:183]
    v_mfma_f32_16x16x32_bf16 v[180:183], a[180:183], v[92:95], v[180:183]
    v_mfma_f32_16x16x32_bf16 v[184:187], a[136:139], v[80:83], v[184:187]
    v_mfma_f32_16x16x32_bf16 v[184:187], a[152:155], v[84:87], v[184:187]
    v_mfma_f32_16x16x32_bf16 v[184:187], a[168:171], v[88:91], v[184:187]
    v_mfma_f32_16x16x32_bf16 v[184:187], a[184:187], v[92:95], v[184:187]
    v_mfma_f32_16x16x32_bf16 v[188:191], a[140:143], v[80:83], v[188:191]
    v_mfma_f32_16x16x32_bf16 v[188:191], a[156:159], v[84:87], v[188:191]
    s_add_u32 s38, s36, 69632
    buffer_store_dwordx4 v[12:15], v240, s[16:19], s38 offen offset:1536 sc1
    v_mfma_f32_16x16x32_bf16 v[188:191], a[172:175], v[88:91], v[188:191]
    v_mfma_f32_16x16x32_bf16 v[188:191], a[188:191], v[92:95], v[188:191]
    s_waitcnt lgkmcnt(0)
    v_mfma_f32_16x16x32_bf16 v[192:195], a[128:131], v[64:67], v[192:195]
    ds_read_b128 v[80:83], v224 offset:38912
    v_mfma_f32_16x16x32_bf16 v[192:195], a[144:147], v[68:71], v[192:195]
    ds_read_b128 v[84:87], v225 offset:38912
    v_mfma_f32_16x16x32_bf16 v[192:195], a[160:163], v[72:75], v[192:195]
    ds_read_b128 v[88:91], v224 offset:47104
    v_mfma_f32_16x16x32_bf16 v[192:195], a[176:179], v[76:79], v[192:195]
    ds_read_b128 v[92:95], v225 offset:47104
    v_mfma_f32_16x16x32_bf16 v[196:199], a[132:135], v[64:67], v[196:199]
    v_mfma_f32_16x16x32_bf16 v[196:199], a[148:151], v[68:71], v[196:199]
    v_mfma_f32_16x16x32_bf16 v[196:199], a[164:167], v[72:75], v[196:199]
    v_mfma_f32_16x16x32_bf16 v[196:199], a[180:183], v[76:79], v[196:199]
    v_mfma_f32_16x16x32_bf16 v[200:203], a[136:139], v[64:67], v[200:203]
    v_mfma_f32_16x16x32_bf16 v[200:203], a[152:155], v[68:71], v[200:203]
    v_mfma_f32_16x16x32_bf16 v[200:203], a[168:171], v[72:75], v[200:203]
    v_mfma_f32_16x16x32_bf16 v[200:203], a[184:187], v[76:79], v[200:203]
    v_mfma_f32_16x16x32_bf16 v[204:207], a[140:143], v[64:67], v[204:207]
    v_mfma_f32_16x16x32_bf16 v[204:207], a[156:159], v[68:71], v[204:207]
    v_mfma_f32_16x16x32_bf16 v[204:207], a[172:175], v[72:75], v[204:207]
    v_mfma_f32_16x16x32_bf16 v[204:207], a[188:191], v[76:79], v[204:207]
    s_waitcnt lgkmcnt(0)
    v_mfma_f32_16x16x32_bf16 v[208:211], a[128:131], v[80:83], v[208:211]
    ds_read_b128 v[64:67], v224 offset:49152
    v_mfma_f32_16x16x32_bf16 v[208:211], a[144:147], v[84:87], v[208:211]
    ds_read_b128 v[68:71], v224 offset:51200
    v_mfma_f32_16x16x32_bf16 v[208:211], a[160:163], v[88:91], v[208:211]
    ds_read_b128 v[72:75], v224 offset:53248
    v_mfma_f32_16x16x32_bf16 v[208:211], a[176:179], v[92:95], v[208:211]
    ds_read_b128 v[76:79], v224 offset:55296
    s_add_u32 s38, s36, 73728
    buffer_store_dwordx4 v[16:19], v240, s[16:19], s38 offen offset:2560 sc1
    v_mfma_f32_16x16x32_bf16 v[212:215], a[132:135], v[80:83], v[212:215]
    v_mfma_f32_16x16x32_bf16 v[212:215], a[148:151], v[84:87], v[212:215]
    v_mfma_f32_16x16x32_bf16 v[212:215], a[164:167], v[88:91], v[212:215]
    v_mfma_f32_16x16x32_bf16 v[212:215], a[180:183], v[92:95], v[212:215]
    v_mfma_f32_16x16x32_bf16 v[216:219], a[136:139], v[80:83], v[216:219]
    v_mfma_f32_16x16x32_bf16 v[216:219], a[152:155], v[84:87], v[216:219]
    v_mfma_f32_16x16x32_bf16 v[216:219], a[168:171], v[88:91], v[216:219]
    v_mfma_f32_16x16x32_bf16 v[216:219], a[184:187], v[92:95], v[216:219]
    v_mfma_f32_16x16x32_bf16 v[220:223], a[140:143], v[80:83], v[220:223]
    v_mfma_f32_16x16x32_bf16 v[220:223], a[156:159], v[84:87], v[220:223]
    v_mfma_f32_16x16x32_bf16 v[220:223], a[172:175], v[88:91], v[220:223]
    v_mfma_f32_16x16x32_bf16 v[220:223], a[188:191], v[92:95], v[220:223]
    s_waitcnt vmcnt(3)
    v_readfirstlane_b32 s24, v254
    s_lshl_b32 s25, s3, 16
    s_add_u32 s24, s24, s25
    s_cmp_ge_u32 s24, 32
    s_cbranch_scc0 kf_spin33
kf_spinr34:
    s_waitcnt lgkmcnt(0)
    s_barrier
    v_mfma_f32_16x16x32_bf16 v[160:163], a[192:195], v[64:67], v[160:163]
    ds_read_b128 v[80:83], v225 offset:49152
    v_mfma_f32_16x16x32_bf16 v[164:167], a[196:199], v[64:67], v[164:167]
    ds_read_b128 v[84:87], v225 offset:51200
    v_mfma_f32_16x16x32_bf16 v[168:171], a[200:203], v[64:67], v[168:171]
    ds_read_b128 v[88:91], v225 offset:53248
    v_mfma_f32_16x16x32_bf16 v[172:175], a[204:207], v[64:67], v[172:175]
    ds_read_b128 v[92:95], v225 offset:55296
    v_mfma_f32_16x16x32_bf16 v[176:179], a[192:195], v[68:71], v[176:179]
    v_mfma_f32_16x16x32_bf16 v[180:183], a[196:199], v[68:71], v[180:183]
    v_mfma_f32_16x16x32_bf16 v[184:187], a[200:203], v[68:71], v[184:187]
    v_mfma_f32_16x16x32_bf16 v[188:191], a[204:207], v[68:71], v[188:191]
    v_mfma_f32_16x16x32_bf16 v[192:195], a[192:195], v[72:75], v[192:195]
    buffer_load_dwordx4 a[128:131], v248, s[8:11], s28 offen offset:0 sc1
    s_add_u32 s38, s36, 77824
    buffer_store_dwordx4 v[20:23], v240, s[16:19], s38 offen offset:512 sc1
    v_mfma_f32_16x16x32_bf16 v[196:199], a[196:199], v[72:75], v[196:199]
    v_mfma_f32_16x16x32_bf16 v[200:203], a[200:203], v[72:75], v[200:203]
    buffer_load_dwordx4 a[132:135], v248, s[8:11], s29 offen offset:0 sc1
    v_mfma_f32_16x16x32_bf16 v[204:207], a[204:207], v[72:75], v[204:207]
    v_mfma_f32_16x16x32_bf16 v[208:211], a[192:195], v[76:79], v[208:211]
    v_mfma_f32_16x16x32_bf16 v[212:215], a[196:199], v[76:79], v[212:215]
    buffer_load_dwordx4 a[136:139], v249, s[8:11], s28 offen offset:0 sc1
    v_mfma_f32_16x16x32_bf16 v[216:219], a[200:203], v[76:79], v[216:219]
    v_mfma_f32_16x16x32_bf16 v[220:223], a[204:207], v[76:79], v[220:223]
    s_waitcnt lgkmcnt(0)
    v_mfma_f32_16x16x32_bf16 v[160:163], a[208:211], v[80:83], v[160:163]
    ds_read_b128 v[64:67], v224 offset:57344
    v_mfma_f32_16x16x32_bf16 v[164:167], a[212:215], v[80:83], v[164:167]
    ds_read_b128 v[68:71], v224 offset:59392
    v_mfma_f32_16x16x32_bf16 v[168:171], a[216:219], v[80:83], v[168:171]
    ds_read_b128 v[72:75], v224 offset:61440
    v_mfma_f32_16x16x32_bf16 v[172:175], a[220:223], v[80:83], v[172:175]
    ds_read_b128 v[76:79], v224 offset:63488
    v_mfma_f32_16x16x32_bf16 v[176:179], a[208:211], v[84:87], v[176:179]
    v_mfma_f32_16x16x32_bf16 v[180:183], a[212:215], v[84:87], v[180:183]
    v_mfma_f32_16x16x32_bf16 v[184:187], a[216:219], v[84:87], v[184:187]
    v_mfma_f32_16x16x32_bf16 v[188:191], a[220:223], v[84:87], v[188:191]
    v_mfma_f32_16x16x32_bf16 v[192:195], a[208:211], v[88:91], v[192:195]
    buffer_load_dwordx4 a[140:143], v249, s[8:11], s29 offen offset:0 sc1
    v_mfma_f32_16x16x32_bf16 v[196:199], a[212:215], v[88:91], v[196:199]
    v_mfma_f32_16x16x32_bf16 v[200:203], a[216:219], v[88:91], v[200:203]
    buffer_load_dwordx4 a[144:147], v248, s[8:11], s28 offen offset:1024 sc1
    v_mfma_f32_16x16x32_bf16 v[204:207], a[220:223], v[88:91], v[204:207]
    v_mfma_f32_16x16x32_bf16 v[208:211], a[208:211], v[92:95], v[208:211]
    v_mfma_f32_16x16x32_bf16 v[212:215], a[212:215], v[92:95], v[212:215]
    buffer_load_dwordx4 a[148:151], v248, s[8:11], s29 offen offset:1024 sc1
    v_mfma_f32_16x16x32_bf16 v[216:219], a[216:219], v[92:95], v[216:219]
    s_add_u32 s38, s36, 73728
    buffer_store_dwordx4 v[24:27], v240, s[16:19], s38 offen offset:3584 sc1
    v_mfma_f32_16x16x32_bf16 v[220:223], a[220:223], v[92:95], v[220:223]
    s_waitcnt lgkmcnt(0)
    v_mfma_f32_16x16x32_bf16 v[160:163], a[224:227], v[64:67], v[160:163]
    ds_read_b128 v[80:83], v225 offset:57344
    v_mfma_f32_16x16x32_bf16 v[164:167], a[228:231], v[64:67], v[164:167]
    ds_read_b128 v[84:87], v225 offset:59392
    v_mfma_f32_16x16x32_bf16 v[168:171], a[232:235], v[64:67], v[168:171]
    ds_read_b128 v[88:91], v225 offset:61440
    v_mfma_f32_16x16x32_bf16 v[172:175], a[236:239], v[64:67], v[172:175]
    ds_read_b128 v[92:95], v225 offset:63488
    v_mfma_f32_16x16x32_bf16 v[176:179], a[224:227], v[68:71], v[176:179]
    v_mfma_f32_16x16x32_bf16 v[180:183], a[228:231], v[68:71], v[180:183]
    v_mfma_f32_16x16x32_bf16 v[184:187], a[232:235], v[68:71], v[184:187]
    v_mfma_f32_16x16x32_bf16 v[188:191], a[236:239], v[68:71], v[188:191]
    v_mfma_f32_16x16x32_bf16 v[192:195], a[224:227], v[72:75], v[192:195]
    buffer_load_dwordx4 a[152:155], v249, s[8:11], s28 offen offset:1024 sc1
    v_mfma_f32_16x16x32_bf16 v[196:199], a[228:231], v[72:75], v[196:199]
    v_mfma_f32_16x16x32_bf16 v[200:203], a[232:235], v[72:75], v[200:203]
    buffer_load_dwordx4 a[156:159], v249, s[8:11], s29 offen offset:1024 sc1
    v_mfma_f32_16x16x32_bf16 v[204:207], a[236:239], v[72:75], v[204:207]
    v_mfma_f32_16x16x32_bf16 v[208:211], a[224:227], v[76:79], v[208:211]
    v_mfma_f32_16x16x32_bf16 v[212:215], a[228:231], v[76:79], v[212:215]
    buffer_load_dwordx4 a[160:163], v248, s[8:11], s28 offen offset:2048 sc1
    v_mfma_f32_16x16x32_bf16 v[216:219], a[232:235], v[76:79], v[216:219]
    v_mfma_f32_16x16x32_bf16 v[220:223], a[236:239], v[76:79], v[220:223]
    s_waitcnt vmcnt(38) lgkmcnt(0)
    s_barrier
    v_mfma_f32_16x16x32_bf16 v[160:163], a[240:243], v[80:83], v[160:163]
    ds_read_b64_tr_b16 a[192:193], v246 offset:0
    v_mfma_f32_16x16x32_bf16 v[164:167], a[244:247], v[80:83], v[164:167]
    ds_read_b64_tr_b16 a[194:195], v246 offset:1024
    v_mfma_f32_16x16x32_bf16 v[168:171], a[248:251], v[80:83], v[168:171]
    ds_read_b64_tr_b16 a[196:197], v238 offset:0
    v_mfma_f32_16x16x32_bf16 v[172:175], a[252:255], v[80:83], v[172:175]
    ds_read_b64_tr_b16 a[198:199], v238 offset:1024
    v_mfma_f32_16x16x32_bf16 v[176:179], a[240:243], v[84:87], v[176:179]
    ds_read_b64_tr_b16 a[200:201], v246 offset:256
    s_add_u32 s38, s36, 77824
    buffer_store_dwordx4 v[28:31], v240, s[16:19], s38 offen offset:1536 sc1
    v_mfma_f32_16x16x32_bf16 v[180:183], a[244:247], v[84:87], v[180:183]
    ds_read_b64_tr_b16 a[202:203], v246 offset:1280
    v_mfma_f32_16x16x32_bf16 v[184:187], a[248:251], v[84:87], v[184:187]
    ds_read_b64_tr_b16 a[204:205], v238 offset:256
    v_mfma_f32_16x16x32_bf16 v[188:191], a[252:255], v[84:87], v[188:191]
    ds_read_b64_tr_b16 a[206:207], v238 offset:1280
    v_mfma_f32_16x16x32_bf16 v[192:195], a[240:243], v[88:91], v[192:195]
    buffer_load_dwordx4 a[164:167], v248, s[8:11], s29 offen offset:2048 sc1
    v_mfma_f32_16x16x32_bf16 v[196:199], a[244:247], v[88:91], v[196:199]
    v_cvt_pk_bf16_f32 v32, v160, v161
    v_cvt_pk_bf16_f32 v33, v162, v163
    v_mfma_f32_16x16x32_bf16 v[200:203], a[248:251], v[88:91], v[200:203]
    buffer_load_dwordx4 a[168:171], v249, s[8:11], s28 offen offset:2048 sc1
    v_cvt_pk_bf16_f32 v34, v164, v165
    v_cvt_pk_bf16_f32 v35, v166, v167
    v_mfma_f32_16x16x32_bf16 v[204:207], a[252:255], v[88:91], v[204:207]
    v_cvt_pk_bf16_f32 v36, v168, v169
    v_cvt_pk_bf16_f32 v37, v170, v171
    v_mfma_f32_16x16x32_bf16 v[208:211], a[240:243], v[92:95], v[208:211]
    v_cvt_pk_bf16_f32 v38, v172, v173
    v_cvt_pk_bf16_f32 v39, v174, v175
    v_mfma_f32_16x16x32_bf16 v[212:215], a[244:247], v[92:95], v[212:215]
    buffer_load_dwordx4 a[172:175], v249, s[8:11], s29 offen offset:2048 sc1
    v_cvt_pk_bf16_f32 v40, v176, v177
    v_cvt_pk_bf16_f32 v41, v178, v179
    v_mfma_f32_16x16x32_bf16 v[216:219], a[248:251], v[92:95], v[216:219]
    v_cvt_pk_bf16_f32 v42, v180, v181
    v_cvt_pk_bf16_f32 v43, v182, v183
    v_mfma_f32_16x16x32_bf16 v[220:223], a[252:255], v[92:95], v[220:223]
    v_cvt_pk_bf16_f32 v44, v184, v185
    v_cvt_pk_bf16_f32 v45, v186, v187
    s_nop 3
    v_cvt_pk_bf16_f32 v46, v188, v189
    v_cvt_pk_bf16_f32 v47, v190, v191
    v_cvt_pk_bf16_f32 v48, v192, v193
    v_cvt_pk_bf16_f32 v49, v194, v195
    v_cvt_pk_bf16_f32 v50, v196, v197
    v_cvt_pk_bf16_f32 v51, v198, v199
    v_cvt_pk_bf16_f32 v52, v200, v201
    v_cvt_pk_bf16_f32 v53, v202, v203
    v_cvt_pk_bf16_f32 v54, v204, v205
    v_cvt_pk_bf16_f32 v55, v206, v207
    v_cvt_pk_bf16_f32 v56, v208, v209
    v_cvt_pk_bf16_f32 v57, v210, v211
    v_cvt_pk_bf16_f32 v58, v212, v213
    v_cvt_pk_bf16_f32 v59, v214, v215
    v_cvt_pk_bf16_f32 v60, v216, v217
    v_cvt_pk_bf16_f32 v61, v218, v219
    v_cvt_pk_bf16_f32 v62, v220, v221
    v_cvt_pk_bf16_f32 v63, v222, v223
    s_add_u32 s80, s36, 102144
    s_add_u32 s81, s36, 104192
    s_add_u32 s82, s36, 103168
    s_add_u32 s83, s36, 105216
    s_add_u32 s84, s36, 110336
    s_add_u32 s85, s36, 112384
    s_add_u32 s86, s36, 111360
    s_add_u32 s87, s36, 113408
    s_branch ka_Q
ka_V:
    s_waitcnt lgkmcnt(0)
    v_mfma_f32_16x16x32_bf16 v[96:99], v[64:67], a[0:3], 0
    ds_read_b128 v[80:83], v224 offset:8192
    v_mfma_f32_16x16x32_bf16 v[100:103], v[68:71], a[0:3], 0
    ds_read_b128 v[84:87], v224 offset:10240
    v_mfma_f32_16x16x32_bf16 v[104:107], v[64:67], a[4:7], 0
    ds_read_b128 v[88:91], v224 offset:12288
    v_mfma_f32_16x16x32_bf16 v[108:111], v[68:71], a[4:7], 0
    ds_read_b128 v[92:95], v224 offset:14336
    v_mfma_f32_16x16x32_bf16 v[112:115], v[64:67], a[8:11], 0
    ds_read_b64_tr_b16 a[16:17], v228 offset:4096
    v_mfma_f32_16x16x32_bf16 v[116:119], v[68:71], a[8:11], 0
    ds_read_b64_tr_b16 a[18:19], v228 offset:4608
    v_mfma_f32_16x16x32_bf16 v[120:123], v[64:67], a[12:15], 0
    ds_read_b64_tr_b16 a[20:21], v229 offset:4096
    v_mfma_f32_16x16x32_bf16 v[124:127], v[68:71], a[12:15], 0
    ds_read_b64_tr_b16 a[22:23], v229 offset:4608
    v_mfma_f32_16x16x32_bf16 v[128:131], v[72:75], a[0:3], 0
    s_add_u32 m0, s35, 16384
    s_and_b32 s33, s82, 1023
    s_lshl_b32 s33, s33, 12
    buffer_load_dwordx4 v234, s[48:51], s33 offen lds
    v_mfma_f32_16x16x32_bf16 v[132:135], v[76:79], a[0:3], 0
    v_mfma_f32_16x16x32_bf16 v[136:139], v[72:75], a[4:7], 0
    buffer_load_dwordx4 v235, s[48:51], s33 offen offset:1024 lds
    v_mfma_f32_16x16x32_bf16 v[140:143], v[76:79], a[4:7], 0
    v_mfma_f32_16x16x32_bf16 v[144:147], v[72:75], a[8:11], 0
    s_add_u32 m0, s35, 18432
    s_add_u32 s33, s33, 131072
    buffer_load_dwordx4 v234, s[48:51], s33 offen lds
    v_mfma_f32_16x16x32_bf16 v[148:151], v[76:79], a[8:11], 0
    v_mfma_f32_16x16x32_bf16 v[152:155], v[72:75], a[12:15], 0
    buffer_load_dwordx4 v235, s[48:51], s33 offen offset:1024 lds
    v_mfma_f32_16x16x32_bf16 v[156:159], v[76:79], a[12:15], 0
    s_waitcnt lgkmcnt(0)
    v_mfma_f32_16x16x32_bf16 v[160:163], v[80:83], a[0:3], 0
    ds_read_b128 v[64:67], v225 offset:0
    v_mfma_f32_16x16x32_bf16 v[164:167], v[84:87], a[0:3], 0
    ds_read_b128 v[68:71], v225 offset:2048
    v_mfma_f32_16x16x32_bf16 v[168:171], v[80:83], a[4:7], 0
    ds_read_b128 v[72:75], v225 offset:4096
    v_mfma_f32_16x16x32_bf16 v[172:175], v[84:87], a[4:7], 0
    ds_read_b128 v[76:79], v225 offset:6144
    v_mfma_f32_16x16x32_bf16 v[176:179], v[80:83], a[8:11], 0
    ds_read_b64_tr_b16 a[24:25], v230 offset:4096
    v_mfma_f32_16x16x32_bf16 v[180:183], v[84:87], a[8:11], 0
    ds_read_b64_tr_b16 a[26:27], v230 offset:4608
    v_mfma_f32_16x16x32_bf16 v[184:187], v[80:83], a[12:15], 0
    ds_read_b64_tr_b16 a[28:29], v231 offset:4096
    v_mfma_f32_16x16x32_bf16 v[188:191], v[84:87], a[12:15], 0
    ds_read_b64_tr_b16 a[30:31], v231 offset:4608
    v_mfma_f32_16x16x32_bf16 v[192:195], v[88:91], a[0:3], 0
    s_add_u32 m0, s35, 20480
    s_add_u32 s33, s33, 131072
    buffer_load_dwordx4 v234, s[48:51], s33 offen lds
    v_mfma_f32_16x16x32_bf16 v[196:199], v[92:95], a[0:3], 0
    v_mfma_f32_16x16x32_bf16 v[200:203], v[88:91], a[4:7], 0
    buffer_load_dwordx4 v235, s[48:51], s33 offen offset:1024 lds
    v_mfma_f32_16x16x32_bf16 v[204:207], v[92:95], a[4:7], 0
    v_mfma_f32_16x16x32_bf16 v[208:211], v[88:91], a[8:11], 0
    s_add_u32 m0, s35, 22528
    s_add_u32 s33, s33, 131072
    buffer_load_dwordx4 v234, s[48:51], s33 offen lds
    v_mfma_f32_16x16x32_bf16 v[212:215], v[92:95], a[8:11], 0
    v_mfma_f32_16x16x32_bf16 v[216:219], v[88:91], a[12:15], 0
    buffer_load_dwordx4 v235, s[48:51], s33 offen offset:1024 lds
    v_mfma_f32_16x16x32_bf16 v[220:223], v[92:95], a[12:15], 0
    s_waitcnt vmcnt(13) lgkmcnt(0)
    v_mfma_f32_16x16x32_bf16 v[96:99], v[64:67], a[16:19], v[96:99]
    ds_read_b128 v[80:83], v225 offset:8192
    v_mfma_f32_16x16x32_bf16 v[100:103], v[68:71], a[16:19], v[100:103]
    ds_read_b128 v[84:87], v225 offset:10240
    v_mfma_f32_16x16x32_bf16 v[104:107], v[64:67], a[20:23], v[104:107]
    ds_read_b128 v[88:91], v225 offset:12288
    v_mfma_f32_16x16x32_bf16 v[108:111], v[68:71], a[20:23], v[108:111]
    ds_read_b128 v[92:95], v225 offset:14336
    v_mfma_f32_16x16x32_bf16 v[112:115], v[64:67], a[24:27], v[112:115]
    ds_read_b64_tr_b16 a[32:33], v228 offset:8192
    v_mfma_f32_16x16x32_bf16 v[116:119], v[68:71], a[24:27], v[116:119]
    ds_read_b64_tr_b16 a[34:35], v228 offset:8704
    v_mfma_f32_16x16x32_bf16 v[120:123], v[64:67], a[28:31], v[120:123]
    ds_read_b64_tr_b16 a[36:37], v229 offset:8192
    v_mfma_f32_16x16x32_bf16 v[124:127], v[68:71], a[28:31], v[124:127]
    ds_read_b64_tr_b16 a[38:39], v229 offset:8704
    v_mfma_f32_16x16x32_bf16 v[128:131], v[72:75], a[16:19], v[128:131]
    ds_read_b64_tr_b16 a[40:41], v230 offset:8192
    s_add_u32 m0, s34, 32768
    s_add_u32 s37, s82, 0
    buffer_load_dwordx4 v232, s[44:47], s37 offen lds
    v_mfma_f32_16x16x32_bf16 v[132:135], v[76:79], a[16:19], v[132:135]
    ds_read_b64_tr_b16 a[42:43], v230 offset:8704
    buffer_load_dwordx4 v233, s[44:47], s37 offen offset:1024 lds
    v_mfma_f32_16x16x32_bf16 v[136:139], v[72:75], a[20:23], v[136:139]
    ds_read_b64_tr_b16 a[44:45], v231 offset:8192
    s_add_u32 m0, s34, 40960
    s_add_u32 s37, s82, 65536
    buffer_load_dwordx4 v232, s[44:47], s37 offen lds
    v_mfma_f32_16x16x32_bf16 v[140:143], v[76:79], a[20:23], v[140:143]
    ds_read_b64_tr_b16 a[46:47], v231 offset:8704
    buffer_load_dwordx4 v233, s[44:47], s37 offen offset:1024 lds
    v_mfma_f32_16x16x32_bf16 v[144:147], v[72:75], a[24:27], v[144:147]
    s_add_u32 m0, s35, 0
    s_and_b32 s33, s83, 1023
    s_lshl_b32 s33, s33, 12
    buffer_load_dwordx4 v234, s[48:51], s33 offen lds
    v_mfma_f32_16x16x32_bf16 v[148:151], v[76:79], a[24:27], v[148:151]
    buffer_load_dwordx4 v235, s[48:51], s33 offen offset:1024 lds
    v_mfma_f32_16x16x32_bf16 v[152:155], v[72:75], a[28:31], v[152:155]
    s_add_u32 m0, s35, 2048
    s_add_u32 s33, s33, 131072
    buffer_load_dwordx4 v234, s[48:51], s33 offen lds
    v_mfma_f32_16x16x32_bf16 v[156:159], v[76:79], a[28:31], v[156:159]
    buffer_load_dwordx4 v235, s[48:51], s33 offen offset:1024 lds
    s_waitcnt vmcnt(17) lgkmcnt(0)
    s_barrier
    v_mfma_f32_16x16x32_bf16 v[160:163], v[80:83], a[16:19], v[160:163]
    ds_read_b128 v[64:67], v224 offset:16384
    v_mfma_f32_16x16x32_bf16 v[164:167], v[84:87], a[16:19], v[164:167]
    ds_read_b128 v[68:71], v225 offset:16384
    v_mfma_f32_16x16x32_bf16 v[168:171], v[80:83], a[20:23], v[168:171]
    ds_read_b128 v[72:75], v224 offset:18432
    v_mfma_f32_16x16x32_bf16 v[172:175], v[84:87], a[20:23], v[172:175]
    ds_read_b128 v[76:79], v225 offset:18432
    v_mfma_f32_16x16x32_bf16 v[176:179], v[80:83], a[24:27], v[176:179]
    ds_read_b64_tr_b16 a[48:49], v228 offset:12288
    s_add_u32 m0, s34, 49152
    s_add_u32 s37, s83, 0
    buffer_load_dwordx4 v232, s[44:47], s37 offen lds
    v_mfma_f32_16x16x32_bf16 v[180:183], v[84:87], a[24:27], v[180:183]
    ds_read_b64_tr_b16 a[50:51], v228 offset:12800
    buffer_load_dwordx4 v233, s[44:47], s37 offen offset:1024 lds
    v_mfma_f32_16x16x32_bf16 v[184:187], v[80:83], a[28:31], v[184:187]
    ds_read_b64_tr_b16 a[52:53], v229 offset:12288
    s_add_u32 m0, s34, 57344
    s_add_u32 s37, s83, 65536
    buffer_load_dwordx4 v232, s[44:47], s37 offen lds
    v_mfma_f32_16x16x32_bf16 v[188:191], v[84:87], a[28:31], v[188:191]
    ds_read_b64_tr_b16 a[54:55], v229 offset:12800
    buffer_load_dwordx4 v233, s[44:47], s37 offen offset:1024 lds
    v_mfma_f32_16x16x32_bf16 v[192:195], v[88:91], a[16:19], v[192:195]
    ds_read_b64_tr_b16 a[56:57], v230 offset:12288
    s_add_u32 m0, s34, 0
    s_add_u32 s37, s84, 0
    buffer_load_dwordx4 v232, s[44:47], s37 offen lds
    v_mfma_f32_16x16x32_bf16 v[196:199], v[92:95], a[16:19], v[196:199]
    ds_read_b64_tr_b16 a[58:59], v230 offset:12800
    v_mfma_f32_16x16x32_bf16 v[200:203], v[88:91], a[20:23], v[200:203]
    ds_read_b64_tr_b16 a[60:61], v231 offset:12288
    buffer_load_dwordx4 v233, s[44:47], s37 offen offset:1024 lds
    v_mfma_f32_16x16x32_bf16 v[204:207], v[92:95], a[20:23], v[204:207]
    ds_read_b64_tr_b16 a[62:63], v231 offset:12800
    buffer_load_dwordx4 v[0:3], v236, s[52:55], 0 offen offset:0
    v_mfma_f32_16x16x32_bf16 v[208:211], v[88:91], a[24:27], v[208:211]
    buffer_load_dwordx4 v[4:7], v236, s[52:55], 0 offen offset:512
    v_mfma_f32_16x16x32_bf16 v[212:215], v[92:95], a[24:27], v[212:215]
    buffer_load_dwordx4 v[8:11], v236, s[52:55], 0 offen offset:1024
    v_mfma_f32_16x16x32_bf16 v[216:219], v[88:91], a[28:31], v[216:219]
    buffer_load_dwordx4 v[12:15], v236, s[52:55], 0 offen offset:1536
    v_mfma_f32_16x16x32_bf16 v[220:223], v[92:95], a[28:31], v[220:223]
    s_waitcnt lgkmcnt(0)
    v_mfma_f32_16x16x32_bf16 v[96:99], v[64:67], a[32:35], v[96:99]
    ds_read_b128 v[80:83], v224 offset:20480
    v_mfma_f32_16x16x32_bf16 v[96:99], v[68:71], a[48:51], v[96:99]
    ds_read_b128 v[84:87], v225 offset:20480
    v_mfma_f32_16x16x32_bf16 v[100:103], v[72:75], a[32:35], v[100:103]
    ds_read_b128 v[88:91], v224 offset:22528
    v_mfma_f32_16x16x32_bf16 v[100:103], v[76:79], a[48:51], v[100:103]
    ds_read_b128 v[92:95], v225 offset:22528
    v_mfma_f32_16x16x32_bf16 v[104:107], v[64:67], a[36:39], v[104:107]
    v_mfma_f32_16x16x32_bf16 v[104:107], v[68:71], a[52:55], v[104:107]
    v_mfma_f32_16x16x32_bf16 v[108:111], v[72:75], a[36:39], v[108:111]
    v_mfma_f32_16x16x32_bf16 v[108:111], v[76:79], a[52:55], v[108:111]
    v_mfma_f32_16x16x32_bf16 v[112:115], v[64:67], a[40:43], v[112:115]
    s_add_u32 m0, s35, 4096
    s_add_u32 s33, s33, 131072
    buffer_load_dwordx4 v234, s[48:51], s33 offen lds
    v_mfma_f32_16x16x32_bf16 v[112:115], v[68:71], a[56:59], v[112:115]
    v_mfma_f32_16x16x32_bf16 v[116:119], v[72:75], a[40:43], v[116:119]
    buffer_load_dwordx4 v235, s[48:51], s33 offen offset:1024 lds
    v_mfma_f32_16x16x32_bf16 v[116:119], v[76:79], a[56:59], v[116:119]
    v_mfma_f32_16x16x32_bf16 v[120:123], v[64:67], a[44:47], v[120:123]
    s_add_u32 m0, s35, 6144
    s_add_u32 s33, s33, 131072
    buffer_load_dwordx4 v234, s[48:51], s33 offen lds
    v_mfma_f32_16x16x32_bf16 v[120:123], v[68:71], a[60:63], v[120:123]
    v_mfma_f32_16x16x32_bf16 v[124:127], v[72:75], a[44:47], v[124:127]
    buffer_load_dwordx4 v235, s[48:51], s33 offen offset:1024 lds
    v_mfma_f32_16x16x32_bf16 v[124:127], v[76:79], a[60:63], v[124:127]
    s_waitcnt lgkmcnt(0)
    v_mfma_f32_16x16x32_bf16 v[128:131], v[80:83], a[32:35], v[128:131]
    ds_read_b128 v[64:67], v224 offset:24576
    v_mfma_f32_16x16x32_bf16 v[128:131], v[84:87], a[48:51], v[128:131]
    ds_read_b128 v[68:71], v225 offset:24576
    v_mfma_f32_16x16x32_bf16 v[132:135], v[88:91], a[32:35], v[132:135]
    ds_read_b128 v[72:75], v224 offset:26624
    v_mfma_f32_16x16x32_bf16 v[132:135], v[92:95], a[48:51], v[132:135]
    ds_read_b128 v[76:79], v225 offset:26624
    v_mfma_f32_16x16x32_bf16 v[136:139], v[80:83], a[36:39], v[136:139]
    v_mfma_f32_16x16x32_bf16 v[136:139], v[84:87], a[52:55], v[136:139]
    v_mfma_f32_16x16x32_bf16 v[140:143], v[88:91], a[36:39], v[140:143]
    v_mfma_f32_16x16x32_bf16 v[140:143], v[92:95], a[52:55], v[140:143]
    v_mfma_f32_16x16x32_bf16 v[144:147], v[80:83], a[40:43], v[144:147]
    s_add_u32 m0, s34, 8192
    s_add_u32 s37, s84, 65536
    buffer_load_dwordx4 v232, s[44:47], s37 offen lds
    v_mfma_f32_16x16x32_bf16 v[144:147], v[84:87], a[56:59], v[144:147]
    v_mfma_f32_16x16x32_bf16 v[148:151], v[88:91], a[40:43], v[148:151]
    v_mfma_f32_16x16x32_bf16 v[148:151], v[92:95], a[56:59], v[148:151]
    v_mfma_f32_16x16x32_bf16 v[152:155], v[80:83], a[44:47], v[152:155]
    buffer_load_dwordx4 v233, s[44:47], s37 offen offset:1024 lds
    v_mfma_f32_16x16x32_bf16 v[152:155], v[84:87], a[60:63], v[152:155]
    v_mfma_f32_16x16x32_bf16 v[156:159], v[88:91], a[44:47], v[156:159]
    v_mfma_f32_16x16x32_bf16 v[156:159], v[92:95], a[60:63], v[156:159]
    s_waitcnt vmcnt(24) lgkmcnt(0)
    v_mfma_f32_16x16x32_bf16 v[160:163], v[64:67], a[32:35], v[160:163]
    ds_read_b128 v[80:83], v224 offset:28672
    v_mfma_f32_16x16x32_bf16 v[160:163], v[68:71], a[48:51], v[160:163]
    ds_read_b128 v[84:87], v225 offset:28672
    v_mfma_f32_16x16x32_bf16 v[164:167], v[72:75], a[32:35], v[164:167]
    ds_read_b128 v[88:91], v224 offset:30720
    v_mfma_f32_16x16x32_bf16 v[164:167], v[76:79], a[48:51], v[164:167]
    ds_read_b128 v[92:95], v225 offset:30720
    v_mfma_f32_16x16x32_bf16 v[168:171], v[64:67], a[36:39], v[168:171]
    ds_read_b64_tr_b16 a[64:65], v228 offset:16384
    v_mfma_f32_16x16x32_bf16 v[168:171], v[68:71], a[52:55], v[168:171]
    ds_read_b64_tr_b16 a[66:67], v228 offset:16896
    v_mfma_f32_16x16x32_bf16 v[172:175], v[72:75], a[36:39], v[172:175]
    ds_read_b64_tr_b16 a[68:69], v229 offset:16384
    v_mfma_f32_16x16x32_bf16 v[172:175], v[76:79], a[52:55], v[172:175]
    ds_read_b64_tr_b16 a[70:71], v229 offset:16896
    v_mfma_f32_16x16x32_bf16 v[176:179], v[64:67], a[40:43], v[176:179]
    ds_read_b64_tr_b16 a[72:73], v230 offset:16384
    s_add_u32 m0, s35, 8192
    s_and_b32 s33, s84, 1023
    s_lshl_b32 s33, s33, 12
    buffer_load_dwordx4 v234, s[48:51], s33 offen lds
    v_mfma_f32_16x16x32_bf16 v[176:179], v[68:71], a[56:59], v[176:179]
    ds_read_b64_tr_b16 a[74:75], v230 offset:16896
    v_mfma_f32_16x16x32_bf16 v[180:183], v[72:75], a[40:43], v[180:183]
    ds_read_b64_tr_b16 a[76:77], v231 offset:16384
    buffer_load_dwordx4 v235, s[48:51], s33 offen offset:1024 lds
    v_mfma_f32_16x16x32_bf16 v[180:183], v[76:79], a[56:59], v[180:183]
    ds_read_b64_tr_b16 a[78:79], v231 offset:16896
    v_mfma_f32_16x16x32_bf16 v[184:187], v[64:67], a[44:47], v[184:187]
    s_add_u32 m0, s35, 10240
    s_add_u32 s33, s33, 131072
    buffer_load_dwordx4 v234, s[48:51], s33 offen lds
    v_mfma_f32_16x16x32_bf16 v[184:187], v[68:71], a[60:63], v[184:187]
    v_mfma_f32_16x16x32_bf16 v[188:191], v[72:75], a[44:47], v[188:191]
    buffer_load_dwordx4 v235, s[48:51], s33 offen offset:1024 lds
    v_mfma_f32_16x16x32_bf16 v[188:191], v[76:79], a[60:63], v[188:191]
    s_waitcnt vmcnt(24) lgkmcnt(0)
    s_barrier
    v_mfma_f32_16x16x32_bf16 v[192:195], v[80:83], a[32:35], v[192:195]
    ds_read_b128 v[64:67], v224 offset:32768
    v_mfma_f32_16x16x32_bf16 v[192:195], v[84:87], a[48:51], v[192:195]
    ds_read_b128 v[68:71], v225 offset:32768
    v_mfma_f32_16x16x32_bf16 v[196:199], v[88:91], a[32:35], v[196:199]
    ds_read_b128 v[72:75], v224 offset:34816
    v_mfma_f32_16x16x32_bf16 v[196:199], v[92:95], a[48:51], v[196:199]
    ds_read_b128 v[76:79], v225 offset:34816
    v_mfma_f32_16x16x32_bf16 v[200:203], v[80:83], a[36:39], v[200:203]
    ds_read_b64_tr_b16 a[80:81], v228 offset:20480
    v_mfma_f32_16x16x32_bf16 v[200:203], v[84:87], a[52:55], v[200:203]
    ds_read_b64_tr_b16 a[82:83], v228 offset:20992
    v_mfma_f32_16x16x32_bf16 v[204:207], v[88:91], a[36:39], v[204:207]
    ds_read_b64_tr_b16 a[84:85], v229 offset:20480
    v_mfma_f32_16x16x32_bf16 v[204:207], v[92:95], a[52:55], v[204:207]
    ds_read_b64_tr_b16 a[86:87], v229 offset:20992
    v_mfma_f32_16x16x32_bf16 v[208:211], v[80:83], a[40:43], v[208:211]
    ds_read_b64_tr_b16 a[88:89], v230 offset:20480
    s_add_u32 m0, s34, 16384
    s_add_u32 s37, s85, 0
    buffer_load_dwordx4 v232, s[44:47], s37 offen lds
    v_mfma_f32_16x16x32_bf16 v[208:211], v[84:87], a[56:59], v[208:211]
    ds_read_b64_tr_b16 a[90:91], v230 offset:20992
    v_mfma_f32_16x16x32_bf16 v[212:215], v[88:91], a[40:43], v[212:215]
    ds_read_b64_tr_b16 a[92:93], v231 offset:20480
    v_mfma_f32_16x16x32_bf16 v[212:215], v[92:95], a[56:59], v[212:215]
    ds_read_b64_tr_b16 a[94:95], v231 offset:20992
    v_mfma_f32_16x16x32_bf16 v[216:219], v[80:83], a[44:47], v[216:219]
    buffer_load_dwordx4 v233, s[44:47], s37 offen offset:1024 lds
    v_mfma_f32_16x16x32_bf16 v[216:219], v[84:87], a[60:63], v[216:219]
    v_mfma_f32_16x16x32_bf16 v[220:223], v[88:91], a[44:47], v[220:223]
    v_mfma_f32_16x16x32_bf16 v[220:223], v[92:95], a[60:63], v[220:223]
    s_waitcnt lgkmcnt(0)
    v_mfma_f32_16x16x32_bf16 v[96:99], v[64:67], a[64:67], v[96:99]
    ds_read_b128 v[80:83], v224 offset:36864
    v_mfma_f32_16x16x32_bf16 v[96:99], v[68:71], a[80:83], v[96:99]
    ds_read_b128 v[84:87], v225 offset:36864
    v_mfma_f32_16x16x32_bf16 v[100:103], v[72:75], a[64:67], v[100:103]
    ds_read_b128 v[88:91], v224 offset:38912
    v_mfma_f32_16x16x32_bf16 v[100:103], v[76:79], a[80:83], v[100:103]
    ds_read_b128 v[92:95], v225 offset:38912
    v_mfma_f32_16x16x32_bf16 v[104:107], v[64:67], a[68:71], v[104:107]
    v_mfma_f32_16x16x32_bf16 v[104:107], v[68:71], a[84:87], v[104:107]
    v_mfma_f32_16x16x32_bf16 v[108:111], v[72:75], a[68:71], v[108:111]
    v_mfma_f32_16x16x32_bf16 v[108:111], v[76:79], a[84:87], v[108:111]
    v_mfma_f32_16x16x32_bf16 v[112:115], v[64:67], a[72:75], v[112:115]
    s_add_u32 m0, s35, 12288
    s_add_u32 s33, s33, 131072
    buffer_load_dwordx4 v234, s[48:51], s33 offen lds
    v_mfma_f32_16x16x32_bf16 v[112:115], v[68:71], a[88:91], v[112:115]
    v_mfma_f32_16x16x32_bf16 v[116:119], v[72:75], a[72:75], v[116:119]
    buffer_load_dwordx4 v235, s[48:51], s33 offen offset:1024 lds
    v_mfma_f32_16x16x32_bf16 v[116:119], v[76:79], a[88:91], v[116:119]
    v_mfma_f32_16x16x32_bf16 v[120:123], v[64:67], a[76:79], v[120:123]
    s_add_u32 m0, s35, 14336
    s_add_u32 s33, s33, 131072
    buffer_load_dwordx4 v234, s[48:51], s33 offen lds
    v_mfma_f32_16x16x32_bf16 v[120:123], v[68:71], a[92:95], v[120:123]
    v_mfma_f32_16x16x32_bf16 v[124:127], v[72:75], a[76:79], v[124:127]
    buffer_load_dwordx4 v235, s[48:51], s33 offen offset:1024 lds
    v_mfma_f32_16x16x32_bf16 v[124:127], v[76:79], a[92:95], v[124:127]
    s_waitcnt lgkmcnt(0)
    v_mfma_f32_16x16x32_bf16 v[128:131], v[80:83], a[64:67], v[128:131]
    ds_read_b128 v[64:67], v224 offset:40960
    v_mfma_f32_16x16x32_bf16 v[128:131], v[84:87], a[80:83], v[128:131]
    ds_read_b128 v[68:71], v225 offset:40960
    v_mfma_f32_16x16x32_bf16 v[132:135], v[88:91], a[64:67], v[132:135]
    ds_read_b128 v[72:75], v224 offset:43008
    v_mfma_f32_16x16x32_bf16 v[132:135], v[92:95], a[80:83], v[132:135]
    ds_read_b128 v[76:79], v225 offset:43008
    v_mfma_f32_16x16x32_bf16 v[136:139], v[80:83], a[68:71], v[136:139]
    v_mfma_f32_16x16x32_bf16 v[136:139], v[84:87], a[84:87], v[136:139]
    v_mfma_f32_16x16x32_bf16 v[140:143], v[88:91], a[68:71], v[140:143]
    v_mfma_f32_16x16x32_bf16 v[140:143], v[92:95], a[84:87], v[140:143]
    v_mfma_f32_16x16x32_bf16 v[144:147], v[80:83], a[72:75], v[144:147]
    s_add_u32 m0, s34, 24576
    s_add_u32 s37, s85, 65536
    buffer_load_dwordx4 v232, s[44:47], s37 offen lds
    v_mfma_f32_16x16x32_bf16 v[144:147], v[84:87], a[88:91], v[144:147]
    v_mfma_f32_16x16x32_bf16 v[148:151], v[88:91], a[72:75], v[148:151]
    v_mfma_f32_16x16x32_bf16 v[148:151], v[92:95], a[88:91], v[148:151]
    v_mfma_f32_16x16x32_bf16 v[152:155], v[80:83], a[76:79], v[152:155]
    buffer_load_dwordx4 v233, s[44:47], s37 offen offset:1024 lds
    v_mfma_f32_16x16x32_bf16 v[152:155], v[84:87], a[92:95], v[152:155]
    v_mfma_f32_16x16x32_bf16 v[156:159], v[88:91], a[76:79], v[156:159]
    v_mfma_f32_16x16x32_bf16 v[156:159], v[92:95], a[92:95], v[156:159]
    s_waitcnt vmcnt(14) lgkmcnt(0)
    v_mfma_f32_16x16x32_bf16 v[160:163], v[64:67], a[64:67], v[160:163]
    ds_read_b128 v[80:83], v224 offset:45056
    s_waitcnt vmcnt(18)
    v_mfma_f32_16x16x32_bf16 v[160:163], v[68:71], a[80:83], v[160:163]
    ds_read_b128 v[84:87], v225 offset:45056
    v_lshlrev_b32_e64 v16, 16, v0
    v_mfma_f32_16x16x32_bf16 v[164:167], v[72:75], a[64:67], v[164:167]
    ds_read_b128 v[88:91], v224 offset:47104
    v_and_b32 v17, 0xffff0000, v0
    v_lshlrev_b32_e64 v18, 16, v1
    v_mfma_f32_16x16x32_bf16 v[164:167], v[76:79], a[80:83], v[164:167]
    ds_read_b128 v[92:95], v225 offset:47104
    v_and_b32 v19, 0xffff0000, v1
    v_mfma_f32_16x16x32_bf16 v[168:171], v[64:67], a[68:71], v[168:171]
    ds_read_b64_tr_b16 a[96:97], v228 offset:0
    v_lshlrev_b32_e64 v20, 16, v2
    v_mfma_f32_16x16x32_bf16 v[168:171], v[68:71], a[84:87], v[168:171]
    ds_read_b64_tr_b16 a[98:99], v228 offset:512
    v_and_b32 v21, 0xffff0000, v2
    v_mfma_f32_16x16x32_bf16 v[172:175], v[72:75], a[68:71], v[172:175]
    ds_read_b64_tr_b16 a[100:101], v229 offset:0
    v_lshlrev_b32_e64 v22, 16, v3
    v_mfma_f32_16x16x32_bf16 v[172:175], v[76:79], a[84:87], v[172:175]
    ds_read_b64_tr_b16 a[102:103], v229 offset:512
    v_and_b32 v23, 0xffff0000, v3
    v_mfma_f32_16x16x32_bf16 v[176:179], v[64:67], a[72:75], v[176:179]
    ds_read_b64_tr_b16 a[104:105], v230 offset:0
    s_add_u32 m0, s35, 16384
    s_and_b32 s33, s85, 1023
    s_lshl_b32 s33, s33, 12
    buffer_load_dwordx4 v234, s[48:51], s33 offen lds
    v_mfma_f32_16x16x32_bf16 v[176:179], v[68:71], a[88:91], v[176:179]
    ds_read_b64_tr_b16 a[106:107], v230 offset:512
    buffer_load_dwordx4 v235, s[48:51], s33 offen offset:1024 lds
    v_mfma_f32_16x16x32_bf16 v[180:183], v[72:75], a[72:75], v[180:183]
    ds_read_b64_tr_b16 a[108:109], v231 offset:0
    s_add_u32 m0, s35, 18432
    s_add_u32 s33, s33, 131072
    buffer_load_dwordx4 v234, s[48:51], s33 offen lds
    v_mfma_f32_16x16x32_bf16 v[180:183], v[76:79], a[88:91], v[180:183]
    ds_read_b64_tr_b16 a[110:111], v231 offset:512
    v_lshlrev_b32 v24, 16, v4
    v_and_b32 v25, 0xffff0000, v4
    v_mfma_f32_16x16x32_bf16 v[184:187], v[64:67], a[76:79], v[184:187]
    buffer_load_dwordx4 v235, s[48:51], s33 offen offset:1024 lds
    v_lshlrev_b32_e64 v26, 16, v5
    v_mfma_f32_16x16x32_bf16 v[184:187], v[68:71], a[92:95], v[184:187]
    s_lshl2_add_u32 s26, s4, s3
    s_lshl_b32 s26, s26, 10
    s_add_u32 s26, s26, s32
    s_add_u32 s26, s26, 131072
    v_mfma_f32_16x16x32_bf16 v[188:191], v[72:75], a[76:79], v[188:191]
    v_and_b32 v226, 0x40000380, v251
    buffer_load_dword v241, v226, s[44:47], s26 offen
    v_mfma_f32_16x16x32_bf16 v[188:191], v[76:79], a[92:95], v[188:191]
    s_waitcnt vmcnt(29) lgkmcnt(0)
    s_barrier
    v_mfma_f32_16x16x32_bf16 v[192:195], v[80:83], a[64:67], v[192:195]
    ds_read_b128 v[64:67], v224 offset:49152
    v_and_b32 v27, 0xffff0000, v5
    v_mfma_f32_16x16x32_bf16 v[192:195], v[84:87], a[80:83], v[192:195]
    ds_read_b128 v[68:71], v225 offset:49152
    v_lshlrev_b32 v28, 16, v6
    v_mfma_f32_16x16x32_bf16 v[196:199], v[88:91], a[64:67], v[196:199]
    ds_read_b128 v[72:75], v224 offset:51200
    v_and_b32 v29, 0xffff0000, v6
    v_mfma_f32_16x16x32_bf16 v[196:199], v[92:95], a[80:83], v[196:199]
    ds_read_b128 v[76:79], v225 offset:51200
    v_lshlrev_b32_e64 v30, 16, v7
    v_and_b32 v31, 0xffff0000, v7
    v_mfma_f32_16x16x32_bf16 v[200:203], v[80:83], a[68:71], v[200:203]
    ds_read_b64_tr_b16 a[112:113], v228 offset:4096
    v_lshlrev_b32_e64 v32, 16, v8
    v_mfma_f32_16x16x32_bf16 v[200:203], v[84:87], a[84:87], v[200:203]
    ds_read_b64_tr_b16 a[114:115], v228 offset:4608
    v_and_b32 v33, 0xffff0000, v8
    v_mfma_f32_16x16x32_bf16 v[204:207], v[88:91], a[68:71], v[204:207]
    ds_read_b64_tr_b16 a[116:117], v229 offset:4096
    v_lshlrev_b32_e64 v34, 16, v9
    v_mfma_f32_16x16x32_bf16 v[204:207], v[92:95], a[84:87], v[204:207]
    ds_read_b64_tr_b16 a[118:119], v229 offset:4608
    v_and_b32 v35, 0xffff0000, v9
    v_mfma_f32_16x16x32_bf16 v[208:211], v[80:83], a[72:75], v[208:211]
    ds_read_b64_tr_b16 a[120:121], v230 offset:4096
    s_add_u32 m0, s34, 32768
    s_add_u32 s37, s86, 0
    buffer_load_dwordx4 v232, s[44:47], s37 offen lds
    v_mfma_f32_16x16x32_bf16 v[208:211], v[84:87], a[88:91], v[208:211]
    ds_read_b64_tr_b16 a[122:123], v230 offset:4608
    v_lshlrev_b32 v36, 16, v10
    v_mfma_f32_16x16x32_bf16 v[212:215], v[88:91], a[72:75], v[212:215]
    ds_read_b64_tr_b16 a[124:125], v231 offset:4096
    v_and_b32 v37, 0xffff0000, v10
    v_lshlrev_b32_e64 v38, 16, v11
    v_mfma_f32_16x16x32_bf16 v[212:215], v[92:95], a[88:91], v[212:215]
    ds_read_b64_tr_b16 a[126:127], v231 offset:4608
    v_and_b32 v39, 0xffff0000, v11
    v_mfma_f32_16x16x32_bf16 v[216:219], v[80:83], a[76:79], v[216:219]
    buffer_load_dwordx4 v233, s[44:47], s37 offen offset:1024 lds
    v_lshlrev_b32_e64 v40, 16, v12
    v_mfma_f32_16x16x32_bf16 v[216:219], v[84:87], a[92:95], v[216:219]
    v_and_b32 v41, 0xffff0000, v12
    v_lshlrev_b32_e64 v42, 16, v13
    v_mfma_f32_16x16x32_bf16 v[220:223], v[88:91], a[76:79], v[220:223]
    v_and_b32 v43, 0xffff0000, v13
    v_lshlrev_b32_e64 v44, 16, v14
    v_and_b32 v45, 0xffff0000, v14
    v_mfma_f32_16x16x32_bf16 v[220:223], v[92:95], a[92:95], v[220:223]
    v_lshlrev_b32 v46, 16, v15
    s_waitcnt lgkmcnt(0)
    v_mfma_f32_16x16x32_bf16 v[96:99], v[64:67], a[96:99], v[96:99]
    ds_read_b128 v[80:83], v224 offset:53248
    v_and_b32 v47, 0xffff0000, v15
    v_mfma_f32_16x16x32_bf16 v[96:99], v[68:71], a[112:115], v[96:99]
    ds_read_b128 v[84:87], v225 offset:53248
    v_add_f32_e64 v52, v16, v20
    v_mfma_f32_16x16x32_bf16 v[100:103], v[72:75], a[96:99], v[100:103]
    ds_read_b128 v[88:91], v224 offset:55296
    v_add_f32_e64 v53, v17, v21
    v_mfma_f32_16x16x32_bf16 v[100:103], v[76:79], a[112:115], v[100:103]
    ds_read_b128 v[92:95], v225 offset:55296
    v_add_f32 v54, v18, v22
    v_add_f32 v55, v19, v23
    v_mfma_f32_16x16x32_bf16 v[104:107], v[64:67], a[100:103], v[104:107]
    v_add_f32 v52, v52, v24
    v_add_f32 v53, v53, v25
    v_mfma_f32_16x16x32_bf16 v[104:107], v[68:71], a[116:119], v[104:107]
    v_add_f32 v54, v54, v26
    v_add_f32 v55, v55, v27
    v_mfma_f32_16x16x32_bf16 v[108:111], v[72:75], a[100:103], v[108:111]
    v_add_f32 v52, v52, v28
    v_add_f32 v53, v53, v29
    v_add_f32_e64 v54, v54, v30
    v_mfma_f32_16x16x32_bf16 v[108:111], v[76:79], a[116:119], v[108:111]
    v_add_f32 v55, v55, v31
    v_add_f32 v52, v52, v32
    v_mfma_f32_16x16x32_bf16 v[112:115], v[64:67], a[104:107], v[112:115]
    s_add_u32 m0, s35, 20480
    s_add_u32 s33, s33, 131072
    buffer_load_dwordx4 v234, s[48:51], s33 offen lds
    v_mfma_f32_16x16x32_bf16 v[112:115], v[68:71], a[120:123], v[112:115]
    v_add_f32 v53, v53, v33
    v_add_f32 v54, v54, v34
    v_mfma_f32_16x16x32_bf16 v[116:119], v[72:75], a[104:107], v[116:119]
    buffer_load_dwordx4 v235, s[48:51], s33 offen offset:1024 lds
    v_add_f32 v55, v55, v35
    v_add_f32 v52, v52, v36
    v_mfma_f32_16x16x32_bf16 v[116:119], v[76:79], a[120:123], v[116:119]
    v_add_f32 v53, v53, v37
    v_add_f32 v54, v54, v38
    v_mfma_f32_16x16x32_bf16 v[120:123], v[64:67], a[108:111], v[120:123]
    s_add_u32 m0, s35, 22528
    s_add_u32 s33, s33, 131072
    buffer_load_dwordx4 v234, s[48:51], s33 offen lds
    v_mfma_f32_16x16x32_bf16 v[120:123], v[68:71], a[124:127], v[120:123]
    v_add_f32 v55, v55, v39
    v_add_f32 v52, v52, v40
    v_mfma_f32_16x16x32_bf16 v[124:127], v[72:75], a[108:111], v[124:127]
    buffer_load_dwordx4 v235, s[48:51], s33 offen offset:1024 lds
    v_add_f32 v53, v53, v41
    v_add_f32 v54, v54, v42
    v_mfma_f32_16x16x32_bf16 v[124:127], v[76:79], a[124:127], v[124:127]
    v_add_f32 v55, v55, v43
    s_waitcnt lgkmcnt(0)
    v_mfma_f32_16x16x32_bf16 v[128:131], v[80:83], a[96:99], v[128:131]
    ds_read_b128 v[64:67], v224 offset:57344
    v_add_f32_e64 v52, v52, v44
    v_mfma_f32_16x16x32_bf16 v[128:131], v[84:87], a[112:115], v[128:131]
    ds_read_b128 v[68:71], v225 offset:57344
    v_add_f32_e64 v53, v53, v45
    v_mfma_f32_16x16x32_bf16 v[132:135], v[88:91], a[96:99], v[132:135]
    ds_read_b128 v[72:75], v224 offset:59392
    v_add_f32_e64 v54, v54, v46
    v_mfma_f32_16x16x32_bf16 v[132:135], v[92:95], a[112:115], v[132:135]
    ds_read_b128 v[76:79], v225 offset:59392
    v_add_f32 v55, v55, v47
    v_add_f32 v52, v52, v53
    v_mfma_f32_16x16x32_bf16 v[136:139], v[80:83], a[100:103], v[136:139]
    v_add_f32 v54, v54, v55
    v_add_f32 v48, v52, v54
    v_mfma_f32_16x16x32_bf16 v[136:139], v[84:87], a[116:119], v[136:139]
    s_nop 1
    v_add_f32_dpp v48, v48, v48 quad_perm:[1,0,3,2] row_mask:0xf bank_mask:0xf
    v_mfma_f32_16x16x32_bf16 v[140:143], v[88:91], a[100:103], v[140:143]
    s_nop 1
    v_add_f32_dpp v48, v48, v48 quad_perm:[2,3,0,1] row_mask:0xf bank_mask:0xf
    s_nop 1
    v_mfma_f32_16x16x32_bf16 v[140:143], v[92:95], a[116:119], v[140:143]
    v_add_f32_dpp v48, v48, v48 row_half_mirror row_mask:0xf bank_mask:0xf
    s_nop 1
    v_mfma_f32_16x16x32_bf16 v[144:147], v[80:83], a[104:107], v[144:147]
    s_add_u32 m0, s34, 40960
    s_add_u32 s37, s86, 65536
    buffer_load_dwordx4 v232, s[44:47], s37 offen lds
    v_mfma_f32_16x16x32_bf16 v[144:147], v[84:87], a[120:123], v[144:147]
    v_add_f32_dpp v48, v48, v48 row_mirror row_mask:0xf bank_mask:0xf
    s_nop 0
    v_mfma_f32_16x16x32_bf16 v[148:151], v[88:91], a[104:107], v[148:151]
    buffer_load_dwordx4 v233, s[44:47], s37 offen offset:1024 lds
    v_mov_b32_e64 v49, v48
    s_nop 1
    v_mfma_f32_16x16x32_bf16 v[148:151], v[92:95], a[120:123], v[148:151]
    v_permlane16_swap_b32 v48, v49
    s_nop 0
    v_mfma_f32_16x16x32_bf16 v[152:155], v[80:83], a[108:111], v[152:155]
    v_lshlrev_b32_e64 v227, 3, v240
    v_min_u32 v227, 1920, v227
    s_lshl2_add_u32 s25, s2, s3
    v_mfma_f32_16x16x32_bf16 v[152:155], v[84:87], a[124:127], v[152:155]
    v_add_f32 v48, v48, v49
    v_mul_f32 v48, 0x3a800000, v48
    v_mfma_f32_16x16x32_bf16 v[156:159], v[88:91], a[108:111], v[156:159]
    s_lshl_b32 s25, s25, 13
    s_add_u32 s25, s25, 0
    buffer_load_dword v241, v227, s[12:15], s25 offen
    v_mfma_f32_16x16x32_bf16 v[156:159], v[92:95], a[124:127], v[156:159]
    v_sub_f32 v56, v16, v48
    s_waitcnt vmcnt(16) lgkmcnt(0)
    v_mfma_f32_16x16x32_bf16 v[160:163], v[64:67], a[96:99], v[160:163]
    ds_read_b128 v[80:83], v224 offset:61440
    v_mul_f32 v52, v56, v56
    v_sub_f32 v57, v17, v48
    v_mfma_f32_16x16x32_bf16 v[160:163], v[68:71], a[112:115], v[160:163]
    ds_read_b128 v[84:87], v225 offset:61440
    v_mul_f32_e64 v53, v57, v57
    v_mfma_f32_16x16x32_bf16 v[164:167], v[72:75], a[96:99], v[164:167]
    ds_read_b128 v[88:91], v224 offset:63488
    v_sub_f32_e64 v58, v18, v48
    v_mfma_f32_16x16x32_bf16 v[164:167], v[76:79], a[112:115], v[164:167]
    ds_read_b128 v[92:95], v225 offset:63488
    v_mul_f32_e64 v54, v58, v58
    v_mfma_f32_16x16x32_bf16 v[168:171], v[64:67], a[100:103], v[168:171]
    ds_read_b64_tr_b16 a[128:129], v228 offset:8192
    v_sub_f32_e64 v59, v19, v48
    v_mfma_f32_16x16x32_bf16 v[168:171], v[68:71], a[116:119], v[168:171]
    ds_read_b64_tr_b16 a[130:131], v228 offset:8704
    v_mul_f32 v55, v59, v59
    v_sub_f32 v56, v20, v48
    v_mfma_f32_16x16x32_bf16 v[172:175], v[72:75], a[100:103], v[172:175]
    ds_read_b64_tr_b16 a[132:133], v229 offset:8192
    v_fmac_f32_e64 v52, v56, v56
    v_mfma_f32_16x16x32_bf16 v[172:175], v[76:79], a[116:119], v[172:175]
    ds_read_b64_tr_b16 a[134:135], v229 offset:8704
    v_sub_f32_e64 v57, v21, v48
    v_mfma_f32_16x16x32_bf16 v[176:179], v[64:67], a[104:107], v[176:179]
    ds_read_b64_tr_b16 a[136:137], v230 offset:8192
    s_add_u32 m0, s35, 0
    s_and_b32 s33, s86, 1023
    s_lshl_b32 s33, s33, 12
    buffer_load_dwordx4 v234, s[48:51], s33 offen lds
    v_mfma_f32_16x16x32_bf16 v[176:179], v[68:71], a[120:123], v[176:179]
    ds_read_b64_tr_b16 a[138:139], v230 offset:8704
    v_fmac_f32_e64 v53, v57, v57
    v_mfma_f32_16x16x32_bf16 v[180:183], v[72:75], a[104:107], v[180:183]
    ds_read_b64_tr_b16 a[140:141], v231 offset:8192
    buffer_load_dwordx4 v235, s[48:51], s33 offen offset:1024 lds
    v_mfma_f32_16x16x32_bf16 v[180:183], v[76:79], a[120:123], v[180:183]
    ds_read_b64_tr_b16 a[142:143], v231 offset:8704
    v_sub_f32_e64 v58, v22, v48
    v_mfma_f32_16x16x32_bf16 v[184:187], v[64:67], a[108:111], v[184:187]
    s_add_u32 m0, s35, 2048
    s_add_u32 s33, s33, 131072
    buffer_load_dwordx4 v234, s[48:51], s33 offen lds
    v_mfma_f32_16x16x32_bf16 v[184:187], v[68:71], a[124:127], v[184:187]
    v_fmac_f32 v54, v58, v58
    v_sub_f32 v59, v23, v48
    v_fmac_f32_e64 v55, v59, v59
    v_mfma_f32_16x16x32_bf16 v[188:191], v[72:75], a[108:111], v[188:191]
    buffer_load_dwordx4 v235, s[48:51], s33 offen offset:1024 lds
    v_sub_f32_e64 v56, v24, v48
    v_mfma_f32_16x16x32_bf16 v[188:191], v[76:79], a[124:127], v[188:191]
    s_waitcnt vmcnt(30) lgkmcnt(0)
    s_barrier
    v_mfma_f32_16x16x32_bf16 v[192:195], v[80:83], a[96:99], v[192:195]
    ds_read_b128 v[64:67], v224 offset:0
    v_fmac_f32_e64 v52, v56, v56
    v_mfma_f32_16x16x32_bf16 v[192:195], v[84:87], a[112:115], v[192:195]
    ds_read_b128 v[68:71], v225 offset:0
    v_sub_f32_e64 v57, v25, v48
    v_mfma_f32_16x16x32_bf16 v[196:199], v[88:91], a[96:99], v[196:199]
    ds_read_b128 v[72:75], v224 offset:2048
    v_fmac_f32_e64 v53, v57, v57
    v_mfma_f32_16x16x32_bf16 v[196:199], v[92:95], a[112:115], v[196:199]
    ds_read_b128 v[76:79], v225 offset:2048
    v_sub_f32 v58, v26, v48
    v_fmac_f32 v54, v58, v58
    v_mfma_f32_16x16x32_bf16 v[200:203], v[80:83], a[100:103], v[200:203]
    ds_read_b64_tr_b16 a[144:145], v228 offset:12288
    v_sub_f32_e64 v59, v27, v48
    v_mfma_f32_16x16x32_bf16 v[200:203], v[84:87], a[116:119], v[200:203]
    ds_read_b64_tr_b16 a[146:147], v228 offset:12800
    v_fmac_f32_e64 v55, v59, v59
    v_mfma_f32_16x16x32_bf16 v[204:207], v[88:91], a[100:103], v[204:207]
    ds_read_b64_tr_b16 a[148:149], v229 offset:12288
    v_sub_f32_e64 v56, v28, v48
    v_mfma_f32_16x16x32_bf16 v[204:207], v[92:95], a[116:119], v[204:207]
    ds_read_b64_tr_b16 a[150:151], v229 offset:12800
    v_fmac_f32_e64 v52, v56, v56
    v_mfma_f32_16x16x32_bf16 v[208:211], v[80:83], a[104:107], v[208:211]
    ds_read_b64_tr_b16 a[152:153], v230 offset:12288
    s_add_u32 m0, s34, 49152
    s_add_u32 s37, s87, 0
    buffer_load_dwordx4 v232, s[44:47], s37 offen lds
    v_mfma_f32_16x16x32_bf16 v[208:211], v[84:87], a[120:123], v[208:211]
    ds_read_b64_tr_b16 a[154:155], v230 offset:12800
    v_sub_f32 v57, v29, v48
    v_mfma_f32_16x16x32_bf16 v[212:215], v[88:91], a[104:107], v[212:215]
    ds_read_b64_tr_b16 a[156:157], v231 offset:12288
    v_fmac_f32 v53, v57, v57
    v_sub_f32 v58, v30, v48
    v_mfma_f32_16x16x32_bf16 v[212:215], v[92:95], a[120:123], v[212:215]
    ds_read_b64_tr_b16 a[158:159], v231 offset:12800
    v_fmac_f32_e64 v54, v58, v58
    v_mfma_f32_16x16x32_bf16 v[216:219], v[80:83], a[108:111], v[216:219]
    buffer_load_dwordx4 v233, s[44:47], s37 offen offset:1024 lds
    v_sub_f32_e64 v59, v31, v48
    v_mfma_f32_16x16x32_bf16 v[216:219], v[84:87], a[124:127], v[216:219]
    v_fmac_f32 v55, v59, v59
    v_sub_f32 v56, v32, v48
    v_mfma_f32_16x16x32_bf16 v[220:223], v[88:91], a[108:111], v[220:223]
    v_fmac_f32 v52, v56, v56
    v_sub_f32 v57, v33, v48
    v_fmac_f32_e64 v53, v57, v57
    v_mfma_f32_16x16x32_bf16 v[220:223], v[92:95], a[124:127], v[220:223]
    v_sub_f32 v58, v34, v48
    s_waitcnt lgkmcnt(0)
    v_mfma_f32_16x16x32_bf16 v[96:99], v[64:67], a[128:131], v[96:99]
    ds_read_b128 v[80:83], v224 offset:4096
    v_fmac_f32_e64 v54, v58, v58
    v_mfma_f32_16x16x32_bf16 v[96:99], v[68:71], a[144:147], v[96:99]
    ds_read_b128 v[84:87], v225 offset:4096
    v_sub_f32_e64 v59, v35, v48
    v_mfma_f32_16x16x32_bf16 v[100:103], v[72:75], a[128:131], v[100:103]
    ds_read_b128 v[88:91], v224 offset:6144
    v_fmac_f32_e64 v55, v59, v59
    v_mfma_f32_16x16x32_bf16 v[100:103], v[76:79], a[144:147], v[100:103]
    ds_read_b128 v[92:95], v225 offset:6144
    v_sub_f32 v56, v36, v48
    v_fmac_f32 v52, v56, v56
    v_mfma_f32_16x16x32_bf16 v[104:107], v[64:67], a[132:135], v[104:107]
    v_sub_f32 v57, v37, v48
    v_fmac_f32 v53, v57, v57
    v_mfma_f32_16x16x32_bf16 v[104:107], v[68:71], a[148:151], v[104:107]
    v_sub_f32 v58, v38, v48
    v_fmac_f32 v54, v58, v58
    v_mfma_f32_16x16x32_bf16 v[108:111], v[72:75], a[132:135], v[108:111]
    v_sub_f32 v59, v39, v48
    v_fmac_f32 v55, v59, v59
    v_sub_f32_e64 v56, v40, v48
    v_mfma_f32_16x16x32_bf16 v[108:111], v[76:79], a[148:151], v[108:111]
    v_fmac_f32 v52, v56, v56
    v_sub_f32 v57, v41, v48
    v_mfma_f32_16x16x32_bf16 v[112:115], v[64:67], a[136:139], v[112:115]
    s_add_u32 m0, s35, 4096
    s_add_u32 s33, s33, 131072
    buffer_load_dwordx4 v234, s[48:51], s33 offen lds
    v_mfma_f32_16x16x32_bf16 v[112:115], v[68:71], a[152:155], v[112:115]
    v_fmac_f32 v53, v57, v57
    v_sub_f32 v58, v42, v48
    v_mfma_f32_16x16x32_bf16 v[116:119], v[72:75], a[136:139], v[116:119]
    buffer_load_dwordx4 v235, s[48:51], s33 offen offset:1024 lds
    v_fmac_f32 v54, v58, v58
    v_sub_f32 v59, v43, v48
    v_mfma_f32_16x16x32_bf16 v[116:119], v[76:79], a[152:155], v[116:119]
    v_fmac_f32 v55, v59, v59
    v_sub_f32 v56, v44, v48
    v_mfma_f32_16x16x32_bf16 v[120:123], v[64:67], a[140:143], v[120:123]
    s_add_u32 m0, s35, 6144
    s_add_u32 s33, s33, 131072
    buffer_load_dwordx4 v234, s[48:51], s33 offen lds
    v_mfma_f32_16x16x32_bf16 v[120:123], v[68:71], a[156:159], v[120:123]
    v_fmac_f32 v52, v56, v56
    v_sub_f32 v57, v45, v48
    v_mfma_f32_16x16x32_bf16 v[124:127], v[72:75], a[140:143], v[124:127]
    buffer_load_dwordx4 v235, s[48:51], s33 offen offset:1024 lds
    v_fmac_f32 v53, v57, v57
    v_sub_f32 v58, v46, v48
    v_mfma_f32_16x16x32_bf16 v[124:127], v[76:79], a[156:159], v[124:127]
    v_fmac_f32 v54, v58, v58
    s_waitcnt lgkmcnt(0)
    v_mfma_f32_16x16x32_bf16 v[128:131], v[80:83], a[128:131], v[128:131]
    ds_read_b128 v[64:67], v224 offset:8192
    v_sub_f32_e64 v59, v47, v48
    v_mfma_f32_16x16x32_bf16 v[128:131], v[84:87], a[144:147], v[128:131]
    ds_read_b128 v[68:71], v225 offset:8192
    v_fmac_f32_e64 v55, v59, v59
    v_mfma_f32_16x16x32_bf16 v[132:135], v[88:91], a[128:131], v[132:135]
    ds_read_b128 v[72:75], v224 offset:10240
    v_add_f32_e64 v52, v52, v53
    v_mfma_f32_16x16x32_bf16 v[132:135], v[92:95], a[144:147], v[132:135]
    ds_read_b128 v[76:79], v225 offset:10240
    v_add_f32_e64 v54, v54, v55
    v_mfma_f32_16x16x32_bf16 v[136:139], v[80:83], a[132:135], v[136:139]
    v_add_f32 v51, v52, v54
    s_nop 1
    v_add_f32_dpp v51, v51, v51 quad_perm:[1,0,3,2] row_mask:0xf bank_mask:0xf
    v_mfma_f32_16x16x32_bf16 v[136:139], v[84:87], a[148:151], v[136:139]
    s_nop 1
    v_add_f32_dpp v51, v51, v51 quad_perm:[2,3,0,1] row_mask:0xf bank_mask:0xf
    v_mfma_f32_16x16x32_bf16 v[140:143], v[88:91], a[132:135], v[140:143]
    s_nop 1
    v_add_f32_dpp v51, v51, v51 row_half_mirror row_mask:0xf bank_mask:0xf
    s_nop 1
    v_mfma_f32_16x16x32_bf16 v[140:143], v[92:95], a[148:151], v[140:143]
    v_add_f32_dpp v51, v51, v51 row_mirror row_mask:0xf bank_mask:0xf
    s_nop 0
    v_mfma_f32_16x16x32_bf16 v[144:147], v[80:83], a[136:139], v[144:147]
    s_add_u32 m0, s34, 57344
    s_add_u32 s37, s87, 65536
    buffer_load_dwordx4 v232, s[44:47], s37 offen lds
    v_mfma_f32_16x16x32_bf16 v[144:147], v[84:87], a[152:155], v[144:147]
    v_mov_b32 v49, v51
    s_nop 1
    v_mfma_f32_16x16x32_bf16 v[148:151], v[88:91], a[136:139], v[148:151]
    buffer_load_dwordx4 v233, s[44:47], s37 offen offset:1024 lds
    v_permlane16_swap_b32 v51, v49
    s_nop 0
    v_mfma_f32_16x16x32_bf16 v[148:151], v[92:95], a[152:155], v[148:151]
    v_add_f32_e64 v51, v51, v49
    v_mul_f32 v51, 0x3a800000, v51
    v_mfma_f32_16x16x32_bf16 v[152:155], v[80:83], a[140:143], v[152:155]
    v_lshlrev_b32_e64 v227, 3, v240
    v_min_u32 v227, 1920, v227
    s_lshl2_add_u32 s25, s2, s3
    v_mfma_f32_16x16x32_bf16 v[152:155], v[84:87], a[156:159], v[152:155]
    v_cvt_pk_bf16_f32 v50, v48, v51
    v_and_b32 v51, 0xffff0000, v50
    v_mfma_f32_16x16x32_bf16 v[156:159], v[88:91], a[140:143], v[156:159]
    s_lshl_b32 s25, s25, 13
    s_add_u32 s25, s25, 2048
    buffer_load_dword v241, v227, s[12:15], s25 offen
    v_mfma_f32_16x16x32_bf16 v[156:159], v[92:95], a[156:159], v[156:159]
    v_lshlrev_b32 v50, 16, v50
    s_waitcnt vmcnt(16) lgkmcnt(0)
    v_mfma_f32_16x16x32_bf16 v[160:163], v[64:67], a[128:131], v[160:163]
    ds_read_b128 v[80:83], v224 offset:12288
    v_add_f32 v51, 0x3727c5ac, v51
    v_cvt_pk_bf16_f32 v51, v51, v51
    v_mfma_f32_16x16x32_bf16 v[160:163], v[68:71], a[144:147], v[160:163]
    ds_read_b128 v[84:87], v225 offset:12288
    v_lshlrev_b32_e64 v51, 16, v51
    v_mfma_f32_16x16x32_bf16 v[164:167], v[72:75], a[128:131], v[164:167]
    ds_read_b128 v[88:91], v224 offset:14336
    v_mfma_f32_16x16x32_bf16 v[164:167], v[76:79], a[144:147], v[164:167]
    ds_read_b128 v[92:95], v225 offset:14336
    v_sqrt_f32 v51, v51
    v_mfma_f32_16x16x32_bf16 v[168:171], v[64:67], a[132:135], v[168:171]
    ds_read_b64_tr_b16 a[160:161], v228 offset:16384
    s_nop 0
    v_mfma_f32_16x16x32_bf16 v[168:171], v[68:71], a[148:151], v[168:171]
    ds_read_b64_tr_b16 a[162:163], v228 offset:16896
    v_cvt_pk_bf16_f32 v51, v51, v51
    v_lshlrev_b32_e64 v51, 16, v51
    v_mfma_f32_16x16x32_bf16 v[172:175], v[72:75], a[132:135], v[172:175]
    ds_read_b64_tr_b16 a[164:165], v229 offset:16384
    v_mfma_f32_16x16x32_bf16 v[172:175], v[76:79], a[148:151], v[172:175]
    ds_read_b64_tr_b16 a[166:167], v229 offset:16896
    v_rcp_f32_e64 v51, v51
    v_mfma_f32_16x16x32_bf16 v[176:179], v[64:67], a[136:139], v[176:179]
    ds_read_b64_tr_b16 a[168:169], v230 offset:16384
    s_add_u32 m0, s35, 8192
    s_and_b32 s33, s87, 1023
    s_lshl_b32 s33, s33, 12
    buffer_load_dwordx4 v234, s[48:51], s33 offen lds
    v_mfma_f32_16x16x32_bf16 v[176:179], v[68:71], a[152:155], v[176:179]
    ds_read_b64_tr_b16 a[170:171], v230 offset:16896
    s_nop 0
    v_mfma_f32_16x16x32_bf16 v[180:183], v[72:75], a[136:139], v[180:183]
    ds_read_b64_tr_b16 a[172:173], v231 offset:16384
    buffer_load_dwordx4 v235, s[48:51], s33 offen offset:1024 lds
    v_mfma_f32_16x16x32_bf16 v[180:183], v[76:79], a[152:155], v[180:183]
    ds_read_b64_tr_b16 a[174:175], v231 offset:16896
    v_mul_f32 v51, 0x3e0293ee, v51
    v_mfma_f32_16x16x32_bf16 v[184:187], v[64:67], a[140:143], v[184:187]
    s_add_u32 m0, s35, 10240
    s_add_u32 s33, s33, 131072
    buffer_load_dwordx4 v234, s[48:51], s33 offen lds
    v_mfma_f32_16x16x32_bf16 v[184:187], v[68:71], a[156:159], v[184:187]
    v_sub_f32 v16, v16, v50
    v_sub_f32 v17, v17, v50
    v_cvt_pk_bf16_f32 v17, v16, v17
    v_mfma_f32_16x16x32_bf16 v[188:191], v[72:75], a[140:143], v[188:191]
    buffer_load_dwordx4 v235, s[48:51], s33 offen offset:1024 lds
    v_lshlrev_b32_e64 v16, 16, v17
    v_mfma_f32_16x16x32_bf16 v[188:191], v[76:79], a[156:159], v[188:191]
    s_waitcnt vmcnt(31) lgkmcnt(0)
    s_barrier
    v_mfma_f32_16x16x32_bf16 v[192:195], v[80:83], a[128:131], v[192:195]
    ds_read_b128 v[64:67], v224 offset:16384
    v_and_b32 v17, 0xffff0000, v17
    v_mfma_f32_16x16x32_bf16 v[192:195], v[84:87], a[144:147], v[192:195]
    ds_read_b128 v[68:71], v225 offset:16384
    v_mul_f32_e64 v16, v16, v51
    v_mfma_f32_16x16x32_bf16 v[196:199], v[88:91], a[128:131], v[196:199]
    ds_read_b128 v[72:75], v224 offset:18432
    v_mul_f32_e64 v17, v17, v51
    v_mfma_f32_16x16x32_bf16 v[196:199], v[92:95], a[144:147], v[196:199]
    ds_read_b128 v[76:79], v225 offset:18432
    v_cvt_pk_bf16_f32 v0, v16, v17
    v_sub_f32_e64 v18, v18, v50
    v_mfma_f32_16x16x32_bf16 v[200:203], v[80:83], a[132:135], v[200:203]
    ds_read_b64_tr_b16 a[176:177], v228 offset:20480
    v_sub_f32_e64 v19, v19, v50
    v_mfma_f32_16x16x32_bf16 v[200:203], v[84:87], a[148:151], v[200:203]
    ds_read_b64_tr_b16 a[178:179], v228 offset:20992
    v_cvt_pk_bf16_f32 v19, v18, v19
    v_mfma_f32_16x16x32_bf16 v[204:207], v[88:91], a[132:135], v[204:207]
    ds_read_b64_tr_b16 a[180:181], v229 offset:20480
    v_lshlrev_b32_e64 v18, 16, v19
    v_mfma_f32_16x16x32_bf16 v[204:207], v[92:95], a[148:151], v[204:207]
    ds_read_b64_tr_b16 a[182:183], v229 offset:20992
    v_and_b32 v19, 0xffff0000, v19
    v_mfma_f32_16x16x32_bf16 v[208:211], v[80:83], a[136:139], v[208:211]
    ds_read_b64_tr_b16 a[184:185], v230 offset:20480
    s_add_u32 m0, s34, 0
    s_add_u32 s37, s80, 131072
    buffer_load_dwordx4 v232, s[44:47], s37 offen lds
    v_mfma_f32_16x16x32_bf16 v[208:211], v[84:87], a[152:155], v[208:211]
    ds_read_b64_tr_b16 a[186:187], v230 offset:20992
    v_mul_f32 v18, v18, v51
    v_mfma_f32_16x16x32_bf16 v[212:215], v[88:91], a[136:139], v[212:215]
    ds_read_b64_tr_b16 a[188:189], v231 offset:20480
    v_mul_f32_e64 v19, v19, v51
    v_cvt_pk_bf16_f32 v1, v18, v19
    v_mfma_f32_16x16x32_bf16 v[212:215], v[92:95], a[152:155], v[212:215]
    ds_read_b64_tr_b16 a[190:191], v231 offset:20992
    v_sub_f32_e64 v20, v20, v50
    v_mfma_f32_16x16x32_bf16 v[216:219], v[80:83], a[140:143], v[216:219]
    buffer_load_dwordx4 v233, s[44:47], s37 offen offset:1024 lds
    v_sub_f32_e64 v21, v21, v50
    v_mfma_f32_16x16x32_bf16 v[216:219], v[84:87], a[156:159], v[216:219]
    v_cvt_pk_bf16_f32 v21, v20, v21
    v_lshlrev_b32_e64 v20, 16, v21
    v_mfma_f32_16x16x32_bf16 v[220:223], v[88:91], a[140:143], v[220:223]
    v_and_b32 v21, 0xffff0000, v21
    v_mul_f32 v20, v20, v51
    v_mul_f32 v21, v21, v51
    v_mfma_f32_16x16x32_bf16 v[220:223], v[92:95], a[156:159], v[220:223]
    v_cvt_pk_bf16_f32 v2, v20, v21
    s_waitcnt lgkmcnt(0)
    v_mfma_f32_16x16x32_bf16 v[96:99], v[64:67], a[160:163], v[96:99]
    ds_read_b128 v[80:83], v224 offset:20480
    v_sub_f32 v22, v22, v50
    v_mfma_f32_16x16x32_bf16 v[96:99], v[68:71], a[176:179], v[96:99]
    ds_read_b128 v[84:87], v225 offset:20480
    v_sub_f32_e64 v23, v23, v50
    v_mfma_f32_16x16x32_bf16 v[100:103], v[72:75], a[160:163], v[100:103]
    ds_read_b128 v[88:91], v224 offset:22528
    v_cvt_pk_bf16_f32 v23, v22, v23
    v_mfma_f32_16x16x32_bf16 v[100:103], v[76:79], a[176:179], v[100:103]
    ds_read_b128 v[92:95], v225 offset:22528
    v_lshlrev_b32_e64 v22, 16, v23
    v_and_b32 v23, 0xffff0000, v23
    v_mfma_f32_16x16x32_bf16 v[104:107], v[64:67], a[164:167], v[104:107]
    v_mul_f32 v22, v22, v51
    v_mul_f32 v23, v23, v51
    v_mfma_f32_16x16x32_bf16 v[104:107], v[68:71], a[180:183], v[104:107]
    v_cvt_pk_bf16_f32 v3, v22, v23
    v_sub_f32_e64 v24, v24, v50
    v_mfma_f32_16x16x32_bf16 v[108:111], v[72:75], a[164:167], v[108:111]
    v_sub_f32_e64 v25, v25, v50
    v_cvt_pk_bf16_f32 v25, v24, v25
    v_lshlrev_b32_e64 v24, 16, v25
    v_mfma_f32_16x16x32_bf16 v[108:111], v[76:79], a[180:183], v[108:111]
    v_and_b32 v25, 0xffff0000, v25
    v_mul_f32_e64 v24, v24, v51
    v_mfma_f32_16x16x32_bf16 v[112:115], v[64:67], a[168:171], v[112:115]
    s_add_u32 m0, s35, 12288
    s_add_u32 s33, s33, 131072
    buffer_load_dwordx4 v234, s[48:51], s33 offen lds
    v_mfma_f32_16x16x32_bf16 v[112:115], v[68:71], a[184:187], v[112:115]
    v_mul_f32_e64 v25, v25, v51
    v_cvt_pk_bf16_f32 v4, v24, v25
    v_mfma_f32_16x16x32_bf16 v[116:119], v[72:75], a[168:171], v[116:119]
    buffer_load_dwordx4 v235, s[48:51], s33 offen offset:1024 lds
    v_sub_f32 v26, v26, v50
    v_sub_f32 v27, v27, v50
    v_mfma_f32_16x16x32_bf16 v[116:119], v[76:79], a[184:187], v[116:119]
    v_cvt_pk_bf16_f32 v27, v26, v27
    v_lshlrev_b32_e64 v26, 16, v27
    v_mfma_f32_16x16x32_bf16 v[120:123], v[64:67], a[172:175], v[120:123]
    s_add_u32 m0, s35, 14336
    s_add_u32 s33, s33, 131072
    buffer_load_dwordx4 v234, s[48:51], s33 offen lds
    v_mfma_f32_16x16x32_bf16 v[120:123], v[68:71], a[188:191], v[120:123]
    v_and_b32 v27, 0xffff0000, v27
    v_mul_f32_e64 v26, v26, v51
    v_mfma_f32_16x16x32_bf16 v[124:127], v[72:75], a[172:175], v[124:127]
    buffer_load_dwordx4 v235, s[48:51], s33 offen offset:1024 lds
    v_mul_f32_e64 v27, v27, v51
    v_cvt_pk_bf16_f32 v5, v26, v27
    v_mfma_f32_16x16x32_bf16 v[124:127], v[76:79], a[188:191], v[124:127]
    v_sub_f32 v28, v28, v50
    s_waitcnt lgkmcnt(0)
    v_mfma_f32_16x16x32_bf16 v[128:131], v[80:83], a[160:163], v[128:131]
    ds_read_b128 v[64:67], v224 offset:24576
    v_sub_f32_e64 v29, v29, v50
    v_mfma_f32_16x16x32_bf16 v[128:131], v[84:87], a[176:179], v[128:131]
    ds_read_b128 v[68:71], v225 offset:24576
    v_cvt_pk_bf16_f32 v29, v28, v29
    v_mfma_f32_16x16x32_bf16 v[132:135], v[88:91], a[160:163], v[132:135]
    ds_read_b128 v[72:75], v224 offset:26624
    v_lshlrev_b32_e64 v28, 16, v29
    v_mfma_f32_16x16x32_bf16 v[132:135], v[92:95], a[176:179], v[132:135]
    ds_read_b128 v[76:79], v225 offset:26624
    v_and_b32 v29, 0xffff0000, v29
    v_mfma_f32_16x16x32_bf16 v[136:139], v[80:83], a[164:167], v[136:139]
    v_mul_f32 v28, v28, v51
    v_mul_f32 v29, v29, v51
    v_cvt_pk_bf16_f32 v6, v28, v29
    v_mfma_f32_16x16x32_bf16 v[136:139], v[84:87], a[180:183], v[136:139]
    v_sub_f32 v30, v30, v50
    v_sub_f32 v31, v31, v50
    v_mfma_f32_16x16x32_bf16 v[140:143], v[88:91], a[164:167], v[140:143]
    v_cvt_pk_bf16_f32 v31, v30, v31
    v_lshlrev_b32_e64 v30, 16, v31
    v_and_b32 v31, 0xffff0000, v31
    v_mfma_f32_16x16x32_bf16 v[140:143], v[92:95], a[180:183], v[140:143]
    v_mul_f32 v30, v30, v51
    v_mul_f32 v31, v31, v51
    v_mfma_f32_16x16x32_bf16 v[144:147], v[80:83], a[168:171], v[144:147]
    s_add_u32 m0, s34, 8192
    s_add_u32 s37, s81, 131072
    buffer_load_dwordx4 v232, s[44:47], s37 offen lds
    v_mfma_f32_16x16x32_bf16 v[144:147], v[84:87], a[184:187], v[144:147]
    v_cvt_pk_bf16_f32 v7, v30, v31
    v_sub_f32_e64 v32, v32, v50
    v_mfma_f32_16x16x32_bf16 v[148:151], v[88:91], a[168:171], v[148:151]
    buffer_load_dwordx4 v233, s[44:47], s37 offen offset:1024 lds
    v_sub_f32_e64 v33, v33, v50
    v_mfma_f32_16x16x32_bf16 v[148:151], v[92:95], a[184:187], v[148:151]
    v_cvt_pk_bf16_f32 v33, v32, v33
    v_lshlrev_b32_e64 v32, 16, v33
    v_and_b32 v33, 0xffff0000, v33
    v_mfma_f32_16x16x32_bf16 v[152:155], v[80:83], a[172:175], v[152:155]
    v_lshlrev_b32_e64 v227, 3, v240
    v_min_u32 v227, 1920, v227
    s_lshl2_add_u32 s25, s2, s3
    v_mfma_f32_16x16x32_bf16 v[152:155], v[84:87], a[188:191], v[152:155]
    v_mul_f32 v32, v32, v51
    v_mul_f32_e64 v33, v33, v51
    v_mfma_f32_16x16x32_bf16 v[156:159], v[88:91], a[172:175], v[156:159]
    s_lshl_b32 s25, s25, 13
    s_add_u32 s25, s25, 4096
    buffer_load_dword v241, v227, s[12:15], s25 offen
    v_mfma_f32_16x16x32_bf16 v[156:159], v[92:95], a[188:191], v[156:159]
    v_cvt_pk_bf16_f32 v8, v32, v33
    s_waitcnt vmcnt(16) lgkmcnt(0)
    v_mfma_f32_16x16x32_bf16 v[160:163], v[64:67], a[160:163], v[160:163]
    ds_read_b128 v[80:83], v224 offset:28672
    v_sub_f32 v34, v34, v50
    v_sub_f32 v35, v35, v50
    v_mfma_f32_16x16x32_bf16 v[160:163], v[68:71], a[176:179], v[160:163]
    ds_read_b128 v[84:87], v225 offset:28672
    v_cvt_pk_bf16_f32 v35, v34, v35
    v_mfma_f32_16x16x32_bf16 v[164:167], v[72:75], a[160:163], v[164:167]
    ds_read_b128 v[88:91], v224 offset:30720
    v_lshlrev_b32_e64 v34, 16, v35
    v_mfma_f32_16x16x32_bf16 v[164:167], v[76:79], a[176:179], v[164:167]
    ds_read_b128 v[92:95], v225 offset:30720
    v_and_b32 v35, 0xffff0000, v35
    v_mfma_f32_16x16x32_bf16 v[168:171], v[64:67], a[164:167], v[168:171]
    ds_read_b64_tr_b16 a[192:193], v228 offset:0
    v_mul_f32_e64 v34, v34, v51
    v_mfma_f32_16x16x32_bf16 v[168:171], v[68:71], a[180:183], v[168:171]
    ds_read_b64_tr_b16 a[194:195], v228 offset:512
    v_mul_f32_e64 v35, v35, v51
    v_cvt_pk_bf16_f32 v9, v34, v35
    v_mfma_f32_16x16x32_bf16 v[172:175], v[72:75], a[164:167], v[172:175]
    ds_read_b64_tr_b16 a[196:197], v229 offset:0
    v_sub_f32_e64 v36, v36, v50
    v_mfma_f32_16x16x32_bf16 v[172:175], v[76:79], a[180:183], v[172:175]
    ds_read_b64_tr_b16 a[198:199], v229 offset:512
    v_sub_f32_e64 v37, v37, v50
    v_mfma_f32_16x16x32_bf16 v[176:179], v[64:67], a[168:171], v[176:179]
    ds_read_b64_tr_b16 a[200:201], v230 offset:0
    v_cvt_pk_bf16_f32 v37, v36, v37
    v_mfma_f32_16x16x32_bf16 v[176:179], v[68:71], a[184:187], v[176:179]
    ds_read_b64_tr_b16 a[202:203], v230 offset:512
    v_lshlrev_b32_e64 v36, 16, v37
    v_mfma_f32_16x16x32_bf16 v[180:183], v[72:75], a[168:171], v[180:183]
    ds_read_b64_tr_b16 a[204:205], v231 offset:0
    v_and_b32 v37, 0xffff0000, v37
    v_mfma_f32_16x16x32_bf16 v[180:183], v[76:79], a[184:187], v[180:183]
    ds_read_b64_tr_b16 a[206:207], v231 offset:512
    v_mul_f32 v36, v36, v51
    v_mul_f32 v37, v37, v51
    v_mfma_f32_16x16x32_bf16 v[184:187], v[64:67], a[172:175], v[184:187]
    v_cvt_pk_bf16_f32 v10, v36, v37
    v_sub_f32_e64 v38, v38, v50
    v_mfma_f32_16x16x32_bf16 v[184:187], v[68:71], a[188:191], v[184:187]
    v_sub_f32_e64 v39, v39, v50
    v_cvt_pk_bf16_f32 v39, v38, v39
    v_mfma_f32_16x16x32_bf16 v[188:191], v[72:75], a[172:175], v[188:191]
    v_lshlrev_b32_e64 v38, 16, v39
    v_and_b32 v39, 0xffff0000, v39
    v_mul_f32_e64 v38, v38, v51
    v_mfma_f32_16x16x32_bf16 v[188:191], v[76:79], a[188:191], v[188:191]
    s_waitcnt vmcnt(27) lgkmcnt(0)
    s_barrier
    v_mfma_f32_16x16x32_bf16 v[192:195], v[80:83], a[160:163], v[192:195]
    ds_read_b128 v[64:67], v224 offset:32768
    v_mul_f32_e64 v39, v39, v51
    v_mfma_f32_16x16x32_bf16 v[192:195], v[84:87], a[176:179], v[192:195]
    ds_read_b128 v[68:71], v225 offset:32768
    v_cvt_pk_bf16_f32 v11, v38, v39
    v_mfma_f32_16x16x32_bf16 v[196:199], v[88:91], a[160:163], v[196:199]
    ds_read_b128 v[72:75], v224 offset:34816
    v_sub_f32_e64 v40, v40, v50
    v_mfma_f32_16x16x32_bf16 v[196:199], v[92:95], a[176:179], v[196:199]
    ds_read_b128 v[76:79], v225 offset:34816
    v_sub_f32_e64 v41, v41, v50
    v_mfma_f32_16x16x32_bf16 v[200:203], v[80:83], a[164:167], v[200:203]
    ds_read_b64_tr_b16 a[208:209], v228 offset:4096
    v_cvt_pk_bf16_f32 v41, v40, v41
    v_lshlrev_b32_e64 v40, 16, v41
    v_mfma_f32_16x16x32_bf16 v[200:203], v[84:87], a[180:183], v[200:203]
    ds_read_b64_tr_b16 a[210:211], v228 offset:4608
    v_and_b32 v41, 0xffff0000, v41
    v_mfma_f32_16x16x32_bf16 v[204:207], v[88:91], a[164:167], v[204:207]
    ds_read_b64_tr_b16 a[212:213], v229 offset:4096
    v_mul_f32_e64 v40, v40, v51
    v_mfma_f32_16x16x32_bf16 v[204:207], v[92:95], a[180:183], v[204:207]
    ds_read_b64_tr_b16 a[214:215], v229 offset:4608
    v_mul_f32_e64 v41, v41, v51
    v_mfma_f32_16x16x32_bf16 v[208:211], v[80:83], a[168:171], v[208:211]
    ds_read_b64_tr_b16 a[216:217], v230 offset:4096
    s_add_u32 m0, s34, 16384
    s_add_u32 s37, s82, 131072
    buffer_load_dwordx4 v232, s[44:47], s37 offen lds
    v_mfma_f32_16x16x32_bf16 v[208:211], v[84:87], a[184:187], v[208:211]
    ds_read_b64_tr_b16 a[218:219], v230 offset:4608
    v_cvt_pk_bf16_f32 v12, v40, v41
    v_mfma_f32_16x16x32_bf16 v[212:215], v[88:91], a[168:171], v[212:215]
    ds_read_b64_tr_b16 a[220:221], v231 offset:4096
    v_sub_f32 v42, v42, v50
    v_sub_f32 v43, v43, v50
    v_mfma_f32_16x16x32_bf16 v[212:215], v[92:95], a[184:187], v[212:215]
    ds_read_b64_tr_b16 a[222:223], v231 offset:4608
    v_cvt_pk_bf16_f32 v43, v42, v43
    v_mfma_f32_16x16x32_bf16 v[216:219], v[80:83], a[172:175], v[216:219]
    buffer_load_dwordx4 v233, s[44:47], s37 offen offset:1024 lds
    v_lshlrev_b32_e64 v42, 16, v43
    v_mfma_f32_16x16x32_bf16 v[216:219], v[84:87], a[188:191], v[216:219]
    v_and_b32 v43, 0xffff0000, v43
    v_mul_f32_e64 v42, v42, v51
    v_mfma_f32_16x16x32_bf16 v[220:223], v[88:91], a[172:175], v[220:223]
    v_mul_f32_e64 v43, v43, v51
    v_cvt_pk_bf16_f32 v13, v42, v43
    v_sub_f32_e64 v44, v44, v50
    v_mfma_f32_16x16x32_bf16 v[220:223], v[92:95], a[188:191], v[220:223]
    v_sub_f32 v45, v45, v50
    s_waitcnt lgkmcnt(0)
    v_mfma_f32_16x16x32_bf16 v[96:99], v[64:67], a[192:195], v[96:99]
    ds_read_b128 v[80:83], v224 offset:36864
    v_cvt_pk_bf16_f32 v45, v44, v45
    v_mfma_f32_16x16x32_bf16 v[96:99], v[68:71], a[208:211], v[96:99]
    ds_read_b128 v[84:87], v225 offset:36864
    v_lshlrev_b32_e64 v44, 16, v45
    v_mfma_f32_16x16x32_bf16 v[100:103], v[72:75], a[192:195], v[100:103]
    ds_read_b128 v[88:91], v224 offset:38912
    v_and_b32 v45, 0xffff0000, v45
    v_mfma_f32_16x16x32_bf16 v[100:103], v[76:79], a[208:211], v[100:103]
    ds_read_b128 v[92:95], v225 offset:38912
    v_mul_f32 v44, v44, v51
    v_mul_f32 v45, v45, v51
    v_mfma_f32_16x16x32_bf16 v[104:107], v[64:67], a[196:199], v[104:107]
    v_cvt_pk_bf16_f32 v14, v44, v45
    v_sub_f32_e64 v46, v46, v50
    v_mfma_f32_16x16x32_bf16 v[104:107], v[68:71], a[212:215], v[104:107]
    v_sub_f32_e64 v47, v47, v50
    v_cvt_pk_bf16_f32 v47, v46, v47
    v_mfma_f32_16x16x32_bf16 v[108:111], v[72:75], a[196:199], v[108:111]
    v_lshlrev_b32_e64 v46, 16, v47
    v_and_b32 v47, 0xffff0000, v47
    v_mul_f32_e64 v46, v46, v51
    v_mfma_f32_16x16x32_bf16 v[108:111], v[76:79], a[212:215], v[108:111]
    v_mul_f32_e64 v47, v47, v51
    v_cvt_pk_bf16_f32 v15, v46, v47
    v_mfma_f32_16x16x32_bf16 v[112:115], v[64:67], a[200:203], v[112:115]
    v_mfma_f32_16x16x32_bf16 v[112:115], v[68:71], a[216:219], v[112:115]
    ds_write_b128 v237, v[0:3] offset:0
    v_mfma_f32_16x16x32_bf16 v[116:119], v[72:75], a[200:203], v[116:119]
    ds_write_b128 v237, v[4:7] offset:4096
    v_mfma_f32_16x16x32_bf16 v[116:119], v[76:79], a[216:219], v[116:119]
    ds_write_b128 v237, v[8:11] offset:24576
    v_mfma_f32_16x16x32_bf16 v[120:123], v[64:67], a[204:207], v[120:123]
    ds_write_b128 v237, v[12:15] offset:28672
    v_mfma_f32_16x16x32_bf16 v[120:123], v[68:71], a[220:223], v[120:123]
    v_mfma_f32_16x16x32_bf16 v[124:127], v[72:75], a[204:207], v[124:127]
    v_mfma_f32_16x16x32_bf16 v[124:127], v[76:79], a[220:223], v[124:127]
    s_waitcnt lgkmcnt(0)
    v_mfma_f32_16x16x32_bf16 v[128:131], v[80:83], a[192:195], v[128:131]
    ds_read_b128 v[64:67], v224 offset:40960
    v_mfma_f32_16x16x32_bf16 v[128:131], v[84:87], a[208:211], v[128:131]
    ds_read_b128 v[68:71], v225 offset:40960
    v_mfma_f32_16x16x32_bf16 v[132:135], v[88:91], a[192:195], v[132:135]
    ds_read_b128 v[72:75], v224 offset:43008
    v_mfma_f32_16x16x32_bf16 v[132:135], v[92:95], a[208:211], v[132:135]
    ds_read_b128 v[76:79], v225 offset:43008
    v_mfma_f32_16x16x32_bf16 v[136:139], v[80:83], a[196:199], v[136:139]
    v_mfma_f32_16x16x32_bf16 v[136:139], v[84:87], a[212:215], v[136:139]
    v_mfma_f32_16x16x32_bf16 v[140:143], v[88:91], a[196:199], v[140:143]
    v_mfma_f32_16x16x32_bf16 v[140:143], v[92:95], a[212:215], v[140:143]
    v_mfma_f32_16x16x32_bf16 v[144:147], v[80:83], a[200:203], v[144:147]
    s_add_u32 m0, s34, 24576
    s_add_u32 s37, s83, 131072
    buffer_load_dwordx4 v232, s[44:47], s37 offen lds
    v_mfma_f32_16x16x32_bf16 v[144:147], v[84:87], a[216:219], v[144:147]
    buffer_load_dwordx4 v233, s[44:47], s37 offen offset:1024 lds
    v_mfma_f32_16x16x32_bf16 v[148:151], v[88:91], a[200:203], v[148:151]
    v_mfma_f32_16x16x32_bf16 v[148:151], v[92:95], a[216:219], v[148:151]
    v_lshlrev_b32 v227, 3, v240
    v_min_u32 v227, 1920, v227
    s_lshl2_add_u32 s25, s2, s3
    v_mfma_f32_16x16x32_bf16 v[152:155], v[80:83], a[204:207], v[152:155]
    s_lshl_b32 s25, s25, 13
    s_add_u32 s25, s25, 6144
    buffer_load_dword v241, v227, s[12:15], s25 offen
    v_mfma_f32_16x16x32_bf16 v[152:155], v[84:87], a[220:223], v[152:155]
    v_mfma_f32_16x16x32_bf16 v[156:159], v[88:91], a[204:207], v[156:159]
    buffer_load_dword v254, off, s[88:91], s97 sc1
    v_mfma_f32_16x16x32_bf16 v[156:159], v[92:95], a[220:223], v[156:159]
    s_waitcnt vmcnt(9) lgkmcnt(0)
    v_mfma_f32_16x16x32_bf16 v[160:163], v[64:67], a[192:195], v[160:163]
    ds_read_b128 v[80:83], v224 offset:45056
    v_mfma_f32_16x16x32_bf16 v[160:163], v[68:71], a[208:211], v[160:163]
    ds_read_b128 v[84:87], v225 offset:45056
    s_mul_i32 s38, s2, 100
    v_mfma_f32_16x16x32_bf16 v[164:167], v[72:75], a[192:195], v[164:167]
    ds_read_b128 v[88:91], v224 offset:47104
    v_mfma_f32_16x16x32_bf16 v[164:167], v[76:79], a[208:211], v[164:167]
    ds_read_b128 v[92:95], v225 offset:47104
    v_lshl_add_u32 v60, v253, 2, s38
    v_mfma_f32_16x16x32_bf16 v[168:171], v[64:67], a[196:199], v[168:171]
    ds_read_b64_tr_b16 a[224:225], v228 offset:8192
    v_mfma_f32_16x16x32_bf16 v[168:171], v[68:71], a[212:215], v[168:171]
    ds_read_b64_tr_b16 a[226:227], v228 offset:8704
    v_cmp_gt_u32 vcc, 25, v253
    v_mfma_f32_16x16x32_bf16 v[172:175], v[72:75], a[196:199], v[172:175]
    ds_read_b64_tr_b16 a[228:229], v229 offset:8192
    v_mfma_f32_16x16x32_bf16 v[172:175], v[76:79], a[212:215], v[172:175]
    ds_read_b64_tr_b16 a[230:231], v229 offset:8704
    v_mov_b32_e64 v61, 0
    v_mfma_f32_16x16x32_bf16 v[176:179], v[64:67], a[200:203], v[176:179]
    ds_read_b64_tr_b16 a[232:233], v230 offset:8192
    v_mfma_f32_16x16x32_bf16 v[176:179], v[68:71], a[216:219], v[176:179]
    ds_read_b64_tr_b16 a[234:235], v230 offset:8704
    v_mfma_f32_16x16x32_bf16 v[180:183], v[72:75], a[200:203], v[180:183]
    ds_read_b64_tr_b16 a[236:237], v231 offset:8192
    v_mov_b32 v62, 0x7ffffff0
    v_mfma_f32_16x16x32_bf16 v[180:183], v[76:79], a[216:219], v[180:183]
    ds_read_b64_tr_b16 a[238:239], v231 offset:8704
    v_mfma_f32_16x16x32_bf16 v[184:187], v[64:67], a[204:207], v[184:187]
    v_cndmask_b32 v60, v62, v60, vcc
    v_mfma_f32_16x16x32_bf16 v[184:187], v[68:71], a[220:223], v[184:187]
    buffer_store_dword v61, v60, s[56:59], 0 offen sc1
    v_mfma_f32_16x16x32_bf16 v[188:191], v[72:75], a[204:207], v[188:191]
    v_mfma_f32_16x16x32_bf16 v[188:191], v[76:79], a[220:223], v[188:191]
    s_waitcnt vmcnt(21) lgkmcnt(0)
    s_barrier
    v_mfma_f32_16x16x32_bf16 v[192:195], v[80:83], a[192:195], v[192:195]
    ds_read_b128 v[64:67], v224 offset:49152
    v_mfma_f32_16x16x32_bf16 v[192:195], v[84:87], a[208:211], v[192:195]
    ds_read_b128 v[68:71], v225 offset:49152
    v_mfma_f32_16x16x32_bf16 v[196:199], v[88:91], a[192:195], v[196:199]
    ds_read_b128 v[72:75], v224 offset:51200
    v_mfma_f32_16x16x32_bf16 v[196:199], v[92:95], a[208:211], v[196:199]
    ds_read_b128 v[76:79], v225 offset:51200
    v_mfma_f32_16x16x32_bf16 v[200:203], v[80:83], a[196:199], v[200:203]
    ds_read_b64_tr_b16 a[240:241], v228 offset:12288
    v_mfma_f32_16x16x32_bf16 v[200:203], v[84:87], a[212:215], v[200:203]
    ds_read_b64_tr_b16 a[242:243], v228 offset:12800
    v_mfma_f32_16x16x32_bf16 v[204:207], v[88:91], a[196:199], v[204:207]
    ds_read_b64_tr_b16 a[244:245], v229 offset:12288
    v_mfma_f32_16x16x32_bf16 v[204:207], v[92:95], a[212:215], v[204:207]
    ds_read_b64_tr_b16 a[246:247], v229 offset:12800
    v_mfma_f32_16x16x32_bf16 v[208:211], v[80:83], a[200:203], v[208:211]
    ds_read_b64_tr_b16 a[248:249], v230 offset:12288
    v_lshlrev_b32 v237, 4, v253
    v_add_u32 v237, 81920, v237
    ds_read_b128 v[16:19], v237 offset:0
    ds_read_b128 v[20:23], v237 offset:4096
    ds_read_b128 v[24:27], v237 offset:24576
    ds_read_b128 v[28:31], v237 offset:28672
    s_add_u32 m0, s34, 32768
    s_add_u32 s37, s84, 131072
    buffer_load_dwordx4 v232, s[44:47], s37 offen lds
    v_mfma_f32_16x16x32_bf16 v[208:211], v[84:87], a[216:219], v[208:211]
    ds_read_b64_tr_b16 a[250:251], v230 offset:12800
    v_mfma_f32_16x16x32_bf16 v[212:215], v[88:91], a[200:203], v[212:215]
    ds_read_b64_tr_b16 a[252:253], v231 offset:12288
    v_mfma_f32_16x16x32_bf16 v[212:215], v[92:95], a[216:219], v[212:215]
    ds_read_b64_tr_b16 a[254:255], v231 offset:12800
    v_mfma_f32_16x16x32_bf16 v[216:219], v[80:83], a[204:207], v[216:219]
    buffer_load_dwordx4 v233, s[44:47], s37 offen offset:1024 lds
    v_mfma_f32_16x16x32_bf16 v[216:219], v[84:87], a[220:223], v[216:219]
    v_mfma_f32_16x16x32_bf16 v[220:223], v[88:91], a[204:207], v[220:223]
    v_mfma_f32_16x16x32_bf16 v[220:223], v[92:95], a[220:223], v[220:223]
    s_waitcnt lgkmcnt(0)
    v_mfma_f32_16x16x32_bf16 v[96:99], v[64:67], a[224:227], v[96:99]
    ds_read_b128 v[80:83], v224 offset:53248
    v_mfma_f32_16x16x32_bf16 v[96:99], v[68:71], a[240:243], v[96:99]
    ds_read_b128 v[84:87], v225 offset:53248
    v_mfma_f32_16x16x32_bf16 v[100:103], v[72:75], a[224:227], v[100:103]
    ds_read_b128 v[88:91], v224 offset:55296
    v_mfma_f32_16x16x32_bf16 v[100:103], v[76:79], a[240:243], v[100:103]
    ds_read_b128 v[92:95], v225 offset:55296
    v_mfma_f32_16x16x32_bf16 v[104:107], v[64:67], a[228:231], v[104:107]
    v_mfma_f32_16x16x32_bf16 v[104:107], v[68:71], a[244:247], v[104:107]
    s_mov_b32 s39, 0
    buffer_store_dwordx4 v[16:19], v238, s[8:11], s39 offen sc1
    v_mfma_f32_16x16x32_bf16 v[108:111], v[72:75], a[228:231], v[108:111]
    v_mfma_f32_16x16x32_bf16 v[108:111], v[76:79], a[244:247], v[108:111]
    v_mfma_f32_16x16x32_bf16 v[112:115], v[64:67], a[232:235], v[112:115]
    v_mfma_f32_16x16x32_bf16 v[112:115], v[68:71], a[248:251], v[112:115]
    v_mfma_f32_16x16x32_bf16 v[116:119], v[72:75], a[232:235], v[116:119]
    v_mfma_f32_16x16x32_bf16 v[116:119], v[76:79], a[248:251], v[116:119]
    v_mfma_f32_16x16x32_bf16 v[120:123], v[64:67], a[236:239], v[120:123]
    v_mfma_f32_16x16x32_bf16 v[120:123], v[68:71], a[252:255], v[120:123]
    s_mov_b32 s39, 8192
    buffer_store_dwordx4 v[20:23], v238, s[8:11], s39 offen sc1
    v_mfma_f32_16x16x32_bf16 v[124:127], v[72:75], a[236:239], v[124:127]
    v_mfma_f32_16x16x32_bf16 v[124:127], v[76:79], a[252:255], v[124:127]
    s_waitcnt lgkmcnt(0)
    v_mfma_f32_16x16x32_bf16 v[128:131], v[80:83], a[224:227], v[128:131]
    ds_read_b128 v[64:67], v224 offset:57344
    v_mfma_f32_16x16x32_bf16 v[128:131], v[84:87], a[240:243], v[128:131]
    ds_read_b128 v[68:71], v225 offset:57344
    v_mfma_f32_16x16x32_bf16 v[132:135], v[88:91], a[224:227], v[132:135]
    ds_read_b128 v[72:75], v224 offset:59392
    v_mfma_f32_16x16x32_bf16 v[132:135], v[92:95], a[240:243], v[132:135]
    ds_read_b128 v[76:79], v225 offset:59392
    v_mfma_f32_16x16x32_bf16 v[136:139], v[80:83], a[228:231], v[136:139]
    v_mfma_f32_16x16x32_bf16 v[136:139], v[84:87], a[244:247], v[136:139]
    s_mov_b32 s39, 16384
    buffer_store_dwordx4 v[24:27], v238, s[8:11], s39 offen sc1
    v_mfma_f32_16x16x32_bf16 v[140:143], v[88:91], a[228:231], v[140:143]
    v_mfma_f32_16x16x32_bf16 v[140:143], v[92:95], a[244:247], v[140:143]
    v_mfma_f32_16x16x32_bf16 v[144:147], v[80:83], a[232:235], v[144:147]
    s_add_u32 m0, s34, 40960
    s_add_u32 s37, s85, 131072
    buffer_load_dwordx4 v232, s[44:47], s37 offen lds
    v_mfma_f32_16x16x32_bf16 v[144:147], v[84:87], a[248:251], v[144:147]
    v_mfma_f32_16x16x32_bf16 v[148:151], v[88:91], a[232:235], v[148:151]
    v_mfma_f32_16x16x32_bf16 v[148:151], v[92:95], a[248:251], v[148:151]
    v_mfma_f32_16x16x32_bf16 v[152:155], v[80:83], a[236:239], v[152:155]
    buffer_load_dwordx4 v233, s[44:47], s37 offen offset:1024 lds
    v_mfma_f32_16x16x32_bf16 v[152:155], v[84:87], a[252:255], v[152:155]
    s_mov_b32 s39, 24576
    buffer_store_dwordx4 v[28:31], v238, s[8:11], s39 offen sc1
    v_mfma_f32_16x16x32_bf16 v[156:159], v[88:91], a[236:239], v[156:159]
    v_mfma_f32_16x16x32_bf16 v[156:159], v[92:95], a[252:255], v[156:159]
    s_waitcnt lgkmcnt(0)
    v_mfma_f32_16x16x32_bf16 v[160:163], v[64:67], a[224:227], v[160:163]
    ds_read_b128 v[80:83], v224 offset:61440
    v_mfma_f32_16x16x32_bf16 v[160:163], v[68:71], a[240:243], v[160:163]
    ds_read_b128 v[84:87], v225 offset:61440
    v_mfma_f32_16x16x32_bf16 v[164:167], v[72:75], a[224:227], v[164:167]
    ds_read_b128 v[88:91], v224 offset:63488
    v_mfma_f32_16x16x32_bf16 v[164:167], v[76:79], a[240:243], v[164:167]
    ds_read_b128 v[92:95], v225 offset:63488
    v_mfma_f32_16x16x32_bf16 v[168:171], v[64:67], a[228:231], v[168:171]
    v_mfma_f32_16x16x32_bf16 v[168:171], v[68:71], a[244:247], v[168:171]
    v_mfma_f32_16x16x32_bf16 v[172:175], v[72:75], a[228:231], v[172:175]
    v_mfma_f32_16x16x32_bf16 v[172:175], v[76:79], a[244:247], v[172:175]
    v_mfma_f32_16x16x32_bf16 v[176:179], v[64:67], a[232:235], v[176:179]
    v_mfma_f32_16x16x32_bf16 v[176:179], v[68:71], a[248:251], v[176:179]
    v_cvt_pk_bf16_f32 v0, v96, v97
    v_cvt_pk_bf16_f32 v1, v98, v99
    v_mfma_f32_16x16x32_bf16 v[180:183], v[72:75], a[232:235], v[180:183]
    v_cvt_pk_bf16_f32 v2, v100, v101
    v_cvt_pk_bf16_f32 v3, v102, v103
    v_mfma_f32_16x16x32_bf16 v[180:183], v[76:79], a[248:251], v[180:183]
    v_cvt_pk_bf16_f32 v4, v104, v105
    v_cvt_pk_bf16_f32 v5, v106, v107
    v_mfma_f32_16x16x32_bf16 v[184:187], v[64:67], a[236:239], v[184:187]
    v_cvt_pk_bf16_f32 v6, v108, v109
    v_cvt_pk_bf16_f32 v7, v110, v111
    v_mfma_f32_16x16x32_bf16 v[184:187], v[68:71], a[252:255], v[184:187]
    v_cvt_pk_bf16_f32 v8, v112, v113
    v_cvt_pk_bf16_f32 v9, v114, v115
    v_mfma_f32_16x16x32_bf16 v[188:191], v[72:75], a[236:239], v[188:191]
    v_cvt_pk_bf16_f32 v10, v116, v117
    v_cvt_pk_bf16_f32 v11, v118, v119
    v_mfma_f32_16x16x32_bf16 v[188:191], v[76:79], a[252:255], v[188:191]
    v_cvt_pk_bf16_f32 v12, v120, v121
    v_cvt_pk_bf16_f32 v13, v122, v123
    s_waitcnt vmcnt(16) lgkmcnt(0)
    s_barrier
    v_mfma_f32_16x16x32_bf16 v[192:195], v[80:83], a[224:227], v[192:195]
    ds_read_b128 v[64:67], v224 offset:0
    v_cvt_pk_bf16_f32 v14, v124, v125
    v_cvt_pk_bf16_f32 v15, v126, v127
    v_mfma_f32_16x16x32_bf16 v[192:195], v[84:87], a[240:243], v[192:195]
    ds_read_b128 v[68:71], v225 offset:0
    v_cvt_pk_bf16_f32 v16, v128, v129
    v_cvt_pk_bf16_f32 v17, v130, v131
    v_mfma_f32_16x16x32_bf16 v[196:199], v[88:91], a[224:227], v[196:199]
    ds_read_b128 v[72:75], v224 offset:8192
    v_cvt_pk_bf16_f32 v18, v132, v133
    v_cvt_pk_bf16_f32 v19, v134, v135
    v_mfma_f32_16x16x32_bf16 v[196:199], v[92:95], a[240:243], v[196:199]
    ds_read_b128 v[76:79], v225 offset:8192
    v_cvt_pk_bf16_f32 v20, v136, v137
    v_cvt_pk_bf16_f32 v21, v138, v139
    v_mfma_f32_16x16x32_bf16 v[200:203], v[80:83], a[228:231], v[200:203]
    v_cvt_pk_bf16_f32 v22, v140, v141
    v_cvt_pk_bf16_f32 v23, v142, v143
    v_mfma_f32_16x16x32_bf16 v[200:203], v[84:87], a[244:247], v[200:203]
    v_cvt_pk_bf16_f32 v24, v144, v145
    v_cvt_pk_bf16_f32 v25, v146, v147
    v_mfma_f32_16x16x32_bf16 v[204:207], v[88:91], a[228:231], v[204:207]
    v_cvt_pk_bf16_f32 v26, v148, v149
    v_cvt_pk_bf16_f32 v27, v150, v151
    v_mfma_f32_16x16x32_bf16 v[204:207], v[92:95], a[244:247], v[204:207]
    v_cvt_pk_bf16_f32 v28, v152, v153
    v_cvt_pk_bf16_f32 v29, v154, v155
    v_mfma_f32_16x16x32_bf16 v[208:211], v[80:83], a[232:235], v[208:211]
    s_add_u32 m0, s34, 49152
    s_add_u32 s37, s86, 131072
    buffer_load_dwordx4 v232, s[44:47], s37 offen lds
    v_cvt_pk_bf16_f32 v30, v156, v157
    v_cvt_pk_bf16_f32 v31, v158, v159
    v_mfma_f32_16x16x32_bf16 v[208:211], v[84:87], a[248:251], v[208:211]
    v_cvt_pk_bf16_f32 v32, v160, v161
    v_cvt_pk_bf16_f32 v33, v162, v163
    v_mfma_f32_16x16x32_bf16 v[212:215], v[88:91], a[232:235], v[212:215]
    v_cvt_pk_bf16_f32 v34, v164, v165
    v_cvt_pk_bf16_f32 v35, v166, v167
    v_mfma_f32_16x16x32_bf16 v[212:215], v[92:95], a[248:251], v[212:215]
    v_cvt_pk_bf16_f32 v36, v168, v169
    v_cvt_pk_bf16_f32 v37, v170, v171
    v_mfma_f32_16x16x32_bf16 v[216:219], v[80:83], a[236:239], v[216:219]
    buffer_load_dwordx4 v233, s[44:47], s37 offen offset:1024 lds
    v_cvt_pk_bf16_f32 v38, v172, v173
    v_cvt_pk_bf16_f32 v39, v174, v175
    v_mfma_f32_16x16x32_bf16 v[216:219], v[84:87], a[252:255], v[216:219]
    v_cvt_pk_bf16_f32 v40, v176, v177
    v_cvt_pk_bf16_f32 v41, v178, v179
    v_mfma_f32_16x16x32_bf16 v[220:223], v[88:91], a[236:239], v[220:223]
    v_cvt_pk_bf16_f32 v42, v180, v181
    v_cvt_pk_bf16_f32 v43, v182, v183
    v_mfma_f32_16x16x32_bf16 v[220:223], v[92:95], a[252:255], v[220:223]
    v_cvt_pk_bf16_f32 v44, v184, v185
    v_cvt_pk_bf16_f32 v45, v186, v187
    s_waitcnt lgkmcnt(0)
    v_mfma_f32_16x16x32_bf16 v[96:99], v[64:67], a[0:3], 0
    ds_read_b128 v[80:83], v224 offset:2048
    v_cvt_pk_bf16_f32 v46, v188, v189
    v_cvt_pk_bf16_f32 v47, v190, v191
    v_mfma_f32_16x16x32_bf16 v[96:99], v[68:71], a[16:19], v[96:99]
    ds_read_b128 v[84:87], v225 offset:2048
    v_cvt_pk_bf16_f32 v48, v192, v193
    v_cvt_pk_bf16_f32 v49, v194, v195
    v_mfma_f32_16x16x32_bf16 v[96:99], v[72:75], a[32:35], v[96:99]
    ds_read_b128 v[88:91], v224 offset:10240
    v_cvt_pk_bf16_f32 v50, v196, v197
    v_cvt_pk_bf16_f32 v51, v198, v199
    v_mfma_f32_16x16x32_bf16 v[96:99], v[76:79], a[48:51], v[96:99]
    ds_read_b128 v[92:95], v225 offset:10240
    v_cvt_pk_bf16_f32 v52, v200, v201
    v_cvt_pk_bf16_f32 v53, v202, v203
    v_mfma_f32_16x16x32_bf16 v[104:107], v[64:67], a[4:7], 0
    v_cvt_pk_bf16_f32 v54, v204, v205
    v_cvt_pk_bf16_f32 v55, v206, v207
    s_add_u32 s38, s36, 0
    buffer_store_dwordx4 v[0:3], v240, s[16:19], s38 offen offset:0 sc1
    v_mfma_f32_16x16x32_bf16 v[104:107], v[68:71], a[20:23], v[104:107]
    v_cvt_pk_bf16_f32 v56, v208, v209
    v_cvt_pk_bf16_f32 v57, v210, v211
    v_mfma_f32_16x16x32_bf16 v[104:107], v[72:75], a[36:39], v[104:107]
    v_cvt_pk_bf16_f32 v58, v212, v213
    v_cvt_pk_bf16_f32 v59, v214, v215
    v_mfma_f32_16x16x32_bf16 v[104:107], v[76:79], a[52:55], v[104:107]
    v_cvt_pk_bf16_f32 v60, v216, v217
    v_cvt_pk_bf16_f32 v61, v218, v219
    v_mfma_f32_16x16x32_bf16 v[112:115], v[64:67], a[8:11], 0
    v_xor_b32 v237, 16, v245
    v_xor_b32 v238, 16, v246
    v_cvt_pk_bf16_f32 v62, v220, v221
    v_cvt_pk_bf16_f32 v63, v222, v223
    v_mfma_f32_16x16x32_bf16 v[112:115], v[68:71], a[24:27], v[112:115]
    v_mfma_f32_16x16x32_bf16 v[112:115], v[72:75], a[40:43], v[112:115]
    v_mfma_f32_16x16x32_bf16 v[112:115], v[76:79], a[56:59], v[112:115]
    v_mfma_f32_16x16x32_bf16 v[120:123], v[64:67], a[12:15], 0
    v_mfma_f32_16x16x32_bf16 v[120:123], v[68:71], a[28:31], v[120:123]
    v_mfma_f32_16x16x32_bf16 v[120:123], v[72:75], a[44:47], v[120:123]
    v_mfma_f32_16x16x32_bf16 v[120:123], v[76:79], a[60:63], v[120:123]
    s_waitcnt lgkmcnt(0)
    v_mfma_f32_16x16x32_bf16 v[100:103], v[80:83], a[0:3], 0
    ds_read_b128 v[64:67], v224 offset:4096
    v_mfma_f32_16x16x32_bf16 v[100:103], v[84:87], a[16:19], v[100:103]
    ds_read_b128 v[68:71], v225 offset:4096
    v_mfma_f32_16x16x32_bf16 v[100:103], v[88:91], a[32:35], v[100:103]
    ds_read_b128 v[72:75], v224 offset:12288
    v_mfma_f32_16x16x32_bf16 v[100:103], v[92:95], a[48:51], v[100:103]
    ds_read_b128 v[76:79], v225 offset:12288
    v_mfma_f32_16x16x32_bf16 v[108:111], v[80:83], a[4:7], 0
    v_mfma_f32_16x16x32_bf16 v[108:111], v[84:87], a[20:23], v[108:111]
    v_mfma_f32_16x16x32_bf16 v[108:111], v[88:91], a[36:39], v[108:111]
    v_mfma_f32_16x16x32_bf16 v[108:111], v[92:95], a[52:55], v[108:111]
    v_mfma_f32_16x16x32_bf16 v[116:119], v[80:83], a[8:11], 0
    s_add_u32 m0, s34, 57344
    s_add_u32 s37, s87, 131072
    buffer_load_dwordx4 v232, s[44:47], s37 offen lds
    v_mfma_f32_16x16x32_bf16 v[116:119], v[84:87], a[24:27], v[116:119]
    s_add_u32 s38, s36, 0
    buffer_store_dwordx4 v[4:7], v240, s[16:19], s38 offen offset:1024 sc1
    v_mfma_f32_16x16x32_bf16 v[116:119], v[88:91], a[40:43], v[116:119]
    v_mfma_f32_16x16x32_bf16 v[116:119], v[92:95], a[56:59], v[116:119]
    v_mfma_f32_16x16x32_bf16 v[124:127], v[80:83], a[12:15], 0
    buffer_load_dwordx4 v233, s[44:47], s37 offen offset:1024 lds
    v_mfma_f32_16x16x32_bf16 v[124:127], v[84:87], a[28:31], v[124:127]
    v_mfma_f32_16x16x32_bf16 v[124:127], v[88:91], a[44:47], v[124:127]
    v_mfma_f32_16x16x32_bf16 v[124:127], v[92:95], a[60:63], v[124:127]
    s_waitcnt lgkmcnt(0)
    v_mfma_f32_16x16x32_bf16 v[128:131], v[64:67], a[0:3], 0
    ds_read_b128 v[80:83], v224 offset:6144
    v_mfma_f32_16x16x32_bf16 v[128:131], v[68:71], a[16:19], v[128:131]
    ds_read_b128 v[84:87], v225 offset:6144
    v_mfma_f32_16x16x32_bf16 v[128:131], v[72:75], a[32:35], v[128:131]
    ds_read_b128 v[88:91], v224 offset:14336
    v_mfma_f32_16x16x32_bf16 v[128:131], v[76:79], a[48:51], v[128:131]
    ds_read_b128 v[92:95], v225 offset:14336
    v_mfma_f32_16x16x32_bf16 v[136:139], v[64:67], a[4:7], 0
    v_mfma_f32_16x16x32_bf16 v[136:139], v[68:71], a[20:23], v[136:139]
    v_mfma_f32_16x16x32_bf16 v[136:139], v[72:75], a[36:39], v[136:139]
    v_mfma_f32_16x16x32_bf16 v[136:139], v[76:79], a[52:55], v[136:139]
    v_mfma_f32_16x16x32_bf16 v[144:147], v[64:67], a[8:11], 0
    s_waitcnt vmcnt(15)
    v_readfirstlane_b32 s24, v254
    s_lshl_b32 s25, s3, 16
    s_add_u32 s24, s24, s25
    s_cmp_ge_u32 s24, 1
    s_cbranch_scc0 kf_spin35
kf_spinr36:
    v_mfma_f32_16x16x32_bf16 v[144:147], v[68:71], a[24:27], v[144:147]
    v_mfma_f32_16x16x32_bf16 v[144:147], v[72:75], a[40:43], v[144:147]
    v_mfma_f32_16x16x32_bf16 v[144:147], v[76:79], a[56:59], v[144:147]
    v_mfma_f32_16x16x32_bf16 v[152:155], v[64:67], a[12:15], 0
    s_add_u32 s88, s20, 0x14a0000
    s_addc_u32 s89, s21, 0
    s_mov_b32 s90, 20480
    v_mfma_f32_16x16x32_bf16 v[152:155], v[68:71], a[28:31], v[152:155]
    v_mfma_f32_16x16x32_bf16 v[152:155], v[72:75], a[44:47], v[152:155]
    v_mfma_f32_16x16x32_bf16 v[152:155], v[76:79], a[60:63], v[152:155]
    s_add_u32 s38, s36, 0
    buffer_store_dwordx4 v[8:11], v240, s[16:19], s38 offen offset:2048 sc1
    s_waitcnt vmcnt(7) lgkmcnt(0)
    s_barrier
    v_mfma_f32_16x16x32_bf16 v[132:135], v[80:83], a[0:3], 0
    ds_read_b128 v[64:67], v224 offset:16384
    v_mfma_f32_16x16x32_bf16 v[132:135], v[84:87], a[16:19], v[132:135]
    ds_read_b128 v[68:71], v225 offset:16384
    v_mfma_f32_16x16x32_bf16 v[132:135], v[88:91], a[32:35], v[132:135]
    ds_read_b128 v[72:75], v224 offset:24576
    v_mfma_f32_16x16x32_bf16 v[132:135], v[92:95], a[48:51], v[132:135]
    ds_read_b128 v[76:79], v225 offset:24576
    v_mfma_f32_16x16x32_bf16 v[140:143], v[80:83], a[4:7], 0
    v_mfma_f32_16x16x32_bf16 v[140:143], v[84:87], a[20:23], v[140:143]
    v_mfma_f32_16x16x32_bf16 v[140:143], v[88:91], a[36:39], v[140:143]
    v_mfma_f32_16x16x32_bf16 v[140:143], v[92:95], a[52:55], v[140:143]
    v_mfma_f32_16x16x32_bf16 v[148:151], v[80:83], a[8:11], 0
    s_add_u32 m0, s34, 0
    s_add_u32 s37, s80, 196608
    buffer_load_dwordx4 v232, s[44:47], s37 offen lds
    v_mfma_f32_16x16x32_bf16 v[148:151], v[84:87], a[24:27], v[148:151]
    v_mfma_f32_16x16x32_bf16 v[148:151], v[88:91], a[40:43], v[148:151]
    buffer_load_dwordx4 v233, s[44:47], s37 offen offset:1024 lds
    v_mfma_f32_16x16x32_bf16 v[148:151], v[92:95], a[56:59], v[148:151]
    v_mfma_f32_16x16x32_bf16 v[156:159], v[80:83], a[12:15], 0
    v_mfma_f32_16x16x32_bf16 v[156:159], v[84:87], a[28:31], v[156:159]
    s_lshl_b32 s39, s5, 7
    s_add_u32 s39, s39, 8192
    buffer_atomic_add v255, v250, s[88:91], s39 offen sc1
    s_cmp_eq_u32 s3, 0
    s_cselect_b32 s39, s39, s43
    v_mfma_f32_16x16x32_bf16 v[156:159], v[88:91], a[44:47], v[156:159]
    v_mfma_f32_16x16x32_bf16 v[156:159], v[92:95], a[60:63], v[156:159]
    s_waitcnt lgkmcnt(0)
    v_mfma_f32_16x16x32_bf16 v[96:99], v[64:67], a[64:67], v[96:99]
    ds_read_b128 v[80:83], v224 offset:18432
    v_mfma_f32_16x16x32_bf16 v[96:99], v[68:71], a[80:83], v[96:99]
    ds_read_b128 v[84:87], v225 offset:18432
    v_mfma_f32_16x16x32_bf16 v[96:99], v[72:75], a[96:99], v[96:99]
    ds_read_b128 v[88:91], v224 offset:26624
    v_mfma_f32_16x16x32_bf16 v[96:99], v[76:79], a[112:115], v[96:99]
    ds_read_b128 v[92:95], v225 offset:26624
    v_mfma_f32_16x16x32_bf16 v[104:107], v[64:67], a[68:71], v[104:107]
    s_add_u32 s38, s36, 0
    buffer_store_dwordx4 v[12:15], v240, s[16:19], s38 offen offset:3072 sc1
    v_mfma_f32_16x16x32_bf16 v[104:107], v[68:71], a[84:87], v[104:107]
    v_mfma_f32_16x16x32_bf16 v[104:107], v[72:75], a[100:103], v[104:107]
    v_mfma_f32_16x16x32_bf16 v[104:107], v[76:79], a[116:119], v[104:107]
    v_mfma_f32_16x16x32_bf16 v[112:115], v[64:67], a[72:75], v[112:115]
    s_add_u32 m0, s31, 0
    s_add_u32 s24, s27, 0
    buffer_load_dwordx4 v245, s[12:15], s24 offen lds
    v_mfma_f32_16x16x32_bf16 v[112:115], v[68:71], a[88:91], v[112:115]
    v_mfma_f32_16x16x32_bf16 v[112:115], v[72:75], a[104:107], v[112:115]
    v_mfma_f32_16x16x32_bf16 v[112:115], v[76:79], a[120:123], v[112:115]
    v_mfma_f32_16x16x32_bf16 v[120:123], v[64:67], a[76:79], v[120:123]
    v_mfma_f32_16x16x32_bf16 v[120:123], v[68:71], a[92:95], v[120:123]
    v_mfma_f32_16x16x32_bf16 v[120:123], v[72:75], a[108:111], v[120:123]
    v_mfma_f32_16x16x32_bf16 v[120:123], v[76:79], a[124:127], v[120:123]
    s_waitcnt lgkmcnt(0)
    v_mfma_f32_16x16x32_bf16 v[100:103], v[80:83], a[64:67], v[100:103]
    ds_read_b128 v[64:67], v224 offset:20480
    v_mfma_f32_16x16x32_bf16 v[100:103], v[84:87], a[80:83], v[100:103]
    ds_read_b128 v[68:71], v225 offset:20480
    v_mfma_f32_16x16x32_bf16 v[100:103], v[88:91], a[96:99], v[100:103]
    ds_read_b128 v[72:75], v224 offset:28672
    v_mfma_f32_16x16x32_bf16 v[100:103], v[92:95], a[112:115], v[100:103]
    ds_read_b128 v[76:79], v225 offset:28672
    v_mfma_f32_16x16x32_bf16 v[108:111], v[80:83], a[68:71], v[108:111]
    v_mfma_f32_16x16x32_bf16 v[108:111], v[84:87], a[84:87], v[108:111]
    v_mfma_f32_16x16x32_bf16 v[108:111], v[88:91], a[100:103], v[108:111]
    v_mfma_f32_16x16x32_bf16 v[108:111], v[92:95], a[116:119], v[108:111]
    v_mfma_f32_16x16x32_bf16 v[116:119], v[80:83], a[72:75], v[116:119]
    s_add_u32 m0, s34, 8192
    s_add_u32 s37, s81, 196608
    buffer_load_dwordx4 v232, s[44:47], s37 offen lds
    v_mfma_f32_16x16x32_bf16 v[116:119], v[84:87], a[88:91], v[116:119]
    v_mfma_f32_16x16x32_bf16 v[116:119], v[88:91], a[104:107], v[116:119]
    buffer_load_dwordx4 v233, s[44:47], s37 offen offset:1024 lds
    s_add_u32 s38, s36, 8192
    buffer_store_dwordx4 v[16:19], v240, s[16:19], s38 offen offset:0 sc1
    v_mfma_f32_16x16x32_bf16 v[116:119], v[92:95], a[120:123], v[116:119]
    v_mfma_f32_16x16x32_bf16 v[124:127], v[80:83], a[76:79], v[124:127]
    v_mfma_f32_16x16x32_bf16 v[124:127], v[84:87], a[92:95], v[124:127]
    s_add_u32 m0, s31, 1024
    s_add_u32 s24, s27, 32768
    buffer_load_dwordx4 v245, s[12:15], s24 offen lds
    v_mfma_f32_16x16x32_bf16 v[124:127], v[88:91], a[108:111], v[124:127]
    v_mfma_f32_16x16x32_bf16 v[124:127], v[92:95], a[124:127], v[124:127]
    s_waitcnt lgkmcnt(0)
    v_mfma_f32_16x16x32_bf16 v[128:131], v[64:67], a[64:67], v[128:131]
    ds_read_b128 v[80:83], v224 offset:22528
    v_mfma_f32_16x16x32_bf16 v[128:131], v[68:71], a[80:83], v[128:131]
    ds_read_b128 v[84:87], v225 offset:22528
    v_mfma_f32_16x16x32_bf16 v[128:131], v[72:75], a[96:99], v[128:131]
    ds_read_b128 v[88:91], v224 offset:30720
    v_mfma_f32_16x16x32_bf16 v[128:131], v[76:79], a[112:115], v[128:131]
    ds_read_b128 v[92:95], v225 offset:30720
    v_mfma_f32_16x16x32_bf16 v[136:139], v[64:67], a[68:71], v[136:139]
    v_mfma_f32_16x16x32_bf16 v[136:139], v[68:71], a[84:87], v[136:139]
    v_mfma_f32_16x16x32_bf16 v[136:139], v[72:75], a[100:103], v[136:139]
    v_mfma_f32_16x16x32_bf16 v[136:139], v[76:79], a[116:119], v[136:139]
    v_mfma_f32_16x16x32_bf16 v[144:147], v[64:67], a[72:75], v[144:147]
    s_add_u32 m0, s31, 2048
    s_add_u32 s24, s27, 65536
    buffer_load_dwordx4 v237, s[12:15], s24 offen lds
    v_mfma_f32_16x16x32_bf16 v[144:147], v[68:71], a[88:91], v[144:147]
    v_mfma_f32_16x16x32_bf16 v[144:147], v[72:75], a[104:107], v[144:147]
    v_mfma_f32_16x16x32_bf16 v[144:147], v[76:79], a[120:123], v[144:147]
    v_mfma_f32_16x16x32_bf16 v[152:155], v[64:67], a[76:79], v[152:155]
    v_mfma_f32_16x16x32_bf16 v[152:155], v[68:71], a[92:95], v[152:155]
    v_mfma_f32_16x16x32_bf16 v[152:155], v[72:75], a[108:111], v[152:155]
    v_mfma_f32_16x16x32_bf16 v[152:155], v[76:79], a[124:127], v[152:155]
    s_add_u32 s38, s36, 8192
    buffer_store_dwordx4 v[20:23], v240, s[16:19], s38 offen offset:1024 sc1
    s_waitcnt vmcnt(19) lgkmcnt(0)
    s_barrier
    v_mfma_f32_16x16x32_bf16 v[132:135], v[80:83], a[64:67], v[132:135]
    ds_read_b128 v[64:67], v224 offset:32768
    v_mfma_f32_16x16x32_bf16 v[132:135], v[84:87], a[80:83], v[132:135]
    ds_read_b128 v[68:71], v225 offset:32768
    v_mfma_f32_16x16x32_bf16 v[132:135], v[88:91], a[96:99], v[132:135]
    ds_read_b128 v[72:75], v224 offset:40960
    v_mfma_f32_16x16x32_bf16 v[132:135], v[92:95], a[112:115], v[132:135]
    ds_read_b128 v[76:79], v225 offset:40960
    v_mfma_f32_16x16x32_bf16 v[140:143], v[80:83], a[68:71], v[140:143]
    v_mfma_f32_16x16x32_bf16 v[140:143], v[84:87], a[84:87], v[140:143]
    v_mfma_f32_16x16x32_bf16 v[140:143], v[88:91], a[100:103], v[140:143]
    v_mfma_f32_16x16x32_bf16 v[140:143], v[92:95], a[116:119], v[140:143]
    v_mfma_f32_16x16x32_bf16 v[148:151], v[80:83], a[72:75], v[148:151]
    s_add_u32 m0, s34, 16384
    s_add_u32 s37, s82, 196608
    buffer_load_dwordx4 v232, s[44:47], s37 offen lds
    v_mfma_f32_16x16x32_bf16 v[148:151], v[84:87], a[88:91], v[148:151]
    v_mfma_f32_16x16x32_bf16 v[148:151], v[88:91], a[104:107], v[148:151]
    buffer_load_dwordx4 v233, s[44:47], s37 offen offset:1024 lds
    v_mfma_f32_16x16x32_bf16 v[148:151], v[92:95], a[120:123], v[148:151]
    v_mfma_f32_16x16x32_bf16 v[156:159], v[80:83], a[76:79], v[156:159]
    v_mfma_f32_16x16x32_bf16 v[156:159], v[84:87], a[92:95], v[156:159]
    s_add_u32 m0, s31, 3072
    s_add_u32 s24, s27, 98304
    buffer_load_dwordx4 v237, s[12:15], s24 offen lds
    v_mfma_f32_16x16x32_bf16 v[156:159], v[88:91], a[108:111], v[156:159]
    v_mfma_f32_16x16x32_bf16 v[156:159], v[92:95], a[124:127], v[156:159]
    s_waitcnt lgkmcnt(0)
    v_mfma_f32_16x16x32_bf16 v[96:99], v[64:67], a[128:131], v[96:99]
    ds_read_b128 v[80:83], v224 offset:34816
    v_mfma_f32_16x16x32_bf16 v[96:99], v[68:71], a[144:147], v[96:99]
    ds_read_b128 v[84:87], v225 offset:34816
    v_mfma_f32_16x16x32_bf16 v[96:99], v[72:75], a[160:163], v[96:99]
    ds_read_b128 v[88:91], v224 offset:43008
    v_mfma_f32_16x16x32_bf16 v[96:99], v[76:79], a[176:179], v[96:99]
    ds_read_b128 v[92:95], v225 offset:43008
    v_mfma_f32_16x16x32_bf16 v[104:107], v[64:67], a[132:135], v[104:107]
    v_mfma_f32_16x16x32_bf16 v[104:107], v[68:71], a[148:151], v[104:107]
    s_add_u32 s38, s36, 8192
    buffer_store_dwordx4 v[24:27], v240, s[16:19], s38 offen offset:2048 sc1
    v_mfma_f32_16x16x32_bf16 v[104:107], v[72:75], a[164:167], v[104:107]
    v_mfma_f32_16x16x32_bf16 v[104:107], v[76:79], a[180:183], v[104:107]
    v_mfma_f32_16x16x32_bf16 v[112:115], v[64:67], a[136:139], v[112:115]
    s_add_u32 m0, s31, 4096
    s_add_u32 s24, s27, 131072
    buffer_load_dwordx4 v245, s[12:15], s24 offen lds
    v_mfma_f32_16x16x32_bf16 v[112:115], v[68:71], a[152:155], v[112:115]
    v_mfma_f32_16x16x32_bf16 v[112:115], v[72:75], a[168:171], v[112:115]
    v_mfma_f32_16x16x32_bf16 v[112:115], v[76:79], a[184:187], v[112:115]
    v_mfma_f32_16x16x32_bf16 v[120:123], v[64:67], a[140:143], v[120:123]
    v_mfma_f32_16x16x32_bf16 v[120:123], v[68:71], a[156:159], v[120:123]
    v_mfma_f32_16x16x32_bf16 v[120:123], v[72:75], a[172:175], v[120:123]
    v_mfma_f32_16x16x32_bf16 v[120:123], v[76:79], a[188:191], v[120:123]
    s_waitcnt lgkmcnt(0)
    v_mfma_f32_16x16x32_bf16 v[100:103], v[80:83], a[128:131], v[100:103]
    ds_read_b128 v[64:67], v224 offset:36864
    v_mfma_f32_16x16x32_bf16 v[100:103], v[84:87], a[144:147], v[100:103]
    ds_read_b128 v[68:71], v225 offset:36864
    v_mfma_f32_16x16x32_bf16 v[100:103], v[88:91], a[160:163], v[100:103]
    ds_read_b128 v[72:75], v224 offset:45056
    v_mfma_f32_16x16x32_bf16 v[100:103], v[92:95], a[176:179], v[100:103]
    ds_read_b128 v[76:79], v225 offset:45056
    v_mfma_f32_16x16x32_bf16 v[108:111], v[80:83], a[132:135], v[108:111]
    v_mfma_f32_16x16x32_bf16 v[108:111], v[84:87], a[148:151], v[108:111]
    v_mfma_f32_16x16x32_bf16 v[108:111], v[88:91], a[164:167], v[108:111]
    v_mfma_f32_16x16x32_bf16 v[108:111], v[92:95], a[180:183], v[108:111]
    v_mfma_f32_16x16x32_bf16 v[116:119], v[80:83], a[136:139], v[116:119]
    s_add_u32 m0, s34, 24576
    s_add_u32 s37, s83, 196608
    buffer_load_dwordx4 v232, s[44:47], s37 offen lds
    v_mfma_f32_16x16x32_bf16 v[116:119], v[84:87], a[152:155], v[116:119]
    v_mfma_f32_16x16x32_bf16 v[116:119], v[88:91], a[168:171], v[116:119]
    buffer_load_dwordx4 v233, s[44:47], s37 offen offset:1024 lds
    s_add_u32 s38, s36, 8192
    buffer_store_dwordx4 v[28:31], v240, s[16:19], s38 offen offset:3072 sc1
    v_mfma_f32_16x16x32_bf16 v[116:119], v[92:95], a[184:187], v[116:119]
    v_mfma_f32_16x16x32_bf16 v[124:127], v[80:83], a[140:143], v[124:127]
    v_mfma_f32_16x16x32_bf16 v[124:127], v[84:87], a[156:159], v[124:127]
    s_add_u32 m0, s31, 5120
    s_add_u32 s24, s27, 163840
    buffer_load_dwordx4 v245, s[12:15], s24 offen lds
    v_mfma_f32_16x16x32_bf16 v[124:127], v[88:91], a[172:175], v[124:127]
    v_mfma_f32_16x16x32_bf16 v[124:127], v[92:95], a[188:191], v[124:127]
    s_waitcnt lgkmcnt(0)
    v_mfma_f32_16x16x32_bf16 v[128:131], v[64:67], a[128:131], v[128:131]
    ds_read_b128 v[80:83], v224 offset:38912
    v_mfma_f32_16x16x32_bf16 v[128:131], v[68:71], a[144:147], v[128:131]
    ds_read_b128 v[84:87], v225 offset:38912
    v_mfma_f32_16x16x32_bf16 v[128:131], v[72:75], a[160:163], v[128:131]
    ds_read_b128 v[88:91], v224 offset:47104
    v_mfma_f32_16x16x32_bf16 v[128:131], v[76:79], a[176:179], v[128:131]
    ds_read_b128 v[92:95], v225 offset:47104
    v_mfma_f32_16x16x32_bf16 v[136:139], v[64:67], a[132:135], v[136:139]
    v_mfma_f32_16x16x32_bf16 v[136:139], v[68:71], a[148:151], v[136:139]
    v_mfma_f32_16x16x32_bf16 v[136:139], v[72:75], a[164:167], v[136:139]
    v_mfma_f32_16x16x32_bf16 v[136:139], v[76:79], a[180:183], v[136:139]
    v_mfma_f32_16x16x32_bf16 v[144:147], v[64:67], a[136:139], v[144:147]
    s_add_u32 m0, s31, 6144
    s_add_u32 s24, s27, 196608
    buffer_load_dwordx4 v237, s[12:15], s24 offen lds
    v_mfma_f32_16x16x32_bf16 v[144:147], v[68:71], a[152:155], v[144:147]
    v_mfma_f32_16x16x32_bf16 v[144:147], v[72:75], a[168:171], v[144:147]
    v_mfma_f32_16x16x32_bf16 v[144:147], v[76:79], a[184:187], v[144:147]
    v_mfma_f32_16x16x32_bf16 v[152:155], v[64:67], a[140:143], v[152:155]
    v_mfma_f32_16x16x32_bf16 v[152:155], v[68:71], a[156:159], v[152:155]
    v_mfma_f32_16x16x32_bf16 v[152:155], v[72:75], a[172:175], v[152:155]
    v_mfma_f32_16x16x32_bf16 v[152:155], v[76:79], a[188:191], v[152:155]
    s_waitcnt vmcnt(22) lgkmcnt(0)
    s_barrier
    v_mfma_f32_16x16x32_bf16 v[132:135], v[80:83], a[128:131], v[132:135]
    ds_read_b128 v[64:67], v224 offset:49152
    s_add_u32 s38, s36, 32768
    buffer_store_dwordx4 v[32:35], v240, s[16:19], s38 offen offset:1280 sc1
    v_mfma_f32_16x16x32_bf16 v[132:135], v[84:87], a[144:147], v[132:135]
    ds_read_b128 v[68:71], v225 offset:49152
    v_mfma_f32_16x16x32_bf16 v[132:135], v[88:91], a[160:163], v[132:135]
    ds_read_b128 v[72:75], v224 offset:57344
    v_mfma_f32_16x16x32_bf16 v[132:135], v[92:95], a[176:179], v[132:135]
    ds_read_b128 v[76:79], v225 offset:57344
    v_mfma_f32_16x16x32_bf16 v[140:143], v[80:83], a[132:135], v[140:143]
    v_mfma_f32_16x16x32_bf16 v[140:143], v[84:87], a[148:151], v[140:143]
    v_mfma_f32_16x16x32_bf16 v[140:143], v[88:91], a[164:167], v[140:143]
    v_mfma_f32_16x16x32_bf16 v[140:143], v[92:95], a[180:183], v[140:143]
    v_mfma_f32_16x16x32_bf16 v[148:151], v[80:83], a[136:139], v[148:151]
    s_add_u32 m0, s34, 32768
    s_add_u32 s37, s84, 196608
    buffer_load_dwordx4 v232, s[44:47], s37 offen lds
    v_mfma_f32_16x16x32_bf16 v[148:151], v[84:87], a[152:155], v[148:151]
    buffer_load_dwordx4 v233, s[44:47], s37 offen offset:1024 lds
    v_mfma_f32_16x16x32_bf16 v[148:151], v[88:91], a[168:171], v[148:151]
    v_mfma_f32_16x16x32_bf16 v[148:151], v[92:95], a[184:187], v[148:151]
    s_add_u32 m0, s31, 7168
    s_add_u32 s24, s27, 229376
    buffer_load_dwordx4 v237, s[12:15], s24 offen lds
    v_mfma_f32_16x16x32_bf16 v[156:159], v[80:83], a[140:143], v[156:159]
    s_add_u32 s27, s27, 1048576
    s_and_b32 s27, s27, 0x407fffff
    s_cmp_eq_u32 s27, s7
    s_cselect_b32 s27, s43, s27
    v_mfma_f32_16x16x32_bf16 v[156:159], v[84:87], a[156:159], v[156:159]
    v_mfma_f32_16x16x32_bf16 v[156:159], v[88:91], a[172:175], v[156:159]
    s_add_u32 s31, s31, 32768
    s_cmp_ge_u32 s31, 163840
    s_cselect_b32 s24, 98304, 0
    s_sub_u32 s31, s31, s24
    v_mfma_f32_16x16x32_bf16 v[156:159], v[92:95], a[188:191], v[156:159]
    s_waitcnt lgkmcnt(0)
    v_mfma_f32_16x16x32_bf16 v[96:99], v[64:67], a[192:195], v[96:99]
    ds_read_b128 v[80:83], v224 offset:51200
    v_mfma_f32_16x16x32_bf16 v[96:99], v[68:71], a[208:211], v[96:99]
    ds_read_b128 v[84:87], v225 offset:51200
    v_mfma_f32_16x16x32_bf16 v[96:99], v[72:75], a[224:227], v[96:99]
    ds_read_b128 v[88:91], v224 offset:59392
    v_mfma_f32_16x16x32_bf16 v[96:99], v[76:79], a[240:243], v[96:99]
    ds_read_b128 v[92:95], v225 offset:59392
    v_mfma_f32_16x16x32_bf16 v[104:107], v[64:67], a[196:199], v[104:107]
    v_mfma_f32_16x16x32_bf16 v[104:107], v[68:71], a[212:215], v[104:107]
    v_mfma_f32_16x16x32_bf16 v[104:107], v[72:75], a[228:231], v[104:107]
    s_add_u32 s38, s36, 32768
    buffer_store_dwordx4 v[36:39], v240, s[16:19], s38 offen offset:2304 sc1
    v_mfma_f32_16x16x32_bf16 v[104:107], v[76:79], a[244:247], v[104:107]
    v_mfma_f32_16x16x32_bf16 v[112:115], v[64:67], a[200:203], v[112:115]
    v_mfma_f32_16x16x32_bf16 v[112:115], v[68:71], a[216:219], v[112:115]
    v_mfma_f32_16x16x32_bf16 v[112:115], v[72:75], a[232:235], v[112:115]
    v_mfma_f32_16x16x32_bf16 v[112:115], v[76:79], a[248:251], v[112:115]
    v_mfma_f32_16x16x32_bf16 v[120:123], v[64:67], a[204:207], v[120:123]
    v_mfma_f32_16x16x32_bf16 v[120:123], v[68:71], a[220:223], v[120:123]
    v_mfma_f32_16x16x32_bf16 v[120:123], v[72:75], a[236:239], v[120:123]
    v_mfma_f32_16x16x32_bf16 v[120:123], v[76:79], a[252:255], v[120:123]
    s_waitcnt lgkmcnt(0)
    v_mfma_f32_16x16x32_bf16 v[100:103], v[80:83], a[192:195], v[100:103]
    ds_read_b128 v[64:67], v224 offset:53248
    v_mfma_f32_16x16x32_bf16 v[100:103], v[84:87], a[208:211], v[100:103]
    ds_read_b128 v[68:71], v225 offset:53248
    v_mfma_f32_16x16x32_bf16 v[100:103], v[88:91], a[224:227], v[100:103]
    ds_read_b128 v[72:75], v224 offset:61440
    v_mfma_f32_16x16x32_bf16 v[100:103], v[92:95], a[240:243], v[100:103]
    ds_read_b128 v[76:79], v225 offset:61440
    v_mfma_f32_16x16x32_bf16 v[108:111], v[80:83], a[196:199], v[108:111]
    v_mfma_f32_16x16x32_bf16 v[108:111], v[84:87], a[212:215], v[108:111]
    v_mfma_f32_16x16x32_bf16 v[108:111], v[88:91], a[228:231], v[108:111]
    v_mfma_f32_16x16x32_bf16 v[108:111], v[92:95], a[244:247], v[108:111]
    v_mfma_f32_16x16x32_bf16 v[116:119], v[80:83], a[200:203], v[116:119]
    s_add_u32 m0, s34, 40960
    s_add_u32 s37, s85, 196608
    buffer_load_dwordx4 v232, s[44:47], s37 offen lds
    v_mfma_f32_16x16x32_bf16 v[116:119], v[84:87], a[216:219], v[116:119]
    v_mfma_f32_16x16x32_bf16 v[116:119], v[88:91], a[232:235], v[116:119]
    v_mfma_f32_16x16x32_bf16 v[116:119], v[92:95], a[248:251], v[116:119]
    s_add_u32 s38, s36, 32768
    buffer_store_dwordx4 v[40:43], v240, s[16:19], s38 offen offset:3328 sc1
    v_mfma_f32_16x16x32_bf16 v[124:127], v[80:83], a[204:207], v[124:127]
    buffer_load_dwordx4 v233, s[44:47], s37 offen offset:1024 lds
    v_mfma_f32_16x16x32_bf16 v[124:127], v[84:87], a[220:223], v[124:127]
    v_mfma_f32_16x16x32_bf16 v[124:127], v[88:91], a[236:239], v[124:127]
    v_mfma_f32_16x16x32_bf16 v[124:127], v[92:95], a[252:255], v[124:127]
    s_waitcnt lgkmcnt(0)
    v_mfma_f32_16x16x32_bf16 v[128:131], v[64:67], a[192:195], v[128:131]
    ds_read_b128 v[80:83], v224 offset:55296
    v_mfma_f32_16x16x32_bf16 v[128:131], v[68:71], a[208:211], v[128:131]
    ds_read_b128 v[84:87], v225 offset:55296
    v_mfma_f32_16x16x32_bf16 v[128:131], v[72:75], a[224:227], v[128:131]
    ds_read_b128 v[88:91], v224 offset:63488
    v_mfma_f32_16x16x32_bf16 v[128:131], v[76:79], a[240:243], v[128:131]
    ds_read_b128 v[92:95], v225 offset:63488
    v_mfma_f32_16x16x32_bf16 v[136:139], v[64:67], a[196:199], v[136:139]
    v_mfma_f32_16x16x32_bf16 v[136:139], v[68:71], a[212:215], v[136:139]
    v_mfma_f32_16x16x32_bf16 v[136:139], v[72:75], a[228:231], v[136:139]
    v_mfma_f32_16x16x32_bf16 v[136:139], v[76:79], a[244:247], v[136:139]
    v_mfma_f32_16x16x32_bf16 v[144:147], v[64:67], a[200:203], v[144:147]
    s_add_u32 m0, s31, 0
    s_add_u32 s24, s27, 0
    buffer_load_dwordx4 v245, s[12:15], s24 offen lds
    v_mfma_f32_16x16x32_bf16 v[144:147], v[68:71], a[216:219], v[144:147]
    v_mfma_f32_16x16x32_bf16 v[144:147], v[72:75], a[232:235], v[144:147]
    v_mfma_f32_16x16x32_bf16 v[144:147], v[76:79], a[248:251], v[144:147]
    v_mfma_f32_16x16x32_bf16 v[152:155], v[64:67], a[204:207], v[152:155]
    v_mfma_f32_16x16x32_bf16 v[152:155], v[68:71], a[220:223], v[152:155]
    v_mfma_f32_16x16x32_bf16 v[152:155], v[72:75], a[236:239], v[152:155]
    v_mfma_f32_16x16x32_bf16 v[152:155], v[76:79], a[252:255], v[152:155]
    s_waitcnt vmcnt(23) lgkmcnt(0)
    s_barrier
    v_mfma_f32_16x16x32_bf16 v[132:135], v[80:83], a[192:195], v[132:135]
    ds_read_b128 v[64:67], v224 offset:0
    v_mfma_f32_16x16x32_bf16 v[132:135], v[84:87], a[208:211], v[132:135]
    ds_read_b128 v[68:71], v225 offset:0
    s_add_u32 s38, s36, 36864
    buffer_store_dwordx4 v[44:47], v240, s[16:19], s38 offen offset:256 sc1
    v_mfma_f32_16x16x32_bf16 v[132:135], v[88:91], a[224:227], v[132:135]
    ds_read_b128 v[72:75], v224 offset:8192
    v_mfma_f32_16x16x32_bf16 v[132:135], v[92:95], a[240:243], v[132:135]
    ds_read_b128 v[76:79], v225 offset:8192
    v_mfma_f32_16x16x32_bf16 v[140:143], v[80:83], a[196:199], v[140:143]
    v_mfma_f32_16x16x32_bf16 v[140:143], v[84:87], a[212:215], v[140:143]
    v_mfma_f32_16x16x32_bf16 v[140:143], v[88:91], a[228:231], v[140:143]
    v_mfma_f32_16x16x32_bf16 v[140:143], v[92:95], a[244:247], v[140:143]
    v_mfma_f32_16x16x32_bf16 v[148:151], v[80:83], a[200:203], v[148:151]
    s_add_u32 m0, s34, 49152
    s_add_u32 s37, s86, 196608
    buffer_load_dwordx4 v232, s[44:47], s37 offen lds
    v_mfma_f32_16x16x32_bf16 v[148:151], v[84:87], a[216:219], v[148:151]
    v_mfma_f32_16x16x32_bf16 v[148:151], v[88:91], a[232:235], v[148:151]
    buffer_load_dwordx4 v233, s[44:47], s37 offen offset:1024 lds
    v_mfma_f32_16x16x32_bf16 v[148:151], v[92:95], a[248:251], v[148:151]
    v_mfma_f32_16x16x32_bf16 v[156:159], v[80:83], a[204:207], v[156:159]
    v_mfma_f32_16x16x32_bf16 v[156:159], v[84:87], a[220:223], v[156:159]
    s_add_u32 m0, s31, 1024
    s_add_u32 s24, s27, 32768
    buffer_load_dwordx4 v245, s[12:15], s24 offen lds
    v_mfma_f32_16x16x32_bf16 v[156:159], v[88:91], a[236:239], v[156:159]
    v_mfma_f32_16x16x32_bf16 v[156:159], v[92:95], a[252:255], v[156:159]
    s_waitcnt lgkmcnt(0)
    v_mfma_f32_16x16x32_bf16 v[160:163], v[64:67], a[0:3], 0
    ds_read_b128 v[80:83], v224 offset:2048
    v_mfma_f32_16x16x32_bf16 v[160:163], v[68:71], a[16:19], v[160:163]
    ds_read_b128 v[84:87], v225 offset:2048
    v_mfma_f32_16x16x32_bf16 v[160:163], v[72:75], a[32:35], v[160:163]
    ds_read_b128 v[88:91], v224 offset:10240
    v_mfma_f32_16x16x32_bf16 v[160:163], v[76:79], a[48:51], v[160:163]
    ds_read_b128 v[92:95], v225 offset:10240
    v_mfma_f32_16x16x32_bf16 v[168:171], v[64:67], a[4:7], 0
    v_cvt_pk_bf16_f32 v0, v96, v97
    v_cvt_pk_bf16_f32 v1, v98, v99
    v_mfma_f32_16x16x32_bf16 v[168:171], v[68:71], a[20:23], v[168:171]
    v_mfma_f32_16x16x32_bf16 v[168:171], v[72:75], a[36:39], v[168:171]
    v_cvt_pk_bf16_f32 v2, v100, v101
    v_cvt_pk_bf16_f32 v3, v102, v103
    s_add_u32 s38, s36, 40960
    buffer_store_dwordx4 v[48:51], v240, s[16:19], s38 offen offset:1280 sc1
    v_mfma_f32_16x16x32_bf16 v[168:171], v[76:79], a[52:55], v[168:171]
    v_mfma_f32_16x16x32_bf16 v[176:179], v[64:67], a[8:11], 0
    s_add_u32 m0, s31, 2048
    s_add_u32 s24, s27, 65536
    buffer_load_dwordx4 v237, s[12:15], s24 offen lds
    v_cvt_pk_bf16_f32 v4, v104, v105
    v_cvt_pk_bf16_f32 v5, v106, v107
    v_mfma_f32_16x16x32_bf16 v[176:179], v[68:71], a[24:27], v[176:179]
    v_mfma_f32_16x16x32_bf16 v[176:179], v[72:75], a[40:43], v[176:179]
    v_cvt_pk_bf16_f32 v6, v108, v109
    v_cvt_pk_bf16_f32 v7, v110, v111
    v_mfma_f32_16x16x32_bf16 v[176:179], v[76:79], a[56:59], v[176:179]
    v_mfma_f32_16x16x32_bf16 v[184:187], v[64:67], a[12:15], 0
    v_cvt_pk_bf16_f32 v8, v112, v113
    v_cvt_pk_bf16_f32 v9, v114, v115
    v_mfma_f32_16x16x32_bf16 v[184:187], v[68:71], a[28:31], v[184:187]
    v_mfma_f32_16x16x32_bf16 v[184:187], v[72:75], a[44:47], v[184:187]
    v_cvt_pk_bf16_f32 v10, v116, v117
    v_cvt_pk_bf16_f32 v11, v118, v119
    v_mfma_f32_16x16x32_bf16 v[184:187], v[76:79], a[60:63], v[184:187]
    s_waitcnt lgkmcnt(0)
    v_mfma_f32_16x16x32_bf16 v[164:167], v[80:83], a[0:3], 0
    ds_read_b128 v[64:67], v224 offset:4096
    v_cvt_pk_bf16_f32 v12, v120, v121
    v_cvt_pk_bf16_f32 v13, v122, v123
    v_mfma_f32_16x16x32_bf16 v[164:167], v[84:87], a[16:19], v[164:167]
    ds_read_b128 v[68:71], v225 offset:4096
    v_mfma_f32_16x16x32_bf16 v[164:167], v[88:91], a[32:35], v[164:167]
    ds_read_b128 v[72:75], v224 offset:12288
    v_cvt_pk_bf16_f32 v14, v124, v125
    v_cvt_pk_bf16_f32 v15, v126, v127
    v_mfma_f32_16x16x32_bf16 v[164:167], v[92:95], a[48:51], v[164:167]
    ds_read_b128 v[76:79], v225 offset:12288
    v_mfma_f32_16x16x32_bf16 v[172:175], v[80:83], a[4:7], 0
    v_cvt_pk_bf16_f32 v16, v128, v129
    v_cvt_pk_bf16_f32 v17, v130, v131
    v_mfma_f32_16x16x32_bf16 v[172:175], v[84:87], a[20:23], v[172:175]
    v_mfma_f32_16x16x32_bf16 v[172:175], v[88:91], a[36:39], v[172:175]
    v_cvt_pk_bf16_f32 v18, v132, v133
    v_cvt_pk_bf16_f32 v19, v134, v135
    v_mfma_f32_16x16x32_bf16 v[172:175], v[92:95], a[52:55], v[172:175]
    v_mfma_f32_16x16x32_bf16 v[180:183], v[80:83], a[8:11], 0
    s_add_u32 m0, s34, 57344
    s_add_u32 s37, s87, 196608
    buffer_load_dwordx4 v232, s[44:47], s37 offen lds
    v_cvt_pk_bf16_f32 v20, v136, v137
    v_cvt_pk_bf16_f32 v21, v138, v139
    v_mfma_f32_16x16x32_bf16 v[180:183], v[84:87], a[24:27], v[180:183]
    v_mfma_f32_16x16x32_bf16 v[180:183], v[88:91], a[40:43], v[180:183]
    buffer_load_dwordx4 v233, s[44:47], s37 offen offset:1024 lds
    v_cvt_pk_bf16_f32 v22, v140, v141
    v_cvt_pk_bf16_f32 v23, v142, v143
    v_mfma_f32_16x16x32_bf16 v[180:183], v[92:95], a[56:59], v[180:183]
    v_mfma_f32_16x16x32_bf16 v[188:191], v[80:83], a[12:15], 0
    v_cvt_pk_bf16_f32 v24, v144, v145
    v_cvt_pk_bf16_f32 v25, v146, v147
    s_add_u32 s38, s36, 40960
    buffer_store_dwordx4 v[52:55], v240, s[16:19], s38 offen offset:2304 sc1
    v_mfma_f32_16x16x32_bf16 v[188:191], v[84:87], a[28:31], v[188:191]
    s_add_u32 m0, s31, 3072
    s_add_u32 s24, s27, 98304
    buffer_load_dwordx4 v237, s[12:15], s24 offen lds
    v_mfma_f32_16x16x32_bf16 v[188:191], v[88:91], a[44:47], v[188:191]
    v_cvt_pk_bf16_f32 v26, v148, v149
    v_cvt_pk_bf16_f32 v27, v150, v151
    v_mfma_f32_16x16x32_bf16 v[188:191], v[92:95], a[60:63], v[188:191]
    s_waitcnt lgkmcnt(0)
    v_mfma_f32_16x16x32_bf16 v[192:195], v[64:67], a[0:3], 0
    ds_read_b128 v[80:83], v224 offset:6144
    v_cvt_pk_bf16_f32 v28, v152, v153
    v_cvt_pk_bf16_f32 v29, v154, v155
    v_mfma_f32_16x16x32_bf16 v[192:195], v[68:71], a[16:19], v[192:195]
    ds_read_b128 v[84:87], v225 offset:6144
    v_mfma_f32_16x16x32_bf16 v[192:195], v[72:75], a[32:35], v[192:195]
    ds_read_b128 v[88:91], v224 offset:14336
    v_cvt_pk_bf16_f32 v30, v156, v157
    v_cvt_pk_bf16_f32 v31, v158, v159
    v_mfma_f32_16x16x32_bf16 v[192:195], v[76:79], a[48:51], v[192:195]
    ds_read_b128 v[92:95], v225 offset:14336
    v_mfma_f32_16x16x32_bf16 v[200:203], v[64:67], a[4:7], 0
    v_mfma_f32_16x16x32_bf16 v[200:203], v[68:71], a[20:23], v[200:203]
    v_mfma_f32_16x16x32_bf16 v[200:203], v[72:75], a[36:39], v[200:203]
    v_mfma_f32_16x16x32_bf16 v[200:203], v[76:79], a[52:55], v[200:203]
    v_mfma_f32_16x16x32_bf16 v[208:211], v[64:67], a[8:11], 0
    s_add_u32 m0, s31, 4096
    s_add_u32 s24, s27, 131072
    buffer_load_dwordx4 v245, s[12:15], s24 offen lds
    v_mfma_f32_16x16x32_bf16 v[208:211], v[68:71], a[24:27], v[208:211]
    v_mfma_f32_16x16x32_bf16 v[208:211], v[72:75], a[40:43], v[208:211]
    v_mfma_f32_16x16x32_bf16 v[208:211], v[76:79], a[56:59], v[208:211]
    v_mfma_f32_16x16x32_bf16 v[216:219], v[64:67], a[12:15], 0
    v_mfma_f32_16x16x32_bf16 v[216:219], v[68:71], a[28:31], v[216:219]
    v_mfma_f32_16x16x32_bf16 v[216:219], v[72:75], a[44:47], v[216:219]
    v_mfma_f32_16x16x32_bf16 v[216:219], v[76:79], a[60:63], v[216:219]
    s_waitcnt vmcnt(23) lgkmcnt(0)
    s_barrier
    v_mfma_f32_16x16x32_bf16 v[196:199], v[80:83], a[0:3], 0
    ds_read_b128 v[64:67], v224 offset:16384
    v_mfma_f32_16x16x32_bf16 v[196:199], v[84:87], a[16:19], v[196:199]
    ds_read_b128 v[68:71], v225 offset:16384
    s_add_u32 s38, s36, 40960
    buffer_store_dwordx4 v[56:59], v240, s[16:19], s38 offen offset:3328 sc1
    v_mfma_f32_16x16x32_bf16 v[196:199], v[88:91], a[32:35], v[196:199]
    ds_read_b128 v[72:75], v224 offset:24576
    v_mfma_f32_16x16x32_bf16 v[196:199], v[92:95], a[48:51], v[196:199]
    ds_read_b128 v[76:79], v225 offset:24576
    v_mfma_f32_16x16x32_bf16 v[204:207], v[80:83], a[4:7], 0
    v_mfma_f32_16x16x32_bf16 v[204:207], v[84:87], a[20:23], v[204:207]
    v_mfma_f32_16x16x32_bf16 v[204:207], v[88:91], a[36:39], v[204:207]
    v_mfma_f32_16x16x32_bf16 v[204:207], v[92:95], a[52:55], v[204:207]
    v_mfma_f32_16x16x32_bf16 v[212:215], v[80:83], a[8:11], 0
    s_add_u32 m0, s31, 5120
    s_add_u32 s24, s27, 163840
    buffer_load_dwordx4 v245, s[12:15], s24 offen lds
    v_mfma_f32_16x16x32_bf16 v[212:215], v[84:87], a[24:27], v[212:215]
    v_mfma_f32_16x16x32_bf16 v[212:215], v[88:91], a[40:43], v[212:215]
    v_mfma_f32_16x16x32_bf16 v[212:215], v[92:95], a[56:59], v[212:215]
    v_mfma_f32_16x16x32_bf16 v[220:223], v[80:83], a[12:15], 0
    v_mfma_f32_16x16x32_bf16 v[220:223], v[84:87], a[28:31], v[220:223]
    v_mfma_f32_16x16x32_bf16 v[220:223], v[88:91], a[44:47], v[220:223]
    v_mfma_f32_16x16x32_bf16 v[220:223], v[92:95], a[60:63], v[220:223]
    s_waitcnt lgkmcnt(0)
    v_mfma_f32_16x16x32_bf16 v[160:163], v[64:67], a[64:67], v[160:163]
    ds_read_b128 v[80:83], v224 offset:18432
    v_mfma_f32_16x16x32_bf16 v[160:163], v[68:71], a[80:83], v[160:163]
    ds_read_b128 v[84:87], v225 offset:18432
    v_mfma_f32_16x16x32_bf16 v[160:163], v[72:75], a[96:99], v[160:163]
    ds_read_b128 v[88:91], v224 offset:26624
    v_mfma_f32_16x16x32_bf16 v[160:163], v[76:79], a[112:115], v[160:163]
    ds_read_b128 v[92:95], v225 offset:26624
    v_mfma_f32_16x16x32_bf16 v[168:171], v[64:67], a[68:71], v[168:171]
    v_mfma_f32_16x16x32_bf16 v[168:171], v[68:71], a[84:87], v[168:171]
    v_mfma_f32_16x16x32_bf16 v[168:171], v[72:75], a[100:103], v[168:171]
    v_mfma_f32_16x16x32_bf16 v[168:171], v[76:79], a[116:119], v[168:171]
    s_add_u32 s38, s36, 45056
    buffer_store_dwordx4 v[60:63], v240, s[16:19], s38 offen offset:256 sc1
    v_mfma_f32_16x16x32_bf16 v[176:179], v[64:67], a[72:75], v[176:179]
    s_add_u32 m0, s31, 6144
    s_add_u32 s24, s27, 196608
    buffer_load_dwordx4 v237, s[12:15], s24 offen lds
    v_mfma_f32_16x16x32_bf16 v[176:179], v[68:71], a[88:91], v[176:179]
    v_mfma_f32_16x16x32_bf16 v[176:179], v[72:75], a[104:107], v[176:179]
    v_mfma_f32_16x16x32_bf16 v[176:179], v[76:79], a[120:123], v[176:179]
    v_mfma_f32_16x16x32_bf16 v[184:187], v[64:67], a[76:79], v[184:187]
    v_mfma_f32_16x16x32_bf16 v[184:187], v[68:71], a[92:95], v[184:187]
    v_mfma_f32_16x16x32_bf16 v[184:187], v[72:75], a[108:111], v[184:187]
    v_mfma_f32_16x16x32_bf16 v[184:187], v[76:79], a[124:127], v[184:187]
    s_waitcnt lgkmcnt(0)
    v_mfma_f32_16x16x32_bf16 v[164:167], v[80:83], a[64:67], v[164:167]
    ds_read_b128 v[64:67], v224 offset:20480
    v_mfma_f32_16x16x32_bf16 v[164:167], v[84:87], a[80:83], v[164:167]
    ds_read_b128 v[68:71], v225 offset:20480
    v_mfma_f32_16x16x32_bf16 v[164:167], v[88:91], a[96:99], v[164:167]
    ds_read_b128 v[72:75], v224 offset:28672
    v_mfma_f32_16x16x32_bf16 v[164:167], v[92:95], a[112:115], v[164:167]
    ds_read_b128 v[76:79], v225 offset:28672
    v_mfma_f32_16x16x32_bf16 v[172:175], v[80:83], a[68:71], v[172:175]
    v_mfma_f32_16x16x32_bf16 v[172:175], v[84:87], a[84:87], v[172:175]
    v_mfma_f32_16x16x32_bf16 v[172:175], v[88:91], a[100:103], v[172:175]
    v_mfma_f32_16x16x32_bf16 v[172:175], v[92:95], a[116:119], v[172:175]
    v_mfma_f32_16x16x32_bf16 v[180:183], v[80:83], a[72:75], v[180:183]
    s_add_u32 m0, s31, 7168
    s_add_u32 s24, s27, 229376
    buffer_load_dwordx4 v237, s[12:15], s24 offen lds
    v_mfma_f32_16x16x32_bf16 v[180:183], v[84:87], a[88:91], v[180:183]
    v_mfma_f32_16x16x32_bf16 v[180:183], v[88:91], a[104:107], v[180:183]
    s_add_u32 s27, s27, 1048576
    s_and_b32 s27, s27, 0x407fffff
    s_cmp_eq_u32 s27, s7
    s_cselect_b32 s27, s43, s27
    v_mfma_f32_16x16x32_bf16 v[180:183], v[92:95], a[120:123], v[180:183]
    v_mfma_f32_16x16x32_bf16 v[188:191], v[80:83], a[76:79], v[188:191]
    v_mfma_f32_16x16x32_bf16 v[188:191], v[84:87], a[92:95], v[188:191]
    s_add_u32 s31, s31, 32768
    s_cmp_ge_u32 s31, 163840
    s_cselect_b32 s24, 98304, 0
    s_sub_u32 s31, s31, s24
    s_add_u32 s38, s36, 65536
    buffer_store_dwordx4 v[0:3], v240, s[16:19], s38 offen offset:2560 sc1
    v_mfma_f32_16x16x32_bf16 v[188:191], v[88:91], a[108:111], v[188:191]
    v_mfma_f32_16x16x32_bf16 v[188:191], v[92:95], a[124:127], v[188:191]
    s_waitcnt lgkmcnt(0)
    v_mfma_f32_16x16x32_bf16 v[192:195], v[64:67], a[64:67], v[192:195]
    ds_read_b128 v[80:83], v224 offset:22528
    v_mfma_f32_16x16x32_bf16 v[192:195], v[68:71], a[80:83], v[192:195]
    ds_read_b128 v[84:87], v225 offset:22528
    v_mfma_f32_16x16x32_bf16 v[192:195], v[72:75], a[96:99], v[192:195]
    ds_read_b128 v[88:91], v224 offset:30720
    v_mfma_f32_16x16x32_bf16 v[192:195], v[76:79], a[112:115], v[192:195]
    ds_read_b128 v[92:95], v225 offset:30720
    v_mfma_f32_16x16x32_bf16 v[200:203], v[64:67], a[68:71], v[200:203]
    v_mfma_f32_16x16x32_bf16 v[200:203], v[68:71], a[84:87], v[200:203]
    v_mfma_f32_16x16x32_bf16 v[200:203], v[72:75], a[100:103], v[200:203]
    v_mfma_f32_16x16x32_bf16 v[200:203], v[76:79], a[116:119], v[200:203]
    v_mfma_f32_16x16x32_bf16 v[208:211], v[64:67], a[72:75], v[208:211]
    v_mfma_f32_16x16x32_bf16 v[208:211], v[68:71], a[88:91], v[208:211]
    v_mfma_f32_16x16x32_bf16 v[208:211], v[72:75], a[104:107], v[208:211]
    v_mfma_f32_16x16x32_bf16 v[208:211], v[76:79], a[120:123], v[208:211]
    v_mfma_f32_16x16x32_bf16 v[216:219], v[64:67], a[76:79], v[216:219]
    v_mfma_f32_16x16x32_bf16 v[216:219], v[68:71], a[92:95], v[216:219]
    v_mfma_f32_16x16x32_bf16 v[216:219], v[72:75], a[108:111], v[216:219]
    v_mfma_f32_16x16x32_bf16 v[216:219], v[76:79], a[124:127], v[216:219]
    s_waitcnt vmcnt(9) lgkmcnt(0)
    s_barrier
    v_mfma_f32_16x16x32_bf16 v[196:199], v[80:83], a[64:67], v[196:199]
    ds_read_b128 v[64:67], v224 offset:32768
    v_mfma_f32_16x16x32_bf16 v[196:199], v[84:87], a[80:83], v[196:199]
    ds_read_b128 v[68:71], v225 offset:32768
    v_mfma_f32_16x16x32_bf16 v[196:199], v[88:91], a[96:99], v[196:199]
    ds_read_b128 v[72:75], v224 offset:40960
    s_add_u32 s38, s36, 65536
    buffer_store_dwordx4 v[4:7], v240, s[16:19], s38 offen offset:3584 sc1
    v_mfma_f32_16x16x32_bf16 v[196:199], v[92:95], a[112:115], v[196:199]
    ds_read_b128 v[76:79], v225 offset:40960
    v_mfma_f32_16x16x32_bf16 v[204:207], v[80:83], a[68:71], v[204:207]
    v_mfma_f32_16x16x32_bf16 v[204:207], v[84:87], a[84:87], v[204:207]
    v_mfma_f32_16x16x32_bf16 v[204:207], v[88:91], a[100:103], v[204:207]
    v_mfma_f32_16x16x32_bf16 v[204:207], v[92:95], a[116:119], v[204:207]
    v_mfma_f32_16x16x32_bf16 v[212:215], v[80:83], a[72:75], v[212:215]
    v_mfma_f32_16x16x32_bf16 v[212:215], v[84:87], a[88:91], v[212:215]
    v_mfma_f32_16x16x32_bf16 v[212:215], v[88:91], a[104:107], v[212:215]
    v_mfma_f32_16x16x32_bf16 v[212:215], v[92:95], a[120:123], v[212:215]
    v_mfma_f32_16x16x32_bf16 v[220:223], v[80:83], a[76:79], v[220:223]
    v_mfma_f32_16x16x32_bf16 v[220:223], v[84:87], a[92:95], v[220:223]
    v_mfma_f32_16x16x32_bf16 v[220:223], v[88:91], a[108:111], v[220:223]
    v_mfma_f32_16x16x32_bf16 v[220:223], v[92:95], a[124:127], v[220:223]
    s_waitcnt lgkmcnt(0)
    v_mfma_f32_16x16x32_bf16 v[160:163], v[64:67], a[128:131], v[160:163]
    ds_read_b128 v[80:83], v224 offset:34816
    v_mfma_f32_16x16x32_bf16 v[160:163], v[68:71], a[144:147], v[160:163]
    ds_read_b128 v[84:87], v225 offset:34816
    v_mfma_f32_16x16x32_bf16 v[160:163], v[72:75], a[160:163], v[160:163]
    ds_read_b128 v[88:91], v224 offset:43008
    v_mfma_f32_16x16x32_bf16 v[160:163], v[76:79], a[176:179], v[160:163]
    ds_read_b128 v[92:95], v225 offset:43008
    v_mfma_f32_16x16x32_bf16 v[168:171], v[64:67], a[132:135], v[168:171]
    v_mfma_f32_16x16x32_bf16 v[168:171], v[68:71], a[148:151], v[168:171]
    v_mfma_f32_16x16x32_bf16 v[168:171], v[72:75], a[164:167], v[168:171]
    v_mfma_f32_16x16x32_bf16 v[168:171], v[76:79], a[180:183], v[168:171]
    v_mfma_f32_16x16x32_bf16 v[176:179], v[64:67], a[136:139], v[176:179]
    buffer_load_dword v254, off, s[88:91], s39 sc1
    s_add_u32 s38, s36, 69632
    buffer_store_dwordx4 v[8:11], v240, s[16:19], s38 offen offset:512 sc1
    v_mfma_f32_16x16x32_bf16 v[176:179], v[68:71], a[152:155], v[176:179]
    v_mfma_f32_16x16x32_bf16 v[176:179], v[72:75], a[168:171], v[176:179]
    v_mfma_f32_16x16x32_bf16 v[176:179], v[76:79], a[184:187], v[176:179]
    v_mfma_f32_16x16x32_bf16 v[184:187], v[64:67], a[140:143], v[184:187]
    v_mfma_f32_16x16x32_bf16 v[184:187], v[68:71], a[156:159], v[184:187]
    v_mfma_f32_16x16x32_bf16 v[184:187], v[72:75], a[172:175], v[184:187]
    v_mfma_f32_16x16x32_bf16 v[184:187], v[76:79], a[188:191], v[184:187]
    s_waitcnt lgkmcnt(0)
    v_mfma_f32_16x16x32_bf16 v[164:167], v[80:83], a[128:131], v[164:167]
    ds_read_b128 v[64:67], v224 offset:36864
    v_mfma_f32_16x16x32_bf16 v[164:167], v[84:87], a[144:147], v[164:167]
    ds_read_b128 v[68:71], v225 offset:36864
    v_mfma_f32_16x16x32_bf16 v[164:167], v[88:91], a[160:163], v[164:167]
    ds_read_b128 v[72:75], v224 offset:45056
    v_mfma_f32_16x16x32_bf16 v[164:167], v[92:95], a[176:179], v[164:167]
    ds_read_b128 v[76:79], v225 offset:45056
    v_mfma_f32_16x16x32_bf16 v[172:175], v[80:83], a[132:135], v[172:175]
    v_mfma_f32_16x16x32_bf16 v[172:175], v[84:87], a[148:151], v[172:175]
    v_mfma_f32_16x16x32_bf16 v[172:175], v[88:91], a[164:167], v[172:175]
    v_mfma_f32_16x16x32_bf16 v[172:175], v[92:95], a[180:183], v[172:175]
    v_mfma_f32_16x16x32_bf16 v[180:183], v[80:83], a[136:139], v[180:183]
    v_mfma_f32_16x16x32_bf16 v[180:183], v[84:87], a[152:155], v[180:183]
    v_mfma_f32_16x16x32_bf16 v[180:183], v[88:91], a[168:171], v[180:183]
    v_mfma_f32_16x16x32_bf16 v[180:183], v[92:95], a[184:187], v[180:183]
    v_mfma_f32_16x16x32_bf16 v[188:191], v[80:83], a[140:143], v[188:191]
    v_mfma_f32_16x16x32_bf16 v[188:191], v[84:87], a[156:159], v[188:191]
    s_add_u32 s38, s36, 69632
    buffer_store_dwordx4 v[12:15], v240, s[16:19], s38 offen offset:1536 sc1
    v_mfma_f32_16x16x32_bf16 v[188:191], v[88:91], a[172:175], v[188:191]
    v_mfma_f32_16x16x32_bf16 v[188:191], v[92:95], a[188:191], v[188:191]
    s_waitcnt lgkmcnt(0)
    v_mfma_f32_16x16x32_bf16 v[192:195], v[64:67], a[128:131], v[192:195]
    ds_read_b128 v[80:83], v224 offset:38912
    v_mfma_f32_16x16x32_bf16 v[192:195], v[68:71], a[144:147], v[192:195]
    ds_read_b128 v[84:87], v225 offset:38912
    v_mfma_f32_16x16x32_bf16 v[192:195], v[72:75], a[160:163], v[192:195]
    ds_read_b128 v[88:91], v224 offset:47104
    v_mfma_f32_16x16x32_bf16 v[192:195], v[76:79], a[176:179], v[192:195]
    ds_read_b128 v[92:95], v225 offset:47104
    v_mfma_f32_16x16x32_bf16 v[200:203], v[64:67], a[132:135], v[200:203]
    v_mfma_f32_16x16x32_bf16 v[200:203], v[68:71], a[148:151], v[200:203]
    v_mfma_f32_16x16x32_bf16 v[200:203], v[72:75], a[164:167], v[200:203]
    v_mfma_f32_16x16x32_bf16 v[200:203], v[76:79], a[180:183], v[200:203]
    v_mfma_f32_16x16x32_bf16 v[208:211], v[64:67], a[136:139], v[208:211]
    v_mfma_f32_16x16x32_bf16 v[208:211], v[68:71], a[152:155], v[208:211]
    v_mfma_f32_16x16x32_bf16 v[208:211], v[72:75], a[168:171], v[208:211]
    v_mfma_f32_16x16x32_bf16 v[208:211], v[76:79], a[184:187], v[208:211]
    v_mfma_f32_16x16x32_bf16 v[216:219], v[64:67], a[140:143], v[216:219]
    v_mfma_f32_16x16x32_bf16 v[216:219], v[68:71], a[156:159], v[216:219]
    v_mfma_f32_16x16x32_bf16 v[216:219], v[72:75], a[172:175], v[216:219]
    v_mfma_f32_16x16x32_bf16 v[216:219], v[76:79], a[188:191], v[216:219]
    s_waitcnt lgkmcnt(0)
    v_mfma_f32_16x16x32_bf16 v[196:199], v[80:83], a[128:131], v[196:199]
    ds_read_b128 v[64:67], v224 offset:49152
    v_mfma_f32_16x16x32_bf16 v[196:199], v[84:87], a[144:147], v[196:199]
    ds_read_b128 v[68:71], v224 offset:51200
    v_mfma_f32_16x16x32_bf16 v[196:199], v[88:91], a[160:163], v[196:199]
    ds_read_b128 v[72:75], v224 offset:53248
    v_mfma_f32_16x16x32_bf16 v[196:199], v[92:95], a[176:179], v[196:199]
    ds_read_b128 v[76:79], v224 offset:55296
    s_add_u32 s38, s36, 73728
    buffer_store_dwordx4 v[16:19], v240, s[16:19], s38 offen offset:2560 sc1
    v_mfma_f32_16x16x32_bf16 v[204:207], v[80:83], a[132:135], v[204:207]
    v_mfma_f32_16x16x32_bf16 v[204:207], v[84:87], a[148:151], v[204:207]
    v_mfma_f32_16x16x32_bf16 v[204:207], v[88:91], a[164:167], v[204:207]
    v_mfma_f32_16x16x32_bf16 v[204:207], v[92:95], a[180:183], v[204:207]
    v_mfma_f32_16x16x32_bf16 v[212:215], v[80:83], a[136:139], v[212:215]
    v_mfma_f32_16x16x32_bf16 v[212:215], v[84:87], a[152:155], v[212:215]
    v_mfma_f32_16x16x32_bf16 v[212:215], v[88:91], a[168:171], v[212:215]
    v_mfma_f32_16x16x32_bf16 v[212:215], v[92:95], a[184:187], v[212:215]
    v_mfma_f32_16x16x32_bf16 v[220:223], v[80:83], a[140:143], v[220:223]
    v_mfma_f32_16x16x32_bf16 v[220:223], v[84:87], a[156:159], v[220:223]
    v_mfma_f32_16x16x32_bf16 v[220:223], v[88:91], a[172:175], v[220:223]
    v_mfma_f32_16x16x32_bf16 v[220:223], v[92:95], a[188:191], v[220:223]
    s_waitcnt vmcnt(3)
    v_readfirstlane_b32 s24, v254
    s_lshl_b32 s25, s3, 16
    s_add_u32 s24, s24, s25
    s_cmp_ge_u32 s24, 32
    s_cbranch_scc0 kf_spin37
kf_spinr38:
    s_waitcnt lgkmcnt(0)
    s_barrier
    v_mfma_f32_16x16x32_bf16 v[160:163], v[64:67], a[192:195], v[160:163]
    ds_read_b128 v[80:83], v225 offset:49152
    v_mfma_f32_16x16x32_bf16 v[164:167], v[68:71], a[192:195], v[164:167]
    ds_read_b128 v[84:87], v225 offset:51200
    v_mfma_f32_16x16x32_bf16 v[168:171], v[64:67], a[196:199], v[168:171]
    ds_read_b128 v[88:91], v225 offset:53248
    v_mfma_f32_16x16x32_bf16 v[172:175], v[68:71], a[196:199], v[172:175]
    ds_read_b128 v[92:95], v225 offset:55296
    v_mfma_f32_16x16x32_bf16 v[176:179], v[64:67], a[200:203], v[176:179]
    v_mfma_f32_16x16x32_bf16 v[180:183], v[68:71], a[200:203], v[180:183]
    v_mfma_f32_16x16x32_bf16 v[184:187], v[64:67], a[204:207], v[184:187]
    v_mfma_f32_16x16x32_bf16 v[188:191], v[68:71], a[204:207], v[188:191]
    v_mfma_f32_16x16x32_bf16 v[192:195], v[72:75], a[192:195], v[192:195]
    buffer_load_dwordx4 a[128:131], v248, s[8:11], s28 offen offset:0 sc1
    s_add_u32 s38, s36, 73728
    buffer_store_dwordx4 v[20:23], v240, s[16:19], s38 offen offset:3584 sc1
    v_mfma_f32_16x16x32_bf16 v[196:199], v[76:79], a[192:195], v[196:199]
    v_mfma_f32_16x16x32_bf16 v[200:203], v[72:75], a[196:199], v[200:203]
    buffer_load_dwordx4 a[132:135], v248, s[8:11], s29 offen offset:0 sc1
    v_mfma_f32_16x16x32_bf16 v[204:207], v[76:79], a[196:199], v[204:207]
    v_mfma_f32_16x16x32_bf16 v[208:211], v[72:75], a[200:203], v[208:211]
    v_mfma_f32_16x16x32_bf16 v[212:215], v[76:79], a[200:203], v[212:215]
    buffer_load_dwordx4 a[136:139], v249, s[8:11], s28 offen offset:0 sc1
    v_mfma_f32_16x16x32_bf16 v[216:219], v[72:75], a[204:207], v[216:219]
    v_mfma_f32_16x16x32_bf16 v[220:223], v[76:79], a[204:207], v[220:223]
    s_waitcnt lgkmcnt(0)
    v_mfma_f32_16x16x32_bf16 v[160:163], v[80:83], a[208:211], v[160:163]
    ds_read_b128 v[64:67], v224 offset:57344
    v_mfma_f32_16x16x32_bf16 v[164:167], v[84:87], a[208:211], v[164:167]
    ds_read_b128 v[68:71], v224 offset:59392
    v_mfma_f32_16x16x32_bf16 v[168:171], v[80:83], a[212:215], v[168:171]
    ds_read_b128 v[72:75], v224 offset:61440
    v_mfma_f32_16x16x32_bf16 v[172:175], v[84:87], a[212:215], v[172:175]
    ds_read_b128 v[76:79], v224 offset:63488
    v_mfma_f32_16x16x32_bf16 v[176:179], v[80:83], a[216:219], v[176:179]
    v_mfma_f32_16x16x32_bf16 v[180:183], v[84:87], a[216:219], v[180:183]
    v_mfma_f32_16x16x32_bf16 v[184:187], v[80:83], a[220:223], v[184:187]
    v_mfma_f32_16x16x32_bf16 v[188:191], v[84:87], a[220:223], v[188:191]
    v_mfma_f32_16x16x32_bf16 v[192:195], v[88:91], a[208:211], v[192:195]
    buffer_load_dwordx4 a[140:143], v249, s[8:11], s29 offen offset:0 sc1
    v_mfma_f32_16x16x32_bf16 v[196:199], v[92:95], a[208:211], v[196:199]
    v_mfma_f32_16x16x32_bf16 v[200:203], v[88:91], a[212:215], v[200:203]
    buffer_load_dwordx4 a[144:147], v248, s[8:11], s28 offen offset:1024 sc1
    v_mfma_f32_16x16x32_bf16 v[204:207], v[92:95], a[212:215], v[204:207]
    v_mfma_f32_16x16x32_bf16 v[208:211], v[88:91], a[216:219], v[208:211]
    v_mfma_f32_16x16x32_bf16 v[212:215], v[92:95], a[216:219], v[212:215]
    buffer_load_dwordx4 a[148:151], v248, s[8:11], s29 offen offset:1024 sc1
    v_mfma_f32_16x16x32_bf16 v[216:219], v[88:91], a[220:223], v[216:219]
    s_add_u32 s38, s36, 77824
    buffer_store_dwordx4 v[24:27], v240, s[16:19], s38 offen offset:512 sc1
    v_mfma_f32_16x16x32_bf16 v[220:223], v[92:95], a[220:223], v[220:223]
    s_waitcnt lgkmcnt(0)
    v_mfma_f32_16x16x32_bf16 v[160:163], v[64:67], a[224:227], v[160:163]
    ds_read_b128 v[80:83], v225 offset:57344
    v_mfma_f32_16x16x32_bf16 v[164:167], v[68:71], a[224:227], v[164:167]
    ds_read_b128 v[84:87], v225 offset:59392
    v_mfma_f32_16x16x32_bf16 v[168:171], v[64:67], a[228:231], v[168:171]
    ds_read_b128 v[88:91], v225 offset:61440
    v_mfma_f32_16x16x32_bf16 v[172:175], v[68:71], a[228:231], v[172:175]
    ds_read_b128 v[92:95], v225 offset:63488
    v_mfma_f32_16x16x32_bf16 v[176:179], v[64:67], a[232:235], v[176:179]
    v_mfma_f32_16x16x32_bf16 v[180:183], v[68:71], a[232:235], v[180:183]
    v_mfma_f32_16x16x32_bf16 v[184:187], v[64:67], a[236:239], v[184:187]
    v_mfma_f32_16x16x32_bf16 v[188:191], v[68:71], a[236:239], v[188:191]
    v_mfma_f32_16x16x32_bf16 v[192:195], v[72:75], a[224:227], v[192:195]
    buffer_load_dwordx4 a[152:155], v249, s[8:11], s28 offen offset:1024 sc1
    v_mfma_f32_16x16x32_bf16 v[196:199], v[76:79], a[224:227], v[196:199]
    v_mfma_f32_16x16x32_bf16 v[200:203], v[72:75], a[228:231], v[200:203]
    buffer_load_dwordx4 a[156:159], v249, s[8:11], s29 offen offset:1024 sc1
    v_mfma_f32_16x16x32_bf16 v[204:207], v[76:79], a[228:231], v[204:207]
    v_mfma_f32_16x16x32_bf16 v[208:211], v[72:75], a[232:235], v[208:211]
    v_mfma_f32_16x16x32_bf16 v[212:215], v[76:79], a[232:235], v[212:215]
    buffer_load_dwordx4 a[160:163], v248, s[8:11], s28 offen offset:2048 sc1
    v_mfma_f32_16x16x32_bf16 v[216:219], v[72:75], a[236:239], v[216:219]
    v_mfma_f32_16x16x32_bf16 v[220:223], v[76:79], a[236:239], v[220:223]
    s_waitcnt vmcnt(38) lgkmcnt(0)
    s_barrier
    v_mfma_f32_16x16x32_bf16 v[160:163], v[80:83], a[240:243], v[160:163]
    ds_read_b64_tr_b16 a[192:193], v246 offset:0
    v_mfma_f32_16x16x32_bf16 v[164:167], v[84:87], a[240:243], v[164:167]
    ds_read_b64_tr_b16 a[194:195], v246 offset:1024
    v_mfma_f32_16x16x32_bf16 v[168:171], v[80:83], a[244:247], v[168:171]
    ds_read_b64_tr_b16 a[196:197], v238 offset:0
    v_mfma_f32_16x16x32_bf16 v[172:175], v[84:87], a[244:247], v[172:175]
    ds_read_b64_tr_b16 a[198:199], v238 offset:1024
    v_mfma_f32_16x16x32_bf16 v[176:179], v[80:83], a[248:251], v[176:179]
    ds_read_b64_tr_b16 a[200:201], v246 offset:256
    s_add_u32 s38, s36, 77824
    buffer_store_dwordx4 v[28:31], v240, s[16:19], s38 offen offset:1536 sc1
    v_mfma_f32_16x16x32_bf16 v[180:183], v[84:87], a[248:251], v[180:183]
    ds_read_b64_tr_b16 a[202:203], v246 offset:1280
    v_mfma_f32_16x16x32_bf16 v[184:187], v[80:83], a[252:255], v[184:187]
    ds_read_b64_tr_b16 a[204:205], v238 offset:256
    v_mfma_f32_16x16x32_bf16 v[188:191], v[84:87], a[252:255], v[188:191]
    ds_read_b64_tr_b16 a[206:207], v238 offset:1280
    v_mfma_f32_16x16x32_bf16 v[192:195], v[88:91], a[240:243], v[192:195]
    buffer_load_dwordx4 a[164:167], v248, s[8:11], s29 offen offset:2048 sc1
    v_mfma_f32_16x16x32_bf16 v[196:199], v[92:95], a[240:243], v[196:199]
    v_cvt_pk_bf16_f32 v32, v160, v161
    v_cvt_pk_bf16_f32 v33, v162, v163
    v_mfma_f32_16x16x32_bf16 v[200:203], v[88:91], a[244:247], v[200:203]
    buffer_load_dwordx4 a[168:171], v249, s[8:11], s28 offen offset:2048 sc1
    v_cvt_pk_bf16_f32 v34, v164, v165
    v_cvt_pk_bf16_f32 v35, v166, v167
    v_mfma_f32_16x16x32_bf16 v[204:207], v[92:95], a[244:247], v[204:207]
    v_cvt_pk_bf16_f32 v36, v168, v169
    v_cvt_pk_bf16_f32 v37, v170, v171
    v_mfma_f32_16x16x32_bf16 v[208:211], v[88:91], a[248:251], v[208:211]
    v_cvt_pk_bf16_f32 v38, v172, v173
    v_cvt_pk_bf16_f32 v39, v174, v175
    v_mfma_f32_16x16x32_bf16 v[212:215], v[92:95], a[248:251], v[212:215]
    buffer_load_dwordx4 a[172:175], v249, s[8:11], s29 offen offset:2048 sc1
    v_cvt_pk_bf16_f32 v40, v176, v177
    v_cvt_pk_bf16_f32 v41, v178, v179
    v_mfma_f32_16x16x32_bf16 v[216:219], v[88:91], a[252:255], v[216:219]
    v_cvt_pk_bf16_f32 v42, v180, v181
    v_cvt_pk_bf16_f32 v43, v182, v183
    v_mfma_f32_16x16x32_bf16 v[220:223], v[92:95], a[252:255], v[220:223]
    v_cvt_pk_bf16_f32 v44, v184, v185
    v_cvt_pk_bf16_f32 v45, v186, v187
    s_nop 3
    v_cvt_pk_bf16_f32 v46, v188, v189
    v_cvt_pk_bf16_f32 v47, v190, v191
    v_cvt_pk_bf16_f32 v48, v192, v193
    v_cvt_pk_bf16_f32 v49, v194, v195
    v_cvt_pk_bf16_f32 v50, v196, v197
    v_cvt_pk_bf16_f32 v51, v198, v199
    v_cvt_pk_bf16_f32 v52, v200, v201
    v_cvt_pk_bf16_f32 v53, v202, v203
    v_cvt_pk_bf16_f32 v54, v204, v205
    v_cvt_pk_bf16_f32 v55, v206, v207
    v_cvt_pk_bf16_f32 v56, v208, v209
    v_cvt_pk_bf16_f32 v57, v210, v211
    v_cvt_pk_bf16_f32 v58, v212, v213
    v_cvt_pk_bf16_f32 v59, v214, v215
    v_cvt_pk_bf16_f32 v60, v216, v217
    v_cvt_pk_bf16_f32 v61, v218, v219
    v_cvt_pk_bf16_f32 v62, v220, v221
    v_cvt_pk_bf16_f32 v63, v222, v223
    s_add_u32 s80, s36, 102144
    s_add_u32 s81, s36, 103168
    s_add_u32 s82, s36, 104192
    s_add_u32 s83, s36, 105216
    s_add_u32 s84, s36, 110336
    s_add_u32 s85, s36, 111360
    s_add_u32 s86, s36, 112384
    s_add_u32 s87, s36, 113408
ka_Q:
    s_waitcnt vmcnt(10) lgkmcnt(0)
    v_mfma_f32_16x16x32_bf16 v[96:99], a[192:195], a[128:131], 0
    ds_read_b64_tr_b16 a[208:209], v246 offset:512
    s_lshl_b32 s97, s4, 7
    v_mfma_f32_16x16x32_bf16 v[100:103], a[192:195], a[132:135], 0
    ds_read_b64_tr_b16 a[210:211], v246 offset:1536
    s_add_u32 s97, s97, 12288
    s_cmp_eq_u32 s3, 0
    s_cselect_b32 s35, s97, s43
    v_mfma_f32_16x16x32_bf16 v[104:107], a[192:195], a[136:139], 0
    ds_read_b64_tr_b16 a[212:213], v238 offset:512
    s_lshl_b32 s37, s3, 12
    v_mfma_f32_16x16x32_bf16 v[108:111], a[192:195], a[140:143], 0
    ds_read_b64_tr_b16 a[214:215], v238 offset:1536
    s_mov_b32 s34, s37
    s_mul_i32 s32, s4, 1089536
    v_mfma_f32_16x16x32_bf16 v[112:115], a[196:199], a[128:131], 0
    ds_read_b64_tr_b16 a[216:217], v246 offset:768
    s_mov_b32 s33, 0
    v_mfma_f32_16x16x32_bf16 v[116:119], a[196:199], a[132:135], 0
    ds_read_b64_tr_b16 a[218:219], v246 offset:1792
    s_lshl_b32 s39, s6, 18
    v_mfma_f32_16x16x32_bf16 v[120:123], a[196:199], a[136:139], 0
    ds_read_b64_tr_b16 a[220:221], v238 offset:768
    s_sub_u32 s25, 63, s6
    s_lshl_b32 s40, s25, 18
    v_mfma_f32_16x16x32_bf16 v[124:127], a[196:199], a[140:143], 0
    ds_read_b64_tr_b16 a[222:223], v238 offset:1792
    s_lshl_b32 s25, s4, 12
    v_mfma_f32_16x16x32_bf16 v[128:131], a[200:203], a[128:131], 0
    buffer_load_dwordx4 a[176:179], v248, s[8:11], s28 offen offset:3072 sc1
    s_add_u32 s39, s39, s25
    s_add_u32 s40, s40, s25
    v_mfma_f32_16x16x32_bf16 v[132:135], a[200:203], a[132:135], 0
    s_mov_b32 s38, 0x40004000
    s_mov_b32 s36, s6
    v_mfma_f32_16x16x32_bf16 v[136:139], a[200:203], a[136:139], 0
    buffer_load_dwordx4 a[180:183], v248, s[8:11], s29 offen offset:3072 sc1
    s_mov_b32 s26, 6
    v_mfma_f32_16x16x32_bf16 v[140:143], a[200:203], a[140:143], 0
    s_add_u32 m0, s31, 0
    s_add_u32 s24, s27, 0
    s_mov_b32 s52, s41
    v_mfma_f32_16x16x32_bf16 v[144:147], a[204:207], a[128:131], 0
    buffer_load_dwordx4 v245, s[12:15], s24 offen lds
    s_mov_b32 s53, s42
    v_mfma_f32_16x16x32_bf16 v[148:151], a[204:207], a[132:135], 0
    s_mov_b32 s54, 0x700000
    s_add_u32 s48, s20, 0x1c00000
    s_addc_u32 s49, s21, 0
    v_mfma_f32_16x16x32_bf16 v[152:155], a[204:207], a[136:139], 0
    buffer_store_dwordx4 v[32:35], v240, s[16:19], s80 offen sc1
    s_mov_b32 s50, 0x1c00000
    s_and_b32 s25, s3, 1
    v_mfma_f32_16x16x32_bf16 v[156:159], a[204:207], a[140:143], 0
    s_lshl1_add_u32 s47, s4, s25
    s_waitcnt lgkmcnt(0)
    v_mfma_f32_16x16x32_bf16 v[160:163], a[208:211], a[128:131], 0
    ds_read_b64_tr_b16 a[192:193], v246 offset:8192
    s_lshr_b32 s101, s3, 1
    v_mfma_f32_16x16x32_bf16 v[164:167], a[208:211], a[132:135], 0
    ds_read_b64_tr_b16 a[194:195], v246 offset:9216
    s_add_u32 s45, s5, s101
    s_sub_u32 s45, s45, 1
    v_mfma_f32_16x16x32_bf16 v[168:171], a[208:211], a[136:139], 0
    ds_read_b64_tr_b16 a[196:197], v238 offset:8192
    s_mul_i32 s45, s45, s5
    v_mfma_f32_16x16x32_bf16 v[172:175], a[208:211], a[140:143], 0
    ds_read_b64_tr_b16 a[198:199], v238 offset:9216
    s_lshl_b32 s100, s101, 14
    s_add_u32 s100, s100, 114688
    v_mfma_f32_16x16x32_bf16 v[176:179], a[212:215], a[128:131], 0
    ds_read_b64_tr_b16 a[200:201], v246 offset:8448
    s_mul_i32 s100, s100, s47
    v_mfma_f32_16x16x32_bf16 v[180:183], a[212:215], a[132:135], 0
    ds_read_b64_tr_b16 a[202:203], v246 offset:9472
    s_lshl_b32 s25, s45, 11
    v_mfma_f32_16x16x32_bf16 v[184:187], a[212:215], a[136:139], 0
    ds_read_b64_tr_b16 a[204:205], v238 offset:8448
    s_add_u32 s100, s100, s25
    s_lshl_b32 s46, s47, 9
    v_mfma_f32_16x16x32_bf16 v[188:191], a[212:215], a[140:143], 0
    ds_read_b64_tr_b16 a[206:207], v238 offset:9472
    s_mul_i32 s44, s47, 114688
    v_mfma_f32_16x16x32_bf16 v[192:195], a[216:219], a[128:131], 0
    buffer_load_dwordx4 a[184:187], v249, s[8:11], s28 offen offset:3072 sc1
    s_add_u32 s47, s44, 7168
    s_lshl_b32 s25, s45, 7
    v_mfma_f32_16x16x32_bf16 v[196:199], a[216:219], a[132:135], 0
    s_add_u32 s44, s44, s25
    s_lshl_b32 s45, s45, 18
    v_mfma_f32_16x16x32_bf16 v[200:203], a[216:219], a[136:139], 0
    buffer_load_dwordx4 a[188:191], v249, s[8:11], s29 offen offset:3072 sc1
    s_add_u32 s46, s46, s45
    v_mfma_f32_16x16x32_bf16 v[204:207], a[216:219], a[140:143], 0
    s_add_u32 m0, s31, 1024
    s_add_u32 s24, s27, 32768
    s_lshr_b32 s25, s3, 1
    v_mfma_f32_16x16x32_bf16 v[208:211], a[220:223], a[128:131], 0
    buffer_load_dwordx4 v245, s[12:15], s24 offen lds
    s_lshl_b32 s25, s25, 15
    v_mfma_f32_16x16x32_bf16 v[212:215], a[220:223], a[132:135], 0
    s_add_u32 s46, s46, s25
    s_mov_b32 s45, s43
    v_mfma_f32_16x16x32_bf16 v[216:219], a[220:223], a[136:139], 0
    s_add_u32 s28, s28, 4096
    s_and_b32 s28, s28, 32767
    buffer_store_dwordx4 v[36:39], v240, s[16:19], s81 offen sc1
    v_mfma_f32_16x16x32_bf16 v[220:223], a[220:223], a[140:143], 0
    s_add_u32 s29, s28, 32768
    v_accvgpr_write_b32 a0, 0
    s_waitcnt vmcnt(13) lgkmcnt(0)
    v_mfma_f32_16x16x32_bf16 v[96:99], a[192:195], a[144:147], v[96:99]
    ds_read_b64_tr_b16 a[208:209], v246 offset:8704
    s_load_dwordx2 s[56:57], s[0:1], 40
    v_accvgpr_write_b32 a1, 0
    v_mfma_f32_16x16x32_bf16 v[100:103], a[192:195], a[148:151], v[100:103]
    ds_read_b64_tr_b16 a[210:211], v246 offset:9728
    v_accvgpr_write_b32 a2, 0
    v_mfma_f32_16x16x32_bf16 v[104:107], a[192:195], a[152:155], v[104:107]
    ds_read_b64_tr_b16 a[212:213], v238 offset:8704
    v_accvgpr_write_b32 a3, 0
    v_mfma_f32_16x16x32_bf16 v[108:111], a[192:195], a[156:159], v[108:111]
    ds_read_b64_tr_b16 a[214:215], v238 offset:9728
    v_accvgpr_write_b32 a4, 0
    v_accvgpr_write_b32 a5, 0
    v_mfma_f32_16x16x32_bf16 v[112:115], a[196:199], a[144:147], v[112:115]
    ds_read_b64_tr_b16 a[216:217], v246 offset:8960
    v_accvgpr_write_b32 a6, 0
    v_mfma_f32_16x16x32_bf16 v[116:119], a[196:199], a[148:151], v[116:119]
    ds_read_b64_tr_b16 a[218:219], v246 offset:9984
    v_accvgpr_write_b32 a7, 0
    v_accvgpr_write_b32 a8, 0
    v_mfma_f32_16x16x32_bf16 v[120:123], a[196:199], a[152:155], v[120:123]
    ds_read_b64_tr_b16 a[220:221], v238 offset:8960
    v_accvgpr_write_b32 a9, 0
    v_mfma_f32_16x16x32_bf16 v[124:127], a[196:199], a[156:159], v[124:127]
    ds_read_b64_tr_b16 a[222:223], v238 offset:9984
    v_accvgpr_write_b32 a10, 0
    v_mfma_f32_16x16x32_bf16 v[128:131], a[200:203], a[144:147], v[128:131]
    buffer_load_dwordx4 a[128:131], v248, s[8:11], s28 offen offset:0 sc1
    v_accvgpr_write_b32 a11, 0
    v_accvgpr_write_b32 a12, 0
    v_mfma_f32_16x16x32_bf16 v[132:135], a[200:203], a[148:151], v[132:135]
    v_accvgpr_write_b32 a13, 0
    v_accvgpr_write_b32 a14, 0
    v_mfma_f32_16x16x32_bf16 v[136:139], a[200:203], a[152:155], v[136:139]
    buffer_load_dwordx4 a[132:135], v248, s[8:11], s29 offen offset:0 sc1
    v_accvgpr_write_b32 a15, 0
    v_mfma_f32_16x16x32_bf16 v[140:143], a[200:203], a[156:159], v[140:143]
    s_add_u32 m0, s31, 2048
    s_add_u32 s24, s27, 65536
    v_accvgpr_write_b32 a16, 0
    v_mfma_f32_16x16x32_bf16 v[144:147], a[204:207], a[144:147], v[144:147]
    buffer_load_dwordx4 v237, s[12:15], s24 offen lds
    v_accvgpr_write_b32 a17, 0
    v_mfma_f32_16x16x32_bf16 v[148:151], a[204:207], a[148:151], v[148:151]
    v_accvgpr_write_b32 a18, 0
    v_accvgpr_write_b32 a19, 0
    v_accvgpr_write_b32 a20, 0
    v_mfma_f32_16x16x32_bf16 v[152:155], a[204:207], a[152:155], v[152:155]
    buffer_store_dwordx4 v[40:43], v240, s[16:19], s82 offen sc1
    v_accvgpr_write_b32 a21, 0
    v_mfma_f32_16x16x32_bf16 v[156:159], a[204:207], a[156:159], v[156:159]
    v_accvgpr_write_b32 a22, 0
    s_waitcnt lgkmcnt(0)
    v_mfma_f32_16x16x32_bf16 v[160:163], a[208:211], a[144:147], v[160:163]
    ds_read_b64_tr_b16 a[192:193], v246 offset:16384
    v_accvgpr_write_b32 a23, 0
    v_accvgpr_write_b32 a24, 0
    v_mfma_f32_16x16x32_bf16 v[164:167], a[208:211], a[148:151], v[164:167]
    ds_read_b64_tr_b16 a[194:195], v246 offset:17408
    v_accvgpr_write_b32 a25, 0
    v_mfma_f32_16x16x32_bf16 v[168:171], a[208:211], a[152:155], v[168:171]
    ds_read_b64_tr_b16 a[196:197], v238 offset:16384
    v_accvgpr_write_b32 a26, 0
    v_mfma_f32_16x16x32_bf16 v[172:175], a[208:211], a[156:159], v[172:175]
    ds_read_b64_tr_b16 a[198:199], v238 offset:17408
    v_accvgpr_write_b32 a27, 0
    v_accvgpr_write_b32 a28, 0
    v_mfma_f32_16x16x32_bf16 v[176:179], a[212:215], a[144:147], v[176:179]
    ds_read_b64_tr_b16 a[200:201], v246 offset:16640
    v_accvgpr_write_b32 a29, 0
    v_mfma_f32_16x16x32_bf16 v[180:183], a[212:215], a[148:151], v[180:183]
    ds_read_b64_tr_b16 a[202:203], v246 offset:17664
    v_accvgpr_write_b32 a30, 0
    v_accvgpr_write_b32 a31, 0
    v_mfma_f32_16x16x32_bf16 v[184:187], a[212:215], a[152:155], v[184:187]
    ds_read_b64_tr_b16 a[204:205], v238 offset:16640
    v_accvgpr_write_b32 a32, 0
    v_mfma_f32_16x16x32_bf16 v[188:191], a[212:215], a[156:159], v[188:191]
    ds_read_b64_tr_b16 a[206:207], v238 offset:17664
    v_accvgpr_write_b32 a33, 0
    v_mfma_f32_16x16x32_bf16 v[192:195], a[216:219], a[144:147], v[192:195]
    buffer_load_dwordx4 a[136:139], v249, s[8:11], s28 offen offset:0 sc1
    v_accvgpr_write_b32 a34, 0
    v_accvgpr_write_b32 a35, 0
    v_mfma_f32_16x16x32_bf16 v[196:199], a[216:219], a[148:151], v[196:199]
    v_accvgpr_write_b32 a36, 0
    v_accvgpr_write_b32 a37, 0
    v_mfma_f32_16x16x32_bf16 v[200:203], a[216:219], a[152:155], v[200:203]
    buffer_load_dwordx4 a[140:143], v249, s[8:11], s29 offen offset:0 sc1
    v_accvgpr_write_b32 a38, 0
    v_mfma_f32_16x16x32_bf16 v[204:207], a[216:219], a[156:159], v[204:207]
    s_add_u32 m0, s31, 3072
    s_add_u32 s24, s27, 98304
    v_accvgpr_write_b32 a39, 0
    v_mfma_f32_16x16x32_bf16 v[208:211], a[220:223], a[144:147], v[208:211]
    buffer_load_dwordx4 v237, s[12:15], s24 offen lds
    v_accvgpr_write_b32 a40, 0
    v_mfma_f32_16x16x32_bf16 v[212:215], a[220:223], a[148:151], v[212:215]
    v_accvgpr_write_b32 a41, 0
    v_accvgpr_write_b32 a42, 0
    v_accvgpr_write_b32 a43, 0
    v_mfma_f32_16x16x32_bf16 v[216:219], a[220:223], a[152:155], v[216:219]
    buffer_store_dwordx4 v[44:47], v240, s[16:19], s83 offen sc1
    v_accvgpr_write_b32 a44, 0
    v_mfma_f32_16x16x32_bf16 v[220:223], a[220:223], a[156:159], v[220:223]
    v_accvgpr_write_b32 a45, 0
    s_waitcnt vmcnt(16) lgkmcnt(0)
    v_mfma_f32_16x16x32_bf16 v[96:99], a[192:195], a[160:163], v[96:99]
    ds_read_b64_tr_b16 a[208:209], v246 offset:16896
    v_accvgpr_write_b32 a46, 0
    v_accvgpr_write_b32 a47, 0
    v_mfma_f32_16x16x32_bf16 v[100:103], a[192:195], a[164:167], v[100:103]
    ds_read_b64_tr_b16 a[210:211], v246 offset:17920
    v_accvgpr_write_b32 a48, 0
    v_mfma_f32_16x16x32_bf16 v[104:107], a[192:195], a[168:171], v[104:107]
    ds_read_b64_tr_b16 a[212:213], v238 offset:16896
    v_accvgpr_write_b32 a49, 0
    v_accvgpr_write_b32 a50, 0
    v_mfma_f32_16x16x32_bf16 v[108:111], a[192:195], a[172:175], v[108:111]
    ds_read_b64_tr_b16 a[214:215], v238 offset:17920
    v_accvgpr_write_b32 a51, 0
    v_mfma_f32_16x16x32_bf16 v[112:115], a[196:199], a[160:163], v[112:115]
    ds_read_b64_tr_b16 a[216:217], v246 offset:17152
    v_accvgpr_write_b32 a52, 0
    v_mfma_f32_16x16x32_bf16 v[116:119], a[196:199], a[164:167], v[116:119]
    ds_read_b64_tr_b16 a[218:219], v246 offset:18176
    v_accvgpr_write_b32 a53, 0
    v_accvgpr_write_b32 a54, 0
    v_mfma_f32_16x16x32_bf16 v[120:123], a[196:199], a[168:171], v[120:123]
    ds_read_b64_tr_b16 a[220:221], v238 offset:17152
    v_accvgpr_write_b32 a55, 0
    v_mfma_f32_16x16x32_bf16 v[124:127], a[196:199], a[172:175], v[124:127]
    ds_read_b64_tr_b16 a[222:223], v238 offset:18176
    v_accvgpr_write_b32 a56, 0
    v_accvgpr_write_b32 a57, 0
    v_mfma_f32_16x16x32_bf16 v[128:131], a[200:203], a[160:163], v[128:131]
    buffer_load_dwordx4 a[144:147], v248, s[8:11], s28 offen offset:1024 sc1
    v_accvgpr_write_b32 a58, 0
    v_mfma_f32_16x16x32_bf16 v[132:135], a[200:203], a[164:167], v[132:135]
    v_accvgpr_write_b32 a59, 0
    v_accvgpr_write_b32 a60, 0
    v_mfma_f32_16x16x32_bf16 v[136:139], a[200:203], a[168:171], v[136:139]
    buffer_load_dwordx4 a[148:151], v248, s[8:11], s29 offen offset:1024 sc1
    v_accvgpr_write_b32 a61, 0
    v_mfma_f32_16x16x32_bf16 v[140:143], a[200:203], a[172:175], v[140:143]
    s_add_u32 m0, s31, 4096
    s_add_u32 s24, s27, 131072
    v_accvgpr_write_b32 a62, 0
    v_mfma_f32_16x16x32_bf16 v[144:147], a[204:207], a[160:163], v[144:147]
    buffer_load_dwordx4 v245, s[12:15], s24 offen lds
    v_accvgpr_write_b32 a63, 0
    v_mfma_f32_16x16x32_bf16 v[148:151], a[204:207], a[164:167], v[148:151]
    v_accvgpr_write_b32 a64, 0
    v_accvgpr_write_b32 a65, 0
    v_accvgpr_write_b32 a66, 0
    v_mfma_f32_16x16x32_bf16 v[152:155], a[204:207], a[168:171], v[152:155]
    buffer_store_dwordx4 v[48:51], v240, s[16:19], s84 offen sc1
    v_accvgpr_write_b32 a67, 0
    v_mfma_f32_16x16x32_bf16 v[156:159], a[204:207], a[172:175], v[156:159]
    v_accvgpr_write_b32 a68, 0
    s_waitcnt lgkmcnt(0)
    v_mfma_f32_16x16x32_bf16 v[160:163], a[208:211], a[160:163], v[160:163]
    ds_read_b64_tr_b16 a[192:193], v246 offset:24576
    v_accvgpr_write_b32 a69, 0
    v_accvgpr_write_b32 a70, 0
    v_mfma_f32_16x16x32_bf16 v[164:167], a[208:211], a[164:167], v[164:167]
    ds_read_b64_tr_b16 a[194:195], v246 offset:25600
    v_accvgpr_write_b32 a71, 0
    v_mfma_f32_16x16x32_bf16 v[168:171], a[208:211], a[168:171], v[168:171]
    ds_read_b64_tr_b16 a[196:197], v238 offset:24576
    v_accvgpr_write_b32 a72, 0
    v_accvgpr_write_b32 a73, 0
    v_mfma_f32_16x16x32_bf16 v[172:175], a[208:211], a[172:175], v[172:175]
    ds_read_b64_tr_b16 a[198:199], v238 offset:25600
    v_accvgpr_write_b32 a74, 0
    v_mfma_f32_16x16x32_bf16 v[176:179], a[212:215], a[160:163], v[176:179]
    ds_read_b64_tr_b16 a[200:201], v246 offset:24832
    v_accvgpr_write_b32 a75, 0
    v_mfma_f32_16x16x32_bf16 v[180:183], a[212:215], a[164:167], v[180:183]
    ds_read_b64_tr_b16 a[202:203], v246 offset:25856
    v_accvgpr_write_b32 a76, 0
    v_accvgpr_write_b32 a77, 0
    v_mfma_f32_16x16x32_bf16 v[184:187], a[212:215], a[168:171], v[184:187]
    ds_read_b64_tr_b16 a[204:205], v238 offset:24832
    v_accvgpr_write_b32 a78, 0
    v_mfma_f32_16x16x32_bf16 v[188:191], a[212:215], a[172:175], v[188:191]
    ds_read_b64_tr_b16 a[206:207], v238 offset:25856
    v_accvgpr_write_b32 a79, 0
    v_accvgpr_write_b32 a80, 0
    v_mfma_f32_16x16x32_bf16 v[192:195], a[216:219], a[160:163], v[192:195]
    buffer_load_dwordx4 a[152:155], v249, s[8:11], s28 offen offset:1024 sc1
    v_accvgpr_write_b32 a81, 0
    v_mfma_f32_16x16x32_bf16 v[196:199], a[216:219], a[164:167], v[196:199]
    v_accvgpr_write_b32 a82, 0
    v_accvgpr_write_b32 a83, 0
    v_mfma_f32_16x16x32_bf16 v[200:203], a[216:219], a[168:171], v[200:203]
    buffer_load_dwordx4 a[156:159], v249, s[8:11], s29 offen offset:1024 sc1
    v_accvgpr_write_b32 a84, 0
    v_mfma_f32_16x16x32_bf16 v[204:207], a[216:219], a[172:175], v[204:207]
    s_add_u32 m0, s31, 5120
    s_add_u32 s24, s27, 163840
    v_accvgpr_write_b32 a85, 0
    v_mfma_f32_16x16x32_bf16 v[208:211], a[220:223], a[160:163], v[208:211]
    buffer_load_dwordx4 v245, s[12:15], s24 offen lds
    v_accvgpr_write_b32 a86, 0
    v_accvgpr_write_b32 a87, 0
    v_mfma_f32_16x16x32_bf16 v[212:215], a[220:223], a[164:167], v[212:215]
    v_accvgpr_write_b32 a88, 0
    v_accvgpr_write_b32 a89, 0
    v_mfma_f32_16x16x32_bf16 v[216:219], a[220:223], a[168:171], v[216:219]
    s_add_u32 s30, s30, 32768
    buffer_store_dwordx4 v[52:55], v240, s[16:19], s85 offen sc1
    v_mfma_f32_16x16x32_bf16 v[220:223], a[220:223], a[172:175], v[220:223]
    s_cmp_ge_u32 s30, 163840
    s_cselect_b32 s30, 65536, s30
    s_waitcnt vmcnt(18) lgkmcnt(0)
    v_mfma_f32_16x16x32_bf16 v[96:99], a[192:195], a[176:179], v[96:99]
    ds_read_b64_tr_b16 a[208:209], v246 offset:25088
    v_accvgpr_write_b32 a90, 0
    v_accvgpr_write_b32 a91, 0
    v_mfma_f32_16x16x32_bf16 v[100:103], a[192:195], a[180:183], v[100:103]
    ds_read_b64_tr_b16 a[210:211], v246 offset:26112
    v_accvgpr_write_b32 a92, 0
    v_mfma_f32_16x16x32_bf16 v[104:107], a[192:195], a[184:187], v[104:107]
    ds_read_b64_tr_b16 a[212:213], v238 offset:25088
    v_accvgpr_write_b32 a93, 0
    v_mfma_f32_16x16x32_bf16 v[108:111], a[192:195], a[188:191], v[108:111]
    ds_read_b64_tr_b16 a[214:215], v238 offset:26112
    v_accvgpr_write_b32 a94, 0
    v_accvgpr_write_b32 a95, 0
    v_mfma_f32_16x16x32_bf16 v[112:115], a[196:199], a[176:179], v[112:115]
    ds_read_b64_tr_b16 a[216:217], v246 offset:25344
    v_accvgpr_write_b32 a96, 0
    v_mfma_f32_16x16x32_bf16 v[116:119], a[196:199], a[180:183], v[116:119]
    ds_read_b64_tr_b16 a[218:219], v246 offset:26368
    v_accvgpr_write_b32 a97, 0
    v_accvgpr_write_b32 a98, 0
    v_mfma_f32_16x16x32_bf16 v[120:123], a[196:199], a[184:187], v[120:123]
    ds_read_b64_tr_b16 a[220:221], v238 offset:25344
    v_accvgpr_write_b32 a99, 0
    v_mfma_f32_16x16x32_bf16 v[124:127], a[196:199], a[188:191], v[124:127]
    ds_read_b64_tr_b16 a[222:223], v238 offset:26368
    v_accvgpr_write_b32 a100, 0
    v_mfma_f32_16x16x32_bf16 v[128:131], a[200:203], a[176:179], v[128:131]
    buffer_load_dwordx4 a[160:163], v248, s[8:11], s28 offen offset:2048 sc1
    v_accvgpr_write_b32 a101, 0
    v_accvgpr_write_b32 a102, 0
    v_mfma_f32_16x16x32_bf16 v[132:135], a[200:203], a[180:183], v[132:135]
    v_accvgpr_write_b32 a103, 0
    v_accvgpr_write_b32 a104, 0
    v_mfma_f32_16x16x32_bf16 v[136:139], a[200:203], a[184:187], v[136:139]
    buffer_load_dwordx4 a[164:167], v248, s[8:11], s29 offen offset:2048 sc1
    v_accvgpr_write_b32 a105, 0
    v_mfma_f32_16x16x32_bf16 v[140:143], a[200:203], a[188:191], v[140:143]
    s_add_u32 m0, s31, 6144
    s_add_u32 s24, s27, 196608
    v_accvgpr_write_b32 a106, 0
    v_mfma_f32_16x16x32_bf16 v[144:147], a[204:207], a[176:179], v[144:147]
    buffer_load_dwordx4 v237, s[12:15], s24 offen lds
    v_accvgpr_write_b32 a107, 0
    v_mfma_f32_16x16x32_bf16 v[148:151], a[204:207], a[180:183], v[148:151]
    v_accvgpr_write_b32 a108, 0
    v_accvgpr_write_b32 a109, 0
    v_accvgpr_write_b32 a110, 0
    v_mfma_f32_16x16x32_bf16 v[152:155], a[204:207], a[184:187], v[152:155]
    buffer_store_dwordx4 v[56:59], v240, s[16:19], s86 offen sc1
    v_accvgpr_write_b32 a111, 0
    v_mfma_f32_16x16x32_bf16 v[156:159], a[204:207], a[188:191], v[156:159]
    s_waitcnt vmcnt(49) lgkmcnt(0)
    s_barrier
    v_add_u32 v246, s30, v247
    v_mfma_f32_16x16x32_bf16 v[160:163], a[208:211], a[176:179], v[160:163]
    v_xor_b32_e64 v238, 16, v246
    ds_read_b64_tr_b16 a[192:193], v246 offset:0
    v_accvgpr_write_b32 a112, 0
    v_mfma_f32_16x16x32_bf16 v[164:167], a[208:211], a[180:183], v[164:167]
    ds_read_b64_tr_b16 a[194:195], v246 offset:1024
    v_accvgpr_write_b32 a113, 0
    v_mfma_f32_16x16x32_bf16 v[168:171], a[208:211], a[184:187], v[168:171]
    ds_read_b64_tr_b16 a[196:197], v238 offset:0
    v_accvgpr_write_b32 a114, 0
    v_mfma_f32_16x16x32_bf16 v[172:175], a[208:211], a[188:191], v[172:175]
    ds_read_b64_tr_b16 a[198:199], v238 offset:1024
    v_accvgpr_write_b32 a115, 0
    v_accvgpr_write_b32 a116, 0
    v_mfma_f32_16x16x32_bf16 v[176:179], a[212:215], a[176:179], v[176:179]
    ds_read_b64_tr_b16 a[200:201], v246 offset:256
    v_accvgpr_write_b32 a117, 0
    v_mfma_f32_16x16x32_bf16 v[180:183], a[212:215], a[180:183], v[180:183]
    ds_read_b64_tr_b16 a[202:203], v246 offset:1280
    v_accvgpr_write_b32 a118, 0
    v_accvgpr_write_b32 a119, 0
    v_mfma_f32_16x16x32_bf16 v[184:187], a[212:215], a[184:187], v[184:187]
    ds_read_b64_tr_b16 a[204:205], v238 offset:256
    buffer_store_dwordx4 v[60:63], v240, s[16:19], s87 offen sc1
    v_mfma_f32_16x16x32_bf16 v[188:191], a[212:215], a[188:191], v[188:191]
    ds_read_b64_tr_b16 a[206:207], v238 offset:1280
    v_accvgpr_write_b32 a120, 0
    v_accvgpr_write_b32 a121, 0
    v_mfma_f32_16x16x32_bf16 v[192:195], a[216:219], a[176:179], v[192:195]
    buffer_load_dwordx4 a[168:171], v249, s[8:11], s28 offen offset:2048 sc1
    v_accvgpr_write_b32 a122, 0
    v_mfma_f32_16x16x32_bf16 v[196:199], a[216:219], a[180:183], v[196:199]
    s_lshl2_add_u32 s80, s2, s3
    s_mul_i32 s80, s80, 12288
    s_add_u32 s80, s80, 0x1000000
    v_mov_b32 v0, -1
    v_mov_b32 v1, -1
    v_mov_b32 v2, -1
    v_mov_b32_e64 v3, -1
    v_mfma_f32_16x16x32_bf16 v[200:203], a[216:219], a[184:187], v[200:203]
    buffer_load_dwordx4 a[172:175], v249, s[8:11], s29 offen offset:2048 sc1
    v_accvgpr_write_b32 a123, 0
    v_accvgpr_write_b32 a124, 0
    v_mfma_f32_16x16x32_bf16 v[204:207], a[216:219], a[188:191], v[204:207]
    s_add_u32 m0, s31, 7168
    s_add_u32 s24, s27, 229376
    v_mfma_f32_16x16x32_bf16 v[208:211], a[220:223], a[176:179], v[208:211]
    buffer_load_dwordx4 v237, s[12:15], s24 offen lds
    v_accvgpr_write_b32 a125, 0
    v_accvgpr_write_b32 a126, 0
    v_mfma_f32_16x16x32_bf16 v[212:215], a[220:223], a[180:183], v[212:215]
    s_add_u32 s27, s27, 1048576
    s_and_b32 s27, s27, 0x407fffff
    v_mfma_f32_16x16x32_bf16 v[216:219], a[220:223], a[184:187], v[216:219]
    s_cmp_eq_u32 s27, s7
    s_cselect_b32 s27, s43, s27
    v_accvgpr_write_b32 a127, 0
    v_mfma_f32_16x16x32_bf16 v[220:223], a[220:223], a[188:191], v[220:223]
    s_add_u32 s31, s31, 32768
    s_cmp_ge_u32 s31, 163840
    s_cselect_b32 s24, 98304, 0
    s_sub_u32 s31, s31, s24
.p2align 3
ka_qp:
    s_waitcnt vmcnt(15) lgkmcnt(0)
    v_mfma_f32_16x16x32_bf16 v[96:99], a[192:195], a[128:131], v[96:99]
    ds_read_b64_tr_b16 a[208:209], v246 offset:512
    v_mfma_f32_16x16x32_bf16 v[100:103], a[192:195], a[132:135], v[100:103]
    ds_read_b64_tr_b16 a[210:211], v246 offset:1536
    v_mfma_f32_16x16x32_bf16 v[104:107], a[192:195], a[136:139], v[104:107]
    ds_read_b64_tr_b16 a[212:213], v238 offset:512
    v_mfma_f32_16x16x32_bf16 v[108:111], a[192:195], a[140:143], v[108:111]
    ds_read_b64_tr_b16 a[214:215], v238 offset:1536
    v_mfma_f32_16x16x32_bf16 v[112:115], a[196:199], a[128:131], v[112:115]
    ds_read_b64_tr_b16 a[216:217], v246 offset:768
    v_mfma_f32_16x16x32_bf16 v[116:119], a[196:199], a[132:135], v[116:119]
    ds_read_b64_tr_b16 a[218:219], v246 offset:1792
    v_mfma_f32_16x16x32_bf16 v[120:123], a[196:199], a[136:139], v[120:123]
    ds_read_b64_tr_b16 a[220:221], v238 offset:768
    v_mfma_f32_16x16x32_bf16 v[124:127], a[196:199], a[140:143], v[124:127]
    ds_read_b64_tr_b16 a[222:223], v238 offset:1792
    v_mfma_f32_16x16x32_bf16 v[128:131], a[200:203], a[128:131], v[128:131]
    buffer_load_dwordx4 a[176:179], v248, s[8:11], s28 offen offset:3072 sc1
    s_cmp_eq_u32 s26, 1
    s_cselect_b32 s41, s35, s43
    buffer_load_dword v254, off, s[88:91], s41 sc1
    v_mfma_f32_16x16x32_bf16 v[132:135], a[200:203], a[132:135], v[132:135]
    v_mfma_f32_16x16x32_bf16 v[136:139], a[200:203], a[136:139], v[136:139]
    buffer_load_dwordx4 a[180:183], v248, s[8:11], s29 offen offset:3072 sc1
    v_mfma_f32_16x16x32_bf16 v[140:143], a[200:203], a[140:143], v[140:143]
    s_add_u32 m0, s31, 0
    s_add_u32 s24, s27, 0
    v_mfma_f32_16x16x32_bf16 v[144:147], a[204:207], a[128:131], v[144:147]
    buffer_load_dwordx4 v245, s[12:15], s24 offen lds
    v_mfma_f32_16x16x32_bf16 v[148:151], a[204:207], a[132:135], v[148:151]
    v_mfma_f32_16x16x32_bf16 v[152:155], a[204:207], a[136:139], v[152:155]
    v_mfma_f32_16x16x32_bf16 v[156:159], a[204:207], a[140:143], v[156:159]
    s_waitcnt lgkmcnt(0)
    v_mfma_f32_16x16x32_bf16 v[160:163], a[208:211], a[128:131], v[160:163]
    ds_read_b64_tr_b16 a[192:193], v246 offset:8192
    v_mfma_f32_16x16x32_bf16 v[164:167], a[208:211], a[132:135], v[164:167]
    ds_read_b64_tr_b16 a[194:195], v246 offset:9216
    v_mfma_f32_16x16x32_bf16 v[168:171], a[208:211], a[136:139], v[168:171]
    ds_read_b64_tr_b16 a[196:197], v238 offset:8192
    v_mfma_f32_16x16x32_bf16 v[172:175], a[208:211], a[140:143], v[172:175]
    ds_read_b64_tr_b16 a[198:199], v238 offset:9216
    v_mfma_f32_16x16x32_bf16 v[176:179], a[212:215], a[128:131], v[176:179]
    ds_read_b64_tr_b16 a[200:201], v246 offset:8448
    v_mfma_f32_16x16x32_bf16 v[180:183], a[212:215], a[132:135], v[180:183]
    ds_read_b64_tr_b16 a[202:203], v246 offset:9472
    v_mfma_f32_16x16x32_bf16 v[184:187], a[212:215], a[136:139], v[184:187]
    ds_read_b64_tr_b16 a[204:205], v238 offset:8448
    v_mfma_f32_16x16x32_bf16 v[188:191], a[212:215], a[140:143], v[188:191]
    ds_read_b64_tr_b16 a[206:207], v238 offset:9472
    v_mfma_f32_16x16x32_bf16 v[192:195], a[216:219], a[128:131], v[192:195]
    buffer_load_dwordx4 a[184:187], v249, s[8:11], s28 offen offset:3072 sc1
    v_mfma_f32_16x16x32_bf16 v[196:199], a[216:219], a[132:135], v[196:199]
    v_mfma_f32_16x16x32_bf16 v[200:203], a[216:219], a[136:139], v[200:203]
    buffer_load_dwordx4 a[188:191], v249, s[8:11], s29 offen offset:3072 sc1
    v_mfma_f32_16x16x32_bf16 v[204:207], a[216:219], a[140:143], v[204:207]
    s_add_u32 m0, s31, 1024
    s_add_u32 s24, s27, 32768
    v_mfma_f32_16x16x32_bf16 v[208:211], a[220:223], a[128:131], v[208:211]
    buffer_load_dwordx4 v245, s[12:15], s24 offen lds
    v_mfma_f32_16x16x32_bf16 v[212:215], a[220:223], a[132:135], v[212:215]
    v_mfma_f32_16x16x32_bf16 v[216:219], a[220:223], a[136:139], v[216:219]
    s_add_u32 s28, s28, 4096
    s_and_b32 s28, s28, 32767
    v_mfma_f32_16x16x32_bf16 v[220:223], a[220:223], a[140:143], v[220:223]
    s_add_u32 s29, s28, 32768
    s_waitcnt vmcnt(16) lgkmcnt(0)
    v_mfma_f32_16x16x32_bf16 v[96:99], a[192:195], a[144:147], v[96:99]
    ds_read_b64_tr_b16 a[208:209], v246 offset:8704
    v_mfma_f32_16x16x32_bf16 v[100:103], a[192:195], a[148:151], v[100:103]
    ds_read_b64_tr_b16 a[210:211], v246 offset:9728
    v_mfma_f32_16x16x32_bf16 v[104:107], a[192:195], a[152:155], v[104:107]
    ds_read_b64_tr_b16 a[212:213], v238 offset:8704
    v_mfma_f32_16x16x32_bf16 v[108:111], a[192:195], a[156:159], v[108:111]
    ds_read_b64_tr_b16 a[214:215], v238 offset:9728
    v_mfma_f32_16x16x32_bf16 v[112:115], a[196:199], a[144:147], v[112:115]
    ds_read_b64_tr_b16 a[216:217], v246 offset:8960
    v_mfma_f32_16x16x32_bf16 v[116:119], a[196:199], a[148:151], v[116:119]
    ds_read_b64_tr_b16 a[218:219], v246 offset:9984
    v_mfma_f32_16x16x32_bf16 v[120:123], a[196:199], a[152:155], v[120:123]
    ds_read_b64_tr_b16 a[220:221], v238 offset:8960
    v_mfma_f32_16x16x32_bf16 v[124:127], a[196:199], a[156:159], v[124:127]
    ds_read_b64_tr_b16 a[222:223], v238 offset:9984
    v_mfma_f32_16x16x32_bf16 v[128:131], a[200:203], a[144:147], v[128:131]
    buffer_load_dwordx4 a[128:131], v248, s[8:11], s28 offen offset:0 sc1
    v_mfma_f32_16x16x32_bf16 v[132:135], a[200:203], a[148:151], v[132:135]
    v_mfma_f32_16x16x32_bf16 v[136:139], a[200:203], a[152:155], v[136:139]
    buffer_load_dwordx4 a[132:135], v248, s[8:11], s29 offen offset:0 sc1
    v_mfma_f32_16x16x32_bf16 v[140:143], a[200:203], a[156:159], v[140:143]
    s_add_u32 m0, s31, 2048
    s_add_u32 s24, s27, 65536
    v_mfma_f32_16x16x32_bf16 v[144:147], a[204:207], a[144:147], v[144:147]
    buffer_load_dwordx4 v237, s[12:15], s24 offen lds
    v_mfma_f32_16x16x32_bf16 v[148:151], a[204:207], a[148:151], v[148:151]
    buffer_store_dwordx4 v[0:3], v240, s[48:51], s80 offen sc1
    s_add_u32 s80, s80, 1024
    v_mfma_f32_16x16x32_bf16 v[152:155], a[204:207], a[152:155], v[152:155]
    v_mfma_f32_16x16x32_bf16 v[156:159], a[204:207], a[156:159], v[156:159]
    s_waitcnt lgkmcnt(0)
    v_mfma_f32_16x16x32_bf16 v[160:163], a[208:211], a[144:147], v[160:163]
    ds_read_b64_tr_b16 a[192:193], v246 offset:16384
    v_mfma_f32_16x16x32_bf16 v[164:167], a[208:211], a[148:151], v[164:167]
    ds_read_b64_tr_b16 a[194:195], v246 offset:17408
    v_mfma_f32_16x16x32_bf16 v[168:171], a[208:211], a[152:155], v[168:171]
    ds_read_b64_tr_b16 a[196:197], v238 offset:16384
    v_mfma_f32_16x16x32_bf16 v[172:175], a[208:211], a[156:159], v[172:175]
    ds_read_b64_tr_b16 a[198:199], v238 offset:17408
    v_mfma_f32_16x16x32_bf16 v[176:179], a[212:215], a[144:147], v[176:179]
    ds_read_b64_tr_b16 a[200:201], v246 offset:16640
    v_mfma_f32_16x16x32_bf16 v[180:183], a[212:215], a[148:151], v[180:183]
    ds_read_b64_tr_b16 a[202:203], v246 offset:17664
    v_mfma_f32_16x16x32_bf16 v[184:187], a[212:215], a[152:155], v[184:187]
    ds_read_b64_tr_b16 a[204:205], v238 offset:16640
    v_mfma_f32_16x16x32_bf16 v[188:191], a[212:215], a[156:159], v[188:191]
    ds_read_b64_tr_b16 a[206:207], v238 offset:17664
    v_mfma_f32_16x16x32_bf16 v[192:195], a[216:219], a[144:147], v[192:195]
    buffer_load_dwordx4 a[136:139], v249, s[8:11], s28 offen offset:0 sc1
    v_mfma_f32_16x16x32_bf16 v[196:199], a[216:219], a[148:151], v[196:199]
    v_mfma_f32_16x16x32_bf16 v[200:203], a[216:219], a[152:155], v[200:203]
    buffer_load_dwordx4 a[140:143], v249, s[8:11], s29 offen offset:0 sc1
    v_mfma_f32_16x16x32_bf16 v[204:207], a[216:219], a[156:159], v[204:207]
    s_add_u32 m0, s31, 3072
    s_add_u32 s24, s27, 98304
    v_mfma_f32_16x16x32_bf16 v[208:211], a[220:223], a[144:147], v[208:211]
    buffer_load_dwordx4 v237, s[12:15], s24 offen lds
    v_mfma_f32_16x16x32_bf16 v[212:215], a[220:223], a[148:151], v[212:215]
    v_mfma_f32_16x16x32_bf16 v[216:219], a[220:223], a[152:155], v[216:219]
    v_mfma_f32_16x16x32_bf16 v[220:223], a[220:223], a[156:159], v[220:223]
    s_waitcnt vmcnt(15) lgkmcnt(0)
    v_mfma_f32_16x16x32_bf16 v[96:99], a[192:195], a[160:163], v[96:99]
    ds_read_b64_tr_b16 a[208:209], v246 offset:16896
    v_mfma_f32_16x16x32_bf16 v[100:103], a[192:195], a[164:167], v[100:103]
    ds_read_b64_tr_b16 a[210:211], v246 offset:17920
    v_mfma_f32_16x16x32_bf16 v[104:107], a[192:195], a[168:171], v[104:107]
    ds_read_b64_tr_b16 a[212:213], v238 offset:16896
    v_mfma_f32_16x16x32_bf16 v[108:111], a[192:195], a[172:175], v[108:111]
    ds_read_b64_tr_b16 a[214:215], v238 offset:17920
    v_mfma_f32_16x16x32_bf16 v[112:115], a[196:199], a[160:163], v[112:115]
    ds_read_b64_tr_b16 a[216:217], v246 offset:17152
    v_mfma_f32_16x16x32_bf16 v[116:119], a[196:199], a[164:167], v[116:119]
    ds_read_b64_tr_b16 a[218:219], v246 offset:18176
    v_mfma_f32_16x16x32_bf16 v[120:123], a[196:199], a[168:171], v[120:123]
    ds_read_b64_tr_b16 a[220:221], v238 offset:17152
    v_mfma_f32_16x16x32_bf16 v[124:127], a[196:199], a[172:175], v[124:127]
    ds_read_b64_tr_b16 a[222:223], v238 offset:18176
    v_mfma_f32_16x16x32_bf16 v[128:131], a[200:203], a[160:163], v[128:131]
    buffer_load_dwordx4 a[144:147], v248, s[8:11], s28 offen offset:1024 sc1
    v_mfma_f32_16x16x32_bf16 v[132:135], a[200:203], a[164:167], v[132:135]
    v_mfma_f32_16x16x32_bf16 v[136:139], a[200:203], a[168:171], v[136:139]
    buffer_load_dwordx4 a[148:151], v248, s[8:11], s29 offen offset:1024 sc1
    v_mfma_f32_16x16x32_bf16 v[140:143], a[200:203], a[172:175], v[140:143]
    s_add_u32 m0, s31, 4096
    s_add_u32 s24, s27, 131072
    v_mfma_f32_16x16x32_bf16 v[144:147], a[204:207], a[160:163], v[144:147]
    buffer_load_dwordx4 v245, s[12:15], s24 offen lds
    v_mfma_f32_16x16x32_bf16 v[148:151], a[204:207], a[164:167], v[148:151]
    v_mfma_f32_16x16x32_bf16 v[152:155], a[204:207], a[168:171], v[152:155]
    v_mfma_f32_16x16x32_bf16 v[156:159], a[204:207], a[172:175], v[156:159]
    s_waitcnt lgkmcnt(0)
    v_mfma_f32_16x16x32_bf16 v[160:163], a[208:211], a[160:163], v[160:163]
    ds_read_b64_tr_b16 a[192:193], v246 offset:24576
    v_mfma_f32_16x16x32_bf16 v[164:167], a[208:211], a[164:167], v[164:167]
    ds_read_b64_tr_b16 a[194:195], v246 offset:25600
    v_mfma_f32_16x16x32_bf16 v[168:171], a[208:211], a[168:171], v[168:171]
    ds_read_b64_tr_b16 a[196:197], v238 offset:24576
    v_mfma_f32_16x16x32_bf16 v[172:175], a[208:211], a[172:175], v[172:175]
    ds_read_b64_tr_b16 a[198:199], v238 offset:25600
    v_mfma_f32_16x16x32_bf16 v[176:179], a[212:215], a[160:163], v[176:179]
    ds_read_b64_tr_b16 a[200:201], v246 offset:24832
    v_mfma_f32_16x16x32_bf16 v[180:183], a[212:215], a[164:167], v[180:183]
    ds_read_b64_tr_b16 a[202:203], v246 offset:25856
    v_mfma_f32_16x16x32_bf16 v[184:187], a[212:215], a[168:171], v[184:187]
    ds_read_b64_tr_b16 a[204:205], v238 offset:24832
    v_mfma_f32_16x16x32_bf16 v[188:191], a[212:215], a[172:175], v[188:191]
    ds_read_b64_tr_b16 a[206:207], v238 offset:25856
    v_mfma_f32_16x16x32_bf16 v[192:195], a[216:219], a[160:163], v[192:195]
    buffer_load_dwordx4 a[152:155], v249, s[8:11], s28 offen offset:1024 sc1
    v_mfma_f32_16x16x32_bf16 v[196:199], a[216:219], a[164:167], v[196:199]
    v_mfma_f32_16x16x32_bf16 v[200:203], a[216:219], a[168:171], v[200:203]
    buffer_load_dwordx4 a[156:159], v249, s[8:11], s29 offen offset:1024 sc1
    v_mfma_f32_16x16x32_bf16 v[204:207], a[216:219], a[172:175], v[204:207]
    s_add_u32 m0, s31, 5120
    s_add_u32 s24, s27, 163840
    v_mfma_f32_16x16x32_bf16 v[208:211], a[220:223], a[160:163], v[208:211]
    buffer_load_dwordx4 v245, s[12:15], s24 offen lds
    v_mfma_f32_16x16x32_bf16 v[212:215], a[220:223], a[164:167], v[212:215]
    buffer_store_dwordx4 v[0:3], v240, s[48:51], s80 offen sc1
    s_add_u32 s80, s80, 1024
    v_mfma_f32_16x16x32_bf16 v[216:219], a[220:223], a[168:171], v[216:219]
    s_add_u32 s30, s30, 32768
    v_mfma_f32_16x16x32_bf16 v[220:223], a[220:223], a[172:175], v[220:223]
    s_cmp_ge_u32 s30, 163840
    s_cselect_b32 s30, 65536, s30
    s_waitcnt vmcnt(15) lgkmcnt(0)
    v_mfma_f32_16x16x32_bf16 v[96:99], a[192:195], a[176:179], v[96:99]
    ds_read_b64_tr_b16 a[208:209], v246 offset:25088
    v_mfma_f32_16x16x32_bf16 v[100:103], a[192:195], a[180:183], v[100:103]
    ds_read_b64_tr_b16 a[210:211], v246 offset:26112
    v_mfma_f32_16x16x32_bf16 v[104:107], a[192:195], a[184:187], v[104:107]
    ds_read_b64_tr_b16 a[212:213], v238 offset:25088
    v_mfma_f32_16x16x32_bf16 v[108:111], a[192:195], a[188:191], v[108:111]
    ds_read_b64_tr_b16 a[214:215], v238 offset:26112
    v_mfma_f32_16x16x32_bf16 v[112:115], a[196:199], a[176:179], v[112:115]
    ds_read_b64_tr_b16 a[216:217], v246 offset:25344
    v_mfma_f32_16x16x32_bf16 v[116:119], a[196:199], a[180:183], v[116:119]
    ds_read_b64_tr_b16 a[218:219], v246 offset:26368
    v_mfma_f32_16x16x32_bf16 v[120:123], a[196:199], a[184:187], v[120:123]
    ds_read_b64_tr_b16 a[220:221], v238 offset:25344
    v_mfma_f32_16x16x32_bf16 v[124:127], a[196:199], a[188:191], v[124:127]
    ds_read_b64_tr_b16 a[222:223], v238 offset:26368
    v_mfma_f32_16x16x32_bf16 v[128:131], a[200:203], a[176:179], v[128:131]
    buffer_load_dwordx4 a[160:163], v248, s[8:11], s28 offen offset:2048 sc1
    v_mfma_f32_16x16x32_bf16 v[132:135], a[200:203], a[180:183], v[132:135]
    v_mfma_f32_16x16x32_bf16 v[136:139], a[200:203], a[184:187], v[136:139]
    buffer_load_dwordx4 a[164:167], v248, s[8:11], s29 offen offset:2048 sc1
    v_mfma_f32_16x16x32_bf16 v[140:143], a[200:203], a[188:191], v[140:143]
    s_add_u32 m0, s31, 6144
    s_add_u32 s24, s27, 196608
    v_mfma_f32_16x16x32_bf16 v[144:147], a[204:207], a[176:179], v[144:147]
    buffer_load_dwordx4 v237, s[12:15], s24 offen lds
    v_mfma_f32_16x16x32_bf16 v[148:151], a[204:207], a[180:183], v[148:151]
    v_mfma_f32_16x16x32_bf16 v[152:155], a[204:207], a[184:187], v[152:155]
    s_cmp_eq_u32 s26, 1
    s_cbranch_scc0 ka_nopk
    s_waitcnt vmcnt(22)
    v_readfirstlane_b32 s24, v254
    s_lshl_b32 s25, s3, 16
    s_add_u32 s24, s24, s25
    s_cmp_ge_u32 s24, 8
    s_cbranch_scc0 kf_spin39
kf_spinr40:
ka_nopk:
    v_mfma_f32_16x16x32_bf16 v[156:159], a[204:207], a[188:191], v[156:159]
    s_waitcnt vmcnt(24) lgkmcnt(0)
    s_barrier
    v_add_u32 v246, s30, v247
    v_mfma_f32_16x16x32_bf16 v[160:163], a[208:211], a[176:179], v[160:163]
    v_xor_b32_e64 v238, 16, v246
    ds_read_b64_tr_b16 a[192:193], v246 offset:0
    v_mfma_f32_16x16x32_bf16 v[164:167], a[208:211], a[180:183], v[164:167]
    ds_read_b64_tr_b16 a[194:195], v246 offset:1024
    v_mfma_f32_16x16x32_bf16 v[168:171], a[208:211], a[184:187], v[168:171]
    ds_read_b64_tr_b16 a[196:197], v238 offset:0
    v_mfma_f32_16x16x32_bf16 v[172:175], a[208:211], a[188:191], v[172:175]
    ds_read_b64_tr_b16 a[198:199], v238 offset:1024
    v_mfma_f32_16x16x32_bf16 v[176:179], a[212:215], a[176:179], v[176:179]
    ds_read_b64_tr_b16 a[200:201], v246 offset:256
    v_mfma_f32_16x16x32_bf16 v[180:183], a[212:215], a[180:183], v[180:183]
    ds_read_b64_tr_b16 a[202:203], v246 offset:1280
    v_mfma_f32_16x16x32_bf16 v[184:187], a[212:215], a[184:187], v[184:187]
    ds_read_b64_tr_b16 a[204:205], v238 offset:256
    buffer_atomic_add v255, v250, s[88:91], s97 offen sc1
    s_mov_b32 s97, s43
    v_mfma_f32_16x16x32_bf16 v[188:191], a[212:215], a[188:191], v[188:191]
    ds_read_b64_tr_b16 a[206:207], v238 offset:1280
    v_mfma_f32_16x16x32_bf16 v[192:195], a[216:219], a[176:179], v[192:195]
    buffer_load_dwordx4 a[168:171], v249, s[8:11], s28 offen offset:2048 sc1
    v_mfma_f32_16x16x32_bf16 v[196:199], a[216:219], a[180:183], v[196:199]
    v_mfma_f32_16x16x32_bf16 v[200:203], a[216:219], a[184:187], v[200:203]
    buffer_load_dwordx4 a[172:175], v249, s[8:11], s29 offen offset:2048 sc1
    v_mfma_f32_16x16x32_bf16 v[204:207], a[216:219], a[188:191], v[204:207]
    s_add_u32 m0, s31, 7168
    s_add_u32 s24, s27, 229376
    v_mfma_f32_16x16x32_bf16 v[208:211], a[220:223], a[176:179], v[208:211]
    buffer_load_dwordx4 v237, s[12:15], s24 offen lds
    v_mfma_f32_16x16x32_bf16 v[212:215], a[220:223], a[180:183], v[212:215]
    s_add_u32 s27, s27, 1048576
    s_and_b32 s27, s27, 0x407fffff
    v_mfma_f32_16x16x32_bf16 v[216:219], a[220:223], a[184:187], v[216:219]
    s_cmp_eq_u32 s27, s7
    s_cselect_b32 s27, s43, s27
    v_mfma_f32_16x16x32_bf16 v[220:223], a[220:223], a[188:191], v[220:223]
    s_add_u32 s31, s31, 32768
    s_cmp_ge_u32 s31, 163840
    s_cselect_b32 s24, 98304, 0
    s_sub_u32 s31, s31, s24
    s_sub_u32 s26, s26, 1
    s_cmp_lg_u32 s26, 0
    s_cbranch_scc1 ka_qp
    s_waitcnt vmcnt(15) lgkmcnt(0)
    v_mfma_f32_16x16x32_bf16 v[96:99], a[192:195], a[128:131], v[96:99]
    ds_read_b64_tr_b16 a[208:209], v246 offset:512
    s_sub_u32 s42, s32, 17664
    v_mfma_f32_16x16x32_bf16 v[100:103], a[192:195], a[132:135], v[100:103]
    ds_read_b64_tr_b16 a[210:211], v246 offset:1536
    v_mfma_f32_16x16x32_bf16 v[104:107], a[192:195], a[136:139], v[104:107]
    ds_read_b64_tr_b16 a[212:213], v238 offset:512
    s_mov_b32 m0, s34
    s_add_u32 s41, s42, 17664
    v_mfma_f32_16x16x32_bf16 v[108:111], a[192:195], a[140:143], v[108:111]
    ds_read_b64_tr_b16 a[214:215], v238 offset:1536
    v_mfma_f32_16x16x32_bf16 v[112:115], a[196:199], a[128:131], v[112:115]
    ds_read_b64_tr_b16 a[216:217], v246 offset:768
    v_mfma_f32_16x16x32_bf16 v[116:119], a[196:199], a[132:135], v[116:119]
    ds_read_b64_tr_b16 a[218:219], v246 offset:1792
    buffer_load_dwordx4 v242, s[16:19], s41 offen offset:0 sc1 lds
    v_mfma_f32_16x16x32_bf16 v[120:123], a[196:199], a[136:139], v[120:123]
    ds_read_b64_tr_b16 a[220:221], v238 offset:768
    v_mfma_f32_16x16x32_bf16 v[124:127], a[196:199], a[140:143], v[124:127]
    ds_read_b64_tr_b16 a[222:223], v238 offset:1792
    v_mfma_f32_16x16x32_bf16 v[128:131], a[200:203], a[128:131], v[128:131]
    buffer_load_dwordx4 a[176:179], v248, s[8:11], s28 offen offset:3072 sc1
    buffer_load_dwordx4 v242, s[16:19], s41 offen offset:1024 sc1 lds
    v_mfma_f32_16x16x32_bf16 v[132:135], a[200:203], a[132:135], v[132:135]
    v_mfma_f32_16x16x32_bf16 v[136:139], a[200:203], a[136:139], v[136:139]
    buffer_load_dwordx4 a[180:183], v248, s[8:11], s29 offen offset:3072 sc1
    v_mfma_f32_16x16x32_bf16 v[140:143], a[200:203], a[140:143], v[140:143]
    buffer_load_dwordx4 v242, s[16:19], s41 offen offset:2048 sc1 lds
    v_mfma_f32_16x16x32_bf16 v[144:147], a[204:207], a[128:131], v[144:147]
    v_mfma_f32_16x16x32_bf16 v[148:151], a[204:207], a[132:135], v[148:151]
    v_mfma_f32_16x16x32_bf16 v[152:155], a[204:207], a[136:139], v[152:155]
    buffer_load_dwordx4 v242, s[16:19], s41 offen offset:3072 sc1 lds
    v_mfma_f32_16x16x32_bf16 v[156:159], a[204:207], a[140:143], v[156:159]
    s_waitcnt lgkmcnt(0)
    v_mfma_f32_16x16x32_bf16 v[160:163], a[208:211], a[128:131], v[160:163]
    ds_read_b64_tr_b16 a[192:193], v246 offset:8192
    v_mfma_f32_16x16x32_bf16 v[164:167], a[208:211], a[132:135], v[164:167]
    ds_read_b64_tr_b16 a[194:195], v246 offset:9216
    v_mfma_f32_16x16x32_bf16 v[168:171], a[208:211], a[136:139], v[168:171]
    ds_read_b64_tr_b16 a[196:197], v238 offset:8192
    s_add_u32 s34, s34, 32768
    s_cmp_ge_u32 s34, 163840
    s_cselect_b32 s34, s37, s34
    s_add_u32 s42, s42, 34048
    v_mfma_f32_16x16x32_bf16 v[172:175], a[208:211], a[140:143], v[172:175]
    ds_read_b64_tr_b16 a[198:199], v238 offset:9216
    v_mfma_f32_16x16x32_bf16 v[176:179], a[212:215], a[128:131], v[176:179]
    ds_read_b64_tr_b16 a[200:201], v246 offset:8448
    v_mfma_f32_16x16x32_bf16 v[180:183], a[212:215], a[132:135], v[180:183]
    ds_read_b64_tr_b16 a[202:203], v246 offset:9472
    s_mov_b32 m0, s34
    s_add_u32 s41, s42, 17664
    v_mfma_f32_16x16x32_bf16 v[184:187], a[212:215], a[136:139], v[184:187]
    ds_read_b64_tr_b16 a[204:205], v238 offset:8448
    v_mfma_f32_16x16x32_bf16 v[188:191], a[212:215], a[140:143], v[188:191]
    ds_read_b64_tr_b16 a[206:207], v238 offset:9472
    v_mfma_f32_16x16x32_bf16 v[192:195], a[216:219], a[128:131], v[192:195]
    buffer_load_dwordx4 a[184:187], v249, s[8:11], s28 offen offset:3072 sc1
    buffer_load_dwordx4 v242, s[16:19], s41 offen offset:0 sc1 lds
    v_mfma_f32_16x16x32_bf16 v[196:199], a[216:219], a[132:135], v[196:199]
    v_mfma_f32_16x16x32_bf16 v[200:203], a[216:219], a[136:139], v[200:203]
    buffer_load_dwordx4 a[188:191], v249, s[8:11], s29 offen offset:3072 sc1
    v_mfma_f32_16x16x32_bf16 v[204:207], a[216:219], a[140:143], v[204:207]
    buffer_load_dwordx4 v242, s[16:19], s41 offen offset:1024 sc1 lds
    v_mfma_f32_16x16x32_bf16 v[208:211], a[220:223], a[128:131], v[208:211]
    v_mfma_f32_16x16x32_bf16 v[212:215], a[220:223], a[132:135], v[212:215]
    v_mfma_f32_16x16x32_bf16 v[216:219], a[220:223], a[136:139], v[216:219]
    s_add_u32 s28, s28, 4096
    s_and_b32 s28, s28, 32767
    v_mfma_f32_16x16x32_bf16 v[220:223], a[220:223], a[140:143], v[220:223]
    s_add_u32 s29, s28, 32768
    buffer_load_dwordx4 v242, s[16:19], s41 offen offset:2048 sc1 lds
    s_waitcnt vmcnt(20) lgkmcnt(0)
    v_mfma_f32_16x16x32_bf16 v[96:99], a[192:195], a[144:147], v[96:99]
    ds_read_b64_tr_b16 a[208:209], v246 offset:8704
    s_load_dwordx2 s[80:81], s[0:1], 0
    s_load_dwordx2 s[82:83], s[0:1], 56
    s_load_dwordx4 s[84:87], s[0:1], 80
    v_mfma_f32_16x16x32_bf16 v[100:103], a[192:195], a[148:151], v[100:103]
    ds_read_b64_tr_b16 a[210:211], v246 offset:9728
    v_mfma_f32_16x16x32_bf16 v[104:107], a[192:195], a[152:155], v[104:107]
    ds_read_b64_tr_b16 a[212:213], v238 offset:8704
    buffer_load_dwordx4 v242, s[16:19], s41 offen offset:3072 sc1 lds
    v_mfma_f32_16x16x32_bf16 v[108:111], a[192:195], a[156:159], v[108:111]
    ds_read_b64_tr_b16 a[214:215], v238 offset:9728
    v_mfma_f32_16x16x32_bf16 v[112:115], a[196:199], a[144:147], v[112:115]
    ds_read_b64_tr_b16 a[216:217], v246 offset:8960
    v_mfma_f32_16x16x32_bf16 v[116:119], a[196:199], a[148:151], v[116:119]
    ds_read_b64_tr_b16 a[218:219], v246 offset:9984
    s_add_u32 m0, s34, 16384
    s_add_u32 s34, s34, 32768
    s_cmp_ge_u32 s34, 163840
    s_cselect_b32 s34, s37, s34
    v_mfma_f32_16x16x32_bf16 v[120:123], a[196:199], a[152:155], v[120:123]
    ds_read_b64_tr_b16 a[220:221], v238 offset:8960
    v_mfma_f32_16x16x32_bf16 v[124:127], a[196:199], a[156:159], v[124:127]
    ds_read_b64_tr_b16 a[222:223], v238 offset:9984
    v_mfma_f32_16x16x32_bf16 v[128:131], a[200:203], a[144:147], v[128:131]
    buffer_load_dwordx4 v242, s[16:19], s42 offen offset:0 sc1 lds
    v_mov_b32_e64 v241, v240
    v_mfma_f32_16x16x32_bf16 v[132:135], a[200:203], a[148:151], v[132:135]
    v_lshrrev_b32_e64 v230, 7, v240
    v_mfma_f32_16x16x32_bf16 v[136:139], a[200:203], a[152:155], v[136:139]
    v_mul_u32_u24 v253, 7168, v230
    v_mfma_f32_16x16x32_bf16 v[140:143], a[200:203], a[156:159], v[140:143]
    v_and_b32 v231, 0x70, v240
    v_mfma_f32_16x16x32_bf16 v[144:147], a[204:207], a[144:147], v[144:147]
    buffer_load_dwordx4 v242, s[16:19], s42 offen offset:1024 sc1 lds
    v_mfma_f32_16x16x32_bf16 v[148:151], a[204:207], a[148:151], v[148:151]
    v_add_u32_e64 v253, v253, v231
    v_mfma_f32_16x16x32_bf16 v[152:155], a[204:207], a[152:155], v[152:155]
    v_lshlrev_b32_e64 v255, 5, v230
    v_mfma_f32_16x16x32_bf16 v[156:159], a[204:207], a[156:159], v[156:159]
    buffer_load_dwordx4 v242, s[16:19], s42 offen offset:2048 sc1 lds
    s_waitcnt lgkmcnt(0)
    v_mfma_f32_16x16x32_bf16 v[160:163], a[208:211], a[144:147], v[160:163]
    ds_read_b64_tr_b16 a[192:193], v246 offset:16384
    v_and_b32 v230, 16, v240
    v_mfma_f32_16x16x32_bf16 v[164:167], a[208:211], a[148:151], v[164:167]
    ds_read_b64_tr_b16 a[194:195], v246 offset:17408
    v_mfma_f32_16x16x32_bf16 v[168:171], a[208:211], a[152:155], v[168:171]
    ds_read_b64_tr_b16 a[196:197], v238 offset:16384
    buffer_load_dwordx4 v242, s[16:19], s42 offen offset:3072 sc1 lds
    s_add_u32 s42, s42, 34048
    v_mfma_f32_16x16x32_bf16 v[172:175], a[208:211], a[156:159], v[172:175]
    ds_read_b64_tr_b16 a[198:199], v238 offset:17408
    v_add_u32_e64 v255, v255, v230
    v_mfma_f32_16x16x32_bf16 v[176:179], a[212:215], a[144:147], v[176:179]
    ds_read_b64_tr_b16 a[200:201], v246 offset:16640
    v_mfma_f32_16x16x32_bf16 v[180:183], a[212:215], a[148:151], v[180:183]
    ds_read_b64_tr_b16 a[202:203], v246 offset:17664
    s_mov_b32 m0, s34
    s_add_u32 s41, s42, 17664
    v_mfma_f32_16x16x32_bf16 v[184:187], a[212:215], a[152:155], v[184:187]
    ds_read_b64_tr_b16 a[204:205], v238 offset:16640
    v_lshrrev_b32 v231, 5, v231
    v_mfma_f32_16x16x32_bf16 v[188:191], a[212:215], a[156:159], v[188:191]
    ds_read_b64_tr_b16 a[206:207], v238 offset:17664
    v_mfma_f32_16x16x32_bf16 v[192:195], a[216:219], a[144:147], v[192:195]
    buffer_load_dwordx4 v242, s[16:19], s41 offen offset:0 sc1 lds
    v_lshl_add_u32 v255, v231, 16, v255
    v_mfma_f32_16x16x32_bf16 v[196:199], a[216:219], a[148:151], v[196:199]
    v_mov_b32_e64 v64, 0
    v_mfma_f32_16x16x32_bf16 v[200:203], a[216:219], a[152:155], v[200:203]
    v_mov_b32_e64 v65, 0
    v_mfma_f32_16x16x32_bf16 v[204:207], a[216:219], a[156:159], v[204:207]
    v_mov_b32_e64 v66, 0
    v_mfma_f32_16x16x32_bf16 v[208:211], a[220:223], a[144:147], v[208:211]
    buffer_load_dwordx4 v242, s[16:19], s41 offen offset:1024 sc1 lds
    v_mfma_f32_16x16x32_bf16 v[212:215], a[220:223], a[148:151], v[212:215]
    v_mov_b32_e64 v67, 0
    v_mfma_f32_16x16x32_bf16 v[216:219], a[220:223], a[152:155], v[216:219]
    v_mov_b32_e64 v68, 0
    v_mfma_f32_16x16x32_bf16 v[220:223], a[220:223], a[156:159], v[220:223]
    buffer_load_dwordx4 v242, s[16:19], s41 offen offset:2048 sc1 lds
    s_waitcnt vmcnt(20) lgkmcnt(0)
    v_mfma_f32_16x16x32_bf16 v[96:99], a[192:195], a[160:163], v[96:99]
    ds_read_b64_tr_b16 a[208:209], v246 offset:16896
    v_mov_b32 v69, 0
    v_mfma_f32_16x16x32_bf16 v[100:103], a[192:195], a[164:167], v[100:103]
    ds_read_b64_tr_b16 a[210:211], v246 offset:17920
    v_mfma_f32_16x16x32_bf16 v[104:107], a[192:195], a[168:171], v[104:107]
    ds_read_b64_tr_b16 a[212:213], v238 offset:16896
    buffer_load_dwordx4 v242, s[16:19], s41 offen offset:3072 sc1 lds
    v_mfma_f32_16x16x32_bf16 v[108:111], a[192:195], a[172:175], v[108:111]
    ds_read_b64_tr_b16 a[214:215], v238 offset:17920
    v_mov_b32_e64 v70, 0
    v_mfma_f32_16x16x32_bf16 v[112:115], a[196:199], a[160:163], v[112:115]
    ds_read_b64_tr_b16 a[216:217], v246 offset:17152
    v_mfma_f32_16x16x32_bf16 v[116:119], a[196:199], a[164:167], v[116:119]
    ds_read_b64_tr_b16 a[218:219], v246 offset:18176
    s_add_u32 m0, s34, 16384
    s_add_u32 s34, s34, 32768
    s_cmp_ge_u32 s34, 163840
    s_cselect_b32 s34, s37, s34
    v_mfma_f32_16x16x32_bf16 v[120:123], a[196:199], a[168:171], v[120:123]
    ds_read_b64_tr_b16 a[220:221], v238 offset:17152
    v_mov_b32 v71, 0
    v_mfma_f32_16x16x32_bf16 v[124:127], a[196:199], a[172:175], v[124:127]
    ds_read_b64_tr_b16 a[222:223], v238 offset:18176
    v_mfma_f32_16x16x32_bf16 v[128:131], a[200:203], a[160:163], v[128:131]
    v_mov_b32_e64 v72, 0
    v_mfma_f32_16x16x32_bf16 v[132:135], a[200:203], a[164:167], v[132:135]
    buffer_load_dwordx4 v242, s[16:19], s42 offen offset:0 sc1 lds
    v_mov_b32_e64 v73, 0
    v_mfma_f32_16x16x32_bf16 v[136:139], a[200:203], a[168:171], v[136:139]
    v_mov_b32_e64 v74, 0
    v_mfma_f32_16x16x32_bf16 v[140:143], a[200:203], a[172:175], v[140:143]
    v_mov_b32_e64 v75, 0
    v_mfma_f32_16x16x32_bf16 v[144:147], a[204:207], a[160:163], v[144:147]
    buffer_load_dwordx4 v242, s[16:19], s42 offen offset:1024 sc1 lds
    v_mfma_f32_16x16x32_bf16 v[148:151], a[204:207], a[164:167], v[148:151]
    v_mov_b32_e64 v76, 0
    v_mfma_f32_16x16x32_bf16 v[152:155], a[204:207], a[168:171], v[152:155]
    v_mov_b32_e64 v77, 0
    v_mfma_f32_16x16x32_bf16 v[156:159], a[204:207], a[172:175], v[156:159]
    buffer_load_dwordx4 v242, s[16:19], s42 offen offset:2048 sc1 lds
    s_waitcnt lgkmcnt(0)
    v_mfma_f32_16x16x32_bf16 v[160:163], a[208:211], a[160:163], v[160:163]
    ds_read_b64_tr_b16 a[192:193], v246 offset:24576
    v_mov_b32 v78, 0
    v_mfma_f32_16x16x32_bf16 v[164:167], a[208:211], a[164:167], v[164:167]
    ds_read_b64_tr_b16 a[194:195], v246 offset:25600
    v_mfma_f32_16x16x32_bf16 v[168:171], a[208:211], a[168:171], v[168:171]
    ds_read_b64_tr_b16 a[196:197], v238 offset:24576
    buffer_load_dwordx4 v242, s[16:19], s42 offen offset:3072 sc1 lds
    s_add_u32 s42, s42, 34048
    v_mfma_f32_16x16x32_bf16 v[172:175], a[208:211], a[172:175], v[172:175]
    ds_read_b64_tr_b16 a[198:199], v238 offset:25600
    v_mov_b32_e64 v79, 0
    v_mfma_f32_16x16x32_bf16 v[176:179], a[212:215], a[160:163], v[176:179]
    ds_read_b64_tr_b16 a[200:201], v246 offset:24832
    v_mfma_f32_16x16x32_bf16 v[180:183], a[212:215], a[164:167], v[180:183]
    ds_read_b64_tr_b16 a[202:203], v246 offset:25856
    v_mov_b32_e64 v80, 0
    v_mfma_f32_16x16x32_bf16 v[184:187], a[212:215], a[168:171], v[184:187]
    ds_read_b64_tr_b16 a[204:205], v238 offset:24832
    v_mfma_f32_16x16x32_bf16 v[188:191], a[212:215], a[172:175], v[188:191]
    ds_read_b64_tr_b16 a[206:207], v238 offset:25856
    v_mov_b32_e64 v81, 0
    v_mfma_f32_16x16x32_bf16 v[192:195], a[216:219], a[160:163], v[192:195]
    v_mov_b32_e64 v82, 0
    v_mfma_f32_16x16x32_bf16 v[196:199], a[216:219], a[164:167], v[196:199]
    v_mov_b32_e64 v83, 0
    v_mfma_f32_16x16x32_bf16 v[200:203], a[216:219], a[168:171], v[200:203]
    v_mov_b32_e64 v84, 0
    v_mfma_f32_16x16x32_bf16 v[204:207], a[216:219], a[172:175], v[204:207]
    v_mov_b32_e64 v85, 0
    v_mfma_f32_16x16x32_bf16 v[208:211], a[220:223], a[160:163], v[208:211]
    v_mov_b32_e64 v86, 0
    v_mfma_f32_16x16x32_bf16 v[212:215], a[220:223], a[164:167], v[212:215]
    v_mov_b32_e64 v87, 0
    v_mfma_f32_16x16x32_bf16 v[216:219], a[220:223], a[168:171], v[216:219]
    v_mov_b32_e64 v88, 0
    v_mfma_f32_16x16x32_bf16 v[220:223], a[220:223], a[172:175], v[220:223]
    s_waitcnt vmcnt(15) lgkmcnt(0)
    v_mfma_f32_16x16x32_bf16 v[96:99], a[192:195], a[176:179], v[96:99]
    ds_read_b64_tr_b16 a[208:209], v246 offset:25088
    v_mov_b32 v89, 0
    v_mfma_f32_16x16x32_bf16 v[100:103], a[192:195], a[180:183], v[100:103]
    ds_read_b64_tr_b16 a[210:211], v246 offset:26112
    v_mfma_f32_16x16x32_bf16 v[104:107], a[192:195], a[184:187], v[104:107]
    ds_read_b64_tr_b16 a[212:213], v238 offset:25088
    v_mov_b32_e64 v90, 0
    v_mfma_f32_16x16x32_bf16 v[108:111], a[192:195], a[188:191], v[108:111]
    ds_read_b64_tr_b16 a[214:215], v238 offset:26112
    v_mfma_f32_16x16x32_bf16 v[112:115], a[196:199], a[176:179], v[112:115]
    ds_read_b64_tr_b16 a[216:217], v246 offset:25344
    v_mov_b32_e64 v91, 0
    v_mfma_f32_16x16x32_bf16 v[116:119], a[196:199], a[180:183], v[116:119]
    ds_read_b64_tr_b16 a[218:219], v246 offset:26368
    v_mfma_f32_16x16x32_bf16 v[120:123], a[196:199], a[184:187], v[120:123]
    ds_read_b64_tr_b16 a[220:221], v238 offset:25344
    v_mov_b32_e64 v92, 0
    v_mfma_f32_16x16x32_bf16 v[124:127], a[196:199], a[188:191], v[124:127]
    ds_read_b64_tr_b16 a[222:223], v238 offset:26368
    v_mfma_f32_16x16x32_bf16 v[128:131], a[200:203], a[176:179], v[128:131]
    v_mov_b32_e64 v93, 0
    v_mfma_f32_16x16x32_bf16 v[132:135], a[200:203], a[180:183], v[132:135]
    v_mov_b32_e64 v94, 0
    v_mfma_f32_16x16x32_bf16 v[136:139], a[200:203], a[184:187], v[136:139]
    v_mov_b32_e64 v95, 0
    v_mfma_f32_16x16x32_bf16 v[140:143], a[200:203], a[188:191], v[140:143]
    v_mov_b32_e64 v224, 0
    v_mfma_f32_16x16x32_bf16 v[144:147], a[204:207], a[176:179], v[144:147]
    v_mov_b32_e64 v225, 0
    v_mfma_f32_16x16x32_bf16 v[148:151], a[204:207], a[180:183], v[148:151]
    v_mov_b32_e64 v226, 0
    v_mfma_f32_16x16x32_bf16 v[152:155], a[204:207], a[184:187], v[152:155]
    v_mov_b32_e64 v227, 0
    v_mfma_f32_16x16x32_bf16 v[156:159], a[204:207], a[188:191], v[156:159]
    s_waitcnt vmcnt(8) lgkmcnt(0)
    s_barrier
    v_mfma_f32_16x16x32_bf16 v[160:163], a[208:211], a[176:179], v[160:163]
    ds_read_b128 a[192:195], v241 offset:0
    s_mov_b32 m0, s34
    s_add_u32 s41, s42, 17664
    v_mfma_f32_16x16x32_bf16 v[164:167], a[208:211], a[180:183], v[164:167]
    ds_read_b128 a[196:199], v241 offset:2048
    buffer_load_dwordx4 v242, s[16:19], s41 offen offset:0 sc1 lds
    v_mfma_f32_16x16x32_bf16 v[168:171], a[208:211], a[184:187], v[168:171]
    ds_read_b128 a[200:203], v241 offset:4096
    v_mfma_f32_16x16x32_bf16 v[172:175], a[208:211], a[188:191], v[172:175]
    ds_read_b128 a[204:207], v241 offset:6144
    buffer_load_dwordx4 v242, s[16:19], s41 offen offset:1024 sc1 lds
    v_mfma_f32_16x16x32_bf16 v[176:179], a[212:215], a[176:179], v[176:179]
    ds_read_b128 a[224:227], v241 offset:8192
    buffer_load_dwordx4 v242, s[16:19], s41 offen offset:2048 sc1 lds
    v_mfma_f32_16x16x32_bf16 v[180:183], a[212:215], a[180:183], v[180:183]
    ds_read_b128 a[228:231], v241 offset:10240
    v_mfma_f32_16x16x32_bf16 v[184:187], a[212:215], a[184:187], v[184:187]
    ds_read_b128 a[232:235], v241 offset:12288
    buffer_load_dwordx4 v242, s[16:19], s41 offen offset:3072 sc1 lds
    v_mfma_f32_16x16x32_bf16 v[188:191], a[212:215], a[188:191], v[188:191]
    ds_read_b128 a[236:239], v241 offset:14336
    v_mfma_f32_16x16x32_bf16 v[192:195], a[216:219], a[176:179], v[192:195]
    ds_read_b128 a[240:243], v241 offset:9216
    s_add_u32 m0, s34, 16384
    s_add_u32 s34, s34, 32768
    s_cmp_ge_u32 s34, 163840
    s_cselect_b32 s34, s37, s34
    v_mfma_f32_16x16x32_bf16 v[196:199], a[216:219], a[180:183], v[196:199]
    ds_read_b128 a[244:247], v241 offset:11264
    buffer_load_dwordx4 v242, s[16:19], s42 offen offset:0 sc1 lds
    v_mfma_f32_16x16x32_bf16 v[200:203], a[216:219], a[184:187], v[200:203]
    ds_read_b128 a[248:251], v241 offset:13312
    v_mfma_f32_16x16x32_bf16 v[204:207], a[216:219], a[188:191], v[204:207]
    ds_read_b128 a[252:255], v241 offset:15360
    buffer_load_dwordx4 v242, s[16:19], s42 offen offset:1024 sc1 lds
    v_mfma_f32_16x16x32_bf16 v[208:211], a[220:223], a[176:179], v[208:211]
    buffer_load_dwordx4 v242, s[16:19], s42 offen offset:2048 sc1 lds
    v_mfma_f32_16x16x32_bf16 v[212:215], a[220:223], a[180:183], v[212:215]
    v_mfma_f32_16x16x32_bf16 v[216:219], a[220:223], a[184:187], v[216:219]
    buffer_load_dwordx4 v242, s[16:19], s42 offen offset:3072 sc1 lds
    s_add_u32 s42, s42, 34048
    v_mfma_f32_16x16x32_bf16 v[220:223], a[220:223], a[188:191], v[220:223]
    s_waitcnt lgkmcnt(8)
    ds_read_b128 a[208:211], v241 offset:1024
    ds_read_b128 a[212:215], v241 offset:3072
    ds_read_b128 a[216:219], v241 offset:5120
    ds_read_b128 a[220:223], v241 offset:7168
    s_sub_u32 s36, s36, 1
    s_cbranch_scc1 kf_fix1
kf_fixr2:
    v_cvt_pk_bf16_f32 v96, v96, v97
    v_cvt_pk_bf16_f32 v97, v98, v99
    v_cvt_pk_bf16_f32 v98, v112, v113
    v_cvt_pk_bf16_f32 v99, v114, v115
    v_accvgpr_write_b32 a128, v96
    v_accvgpr_write_b32 a129, v97
    v_accvgpr_write_b32 a130, v98
    v_accvgpr_write_b32 a131, v99
    v_cvt_pk_bf16_f32 v100, v100, v101
    v_cvt_pk_bf16_f32 v101, v102, v103
    v_cvt_pk_bf16_f32 v102, v116, v117
    v_cvt_pk_bf16_f32 v103, v118, v119
    v_accvgpr_write_b32 a144, v100
    v_accvgpr_write_b32 a145, v101
    v_accvgpr_write_b32 a146, v102
    v_accvgpr_write_b32 a147, v103
    v_cvt_pk_bf16_f32 v104, v104, v105
    v_cvt_pk_bf16_f32 v105, v106, v107
    v_cvt_pk_bf16_f32 v106, v120, v121
    v_cvt_pk_bf16_f32 v107, v122, v123
    v_accvgpr_write_b32 a160, v104
    v_accvgpr_write_b32 a161, v105
    v_accvgpr_write_b32 a162, v106
    v_accvgpr_write_b32 a163, v107
    v_cvt_pk_bf16_f32 v108, v108, v109
    v_cvt_pk_bf16_f32 v109, v110, v111
    v_cvt_pk_bf16_f32 v110, v124, v125
    v_cvt_pk_bf16_f32 v111, v126, v127
    v_accvgpr_write_b32 a176, v108
    v_accvgpr_write_b32 a177, v109
    v_accvgpr_write_b32 a178, v110
    v_accvgpr_write_b32 a179, v111
    s_nop 1
    s_waitcnt lgkmcnt(0)
    v_mfma_f32_16x16x32_bf16 v[0:3], a[192:195], a[128:131], v[64:67]
    v_cvt_pk_bf16_f32 v128, v128, v129
    v_cvt_pk_bf16_f32 v129, v130, v131
    v_cvt_pk_bf16_f32 v130, v144, v145
    v_cvt_pk_bf16_f32 v131, v146, v147
    v_mfma_f32_16x16x32_bf16 v[8:11], a[192:195], a[144:147], v[72:75]
    v_accvgpr_write_b32 a132, v128
    v_accvgpr_write_b32 a133, v129
    v_accvgpr_write_b32 a134, v130
    v_accvgpr_write_b32 a135, v131
    v_mfma_f32_16x16x32_bf16 v[16:19], a[192:195], a[160:163], v[80:83]
    v_cvt_pk_bf16_f32 v132, v132, v133
    v_cvt_pk_bf16_f32 v133, v134, v135
    v_cvt_pk_bf16_f32 v134, v148, v149
    v_cvt_pk_bf16_f32 v135, v150, v151
    v_mfma_f32_16x16x32_bf16 v[24:27], a[192:195], a[176:179], v[88:91]
    v_accvgpr_write_b32 a148, v132
    v_accvgpr_write_b32 a149, v133
    v_accvgpr_write_b32 a150, v134
    v_accvgpr_write_b32 a151, v135
    v_mfma_f32_16x16x32_bf16 v[4:7], a[208:211], a[128:131], v[68:71]
    v_cvt_pk_bf16_f32 v136, v136, v137
    v_cvt_pk_bf16_f32 v137, v138, v139
    v_cvt_pk_bf16_f32 v138, v152, v153
    v_cvt_pk_bf16_f32 v139, v154, v155
    v_mfma_f32_16x16x32_bf16 v[12:15], a[208:211], a[144:147], v[76:79]
    v_accvgpr_write_b32 a164, v136
    v_accvgpr_write_b32 a165, v137
    v_accvgpr_write_b32 a166, v138
    v_accvgpr_write_b32 a167, v139
    v_mfma_f32_16x16x32_bf16 v[20:23], a[208:211], a[160:163], v[84:87]
    v_cvt_pk_bf16_f32 v140, v140, v141
    v_cvt_pk_bf16_f32 v141, v142, v143
    v_cvt_pk_bf16_f32 v142, v156, v157
    v_cvt_pk_bf16_f32 v143, v158, v159
    v_mfma_f32_16x16x32_bf16 v[28:31], a[208:211], a[176:179], v[92:95]
    v_accvgpr_write_b32 a180, v140
    v_accvgpr_write_b32 a181, v141
    v_accvgpr_write_b32 a182, v142
    v_accvgpr_write_b32 a183, v143
    s_nop 1
    v_mfma_f32_16x16x32_bf16 v[0:3], a[196:199], a[132:135], v[0:3]
    v_cvt_pk_bf16_f32 v160, v160, v161
    v_cvt_pk_bf16_f32 v161, v162, v163
    v_cvt_pk_bf16_f32 v162, v176, v177
    v_cvt_pk_bf16_f32 v163, v178, v179
    v_mfma_f32_16x16x32_bf16 v[8:11], a[196:199], a[148:151], v[8:11]
    v_accvgpr_write_b32 a136, v160
    v_accvgpr_write_b32 a137, v161
    v_accvgpr_write_b32 a138, v162
    v_accvgpr_write_b32 a139, v163
    v_mfma_f32_16x16x32_bf16 v[16:19], a[196:199], a[164:167], v[16:19]
    v_cvt_pk_bf16_f32 v164, v164, v165
    v_cvt_pk_bf16_f32 v165, v166, v167
    v_cvt_pk_bf16_f32 v166, v180, v181
    v_cvt_pk_bf16_f32 v167, v182, v183
    v_mfma_f32_16x16x32_bf16 v[24:27], a[196:199], a[180:183], v[24:27]
    v_accvgpr_write_b32 a152, v164
    v_accvgpr_write_b32 a153, v165
    v_accvgpr_write_b32 a154, v166
    v_accvgpr_write_b32 a155, v167
    v_mfma_f32_16x16x32_bf16 v[4:7], a[212:215], a[132:135], v[4:7]
    v_cvt_pk_bf16_f32 v168, v168, v169
    v_cvt_pk_bf16_f32 v169, v170, v171
    v_cvt_pk_bf16_f32 v170, v184, v185
    v_cvt_pk_bf16_f32 v171, v186, v187
    v_mfma_f32_16x16x32_bf16 v[12:15], a[212:215], a[148:151], v[12:15]
    v_accvgpr_write_b32 a168, v168
    v_accvgpr_write_b32 a169, v169
    v_accvgpr_write_b32 a170, v170
    v_accvgpr_write_b32 a171, v171
    v_mfma_f32_16x16x32_bf16 v[20:23], a[212:215], a[164:167], v[20:23]
    v_cvt_pk_bf16_f32 v172, v172, v173
    v_cvt_pk_bf16_f32 v173, v174, v175
    v_cvt_pk_bf16_f32 v174, v188, v189
    v_cvt_pk_bf16_f32 v175, v190, v191
    v_mfma_f32_16x16x32_bf16 v[28:31], a[212:215], a[180:183], v[28:31]
    v_accvgpr_write_b32 a184, v172
    v_accvgpr_write_b32 a185, v173
    v_accvgpr_write_b32 a186, v174
    v_accvgpr_write_b32 a187, v175
    s_nop 1
    s_waitcnt lgkmcnt(0)
    v_mfma_f32_16x16x32_bf16 v[0:3], a[200:203], a[136:139], v[0:3]
    v_cvt_pk_bf16_f32 v192, v192, v193
    v_cvt_pk_bf16_f32 v193, v194, v195
    v_cvt_pk_bf16_f32 v194, v208, v209
    v_cvt_pk_bf16_f32 v195, v210, v211
    v_mfma_f32_16x16x32_bf16 v[8:11], a[200:203], a[152:155], v[8:11]
    v_accvgpr_write_b32 a140, v192
    v_accvgpr_write_b32 a141, v193
    v_accvgpr_write_b32 a142, v194
    v_accvgpr_write_b32 a143, v195
    v_mfma_f32_16x16x32_bf16 v[16:19], a[200:203], a[168:171], v[16:19]
    v_cvt_pk_bf16_f32 v196, v196, v197
    v_cvt_pk_bf16_f32 v197, v198, v199
    v_cvt_pk_bf16_f32 v198, v212, v213
    v_cvt_pk_bf16_f32 v199, v214, v215
    v_mfma_f32_16x16x32_bf16 v[24:27], a[200:203], a[184:187], v[24:27]
    v_accvgpr_write_b32 a156, v196
    v_accvgpr_write_b32 a157, v197
    v_accvgpr_write_b32 a158, v198
    v_accvgpr_write_b32 a159, v199
    v_mfma_f32_16x16x32_bf16 v[4:7], a[216:219], a[136:139], v[4:7]
    v_cvt_pk_bf16_f32 v200, v200, v201
    v_cvt_pk_bf16_f32 v201, v202, v203
    v_cvt_pk_bf16_f32 v202, v216, v217
    v_cvt_pk_bf16_f32 v203, v218, v219
    v_mfma_f32_16x16x32_bf16 v[12:15], a[216:219], a[152:155], v[12:15]
    v_accvgpr_write_b32 a172, v200
    v_accvgpr_write_b32 a173, v201
    v_accvgpr_write_b32 a174, v202
    v_accvgpr_write_b32 a175, v203
    v_mfma_f32_16x16x32_bf16 v[20:23], a[216:219], a[168:171], v[20:23]
    v_cvt_pk_bf16_f32 v204, v204, v205
    v_cvt_pk_bf16_f32 v205, v206, v207
    v_cvt_pk_bf16_f32 v206, v220, v221
    v_cvt_pk_bf16_f32 v207, v222, v223
    v_mfma_f32_16x16x32_bf16 v[28:31], a[216:219], a[184:187], v[28:31]
    v_accvgpr_write_b32 a188, v204
    v_accvgpr_write_b32 a189, v205
    v_accvgpr_write_b32 a190, v206
    v_accvgpr_write_b32 a191, v207
    s_nop 1
    v_mfma_f32_16x16x32_bf16 v[0:3], a[204:207], a[140:143], v[0:3]
    v_mov_b32 v144, 0
    v_mov_b32 v145, 0
    v_mov_b32 v146, 0
    v_mfma_f32_16x16x32_bf16 v[8:11], a[204:207], a[156:159], v[8:11]
    v_mov_b32 v147, 0
    v_mov_b32 v148, 0
    v_mfma_f32_16x16x32_bf16 v[16:19], a[204:207], a[172:175], v[16:19]
    v_mov_b32 v149, 0
    v_mov_b32 v150, 0
    v_mov_b32_e64 v151, 0
    v_mfma_f32_16x16x32_bf16 v[24:27], a[204:207], a[188:191], v[24:27]
    v_mov_b32 v152, 0
    v_mov_b32 v153, 0
    v_mfma_f32_16x16x32_bf16 v[4:7], a[220:223], a[140:143], v[4:7]
    v_mov_b32 v154, 0
    v_mov_b32 v155, 0
    v_mov_b32_e64 v156, 0
    v_mfma_f32_16x16x32_bf16 v[12:15], a[220:223], a[156:159], v[12:15]
    v_mov_b32 v157, 0
    v_mov_b32 v158, 0
    v_mfma_f32_16x16x32_bf16 v[20:23], a[220:223], a[172:175], v[20:23]
    v_mov_b32_e64 v159, 0
    v_mov_b32 v204, 0x3f803f80
    v_mov_b32 v205, 0x3f803f80
    v_mfma_f32_16x16x32_bf16 v[28:31], a[220:223], a[188:191], v[28:31]
    v_mov_b32 v206, 0x3f803f80
    v_mov_b32 v207, 0x3f803f80
    s_nop 4
    v_max3_f32 v128, v0, v1, v2
    v_max3_f32 v130, v8, v9, v10
    v_max3_f32 v132, v16, v17, v18
    v_max3_f32 v134, v24, v25, v26
    v_max3_f32 v128, v128, v3, v4
    v_max3_f32 v130, v130, v11, v12
    v_max3_f32 v132, v132, v19, v20
    v_max3_f32 v134, v134, v27, v28
    v_max3_f32 v128, v128, v5, v6
    v_max3_f32 v130, v130, v13, v14
    v_max3_f32 v132, v132, v21, v22
    v_max3_f32 v134, v134, v29, v30
    v_max_f32 v128, v128, v7
    v_max_f32 v130, v130, v15
    v_max_f32 v132, v132, v23
    v_max_f32 v134, v134, v31
    v_mov_b32 v129, v128
    v_mov_b32 v131, v130
    v_mov_b32 v133, v132
    v_mov_b32 v135, v134
    v_permlane16_swap_b32 v128, v129
    v_permlane16_swap_b32 v130, v131
    v_permlane16_swap_b32 v132, v133
    v_permlane16_swap_b32 v134, v135
    v_max_f32 v128, v128, v129
    v_max_f32 v130, v130, v131
    v_max_f32 v132, v132, v133
    v_max_f32 v134, v134, v135
    v_mov_b32 v129, v128
    v_mov_b32 v131, v130
    v_mov_b32 v133, v132
    v_mov_b32 v135, v134
    v_permlane32_swap_b32 v128, v129
    v_permlane32_swap_b32 v130, v131
    v_permlane32_swap_b32 v132, v133
    v_permlane32_swap_b32 v134, v135
    v_max_f32 v128, v128, v129
    v_max_f32 v130, v130, v131
    v_max_f32 v132, v132, v133
    v_max_f32_e64 v134, v134, v135
    v_add_f32 v128, 0x41800000, v128
    v_add_f32 v130, 0x41800000, v130
    v_add_f32 v132, 0x41800000, v132
    v_add_f32 v134, 0x41800000, v134
    v_sub_f32 v224, 0, v128
    v_sub_f32 v64, v64, v128
    v_sub_f32 v65, v65, v128
    v_sub_f32 v66, v66, v128
    v_sub_f32 v67, v67, v128
    v_sub_f32 v68, v68, v128
    v_sub_f32 v69, v69, v128
    v_sub_f32 v70, v70, v128
    v_sub_f32 v71, v71, v128
    v_sub_f32 v225, 0, v130
    v_sub_f32 v72, v72, v130
    v_sub_f32 v73, v73, v130
    v_sub_f32 v74, v74, v130
    v_sub_f32 v75, v75, v130
    v_sub_f32 v76, v76, v130
    v_sub_f32 v77, v77, v130
    v_sub_f32 v78, v78, v130
    v_sub_f32 v79, v79, v130
    v_sub_f32 v226, 0, v132
    v_sub_f32 v80, v80, v132
    v_sub_f32 v81, v81, v132
    v_sub_f32 v82, v82, v132
    v_sub_f32 v83, v83, v132
    v_sub_f32 v84, v84, v132
    v_sub_f32 v85, v85, v132
    v_sub_f32 v86, v86, v132
    v_sub_f32 v87, v87, v132
    v_sub_f32 v227, 0, v134
    v_sub_f32 v88, v88, v134
    v_sub_f32 v89, v89, v134
    v_sub_f32 v90, v90, v134
    v_sub_f32 v91, v91, v134
    v_sub_f32 v92, v92, v134
    v_sub_f32 v93, v93, v134
    v_sub_f32 v94, v94, v134
    v_sub_f32 v95, v95, v134
    v_sub_f32 v0, v0, v128
    v_sub_f32 v1, v1, v128
    v_sub_f32 v2, v2, v128
    v_sub_f32 v3, v3, v128
    v_sub_f32 v4, v4, v128
    v_sub_f32 v5, v5, v128
    v_sub_f32 v6, v6, v128
    v_sub_f32 v7, v7, v128
    v_sub_f32 v8, v8, v130
    v_sub_f32 v9, v9, v130
    v_sub_f32 v10, v10, v130
    v_sub_f32 v11, v11, v130
    v_sub_f32 v12, v12, v130
    v_sub_f32 v13, v13, v130
    v_sub_f32 v14, v14, v130
    v_sub_f32 v15, v15, v130
    v_sub_f32 v16, v16, v132
    v_sub_f32 v17, v17, v132
    v_sub_f32 v18, v18, v132
    v_sub_f32 v19, v19, v132
    v_sub_f32 v20, v20, v132
    v_sub_f32 v21, v21, v132
    v_sub_f32 v22, v22, v132
    v_sub_f32 v23, v23, v132
    v_sub_f32 v24, v24, v134
    v_sub_f32 v25, v25, v134
    v_sub_f32 v26, v26, v134
    v_sub_f32 v27, v27, v134
    v_sub_f32 v28, v28, v134
    v_sub_f32 v29, v29, v134
    v_sub_f32 v30, v30, v134
    v_sub_f32 v31, v31, v134
    s_mov_b32 s35, 32768
    v_add_u32_e64 v241, s35, v240
    s_sub_u32 s36, s36, 1
    s_cbranch_scc1 kf_fix3
kf_fixr4:
    v_mfma_f32_16x16x32_bf16 v[32:35], a[224:227], a[128:131], v[64:67]
    ds_read_b128 a[192:195], v241 offset:0
    v_exp_f32_e64 v128, v0
    v_mfma_f32_16x16x32_bf16 v[32:35], a[228:231], a[132:135], v[32:35]
    v_exp_f32_e64 v129, v1
    v_mfma_f32_16x16x32_bf16 v[32:35], a[232:235], a[136:139], v[32:35]
    v_exp_f32_e64 v130, v2
    v_cvt_pk_bf16_f32 v96, v128, v129
    v_mfma_f32_16x16x32_bf16 v[32:35], a[236:239], a[140:143], v[32:35]
    v_exp_f32_e64 v131, v3
    v_mfma_f32_16x16x32_bf16 v[40:43], a[224:227], a[144:147], v[72:75]
    ds_read_b128 a[196:199], v241 offset:2048
    v_exp_f32_e64 v132, v4
    v_mfma_f32_16x16x32_bf16 v[40:43], a[228:231], a[148:151], v[40:43]
    v_exp_f32_e64 v133, v5
    v_cvt_pk_bf16_f32 v97, v130, v131
    v_mfma_f32_16x16x32_bf16 v[40:43], a[232:235], a[152:155], v[40:43]
    v_exp_f32_e64 v134, v6
    v_cvt_pk_bf16_f32 v98, v132, v133
    v_mfma_f32_16x16x32_bf16 v[40:43], a[236:239], a[156:159], v[40:43]
    v_exp_f32_e64 v135, v7
    v_mfma_f32_16x16x32_bf16 v[48:51], a[224:227], a[160:163], v[80:83]
    ds_read_b128 a[200:203], v241 offset:4096
    v_exp_f32_e64 v136, v8
    v_mfma_f32_16x16x32_bf16 v[48:51], a[228:231], a[164:167], v[48:51]
    v_exp_f32_e64 v137, v9
    v_cvt_pk_bf16_f32 v99, v134, v135
    v_mfma_f32_16x16x32_bf16 v[48:51], a[232:235], a[168:171], v[48:51]
    v_exp_f32 v138, v10
    v_exp_f32 v139, v11
    v_mfma_f32_16x16x32_bf16 v[48:51], a[236:239], a[172:175], v[48:51]
    v_exp_f32_e64 v140, v12
    v_cvt_pk_bf16_f32 v100, v136, v137
    v_mfma_f32_16x16x32_bf16 v[56:59], a[224:227], a[176:179], v[88:91]
    ds_read_b128 a[204:207], v241 offset:6144
    v_exp_f32_e64 v141, v13
    v_mfma_f32_16x16x32_bf16 v[56:59], a[228:231], a[180:183], v[56:59]
    v_exp_f32_e64 v142, v14
    v_cvt_pk_bf16_f32 v101, v138, v139
    v_mfma_f32_16x16x32_bf16 v[56:59], a[232:235], a[184:187], v[56:59]
    v_exp_f32_e64 v143, v15
    v_cvt_pk_bf16_f32 v102, v140, v141
    v_mfma_f32_16x16x32_bf16 v[56:59], a[236:239], a[188:191], v[56:59]
    v_exp_f32_e64 v128, v16
    v_cvt_pk_bf16_f32 v103, v142, v143
    v_mfma_f32_16x16x32_bf16 v[36:39], a[240:243], a[128:131], v[68:71]
    ds_read_b128 a[208:211], v241 offset:1024
    v_exp_f32_e64 v129, v17
    v_mfma_f32_16x16x32_bf16 v[36:39], a[244:247], a[132:135], v[36:39]
    v_exp_f32_e64 v130, v18
    v_cvt_pk_bf16_f32 v104, v128, v129
    v_mfma_f32_16x16x32_bf16 v[36:39], a[248:251], a[136:139], v[36:39]
    v_exp_f32_e64 v131, v19
    v_mfma_f32_16x16x32_bf16 v[36:39], a[252:255], a[140:143], v[36:39]
    v_exp_f32_e64 v132, v20
    v_cvt_pk_bf16_f32 v105, v130, v131
    v_mfma_f32_16x16x32_bf16 v[44:47], a[240:243], a[144:147], v[76:79]
    ds_read_b128 a[212:215], v241 offset:3072
    v_exp_f32_e64 v133, v21
    v_mfma_f32_16x16x32_bf16 v[44:47], a[244:247], a[148:151], v[44:47]
    v_exp_f32 v134, v22
    v_exp_f32 v135, v23
    v_mfma_f32_16x16x32_bf16 v[44:47], a[248:251], a[152:155], v[44:47]
    v_exp_f32_e64 v136, v24
    v_cvt_pk_bf16_f32 v106, v132, v133
    v_mfma_f32_16x16x32_bf16 v[44:47], a[252:255], a[156:159], v[44:47]
    v_exp_f32_e64 v137, v25
    v_cvt_pk_bf16_f32 v107, v134, v135
    v_mfma_f32_16x16x32_bf16 v[52:55], a[240:243], a[160:163], v[84:87]
    ds_read_b128 a[216:219], v241 offset:5120
    v_exp_f32_e64 v138, v26
    v_mfma_f32_16x16x32_bf16 v[52:55], a[244:247], a[164:167], v[52:55]
    v_exp_f32_e64 v139, v27
    v_cvt_pk_bf16_f32 v108, v136, v137
    v_mfma_f32_16x16x32_bf16 v[52:55], a[248:251], a[168:171], v[52:55]
    v_exp_f32_e64 v140, v28
    v_cvt_pk_bf16_f32 v109, v138, v139
    v_mfma_f32_16x16x32_bf16 v[52:55], a[252:255], a[172:175], v[52:55]
    v_exp_f32_e64 v141, v29
    v_mfma_f32_16x16x32_bf16 v[60:63], a[240:243], a[176:179], v[92:95]
    ds_read_b128 a[220:223], v241 offset:7168
    v_exp_f32_e64 v142, v30
    v_mfma_f32_16x16x32_bf16 v[60:63], a[244:247], a[180:183], v[60:63]
    v_exp_f32_e64 v143, v31
    v_cvt_pk_bf16_f32 v110, v140, v141
    v_mfma_f32_16x16x32_bf16 v[60:63], a[248:251], a[184:187], v[60:63]
    v_cvt_pk_bf16_f32 v111, v142, v143
    v_mfma_f32_16x16x32_bf16 v[60:63], a[252:255], a[188:191], v[60:63]
    v_add_f32 v200, 0, v243
    v_min_f32 v200, 0, v200
    v_add_f32 v201, 0xf1800000, v243
    v_min_f32_e64 v201, 0, v201
    v_add_f32 v202, 0xf2000000, v243
    v_min_f32_e64 v202, 0, v202
    v_add_f32 v203, 0xf2400000, v243
    v_min_f32_e64 v203, 0, v203
    v_add_f32 v209, 0xf3000000, v243
    v_min_f32_e64 v209, 0, v209
    v_add_f32 v210, 0xf3100000, v243
    v_min_f32_e64 v210, 0, v210
    v_add_f32 v211, 0xf3200000, v243
    v_min_f32_e64 v211, 0, v211
    v_add_f32 v212, 0xf3300000, v243
    v_min_f32_e64 v212, 0, v212
    v_add_f32 v213, 0x73800000, v243
    v_min_f32_e64 v213, 0, v213
    v_add_f32 v214, 0x73700000, v243
    v_min_f32_e64 v214, 0, v214
    v_add_f32 v215, 0x73600000, v243
    v_min_f32_e64 v215, 0, v215
    v_add_f32 v216, 0x73500000, v243
    v_min_f32_e64 v216, 0, v216
    v_add_f32 v217, 0x73000000, v243
    v_min_f32_e64 v217, 0, v217
    v_add_f32 v218, 0x72e00000, v243
    v_min_f32_e64 v218, 0, v218
    v_add_f32 v219, 0x72c00000, v243
    v_min_f32_e64 v219, 0, v219
    v_add_f32 v220, 0x72a00000, v243
    v_min_f32_e64 v220, 0, v220
    ds_read_b128 a[224:227], v241 offset:16384
    ds_read_b128 a[228:231], v241 offset:17408
    ds_read_b128 a[232:235], v241 offset:18432
    ds_read_b128 a[236:239], v241 offset:19456
    s_mul_i32 s27, s5, 68096
    s_sub_u32 s27, s32, s27
    s_add_u32 s18, s27, 1089536
    s_mov_b32 s31, s101
    v_mul_u32_u24 v245, 448, v240
    v_and_b32 v230, 0x40000000, v251
    v_or_b32 v245, v245, v230
    s_lshl1_add_u32 s26, s5, s31
    s_branch ka_p1_e
.p2align 5
ka_p1:
    s_sub_u32 s36, s36, 1
    s_cbranch_scc1 kf_fix7
kf_fixr8:
    s_waitcnt lgkmcnt(8)
    v_mfma_f32_16x16x32_bf16 v[0:3], a[192:195], a[128:131], v[64:67]
    ds_read_b128 a[240:243], v241 offset:20480
    s_waitcnt vmcnt(11)
    v_mfma_f32_16x16x32_bf16 v[0:3], a[196:199], a[132:135], v[0:3]
    v_exp_f32_e64 v128, v32
    v_mfma_f32_16x16x32_bf16 v[0:3], a[200:203], a[136:139], v[0:3]
    v_exp_f32_e64 v129, v33
    v_mfma_f32_16x16x32_bf16 v[0:3], a[204:207], a[140:143], v[0:3]
    v_exp_f32_e64 v130, v34
    v_mfma_f32_16x16x32_bf16 v[8:11], a[192:195], a[144:147], v[72:75]
    ds_read_b128 a[244:247], v241 offset:21504
    buffer_store_dwordx4 v[192:195], v255, s[48:51], s45 offen offset:0 sc1
    v_mfma_f32_16x16x32_bf16 v[8:11], a[196:199], a[148:151], v[8:11]
    s_cmp_lt_u32 s44, s47
    s_cselect_b32 s101, s44, s43
    v_mfma_f32_16x16x32_bf16 v[8:11], a[200:203], a[152:155], v[8:11]
    buffer_load_dwordx4 v[192:195], v253, s[52:55], s101 offen
    v_cvt_pk_bf16_f32 v112, v128, v129
    v_mfma_f32_16x16x32_bf16 v[8:11], a[204:207], a[156:159], v[8:11]
    v_exp_f32_e64 v131, v35
    v_mfma_f32_16x16x32_bf16 v[16:19], a[192:195], a[160:163], v[80:83]
    ds_read_b128 a[248:251], v241 offset:22528
    v_cvt_pk_bf16_f32 v113, v130, v131
    v_mfma_f32_16x16x32_bf16 v[16:19], a[196:199], a[164:167], v[16:19]
    v_exp_f32_e64 v132, v36
    v_mfma_f32_16x16x32_bf16 v[16:19], a[200:203], a[168:171], v[16:19]
    v_exp_f32_e64 v133, v37
    v_mfma_f32_16x16x32_bf16 v[16:19], a[204:207], a[172:175], v[16:19]
    v_exp_f32_e64 v134, v38
    v_mfma_f32_16x16x32_bf16 v[24:27], a[192:195], a[176:179], v[88:91]
    ds_read_b128 a[252:255], v241 offset:23552
    s_mov_b32 m0, s34
    v_mfma_f32_16x16x32_bf16 v[24:27], a[196:199], a[180:183], v[24:27]
    s_add_u32 s41, s42, 17664
    v_cvt_pk_bf16_f32 v114, v132, v133
    v_mfma_f32_16x16x32_bf16 v[24:27], a[200:203], a[184:187], v[24:27]
    v_exp_f32 v135, v39
    v_mfma_f32_16x16x32_bf16 v[24:27], a[204:207], a[188:191], v[24:27]
    v_or3_b32 v208, v112, v113, v114
    s_waitcnt lgkmcnt(8)
    v_mfma_f32_16x16x32_bf16 v[4:7], a[208:211], a[128:131], v[68:71]
    ds_read_b128 a[192:195], v241 offset:8192
    v_cvt_pk_bf16_f32 v115, v134, v135
    v_mfma_f32_16x16x32_bf16 v[4:7], a[212:215], a[132:135], v[4:7]
    v_exp_f32 v136, v40
    v_mfma_f32_16x16x32_bf16 v[4:7], a[216:219], a[136:139], v[4:7]
    v_exp_f32_e64 v137, v41
    v_mfma_f32_16x16x32_bf16 v[4:7], a[220:223], a[140:143], v[4:7]
    v_exp_f32_e64 v138, v42
    v_mfma_f32_16x16x32_bf16 v[12:15], a[208:211], a[144:147], v[76:79]
    ds_read_b128 a[196:199], v241 offset:10240
    buffer_load_dwordx4 v242, s[16:19], s41 offen offset:0 sc1 lds
    v_mfma_f32_16x16x32_bf16 v[12:15], a[212:215], a[148:151], v[12:15]
    v_exp_f32_e64 v139, v43
    v_mfma_f32_16x16x32_bf16 v[12:15], a[216:219], a[152:155], v[12:15]
    v_exp_f32_e64 v140, v44
    v_mfma_f32_16x16x32_bf16 v[12:15], a[220:223], a[156:159], v[12:15]
    v_exp_f32_e64 v141, v45
    v_mfma_f32_16x16x32_bf16 v[20:23], a[208:211], a[160:163], v[84:87]
    ds_read_b128 a[200:203], v241 offset:12288
    v_cvt_pk_bf16_f32 v116, v136, v137
    v_mfma_f32_16x16x32_bf16 v[20:23], a[212:215], a[164:167], v[20:23]
    v_exp_f32_e64 v142, v46
    v_mfma_f32_16x16x32_bf16 v[20:23], a[216:219], a[168:171], v[20:23]
    v_exp_f32_e64 v143, v47
    v_mfma_f32_16x16x32_bf16 v[20:23], a[220:223], a[172:175], v[20:23]
    v_or3_b32 v208, v208, v115, v116
    v_cvt_pk_bf16_f32 v117, v138, v139
    v_mfma_f32_16x16x32_bf16 v[28:31], a[208:211], a[176:179], v[92:95]
    ds_read_b128 a[204:207], v241 offset:14336
    buffer_load_dwordx4 v242, s[16:19], s41 offen offset:1024 sc1 lds
    v_mfma_f32_16x16x32_bf16 v[28:31], a[212:215], a[180:183], v[28:31]
    v_exp_f32_e64 v128, v48
    v_mfma_f32_16x16x32_bf16 v[28:31], a[216:219], a[184:187], v[28:31]
    v_exp_f32_e64 v129, v49
    v_mfma_f32_16x16x32_bf16 v[28:31], a[220:223], a[188:191], v[28:31]
    v_cvt_pk_bf16_f32 v118, v140, v141
    s_waitcnt lgkmcnt(8)
    v_mfma_f32_16x16x32_bf16 a[0:3], a[224:227], v[96:99], a[0:3]
    ds_read_b128 a[208:211], v241 offset:9216
    v_or3_b32 v208, v208, v117, v118
    v_mfma_f32_16x16x32_bf16 a[32:35], a[224:227], v[100:103], a[32:35]
    v_exp_f32 v130, v50
    v_mfma_f32_16x16x32_bf16 a[64:67], a[224:227], v[104:107], a[64:67]
    v_exp_f32_e64 v131, v51
    v_mfma_f32_16x16x32_bf16 a[96:99], a[224:227], v[108:111], a[96:99]
    v_exp_f32_e64 v132, v52
    v_mfma_f32_16x16x32_bf16 a[4:7], a[228:231], v[96:99], a[4:7]
    ds_read_b128 a[212:215], v241 offset:11264
    v_cvt_pk_bf16_f32 v119, v142, v143
    v_mfma_f32_16x16x32_bf16 a[36:39], a[228:231], v[100:103], a[36:39]
    buffer_load_dwordx4 v242, s[16:19], s41 offen offset:2048 sc1 lds
    v_cvt_pk_bf16_f32 v120, v128, v129
    v_mfma_f32_16x16x32_bf16 a[68:71], a[228:231], v[104:107], a[68:71]
    v_exp_f32_e64 v133, v53
    v_mfma_f32_16x16x32_bf16 a[100:103], a[228:231], v[108:111], a[100:103]
    v_exp_f32_e64 v134, v54
    v_mfma_f32_16x16x32_bf16 a[8:11], a[232:235], v[96:99], a[8:11]
    ds_read_b128 a[216:219], v241 offset:13312
    v_or3_b32 v208, v208, v119, v120
    v_mfma_f32_16x16x32_bf16 a[40:43], a[232:235], v[100:103], a[40:43]
    v_exp_f32_e64 v135, v55
    v_mfma_f32_16x16x32_bf16 a[72:75], a[232:235], v[104:107], a[72:75]
    v_exp_f32_e64 v136, v56
    v_mfma_f32_16x16x32_bf16 a[104:107], a[232:235], v[108:111], a[104:107]
    v_exp_f32_e64 v137, v57
    v_mfma_f32_16x16x32_bf16 a[12:15], a[236:239], v[96:99], a[12:15]
    ds_read_b128 a[220:223], v241 offset:15360
    v_cvt_pk_bf16_f32 v121, v130, v131
    v_mfma_f32_16x16x32_bf16 a[44:47], a[236:239], v[100:103], a[44:47]
    v_cvt_pk_bf16_f32 v122, v132, v133
    v_or3_b32 v208, v208, v121, v122
    v_mfma_f32_16x16x32_bf16 a[76:79], a[236:239], v[104:107], a[76:79]
    buffer_load_dwordx4 v242, s[16:19], s41 offen offset:3072 sc1 lds
    v_cvt_pk_bf16_f32 v123, v134, v135
    v_mfma_f32_16x16x32_bf16 a[108:111], a[236:239], v[108:111], a[108:111]
    v_cvt_pk_bf16_f32 v124, v136, v137
    s_waitcnt lgkmcnt(8)
    v_mfma_f32_16x16x32_bf16 a[16:19], a[240:243], v[96:99], a[16:19]
    ds_read_b128 a[224:227], v241 offset:24576
    v_or3_b32 v208, v208, v123, v124
    v_mfma_f32_16x16x32_bf16 a[48:51], a[240:243], v[100:103], a[48:51]
    v_exp_f32 v138, v58
    v_mfma_f32_16x16x32_bf16 a[80:83], a[240:243], v[104:107], a[80:83]
    v_exp_f32_e64 v139, v59
    v_mfma_f32_16x16x32_bf16 a[112:115], a[240:243], v[108:111], a[112:115]
    v_exp_f32_e64 v140, v60
    v_mfma_f32_16x16x32_bf16 a[20:23], a[244:247], v[96:99], a[20:23]
    ds_read_b128 a[228:231], v241 offset:25600
    v_cvt_pk_bf16_f32 v125, v138, v139
    v_mfma_f32_16x16x32_bf16 a[52:55], a[244:247], v[100:103], a[52:55]
    v_exp_f32_e64 v141, v61
    v_mfma_f32_16x16x32_bf16 a[84:87], a[244:247], v[104:107], a[84:87]
    v_exp_f32_e64 v142, v62
    v_mfma_f32_16x16x32_bf16 a[116:119], a[244:247], v[108:111], a[116:119]
    s_add_u32 s35, s35, 32768
    v_cvt_pk_bf16_f32 v126, v140, v141
    v_mfma_f32_16x16x32_bf16 a[24:27], a[248:251], v[96:99], a[24:27]
    ds_read_b128 a[232:235], v241 offset:26624
    v_or3_b32 v208, v208, v125, v126
    v_mfma_f32_16x16x32_bf16 a[56:59], a[248:251], v[100:103], a[56:59]
    s_cmp_ge_u32 s35, 163840
    s_cselect_b32 s35, 0, s35
    v_mfma_f32_16x16x32_bf16 a[88:91], a[248:251], v[104:107], a[88:91]
    v_exp_f32 v143, v63
    v_mfma_f32_16x16x32_bf16 a[120:123], a[248:251], v[108:111], a[120:123]
    v_cvt_pk_bf16_f32 v127, v142, v143
    v_or_b32_e64 v208, v208, v127
    v_mfma_f32_16x16x32_bf16 a[28:31], a[252:255], v[96:99], a[28:31]
    ds_read_b128 a[236:239], v241 offset:27648
    v_and_b32_e64 v208, s38, v208
    v_mfma_f32_16x16x32_bf16 a[60:63], a[252:255], v[100:103], a[60:63]
    v_cmp_ne_u32_e64 vcc, 0, v208
    v_mfma_f32_16x16x32_bf16 a[92:95], a[252:255], v[104:107], a[92:95]
    v_mfma_f32_16x16x32_bf16 a[124:127], a[252:255], v[108:111], a[124:127]
    v_mfma_f32_16x16x32_bf16 v[144:147], v[204:207], v[96:99], v[144:147]
    v_mfma_f32_16x16x32_bf16 v[148:151], v[204:207], v[100:103], v[148:151]
    v_mfma_f32_16x16x32_bf16 v[152:155], v[204:207], v[104:107], v[152:155]
    v_mfma_f32_16x16x32_bf16 v[156:159], v[204:207], v[108:111], v[156:159]
    s_cbranch_vccnz kf_rare6
kf_rr5:
    s_sub_u32 s36, s36, 1
    s_cbranch_scc1 kf_fix11
kf_fixr12:
    s_waitcnt lgkmcnt(8)
    v_mfma_f32_16x16x32_bf16 v[32:35], a[192:195], a[128:131], v[64:67]
    ds_read_b128 a[240:243], v241 offset:28672
    s_waitcnt vmcnt(11)
    v_mfma_f32_16x16x32_bf16 v[32:35], a[196:199], a[132:135], v[32:35]
    v_exp_f32 v128, v0
    v_mfma_f32_16x16x32_bf16 v[32:35], a[200:203], a[136:139], v[32:35]
    v_exp_f32_e64 v129, v1
    v_mfma_f32_16x16x32_bf16 v[32:35], a[204:207], a[140:143], v[32:35]
    v_exp_f32_e64 v130, v2
    v_mfma_f32_16x16x32_bf16 v[40:43], a[192:195], a[144:147], v[72:75]
    ds_read_b128 a[244:247], v241 offset:29696
    buffer_store_dwordx4 v[196:199], v255, s[48:51], s45 offen offset:256 sc1
    v_mfma_f32_16x16x32_bf16 v[40:43], a[196:199], a[148:151], v[40:43]
    s_add_u32 s101, s101, 57344
    buffer_load_dwordx4 v[196:199], v253, s[52:55], s101 offen
    v_mfma_f32_16x16x32_bf16 v[40:43], a[200:203], a[152:155], v[40:43]
    v_exp_f32_e64 v131, v3
    v_mfma_f32_16x16x32_bf16 v[40:43], a[204:207], a[156:159], v[40:43]
    v_exp_f32_e64 v132, v4
    v_mfma_f32_16x16x32_bf16 v[48:51], a[192:195], a[160:163], v[80:83]
    ds_read_b128 a[248:251], v241 offset:30720
    v_cvt_pk_bf16_f32 v96, v128, v129
    v_mfma_f32_16x16x32_bf16 v[48:51], a[196:199], a[164:167], v[48:51]
    s_cmp_lt_u32 s44, s47
    s_cselect_b32 s45, s46, s43
    v_mfma_f32_16x16x32_bf16 v[48:51], a[200:203], a[168:171], v[48:51]
    v_exp_f32_e64 v133, v5
    v_mfma_f32_16x16x32_bf16 v[48:51], a[204:207], a[172:175], v[48:51]
    v_exp_f32_e64 v134, v6
    v_mfma_f32_16x16x32_bf16 v[56:59], a[192:195], a[176:179], v[88:91]
    ds_read_b128 a[252:255], v241 offset:31744
    s_add_u32 s44, s44, 128
    v_mfma_f32_16x16x32_bf16 v[56:59], a[196:199], a[180:183], v[56:59]
    s_add_u32 s46, s46, 262144
    v_cvt_pk_bf16_f32 v97, v130, v131
    v_mfma_f32_16x16x32_bf16 v[56:59], a[200:203], a[184:187], v[56:59]
    v_exp_f32_e64 v135, v7
    v_mfma_f32_16x16x32_bf16 v[56:59], a[204:207], a[188:191], v[56:59]
    v_cvt_pk_bf16_f32 v98, v132, v133
    s_waitcnt lgkmcnt(8)
    v_mfma_f32_16x16x32_bf16 v[36:39], a[208:211], a[128:131], v[68:71]
    s_waitcnt vmcnt(16)
    s_barrier
    v_add_u32 v241, s35, v240
    ds_read_b128 a[192:195], v241 offset:0
    v_mfma_f32_16x16x32_bf16 v[36:39], a[212:215], a[132:135], v[36:39]
    v_exp_f32_e64 v136, v8
    v_mfma_f32_16x16x32_bf16 v[36:39], a[216:219], a[136:139], v[36:39]
    v_exp_f32_e64 v137, v9
    v_mfma_f32_16x16x32_bf16 v[36:39], a[220:223], a[140:143], v[36:39]
    v_exp_f32_e64 v138, v10
    v_mfma_f32_16x16x32_bf16 v[44:47], a[208:211], a[144:147], v[76:79]
    ds_read_b128 a[196:199], v241 offset:2048
    s_add_u32 m0, s34, 16384
    v_mfma_f32_16x16x32_bf16 v[44:47], a[212:215], a[148:151], v[44:47]
    s_add_u32 s34, s34, 32768
    v_or3_b32 v208, v96, v97, v98
    v_mfma_f32_16x16x32_bf16 v[44:47], a[216:219], a[152:155], v[44:47]
    s_cmp_ge_u32 s34, 163840
    s_cselect_b32 s34, s37, s34
    v_mfma_f32_16x16x32_bf16 v[44:47], a[220:223], a[156:159], v[44:47]
    v_exp_f32 v139, v11
    v_mfma_f32_16x16x32_bf16 v[52:55], a[208:211], a[160:163], v[84:87]
    ds_read_b128 a[200:203], v241 offset:4096
    v_cvt_pk_bf16_f32 v99, v134, v135
    v_mfma_f32_16x16x32_bf16 v[52:55], a[212:215], a[164:167], v[52:55]
    v_exp_f32_e64 v140, v12
    v_mfma_f32_16x16x32_bf16 v[52:55], a[216:219], a[168:171], v[52:55]
    v_exp_f32_e64 v141, v13
    v_mfma_f32_16x16x32_bf16 v[52:55], a[220:223], a[172:175], v[52:55]
    v_cvt_pk_bf16_f32 v100, v136, v137
    buffer_load_dwordx4 v242, s[16:19], s42 offen offset:0 sc1 lds
    v_mfma_f32_16x16x32_bf16 v[60:63], a[208:211], a[176:179], v[92:95]
    ds_read_b128 a[204:207], v241 offset:6144
    v_or3_b32 v208, v208, v99, v100
    v_mfma_f32_16x16x32_bf16 v[60:63], a[212:215], a[180:183], v[60:63]
    v_exp_f32_e64 v142, v14
    v_mfma_f32_16x16x32_bf16 v[60:63], a[216:219], a[184:187], v[60:63]
    v_exp_f32_e64 v143, v15
    v_mfma_f32_16x16x32_bf16 v[60:63], a[220:223], a[188:191], v[60:63]
    v_cvt_pk_bf16_f32 v101, v138, v139
    s_waitcnt lgkmcnt(8)
    v_mfma_f32_16x16x32_bf16 a[0:3], a[224:227], v[112:115], a[0:3]
    ds_read_b128 a[208:211], v241 offset:1024
    v_cvt_pk_bf16_f32 v102, v140, v141
    v_mfma_f32_16x16x32_bf16 a[32:35], a[224:227], v[116:119], a[32:35]
    v_exp_f32 v128, v16
    v_mfma_f32_16x16x32_bf16 a[64:67], a[224:227], v[120:123], a[64:67]
    v_exp_f32_e64 v129, v17
    v_mfma_f32_16x16x32_bf16 a[96:99], a[224:227], v[124:127], a[96:99]
    v_exp_f32_e64 v130, v18
    v_mfma_f32_16x16x32_bf16 a[4:7], a[228:231], v[112:115], a[4:7]
    ds_read_b128 a[212:215], v241 offset:3072
    buffer_load_dwordx4 v242, s[16:19], s42 offen offset:1024 sc1 lds
    v_mfma_f32_16x16x32_bf16 a[36:39], a[228:231], v[116:119], a[36:39]
    v_exp_f32_e64 v131, v19
    v_mfma_f32_16x16x32_bf16 a[68:71], a[228:231], v[120:123], a[68:71]
    v_or3_b32 v208, v208, v101, v102
    v_cvt_pk_bf16_f32 v103, v142, v143
    v_mfma_f32_16x16x32_bf16 a[100:103], a[228:231], v[124:127], a[100:103]
    v_exp_f32_e64 v132, v20
    v_mfma_f32_16x16x32_bf16 a[8:11], a[232:235], v[112:115], a[8:11]
    ds_read_b128 a[216:219], v241 offset:5120
    v_cvt_pk_bf16_f32 v104, v128, v129
    v_mfma_f32_16x16x32_bf16 a[40:43], a[232:235], v[116:119], a[40:43]
    v_exp_f32_e64 v133, v21
    v_mfma_f32_16x16x32_bf16 a[72:75], a[232:235], v[120:123], a[72:75]
    v_exp_f32_e64 v134, v22
    v_mfma_f32_16x16x32_bf16 a[104:107], a[232:235], v[124:127], a[104:107]
    v_exp_f32_e64 v135, v23
    v_mfma_f32_16x16x32_bf16 a[12:15], a[236:239], v[112:115], a[12:15]
    ds_read_b128 a[220:223], v241 offset:7168
    buffer_load_dwordx4 v242, s[16:19], s42 offen offset:2048 sc1 lds
    v_mfma_f32_16x16x32_bf16 a[44:47], a[236:239], v[116:119], a[44:47]
    v_or3_b32 v208, v208, v103, v104
    v_cvt_pk_bf16_f32 v105, v130, v131
    v_mfma_f32_16x16x32_bf16 a[76:79], a[236:239], v[120:123], a[76:79]
    v_exp_f32_e64 v136, v24
    v_mfma_f32_16x16x32_bf16 a[108:111], a[236:239], v[124:127], a[108:111]
    v_cvt_pk_bf16_f32 v106, v132, v133
    s_waitcnt lgkmcnt(8)
    v_mfma_f32_16x16x32_bf16 a[16:19], a[240:243], v[112:115], a[16:19]
    ds_read_b128 a[224:227], v241 offset:16384
    v_or3_b32 v208, v208, v105, v106
    v_mfma_f32_16x16x32_bf16 a[48:51], a[240:243], v[116:119], a[48:51]
    v_exp_f32 v137, v25
    v_mfma_f32_16x16x32_bf16 a[80:83], a[240:243], v[120:123], a[80:83]
    v_exp_f32_e64 v138, v26
    v_mfma_f32_16x16x32_bf16 a[112:115], a[240:243], v[124:127], a[112:115]
    v_exp_f32_e64 v139, v27
    v_mfma_f32_16x16x32_bf16 a[20:23], a[244:247], v[112:115], a[20:23]
    ds_read_b128 a[228:231], v241 offset:17408
    buffer_load_dwordx4 v242, s[16:19], s42 offen offset:3072 sc1 lds
    v_mfma_f32_16x16x32_bf16 a[52:55], a[244:247], v[116:119], a[52:55]
    s_add_u32 s42, s42, 34048
    v_cvt_pk_bf16_f32 v107, v134, v135
    v_mfma_f32_16x16x32_bf16 a[84:87], a[244:247], v[120:123], a[84:87]
    v_exp_f32_e64 v140, v28
    v_mfma_f32_16x16x32_bf16 a[116:119], a[244:247], v[124:127], a[116:119]
    v_exp_f32_e64 v141, v29
    v_mfma_f32_16x16x32_bf16 a[24:27], a[248:251], v[112:115], a[24:27]
    ds_read_b128 a[232:235], v241 offset:18432
    v_cvt_pk_bf16_f32 v108, v136, v137
    v_mfma_f32_16x16x32_bf16 a[56:59], a[248:251], v[116:119], a[56:59]
    v_exp_f32_e64 v142, v30
    v_mfma_f32_16x16x32_bf16 a[88:91], a[248:251], v[120:123], a[88:91]
    v_exp_f32_e64 v143, v31
    v_mfma_f32_16x16x32_bf16 a[120:123], a[248:251], v[124:127], a[120:123]
    buffer_load_dword v252, v251, s[60:63], s100 offen
    s_add_u32 s100, s100, 2048
    v_mfma_f32_16x16x32_bf16 a[28:31], a[252:255], v[112:115], a[28:31]
    ds_read_b128 a[236:239], v241 offset:19456
    v_or3_b32 v208, v208, v107, v108
    v_mfma_f32_16x16x32_bf16 a[60:63], a[252:255], v[116:119], a[60:63]
    v_cvt_pk_bf16_f32 v109, v138, v139
    v_cvt_pk_bf16_f32 v110, v140, v141
    v_mfma_f32_16x16x32_bf16 a[92:95], a[252:255], v[120:123], a[92:95]
    v_or3_b32 v208, v208, v109, v110
    v_cvt_pk_bf16_f32 v111, v142, v143
    v_mfma_f32_16x16x32_bf16 a[124:127], a[252:255], v[124:127], a[124:127]
    v_or_b32 v208, v208, v111
    v_and_b32 v208, s38, v208
    v_mfma_f32_16x16x32_bf16 v[144:147], v[204:207], v[112:115], v[144:147]
    v_cmp_ne_u32_e64 vcc, 0, v208
    v_mfma_f32_16x16x32_bf16 v[148:151], v[204:207], v[116:119], v[148:151]
    v_mfma_f32_16x16x32_bf16 v[152:155], v[204:207], v[120:123], v[152:155]
    v_mfma_f32_16x16x32_bf16 v[156:159], v[204:207], v[124:127], v[156:159]
    s_cbranch_vccnz kf_rare10
kf_rr9:
ka_p1_e:
    s_sub_u32 s26, s26, 1
    s_cbranch_scc0 ka_p1
    s_branch ka_p1_x
kf_fix7:
    s_mov_b32 s24, 0
    s_branch kf_fix7c
kf_fix11:
    s_mov_b32 s24, 1
kf_fix7c:
    s_cmp_eq_u32 s33, 0
    s_cbranch_scc0 kf_fix7f
    s_mov_b32 s36, 0
    s_mov_b32 s33, 1
    v_add_f32 v64, v224, v200
    v_add_f32 v65, v224, v201
    v_add_f32 v66, v224, v202
    v_add_f32 v67, v224, v203
    v_add_f32 v68, v224, v209
    v_add_f32 v69, v224, v210
    v_add_f32 v70, v224, v211
    v_add_f32 v71, v224, v212
    v_add_f32 v72, v225, v213
    v_add_f32 v73, v225, v214
    v_add_f32 v74, v225, v215
    v_add_f32 v75, v225, v216
    v_add_f32 v76, v225, v217
    v_add_f32 v77, v225, v218
    v_add_f32 v78, v225, v219
    v_add_f32 v79, v225, v220
    s_cmp_eq_u32 s24, 0
    s_cbranch_scc1 kf_fixr8
    s_branch kf_fixr12
kf_fix7f:
    s_mov_b32 s36, 0x1000
    v_mov_b32 v64, 0xf1800000
    v_mov_b32 v65, v64
    v_mov_b32 v66, v64
    v_mov_b32 v67, v64
    v_mov_b32 v68, v64
    v_mov_b32 v69, v64
    v_mov_b32 v70, v64
    v_mov_b32 v71, v64
    v_mov_b32 v72, v64
    v_mov_b32 v73, v64
    v_mov_b32 v74, v64
    v_mov_b32 v75, v64
    v_mov_b32 v76, v64
    v_mov_b32 v77, v64
    v_mov_b32 v78, v64
    v_mov_b32 v79, v64
    s_cmp_eq_u32 s24, 0
    s_cbranch_scc1 kf_fixr8
    s_branch kf_fixr12
kf_fix15:
    s_mov_b32 s24, 0
    s_branch kf_fix15c
kf_fix19:
    s_mov_b32 s24, 1
kf_fix15c:
    s_cmp_eq_u32 s33, 0
    s_cbranch_scc0 kf_fix15f
    s_mov_b32 s36, 0
    s_mov_b32 s33, 1
    v_add_f32 v80, v226, v200
    v_add_f32 v81, v226, v201
    v_add_f32 v82, v226, v202
    v_add_f32 v83, v226, v203
    v_add_f32 v84, v226, v209
    v_add_f32 v85, v226, v210
    v_add_f32 v86, v226, v211
    v_add_f32 v87, v226, v212
    v_add_f32 v88, v227, v213
    v_add_f32 v89, v227, v214
    v_add_f32 v90, v227, v215
    v_add_f32 v91, v227, v216
    v_add_f32 v92, v227, v217
    v_add_f32 v93, v227, v218
    v_add_f32 v94, v227, v219
    v_add_f32 v95, v227, v220
    s_cmp_eq_u32 s24, 0
    s_cbranch_scc1 kf_fixr16
    s_branch kf_fixr20
kf_fix15f:
    s_mov_b32 s36, 0x1000
    v_mov_b32 v80, 0xf1800000
    v_mov_b32 v81, v80
    v_mov_b32 v82, v80
    v_mov_b32 v83, v80
    v_mov_b32 v84, v80
    v_mov_b32 v85, v80
    v_mov_b32 v86, v80
    v_mov_b32 v87, v80
    v_mov_b32 v88, v80
    v_mov_b32 v89, v80
    v_mov_b32 v90, v80
    v_mov_b32 v91, v80
    v_mov_b32 v92, v80
    v_mov_b32 v93, v80
    v_mov_b32 v94, v80
    v_mov_b32_e64 v95, v80
    s_cmp_eq_u32 s24, 0
    s_cbranch_scc1 kf_fixr16
    s_branch kf_fixr20
ka_p1_x:
    s_lshl2_add_u32 s36, s5, s6
    s_lshl1_add_u32 s36, s31, s36
    s_sub_u32 s36, 61, s36
    s_mov_b32 s33, 0
    s_sub_u32 s36, s36, 1
    s_cbranch_scc1 kf_fix15
kf_fixr16:
    s_waitcnt lgkmcnt(8)
    v_mfma_f32_16x16x32_bf16 v[16:19], a[192:195], a[160:163], v[80:83]
    ds_read_b128 a[240:243], v241 offset:20480
    ds_read_b128 a[244:247], v241 offset:21504
    v_mfma_f32_16x16x32_bf16 v[16:19], a[196:199], a[164:167], v[16:19]
    s_waitcnt vmcnt(11)
    v_exp_f32 v128, v32
    v_mfma_f32_16x16x32_bf16 v[16:19], a[200:203], a[168:171], v[16:19]
    v_exp_f32_e64 v129, v33
    v_mfma_f32_16x16x32_bf16 v[16:19], a[204:207], a[172:175], v[16:19]
    buffer_store_dwordx4 v[192:195], v255, s[48:51], s45 offen offset:0 sc1
    v_exp_f32_e64 v130, v34
    v_mfma_f32_16x16x32_bf16 v[24:27], a[192:195], a[176:179], v[88:91]
    ds_read_b128 a[248:251], v241 offset:22528
    ds_read_b128 a[252:255], v241 offset:23552
    v_mfma_f32_16x16x32_bf16 v[24:27], a[196:199], a[180:183], v[24:27]
    v_exp_f32_e64 v131, v35
    v_mfma_f32_16x16x32_bf16 v[24:27], a[200:203], a[184:187], v[24:27]
    v_exp_f32_e64 v132, v36
    v_cvt_pk_bf16_f32 v112, v128, v129
    v_mfma_f32_16x16x32_bf16 v[24:27], a[204:207], a[188:191], v[24:27]
    s_mov_b32 m0, s34
    s_waitcnt lgkmcnt(8)
    v_mfma_f32_16x16x32_bf16 v[20:23], a[208:211], a[160:163], v[84:87]
    ds_read_b128 a[192:195], v241 offset:8192
    ds_read_b128 a[196:199], v241 offset:10240
    v_mfma_f32_16x16x32_bf16 v[20:23], a[212:215], a[164:167], v[20:23]
    s_add_u32 s41, s42, 17664
    v_exp_f32_e64 v133, v37
    v_mfma_f32_16x16x32_bf16 v[20:23], a[216:219], a[168:171], v[20:23]
    v_exp_f32_e64 v134, v38
    v_mfma_f32_16x16x32_bf16 v[20:23], a[220:223], a[172:175], v[20:23]
    v_exp_f32_e64 v135, v39
    v_mfma_f32_16x16x32_bf16 v[28:31], a[208:211], a[176:179], v[92:95]
    ds_read_b128 a[200:203], v241 offset:12288
    ds_read_b128 a[204:207], v241 offset:14336
    v_cvt_pk_bf16_f32 v113, v130, v131
    v_mfma_f32_16x16x32_bf16 v[28:31], a[212:215], a[180:183], v[28:31]
    v_exp_f32_e64 v136, v40
    v_mfma_f32_16x16x32_bf16 v[28:31], a[216:219], a[184:187], v[28:31]
    v_exp_f32_e64 v137, v41
    v_mfma_f32_16x16x32_bf16 v[28:31], a[220:223], a[188:191], v[28:31]
    v_cvt_pk_bf16_f32 v114, v132, v133
    buffer_load_dwordx4 v242, s[16:19], s41 offen offset:0 sc1 lds
    s_waitcnt lgkmcnt(8)
    v_mfma_f32_16x16x32_bf16 a[0:3], a[224:227], v[96:99], a[0:3]
    ds_read_b128 a[208:211], v241 offset:9216
    v_or3_b32 v208, v112, v113, v114
    v_mfma_f32_16x16x32_bf16 a[32:35], a[224:227], v[100:103], a[32:35]
    v_exp_f32 v138, v42
    v_mfma_f32_16x16x32_bf16 a[64:67], a[224:227], v[104:107], a[64:67]
    v_exp_f32_e64 v139, v43
    v_cvt_pk_bf16_f32 v115, v134, v135
    v_mfma_f32_16x16x32_bf16 a[96:99], a[224:227], v[108:111], a[96:99]
    v_exp_f32_e64 v140, v44
    v_mfma_f32_16x16x32_bf16 a[4:7], a[228:231], v[96:99], a[4:7]
    ds_read_b128 a[212:215], v241 offset:11264
    v_cvt_pk_bf16_f32 v116, v136, v137
    v_mfma_f32_16x16x32_bf16 a[36:39], a[228:231], v[100:103], a[36:39]
    buffer_load_dwordx4 v242, s[16:19], s41 offen offset:1024 sc1 lds
    v_exp_f32_e64 v141, v45
    v_mfma_f32_16x16x32_bf16 a[68:71], a[228:231], v[104:107], a[68:71]
    v_exp_f32_e64 v142, v46
    v_mfma_f32_16x16x32_bf16 a[100:103], a[228:231], v[108:111], a[100:103]
    v_exp_f32_e64 v143, v47
    v_mfma_f32_16x16x32_bf16 a[8:11], a[232:235], v[96:99], a[8:11]
    ds_read_b128 a[216:219], v241 offset:13312
    v_or3_b32 v208, v208, v115, v116
    v_cvt_pk_bf16_f32 v117, v138, v139
    v_mfma_f32_16x16x32_bf16 a[40:43], a[232:235], v[100:103], a[40:43]
    v_exp_f32_e64 v128, v48
    v_mfma_f32_16x16x32_bf16 a[72:75], a[232:235], v[104:107], a[72:75]
    v_exp_f32_e64 v129, v49
    v_mfma_f32_16x16x32_bf16 a[104:107], a[232:235], v[108:111], a[104:107]
    v_cvt_pk_bf16_f32 v118, v140, v141
    v_exp_f32_e64 v130, v50
    v_mfma_f32_16x16x32_bf16 a[12:15], a[236:239], v[96:99], a[12:15]
    ds_read_b128 a[220:223], v241 offset:15360
    buffer_load_dwordx4 v242, s[16:19], s41 offen offset:2048 sc1 lds
    v_mfma_f32_16x16x32_bf16 a[44:47], a[236:239], v[100:103], a[44:47]
    v_exp_f32_e64 v131, v51
    v_or3_b32 v208, v208, v117, v118
    v_mfma_f32_16x16x32_bf16 a[76:79], a[236:239], v[104:107], a[76:79]
    v_exp_f32_e64 v132, v52
    v_mfma_f32_16x16x32_bf16 a[108:111], a[236:239], v[108:111], a[108:111]
    v_cvt_pk_bf16_f32 v119, v142, v143
    s_waitcnt lgkmcnt(8)
    v_mfma_f32_16x16x32_bf16 a[16:19], a[240:243], v[96:99], a[16:19]
    ds_read_b128 a[224:227], v241 offset:24576
    v_exp_f32 v133, v53
    v_mfma_f32_16x16x32_bf16 a[48:51], a[240:243], v[100:103], a[48:51]
    v_cvt_pk_bf16_f32 v120, v128, v129
    v_or3_b32 v208, v208, v119, v120
    v_mfma_f32_16x16x32_bf16 a[80:83], a[240:243], v[104:107], a[80:83]
    v_exp_f32_e64 v134, v54
    v_mfma_f32_16x16x32_bf16 a[112:115], a[240:243], v[108:111], a[112:115]
    buffer_load_dwordx4 v242, s[16:19], s41 offen offset:3072 sc1 lds
    v_exp_f32_e64 v135, v55
    v_mfma_f32_16x16x32_bf16 a[20:23], a[244:247], v[96:99], a[20:23]
    ds_read_b128 a[228:231], v241 offset:25600
    v_cvt_pk_bf16_f32 v121, v130, v131
    v_mfma_f32_16x16x32_bf16 a[52:55], a[244:247], v[100:103], a[52:55]
    v_exp_f32_e64 v136, v56
    v_mfma_f32_16x16x32_bf16 a[84:87], a[244:247], v[104:107], a[84:87]
    v_exp_f32_e64 v137, v57
    v_cvt_pk_bf16_f32 v122, v132, v133
    v_mfma_f32_16x16x32_bf16 a[116:119], a[244:247], v[108:111], a[116:119]
    v_exp_f32_e64 v138, v58
    v_mfma_f32_16x16x32_bf16 a[24:27], a[248:251], v[96:99], a[24:27]
    ds_read_b128 a[232:235], v241 offset:26624
    v_or3_b32 v208, v208, v121, v122
    v_mfma_f32_16x16x32_bf16 a[56:59], a[248:251], v[100:103], a[56:59]
    v_exp_f32_e64 v139, v59
    v_cvt_pk_bf16_f32 v123, v134, v135
    v_mfma_f32_16x16x32_bf16 a[88:91], a[248:251], v[104:107], a[88:91]
    v_exp_f32_e64 v140, v60
    v_mfma_f32_16x16x32_bf16 a[120:123], a[248:251], v[108:111], a[120:123]
    v_exp_f32_e64 v141, v61
    v_mfma_f32_16x16x32_bf16 a[28:31], a[252:255], v[96:99], a[28:31]
    ds_read_b128 a[236:239], v241 offset:27648
    v_cvt_pk_bf16_f32 v124, v136, v137
    s_add_u32 s35, s35, 32768
    v_mfma_f32_16x16x32_bf16 a[60:63], a[252:255], v[100:103], a[60:63]
    s_cmp_ge_u32 s35, 163840
    s_cselect_b32 s35, 0, s35
    v_mfma_f32_16x16x32_bf16 a[92:95], a[252:255], v[104:107], a[92:95]
    v_exp_f32 v142, v62
    v_mfma_f32_16x16x32_bf16 a[124:127], a[252:255], v[108:111], a[124:127]
    v_exp_f32_e64 v143, v63
    v_or3_b32 v208, v208, v123, v124
    v_mfma_f32_16x16x32_bf16 v[144:147], v[204:207], v[96:99], v[144:147]
    v_cvt_pk_bf16_f32 v125, v138, v139
    v_cvt_pk_bf16_f32 v126, v140, v141
    v_mfma_f32_16x16x32_bf16 v[148:151], v[204:207], v[100:103], v[148:151]
    v_or3_b32 v208, v208, v125, v126
    v_cvt_pk_bf16_f32 v127, v142, v143
    v_mfma_f32_16x16x32_bf16 v[152:155], v[204:207], v[104:107], v[152:155]
    v_or_b32 v208, v208, v127
    v_and_b32 v208, s38, v208
    v_cmp_ne_u32_e64 vcc, 0, v208
    v_mfma_f32_16x16x32_bf16 v[156:159], v[204:207], v[108:111], v[156:159]
    s_cbranch_vccnz kf_rare14
kf_rr13:
    s_sub_u32 s36, s36, 1
    s_cbranch_scc1 kf_fix19
kf_fixr20:
    s_waitcnt lgkmcnt(8)
    v_mfma_f32_16x16x32_bf16 v[48:51], a[192:195], a[160:163], v[80:83]
    ds_read_b128 a[240:243], v241 offset:28672
    ds_read_b128 a[244:247], v241 offset:29696
    v_mfma_f32_16x16x32_bf16 v[48:51], a[196:199], a[164:167], v[48:51]
    v_exp_f32_e64 v128, v16
    v_mfma_f32_16x16x32_bf16 v[48:51], a[200:203], a[168:171], v[48:51]
    v_exp_f32_e64 v129, v17
    v_mfma_f32_16x16x32_bf16 v[48:51], a[204:207], a[172:175], v[48:51]
    s_waitcnt vmcnt(10)
    buffer_store_dwordx4 v[196:199], v255, s[48:51], s45 offen offset:256 sc1
    v_mfma_f32_16x16x32_bf16 v[56:59], a[192:195], a[176:179], v[88:91]
    ds_read_b128 a[248:251], v241 offset:30720
    ds_read_b128 a[252:255], v241 offset:31744
    v_mfma_f32_16x16x32_bf16 v[56:59], a[196:199], a[180:183], v[56:59]
    v_exp_f32 v130, v18
    v_mfma_f32_16x16x32_bf16 v[56:59], a[200:203], a[184:187], v[56:59]
    v_exp_f32_e64 v131, v19
    v_mfma_f32_16x16x32_bf16 v[56:59], a[204:207], a[188:191], v[56:59]
    v_cvt_pk_bf16_f32 v104, v128, v129
    s_waitcnt lgkmcnt(8)
    v_mfma_f32_16x16x32_bf16 v[52:55], a[208:211], a[160:163], v[84:87]
    s_waitcnt vmcnt(14)
    s_barrier
    v_add_u32 v241, s35, v240
    ds_read_b128 a[192:195], v241 offset:0
    v_mfma_f32_16x16x32_bf16 v[52:55], a[212:215], a[164:167], v[52:55]
    s_add_u32 m0, s34, 16384
    s_add_u32 s34, s34, 32768
    v_mfma_f32_16x16x32_bf16 v[52:55], a[216:219], a[168:171], v[52:55]
    ds_read_b128 a[196:199], v241 offset:2048
    v_cvt_pk_bf16_f32 v105, v130, v131
    v_mfma_f32_16x16x32_bf16 v[52:55], a[220:223], a[172:175], v[52:55]
    s_cmp_ge_u32 s34, 163840
    s_cselect_b32 s34, s37, s34
    v_mfma_f32_16x16x32_bf16 v[60:63], a[208:211], a[176:179], v[92:95]
    ds_read_b128 a[200:203], v241 offset:4096
    ds_read_b128 a[204:207], v241 offset:6144
    v_mfma_f32_16x16x32_bf16 v[60:63], a[212:215], a[180:183], v[60:63]
    v_exp_f32 v132, v20
    v_mfma_f32_16x16x32_bf16 v[60:63], a[216:219], a[184:187], v[60:63]
    v_exp_f32_e64 v133, v21
    v_mfma_f32_16x16x32_bf16 v[60:63], a[220:223], a[188:191], v[60:63]
    v_cvt_pk_bf16_f32 v106, v132, v133
    s_waitcnt lgkmcnt(8)
    v_mfma_f32_16x16x32_bf16 a[0:3], a[224:227], v[112:115], a[0:3]
    ds_read_b128 a[208:211], v241 offset:1024
    v_or3_b32 v208, v104, v105, v106
    v_mfma_f32_16x16x32_bf16 a[32:35], a[224:227], v[116:119], a[32:35]
    v_exp_f32 v134, v22
    v_mfma_f32_16x16x32_bf16 a[64:67], a[224:227], v[120:123], a[64:67]
    buffer_load_dwordx4 v242, s[16:19], s42 offen offset:0 sc1 lds
    v_mfma_f32_16x16x32_bf16 a[96:99], a[224:227], v[124:127], a[96:99]
    v_exp_f32_e64 v135, v23
    v_mfma_f32_16x16x32_bf16 a[4:7], a[228:231], v[112:115], a[4:7]
    ds_read_b128 a[212:215], v241 offset:3072
    v_cvt_pk_bf16_f32 v107, v134, v135
    v_mfma_f32_16x16x32_bf16 a[36:39], a[228:231], v[116:119], a[36:39]
    v_exp_f32_e64 v136, v24
    v_mfma_f32_16x16x32_bf16 a[68:71], a[228:231], v[120:123], a[68:71]
    v_exp_f32_e64 v137, v25
    v_mfma_f32_16x16x32_bf16 a[100:103], a[228:231], v[124:127], a[100:103]
    v_exp_f32_e64 v138, v26
    v_mfma_f32_16x16x32_bf16 a[8:11], a[232:235], v[112:115], a[8:11]
    ds_read_b128 a[216:219], v241 offset:5120
    v_cvt_pk_bf16_f32 v108, v136, v137
    v_mfma_f32_16x16x32_bf16 a[40:43], a[232:235], v[116:119], a[40:43]
    buffer_load_dwordx4 v242, s[16:19], s42 offen offset:1024 sc1 lds
    v_or3_b32 v208, v208, v107, v108
    v_mfma_f32_16x16x32_bf16 a[72:75], a[232:235], v[120:123], a[72:75]
    v_exp_f32_e64 v139, v27
    v_mfma_f32_16x16x32_bf16 a[104:107], a[232:235], v[124:127], a[104:107]
    v_exp_f32_e64 v140, v28
    v_mfma_f32_16x16x32_bf16 a[12:15], a[236:239], v[112:115], a[12:15]
    ds_read_b128 a[220:223], v241 offset:7168
    v_cvt_pk_bf16_f32 v109, v138, v139
    v_mfma_f32_16x16x32_bf16 a[44:47], a[236:239], v[116:119], a[44:47]
    v_exp_f32_e64 v141, v29
    v_mfma_f32_16x16x32_bf16 a[76:79], a[236:239], v[120:123], a[76:79]
    v_exp_f32_e64 v142, v30
    v_mfma_f32_16x16x32_bf16 a[108:111], a[236:239], v[124:127], a[108:111]
    v_cvt_pk_bf16_f32 v110, v140, v141
    s_waitcnt lgkmcnt(8)
    v_mfma_f32_16x16x32_bf16 a[16:19], a[240:243], v[112:115], a[16:19]
    ds_read_b128 a[224:227], v241 offset:16384
    v_or3_b32 v208, v208, v109, v110
    v_mfma_f32_16x16x32_bf16 a[48:51], a[240:243], v[116:119], a[48:51]
    buffer_load_dwordx4 v242, s[16:19], s42 offen offset:2048 sc1 lds
    v_mfma_f32_16x16x32_bf16 a[80:83], a[240:243], v[120:123], a[80:83]
    v_exp_f32 v143, v31
    v_mfma_f32_16x16x32_bf16 a[112:115], a[240:243], v[124:127], a[112:115]
    v_cvt_pk_bf16_f32 v111, v142, v143
    v_or_b32_e64 v208, v208, v111
    v_mfma_f32_16x16x32_bf16 a[20:23], a[244:247], v[112:115], a[20:23]
    ds_read_b128 a[228:231], v241 offset:17408
    v_and_b32_e64 v208, s38, v208
    v_mfma_f32_16x16x32_bf16 a[52:55], a[244:247], v[116:119], a[52:55]
    v_cmp_ne_u32_e64 vcc, 0, v208
    buffer_load_dwordx4 v242, s[16:19], s42 offen offset:3072 sc1 lds
    v_mfma_f32_16x16x32_bf16 a[84:87], a[244:247], v[120:123], a[84:87]
    s_add_u32 s42, s42, 34048
    v_mfma_f32_16x16x32_bf16 a[116:119], a[244:247], v[124:127], a[116:119]
    v_mfma_f32_16x16x32_bf16 a[24:27], a[248:251], v[112:115], a[24:27]
    ds_read_b128 a[232:235], v241 offset:18432
    v_mfma_f32_16x16x32_bf16 a[56:59], a[248:251], v[116:119], a[56:59]
    v_mfma_f32_16x16x32_bf16 a[88:91], a[248:251], v[120:123], a[88:91]
    v_mfma_f32_16x16x32_bf16 a[120:123], a[248:251], v[124:127], a[120:123]
    v_mfma_f32_16x16x32_bf16 a[28:31], a[252:255], v[112:115], a[28:31]
    ds_read_b128 a[236:239], v241 offset:19456
    v_mfma_f32_16x16x32_bf16 a[60:63], a[252:255], v[116:119], a[60:63]
    v_mfma_f32_16x16x32_bf16 a[92:95], a[252:255], v[120:123], a[92:95]
    v_mfma_f32_16x16x32_bf16 a[124:127], a[252:255], v[124:127], a[124:127]
    v_mfma_f32_16x16x32_bf16 v[144:147], v[204:207], v[112:115], v[144:147]
    v_mfma_f32_16x16x32_bf16 v[148:151], v[204:207], v[116:119], v[148:151]
    v_mfma_f32_16x16x32_bf16 v[152:155], v[204:207], v[120:123], v[152:155]
    v_mfma_f32_16x16x32_bf16 v[156:159], v[204:207], v[124:127], v[156:159]
    s_cbranch_vccnz kf_rare18
kf_rr17:
    s_nop 6
    v_rcp_f32 v230, v144
    v_rcp_f32 v231, v148
    v_accvgpr_read_b32 v160, a0
    v_accvgpr_read_b32 v161, a1
    v_accvgpr_read_b32 v162, a2
    v_accvgpr_read_b32 v163, a3
    v_accvgpr_read_b32 v164, a4
    v_accvgpr_read_b32 v165, a5
    v_accvgpr_read_b32 v166, a6
    v_accvgpr_read_b32 v167, a7
    v_mul_f32 v160, v160, v230
    v_mul_f32 v161, v161, v230
    v_mul_f32 v162, v162, v230
    v_mul_f32 v163, v163, v230
    v_mul_f32 v164, v164, v230
    v_mul_f32 v165, v165, v230
    v_mul_f32 v166, v166, v230
    v_mul_f32 v167, v167, v230
    v_cvt_pk_bf16_f32 v176, v160, v161
    v_cvt_pk_bf16_f32 v177, v162, v163
    v_cvt_pk_bf16_f32 v178, v164, v165
    v_cvt_pk_bf16_f32 v179, v166, v167
    buffer_store_dwordx4 v[176:179], v240, s[20:23], s39 offen offset:0 sc1
    v_accvgpr_read_b32 v168, a8
    v_accvgpr_read_b32 v169, a9
    v_accvgpr_read_b32 v170, a10
    v_accvgpr_read_b32 v171, a11
    v_accvgpr_read_b32 v172, a12
    v_accvgpr_read_b32 v173, a13
    v_accvgpr_read_b32 v174, a14
    v_accvgpr_read_b32 v175, a15
    v_mul_f32 v168, v168, v230
    v_mul_f32 v169, v169, v230
    v_mul_f32 v170, v170, v230
    v_mul_f32 v171, v171, v230
    v_mul_f32 v172, v172, v230
    v_mul_f32 v173, v173, v230
    v_mul_f32 v174, v174, v230
    v_mul_f32 v175, v175, v230
    v_cvt_pk_bf16_f32 v180, v168, v169
    v_cvt_pk_bf16_f32 v181, v170, v171
    v_cvt_pk_bf16_f32 v182, v172, v173
    v_cvt_pk_bf16_f32 v183, v174, v175
    buffer_store_dwordx4 v[180:183], v240, s[20:23], s39 offen offset:1024 sc1
    v_accvgpr_read_b32 v160, a16
    v_accvgpr_read_b32 v161, a17
    v_accvgpr_read_b32 v162, a18
    v_accvgpr_read_b32 v163, a19
    v_accvgpr_read_b32 v164, a20
    v_accvgpr_read_b32 v165, a21
    v_accvgpr_read_b32 v166, a22
    v_accvgpr_read_b32 v167, a23
    v_mul_f32 v160, v160, v230
    v_mul_f32 v161, v161, v230
    v_mul_f32 v162, v162, v230
    v_mul_f32 v163, v163, v230
    v_mul_f32 v164, v164, v230
    v_mul_f32 v165, v165, v230
    v_mul_f32 v166, v166, v230
    v_mul_f32 v167, v167, v230
    v_cvt_pk_bf16_f32 v184, v160, v161
    v_cvt_pk_bf16_f32 v185, v162, v163
    v_cvt_pk_bf16_f32 v186, v164, v165
    v_cvt_pk_bf16_f32 v187, v166, v167
    buffer_store_dwordx4 v[184:187], v240, s[20:23], s39 offen offset:2048 sc1
    v_accvgpr_read_b32 v168, a24
    v_accvgpr_read_b32 v169, a25
    v_accvgpr_read_b32 v170, a26
    v_accvgpr_read_b32 v171, a27
    v_accvgpr_read_b32 v172, a28
    v_accvgpr_read_b32 v173, a29
    v_accvgpr_read_b32 v174, a30
    v_accvgpr_read_b32 v175, a31
    v_mul_f32 v168, v168, v230
    v_mul_f32 v169, v169, v230
    v_mul_f32 v170, v170, v230
    v_mul_f32 v171, v171, v230
    v_mul_f32 v172, v172, v230
    v_mul_f32 v173, v173, v230
    v_mul_f32 v174, v174, v230
    v_mul_f32 v175, v175, v230
    v_cvt_pk_bf16_f32 v188, v168, v169
    v_cvt_pk_bf16_f32 v189, v170, v171
    v_cvt_pk_bf16_f32 v190, v172, v173
    v_cvt_pk_bf16_f32 v191, v174, v175
    buffer_store_dwordx4 v[188:191], v240, s[20:23], s39 offen offset:3072 sc1
    v_accvgpr_read_b32 v160, a32
    v_accvgpr_read_b32 v161, a33
    v_accvgpr_read_b32 v162, a34
    v_accvgpr_read_b32 v163, a35
    v_accvgpr_read_b32 v164, a36
    v_accvgpr_read_b32 v165, a37
    v_accvgpr_read_b32 v166, a38
    v_accvgpr_read_b32 v167, a39
    v_mul_f32 v160, v160, v231
    v_mul_f32 v161, v161, v231
    v_mul_f32 v162, v162, v231
    v_mul_f32 v163, v163, v231
    v_mul_f32 v164, v164, v231
    v_mul_f32 v165, v165, v231
    v_mul_f32 v166, v166, v231
    v_mul_f32 v167, v167, v231
    v_cvt_pk_bf16_f32 v176, v160, v161
    v_cvt_pk_bf16_f32 v177, v162, v163
    v_cvt_pk_bf16_f32 v178, v164, v165
    v_cvt_pk_bf16_f32 v179, v166, v167
    buffer_store_dwordx4 v[176:179], v244, s[20:23], s39 offen offset:0 sc1
    v_accvgpr_read_b32 v168, a40
    v_accvgpr_read_b32 v169, a41
    v_accvgpr_read_b32 v170, a42
    v_accvgpr_read_b32 v171, a43
    v_accvgpr_read_b32 v172, a44
    v_accvgpr_read_b32 v173, a45
    v_accvgpr_read_b32 v174, a46
    v_accvgpr_read_b32 v175, a47
    v_mul_f32 v168, v168, v231
    v_mul_f32 v169, v169, v231
    v_mul_f32 v170, v170, v231
    v_mul_f32 v171, v171, v231
    v_mul_f32 v172, v172, v231
    v_mul_f32 v173, v173, v231
    v_mul_f32 v174, v174, v231
    v_mul_f32 v175, v175, v231
    v_cvt_pk_bf16_f32 v180, v168, v169
    v_cvt_pk_bf16_f32 v181, v170, v171
    v_cvt_pk_bf16_f32 v182, v172, v173
    v_cvt_pk_bf16_f32 v183, v174, v175
    buffer_store_dwordx4 v[180:183], v244, s[20:23], s39 offen offset:1024 sc1
    v_accvgpr_read_b32 v160, a48
    v_accvgpr_read_b32 v161, a49
    v_accvgpr_read_b32 v162, a50
    v_accvgpr_read_b32 v163, a51
    v_accvgpr_read_b32 v164, a52
    v_accvgpr_read_b32 v165, a53
    v_accvgpr_read_b32 v166, a54
    v_accvgpr_read_b32 v167, a55
    v_mul_f32 v160, v160, v231
    v_mul_f32 v161, v161, v231
    v_mul_f32 v162, v162, v231
    v_mul_f32 v163, v163, v231
    v_mul_f32 v164, v164, v231
    v_mul_f32 v165, v165, v231
    v_mul_f32 v166, v166, v231
    v_mul_f32 v167, v167, v231
    v_cvt_pk_bf16_f32 v184, v160, v161
    v_cvt_pk_bf16_f32 v185, v162, v163
    v_cvt_pk_bf16_f32 v186, v164, v165
    v_cvt_pk_bf16_f32 v187, v166, v167
    buffer_store_dwordx4 v[184:187], v244, s[20:23], s39 offen offset:2048 sc1
    v_accvgpr_read_b32 v168, a56
    v_accvgpr_read_b32 v169, a57
    v_accvgpr_read_b32 v170, a58
    v_accvgpr_read_b32 v171, a59
    v_accvgpr_read_b32 v172, a60
    v_accvgpr_read_b32 v173, a61
    v_accvgpr_read_b32 v174, a62
    v_accvgpr_read_b32 v175, a63
    v_mul_f32 v168, v168, v231
    v_mul_f32 v169, v169, v231
    v_mul_f32 v170, v170, v231
    v_mul_f32 v171, v171, v231
    v_mul_f32 v172, v172, v231
    v_mul_f32 v173, v173, v231
    v_mul_f32 v174, v174, v231
    v_mul_f32 v175, v175, v231
    v_cvt_pk_bf16_f32 v188, v168, v169
    v_cvt_pk_bf16_f32 v189, v170, v171
    v_cvt_pk_bf16_f32 v190, v172, v173
    v_cvt_pk_bf16_f32 v191, v174, v175
    buffer_store_dwordx4 v[188:191], v244, s[20:23], s39 offen offset:3072 sc1
ka_noe0:
    s_lshl1_add_u32 s26, s5, s31
    s_lshl_b32 s26, s26, 1
    s_sub_u32 s26, 30, s26
    s_branch ka_p2_e
.p2align 5
ka_p2:
    s_sub_u32 s36, s36, 1
    s_cbranch_scc1 kf_fix23
kf_fixr24:
    s_waitcnt lgkmcnt(8)
    v_mfma_f32_16x16x32_bf16 v[16:19], a[192:195], a[160:163], v[80:83]
    ds_read_b128 a[240:243], v241 offset:20480
    ds_read_b128 a[244:247], v241 offset:21504
    v_mfma_f32_16x16x32_bf16 v[16:19], a[196:199], a[164:167], v[16:19]
    v_exp_f32 v128, v48
    v_mfma_f32_16x16x32_bf16 v[16:19], a[200:203], a[168:171], v[16:19]
    s_mov_b32 m0, s34
    v_exp_f32 v129, v49
    v_mfma_f32_16x16x32_bf16 v[16:19], a[204:207], a[172:175], v[16:19]
    v_exp_f32_e64 v130, v50
    v_mfma_f32_16x16x32_bf16 v[24:27], a[192:195], a[176:179], v[88:91]
    ds_read_b128 a[248:251], v241 offset:22528
    ds_read_b128 a[252:255], v241 offset:23552
    v_mfma_f32_16x16x32_bf16 v[24:27], a[196:199], a[180:183], v[24:27]
    s_add_u32 s41, s42, 17664
    v_cvt_pk_bf16_f32 v120, v128, v129
    v_mfma_f32_16x16x32_bf16 v[24:27], a[200:203], a[184:187], v[24:27]
    buffer_load_dwordx4 v242, s[16:19], s41 offen offset:0 sc1 lds
    v_exp_f32_e64 v131, v51
    v_mfma_f32_16x16x32_bf16 v[24:27], a[204:207], a[188:191], v[24:27]
    v_cvt_pk_bf16_f32 v121, v130, v131
    s_waitcnt lgkmcnt(8)
    v_mfma_f32_16x16x32_bf16 v[20:23], a[208:211], a[160:163], v[84:87]
    ds_read_b128 a[192:195], v241 offset:8192
    ds_read_b128 a[196:199], v241 offset:10240
    v_mfma_f32_16x16x32_bf16 v[20:23], a[212:215], a[164:167], v[20:23]
    v_exp_f32 v132, v52
    v_mfma_f32_16x16x32_bf16 v[20:23], a[216:219], a[168:171], v[20:23]
    v_exp_f32_e64 v133, v53
    buffer_load_dwordx4 v242, s[16:19], s41 offen offset:1024 sc1 lds
    v_mfma_f32_16x16x32_bf16 v[20:23], a[220:223], a[172:175], v[20:23]
    v_exp_f32_e64 v134, v54
    v_mfma_f32_16x16x32_bf16 v[28:31], a[208:211], a[176:179], v[92:95]
    ds_read_b128 a[200:203], v241 offset:12288
    ds_read_b128 a[204:207], v241 offset:14336
    v_mfma_f32_16x16x32_bf16 v[28:31], a[212:215], a[180:183], v[28:31]
    v_exp_f32_e64 v135, v55
    v_mfma_f32_16x16x32_bf16 v[28:31], a[216:219], a[184:187], v[28:31]
    v_exp_f32_e64 v136, v56
    v_cvt_pk_bf16_f32 v122, v132, v133
    v_mfma_f32_16x16x32_bf16 v[28:31], a[220:223], a[188:191], v[28:31]
    v_or3_b32 v208, v120, v121, v122
    s_waitcnt lgkmcnt(8)
    v_mfma_f32_16x16x32_bf16 a[64:67], a[224:227], v[104:107], a[64:67]
    ds_read_b128 a[208:211], v241 offset:9216
    ds_read_b128 a[212:215], v241 offset:11264
    v_mfma_f32_16x16x32_bf16 a[96:99], a[224:227], v[108:111], a[96:99]
    v_exp_f32 v137, v57
    v_mfma_f32_16x16x32_bf16 a[68:71], a[228:231], v[104:107], a[68:71]
    v_exp_f32_e64 v138, v58
    v_mfma_f32_16x16x32_bf16 a[100:103], a[228:231], v[108:111], a[100:103]
    buffer_load_dwordx4 v242, s[16:19], s41 offen offset:2048 sc1 lds
    v_exp_f32_e64 v139, v59
    v_mfma_f32_16x16x32_bf16 a[72:75], a[232:235], v[104:107], a[72:75]
    ds_read_b128 a[216:219], v241 offset:13312
    ds_read_b128 a[220:223], v241 offset:15360
    v_mfma_f32_16x16x32_bf16 a[104:107], a[232:235], v[108:111], a[104:107]
    v_exp_f32_e64 v140, v60
    v_mfma_f32_16x16x32_bf16 a[76:79], a[236:239], v[104:107], a[76:79]
    buffer_load_dwordx4 v242, s[16:19], s41 offen offset:3072 sc1 lds
    v_cvt_pk_bf16_f32 v123, v134, v135
    v_mfma_f32_16x16x32_bf16 a[108:111], a[236:239], v[108:111], a[108:111]
    v_exp_f32 v141, v61
    s_waitcnt lgkmcnt(8)
    v_mfma_f32_16x16x32_bf16 a[80:83], a[240:243], v[104:107], a[80:83]
    ds_read_b128 a[224:227], v241 offset:24576
    ds_read_b128 a[228:231], v241 offset:25600
    v_mfma_f32_16x16x32_bf16 a[112:115], a[240:243], v[108:111], a[112:115]
    v_cvt_pk_bf16_f32 v124, v136, v137
    v_or3_b32 v208, v208, v123, v124
    v_mfma_f32_16x16x32_bf16 a[84:87], a[244:247], v[104:107], a[84:87]
    v_exp_f32_e64 v142, v62
    v_mfma_f32_16x16x32_bf16 a[116:119], a[244:247], v[108:111], a[116:119]
    s_add_u32 s35, s35, 32768
    s_cmp_ge_u32 s35, 163840
    s_cselect_b32 s35, 0, s35
    v_mfma_f32_16x16x32_bf16 a[88:91], a[248:251], v[104:107], a[88:91]
    ds_read_b128 a[232:235], v241 offset:26624
    ds_read_b128 a[236:239], v241 offset:27648
    v_mfma_f32_16x16x32_bf16 a[120:123], a[248:251], v[108:111], a[120:123]
    v_exp_f32 v143, v63
    v_mfma_f32_16x16x32_bf16 a[92:95], a[252:255], v[104:107], a[92:95]
    v_cvt_pk_bf16_f32 v125, v138, v139
    v_cvt_pk_bf16_f32 v126, v140, v141
    v_mfma_f32_16x16x32_bf16 a[124:127], a[252:255], v[108:111], a[124:127]
    v_or3_b32 v208, v208, v125, v126
    v_cvt_pk_bf16_f32 v127, v142, v143
    v_or_b32_e64 v208, v208, v127
    v_mfma_f32_16x16x32_bf16 v[152:155], v[204:207], v[104:107], v[152:155]
    v_and_b32 v208, s38, v208
    v_cmp_ne_u32 vcc, 0, v208
    v_mfma_f32_16x16x32_bf16 v[156:159], v[204:207], v[108:111], v[156:159]
    s_cbranch_vccnz kf_rare22
kf_rr21:
    s_sub_u32 s36, s36, 1
    s_cbranch_scc1 kf_fix27
kf_fixr28:
    s_waitcnt lgkmcnt(8)
    v_mfma_f32_16x16x32_bf16 v[48:51], a[192:195], a[160:163], v[80:83]
    ds_read_b128 a[240:243], v241 offset:28672
    ds_read_b128 a[244:247], v241 offset:29696
    v_mfma_f32_16x16x32_bf16 v[48:51], a[196:199], a[164:167], v[48:51]
    s_add_u32 m0, s34, 16384
    v_exp_f32_e64 v128, v16
    v_mfma_f32_16x16x32_bf16 v[48:51], a[200:203], a[168:171], v[48:51]
    v_exp_f32_e64 v129, v17
    v_mfma_f32_16x16x32_bf16 v[48:51], a[204:207], a[172:175], v[48:51]
    v_exp_f32_e64 v130, v18
    v_mfma_f32_16x16x32_bf16 v[56:59], a[192:195], a[176:179], v[88:91]
    ds_read_b128 a[248:251], v241 offset:30720
    ds_read_b128 a[252:255], v241 offset:31744
    s_add_u32 s34, s34, 32768
    v_mfma_f32_16x16x32_bf16 v[56:59], a[196:199], a[180:183], v[56:59]
    s_cmp_ge_u32 s34, 163840
    s_cselect_b32 s34, s37, s34
    v_mfma_f32_16x16x32_bf16 v[56:59], a[200:203], a[184:187], v[56:59]
    v_exp_f32 v131, v19
    v_mfma_f32_16x16x32_bf16 v[56:59], a[204:207], a[188:191], v[56:59]
    v_exp_f32 v132, v20
    s_waitcnt lgkmcnt(8)
    v_mfma_f32_16x16x32_bf16 v[52:55], a[208:211], a[160:163], v[84:87]
    s_waitcnt vmcnt(12)
    s_barrier
    v_add_u32_e64 v241, s35, v240
    ds_read_b128 a[192:195], v241 offset:0
    v_mfma_f32_16x16x32_bf16 v[52:55], a[212:215], a[164:167], v[52:55]
    v_exp_f32_e64 v133, v21
    v_mfma_f32_16x16x32_bf16 v[52:55], a[216:219], a[168:171], v[52:55]
    ds_read_b128 a[196:199], v241 offset:2048
    buffer_load_dwordx4 v242, s[16:19], s42 offen offset:0 sc1 lds
    v_mfma_f32_16x16x32_bf16 v[52:55], a[220:223], a[172:175], v[52:55]
    v_exp_f32_e64 v134, v22
    v_cvt_pk_bf16_f32 v104, v128, v129
    v_mfma_f32_16x16x32_bf16 v[60:63], a[208:211], a[176:179], v[92:95]
    ds_read_b128 a[200:203], v241 offset:4096
    ds_read_b128 a[204:207], v241 offset:6144
    v_mfma_f32_16x16x32_bf16 v[60:63], a[212:215], a[180:183], v[60:63]
    v_exp_f32_e64 v135, v23
    v_mfma_f32_16x16x32_bf16 v[60:63], a[216:219], a[184:187], v[60:63]
    buffer_load_dwordx4 v242, s[16:19], s42 offen offset:1024 sc1 lds
    v_exp_f32_e64 v136, v24
    v_mfma_f32_16x16x32_bf16 v[60:63], a[220:223], a[188:191], v[60:63]
    v_cvt_pk_bf16_f32 v105, v130, v131
    s_waitcnt lgkmcnt(8)
    v_mfma_f32_16x16x32_bf16 a[64:67], a[224:227], v[120:123], a[64:67]
    ds_read_b128 a[208:211], v241 offset:1024
    ds_read_b128 a[212:215], v241 offset:3072
    v_mfma_f32_16x16x32_bf16 a[96:99], a[224:227], v[124:127], a[96:99]
    v_exp_f32 v137, v25
    v_mfma_f32_16x16x32_bf16 a[68:71], a[228:231], v[120:123], a[68:71]
    v_cvt_pk_bf16_f32 v106, v132, v133
    v_exp_f32_e64 v138, v26
    v_mfma_f32_16x16x32_bf16 a[100:103], a[228:231], v[124:127], a[100:103]
    v_exp_f32_e64 v139, v27
    v_mfma_f32_16x16x32_bf16 a[72:75], a[232:235], v[120:123], a[72:75]
    ds_read_b128 a[216:219], v241 offset:5120
    ds_read_b128 a[220:223], v241 offset:7168
    v_mfma_f32_16x16x32_bf16 a[104:107], a[232:235], v[124:127], a[104:107]
    buffer_load_dwordx4 v242, s[16:19], s42 offen offset:2048 sc1 lds
    v_or3_b32 v208, v104, v105, v106
    v_cvt_pk_bf16_f32 v107, v134, v135
    v_mfma_f32_16x16x32_bf16 a[76:79], a[236:239], v[120:123], a[76:79]
    v_exp_f32_e64 v140, v28
    v_mfma_f32_16x16x32_bf16 a[108:111], a[236:239], v[124:127], a[108:111]
    v_cvt_pk_bf16_f32 v108, v136, v137
    s_waitcnt lgkmcnt(8)
    v_mfma_f32_16x16x32_bf16 a[80:83], a[240:243], v[120:123], a[80:83]
    ds_read_b128 a[224:227], v241 offset:16384
    ds_read_b128 a[228:231], v241 offset:17408
    v_or3_b32 v208, v208, v107, v108
    v_mfma_f32_16x16x32_bf16 a[112:115], a[240:243], v[124:127], a[112:115]
    v_exp_f32 v141, v29
    v_mfma_f32_16x16x32_bf16 a[84:87], a[244:247], v[120:123], a[84:87]
    v_exp_f32_e64 v142, v30
    v_mfma_f32_16x16x32_bf16 a[116:119], a[244:247], v[124:127], a[116:119]
    v_exp_f32_e64 v143, v31
    v_mfma_f32_16x16x32_bf16 a[88:91], a[248:251], v[120:123], a[88:91]
    ds_read_b128 a[232:235], v241 offset:18432
    ds_read_b128 a[236:239], v241 offset:19456
    buffer_load_dwordx4 v242, s[16:19], s42 offen offset:3072 sc1 lds
    v_mfma_f32_16x16x32_bf16 a[120:123], a[248:251], v[124:127], a[120:123]
    s_add_u32 s42, s42, 34048
    v_cvt_pk_bf16_f32 v109, v138, v139
    v_mfma_f32_16x16x32_bf16 a[92:95], a[252:255], v[120:123], a[92:95]
    v_cvt_pk_bf16_f32 v110, v140, v141
    v_or3_b32 v208, v208, v109, v110
    v_mfma_f32_16x16x32_bf16 a[124:127], a[252:255], v[124:127], a[124:127]
    v_cvt_pk_bf16_f32 v111, v142, v143
    v_or_b32 v208, v208, v111
    v_and_b32 v208, s38, v208
    v_mfma_f32_16x16x32_bf16 v[152:155], v[204:207], v[120:123], v[152:155]
    v_cmp_ne_u32_e64 vcc, 0, v208
    v_mfma_f32_16x16x32_bf16 v[156:159], v[204:207], v[124:127], v[156:159]
    s_cbranch_vccnz kf_rare26
kf_rr25:
ka_p2_e:
    s_sub_u32 s26, s26, 1
    s_cbranch_scc0 ka_p2
    s_branch ka_p2_x
kf_fix23:
    s_mov_b32 s24, 0
    s_branch kf_fix23c
kf_fix27:
    s_mov_b32 s24, 1
kf_fix23c:
    s_cmp_eq_u32 s33, 0
    s_cbranch_scc0 kf_fix23f
    s_mov_b32 s36, 0
    s_mov_b32 s33, 1
    v_add_f32 v80, v226, v200
    v_add_f32 v81, v226, v201
    v_add_f32 v82, v226, v202
    v_add_f32 v83, v226, v203
    v_add_f32 v84, v226, v209
    v_add_f32 v85, v226, v210
    v_add_f32 v86, v226, v211
    v_add_f32 v87, v226, v212
    v_add_f32 v88, v227, v213
    v_add_f32 v89, v227, v214
    v_add_f32 v90, v227, v215
    v_add_f32 v91, v227, v216
    v_add_f32 v92, v227, v217
    v_add_f32 v93, v227, v218
    v_add_f32 v94, v227, v219
    v_add_f32 v95, v227, v220
    s_cmp_eq_u32 s24, 0
    s_cbranch_scc1 kf_fixr24
    s_branch kf_fixr28
kf_fix23f:
    s_mov_b32 s36, 0x1000
    v_mov_b32 v80, 0xf1800000
    v_mov_b32 v81, v80
    v_mov_b32 v82, v80
    v_mov_b32 v83, v80
    v_mov_b32 v84, v80
    v_mov_b32 v85, v80
    v_mov_b32 v86, v80
    v_mov_b32 v87, v80
    v_mov_b32 v88, v80
    v_mov_b32 v89, v80
    v_mov_b32 v90, v80
    v_mov_b32 v91, v80
    v_mov_b32 v92, v80
    v_mov_b32 v93, v80
    v_mov_b32 v94, v80
    v_mov_b32_e64 v95, v80
    s_cmp_eq_u32 s24, 0
    s_cbranch_scc1 kf_fixr24
    s_branch kf_fixr28
ka_p2_x:
    s_waitcnt lgkmcnt(0)
    ds_read_b128 a[224:227], v241 offset:16384
    ds_read_b128 a[228:231], v241 offset:17408
    ds_read_b128 a[232:235], v241 offset:18432
    ds_read_b128 a[236:239], v241 offset:19456
    ds_read_b128 a[240:243], v241 offset:20480
    ds_read_b128 a[244:247], v241 offset:21504
    ds_read_b128 a[248:251], v241 offset:22528
    ds_read_b128 a[252:255], v241 offset:23552
    ds_read_b128 a[192:195], v241 offset:24576
    ds_read_b128 a[196:199], v241 offset:25600
    ds_read_b128 a[200:203], v241 offset:26624
    ds_read_b128 a[204:207], v241 offset:27648
    ds_read_b128 a[208:211], v241 offset:28672
    ds_read_b128 a[212:215], v241 offset:29696
    ds_read_b128 a[216:219], v241 offset:30720
    s_waitcnt lgkmcnt(7)
    ds_read_b128 a[220:223], v241 offset:31744
    v_mfma_f32_16x16x32_bf16 a[64:67], a[224:227], v[104:107], a[64:67]
    v_exp_f32 v128, v48
    v_exp_f32_e64 v129, v49
    v_mfma_f32_16x16x32_bf16 a[96:99], a[224:227], v[108:111], a[96:99]
    v_exp_f32_e64 v130, v50
    v_cvt_pk_bf16_f32 v120, v128, v129
    v_mfma_f32_16x16x32_bf16 a[68:71], a[228:231], v[104:107], a[68:71]
    v_exp_f32_e64 v131, v51
    v_mfma_f32_16x16x32_bf16 a[100:103], a[228:231], v[108:111], a[100:103]
    v_exp_f32_e64 v132, v52
    v_cvt_pk_bf16_f32 v121, v130, v131
    v_mfma_f32_16x16x32_bf16 a[72:75], a[232:235], v[104:107], a[72:75]
    v_exp_f32_e64 v133, v53
    v_mfma_f32_16x16x32_bf16 a[104:107], a[232:235], v[108:111], a[104:107]
    v_exp_f32_e64 v134, v54
    v_cvt_pk_bf16_f32 v122, v132, v133
    v_mfma_f32_16x16x32_bf16 a[76:79], a[236:239], v[104:107], a[76:79]
    v_exp_f32_e64 v135, v55
    v_or3_b32 v208, v120, v121, v122
    v_mfma_f32_16x16x32_bf16 a[108:111], a[236:239], v[108:111], a[108:111]
    v_exp_f32_e64 v136, v56
    v_cvt_pk_bf16_f32 v123, v134, v135
    v_mfma_f32_16x16x32_bf16 a[80:83], a[240:243], v[104:107], a[80:83]
    v_exp_f32_e64 v137, v57
    v_mfma_f32_16x16x32_bf16 a[112:115], a[240:243], v[108:111], a[112:115]
    v_exp_f32_e64 v138, v58
    v_cvt_pk_bf16_f32 v124, v136, v137
    v_mfma_f32_16x16x32_bf16 a[84:87], a[244:247], v[104:107], a[84:87]
    v_exp_f32_e64 v139, v59
    v_or3_b32 v208, v208, v123, v124
    v_mfma_f32_16x16x32_bf16 a[116:119], a[244:247], v[108:111], a[116:119]
    v_exp_f32_e64 v140, v60
    v_cvt_pk_bf16_f32 v125, v138, v139
    v_mfma_f32_16x16x32_bf16 a[88:91], a[248:251], v[104:107], a[88:91]
    v_exp_f32_e64 v141, v61
    v_mfma_f32_16x16x32_bf16 a[120:123], a[248:251], v[108:111], a[120:123]
    v_exp_f32_e64 v142, v62
    v_cvt_pk_bf16_f32 v126, v140, v141
    v_mfma_f32_16x16x32_bf16 a[92:95], a[252:255], v[104:107], a[92:95]
    v_exp_f32_e64 v143, v63
    v_or3_b32 v208, v208, v125, v126
    v_mfma_f32_16x16x32_bf16 a[124:127], a[252:255], v[108:111], a[124:127]
    v_cvt_pk_bf16_f32 v127, v142, v143
    v_or_b32 v208, v208, v127
    v_and_b32 v208, s38, v208
    v_mfma_f32_16x16x32_bf16 v[152:155], v[204:207], v[104:107], v[152:155]
    v_cmp_ne_u32_e64 vcc, 0, v208
    v_mfma_f32_16x16x32_bf16 v[156:159], v[204:207], v[108:111], v[156:159]
    s_cbranch_vccnz kf_rare30
kf_rr29:
    s_waitcnt lgkmcnt(0)
    s_nop 0
    v_mfma_f32_16x16x32_bf16 a[64:67], a[192:195], v[120:123], a[64:67]
    v_mfma_f32_16x16x32_bf16 a[96:99], a[192:195], v[124:127], a[96:99]
    v_mfma_f32_16x16x32_bf16 a[68:71], a[196:199], v[120:123], a[68:71]
    v_mfma_f32_16x16x32_bf16 a[100:103], a[196:199], v[124:127], a[100:103]
    v_mfma_f32_16x16x32_bf16 a[72:75], a[200:203], v[120:123], a[72:75]
    v_mfma_f32_16x16x32_bf16 a[104:107], a[200:203], v[124:127], a[104:107]
    v_mfma_f32_16x16x32_bf16 a[76:79], a[204:207], v[120:123], a[76:79]
    v_mfma_f32_16x16x32_bf16 a[108:111], a[204:207], v[124:127], a[108:111]
    v_mfma_f32_16x16x32_bf16 a[80:83], a[208:211], v[120:123], a[80:83]
    v_mfma_f32_16x16x32_bf16 a[112:115], a[208:211], v[124:127], a[112:115]
    v_mfma_f32_16x16x32_bf16 a[84:87], a[212:215], v[120:123], a[84:87]
    v_mfma_f32_16x16x32_bf16 a[116:119], a[212:215], v[124:127], a[116:119]
    v_mfma_f32_16x16x32_bf16 a[88:91], a[216:219], v[120:123], a[88:91]
    v_mfma_f32_16x16x32_bf16 a[120:123], a[216:219], v[124:127], a[120:123]
    v_mfma_f32_16x16x32_bf16 a[92:95], a[220:223], v[120:123], a[92:95]
    v_mfma_f32_16x16x32_bf16 a[124:127], a[220:223], v[124:127], a[124:127]
    v_mfma_f32_16x16x32_bf16 v[152:155], v[204:207], v[120:123], v[152:155]
    v_mfma_f32_16x16x32_bf16 v[156:159], v[204:207], v[124:127], v[156:159]
    s_cmp_eq_u32 s31, 0
    s_cbranch_scc1 ka_nox
    s_waitcnt vmcnt(8)
    s_barrier
ka_nox:
    s_nop 6
    v_rcp_f32 v230, v152
    v_rcp_f32 v231, v156
    v_accvgpr_read_b32 v160, a64
    v_accvgpr_read_b32 v161, a65
    v_accvgpr_read_b32 v162, a66
    v_accvgpr_read_b32 v163, a67
    v_accvgpr_read_b32 v164, a68
    v_accvgpr_read_b32 v165, a69
    v_accvgpr_read_b32 v166, a70
    v_accvgpr_read_b32 v167, a71
    v_mul_f32 v160, v160, v230
    v_mul_f32 v161, v161, v230
    v_mul_f32 v162, v162, v230
    v_mul_f32 v163, v163, v230
    v_mul_f32 v164, v164, v230
    v_mul_f32 v165, v165, v230
    v_mul_f32 v166, v166, v230
    v_mul_f32 v167, v167, v230
    v_cvt_pk_bf16_f32 v176, v160, v161
    v_cvt_pk_bf16_f32 v177, v162, v163
    v_cvt_pk_bf16_f32 v178, v164, v165
    v_cvt_pk_bf16_f32 v179, v166, v167
    buffer_store_dwordx4 v[176:179], v240, s[20:23], s40 offen offset:0 sc1
    v_accvgpr_read_b32 v168, a72
    v_accvgpr_read_b32 v169, a73
    v_accvgpr_read_b32 v170, a74
    v_accvgpr_read_b32 v171, a75
    v_accvgpr_read_b32 v172, a76
    v_accvgpr_read_b32 v173, a77
    v_accvgpr_read_b32 v174, a78
    v_accvgpr_read_b32 v175, a79
    v_mul_f32 v168, v168, v230
    v_mul_f32 v169, v169, v230
    v_mul_f32 v170, v170, v230
    v_mul_f32 v171, v171, v230
    v_mul_f32 v172, v172, v230
    v_mul_f32 v173, v173, v230
    v_mul_f32 v174, v174, v230
    v_mul_f32 v175, v175, v230
    v_cvt_pk_bf16_f32 v180, v168, v169
    v_cvt_pk_bf16_f32 v181, v170, v171
    v_cvt_pk_bf16_f32 v182, v172, v173
    v_cvt_pk_bf16_f32 v183, v174, v175
    buffer_store_dwordx4 v[180:183], v240, s[20:23], s40 offen offset:1024 sc1
    v_accvgpr_read_b32 v160, a80
    v_accvgpr_read_b32 v161, a81
    v_accvgpr_read_b32 v162, a82
    v_accvgpr_read_b32 v163, a83
    v_accvgpr_read_b32 v164, a84
    v_accvgpr_read_b32 v165, a85
    v_accvgpr_read_b32 v166, a86
    v_accvgpr_read_b32 v167, a87
    v_mul_f32 v160, v160, v230
    v_mul_f32 v161, v161, v230
    v_mul_f32 v162, v162, v230
    v_mul_f32 v163, v163, v230
    v_mul_f32 v164, v164, v230
    v_mul_f32 v165, v165, v230
    v_mul_f32 v166, v166, v230
    v_mul_f32 v167, v167, v230
    v_cvt_pk_bf16_f32 v184, v160, v161
    v_cvt_pk_bf16_f32 v185, v162, v163
    v_cvt_pk_bf16_f32 v186, v164, v165
    v_cvt_pk_bf16_f32 v187, v166, v167
    buffer_store_dwordx4 v[184:187], v240, s[20:23], s40 offen offset:2048 sc1
    v_accvgpr_read_b32 v168, a88
    v_accvgpr_read_b32 v169, a89
    v_accvgpr_read_b32 v170, a90
    v_accvgpr_read_b32 v171, a91
    v_accvgpr_read_b32 v172, a92
    v_accvgpr_read_b32 v173, a93
    v_accvgpr_read_b32 v174, a94
    v_accvgpr_read_b32 v175, a95
    v_mul_f32 v168, v168, v230
    v_mul_f32 v169, v169, v230
    v_mul_f32 v170, v170, v230
    v_mul_f32 v171, v171, v230
    v_mul_f32 v172, v172, v230
    v_mul_f32 v173, v173, v230
    v_mul_f32 v174, v174, v230
    v_mul_f32 v175, v175, v230
    v_cvt_pk_bf16_f32 v188, v168, v169
    v_cvt_pk_bf16_f32 v189, v170, v171
    v_cvt_pk_bf16_f32 v190, v172, v173
    v_cvt_pk_bf16_f32 v191, v174, v175
    buffer_store_dwordx4 v[188:191], v240, s[20:23], s40 offen offset:3072 sc1
    v_accvgpr_read_b32 v160, a96
    v_accvgpr_read_b32 v161, a97
    v_accvgpr_read_b32 v162, a98
    v_accvgpr_read_b32 v163, a99
    v_accvgpr_read_b32 v164, a100
    v_accvgpr_read_b32 v165, a101
    v_accvgpr_read_b32 v166, a102
    v_accvgpr_read_b32 v167, a103
    v_mul_f32 v160, v160, v231
    v_mul_f32 v161, v161, v231
    v_mul_f32 v162, v162, v231
    v_mul_f32 v163, v163, v231
    v_mul_f32 v164, v164, v231
    v_mul_f32 v165, v165, v231
    v_mul_f32 v166, v166, v231
    v_mul_f32 v167, v167, v231
    v_cvt_pk_bf16_f32 v176, v160, v161
    v_cvt_pk_bf16_f32 v177, v162, v163
    v_cvt_pk_bf16_f32 v178, v164, v165
    v_cvt_pk_bf16_f32 v179, v166, v167
    buffer_store_dwordx4 v[176:179], v244, s[20:23], s40 offen offset:0 sc1
    v_accvgpr_read_b32 v168, a104
    v_accvgpr_read_b32 v169, a105
    v_accvgpr_read_b32 v170, a106
    v_accvgpr_read_b32 v171, a107
    v_accvgpr_read_b32 v172, a108
    v_accvgpr_read_b32 v173, a109
    v_accvgpr_read_b32 v174, a110
    v_accvgpr_read_b32 v175, a111
    v_mul_f32 v168, v168, v231
    v_mul_f32 v169, v169, v231
    v_mul_f32 v170, v170, v231
    v_mul_f32 v171, v171, v231
    v_mul_f32 v172, v172, v231
    v_mul_f32 v173, v173, v231
    v_mul_f32 v174, v174, v231
    v_mul_f32 v175, v175, v231
    v_cvt_pk_bf16_f32 v180, v168, v169
    v_cvt_pk_bf16_f32 v181, v170, v171
    v_cvt_pk_bf16_f32 v182, v172, v173
    v_cvt_pk_bf16_f32 v183, v174, v175
    buffer_store_dwordx4 v[180:183], v244, s[20:23], s40 offen offset:1024 sc1
    v_accvgpr_read_b32 v160, a112
    v_accvgpr_read_b32 v161, a113
    v_accvgpr_read_b32 v162, a114
    v_accvgpr_read_b32 v163, a115
    v_accvgpr_read_b32 v164, a116
    v_accvgpr_read_b32 v165, a117
    v_accvgpr_read_b32 v166, a118
    v_accvgpr_read_b32 v167, a119
    v_mul_f32 v160, v160, v231
    v_mul_f32 v161, v161, v231
    v_mul_f32 v162, v162, v231
    v_mul_f32 v163, v163, v231
    v_mul_f32 v164, v164, v231
    v_mul_f32 v165, v165, v231
    v_mul_f32 v166, v166, v231
    v_mul_f32 v167, v167, v231
    v_cvt_pk_bf16_f32 v184, v160, v161
    v_cvt_pk_bf16_f32 v185, v162, v163
    v_cvt_pk_bf16_f32 v186, v164, v165
    v_cvt_pk_bf16_f32 v187, v166, v167
    buffer_store_dwordx4 v[184:187], v244, s[20:23], s40 offen offset:2048 sc1
    v_accvgpr_read_b32 v168, a120
    v_accvgpr_read_b32 v169, a121
    v_accvgpr_read_b32 v170, a122
    v_accvgpr_read_b32 v171, a123
    v_accvgpr_read_b32 v172, a124
    v_accvgpr_read_b32 v173, a125
    v_accvgpr_read_b32 v174, a126
    v_accvgpr_read_b32 v175, a127
    v_mul_f32 v168, v168, v231
    v_mul_f32 v169, v169, v231
    v_mul_f32 v170, v170, v231
    v_mul_f32 v171, v171, v231
    v_mul_f32 v172, v172, v231
    v_mul_f32 v173, v173, v231
    v_mul_f32 v174, v174, v231
    v_mul_f32 v175, v175, v231
    v_cvt_pk_bf16_f32 v188, v168, v169
    v_cvt_pk_bf16_f32 v189, v170, v171
    v_cvt_pk_bf16_f32 v190, v172, v173
    v_cvt_pk_bf16_f32 v191, v174, v175
    buffer_store_dwordx4 v[188:191], v244, s[20:23], s40 offen offset:3072 sc1
    s_sub_u32 s46, s20, 0x2400000
    s_subb_u32 s47, s21, 0
    s_mov_b64 s[42:43], s[56:57]
    s_mov_b64 s[40:41], s[80:81]
    s_mov_b64 s[44:45], s[82:83]
    s_mov_b64 s[60:61], s[84:85]
    s_mov_b64 s[62:63], s[86:87]
    v_mbcnt_lo_u32_b32 v237, -1, 0
    v_mbcnt_hi_u32_b32 v237, -1, v237
    s_lshl_b32 s32, s3, 6
    v_add_u32 v230, s32, v237
    s_lshr_b32 s53, s2, 3
    s_lshr_b32 s6, s2, 1
    s_and_b32 s6, s6, 3
    s_and_b32 s4, s2, 1
    s_lshl_b32 s4, s4, 2
    s_and_b32 s33, s53, 3
    s_add_u32 s4, s4, s33
    s_lshr_b32 s5, s53, 2
    v_lshlrev_b32 v228, 4, v237
    v_lshrrev_b32 v234, 4, v237
    v_and_b32 v235, 15, v237
    v_lshlrev_b32 v236, 1, v234
    v_xor_b32 v235, v235, v236
    v_lshlrev_b32 v234, 11, v234
    s_lshl_b32 s32, s3, 14
    s_lshl_b32 s33, s5, 8
    s_add_u32 s32, s32, s33
    v_add_u32 v234, s32, v234
    v_lshl_add_u32 v224, v235, 4, v234
    v_xor_b32_e64 v235, 8, v235
    v_lshl_add_u32 v225, v235, 4, v234
    v_add_u32 v225, 7168, v225
    s_lshl_b32 s37, s6, 21
    s_lshl_b32 s38, s3, 11
    s_lshl2_add_u32 s4, s4, s3
    s_sub_u32 s32, 63, s4
    s_cmp_lt_u32 s6, 2
    s_cselect_b32 s4, s4, s32
    s_lshl_b32 s32, s4, 18
    v_add_u32 v226, s32, v228
    v_add_u32 v227, 0x20000, v226
    v_xor_b32 v245, 0xfc0000, v226
    v_xor_b32 v246, 0xfc0000, v227
    s_lshl_b32 s35, s6, 15
    s_add_u32 s35, s35, 0x2400000
    s_getpc_b64 s[56:57]
kc_pc0:
    s_mov_b32 s58, kc_end-kc_pc0
    s_mov_b32 s59, 0x00020000
    v_lshlrev_b32_e64 v234, 7, v230
    buffer_load_dword v241, v234, s[56:59], 0 offen
    s_waitcnt lgkmcnt(0)
    s_mov_b32 s8, s46
    s_mov_b32 s9, s47
    s_mov_b32 s10, 0x10000000
    s_mov_b32 s11, 0x00020000
    s_mov_b32 s12, s42
    s_mov_b32 s13, s43
    s_mov_b32 s14, 0x800000
    s_mov_b32 s15, 0x00020000
    s_mov_b32 s16, s40
    s_mov_b32 s17, s41
    s_mov_b32 s18, 0x400000
    s_mov_b32 s19, 0x00020000
    s_mov_b32 s20, s44
    s_mov_b32 s21, s45
    s_mov_b32 s22, 0x800
    s_mov_b32 s23, 0x00020000
    s_mov_b32 s24, s60
    s_mov_b32 s25, s61
    s_mov_b32 s26, 0x700000
    s_mov_b32 s27, 0x00020000
    s_mov_b32 s28, s62
    s_mov_b32 s29, s63
    s_mov_b32 s30, 0x400000
    s_mov_b32 s31, 0x00020000
    s_lshr_b32 s44, s6, 1
    s_and_b32 s6, s6, 1
    v_bfe_u32 v234, v237, 2, 3
    v_lshrrev_b32 v235, 5, v237
    v_lshl_add_u32 v235, v235, 4, v234
    v_lshlrev_b32 v235, 8, v235
    v_and_b32 v236, 1, v237
    v_lshl_add_u32 v235, v236, 3, v235
    v_lshlrev_b32_e64 v234, 1, v234
    v_bfe_u32 v236, v237, 1, 1
    v_or_b32 v234, v234, v236
    s_lshl_b32 s32, s6, 3
    v_xor_b32 v234, s32, v234
    v_xor_b32 v236, 0, v234
    v_lshl_add_u32 v216, v236, 4, v235
    v_xor_b32_e64 v236, 2, v234
    v_lshl_add_u32 v217, v236, 4, v235
    v_xor_b32_e64 v236, 4, v234
    v_lshl_add_u32 v218, v236, 4, v235
    v_xor_b32_e64 v236, 6, v234
    v_lshl_add_u32 v219, v236, 4, v235
    v_xor_b32_e64 v236, 8, v234
    v_lshl_add_u32 v220, v236, 4, v235
    v_xor_b32_e64 v236, 10, v234
    v_lshl_add_u32 v221, v236, 4, v235
    v_xor_b32_e64 v236, 12, v234
    v_lshl_add_u32 v222, v236, 4, v235
    v_xor_b32_e64 v236, 14, v234
    v_lshl_add_u32 v223, v236, 4, v235
    s_lshl_b32 s44, s4, 5
    v_lshrrev_b32 v234, 3, v237
    v_add_u32 v242, s44, v234
    v_and_b32 v235, 7, v237
    s_lshl1_add_u32 s33, s5, s6
    s_lshl_b32 s33, s33, 7
    v_lshl_add_u32 v240, v235, 4, s33
    v_lshl_add_u32 v229, v242, 11, v240
    s_mul_i32 s32, s3, 4608
    s_add_u32 s32, s32, 131072
    v_mul_u32_u24 v234, 144, v234
    v_lshl_add_u32 v234, v235, 4, v234
    v_add_u32 v239, s32, v234
    v_and_b32 v234, 15, v237
    v_mul_u32_u24 v234, 144, v234
    v_lshrrev_b32_e64 v236, 4, v237
    v_lshl_add_u32 v234, v236, 3, v234
    v_add_u32 v238, s32, v234
    v_and_b32 v234, 3, v237
    v_lshl_add_u32 v234, v234, 3, v242
    v_lshlrev_b32 v234, 2, v234
    v_lshrrev_b32 v235, 2, v235
    v_lshl_add_u32 v231, v235, 13, v234
    v_lshlrev_b32_e64 v235, 30, v235
    v_add_u32 v235, 16384, v235
    v_add_u32 v232, v235, v234
    s_cmp_eq_u32 s44, 0
    s_cselect_b32 s32, 4, 64
    v_cmp_eq_u32 vcc, s32, v237
    v_mov_b32 v235, 24576
    v_mov_b32 v233, 1
    v_cndmask_b32 v232, v232, v235, vcc
    v_and_b32_e64 v234, 1, v237
    v_cmp_ne_u32 s[60:61], 0, v234
    v_and_b32_e64 v234, 2, v237
    v_cmp_ne_u32 s[62:63], 0, v234
    v_and_b32_e64 v234, 4, v237
    v_cmp_ne_u32 s[40:41], 0, v234
    v_cmp_eq_u32 vcc, 0, v237
    v_mov_b32_e64 v235, 0x40000000
    s_nop 0
    v_cndmask_b32 v243, v235, v237, vcc
    s_lshl2_add_u32 s39, s2, s3
    s_mov_b32 s48, 0x3800000
    s_mov_b32 s49, 0x3802000
    s_mov_b32 s50, 0x3804000
    s_and_b32 s52, s2, 7
    s_mul_i32 s54, s52, 28
    s_add_u32 s54, s54, s53
    v_lshrrev_b32 v234, 3, v237
    v_lshlrev_b32 v234, 11, v234
    v_and_b32 v235, 7, v237
    v_lshl_add_u32 v244, v235, 4, v234
    s_lshl_b32 s55, s54, 16
    s_lshl_b32 s32, s3, 13
    s_add_u32 s55, s55, s32
    s_add_u32 s55, s55, 0x4000000
    s_lshl_b32 s51, s54, 15
    s_lshl_b32 s32, s3, 9
    s_add_u32 s51, s51, s32
    s_cmp_ge_u32 s53, 28
    s_cselect_b32 s55, 0x40000000, s55
    s_cselect_b32 s51, 0x40000000, s51
    s_lshr_b32 s32, s2, 5
    s_lshl_b32 s32, s32, 9
    s_and_b32 s33, s2, 6
    s_lshl_b32 s33, s33, 6
    s_add_u32 s32, s32, s33
    s_add_u32 s32, s32, 0x38a4000
    s_waitcnt vmcnt(0)
    s_barrier
    s_cmp_lg_u32 s3, 0
    s_cbranch_scc1 kc_a0
    buffer_atomic_add v233, v243, s[8:11], s32 offen sc1
    s_lshl_b32 s32, s52, 7
    s_add_u32 s32, s32, 0x38a1000
    v_mov_b32 v235, 1
    buffer_atomic_add v235, v243, s[8:11], s32 offen sc0 sc1
    v_lshlrev_b32 v234, 7, v237
    v_cmp_gt_u32 vcc, 8, v237
    v_mov_b32_e64 v236, 0x40000000
    s_mov_b32 s34, 0x38a1400
    v_cndmask_b32 v234, v236, v234, vcc
    s_waitcnt vmcnt(0)
    v_readfirstlane_b32 s36, v235
    s_cmp_lg_u32 s36, 31
    s_cbranch_scc1 kc_a0
    buffer_atomic_add v233, v234, s[8:11], s34 offen sc1
kc_a0:
    s_add_u32 m0, s38, 0
    s_add_u32 s32, s37, 0
    buffer_load_dwordx4 v224, s[12:15], s32 offen lds
    buffer_load_dwordx4 v225, s[12:15], s32 offen offset:1024 lds
    s_add_u32 m0, s38, 8192
    s_add_u32 s32, s37, 65536
    buffer_load_dwordx4 v224, s[12:15], s32 offen lds
    buffer_load_dwordx4 v225, s[12:15], s32 offen offset:1024 lds
    s_add_u32 m0, s38, 16384
    s_add_u32 s32, s37, 131072
    buffer_load_dwordx4 v224, s[12:15], s32 offen lds
    buffer_load_dwordx4 v225, s[12:15], s32 offen offset:1024 lds
    s_add_u32 m0, s38, 24576
    s_add_u32 s32, s37, 196608
    buffer_load_dwordx4 v224, s[12:15], s32 offen lds
    buffer_load_dwordx4 v225, s[12:15], s32 offen offset:1024 lds
    s_add_u32 m0, s38, 32768
    s_add_u32 s32, s37, 262144
    buffer_load_dwordx4 v224, s[12:15], s32 offen lds
    buffer_load_dwordx4 v225, s[12:15], s32 offen offset:1024 lds
    s_add_u32 m0, s38, 40960
    s_add_u32 s32, s37, 327680
    buffer_load_dwordx4 v224, s[12:15], s32 offen lds
    buffer_load_dwordx4 v225, s[12:15], s32 offen offset:1024 lds
    s_add_u32 m0, s38, 49152
    s_add_u32 s32, s37, 393216
    buffer_load_dwordx4 v224, s[12:15], s32 offen lds
    buffer_load_dwordx4 v225, s[12:15], s32 offen offset:1024 lds
    s_add_u32 m0, s38, 57344
    s_add_u32 s32, s37, 458752
    buffer_load_dwordx4 v224, s[12:15], s32 offen lds
    buffer_load_dwordx4 v225, s[12:15], s32 offen offset:1024 lds
    s_add_u32 m0, s38, 65536
    s_add_u32 s32, s37, 524288
    buffer_load_dwordx4 v224, s[12:15], s32 offen lds
    buffer_load_dwordx4 v225, s[12:15], s32 offen offset:1024 lds
    s_add_u32 m0, s38, 73728
    s_add_u32 s32, s37, 589824
    buffer_load_dwordx4 v224, s[12:15], s32 offen lds
    buffer_load_dwordx4 v225, s[12:15], s32 offen offset:1024 lds
    s_add_u32 m0, s38, 81920
    s_add_u32 s32, s37, 655360
    buffer_load_dwordx4 v224, s[12:15], s32 offen lds
    buffer_load_dwordx4 v225, s[12:15], s32 offen offset:1024 lds
    s_add_u32 m0, s38, 90112
    s_add_u32 s32, s37, 720896
    buffer_load_dwordx4 v224, s[12:15], s32 offen lds
    buffer_load_dwordx4 v225, s[12:15], s32 offen offset:1024 lds
    s_add_u32 m0, s38, 98304
    s_add_u32 s32, s37, 786432
    buffer_load_dwordx4 v224, s[12:15], s32 offen lds
    buffer_load_dwordx4 v225, s[12:15], s32 offen offset:1024 lds
    s_add_u32 m0, s38, 106496
    s_add_u32 s32, s37, 851968
    buffer_load_dwordx4 v224, s[12:15], s32 offen lds
    buffer_load_dwordx4 v225, s[12:15], s32 offen offset:1024 lds
    s_add_u32 m0, s38, 114688
    s_add_u32 s32, s37, 917504
    buffer_load_dwordx4 v224, s[12:15], s32 offen lds
    buffer_load_dwordx4 v225, s[12:15], s32 offen offset:1024 lds
    s_add_u32 m0, s38, 122880
    s_add_u32 s32, s37, 983040
    buffer_load_dwordx4 v224, s[12:15], s32 offen lds
    buffer_load_dwordx4 v225, s[12:15], s32 offen offset:1024 lds
    s_add_u32 s33, s51, 0
    buffer_load_dwordx4 a[192:195], v244, s[24:27], s33 offen offset:0
    s_add_u32 s33, s51, 16384
    buffer_load_dwordx4 a[196:199], v244, s[24:27], s33 offen offset:0
    s_add_u32 s33, s51, 0
    buffer_load_dwordx4 a[200:203], v244, s[24:27], s33 offen offset:128
    s_add_u32 s33, s51, 16384
    buffer_load_dwordx4 a[204:207], v244, s[24:27], s33 offen offset:128
    s_add_u32 s33, s51, 0
    buffer_load_dwordx4 a[208:211], v244, s[24:27], s33 offen offset:256
    s_add_u32 s33, s51, 16384
    buffer_load_dwordx4 a[212:215], v244, s[24:27], s33 offen offset:256
    s_add_u32 s33, s51, 0
    buffer_load_dwordx4 a[216:219], v244, s[24:27], s33 offen offset:384
    s_add_u32 s33, s51, 16384
    buffer_load_dwordx4 a[220:223], v244, s[24:27], s33 offen offset:384
    s_cmp_lg_u32 s3, 0
    s_cbranch_scc1 kc_b03
    s_and_b32 s32, s2, 1
    s_lshl_b32 s32, s32, 2
    s_and_b32 s33, s53, 3
    s_add_u32 s32, s32, s33
    s_lshl_b32 s32, s32, 9
    s_and_b32 s33, s2, 6
    s_lshl_b32 s33, s33, 6
    s_add_u32 s32, s32, s33
    s_add_u32 s32, s32, 0x38a4000
    s_mov_b32 s34, 0x400000
    s_branch kc_b01
kc_b00:
    s_sleep 2
kc_b01:
    buffer_load_dword v235, off, s[8:11], s32 sc1
    s_waitcnt vmcnt(0)
    v_cmp_ne_u32 vcc, 8, v235
    s_sub_u32 s34, s34, 1
    s_cbranch_scc1 kc_b02
    s_cbranch_vccnz kc_b00
kc_b02:
kc_b03:
    s_waitcnt vmcnt(8)
    s_barrier
    buffer_load_dwordx4 a[0:3], v226, s[8:11], s35 offen offset:0 sc1
    buffer_load_dwordx4 a[4:7], v227, s[8:11], s35 offen offset:0 sc1
    buffer_load_dwordx4 a[8:11], v245, s[8:11], s35 offen offset:0 sc1
    buffer_load_dwordx4 a[12:15], v246, s[8:11], s35 offen offset:0 sc1
    buffer_load_dwordx4 a[16:19], v226, s[8:11], s35 offen offset:1024 sc1
    buffer_load_dwordx4 a[20:23], v227, s[8:11], s35 offen offset:1024 sc1
    buffer_load_dwordx4 a[24:27], v245, s[8:11], s35 offen offset:1024 sc1
    buffer_load_dwordx4 a[28:31], v246, s[8:11], s35 offen offset:1024 sc1
    buffer_load_dwordx4 a[32:35], v226, s[8:11], s35 offen offset:2048 sc1
    buffer_load_dwordx4 a[36:39], v227, s[8:11], s35 offen offset:2048 sc1
    buffer_load_dwordx4 a[40:43], v245, s[8:11], s35 offen offset:2048 sc1
    buffer_load_dwordx4 a[44:47], v246, s[8:11], s35 offen offset:2048 sc1
    buffer_load_dwordx4 a[48:51], v226, s[8:11], s35 offen offset:3072 sc1
    buffer_load_dwordx4 a[52:55], v227, s[8:11], s35 offen offset:3072 sc1
    buffer_load_dwordx4 a[56:59], v245, s[8:11], s35 offen offset:3072 sc1
    buffer_load_dwordx4 a[60:63], v246, s[8:11], s35 offen offset:3072 sc1
    ds_read_b64_tr_b16 v[128:129], v216 offset:0
    ds_read_b64_tr_b16 v[130:131], v216 offset:2048
    ds_read_b64_tr_b16 v[132:133], v217 offset:0
    ds_read_b64_tr_b16 v[134:135], v217 offset:2048
    ds_read_b64_tr_b16 v[136:137], v218 offset:0
    ds_read_b64_tr_b16 v[138:139], v218 offset:2048
    ds_read_b64_tr_b16 v[140:141], v219 offset:0
    ds_read_b64_tr_b16 v[142:143], v219 offset:2048
    s_waitcnt vmcnt(12) lgkmcnt(0)
    v_mfma_f32_16x16x32_bf16 v[32:35], v[128:131], a[0:3], 0
    ds_read_b64_tr_b16 v[144:145], v220 offset:0
    v_mfma_f32_16x16x32_bf16 v[36:39], v[128:131], a[4:7], 0
    ds_read_b64_tr_b16 v[146:147], v220 offset:2048
    v_mfma_f32_16x16x32_bf16 v[64:67], v[128:131], a[8:11], 0
    ds_read_b64_tr_b16 v[148:149], v221 offset:0
    v_mfma_f32_16x16x32_bf16 v[68:71], v[128:131], a[12:15], 0
    ds_read_b64_tr_b16 v[150:151], v221 offset:2048
    v_mfma_f32_16x16x32_bf16 v[40:43], v[132:135], a[0:3], 0
    ds_read_b64_tr_b16 v[152:153], v222 offset:0
    v_mfma_f32_16x16x32_bf16 v[44:47], v[132:135], a[4:7], 0
    ds_read_b64_tr_b16 v[154:155], v222 offset:2048
    v_mfma_f32_16x16x32_bf16 v[72:75], v[132:135], a[8:11], 0
    ds_read_b64_tr_b16 v[156:157], v223 offset:0
    v_mfma_f32_16x16x32_bf16 v[76:79], v[132:135], a[12:15], 0
    ds_read_b64_tr_b16 v[158:159], v223 offset:2048
    v_mfma_f32_16x16x32_bf16 v[48:51], v[136:139], a[0:3], 0
    s_add_u32 s35, s35, 4096
    buffer_load_dwordx4 a[64:67], v226, s[8:11], s35 offen offset:0 sc1
    v_mfma_f32_16x16x32_bf16 v[52:55], v[136:139], a[4:7], 0
    v_mfma_f32_16x16x32_bf16 v[80:83], v[136:139], a[8:11], 0
    v_mfma_f32_16x16x32_bf16 v[84:87], v[136:139], a[12:15], 0
    buffer_load_dwordx4 a[68:71], v227, s[8:11], s35 offen offset:0 sc1
    v_mfma_f32_16x16x32_bf16 v[56:59], v[140:143], a[0:3], 0
    v_mfma_f32_16x16x32_bf16 v[60:63], v[140:143], a[4:7], 0
    v_mfma_f32_16x16x32_bf16 v[88:91], v[140:143], a[8:11], 0
    v_mfma_f32_16x16x32_bf16 v[92:95], v[140:143], a[12:15], 0
    buffer_load_dwordx4 a[72:75], v245, s[8:11], s35 offen offset:0 sc1
    s_waitcnt lgkmcnt(0)
    v_mfma_f32_16x16x32_bf16 v[0:3], v[144:147], a[0:3], 0
    ds_read_b64_tr_b16 v[128:129], v216 offset:8192
    v_mfma_f32_16x16x32_bf16 v[4:7], v[144:147], a[4:7], 0
    ds_read_b64_tr_b16 v[130:131], v216 offset:10240
    v_mfma_f32_16x16x32_bf16 v[96:99], v[144:147], a[8:11], 0
    ds_read_b64_tr_b16 v[132:133], v217 offset:8192
    v_mfma_f32_16x16x32_bf16 v[100:103], v[144:147], a[12:15], 0
    ds_read_b64_tr_b16 v[134:135], v217 offset:10240
    v_mfma_f32_16x16x32_bf16 v[8:11], v[148:151], a[0:3], 0
    ds_read_b64_tr_b16 v[136:137], v218 offset:8192
    v_mfma_f32_16x16x32_bf16 v[12:15], v[148:151], a[4:7], 0
    ds_read_b64_tr_b16 v[138:139], v218 offset:10240
    v_mfma_f32_16x16x32_bf16 v[104:107], v[148:151], a[8:11], 0
    ds_read_b64_tr_b16 v[140:141], v219 offset:8192
    v_mfma_f32_16x16x32_bf16 v[108:111], v[148:151], a[12:15], 0
    ds_read_b64_tr_b16 v[142:143], v219 offset:10240
    v_mfma_f32_16x16x32_bf16 v[16:19], v[152:155], a[0:3], 0
    buffer_load_dwordx4 a[76:79], v246, s[8:11], s35 offen offset:0 sc1
    v_mfma_f32_16x16x32_bf16 v[20:23], v[152:155], a[4:7], 0
    v_mfma_f32_16x16x32_bf16 v[112:115], v[152:155], a[8:11], 0
    buffer_load_dwordx4 a[80:83], v226, s[8:11], s35 offen offset:1024 sc1
    v_mfma_f32_16x16x32_bf16 v[116:119], v[152:155], a[12:15], 0
    v_mfma_f32_16x16x32_bf16 v[24:27], v[156:159], a[0:3], 0
    v_mfma_f32_16x16x32_bf16 v[28:31], v[156:159], a[4:7], 0
    v_mfma_f32_16x16x32_bf16 v[120:123], v[156:159], a[8:11], 0
    v_mfma_f32_16x16x32_bf16 v[124:127], v[156:159], a[12:15], 0
    s_waitcnt vmcnt(13) lgkmcnt(0)
    v_mfma_f32_16x16x32_bf16 v[32:35], v[128:131], a[16:19], v[32:35]
    ds_read_b64_tr_b16 v[144:145], v220 offset:8192
    v_mfma_f32_16x16x32_bf16 v[36:39], v[128:131], a[20:23], v[36:39]
    ds_read_b64_tr_b16 v[146:147], v220 offset:10240
    v_mfma_f32_16x16x32_bf16 v[64:67], v[128:131], a[24:27], v[64:67]
    ds_read_b64_tr_b16 v[148:149], v221 offset:8192
    v_mfma_f32_16x16x32_bf16 v[68:71], v[128:131], a[28:31], v[68:71]
    ds_read_b64_tr_b16 v[150:151], v221 offset:10240
    v_mfma_f32_16x16x32_bf16 v[40:43], v[132:135], a[16:19], v[40:43]
    ds_read_b64_tr_b16 v[152:153], v222 offset:8192
    v_mfma_f32_16x16x32_bf16 v[44:47], v[132:135], a[20:23], v[44:47]
    ds_read_b64_tr_b16 v[154:155], v222 offset:10240
    v_mfma_f32_16x16x32_bf16 v[72:75], v[132:135], a[24:27], v[72:75]
    ds_read_b64_tr_b16 v[156:157], v223 offset:8192
    v_mfma_f32_16x16x32_bf16 v[76:79], v[132:135], a[28:31], v[76:79]
    ds_read_b64_tr_b16 v[158:159], v223 offset:10240
    v_mfma_f32_16x16x32_bf16 v[48:51], v[136:139], a[16:19], v[48:51]
    buffer_load_dwordx4 a[84:87], v227, s[8:11], s35 offen offset:1024 sc1
    v_mfma_f32_16x16x32_bf16 v[52:55], v[136:139], a[20:23], v[52:55]
    v_mfma_f32_16x16x32_bf16 v[80:83], v[136:139], a[24:27], v[80:83]
    v_mfma_f32_16x16x32_bf16 v[84:87], v[136:139], a[28:31], v[84:87]
    buffer_load_dwordx4 a[88:91], v245, s[8:11], s35 offen offset:1024 sc1
    v_mfma_f32_16x16x32_bf16 v[56:59], v[140:143], a[16:19], v[56:59]
    v_mfma_f32_16x16x32_bf16 v[60:63], v[140:143], a[20:23], v[60:63]
    v_mfma_f32_16x16x32_bf16 v[88:91], v[140:143], a[24:27], v[88:91]
    v_mfma_f32_16x16x32_bf16 v[92:95], v[140:143], a[28:31], v[92:95]
    buffer_load_dwordx4 a[92:95], v246, s[8:11], s35 offen offset:1024 sc1
    s_waitcnt lgkmcnt(0)
    v_mfma_f32_16x16x32_bf16 v[0:3], v[144:147], a[16:19], v[0:3]
    ds_read_b64_tr_b16 v[128:129], v216 offset:16384
    v_mfma_f32_16x16x32_bf16 v[4:7], v[144:147], a[20:23], v[4:7]
    ds_read_b64_tr_b16 v[130:131], v216 offset:18432
    v_mfma_f32_16x16x32_bf16 v[96:99], v[144:147], a[24:27], v[96:99]
    ds_read_b64_tr_b16 v[132:133], v217 offset:16384
    v_mfma_f32_16x16x32_bf16 v[100:103], v[144:147], a[28:31], v[100:103]
    ds_read_b64_tr_b16 v[134:135], v217 offset:18432
    v_mfma_f32_16x16x32_bf16 v[8:11], v[148:151], a[16:19], v[8:11]
    ds_read_b64_tr_b16 v[136:137], v218 offset:16384
    v_mfma_f32_16x16x32_bf16 v[12:15], v[148:151], a[20:23], v[12:15]
    ds_read_b64_tr_b16 v[138:139], v218 offset:18432
    v_mfma_f32_16x16x32_bf16 v[104:107], v[148:151], a[24:27], v[104:107]
    ds_read_b64_tr_b16 v[140:141], v219 offset:16384
    v_mfma_f32_16x16x32_bf16 v[108:111], v[148:151], a[28:31], v[108:111]
    ds_read_b64_tr_b16 v[142:143], v219 offset:18432
    v_mfma_f32_16x16x32_bf16 v[16:19], v[152:155], a[16:19], v[16:19]
    buffer_load_dwordx4 a[96:99], v226, s[8:11], s35 offen offset:2048 sc1
    v_mfma_f32_16x16x32_bf16 v[20:23], v[152:155], a[20:23], v[20:23]
    v_mfma_f32_16x16x32_bf16 v[112:115], v[152:155], a[24:27], v[112:115]
    v_mfma_f32_16x16x32_bf16 v[116:119], v[152:155], a[28:31], v[116:119]
    v_mfma_f32_16x16x32_bf16 v[24:27], v[156:159], a[16:19], v[24:27]
    buffer_load_dwordx4 a[100:103], v227, s[8:11], s35 offen offset:2048 sc1
    v_mfma_f32_16x16x32_bf16 v[28:31], v[156:159], a[20:23], v[28:31]
    v_mfma_f32_16x16x32_bf16 v[120:123], v[156:159], a[24:27], v[120:123]
    v_mfma_f32_16x16x32_bf16 v[124:127], v[156:159], a[28:31], v[124:127]
    s_waitcnt vmcnt(14) lgkmcnt(0)
    v_mfma_f32_16x16x32_bf16 v[32:35], v[128:131], a[32:35], v[32:35]
    ds_read_b64_tr_b16 v[144:145], v220 offset:16384
    v_mfma_f32_16x16x32_bf16 v[36:39], v[128:131], a[36:39], v[36:39]
    ds_read_b64_tr_b16 v[146:147], v220 offset:18432
    v_mfma_f32_16x16x32_bf16 v[64:67], v[128:131], a[40:43], v[64:67]
    ds_read_b64_tr_b16 v[148:149], v221 offset:16384
    v_mfma_f32_16x16x32_bf16 v[68:71], v[128:131], a[44:47], v[68:71]
    ds_read_b64_tr_b16 v[150:151], v221 offset:18432
    v_mfma_f32_16x16x32_bf16 v[40:43], v[132:135], a[32:35], v[40:43]
    ds_read_b64_tr_b16 v[152:153], v222 offset:16384
    v_mfma_f32_16x16x32_bf16 v[44:47], v[132:135], a[36:39], v[44:47]
    ds_read_b64_tr_b16 v[154:155], v222 offset:18432
    v_mfma_f32_16x16x32_bf16 v[72:75], v[132:135], a[40:43], v[72:75]
    ds_read_b64_tr_b16 v[156:157], v223 offset:16384
    v_mfma_f32_16x16x32_bf16 v[76:79], v[132:135], a[44:47], v[76:79]
    ds_read_b64_tr_b16 v[158:159], v223 offset:18432
    v_mfma_f32_16x16x32_bf16 v[48:51], v[136:139], a[32:35], v[48:51]
    buffer_load_dwordx4 a[104:107], v245, s[8:11], s35 offen offset:2048 sc1
    v_mfma_f32_16x16x32_bf16 v[52:55], v[136:139], a[36:39], v[52:55]
    v_mfma_f32_16x16x32_bf16 v[80:83], v[136:139], a[40:43], v[80:83]
    v_mfma_f32_16x16x32_bf16 v[84:87], v[136:139], a[44:47], v[84:87]
    buffer_load_dwordx4 a[108:111], v246, s[8:11], s35 offen offset:2048 sc1
    v_mfma_f32_16x16x32_bf16 v[56:59], v[140:143], a[32:35], v[56:59]
    v_mfma_f32_16x16x32_bf16 v[60:63], v[140:143], a[36:39], v[60:63]
    v_mfma_f32_16x16x32_bf16 v[88:91], v[140:143], a[40:43], v[88:91]
    v_mfma_f32_16x16x32_bf16 v[92:95], v[140:143], a[44:47], v[92:95]
    buffer_load_dwordx4 a[112:115], v226, s[8:11], s35 offen offset:3072 sc1
    s_waitcnt lgkmcnt(0)
    v_mfma_f32_16x16x32_bf16 v[0:3], v[144:147], a[32:35], v[0:3]
    ds_read_b64_tr_b16 v[128:129], v216 offset:24576
    v_mfma_f32_16x16x32_bf16 v[4:7], v[144:147], a[36:39], v[4:7]
    ds_read_b64_tr_b16 v[130:131], v216 offset:26624
    v_mfma_f32_16x16x32_bf16 v[96:99], v[144:147], a[40:43], v[96:99]
    ds_read_b64_tr_b16 v[132:133], v217 offset:24576
    v_mfma_f32_16x16x32_bf16 v[100:103], v[144:147], a[44:47], v[100:103]
    ds_read_b64_tr_b16 v[134:135], v217 offset:26624
    v_mfma_f32_16x16x32_bf16 v[8:11], v[148:151], a[32:35], v[8:11]
    ds_read_b64_tr_b16 v[136:137], v218 offset:24576
    v_mfma_f32_16x16x32_bf16 v[12:15], v[148:151], a[36:39], v[12:15]
    ds_read_b64_tr_b16 v[138:139], v218 offset:26624
    v_mfma_f32_16x16x32_bf16 v[104:107], v[148:151], a[40:43], v[104:107]
    ds_read_b64_tr_b16 v[140:141], v219 offset:24576
    v_mfma_f32_16x16x32_bf16 v[108:111], v[148:151], a[44:47], v[108:111]
    ds_read_b64_tr_b16 v[142:143], v219 offset:26624
    v_mfma_f32_16x16x32_bf16 v[16:19], v[152:155], a[32:35], v[16:19]
    buffer_load_dwordx4 a[116:119], v227, s[8:11], s35 offen offset:3072 sc1
    v_mfma_f32_16x16x32_bf16 v[20:23], v[152:155], a[36:39], v[20:23]
    v_mfma_f32_16x16x32_bf16 v[112:115], v[152:155], a[40:43], v[112:115]
    v_mfma_f32_16x16x32_bf16 v[116:119], v[152:155], a[44:47], v[116:119]
    v_mfma_f32_16x16x32_bf16 v[24:27], v[156:159], a[32:35], v[24:27]
    buffer_load_dwordx4 a[120:123], v245, s[8:11], s35 offen offset:3072 sc1
    v_mfma_f32_16x16x32_bf16 v[28:31], v[156:159], a[36:39], v[28:31]
    v_mfma_f32_16x16x32_bf16 v[120:123], v[156:159], a[40:43], v[120:123]
    v_mfma_f32_16x16x32_bf16 v[124:127], v[156:159], a[44:47], v[124:127]
    s_waitcnt vmcnt(15) lgkmcnt(0)
    v_mfma_f32_16x16x32_bf16 v[32:35], v[128:131], a[48:51], v[32:35]
    ds_read_b64_tr_b16 v[144:145], v220 offset:24576
    v_mfma_f32_16x16x32_bf16 v[36:39], v[128:131], a[52:55], v[36:39]
    ds_read_b64_tr_b16 v[146:147], v220 offset:26624
    v_mfma_f32_16x16x32_bf16 v[64:67], v[128:131], a[56:59], v[64:67]
    ds_read_b64_tr_b16 v[148:149], v221 offset:24576
    v_mfma_f32_16x16x32_bf16 v[68:71], v[128:131], a[60:63], v[68:71]
    ds_read_b64_tr_b16 v[150:151], v221 offset:26624
    v_mfma_f32_16x16x32_bf16 v[40:43], v[132:135], a[48:51], v[40:43]
    ds_read_b64_tr_b16 v[152:153], v222 offset:24576
    v_mfma_f32_16x16x32_bf16 v[44:47], v[132:135], a[52:55], v[44:47]
    ds_read_b64_tr_b16 v[154:155], v222 offset:26624
    v_mfma_f32_16x16x32_bf16 v[72:75], v[132:135], a[56:59], v[72:75]
    ds_read_b64_tr_b16 v[156:157], v223 offset:24576
    v_mfma_f32_16x16x32_bf16 v[76:79], v[132:135], a[60:63], v[76:79]
    ds_read_b64_tr_b16 v[158:159], v223 offset:26624
    v_mfma_f32_16x16x32_bf16 v[48:51], v[136:139], a[48:51], v[48:51]
    buffer_load_dwordx4 a[124:127], v246, s[8:11], s35 offen offset:3072 sc1
    v_mfma_f32_16x16x32_bf16 v[52:55], v[136:139], a[52:55], v[52:55]
    v_mfma_f32_16x16x32_bf16 v[80:83], v[136:139], a[56:59], v[80:83]
    v_mfma_f32_16x16x32_bf16 v[84:87], v[136:139], a[60:63], v[84:87]
    s_add_u32 s35, s35, 4096
    buffer_load_dwordx4 a[0:3], v226, s[8:11], s35 offen offset:0 sc1
    v_mfma_f32_16x16x32_bf16 v[56:59], v[140:143], a[48:51], v[56:59]
    v_mfma_f32_16x16x32_bf16 v[60:63], v[140:143], a[52:55], v[60:63]
    v_mfma_f32_16x16x32_bf16 v[88:91], v[140:143], a[56:59], v[88:91]
    v_mfma_f32_16x16x32_bf16 v[92:95], v[140:143], a[60:63], v[92:95]
    buffer_load_dwordx4 a[4:7], v227, s[8:11], s35 offen offset:0 sc1
    s_waitcnt lgkmcnt(0)
    s_barrier
    v_mfma_f32_16x16x32_bf16 v[0:3], v[144:147], a[48:51], v[0:3]
    ds_read_b64_tr_b16 v[128:129], v216 offset:32768
    v_mfma_f32_16x16x32_bf16 v[4:7], v[144:147], a[52:55], v[4:7]
    ds_read_b64_tr_b16 v[130:131], v216 offset:34816
    v_mfma_f32_16x16x32_bf16 v[96:99], v[144:147], a[56:59], v[96:99]
    ds_read_b64_tr_b16 v[132:133], v216 offset:40960
    v_mfma_f32_16x16x32_bf16 v[100:103], v[144:147], a[60:63], v[100:103]
    ds_read_b64_tr_b16 v[134:135], v216 offset:43008
    v_mfma_f32_16x16x32_bf16 v[8:11], v[148:151], a[48:51], v[8:11]
    ds_read_b64_tr_b16 v[136:137], v217 offset:32768
    v_mfma_f32_16x16x32_bf16 v[12:15], v[148:151], a[52:55], v[12:15]
    ds_read_b64_tr_b16 v[138:139], v217 offset:34816
    v_mfma_f32_16x16x32_bf16 v[104:107], v[148:151], a[56:59], v[104:107]
    ds_read_b64_tr_b16 v[140:141], v217 offset:40960
    v_mfma_f32_16x16x32_bf16 v[108:111], v[148:151], a[60:63], v[108:111]
    ds_read_b64_tr_b16 v[142:143], v217 offset:43008
    v_mfma_f32_16x16x32_bf16 v[16:19], v[152:155], a[48:51], v[16:19]
    buffer_load_dwordx4 a[8:11], v245, s[8:11], s35 offen offset:0 sc1
    v_mfma_f32_16x16x32_bf16 v[20:23], v[152:155], a[52:55], v[20:23]
    v_mfma_f32_16x16x32_bf16 v[112:115], v[152:155], a[56:59], v[112:115]
    v_mfma_f32_16x16x32_bf16 v[116:119], v[152:155], a[60:63], v[116:119]
    v_mfma_f32_16x16x32_bf16 v[24:27], v[156:159], a[48:51], v[24:27]
    buffer_load_dwordx4 a[12:15], v246, s[8:11], s35 offen offset:0 sc1
    v_mfma_f32_16x16x32_bf16 v[28:31], v[156:159], a[52:55], v[28:31]
    v_mfma_f32_16x16x32_bf16 v[120:123], v[156:159], a[56:59], v[120:123]
    v_mfma_f32_16x16x32_bf16 v[124:127], v[156:159], a[60:63], v[124:127]
    s_waitcnt vmcnt(12) lgkmcnt(0)
    v_mfma_f32_16x16x32_bf16 v[32:35], v[128:131], a[64:67], v[32:35]
    ds_read_b64_tr_b16 v[144:145], v218 offset:32768
    v_mfma_f32_16x16x32_bf16 v[32:35], v[132:135], a[80:83], v[32:35]
    ds_read_b64_tr_b16 v[146:147], v218 offset:34816
    v_mfma_f32_16x16x32_bf16 v[36:39], v[128:131], a[68:71], v[36:39]
    ds_read_b64_tr_b16 v[148:149], v218 offset:40960
    v_mfma_f32_16x16x32_bf16 v[36:39], v[132:135], a[84:87], v[36:39]
    ds_read_b64_tr_b16 v[150:151], v218 offset:43008
    v_mfma_f32_16x16x32_bf16 v[64:67], v[128:131], a[72:75], v[64:67]
    ds_read_b64_tr_b16 v[152:153], v219 offset:32768
    v_mfma_f32_16x16x32_bf16 v[64:67], v[132:135], a[88:91], v[64:67]
    ds_read_b64_tr_b16 v[154:155], v219 offset:34816
    v_mfma_f32_16x16x32_bf16 v[68:71], v[128:131], a[76:79], v[68:71]
    ds_read_b64_tr_b16 v[156:157], v219 offset:40960
    v_mfma_f32_16x16x32_bf16 v[68:71], v[132:135], a[92:95], v[68:71]
    ds_read_b64_tr_b16 v[158:159], v219 offset:43008
    v_mfma_f32_16x16x32_bf16 v[40:43], v[136:139], a[64:67], v[40:43]
    buffer_load_dwordx4 a[16:19], v226, s[8:11], s35 offen offset:1024 sc1
    v_mfma_f32_16x16x32_bf16 v[40:43], v[140:143], a[80:83], v[40:43]
    s_add_u32 m0, s38, 0
    s_add_u32 s32, s37, 1048576
    v_mfma_f32_16x16x32_bf16 v[44:47], v[136:139], a[68:71], v[44:47]
    buffer_load_dwordx4 v224, s[12:15], s32 offen lds
    v_mfma_f32_16x16x32_bf16 v[44:47], v[140:143], a[84:87], v[44:47]
    buffer_load_dwordx4 a[20:23], v227, s[8:11], s35 offen offset:1024 sc1
    v_mfma_f32_16x16x32_bf16 v[72:75], v[136:139], a[72:75], v[72:75]
    v_mfma_f32_16x16x32_bf16 v[72:75], v[140:143], a[88:91], v[72:75]
    buffer_load_dwordx4 v225, s[12:15], s32 offen offset:1024 lds
    v_mfma_f32_16x16x32_bf16 v[76:79], v[136:139], a[76:79], v[76:79]
    v_mfma_f32_16x16x32_bf16 v[76:79], v[140:143], a[92:95], v[76:79]
    s_waitcnt lgkmcnt(0)
    v_mfma_f32_16x16x32_bf16 v[48:51], v[144:147], a[64:67], v[48:51]
    ds_read_b64_tr_b16 v[128:129], v220 offset:32768
    v_mfma_f32_16x16x32_bf16 v[48:51], v[148:151], a[80:83], v[48:51]
    ds_read_b64_tr_b16 v[130:131], v220 offset:34816
    v_mfma_f32_16x16x32_bf16 v[52:55], v[144:147], a[68:71], v[52:55]
    ds_read_b64_tr_b16 v[132:133], v220 offset:40960
    v_mfma_f32_16x16x32_bf16 v[52:55], v[148:151], a[84:87], v[52:55]
    ds_read_b64_tr_b16 v[134:135], v220 offset:43008
    v_mfma_f32_16x16x32_bf16 v[80:83], v[144:147], a[72:75], v[80:83]
    ds_read_b64_tr_b16 v[136:137], v221 offset:32768
    v_mfma_f32_16x16x32_bf16 v[80:83], v[148:151], a[88:91], v[80:83]
    ds_read_b64_tr_b16 v[138:139], v221 offset:34816
    v_mfma_f32_16x16x32_bf16 v[84:87], v[144:147], a[76:79], v[84:87]
    ds_read_b64_tr_b16 v[140:141], v221 offset:40960
    v_mfma_f32_16x16x32_bf16 v[84:87], v[148:151], a[92:95], v[84:87]
    ds_read_b64_tr_b16 v[142:143], v221 offset:43008
    v_mfma_f32_16x16x32_bf16 v[56:59], v[152:155], a[64:67], v[56:59]
    buffer_load_dwordx4 a[24:27], v245, s[8:11], s35 offen offset:1024 sc1
    v_mfma_f32_16x16x32_bf16 v[56:59], v[156:159], a[80:83], v[56:59]
    v_mfma_f32_16x16x32_bf16 v[60:63], v[152:155], a[68:71], v[60:63]
    buffer_load_dwordx4 a[28:31], v246, s[8:11], s35 offen offset:1024 sc1
    v_mfma_f32_16x16x32_bf16 v[60:63], v[156:159], a[84:87], v[60:63]
    v_mfma_f32_16x16x32_bf16 v[88:91], v[152:155], a[72:75], v[88:91]
    v_mfma_f32_16x16x32_bf16 v[88:91], v[156:159], a[88:91], v[88:91]
    v_mfma_f32_16x16x32_bf16 v[92:95], v[152:155], a[76:79], v[92:95]
    v_mfma_f32_16x16x32_bf16 v[92:95], v[156:159], a[92:95], v[92:95]
    buffer_load_dwordx4 a[32:35], v226, s[8:11], s35 offen offset:2048 sc1
    s_waitcnt lgkmcnt(0)
    v_mfma_f32_16x16x32_bf16 v[0:3], v[128:131], a[64:67], v[0:3]
    ds_read_b64_tr_b16 v[144:145], v222 offset:32768
    v_mfma_f32_16x16x32_bf16 v[0:3], v[132:135], a[80:83], v[0:3]
    ds_read_b64_tr_b16 v[146:147], v222 offset:34816
    v_mfma_f32_16x16x32_bf16 v[4:7], v[128:131], a[68:71], v[4:7]
    ds_read_b64_tr_b16 v[148:149], v222 offset:40960
    v_mfma_f32_16x16x32_bf16 v[4:7], v[132:135], a[84:87], v[4:7]
    ds_read_b64_tr_b16 v[150:151], v222 offset:43008
    v_mfma_f32_16x16x32_bf16 v[96:99], v[128:131], a[72:75], v[96:99]
    ds_read_b64_tr_b16 v[152:153], v223 offset:32768
    v_mfma_f32_16x16x32_bf16 v[96:99], v[132:135], a[88:91], v[96:99]
    ds_read_b64_tr_b16 v[154:155], v223 offset:34816
    v_mfma_f32_16x16x32_bf16 v[100:103], v[128:131], a[76:79], v[100:103]
    ds_read_b64_tr_b16 v[156:157], v223 offset:40960
    v_mfma_f32_16x16x32_bf16 v[100:103], v[132:135], a[92:95], v[100:103]
    ds_read_b64_tr_b16 v[158:159], v223 offset:43008
    v_mfma_f32_16x16x32_bf16 v[8:11], v[136:139], a[64:67], v[8:11]
    buffer_load_dwordx4 a[36:39], v227, s[8:11], s35 offen offset:2048 sc1
    v_mfma_f32_16x16x32_bf16 v[8:11], v[140:143], a[80:83], v[8:11]
    s_add_u32 m0, s38, 8192
    s_add_u32 s32, s37, 1114112
    v_mfma_f32_16x16x32_bf16 v[12:15], v[136:139], a[68:71], v[12:15]
    buffer_load_dwordx4 v224, s[12:15], s32 offen lds
    v_mfma_f32_16x16x32_bf16 v[12:15], v[140:143], a[84:87], v[12:15]
    buffer_load_dwordx4 a[40:43], v245, s[8:11], s35 offen offset:2048 sc1
    v_mfma_f32_16x16x32_bf16 v[104:107], v[136:139], a[72:75], v[104:107]
    v_mfma_f32_16x16x32_bf16 v[104:107], v[140:143], a[88:91], v[104:107]
    buffer_load_dwordx4 v225, s[12:15], s32 offen offset:1024 lds
    v_mfma_f32_16x16x32_bf16 v[108:111], v[136:139], a[76:79], v[108:111]
    v_mfma_f32_16x16x32_bf16 v[108:111], v[140:143], a[92:95], v[108:111]
    s_waitcnt lgkmcnt(0)
    v_mfma_f32_16x16x32_bf16 v[16:19], v[144:147], a[64:67], v[16:19]
    ds_read_b64_tr_b16 v[128:129], v216 offset:49152
    v_mfma_f32_16x16x32_bf16 v[16:19], v[148:151], a[80:83], v[16:19]
    ds_read_b64_tr_b16 v[130:131], v216 offset:51200
    v_mfma_f32_16x16x32_bf16 v[20:23], v[144:147], a[68:71], v[20:23]
    ds_read_b64_tr_b16 v[132:133], v216 offset:57344
    v_mfma_f32_16x16x32_bf16 v[20:23], v[148:151], a[84:87], v[20:23]
    ds_read_b64_tr_b16 v[134:135], v216 offset:59392
    v_mfma_f32_16x16x32_bf16 v[112:115], v[144:147], a[72:75], v[112:115]
    ds_read_b64_tr_b16 v[136:137], v217 offset:49152
    v_mfma_f32_16x16x32_bf16 v[112:115], v[148:151], a[88:91], v[112:115]
    ds_read_b64_tr_b16 v[138:139], v217 offset:51200
    v_mfma_f32_16x16x32_bf16 v[116:119], v[144:147], a[76:79], v[116:119]
    ds_read_b64_tr_b16 v[140:141], v217 offset:57344
    v_mfma_f32_16x16x32_bf16 v[116:119], v[148:151], a[92:95], v[116:119]
    ds_read_b64_tr_b16 v[142:143], v217 offset:59392
    v_mfma_f32_16x16x32_bf16 v[24:27], v[152:155], a[64:67], v[24:27]
    buffer_load_dwordx4 a[44:47], v246, s[8:11], s35 offen offset:2048 sc1
    v_mfma_f32_16x16x32_bf16 v[24:27], v[156:159], a[80:83], v[24:27]
    v_mfma_f32_16x16x32_bf16 v[28:31], v[152:155], a[68:71], v[28:31]
    buffer_load_dwordx4 a[48:51], v226, s[8:11], s35 offen offset:3072 sc1
    v_mfma_f32_16x16x32_bf16 v[28:31], v[156:159], a[84:87], v[28:31]
    v_mfma_f32_16x16x32_bf16 v[120:123], v[152:155], a[72:75], v[120:123]
    v_mfma_f32_16x16x32_bf16 v[120:123], v[156:159], a[88:91], v[120:123]
    v_mfma_f32_16x16x32_bf16 v[124:127], v[152:155], a[76:79], v[124:127]
    v_mfma_f32_16x16x32_bf16 v[124:127], v[156:159], a[92:95], v[124:127]
    buffer_load_dwordx4 a[52:55], v227, s[8:11], s35 offen offset:3072 sc1
    s_waitcnt vmcnt(18) lgkmcnt(0)
    v_mfma_f32_16x16x32_bf16 v[32:35], v[128:131], a[96:99], v[32:35]
    ds_read_b64_tr_b16 v[144:145], v218 offset:49152
    v_mfma_f32_16x16x32_bf16 v[32:35], v[132:135], a[112:115], v[32:35]
    ds_read_b64_tr_b16 v[146:147], v218 offset:51200
    v_mfma_f32_16x16x32_bf16 v[36:39], v[128:131], a[100:103], v[36:39]
    ds_read_b64_tr_b16 v[148:149], v218 offset:57344
    v_mfma_f32_16x16x32_bf16 v[36:39], v[132:135], a[116:119], v[36:39]
    ds_read_b64_tr_b16 v[150:151], v218 offset:59392
    v_mfma_f32_16x16x32_bf16 v[64:67], v[128:131], a[104:107], v[64:67]
    ds_read_b64_tr_b16 v[152:153], v219 offset:49152
    v_mfma_f32_16x16x32_bf16 v[64:67], v[132:135], a[120:123], v[64:67]
    ds_read_b64_tr_b16 v[154:155], v219 offset:51200
    v_mfma_f32_16x16x32_bf16 v[68:71], v[128:131], a[108:111], v[68:71]
    ds_read_b64_tr_b16 v[156:157], v219 offset:57344
    v_mfma_f32_16x16x32_bf16 v[68:71], v[132:135], a[124:127], v[68:71]
    ds_read_b64_tr_b16 v[158:159], v219 offset:59392
    v_mfma_f32_16x16x32_bf16 v[40:43], v[136:139], a[96:99], v[40:43]
    buffer_load_dwordx4 a[56:59], v245, s[8:11], s35 offen offset:3072 sc1
    v_mfma_f32_16x16x32_bf16 v[40:43], v[140:143], a[112:115], v[40:43]
    s_add_u32 m0, s38, 16384
    s_add_u32 s32, s37, 1179648
    v_mfma_f32_16x16x32_bf16 v[44:47], v[136:139], a[100:103], v[44:47]
    buffer_load_dwordx4 v224, s[12:15], s32 offen lds
    v_mfma_f32_16x16x32_bf16 v[44:47], v[140:143], a[116:119], v[44:47]
    buffer_load_dwordx4 a[60:63], v246, s[8:11], s35 offen offset:3072 sc1
    v_mfma_f32_16x16x32_bf16 v[72:75], v[136:139], a[104:107], v[72:75]
    v_mfma_f32_16x16x32_bf16 v[72:75], v[140:143], a[120:123], v[72:75]
    buffer_load_dwordx4 v225, s[12:15], s32 offen offset:1024 lds
    v_mfma_f32_16x16x32_bf16 v[76:79], v[136:139], a[108:111], v[76:79]
    v_mfma_f32_16x16x32_bf16 v[76:79], v[140:143], a[124:127], v[76:79]
    s_waitcnt lgkmcnt(0)
    v_mfma_f32_16x16x32_bf16 v[48:51], v[144:147], a[96:99], v[48:51]
    ds_read_b64_tr_b16 v[128:129], v220 offset:49152
    v_mfma_f32_16x16x32_bf16 v[48:51], v[148:151], a[112:115], v[48:51]
    ds_read_b64_tr_b16 v[130:131], v220 offset:51200
    v_mfma_f32_16x16x32_bf16 v[52:55], v[144:147], a[100:103], v[52:55]
    ds_read_b64_tr_b16 v[132:133], v220 offset:57344
    v_mfma_f32_16x16x32_bf16 v[52:55], v[148:151], a[116:119], v[52:55]
    ds_read_b64_tr_b16 v[134:135], v220 offset:59392
    v_mfma_f32_16x16x32_bf16 v[80:83], v[144:147], a[104:107], v[80:83]
    ds_read_b64_tr_b16 v[136:137], v221 offset:49152
    v_mfma_f32_16x16x32_bf16 v[80:83], v[148:151], a[120:123], v[80:83]
    ds_read_b64_tr_b16 v[138:139], v221 offset:51200
    v_mfma_f32_16x16x32_bf16 v[84:87], v[144:147], a[108:111], v[84:87]
    ds_read_b64_tr_b16 v[140:141], v221 offset:57344
    v_mfma_f32_16x16x32_bf16 v[84:87], v[148:151], a[124:127], v[84:87]
    ds_read_b64_tr_b16 v[142:143], v221 offset:59392
    v_mfma_f32_16x16x32_bf16 v[56:59], v[152:155], a[96:99], v[56:59]
    s_add_u32 s35, s35, 4096
    buffer_load_dwordx4 a[64:67], v226, s[8:11], s35 offen offset:0 sc1
    v_mfma_f32_16x16x32_bf16 v[56:59], v[156:159], a[112:115], v[56:59]
    v_mfma_f32_16x16x32_bf16 v[60:63], v[152:155], a[100:103], v[60:63]
    buffer_load_dwordx4 a[68:71], v227, s[8:11], s35 offen offset:0 sc1
    v_mfma_f32_16x16x32_bf16 v[60:63], v[156:159], a[116:119], v[60:63]
    v_mfma_f32_16x16x32_bf16 v[88:91], v[152:155], a[104:107], v[88:91]
    v_mfma_f32_16x16x32_bf16 v[88:91], v[156:159], a[120:123], v[88:91]
    v_mfma_f32_16x16x32_bf16 v[92:95], v[152:155], a[108:111], v[92:95]
    v_mfma_f32_16x16x32_bf16 v[92:95], v[156:159], a[124:127], v[92:95]
    buffer_load_dwordx4 a[72:75], v245, s[8:11], s35 offen offset:0 sc1
    s_waitcnt lgkmcnt(0)
    v_mfma_f32_16x16x32_bf16 v[0:3], v[128:131], a[96:99], v[0:3]
    ds_read_b64_tr_b16 v[144:145], v222 offset:49152
    v_mfma_f32_16x16x32_bf16 v[0:3], v[132:135], a[112:115], v[0:3]
    ds_read_b64_tr_b16 v[146:147], v222 offset:51200
    v_mfma_f32_16x16x32_bf16 v[4:7], v[128:131], a[100:103], v[4:7]
    ds_read_b64_tr_b16 v[148:149], v222 offset:57344
    v_mfma_f32_16x16x32_bf16 v[4:7], v[132:135], a[116:119], v[4:7]
    ds_read_b64_tr_b16 v[150:151], v222 offset:59392
    v_mfma_f32_16x16x32_bf16 v[96:99], v[128:131], a[104:107], v[96:99]
    ds_read_b64_tr_b16 v[152:153], v223 offset:49152
    v_mfma_f32_16x16x32_bf16 v[96:99], v[132:135], a[120:123], v[96:99]
    ds_read_b64_tr_b16 v[154:155], v223 offset:51200
    v_mfma_f32_16x16x32_bf16 v[100:103], v[128:131], a[108:111], v[100:103]
    ds_read_b64_tr_b16 v[156:157], v223 offset:57344
    v_mfma_f32_16x16x32_bf16 v[100:103], v[132:135], a[124:127], v[100:103]
    ds_read_b64_tr_b16 v[158:159], v223 offset:59392
    v_mfma_f32_16x16x32_bf16 v[8:11], v[136:139], a[96:99], v[8:11]
    buffer_load_dwordx4 a[76:79], v246, s[8:11], s35 offen offset:0 sc1
    v_mfma_f32_16x16x32_bf16 v[8:11], v[140:143], a[112:115], v[8:11]
    s_add_u32 m0, s38, 24576
    s_add_u32 s32, s37, 1245184
    v_mfma_f32_16x16x32_bf16 v[12:15], v[136:139], a[100:103], v[12:15]
    buffer_load_dwordx4 v224, s[12:15], s32 offen lds
    v_mfma_f32_16x16x32_bf16 v[12:15], v[140:143], a[116:119], v[12:15]
    v_mfma_f32_16x16x32_bf16 v[104:107], v[136:139], a[104:107], v[104:107]
    v_mfma_f32_16x16x32_bf16 v[104:107], v[140:143], a[120:123], v[104:107]
    buffer_load_dwordx4 v225, s[12:15], s32 offen offset:1024 lds
    v_mfma_f32_16x16x32_bf16 v[108:111], v[136:139], a[108:111], v[108:111]
    v_mfma_f32_16x16x32_bf16 v[108:111], v[140:143], a[124:127], v[108:111]
    buffer_load_dwordx4 a[80:83], v226, s[8:11], s35 offen offset:1024 sc1
    s_waitcnt lgkmcnt(0)
    s_barrier
    v_mfma_f32_16x16x32_bf16 v[16:19], v[144:147], a[96:99], v[16:19]
    v_xor_b32 v216, 0x10000, v216
    ds_read_b64_tr_b16 v[128:129], v216 offset:0
    v_mfma_f32_16x16x32_bf16 v[16:19], v[148:151], a[112:115], v[16:19]
    ds_read_b64_tr_b16 v[130:131], v216 offset:2048
    v_mfma_f32_16x16x32_bf16 v[20:23], v[144:147], a[100:103], v[20:23]
    ds_read_b64_tr_b16 v[132:133], v216 offset:8192
    v_mfma_f32_16x16x32_bf16 v[20:23], v[148:151], a[116:119], v[20:23]
    ds_read_b64_tr_b16 v[134:135], v216 offset:10240
    v_mfma_f32_16x16x32_bf16 v[112:115], v[144:147], a[104:107], v[112:115]
    v_xor_b32 v217, 0x10000, v217
    ds_read_b64_tr_b16 v[136:137], v217 offset:0
    v_mfma_f32_16x16x32_bf16 v[112:115], v[148:151], a[120:123], v[112:115]
    ds_read_b64_tr_b16 v[138:139], v217 offset:2048
    v_mfma_f32_16x16x32_bf16 v[116:119], v[144:147], a[108:111], v[116:119]
    ds_read_b64_tr_b16 v[140:141], v217 offset:8192
    v_mfma_f32_16x16x32_bf16 v[116:119], v[148:151], a[124:127], v[116:119]
    ds_read_b64_tr_b16 v[142:143], v217 offset:10240
    v_mfma_f32_16x16x32_bf16 v[24:27], v[152:155], a[96:99], v[24:27]
    buffer_load_dwordx4 a[84:87], v227, s[8:11], s35 offen offset:1024 sc1
    v_mfma_f32_16x16x32_bf16 v[24:27], v[156:159], a[112:115], v[24:27]
    v_mfma_f32_16x16x32_bf16 v[28:31], v[152:155], a[100:103], v[28:31]
    buffer_load_dwordx4 a[88:91], v245, s[8:11], s35 offen offset:1024 sc1
    v_mfma_f32_16x16x32_bf16 v[28:31], v[156:159], a[116:119], v[28:31]
    v_mfma_f32_16x16x32_bf16 v[120:123], v[152:155], a[104:107], v[120:123]
    v_mfma_f32_16x16x32_bf16 v[120:123], v[156:159], a[120:123], v[120:123]
    v_mfma_f32_16x16x32_bf16 v[124:127], v[152:155], a[108:111], v[124:127]
    v_mfma_f32_16x16x32_bf16 v[124:127], v[156:159], a[124:127], v[124:127]
    s_waitcnt vmcnt(21) lgkmcnt(0)
    v_mfma_f32_16x16x32_bf16 v[32:35], v[128:131], a[0:3], v[32:35]
    v_xor_b32 v218, 0x10000, v218
    ds_read_b64_tr_b16 v[144:145], v218 offset:0
    v_mfma_f32_16x16x32_bf16 v[32:35], v[132:135], a[16:19], v[32:35]
    ds_read_b64_tr_b16 v[146:147], v218 offset:2048
    v_mfma_f32_16x16x32_bf16 v[36:39], v[128:131], a[4:7], v[36:39]
    ds_read_b64_tr_b16 v[148:149], v218 offset:8192
    v_mfma_f32_16x16x32_bf16 v[36:39], v[132:135], a[20:23], v[36:39]
    ds_read_b64_tr_b16 v[150:151], v218 offset:10240
    v_mfma_f32_16x16x32_bf16 v[64:67], v[128:131], a[8:11], v[64:67]
    v_xor_b32 v219, 0x10000, v219
    ds_read_b64_tr_b16 v[152:153], v219 offset:0
    v_mfma_f32_16x16x32_bf16 v[64:67], v[132:135], a[24:27], v[64:67]
    ds_read_b64_tr_b16 v[154:155], v219 offset:2048
    v_mfma_f32_16x16x32_bf16 v[68:71], v[128:131], a[12:15], v[68:71]
    ds_read_b64_tr_b16 v[156:157], v219 offset:8192
    v_mfma_f32_16x16x32_bf16 v[68:71], v[132:135], a[28:31], v[68:71]
    ds_read_b64_tr_b16 v[158:159], v219 offset:10240
    v_mfma_f32_16x16x32_bf16 v[40:43], v[136:139], a[0:3], v[40:43]
    buffer_load_dwordx4 a[92:95], v246, s[8:11], s35 offen offset:1024 sc1
    v_mfma_f32_16x16x32_bf16 v[40:43], v[140:143], a[16:19], v[40:43]
    s_add_u32 m0, s38, 32768
    s_add_u32 s32, s37, 1310720
    v_mfma_f32_16x16x32_bf16 v[44:47], v[136:139], a[4:7], v[44:47]
    buffer_load_dwordx4 v224, s[12:15], s32 offen lds
    v_mfma_f32_16x16x32_bf16 v[44:47], v[140:143], a[20:23], v[44:47]
    buffer_load_dwordx4 a[96:99], v226, s[8:11], s35 offen offset:2048 sc1
    v_mfma_f32_16x16x32_bf16 v[72:75], v[136:139], a[8:11], v[72:75]
    v_mfma_f32_16x16x32_bf16 v[72:75], v[140:143], a[24:27], v[72:75]
    buffer_load_dwordx4 v225, s[12:15], s32 offen offset:1024 lds
    v_mfma_f32_16x16x32_bf16 v[76:79], v[136:139], a[12:15], v[76:79]
    s_lshl_b32 s45, s52, 7
    s_add_u32 s45, s45, 0x38a1400
    v_mfma_f32_16x16x32_bf16 v[76:79], v[140:143], a[28:31], v[76:79]
    buffer_load_dwordx4 a[100:103], v227, s[8:11], s35 offen offset:2048 sc1
    s_waitcnt lgkmcnt(0)
    v_mfma_f32_16x16x32_bf16 v[48:51], v[144:147], a[0:3], v[48:51]
    v_xor_b32 v220, 0x10000, v220
    ds_read_b64_tr_b16 v[128:129], v220 offset:0
    v_mfma_f32_16x16x32_bf16 v[48:51], v[148:151], a[16:19], v[48:51]
    ds_read_b64_tr_b16 v[130:131], v220 offset:2048
    v_mfma_f32_16x16x32_bf16 v[52:55], v[144:147], a[4:7], v[52:55]
    ds_read_b64_tr_b16 v[132:133], v220 offset:8192
    v_mfma_f32_16x16x32_bf16 v[52:55], v[148:151], a[20:23], v[52:55]
    ds_read_b64_tr_b16 v[134:135], v220 offset:10240
    v_mfma_f32_16x16x32_bf16 v[80:83], v[144:147], a[8:11], v[80:83]
    v_xor_b32 v221, 0x10000, v221
    ds_read_b64_tr_b16 v[136:137], v221 offset:0
    v_mfma_f32_16x16x32_bf16 v[80:83], v[148:151], a[24:27], v[80:83]
    ds_read_b64_tr_b16 v[138:139], v221 offset:2048
    v_mfma_f32_16x16x32_bf16 v[84:87], v[144:147], a[12:15], v[84:87]
    ds_read_b64_tr_b16 v[140:141], v221 offset:8192
    v_mfma_f32_16x16x32_bf16 v[84:87], v[148:151], a[28:31], v[84:87]
    ds_read_b64_tr_b16 v[142:143], v221 offset:10240
    v_mfma_f32_16x16x32_bf16 v[56:59], v[152:155], a[0:3], v[56:59]
    buffer_load_dwordx4 a[104:107], v245, s[8:11], s35 offen offset:2048 sc1
    v_mfma_f32_16x16x32_bf16 v[56:59], v[156:159], a[16:19], v[56:59]
    s_cmp_eq_u32 s3, 0
    s_cselect_b32 s45, s45, 0x40000000
    v_mfma_f32_16x16x32_bf16 v[60:63], v[152:155], a[4:7], v[60:63]
    buffer_load_dwordx4 a[108:111], v246, s[8:11], s35 offen offset:2048 sc1
    buffer_load_dword v235, off, s[8:11], s45 sc1
    v_mfma_f32_16x16x32_bf16 v[60:63], v[156:159], a[20:23], v[60:63]
    v_mfma_f32_16x16x32_bf16 v[88:91], v[152:155], a[8:11], v[88:91]
    v_mfma_f32_16x16x32_bf16 v[88:91], v[156:159], a[24:27], v[88:91]
    v_mfma_f32_16x16x32_bf16 v[92:95], v[152:155], a[12:15], v[92:95]
    v_mfma_f32_16x16x32_bf16 v[92:95], v[156:159], a[28:31], v[92:95]
    s_waitcnt lgkmcnt(0)
    v_mfma_f32_16x16x32_bf16 v[0:3], v[128:131], a[0:3], v[0:3]
    v_xor_b32 v222, 0x10000, v222
    ds_read_b64_tr_b16 v[144:145], v222 offset:0
    v_mfma_f32_16x16x32_bf16 v[0:3], v[132:135], a[16:19], v[0:3]
    ds_read_b64_tr_b16 v[146:147], v222 offset:2048
    v_mfma_f32_16x16x32_bf16 v[4:7], v[128:131], a[4:7], v[4:7]
    ds_read_b64_tr_b16 v[148:149], v222 offset:8192
    v_mfma_f32_16x16x32_bf16 v[4:7], v[132:135], a[20:23], v[4:7]
    ds_read_b64_tr_b16 v[150:151], v222 offset:10240
    v_mfma_f32_16x16x32_bf16 v[96:99], v[128:131], a[8:11], v[96:99]
    v_xor_b32 v223, 0x10000, v223
    ds_read_b64_tr_b16 v[152:153], v223 offset:0
    v_mfma_f32_16x16x32_bf16 v[96:99], v[132:135], a[24:27], v[96:99]
    ds_read_b64_tr_b16 v[154:155], v223 offset:2048
    v_mfma_f32_16x16x32_bf16 v[100:103], v[128:131], a[12:15], v[100:103]
    ds_read_b64_tr_b16 v[156:157], v223 offset:8192
    v_mfma_f32_16x16x32_bf16 v[100:103], v[132:135], a[28:31], v[100:103]
    ds_read_b64_tr_b16 v[158:159], v223 offset:10240
    v_mfma_f32_16x16x32_bf16 v[8:11], v[136:139], a[0:3], v[8:11]
    buffer_load_dwordx4 a[112:115], v226, s[8:11], s35 offen offset:3072 sc1
    v_mfma_f32_16x16x32_bf16 v[8:11], v[140:143], a[16:19], v[8:11]
    s_add_u32 m0, s38, 40960
    s_add_u32 s32, s37, 1376256
    v_mfma_f32_16x16x32_bf16 v[12:15], v[136:139], a[4:7], v[12:15]
    buffer_load_dwordx4 v224, s[12:15], s32 offen lds
    v_mfma_f32_16x16x32_bf16 v[12:15], v[140:143], a[20:23], v[12:15]
    buffer_load_dwordx4 a[116:119], v227, s[8:11], s35 offen offset:3072 sc1
    v_mfma_f32_16x16x32_bf16 v[104:107], v[136:139], a[8:11], v[104:107]
    v_mfma_f32_16x16x32_bf16 v[104:107], v[140:143], a[24:27], v[104:107]
    buffer_load_dwordx4 v225, s[12:15], s32 offen offset:1024 lds
    v_mfma_f32_16x16x32_bf16 v[108:111], v[136:139], a[12:15], v[108:111]
    v_mfma_f32_16x16x32_bf16 v[108:111], v[140:143], a[28:31], v[108:111]
    buffer_load_dwordx4 a[120:123], v245, s[8:11], s35 offen offset:3072 sc1
    s_waitcnt lgkmcnt(0)
    v_mfma_f32_16x16x32_bf16 v[16:19], v[144:147], a[0:3], v[16:19]
    ds_read_b64_tr_b16 v[128:129], v216 offset:16384
    v_mfma_f32_16x16x32_bf16 v[16:19], v[148:151], a[16:19], v[16:19]
    ds_read_b64_tr_b16 v[130:131], v216 offset:18432
    v_mfma_f32_16x16x32_bf16 v[20:23], v[144:147], a[4:7], v[20:23]
    ds_read_b64_tr_b16 v[132:133], v216 offset:24576
    v_mfma_f32_16x16x32_bf16 v[20:23], v[148:151], a[20:23], v[20:23]
    ds_read_b64_tr_b16 v[134:135], v216 offset:26624
    v_mfma_f32_16x16x32_bf16 v[112:115], v[144:147], a[8:11], v[112:115]
    ds_read_b64_tr_b16 v[136:137], v217 offset:16384
    v_mfma_f32_16x16x32_bf16 v[112:115], v[148:151], a[24:27], v[112:115]
    ds_read_b64_tr_b16 v[138:139], v217 offset:18432
    v_mfma_f32_16x16x32_bf16 v[116:119], v[144:147], a[12:15], v[116:119]
    ds_read_b64_tr_b16 v[140:141], v217 offset:24576
    v_mfma_f32_16x16x32_bf16 v[116:119], v[148:151], a[28:31], v[116:119]
    ds_read_b64_tr_b16 v[142:143], v217 offset:26624
    v_mfma_f32_16x16x32_bf16 v[24:27], v[152:155], a[0:3], v[24:27]
    buffer_load_dwordx4 a[124:127], v246, s[8:11], s35 offen offset:3072 sc1
    v_mfma_f32_16x16x32_bf16 v[24:27], v[156:159], a[16:19], v[24:27]
    v_mfma_f32_16x16x32_bf16 v[28:31], v[152:155], a[4:7], v[28:31]
    v_mfma_f32_16x16x32_bf16 v[28:31], v[156:159], a[20:23], v[28:31]
    v_mfma_f32_16x16x32_bf16 v[120:123], v[152:155], a[8:11], v[120:123]
    v_mfma_f32_16x16x32_bf16 v[120:123], v[156:159], a[24:27], v[120:123]
    v_mfma_f32_16x16x32_bf16 v[124:127], v[152:155], a[12:15], v[124:127]
    v_mfma_f32_16x16x32_bf16 v[124:127], v[156:159], a[28:31], v[124:127]
    s_add_u32 s35, s35, 4096
    buffer_load_dwordx4 a[0:3], v226, s[8:11], s35 offen offset:0 sc1
    s_waitcnt vmcnt(25) lgkmcnt(0)
    v_mfma_f32_16x16x32_bf16 v[32:35], v[128:131], a[32:35], v[32:35]
    ds_read_b64_tr_b16 v[144:145], v218 offset:16384
    v_mfma_f32_16x16x32_bf16 v[32:35], v[132:135], a[48:51], v[32:35]
    ds_read_b64_tr_b16 v[146:147], v218 offset:18432
    v_mfma_f32_16x16x32_bf16 v[36:39], v[128:131], a[36:39], v[36:39]
    ds_read_b64_tr_b16 v[148:149], v218 offset:24576
    v_mfma_f32_16x16x32_bf16 v[36:39], v[132:135], a[52:55], v[36:39]
    ds_read_b64_tr_b16 v[150:151], v218 offset:26624
    v_mfma_f32_16x16x32_bf16 v[64:67], v[128:131], a[40:43], v[64:67]
    ds_read_b64_tr_b16 v[152:153], v219 offset:16384
    v_mfma_f32_16x16x32_bf16 v[64:67], v[132:135], a[56:59], v[64:67]
    ds_read_b64_tr_b16 v[154:155], v219 offset:18432
    v_mfma_f32_16x16x32_bf16 v[68:71], v[128:131], a[44:47], v[68:71]
    ds_read_b64_tr_b16 v[156:157], v219 offset:24576
    v_mfma_f32_16x16x32_bf16 v[68:71], v[132:135], a[60:63], v[68:71]
    ds_read_b64_tr_b16 v[158:159], v219 offset:26624
    v_mfma_f32_16x16x32_bf16 v[40:43], v[136:139], a[32:35], v[40:43]
    buffer_load_dwordx4 a[4:7], v227, s[8:11], s35 offen offset:0 sc1
    v_mfma_f32_16x16x32_bf16 v[40:43], v[140:143], a[48:51], v[40:43]
    s_add_u32 m0, s38, 49152
    s_add_u32 s32, s37, 1441792
    v_mfma_f32_16x16x32_bf16 v[44:47], v[136:139], a[36:39], v[44:47]
    buffer_load_dwordx4 v224, s[12:15], s32 offen lds
    v_mfma_f32_16x16x32_bf16 v[44:47], v[140:143], a[52:55], v[44:47]
    buffer_load_dwordx4 a[8:11], v245, s[8:11], s35 offen offset:0 sc1
    v_mfma_f32_16x16x32_bf16 v[72:75], v[136:139], a[40:43], v[72:75]
    v_mfma_f32_16x16x32_bf16 v[72:75], v[140:143], a[56:59], v[72:75]
    buffer_load_dwordx4 v225, s[12:15], s32 offen offset:1024 lds
    v_mfma_f32_16x16x32_bf16 v[76:79], v[136:139], a[44:47], v[76:79]
    v_mfma_f32_16x16x32_bf16 v[76:79], v[140:143], a[60:63], v[76:79]
    buffer_load_dwordx4 a[12:15], v246, s[8:11], s35 offen offset:0 sc1
    s_waitcnt lgkmcnt(0)
    v_mfma_f32_16x16x32_bf16 v[48:51], v[144:147], a[32:35], v[48:51]
    ds_read_b64_tr_b16 v[128:129], v220 offset:16384
    v_mfma_f32_16x16x32_bf16 v[48:51], v[148:151], a[48:51], v[48:51]
    ds_read_b64_tr_b16 v[130:131], v220 offset:18432
    v_mfma_f32_16x16x32_bf16 v[52:55], v[144:147], a[36:39], v[52:55]
    ds_read_b64_tr_b16 v[132:133], v220 offset:24576
    v_mfma_f32_16x16x32_bf16 v[52:55], v[148:151], a[52:55], v[52:55]
    ds_read_b64_tr_b16 v[134:135], v220 offset:26624
    v_mfma_f32_16x16x32_bf16 v[80:83], v[144:147], a[40:43], v[80:83]
    ds_read_b64_tr_b16 v[136:137], v221 offset:16384
    v_mfma_f32_16x16x32_bf16 v[80:83], v[148:151], a[56:59], v[80:83]
    ds_read_b64_tr_b16 v[138:139], v221 offset:18432
    v_mfma_f32_16x16x32_bf16 v[84:87], v[144:147], a[44:47], v[84:87]
    ds_read_b64_tr_b16 v[140:141], v221 offset:24576
    v_mfma_f32_16x16x32_bf16 v[84:87], v[148:151], a[60:63], v[84:87]
    ds_read_b64_tr_b16 v[142:143], v221 offset:26624
    v_mfma_f32_16x16x32_bf16 v[56:59], v[152:155], a[32:35], v[56:59]
    buffer_load_dwordx4 a[16:19], v226, s[8:11], s35 offen offset:1024 sc1
    v_mfma_f32_16x16x32_bf16 v[56:59], v[156:159], a[48:51], v[56:59]
    v_mfma_f32_16x16x32_bf16 v[60:63], v[152:155], a[36:39], v[60:63]
    v_mfma_f32_16x16x32_bf16 v[60:63], v[156:159], a[52:55], v[60:63]
    v_mfma_f32_16x16x32_bf16 v[88:91], v[152:155], a[40:43], v[88:91]
    buffer_load_dwordx4 a[20:23], v227, s[8:11], s35 offen offset:1024 sc1
    v_mfma_f32_16x16x32_bf16 v[88:91], v[156:159], a[56:59], v[88:91]
    v_mfma_f32_16x16x32_bf16 v[92:95], v[152:155], a[44:47], v[92:95]
    v_mfma_f32_16x16x32_bf16 v[92:95], v[156:159], a[60:63], v[92:95]
    s_waitcnt lgkmcnt(0)
    v_mfma_f32_16x16x32_bf16 v[0:3], v[128:131], a[32:35], v[0:3]
    ds_read_b64_tr_b16 v[144:145], v222 offset:16384
    v_mfma_f32_16x16x32_bf16 v[0:3], v[132:135], a[48:51], v[0:3]
    ds_read_b64_tr_b16 v[146:147], v222 offset:18432
    v_mfma_f32_16x16x32_bf16 v[4:7], v[128:131], a[36:39], v[4:7]
    ds_read_b64_tr_b16 v[148:149], v222 offset:24576
    v_mfma_f32_16x16x32_bf16 v[4:7], v[132:135], a[52:55], v[4:7]
    ds_read_b64_tr_b16 v[150:151], v222 offset:26624
    v_mfma_f32_16x16x32_bf16 v[96:99], v[128:131], a[40:43], v[96:99]
    ds_read_b64_tr_b16 v[152:153], v223 offset:16384
    v_mfma_f32_16x16x32_bf16 v[96:99], v[132:135], a[56:59], v[96:99]
    ds_read_b64_tr_b16 v[154:155], v223 offset:18432
    v_mfma_f32_16x16x32_bf16 v[100:103], v[128:131], a[44:47], v[100:103]
    ds_read_b64_tr_b16 v[156:157], v223 offset:24576
    v_mfma_f32_16x16x32_bf16 v[100:103], v[132:135], a[60:63], v[100:103]
    ds_read_b64_tr_b16 v[158:159], v223 offset:26624
    v_mfma_f32_16x16x32_bf16 v[8:11], v[136:139], a[32:35], v[8:11]
    buffer_load_dwordx4 a[24:27], v245, s[8:11], s35 offen offset:1024 sc1
    v_mfma_f32_16x16x32_bf16 v[8:11], v[140:143], a[48:51], v[8:11]
    s_add_u32 m0, s38, 57344
    s_add_u32 s32, s37, 1507328
    v_mfma_f32_16x16x32_bf16 v[12:15], v[136:139], a[36:39], v[12:15]
    buffer_load_dwordx4 v224, s[12:15], s32 offen lds
    v_mfma_f32_16x16x32_bf16 v[12:15], v[140:143], a[52:55], v[12:15]
    buffer_load_dwordx4 a[28:31], v246, s[8:11], s35 offen offset:1024 sc1
    v_mfma_f32_16x16x32_bf16 v[104:107], v[136:139], a[40:43], v[104:107]
    v_mfma_f32_16x16x32_bf16 v[104:107], v[140:143], a[56:59], v[104:107]
    buffer_load_dwordx4 v225, s[12:15], s32 offen offset:1024 lds
    v_mfma_f32_16x16x32_bf16 v[108:111], v[136:139], a[44:47], v[108:111]
    s_waitcnt vmcnt(18)
    v_readfirstlane_b32 s36, v235
    s_lshl_b32 s34, s3, 8
    s_add_u32 s36, s36, s34
    s_cmp_ge_u32 s36, 8
    s_cbranch_scc0 kc_g
kc_gr:
    v_mfma_f32_16x16x32_bf16 v[108:111], v[140:143], a[60:63], v[108:111]
    s_waitcnt lgkmcnt(0)
    s_barrier
    v_mfma_f32_16x16x32_bf16 v[16:19], v[144:147], a[32:35], v[16:19]
    ds_read_b64_tr_b16 v[128:129], v216 offset:32768
    v_mfma_f32_16x16x32_bf16 v[16:19], v[148:151], a[48:51], v[16:19]
    ds_read_b64_tr_b16 v[130:131], v216 offset:34816
    v_mfma_f32_16x16x32_bf16 v[20:23], v[144:147], a[36:39], v[20:23]
    ds_read_b64_tr_b16 v[132:133], v216 offset:40960
    v_mfma_f32_16x16x32_bf16 v[20:23], v[148:151], a[52:55], v[20:23]
    ds_read_b64_tr_b16 v[134:135], v216 offset:43008
    v_mfma_f32_16x16x32_bf16 v[112:115], v[144:147], a[40:43], v[112:115]
    ds_read_b64_tr_b16 v[136:137], v217 offset:32768
    v_mfma_f32_16x16x32_bf16 v[112:115], v[148:151], a[56:59], v[112:115]
    ds_read_b64_tr_b16 v[138:139], v217 offset:34816
    v_mfma_f32_16x16x32_bf16 v[116:119], v[144:147], a[44:47], v[116:119]
    ds_read_b64_tr_b16 v[140:141], v217 offset:40960
    v_mfma_f32_16x16x32_bf16 v[116:119], v[148:151], a[60:63], v[116:119]
    ds_read_b64_tr_b16 v[142:143], v217 offset:43008
    v_mfma_f32_16x16x32_bf16 v[24:27], v[152:155], a[32:35], v[24:27]
    v_mfma_f32_16x16x32_bf16 v[24:27], v[156:159], a[48:51], v[24:27]
    v_mfma_f32_16x16x32_bf16 v[28:31], v[152:155], a[36:39], v[28:31]
    v_mfma_f32_16x16x32_bf16 v[28:31], v[156:159], a[52:55], v[28:31]
    v_mfma_f32_16x16x32_bf16 v[120:123], v[152:155], a[40:43], v[120:123]
    v_mfma_f32_16x16x32_bf16 v[120:123], v[156:159], a[56:59], v[120:123]
    v_mfma_f32_16x16x32_bf16 v[124:127], v[152:155], a[44:47], v[124:127]
    v_mfma_f32_16x16x32_bf16 v[124:127], v[156:159], a[60:63], v[124:127]
    buffer_load_dwordx4 a[32:35], v226, s[8:11], s35 offen offset:2048 sc1
    s_waitcnt vmcnt(26) lgkmcnt(0)
    v_mfma_f32_16x16x32_bf16 v[32:35], v[128:131], a[64:67], v[32:35]
    ds_read_b64_tr_b16 v[144:145], v218 offset:32768
    v_mfma_f32_16x16x32_bf16 v[32:35], v[132:135], a[80:83], v[32:35]
    ds_read_b64_tr_b16 v[146:147], v218 offset:34816
    v_mfma_f32_16x16x32_bf16 v[36:39], v[128:131], a[68:71], v[36:39]
    ds_read_b64_tr_b16 v[148:149], v218 offset:40960
    v_mfma_f32_16x16x32_bf16 v[36:39], v[132:135], a[84:87], v[36:39]
    ds_read_b64_tr_b16 v[150:151], v218 offset:43008
    v_mfma_f32_16x16x32_bf16 v[64:67], v[128:131], a[72:75], v[64:67]
    ds_read_b64_tr_b16 v[152:153], v219 offset:32768
    v_mfma_f32_16x16x32_bf16 v[64:67], v[132:135], a[88:91], v[64:67]
    ds_read_b64_tr_b16 v[154:155], v219 offset:34816
    v_mfma_f32_16x16x32_bf16 v[68:71], v[128:131], a[76:79], v[68:71]
    ds_read_b64_tr_b16 v[156:157], v219 offset:40960
    v_mfma_f32_16x16x32_bf16 v[68:71], v[132:135], a[92:95], v[68:71]
    ds_read_b64_tr_b16 v[158:159], v219 offset:43008
    v_mfma_f32_16x16x32_bf16 v[40:43], v[136:139], a[64:67], v[40:43]
    buffer_load_dwordx4 a[36:39], v227, s[8:11], s35 offen offset:2048 sc1
    v_mfma_f32_16x16x32_bf16 v[40:43], v[140:143], a[80:83], v[40:43]
    s_add_u32 m0, s38, 65536
    s_add_u32 s32, s37, 1572864
    v_mfma_f32_16x16x32_bf16 v[44:47], v[136:139], a[68:71], v[44:47]
    buffer_load_dwordx4 v224, s[12:15], s32 offen lds
    v_mfma_f32_16x16x32_bf16 v[44:47], v[140:143], a[84:87], v[44:47]
    buffer_load_dwordx4 a[40:43], v245, s[8:11], s35 offen offset:2048 sc1
    v_mfma_f32_16x16x32_bf16 v[72:75], v[136:139], a[72:75], v[72:75]
    v_mfma_f32_16x16x32_bf16 v[72:75], v[140:143], a[88:91], v[72:75]
    buffer_load_dwordx4 v225, s[12:15], s32 offen offset:1024 lds
    v_mfma_f32_16x16x32_bf16 v[76:79], v[136:139], a[76:79], v[76:79]
    s_add_u32 s33, s55, 0
    buffer_load_dwordx4 a[128:131], v228, s[8:11], s33 offen offset:0 sc1
    v_mfma_f32_16x16x32_bf16 v[76:79], v[140:143], a[92:95], v[76:79]
    buffer_load_dwordx4 a[44:47], v246, s[8:11], s35 offen offset:2048 sc1
    s_waitcnt lgkmcnt(0)
    v_mfma_f32_16x16x32_bf16 v[48:51], v[144:147], a[64:67], v[48:51]
    ds_read_b64_tr_b16 v[128:129], v220 offset:32768
    v_mfma_f32_16x16x32_bf16 v[48:51], v[148:151], a[80:83], v[48:51]
    ds_read_b64_tr_b16 v[130:131], v220 offset:34816
    v_mfma_f32_16x16x32_bf16 v[52:55], v[144:147], a[68:71], v[52:55]
    ds_read_b64_tr_b16 v[132:133], v220 offset:40960
    v_mfma_f32_16x16x32_bf16 v[52:55], v[148:151], a[84:87], v[52:55]
    ds_read_b64_tr_b16 v[134:135], v220 offset:43008
    v_mfma_f32_16x16x32_bf16 v[80:83], v[144:147], a[72:75], v[80:83]
    ds_read_b64_tr_b16 v[136:137], v221 offset:32768
    v_mfma_f32_16x16x32_bf16 v[80:83], v[148:151], a[88:91], v[80:83]
    ds_read_b64_tr_b16 v[138:139], v221 offset:34816
    v_mfma_f32_16x16x32_bf16 v[84:87], v[144:147], a[76:79], v[84:87]
    ds_read_b64_tr_b16 v[140:141], v221 offset:40960
    v_mfma_f32_16x16x32_bf16 v[84:87], v[148:151], a[92:95], v[84:87]
    ds_read_b64_tr_b16 v[142:143], v221 offset:43008
    v_mfma_f32_16x16x32_bf16 v[56:59], v[152:155], a[64:67], v[56:59]
    buffer_load_dwordx4 a[48:51], v226, s[8:11], s35 offen offset:3072 sc1
    v_mfma_f32_16x16x32_bf16 v[56:59], v[156:159], a[80:83], v[56:59]
    v_mfma_f32_16x16x32_bf16 v[60:63], v[152:155], a[68:71], v[60:63]
    buffer_load_dwordx4 a[52:55], v227, s[8:11], s35 offen offset:3072 sc1
    v_mfma_f32_16x16x32_bf16 v[60:63], v[156:159], a[84:87], v[60:63]
    v_mfma_f32_16x16x32_bf16 v[88:91], v[152:155], a[72:75], v[88:91]
    buffer_load_dwordx4 a[56:59], v245, s[8:11], s35 offen offset:3072 sc1
    v_mfma_f32_16x16x32_bf16 v[88:91], v[156:159], a[88:91], v[88:91]
    v_mfma_f32_16x16x32_bf16 v[92:95], v[152:155], a[76:79], v[92:95]
    buffer_load_dwordx4 a[132:135], v228, s[8:11], s33 offen offset:1024 sc1
    v_mfma_f32_16x16x32_bf16 v[92:95], v[156:159], a[92:95], v[92:95]
    buffer_load_dwordx4 a[60:63], v246, s[8:11], s35 offen offset:3072 sc1
    s_waitcnt lgkmcnt(0)
    v_mfma_f32_16x16x32_bf16 v[0:3], v[128:131], a[64:67], v[0:3]
    ds_read_b64_tr_b16 v[144:145], v222 offset:32768
    v_mfma_f32_16x16x32_bf16 v[0:3], v[132:135], a[80:83], v[0:3]
    ds_read_b64_tr_b16 v[146:147], v222 offset:34816
    v_mfma_f32_16x16x32_bf16 v[4:7], v[128:131], a[68:71], v[4:7]
    ds_read_b64_tr_b16 v[148:149], v222 offset:40960
    v_mfma_f32_16x16x32_bf16 v[4:7], v[132:135], a[84:87], v[4:7]
    ds_read_b64_tr_b16 v[150:151], v222 offset:43008
    v_mfma_f32_16x16x32_bf16 v[96:99], v[128:131], a[72:75], v[96:99]
    ds_read_b64_tr_b16 v[152:153], v223 offset:32768
    v_mfma_f32_16x16x32_bf16 v[96:99], v[132:135], a[88:91], v[96:99]
    ds_read_b64_tr_b16 v[154:155], v223 offset:34816
    v_mfma_f32_16x16x32_bf16 v[100:103], v[128:131], a[76:79], v[100:103]
    ds_read_b64_tr_b16 v[156:157], v223 offset:40960
    v_mfma_f32_16x16x32_bf16 v[100:103], v[132:135], a[92:95], v[100:103]
    ds_read_b64_tr_b16 v[158:159], v223 offset:43008
    v_mfma_f32_16x16x32_bf16 v[8:11], v[136:139], a[64:67], v[8:11]
    v_mfma_f32_16x16x32_bf16 v[8:11], v[140:143], a[80:83], v[8:11]
    s_add_u32 m0, s38, 73728
    s_add_u32 s32, s37, 1638400
    v_mfma_f32_16x16x32_bf16 v[12:15], v[136:139], a[68:71], v[12:15]
    buffer_load_dwordx4 v224, s[12:15], s32 offen lds
    v_mfma_f32_16x16x32_bf16 v[12:15], v[140:143], a[84:87], v[12:15]
    v_mfma_f32_16x16x32_bf16 v[104:107], v[136:139], a[72:75], v[104:107]
    v_mfma_f32_16x16x32_bf16 v[104:107], v[140:143], a[88:91], v[104:107]
    buffer_load_dwordx4 v225, s[12:15], s32 offen offset:1024 lds
    v_mfma_f32_16x16x32_bf16 v[108:111], v[136:139], a[76:79], v[108:111]
    buffer_load_dwordx4 a[136:139], v228, s[8:11], s33 offen offset:2048 sc1
    v_mfma_f32_16x16x32_bf16 v[108:111], v[140:143], a[92:95], v[108:111]
    s_waitcnt lgkmcnt(0)
    v_mfma_f32_16x16x32_bf16 v[16:19], v[144:147], a[64:67], v[16:19]
    ds_read_b64_tr_b16 v[128:129], v216 offset:49152
    v_mfma_f32_16x16x32_bf16 v[16:19], v[148:151], a[80:83], v[16:19]
    ds_read_b64_tr_b16 v[130:131], v216 offset:51200
    v_mfma_f32_16x16x32_bf16 v[20:23], v[144:147], a[68:71], v[20:23]
    ds_read_b64_tr_b16 v[132:133], v216 offset:57344
    v_mfma_f32_16x16x32_bf16 v[20:23], v[148:151], a[84:87], v[20:23]
    ds_read_b64_tr_b16 v[134:135], v216 offset:59392
    v_mfma_f32_16x16x32_bf16 v[112:115], v[144:147], a[72:75], v[112:115]
    ds_read_b64_tr_b16 v[136:137], v217 offset:49152
    v_mfma_f32_16x16x32_bf16 v[112:115], v[148:151], a[88:91], v[112:115]
    ds_read_b64_tr_b16 v[138:139], v217 offset:51200
    v_mfma_f32_16x16x32_bf16 v[116:119], v[144:147], a[76:79], v[116:119]
    ds_read_b64_tr_b16 v[140:141], v217 offset:57344
    v_mfma_f32_16x16x32_bf16 v[116:119], v[148:151], a[92:95], v[116:119]
    ds_read_b64_tr_b16 v[142:143], v217 offset:59392
    v_mfma_f32_16x16x32_bf16 v[24:27], v[152:155], a[64:67], v[24:27]
    v_mfma_f32_16x16x32_bf16 v[24:27], v[156:159], a[80:83], v[24:27]
    v_mfma_f32_16x16x32_bf16 v[28:31], v[152:155], a[68:71], v[28:31]
    v_mfma_f32_16x16x32_bf16 v[28:31], v[156:159], a[84:87], v[28:31]
    v_mfma_f32_16x16x32_bf16 v[120:123], v[152:155], a[72:75], v[120:123]
    v_mfma_f32_16x16x32_bf16 v[120:123], v[156:159], a[88:91], v[120:123]
    v_mfma_f32_16x16x32_bf16 v[124:127], v[152:155], a[76:79], v[124:127]
    buffer_load_dwordx4 a[140:143], v228, s[8:11], s33 offen offset:3072 sc1
    v_mfma_f32_16x16x32_bf16 v[124:127], v[156:159], a[92:95], v[124:127]
    s_add_u32 s35, s35, 4096
    buffer_load_dwordx4 a[224:227], v226, s[8:11], s35 offen offset:0 sc1
    s_waitcnt vmcnt(29) lgkmcnt(0)
    v_mfma_f32_16x16x32_bf16 v[32:35], v[128:131], a[96:99], v[32:35]
    ds_read_b64_tr_b16 v[144:145], v218 offset:49152
    v_mfma_f32_16x16x32_bf16 v[32:35], v[132:135], a[112:115], v[32:35]
    ds_read_b64_tr_b16 v[146:147], v218 offset:51200
    v_mfma_f32_16x16x32_bf16 v[36:39], v[128:131], a[100:103], v[36:39]
    ds_read_b64_tr_b16 v[148:149], v218 offset:57344
    v_mfma_f32_16x16x32_bf16 v[36:39], v[132:135], a[116:119], v[36:39]
    ds_read_b64_tr_b16 v[150:151], v218 offset:59392
    v_mfma_f32_16x16x32_bf16 v[64:67], v[128:131], a[104:107], v[64:67]
    ds_read_b64_tr_b16 v[152:153], v219 offset:49152
    v_mfma_f32_16x16x32_bf16 v[64:67], v[132:135], a[120:123], v[64:67]
    ds_read_b64_tr_b16 v[154:155], v219 offset:51200
    v_mfma_f32_16x16x32_bf16 v[68:71], v[128:131], a[108:111], v[68:71]
    ds_read_b64_tr_b16 v[156:157], v219 offset:57344
    v_mfma_f32_16x16x32_bf16 v[68:71], v[132:135], a[124:127], v[68:71]
    ds_read_b64_tr_b16 v[158:159], v219 offset:59392
    v_mfma_f32_16x16x32_bf16 v[40:43], v[136:139], a[96:99], v[40:43]
    buffer_load_dwordx4 a[228:231], v227, s[8:11], s35 offen offset:0 sc1
    v_mfma_f32_16x16x32_bf16 v[40:43], v[140:143], a[112:115], v[40:43]
    s_add_u32 m0, s38, 81920
    s_add_u32 s32, s37, 1703936
    v_mfma_f32_16x16x32_bf16 v[44:47], v[136:139], a[100:103], v[44:47]
    buffer_load_dwordx4 v224, s[12:15], s32 offen lds
    v_mfma_f32_16x16x32_bf16 v[44:47], v[140:143], a[116:119], v[44:47]
    buffer_load_dwordx4 a[72:75], v245, s[8:11], s35 offen offset:0 sc1
    v_mfma_f32_16x16x32_bf16 v[72:75], v[136:139], a[104:107], v[72:75]
    v_mfma_f32_16x16x32_bf16 v[72:75], v[140:143], a[120:123], v[72:75]
    buffer_load_dwordx4 v225, s[12:15], s32 offen offset:1024 lds
    v_mfma_f32_16x16x32_bf16 v[76:79], v[136:139], a[108:111], v[76:79]
    s_add_u32 s33, s55, 4096
    buffer_load_dwordx4 a[144:147], v228, s[8:11], s33 offen offset:0 sc1
    v_mfma_f32_16x16x32_bf16 v[76:79], v[140:143], a[124:127], v[76:79]
    buffer_load_dwordx4 a[76:79], v246, s[8:11], s35 offen offset:0 sc1
    s_waitcnt lgkmcnt(0)
    v_mfma_f32_16x16x32_bf16 v[48:51], v[144:147], a[96:99], v[48:51]
    ds_read_b64_tr_b16 v[128:129], v220 offset:49152
    v_mfma_f32_16x16x32_bf16 v[48:51], v[148:151], a[112:115], v[48:51]
    ds_read_b64_tr_b16 v[130:131], v220 offset:51200
    v_mfma_f32_16x16x32_bf16 v[52:55], v[144:147], a[100:103], v[52:55]
    ds_read_b64_tr_b16 v[132:133], v220 offset:57344
    v_mfma_f32_16x16x32_bf16 v[52:55], v[148:151], a[116:119], v[52:55]
    ds_read_b64_tr_b16 v[134:135], v220 offset:59392
    v_mfma_f32_16x16x32_bf16 v[80:83], v[144:147], a[104:107], v[80:83]
    ds_read_b64_tr_b16 v[136:137], v221 offset:49152
    v_mfma_f32_16x16x32_bf16 v[80:83], v[148:151], a[120:123], v[80:83]
    ds_read_b64_tr_b16 v[138:139], v221 offset:51200
    v_mfma_f32_16x16x32_bf16 v[84:87], v[144:147], a[108:111], v[84:87]
    ds_read_b64_tr_b16 v[140:141], v221 offset:57344
    v_mfma_f32_16x16x32_bf16 v[84:87], v[148:151], a[124:127], v[84:87]
    ds_read_b64_tr_b16 v[142:143], v221 offset:59392
    v_mfma_f32_16x16x32_bf16 v[56:59], v[152:155], a[96:99], v[56:59]
    buffer_load_dwordx4 a[232:235], v226, s[8:11], s35 offen offset:1024 sc1
    v_mfma_f32_16x16x32_bf16 v[56:59], v[156:159], a[112:115], v[56:59]
    v_mfma_f32_16x16x32_bf16 v[60:63], v[152:155], a[100:103], v[60:63]
    buffer_load_dwordx4 a[236:239], v227, s[8:11], s35 offen offset:1024 sc1
    v_mfma_f32_16x16x32_bf16 v[60:63], v[156:159], a[116:119], v[60:63]
    v_mfma_f32_16x16x32_bf16 v[88:91], v[152:155], a[104:107], v[88:91]
    buffer_load_dwordx4 a[88:91], v245, s[8:11], s35 offen offset:1024 sc1
    v_mfma_f32_16x16x32_bf16 v[88:91], v[156:159], a[120:123], v[88:91]
    v_mfma_f32_16x16x32_bf16 v[92:95], v[152:155], a[108:111], v[92:95]
    buffer_load_dwordx4 a[148:151], v228, s[8:11], s33 offen offset:1024 sc1
    v_mfma_f32_16x16x32_bf16 v[92:95], v[156:159], a[124:127], v[92:95]
    buffer_load_dwordx4 a[92:95], v246, s[8:11], s35 offen offset:1024 sc1
    s_waitcnt lgkmcnt(0)
    v_mfma_f32_16x16x32_bf16 v[0:3], v[128:131], a[96:99], v[0:3]
    ds_read_b64_tr_b16 v[144:145], v222 offset:49152
    v_mfma_f32_16x16x32_bf16 v[0:3], v[132:135], a[112:115], v[0:3]
    ds_read_b64_tr_b16 v[146:147], v222 offset:51200
    v_mfma_f32_16x16x32_bf16 v[4:7], v[128:131], a[100:103], v[4:7]
    ds_read_b64_tr_b16 v[148:149], v222 offset:57344
    v_mfma_f32_16x16x32_bf16 v[4:7], v[132:135], a[116:119], v[4:7]
    ds_read_b64_tr_b16 v[150:151], v222 offset:59392
    v_mfma_f32_16x16x32_bf16 v[96:99], v[128:131], a[104:107], v[96:99]
    ds_read_b64_tr_b16 v[152:153], v223 offset:49152
    v_mfma_f32_16x16x32_bf16 v[96:99], v[132:135], a[120:123], v[96:99]
    ds_read_b64_tr_b16 v[154:155], v223 offset:51200
    v_mfma_f32_16x16x32_bf16 v[100:103], v[128:131], a[108:111], v[100:103]
    ds_read_b64_tr_b16 v[156:157], v223 offset:57344
    v_mfma_f32_16x16x32_bf16 v[100:103], v[132:135], a[124:127], v[100:103]
    ds_read_b64_tr_b16 v[158:159], v223 offset:59392
    v_mfma_f32_16x16x32_bf16 v[8:11], v[136:139], a[96:99], v[8:11]
    v_mfma_f32_16x16x32_bf16 v[8:11], v[140:143], a[112:115], v[8:11]
    s_add_u32 m0, s38, 90112
    s_add_u32 s32, s37, 1769472
    v_mfma_f32_16x16x32_bf16 v[12:15], v[136:139], a[100:103], v[12:15]
    buffer_load_dwordx4 v224, s[12:15], s32 offen lds
    v_mfma_f32_16x16x32_bf16 v[12:15], v[140:143], a[116:119], v[12:15]
    v_mfma_f32_16x16x32_bf16 v[104:107], v[136:139], a[104:107], v[104:107]
    v_mfma_f32_16x16x32_bf16 v[104:107], v[140:143], a[120:123], v[104:107]
    buffer_load_dwordx4 v225, s[12:15], s32 offen offset:1024 lds
    v_mfma_f32_16x16x32_bf16 v[108:111], v[136:139], a[108:111], v[108:111]
    buffer_load_dwordx4 a[152:155], v228, s[8:11], s33 offen offset:2048 sc1
    v_mfma_f32_16x16x32_bf16 v[108:111], v[140:143], a[124:127], v[108:111]
    s_waitcnt vmcnt(60) lgkmcnt(0)
    s_barrier
    v_mfma_f32_16x16x32_bf16 v[16:19], v[144:147], a[96:99], v[16:19]
    v_xor_b32 v216, 0x10000, v216
    ds_read_b64_tr_b16 v[128:129], v216 offset:0
    v_mfma_f32_16x16x32_bf16 v[16:19], v[148:151], a[112:115], v[16:19]
    ds_read_b64_tr_b16 v[130:131], v216 offset:2048
    v_mfma_f32_16x16x32_bf16 v[20:23], v[144:147], a[100:103], v[20:23]
    ds_read_b64_tr_b16 v[132:133], v216 offset:8192
    v_mfma_f32_16x16x32_bf16 v[20:23], v[148:151], a[116:119], v[20:23]
    ds_read_b64_tr_b16 v[134:135], v216 offset:10240
    v_mfma_f32_16x16x32_bf16 v[112:115], v[144:147], a[104:107], v[112:115]
    v_xor_b32 v217, 0x10000, v217
    ds_read_b64_tr_b16 v[136:137], v217 offset:0
    v_mfma_f32_16x16x32_bf16 v[112:115], v[148:151], a[120:123], v[112:115]
    ds_read_b64_tr_b16 v[138:139], v217 offset:2048
    v_mfma_f32_16x16x32_bf16 v[116:119], v[144:147], a[108:111], v[116:119]
    ds_read_b64_tr_b16 v[140:141], v217 offset:8192
    v_mfma_f32_16x16x32_bf16 v[116:119], v[148:151], a[124:127], v[116:119]
    ds_read_b64_tr_b16 v[142:143], v217 offset:10240
    v_mfma_f32_16x16x32_bf16 v[24:27], v[152:155], a[96:99], v[24:27]
    v_mfma_f32_16x16x32_bf16 v[24:27], v[156:159], a[112:115], v[24:27]
    v_mfma_f32_16x16x32_bf16 v[28:31], v[152:155], a[100:103], v[28:31]
    v_mfma_f32_16x16x32_bf16 v[28:31], v[156:159], a[116:119], v[28:31]
    v_mfma_f32_16x16x32_bf16 v[120:123], v[152:155], a[104:107], v[120:123]
    v_mfma_f32_16x16x32_bf16 v[120:123], v[156:159], a[120:123], v[120:123]
    v_mfma_f32_16x16x32_bf16 v[124:127], v[152:155], a[108:111], v[124:127]
    buffer_load_dwordx4 a[156:159], v228, s[8:11], s33 offen offset:3072 sc1
    v_mfma_f32_16x16x32_bf16 v[124:127], v[156:159], a[124:127], v[124:127]
    buffer_load_dwordx4 a[240:243], v226, s[8:11], s35 offen offset:2048 sc1
    s_waitcnt vmcnt(34) lgkmcnt(0)
    v_mfma_f32_16x16x32_bf16 v[32:35], v[128:131], a[0:3], v[32:35]
    v_xor_b32 v218, 0x10000, v218
    ds_read_b64_tr_b16 v[144:145], v218 offset:0
    v_mfma_f32_16x16x32_bf16 v[32:35], v[132:135], a[16:19], v[32:35]
    ds_read_b64_tr_b16 v[146:147], v218 offset:2048
    v_mfma_f32_16x16x32_bf16 v[36:39], v[128:131], a[4:7], v[36:39]
    ds_read_b64_tr_b16 v[148:149], v218 offset:8192
    v_mfma_f32_16x16x32_bf16 v[36:39], v[132:135], a[20:23], v[36:39]
    ds_read_b64_tr_b16 v[150:151], v218 offset:10240
    v_mfma_f32_16x16x32_bf16 v[64:67], v[128:131], a[8:11], v[64:67]
    v_xor_b32 v219, 0x10000, v219
    ds_read_b64_tr_b16 v[152:153], v219 offset:0
    v_mfma_f32_16x16x32_bf16 v[64:67], v[132:135], a[24:27], v[64:67]
    ds_read_b64_tr_b16 v[154:155], v219 offset:2048
    v_mfma_f32_16x16x32_bf16 v[68:71], v[128:131], a[12:15], v[68:71]
    ds_read_b64_tr_b16 v[156:157], v219 offset:8192
    v_mfma_f32_16x16x32_bf16 v[68:71], v[132:135], a[28:31], v[68:71]
    ds_read_b64_tr_b16 v[158:159], v219 offset:10240
    v_mfma_f32_16x16x32_bf16 v[40:43], v[136:139], a[0:3], v[40:43]
    buffer_load_dwordx4 a[244:247], v227, s[8:11], s35 offen offset:2048 sc1
    v_mfma_f32_16x16x32_bf16 v[40:43], v[140:143], a[16:19], v[40:43]
    s_add_u32 m0, s38, 98304
    s_add_u32 s32, s37, 1835008
    v_mfma_f32_16x16x32_bf16 v[44:47], v[136:139], a[4:7], v[44:47]
    buffer_load_dwordx4 v224, s[12:15], s32 offen lds
    v_mfma_f32_16x16x32_bf16 v[44:47], v[140:143], a[20:23], v[44:47]
    buffer_load_dwordx4 a[104:107], v245, s[8:11], s35 offen offset:2048 sc1
    v_mfma_f32_16x16x32_bf16 v[72:75], v[136:139], a[8:11], v[72:75]
    v_mfma_f32_16x16x32_bf16 v[72:75], v[140:143], a[24:27], v[72:75]
    buffer_load_dwordx4 v225, s[12:15], s32 offen offset:1024 lds
    v_mfma_f32_16x16x32_bf16 v[76:79], v[136:139], a[12:15], v[76:79]
    s_add_u32 s33, s55, 32768
    buffer_load_dwordx4 a[160:163], v228, s[8:11], s33 offen offset:0 sc1
    v_mfma_f32_16x16x32_bf16 v[76:79], v[140:143], a[28:31], v[76:79]
    buffer_load_dwordx4 a[108:111], v246, s[8:11], s35 offen offset:2048 sc1
    s_waitcnt lgkmcnt(0)
    v_mfma_f32_16x16x32_bf16 v[48:51], v[144:147], a[0:3], v[48:51]
    v_xor_b32 v220, 0x10000, v220
    ds_read_b64_tr_b16 v[128:129], v220 offset:0
    v_mfma_f32_16x16x32_bf16 v[48:51], v[148:151], a[16:19], v[48:51]
    ds_read_b64_tr_b16 v[130:131], v220 offset:2048
    v_mfma_f32_16x16x32_bf16 v[52:55], v[144:147], a[4:7], v[52:55]
    ds_read_b64_tr_b16 v[132:133], v220 offset:8192
    v_mfma_f32_16x16x32_bf16 v[52:55], v[148:151], a[20:23], v[52:55]
    ds_read_b64_tr_b16 v[134:135], v220 offset:10240
    v_mfma_f32_16x16x32_bf16 v[80:83], v[144:147], a[8:11], v[80:83]
    v_xor_b32 v221, 0x10000, v221
    ds_read_b64_tr_b16 v[136:137], v221 offset:0
    v_mfma_f32_16x16x32_bf16 v[80:83], v[148:151], a[24:27], v[80:83]
    ds_read_b64_tr_b16 v[138:139], v221 offset:2048
    v_mfma_f32_16x16x32_bf16 v[84:87], v[144:147], a[12:15], v[84:87]
    ds_read_b64_tr_b16 v[140:141], v221 offset:8192
    v_mfma_f32_16x16x32_bf16 v[84:87], v[148:151], a[28:31], v[84:87]
    ds_read_b64_tr_b16 v[142:143], v221 offset:10240
    v_mfma_f32_16x16x32_bf16 v[56:59], v[152:155], a[0:3], v[56:59]
    buffer_load_dwordx4 a[248:251], v226, s[8:11], s35 offen offset:3072 sc1
    v_mfma_f32_16x16x32_bf16 v[56:59], v[156:159], a[16:19], v[56:59]
    v_mfma_f32_16x16x32_bf16 v[60:63], v[152:155], a[4:7], v[60:63]
    buffer_load_dwordx4 a[252:255], v227, s[8:11], s35 offen offset:3072 sc1
    v_mfma_f32_16x16x32_bf16 v[60:63], v[156:159], a[20:23], v[60:63]
    v_mfma_f32_16x16x32_bf16 v[88:91], v[152:155], a[8:11], v[88:91]
    buffer_load_dwordx4 a[120:123], v245, s[8:11], s35 offen offset:3072 sc1
    v_mfma_f32_16x16x32_bf16 v[88:91], v[156:159], a[24:27], v[88:91]
    v_mfma_f32_16x16x32_bf16 v[92:95], v[152:155], a[12:15], v[92:95]
    buffer_load_dwordx4 a[164:167], v228, s[8:11], s33 offen offset:1024 sc1
    v_mfma_f32_16x16x32_bf16 v[92:95], v[156:159], a[28:31], v[92:95]
    buffer_load_dwordx4 a[124:127], v246, s[8:11], s35 offen offset:3072 sc1
    s_waitcnt lgkmcnt(0)
    v_mfma_f32_16x16x32_bf16 v[0:3], v[128:131], a[0:3], v[0:3]
    v_xor_b32 v222, 0x10000, v222
    ds_read_b64_tr_b16 v[144:145], v222 offset:0
    v_mfma_f32_16x16x32_bf16 v[0:3], v[132:135], a[16:19], v[0:3]
    ds_read_b64_tr_b16 v[146:147], v222 offset:2048
    v_mfma_f32_16x16x32_bf16 v[4:7], v[128:131], a[4:7], v[4:7]
    ds_read_b64_tr_b16 v[148:149], v222 offset:8192
    v_mfma_f32_16x16x32_bf16 v[4:7], v[132:135], a[20:23], v[4:7]
    ds_read_b64_tr_b16 v[150:151], v222 offset:10240
    v_mfma_f32_16x16x32_bf16 v[96:99], v[128:131], a[8:11], v[96:99]
    v_xor_b32 v223, 0x10000, v223
    ds_read_b64_tr_b16 v[152:153], v223 offset:0
    v_mfma_f32_16x16x32_bf16 v[96:99], v[132:135], a[24:27], v[96:99]
    ds_read_b64_tr_b16 v[154:155], v223 offset:2048
    v_mfma_f32_16x16x32_bf16 v[100:103], v[128:131], a[12:15], v[100:103]
    ds_read_b64_tr_b16 v[156:157], v223 offset:8192
    v_mfma_f32_16x16x32_bf16 v[100:103], v[132:135], a[28:31], v[100:103]
    ds_read_b64_tr_b16 v[158:159], v223 offset:10240
    v_mfma_f32_16x16x32_bf16 v[8:11], v[136:139], a[0:3], v[8:11]
    v_mfma_f32_16x16x32_bf16 v[8:11], v[140:143], a[16:19], v[8:11]
    s_add_u32 m0, s38, 106496
    s_add_u32 s32, s37, 1900544
    v_mfma_f32_16x16x32_bf16 v[12:15], v[136:139], a[4:7], v[12:15]
    buffer_load_dwordx4 v224, s[12:15], s32 offen lds
    v_mfma_f32_16x16x32_bf16 v[12:15], v[140:143], a[20:23], v[12:15]
    v_mfma_f32_16x16x32_bf16 v[104:107], v[136:139], a[8:11], v[104:107]
    v_mfma_f32_16x16x32_bf16 v[104:107], v[140:143], a[24:27], v[104:107]
    buffer_load_dwordx4 v225, s[12:15], s32 offen offset:1024 lds
    v_mfma_f32_16x16x32_bf16 v[108:111], v[136:139], a[12:15], v[108:111]
    buffer_load_dwordx4 a[168:171], v228, s[8:11], s33 offen offset:2048 sc1
    v_mfma_f32_16x16x32_bf16 v[108:111], v[140:143], a[28:31], v[108:111]
    s_waitcnt lgkmcnt(0)
    v_mfma_f32_16x16x32_bf16 v[16:19], v[144:147], a[0:3], v[16:19]
    ds_read_b64_tr_b16 v[128:129], v216 offset:16384
    v_mfma_f32_16x16x32_bf16 v[16:19], v[148:151], a[16:19], v[16:19]
    ds_read_b64_tr_b16 v[130:131], v216 offset:18432
    v_mfma_f32_16x16x32_bf16 v[20:23], v[144:147], a[4:7], v[20:23]
    ds_read_b64_tr_b16 v[132:133], v216 offset:24576
    v_mfma_f32_16x16x32_bf16 v[20:23], v[148:151], a[20:23], v[20:23]
    ds_read_b64_tr_b16 v[134:135], v216 offset:26624
    v_mfma_f32_16x16x32_bf16 v[112:115], v[144:147], a[8:11], v[112:115]
    ds_read_b64_tr_b16 v[136:137], v217 offset:16384
    v_mfma_f32_16x16x32_bf16 v[112:115], v[148:151], a[24:27], v[112:115]
    ds_read_b64_tr_b16 v[138:139], v217 offset:18432
    v_mfma_f32_16x16x32_bf16 v[116:119], v[144:147], a[12:15], v[116:119]
    ds_read_b64_tr_b16 v[140:141], v217 offset:24576
    v_mfma_f32_16x16x32_bf16 v[116:119], v[148:151], a[28:31], v[116:119]
    ds_read_b64_tr_b16 v[142:143], v217 offset:26624
    v_mfma_f32_16x16x32_bf16 v[24:27], v[152:155], a[0:3], v[24:27]
    v_mfma_f32_16x16x32_bf16 v[24:27], v[156:159], a[16:19], v[24:27]
    v_mfma_f32_16x16x32_bf16 v[28:31], v[152:155], a[4:7], v[28:31]
    v_mfma_f32_16x16x32_bf16 v[28:31], v[156:159], a[20:23], v[28:31]
    v_mfma_f32_16x16x32_bf16 v[120:123], v[152:155], a[8:11], v[120:123]
    v_mfma_f32_16x16x32_bf16 v[120:123], v[156:159], a[24:27], v[120:123]
    v_mfma_f32_16x16x32_bf16 v[124:127], v[152:155], a[12:15], v[124:127]
    buffer_load_dwordx4 a[172:175], v228, s[8:11], s33 offen offset:3072 sc1
    v_mfma_f32_16x16x32_bf16 v[124:127], v[156:159], a[28:31], v[124:127]
    s_add_u32 s35, s35, 4096
    buffer_load_dwordx4 a[0:3], v226, s[8:11], s35 offen offset:0 sc1
    s_waitcnt vmcnt(37) lgkmcnt(0)
    v_mfma_f32_16x16x32_bf16 v[32:35], v[128:131], a[32:35], v[32:35]
    ds_read_b64_tr_b16 v[144:145], v218 offset:16384
    v_mfma_f32_16x16x32_bf16 v[32:35], v[132:135], a[48:51], v[32:35]
    ds_read_b64_tr_b16 v[146:147], v218 offset:18432
    v_mfma_f32_16x16x32_bf16 v[36:39], v[128:131], a[36:39], v[36:39]
    ds_read_b64_tr_b16 v[148:149], v218 offset:24576
    v_mfma_f32_16x16x32_bf16 v[36:39], v[132:135], a[52:55], v[36:39]
    ds_read_b64_tr_b16 v[150:151], v218 offset:26624
    v_mfma_f32_16x16x32_bf16 v[64:67], v[128:131], a[40:43], v[64:67]
    ds_read_b64_tr_b16 v[152:153], v219 offset:16384
    v_mfma_f32_16x16x32_bf16 v[64:67], v[132:135], a[56:59], v[64:67]
    ds_read_b64_tr_b16 v[154:155], v219 offset:18432
    v_mfma_f32_16x16x32_bf16 v[68:71], v[128:131], a[44:47], v[68:71]
    ds_read_b64_tr_b16 v[156:157], v219 offset:24576
    v_mfma_f32_16x16x32_bf16 v[68:71], v[132:135], a[60:63], v[68:71]
    ds_read_b64_tr_b16 v[158:159], v219 offset:26624
    v_mfma_f32_16x16x32_bf16 v[40:43], v[136:139], a[32:35], v[40:43]
    buffer_load_dwordx4 a[4:7], v227, s[8:11], s35 offen offset:0 sc1
    v_mfma_f32_16x16x32_bf16 v[40:43], v[140:143], a[48:51], v[40:43]
    s_add_u32 m0, s38, 114688
    s_add_u32 s32, s37, 1966080
    v_mfma_f32_16x16x32_bf16 v[44:47], v[136:139], a[36:39], v[44:47]
    buffer_load_dwordx4 v224, s[12:15], s32 offen lds
    v_mfma_f32_16x16x32_bf16 v[44:47], v[140:143], a[52:55], v[44:47]
    buffer_load_dwordx4 a[8:11], v245, s[8:11], s35 offen offset:0 sc1
    v_mfma_f32_16x16x32_bf16 v[72:75], v[136:139], a[40:43], v[72:75]
    v_mfma_f32_16x16x32_bf16 v[72:75], v[140:143], a[56:59], v[72:75]
    buffer_load_dwordx4 v225, s[12:15], s32 offen offset:1024 lds
    v_mfma_f32_16x16x32_bf16 v[76:79], v[136:139], a[44:47], v[76:79]
    s_add_u32 s33, s55, 36864
    buffer_load_dwordx4 a[176:179], v228, s[8:11], s33 offen offset:0 sc1
    v_mfma_f32_16x16x32_bf16 v[76:79], v[140:143], a[60:63], v[76:79]
    buffer_load_dwordx4 a[12:15], v246, s[8:11], s35 offen offset:0 sc1
    s_waitcnt lgkmcnt(0)
    v_mfma_f32_16x16x32_bf16 v[48:51], v[144:147], a[32:35], v[48:51]
    ds_read_b64_tr_b16 v[128:129], v220 offset:16384
    v_mfma_f32_16x16x32_bf16 v[48:51], v[148:151], a[48:51], v[48:51]
    ds_read_b64_tr_b16 v[130:131], v220 offset:18432
    v_mfma_f32_16x16x32_bf16 v[52:55], v[144:147], a[36:39], v[52:55]
    ds_read_b64_tr_b16 v[132:133], v220 offset:24576
    v_mfma_f32_16x16x32_bf16 v[52:55], v[148:151], a[52:55], v[52:55]
    ds_read_b64_tr_b16 v[134:135], v220 offset:26624
    v_mfma_f32_16x16x32_bf16 v[80:83], v[144:147], a[40:43], v[80:83]
    ds_read_b64_tr_b16 v[136:137], v221 offset:16384
    v_mfma_f32_16x16x32_bf16 v[80:83], v[148:151], a[56:59], v[80:83]
    ds_read_b64_tr_b16 v[138:139], v221 offset:18432
    v_mfma_f32_16x16x32_bf16 v[84:87], v[144:147], a[44:47], v[84:87]
    ds_read_b64_tr_b16 v[140:141], v221 offset:24576
    v_mfma_f32_16x16x32_bf16 v[84:87], v[148:151], a[60:63], v[84:87]
    ds_read_b64_tr_b16 v[142:143], v221 offset:26624
    v_mfma_f32_16x16x32_bf16 v[56:59], v[152:155], a[32:35], v[56:59]
    buffer_load_dwordx4 a[16:19], v226, s[8:11], s35 offen offset:1024 sc1
    v_mfma_f32_16x16x32_bf16 v[56:59], v[156:159], a[48:51], v[56:59]
    v_mfma_f32_16x16x32_bf16 v[60:63], v[152:155], a[36:39], v[60:63]
    buffer_load_dwordx4 a[20:23], v227, s[8:11], s35 offen offset:1024 sc1
    v_mfma_f32_16x16x32_bf16 v[60:63], v[156:159], a[52:55], v[60:63]
    v_mfma_f32_16x16x32_bf16 v[88:91], v[152:155], a[40:43], v[88:91]
    buffer_load_dwordx4 a[24:27], v245, s[8:11], s35 offen offset:1024 sc1
    v_mfma_f32_16x16x32_bf16 v[88:91], v[156:159], a[56:59], v[88:91]
    v_mfma_f32_16x16x32_bf16 v[92:95], v[152:155], a[44:47], v[92:95]
    buffer_load_dwordx4 a[180:183], v228, s[8:11], s33 offen offset:1024 sc1
    v_mfma_f32_16x16x32_bf16 v[92:95], v[156:159], a[60:63], v[92:95]
    buffer_load_dwordx4 a[28:31], v246, s[8:11], s35 offen offset:1024 sc1
    s_waitcnt lgkmcnt(0)
    v_mfma_f32_16x16x32_bf16 v[0:3], v[128:131], a[32:35], v[0:3]
    ds_read_b64_tr_b16 v[144:145], v222 offset:16384
    v_mfma_f32_16x16x32_bf16 v[0:3], v[132:135], a[48:51], v[0:3]
    ds_read_b64_tr_b16 v[146:147], v222 offset:18432
    v_mfma_f32_16x16x32_bf16 v[4:7], v[128:131], a[36:39], v[4:7]
    ds_read_b64_tr_b16 v[148:149], v222 offset:24576
    v_mfma_f32_16x16x32_bf16 v[4:7], v[132:135], a[52:55], v[4:7]
    ds_read_b64_tr_b16 v[150:151], v222 offset:26624
    v_mfma_f32_16x16x32_bf16 v[96:99], v[128:131], a[40:43], v[96:99]
    ds_read_b64_tr_b16 v[152:153], v223 offset:16384
    v_mfma_f32_16x16x32_bf16 v[96:99], v[132:135], a[56:59], v[96:99]
    ds_read_b64_tr_b16 v[154:155], v223 offset:18432
    v_mfma_f32_16x16x32_bf16 v[100:103], v[128:131], a[44:47], v[100:103]
    ds_read_b64_tr_b16 v[156:157], v223 offset:24576
    v_mfma_f32_16x16x32_bf16 v[100:103], v[132:135], a[60:63], v[100:103]
    ds_read_b64_tr_b16 v[158:159], v223 offset:26624
    v_mfma_f32_16x16x32_bf16 v[8:11], v[136:139], a[32:35], v[8:11]
    v_mfma_f32_16x16x32_bf16 v[8:11], v[140:143], a[48:51], v[8:11]
    s_add_u32 m0, s38, 122880
    s_add_u32 s32, s37, 2031616
    v_mfma_f32_16x16x32_bf16 v[12:15], v[136:139], a[36:39], v[12:15]
    buffer_load_dwordx4 v224, s[12:15], s32 offen lds
    v_mfma_f32_16x16x32_bf16 v[12:15], v[140:143], a[52:55], v[12:15]
    v_mfma_f32_16x16x32_bf16 v[104:107], v[136:139], a[40:43], v[104:107]
    v_mfma_f32_16x16x32_bf16 v[104:107], v[140:143], a[56:59], v[104:107]
    buffer_load_dwordx4 v225, s[12:15], s32 offen offset:1024 lds
    v_mfma_f32_16x16x32_bf16 v[108:111], v[136:139], a[44:47], v[108:111]
    buffer_load_dwordx4 a[184:187], v228, s[8:11], s33 offen offset:2048 sc1
    v_mfma_f32_16x16x32_bf16 v[108:111], v[140:143], a[60:63], v[108:111]
    s_waitcnt vmcnt(63) lgkmcnt(0)
    s_barrier
    v_mfma_f32_16x16x32_bf16 v[16:19], v[144:147], a[32:35], v[16:19]
    ds_read_b64_tr_b16 v[128:129], v216 offset:32768
    v_mfma_f32_16x16x32_bf16 v[16:19], v[148:151], a[48:51], v[16:19]
    ds_read_b64_tr_b16 v[130:131], v216 offset:34816
    v_mfma_f32_16x16x32_bf16 v[20:23], v[144:147], a[36:39], v[20:23]
    ds_read_b64_tr_b16 v[132:133], v216 offset:40960
    v_mfma_f32_16x16x32_bf16 v[20:23], v[148:151], a[52:55], v[20:23]
    ds_read_b64_tr_b16 v[134:135], v216 offset:43008
    v_mfma_f32_16x16x32_bf16 v[112:115], v[144:147], a[40:43], v[112:115]
    ds_read_b64_tr_b16 v[136:137], v217 offset:32768
    v_mfma_f32_16x16x32_bf16 v[112:115], v[148:151], a[56:59], v[112:115]
    ds_read_b64_tr_b16 v[138:139], v217 offset:34816
    v_mfma_f32_16x16x32_bf16 v[116:119], v[144:147], a[44:47], v[116:119]
    ds_read_b64_tr_b16 v[140:141], v217 offset:40960
    v_mfma_f32_16x16x32_bf16 v[116:119], v[148:151], a[60:63], v[116:119]
    ds_read_b64_tr_b16 v[142:143], v217 offset:43008
    v_mfma_f32_16x16x32_bf16 v[24:27], v[152:155], a[32:35], v[24:27]
    v_mfma_f32_16x16x32_bf16 v[24:27], v[156:159], a[48:51], v[24:27]
    v_mfma_f32_16x16x32_bf16 v[28:31], v[152:155], a[36:39], v[28:31]
    v_mfma_f32_16x16x32_bf16 v[28:31], v[156:159], a[52:55], v[28:31]
    v_mfma_f32_16x16x32_bf16 v[120:123], v[152:155], a[40:43], v[120:123]
    v_mfma_f32_16x16x32_bf16 v[120:123], v[156:159], a[56:59], v[120:123]
    v_mfma_f32_16x16x32_bf16 v[124:127], v[152:155], a[44:47], v[124:127]
    buffer_load_dwordx4 a[188:191], v228, s[8:11], s33 offen offset:3072 sc1
    v_mfma_f32_16x16x32_bf16 v[124:127], v[156:159], a[60:63], v[124:127]
    buffer_load_dwordx4 a[32:35], v226, s[8:11], s35 offen offset:2048 sc1
    s_waitcnt vmcnt(37) lgkmcnt(0)
    v_mfma_f32_16x16x32_bf16 v[64:67], v[128:131], a[72:75], v[64:67]
    ds_read_b64_tr_b16 v[144:145], v218 offset:32768
    v_mfma_f32_16x16x32_bf16 v[64:67], v[132:135], a[88:91], v[64:67]
    ds_read_b64_tr_b16 v[146:147], v218 offset:34816
    v_mfma_f32_16x16x32_bf16 v[68:71], v[128:131], a[76:79], v[68:71]
    ds_read_b64_tr_b16 v[148:149], v218 offset:40960
    buffer_load_dwordx4 a[36:39], v227, s[8:11], s35 offen offset:2048 sc1
    v_mfma_f32_16x16x32_bf16 v[68:71], v[132:135], a[92:95], v[68:71]
    ds_read_b64_tr_b16 v[150:151], v218 offset:43008
    v_mfma_f32_16x16x32_bf16 v[72:75], v[136:139], a[72:75], v[72:75]
    ds_read_b64_tr_b16 v[152:153], v219 offset:32768
    v_mfma_f32_16x16x32_bf16 v[72:75], v[140:143], a[88:91], v[72:75]
    ds_read_b64_tr_b16 v[154:155], v219 offset:34816
    v_mfma_f32_16x16x32_bf16 v[76:79], v[136:139], a[76:79], v[76:79]
    ds_read_b64_tr_b16 v[156:157], v219 offset:40960
    buffer_load_dwordx4 a[40:43], v245, s[8:11], s35 offen offset:2048 sc1
    v_mfma_f32_16x16x32_bf16 v[76:79], v[140:143], a[92:95], v[76:79]
    ds_read_b64_tr_b16 v[158:159], v219 offset:43008
    s_waitcnt lgkmcnt(4)
    v_mfma_f32_16x16x32_bf16 v[80:83], v[144:147], a[72:75], v[80:83]
    ds_read_b64_tr_b16 v[128:129], v220 offset:32768
    v_mfma_f32_16x16x32_bf16 v[80:83], v[148:151], a[88:91], v[80:83]
    ds_read_b64_tr_b16 v[130:131], v220 offset:34816
    v_mfma_f32_16x16x32_bf16 v[84:87], v[144:147], a[76:79], v[84:87]
    ds_read_b64_tr_b16 v[132:133], v220 offset:40960
    buffer_load_dwordx4 a[44:47], v246, s[8:11], s35 offen offset:2048 sc1
    v_mfma_f32_16x16x32_bf16 v[84:87], v[148:151], a[92:95], v[84:87]
    ds_read_b64_tr_b16 v[134:135], v220 offset:43008
    s_waitcnt lgkmcnt(4)
    v_mfma_f32_16x16x32_bf16 v[88:91], v[152:155], a[72:75], v[88:91]
    ds_read_b64_tr_b16 v[136:137], v221 offset:32768
    v_mfma_f32_16x16x32_bf16 v[88:91], v[156:159], a[88:91], v[88:91]
    ds_read_b64_tr_b16 v[138:139], v221 offset:34816
    s_mov_b32 s32, 0
    buffer_load_dwordx4 v[192:195], v229, s[16:19], s32 offen
    v_mfma_f32_16x16x32_bf16 v[92:95], v[152:155], a[76:79], v[92:95]
    ds_read_b64_tr_b16 v[140:141], v221 offset:40960
    buffer_load_dwordx4 a[48:51], v226, s[8:11], s35 offen offset:3072 sc1
    v_mfma_f32_16x16x32_bf16 v[92:95], v[156:159], a[92:95], v[92:95]
    ds_read_b64_tr_b16 v[142:143], v221 offset:43008
    s_waitcnt lgkmcnt(4)
    v_mfma_f32_16x16x32_bf16 v[0:3], v[128:131], a[224:227], v[0:3]
    ds_read_b64_tr_b16 v[144:145], v222 offset:32768
    v_mfma_f32_16x16x32_bf16 v[0:3], v[132:135], a[232:235], v[0:3]
    ds_read_b64_tr_b16 v[146:147], v222 offset:34816
    v_mfma_f32_16x16x32_bf16 v[4:7], v[128:131], a[228:231], v[4:7]
    ds_read_b64_tr_b16 v[148:149], v222 offset:40960
    v_mfma_f32_16x16x32_bf16 v[4:7], v[132:135], a[236:239], v[4:7]
    ds_read_b64_tr_b16 v[150:151], v222 offset:43008
    v_mfma_f32_16x16x32_bf16 v[96:99], v[128:131], a[72:75], v[96:99]
    ds_read_b64_tr_b16 v[152:153], v223 offset:32768
    v_mfma_f32_16x16x32_bf16 v[96:99], v[132:135], a[88:91], v[96:99]
    ds_read_b64_tr_b16 v[154:155], v223 offset:34816
    s_mov_b32 s32, 16384
    buffer_load_dwordx4 v[196:199], v229, s[16:19], s32 offen
    v_mfma_f32_16x16x32_bf16 v[100:103], v[128:131], a[76:79], v[100:103]
    ds_read_b64_tr_b16 v[156:157], v223 offset:40960
    v_mfma_f32_16x16x32_bf16 v[100:103], v[132:135], a[92:95], v[100:103]
    ds_read_b64_tr_b16 v[158:159], v223 offset:43008
    s_waitcnt lgkmcnt(8)
    v_mfma_f32_16x16x32_bf16 v[8:11], v[136:139], a[224:227], v[8:11]
    buffer_load_dwordx4 a[52:55], v227, s[8:11], s35 offen offset:3072 sc1
    v_mfma_f32_16x16x32_bf16 v[8:11], v[140:143], a[232:235], v[8:11]
    v_mfma_f32_16x16x32_bf16 v[12:15], v[136:139], a[228:231], v[12:15]
    v_mfma_f32_16x16x32_bf16 v[12:15], v[140:143], a[236:239], v[12:15]
    buffer_load_dwordx4 a[56:59], v245, s[8:11], s35 offen offset:3072 sc1
    v_mfma_f32_16x16x32_bf16 v[104:107], v[136:139], a[72:75], v[104:107]
    v_mfma_f32_16x16x32_bf16 v[104:107], v[140:143], a[88:91], v[104:107]
    s_mov_b32 s32, 32768
    buffer_load_dwordx4 v[200:203], v229, s[16:19], s32 offen
    v_mfma_f32_16x16x32_bf16 v[108:111], v[136:139], a[76:79], v[108:111]
    v_mfma_f32_16x16x32_bf16 v[108:111], v[140:143], a[92:95], v[108:111]
    buffer_load_dwordx4 a[60:63], v246, s[8:11], s35 offen offset:3072 sc1
    s_waitcnt lgkmcnt(0)
    v_mfma_f32_16x16x32_bf16 v[16:19], v[144:147], a[224:227], v[16:19]
    ds_read_b64_tr_b16 v[128:129], v216 offset:49152
    v_mfma_f32_16x16x32_bf16 v[16:19], v[148:151], a[232:235], v[16:19]
    ds_read_b64_tr_b16 v[130:131], v216 offset:51200
    v_mfma_f32_16x16x32_bf16 v[20:23], v[144:147], a[228:231], v[20:23]
    ds_read_b64_tr_b16 v[132:133], v216 offset:57344
    v_mfma_f32_16x16x32_bf16 v[20:23], v[148:151], a[236:239], v[20:23]
    ds_read_b64_tr_b16 v[134:135], v216 offset:59392
    v_mfma_f32_16x16x32_bf16 v[112:115], v[144:147], a[72:75], v[112:115]
    ds_read_b64_tr_b16 v[136:137], v217 offset:49152
    v_mfma_f32_16x16x32_bf16 v[112:115], v[148:151], a[88:91], v[112:115]
    ds_read_b64_tr_b16 v[138:139], v217 offset:51200
    v_mfma_f32_16x16x32_bf16 v[116:119], v[144:147], a[76:79], v[116:119]
    ds_read_b64_tr_b16 v[140:141], v217 offset:57344
    v_mfma_f32_16x16x32_bf16 v[116:119], v[148:151], a[92:95], v[116:119]
    ds_read_b64_tr_b16 v[142:143], v217 offset:59392
    v_mfma_f32_16x16x32_bf16 v[24:27], v[152:155], a[224:227], v[24:27]
    v_mfma_f32_16x16x32_bf16 v[24:27], v[156:159], a[232:235], v[24:27]
    v_mfma_f32_16x16x32_bf16 v[28:31], v[152:155], a[228:231], v[28:31]
    v_mfma_f32_16x16x32_bf16 v[28:31], v[156:159], a[236:239], v[28:31]
    v_mfma_f32_16x16x32_bf16 v[120:123], v[152:155], a[72:75], v[120:123]
    v_mfma_f32_16x16x32_bf16 v[120:123], v[156:159], a[88:91], v[120:123]
    s_mov_b32 s32, 49152
    buffer_load_dwordx4 v[204:207], v229, s[16:19], s32 offen
    v_mfma_f32_16x16x32_bf16 v[124:127], v[152:155], a[76:79], v[124:127]
    v_mfma_f32_16x16x32_bf16 v[124:127], v[156:159], a[92:95], v[124:127]
    s_add_u32 s35, s35, 4096
    buffer_load_dwordx4 a[64:67], v226, s[8:11], s35 offen offset:0 sc1
    s_waitcnt vmcnt(33) lgkmcnt(0)
    v_mfma_f32_16x16x32_bf16 v[64:67], v[128:131], a[104:107], v[64:67]
    ds_read_b64_tr_b16 v[144:145], v218 offset:49152
    v_mfma_f32_16x16x32_bf16 v[64:67], v[132:135], a[120:123], v[64:67]
    ds_read_b64_tr_b16 v[146:147], v218 offset:51200
    v_mfma_f32_16x16x32_bf16 v[68:71], v[128:131], a[108:111], v[68:71]
    ds_read_b64_tr_b16 v[148:149], v218 offset:57344
    buffer_load_dwordx4 a[68:71], v227, s[8:11], s35 offen offset:0 sc1
    v_mfma_f32_16x16x32_bf16 v[68:71], v[132:135], a[124:127], v[68:71]
    ds_read_b64_tr_b16 v[150:151], v218 offset:59392
    v_mfma_f32_16x16x32_bf16 v[72:75], v[136:139], a[104:107], v[72:75]
    ds_read_b64_tr_b16 v[152:153], v219 offset:49152
    v_mfma_f32_16x16x32_bf16 v[72:75], v[140:143], a[120:123], v[72:75]
    ds_read_b64_tr_b16 v[154:155], v219 offset:51200
    v_mfma_f32_16x16x32_bf16 v[76:79], v[136:139], a[108:111], v[76:79]
    ds_read_b64_tr_b16 v[156:157], v219 offset:57344
    buffer_load_dwordx4 a[72:75], v245, s[8:11], s35 offen offset:0 sc1
    v_mfma_f32_16x16x32_bf16 v[76:79], v[140:143], a[124:127], v[76:79]
    ds_read_b64_tr_b16 v[158:159], v219 offset:59392
    s_waitcnt lgkmcnt(4)
    v_mfma_f32_16x16x32_bf16 v[80:83], v[144:147], a[104:107], v[80:83]
    ds_read_b64_tr_b16 v[128:129], v220 offset:49152
    v_mfma_f32_16x16x32_bf16 v[80:83], v[148:151], a[120:123], v[80:83]
    ds_read_b64_tr_b16 v[130:131], v220 offset:51200
    v_mfma_f32_16x16x32_bf16 v[84:87], v[144:147], a[108:111], v[84:87]
    ds_read_b64_tr_b16 v[132:133], v220 offset:57344
    buffer_load_dwordx4 a[76:79], v246, s[8:11], s35 offen offset:0 sc1
    v_mfma_f32_16x16x32_bf16 v[84:87], v[148:151], a[124:127], v[84:87]
    ds_read_b64_tr_b16 v[134:135], v220 offset:59392
    s_waitcnt lgkmcnt(4)
    v_mfma_f32_16x16x32_bf16 v[88:91], v[152:155], a[104:107], v[88:91]
    ds_read_b64_tr_b16 v[136:137], v221 offset:49152
    v_mfma_f32_16x16x32_bf16 v[88:91], v[156:159], a[120:123], v[88:91]
    ds_read_b64_tr_b16 v[138:139], v221 offset:51200
    buffer_load_dwordx4 v[208:211], v240, s[20:23], 0 offen
    v_mfma_f32_16x16x32_bf16 v[92:95], v[152:155], a[108:111], v[92:95]
    ds_read_b64_tr_b16 v[140:141], v221 offset:57344
    buffer_load_dwordx4 a[80:83], v226, s[8:11], s35 offen offset:1024 sc1
    v_mfma_f32_16x16x32_bf16 v[92:95], v[156:159], a[124:127], v[92:95]
    ds_read_b64_tr_b16 v[142:143], v221 offset:59392
    s_waitcnt lgkmcnt(4)
    v_mfma_f32_16x16x32_bf16 v[0:3], v[128:131], a[240:243], v[0:3]
    ds_read_b64_tr_b16 v[144:145], v222 offset:49152
    v_mfma_f32_16x16x32_bf16 v[0:3], v[132:135], a[248:251], v[0:3]
    ds_read_b64_tr_b16 v[146:147], v222 offset:51200
    v_mfma_f32_16x16x32_bf16 v[4:7], v[128:131], a[244:247], v[4:7]
    ds_read_b64_tr_b16 v[148:149], v222 offset:57344
    v_mfma_f32_16x16x32_bf16 v[4:7], v[132:135], a[252:255], v[4:7]
    ds_read_b64_tr_b16 v[150:151], v222 offset:59392
    v_mfma_f32_16x16x32_bf16 v[96:99], v[128:131], a[104:107], v[96:99]
    ds_read_b64_tr_b16 v[152:153], v223 offset:49152
    v_mfma_f32_16x16x32_bf16 v[96:99], v[132:135], a[120:123], v[96:99]
    ds_read_b64_tr_b16 v[154:155], v223 offset:51200
    s_mov_b32 s32, kc_tail-kc_pc0
    v_lshlrev_b32 v234, 7, v230
    buffer_load_dword v241, v234, s[56:59], s32 offen
    v_mfma_f32_16x16x32_bf16 v[100:103], v[128:131], a[108:111], v[100:103]
    ds_read_b64_tr_b16 v[156:157], v223 offset:57344
    v_mfma_f32_16x16x32_bf16 v[100:103], v[132:135], a[124:127], v[100:103]
    ds_read_b64_tr_b16 v[158:159], v223 offset:59392
    s_waitcnt lgkmcnt(8)
    v_mfma_f32_16x16x32_bf16 v[8:11], v[136:139], a[240:243], v[8:11]
    buffer_load_dwordx4 a[84:87], v227, s[8:11], s35 offen offset:1024 sc1
    v_mfma_f32_16x16x32_bf16 v[8:11], v[140:143], a[248:251], v[8:11]
    v_mfma_f32_16x16x32_bf16 v[12:15], v[136:139], a[244:247], v[12:15]
    v_mfma_f32_16x16x32_bf16 v[12:15], v[140:143], a[252:255], v[12:15]
    buffer_load_dwordx4 a[88:91], v245, s[8:11], s35 offen offset:1024 sc1
    v_mfma_f32_16x16x32_bf16 v[104:107], v[136:139], a[104:107], v[104:107]
    v_mfma_f32_16x16x32_bf16 v[104:107], v[140:143], a[120:123], v[104:107]
    v_mfma_f32_16x16x32_bf16 v[108:111], v[136:139], a[108:111], v[108:111]
    v_mfma_f32_16x16x32_bf16 v[108:111], v[140:143], a[124:127], v[108:111]
    buffer_load_dwordx4 a[92:95], v246, s[8:11], s35 offen offset:1024 sc1
    s_waitcnt vmcnt(24) lgkmcnt(0)
    s_barrier
    v_mfma_f32_16x16x32_bf16 v[16:19], v[144:147], a[240:243], v[16:19]
    v_xor_b32 v220, 0x10000, v220
    ds_read_b64_tr_b16 v[128:129], v220 offset:0
    v_mfma_f32_16x16x32_bf16 v[16:19], v[148:151], a[248:251], v[16:19]
    ds_read_b64_tr_b16 v[130:131], v220 offset:2048
    v_mfma_f32_16x16x32_bf16 v[20:23], v[144:147], a[244:247], v[20:23]
    ds_read_b64_tr_b16 v[132:133], v220 offset:8192
    v_mfma_f32_16x16x32_bf16 v[20:23], v[148:151], a[252:255], v[20:23]
    ds_read_b64_tr_b16 v[134:135], v220 offset:10240
    v_mfma_f32_16x16x32_bf16 v[112:115], v[144:147], a[104:107], v[112:115]
    v_xor_b32 v221, 0x10000, v221
    ds_read_b64_tr_b16 v[136:137], v221 offset:0
    v_mfma_f32_16x16x32_bf16 v[112:115], v[148:151], a[120:123], v[112:115]
    ds_read_b64_tr_b16 v[138:139], v221 offset:2048
    v_mfma_f32_16x16x32_bf16 v[116:119], v[144:147], a[108:111], v[116:119]
    ds_read_b64_tr_b16 v[140:141], v221 offset:8192
    v_mfma_f32_16x16x32_bf16 v[116:119], v[148:151], a[124:127], v[116:119]
    ds_read_b64_tr_b16 v[142:143], v221 offset:10240
    v_mfma_f32_16x16x32_bf16 v[24:27], v[152:155], a[240:243], v[24:27]
    v_mfma_f32_16x16x32_bf16 v[24:27], v[156:159], a[248:251], v[24:27]
    v_mfma_f32_16x16x32_bf16 v[28:31], v[152:155], a[244:247], v[28:31]
    v_mfma_f32_16x16x32_bf16 v[28:31], v[156:159], a[252:255], v[28:31]
    v_mfma_f32_16x16x32_bf16 v[120:123], v[152:155], a[104:107], v[120:123]
    v_mfma_f32_16x16x32_bf16 v[120:123], v[156:159], a[120:123], v[120:123]
    v_mfma_f32_16x16x32_bf16 v[124:127], v[152:155], a[108:111], v[124:127]
    v_mfma_f32_16x16x32_bf16 v[124:127], v[156:159], a[124:127], v[124:127]
    buffer_load_dwordx4 a[96:99], v226, s[8:11], s35 offen offset:2048 sc1
    s_waitcnt vmcnt(27) lgkmcnt(4)
    v_mfma_f32_16x16x32_bf16 v[96:99], v[128:131], a[8:11], v[96:99]
    v_xor_b32 v222, 0x10000, v222
    ds_read_b64_tr_b16 v[144:145], v222 offset:0
    v_mfma_f32_16x16x32_bf16 v[96:99], v[132:135], a[24:27], v[96:99]
    ds_read_b64_tr_b16 v[146:147], v222 offset:2048
    v_mfma_f32_16x16x32_bf16 v[100:103], v[128:131], a[12:15], v[100:103]
    ds_read_b64_tr_b16 v[148:149], v222 offset:8192
    buffer_load_dwordx4 a[100:103], v227, s[8:11], s35 offen offset:2048 sc1
    v_mfma_f32_16x16x32_bf16 v[100:103], v[132:135], a[28:31], v[100:103]
    ds_read_b64_tr_b16 v[150:151], v222 offset:10240
    s_waitcnt lgkmcnt(4)
    v_mfma_f32_16x16x32_bf16 v[104:107], v[136:139], a[8:11], v[104:107]
    v_xor_b32 v223, 0x10000, v223
    ds_read_b64_tr_b16 v[152:153], v223 offset:0
    v_mfma_f32_16x16x32_bf16 v[104:107], v[140:143], a[24:27], v[104:107]
    ds_read_b64_tr_b16 v[154:155], v223 offset:2048
    v_mfma_f32_16x16x32_bf16 v[108:111], v[136:139], a[12:15], v[108:111]
    ds_read_b64_tr_b16 v[156:157], v223 offset:8192
    buffer_load_dwordx4 a[104:107], v245, s[8:11], s35 offen offset:2048 sc1
    v_mfma_f32_16x16x32_bf16 v[108:111], v[140:143], a[28:31], v[108:111]
    ds_read_b64_tr_b16 v[158:159], v223 offset:10240
    s_waitcnt lgkmcnt(4)
    v_mfma_f32_16x16x32_bf16 v[112:115], v[144:147], a[8:11], v[112:115]
    ds_read_b64_tr_b16 v[128:129], v220 offset:16384
    v_mfma_f32_16x16x32_bf16 v[112:115], v[148:151], a[24:27], v[112:115]
    ds_read_b64_tr_b16 v[130:131], v220 offset:18432
    v_mfma_f32_16x16x32_bf16 v[116:119], v[144:147], a[12:15], v[116:119]
    ds_read_b64_tr_b16 v[132:133], v220 offset:24576
    buffer_load_dwordx4 a[108:111], v246, s[8:11], s35 offen offset:2048 sc1
    v_mfma_f32_16x16x32_bf16 v[116:119], v[148:151], a[28:31], v[116:119]
    ds_read_b64_tr_b16 v[134:135], v220 offset:26624
    s_waitcnt lgkmcnt(4)
    v_mfma_f32_16x16x32_bf16 v[120:123], v[152:155], a[8:11], v[120:123]
    ds_read_b64_tr_b16 v[136:137], v221 offset:16384
    v_mfma_f32_16x16x32_bf16 v[120:123], v[156:159], a[24:27], v[120:123]
    ds_read_b64_tr_b16 v[138:139], v221 offset:18432
    v_mfma_f32_16x16x32_bf16 v[124:127], v[152:155], a[12:15], v[124:127]
    ds_read_b64_tr_b16 v[140:141], v221 offset:24576
    buffer_load_dwordx4 a[112:115], v226, s[8:11], s35 offen offset:3072 sc1
    v_mfma_f32_16x16x32_bf16 v[124:127], v[156:159], a[28:31], v[124:127]
    ds_read_b64_tr_b16 v[142:143], v221 offset:26624
    s_waitcnt vmcnt(16) lgkmcnt(4)
    v_mfma_f32_16x16x32_bf16 v[96:99], v[128:131], a[40:43], v[96:99]
    ds_read_b64_tr_b16 v[144:145], v222 offset:16384
    v_mfma_f32_16x16x32_bf16 v[96:99], v[132:135], a[56:59], v[96:99]
    ds_read_b64_tr_b16 v[146:147], v222 offset:18432
    v_mfma_f32_16x16x32_bf16 v[100:103], v[128:131], a[44:47], v[100:103]
    ds_read_b64_tr_b16 v[148:149], v222 offset:24576
    buffer_load_dwordx4 a[116:119], v227, s[8:11], s35 offen offset:3072 sc1
    v_mfma_f32_16x16x32_bf16 v[100:103], v[132:135], a[60:63], v[100:103]
    ds_read_b64_tr_b16 v[150:151], v222 offset:26624
    s_waitcnt lgkmcnt(4)
    v_mfma_f32_16x16x32_bf16 v[104:107], v[136:139], a[40:43], v[104:107]
    ds_read_b64_tr_b16 v[152:153], v223 offset:16384
    v_mfma_f32_16x16x32_bf16 v[104:107], v[140:143], a[56:59], v[104:107]
    ds_read_b64_tr_b16 v[154:155], v223 offset:18432
    v_mfma_f32_16x16x32_bf16 v[108:111], v[136:139], a[44:47], v[108:111]
    ds_read_b64_tr_b16 v[156:157], v223 offset:24576
    buffer_load_dwordx4 a[120:123], v245, s[8:11], s35 offen offset:3072 sc1
    v_mfma_f32_16x16x32_bf16 v[108:111], v[140:143], a[60:63], v[108:111]
    ds_read_b64_tr_b16 v[158:159], v223 offset:26624
    s_waitcnt lgkmcnt(4)
    v_mfma_f32_16x16x32_bf16 v[112:115], v[144:147], a[40:43], v[112:115]
    ds_read_b64_tr_b16 v[128:129], v220 offset:32768
    v_mfma_f32_16x16x32_bf16 v[112:115], v[148:151], a[56:59], v[112:115]
    ds_read_b64_tr_b16 v[130:131], v220 offset:34816
    v_mfma_f32_16x16x32_bf16 v[116:119], v[144:147], a[44:47], v[116:119]
    ds_read_b64_tr_b16 v[132:133], v220 offset:40960
    buffer_load_dwordx4 a[124:127], v246, s[8:11], s35 offen offset:3072 sc1
    v_mfma_f32_16x16x32_bf16 v[116:119], v[148:151], a[60:63], v[116:119]
    ds_read_b64_tr_b16 v[134:135], v220 offset:43008
    s_waitcnt lgkmcnt(4)
    v_mfma_f32_16x16x32_bf16 v[120:123], v[152:155], a[40:43], v[120:123]
    ds_read_b64_tr_b16 v[136:137], v221 offset:32768
    v_mfma_f32_16x16x32_bf16 v[120:123], v[156:159], a[56:59], v[120:123]
    ds_read_b64_tr_b16 v[138:139], v221 offset:34816
    v_mfma_f32_16x16x32_bf16 v[124:127], v[152:155], a[44:47], v[124:127]
    ds_read_b64_tr_b16 v[140:141], v221 offset:40960
    v_mfma_f32_16x16x32_bf16 v[124:127], v[156:159], a[60:63], v[124:127]
    ds_read_b64_tr_b16 v[142:143], v221 offset:43008
    s_waitcnt vmcnt(8) lgkmcnt(4)
    v_mfma_f32_16x16x32_bf16 v[96:99], v[128:131], a[72:75], v[96:99]
    ds_read_b64_tr_b16 v[144:145], v222 offset:32768
    v_mfma_f32_16x16x32_bf16 v[96:99], v[132:135], a[88:91], v[96:99]
    ds_read_b64_tr_b16 v[146:147], v222 offset:34816
    s_xor_b32 s7, s39, 24
    v_mfma_f32_16x16x32_bf16 v[100:103], v[128:131], a[76:79], v[100:103]
    ds_read_b64_tr_b16 v[148:149], v222 offset:40960
    v_mfma_f32_16x16x32_bf16 v[100:103], v[132:135], a[92:95], v[100:103]
    ds_read_b64_tr_b16 v[150:151], v222 offset:43008
    s_waitcnt lgkmcnt(4)
    v_mfma_f32_16x16x32_bf16 v[104:107], v[136:139], a[72:75], v[104:107]
    ds_read_b64_tr_b16 v[152:153], v223 offset:32768
    v_mfma_f32_16x16x32_bf16 v[104:107], v[140:143], a[88:91], v[104:107]
    ds_read_b64_tr_b16 v[154:155], v223 offset:34816
    s_mul_i32 s7, s7, 12288
    v_mfma_f32_16x16x32_bf16 v[108:111], v[136:139], a[76:79], v[108:111]
    ds_read_b64_tr_b16 v[156:157], v223 offset:40960
    s_add_u32 s7, s7, 0x5002000
    v_mfma_f32_16x16x32_bf16 v[108:111], v[140:143], a[92:95], v[108:111]
    ds_read_b64_tr_b16 v[158:159], v223 offset:43008
    s_waitcnt lgkmcnt(4)
    v_mfma_f32_16x16x32_bf16 v[112:115], v[144:147], a[72:75], v[112:115]
    ds_read_b64_tr_b16 v[128:129], v220 offset:49152
    v_mfma_f32_16x16x32_bf16 v[112:115], v[148:151], a[88:91], v[112:115]
    ds_read_b64_tr_b16 v[130:131], v220 offset:51200
    s_xor_b32 s37, s39, 8
    v_mfma_f32_16x16x32_bf16 v[116:119], v[144:147], a[76:79], v[116:119]
    ds_read_b64_tr_b16 v[132:133], v220 offset:57344
    v_mfma_f32_16x16x32_bf16 v[116:119], v[148:151], a[92:95], v[116:119]
    ds_read_b64_tr_b16 v[134:135], v220 offset:59392
    s_waitcnt lgkmcnt(4)
    v_mfma_f32_16x16x32_bf16 v[120:123], v[152:155], a[72:75], v[120:123]
    ds_read_b64_tr_b16 v[136:137], v221 offset:49152
    v_mfma_f32_16x16x32_bf16 v[120:123], v[156:159], a[88:91], v[120:123]
    ds_read_b64_tr_b16 v[138:139], v221 offset:51200
    s_mul_i32 s37, s37, 12288
    v_mfma_f32_16x16x32_bf16 v[124:127], v[152:155], a[76:79], v[124:127]
    ds_read_b64_tr_b16 v[140:141], v221 offset:57344
    s_add_u32 s37, s37, 0x5000000
    v_mfma_f32_16x16x32_bf16 v[124:127], v[156:159], a[92:95], v[124:127]
    ds_read_b64_tr_b16 v[142:143], v221 offset:59392
    s_waitcnt vmcnt(0) lgkmcnt(4)
    v_mfma_f32_16x16x32_bf16 v[96:99], v[128:131], a[104:107], v[96:99]
    ds_read_b64_tr_b16 v[144:145], v222 offset:49152
    v_mfma_f32_16x16x32_bf16 v[96:99], v[132:135], a[120:123], v[96:99]
    ds_read_b64_tr_b16 v[146:147], v222 offset:51200
    s_xor_b32 s38, s39, 16
    v_mfma_f32_16x16x32_bf16 v[100:103], v[128:131], a[108:111], v[100:103]
    ds_read_b64_tr_b16 v[148:149], v222 offset:57344
    v_mfma_f32_16x16x32_bf16 v[100:103], v[132:135], a[124:127], v[100:103]
    ds_read_b64_tr_b16 v[150:151], v222 offset:59392
    s_waitcnt lgkmcnt(4)
    v_mfma_f32_16x16x32_bf16 v[104:107], v[136:139], a[104:107], v[104:107]
    ds_read_b64_tr_b16 v[152:153], v223 offset:49152
    v_mfma_f32_16x16x32_bf16 v[104:107], v[140:143], a[120:123], v[104:107]
    ds_read_b64_tr_b16 v[154:155], v223 offset:51200
    s_mul_i32 s38, s38, 12288
    v_mfma_f32_16x16x32_bf16 v[108:111], v[136:139], a[108:111], v[108:111]
    ds_read_b64_tr_b16 v[156:157], v223 offset:57344
    s_add_u32 s38, s38, 0x5001000
    v_mfma_f32_16x16x32_bf16 v[108:111], v[140:143], a[124:127], v[108:111]
    ds_read_b64_tr_b16 v[158:159], v223 offset:59392
    s_waitcnt lgkmcnt(4)
    v_mfma_f32_16x16x32_bf16 v[112:115], v[144:147], a[104:107], v[112:115]
    ds_read_b64_tr_b16 v[128:129], v220 offset:0
    v_mfma_f32_16x16x32_bf16 v[112:115], v[148:151], a[120:123], v[112:115]
    ds_read_b64_tr_b16 v[130:131], v220 offset:2048
    v_mfma_f32_16x16x32_bf16 v[116:119], v[144:147], a[108:111], v[116:119]
    ds_read_b64_tr_b16 v[132:133], v220 offset:8192
    v_mfma_f32_16x16x32_bf16 v[116:119], v[148:151], a[124:127], v[116:119]
    ds_read_b64_tr_b16 v[134:135], v220 offset:10240
    s_waitcnt lgkmcnt(4)
    v_mfma_f32_16x16x32_bf16 v[120:123], v[152:155], a[104:107], v[120:123]
    ds_read_b64_tr_b16 v[136:137], v221 offset:0
    v_mfma_f32_16x16x32_bf16 v[120:123], v[156:159], a[120:123], v[120:123]
    ds_read_b64_tr_b16 v[138:139], v221 offset:2048
    v_mfma_f32_16x16x32_bf16 v[124:127], v[152:155], a[108:111], v[124:127]
    ds_read_b64_tr_b16 v[140:141], v221 offset:8192
    v_mfma_f32_16x16x32_bf16 v[124:127], v[156:159], a[124:127], v[124:127]
    ds_read_b64_tr_b16 v[142:143], v221 offset:10240
    s_waitcnt lgkmcnt(4)
    v_mfma_f32_16x16x32_bf16 v[0:3], v[128:131], a[0:3], v[0:3]
    ds_read_b64_tr_b16 v[144:145], v222 offset:0
    v_mfma_f32_16x16x32_bf16 v[0:3], v[132:135], a[16:19], v[0:3]
    ds_read_b64_tr_b16 v[146:147], v222 offset:2048
    v_mfma_f32_16x16x32_bf16 v[4:7], v[128:131], a[4:7], v[4:7]
    ds_read_b64_tr_b16 v[148:149], v222 offset:8192
    v_mfma_f32_16x16x32_bf16 v[4:7], v[132:135], a[20:23], v[4:7]
    ds_read_b64_tr_b16 v[150:151], v222 offset:10240
    s_waitcnt lgkmcnt(4)
    v_mfma_f32_16x16x32_bf16 v[8:11], v[136:139], a[0:3], v[8:11]
    ds_read_b64_tr_b16 v[152:153], v223 offset:0
    v_mfma_f32_16x16x32_bf16 v[8:11], v[140:143], a[16:19], v[8:11]
    ds_read_b64_tr_b16 v[154:155], v223 offset:2048
    v_mfma_f32_16x16x32_bf16 v[12:15], v[136:139], a[4:7], v[12:15]
    ds_read_b64_tr_b16 v[156:157], v223 offset:8192
    v_mfma_f32_16x16x32_bf16 v[12:15], v[140:143], a[20:23], v[12:15]
    ds_read_b64_tr_b16 v[158:159], v223 offset:10240
    s_waitcnt lgkmcnt(4)
    v_mfma_f32_16x16x32_bf16 v[16:19], v[144:147], a[0:3], v[16:19]
    ds_read_b64_tr_b16 v[128:129], v220 offset:16384
    s_mul_i32 s33, s39, 12288
    s_add_u32 s33, s33, 0x5002000
    v_mfma_f32_16x16x32_bf16 v[16:19], v[148:151], a[16:19], v[16:19]
    ds_read_b64_tr_b16 v[130:131], v220 offset:18432
    v_mfma_f32_16x16x32_bf16 v[20:23], v[144:147], a[4:7], v[20:23]
    ds_read_b64_tr_b16 v[132:133], v220 offset:24576
    v_cvt_pk_bf16_f32 v96, v96, v97
    v_mfma_f32_16x16x32_bf16 v[20:23], v[148:151], a[20:23], v[20:23]
    ds_read_b64_tr_b16 v[134:135], v220 offset:26624
    v_cvt_pk_bf16_f32 v97, v98, v99
    s_waitcnt lgkmcnt(4)
    v_mfma_f32_16x16x32_bf16 v[24:27], v[152:155], a[0:3], v[24:27]
    ds_read_b64_tr_b16 v[136:137], v221 offset:16384
    v_cvt_pk_bf16_f32 v98, v100, v101
    v_mfma_f32_16x16x32_bf16 v[24:27], v[156:159], a[16:19], v[24:27]
    ds_read_b64_tr_b16 v[138:139], v221 offset:18432
    v_cvt_pk_bf16_f32 v99, v102, v103
    v_mfma_f32_16x16x32_bf16 v[28:31], v[152:155], a[4:7], v[28:31]
    ds_read_b64_tr_b16 v[140:141], v221 offset:24576
    v_min_u32_e64 v96, -2, v96
    v_mfma_f32_16x16x32_bf16 v[28:31], v[156:159], a[20:23], v[28:31]
    ds_read_b64_tr_b16 v[142:143], v221 offset:26624
    v_min_u32 v97, -2, v97
    s_waitcnt lgkmcnt(4)
    v_mfma_f32_16x16x32_bf16 v[0:3], v[128:131], a[32:35], v[0:3]
    ds_read_b64_tr_b16 v[144:145], v222 offset:16384
    v_min_u32_e64 v98, -2, v98
    v_mfma_f32_16x16x32_bf16 v[0:3], v[132:135], a[48:51], v[0:3]
    ds_read_b64_tr_b16 v[146:147], v222 offset:18432
    v_min_u32_e64 v99, -2, v99
    v_mfma_f32_16x16x32_bf16 v[4:7], v[128:131], a[36:39], v[4:7]
    ds_read_b64_tr_b16 v[148:149], v222 offset:24576
    buffer_store_dwordx4 v[96:99], v228, s[8:11], s33 offen offset:0 sc1
    v_mfma_f32_16x16x32_bf16 v[4:7], v[132:135], a[52:55], v[4:7]
    ds_read_b64_tr_b16 v[150:151], v222 offset:26624
    s_waitcnt lgkmcnt(4)
    v_mfma_f32_16x16x32_bf16 v[8:11], v[136:139], a[32:35], v[8:11]
    ds_read_b64_tr_b16 v[152:153], v223 offset:16384
    v_mfma_f32_16x16x32_bf16 v[8:11], v[140:143], a[48:51], v[8:11]
    ds_read_b64_tr_b16 v[154:155], v223 offset:18432
    v_mfma_f32_16x16x32_bf16 v[12:15], v[136:139], a[36:39], v[12:15]
    ds_read_b64_tr_b16 v[156:157], v223 offset:24576
    v_cvt_pk_bf16_f32 v100, v104, v105
    v_mfma_f32_16x16x32_bf16 v[12:15], v[140:143], a[52:55], v[12:15]
    ds_read_b64_tr_b16 v[158:159], v223 offset:26624
    v_cvt_pk_bf16_f32 v101, v106, v107
    s_waitcnt lgkmcnt(4)
    v_mfma_f32_16x16x32_bf16 v[16:19], v[144:147], a[32:35], v[16:19]
    ds_read_b64_tr_b16 v[128:129], v220 offset:32768
    v_cvt_pk_bf16_f32 v102, v108, v109
    v_mfma_f32_16x16x32_bf16 v[16:19], v[148:151], a[48:51], v[16:19]
    ds_read_b64_tr_b16 v[130:131], v220 offset:34816
    v_cvt_pk_bf16_f32 v103, v110, v111
    v_mfma_f32_16x16x32_bf16 v[20:23], v[144:147], a[36:39], v[20:23]
    ds_read_b64_tr_b16 v[132:133], v220 offset:40960
    v_min_u32_e64 v100, -2, v100
    v_mfma_f32_16x16x32_bf16 v[20:23], v[148:151], a[52:55], v[20:23]
    ds_read_b64_tr_b16 v[134:135], v220 offset:43008
    v_min_u32 v101, -2, v101
    s_waitcnt lgkmcnt(4)
    v_mfma_f32_16x16x32_bf16 v[24:27], v[152:155], a[32:35], v[24:27]
    ds_read_b64_tr_b16 v[136:137], v221 offset:32768
    v_min_u32_e64 v102, -2, v102
    v_mfma_f32_16x16x32_bf16 v[24:27], v[156:159], a[48:51], v[24:27]
    ds_read_b64_tr_b16 v[138:139], v221 offset:34816
    v_min_u32_e64 v103, -2, v103
    v_mfma_f32_16x16x32_bf16 v[28:31], v[152:155], a[36:39], v[28:31]
    ds_read_b64_tr_b16 v[140:141], v221 offset:40960
    buffer_store_dwordx4 v[100:103], v228, s[8:11], s33 offen offset:1024 sc1
    v_mfma_f32_16x16x32_bf16 v[28:31], v[156:159], a[52:55], v[28:31]
    ds_read_b64_tr_b16 v[142:143], v221 offset:43008
    s_waitcnt lgkmcnt(4)
    v_mfma_f32_16x16x32_bf16 v[0:3], v[128:131], a[64:67], v[0:3]
    ds_read_b64_tr_b16 v[144:145], v222 offset:32768
    v_mfma_f32_16x16x32_bf16 v[0:3], v[132:135], a[80:83], v[0:3]
    ds_read_b64_tr_b16 v[146:147], v222 offset:34816
    v_mfma_f32_16x16x32_bf16 v[4:7], v[128:131], a[68:71], v[4:7]
    ds_read_b64_tr_b16 v[148:149], v222 offset:40960
    v_cvt_pk_bf16_f32 v104, v112, v113
    v_mfma_f32_16x16x32_bf16 v[4:7], v[132:135], a[84:87], v[4:7]
    ds_read_b64_tr_b16 v[150:151], v222 offset:43008
    v_cvt_pk_bf16_f32 v105, v114, v115
    s_waitcnt lgkmcnt(4)
    v_mfma_f32_16x16x32_bf16 v[8:11], v[136:139], a[64:67], v[8:11]
    ds_read_b64_tr_b16 v[152:153], v223 offset:32768
    v_cvt_pk_bf16_f32 v106, v116, v117
    v_mfma_f32_16x16x32_bf16 v[8:11], v[140:143], a[80:83], v[8:11]
    ds_read_b64_tr_b16 v[154:155], v223 offset:34816
    v_cvt_pk_bf16_f32 v107, v118, v119
    v_mfma_f32_16x16x32_bf16 v[12:15], v[136:139], a[68:71], v[12:15]
    ds_read_b64_tr_b16 v[156:157], v223 offset:40960
    v_min_u32_e64 v104, -2, v104
    v_mfma_f32_16x16x32_bf16 v[12:15], v[140:143], a[84:87], v[12:15]
    ds_read_b64_tr_b16 v[158:159], v223 offset:43008
    v_min_u32 v105, -2, v105
    s_waitcnt lgkmcnt(4)
    v_mfma_f32_16x16x32_bf16 v[16:19], v[144:147], a[64:67], v[16:19]
    ds_read_b64_tr_b16 v[128:129], v220 offset:49152
    v_min_u32_e64 v106, -2, v106
    v_mfma_f32_16x16x32_bf16 v[16:19], v[148:151], a[80:83], v[16:19]
    ds_read_b64_tr_b16 v[130:131], v220 offset:51200
    v_min_u32_e64 v107, -2, v107
    v_mfma_f32_16x16x32_bf16 v[20:23], v[144:147], a[68:71], v[20:23]
    ds_read_b64_tr_b16 v[132:133], v220 offset:57344
    buffer_store_dwordx4 v[104:107], v228, s[8:11], s33 offen offset:2048 sc1
    v_mfma_f32_16x16x32_bf16 v[20:23], v[148:151], a[84:87], v[20:23]
    ds_read_b64_tr_b16 v[134:135], v220 offset:59392
    s_waitcnt lgkmcnt(4)
    v_mfma_f32_16x16x32_bf16 v[24:27], v[152:155], a[64:67], v[24:27]
    ds_read_b64_tr_b16 v[136:137], v221 offset:49152
    v_mfma_f32_16x16x32_bf16 v[24:27], v[156:159], a[80:83], v[24:27]
    ds_read_b64_tr_b16 v[138:139], v221 offset:51200
    v_mfma_f32_16x16x32_bf16 v[28:31], v[152:155], a[68:71], v[28:31]
    ds_read_b64_tr_b16 v[140:141], v221 offset:57344
    v_cvt_pk_bf16_f32 v108, v120, v121
    v_mfma_f32_16x16x32_bf16 v[28:31], v[156:159], a[84:87], v[28:31]
    ds_read_b64_tr_b16 v[142:143], v221 offset:59392
    v_cvt_pk_bf16_f32 v109, v122, v123
    s_waitcnt lgkmcnt(4)
    v_mfma_f32_16x16x32_bf16 v[0:3], v[128:131], a[96:99], v[0:3]
    ds_read_b64_tr_b16 v[144:145], v222 offset:49152
    v_cvt_pk_bf16_f32 v110, v124, v125
    v_mfma_f32_16x16x32_bf16 v[0:3], v[132:135], a[112:115], v[0:3]
    ds_read_b64_tr_b16 v[146:147], v222 offset:51200
    v_cvt_pk_bf16_f32 v111, v126, v127
    v_mfma_f32_16x16x32_bf16 v[4:7], v[128:131], a[100:103], v[4:7]
    ds_read_b64_tr_b16 v[148:149], v222 offset:57344
    v_min_u32_e64 v108, -2, v108
    v_mfma_f32_16x16x32_bf16 v[4:7], v[132:135], a[116:119], v[4:7]
    ds_read_b64_tr_b16 v[150:151], v222 offset:59392
    v_min_u32 v109, -2, v109
    s_waitcnt lgkmcnt(4)
    v_mfma_f32_16x16x32_bf16 v[8:11], v[136:139], a[96:99], v[8:11]
    ds_read_b64_tr_b16 v[152:153], v223 offset:49152
    v_min_u32_e64 v110, -2, v110
    v_mfma_f32_16x16x32_bf16 v[8:11], v[140:143], a[112:115], v[8:11]
    ds_read_b64_tr_b16 v[154:155], v223 offset:51200
    v_min_u32_e64 v111, -2, v111
    v_mfma_f32_16x16x32_bf16 v[12:15], v[136:139], a[100:103], v[12:15]
    ds_read_b64_tr_b16 v[156:157], v223 offset:57344
    buffer_store_dwordx4 v[108:111], v228, s[8:11], s33 offen offset:3072 sc1
    v_mfma_f32_16x16x32_bf16 v[12:15], v[140:143], a[116:119], v[12:15]
    ds_read_b64_tr_b16 v[158:159], v223 offset:59392
    s_waitcnt lgkmcnt(4)
    v_mfma_f32_16x16x32_bf16 v[16:19], v[144:147], a[96:99], v[16:19]
    v_xor_b32 v216, 0x10000, v216
    ds_read_b64_tr_b16 v[128:129], v216 offset:0
    v_mfma_f32_16x16x32_bf16 v[16:19], v[148:151], a[112:115], v[16:19]
    ds_read_b64_tr_b16 v[130:131], v216 offset:2048
    v_mfma_f32_16x16x32_bf16 v[20:23], v[144:147], a[100:103], v[20:23]
    ds_read_b64_tr_b16 v[132:133], v216 offset:8192
    v_mfma_f32_16x16x32_bf16 v[20:23], v[148:151], a[116:119], v[20:23]
    ds_read_b64_tr_b16 v[134:135], v216 offset:10240
    s_waitcnt lgkmcnt(4)
    v_mfma_f32_16x16x32_bf16 v[24:27], v[152:155], a[96:99], v[24:27]
    v_xor_b32 v217, 0x10000, v217
    ds_read_b64_tr_b16 v[136:137], v217 offset:0
    v_mfma_f32_16x16x32_bf16 v[24:27], v[156:159], a[112:115], v[24:27]
    ds_read_b64_tr_b16 v[138:139], v217 offset:2048
    v_mfma_f32_16x16x32_bf16 v[28:31], v[152:155], a[100:103], v[28:31]
    ds_read_b64_tr_b16 v[140:141], v217 offset:8192
    v_mfma_f32_16x16x32_bf16 v[28:31], v[156:159], a[116:119], v[28:31]
    ds_read_b64_tr_b16 v[142:143], v217 offset:10240
    s_waitcnt lgkmcnt(4)
    v_mfma_f32_16x16x32_bf16 v[64:67], v[128:131], a[8:11], v[64:67]
    v_xor_b32 v218, 0x10000, v218
    ds_read_b64_tr_b16 v[144:145], v218 offset:0
    v_mfma_f32_16x16x32_bf16 v[64:67], v[132:135], a[24:27], v[64:67]
    ds_read_b64_tr_b16 v[146:147], v218 offset:2048
    v_mfma_f32_16x16x32_bf16 v[68:71], v[128:131], a[12:15], v[68:71]
    ds_read_b64_tr_b16 v[148:149], v218 offset:8192
    v_mfma_f32_16x16x32_bf16 v[68:71], v[132:135], a[28:31], v[68:71]
    ds_read_b64_tr_b16 v[150:151], v218 offset:10240
    s_waitcnt lgkmcnt(4)
    v_mfma_f32_16x16x32_bf16 v[72:75], v[136:139], a[8:11], v[72:75]
    v_xor_b32 v219, 0x10000, v219
    ds_read_b64_tr_b16 v[152:153], v219 offset:0
    v_mfma_f32_16x16x32_bf16 v[72:75], v[140:143], a[24:27], v[72:75]
    ds_read_b64_tr_b16 v[154:155], v219 offset:2048
    v_mfma_f32_16x16x32_bf16 v[76:79], v[136:139], a[12:15], v[76:79]
    ds_read_b64_tr_b16 v[156:157], v219 offset:8192
    v_mfma_f32_16x16x32_bf16 v[76:79], v[140:143], a[28:31], v[76:79]
    ds_read_b64_tr_b16 v[158:159], v219 offset:10240
    s_waitcnt lgkmcnt(4)
    v_mfma_f32_16x16x32_bf16 v[80:83], v[144:147], a[8:11], v[80:83]
    ds_read_b64_tr_b16 v[128:129], v216 offset:16384
    s_mul_i32 s33, s39, 12288
    s_add_u32 s33, s33, 0x5000000
    v_mfma_f32_16x16x32_bf16 v[80:83], v[148:151], a[24:27], v[80:83]
    ds_read_b64_tr_b16 v[130:131], v216 offset:18432
    v_mfma_f32_16x16x32_bf16 v[84:87], v[144:147], a[12:15], v[84:87]
    ds_read_b64_tr_b16 v[132:133], v216 offset:24576
    v_cvt_pk_bf16_f32 v0, v0, v1
    v_mfma_f32_16x16x32_bf16 v[84:87], v[148:151], a[28:31], v[84:87]
    ds_read_b64_tr_b16 v[134:135], v216 offset:26624
    v_cvt_pk_bf16_f32 v1, v2, v3
    s_waitcnt lgkmcnt(4)
    v_mfma_f32_16x16x32_bf16 v[88:91], v[152:155], a[8:11], v[88:91]
    ds_read_b64_tr_b16 v[136:137], v217 offset:16384
    v_cvt_pk_bf16_f32 v2, v4, v5
    v_mfma_f32_16x16x32_bf16 v[88:91], v[156:159], a[24:27], v[88:91]
    ds_read_b64_tr_b16 v[138:139], v217 offset:18432
    v_cvt_pk_bf16_f32 v3, v6, v7
    v_mfma_f32_16x16x32_bf16 v[92:95], v[152:155], a[12:15], v[92:95]
    ds_read_b64_tr_b16 v[140:141], v217 offset:24576
    v_min_u32_e64 v0, -2, v0
    v_mfma_f32_16x16x32_bf16 v[92:95], v[156:159], a[28:31], v[92:95]
    ds_read_b64_tr_b16 v[142:143], v217 offset:26624
    v_min_u32 v1, -2, v1
    s_waitcnt lgkmcnt(4)
    v_mfma_f32_16x16x32_bf16 v[64:67], v[128:131], a[40:43], v[64:67]
    ds_read_b64_tr_b16 v[144:145], v218 offset:16384
    v_min_u32_e64 v2, -2, v2
    v_mfma_f32_16x16x32_bf16 v[64:67], v[132:135], a[56:59], v[64:67]
    ds_read_b64_tr_b16 v[146:147], v218 offset:18432
    v_min_u32_e64 v3, -2, v3
    v_mfma_f32_16x16x32_bf16 v[68:71], v[128:131], a[44:47], v[68:71]
    ds_read_b64_tr_b16 v[148:149], v218 offset:24576
    buffer_store_dwordx4 v[0:3], v228, s[8:11], s33 offen offset:0 sc1
    v_mfma_f32_16x16x32_bf16 v[68:71], v[132:135], a[60:63], v[68:71]
    ds_read_b64_tr_b16 v[150:151], v218 offset:26624
    s_waitcnt lgkmcnt(4)
    v_mfma_f32_16x16x32_bf16 v[72:75], v[136:139], a[40:43], v[72:75]
    ds_read_b64_tr_b16 v[152:153], v219 offset:16384
    v_mfma_f32_16x16x32_bf16 v[72:75], v[140:143], a[56:59], v[72:75]
    ds_read_b64_tr_b16 v[154:155], v219 offset:18432
    v_mfma_f32_16x16x32_bf16 v[76:79], v[136:139], a[44:47], v[76:79]
    ds_read_b64_tr_b16 v[156:157], v219 offset:24576
    v_cvt_pk_bf16_f32 v4, v8, v9
    v_mfma_f32_16x16x32_bf16 v[76:79], v[140:143], a[60:63], v[76:79]
    ds_read_b64_tr_b16 v[158:159], v219 offset:26624
    v_cvt_pk_bf16_f32 v5, v10, v11
    s_waitcnt lgkmcnt(4)
    v_mfma_f32_16x16x32_bf16 v[80:83], v[144:147], a[40:43], v[80:83]
    ds_read_b64_tr_b16 v[128:129], v216 offset:32768
    v_cvt_pk_bf16_f32 v6, v12, v13
    v_mfma_f32_16x16x32_bf16 v[80:83], v[148:151], a[56:59], v[80:83]
    ds_read_b64_tr_b16 v[130:131], v216 offset:34816
    v_cvt_pk_bf16_f32 v7, v14, v15
    v_mfma_f32_16x16x32_bf16 v[84:87], v[144:147], a[44:47], v[84:87]
    ds_read_b64_tr_b16 v[132:133], v216 offset:40960
    v_min_u32_e64 v4, -2, v4
    v_mfma_f32_16x16x32_bf16 v[84:87], v[148:151], a[60:63], v[84:87]
    ds_read_b64_tr_b16 v[134:135], v216 offset:43008
    v_min_u32 v5, -2, v5
    s_waitcnt lgkmcnt(4)
    v_mfma_f32_16x16x32_bf16 v[88:91], v[152:155], a[40:43], v[88:91]
    ds_read_b64_tr_b16 v[136:137], v217 offset:32768
    v_min_u32_e64 v6, -2, v6
    v_mfma_f32_16x16x32_bf16 v[88:91], v[156:159], a[56:59], v[88:91]
    ds_read_b64_tr_b16 v[138:139], v217 offset:34816
    v_min_u32_e64 v7, -2, v7
    v_mfma_f32_16x16x32_bf16 v[92:95], v[152:155], a[44:47], v[92:95]
    ds_read_b64_tr_b16 v[140:141], v217 offset:40960
    buffer_store_dwordx4 v[4:7], v228, s[8:11], s33 offen offset:1024 sc1
    v_mfma_f32_16x16x32_bf16 v[92:95], v[156:159], a[60:63], v[92:95]
    ds_read_b64_tr_b16 v[142:143], v217 offset:43008
    s_waitcnt lgkmcnt(4)
    v_mfma_f32_16x16x32_bf16 v[64:67], v[128:131], a[72:75], v[64:67]
    ds_read_b64_tr_b16 v[144:145], v218 offset:32768
    v_mfma_f32_16x16x32_bf16 v[64:67], v[132:135], a[88:91], v[64:67]
    ds_read_b64_tr_b16 v[146:147], v218 offset:34816
    v_mfma_f32_16x16x32_bf16 v[68:71], v[128:131], a[76:79], v[68:71]
    ds_read_b64_tr_b16 v[148:149], v218 offset:40960
    v_cvt_pk_bf16_f32 v8, v16, v17
    v_mfma_f32_16x16x32_bf16 v[68:71], v[132:135], a[92:95], v[68:71]
    ds_read_b64_tr_b16 v[150:151], v218 offset:43008
    v_cvt_pk_bf16_f32 v9, v18, v19
    s_waitcnt lgkmcnt(4)
    v_mfma_f32_16x16x32_bf16 v[72:75], v[136:139], a[72:75], v[72:75]
    ds_read_b64_tr_b16 v[152:153], v219 offset:32768
    v_cvt_pk_bf16_f32 v10, v20, v21
    v_mfma_f32_16x16x32_bf16 v[72:75], v[140:143], a[88:91], v[72:75]
    ds_read_b64_tr_b16 v[154:155], v219 offset:34816
    v_cvt_pk_bf16_f32 v11, v22, v23
    v_mfma_f32_16x16x32_bf16 v[76:79], v[136:139], a[76:79], v[76:79]
    ds_read_b64_tr_b16 v[156:157], v219 offset:40960
    v_min_u32_e64 v8, -2, v8
    v_mfma_f32_16x16x32_bf16 v[76:79], v[140:143], a[92:95], v[76:79]
    ds_read_b64_tr_b16 v[158:159], v219 offset:43008
    v_min_u32 v9, -2, v9
    s_waitcnt lgkmcnt(4)
    v_mfma_f32_16x16x32_bf16 v[80:83], v[144:147], a[72:75], v[80:83]
    ds_read_b64_tr_b16 v[128:129], v216 offset:49152
    v_min_u32_e64 v10, -2, v10
    v_mfma_f32_16x16x32_bf16 v[80:83], v[148:151], a[88:91], v[80:83]
    ds_read_b64_tr_b16 v[130:131], v216 offset:51200
    v_min_u32_e64 v11, -2, v11
    v_mfma_f32_16x16x32_bf16 v[84:87], v[144:147], a[76:79], v[84:87]
    ds_read_b64_tr_b16 v[132:133], v216 offset:57344
    buffer_store_dwordx4 v[8:11], v228, s[8:11], s33 offen offset:2048 sc1
    v_mfma_f32_16x16x32_bf16 v[84:87], v[148:151], a[92:95], v[84:87]
    ds_read_b64_tr_b16 v[134:135], v216 offset:59392
    s_waitcnt lgkmcnt(4)
    v_mfma_f32_16x16x32_bf16 v[88:91], v[152:155], a[72:75], v[88:91]
    ds_read_b64_tr_b16 v[136:137], v217 offset:49152
    v_mfma_f32_16x16x32_bf16 v[88:91], v[156:159], a[88:91], v[88:91]
    ds_read_b64_tr_b16 v[138:139], v217 offset:51200
    v_mfma_f32_16x16x32_bf16 v[92:95], v[152:155], a[76:79], v[92:95]
    ds_read_b64_tr_b16 v[140:141], v217 offset:57344
    v_cvt_pk_bf16_f32 v12, v24, v25
    v_mfma_f32_16x16x32_bf16 v[92:95], v[156:159], a[92:95], v[92:95]
    ds_read_b64_tr_b16 v[142:143], v217 offset:59392
    v_cvt_pk_bf16_f32 v13, v26, v27
    s_waitcnt lgkmcnt(4)
    v_mfma_f32_16x16x32_bf16 v[64:67], v[128:131], a[104:107], v[64:67]
    ds_read_b64_tr_b16 v[144:145], v218 offset:49152
    v_cvt_pk_bf16_f32 v14, v28, v29
    v_mfma_f32_16x16x32_bf16 v[64:67], v[132:135], a[120:123], v[64:67]
    ds_read_b64_tr_b16 v[146:147], v218 offset:51200
    v_cvt_pk_bf16_f32 v15, v30, v31
    v_mfma_f32_16x16x32_bf16 v[68:71], v[128:131], a[108:111], v[68:71]
    ds_read_b64_tr_b16 v[148:149], v218 offset:57344
    v_min_u32_e64 v12, -2, v12
    v_mfma_f32_16x16x32_bf16 v[68:71], v[132:135], a[124:127], v[68:71]
    ds_read_b64_tr_b16 v[150:151], v218 offset:59392
    v_min_u32 v13, -2, v13
    s_waitcnt lgkmcnt(4)
    v_mfma_f32_16x16x32_bf16 v[72:75], v[136:139], a[104:107], v[72:75]
    ds_read_b64_tr_b16 v[152:153], v219 offset:49152
    v_min_u32_e64 v14, -2, v14
    v_mfma_f32_16x16x32_bf16 v[72:75], v[140:143], a[120:123], v[72:75]
    ds_read_b64_tr_b16 v[154:155], v219 offset:51200
    v_min_u32_e64 v15, -2, v15
    v_mfma_f32_16x16x32_bf16 v[76:79], v[136:139], a[108:111], v[76:79]
    ds_read_b64_tr_b16 v[156:157], v219 offset:57344
    buffer_store_dwordx4 v[12:15], v228, s[8:11], s33 offen offset:3072 sc1
    v_mfma_f32_16x16x32_bf16 v[76:79], v[140:143], a[124:127], v[76:79]
    ds_read_b64_tr_b16 v[158:159], v219 offset:59392
    s_waitcnt lgkmcnt(4)
    v_mfma_f32_16x16x32_bf16 v[80:83], v[144:147], a[104:107], v[80:83]
    v_xor_b32 v216, 0x10000, v216
    ds_read_b64_tr_b16 v[128:129], v216 offset:32768
    v_mfma_f32_16x16x32_bf16 v[80:83], v[148:151], a[120:123], v[80:83]
    ds_read_b64_tr_b16 v[130:131], v216 offset:34816
    v_mfma_f32_16x16x32_bf16 v[84:87], v[144:147], a[108:111], v[84:87]
    ds_read_b64_tr_b16 v[132:133], v216 offset:40960
    v_mfma_f32_16x16x32_bf16 v[84:87], v[148:151], a[124:127], v[84:87]
    ds_read_b64_tr_b16 v[134:135], v216 offset:43008
    s_waitcnt lgkmcnt(4)
    v_mfma_f32_16x16x32_bf16 v[88:91], v[152:155], a[104:107], v[88:91]
    v_xor_b32 v217, 0x10000, v217
    ds_read_b64_tr_b16 v[136:137], v217 offset:32768
    v_mfma_f32_16x16x32_bf16 v[88:91], v[156:159], a[120:123], v[88:91]
    ds_read_b64_tr_b16 v[138:139], v217 offset:34816
    v_mfma_f32_16x16x32_bf16 v[92:95], v[152:155], a[108:111], v[92:95]
    ds_read_b64_tr_b16 v[140:141], v217 offset:40960
    v_mfma_f32_16x16x32_bf16 v[92:95], v[156:159], a[124:127], v[92:95]
    ds_read_b64_tr_b16 v[142:143], v217 offset:43008
    s_waitcnt lgkmcnt(4)
    v_mfma_f32_16x16x32_bf16 v[32:35], v[128:131], a[224:227], v[32:35]
    v_xor_b32 v218, 0x10000, v218
    ds_read_b64_tr_b16 v[144:145], v218 offset:32768
    v_mfma_f32_16x16x32_bf16 v[32:35], v[132:135], a[232:235], v[32:35]
    ds_read_b64_tr_b16 v[146:147], v218 offset:34816
    buffer_load_dwordx4 v[176:179], v228, s[8:11], s7 offen offset:0 sc1
    v_mfma_f32_16x16x32_bf16 v[36:39], v[128:131], a[228:231], v[36:39]
    ds_read_b64_tr_b16 v[148:149], v218 offset:40960
    v_mfma_f32_16x16x32_bf16 v[36:39], v[132:135], a[236:239], v[36:39]
    ds_read_b64_tr_b16 v[150:151], v218 offset:43008
    buffer_load_dwordx4 v[180:183], v228, s[8:11], s7 offen offset:1024 sc1
    s_waitcnt lgkmcnt(4)
    v_mfma_f32_16x16x32_bf16 v[40:43], v[136:139], a[224:227], v[40:43]
    v_xor_b32 v219, 0x10000, v219
    ds_read_b64_tr_b16 v[152:153], v219 offset:32768
    v_mfma_f32_16x16x32_bf16 v[40:43], v[140:143], a[232:235], v[40:43]
    ds_read_b64_tr_b16 v[154:155], v219 offset:34816
    buffer_load_dwordx4 v[184:187], v228, s[8:11], s7 offen offset:2048 sc1
    v_mfma_f32_16x16x32_bf16 v[44:47], v[136:139], a[228:231], v[44:47]
    ds_read_b64_tr_b16 v[156:157], v219 offset:40960
    v_mfma_f32_16x16x32_bf16 v[44:47], v[140:143], a[236:239], v[44:47]
    ds_read_b64_tr_b16 v[158:159], v219 offset:43008
    buffer_load_dwordx4 v[188:191], v228, s[8:11], s7 offen offset:3072 sc1
    s_waitcnt lgkmcnt(4)
    v_mfma_f32_16x16x32_bf16 v[48:51], v[144:147], a[224:227], v[48:51]
    ds_read_b64_tr_b16 v[128:129], v216 offset:49152
    s_mul_i32 s33, s39, 12288
    s_add_u32 s33, s33, 0x5001000
    v_mfma_f32_16x16x32_bf16 v[48:51], v[148:151], a[232:235], v[48:51]
    ds_read_b64_tr_b16 v[130:131], v216 offset:51200
    v_mfma_f32_16x16x32_bf16 v[52:55], v[144:147], a[228:231], v[52:55]
    ds_read_b64_tr_b16 v[132:133], v216 offset:57344
    v_cvt_pk_bf16_f32 v64, v64, v65
    v_mfma_f32_16x16x32_bf16 v[52:55], v[148:151], a[236:239], v[52:55]
    ds_read_b64_tr_b16 v[134:135], v216 offset:59392
    v_cvt_pk_bf16_f32 v65, v66, v67
    s_waitcnt lgkmcnt(4)
    v_mfma_f32_16x16x32_bf16 v[56:59], v[152:155], a[224:227], v[56:59]
    ds_read_b64_tr_b16 v[136:137], v217 offset:49152
    v_cvt_pk_bf16_f32 v66, v68, v69
    v_mfma_f32_16x16x32_bf16 v[56:59], v[156:159], a[232:235], v[56:59]
    ds_read_b64_tr_b16 v[138:139], v217 offset:51200
    v_cvt_pk_bf16_f32 v67, v70, v71
    v_mfma_f32_16x16x32_bf16 v[60:63], v[152:155], a[228:231], v[60:63]
    ds_read_b64_tr_b16 v[140:141], v217 offset:57344
    v_min_u32_e64 v64, -2, v64
    v_mfma_f32_16x16x32_bf16 v[60:63], v[156:159], a[236:239], v[60:63]
    ds_read_b64_tr_b16 v[142:143], v217 offset:59392
    v_min_u32 v65, -2, v65
    s_waitcnt lgkmcnt(4)
    v_mfma_f32_16x16x32_bf16 v[32:35], v[128:131], a[240:243], v[32:35]
    ds_read_b64_tr_b16 v[144:145], v218 offset:49152
    v_min_u32_e64 v66, -2, v66
    v_mfma_f32_16x16x32_bf16 v[32:35], v[132:135], a[248:251], v[32:35]
    ds_read_b64_tr_b16 v[146:147], v218 offset:51200
    v_min_u32_e64 v67, -2, v67
    v_mfma_f32_16x16x32_bf16 v[36:39], v[128:131], a[244:247], v[36:39]
    ds_read_b64_tr_b16 v[148:149], v218 offset:57344
    buffer_store_dwordx4 v[64:67], v228, s[8:11], s33 offen offset:0 sc1
    v_mfma_f32_16x16x32_bf16 v[36:39], v[132:135], a[252:255], v[36:39]
    ds_read_b64_tr_b16 v[150:151], v218 offset:59392
    s_waitcnt lgkmcnt(4)
    v_mfma_f32_16x16x32_bf16 v[40:43], v[136:139], a[240:243], v[40:43]
    ds_read_b64_tr_b16 v[152:153], v219 offset:49152
    v_mfma_f32_16x16x32_bf16 v[40:43], v[140:143], a[248:251], v[40:43]
    ds_read_b64_tr_b16 v[154:155], v219 offset:51200
    v_mfma_f32_16x16x32_bf16 v[44:47], v[136:139], a[244:247], v[44:47]
    ds_read_b64_tr_b16 v[156:157], v219 offset:57344
    v_cvt_pk_bf16_f32 v68, v72, v73
    v_mfma_f32_16x16x32_bf16 v[44:47], v[140:143], a[252:255], v[44:47]
    ds_read_b64_tr_b16 v[158:159], v219 offset:59392
    v_cvt_pk_bf16_f32 v69, v74, v75
    s_waitcnt lgkmcnt(4)
    v_mfma_f32_16x16x32_bf16 v[48:51], v[144:147], a[240:243], v[48:51]
    v_xor_b32 v216, 0x10000, v216
    ds_read_b64_tr_b16 v[128:129], v216 offset:0
    v_cvt_pk_bf16_f32 v70, v76, v77
    v_mfma_f32_16x16x32_bf16 v[48:51], v[148:151], a[248:251], v[48:51]
    ds_read_b64_tr_b16 v[130:131], v216 offset:2048
    v_cvt_pk_bf16_f32 v71, v78, v79
    v_mfma_f32_16x16x32_bf16 v[52:55], v[144:147], a[244:247], v[52:55]
    ds_read_b64_tr_b16 v[132:133], v216 offset:8192
    v_min_u32_e64 v68, -2, v68
    v_mfma_f32_16x16x32_bf16 v[52:55], v[148:151], a[252:255], v[52:55]
    ds_read_b64_tr_b16 v[134:135], v216 offset:10240
    v_min_u32 v69, -2, v69
    s_waitcnt lgkmcnt(4)
    v_mfma_f32_16x16x32_bf16 v[56:59], v[152:155], a[240:243], v[56:59]
    v_xor_b32 v217, 0x10000, v217
    ds_read_b64_tr_b16 v[136:137], v217 offset:0
    v_min_u32_e64 v70, -2, v70
    v_mfma_f32_16x16x32_bf16 v[56:59], v[156:159], a[248:251], v[56:59]
    ds_read_b64_tr_b16 v[138:139], v217 offset:2048
    v_min_u32_e64 v71, -2, v71
    v_mfma_f32_16x16x32_bf16 v[60:63], v[152:155], a[244:247], v[60:63]
    ds_read_b64_tr_b16 v[140:141], v217 offset:8192
    buffer_store_dwordx4 v[68:71], v228, s[8:11], s33 offen offset:1024 sc1
    v_mfma_f32_16x16x32_bf16 v[60:63], v[156:159], a[252:255], v[60:63]
    ds_read_b64_tr_b16 v[142:143], v217 offset:10240
    s_waitcnt lgkmcnt(4)
    v_mfma_f32_16x16x32_bf16 v[32:35], v[128:131], a[0:3], v[32:35]
    v_xor_b32 v218, 0x10000, v218
    ds_read_b64_tr_b16 v[144:145], v218 offset:0
    v_mfma_f32_16x16x32_bf16 v[32:35], v[132:135], a[16:19], v[32:35]
    ds_read_b64_tr_b16 v[146:147], v218 offset:2048
    v_mfma_f32_16x16x32_bf16 v[36:39], v[128:131], a[4:7], v[36:39]
    ds_read_b64_tr_b16 v[148:149], v218 offset:8192
    v_cvt_pk_bf16_f32 v72, v80, v81
    v_mfma_f32_16x16x32_bf16 v[36:39], v[132:135], a[20:23], v[36:39]
    ds_read_b64_tr_b16 v[150:151], v218 offset:10240
    v_cvt_pk_bf16_f32 v73, v82, v83
    s_waitcnt lgkmcnt(4)
    v_mfma_f32_16x16x32_bf16 v[40:43], v[136:139], a[0:3], v[40:43]
    v_xor_b32 v219, 0x10000, v219
    ds_read_b64_tr_b16 v[152:153], v219 offset:0
    v_cvt_pk_bf16_f32 v74, v84, v85
    v_mfma_f32_16x16x32_bf16 v[40:43], v[140:143], a[16:19], v[40:43]
    ds_read_b64_tr_b16 v[154:155], v219 offset:2048
    v_cvt_pk_bf16_f32 v75, v86, v87
    v_mfma_f32_16x16x32_bf16 v[44:47], v[136:139], a[4:7], v[44:47]
    ds_read_b64_tr_b16 v[156:157], v219 offset:8192
    v_min_u32_e64 v72, -2, v72
    v_mfma_f32_16x16x32_bf16 v[44:47], v[140:143], a[20:23], v[44:47]
    ds_read_b64_tr_b16 v[158:159], v219 offset:10240
    v_min_u32 v73, -2, v73
    s_waitcnt lgkmcnt(4)
    v_mfma_f32_16x16x32_bf16 v[48:51], v[144:147], a[0:3], v[48:51]
    ds_read_b64_tr_b16 v[128:129], v216 offset:16384
    v_min_u32_e64 v74, -2, v74
    v_mfma_f32_16x16x32_bf16 v[48:51], v[148:151], a[16:19], v[48:51]
    ds_read_b64_tr_b16 v[130:131], v216 offset:18432
    v_min_u32_e64 v75, -2, v75
    v_mfma_f32_16x16x32_bf16 v[52:55], v[144:147], a[4:7], v[52:55]
    ds_read_b64_tr_b16 v[132:133], v216 offset:24576
    buffer_store_dwordx4 v[72:75], v228, s[8:11], s33 offen offset:2048 sc1
    v_mfma_f32_16x16x32_bf16 v[52:55], v[148:151], a[20:23], v[52:55]
    ds_read_b64_tr_b16 v[134:135], v216 offset:26624
    s_waitcnt lgkmcnt(4)
    v_mfma_f32_16x16x32_bf16 v[56:59], v[152:155], a[0:3], v[56:59]
    ds_read_b64_tr_b16 v[136:137], v217 offset:16384
    v_mfma_f32_16x16x32_bf16 v[56:59], v[156:159], a[16:19], v[56:59]
    ds_read_b64_tr_b16 v[138:139], v217 offset:18432
    v_mfma_f32_16x16x32_bf16 v[60:63], v[152:155], a[4:7], v[60:63]
    ds_read_b64_tr_b16 v[140:141], v217 offset:24576
    v_cvt_pk_bf16_f32 v76, v88, v89
    v_mfma_f32_16x16x32_bf16 v[60:63], v[156:159], a[20:23], v[60:63]
    ds_read_b64_tr_b16 v[142:143], v217 offset:26624
    v_cvt_pk_bf16_f32 v77, v90, v91
    s_waitcnt lgkmcnt(4)
    v_mfma_f32_16x16x32_bf16 v[32:35], v[128:131], a[32:35], v[32:35]
    ds_read_b64_tr_b16 v[144:145], v218 offset:16384
    v_cvt_pk_bf16_f32 v78, v92, v93
    v_mfma_f32_16x16x32_bf16 v[32:35], v[132:135], a[48:51], v[32:35]
    ds_read_b64_tr_b16 v[146:147], v218 offset:18432
    v_cvt_pk_bf16_f32 v79, v94, v95
    v_mfma_f32_16x16x32_bf16 v[36:39], v[128:131], a[36:39], v[36:39]
    ds_read_b64_tr_b16 v[148:149], v218 offset:24576
    v_min_u32_e64 v76, -2, v76
    v_mfma_f32_16x16x32_bf16 v[36:39], v[132:135], a[52:55], v[36:39]
    ds_read_b64_tr_b16 v[150:151], v218 offset:26624
    v_min_u32 v77, -2, v77
    s_waitcnt lgkmcnt(4)
    v_mfma_f32_16x16x32_bf16 v[40:43], v[136:139], a[32:35], v[40:43]
    ds_read_b64_tr_b16 v[152:153], v219 offset:16384
    v_min_u32_e64 v78, -2, v78
    v_mfma_f32_16x16x32_bf16 v[40:43], v[140:143], a[48:51], v[40:43]
    ds_read_b64_tr_b16 v[154:155], v219 offset:18432
    v_min_u32_e64 v79, -2, v79
    v_mfma_f32_16x16x32_bf16 v[44:47], v[136:139], a[36:39], v[44:47]
    ds_read_b64_tr_b16 v[156:157], v219 offset:24576
    buffer_store_dwordx4 v[76:79], v228, s[8:11], s33 offen offset:3072 sc1
    v_mfma_f32_16x16x32_bf16 v[44:47], v[140:143], a[52:55], v[44:47]
    ds_read_b64_tr_b16 v[158:159], v219 offset:26624
    s_waitcnt lgkmcnt(4)
    v_mfma_f32_16x16x32_bf16 v[48:51], v[144:147], a[32:35], v[48:51]
    ds_read_b64_tr_b16 v[128:129], v216 offset:32768
    v_mfma_f32_16x16x32_bf16 v[48:51], v[148:151], a[48:51], v[48:51]
    ds_read_b64_tr_b16 v[130:131], v216 offset:34816
    v_mfma_f32_16x16x32_bf16 v[52:55], v[144:147], a[36:39], v[52:55]
    ds_read_b64_tr_b16 v[132:133], v216 offset:40960
    v_mfma_f32_16x16x32_bf16 v[52:55], v[148:151], a[52:55], v[52:55]
    ds_read_b64_tr_b16 v[134:135], v216 offset:43008
    s_waitcnt lgkmcnt(4)
    v_mfma_f32_16x16x32_bf16 v[56:59], v[152:155], a[32:35], v[56:59]
    ds_read_b64_tr_b16 v[136:137], v217 offset:32768
    v_mfma_f32_16x16x32_bf16 v[56:59], v[156:159], a[48:51], v[56:59]
    ds_read_b64_tr_b16 v[138:139], v217 offset:34816
    v_mfma_f32_16x16x32_bf16 v[60:63], v[152:155], a[36:39], v[60:63]
    ds_read_b64_tr_b16 v[140:141], v217 offset:40960
    v_mfma_f32_16x16x32_bf16 v[60:63], v[156:159], a[52:55], v[60:63]
    ds_read_b64_tr_b16 v[142:143], v217 offset:43008
    s_waitcnt lgkmcnt(4)
    v_mfma_f32_16x16x32_bf16 v[32:35], v[128:131], a[64:67], v[32:35]
    ds_read_b64_tr_b16 v[144:145], v218 offset:32768
    v_mfma_f32_16x16x32_bf16 v[32:35], v[132:135], a[80:83], v[32:35]
    ds_read_b64_tr_b16 v[146:147], v218 offset:34816
    v_mfma_f32_16x16x32_bf16 v[36:39], v[128:131], a[68:71], v[36:39]
    ds_read_b64_tr_b16 v[148:149], v218 offset:40960
    v_mfma_f32_16x16x32_bf16 v[36:39], v[132:135], a[84:87], v[36:39]
    ds_read_b64_tr_b16 v[150:151], v218 offset:43008
    s_waitcnt lgkmcnt(4)
    v_mfma_f32_16x16x32_bf16 v[40:43], v[136:139], a[64:67], v[40:43]
    ds_read_b64_tr_b16 v[152:153], v219 offset:32768
    v_mfma_f32_16x16x32_bf16 v[40:43], v[140:143], a[80:83], v[40:43]
    ds_read_b64_tr_b16 v[154:155], v219 offset:34816
    v_mfma_f32_16x16x32_bf16 v[44:47], v[136:139], a[68:71], v[44:47]
    ds_read_b64_tr_b16 v[156:157], v219 offset:40960
    v_mfma_f32_16x16x32_bf16 v[44:47], v[140:143], a[84:87], v[44:47]
    ds_read_b64_tr_b16 v[158:159], v219 offset:43008
    s_waitcnt lgkmcnt(4)
    v_mfma_f32_16x16x32_bf16 v[48:51], v[144:147], a[64:67], v[48:51]
    ds_read_b64_tr_b16 v[128:129], v216 offset:49152
    v_mfma_f32_16x16x32_bf16 v[48:51], v[148:151], a[80:83], v[48:51]
    ds_read_b64_tr_b16 v[130:131], v216 offset:51200
    v_mfma_f32_16x16x32_bf16 v[52:55], v[144:147], a[68:71], v[52:55]
    ds_read_b64_tr_b16 v[132:133], v216 offset:57344
    v_mfma_f32_16x16x32_bf16 v[52:55], v[148:151], a[84:87], v[52:55]
    ds_read_b64_tr_b16 v[134:135], v216 offset:59392
    s_waitcnt lgkmcnt(4)
    v_mfma_f32_16x16x32_bf16 v[56:59], v[152:155], a[64:67], v[56:59]
    ds_read_b64_tr_b16 v[136:137], v217 offset:49152
    v_mfma_f32_16x16x32_bf16 v[56:59], v[156:159], a[80:83], v[56:59]
    ds_read_b64_tr_b16 v[138:139], v217 offset:51200
    v_mfma_f32_16x16x32_bf16 v[60:63], v[152:155], a[68:71], v[60:63]
    ds_read_b64_tr_b16 v[140:141], v217 offset:57344
    v_mfma_f32_16x16x32_bf16 v[60:63], v[156:159], a[84:87], v[60:63]
    ds_read_b64_tr_b16 v[142:143], v217 offset:59392
    s_waitcnt lgkmcnt(4)
    v_mfma_f32_16x16x32_bf16 v[32:35], v[128:131], a[96:99], v[32:35]
    ds_read_b64_tr_b16 v[144:145], v218 offset:49152
    v_mfma_f32_16x16x32_bf16 v[32:35], v[132:135], a[112:115], v[32:35]
    ds_read_b64_tr_b16 v[146:147], v218 offset:51200
    v_mfma_f32_16x16x32_bf16 v[36:39], v[128:131], a[100:103], v[36:39]
    ds_read_b64_tr_b16 v[148:149], v218 offset:57344
    v_mfma_f32_16x16x32_bf16 v[36:39], v[132:135], a[116:119], v[36:39]
    ds_read_b64_tr_b16 v[150:151], v218 offset:59392
    s_waitcnt lgkmcnt(4)
    v_mfma_f32_16x16x32_bf16 v[40:43], v[136:139], a[96:99], v[40:43]
    ds_read_b64_tr_b16 v[152:153], v219 offset:49152
    v_mfma_f32_16x16x32_bf16 v[40:43], v[140:143], a[112:115], v[40:43]
    ds_read_b64_tr_b16 v[154:155], v219 offset:51200
    v_mfma_f32_16x16x32_bf16 v[44:47], v[136:139], a[100:103], v[44:47]
    ds_read_b64_tr_b16 v[156:157], v219 offset:57344
    v_mfma_f32_16x16x32_bf16 v[44:47], v[140:143], a[116:119], v[44:47]
    ds_read_b64_tr_b16 v[158:159], v219 offset:59392
    s_waitcnt lgkmcnt(4)
    v_mfma_f32_16x16x32_bf16 v[48:51], v[144:147], a[96:99], v[48:51]
    buffer_load_dwordx4 v[96:99], v228, s[8:11], s37 offen offset:0 sc1
    v_mfma_f32_16x16x32_bf16 v[48:51], v[148:151], a[112:115], v[48:51]
    v_mfma_f32_16x16x32_bf16 v[52:55], v[144:147], a[100:103], v[52:55]
    buffer_load_dwordx4 v[100:103], v228, s[8:11], s37 offen offset:1024 sc1
    v_mfma_f32_16x16x32_bf16 v[52:55], v[148:151], a[116:119], v[52:55]
    s_waitcnt lgkmcnt(0)
    v_mfma_f32_16x16x32_bf16 v[56:59], v[152:155], a[96:99], v[56:59]
    buffer_load_dwordx4 v[104:107], v228, s[8:11], s37 offen offset:2048 sc1
    v_mfma_f32_16x16x32_bf16 v[56:59], v[156:159], a[112:115], v[56:59]
    v_mfma_f32_16x16x32_bf16 v[60:63], v[152:155], a[100:103], v[60:63]
    buffer_load_dwordx4 v[108:111], v228, s[8:11], s37 offen offset:3072 sc1
    v_mfma_f32_16x16x32_bf16 v[60:63], v[156:159], a[116:119], v[60:63]
kc_tail:
    buffer_load_dwordx4 v[160:163], v228, s[8:11], s38 offen offset:0 sc1
    buffer_load_dwordx4 v[164:167], v228, s[8:11], s38 offen offset:1024 sc1
    buffer_load_dwordx4 v[168:171], v228, s[8:11], s38 offen offset:2048 sc1
    buffer_load_dwordx4 v[172:175], v228, s[8:11], s38 offen offset:3072 sc1
    v_lshlrev_b32_e64 v128, 16, v192
    v_and_b32 v129, 0xffff0000, v192
    v_lshlrev_b32_e64 v130, 16, v193
    v_and_b32 v131, 0xffff0000, v193
    v_lshlrev_b32_e64 v132, 16, v194
    v_and_b32 v133, 0xffff0000, v194
    v_lshlrev_b32_e64 v134, 16, v195
    v_and_b32 v135, 0xffff0000, v195
    v_lshlrev_b32_e64 v136, 16, v196
    v_and_b32 v137, 0xffff0000, v196
    v_lshlrev_b32_e64 v138, 16, v197
    v_and_b32 v139, 0xffff0000, v197
    v_lshlrev_b32_e64 v140, 16, v198
    v_and_b32 v141, 0xffff0000, v198
    v_lshlrev_b32_e64 v142, 16, v199
    v_and_b32 v143, 0xffff0000, v199
    v_lshlrev_b32_e64 v144, 16, v200
    v_and_b32 v145, 0xffff0000, v200
    v_lshlrev_b32_e64 v146, 16, v201
    v_and_b32 v147, 0xffff0000, v201
    v_lshlrev_b32_e64 v148, 16, v202
    v_and_b32 v149, 0xffff0000, v202
    v_lshlrev_b32_e64 v150, 16, v203
    v_and_b32 v151, 0xffff0000, v203
    v_lshlrev_b32_e64 v152, 16, v204
    v_and_b32 v153, 0xffff0000, v204
    v_lshlrev_b32_e64 v154, 16, v205
    v_and_b32 v155, 0xffff0000, v205
    v_lshlrev_b32_e64 v156, 16, v206
    v_and_b32 v157, 0xffff0000, v206
    v_lshlrev_b32_e64 v158, 16, v207
    v_and_b32 v159, 0xffff0000, v207
    v_lshlrev_b32_e64 v112, 16, v208
    v_and_b32 v113, 0xffff0000, v208
    v_lshlrev_b32_e64 v114, 16, v209
    v_and_b32 v115, 0xffff0000, v209
    v_lshlrev_b32_e64 v116, 16, v210
    v_and_b32 v117, 0xffff0000, v210
    v_lshlrev_b32_e64 v118, 16, v211
    v_and_b32 v119, 0xffff0000, v211
    v_pk_add_f32 v[120:121], v[112:113], v[114:115]
    v_pk_add_f32 v[122:123], v[116:117], v[118:119]
    v_pk_add_f32 v[120:121], v[120:121], v[122:123]
    v_add_f32_e64 v196, v120, v121
    s_barrier
    s_waitcnt vmcnt(12)
    v_max3_u32 v235, v176, v177, v178
    v_max3_u32 v235, v235, v179, v180
    v_max3_u32 v235, v235, v181, v182
    v_max3_u32 v235, v235, v183, v184
    v_max3_u32 v235, v235, v185, v186
    v_max3_u32 v235, v235, v187, v188
    v_max3_u32 v235, v235, v189, v190
    v_max_u32 v235, v235, v191
    v_cmp_eq_u32 vcc, -1, v235
    s_cbranch_vccnz kc_r3
kc_r3o:
    v_lshlrev_b32 v64, 16, v176
    v_and_b32 v65, 0xffff0000, v176
    v_lshlrev_b32_e64 v66, 16, v177
    v_and_b32 v67, 0xffff0000, v177
    v_pk_add_f32 v[32:33], v[32:33], v[64:65]
    v_pk_add_f32 v[34:35], v[34:35], v[66:67]
    v_lshlrev_b32_e64 v68, 16, v178
    v_and_b32 v69, 0xffff0000, v178
    v_lshlrev_b32_e64 v70, 16, v179
    v_and_b32 v71, 0xffff0000, v179
    v_pk_add_f32 v[36:37], v[36:37], v[68:69]
    v_pk_add_f32 v[38:39], v[38:39], v[70:71]
    v_lshlrev_b32_e64 v72, 16, v180
    v_and_b32 v73, 0xffff0000, v180
    v_lshlrev_b32_e64 v74, 16, v181
    v_and_b32 v75, 0xffff0000, v181
    v_pk_add_f32 v[40:41], v[40:41], v[72:73]
    v_pk_add_f32 v[42:43], v[42:43], v[74:75]
    v_lshlrev_b32_e64 v76, 16, v182
    v_and_b32 v77, 0xffff0000, v182
    v_lshlrev_b32_e64 v78, 16, v183
    v_and_b32 v79, 0xffff0000, v183
    v_pk_add_f32 v[44:45], v[44:45], v[76:77]
    v_pk_add_f32 v[46:47], v[46:47], v[78:79]
    v_lshlrev_b32_e64 v80, 16, v184
    v_and_b32 v81, 0xffff0000, v184
    v_lshlrev_b32_e64 v82, 16, v185
    v_and_b32 v83, 0xffff0000, v185
    v_pk_add_f32 v[48:49], v[48:49], v[80:81]
    v_pk_add_f32 v[50:51], v[50:51], v[82:83]
    v_lshlrev_b32_e64 v84, 16, v186
    v_and_b32 v85, 0xffff0000, v186
    v_lshlrev_b32_e64 v86, 16, v187
    v_and_b32 v87, 0xffff0000, v187
    v_pk_add_f32 v[52:53], v[52:53], v[84:85]
    v_pk_add_f32 v[54:55], v[54:55], v[86:87]
    v_lshlrev_b32_e64 v88, 16, v188
    v_and_b32 v89, 0xffff0000, v188
    v_lshlrev_b32_e64 v90, 16, v189
    v_and_b32 v91, 0xffff0000, v189
    v_pk_add_f32 v[56:57], v[56:57], v[88:89]
    v_pk_add_f32 v[58:59], v[58:59], v[90:91]
    v_lshlrev_b32_e64 v92, 16, v190
    v_and_b32 v93, 0xffff0000, v190
    v_lshlrev_b32_e64 v94, 16, v191
    v_and_b32 v95, 0xffff0000, v191
    v_pk_add_f32 v[60:61], v[60:61], v[92:93]
    v_pk_add_f32 v[62:63], v[62:63], v[94:95]
    s_waitcnt vmcnt(4)
    v_max3_u32 v235, v96, v97, v98
    v_max3_u32 v235, v235, v99, v100
    v_max3_u32 v235, v235, v101, v102
    v_max3_u32 v235, v235, v103, v104
    v_max3_u32 v235, v235, v105, v106
    v_max3_u32 v235, v235, v107, v108
    v_max3_u32 v235, v235, v109, v110
    v_max_u32 v235, v235, v111
    v_cmp_eq_u32 vcc, -1, v235
    s_cbranch_vccnz kc_r1
kc_r1o:
    v_lshlrev_b32_e64 v64, 16, v96
    v_and_b32 v65, 0xffff0000, v96
    v_lshlrev_b32_e64 v66, 16, v97
    v_and_b32 v67, 0xffff0000, v97
    v_pk_add_f32 v[32:33], v[32:33], v[64:65]
    v_pk_add_f32 v[34:35], v[34:35], v[66:67]
    v_lshlrev_b32_e64 v68, 16, v98
    v_and_b32 v69, 0xffff0000, v98
    v_lshlrev_b32_e64 v70, 16, v99
    v_and_b32 v71, 0xffff0000, v99
    v_pk_add_f32 v[36:37], v[36:37], v[68:69]
    v_pk_add_f32 v[38:39], v[38:39], v[70:71]
    v_lshlrev_b32_e64 v72, 16, v100
    v_and_b32 v73, 0xffff0000, v100
    v_lshlrev_b32_e64 v74, 16, v101
    v_and_b32 v75, 0xffff0000, v101
    v_pk_add_f32 v[40:41], v[40:41], v[72:73]
    v_pk_add_f32 v[42:43], v[42:43], v[74:75]
    v_lshlrev_b32_e64 v76, 16, v102
    v_and_b32 v77, 0xffff0000, v102
    v_lshlrev_b32_e64 v78, 16, v103
    v_and_b32 v79, 0xffff0000, v103
    v_pk_add_f32 v[44:45], v[44:45], v[76:77]
    v_pk_add_f32 v[46:47], v[46:47], v[78:79]
    v_lshlrev_b32_e64 v80, 16, v104
    v_and_b32 v81, 0xffff0000, v104
    v_lshlrev_b32_e64 v82, 16, v105
    v_and_b32 v83, 0xffff0000, v105
    v_pk_add_f32 v[48:49], v[48:49], v[80:81]
    v_pk_add_f32 v[50:51], v[50:51], v[82:83]
    v_lshlrev_b32_e64 v84, 16, v106
    v_and_b32 v85, 0xffff0000, v106
    v_lshlrev_b32_e64 v86, 16, v107
    v_and_b32 v87, 0xffff0000, v107
    v_pk_add_f32 v[52:53], v[52:53], v[84:85]
    v_pk_add_f32 v[54:55], v[54:55], v[86:87]
    v_lshlrev_b32_e64 v88, 16, v108
    v_and_b32 v89, 0xffff0000, v108
    v_lshlrev_b32_e64 v90, 16, v109
    v_and_b32 v91, 0xffff0000, v109
    v_pk_add_f32 v[56:57], v[56:57], v[88:89]
    v_pk_add_f32 v[58:59], v[58:59], v[90:91]
    v_lshlrev_b32_e64 v92, 16, v110
    v_and_b32 v93, 0xffff0000, v110
    v_lshlrev_b32_e64 v94, 16, v111
    v_and_b32 v95, 0xffff0000, v111
    v_pk_add_f32 v[60:61], v[60:61], v[92:93]
    v_pk_add_f32 v[62:63], v[62:63], v[94:95]
    s_waitcnt vmcnt(0)
    v_max3_u32 v235, v160, v161, v162
    v_max3_u32 v235, v235, v163, v164
    v_max3_u32 v235, v235, v165, v166
    v_max3_u32 v235, v235, v167, v168
    v_max3_u32 v235, v235, v169, v170
    v_max3_u32 v235, v235, v171, v172
    v_max3_u32 v235, v235, v173, v174
    v_max_u32 v235, v235, v175
    v_cmp_eq_u32 vcc, -1, v235
    s_cbranch_vccnz kc_r2
kc_r2o:
    v_lshlrev_b32_e64 v64, 16, v160
    v_and_b32 v65, 0xffff0000, v160
    v_lshlrev_b32_e64 v66, 16, v161
    v_and_b32 v67, 0xffff0000, v161
    v_pk_add_f32 v[32:33], v[32:33], v[64:65]
    v_pk_add_f32 v[34:35], v[34:35], v[66:67]
    v_cvt_pk_bf16_f32 v0, v32, v33
    v_cvt_pk_bf16_f32 v1, v34, v35
    ds_write_b64 v238, v[0:1] offset:0
    v_lshlrev_b32_e64 v68, 16, v162
    v_and_b32 v69, 0xffff0000, v162
    v_lshlrev_b32_e64 v70, 16, v163
    v_and_b32 v71, 0xffff0000, v163
    v_pk_add_f32 v[36:37], v[36:37], v[68:69]
    v_pk_add_f32 v[38:39], v[38:39], v[70:71]
    v_cvt_pk_bf16_f32 v2, v36, v37
    v_cvt_pk_bf16_f32 v3, v38, v39
    ds_write_b64 v238, v[2:3] offset:2304
    v_lshlrev_b32_e64 v72, 16, v164
    v_and_b32 v73, 0xffff0000, v164
    v_lshlrev_b32_e64 v74, 16, v165
    v_and_b32 v75, 0xffff0000, v165
    v_pk_add_f32 v[40:41], v[40:41], v[72:73]
    v_pk_add_f32 v[42:43], v[42:43], v[74:75]
    v_cvt_pk_bf16_f32 v4, v40, v41
    v_cvt_pk_bf16_f32 v5, v42, v43
    ds_write_b64 v238, v[4:5] offset:32
    v_lshlrev_b32_e64 v76, 16, v166
    v_and_b32 v77, 0xffff0000, v166
    v_lshlrev_b32_e64 v78, 16, v167
    v_and_b32 v79, 0xffff0000, v167
    v_pk_add_f32 v[44:45], v[44:45], v[76:77]
    v_pk_add_f32 v[46:47], v[46:47], v[78:79]
    v_cvt_pk_bf16_f32 v6, v44, v45
    v_cvt_pk_bf16_f32 v7, v46, v47
    ds_write_b64 v238, v[6:7] offset:2336
    v_lshlrev_b32_e64 v80, 16, v168
    v_and_b32 v81, 0xffff0000, v168
    v_lshlrev_b32_e64 v82, 16, v169
    v_and_b32 v83, 0xffff0000, v169
    v_pk_add_f32 v[48:49], v[48:49], v[80:81]
    v_pk_add_f32 v[50:51], v[50:51], v[82:83]
    v_cvt_pk_bf16_f32 v8, v48, v49
    v_cvt_pk_bf16_f32 v9, v50, v51
    ds_write_b64 v238, v[8:9] offset:64
    v_lshlrev_b32_e64 v84, 16, v170
    v_and_b32 v85, 0xffff0000, v170
    v_lshlrev_b32_e64 v86, 16, v171
    v_and_b32 v87, 0xffff0000, v171
    v_pk_add_f32 v[52:53], v[52:53], v[84:85]
    v_pk_add_f32 v[54:55], v[54:55], v[86:87]
    v_cvt_pk_bf16_f32 v10, v52, v53
    v_cvt_pk_bf16_f32 v11, v54, v55
    ds_write_b64 v238, v[10:11] offset:2368
    v_lshlrev_b32_e64 v88, 16, v172
    v_and_b32 v89, 0xffff0000, v172
    v_lshlrev_b32_e64 v90, 16, v173
    v_and_b32 v91, 0xffff0000, v173
    v_pk_add_f32 v[56:57], v[56:57], v[88:89]
    v_pk_add_f32 v[58:59], v[58:59], v[90:91]
    v_cvt_pk_bf16_f32 v12, v56, v57
    v_cvt_pk_bf16_f32 v13, v58, v59
    ds_write_b64 v238, v[12:13] offset:96
    v_lshlrev_b32_e64 v92, 16, v174
    v_and_b32 v93, 0xffff0000, v174
    v_lshlrev_b32_e64 v94, 16, v175
    v_and_b32 v95, 0xffff0000, v175
    v_pk_add_f32 v[60:61], v[60:61], v[92:93]
    v_pk_add_f32 v[62:63], v[62:63], v[94:95]
    v_cvt_pk_bf16_f32 v14, v60, v61
    v_cvt_pk_bf16_f32 v15, v62, v63
    ds_write_b64 v238, v[14:15] offset:2400
    s_waitcnt lgkmcnt(0)
    ds_read_b128 v[16:19], v239 offset:0
    ds_read_b128 v[20:23], v239 offset:1152
    ds_read_b128 v[24:27], v239 offset:2304
    ds_read_b128 v[28:31], v239 offset:3456
    s_waitcnt lgkmcnt(3)
    v_lshlrev_b32 v64, 16, v16
    v_lshlrev_b32 v66, 16, v17
    v_lshlrev_b32 v68, 16, v18
    v_lshlrev_b32 v70, 16, v19
    v_and_b32 v65, 0xffff0000, v16
    v_and_b32 v67, 0xffff0000, v17
    v_and_b32 v69, 0xffff0000, v18
    v_and_b32 v71, 0xffff0000, v19
    v_pk_add_f32 v[64:65], v[64:65], v[128:129]
    v_pk_add_f32 v[66:67], v[66:67], v[130:131]
    v_pk_add_f32 v[68:69], v[68:69], v[132:133]
    v_pk_add_f32 v[70:71], v[70:71], v[134:135]
    v_cvt_pk_bf16_f32 v16, v64, v65
    v_cvt_pk_bf16_f32 v17, v66, v67
    v_cvt_pk_bf16_f32 v18, v68, v69
    v_cvt_pk_bf16_f32 v19, v70, v71
    v_lshlrev_b32 v64, 16, v16
    v_lshlrev_b32 v66, 16, v17
    v_lshlrev_b32 v68, 16, v18
    v_lshlrev_b32 v70, 16, v19
    v_and_b32 v65, 0xffff0000, v16
    v_and_b32 v67, 0xffff0000, v17
    v_and_b32 v69, 0xffff0000, v18
    v_and_b32 v71, 0xffff0000, v19
    s_mov_b32 s32, 0x3400000
    buffer_store_dwordx4 v[16:19], v229, s[8:11], s32 offen sc1
    v_pk_add_f32 v[160:161], v[64:65], v[66:67]
    v_pk_mul_f32 v[162:163], v[64:65], v[64:65]
    v_pk_mul_f32 v[164:165], v[64:65], v[112:113]
    v_pk_fma_f32 v[162:163], v[66:67], v[66:67], v[162:163]
    v_pk_fma_f32 v[164:165], v[66:67], v[114:115], v[164:165]
    v_pk_add_f32 v[160:161], v[160:161], v[68:69]
    v_pk_fma_f32 v[162:163], v[68:69], v[68:69], v[162:163]
    v_pk_fma_f32 v[164:165], v[68:69], v[116:117], v[164:165]
    v_pk_add_f32 v[160:161], v[160:161], v[70:71]
    v_pk_fma_f32 v[162:163], v[70:71], v[70:71], v[162:163]
    v_pk_fma_f32 v[164:165], v[70:71], v[118:119], v[164:165]
    v_add_f32 v184, v160, v161
    v_add_f32 v185, v162, v163
    v_add_f32 v186, v164, v165
    s_waitcnt lgkmcnt(2)
    v_lshlrev_b32 v72, 16, v20
    v_lshlrev_b32 v74, 16, v21
    v_lshlrev_b32 v76, 16, v22
    v_lshlrev_b32 v78, 16, v23
    v_and_b32 v73, 0xffff0000, v20
    v_and_b32 v75, 0xffff0000, v21
    v_and_b32 v77, 0xffff0000, v22
    v_and_b32 v79, 0xffff0000, v23
    v_pk_add_f32 v[72:73], v[72:73], v[136:137]
    v_pk_add_f32 v[74:75], v[74:75], v[138:139]
    v_pk_add_f32 v[76:77], v[76:77], v[140:141]
    v_pk_add_f32 v[78:79], v[78:79], v[142:143]
    v_cvt_pk_bf16_f32 v20, v72, v73
    v_cvt_pk_bf16_f32 v21, v74, v75
    v_cvt_pk_bf16_f32 v22, v76, v77
    v_cvt_pk_bf16_f32 v23, v78, v79
    v_lshlrev_b32 v72, 16, v20
    v_lshlrev_b32 v74, 16, v21
    v_lshlrev_b32 v76, 16, v22
    v_lshlrev_b32 v78, 16, v23
    v_and_b32 v73, 0xffff0000, v20
    v_and_b32 v75, 0xffff0000, v21
    v_and_b32 v77, 0xffff0000, v22
    v_and_b32 v79, 0xffff0000, v23
    s_mov_b32 s32, 0x3404000
    buffer_store_dwordx4 v[20:23], v229, s[8:11], s32 offen sc1
    v_pk_add_f32 v[166:167], v[72:73], v[74:75]
    v_pk_mul_f32 v[168:169], v[72:73], v[72:73]
    v_pk_mul_f32 v[170:171], v[72:73], v[112:113]
    v_pk_fma_f32 v[168:169], v[74:75], v[74:75], v[168:169]
    v_pk_fma_f32 v[170:171], v[74:75], v[114:115], v[170:171]
    v_pk_add_f32 v[166:167], v[166:167], v[76:77]
    v_pk_fma_f32 v[168:169], v[76:77], v[76:77], v[168:169]
    v_pk_fma_f32 v[170:171], v[76:77], v[116:117], v[170:171]
    v_pk_add_f32 v[166:167], v[166:167], v[78:79]
    v_pk_fma_f32 v[168:169], v[78:79], v[78:79], v[168:169]
    v_pk_fma_f32 v[170:171], v[78:79], v[118:119], v[170:171]
    v_add_f32 v187, v166, v167
    v_add_f32 v188, v168, v169
    v_add_f32 v189, v170, v171
    s_waitcnt lgkmcnt(1)
    v_lshlrev_b32 v80, 16, v24
    v_lshlrev_b32 v82, 16, v25
    v_lshlrev_b32 v84, 16, v26
    v_lshlrev_b32 v86, 16, v27
    v_and_b32 v81, 0xffff0000, v24
    v_and_b32 v83, 0xffff0000, v25
    v_and_b32 v85, 0xffff0000, v26
    v_and_b32 v87, 0xffff0000, v27
    v_pk_add_f32 v[80:81], v[80:81], v[144:145]
    v_pk_add_f32 v[82:83], v[82:83], v[146:147]
    v_pk_add_f32 v[84:85], v[84:85], v[148:149]
    v_pk_add_f32 v[86:87], v[86:87], v[150:151]
    v_cvt_pk_bf16_f32 v24, v80, v81
    v_cvt_pk_bf16_f32 v25, v82, v83
    v_cvt_pk_bf16_f32 v26, v84, v85
    v_cvt_pk_bf16_f32 v27, v86, v87
    v_lshlrev_b32 v80, 16, v24
    v_lshlrev_b32 v82, 16, v25
    v_lshlrev_b32 v84, 16, v26
    v_lshlrev_b32 v86, 16, v27
    v_and_b32 v81, 0xffff0000, v24
    v_and_b32 v83, 0xffff0000, v25
    v_and_b32 v85, 0xffff0000, v26
    v_and_b32 v87, 0xffff0000, v27
    s_mov_b32 s32, 0x3408000
    buffer_store_dwordx4 v[24:27], v229, s[8:11], s32 offen sc1
    v_pk_add_f32 v[172:173], v[80:81], v[82:83]
    v_pk_mul_f32 v[174:175], v[80:81], v[80:81]
    v_pk_mul_f32 v[176:177], v[80:81], v[112:113]
    v_pk_fma_f32 v[174:175], v[82:83], v[82:83], v[174:175]
    v_pk_fma_f32 v[176:177], v[82:83], v[114:115], v[176:177]
    v_pk_add_f32 v[172:173], v[172:173], v[84:85]
    v_pk_fma_f32 v[174:175], v[84:85], v[84:85], v[174:175]
    v_pk_fma_f32 v[176:177], v[84:85], v[116:117], v[176:177]
    v_pk_add_f32 v[172:173], v[172:173], v[86:87]
    v_pk_fma_f32 v[174:175], v[86:87], v[86:87], v[174:175]
    v_pk_fma_f32 v[176:177], v[86:87], v[118:119], v[176:177]
    v_add_f32 v190, v172, v173
    v_add_f32 v191, v174, v175
    v_add_f32 v192, v176, v177
    s_waitcnt lgkmcnt(0)
    v_lshlrev_b32 v88, 16, v28
    v_lshlrev_b32 v90, 16, v29
    v_lshlrev_b32 v92, 16, v30
    v_lshlrev_b32 v94, 16, v31
    v_and_b32 v89, 0xffff0000, v28
    v_and_b32 v91, 0xffff0000, v29
    v_and_b32 v93, 0xffff0000, v30
    v_and_b32 v95, 0xffff0000, v31
    v_pk_add_f32 v[88:89], v[88:89], v[152:153]
    v_pk_add_f32 v[90:91], v[90:91], v[154:155]
    v_pk_add_f32 v[92:93], v[92:93], v[156:157]
    v_pk_add_f32 v[94:95], v[94:95], v[158:159]
    v_cvt_pk_bf16_f32 v28, v88, v89
    v_cvt_pk_bf16_f32 v29, v90, v91
    v_cvt_pk_bf16_f32 v30, v92, v93
    v_cvt_pk_bf16_f32 v31, v94, v95
    v_lshlrev_b32 v88, 16, v28
    v_lshlrev_b32 v90, 16, v29
    v_lshlrev_b32 v92, 16, v30
    v_lshlrev_b32 v94, 16, v31
    v_and_b32 v89, 0xffff0000, v28
    v_and_b32 v91, 0xffff0000, v29
    v_and_b32 v93, 0xffff0000, v30
    v_and_b32 v95, 0xffff0000, v31
    s_mov_b32 s32, 0x340c000
    buffer_store_dwordx4 v[28:31], v229, s[8:11], s32 offen sc1
    v_pk_add_f32 v[178:179], v[88:89], v[90:91]
    v_pk_mul_f32 v[180:181], v[88:89], v[88:89]
    v_pk_mul_f32 v[182:183], v[88:89], v[112:113]
    v_pk_fma_f32 v[180:181], v[90:91], v[90:91], v[180:181]
    v_pk_fma_f32 v[182:183], v[90:91], v[114:115], v[182:183]
    v_pk_add_f32 v[178:179], v[178:179], v[92:93]
    v_pk_fma_f32 v[180:181], v[92:93], v[92:93], v[180:181]
    v_pk_fma_f32 v[182:183], v[92:93], v[116:117], v[182:183]
    v_pk_add_f32 v[178:179], v[178:179], v[94:95]
    v_pk_fma_f32 v[180:181], v[94:95], v[94:95], v[180:181]
    v_pk_fma_f32 v[182:183], v[94:95], v[118:119], v[182:183]
    v_add_f32 v193, v178, v179
    v_add_f32 v194, v180, v181
    v_add_f32_e64 v195, v182, v183
    v_add_f32_dpp v196, v196, v196 quad_perm:[1,0,3,2] row_mask:0xf bank_mask:0xf
    v_add_f32_dpp v184, v184, v184 quad_perm:[1,0,3,2] row_mask:0xf bank_mask:0xf
    v_add_f32_dpp v185, v185, v185 quad_perm:[1,0,3,2] row_mask:0xf bank_mask:0xf
    v_add_f32_dpp v186, v186, v186 quad_perm:[1,0,3,2] row_mask:0xf bank_mask:0xf
    v_add_f32_dpp v187, v187, v187 quad_perm:[1,0,3,2] row_mask:0xf bank_mask:0xf
    v_add_f32_dpp v188, v188, v188 quad_perm:[1,0,3,2] row_mask:0xf bank_mask:0xf
    v_add_f32_dpp v189, v189, v189 quad_perm:[1,0,3,2] row_mask:0xf bank_mask:0xf
    v_add_f32_dpp v190, v190, v190 quad_perm:[1,0,3,2] row_mask:0xf bank_mask:0xf
    v_add_f32_dpp v191, v191, v191 quad_perm:[1,0,3,2] row_mask:0xf bank_mask:0xf
    v_add_f32_dpp v192, v192, v192 quad_perm:[1,0,3,2] row_mask:0xf bank_mask:0xf
    v_add_f32_dpp v193, v193, v193 quad_perm:[1,0,3,2] row_mask:0xf bank_mask:0xf
    v_add_f32_dpp v194, v194, v194 quad_perm:[1,0,3,2] row_mask:0xf bank_mask:0xf
    v_add_f32_dpp v195, v195, v195 quad_perm:[1,0,3,2] row_mask:0xf bank_mask:0xf
    v_add_f32_dpp v196, v196, v196 quad_perm:[2,3,0,1] row_mask:0xf bank_mask:0xf
    v_add_f32_dpp v184, v184, v184 quad_perm:[2,3,0,1] row_mask:0xf bank_mask:0xf
    v_add_f32_dpp v185, v185, v185 quad_perm:[2,3,0,1] row_mask:0xf bank_mask:0xf
    v_add_f32_dpp v186, v186, v186 quad_perm:[2,3,0,1] row_mask:0xf bank_mask:0xf
    v_add_f32_dpp v187, v187, v187 quad_perm:[2,3,0,1] row_mask:0xf bank_mask:0xf
    v_add_f32_dpp v188, v188, v188 quad_perm:[2,3,0,1] row_mask:0xf bank_mask:0xf
    v_add_f32_dpp v189, v189, v189 quad_perm:[2,3,0,1] row_mask:0xf bank_mask:0xf
    v_add_f32_dpp v190, v190, v190 quad_perm:[2,3,0,1] row_mask:0xf bank_mask:0xf
    v_add_f32_dpp v191, v191, v191 quad_perm:[2,3,0,1] row_mask:0xf bank_mask:0xf
    v_add_f32_dpp v192, v192, v192 quad_perm:[2,3,0,1] row_mask:0xf bank_mask:0xf
    v_add_f32_dpp v193, v193, v193 quad_perm:[2,3,0,1] row_mask:0xf bank_mask:0xf
    v_add_f32_dpp v194, v194, v194 quad_perm:[2,3,0,1] row_mask:0xf bank_mask:0xf
    v_add_f32_dpp v195, v195, v195 quad_perm:[2,3,0,1] row_mask:0xf bank_mask:0xf
    v_add_f32_dpp v196, v196, v196 row_half_mirror row_mask:0xf bank_mask:0xf
    v_add_f32_dpp v184, v184, v184 row_half_mirror row_mask:0xf bank_mask:0xf
    v_add_f32_dpp v185, v185, v185 row_half_mirror row_mask:0xf bank_mask:0xf
    v_add_f32_dpp v186, v186, v186 row_half_mirror row_mask:0xf bank_mask:0xf
    v_add_f32_dpp v187, v187, v187 row_half_mirror row_mask:0xf bank_mask:0xf
    v_add_f32_dpp v188, v188, v188 row_half_mirror row_mask:0xf bank_mask:0xf
    v_add_f32_dpp v189, v189, v189 row_half_mirror row_mask:0xf bank_mask:0xf
    v_add_f32_dpp v190, v190, v190 row_half_mirror row_mask:0xf bank_mask:0xf
    v_add_f32_dpp v191, v191, v191 row_half_mirror row_mask:0xf bank_mask:0xf
    v_add_f32_dpp v192, v192, v192 row_half_mirror row_mask:0xf bank_mask:0xf
    v_add_f32_dpp v193, v193, v193 row_half_mirror row_mask:0xf bank_mask:0xf
    v_add_f32_dpp v194, v194, v194 row_half_mirror row_mask:0xf bank_mask:0xf
    v_add_f32_dpp v195, v195, v195 row_half_mirror row_mask:0xf bank_mask:0xf
    v_cndmask_b32 v184, v184, v187, s[60:61]
    v_cndmask_b32 v190, v190, v193, s[60:61]
    v_cndmask_b32 v185, v185, v188, s[60:61]
    v_cndmask_b32 v191, v191, v194, s[60:61]
    v_cndmask_b32 v186, v186, v189, s[60:61]
    v_cndmask_b32 v192, v192, v195, s[60:61]
    v_cndmask_b32 v184, v184, v190, s[62:63]
    v_cndmask_b32 v185, v185, v191, s[62:63]
    v_cndmask_b32 v186, v186, v192, s[62:63]
    v_cndmask_b32 v184, v184, v185, s[40:41]
    v_cndmask_b32 v186, v186, v196, s[40:41]
    buffer_atomic_add_f32 v184, v231, s[8:11], s48 offen
    buffer_atomic_add_f32 v186, v232, s[8:11], s48 offen
    s_lshl_b32 s32, s3, 13
    v_add_u32 v234, s32, v228
    v_add_u32 v235, 65536, v234
    ds_write_b128 v234, a[128:131] offset:0
    ds_write_b128 v234, a[132:135] offset:1024
    ds_write_b128 v234, a[136:139] offset:2048
    ds_write_b128 v234, a[140:143] offset:3072
    ds_write_b128 v234, a[144:147] offset:4096
    ds_write_b128 v234, a[148:151] offset:5120
    ds_write_b128 v234, a[152:155] offset:6144
    ds_write_b128 v234, a[156:159] offset:7168
    s_waitcnt lgkmcnt(4)
    ds_write_b128 v234, a[160:163] offset:32768
    ds_write_b128 v234, a[164:167] offset:33792
    ds_write_b128 v234, a[168:171] offset:34816
    ds_write_b128 v234, a[172:175] offset:35840
    ds_write_b128 v234, a[176:179] offset:36864
    ds_write_b128 v234, a[180:183] offset:37888
    ds_write_b128 v234, a[184:187] offset:38912
    ds_write_b128 v234, a[188:191] offset:39936
    s_waitcnt lgkmcnt(4)
    ds_write_b128 v235, a[192:195] offset:0
    ds_write_b128 v235, a[196:199] offset:1024
    ds_write_b128 v235, a[200:203] offset:2048
    ds_write_b128 v235, a[204:207] offset:3072
    ds_write_b128 v235, a[208:211] offset:4096
    ds_write_b128 v235, a[212:215] offset:5120
    ds_write_b128 v235, a[216:219] offset:6144
    ds_write_b128 v235, a[220:223] offset:7168
    s_waitcnt lgkmcnt(4)
    s_lshl_b32 s35, s3, 13
    v_bfe_u32 v234, v237, 2, 3
    v_lshrrev_b32_e64 v235, 5, v237
    v_lshl_add_u32 v234, v235, 4, v234
    v_lshlrev_b32 v234, 5, v234
    v_and_b32 v236, 3, v237
    v_lshl_add_u32 v234, v236, 3, v234
    v_add_u32 v217, s35, v234
    v_lshlrev_b32 v235, 5, v235
    v_bfe_u32 v236, v237, 4, 1
    v_lshl_add_u32 v235, v236, 3, v235
    v_and_b32_e64 v236, 1, v237
    v_lshl_add_u32 v235, v236, 11, v235
    s_lshl_b32 s32, s3, 9
    s_add_u32 s32, s32, 98304
    v_add_u32 v218, s32, v235
    v_lshlrev_b32_e64 v234, 4, v230
    v_add_u32 v220, 106752, v234
    v_add_u32 v221, 106752, v228
    v_lshrrev_b32 v236, 2, v237
    v_lshlrev_b32 v236, 7, v236
    v_and_b32_e64 v234, 3, v237
    v_lshl_add_u32 v236, v234, 3, v236
    s_add_u32 s32, s35, 65536
    v_add_u32 v219, s32, v236
    s_lshl_b32 s32, s3, 12
    s_add_u32 s32, s32, 114944
    v_and_b32 v234, 15, v237
    v_min_u32 v234, 2, v234
    v_lshlrev_b32 v234, 10, v234
    v_lshrrev_b32 v235, 4, v237
    v_lshl_add_u32 v234, v235, 4, v234
    v_add_u32 v222, s32, v234
    v_add_u32 v223, s32, v228
    s_mov_b32 s12, 0x00030003
    s_mov_b32 s13, 0x00030003
    s_lshl_b64 s[14:15], s[12:13], 2
    s_lshl_b64 s[16:17], s[12:13], 4
    s_lshl_b64 s[18:19], s[12:13], 6
    s_lshl_b64 s[20:21], s[12:13], 8
    s_lshl_b64 s[22:23], s[12:13], 10
    s_lshl_b64 s[24:25], s[12:13], 12
    s_lshl_b64 s[26:27], s[12:13], 14
    v_and_b32 v234, 1, v237
    v_lshlrev_b32_e64 v234, 12, v234
    v_bfe_u32 v235, v237, 1, 3
    v_lshl_add_u32 v234, v235, 6, v234
    v_lshrrev_b32_e64 v235, 4, v237
    v_lshl_add_u32 v222, v235, 4, v234
    s_lshl_b32 s38, s54, 13
    s_lshl_b32 s33, s3, 10
    s_add_u32 s38, s38, s33
    s_add_u32 s38, s38, 0x3900000
    s_waitcnt vmcnt(0)
    s_barrier
    s_cmp_lg_u32 s3, 0
    s_cbranch_scc1 kc_a1
    s_lshl_b32 s32, s52, 7
    s_add_u32 s32, s32, 0x38a0000
    v_mov_b32_e64 v235, 1
    buffer_atomic_add v235, v243, s[8:11], s32 offen sc0 sc1
    v_lshlrev_b32 v234, 7, v237
    v_cmp_gt_u32 vcc, 8, v237
    v_mov_b32_e64 v236, 0x40000000
    s_mov_b32 s34, 0x38a0400
    v_cndmask_b32 v234, v236, v234, vcc
    s_waitcnt vmcnt(0)
    v_readfirstlane_b32 s36, v235
    s_cmp_lg_u32 s36, 31
    s_cbranch_scc1 kc_a1
    buffer_atomic_add v233, v234, s[8:11], s34 offen sc1
kc_a1:
    s_waitcnt lgkmcnt(0)
    ds_read_b64_tr_b16 a[0:1], v217 offset:0
    ds_read_b64_tr_b16 a[2:3], v217 offset:256
    ds_read_b64_tr_b16 a[32:33], v217 offset:32768
    ds_read_b64_tr_b16 a[34:35], v217 offset:33024
    ds_read_b64_tr_b16 a[4:5], v217 offset:1024
    ds_read_b64_tr_b16 a[6:7], v217 offset:1280
    ds_read_b64_tr_b16 a[36:37], v217 offset:33792
    ds_read_b64_tr_b16 a[38:39], v217 offset:34048
    s_waitcnt lgkmcnt(6)
    ds_read_b64_tr_b16 a[8:9], v217 offset:2048
    ds_read_b64_tr_b16 a[10:11], v217 offset:2304
    ds_read_b64_tr_b16 a[40:41], v217 offset:34816
    ds_read_b64_tr_b16 a[42:43], v217 offset:35072
    ds_read_b64_tr_b16 a[12:13], v217 offset:3072
    ds_read_b64_tr_b16 a[14:15], v217 offset:3328
    ds_read_b64_tr_b16 a[44:45], v217 offset:35840
    ds_read_b64_tr_b16 a[46:47], v217 offset:36096
    s_waitcnt lgkmcnt(6)
    ds_read_b64_tr_b16 a[16:17], v217 offset:4096
    ds_read_b64_tr_b16 a[18:19], v217 offset:4352
    ds_read_b64_tr_b16 a[48:49], v217 offset:36864
    ds_read_b64_tr_b16 a[50:51], v217 offset:37120
    ds_read_b64_tr_b16 a[20:21], v217 offset:5120
    ds_read_b64_tr_b16 a[22:23], v217 offset:5376
    ds_read_b64_tr_b16 a[52:53], v217 offset:37888
    ds_read_b64_tr_b16 a[54:55], v217 offset:38144
    s_waitcnt lgkmcnt(6)
    ds_read_b64_tr_b16 a[24:25], v217 offset:6144
    ds_read_b64_tr_b16 a[26:27], v217 offset:6400
    ds_read_b64_tr_b16 a[56:57], v217 offset:38912
    ds_read_b64_tr_b16 a[58:59], v217 offset:39168
    ds_read_b64_tr_b16 a[28:29], v217 offset:7168
    ds_read_b64_tr_b16 a[30:31], v217 offset:7424
    ds_read_b64_tr_b16 a[60:61], v217 offset:39936
    ds_read_b64_tr_b16 a[62:63], v217 offset:40192
    s_waitcnt lgkmcnt(6)
    ds_read_b64_tr_b16 a[64:65], v219 offset:0
    ds_read_b64_tr_b16 a[66:67], v219 offset:32
    ds_read_b64_tr_b16 a[68:69], v219 offset:64
    ds_read_b64_tr_b16 a[70:71], v219 offset:96
    ds_read_b64_tr_b16 a[72:73], v219 offset:2048
    ds_read_b64_tr_b16 a[74:75], v219 offset:2080
    ds_read_b64_tr_b16 a[76:77], v219 offset:2112
    ds_read_b64_tr_b16 a[78:79], v219 offset:2144
    s_waitcnt lgkmcnt(6)
    ds_read_b64_tr_b16 a[80:81], v219 offset:4096
    ds_read_b64_tr_b16 a[82:83], v219 offset:4128
    ds_read_b64_tr_b16 a[84:85], v219 offset:4160
    ds_read_b64_tr_b16 a[86:87], v219 offset:4192
    ds_read_b64_tr_b16 a[88:89], v219 offset:6144
    ds_read_b64_tr_b16 a[90:91], v219 offset:6176
    ds_read_b64_tr_b16 a[92:93], v219 offset:6208
    ds_read_b64_tr_b16 a[94:95], v219 offset:6240
    s_waitcnt lgkmcnt(6)
    v_mov_b32 v130, 0x3a800000
    v_mov_b32 v131, 0x3a800000
    v_mov_b32 v132, 0x3727c5ac
    v_mov_b32 v133, 0x3727c5ac
    s_mov_b32 s33, 0xfffff800
    s_lshl_b32 s39, s3, 11
    v_add_u32 v238, s39, v228
    v_lshlrev_b32 v239, 2, v242
    s_lshl_b32 s39, s3, 3
    s_add_u32 s7, s39, 106512
    v_lshlrev_b32 v141, 5, v237
    v_or_b32_e64 v141, s39, v141
    s_cmp_lg_u32 s3, 0
    s_cbranch_scc1 kc_b12
    s_lshl_b32 s32, s52, 7
    s_add_u32 s32, s32, 0x38a0400
    s_mov_b32 s34, 0x400000
    s_branch kc_b11
kc_b10:
    s_sleep 2
kc_b11:
    buffer_load_dword v235, off, s[8:11], s32 sc1
    s_waitcnt vmcnt(0)
    v_cmp_ne_u32 vcc, 8, v235
    s_sub_u32 s34, s34, 1
    s_cbranch_scc1 kc_b12
    s_cbranch_vccnz kc_b10
kc_b12:
    s_barrier
    s_add_u32 s32, s48, 24576
    buffer_load_dword v128, off, s[8:11], s32 sc1
    buffer_load_dwordx4 v[32:35], v238, s[8:11], s48 offen offset:0 sc1
    buffer_load_dwordx4 v[40:43], v238, s[8:11], s49 offen offset:0 sc1
    buffer_load_dwordx4 v[48:51], v238, s[8:11], s50 offen offset:0 sc1
    buffer_load_dwordx4 v[36:39], v238, s[8:11], s48 offen offset:1024 sc1
    buffer_load_dwordx4 v[44:47], v238, s[8:11], s49 offen offset:1024 sc1
    buffer_load_dwordx4 v[52:55], v238, s[8:11], s50 offen offset:1024 sc1
    buffer_load_dword v0, v239, s[8:11], s48 offen offset:0 sc1
    buffer_load_dword v4, v239, s[8:11], s49 offen offset:0 sc1
    buffer_load_dword v1, v239, s[8:11], s48 offen offset:32 sc1
    buffer_load_dword v5, v239, s[8:11], s49 offen offset:32 sc1
    buffer_load_dword v2, v239, s[8:11], s48 offen offset:64 sc1
    buffer_load_dword v6, v239, s[8:11], s49 offen offset:64 sc1
    buffer_load_dword v3, v239, s[8:11], s48 offen offset:96 sc1
    buffer_load_dword v7, v239, s[8:11], s49 offen offset:96 sc1
    s_waitcnt vmcnt(8)
    v_mov_b32 v129, v128
    v_pk_mul_f32 v[32:33], v[32:33], v[130:131]
    v_pk_mul_f32 v[34:35], v[34:35], v[130:131]
    v_pk_mul_f32 v[36:37], v[36:37], v[130:131]
    v_pk_mul_f32 v[38:39], v[38:39], v[130:131]
    v_pk_fma_f32 v[40:41], v[40:41], v[130:131], v[132:133]
    v_pk_fma_f32 v[42:43], v[42:43], v[130:131], v[132:133]
    v_pk_fma_f32 v[44:45], v[44:45], v[130:131], v[132:133]
    v_pk_fma_f32 v[46:47], v[46:47], v[130:131], v[132:133]
    v_pk_fma_f32 v[40:41], v[32:33], v[32:33], v[40:41] neg_lo:[1,0,0] neg_hi:[1,0,0]
    v_pk_fma_f32 v[42:43], v[34:35], v[34:35], v[42:43] neg_lo:[1,0,0] neg_hi:[1,0,0]
    v_pk_fma_f32 v[44:45], v[36:37], v[36:37], v[44:45] neg_lo:[1,0,0] neg_hi:[1,0,0]
    v_pk_fma_f32 v[46:47], v[38:39], v[38:39], v[46:47] neg_lo:[1,0,0] neg_hi:[1,0,0]
    v_pk_fma_f32 v[48:49], v[32:33], v[128:129], v[48:49] neg_lo:[1,0,0] neg_hi:[1,0,0]
    v_pk_fma_f32 v[50:51], v[34:35], v[128:129], v[50:51] neg_lo:[1,0,0] neg_hi:[1,0,0]
    v_pk_fma_f32 v[52:53], v[36:37], v[128:129], v[52:53] neg_lo:[1,0,0] neg_hi:[1,0,0]
    v_pk_fma_f32 v[54:55], v[38:39], v[128:129], v[54:55] neg_lo:[1,0,0] neg_hi:[1,0,0]
    v_max_f32 v40, v40, v132
    v_max_f32 v42, v42, v132
    v_max_f32 v44, v44, v132
    v_max_f32 v46, v46, v132
    v_max_f32 v41, v41, v132
    v_max_f32 v43, v43, v132
    v_max_f32 v45, v45, v132
    v_max_f32 v47, v47, v132
    v_rsq_f32 v40, v40
    v_rsq_f32 v42, v42
    v_rsq_f32 v44, v44
    v_rsq_f32 v46, v46
    v_rsq_f32 v41, v41
    v_rsq_f32 v43, v43
    v_rsq_f32 v45, v45
    v_rsq_f32 v47, v47
    v_pk_mul_f32 v[48:49], v[48:49], v[40:41]
    v_pk_mul_f32 v[50:51], v[50:51], v[42:43]
    v_pk_mul_f32 v[52:53], v[52:53], v[44:45]
    v_pk_mul_f32 v[54:55], v[54:55], v[46:47]
    v_and_or_b32 v48, v48, s33, 0
    v_and_or_b32 v50, v50, s33, 2
    v_and_or_b32 v52, v52, s33, 4
    v_and_or_b32 v54, v54, s33, 6
    v_and_or_b32 v49, v49, s33, 1
    v_and_or_b32 v51, v51, s33, 3
    v_and_or_b32 v53, v53, s33, 5
    v_and_or_b32 v55, v55, s33, 7
    v_max_f32 v136, v48, v49
    v_min_f32 v137, v48, v49
    v_med3_f32 v137, v136, v50, v137
    v_max_f32_e64 v136, v136, v50
    v_med3_f32 v137, v136, v51, v137
    v_max_f32_e64 v136, v136, v51
    v_med3_f32 v137, v136, v52, v137
    v_max_f32_e64 v136, v136, v52
    v_med3_f32 v137, v136, v53, v137
    v_max_f32_e64 v136, v136, v53
    v_med3_f32 v137, v136, v54, v137
    v_max_f32_e64 v136, v136, v54
    v_med3_f32 v137, v136, v55, v137
    v_max_f32 v136, v136, v55
    v_or_b32 v136, v141, v136
    v_or_b32 v137, v141, v137
    s_nop 1
    v_mov_b32_dpp v138, v136 quad_perm:[1,0,3,2] row_mask:0xf bank_mask:0xf
    v_mov_b32_dpp v139, v137 quad_perm:[1,0,3,2] row_mask:0xf bank_mask:0xf
    v_min_f32 v140, v136, v138
    v_max_f32 v136, v136, v138
    v_max3_f32 v137, v140, v137, v139
    s_nop 1
    v_mov_b32_dpp v138, v136 quad_perm:[2,3,0,1] row_mask:0xf bank_mask:0xf
    v_mov_b32_dpp v139, v137 quad_perm:[2,3,0,1] row_mask:0xf bank_mask:0xf
    v_min_f32 v140, v136, v138
    v_max_f32_e64 v136, v136, v138
    v_max3_f32 v137, v140, v137, v139
    s_nop 1
    v_mov_b32_dpp v138, v136 row_half_mirror row_mask:0xf bank_mask:0xf
    v_mov_b32_dpp v139, v137 row_half_mirror row_mask:0xf bank_mask:0xf
    v_min_f32 v140, v136, v138
    v_max_f32_e64 v136, v136, v138
    v_max3_f32 v137, v140, v137, v139
    s_nop 1
    v_mov_b32_dpp v138, v136 row_mirror row_mask:0xf bank_mask:0xf
    v_mov_b32_dpp v139, v137 row_mirror row_mask:0xf bank_mask:0xf
    v_min_f32 v140, v136, v138
    v_max_f32_e64 v136, v136, v138
    v_max3_f32 v137, v140, v137, v139
    v_mov_b32 v138, v136
    v_mov_b32 v139, v137
    s_nop 1
    v_permlane16_swap_b32 v136, v138
    v_permlane16_swap_b32 v137, v139
    s_nop 0
    v_min_f32 v140, v136, v138
    v_max_f32 v136, v136, v138
    v_max3_f32 v137, v140, v137, v139
    v_mov_b32 v138, v136
    v_mov_b32 v139, v137
    s_nop 1
    v_permlane32_swap_b32 v136, v138
    v_permlane32_swap_b32 v137, v139
    s_nop 0
    v_min_f32 v140, v136, v138
    v_max_f32 v136, v136, v138
    v_max3_f32 v137, v140, v137, v139
    v_mov_b32_e64 v234, s7
    ds_write_b64 v234, v[136:137]
    v_mov_b32 v234, 106512
    s_waitcnt lgkmcnt(0)
    s_barrier
    ds_read_b128 v[56:59], v234
    ds_read_b128 v[60:63], v234 offset:16
    s_waitcnt lgkmcnt(0)
    v_min_f32 v140, v56, v58
    v_max_f32_e64 v56, v56, v58
    v_max3_f32 v57, v140, v57, v59
    v_min_f32 v140, v60, v62
    v_max_f32 v60, v60, v62
    v_max3_f32 v61, v140, v61, v63
    v_min_f32 v140, v56, v60
    v_max_f32 v56, v56, v60
    v_max3_f32 v57, v140, v57, v61
    v_bfe_u32 v234, v56, 5, 6
    v_bfe_u32 v235, v56, 2, 3
    v_and_b32_e64 v8, 3, v56
    v_lshl_add_u32 v8, v234, 2, v8
    v_lshl_add_u32 v8, v235, 8, v8
    v_bfe_u32 v234, v57, 5, 6
    v_bfe_u32 v235, v57, 2, 3
    v_and_b32_e64 v10, 3, v57
    v_lshl_add_u32 v10, v234, 2, v10
    v_lshl_add_u32 v10, v235, 8, v10
    s_cmp_lt_u32 s3, 2
    s_cselect_b64 vcc, -1, 0
    v_lshlrev_b32 v236, 4, v230
    v_cndmask_b32 v142, v10, v8, vcc
    v_lshlrev_b32_e64 v234, 2, v142
    v_and_b32 v235, 2047, v236
    v_lshl_add_u32 v235, v142, 11, v235
    s_mov_b32 s32, 0x3400000
    buffer_load_dwordx4 v[32:35], v235, s[8:11], s32 offen sc1
    buffer_load_dword v144, v234, s[8:11], s48 offen sc1
    buffer_load_dword v145, v234, s[8:11], s49 offen sc1
    buffer_load_dword v146, v234, s[8:11], s50 offen sc1
    v_add_u32 v236, 98304, v236
    s_lshr_b32 s32, s3, 1
    s_lshl_b32 s32, s32, 2
    s_add_u32 s32, s32, 106496
    v_mov_b32 v234, s32
    s_waitcnt vmcnt(4)
    v_mul_f32 v0, 0x3a800000, v0
    v_mul_f32 v1, 0x3a800000, v1
    v_mul_f32 v2, 0x3a800000, v2
    v_mul_f32 v3, 0x3a800000, v3
    v_mul_f32 v4, 0x3a800000, v4
    v_mul_f32 v5, 0x3a800000, v5
    v_mul_f32 v6, 0x3a800000, v6
    v_mul_f32 v7, 0x3a800000, v7
    v_fma_f32 v4, -v0, v0, v4
    v_fma_f32 v5, -v1, v1, v5
    v_fma_f32 v6, -v2, v2, v6
    v_fma_f32 v7, -v3, v3, v7
    v_max_f32 v4, 0, v4
    v_max_f32 v5, 0, v5
    v_max_f32 v6, 0, v6
    v_max_f32 v7, 0, v7
    v_cvt_pk_bf16_f32 v12, v0, v4
    v_cvt_pk_bf16_f32 v13, v1, v5
    v_cvt_pk_bf16_f32 v14, v2, v6
    v_cvt_pk_bf16_f32 v15, v3, v7
    v_lshlrev_b32 v0, 16, v12
    v_lshlrev_b32 v1, 16, v13
    v_lshlrev_b32 v2, 16, v14
    v_lshlrev_b32 v3, 16, v15
    v_and_b32 v4, 0xffff0000, v12
    v_and_b32 v5, 0xffff0000, v13
    v_and_b32 v6, 0xffff0000, v14
    v_and_b32 v7, 0xffff0000, v15
    v_add_f32 v4, 0x3727c5ac, v4
    v_add_f32 v5, 0x3727c5ac, v5
    v_add_f32 v6, 0x3727c5ac, v6
    v_add_f32 v7, 0x3727c5ac, v7
    v_cvt_pk_bf16_f32 v4, v4, v4
    v_cvt_pk_bf16_f32 v5, v5, v5
    v_cvt_pk_bf16_f32 v6, v6, v6
    v_cvt_pk_bf16_f32 v7, v7, v7
    v_lshlrev_b32 v4, 16, v4
    v_lshlrev_b32 v5, 16, v5
    v_lshlrev_b32 v6, 16, v6
    v_lshlrev_b32 v7, 16, v7
    v_sqrt_f32 v4, v4
    v_sqrt_f32 v5, v5
    v_sqrt_f32 v6, v6
    v_sqrt_f32 v7, v7
    v_cvt_pk_bf16_f32 v4, v4, v4
    v_cvt_pk_bf16_f32 v5, v5, v5
    v_cvt_pk_bf16_f32 v6, v6, v6
    v_cvt_pk_bf16_f32 v7, v7, v7
    v_lshlrev_b32 v4, 16, v4
    v_lshlrev_b32 v5, 16, v5
    v_lshlrev_b32 v6, 16, v6
    v_lshlrev_b32 v7, 16, v7
    v_rcp_f32 v4, v4
    v_rcp_f32 v5, v5
    v_rcp_f32 v6, v6
    v_rcp_f32_e64 v7, v7
    s_waitcnt vmcnt(0)
    v_mul_f32 v144, 0x3a800000, v144
    v_mul_f32 v145, 0x3a800000, v145
    v_fma_f32 v145, -v144, v144, v145
    v_max_f32_e64 v145, 0, v145
    v_cvt_pk_bf16_f32 v140, v144, v145
    v_lshlrev_b32_e64 v144, 16, v140
    v_and_b32 v145, 0xffff0000, v140
    v_add_f32 v145, 0x3727c5ac, v145
    v_cvt_pk_bf16_f32 v145, v145, v145
    v_lshlrev_b32_e64 v145, 16, v145
    v_sqrt_f32 v145, v145
    s_nop 0
    v_cvt_pk_bf16_f32 v145, v145, v145
    v_lshlrev_b32 v145, 16, v145
    v_rcp_f32 v145, v145
    s_nop 0
    v_lshlrev_b32 v64, 16, v32
    v_lshlrev_b32 v66, 16, v33
    v_lshlrev_b32 v68, 16, v34
    v_lshlrev_b32_e64 v70, 16, v35
    v_and_b32 v65, 0xffff0000, v32
    v_and_b32 v67, 0xffff0000, v33
    v_and_b32 v69, 0xffff0000, v34
    v_and_b32 v71, 0xffff0000, v35
    v_sub_f32 v64, v64, v144
    v_sub_f32 v66, v66, v144
    v_sub_f32 v68, v68, v144
    v_sub_f32 v70, v70, v144
    v_sub_f32 v65, v65, v144
    v_sub_f32 v67, v67, v144
    v_sub_f32 v69, v69, v144
    v_sub_f32 v71, v71, v144
    v_cvt_pk_bf16_f32 v65, v64, v65
    v_cvt_pk_bf16_f32 v67, v66, v67
    v_cvt_pk_bf16_f32 v69, v68, v69
    v_cvt_pk_bf16_f32 v71, v70, v71
    v_lshlrev_b32 v64, 16, v65
    v_lshlrev_b32 v66, 16, v67
    v_lshlrev_b32 v68, 16, v69
    v_lshlrev_b32 v70, 16, v71
    v_and_b32 v65, 0xffff0000, v65
    v_and_b32 v67, 0xffff0000, v67
    v_and_b32 v69, 0xffff0000, v69
    v_and_b32 v71, 0xffff0000, v71
    v_mul_f32 v64, v64, v145
    v_mul_f32 v66, v66, v145
    v_mul_f32 v68, v68, v145
    v_mul_f32 v70, v70, v145
    v_mul_f32 v65, v65, v145
    v_mul_f32 v67, v67, v145
    v_mul_f32 v69, v69, v145
    v_mul_f32 v71, v71, v145
    v_cvt_pk_bf16_f32 v48, v64, v65
    v_cvt_pk_bf16_f32 v49, v66, v67
    v_cvt_pk_bf16_f32 v50, v68, v69
    v_cvt_pk_bf16_f32 v51, v70, v71
    ds_write_b128 v236, v[48:51]
    ds_write_b128 v236, v[32:35] offset:4096
    v_fma_f32 v143, -v144, v128, v146
    v_mul_f32_e64 v143, v143, v145
    ds_write_b32 v234, v143
    s_waitcnt lgkmcnt(0)
kc_com:
    s_barrier
    s_cmp_ge_u32 s53, 28
    s_cbranch_scc1 kc_red
    ds_read_b64 v[96:97], v218 offset:0
    ds_read_b64 v[98:99], v218 offset:16
    ds_read_b64 v[100:101], v218 offset:64
    ds_read_b64 v[102:103], v218 offset:80
    ds_read_b64 v[104:105], v218 offset:128
    ds_read_b64 v[106:107], v218 offset:144
    ds_read_b64 v[108:109], v218 offset:192
    ds_read_b64 v[110:111], v218 offset:208
    ds_read_b64 v[112:113], v218 offset:256
    ds_read_b64 v[114:115], v218 offset:272
    ds_read_b64 v[116:117], v218 offset:320
    ds_read_b64 v[118:119], v218 offset:336
    ds_read_b64 v[120:121], v218 offset:384
    ds_read_b64 v[122:123], v218 offset:400
    s_waitcnt lgkmcnt(12)
    ds_read_b64 v[124:125], v218 offset:448
    ds_read_b64 v[126:127], v218 offset:464
    v_mfma_f32_16x16x32_bf16 v[128:131], a[0:3], v[96:99], 0
    v_mfma_f32_16x16x32_bf16 v[132:135], a[32:35], v[96:99], 0
    s_waitcnt lgkmcnt(12)
    v_mfma_f32_16x16x32_bf16 v[128:131], a[4:7], v[100:103], v[128:131]
    v_mfma_f32_16x16x32_bf16 v[132:135], a[36:39], v[100:103], v[132:135]
    s_waitcnt lgkmcnt(10)
    v_mfma_f32_16x16x32_bf16 v[128:131], a[8:11], v[104:107], v[128:131]
    v_mfma_f32_16x16x32_bf16 v[132:135], a[40:43], v[104:107], v[132:135]
    s_waitcnt lgkmcnt(8)
    v_mfma_f32_16x16x32_bf16 v[128:131], a[12:15], v[108:111], v[128:131]
    v_mfma_f32_16x16x32_bf16 v[132:135], a[44:47], v[108:111], v[132:135]
    s_waitcnt lgkmcnt(6)
    v_mfma_f32_16x16x32_bf16 v[128:131], a[16:19], v[112:115], v[128:131]
    v_mfma_f32_16x16x32_bf16 v[132:135], a[48:51], v[112:115], v[132:135]
    s_waitcnt lgkmcnt(4)
    v_mfma_f32_16x16x32_bf16 v[128:131], a[20:23], v[116:119], v[128:131]
    v_mfma_f32_16x16x32_bf16 v[132:135], a[52:55], v[116:119], v[132:135]
    s_waitcnt lgkmcnt(2)
    v_mfma_f32_16x16x32_bf16 v[128:131], a[24:27], v[120:123], v[128:131]
    v_mfma_f32_16x16x32_bf16 v[132:135], a[56:59], v[120:123], v[132:135]
    s_waitcnt lgkmcnt(0)
    v_mfma_f32_16x16x32_bf16 v[128:131], a[28:31], v[124:127], v[128:131]
    v_mfma_f32_16x16x32_bf16 v[132:135], a[60:63], v[124:127], v[132:135]
    s_nop 6
    ds_write_b128 v220, v[128:131]
    ds_write_b128 v220, v[132:135] offset:4096
    s_waitcnt lgkmcnt(0)
    s_barrier
    ds_read_b128 v[32:35], v221 offset:0
    ds_read_b128 v[48:51], v221 offset:4096
    ds_read_b128 v[36:39], v221 offset:1024
    ds_read_b128 v[52:55], v221 offset:5120
    ds_read_b128 v[40:43], v221 offset:2048
    ds_read_b128 v[56:59], v221 offset:6144
    ds_read_b128 v[44:47], v221 offset:3072
    ds_read_b128 v[60:63], v221 offset:7168
    s_waitcnt lgkmcnt(0)
    v_pk_add_f32 v[32:33], v[32:33], v[36:37]
    v_pk_add_f32 v[34:35], v[34:35], v[38:39]
    v_pk_add_f32 v[40:41], v[40:41], v[44:45]
    v_pk_add_f32 v[42:43], v[42:43], v[46:47]
    v_pk_add_f32 v[48:49], v[48:49], v[52:53]
    v_pk_add_f32 v[50:51], v[50:51], v[54:55]
    v_pk_add_f32 v[56:57], v[56:57], v[60:61]
    v_pk_add_f32 v[58:59], v[58:59], v[62:63]
    v_pk_add_f32 v[32:33], v[32:33], v[40:41]
    v_pk_add_f32 v[34:35], v[34:35], v[42:43]
    v_pk_add_f32 v[48:49], v[48:49], v[56:57]
    v_pk_add_f32 v[50:51], v[50:51], v[58:59]
    v_cvt_pk_bf16_f32 v48, v32, v48
    v_cvt_pk_bf16_f32 v49, v33, v49
    v_cvt_pk_bf16_f32 v50, v34, v50
    v_cvt_pk_bf16_f32 v51, v35, v51
    v_lshlrev_b32 v32, 16, v48
    v_lshlrev_b32 v33, 16, v49
    v_lshlrev_b32 v34, 16, v50
    v_lshlrev_b32 v35, 16, v51
    v_and_b32 v48, 0xffff0000, v48
    v_and_b32 v49, 0xffff0000, v49
    v_and_b32 v50, 0xffff0000, v50
    v_and_b32 v51, 0xffff0000, v51
    v_mul_f32 v136, 0xbfb8aa3b, v32
    v_mul_f32 v137, 0xbfb8aa3b, v33
    v_mul_f32 v138, 0xbfb8aa3b, v34
    v_mul_f32 v139, 0xbfb8aa3b, v35
    v_exp_f32 v136, v136
    v_exp_f32 v137, v137
    v_exp_f32 v138, v138
    v_exp_f32 v139, v139
    v_add_f32 v136, 1.0, v136
    v_add_f32 v137, 1.0, v137
    v_add_f32 v138, 1.0, v138
    v_add_f32 v139, 1.0, v139
    v_rcp_f32 v136, v136
    v_rcp_f32 v137, v137
    v_rcp_f32 v138, v138
    v_rcp_f32 v139, v139
    v_mul_f32 v32, v32, v136
    v_mul_f32 v33, v33, v137
    v_mul_f32 v34, v34, v138
    v_mul_f32 v35, v35, v139
    v_cvt_pk_bf16_f32 v32, v32, v32
    v_cvt_pk_bf16_f32 v33, v33, v33
    v_cvt_pk_bf16_f32 v34, v34, v34
    v_cvt_pk_bf16_f32 v35, v35, v35
    v_lshlrev_b32 v32, 16, v32
    v_lshlrev_b32 v33, 16, v33
    v_lshlrev_b32 v34, 16, v34
    v_lshlrev_b32 v35, 16, v35
    v_mul_f32 v32, v32, v48
    v_mul_f32 v33, v33, v49
    v_mul_f32 v34, v34, v50
    v_mul_f32 v35, v35, v51
    v_cvt_pk_bf16_f32 v128, v32, v33
    v_cvt_pk_bf16_f32 v129, v34, v35
    v_cndmask_b32 v64, 0, v128, s[12:13]
    v_cndmask_b32 v65, 0, v129, s[12:13]
    v_cndmask_b32 v66, 0, v128, s[14:15]
    v_cndmask_b32 v67, 0, v129, s[14:15]
    v_cndmask_b32 v68, 0, v128, s[16:17]
    v_cndmask_b32 v69, 0, v129, s[16:17]
    v_cndmask_b32 v70, 0, v128, s[18:19]
    v_cndmask_b32 v71, 0, v129, s[18:19]
    v_cndmask_b32 v72, 0, v128, s[20:21]
    v_cndmask_b32 v73, 0, v129, s[20:21]
    v_cndmask_b32 v74, 0, v128, s[22:23]
    v_cndmask_b32 v75, 0, v129, s[22:23]
    v_cndmask_b32 v76, 0, v128, s[24:25]
    v_cndmask_b32 v77, 0, v129, s[24:25]
    v_cndmask_b32 v78, 0, v128, s[26:27]
    v_cndmask_b32 v79, 0, v129, s[26:27]
    v_mfma_f32_16x16x32_bf16 v[32:35], a[64:67], v[64:67], 0
    v_mfma_f32_16x16x32_bf16 v[36:39], a[80:83], v[64:67], 0
    v_mfma_f32_16x16x32_bf16 v[32:35], a[68:71], v[68:71], v[32:35]
    v_mfma_f32_16x16x32_bf16 v[36:39], a[84:87], v[68:71], v[36:39]
    v_mfma_f32_16x16x32_bf16 v[32:35], a[72:75], v[72:75], v[32:35]
    v_mfma_f32_16x16x32_bf16 v[36:39], a[88:91], v[72:75], v[36:39]
    v_mfma_f32_16x16x32_bf16 v[32:35], a[76:79], v[76:79], v[32:35]
    v_mfma_f32_16x16x32_bf16 v[36:39], a[92:95], v[76:79], v[36:39]
    s_nop 6
    buffer_store_dwordx4 v[32:35], v222, s[8:11], s38 offen sc1
    buffer_store_dwordx4 v[36:39], v222, s[8:11], s38 offen offset:512 sc1
    v_lshlrev_b32 v144, 16, v16
    v_lshlrev_b32 v148, 16, v17
    v_lshlrev_b32 v152, 16, v18
    v_lshlrev_b32_e64 v156, 16, v19
    v_and_b32 v145, 0xffff0000, v16
    v_and_b32 v149, 0xffff0000, v17
    v_and_b32 v153, 0xffff0000, v18
    v_and_b32 v157, 0xffff0000, v19
    v_sub_f32 v144, v144, v0
    v_sub_f32 v148, v148, v0
    v_sub_f32 v152, v152, v0
    v_sub_f32 v156, v156, v0
    v_sub_f32 v145, v145, v0
    v_sub_f32 v149, v149, v0
    v_sub_f32 v153, v153, v0
    v_sub_f32 v157, v157, v0
    v_cvt_pk_bf16_f32 v145, v144, v145
    v_cvt_pk_bf16_f32 v149, v148, v149
    v_cvt_pk_bf16_f32 v153, v152, v153
    v_cvt_pk_bf16_f32 v157, v156, v157
    v_lshlrev_b32 v144, 16, v145
    v_lshlrev_b32 v148, 16, v149
    v_lshlrev_b32 v152, 16, v153
    v_lshlrev_b32 v156, 16, v157
    v_and_b32 v145, 0xffff0000, v145
    v_and_b32 v149, 0xffff0000, v149
    v_and_b32 v153, 0xffff0000, v153
    v_and_b32 v157, 0xffff0000, v157
    v_mul_f32 v144, v144, v4
    v_mul_f32 v148, v148, v4
    v_mul_f32 v152, v152, v4
    v_mul_f32 v156, v156, v4
    v_mul_f32 v145, v145, v4
    v_mul_f32 v149, v149, v4
    v_mul_f32 v153, v153, v4
    v_mul_f32 v157, v157, v4
    v_cvt_pk_bf16_f32 v146, v144, v145
    v_cvt_pk_bf16_f32 v150, v148, v149
    v_cvt_pk_bf16_f32 v154, v152, v153
    v_cvt_pk_bf16_f32 v158, v156, v157
    v_lshlrev_b32 v144, 16, v146
    v_lshlrev_b32 v148, 16, v150
    v_lshlrev_b32 v152, 16, v154
    v_lshlrev_b32 v156, 16, v158
    v_and_b32 v145, 0xffff0000, v146
    v_and_b32 v149, 0xffff0000, v150
    v_and_b32 v153, 0xffff0000, v154
    v_and_b32 v157, 0xffff0000, v158
    v_lshlrev_b32 v146, 16, v16
    v_lshlrev_b32 v150, 16, v17
    v_lshlrev_b32 v154, 16, v18
    v_lshlrev_b32 v158, 16, v19
    v_and_b32 v147, 0xffff0000, v16
    v_and_b32 v151, 0xffff0000, v17
    v_and_b32 v155, 0xffff0000, v18
    v_and_b32 v159, 0xffff0000, v19
    v_pk_add_f32 v[144:145], v[144:145], v[146:147]
    v_pk_add_f32 v[148:149], v[148:149], v[150:151]
    v_pk_add_f32 v[152:153], v[152:153], v[154:155]
    v_pk_add_f32 v[156:157], v[156:157], v[158:159]
    v_cvt_pk_bf16_f32 v16, v144, v145
    v_cvt_pk_bf16_f32 v17, v148, v149
    v_cvt_pk_bf16_f32 v18, v152, v153
    v_cvt_pk_bf16_f32 v19, v156, v157
    v_add_u32 v160, 0, v242
    v_cmp_eq_u32 vcc, v160, v8
    v_cmp_eq_u32 s[60:61], v160, v10
    v_mov_b32 v161, 0x40000000
    s_or_b64 vcc, vcc, s[60:61]
    v_cndmask_b32 v12, v229, v161, vcc
    s_waitcnt vmcnt(0)
    s_barrier
    s_cmp_lg_u32 s3, 0
    s_cbranch_scc1 kc_a2
    s_lshl_b32 s32, s52, 7
    s_add_u32 s32, s32, 0x38a0800
    v_mov_b32_e64 v235, 1
    buffer_atomic_add v235, v243, s[8:11], s32 offen sc0 sc1
    v_lshlrev_b32 v234, 7, v237
    v_cmp_gt_u32 vcc, 8, v237
    v_mov_b32_e64 v236, 0x40000000
    s_mov_b32 s34, 0x38a0c00
    v_cndmask_b32 v234, v236, v234, vcc
    s_waitcnt vmcnt(0)
    v_readfirstlane_b32 s36, v235
    s_cmp_lg_u32 s36, 27
    s_cbranch_scc1 kc_a2
    buffer_atomic_add v233, v234, s[8:11], s34 offen sc1
kc_a2:
    v_lshlrev_b32 v144, 16, v20
    v_lshlrev_b32 v148, 16, v21
    v_lshlrev_b32 v152, 16, v22
    v_lshlrev_b32_e64 v156, 16, v23
    v_and_b32 v145, 0xffff0000, v20
    v_and_b32 v149, 0xffff0000, v21
    v_and_b32 v153, 0xffff0000, v22
    v_and_b32 v157, 0xffff0000, v23
    v_sub_f32 v144, v144, v1
    v_sub_f32 v148, v148, v1
    v_sub_f32 v152, v152, v1
    v_sub_f32 v156, v156, v1
    v_sub_f32 v145, v145, v1
    v_sub_f32 v149, v149, v1
    v_sub_f32 v153, v153, v1
    v_sub_f32 v157, v157, v1
    v_cvt_pk_bf16_f32 v145, v144, v145
    v_cvt_pk_bf16_f32 v149, v148, v149
    v_cvt_pk_bf16_f32 v153, v152, v153
    v_cvt_pk_bf16_f32 v157, v156, v157
    v_lshlrev_b32 v144, 16, v145
    v_lshlrev_b32 v148, 16, v149
    v_lshlrev_b32 v152, 16, v153
    v_lshlrev_b32 v156, 16, v157
    v_and_b32 v145, 0xffff0000, v145
    v_and_b32 v149, 0xffff0000, v149
    v_and_b32 v153, 0xffff0000, v153
    v_and_b32 v157, 0xffff0000, v157
    v_mul_f32 v144, v144, v5
    v_mul_f32 v148, v148, v5
    v_mul_f32 v152, v152, v5
    v_mul_f32 v156, v156, v5
    v_mul_f32 v145, v145, v5
    v_mul_f32 v149, v149, v5
    v_mul_f32 v153, v153, v5
    v_mul_f32 v157, v157, v5
    v_cvt_pk_bf16_f32 v146, v144, v145
    v_cvt_pk_bf16_f32 v150, v148, v149
    v_cvt_pk_bf16_f32 v154, v152, v153
    v_cvt_pk_bf16_f32 v158, v156, v157
    v_lshlrev_b32 v144, 16, v146
    v_lshlrev_b32 v148, 16, v150
    v_lshlrev_b32 v152, 16, v154
    v_lshlrev_b32 v156, 16, v158
    v_and_b32 v145, 0xffff0000, v146
    v_and_b32 v149, 0xffff0000, v150
    v_and_b32 v153, 0xffff0000, v154
    v_and_b32 v157, 0xffff0000, v158
    v_lshlrev_b32 v146, 16, v20
    v_lshlrev_b32 v150, 16, v21
    v_lshlrev_b32 v154, 16, v22
    v_lshlrev_b32 v158, 16, v23
    v_and_b32 v147, 0xffff0000, v20
    v_and_b32 v151, 0xffff0000, v21
    v_and_b32 v155, 0xffff0000, v22
    v_and_b32 v159, 0xffff0000, v23
    v_pk_add_f32 v[144:145], v[144:145], v[146:147]
    v_pk_add_f32 v[148:149], v[148:149], v[150:151]
    v_pk_add_f32 v[152:153], v[152:153], v[154:155]
    v_pk_add_f32 v[156:157], v[156:157], v[158:159]
    v_cvt_pk_bf16_f32 v20, v144, v145
    v_cvt_pk_bf16_f32 v21, v148, v149
    v_cvt_pk_bf16_f32 v22, v152, v153
    v_cvt_pk_bf16_f32 v23, v156, v157
    v_add_u32 v160, 8, v242
    v_cmp_eq_u32 vcc, v160, v8
    v_cmp_eq_u32 s[60:61], v160, v10
    v_mov_b32 v161, 0x40000000
    s_or_b64 vcc, vcc, s[60:61]
    v_cndmask_b32 v13, v229, v161, vcc
    v_lshlrev_b32 v144, 16, v24
    v_lshlrev_b32 v148, 16, v25
    v_lshlrev_b32 v152, 16, v26
    v_lshlrev_b32_e64 v156, 16, v27
    v_and_b32 v145, 0xffff0000, v24
    v_and_b32 v149, 0xffff0000, v25
    v_and_b32 v153, 0xffff0000, v26
    v_and_b32 v157, 0xffff0000, v27
    v_sub_f32 v144, v144, v2
    v_sub_f32 v148, v148, v2
    v_sub_f32 v152, v152, v2
    v_sub_f32 v156, v156, v2
    v_sub_f32 v145, v145, v2
    v_sub_f32 v149, v149, v2
    v_sub_f32 v153, v153, v2
    v_sub_f32 v157, v157, v2
    v_cvt_pk_bf16_f32 v145, v144, v145
    v_cvt_pk_bf16_f32 v149, v148, v149
    v_cvt_pk_bf16_f32 v153, v152, v153
    v_cvt_pk_bf16_f32 v157, v156, v157
    v_lshlrev_b32 v144, 16, v145
    v_lshlrev_b32 v148, 16, v149
    v_lshlrev_b32 v152, 16, v153
    v_lshlrev_b32 v156, 16, v157
    v_and_b32 v145, 0xffff0000, v145
    v_and_b32 v149, 0xffff0000, v149
    v_and_b32 v153, 0xffff0000, v153
    v_and_b32 v157, 0xffff0000, v157
    v_mul_f32 v144, v144, v6
    v_mul_f32 v148, v148, v6
    v_mul_f32 v152, v152, v6
    v_mul_f32 v156, v156, v6
    v_mul_f32 v145, v145, v6
    v_mul_f32 v149, v149, v6
    v_mul_f32 v153, v153, v6
    v_mul_f32 v157, v157, v6
    v_cvt_pk_bf16_f32 v146, v144, v145
    v_cvt_pk_bf16_f32 v150, v148, v149
    v_cvt_pk_bf16_f32 v154, v152, v153
    v_cvt_pk_bf16_f32 v158, v156, v157
    v_lshlrev_b32 v144, 16, v146
    v_lshlrev_b32 v148, 16, v150
    v_lshlrev_b32 v152, 16, v154
    v_lshlrev_b32 v156, 16, v158
    v_and_b32 v145, 0xffff0000, v146
    v_and_b32 v149, 0xffff0000, v150
    v_and_b32 v153, 0xffff0000, v154
    v_and_b32 v157, 0xffff0000, v158
    v_lshlrev_b32 v146, 16, v24
    v_lshlrev_b32 v150, 16, v25
    v_lshlrev_b32 v154, 16, v26
    v_lshlrev_b32 v158, 16, v27
    v_and_b32 v147, 0xffff0000, v24
    v_and_b32 v151, 0xffff0000, v25
    v_and_b32 v155, 0xffff0000, v26
    v_and_b32 v159, 0xffff0000, v27
    v_pk_add_f32 v[144:145], v[144:145], v[146:147]
    v_pk_add_f32 v[148:149], v[148:149], v[150:151]
    v_pk_add_f32 v[152:153], v[152:153], v[154:155]
    v_pk_add_f32 v[156:157], v[156:157], v[158:159]
    v_cvt_pk_bf16_f32 v24, v144, v145
    v_cvt_pk_bf16_f32 v25, v148, v149
    v_cvt_pk_bf16_f32 v26, v152, v153
    v_cvt_pk_bf16_f32 v27, v156, v157
    v_add_u32 v160, 16, v242
    v_cmp_eq_u32 vcc, v160, v8
    v_cmp_eq_u32 s[60:61], v160, v10
    v_mov_b32 v161, 0x40000000
    s_or_b64 vcc, vcc, s[60:61]
    v_cndmask_b32 v14, v229, v161, vcc
    v_lshlrev_b32 v144, 16, v28
    v_lshlrev_b32 v148, 16, v29
    v_lshlrev_b32 v152, 16, v30
    v_lshlrev_b32_e64 v156, 16, v31
    v_and_b32 v145, 0xffff0000, v28
    v_and_b32 v149, 0xffff0000, v29
    v_and_b32 v153, 0xffff0000, v30
    v_and_b32 v157, 0xffff0000, v31
    v_sub_f32 v144, v144, v3
    v_sub_f32 v148, v148, v3
    v_sub_f32 v152, v152, v3
    v_sub_f32 v156, v156, v3
    v_sub_f32 v145, v145, v3
    v_sub_f32 v149, v149, v3
    v_sub_f32 v153, v153, v3
    v_sub_f32 v157, v157, v3
    v_cvt_pk_bf16_f32 v145, v144, v145
    v_cvt_pk_bf16_f32 v149, v148, v149
    v_cvt_pk_bf16_f32 v153, v152, v153
    v_cvt_pk_bf16_f32 v157, v156, v157
    v_lshlrev_b32 v144, 16, v145
    v_lshlrev_b32 v148, 16, v149
    v_lshlrev_b32 v152, 16, v153
    v_lshlrev_b32 v156, 16, v157
    v_and_b32 v145, 0xffff0000, v145
    v_and_b32 v149, 0xffff0000, v149
    v_and_b32 v153, 0xffff0000, v153
    v_and_b32 v157, 0xffff0000, v157
    v_mul_f32 v144, v144, v7
    v_mul_f32 v148, v148, v7
    v_mul_f32 v152, v152, v7
    v_mul_f32 v156, v156, v7
    v_mul_f32 v145, v145, v7
    v_mul_f32 v149, v149, v7
    v_mul_f32 v153, v153, v7
    v_mul_f32 v157, v157, v7
    v_cvt_pk_bf16_f32 v146, v144, v145
    v_cvt_pk_bf16_f32 v150, v148, v149
    v_cvt_pk_bf16_f32 v154, v152, v153
    v_cvt_pk_bf16_f32 v158, v156, v157
    v_lshlrev_b32 v144, 16, v146
    v_lshlrev_b32 v148, 16, v150
    v_lshlrev_b32 v152, 16, v154
    v_lshlrev_b32 v156, 16, v158
    v_and_b32 v145, 0xffff0000, v146
    v_and_b32 v149, 0xffff0000, v150
    v_and_b32 v153, 0xffff0000, v154
    v_and_b32 v157, 0xffff0000, v158
    v_lshlrev_b32 v146, 16, v28
    v_lshlrev_b32 v150, 16, v29
    v_lshlrev_b32 v154, 16, v30
    v_lshlrev_b32 v158, 16, v31
    v_and_b32 v147, 0xffff0000, v28
    v_and_b32 v151, 0xffff0000, v29
    v_and_b32 v155, 0xffff0000, v30
    v_and_b32 v159, 0xffff0000, v31
    v_pk_add_f32 v[144:145], v[144:145], v[146:147]
    v_pk_add_f32 v[148:149], v[148:149], v[150:151]
    v_pk_add_f32 v[152:153], v[152:153], v[154:155]
    v_pk_add_f32 v[156:157], v[156:157], v[158:159]
    v_cvt_pk_bf16_f32 v28, v144, v145
    v_cvt_pk_bf16_f32 v29, v148, v149
    v_cvt_pk_bf16_f32 v30, v152, v153
    v_cvt_pk_bf16_f32 v31, v156, v157
    v_add_u32 v160, 24, v242
    v_cmp_eq_u32 vcc, v160, v8
    v_cmp_eq_u32 s[60:61], v160, v10
    v_mov_b32 v161, 0x40000000
    s_or_b64 vcc, vcc, s[60:61]
    v_cndmask_b32 v15, v229, v161, vcc
    s_mov_b32 s32, 0
    buffer_store_dwordx4 v[16:19], v12, s[28:31], s32 offen nt
    s_mov_b32 s32, 16384
    buffer_store_dwordx4 v[20:23], v13, s[28:31], s32 offen nt
    s_mov_b32 s32, 32768
    buffer_store_dwordx4 v[24:27], v14, s[28:31], s32 offen nt
    s_mov_b32 s32, 49152
    buffer_store_dwordx4 v[28:31], v15, s[28:31], s32 offen nt
    s_branch kc_fin
kc_red:
    v_lshlrev_b32 v144, 16, v16
    v_lshlrev_b32 v148, 16, v17
    v_lshlrev_b32 v152, 16, v18
    v_lshlrev_b32_e64 v156, 16, v19
    v_and_b32 v145, 0xffff0000, v16
    v_and_b32 v149, 0xffff0000, v17
    v_and_b32 v153, 0xffff0000, v18
    v_and_b32 v157, 0xffff0000, v19
    v_sub_f32 v144, v144, v0
    v_sub_f32 v148, v148, v0
    v_sub_f32 v152, v152, v0
    v_sub_f32 v156, v156, v0
    v_sub_f32 v145, v145, v0
    v_sub_f32 v149, v149, v0
    v_sub_f32 v153, v153, v0
    v_sub_f32 v157, v157, v0
    v_cvt_pk_bf16_f32 v145, v144, v145
    v_cvt_pk_bf16_f32 v149, v148, v149
    v_cvt_pk_bf16_f32 v153, v152, v153
    v_cvt_pk_bf16_f32 v157, v156, v157
    v_lshlrev_b32 v144, 16, v145
    v_lshlrev_b32 v148, 16, v149
    v_lshlrev_b32 v152, 16, v153
    v_lshlrev_b32 v156, 16, v157
    v_and_b32 v145, 0xffff0000, v145
    v_and_b32 v149, 0xffff0000, v149
    v_and_b32 v153, 0xffff0000, v153
    v_and_b32 v157, 0xffff0000, v157
    v_mul_f32 v144, v144, v4
    v_mul_f32 v148, v148, v4
    v_mul_f32 v152, v152, v4
    v_mul_f32 v156, v156, v4
    v_mul_f32 v145, v145, v4
    v_mul_f32 v149, v149, v4
    v_mul_f32 v153, v153, v4
    v_mul_f32 v157, v157, v4
    v_cvt_pk_bf16_f32 v146, v144, v145
    v_cvt_pk_bf16_f32 v150, v148, v149
    v_cvt_pk_bf16_f32 v154, v152, v153
    v_cvt_pk_bf16_f32 v158, v156, v157
    v_lshlrev_b32 v144, 16, v146
    v_lshlrev_b32 v148, 16, v150
    v_lshlrev_b32 v152, 16, v154
    v_lshlrev_b32 v156, 16, v158
    v_and_b32 v145, 0xffff0000, v146
    v_and_b32 v149, 0xffff0000, v150
    v_and_b32 v153, 0xffff0000, v154
    v_and_b32 v157, 0xffff0000, v158
    v_lshlrev_b32 v146, 16, v16
    v_lshlrev_b32 v150, 16, v17
    v_lshlrev_b32 v154, 16, v18
    v_lshlrev_b32 v158, 16, v19
    v_and_b32 v147, 0xffff0000, v16
    v_and_b32 v151, 0xffff0000, v17
    v_and_b32 v155, 0xffff0000, v18
    v_and_b32 v159, 0xffff0000, v19
    v_pk_add_f32 v[144:145], v[144:145], v[146:147]
    v_pk_add_f32 v[148:149], v[148:149], v[150:151]
    v_pk_add_f32 v[152:153], v[152:153], v[154:155]
    v_pk_add_f32 v[156:157], v[156:157], v[158:159]
    v_cvt_pk_bf16_f32 v16, v144, v145
    v_cvt_pk_bf16_f32 v17, v148, v149
    v_cvt_pk_bf16_f32 v18, v152, v153
    v_cvt_pk_bf16_f32 v19, v156, v157
    v_add_u32 v160, 0, v242
    v_cmp_eq_u32 vcc, v160, v8
    v_cmp_eq_u32 s[60:61], v160, v10
    v_mov_b32 v161, 0x40000000
    s_or_b64 vcc, vcc, s[60:61]
    v_cndmask_b32 v12, v229, v161, vcc
    v_lshlrev_b32 v144, 16, v20
    v_lshlrev_b32 v148, 16, v21
    v_lshlrev_b32 v152, 16, v22
    v_lshlrev_b32_e64 v156, 16, v23
    v_and_b32 v145, 0xffff0000, v20
    v_and_b32 v149, 0xffff0000, v21
    v_and_b32 v153, 0xffff0000, v22
    v_and_b32 v157, 0xffff0000, v23
    v_sub_f32 v144, v144, v1
    v_sub_f32 v148, v148, v1
    v_sub_f32 v152, v152, v1
    v_sub_f32 v156, v156, v1
    v_sub_f32 v145, v145, v1
    v_sub_f32 v149, v149, v1
    v_sub_f32 v153, v153, v1
    v_sub_f32 v157, v157, v1
    v_cvt_pk_bf16_f32 v145, v144, v145
    v_cvt_pk_bf16_f32 v149, v148, v149
    v_cvt_pk_bf16_f32 v153, v152, v153
    v_cvt_pk_bf16_f32 v157, v156, v157
    v_lshlrev_b32 v144, 16, v145
    v_lshlrev_b32 v148, 16, v149
    v_lshlrev_b32 v152, 16, v153
    v_lshlrev_b32 v156, 16, v157
    v_and_b32 v145, 0xffff0000, v145
    v_and_b32 v149, 0xffff0000, v149
    v_and_b32 v153, 0xffff0000, v153
    v_and_b32 v157, 0xffff0000, v157
    v_mul_f32 v144, v144, v5
    v_mul_f32 v148, v148, v5
    v_mul_f32 v152, v152, v5
    v_mul_f32 v156, v156, v5
    v_mul_f32 v145, v145, v5
    v_mul_f32 v149, v149, v5
    v_mul_f32 v153, v153, v5
    v_mul_f32 v157, v157, v5
    v_cvt_pk_bf16_f32 v146, v144, v145
    v_cvt_pk_bf16_f32 v150, v148, v149
    v_cvt_pk_bf16_f32 v154, v152, v153
    v_cvt_pk_bf16_f32 v158, v156, v157
    v_lshlrev_b32 v144, 16, v146
    v_lshlrev_b32 v148, 16, v150
    v_lshlrev_b32 v152, 16, v154
    v_lshlrev_b32 v156, 16, v158
    v_and_b32 v145, 0xffff0000, v146
    v_and_b32 v149, 0xffff0000, v150
    v_and_b32 v153, 0xffff0000, v154
    v_and_b32 v157, 0xffff0000, v158
    v_lshlrev_b32 v146, 16, v20
    v_lshlrev_b32 v150, 16, v21
    v_lshlrev_b32 v154, 16, v22
    v_lshlrev_b32 v158, 16, v23
    v_and_b32 v147, 0xffff0000, v20
    v_and_b32 v151, 0xffff0000, v21
    v_and_b32 v155, 0xffff0000, v22
    v_and_b32 v159, 0xffff0000, v23
    v_pk_add_f32 v[144:145], v[144:145], v[146:147]
    v_pk_add_f32 v[148:149], v[148:149], v[150:151]
    v_pk_add_f32 v[152:153], v[152:153], v[154:155]
    v_pk_add_f32 v[156:157], v[156:157], v[158:159]
    v_cvt_pk_bf16_f32 v20, v144, v145
    v_cvt_pk_bf16_f32 v21, v148, v149
    v_cvt_pk_bf16_f32 v22, v152, v153
    v_cvt_pk_bf16_f32 v23, v156, v157
    v_add_u32 v160, 8, v242
    v_cmp_eq_u32 vcc, v160, v8
    v_cmp_eq_u32 s[60:61], v160, v10
    v_mov_b32 v161, 0x40000000
    s_or_b64 vcc, vcc, s[60:61]
    v_cndmask_b32 v13, v229, v161, vcc
    v_lshlrev_b32 v144, 16, v24
    v_lshlrev_b32 v148, 16, v25
    v_lshlrev_b32 v152, 16, v26
    v_lshlrev_b32_e64 v156, 16, v27
    v_and_b32 v145, 0xffff0000, v24
    v_and_b32 v149, 0xffff0000, v25
    v_and_b32 v153, 0xffff0000, v26
    v_and_b32 v157, 0xffff0000, v27
    v_sub_f32 v144, v144, v2
    v_sub_f32 v148, v148, v2
    v_sub_f32 v152, v152, v2
    v_sub_f32 v156, v156, v2
    v_sub_f32 v145, v145, v2
    v_sub_f32 v149, v149, v2
    v_sub_f32 v153, v153, v2
    v_sub_f32 v157, v157, v2
    v_cvt_pk_bf16_f32 v145, v144, v145
    v_cvt_pk_bf16_f32 v149, v148, v149
    v_cvt_pk_bf16_f32 v153, v152, v153
    v_cvt_pk_bf16_f32 v157, v156, v157
    v_lshlrev_b32 v144, 16, v145
    v_lshlrev_b32 v148, 16, v149
    v_lshlrev_b32 v152, 16, v153
    v_lshlrev_b32 v156, 16, v157
    v_and_b32 v145, 0xffff0000, v145
    v_and_b32 v149, 0xffff0000, v149
    v_and_b32 v153, 0xffff0000, v153
    v_and_b32 v157, 0xffff0000, v157
    v_mul_f32 v144, v144, v6
    v_mul_f32 v148, v148, v6
    v_mul_f32 v152, v152, v6
    v_mul_f32 v156, v156, v6
    v_mul_f32 v145, v145, v6
    v_mul_f32 v149, v149, v6
    v_mul_f32 v153, v153, v6
    v_mul_f32 v157, v157, v6
    v_cvt_pk_bf16_f32 v146, v144, v145
    v_cvt_pk_bf16_f32 v150, v148, v149
    v_cvt_pk_bf16_f32 v154, v152, v153
    v_cvt_pk_bf16_f32 v158, v156, v157
    v_lshlrev_b32 v144, 16, v146
    v_lshlrev_b32 v148, 16, v150
    v_lshlrev_b32 v152, 16, v154
    v_lshlrev_b32 v156, 16, v158
    v_and_b32 v145, 0xffff0000, v146
    v_and_b32 v149, 0xffff0000, v150
    v_and_b32 v153, 0xffff0000, v154
    v_and_b32 v157, 0xffff0000, v158
    v_lshlrev_b32 v146, 16, v24
    v_lshlrev_b32 v150, 16, v25
    v_lshlrev_b32 v154, 16, v26
    v_lshlrev_b32 v158, 16, v27
    v_and_b32 v147, 0xffff0000, v24
    v_and_b32 v151, 0xffff0000, v25
    v_and_b32 v155, 0xffff0000, v26
    v_and_b32 v159, 0xffff0000, v27
    v_pk_add_f32 v[144:145], v[144:145], v[146:147]
    v_pk_add_f32 v[148:149], v[148:149], v[150:151]
    v_pk_add_f32 v[152:153], v[152:153], v[154:155]
    v_pk_add_f32 v[156:157], v[156:157], v[158:159]
    v_cvt_pk_bf16_f32 v24, v144, v145
    v_cvt_pk_bf16_f32 v25, v148, v149
    v_cvt_pk_bf16_f32 v26, v152, v153
    v_cvt_pk_bf16_f32 v27, v156, v157
    v_add_u32 v160, 16, v242
    v_cmp_eq_u32 vcc, v160, v8
    v_cmp_eq_u32 s[60:61], v160, v10
    v_mov_b32 v161, 0x40000000
    s_or_b64 vcc, vcc, s[60:61]
    v_cndmask_b32 v14, v229, v161, vcc
    v_lshlrev_b32 v144, 16, v28
    v_lshlrev_b32 v148, 16, v29
    v_lshlrev_b32 v152, 16, v30
    v_lshlrev_b32_e64 v156, 16, v31
    v_and_b32 v145, 0xffff0000, v28
    v_and_b32 v149, 0xffff0000, v29
    v_and_b32 v153, 0xffff0000, v30
    v_and_b32 v157, 0xffff0000, v31
    v_sub_f32 v144, v144, v3
    v_sub_f32 v148, v148, v3
    v_sub_f32 v152, v152, v3
    v_sub_f32 v156, v156, v3
    v_sub_f32 v145, v145, v3
    v_sub_f32 v149, v149, v3
    v_sub_f32 v153, v153, v3
    v_sub_f32 v157, v157, v3
    v_cvt_pk_bf16_f32 v145, v144, v145
    v_cvt_pk_bf16_f32 v149, v148, v149
    v_cvt_pk_bf16_f32 v153, v152, v153
    v_cvt_pk_bf16_f32 v157, v156, v157
    v_lshlrev_b32 v144, 16, v145
    v_lshlrev_b32 v148, 16, v149
    v_lshlrev_b32 v152, 16, v153
    v_lshlrev_b32 v156, 16, v157
    v_and_b32 v145, 0xffff0000, v145
    v_and_b32 v149, 0xffff0000, v149
    v_and_b32 v153, 0xffff0000, v153
    v_and_b32 v157, 0xffff0000, v157
    v_mul_f32 v144, v144, v7
    v_mul_f32 v148, v148, v7
    v_mul_f32 v152, v152, v7
    v_mul_f32 v156, v156, v7
    v_mul_f32 v145, v145, v7
    v_mul_f32 v149, v149, v7
    v_mul_f32 v153, v153, v7
    v_mul_f32 v157, v157, v7
    v_cvt_pk_bf16_f32 v146, v144, v145
    v_cvt_pk_bf16_f32 v150, v148, v149
    v_cvt_pk_bf16_f32 v154, v152, v153
    v_cvt_pk_bf16_f32 v158, v156, v157
    v_lshlrev_b32 v144, 16, v146
    v_lshlrev_b32 v148, 16, v150
    v_lshlrev_b32 v152, 16, v154
    v_lshlrev_b32 v156, 16, v158
    v_and_b32 v145, 0xffff0000, v146
    v_and_b32 v149, 0xffff0000, v150
    v_and_b32 v153, 0xffff0000, v154
    v_and_b32 v157, 0xffff0000, v158
    v_lshlrev_b32 v146, 16, v28
    v_lshlrev_b32 v150, 16, v29
    v_lshlrev_b32 v154, 16, v30
    v_lshlrev_b32 v158, 16, v31
    v_and_b32 v147, 0xffff0000, v28
    v_and_b32 v151, 0xffff0000, v29
    v_and_b32 v155, 0xffff0000, v30
    v_and_b32 v159, 0xffff0000, v31
    v_pk_add_f32 v[144:145], v[144:145], v[146:147]
    v_pk_add_f32 v[148:149], v[148:149], v[150:151]
    v_pk_add_f32 v[152:153], v[152:153], v[154:155]
    v_pk_add_f32 v[156:157], v[156:157], v[158:159]
    v_cvt_pk_bf16_f32 v28, v144, v145
    v_cvt_pk_bf16_f32 v29, v148, v149
    v_cvt_pk_bf16_f32 v30, v152, v153
    v_cvt_pk_bf16_f32 v31, v156, v157
    v_add_u32 v160, 24, v242
    v_cmp_eq_u32 vcc, v160, v8
    v_cmp_eq_u32 s[60:61], v160, v10
    v_mov_b32 v161, 0x40000000
    s_or_b64 vcc, vcc, s[60:61]
    v_cndmask_b32 v15, v229, v161, vcc
    s_mov_b32 s32, 0
    buffer_store_dwordx4 v[16:19], v12, s[28:31], s32 offen nt
    s_mov_b32 s32, 16384
    buffer_store_dwordx4 v[20:23], v13, s[28:31], s32 offen nt
    s_mov_b32 s32, 32768
    buffer_store_dwordx4 v[24:27], v14, s[28:31], s32 offen nt
    s_mov_b32 s32, 49152
    buffer_store_dwordx4 v[28:31], v15, s[28:31], s32 offen nt
    s_sub_u32 s54, s2, 224
    v_lshrrev_b32 v234, 4, v230
    v_lshlrev_b32 v234, 13, v234
    v_and_b32_e64 v235, 15, v237
    v_lshl_add_u32 v217, v235, 4, v234
    s_lshl_b32 s35, s54, 8
    s_add_u32 s35, s35, 0x3900000
    v_bfe_u32 v234, v237, 4, 1
    v_lshrrev_b32 v236, 5, v237
    v_lshl_add_u32 v234, v234, 1, v236
    v_lshl_add_u32 v234, v235, 2, v234
    s_lshl_b32 s32, s54, 6
    v_add_u32 v234, s32, v234
    v_lshlrev_b32_e64 v218, 1, v234
    v_add_u32 v234, 98304, v218
    ds_read_u16 v100, v234
    ds_read_u16 v101, v234 offset:4096
    s_cmp_lt_u32 s54, 16
    s_cselect_b64 vcc, -1, 0
    v_cndmask_b32 v102, v10, v8, vcc
    s_cselect_b32 s32, 0, 4
    s_add_u32 s32, s32, 106496
    v_mov_b32_e64 v234, s32
    ds_read_b32 v103, v234
    s_waitcnt lgkmcnt(0)
    v_cvt_pk_bf16_f32 v103, v103, v103
    v_lshlrev_b32 v103, 16, v103
    v_mul_f32 v103, 0xbfb8aa3b, v103
    v_exp_f32 v103, v103
    s_nop 0
    v_add_f32 v103, 1.0, v103
    v_rcp_f32_e64 v103, v103
    s_nop 0
    v_cvt_pk_bf16_f32 v103, v103, v103
    v_lshlrev_b32_e64 v103, 16, v103
    v_and_b32 v218, 2047, v218
    v_lshl_add_u32 v218, v102, 11, v218
    v_lshlrev_b32_e64 v220, 2, v230
    v_add_u32 v220, 106752, v220
    v_lshlrev_b32_e64 v221, 2, v237
    v_add_u32 v221, 106752, v221
    s_cmp_lg_u32 s3, 0
    s_cbranch_scc1 kc_b22
    s_lshl_b32 s32, s52, 7
    s_add_u32 s32, s32, 0x38a0c00
    s_mov_b32 s34, 0x400000
    s_branch kc_b21
kc_b20:
    s_sleep 2
kc_b21:
    buffer_load_dword v235, off, s[8:11], s32 sc1
    s_waitcnt vmcnt(0)
    v_cmp_ne_u32 vcc, 8, v235
    s_sub_u32 s34, s34, 1
    s_cbranch_scc1 kc_b22
    s_cbranch_vccnz kc_b20
kc_b22:
    s_barrier
    s_add_u32 s32, s35, 0
    buffer_load_dwordx4 v[32:35], v217, s[8:11], s32 offen sc1
    s_add_u32 s32, s35, 131072
    buffer_load_dwordx4 v[36:39], v217, s[8:11], s32 offen sc1
    s_add_u32 s32, s35, 262144
    buffer_load_dwordx4 v[40:43], v217, s[8:11], s32 offen sc1
    s_add_u32 s32, s35, 393216
    buffer_load_dwordx4 v[44:47], v217, s[8:11], s32 offen sc1
    s_add_u32 s32, s35, 524288
    buffer_load_dwordx4 v[48:51], v217, s[8:11], s32 offen sc1
    s_add_u32 s32, s35, 655360
    buffer_load_dwordx4 v[52:55], v217, s[8:11], s32 offen sc1
    s_add_u32 s32, s35, 786432
    buffer_load_dwordx4 v[56:59], v217, s[8:11], s32 offen sc1
    s_add_u32 s32, s35, 917504
    buffer_load_dwordx4 v[60:63], v217, s[8:11], s32 offen sc1
    s_add_u32 s32, s35, 1048576
    buffer_load_dwordx4 v[64:67], v217, s[8:11], s32 offen sc1
    s_add_u32 s32, s35, 1179648
    buffer_load_dwordx4 v[68:71], v217, s[8:11], s32 offen sc1
    s_add_u32 s32, s35, 1310720
    buffer_load_dwordx4 v[72:75], v217, s[8:11], s32 offen sc1
    s_add_u32 s32, s35, 1441792
    buffer_load_dwordx4 v[76:79], v217, s[8:11], s32 offen sc1
    s_add_u32 s32, s35, 1572864
    buffer_load_dwordx4 v[80:83], v217, s[8:11], s32 offen sc1
    s_add_u32 s32, s35, 1703936
    buffer_load_dwordx4 v[84:87], v217, s[8:11], s32 offen sc1
    s_waitcnt vmcnt(12)
    v_pk_add_f32 v[32:33], v[32:33], v[36:37]
    v_pk_add_f32 v[34:35], v[34:35], v[38:39]
    s_waitcnt vmcnt(11)
    v_pk_add_f32 v[32:33], v[32:33], v[40:41]
    v_pk_add_f32 v[34:35], v[34:35], v[42:43]
    s_waitcnt vmcnt(10)
    v_pk_add_f32 v[32:33], v[32:33], v[44:45]
    v_pk_add_f32 v[34:35], v[34:35], v[46:47]
    s_waitcnt vmcnt(9)
    v_pk_add_f32 v[32:33], v[32:33], v[48:49]
    v_pk_add_f32 v[34:35], v[34:35], v[50:51]
    s_waitcnt vmcnt(8)
    v_pk_add_f32 v[32:33], v[32:33], v[52:53]
    v_pk_add_f32 v[34:35], v[34:35], v[54:55]
    s_waitcnt vmcnt(7)
    v_pk_add_f32 v[32:33], v[32:33], v[56:57]
    v_pk_add_f32 v[34:35], v[34:35], v[58:59]
    s_waitcnt vmcnt(6)
    v_pk_add_f32 v[32:33], v[32:33], v[60:61]
    v_pk_add_f32 v[34:35], v[34:35], v[62:63]
    s_waitcnt vmcnt(5)
    v_pk_add_f32 v[32:33], v[32:33], v[64:65]
    v_pk_add_f32 v[34:35], v[34:35], v[66:67]
    s_waitcnt vmcnt(4)
    v_pk_add_f32 v[32:33], v[32:33], v[68:69]
    v_pk_add_f32 v[34:35], v[34:35], v[70:71]
    s_waitcnt vmcnt(3)
    v_pk_add_f32 v[32:33], v[32:33], v[72:73]
    v_pk_add_f32 v[34:35], v[34:35], v[74:75]
    s_waitcnt vmcnt(2)
    v_pk_add_f32 v[32:33], v[32:33], v[76:77]
    v_pk_add_f32 v[34:35], v[34:35], v[78:79]
    s_waitcnt vmcnt(1)
    v_pk_add_f32 v[32:33], v[32:33], v[80:81]
    v_pk_add_f32 v[34:35], v[34:35], v[82:83]
    s_waitcnt vmcnt(0)
    v_pk_add_f32 v[32:33], v[32:33], v[84:85]
    v_pk_add_f32 v[34:35], v[34:35], v[86:87]
    s_nop 1
    v_permlane32_swap_b32 v32, v33
    v_permlane32_swap_b32 v34, v35
    s_nop 0
    v_add_f32 v32, v32, v33
    v_add_f32 v34, v34, v35
    s_nop 1
    v_permlane16_swap_b32 v32, v34
    s_nop 0
    v_add_f32_e64 v32, v32, v34
    ds_write_b32 v220, v32
    s_waitcnt lgkmcnt(0)
    s_barrier
    s_cmp_lg_u32 s3, 0
    s_cbranch_scc1 kc_fin
    ds_read_b32 v32, v221
    ds_read_b32 v33, v221 offset:256
    ds_read_b32 v34, v221 offset:512
    ds_read_b32 v35, v221 offset:768
    v_lshlrev_b32 v100, 16, v100
    v_lshlrev_b32 v101, 16, v101
    s_waitcnt lgkmcnt(0)
    v_add_f32 v32, v32, v33
    v_add_f32 v34, v34, v35
    v_add_f32 v32, v32, v34
    v_cvt_pk_bf16_f32 v32, v32, v32
    v_lshlrev_b32 v32, 16, v32
    v_mul_f32 v32, v32, v103
    v_cvt_pk_bf16_f32 v32, v32, v32
    v_lshlrev_b32 v32, 16, v32
    v_add_f32 v32, v32, v100
    v_cvt_pk_bf16_f32 v32, v32, v32
    v_lshlrev_b32 v32, 16, v32
    v_add_f32 v32, v32, v101
    v_cvt_pk_bf16_f32 v32, v32, v32
    buffer_store_short v32, v218, s[28:31], 0 offen
kc_fin:
    s_endpgm
kc_r3:
    s_mov_b32 s34, 0x400000
kc_r3l:
    s_sleep 4
    buffer_load_dwordx4 v[176:179], v228, s[8:11], s7 offen offset:0 sc1
    buffer_load_dwordx4 v[180:183], v228, s[8:11], s7 offen offset:1024 sc1
    buffer_load_dwordx4 v[184:187], v228, s[8:11], s7 offen offset:2048 sc1
    buffer_load_dwordx4 v[188:191], v228, s[8:11], s7 offen offset:3072 sc1
    s_waitcnt vmcnt(0)
    v_max3_u32 v235, v176, v177, v178
    v_max3_u32 v235, v235, v179, v180
    v_max3_u32 v235, v235, v181, v182
    v_max3_u32 v235, v235, v183, v184
    v_max3_u32 v235, v235, v185, v186
    v_max3_u32 v235, v235, v187, v188
    v_max3_u32 v235, v235, v189, v190
    v_max_u32 v235, v235, v191
    v_cmp_eq_u32 vcc, -1, v235
    s_sub_u32 s34, s34, 1
    s_cbranch_scc1 kc_r3o
    s_cbranch_vccnz kc_r3l
    s_branch kc_r3o
kc_r1:
    s_mov_b32 s34, 0x400000
kc_r1l:
    s_sleep 4
    buffer_load_dwordx4 v[96:99], v228, s[8:11], s37 offen offset:0 sc1
    buffer_load_dwordx4 v[100:103], v228, s[8:11], s37 offen offset:1024 sc1
    buffer_load_dwordx4 v[104:107], v228, s[8:11], s37 offen offset:2048 sc1
    buffer_load_dwordx4 v[108:111], v228, s[8:11], s37 offen offset:3072 sc1
    s_waitcnt vmcnt(0)
    v_max3_u32 v235, v96, v97, v98
    v_max3_u32 v235, v235, v99, v100
    v_max3_u32 v235, v235, v101, v102
    v_max3_u32 v235, v235, v103, v104
    v_max3_u32 v235, v235, v105, v106
    v_max3_u32 v235, v235, v107, v108
    v_max3_u32 v235, v235, v109, v110
    v_max_u32 v235, v235, v111
    v_cmp_eq_u32 vcc, -1, v235
    s_sub_u32 s34, s34, 1
    s_cbranch_scc1 kc_r1o
    s_cbranch_vccnz kc_r1l
    s_branch kc_r1o
kc_r2:
    s_mov_b32 s34, 0x400000
kc_r2l:
    s_sleep 4
    buffer_load_dwordx4 v[160:163], v228, s[8:11], s38 offen offset:0 sc1
    buffer_load_dwordx4 v[164:167], v228, s[8:11], s38 offen offset:1024 sc1
    buffer_load_dwordx4 v[168:171], v228, s[8:11], s38 offen offset:2048 sc1
    buffer_load_dwordx4 v[172:175], v228, s[8:11], s38 offen offset:3072 sc1
    s_waitcnt vmcnt(0)
    v_max3_u32 v235, v160, v161, v162
    v_max3_u32 v235, v235, v163, v164
    v_max3_u32 v235, v235, v165, v166
    v_max3_u32 v235, v235, v167, v168
    v_max3_u32 v235, v235, v169, v170
    v_max3_u32 v235, v235, v171, v172
    v_max3_u32 v235, v235, v173, v174
    v_max_u32 v235, v235, v175
    v_cmp_eq_u32 vcc, -1, v235
    s_sub_u32 s34, s34, 1
    s_cbranch_scc1 kc_r2o
    s_cbranch_vccnz kc_r2l
    s_branch kc_r2o
kc_g:
    s_mov_b32 s34, 0x400000
    s_branch kc_gs1
kc_gs0:
    s_sleep 2
kc_gs1:
    buffer_load_dword v235, off, s[8:11], s45 sc1
    s_waitcnt vmcnt(0)
    v_cmp_ne_u32_e64 vcc, 8, v235
    s_sub_u32 s34, s34, 1
    s_cbranch_scc1 kc_gs2
    s_cbranch_vccnz kc_gs0
kc_gs2:
    s_branch kc_gr
kc_end:
ka_done:
    s_endpgm
kf_fix1:
    s_cmp_eq_u32 s33, 0
    s_cselect_b32 s24, 0, 0x74000000
    s_cselect_b32 s36, 0, 0x1000
    s_mov_b32 s33, 1
    v_subrev_f32 v230, s24, v243
    v_add_f32 v231, 0, v230
    v_min_f32 v64, v224, v231
    v_add_f32 v232, 0xf1800000, v230
    v_min_f32_e64 v65, v224, v232
    v_add_f32 v231, 0xf2000000, v230
    v_min_f32_e64 v66, v224, v231
    v_add_f32 v232, 0xf2400000, v230
    v_min_f32_e64 v67, v224, v232
    v_add_f32 v231, 0xf3000000, v230
    v_min_f32_e64 v68, v224, v231
    v_add_f32 v232, 0xf3100000, v230
    v_min_f32_e64 v69, v224, v232
    v_add_f32 v231, 0xf3200000, v230
    v_min_f32_e64 v70, v224, v231
    v_add_f32 v232, 0xf3300000, v230
    v_min_f32_e64 v71, v224, v232
    v_add_f32 v231, 0x73800000, v230
    v_min_f32_e64 v72, v225, v231
    v_add_f32 v232, 0x73700000, v230
    v_min_f32_e64 v73, v225, v232
    v_add_f32 v231, 0x73600000, v230
    v_min_f32_e64 v74, v225, v231
    v_add_f32 v232, 0x73500000, v230
    v_min_f32_e64 v75, v225, v232
    v_add_f32 v231, 0x73000000, v230
    v_min_f32_e64 v76, v225, v231
    v_add_f32 v232, 0x72e00000, v230
    v_min_f32_e64 v77, v225, v232
    v_add_f32 v231, 0x72c00000, v230
    v_min_f32_e64 v78, v225, v231
    v_add_f32 v232, 0x72a00000, v230
    v_min_f32 v79, v225, v232
    s_nop 1
    s_branch kf_fixr2
kf_fix3:
    s_cmp_eq_u32 s33, 0
    s_cselect_b32 s24, 0, 0x74000000
    s_cselect_b32 s36, 0, 0x1000
    s_mov_b32 s33, 1
    v_subrev_f32 v230, s24, v243
    v_add_f32 v231, 0, v230
    v_min_f32 v64, v224, v231
    v_add_f32 v232, 0xf1800000, v230
    v_min_f32_e64 v65, v224, v232
    v_add_f32 v231, 0xf2000000, v230
    v_min_f32_e64 v66, v224, v231
    v_add_f32 v232, 0xf2400000, v230
    v_min_f32_e64 v67, v224, v232
    v_add_f32 v231, 0xf3000000, v230
    v_min_f32_e64 v68, v224, v231
    v_add_f32 v232, 0xf3100000, v230
    v_min_f32_e64 v69, v224, v232
    v_add_f32 v231, 0xf3200000, v230
    v_min_f32_e64 v70, v224, v231
    v_add_f32 v232, 0xf3300000, v230
    v_min_f32_e64 v71, v224, v232
    v_add_f32 v231, 0x73800000, v230
    v_min_f32_e64 v72, v225, v231
    v_add_f32 v232, 0x73700000, v230
    v_min_f32_e64 v73, v225, v232
    v_add_f32 v231, 0x73600000, v230
    v_min_f32_e64 v74, v225, v231
    v_add_f32 v232, 0x73500000, v230
    v_min_f32_e64 v75, v225, v232
    v_add_f32 v231, 0x73000000, v230
    v_min_f32_e64 v76, v225, v231
    v_add_f32 v232, 0x72e00000, v230
    v_min_f32_e64 v77, v225, v232
    v_add_f32 v231, 0x72c00000, v230
    v_min_f32_e64 v78, v225, v231
    v_add_f32 v232, 0x72a00000, v230
    v_min_f32 v79, v225, v232
    s_nop 1
    s_branch kf_fixr4
kf_rare6:
    s_nop 15
    v_max3_f32 v230, v32, v33, v34
    v_max3_f32 v230, v230, v35, v36
    v_max3_f32 v230, v230, v37, v38
    v_max_f32 v230, v230, v39
    v_mov_b32 v231, v230
    s_nop 1
    v_permlane16_swap_b32 v230, v231
    s_nop 0
    v_max_f32 v230, v230, v231
    v_mov_b32 v231, v230
    s_nop 1
    v_permlane32_swap_b32 v230, v231
    s_nop 0
    v_max_f32_e64 v230, v230, v231
    v_add_f32 v230, 0x41800000, v230
    v_max_f32 v230, 0, v230
    v_sub_f32 v232, 0, v230
    v_exp_f32 v232, v232
    v_sub_f32 v224, v224, v230
    v_sub_f32 v64, v64, v230
    v_sub_f32 v0, v0, v230
    v_sub_f32 v32, v32, v230
    v_sub_f32 v65, v65, v230
    v_sub_f32 v1, v1, v230
    v_sub_f32 v33, v33, v230
    v_sub_f32 v66, v66, v230
    v_sub_f32 v2, v2, v230
    v_sub_f32 v34, v34, v230
    v_sub_f32 v67, v67, v230
    v_sub_f32 v3, v3, v230
    v_sub_f32 v35, v35, v230
    v_sub_f32 v68, v68, v230
    v_sub_f32 v4, v4, v230
    v_sub_f32 v36, v36, v230
    v_sub_f32 v69, v69, v230
    v_sub_f32 v5, v5, v230
    v_sub_f32 v37, v37, v230
    v_sub_f32 v70, v70, v230
    v_sub_f32 v6, v6, v230
    v_sub_f32 v38, v38, v230
    v_sub_f32 v71, v71, v230
    v_sub_f32 v7, v7, v230
    v_sub_f32 v39, v39, v230
    v_mul_f32 v144, v144, v232
    v_mul_f32 v145, v145, v232
    v_mul_f32 v146, v146, v232
    v_mul_f32 v147, v147, v232
    v_accvgpr_read_b32 v233, a0
    v_mul_f32_e64 v233, v233, v232
    v_accvgpr_write_b32 a0, v233
    v_accvgpr_read_b32 v234, a1
    v_mul_f32_e64 v234, v234, v232
    v_accvgpr_write_b32 a1, v234
    v_accvgpr_read_b32 v235, a2
    v_mul_f32_e64 v235, v235, v232
    v_accvgpr_write_b32 a2, v235
    v_accvgpr_read_b32 v236, a3
    v_mul_f32_e64 v236, v236, v232
    v_accvgpr_write_b32 a3, v236
    v_accvgpr_read_b32 v233, a4
    v_mul_f32_e64 v233, v233, v232
    v_accvgpr_write_b32 a4, v233
    v_accvgpr_read_b32 v234, a5
    v_mul_f32_e64 v234, v234, v232
    v_accvgpr_write_b32 a5, v234
    v_accvgpr_read_b32 v235, a6
    v_mul_f32_e64 v235, v235, v232
    v_accvgpr_write_b32 a6, v235
    v_accvgpr_read_b32 v236, a7
    v_mul_f32_e64 v236, v236, v232
    v_accvgpr_write_b32 a7, v236
    v_accvgpr_read_b32 v233, a8
    v_mul_f32_e64 v233, v233, v232
    v_accvgpr_write_b32 a8, v233
    v_accvgpr_read_b32 v234, a9
    v_mul_f32_e64 v234, v234, v232
    v_accvgpr_write_b32 a9, v234
    v_accvgpr_read_b32 v235, a10
    v_mul_f32_e64 v235, v235, v232
    v_accvgpr_write_b32 a10, v235
    v_accvgpr_read_b32 v236, a11
    v_mul_f32_e64 v236, v236, v232
    v_accvgpr_write_b32 a11, v236
    v_accvgpr_read_b32 v233, a12
    v_mul_f32_e64 v233, v233, v232
    v_accvgpr_write_b32 a12, v233
    v_accvgpr_read_b32 v234, a13
    v_mul_f32_e64 v234, v234, v232
    v_accvgpr_write_b32 a13, v234
    v_accvgpr_read_b32 v235, a14
    v_mul_f32_e64 v235, v235, v232
    v_accvgpr_write_b32 a14, v235
    v_accvgpr_read_b32 v236, a15
    v_mul_f32_e64 v236, v236, v232
    v_accvgpr_write_b32 a15, v236
    v_accvgpr_read_b32 v233, a16
    v_mul_f32_e64 v233, v233, v232
    v_accvgpr_write_b32 a16, v233
    v_accvgpr_read_b32 v234, a17
    v_mul_f32_e64 v234, v234, v232
    v_accvgpr_write_b32 a17, v234
    v_accvgpr_read_b32 v235, a18
    v_mul_f32_e64 v235, v235, v232
    v_accvgpr_write_b32 a18, v235
    v_accvgpr_read_b32 v236, a19
    v_mul_f32_e64 v236, v236, v232
    v_accvgpr_write_b32 a19, v236
    v_accvgpr_read_b32 v233, a20
    v_mul_f32_e64 v233, v233, v232
    v_accvgpr_write_b32 a20, v233
    v_accvgpr_read_b32 v234, a21
    v_mul_f32_e64 v234, v234, v232
    v_accvgpr_write_b32 a21, v234
    v_accvgpr_read_b32 v235, a22
    v_mul_f32_e64 v235, v235, v232
    v_accvgpr_write_b32 a22, v235
    v_accvgpr_read_b32 v236, a23
    v_mul_f32_e64 v236, v236, v232
    v_accvgpr_write_b32 a23, v236
    v_accvgpr_read_b32 v233, a24
    v_mul_f32_e64 v233, v233, v232
    v_accvgpr_write_b32 a24, v233
    v_accvgpr_read_b32 v234, a25
    v_mul_f32_e64 v234, v234, v232
    v_accvgpr_write_b32 a25, v234
    v_accvgpr_read_b32 v235, a26
    v_mul_f32_e64 v235, v235, v232
    v_accvgpr_write_b32 a26, v235
    v_accvgpr_read_b32 v236, a27
    v_mul_f32_e64 v236, v236, v232
    v_accvgpr_write_b32 a27, v236
    v_accvgpr_read_b32 v233, a28
    v_mul_f32_e64 v233, v233, v232
    v_accvgpr_write_b32 a28, v233
    v_accvgpr_read_b32 v234, a29
    v_mul_f32_e64 v234, v234, v232
    v_accvgpr_write_b32 a29, v234
    v_accvgpr_read_b32 v235, a30
    v_mul_f32_e64 v235, v235, v232
    v_accvgpr_write_b32 a30, v235
    v_accvgpr_read_b32 v236, a31
    v_mul_f32_e64 v236, v236, v232
    v_accvgpr_write_b32 a31, v236
    v_exp_f32 v128, v32
    v_exp_f32 v129, v33
    v_exp_f32 v130, v34
    v_exp_f32 v131, v35
    v_exp_f32 v132, v36
    v_exp_f32 v133, v37
    v_exp_f32 v134, v38
    v_exp_f32_e64 v135, v39
    s_nop 0
    v_cvt_pk_bf16_f32 v112, v128, v129
    v_cvt_pk_bf16_f32 v113, v130, v131
    v_cvt_pk_bf16_f32 v114, v132, v133
    v_cvt_pk_bf16_f32 v115, v134, v135
    v_max3_f32 v230, v40, v41, v42
    v_max3_f32 v230, v230, v43, v44
    v_max3_f32 v230, v230, v45, v46
    v_max_f32 v230, v230, v47
    v_mov_b32 v231, v230
    s_nop 1
    v_permlane16_swap_b32 v230, v231
    s_nop 0
    v_max_f32 v230, v230, v231
    v_mov_b32 v231, v230
    s_nop 1
    v_permlane32_swap_b32 v230, v231
    s_nop 0
    v_max_f32_e64 v230, v230, v231
    v_add_f32 v230, 0x41800000, v230
    v_max_f32 v230, 0, v230
    v_sub_f32 v232, 0, v230
    v_exp_f32 v232, v232
    v_sub_f32 v225, v225, v230
    v_sub_f32 v72, v72, v230
    v_sub_f32 v8, v8, v230
    v_sub_f32 v40, v40, v230
    v_sub_f32 v73, v73, v230
    v_sub_f32 v9, v9, v230
    v_sub_f32 v41, v41, v230
    v_sub_f32 v74, v74, v230
    v_sub_f32 v10, v10, v230
    v_sub_f32 v42, v42, v230
    v_sub_f32 v75, v75, v230
    v_sub_f32 v11, v11, v230
    v_sub_f32 v43, v43, v230
    v_sub_f32 v76, v76, v230
    v_sub_f32 v12, v12, v230
    v_sub_f32 v44, v44, v230
    v_sub_f32 v77, v77, v230
    v_sub_f32 v13, v13, v230
    v_sub_f32 v45, v45, v230
    v_sub_f32 v78, v78, v230
    v_sub_f32 v14, v14, v230
    v_sub_f32 v46, v46, v230
    v_sub_f32 v79, v79, v230
    v_sub_f32 v15, v15, v230
    v_sub_f32 v47, v47, v230
    v_mul_f32 v148, v148, v232
    v_mul_f32 v149, v149, v232
    v_mul_f32 v150, v150, v232
    v_mul_f32 v151, v151, v232
    v_accvgpr_read_b32 v233, a32
    v_mul_f32_e64 v233, v233, v232
    v_accvgpr_write_b32 a32, v233
    v_accvgpr_read_b32 v234, a33
    v_mul_f32_e64 v234, v234, v232
    v_accvgpr_write_b32 a33, v234
    v_accvgpr_read_b32 v235, a34
    v_mul_f32_e64 v235, v235, v232
    v_accvgpr_write_b32 a34, v235
    v_accvgpr_read_b32 v236, a35
    v_mul_f32_e64 v236, v236, v232
    v_accvgpr_write_b32 a35, v236
    v_accvgpr_read_b32 v233, a36
    v_mul_f32_e64 v233, v233, v232
    v_accvgpr_write_b32 a36, v233
    v_accvgpr_read_b32 v234, a37
    v_mul_f32_e64 v234, v234, v232
    v_accvgpr_write_b32 a37, v234
    v_accvgpr_read_b32 v235, a38
    v_mul_f32_e64 v235, v235, v232
    v_accvgpr_write_b32 a38, v235
    v_accvgpr_read_b32 v236, a39
    v_mul_f32_e64 v236, v236, v232
    v_accvgpr_write_b32 a39, v236
    v_accvgpr_read_b32 v233, a40
    v_mul_f32_e64 v233, v233, v232
    v_accvgpr_write_b32 a40, v233
    v_accvgpr_read_b32 v234, a41
    v_mul_f32_e64 v234, v234, v232
    v_accvgpr_write_b32 a41, v234
    v_accvgpr_read_b32 v235, a42
    v_mul_f32_e64 v235, v235, v232
    v_accvgpr_write_b32 a42, v235
    v_accvgpr_read_b32 v236, a43
    v_mul_f32_e64 v236, v236, v232
    v_accvgpr_write_b32 a43, v236
    v_accvgpr_read_b32 v233, a44
    v_mul_f32_e64 v233, v233, v232
    v_accvgpr_write_b32 a44, v233
    v_accvgpr_read_b32 v234, a45
    v_mul_f32_e64 v234, v234, v232
    v_accvgpr_write_b32 a45, v234
    v_accvgpr_read_b32 v235, a46
    v_mul_f32_e64 v235, v235, v232
    v_accvgpr_write_b32 a46, v235
    v_accvgpr_read_b32 v236, a47
    v_mul_f32_e64 v236, v236, v232
    v_accvgpr_write_b32 a47, v236
    v_accvgpr_read_b32 v233, a48
    v_mul_f32_e64 v233, v233, v232
    v_accvgpr_write_b32 a48, v233
    v_accvgpr_read_b32 v234, a49
    v_mul_f32_e64 v234, v234, v232
    v_accvgpr_write_b32 a49, v234
    v_accvgpr_read_b32 v235, a50
    v_mul_f32_e64 v235, v235, v232
    v_accvgpr_write_b32 a50, v235
    v_accvgpr_read_b32 v236, a51
    v_mul_f32_e64 v236, v236, v232
    v_accvgpr_write_b32 a51, v236
    v_accvgpr_read_b32 v233, a52
    v_mul_f32_e64 v233, v233, v232
    v_accvgpr_write_b32 a52, v233
    v_accvgpr_read_b32 v234, a53
    v_mul_f32_e64 v234, v234, v232
    v_accvgpr_write_b32 a53, v234
    v_accvgpr_read_b32 v235, a54
    v_mul_f32_e64 v235, v235, v232
    v_accvgpr_write_b32 a54, v235
    v_accvgpr_read_b32 v236, a55
    v_mul_f32_e64 v236, v236, v232
    v_accvgpr_write_b32 a55, v236
    v_accvgpr_read_b32 v233, a56
    v_mul_f32_e64 v233, v233, v232
    v_accvgpr_write_b32 a56, v233
    v_accvgpr_read_b32 v234, a57
    v_mul_f32_e64 v234, v234, v232
    v_accvgpr_write_b32 a57, v234
    v_accvgpr_read_b32 v235, a58
    v_mul_f32_e64 v235, v235, v232
    v_accvgpr_write_b32 a58, v235
    v_accvgpr_read_b32 v236, a59
    v_mul_f32_e64 v236, v236, v232
    v_accvgpr_write_b32 a59, v236
    v_accvgpr_read_b32 v233, a60
    v_mul_f32_e64 v233, v233, v232
    v_accvgpr_write_b32 a60, v233
    v_accvgpr_read_b32 v234, a61
    v_mul_f32_e64 v234, v234, v232
    v_accvgpr_write_b32 a61, v234
    v_accvgpr_read_b32 v235, a62
    v_mul_f32_e64 v235, v235, v232
    v_accvgpr_write_b32 a62, v235
    v_accvgpr_read_b32 v236, a63
    v_mul_f32_e64 v236, v236, v232
    v_accvgpr_write_b32 a63, v236
    v_exp_f32 v128, v40
    v_exp_f32 v129, v41
    v_exp_f32 v130, v42
    v_exp_f32 v131, v43
    v_exp_f32 v132, v44
    v_exp_f32 v133, v45
    v_exp_f32 v134, v46
    v_exp_f32_e64 v135, v47
    s_nop 0
    v_cvt_pk_bf16_f32 v116, v128, v129
    v_cvt_pk_bf16_f32 v117, v130, v131
    v_cvt_pk_bf16_f32 v118, v132, v133
    v_cvt_pk_bf16_f32 v119, v134, v135
    v_max3_f32 v230, v48, v49, v50
    v_max3_f32 v230, v230, v51, v52
    v_max3_f32 v230, v230, v53, v54
    v_max_f32 v230, v230, v55
    v_mov_b32 v231, v230
    s_nop 1
    v_permlane16_swap_b32 v230, v231
    s_nop 0
    v_max_f32 v230, v230, v231
    v_mov_b32 v231, v230
    s_nop 1
    v_permlane32_swap_b32 v230, v231
    s_nop 0
    v_max_f32_e64 v230, v230, v231
    v_add_f32 v230, 0x41800000, v230
    v_max_f32 v230, 0, v230
    v_sub_f32 v232, 0, v230
    v_exp_f32 v232, v232
    v_sub_f32 v226, v226, v230
    v_sub_f32 v80, v80, v230
    v_sub_f32 v16, v16, v230
    v_sub_f32 v48, v48, v230
    v_sub_f32 v81, v81, v230
    v_sub_f32 v17, v17, v230
    v_sub_f32 v49, v49, v230
    v_sub_f32 v82, v82, v230
    v_sub_f32 v18, v18, v230
    v_sub_f32 v50, v50, v230
    v_sub_f32 v83, v83, v230
    v_sub_f32 v19, v19, v230
    v_sub_f32 v51, v51, v230
    v_sub_f32 v84, v84, v230
    v_sub_f32 v20, v20, v230
    v_sub_f32 v52, v52, v230
    v_sub_f32 v85, v85, v230
    v_sub_f32 v21, v21, v230
    v_sub_f32 v53, v53, v230
    v_sub_f32 v86, v86, v230
    v_sub_f32 v22, v22, v230
    v_sub_f32 v54, v54, v230
    v_sub_f32 v87, v87, v230
    v_sub_f32 v23, v23, v230
    v_sub_f32 v55, v55, v230
    v_mul_f32 v152, v152, v232
    v_mul_f32 v153, v153, v232
    v_mul_f32 v154, v154, v232
    v_mul_f32 v155, v155, v232
    v_accvgpr_read_b32 v233, a64
    v_mul_f32_e64 v233, v233, v232
    v_accvgpr_write_b32 a64, v233
    v_accvgpr_read_b32 v234, a65
    v_mul_f32_e64 v234, v234, v232
    v_accvgpr_write_b32 a65, v234
    v_accvgpr_read_b32 v235, a66
    v_mul_f32_e64 v235, v235, v232
    v_accvgpr_write_b32 a66, v235
    v_accvgpr_read_b32 v236, a67
    v_mul_f32_e64 v236, v236, v232
    v_accvgpr_write_b32 a67, v236
    v_accvgpr_read_b32 v233, a68
    v_mul_f32_e64 v233, v233, v232
    v_accvgpr_write_b32 a68, v233
    v_accvgpr_read_b32 v234, a69
    v_mul_f32_e64 v234, v234, v232
    v_accvgpr_write_b32 a69, v234
    v_accvgpr_read_b32 v235, a70
    v_mul_f32_e64 v235, v235, v232
    v_accvgpr_write_b32 a70, v235
    v_accvgpr_read_b32 v236, a71
    v_mul_f32_e64 v236, v236, v232
    v_accvgpr_write_b32 a71, v236
    v_accvgpr_read_b32 v233, a72
    v_mul_f32_e64 v233, v233, v232
    v_accvgpr_write_b32 a72, v233
    v_accvgpr_read_b32 v234, a73
    v_mul_f32_e64 v234, v234, v232
    v_accvgpr_write_b32 a73, v234
    v_accvgpr_read_b32 v235, a74
    v_mul_f32_e64 v235, v235, v232
    v_accvgpr_write_b32 a74, v235
    v_accvgpr_read_b32 v236, a75
    v_mul_f32_e64 v236, v236, v232
    v_accvgpr_write_b32 a75, v236
    v_accvgpr_read_b32 v233, a76
    v_mul_f32_e64 v233, v233, v232
    v_accvgpr_write_b32 a76, v233
    v_accvgpr_read_b32 v234, a77
    v_mul_f32_e64 v234, v234, v232
    v_accvgpr_write_b32 a77, v234
    v_accvgpr_read_b32 v235, a78
    v_mul_f32_e64 v235, v235, v232
    v_accvgpr_write_b32 a78, v235
    v_accvgpr_read_b32 v236, a79
    v_mul_f32_e64 v236, v236, v232
    v_accvgpr_write_b32 a79, v236
    v_accvgpr_read_b32 v233, a80
    v_mul_f32_e64 v233, v233, v232
    v_accvgpr_write_b32 a80, v233
    v_accvgpr_read_b32 v234, a81
    v_mul_f32_e64 v234, v234, v232
    v_accvgpr_write_b32 a81, v234
    v_accvgpr_read_b32 v235, a82
    v_mul_f32_e64 v235, v235, v232
    v_accvgpr_write_b32 a82, v235
    v_accvgpr_read_b32 v236, a83
    v_mul_f32_e64 v236, v236, v232
    v_accvgpr_write_b32 a83, v236
    v_accvgpr_read_b32 v233, a84
    v_mul_f32_e64 v233, v233, v232
    v_accvgpr_write_b32 a84, v233
    v_accvgpr_read_b32 v234, a85
    v_mul_f32_e64 v234, v234, v232
    v_accvgpr_write_b32 a85, v234
    v_accvgpr_read_b32 v235, a86
    v_mul_f32_e64 v235, v235, v232
    v_accvgpr_write_b32 a86, v235
    v_accvgpr_read_b32 v236, a87
    v_mul_f32_e64 v236, v236, v232
    v_accvgpr_write_b32 a87, v236
    v_accvgpr_read_b32 v233, a88
    v_mul_f32_e64 v233, v233, v232
    v_accvgpr_write_b32 a88, v233
    v_accvgpr_read_b32 v234, a89
    v_mul_f32_e64 v234, v234, v232
    v_accvgpr_write_b32 a89, v234
    v_accvgpr_read_b32 v235, a90
    v_mul_f32_e64 v235, v235, v232
    v_accvgpr_write_b32 a90, v235
    v_accvgpr_read_b32 v236, a91
    v_mul_f32_e64 v236, v236, v232
    v_accvgpr_write_b32 a91, v236
    v_accvgpr_read_b32 v233, a92
    v_mul_f32_e64 v233, v233, v232
    v_accvgpr_write_b32 a92, v233
    v_accvgpr_read_b32 v234, a93
    v_mul_f32_e64 v234, v234, v232
    v_accvgpr_write_b32 a93, v234
    v_accvgpr_read_b32 v235, a94
    v_mul_f32_e64 v235, v235, v232
    v_accvgpr_write_b32 a94, v235
    v_accvgpr_read_b32 v236, a95
    v_mul_f32_e64 v236, v236, v232
    v_accvgpr_write_b32 a95, v236
    v_exp_f32 v128, v48
    v_exp_f32 v129, v49
    v_exp_f32 v130, v50
    v_exp_f32 v131, v51
    v_exp_f32 v132, v52
    v_exp_f32 v133, v53
    v_exp_f32 v134, v54
    v_exp_f32_e64 v135, v55
    s_nop 0
    v_cvt_pk_bf16_f32 v120, v128, v129
    v_cvt_pk_bf16_f32 v121, v130, v131
    v_cvt_pk_bf16_f32 v122, v132, v133
    v_cvt_pk_bf16_f32 v123, v134, v135
    v_max3_f32 v230, v56, v57, v58
    v_max3_f32 v230, v230, v59, v60
    v_max3_f32 v230, v230, v61, v62
    v_max_f32 v230, v230, v63
    v_mov_b32 v231, v230
    s_nop 1
    v_permlane16_swap_b32 v230, v231
    s_nop 0
    v_max_f32 v230, v230, v231
    v_mov_b32 v231, v230
    s_nop 1
    v_permlane32_swap_b32 v230, v231
    s_nop 0
    v_max_f32_e64 v230, v230, v231
    v_add_f32 v230, 0x41800000, v230
    v_max_f32 v230, 0, v230
    v_sub_f32 v232, 0, v230
    v_exp_f32 v232, v232
    v_sub_f32 v227, v227, v230
    v_sub_f32 v88, v88, v230
    v_sub_f32 v24, v24, v230
    v_sub_f32 v56, v56, v230
    v_sub_f32 v89, v89, v230
    v_sub_f32 v25, v25, v230
    v_sub_f32 v57, v57, v230
    v_sub_f32 v90, v90, v230
    v_sub_f32 v26, v26, v230
    v_sub_f32 v58, v58, v230
    v_sub_f32 v91, v91, v230
    v_sub_f32 v27, v27, v230
    v_sub_f32 v59, v59, v230
    v_sub_f32 v92, v92, v230
    v_sub_f32 v28, v28, v230
    v_sub_f32 v60, v60, v230
    v_sub_f32 v93, v93, v230
    v_sub_f32 v29, v29, v230
    v_sub_f32 v61, v61, v230
    v_sub_f32 v94, v94, v230
    v_sub_f32 v30, v30, v230
    v_sub_f32 v62, v62, v230
    v_sub_f32 v95, v95, v230
    v_sub_f32 v31, v31, v230
    v_sub_f32 v63, v63, v230
    v_mul_f32 v156, v156, v232
    v_mul_f32 v157, v157, v232
    v_mul_f32 v158, v158, v232
    v_mul_f32 v159, v159, v232
    v_accvgpr_read_b32 v233, a96
    v_mul_f32_e64 v233, v233, v232
    v_accvgpr_write_b32 a96, v233
    v_accvgpr_read_b32 v234, a97
    v_mul_f32_e64 v234, v234, v232
    v_accvgpr_write_b32 a97, v234
    v_accvgpr_read_b32 v235, a98
    v_mul_f32_e64 v235, v235, v232
    v_accvgpr_write_b32 a98, v235
    v_accvgpr_read_b32 v236, a99
    v_mul_f32_e64 v236, v236, v232
    v_accvgpr_write_b32 a99, v236
    v_accvgpr_read_b32 v233, a100
    v_mul_f32_e64 v233, v233, v232
    v_accvgpr_write_b32 a100, v233
    v_accvgpr_read_b32 v234, a101
    v_mul_f32_e64 v234, v234, v232
    v_accvgpr_write_b32 a101, v234
    v_accvgpr_read_b32 v235, a102
    v_mul_f32_e64 v235, v235, v232
    v_accvgpr_write_b32 a102, v235
    v_accvgpr_read_b32 v236, a103
    v_mul_f32_e64 v236, v236, v232
    v_accvgpr_write_b32 a103, v236
    v_accvgpr_read_b32 v233, a104
    v_mul_f32_e64 v233, v233, v232
    v_accvgpr_write_b32 a104, v233
    v_accvgpr_read_b32 v234, a105
    v_mul_f32_e64 v234, v234, v232
    v_accvgpr_write_b32 a105, v234
    v_accvgpr_read_b32 v235, a106
    v_mul_f32_e64 v235, v235, v232
    v_accvgpr_write_b32 a106, v235
    v_accvgpr_read_b32 v236, a107
    v_mul_f32_e64 v236, v236, v232
    v_accvgpr_write_b32 a107, v236
    v_accvgpr_read_b32 v233, a108
    v_mul_f32_e64 v233, v233, v232
    v_accvgpr_write_b32 a108, v233
    v_accvgpr_read_b32 v234, a109
    v_mul_f32_e64 v234, v234, v232
    v_accvgpr_write_b32 a109, v234
    v_accvgpr_read_b32 v235, a110
    v_mul_f32_e64 v235, v235, v232
    v_accvgpr_write_b32 a110, v235
    v_accvgpr_read_b32 v236, a111
    v_mul_f32_e64 v236, v236, v232
    v_accvgpr_write_b32 a111, v236
    v_accvgpr_read_b32 v233, a112
    v_mul_f32_e64 v233, v233, v232
    v_accvgpr_write_b32 a112, v233
    v_accvgpr_read_b32 v234, a113
    v_mul_f32_e64 v234, v234, v232
    v_accvgpr_write_b32 a113, v234
    v_accvgpr_read_b32 v235, a114
    v_mul_f32_e64 v235, v235, v232
    v_accvgpr_write_b32 a114, v235
    v_accvgpr_read_b32 v236, a115
    v_mul_f32_e64 v236, v236, v232
    v_accvgpr_write_b32 a115, v236
    v_accvgpr_read_b32 v233, a116
    v_mul_f32_e64 v233, v233, v232
    v_accvgpr_write_b32 a116, v233
    v_accvgpr_read_b32 v234, a117
    v_mul_f32_e64 v234, v234, v232
    v_accvgpr_write_b32 a117, v234
    v_accvgpr_read_b32 v235, a118
    v_mul_f32_e64 v235, v235, v232
    v_accvgpr_write_b32 a118, v235
    v_accvgpr_read_b32 v236, a119
    v_mul_f32_e64 v236, v236, v232
    v_accvgpr_write_b32 a119, v236
    v_accvgpr_read_b32 v233, a120
    v_mul_f32_e64 v233, v233, v232
    v_accvgpr_write_b32 a120, v233
    v_accvgpr_read_b32 v234, a121
    v_mul_f32_e64 v234, v234, v232
    v_accvgpr_write_b32 a121, v234
    v_accvgpr_read_b32 v235, a122
    v_mul_f32_e64 v235, v235, v232
    v_accvgpr_write_b32 a122, v235
    v_accvgpr_read_b32 v236, a123
    v_mul_f32_e64 v236, v236, v232
    v_accvgpr_write_b32 a123, v236
    v_accvgpr_read_b32 v233, a124
    v_mul_f32_e64 v233, v233, v232
    v_accvgpr_write_b32 a124, v233
    v_accvgpr_read_b32 v234, a125
    v_mul_f32_e64 v234, v234, v232
    v_accvgpr_write_b32 a125, v234
    v_accvgpr_read_b32 v235, a126
    v_mul_f32_e64 v235, v235, v232
    v_accvgpr_write_b32 a126, v235
    v_accvgpr_read_b32 v236, a127
    v_mul_f32_e64 v236, v236, v232
    v_accvgpr_write_b32 a127, v236
    v_exp_f32 v128, v56
    v_exp_f32 v129, v57
    v_exp_f32 v130, v58
    v_exp_f32 v131, v59
    v_exp_f32 v132, v60
    v_exp_f32 v133, v61
    v_exp_f32 v134, v62
    v_exp_f32_e64 v135, v63
    s_nop 0
    v_cvt_pk_bf16_f32 v124, v128, v129
    v_cvt_pk_bf16_f32 v125, v130, v131
    v_cvt_pk_bf16_f32 v126, v132, v133
    v_cvt_pk_bf16_f32 v127, v134, v135
    s_nop 1
    s_branch kf_rr5
kf_rare10:
    s_nop 15
    v_max3_f32 v230, v0, v1, v2
    v_max3_f32 v230, v230, v3, v4
    v_max3_f32 v230, v230, v5, v6
    v_max_f32 v230, v230, v7
    v_mov_b32 v231, v230
    s_nop 1
    v_permlane16_swap_b32 v230, v231
    s_nop 0
    v_max_f32 v230, v230, v231
    v_mov_b32 v231, v230
    s_nop 1
    v_permlane32_swap_b32 v230, v231
    s_nop 0
    v_max_f32 v230, v230, v231
    v_add_f32 v230, 0x41800000, v230
    v_max_f32 v230, 0, v230
    v_sub_f32 v232, 0, v230
    v_exp_f32 v232, v232
    v_sub_f32 v224, v224, v230
    v_sub_f32 v64, v64, v230
    v_sub_f32 v32, v32, v230
    v_sub_f32 v0, v0, v230
    v_sub_f32 v65, v65, v230
    v_sub_f32 v33, v33, v230
    v_sub_f32 v1, v1, v230
    v_sub_f32 v66, v66, v230
    v_sub_f32 v34, v34, v230
    v_sub_f32 v2, v2, v230
    v_sub_f32 v67, v67, v230
    v_sub_f32 v35, v35, v230
    v_sub_f32 v3, v3, v230
    v_sub_f32 v68, v68, v230
    v_sub_f32 v36, v36, v230
    v_sub_f32 v4, v4, v230
    v_sub_f32 v69, v69, v230
    v_sub_f32 v37, v37, v230
    v_sub_f32 v5, v5, v230
    v_sub_f32 v70, v70, v230
    v_sub_f32 v38, v38, v230
    v_sub_f32 v6, v6, v230
    v_sub_f32 v71, v71, v230
    v_sub_f32 v39, v39, v230
    v_sub_f32 v7, v7, v230
    v_mul_f32 v144, v144, v232
    v_mul_f32 v145, v145, v232
    v_mul_f32 v146, v146, v232
    v_mul_f32 v147, v147, v232
    v_accvgpr_read_b32 v233, a0
    v_mul_f32_e64 v233, v233, v232
    v_accvgpr_write_b32 a0, v233
    v_accvgpr_read_b32 v234, a1
    v_mul_f32_e64 v234, v234, v232
    v_accvgpr_write_b32 a1, v234
    v_accvgpr_read_b32 v235, a2
    v_mul_f32_e64 v235, v235, v232
    v_accvgpr_write_b32 a2, v235
    v_accvgpr_read_b32 v236, a3
    v_mul_f32_e64 v236, v236, v232
    v_accvgpr_write_b32 a3, v236
    v_accvgpr_read_b32 v233, a4
    v_mul_f32_e64 v233, v233, v232
    v_accvgpr_write_b32 a4, v233
    v_accvgpr_read_b32 v234, a5
    v_mul_f32_e64 v234, v234, v232
    v_accvgpr_write_b32 a5, v234
    v_accvgpr_read_b32 v235, a6
    v_mul_f32_e64 v235, v235, v232
    v_accvgpr_write_b32 a6, v235
    v_accvgpr_read_b32 v236, a7
    v_mul_f32_e64 v236, v236, v232
    v_accvgpr_write_b32 a7, v236
    v_accvgpr_read_b32 v233, a8
    v_mul_f32_e64 v233, v233, v232
    v_accvgpr_write_b32 a8, v233
    v_accvgpr_read_b32 v234, a9
    v_mul_f32_e64 v234, v234, v232
    v_accvgpr_write_b32 a9, v234
    v_accvgpr_read_b32 v235, a10
    v_mul_f32_e64 v235, v235, v232
    v_accvgpr_write_b32 a10, v235
    v_accvgpr_read_b32 v236, a11
    v_mul_f32_e64 v236, v236, v232
    v_accvgpr_write_b32 a11, v236
    v_accvgpr_read_b32 v233, a12
    v_mul_f32_e64 v233, v233, v232
    v_accvgpr_write_b32 a12, v233
    v_accvgpr_read_b32 v234, a13
    v_mul_f32_e64 v234, v234, v232
    v_accvgpr_write_b32 a13, v234
    v_accvgpr_read_b32 v235, a14
    v_mul_f32_e64 v235, v235, v232
    v_accvgpr_write_b32 a14, v235
    v_accvgpr_read_b32 v236, a15
    v_mul_f32_e64 v236, v236, v232
    v_accvgpr_write_b32 a15, v236
    v_accvgpr_read_b32 v233, a16
    v_mul_f32_e64 v233, v233, v232
    v_accvgpr_write_b32 a16, v233
    v_accvgpr_read_b32 v234, a17
    v_mul_f32_e64 v234, v234, v232
    v_accvgpr_write_b32 a17, v234
    v_accvgpr_read_b32 v235, a18
    v_mul_f32_e64 v235, v235, v232
    v_accvgpr_write_b32 a18, v235
    v_accvgpr_read_b32 v236, a19
    v_mul_f32_e64 v236, v236, v232
    v_accvgpr_write_b32 a19, v236
    v_accvgpr_read_b32 v233, a20
    v_mul_f32_e64 v233, v233, v232
    v_accvgpr_write_b32 a20, v233
    v_accvgpr_read_b32 v234, a21
    v_mul_f32_e64 v234, v234, v232
    v_accvgpr_write_b32 a21, v234
    v_accvgpr_read_b32 v235, a22
    v_mul_f32_e64 v235, v235, v232
    v_accvgpr_write_b32 a22, v235
    v_accvgpr_read_b32 v236, a23
    v_mul_f32_e64 v236, v236, v232
    v_accvgpr_write_b32 a23, v236
    v_accvgpr_read_b32 v233, a24
    v_mul_f32_e64 v233, v233, v232
    v_accvgpr_write_b32 a24, v233
    v_accvgpr_read_b32 v234, a25
    v_mul_f32_e64 v234, v234, v232
    v_accvgpr_write_b32 a25, v234
    v_accvgpr_read_b32 v235, a26
    v_mul_f32_e64 v235, v235, v232
    v_accvgpr_write_b32 a26, v235
    v_accvgpr_read_b32 v236, a27
    v_mul_f32_e64 v236, v236, v232
    v_accvgpr_write_b32 a27, v236
    v_accvgpr_read_b32 v233, a28
    v_mul_f32_e64 v233, v233, v232
    v_accvgpr_write_b32 a28, v233
    v_accvgpr_read_b32 v234, a29
    v_mul_f32_e64 v234, v234, v232
    v_accvgpr_write_b32 a29, v234
    v_accvgpr_read_b32 v235, a30
    v_mul_f32_e64 v235, v235, v232
    v_accvgpr_write_b32 a30, v235
    v_accvgpr_read_b32 v236, a31
    v_mul_f32_e64 v236, v236, v232
    v_accvgpr_write_b32 a31, v236
    v_exp_f32 v128, v0
    v_exp_f32 v129, v1
    v_exp_f32 v130, v2
    v_exp_f32 v131, v3
    v_exp_f32 v132, v4
    v_exp_f32 v133, v5
    v_exp_f32 v134, v6
    v_exp_f32_e64 v135, v7
    s_nop 0
    v_cvt_pk_bf16_f32 v96, v128, v129
    v_cvt_pk_bf16_f32 v97, v130, v131
    v_cvt_pk_bf16_f32 v98, v132, v133
    v_cvt_pk_bf16_f32 v99, v134, v135
    v_max3_f32 v230, v8, v9, v10
    v_max3_f32 v230, v230, v11, v12
    v_max3_f32 v230, v230, v13, v14
    v_max_f32 v230, v230, v15
    v_mov_b32 v231, v230
    s_nop 1
    v_permlane16_swap_b32 v230, v231
    s_nop 0
    v_max_f32 v230, v230, v231
    v_mov_b32 v231, v230
    s_nop 1
    v_permlane32_swap_b32 v230, v231
    s_nop 0
    v_max_f32_e64 v230, v230, v231
    v_add_f32 v230, 0x41800000, v230
    v_max_f32 v230, 0, v230
    v_sub_f32 v232, 0, v230
    v_exp_f32 v232, v232
    v_sub_f32 v225, v225, v230
    v_sub_f32 v72, v72, v230
    v_sub_f32 v40, v40, v230
    v_sub_f32 v8, v8, v230
    v_sub_f32 v73, v73, v230
    v_sub_f32 v41, v41, v230
    v_sub_f32 v9, v9, v230
    v_sub_f32 v74, v74, v230
    v_sub_f32 v42, v42, v230
    v_sub_f32 v10, v10, v230
    v_sub_f32 v75, v75, v230
    v_sub_f32 v43, v43, v230
    v_sub_f32 v11, v11, v230
    v_sub_f32 v76, v76, v230
    v_sub_f32 v44, v44, v230
    v_sub_f32 v12, v12, v230
    v_sub_f32 v77, v77, v230
    v_sub_f32 v45, v45, v230
    v_sub_f32 v13, v13, v230
    v_sub_f32 v78, v78, v230
    v_sub_f32 v46, v46, v230
    v_sub_f32 v14, v14, v230
    v_sub_f32 v79, v79, v230
    v_sub_f32 v47, v47, v230
    v_sub_f32 v15, v15, v230
    v_mul_f32 v148, v148, v232
    v_mul_f32 v149, v149, v232
    v_mul_f32 v150, v150, v232
    v_mul_f32 v151, v151, v232
    v_accvgpr_read_b32 v233, a32
    v_mul_f32_e64 v233, v233, v232
    v_accvgpr_write_b32 a32, v233
    v_accvgpr_read_b32 v234, a33
    v_mul_f32_e64 v234, v234, v232
    v_accvgpr_write_b32 a33, v234
    v_accvgpr_read_b32 v235, a34
    v_mul_f32_e64 v235, v235, v232
    v_accvgpr_write_b32 a34, v235
    v_accvgpr_read_b32 v236, a35
    v_mul_f32_e64 v236, v236, v232
    v_accvgpr_write_b32 a35, v236
    v_accvgpr_read_b32 v233, a36
    v_mul_f32_e64 v233, v233, v232
    v_accvgpr_write_b32 a36, v233
    v_accvgpr_read_b32 v234, a37
    v_mul_f32_e64 v234, v234, v232
    v_accvgpr_write_b32 a37, v234
    v_accvgpr_read_b32 v235, a38
    v_mul_f32_e64 v235, v235, v232
    v_accvgpr_write_b32 a38, v235
    v_accvgpr_read_b32 v236, a39
    v_mul_f32_e64 v236, v236, v232
    v_accvgpr_write_b32 a39, v236
    v_accvgpr_read_b32 v233, a40
    v_mul_f32_e64 v233, v233, v232
    v_accvgpr_write_b32 a40, v233
    v_accvgpr_read_b32 v234, a41
    v_mul_f32_e64 v234, v234, v232
    v_accvgpr_write_b32 a41, v234
    v_accvgpr_read_b32 v235, a42
    v_mul_f32_e64 v235, v235, v232
    v_accvgpr_write_b32 a42, v235
    v_accvgpr_read_b32 v236, a43
    v_mul_f32_e64 v236, v236, v232
    v_accvgpr_write_b32 a43, v236
    v_accvgpr_read_b32 v233, a44
    v_mul_f32_e64 v233, v233, v232
    v_accvgpr_write_b32 a44, v233
    v_accvgpr_read_b32 v234, a45
    v_mul_f32_e64 v234, v234, v232
    v_accvgpr_write_b32 a45, v234
    v_accvgpr_read_b32 v235, a46
    v_mul_f32_e64 v235, v235, v232
    v_accvgpr_write_b32 a46, v235
    v_accvgpr_read_b32 v236, a47
    v_mul_f32_e64 v236, v236, v232
    v_accvgpr_write_b32 a47, v236
    v_accvgpr_read_b32 v233, a48
    v_mul_f32_e64 v233, v233, v232
    v_accvgpr_write_b32 a48, v233
    v_accvgpr_read_b32 v234, a49
    v_mul_f32_e64 v234, v234, v232
    v_accvgpr_write_b32 a49, v234
    v_accvgpr_read_b32 v235, a50
    v_mul_f32_e64 v235, v235, v232
    v_accvgpr_write_b32 a50, v235
    v_accvgpr_read_b32 v236, a51
    v_mul_f32_e64 v236, v236, v232
    v_accvgpr_write_b32 a51, v236
    v_accvgpr_read_b32 v233, a52
    v_mul_f32_e64 v233, v233, v232
    v_accvgpr_write_b32 a52, v233
    v_accvgpr_read_b32 v234, a53
    v_mul_f32_e64 v234, v234, v232
    v_accvgpr_write_b32 a53, v234
    v_accvgpr_read_b32 v235, a54
    v_mul_f32_e64 v235, v235, v232
    v_accvgpr_write_b32 a54, v235
    v_accvgpr_read_b32 v236, a55
    v_mul_f32_e64 v236, v236, v232
    v_accvgpr_write_b32 a55, v236
    v_accvgpr_read_b32 v233, a56
    v_mul_f32_e64 v233, v233, v232
    v_accvgpr_write_b32 a56, v233
    v_accvgpr_read_b32 v234, a57
    v_mul_f32_e64 v234, v234, v232
    v_accvgpr_write_b32 a57, v234
    v_accvgpr_read_b32 v235, a58
    v_mul_f32_e64 v235, v235, v232
    v_accvgpr_write_b32 a58, v235
    v_accvgpr_read_b32 v236, a59
    v_mul_f32_e64 v236, v236, v232
    v_accvgpr_write_b32 a59, v236
    v_accvgpr_read_b32 v233, a60
    v_mul_f32_e64 v233, v233, v232
    v_accvgpr_write_b32 a60, v233
    v_accvgpr_read_b32 v234, a61
    v_mul_f32_e64 v234, v234, v232
    v_accvgpr_write_b32 a61, v234
    v_accvgpr_read_b32 v235, a62
    v_mul_f32_e64 v235, v235, v232
    v_accvgpr_write_b32 a62, v235
    v_accvgpr_read_b32 v236, a63
    v_mul_f32_e64 v236, v236, v232
    v_accvgpr_write_b32 a63, v236
    v_exp_f32 v128, v8
    v_exp_f32 v129, v9
    v_exp_f32 v130, v10
    v_exp_f32 v131, v11
    v_exp_f32 v132, v12
    v_exp_f32 v133, v13
    v_exp_f32 v134, v14
    v_exp_f32_e64 v135, v15
    s_nop 0
    v_cvt_pk_bf16_f32 v100, v128, v129
    v_cvt_pk_bf16_f32 v101, v130, v131
    v_cvt_pk_bf16_f32 v102, v132, v133
    v_cvt_pk_bf16_f32 v103, v134, v135
    v_max3_f32 v230, v16, v17, v18
    v_max3_f32 v230, v230, v19, v20
    v_max3_f32 v230, v230, v21, v22
    v_max_f32 v230, v230, v23
    v_mov_b32 v231, v230
    s_nop 1
    v_permlane16_swap_b32 v230, v231
    s_nop 0
    v_max_f32 v230, v230, v231
    v_mov_b32 v231, v230
    s_nop 1
    v_permlane32_swap_b32 v230, v231
    s_nop 0
    v_max_f32_e64 v230, v230, v231
    v_add_f32 v230, 0x41800000, v230
    v_max_f32 v230, 0, v230
    v_sub_f32 v232, 0, v230
    v_exp_f32 v232, v232
    v_sub_f32 v226, v226, v230
    v_sub_f32 v80, v80, v230
    v_sub_f32 v48, v48, v230
    v_sub_f32 v16, v16, v230
    v_sub_f32 v81, v81, v230
    v_sub_f32 v49, v49, v230
    v_sub_f32 v17, v17, v230
    v_sub_f32 v82, v82, v230
    v_sub_f32 v50, v50, v230
    v_sub_f32 v18, v18, v230
    v_sub_f32 v83, v83, v230
    v_sub_f32 v51, v51, v230
    v_sub_f32 v19, v19, v230
    v_sub_f32 v84, v84, v230
    v_sub_f32 v52, v52, v230
    v_sub_f32 v20, v20, v230
    v_sub_f32 v85, v85, v230
    v_sub_f32 v53, v53, v230
    v_sub_f32 v21, v21, v230
    v_sub_f32 v86, v86, v230
    v_sub_f32 v54, v54, v230
    v_sub_f32 v22, v22, v230
    v_sub_f32 v87, v87, v230
    v_sub_f32 v55, v55, v230
    v_sub_f32 v23, v23, v230
    v_mul_f32 v152, v152, v232
    v_mul_f32 v153, v153, v232
    v_mul_f32 v154, v154, v232
    v_mul_f32 v155, v155, v232
    v_accvgpr_read_b32 v233, a64
    v_mul_f32_e64 v233, v233, v232
    v_accvgpr_write_b32 a64, v233
    v_accvgpr_read_b32 v234, a65
    v_mul_f32_e64 v234, v234, v232
    v_accvgpr_write_b32 a65, v234
    v_accvgpr_read_b32 v235, a66
    v_mul_f32_e64 v235, v235, v232
    v_accvgpr_write_b32 a66, v235
    v_accvgpr_read_b32 v236, a67
    v_mul_f32_e64 v236, v236, v232
    v_accvgpr_write_b32 a67, v236
    v_accvgpr_read_b32 v233, a68
    v_mul_f32_e64 v233, v233, v232
    v_accvgpr_write_b32 a68, v233
    v_accvgpr_read_b32 v234, a69
    v_mul_f32_e64 v234, v234, v232
    v_accvgpr_write_b32 a69, v234
    v_accvgpr_read_b32 v235, a70
    v_mul_f32_e64 v235, v235, v232
    v_accvgpr_write_b32 a70, v235
    v_accvgpr_read_b32 v236, a71
    v_mul_f32_e64 v236, v236, v232
    v_accvgpr_write_b32 a71, v236
    v_accvgpr_read_b32 v233, a72
    v_mul_f32_e64 v233, v233, v232
    v_accvgpr_write_b32 a72, v233
    v_accvgpr_read_b32 v234, a73
    v_mul_f32_e64 v234, v234, v232
    v_accvgpr_write_b32 a73, v234
    v_accvgpr_read_b32 v235, a74
    v_mul_f32_e64 v235, v235, v232
    v_accvgpr_write_b32 a74, v235
    v_accvgpr_read_b32 v236, a75
    v_mul_f32_e64 v236, v236, v232
    v_accvgpr_write_b32 a75, v236
    v_accvgpr_read_b32 v233, a76
    v_mul_f32_e64 v233, v233, v232
    v_accvgpr_write_b32 a76, v233
    v_accvgpr_read_b32 v234, a77
    v_mul_f32_e64 v234, v234, v232
    v_accvgpr_write_b32 a77, v234
    v_accvgpr_read_b32 v235, a78
    v_mul_f32_e64 v235, v235, v232
    v_accvgpr_write_b32 a78, v235
    v_accvgpr_read_b32 v236, a79
    v_mul_f32_e64 v236, v236, v232
    v_accvgpr_write_b32 a79, v236
    v_accvgpr_read_b32 v233, a80
    v_mul_f32_e64 v233, v233, v232
    v_accvgpr_write_b32 a80, v233
    v_accvgpr_read_b32 v234, a81
    v_mul_f32_e64 v234, v234, v232
    v_accvgpr_write_b32 a81, v234
    v_accvgpr_read_b32 v235, a82
    v_mul_f32_e64 v235, v235, v232
    v_accvgpr_write_b32 a82, v235
    v_accvgpr_read_b32 v236, a83
    v_mul_f32_e64 v236, v236, v232
    v_accvgpr_write_b32 a83, v236
    v_accvgpr_read_b32 v233, a84
    v_mul_f32_e64 v233, v233, v232
    v_accvgpr_write_b32 a84, v233
    v_accvgpr_read_b32 v234, a85
    v_mul_f32_e64 v234, v234, v232
    v_accvgpr_write_b32 a85, v234
    v_accvgpr_read_b32 v235, a86
    v_mul_f32_e64 v235, v235, v232
    v_accvgpr_write_b32 a86, v235
    v_accvgpr_read_b32 v236, a87
    v_mul_f32_e64 v236, v236, v232
    v_accvgpr_write_b32 a87, v236
    v_accvgpr_read_b32 v233, a88
    v_mul_f32_e64 v233, v233, v232
    v_accvgpr_write_b32 a88, v233
    v_accvgpr_read_b32 v234, a89
    v_mul_f32_e64 v234, v234, v232
    v_accvgpr_write_b32 a89, v234
    v_accvgpr_read_b32 v235, a90
    v_mul_f32_e64 v235, v235, v232
    v_accvgpr_write_b32 a90, v235
    v_accvgpr_read_b32 v236, a91
    v_mul_f32_e64 v236, v236, v232
    v_accvgpr_write_b32 a91, v236
    v_accvgpr_read_b32 v233, a92
    v_mul_f32_e64 v233, v233, v232
    v_accvgpr_write_b32 a92, v233
    v_accvgpr_read_b32 v234, a93
    v_mul_f32_e64 v234, v234, v232
    v_accvgpr_write_b32 a93, v234
    v_accvgpr_read_b32 v235, a94
    v_mul_f32_e64 v235, v235, v232
    v_accvgpr_write_b32 a94, v235
    v_accvgpr_read_b32 v236, a95
    v_mul_f32_e64 v236, v236, v232
    v_accvgpr_write_b32 a95, v236
    v_exp_f32 v128, v16
    v_exp_f32 v129, v17
    v_exp_f32 v130, v18
    v_exp_f32 v131, v19
    v_exp_f32 v132, v20
    v_exp_f32 v133, v21
    v_exp_f32 v134, v22
    v_exp_f32_e64 v135, v23
    s_nop 0
    v_cvt_pk_bf16_f32 v104, v128, v129
    v_cvt_pk_bf16_f32 v105, v130, v131
    v_cvt_pk_bf16_f32 v106, v132, v133
    v_cvt_pk_bf16_f32 v107, v134, v135
    v_max3_f32 v230, v24, v25, v26
    v_max3_f32 v230, v230, v27, v28
    v_max3_f32 v230, v230, v29, v30
    v_max_f32 v230, v230, v31
    v_mov_b32 v231, v230
    s_nop 1
    v_permlane16_swap_b32 v230, v231
    s_nop 0
    v_max_f32 v230, v230, v231
    v_mov_b32 v231, v230
    s_nop 1
    v_permlane32_swap_b32 v230, v231
    s_nop 0
    v_max_f32_e64 v230, v230, v231
    v_add_f32 v230, 0x41800000, v230
    v_max_f32 v230, 0, v230
    v_sub_f32 v232, 0, v230
    v_exp_f32 v232, v232
    v_sub_f32 v227, v227, v230
    v_sub_f32 v88, v88, v230
    v_sub_f32 v56, v56, v230
    v_sub_f32 v24, v24, v230
    v_sub_f32 v89, v89, v230
    v_sub_f32 v57, v57, v230
    v_sub_f32 v25, v25, v230
    v_sub_f32 v90, v90, v230
    v_sub_f32 v58, v58, v230
    v_sub_f32 v26, v26, v230
    v_sub_f32 v91, v91, v230
    v_sub_f32 v59, v59, v230
    v_sub_f32 v27, v27, v230
    v_sub_f32 v92, v92, v230
    v_sub_f32 v60, v60, v230
    v_sub_f32 v28, v28, v230
    v_sub_f32 v93, v93, v230
    v_sub_f32 v61, v61, v230
    v_sub_f32 v29, v29, v230
    v_sub_f32 v94, v94, v230
    v_sub_f32 v62, v62, v230
    v_sub_f32 v30, v30, v230
    v_sub_f32 v95, v95, v230
    v_sub_f32 v63, v63, v230
    v_sub_f32 v31, v31, v230
    v_mul_f32 v156, v156, v232
    v_mul_f32 v157, v157, v232
    v_mul_f32 v158, v158, v232
    v_mul_f32 v159, v159, v232
    v_accvgpr_read_b32 v233, a96
    v_mul_f32_e64 v233, v233, v232
    v_accvgpr_write_b32 a96, v233
    v_accvgpr_read_b32 v234, a97
    v_mul_f32_e64 v234, v234, v232
    v_accvgpr_write_b32 a97, v234
    v_accvgpr_read_b32 v235, a98
    v_mul_f32_e64 v235, v235, v232
    v_accvgpr_write_b32 a98, v235
    v_accvgpr_read_b32 v236, a99
    v_mul_f32_e64 v236, v236, v232
    v_accvgpr_write_b32 a99, v236
    v_accvgpr_read_b32 v233, a100
    v_mul_f32_e64 v233, v233, v232
    v_accvgpr_write_b32 a100, v233
    v_accvgpr_read_b32 v234, a101
    v_mul_f32_e64 v234, v234, v232
    v_accvgpr_write_b32 a101, v234
    v_accvgpr_read_b32 v235, a102
    v_mul_f32_e64 v235, v235, v232
    v_accvgpr_write_b32 a102, v235
    v_accvgpr_read_b32 v236, a103
    v_mul_f32_e64 v236, v236, v232
    v_accvgpr_write_b32 a103, v236
    v_accvgpr_read_b32 v233, a104
    v_mul_f32_e64 v233, v233, v232
    v_accvgpr_write_b32 a104, v233
    v_accvgpr_read_b32 v234, a105
    v_mul_f32_e64 v234, v234, v232
    v_accvgpr_write_b32 a105, v234
    v_accvgpr_read_b32 v235, a106
    v_mul_f32_e64 v235, v235, v232
    v_accvgpr_write_b32 a106, v235
    v_accvgpr_read_b32 v236, a107
    v_mul_f32_e64 v236, v236, v232
    v_accvgpr_write_b32 a107, v236
    v_accvgpr_read_b32 v233, a108
    v_mul_f32_e64 v233, v233, v232
    v_accvgpr_write_b32 a108, v233
    v_accvgpr_read_b32 v234, a109
    v_mul_f32_e64 v234, v234, v232
    v_accvgpr_write_b32 a109, v234
    v_accvgpr_read_b32 v235, a110
    v_mul_f32_e64 v235, v235, v232
    v_accvgpr_write_b32 a110, v235
    v_accvgpr_read_b32 v236, a111
    v_mul_f32_e64 v236, v236, v232
    v_accvgpr_write_b32 a111, v236
    v_accvgpr_read_b32 v233, a112
    v_mul_f32_e64 v233, v233, v232
    v_accvgpr_write_b32 a112, v233
    v_accvgpr_read_b32 v234, a113
    v_mul_f32_e64 v234, v234, v232
    v_accvgpr_write_b32 a113, v234
    v_accvgpr_read_b32 v235, a114
    v_mul_f32_e64 v235, v235, v232
    v_accvgpr_write_b32 a114, v235
    v_accvgpr_read_b32 v236, a115
    v_mul_f32_e64 v236, v236, v232
    v_accvgpr_write_b32 a115, v236
    v_accvgpr_read_b32 v233, a116
    v_mul_f32_e64 v233, v233, v232
    v_accvgpr_write_b32 a116, v233
    v_accvgpr_read_b32 v234, a117
    v_mul_f32_e64 v234, v234, v232
    v_accvgpr_write_b32 a117, v234
    v_accvgpr_read_b32 v235, a118
    v_mul_f32_e64 v235, v235, v232
    v_accvgpr_write_b32 a118, v235
    v_accvgpr_read_b32 v236, a119
    v_mul_f32_e64 v236, v236, v232
    v_accvgpr_write_b32 a119, v236
    v_accvgpr_read_b32 v233, a120
    v_mul_f32_e64 v233, v233, v232
    v_accvgpr_write_b32 a120, v233
    v_accvgpr_read_b32 v234, a121
    v_mul_f32_e64 v234, v234, v232
    v_accvgpr_write_b32 a121, v234
    v_accvgpr_read_b32 v235, a122
    v_mul_f32_e64 v235, v235, v232
    v_accvgpr_write_b32 a122, v235
    v_accvgpr_read_b32 v236, a123
    v_mul_f32_e64 v236, v236, v232
    v_accvgpr_write_b32 a123, v236
    v_accvgpr_read_b32 v233, a124
    v_mul_f32_e64 v233, v233, v232
    v_accvgpr_write_b32 a124, v233
    v_accvgpr_read_b32 v234, a125
    v_mul_f32_e64 v234, v234, v232
    v_accvgpr_write_b32 a125, v234
    v_accvgpr_read_b32 v235, a126
    v_mul_f32_e64 v235, v235, v232
    v_accvgpr_write_b32 a126, v235
    v_accvgpr_read_b32 v236, a127
    v_mul_f32_e64 v236, v236, v232
    v_accvgpr_write_b32 a127, v236
    v_exp_f32 v128, v24
    v_exp_f32 v129, v25
    v_exp_f32 v130, v26
    v_exp_f32 v131, v27
    v_exp_f32 v132, v28
    v_exp_f32 v133, v29
    v_exp_f32 v134, v30
    v_exp_f32_e64 v135, v31
    s_nop 0
    v_cvt_pk_bf16_f32 v108, v128, v129
    v_cvt_pk_bf16_f32 v109, v130, v131
    v_cvt_pk_bf16_f32 v110, v132, v133
    v_cvt_pk_bf16_f32 v111, v134, v135
    s_nop 1
    s_branch kf_rr9
kf_rare14:
    s_nop 15
    v_max3_f32 v230, v32, v33, v34
    v_max3_f32 v230, v230, v35, v36
    v_max3_f32 v230, v230, v37, v38
    v_max_f32 v230, v230, v39
    v_mov_b32 v231, v230
    s_nop 1
    v_permlane16_swap_b32 v230, v231
    s_nop 0
    v_max_f32 v230, v230, v231
    v_mov_b32 v231, v230
    s_nop 1
    v_permlane32_swap_b32 v230, v231
    s_nop 0
    v_max_f32 v230, v230, v231
    v_add_f32 v230, 0x41800000, v230
    v_max_f32 v230, 0, v230
    v_sub_f32 v232, 0, v230
    v_exp_f32 v232, v232
    v_sub_f32 v224, v224, v230
    v_sub_f32 v64, v64, v230
    v_sub_f32 v0, v0, v230
    v_sub_f32 v32, v32, v230
    v_sub_f32 v65, v65, v230
    v_sub_f32 v1, v1, v230
    v_sub_f32 v33, v33, v230
    v_sub_f32 v66, v66, v230
    v_sub_f32 v2, v2, v230
    v_sub_f32 v34, v34, v230
    v_sub_f32 v67, v67, v230
    v_sub_f32 v3, v3, v230
    v_sub_f32 v35, v35, v230
    v_sub_f32 v68, v68, v230
    v_sub_f32 v4, v4, v230
    v_sub_f32 v36, v36, v230
    v_sub_f32 v69, v69, v230
    v_sub_f32 v5, v5, v230
    v_sub_f32 v37, v37, v230
    v_sub_f32 v70, v70, v230
    v_sub_f32 v6, v6, v230
    v_sub_f32 v38, v38, v230
    v_sub_f32 v71, v71, v230
    v_sub_f32 v7, v7, v230
    v_sub_f32 v39, v39, v230
    v_mul_f32 v144, v144, v232
    v_mul_f32 v145, v145, v232
    v_mul_f32 v146, v146, v232
    v_mul_f32 v147, v147, v232
    v_accvgpr_read_b32 v233, a0
    v_mul_f32_e64 v233, v233, v232
    v_accvgpr_write_b32 a0, v233
    v_accvgpr_read_b32 v234, a1
    v_mul_f32_e64 v234, v234, v232
    v_accvgpr_write_b32 a1, v234
    v_accvgpr_read_b32 v235, a2
    v_mul_f32_e64 v235, v235, v232
    v_accvgpr_write_b32 a2, v235
    v_accvgpr_read_b32 v236, a3
    v_mul_f32_e64 v236, v236, v232
    v_accvgpr_write_b32 a3, v236
    v_accvgpr_read_b32 v233, a4
    v_mul_f32_e64 v233, v233, v232
    v_accvgpr_write_b32 a4, v233
    v_accvgpr_read_b32 v234, a5
    v_mul_f32_e64 v234, v234, v232
    v_accvgpr_write_b32 a5, v234
    v_accvgpr_read_b32 v235, a6
    v_mul_f32_e64 v235, v235, v232
    v_accvgpr_write_b32 a6, v235
    v_accvgpr_read_b32 v236, a7
    v_mul_f32_e64 v236, v236, v232
    v_accvgpr_write_b32 a7, v236
    v_accvgpr_read_b32 v233, a8
    v_mul_f32_e64 v233, v233, v232
    v_accvgpr_write_b32 a8, v233
    v_accvgpr_read_b32 v234, a9
    v_mul_f32_e64 v234, v234, v232
    v_accvgpr_write_b32 a9, v234
    v_accvgpr_read_b32 v235, a10
    v_mul_f32_e64 v235, v235, v232
    v_accvgpr_write_b32 a10, v235
    v_accvgpr_read_b32 v236, a11
    v_mul_f32_e64 v236, v236, v232
    v_accvgpr_write_b32 a11, v236
    v_accvgpr_read_b32 v233, a12
    v_mul_f32_e64 v233, v233, v232
    v_accvgpr_write_b32 a12, v233
    v_accvgpr_read_b32 v234, a13
    v_mul_f32_e64 v234, v234, v232
    v_accvgpr_write_b32 a13, v234
    v_accvgpr_read_b32 v235, a14
    v_mul_f32_e64 v235, v235, v232
    v_accvgpr_write_b32 a14, v235
    v_accvgpr_read_b32 v236, a15
    v_mul_f32_e64 v236, v236, v232
    v_accvgpr_write_b32 a15, v236
    v_accvgpr_read_b32 v233, a16
    v_mul_f32_e64 v233, v233, v232
    v_accvgpr_write_b32 a16, v233
    v_accvgpr_read_b32 v234, a17
    v_mul_f32_e64 v234, v234, v232
    v_accvgpr_write_b32 a17, v234
    v_accvgpr_read_b32 v235, a18
    v_mul_f32_e64 v235, v235, v232
    v_accvgpr_write_b32 a18, v235
    v_accvgpr_read_b32 v236, a19
    v_mul_f32_e64 v236, v236, v232
    v_accvgpr_write_b32 a19, v236
    v_accvgpr_read_b32 v233, a20
    v_mul_f32_e64 v233, v233, v232
    v_accvgpr_write_b32 a20, v233
    v_accvgpr_read_b32 v234, a21
    v_mul_f32_e64 v234, v234, v232
    v_accvgpr_write_b32 a21, v234
    v_accvgpr_read_b32 v235, a22
    v_mul_f32_e64 v235, v235, v232
    v_accvgpr_write_b32 a22, v235
    v_accvgpr_read_b32 v236, a23
    v_mul_f32_e64 v236, v236, v232
    v_accvgpr_write_b32 a23, v236
    v_accvgpr_read_b32 v233, a24
    v_mul_f32_e64 v233, v233, v232
    v_accvgpr_write_b32 a24, v233
    v_accvgpr_read_b32 v234, a25
    v_mul_f32_e64 v234, v234, v232
    v_accvgpr_write_b32 a25, v234
    v_accvgpr_read_b32 v235, a26
    v_mul_f32_e64 v235, v235, v232
    v_accvgpr_write_b32 a26, v235
    v_accvgpr_read_b32 v236, a27
    v_mul_f32_e64 v236, v236, v232
    v_accvgpr_write_b32 a27, v236
    v_accvgpr_read_b32 v233, a28
    v_mul_f32_e64 v233, v233, v232
    v_accvgpr_write_b32 a28, v233
    v_accvgpr_read_b32 v234, a29
    v_mul_f32_e64 v234, v234, v232
    v_accvgpr_write_b32 a29, v234
    v_accvgpr_read_b32 v235, a30
    v_mul_f32_e64 v235, v235, v232
    v_accvgpr_write_b32 a30, v235
    v_accvgpr_read_b32 v236, a31
    v_mul_f32_e64 v236, v236, v232
    v_accvgpr_write_b32 a31, v236
    v_exp_f32 v128, v32
    v_exp_f32 v129, v33
    v_exp_f32 v130, v34
    v_exp_f32 v131, v35
    v_exp_f32 v132, v36
    v_exp_f32 v133, v37
    v_exp_f32 v134, v38
    v_exp_f32_e64 v135, v39
    s_nop 0
    v_cvt_pk_bf16_f32 v112, v128, v129
    v_cvt_pk_bf16_f32 v113, v130, v131
    v_cvt_pk_bf16_f32 v114, v132, v133
    v_cvt_pk_bf16_f32 v115, v134, v135
    v_max3_f32 v230, v40, v41, v42
    v_max3_f32 v230, v230, v43, v44
    v_max3_f32 v230, v230, v45, v46
    v_max_f32 v230, v230, v47
    v_mov_b32 v231, v230
    s_nop 1
    v_permlane16_swap_b32 v230, v231
    s_nop 0
    v_max_f32 v230, v230, v231
    v_mov_b32 v231, v230
    s_nop 1
    v_permlane32_swap_b32 v230, v231
    s_nop 0
    v_max_f32_e64 v230, v230, v231
    v_add_f32 v230, 0x41800000, v230
    v_max_f32 v230, 0, v230
    v_sub_f32 v232, 0, v230
    v_exp_f32 v232, v232
    v_sub_f32 v225, v225, v230
    v_sub_f32 v72, v72, v230
    v_sub_f32 v8, v8, v230
    v_sub_f32 v40, v40, v230
    v_sub_f32 v73, v73, v230
    v_sub_f32 v9, v9, v230
    v_sub_f32 v41, v41, v230
    v_sub_f32 v74, v74, v230
    v_sub_f32 v10, v10, v230
    v_sub_f32 v42, v42, v230
    v_sub_f32 v75, v75, v230
    v_sub_f32 v11, v11, v230
    v_sub_f32 v43, v43, v230
    v_sub_f32 v76, v76, v230
    v_sub_f32 v12, v12, v230
    v_sub_f32 v44, v44, v230
    v_sub_f32 v77, v77, v230
    v_sub_f32 v13, v13, v230
    v_sub_f32 v45, v45, v230
    v_sub_f32 v78, v78, v230
    v_sub_f32 v14, v14, v230
    v_sub_f32 v46, v46, v230
    v_sub_f32 v79, v79, v230
    v_sub_f32 v15, v15, v230
    v_sub_f32 v47, v47, v230
    v_mul_f32 v148, v148, v232
    v_mul_f32 v149, v149, v232
    v_mul_f32 v150, v150, v232
    v_mul_f32 v151, v151, v232
    v_accvgpr_read_b32 v233, a32
    v_mul_f32_e64 v233, v233, v232
    v_accvgpr_write_b32 a32, v233
    v_accvgpr_read_b32 v234, a33
    v_mul_f32_e64 v234, v234, v232
    v_accvgpr_write_b32 a33, v234
    v_accvgpr_read_b32 v235, a34
    v_mul_f32_e64 v235, v235, v232
    v_accvgpr_write_b32 a34, v235
    v_accvgpr_read_b32 v236, a35
    v_mul_f32_e64 v236, v236, v232
    v_accvgpr_write_b32 a35, v236
    v_accvgpr_read_b32 v233, a36
    v_mul_f32_e64 v233, v233, v232
    v_accvgpr_write_b32 a36, v233
    v_accvgpr_read_b32 v234, a37
    v_mul_f32_e64 v234, v234, v232
    v_accvgpr_write_b32 a37, v234
    v_accvgpr_read_b32 v235, a38
    v_mul_f32_e64 v235, v235, v232
    v_accvgpr_write_b32 a38, v235
    v_accvgpr_read_b32 v236, a39
    v_mul_f32_e64 v236, v236, v232
    v_accvgpr_write_b32 a39, v236
    v_accvgpr_read_b32 v233, a40
    v_mul_f32_e64 v233, v233, v232
    v_accvgpr_write_b32 a40, v233
    v_accvgpr_read_b32 v234, a41
    v_mul_f32_e64 v234, v234, v232
    v_accvgpr_write_b32 a41, v234
    v_accvgpr_read_b32 v235, a42
    v_mul_f32_e64 v235, v235, v232
    v_accvgpr_write_b32 a42, v235
    v_accvgpr_read_b32 v236, a43
    v_mul_f32_e64 v236, v236, v232
    v_accvgpr_write_b32 a43, v236
    v_accvgpr_read_b32 v233, a44
    v_mul_f32_e64 v233, v233, v232
    v_accvgpr_write_b32 a44, v233
    v_accvgpr_read_b32 v234, a45
    v_mul_f32_e64 v234, v234, v232
    v_accvgpr_write_b32 a45, v234
    v_accvgpr_read_b32 v235, a46
    v_mul_f32_e64 v235, v235, v232
    v_accvgpr_write_b32 a46, v235
    v_accvgpr_read_b32 v236, a47
    v_mul_f32_e64 v236, v236, v232
    v_accvgpr_write_b32 a47, v236
    v_accvgpr_read_b32 v233, a48
    v_mul_f32_e64 v233, v233, v232
    v_accvgpr_write_b32 a48, v233
    v_accvgpr_read_b32 v234, a49
    v_mul_f32_e64 v234, v234, v232
    v_accvgpr_write_b32 a49, v234
    v_accvgpr_read_b32 v235, a50
    v_mul_f32_e64 v235, v235, v232
    v_accvgpr_write_b32 a50, v235
    v_accvgpr_read_b32 v236, a51
    v_mul_f32_e64 v236, v236, v232
    v_accvgpr_write_b32 a51, v236
    v_accvgpr_read_b32 v233, a52
    v_mul_f32_e64 v233, v233, v232
    v_accvgpr_write_b32 a52, v233
    v_accvgpr_read_b32 v234, a53
    v_mul_f32_e64 v234, v234, v232
    v_accvgpr_write_b32 a53, v234
    v_accvgpr_read_b32 v235, a54
    v_mul_f32_e64 v235, v235, v232
    v_accvgpr_write_b32 a54, v235
    v_accvgpr_read_b32 v236, a55
    v_mul_f32_e64 v236, v236, v232
    v_accvgpr_write_b32 a55, v236
    v_accvgpr_read_b32 v233, a56
    v_mul_f32_e64 v233, v233, v232
    v_accvgpr_write_b32 a56, v233
    v_accvgpr_read_b32 v234, a57
    v_mul_f32_e64 v234, v234, v232
    v_accvgpr_write_b32 a57, v234
    v_accvgpr_read_b32 v235, a58
    v_mul_f32_e64 v235, v235, v232
    v_accvgpr_write_b32 a58, v235
    v_accvgpr_read_b32 v236, a59
    v_mul_f32_e64 v236, v236, v232
    v_accvgpr_write_b32 a59, v236
    v_accvgpr_read_b32 v233, a60
    v_mul_f32_e64 v233, v233, v232
    v_accvgpr_write_b32 a60, v233
    v_accvgpr_read_b32 v234, a61
    v_mul_f32_e64 v234, v234, v232
    v_accvgpr_write_b32 a61, v234
    v_accvgpr_read_b32 v235, a62
    v_mul_f32_e64 v235, v235, v232
    v_accvgpr_write_b32 a62, v235
    v_accvgpr_read_b32 v236, a63
    v_mul_f32_e64 v236, v236, v232
    v_accvgpr_write_b32 a63, v236
    v_exp_f32 v128, v40
    v_exp_f32 v129, v41
    v_exp_f32 v130, v42
    v_exp_f32 v131, v43
    v_exp_f32 v132, v44
    v_exp_f32 v133, v45
    v_exp_f32 v134, v46
    v_exp_f32_e64 v135, v47
    s_nop 0
    v_cvt_pk_bf16_f32 v116, v128, v129
    v_cvt_pk_bf16_f32 v117, v130, v131
    v_cvt_pk_bf16_f32 v118, v132, v133
    v_cvt_pk_bf16_f32 v119, v134, v135
    v_max3_f32 v230, v48, v49, v50
    v_max3_f32 v230, v230, v51, v52
    v_max3_f32 v230, v230, v53, v54
    v_max_f32 v230, v230, v55
    v_mov_b32 v231, v230
    s_nop 1
    v_permlane16_swap_b32 v230, v231
    s_nop 0
    v_max_f32 v230, v230, v231
    v_mov_b32 v231, v230
    s_nop 1
    v_permlane32_swap_b32 v230, v231
    s_nop 0
    v_max_f32_e64 v230, v230, v231
    v_add_f32 v230, 0x41800000, v230
    v_max_f32 v230, 0, v230
    v_sub_f32 v232, 0, v230
    v_exp_f32 v232, v232
    v_sub_f32 v226, v226, v230
    v_sub_f32 v80, v80, v230
    v_sub_f32 v16, v16, v230
    v_sub_f32 v48, v48, v230
    v_sub_f32 v81, v81, v230
    v_sub_f32 v17, v17, v230
    v_sub_f32 v49, v49, v230
    v_sub_f32 v82, v82, v230
    v_sub_f32 v18, v18, v230
    v_sub_f32 v50, v50, v230
    v_sub_f32 v83, v83, v230
    v_sub_f32 v19, v19, v230
    v_sub_f32 v51, v51, v230
    v_sub_f32 v84, v84, v230
    v_sub_f32 v20, v20, v230
    v_sub_f32 v52, v52, v230
    v_sub_f32 v85, v85, v230
    v_sub_f32 v21, v21, v230
    v_sub_f32 v53, v53, v230
    v_sub_f32 v86, v86, v230
    v_sub_f32 v22, v22, v230
    v_sub_f32 v54, v54, v230
    v_sub_f32 v87, v87, v230
    v_sub_f32 v23, v23, v230
    v_sub_f32 v55, v55, v230
    v_mul_f32 v152, v152, v232
    v_mul_f32 v153, v153, v232
    v_mul_f32 v154, v154, v232
    v_mul_f32 v155, v155, v232
    v_accvgpr_read_b32 v233, a64
    v_mul_f32_e64 v233, v233, v232
    v_accvgpr_write_b32 a64, v233
    v_accvgpr_read_b32 v234, a65
    v_mul_f32_e64 v234, v234, v232
    v_accvgpr_write_b32 a65, v234
    v_accvgpr_read_b32 v235, a66
    v_mul_f32_e64 v235, v235, v232
    v_accvgpr_write_b32 a66, v235
    v_accvgpr_read_b32 v236, a67
    v_mul_f32_e64 v236, v236, v232
    v_accvgpr_write_b32 a67, v236
    v_accvgpr_read_b32 v233, a68
    v_mul_f32_e64 v233, v233, v232
    v_accvgpr_write_b32 a68, v233
    v_accvgpr_read_b32 v234, a69
    v_mul_f32_e64 v234, v234, v232
    v_accvgpr_write_b32 a69, v234
    v_accvgpr_read_b32 v235, a70
    v_mul_f32_e64 v235, v235, v232
    v_accvgpr_write_b32 a70, v235
    v_accvgpr_read_b32 v236, a71
    v_mul_f32_e64 v236, v236, v232
    v_accvgpr_write_b32 a71, v236
    v_accvgpr_read_b32 v233, a72
    v_mul_f32_e64 v233, v233, v232
    v_accvgpr_write_b32 a72, v233
    v_accvgpr_read_b32 v234, a73
    v_mul_f32_e64 v234, v234, v232
    v_accvgpr_write_b32 a73, v234
    v_accvgpr_read_b32 v235, a74
    v_mul_f32_e64 v235, v235, v232
    v_accvgpr_write_b32 a74, v235
    v_accvgpr_read_b32 v236, a75
    v_mul_f32_e64 v236, v236, v232
    v_accvgpr_write_b32 a75, v236
    v_accvgpr_read_b32 v233, a76
    v_mul_f32_e64 v233, v233, v232
    v_accvgpr_write_b32 a76, v233
    v_accvgpr_read_b32 v234, a77
    v_mul_f32_e64 v234, v234, v232
    v_accvgpr_write_b32 a77, v234
    v_accvgpr_read_b32 v235, a78
    v_mul_f32_e64 v235, v235, v232
    v_accvgpr_write_b32 a78, v235
    v_accvgpr_read_b32 v236, a79
    v_mul_f32_e64 v236, v236, v232
    v_accvgpr_write_b32 a79, v236
    v_accvgpr_read_b32 v233, a80
    v_mul_f32_e64 v233, v233, v232
    v_accvgpr_write_b32 a80, v233
    v_accvgpr_read_b32 v234, a81
    v_mul_f32_e64 v234, v234, v232
    v_accvgpr_write_b32 a81, v234
    v_accvgpr_read_b32 v235, a82
    v_mul_f32_e64 v235, v235, v232
    v_accvgpr_write_b32 a82, v235
    v_accvgpr_read_b32 v236, a83
    v_mul_f32_e64 v236, v236, v232
    v_accvgpr_write_b32 a83, v236
    v_accvgpr_read_b32 v233, a84
    v_mul_f32_e64 v233, v233, v232
    v_accvgpr_write_b32 a84, v233
    v_accvgpr_read_b32 v234, a85
    v_mul_f32_e64 v234, v234, v232
    v_accvgpr_write_b32 a85, v234
    v_accvgpr_read_b32 v235, a86
    v_mul_f32_e64 v235, v235, v232
    v_accvgpr_write_b32 a86, v235
    v_accvgpr_read_b32 v236, a87
    v_mul_f32_e64 v236, v236, v232
    v_accvgpr_write_b32 a87, v236
    v_accvgpr_read_b32 v233, a88
    v_mul_f32_e64 v233, v233, v232
    v_accvgpr_write_b32 a88, v233
    v_accvgpr_read_b32 v234, a89
    v_mul_f32_e64 v234, v234, v232
    v_accvgpr_write_b32 a89, v234
    v_accvgpr_read_b32 v235, a90
    v_mul_f32_e64 v235, v235, v232
    v_accvgpr_write_b32 a90, v235
    v_accvgpr_read_b32 v236, a91
    v_mul_f32_e64 v236, v236, v232
    v_accvgpr_write_b32 a91, v236
    v_accvgpr_read_b32 v233, a92
    v_mul_f32_e64 v233, v233, v232
    v_accvgpr_write_b32 a92, v233
    v_accvgpr_read_b32 v234, a93
    v_mul_f32_e64 v234, v234, v232
    v_accvgpr_write_b32 a93, v234
    v_accvgpr_read_b32 v235, a94
    v_mul_f32_e64 v235, v235, v232
    v_accvgpr_write_b32 a94, v235
    v_accvgpr_read_b32 v236, a95
    v_mul_f32_e64 v236, v236, v232
    v_accvgpr_write_b32 a95, v236
    v_exp_f32 v128, v48
    v_exp_f32 v129, v49
    v_exp_f32 v130, v50
    v_exp_f32 v131, v51
    v_exp_f32 v132, v52
    v_exp_f32 v133, v53
    v_exp_f32 v134, v54
    v_exp_f32_e64 v135, v55
    s_nop 0
    v_cvt_pk_bf16_f32 v120, v128, v129
    v_cvt_pk_bf16_f32 v121, v130, v131
    v_cvt_pk_bf16_f32 v122, v132, v133
    v_cvt_pk_bf16_f32 v123, v134, v135
    v_max3_f32 v230, v56, v57, v58
    v_max3_f32 v230, v230, v59, v60
    v_max3_f32 v230, v230, v61, v62
    v_max_f32 v230, v230, v63
    v_mov_b32 v231, v230
    s_nop 1
    v_permlane16_swap_b32 v230, v231
    s_nop 0
    v_max_f32 v230, v230, v231
    v_mov_b32 v231, v230
    s_nop 1
    v_permlane32_swap_b32 v230, v231
    s_nop 0
    v_max_f32_e64 v230, v230, v231
    v_add_f32 v230, 0x41800000, v230
    v_max_f32 v230, 0, v230
    v_sub_f32 v232, 0, v230
    v_exp_f32 v232, v232
    v_sub_f32 v227, v227, v230
    v_sub_f32 v88, v88, v230
    v_sub_f32 v24, v24, v230
    v_sub_f32 v56, v56, v230
    v_sub_f32 v89, v89, v230
    v_sub_f32 v25, v25, v230
    v_sub_f32 v57, v57, v230
    v_sub_f32 v90, v90, v230
    v_sub_f32 v26, v26, v230
    v_sub_f32 v58, v58, v230
    v_sub_f32 v91, v91, v230
    v_sub_f32 v27, v27, v230
    v_sub_f32 v59, v59, v230
    v_sub_f32 v92, v92, v230
    v_sub_f32 v28, v28, v230
    v_sub_f32 v60, v60, v230
    v_sub_f32 v93, v93, v230
    v_sub_f32 v29, v29, v230
    v_sub_f32 v61, v61, v230
    v_sub_f32 v94, v94, v230
    v_sub_f32 v30, v30, v230
    v_sub_f32 v62, v62, v230
    v_sub_f32 v95, v95, v230
    v_sub_f32 v31, v31, v230
    v_sub_f32 v63, v63, v230
    v_mul_f32 v156, v156, v232
    v_mul_f32 v157, v157, v232
    v_mul_f32 v158, v158, v232
    v_mul_f32 v159, v159, v232
    v_accvgpr_read_b32 v233, a96
    v_mul_f32_e64 v233, v233, v232
    v_accvgpr_write_b32 a96, v233
    v_accvgpr_read_b32 v234, a97
    v_mul_f32_e64 v234, v234, v232
    v_accvgpr_write_b32 a97, v234
    v_accvgpr_read_b32 v235, a98
    v_mul_f32_e64 v235, v235, v232
    v_accvgpr_write_b32 a98, v235
    v_accvgpr_read_b32 v236, a99
    v_mul_f32_e64 v236, v236, v232
    v_accvgpr_write_b32 a99, v236
    v_accvgpr_read_b32 v233, a100
    v_mul_f32_e64 v233, v233, v232
    v_accvgpr_write_b32 a100, v233
    v_accvgpr_read_b32 v234, a101
    v_mul_f32_e64 v234, v234, v232
    v_accvgpr_write_b32 a101, v234
    v_accvgpr_read_b32 v235, a102
    v_mul_f32_e64 v235, v235, v232
    v_accvgpr_write_b32 a102, v235
    v_accvgpr_read_b32 v236, a103
    v_mul_f32_e64 v236, v236, v232
    v_accvgpr_write_b32 a103, v236
    v_accvgpr_read_b32 v233, a104
    v_mul_f32_e64 v233, v233, v232
    v_accvgpr_write_b32 a104, v233
    v_accvgpr_read_b32 v234, a105
    v_mul_f32_e64 v234, v234, v232
    v_accvgpr_write_b32 a105, v234
    v_accvgpr_read_b32 v235, a106
    v_mul_f32_e64 v235, v235, v232
    v_accvgpr_write_b32 a106, v235
    v_accvgpr_read_b32 v236, a107
    v_mul_f32_e64 v236, v236, v232
    v_accvgpr_write_b32 a107, v236
    v_accvgpr_read_b32 v233, a108
    v_mul_f32_e64 v233, v233, v232
    v_accvgpr_write_b32 a108, v233
    v_accvgpr_read_b32 v234, a109
    v_mul_f32_e64 v234, v234, v232
    v_accvgpr_write_b32 a109, v234
    v_accvgpr_read_b32 v235, a110
    v_mul_f32_e64 v235, v235, v232
    v_accvgpr_write_b32 a110, v235
    v_accvgpr_read_b32 v236, a111
    v_mul_f32_e64 v236, v236, v232
    v_accvgpr_write_b32 a111, v236
    v_accvgpr_read_b32 v233, a112
    v_mul_f32_e64 v233, v233, v232
    v_accvgpr_write_b32 a112, v233
    v_accvgpr_read_b32 v234, a113
    v_mul_f32_e64 v234, v234, v232
    v_accvgpr_write_b32 a113, v234
    v_accvgpr_read_b32 v235, a114
    v_mul_f32_e64 v235, v235, v232
    v_accvgpr_write_b32 a114, v235
    v_accvgpr_read_b32 v236, a115
    v_mul_f32_e64 v236, v236, v232
    v_accvgpr_write_b32 a115, v236
    v_accvgpr_read_b32 v233, a116
    v_mul_f32_e64 v233, v233, v232
    v_accvgpr_write_b32 a116, v233
    v_accvgpr_read_b32 v234, a117
    v_mul_f32_e64 v234, v234, v232
    v_accvgpr_write_b32 a117, v234
    v_accvgpr_read_b32 v235, a118
    v_mul_f32_e64 v235, v235, v232
    v_accvgpr_write_b32 a118, v235
    v_accvgpr_read_b32 v236, a119
    v_mul_f32_e64 v236, v236, v232
    v_accvgpr_write_b32 a119, v236
    v_accvgpr_read_b32 v233, a120
    v_mul_f32_e64 v233, v233, v232
    v_accvgpr_write_b32 a120, v233
    v_accvgpr_read_b32 v234, a121
    v_mul_f32_e64 v234, v234, v232
    v_accvgpr_write_b32 a121, v234
    v_accvgpr_read_b32 v235, a122
    v_mul_f32_e64 v235, v235, v232
    v_accvgpr_write_b32 a122, v235
    v_accvgpr_read_b32 v236, a123
    v_mul_f32_e64 v236, v236, v232
    v_accvgpr_write_b32 a123, v236
    v_accvgpr_read_b32 v233, a124
    v_mul_f32_e64 v233, v233, v232
    v_accvgpr_write_b32 a124, v233
    v_accvgpr_read_b32 v234, a125
    v_mul_f32_e64 v234, v234, v232
    v_accvgpr_write_b32 a125, v234
    v_accvgpr_read_b32 v235, a126
    v_mul_f32_e64 v235, v235, v232
    v_accvgpr_write_b32 a126, v235
    v_accvgpr_read_b32 v236, a127
    v_mul_f32_e64 v236, v236, v232
    v_accvgpr_write_b32 a127, v236
    v_exp_f32 v128, v56
    v_exp_f32 v129, v57
    v_exp_f32 v130, v58
    v_exp_f32 v131, v59
    v_exp_f32 v132, v60
    v_exp_f32 v133, v61
    v_exp_f32 v134, v62
    v_exp_f32_e64 v135, v63
    s_nop 0
    v_cvt_pk_bf16_f32 v124, v128, v129
    v_cvt_pk_bf16_f32 v125, v130, v131
    v_cvt_pk_bf16_f32 v126, v132, v133
    v_cvt_pk_bf16_f32 v127, v134, v135
    s_nop 1
    s_branch kf_rr13
kf_rare18:
    s_nop 15
    v_max3_f32 v230, v16, v17, v18
    v_max3_f32 v230, v230, v19, v20
    v_max3_f32 v230, v230, v21, v22
    v_max_f32 v230, v230, v23
    v_mov_b32 v231, v230
    s_nop 1
    v_permlane16_swap_b32 v230, v231
    s_nop 0
    v_max_f32 v230, v230, v231
    v_mov_b32 v231, v230
    s_nop 1
    v_permlane32_swap_b32 v230, v231
    s_nop 0
    v_max_f32 v230, v230, v231
    v_add_f32 v230, 0x41800000, v230
    v_max_f32 v230, 0, v230
    v_sub_f32 v232, 0, v230
    v_exp_f32 v232, v232
    v_sub_f32 v226, v226, v230
    v_sub_f32 v80, v80, v230
    v_sub_f32 v48, v48, v230
    v_sub_f32 v16, v16, v230
    v_sub_f32 v81, v81, v230
    v_sub_f32 v49, v49, v230
    v_sub_f32 v17, v17, v230
    v_sub_f32 v82, v82, v230
    v_sub_f32 v50, v50, v230
    v_sub_f32 v18, v18, v230
    v_sub_f32 v83, v83, v230
    v_sub_f32 v51, v51, v230
    v_sub_f32 v19, v19, v230
    v_sub_f32 v84, v84, v230
    v_sub_f32 v52, v52, v230
    v_sub_f32 v20, v20, v230
    v_sub_f32 v85, v85, v230
    v_sub_f32 v53, v53, v230
    v_sub_f32 v21, v21, v230
    v_sub_f32 v86, v86, v230
    v_sub_f32 v54, v54, v230
    v_sub_f32 v22, v22, v230
    v_sub_f32 v87, v87, v230
    v_sub_f32 v55, v55, v230
    v_sub_f32 v23, v23, v230
    v_mul_f32 v152, v152, v232
    v_mul_f32 v153, v153, v232
    v_mul_f32 v154, v154, v232
    v_mul_f32 v155, v155, v232
    v_accvgpr_read_b32 v233, a64
    v_mul_f32_e64 v233, v233, v232
    v_accvgpr_write_b32 a64, v233
    v_accvgpr_read_b32 v234, a65
    v_mul_f32_e64 v234, v234, v232
    v_accvgpr_write_b32 a65, v234
    v_accvgpr_read_b32 v235, a66
    v_mul_f32_e64 v235, v235, v232
    v_accvgpr_write_b32 a66, v235
    v_accvgpr_read_b32 v236, a67
    v_mul_f32_e64 v236, v236, v232
    v_accvgpr_write_b32 a67, v236
    v_accvgpr_read_b32 v233, a68
    v_mul_f32_e64 v233, v233, v232
    v_accvgpr_write_b32 a68, v233
    v_accvgpr_read_b32 v234, a69
    v_mul_f32_e64 v234, v234, v232
    v_accvgpr_write_b32 a69, v234
    v_accvgpr_read_b32 v235, a70
    v_mul_f32_e64 v235, v235, v232
    v_accvgpr_write_b32 a70, v235
    v_accvgpr_read_b32 v236, a71
    v_mul_f32_e64 v236, v236, v232
    v_accvgpr_write_b32 a71, v236
    v_accvgpr_read_b32 v233, a72
    v_mul_f32_e64 v233, v233, v232
    v_accvgpr_write_b32 a72, v233
    v_accvgpr_read_b32 v234, a73
    v_mul_f32_e64 v234, v234, v232
    v_accvgpr_write_b32 a73, v234
    v_accvgpr_read_b32 v235, a74
    v_mul_f32_e64 v235, v235, v232
    v_accvgpr_write_b32 a74, v235
    v_accvgpr_read_b32 v236, a75
    v_mul_f32_e64 v236, v236, v232
    v_accvgpr_write_b32 a75, v236
    v_accvgpr_read_b32 v233, a76
    v_mul_f32_e64 v233, v233, v232
    v_accvgpr_write_b32 a76, v233
    v_accvgpr_read_b32 v234, a77
    v_mul_f32_e64 v234, v234, v232
    v_accvgpr_write_b32 a77, v234
    v_accvgpr_read_b32 v235, a78
    v_mul_f32_e64 v235, v235, v232
    v_accvgpr_write_b32 a78, v235
    v_accvgpr_read_b32 v236, a79
    v_mul_f32_e64 v236, v236, v232
    v_accvgpr_write_b32 a79, v236
    v_accvgpr_read_b32 v233, a80
    v_mul_f32_e64 v233, v233, v232
    v_accvgpr_write_b32 a80, v233
    v_accvgpr_read_b32 v234, a81
    v_mul_f32_e64 v234, v234, v232
    v_accvgpr_write_b32 a81, v234
    v_accvgpr_read_b32 v235, a82
    v_mul_f32_e64 v235, v235, v232
    v_accvgpr_write_b32 a82, v235
    v_accvgpr_read_b32 v236, a83
    v_mul_f32_e64 v236, v236, v232
    v_accvgpr_write_b32 a83, v236
    v_accvgpr_read_b32 v233, a84
    v_mul_f32_e64 v233, v233, v232
    v_accvgpr_write_b32 a84, v233
    v_accvgpr_read_b32 v234, a85
    v_mul_f32_e64 v234, v234, v232
    v_accvgpr_write_b32 a85, v234
    v_accvgpr_read_b32 v235, a86
    v_mul_f32_e64 v235, v235, v232
    v_accvgpr_write_b32 a86, v235
    v_accvgpr_read_b32 v236, a87
    v_mul_f32_e64 v236, v236, v232
    v_accvgpr_write_b32 a87, v236
    v_accvgpr_read_b32 v233, a88
    v_mul_f32_e64 v233, v233, v232
    v_accvgpr_write_b32 a88, v233
    v_accvgpr_read_b32 v234, a89
    v_mul_f32_e64 v234, v234, v232
    v_accvgpr_write_b32 a89, v234
    v_accvgpr_read_b32 v235, a90
    v_mul_f32_e64 v235, v235, v232
    v_accvgpr_write_b32 a90, v235
    v_accvgpr_read_b32 v236, a91
    v_mul_f32_e64 v236, v236, v232
    v_accvgpr_write_b32 a91, v236
    v_accvgpr_read_b32 v233, a92
    v_mul_f32_e64 v233, v233, v232
    v_accvgpr_write_b32 a92, v233
    v_accvgpr_read_b32 v234, a93
    v_mul_f32_e64 v234, v234, v232
    v_accvgpr_write_b32 a93, v234
    v_accvgpr_read_b32 v235, a94
    v_mul_f32_e64 v235, v235, v232
    v_accvgpr_write_b32 a94, v235
    v_accvgpr_read_b32 v236, a95
    v_mul_f32_e64 v236, v236, v232
    v_accvgpr_write_b32 a95, v236
    v_exp_f32 v128, v16
    v_exp_f32 v129, v17
    v_exp_f32 v130, v18
    v_exp_f32 v131, v19
    v_exp_f32 v132, v20
    v_exp_f32 v133, v21
    v_exp_f32 v134, v22
    v_exp_f32_e64 v135, v23
    s_nop 0
    v_cvt_pk_bf16_f32 v104, v128, v129
    v_cvt_pk_bf16_f32 v105, v130, v131
    v_cvt_pk_bf16_f32 v106, v132, v133
    v_cvt_pk_bf16_f32 v107, v134, v135
    v_max3_f32 v230, v24, v25, v26
    v_max3_f32 v230, v230, v27, v28
    v_max3_f32 v230, v230, v29, v30
    v_max_f32 v230, v230, v31
    v_mov_b32 v231, v230
    s_nop 1
    v_permlane16_swap_b32 v230, v231
    s_nop 0
    v_max_f32 v230, v230, v231
    v_mov_b32 v231, v230
    s_nop 1
    v_permlane32_swap_b32 v230, v231
    s_nop 0
    v_max_f32_e64 v230, v230, v231
    v_add_f32 v230, 0x41800000, v230
    v_max_f32 v230, 0, v230
    v_sub_f32 v232, 0, v230
    v_exp_f32 v232, v232
    v_sub_f32 v227, v227, v230
    v_sub_f32 v88, v88, v230
    v_sub_f32 v56, v56, v230
    v_sub_f32 v24, v24, v230
    v_sub_f32 v89, v89, v230
    v_sub_f32 v57, v57, v230
    v_sub_f32 v25, v25, v230
    v_sub_f32 v90, v90, v230
    v_sub_f32 v58, v58, v230
    v_sub_f32 v26, v26, v230
    v_sub_f32 v91, v91, v230
    v_sub_f32 v59, v59, v230
    v_sub_f32 v27, v27, v230
    v_sub_f32 v92, v92, v230
    v_sub_f32 v60, v60, v230
    v_sub_f32 v28, v28, v230
    v_sub_f32 v93, v93, v230
    v_sub_f32 v61, v61, v230
    v_sub_f32 v29, v29, v230
    v_sub_f32 v94, v94, v230
    v_sub_f32 v62, v62, v230
    v_sub_f32 v30, v30, v230
    v_sub_f32 v95, v95, v230
    v_sub_f32 v63, v63, v230
    v_sub_f32 v31, v31, v230
    v_mul_f32 v156, v156, v232
    v_mul_f32 v157, v157, v232
    v_mul_f32 v158, v158, v232
    v_mul_f32 v159, v159, v232
    v_accvgpr_read_b32 v233, a96
    v_mul_f32_e64 v233, v233, v232
    v_accvgpr_write_b32 a96, v233
    v_accvgpr_read_b32 v234, a97
    v_mul_f32_e64 v234, v234, v232
    v_accvgpr_write_b32 a97, v234
    v_accvgpr_read_b32 v235, a98
    v_mul_f32_e64 v235, v235, v232
    v_accvgpr_write_b32 a98, v235
    v_accvgpr_read_b32 v236, a99
    v_mul_f32_e64 v236, v236, v232
    v_accvgpr_write_b32 a99, v236
    v_accvgpr_read_b32 v233, a100
    v_mul_f32_e64 v233, v233, v232
    v_accvgpr_write_b32 a100, v233
    v_accvgpr_read_b32 v234, a101
    v_mul_f32_e64 v234, v234, v232
    v_accvgpr_write_b32 a101, v234
    v_accvgpr_read_b32 v235, a102
    v_mul_f32_e64 v235, v235, v232
    v_accvgpr_write_b32 a102, v235
    v_accvgpr_read_b32 v236, a103
    v_mul_f32_e64 v236, v236, v232
    v_accvgpr_write_b32 a103, v236
    v_accvgpr_read_b32 v233, a104
    v_mul_f32_e64 v233, v233, v232
    v_accvgpr_write_b32 a104, v233
    v_accvgpr_read_b32 v234, a105
    v_mul_f32_e64 v234, v234, v232
    v_accvgpr_write_b32 a105, v234
    v_accvgpr_read_b32 v235, a106
    v_mul_f32_e64 v235, v235, v232
    v_accvgpr_write_b32 a106, v235
    v_accvgpr_read_b32 v236, a107
    v_mul_f32_e64 v236, v236, v232
    v_accvgpr_write_b32 a107, v236
    v_accvgpr_read_b32 v233, a108
    v_mul_f32_e64 v233, v233, v232
    v_accvgpr_write_b32 a108, v233
    v_accvgpr_read_b32 v234, a109
    v_mul_f32_e64 v234, v234, v232
    v_accvgpr_write_b32 a109, v234
    v_accvgpr_read_b32 v235, a110
    v_mul_f32_e64 v235, v235, v232
    v_accvgpr_write_b32 a110, v235
    v_accvgpr_read_b32 v236, a111
    v_mul_f32_e64 v236, v236, v232
    v_accvgpr_write_b32 a111, v236
    v_accvgpr_read_b32 v233, a112
    v_mul_f32_e64 v233, v233, v232
    v_accvgpr_write_b32 a112, v233
    v_accvgpr_read_b32 v234, a113
    v_mul_f32_e64 v234, v234, v232
    v_accvgpr_write_b32 a113, v234
    v_accvgpr_read_b32 v235, a114
    v_mul_f32_e64 v235, v235, v232
    v_accvgpr_write_b32 a114, v235
    v_accvgpr_read_b32 v236, a115
    v_mul_f32_e64 v236, v236, v232
    v_accvgpr_write_b32 a115, v236
    v_accvgpr_read_b32 v233, a116
    v_mul_f32_e64 v233, v233, v232
    v_accvgpr_write_b32 a116, v233
    v_accvgpr_read_b32 v234, a117
    v_mul_f32_e64 v234, v234, v232
    v_accvgpr_write_b32 a117, v234
    v_accvgpr_read_b32 v235, a118
    v_mul_f32_e64 v235, v235, v232
    v_accvgpr_write_b32 a118, v235
    v_accvgpr_read_b32 v236, a119
    v_mul_f32_e64 v236, v236, v232
    v_accvgpr_write_b32 a119, v236
    v_accvgpr_read_b32 v233, a120
    v_mul_f32_e64 v233, v233, v232
    v_accvgpr_write_b32 a120, v233
    v_accvgpr_read_b32 v234, a121
    v_mul_f32_e64 v234, v234, v232
    v_accvgpr_write_b32 a121, v234
    v_accvgpr_read_b32 v235, a122
    v_mul_f32_e64 v235, v235, v232
    v_accvgpr_write_b32 a122, v235
    v_accvgpr_read_b32 v236, a123
    v_mul_f32_e64 v236, v236, v232
    v_accvgpr_write_b32 a123, v236
    v_accvgpr_read_b32 v233, a124
    v_mul_f32_e64 v233, v233, v232
    v_accvgpr_write_b32 a124, v233
    v_accvgpr_read_b32 v234, a125
    v_mul_f32_e64 v234, v234, v232
    v_accvgpr_write_b32 a125, v234
    v_accvgpr_read_b32 v235, a126
    v_mul_f32_e64 v235, v235, v232
    v_accvgpr_write_b32 a126, v235
    v_accvgpr_read_b32 v236, a127
    v_mul_f32_e64 v236, v236, v232
    v_accvgpr_write_b32 a127, v236
    v_exp_f32 v128, v24
    v_exp_f32 v129, v25
    v_exp_f32 v130, v26
    v_exp_f32 v131, v27
    v_exp_f32 v132, v28
    v_exp_f32 v133, v29
    v_exp_f32 v134, v30
    v_exp_f32_e64 v135, v31
    s_nop 0
    v_cvt_pk_bf16_f32 v108, v128, v129
    v_cvt_pk_bf16_f32 v109, v130, v131
    v_cvt_pk_bf16_f32 v110, v132, v133
    v_cvt_pk_bf16_f32 v111, v134, v135
    s_nop 1
    s_branch kf_rr17
kf_rare22:
    s_nop 15
    v_max3_f32 v230, v48, v49, v50
    v_max3_f32 v230, v230, v51, v52
    v_max3_f32 v230, v230, v53, v54
    v_max_f32 v230, v230, v55
    v_mov_b32 v231, v230
    s_nop 1
    v_permlane16_swap_b32 v230, v231
    s_nop 0
    v_max_f32 v230, v230, v231
    v_mov_b32 v231, v230
    s_nop 1
    v_permlane32_swap_b32 v230, v231
    s_nop 0
    v_max_f32 v230, v230, v231
    v_add_f32 v230, 0x41800000, v230
    v_max_f32 v230, 0, v230
    v_sub_f32 v232, 0, v230
    v_exp_f32 v232, v232
    v_sub_f32 v226, v226, v230
    v_sub_f32 v80, v80, v230
    v_sub_f32 v16, v16, v230
    v_sub_f32 v48, v48, v230
    v_sub_f32 v81, v81, v230
    v_sub_f32 v17, v17, v230
    v_sub_f32 v49, v49, v230
    v_sub_f32 v82, v82, v230
    v_sub_f32 v18, v18, v230
    v_sub_f32 v50, v50, v230
    v_sub_f32 v83, v83, v230
    v_sub_f32 v19, v19, v230
    v_sub_f32 v51, v51, v230
    v_sub_f32 v84, v84, v230
    v_sub_f32 v20, v20, v230
    v_sub_f32 v52, v52, v230
    v_sub_f32 v85, v85, v230
    v_sub_f32 v21, v21, v230
    v_sub_f32 v53, v53, v230
    v_sub_f32 v86, v86, v230
    v_sub_f32 v22, v22, v230
    v_sub_f32 v54, v54, v230
    v_sub_f32 v87, v87, v230
    v_sub_f32 v23, v23, v230
    v_sub_f32 v55, v55, v230
    v_mul_f32 v152, v152, v232
    v_mul_f32 v153, v153, v232
    v_mul_f32 v154, v154, v232
    v_mul_f32 v155, v155, v232
    v_accvgpr_read_b32 v233, a64
    v_mul_f32_e64 v233, v233, v232
    v_accvgpr_write_b32 a64, v233
    v_accvgpr_read_b32 v234, a65
    v_mul_f32_e64 v234, v234, v232
    v_accvgpr_write_b32 a65, v234
    v_accvgpr_read_b32 v235, a66
    v_mul_f32_e64 v235, v235, v232
    v_accvgpr_write_b32 a66, v235
    v_accvgpr_read_b32 v236, a67
    v_mul_f32_e64 v236, v236, v232
    v_accvgpr_write_b32 a67, v236
    v_accvgpr_read_b32 v233, a68
    v_mul_f32_e64 v233, v233, v232
    v_accvgpr_write_b32 a68, v233
    v_accvgpr_read_b32 v234, a69
    v_mul_f32_e64 v234, v234, v232
    v_accvgpr_write_b32 a69, v234
    v_accvgpr_read_b32 v235, a70
    v_mul_f32_e64 v235, v235, v232
    v_accvgpr_write_b32 a70, v235
    v_accvgpr_read_b32 v236, a71
    v_mul_f32_e64 v236, v236, v232
    v_accvgpr_write_b32 a71, v236
    v_accvgpr_read_b32 v233, a72
    v_mul_f32_e64 v233, v233, v232
    v_accvgpr_write_b32 a72, v233
    v_accvgpr_read_b32 v234, a73
    v_mul_f32_e64 v234, v234, v232
    v_accvgpr_write_b32 a73, v234
    v_accvgpr_read_b32 v235, a74
    v_mul_f32_e64 v235, v235, v232
    v_accvgpr_write_b32 a74, v235
    v_accvgpr_read_b32 v236, a75
    v_mul_f32_e64 v236, v236, v232
    v_accvgpr_write_b32 a75, v236
    v_accvgpr_read_b32 v233, a76
    v_mul_f32_e64 v233, v233, v232
    v_accvgpr_write_b32 a76, v233
    v_accvgpr_read_b32 v234, a77
    v_mul_f32_e64 v234, v234, v232
    v_accvgpr_write_b32 a77, v234
    v_accvgpr_read_b32 v235, a78
    v_mul_f32_e64 v235, v235, v232
    v_accvgpr_write_b32 a78, v235
    v_accvgpr_read_b32 v236, a79
    v_mul_f32_e64 v236, v236, v232
    v_accvgpr_write_b32 a79, v236
    v_accvgpr_read_b32 v233, a80
    v_mul_f32_e64 v233, v233, v232
    v_accvgpr_write_b32 a80, v233
    v_accvgpr_read_b32 v234, a81
    v_mul_f32_e64 v234, v234, v232
    v_accvgpr_write_b32 a81, v234
    v_accvgpr_read_b32 v235, a82
    v_mul_f32_e64 v235, v235, v232
    v_accvgpr_write_b32 a82, v235
    v_accvgpr_read_b32 v236, a83
    v_mul_f32_e64 v236, v236, v232
    v_accvgpr_write_b32 a83, v236
    v_accvgpr_read_b32 v233, a84
    v_mul_f32_e64 v233, v233, v232
    v_accvgpr_write_b32 a84, v233
    v_accvgpr_read_b32 v234, a85
    v_mul_f32_e64 v234, v234, v232
    v_accvgpr_write_b32 a85, v234
    v_accvgpr_read_b32 v235, a86
    v_mul_f32_e64 v235, v235, v232
    v_accvgpr_write_b32 a86, v235
    v_accvgpr_read_b32 v236, a87
    v_mul_f32_e64 v236, v236, v232
    v_accvgpr_write_b32 a87, v236
    v_accvgpr_read_b32 v233, a88
    v_mul_f32_e64 v233, v233, v232
    v_accvgpr_write_b32 a88, v233
    v_accvgpr_read_b32 v234, a89
    v_mul_f32_e64 v234, v234, v232
    v_accvgpr_write_b32 a89, v234
    v_accvgpr_read_b32 v235, a90
    v_mul_f32_e64 v235, v235, v232
    v_accvgpr_write_b32 a90, v235
    v_accvgpr_read_b32 v236, a91
    v_mul_f32_e64 v236, v236, v232
    v_accvgpr_write_b32 a91, v236
    v_accvgpr_read_b32 v233, a92
    v_mul_f32_e64 v233, v233, v232
    v_accvgpr_write_b32 a92, v233
    v_accvgpr_read_b32 v234, a93
    v_mul_f32_e64 v234, v234, v232
    v_accvgpr_write_b32 a93, v234
    v_accvgpr_read_b32 v235, a94
    v_mul_f32_e64 v235, v235, v232
    v_accvgpr_write_b32 a94, v235
    v_accvgpr_read_b32 v236, a95
    v_mul_f32_e64 v236, v236, v232
    v_accvgpr_write_b32 a95, v236
    v_exp_f32 v128, v48
    v_exp_f32 v129, v49
    v_exp_f32 v130, v50
    v_exp_f32 v131, v51
    v_exp_f32 v132, v52
    v_exp_f32 v133, v53
    v_exp_f32 v134, v54
    v_exp_f32_e64 v135, v55
    s_nop 0
    v_cvt_pk_bf16_f32 v120, v128, v129
    v_cvt_pk_bf16_f32 v121, v130, v131
    v_cvt_pk_bf16_f32 v122, v132, v133
    v_cvt_pk_bf16_f32 v123, v134, v135
    v_max3_f32 v230, v56, v57, v58
    v_max3_f32 v230, v230, v59, v60
    v_max3_f32 v230, v230, v61, v62
    v_max_f32 v230, v230, v63
    v_mov_b32 v231, v230
    s_nop 1
    v_permlane16_swap_b32 v230, v231
    s_nop 0
    v_max_f32 v230, v230, v231
    v_mov_b32 v231, v230
    s_nop 1
    v_permlane32_swap_b32 v230, v231
    s_nop 0
    v_max_f32_e64 v230, v230, v231
    v_add_f32 v230, 0x41800000, v230
    v_max_f32 v230, 0, v230
    v_sub_f32 v232, 0, v230
    v_exp_f32 v232, v232
    v_sub_f32 v227, v227, v230
    v_sub_f32 v88, v88, v230
    v_sub_f32 v24, v24, v230
    v_sub_f32 v56, v56, v230
    v_sub_f32 v89, v89, v230
    v_sub_f32 v25, v25, v230
    v_sub_f32 v57, v57, v230
    v_sub_f32 v90, v90, v230
    v_sub_f32 v26, v26, v230
    v_sub_f32 v58, v58, v230
    v_sub_f32 v91, v91, v230
    v_sub_f32 v27, v27, v230
    v_sub_f32 v59, v59, v230
    v_sub_f32 v92, v92, v230
    v_sub_f32 v28, v28, v230
    v_sub_f32 v60, v60, v230
    v_sub_f32 v93, v93, v230
    v_sub_f32 v29, v29, v230
    v_sub_f32 v61, v61, v230
    v_sub_f32 v94, v94, v230
    v_sub_f32 v30, v30, v230
    v_sub_f32 v62, v62, v230
    v_sub_f32 v95, v95, v230
    v_sub_f32 v31, v31, v230
    v_sub_f32 v63, v63, v230
    v_mul_f32 v156, v156, v232
    v_mul_f32 v157, v157, v232
    v_mul_f32 v158, v158, v232
    v_mul_f32 v159, v159, v232
    v_accvgpr_read_b32 v233, a96
    v_mul_f32_e64 v233, v233, v232
    v_accvgpr_write_b32 a96, v233
    v_accvgpr_read_b32 v234, a97
    v_mul_f32_e64 v234, v234, v232
    v_accvgpr_write_b32 a97, v234
    v_accvgpr_read_b32 v235, a98
    v_mul_f32_e64 v235, v235, v232
    v_accvgpr_write_b32 a98, v235
    v_accvgpr_read_b32 v236, a99
    v_mul_f32_e64 v236, v236, v232
    v_accvgpr_write_b32 a99, v236
    v_accvgpr_read_b32 v233, a100
    v_mul_f32_e64 v233, v233, v232
    v_accvgpr_write_b32 a100, v233
    v_accvgpr_read_b32 v234, a101
    v_mul_f32_e64 v234, v234, v232
    v_accvgpr_write_b32 a101, v234
    v_accvgpr_read_b32 v235, a102
    v_mul_f32_e64 v235, v235, v232
    v_accvgpr_write_b32 a102, v235
    v_accvgpr_read_b32 v236, a103
    v_mul_f32_e64 v236, v236, v232
    v_accvgpr_write_b32 a103, v236
    v_accvgpr_read_b32 v233, a104
    v_mul_f32_e64 v233, v233, v232
    v_accvgpr_write_b32 a104, v233
    v_accvgpr_read_b32 v234, a105
    v_mul_f32_e64 v234, v234, v232
    v_accvgpr_write_b32 a105, v234
    v_accvgpr_read_b32 v235, a106
    v_mul_f32_e64 v235, v235, v232
    v_accvgpr_write_b32 a106, v235
    v_accvgpr_read_b32 v236, a107
    v_mul_f32_e64 v236, v236, v232
    v_accvgpr_write_b32 a107, v236
    v_accvgpr_read_b32 v233, a108
    v_mul_f32_e64 v233, v233, v232
    v_accvgpr_write_b32 a108, v233
    v_accvgpr_read_b32 v234, a109
    v_mul_f32_e64 v234, v234, v232
    v_accvgpr_write_b32 a109, v234
    v_accvgpr_read_b32 v235, a110
    v_mul_f32_e64 v235, v235, v232
    v_accvgpr_write_b32 a110, v235
    v_accvgpr_read_b32 v236, a111
    v_mul_f32_e64 v236, v236, v232
    v_accvgpr_write_b32 a111, v236
    v_accvgpr_read_b32 v233, a112
    v_mul_f32_e64 v233, v233, v232
    v_accvgpr_write_b32 a112, v233
    v_accvgpr_read_b32 v234, a113
    v_mul_f32_e64 v234, v234, v232
    v_accvgpr_write_b32 a113, v234
    v_accvgpr_read_b32 v235, a114
    v_mul_f32_e64 v235, v235, v232
    v_accvgpr_write_b32 a114, v235
    v_accvgpr_read_b32 v236, a115
    v_mul_f32_e64 v236, v236, v232
    v_accvgpr_write_b32 a115, v236
    v_accvgpr_read_b32 v233, a116
    v_mul_f32_e64 v233, v233, v232
    v_accvgpr_write_b32 a116, v233
    v_accvgpr_read_b32 v234, a117
    v_mul_f32_e64 v234, v234, v232
    v_accvgpr_write_b32 a117, v234
    v_accvgpr_read_b32 v235, a118
    v_mul_f32_e64 v235, v235, v232
    v_accvgpr_write_b32 a118, v235
    v_accvgpr_read_b32 v236, a119
    v_mul_f32_e64 v236, v236, v232
    v_accvgpr_write_b32 a119, v236
    v_accvgpr_read_b32 v233, a120
    v_mul_f32_e64 v233, v233, v232
    v_accvgpr_write_b32 a120, v233
    v_accvgpr_read_b32 v234, a121
    v_mul_f32_e64 v234, v234, v232
    v_accvgpr_write_b32 a121, v234
    v_accvgpr_read_b32 v235, a122
    v_mul_f32_e64 v235, v235, v232
    v_accvgpr_write_b32 a122, v235
    v_accvgpr_read_b32 v236, a123
    v_mul_f32_e64 v236, v236, v232
    v_accvgpr_write_b32 a123, v236
    v_accvgpr_read_b32 v233, a124
    v_mul_f32_e64 v233, v233, v232
    v_accvgpr_write_b32 a124, v233
    v_accvgpr_read_b32 v234, a125
    v_mul_f32_e64 v234, v234, v232
    v_accvgpr_write_b32 a125, v234
    v_accvgpr_read_b32 v235, a126
    v_mul_f32_e64 v235, v235, v232
    v_accvgpr_write_b32 a126, v235
    v_accvgpr_read_b32 v236, a127
    v_mul_f32_e64 v236, v236, v232
    v_accvgpr_write_b32 a127, v236
    v_exp_f32 v128, v56
    v_exp_f32 v129, v57
    v_exp_f32 v130, v58
    v_exp_f32 v131, v59
    v_exp_f32 v132, v60
    v_exp_f32 v133, v61
    v_exp_f32 v134, v62
    v_exp_f32_e64 v135, v63
    s_nop 0
    v_cvt_pk_bf16_f32 v124, v128, v129
    v_cvt_pk_bf16_f32 v125, v130, v131
    v_cvt_pk_bf16_f32 v126, v132, v133
    v_cvt_pk_bf16_f32 v127, v134, v135
    s_nop 1
    s_branch kf_rr21
kf_rare26:
    s_nop 15
    v_max3_f32 v230, v16, v17, v18
    v_max3_f32 v230, v230, v19, v20
    v_max3_f32 v230, v230, v21, v22
    v_max_f32 v230, v230, v23
    v_mov_b32 v231, v230
    s_nop 1
    v_permlane16_swap_b32 v230, v231
    s_nop 0
    v_max_f32 v230, v230, v231
    v_mov_b32 v231, v230
    s_nop 1
    v_permlane32_swap_b32 v230, v231
    s_nop 0
    v_max_f32 v230, v230, v231
    v_add_f32 v230, 0x41800000, v230
    v_max_f32 v230, 0, v230
    v_sub_f32 v232, 0, v230
    v_exp_f32 v232, v232
    v_sub_f32 v226, v226, v230
    v_sub_f32 v80, v80, v230
    v_sub_f32 v48, v48, v230
    v_sub_f32 v16, v16, v230
    v_sub_f32 v81, v81, v230
    v_sub_f32 v49, v49, v230
    v_sub_f32 v17, v17, v230
    v_sub_f32 v82, v82, v230
    v_sub_f32 v50, v50, v230
    v_sub_f32 v18, v18, v230
    v_sub_f32 v83, v83, v230
    v_sub_f32 v51, v51, v230
    v_sub_f32 v19, v19, v230
    v_sub_f32 v84, v84, v230
    v_sub_f32 v52, v52, v230
    v_sub_f32 v20, v20, v230
    v_sub_f32 v85, v85, v230
    v_sub_f32 v53, v53, v230
    v_sub_f32 v21, v21, v230
    v_sub_f32 v86, v86, v230
    v_sub_f32 v54, v54, v230
    v_sub_f32 v22, v22, v230
    v_sub_f32 v87, v87, v230
    v_sub_f32 v55, v55, v230
    v_sub_f32 v23, v23, v230
    v_mul_f32 v152, v152, v232
    v_mul_f32 v153, v153, v232
    v_mul_f32 v154, v154, v232
    v_mul_f32 v155, v155, v232
    v_accvgpr_read_b32 v233, a64
    v_mul_f32_e64 v233, v233, v232
    v_accvgpr_write_b32 a64, v233
    v_accvgpr_read_b32 v234, a65
    v_mul_f32_e64 v234, v234, v232
    v_accvgpr_write_b32 a65, v234
    v_accvgpr_read_b32 v235, a66
    v_mul_f32_e64 v235, v235, v232
    v_accvgpr_write_b32 a66, v235
    v_accvgpr_read_b32 v236, a67
    v_mul_f32_e64 v236, v236, v232
    v_accvgpr_write_b32 a67, v236
    v_accvgpr_read_b32 v233, a68
    v_mul_f32_e64 v233, v233, v232
    v_accvgpr_write_b32 a68, v233
    v_accvgpr_read_b32 v234, a69
    v_mul_f32_e64 v234, v234, v232
    v_accvgpr_write_b32 a69, v234
    v_accvgpr_read_b32 v235, a70
    v_mul_f32_e64 v235, v235, v232
    v_accvgpr_write_b32 a70, v235
    v_accvgpr_read_b32 v236, a71
    v_mul_f32_e64 v236, v236, v232
    v_accvgpr_write_b32 a71, v236
    v_accvgpr_read_b32 v233, a72
    v_mul_f32_e64 v233, v233, v232
    v_accvgpr_write_b32 a72, v233
    v_accvgpr_read_b32 v234, a73
    v_mul_f32_e64 v234, v234, v232
    v_accvgpr_write_b32 a73, v234
    v_accvgpr_read_b32 v235, a74
    v_mul_f32_e64 v235, v235, v232
    v_accvgpr_write_b32 a74, v235
    v_accvgpr_read_b32 v236, a75
    v_mul_f32_e64 v236, v236, v232
    v_accvgpr_write_b32 a75, v236
    v_accvgpr_read_b32 v233, a76
    v_mul_f32_e64 v233, v233, v232
    v_accvgpr_write_b32 a76, v233
    v_accvgpr_read_b32 v234, a77
    v_mul_f32_e64 v234, v234, v232
    v_accvgpr_write_b32 a77, v234
    v_accvgpr_read_b32 v235, a78
    v_mul_f32_e64 v235, v235, v232
    v_accvgpr_write_b32 a78, v235
    v_accvgpr_read_b32 v236, a79
    v_mul_f32_e64 v236, v236, v232
    v_accvgpr_write_b32 a79, v236
    v_accvgpr_read_b32 v233, a80
    v_mul_f32_e64 v233, v233, v232
    v_accvgpr_write_b32 a80, v233
    v_accvgpr_read_b32 v234, a81
    v_mul_f32_e64 v234, v234, v232
    v_accvgpr_write_b32 a81, v234
    v_accvgpr_read_b32 v235, a82
    v_mul_f32_e64 v235, v235, v232
    v_accvgpr_write_b32 a82, v235
    v_accvgpr_read_b32 v236, a83
    v_mul_f32_e64 v236, v236, v232
    v_accvgpr_write_b32 a83, v236
    v_accvgpr_read_b32 v233, a84
    v_mul_f32_e64 v233, v233, v232
    v_accvgpr_write_b32 a84, v233
    v_accvgpr_read_b32 v234, a85
    v_mul_f32_e64 v234, v234, v232
    v_accvgpr_write_b32 a85, v234
    v_accvgpr_read_b32 v235, a86
    v_mul_f32_e64 v235, v235, v232
    v_accvgpr_write_b32 a86, v235
    v_accvgpr_read_b32 v236, a87
    v_mul_f32_e64 v236, v236, v232
    v_accvgpr_write_b32 a87, v236
    v_accvgpr_read_b32 v233, a88
    v_mul_f32_e64 v233, v233, v232
    v_accvgpr_write_b32 a88, v233
    v_accvgpr_read_b32 v234, a89
    v_mul_f32_e64 v234, v234, v232
    v_accvgpr_write_b32 a89, v234
    v_accvgpr_read_b32 v235, a90
    v_mul_f32_e64 v235, v235, v232
    v_accvgpr_write_b32 a90, v235
    v_accvgpr_read_b32 v236, a91
    v_mul_f32_e64 v236, v236, v232
    v_accvgpr_write_b32 a91, v236
    v_accvgpr_read_b32 v233, a92
    v_mul_f32_e64 v233, v233, v232
    v_accvgpr_write_b32 a92, v233
    v_accvgpr_read_b32 v234, a93
    v_mul_f32_e64 v234, v234, v232
    v_accvgpr_write_b32 a93, v234
    v_accvgpr_read_b32 v235, a94
    v_mul_f32_e64 v235, v235, v232
    v_accvgpr_write_b32 a94, v235
    v_accvgpr_read_b32 v236, a95
    v_mul_f32_e64 v236, v236, v232
    v_accvgpr_write_b32 a95, v236
    v_exp_f32 v128, v16
    v_exp_f32 v129, v17
    v_exp_f32 v130, v18
    v_exp_f32 v131, v19
    v_exp_f32 v132, v20
    v_exp_f32 v133, v21
    v_exp_f32 v134, v22
    v_exp_f32_e64 v135, v23
    s_nop 0
    v_cvt_pk_bf16_f32 v104, v128, v129
    v_cvt_pk_bf16_f32 v105, v130, v131
    v_cvt_pk_bf16_f32 v106, v132, v133
    v_cvt_pk_bf16_f32 v107, v134, v135
    v_max3_f32 v230, v24, v25, v26
    v_max3_f32 v230, v230, v27, v28
    v_max3_f32 v230, v230, v29, v30
    v_max_f32 v230, v230, v31
    v_mov_b32 v231, v230
    s_nop 1
    v_permlane16_swap_b32 v230, v231
    s_nop 0
    v_max_f32 v230, v230, v231
    v_mov_b32 v231, v230
    s_nop 1
    v_permlane32_swap_b32 v230, v231
    s_nop 0
    v_max_f32_e64 v230, v230, v231
    v_add_f32 v230, 0x41800000, v230
    v_max_f32 v230, 0, v230
    v_sub_f32 v232, 0, v230
    v_exp_f32 v232, v232
    v_sub_f32 v227, v227, v230
    v_sub_f32 v88, v88, v230
    v_sub_f32 v56, v56, v230
    v_sub_f32 v24, v24, v230
    v_sub_f32 v89, v89, v230
    v_sub_f32 v57, v57, v230
    v_sub_f32 v25, v25, v230
    v_sub_f32 v90, v90, v230
    v_sub_f32 v58, v58, v230
    v_sub_f32 v26, v26, v230
    v_sub_f32 v91, v91, v230
    v_sub_f32 v59, v59, v230
    v_sub_f32 v27, v27, v230
    v_sub_f32 v92, v92, v230
    v_sub_f32 v60, v60, v230
    v_sub_f32 v28, v28, v230
    v_sub_f32 v93, v93, v230
    v_sub_f32 v61, v61, v230
    v_sub_f32 v29, v29, v230
    v_sub_f32 v94, v94, v230
    v_sub_f32 v62, v62, v230
    v_sub_f32 v30, v30, v230
    v_sub_f32 v95, v95, v230
    v_sub_f32 v63, v63, v230
    v_sub_f32 v31, v31, v230
    v_mul_f32 v156, v156, v232
    v_mul_f32 v157, v157, v232
    v_mul_f32 v158, v158, v232
    v_mul_f32 v159, v159, v232
    v_accvgpr_read_b32 v233, a96
    v_mul_f32_e64 v233, v233, v232
    v_accvgpr_write_b32 a96, v233
    v_accvgpr_read_b32 v234, a97
    v_mul_f32_e64 v234, v234, v232
    v_accvgpr_write_b32 a97, v234
    v_accvgpr_read_b32 v235, a98
    v_mul_f32_e64 v235, v235, v232
    v_accvgpr_write_b32 a98, v235
    v_accvgpr_read_b32 v236, a99
    v_mul_f32_e64 v236, v236, v232
    v_accvgpr_write_b32 a99, v236
    v_accvgpr_read_b32 v233, a100
    v_mul_f32_e64 v233, v233, v232
    v_accvgpr_write_b32 a100, v233
    v_accvgpr_read_b32 v234, a101
    v_mul_f32_e64 v234, v234, v232
    v_accvgpr_write_b32 a101, v234
    v_accvgpr_read_b32 v235, a102
    v_mul_f32_e64 v235, v235, v232
    v_accvgpr_write_b32 a102, v235
    v_accvgpr_read_b32 v236, a103
    v_mul_f32_e64 v236, v236, v232
    v_accvgpr_write_b32 a103, v236
    v_accvgpr_read_b32 v233, a104
    v_mul_f32_e64 v233, v233, v232
    v_accvgpr_write_b32 a104, v233
    v_accvgpr_read_b32 v234, a105
    v_mul_f32_e64 v234, v234, v232
    v_accvgpr_write_b32 a105, v234
    v_accvgpr_read_b32 v235, a106
    v_mul_f32_e64 v235, v235, v232
    v_accvgpr_write_b32 a106, v235
    v_accvgpr_read_b32 v236, a107
    v_mul_f32_e64 v236, v236, v232
    v_accvgpr_write_b32 a107, v236
    v_accvgpr_read_b32 v233, a108
    v_mul_f32_e64 v233, v233, v232
    v_accvgpr_write_b32 a108, v233
    v_accvgpr_read_b32 v234, a109
    v_mul_f32_e64 v234, v234, v232
    v_accvgpr_write_b32 a109, v234
    v_accvgpr_read_b32 v235, a110
    v_mul_f32_e64 v235, v235, v232
    v_accvgpr_write_b32 a110, v235
    v_accvgpr_read_b32 v236, a111
    v_mul_f32_e64 v236, v236, v232
    v_accvgpr_write_b32 a111, v236
    v_accvgpr_read_b32 v233, a112
    v_mul_f32_e64 v233, v233, v232
    v_accvgpr_write_b32 a112, v233
    v_accvgpr_read_b32 v234, a113
    v_mul_f32_e64 v234, v234, v232
    v_accvgpr_write_b32 a113, v234
    v_accvgpr_read_b32 v235, a114
    v_mul_f32_e64 v235, v235, v232
    v_accvgpr_write_b32 a114, v235
    v_accvgpr_read_b32 v236, a115
    v_mul_f32_e64 v236, v236, v232
    v_accvgpr_write_b32 a115, v236
    v_accvgpr_read_b32 v233, a116
    v_mul_f32_e64 v233, v233, v232
    v_accvgpr_write_b32 a116, v233
    v_accvgpr_read_b32 v234, a117
    v_mul_f32_e64 v234, v234, v232
    v_accvgpr_write_b32 a117, v234
    v_accvgpr_read_b32 v235, a118
    v_mul_f32_e64 v235, v235, v232
    v_accvgpr_write_b32 a118, v235
    v_accvgpr_read_b32 v236, a119
    v_mul_f32_e64 v236, v236, v232
    v_accvgpr_write_b32 a119, v236
    v_accvgpr_read_b32 v233, a120
    v_mul_f32_e64 v233, v233, v232
    v_accvgpr_write_b32 a120, v233
    v_accvgpr_read_b32 v234, a121
    v_mul_f32_e64 v234, v234, v232
    v_accvgpr_write_b32 a121, v234
    v_accvgpr_read_b32 v235, a122
    v_mul_f32_e64 v235, v235, v232
    v_accvgpr_write_b32 a122, v235
    v_accvgpr_read_b32 v236, a123
    v_mul_f32_e64 v236, v236, v232
    v_accvgpr_write_b32 a123, v236
    v_accvgpr_read_b32 v233, a124
    v_mul_f32_e64 v233, v233, v232
    v_accvgpr_write_b32 a124, v233
    v_accvgpr_read_b32 v234, a125
    v_mul_f32_e64 v234, v234, v232
    v_accvgpr_write_b32 a125, v234
    v_accvgpr_read_b32 v235, a126
    v_mul_f32_e64 v235, v235, v232
    v_accvgpr_write_b32 a126, v235
    v_accvgpr_read_b32 v236, a127
    v_mul_f32_e64 v236, v236, v232
    v_accvgpr_write_b32 a127, v236
    v_exp_f32 v128, v24
    v_exp_f32 v129, v25
    v_exp_f32 v130, v26
    v_exp_f32 v131, v27
    v_exp_f32 v132, v28
    v_exp_f32 v133, v29
    v_exp_f32 v134, v30
    v_exp_f32_e64 v135, v31
    s_nop 0
    v_cvt_pk_bf16_f32 v108, v128, v129
    v_cvt_pk_bf16_f32 v109, v130, v131
    v_cvt_pk_bf16_f32 v110, v132, v133
    v_cvt_pk_bf16_f32 v111, v134, v135
    s_nop 1
    s_branch kf_rr25
kf_rare30:
    s_nop 15
    v_max3_f32 v230, v48, v49, v50
    v_max3_f32 v230, v230, v51, v52
    v_max3_f32 v230, v230, v53, v54
    v_max_f32 v230, v230, v55
    v_mov_b32 v231, v230
    s_nop 1
    v_permlane16_swap_b32 v230, v231
    s_nop 0
    v_max_f32 v230, v230, v231
    v_mov_b32 v231, v230
    s_nop 1
    v_permlane32_swap_b32 v230, v231
    s_nop 0
    v_max_f32 v230, v230, v231
    v_add_f32 v230, 0x41800000, v230
    v_max_f32 v230, 0, v230
    v_sub_f32 v232, 0, v230
    v_exp_f32 v232, v232
    v_sub_f32 v226, v226, v230
    v_sub_f32 v80, v80, v230
    v_sub_f32 v16, v16, v230
    v_sub_f32 v48, v48, v230
    v_sub_f32 v81, v81, v230
    v_sub_f32 v17, v17, v230
    v_sub_f32 v49, v49, v230
    v_sub_f32 v82, v82, v230
    v_sub_f32 v18, v18, v230
    v_sub_f32 v50, v50, v230
    v_sub_f32 v83, v83, v230
    v_sub_f32 v19, v19, v230
    v_sub_f32 v51, v51, v230
    v_sub_f32 v84, v84, v230
    v_sub_f32 v20, v20, v230
    v_sub_f32 v52, v52, v230
    v_sub_f32 v85, v85, v230
    v_sub_f32 v21, v21, v230
    v_sub_f32 v53, v53, v230
    v_sub_f32 v86, v86, v230
    v_sub_f32 v22, v22, v230
    v_sub_f32 v54, v54, v230
    v_sub_f32 v87, v87, v230
    v_sub_f32 v23, v23, v230
    v_sub_f32 v55, v55, v230
    v_mul_f32 v152, v152, v232
    v_mul_f32 v153, v153, v232
    v_mul_f32 v154, v154, v232
    v_mul_f32 v155, v155, v232
    v_accvgpr_read_b32 v233, a64
    v_mul_f32_e64 v233, v233, v232
    v_accvgpr_write_b32 a64, v233
    v_accvgpr_read_b32 v234, a65
    v_mul_f32_e64 v234, v234, v232
    v_accvgpr_write_b32 a65, v234
    v_accvgpr_read_b32 v235, a66
    v_mul_f32_e64 v235, v235, v232
    v_accvgpr_write_b32 a66, v235
    v_accvgpr_read_b32 v236, a67
    v_mul_f32_e64 v236, v236, v232
    v_accvgpr_write_b32 a67, v236
    v_accvgpr_read_b32 v233, a68
    v_mul_f32_e64 v233, v233, v232
    v_accvgpr_write_b32 a68, v233
    v_accvgpr_read_b32 v234, a69
    v_mul_f32_e64 v234, v234, v232
    v_accvgpr_write_b32 a69, v234
    v_accvgpr_read_b32 v235, a70
    v_mul_f32_e64 v235, v235, v232
    v_accvgpr_write_b32 a70, v235
    v_accvgpr_read_b32 v236, a71
    v_mul_f32_e64 v236, v236, v232
    v_accvgpr_write_b32 a71, v236
    v_accvgpr_read_b32 v233, a72
    v_mul_f32_e64 v233, v233, v232
    v_accvgpr_write_b32 a72, v233
    v_accvgpr_read_b32 v234, a73
    v_mul_f32_e64 v234, v234, v232
    v_accvgpr_write_b32 a73, v234
    v_accvgpr_read_b32 v235, a74
    v_mul_f32_e64 v235, v235, v232
    v_accvgpr_write_b32 a74, v235
    v_accvgpr_read_b32 v236, a75
    v_mul_f32_e64 v236, v236, v232
    v_accvgpr_write_b32 a75, v236
    v_accvgpr_read_b32 v233, a76
    v_mul_f32_e64 v233, v233, v232
    v_accvgpr_write_b32 a76, v233
    v_accvgpr_read_b32 v234, a77
    v_mul_f32_e64 v234, v234, v232
    v_accvgpr_write_b32 a77, v234
    v_accvgpr_read_b32 v235, a78
    v_mul_f32_e64 v235, v235, v232
    v_accvgpr_write_b32 a78, v235
    v_accvgpr_read_b32 v236, a79
    v_mul_f32_e64 v236, v236, v232
    v_accvgpr_write_b32 a79, v236
    v_accvgpr_read_b32 v233, a80
    v_mul_f32_e64 v233, v233, v232
    v_accvgpr_write_b32 a80, v233
    v_accvgpr_read_b32 v234, a81
    v_mul_f32_e64 v234, v234, v232
    v_accvgpr_write_b32 a81, v234
    v_accvgpr_read_b32 v235, a82
    v_mul_f32_e64 v235, v235, v232
    v_accvgpr_write_b32 a82, v235
    v_accvgpr_read_b32 v236, a83
    v_mul_f32_e64 v236, v236, v232
    v_accvgpr_write_b32 a83, v236
    v_accvgpr_read_b32 v233, a84
    v_mul_f32_e64 v233, v233, v232
    v_accvgpr_write_b32 a84, v233
    v_accvgpr_read_b32 v234, a85
    v_mul_f32_e64 v234, v234, v232
    v_accvgpr_write_b32 a85, v234
    v_accvgpr_read_b32 v235, a86
    v_mul_f32_e64 v235, v235, v232
    v_accvgpr_write_b32 a86, v235
    v_accvgpr_read_b32 v236, a87
    v_mul_f32_e64 v236, v236, v232
    v_accvgpr_write_b32 a87, v236
    v_accvgpr_read_b32 v233, a88
    v_mul_f32_e64 v233, v233, v232
    v_accvgpr_write_b32 a88, v233
    v_accvgpr_read_b32 v234, a89
    v_mul_f32_e64 v234, v234, v232
    v_accvgpr_write_b32 a89, v234
    v_accvgpr_read_b32 v235, a90
    v_mul_f32_e64 v235, v235, v232
    v_accvgpr_write_b32 a90, v235
    v_accvgpr_read_b32 v236, a91
    v_mul_f32_e64 v236, v236, v232
    v_accvgpr_write_b32 a91, v236
    v_accvgpr_read_b32 v233, a92
    v_mul_f32_e64 v233, v233, v232
    v_accvgpr_write_b32 a92, v233
    v_accvgpr_read_b32 v234, a93
    v_mul_f32_e64 v234, v234, v232
    v_accvgpr_write_b32 a93, v234
    v_accvgpr_read_b32 v235, a94
    v_mul_f32_e64 v235, v235, v232
    v_accvgpr_write_b32 a94, v235
    v_accvgpr_read_b32 v236, a95
    v_mul_f32_e64 v236, v236, v232
    v_accvgpr_write_b32 a95, v236
    v_exp_f32 v128, v48
    v_exp_f32 v129, v49
    v_exp_f32 v130, v50
    v_exp_f32 v131, v51
    v_exp_f32 v132, v52
    v_exp_f32 v133, v53
    v_exp_f32 v134, v54
    v_exp_f32_e64 v135, v55
    s_nop 0
    v_cvt_pk_bf16_f32 v120, v128, v129
    v_cvt_pk_bf16_f32 v121, v130, v131
    v_cvt_pk_bf16_f32 v122, v132, v133
    v_cvt_pk_bf16_f32 v123, v134, v135
    v_max3_f32 v230, v56, v57, v58
    v_max3_f32 v230, v230, v59, v60
    v_max3_f32 v230, v230, v61, v62
    v_max_f32 v230, v230, v63
    v_mov_b32 v231, v230
    s_nop 1
    v_permlane16_swap_b32 v230, v231
    s_nop 0
    v_max_f32 v230, v230, v231
    v_mov_b32 v231, v230
    s_nop 1
    v_permlane32_swap_b32 v230, v231
    s_nop 0
    v_max_f32_e64 v230, v230, v231
    v_add_f32 v230, 0x41800000, v230
    v_max_f32 v230, 0, v230
    v_sub_f32 v232, 0, v230
    v_exp_f32 v232, v232
    v_sub_f32 v227, v227, v230
    v_sub_f32 v88, v88, v230
    v_sub_f32 v24, v24, v230
    v_sub_f32 v56, v56, v230
    v_sub_f32 v89, v89, v230
    v_sub_f32 v25, v25, v230
    v_sub_f32 v57, v57, v230
    v_sub_f32 v90, v90, v230
    v_sub_f32 v26, v26, v230
    v_sub_f32 v58, v58, v230
    v_sub_f32 v91, v91, v230
    v_sub_f32 v27, v27, v230
    v_sub_f32 v59, v59, v230
    v_sub_f32 v92, v92, v230
    v_sub_f32 v28, v28, v230
    v_sub_f32 v60, v60, v230
    v_sub_f32 v93, v93, v230
    v_sub_f32 v29, v29, v230
    v_sub_f32 v61, v61, v230
    v_sub_f32 v94, v94, v230
    v_sub_f32 v30, v30, v230
    v_sub_f32 v62, v62, v230
    v_sub_f32 v95, v95, v230
    v_sub_f32 v31, v31, v230
    v_sub_f32 v63, v63, v230
    v_mul_f32 v156, v156, v232
    v_mul_f32 v157, v157, v232
    v_mul_f32 v158, v158, v232
    v_mul_f32 v159, v159, v232
    v_accvgpr_read_b32 v233, a96
    v_mul_f32_e64 v233, v233, v232
    v_accvgpr_write_b32 a96, v233
    v_accvgpr_read_b32 v234, a97
    v_mul_f32_e64 v234, v234, v232
    v_accvgpr_write_b32 a97, v234
    v_accvgpr_read_b32 v235, a98
    v_mul_f32_e64 v235, v235, v232
    v_accvgpr_write_b32 a98, v235
    v_accvgpr_read_b32 v236, a99
    v_mul_f32_e64 v236, v236, v232
    v_accvgpr_write_b32 a99, v236
    v_accvgpr_read_b32 v233, a100
    v_mul_f32_e64 v233, v233, v232
    v_accvgpr_write_b32 a100, v233
    v_accvgpr_read_b32 v234, a101
    v_mul_f32_e64 v234, v234, v232
    v_accvgpr_write_b32 a101, v234
    v_accvgpr_read_b32 v235, a102
    v_mul_f32_e64 v235, v235, v232
    v_accvgpr_write_b32 a102, v235
    v_accvgpr_read_b32 v236, a103
    v_mul_f32_e64 v236, v236, v232
    v_accvgpr_write_b32 a103, v236
    v_accvgpr_read_b32 v233, a104
    v_mul_f32_e64 v233, v233, v232
    v_accvgpr_write_b32 a104, v233
    v_accvgpr_read_b32 v234, a105
    v_mul_f32_e64 v234, v234, v232
    v_accvgpr_write_b32 a105, v234
    v_accvgpr_read_b32 v235, a106
    v_mul_f32_e64 v235, v235, v232
    v_accvgpr_write_b32 a106, v235
    v_accvgpr_read_b32 v236, a107
    v_mul_f32_e64 v236, v236, v232
    v_accvgpr_write_b32 a107, v236
    v_accvgpr_read_b32 v233, a108
    v_mul_f32_e64 v233, v233, v232
    v_accvgpr_write_b32 a108, v233
    v_accvgpr_read_b32 v234, a109
    v_mul_f32_e64 v234, v234, v232
    v_accvgpr_write_b32 a109, v234
    v_accvgpr_read_b32 v235, a110
    v_mul_f32_e64 v235, v235, v232
    v_accvgpr_write_b32 a110, v235
    v_accvgpr_read_b32 v236, a111
    v_mul_f32_e64 v236, v236, v232
    v_accvgpr_write_b32 a111, v236
    v_accvgpr_read_b32 v233, a112
    v_mul_f32_e64 v233, v233, v232
    v_accvgpr_write_b32 a112, v233
    v_accvgpr_read_b32 v234, a113
    v_mul_f32_e64 v234, v234, v232
    v_accvgpr_write_b32 a113, v234
    v_accvgpr_read_b32 v235, a114
    v_mul_f32_e64 v235, v235, v232
    v_accvgpr_write_b32 a114, v235
    v_accvgpr_read_b32 v236, a115
    v_mul_f32_e64 v236, v236, v232
    v_accvgpr_write_b32 a115, v236
    v_accvgpr_read_b32 v233, a116
    v_mul_f32_e64 v233, v233, v232
    v_accvgpr_write_b32 a116, v233
    v_accvgpr_read_b32 v234, a117
    v_mul_f32_e64 v234, v234, v232
    v_accvgpr_write_b32 a117, v234
    v_accvgpr_read_b32 v235, a118
    v_mul_f32_e64 v235, v235, v232
    v_accvgpr_write_b32 a118, v235
    v_accvgpr_read_b32 v236, a119
    v_mul_f32_e64 v236, v236, v232
    v_accvgpr_write_b32 a119, v236
    v_accvgpr_read_b32 v233, a120
    v_mul_f32_e64 v233, v233, v232
    v_accvgpr_write_b32 a120, v233
    v_accvgpr_read_b32 v234, a121
    v_mul_f32_e64 v234, v234, v232
    v_accvgpr_write_b32 a121, v234
    v_accvgpr_read_b32 v235, a122
    v_mul_f32_e64 v235, v235, v232
    v_accvgpr_write_b32 a122, v235
    v_accvgpr_read_b32 v236, a123
    v_mul_f32_e64 v236, v236, v232
    v_accvgpr_write_b32 a123, v236
    v_accvgpr_read_b32 v233, a124
    v_mul_f32_e64 v233, v233, v232
    v_accvgpr_write_b32 a124, v233
    v_accvgpr_read_b32 v234, a125
    v_mul_f32_e64 v234, v234, v232
    v_accvgpr_write_b32 a125, v234
    v_accvgpr_read_b32 v235, a126
    v_mul_f32_e64 v235, v235, v232
    v_accvgpr_write_b32 a126, v235
    v_accvgpr_read_b32 v236, a127
    v_mul_f32_e64 v236, v236, v232
    v_accvgpr_write_b32 a127, v236
    v_exp_f32 v128, v56
    v_exp_f32 v129, v57
    v_exp_f32 v130, v58
    v_exp_f32 v131, v59
    v_exp_f32 v132, v60
    v_exp_f32 v133, v61
    v_exp_f32 v134, v62
    v_exp_f32_e64 v135, v63
    s_nop 0
    v_cvt_pk_bf16_f32 v124, v128, v129
    v_cvt_pk_bf16_f32 v125, v130, v131
    v_cvt_pk_bf16_f32 v126, v132, v133
    v_cvt_pk_bf16_f32 v127, v134, v135
    s_nop 1
    s_branch kf_rr29
kf_spin31:
    s_mov_b32 s25, 0x400000
kf_spin31_l:
    s_sleep 2
    buffer_load_dword v254, off, s[88:91], s97 sc1
    s_waitcnt vmcnt(0)
    v_readfirstlane_b32 s24, v254
    s_sub_u32 s25, s25, 1
    s_cbranch_scc1 kf_spinr32
    s_cmp_ge_u32 s24, 1
    s_cbranch_scc0 kf_spin31_l
    s_branch kf_spinr32
kf_spin33:
    s_mov_b32 s25, 0x400000
kf_spin33_l:
    s_sleep 2
    buffer_load_dword v254, off, s[88:91], s39 sc1
    s_waitcnt vmcnt(0)
    v_readfirstlane_b32 s24, v254
    s_sub_u32 s25, s25, 1
    s_cbranch_scc1 kf_spinr34
    s_cmp_ge_u32 s24, 32
    s_cbranch_scc0 kf_spin33_l
    s_branch kf_spinr34
kf_spin35:
    s_mov_b32 s25, 0x400000
kf_spin35_l:
    s_sleep 2
    buffer_load_dword v254, off, s[88:91], s97 sc1
    s_waitcnt vmcnt(0)
    v_readfirstlane_b32 s24, v254
    s_sub_u32 s25, s25, 1
    s_cbranch_scc1 kf_spinr36
    s_cmp_ge_u32 s24, 1
    s_cbranch_scc0 kf_spin35_l
    s_branch kf_spinr36
kf_spin37:
    s_mov_b32 s25, 0x400000
kf_spin37_l:
    s_sleep 2
    buffer_load_dword v254, off, s[88:91], s39 sc1
    s_waitcnt vmcnt(0)
    v_readfirstlane_b32 s24, v254
    s_sub_u32 s25, s25, 1
    s_cbranch_scc1 kf_spinr38
    s_cmp_ge_u32 s24, 32
    s_cbranch_scc0 kf_spin37_l
    s_branch kf_spinr38
kf_spin39:
    s_mov_b32 s25, 0x400000
kf_spin39_l:
    s_sleep 2
    buffer_load_dword v254, off, s[88:91], s35 sc1
    s_waitcnt vmcnt(0)
    v_readfirstlane_b32 s24, v254
    s_sub_u32 s25, s25, 1
    s_cbranch_scc1 kf_spinr40
    s_cmp_ge_u32 s24, 8
    s_cbranch_scc0 kf_spin39_l
    s_branch kf_spinr40

code_end:
.section .rodata,"a"
.p2align 6
.amdhsa_kernel sequential_preLN__compressed_kv_cla__moe_arch_mod__prompt_kernel
  .amdhsa_next_free_vgpr 512
  .amdhsa_next_free_sgpr 102
  .amdhsa_accum_offset 256
  .amdhsa_group_segment_fixed_size 0
  .amdhsa_kernarg_size 112
  .amdhsa_user_sgpr_count 2
  .amdhsa_user_sgpr_kernarg_segment_ptr 1
  .amdhsa_system_sgpr_workgroup_id_x 1
  .amdhsa_float_denorm_mode_32 3
.end_amdhsa_kernel
```

```asm
; @launch grid=(256,1,1) block=(256,1,1) lds=163840
.amdgcn_target "amdgcn-amd-amdhsa--gfx950"
.text
.globl sequential_preLN__compressed_kv_cla__moe_arch_mod__prompt_kernel
.p2align 8
.type sequential_preLN__compressed_kv_cla__moe_arch_mod__prompt_kernel,@function
sequential_preLN__compressed_kv_cla__moe_arch_mod__prompt_kernel:
    s_cmp_ge_u32 s2, 256
    s_cbranch_scc1 ka_done
    s_load_dwordx8 s[64:71], s[0:1], 0
    s_load_dwordx4 s[72:75], s[0:1], 32
    s_load_dwordx4 s[76:79], s[0:1], 64
    s_load_dwordx8 s[8:15], s[0:1], 80
    v_lshrrev_b32 v1, 6, v0
    v_and_b32 v2, 63, v0
    v_readfirstlane_b32 s3, v1
    v_mov_b32_e64 v253, v0
    s_and_b32 s4, s2, 7
    s_lshl_b32 s4, s4, 2
    s_lshr_b32 s24, s2, 3
    s_and_b32 s24, s24, 3
    s_add_u32 s4, s4, s24
    s_lshr_b32 s5, s2, 5
    s_lshl2_add_u32 s6, s5, s3
    s_getpc_b64 s[56:57]
ka_pc:
    s_mov_b32 s58, code_end-ka_pc
    s_mov_b32 s59, 0x00020000
    s_lshr_b32 s24, s2, 3
    s_xor_b32 s24, s24, 31
    s_lshl2_add_u32 s24, s24, s3
    s_lshl_b32 s24, s24, 13
    v_lshlrev_b32_e64 v3, 7, v2
    buffer_load_dword v252, v3, s[56:59], s24 offen
    v_mov_b32 v192, v2
    v_lshrrev_b32 v198, 3, v192
    v_and_b32 v199, 7, v192
    s_lshr_b32 s24, s3, 1
    s_lshl_b32 s24, s24, 5
    s_and_b32 s25, s3, 1
    s_lshl_b32 s26, s25, 3
    s_add_u32 s24, s24, s26
    v_add_u32 v194, s24, v198
    v_lshlrev_b32 v194, 10, v194
    v_lshrrev_b32 v195, 1, v198
    v_xor_b32 v195, v199, v195
    v_lshl_add_u32 v232, v195, 4, v194
    v_xor_b32_e64 v195, 4, v195
    v_lshl_add_u32 v233, v195, 4, v194
    v_add_u32 v233, 15360, v233
    s_lshl_b32 s24, s4, 8
    s_lshl_b32 s26, s25, 7
    s_add_u32 s24, s24, s26
    v_lshlrev_b32 v194, 13, v198
    v_add_u32_e64 v194, s24, v194
    v_bfe_u32 v195, v198, 1, 1
    v_xor_b32_e64 v195, v199, v195
    v_lshl_add_u32 v234, v195, 4, v194
    v_xor_b32_e64 v195, 4, v195
    v_lshl_add_u32 v235, v195, 4, v194
    v_add_u32 v235, 64512, v235
    s_lshl_b32 s34, s3, 11
    s_mul_i32 s35, s3, 24576
    s_add_u32 s35, s35, 65536
    s_lshl_b32 s32, s5, 18
    s_and_b32 s7, s4, 3
    s_lshl1_add_u32 s7, s7, s5
    s_add_u32 s80, s7, 0
    s_and_b32 s80, s80, 7
    s_lshl_b32 s80, s80, 7
    s_add_u32 s80, s80, s32
    s_waitcnt lgkmcnt(0)
    s_cmp_lt_u32 s3, 2
    s_cselect_b32 s48, s70, s72
    s_cselect_b32 s49, s71, s73
    s_mov_b32 s50, 0x400000
    s_mov_b32 s51, 0x00020000
    s_mov_b32 s44, s66
    s_mov_b32 s45, s67
    s_mov_b32 s46, 0x200000
    s_mov_b32 s47, 0x00020000
    s_add_u32 m0, s35, 0
    s_and_b32 s33, s80, 1023
    s_lshl_b32 s33, s33, 12
    buffer_load_dwordx4 v234, s[48:51], s33 offen lds
    buffer_load_dwordx4 v235, s[48:51], s33 offen offset:1024 lds
    s_add_u32 m0, s35, 2048
    s_add_u32 s33, s33, 131072
    buffer_load_dwordx4 v234, s[48:51], s33 offen lds
    buffer_load_dwordx4 v235, s[48:51], s33 offen offset:1024 lds
    s_add_u32 m0, s34, 0
    s_add_u32 s37, s80, 0
    buffer_load_dwordx4 v232, s[44:47], s37 offen lds
    buffer_load_dwordx4 v233, s[44:47], s37 offen offset:1024 lds
    s_add_u32 m0, s34, 8192
    s_add_u32 s37, s80, 65536
    buffer_load_dwordx4 v232, s[44:47], s37 offen lds
    buffer_load_dwordx4 v233, s[44:47], s37 offen offset:1024 lds
    s_add_u32 m0, s35, 4096
    s_add_u32 s33, s33, 131072
    buffer_load_dwordx4 v234, s[48:51], s33 offen lds
    buffer_load_dwordx4 v235, s[48:51], s33 offen offset:1024 lds
    s_add_u32 m0, s35, 6144
    s_add_u32 s33, s33, 131072
    buffer_load_dwordx4 v234, s[48:51], s33 offen lds
    buffer_load_dwordx4 v235, s[48:51], s33 offen offset:1024 lds
    s_mov_b32 s52, s64
    s_mov_b32 s53, s65
    s_mov_b32 s54, 0x400000
    s_mov_b32 s55, 0x00020000
    s_add_u32 s16, s14, 0x5c00000
    s_addc_u32 s17, s15, 0
    s_mov_b32 s18, 0x2140000
    s_mov_b32 s19, 0x00020000
    s_add_u32 s56, s14, 0x3800000
    s_addc_u32 s57, s15, 0
    s_mov_b32 s58, 0x6040
    s_mov_b32 s59, 0x00020000
    s_add_u32 s20, s14, 0x2400000
    s_addc_u32 s21, s15, 0
    s_mov_b32 s22, 0x1000000
    s_mov_b32 s23, 0x00020000
    s_mov_b32 s88, s12
    s_mov_b32 s89, s13
    s_mov_b32 s90, 0x100
    s_mov_b32 s91, 0x00020000
    s_cmp_lt_u32 s3, 2
    s_cselect_b32 s60, s8, s74
    s_cselect_b32 s61, s9, s75
    s_mov_b32 s62, 0x800000
    s_cselect_b32 s62, 0x700000, s62
    s_mov_b32 s63, 0x00020000
    s_cselect_b32 s41, s76, s78
    s_cselect_b32 s42, s77, s79
    s_mov_b32 s8, s14
    s_mov_b32 s9, s15
    s_mov_b32 s10, 0x400000
    s_mov_b32 s11, 0x00020000
    s_mov_b32 s12, s68
    s_mov_b32 s13, s69
    s_mov_b32 s14, 0x800000
    s_mov_b32 s15, 0x00020000
    s_add_u32 s81, s7, 1
    s_and_b32 s81, s81, 7
    s_lshl_b32 s81, s81, 7
    s_add_u32 s81, s81, s32
    s_add_u32 s82, s7, 2
    s_and_b32 s82, s82, 7
    s_lshl_b32 s82, s82, 7
    s_add_u32 s82, s82, s32
    s_add_u32 s83, s7, 3
    s_and_b32 s83, s83, 7
    s_lshl_b32 s83, s83, 7
    s_add_u32 s83, s83, s32
    s_add_u32 s84, s7, 4
    s_and_b32 s84, s84, 7
    s_lshl_b32 s84, s84, 7
    s_add_u32 s84, s84, s32
    s_add_u32 s85, s7, 5
    s_and_b32 s85, s85, 7
    s_lshl_b32 s85, s85, 7
    s_add_u32 s85, s85, s32
    s_add_u32 s86, s7, 6
    s_and_b32 s86, s86, 7
    s_lshl_b32 s86, s86, 7
    s_add_u32 s86, s86, s32
    s_add_u32 s87, s7, 7
    s_and_b32 s87, s87, 7
    s_lshl_b32 s87, s87, 7
    s_add_u32 s87, s87, s32
    s_cmp_eq_u32 s2, 200
    s_mov_b32 s97, 0x40000000
    s_cselect_b32 s97, 0xa0000, s97
    s_mov_b32 s58, 0xa5000
    v_lshlrev_b32 v194, 7, v253
    v_mov_b32_e64 v195, 0
    buffer_store_dword v195, v194, s[56:59], s97 offen sc1
    s_cselect_b32 s97, 0, 0x40000000
    s_mov_b32 s58, 0x6040
    v_and_b32 v200, 15, v192
    v_lshrrev_b32 v201, 4, v192
    v_lshrrev_b32 v194, 1, v200
    v_xor_b32 v194, v201, v194
    v_lshlrev_b32 v194, 4, v194
    v_lshl_add_u32 v224, v200, 7, v194
    v_xor_b32 v225, 64, v224
    v_lshrrev_b32 v194, 2, v200
    v_lshl_add_u32 v195, v201, 3, v194
    v_lshlrev_b32 v195, 7, v195
    v_add_u32 v195, s35, v195
    v_and_b32_e64 v196, 1, v200
    v_lshl_add_u32 v195, v196, 3, v195
    v_lshrrev_b32 v194, 1, v194
    v_and_b32 v196, 1, v201
    v_lshl_or_b32 v194, v196, 2, v194
    v_and_b32 v196, 2, v200
    v_xor_b32 v194, v194, v196
    v_xor_b32_e64 v196, 0, v194
    v_lshl_add_u32 v228, v196, 4, v195
    v_xor_b32_e64 v196, 1, v194
    v_lshl_add_u32 v229, v196, 4, v195
    v_xor_b32_e64 v196, 4, v194
    v_lshl_add_u32 v230, v196, 4, v195
    v_xor_b32_e64 v196, 5, v194
    v_lshl_add_u32 v231, v196, 4, v195
    s_mul_i32 s36, s4, 1089536
    s_mul_i32 s24, s5, 136192
    s_add_u32 s36, s36, s24
    s_and_b32 s24, s3, 1
    s_lshl_b32 s24, s24, 12
    s_and_b32 s26, s3, 2
    s_lshl_b32 s26, s26, 13
    s_add_u32 s36, s36, s24
    s_add_u32 s36, s36, s26
    s_lshl_b32 s24, s5, 7
    s_sub_u32 s26, 1792, s24
    s_cmp_lt_u32 s4, 16
    s_cselect_b32 s24, s24, s26
    s_lshl_b32 s26, s4, 3
    s_add_u32 s24, s24, s26
    v_lshrrev_b32 v194, 5, v253
    v_add_u32 v196, s24, v194
    v_and_b32 v195, 31, v192
    v_lshlrev_b32 v196, 11, v196
    v_lshl_add_u32 v236, v195, 4, v196
    v_xor_b32 v194, v194, v199
    v_lshlrev_b32 v194, 4, v194
    v_lshl_add_u32 v194, v195, 7, v194
    v_add_u32 v237, 81920, v194
    s_lshr_b32 s26, s24, 4
    s_lshl_b32 s26, s26, 15
    s_and_b32 s24, s24, 15
    s_lshl_b32 s24, s24, 4
    s_add_u32 s24, s24, s26
    v_lshrrev_b32 v194, 3, v253
    v_lshlrev_b32 v194, 8, v194
    v_xor_b32 v195, v199, v198
    v_lshl_add_u32 v194, v195, 4, v194
    v_add_u32 v238, s24, v194
    v_lshlrev_b32 v240, 4, v192
    s_lshl_b32 s24, s3, 12
    v_add_u32 v242, s24, v240
    s_lshl_b32 s24, s6, 16
    v_add_u32 v248, s24, v240
    s_sub_u32 s25, 63, s6
    s_lshl_b32 s24, s25, 16
    v_add_u32_e64 v249, s24, v240
    v_bfe_u32 v194, v192, 2, 2
    v_lshlrev_b32_e64 v194, 13, v194
    v_lshl_add_u32 v194, v201, 6, v194
    v_and_b32_e64 v195, 3, v192
    v_lshl_add_u32 v194, v195, 4, v194
    s_lshl_b32 s24, s4, 8
    s_lshl_b32 s25, s3, 18
    s_add_u32 s24, s24, s25
    v_add_u32_e64 v245, s24, v194
    s_lshl_b32 s31, s3, 13
    s_add_u32 s31, s31, 65536
    s_lshl_b32 s27, s5, 20
    s_mov_b32 s7, s27
    s_mov_b32 s43, 0x40000000
    s_lshr_b32 s28, s27, 8
    s_add_u32 s29, s28, 32768
    s_nop 0
    v_lshlrev_b32 v194, 11, v201
    v_bfe_u32 v195, v192, 2, 2
    v_lshl_add_u32 v194, v195, 6, v194
    v_bfe_u32 v195, v192, 4, 1
    v_lshl_add_u32 v194, v195, 4, v194
    v_and_b32_e64 v195, 1, v192
    v_lshl_add_u32 v194, v195, 3, v194
    v_bfe_u32 v195, v192, 1, 1
    v_lshl_add_u32 v247, v195, 5, v194
    s_mov_b32 s30, 65536
    v_add_u32 v246, s30, v247
    v_lshrrev_b32 v195, 5, v192
    v_lshlrev_b32 v195, 4, v195
    v_sub_u32 v194, v200, v195
    v_bfe_u32 v195, v192, 4, 1
    v_lshlrev_b32 v195, 2, v195
    v_sub_u32 v194, v194, v195
    v_cvt_f32_i32 v194, v194
    v_add_f32 v194, 0.5, v194
    v_mul_f32 v243, 0x71800000, v194
    v_add_u32 v244, 0x20000, v240
    v_lshlrev_b32 v251, 7, v192
    v_cmp_gt_u32 vcc, 16, v192
    v_mov_b32 v194, 0x40000000
    v_mov_b32 v255, 1
    v_cndmask_b32 v251, v194, v251, vcc
    v_cmp_eq_u32 vcc, 0, v253
    s_nop 1
    v_cndmask_b32 v250, v194, v253, vcc
    s_add_u32 m0, s35, 8192
    s_and_b32 s33, s81, 1023
    s_lshl_b32 s33, s33, 12
    buffer_load_dwordx4 v234, s[48:51], s33 offen lds
    buffer_load_dwordx4 v235, s[48:51], s33 offen offset:1024 lds
    s_add_u32 m0, s35, 10240
    s_add_u32 s33, s33, 131072
    buffer_load_dwordx4 v234, s[48:51], s33 offen lds
    buffer_load_dwordx4 v235, s[48:51], s33 offen offset:1024 lds
    s_add_u32 m0, s35, 12288
    s_add_u32 s33, s33, 131072
    buffer_load_dwordx4 v234, s[48:51], s33 offen lds
    buffer_load_dwordx4 v235, s[48:51], s33 offen offset:1024 lds
    s_add_u32 m0, s35, 14336
    s_add_u32 s33, s33, 131072
    buffer_load_dwordx4 v234, s[48:51], s33 offen lds
    buffer_load_dwordx4 v235, s[48:51], s33 offen offset:1024 lds
    s_add_u32 m0, s34, 16384
    s_add_u32 s37, s81, 0
    buffer_load_dwordx4 v232, s[44:47], s37 offen lds
    buffer_load_dwordx4 v233, s[44:47], s37 offen offset:1024 lds
    s_add_u32 m0, s34, 24576
    s_add_u32 s37, s81, 65536
    buffer_load_dwordx4 v232, s[44:47], s37 offen lds
    buffer_load_dwordx4 v233, s[44:47], s37 offen offset:1024 lds
    s_waitcnt vmcnt(19)
    s_barrier
    ds_read_b128 v[64:67], v224 offset:0
    ds_read_b128 v[68:71], v224 offset:2048
    ds_read_b128 v[72:75], v224 offset:4096
    ds_read_b128 v[76:79], v224 offset:6144
    ds_read_b64_tr_b16 a[0:1], v228 offset:0
    ds_read_b64_tr_b16 a[2:3], v228 offset:512
    ds_read_b64_tr_b16 a[4:5], v229 offset:0
    ds_read_b64_tr_b16 a[6:7], v229 offset:512
    ds_read_b64_tr_b16 a[8:9], v230 offset:0
    ds_read_b64_tr_b16 a[10:11], v230 offset:512
    ds_read_b64_tr_b16 a[12:13], v231 offset:0
    ds_read_b64_tr_b16 a[14:15], v231 offset:512
    s_waitcnt vmcnt(12)
    s_barrier
    buffer_store_dword v255, v250, s[88:91], s97 offen sc1
    s_cmp_eq_u32 s3, 0
    s_cselect_b32 s97, 0, s43
    s_cmp_lt_u32 s3, 2
    s_cbranch_scc0 ka_V
    s_waitcnt lgkmcnt(0)
    v_mfma_f32_16x16x32_bf16 v[96:99], a[0:3], v[64:67], 0
    ds_read_b128 v[80:83], v224 offset:8192
    v_mfma_f32_16x16x32_bf16 v[100:103], a[4:7], v[64:67], 0
    ds_read_b128 v[84:87], v224 offset:10240
    v_mfma_f32_16x16x32_bf16 v[104:107], a[8:11], v[64:67], 0
    ds_read_b128 v[88:91], v224 offset:12288
    v_mfma_f32_16x16x32_bf16 v[108:111], a[12:15], v[64:67], 0
    ds_read_b128 v[92:95], v224 offset:14336
    v_mfma_f32_16x16x32_bf16 v[112:115], a[0:3], v[68:71], 0
    ds_read_b64_tr_b16 a[16:17], v228 offset:4096
    v_mfma_f32_16x16x32_bf16 v[116:119], a[4:7], v[68:71], 0
    ds_read_b64_tr_b16 a[18:19], v228 offset:4608
    v_mfma_f32_16x16x32_bf16 v[120:123], a[8:11], v[68:71], 0
    ds_read_b64_tr_b16 a[20:21], v229 offset:4096
    v_mfma_f32_16x16x32_bf16 v[124:127], a[12:15], v[68:71], 0
    ds_read_b64_tr_b16 a[22:23], v229 offset:4608
    v_mfma_f32_16x16x32_bf16 v[128:131], a[0:3], v[72:75], 0
    s_add_u32 m0, s35, 16384
    s_and_b32 s33, s82, 1023
    s_lshl_b32 s33, s33, 12
    buffer_load_dwordx4 v234, s[48:51], s33 offen lds
    v_mfma_f32_16x16x32_bf16 v[132:135], a[4:7], v[72:75], 0
    v_mfma_f32_16x16x32_bf16 v[136:139], a[8:11], v[72:75], 0
    buffer_load_dwordx4 v235, s[48:51], s33 offen offset:1024 lds
    v_mfma_f32_16x16x32_bf16 v[140:143], a[12:15], v[72:75], 0
    v_mfma_f32_16x16x32_bf16 v[144:147], a[0:3], v[76:79], 0
    s_add_u32 m0, s35, 18432
    s_add_u32 s33, s33, 131072
    buffer_load_dwordx4 v234, s[48:51], s33 offen lds
    v_mfma_f32_16x16x32_bf16 v[148:151], a[4:7], v[76:79], 0
    v_mfma_f32_16x16x32_bf16 v[152:155], a[8:11], v[76:79], 0
    buffer_load_dwordx4 v235, s[48:51], s33 offen offset:1024 lds
    v_mfma_f32_16x16x32_bf16 v[156:159], a[12:15], v[76:79], 0
    s_waitcnt lgkmcnt(0)
    v_mfma_f32_16x16x32_bf16 v[160:163], a[0:3], v[80:83], 0
    ds_read_b128 v[64:67], v225 offset:0
    v_mfma_f32_16x16x32_bf16 v[164:167], a[4:7], v[80:83], 0
    ds_read_b128 v[68:71], v225 offset:2048
    v_mfma_f32_16x16x32_bf16 v[168:171], a[8:11], v[80:83], 0
    ds_read_b128 v[72:75], v225 offset:4096
    v_mfma_f32_16x16x32_bf16 v[172:175], a[12:15], v[80:83], 0
    ds_read_b128 v[76:79], v225 offset:6144
    v_mfma_f32_16x16x32_bf16 v[176:179], a[0:3], v[84:87], 0
    ds_read_b64_tr_b16 a[24:25], v230 offset:4096
    v_mfma_f32_16x16x32_bf16 v[180:183], a[4:7], v[84:87], 0
    ds_read_b64_tr_b16 a[26:27], v230 offset:4608
    v_mfma_f32_16x16x32_bf16 v[184:187], a[8:11], v[84:87], 0
    ds_read_b64_tr_b16 a[28:29], v231 offset:4096
    v_mfma_f32_16x16x32_bf16 v[188:191], a[12:15], v[84:87], 0
    ds_read_b64_tr_b16 a[30:31], v231 offset:4608
    v_mfma_f32_16x16x32_bf16 v[192:195], a[0:3], v[88:91], 0
    s_add_u32 m0, s35, 20480
    s_add_u32 s33, s33, 131072
    buffer_load_dwordx4 v234, s[48:51], s33 offen lds
    v_mfma_f32_16x16x32_bf16 v[196:199], a[4:7], v[88:91], 0
    v_mfma_f32_16x16x32_bf16 v[200:203], a[8:11], v[88:91], 0
    buffer_load_dwordx4 v235, s[48:51], s33 offen offset:1024 lds
    v_mfma_f32_16x16x32_bf16 v[204:207], a[12:15], v[88:91], 0
    v_mfma_f32_16x16x32_bf16 v[208:211], a[0:3], v[92:95], 0
    s_add_u32 m0, s35, 22528
    s_add_u32 s33, s33, 131072
    buffer_load_dwordx4 v234, s[48:51], s33 offen lds
    v_mfma_f32_16x16x32_bf16 v[212:215], a[4:7], v[92:95], 0
    v_mfma_f32_16x16x32_bf16 v[216:219], a[8:11], v[92:95], 0
    buffer_load_dwordx4 v235, s[48:51], s33 offen offset:1024 lds
    v_mfma_f32_16x16x32_bf16 v[220:223], a[12:15], v[92:95], 0
    s_waitcnt vmcnt(13) lgkmcnt(0)
    v_mfma_f32_16x16x32_bf16 v[96:99], a[16:19], v[64:67], v[96:99]
    ds_read_b128 v[80:83], v225 offset:8192
    v_mfma_f32_16x16x32_bf16 v[100:103], a[20:23], v[64:67], v[100:103]
    ds_read_b128 v[84:87], v225 offset:10240
    v_mfma_f32_16x16x32_bf16 v[104:107], a[24:27], v[64:67], v[104:107]
    ds_read_b128 v[88:91], v225 offset:12288
    v_mfma_f32_16x16x32_bf16 v[108:111], a[28:31], v[64:67], v[108:111]
    ds_read_b128 v[92:95], v225 offset:14336
    v_mfma_f32_16x16x32_bf16 v[112:115], a[16:19], v[68:71], v[112:115]
    ds_read_b64_tr_b16 a[32:33], v228 offset:8192
    v_mfma_f32_16x16x32_bf16 v[116:119], a[20:23], v[68:71], v[116:119]
    ds_read_b64_tr_b16 a[34:35], v228 offset:8704
    v_mfma_f32_16x16x32_bf16 v[120:123], a[24:27], v[68:71], v[120:123]
    ds_read_b64_tr_b16 a[36:37], v229 offset:8192
    v_mfma_f32_16x16x32_bf16 v[124:127], a[28:31], v[68:71], v[124:127]
    ds_read_b64_tr_b16 a[38:39], v229 offset:8704
    v_mfma_f32_16x16x32_bf16 v[128:131], a[16:19], v[72:75], v[128:131]
    ds_read_b64_tr_b16 a[40:41], v230 offset:8192
    s_add_u32 m0, s34, 32768
    s_add_u32 s37, s82, 0
    buffer_load_dwordx4 v232, s[44:47], s37 offen lds
    v_mfma_f32_16x16x32_bf16 v[132:135], a[20:23], v[72:75], v[132:135]
    ds_read_b64_tr_b16 a[42:43], v230 offset:8704
    buffer_load_dwordx4 v233, s[44:47], s37 offen offset:1024 lds
    v_mfma_f32_16x16x32_bf16 v[136:139], a[24:27], v[72:75], v[136:139]
    ds_read_b64_tr_b16 a[44:45], v231 offset:8192
    s_add_u32 m0, s34, 40960
    s_add_u32 s37, s82, 65536
    buffer_load_dwordx4 v232, s[44:47], s37 offen lds
    v_mfma_f32_16x16x32_bf16 v[140:143], a[28:31], v[72:75], v[140:143]
    ds_read_b64_tr_b16 a[46:47], v231 offset:8704
    buffer_load_dwordx4 v233, s[44:47], s37 offen offset:1024 lds
    v_mfma_f32_16x16x32_bf16 v[144:147], a[16:19], v[76:79], v[144:147]
    s_add_u32 m0, s35, 0
    s_and_b32 s33, s83, 1023
    s_lshl_b32 s33, s33, 12
    buffer_load_dwordx4 v234, s[48:51], s33 offen lds
    v_mfma_f32_16x16x32_bf16 v[148:151], a[20:23], v[76:79], v[148:151]
    buffer_load_dwordx4 v235, s[48:51], s33 offen offset:1024 lds
    v_mfma_f32_16x16x32_bf16 v[152:155], a[24:27], v[76:79], v[152:155]
    s_add_u32 m0, s35, 2048
    s_add_u32 s33, s33, 131072
    buffer_load_dwordx4 v234, s[48:51], s33 offen lds
    v_mfma_f32_16x16x32_bf16 v[156:159], a[28:31], v[76:79], v[156:159]
    buffer_load_dwordx4 v235, s[48:51], s33 offen offset:1024 lds
    s_waitcnt vmcnt(17) lgkmcnt(0)
    s_barrier
    v_mfma_f32_16x16x32_bf16 v[160:163], a[16:19], v[80:83], v[160:163]
    ds_read_b128 v[64:67], v224 offset:16384
    v_mfma_f32_16x16x32_bf16 v[164:167], a[20:23], v[80:83], v[164:167]
    ds_read_b128 v[68:71], v225 offset:16384
    v_mfma_f32_16x16x32_bf16 v[168:171], a[24:27], v[80:83], v[168:171]
    ds_read_b128 v[72:75], v224 offset:18432
    v_mfma_f32_16x16x32_bf16 v[172:175], a[28:31], v[80:83], v[172:175]
    ds_read_b128 v[76:79], v225 offset:18432
    v_mfma_f32_16x16x32_bf16 v[176:179], a[16:19], v[84:87], v[176:179]
    ds_read_b64_tr_b16 a[48:49], v228 offset:12288
    s_add_u32 m0, s34, 49152
    s_add_u32 s37, s83, 0
    buffer_load_dwordx4 v232, s[44:47], s37 offen lds
    v_mfma_f32_16x16x32_bf16 v[180:183], a[20:23], v[84:87], v[180:183]
    ds_read_b64_tr_b16 a[50:51], v228 offset:12800
    buffer_load_dwordx4 v233, s[44:47], s37 offen offset:1024 lds
    v_mfma_f32_16x16x32_bf16 v[184:187], a[24:27], v[84:87], v[184:187]
    ds_read_b64_tr_b16 a[52:53], v229 offset:12288
    s_add_u32 m0, s34, 57344
    s_add_u32 s37, s83, 65536
    buffer_load_dwordx4 v232, s[44:47], s37 offen lds
    v_mfma_f32_16x16x32_bf16 v[188:191], a[28:31], v[84:87], v[188:191]
    ds_read_b64_tr_b16 a[54:55], v229 offset:12800
    buffer_load_dwordx4 v233, s[44:47], s37 offen offset:1024 lds
    v_mfma_f32_16x16x32_bf16 v[192:195], a[16:19], v[88:91], v[192:195]
    ds_read_b64_tr_b16 a[56:57], v230 offset:12288
    s_add_u32 m0, s34, 0
    s_add_u32 s37, s84, 0
    buffer_load_dwordx4 v232, s[44:47], s37 offen lds
    v_mfma_f32_16x16x32_bf16 v[196:199], a[20:23], v[88:91], v[196:199]
    ds_read_b64_tr_b16 a[58:59], v230 offset:12800
    v_mfma_f32_16x16x32_bf16 v[200:203], a[24:27], v[88:91], v[200:203]
    ds_read_b64_tr_b16 a[60:61], v231 offset:12288
    buffer_load_dwordx4 v233, s[44:47], s37 offen offset:1024 lds
    v_mfma_f32_16x16x32_bf16 v[204:207], a[28:31], v[88:91], v[204:207]
    ds_read_b64_tr_b16 a[62:63], v231 offset:12800
    buffer_load_dwordx4 v[0:3], v236, s[52:55], 0 offen offset:0
    v_mfma_f32_16x16x32_bf16 v[208:211], a[16:19], v[92:95], v[208:211]
    buffer_load_dwordx4 v[4:7], v236, s[52:55], 0 offen offset:512
    v_mfma_f32_16x16x32_bf16 v[212:215], a[20:23], v[92:95], v[212:215]
    buffer_load_dwordx4 v[8:11], v236, s[52:55], 0 offen offset:1024
    v_mfma_f32_16x16x32_bf16 v[216:219], a[24:27], v[92:95], v[216:219]
    buffer_load_dwordx4 v[12:15], v236, s[52:55], 0 offen offset:1536
    v_mfma_f32_16x16x32_bf16 v[220:223], a[28:31], v[92:95], v[220:223]
    s_waitcnt lgkmcnt(0)
    v_mfma_f32_16x16x32_bf16 v[96:99], a[32:35], v[64:67], v[96:99]
    ds_read_b128 v[80:83], v224 offset:20480
    v_mfma_f32_16x16x32_bf16 v[96:99], a[48:51], v[68:71], v[96:99]
    ds_read_b128 v[84:87], v225 offset:20480
    v_mfma_f32_16x16x32_bf16 v[100:103], a[36:39], v[64:67], v[100:103]
    ds_read_b128 v[88:91], v224 offset:22528
    v_mfma_f32_16x16x32_bf16 v[100:103], a[52:55], v[68:71], v[100:103]
    ds_read_b128 v[92:95], v225 offset:22528
    v_mfma_f32_16x16x32_bf16 v[104:107], a[40:43], v[64:67], v[104:107]
    v_mfma_f32_16x16x32_bf16 v[104:107], a[56:59], v[68:71], v[104:107]
    v_mfma_f32_16x16x32_bf16 v[108:111], a[44:47], v[64:67], v[108:111]
    v_mfma_f32_16x16x32_bf16 v[108:111], a[60:63], v[68:71], v[108:111]
    v_mfma_f32_16x16x32_bf16 v[112:115], a[32:35], v[72:75], v[112:115]
    s_add_u32 m0, s35, 4096
    s_add_u32 s33, s33, 131072
    buffer_load_dwordx4 v234, s[48:51], s33 offen lds
    v_mfma_f32_16x16x32_bf16 v[112:115], a[48:51], v[76:79], v[112:115]
    v_mfma_f32_16x16x32_bf16 v[116:119], a[36:39], v[72:75], v[116:119]
    buffer_load_dwordx4 v235, s[48:51], s33 offen offset:1024 lds
    v_mfma_f32_16x16x32_bf16 v[116:119], a[52:55], v[76:79], v[116:119]
    v_mfma_f32_16x16x32_bf16 v[120:123], a[40:43], v[72:75], v[120:123]
    s_add_u32 m0, s35, 6144
    s_add_u32 s33, s33, 131072
    buffer_load_dwordx4 v234, s[48:51], s33 offen lds
    v_mfma_f32_16x16x32_bf16 v[120:123], a[56:59], v[76:79], v[120:123]
    v_mfma_f32_16x16x32_bf16 v[124:127], a[44:47], v[72:75], v[124:127]
    buffer_load_dwordx4 v235, s[48:51], s33 offen offset:1024 lds
    v_mfma_f32_16x16x32_bf16 v[124:127], a[60:63], v[76:79], v[124:127]
    s_waitcnt lgkmcnt(0)
    v_mfma_f32_16x16x32_bf16 v[128:131], a[32:35], v[80:83], v[128:131]
    ds_read_b128 v[64:67], v224 offset:24576
    v_mfma_f32_16x16x32_bf16 v[128:131], a[48:51], v[84:87], v[128:131]
    ds_read_b128 v[68:71], v225 offset:24576
    v_mfma_f32_16x16x32_bf16 v[132:135], a[36:39], v[80:83], v[132:135]
    ds_read_b128 v[72:75], v224 offset:26624
    v_mfma_f32_16x16x32_bf16 v[132:135], a[52:55], v[84:87], v[132:135]
    ds_read_b128 v[76:79], v225 offset:26624
    v_mfma_f32_16x16x32_bf16 v[136:139], a[40:43], v[80:83], v[136:139]
    v_mfma_f32_16x16x32_bf16 v[136:139], a[56:59], v[84:87], v[136:139]
    v_mfma_f32_16x16x32_bf16 v[140:143], a[44:47], v[80:83], v[140:143]
    v_mfma_f32_16x16x32_bf16 v[140:143], a[60:63], v[84:87], v[140:143]
    v_mfma_f32_16x16x32_bf16 v[144:147], a[32:35], v[88:91], v[144:147]
    s_add_u32 m0, s34, 8192
    s_add_u32 s37, s84, 65536
    buffer_load_dwordx4 v232, s[44:47], s37 offen lds
    v_mfma_f32_16x16x32_bf16 v[144:147], a[48:51], v[92:95], v[144:147]
    v_mfma_f32_16x16x32_bf16 v[148:151], a[36:39], v[88:91], v[148:151]
    v_mfma_f32_16x16x32_bf16 v[148:151], a[52:55], v[92:95], v[148:151]
    v_mfma_f32_16x16x32_bf16 v[152:155], a[40:43], v[88:91], v[152:155]
    buffer_load_dwordx4 v233, s[44:47], s37 offen offset:1024 lds
    v_mfma_f32_16x16x32_bf16 v[152:155], a[56:59], v[92:95], v[152:155]
    v_mfma_f32_16x16x32_bf16 v[156:159], a[44:47], v[88:91], v[156:159]
    v_mfma_f32_16x16x32_bf16 v[156:159], a[60:63], v[92:95], v[156:159]
    s_waitcnt vmcnt(24) lgkmcnt(0)
    v_mfma_f32_16x16x32_bf16 v[160:163], a[32:35], v[64:67], v[160:163]
    ds_read_b128 v[80:83], v224 offset:28672
    v_mfma_f32_16x16x32_bf16 v[160:163], a[48:51], v[68:71], v[160:163]
    ds_read_b128 v[84:87], v225 offset:28672
    v_mfma_f32_16x16x32_bf16 v[164:167], a[36:39], v[64:67], v[164:167]
    ds_read_b128 v[88:91], v224 offset:30720
    v_mfma_f32_16x16x32_bf16 v[164:167], a[52:55], v[68:71], v[164:167]
    ds_read_b128 v[92:95], v225 offset:30720
    v_mfma_f32_16x16x32_bf16 v[168:171], a[40:43], v[64:67], v[168:171]
    ds_read_b64_tr_b16 a[64:65], v228 offset:16384
    v_mfma_f32_16x16x32_bf16 v[168:171], a[56:59], v[68:71], v[168:171]
    ds_read_b64_tr_b16 a[66:67], v228 offset:16896
    v_mfma_f32_16x16x32_bf16 v[172:175], a[44:47], v[64:67], v[172:175]
    ds_read_b64_tr_b16 a[68:69], v229 offset:16384
    v_mfma_f32_16x16x32_bf16 v[172:175], a[60:63], v[68:71], v[172:175]
    ds_read_b64_tr_b16 a[70:71], v229 offset:16896
    v_mfma_f32_16x16x32_bf16 v[176:179], a[32:35], v[72:75], v[176:179]
    ds_read_b64_tr_b16 a[72:73], v230 offset:16384
    s_add_u32 m0, s35, 8192
    s_and_b32 s33, s84, 1023
    s_lshl_b32 s33, s33, 12
    buffer_load_dwordx4 v234, s[48:51], s33 offen lds
    v_mfma_f32_16x16x32_bf16 v[176:179], a[48:51], v[76:79], v[176:179]
    ds_read_b64_tr_b16 a[74:75], v230 offset:16896
    v_mfma_f32_16x16x32_bf16 v[180:183], a[36:39], v[72:75], v[180:183]
    ds_read_b64_tr_b16 a[76:77], v231 offset:16384
    buffer_load_dwordx4 v235, s[48:51], s33 offen offset:1024 lds
    v_mfma_f32_16x16x32_bf16 v[180:183], a[52:55], v[76:79], v[180:183]
    ds_read_b64_tr_b16 a[78:79], v231 offset:16896
    v_mfma_f32_16x16x32_bf16 v[184:187], a[40:43], v[72:75], v[184:187]
    s_add_u32 m0, s35, 10240
    s_add_u32 s33, s33, 131072
    buffer_load_dwordx4 v234, s[48:51], s33 offen lds
    v_mfma_f32_16x16x32_bf16 v[184:187], a[56:59], v[76:79], v[184:187]
    v_mfma_f32_16x16x32_bf16 v[188:191], a[44:47], v[72:75], v[188:191]
    buffer_load_dwordx4 v235, s[48:51], s33 offen offset:1024 lds
    v_mfma_f32_16x16x32_bf16 v[188:191], a[60:63], v[76:79], v[188:191]
    s_waitcnt vmcnt(24) lgkmcnt(0)
    s_barrier
    v_mfma_f32_16x16x32_bf16 v[192:195], a[32:35], v[80:83], v[192:195]
    ds_read_b128 v[64:67], v224 offset:32768
    v_mfma_f32_16x16x32_bf16 v[192:195], a[48:51], v[84:87], v[192:195]
    ds_read_b128 v[68:71], v225 offset:32768
    v_mfma_f32_16x16x32_bf16 v[196:199], a[36:39], v[80:83], v[196:199]
    ds_read_b128 v[72:75], v224 offset:34816
    v_mfma_f32_16x16x32_bf16 v[196:199], a[52:55], v[84:87], v[196:199]
    ds_read_b128 v[76:79], v225 offset:34816
    v_mfma_f32_16x16x32_bf16 v[200:203], a[40:43], v[80:83], v[200:203]
    ds_read_b64_tr_b16 a[80:81], v228 offset:20480
    v_mfma_f32_16x16x32_bf16 v[200:203], a[56:59], v[84:87], v[200:203]
    ds_read_b64_tr_b16 a[82:83], v228 offset:20992
    v_mfma_f32_16x16x32_bf16 v[204:207], a[44:47], v[80:83], v[204:207]
    ds_read_b64_tr_b16 a[84:85], v229 offset:20480
    v_mfma_f32_16x16x32_bf16 v[204:207], a[60:63], v[84:87], v[204:207]
    ds_read_b64_tr_b16 a[86:87], v229 offset:20992
    v_mfma_f32_16x16x32_bf16 v[208:211], a[32:35], v[88:91], v[208:211]
    ds_read_b64_tr_b16 a[88:89], v230 offset:20480
    s_add_u32 m0, s34, 16384
    s_add_u32 s37, s85, 0
    buffer_load_dwordx4 v232, s[44:47], s37 offen lds
    v_mfma_f32_16x16x32_bf16 v[208:211], a[48:51], v[92:95], v[208:211]
    ds_read_b64_tr_b16 a[90:91], v230 offset:20992
    v_mfma_f32_16x16x32_bf16 v[212:215], a[36:39], v[88:91], v[212:215]
    ds_read_b64_tr_b16 a[92:93], v231 offset:20480
    v_mfma_f32_16x16x32_bf16 v[212:215], a[52:55], v[92:95], v[212:215]
    ds_read_b64_tr_b16 a[94:95], v231 offset:20992
    v_mfma_f32_16x16x32_bf16 v[216:219], a[40:43], v[88:91], v[216:219]
    buffer_load_dwordx4 v233, s[44:47], s37 offen offset:1024 lds
    v_mfma_f32_16x16x32_bf16 v[216:219], a[56:59], v[92:95], v[216:219]
    v_mfma_f32_16x16x32_bf16 v[220:223], a[44:47], v[88:91], v[220:223]
    v_mfma_f32_16x16x32_bf16 v[220:223], a[60:63], v[92:95], v[220:223]
    s_waitcnt lgkmcnt(0)
    v_mfma_f32_16x16x32_bf16 v[96:99], a[64:67], v[64:67], v[96:99]
    ds_read_b128 v[80:83], v224 offset:36864
    v_mfma_f32_16x16x32_bf16 v[96:99], a[80:83], v[68:71], v[96:99]
    ds_read_b128 v[84:87], v225 offset:36864
    v_mfma_f32_16x16x32_bf16 v[100:103], a[68:71], v[64:67], v[100:103]
    ds_read_b128 v[88:91], v224 offset:38912
    v_mfma_f32_16x16x32_bf16 v[100:103], a[84:87], v[68:71], v[100:103]
    ds_read_b128 v[92:95], v225 offset:38912
    v_mfma_f32_16x16x32_bf16 v[104:107], a[72:75], v[64:67], v[104:107]
    v_mfma_f32_16x16x32_bf16 v[104:107], a[88:91], v[68:71], v[104:107]
    v_mfma_f32_16x16x32_bf16 v[108:111], a[76:79], v[64:67], v[108:111]
    v_mfma_f32_16x16x32_bf16 v[108:111], a[92:95], v[68:71], v[108:111]
    v_mfma_f32_16x16x32_bf16 v[112:115], a[64:67], v[72:75], v[112:115]
    s_add_u32 m0, s35, 12288
    s_add_u32 s33, s33, 131072
    buffer_load_dwordx4 v234, s[48:51], s33 offen lds
    v_mfma_f32_16x16x32_bf16 v[112:115], a[80:83], v[76:79], v[112:115]
    v_mfma_f32_16x16x32_bf16 v[116:119], a[68:71], v[72:75], v[116:119]
    buffer_load_dwordx4 v235, s[48:51], s33 offen offset:1024 lds
    v_mfma_f32_16x16x32_bf16 v[116:119], a[84:87], v[76:79], v[116:119]
    v_mfma_f32_16x16x32_bf16 v[120:123], a[72:75], v[72:75], v[120:123]
    s_add_u32 m0, s35, 14336
    s_add_u32 s33, s33, 131072
    buffer_load_dwordx4 v234, s[48:51], s33 offen lds
    v_mfma_f32_16x16x32_bf16 v[120:123], a[88:91], v[76:79], v[120:123]
    v_mfma_f32_16x16x32_bf16 v[124:127], a[76:79], v[72:75], v[124:127]
    buffer_load_dwordx4 v235, s[48:51], s33 offen offset:1024 lds
    v_mfma_f32_16x16x32_bf16 v[124:127], a[92:95], v[76:79], v[124:127]
    s_waitcnt lgkmcnt(0)
    v_mfma_f32_16x16x32_bf16 v[128:131], a[64:67], v[80:83], v[128:131]
    ds_read_b128 v[64:67], v224 offset:40960
    v_mfma_f32_16x16x32_bf16 v[128:131], a[80:83], v[84:87], v[128:131]
    ds_read_b128 v[68:71], v225 offset:40960
    v_mfma_f32_16x16x32_bf16 v[132:135], a[68:71], v[80:83], v[132:135]
    ds_read_b128 v[72:75], v224 offset:43008
    v_mfma_f32_16x16x32_bf16 v[132:135], a[84:87], v[84:87], v[132:135]
    ds_read_b128 v[76:79], v225 offset:43008
    v_mfma_f32_16x16x32_bf16 v[136:139], a[72:75], v[80:83], v[136:139]
    v_mfma_f32_16x16x32_bf16 v[136:139], a[88:91], v[84:87], v[136:139]
    v_mfma_f32_16x16x32_bf16 v[140:143], a[76:79], v[80:83], v[140:143]
    v_mfma_f32_16x16x32_bf16 v[140:143], a[92:95], v[84:87], v[140:143]
    v_mfma_f32_16x16x32_bf16 v[144:147], a[64:67], v[88:91], v[144:147]
    s_add_u32 m0, s34, 24576
    s_add_u32 s37, s85, 65536
    buffer_load_dwordx4 v232, s[44:47], s37 offen lds
    v_mfma_f32_16x16x32_bf16 v[144:147], a[80:83], v[92:95], v[144:147]
    v_mfma_f32_16x16x32_bf16 v[148:151], a[68:71], v[88:91], v[148:151]
    v_mfma_f32_16x16x32_bf16 v[148:151], a[84:87], v[92:95], v[148:151]
    v_mfma_f32_16x16x32_bf16 v[152:155], a[72:75], v[88:91], v[152:155]
    buffer_load_dwordx4 v233, s[44:47], s37 offen offset:1024 lds
    v_mfma_f32_16x16x32_bf16 v[152:155], a[88:91], v[92:95], v[152:155]
    v_mfma_f32_16x16x32_bf16 v[156:159], a[76:79], v[88:91], v[156:159]
    v_mfma_f32_16x16x32_bf16 v[156:159], a[92:95], v[92:95], v[156:159]
    s_waitcnt vmcnt(14) lgkmcnt(0)
    v_mfma_f32_16x16x32_bf16 v[160:163], a[64:67], v[64:67], v[160:163]
    ds_read_b128 v[80:83], v224 offset:45056
    s_waitcnt vmcnt(18)
    v_mfma_f32_16x16x32_bf16 v[160:163], a[80:83], v[68:71], v[160:163]
    ds_read_b128 v[84:87], v225 offset:45056
    v_lshlrev_b32 v16, 16, v0
    v_mfma_f32_16x16x32_bf16 v[164:167], a[68:71], v[64:67], v[164:167]
    ds_read_b128 v[88:91], v224 offset:47104
    v_and_b32 v17, 0xffff0000, v0
    v_lshlrev_b32_e64 v18, 16, v1
    v_mfma_f32_16x16x32_bf16 v[164:167], a[84:87], v[68:71], v[164:167]
    ds_read_b128 v[92:95], v225 offset:47104
    v_and_b32 v19, 0xffff0000, v1
    v_mfma_f32_16x16x32_bf16 v[168:171], a[72:75], v[64:67], v[168:171]
    ds_read_b64_tr_b16 a[96:97], v228 offset:0
    v_lshlrev_b32_e64 v20, 16, v2
    v_mfma_f32_16x16x32_bf16 v[168:171], a[88:91], v[68:71], v[168:171]
    ds_read_b64_tr_b16 a[98:99], v228 offset:512
    v_and_b32 v21, 0xffff0000, v2
    v_mfma_f32_16x16x32_bf16 v[172:175], a[76:79], v[64:67], v[172:175]
    ds_read_b64_tr_b16 a[100:101], v229 offset:0
    v_lshlrev_b32_e64 v22, 16, v3
    v_mfma_f32_16x16x32_bf16 v[172:175], a[92:95], v[68:71], v[172:175]
    ds_read_b64_tr_b16 a[102:103], v229 offset:512
    v_and_b32 v23, 0xffff0000, v3
    v_mfma_f32_16x16x32_bf16 v[176:179], a[64:67], v[72:75], v[176:179]
    ds_read_b64_tr_b16 a[104:105], v230 offset:0
    s_add_u32 m0, s35, 16384
    s_and_b32 s33, s85, 1023
    s_lshl_b32 s33, s33, 12
    buffer_load_dwordx4 v234, s[48:51], s33 offen lds
    v_mfma_f32_16x16x32_bf16 v[176:179], a[80:83], v[76:79], v[176:179]
    ds_read_b64_tr_b16 a[106:107], v230 offset:512
    buffer_load_dwordx4 v235, s[48:51], s33 offen offset:1024 lds
    v_mfma_f32_16x16x32_bf16 v[180:183], a[68:71], v[72:75], v[180:183]
    ds_read_b64_tr_b16 a[108:109], v231 offset:0
    s_add_u32 m0, s35, 18432
    s_add_u32 s33, s33, 131072
    buffer_load_dwordx4 v234, s[48:51], s33 offen lds
    v_mfma_f32_16x16x32_bf16 v[180:183], a[84:87], v[76:79], v[180:183]
    ds_read_b64_tr_b16 a[110:111], v231 offset:512
    v_lshlrev_b32 v24, 16, v4
    v_and_b32 v25, 0xffff0000, v4
    v_mfma_f32_16x16x32_bf16 v[184:187], a[72:75], v[72:75], v[184:187]
    buffer_load_dwordx4 v235, s[48:51], s33 offen offset:1024 lds
    v_lshlrev_b32_e64 v26, 16, v5
    v_mfma_f32_16x16x32_bf16 v[184:187], a[88:91], v[76:79], v[184:187]
    s_lshl2_add_u32 s26, s4, s3
    s_lshl_b32 s26, s26, 10
    s_add_u32 s26, s26, s32
    s_add_u32 s26, s26, 131072
    v_mfma_f32_16x16x32_bf16 v[188:191], a[76:79], v[72:75], v[188:191]
    v_and_b32 v226, 0x40000380, v251
    buffer_load_dword v241, v226, s[44:47], s26 offen
    v_mfma_f32_16x16x32_bf16 v[188:191], a[92:95], v[76:79], v[188:191]
    s_waitcnt vmcnt(29) lgkmcnt(0)
    s_barrier
    v_mfma_f32_16x16x32_bf16 v[192:195], a[64:67], v[80:83], v[192:195]
    ds_read_b128 v[64:67], v224 offset:49152
    v_and_b32 v27, 0xffff0000, v5
    v_mfma_f32_16x16x32_bf16 v[192:195], a[80:83], v[84:87], v[192:195]
    ds_read_b128 v[68:71], v225 offset:49152
    v_lshlrev_b32 v28, 16, v6
    v_mfma_f32_16x16x32_bf16 v[196:199], a[68:71], v[80:83], v[196:199]
    ds_read_b128 v[72:75], v224 offset:51200
    v_and_b32 v29, 0xffff0000, v6
    v_mfma_f32_16x16x32_bf16 v[196:199], a[84:87], v[84:87], v[196:199]
    ds_read_b128 v[76:79], v225 offset:51200
    v_lshlrev_b32_e64 v30, 16, v7
    v_and_b32 v31, 0xffff0000, v7
    v_mfma_f32_16x16x32_bf16 v[200:203], a[72:75], v[80:83], v[200:203]
    ds_read_b64_tr_b16 a[112:113], v228 offset:4096
    v_lshlrev_b32_e64 v32, 16, v8
    v_mfma_f32_16x16x32_bf16 v[200:203], a[88:91], v[84:87], v[200:203]
    ds_read_b64_tr_b16 a[114:115], v228 offset:4608
    v_and_b32 v33, 0xffff0000, v8
    v_mfma_f32_16x16x32_bf16 v[204:207], a[76:79], v[80:83], v[204:207]
    ds_read_b64_tr_b16 a[116:117], v229 offset:4096
    v_lshlrev_b32_e64 v34, 16, v9
    v_mfma_f32_16x16x32_bf16 v[204:207], a[92:95], v[84:87], v[204:207]
    ds_read_b64_tr_b16 a[118:119], v229 offset:4608
    v_and_b32 v35, 0xffff0000, v9
    v_mfma_f32_16x16x32_bf16 v[208:211], a[64:67], v[88:91], v[208:211]
    ds_read_b64_tr_b16 a[120:121], v230 offset:4096
    s_add_u32 m0, s34, 32768
    s_add_u32 s37, s86, 0
    buffer_load_dwordx4 v232, s[44:47], s37 offen lds
    v_mfma_f32_16x16x32_bf16 v[208:211], a[80:83], v[92:95], v[208:211]
    ds_read_b64_tr_b16 a[122:123], v230 offset:4608
    v_lshlrev_b32 v36, 16, v10
    v_mfma_f32_16x16x32_bf16 v[212:215], a[68:71], v[88:91], v[212:215]
    ds_read_b64_tr_b16 a[124:125], v231 offset:4096
    v_and_b32 v37, 0xffff0000, v10
    v_lshlrev_b32_e64 v38, 16, v11
    v_mfma_f32_16x16x32_bf16 v[212:215], a[84:87], v[92:95], v[212:215]
    ds_read_b64_tr_b16 a[126:127], v231 offset:4608
    v_and_b32 v39, 0xffff0000, v11
    v_mfma_f32_16x16x32_bf16 v[216:219], a[72:75], v[88:91], v[216:219]
    buffer_load_dwordx4 v233, s[44:47], s37 offen offset:1024 lds
    v_lshlrev_b32_e64 v40, 16, v12
    v_mfma_f32_16x16x32_bf16 v[216:219], a[88:91], v[92:95], v[216:219]
    v_and_b32 v41, 0xffff0000, v12
    v_lshlrev_b32_e64 v42, 16, v13
    v_mfma_f32_16x16x32_bf16 v[220:223], a[76:79], v[88:91], v[220:223]
    v_and_b32 v43, 0xffff0000, v13
    v_lshlrev_b32_e64 v44, 16, v14
    v_and_b32 v45, 0xffff0000, v14
    v_mfma_f32_16x16x32_bf16 v[220:223], a[92:95], v[92:95], v[220:223]
    v_lshlrev_b32 v46, 16, v15
    s_waitcnt lgkmcnt(0)
    v_mfma_f32_16x16x32_bf16 v[96:99], a[96:99], v[64:67], v[96:99]
    ds_read_b128 v[80:83], v224 offset:53248
    v_and_b32 v47, 0xffff0000, v15
    v_mfma_f32_16x16x32_bf16 v[96:99], a[112:115], v[68:71], v[96:99]
    ds_read_b128 v[84:87], v225 offset:53248
    v_add_f32_e64 v52, v16, v20
    v_mfma_f32_16x16x32_bf16 v[100:103], a[100:103], v[64:67], v[100:103]
    ds_read_b128 v[88:91], v224 offset:55296
    v_add_f32_e64 v53, v17, v21
    v_mfma_f32_16x16x32_bf16 v[100:103], a[116:119], v[68:71], v[100:103]
    ds_read_b128 v[92:95], v225 offset:55296
    v_add_f32 v54, v18, v22
    v_add_f32 v55, v19, v23
    v_mfma_f32_16x16x32_bf16 v[104:107], a[104:107], v[64:67], v[104:107]
    v_add_f32 v52, v52, v24
    v_add_f32 v53, v53, v25
    v_mfma_f32_16x16x32_bf16 v[104:107], a[120:123], v[68:71], v[104:107]
    v_add_f32 v54, v54, v26
    v_add_f32 v55, v55, v27
    v_mfma_f32_16x16x32_bf16 v[108:111], a[108:111], v[64:67], v[108:111]
    v_add_f32 v52, v52, v28
    v_add_f32 v53, v53, v29
    v_add_f32_e64 v54, v54, v30
    v_mfma_f32_16x16x32_bf16 v[108:111], a[124:127], v[68:71], v[108:111]
    v_add_f32 v55, v55, v31
    v_add_f32 v52, v52, v32
    v_mfma_f32_16x16x32_bf16 v[112:115], a[96:99], v[72:75], v[112:115]
    s_add_u32 m0, s35, 20480
    s_add_u32 s33, s33, 131072
    buffer_load_dwordx4 v234, s[48:51], s33 offen lds
    v_mfma_f32_16x16x32_bf16 v[112:115], a[112:115], v[76:79], v[112:115]
    v_add_f32 v53, v53, v33
    v_add_f32 v54, v54, v34
    v_mfma_f32_16x16x32_bf16 v[116:119], a[100:103], v[72:75], v[116:119]
    buffer_load_dwordx4 v235, s[48:51], s33 offen offset:1024 lds
    v_add_f32 v55, v55, v35
    v_add_f32 v52, v52, v36
    v_mfma_f32_16x16x32_bf16 v[116:119], a[116:119], v[76:79], v[116:119]
    v_add_f32 v53, v53, v37
    v_add_f32 v54, v54, v38
    v_mfma_f32_16x16x32_bf16 v[120:123], a[104:107], v[72:75], v[120:123]
    s_add_u32 m0, s35, 22528
    s_add_u32 s33, s33, 131072
    buffer_load_dwordx4 v234, s[48:51], s33 offen lds
    v_mfma_f32_16x16x32_bf16 v[120:123], a[120:123], v[76:79], v[120:123]
    v_add_f32 v55, v55, v39
    v_add_f32 v52, v52, v40
    v_mfma_f32_16x16x32_bf16 v[124:127], a[108:111], v[72:75], v[124:127]
    buffer_load_dwordx4 v235, s[48:51], s33 offen offset:1024 lds
    v_add_f32 v53, v53, v41
    v_add_f32 v54, v54, v42
    v_mfma_f32_16x16x32_bf16 v[124:127], a[124:127], v[76:79], v[124:127]
    v_add_f32 v55, v55, v43
    s_waitcnt lgkmcnt(0)
    v_mfma_f32_16x16x32_bf16 v[128:131], a[96:99], v[80:83], v[128:131]
    ds_read_b128 v[64:67], v224 offset:57344
    v_add_f32_e64 v52, v52, v44
    v_mfma_f32_16x16x32_bf16 v[128:131], a[112:115], v[84:87], v[128:131]
    ds_read_b128 v[68:71], v225 offset:57344
    v_add_f32_e64 v53, v53, v45
    v_mfma_f32_16x16x32_bf16 v[132:135], a[100:103], v[80:83], v[132:135]
    ds_read_b128 v[72:75], v224 offset:59392
    v_add_f32_e64 v54, v54, v46
    v_mfma_f32_16x16x32_bf16 v[132:135], a[116:119], v[84:87], v[132:135]
    ds_read_b128 v[76:79], v225 offset:59392
    v_add_f32 v55, v55, v47
    v_add_f32 v52, v52, v53
    v_mfma_f32_16x16x32_bf16 v[136:139], a[104:107], v[80:83], v[136:139]
    v_add_f32 v54, v54, v55
    v_add_f32 v48, v52, v54
    v_mfma_f32_16x16x32_bf16 v[136:139], a[120:123], v[84:87], v[136:139]
    s_nop 1
    v_add_f32_dpp v48, v48, v48 quad_perm:[1,0,3,2] row_mask:0xf bank_mask:0xf
    v_mfma_f32_16x16x32_bf16 v[140:143], a[108:111], v[80:83], v[140:143]
    s_nop 1
    v_add_f32_dpp v48, v48, v48 quad_perm:[2,3,0,1] row_mask:0xf bank_mask:0xf
    s_nop 1
    v_mfma_f32_16x16x32_bf16 v[140:143], a[124:127], v[84:87], v[140:143]
    v_add_f32_dpp v48, v48, v48 row_half_mirror row_mask:0xf bank_mask:0xf
    s_nop 1
    v_mfma_f32_16x16x32_bf16 v[144:147], a[96:99], v[88:91], v[144:147]
    s_add_u32 m0, s34, 40960
    s_add_u32 s37, s86, 65536
    buffer_load_dwordx4 v232, s[44:47], s37 offen lds
    v_mfma_f32_16x16x32_bf16 v[144:147], a[112:115], v[92:95], v[144:147]
    v_add_f32_dpp v48, v48, v48 row_mirror row_mask:0xf bank_mask:0xf
    s_nop 0
    v_mfma_f32_16x16x32_bf16 v[148:151], a[100:103], v[88:91], v[148:151]
    buffer_load_dwordx4 v233, s[44:47], s37 offen offset:1024 lds
    v_mov_b32_e64 v49, v48
    s_nop 1
    v_mfma_f32_16x16x32_bf16 v[148:151], a[116:119], v[92:95], v[148:151]
    v_permlane16_swap_b32 v48, v49
    s_nop 0
    v_mfma_f32_16x16x32_bf16 v[152:155], a[104:107], v[88:91], v[152:155]
    v_lshlrev_b32_e64 v227, 3, v240
    v_min_u32 v227, 1920, v227
    s_lshl2_add_u32 s25, s2, s3
    v_mfma_f32_16x16x32_bf16 v[152:155], a[120:123], v[92:95], v[152:155]
    v_add_f32 v48, v48, v49
    v_mul_f32 v48, 0x3a800000, v48
    v_mfma_f32_16x16x32_bf16 v[156:159], a[108:111], v[88:91], v[156:159]
    s_lshl_b32 s25, s25, 13
    s_add_u32 s25, s25, 0
    buffer_load_dword v241, v227, s[12:15], s25 offen
    v_mfma_f32_16x16x32_bf16 v[156:159], a[124:127], v[92:95], v[156:159]
    v_sub_f32 v56, v16, v48
    s_waitcnt vmcnt(16) lgkmcnt(0)
    v_mfma_f32_16x16x32_bf16 v[160:163], a[96:99], v[64:67], v[160:163]
    ds_read_b128 v[80:83], v224 offset:61440
    v_mul_f32 v52, v56, v56
    v_sub_f32 v57, v17, v48
    v_mfma_f32_16x16x32_bf16 v[160:163], a[112:115], v[68:71], v[160:163]
    ds_read_b128 v[84:87], v225 offset:61440
    v_mul_f32_e64 v53, v57, v57
    v_mfma_f32_16x16x32_bf16 v[164:167], a[100:103], v[64:67], v[164:167]
    ds_read_b128 v[88:91], v224 offset:63488
    v_sub_f32_e64 v58, v18, v48
    v_mfma_f32_16x16x32_bf16 v[164:167], a[116:119], v[68:71], v[164:167]
    ds_read_b128 v[92:95], v225 offset:63488
    v_mul_f32_e64 v54, v58, v58
    v_mfma_f32_16x16x32_bf16 v[168:171], a[104:107], v[64:67], v[168:171]
    ds_read_b64_tr_b16 a[128:129], v228 offset:8192
    v_sub_f32_e64 v59, v19, v48
    v_mfma_f32_16x16x32_bf16 v[168:171], a[120:123], v[68:71], v[168:171]
    ds_read_b64_tr_b16 a[130:131], v228 offset:8704
    v_mul_f32 v55, v59, v59
    v_sub_f32 v56, v20, v48
    v_mfma_f32_16x16x32_bf16 v[172:175], a[108:111], v[64:67], v[172:175]
    ds_read_b64_tr_b16 a[132:133], v229 offset:8192
    v_fmac_f32_e64 v52, v56, v56
    v_mfma_f32_16x16x32_bf16 v[172:175], a[124:127], v[68:71], v[172:175]
    ds_read_b64_tr_b16 a[134:135], v229 offset:8704
    v_sub_f32_e64 v57, v21, v48
    v_mfma_f32_16x16x32_bf16 v[176:179], a[96:99], v[72:75], v[176:179]
    ds_read_b64_tr_b16 a[136:137], v230 offset:8192
    s_add_u32 m0, s35, 0
    s_and_b32 s33, s86, 1023
    s_lshl_b32 s33, s33, 12
    buffer_load_dwordx4 v234, s[48:51], s33 offen lds
    v_mfma_f32_16x16x32_bf16 v[176:179], a[112:115], v[76:79], v[176:179]
    ds_read_b64_tr_b16 a[138:139], v230 offset:8704
    v_fmac_f32_e64 v53, v57, v57
    v_mfma_f32_16x16x32_bf16 v[180:183], a[100:103], v[72:75], v[180:183]
    ds_read_b64_tr_b16 a[140:141], v231 offset:8192
    buffer_load_dwordx4 v235, s[48:51], s33 offen offset:1024 lds
    v_mfma_f32_16x16x32_bf16 v[180:183], a[116:119], v[76:79], v[180:183]
    ds_read_b64_tr_b16 a[142:143], v231 offset:8704
    v_sub_f32_e64 v58, v22, v48
    v_mfma_f32_16x16x32_bf16 v[184:187], a[104:107], v[72:75], v[184:187]
    s_add_u32 m0, s35, 2048
    s_add_u32 s33, s33, 131072
    buffer_load_dwordx4 v234, s[48:51], s33 offen lds
    v_mfma_f32_16x16x32_bf16 v[184:187], a[120:123], v[76:79], v[184:187]
    v_fmac_f32 v54, v58, v58
    v_sub_f32 v59, v23, v48
    v_fmac_f32_e64 v55, v59, v59
    v_mfma_f32_16x16x32_bf16 v[188:191], a[108:111], v[72:75], v[188:191]
    buffer_load_dwordx4 v235, s[48:51], s33 offen offset:1024 lds
    v_sub_f32_e64 v56, v24, v48
    v_mfma_f32_16x16x32_bf16 v[188:191], a[124:127], v[76:79], v[188:191]
    s_waitcnt vmcnt(30) lgkmcnt(0)
    s_barrier
    v_mfma_f32_16x16x32_bf16 v[192:195], a[96:99], v[80:83], v[192:195]
    ds_read_b128 v[64:67], v224 offset:0
    v_fmac_f32_e64 v52, v56, v56
    v_mfma_f32_16x16x32_bf16 v[192:195], a[112:115], v[84:87], v[192:195]
    ds_read_b128 v[68:71], v225 offset:0
    v_sub_f32_e64 v57, v25, v48
    v_mfma_f32_16x16x32_bf16 v[196:199], a[100:103], v[80:83], v[196:199]
    ds_read_b128 v[72:75], v224 offset:2048
    v_fmac_f32_e64 v53, v57, v57
    v_mfma_f32_16x16x32_bf16 v[196:199], a[116:119], v[84:87], v[196:199]
    ds_read_b128 v[76:79], v225 offset:2048
    v_sub_f32 v58, v26, v48
    v_fmac_f32 v54, v58, v58
    v_mfma_f32_16x16x32_bf16 v[200:203], a[104:107], v[80:83], v[200:203]
    ds_read_b64_tr_b16 a[144:145], v228 offset:12288
    v_sub_f32_e64 v59, v27, v48
    v_mfma_f32_16x16x32_bf16 v[200:203], a[120:123], v[84:87], v[200:203]
    ds_read_b64_tr_b16 a[146:147], v228 offset:12800
    v_fmac_f32_e64 v55, v59, v59
    v_mfma_f32_16x16x32_bf16 v[204:207], a[108:111], v[80:83], v[204:207]
    ds_read_b64_tr_b16 a[148:149], v229 offset:12288
    v_sub_f32_e64 v56, v28, v48
    v_mfma_f32_16x16x32_bf16 v[204:207], a[124:127], v[84:87], v[204:207]
    ds_read_b64_tr_b16 a[150:151], v229 offset:12800
    v_fmac_f32_e64 v52, v56, v56
    v_mfma_f32_16x16x32_bf16 v[208:211], a[96:99], v[88:91], v[208:211]
    ds_read_b64_tr_b16 a[152:153], v230 offset:12288
    s_add_u32 m0, s34, 49152
    s_add_u32 s37, s87, 0
    buffer_load_dwordx4 v232, s[44:47], s37 offen lds
    v_mfma_f32_16x16x32_bf16 v[208:211], a[112:115], v[92:95], v[208:211]
    ds_read_b64_tr_b16 a[154:155], v230 offset:12800
    v_sub_f32 v57, v29, v48
    v_mfma_f32_16x16x32_bf16 v[212:215], a[100:103], v[88:91], v[212:215]
    ds_read_b64_tr_b16 a[156:157], v231 offset:12288
    v_fmac_f32 v53, v57, v57
    v_sub_f32 v58, v30, v48
    v_mfma_f32_16x16x32_bf16 v[212:215], a[116:119], v[92:95], v[212:215]
    ds_read_b64_tr_b16 a[158:159], v231 offset:12800
    v_fmac_f32_e64 v54, v58, v58
    v_mfma_f32_16x16x32_bf16 v[216:219], a[104:107], v[88:91], v[216:219]
    buffer_load_dwordx4 v233, s[44:47], s37 offen offset:1024 lds
    v_sub_f32_e64 v59, v31, v48
    v_mfma_f32_16x16x32_bf16 v[216:219], a[120:123], v[92:95], v[216:219]
    v_fmac_f32 v55, v59, v59
    v_sub_f32 v56, v32, v48
    v_mfma_f32_16x16x32_bf16 v[220:223], a[108:111], v[88:91], v[220:223]
    v_fmac_f32 v52, v56, v56
    v_sub_f32 v57, v33, v48
    v_fmac_f32_e64 v53, v57, v57
    v_mfma_f32_16x16x32_bf16 v[220:223], a[124:127], v[92:95], v[220:223]
    v_sub_f32 v58, v34, v48
    s_waitcnt lgkmcnt(0)
    v_mfma_f32_16x16x32_bf16 v[96:99], a[128:131], v[64:67], v[96:99]
    ds_read_b128 v[80:83], v224 offset:4096
    v_fmac_f32_e64 v54, v58, v58
    v_mfma_f32_16x16x32_bf16 v[96:99], a[144:147], v[68:71], v[96:99]
    ds_read_b128 v[84:87], v225 offset:4096
    v_sub_f32_e64 v59, v35, v48
    v_mfma_f32_16x16x32_bf16 v[100:103], a[132:135], v[64:67], v[100:103]
    ds_read_b128 v[88:91], v224 offset:6144
    v_fmac_f32_e64 v55, v59, v59
    v_mfma_f32_16x16x32_bf16 v[100:103], a[148:151], v[68:71], v[100:103]
    ds_read_b128 v[92:95], v225 offset:6144
    v_sub_f32 v56, v36, v48
    v_fmac_f32 v52, v56, v56
    v_mfma_f32_16x16x32_bf16 v[104:107], a[136:139], v[64:67], v[104:107]
    v_sub_f32 v57, v37, v48
    v_fmac_f32 v53, v57, v57
    v_mfma_f32_16x16x32_bf16 v[104:107], a[152:155], v[68:71], v[104:107]
    v_sub_f32 v58, v38, v48
    v_fmac_f32 v54, v58, v58
    v_mfma_f32_16x16x32_bf16 v[108:111], a[140:143], v[64:67], v[108:111]
    v_sub_f32 v59, v39, v48
    v_fmac_f32 v55, v59, v59
    v_sub_f32_e64 v56, v40, v48
    v_mfma_f32_16x16x32_bf16 v[108:111], a[156:159], v[68:71], v[108:111]
    v_fmac_f32 v52, v56, v56
    v_sub_f32 v57, v41, v48
    v_mfma_f32_16x16x32_bf16 v[112:115], a[128:131], v[72:75], v[112:115]
    s_add_u32 m0, s35, 4096
    s_add_u32 s33, s33, 131072
    buffer_load_dwordx4 v234, s[48:51], s33 offen lds
    v_mfma_f32_16x16x32_bf16 v[112:115], a[144:147], v[76:79], v[112:115]
    v_fmac_f32 v53, v57, v57
    v_sub_f32 v58, v42, v48
    v_mfma_f32_16x16x32_bf16 v[116:119], a[132:135], v[72:75], v[116:119]
    buffer_load_dwordx4 v235, s[48:51], s33 offen offset:1024 lds
    v_fmac_f32 v54, v58, v58
    v_sub_f32 v59, v43, v48
    v_mfma_f32_16x16x32_bf16 v[116:119], a[148:151], v[76:79], v[116:119]
    v_fmac_f32 v55, v59, v59
    v_sub_f32 v56, v44, v48
    v_mfma_f32_16x16x32_bf16 v[120:123], a[136:139], v[72:75], v[120:123]
    s_add_u32 m0, s35, 6144
    s_add_u32 s33, s33, 131072
    buffer_load_dwordx4 v234, s[48:51], s33 offen lds
    v_mfma_f32_16x16x32_bf16 v[120:123], a[152:155], v[76:79], v[120:123]
    v_fmac_f32 v52, v56, v56
    v_sub_f32 v57, v45, v48
    v_mfma_f32_16x16x32_bf16 v[124:127], a[140:143], v[72:75], v[124:127]
    buffer_load_dwordx4 v235, s[48:51], s33 offen offset:1024 lds
    v_fmac_f32 v53, v57, v57
    v_sub_f32 v58, v46, v48
    v_mfma_f32_16x16x32_bf16 v[124:127], a[156:159], v[76:79], v[124:127]
    v_fmac_f32 v54, v58, v58
    s_waitcnt lgkmcnt(0)
    v_mfma_f32_16x16x32_bf16 v[128:131], a[128:131], v[80:83], v[128:131]
    ds_read_b128 v[64:67], v224 offset:8192
    v_sub_f32_e64 v59, v47, v48
    v_mfma_f32_16x16x32_bf16 v[128:131], a[144:147], v[84:87], v[128:131]
    ds_read_b128 v[68:71], v225 offset:8192
    v_fmac_f32_e64 v55, v59, v59
    v_mfma_f32_16x16x32_bf16 v[132:135], a[132:135], v[80:83], v[132:135]
    ds_read_b128 v[72:75], v224 offset:10240
    v_add_f32_e64 v52, v52, v53
    v_mfma_f32_16x16x32_bf16 v[132:135], a[148:151], v[84:87], v[132:135]
    ds_read_b128 v[76:79], v225 offset:10240
    v_add_f32_e64 v54, v54, v55
    v_mfma_f32_16x16x32_bf16 v[136:139], a[136:139], v[80:83], v[136:139]
    v_add_f32 v51, v52, v54
    s_nop 1
    v_add_f32_dpp v51, v51, v51 quad_perm:[1,0,3,2] row_mask:0xf bank_mask:0xf
    v_mfma_f32_16x16x32_bf16 v[136:139], a[152:155], v[84:87], v[136:139]
    s_nop 1
    v_add_f32_dpp v51, v51, v51 quad_perm:[2,3,0,1] row_mask:0xf bank_mask:0xf
    v_mfma_f32_16x16x32_bf16 v[140:143], a[140:143], v[80:83], v[140:143]
    s_nop 1
    v_add_f32_dpp v51, v51, v51 row_half_mirror row_mask:0xf bank_mask:0xf
    s_nop 1
    v_mfma_f32_16x16x32_bf16 v[140:143], a[156:159], v[84:87], v[140:143]
    v_add_f32_dpp v51, v51, v51 row_mirror row_mask:0xf bank_mask:0xf
    s_nop 0
    v_mfma_f32_16x16x32_bf16 v[144:147], a[128:131], v[88:91], v[144:147]
    s_add_u32 m0, s34, 57344
    s_add_u32 s37, s87, 65536
    buffer_load_dwordx4 v232, s[44:47], s37 offen lds
    v_mfma_f32_16x16x32_bf16 v[144:147], a[144:147], v[92:95], v[144:147]
    v_mov_b32 v49, v51
    s_nop 1
    v_mfma_f32_16x16x32_bf16 v[148:151], a[132:135], v[88:91], v[148:151]
    buffer_load_dwordx4 v233, s[44:47], s37 offen offset:1024 lds
    v_permlane16_swap_b32 v51, v49
    s_nop 0
    v_mfma_f32_16x16x32_bf16 v[148:151], a[148:151], v[92:95], v[148:151]
    v_add_f32_e64 v51, v51, v49
    v_mul_f32 v51, 0x3a800000, v51
    v_mfma_f32_16x16x32_bf16 v[152:155], a[136:139], v[88:91], v[152:155]
    v_lshlrev_b32_e64 v227, 3, v240
    v_min_u32 v227, 1920, v227
    s_lshl2_add_u32 s25, s2, s3
    v_mfma_f32_16x16x32_bf16 v[152:155], a[152:155], v[92:95], v[152:155]
    v_cvt_pk_bf16_f32 v50, v48, v51
    v_and_b32 v51, 0xffff0000, v50
    v_mfma_f32_16x16x32_bf16 v[156:159], a[140:143], v[88:91], v[156:159]
    s_lshl_b32 s25, s25, 13
    s_add_u32 s25, s25, 2048
    buffer_load_dword v241, v227, s[12:15], s25 offen
    v_mfma_f32_16x16x32_bf16 v[156:159], a[156:159], v[92:95], v[156:159]
    v_lshlrev_b32 v50, 16, v50
    s_waitcnt vmcnt(16) lgkmcnt(0)
    v_mfma_f32_16x16x32_bf16 v[160:163], a[128:131], v[64:67], v[160:163]
    ds_read_b128 v[80:83], v224 offset:12288
    v_add_f32 v51, 0x3727c5ac, v51
    v_cvt_pk_bf16_f32 v51, v51, v51
    v_mfma_f32_16x16x32_bf16 v[160:163], a[144:147], v[68:71], v[160:163]
    ds_read_b128 v[84:87], v225 offset:12288
    v_lshlrev_b32_e64 v51, 16, v51
    v_mfma_f32_16x16x32_bf16 v[164:167], a[132:135], v[64:67], v[164:167]
    ds_read_b128 v[88:91], v224 offset:14336
    v_mfma_f32_16x16x32_bf16 v[164:167], a[148:151], v[68:71], v[164:167]
    ds_read_b128 v[92:95], v225 offset:14336
    v_sqrt_f32 v51, v51
    v_mfma_f32_16x16x32_bf16 v[168:171], a[136:139], v[64:67], v[168:171]
    ds_read_b64_tr_b16 a[160:161], v228 offset:16384
    s_nop 0
    v_mfma_f32_16x16x32_bf16 v[168:171], a[152:155], v[68:71], v[168:171]
    ds_read_b64_tr_b16 a[162:163], v228 offset:16896
    v_cvt_pk_bf16_f32 v51, v51, v51
    v_lshlrev_b32_e64 v51, 16, v51
    v_mfma_f32_16x16x32_bf16 v[172:175], a[140:143], v[64:67], v[172:175]
    ds_read_b64_tr_b16 a[164:165], v229 offset:16384
    v_mfma_f32_16x16x32_bf16 v[172:175], a[156:159], v[68:71], v[172:175]
    ds_read_b64_tr_b16 a[166:167], v229 offset:16896
    v_rcp_f32_e64 v51, v51
    v_mfma_f32_16x16x32_bf16 v[176:179], a[128:131], v[72:75], v[176:179]
    ds_read_b64_tr_b16 a[168:169], v230 offset:16384
    s_add_u32 m0, s35, 8192
    s_and_b32 s33, s87, 1023
    s_lshl_b32 s33, s33, 12
    buffer_load_dwordx4 v234, s[48:51], s33 offen lds
    v_mfma_f32_16x16x32_bf16 v[176:179], a[144:147], v[76:79], v[176:179]
    ds_read_b64_tr_b16 a[170:171], v230 offset:16896
    s_nop 0
    v_mfma_f32_16x16x32_bf16 v[180:183], a[132:135], v[72:75], v[180:183]
    ds_read_b64_tr_b16 a[172:173], v231 offset:16384
    buffer_load_dwordx4 v235, s[48:51], s33 offen offset:1024 lds
    v_mfma_f32_16x16x32_bf16 v[180:183], a[148:151], v[76:79], v[180:183]
    ds_read_b64_tr_b16 a[174:175], v231 offset:16896
    v_mul_f32 v51, 0x3e0293ee, v51
    v_mfma_f32_16x16x32_bf16 v[184:187], a[136:139], v[72:75], v[184:187]
    s_add_u32 m0, s35, 10240
    s_add_u32 s33, s33, 131072
    buffer_load_dwordx4 v234, s[48:51], s33 offen lds
    v_mfma_f32_16x16x32_bf16 v[184:187], a[152:155], v[76:79], v[184:187]
    v_sub_f32 v16, v16, v50
    v_sub_f32 v17, v17, v50
    v_cvt_pk_bf16_f32 v17, v16, v17
    v_mfma_f32_16x16x32_bf16 v[188:191], a[140:143], v[72:75], v[188:191]
    buffer_load_dwordx4 v235, s[48:51], s33 offen offset:1024 lds
    v_lshlrev_b32_e64 v16, 16, v17
    v_mfma_f32_16x16x32_bf16 v[188:191], a[156:159], v[76:79], v[188:191]
    s_waitcnt vmcnt(31) lgkmcnt(0)
    s_barrier
    v_mfma_f32_16x16x32_bf16 v[192:195], a[128:131], v[80:83], v[192:195]
    ds_read_b128 v[64:67], v224 offset:16384
    v_and_b32 v17, 0xffff0000, v17
    v_mfma_f32_16x16x32_bf16 v[192:195], a[144:147], v[84:87], v[192:195]
    ds_read_b128 v[68:71], v225 offset:16384
    v_mul_f32_e64 v16, v16, v51
    v_mfma_f32_16x16x32_bf16 v[196:199], a[132:135], v[80:83], v[196:199]
    ds_read_b128 v[72:75], v224 offset:18432
    v_mul_f32_e64 v17, v17, v51
    v_mfma_f32_16x16x32_bf16 v[196:199], a[148:151], v[84:87], v[196:199]
    ds_read_b128 v[76:79], v225 offset:18432
    v_cvt_pk_bf16_f32 v0, v16, v17
    v_sub_f32_e64 v18, v18, v50
    v_mfma_f32_16x16x32_bf16 v[200:203], a[136:139], v[80:83], v[200:203]
    ds_read_b64_tr_b16 a[176:177], v228 offset:20480
    v_sub_f32_e64 v19, v19, v50
    v_mfma_f32_16x16x32_bf16 v[200:203], a[152:155], v[84:87], v[200:203]
    ds_read_b64_tr_b16 a[178:179], v228 offset:20992
    v_cvt_pk_bf16_f32 v19, v18, v19
    v_mfma_f32_16x16x32_bf16 v[204:207], a[140:143], v[80:83], v[204:207]
    ds_read_b64_tr_b16 a[180:181], v229 offset:20480
    v_lshlrev_b32_e64 v18, 16, v19
    v_mfma_f32_16x16x32_bf16 v[204:207], a[156:159], v[84:87], v[204:207]
    ds_read_b64_tr_b16 a[182:183], v229 offset:20992
    v_and_b32 v19, 0xffff0000, v19
    v_mfma_f32_16x16x32_bf16 v[208:211], a[128:131], v[88:91], v[208:211]
    ds_read_b64_tr_b16 a[184:185], v230 offset:20480
    s_add_u32 m0, s34, 0
    s_add_u32 s37, s80, 131072
    buffer_load_dwordx4 v232, s[44:47], s37 offen lds
    v_mfma_f32_16x16x32_bf16 v[208:211], a[144:147], v[92:95], v[208:211]
    ds_read_b64_tr_b16 a[186:187], v230 offset:20992
    v_mul_f32 v18, v18, v51
    v_mfma_f32_16x16x32_bf16 v[212:215], a[132:135], v[88:91], v[212:215]
    ds_read_b64_tr_b16 a[188:189], v231 offset:20480
    v_mul_f32_e64 v19, v19, v51
    v_cvt_pk_bf16_f32 v1, v18, v19
    v_mfma_f32_16x16x32_bf16 v[212:215], a[148:151], v[92:95], v[212:215]
    ds_read_b64_tr_b16 a[190:191], v231 offset:20992
    v_sub_f32_e64 v20, v20, v50
    v_mfma_f32_16x16x32_bf16 v[216:219], a[136:139], v[88:91], v[216:219]
    buffer_load_dwordx4 v233, s[44:47], s37 offen offset:1024 lds
    v_sub_f32_e64 v21, v21, v50
    v_mfma_f32_16x16x32_bf16 v[216:219], a[152:155], v[92:95], v[216:219]
    v_cvt_pk_bf16_f32 v21, v20, v21
    v_lshlrev_b32_e64 v20, 16, v21
    v_mfma_f32_16x16x32_bf16 v[220:223], a[140:143], v[88:91], v[220:223]
    v_and_b32 v21, 0xffff0000, v21
    v_mul_f32 v20, v20, v51
    v_mul_f32 v21, v21, v51
    v_mfma_f32_16x16x32_bf16 v[220:223], a[156:159], v[92:95], v[220:223]
    v_cvt_pk_bf16_f32 v2, v20, v21
    s_waitcnt lgkmcnt(0)
    v_mfma_f32_16x16x32_bf16 v[96:99], a[160:163], v[64:67], v[96:99]
    ds_read_b128 v[80:83], v224 offset:20480
    v_sub_f32 v22, v22, v50
    v_mfma_f32_16x16x32_bf16 v[96:99], a[176:179], v[68:71], v[96:99]
    ds_read_b128 v[84:87], v225 offset:20480
    v_sub_f32_e64 v23, v23, v50
    v_mfma_f32_16x16x32_bf16 v[100:103], a[164:167], v[64:67], v[100:103]
    ds_read_b128 v[88:91], v224 offset:22528
    v_cvt_pk_bf16_f32 v23, v22, v23
    v_mfma_f32_16x16x32_bf16 v[100:103], a[180:183], v[68:71], v[100:103]
    ds_read_b128 v[92:95], v225 offset:22528
    v_lshlrev_b32_e64 v22, 16, v23
    v_and_b32 v23, 0xffff0000, v23
    v_mfma_f32_16x16x32_bf16 v[104:107], a[168:171], v[64:67], v[104:107]
    v_mul_f32 v22, v22, v51
    v_mul_f32 v23, v23, v51
    v_mfma_f32_16x16x32_bf16 v[104:107], a[184:187], v[68:71], v[104:107]
    v_cvt_pk_bf16_f32 v3, v22, v23
    v_sub_f32_e64 v24, v24, v50
    v_mfma_f32_16x16x32_bf16 v[108:111], a[172:175], v[64:67], v[108:111]
    v_sub_f32_e64 v25, v25, v50
    v_cvt_pk_bf16_f32 v25, v24, v25
    v_lshlrev_b32_e64 v24, 16, v25
    v_mfma_f32_16x16x32_bf16 v[108:111], a[188:191], v[68:71], v[108:111]
    v_and_b32 v25, 0xffff0000, v25
    v_mul_f32_e64 v24, v24, v51
    v_mfma_f32_16x16x32_bf16 v[112:115], a[160:163], v[72:75], v[112:115]
    s_add_u32 m0, s35, 12288
    s_add_u32 s33, s33, 131072
    buffer_load_dwordx4 v234, s[48:51], s33 offen lds
    v_mfma_f32_16x16x32_bf16 v[112:115], a[176:179], v[76:79], v[112:115]
    v_mul_f32_e64 v25, v25, v51
    v_cvt_pk_bf16_f32 v4, v24, v25
    v_mfma_f32_16x16x32_bf16 v[116:119], a[164:167], v[72:75], v[116:119]
    buffer_load_dwordx4 v235, s[48:51], s33 offen offset:1024 lds
    v_sub_f32 v26, v26, v50
    v_sub_f32 v27, v27, v50
    v_mfma_f32_16x16x32_bf16 v[116:119], a[180:183], v[76:79], v[116:119]
    v_cvt_pk_bf16_f32 v27, v26, v27
    v_lshlrev_b32_e64 v26, 16, v27
    v_mfma_f32_16x16x32_bf16 v[120:123], a[168:171], v[72:75], v[120:123]
    s_add_u32 m0, s35, 14336
    s_add_u32 s33, s33, 131072
    buffer_load_dwordx4 v234, s[48:51], s33 offen lds
    v_mfma_f32_16x16x32_bf16 v[120:123], a[184:187], v[76:79], v[120:123]
    v_and_b32 v27, 0xffff0000, v27
    v_mul_f32_e64 v26, v26, v51
    v_mfma_f32_16x16x32_bf16 v[124:127], a[172:175], v[72:75], v[124:127]
    buffer_load_dwordx4 v235, s[48:51], s33 offen offset:1024 lds
    v_mul_f32_e64 v27, v27, v51
    v_cvt_pk_bf16_f32 v5, v26, v27
    v_mfma_f32_16x16x32_bf16 v[124:127], a[188:191], v[76:79], v[124:127]
    v_sub_f32 v28, v28, v50
    s_waitcnt lgkmcnt(0)
    v_mfma_f32_16x16x32_bf16 v[128:131], a[160:163], v[80:83], v[128:131]
    ds_read_b128 v[64:67], v224 offset:24576
    v_sub_f32_e64 v29, v29, v50
    v_mfma_f32_16x16x32_bf16 v[128:131], a[176:179], v[84:87], v[128:131]
    ds_read_b128 v[68:71], v225 offset:24576
    v_cvt_pk_bf16_f32 v29, v28, v29
    v_mfma_f32_16x16x32_bf16 v[132:135], a[164:167], v[80:83], v[132:135]
    ds_read_b128 v[72:75], v224 offset:26624
    v_lshlrev_b32_e64 v28, 16, v29
    v_mfma_f32_16x16x32_bf16 v[132:135], a[180:183], v[84:87], v[132:135]
    ds_read_b128 v[76:79], v225 offset:26624
    v_and_b32 v29, 0xffff0000, v29
    v_mfma_f32_16x16x32_bf16 v[136:139], a[168:171], v[80:83], v[136:139]
    v_mul_f32 v28, v28, v51
    v_mul_f32 v29, v29, v51
    v_cvt_pk_bf16_f32 v6, v28, v29
    v_mfma_f32_16x16x32_bf16 v[136:139], a[184:187], v[84:87], v[136:139]
    v_sub_f32 v30, v30, v50
    v_sub_f32 v31, v31, v50
    v_mfma_f32_16x16x32_bf16 v[140:143], a[172:175], v[80:83], v[140:143]
    v_cvt_pk_bf16_f32 v31, v30, v31
    v_lshlrev_b32_e64 v30, 16, v31
    v_and_b32 v31, 0xffff0000, v31
    v_mfma_f32_16x16x32_bf16 v[140:143], a[188:191], v[84:87], v[140:143]
    v_mul_f32 v30, v30, v51
    v_mul_f32 v31, v31, v51
    v_mfma_f32_16x16x32_bf16 v[144:147], a[160:163], v[88:91], v[144:147]
    s_add_u32 m0, s34, 8192
    s_add_u32 s37, s81, 131072
    buffer_load_dwordx4 v232, s[44:47], s37 offen lds
    v_mfma_f32_16x16x32_bf16 v[144:147], a[176:179], v[92:95], v[144:147]
    v_cvt_pk_bf16_f32 v7, v30, v31
    v_sub_f32_e64 v32, v32, v50
    v_mfma_f32_16x16x32_bf16 v[148:151], a[164:167], v[88:91], v[148:151]
    buffer_load_dwordx4 v233, s[44:47], s37 offen offset:1024 lds
    v_sub_f32_e64 v33, v33, v50
    v_mfma_f32_16x16x32_bf16 v[148:151], a[180:183], v[92:95], v[148:151]
    v_cvt_pk_bf16_f32 v33, v32, v33
    v_lshlrev_b32_e64 v32, 16, v33
    v_and_b32 v33, 0xffff0000, v33
    v_mfma_f32_16x16x32_bf16 v[152:155], a[168:171], v[88:91], v[152:155]
    v_lshlrev_b32_e64 v227, 3, v240
    v_min_u32 v227, 1920, v227
    s_lshl2_add_u32 s25, s2, s3
    v_mfma_f32_16x16x32_bf16 v[152:155], a[184:187], v[92:95], v[152:155]
    v_mul_f32 v32, v32, v51
    v_mul_f32_e64 v33, v33, v51
    v_mfma_f32_16x16x32_bf16 v[156:159], a[172:175], v[88:91], v[156:159]
    s_lshl_b32 s25, s25, 13
    s_add_u32 s25, s25, 4096
    buffer_load_dword v241, v227, s[12:15], s25 offen
    v_mfma_f32_16x16x32_bf16 v[156:159], a[188:191], v[92:95], v[156:159]
    v_cvt_pk_bf16_f32 v8, v32, v33
    s_waitcnt vmcnt(16) lgkmcnt(0)
    v_mfma_f32_16x16x32_bf16 v[160:163], a[160:163], v[64:67], v[160:163]
    ds_read_b128 v[80:83], v224 offset:28672
    v_sub_f32 v34, v34, v50
    v_sub_f32 v35, v35, v50
    v_mfma_f32_16x16x32_bf16 v[160:163], a[176:179], v[68:71], v[160:163]
    ds_read_b128 v[84:87], v225 offset:28672
    v_cvt_pk_bf16_f32 v35, v34, v35
    v_mfma_f32_16x16x32_bf16 v[164:167], a[164:167], v[64:67], v[164:167]
    ds_read_b128 v[88:91], v224 offset:30720
    v_lshlrev_b32_e64 v34, 16, v35
    v_mfma_f32_16x16x32_bf16 v[164:167], a[180:183], v[68:71], v[164:167]
    ds_read_b128 v[92:95], v225 offset:30720
    v_and_b32 v35, 0xffff0000, v35
    v_mfma_f32_16x16x32_bf16 v[168:171], a[168:171], v[64:67], v[168:171]
    ds_read_b64_tr_b16 a[192:193], v228 offset:0
    v_mul_f32_e64 v34, v34, v51
    v_mfma_f32_16x16x32_bf16 v[168:171], a[184:187], v[68:71], v[168:171]
    ds_read_b64_tr_b16 a[194:195], v228 offset:512
    v_mul_f32_e64 v35, v35, v51
    v_cvt_pk_bf16_f32 v9, v34, v35
    v_mfma_f32_16x16x32_bf16 v[172:175], a[172:175], v[64:67], v[172:175]
    ds_read_b64_tr_b16 a[196:197], v229 offset:0
    v_sub_f32_e64 v36, v36, v50
    v_mfma_f32_16x16x32_bf16 v[172:175], a[188:191], v[68:71], v[172:175]
    ds_read_b64_tr_b16 a[198:199], v229 offset:512
    v_sub_f32_e64 v37, v37, v50
    v_mfma_f32_16x16x32_bf16 v[176:179], a[160:163], v[72:75], v[176:179]
    ds_read_b64_tr_b16 a[200:201], v230 offset:0
    v_cvt_pk_bf16_f32 v37, v36, v37
    v_mfma_f32_16x16x32_bf16 v[176:179], a[176:179], v[76:79], v[176:179]
    ds_read_b64_tr_b16 a[202:203], v230 offset:512
    v_lshlrev_b32_e64 v36, 16, v37
    v_mfma_f32_16x16x32_bf16 v[180:183], a[164:167], v[72:75], v[180:183]
    ds_read_b64_tr_b16 a[204:205], v231 offset:0
    v_and_b32 v37, 0xffff0000, v37
    v_mfma_f32_16x16x32_bf16 v[180:183], a[180:183], v[76:79], v[180:183]
    ds_read_b64_tr_b16 a[206:207], v231 offset:512
    v_mul_f32 v36, v36, v51
    v_mul_f32 v37, v37, v51
    v_mfma_f32_16x16x32_bf16 v[184:187], a[168:171], v[72:75], v[184:187]
    v_cvt_pk_bf16_f32 v10, v36, v37
    v_sub_f32_e64 v38, v38, v50
    v_mfma_f32_16x16x32_bf16 v[184:187], a[184:187], v[76:79], v[184:187]
    v_sub_f32_e64 v39, v39, v50
    v_cvt_pk_bf16_f32 v39, v38, v39
    v_mfma_f32_16x16x32_bf16 v[188:191], a[172:175], v[72:75], v[188:191]
    v_lshlrev_b32_e64 v38, 16, v39
    v_and_b32 v39, 0xffff0000, v39
    v_mul_f32_e64 v38, v38, v51
    v_mfma_f32_16x16x32_bf16 v[188:191], a[188:191], v[76:79], v[188:191]
    s_waitcnt vmcnt(27) lgkmcnt(0)
    s_barrier
    v_mfma_f32_16x16x32_bf16 v[192:195], a[160:163], v[80:83], v[192:195]
    ds_read_b128 v[64:67], v224 offset:32768
    v_mul_f32_e64 v39, v39, v51
    v_mfma_f32_16x16x32_bf16 v[192:195], a[176:179], v[84:87], v[192:195]
    ds_read_b128 v[68:71], v225 offset:32768
    v_cvt_pk_bf16_f32 v11, v38, v39
    v_mfma_f32_16x16x32_bf16 v[196:199], a[164:167], v[80:83], v[196:199]
    ds_read_b128 v[72:75], v224 offset:34816
    v_sub_f32_e64 v40, v40, v50
    v_mfma_f32_16x16x32_bf16 v[196:199], a[180:183], v[84:87], v[196:199]
    ds_read_b128 v[76:79], v225 offset:34816
    v_sub_f32_e64 v41, v41, v50
    v_mfma_f32_16x16x32_bf16 v[200:203], a[168:171], v[80:83], v[200:203]
    ds_read_b64_tr_b16 a[208:209], v228 offset:4096
    v_cvt_pk_bf16_f32 v41, v40, v41
    v_lshlrev_b32_e64 v40, 16, v41
    v_mfma_f32_16x16x32_bf16 v[200:203], a[184:187], v[84:87], v[200:203]
    ds_read_b64_tr_b16 a[210:211], v228 offset:4608
    v_and_b32 v41, 0xffff0000, v41
    v_mfma_f32_16x16x32_bf16 v[204:207], a[172:175], v[80:83], v[204:207]
    ds_read_b64_tr_b16 a[212:213], v229 offset:4096
    v_mul_f32_e64 v40, v40, v51
    v_mfma_f32_16x16x32_bf16 v[204:207], a[188:191], v[84:87], v[204:207]
    ds_read_b64_tr_b16 a[214:215], v229 offset:4608
    v_mul_f32_e64 v41, v41, v51
    v_mfma_f32_16x16x32_bf16 v[208:211], a[160:163], v[88:91], v[208:211]
    ds_read_b64_tr_b16 a[216:217], v230 offset:4096
    s_add_u32 m0, s34, 16384
    s_add_u32 s37, s82, 131072
    buffer_load_dwordx4 v232, s[44:47], s37 offen lds
    v_mfma_f32_16x16x32_bf16 v[208:211], a[176:179], v[92:95], v[208:211]
    ds_read_b64_tr_b16 a[218:219], v230 offset:4608
    v_cvt_pk_bf16_f32 v12, v40, v41
    v_mfma_f32_16x16x32_bf16 v[212:215], a[164:167], v[88:91], v[212:215]
    ds_read_b64_tr_b16 a[220:221], v231 offset:4096
    v_sub_f32 v42, v42, v50
    v_sub_f32 v43, v43, v50
    v_mfma_f32_16x16x32_bf16 v[212:215], a[180:183], v[92:95], v[212:215]
    ds_read_b64_tr_b16 a[222:223], v231 offset:4608
    v_cvt_pk_bf16_f32 v43, v42, v43
    v_mfma_f32_16x16x32_bf16 v[216:219], a[168:171], v[88:91], v[216:219]
    buffer_load_dwordx4 v233, s[44:47], s37 offen offset:1024 lds
    v_lshlrev_b32_e64 v42, 16, v43
    v_mfma_f32_16x16x32_bf16 v[216:219], a[184:187], v[92:95], v[216:219]
    v_and_b32 v43, 0xffff0000, v43
    v_mul_f32_e64 v42, v42, v51
    v_mfma_f32_16x16x32_bf16 v[220:223], a[172:175], v[88:91], v[220:223]
    v_mul_f32_e64 v43, v43, v51
    v_cvt_pk_bf16_f32 v13, v42, v43
    v_sub_f32_e64 v44, v44, v50
    v_mfma_f32_16x16x32_bf16 v[220:223], a[188:191], v[92:95], v[220:223]
    v_sub_f32 v45, v45, v50
    s_waitcnt lgkmcnt(0)
    v_mfma_f32_16x16x32_bf16 v[96:99], a[192:195], v[64:67], v[96:99]
    ds_read_b128 v[80:83], v224 offset:36864
    v_cvt_pk_bf16_f32 v45, v44, v45
    v_mfma_f32_16x16x32_bf16 v[96:99], a[208:211], v[68:71], v[96:99]
    ds_read_b128 v[84:87], v225 offset:36864
    v_lshlrev_b32_e64 v44, 16, v45
    v_mfma_f32_16x16x32_bf16 v[100:103], a[196:199], v[64:67], v[100:103]
    ds_read_b128 v[88:91], v224 offset:38912
    v_and_b32 v45, 0xffff0000, v45
    v_mfma_f32_16x16x32_bf16 v[100:103], a[212:215], v[68:71], v[100:103]
    ds_read_b128 v[92:95], v225 offset:38912
    v_mul_f32 v44, v44, v51
    v_mul_f32 v45, v45, v51
    v_mfma_f32_16x16x32_bf16 v[104:107], a[200:203], v[64:67], v[104:107]
    v_cvt_pk_bf16_f32 v14, v44, v45
    v_sub_f32_e64 v46, v46, v50
    v_mfma_f32_16x16x32_bf16 v[104:107], a[216:219], v[68:71], v[104:107]
    v_sub_f32_e64 v47, v47, v50
    v_cvt_pk_bf16_f32 v47, v46, v47
    v_mfma_f32_16x16x32_bf16 v[108:111], a[204:207], v[64:67], v[108:111]
    v_lshlrev_b32_e64 v46, 16, v47
    v_and_b32 v47, 0xffff0000, v47
    v_mul_f32_e64 v46, v46, v51
    v_mfma_f32_16x16x32_bf16 v[108:111], a[220:223], v[68:71], v[108:111]
    v_mul_f32_e64 v47, v47, v51
    v_cvt_pk_bf16_f32 v15, v46, v47
    v_mfma_f32_16x16x32_bf16 v[112:115], a[192:195], v[72:75], v[112:115]
    v_mfma_f32_16x16x32_bf16 v[112:115], a[208:211], v[76:79], v[112:115]
    ds_write_b128 v237, v[0:3] offset:0
    v_mfma_f32_16x16x32_bf16 v[116:119], a[196:199], v[72:75], v[116:119]
    ds_write_b128 v237, v[4:7] offset:4096
    v_mfma_f32_16x16x32_bf16 v[116:119], a[212:215], v[76:79], v[116:119]
    ds_write_b128 v237, v[8:11] offset:24576
    v_mfma_f32_16x16x32_bf16 v[120:123], a[200:203], v[72:75], v[120:123]
    ds_write_b128 v237, v[12:15] offset:28672
    v_mfma_f32_16x16x32_bf16 v[120:123], a[216:219], v[76:79], v[120:123]
    v_mfma_f32_16x16x32_bf16 v[124:127], a[204:207], v[72:75], v[124:127]
    v_mfma_f32_16x16x32_bf16 v[124:127], a[220:223], v[76:79], v[124:127]
    s_waitcnt lgkmcnt(0)
    v_mfma_f32_16x16x32_bf16 v[128:131], a[192:195], v[80:83], v[128:131]
    ds_read_b128 v[64:67], v224 offset:40960
    v_mfma_f32_16x16x32_bf16 v[128:131], a[208:211], v[84:87], v[128:131]
    ds_read_b128 v[68:71], v225 offset:40960
    v_mfma_f32_16x16x32_bf16 v[132:135], a[196:199], v[80:83], v[132:135]
    ds_read_b128 v[72:75], v224 offset:43008
    v_mfma_f32_16x16x32_bf16 v[132:135], a[212:215], v[84:87], v[132:135]
    ds_read_b128 v[76:79], v225 offset:43008
    v_mfma_f32_16x16x32_bf16 v[136:139], a[200:203], v[80:83], v[136:139]
    v_mfma_f32_16x16x32_bf16 v[136:139], a[216:219], v[84:87], v[136:139]
    v_mfma_f32_16x16x32_bf16 v[140:143], a[204:207], v[80:83], v[140:143]
    v_mfma_f32_16x16x32_bf16 v[140:143], a[220:223], v[84:87], v[140:143]
    v_mfma_f32_16x16x32_bf16 v[144:147], a[192:195], v[88:91], v[144:147]
    s_add_u32 m0, s34, 24576
    s_add_u32 s37, s83, 131072
    buffer_load_dwordx4 v232, s[44:47], s37 offen lds
    v_mfma_f32_16x16x32_bf16 v[144:147], a[208:211], v[92:95], v[144:147]
    buffer_load_dwordx4 v233, s[44:47], s37 offen offset:1024 lds
    v_mfma_f32_16x16x32_bf16 v[148:151], a[196:199], v[88:91], v[148:151]
    v_mfma_f32_16x16x32_bf16 v[148:151], a[212:215], v[92:95], v[148:151]
    v_lshlrev_b32 v227, 3, v240
    v_min_u32 v227, 1920, v227
    s_lshl2_add_u32 s25, s2, s3
    v_mfma_f32_16x16x32_bf16 v[152:155], a[200:203], v[88:91], v[152:155]
    s_lshl_b32 s25, s25, 13
    s_add_u32 s25, s25, 6144
    buffer_load_dword v241, v227, s[12:15], s25 offen
    v_mfma_f32_16x16x32_bf16 v[152:155], a[216:219], v[92:95], v[152:155]
    v_mfma_f32_16x16x32_bf16 v[156:159], a[204:207], v[88:91], v[156:159]
    buffer_load_dword v254, off, s[88:91], s97 sc1
    v_mfma_f32_16x16x32_bf16 v[156:159], a[220:223], v[92:95], v[156:159]
    s_waitcnt vmcnt(9) lgkmcnt(0)
    v_mfma_f32_16x16x32_bf16 v[160:163], a[192:195], v[64:67], v[160:163]
    ds_read_b128 v[80:83], v224 offset:45056
    v_mfma_f32_16x16x32_bf16 v[160:163], a[208:211], v[68:71], v[160:163]
    ds_read_b128 v[84:87], v225 offset:45056
    s_mul_i32 s38, s2, 100
    v_mfma_f32_16x16x32_bf16 v[164:167], a[196:199], v[64:67], v[164:167]
    ds_read_b128 v[88:91], v224 offset:47104
    v_mfma_f32_16x16x32_bf16 v[164:167], a[212:215], v[68:71], v[164:167]
    ds_read_b128 v[92:95], v225 offset:47104
    v_lshl_add_u32 v60, v253, 2, s38
    v_mfma_f32_16x16x32_bf16 v[168:171], a[200:203], v[64:67], v[168:171]
    ds_read_b64_tr_b16 a[224:225], v228 offset:8192
    v_mfma_f32_16x16x32_bf16 v[168:171], a[216:219], v[68:71], v[168:171]
    ds_read_b64_tr_b16 a[226:227], v228 offset:8704
    v_cmp_gt_u32 vcc, 25, v253
    v_mfma_f32_16x16x32_bf16 v[172:175], a[204:207], v[64:67], v[172:175]
    ds_read_b64_tr_b16 a[228:229], v229 offset:8192
    v_mfma_f32_16x16x32_bf16 v[172:175], a[220:223], v[68:71], v[172:175]
    ds_read_b64_tr_b16 a[230:231], v229 offset:8704
    v_mov_b32_e64 v61, 0
    v_mfma_f32_16x16x32_bf16 v[176:179], a[192:195], v[72:75], v[176:179]
    ds_read_b64_tr_b16 a[232:233], v230 offset:8192
    v_mfma_f32_16x16x32_bf16 v[176:179], a[208:211], v[76:79], v[176:179]
    ds_read_b64_tr_b16 a[234:235], v230 offset:8704
    v_mfma_f32_16x16x32_bf16 v[180:183], a[196:199], v[72:75], v[180:183]
    ds_read_b64_tr_b16 a[236:237], v231 offset:8192
    v_mov_b32 v62, 0x7ffffff0
    v_mfma_f32_16x16x32_bf16 v[180:183], a[212:215], v[76:79], v[180:183]
    ds_read_b64_tr_b16 a[238:239], v231 offset:8704
    v_mfma_f32_16x16x32_bf16 v[184:187], a[200:203], v[72:75], v[184:187]
    v_cndmask_b32 v60, v62, v60, vcc
    v_mfma_f32_16x16x32_bf16 v[184:187], a[216:219], v[76:79], v[184:187]
    buffer_store_dword v61, v60, s[56:59], 0 offen sc1
    v_mfma_f32_16x16x32_bf16 v[188:191], a[204:207], v[72:75], v[188:191]
    v_mfma_f32_16x16x32_bf16 v[188:191], a[220:223], v[76:79], v[188:191]
    s_waitcnt vmcnt(21) lgkmcnt(0)
    s_barrier
    v_mfma_f32_16x16x32_bf16 v[192:195], a[192:195], v[80:83], v[192:195]
    ds_read_b128 v[64:67], v224 offset:49152
    v_mfma_f32_16x16x32_bf16 v[192:195], a[208:211], v[84:87], v[192:195]
    ds_read_b128 v[68:71], v225 offset:49152
    v_mfma_f32_16x16x32_bf16 v[196:199], a[196:199], v[80:83], v[196:199]
    ds_read_b128 v[72:75], v224 offset:51200
    v_mfma_f32_16x16x32_bf16 v[196:199], a[212:215], v[84:87], v[196:199]
    ds_read_b128 v[76:79], v225 offset:51200
    v_mfma_f32_16x16x32_bf16 v[200:203], a[200:203], v[80:83], v[200:203]
    ds_read_b64_tr_b16 a[240:241], v228 offset:12288
    v_mfma_f32_16x16x32_bf16 v[200:203], a[216:219], v[84:87], v[200:203]
    ds_read_b64_tr_b16 a[242:243], v228 offset:12800
    v_mfma_f32_16x16x32_bf16 v[204:207], a[204:207], v[80:83], v[204:207]
    ds_read_b64_tr_b16 a[244:245], v229 offset:12288
    v_mfma_f32_16x16x32_bf16 v[204:207], a[220:223], v[84:87], v[204:207]
    ds_read_b64_tr_b16 a[246:247], v229 offset:12800
    v_mfma_f32_16x16x32_bf16 v[208:211], a[192:195], v[88:91], v[208:211]
    ds_read_b64_tr_b16 a[248:249], v230 offset:12288
    v_lshlrev_b32 v237, 4, v253
    v_add_u32 v237, 81920, v237
    ds_read_b128 v[16:19], v237 offset:0
    ds_read_b128 v[20:23], v237 offset:4096
    ds_read_b128 v[24:27], v237 offset:24576
    ds_read_b128 v[28:31], v237 offset:28672
    s_add_u32 m0, s34, 32768
    s_add_u32 s37, s84, 131072
    buffer_load_dwordx4 v232, s[44:47], s37 offen lds
    v_mfma_f32_16x16x32_bf16 v[208:211], a[208:211], v[92:95], v[208:211]
    ds_read_b64_tr_b16 a[250:251], v230 offset:12800
    v_mfma_f32_16x16x32_bf16 v[212:215], a[196:199], v[88:91], v[212:215]
    ds_read_b64_tr_b16 a[252:253], v231 offset:12288
    v_mfma_f32_16x16x32_bf16 v[212:215], a[212:215], v[92:95], v[212:215]
    ds_read_b64_tr_b16 a[254:255], v231 offset:12800
    v_mfma_f32_16x16x32_bf16 v[216:219], a[200:203], v[88:91], v[216:219]
    buffer_load_dwordx4 v233, s[44:47], s37 offen offset:1024 lds
    v_mfma_f32_16x16x32_bf16 v[216:219], a[216:219], v[92:95], v[216:219]
    v_mfma_f32_16x16x32_bf16 v[220:223], a[204:207], v[88:91], v[220:223]
    v_mfma_f32_16x16x32_bf16 v[220:223], a[220:223], v[92:95], v[220:223]
    s_waitcnt lgkmcnt(0)
    v_mfma_f32_16x16x32_bf16 v[96:99], a[224:227], v[64:67], v[96:99]
    ds_read_b128 v[80:83], v224 offset:53248
    v_mfma_f32_16x16x32_bf16 v[96:99], a[240:243], v[68:71], v[96:99]
    ds_read_b128 v[84:87], v225 offset:53248
    v_mfma_f32_16x16x32_bf16 v[100:103], a[228:231], v[64:67], v[100:103]
    ds_read_b128 v[88:91], v224 offset:55296
    v_mfma_f32_16x16x32_bf16 v[100:103], a[244:247], v[68:71], v[100:103]
    ds_read_b128 v[92:95], v225 offset:55296
    v_mfma_f32_16x16x32_bf16 v[104:107], a[232:235], v[64:67], v[104:107]
    v_mfma_f32_16x16x32_bf16 v[104:107], a[248:251], v[68:71], v[104:107]
    s_mov_b32 s39, 0
    buffer_store_dwordx4 v[16:19], v238, s[8:11], s39 offen sc1
    v_mfma_f32_16x16x32_bf16 v[108:111], a[236:239], v[64:67], v[108:111]
    v_mfma_f32_16x16x32_bf16 v[108:111], a[252:255], v[68:71], v[108:111]
    v_mfma_f32_16x16x32_bf16 v[112:115], a[224:227], v[72:75], v[112:115]
    v_mfma_f32_16x16x32_bf16 v[112:115], a[240:243], v[76:79], v[112:115]
    v_mfma_f32_16x16x32_bf16 v[116:119], a[228:231], v[72:75], v[116:119]
    v_mfma_f32_16x16x32_bf16 v[116:119], a[244:247], v[76:79], v[116:119]
    v_mfma_f32_16x16x32_bf16 v[120:123], a[232:235], v[72:75], v[120:123]
    v_mfma_f32_16x16x32_bf16 v[120:123], a[248:251], v[76:79], v[120:123]
    s_mov_b32 s39, 8192
    buffer_store_dwordx4 v[20:23], v238, s[8:11], s39 offen sc1
    v_mfma_f32_16x16x32_bf16 v[124:127], a[236:239], v[72:75], v[124:127]
    v_mfma_f32_16x16x32_bf16 v[124:127], a[252:255], v[76:79], v[124:127]
    s_waitcnt lgkmcnt(0)
    v_mfma_f32_16x16x32_bf16 v[128:131], a[224:227], v[80:83], v[128:131]
    ds_read_b128 v[64:67], v224 offset:57344
    v_mfma_f32_16x16x32_bf16 v[128:131], a[240:243], v[84:87], v[128:131]
    ds_read_b128 v[68:71], v225 offset:57344
    v_mfma_f32_16x16x32_bf16 v[132:135], a[228:231], v[80:83], v[132:135]
    ds_read_b128 v[72:75], v224 offset:59392
    v_mfma_f32_16x16x32_bf16 v[132:135], a[244:247], v[84:87], v[132:135]
    ds_read_b128 v[76:79], v225 offset:59392
    v_mfma_f32_16x16x32_bf16 v[136:139], a[232:235], v[80:83], v[136:139]
    v_mfma_f32_16x16x32_bf16 v[136:139], a[248:251], v[84:87], v[136:139]
    s_mov_b32 s39, 16384
    buffer_store_dwordx4 v[24:27], v238, s[8:11], s39 offen sc1
    v_mfma_f32_16x16x32_bf16 v[140:143], a[236:239], v[80:83], v[140:143]
    v_mfma_f32_16x16x32_bf16 v[140:143], a[252:255], v[84:87], v[140:143]
    v_mfma_f32_16x16x32_bf16 v[144:147], a[224:227], v[88:91], v[144:147]
    s_add_u32 m0, s34, 40960
    s_add_u32 s37, s85, 131072
    buffer_load_dwordx4 v232, s[44:47], s37 offen lds
    v_mfma_f32_16x16x32_bf16 v[144:147], a[240:243], v[92:95], v[144:147]
    v_mfma_f32_16x16x32_bf16 v[148:151], a[228:231], v[88:91], v[148:151]
    v_mfma_f32_16x16x32_bf16 v[148:151], a[244:247], v[92:95], v[148:151]
    v_mfma_f32_16x16x32_bf16 v[152:155], a[232:235], v[88:91], v[152:155]
    buffer_load_dwordx4 v233, s[44:47], s37 offen offset:1024 lds
    v_mfma_f32_16x16x32_bf16 v[152:155], a[248:251], v[92:95], v[152:155]
    s_mov_b32 s39, 24576
    buffer_store_dwordx4 v[28:31], v238, s[8:11], s39 offen sc1
    v_mfma_f32_16x16x32_bf16 v[156:159], a[236:239], v[88:91], v[156:159]
    v_mfma_f32_16x16x32_bf16 v[156:159], a[252:255], v[92:95], v[156:159]
    s_waitcnt lgkmcnt(0)
    v_mfma_f32_16x16x32_bf16 v[160:163], a[224:227], v[64:67], v[160:163]
    ds_read_b128 v[80:83], v224 offset:61440
    v_mfma_f32_16x16x32_bf16 v[160:163], a[240:243], v[68:71], v[160:163]
    ds_read_b128 v[84:87], v225 offset:61440
    v_mfma_f32_16x16x32_bf16 v[164:167], a[228:231], v[64:67], v[164:167]
    ds_read_b128 v[88:91], v224 offset:63488
    v_mfma_f32_16x16x32_bf16 v[164:167], a[244:247], v[68:71], v[164:167]
    ds_read_b128 v[92:95], v225 offset:63488
    v_mfma_f32_16x16x32_bf16 v[168:171], a[232:235], v[64:67], v[168:171]
    v_mfma_f32_16x16x32_bf16 v[168:171], a[248:251], v[68:71], v[168:171]
    v_mfma_f32_16x16x32_bf16 v[172:175], a[236:239], v[64:67], v[172:175]
    v_mfma_f32_16x16x32_bf16 v[172:175], a[252:255], v[68:71], v[172:175]
    v_mfma_f32_16x16x32_bf16 v[176:179], a[224:227], v[72:75], v[176:179]
    v_mfma_f32_16x16x32_bf16 v[176:179], a[240:243], v[76:79], v[176:179]
    v_cvt_pk_bf16_f32 v0, v96, v97
    v_cvt_pk_bf16_f32 v1, v98, v99
    v_mfma_f32_16x16x32_bf16 v[180:183], a[228:231], v[72:75], v[180:183]
    v_cvt_pk_bf16_f32 v2, v100, v101
    v_cvt_pk_bf16_f32 v3, v102, v103
    v_mfma_f32_16x16x32_bf16 v[180:183], a[244:247], v[76:79], v[180:183]
    v_cvt_pk_bf16_f32 v4, v104, v105
    v_cvt_pk_bf16_f32 v5, v106, v107
    v_mfma_f32_16x16x32_bf16 v[184:187], a[232:235], v[72:75], v[184:187]
    v_cvt_pk_bf16_f32 v6, v108, v109
    v_cvt_pk_bf16_f32 v7, v110, v111
    v_mfma_f32_16x16x32_bf16 v[184:187], a[248:251], v[76:79], v[184:187]
    v_cvt_pk_bf16_f32 v8, v112, v113
    v_cvt_pk_bf16_f32 v9, v114, v115
    v_mfma_f32_16x16x32_bf16 v[188:191], a[236:239], v[72:75], v[188:191]
    v_cvt_pk_bf16_f32 v10, v116, v117
    v_cvt_pk_bf16_f32 v11, v118, v119
    v_mfma_f32_16x16x32_bf16 v[188:191], a[252:255], v[76:79], v[188:191]
    v_cvt_pk_bf16_f32 v12, v120, v121
    v_cvt_pk_bf16_f32 v13, v122, v123
    s_waitcnt vmcnt(16) lgkmcnt(0)
    s_barrier
    v_mfma_f32_16x16x32_bf16 v[192:195], a[224:227], v[80:83], v[192:195]
    ds_read_b128 v[64:67], v224 offset:0
    v_cvt_pk_bf16_f32 v14, v124, v125
    v_cvt_pk_bf16_f32 v15, v126, v127
    v_mfma_f32_16x16x32_bf16 v[192:195], a[240:243], v[84:87], v[192:195]
    ds_read_b128 v[68:71], v225 offset:0
    v_cvt_pk_bf16_f32 v16, v128, v129
    v_cvt_pk_bf16_f32 v17, v130, v131
    v_mfma_f32_16x16x32_bf16 v[196:199], a[228:231], v[80:83], v[196:199]
    ds_read_b128 v[72:75], v224 offset:8192
    v_cvt_pk_bf16_f32 v18, v132, v133
    v_cvt_pk_bf16_f32 v19, v134, v135
    v_mfma_f32_16x16x32_bf16 v[196:199], a[244:247], v[84:87], v[196:199]
    ds_read_b128 v[76:79], v225 offset:8192
    v_cvt_pk_bf16_f32 v20, v136, v137
    v_cvt_pk_bf16_f32 v21, v138, v139
    v_mfma_f32_16x16x32_bf16 v[200:203], a[232:235], v[80:83], v[200:203]
    v_cvt_pk_bf16_f32 v22, v140, v141
    v_cvt_pk_bf16_f32 v23, v142, v143
    v_mfma_f32_16x16x32_bf16 v[200:203], a[248:251], v[84:87], v[200:203]
    v_cvt_pk_bf16_f32 v24, v144, v145
    v_cvt_pk_bf16_f32 v25, v146, v147
    v_mfma_f32_16x16x32_bf16 v[204:207], a[236:239], v[80:83], v[204:207]
    v_cvt_pk_bf16_f32 v26, v148, v149
    v_cvt_pk_bf16_f32 v27, v150, v151
    v_mfma_f32_16x16x32_bf16 v[204:207], a[252:255], v[84:87], v[204:207]
    v_cvt_pk_bf16_f32 v28, v152, v153
    v_cvt_pk_bf16_f32 v29, v154, v155
    v_mfma_f32_16x16x32_bf16 v[208:211], a[224:227], v[88:91], v[208:211]
    s_add_u32 m0, s34, 49152
    s_add_u32 s37, s86, 131072
    buffer_load_dwordx4 v232, s[44:47], s37 offen lds
    v_cvt_pk_bf16_f32 v30, v156, v157
    v_cvt_pk_bf16_f32 v31, v158, v159
    v_mfma_f32_16x16x32_bf16 v[208:211], a[240:243], v[92:95], v[208:211]
    v_cvt_pk_bf16_f32 v32, v160, v161
    v_cvt_pk_bf16_f32 v33, v162, v163
    v_mfma_f32_16x16x32_bf16 v[212:215], a[228:231], v[88:91], v[212:215]
    v_cvt_pk_bf16_f32 v34, v164, v165
    v_cvt_pk_bf16_f32 v35, v166, v167
    v_mfma_f32_16x16x32_bf16 v[212:215], a[244:247], v[92:95], v[212:215]
    v_cvt_pk_bf16_f32 v36, v168, v169
    v_cvt_pk_bf16_f32 v37, v170, v171
    v_mfma_f32_16x16x32_bf16 v[216:219], a[232:235], v[88:91], v[216:219]
    buffer_load_dwordx4 v233, s[44:47], s37 offen offset:1024 lds
    v_cvt_pk_bf16_f32 v38, v172, v173
    v_cvt_pk_bf16_f32 v39, v174, v175
    v_mfma_f32_16x16x32_bf16 v[216:219], a[248:251], v[92:95], v[216:219]
    v_cvt_pk_bf16_f32 v40, v176, v177
    v_cvt_pk_bf16_f32 v41, v178, v179
    v_mfma_f32_16x16x32_bf16 v[220:223], a[236:239], v[88:91], v[220:223]
    v_cvt_pk_bf16_f32 v42, v180, v181
    v_cvt_pk_bf16_f32 v43, v182, v183
    v_mfma_f32_16x16x32_bf16 v[220:223], a[252:255], v[92:95], v[220:223]
    v_cvt_pk_bf16_f32 v44, v184, v185
    v_cvt_pk_bf16_f32 v45, v186, v187
    s_waitcnt lgkmcnt(0)
    v_mfma_f32_16x16x32_bf16 v[96:99], a[0:3], v[64:67], 0
    ds_read_b128 v[80:83], v224 offset:2048
    v_cvt_pk_bf16_f32 v46, v188, v189
    v_cvt_pk_bf16_f32 v47, v190, v191
    v_mfma_f32_16x16x32_bf16 v[96:99], a[16:19], v[68:71], v[96:99]
    ds_read_b128 v[84:87], v225 offset:2048
    v_cvt_pk_bf16_f32 v48, v192, v193
    v_cvt_pk_bf16_f32 v49, v194, v195
    v_mfma_f32_16x16x32_bf16 v[96:99], a[32:35], v[72:75], v[96:99]
    ds_read_b128 v[88:91], v224 offset:10240
    v_cvt_pk_bf16_f32 v50, v196, v197
    v_cvt_pk_bf16_f32 v51, v198, v199
    v_mfma_f32_16x16x32_bf16 v[96:99], a[48:51], v[76:79], v[96:99]
    ds_read_b128 v[92:95], v225 offset:10240
    v_cvt_pk_bf16_f32 v52, v200, v201
    v_cvt_pk_bf16_f32 v53, v202, v203
    v_mfma_f32_16x16x32_bf16 v[100:103], a[4:7], v[64:67], 0
    v_cvt_pk_bf16_f32 v54, v204, v205
    v_cvt_pk_bf16_f32 v55, v206, v207
    s_add_u32 s38, s36, 0
    buffer_store_dwordx4 v[0:3], v240, s[16:19], s38 offen offset:0 sc1
    v_mfma_f32_16x16x32_bf16 v[100:103], a[20:23], v[68:71], v[100:103]
    v_cvt_pk_bf16_f32 v56, v208, v209
    v_cvt_pk_bf16_f32 v57, v210, v211
    v_mfma_f32_16x16x32_bf16 v[100:103], a[36:39], v[72:75], v[100:103]
    v_cvt_pk_bf16_f32 v58, v212, v213
    v_cvt_pk_bf16_f32 v59, v214, v215
    v_mfma_f32_16x16x32_bf16 v[100:103], a[52:55], v[76:79], v[100:103]
    v_cvt_pk_bf16_f32 v60, v216, v217
    v_cvt_pk_bf16_f32 v61, v218, v219
    v_mfma_f32_16x16x32_bf16 v[104:107], a[8:11], v[64:67], 0
    v_xor_b32 v237, 16, v245
    v_xor_b32 v238, 16, v246
    v_cvt_pk_bf16_f32 v62, v220, v221
    v_cvt_pk_bf16_f32 v63, v222, v223
    v_mfma_f32_16x16x32_bf16 v[104:107], a[24:27], v[68:71], v[104:107]
    v_mfma_f32_16x16x32_bf16 v[104:107], a[40:43], v[72:75], v[104:107]
    v_mfma_f32_16x16x32_bf16 v[104:107], a[56:59], v[76:79], v[104:107]
    v_mfma_f32_16x16x32_bf16 v[108:111], a[12:15], v[64:67], 0
    v_mfma_f32_16x16x32_bf16 v[108:111], a[28:31], v[68:71], v[108:111]
    v_mfma_f32_16x16x32_bf16 v[108:111], a[44:47], v[72:75], v[108:111]
    v_mfma_f32_16x16x32_bf16 v[108:111], a[60:63], v[76:79], v[108:111]
    s_waitcnt lgkmcnt(0)
    v_mfma_f32_16x16x32_bf16 v[112:115], a[0:3], v[80:83], 0
    ds_read_b128 v[64:67], v224 offset:4096
    v_mfma_f32_16x16x32_bf16 v[112:115], a[16:19], v[84:87], v[112:115]
    ds_read_b128 v[68:71], v225 offset:4096
    v_mfma_f32_16x16x32_bf16 v[112:115], a[32:35], v[88:91], v[112:115]
    ds_read_b128 v[72:75], v224 offset:12288
    v_mfma_f32_16x16x32_bf16 v[112:115], a[48:51], v[92:95], v[112:115]
    ds_read_b128 v[76:79], v225 offset:12288
    v_mfma_f32_16x16x32_bf16 v[116:119], a[4:7], v[80:83], 0
    v_mfma_f32_16x16x32_bf16 v[116:119], a[20:23], v[84:87], v[116:119]
    v_mfma_f32_16x16x32_bf16 v[116:119], a[36:39], v[88:91], v[116:119]
    v_mfma_f32_16x16x32_bf16 v[116:119], a[52:55], v[92:95], v[116:119]
    v_mfma_f32_16x16x32_bf16 v[120:123], a[8:11], v[80:83], 0
    s_add_u32 m0, s34, 57344
    s_add_u32 s37, s87, 131072
    buffer_load_dwordx4 v232, s[44:47], s37 offen lds
    v_mfma_f32_16x16x32_bf16 v[120:123], a[24:27], v[84:87], v[120:123]
    s_add_u32 s38, s36, 0
    buffer_store_dwordx4 v[4:7], v240, s[16:19], s38 offen offset:2048 sc1
    v_mfma_f32_16x16x32_bf16 v[120:123], a[40:43], v[88:91], v[120:123]
    v_mfma_f32_16x16x32_bf16 v[120:123], a[56:59], v[92:95], v[120:123]
    v_mfma_f32_16x16x32_bf16 v[124:127], a[12:15], v[80:83], 0
    buffer_load_dwordx4 v233, s[44:47], s37 offen offset:1024 lds
    v_mfma_f32_16x16x32_bf16 v[124:127], a[28:31], v[84:87], v[124:127]
    v_mfma_f32_16x16x32_bf16 v[124:127], a[44:47], v[88:91], v[124:127]
    v_mfma_f32_16x16x32_bf16 v[124:127], a[60:63], v[92:95], v[124:127]
    s_waitcnt lgkmcnt(0)
    v_mfma_f32_16x16x32_bf16 v[128:131], a[0:3], v[64:67], 0
    ds_read_b128 v[80:83], v224 offset:6144
    v_mfma_f32_16x16x32_bf16 v[128:131], a[16:19], v[68:71], v[128:131]
    ds_read_b128 v[84:87], v225 offset:6144
    v_mfma_f32_16x16x32_bf16 v[128:131], a[32:35], v[72:75], v[128:131]
    ds_read_b128 v[88:91], v224 offset:14336
    v_mfma_f32_16x16x32_bf16 v[128:131], a[48:51], v[76:79], v[128:131]
    ds_read_b128 v[92:95], v225 offset:14336
    v_mfma_f32_16x16x32_bf16 v[132:135], a[4:7], v[64:67], 0
    v_mfma_f32_16x16x32_bf16 v[132:135], a[20:23], v[68:71], v[132:135]
    v_mfma_f32_16x16x32_bf16 v[132:135], a[36:39], v[72:75], v[132:135]
    v_mfma_f32_16x16x32_bf16 v[132:135], a[52:55], v[76:79], v[132:135]
    v_mfma_f32_16x16x32_bf16 v[136:139], a[8:11], v[64:67], 0
    s_waitcnt vmcnt(15)
    v_readfirstlane_b32 s24, v254
    s_lshl_b32 s25, s3, 16
    s_add_u32 s24, s24, s25
    s_cmp_ge_u32 s24, 1
    s_cbranch_scc0 kf_spin31
kf_spinr32:
    v_mfma_f32_16x16x32_bf16 v[136:139], a[24:27], v[68:71], v[136:139]
    v_mfma_f32_16x16x32_bf16 v[136:139], a[40:43], v[72:75], v[136:139]
    v_mfma_f32_16x16x32_bf16 v[136:139], a[56:59], v[76:79], v[136:139]
    v_mfma_f32_16x16x32_bf16 v[140:143], a[12:15], v[64:67], 0
    s_add_u32 s88, s20, 0x14a0000
    s_addc_u32 s89, s21, 0
    s_mov_b32 s90, 20480
    v_mfma_f32_16x16x32_bf16 v[140:143], a[28:31], v[68:71], v[140:143]
    v_mfma_f32_16x16x32_bf16 v[140:143], a[44:47], v[72:75], v[140:143]
    v_mfma_f32_16x16x32_bf16 v[140:143], a[60:63], v[76:79], v[140:143]
    s_add_u32 s38, s36, 0
    buffer_store_dwordx4 v[8:11], v240, s[16:19], s38 offen offset:1024 sc1
    s_waitcnt vmcnt(7) lgkmcnt(0)
    s_barrier
    v_mfma_f32_16x16x32_bf16 v[144:147], a[0:3], v[80:83], 0
    ds_read_b128 v[64:67], v224 offset:16384
    v_mfma_f32_16x16x32_bf16 v[144:147], a[16:19], v[84:87], v[144:147]
    ds_read_b128 v[68:71], v225 offset:16384
    v_mfma_f32_16x16x32_bf16 v[144:147], a[32:35], v[88:91], v[144:147]
    ds_read_b128 v[72:75], v224 offset:24576
    v_mfma_f32_16x16x32_bf16 v[144:147], a[48:51], v[92:95], v[144:147]
    ds_read_b128 v[76:79], v225 offset:24576
    v_mfma_f32_16x16x32_bf16 v[148:151], a[4:7], v[80:83], 0
    v_mfma_f32_16x16x32_bf16 v[148:151], a[20:23], v[84:87], v[148:151]
    v_mfma_f32_16x16x32_bf16 v[148:151], a[36:39], v[88:91], v[148:151]
    v_mfma_f32_16x16x32_bf16 v[148:151], a[52:55], v[92:95], v[148:151]
    v_mfma_f32_16x16x32_bf16 v[152:155], a[8:11], v[80:83], 0
    s_add_u32 m0, s34, 0
    s_add_u32 s37, s80, 196608
    buffer_load_dwordx4 v232, s[44:47], s37 offen lds
    v_mfma_f32_16x16x32_bf16 v[152:155], a[24:27], v[84:87], v[152:155]
    v_mfma_f32_16x16x32_bf16 v[152:155], a[40:43], v[88:91], v[152:155]
    buffer_load_dwordx4 v233, s[44:47], s37 offen offset:1024 lds
    v_mfma_f32_16x16x32_bf16 v[152:155], a[56:59], v[92:95], v[152:155]
    v_mfma_f32_16x16x32_bf16 v[156:159], a[12:15], v[80:83], 0
    v_mfma_f32_16x16x32_bf16 v[156:159], a[28:31], v[84:87], v[156:159]
    s_lshl_b32 s39, s5, 7
    s_add_u32 s39, s39, 8192
    buffer_atomic_add v255, v250, s[88:91], s39 offen sc1
    s_cmp_eq_u32 s3, 0
    s_cselect_b32 s39, s39, s43
    v_mfma_f32_16x16x32_bf16 v[156:159], a[44:47], v[88:91], v[156:159]
    v_mfma_f32_16x16x32_bf16 v[156:159], a[60:63], v[92:95], v[156:159]
    s_waitcnt lgkmcnt(0)
    v_mfma_f32_16x16x32_bf16 v[96:99], a[64:67], v[64:67], v[96:99]
    ds_read_b128 v[80:83], v224 offset:18432
    v_mfma_f32_16x16x32_bf16 v[96:99], a[80:83], v[68:71], v[96:99]
    ds_read_b128 v[84:87], v225 offset:18432
    v_mfma_f32_16x16x32_bf16 v[96:99], a[96:99], v[72:75], v[96:99]
    ds_read_b128 v[88:91], v224 offset:26624
    v_mfma_f32_16x16x32_bf16 v[96:99], a[112:115], v[76:79], v[96:99]
    ds_read_b128 v[92:95], v225 offset:26624
    v_mfma_f32_16x16x32_bf16 v[100:103], a[68:71], v[64:67], v[100:103]
    s_add_u32 s38, s36, 0
    buffer_store_dwordx4 v[12:15], v240, s[16:19], s38 offen offset:3072 sc1
    v_mfma_f32_16x16x32_bf16 v[100:103], a[84:87], v[68:71], v[100:103]
    v_mfma_f32_16x16x32_bf16 v[100:103], a[100:103], v[72:75], v[100:103]
    v_mfma_f32_16x16x32_bf16 v[100:103], a[116:119], v[76:79], v[100:103]
    v_mfma_f32_16x16x32_bf16 v[104:107], a[72:75], v[64:67], v[104:107]
    s_add_u32 m0, s31, 0
    s_add_u32 s24, s27, 0
    buffer_load_dwordx4 v245, s[12:15], s24 offen lds
    v_mfma_f32_16x16x32_bf16 v[104:107], a[88:91], v[68:71], v[104:107]
    v_mfma_f32_16x16x32_bf16 v[104:107], a[104:107], v[72:75], v[104:107]
    v_mfma_f32_16x16x32_bf16 v[104:107], a[120:123], v[76:79], v[104:107]
    v_mfma_f32_16x16x32_bf16 v[108:111], a[76:79], v[64:67], v[108:111]
    v_mfma_f32_16x16x32_bf16 v[108:111], a[92:95], v[68:71], v[108:111]
    v_mfma_f32_16x16x32_bf16 v[108:111], a[108:111], v[72:75], v[108:111]
    v_mfma_f32_16x16x32_bf16 v[108:111], a[124:127], v[76:79], v[108:111]
    s_waitcnt lgkmcnt(0)
    v_mfma_f32_16x16x32_bf16 v[112:115], a[64:67], v[80:83], v[112:115]
    ds_read_b128 v[64:67], v224 offset:20480
    v_mfma_f32_16x16x32_bf16 v[112:115], a[80:83], v[84:87], v[112:115]
    ds_read_b128 v[68:71], v225 offset:20480
    v_mfma_f32_16x16x32_bf16 v[112:115], a[96:99], v[88:91], v[112:115]
    ds_read_b128 v[72:75], v224 offset:28672
    v_mfma_f32_16x16x32_bf16 v[112:115], a[112:115], v[92:95], v[112:115]
    ds_read_b128 v[76:79], v225 offset:28672
    v_mfma_f32_16x16x32_bf16 v[116:119], a[68:71], v[80:83], v[116:119]
    v_mfma_f32_16x16x32_bf16 v[116:119], a[84:87], v[84:87], v[116:119]
    v_mfma_f32_16x16x32_bf16 v[116:119], a[100:103], v[88:91], v[116:119]
    v_mfma_f32_16x16x32_bf16 v[116:119], a[116:119], v[92:95], v[116:119]
    v_mfma_f32_16x16x32_bf16 v[120:123], a[72:75], v[80:83], v[120:123]
    s_add_u32 m0, s34, 8192
    s_add_u32 s37, s81, 196608
    buffer_load_dwordx4 v232, s[44:47], s37 offen lds
    v_mfma_f32_16x16x32_bf16 v[120:123], a[88:91], v[84:87], v[120:123]
    v_mfma_f32_16x16x32_bf16 v[120:123], a[104:107], v[88:91], v[120:123]
    buffer_load_dwordx4 v233, s[44:47], s37 offen offset:1024 lds
    s_add_u32 s38, s36, 8192
    buffer_store_dwordx4 v[16:19], v240, s[16:19], s38 offen offset:0 sc1
    v_mfma_f32_16x16x32_bf16 v[120:123], a[120:123], v[92:95], v[120:123]
    v_mfma_f32_16x16x32_bf16 v[124:127], a[76:79], v[80:83], v[124:127]
    v_mfma_f32_16x16x32_bf16 v[124:127], a[92:95], v[84:87], v[124:127]
    s_add_u32 m0, s31, 1024
    s_add_u32 s24, s27, 32768
    buffer_load_dwordx4 v245, s[12:15], s24 offen lds
    v_mfma_f32_16x16x32_bf16 v[124:127], a[108:111], v[88:91], v[124:127]
    v_mfma_f32_16x16x32_bf16 v[124:127], a[124:127], v[92:95], v[124:127]
    s_waitcnt lgkmcnt(0)
    v_mfma_f32_16x16x32_bf16 v[128:131], a[64:67], v[64:67], v[128:131]
    ds_read_b128 v[80:83], v224 offset:22528
    v_mfma_f32_16x16x32_bf16 v[128:131], a[80:83], v[68:71], v[128:131]
    ds_read_b128 v[84:87], v225 offset:22528
    v_mfma_f32_16x16x32_bf16 v[128:131], a[96:99], v[72:75], v[128:131]
    ds_read_b128 v[88:91], v224 offset:30720
    v_mfma_f32_16x16x32_bf16 v[128:131], a[112:115], v[76:79], v[128:131]
    ds_read_b128 v[92:95], v225 offset:30720
    v_mfma_f32_16x16x32_bf16 v[132:135], a[68:71], v[64:67], v[132:135]
    v_mfma_f32_16x16x32_bf16 v[132:135], a[84:87], v[68:71], v[132:135]
    v_mfma_f32_16x16x32_bf16 v[132:135], a[100:103], v[72:75], v[132:135]
    v_mfma_f32_16x16x32_bf16 v[132:135], a[116:119], v[76:79], v[132:135]
    v_mfma_f32_16x16x32_bf16 v[136:139], a[72:75], v[64:67], v[136:139]
    s_add_u32 m0, s31, 2048
    s_add_u32 s24, s27, 65536
    buffer_load_dwordx4 v237, s[12:15], s24 offen lds
    v_mfma_f32_16x16x32_bf16 v[136:139], a[88:91], v[68:71], v[136:139]
    v_mfma_f32_16x16x32_bf16 v[136:139], a[104:107], v[72:75], v[136:139]
    v_mfma_f32_16x16x32_bf16 v[136:139], a[120:123], v[76:79], v[136:139]
    v_mfma_f32_16x16x32_bf16 v[140:143], a[76:79], v[64:67], v[140:143]
    v_mfma_f32_16x16x32_bf16 v[140:143], a[92:95], v[68:71], v[140:143]
    v_mfma_f32_16x16x32_bf16 v[140:143], a[108:111], v[72:75], v[140:143]
    v_mfma_f32_16x16x32_bf16 v[140:143], a[124:127], v[76:79], v[140:143]
    s_add_u32 s38, s36, 8192
    buffer_store_dwordx4 v[20:23], v240, s[16:19], s38 offen offset:2048 sc1
    s_waitcnt vmcnt(19) lgkmcnt(0)
    s_barrier
    v_mfma_f32_16x16x32_bf16 v[144:147], a[64:67], v[80:83], v[144:147]
    ds_read_b128 v[64:67], v224 offset:32768
    v_mfma_f32_16x16x32_bf16 v[144:147], a[80:83], v[84:87], v[144:147]
    ds_read_b128 v[68:71], v225 offset:32768
    v_mfma_f32_16x16x32_bf16 v[144:147], a[96:99], v[88:91], v[144:147]
    ds_read_b128 v[72:75], v224 offset:40960
    v_mfma_f32_16x16x32_bf16 v[144:147], a[112:115], v[92:95], v[144:147]
    ds_read_b128 v[76:79], v225 offset:40960
    v_mfma_f32_16x16x32_bf16 v[148:151], a[68:71], v[80:83], v[148:151]
    v_mfma_f32_16x16x32_bf16 v[148:151], a[84:87], v[84:87], v[148:151]
    v_mfma_f32_16x16x32_bf16 v[148:151], a[100:103], v[88:91], v[148:151]
    v_mfma_f32_16x16x32_bf16 v[148:151], a[116:119], v[92:95], v[148:151]
    v_mfma_f32_16x16x32_bf16 v[152:155], a[72:75], v[80:83], v[152:155]
    s_add_u32 m0, s34, 16384
    s_add_u32 s37, s82, 196608
    buffer_load_dwordx4 v232, s[44:47], s37 offen lds
    v_mfma_f32_16x16x32_bf16 v[152:155], a[88:91], v[84:87], v[152:155]
    v_mfma_f32_16x16x32_bf16 v[152:155], a[104:107], v[88:91], v[152:155]
    buffer_load_dwordx4 v233, s[44:47], s37 offen offset:1024 lds
    v_mfma_f32_16x16x32_bf16 v[152:155], a[120:123], v[92:95], v[152:155]
    v_mfma_f32_16x16x32_bf16 v[156:159], a[76:79], v[80:83], v[156:159]
    v_mfma_f32_16x16x32_bf16 v[156:159], a[92:95], v[84:87], v[156:159]
    s_add_u32 m0, s31, 3072
    s_add_u32 s24, s27, 98304
    buffer_load_dwordx4 v237, s[12:15], s24 offen lds
    v_mfma_f32_16x16x32_bf16 v[156:159], a[108:111], v[88:91], v[156:159]
    v_mfma_f32_16x16x32_bf16 v[156:159], a[124:127], v[92:95], v[156:159]
    s_waitcnt lgkmcnt(0)
    v_mfma_f32_16x16x32_bf16 v[96:99], a[128:131], v[64:67], v[96:99]
    ds_read_b128 v[80:83], v224 offset:34816
    v_mfma_f32_16x16x32_bf16 v[96:99], a[144:147], v[68:71], v[96:99]
    ds_read_b128 v[84:87], v225 offset:34816
    v_mfma_f32_16x16x32_bf16 v[96:99], a[160:163], v[72:75], v[96:99]
    ds_read_b128 v[88:91], v224 offset:43008
    v_mfma_f32_16x16x32_bf16 v[96:99], a[176:179], v[76:79], v[96:99]
    ds_read_b128 v[92:95], v225 offset:43008
    v_mfma_f32_16x16x32_bf16 v[100:103], a[132:135], v[64:67], v[100:103]
    v_mfma_f32_16x16x32_bf16 v[100:103], a[148:151], v[68:71], v[100:103]
    s_add_u32 s38, s36, 8192
    buffer_store_dwordx4 v[24:27], v240, s[16:19], s38 offen offset:1024 sc1
    v_mfma_f32_16x16x32_bf16 v[100:103], a[164:167], v[72:75], v[100:103]
    v_mfma_f32_16x16x32_bf16 v[100:103], a[180:183], v[76:79], v[100:103]
    v_mfma_f32_16x16x32_bf16 v[104:107], a[136:139], v[64:67], v[104:107]
    s_add_u32 m0, s31, 4096
    s_add_u32 s24, s27, 131072
    buffer_load_dwordx4 v245, s[12:15], s24 offen lds
    v_mfma_f32_16x16x32_bf16 v[104:107], a[152:155], v[68:71], v[104:107]
    v_mfma_f32_16x16x32_bf16 v[104:107], a[168:171], v[72:75], v[104:107]
    v_mfma_f32_16x16x32_bf16 v[104:107], a[184:187], v[76:79], v[104:107]
    v_mfma_f32_16x16x32_bf16 v[108:111], a[140:143], v[64:67], v[108:111]
    v_mfma_f32_16x16x32_bf16 v[108:111], a[156:159], v[68:71], v[108:111]
    v_mfma_f32_16x16x32_bf16 v[108:111], a[172:175], v[72:75], v[108:111]
    v_mfma_f32_16x16x32_bf16 v[108:111], a[188:191], v[76:79], v[108:111]
    s_waitcnt lgkmcnt(0)
    v_mfma_f32_16x16x32_bf16 v[112:115], a[128:131], v[80:83], v[112:115]
    ds_read_b128 v[64:67], v224 offset:36864
    v_mfma_f32_16x16x32_bf16 v[112:115], a[144:147], v[84:87], v[112:115]
    ds_read_b128 v[68:71], v225 offset:36864
    v_mfma_f32_16x16x32_bf16 v[112:115], a[160:163], v[88:91], v[112:115]
    ds_read_b128 v[72:75], v224 offset:45056
    v_mfma_f32_16x16x32_bf16 v[112:115], a[176:179], v[92:95], v[112:115]
    ds_read_b128 v[76:79], v225 offset:45056
    v_mfma_f32_16x16x32_bf16 v[116:119], a[132:135], v[80:83], v[116:119]
    v_mfma_f32_16x16x32_bf16 v[116:119], a[148:151], v[84:87], v[116:119]
    v_mfma_f32_16x16x32_bf16 v[116:119], a[164:167], v[88:91], v[116:119]
    v_mfma_f32_16x16x32_bf16 v[116:119], a[180:183], v[92:95], v[116:119]
    v_mfma_f32_16x16x32_bf16 v[120:123], a[136:139], v[80:83], v[120:123]
    s_add_u32 m0, s34, 24576
    s_add_u32 s37, s83, 196608
    buffer_load_dwordx4 v232, s[44:47], s37 offen lds
    v_mfma_f32_16x16x32_bf16 v[120:123], a[152:155], v[84:87], v[120:123]
    v_mfma_f32_16x16x32_bf16 v[120:123], a[168:171], v[88:91], v[120:123]
    buffer_load_dwordx4 v233, s[44:47], s37 offen offset:1024 lds
    s_add_u32 s38, s36, 8192
    buffer_store_dwordx4 v[28:31], v240, s[16:19], s38 offen offset:3072 sc1
    v_mfma_f32_16x16x32_bf16 v[120:123], a[184:187], v[92:95], v[120:123]
    v_mfma_f32_16x16x32_bf16 v[124:127], a[140:143], v[80:83], v[124:127]
    v_mfma_f32_16x16x32_bf16 v[124:127], a[156:159], v[84:87], v[124:127]
    s_add_u32 m0, s31, 5120
    s_add_u32 s24, s27, 163840
    buffer_load_dwordx4 v245, s[12:15], s24 offen lds
    v_mfma_f32_16x16x32_bf16 v[124:127], a[172:175], v[88:91], v[124:127]
    v_mfma_f32_16x16x32_bf16 v[124:127], a[188:191], v[92:95], v[124:127]
    s_waitcnt lgkmcnt(0)
    v_mfma_f32_16x16x32_bf16 v[128:131], a[128:131], v[64:67], v[128:131]
    ds_read_b128 v[80:83], v224 offset:38912
    v_mfma_f32_16x16x32_bf16 v[128:131], a[144:147], v[68:71], v[128:131]
    ds_read_b128 v[84:87], v225 offset:38912
    v_mfma_f32_16x16x32_bf16 v[128:131], a[160:163], v[72:75], v[128:131]
    ds_read_b128 v[88:91], v224 offset:47104
    v_mfma_f32_16x16x32_bf16 v[128:131], a[176:179], v[76:79], v[128:131]
    ds_read_b128 v[92:95], v225 offset:47104
    v_mfma_f32_16x16x32_bf16 v[132:135], a[132:135], v[64:67], v[132:135]
    v_mfma_f32_16x16x32_bf16 v[132:135], a[148:151], v[68:71], v[132:135]
    v_mfma_f32_16x16x32_bf16 v[132:135], a[164:167], v[72:75], v[132:135]
    v_mfma_f32_16x16x32_bf16 v[132:135], a[180:183], v[76:79], v[132:135]
    v_mfma_f32_16x16x32_bf16 v[136:139], a[136:139], v[64:67], v[136:139]
    s_add_u32 m0, s31, 6144
    s_add_u32 s24, s27, 196608
    buffer_load_dwordx4 v237, s[12:15], s24 offen lds
    v_mfma_f32_16x16x32_bf16 v[136:139], a[152:155], v[68:71], v[136:139]
    v_mfma_f32_16x16x32_bf16 v[136:139], a[168:171], v[72:75], v[136:139]
    v_mfma_f32_16x16x32_bf16 v[136:139], a[184:187], v[76:79], v[136:139]
    v_mfma_f32_16x16x32_bf16 v[140:143], a[140:143], v[64:67], v[140:143]
    v_mfma_f32_16x16x32_bf16 v[140:143], a[156:159], v[68:71], v[140:143]
    v_mfma_f32_16x16x32_bf16 v[140:143], a[172:175], v[72:75], v[140:143]
    v_mfma_f32_16x16x32_bf16 v[140:143], a[188:191], v[76:79], v[140:143]
    s_waitcnt vmcnt(22) lgkmcnt(0)
    s_barrier
    v_mfma_f32_16x16x32_bf16 v[144:147], a[128:131], v[80:83], v[144:147]
    ds_read_b128 v[64:67], v224 offset:49152
    s_add_u32 s38, s36, 32768
    buffer_store_dwordx4 v[32:35], v240, s[16:19], s38 offen offset:1280 sc1
    v_mfma_f32_16x16x32_bf16 v[144:147], a[144:147], v[84:87], v[144:147]
    ds_read_b128 v[68:71], v225 offset:49152
    v_mfma_f32_16x16x32_bf16 v[144:147], a[160:163], v[88:91], v[144:147]
    ds_read_b128 v[72:75], v224 offset:57344
    v_mfma_f32_16x16x32_bf16 v[144:147], a[176:179], v[92:95], v[144:147]
    ds_read_b128 v[76:79], v225 offset:57344
    v_mfma_f32_16x16x32_bf16 v[148:151], a[132:135], v[80:83], v[148:151]
    v_mfma_f32_16x16x32_bf16 v[148:151], a[148:151], v[84:87], v[148:151]
    v_mfma_f32_16x16x32_bf16 v[148:151], a[164:167], v[88:91], v[148:151]
    v_mfma_f32_16x16x32_bf16 v[148:151], a[180:183], v[92:95], v[148:151]
    v_mfma_f32_16x16x32_bf16 v[152:155], a[136:139], v[80:83], v[152:155]
    s_add_u32 m0, s34, 32768
    s_add_u32 s37, s84, 196608
    buffer_load_dwordx4 v232, s[44:47], s37 offen lds
    v_mfma_f32_16x16x32_bf16 v[152:155], a[152:155], v[84:87], v[152:155]
    buffer_load_dwordx4 v233, s[44:47], s37 offen offset:1024 lds
    v_mfma_f32_16x16x32_bf16 v[152:155], a[168:171], v[88:91], v[152:155]
    v_mfma_f32_16x16x32_bf16 v[152:155], a[184:187], v[92:95], v[152:155]
    s_add_u32 m0, s31, 7168
    s_add_u32 s24, s27, 229376
    buffer_load_dwordx4 v237, s[12:15], s24 offen lds
    v_mfma_f32_16x16x32_bf16 v[156:159], a[140:143], v[80:83], v[156:159]
    s_add_u32 s27, s27, 1048576
    s_and_b32 s27, s27, 0x407fffff
    s_cmp_eq_u32 s27, s7
    s_cselect_b32 s27, s43, s27
    v_mfma_f32_16x16x32_bf16 v[156:159], a[156:159], v[84:87], v[156:159]
    v_mfma_f32_16x16x32_bf16 v[156:159], a[172:175], v[88:91], v[156:159]
    s_add_u32 s31, s31, 32768
    s_cmp_ge_u32 s31, 163840
    s_cselect_b32 s24, 98304, 0
    s_sub_u32 s31, s31, s24
    v_mfma_f32_16x16x32_bf16 v[156:159], a[188:191], v[92:95], v[156:159]
    s_waitcnt lgkmcnt(0)
    v_mfma_f32_16x16x32_bf16 v[96:99], a[192:195], v[64:67], v[96:99]
    ds_read_b128 v[80:83], v224 offset:51200
    v_mfma_f32_16x16x32_bf16 v[96:99], a[208:211], v[68:71], v[96:99]
    ds_read_b128 v[84:87], v225 offset:51200
    v_mfma_f32_16x16x32_bf16 v[96:99], a[224:227], v[72:75], v[96:99]
    ds_read_b128 v[88:91], v224 offset:59392
    v_mfma_f32_16x16x32_bf16 v[96:99], a[240:243], v[76:79], v[96:99]
    ds_read_b128 v[92:95], v225 offset:59392
    v_mfma_f32_16x16x32_bf16 v[100:103], a[196:199], v[64:67], v[100:103]
    v_mfma_f32_16x16x32_bf16 v[100:103], a[212:215], v[68:71], v[100:103]
    v_mfma_f32_16x16x32_bf16 v[100:103], a[228:231], v[72:75], v[100:103]
    s_add_u32 s38, s36, 32768
    buffer_store_dwordx4 v[36:39], v240, s[16:19], s38 offen offset:3328 sc1
    v_mfma_f32_16x16x32_bf16 v[100:103], a[244:247], v[76:79], v[100:103]
    v_mfma_f32_16x16x32_bf16 v[104:107], a[200:203], v[64:67], v[104:107]
    v_mfma_f32_16x16x32_bf16 v[104:107], a[216:219], v[68:71], v[104:107]
    v_mfma_f32_16x16x32_bf16 v[104:107], a[232:235], v[72:75], v[104:107]
    v_mfma_f32_16x16x32_bf16 v[104:107], a[248:251], v[76:79], v[104:107]
    v_mfma_f32_16x16x32_bf16 v[108:111], a[204:207], v[64:67], v[108:111]
    v_mfma_f32_16x16x32_bf16 v[108:111], a[220:223], v[68:71], v[108:111]
    v_mfma_f32_16x16x32_bf16 v[108:111], a[236:239], v[72:75], v[108:111]
    v_mfma_f32_16x16x32_bf16 v[108:111], a[252:255], v[76:79], v[108:111]
    s_waitcnt lgkmcnt(0)
    v_mfma_f32_16x16x32_bf16 v[112:115], a[192:195], v[80:83], v[112:115]
    ds_read_b128 v[64:67], v224 offset:53248
    v_mfma_f32_16x16x32_bf16 v[112:115], a[208:211], v[84:87], v[112:115]
    ds_read_b128 v[68:71], v225 offset:53248
    v_mfma_f32_16x16x32_bf16 v[112:115], a[224:227], v[88:91], v[112:115]
    ds_read_b128 v[72:75], v224 offset:61440
    v_mfma_f32_16x16x32_bf16 v[112:115], a[240:243], v[92:95], v[112:115]
    ds_read_b128 v[76:79], v225 offset:61440
    v_mfma_f32_16x16x32_bf16 v[116:119], a[196:199], v[80:83], v[116:119]
    v_mfma_f32_16x16x32_bf16 v[116:119], a[212:215], v[84:87], v[116:119]
    v_mfma_f32_16x16x32_bf16 v[116:119], a[228:231], v[88:91], v[116:119]
    v_mfma_f32_16x16x32_bf16 v[116:119], a[244:247], v[92:95], v[116:119]
    v_mfma_f32_16x16x32_bf16 v[120:123], a[200:203], v[80:83], v[120:123]
    s_add_u32 m0, s34, 40960
    s_add_u32 s37, s85, 196608
    buffer_load_dwordx4 v232, s[44:47], s37 offen lds
    v_mfma_f32_16x16x32_bf16 v[120:123], a[216:219], v[84:87], v[120:123]
    v_mfma_f32_16x16x32_bf16 v[120:123], a[232:235], v[88:91], v[120:123]
    v_mfma_f32_16x16x32_bf16 v[120:123], a[248:251], v[92:95], v[120:123]
    s_add_u32 s38, s36, 32768
    buffer_store_dwordx4 v[40:43], v240, s[16:19], s38 offen offset:2304 sc1
    v_mfma_f32_16x16x32_bf16 v[124:127], a[204:207], v[80:83], v[124:127]
    buffer_load_dwordx4 v233, s[44:47], s37 offen offset:1024 lds
    v_mfma_f32_16x16x32_bf16 v[124:127], a[220:223], v[84:87], v[124:127]
    v_mfma_f32_16x16x32_bf16 v[124:127], a[236:239], v[88:91], v[124:127]
    v_mfma_f32_16x16x32_bf16 v[124:127], a[252:255], v[92:95], v[124:127]
    s_waitcnt lgkmcnt(0)
    v_mfma_f32_16x16x32_bf16 v[128:131], a[192:195], v[64:67], v[128:131]
    ds_read_b128 v[80:83], v224 offset:55296
    v_mfma_f32_16x16x32_bf16 v[128:131], a[208:211], v[68:71], v[128:131]
    ds_read_b128 v[84:87], v225 offset:55296
    v_mfma_f32_16x16x32_bf16 v[128:131], a[224:227], v[72:75], v[128:131]
    ds_read_b128 v[88:91], v224 offset:63488
    v_mfma_f32_16x16x32_bf16 v[128:131], a[240:243], v[76:79], v[128:131]
    ds_read_b128 v[92:95], v225 offset:63488
    v_mfma_f32_16x16x32_bf16 v[132:135], a[196:199], v[64:67], v[132:135]
    v_mfma_f32_16x16x32_bf16 v[132:135], a[212:215], v[68:71], v[132:135]
    v_mfma_f32_16x16x32_bf16 v[132:135], a[228:231], v[72:75], v[132:135]
    v_mfma_f32_16x16x32_bf16 v[132:135], a[244:247], v[76:79], v[132:135]
    v_mfma_f32_16x16x32_bf16 v[136:139], a[200:203], v[64:67], v[136:139]
    s_add_u32 m0, s31, 0
    s_add_u32 s24, s27, 0
    buffer_load_dwordx4 v245, s[12:15], s24 offen lds
    v_mfma_f32_16x16x32_bf16 v[136:139], a[216:219], v[68:71], v[136:139]
    v_mfma_f32_16x16x32_bf16 v[136:139], a[232:235], v[72:75], v[136:139]
    v_mfma_f32_16x16x32_bf16 v[136:139], a[248:251], v[76:79], v[136:139]
    v_mfma_f32_16x16x32_bf16 v[140:143], a[204:207], v[64:67], v[140:143]
    v_mfma_f32_16x16x32_bf16 v[140:143], a[220:223], v[68:71], v[140:143]
    v_mfma_f32_16x16x32_bf16 v[140:143], a[236:239], v[72:75], v[140:143]
    v_mfma_f32_16x16x32_bf16 v[140:143], a[252:255], v[76:79], v[140:143]
    s_waitcnt vmcnt(23) lgkmcnt(0)
    s_barrier
    v_mfma_f32_16x16x32_bf16 v[144:147], a[192:195], v[80:83], v[144:147]
    ds_read_b128 v[64:67], v224 offset:0
    v_mfma_f32_16x16x32_bf16 v[144:147], a[208:211], v[84:87], v[144:147]
    ds_read_b128 v[68:71], v225 offset:0
    s_add_u32 s38, s36, 36864
    buffer_store_dwordx4 v[44:47], v240, s[16:19], s38 offen offset:256 sc1
    v_mfma_f32_16x16x32_bf16 v[144:147], a[224:227], v[88:91], v[144:147]
    ds_read_b128 v[72:75], v224 offset:8192
    v_mfma_f32_16x16x32_bf16 v[144:147], a[240:243], v[92:95], v[144:147]
    ds_read_b128 v[76:79], v225 offset:8192
    v_mfma_f32_16x16x32_bf16 v[148:151], a[196:199], v[80:83], v[148:151]
    v_mfma_f32_16x16x32_bf16 v[148:151], a[212:215], v[84:87], v[148:151]
    v_mfma_f32_16x16x32_bf16 v[148:151], a[228:231], v[88:91], v[148:151]
    v_mfma_f32_16x16x32_bf16 v[148:151], a[244:247], v[92:95], v[148:151]
    v_mfma_f32_16x16x32_bf16 v[152:155], a[200:203], v[80:83], v[152:155]
    s_add_u32 m0, s34, 49152
    s_add_u32 s37, s86, 196608
    buffer_load_dwordx4 v232, s[44:47], s37 offen lds
    v_mfma_f32_16x16x32_bf16 v[152:155], a[216:219], v[84:87], v[152:155]
    v_mfma_f32_16x16x32_bf16 v[152:155], a[232:235], v[88:91], v[152:155]
    buffer_load_dwordx4 v233, s[44:47], s37 offen offset:1024 lds
    v_mfma_f32_16x16x32_bf16 v[152:155], a[248:251], v[92:95], v[152:155]
    v_mfma_f32_16x16x32_bf16 v[156:159], a[204:207], v[80:83], v[156:159]
    v_mfma_f32_16x16x32_bf16 v[156:159], a[220:223], v[84:87], v[156:159]
    s_add_u32 m0, s31, 1024
    s_add_u32 s24, s27, 32768
    buffer_load_dwordx4 v245, s[12:15], s24 offen lds
    v_mfma_f32_16x16x32_bf16 v[156:159], a[236:239], v[88:91], v[156:159]
    v_mfma_f32_16x16x32_bf16 v[156:159], a[252:255], v[92:95], v[156:159]
    s_waitcnt lgkmcnt(0)
    v_mfma_f32_16x16x32_bf16 v[160:163], a[0:3], v[64:67], 0
    ds_read_b128 v[80:83], v224 offset:2048
    v_mfma_f32_16x16x32_bf16 v[160:163], a[16:19], v[68:71], v[160:163]
    ds_read_b128 v[84:87], v225 offset:2048
    v_mfma_f32_16x16x32_bf16 v[160:163], a[32:35], v[72:75], v[160:163]
    ds_read_b128 v[88:91], v224 offset:10240
    v_mfma_f32_16x16x32_bf16 v[160:163], a[48:51], v[76:79], v[160:163]
    ds_read_b128 v[92:95], v225 offset:10240
    v_mfma_f32_16x16x32_bf16 v[164:167], a[4:7], v[64:67], 0
    v_cvt_pk_bf16_f32 v0, v96, v97
    v_cvt_pk_bf16_f32 v1, v98, v99
    v_mfma_f32_16x16x32_bf16 v[164:167], a[20:23], v[68:71], v[164:167]
    v_mfma_f32_16x16x32_bf16 v[164:167], a[36:39], v[72:75], v[164:167]
    v_cvt_pk_bf16_f32 v2, v100, v101
    v_cvt_pk_bf16_f32 v3, v102, v103
    s_add_u32 s38, s36, 40960
    buffer_store_dwordx4 v[48:51], v240, s[16:19], s38 offen offset:1280 sc1
    v_mfma_f32_16x16x32_bf16 v[164:167], a[52:55], v[76:79], v[164:167]
    v_mfma_f32_16x16x32_bf16 v[168:171], a[8:11], v[64:67], 0
    s_add_u32 m0, s31, 2048
    s_add_u32 s24, s27, 65536
    buffer_load_dwordx4 v237, s[12:15], s24 offen lds
    v_cvt_pk_bf16_f32 v4, v104, v105
    v_cvt_pk_bf16_f32 v5, v106, v107
    v_mfma_f32_16x16x32_bf16 v[168:171], a[24:27], v[68:71], v[168:171]
    v_mfma_f32_16x16x32_bf16 v[168:171], a[40:43], v[72:75], v[168:171]
    v_cvt_pk_bf16_f32 v6, v108, v109
    v_cvt_pk_bf16_f32 v7, v110, v111
    v_mfma_f32_16x16x32_bf16 v[168:171], a[56:59], v[76:79], v[168:171]
    v_mfma_f32_16x16x32_bf16 v[172:175], a[12:15], v[64:67], 0
    v_cvt_pk_bf16_f32 v8, v112, v113
    v_cvt_pk_bf16_f32 v9, v114, v115
    v_mfma_f32_16x16x32_bf16 v[172:175], a[28:31], v[68:71], v[172:175]
    v_mfma_f32_16x16x32_bf16 v[172:175], a[44:47], v[72:75], v[172:175]
    v_cvt_pk_bf16_f32 v10, v116, v117
    v_cvt_pk_bf16_f32 v11, v118, v119
    v_mfma_f32_16x16x32_bf16 v[172:175], a[60:63], v[76:79], v[172:175]
    s_waitcnt lgkmcnt(0)
    v_mfma_f32_16x16x32_bf16 v[176:179], a[0:3], v[80:83], 0
    ds_read_b128 v[64:67], v224 offset:4096
    v_cvt_pk_bf16_f32 v12, v120, v121
    v_cvt_pk_bf16_f32 v13, v122, v123
    v_mfma_f32_16x16x32_bf16 v[176:179], a[16:19], v[84:87], v[176:179]
    ds_read_b128 v[68:71], v225 offset:4096
    v_mfma_f32_16x16x32_bf16 v[176:179], a[32:35], v[88:91], v[176:179]
    ds_read_b128 v[72:75], v224 offset:12288
    v_cvt_pk_bf16_f32 v14, v124, v125
    v_cvt_pk_bf16_f32 v15, v126, v127
    v_mfma_f32_16x16x32_bf16 v[176:179], a[48:51], v[92:95], v[176:179]
    ds_read_b128 v[76:79], v225 offset:12288
    v_mfma_f32_16x16x32_bf16 v[180:183], a[4:7], v[80:83], 0
    v_cvt_pk_bf16_f32 v16, v128, v129
    v_cvt_pk_bf16_f32 v17, v130, v131
    v_mfma_f32_16x16x32_bf16 v[180:183], a[20:23], v[84:87], v[180:183]
    v_mfma_f32_16x16x32_bf16 v[180:183], a[36:39], v[88:91], v[180:183]
    v_cvt_pk_bf16_f32 v18, v132, v133
    v_cvt_pk_bf16_f32 v19, v134, v135
    v_mfma_f32_16x16x32_bf16 v[180:183], a[52:55], v[92:95], v[180:183]
    v_mfma_f32_16x16x32_bf16 v[184:187], a[8:11], v[80:83], 0
    s_add_u32 m0, s34, 57344
    s_add_u32 s37, s87, 196608
    buffer_load_dwordx4 v232, s[44:47], s37 offen lds
    v_cvt_pk_bf16_f32 v20, v136, v137
    v_cvt_pk_bf16_f32 v21, v138, v139
    v_mfma_f32_16x16x32_bf16 v[184:187], a[24:27], v[84:87], v[184:187]
    v_mfma_f32_16x16x32_bf16 v[184:187], a[40:43], v[88:91], v[184:187]
    buffer_load_dwordx4 v233, s[44:47], s37 offen offset:1024 lds
    v_cvt_pk_bf16_f32 v22, v140, v141
    v_cvt_pk_bf16_f32 v23, v142, v143
    v_mfma_f32_16x16x32_bf16 v[184:187], a[56:59], v[92:95], v[184:187]
    v_mfma_f32_16x16x32_bf16 v[188:191], a[12:15], v[80:83], 0
    v_cvt_pk_bf16_f32 v24, v144, v145
    v_cvt_pk_bf16_f32 v25, v146, v147
    s_add_u32 s38, s36, 40960
    buffer_store_dwordx4 v[52:55], v240, s[16:19], s38 offen offset:3328 sc1
    v_mfma_f32_16x16x32_bf16 v[188:191], a[28:31], v[84:87], v[188:191]
    s_add_u32 m0, s31, 3072
    s_add_u32 s24, s27, 98304
    buffer_load_dwordx4 v237, s[12:15], s24 offen lds
    v_mfma_f32_16x16x32_bf16 v[188:191], a[44:47], v[88:91], v[188:191]
    v_cvt_pk_bf16_f32 v26, v148, v149
    v_cvt_pk_bf16_f32 v27, v150, v151
    v_mfma_f32_16x16x32_bf16 v[188:191], a[60:63], v[92:95], v[188:191]
    s_waitcnt lgkmcnt(0)
    v_mfma_f32_16x16x32_bf16 v[192:195], a[0:3], v[64:67], 0
    ds_read_b128 v[80:83], v224 offset:6144
    v_cvt_pk_bf16_f32 v28, v152, v153
    v_cvt_pk_bf16_f32 v29, v154, v155
    v_mfma_f32_16x16x32_bf16 v[192:195], a[16:19], v[68:71], v[192:195]
    ds_read_b128 v[84:87], v225 offset:6144
    v_mfma_f32_16x16x32_bf16 v[192:195], a[32:35], v[72:75], v[192:195]
    ds_read_b128 v[88:91], v224 offset:14336
    v_cvt_pk_bf16_f32 v30, v156, v157
    v_cvt_pk_bf16_f32 v31, v158, v159
    v_mfma_f32_16x16x32_bf16 v[192:195], a[48:51], v[76:79], v[192:195]
    ds_read_b128 v[92:95], v225 offset:14336
    v_mfma_f32_16x16x32_bf16 v[196:199], a[4:7], v[64:67], 0
    v_mfma_f32_16x16x32_bf16 v[196:199], a[20:23], v[68:71], v[196:199]
    v_mfma_f32_16x16x32_bf16 v[196:199], a[36:39], v[72:75], v[196:199]
    v_mfma_f32_16x16x32_bf16 v[196:199], a[52:55], v[76:79], v[196:199]
    v_mfma_f32_16x16x32_bf16 v[200:203], a[8:11], v[64:67], 0
    s_add_u32 m0, s31, 4096
    s_add_u32 s24, s27, 131072
    buffer_load_dwordx4 v245, s[12:15], s24 offen lds
    v_mfma_f32_16x16x32_bf16 v[200:203], a[24:27], v[68:71], v[200:203]
    v_mfma_f32_16x16x32_bf16 v[200:203], a[40:43], v[72:75], v[200:203]
    v_mfma_f32_16x16x32_bf16 v[200:203], a[56:59], v[76:79], v[200:203]
    v_mfma_f32_16x16x32_bf16 v[204:207], a[12:15], v[64:67], 0
    v_mfma_f32_16x16x32_bf16 v[204:207], a[28:31], v[68:71], v[204:207]
    v_mfma_f32_16x16x32_bf16 v[204:207], a[44:47], v[72:75], v[204:207]
    v_mfma_f32_16x16x32_bf16 v[204:207], a[60:63], v[76:79], v[204:207]
    s_waitcnt vmcnt(23) lgkmcnt(0)
    s_barrier
    v_mfma_f32_16x16x32_bf16 v[208:211], a[0:3], v[80:83], 0
    ds_read_b128 v[64:67], v224 offset:16384
    v_mfma_f32_16x16x32_bf16 v[208:211], a[16:19], v[84:87], v[208:211]
    ds_read_b128 v[68:71], v225 offset:16384
    s_add_u32 s38, s36, 40960
    buffer_store_dwordx4 v[56:59], v240, s[16:19], s38 offen offset:2304 sc1
    v_mfma_f32_16x16x32_bf16 v[208:211], a[32:35], v[88:91], v[208:211]
    ds_read_b128 v[72:75], v224 offset:24576
    v_mfma_f32_16x16x32_bf16 v[208:211], a[48:51], v[92:95], v[208:211]
    ds_read_b128 v[76:79], v225 offset:24576
    v_mfma_f32_16x16x32_bf16 v[212:215], a[4:7], v[80:83], 0
    v_mfma_f32_16x16x32_bf16 v[212:215], a[20:23], v[84:87], v[212:215]
    v_mfma_f32_16x16x32_bf16 v[212:215], a[36:39], v[88:91], v[212:215]
    v_mfma_f32_16x16x32_bf16 v[212:215], a[52:55], v[92:95], v[212:215]
    v_mfma_f32_16x16x32_bf16 v[216:219], a[8:11], v[80:83], 0
    s_add_u32 m0, s31, 5120
    s_add_u32 s24, s27, 163840
    buffer_load_dwordx4 v245, s[12:15], s24 offen lds
    v_mfma_f32_16x16x32_bf16 v[216:219], a[24:27], v[84:87], v[216:219]
    v_mfma_f32_16x16x32_bf16 v[216:219], a[40:43], v[88:91], v[216:219]
    v_mfma_f32_16x16x32_bf16 v[216:219], a[56:59], v[92:95], v[216:219]
    v_mfma_f32_16x16x32_bf16 v[220:223], a[12:15], v[80:83], 0
    v_mfma_f32_16x16x32_bf16 v[220:223], a[28:31], v[84:87], v[220:223]
    v_mfma_f32_16x16x32_bf16 v[220:223], a[44:47], v[88:91], v[220:223]
    v_mfma_f32_16x16x32_bf16 v[220:223], a[60:63], v[92:95], v[220:223]
    s_waitcnt lgkmcnt(0)
    v_mfma_f32_16x16x32_bf16 v[160:163], a[64:67], v[64:67], v[160:163]
    ds_read_b128 v[80:83], v224 offset:18432
    v_mfma_f32_16x16x32_bf16 v[160:163], a[80:83], v[68:71], v[160:163]
    ds_read_b128 v[84:87], v225 offset:18432
    v_mfma_f32_16x16x32_bf16 v[160:163], a[96:99], v[72:75], v[160:163]
    ds_read_b128 v[88:91], v224 offset:26624
    v_mfma_f32_16x16x32_bf16 v[160:163], a[112:115], v[76:79], v[160:163]
    ds_read_b128 v[92:95], v225 offset:26624
    v_mfma_f32_16x16x32_bf16 v[164:167], a[68:71], v[64:67], v[164:167]
    v_mfma_f32_16x16x32_bf16 v[164:167], a[84:87], v[68:71], v[164:167]
    v_mfma_f32_16x16x32_bf16 v[164:167], a[100:103], v[72:75], v[164:167]
    v_mfma_f32_16x16x32_bf16 v[164:167], a[116:119], v[76:79], v[164:167]
    s_add_u32 s38, s36, 45056
    buffer_store_dwordx4 v[60:63], v240, s[16:19], s38 offen offset:256 sc1
    v_mfma_f32_16x16x32_bf16 v[168:171], a[72:75], v[64:67], v[168:171]
    s_add_u32 m0, s31, 6144
    s_add_u32 s24, s27, 196608
    buffer_load_dwordx4 v237, s[12:15], s24 offen lds
    v_mfma_f32_16x16x32_bf16 v[168:171], a[88:91], v[68:71], v[168:171]
    v_mfma_f32_16x16x32_bf16 v[168:171], a[104:107], v[72:75], v[168:171]
    v_mfma_f32_16x16x32_bf16 v[168:171], a[120:123], v[76:79], v[168:171]
    v_mfma_f32_16x16x32_bf16 v[172:175], a[76:79], v[64:67], v[172:175]
    v_mfma_f32_16x16x32_bf16 v[172:175], a[92:95], v[68:71], v[172:175]
    v_mfma_f32_16x16x32_bf16 v[172:175], a[108:111], v[72:75], v[172:175]
    v_mfma_f32_16x16x32_bf16 v[172:175], a[124:127], v[76:79], v[172:175]
    s_waitcnt lgkmcnt(0)
    v_mfma_f32_16x16x32_bf16 v[176:179], a[64:67], v[80:83], v[176:179]
    ds_read_b128 v[64:67], v224 offset:20480
    v_mfma_f32_16x16x32_bf16 v[176:179], a[80:83], v[84:87], v[176:179]
    ds_read_b128 v[68:71], v225 offset:20480
    v_mfma_f32_16x16x32_bf16 v[176:179], a[96:99], v[88:91], v[176:179]
    ds_read_b128 v[72:75], v224 offset:28672
    v_mfma_f32_16x16x32_bf16 v[176:179], a[112:115], v[92:95], v[176:179]
    ds_read_b128 v[76:79], v225 offset:28672
    v_mfma_f32_16x16x32_bf16 v[180:183], a[68:71], v[80:83], v[180:183]
    v_mfma_f32_16x16x32_bf16 v[180:183], a[84:87], v[84:87], v[180:183]
    v_mfma_f32_16x16x32_bf16 v[180:183], a[100:103], v[88:91], v[180:183]
    v_mfma_f32_16x16x32_bf16 v[180:183], a[116:119], v[92:95], v[180:183]
    v_mfma_f32_16x16x32_bf16 v[184:187], a[72:75], v[80:83], v[184:187]
    s_add_u32 m0, s31, 7168
    s_add_u32 s24, s27, 229376
    buffer_load_dwordx4 v237, s[12:15], s24 offen lds
    v_mfma_f32_16x16x32_bf16 v[184:187], a[88:91], v[84:87], v[184:187]
    v_mfma_f32_16x16x32_bf16 v[184:187], a[104:107], v[88:91], v[184:187]
    s_add_u32 s27, s27, 1048576
    s_and_b32 s27, s27, 0x407fffff
    s_cmp_eq_u32 s27, s7
    s_cselect_b32 s27, s43, s27
    v_mfma_f32_16x16x32_bf16 v[184:187], a[120:123], v[92:95], v[184:187]
    v_mfma_f32_16x16x32_bf16 v[188:191], a[76:79], v[80:83], v[188:191]
    v_mfma_f32_16x16x32_bf16 v[188:191], a[92:95], v[84:87], v[188:191]
    s_add_u32 s31, s31, 32768
    s_cmp_ge_u32 s31, 163840
    s_cselect_b32 s24, 98304, 0
    s_sub_u32 s31, s31, s24
    s_add_u32 s38, s36, 65536
    buffer_store_dwordx4 v[0:3], v240, s[16:19], s38 offen offset:2560 sc1
    v_mfma_f32_16x16x32_bf16 v[188:191], a[108:111], v[88:91], v[188:191]
    v_mfma_f32_16x16x32_bf16 v[188:191], a[124:127], v[92:95], v[188:191]
    s_waitcnt lgkmcnt(0)
    v_mfma_f32_16x16x32_bf16 v[192:195], a[64:67], v[64:67], v[192:195]
    ds_read_b128 v[80:83], v224 offset:22528
    v_mfma_f32_16x16x32_bf16 v[192:195], a[80:83], v[68:71], v[192:195]
    ds_read_b128 v[84:87], v225 offset:22528
    v_mfma_f32_16x16x32_bf16 v[192:195], a[96:99], v[72:75], v[192:195]
    ds_read_b128 v[88:91], v224 offset:30720
    v_mfma_f32_16x16x32_bf16 v[192:195], a[112:115], v[76:79], v[192:195]
    ds_read_b128 v[92:95], v225 offset:30720
    v_mfma_f32_16x16x32_bf16 v[196:199], a[68:71], v[64:67], v[196:199]
    v_mfma_f32_16x16x32_bf16 v[196:199], a[84:87], v[68:71], v[196:199]
    v_mfma_f32_16x16x32_bf16 v[196:199], a[100:103], v[72:75], v[196:199]
    v_mfma_f32_16x16x32_bf16 v[196:199], a[116:119], v[76:79], v[196:199]
    v_mfma_f32_16x16x32_bf16 v[200:203], a[72:75], v[64:67], v[200:203]
    v_mfma_f32_16x16x32_bf16 v[200:203], a[88:91], v[68:71], v[200:203]
    v_mfma_f32_16x16x32_bf16 v[200:203], a[104:107], v[72:75], v[200:203]
    v_mfma_f32_16x16x32_bf16 v[200:203], a[120:123], v[76:79], v[200:203]
    v_mfma_f32_16x16x32_bf16 v[204:207], a[76:79], v[64:67], v[204:207]
    v_mfma_f32_16x16x32_bf16 v[204:207], a[92:95], v[68:71], v[204:207]
    v_mfma_f32_16x16x32_bf16 v[204:207], a[108:111], v[72:75], v[204:207]
    v_mfma_f32_16x16x32_bf16 v[204:207], a[124:127], v[76:79], v[204:207]
    s_waitcnt vmcnt(9) lgkmcnt(0)
    s_barrier
    v_mfma_f32_16x16x32_bf16 v[208:211], a[64:67], v[80:83], v[208:211]
    ds_read_b128 v[64:67], v224 offset:32768
    v_mfma_f32_16x16x32_bf16 v[208:211], a[80:83], v[84:87], v[208:211]
    ds_read_b128 v[68:71], v225 offset:32768
    v_mfma_f32_16x16x32_bf16 v[208:211], a[96:99], v[88:91], v[208:211]
    ds_read_b128 v[72:75], v224 offset:40960
    s_add_u32 s38, s36, 69632
    buffer_store_dwordx4 v[4:7], v240, s[16:19], s38 offen offset:512 sc1
    v_mfma_f32_16x16x32_bf16 v[208:211], a[112:115], v[92:95], v[208:211]
    ds_read_b128 v[76:79], v225 offset:40960
    v_mfma_f32_16x16x32_bf16 v[212:215], a[68:71], v[80:83], v[212:215]
    v_mfma_f32_16x16x32_bf16 v[212:215], a[84:87], v[84:87], v[212:215]
    v_mfma_f32_16x16x32_bf16 v[212:215], a[100:103], v[88:91], v[212:215]
    v_mfma_f32_16x16x32_bf16 v[212:215], a[116:119], v[92:95], v[212:215]
    v_mfma_f32_16x16x32_bf16 v[216:219], a[72:75], v[80:83], v[216:219]
    v_mfma_f32_16x16x32_bf16 v[216:219], a[88:91], v[84:87], v[216:219]
    v_mfma_f32_16x16x32_bf16 v[216:219], a[104:107], v[88:91], v[216:219]
    v_mfma_f32_16x16x32_bf16 v[216:219], a[120:123], v[92:95], v[216:219]
    v_mfma_f32_16x16x32_bf16 v[220:223], a[76:79], v[80:83], v[220:223]
    v_mfma_f32_16x16x32_bf16 v[220:223], a[92:95], v[84:87], v[220:223]
    v_mfma_f32_16x16x32_bf16 v[220:223], a[108:111], v[88:91], v[220:223]
    v_mfma_f32_16x16x32_bf16 v[220:223], a[124:127], v[92:95], v[220:223]
    s_waitcnt lgkmcnt(0)
    v_mfma_f32_16x16x32_bf16 v[160:163], a[128:131], v[64:67], v[160:163]
    ds_read_b128 v[80:83], v224 offset:34816
    v_mfma_f32_16x16x32_bf16 v[160:163], a[144:147], v[68:71], v[160:163]
    ds_read_b128 v[84:87], v225 offset:34816
    v_mfma_f32_16x16x32_bf16 v[160:163], a[160:163], v[72:75], v[160:163]
    ds_read_b128 v[88:91], v224 offset:43008
    v_mfma_f32_16x16x32_bf16 v[160:163], a[176:179], v[76:79], v[160:163]
    ds_read_b128 v[92:95], v225 offset:43008
    v_mfma_f32_16x16x32_bf16 v[164:167], a[132:135], v[64:67], v[164:167]
    v_mfma_f32_16x16x32_bf16 v[164:167], a[148:151], v[68:71], v[164:167]
    v_mfma_f32_16x16x32_bf16 v[164:167], a[164:167], v[72:75], v[164:167]
    v_mfma_f32_16x16x32_bf16 v[164:167], a[180:183], v[76:79], v[164:167]
    v_mfma_f32_16x16x32_bf16 v[168:171], a[136:139], v[64:67], v[168:171]
    buffer_load_dword v254, off, s[88:91], s39 sc1
    s_add_u32 s38, s36, 65536
    buffer_store_dwordx4 v[8:11], v240, s[16:19], s38 offen offset:3584 sc1
    v_mfma_f32_16x16x32_bf16 v[168:171], a[152:155], v[68:71], v[168:171]
    v_mfma_f32_16x16x32_bf16 v[168:171], a[168:171], v[72:75], v[168:171]
    v_mfma_f32_16x16x32_bf16 v[168:171], a[184:187], v[76:79], v[168:171]
    v_mfma_f32_16x16x32_bf16 v[172:175], a[140:143], v[64:67], v[172:175]
    v_mfma_f32_16x16x32_bf16 v[172:175], a[156:159], v[68:71], v[172:175]
    v_mfma_f32_16x16x32_bf16 v[172:175], a[172:175], v[72:75], v[172:175]
    v_mfma_f32_16x16x32_bf16 v[172:175], a[188:191], v[76:79], v[172:175]
    s_waitcnt lgkmcnt(0)
    v_mfma_f32_16x16x32_bf16 v[176:179], a[128:131], v[80:83], v[176:179]
    ds_read_b128 v[64:67], v224 offset:36864
    v_mfma_f32_16x16x32_bf16 v[176:179], a[144:147], v[84:87], v[176:179]
    ds_read_b128 v[68:71], v225 offset:36864
    v_mfma_f32_16x16x32_bf16 v[176:179], a[160:163], v[88:91], v[176:179]
    ds_read_b128 v[72:75], v224 offset:45056
    v_mfma_f32_16x16x32_bf16 v[176:179], a[176:179], v[92:95], v[176:179]
    ds_read_b128 v[76:79], v225 offset:45056
    v_mfma_f32_16x16x32_bf16 v[180:183], a[132:135], v[80:83], v[180:183]
    v_mfma_f32_16x16x32_bf16 v[180:183], a[148:151], v[84:87], v[180:183]
    v_mfma_f32_16x16x32_bf16 v[180:183], a[164:167], v[88:91], v[180:183]
    v_mfma_f32_16x16x32_bf16 v[180:183], a[180:183], v[92:95], v[180:183]
    v_mfma_f32_16x16x32_bf16 v[184:187], a[136:139], v[80:83], v[184:187]
    v_mfma_f32_16x16x32_bf16 v[184:187], a[152:155], v[84:87], v[184:187]
    v_mfma_f32_16x16x32_bf16 v[184:187], a[168:171], v[88:91], v[184:187]
    v_mfma_f32_16x16x32_bf16 v[184:187], a[184:187], v[92:95], v[184:187]
    v_mfma_f32_16x16x32_bf16 v[188:191], a[140:143], v[80:83], v[188:191]
    v_mfma_f32_16x16x32_bf16 v[188:191], a[156:159], v[84:87], v[188:191]
    s_add_u32 s38, s36, 69632
    buffer_store_dwordx4 v[12:15], v240, s[16:19], s38 offen offset:1536 sc1
    v_mfma_f32_16x16x32_bf16 v[188:191], a[172:175], v[88:91], v[188:191]
    v_mfma_f32_16x16x32_bf16 v[188:191], a[188:191], v[92:95], v[188:191]
    s_waitcnt lgkmcnt(0)
    v_mfma_f32_16x16x32_bf16 v[192:195], a[128:131], v[64:67], v[192:195]
    ds_read_b128 v[80:83], v224 offset:38912
    v_mfma_f32_16x16x32_bf16 v[192:195], a[144:147], v[68:71], v[192:195]
    ds_read_b128 v[84:87], v225 offset:38912
    v_mfma_f32_16x16x32_bf16 v[192:195], a[160:163], v[72:75], v[192:195]
    ds_read_b128 v[88:91], v224 offset:47104
    v_mfma_f32_16x16x32_bf16 v[192:195], a[176:179], v[76:79], v[192:195]
    ds_read_b128 v[92:95], v225 offset:47104
    v_mfma_f32_16x16x32_bf16 v[196:199], a[132:135], v[64:67], v[196:199]
    v_mfma_f32_16x16x32_bf16 v[196:199], a[148:151], v[68:71], v[196:199]
    v_mfma_f32_16x16x32_bf16 v[196:199], a[164:167], v[72:75], v[196:199]
    v_mfma_f32_16x16x32_bf16 v[196:199], a[180:183], v[76:79], v[196:199]
    v_mfma_f32_16x16x32_bf16 v[200:203], a[136:139], v[64:67], v[200:203]
    v_mfma_f32_16x16x32_bf16 v[200:203], a[152:155], v[68:71], v[200:203]
    v_mfma_f32_16x16x32_bf16 v[200:203], a[168:171], v[72:75], v[200:203]
    v_mfma_f32_16x16x32_bf16 v[200:203], a[184:187], v[76:79], v[200:203]
    v_mfma_f32_16x16x32_bf16 v[204:207], a[140:143], v[64:67], v[204:207]
    v_mfma_f32_16x16x32_bf16 v[204:207], a[156:159], v[68:71], v[204:207]
    v_mfma_f32_16x16x32_bf16 v[204:207], a[172:175], v[72:75], v[204:207]
    v_mfma_f32_16x16x32_bf16 v[204:207], a[188:191], v[76:79], v[204:207]
    s_waitcnt lgkmcnt(0)
    v_mfma_f32_16x16x32_bf16 v[208:211], a[128:131], v[80:83], v[208:211]
    ds_read_b128 v[64:67], v224 offset:49152
    v_mfma_f32_16x16x32_bf16 v[208:211], a[144:147], v[84:87], v[208:211]
    ds_read_b128 v[68:71], v224 offset:51200
    v_mfma_f32_16x16x32_bf16 v[208:211], a[160:163], v[88:91], v[208:211]
    ds_read_b128 v[72:75], v224 offset:53248
    v_mfma_f32_16x16x32_bf16 v[208:211], a[176:179], v[92:95], v[208:211]
    ds_read_b128 v[76:79], v224 offset:55296
    s_add_u32 s38, s36, 73728
    buffer_store_dwordx4 v[16:19], v240, s[16:19], s38 offen offset:2560 sc1
    v_mfma_f32_16x16x32_bf16 v[212:215], a[132:135], v[80:83], v[212:215]
    v_mfma_f32_16x16x32_bf16 v[212:215], a[148:151], v[84:87], v[212:215]
    v_mfma_f32_16x16x32_bf16 v[212:215], a[164:167], v[88:91], v[212:215]
    v_mfma_f32_16x16x32_bf16 v[212:215], a[180:183], v[92:95], v[212:215]
    v_mfma_f32_16x16x32_bf16 v[216:219], a[136:139], v[80:83], v[216:219]
    v_mfma_f32_16x16x32_bf16 v[216:219], a[152:155], v[84:87], v[216:219]
    v_mfma_f32_16x16x32_bf16 v[216:219], a[168:171], v[88:91], v[216:219]
    v_mfma_f32_16x16x32_bf16 v[216:219], a[184:187], v[92:95], v[216:219]
    v_mfma_f32_16x16x32_bf16 v[220:223], a[140:143], v[80:83], v[220:223]
    v_mfma_f32_16x16x32_bf16 v[220:223], a[156:159], v[84:87], v[220:223]
    v_mfma_f32_16x16x32_bf16 v[220:223], a[172:175], v[88:91], v[220:223]
    v_mfma_f32_16x16x32_bf16 v[220:223], a[188:191], v[92:95], v[220:223]
    s_waitcnt vmcnt(3)
    v_readfirstlane_b32 s24, v254
    s_lshl_b32 s25, s3, 16
    s_add_u32 s24, s24, s25
    s_cmp_ge_u32 s24, 32
    s_cbranch_scc0 kf_spin33
kf_spinr34:
    s_waitcnt lgkmcnt(0)
    s_barrier
    v_mfma_f32_16x16x32_bf16 v[160:163], a[192:195], v[64:67], v[160:163]
    ds_read_b128 v[80:83], v225 offset:49152
    v_mfma_f32_16x16x32_bf16 v[164:167], a[196:199], v[64:67], v[164:167]
    ds_read_b128 v[84:87], v225 offset:51200
    v_mfma_f32_16x16x32_bf16 v[168:171], a[200:203], v[64:67], v[168:171]
    ds_read_b128 v[88:91], v225 offset:53248
    v_mfma_f32_16x16x32_bf16 v[172:175], a[204:207], v[64:67], v[172:175]
    ds_read_b128 v[92:95], v225 offset:55296
    v_mfma_f32_16x16x32_bf16 v[176:179], a[192:195], v[68:71], v[176:179]
    v_mfma_f32_16x16x32_bf16 v[180:183], a[196:199], v[68:71], v[180:183]
    v_mfma_f32_16x16x32_bf16 v[184:187], a[200:203], v[68:71], v[184:187]
    v_mfma_f32_16x16x32_bf16 v[188:191], a[204:207], v[68:71], v[188:191]
    v_mfma_f32_16x16x32_bf16 v[192:195], a[192:195], v[72:75], v[192:195]
    buffer_load_dwordx4 a[128:131], v248, s[8:11], s28 offen offset:0 sc1
    s_add_u32 s38, s36, 77824
    buffer_store_dwordx4 v[20:23], v240, s[16:19], s38 offen offset:512 sc1
    v_mfma_f32_16x16x32_bf16 v[196:199], a[196:199], v[72:75], v[196:199]
    v_mfma_f32_16x16x32_bf16 v[200:203], a[200:203], v[72:75], v[200:203]
    buffer_load_dwordx4 a[132:135], v248, s[8:11], s29 offen offset:0 sc1
    v_mfma_f32_16x16x32_bf16 v[204:207], a[204:207], v[72:75], v[204:207]
    v_mfma_f32_16x16x32_bf16 v[208:211], a[192:195], v[76:79], v[208:211]
    v_mfma_f32_16x16x32_bf16 v[212:215], a[196:199], v[76:79], v[212:215]
    buffer_load_dwordx4 a[136:139], v249, s[8:11], s28 offen offset:0 sc1
    v_mfma_f32_16x16x32_bf16 v[216:219], a[200:203], v[76:79], v[216:219]
    v_mfma_f32_16x16x32_bf16 v[220:223], a[204:207], v[76:79], v[220:223]
    s_waitcnt lgkmcnt(0)
    v_mfma_f32_16x16x32_bf16 v[160:163], a[208:211], v[80:83], v[160:163]
    ds_read_b128 v[64:67], v224 offset:57344
    v_mfma_f32_16x16x32_bf16 v[164:167], a[212:215], v[80:83], v[164:167]
    ds_read_b128 v[68:71], v224 offset:59392
    v_mfma_f32_16x16x32_bf16 v[168:171], a[216:219], v[80:83], v[168:171]
    ds_read_b128 v[72:75], v224 offset:61440
    v_mfma_f32_16x16x32_bf16 v[172:175], a[220:223], v[80:83], v[172:175]
    ds_read_b128 v[76:79], v224 offset:63488
    v_mfma_f32_16x16x32_bf16 v[176:179], a[208:211], v[84:87], v[176:179]
    v_mfma_f32_16x16x32_bf16 v[180:183], a[212:215], v[84:87], v[180:183]
    v_mfma_f32_16x16x32_bf16 v[184:187], a[216:219], v[84:87], v[184:187]
    v_mfma_f32_16x16x32_bf16 v[188:191], a[220:223], v[84:87], v[188:191]
    v_mfma_f32_16x16x32_bf16 v[192:195], a[208:211], v[88:91], v[192:195]
    buffer_load_dwordx4 a[140:143], v249, s[8:11], s29 offen offset:0 sc1
    v_mfma_f32_16x16x32_bf16 v[196:199], a[212:215], v[88:91], v[196:199]
    v_mfma_f32_16x16x32_bf16 v[200:203], a[216:219], v[88:91], v[200:203]
    buffer_load_dwordx4 a[144:147], v248, s[8:11], s28 offen offset:1024 sc1
    v_mfma_f32_16x16x32_bf16 v[204:207], a[220:223], v[88:91], v[204:207]
    v_mfma_f32_16x16x32_bf16 v[208:211], a[208:211], v[92:95], v[208:211]
    v_mfma_f32_16x16x32_bf16 v[212:215], a[212:215], v[92:95], v[212:215]
    buffer_load_dwordx4 a[148:151], v248, s[8:11], s29 offen offset:1024 sc1
    v_mfma_f32_16x16x32_bf16 v[216:219], a[216:219], v[92:95], v[216:219]
    s_add_u32 s38, s36, 73728
    buffer_store_dwordx4 v[24:27], v240, s[16:19], s38 offen offset:3584 sc1
    v_mfma_f32_16x16x32_bf16 v[220:223], a[220:223], v[92:95], v[220:223]
    s_waitcnt lgkmcnt(0)
    v_mfma_f32_16x16x32_bf16 v[160:163], a[224:227], v[64:67], v[160:163]
    ds_read_b128 v[80:83], v225 offset:57344
    v_mfma_f32_16x16x32_bf16 v[164:167], a[228:231], v[64:67], v[164:167]
    ds_read_b128 v[84:87], v225 offset:59392
    v_mfma_f32_16x16x32_bf16 v[168:171], a[232:235], v[64:67], v[168:171]
    ds_read_b128 v[88:91], v225 offset:61440
    v_mfma_f32_16x16x32_bf16 v[172:175], a[236:239], v[64:67], v[172:175]
    ds_read_b128 v[92:95], v225 offset:63488
    v_mfma_f32_16x16x32_bf16 v[176:179], a[224:227], v[68:71], v[176:179]
    v_mfma_f32_16x16x32_bf16 v[180:183], a[228:231], v[68:71], v[180:183]
    v_mfma_f32_16x16x32_bf16 v[184:187], a[232:235], v[68:71], v[184:187]
    v_mfma_f32_16x16x32_bf16 v[188:191], a[236:239], v[68:71], v[188:191]
    v_mfma_f32_16x16x32_bf16 v[192:195], a[224:227], v[72:75], v[192:195]
    buffer_load_dwordx4 a[152:155], v249, s[8:11], s28 offen offset:1024 sc1
    v_mfma_f32_16x16x32_bf16 v[196:199], a[228:231], v[72:75], v[196:199]
    v_mfma_f32_16x16x32_bf16 v[200:203], a[232:235], v[72:75], v[200:203]
    buffer_load_dwordx4 a[156:159], v249, s[8:11], s29 offen offset:1024 sc1
    v_mfma_f32_16x16x32_bf16 v[204:207], a[236:239], v[72:75], v[204:207]
    v_mfma_f32_16x16x32_bf16 v[208:211], a[224:227], v[76:79], v[208:211]
    v_mfma_f32_16x16x32_bf16 v[212:215], a[228:231], v[76:79], v[212:215]
    buffer_load_dwordx4 a[160:163], v248, s[8:11], s28 offen offset:2048 sc1
    v_mfma_f32_16x16x32_bf16 v[216:219], a[232:235], v[76:79], v[216:219]
    v_mfma_f32_16x16x32_bf16 v[220:223], a[236:239], v[76:79], v[220:223]
    s_waitcnt vmcnt(38) lgkmcnt(0)
    s_barrier
    v_mfma_f32_16x16x32_bf16 v[160:163], a[240:243], v[80:83], v[160:163]
    ds_read_b64_tr_b16 a[192:193], v246 offset:0
    v_mfma_f32_16x16x32_bf16 v[164:167], a[244:247], v[80:83], v[164:167]
    ds_read_b64_tr_b16 a[194:195], v246 offset:1024
    v_mfma_f32_16x16x32_bf16 v[168:171], a[248:251], v[80:83], v[168:171]
    ds_read_b64_tr_b16 a[196:197], v238 offset:0
    v_mfma_f32_16x16x32_bf16 v[172:175], a[252:255], v[80:83], v[172:175]
    ds_read_b64_tr_b16 a[198:199], v238 offset:1024
    v_mfma_f32_16x16x32_bf16 v[176:179], a[240:243], v[84:87], v[176:179]
    ds_read_b64_tr_b16 a[200:201], v246 offset:256
    s_add_u32 s38, s36, 77824
    buffer_store_dwordx4 v[28:31], v240, s[16:19], s38 offen offset:1536 sc1
    v_mfma_f32_16x16x32_bf16 v[180:183], a[244:247], v[84:87], v[180:183]
    ds_read_b64_tr_b16 a[202:203], v246 offset:1280
    v_mfma_f32_16x16x32_bf16 v[184:187], a[248:251], v[84:87], v[184:187]
    ds_read_b64_tr_b16 a[204:205], v238 offset:256
    v_mfma_f32_16x16x32_bf16 v[188:191], a[252:255], v[84:87], v[188:191]
    ds_read_b64_tr_b16 a[206:207], v238 offset:1280
    v_mfma_f32_16x16x32_bf16 v[192:195], a[240:243], v[88:91], v[192:195]
    buffer_load_dwordx4 a[164:167], v248, s[8:11], s29 offen offset:2048 sc1
    v_mfma_f32_16x16x32_bf16 v[196:199], a[244:247], v[88:91], v[196:199]
    v_cvt_pk_bf16_f32 v32, v160, v161
    v_cvt_pk_bf16_f32 v33, v162, v163
    v_mfma_f32_16x16x32_bf16 v[200:203], a[248:251], v[88:91], v[200:203]
    buffer_load_dwordx4 a[168:171], v249, s[8:11], s28 offen offset:2048 sc1
    v_cvt_pk_bf16_f32 v34, v164, v165
    v_cvt_pk_bf16_f32 v35, v166, v167
    v_mfma_f32_16x16x32_bf16 v[204:207], a[252:255], v[88:91], v[204:207]
    v_cvt_pk_bf16_f32 v36, v168, v169
    v_cvt_pk_bf16_f32 v37, v170, v171
    v_mfma_f32_16x16x32_bf16 v[208:211], a[240:243], v[92:95], v[208:211]
    v_cvt_pk_bf16_f32 v38, v172, v173
    v_cvt_pk_bf16_f32 v39, v174, v175
    v_mfma_f32_16x16x32_bf16 v[212:215], a[244:247], v[92:95], v[212:215]
    buffer_load_dwordx4 a[172:175], v249, s[8:11], s29 offen offset:2048 sc1
    v_cvt_pk_bf16_f32 v40, v176, v177
    v_cvt_pk_bf16_f32 v41, v178, v179
    v_mfma_f32_16x16x32_bf16 v[216:219], a[248:251], v[92:95], v[216:219]
    v_cvt_pk_bf16_f32 v42, v180, v181
    v_cvt_pk_bf16_f32 v43, v182, v183
    v_mfma_f32_16x16x32_bf16 v[220:223], a[252:255], v[92:95], v[220:223]
    v_cvt_pk_bf16_f32 v44, v184, v185
    v_cvt_pk_bf16_f32 v45, v186, v187
    s_nop 3
    v_cvt_pk_bf16_f32 v46, v188, v189
    v_cvt_pk_bf16_f32 v47, v190, v191
    v_cvt_pk_bf16_f32 v48, v192, v193
    v_cvt_pk_bf16_f32 v49, v194, v195
    v_cvt_pk_bf16_f32 v50, v196, v197
    v_cvt_pk_bf16_f32 v51, v198, v199
    v_cvt_pk_bf16_f32 v52, v200, v201
    v_cvt_pk_bf16_f32 v53, v202, v203
    v_cvt_pk_bf16_f32 v54, v204, v205
    v_cvt_pk_bf16_f32 v55, v206, v207
    v_cvt_pk_bf16_f32 v56, v208, v209
    v_cvt_pk_bf16_f32 v57, v210, v211
    v_cvt_pk_bf16_f32 v58, v212, v213
    v_cvt_pk_bf16_f32 v59, v214, v215
    v_cvt_pk_bf16_f32 v60, v216, v217
    v_cvt_pk_bf16_f32 v61, v218, v219
    v_cvt_pk_bf16_f32 v62, v220, v221
    v_cvt_pk_bf16_f32 v63, v222, v223
    s_add_u32 s80, s36, 102144
    s_add_u32 s81, s36, 104192
    s_add_u32 s82, s36, 103168
    s_add_u32 s83, s36, 105216
    s_add_u32 s84, s36, 110336
    s_add_u32 s85, s36, 112384
    s_add_u32 s86, s36, 111360
    s_add_u32 s87, s36, 113408
    s_branch ka_Q
ka_V:
    s_waitcnt lgkmcnt(0)
    v_mfma_f32_16x16x32_bf16 v[96:99], v[64:67], a[0:3], 0
    ds_read_b128 v[80:83], v224 offset:8192
    v_mfma_f32_16x16x32_bf16 v[100:103], v[68:71], a[0:3], 0
    ds_read_b128 v[84:87], v224 offset:10240
    v_mfma_f32_16x16x32_bf16 v[104:107], v[64:67], a[4:7], 0
    ds_read_b128 v[88:91], v224 offset:12288
    v_mfma_f32_16x16x32_bf16 v[108:111], v[68:71], a[4:7], 0
    ds_read_b128 v[92:95], v224 offset:14336
    v_mfma_f32_16x16x32_bf16 v[112:115], v[64:67], a[8:11], 0
    ds_read_b64_tr_b16 a[16:17], v228 offset:4096
    v_mfma_f32_16x16x32_bf16 v[116:119], v[68:71], a[8:11], 0
    ds_read_b64_tr_b16 a[18:19], v228 offset:4608
    v_mfma_f32_16x16x32_bf16 v[120:123], v[64:67], a[12:15], 0
    ds_read_b64_tr_b16 a[20:21], v229 offset:4096
    v_mfma_f32_16x16x32_bf16 v[124:127], v[68:71], a[12:15], 0
    ds_read_b64_tr_b16 a[22:23], v229 offset:4608
    v_mfma_f32_16x16x32_bf16 v[128:131], v[72:75], a[0:3], 0
    s_add_u32 m0, s35, 16384
    s_and_b32 s33, s82, 1023
    s_lshl_b32 s33, s33, 12
    buffer_load_dwordx4 v234, s[48:51], s33 offen lds
    v_mfma_f32_16x16x32_bf16 v[132:135], v[76:79], a[0:3], 0
    v_mfma_f32_16x16x32_bf16 v[136:139], v[72:75], a[4:7], 0
    buffer_load_dwordx4 v235, s[48:51], s33 offen offset:1024 lds
    v_mfma_f32_16x16x32_bf16 v[140:143], v[76:79], a[4:7], 0
    v_mfma_f32_16x16x32_bf16 v[144:147], v[72:75], a[8:11], 0
    s_add_u32 m0, s35, 18432
    s_add_u32 s33, s33, 131072
    buffer_load_dwordx4 v234, s[48:51], s33 offen lds
    v_mfma_f32_16x16x32_bf16 v[148:151], v[76:79], a[8:11], 0
    v_mfma_f32_16x16x32_bf16 v[152:155], v[72:75], a[12:15], 0
    buffer_load_dwordx4 v235, s[48:51], s33 offen offset:1024 lds
    v_mfma_f32_16x16x32_bf16 v[156:159], v[76:79], a[12:15], 0
    s_waitcnt lgkmcnt(0)
    v_mfma_f32_16x16x32_bf16 v[160:163], v[80:83], a[0:3], 0
    ds_read_b128 v[64:67], v225 offset:0
    v_mfma_f32_16x16x32_bf16 v[164:167], v[84:87], a[0:3], 0
    ds_read_b128 v[68:71], v225 offset:2048
    v_mfma_f32_16x16x32_bf16 v[168:171], v[80:83], a[4:7], 0
    ds_read_b128 v[72:75], v225 offset:4096
    v_mfma_f32_16x16x32_bf16 v[172:175], v[84:87], a[4:7], 0
    ds_read_b128 v[76:79], v225 offset:6144
    v_mfma_f32_16x16x32_bf16 v[176:179], v[80:83], a[8:11], 0
    ds_read_b64_tr_b16 a[24:25], v230 offset:4096
    v_mfma_f32_16x16x32_bf16 v[180:183], v[84:87], a[8:11], 0
    ds_read_b64_tr_b16 a[26:27], v230 offset:4608
    v_mfma_f32_16x16x32_bf16 v[184:187], v[80:83], a[12:15], 0
    ds_read_b64_tr_b16 a[28:29], v231 offset:4096
    v_mfma_f32_16x16x32_bf16 v[188:191], v[84:87], a[12:15], 0
    ds_read_b64_tr_b16 a[30:31], v231 offset:4608
    v_mfma_f32_16x16x32_bf16 v[192:195], v[88:91], a[0:3], 0
    s_add_u32 m0, s35, 20480
    s_add_u32 s33, s33, 131072
    buffer_load_dwordx4 v234, s[48:51], s33 offen lds
    v_mfma_f32_16x16x32_bf16 v[196:199], v[92:95], a[0:3], 0
    v_mfma_f32_16x16x32_bf16 v[200:203], v[88:91], a[4:7], 0
    buffer_load_dwordx4 v235, s[48:51], s33 offen offset:1024 lds
    v_mfma_f32_16x16x32_bf16 v[204:207], v[92:95], a[4:7], 0
    v_mfma_f32_16x16x32_bf16 v[208:211], v[88:91], a[8:11], 0
    s_add_u32 m0, s35, 22528
    s_add_u32 s33, s33, 131072
    buffer_load_dwordx4 v234, s[48:51], s33 offen lds
    v_mfma_f32_16x16x32_bf16 v[212:215], v[92:95], a[8:11], 0
    v_mfma_f32_16x16x32_bf16 v[216:219], v[88:91], a[12:15], 0
    buffer_load_dwordx4 v235, s[48:51], s33 offen offset:1024 lds
    v_mfma_f32_16x16x32_bf16 v[220:223], v[92:95], a[12:15], 0
    s_waitcnt vmcnt(13) lgkmcnt(0)
    v_mfma_f32_16x16x32_bf16 v[96:99], v[64:67], a[16:19], v[96:99]
    ds_read_b128 v[80:83], v225 offset:8192
    v_mfma_f32_16x16x32_bf16 v[100:103], v[68:71], a[16:19], v[100:103]
    ds_read_b128 v[84:87], v225 offset:10240
    v_mfma_f32_16x16x32_bf16 v[104:107], v[64:67], a[20:23], v[104:107]
    ds_read_b128 v[88:91], v225 offset:12288
    v_mfma_f32_16x16x32_bf16 v[108:111], v[68:71], a[20:23], v[108:111]
    ds_read_b128 v[92:95], v225 offset:14336
    v_mfma_f32_16x16x32_bf16 v[112:115], v[64:67], a[24:27], v[112:115]
    ds_read_b64_tr_b16 a[32:33], v228 offset:8192
    v_mfma_f32_16x16x32_bf16 v[116:119], v[68:71], a[24:27], v[116:119]
    ds_read_b64_tr_b16 a[34:35], v228 offset:8704
    v_mfma_f32_16x16x32_bf16 v[120:123], v[64:67], a[28:31], v[120:123]
    ds_read_b64_tr_b16 a[36:37], v229 offset:8192
    v_mfma_f32_16x16x32_bf16 v[124:127], v[68:71], a[28:31], v[124:127]
    ds_read_b64_tr_b16 a[38:39], v229 offset:8704
    v_mfma_f32_16x16x32_bf16 v[128:131], v[72:75], a[16:19], v[128:131]
    ds_read_b64_tr_b16 a[40:41], v230 offset:8192
    s_add_u32 m0, s34, 32768
    s_add_u32 s37, s82, 0
    buffer_load_dwordx4 v232, s[44:47], s37 offen lds
    v_mfma_f32_16x16x32_bf16 v[132:135], v[76:79], a[16:19], v[132:135]
    ds_read_b64_tr_b16 a[42:43], v230 offset:8704
    buffer_load_dwordx4 v233, s[44:47], s37 offen offset:1024 lds
    v_mfma_f32_16x16x32_bf16 v[136:139], v[72:75], a[20:23], v[136:139]
    ds_read_b64_tr_b16 a[44:45], v231 offset:8192
    s_add_u32 m0, s34, 40960
    s_add_u32 s37, s82, 65536
    buffer_load_dwordx4 v232, s[44:47], s37 offen lds
    v_mfma_f32_16x16x32_bf16 v[140:143], v[76:79], a[20:23], v[140:143]
    ds_read_b64_tr_b16 a[46:47], v231 offset:8704
    buffer_load_dwordx4 v233, s[44:47], s37 offen offset:1024 lds
    v_mfma_f32_16x16x32_bf16 v[144:147], v[72:75], a[24:27], v[144:147]
    s_add_u32 m0, s35, 0
    s_and_b32 s33, s83, 1023
    s_lshl_b32 s33, s33, 12
    buffer_load_dwordx4 v234, s[48:51], s33 offen lds
    v_mfma_f32_16x16x32_bf16 v[148:151], v[76:79], a[24:27], v[148:151]
    buffer_load_dwordx4 v235, s[48:51], s33 offen offset:1024 lds
    v_mfma_f32_16x16x32_bf16 v[152:155], v[72:75], a[28:31], v[152:155]
    s_add_u32 m0, s35, 2048
    s_add_u32 s33, s33, 131072
    buffer_load_dwordx4 v234, s[48:51], s33 offen lds
    v_mfma_f32_16x16x32_bf16 v[156:159], v[76:79], a[28:31], v[156:159]
    buffer_load_dwordx4 v235, s[48:51], s33 offen offset:1024 lds
    s_waitcnt vmcnt(17) lgkmcnt(0)
    s_barrier
    v_mfma_f32_16x16x32_bf16 v[160:163], v[80:83], a[16:19], v[160:163]
    ds_read_b128 v[64:67], v224 offset:16384
    v_mfma_f32_16x16x32_bf16 v[164:167], v[84:87], a[16:19], v[164:167]
    ds_read_b128 v[68:71], v225 offset:16384
    v_mfma_f32_16x16x32_bf16 v[168:171], v[80:83], a[20:23], v[168:171]
    ds_read_b128 v[72:75], v224 offset:18432
    v_mfma_f32_16x16x32_bf16 v[172:175], v[84:87], a[20:23], v[172:175]
    ds_read_b128 v[76:79], v225 offset:18432
    v_mfma_f32_16x16x32_bf16 v[176:179], v[80:83], a[24:27], v[176:179]
    ds_read_b64_tr_b16 a[48:49], v228 offset:12288
    s_add_u32 m0, s34, 49152
    s_add_u32 s37, s83, 0
    buffer_load_dwordx4 v232, s[44:47], s37 offen lds
    v_mfma_f32_16x16x32_bf16 v[180:183], v[84:87], a[24:27], v[180:183]
    ds_read_b64_tr_b16 a[50:51], v228 offset:12800
    buffer_load_dwordx4 v233, s[44:47], s37 offen offset:1024 lds
    v_mfma_f32_16x16x32_bf16 v[184:187], v[80:83], a[28:31], v[184:187]
    ds_read_b64_tr_b16 a[52:53], v229 offset:12288
    s_add_u32 m0, s34, 57344
    s_add_u32 s37, s83, 65536
    buffer_load_dwordx4 v232, s[44:47], s37 offen lds
    v_mfma_f32_16x16x32_bf16 v[188:191], v[84:87], a[28:31], v[188:191]
    ds_read_b64_tr_b16 a[54:55], v229 offset:12800
    buffer_load_dwordx4 v233, s[44:47], s37 offen offset:1024 lds
    v_mfma_f32_16x16x32_bf16 v[192:195], v[88:91], a[16:19], v[192:195]
    ds_read_b64_tr_b16 a[56:57], v230 offset:12288
    s_add_u32 m0, s34, 0
    s_add_u32 s37, s84, 0
    buffer_load_dwordx4 v232, s[44:47], s37 offen lds
    v_mfma_f32_16x16x32_bf16 v[196:199], v[92:95], a[16:19], v[196:199]
    ds_read_b64_tr_b16 a[58:59], v230 offset:12800
    v_mfma_f32_16x16x32_bf16 v[200:203], v[88:91], a[20:23], v[200:203]
    ds_read_b64_tr_b16 a[60:61], v231 offset:12288
    buffer_load_dwordx4 v233, s[44:47], s37 offen offset:1024 lds
    v_mfma_f32_16x16x32_bf16 v[204:207], v[92:95], a[20:23], v[204:207]
    ds_read_b64_tr_b16 a[62:63], v231 offset:12800
    buffer_load_dwordx4 v[0:3], v236, s[52:55], 0 offen offset:0
    v_mfma_f32_16x16x32_bf16 v[208:211], v[88:91], a[24:27], v[208:211]
    buffer_load_dwordx4 v[4:7], v236, s[52:55], 0 offen offset:512
    v_mfma_f32_16x16x32_bf16 v[212:215], v[92:95], a[24:27], v[212:215]
    buffer_load_dwordx4 v[8:11], v236, s[52:55], 0 offen offset:1024
    v_mfma_f32_16x16x32_bf16 v[216:219], v[88:91], a[28:31], v[216:219]
    buffer_load_dwordx4 v[12:15], v236, s[52:55], 0 offen offset:1536
    v_mfma_f32_16x16x32_bf16 v[220:223], v[92:95], a[28:31], v[220:223]
    s_waitcnt lgkmcnt(0)
    v_mfma_f32_16x16x32_bf16 v[96:99], v[64:67], a[32:35], v[96:99]
    ds_read_b128 v[80:83], v224 offset:20480
    v_mfma_f32_16x16x32_bf16 v[96:99], v[68:71], a[48:51], v[96:99]
    ds_read_b128 v[84:87], v225 offset:20480
    v_mfma_f32_16x16x32_bf16 v[100:103], v[72:75], a[32:35], v[100:103]
    ds_read_b128 v[88:91], v224 offset:22528
    v_mfma_f32_16x16x32_bf16 v[100:103], v[76:79], a[48:51], v[100:103]
    ds_read_b128 v[92:95], v225 offset:22528
    v_mfma_f32_16x16x32_bf16 v[104:107], v[64:67], a[36:39], v[104:107]
    v_mfma_f32_16x16x32_bf16 v[104:107], v[68:71], a[52:55], v[104:107]
    v_mfma_f32_16x16x32_bf16 v[108:111], v[72:75], a[36:39], v[108:111]
    v_mfma_f32_16x16x32_bf16 v[108:111], v[76:79], a[52:55], v[108:111]
    v_mfma_f32_16x16x32_bf16 v[112:115], v[64:67], a[40:43], v[112:115]
    s_add_u32 m0, s35, 4096
    s_add_u32 s33, s33, 131072
    buffer_load_dwordx4 v234, s[48:51], s33 offen lds
    v_mfma_f32_16x16x32_bf16 v[112:115], v[68:71], a[56:59], v[112:115]
    v_mfma_f32_16x16x32_bf16 v[116:119], v[72:75], a[40:43], v[116:119]
    buffer_load_dwordx4 v235, s[48:51], s33 offen offset:1024 lds
    v_mfma_f32_16x16x32_bf16 v[116:119], v[76:79], a[56:59], v[116:119]
    v_mfma_f32_16x16x32_bf16 v[120:123], v[64:67], a[44:47], v[120:123]
    s_add_u32 m0, s35, 6144
    s_add_u32 s33, s33, 131072
    buffer_load_dwordx4 v234, s[48:51], s33 offen lds
    v_mfma_f32_16x16x32_bf16 v[120:123], v[68:71], a[60:63], v[120:123]
    v_mfma_f32_16x16x32_bf16 v[124:127], v[72:75], a[44:47], v[124:127]
    buffer_load_dwordx4 v235, s[48:51], s33 offen offset:1024 lds
    v_mfma_f32_16x16x32_bf16 v[124:127], v[76:79], a[60:63], v[124:127]
    s_waitcnt lgkmcnt(0)
    v_mfma_f32_16x16x32_bf16 v[128:131], v[80:83], a[32:35], v[128:131]
    ds_read_b128 v[64:67], v224 offset:24576
    v_mfma_f32_16x16x32_bf16 v[128:131], v[84:87], a[48:51], v[128:131]
    ds_read_b128 v[68:71], v225 offset:24576
    v_mfma_f32_16x16x32_bf16 v[132:135], v[88:91], a[32:35], v[132:135]
    ds_read_b128 v[72:75], v224 offset:26624
    v_mfma_f32_16x16x32_bf16 v[132:135], v[92:95], a[48:51], v[132:135]
    ds_read_b128 v[76:79], v225 offset:26624
    v_mfma_f32_16x16x32_bf16 v[136:139], v[80:83], a[36:39], v[136:139]
    v_mfma_f32_16x16x32_bf16 v[136:139], v[84:87], a[52:55], v[136:139]
    v_mfma_f32_16x16x32_bf16 v[140:143], v[88:91], a[36:39], v[140:143]
    v_mfma_f32_16x16x32_bf16 v[140:143], v[92:95], a[52:55], v[140:143]
    v_mfma_f32_16x16x32_bf16 v[144:147], v[80:83], a[40:43], v[144:147]
    s_add_u32 m0, s34, 8192
    s_add_u32 s37, s84, 65536
    buffer_load_dwordx4 v232, s[44:47], s37 offen lds
    v_mfma_f32_16x16x32_bf16 v[144:147], v[84:87], a[56:59], v[144:147]
    v_mfma_f32_16x16x32_bf16 v[148:151], v[88:91], a[40:43], v[148:151]
    v_mfma_f32_16x16x32_bf16 v[148:151], v[92:95], a[56:59], v[148:151]
    v_mfma_f32_16x16x32_bf16 v[152:155], v[80:83], a[44:47], v[152:155]
    buffer_load_dwordx4 v233, s[44:47], s37 offen offset:1024 lds
    v_mfma_f32_16x16x32_bf16 v[152:155], v[84:87], a[60:63], v[152:155]
    v_mfma_f32_16x16x32_bf16 v[156:159], v[88:91], a[44:47], v[156:159]
    v_mfma_f32_16x16x32_bf16 v[156:159], v[92:95], a[60:63], v[156:159]
    s_waitcnt vmcnt(24) lgkmcnt(0)
    v_mfma_f32_16x16x32_bf16 v[160:163], v[64:67], a[32:35], v[160:163]
    ds_read_b128 v[80:83], v224 offset:28672
    v_mfma_f32_16x16x32_bf16 v[160:163], v[68:71], a[48:51], v[160:163]
    ds_read_b128 v[84:87], v225 offset:28672
    v_mfma_f32_16x16x32_bf16 v[164:167], v[72:75], a[32:35], v[164:167]
    ds_read_b128 v[88:91], v224 offset:30720
    v_mfma_f32_16x16x32_bf16 v[164:167], v[76:79], a[48:51], v[164:167]
    ds_read_b128 v[92:95], v225 offset:30720
    v_mfma_f32_16x16x32_bf16 v[168:171], v[64:67], a[36:39], v[168:171]
    ds_read_b64_tr_b16 a[64:65], v228 offset:16384
    v_mfma_f32_16x16x32_bf16 v[168:171], v[68:71], a[52:55], v[168:171]
    ds_read_b64_tr_b16 a[66:67], v228 offset:16896
    v_mfma_f32_16x16x32_bf16 v[172:175], v[72:75], a[36:39], v[172:175]
    ds_read_b64_tr_b16 a[68:69], v229 offset:16384
    v_mfma_f32_16x16x32_bf16 v[172:175], v[76:79], a[52:55], v[172:175]
    ds_read_b64_tr_b16 a[70:71], v229 offset:16896
    v_mfma_f32_16x16x32_bf16 v[176:179], v[64:67], a[40:43], v[176:179]
    ds_read_b64_tr_b16 a[72:73], v230 offset:16384
    s_add_u32 m0, s35, 8192
    s_and_b32 s33, s84, 1023
    s_lshl_b32 s33, s33, 12
    buffer_load_dwordx4 v234, s[48:51], s33 offen lds
    v_mfma_f32_16x16x32_bf16 v[176:179], v[68:71], a[56:59], v[176:179]
    ds_read_b64_tr_b16 a[74:75], v230 offset:16896
    v_mfma_f32_16x16x32_bf16 v[180:183], v[72:75], a[40:43], v[180:183]
    ds_read_b64_tr_b16 a[76:77], v231 offset:16384
    buffer_load_dwordx4 v235, s[48:51], s33 offen offset:1024 lds
    v_mfma_f32_16x16x32_bf16 v[180:183], v[76:79], a[56:59], v[180:183]
    ds_read_b64_tr_b16 a[78:79], v231 offset:16896
    v_mfma_f32_16x16x32_bf16 v[184:187], v[64:67], a[44:47], v[184:187]
    s_add_u32 m0, s35, 10240
    s_add_u32 s33, s33, 131072
    buffer_load_dwordx4 v234, s[48:51], s33 offen lds
    v_mfma_f32_16x16x32_bf16 v[184:187], v[68:71], a[60:63], v[184:187]
    v_mfma_f32_16x16x32_bf16 v[188:191], v[72:75], a[44:47], v[188:191]
    buffer_load_dwordx4 v235, s[48:51], s33 offen offset:1024 lds
    v_mfma_f32_16x16x32_bf16 v[188:191], v[76:79], a[60:63], v[188:191]
    s_waitcnt vmcnt(24) lgkmcnt(0)
    s_barrier
    v_mfma_f32_16x16x32_bf16 v[192:195], v[80:83], a[32:35], v[192:195]
    ds_read_b128 v[64:67], v224 offset:32768
    v_mfma_f32_16x16x32_bf16 v[192:195], v[84:87], a[48:51], v[192:195]
    ds_read_b128 v[68:71], v225 offset:32768
    v_mfma_f32_16x16x32_bf16 v[196:199], v[88:91], a[32:35], v[196:199]
    ds_read_b128 v[72:75], v224 offset:34816
    v_mfma_f32_16x16x32_bf16 v[196:199], v[92:95], a[48:51], v[196:199]
    ds_read_b128 v[76:79], v225 offset:34816
    v_mfma_f32_16x16x32_bf16 v[200:203], v[80:83], a[36:39], v[200:203]
    ds_read_b64_tr_b16 a[80:81], v228 offset:20480
    v_mfma_f32_16x16x32_bf16 v[200:203], v[84:87], a[52:55], v[200:203]
    ds_read_b64_tr_b16 a[82:83], v228 offset:20992
    v_mfma_f32_16x16x32_bf16 v[204:207], v[88:91], a[36:39], v[204:207]
    ds_read_b64_tr_b16 a[84:85], v229 offset:20480
    v_mfma_f32_16x16x32_bf16 v[204:207], v[92:95], a[52:55], v[204:207]
    ds_read_b64_tr_b16 a[86:87], v229 offset:20992
    v_mfma_f32_16x16x32_bf16 v[208:211], v[80:83], a[40:43], v[208:211]
    ds_read_b64_tr_b16 a[88:89], v230 offset:20480
    s_add_u32 m0, s34, 16384
    s_add_u32 s37, s85, 0
    buffer_load_dwordx4 v232, s[44:47], s37 offen lds
    v_mfma_f32_16x16x32_bf16 v[208:211], v[84:87], a[56:59], v[208:211]
    ds_read_b64_tr_b16 a[90:91], v230 offset:20992
    v_mfma_f32_16x16x32_bf16 v[212:215], v[88:91], a[40:43], v[212:215]
    ds_read_b64_tr_b16 a[92:93], v231 offset:20480
    v_mfma_f32_16x16x32_bf16 v[212:215], v[92:95], a[56:59], v[212:215]
    ds_read_b64_tr_b16 a[94:95], v231 offset:20992
    v_mfma_f32_16x16x32_bf16 v[216:219], v[80:83], a[44:47], v[216:219]
    buffer_load_dwordx4 v233, s[44:47], s37 offen offset:1024 lds
    v_mfma_f32_16x16x32_bf16 v[216:219], v[84:87], a[60:63], v[216:219]
    v_mfma_f32_16x16x32_bf16 v[220:223], v[88:91], a[44:47], v[220:223]
    v_mfma_f32_16x16x32_bf16 v[220:223], v[92:95], a[60:63], v[220:223]
    s_waitcnt lgkmcnt(0)
    v_mfma_f32_16x16x32_bf16 v[96:99], v[64:67], a[64:67], v[96:99]
    ds_read_b128 v[80:83], v224 offset:36864
    v_mfma_f32_16x16x32_bf16 v[96:99], v[68:71], a[80:83], v[96:99]
    ds_read_b128 v[84:87], v225 offset:36864
    v_mfma_f32_16x16x32_bf16 v[100:103], v[72:75], a[64:67], v[100:103]
    ds_read_b128 v[88:91], v224 offset:38912
    v_mfma_f32_16x16x32_bf16 v[100:103], v[76:79], a[80:83], v[100:103]
    ds_read_b128 v[92:95], v225 offset:38912
    v_mfma_f32_16x16x32_bf16 v[104:107], v[64:67], a[68:71], v[104:107]
    v_mfma_f32_16x16x32_bf16 v[104:107], v[68:71], a[84:87], v[104:107]
    v_mfma_f32_16x16x32_bf16 v[108:111], v[72:75], a[68:71], v[108:111]
    v_mfma_f32_16x16x32_bf16 v[108:111], v[76:79], a[84:87], v[108:111]
    v_mfma_f32_16x16x32_bf16 v[112:115], v[64:67], a[72:75], v[112:115]
    s_add_u32 m0, s35, 12288
    s_add_u32 s33, s33, 131072
    buffer_load_dwordx4 v234, s[48:51], s33 offen lds
    v_mfma_f32_16x16x32_bf16 v[112:115], v[68:71], a[88:91], v[112:115]
    v_mfma_f32_16x16x32_bf16 v[116:119], v[72:75], a[72:75], v[116:119]
    buffer_load_dwordx4 v235, s[48:51], s33 offen offset:1024 lds
    v_mfma_f32_16x16x32_bf16 v[116:119], v[76:79], a[88:91], v[116:119]
    v_mfma_f32_16x16x32_bf16 v[120:123], v[64:67], a[76:79], v[120:123]
    s_add_u32 m0, s35, 14336
    s_add_u32 s33, s33, 131072
    buffer_load_dwordx4 v234, s[48:51], s33 offen lds
    v_mfma_f32_16x16x32_bf16 v[120:123], v[68:71], a[92:95], v[120:123]
    v_mfma_f32_16x16x32_bf16 v[124:127], v[72:75], a[76:79], v[124:127]
    buffer_load_dwordx4 v235, s[48:51], s33 offen offset:1024 lds
    v_mfma_f32_16x16x32_bf16 v[124:127], v[76:79], a[92:95], v[124:127]
    s_waitcnt lgkmcnt(0)
    v_mfma_f32_16x16x32_bf16 v[128:131], v[80:83], a[64:67], v[128:131]
    ds_read_b128 v[64:67], v224 offset:40960
    v_mfma_f32_16x16x32_bf16 v[128:131], v[84:87], a[80:83], v[128:131]
    ds_read_b128 v[68:71], v225 offset:40960
    v_mfma_f32_16x16x32_bf16 v[132:135], v[88:91], a[64:67], v[132:135]
    ds_read_b128 v[72:75], v224 offset:43008
    v_mfma_f32_16x16x32_bf16 v[132:135], v[92:95], a[80:83], v[132:135]
    ds_read_b128 v[76:79], v225 offset:43008
    v_mfma_f32_16x16x32_bf16 v[136:139], v[80:83], a[68:71], v[136:139]
    v_mfma_f32_16x16x32_bf16 v[136:139], v[84:87], a[84:87], v[136:139]
    v_mfma_f32_16x16x32_bf16 v[140:143], v[88:91], a[68:71], v[140:143]
    v_mfma_f32_16x16x32_bf16 v[140:143], v[92:95], a[84:87], v[140:143]
    v_mfma_f32_16x16x32_bf16 v[144:147], v[80:83], a[72:75], v[144:147]
    s_add_u32 m0, s34, 24576
    s_add_u32 s37, s85, 65536
    buffer_load_dwordx4 v232, s[44:47], s37 offen lds
    v_mfma_f32_16x16x32_bf16 v[144:147], v[84:87], a[88:91], v[144:147]
    v_mfma_f32_16x16x32_bf16 v[148:151], v[88:91], a[72:75], v[148:151]
    v_mfma_f32_16x16x32_bf16 v[148:151], v[92:95], a[88:91], v[148:151]
    v_mfma_f32_16x16x32_bf16 v[152:155], v[80:83], a[76:79], v[152:155]
    buffer_load_dwordx4 v233, s[44:47], s37 offen offset:1024 lds
    v_mfma_f32_16x16x32_bf16 v[152:155], v[84:87], a[92:95], v[152:155]
    v_mfma_f32_16x16x32_bf16 v[156:159], v[88:91], a[76:79], v[156:159]
    v_mfma_f32_16x16x32_bf16 v[156:159], v[92:95], a[92:95], v[156:159]
    s_waitcnt vmcnt(14) lgkmcnt(0)
    v_mfma_f32_16x16x32_bf16 v[160:163], v[64:67], a[64:67], v[160:163]
    ds_read_b128 v[80:83], v224 offset:45056
    s_waitcnt vmcnt(18)
    v_mfma_f32_16x16x32_bf16 v[160:163], v[68:71], a[80:83], v[160:163]
    ds_read_b128 v[84:87], v225 offset:45056
    v_lshlrev_b32_e64 v16, 16, v0
    v_mfma_f32_16x16x32_bf16 v[164:167], v[72:75], a[64:67], v[164:167]
    ds_read_b128 v[88:91], v224 offset:47104
    v_and_b32 v17, 0xffff0000, v0
    v_lshlrev_b32_e64 v18, 16, v1
    v_mfma_f32_16x16x32_bf16 v[164:167], v[76:79], a[80:83], v[164:167]
    ds_read_b128 v[92:95], v225 offset:47104
    v_and_b32 v19, 0xffff0000, v1
    v_mfma_f32_16x16x32_bf16 v[168:171], v[64:67], a[68:71], v[168:171]
    ds_read_b64_tr_b16 a[96:97], v228 offset:0
    v_lshlrev_b32_e64 v20, 16, v2
    v_mfma_f32_16x16x32_bf16 v[168:171], v[68:71], a[84:87], v[168:171]
    ds_read_b64_tr_b16 a[98:99], v228 offset:512
    v_and_b32 v21, 0xffff0000, v2
    v_mfma_f32_16x16x32_bf16 v[172:175], v[72:75], a[68:71], v[172:175]
    ds_read_b64_tr_b16 a[100:101], v229 offset:0
    v_lshlrev_b32_e64 v22, 16, v3
    v_mfma_f32_16x16x32_bf16 v[172:175], v[76:79], a[84:87], v[172:175]
    ds_read_b64_tr_b16 a[102:103], v229 offset:512
    v_and_b32 v23, 0xffff0000, v3
    v_mfma_f32_16x16x32_bf16 v[176:179], v[64:67], a[72:75], v[176:179]
    ds_read_b64_tr_b16 a[104:105], v230 offset:0
    s_add_u32 m0, s35, 16384
    s_and_b32 s33, s85, 1023
    s_lshl_b32 s33, s33, 12
    buffer_load_dwordx4 v234, s[48:51], s33 offen lds
    v_mfma_f32_16x16x32_bf16 v[176:179], v[68:71], a[88:91], v[176:179]
    ds_read_b64_tr_b16 a[106:107], v230 offset:512
    buffer_load_dwordx4 v235, s[48:51], s33 offen offset:1024 lds
    v_mfma_f32_16x16x32_bf16 v[180:183], v[72:75], a[72:75], v[180:183]
    ds_read_b64_tr_b16 a[108:109], v231 offset:0
    s_add_u32 m0, s35, 18432
    s_add_u32 s33, s33, 131072
    buffer_load_dwordx4 v234, s[48:51], s33 offen lds
    v_mfma_f32_16x16x32_bf16 v[180:183], v[76:79], a[88:91], v[180:183]
    ds_read_b64_tr_b16 a[110:111], v231 offset:512
    v_lshlrev_b32 v24, 16, v4
    v_and_b32 v25, 0xffff0000, v4
    v_mfma_f32_16x16x32_bf16 v[184:187], v[64:67], a[76:79], v[184:187]
    buffer_load_dwordx4 v235, s[48:51], s33 offen offset:1024 lds
    v_lshlrev_b32_e64 v26, 16, v5
    v_mfma_f32_16x16x32_bf16 v[184:187], v[68:71], a[92:95], v[184:187]
    s_lshl2_add_u32 s26, s4, s3
    s_lshl_b32 s26, s26, 10
    s_add_u32 s26, s26, s32
    s_add_u32 s26, s26, 131072
    v_mfma_f32_16x16x32_bf16 v[188:191], v[72:75], a[76:79], v[188:191]
    v_and_b32 v226, 0x40000380, v251
    buffer_load_dword v241, v226, s[44:47], s26 offen
    v_mfma_f32_16x16x32_bf16 v[188:191], v[76:79], a[92:95], v[188:191]
    s_waitcnt vmcnt(29) lgkmcnt(0)
    s_barrier
    v_mfma_f32_16x16x32_bf16 v[192:195], v[80:83], a[64:67], v[192:195]
    ds_read_b128 v[64:67], v224 offset:49152
    v_and_b32 v27, 0xffff0000, v5
    v_mfma_f32_16x16x32_bf16 v[192:195], v[84:87], a[80:83], v[192:195]
    ds_read_b128 v[68:71], v225 offset:49152
    v_lshlrev_b32 v28, 16, v6
    v_mfma_f32_16x16x32_bf16 v[196:199], v[88:91], a[64:67], v[196:199]
    ds_read_b128 v[72:75], v224 offset:51200
    v_and_b32 v29, 0xffff0000, v6
    v_mfma_f32_16x16x32_bf16 v[196:199], v[92:95], a[80:83], v[196:199]
    ds_read_b128 v[76:79], v225 offset:51200
    v_lshlrev_b32_e64 v30, 16, v7
    v_and_b32 v31, 0xffff0000, v7
    v_mfma_f32_16x16x32_bf16 v[200:203], v[80:83], a[68:71], v[200:203]
    ds_read_b64_tr_b16 a[112:113], v228 offset:4096
    v_lshlrev_b32_e64 v32, 16, v8
    v_mfma_f32_16x16x32_bf16 v[200:203], v[84:87], a[84:87], v[200:203]
    ds_read_b64_tr_b16 a[114:115], v228 offset:4608
    v_and_b32 v33, 0xffff0000, v8
    v_mfma_f32_16x16x32_bf16 v[204:207], v[88:91], a[68:71], v[204:207]
    ds_read_b64_tr_b16 a[116:117], v229 offset:4096
    v_lshlrev_b32_e64 v34, 16, v9
    v_mfma_f32_16x16x32_bf16 v[204:207], v[92:95], a[84:87], v[204:207]
    ds_read_b64_tr_b16 a[118:119], v229 offset:4608
    v_and_b32 v35, 0xffff0000, v9
    v_mfma_f32_16x16x32_bf16 v[208:211], v[80:83], a[72:75], v[208:211]
    ds_read_b64_tr_b16 a[120:121], v230 offset:4096
    s_add_u32 m0, s34, 32768
    s_add_u32 s37, s86, 0
    buffer_load_dwordx4 v232, s[44:47], s37 offen lds
    v_mfma_f32_16x16x32_bf16 v[208:211], v[84:87], a[88:91], v[208:211]
    ds_read_b64_tr_b16 a[122:123], v230 offset:4608
    v_lshlrev_b32 v36, 16, v10
    v_mfma_f32_16x16x32_bf16 v[212:215], v[88:91], a[72:75], v[212:215]
    ds_read_b64_tr_b16 a[124:125], v231 offset:4096
    v_and_b32 v37, 0xffff0000, v10
    v_lshlrev_b32_e64 v38, 16, v11
    v_mfma_f32_16x16x32_bf16 v[212:215], v[92:95], a[88:91], v[212:215]
    ds_read_b64_tr_b16 a[126:127], v231 offset:4608
    v_and_b32 v39, 0xffff0000, v11
    v_mfma_f32_16x16x32_bf16 v[216:219], v[80:83], a[76:79], v[216:219]
    buffer_load_dwordx4 v233, s[44:47], s37 offen offset:1024 lds
    v_lshlrev_b32_e64 v40, 16, v12
    v_mfma_f32_16x16x32_bf16 v[216:219], v[84:87], a[92:95], v[216:219]
    v_and_b32 v41, 0xffff0000, v12
    v_lshlrev_b32_e64 v42, 16, v13
    v_mfma_f32_16x16x32_bf16 v[220:223], v[88:91], a[76:79], v[220:223]
    v_and_b32 v43, 0xffff0000, v13
    v_lshlrev_b32_e64 v44, 16, v14
    v_and_b32 v45, 0xffff0000, v14
    v_mfma_f32_16x16x32_bf16 v[220:223], v[92:95], a[92:95], v[220:223]
    v_lshlrev_b32 v46, 16, v15
    s_waitcnt lgkmcnt(0)
    v_mfma_f32_16x16x32_bf16 v[96:99], v[64:67], a[96:99], v[96:99]
    ds_read_b128 v[80:83], v224 offset:53248
    v_and_b32 v47, 0xffff0000, v15
    v_mfma_f32_16x16x32_bf16 v[96:99], v[68:71], a[112:115], v[96:99]
    ds_read_b128 v[84:87], v225 offset:53248
    v_add_f32_e64 v52, v16, v20
    v_mfma_f32_16x16x32_bf16 v[100:103], v[72:75], a[96:99], v[100:103]
    ds_read_b128 v[88:91], v224 offset:55296
    v_add_f32_e64 v53, v17, v21
    v_mfma_f32_16x16x32_bf16 v[100:103], v[76:79], a[112:115], v[100:103]
    ds_read_b128 v[92:95], v225 offset:55296
    v_add_f32 v54, v18, v22
    v_add_f32 v55, v19, v23
    v_mfma_f32_16x16x32_bf16 v[104:107], v[64:67], a[100:103], v[104:107]
    v_add_f32 v52, v52, v24
    v_add_f32 v53, v53, v25
    v_mfma_f32_16x16x32_bf16 v[104:107], v[68:71], a[116:119], v[104:107]
    v_add_f32 v54, v54, v26
    v_add_f32 v55, v55, v27
    v_mfma_f32_16x16x32_bf16 v[108:111], v[72:75], a[100:103], v[108:111]
    v_add_f32 v52, v52, v28
    v_add_f32 v53, v53, v29
    v_add_f32_e64 v54, v54, v30
    v_mfma_f32_16x16x32_bf16 v[108:111], v[76:79], a[116:119], v[108:111]
    v_add_f32 v55, v55, v31
    v_add_f32 v52, v52, v32
    v_mfma_f32_16x16x32_bf16 v[112:115], v[64:67], a[104:107], v[112:115]
    s_add_u32 m0, s35, 20480
    s_add_u32 s33, s33, 131072
    buffer_load_dwordx4 v234, s[48:51], s33 offen lds
    v_mfma_f32_16x16x32_bf16 v[112:115], v[68:71], a[120:123], v[112:115]
    v_add_f32 v53, v53, v33
    v_add_f32 v54, v54, v34
    v_mfma_f32_16x16x32_bf16 v[116:119], v[72:75], a[104:107], v[116:119]
    buffer_load_dwordx4 v235, s[48:51], s33 offen offset:1024 lds
    v_add_f32 v55, v55, v35
    v_add_f32 v52, v52, v36
    v_mfma_f32_16x16x32_bf16 v[116:119], v[76:79], a[120:123], v[116:119]
    v_add_f32 v53, v53, v37
    v_add_f32 v54, v54, v38
    v_mfma_f32_16x16x32_bf16 v[120:123], v[64:67], a[108:111], v[120:123]
    s_add_u32 m0, s35, 22528
    s_add_u32 s33, s33, 131072
    buffer_load_dwordx4 v234, s[48:51], s33 offen lds
    v_mfma_f32_16x16x32_bf16 v[120:123], v[68:71], a[124:127], v[120:123]
    v_add_f32 v55, v55, v39
    v_add_f32 v52, v52, v40
    v_mfma_f32_16x16x32_bf16 v[124:127], v[72:75], a[108:111], v[124:127]
    buffer_load_dwordx4 v235, s[48:51], s33 offen offset:1024 lds
    v_add_f32 v53, v53, v41
    v_add_f32 v54, v54, v42
    v_mfma_f32_16x16x32_bf16 v[124:127], v[76:79], a[124:127], v[124:127]
    v_add_f32 v55, v55, v43
    s_waitcnt lgkmcnt(0)
    v_mfma_f32_16x16x32_bf16 v[128:131], v[80:83], a[96:99], v[128:131]
    ds_read_b128 v[64:67], v224 offset:57344
    v_add_f32_e64 v52, v52, v44
    v_mfma_f32_16x16x32_bf16 v[128:131], v[84:87], a[112:115], v[128:131]
    ds_read_b128 v[68:71], v225 offset:57344
    v_add_f32_e64 v53, v53, v45
    v_mfma_f32_16x16x32_bf16 v[132:135], v[88:91], a[96:99], v[132:135]
    ds_read_b128 v[72:75], v224 offset:59392
    v_add_f32_e64 v54, v54, v46
    v_mfma_f32_16x16x32_bf16 v[132:135], v[92:95], a[112:115], v[132:135]
    ds_read_b128 v[76:79], v225 offset:59392
    v_add_f32 v55, v55, v47
    v_add_f32 v52, v52, v53
    v_mfma_f32_16x16x32_bf16 v[136:139], v[80:83], a[100:103], v[136:139]
    v_add_f32 v54, v54, v55
    v_add_f32 v48, v52, v54
    v_mfma_f32_16x16x32_bf16 v[136:139], v[84:87], a[116:119], v[136:139]
    s_nop 1
    v_add_f32_dpp v48, v48, v48 quad_perm:[1,0,3,2] row_mask:0xf bank_mask:0xf
    v_mfma_f32_16x16x32_bf16 v[140:143], v[88:91], a[100:103], v[140:143]
    s_nop 1
    v_add_f32_dpp v48, v48, v48 quad_perm:[2,3,0,1] row_mask:0xf bank_mask:0xf
    s_nop 1
    v_mfma_f32_16x16x32_bf16 v[140:143], v[92:95], a[116:119], v[140:143]
    v_add_f32_dpp v48, v48, v48 row_half_mirror row_mask:0xf bank_mask:0xf
    s_nop 1
    v_mfma_f32_16x16x32_bf16 v[144:147], v[80:83], a[104:107], v[144:147]
    s_add_u32 m0, s34, 40960
    s_add_u32 s37, s86, 65536
    buffer_load_dwordx4 v232, s[44:47], s37 offen lds
    v_mfma_f32_16x16x32_bf16 v[144:147], v[84:87], a[120:123], v[144:147]
    v_add_f32_dpp v48, v48, v48 row_mirror row_mask:0xf bank_mask:0xf
    s_nop 0
    v_mfma_f32_16x16x32_bf16 v[148:151], v[88:91], a[104:107], v[148:151]
    buffer_load_dwordx4 v233, s[44:47], s37 offen offset:1024 lds
    v_mov_b32_e64 v49, v48
    s_nop 1
    v_mfma_f32_16x16x32_bf16 v[148:151], v[92:95], a[120:123], v[148:151]
    v_permlane16_swap_b32 v48, v49
    s_nop 0
    v_mfma_f32_16x16x32_bf16 v[152:155], v[80:83], a[108:111], v[152:155]
    v_lshlrev_b32_e64 v227, 3, v240
    v_min_u32 v227, 1920, v227
    s_lshl2_add_u32 s25, s2, s3
    v_mfma_f32_16x16x32_bf16 v[152:155], v[84:87], a[124:127], v[152:155]
    v_add_f32 v48, v48, v49
    v_mul_f32 v48, 0x3a800000, v48
    v_mfma_f32_16x16x32_bf16 v[156:159], v[88:91], a[108:111], v[156:159]
    s_lshl_b32 s25, s25, 13
    s_add_u32 s25, s25, 0
    buffer_load_dword v241, v227, s[12:15], s25 offen
    v_mfma_f32_16x16x32_bf16 v[156:159], v[92:95], a[124:127], v[156:159]
    v_sub_f32 v56, v16, v48
    s_waitcnt vmcnt(16) lgkmcnt(0)
    v_mfma_f32_16x16x32_bf16 v[160:163], v[64:67], a[96:99], v[160:163]
    ds_read_b128 v[80:83], v224 offset:61440
    v_mul_f32 v52, v56, v56
    v_sub_f32 v57, v17, v48
    v_mfma_f32_16x16x32_bf16 v[160:163], v[68:71], a[112:115], v[160:163]
    ds_read_b128 v[84:87], v225 offset:61440
    v_mul_f32_e64 v53, v57, v57
    v_mfma_f32_16x16x32_bf16 v[164:167], v[72:75], a[96:99], v[164:167]
    ds_read_b128 v[88:91], v224 offset:63488
    v_sub_f32_e64 v58, v18, v48
    v_mfma_f32_16x16x32_bf16 v[164:167], v[76:79], a[112:115], v[164:167]
    ds_read_b128 v[92:95], v225 offset:63488
    v_mul_f32_e64 v54, v58, v58
    v_mfma_f32_16x16x32_bf16 v[168:171], v[64:67], a[100:103], v[168:171]
    ds_read_b64_tr_b16 a[128:129], v228 offset:8192
    v_sub_f32_e64 v59, v19, v48
    v_mfma_f32_16x16x32_bf16 v[168:171], v[68:71], a[116:119], v[168:171]
    ds_read_b64_tr_b16 a[130:131], v228 offset:8704
    v_mul_f32 v55, v59, v59
    v_sub_f32 v56, v20, v48
    v_mfma_f32_16x16x32_bf16 v[172:175], v[72:75], a[100:103], v[172:175]
    ds_read_b64_tr_b16 a[132:133], v229 offset:8192
    v_fmac_f32_e64 v52, v56, v56
    v_mfma_f32_16x16x32_bf16 v[172:175], v[76:79], a[116:119], v[172:175]
    ds_read_b64_tr_b16 a[134:135], v229 offset:8704
    v_sub_f32_e64 v57, v21, v48
    v_mfma_f32_16x16x32_bf16 v[176:179], v[64:67], a[104:107], v[176:179]
    ds_read_b64_tr_b16 a[136:137], v230 offset:8192
    s_add_u32 m0, s35, 0
    s_and_b32 s33, s86, 1023
    s_lshl_b32 s33, s33, 12
    buffer_load_dwordx4 v234, s[48:51], s33 offen lds
    v_mfma_f32_16x16x32_bf16 v[176:179], v[68:71], a[120:123], v[176:179]
    ds_read_b64_tr_b16 a[138:139], v230 offset:8704
    v_fmac_f32_e64 v53, v57, v57
    v_mfma_f32_16x16x32_bf16 v[180:183], v[72:75], a[104:107], v[180:183]
    ds_read_b64_tr_b16 a[140:141], v231 offset:8192
    buffer_load_dwordx4 v235, s[48:51], s33 offen offset:1024 lds
    v_mfma_f32_16x16x32_bf16 v[180:183], v[76:79], a[120:123], v[180:183]
    ds_read_b64_tr_b16 a[142:143], v231 offset:8704
    v_sub_f32_e64 v58, v22, v48
    v_mfma_f32_16x16x32_bf16 v[184:187], v[64:67], a[108:111], v[184:187]
    s_add_u32 m0, s35, 2048
    s_add_u32 s33, s33, 131072
    buffer_load_dwordx4 v234, s[48:51], s33 offen lds
    v_mfma_f32_16x16x32_bf16 v[184:187], v[68:71], a[124:127], v[184:187]
    v_fmac_f32 v54, v58, v58
    v_sub_f32 v59, v23, v48
    v_fmac_f32_e64 v55, v59, v59
    v_mfma_f32_16x16x32_bf16 v[188:191], v[72:75], a[108:111], v[188:191]
    buffer_load_dwordx4 v235, s[48:51], s33 offen offset:1024 lds
    v_sub_f32_e64 v56, v24, v48
    v_mfma_f32_16x16x32_bf16 v[188:191], v[76:79], a[124:127], v[188:191]
    s_waitcnt vmcnt(30) lgkmcnt(0)
    s_barrier
    v_mfma_f32_16x16x32_bf16 v[192:195], v[80:83], a[96:99], v[192:195]
    ds_read_b128 v[64:67], v224 offset:0
    v_fmac_f32_e64 v52, v56, v56
    v_mfma_f32_16x16x32_bf16 v[192:195], v[84:87], a[112:115], v[192:195]
    ds_read_b128 v[68:71], v225 offset:0
    v_sub_f32_e64 v57, v25, v48
    v_mfma_f32_16x16x32_bf16 v[196:199], v[88:91], a[96:99], v[196:199]
    ds_read_b128 v[72:75], v224 offset:2048
    v_fmac_f32_e64 v53, v57, v57
    v_mfma_f32_16x16x32_bf16 v[196:199], v[92:95], a[112:115], v[196:199]
    ds_read_b128 v[76:79], v225 offset:2048
    v_sub_f32 v58, v26, v48
    v_fmac_f32 v54, v58, v58
    v_mfma_f32_16x16x32_bf16 v[200:203], v[80:83], a[100:103], v[200:203]
    ds_read_b64_tr_b16 a[144:145], v228 offset:12288
    v_sub_f32_e64 v59, v27, v48
    v_mfma_f32_16x16x32_bf16 v[200:203], v[84:87], a[116:119], v[200:203]
    ds_read_b64_tr_b16 a[146:147], v228 offset:12800
    v_fmac_f32_e64 v55, v59, v59
    v_mfma_f32_16x16x32_bf16 v[204:207], v[88:91], a[100:103], v[204:207]
    ds_read_b64_tr_b16 a[148:149], v229 offset:12288
    v_sub_f32_e64 v56, v28, v48
    v_mfma_f32_16x16x32_bf16 v[204:207], v[92:95], a[116:119], v[204:207]
    ds_read_b64_tr_b16 a[150:151], v229 offset:12800
    v_fmac_f32_e64 v52, v56, v56
    v_mfma_f32_16x16x32_bf16 v[208:211], v[80:83], a[104:107], v[208:211]
    ds_read_b64_tr_b16 a[152:153], v230 offset:12288
    s_add_u32 m0, s34, 49152
    s_add_u32 s37, s87, 0
    buffer_load_dwordx4 v232, s[44:47], s37 offen lds
    v_mfma_f32_16x16x32_bf16 v[208:211], v[84:87], a[120:123], v[208:211]
    ds_read_b64_tr_b16 a[154:155], v230 offset:12800
    v_sub_f32 v57, v29, v48
    v_mfma_f32_16x16x32_bf16 v[212:215], v[88:91], a[104:107], v[212:215]
    ds_read_b64_tr_b16 a[156:157], v231 offset:12288
    v_fmac_f32 v53, v57, v57
    v_sub_f32 v58, v30, v48
    v_mfma_f32_16x16x32_bf16 v[212:215], v[92:95], a[120:123], v[212:215]
    ds_read_b64_tr_b16 a[158:159], v231 offset:12800
    v_fmac_f32_e64 v54, v58, v58
    v_mfma_f32_16x16x32_bf16 v[216:219], v[80:83], a[108:111], v[216:219]
    buffer_load_dwordx4 v233, s[44:47], s37 offen offset:1024 lds
    v_sub_f32_e64 v59, v31, v48
    v_mfma_f32_16x16x32_bf16 v[216:219], v[84:87], a[124:127], v[216:219]
    v_fmac_f32 v55, v59, v59
    v_sub_f32 v56, v32, v48
    v_mfma_f32_16x16x32_bf16 v[220:223], v[88:91], a[108:111], v[220:223]
    v_fmac_f32 v52, v56, v56
    v_sub_f32 v57, v33, v48
    v_fmac_f32_e64 v53, v57, v57
    v_mfma_f32_16x16x32_bf16 v[220:223], v[92:95], a[124:127], v[220:223]
    v_sub_f32 v58, v34, v48
    s_waitcnt lgkmcnt(0)
    v_mfma_f32_16x16x32_bf16 v[96:99], v[64:67], a[128:131], v[96:99]
    ds_read_b128 v[80:83], v224 offset:4096
    v_fmac_f32_e64 v54, v58, v58
    v_mfma_f32_16x16x32_bf16 v[96:99], v[68:71], a[144:147], v[96:99]
    ds_read_b128 v[84:87], v225 offset:4096
    v_sub_f32_e64 v59, v35, v48
    v_mfma_f32_16x16x32_bf16 v[100:103], v[72:75], a[128:131], v[100:103]
    ds_read_b128 v[88:91], v224 offset:6144
    v_fmac_f32_e64 v55, v59, v59
    v_mfma_f32_16x16x32_bf16 v[100:103], v[76:79], a[144:147], v[100:103]
    ds_read_b128 v[92:95], v225 offset:6144
    v_sub_f32 v56, v36, v48
    v_fmac_f32 v52, v56, v56
    v_mfma_f32_16x16x32_bf16 v[104:107], v[64:67], a[132:135], v[104:107]
    v_sub_f32 v57, v37, v48
    v_fmac_f32 v53, v57, v57
    v_mfma_f32_16x16x32_bf16 v[104:107], v[68:71], a[148:151], v[104:107]
    v_sub_f32 v58, v38, v48
    v_fmac_f32 v54, v58, v58
    v_mfma_f32_16x16x32_bf16 v[108:111], v[72:75], a[132:135], v[108:111]
    v_sub_f32 v59, v39, v48
    v_fmac_f32 v55, v59, v59
    v_sub_f32_e64 v56, v40, v48
    v_mfma_f32_16x16x32_bf16 v[108:111], v[76:79], a[148:151], v[108:111]
    v_fmac_f32 v52, v56, v56
    v_sub_f32 v57, v41, v48
    v_mfma_f32_16x16x32_bf16 v[112:115], v[64:67], a[136:139], v[112:115]
    s_add_u32 m0, s35, 4096
    s_add_u32 s33, s33, 131072
    buffer_load_dwordx4 v234, s[48:51], s33 offen lds
    v_mfma_f32_16x16x32_bf16 v[112:115], v[68:71], a[152:155], v[112:115]
    v_fmac_f32 v53, v57, v57
    v_sub_f32 v58, v42, v48
    v_mfma_f32_16x16x32_bf16 v[116:119], v[72:75], a[136:139], v[116:119]
    buffer_load_dwordx4 v235, s[48:51], s33 offen offset:1024 lds
    v_fmac_f32 v54, v58, v58
    v_sub_f32 v59, v43, v48
    v_mfma_f32_16x16x32_bf16 v[116:119], v[76:79], a[152:155], v[116:119]
    v_fmac_f32 v55, v59, v59
    v_sub_f32 v56, v44, v48
    v_mfma_f32_16x16x32_bf16 v[120:123], v[64:67], a[140:143], v[120:123]
    s_add_u32 m0, s35, 6144
    s_add_u32 s33, s33, 131072
    buffer_load_dwordx4 v234, s[48:51], s33 offen lds
    v_mfma_f32_16x16x32_bf16 v[120:123], v[68:71], a[156:159], v[120:123]
    v_fmac_f32 v52, v56, v56
    v_sub_f32 v57, v45, v48
    v_mfma_f32_16x16x32_bf16 v[124:127], v[72:75], a[140:143], v[124:127]
    buffer_load_dwordx4 v235, s[48:51], s33 offen offset:1024 lds
    v_fmac_f32 v53, v57, v57
    v_sub_f32 v58, v46, v48
    v_mfma_f32_16x16x32_bf16 v[124:127], v[76:79], a[156:159], v[124:127]
    v_fmac_f32 v54, v58, v58
    s_waitcnt lgkmcnt(0)
    v_mfma_f32_16x16x32_bf16 v[128:131], v[80:83], a[128:131], v[128:131]
    ds_read_b128 v[64:67], v224 offset:8192
    v_sub_f32_e64 v59, v47, v48
    v_mfma_f32_16x16x32_bf16 v[128:131], v[84:87], a[144:147], v[128:131]
    ds_read_b128 v[68:71], v225 offset:8192
    v_fmac_f32_e64 v55, v59, v59
    v_mfma_f32_16x16x32_bf16 v[132:135], v[88:91], a[128:131], v[132:135]
    ds_read_b128 v[72:75], v224 offset:10240
    v_add_f32_e64 v52, v52, v53
    v_mfma_f32_16x16x32_bf16 v[132:135], v[92:95], a[144:147], v[132:135]
    ds_read_b128 v[76:79], v225 offset:10240
    v_add_f32_e64 v54, v54, v55
    v_mfma_f32_16x16x32_bf16 v[136:139], v[80:83], a[132:135], v[136:139]
    v_add_f32 v51, v52, v54
    s_nop 1
    v_add_f32_dpp v51, v51, v51 quad_perm:[1,0,3,2] row_mask:0xf bank_mask:0xf
    v_mfma_f32_16x16x32_bf16 v[136:139], v[84:87], a[148:151], v[136:139]
    s_nop 1
    v_add_f32_dpp v51, v51, v51 quad_perm:[2,3,0,1] row_mask:0xf bank_mask:0xf
    v_mfma_f32_16x16x32_bf16 v[140:143], v[88:91], a[132:135], v[140:143]
    s_nop 1
    v_add_f32_dpp v51, v51, v51 row_half_mirror row_mask:0xf bank_mask:0xf
    s_nop 1
    v_mfma_f32_16x16x32_bf16 v[140:143], v[92:95], a[148:151], v[140:143]
    v_add_f32_dpp v51, v51, v51 row_mirror row_mask:0xf bank_mask:0xf
    s_nop 0
    v_mfma_f32_16x16x32_bf16 v[144:147], v[80:83], a[136:139], v[144:147]
    s_add_u32 m0, s34, 57344
    s_add_u32 s37, s87, 65536
    buffer_load_dwordx4 v232, s[44:47], s37 offen lds
    v_mfma_f32_16x16x32_bf16 v[144:147], v[84:87], a[152:155], v[144:147]
    v_mov_b32 v49, v51
    s_nop 1
    v_mfma_f32_16x16x32_bf16 v[148:151], v[88:91], a[136:139], v[148:151]
    buffer_load_dwordx4 v233, s[44:47], s37 offen offset:1024 lds
    v_permlane16_swap_b32 v51, v49
    s_nop 0
    v_mfma_f32_16x16x32_bf16 v[148:151], v[92:95], a[152:155], v[148:151]
    v_add_f32_e64 v51, v51, v49
    v_mul_f32 v51, 0x3a800000, v51
    v_mfma_f32_16x16x32_bf16 v[152:155], v[80:83], a[140:143], v[152:155]
    v_lshlrev_b32_e64 v227, 3, v240
    v_min_u32 v227, 1920, v227
    s_lshl2_add_u32 s25, s2, s3
    v_mfma_f32_16x16x32_bf16 v[152:155], v[84:87], a[156:159], v[152:155]
    v_cvt_pk_bf16_f32 v50, v48, v51
    v_and_b32 v51, 0xffff0000, v50
    v_mfma_f32_16x16x32_bf16 v[156:159], v[88:91], a[140:143], v[156:159]
    s_lshl_b32 s25, s25, 13
    s_add_u32 s25, s25, 2048
    buffer_load_dword v241, v227, s[12:15], s25 offen
    v_mfma_f32_16x16x32_bf16 v[156:159], v[92:95], a[156:159], v[156:159]
    v_lshlrev_b32 v50, 16, v50
    s_waitcnt vmcnt(16) lgkmcnt(0)
    v_mfma_f32_16x16x32_bf16 v[160:163], v[64:67], a[128:131], v[160:163]
    ds_read_b128 v[80:83], v224 offset:12288
    v_add_f32 v51, 0x3727c5ac, v51
    v_cvt_pk_bf16_f32 v51, v51, v51
    v_mfma_f32_16x16x32_bf16 v[160:163], v[68:71], a[144:147], v[160:163]
    ds_read_b128 v[84:87], v225 offset:12288
    v_lshlrev_b32_e64 v51, 16, v51
    v_mfma_f32_16x16x32_bf16 v[164:167], v[72:75], a[128:131], v[164:167]
    ds_read_b128 v[88:91], v224 offset:14336
    v_mfma_f32_16x16x32_bf16 v[164:167], v[76:79], a[144:147], v[164:167]
    ds_read_b128 v[92:95], v225 offset:14336
    v_sqrt_f32 v51, v51
    v_mfma_f32_16x16x32_bf16 v[168:171], v[64:67], a[132:135], v[168:171]
    ds_read_b64_tr_b16 a[160:161], v228 offset:16384
    s_nop 0
    v_mfma_f32_16x16x32_bf16 v[168:171], v[68:71], a[148:151], v[168:171]
    ds_read_b64_tr_b16 a[162:163], v228 offset:16896
    v_cvt_pk_bf16_f32 v51, v51, v51
    v_lshlrev_b32_e64 v51, 16, v51
    v_mfma_f32_16x16x32_bf16 v[172:175], v[72:75], a[132:135], v[172:175]
    ds_read_b64_tr_b16 a[164:165], v229 offset:16384
    v_mfma_f32_16x16x32_bf16 v[172:175], v[76:79], a[148:151], v[172:175]
    ds_read_b64_tr_b16 a[166:167], v229 offset:16896
    v_rcp_f32_e64 v51, v51
    v_mfma_f32_16x16x32_bf16 v[176:179], v[64:67], a[136:139], v[176:179]
    ds_read_b64_tr_b16 a[168:169], v230 offset:16384
    s_add_u32 m0, s35, 8192
    s_and_b32 s33, s87, 1023
    s_lshl_b32 s33, s33, 12
    buffer_load_dwordx4 v234, s[48:51], s33 offen lds
    v_mfma_f32_16x16x32_bf16 v[176:179], v[68:71], a[152:155], v[176:179]
    ds_read_b64_tr_b16 a[170:171], v230 offset:16896
    s_nop 0
    v_mfma_f32_16x16x32_bf16 v[180:183], v[72:75], a[136:139], v[180:183]
    ds_read_b64_tr_b16 a[172:173], v231 offset:16384
    buffer_load_dwordx4 v235, s[48:51], s33 offen offset:1024 lds
    v_mfma_f32_16x16x32_bf16 v[180:183], v[76:79], a[152:155], v[180:183]
    ds_read_b64_tr_b16 a[174:175], v231 offset:16896
    v_mul_f32 v51, 0x3e0293ee, v51
    v_mfma_f32_16x16x32_bf16 v[184:187], v[64:67], a[140:143], v[184:187]
    s_add_u32 m0, s35, 10240
    s_add_u32 s33, s33, 131072
    buffer_load_dwordx4 v234, s[48:51], s33 offen lds
    v_mfma_f32_16x16x32_bf16 v[184:187], v[68:71], a[156:159], v[184:187]
    v_sub_f32 v16, v16, v50
    v_sub_f32 v17, v17, v50
    v_cvt_pk_bf16_f32 v17, v16, v17
    v_mfma_f32_16x16x32_bf16 v[188:191], v[72:75], a[140:143], v[188:191]
    buffer_load_dwordx4 v235, s[48:51], s33 offen offset:1024 lds
    v_lshlrev_b32_e64 v16, 16, v17
    v_mfma_f32_16x16x32_bf16 v[188:191], v[76:79], a[156:159], v[188:191]
    s_waitcnt vmcnt(31) lgkmcnt(0)
    s_barrier
    v_mfma_f32_16x16x32_bf16 v[192:195], v[80:83], a[128:131], v[192:195]
    ds_read_b128 v[64:67], v224 offset:16384
    v_and_b32 v17, 0xffff0000, v17
    v_mfma_f32_16x16x32_bf16 v[192:195], v[84:87], a[144:147], v[192:195]
    ds_read_b128 v[68:71], v225 offset:16384
    v_mul_f32_e64 v16, v16, v51
    v_mfma_f32_16x16x32_bf16 v[196:199], v[88:91], a[128:131], v[196:199]
    ds_read_b128 v[72:75], v224 offset:18432
    v_mul_f32_e64 v17, v17, v51
    v_mfma_f32_16x16x32_bf16 v[196:199], v[92:95], a[144:147], v[196:199]
    ds_read_b128 v[76:79], v225 offset:18432
    v_cvt_pk_bf16_f32 v0, v16, v17
    v_sub_f32_e64 v18, v18, v50
    v_mfma_f32_16x16x32_bf16 v[200:203], v[80:83], a[132:135], v[200:203]
    ds_read_b64_tr_b16 a[176:177], v228 offset:20480
    v_sub_f32_e64 v19, v19, v50
    v_mfma_f32_16x16x32_bf16 v[200:203], v[84:87], a[148:151], v[200:203]
    ds_read_b64_tr_b16 a[178:179], v228 offset:20992
    v_cvt_pk_bf16_f32 v19, v18, v19
    v_mfma_f32_16x16x32_bf16 v[204:207], v[88:91], a[132:135], v[204:207]
    ds_read_b64_tr_b16 a[180:181], v229 offset:20480
    v_lshlrev_b32_e64 v18, 16, v19
    v_mfma_f32_16x16x32_bf16 v[204:207], v[92:95], a[148:151], v[204:207]
    ds_read_b64_tr_b16 a[182:183], v229 offset:20992
    v_and_b32 v19, 0xffff0000, v19
    v_mfma_f32_16x16x32_bf16 v[208:211], v[80:83], a[136:139], v[208:211]
    ds_read_b64_tr_b16 a[184:185], v230 offset:20480
    s_add_u32 m0, s34, 0
    s_add_u32 s37, s80, 131072
    buffer_load_dwordx4 v232, s[44:47], s37 offen lds
    v_mfma_f32_16x16x32_bf16 v[208:211], v[84:87], a[152:155], v[208:211]
    ds_read_b64_tr_b16 a[186:187], v230 offset:20992
    v_mul_f32 v18, v18, v51
    v_mfma_f32_16x16x32_bf16 v[212:215], v[88:91], a[136:139], v[212:215]
    ds_read_b64_tr_b16 a[188:189], v231 offset:20480
    v_mul_f32_e64 v19, v19, v51
    v_cvt_pk_bf16_f32 v1, v18, v19
    v_mfma_f32_16x16x32_bf16 v[212:215], v[92:95], a[152:155], v[212:215]
    ds_read_b64_tr_b16 a[190:191], v231 offset:20992
    v_sub_f32_e64 v20, v20, v50
    v_mfma_f32_16x16x32_bf16 v[216:219], v[80:83], a[140:143], v[216:219]
    buffer_load_dwordx4 v233, s[44:47], s37 offen offset:1024 lds
    v_sub_f32_e64 v21, v21, v50
    v_mfma_f32_16x16x32_bf16 v[216:219], v[84:87], a[156:159], v[216:219]
    v_cvt_pk_bf16_f32 v21, v20, v21
    v_lshlrev_b32_e64 v20, 16, v21
    v_mfma_f32_16x16x32_bf16 v[220:223], v[88:91], a[140:143], v[220:223]
    v_and_b32 v21, 0xffff0000, v21
    v_mul_f32 v20, v20, v51
    v_mul_f32 v21, v21, v51
    v_mfma_f32_16x16x32_bf16 v[220:223], v[92:95], a[156:159], v[220:223]
    v_cvt_pk_bf16_f32 v2, v20, v21
    s_waitcnt lgkmcnt(0)
    v_mfma_f32_16x16x32_bf16 v[96:99], v[64:67], a[160:163], v[96:99]
    ds_read_b128 v[80:83], v224 offset:20480
    v_sub_f32 v22, v22, v50
    v_mfma_f32_16x16x32_bf16 v[96:99], v[68:71], a[176:179], v[96:99]
    ds_read_b128 v[84:87], v225 offset:20480
    v_sub_f32_e64 v23, v23, v50
    v_mfma_f32_16x16x32_bf16 v[100:103], v[72:75], a[160:163], v[100:103]
    ds_read_b128 v[88:91], v224 offset:22528
    v_cvt_pk_bf16_f32 v23, v22, v23
    v_mfma_f32_16x16x32_bf16 v[100:103], v[76:79], a[176:179], v[100:103]
    ds_read_b128 v[92:95], v225 offset:22528
    v_lshlrev_b32_e64 v22, 16, v23
    v_and_b32 v23, 0xffff0000, v23
    v_mfma_f32_16x16x32_bf16 v[104:107], v[64:67], a[164:167], v[104:107]
    v_mul_f32 v22, v22, v51
    v_mul_f32 v23, v23, v51
    v_mfma_f32_16x16x32_bf16 v[104:107], v[68:71], a[180:183], v[104:107]
    v_cvt_pk_bf16_f32 v3, v22, v23
    v_sub_f32_e64 v24, v24, v50
    v_mfma_f32_16x16x32_bf16 v[108:111], v[72:75], a[164:167], v[108:111]
    v_sub_f32_e64 v25, v25, v50
    v_cvt_pk_bf16_f32 v25, v24, v25
    v_lshlrev_b32_e64 v24, 16, v25
    v_mfma_f32_16x16x32_bf16 v[108:111], v[76:79], a[180:183], v[108:111]
    v_and_b32 v25, 0xffff0000, v25
    v_mul_f32_e64 v24, v24, v51
    v_mfma_f32_16x16x32_bf16 v[112:115], v[64:67], a[168:171], v[112:115]
    s_add_u32 m0, s35, 12288
    s_add_u32 s33, s33, 131072
    buffer_load_dwordx4 v234, s[48:51], s33 offen lds
    v_mfma_f32_16x16x32_bf16 v[112:115], v[68:71], a[184:187], v[112:115]
    v_mul_f32_e64 v25, v25, v51
    v_cvt_pk_bf16_f32 v4, v24, v25
    v_mfma_f32_16x16x32_bf16 v[116:119], v[72:75], a[168:171], v[116:119]
    buffer_load_dwordx4 v235, s[48:51], s33 offen offset:1024 lds
    v_sub_f32 v26, v26, v50
    v_sub_f32 v27, v27, v50
    v_mfma_f32_16x16x32_bf16 v[116:119], v[76:79], a[184:187], v[116:119]
    v_cvt_pk_bf16_f32 v27, v26, v27
    v_lshlrev_b32_e64 v26, 16, v27
    v_mfma_f32_16x16x32_bf16 v[120:123], v[64:67], a[172:175], v[120:123]
    s_add_u32 m0, s35, 14336
    s_add_u32 s33, s33, 131072
    buffer_load_dwordx4 v234, s[48:51], s33 offen lds
    v_mfma_f32_16x16x32_bf16 v[120:123], v[68:71], a[188:191], v[120:123]
    v_and_b32 v27, 0xffff0000, v27
    v_mul_f32_e64 v26, v26, v51
    v_mfma_f32_16x16x32_bf16 v[124:127], v[72:75], a[172:175], v[124:127]
    buffer_load_dwordx4 v235, s[48:51], s33 offen offset:1024 lds
    v_mul_f32_e64 v27, v27, v51
    v_cvt_pk_bf16_f32 v5, v26, v27
    v_mfma_f32_16x16x32_bf16 v[124:127], v[76:79], a[188:191], v[124:127]
    v_sub_f32 v28, v28, v50
    s_waitcnt lgkmcnt(0)
    v_mfma_f32_16x16x32_bf16 v[128:131], v[80:83], a[160:163], v[128:131]
    ds_read_b128 v[64:67], v224 offset:24576
    v_sub_f32_e64 v29, v29, v50
    v_mfma_f32_16x16x32_bf16 v[128:131], v[84:87], a[176:179], v[128:131]
    ds_read_b128 v[68:71], v225 offset:24576
    v_cvt_pk_bf16_f32 v29, v28, v29
    v_mfma_f32_16x16x32_bf16 v[132:135], v[88:91], a[160:163], v[132:135]
    ds_read_b128 v[72:75], v224 offset:26624
    v_lshlrev_b32_e64 v28, 16, v29
    v_mfma_f32_16x16x32_bf16 v[132:135], v[92:95], a[176:179], v[132:135]
    ds_read_b128 v[76:79], v225 offset:26624
    v_and_b32 v29, 0xffff0000, v29
    v_mfma_f32_16x16x32_bf16 v[136:139], v[80:83], a[164:167], v[136:139]
    v_mul_f32 v28, v28, v51
    v_mul_f32 v29, v29, v51
    v_cvt_pk_bf16_f32 v6, v28, v29
    v_mfma_f32_16x16x32_bf16 v[136:139], v[84:87], a[180:183], v[136:139]
    v_sub_f32 v30, v30, v50
    v_sub_f32 v31, v31, v50
    v_mfma_f32_16x16x32_bf16 v[140:143], v[88:91], a[164:167], v[140:143]
    v_cvt_pk_bf16_f32 v31, v30, v31
    v_lshlrev_b32_e64 v30, 16, v31
    v_and_b32 v31, 0xffff0000, v31
    v_mfma_f32_16x16x32_bf16 v[140:143], v[92:95], a[180:183], v[140:143]
    v_mul_f32 v30, v30, v51
    v_mul_f32 v31, v31, v51
    v_mfma_f32_16x16x32_bf16 v[144:147], v[80:83], a[168:171], v[144:147]
    s_add_u32 m0, s34, 8192
    s_add_u32 s37, s81, 131072
    buffer_load_dwordx4 v232, s[44:47], s37 offen lds
    v_mfma_f32_16x16x32_bf16 v[144:147], v[84:87], a[184:187], v[144:147]
    v_cvt_pk_bf16_f32 v7, v30, v31
    v_sub_f32_e64 v32, v32, v50
    v_mfma_f32_16x16x32_bf16 v[148:151], v[88:91], a[168:171], v[148:151]
    buffer_load_dwordx4 v233, s[44:47], s37 offen offset:1024 lds
    v_sub_f32_e64 v33, v33, v50
    v_mfma_f32_16x16x32_bf16 v[148:151], v[92:95], a[184:187], v[148:151]
    v_cvt_pk_bf16_f32 v33, v32, v33
    v_lshlrev_b32_e64 v32, 16, v33
    v_and_b32 v33, 0xffff0000, v33
    v_mfma_f32_16x16x32_bf16 v[152:155], v[80:83], a[172:175], v[152:155]
    v_lshlrev_b32_e64 v227, 3, v240
    v_min_u32 v227, 1920, v227
    s_lshl2_add_u32 s25, s2, s3
    v_mfma_f32_16x16x32_bf16 v[152:155], v[84:87], a[188:191], v[152:155]
    v_mul_f32 v32, v32, v51
    v_mul_f32_e64 v33, v33, v51
    v_mfma_f32_16x16x32_bf16 v[156:159], v[88:91], a[172:175], v[156:159]
    s_lshl_b32 s25, s25, 13
    s_add_u32 s25, s25, 4096
    buffer_load_dword v241, v227, s[12:15], s25 offen
    v_mfma_f32_16x16x32_bf16 v[156:159], v[92:95], a[188:191], v[156:159]
    v_cvt_pk_bf16_f32 v8, v32, v33
    s_waitcnt vmcnt(16) lgkmcnt(0)
    v_mfma_f32_16x16x32_bf16 v[160:163], v[64:67], a[160:163], v[160:163]
    ds_read_b128 v[80:83], v224 offset:28672
    v_sub_f32 v34, v34, v50
    v_sub_f32 v35, v35, v50
    v_mfma_f32_16x16x32_bf16 v[160:163], v[68:71], a[176:179], v[160:163]
    ds_read_b128 v[84:87], v225 offset:28672
    v_cvt_pk_bf16_f32 v35, v34, v35
    v_mfma_f32_16x16x32_bf16 v[164:167], v[72:75], a[160:163], v[164:167]
    ds_read_b128 v[88:91], v224 offset:30720
    v_lshlrev_b32_e64 v34, 16, v35
    v_mfma_f32_16x16x32_bf16 v[164:167], v[76:79], a[176:179], v[164:167]
    ds_read_b128 v[92:95], v225 offset:30720
    v_and_b32 v35, 0xffff0000, v35
    v_mfma_f32_16x16x32_bf16 v[168:171], v[64:67], a[164:167], v[168:171]
    ds_read_b64_tr_b16 a[192:193], v228 offset:0
    v_mul_f32_e64 v34, v34, v51
    v_mfma_f32_16x16x32_bf16 v[168:171], v[68:71], a[180:183], v[168:171]
    ds_read_b64_tr_b16 a[194:195], v228 offset:512
    v_mul_f32_e64 v35, v35, v51
    v_cvt_pk_bf16_f32 v9, v34, v35
    v_mfma_f32_16x16x32_bf16 v[172:175], v[72:75], a[164:167], v[172:175]
    ds_read_b64_tr_b16 a[196:197], v229 offset:0
    v_sub_f32_e64 v36, v36, v50
    v_mfma_f32_16x16x32_bf16 v[172:175], v[76:79], a[180:183], v[172:175]
    ds_read_b64_tr_b16 a[198:199], v229 offset:512
    v_sub_f32_e64 v37, v37, v50
    v_mfma_f32_16x16x32_bf16 v[176:179], v[64:67], a[168:171], v[176:179]
    ds_read_b64_tr_b16 a[200:201], v230 offset:0
    v_cvt_pk_bf16_f32 v37, v36, v37
    v_mfma_f32_16x16x32_bf16 v[176:179], v[68:71], a[184:187], v[176:179]
    ds_read_b64_tr_b16 a[202:203], v230 offset:512
    v_lshlrev_b32_e64 v36, 16, v37
    v_mfma_f32_16x16x32_bf16 v[180:183], v[72:75], a[168:171], v[180:183]
    ds_read_b64_tr_b16 a[204:205], v231 offset:0
    v_and_b32 v37, 0xffff0000, v37
    v_mfma_f32_16x16x32_bf16 v[180:183], v[76:79], a[184:187], v[180:183]
    ds_read_b64_tr_b16 a[206:207], v231 offset:512
    v_mul_f32 v36, v36, v51
    v_mul_f32 v37, v37, v51
    v_mfma_f32_16x16x32_bf16 v[184:187], v[64:67], a[172:175], v[184:187]
    v_cvt_pk_bf16_f32 v10, v36, v37
    v_sub_f32_e64 v38, v38, v50
    v_mfma_f32_16x16x32_bf16 v[184:187], v[68:71], a[188:191], v[184:187]
    v_sub_f32_e64 v39, v39, v50
    v_cvt_pk_bf16_f32 v39, v38, v39
    v_mfma_f32_16x16x32_bf16 v[188:191], v[72:75], a[172:175], v[188:191]
    v_lshlrev_b32_e64 v38, 16, v39
    v_and_b32 v39, 0xffff0000, v39
    v_mul_f32_e64 v38, v38, v51
    v_mfma_f32_16x16x32_bf16 v[188:191], v[76:79], a[188:191], v[188:191]
    s_waitcnt vmcnt(27) lgkmcnt(0)
    s_barrier
    v_mfma_f32_16x16x32_bf16 v[192:195], v[80:83], a[160:163], v[192:195]
    ds_read_b128 v[64:67], v224 offset:32768
    v_mul_f32_e64 v39, v39, v51
    v_mfma_f32_16x16x32_bf16 v[192:195], v[84:87], a[176:179], v[192:195]
    ds_read_b128 v[68:71], v225 offset:32768
    v_cvt_pk_bf16_f32 v11, v38, v39
    v_mfma_f32_16x16x32_bf16 v[196:199], v[88:91], a[160:163], v[196:199]
    ds_read_b128 v[72:75], v224 offset:34816
    v_sub_f32_e64 v40, v40, v50
    v_mfma_f32_16x16x32_bf16 v[196:199], v[92:95], a[176:179], v[196:199]
    ds_read_b128 v[76:79], v225 offset:34816
    v_sub_f32_e64 v41, v41, v50
    v_mfma_f32_16x16x32_bf16 v[200:203], v[80:83], a[164:167], v[200:203]
    ds_read_b64_tr_b16 a[208:209], v228 offset:4096
    v_cvt_pk_bf16_f32 v41, v40, v41
    v_lshlrev_b32_e64 v40, 16, v41
    v_mfma_f32_16x16x32_bf16 v[200:203], v[84:87], a[180:183], v[200:203]
    ds_read_b64_tr_b16 a[210:211], v228 offset:4608
    v_and_b32 v41, 0xffff0000, v41
    v_mfma_f32_16x16x32_bf16 v[204:207], v[88:91], a[164:167], v[204:207]
    ds_read_b64_tr_b16 a[212:213], v229 offset:4096
    v_mul_f32_e64 v40, v40, v51
    v_mfma_f32_16x16x32_bf16 v[204:207], v[92:95], a[180:183], v[204:207]
    ds_read_b64_tr_b16 a[214:215], v229 offset:4608
    v_mul_f32_e64 v41, v41, v51
    v_mfma_f32_16x16x32_bf16 v[208:211], v[80:83], a[168:171], v[208:211]
    ds_read_b64_tr_b16 a[216:217], v230 offset:4096
    s_add_u32 m0, s34, 16384
    s_add_u32 s37, s82, 131072
    buffer_load_dwordx4 v232, s[44:47], s37 offen lds
    v_mfma_f32_16x16x32_bf16 v[208:211], v[84:87], a[184:187], v[208:211]
    ds_read_b64_tr_b16 a[218:219], v230 offset:4608
    v_cvt_pk_bf16_f32 v12, v40, v41
    v_mfma_f32_16x16x32_bf16 v[212:215], v[88:91], a[168:171], v[212:215]
    ds_read_b64_tr_b16 a[220:221], v231 offset:4096
    v_sub_f32 v42, v42, v50
    v_sub_f32 v43, v43, v50
    v_mfma_f32_16x16x32_bf16 v[212:215], v[92:95], a[184:187], v[212:215]
    ds_read_b64_tr_b16 a[222:223], v231 offset:4608
    v_cvt_pk_bf16_f32 v43, v42, v43
    v_mfma_f32_16x16x32_bf16 v[216:219], v[80:83], a[172:175], v[216:219]
    buffer_load_dwordx4 v233, s[44:47], s37 offen offset:1024 lds
    v_lshlrev_b32_e64 v42, 16, v43
    v_mfma_f32_16x16x32_bf16 v[216:219], v[84:87], a[188:191], v[216:219]
    v_and_b32 v43, 0xffff0000, v43
    v_mul_f32_e64 v42, v42, v51
    v_mfma_f32_16x16x32_bf16 v[220:223], v[88:91], a[172:175], v[220:223]
    v_mul_f32_e64 v43, v43, v51
    v_cvt_pk_bf16_f32 v13, v42, v43
    v_sub_f32_e64 v44, v44, v50
    v_mfma_f32_16x16x32_bf16 v[220:223], v[92:95], a[188:191], v[220:223]
    v_sub_f32 v45, v45, v50
    s_waitcnt lgkmcnt(0)
    v_mfma_f32_16x16x32_bf16 v[96:99], v[64:67], a[192:195], v[96:99]
    ds_read_b128 v[80:83], v224 offset:36864
    v_cvt_pk_bf16_f32 v45, v44, v45
    v_mfma_f32_16x16x32_bf16 v[96:99], v[68:71], a[208:211], v[96:99]
    ds_read_b128 v[84:87], v225 offset:36864
    v_lshlrev_b32_e64 v44, 16, v45
    v_mfma_f32_16x16x32_bf16 v[100:103], v[72:75], a[192:195], v[100:103]
    ds_read_b128 v[88:91], v224 offset:38912
    v_and_b32 v45, 0xffff0000, v45
    v_mfma_f32_16x16x32_bf16 v[100:103], v[76:79], a[208:211], v[100:103]
    ds_read_b128 v[92:95], v225 offset:38912
    v_mul_f32 v44, v44, v51
    v_mul_f32 v45, v45, v51
    v_mfma_f32_16x16x32_bf16 v[104:107], v[64:67], a[196:199], v[104:107]
    v_cvt_pk_bf16_f32 v14, v44, v45
    v_sub_f32_e64 v46, v46, v50
    v_mfma_f32_16x16x32_bf16 v[104:107], v[68:71], a[212:215], v[104:107]
    v_sub_f32_e64 v47, v47, v50
    v_cvt_pk_bf16_f32 v47, v46, v47
    v_mfma_f32_16x16x32_bf16 v[108:111], v[72:75], a[196:199], v[108:111]
    v_lshlrev_b32_e64 v46, 16, v47
    v_and_b32 v47, 0xffff0000, v47
    v_mul_f32_e64 v46, v46, v51
    v_mfma_f32_16x16x32_bf16 v[108:111], v[76:79], a[212:215], v[108:111]
    v_mul_f32_e64 v47, v47, v51
    v_cvt_pk_bf16_f32 v15, v46, v47
    v_mfma_f32_16x16x32_bf16 v[112:115], v[64:67], a[200:203], v[112:115]
    v_mfma_f32_16x16x32_bf16 v[112:115], v[68:71], a[216:219], v[112:115]
    ds_write_b128 v237, v[0:3] offset:0
    v_mfma_f32_16x16x32_bf16 v[116:119], v[72:75], a[200:203], v[116:119]
    ds_write_b128 v237, v[4:7] offset:4096
    v_mfma_f32_16x16x32_bf16 v[116:119], v[76:79], a[216:219], v[116:119]
    ds_write_b128 v237, v[8:11] offset:24576
    v_mfma_f32_16x16x32_bf16 v[120:123], v[64:67], a[204:207], v[120:123]
    ds_write_b128 v237, v[12:15] offset:28672
    v_mfma_f32_16x16x32_bf16 v[120:123], v[68:71], a[220:223], v[120:123]
    v_mfma_f32_16x16x32_bf16 v[124:127], v[72:75], a[204:207], v[124:127]
    v_mfma_f32_16x16x32_bf16 v[124:127], v[76:79], a[220:223], v[124:127]
    s_waitcnt lgkmcnt(0)
    v_mfma_f32_16x16x32_bf16 v[128:131], v[80:83], a[192:195], v[128:131]
    ds_read_b128 v[64:67], v224 offset:40960
    v_mfma_f32_16x16x32_bf16 v[128:131], v[84:87], a[208:211], v[128:131]
    ds_read_b128 v[68:71], v225 offset:40960
    v_mfma_f32_16x16x32_bf16 v[132:135], v[88:91], a[192:195], v[132:135]
    ds_read_b128 v[72:75], v224 offset:43008
    v_mfma_f32_16x16x32_bf16 v[132:135], v[92:95], a[208:211], v[132:135]
    ds_read_b128 v[76:79], v225 offset:43008
    v_mfma_f32_16x16x32_bf16 v[136:139], v[80:83], a[196:199], v[136:139]
    v_mfma_f32_16x16x32_bf16 v[136:139], v[84:87], a[212:215], v[136:139]
    v_mfma_f32_16x16x32_bf16 v[140:143], v[88:91], a[196:199], v[140:143]
    v_mfma_f32_16x16x32_bf16 v[140:143], v[92:95], a[212:215], v[140:143]
    v_mfma_f32_16x16x32_bf16 v[144:147], v[80:83], a[200:203], v[144:147]
    s_add_u32 m0, s34, 24576
    s_add_u32 s37, s83, 131072
    buffer_load_dwordx4 v232, s[44:47], s37 offen lds
    v_mfma_f32_16x16x32_bf16 v[144:147], v[84:87], a[216:219], v[144:147]
    buffer_load_dwordx4 v233, s[44:47], s37 offen offset:1024 lds
    v_mfma_f32_16x16x32_bf16 v[148:151], v[88:91], a[200:203], v[148:151]
    v_mfma_f32_16x16x32_bf16 v[148:151], v[92:95], a[216:219], v[148:151]
    v_lshlrev_b32 v227, 3, v240
    v_min_u32 v227, 1920, v227
    s_lshl2_add_u32 s25, s2, s3
    v_mfma_f32_16x16x32_bf16 v[152:155], v[80:83], a[204:207], v[152:155]
    s_lshl_b32 s25, s25, 13
    s_add_u32 s25, s25, 6144
    buffer_load_dword v241, v227, s[12:15], s25 offen
    v_mfma_f32_16x16x32_bf16 v[152:155], v[84:87], a[220:223], v[152:155]
    v_mfma_f32_16x16x32_bf16 v[156:159], v[88:91], a[204:207], v[156:159]
    buffer_load_dword v254, off, s[88:91], s97 sc1
    v_mfma_f32_16x16x32_bf16 v[156:159], v[92:95], a[220:223], v[156:159]
    s_waitcnt vmcnt(9) lgkmcnt(0)
    v_mfma_f32_16x16x32_bf16 v[160:163], v[64:67], a[192:195], v[160:163]
    ds_read_b128 v[80:83], v224 offset:45056
    v_mfma_f32_16x16x32_bf16 v[160:163], v[68:71], a[208:211], v[160:163]
    ds_read_b128 v[84:87], v225 offset:45056
    s_mul_i32 s38, s2, 100
    v_mfma_f32_16x16x32_bf16 v[164:167], v[72:75], a[192:195], v[164:167]
    ds_read_b128 v[88:91], v224 offset:47104
    v_mfma_f32_16x16x32_bf16 v[164:167], v[76:79], a[208:211], v[164:167]
    ds_read_b128 v[92:95], v225 offset:47104
    v_lshl_add_u32 v60, v253, 2, s38
    v_mfma_f32_16x16x32_bf16 v[168:171], v[64:67], a[196:199], v[168:171]
    ds_read_b64_tr_b16 a[224:225], v228 offset:8192
    v_mfma_f32_16x16x32_bf16 v[168:171], v[68:71], a[212:215], v[168:171]
    ds_read_b64_tr_b16 a[226:227], v228 offset:8704
    v_cmp_gt_u32 vcc, 25, v253
    v_mfma_f32_16x16x32_bf16 v[172:175], v[72:75], a[196:199], v[172:175]
    ds_read_b64_tr_b16 a[228:229], v229 offset:8192
    v_mfma_f32_16x16x32_bf16 v[172:175], v[76:79], a[212:215], v[172:175]
    ds_read_b64_tr_b16 a[230:231], v229 offset:8704
    v_mov_b32_e64 v61, 0
    v_mfma_f32_16x16x32_bf16 v[176:179], v[64:67], a[200:203], v[176:179]
    ds_read_b64_tr_b16 a[232:233], v230 offset:8192
    v_mfma_f32_16x16x32_bf16 v[176:179], v[68:71], a[216:219], v[176:179]
    ds_read_b64_tr_b16 a[234:235], v230 offset:8704
    v_mfma_f32_16x16x32_bf16 v[180:183], v[72:75], a[200:203], v[180:183]
    ds_read_b64_tr_b16 a[236:237], v231 offset:8192
    v_mov_b32 v62, 0x7ffffff0
    v_mfma_f32_16x16x32_bf16 v[180:183], v[76:79], a[216:219], v[180:183]
    ds_read_b64_tr_b16 a[238:239], v231 offset:8704
    v_mfma_f32_16x16x32_bf16 v[184:187], v[64:67], a[204:207], v[184:187]
    v_cndmask_b32 v60, v62, v60, vcc
    v_mfma_f32_16x16x32_bf16 v[184:187], v[68:71], a[220:223], v[184:187]
    buffer_store_dword v61, v60, s[56:59], 0 offen sc1
    v_mfma_f32_16x16x32_bf16 v[188:191], v[72:75], a[204:207], v[188:191]
    v_mfma_f32_16x16x32_bf16 v[188:191], v[76:79], a[220:223], v[188:191]
    s_waitcnt vmcnt(21) lgkmcnt(0)
    s_barrier
    v_mfma_f32_16x16x32_bf16 v[192:195], v[80:83], a[192:195], v[192:195]
    ds_read_b128 v[64:67], v224 offset:49152
    v_mfma_f32_16x16x32_bf16 v[192:195], v[84:87], a[208:211], v[192:195]
    ds_read_b128 v[68:71], v225 offset:49152
    v_mfma_f32_16x16x32_bf16 v[196:199], v[88:91], a[192:195], v[196:199]
    ds_read_b128 v[72:75], v224 offset:51200
    v_mfma_f32_16x16x32_bf16 v[196:199], v[92:95], a[208:211], v[196:199]
    ds_read_b128 v[76:79], v225 offset:51200
    v_mfma_f32_16x16x32_bf16 v[200:203], v[80:83], a[196:199], v[200:203]
    ds_read_b64_tr_b16 a[240:241], v228 offset:12288
    v_mfma_f32_16x16x32_bf16 v[200:203], v[84:87], a[212:215], v[200:203]
    ds_read_b64_tr_b16 a[242:243], v228 offset:12800
    v_mfma_f32_16x16x32_bf16 v[204:207], v[88:91], a[196:199], v[204:207]
    ds_read_b64_tr_b16 a[244:245], v229 offset:12288
    v_mfma_f32_16x16x32_bf16 v[204:207], v[92:95], a[212:215], v[204:207]
    ds_read_b64_tr_b16 a[246:247], v229 offset:12800
    v_mfma_f32_16x16x32_bf16 v[208:211], v[80:83], a[200:203], v[208:211]
    ds_read_b64_tr_b16 a[248:249], v230 offset:12288
    v_lshlrev_b32 v237, 4, v253
    v_add_u32 v237, 81920, v237
    ds_read_b128 v[16:19], v237 offset:0
    ds_read_b128 v[20:23], v237 offset:4096
    ds_read_b128 v[24:27], v237 offset:24576
    ds_read_b128 v[28:31], v237 offset:28672
    s_add_u32 m0, s34, 32768
    s_add_u32 s37, s84, 131072
    buffer_load_dwordx4 v232, s[44:47], s37 offen lds
    v_mfma_f32_16x16x32_bf16 v[208:211], v[84:87], a[216:219], v[208:211]
    ds_read_b64_tr_b16 a[250:251], v230 offset:12800
    v_mfma_f32_16x16x32_bf16 v[212:215], v[88:91], a[200:203], v[212:215]
    ds_read_b64_tr_b16 a[252:253], v231 offset:12288
    v_mfma_f32_16x16x32_bf16 v[212:215], v[92:95], a[216:219], v[212:215]
    ds_read_b64_tr_b16 a[254:255], v231 offset:12800
    v_mfma_f32_16x16x32_bf16 v[216:219], v[80:83], a[204:207], v[216:219]
    buffer_load_dwordx4 v233, s[44:47], s37 offen offset:1024 lds
    v_mfma_f32_16x16x32_bf16 v[216:219], v[84:87], a[220:223], v[216:219]
    v_mfma_f32_16x16x32_bf16 v[220:223], v[88:91], a[204:207], v[220:223]
    v_mfma_f32_16x16x32_bf16 v[220:223], v[92:95], a[220:223], v[220:223]
    s_waitcnt lgkmcnt(0)
    v_mfma_f32_16x16x32_bf16 v[96:99], v[64:67], a[224:227], v[96:99]
    ds_read_b128 v[80:83], v224 offset:53248
    v_mfma_f32_16x16x32_bf16 v[96:99], v[68:71], a[240:243], v[96:99]
    ds_read_b128 v[84:87], v225 offset:53248
    v_mfma_f32_16x16x32_bf16 v[100:103], v[72:75], a[224:227], v[100:103]
    ds_read_b128 v[88:91], v224 offset:55296
    v_mfma_f32_16x16x32_bf16 v[100:103], v[76:79], a[240:243], v[100:103]
    ds_read_b128 v[92:95], v225 offset:55296
    v_mfma_f32_16x16x32_bf16 v[104:107], v[64:67], a[228:231], v[104:107]
    v_mfma_f32_16x16x32_bf16 v[104:107], v[68:71], a[244:247], v[104:107]
    s_mov_b32 s39, 0
    buffer_store_dwordx4 v[16:19], v238, s[8:11], s39 offen sc1
    v_mfma_f32_16x16x32_bf16 v[108:111], v[72:75], a[228:231], v[108:111]
    v_mfma_f32_16x16x32_bf16 v[108:111], v[76:79], a[244:247], v[108:111]
    v_mfma_f32_16x16x32_bf16 v[112:115], v[64:67], a[232:235], v[112:115]
    v_mfma_f32_16x16x32_bf16 v[112:115], v[68:71], a[248:251], v[112:115]
    v_mfma_f32_16x16x32_bf16 v[116:119], v[72:75], a[232:235], v[116:119]
    v_mfma_f32_16x16x32_bf16 v[116:119], v[76:79], a[248:251], v[116:119]
    v_mfma_f32_16x16x32_bf16 v[120:123], v[64:67], a[236:239], v[120:123]
    v_mfma_f32_16x16x32_bf16 v[120:123], v[68:71], a[252:255], v[120:123]
    s_mov_b32 s39, 8192
    buffer_store_dwordx4 v[20:23], v238, s[8:11], s39 offen sc1
    v_mfma_f32_16x16x32_bf16 v[124:127], v[72:75], a[236:239], v[124:127]
    v_mfma_f32_16x16x32_bf16 v[124:127], v[76:79], a[252:255], v[124:127]
    s_waitcnt lgkmcnt(0)
    v_mfma_f32_16x16x32_bf16 v[128:131], v[80:83], a[224:227], v[128:131]
    ds_read_b128 v[64:67], v224 offset:57344
    v_mfma_f32_16x16x32_bf16 v[128:131], v[84:87], a[240:243], v[128:131]
    ds_read_b128 v[68:71], v225 offset:57344
    v_mfma_f32_16x16x32_bf16 v[132:135], v[88:91], a[224:227], v[132:135]
    ds_read_b128 v[72:75], v224 offset:59392
    v_mfma_f32_16x16x32_bf16 v[132:135], v[92:95], a[240:243], v[132:135]
    ds_read_b128 v[76:79], v225 offset:59392
    v_mfma_f32_16x16x32_bf16 v[136:139], v[80:83], a[228:231], v[136:139]
    v_mfma_f32_16x16x32_bf16 v[136:139], v[84:87], a[244:247], v[136:139]
    s_mov_b32 s39, 16384
    buffer_store_dwordx4 v[24:27], v238, s[8:11], s39 offen sc1
    v_mfma_f32_16x16x32_bf16 v[140:143], v[88:91], a[228:231], v[140:143]
    v_mfma_f32_16x16x32_bf16 v[140:143], v[92:95], a[244:247], v[140:143]
    v_mfma_f32_16x16x32_bf16 v[144:147], v[80:83], a[232:235], v[144:147]
    s_add_u32 m0, s34, 40960
    s_add_u32 s37, s85, 131072
    buffer_load_dwordx4 v232, s[44:47], s37 offen lds
    v_mfma_f32_16x16x32_bf16 v[144:147], v[84:87], a[248:251], v[144:147]
    v_mfma_f32_16x16x32_bf16 v[148:151], v[88:91], a[232:235], v[148:151]
    v_mfma_f32_16x16x32_bf16 v[148:151], v[92:95], a[248:251], v[148:151]
    v_mfma_f32_16x16x32_bf16 v[152:155], v[80:83], a[236:239], v[152:155]
    buffer_load_dwordx4 v233, s[44:47], s37 offen offset:1024 lds
    v_mfma_f32_16x16x32_bf16 v[152:155], v[84:87], a[252:255], v[152:155]
    s_mov_b32 s39, 24576
    buffer_store_dwordx4 v[28:31], v238, s[8:11], s39 offen sc1
    v_mfma_f32_16x16x32_bf16 v[156:159], v[88:91], a[236:239], v[156:159]
    v_mfma_f32_16x16x32_bf16 v[156:159], v[92:95], a[252:255], v[156:159]
    s_waitcnt lgkmcnt(0)
    v_mfma_f32_16x16x32_bf16 v[160:163], v[64:67], a[224:227], v[160:163]
    ds_read_b128 v[80:83], v224 offset:61440
    v_mfma_f32_16x16x32_bf16 v[160:163], v[68:71], a[240:243], v[160:163]
    ds_read_b128 v[84:87], v225 offset:61440
    v_mfma_f32_16x16x32_bf16 v[164:167], v[72:75], a[224:227], v[164:167]
    ds_read_b128 v[88:91], v224 offset:63488
    v_mfma_f32_16x16x32_bf16 v[164:167], v[76:79], a[240:243], v[164:167]
    ds_read_b128 v[92:95], v225 offset:63488
    v_mfma_f32_16x16x32_bf16 v[168:171], v[64:67], a[228:231], v[168:171]
    v_mfma_f32_16x16x32_bf16 v[168:171], v[68:71], a[244:247], v[168:171]
    v_mfma_f32_16x16x32_bf16 v[172:175], v[72:75], a[228:231], v[172:175]
    v_mfma_f32_16x16x32_bf16 v[172:175], v[76:79], a[244:247], v[172:175]
    v_mfma_f32_16x16x32_bf16 v[176:179], v[64:67], a[232:235], v[176:179]
    v_mfma_f32_16x16x32_bf16 v[176:179], v[68:71], a[248:251], v[176:179]
    v_cvt_pk_bf16_f32 v0, v96, v97
    v_cvt_pk_bf16_f32 v1, v98, v99
    v_mfma_f32_16x16x32_bf16 v[180:183], v[72:75], a[232:235], v[180:183]
    v_cvt_pk_bf16_f32 v2, v100, v101
    v_cvt_pk_bf16_f32 v3, v102, v103
    v_mfma_f32_16x16x32_bf16 v[180:183], v[76:79], a[248:251], v[180:183]
    v_cvt_pk_bf16_f32 v4, v104, v105
    v_cvt_pk_bf16_f32 v5, v106, v107
    v_mfma_f32_16x16x32_bf16 v[184:187], v[64:67], a[236:239], v[184:187]
    v_cvt_pk_bf16_f32 v6, v108, v109
    v_cvt_pk_bf16_f32 v7, v110, v111
    v_mfma_f32_16x16x32_bf16 v[184:187], v[68:71], a[252:255], v[184:187]
    v_cvt_pk_bf16_f32 v8, v112, v113
    v_cvt_pk_bf16_f32 v9, v114, v115
    v_mfma_f32_16x16x32_bf16 v[188:191], v[72:75], a[236:239], v[188:191]
    v_cvt_pk_bf16_f32 v10, v116, v117
    v_cvt_pk_bf16_f32 v11, v118, v119
    v_mfma_f32_16x16x32_bf16 v[188:191], v[76:79], a[252:255], v[188:191]
    v_cvt_pk_bf16_f32 v12, v120, v121
    v_cvt_pk_bf16_f32 v13, v122, v123
    s_waitcnt vmcnt(16) lgkmcnt(0)
    s_barrier
    v_mfma_f32_16x16x32_bf16 v[192:195], v[80:83], a[224:227], v[192:195]
    ds_read_b128 v[64:67], v224 offset:0
    v_cvt_pk_bf16_f32 v14, v124, v125
    v_cvt_pk_bf16_f32 v15, v126, v127
    v_mfma_f32_16x16x32_bf16 v[192:195], v[84:87], a[240:243], v[192:195]
    ds_read_b128 v[68:71], v225 offset:0
    v_cvt_pk_bf16_f32 v16, v128, v129
    v_cvt_pk_bf16_f32 v17, v130, v131
    v_mfma_f32_16x16x32_bf16 v[196:199], v[88:91], a[224:227], v[196:199]
    ds_read_b128 v[72:75], v224 offset:8192
    v_cvt_pk_bf16_f32 v18, v132, v133
    v_cvt_pk_bf16_f32 v19, v134, v135
    v_mfma_f32_16x16x32_bf16 v[196:199], v[92:95], a[240:243], v[196:199]
    ds_read_b128 v[76:79], v225 offset:8192
    v_cvt_pk_bf16_f32 v20, v136, v137
    v_cvt_pk_bf16_f32 v21, v138, v139
    v_mfma_f32_16x16x32_bf16 v[200:203], v[80:83], a[228:231], v[200:203]
    v_cvt_pk_bf16_f32 v22, v140, v141
    v_cvt_pk_bf16_f32 v23, v142, v143
    v_mfma_f32_16x16x32_bf16 v[200:203], v[84:87], a[244:247], v[200:203]
    v_cvt_pk_bf16_f32 v24, v144, v145
    v_cvt_pk_bf16_f32 v25, v146, v147
    v_mfma_f32_16x16x32_bf16 v[204:207], v[88:91], a[228:231], v[204:207]
    v_cvt_pk_bf16_f32 v26, v148, v149
    v_cvt_pk_bf16_f32 v27, v150, v151
    v_mfma_f32_16x16x32_bf16 v[204:207], v[92:95], a[244:247], v[204:207]
    v_cvt_pk_bf16_f32 v28, v152, v153
    v_cvt_pk_bf16_f32 v29, v154, v155
    v_mfma_f32_16x16x32_bf16 v[208:211], v[80:83], a[232:235], v[208:211]
    s_add_u32 m0, s34, 49152
    s_add_u32 s37, s86, 131072
    buffer_load_dwordx4 v232, s[44:47], s37 offen lds
    v_cvt_pk_bf16_f32 v30, v156, v157
    v_cvt_pk_bf16_f32 v31, v158, v159
    v_mfma_f32_16x16x32_bf16 v[208:211], v[84:87], a[248:251], v[208:211]
    v_cvt_pk_bf16_f32 v32, v160, v161
    v_cvt_pk_bf16_f32 v33, v162, v163
    v_mfma_f32_16x16x32_bf16 v[212:215], v[88:91], a[232:235], v[212:215]
    v_cvt_pk_bf16_f32 v34, v164, v165
    v_cvt_pk_bf16_f32 v35, v166, v167
    v_mfma_f32_16x16x32_bf16 v[212:215], v[92:95], a[248:251], v[212:215]
    v_cvt_pk_bf16_f32 v36, v168, v169
    v_cvt_pk_bf16_f32 v37, v170, v171
    v_mfma_f32_16x16x32_bf16 v[216:219], v[80:83], a[236:239], v[216:219]
    buffer_load_dwordx4 v233, s[44:47], s37 offen offset:1024 lds
    v_cvt_pk_bf16_f32 v38, v172, v173
    v_cvt_pk_bf16_f32 v39, v174, v175
    v_mfma_f32_16x16x32_bf16 v[216:219], v[84:87], a[252:255], v[216:219]
    v_cvt_pk_bf16_f32 v40, v176, v177
    v_cvt_pk_bf16_f32 v41, v178, v179
    v_mfma_f32_16x16x32_bf16 v[220:223], v[88:91], a[236:239], v[220:223]
    v_cvt_pk_bf16_f32 v42, v180, v181
    v_cvt_pk_bf16_f32 v43, v182, v183
    v_mfma_f32_16x16x32_bf16 v[220:223], v[92:95], a[252:255], v[220:223]
    v_cvt_pk_bf16_f32 v44, v184, v185
    v_cvt_pk_bf16_f32 v45, v186, v187
    s_waitcnt lgkmcnt(0)
    v_mfma_f32_16x16x32_bf16 v[96:99], v[64:67], a[0:3], 0
    ds_read_b128 v[80:83], v224 offset:2048
    v_cvt_pk_bf16_f32 v46, v188, v189
    v_cvt_pk_bf16_f32 v47, v190, v191
    v_mfma_f32_16x16x32_bf16 v[96:99], v[68:71], a[16:19], v[96:99]
    ds_read_b128 v[84:87], v225 offset:2048
    v_cvt_pk_bf16_f32 v48, v192, v193
    v_cvt_pk_bf16_f32 v49, v194, v195
    v_mfma_f32_16x16x32_bf16 v[96:99], v[72:75], a[32:35], v[96:99]
    ds_read_b128 v[88:91], v224 offset:10240
    v_cvt_pk_bf16_f32 v50, v196, v197
    v_cvt_pk_bf16_f32 v51, v198, v199
    v_mfma_f32_16x16x32_bf16 v[96:99], v[76:79], a[48:51], v[96:99]
    ds_read_b128 v[92:95], v225 offset:10240
    v_cvt_pk_bf16_f32 v52, v200, v201
    v_cvt_pk_bf16_f32 v53, v202, v203
    v_mfma_f32_16x16x32_bf16 v[104:107], v[64:67], a[4:7], 0
    v_cvt_pk_bf16_f32 v54, v204, v205
    v_cvt_pk_bf16_f32 v55, v206, v207
    s_add_u32 s38, s36, 0
    buffer_store_dwordx4 v[0:3], v240, s[16:19], s38 offen offset:0 sc1
    v_mfma_f32_16x16x32_bf16 v[104:107], v[68:71], a[20:23], v[104:107]
    v_cvt_pk_bf16_f32 v56, v208, v209
    v_cvt_pk_bf16_f32 v57, v210, v211
    v_mfma_f32_16x16x32_bf16 v[104:107], v[72:75], a[36:39], v[104:107]
    v_cvt_pk_bf16_f32 v58, v212, v213
    v_cvt_pk_bf16_f32 v59, v214, v215
    v_mfma_f32_16x16x32_bf16 v[104:107], v[76:79], a[52:55], v[104:107]
    v_cvt_pk_bf16_f32 v60, v216, v217
    v_cvt_pk_bf16_f32 v61, v218, v219
    v_mfma_f32_16x16x32_bf16 v[112:115], v[64:67], a[8:11], 0
    v_xor_b32 v237, 16, v245
    v_xor_b32 v238, 16, v246
    v_cvt_pk_bf16_f32 v62, v220, v221
    v_cvt_pk_bf16_f32 v63, v222, v223
    v_mfma_f32_16x16x32_bf16 v[112:115], v[68:71], a[24:27], v[112:115]
    v_mfma_f32_16x16x32_bf16 v[112:115], v[72:75], a[40:43], v[112:115]
    v_mfma_f32_16x16x32_bf16 v[112:115], v[76:79], a[56:59], v[112:115]
    v_mfma_f32_16x16x32_bf16 v[120:123], v[64:67], a[12:15], 0
    v_mfma_f32_16x16x32_bf16 v[120:123], v[68:71], a[28:31], v[120:123]
    v_mfma_f32_16x16x32_bf16 v[120:123], v[72:75], a[44:47], v[120:123]
    v_mfma_f32_16x16x32_bf16 v[120:123], v[76:79], a[60:63], v[120:123]
    s_waitcnt lgkmcnt(0)
    v_mfma_f32_16x16x32_bf16 v[100:103], v[80:83], a[0:3], 0
    ds_read_b128 v[64:67], v224 offset:4096
    v_mfma_f32_16x16x32_bf16 v[100:103], v[84:87], a[16:19], v[100:103]
    ds_read_b128 v[68:71], v225 offset:4096
    v_mfma_f32_16x16x32_bf16 v[100:103], v[88:91], a[32:35], v[100:103]
    ds_read_b128 v[72:75], v224 offset:12288
    v_mfma_f32_16x16x32_bf16 v[100:103], v[92:95], a[48:51], v[100:103]
    ds_read_b128 v[76:79], v225 offset:12288
    v_mfma_f32_16x16x32_bf16 v[108:111], v[80:83], a[4:7], 0
    v_mfma_f32_16x16x32_bf16 v[108:111], v[84:87], a[20:23], v[108:111]
    v_mfma_f32_16x16x32_bf16 v[108:111], v[88:91], a[36:39], v[108:111]
    v_mfma_f32_16x16x32_bf16 v[108:111], v[92:95], a[52:55], v[108:111]
    v_mfma_f32_16x16x32_bf16 v[116:119], v[80:83], a[8:11], 0
    s_add_u32 m0, s34, 57344
    s_add_u32 s37, s87, 131072
    buffer_load_dwordx4 v232, s[44:47], s37 offen lds
    v_mfma_f32_16x16x32_bf16 v[116:119], v[84:87], a[24:27], v[116:119]
    s_add_u32 s38, s36, 0
    buffer_store_dwordx4 v[4:7], v240, s[16:19], s38 offen offset:1024 sc1
    v_mfma_f32_16x16x32_bf16 v[116:119], v[88:91], a[40:43], v[116:119]
    v_mfma_f32_16x16x32_bf16 v[116:119], v[92:95], a[56:59], v[116:119]
    v_mfma_f32_16x16x32_bf16 v[124:127], v[80:83], a[12:15], 0
    buffer_load_dwordx4 v233, s[44:47], s37 offen offset:1024 lds
    v_mfma_f32_16x16x32_bf16 v[124:127], v[84:87], a[28:31], v[124:127]
    v_mfma_f32_16x16x32_bf16 v[124:127], v[88:91], a[44:47], v[124:127]
    v_mfma_f32_16x16x32_bf16 v[124:127], v[92:95], a[60:63], v[124:127]
    s_waitcnt lgkmcnt(0)
    v_mfma_f32_16x16x32_bf16 v[128:131], v[64:67], a[0:3], 0
    ds_read_b128 v[80:83], v224 offset:6144
    v_mfma_f32_16x16x32_bf16 v[128:131], v[68:71], a[16:19], v[128:131]
    ds_read_b128 v[84:87], v225 offset:6144
    v_mfma_f32_16x16x32_bf16 v[128:131], v[72:75], a[32:35], v[128:131]
    ds_read_b128 v[88:91], v224 offset:14336
    v_mfma_f32_16x16x32_bf16 v[128:131], v[76:79], a[48:51], v[128:131]
    ds_read_b128 v[92:95], v225 offset:14336
    v_mfma_f32_16x16x32_bf16 v[136:139], v[64:67], a[4:7], 0
    v_mfma_f32_16x16x32_bf16 v[136:139], v[68:71], a[20:23], v[136:139]
    v_mfma_f32_16x16x32_bf16 v[136:139], v[72:75], a[36:39], v[136:139]
    v_mfma_f32_16x16x32_bf16 v[136:139], v[76:79], a[52:55], v[136:139]
    v_mfma_f32_16x16x32_bf16 v[144:147], v[64:67], a[8:11], 0
    s_waitcnt vmcnt(15)
    v_readfirstlane_b32 s24, v254
    s_lshl_b32 s25, s3, 16
    s_add_u32 s24, s24, s25
    s_cmp_ge_u32 s24, 1
    s_cbranch_scc0 kf_spin35
kf_spinr36:
    v_mfma_f32_16x16x32_bf16 v[144:147], v[68:71], a[24:27], v[144:147]
    v_mfma_f32_16x16x32_bf16 v[144:147], v[72:75], a[40:43], v[144:147]
    v_mfma_f32_16x16x32_bf16 v[144:147], v[76:79], a[56:59], v[144:147]
    v_mfma_f32_16x16x32_bf16 v[152:155], v[64:67], a[12:15], 0
    s_add_u32 s88, s20, 0x14a0000
    s_addc_u32 s89, s21, 0
    s_mov_b32 s90, 20480
    v_mfma_f32_16x16x32_bf16 v[152:155], v[68:71], a[28:31], v[152:155]
    v_mfma_f32_16x16x32_bf16 v[152:155], v[72:75], a[44:47], v[152:155]
    v_mfma_f32_16x16x32_bf16 v[152:155], v[76:79], a[60:63], v[152:155]
    s_add_u32 s38, s36, 0
    buffer_store_dwordx4 v[8:11], v240, s[16:19], s38 offen offset:2048 sc1
    s_waitcnt vmcnt(7) lgkmcnt(0)
    s_barrier
    v_mfma_f32_16x16x32_bf16 v[132:135], v[80:83], a[0:3], 0
    ds_read_b128 v[64:67], v224 offset:16384
    v_mfma_f32_16x16x32_bf16 v[132:135], v[84:87], a[16:19], v[132:135]
    ds_read_b128 v[68:71], v225 offset:16384
    v_mfma_f32_16x16x32_bf16 v[132:135], v[88:91], a[32:35], v[132:135]
    ds_read_b128 v[72:75], v224 offset:24576
    v_mfma_f32_16x16x32_bf16 v[132:135], v[92:95], a[48:51], v[132:135]
    ds_read_b128 v[76:79], v225 offset:24576
    v_mfma_f32_16x16x32_bf16 v[140:143], v[80:83], a[4:7], 0
    v_mfma_f32_16x16x32_bf16 v[140:143], v[84:87], a[20:23], v[140:143]
    v_mfma_f32_16x16x32_bf16 v[140:143], v[88:91], a[36:39], v[140:143]
    v_mfma_f32_16x16x32_bf16 v[140:143], v[92:95], a[52:55], v[140:143]
    v_mfma_f32_16x16x32_bf16 v[148:151], v[80:83], a[8:11], 0
    s_add_u32 m0, s34, 0
    s_add_u32 s37, s80, 196608
    buffer_load_dwordx4 v232, s[44:47], s37 offen lds
    v_mfma_f32_16x16x32_bf16 v[148:151], v[84:87], a[24:27], v[148:151]
    v_mfma_f32_16x16x32_bf16 v[148:151], v[88:91], a[40:43], v[148:151]
    buffer_load_dwordx4 v233, s[44:47], s37 offen offset:1024 lds
    v_mfma_f32_16x16x32_bf16 v[148:151], v[92:95], a[56:59], v[148:151]
    v_mfma_f32_16x16x32_bf16 v[156:159], v[80:83], a[12:15], 0
    v_mfma_f32_16x16x32_bf16 v[156:159], v[84:87], a[28:31], v[156:159]
    s_lshl_b32 s39, s5, 7
    s_add_u32 s39, s39, 8192
    buffer_atomic_add v255, v250, s[88:91], s39 offen sc1
    s_cmp_eq_u32 s3, 0
    s_cselect_b32 s39, s39, s43
    v_mfma_f32_16x16x32_bf16 v[156:159], v[88:91], a[44:47], v[156:159]
    v_mfma_f32_16x16x32_bf16 v[156:159], v[92:95], a[60:63], v[156:159]
    s_waitcnt lgkmcnt(0)
    v_mfma_f32_16x16x32_bf16 v[96:99], v[64:67], a[64:67], v[96:99]
    ds_read_b128 v[80:83], v224 offset:18432
    v_mfma_f32_16x16x32_bf16 v[96:99], v[68:71], a[80:83], v[96:99]
    ds_read_b128 v[84:87], v225 offset:18432
    v_mfma_f32_16x16x32_bf16 v[96:99], v[72:75], a[96:99], v[96:99]
    ds_read_b128 v[88:91], v224 offset:26624
    v_mfma_f32_16x16x32_bf16 v[96:99], v[76:79], a[112:115], v[96:99]
    ds_read_b128 v[92:95], v225 offset:26624
    v_mfma_f32_16x16x32_bf16 v[104:107], v[64:67], a[68:71], v[104:107]
    s_add_u32 s38, s36, 0
    buffer_store_dwordx4 v[12:15], v240, s[16:19], s38 offen offset:3072 sc1
    v_mfma_f32_16x16x32_bf16 v[104:107], v[68:71], a[84:87], v[104:107]
    v_mfma_f32_16x16x32_bf16 v[104:107], v[72:75], a[100:103], v[104:107]
    v_mfma_f32_16x16x32_bf16 v[104:107], v[76:79], a[116:119], v[104:107]
    v_mfma_f32_16x16x32_bf16 v[112:115], v[64:67], a[72:75], v[112:115]
    s_add_u32 m0, s31, 0
    s_add_u32 s24, s27, 0
    buffer_load_dwordx4 v245, s[12:15], s24 offen lds
    v_mfma_f32_16x16x32_bf16 v[112:115], v[68:71], a[88:91], v[112:115]
    v_mfma_f32_16x16x32_bf16 v[112:115], v[72:75], a[104:107], v[112:115]
    v_mfma_f32_16x16x32_bf16 v[112:115], v[76:79], a[120:123], v[112:115]
    v_mfma_f32_16x16x32_bf16 v[120:123], v[64:67], a[76:79], v[120:123]
    v_mfma_f32_16x16x32_bf16 v[120:123], v[68:71], a[92:95], v[120:123]
    v_mfma_f32_16x16x32_bf16 v[120:123], v[72:75], a[108:111], v[120:123]
    v_mfma_f32_16x16x32_bf16 v[120:123], v[76:79], a[124:127], v[120:123]
    s_waitcnt lgkmcnt(0)
    v_mfma_f32_16x16x32_bf16 v[100:103], v[80:83], a[64:67], v[100:103]
    ds_read_b128 v[64:67], v224 offset:20480
    v_mfma_f32_16x16x32_bf16 v[100:103], v[84:87], a[80:83], v[100:103]
    ds_read_b128 v[68:71], v225 offset:20480
    v_mfma_f32_16x16x32_bf16 v[100:103], v[88:91], a[96:99], v[100:103]
    ds_read_b128 v[72:75], v224 offset:28672
    v_mfma_f32_16x16x32_bf16 v[100:103], v[92:95], a[112:115], v[100:103]
    ds_read_b128 v[76:79], v225 offset:28672
    v_mfma_f32_16x16x32_bf16 v[108:111], v[80:83], a[68:71], v[108:111]
    v_mfma_f32_16x16x32_bf16 v[108:111], v[84:87], a[84:87], v[108:111]
    v_mfma_f32_16x16x32_bf16 v[108:111], v[88:91], a[100:103], v[108:111]
    v_mfma_f32_16x16x32_bf16 v[108:111], v[92:95], a[116:119], v[108:111]
    v_mfma_f32_16x16x32_bf16 v[116:119], v[80:83], a[72:75], v[116:119]
    s_add_u32 m0, s34, 8192
    s_add_u32 s37, s81, 196608
    buffer_load_dwordx4 v232, s[44:47], s37 offen lds
    v_mfma_f32_16x16x32_bf16 v[116:119], v[84:87], a[88:91], v[116:119]
    v_mfma_f32_16x16x32_bf16 v[116:119], v[88:91], a[104:107], v[116:119]
    buffer_load_dwordx4 v233, s[44:47], s37 offen offset:1024 lds
    s_add_u32 s38, s36, 8192
    buffer_store_dwordx4 v[16:19], v240, s[16:19], s38 offen offset:0 sc1
    v_mfma_f32_16x16x32_bf16 v[116:119], v[92:95], a[120:123], v[116:119]
    v_mfma_f32_16x16x32_bf16 v[124:127], v[80:83], a[76:79], v[124:127]
    v_mfma_f32_16x16x32_bf16 v[124:127], v[84:87], a[92:95], v[124:127]
    s_add_u32 m0, s31, 1024
    s_add_u32 s24, s27, 32768
    buffer_load_dwordx4 v245, s[12:15], s24 offen lds
    v_mfma_f32_16x16x32_bf16 v[124:127], v[88:91], a[108:111], v[124:127]
    v_mfma_f32_16x16x32_bf16 v[124:127], v[92:95], a[124:127], v[124:127]
    s_waitcnt lgkmcnt(0)
    v_mfma_f32_16x16x32_bf16 v[128:131], v[64:67], a[64:67], v[128:131]
    ds_read_b128 v[80:83], v224 offset:22528
    v_mfma_f32_16x16x32_bf16 v[128:131], v[68:71], a[80:83], v[128:131]
    ds_read_b128 v[84:87], v225 offset:22528
    v_mfma_f32_16x16x32_bf16 v[128:131], v[72:75], a[96:99], v[128:131]
    ds_read_b128 v[88:91], v224 offset:30720
    v_mfma_f32_16x16x32_bf16 v[128:131], v[76:79], a[112:115], v[128:131]
    ds_read_b128 v[92:95], v225 offset:30720
    v_mfma_f32_16x16x32_bf16 v[136:139], v[64:67], a[68:71], v[136:139]
    v_mfma_f32_16x16x32_bf16 v[136:139], v[68:71], a[84:87], v[136:139]
    v_mfma_f32_16x16x32_bf16 v[136:139], v[72:75], a[100:103], v[136:139]
    v_mfma_f32_16x16x32_bf16 v[136:139], v[76:79], a[116:119], v[136:139]
    v_mfma_f32_16x16x32_bf16 v[144:147], v[64:67], a[72:75], v[144:147]
    s_add_u32 m0, s31, 2048
    s_add_u32 s24, s27, 65536
    buffer_load_dwordx4 v237, s[12:15], s24 offen lds
    v_mfma_f32_16x16x32_bf16 v[144:147], v[68:71], a[88:91], v[144:147]
    v_mfma_f32_16x16x32_bf16 v[144:147], v[72:75], a[104:107], v[144:147]
    v_mfma_f32_16x16x32_bf16 v[144:147], v[76:79], a[120:123], v[144:147]
    v_mfma_f32_16x16x32_bf16 v[152:155], v[64:67], a[76:79], v[152:155]
    v_mfma_f32_16x16x32_bf16 v[152:155], v[68:71], a[92:95], v[152:155]
    v_mfma_f32_16x16x32_bf16 v[152:155], v[72:75], a[108:111], v[152:155]
    v_mfma_f32_16x16x32_bf16 v[152:155], v[76:79], a[124:127], v[152:155]
    s_add_u32 s38, s36, 8192
    buffer_store_dwordx4 v[20:23], v240, s[16:19], s38 offen offset:1024 sc1
    s_waitcnt vmcnt(19) lgkmcnt(0)
    s_barrier
    v_mfma_f32_16x16x32_bf16 v[132:135], v[80:83], a[64:67], v[132:135]
    ds_read_b128 v[64:67], v224 offset:32768
    v_mfma_f32_16x16x32_bf16 v[132:135], v[84:87], a[80:83], v[132:135]
    ds_read_b128 v[68:71], v225 offset:32768
    v_mfma_f32_16x16x32_bf16 v[132:135], v[88:91], a[96:99], v[132:135]
    ds_read_b128 v[72:75], v224 offset:40960
    v_mfma_f32_16x16x32_bf16 v[132:135], v[92:95], a[112:115], v[132:135]
    ds_read_b128 v[76:79], v225 offset:40960
    v_mfma_f32_16x16x32_bf16 v[140:143], v[80:83], a[68:71], v[140:143]
    v_mfma_f32_16x16x32_bf16 v[140:143], v[84:87], a[84:87], v[140:143]
    v_mfma_f32_16x16x32_bf16 v[140:143], v[88:91], a[100:103], v[140:143]
    v_mfma_f32_16x16x32_bf16 v[140:143], v[92:95], a[116:119], v[140:143]
    v_mfma_f32_16x16x32_bf16 v[148:151], v[80:83], a[72:75], v[148:151]
    s_add_u32 m0, s34, 16384
    s_add_u32 s37, s82, 196608
    buffer_load_dwordx4 v232, s[44:47], s37 offen lds
    v_mfma_f32_16x16x32_bf16 v[148:151], v[84:87], a[88:91], v[148:151]
    v_mfma_f32_16x16x32_bf16 v[148:151], v[88:91], a[104:107], v[148:151]
    buffer_load_dwordx4 v233, s[44:47], s37 offen offset:1024 lds
    v_mfma_f32_16x16x32_bf16 v[148:151], v[92:95], a[120:123], v[148:151]
    v_mfma_f32_16x16x32_bf16 v[156:159], v[80:83], a[76:79], v[156:159]
    v_mfma_f32_16x16x32_bf16 v[156:159], v[84:87], a[92:95], v[156:159]
    s_add_u32 m0, s31, 3072
    s_add_u32 s24, s27, 98304
    buffer_load_dwordx4 v237, s[12:15], s24 offen lds
    v_mfma_f32_16x16x32_bf16 v[156:159], v[88:91], a[108:111], v[156:159]
    v_mfma_f32_16x16x32_bf16 v[156:159], v[92:95], a[124:127], v[156:159]
    s_waitcnt lgkmcnt(0)
    v_mfma_f32_16x16x32_bf16 v[96:99], v[64:67], a[128:131], v[96:99]
    ds_read_b128 v[80:83], v224 offset:34816
    v_mfma_f32_16x16x32_bf16 v[96:99], v[68:71], a[144:147], v[96:99]
    ds_read_b128 v[84:87], v225 offset:34816
    v_mfma_f32_16x16x32_bf16 v[96:99], v[72:75], a[160:163], v[96:99]
    ds_read_b128 v[88:91], v224 offset:43008
    v_mfma_f32_16x16x32_bf16 v[96:99], v[76:79], a[176:179], v[96:99]
    ds_read_b128 v[92:95], v225 offset:43008
    v_mfma_f32_16x16x32_bf16 v[104:107], v[64:67], a[132:135], v[104:107]
    v_mfma_f32_16x16x32_bf16 v[104:107], v[68:71], a[148:151], v[104:107]
    s_add_u32 s38, s36, 8192
    buffer_store_dwordx4 v[24:27], v240, s[16:19], s38 offen offset:2048 sc1
    v_mfma_f32_16x16x32_bf16 v[104:107], v[72:75], a[164:167], v[104:107]
    v_mfma_f32_16x16x32_bf16 v[104:107], v[76:79], a[180:183], v[104:107]
    v_mfma_f32_16x16x32_bf16 v[112:115], v[64:67], a[136:139], v[112:115]
    s_add_u32 m0, s31, 4096
    s_add_u32 s24, s27, 131072
    buffer_load_dwordx4 v245, s[12:15], s24 offen lds
    v_mfma_f32_16x16x32_bf16 v[112:115], v[68:71], a[152:155], v[112:115]
    v_mfma_f32_16x16x32_bf16 v[112:115], v[72:75], a[168:171], v[112:115]
    v_mfma_f32_16x16x32_bf16 v[112:115], v[76:79], a[184:187], v[112:115]
    v_mfma_f32_16x16x32_bf16 v[120:123], v[64:67], a[140:143], v[120:123]
    v_mfma_f32_16x16x32_bf16 v[120:123], v[68:71], a[156:159], v[120:123]
    v_mfma_f32_16x16x32_bf16 v[120:123], v[72:75], a[172:175], v[120:123]
    v_mfma_f32_16x16x32_bf16 v[120:123], v[76:79], a[188:191], v[120:123]
    s_waitcnt lgkmcnt(0)
    v_mfma_f32_16x16x32_bf16 v[100:103], v[80:83], a[128:131], v[100:103]
    ds_read_b128 v[64:67], v224 offset:36864
    v_mfma_f32_16x16x32_bf16 v[100:103], v[84:87], a[144:147], v[100:103]
    ds_read_b128 v[68:71], v225 offset:36864
    v_mfma_f32_16x16x32_bf16 v[100:103], v[88:91], a[160:163], v[100:103]
    ds_read_b128 v[72:75], v224 offset:45056
    v_mfma_f32_16x16x32_bf16 v[100:103], v[92:95], a[176:179], v[100:103]
    ds_read_b128 v[76:79], v225 offset:45056
    v_mfma_f32_16x16x32_bf16 v[108:111], v[80:83], a[132:135], v[108:111]
    v_mfma_f32_16x16x32_bf16 v[108:111], v[84:87], a[148:151], v[108:111]
    v_mfma_f32_16x16x32_bf16 v[108:111], v[88:91], a[164:167], v[108:111]
    v_mfma_f32_16x16x32_bf16 v[108:111], v[92:95], a[180:183], v[108:111]
    v_mfma_f32_16x16x32_bf16 v[116:119], v[80:83], a[136:139], v[116:119]
    s_add_u32 m0, s34, 24576
    s_add_u32 s37, s83, 196608
    buffer_load_dwordx4 v232, s[44:47], s37 offen lds
    v_mfma_f32_16x16x32_bf16 v[116:119], v[84:87], a[152:155], v[116:119]
    v_mfma_f32_16x16x32_bf16 v[116:119], v[88:91], a[168:171], v[116:119]
    buffer_load_dwordx4 v233, s[44:47], s37 offen offset:1024 lds
    s_add_u32 s38, s36, 8192
    buffer_store_dwordx4 v[28:31], v240, s[16:19], s38 offen offset:3072 sc1
    v_mfma_f32_16x16x32_bf16 v[116:119], v[92:95], a[184:187], v[116:119]
    v_mfma_f32_16x16x32_bf16 v[124:127], v[80:83], a[140:143], v[124:127]
    v_mfma_f32_16x16x32_bf16 v[124:127], v[84:87], a[156:159], v[124:127]
    s_add_u32 m0, s31, 5120
    s_add_u32 s24, s27, 163840
    buffer_load_dwordx4 v245, s[12:15], s24 offen lds
    v_mfma_f32_16x16x32_bf16 v[124:127], v[88:91], a[172:175], v[124:127]
    v_mfma_f32_16x16x32_bf16 v[124:127], v[92:95], a[188:191], v[124:127]
    s_waitcnt lgkmcnt(0)
    v_mfma_f32_16x16x32_bf16 v[128:131], v[64:67], a[128:131], v[128:131]
    ds_read_b128 v[80:83], v224 offset:38912
    v_mfma_f32_16x16x32_bf16 v[128:131], v[68:71], a[144:147], v[128:131]
    ds_read_b128 v[84:87], v225 offset:38912
    v_mfma_f32_16x16x32_bf16 v[128:131], v[72:75], a[160:163], v[128:131]
    ds_read_b128 v[88:91], v224 offset:47104
    v_mfma_f32_16x16x32_bf16 v[128:131], v[76:79], a[176:179], v[128:131]
    ds_read_b128 v[92:95], v225 offset:47104
    v_mfma_f32_16x16x32_bf16 v[136:139], v[64:67], a[132:135], v[136:139]
    v_mfma_f32_16x16x32_bf16 v[136:139], v[68:71], a[148:151], v[136:139]
    v_mfma_f32_16x16x32_bf16 v[136:139], v[72:75], a[164:167], v[136:139]
    v_mfma_f32_16x16x32_bf16 v[136:139], v[76:79], a[180:183], v[136:139]
    v_mfma_f32_16x16x32_bf16 v[144:147], v[64:67], a[136:139], v[144:147]
    s_add_u32 m0, s31, 6144
    s_add_u32 s24, s27, 196608
    buffer_load_dwordx4 v237, s[12:15], s24 offen lds
    v_mfma_f32_16x16x32_bf16 v[144:147], v[68:71], a[152:155], v[144:147]
    v_mfma_f32_16x16x32_bf16 v[144:147], v[72:75], a[168:171], v[144:147]
    v_mfma_f32_16x16x32_bf16 v[144:147], v[76:79], a[184:187], v[144:147]
    v_mfma_f32_16x16x32_bf16 v[152:155], v[64:67], a[140:143], v[152:155]
    v_mfma_f32_16x16x32_bf16 v[152:155], v[68:71], a[156:159], v[152:155]
    v_mfma_f32_16x16x32_bf16 v[152:155], v[72:75], a[172:175], v[152:155]
    v_mfma_f32_16x16x32_bf16 v[152:155], v[76:79], a[188:191], v[152:155]
    s_waitcnt vmcnt(22) lgkmcnt(0)
    s_barrier
    v_mfma_f32_16x16x32_bf16 v[132:135], v[80:83], a[128:131], v[132:135]
    ds_read_b128 v[64:67], v224 offset:49152
    s_add_u32 s38, s36, 32768
    buffer_store_dwordx4 v[32:35], v240, s[16:19], s38 offen offset:1280 sc1
    v_mfma_f32_16x16x32_bf16 v[132:135], v[84:87], a[144:147], v[132:135]
    ds_read_b128 v[68:71], v225 offset:49152
    v_mfma_f32_16x16x32_bf16 v[132:135], v[88:91], a[160:163], v[132:135]
    ds_read_b128 v[72:75], v224 offset:57344
    v_mfma_f32_16x16x32_bf16 v[132:135], v[92:95], a[176:179], v[132:135]
    ds_read_b128 v[76:79], v225 offset:57344
    v_mfma_f32_16x16x32_bf16 v[140:143], v[80:83], a[132:135], v[140:143]
    v_mfma_f32_16x16x32_bf16 v[140:143], v[84:87], a[148:151], v[140:143]
    v_mfma_f32_16x16x32_bf16 v[140:143], v[88:91], a[164:167], v[140:143]
    v_mfma_f32_16x16x32_bf16 v[140:143], v[92:95], a[180:183], v[140:143]
    v_mfma_f32_16x16x32_bf16 v[148:151], v[80:83], a[136:139], v[148:151]
    s_add_u32 m0, s34, 32768
    s_add_u32 s37, s84, 196608
    buffer_load_dwordx4 v232, s[44:47], s37 offen lds
    v_mfma_f32_16x16x32_bf16 v[148:151], v[84:87], a[152:155], v[148:151]
    buffer_load_dwordx4 v233, s[44:47], s37 offen offset:1024 lds
    v_mfma_f32_16x16x32_bf16 v[148:151], v[88:91], a[168:171], v[148:151]
    v_mfma_f32_16x16x32_bf16 v[148:151], v[92:95], a[184:187], v[148:151]
    s_add_u32 m0, s31, 7168
    s_add_u32 s24, s27, 229376
    buffer_load_dwordx4 v237, s[12:15], s24 offen lds
    v_mfma_f32_16x16x32_bf16 v[156:159], v[80:83], a[140:143], v[156:159]
    s_add_u32 s27, s27, 1048576
    s_and_b32 s27, s27, 0x407fffff
    s_cmp_eq_u32 s27, s7
    s_cselect_b32 s27, s43, s27
    v_mfma_f32_16x16x32_bf16 v[156:159], v[84:87], a[156:159], v[156:159]
    v_mfma_f32_16x16x32_bf16 v[156:159], v[88:91], a[172:175], v[156:159]
    s_add_u32 s31, s31, 32768
    s_cmp_ge_u32 s31, 163840
    s_cselect_b32 s24, 98304, 0
    s_sub_u32 s31, s31, s24
    v_mfma_f32_16x16x32_bf16 v[156:159], v[92:95], a[188:191], v[156:159]
    s_waitcnt lgkmcnt(0)
    v_mfma_f32_16x16x32_bf16 v[96:99], v[64:67], a[192:195], v[96:99]
    ds_read_b128 v[80:83], v224 offset:51200
    v_mfma_f32_16x16x32_bf16 v[96:99], v[68:71], a[208:211], v[96:99]
    ds_read_b128 v[84:87], v225 offset:51200
    v_mfma_f32_16x16x32_bf16 v[96:99], v[72:75], a[224:227], v[96:99]
    ds_read_b128 v[88:91], v224 offset:59392
    v_mfma_f32_16x16x32_bf16 v[96:99], v[76:79], a[240:243], v[96:99]
    ds_read_b128 v[92:95], v225 offset:59392
    v_mfma_f32_16x16x32_bf16 v[104:107], v[64:67], a[196:199], v[104:107]
    v_mfma_f32_16x16x32_bf16 v[104:107], v[68:71], a[212:215], v[104:107]
    v_mfma_f32_16x16x32_bf16 v[104:107], v[72:75], a[228:231], v[104:107]
    s_add_u32 s38, s36, 32768
    buffer_store_dwordx4 v[36:39], v240, s[16:19], s38 offen offset:2304 sc1
    v_mfma_f32_16x16x32_bf16 v[104:107], v[76:79], a[244:247], v[104:107]
    v_mfma_f32_16x16x32_bf16 v[112:115], v[64:67], a[200:203], v[112:115]
    v_mfma_f32_16x16x32_bf16 v[112:115], v[68:71], a[216:219], v[112:115]
    v_mfma_f32_16x16x32_bf16 v[112:115], v[72:75], a[232:235], v[112:115]
    v_mfma_f32_16x16x32_bf16 v[112:115], v[76:79], a[248:251], v[112:115]
    v_mfma_f32_16x16x32_bf16 v[120:123], v[64:67], a[204:207], v[120:123]
    v_mfma_f32_16x16x32_bf16 v[120:123], v[68:71], a[220:223], v[120:123]
    v_mfma_f32_16x16x32_bf16 v[120:123], v[72:75], a[236:239], v[120:123]
    v_mfma_f32_16x16x32_bf16 v[120:123], v[76:79], a[252:255], v[120:123]
    s_waitcnt lgkmcnt(0)
    v_mfma_f32_16x16x32_bf16 v[100:103], v[80:83], a[192:195], v[100:103]
    ds_read_b128 v[64:67], v224 offset:53248
    v_mfma_f32_16x16x32_bf16 v[100:103], v[84:87], a[208:211], v[100:103]
    ds_read_b128 v[68:71], v225 offset:53248
    v_mfma_f32_16x16x32_bf16 v[100:103], v[88:91], a[224:227], v[100:103]
    ds_read_b128 v[72:75], v224 offset:61440
    v_mfma_f32_16x16x32_bf16 v[100:103], v[92:95], a[240:243], v[100:103]
    ds_read_b128 v[76:79], v225 offset:61440
    v_mfma_f32_16x16x32_bf16 v[108:111], v[80:83], a[196:199], v[108:111]
    v_mfma_f32_16x16x32_bf16 v[108:111], v[84:87], a[212:215], v[108:111]
    v_mfma_f32_16x16x32_bf16 v[108:111], v[88:91], a[228:231], v[108:111]
    v_mfma_f32_16x16x32_bf16 v[108:111], v[92:95], a[244:247], v[108:111]
    v_mfma_f32_16x16x32_bf16 v[116:119], v[80:83], a[200:203], v[116:119]
    s_add_u32 m0, s34, 40960
    s_add_u32 s37, s85, 196608
    buffer_load_dwordx4 v232, s[44:47], s37 offen lds
    v_mfma_f32_16x16x32_bf16 v[116:119], v[84:87], a[216:219], v[116:119]
    v_mfma_f32_16x16x32_bf16 v[116:119], v[88:91], a[232:235], v[116:119]
    v_mfma_f32_16x16x32_bf16 v[116:119], v[92:95], a[248:251], v[116:119]
    s_add_u32 s38, s36, 32768
    buffer_store_dwordx4 v[40:43], v240, s[16:19], s38 offen offset:3328 sc1
    v_mfma_f32_16x16x32_bf16 v[124:127], v[80:83], a[204:207], v[124:127]
    buffer_load_dwordx4 v233, s[44:47], s37 offen offset:1024 lds
    v_mfma_f32_16x16x32_bf16 v[124:127], v[84:87], a[220:223], v[124:127]
    v_mfma_f32_16x16x32_bf16 v[124:127], v[88:91], a[236:239], v[124:127]
    v_mfma_f32_16x16x32_bf16 v[124:127], v[92:95], a[252:255], v[124:127]
    s_waitcnt lgkmcnt(0)
    v_mfma_f32_16x16x32_bf16 v[128:131], v[64:67], a[192:195], v[128:131]
    ds_read_b128 v[80:83], v224 offset:55296
    v_mfma_f32_16x16x32_bf16 v[128:131], v[68:71], a[208:211], v[128:131]
    ds_read_b128 v[84:87], v225 offset:55296
    v_mfma_f32_16x16x32_bf16 v[128:131], v[72:75], a[224:227], v[128:131]
    ds_read_b128 v[88:91], v224 offset:63488
    v_mfma_f32_16x16x32_bf16 v[128:131], v[76:79], a[240:243], v[128:131]
    ds_read_b128 v[92:95], v225 offset:63488
    v_mfma_f32_16x16x32_bf16 v[136:139], v[64:67], a[196:199], v[136:139]
    v_mfma_f32_16x16x32_bf16 v[136:139], v[68:71], a[212:215], v[136:139]
    v_mfma_f32_16x16x32_bf16 v[136:139], v[72:75], a[228:231], v[136:139]
    v_mfma_f32_16x16x32_bf16 v[136:139], v[76:79], a[244:247], v[136:139]
    v_mfma_f32_16x16x32_bf16 v[144:147], v[64:67], a[200:203], v[144:147]
    s_add_u32 m0, s31, 0
    s_add_u32 s24, s27, 0
    buffer_load_dwordx4 v245, s[12:15], s24 offen lds
    v_mfma_f32_16x16x32_bf16 v[144:147], v[68:71], a[216:219], v[144:147]
    v_mfma_f32_16x16x32_bf16 v[144:147], v[72:75], a[232:235], v[144:147]
    v_mfma_f32_16x16x32_bf16 v[144:147], v[76:79], a[248:251], v[144:147]
    v_mfma_f32_16x16x32_bf16 v[152:155], v[64:67], a[204:207], v[152:155]
    v_mfma_f32_16x16x32_bf16 v[152:155], v[68:71], a[220:223], v[152:155]
    v_mfma_f32_16x16x32_bf16 v[152:155], v[72:75], a[236:239], v[152:155]
    v_mfma_f32_16x16x32_bf16 v[152:155], v[76:79], a[252:255], v[152:155]
    s_waitcnt vmcnt(23) lgkmcnt(0)
    s_barrier
    v_mfma_f32_16x16x32_bf16 v[132:135], v[80:83], a[192:195], v[132:135]
    ds_read_b128 v[64:67], v224 offset:0
    v_mfma_f32_16x16x32_bf16 v[132:135], v[84:87], a[208:211], v[132:135]
    ds_read_b128 v[68:71], v225 offset:0
    s_add_u32 s38, s36, 36864
    buffer_store_dwordx4 v[44:47], v240, s[16:19], s38 offen offset:256 sc1
    v_mfma_f32_16x16x32_bf16 v[132:135], v[88:91], a[224:227], v[132:135]
    ds_read_b128 v[72:75], v224 offset:8192
    v_mfma_f32_16x16x32_bf16 v[132:135], v[92:95], a[240:243], v[132:135]
    ds_read_b128 v[76:79], v225 offset:8192
    v_mfma_f32_16x16x32_bf16 v[140:143], v[80:83], a[196:199], v[140:143]
    v_mfma_f32_16x16x32_bf16 v[140:143], v[84:87], a[212:215], v[140:143]
    v_mfma_f32_16x16x32_bf16 v[140:143], v[88:91], a[228:231], v[140:143]
    v_mfma_f32_16x16x32_bf16 v[140:143], v[92:95], a[244:247], v[140:143]
    v_mfma_f32_16x16x32_bf16 v[148:151], v[80:83], a[200:203], v[148:151]
    s_add_u32 m0, s34, 49152
    s_add_u32 s37, s86, 196608
    buffer_load_dwordx4 v232, s[44:47], s37 offen lds
    v_mfma_f32_16x16x32_bf16 v[148:151], v[84:87], a[216:219], v[148:151]
    v_mfma_f32_16x16x32_bf16 v[148:151], v[88:91], a[232:235], v[148:151]
    buffer_load_dwordx4 v233, s[44:47], s37 offen offset:1024 lds
    v_mfma_f32_16x16x32_bf16 v[148:151], v[92:95], a[248:251], v[148:151]
    v_mfma_f32_16x16x32_bf16 v[156:159], v[80:83], a[204:207], v[156:159]
    v_mfma_f32_16x16x32_bf16 v[156:159], v[84:87], a[220:223], v[156:159]
    s_add_u32 m0, s31, 1024
    s_add_u32 s24, s27, 32768
    buffer_load_dwordx4 v245, s[12:15], s24 offen lds
    v_mfma_f32_16x16x32_bf16 v[156:159], v[88:91], a[236:239], v[156:159]
    v_mfma_f32_16x16x32_bf16 v[156:159], v[92:95], a[252:255], v[156:159]
    s_waitcnt lgkmcnt(0)
    v_mfma_f32_16x16x32_bf16 v[160:163], v[64:67], a[0:3], 0
    ds_read_b128 v[80:83], v224 offset:2048
    v_mfma_f32_16x16x32_bf16 v[160:163], v[68:71], a[16:19], v[160:163]
    ds_read_b128 v[84:87], v225 offset:2048
    v_mfma_f32_16x16x32_bf16 v[160:163], v[72:75], a[32:35], v[160:163]
    ds_read_b128 v[88:91], v224 offset:10240
    v_mfma_f32_16x16x32_bf16 v[160:163], v[76:79], a[48:51], v[160:163]
    ds_read_b128 v[92:95], v225 offset:10240
    v_mfma_f32_16x16x32_bf16 v[168:171], v[64:67], a[4:7], 0
    v_cvt_pk_bf16_f32 v0, v96, v97
    v_cvt_pk_bf16_f32 v1, v98, v99
    v_mfma_f32_16x16x32_bf16 v[168:171], v[68:71], a[20:23], v[168:171]
    v_mfma_f32_16x16x32_bf16 v[168:171], v[72:75], a[36:39], v[168:171]
    v_cvt_pk_bf16_f32 v2, v100, v101
    v_cvt_pk_bf16_f32 v3, v102, v103
    s_add_u32 s38, s36, 40960
    buffer_store_dwordx4 v[48:51], v240, s[16:19], s38 offen offset:1280 sc1
    v_mfma_f32_16x16x32_bf16 v[168:171], v[76:79], a[52:55], v[168:171]
    v_mfma_f32_16x16x32_bf16 v[176:179], v[64:67], a[8:11], 0
    s_add_u32 m0, s31, 2048
    s_add_u32 s24, s27, 65536
    buffer_load_dwordx4 v237, s[12:15], s24 offen lds
    v_cvt_pk_bf16_f32 v4, v104, v105
    v_cvt_pk_bf16_f32 v5, v106, v107
    v_mfma_f32_16x16x32_bf16 v[176:179], v[68:71], a[24:27], v[176:179]
    v_mfma_f32_16x16x32_bf16 v[176:179], v[72:75], a[40:43], v[176:179]
    v_cvt_pk_bf16_f32 v6, v108, v109
    v_cvt_pk_bf16_f32 v7, v110, v111
    v_mfma_f32_16x16x32_bf16 v[176:179], v[76:79], a[56:59], v[176:179]
    v_mfma_f32_16x16x32_bf16 v[184:187], v[64:67], a[12:15], 0
    v_cvt_pk_bf16_f32 v8, v112, v113
    v_cvt_pk_bf16_f32 v9, v114, v115
    v_mfma_f32_16x16x32_bf16 v[184:187], v[68:71], a[28:31], v[184:187]
    v_mfma_f32_16x16x32_bf16 v[184:187], v[72:75], a[44:47], v[184:187]
    v_cvt_pk_bf16_f32 v10, v116, v117
    v_cvt_pk_bf16_f32 v11, v118, v119
    v_mfma_f32_16x16x32_bf16 v[184:187], v[76:79], a[60:63], v[184:187]
    s_waitcnt lgkmcnt(0)
    v_mfma_f32_16x16x32_bf16 v[164:167], v[80:83], a[0:3], 0
    ds_read_b128 v[64:67], v224 offset:4096
    v_cvt_pk_bf16_f32 v12, v120, v121
    v_cvt_pk_bf16_f32 v13, v122, v123
    v_mfma_f32_16x16x32_bf16 v[164:167], v[84:87], a[16:19], v[164:167]
    ds_read_b128 v[68:71], v225 offset:4096
    v_mfma_f32_16x16x32_bf16 v[164:167], v[88:91], a[32:35], v[164:167]
    ds_read_b128 v[72:75], v224 offset:12288
    v_cvt_pk_bf16_f32 v14, v124, v125
    v_cvt_pk_bf16_f32 v15, v126, v127
    v_mfma_f32_16x16x32_bf16 v[164:167], v[92:95], a[48:51], v[164:167]
    ds_read_b128 v[76:79], v225 offset:12288
    v_mfma_f32_16x16x32_bf16 v[172:175], v[80:83], a[4:7], 0
    v_cvt_pk_bf16_f32 v16, v128, v129
    v_cvt_pk_bf16_f32 v17, v130, v131
    v_mfma_f32_16x16x32_bf16 v[172:175], v[84:87], a[20:23], v[172:175]
    v_mfma_f32_16x16x32_bf16 v[172:175], v[88:91], a[36:39], v[172:175]
    v_cvt_pk_bf16_f32 v18, v132, v133
    v_cvt_pk_bf16_f32 v19, v134, v135
    v_mfma_f32_16x16x32_bf16 v[172:175], v[92:95], a[52:55], v[172:175]
    v_mfma_f32_16x16x32_bf16 v[180:183], v[80:83], a[8:11], 0
    s_add_u32 m0, s34, 57344
    s_add_u32 s37, s87, 196608
    buffer_load_dwordx4 v232, s[44:47], s37 offen lds
    v_cvt_pk_bf16_f32 v20, v136, v137
    v_cvt_pk_bf16_f32 v21, v138, v139
    v_mfma_f32_16x16x32_bf16 v[180:183], v[84:87], a[24:27], v[180:183]
    v_mfma_f32_16x16x32_bf16 v[180:183], v[88:91], a[40:43], v[180:183]
    buffer_load_dwordx4 v233, s[44:47], s37 offen offset:1024 lds
    v_cvt_pk_bf16_f32 v22, v140, v141
    v_cvt_pk_bf16_f32 v23, v142, v143
    v_mfma_f32_16x16x32_bf16 v[180:183], v[92:95], a[56:59], v[180:183]
    v_mfma_f32_16x16x32_bf16 v[188:191], v[80:83], a[12:15], 0
    v_cvt_pk_bf16_f32 v24, v144, v145
    v_cvt_pk_bf16_f32 v25, v146, v147
    s_add_u32 s38, s36, 40960
    buffer_store_dwordx4 v[52:55], v240, s[16:19], s38 offen offset:2304 sc1
    v_mfma_f32_16x16x32_bf16 v[188:191], v[84:87], a[28:31], v[188:191]
    s_add_u32 m0, s31, 3072
    s_add_u32 s24, s27, 98304
    buffer_load_dwordx4 v237, s[12:15], s24 offen lds
    v_mfma_f32_16x16x32_bf16 v[188:191], v[88:91], a[44:47], v[188:191]
    v_cvt_pk_bf16_f32 v26, v148, v149
    v_cvt_pk_bf16_f32 v27, v150, v151
    v_mfma_f32_16x16x32_bf16 v[188:191], v[92:95], a[60:63], v[188:191]
    s_waitcnt lgkmcnt(0)
    v_mfma_f32_16x16x32_bf16 v[192:195], v[64:67], a[0:3], 0
    ds_read_b128 v[80:83], v224 offset:6144
    v_cvt_pk_bf16_f32 v28, v152, v153
    v_cvt_pk_bf16_f32 v29, v154, v155
    v_mfma_f32_16x16x32_bf16 v[192:195], v[68:71], a[16:19], v[192:195]
    ds_read_b128 v[84:87], v225 offset:6144
    v_mfma_f32_16x16x32_bf16 v[192:195], v[72:75], a[32:35], v[192:195]
    ds_read_b128 v[88:91], v224 offset:14336
    v_cvt_pk_bf16_f32 v30, v156, v157
    v_cvt_pk_bf16_f32 v31, v158, v159
    v_mfma_f32_16x16x32_bf16 v[192:195], v[76:79], a[48:51], v[192:195]
    ds_read_b128 v[92:95], v225 offset:14336
    v_mfma_f32_16x16x32_bf16 v[200:203], v[64:67], a[4:7], 0
    v_mfma_f32_16x16x32_bf16 v[200:203], v[68:71], a[20:23], v[200:203]
    v_mfma_f32_16x16x32_bf16 v[200:203], v[72:75], a[36:39], v[200:203]
    v_mfma_f32_16x16x32_bf16 v[200:203], v[76:79], a[52:55], v[200:203]
    v_mfma_f32_16x16x32_bf16 v[208:211], v[64:67], a[8:11], 0
    s_add_u32 m0, s31, 4096
    s_add_u32 s24, s27, 131072
    buffer_load_dwordx4 v245, s[12:15], s24 offen lds
    v_mfma_f32_16x16x32_bf16 v[208:211], v[68:71], a[24:27], v[208:211]
    v_mfma_f32_16x16x32_bf16 v[208:211], v[72:75], a[40:43], v[208:211]
    v_mfma_f32_16x16x32_bf16 v[208:211], v[76:79], a[56:59], v[208:211]
    v_mfma_f32_16x16x32_bf16 v[216:219], v[64:67], a[12:15], 0
    v_mfma_f32_16x16x32_bf16 v[216:219], v[68:71], a[28:31], v[216:219]
    v_mfma_f32_16x16x32_bf16 v[216:219], v[72:75], a[44:47], v[216:219]
    v_mfma_f32_16x16x32_bf16 v[216:219], v[76:79], a[60:63], v[216:219]
    s_waitcnt vmcnt(23) lgkmcnt(0)
    s_barrier
    v_mfma_f32_16x16x32_bf16 v[196:199], v[80:83], a[0:3], 0
    ds_read_b128 v[64:67], v224 offset:16384
    v_mfma_f32_16x16x32_bf16 v[196:199], v[84:87], a[16:19], v[196:199]
    ds_read_b128 v[68:71], v225 offset:16384
    s_add_u32 s38, s36, 40960
    buffer_store_dwordx4 v[56:59], v240, s[16:19], s38 offen offset:3328 sc1
    v_mfma_f32_16x16x32_bf16 v[196:199], v[88:91], a[32:35], v[196:199]
    ds_read_b128 v[72:75], v224 offset:24576
    v_mfma_f32_16x16x32_bf16 v[196:199], v[92:95], a[48:51], v[196:199]
    ds_read_b128 v[76:79], v225 offset:24576
    v_mfma_f32_16x16x32_bf16 v[204:207], v[80:83], a[4:7], 0
    v_mfma_f32_16x16x32_bf16 v[204:207], v[84:87], a[20:23], v[204:207]
    v_mfma_f32_16x16x32_bf16 v[204:207], v[88:91], a[36:39], v[204:207]
    v_mfma_f32_16x16x32_bf16 v[204:207], v[92:95], a[52:55], v[204:207]
    v_mfma_f32_16x16x32_bf16 v[212:215], v[80:83], a[8:11], 0
    s_add_u32 m0, s31, 5120
    s_add_u32 s24, s27, 163840
    buffer_load_dwordx4 v245, s[12:15], s24 offen lds
    v_mfma_f32_16x16x32_bf16 v[212:215], v[84:87], a[24:27], v[212:215]
    v_mfma_f32_16x16x32_bf16 v[212:215], v[88:91], a[40:43], v[212:215]
    v_mfma_f32_16x16x32_bf16 v[212:215], v[92:95], a[56:59], v[212:215]
    v_mfma_f32_16x16x32_bf16 v[220:223], v[80:83], a[12:15], 0
    v_mfma_f32_16x16x32_bf16 v[220:223], v[84:87], a[28:31], v[220:223]
    v_mfma_f32_16x16x32_bf16 v[220:223], v[88:91], a[44:47], v[220:223]
    v_mfma_f32_16x16x32_bf16 v[220:223], v[92:95], a[60:63], v[220:223]
    s_waitcnt lgkmcnt(0)
    v_mfma_f32_16x16x32_bf16 v[160:163], v[64:67], a[64:67], v[160:163]
    ds_read_b128 v[80:83], v224 offset:18432
    v_mfma_f32_16x16x32_bf16 v[160:163], v[68:71], a[80:83], v[160:163]
    ds_read_b128 v[84:87], v225 offset:18432
    v_mfma_f32_16x16x32_bf16 v[160:163], v[72:75], a[96:99], v[160:163]
    ds_read_b128 v[88:91], v224 offset:26624
    v_mfma_f32_16x16x32_bf16 v[160:163], v[76:79], a[112:115], v[160:163]
    ds_read_b128 v[92:95], v225 offset:26624
    v_mfma_f32_16x16x32_bf16 v[168:171], v[64:67], a[68:71], v[168:171]
    v_mfma_f32_16x16x32_bf16 v[168:171], v[68:71], a[84:87], v[168:171]
    v_mfma_f32_16x16x32_bf16 v[168:171], v[72:75], a[100:103], v[168:171]
    v_mfma_f32_16x16x32_bf16 v[168:171], v[76:79], a[116:119], v[168:171]
    s_add_u32 s38, s36, 45056
    buffer_store_dwordx4 v[60:63], v240, s[16:19], s38 offen offset:256 sc1
    v_mfma_f32_16x16x32_bf16 v[176:179], v[64:67], a[72:75], v[176:179]
    s_add_u32 m0, s31, 6144
    s_add_u32 s24, s27, 196608
    buffer_load_dwordx4 v237, s[12:15], s24 offen lds
    v_mfma_f32_16x16x32_bf16 v[176:179], v[68:71], a[88:91], v[176:179]
    v_mfma_f32_16x16x32_bf16 v[176:179], v[72:75], a[104:107], v[176:179]
    v_mfma_f32_16x16x32_bf16 v[176:179], v[76:79], a[120:123], v[176:179]
    v_mfma_f32_16x16x32_bf16 v[184:187], v[64:67], a[76:79], v[184:187]
    v_mfma_f32_16x16x32_bf16 v[184:187], v[68:71], a[92:95], v[184:187]
    v_mfma_f32_16x16x32_bf16 v[184:187], v[72:75], a[108:111], v[184:187]
    v_mfma_f32_16x16x32_bf16 v[184:187], v[76:79], a[124:127], v[184:187]
    s_waitcnt lgkmcnt(0)
    v_mfma_f32_16x16x32_bf16 v[164:167], v[80:83], a[64:67], v[164:167]
    ds_read_b128 v[64:67], v224 offset:20480
    v_mfma_f32_16x16x32_bf16 v[164:167], v[84:87], a[80:83], v[164:167]
    ds_read_b128 v[68:71], v225 offset:20480
    v_mfma_f32_16x16x32_bf16 v[164:167], v[88:91], a[96:99], v[164:167]
    ds_read_b128 v[72:75], v224 offset:28672
    v_mfma_f32_16x16x32_bf16 v[164:167], v[92:95], a[112:115], v[164:167]
    ds_read_b128 v[76:79], v225 offset:28672
    v_mfma_f32_16x16x32_bf16 v[172:175], v[80:83], a[68:71], v[172:175]
    v_mfma_f32_16x16x32_bf16 v[172:175], v[84:87], a[84:87], v[172:175]
    v_mfma_f32_16x16x32_bf16 v[172:175], v[88:91], a[100:103], v[172:175]
    v_mfma_f32_16x16x32_bf16 v[172:175], v[92:95], a[116:119], v[172:175]
    v_mfma_f32_16x16x32_bf16 v[180:183], v[80:83], a[72:75], v[180:183]
    s_add_u32 m0, s31, 7168
    s_add_u32 s24, s27, 229376
    buffer_load_dwordx4 v237, s[12:15], s24 offen lds
    v_mfma_f32_16x16x32_bf16 v[180:183], v[84:87], a[88:91], v[180:183]
    v_mfma_f32_16x16x32_bf16 v[180:183], v[88:91], a[104:107], v[180:183]
    s_add_u32 s27, s27, 1048576
    s_and_b32 s27, s27, 0x407fffff
    s_cmp_eq_u32 s27, s7
    s_cselect_b32 s27, s43, s27
    v_mfma_f32_16x16x32_bf16 v[180:183], v[92:95], a[120:123], v[180:183]
    v_mfma_f32_16x16x32_bf16 v[188:191], v[80:83], a[76:79], v[188:191]
    v_mfma_f32_16x16x32_bf16 v[188:191], v[84:87], a[92:95], v[188:191]
    s_add_u32 s31, s31, 32768
    s_cmp_ge_u32 s31, 163840
    s_cselect_b32 s24, 98304, 0
    s_sub_u32 s31, s31, s24
    s_add_u32 s38, s36, 65536
    buffer_store_dwordx4 v[0:3], v240, s[16:19], s38 offen offset:2560 sc1
    v_mfma_f32_16x16x32_bf16 v[188:191], v[88:91], a[108:111], v[188:191]
    v_mfma_f32_16x16x32_bf16 v[188:191], v[92:95], a[124:127], v[188:191]
    s_waitcnt lgkmcnt(0)
    v_mfma_f32_16x16x32_bf16 v[192:195], v[64:67], a[64:67], v[192:195]
    ds_read_b128 v[80:83], v224 offset:22528
    v_mfma_f32_16x16x32_bf16 v[192:195], v[68:71], a[80:83], v[192:195]
    ds_read_b128 v[84:87], v225 offset:22528
    v_mfma_f32_16x16x32_bf16 v[192:195], v[72:75], a[96:99], v[192:195]
    ds_read_b128 v[88:91], v224 offset:30720
    v_mfma_f32_16x16x32_bf16 v[192:195], v[76:79], a[112:115], v[192:195]
    ds_read_b128 v[92:95], v225 offset:30720
    v_mfma_f32_16x16x32_bf16 v[200:203], v[64:67], a[68:71], v[200:203]
    v_mfma_f32_16x16x32_bf16 v[200:203], v[68:71], a[84:87], v[200:203]
    v_mfma_f32_16x16x32_bf16 v[200:203], v[72:75], a[100:103], v[200:203]
    v_mfma_f32_16x16x32_bf16 v[200:203], v[76:79], a[116:119], v[200:203]
    v_mfma_f32_16x16x32_bf16 v[208:211], v[64:67], a[72:75], v[208:211]
    v_mfma_f32_16x16x32_bf16 v[208:211], v[68:71], a[88:91], v[208:211]
    v_mfma_f32_16x16x32_bf16 v[208:211], v[72:75], a[104:107], v[208:211]
    v_mfma_f32_16x16x32_bf16 v[208:211], v[76:79], a[120:123], v[208:211]
    v_mfma_f32_16x16x32_bf16 v[216:219], v[64:67], a[76:79], v[216:219]
    v_mfma_f32_16x16x32_bf16 v[216:219], v[68:71], a[92:95], v[216:219]
    v_mfma_f32_16x16x32_bf16 v[216:219], v[72:75], a[108:111], v[216:219]
    v_mfma_f32_16x16x32_bf16 v[216:219], v[76:79], a[124:127], v[216:219]
    s_waitcnt vmcnt(9) lgkmcnt(0)
    s_barrier
    v_mfma_f32_16x16x32_bf16 v[196:199], v[80:83], a[64:67], v[196:199]
    ds_read_b128 v[64:67], v224 offset:32768
    v_mfma_f32_16x16x32_bf16 v[196:199], v[84:87], a[80:83], v[196:199]
    ds_read_b128 v[68:71], v225 offset:32768
    v_mfma_f32_16x16x32_bf16 v[196:199], v[88:91], a[96:99], v[196:199]
    ds_read_b128 v[72:75], v224 offset:40960
    s_add_u32 s38, s36, 65536
    buffer_store_dwordx4 v[4:7], v240, s[16:19], s38 offen offset:3584 sc1
    v_mfma_f32_16x16x32_bf16 v[196:199], v[92:95], a[112:115], v[196:199]
    ds_read_b128 v[76:79], v225 offset:40960
    v_mfma_f32_16x16x32_bf16 v[204:207], v[80:83], a[68:71], v[204:207]
    v_mfma_f32_16x16x32_bf16 v[204:207], v[84:87], a[84:87], v[204:207]
    v_mfma_f32_16x16x32_bf16 v[204:207], v[88:91], a[100:103], v[204:207]
    v_mfma_f32_16x16x32_bf16 v[204:207], v[92:95], a[116:119], v[204:207]
    v_mfma_f32_16x16x32_bf16 v[212:215], v[80:83], a[72:75], v[212:215]
    v_mfma_f32_16x16x32_bf16 v[212:215], v[84:87], a[88:91], v[212:215]
    v_mfma_f32_16x16x32_bf16 v[212:215], v[88:91], a[104:107], v[212:215]
    v_mfma_f32_16x16x32_bf16 v[212:215], v[92:95], a[120:123], v[212:215]
    v_mfma_f32_16x16x32_bf16 v[220:223], v[80:83], a[76:79], v[220:223]
    v_mfma_f32_16x16x32_bf16 v[220:223], v[84:87], a[92:95], v[220:223]
    v_mfma_f32_16x16x32_bf16 v[220:223], v[88:91], a[108:111], v[220:223]
    v_mfma_f32_16x16x32_bf16 v[220:223], v[92:95], a[124:127], v[220:223]
    s_waitcnt lgkmcnt(0)
    v_mfma_f32_16x16x32_bf16 v[160:163], v[64:67], a[128:131], v[160:163]
    ds_read_b128 v[80:83], v224 offset:34816
    v_mfma_f32_16x16x32_bf16 v[160:163], v[68:71], a[144:147], v[160:163]
    ds_read_b128 v[84:87], v225 offset:34816
    v_mfma_f32_16x16x32_bf16 v[160:163], v[72:75], a[160:163], v[160:163]
    ds_read_b128 v[88:91], v224 offset:43008
    v_mfma_f32_16x16x32_bf16 v[160:163], v[76:79], a[176:179], v[160:163]
    ds_read_b128 v[92:95], v225 offset:43008
    v_mfma_f32_16x16x32_bf16 v[168:171], v[64:67], a[132:135], v[168:171]
    v_mfma_f32_16x16x32_bf16 v[168:171], v[68:71], a[148:151], v[168:171]
    v_mfma_f32_16x16x32_bf16 v[168:171], v[72:75], a[164:167], v[168:171]
    v_mfma_f32_16x16x32_bf16 v[168:171], v[76:79], a[180:183], v[168:171]
    v_mfma_f32_16x16x32_bf16 v[176:179], v[64:67], a[136:139], v[176:179]
    buffer_load_dword v254, off, s[88:91], s39 sc1
    s_add_u32 s38, s36, 69632
    buffer_store_dwordx4 v[8:11], v240, s[16:19], s38 offen offset:512 sc1
    v_mfma_f32_16x16x32_bf16 v[176:179], v[68:71], a[152:155], v[176:179]
    v_mfma_f32_16x16x32_bf16 v[176:179], v[72:75], a[168:171], v[176:179]
    v_mfma_f32_16x16x32_bf16 v[176:179], v[76:79], a[184:187], v[176:179]
    v_mfma_f32_16x16x32_bf16 v[184:187], v[64:67], a[140:143], v[184:187]
    v_mfma_f32_16x16x32_bf16 v[184:187], v[68:71], a[156:159], v[184:187]
    v_mfma_f32_16x16x32_bf16 v[184:187], v[72:75], a[172:175], v[184:187]
    v_mfma_f32_16x16x32_bf16 v[184:187], v[76:79], a[188:191], v[184:187]
    s_waitcnt lgkmcnt(0)
    v_mfma_f32_16x16x32_bf16 v[164:167], v[80:83], a[128:131], v[164:167]
    ds_read_b128 v[64:67], v224 offset:36864
    v_mfma_f32_16x16x32_bf16 v[164:167], v[84:87], a[144:147], v[164:167]
    ds_read_b128 v[68:71], v225 offset:36864
    v_mfma_f32_16x16x32_bf16 v[164:167], v[88:91], a[160:163], v[164:167]
    ds_read_b128 v[72:75], v224 offset:45056
    v_mfma_f32_16x16x32_bf16 v[164:167], v[92:95], a[176:179], v[164:167]
    ds_read_b128 v[76:79], v225 offset:45056
    v_mfma_f32_16x16x32_bf16 v[172:175], v[80:83], a[132:135], v[172:175]
    v_mfma_f32_16x16x32_bf16 v[172:175], v[84:87], a[148:151], v[172:175]
    v_mfma_f32_16x16x32_bf16 v[172:175], v[88:91], a[164:167], v[172:175]
    v_mfma_f32_16x16x32_bf16 v[172:175], v[92:95], a[180:183], v[172:175]
    v_mfma_f32_16x16x32_bf16 v[180:183], v[80:83], a[136:139], v[180:183]
    v_mfma_f32_16x16x32_bf16 v[180:183], v[84:87], a[152:155], v[180:183]
    v_mfma_f32_16x16x32_bf16 v[180:183], v[88:91], a[168:171], v[180:183]
    v_mfma_f32_16x16x32_bf16 v[180:183], v[92:95], a[184:187], v[180:183]
    v_mfma_f32_16x16x32_bf16 v[188:191], v[80:83], a[140:143], v[188:191]
    v_mfma_f32_16x16x32_bf16 v[188:191], v[84:87], a[156:159], v[188:191]
    s_add_u32 s38, s36, 69632
    buffer_store_dwordx4 v[12:15], v240, s[16:19], s38 offen offset:1536 sc1
    v_mfma_f32_16x16x32_bf16 v[188:191], v[88:91], a[172:175], v[188:191]
    v_mfma_f32_16x16x32_bf16 v[188:191], v[92:95], a[188:191], v[188:191]
    s_waitcnt lgkmcnt(0)
    v_mfma_f32_16x16x32_bf16 v[192:195], v[64:67], a[128:131], v[192:195]
    ds_read_b128 v[80:83], v224 offset:38912
    v_mfma_f32_16x16x32_bf16 v[192:195], v[68:71], a[144:147], v[192:195]
    ds_read_b128 v[84:87], v225 offset:38912
    v_mfma_f32_16x16x32_bf16 v[192:195], v[72:75], a[160:163], v[192:195]
    ds_read_b128 v[88:91], v224 offset:47104
    v_mfma_f32_16x16x32_bf16 v[192:195], v[76:79], a[176:179], v[192:195]
    ds_read_b128 v[92:95], v225 offset:47104
    v_mfma_f32_16x16x32_bf16 v[200:203], v[64:67], a[132:135], v[200:203]
    v_mfma_f32_16x16x32_bf16 v[200:203], v[68:71], a[148:151], v[200:203]
    v_mfma_f32_16x16x32_bf16 v[200:203], v[72:75], a[164:167], v[200:203]
    v_mfma_f32_16x16x32_bf16 v[200:203], v[76:79], a[180:183], v[200:203]
    v_mfma_f32_16x16x32_bf16 v[208:211], v[64:67], a[136:139], v[208:211]
    v_mfma_f32_16x16x32_bf16 v[208:211], v[68:71], a[152:155], v[208:211]
    v_mfma_f32_16x16x32_bf16 v[208:211], v[72:75], a[168:171], v[208:211]
    v_mfma_f32_16x16x32_bf16 v[208:211], v[76:79], a[184:187], v[208:211]
    v_mfma_f32_16x16x32_bf16 v[216:219], v[64:67], a[140:143], v[216:219]
    v_mfma_f32_16x16x32_bf16 v[216:219], v[68:71], a[156:159], v[216:219]
    v_mfma_f32_16x16x32_bf16 v[216:219], v[72:75], a[172:175], v[216:219]
    v_mfma_f32_16x16x32_bf16 v[216:219], v[76:79], a[188:191], v[216:219]
    s_waitcnt lgkmcnt(0)
    v_mfma_f32_16x16x32_bf16 v[196:199], v[80:83], a[128:131], v[196:199]
    ds_read_b128 v[64:67], v224 offset:49152
    v_mfma_f32_16x16x32_bf16 v[196:199], v[84:87], a[144:147], v[196:199]
    ds_read_b128 v[68:71], v224 offset:51200
    v_mfma_f32_16x16x32_bf16 v[196:199], v[88:91], a[160:163], v[196:199]
    ds_read_b128 v[72:75], v224 offset:53248
    v_mfma_f32_16x16x32_bf16 v[196:199], v[92:95], a[176:179], v[196:199]
    ds_read_b128 v[76:79], v224 offset:55296
    s_add_u32 s38, s36, 73728
    buffer_store_dwordx4 v[16:19], v240, s[16:19], s38 offen offset:2560 sc1
    v_mfma_f32_16x16x32_bf16 v[204:207], v[80:83], a[132:135], v[204:207]
    v_mfma_f32_16x16x32_bf16 v[204:207], v[84:87], a[148:151], v[204:207]
    v_mfma_f32_16x16x32_bf16 v[204:207], v[88:91], a[164:167], v[204:207]
    v_mfma_f32_16x16x32_bf16 v[204:207], v[92:95], a[180:183], v[204:207]
    v_mfma_f32_16x16x32_bf16 v[212:215], v[80:83], a[136:139], v[212:215]
    v_mfma_f32_16x16x32_bf16 v[212:215], v[84:87], a[152:155], v[212:215]
    v_mfma_f32_16x16x32_bf16 v[212:215], v[88:91], a[168:171], v[212:215]
    v_mfma_f32_16x16x32_bf16 v[212:215], v[92:95], a[184:187], v[212:215]
    v_mfma_f32_16x16x32_bf16 v[220:223], v[80:83], a[140:143], v[220:223]
    v_mfma_f32_16x16x32_bf16 v[220:223], v[84:87], a[156:159], v[220:223]
    v_mfma_f32_16x16x32_bf16 v[220:223], v[88:91], a[172:175], v[220:223]
    v_mfma_f32_16x16x32_bf16 v[220:223], v[92:95], a[188:191], v[220:223]
    s_waitcnt vmcnt(3)
    v_readfirstlane_b32 s24, v254
    s_lshl_b32 s25, s3, 16
    s_add_u32 s24, s24, s25
    s_cmp_ge_u32 s24, 32
    s_cbranch_scc0 kf_spin37
kf_spinr38:
    s_waitcnt lgkmcnt(0)
    s_barrier
    v_mfma_f32_16x16x32_bf16 v[160:163], v[64:67], a[192:195], v[160:163]
    ds_read_b128 v[80:83], v225 offset:49152
    v_mfma_f32_16x16x32_bf16 v[164:167], v[68:71], a[192:195], v[164:167]
    ds_read_b128 v[84:87], v225 offset:51200
    v_mfma_f32_16x16x32_bf16 v[168:171], v[64:67], a[196:199], v[168:171]
    ds_read_b128 v[88:91], v225 offset:53248
    v_mfma_f32_16x16x32_bf16 v[172:175], v[68:71], a[196:199], v[172:175]
    ds_read_b128 v[92:95], v225 offset:55296
    v_mfma_f32_16x16x32_bf16 v[176:179], v[64:67], a[200:203], v[176:179]
    v_mfma_f32_16x16x32_bf16 v[180:183], v[68:71], a[200:203], v[180:183]
    v_mfma_f32_16x16x32_bf16 v[184:187], v[64:67], a[204:207], v[184:187]
    v_mfma_f32_16x16x32_bf16 v[188:191], v[68:71], a[204:207], v[188:191]
    v_mfma_f32_16x16x32_bf16 v[192:195], v[72:75], a[192:195], v[192:195]
    buffer_load_dwordx4 a[128:131], v248, s[8:11], s28 offen offset:0 sc1
    s_add_u32 s38, s36, 73728
    buffer_store_dwordx4 v[20:23], v240, s[16:19], s38 offen offset:3584 sc1
    v_mfma_f32_16x16x32_bf16 v[196:199], v[76:79], a[192:195], v[196:199]
    v_mfma_f32_16x16x32_bf16 v[200:203], v[72:75], a[196:199], v[200:203]
    buffer_load_dwordx4 a[132:135], v248, s[8:11], s29 offen offset:0 sc1
    v_mfma_f32_16x16x32_bf16 v[204:207], v[76:79], a[196:199], v[204:207]
    v_mfma_f32_16x16x32_bf16 v[208:211], v[72:75], a[200:203], v[208:211]
    v_mfma_f32_16x16x32_bf16 v[212:215], v[76:79], a[200:203], v[212:215]
    buffer_load_dwordx4 a[136:139], v249, s[8:11], s28 offen offset:0 sc1
    v_mfma_f32_16x16x32_bf16 v[216:219], v[72:75], a[204:207], v[216:219]
    v_mfma_f32_16x16x32_bf16 v[220:223], v[76:79], a[204:207], v[220:223]
    s_waitcnt lgkmcnt(0)
    v_mfma_f32_16x16x32_bf16 v[160:163], v[80:83], a[208:211], v[160:163]
    ds_read_b128 v[64:67], v224 offset:57344
    v_mfma_f32_16x16x32_bf16 v[164:167], v[84:87], a[208:211], v[164:167]
    ds_read_b128 v[68:71], v224 offset:59392
    v_mfma_f32_16x16x32_bf16 v[168:171], v[80:83], a[212:215], v[168:171]
    ds_read_b128 v[72:75], v224 offset:61440
    v_mfma_f32_16x16x32_bf16 v[172:175], v[84:87], a[212:215], v[172:175]
    ds_read_b128 v[76:79], v224 offset:63488
    v_mfma_f32_16x16x32_bf16 v[176:179], v[80:83], a[216:219], v[176:179]
    v_mfma_f32_16x16x32_bf16 v[180:183], v[84:87], a[216:219], v[180:183]
    v_mfma_f32_16x16x32_bf16 v[184:187], v[80:83], a[220:223], v[184:187]
    v_mfma_f32_16x16x32_bf16 v[188:191], v[84:87], a[220:223], v[188:191]
    v_mfma_f32_16x16x32_bf16 v[192:195], v[88:91], a[208:211], v[192:195]
    buffer_load_dwordx4 a[140:143], v249, s[8:11], s29 offen offset:0 sc1
    v_mfma_f32_16x16x32_bf16 v[196:199], v[92:95], a[208:211], v[196:199]
    v_mfma_f32_16x16x32_bf16 v[200:203], v[88:91], a[212:215], v[200:203]
    buffer_load_dwordx4 a[144:147], v248, s[8:11], s28 offen offset:1024 sc1
    v_mfma_f32_16x16x32_bf16 v[204:207], v[92:95], a[212:215], v[204:207]
    v_mfma_f32_16x16x32_bf16 v[208:211], v[88:91], a[216:219], v[208:211]
    v_mfma_f32_16x16x32_bf16 v[212:215], v[92:95], a[216:219], v[212:215]
    buffer_load_dwordx4 a[148:151], v248, s[8:11], s29 offen offset:1024 sc1
    v_mfma_f32_16x16x32_bf16 v[216:219], v[88:91], a[220:223], v[216:219]
    s_add_u32 s38, s36, 77824
    buffer_store_dwordx4 v[24:27], v240, s[16:19], s38 offen offset:512 sc1
    v_mfma_f32_16x16x32_bf16 v[220:223], v[92:95], a[220:223], v[220:223]
    s_waitcnt lgkmcnt(0)
    v_mfma_f32_16x16x32_bf16 v[160:163], v[64:67], a[224:227], v[160:163]
    ds_read_b128 v[80:83], v225 offset:57344
    v_mfma_f32_16x16x32_bf16 v[164:167], v[68:71], a[224:227], v[164:167]
    ds_read_b128 v[84:87], v225 offset:59392
    v_mfma_f32_16x16x32_bf16 v[168:171], v[64:67], a[228:231], v[168:171]
    ds_read_b128 v[88:91], v225 offset:61440
    v_mfma_f32_16x16x32_bf16 v[172:175], v[68:71], a[228:231], v[172:175]
    ds_read_b128 v[92:95], v225 offset:63488
    v_mfma_f32_16x16x32_bf16 v[176:179], v[64:67], a[232:235], v[176:179]
    v_mfma_f32_16x16x32_bf16 v[180:183], v[68:71], a[232:235], v[180:183]
    v_mfma_f32_16x16x32_bf16 v[184:187], v[64:67], a[236:239], v[184:187]
    v_mfma_f32_16x16x32_bf16 v[188:191], v[68:71], a[236:239], v[188:191]
    v_mfma_f32_16x16x32_bf16 v[192:195], v[72:75], a[224:227], v[192:195]
    buffer_load_dwordx4 a[152:155], v249, s[8:11], s28 offen offset:1024 sc1
    v_mfma_f32_16x16x32_bf16 v[196:199], v[76:79], a[224:227], v[196:199]
    v_mfma_f32_16x16x32_bf16 v[200:203], v[72:75], a[228:231], v[200:203]
    buffer_load_dwordx4 a[156:159], v249, s[8:11], s29 offen offset:1024 sc1
    v_mfma_f32_16x16x32_bf16 v[204:207], v[76:79], a[228:231], v[204:207]
    v_mfma_f32_16x16x32_bf16 v[208:211], v[72:75], a[232:235], v[208:211]
    v_mfma_f32_16x16x32_bf16 v[212:215], v[76:79], a[232:235], v[212:215]
    buffer_load_dwordx4 a[160:163], v248, s[8:11], s28 offen offset:2048 sc1
    v_mfma_f32_16x16x32_bf16 v[216:219], v[72:75], a[236:239], v[216:219]
    v_mfma_f32_16x16x32_bf16 v[220:223], v[76:79], a[236:239], v[220:223]
    s_waitcnt vmcnt(38) lgkmcnt(0)
    s_barrier
    v_mfma_f32_16x16x32_bf16 v[160:163], v[80:83], a[240:243], v[160:163]
    ds_read_b64_tr_b16 a[192:193], v246 offset:0
    v_mfma_f32_16x16x32_bf16 v[164:167], v[84:87], a[240:243], v[164:167]
    ds_read_b64_tr_b16 a[194:195], v246 offset:1024
    v_mfma_f32_16x16x32_bf16 v[168:171], v[80:83], a[244:247], v[168:171]
    ds_read_b64_tr_b16 a[196:197], v238 offset:0
    v_mfma_f32_16x16x32_bf16 v[172:175], v[84:87], a[244:247], v[172:175]
    ds_read_b64_tr_b16 a[198:199], v238 offset:1024
    v_mfma_f32_16x16x32_bf16 v[176:179], v[80:83], a[248:251], v[176:179]
    ds_read_b64_tr_b16 a[200:201], v246 offset:256
    s_add_u32 s38, s36, 77824
    buffer_store_dwordx4 v[28:31], v240, s[16:19], s38 offen offset:1536 sc1
    v_mfma_f32_16x16x32_bf16 v[180:183], v[84:87], a[248:251], v[180:183]
    ds_read_b64_tr_b16 a[202:203], v246 offset:1280
    v_mfma_f32_16x16x32_bf16 v[184:187], v[80:83], a[252:255], v[184:187]
    ds_read_b64_tr_b16 a[204:205], v238 offset:256
    v_mfma_f32_16x16x32_bf16 v[188:191], v[84:87], a[252:255], v[188:191]
    ds_read_b64_tr_b16 a[206:207], v238 offset:1280
    v_mfma_f32_16x16x32_bf16 v[192:195], v[88:91], a[240:243], v[192:195]
    buffer_load_dwordx4 a[164:167], v248, s[8:11], s29 offen offset:2048 sc1
    v_mfma_f32_16x16x32_bf16 v[196:199], v[92:95], a[240:243], v[196:199]
    v_cvt_pk_bf16_f32 v32, v160, v161
    v_cvt_pk_bf16_f32 v33, v162, v163
    v_mfma_f32_16x16x32_bf16 v[200:203], v[88:91], a[244:247], v[200:203]
    buffer_load_dwordx4 a[168:171], v249, s[8:11], s28 offen offset:2048 sc1
    v_cvt_pk_bf16_f32 v34, v164, v165
    v_cvt_pk_bf16_f32 v35, v166, v167
    v_mfma_f32_16x16x32_bf16 v[204:207], v[92:95], a[244:247], v[204:207]
    v_cvt_pk_bf16_f32 v36, v168, v169
    v_cvt_pk_bf16_f32 v37, v170, v171
    v_mfma_f32_16x16x32_bf16 v[208:211], v[88:91], a[248:251], v[208:211]
    v_cvt_pk_bf16_f32 v38, v172, v173
    v_cvt_pk_bf16_f32 v39, v174, v175
    v_mfma_f32_16x16x32_bf16 v[212:215], v[92:95], a[248:251], v[212:215]
    buffer_load_dwordx4 a[172:175], v249, s[8:11], s29 offen offset:2048 sc1
    v_cvt_pk_bf16_f32 v40, v176, v177
    v_cvt_pk_bf16_f32 v41, v178, v179
    v_mfma_f32_16x16x32_bf16 v[216:219], v[88:91], a[252:255], v[216:219]
    v_cvt_pk_bf16_f32 v42, v180, v181
    v_cvt_pk_bf16_f32 v43, v182, v183
    v_mfma_f32_16x16x32_bf16 v[220:223], v[92:95], a[252:255], v[220:223]
    v_cvt_pk_bf16_f32 v44, v184, v185
    v_cvt_pk_bf16_f32 v45, v186, v187
    s_nop 3
    v_cvt_pk_bf16_f32 v46, v188, v189
    v_cvt_pk_bf16_f32 v47, v190, v191
    v_cvt_pk_bf16_f32 v48, v192, v193
    v_cvt_pk_bf16_f32 v49, v194, v195
    v_cvt_pk_bf16_f32 v50, v196, v197
    v_cvt_pk_bf16_f32 v51, v198, v199
    v_cvt_pk_bf16_f32 v52, v200, v201
    v_cvt_pk_bf16_f32 v53, v202, v203
    v_cvt_pk_bf16_f32 v54, v204, v205
    v_cvt_pk_bf16_f32 v55, v206, v207
    v_cvt_pk_bf16_f32 v56, v208, v209
    v_cvt_pk_bf16_f32 v57, v210, v211
    v_cvt_pk_bf16_f32 v58, v212, v213
    v_cvt_pk_bf16_f32 v59, v214, v215
    v_cvt_pk_bf16_f32 v60, v216, v217
    v_cvt_pk_bf16_f32 v61, v218, v219
    v_cvt_pk_bf16_f32 v62, v220, v221
    v_cvt_pk_bf16_f32 v63, v222, v223
    s_add_u32 s80, s36, 102144
    s_add_u32 s81, s36, 103168
    s_add_u32 s82, s36, 104192
    s_add_u32 s83, s36, 105216
    s_add_u32 s84, s36, 110336
    s_add_u32 s85, s36, 111360
    s_add_u32 s86, s36, 112384
    s_add_u32 s87, s36, 113408
ka_Q:
    s_waitcnt vmcnt(10) lgkmcnt(0)
    v_mfma_f32_16x16x32_bf16 v[96:99], a[192:195], a[128:131], 0
    ds_read_b64_tr_b16 a[208:209], v246 offset:512
    s_lshl_b32 s97, s4, 7
    v_mfma_f32_16x16x32_bf16 v[100:103], a[192:195], a[132:135], 0
    ds_read_b64_tr_b16 a[210:211], v246 offset:1536
    s_add_u32 s97, s97, 12288
    s_cmp_eq_u32 s3, 0
    s_cselect_b32 s35, s97, s43
    v_mfma_f32_16x16x32_bf16 v[104:107], a[192:195], a[136:139], 0
    ds_read_b64_tr_b16 a[212:213], v238 offset:512
    s_lshl_b32 s37, s3, 12
    v_mfma_f32_16x16x32_bf16 v[108:111], a[192:195], a[140:143], 0
    ds_read_b64_tr_b16 a[214:215], v238 offset:1536
    s_mov_b32 s34, s37
    s_mul_i32 s32, s4, 1089536
    v_mfma_f32_16x16x32_bf16 v[112:115], a[196:199], a[128:131], 0
    ds_read_b64_tr_b16 a[216:217], v246 offset:768
    s_mov_b32 s33, 0
    v_mfma_f32_16x16x32_bf16 v[116:119], a[196:199], a[132:135], 0
    ds_read_b64_tr_b16 a[218:219], v246 offset:1792
    s_lshl_b32 s39, s6, 18
    v_mfma_f32_16x16x32_bf16 v[120:123], a[196:199], a[136:139], 0
    ds_read_b64_tr_b16 a[220:221], v238 offset:768
    s_sub_u32 s25, 63, s6
    s_lshl_b32 s40, s25, 18
    v_mfma_f32_16x16x32_bf16 v[124:127], a[196:199], a[140:143], 0
    ds_read_b64_tr_b16 a[222:223], v238 offset:1792
    s_lshl_b32 s25, s4, 12
    v_mfma_f32_16x16x32_bf16 v[128:131], a[200:203], a[128:131], 0
    buffer_load_dwordx4 a[176:179], v248, s[8:11], s28 offen offset:3072 sc1
    s_add_u32 s39, s39, s25
    s_add_u32 s40, s40, s25
    v_mfma_f32_16x16x32_bf16 v[132:135], a[200:203], a[132:135], 0
    s_mov_b32 s38, 0x40004000
    s_mov_b32 s36, s6
    v_mfma_f32_16x16x32_bf16 v[136:139], a[200:203], a[136:139], 0
    buffer_load_dwordx4 a[180:183], v248, s[8:11], s29 offen offset:3072 sc1
    s_mov_b32 s26, 6
    v_mfma_f32_16x16x32_bf16 v[140:143], a[200:203], a[140:143], 0
    s_add_u32 m0, s31, 0
    s_add_u32 s24, s27, 0
    s_mov_b32 s52, s41
    v_mfma_f32_16x16x32_bf16 v[144:147], a[204:207], a[128:131], 0
    buffer_load_dwordx4 v245, s[12:15], s24 offen lds
    s_mov_b32 s53, s42
    v_mfma_f32_16x16x32_bf16 v[148:151], a[204:207], a[132:135], 0
    s_mov_b32 s54, 0x700000
    s_add_u32 s48, s20, 0x1c00000
    s_addc_u32 s49, s21, 0
    v_mfma_f32_16x16x32_bf16 v[152:155], a[204:207], a[136:139], 0
    buffer_store_dwordx4 v[32:35], v240, s[16:19], s80 offen sc1
    s_mov_b32 s50, 0x1c00000
    s_and_b32 s25, s3, 1
    v_mfma_f32_16x16x32_bf16 v[156:159], a[204:207], a[140:143], 0
    s_lshl1_add_u32 s47, s4, s25
    s_waitcnt lgkmcnt(0)
    v_mfma_f32_16x16x32_bf16 v[160:163], a[208:211], a[128:131], 0
    ds_read_b64_tr_b16 a[192:193], v246 offset:8192
    s_lshr_b32 s101, s3, 1
    v_mfma_f32_16x16x32_bf16 v[164:167], a[208:211], a[132:135], 0
    ds_read_b64_tr_b16 a[194:195], v246 offset:9216
    s_add_u32 s45, s5, s101
    s_sub_u32 s45, s45, 1
    v_mfma_f32_16x16x32_bf16 v[168:171], a[208:211], a[136:139], 0
    ds_read_b64_tr_b16 a[196:197], v238 offset:8192
    s_mul_i32 s45, s45, s5
    v_mfma_f32_16x16x32_bf16 v[172:175], a[208:211], a[140:143], 0
    ds_read_b64_tr_b16 a[198:199], v238 offset:9216
    s_lshl_b32 s100, s101, 14
    s_add_u32 s100, s100, 114688
    v_mfma_f32_16x16x32_bf16 v[176:179], a[212:215], a[128:131], 0
    ds_read_b64_tr_b16 a[200:201], v246 offset:8448
    s_mul_i32 s100, s100, s47
    v_mfma_f32_16x16x32_bf16 v[180:183], a[212:215], a[132:135], 0
    ds_read_b64_tr_b16 a[202:203], v246 offset:9472
    s_lshl_b32 s25, s45, 11
    v_mfma_f32_16x16x32_bf16 v[184:187], a[212:215], a[136:139], 0
    ds_read_b64_tr_b16 a[204:205], v238 offset:8448
    s_add_u32 s100, s100, s25
    s_lshl_b32 s46, s47, 9
    v_mfma_f32_16x16x32_bf16 v[188:191], a[212:215], a[140:143], 0
    ds_read_b64_tr_b16 a[206:207], v238 offset:9472
    s_mul_i32 s44, s47, 114688
    v_mfma_f32_16x16x32_bf16 v[192:195], a[216:219], a[128:131], 0
    buffer_load_dwordx4 a[184:187], v249, s[8:11], s28 offen offset:3072 sc1
    s_add_u32 s47, s44, 7168
    s_lshl_b32 s25, s45, 7
    v_mfma_f32_16x16x32_bf16 v[196:199], a[216:219], a[132:135], 0
    s_add_u32 s44, s44, s25
    s_lshl_b32 s45, s45, 18
    v_mfma_f32_16x16x32_bf16 v[200:203], a[216:219], a[136:139], 0
    buffer_load_dwordx4 a[188:191], v249, s[8:11], s29 offen offset:3072 sc1
    s_add_u32 s46, s46, s45
    v_mfma_f32_16x16x32_bf16 v[204:207], a[216:219], a[140:143], 0
    s_add_u32 m0, s31, 1024
    s_add_u32 s24, s27, 32768
    s_lshr_b32 s25, s3, 1
    v_mfma_f32_16x16x32_bf16 v[208:211], a[220:223], a[128:131], 0
    buffer_load_dwordx4 v245, s[12:15], s24 offen lds
    s_lshl_b32 s25, s25, 15
    v_mfma_f32_16x16x32_bf16 v[212:215], a[220:223], a[132:135], 0
    s_add_u32 s46, s46, s25
    s_mov_b32 s45, s43
    v_mfma_f32_16x16x32_bf16 v[216:219], a[220:223], a[136:139], 0
    s_add_u32 s28, s28, 4096
    s_and_b32 s28, s28, 32767
    buffer_store_dwordx4 v[36:39], v240, s[16:19], s81 offen sc1
    v_mfma_f32_16x16x32_bf16 v[220:223], a[220:223], a[140:143], 0
    s_add_u32 s29, s28, 32768
    v_accvgpr_write_b32 a0, 0
    s_waitcnt vmcnt(13) lgkmcnt(0)
    v_mfma_f32_16x16x32_bf16 v[96:99], a[192:195], a[144:147], v[96:99]
    ds_read_b64_tr_b16 a[208:209], v246 offset:8704
    s_load_dwordx2 s[56:57], s[0:1], 40
    v_accvgpr_write_b32 a1, 0
    v_mfma_f32_16x16x32_bf16 v[100:103], a[192:195], a[148:151], v[100:103]
    ds_read_b64_tr_b16 a[210:211], v246 offset:9728
    v_accvgpr_write_b32 a2, 0
    v_mfma_f32_16x16x32_bf16 v[104:107], a[192:195], a[152:155], v[104:107]
    ds_read_b64_tr_b16 a[212:213], v238 offset:8704
    v_accvgpr_write_b32 a3, 0
    v_mfma_f32_16x16x32_bf16 v[108:111], a[192:195], a[156:159], v[108:111]
    ds_read_b64_tr_b16 a[214:215], v238 offset:9728
    v_accvgpr_write_b32 a4, 0
    v_accvgpr_write_b32 a5, 0
    v_mfma_f32_16x16x32_bf16 v[112:115], a[196:199], a[144:147], v[112:115]
    ds_read_b64_tr_b16 a[216:217], v246 offset:8960
    v_accvgpr_write_b32 a6, 0
    v_mfma_f32_16x16x32_bf16 v[116:119], a[196:199], a[148:151], v[116:119]
    ds_read_b64_tr_b16 a[218:219], v246 offset:9984
    v_accvgpr_write_b32 a7, 0
    v_accvgpr_write_b32 a8, 0
    v_mfma_f32_16x16x32_bf16 v[120:123], a[196:199], a[152:155], v[120:123]
    ds_read_b64_tr_b16 a[220:221], v238 offset:8960
    v_accvgpr_write_b32 a9, 0
    v_mfma_f32_16x16x32_bf16 v[124:127], a[196:199], a[156:159], v[124:127]
    ds_read_b64_tr_b16 a[222:223], v238 offset:9984
    v_accvgpr_write_b32 a10, 0
    v_mfma_f32_16x16x32_bf16 v[128:131], a[200:203], a[144:147], v[128:131]
    buffer_load_dwordx4 a[128:131], v248, s[8:11], s28 offen offset:0 sc1
    v_accvgpr_write_b32 a11, 0
    v_accvgpr_write_b32 a12, 0
    v_mfma_f32_16x16x32_bf16 v[132:135], a[200:203], a[148:151], v[132:135]
    v_accvgpr_write_b32 a13, 0
    v_accvgpr_write_b32 a14, 0
    v_mfma_f32_16x16x32_bf16 v[136:139], a[200:203], a[152:155], v[136:139]
    buffer_load_dwordx4 a[132:135], v248, s[8:11], s29 offen offset:0 sc1
    v_accvgpr_write_b32 a15, 0
    v_mfma_f32_16x16x32_bf16 v[140:143], a[200:203], a[156:159], v[140:143]
    s_add_u32 m0, s31, 2048
    s_add_u32 s24, s27, 65536
    v_accvgpr_write_b32 a16, 0
    v_mfma_f32_16x16x32_bf16 v[144:147], a[204:207], a[144:147], v[144:147]
    buffer_load_dwordx4 v237, s[12:15], s24 offen lds
    v_accvgpr_write_b32 a17, 0
    v_mfma_f32_16x16x32_bf16 v[148:151], a[204:207], a[148:151], v[148:151]
    v_accvgpr_write_b32 a18, 0
    v_accvgpr_write_b32 a19, 0
    v_accvgpr_write_b32 a20, 0
    v_mfma_f32_16x16x32_bf16 v[152:155], a[204:207], a[152:155], v[152:155]
    buffer_store_dwordx4 v[40:43], v240, s[16:19], s82 offen sc1
    v_accvgpr_write_b32 a21, 0
    v_mfma_f32_16x16x32_bf16 v[156:159], a[204:207], a[156:159], v[156:159]
    v_accvgpr_write_b32 a22, 0
    s_waitcnt lgkmcnt(0)
    v_mfma_f32_16x16x32_bf16 v[160:163], a[208:211], a[144:147], v[160:163]
    ds_read_b64_tr_b16 a[192:193], v246 offset:16384
    v_accvgpr_write_b32 a23, 0
    v_accvgpr_write_b32 a24, 0
    v_mfma_f32_16x16x32_bf16 v[164:167], a[208:211], a[148:151], v[164:167]
    ds_read_b64_tr_b16 a[194:195], v246 offset:17408
    v_accvgpr_write_b32 a25, 0
    v_mfma_f32_16x16x32_bf16 v[168:171], a[208:211], a[152:155], v[168:171]
    ds_read_b64_tr_b16 a[196:197], v238 offset:16384
    v_accvgpr_write_b32 a26, 0
    v_mfma_f32_16x16x32_bf16 v[172:175], a[208:211], a[156:159], v[172:175]
    ds_read_b64_tr_b16 a[198:199], v238 offset:17408
    v_accvgpr_write_b32 a27, 0
    v_accvgpr_write_b32 a28, 0
    v_mfma_f32_16x16x32_bf16 v[176:179], a[212:215], a[144:147], v[176:179]
    ds_read_b64_tr_b16 a[200:201], v246 offset:16640
    v_accvgpr_write_b32 a29, 0
    v_mfma_f32_16x16x32_bf16 v[180:183], a[212:215], a[148:151], v[180:183]
    ds_read_b64_tr_b16 a[202:203], v246 offset:17664
    v_accvgpr_write_b32 a30, 0
    v_accvgpr_write_b32 a31, 0
    v_mfma_f32_16x16x32_bf16 v[184:187], a[212:215], a[152:155], v[184:187]
    ds_read_b64_tr_b16 a[204:205], v238 offset:16640
    v_accvgpr_write_b32 a32, 0
    v_mfma_f32_16x16x32_bf16 v[188:191], a[212:215], a[156:159], v[188:191]
    ds_read_b64_tr_b16 a[206:207], v238 offset:17664
    v_accvgpr_write_b32 a33, 0
    v_mfma_f32_16x16x32_bf16 v[192:195], a[216:219], a[144:147], v[192:195]
    buffer_load_dwordx4 a[136:139], v249, s[8:11], s28 offen offset:0 sc1
    v_accvgpr_write_b32 a34, 0
    v_accvgpr_write_b32 a35, 0
    v_mfma_f32_16x16x32_bf16 v[196:199], a[216:219], a[148:151], v[196:199]
    v_accvgpr_write_b32 a36, 0
    v_accvgpr_write_b32 a37, 0
    v_mfma_f32_16x16x32_bf16 v[200:203], a[216:219], a[152:155], v[200:203]
    buffer_load_dwordx4 a[140:143], v249, s[8:11], s29 offen offset:0 sc1
    v_accvgpr_write_b32 a38, 0
    v_mfma_f32_16x16x32_bf16 v[204:207], a[216:219], a[156:159], v[204:207]
    s_add_u32 m0, s31, 3072
    s_add_u32 s24, s27, 98304
    v_accvgpr_write_b32 a39, 0
    v_mfma_f32_16x16x32_bf16 v[208:211], a[220:223], a[144:147], v[208:211]
    buffer_load_dwordx4 v237, s[12:15], s24 offen lds
    v_accvgpr_write_b32 a40, 0
    v_mfma_f32_16x16x32_bf16 v[212:215], a[220:223], a[148:151], v[212:215]
    v_accvgpr_write_b32 a41, 0
    v_accvgpr_write_b32 a42, 0
    v_accvgpr_write_b32 a43, 0
    v_mfma_f32_16x16x32_bf16 v[216:219], a[220:223], a[152:155], v[216:219]
    buffer_store_dwordx4 v[44:47], v240, s[16:19], s83 offen sc1
    v_accvgpr_write_b32 a44, 0
    v_mfma_f32_16x16x32_bf16 v[220:223], a[220:223], a[156:159], v[220:223]
    v_accvgpr_write_b32 a45, 0
    s_waitcnt vmcnt(16) lgkmcnt(0)
    v_mfma_f32_16x16x32_bf16 v[96:99], a[192:195], a[160:163], v[96:99]
    ds_read_b64_tr_b16 a[208:209], v246 offset:16896
    v_accvgpr_write_b32 a46, 0
    v_accvgpr_write_b32 a47, 0
    v_mfma_f32_16x16x32_bf16 v[100:103], a[192:195], a[164:167], v[100:103]
    ds_read_b64_tr_b16 a[210:211], v246 offset:17920
    v_accvgpr_write_b32 a48, 0
    v_mfma_f32_16x16x32_bf16 v[104:107], a[192:195], a[168:171], v[104:107]
    ds_read_b64_tr_b16 a[212:213], v238 offset:16896
    v_accvgpr_write_b32 a49, 0
    v_accvgpr_write_b32 a50, 0
    v_mfma_f32_16x16x32_bf16 v[108:111], a[192:195], a[172:175], v[108:111]
    ds_read_b64_tr_b16 a[214:215], v238 offset:17920
    v_accvgpr_write_b32 a51, 0
    v_mfma_f32_16x16x32_bf16 v[112:115], a[196:199], a[160:163], v[112:115]
    ds_read_b64_tr_b16 a[216:217], v246 offset:17152
    v_accvgpr_write_b32 a52, 0
    v_mfma_f32_16x16x32_bf16 v[116:119], a[196:199], a[164:167], v[116:119]
    ds_read_b64_tr_b16 a[218:219], v246 offset:18176
    v_accvgpr_write_b32 a53, 0
    v_accvgpr_write_b32 a54, 0
    v_mfma_f32_16x16x32_bf16 v[120:123], a[196:199], a[168:171], v[120:123]
    ds_read_b64_tr_b16 a[220:221], v238 offset:17152
    v_accvgpr_write_b32 a55, 0
    v_mfma_f32_16x16x32_bf16 v[124:127], a[196:199], a[172:175], v[124:127]
    ds_read_b64_tr_b16 a[222:223], v238 offset:18176
    v_accvgpr_write_b32 a56, 0
    v_accvgpr_write_b32 a57, 0
    v_mfma_f32_16x16x32_bf16 v[128:131], a[200:203], a[160:163], v[128:131]
    buffer_load_dwordx4 a[144:147], v248, s[8:11], s28 offen offset:1024 sc1
    v_accvgpr_write_b32 a58, 0
    v_mfma_f32_16x16x32_bf16 v[132:135], a[200:203], a[164:167], v[132:135]
    v_accvgpr_write_b32 a59, 0
    v_accvgpr_write_b32 a60, 0
    v_mfma_f32_16x16x32_bf16 v[136:139], a[200:203], a[168:171], v[136:139]
    buffer_load_dwordx4 a[148:151], v248, s[8:11], s29 offen offset:1024 sc1
    v_accvgpr_write_b32 a61, 0
    v_mfma_f32_16x16x32_bf16 v[140:143], a[200:203], a[172:175], v[140:143]
    s_add_u32 m0, s31, 4096
    s_add_u32 s24, s27, 131072
    v_accvgpr_write_b32 a62, 0
    v_mfma_f32_16x16x32_bf16 v[144:147], a[204:207], a[160:163], v[144:147]
    buffer_load_dwordx4 v245, s[12:15], s24 offen lds
    v_accvgpr_write_b32 a63, 0
    v_mfma_f32_16x16x32_bf16 v[148:151], a[204:207], a[164:167], v[148:151]
    v_accvgpr_write_b32 a64, 0
    v_accvgpr_write_b32 a65, 0
    v_accvgpr_write_b32 a66, 0
    v_mfma_f32_16x16x32_bf16 v[152:155], a[204:207], a[168:171], v[152:155]
    buffer_store_dwordx4 v[48:51], v240, s[16:19], s84 offen sc1
    v_accvgpr_write_b32 a67, 0
    v_mfma_f32_16x16x32_bf16 v[156:159], a[204:207], a[172:175], v[156:159]
    v_accvgpr_write_b32 a68, 0
    s_waitcnt lgkmcnt(0)
    v_mfma_f32_16x16x32_bf16 v[160:163], a[208:211], a[160:163], v[160:163]
    ds_read_b64_tr_b16 a[192:193], v246 offset:24576
    v_accvgpr_write_b32 a69, 0
    v_accvgpr_write_b32 a70, 0
    v_mfma_f32_16x16x32_bf16 v[164:167], a[208:211], a[164:167], v[164:167]
    ds_read_b64_tr_b16 a[194:195], v246 offset:25600
    v_accvgpr_write_b32 a71, 0
    v_mfma_f32_16x16x32_bf16 v[168:171], a[208:211], a[168:171], v[168:171]
    ds_read_b64_tr_b16 a[196:197], v238 offset:24576
    v_accvgpr_write_b32 a72, 0
    v_accvgpr_write_b32 a73, 0
    v_mfma_f32_16x16x32_bf16 v[172:175], a[208:211], a[172:175], v[172:175]
    ds_read_b64_tr_b16 a[198:199], v238 offset:25600
    v_accvgpr_write_b32 a74, 0
    v_mfma_f32_16x16x32_bf16 v[176:179], a[212:215], a[160:163], v[176:179]
    ds_read_b64_tr_b16 a[200:201], v246 offset:24832
    v_accvgpr_write_b32 a75, 0
    v_mfma_f32_16x16x32_bf16 v[180:183], a[212:215], a[164:167], v[180:183]
    ds_read_b64_tr_b16 a[202:203], v246 offset:25856
    v_accvgpr_write_b32 a76, 0
    v_accvgpr_write_b32 a77, 0
    v_mfma_f32_16x16x32_bf16 v[184:187], a[212:215], a[168:171], v[184:187]
    ds_read_b64_tr_b16 a[204:205], v238 offset:24832
    v_accvgpr_write_b32 a78, 0
    v_mfma_f32_16x16x32_bf16 v[188:191], a[212:215], a[172:175], v[188:191]
    ds_read_b64_tr_b16 a[206:207], v238 offset:25856
    v_accvgpr_write_b32 a79, 0
    v_accvgpr_write_b32 a80, 0
    v_mfma_f32_16x16x32_bf16 v[192:195], a[216:219], a[160:163], v[192:195]
    buffer_load_dwordx4 a[152:155], v249, s[8:11], s28 offen offset:1024 sc1
    v_accvgpr_write_b32 a81, 0
    v_mfma_f32_16x16x32_bf16 v[196:199], a[216:219], a[164:167], v[196:199]
    v_accvgpr_write_b32 a82, 0
    v_accvgpr_write_b32 a83, 0
    v_mfma_f32_16x16x32_bf16 v[200:203], a[216:219], a[168:171], v[200:203]
    buffer_load_dwordx4 a[156:159], v249, s[8:11], s29 offen offset:1024 sc1
    v_accvgpr_write_b32 a84, 0
    v_mfma_f32_16x16x32_bf16 v[204:207], a[216:219], a[172:175], v[204:207]
    s_add_u32 m0, s31, 5120
    s_add_u32 s24, s27, 163840
    v_accvgpr_write_b32 a85, 0
    v_mfma_f32_16x16x32_bf16 v[208:211], a[220:223], a[160:163], v[208:211]
    buffer_load_dwordx4 v245, s[12:15], s24 offen lds
    v_accvgpr_write_b32 a86, 0
    v_accvgpr_write_b32 a87, 0
    v_mfma_f32_16x16x32_bf16 v[212:215], a[220:223], a[164:167], v[212:215]
    v_accvgpr_write_b32 a88, 0
    v_accvgpr_write_b32 a89, 0
    v_mfma_f32_16x16x32_bf16 v[216:219], a[220:223], a[168:171], v[216:219]
    s_add_u32 s30, s30, 32768
    buffer_store_dwordx4 v[52:55], v240, s[16:19], s85 offen sc1
    v_mfma_f32_16x16x32_bf16 v[220:223], a[220:223], a[172:175], v[220:223]
    s_cmp_ge_u32 s30, 163840
    s_cselect_b32 s30, 65536, s30
    s_waitcnt vmcnt(18) lgkmcnt(0)
    v_mfma_f32_16x16x32_bf16 v[96:99], a[192:195], a[176:179], v[96:99]
    ds_read_b64_tr_b16 a[208:209], v246 offset:25088
    v_accvgpr_write_b32 a90, 0
    v_accvgpr_write_b32 a91, 0
    v_mfma_f32_16x16x32_bf16 v[100:103], a[192:195], a[180:183], v[100:103]
    ds_read_b64_tr_b16 a[210:211], v246 offset:26112
    v_accvgpr_write_b32 a92, 0
    v_mfma_f32_16x16x32_bf16 v[104:107], a[192:195], a[184:187], v[104:107]
    ds_read_b64_tr_b16 a[212:213], v238 offset:25088
    v_accvgpr_write_b32 a93, 0
    v_mfma_f32_16x16x32_bf16 v[108:111], a[192:195], a[188:191], v[108:111]
    ds_read_b64_tr_b16 a[214:215], v238 offset:26112
    v_accvgpr_write_b32 a94, 0
    v_accvgpr_write_b32 a95, 0
    v_mfma_f32_16x16x32_bf16 v[112:115], a[196:199], a[176:179], v[112:115]
    ds_read_b64_tr_b16 a[216:217], v246 offset:25344
    v_accvgpr_write_b32 a96, 0
    v_mfma_f32_16x16x32_bf16 v[116:119], a[196:199], a[180:183], v[116:119]
    ds_read_b64_tr_b16 a[218:219], v246 offset:26368
    v_accvgpr_write_b32 a97, 0
    v_accvgpr_write_b32 a98, 0
    v_mfma_f32_16x16x32_bf16 v[120:123], a[196:199], a[184:187], v[120:123]
    ds_read_b64_tr_b16 a[220:221], v238 offset:25344
    v_accvgpr_write_b32 a99, 0
    v_mfma_f32_16x16x32_bf16 v[124:127], a[196:199], a[188:191], v[124:127]
    ds_read_b64_tr_b16 a[222:223], v238 offset:26368
    v_accvgpr_write_b32 a100, 0
    v_mfma_f32_16x16x32_bf16 v[128:131], a[200:203], a[176:179], v[128:131]
    buffer_load_dwordx4 a[160:163], v248, s[8:11], s28 offen offset:2048 sc1
    v_accvgpr_write_b32 a101, 0
    v_accvgpr_write_b32 a102, 0
    v_mfma_f32_16x16x32_bf16 v[132:135], a[200:203], a[180:183], v[132:135]
    v_accvgpr_write_b32 a103, 0
    v_accvgpr_write_b32 a104, 0
    v_mfma_f32_16x16x32_bf16 v[136:139], a[200:203], a[184:187], v[136:139]
    buffer_load_dwordx4 a[164:167], v248, s[8:11], s29 offen offset:2048 sc1
    v_accvgpr_write_b32 a105, 0
    v_mfma_f32_16x16x32_bf16 v[140:143], a[200:203], a[188:191], v[140:143]
    s_add_u32 m0, s31, 6144
    s_add_u32 s24, s27, 196608
    v_accvgpr_write_b32 a106, 0
    v_mfma_f32_16x16x32_bf16 v[144:147], a[204:207], a[176:179], v[144:147]
    buffer_load_dwordx4 v237, s[12:15], s24 offen lds
    v_accvgpr_write_b32 a107, 0
    v_mfma_f32_16x16x32_bf16 v[148:151], a[204:207], a[180:183], v[148:151]
    v_accvgpr_write_b32 a108, 0
    v_accvgpr_write_b32 a109, 0
    v_accvgpr_write_b32 a110, 0
    v_mfma_f32_16x16x32_bf16 v[152:155], a[204:207], a[184:187], v[152:155]
    buffer_store_dwordx4 v[56:59], v240, s[16:19], s86 offen sc1
    v_accvgpr_write_b32 a111, 0
    v_mfma_f32_16x16x32_bf16 v[156:159], a[204:207], a[188:191], v[156:159]
    s_waitcnt vmcnt(49) lgkmcnt(0)
    s_barrier
    v_add_u32 v246, s30, v247
    v_mfma_f32_16x16x32_bf16 v[160:163], a[208:211], a[176:179], v[160:163]
    v_xor_b32_e64 v238, 16, v246
    ds_read_b64_tr_b16 a[192:193], v246 offset:0
    v_accvgpr_write_b32 a112, 0
    v_mfma_f32_16x16x32_bf16 v[164:167], a[208:211], a[180:183], v[164:167]
    ds_read_b64_tr_b16 a[194:195], v246 offset:1024
    v_accvgpr_write_b32 a113, 0
    v_mfma_f32_16x16x32_bf16 v[168:171], a[208:211], a[184:187], v[168:171]
    ds_read_b64_tr_b16 a[196:197], v238 offset:0
    v_accvgpr_write_b32 a114, 0
    v_mfma_f32_16x16x32_bf16 v[172:175], a[208:211], a[188:191], v[172:175]
    ds_read_b64_tr_b16 a[198:199], v238 offset:1024
    v_accvgpr_write_b32 a115, 0
    v_accvgpr_write_b32 a116, 0
    v_mfma_f32_16x16x32_bf16 v[176:179], a[212:215], a[176:179], v[176:179]
    ds_read_b64_tr_b16 a[200:201], v246 offset:256
    v_accvgpr_write_b32 a117, 0
    v_mfma_f32_16x16x32_bf16 v[180:183], a[212:215], a[180:183], v[180:183]
    ds_read_b64_tr_b16 a[202:203], v246 offset:1280
    v_accvgpr_write_b32 a118, 0
    v_accvgpr_write_b32 a119, 0
    v_mfma_f32_16x16x32_bf16 v[184:187], a[212:215], a[184:187], v[184:187]
    ds_read_b64_tr_b16 a[204:205], v238 offset:256
    buffer_store_dwordx4 v[60:63], v240, s[16:19], s87 offen sc1
    v_mfma_f32_16x16x32_bf16 v[188:191], a[212:215], a[188:191], v[188:191]
    ds_read_b64_tr_b16 a[206:207], v238 offset:1280
    v_accvgpr_write_b32 a120, 0
    v_accvgpr_write_b32 a121, 0
    v_mfma_f32_16x16x32_bf16 v[192:195], a[216:219], a[176:179], v[192:195]
    buffer_load_dwordx4 a[168:171], v249, s[8:11], s28 offen offset:2048 sc1
    v_accvgpr_write_b32 a122, 0
    v_mfma_f32_16x16x32_bf16 v[196:199], a[216:219], a[180:183], v[196:199]
    s_lshl2_add_u32 s80, s2, s3
    s_mul_i32 s80, s80, 12288
    s_add_u32 s80, s80, 0x1000000
    v_mov_b32 v0, -1
    v_mov_b32 v1, -1
    v_mov_b32 v2, -1
    v_mov_b32_e64 v3, -1
    v_mfma_f32_16x16x32_bf16 v[200:203], a[216:219], a[184:187], v[200:203]
    buffer_load_dwordx4 a[172:175], v249, s[8:11], s29 offen offset:2048 sc1
    v_accvgpr_write_b32 a123, 0
    v_accvgpr_write_b32 a124, 0
    v_mfma_f32_16x16x32_bf16 v[204:207], a[216:219], a[188:191], v[204:207]
    s_add_u32 m0, s31, 7168
    s_add_u32 s24, s27, 229376
    v_mfma_f32_16x16x32_bf16 v[208:211], a[220:223], a[176:179], v[208:211]
    buffer_load_dwordx4 v237, s[12:15], s24 offen lds
    v_accvgpr_write_b32 a125, 0
    v_accvgpr_write_b32 a126, 0
    v_mfma_f32_16x16x32_bf16 v[212:215], a[220:223], a[180:183], v[212:215]
    s_add_u32 s27, s27, 1048576
    s_and_b32 s27, s27, 0x407fffff
    v_mfma_f32_16x16x32_bf16 v[216:219], a[220:223], a[184:187], v[216:219]
    s_cmp_eq_u32 s27, s7
    s_cselect_b32 s27, s43, s27
    v_accvgpr_write_b32 a127, 0
    v_mfma_f32_16x16x32_bf16 v[220:223], a[220:223], a[188:191], v[220:223]
    s_add_u32 s31, s31, 32768
    s_cmp_ge_u32 s31, 163840
    s_cselect_b32 s24, 98304, 0
    s_sub_u32 s31, s31, s24
.p2align 3
ka_qp:
    s_waitcnt vmcnt(15) lgkmcnt(0)
    v_mfma_f32_16x16x32_bf16 v[96:99], a[192:195], a[128:131], v[96:99]
    ds_read_b64_tr_b16 a[208:209], v246 offset:512
    v_mfma_f32_16x16x32_bf16 v[100:103], a[192:195], a[132:135], v[100:103]
    ds_read_b64_tr_b16 a[210:211], v246 offset:1536
    v_mfma_f32_16x16x32_bf16 v[104:107], a[192:195], a[136:139], v[104:107]
    ds_read_b64_tr_b16 a[212:213], v238 offset:512
    v_mfma_f32_16x16x32_bf16 v[108:111], a[192:195], a[140:143], v[108:111]
    ds_read_b64_tr_b16 a[214:215], v238 offset:1536
    v_mfma_f32_16x16x32_bf16 v[112:115], a[196:199], a[128:131], v[112:115]
    ds_read_b64_tr_b16 a[216:217], v246 offset:768
    v_mfma_f32_16x16x32_bf16 v[116:119], a[196:199], a[132:135], v[116:119]
    ds_read_b64_tr_b16 a[218:219], v246 offset:1792
    v_mfma_f32_16x16x32_bf16 v[120:123], a[196:199], a[136:139], v[120:123]
    ds_read_b64_tr_b16 a[220:221], v238 offset:768
    v_mfma_f32_16x16x32_bf16 v[124:127], a[196:199], a[140:143], v[124:127]
    ds_read_b64_tr_b16 a[222:223], v238 offset:1792
    v_mfma_f32_16x16x32_bf16 v[128:131], a[200:203], a[128:131], v[128:131]
    buffer_load_dwordx4 a[176:179], v248, s[8:11], s28 offen offset:3072 sc1
    s_cmp_eq_u32 s26, 1
    s_cselect_b32 s41, s35, s43
    buffer_load_dword v254, off, s[88:91], s41 sc1
    v_mfma_f32_16x16x32_bf16 v[132:135], a[200:203], a[132:135], v[132:135]
    v_mfma_f32_16x16x32_bf16 v[136:139], a[200:203], a[136:139], v[136:139]
    buffer_load_dwordx4 a[180:183], v248, s[8:11], s29 offen offset:3072 sc1
    v_mfma_f32_16x16x32_bf16 v[140:143], a[200:203], a[140:143], v[140:143]
    s_add_u32 m0, s31, 0
    s_add_u32 s24, s27, 0
    v_mfma_f32_16x16x32_bf16 v[144:147], a[204:207], a[128:131], v[144:147]
    buffer_load_dwordx4 v245, s[12:15], s24 offen lds
    v_mfma_f32_16x16x32_bf16 v[148:151], a[204:207], a[132:135], v[148:151]
    v_mfma_f32_16x16x32_bf16 v[152:155], a[204:207], a[136:139], v[152:155]
    v_mfma_f32_16x16x32_bf16 v[156:159], a[204:207], a[140:143], v[156:159]
    s_waitcnt lgkmcnt(0)
    v_mfma_f32_16x16x32_bf16 v[160:163], a[208:211], a[128:131], v[160:163]
    ds_read_b64_tr_b16 a[192:193], v246 offset:8192
    v_mfma_f32_16x16x32_bf16 v[164:167], a[208:211], a[132:135], v[164:167]
    ds_read_b64_tr_b16 a[194:195], v246 offset:9216
    v_mfma_f32_16x16x32_bf16 v[168:171], a[208:211], a[136:139], v[168:171]
    ds_read_b64_tr_b16 a[196:197], v238 offset:8192
    v_mfma_f32_16x16x32_bf16 v[172:175], a[208:211], a[140:143], v[172:175]
    ds_read_b64_tr_b16 a[198:199], v238 offset:9216
    v_mfma_f32_16x16x32_bf16 v[176:179], a[212:215], a[128:131], v[176:179]
    ds_read_b64_tr_b16 a[200:201], v246 offset:8448
    v_mfma_f32_16x16x32_bf16 v[180:183], a[212:215], a[132:135], v[180:183]
    ds_read_b64_tr_b16 a[202:203], v246 offset:9472
    v_mfma_f32_16x16x32_bf16 v[184:187], a[212:215], a[136:139], v[184:187]
    ds_read_b64_tr_b16 a[204:205], v238 offset:8448
    v_mfma_f32_16x16x32_bf16 v[188:191], a[212:215], a[140:143], v[188:191]
    ds_read_b64_tr_b16 a[206:207], v238 offset:9472
    v_mfma_f32_16x16x32_bf16 v[192:195], a[216:219], a[128:131], v[192:195]
    buffer_load_dwordx4 a[184:187], v249, s[8:11], s28 offen offset:3072 sc1
    v_mfma_f32_16x16x32_bf16 v[196:199], a[216:219], a[132:135], v[196:199]
    v_mfma_f32_16x16x32_bf16 v[200:203], a[216:219], a[136:139], v[200:203]
    buffer_load_dwordx4 a[188:191], v249, s[8:11], s29 offen offset:3072 sc1
    v_mfma_f32_16x16x32_bf16 v[204:207], a[216:219], a[140:143], v[204:207]
    s_add_u32 m0, s31, 1024
    s_add_u32 s24, s27, 32768
    v_mfma_f32_16x16x32_bf16 v[208:211], a[220:223], a[128:131], v[208:211]
    buffer_load_dwordx4 v245, s[12:15], s24 offen lds
    v_mfma_f32_16x16x32_bf16 v[212:215], a[220:223], a[132:135], v[212:215]
    v_mfma_f32_16x16x32_bf16 v[216:219], a[220:223], a[136:139], v[216:219]
    s_add_u32 s28, s28, 4096
    s_and_b32 s28, s28, 32767
    v_mfma_f32_16x16x32_bf16 v[220:223], a[220:223], a[140:143], v[220:223]
    s_add_u32 s29, s28, 32768
    s_waitcnt vmcnt(16) lgkmcnt(0)
    v_mfma_f32_16x16x32_bf16 v[96:99], a[192:195], a[144:147], v[96:99]
    ds_read_b64_tr_b16 a[208:209], v246 offset:8704
    v_mfma_f32_16x16x32_bf16 v[100:103], a[192:195], a[148:151], v[100:103]
    ds_read_b64_tr_b16 a[210:211], v246 offset:9728
    v_mfma_f32_16x16x32_bf16 v[104:107], a[192:195], a[152:155], v[104:107]
    ds_read_b64_tr_b16 a[212:213], v238 offset:8704
    v_mfma_f32_16x16x32_bf16 v[108:111], a[192:195], a[156:159], v[108:111]
    ds_read_b64_tr_b16 a[214:215], v238 offset:9728
    v_mfma_f32_16x16x32_bf16 v[112:115], a[196:199], a[144:147], v[112:115]
    ds_read_b64_tr_b16 a[216:217], v246 offset:8960
    v_mfma_f32_16x16x32_bf16 v[116:119], a[196:199], a[148:151], v[116:119]
    ds_read_b64_tr_b16 a[218:219], v246 offset:9984
    v_mfma_f32_16x16x32_bf16 v[120:123], a[196:199], a[152:155], v[120:123]
    ds_read_b64_tr_b16 a[220:221], v238 offset:8960
    v_mfma_f32_16x16x32_bf16 v[124:127], a[196:199], a[156:159], v[124:127]
    ds_read_b64_tr_b16 a[222:223], v238 offset:9984
    v_mfma_f32_16x16x32_bf16 v[128:131], a[200:203], a[144:147], v[128:131]
    buffer_load_dwordx4 a[128:131], v248, s[8:11], s28 offen offset:0 sc1
    v_mfma_f32_16x16x32_bf16 v[132:135], a[200:203], a[148:151], v[132:135]
    v_mfma_f32_16x16x32_bf16 v[136:139], a[200:203], a[152:155], v[136:139]
    buffer_load_dwordx4 a[132:135], v248, s[8:11], s29 offen offset:0 sc1
    v_mfma_f32_16x16x32_bf16 v[140:143], a[200:203], a[156:159], v[140:143]
    s_add_u32 m0, s31, 2048
    s_add_u32 s24, s27, 65536
    v_mfma_f32_16x16x32_bf16 v[144:147], a[204:207], a[144:147], v[144:147]
    buffer_load_dwordx4 v237, s[12:15], s24 offen lds
    v_mfma_f32_16x16x32_bf16 v[148:151], a[204:207], a[148:151], v[148:151]
    buffer_store_dwordx4 v[0:3], v240, s[48:51], s80 offen sc1
    s_add_u32 s80, s80, 1024
    v_mfma_f32_16x16x32_bf16 v[152:155], a[204:207], a[152:155], v[152:155]
    v_mfma_f32_16x16x32_bf16 v[156:159], a[204:207], a[156:159], v[156:159]
    s_waitcnt lgkmcnt(0)
    v_mfma_f32_16x16x32_bf16 v[160:163], a[208:211], a[144:147], v[160:163]
    ds_read_b64_tr_b16 a[192:193], v246 offset:16384
    v_mfma_f32_16x16x32_bf16 v[164:167], a[208:211], a[148:151], v[164:167]
    ds_read_b64_tr_b16 a[194:195], v246 offset:17408
    v_mfma_f32_16x16x32_bf16 v[168:171], a[208:211], a[152:155], v[168:171]
    ds_read_b64_tr_b16 a[196:197], v238 offset:16384
    v_mfma_f32_16x16x32_bf16 v[172:175], a[208:211], a[156:159], v[172:175]
    ds_read_b64_tr_b16 a[198:199], v238 offset:17408
    v_mfma_f32_16x16x32_bf16 v[176:179], a[212:215], a[144:147], v[176:179]
    ds_read_b64_tr_b16 a[200:201], v246 offset:16640
    v_mfma_f32_16x16x32_bf16 v[180:183], a[212:215], a[148:151], v[180:183]
    ds_read_b64_tr_b16 a[202:203], v246 offset:17664
    v_mfma_f32_16x16x32_bf16 v[184:187], a[212:215], a[152:155], v[184:187]
    ds_read_b64_tr_b16 a[204:205], v238 offset:16640
    v_mfma_f32_16x16x32_bf16 v[188:191], a[212:215], a[156:159], v[188:191]
    ds_read_b64_tr_b16 a[206:207], v238 offset:17664
    v_mfma_f32_16x16x32_bf16 v[192:195], a[216:219], a[144:147], v[192:195]
    buffer_load_dwordx4 a[136:139], v249, s[8:11], s28 offen offset:0 sc1
    v_mfma_f32_16x16x32_bf16 v[196:199], a[216:219], a[148:151], v[196:199]
    v_mfma_f32_16x16x32_bf16 v[200:203], a[216:219], a[152:155], v[200:203]
    buffer_load_dwordx4 a[140:143], v249, s[8:11], s29 offen offset:0 sc1
    v_mfma_f32_16x16x32_bf16 v[204:207], a[216:219], a[156:159], v[204:207]
    s_add_u32 m0, s31, 3072
    s_add_u32 s24, s27, 98304
    v_mfma_f32_16x16x32_bf16 v[208:211], a[220:223], a[144:147], v[208:211]
    buffer_load_dwordx4 v237, s[12:15], s24 offen lds
    v_mfma_f32_16x16x32_bf16 v[212:215], a[220:223], a[148:151], v[212:215]
    v_mfma_f32_16x16x32_bf16 v[216:219], a[220:223], a[152:155], v[216:219]
    v_mfma_f32_16x16x32_bf16 v[220:223], a[220:223], a[156:159], v[220:223]
    s_waitcnt vmcnt(15) lgkmcnt(0)
    v_mfma_f32_16x16x32_bf16 v[96:99], a[192:195], a[160:163], v[96:99]
    ds_read_b64_tr_b16 a[208:209], v246 offset:16896
    v_mfma_f32_16x16x32_bf16 v[100:103], a[192:195], a[164:167], v[100:103]
    ds_read_b64_tr_b16 a[210:211], v246 offset:17920
    v_mfma_f32_16x16x32_bf16 v[104:107], a[192:195], a[168:171], v[104:107]
    ds_read_b64_tr_b16 a[212:213], v238 offset:16896
    v_mfma_f32_16x16x32_bf16 v[108:111], a[192:195], a[172:175], v[108:111]
    ds_read_b64_tr_b16 a[214:215], v238 offset:17920
    v_mfma_f32_16x16x32_bf16 v[112:115], a[196:199], a[160:163], v[112:115]
    ds_read_b64_tr_b16 a[216:217], v246 offset:17152
    v_mfma_f32_16x16x32_bf16 v[116:119], a[196:199], a[164:167], v[116:119]
    ds_read_b64_tr_b16 a[218:219], v246 offset:18176
    v_mfma_f32_16x16x32_bf16 v[120:123], a[196:199], a[168:171], v[120:123]
    ds_read_b64_tr_b16 a[220:221], v238 offset:17152
    v_mfma_f32_16x16x32_bf16 v[124:127], a[196:199], a[172:175], v[124:127]
    ds_read_b64_tr_b16 a[222:223], v238 offset:18176
    v_mfma_f32_16x16x32_bf16 v[128:131], a[200:203], a[160:163], v[128:131]
    buffer_load_dwordx4 a[144:147], v248, s[8:11], s28 offen offset:1024 sc1
    v_mfma_f32_16x16x32_bf16 v[132:135], a[200:203], a[164:167], v[132:135]
    v_mfma_f32_16x16x32_bf16 v[136:139], a[200:203], a[168:171], v[136:139]
    buffer_load_dwordx4 a[148:151], v248, s[8:11], s29 offen offset:1024 sc1
    v_mfma_f32_16x16x32_bf16 v[140:143], a[200:203], a[172:175], v[140:143]
    s_add_u32 m0, s31, 4096
    s_add_u32 s24, s27, 131072
    v_mfma_f32_16x16x32_bf16 v[144:147], a[204:207], a[160:163], v[144:147]
    buffer_load_dwordx4 v245, s[12:15], s24 offen lds
    v_mfma_f32_16x16x32_bf16 v[148:151], a[204:207], a[164:167], v[148:151]
    v_mfma_f32_16x16x32_bf16 v[152:155], a[204:207], a[168:171], v[152:155]
    v_mfma_f32_16x16x32_bf16 v[156:159], a[204:207], a[172:175], v[156:159]
    s_waitcnt lgkmcnt(0)
    v_mfma_f32_16x16x32_bf16 v[160:163], a[208:211], a[160:163], v[160:163]
    ds_read_b64_tr_b16 a[192:193], v246 offset:24576
    v_mfma_f32_16x16x32_bf16 v[164:167], a[208:211], a[164:167], v[164:167]
    ds_read_b64_tr_b16 a[194:195], v246 offset:25600
    v_mfma_f32_16x16x32_bf16 v[168:171], a[208:211], a[168:171], v[168:171]
    ds_read_b64_tr_b16 a[196:197], v238 offset:24576
    v_mfma_f32_16x16x32_bf16 v[172:175], a[208:211], a[172:175], v[172:175]
    ds_read_b64_tr_b16 a[198:199], v238 offset:25600
    v_mfma_f32_16x16x32_bf16 v[176:179], a[212:215], a[160:163], v[176:179]
    ds_read_b64_tr_b16 a[200:201], v246 offset:24832
    v_mfma_f32_16x16x32_bf16 v[180:183], a[212:215], a[164:167], v[180:183]
    ds_read_b64_tr_b16 a[202:203], v246 offset:25856
    v_mfma_f32_16x16x32_bf16 v[184:187], a[212:215], a[168:171], v[184:187]
    ds_read_b64_tr_b16 a[204:205], v238 offset:24832
    v_mfma_f32_16x16x32_bf16 v[188:191], a[212:215], a[172:175], v[188:191]
    ds_read_b64_tr_b16 a[206:207], v238 offset:25856
    v_mfma_f32_16x16x32_bf16 v[192:195], a[216:219], a[160:163], v[192:195]
    buffer_load_dwordx4 a[152:155], v249, s[8:11], s28 offen offset:1024 sc1
    v_mfma_f32_16x16x32_bf16 v[196:199], a[216:219], a[164:167], v[196:199]
    v_mfma_f32_16x16x32_bf16 v[200:203], a[216:219], a[168:171], v[200:203]
    buffer_load_dwordx4 a[156:159], v249, s[8:11], s29 offen offset:1024 sc1
    v_mfma_f32_16x16x32_bf16 v[204:207], a[216:219], a[172:175], v[204:207]
    s_add_u32 m0, s31, 5120
    s_add_u32 s24, s27, 163840
    v_mfma_f32_16x16x32_bf16 v[208:211], a[220:223], a[160:163], v[208:211]
    buffer_load_dwordx4 v245, s[12:15], s24 offen lds
    v_mfma_f32_16x16x32_bf16 v[212:215], a[220:223], a[164:167], v[212:215]
    buffer_store_dwordx4 v[0:3], v240, s[48:51], s80 offen sc1
    s_add_u32 s80, s80, 1024
    v_mfma_f32_16x16x32_bf16 v[216:219], a[220:223], a[168:171], v[216:219]
    s_add_u32 s30, s30, 32768
    v_mfma_f32_16x16x32_bf16 v[220:223], a[220:223], a[172:175], v[220:223]
    s_cmp_ge_u32 s30, 163840
    s_cselect_b32 s30, 65536, s30
    s_waitcnt vmcnt(15) lgkmcnt(0)
    v_mfma_f32_16x16x32_bf16 v[96:99], a[192:195], a[176:179], v[96:99]
    ds_read_b64_tr_b16 a[208:209], v246 offset:25088
    v_mfma_f32_16x16x32_bf16 v[100:103], a[192:195], a[180:183], v[100:103]
    ds_read_b64_tr_b16 a[210:211], v246 offset:26112
    v_mfma_f32_16x16x32_bf16 v[104:107], a[192:195], a[184:187], v[104:107]
    ds_read_b64_tr_b16 a[212:213], v238 offset:25088
    v_mfma_f32_16x16x32_bf16 v[108:111], a[192:195], a[188:191], v[108:111]
    ds_read_b64_tr_b16 a[214:215], v238 offset:26112
    v_mfma_f32_16x16x32_bf16 v[112:115], a[196:199], a[176:179], v[112:115]
    ds_read_b64_tr_b16 a[216:217], v246 offset:25344
    v_mfma_f32_16x16x32_bf16 v[116:119], a[196:199], a[180:183], v[116:119]
    ds_read_b64_tr_b16 a[218:219], v246 offset:26368
    v_mfma_f32_16x16x32_bf16 v[120:123], a[196:199], a[184:187], v[120:123]
    ds_read_b64_tr_b16 a[220:221], v238 offset:25344
    v_mfma_f32_16x16x32_bf16 v[124:127], a[196:199], a[188:191], v[124:127]
    ds_read_b64_tr_b16 a[222:223], v238 offset:26368
    v_mfma_f32_16x16x32_bf16 v[128:131], a[200:203], a[176:179], v[128:131]
    buffer_load_dwordx4 a[160:163], v248, s[8:11], s28 offen offset:2048 sc1
    v_mfma_f32_16x16x32_bf16 v[132:135], a[200:203], a[180:183], v[132:135]
    v_mfma_f32_16x16x32_bf16 v[136:139], a[200:203], a[184:187], v[136:139]
    buffer_load_dwordx4 a[164:167], v248, s[8:11], s29 offen offset:2048 sc1
    v_mfma_f32_16x16x32_bf16 v[140:143], a[200:203], a[188:191], v[140:143]
    s_add_u32 m0, s31, 6144
    s_add_u32 s24, s27, 196608
    v_mfma_f32_16x16x32_bf16 v[144:147], a[204:207], a[176:179], v[144:147]
    buffer_load_dwordx4 v237, s[12:15], s24 offen lds
    v_mfma_f32_16x16x32_bf16 v[148:151], a[204:207], a[180:183], v[148:151]
    v_mfma_f32_16x16x32_bf16 v[152:155], a[204:207], a[184:187], v[152:155]
    s_cmp_eq_u32 s26, 1
    s_cbranch_scc0 ka_nopk
    s_waitcnt vmcnt(22)
    v_readfirstlane_b32 s24, v254
    s_lshl_b32 s25, s3, 16
    s_add_u32 s24, s24, s25
    s_cmp_ge_u32 s24, 8
    s_cbranch_scc0 kf_spin39
kf_spinr40:
ka_nopk:
    v_mfma_f32_16x16x32_bf16 v[156:159], a[204:207], a[188:191], v[156:159]
    s_waitcnt vmcnt(24) lgkmcnt(0)
    s_barrier
    v_add_u32 v246, s30, v247
    v_mfma_f32_16x16x32_bf16 v[160:163], a[208:211], a[176:179], v[160:163]
    v_xor_b32_e64 v238, 16, v246
    ds_read_b64_tr_b16 a[192:193], v246 offset:0
    v_mfma_f32_16x16x32_bf16 v[164:167], a[208:211], a[180:183], v[164:167]
    ds_read_b64_tr_b16 a[194:195], v246 offset:1024
    v_mfma_f32_16x16x32_bf16 v[168:171], a[208:211], a[184:187], v[168:171]
    ds_read_b64_tr_b16 a[196:197], v238 offset:0
    v_mfma_f32_16x16x32_bf16 v[172:175], a[208:211], a[188:191], v[172:175]
    ds_read_b64_tr_b16 a[198:199], v238 offset:1024
    v_mfma_f32_16x16x32_bf16 v[176:179], a[212:215], a[176:179], v[176:179]
    ds_read_b64_tr_b16 a[200:201], v246 offset:256
    v_mfma_f32_16x16x32_bf16 v[180:183], a[212:215], a[180:183], v[180:183]
    ds_read_b64_tr_b16 a[202:203], v246 offset:1280
    v_mfma_f32_16x16x32_bf16 v[184:187], a[212:215], a[184:187], v[184:187]
    ds_read_b64_tr_b16 a[204:205], v238 offset:256
    buffer_atomic_add v255, v250, s[88:91], s97 offen sc1
    s_mov_b32 s97, s43
    v_mfma_f32_16x16x32_bf16 v[188:191], a[212:215], a[188:191], v[188:191]
    ds_read_b64_tr_b16 a[206:207], v238 offset:1280
    v_mfma_f32_16x16x32_bf16 v[192:195], a[216:219], a[176:179], v[192:195]
    buffer_load_dwordx4 a[168:171], v249, s[8:11], s28 offen offset:2048 sc1
    v_mfma_f32_16x16x32_bf16 v[196:199], a[216:219], a[180:183], v[196:199]
    v_mfma_f32_16x16x32_bf16 v[200:203], a[216:219], a[184:187], v[200:203]
    buffer_load_dwordx4 a[172:175], v249, s[8:11], s29 offen offset:2048 sc1
    v_mfma_f32_16x16x32_bf16 v[204:207], a[216:219], a[188:191], v[204:207]
    s_add_u32 m0, s31, 7168
    s_add_u32 s24, s27, 229376
    v_mfma_f32_16x16x32_bf16 v[208:211], a[220:223], a[176:179], v[208:211]
    buffer_load_dwordx4 v237, s[12:15], s24 offen lds
    v_mfma_f32_16x16x32_bf16 v[212:215], a[220:223], a[180:183], v[212:215]
    s_add_u32 s27, s27, 1048576
    s_and_b32 s27, s27, 0x407fffff
    v_mfma_f32_16x16x32_bf16 v[216:219], a[220:223], a[184:187], v[216:219]
    s_cmp_eq_u32 s27, s7
    s_cselect_b32 s27, s43, s27
    v_mfma_f32_16x16x32_bf16 v[220:223], a[220:223], a[188:191], v[220:223]
    s_add_u32 s31, s31, 32768
    s_cmp_ge_u32 s31, 163840
    s_cselect_b32 s24, 98304, 0
    s_sub_u32 s31, s31, s24
    s_sub_u32 s26, s26, 1
    s_cmp_lg_u32 s26, 0
    s_cbranch_scc1 ka_qp
    s_waitcnt vmcnt(15) lgkmcnt(0)
    v_mfma_f32_16x16x32_bf16 v[96:99], a[192:195], a[128:131], v[96:99]
    ds_read_b64_tr_b16 a[208:209], v246 offset:512
    s_sub_u32 s42, s32, 17664
    v_mfma_f32_16x16x32_bf16 v[100:103], a[192:195], a[132:135], v[100:103]
    ds_read_b64_tr_b16 a[210:211], v246 offset:1536
    v_mfma_f32_16x16x32_bf16 v[104:107], a[192:195], a[136:139], v[104:107]
    ds_read_b64_tr_b16 a[212:213], v238 offset:512
    s_mov_b32 m0, s34
    s_add_u32 s41, s42, 17664
    v_mfma_f32_16x16x32_bf16 v[108:111], a[192:195], a[140:143], v[108:111]
    ds_read_b64_tr_b16 a[214:215], v238 offset:1536
    v_mfma_f32_16x16x32_bf16 v[112:115], a[196:199], a[128:131], v[112:115]
    ds_read_b64_tr_b16 a[216:217], v246 offset:768
    v_mfma_f32_16x16x32_bf16 v[116:119], a[196:199], a[132:135], v[116:119]
    ds_read_b64_tr_b16 a[218:219], v246 offset:1792
    buffer_load_dwordx4 v242, s[16:19], s41 offen offset:0 sc1 lds
    v_mfma_f32_16x16x32_bf16 v[120:123], a[196:199], a[136:139], v[120:123]
    ds_read_b64_tr_b16 a[220:221], v238 offset:768
    v_mfma_f32_16x16x32_bf16 v[124:127], a[196:199], a[140:143], v[124:127]
    ds_read_b64_tr_b16 a[222:223], v238 offset:1792
    v_mfma_f32_16x16x32_bf16 v[128:131], a[200:203], a[128:131], v[128:131]
    buffer_load_dwordx4 a[176:179], v248, s[8:11], s28 offen offset:3072 sc1
    buffer_load_dwordx4 v242, s[16:19], s41 offen offset:1024 sc1 lds
    v_mfma_f32_16x16x32_bf16 v[132:135], a[200:203], a[132:135], v[132:135]
    v_mfma_f32_16x16x32_bf16 v[136:139], a[200:203], a[136:139], v[136:139]
    buffer_load_dwordx4 a[180:183], v248, s[8:11], s29 offen offset:3072 sc1
    v_mfma_f32_16x16x32_bf16 v[140:143], a[200:203], a[140:143], v[140:143]
    buffer_load_dwordx4 v242, s[16:19], s41 offen offset:2048 sc1 lds
    v_mfma_f32_16x16x32_bf16 v[144:147], a[204:207], a[128:131], v[144:147]
    v_mfma_f32_16x16x32_bf16 v[148:151], a[204:207], a[132:135], v[148:151]
    v_mfma_f32_16x16x32_bf16 v[152:155], a[204:207], a[136:139], v[152:155]
    buffer_load_dwordx4 v242, s[16:19], s41 offen offset:3072 sc1 lds
    v_mfma_f32_16x16x32_bf16 v[156:159], a[204:207], a[140:143], v[156:159]
    s_waitcnt lgkmcnt(0)
    v_mfma_f32_16x16x32_bf16 v[160:163], a[208:211], a[128:131], v[160:163]
    ds_read_b64_tr_b16 a[192:193], v246 offset:8192
    v_mfma_f32_16x16x32_bf16 v[164:167], a[208:211], a[132:135], v[164:167]
    ds_read_b64_tr_b16 a[194:195], v246 offset:9216
    v_mfma_f32_16x16x32_bf16 v[168:171], a[208:211], a[136:139], v[168:171]
    ds_read_b64_tr_b16 a[196:197], v238 offset:8192
    s_add_u32 s34, s34, 32768
    s_cmp_ge_u32 s34, 163840
    s_cselect_b32 s34, s37, s34
    s_add_u32 s42, s42, 34048
    v_mfma_f32_16x16x32_bf16 v[172:175], a[208:211], a[140:143], v[172:175]
    ds_read_b64_tr_b16 a[198:199], v238 offset:9216
    v_mfma_f32_16x16x32_bf16 v[176:179], a[212:215], a[128:131], v[176:179]
    ds_read_b64_tr_b16 a[200:201], v246 offset:8448
    v_mfma_f32_16x16x32_bf16 v[180:183], a[212:215], a[132:135], v[180:183]
    ds_read_b64_tr_b16 a[202:203], v246 offset:9472
    s_mov_b32 m0, s34
    s_add_u32 s41, s42, 17664
    v_mfma_f32_16x16x32_bf16 v[184:187], a[212:215], a[136:139], v[184:187]
    ds_read_b64_tr_b16 a[204:205], v238 offset:8448
    v_mfma_f32_16x16x32_bf16 v[188:191], a[212:215], a[140:143], v[188:191]
    ds_read_b64_tr_b16 a[206:207], v238 offset:9472
    v_mfma_f32_16x16x32_bf16 v[192:195], a[216:219], a[128:131], v[192:195]
    buffer_load_dwordx4 a[184:187], v249, s[8:11], s28 offen offset:3072 sc1
    buffer_load_dwordx4 v242, s[16:19], s41 offen offset:0 sc1 lds
    v_mfma_f32_16x16x32_bf16 v[196:199], a[216:219], a[132:135], v[196:199]
    v_mfma_f32_16x16x32_bf16 v[200:203], a[216:219], a[136:139], v[200:203]
    buffer_load_dwordx4 a[188:191], v249, s[8:11], s29 offen offset:3072 sc1
    v_mfma_f32_16x16x32_bf16 v[204:207], a[216:219], a[140:143], v[204:207]
    buffer_load_dwordx4 v242, s[16:19], s41 offen offset:1024 sc1 lds
    v_mfma_f32_16x16x32_bf16 v[208:211], a[220:223], a[128:131], v[208:211]
    v_mfma_f32_16x16x32_bf16 v[212:215], a[220:223], a[132:135], v[212:215]
    v_mfma_f32_16x16x32_bf16 v[216:219], a[220:223], a[136:139], v[216:219]
    s_add_u32 s28, s28, 4096
    s_and_b32 s28, s28, 32767
    v_mfma_f32_16x16x32_bf16 v[220:223], a[220:223], a[140:143], v[220:223]
    s_add_u32 s29, s28, 32768
    buffer_load_dwordx4 v242, s[16:19], s41 offen offset:2048 sc1 lds
    s_waitcnt vmcnt(20) lgkmcnt(0)
    v_mfma_f32_16x16x32_bf16 v[96:99], a[192:195], a[144:147], v[96:99]
    ds_read_b64_tr_b16 a[208:209], v246 offset:8704
    s_load_dwordx2 s[80:81], s[0:1], 0
    s_load_dwordx2 s[82:83], s[0:1], 56
    s_load_dwordx4 s[84:87], s[0:1], 80
    v_mfma_f32_16x16x32_bf16 v[100:103], a[192:195], a[148:151], v[100:103]
    ds_read_b64_tr_b16 a[210:211], v246 offset:9728
    v_mfma_f32_16x16x32_bf16 v[104:107], a[192:195], a[152:155], v[104:107]
    ds_read_b64_tr_b16 a[212:213], v238 offset:8704
    buffer_load_dwordx4 v242, s[16:19], s41 offen offset:3072 sc1 lds
    v_mfma_f32_16x16x32_bf16 v[108:111], a[192:195], a[156:159], v[108:111]
    ds_read_b64_tr_b16 a[214:215], v238 offset:9728
    v_mfma_f32_16x16x32_bf16 v[112:115], a[196:199], a[144:147], v[112:115]
    ds_read_b64_tr_b16 a[216:217], v246 offset:8960
    v_mfma_f32_16x16x32_bf16 v[116:119], a[196:199], a[148:151], v[116:119]
    ds_read_b64_tr_b16 a[218:219], v246 offset:9984
    s_add_u32 m0, s34, 16384
    s_add_u32 s34, s34, 32768
    s_cmp_ge_u32 s34, 163840
    s_cselect_b32 s34, s37, s34
    v_mfma_f32_16x16x32_bf16 v[120:123], a[196:199], a[152:155], v[120:123]
    ds_read_b64_tr_b16 a[220:221], v238 offset:8960
    v_mfma_f32_16x16x32_bf16 v[124:127], a[196:199], a[156:159], v[124:127]
    ds_read_b64_tr_b16 a[222:223], v238 offset:9984
    v_mfma_f32_16x16x32_bf16 v[128:131], a[200:203], a[144:147], v[128:131]
    buffer_load_dwordx4 v242, s[16:19], s42 offen offset:0 sc1 lds
    v_mov_b32_e64 v241, v240
    v_mfma_f32_16x16x32_bf16 v[132:135], a[200:203], a[148:151], v[132:135]
    v_lshrrev_b32_e64 v230, 7, v240
    v_mfma_f32_16x16x32_bf16 v[136:139], a[200:203], a[152:155], v[136:139]
    v_mul_u32_u24 v253, 7168, v230
    v_mfma_f32_16x16x32_bf16 v[140:143], a[200:203], a[156:159], v[140:143]
    v_and_b32 v231, 0x70, v240
    v_mfma_f32_16x16x32_bf16 v[144:147], a[204:207], a[144:147], v[144:147]
    buffer_load_dwordx4 v242, s[16:19], s42 offen offset:1024 sc1 lds
    v_mfma_f32_16x16x32_bf16 v[148:151], a[204:207], a[148:151], v[148:151]
    v_add_u32_e64 v253, v253, v231
    v_mfma_f32_16x16x32_bf16 v[152:155], a[204:207], a[152:155], v[152:155]
    v_lshlrev_b32_e64 v255, 5, v230
    v_mfma_f32_16x16x32_bf16 v[156:159], a[204:207], a[156:159], v[156:159]
    buffer_load_dwordx4 v242, s[16:19], s42 offen offset:2048 sc1 lds
    s_waitcnt lgkmcnt(0)
    v_mfma_f32_16x16x32_bf16 v[160:163], a[208:211], a[144:147], v[160:163]
    ds_read_b64_tr_b16 a[192:193], v246 offset:16384
    v_and_b32 v230, 16, v240
    v_mfma_f32_16x16x32_bf16 v[164:167], a[208:211], a[148:151], v[164:167]
    ds_read_b64_tr_b16 a[194:195], v246 offset:17408
    v_mfma_f32_16x16x32_bf16 v[168:171], a[208:211], a[152:155], v[168:171]
    ds_read_b64_tr_b16 a[196:197], v238 offset:16384
    buffer_load_dwordx4 v242, s[16:19], s42 offen offset:3072 sc1 lds
    s_add_u32 s42, s42, 34048
    v_mfma_f32_16x16x32_bf16 v[172:175], a[208:211], a[156:159], v[172:175]
    ds_read_b64_tr_b16 a[198:199], v238 offset:17408
    v_add_u32_e64 v255, v255, v230
    v_mfma_f32_16x16x32_bf16 v[176:179], a[212:215], a[144:147], v[176:179]
    ds_read_b64_tr_b16 a[200:201], v246 offset:16640
    v_mfma_f32_16x16x32_bf16 v[180:183], a[212:215], a[148:151], v[180:183]
    ds_read_b64_tr_b16 a[202:203], v246 offset:17664
    s_mov_b32 m0, s34
    s_add_u32 s41, s42, 17664
    v_mfma_f32_16x16x32_bf16 v[184:187], a[212:215], a[152:155], v[184:187]
    ds_read_b64_tr_b16 a[204:205], v238 offset:16640
    v_lshrrev_b32 v231, 5, v231
    v_mfma_f32_16x16x32_bf16 v[188:191], a[212:215], a[156:159], v[188:191]
    ds_read_b64_tr_b16 a[206:207], v238 offset:17664
    v_mfma_f32_16x16x32_bf16 v[192:195], a[216:219], a[144:147], v[192:195]
    buffer_load_dwordx4 v242, s[16:19], s41 offen offset:0 sc1 lds
    v_lshl_add_u32 v255, v231, 16, v255
    v_mfma_f32_16x16x32_bf16 v[196:199], a[216:219], a[148:151], v[196:199]
    v_mov_b32_e64 v64, 0
    v_mfma_f32_16x16x32_bf16 v[200:203], a[216:219], a[152:155], v[200:203]
    v_mov_b32_e64 v65, 0
    v_mfma_f32_16x16x32_bf16 v[204:207], a[216:219], a[156:159], v[204:207]
    v_mov_b32_e64 v66, 0
    v_mfma_f32_16x16x32_bf16 v[208:211], a[220:223], a[144:147], v[208:211]
    buffer_load_dwordx4 v242, s[16:19], s41 offen offset:1024 sc1 lds
    v_mfma_f32_16x16x32_bf16 v[212:215], a[220:223], a[148:151], v[212:215]
    v_mov_b32_e64 v67, 0
    v_mfma_f32_16x16x32_bf16 v[216:219], a[220:223], a[152:155], v[216:219]
    v_mov_b32_e64 v68, 0
    v_mfma_f32_16x16x32_bf16 v[220:223], a[220:223], a[156:159], v[220:223]
    buffer_load_dwordx4 v242, s[16:19], s41 offen offset:2048 sc1 lds
    s_waitcnt vmcnt(20) lgkmcnt(0)
    v_mfma_f32_16x16x32_bf16 v[96:99], a[192:195], a[160:163], v[96:99]
    ds_read_b64_tr_b16 a[208:209], v246 offset:16896
    v_mov_b32 v69, 0
    v_mfma_f32_16x16x32_bf16 v[100:103], a[192:195], a[164:167], v[100:103]
    ds_read_b64_tr_b16 a[210:211], v246 offset:17920
    v_mfma_f32_16x16x32_bf16 v[104:107], a[192:195], a[168:171], v[104:107]
    ds_read_b64_tr_b16 a[212:213], v238 offset:16896
    buffer_load_dwordx4 v242, s[16:19], s41 offen offset:3072 sc1 lds
    v_mfma_f32_16x16x32_bf16 v[108:111], a[192:195], a[172:175], v[108:111]
    ds_read_b64_tr_b16 a[214:215], v238 offset:17920
    v_mov_b32_e64 v70, 0
    v_mfma_f32_16x16x32_bf16 v[112:115], a[196:199], a[160:163], v[112:115]
    ds_read_b64_tr_b16 a[216:217], v246 offset:17152
    v_mfma_f32_16x16x32_bf16 v[116:119], a[196:199], a[164:167], v[116:119]
    ds_read_b64_tr_b16 a[218:219], v246 offset:18176
    s_add_u32 m0, s34, 16384
    s_add_u32 s34, s34, 32768
    s_cmp_ge_u32 s34, 163840
    s_cselect_b32 s34, s37, s34
    v_mfma_f32_16x16x32_bf16 v[120:123], a[196:199], a[168:171], v[120:123]
    ds_read_b64_tr_b16 a[220:221], v238 offset:17152
    v_mov_b32 v71, 0
    v_mfma_f32_16x16x32_bf16 v[124:127], a[196:199], a[172:175], v[124:127]
    ds_read_b64_tr_b16 a[222:223], v238 offset:18176
    v_mfma_f32_16x16x32_bf16 v[128:131], a[200:203], a[160:163], v[128:131]
    v_mov_b32_e64 v72, 0
    v_mfma_f32_16x16x32_bf16 v[132:135], a[200:203], a[164:167], v[132:135]
    buffer_load_dwordx4 v242, s[16:19], s42 offen offset:0 sc1 lds
    v_mov_b32_e64 v73, 0
    v_mfma_f32_16x16x32_bf16 v[136:139], a[200:203], a[168:171], v[136:139]
    v_mov_b32_e64 v74, 0
    v_mfma_f32_16x16x32_bf16 v[140:143], a[200:203], a[172:175], v[140:143]
    v_mov_b32_e64 v75, 0
    v_mfma_f32_16x16x32_bf16 v[144:147], a[204:207], a[160:163], v[144:147]
    buffer_load_dwordx4 v242, s[16:19], s42 offen offset:1024 sc1 lds
    v_mfma_f32_16x16x32_bf16 v[148:151], a[204:207], a[164:167], v[148:151]
    v_mov_b32_e64 v76, 0
    v_mfma_f32_16x16x32_bf16 v[152:155], a[204:207], a[168:171], v[152:155]
    v_mov_b32_e64 v77, 0
    v_mfma_f32_16x16x32_bf16 v[156:159], a[204:207], a[172:175], v[156:159]
    buffer_load_dwordx4 v242, s[16:19], s42 offen offset:2048 sc1 lds
    s_waitcnt lgkmcnt(0)
    v_mfma_f32_16x16x32_bf16 v[160:163], a[208:211], a[160:163], v[160:163]
    ds_read_b64_tr_b16 a[192:193], v246 offset:24576
    v_mov_b32 v78, 0
    v_mfma_f32_16x16x32_bf16 v[164:167], a[208:211], a[164:167], v[164:167]
    ds_read_b64_tr_b16 a[194:195], v246 offset:25600
    v_mfma_f32_16x16x32_bf16 v[168:171], a[208:211], a[168:171], v[168:171]
    ds_read_b64_tr_b16 a[196:197], v238 offset:24576
    buffer_load_dwordx4 v242, s[16:19], s42 offen offset:3072 sc1 lds
    s_add_u32 s42, s42, 34048
    v_mfma_f32_16x16x32_bf16 v[172:175], a[208:211], a[172:175], v[172:175]
    ds_read_b64_tr_b16 a[198:199], v238 offset:25600
    v_mov_b32_e64 v79, 0
    v_mfma_f32_16x16x32_bf16 v[176:179], a[212:215], a[160:163], v[176:179]
    ds_read_b64_tr_b16 a[200:201], v246 offset:24832
    v_mfma_f32_16x16x32_bf16 v[180:183], a[212:215], a[164:167], v[180:183]
    ds_read_b64_tr_b16 a[202:203], v246 offset:25856
    v_mov_b32_e64 v80, 0
    v_mfma_f32_16x16x32_bf16 v[184:187], a[212:215], a[168:171], v[184:187]
    ds_read_b64_tr_b16 a[204:205], v238 offset:24832
    v_mfma_f32_16x16x32_bf16 v[188:191], a[212:215], a[172:175], v[188:191]
    ds_read_b64_tr_b16 a[206:207], v238 offset:25856
    v_mov_b32_e64 v81, 0
    v_mfma_f32_16x16x32_bf16 v[192:195], a[216:219], a[160:163], v[192:195]
    v_mov_b32_e64 v82, 0
    v_mfma_f32_16x16x32_bf16 v[196:199], a[216:219], a[164:167], v[196:199]
    v_mov_b32_e64 v83, 0
    v_mfma_f32_16x16x32_bf16 v[200:203], a[216:219], a[168:171], v[200:203]
    v_mov_b32_e64 v84, 0
    v_mfma_f32_16x16x32_bf16 v[204:207], a[216:219], a[172:175], v[204:207]
    v_mov_b32_e64 v85, 0
    v_mfma_f32_16x16x32_bf16 v[208:211], a[220:223], a[160:163], v[208:211]
    v_mov_b32_e64 v86, 0
    v_mfma_f32_16x16x32_bf16 v[212:215], a[220:223], a[164:167], v[212:215]
    v_mov_b32_e64 v87, 0
    v_mfma_f32_16x16x32_bf16 v[216:219], a[220:223], a[168:171], v[216:219]
    v_mov_b32_e64 v88, 0
    v_mfma_f32_16x16x32_bf16 v[220:223], a[220:223], a[172:175], v[220:223]
    s_waitcnt vmcnt(15) lgkmcnt(0)
    v_mfma_f32_16x16x32_bf16 v[96:99], a[192:195], a[176:179], v[96:99]
    ds_read_b64_tr_b16 a[208:209], v246 offset:25088
    v_mov_b32 v89, 0
    v_mfma_f32_16x16x32_bf16 v[100:103], a[192:195], a[180:183], v[100:103]
    ds_read_b64_tr_b16 a[210:211], v246 offset:26112
    v_mfma_f32_16x16x32_bf16 v[104:107], a[192:195], a[184:187], v[104:107]
    ds_read_b64_tr_b16 a[212:213], v238 offset:25088
    v_mov_b32_e64 v90, 0
    v_mfma_f32_16x16x32_bf16 v[108:111], a[192:195], a[188:191], v[108:111]
    ds_read_b64_tr_b16 a[214:215], v238 offset:26112
    v_mfma_f32_16x16x32_bf16 v[112:115], a[196:199], a[176:179], v[112:115]
    ds_read_b64_tr_b16 a[216:217], v246 offset:25344
    v_mov_b32_e64 v91, 0
    v_mfma_f32_16x16x32_bf16 v[116:119], a[196:199], a[180:183], v[116:119]
    ds_read_b64_tr_b16 a[218:219], v246 offset:26368
    v_mfma_f32_16x16x32_bf16 v[120:123], a[196:199], a[184:187], v[120:123]
    ds_read_b64_tr_b16 a[220:221], v238 offset:25344
    v_mov_b32_e64 v92, 0
    v_mfma_f32_16x16x32_bf16 v[124:127], a[196:199], a[188:191], v[124:127]
    ds_read_b64_tr_b16 a[222:223], v238 offset:26368
    v_mfma_f32_16x16x32_bf16 v[128:131], a[200:203], a[176:179], v[128:131]
    v_mov_b32_e64 v93, 0
    v_mfma_f32_16x16x32_bf16 v[132:135], a[200:203], a[180:183], v[132:135]
    v_mov_b32_e64 v94, 0
    v_mfma_f32_16x16x32_bf16 v[136:139], a[200:203], a[184:187], v[136:139]
    v_mov_b32_e64 v95, 0
    v_mfma_f32_16x16x32_bf16 v[140:143], a[200:203], a[188:191], v[140:143]
    v_mov_b32_e64 v224, 0
    v_mfma_f32_16x16x32_bf16 v[144:147], a[204:207], a[176:179], v[144:147]
    v_mov_b32_e64 v225, 0
    v_mfma_f32_16x16x32_bf16 v[148:151], a[204:207], a[180:183], v[148:151]
    v_mov_b32_e64 v226, 0
    v_mfma_f32_16x16x32_bf16 v[152:155], a[204:207], a[184:187], v[152:155]
    v_mov_b32_e64 v227, 0
    v_mfma_f32_16x16x32_bf16 v[156:159], a[204:207], a[188:191], v[156:159]
    s_waitcnt vmcnt(8) lgkmcnt(0)
    s_barrier
    v_mfma_f32_16x16x32_bf16 v[160:163], a[208:211], a[176:179], v[160:163]
    ds_read_b128 a[192:195], v241 offset:0
    s_mov_b32 m0, s34
    s_add_u32 s41, s42, 17664
    v_mfma_f32_16x16x32_bf16 v[164:167], a[208:211], a[180:183], v[164:167]
    ds_read_b128 a[196:199], v241 offset:2048
    buffer_load_dwordx4 v242, s[16:19], s41 offen offset:0 sc1 lds
    v_mfma_f32_16x16x32_bf16 v[168:171], a[208:211], a[184:187], v[168:171]
    ds_read_b128 a[200:203], v241 offset:4096
    v_mfma_f32_16x16x32_bf16 v[172:175], a[208:211], a[188:191], v[172:175]
    ds_read_b128 a[204:207], v241 offset:6144
    buffer_load_dwordx4 v242, s[16:19], s41 offen offset:1024 sc1 lds
    v_mfma_f32_16x16x32_bf16 v[176:179], a[212:215], a[176:179], v[176:179]
    ds_read_b128 a[224:227], v241 offset:8192
    buffer_load_dwordx4 v242, s[16:19], s41 offen offset:2048 sc1 lds
    v_mfma_f32_16x16x32_bf16 v[180:183], a[212:215], a[180:183], v[180:183]
    ds_read_b128 a[228:231], v241 offset:10240
    v_mfma_f32_16x16x32_bf16 v[184:187], a[212:215], a[184:187], v[184:187]
    ds_read_b128 a[232:235], v241 offset:12288
    buffer_load_dwordx4 v242, s[16:19], s41 offen offset:3072 sc1 lds
    v_mfma_f32_16x16x32_bf16 v[188:191], a[212:215], a[188:191], v[188:191]
    ds_read_b128 a[236:239], v241 offset:14336
    v_mfma_f32_16x16x32_bf16 v[192:195], a[216:219], a[176:179], v[192:195]
    ds_read_b128 a[240:243], v241 offset:9216
    s_add_u32 m0, s34, 16384
    s_add_u32 s34, s34, 32768
    s_cmp_ge_u32 s34, 163840
    s_cselect_b32 s34, s37, s34
    v_mfma_f32_16x16x32_bf16 v[196:199], a[216:219], a[180:183], v[196:199]
    ds_read_b128 a[244:247], v241 offset:11264
    buffer_load_dwordx4 v242, s[16:19], s42 offen offset:0 sc1 lds
    v_mfma_f32_16x16x32_bf16 v[200:203], a[216:219], a[184:187], v[200:203]
    ds_read_b128 a[248:251], v241 offset:13312
    v_mfma_f32_16x16x32_bf16 v[204:207], a[216:219], a[188:191], v[204:207]
    ds_read_b128 a[252:255], v241 offset:15360
    buffer_load_dwordx4 v242, s[16:19], s42 offen offset:1024 sc1 lds
    v_mfma_f32_16x16x32_bf16 v[208:211], a[220:223], a[176:179], v[208:211]
    buffer_load_dwordx4 v242, s[16:19], s42 offen offset:2048 sc1 lds
    v_mfma_f32_16x16x32_bf16 v[212:215], a[220:223], a[180:183], v[212:215]
    v_mfma_f32_16x16x32_bf16 v[216:219], a[220:223], a[184:187], v[216:219]
    buffer_load_dwordx4 v242, s[16:19], s42 offen offset:3072 sc1 lds
    s_add_u32 s42, s42, 34048
    v_mfma_f32_16x16x32_bf16 v[220:223], a[220:223], a[188:191], v[220:223]
    s_waitcnt lgkmcnt(8)
    ds_read_b128 a[208:211], v241 offset:1024
    ds_read_b128 a[212:215], v241 offset:3072
    ds_read_b128 a[216:219], v241 offset:5120
    ds_read_b128 a[220:223], v241 offset:7168
    s_sub_u32 s36, s36, 1
    s_cbranch_scc1 kf_fix1
kf_fixr2:
    v_cvt_pk_bf16_f32 v96, v96, v97
    v_cvt_pk_bf16_f32 v97, v98, v99
    v_cvt_pk_bf16_f32 v98, v112, v113
    v_cvt_pk_bf16_f32 v99, v114, v115
    v_accvgpr_write_b32 a128, v96
    v_accvgpr_write_b32 a129, v97
    v_accvgpr_write_b32 a130, v98
    v_accvgpr_write_b32 a131, v99
    v_cvt_pk_bf16_f32 v100, v100, v101
    v_cvt_pk_bf16_f32 v101, v102, v103
    v_cvt_pk_bf16_f32 v102, v116, v117
    v_cvt_pk_bf16_f32 v103, v118, v119
    v_accvgpr_write_b32 a144, v100
    v_accvgpr_write_b32 a145, v101
    v_accvgpr_write_b32 a146, v102
    v_accvgpr_write_b32 a147, v103
    v_cvt_pk_bf16_f32 v104, v104, v105
    v_cvt_pk_bf16_f32 v105, v106, v107
    v_cvt_pk_bf16_f32 v106, v120, v121
    v_cvt_pk_bf16_f32 v107, v122, v123
    v_accvgpr_write_b32 a160, v104
    v_accvgpr_write_b32 a161, v105
    v_accvgpr_write_b32 a162, v106
    v_accvgpr_write_b32 a163, v107
    v_cvt_pk_bf16_f32 v108, v108, v109
    v_cvt_pk_bf16_f32 v109, v110, v111
    v_cvt_pk_bf16_f32 v110, v124, v125
    v_cvt_pk_bf16_f32 v111, v126, v127
    v_accvgpr_write_b32 a176, v108
    v_accvgpr_write_b32 a177, v109
    v_accvgpr_write_b32 a178, v110
    v_accvgpr_write_b32 a179, v111
    s_nop 1
    s_waitcnt lgkmcnt(0)
    v_mfma_f32_16x16x32_bf16 v[0:3], a[192:195], a[128:131], v[64:67]
    v_cvt_pk_bf16_f32 v128, v128, v129
    v_cvt_pk_bf16_f32 v129, v130, v131
    v_cvt_pk_bf16_f32 v130, v144, v145
    v_cvt_pk_bf16_f32 v131, v146, v147
    v_mfma_f32_16x16x32_bf16 v[8:11], a[192:195], a[144:147], v[72:75]
    v_accvgpr_write_b32 a132, v128
    v_accvgpr_write_b32 a133, v129
    v_accvgpr_write_b32 a134, v130
    v_accvgpr_write_b32 a135, v131
    v_mfma_f32_16x16x32_bf16 v[16:19], a[192:195], a[160:163], v[80:83]
    v_cvt_pk_bf16_f32 v132, v132, v133
    v_cvt_pk_bf16_f32 v133, v134, v135
    v_cvt_pk_bf16_f32 v134, v148, v149
    v_cvt_pk_bf16_f32 v135, v150, v151
    v_mfma_f32_16x16x32_bf16 v[24:27], a[192:195], a[176:179], v[88:91]
    v_accvgpr_write_b32 a148, v132
    v_accvgpr_write_b32 a149, v133
    v_accvgpr_write_b32 a150, v134
    v_accvgpr_write_b32 a151, v135
    v_mfma_f32_16x16x32_bf16 v[4:7], a[208:211], a[128:131], v[68:71]
    v_cvt_pk_bf16_f32 v136, v136, v137
    v_cvt_pk_bf16_f32 v137, v138, v139
    v_cvt_pk_bf16_f32 v138, v152, v153
    v_cvt_pk_bf16_f32 v139, v154, v155
    v_mfma_f32_16x16x32_bf16 v[12:15], a[208:211], a[144:147], v[76:79]
    v_accvgpr_write_b32 a164, v136
    v_accvgpr_write_b32 a165, v137
    v_accvgpr_write_b32 a166, v138
    v_accvgpr_write_b32 a167, v139
    v_mfma_f32_16x16x32_bf16 v[20:23], a[208:211], a[160:163], v[84:87]
    v_cvt_pk_bf16_f32 v140, v140, v141
    v_cvt_pk_bf16_f32 v141, v142, v143
    v_cvt_pk_bf16_f32 v142, v156, v157
    v_cvt_pk_bf16_f32 v143, v158, v159
    v_mfma_f32_16x16x32_bf16 v[28:31], a[208:211], a[176:179], v[92:95]
    v_accvgpr_write_b32 a180, v140
    v_accvgpr_write_b32 a181, v141
    v_accvgpr_write_b32 a182, v142
    v_accvgpr_write_b32 a183, v143
    s_nop 1
    v_mfma_f32_16x16x32_bf16 v[0:3], a[196:199], a[132:135], v[0:3]
    v_cvt_pk_bf16_f32 v160, v160, v161
    v_cvt_pk_bf16_f32 v161, v162, v163
    v_cvt_pk_bf16_f32 v162, v176, v177
    v_cvt_pk_bf16_f32 v163, v178, v179
    v_mfma_f32_16x16x32_bf16 v[8:11], a[196:199], a[148:151], v[8:11]
    v_accvgpr_write_b32 a136, v160
    v_accvgpr_write_b32 a137, v161
    v_accvgpr_write_b32 a138, v162
    v_accvgpr_write_b32 a139, v163
    v_mfma_f32_16x16x32_bf16 v[16:19], a[196:199], a[164:167], v[16:19]
    v_cvt_pk_bf16_f32 v164, v164, v165
    v_cvt_pk_bf16_f32 v165, v166, v167
    v_cvt_pk_bf16_f32 v166, v180, v181
    v_cvt_pk_bf16_f32 v167, v182, v183
    v_mfma_f32_16x16x32_bf16 v[24:27], a[196:199], a[180:183], v[24:27]
    v_accvgpr_write_b32 a152, v164
    v_accvgpr_write_b32 a153, v165
    v_accvgpr_write_b32 a154, v166
    v_accvgpr_write_b32 a155, v167
    v_mfma_f32_16x16x32_bf16 v[4:7], a[212:215], a[132:135], v[4:7]
    v_cvt_pk_bf16_f32 v168, v168, v169
    v_cvt_pk_bf16_f32 v169, v170, v171
    v_cvt_pk_bf16_f32 v170, v184, v185
    v_cvt_pk_bf16_f32 v171, v186, v187
    v_mfma_f32_16x16x32_bf16 v[12:15], a[212:215], a[148:151], v[12:15]
    v_accvgpr_write_b32 a168, v168
    v_accvgpr_write_b32 a169, v169
    v_accvgpr_write_b32 a170, v170
    v_accvgpr_write_b32 a171, v171
    v_mfma_f32_16x16x32_bf16 v[20:23], a[212:215], a[164:167], v[20:23]
    v_cvt_pk_bf16_f32 v172, v172, v173
    v_cvt_pk_bf16_f32 v173, v174, v175
    v_cvt_pk_bf16_f32 v174, v188, v189
    v_cvt_pk_bf16_f32 v175, v190, v191
    v_mfma_f32_16x16x32_bf16 v[28:31], a[212:215], a[180:183], v[28:31]
    v_accvgpr_write_b32 a184, v172
    v_accvgpr_write_b32 a185, v173
    v_accvgpr_write_b32 a186, v174
    v_accvgpr_write_b32 a187, v175
    s_nop 1
    s_waitcnt lgkmcnt(0)
    v_mfma_f32_16x16x32_bf16 v[0:3], a[200:203], a[136:139], v[0:3]
    v_cvt_pk_bf16_f32 v192, v192, v193
    v_cvt_pk_bf16_f32 v193, v194, v195
    v_cvt_pk_bf16_f32 v194, v208, v209
    v_cvt_pk_bf16_f32 v195, v210, v211
    v_mfma_f32_16x16x32_bf16 v[8:11], a[200:203], a[152:155], v[8:11]
    v_accvgpr_write_b32 a140, v192
    v_accvgpr_write_b32 a141, v193
    v_accvgpr_write_b32 a142, v194
    v_accvgpr_write_b32 a143, v195
    v_mfma_f32_16x16x32_bf16 v[16:19], a[200:203], a[168:171], v[16:19]
    v_cvt_pk_bf16_f32 v196, v196, v197
    v_cvt_pk_bf16_f32 v197, v198, v199
    v_cvt_pk_bf16_f32 v198, v212, v213
    v_cvt_pk_bf16_f32 v199, v214, v215
    v_mfma_f32_16x16x32_bf16 v[24:27], a[200:203], a[184:187], v[24:27]
    v_accvgpr_write_b32 a156, v196
    v_accvgpr_write_b32 a157, v197
    v_accvgpr_write_b32 a158, v198
    v_accvgpr_write_b32 a159, v199
    v_mfma_f32_16x16x32_bf16 v[4:7], a[216:219], a[136:139], v[4:7]
    v_cvt_pk_bf16_f32 v200, v200, v201
    v_cvt_pk_bf16_f32 v201, v202, v203
    v_cvt_pk_bf16_f32 v202, v216, v217
    v_cvt_pk_bf16_f32 v203, v218, v219
    v_mfma_f32_16x16x32_bf16 v[12:15], a[216:219], a[152:155], v[12:15]
    v_accvgpr_write_b32 a172, v200
    v_accvgpr_write_b32 a173, v201
    v_accvgpr_write_b32 a174, v202
    v_accvgpr_write_b32 a175, v203
    v_mfma_f32_16x16x32_bf16 v[20:23], a[216:219], a[168:171], v[20:23]
    v_cvt_pk_bf16_f32 v204, v204, v205
    v_cvt_pk_bf16_f32 v205, v206, v207
    v_cvt_pk_bf16_f32 v206, v220, v221
    v_cvt_pk_bf16_f32 v207, v222, v223
    v_mfma_f32_16x16x32_bf16 v[28:31], a[216:219], a[184:187], v[28:31]
    v_accvgpr_write_b32 a188, v204
    v_accvgpr_write_b32 a189, v205
    v_accvgpr_write_b32 a190, v206
    v_accvgpr_write_b32 a191, v207
    s_nop 1
    v_mfma_f32_16x16x32_bf16 v[0:3], a[204:207], a[140:143], v[0:3]
    v_mov_b32 v144, 0
    v_mov_b32 v145, 0
    v_mov_b32 v146, 0
    v_mfma_f32_16x16x32_bf16 v[8:11], a[204:207], a[156:159], v[8:11]
    v_mov_b32 v147, 0
    v_mov_b32 v148, 0
    v_mfma_f32_16x16x32_bf16 v[16:19], a[204:207], a[172:175], v[16:19]
    v_mov_b32 v149, 0
    v_mov_b32 v150, 0
    v_mov_b32_e64 v151, 0
    v_mfma_f32_16x16x32_bf16 v[24:27], a[204:207], a[188:191], v[24:27]
    v_mov_b32 v152, 0
    v_mov_b32 v153, 0
    v_mfma_f32_16x16x32_bf16 v[4:7], a[220:223], a[140:143], v[4:7]
    v_mov_b32 v154, 0
    v_mov_b32 v155, 0
    v_mov_b32_e64 v156, 0
    v_mfma_f32_16x16x32_bf16 v[12:15], a[220:223], a[156:159], v[12:15]
    v_mov_b32 v157, 0
    v_mov_b32 v158, 0
    v_mfma_f32_16x16x32_bf16 v[20:23], a[220:223], a[172:175], v[20:23]
    v_mov_b32_e64 v159, 0
    v_mov_b32 v204, 0x3f803f80
    v_mov_b32 v205, 0x3f803f80
    v_mfma_f32_16x16x32_bf16 v[28:31], a[220:223], a[188:191], v[28:31]
    v_mov_b32 v206, 0x3f803f80
    v_mov_b32 v207, 0x3f803f80
    s_nop 4
    v_max3_f32 v128, v0, v1, v2
    v_max3_f32 v130, v8, v9, v10
    v_max3_f32 v132, v16, v17, v18
    v_max3_f32 v134, v24, v25, v26
    v_max3_f32 v128, v128, v3, v4
    v_max3_f32 v130, v130, v11, v12
    v_max3_f32 v132, v132, v19, v20
    v_max3_f32 v134, v134, v27, v28
    v_max3_f32 v128, v128, v5, v6
    v_max3_f32 v130, v130, v13, v14
    v_max3_f32 v132, v132, v21, v22
    v_max3_f32 v134, v134, v29, v30
    v_max_f32 v128, v128, v7
    v_max_f32 v130, v130, v15
    v_max_f32 v132, v132, v23
    v_max_f32 v134, v134, v31
    v_mov_b32 v129, v128
    v_mov_b32 v131, v130
    v_mov_b32 v133, v132
    v_mov_b32 v135, v134
    v_permlane16_swap_b32 v128, v129
    v_permlane16_swap_b32 v130, v131
    v_permlane16_swap_b32 v132, v133
    v_permlane16_swap_b32 v134, v135
    v_max_f32 v128, v128, v129
    v_max_f32 v130, v130, v131
    v_max_f32 v132, v132, v133
    v_max_f32 v134, v134, v135
    v_mov_b32 v129, v128
    v_mov_b32 v131, v130
    v_mov_b32 v133, v132
    v_mov_b32 v135, v134
    v_permlane32_swap_b32 v128, v129
    v_permlane32_swap_b32 v130, v131
    v_permlane32_swap_b32 v132, v133
    v_permlane32_swap_b32 v134, v135
    v_max_f32 v128, v128, v129
    v_max_f32 v130, v130, v131
    v_max_f32 v132, v132, v133
    v_max_f32_e64 v134, v134, v135
    v_add_f32 v128, 0x41800000, v128
    v_add_f32 v130, 0x41800000, v130
    v_add_f32 v132, 0x41800000, v132
    v_add_f32 v134, 0x41800000, v134
    v_sub_f32 v224, 0, v128
    v_sub_f32 v64, v64, v128
    v_sub_f32 v65, v65, v128
    v_sub_f32 v66, v66, v128
    v_sub_f32 v67, v67, v128
    v_sub_f32 v68, v68, v128
    v_sub_f32 v69, v69, v128
    v_sub_f32 v70, v70, v128
    v_sub_f32 v71, v71, v128
    v_sub_f32 v225, 0, v130
    v_sub_f32 v72, v72, v130
    v_sub_f32 v73, v73, v130
    v_sub_f32 v74, v74, v130
    v_sub_f32 v75, v75, v130
    v_sub_f32 v76, v76, v130
    v_sub_f32 v77, v77, v130
    v_sub_f32 v78, v78, v130
    v_sub_f32 v79, v79, v130
    v_sub_f32 v226, 0, v132
    v_sub_f32 v80, v80, v132
    v_sub_f32 v81, v81, v132
    v_sub_f32 v82, v82, v132
    v_sub_f32 v83, v83, v132
    v_sub_f32 v84, v84, v132
    v_sub_f32 v85, v85, v132
    v_sub_f32 v86, v86, v132
    v_sub_f32 v87, v87, v132
    v_sub_f32 v227, 0, v134
    v_sub_f32 v88, v88, v134
    v_sub_f32 v89, v89, v134
    v_sub_f32 v90, v90, v134
    v_sub_f32 v91, v91, v134
    v_sub_f32 v92, v92, v134
    v_sub_f32 v93, v93, v134
    v_sub_f32 v94, v94, v134
    v_sub_f32 v95, v95, v134
    v_sub_f32 v0, v0, v128
    v_sub_f32 v1, v1, v128
    v_sub_f32 v2, v2, v128
    v_sub_f32 v3, v3, v128
    v_sub_f32 v4, v4, v128
    v_sub_f32 v5, v5, v128
    v_sub_f32 v6, v6, v128
    v_sub_f32 v7, v7, v128
    v_sub_f32 v8, v8, v130
    v_sub_f32 v9, v9, v130
    v_sub_f32 v10, v10, v130
    v_sub_f32 v11, v11, v130
    v_sub_f32 v12, v12, v130
    v_sub_f32 v13, v13, v130
    v_sub_f32 v14, v14, v130
    v_sub_f32 v15, v15, v130
    v_sub_f32 v16, v16, v132
    v_sub_f32 v17, v17, v132
    v_sub_f32 v18, v18, v132
    v_sub_f32 v19, v19, v132
    v_sub_f32 v20, v20, v132
    v_sub_f32 v21, v21, v132
    v_sub_f32 v22, v22, v132
    v_sub_f32 v23, v23, v132
    v_sub_f32 v24, v24, v134
    v_sub_f32 v25, v25, v134
    v_sub_f32 v26, v26, v134
    v_sub_f32 v27, v27, v134
    v_sub_f32 v28, v28, v134
    v_sub_f32 v29, v29, v134
    v_sub_f32 v30, v30, v134
    v_sub_f32 v31, v31, v134
    s_mov_b32 s35, 32768
    v_add_u32_e64 v241, s35, v240
    s_sub_u32 s36, s36, 1
    s_cbranch_scc1 kf_fix3
kf_fixr4:
    v_mfma_f32_16x16x32_bf16 v[32:35], a[224:227], a[128:131], v[64:67]
    ds_read_b128 a[192:195], v241 offset:0
    v_exp_f32_e64 v128, v0
    v_mfma_f32_16x16x32_bf16 v[32:35], a[228:231], a[132:135], v[32:35]
    v_exp_f32_e64 v129, v1
    v_mfma_f32_16x16x32_bf16 v[32:35], a[232:235], a[136:139], v[32:35]
    v_exp_f32_e64 v130, v2
    v_cvt_pk_bf16_f32 v96, v128, v129
    v_mfma_f32_16x16x32_bf16 v[32:35], a[236:239], a[140:143], v[32:35]
    v_exp_f32_e64 v131, v3
    v_mfma_f32_16x16x32_bf16 v[40:43], a[224:227], a[144:147], v[72:75]
    ds_read_b128 a[196:199], v241 offset:2048
    v_exp_f32_e64 v132, v4
    v_mfma_f32_16x16x32_bf16 v[40:43], a[228:231], a[148:151], v[40:43]
    v_exp_f32_e64 v133, v5
    v_cvt_pk_bf16_f32 v97, v130, v131
    v_mfma_f32_16x16x32_bf16 v[40:43], a[232:235], a[152:155], v[40:43]
    v_exp_f32_e64 v134, v6
    v_cvt_pk_bf16_f32 v98, v132, v133
    v_mfma_f32_16x16x32_bf16 v[40:43], a[236:239], a[156:159], v[40:43]
    v_exp_f32_e64 v135, v7
    v_mfma_f32_16x16x32_bf16 v[48:51], a[224:227], a[160:163], v[80:83]
    ds_read_b128 a[200:203], v241 offset:4096
    v_exp_f32_e64 v136, v8
    v_mfma_f32_16x16x32_bf16 v[48:51], a[228:231], a[164:167], v[48:51]
    v_exp_f32_e64 v137, v9
    v_cvt_pk_bf16_f32 v99, v134, v135
    v_mfma_f32_16x16x32_bf16 v[48:51], a[232:235], a[168:171], v[48:51]
    v_exp_f32 v138, v10
    v_exp_f32 v139, v11
    v_mfma_f32_16x16x32_bf16 v[48:51], a[236:239], a[172:175], v[48:51]
    v_exp_f32_e64 v140, v12
    v_cvt_pk_bf16_f32 v100, v136, v137
    v_mfma_f32_16x16x32_bf16 v[56:59], a[224:227], a[176:179], v[88:91]
    ds_read_b128 a[204:207], v241 offset:6144
    v_exp_f32_e64 v141, v13
    v_mfma_f32_16x16x32_bf16 v[56:59], a[228:231], a[180:183], v[56:59]
    v_exp_f32_e64 v142, v14
    v_cvt_pk_bf16_f32 v101, v138, v139
    v_mfma_f32_16x16x32_bf16 v[56:59], a[232:235], a[184:187], v[56:59]
    v_exp_f32_e64 v143, v15
    v_cvt_pk_bf16_f32 v102, v140, v141
    v_mfma_f32_16x16x32_bf16 v[56:59], a[236:239], a[188:191], v[56:59]
    v_exp_f32_e64 v128, v16
    v_cvt_pk_bf16_f32 v103, v142, v143
    v_mfma_f32_16x16x32_bf16 v[36:39], a[240:243], a[128:131], v[68:71]
    ds_read_b128 a[208:211], v241 offset:1024
    v_exp_f32_e64 v129, v17
    v_mfma_f32_16x16x32_bf16 v[36:39], a[244:247], a[132:135], v[36:39]
    v_exp_f32_e64 v130, v18
    v_cvt_pk_bf16_f32 v104, v128, v129
    v_mfma_f32_16x16x32_bf16 v[36:39], a[248:251], a[136:139], v[36:39]
    v_exp_f32_e64 v131, v19
    v_mfma_f32_16x16x32_bf16 v[36:39], a[252:255], a[140:143], v[36:39]
    v_exp_f32_e64 v132, v20
    v_cvt_pk_bf16_f32 v105, v130, v131
    v_mfma_f32_16x16x32_bf16 v[44:47], a[240:243], a[144:147], v[76:79]
    ds_read_b128 a[212:215], v241 offset:3072
    v_exp_f32_e64 v133, v21
    v_mfma_f32_16x16x32_bf16 v[44:47], a[244:247], a[148:151], v[44:47]
    v_exp_f32 v134, v22
    v_exp_f32 v135, v23
    v_mfma_f32_16x16x32_bf16 v[44:47], a[248:251], a[152:155], v[44:47]
    v_exp_f32_e64 v136, v24
    v_cvt_pk_bf16_f32 v106, v132, v133
    v_mfma_f32_16x16x32_bf16 v[44:47], a[252:255], a[156:159], v[44:47]
    v_exp_f32_e64 v137, v25
    v_cvt_pk_bf16_f32 v107, v134, v135
    v_mfma_f32_16x16x32_bf16 v[52:55], a[240:243], a[160:163], v[84:87]
    ds_read_b128 a[216:219], v241 offset:5120
    v_exp_f32_e64 v138, v26
    v_mfma_f32_16x16x32_bf16 v[52:55], a[244:247], a[164:167], v[52:55]
    v_exp_f32_e64 v139, v27
    v_cvt_pk_bf16_f32 v108, v136, v137
    v_mfma_f32_16x16x32_bf16 v[52:55], a[248:251], a[168:171], v[52:55]
    v_exp_f32_e64 v140, v28
    v_cvt_pk_bf16_f32 v109, v138, v139
    v_mfma_f32_16x16x32_bf16 v[52:55], a[252:255], a[172:175], v[52:55]
    v_exp_f32_e64 v141, v29
    v_mfma_f32_16x16x32_bf16 v[60:63], a[240:243], a[176:179], v[92:95]
    ds_read_b128 a[220:223], v241 offset:7168
    v_exp_f32_e64 v142, v30
    v_mfma_f32_16x16x32_bf16 v[60:63], a[244:247], a[180:183], v[60:63]
    v_exp_f32_e64 v143, v31
    v_cvt_pk_bf16_f32 v110, v140, v141
    v_mfma_f32_16x16x32_bf16 v[60:63], a[248:251], a[184:187], v[60:63]
    v_cvt_pk_bf16_f32 v111, v142, v143
    v_mfma_f32_16x16x32_bf16 v[60:63], a[252:255], a[188:191], v[60:63]
    v_add_f32 v200, 0, v243
    v_min_f32 v200, 0, v200
    v_add_f32 v201, 0xf1800000, v243
    v_min_f32_e64 v201, 0, v201
    v_add_f32 v202, 0xf2000000, v243
    v_min_f32_e64 v202, 0, v202
    v_add_f32 v203, 0xf2400000, v243
    v_min_f32_e64 v203, 0, v203
    v_add_f32 v209, 0xf3000000, v243
    v_min_f32_e64 v209, 0, v209
    v_add_f32 v210, 0xf3100000, v243
    v_min_f32_e64 v210, 0, v210
    v_add_f32 v211, 0xf3200000, v243
    v_min_f32_e64 v211, 0, v211
    v_add_f32 v212, 0xf3300000, v243
    v_min_f32_e64 v212, 0, v212
    v_add_f32 v213, 0x73800000, v243
    v_min_f32_e64 v213, 0, v213
    v_add_f32 v214, 0x73700000, v243
    v_min_f32_e64 v214, 0, v214
    v_add_f32 v215, 0x73600000, v243
    v_min_f32_e64 v215, 0, v215
    v_add_f32 v216, 0x73500000, v243
    v_min_f32_e64 v216, 0, v216
    v_add_f32 v217, 0x73000000, v243
    v_min_f32_e64 v217, 0, v217
    v_add_f32 v218, 0x72e00000, v243
    v_min_f32_e64 v218, 0, v218
    v_add_f32 v219, 0x72c00000, v243
    v_min_f32_e64 v219, 0, v219
    v_add_f32 v220, 0x72a00000, v243
    v_min_f32_e64 v220, 0, v220
    ds_read_b128 a[224:227], v241 offset:16384
    ds_read_b128 a[228:231], v241 offset:17408
    ds_read_b128 a[232:235], v241 offset:18432
    ds_read_b128 a[236:239], v241 offset:19456
    s_mul_i32 s27, s5, 68096
    s_sub_u32 s27, s32, s27
    s_add_u32 s18, s27, 1089536
    s_mov_b32 s31, s101
    v_mul_u32_u24 v245, 448, v240
    v_and_b32 v230, 0x40000000, v251
    v_or_b32 v245, v245, v230
    s_lshl1_add_u32 s26, s5, s31
    s_branch ka_p1_e
.p2align 5
ka_p1:
    s_sub_u32 s36, s36, 1
    s_cbranch_scc1 kf_fix7
kf_fixr8:
    s_waitcnt lgkmcnt(8)
    v_mfma_f32_16x16x32_bf16 v[0:3], a[192:195], a[128:131], v[64:67]
    ds_read_b128 a[240:243], v241 offset:20480
    s_waitcnt vmcnt(11)
    v_mfma_f32_16x16x32_bf16 v[0:3], a[196:199], a[132:135], v[0:3]
    v_exp_f32_e64 v128, v32
    v_mfma_f32_16x16x32_bf16 v[0:3], a[200:203], a[136:139], v[0:3]
    v_exp_f32_e64 v129, v33
    v_mfma_f32_16x16x32_bf16 v[0:3], a[204:207], a[140:143], v[0:3]
    v_exp_f32_e64 v130, v34
    v_mfma_f32_16x16x32_bf16 v[8:11], a[192:195], a[144:147], v[72:75]
    ds_read_b128 a[244:247], v241 offset:21504
    buffer_store_dwordx4 v[192:195], v255, s[48:51], s45 offen offset:0 sc1
    v_mfma_f32_16x16x32_bf16 v[8:11], a[196:199], a[148:151], v[8:11]
    s_cmp_lt_u32 s44, s47
    s_cselect_b32 s101, s44, s43
    v_mfma_f32_16x16x32_bf16 v[8:11], a[200:203], a[152:155], v[8:11]
    buffer_load_dwordx4 v[192:195], v253, s[52:55], s101 offen
    v_cvt_pk_bf16_f32 v112, v128, v129
    v_mfma_f32_16x16x32_bf16 v[8:11], a[204:207], a[156:159], v[8:11]
    v_exp_f32_e64 v131, v35
    v_mfma_f32_16x16x32_bf16 v[16:19], a[192:195], a[160:163], v[80:83]
    ds_read_b128 a[248:251], v241 offset:22528
    v_cvt_pk_bf16_f32 v113, v130, v131
    v_mfma_f32_16x16x32_bf16 v[16:19], a[196:199], a[164:167], v[16:19]
    v_exp_f32_e64 v132, v36
    v_mfma_f32_16x16x32_bf16 v[16:19], a[200:203], a[168:171], v[16:19]
    v_exp_f32_e64 v133, v37
    v_mfma_f32_16x16x32_bf16 v[16:19], a[204:207], a[172:175], v[16:19]
    v_exp_f32_e64 v134, v38
    v_mfma_f32_16x16x32_bf16 v[24:27], a[192:195], a[176:179], v[88:91]
    ds_read_b128 a[252:255], v241 offset:23552
    s_mov_b32 m0, s34
    v_mfma_f32_16x16x32_bf16 v[24:27], a[196:199], a[180:183], v[24:27]
    s_add_u32 s41, s42, 17664
    v_cvt_pk_bf16_f32 v114, v132, v133
    v_mfma_f32_16x16x32_bf16 v[24:27], a[200:203], a[184:187], v[24:27]
    v_exp_f32 v135, v39
    v_mfma_f32_16x16x32_bf16 v[24:27], a[204:207], a[188:191], v[24:27]
    v_or3_b32 v208, v112, v113, v114
    s_waitcnt lgkmcnt(8)
    v_mfma_f32_16x16x32_bf16 v[4:7], a[208:211], a[128:131], v[68:71]
    ds_read_b128 a[192:195], v241 offset:8192
    v_cvt_pk_bf16_f32 v115, v134, v135
    v_mfma_f32_16x16x32_bf16 v[4:7], a[212:215], a[132:135], v[4:7]
    v_exp_f32 v136, v40
    v_mfma_f32_16x16x32_bf16 v[4:7], a[216:219], a[136:139], v[4:7]
    v_exp_f32_e64 v137, v41
    v_mfma_f32_16x16x32_bf16 v[4:7], a[220:223], a[140:143], v[4:7]
    v_exp_f32_e64 v138, v42
    v_mfma_f32_16x16x32_bf16 v[12:15], a[208:211], a[144:147], v[76:79]
    ds_read_b128 a[196:199], v241 offset:10240
    buffer_load_dwordx4 v242, s[16:19], s41 offen offset:0 sc1 lds
    v_mfma_f32_16x16x32_bf16 v[12:15], a[212:215], a[148:151], v[12:15]
    v_exp_f32_e64 v139, v43
    v_mfma_f32_16x16x32_bf16 v[12:15], a[216:219], a[152:155], v[12:15]
    v_exp_f32_e64 v140, v44
    v_mfma_f32_16x16x32_bf16 v[12:15], a[220:223], a[156:159], v[12:15]
    v_exp_f32_e64 v141, v45
    v_mfma_f32_16x16x32_bf16 v[20:23], a[208:211], a[160:163], v[84:87]
    ds_read_b128 a[200:203], v241 offset:12288
    v_cvt_pk_bf16_f32 v116, v136, v137
    v_mfma_f32_16x16x32_bf16 v[20:23], a[212:215], a[164:167], v[20:23]
    v_exp_f32_e64 v142, v46
    v_mfma_f32_16x16x32_bf16 v[20:23], a[216:219], a[168:171], v[20:23]
    v_exp_f32_e64 v143, v47
    v_mfma_f32_16x16x32_bf16 v[20:23], a[220:223], a[172:175], v[20:23]
    v_or3_b32 v208, v208, v115, v116
    v_cvt_pk_bf16_f32 v117, v138, v139
    v_mfma_f32_16x16x32_bf16 v[28:31], a[208:211], a[176:179], v[92:95]
    ds_read_b128 a[204:207], v241 offset:14336
    buffer_load_dwordx4 v242, s[16:19], s41 offen offset:1024 sc1 lds
    v_mfma_f32_16x16x32_bf16 v[28:31], a[212:215], a[180:183], v[28:31]
    v_exp_f32_e64 v128, v48
    v_mfma_f32_16x16x32_bf16 v[28:31], a[216:219], a[184:187], v[28:31]
    v_exp_f32_e64 v129, v49
    v_mfma_f32_16x16x32_bf16 v[28:31], a[220:223], a[188:191], v[28:31]
    v_cvt_pk_bf16_f32 v118, v140, v141
    s_waitcnt lgkmcnt(8)
    v_mfma_f32_16x16x32_bf16 a[0:3], a[224:227], v[96:99], a[0:3]
    ds_read_b128 a[208:211], v241 offset:9216
    v_or3_b32 v208, v208, v117, v118
    v_mfma_f32_16x16x32_bf16 a[32:35], a[224:227], v[100:103], a[32:35]
    v_exp_f32 v130, v50
    v_mfma_f32_16x16x32_bf16 a[64:67], a[224:227], v[104:107], a[64:67]
    v_exp_f32_e64 v131, v51
    v_mfma_f32_16x16x32_bf16 a[96:99], a[224:227], v[108:111], a[96:99]
    v_exp_f32_e64 v132, v52
    v_mfma_f32_16x16x32_bf16 a[4:7], a[228:231], v[96:99], a[4:7]
    ds_read_b128 a[212:215], v241 offset:11264
    v_cvt_pk_bf16_f32 v119, v142, v143
    v_mfma_f32_16x16x32_bf16 a[36:39], a[228:231], v[100:103], a[36:39]
    buffer_load_dwordx4 v242, s[16:19], s41 offen offset:2048 sc1 lds
    v_cvt_pk_bf16_f32 v120, v128, v129
    v_mfma_f32_16x16x32_bf16 a[68:71], a[228:231], v[104:107], a[68:71]
    v_exp_f32_e64 v133, v53
    v_mfma_f32_16x16x32_bf16 a[100:103], a[228:231], v[108:111], a[100:103]
    v_exp_f32_e64 v134, v54
    v_mfma_f32_16x16x32_bf16 a[8:11], a[232:235], v[96:99], a[8:11]
    ds_read_b128 a[216:219], v241 offset:13312
    v_or3_b32 v208, v208, v119, v120
    v_mfma_f32_16x16x32_bf16 a[40:43], a[232:235], v[100:103], a[40:43]
    v_exp_f32_e64 v135, v55
    v_mfma_f32_16x16x32_bf16 a[72:75], a[232:235], v[104:107], a[72:75]
    v_exp_f32_e64 v136, v56
    v_mfma_f32_16x16x32_bf16 a[104:107], a[232:235], v[108:111], a[104:107]
    v_exp_f32_e64 v137, v57
    v_mfma_f32_16x16x32_bf16 a[12:15], a[236:239], v[96:99], a[12:15]
    ds_read_b128 a[220:223], v241 offset:15360
    v_cvt_pk_bf16_f32 v121, v130, v131
    v_mfma_f32_16x16x32_bf16 a[44:47], a[236:239], v[100:103], a[44:47]
    v_cvt_pk_bf16_f32 v122, v132, v133
    v_or3_b32 v208, v208, v121, v122
    v_mfma_f32_16x16x32_bf16 a[76:79], a[236:239], v[104:107], a[76:79]
    buffer_load_dwordx4 v242, s[16:19], s41 offen offset:3072 sc1 lds
    v_cvt_pk_bf16_f32 v123, v134, v135
    v_mfma_f32_16x16x32_bf16 a[108:111], a[236:239], v[108:111], a[108:111]
    v_cvt_pk_bf16_f32 v124, v136, v137
    s_waitcnt lgkmcnt(8)
    v_mfma_f32_16x16x32_bf16 a[16:19], a[240:243], v[96:99], a[16:19]
    ds_read_b128 a[224:227], v241 offset:24576
    v_or3_b32 v208, v208, v123, v124
    v_mfma_f32_16x16x32_bf16 a[48:51], a[240:243], v[100:103], a[48:51]
    v_exp_f32 v138, v58
    v_mfma_f32_16x16x32_bf16 a[80:83], a[240:243], v[104:107], a[80:83]
    v_exp_f32_e64 v139, v59
    v_mfma_f32_16x16x32_bf16 a[112:115], a[240:243], v[108:111], a[112:115]
    v_exp_f32_e64 v140, v60
    v_mfma_f32_16x16x32_bf16 a[20:23], a[244:247], v[96:99], a[20:23]
    ds_read_b128 a[228:231], v241 offset:25600
    v_cvt_pk_bf16_f32 v125, v138, v139
    v_mfma_f32_16x16x32_bf16 a[52:55], a[244:247], v[100:103], a[52:55]
    v_exp_f32_e64 v141, v61
    v_mfma_f32_16x16x32_bf16 a[84:87], a[244:247], v[104:107], a[84:87]
    v_exp_f32_e64 v142, v62
    v_mfma_f32_16x16x32_bf16 a[116:119], a[244:247], v[108:111], a[116:119]
    s_add_u32 s35, s35, 32768
    v_cvt_pk_bf16_f32 v126, v140, v141
    v_mfma_f32_16x16x32_bf16 a[24:27], a[248:251], v[96:99], a[24:27]
    ds_read_b128 a[232:235], v241 offset:26624
    v_or3_b32 v208, v208, v125, v126
    v_mfma_f32_16x16x32_bf16 a[56:59], a[248:251], v[100:103], a[56:59]
    s_cmp_ge_u32 s35, 163840
    s_cselect_b32 s35, 0, s35
    v_mfma_f32_16x16x32_bf16 a[88:91], a[248:251], v[104:107], a[88:91]
    v_exp_f32 v143, v63
    v_mfma_f32_16x16x32_bf16 a[120:123], a[248:251], v[108:111], a[120:123]
    v_cvt_pk_bf16_f32 v127, v142, v143
    v_or_b32_e64 v208, v208, v127
    v_mfma_f32_16x16x32_bf16 a[28:31], a[252:255], v[96:99], a[28:31]
    ds_read_b128 a[236:239], v241 offset:27648
    v_and_b32_e64 v208, s38, v208
    v_mfma_f32_16x16x32_bf16 a[60:63], a[252:255], v[100:103], a[60:63]
    v_cmp_ne_u32_e64 vcc, 0, v208
    v_mfma_f32_16x16x32_bf16 a[92:95], a[252:255], v[104:107], a[92:95]
    v_mfma_f32_16x16x32_bf16 a[124:127], a[252:255], v[108:111], a[124:127]
    v_mfma_f32_16x16x32_bf16 v[144:147], v[204:207], v[96:99], v[144:147]
    v_mfma_f32_16x16x32_bf16 v[148:151], v[204:207], v[100:103], v[148:151]
    v_mfma_f32_16x16x32_bf16 v[152:155], v[204:207], v[104:107], v[152:155]
    v_mfma_f32_16x16x32_bf16 v[156:159], v[204:207], v[108:111], v[156:159]
    s_cbranch_vccnz kf_rare6
kf_rr5:
    s_sub_u32 s36, s36, 1
    s_cbranch_scc1 kf_fix11
kf_fixr12:
    s_waitcnt lgkmcnt(8)
    v_mfma_f32_16x16x32_bf16 v[32:35], a[192:195], a[128:131], v[64:67]
    ds_read_b128 a[240:243], v241 offset:28672
    s_waitcnt vmcnt(11)
    v_mfma_f32_16x16x32_bf16 v[32:35], a[196:199], a[132:135], v[32:35]
    v_exp_f32 v128, v0
    v_mfma_f32_16x16x32_bf16 v[32:35], a[200:203], a[136:139], v[32:35]
    v_exp_f32_e64 v129, v1
    v_mfma_f32_16x16x32_bf16 v[32:35], a[204:207], a[140:143], v[32:35]
    v_exp_f32_e64 v130, v2
    v_mfma_f32_16x16x32_bf16 v[40:43], a[192:195], a[144:147], v[72:75]
    ds_read_b128 a[244:247], v241 offset:29696
    buffer_store_dwordx4 v[196:199], v255, s[48:51], s45 offen offset:256 sc1
    v_mfma_f32_16x16x32_bf16 v[40:43], a[196:199], a[148:151], v[40:43]
    s_add_u32 s101, s101, 57344
    buffer_load_dwordx4 v[196:199], v253, s[52:55], s101 offen
    v_mfma_f32_16x16x32_bf16 v[40:43], a[200:203], a[152:155], v[40:43]
    v_exp_f32_e64 v131, v3
    v_mfma_f32_16x16x32_bf16 v[40:43], a[204:207], a[156:159], v[40:43]
    v_exp_f32_e64 v132, v4
    v_mfma_f32_16x16x32_bf16 v[48:51], a[192:195], a[160:163], v[80:83]
    ds_read_b128 a[248:251], v241 offset:30720
    v_cvt_pk_bf16_f32 v96, v128, v129
    v_mfma_f32_16x16x32_bf16 v[48:51], a[196:199], a[164:167], v[48:51]
    s_cmp_lt_u32 s44, s47
    s_cselect_b32 s45, s46, s43
    v_mfma_f32_16x16x32_bf16 v[48:51], a[200:203], a[168:171], v[48:51]
    v_exp_f32_e64 v133, v5
    v_mfma_f32_16x16x32_bf16 v[48:51], a[204:207], a[172:175], v[48:51]
    v_exp_f32_e64 v134, v6
    v_mfma_f32_16x16x32_bf16 v[56:59], a[192:195], a[176:179], v[88:91]
    ds_read_b128 a[252:255], v241 offset:31744
    s_add_u32 s44, s44, 128
    v_mfma_f32_16x16x32_bf16 v[56:59], a[196:199], a[180:183], v[56:59]
    s_add_u32 s46, s46, 262144
    v_cvt_pk_bf16_f32 v97, v130, v131
    v_mfma_f32_16x16x32_bf16 v[56:59], a[200:203], a[184:187], v[56:59]
    v_exp_f32_e64 v135, v7
    v_mfma_f32_16x16x32_bf16 v[56:59], a[204:207], a[188:191], v[56:59]
    v_cvt_pk_bf16_f32 v98, v132, v133
    s_waitcnt lgkmcnt(8)
    v_mfma_f32_16x16x32_bf16 v[36:39], a[208:211], a[128:131], v[68:71]
    s_waitcnt vmcnt(16)
    s_barrier
    v_add_u32 v241, s35, v240
    ds_read_b128 a[192:195], v241 offset:0
    v_mfma_f32_16x16x32_bf16 v[36:39], a[212:215], a[132:135], v[36:39]
    v_exp_f32_e64 v136, v8
    v_mfma_f32_16x16x32_bf16 v[36:39], a[216:219], a[136:139], v[36:39]
    v_exp_f32_e64 v137, v9
    v_mfma_f32_16x16x32_bf16 v[36:39], a[220:223], a[140:143], v[36:39]
    v_exp_f32_e64 v138, v10
    v_mfma_f32_16x16x32_bf16 v[44:47], a[208:211], a[144:147], v[76:79]
    ds_read_b128 a[196:199], v241 offset:2048
    s_add_u32 m0, s34, 16384
    v_mfma_f32_16x16x32_bf16 v[44:47], a[212:215], a[148:151], v[44:47]
    s_add_u32 s34, s34, 32768
    v_or3_b32 v208, v96, v97, v98
    v_mfma_f32_16x16x32_bf16 v[44:47], a[216:219], a[152:155], v[44:47]
    s_cmp_ge_u32 s34, 163840
    s_cselect_b32 s34, s37, s34
    v_mfma_f32_16x16x32_bf16 v[44:47], a[220:223], a[156:159], v[44:47]
    v_exp_f32 v139, v11
    v_mfma_f32_16x16x32_bf16 v[52:55], a[208:211], a[160:163], v[84:87]
    ds_read_b128 a[200:203], v241 offset:4096
    v_cvt_pk_bf16_f32 v99, v134, v135
    v_mfma_f32_16x16x32_bf16 v[52:55], a[212:215], a[164:167], v[52:55]
    v_exp_f32_e64 v140, v12
    v_mfma_f32_16x16x32_bf16 v[52:55], a[216:219], a[168:171], v[52:55]
    v_exp_f32_e64 v141, v13
    v_mfma_f32_16x16x32_bf16 v[52:55], a[220:223], a[172:175], v[52:55]
    v_cvt_pk_bf16_f32 v100, v136, v137
    buffer_load_dwordx4 v242, s[16:19], s42 offen offset:0 sc1 lds
    v_mfma_f32_16x16x32_bf16 v[60:63], a[208:211], a[176:179], v[92:95]
    ds_read_b128 a[204:207], v241 offset:6144
    v_or3_b32 v208, v208, v99, v100
    v_mfma_f32_16x16x32_bf16 v[60:63], a[212:215], a[180:183], v[60:63]
    v_exp_f32_e64 v142, v14
    v_mfma_f32_16x16x32_bf16 v[60:63], a[216:219], a[184:187], v[60:63]
    v_exp_f32_e64 v143, v15
    v_mfma_f32_16x16x32_bf16 v[60:63], a[220:223], a[188:191], v[60:63]
    v_cvt_pk_bf16_f32 v101, v138, v139
    s_waitcnt lgkmcnt(8)
    v_mfma_f32_16x16x32_bf16 a[0:3], a[224:227], v[112:115], a[0:3]
    ds_read_b128 a[208:211], v241 offset:1024
    v_cvt_pk_bf16_f32 v102, v140, v141
    v_mfma_f32_16x16x32_bf16 a[32:35], a[224:227], v[116:119], a[32:35]
    v_exp_f32 v128, v16
    v_mfma_f32_16x16x32_bf16 a[64:67], a[224:227], v[120:123], a[64:67]
    v_exp_f32_e64 v129, v17
    v_mfma_f32_16x16x32_bf16 a[96:99], a[224:227], v[124:127], a[96:99]
    v_exp_f32_e64 v130, v18
    v_mfma_f32_16x16x32_bf16 a[4:7], a[228:231], v[112:115], a[4:7]
    ds_read_b128 a[212:215], v241 offset:3072
    buffer_load_dwordx4 v242, s[16:19], s42 offen offset:1024 sc1 lds
    v_mfma_f32_16x16x32_bf16 a[36:39], a[228:231], v[116:119], a[36:39]
    v_exp_f32_e64 v131, v19
    v_mfma_f32_16x16x32_bf16 a[68:71], a[228:231], v[120:123], a[68:71]
    v_or3_b32 v208, v208, v101, v102
    v_cvt_pk_bf16_f32 v103, v142, v143
    v_mfma_f32_16x16x32_bf16 a[100:103], a[228:231], v[124:127], a[100:103]
    v_exp_f32_e64 v132, v20
    v_mfma_f32_16x16x32_bf16 a[8:11], a[232:235], v[112:115], a[8:11]
    ds_read_b128 a[216:219], v241 offset:5120
    v_cvt_pk_bf16_f32 v104, v128, v129
    v_mfma_f32_16x16x32_bf16 a[40:43], a[232:235], v[116:119], a[40:43]
    v_exp_f32_e64 v133, v21
    v_mfma_f32_16x16x32_bf16 a[72:75], a[232:235], v[120:123], a[72:75]
    v_exp_f32_e64 v134, v22
    v_mfma_f32_16x16x32_bf16 a[104:107], a[232:235], v[124:127], a[104:107]
    v_exp_f32_e64 v135, v23
    v_mfma_f32_16x16x32_bf16 a[12:15], a[236:239], v[112:115], a[12:15]
    ds_read_b128 a[220:223], v241 offset:7168
    buffer_load_dwordx4 v242, s[16:19], s42 offen offset:2048 sc1 lds
    v_mfma_f32_16x16x32_bf16 a[44:47], a[236:239], v[116:119], a[44:47]
    v_or3_b32 v208, v208, v103, v104
    v_cvt_pk_bf16_f32 v105, v130, v131
    v_mfma_f32_16x16x32_bf16 a[76:79], a[236:239], v[120:123], a[76:79]
    v_exp_f32_e64 v136, v24
    v_mfma_f32_16x16x32_bf16 a[108:111], a[236:239], v[124:127], a[108:111]
    v_cvt_pk_bf16_f32 v106, v132, v133
    s_waitcnt lgkmcnt(8)
    v_mfma_f32_16x16x32_bf16 a[16:19], a[240:243], v[112:115], a[16:19]
    ds_read_b128 a[224:227], v241 offset:16384
    v_or3_b32 v208, v208, v105, v106
    v_mfma_f32_16x16x32_bf16 a[48:51], a[240:243], v[116:119], a[48:51]
    v_exp_f32 v137, v25
    v_mfma_f32_16x16x32_bf16 a[80:83], a[240:243], v[120:123], a[80:83]
    v_exp_f32_e64 v138, v26
    v_mfma_f32_16x16x32_bf16 a[112:115], a[240:243], v[124:127], a[112:115]
    v_exp_f32_e64 v139, v27
    v_mfma_f32_16x16x32_bf16 a[20:23], a[244:247], v[112:115], a[20:23]
    ds_read_b128 a[228:231], v241 offset:17408
    buffer_load_dwordx4 v242, s[16:19], s42 offen offset:3072 sc1 lds
    v_mfma_f32_16x16x32_bf16 a[52:55], a[244:247], v[116:119], a[52:55]
    s_add_u32 s42, s42, 34048
    v_cvt_pk_bf16_f32 v107, v134, v135
    v_mfma_f32_16x16x32_bf16 a[84:87], a[244:247], v[120:123], a[84:87]
    v_exp_f32_e64 v140, v28
    v_mfma_f32_16x16x32_bf16 a[116:119], a[244:247], v[124:127], a[116:119]
    v_exp_f32_e64 v141, v29
    v_mfma_f32_16x16x32_bf16 a[24:27], a[248:251], v[112:115], a[24:27]
    ds_read_b128 a[232:235], v241 offset:18432
    v_cvt_pk_bf16_f32 v108, v136, v137
    v_mfma_f32_16x16x32_bf16 a[56:59], a[248:251], v[116:119], a[56:59]
    v_exp_f32_e64 v142, v30
    v_mfma_f32_16x16x32_bf16 a[88:91], a[248:251], v[120:123], a[88:91]
    v_exp_f32_e64 v143, v31
    v_mfma_f32_16x16x32_bf16 a[120:123], a[248:251], v[124:127], a[120:123]
    buffer_load_dword v252, v251, s[60:63], s100 offen
    s_add_u32 s100, s100, 2048
    v_mfma_f32_16x16x32_bf16 a[28:31], a[252:255], v[112:115], a[28:31]
    ds_read_b128 a[236:239], v241 offset:19456
    v_or3_b32 v208, v208, v107, v108
    v_mfma_f32_16x16x32_bf16 a[60:63], a[252:255], v[116:119], a[60:63]
    v_cvt_pk_bf16_f32 v109, v138, v139
    v_cvt_pk_bf16_f32 v110, v140, v141
    v_mfma_f32_16x16x32_bf16 a[92:95], a[252:255], v[120:123], a[92:95]
    v_or3_b32 v208, v208, v109, v110
    v_cvt_pk_bf16_f32 v111, v142, v143
    v_mfma_f32_16x16x32_bf16 a[124:127], a[252:255], v[124:127], a[124:127]
    v_or_b32 v208, v208, v111
    v_and_b32 v208, s38, v208
    v_mfma_f32_16x16x32_bf16 v[144:147], v[204:207], v[112:115], v[144:147]
    v_cmp_ne_u32_e64 vcc, 0, v208
    v_mfma_f32_16x16x32_bf16 v[148:151], v[204:207], v[116:119], v[148:151]
    v_mfma_f32_16x16x32_bf16 v[152:155], v[204:207], v[120:123], v[152:155]
    v_mfma_f32_16x16x32_bf16 v[156:159], v[204:207], v[124:127], v[156:159]
    s_cbranch_vccnz kf_rare10
kf_rr9:
ka_p1_e:
    s_sub_u32 s26, s26, 1
    s_cbranch_scc0 ka_p1
    s_branch ka_p1_x
kf_fix7:
    s_mov_b32 s24, 0
    s_branch kf_fix7c
kf_fix11:
    s_mov_b32 s24, 1
kf_fix7c:
    s_cmp_eq_u32 s33, 0
    s_cbranch_scc0 kf_fix7f
    s_mov_b32 s36, 0
    s_mov_b32 s33, 1
    v_add_f32 v64, v224, v200
    v_add_f32 v65, v224, v201
    v_add_f32 v66, v224, v202
    v_add_f32 v67, v224, v203
    v_add_f32 v68, v224, v209
    v_add_f32 v69, v224, v210
    v_add_f32 v70, v224, v211
    v_add_f32 v71, v224, v212
    v_add_f32 v72, v225, v213
    v_add_f32 v73, v225, v214
    v_add_f32 v74, v225, v215
    v_add_f32 v75, v225, v216
    v_add_f32 v76, v225, v217
    v_add_f32 v77, v225, v218
    v_add_f32 v78, v225, v219
    v_add_f32 v79, v225, v220
    s_cmp_eq_u32 s24, 0
    s_cbranch_scc1 kf_fixr8
    s_branch kf_fixr12
kf_fix7f:
    s_mov_b32 s36, 0x1000
    v_mov_b32 v64, 0xf1800000
    v_mov_b32 v65, v64
    v_mov_b32 v66, v64
    v_mov_b32 v67, v64
    v_mov_b32 v68, v64
    v_mov_b32 v69, v64
    v_mov_b32 v70, v64
    v_mov_b32 v71, v64
    v_mov_b32 v72, v64
    v_mov_b32 v73, v64
    v_mov_b32 v74, v64
    v_mov_b32 v75, v64
    v_mov_b32 v76, v64
    v_mov_b32 v77, v64
    v_mov_b32 v78, v64
    v_mov_b32 v79, v64
    s_cmp_eq_u32 s24, 0
    s_cbranch_scc1 kf_fixr8
    s_branch kf_fixr12
kf_fix15:
    s_mov_b32 s24, 0
    s_branch kf_fix15c
kf_fix19:
    s_mov_b32 s24, 1
kf_fix15c:
    s_cmp_eq_u32 s33, 0
    s_cbranch_scc0 kf_fix15f
    s_mov_b32 s36, 0
    s_mov_b32 s33, 1
    v_add_f32 v80, v226, v200
    v_add_f32 v81, v226, v201
    v_add_f32 v82, v226, v202
    v_add_f32 v83, v226, v203
    v_add_f32 v84, v226, v209
    v_add_f32 v85, v226, v210
    v_add_f32 v86, v226, v211
    v_add_f32 v87, v226, v212
    v_add_f32 v88, v227, v213
    v_add_f32 v89, v227, v214
    v_add_f32 v90, v227, v215
    v_add_f32 v91, v227, v216
    v_add_f32 v92, v227, v217
    v_add_f32 v93, v227, v218
    v_add_f32 v94, v227, v219
    v_add_f32 v95, v227, v220
    s_cmp_eq_u32 s24, 0
    s_cbranch_scc1 kf_fixr16
    s_branch kf_fixr20
kf_fix15f:
    s_mov_b32 s36, 0x1000
    v_mov_b32 v80, 0xf1800000
    v_mov_b32 v81, v80
    v_mov_b32 v82, v80
    v_mov_b32 v83, v80
    v_mov_b32 v84, v80
    v_mov_b32 v85, v80
    v_mov_b32 v86, v80
    v_mov_b32 v87, v80
    v_mov_b32 v88, v80
    v_mov_b32 v89, v80
    v_mov_b32 v90, v80
    v_mov_b32 v91, v80
    v_mov_b32 v92, v80
    v_mov_b32 v93, v80
    v_mov_b32 v94, v80
    v_mov_b32_e64 v95, v80
    s_cmp_eq_u32 s24, 0
    s_cbranch_scc1 kf_fixr16
    s_branch kf_fixr20
ka_p1_x:
    s_lshl2_add_u32 s36, s5, s6
    s_lshl1_add_u32 s36, s31, s36
    s_sub_u32 s36, 61, s36
    s_mov_b32 s33, 0
    s_sub_u32 s36, s36, 1
    s_cbranch_scc1 kf_fix15
kf_fixr16:
    s_waitcnt lgkmcnt(8)
    v_mfma_f32_16x16x32_bf16 v[16:19], a[192:195], a[160:163], v[80:83]
    ds_read_b128 a[240:243], v241 offset:20480
    ds_read_b128 a[244:247], v241 offset:21504
    v_mfma_f32_16x16x32_bf16 v[16:19], a[196:199], a[164:167], v[16:19]
    s_waitcnt vmcnt(11)
    v_exp_f32 v128, v32
    v_mfma_f32_16x16x32_bf16 v[16:19], a[200:203], a[168:171], v[16:19]
    v_exp_f32_e64 v129, v33
    v_mfma_f32_16x16x32_bf16 v[16:19], a[204:207], a[172:175], v[16:19]
    buffer_store_dwordx4 v[192:195], v255, s[48:51], s45 offen offset:0 sc1
    v_exp_f32_e64 v130, v34
    v_mfma_f32_16x16x32_bf16 v[24:27], a[192:195], a[176:179], v[88:91]
    ds_read_b128 a[248:251], v241 offset:22528
    ds_read_b128 a[252:255], v241 offset:23552
    v_mfma_f32_16x16x32_bf16 v[24:27], a[196:199], a[180:183], v[24:27]
    v_exp_f32_e64 v131, v35
    v_mfma_f32_16x16x32_bf16 v[24:27], a[200:203], a[184:187], v[24:27]
    v_exp_f32_e64 v132, v36
    v_cvt_pk_bf16_f32 v112, v128, v129
    v_mfma_f32_16x16x32_bf16 v[24:27], a[204:207], a[188:191], v[24:27]
    s_mov_b32 m0, s34
    s_waitcnt lgkmcnt(8)
    v_mfma_f32_16x16x32_bf16 v[20:23], a[208:211], a[160:163], v[84:87]
    ds_read_b128 a[192:195], v241 offset:8192
    ds_read_b128 a[196:199], v241 offset:10240
    v_mfma_f32_16x16x32_bf16 v[20:23], a[212:215], a[164:167], v[20:23]
    s_add_u32 s41, s42, 17664
    v_exp_f32_e64 v133, v37
    v_mfma_f32_16x16x32_bf16 v[20:23], a[216:219], a[168:171], v[20:23]
    v_exp_f32_e64 v134, v38
    v_mfma_f32_16x16x32_bf16 v[20:23], a[220:223], a[172:175], v[20:23]
    v_exp_f32_e64 v135, v39
    v_mfma_f32_16x16x32_bf16 v[28:31], a[208:211], a[176:179], v[92:95]
    ds_read_b128 a[200:203], v241 offset:12288
    ds_read_b128 a[204:207], v241 offset:14336
    v_cvt_pk_bf16_f32 v113, v130, v131
    v_mfma_f32_16x16x32_bf16 v[28:31], a[212:215], a[180:183], v[28:31]
    v_exp_f32_e64 v136, v40
    v_mfma_f32_16x16x32_bf16 v[28:31], a[216:219], a[184:187], v[28:31]
    v_exp_f32_e64 v137, v41
    v_mfma_f32_16x16x32_bf16 v[28:31], a[220:223], a[188:191], v[28:31]
    v_cvt_pk_bf16_f32 v114, v132, v133
    buffer_load_dwordx4 v242, s[16:19], s41 offen offset:0 sc1 lds
    s_waitcnt lgkmcnt(8)
    v_mfma_f32_16x16x32_bf16 a[0:3], a[224:227], v[96:99], a[0:3]
    ds_read_b128 a[208:211], v241 offset:9216
    v_or3_b32 v208, v112, v113, v114
    v_mfma_f32_16x16x32_bf16 a[32:35], a[224:227], v[100:103], a[32:35]
    v_exp_f32 v138, v42
    v_mfma_f32_16x16x32_bf16 a[64:67], a[224:227], v[104:107], a[64:67]
    v_exp_f32_e64 v139, v43
    v_cvt_pk_bf16_f32 v115, v134, v135
    v_mfma_f32_16x16x32_bf16 a[96:99], a[224:227], v[108:111], a[96:99]
    v_exp_f32_e64 v140, v44
    v_mfma_f32_16x16x32_bf16 a[4:7], a[228:231], v[96:99], a[4:7]
    ds_read_b128 a[212:215], v241 offset:11264
    v_cvt_pk_bf16_f32 v116, v136, v137
    v_mfma_f32_16x16x32_bf16 a[36:39], a[228:231], v[100:103], a[36:39]
    buffer_load_dwordx4 v242, s[16:19], s41 offen offset:1024 sc1 lds
    v_exp_f32_e64 v141, v45
    v_mfma_f32_16x16x32_bf16 a[68:71], a[228:231], v[104:107], a[68:71]
    v_exp_f32_e64 v142, v46
    v_mfma_f32_16x16x32_bf16 a[100:103], a[228:231], v[108:111], a[100:103]
    v_exp_f32_e64 v143, v47
    v_mfma_f32_16x16x32_bf16 a[8:11], a[232:235], v[96:99], a[8:11]
    ds_read_b128 a[216:219], v241 offset:13312
    v_or3_b32 v208, v208, v115, v116
    v_cvt_pk_bf16_f32 v117, v138, v139
    v_mfma_f32_16x16x32_bf16 a[40:43], a[232:235], v[100:103], a[40:43]
    v_exp_f32_e64 v128, v48
    v_mfma_f32_16x16x32_bf16 a[72:75], a[232:235], v[104:107], a[72:75]
    v_exp_f32_e64 v129, v49
    v_mfma_f32_16x16x32_bf16 a[104:107], a[232:235], v[108:111], a[104:107]
    v_cvt_pk_bf16_f32 v118, v140, v141
    v_exp_f32_e64 v130, v50
    v_mfma_f32_16x16x32_bf16 a[12:15], a[236:239], v[96:99], a[12:15]
    ds_read_b128 a[220:223], v241 offset:15360
    buffer_load_dwordx4 v242, s[16:19], s41 offen offset:2048 sc1 lds
    v_mfma_f32_16x16x32_bf16 a[44:47], a[236:239], v[100:103], a[44:47]
    v_exp_f32_e64 v131, v51
    v_or3_b32 v208, v208, v117, v118
    v_mfma_f32_16x16x32_bf16 a[76:79], a[236:239], v[104:107], a[76:79]
    v_exp_f32_e64 v132, v52
    v_mfma_f32_16x16x32_bf16 a[108:111], a[236:239], v[108:111], a[108:111]
    v_cvt_pk_bf16_f32 v119, v142, v143
    s_waitcnt lgkmcnt(8)
    v_mfma_f32_16x16x32_bf16 a[16:19], a[240:243], v[96:99], a[16:19]
    ds_read_b128 a[224:227], v241 offset:24576
    v_exp_f32 v133, v53
    v_mfma_f32_16x16x32_bf16 a[48:51], a[240:243], v[100:103], a[48:51]
    v_cvt_pk_bf16_f32 v120, v128, v129
    v_or3_b32 v208, v208, v119, v120
    v_mfma_f32_16x16x32_bf16 a[80:83], a[240:243], v[104:107], a[80:83]
    v_exp_f32_e64 v134, v54
    v_mfma_f32_16x16x32_bf16 a[112:115], a[240:243], v[108:111], a[112:115]
    buffer_load_dwordx4 v242, s[16:19], s41 offen offset:3072 sc1 lds
    v_exp_f32_e64 v135, v55
    v_mfma_f32_16x16x32_bf16 a[20:23], a[244:247], v[96:99], a[20:23]
    ds_read_b128 a[228:231], v241 offset:25600
    v_cvt_pk_bf16_f32 v121, v130, v131
    v_mfma_f32_16x16x32_bf16 a[52:55], a[244:247], v[100:103], a[52:55]
    v_exp_f32_e64 v136, v56
    v_mfma_f32_16x16x32_bf16 a[84:87], a[244:247], v[104:107], a[84:87]
    v_exp_f32_e64 v137, v57
    v_cvt_pk_bf16_f32 v122, v132, v133
    v_mfma_f32_16x16x32_bf16 a[116:119], a[244:247], v[108:111], a[116:119]
    v_exp_f32_e64 v138, v58
    v_mfma_f32_16x16x32_bf16 a[24:27], a[248:251], v[96:99], a[24:27]
    ds_read_b128 a[232:235], v241 offset:26624
    v_or3_b32 v208, v208, v121, v122
    v_mfma_f32_16x16x32_bf16 a[56:59], a[248:251], v[100:103], a[56:59]
    v_exp_f32_e64 v139, v59
    v_cvt_pk_bf16_f32 v123, v134, v135
    v_mfma_f32_16x16x32_bf16 a[88:91], a[248:251], v[104:107], a[88:91]
    v_exp_f32_e64 v140, v60
    v_mfma_f32_16x16x32_bf16 a[120:123], a[248:251], v[108:111], a[120:123]
    v_exp_f32_e64 v141, v61
    v_mfma_f32_16x16x32_bf16 a[28:31], a[252:255], v[96:99], a[28:31]
    ds_read_b128 a[236:239], v241 offset:27648
    v_cvt_pk_bf16_f32 v124, v136, v137
    s_add_u32 s35, s35, 32768
    v_mfma_f32_16x16x32_bf16 a[60:63], a[252:255], v[100:103], a[60:63]
    s_cmp_ge_u32 s35, 163840
    s_cselect_b32 s35, 0, s35
    v_mfma_f32_16x16x32_bf16 a[92:95], a[252:255], v[104:107], a[92:95]
    v_exp_f32 v142, v62
    v_mfma_f32_16x16x32_bf16 a[124:127], a[252:255], v[108:111], a[124:127]
    v_exp_f32_e64 v143, v63
    v_or3_b32 v208, v208, v123, v124
    v_mfma_f32_16x16x32_bf16 v[144:147], v[204:207], v[96:99], v[144:147]
    v_cvt_pk_bf16_f32 v125, v138, v139
    v_cvt_pk_bf16_f32 v126, v140, v141
    v_mfma_f32_16x16x32_bf16 v[148:151], v[204:207], v[100:103], v[148:151]
    v_or3_b32 v208, v208, v125, v126
    v_cvt_pk_bf16_f32 v127, v142, v143
    v_mfma_f32_16x16x32_bf16 v[152:155], v[204:207], v[104:107], v[152:155]
    v_or_b32 v208, v208, v127
    v_and_b32 v208, s38, v208
    v_cmp_ne_u32_e64 vcc, 0, v208
    v_mfma_f32_16x16x32_bf16 v[156:159], v[204:207], v[108:111], v[156:159]
    s_cbranch_vccnz kf_rare14
kf_rr13:
    s_sub_u32 s36, s36, 1
    s_cbranch_scc1 kf_fix19
kf_fixr20:
    s_waitcnt lgkmcnt(8)
    v_mfma_f32_16x16x32_bf16 v[48:51], a[192:195], a[160:163], v[80:83]
    ds_read_b128 a[240:243], v241 offset:28672
    ds_read_b128 a[244:247], v241 offset:29696
    v_mfma_f32_16x16x32_bf16 v[48:51], a[196:199], a[164:167], v[48:51]
    v_exp_f32_e64 v128, v16
    v_mfma_f32_16x16x32_bf16 v[48:51], a[200:203], a[168:171], v[48:51]
    v_exp_f32_e64 v129, v17
    v_mfma_f32_16x16x32_bf16 v[48:51], a[204:207], a[172:175], v[48:51]
    s_waitcnt vmcnt(10)
    buffer_store_dwordx4 v[196:199], v255, s[48:51], s45 offen offset:256 sc1
    v_mfma_f32_16x16x32_bf16 v[56:59], a[192:195], a[176:179], v[88:91]
    ds_read_b128 a[248:251], v241 offset:30720
    ds_read_b128 a[252:255], v241 offset:31744
    v_mfma_f32_16x16x32_bf16 v[56:59], a[196:199], a[180:183], v[56:59]
    v_exp_f32 v130, v18
    v_mfma_f32_16x16x32_bf16 v[56:59], a[200:203], a[184:187], v[56:59]
    v_exp_f32_e64 v131, v19
    v_mfma_f32_16x16x32_bf16 v[56:59], a[204:207], a[188:191], v[56:59]
    v_cvt_pk_bf16_f32 v104, v128, v129
    s_waitcnt lgkmcnt(8)
    v_mfma_f32_16x16x32_bf16 v[52:55], a[208:211], a[160:163], v[84:87]
    s_waitcnt vmcnt(14)
    s_barrier
    v_add_u32 v241, s35, v240
    ds_read_b128 a[192:195], v241 offset:0
    v_mfma_f32_16x16x32_bf16 v[52:55], a[212:215], a[164:167], v[52:55]
    s_add_u32 m0, s34, 16384
    s_add_u32 s34, s34, 32768
    v_mfma_f32_16x16x32_bf16 v[52:55], a[216:219], a[168:171], v[52:55]
    ds_read_b128 a[196:199], v241 offset:2048
    v_cvt_pk_bf16_f32 v105, v130, v131
    v_mfma_f32_16x16x32_bf16 v[52:55], a[220:223], a[172:175], v[52:55]
    s_cmp_ge_u32 s34, 163840
    s_cselect_b32 s34, s37, s34
    v_mfma_f32_16x16x32_bf16 v[60:63], a[208:211], a[176:179], v[92:95]
    ds_read_b128 a[200:203], v241 offset:4096
    ds_read_b128 a[204:207], v241 offset:6144
    v_mfma_f32_16x16x32_bf16 v[60:63], a[212:215], a[180:183], v[60:63]
    v_exp_f32 v132, v20
    v_mfma_f32_16x16x32_bf16 v[60:63], a[216:219], a[184:187], v[60:63]
    v_exp_f32_e64 v133, v21
    v_mfma_f32_16x16x32_bf16 v[60:63], a[220:223], a[188:191], v[60:63]
    v_cvt_pk_bf16_f32 v106, v132, v133
    s_waitcnt lgkmcnt(8)
    v_mfma_f32_16x16x32_bf16 a[0:3], a[224:227], v[112:115], a[0:3]
    ds_read_b128 a[208:211], v241 offset:1024
    v_or3_b32 v208, v104, v105, v106
    v_mfma_f32_16x16x32_bf16 a[32:35], a[224:227], v[116:119], a[32:35]
    v_exp_f32 v134, v22
    v_mfma_f32_16x16x32_bf16 a[64:67], a[224:227], v[120:123], a[64:67]
    buffer_load_dwordx4 v242, s[16:19], s42 offen offset:0 sc1 lds
    v_mfma_f32_16x16x32_bf16 a[96:99], a[224:227], v[124:127], a[96:99]
    v_exp_f32_e64 v135, v23
    v_mfma_f32_16x16x32_bf16 a[4:7], a[228:231], v[112:115], a[4:7]
    ds_read_b128 a[212:215], v241 offset:3072
    v_cvt_pk_bf16_f32 v107, v134, v135
    v_mfma_f32_16x16x32_bf16 a[36:39], a[228:231], v[116:119], a[36:39]
    v_exp_f32_e64 v136, v24
    v_mfma_f32_16x16x32_bf16 a[68:71], a[228:231], v[120:123], a[68:71]
    v_exp_f32_e64 v137, v25
    v_mfma_f32_16x16x32_bf16 a[100:103], a[228:231], v[124:127], a[100:103]
    v_exp_f32_e64 v138, v26
    v_mfma_f32_16x16x32_bf16 a[8:11], a[232:235], v[112:115], a[8:11]
    ds_read_b128 a[216:219], v241 offset:5120
    v_cvt_pk_bf16_f32 v108, v136, v137
    v_mfma_f32_16x16x32_bf16 a[40:43], a[232:235], v[116:119], a[40:43]
    buffer_load_dwordx4 v242, s[16:19], s42 offen offset:1024 sc1 lds
    v_or3_b32 v208, v208, v107, v108
    v_mfma_f32_16x16x32_bf16 a[72:75], a[232:235], v[120:123], a[72:75]
    v_exp_f32_e64 v139, v27
    v_mfma_f32_16x16x32_bf16 a[104:107], a[232:235], v[124:127], a[104:107]
    v_exp_f32_e64 v140, v28
    v_mfma_f32_16x16x32_bf16 a[12:15], a[236:239], v[112:115], a[12:15]
    ds_read_b128 a[220:223], v241 offset:7168
    v_cvt_pk_bf16_f32 v109, v138, v139
    v_mfma_f32_16x16x32_bf16 a[44:47], a[236:239], v[116:119], a[44:47]
    v_exp_f32_e64 v141, v29
    v_mfma_f32_16x16x32_bf16 a[76:79], a[236:239], v[120:123], a[76:79]
    v_exp_f32_e64 v142, v30
    v_mfma_f32_16x16x32_bf16 a[108:111], a[236:239], v[124:127], a[108:111]
    v_cvt_pk_bf16_f32 v110, v140, v141
    s_waitcnt lgkmcnt(8)
    v_mfma_f32_16x16x32_bf16 a[16:19], a[240:243], v[112:115], a[16:19]
    ds_read_b128 a[224:227], v241 offset:16384
    v_or3_b32 v208, v208, v109, v110
    v_mfma_f32_16x16x32_bf16 a[48:51], a[240:243], v[116:119], a[48:51]
    buffer_load_dwordx4 v242, s[16:19], s42 offen offset:2048 sc1 lds
    v_mfma_f32_16x16x32_bf16 a[80:83], a[240:243], v[120:123], a[80:83]
    v_exp_f32 v143, v31
    v_mfma_f32_16x16x32_bf16 a[112:115], a[240:243], v[124:127], a[112:115]
    v_cvt_pk_bf16_f32 v111, v142, v143
    v_or_b32_e64 v208, v208, v111
    v_mfma_f32_16x16x32_bf16 a[20:23], a[244:247], v[112:115], a[20:23]
    ds_read_b128 a[228:231], v241 offset:17408
    v_and_b32_e64 v208, s38, v208
    v_mfma_f32_16x16x32_bf16 a[52:55], a[244:247], v[116:119], a[52:55]
    v_cmp_ne_u32_e64 vcc, 0, v208
    buffer_load_dwordx4 v242, s[16:19], s42 offen offset:3072 sc1 lds
    v_mfma_f32_16x16x32_bf16 a[84:87], a[244:247], v[120:123], a[84:87]
    s_add_u32 s42, s42, 34048
    v_mfma_f32_16x16x32_bf16 a[116:119], a[244:247], v[124:127], a[116:119]
    v_mfma_f32_16x16x32_bf16 a[24:27], a[248:251], v[112:115], a[24:27]
    ds_read_b128 a[232:235], v241 offset:18432
    v_mfma_f32_16x16x32_bf16 a[56:59], a[248:251], v[116:119], a[56:59]
    v_mfma_f32_16x16x32_bf16 a[88:91], a[248:251], v[120:123], a[88:91]
    v_mfma_f32_16x16x32_bf16 a[120:123], a[248:251], v[124:127], a[120:123]
    v_mfma_f32_16x16x32_bf16 a[28:31], a[252:255], v[112:115], a[28:31]
    ds_read_b128 a[236:239], v241 offset:19456
    v_mfma_f32_16x16x32_bf16 a[60:63], a[252:255], v[116:119], a[60:63]
    v_mfma_f32_16x16x32_bf16 a[92:95], a[252:255], v[120:123], a[92:95]
    v_mfma_f32_16x16x32_bf16 a[124:127], a[252:255], v[124:127], a[124:127]
    v_mfma_f32_16x16x32_bf16 v[144:147], v[204:207], v[112:115], v[144:147]
    v_mfma_f32_16x16x32_bf16 v[148:151], v[204:207], v[116:119], v[148:151]
    v_mfma_f32_16x16x32_bf16 v[152:155], v[204:207], v[120:123], v[152:155]
    v_mfma_f32_16x16x32_bf16 v[156:159], v[204:207], v[124:127], v[156:159]
    s_cbranch_vccnz kf_rare18
kf_rr17:
    s_nop 6
    v_rcp_f32 v230, v144
    v_rcp_f32 v231, v148
    v_accvgpr_read_b32 v160, a0
    v_accvgpr_read_b32 v161, a1
    v_accvgpr_read_b32 v162, a2
    v_accvgpr_read_b32 v163, a3
    v_accvgpr_read_b32 v164, a4
    v_accvgpr_read_b32 v165, a5
    v_accvgpr_read_b32 v166, a6
    v_accvgpr_read_b32 v167, a7
    v_mul_f32 v160, v160, v230
    v_mul_f32 v161, v161, v230
    v_mul_f32 v162, v162, v230
    v_mul_f32 v163, v163, v230
    v_mul_f32 v164, v164, v230
    v_mul_f32 v165, v165, v230
    v_mul_f32 v166, v166, v230
    v_mul_f32 v167, v167, v230
    v_cvt_pk_bf16_f32 v176, v160, v161
    v_cvt_pk_bf16_f32 v177, v162, v163
    v_cvt_pk_bf16_f32 v178, v164, v165
    v_cvt_pk_bf16_f32 v179, v166, v167
    buffer_store_dwordx4 v[176:179], v240, s[20:23], s39 offen offset:0 sc1
    v_accvgpr_read_b32 v168, a8
    v_accvgpr_read_b32 v169, a9
    v_accvgpr_read_b32 v170, a10
    v_accvgpr_read_b32 v171, a11
    v_accvgpr_read_b32 v172, a12
    v_accvgpr_read_b32 v173, a13
    v_accvgpr_read_b32 v174, a14
    v_accvgpr_read_b32 v175, a15
    v_mul_f32 v168, v168, v230
    v_mul_f32 v169, v169, v230
    v_mul_f32 v170, v170, v230
    v_mul_f32 v171, v171, v230
    v_mul_f32 v172, v172, v230
    v_mul_f32 v173, v173, v230
    v_mul_f32 v174, v174, v230
    v_mul_f32 v175, v175, v230
    v_cvt_pk_bf16_f32 v180, v168, v169
    v_cvt_pk_bf16_f32 v181, v170, v171
    v_cvt_pk_bf16_f32 v182, v172, v173
    v_cvt_pk_bf16_f32 v183, v174, v175
    buffer_store_dwordx4 v[180:183], v240, s[20:23], s39 offen offset:1024 sc1
    v_accvgpr_read_b32 v160, a16
    v_accvgpr_read_b32 v161, a17
    v_accvgpr_read_b32 v162, a18
    v_accvgpr_read_b32 v163, a19
    v_accvgpr_read_b32 v164, a20
    v_accvgpr_read_b32 v165, a21
    v_accvgpr_read_b32 v166, a22
    v_accvgpr_read_b32 v167, a23
    v_mul_f32 v160, v160, v230
    v_mul_f32 v161, v161, v230
    v_mul_f32 v162, v162, v230
    v_mul_f32 v163, v163, v230
    v_mul_f32 v164, v164, v230
    v_mul_f32 v165, v165, v230
    v_mul_f32 v166, v166, v230
    v_mul_f32 v167, v167, v230
    v_cvt_pk_bf16_f32 v184, v160, v161
    v_cvt_pk_bf16_f32 v185, v162, v163
    v_cvt_pk_bf16_f32 v186, v164, v165
    v_cvt_pk_bf16_f32 v187, v166, v167
    buffer_store_dwordx4 v[184:187], v240, s[20:23], s39 offen offset:2048 sc1
    v_accvgpr_read_b32 v168, a24
    v_accvgpr_read_b32 v169, a25
    v_accvgpr_read_b32 v170, a26
    v_accvgpr_read_b32 v171, a27
    v_accvgpr_read_b32 v172, a28
    v_accvgpr_read_b32 v173, a29
    v_accvgpr_read_b32 v174, a30
    v_accvgpr_read_b32 v175, a31
    v_mul_f32 v168, v168, v230
    v_mul_f32 v169, v169, v230
    v_mul_f32 v170, v170, v230
    v_mul_f32 v171, v171, v230
    v_mul_f32 v172, v172, v230
    v_mul_f32 v173, v173, v230
    v_mul_f32 v174, v174, v230
    v_mul_f32 v175, v175, v230
    v_cvt_pk_bf16_f32 v188, v168, v169
    v_cvt_pk_bf16_f32 v189, v170, v171
    v_cvt_pk_bf16_f32 v190, v172, v173
    v_cvt_pk_bf16_f32 v191, v174, v175
    buffer_store_dwordx4 v[188:191], v240, s[20:23], s39 offen offset:3072 sc1
    v_accvgpr_read_b32 v160, a32
    v_accvgpr_read_b32 v161, a33
    v_accvgpr_read_b32 v162, a34
    v_accvgpr_read_b32 v163, a35
    v_accvgpr_read_b32 v164, a36
    v_accvgpr_read_b32 v165, a37
    v_accvgpr_read_b32 v166, a38
    v_accvgpr_read_b32 v167, a39
    v_mul_f32 v160, v160, v231
    v_mul_f32 v161, v161, v231
    v_mul_f32 v162, v162, v231
    v_mul_f32 v163, v163, v231
    v_mul_f32 v164, v164, v231
    v_mul_f32 v165, v165, v231
    v_mul_f32 v166, v166, v231
    v_mul_f32 v167, v167, v231
    v_cvt_pk_bf16_f32 v176, v160, v161
    v_cvt_pk_bf16_f32 v177, v162, v163
    v_cvt_pk_bf16_f32 v178, v164, v165
    v_cvt_pk_bf16_f32 v179, v166, v167
    buffer_store_dwordx4 v[176:179], v244, s[20:23], s39 offen offset:0 sc1
    v_accvgpr_read_b32 v168, a40
    v_accvgpr_read_b32 v169, a41
    v_accvgpr_read_b32 v170, a42
    v_accvgpr_read_b32 v171, a43
    v_accvgpr_read_b32 v172, a44
    v_accvgpr_read_b32 v173, a45
    v_accvgpr_read_b32 v174, a46
    v_accvgpr_read_b32 v175, a47
    v_mul_f32 v168, v168, v231
    v_mul_f32 v169, v169, v231
    v_mul_f32 v170, v170, v231
    v_mul_f32 v171, v171, v231
    v_mul_f32 v172, v172, v231
    v_mul_f32 v173, v173, v231
    v_mul_f32 v174, v174, v231
    v_mul_f32 v175, v175, v231
    v_cvt_pk_bf16_f32 v180, v168, v169
    v_cvt_pk_bf16_f32 v181, v170, v171
    v_cvt_pk_bf16_f32 v182, v172, v173
    v_cvt_pk_bf16_f32 v183, v174, v175
    buffer_store_dwordx4 v[180:183], v244, s[20:23], s39 offen offset:1024 sc1
    v_accvgpr_read_b32 v160, a48
    v_accvgpr_read_b32 v161, a49
    v_accvgpr_read_b32 v162, a50
    v_accvgpr_read_b32 v163, a51
    v_accvgpr_read_b32 v164, a52
    v_accvgpr_read_b32 v165, a53
    v_accvgpr_read_b32 v166, a54
    v_accvgpr_read_b32 v167, a55
    v_mul_f32 v160, v160, v231
    v_mul_f32 v161, v161, v231
    v_mul_f32 v162, v162, v231
    v_mul_f32 v163, v163, v231
    v_mul_f32 v164, v164, v231
    v_mul_f32 v165, v165, v231
    v_mul_f32 v166, v166, v231
    v_mul_f32 v167, v167, v231
    v_cvt_pk_bf16_f32 v184, v160, v161
    v_cvt_pk_bf16_f32 v185, v162, v163
    v_cvt_pk_bf16_f32 v186, v164, v165
    v_cvt_pk_bf16_f32 v187, v166, v167
    buffer_store_dwordx4 v[184:187], v244, s[20:23], s39 offen offset:2048 sc1
    v_accvgpr_read_b32 v168, a56
    v_accvgpr_read_b32 v169, a57
    v_accvgpr_read_b32 v170, a58
    v_accvgpr_read_b32 v171, a59
    v_accvgpr_read_b32 v172, a60
    v_accvgpr_read_b32 v173, a61
    v_accvgpr_read_b32 v174, a62
    v_accvgpr_read_b32 v175, a63
    v_mul_f32 v168, v168, v231
    v_mul_f32 v169, v169, v231
    v_mul_f32 v170, v170, v231
    v_mul_f32 v171, v171, v231
    v_mul_f32 v172, v172, v231
    v_mul_f32 v173, v173, v231
    v_mul_f32 v174, v174, v231
    v_mul_f32 v175, v175, v231
    v_cvt_pk_bf16_f32 v188, v168, v169
    v_cvt_pk_bf16_f32 v189, v170, v171
    v_cvt_pk_bf16_f32 v190, v172, v173
    v_cvt_pk_bf16_f32 v191, v174, v175
    buffer_store_dwordx4 v[188:191], v244, s[20:23], s39 offen offset:3072 sc1
ka_noe0:
    s_lshl1_add_u32 s26, s5, s31
    s_lshl_b32 s26, s26, 1
    s_sub_u32 s26, 30, s26
    s_branch ka_p2_e
.p2align 5
ka_p2:
    s_sub_u32 s36, s36, 1
    s_cbranch_scc1 kf_fix23
kf_fixr24:
    s_waitcnt lgkmcnt(8)
    v_mfma_f32_16x16x32_bf16 v[16:19], a[192:195], a[160:163], v[80:83]
    ds_read_b128 a[240:243], v241 offset:20480
    ds_read_b128 a[244:247], v241 offset:21504
    v_mfma_f32_16x16x32_bf16 v[16:19], a[196:199], a[164:167], v[16:19]
    v_exp_f32 v128, v48
    v_mfma_f32_16x16x32_bf16 v[16:19], a[200:203], a[168:171], v[16:19]
    s_mov_b32 m0, s34
    v_exp_f32 v129, v49
    v_mfma_f32_16x16x32_bf16 v[16:19], a[204:207], a[172:175], v[16:19]
    v_exp_f32_e64 v130, v50
    v_mfma_f32_16x16x32_bf16 v[24:27], a[192:195], a[176:179], v[88:91]
    ds_read_b128 a[248:251], v241 offset:22528
    ds_read_b128 a[252:255], v241 offset:23552
    v_mfma_f32_16x16x32_bf16 v[24:27], a[196:199], a[180:183], v[24:27]
    s_add_u32 s41, s42, 17664
    v_cvt_pk_bf16_f32 v120, v128, v129
    v_mfma_f32_16x16x32_bf16 v[24:27], a[200:203], a[184:187], v[24:27]
    buffer_load_dwordx4 v242, s[16:19], s41 offen offset:0 sc1 lds
    v_exp_f32_e64 v131, v51
    v_mfma_f32_16x16x32_bf16 v[24:27], a[204:207], a[188:191], v[24:27]
    v_cvt_pk_bf16_f32 v121, v130, v131
    s_waitcnt lgkmcnt(8)
    v_mfma_f32_16x16x32_bf16 v[20:23], a[208:211], a[160:163], v[84:87]
    ds_read_b128 a[192:195], v241 offset:8192
    ds_read_b128 a[196:199], v241 offset:10240
    v_mfma_f32_16x16x32_bf16 v[20:23], a[212:215], a[164:167], v[20:23]
    v_exp_f32 v132, v52
    v_mfma_f32_16x16x32_bf16 v[20:23], a[216:219], a[168:171], v[20:23]
    v_exp_f32_e64 v133, v53
    buffer_load_dwordx4 v242, s[16:19], s41 offen offset:1024 sc1 lds
    v_mfma_f32_16x16x32_bf16 v[20:23], a[220:223], a[172:175], v[20:23]
    v_exp_f32_e64 v134, v54
    v_mfma_f32_16x16x32_bf16 v[28:31], a[208:211], a[176:179], v[92:95]
    ds_read_b128 a[200:203], v241 offset:12288
    ds_read_b128 a[204:207], v241 offset:14336
    v_mfma_f32_16x16x32_bf16 v[28:31], a[212:215], a[180:183], v[28:31]
    v_exp_f32_e64 v135, v55
    v_mfma_f32_16x16x32_bf16 v[28:31], a[216:219], a[184:187], v[28:31]
    v_exp_f32_e64 v136, v56
    v_cvt_pk_bf16_f32 v122, v132, v133
    v_mfma_f32_16x16x32_bf16 v[28:31], a[220:223], a[188:191], v[28:31]
    v_or3_b32 v208, v120, v121, v122
    s_waitcnt lgkmcnt(8)
    v_mfma_f32_16x16x32_bf16 a[64:67], a[224:227], v[104:107], a[64:67]
    ds_read_b128 a[208:211], v241 offset:9216
    ds_read_b128 a[212:215], v241 offset:11264
    v_mfma_f32_16x16x32_bf16 a[96:99], a[224:227], v[108:111], a[96:99]
    v_exp_f32 v137, v57
    v_mfma_f32_16x16x32_bf16 a[68:71], a[228:231], v[104:107], a[68:71]
    v_exp_f32_e64 v138, v58
    v_mfma_f32_16x16x32_bf16 a[100:103], a[228:231], v[108:111], a[100:103]
    buffer_load_dwordx4 v242, s[16:19], s41 offen offset:2048 sc1 lds
    v_exp_f32_e64 v139, v59
    v_mfma_f32_16x16x32_bf16 a[72:75], a[232:235], v[104:107], a[72:75]
    ds_read_b128 a[216:219], v241 offset:13312
    ds_read_b128 a[220:223], v241 offset:15360
    v_mfma_f32_16x16x32_bf16 a[104:107], a[232:235], v[108:111], a[104:107]
    v_exp_f32_e64 v140, v60
    v_mfma_f32_16x16x32_bf16 a[76:79], a[236:239], v[104:107], a[76:79]
    buffer_load_dwordx4 v242, s[16:19], s41 offen offset:3072 sc1 lds
    v_cvt_pk_bf16_f32 v123, v134, v135
    v_mfma_f32_16x16x32_bf16 a[108:111], a[236:239], v[108:111], a[108:111]
    v_exp_f32 v141, v61
    s_waitcnt lgkmcnt(8)
    v_mfma_f32_16x16x32_bf16 a[80:83], a[240:243], v[104:107], a[80:83]
    ds_read_b128 a[224:227], v241 offset:24576
    ds_read_b128 a[228:231], v241 offset:25600
    v_mfma_f32_16x16x32_bf16 a[112:115], a[240:243], v[108:111], a[112:115]
    v_cvt_pk_bf16_f32 v124, v136, v137
    v_or3_b32 v208, v208, v123, v124
    v_mfma_f32_16x16x32_bf16 a[84:87], a[244:247], v[104:107], a[84:87]
    v_exp_f32_e64 v142, v62
    v_mfma_f32_16x16x32_bf16 a[116:119], a[244:247], v[108:111], a[116:119]
    s_add_u32 s35, s35, 32768
    s_cmp_ge_u32 s35, 163840
    s_cselect_b32 s35, 0, s35
    v_mfma_f32_16x16x32_bf16 a[88:91], a[248:251], v[104:107], a[88:91]
    ds_read_b128 a[232:235], v241 offset:26624
    ds_read_b128 a[236:239], v241 offset:27648
    v_mfma_f32_16x16x32_bf16 a[120:123], a[248:251], v[108:111], a[120:123]
    v_exp_f32 v143, v63
    v_mfma_f32_16x16x32_bf16 a[92:95], a[252:255], v[104:107], a[92:95]
    v_cvt_pk_bf16_f32 v125, v138, v139
    v_cvt_pk_bf16_f32 v126, v140, v141
    v_mfma_f32_16x16x32_bf16 a[124:127], a[252:255], v[108:111], a[124:127]
    v_or3_b32 v208, v208, v125, v126
    v_cvt_pk_bf16_f32 v127, v142, v143
    v_or_b32_e64 v208, v208, v127
    v_mfma_f32_16x16x32_bf16 v[152:155], v[204:207], v[104:107], v[152:155]
    v_and_b32 v208, s38, v208
    v_cmp_ne_u32 vcc, 0, v208
    v_mfma_f32_16x16x32_bf16 v[156:159], v[204:207], v[108:111], v[156:159]
    s_cbranch_vccnz kf_rare22
kf_rr21:
    s_sub_u32 s36, s36, 1
    s_cbranch_scc1 kf_fix27
kf_fixr28:
    s_waitcnt lgkmcnt(8)
    v_mfma_f32_16x16x32_bf16 v[48:51], a[192:195], a[160:163], v[80:83]
    ds_read_b128 a[240:243], v241 offset:28672
    ds_read_b128 a[244:247], v241 offset:29696
    v_mfma_f32_16x16x32_bf16 v[48:51], a[196:199], a[164:167], v[48:51]
    s_add_u32 m0, s34, 16384
    v_exp_f32_e64 v128, v16
    v_mfma_f32_16x16x32_bf16 v[48:51], a[200:203], a[168:171], v[48:51]
    v_exp_f32_e64 v129, v17
    v_mfma_f32_16x16x32_bf16 v[48:51], a[204:207], a[172:175], v[48:51]
    v_exp_f32_e64 v130, v18
    v_mfma_f32_16x16x32_bf16 v[56:59], a[192:195], a[176:179], v[88:91]
    ds_read_b128 a[248:251], v241 offset:30720
    ds_read_b128 a[252:255], v241 offset:31744
    s_add_u32 s34, s34, 32768
    v_mfma_f32_16x16x32_bf16 v[56:59], a[196:199], a[180:183], v[56:59]
    s_cmp_ge_u32 s34, 163840
    s_cselect_b32 s34, s37, s34
    v_mfma_f32_16x16x32_bf16 v[56:59], a[200:203], a[184:187], v[56:59]
    v_exp_f32 v131, v19
    v_mfma_f32_16x16x32_bf16 v[56:59], a[204:207], a[188:191], v[56:59]
    v_exp_f32 v132, v20
    s_waitcnt lgkmcnt(8)
    v_mfma_f32_16x16x32_bf16 v[52:55], a[208:211], a[160:163], v[84:87]
    s_waitcnt vmcnt(12)
    s_barrier
    v_add_u32_e64 v241, s35, v240
    ds_read_b128 a[192:195], v241 offset:0
    v_mfma_f32_16x16x32_bf16 v[52:55], a[212:215], a[164:167], v[52:55]
    v_exp_f32_e64 v133, v21
    v_mfma_f32_16x16x32_bf16 v[52:55], a[216:219], a[168:171], v[52:55]
    ds_read_b128 a[196:199], v241 offset:2048
    buffer_load_dwordx4 v242, s[16:19], s42 offen offset:0 sc1 lds
    v_mfma_f32_16x16x32_bf16 v[52:55], a[220:223], a[172:175], v[52:55]
    v_exp_f32_e64 v134, v22
    v_cvt_pk_bf16_f32 v104, v128, v129
    v_mfma_f32_16x16x32_bf16 v[60:63], a[208:211], a[176:179], v[92:95]
    ds_read_b128 a[200:203], v241 offset:4096
    ds_read_b128 a[204:207], v241 offset:6144
    v_mfma_f32_16x16x32_bf16 v[60:63], a[212:215], a[180:183], v[60:63]
    v_exp_f32_e64 v135, v23
    v_mfma_f32_16x16x32_bf16 v[60:63], a[216:219], a[184:187], v[60:63]
    buffer_load_dwordx4 v242, s[16:19], s42 offen offset:1024 sc1 lds
    v_exp_f32_e64 v136, v24
    v_mfma_f32_16x16x32_bf16 v[60:63], a[220:223], a[188:191], v[60:63]
    v_cvt_pk_bf16_f32 v105, v130, v131
    s_waitcnt lgkmcnt(8)
    v_mfma_f32_16x16x32_bf16 a[64:67], a[224:227], v[120:123], a[64:67]
    ds_read_b128 a[208:211], v241 offset:1024
    ds_read_b128 a[212:215], v241 offset:3072
    v_mfma_f32_16x16x32_bf16 a[96:99], a[224:227], v[124:127], a[96:99]
    v_exp_f32 v137, v25
    v_mfma_f32_16x16x32_bf16 a[68:71], a[228:231], v[120:123], a[68:71]
    v_cvt_pk_bf16_f32 v106, v132, v133
    v_exp_f32_e64 v138, v26
    v_mfma_f32_16x16x32_bf16 a[100:103], a[228:231], v[124:127], a[100:103]
    v_exp_f32_e64 v139, v27
    v_mfma_f32_16x16x32_bf16 a[72:75], a[232:235], v[120:123], a[72:75]
    ds_read_b128 a[216:219], v241 offset:5120
    ds_read_b128 a[220:223], v241 offset:7168
    v_mfma_f32_16x16x32_bf16 a[104:107], a[232:235], v[124:127], a[104:107]
    buffer_load_dwordx4 v242, s[16:19], s42 offen offset:2048 sc1 lds
    v_or3_b32 v208, v104, v105, v106
    v_cvt_pk_bf16_f32 v107, v134, v135
    v_mfma_f32_16x16x32_bf16 a[76:79], a[236:239], v[120:123], a[76:79]
    v_exp_f32_e64 v140, v28
    v_mfma_f32_16x16x32_bf16 a[108:111], a[236:239], v[124:127], a[108:111]
    v_cvt_pk_bf16_f32 v108, v136, v137
    s_waitcnt lgkmcnt(8)
    v_mfma_f32_16x16x32_bf16 a[80:83], a[240:243], v[120:123], a[80:83]
    ds_read_b128 a[224:227], v241 offset:16384
    ds_read_b128 a[228:231], v241 offset:17408
    v_or3_b32 v208, v208, v107, v108
    v_mfma_f32_16x16x32_bf16 a[112:115], a[240:243], v[124:127], a[112:115]
    v_exp_f32 v141, v29
    v_mfma_f32_16x16x32_bf16 a[84:87], a[244:247], v[120:123], a[84:87]
    v_exp_f32_e64 v142, v30
    v_mfma_f32_16x16x32_bf16 a[116:119], a[244:247], v[124:127], a[116:119]
    v_exp_f32_e64 v143, v31
    v_mfma_f32_16x16x32_bf16 a[88:91], a[248:251], v[120:123], a[88:91]
    ds_read_b128 a[232:235], v241 offset:18432
    ds_read_b128 a[236:239], v241 offset:19456
    buffer_load_dwordx4 v242, s[16:19], s42 offen offset:3072 sc1 lds
    v_mfma_f32_16x16x32_bf16 a[120:123], a[248:251], v[124:127], a[120:123]
    s_add_u32 s42, s42, 34048
    v_cvt_pk_bf16_f32 v109, v138, v139
    v_mfma_f32_16x16x32_bf16 a[92:95], a[252:255], v[120:123], a[92:95]
    v_cvt_pk_bf16_f32 v110, v140, v141
    v_or3_b32 v208, v208, v109, v110
    v_mfma_f32_16x16x32_bf16 a[124:127], a[252:255], v[124:127], a[124:127]
    v_cvt_pk_bf16_f32 v111, v142, v143
    v_or_b32 v208, v208, v111
    v_and_b32 v208, s38, v208
    v_mfma_f32_16x16x32_bf16 v[152:155], v[204:207], v[120:123], v[152:155]
    v_cmp_ne_u32_e64 vcc, 0, v208
    v_mfma_f32_16x16x32_bf16 v[156:159], v[204:207], v[124:127], v[156:159]
    s_cbranch_vccnz kf_rare26
kf_rr25:
ka_p2_e:
    s_sub_u32 s26, s26, 1
    s_cbranch_scc0 ka_p2
    s_branch ka_p2_x
kf_fix23:
    s_mov_b32 s24, 0
    s_branch kf_fix23c
kf_fix27:
    s_mov_b32 s24, 1
kf_fix23c:
    s_cmp_eq_u32 s33, 0
    s_cbranch_scc0 kf_fix23f
    s_mov_b32 s36, 0
    s_mov_b32 s33, 1
    v_add_f32 v80, v226, v200
    v_add_f32 v81, v226, v201
    v_add_f32 v82, v226, v202
    v_add_f32 v83, v226, v203
    v_add_f32 v84, v226, v209
    v_add_f32 v85, v226, v210
    v_add_f32 v86, v226, v211
    v_add_f32 v87, v226, v212
    v_add_f32 v88, v227, v213
    v_add_f32 v89, v227, v214
    v_add_f32 v90, v227, v215
    v_add_f32 v91, v227, v216
    v_add_f32 v92, v227, v217
    v_add_f32 v93, v227, v218
    v_add_f32 v94, v227, v219
    v_add_f32 v95, v227, v220
    s_cmp_eq_u32 s24, 0
    s_cbranch_scc1 kf_fixr24
    s_branch kf_fixr28
kf_fix23f:
    s_mov_b32 s36, 0x1000
    v_mov_b32 v80, 0xf1800000
    v_mov_b32 v81, v80
    v_mov_b32 v82, v80
    v_mov_b32 v83, v80
    v_mov_b32 v84, v80
    v_mov_b32 v85, v80
    v_mov_b32 v86, v80
    v_mov_b32 v87, v80
    v_mov_b32 v88, v80
    v_mov_b32 v89, v80
    v_mov_b32 v90, v80
    v_mov_b32 v91, v80
    v_mov_b32 v92, v80
    v_mov_b32 v93, v80
    v_mov_b32 v94, v80
    v_mov_b32_e64 v95, v80
    s_cmp_eq_u32 s24, 0
    s_cbranch_scc1 kf_fixr24
    s_branch kf_fixr28
ka_p2_x:
    s_waitcnt lgkmcnt(0)
    ds_read_b128 a[224:227], v241 offset:16384
    ds_read_b128 a[228:231], v241 offset:17408
    ds_read_b128 a[232:235], v241 offset:18432
    ds_read_b128 a[236:239], v241 offset:19456
    ds_read_b128 a[240:243], v241 offset:20480
    ds_read_b128 a[244:247], v241 offset:21504
    ds_read_b128 a[248:251], v241 offset:22528
    ds_read_b128 a[252:255], v241 offset:23552
    ds_read_b128 a[192:195], v241 offset:24576
    ds_read_b128 a[196:199], v241 offset:25600
    ds_read_b128 a[200:203], v241 offset:26624
    ds_read_b128 a[204:207], v241 offset:27648
    ds_read_b128 a[208:211], v241 offset:28672
    ds_read_b128 a[212:215], v241 offset:29696
    ds_read_b128 a[216:219], v241 offset:30720
    s_waitcnt lgkmcnt(7)
    ds_read_b128 a[220:223], v241 offset:31744
    v_mfma_f32_16x16x32_bf16 a[64:67], a[224:227], v[104:107], a[64:67]
    v_exp_f32 v128, v48
    v_exp_f32_e64 v129, v49
    v_mfma_f32_16x16x32_bf16 a[96:99], a[224:227], v[108:111], a[96:99]
    v_exp_f32_e64 v130, v50
    v_cvt_pk_bf16_f32 v120, v128, v129
    v_mfma_f32_16x16x32_bf16 a[68:71], a[228:231], v[104:107], a[68:71]
    v_exp_f32_e64 v131, v51
    v_mfma_f32_16x16x32_bf16 a[100:103], a[228:231], v[108:111], a[100:103]
    v_exp_f32_e64 v132, v52
    v_cvt_pk_bf16_f32 v121, v130, v131
    v_mfma_f32_16x16x32_bf16 a[72:75], a[232:235], v[104:107], a[72:75]
    v_exp_f32_e64 v133, v53
    v_mfma_f32_16x16x32_bf16 a[104:107], a[232:235], v[108:111], a[104:107]
    v_exp_f32_e64 v134, v54
    v_cvt_pk_bf16_f32 v122, v132, v133
    v_mfma_f32_16x16x32_bf16 a[76:79], a[236:239], v[104:107], a[76:79]
    v_exp_f32_e64 v135, v55
    v_or3_b32 v208, v120, v121, v122
    v_mfma_f32_16x16x32_bf16 a[108:111], a[236:239], v[108:111], a[108:111]
    v_exp_f32_e64 v136, v56
    v_cvt_pk_bf16_f32 v123, v134, v135
    v_mfma_f32_16x16x32_bf16 a[80:83], a[240:243], v[104:107], a[80:83]
    v_exp_f32_e64 v137, v57
    v_mfma_f32_16x16x32_bf16 a[112:115], a[240:243], v[108:111], a[112:115]
    v_exp_f32_e64 v138, v58
    v_cvt_pk_bf16_f32 v124, v136, v137
    v_mfma_f32_16x16x32_bf16 a[84:87], a[244:247], v[104:107], a[84:87]
    v_exp_f32_e64 v139, v59
    v_or3_b32 v208, v208, v123, v124
    v_mfma_f32_16x16x32_bf16 a[116:119], a[244:247], v[108:111], a[116:119]
    v_exp_f32_e64 v140, v60
    v_cvt_pk_bf16_f32 v125, v138, v139
    v_mfma_f32_16x16x32_bf16 a[88:91], a[248:251], v[104:107], a[88:91]
    v_exp_f32_e64 v141, v61
    v_mfma_f32_16x16x32_bf16 a[120:123], a[248:251], v[108:111], a[120:123]
    v_exp_f32_e64 v142, v62
    v_cvt_pk_bf16_f32 v126, v140, v141
    v_mfma_f32_16x16x32_bf16 a[92:95], a[252:255], v[104:107], a[92:95]
    v_exp_f32_e64 v143, v63
    v_or3_b32 v208, v208, v125, v126
    v_mfma_f32_16x16x32_bf16 a[124:127], a[252:255], v[108:111], a[124:127]
    v_cvt_pk_bf16_f32 v127, v142, v143
    v_or_b32 v208, v208, v127
    v_and_b32 v208, s38, v208
    v_mfma_f32_16x16x32_bf16 v[152:155], v[204:207], v[104:107], v[152:155]
    v_cmp_ne_u32_e64 vcc, 0, v208
    v_mfma_f32_16x16x32_bf16 v[156:159], v[204:207], v[108:111], v[156:159]
    s_cbranch_vccnz kf_rare30
kf_rr29:
    s_waitcnt lgkmcnt(0)
    s_nop 0
    v_mfma_f32_16x16x32_bf16 a[64:67], a[192:195], v[120:123], a[64:67]
    v_mfma_f32_16x16x32_bf16 a[96:99], a[192:195], v[124:127], a[96:99]
    v_mfma_f32_16x16x32_bf16 a[68:71], a[196:199], v[120:123], a[68:71]
    v_mfma_f32_16x16x32_bf16 a[100:103], a[196:199], v[124:127], a[100:103]
    v_mfma_f32_16x16x32_bf16 a[72:75], a[200:203], v[120:123], a[72:75]
    v_mfma_f32_16x16x32_bf16 a[104:107], a[200:203], v[124:127], a[104:107]
    v_mfma_f32_16x16x32_bf16 a[76:79], a[204:207], v[120:123], a[76:79]
    v_mfma_f32_16x16x32_bf16 a[108:111], a[204:207], v[124:127], a[108:111]
    v_mfma_f32_16x16x32_bf16 a[80:83], a[208:211], v[120:123], a[80:83]
    v_mfma_f32_16x16x32_bf16 a[112:115], a[208:211], v[124:127], a[112:115]
    v_mfma_f32_16x16x32_bf16 a[84:87], a[212:215], v[120:123], a[84:87]
    v_mfma_f32_16x16x32_bf16 a[116:119], a[212:215], v[124:127], a[116:119]
    v_mfma_f32_16x16x32_bf16 a[88:91], a[216:219], v[120:123], a[88:91]
    v_mfma_f32_16x16x32_bf16 a[120:123], a[216:219], v[124:127], a[120:123]
    v_mfma_f32_16x16x32_bf16 a[92:95], a[220:223], v[120:123], a[92:95]
    v_mfma_f32_16x16x32_bf16 a[124:127], a[220:223], v[124:127], a[124:127]
    v_mfma_f32_16x16x32_bf16 v[152:155], v[204:207], v[120:123], v[152:155]
    v_mfma_f32_16x16x32_bf16 v[156:159], v[204:207], v[124:127], v[156:159]
    s_cmp_eq_u32 s31, 0
    s_cbranch_scc1 ka_nox
    s_waitcnt vmcnt(8)
    s_barrier
ka_nox:
    s_nop 6
    v_rcp_f32 v230, v152
    v_rcp_f32 v231, v156
    v_accvgpr_read_b32 v160, a64
    v_accvgpr_read_b32 v161, a65
    v_accvgpr_read_b32 v162, a66
    v_accvgpr_read_b32 v163, a67
    v_accvgpr_read_b32 v164, a68
    v_accvgpr_read_b32 v165, a69
    v_accvgpr_read_b32 v166, a70
    v_accvgpr_read_b32 v167, a71
    v_mul_f32 v160, v160, v230
    v_mul_f32 v161, v161, v230
    v_mul_f32 v162, v162, v230
    v_mul_f32 v163, v163, v230
    v_mul_f32 v164, v164, v230
    v_mul_f32 v165, v165, v230
    v_mul_f32 v166, v166, v230
    v_mul_f32 v167, v167, v230
    v_cvt_pk_bf16_f32 v176, v160, v161
    v_cvt_pk_bf16_f32 v177, v162, v163
    v_cvt_pk_bf16_f32 v178, v164, v165
    v_cvt_pk_bf16_f32 v179, v166, v167
    buffer_store_dwordx4 v[176:179], v240, s[20:23], s40 offen offset:0 sc1
    v_accvgpr_read_b32 v168, a72
    v_accvgpr_read_b32 v169, a73
    v_accvgpr_read_b32 v170, a74
    v_accvgpr_read_b32 v171, a75
    v_accvgpr_read_b32 v172, a76
    v_accvgpr_read_b32 v173, a77
    v_accvgpr_read_b32 v174, a78
    v_accvgpr_read_b32 v175, a79
    v_mul_f32 v168, v168, v230
    v_mul_f32 v169, v169, v230
    v_mul_f32 v170, v170, v230
    v_mul_f32 v171, v171, v230
    v_mul_f32 v172, v172, v230
    v_mul_f32 v173, v173, v230
    v_mul_f32 v174, v174, v230
    v_mul_f32 v175, v175, v230
    v_cvt_pk_bf16_f32 v180, v168, v169
    v_cvt_pk_bf16_f32 v181, v170, v171
    v_cvt_pk_bf16_f32 v182, v172, v173
    v_cvt_pk_bf16_f32 v183, v174, v175
    buffer_store_dwordx4 v[180:183], v240, s[20:23], s40 offen offset:1024 sc1
    v_accvgpr_read_b32 v160, a80
    v_accvgpr_read_b32 v161, a81
    v_accvgpr_read_b32 v162, a82
    v_accvgpr_read_b32 v163, a83
    v_accvgpr_read_b32 v164, a84
    v_accvgpr_read_b32 v165, a85
    v_accvgpr_read_b32 v166, a86
    v_accvgpr_read_b32 v167, a87
    v_mul_f32 v160, v160, v230
    v_mul_f32 v161, v161, v230
    v_mul_f32 v162, v162, v230
    v_mul_f32 v163, v163, v230
    v_mul_f32 v164, v164, v230
    v_mul_f32 v165, v165, v230
    v_mul_f32 v166, v166, v230
    v_mul_f32 v167, v167, v230
    v_cvt_pk_bf16_f32 v184, v160, v161
    v_cvt_pk_bf16_f32 v185, v162, v163
    v_cvt_pk_bf16_f32 v186, v164, v165
    v_cvt_pk_bf16_f32 v187, v166, v167
    buffer_store_dwordx4 v[184:187], v240, s[20:23], s40 offen offset:2048 sc1
    v_accvgpr_read_b32 v168, a88
    v_accvgpr_read_b32 v169, a89
    v_accvgpr_read_b32 v170, a90
    v_accvgpr_read_b32 v171, a91
    v_accvgpr_read_b32 v172, a92
    v_accvgpr_read_b32 v173, a93
    v_accvgpr_read_b32 v174, a94
    v_accvgpr_read_b32 v175, a95
    v_mul_f32 v168, v168, v230
    v_mul_f32 v169, v169, v230
    v_mul_f32 v170, v170, v230
    v_mul_f32 v171, v171, v230
    v_mul_f32 v172, v172, v230
    v_mul_f32 v173, v173, v230
    v_mul_f32 v174, v174, v230
    v_mul_f32 v175, v175, v230
    v_cvt_pk_bf16_f32 v188, v168, v169
    v_cvt_pk_bf16_f32 v189, v170, v171
    v_cvt_pk_bf16_f32 v190, v172, v173
    v_cvt_pk_bf16_f32 v191, v174, v175
    buffer_store_dwordx4 v[188:191], v240, s[20:23], s40 offen offset:3072 sc1
    v_accvgpr_read_b32 v160, a96
    v_accvgpr_read_b32 v161, a97
    v_accvgpr_read_b32 v162, a98
    v_accvgpr_read_b32 v163, a99
    v_accvgpr_read_b32 v164, a100
    v_accvgpr_read_b32 v165, a101
    v_accvgpr_read_b32 v166, a102
    v_accvgpr_read_b32 v167, a103
    v_mul_f32 v160, v160, v231
    v_mul_f32 v161, v161, v231
    v_mul_f32 v162, v162, v231
    v_mul_f32 v163, v163, v231
    v_mul_f32 v164, v164, v231
    v_mul_f32 v165, v165, v231
    v_mul_f32 v166, v166, v231
    v_mul_f32 v167, v167, v231
    v_cvt_pk_bf16_f32 v176, v160, v161
    v_cvt_pk_bf16_f32 v177, v162, v163
    v_cvt_pk_bf16_f32 v178, v164, v165
    v_cvt_pk_bf16_f32 v179, v166, v167
    buffer_store_dwordx4 v[176:179], v244, s[20:23], s40 offen offset:0 sc1
    v_accvgpr_read_b32 v168, a104
    v_accvgpr_read_b32 v169, a105
    v_accvgpr_read_b32 v170, a106
    v_accvgpr_read_b32 v171, a107
    v_accvgpr_read_b32 v172, a108
    v_accvgpr_read_b32 v173, a109
    v_accvgpr_read_b32 v174, a110
    v_accvgpr_read_b32 v175, a111
    v_mul_f32 v168, v168, v231
    v_mul_f32 v169, v169, v231
    v_mul_f32 v170, v170, v231
    v_mul_f32 v171, v171, v231
    v_mul_f32 v172, v172, v231
    v_mul_f32 v173, v173, v231
    v_mul_f32 v174, v174, v231
    v_mul_f32 v175, v175, v231
    v_cvt_pk_bf16_f32 v180, v168, v169
    v_cvt_pk_bf16_f32 v181, v170, v171
    v_cvt_pk_bf16_f32 v182, v172, v173
    v_cvt_pk_bf16_f32 v183, v174, v175
    buffer_store_dwordx4 v[180:183], v244, s[20:23], s40 offen offset:1024 sc1
    v_accvgpr_read_b32 v160, a112
    v_accvgpr_read_b32 v161, a113
    v_accvgpr_read_b32 v162, a114
    v_accvgpr_read_b32 v163, a115
    v_accvgpr_read_b32 v164, a116
    v_accvgpr_read_b32 v165, a117
    v_accvgpr_read_b32 v166, a118
    v_accvgpr_read_b32 v167, a119
    v_mul_f32 v160, v160, v231
    v_mul_f32 v161, v161, v231
    v_mul_f32 v162, v162, v231
    v_mul_f32 v163, v163, v231
    v_mul_f32 v164, v164, v231
    v_mul_f32 v165, v165, v231
    v_mul_f32 v166, v166, v231
    v_mul_f32 v167, v167, v231
    v_cvt_pk_bf16_f32 v184, v160, v161
    v_cvt_pk_bf16_f32 v185, v162, v163
    v_cvt_pk_bf16_f32 v186, v164, v165
    v_cvt_pk_bf16_f32 v187, v166, v167
    buffer_store_dwordx4 v[184:187], v244, s[20:23], s40 offen offset:2048 sc1
    v_accvgpr_read_b32 v168, a120
    v_accvgpr_read_b32 v169, a121
    v_accvgpr_read_b32 v170, a122
    v_accvgpr_read_b32 v171, a123
    v_accvgpr_read_b32 v172, a124
    v_accvgpr_read_b32 v173, a125
    v_accvgpr_read_b32 v174, a126
    v_accvgpr_read_b32 v175, a127
    v_mul_f32 v168, v168, v231
    v_mul_f32 v169, v169, v231
    v_mul_f32 v170, v170, v231
    v_mul_f32 v171, v171, v231
    v_mul_f32 v172, v172, v231
    v_mul_f32 v173, v173, v231
    v_mul_f32 v174, v174, v231
    v_mul_f32 v175, v175, v231
    v_cvt_pk_bf16_f32 v188, v168, v169
    v_cvt_pk_bf16_f32 v189, v170, v171
    v_cvt_pk_bf16_f32 v190, v172, v173
    v_cvt_pk_bf16_f32 v191, v174, v175
    buffer_store_dwordx4 v[188:191], v244, s[20:23], s40 offen offset:3072 sc1
    s_sub_u32 s46, s20, 0x2400000
    s_subb_u32 s47, s21, 0
    s_mov_b64 s[42:43], s[56:57]
    s_mov_b64 s[40:41], s[80:81]
    s_mov_b64 s[44:45], s[82:83]
    s_mov_b64 s[60:61], s[84:85]
    s_mov_b64 s[62:63], s[86:87]
    v_mbcnt_lo_u32_b32 v237, -1, 0
    v_mbcnt_hi_u32_b32 v237, -1, v237
    s_lshl_b32 s32, s3, 6
    v_add_u32 v230, s32, v237
    s_lshr_b32 s53, s2, 3
    s_lshr_b32 s6, s2, 1
    s_and_b32 s6, s6, 3
    s_and_b32 s4, s2, 1
    s_lshl_b32 s4, s4, 2
    s_and_b32 s33, s53, 3
    s_add_u32 s4, s4, s33
    s_lshr_b32 s5, s53, 2
    v_lshlrev_b32 v228, 4, v237
    v_lshrrev_b32 v234, 4, v237
    v_and_b32 v235, 15, v237
    v_lshlrev_b32 v236, 1, v234
    v_xor_b32 v235, v235, v236
    v_lshlrev_b32 v234, 11, v234
    s_lshl_b32 s32, s3, 14
    s_lshl_b32 s33, s5, 8
    s_add_u32 s32, s32, s33
    v_add_u32 v234, s32, v234
    v_lshl_add_u32 v224, v235, 4, v234
    v_xor_b32_e64 v235, 8, v235
    v_lshl_add_u32 v225, v235, 4, v234
    v_add_u32 v225, 7168, v225
    s_lshl_b32 s37, s6, 21
    s_lshl_b32 s38, s3, 11
    s_lshl2_add_u32 s4, s4, s3
    s_sub_u32 s32, 63, s4
    s_cmp_lt_u32 s6, 2
    s_cselect_b32 s4, s4, s32
    s_lshl_b32 s32, s4, 18
    v_add_u32 v226, s32, v228
    v_add_u32 v227, 0x20000, v226
    v_xor_b32 v245, 0xfc0000, v226
    v_xor_b32 v246, 0xfc0000, v227
    s_lshl_b32 s35, s6, 15
    s_add_u32 s35, s35, 0x2400000
    s_getpc_b64 s[56:57]
kc_pc0:
    s_mov_b32 s58, kc_end-kc_pc0
    s_mov_b32 s59, 0x00020000
    v_lshlrev_b32_e64 v234, 7, v230
    buffer_load_dword v241, v234, s[56:59], 0 offen
    s_waitcnt lgkmcnt(0)
    s_mov_b32 s8, s46
    s_mov_b32 s9, s47
    s_mov_b32 s10, 0x10000000
    s_mov_b32 s11, 0x00020000
    s_mov_b32 s12, s42
    s_mov_b32 s13, s43
    s_mov_b32 s14, 0x800000
    s_mov_b32 s15, 0x00020000
    s_mov_b32 s16, s40
    s_mov_b32 s17, s41
    s_mov_b32 s18, 0x400000
    s_mov_b32 s19, 0x00020000
    s_mov_b32 s20, s44
    s_mov_b32 s21, s45
    s_mov_b32 s22, 0x800
    s_mov_b32 s23, 0x00020000
    s_mov_b32 s24, s60
    s_mov_b32 s25, s61
    s_mov_b32 s26, 0x700000
    s_mov_b32 s27, 0x00020000
    s_mov_b32 s28, s62
    s_mov_b32 s29, s63
    s_mov_b32 s30, 0x400000
    s_mov_b32 s31, 0x00020000
    s_lshr_b32 s44, s6, 1
    s_and_b32 s6, s6, 1
    v_bfe_u32 v234, v237, 2, 3
    v_lshrrev_b32 v235, 5, v237
    v_lshl_add_u32 v235, v235, 4, v234
    v_lshlrev_b32 v235, 8, v235
    v_and_b32 v236, 1, v237
    v_lshl_add_u32 v235, v236, 3, v235
    v_lshlrev_b32_e64 v234, 1, v234
    v_bfe_u32 v236, v237, 1, 1
    v_or_b32 v234, v234, v236
    s_lshl_b32 s32, s6, 3
    v_xor_b32 v234, s32, v234
    v_xor_b32 v236, 0, v234
    v_lshl_add_u32 v216, v236, 4, v235
    v_xor_b32_e64 v236, 2, v234
    v_lshl_add_u32 v217, v236, 4, v235
    v_xor_b32_e64 v236, 4, v234
    v_lshl_add_u32 v218, v236, 4, v235
    v_xor_b32_e64 v236, 6, v234
    v_lshl_add_u32 v219, v236, 4, v235
    v_xor_b32_e64 v236, 8, v234
    v_lshl_add_u32 v220, v236, 4, v235
    v_xor_b32_e64 v236, 10, v234
    v_lshl_add_u32 v221, v236, 4, v235
    v_xor_b32_e64 v236, 12, v234
    v_lshl_add_u32 v222, v236, 4, v235
    v_xor_b32_e64 v236, 14, v234
    v_lshl_add_u32 v223, v236, 4, v235
    s_lshl_b32 s44, s4, 5
    v_lshrrev_b32 v234, 3, v237
    v_add_u32 v242, s44, v234
    v_and_b32 v235, 7, v237
    s_lshl1_add_u32 s33, s5, s6
    s_lshl_b32 s33, s33, 7
    v_lshl_add_u32 v240, v235, 4, s33
    v_lshl_add_u32 v229, v242, 11, v240
    s_mul_i32 s32, s3, 4608
    s_add_u32 s32, s32, 131072
    v_mul_u32_u24 v234, 144, v234
    v_lshl_add_u32 v234, v235, 4, v234
    v_add_u32 v239, s32, v234
    v_and_b32 v234, 15, v237
    v_mul_u32_u24 v234, 144, v234
    v_lshrrev_b32_e64 v236, 4, v237
    v_lshl_add_u32 v234, v236, 3, v234
    v_add_u32 v238, s32, v234
    v_and_b32 v234, 3, v237
    v_lshl_add_u32 v234, v234, 3, v242
    v_lshlrev_b32 v234, 2, v234
    v_lshrrev_b32 v235, 2, v235
    v_lshl_add_u32 v231, v235, 13, v234
    v_lshlrev_b32_e64 v235, 30, v235
    v_add_u32 v235, 16384, v235
    v_add_u32 v232, v235, v234
    s_cmp_eq_u32 s44, 0
    s_cselect_b32 s32, 4, 64
    v_cmp_eq_u32 vcc, s32, v237
    v_mov_b32 v235, 24576
    v_mov_b32 v233, 1
    v_cndmask_b32 v232, v232, v235, vcc
    v_and_b32_e64 v234, 1, v237
    v_cmp_ne_u32 s[60:61], 0, v234
    v_and_b32_e64 v234, 2, v237
    v_cmp_ne_u32 s[62:63], 0, v234
    v_and_b32_e64 v234, 4, v237
    v_cmp_ne_u32 s[40:41], 0, v234
    v_cmp_eq_u32 vcc, 0, v237
    v_mov_b32_e64 v235, 0x40000000
    s_nop 0
    v_cndmask_b32 v243, v235, v237, vcc
    s_lshl2_add_u32 s39, s2, s3
    s_mov_b32 s48, 0x3800000
    s_mov_b32 s49, 0x3802000
    s_mov_b32 s50, 0x3804000
    s_and_b32 s52, s2, 7
    s_mul_i32 s54, s52, 28
    s_add_u32 s54, s54, s53
    v_lshrrev_b32 v234, 3, v237
    v_lshlrev_b32 v234, 11, v234
    v_and_b32 v235, 7, v237
    v_lshl_add_u32 v244, v235, 4, v234
    s_lshl_b32 s55, s54, 16
    s_lshl_b32 s32, s3, 13
    s_add_u32 s55, s55, s32
    s_add_u32 s55, s55, 0x4000000
    s_lshl_b32 s51, s54, 15
    s_lshl_b32 s32, s3, 9
    s_add_u32 s51, s51, s32
    s_cmp_ge_u32 s53, 28
    s_cselect_b32 s55, 0x40000000, s55
    s_cselect_b32 s51, 0x40000000, s51
    s_lshr_b32 s32, s2, 5
    s_lshl_b32 s32, s32, 9
    s_and_b32 s33, s2, 6
    s_lshl_b32 s33, s33, 6
    s_add_u32 s32, s32, s33
    s_add_u32 s32, s32, 0x38a4000
    s_waitcnt vmcnt(0)
    s_barrier
    s_cmp_lg_u32 s3, 0
    s_cbranch_scc1 kc_a0
    buffer_atomic_add v233, v243, s[8:11], s32 offen sc1
    s_lshl_b32 s32, s52, 7
    s_add_u32 s32, s32, 0x38a1000
    v_mov_b32 v235, 1
    buffer_atomic_add v235, v243, s[8:11], s32 offen sc0 sc1
    v_lshlrev_b32 v234, 7, v237
    v_cmp_gt_u32 vcc, 8, v237
    v_mov_b32_e64 v236, 0x40000000
    s_mov_b32 s34, 0x38a1400
    v_cndmask_b32 v234, v236, v234, vcc
    s_waitcnt vmcnt(0)
    v_readfirstlane_b32 s36, v235
    s_cmp_lg_u32 s36, 31
    s_cbranch_scc1 kc_a0
    buffer_atomic_add v233, v234, s[8:11], s34 offen sc1
kc_a0:
    s_add_u32 m0, s38, 0
    s_add_u32 s32, s37, 0
    buffer_load_dwordx4 v224, s[12:15], s32 offen lds
    buffer_load_dwordx4 v225, s[12:15], s32 offen offset:1024 lds
    s_add_u32 m0, s38, 8192
    s_add_u32 s32, s37, 65536
    buffer_load_dwordx4 v224, s[12:15], s32 offen lds
    buffer_load_dwordx4 v225, s[12:15], s32 offen offset:1024 lds
    s_add_u32 m0, s38, 16384
    s_add_u32 s32, s37, 131072
    buffer_load_dwordx4 v224, s[12:15], s32 offen lds
    buffer_load_dwordx4 v225, s[12:15], s32 offen offset:1024 lds
    s_add_u32 m0, s38, 24576
    s_add_u32 s32, s37, 196608
    buffer_load_dwordx4 v224, s[12:15], s32 offen lds
    buffer_load_dwordx4 v225, s[12:15], s32 offen offset:1024 lds
    s_add_u32 m0, s38, 32768
    s_add_u32 s32, s37, 262144
    buffer_load_dwordx4 v224, s[12:15], s32 offen lds
    buffer_load_dwordx4 v225, s[12:15], s32 offen offset:1024 lds
    s_add_u32 m0, s38, 40960
    s_add_u32 s32, s37, 327680
    buffer_load_dwordx4 v224, s[12:15], s32 offen lds
    buffer_load_dwordx4 v225, s[12:15], s32 offen offset:1024 lds
    s_add_u32 m0, s38, 49152
    s_add_u32 s32, s37, 393216
    buffer_load_dwordx4 v224, s[12:15], s32 offen lds
    buffer_load_dwordx4 v225, s[12:15], s32 offen offset:1024 lds
    s_add_u32 m0, s38, 57344
    s_add_u32 s32, s37, 458752
    buffer_load_dwordx4 v224, s[12:15], s32 offen lds
    buffer_load_dwordx4 v225, s[12:15], s32 offen offset:1024 lds
    s_add_u32 m0, s38, 65536
    s_add_u32 s32, s37, 524288
    buffer_load_dwordx4 v224, s[12:15], s32 offen lds
    buffer_load_dwordx4 v225, s[12:15], s32 offen offset:1024 lds
    s_add_u32 m0, s38, 73728
    s_add_u32 s32, s37, 589824
    buffer_load_dwordx4 v224, s[12:15], s32 offen lds
    buffer_load_dwordx4 v225, s[12:15], s32 offen offset:1024 lds
    s_add_u32 m0, s38, 81920
    s_add_u32 s32, s37, 655360
    buffer_load_dwordx4 v224, s[12:15], s32 offen lds
    buffer_load_dwordx4 v225, s[12:15], s32 offen offset:1024 lds
    s_add_u32 m0, s38, 90112
    s_add_u32 s32, s37, 720896
    buffer_load_dwordx4 v224, s[12:15], s32 offen lds
    buffer_load_dwordx4 v225, s[12:15], s32 offen offset:1024 lds
    s_add_u32 m0, s38, 98304
    s_add_u32 s32, s37, 786432
    buffer_load_dwordx4 v224, s[12:15], s32 offen lds
    buffer_load_dwordx4 v225, s[12:15], s32 offen offset:1024 lds
    s_add_u32 m0, s38, 106496
    s_add_u32 s32, s37, 851968
    buffer_load_dwordx4 v224, s[12:15], s32 offen lds
    buffer_load_dwordx4 v225, s[12:15], s32 offen offset:1024 lds
    s_add_u32 m0, s38, 114688
    s_add_u32 s32, s37, 917504
    buffer_load_dwordx4 v224, s[12:15], s32 offen lds
    buffer_load_dwordx4 v225, s[12:15], s32 offen offset:1024 lds
    s_add_u32 m0, s38, 122880
    s_add_u32 s32, s37, 983040
    buffer_load_dwordx4 v224, s[12:15], s32 offen lds
    buffer_load_dwordx4 v225, s[12:15], s32 offen offset:1024 lds
    s_add_u32 s33, s51, 0
    buffer_load_dwordx4 a[192:195], v244, s[24:27], s33 offen offset:0
    s_add_u32 s33, s51, 16384
    buffer_load_dwordx4 a[196:199], v244, s[24:27], s33 offen offset:0
    s_add_u32 s33, s51, 0
    buffer_load_dwordx4 a[200:203], v244, s[24:27], s33 offen offset:128
    s_add_u32 s33, s51, 16384
    buffer_load_dwordx4 a[204:207], v244, s[24:27], s33 offen offset:128
    s_add_u32 s33, s51, 0
    buffer_load_dwordx4 a[208:211], v244, s[24:27], s33 offen offset:256
    s_add_u32 s33, s51, 16384
    buffer_load_dwordx4 a[212:215], v244, s[24:27], s33 offen offset:256
    s_add_u32 s33, s51, 0
    buffer_load_dwordx4 a[216:219], v244, s[24:27], s33 offen offset:384
    s_add_u32 s33, s51, 16384
    buffer_load_dwordx4 a[220:223], v244, s[24:27], s33 offen offset:384
    s_cmp_lg_u32 s3, 0
    s_cbranch_scc1 kc_b03
    s_and_b32 s32, s2, 1
    s_lshl_b32 s32, s32, 2
    s_and_b32 s33, s53, 3
    s_add_u32 s32, s32, s33
    s_lshl_b32 s32, s32, 9
    s_and_b32 s33, s2, 6
    s_lshl_b32 s33, s33, 6
    s_add_u32 s32, s32, s33
    s_add_u32 s32, s32, 0x38a4000
    s_mov_b32 s34, 0x400000
    s_branch kc_b01
kc_b00:
    s_sleep 2
kc_b01:
    buffer_load_dword v235, off, s[8:11], s32 sc1
    s_waitcnt vmcnt(0)
    v_cmp_ne_u32 vcc, 8, v235
    s_sub_u32 s34, s34, 1
    s_cbranch_scc1 kc_b02
    s_cbranch_vccnz kc_b00
kc_b02:
kc_b03:
    s_waitcnt vmcnt(8)
    s_barrier
    buffer_load_dwordx4 a[0:3], v226, s[8:11], s35 offen offset:0 sc1
    buffer_load_dwordx4 a[4:7], v227, s[8:11], s35 offen offset:0 sc1
    buffer_load_dwordx4 a[8:11], v245, s[8:11], s35 offen offset:0 sc1
    buffer_load_dwordx4 a[12:15], v246, s[8:11], s35 offen offset:0 sc1
    buffer_load_dwordx4 a[16:19], v226, s[8:11], s35 offen offset:1024 sc1
    buffer_load_dwordx4 a[20:23], v227, s[8:11], s35 offen offset:1024 sc1
    buffer_load_dwordx4 a[24:27], v245, s[8:11], s35 offen offset:1024 sc1
    buffer_load_dwordx4 a[28:31], v246, s[8:11], s35 offen offset:1024 sc1
    buffer_load_dwordx4 a[32:35], v226, s[8:11], s35 offen offset:2048 sc1
    buffer_load_dwordx4 a[36:39], v227, s[8:11], s35 offen offset:2048 sc1
    buffer_load_dwordx4 a[40:43], v245, s[8:11], s35 offen offset:2048 sc1
    buffer_load_dwordx4 a[44:47], v246, s[8:11], s35 offen offset:2048 sc1
    buffer_load_dwordx4 a[48:51], v226, s[8:11], s35 offen offset:3072 sc1
    buffer_load_dwordx4 a[52:55], v227, s[8:11], s35 offen offset:3072 sc1
    buffer_load_dwordx4 a[56:59], v245, s[8:11], s35 offen offset:3072 sc1
    buffer_load_dwordx4 a[60:63], v246, s[8:11], s35 offen offset:3072 sc1
    ds_read_b64_tr_b16 v[128:129], v216 offset:0
    ds_read_b64_tr_b16 v[130:131], v216 offset:2048
    ds_read_b64_tr_b16 v[132:133], v217 offset:0
    ds_read_b64_tr_b16 v[134:135], v217 offset:2048
    ds_read_b64_tr_b16 v[136:137], v218 offset:0
    ds_read_b64_tr_b16 v[138:139], v218 offset:2048
    ds_read_b64_tr_b16 v[140:141], v219 offset:0
    ds_read_b64_tr_b16 v[142:143], v219 offset:2048
    s_waitcnt vmcnt(12) lgkmcnt(0)
    v_mfma_f32_16x16x32_bf16 v[32:35], v[128:131], a[0:3], 0
    ds_read_b64_tr_b16 v[144:145], v220 offset:0
    v_mfma_f32_16x16x32_bf16 v[36:39], v[128:131], a[4:7], 0
    ds_read_b64_tr_b16 v[146:147], v220 offset:2048
    v_mfma_f32_16x16x32_bf16 v[64:67], v[128:131], a[8:11], 0
    ds_read_b64_tr_b16 v[148:149], v221 offset:0
    v_mfma_f32_16x16x32_bf16 v[68:71], v[128:131], a[12:15], 0
    ds_read_b64_tr_b16 v[150:151], v221 offset:2048
    v_mfma_f32_16x16x32_bf16 v[40:43], v[132:135], a[0:3], 0
    ds_read_b64_tr_b16 v[152:153], v222 offset:0
    v_mfma_f32_16x16x32_bf16 v[44:47], v[132:135], a[4:7], 0
    ds_read_b64_tr_b16 v[154:155], v222 offset:2048
    v_mfma_f32_16x16x32_bf16 v[72:75], v[132:135], a[8:11], 0
    ds_read_b64_tr_b16 v[156:157], v223 offset:0
    v_mfma_f32_16x16x32_bf16 v[76:79], v[132:135], a[12:15], 0
    ds_read_b64_tr_b16 v[158:159], v223 offset:2048
    v_mfma_f32_16x16x32_bf16 v[48:51], v[136:139], a[0:3], 0
    s_add_u32 s35, s35, 4096
    buffer_load_dwordx4 a[64:67], v226, s[8:11], s35 offen offset:0 sc1
    v_mfma_f32_16x16x32_bf16 v[52:55], v[136:139], a[4:7], 0
    v_mfma_f32_16x16x32_bf16 v[80:83], v[136:139], a[8:11], 0
    v_mfma_f32_16x16x32_bf16 v[84:87], v[136:139], a[12:15], 0
    buffer_load_dwordx4 a[68:71], v227, s[8:11], s35 offen offset:0 sc1
    v_mfma_f32_16x16x32_bf16 v[56:59], v[140:143], a[0:3], 0
    v_mfma_f32_16x16x32_bf16 v[60:63], v[140:143], a[4:7], 0
    v_mfma_f32_16x16x32_bf16 v[88:91], v[140:143], a[8:11], 0
    v_mfma_f32_16x16x32_bf16 v[92:95], v[140:143], a[12:15], 0
    buffer_load_dwordx4 a[72:75], v245, s[8:11], s35 offen offset:0 sc1
    s_waitcnt lgkmcnt(0)
    v_mfma_f32_16x16x32_bf16 v[0:3], v[144:147], a[0:3], 0
    ds_read_b64_tr_b16 v[128:129], v216 offset:8192
    v_mfma_f32_16x16x32_bf16 v[4:7], v[144:147], a[4:7], 0
    ds_read_b64_tr_b16 v[130:131], v216 offset:10240
    v_mfma_f32_16x16x32_bf16 v[96:99], v[144:147], a[8:11], 0
    ds_read_b64_tr_b16 v[132:133], v217 offset:8192
    v_mfma_f32_16x16x32_bf16 v[100:103], v[144:147], a[12:15], 0
    ds_read_b64_tr_b16 v[134:135], v217 offset:10240
    v_mfma_f32_16x16x32_bf16 v[8:11], v[148:151], a[0:3], 0
    ds_read_b64_tr_b16 v[136:137], v218 offset:8192
    v_mfma_f32_16x16x32_bf16 v[12:15], v[148:151], a[4:7], 0
    ds_read_b64_tr_b16 v[138:139], v218 offset:10240
    v_mfma_f32_16x16x32_bf16 v[104:107], v[148:151], a[8:11], 0
    ds_read_b64_tr_b16 v[140:141], v219 offset:8192
    v_mfma_f32_16x16x32_bf16 v[108:111], v[148:151], a[12:15], 0
    ds_read_b64_tr_b16 v[142:143], v219 offset:10240
    v_mfma_f32_16x16x32_bf16 v[16:19], v[152:155], a[0:3], 0
    buffer_load_dwordx4 a[76:79], v246, s[8:11], s35 offen offset:0 sc1
    v_mfma_f32_16x16x32_bf16 v[20:23], v[152:155], a[4:7], 0
    v_mfma_f32_16x16x32_bf16 v[112:115], v[152:155], a[8:11], 0
    buffer_load_dwordx4 a[80:83], v226, s[8:11], s35 offen offset:1024 sc1
    v_mfma_f32_16x16x32_bf16 v[116:119], v[152:155], a[12:15], 0
    v_mfma_f32_16x16x32_bf16 v[24:27], v[156:159], a[0:3], 0
    v_mfma_f32_16x16x32_bf16 v[28:31], v[156:159], a[4:7], 0
    v_mfma_f32_16x16x32_bf16 v[120:123], v[156:159], a[8:11], 0
    v_mfma_f32_16x16x32_bf16 v[124:127], v[156:159], a[12:15], 0
    s_waitcnt vmcnt(13) lgkmcnt(0)
    v_mfma_f32_16x16x32_bf16 v[32:35], v[128:131], a[16:19], v[32:35]
    ds_read_b64_tr_b16 v[144:145], v220 offset:8192
    v_mfma_f32_16x16x32_bf16 v[36:39], v[128:131], a[20:23], v[36:39]
    ds_read_b64_tr_b16 v[146:147], v220 offset:10240
    v_mfma_f32_16x16x32_bf16 v[64:67], v[128:131], a[24:27], v[64:67]
    ds_read_b64_tr_b16 v[148:149], v221 offset:8192
    v_mfma_f32_16x16x32_bf16 v[68:71], v[128:131], a[28:31], v[68:71]
    ds_read_b64_tr_b16 v[150:151], v221 offset:10240
    v_mfma_f32_16x16x32_bf16 v[40:43], v[132:135], a[16:19], v[40:43]
    ds_read_b64_tr_b16 v[152:153], v222 offset:8192
    v_mfma_f32_16x16x32_bf16 v[44:47], v[132:135], a[20:23], v[44:47]
    ds_read_b64_tr_b16 v[154:155], v222 offset:10240
    v_mfma_f32_16x16x32_bf16 v[72:75], v[132:135], a[24:27], v[72:75]
    ds_read_b64_tr_b16 v[156:157], v223 offset:8192
    v_mfma_f32_16x16x32_bf16 v[76:79], v[132:135], a[28:31], v[76:79]
    ds_read_b64_tr_b16 v[158:159], v223 offset:10240
    v_mfma_f32_16x16x32_bf16 v[48:51], v[136:139], a[16:19], v[48:51]
    buffer_load_dwordx4 a[84:87], v227, s[8:11], s35 offen offset:1024 sc1
    v_mfma_f32_16x16x32_bf16 v[52:55], v[136:139], a[20:23], v[52:55]
    v_mfma_f32_16x16x32_bf16 v[80:83], v[136:139], a[24:27], v[80:83]
    v_mfma_f32_16x16x32_bf16 v[84:87], v[136:139], a[28:31], v[84:87]
    buffer_load_dwordx4 a[88:91], v245, s[8:11], s35 offen offset:1024 sc1
    v_mfma_f32_16x16x32_bf16 v[56:59], v[140:143], a[16:19], v[56:59]
    v_mfma_f32_16x16x32_bf16 v[60:63], v[140:143], a[20:23], v[60:63]
    v_mfma_f32_16x16x32_bf16 v[88:91], v[140:143], a[24:27], v[88:91]
    v_mfma_f32_16x16x32_bf16 v[92:95], v[140:143], a[28:31], v[92:95]
    buffer_load_dwordx4 a[92:95], v246, s[8:11], s35 offen offset:1024 sc1
    s_waitcnt lgkmcnt(0)
    v_mfma_f32_16x16x32_bf16 v[0:3], v[144:147], a[16:19], v[0:3]
    ds_read_b64_tr_b16 v[128:129], v216 offset:16384
    v_mfma_f32_16x16x32_bf16 v[4:7], v[144:147], a[20:23], v[4:7]
    ds_read_b64_tr_b16 v[130:131], v216 offset:18432
    v_mfma_f32_16x16x32_bf16 v[96:99], v[144:147], a[24:27], v[96:99]
    ds_read_b64_tr_b16 v[132:133], v217 offset:16384
    v_mfma_f32_16x16x32_bf16 v[100:103], v[144:147], a[28:31], v[100:103]
    ds_read_b64_tr_b16 v[134:135], v217 offset:18432
    v_mfma_f32_16x16x32_bf16 v[8:11], v[148:151], a[16:19], v[8:11]
    ds_read_b64_tr_b16 v[136:137], v218 offset:16384
    v_mfma_f32_16x16x32_bf16 v[12:15], v[148:151], a[20:23], v[12:15]
    ds_read_b64_tr_b16 v[138:139], v218 offset:18432
    v_mfma_f32_16x16x32_bf16 v[104:107], v[148:151], a[24:27], v[104:107]
    ds_read_b64_tr_b16 v[140:141], v219 offset:16384
    v_mfma_f32_16x16x32_bf16 v[108:111], v[148:151], a[28:31], v[108:111]
    ds_read_b64_tr_b16 v[142:143], v219 offset:18432
    v_mfma_f32_16x16x32_bf16 v[16:19], v[152:155], a[16:19], v[16:19]
    buffer_load_dwordx4 a[96:99], v226, s[8:11], s35 offen offset:2048 sc1
    v_mfma_f32_16x16x32_bf16 v[20:23], v[152:155], a[20:23], v[20:23]
    v_mfma_f32_16x16x32_bf16 v[112:115], v[152:155], a[24:27], v[112:115]
    v_mfma_f32_16x16x32_bf16 v[116:119], v[152:155], a[28:31], v[116:119]
    v_mfma_f32_16x16x32_bf16 v[24:27], v[156:159], a[16:19], v[24:27]
    buffer_load_dwordx4 a[100:103], v227, s[8:11], s35 offen offset:2048 sc1
    v_mfma_f32_16x16x32_bf16 v[28:31], v[156:159], a[20:23], v[28:31]
    v_mfma_f32_16x16x32_bf16 v[120:123], v[156:159], a[24:27], v[120:123]
    v_mfma_f32_16x16x32_bf16 v[124:127], v[156:159], a[28:31], v[124:127]
    s_waitcnt vmcnt(14) lgkmcnt(0)
    v_mfma_f32_16x16x32_bf16 v[32:35], v[128:131], a[32:35], v[32:35]
    ds_read_b64_tr_b16 v[144:145], v220 offset:16384
    v_mfma_f32_16x16x32_bf16 v[36:39], v[128:131], a[36:39], v[36:39]
    ds_read_b64_tr_b16 v[146:147], v220 offset:18432
    v_mfma_f32_16x16x32_bf16 v[64:67], v[128:131], a[40:43], v[64:67]
    ds_read_b64_tr_b16 v[148:149], v221 offset:16384
    v_mfma_f32_16x16x32_bf16 v[68:71], v[128:131], a[44:47], v[68:71]
    ds_read_b64_tr_b16 v[150:151], v221 offset:18432
    v_mfma_f32_16x16x32_bf16 v[40:43], v[132:135], a[32:35], v[40:43]
    ds_read_b64_tr_b16 v[152:153], v222 offset:16384
    v_mfma_f32_16x16x32_bf16 v[44:47], v[132:135], a[36:39], v[44:47]
    ds_read_b64_tr_b16 v[154:155], v222 offset:18432
    v_mfma_f32_16x16x32_bf16 v[72:75], v[132:135], a[40:43], v[72:75]
    ds_read_b64_tr_b16 v[156:157], v223 offset:16384
    v_mfma_f32_16x16x32_bf16 v[76:79], v[132:135], a[44:47], v[76:79]
    ds_read_b64_tr_b16 v[158:159], v223 offset:18432
    v_mfma_f32_16x16x32_bf16 v[48:51], v[136:139], a[32:35], v[48:51]
    buffer_load_dwordx4 a[104:107], v245, s[8:11], s35 offen offset:2048 sc1
    v_mfma_f32_16x16x32_bf16 v[52:55], v[136:139], a[36:39], v[52:55]
    v_mfma_f32_16x16x32_bf16 v[80:83], v[136:139], a[40:43], v[80:83]
    v_mfma_f32_16x16x32_bf16 v[84:87], v[136:139], a[44:47], v[84:87]
    buffer_load_dwordx4 a[108:111], v246, s[8:11], s35 offen offset:2048 sc1
    v_mfma_f32_16x16x32_bf16 v[56:59], v[140:143], a[32:35], v[56:59]
    v_mfma_f32_16x16x32_bf16 v[60:63], v[140:143], a[36:39], v[60:63]
    v_mfma_f32_16x16x32_bf16 v[88:91], v[140:143], a[40:43], v[88:91]
    v_mfma_f32_16x16x32_bf16 v[92:95], v[140:143], a[44:47], v[92:95]
    buffer_load_dwordx4 a[112:115], v226, s[8:11], s35 offen offset:3072 sc1
    s_waitcnt lgkmcnt(0)
    v_mfma_f32_16x16x32_bf16 v[0:3], v[144:147], a[32:35], v[0:3]
    ds_read_b64_tr_b16 v[128:129], v216 offset:24576
    v_mfma_f32_16x16x32_bf16 v[4:7], v[144:147], a[36:39], v[4:7]
    ds_read_b64_tr_b16 v[130:131], v216 offset:26624
    v_mfma_f32_16x16x32_bf16 v[96:99], v[144:147], a[40:43], v[96:99]
    ds_read_b64_tr_b16 v[132:133], v217 offset:24576
    v_mfma_f32_16x16x32_bf16 v[100:103], v[144:147], a[44:47], v[100:103]
    ds_read_b64_tr_b16 v[134:135], v217 offset:26624
    v_mfma_f32_16x16x32_bf16 v[8:11], v[148:151], a[32:35], v[8:11]
    ds_read_b64_tr_b16 v[136:137], v218 offset:24576
    v_mfma_f32_16x16x32_bf16 v[12:15], v[148:151], a[36:39], v[12:15]
    ds_read_b64_tr_b16 v[138:139], v218 offset:26624
    v_mfma_f32_16x16x32_bf16 v[104:107], v[148:151], a[40:43], v[104:107]
    ds_read_b64_tr_b16 v[140:141], v219 offset:24576
    v_mfma_f32_16x16x32_bf16 v[108:111], v[148:151], a[44:47], v[108:111]
    ds_read_b64_tr_b16 v[142:143], v219 offset:26624
    v_mfma_f32_16x16x32_bf16 v[16:19], v[152:155], a[32:35], v[16:19]
    buffer_load_dwordx4 a[116:119], v227, s[8:11], s35 offen offset:3072 sc1
    v_mfma_f32_16x16x32_bf16 v[20:23], v[152:155], a[36:39], v[20:23]
    v_mfma_f32_16x16x32_bf16 v[112:115], v[152:155], a[40:43], v[112:115]
    v_mfma_f32_16x16x32_bf16 v[116:119], v[152:155], a[44:47], v[116:119]
    v_mfma_f32_16x16x32_bf16 v[24:27], v[156:159], a[32:35], v[24:27]
    buffer_load_dwordx4 a[120:123], v245, s[8:11], s35 offen offset:3072 sc1
    v_mfma_f32_16x16x32_bf16 v[28:31], v[156:159], a[36:39], v[28:31]
    v_mfma_f32_16x16x32_bf16 v[120:123], v[156:159], a[40:43], v[120:123]
    v_mfma_f32_16x16x32_bf16 v[124:127], v[156:159], a[44:47], v[124:127]
    s_waitcnt vmcnt(15) lgkmcnt(0)
    v_mfma_f32_16x16x32_bf16 v[32:35], v[128:131], a[48:51], v[32:35]
    ds_read_b64_tr_b16 v[144:145], v220 offset:24576
    v_mfma_f32_16x16x32_bf16 v[36:39], v[128:131], a[52:55], v[36:39]
    ds_read_b64_tr_b16 v[146:147], v220 offset:26624
    v_mfma_f32_16x16x32_bf16 v[64:67], v[128:131], a[56:59], v[64:67]
    ds_read_b64_tr_b16 v[148:149], v221 offset:24576
    v_mfma_f32_16x16x32_bf16 v[68:71], v[128:131], a[60:63], v[68:71]
    ds_read_b64_tr_b16 v[150:151], v221 offset:26624
    v_mfma_f32_16x16x32_bf16 v[40:43], v[132:135], a[48:51], v[40:43]
    ds_read_b64_tr_b16 v[152:153], v222 offset:24576
    v_mfma_f32_16x16x32_bf16 v[44:47], v[132:135], a[52:55], v[44:47]
    ds_read_b64_tr_b16 v[154:155], v222 offset:26624
    v_mfma_f32_16x16x32_bf16 v[72:75], v[132:135], a[56:59], v[72:75]
    ds_read_b64_tr_b16 v[156:157], v223 offset:24576
    v_mfma_f32_16x16x32_bf16 v[76:79], v[132:135], a[60:63], v[76:79]
    ds_read_b64_tr_b16 v[158:159], v223 offset:26624
    v_mfma_f32_16x16x32_bf16 v[48:51], v[136:139], a[48:51], v[48:51]
    buffer_load_dwordx4 a[124:127], v246, s[8:11], s35 offen offset:3072 sc1
    v_mfma_f32_16x16x32_bf16 v[52:55], v[136:139], a[52:55], v[52:55]
    v_mfma_f32_16x16x32_bf16 v[80:83], v[136:139], a[56:59], v[80:83]
    v_mfma_f32_16x16x32_bf16 v[84:87], v[136:139], a[60:63], v[84:87]
    s_add_u32 s35, s35, 4096
    buffer_load_dwordx4 a[0:3], v226, s[8:11], s35 offen offset:0 sc1
    v_mfma_f32_16x16x32_bf16 v[56:59], v[140:143], a[48:51], v[56:59]
    v_mfma_f32_16x16x32_bf16 v[60:63], v[140:143], a[52:55], v[60:63]
    v_mfma_f32_16x16x32_bf16 v[88:91], v[140:143], a[56:59], v[88:91]
    v_mfma_f32_16x16x32_bf16 v[92:95], v[140:143], a[60:63], v[92:95]
    buffer_load_dwordx4 a[4:7], v227, s[8:11], s35 offen offset:0 sc1
    s_waitcnt lgkmcnt(0)
    s_barrier
    v_mfma_f32_16x16x32_bf16 v[0:3], v[144:147], a[48:51], v[0:3]
    ds_read_b64_tr_b16 v[128:129], v216 offset:32768
    v_mfma_f32_16x16x32_bf16 v[4:7], v[144:147], a[52:55], v[4:7]
    ds_read_b64_tr_b16 v[130:131], v216 offset:34816
    v_mfma_f32_16x16x32_bf16 v[96:99], v[144:147], a[56:59], v[96:99]
    ds_read_b64_tr_b16 v[132:133], v216 offset:40960
    v_mfma_f32_16x16x32_bf16 v[100:103], v[144:147], a[60:63], v[100:103]
    ds_read_b64_tr_b16 v[134:135], v216 offset:43008
    v_mfma_f32_16x16x32_bf16 v[8:11], v[148:151], a[48:51], v[8:11]
    ds_read_b64_tr_b16 v[136:137], v217 offset:32768
    v_mfma_f32_16x16x32_bf16 v[12:15], v[148:151], a[52:55], v[12:15]
    ds_read_b64_tr_b16 v[138:139], v217 offset:34816
    v_mfma_f32_16x16x32_bf16 v[104:107], v[148:151], a[56:59], v[104:107]
    ds_read_b64_tr_b16 v[140:141], v217 offset:40960
    v_mfma_f32_16x16x32_bf16 v[108:111], v[148:151], a[60:63], v[108:111]
    ds_read_b64_tr_b16 v[142:143], v217 offset:43008
    v_mfma_f32_16x16x32_bf16 v[16:19], v[152:155], a[48:51], v[16:19]
    buffer_load_dwordx4 a[8:11], v245, s[8:11], s35 offen offset:0 sc1
    v_mfma_f32_16x16x32_bf16 v[20:23], v[152:155], a[52:55], v[20:23]
    v_mfma_f32_16x16x32_bf16 v[112:115], v[152:155], a[56:59], v[112:115]
    v_mfma_f32_16x16x32_bf16 v[116:119], v[152:155], a[60:63], v[116:119]
    v_mfma_f32_16x16x32_bf16 v[24:27], v[156:159], a[48:51], v[24:27]
    buffer_load_dwordx4 a[12:15], v246, s[8:11], s35 offen offset:0 sc1
    v_mfma_f32_16x16x32_bf16 v[28:31], v[156:159], a[52:55], v[28:31]
    v_mfma_f32_16x16x32_bf16 v[120:123], v[156:159], a[56:59], v[120:123]
    v_mfma_f32_16x16x32_bf16 v[124:127], v[156:159], a[60:63], v[124:127]
    s_waitcnt vmcnt(12) lgkmcnt(0)
    v_mfma_f32_16x16x32_bf16 v[32:35], v[128:131], a[64:67], v[32:35]
    ds_read_b64_tr_b16 v[144:145], v218 offset:32768
    v_mfma_f32_16x16x32_bf16 v[32:35], v[132:135], a[80:83], v[32:35]
    ds_read_b64_tr_b16 v[146:147], v218 offset:34816
    v_mfma_f32_16x16x32_bf16 v[36:39], v[128:131], a[68:71], v[36:39]
    ds_read_b64_tr_b16 v[148:149], v218 offset:40960
    v_mfma_f32_16x16x32_bf16 v[36:39], v[132:135], a[84:87], v[36:39]
    ds_read_b64_tr_b16 v[150:151], v218 offset:43008
    v_mfma_f32_16x16x32_bf16 v[64:67], v[128:131], a[72:75], v[64:67]
    ds_read_b64_tr_b16 v[152:153], v219 offset:32768
    v_mfma_f32_16x16x32_bf16 v[64:67], v[132:135], a[88:91], v[64:67]
    ds_read_b64_tr_b16 v[154:155], v219 offset:34816
    v_mfma_f32_16x16x32_bf16 v[68:71], v[128:131], a[76:79], v[68:71]
    ds_read_b64_tr_b16 v[156:157], v219 offset:40960
    v_mfma_f32_16x16x32_bf16 v[68:71], v[132:135], a[92:95], v[68:71]
    ds_read_b64_tr_b16 v[158:159], v219 offset:43008
    v_mfma_f32_16x16x32_bf16 v[40:43], v[136:139], a[64:67], v[40:43]
    buffer_load_dwordx4 a[16:19], v226, s[8:11], s35 offen offset:1024 sc1
    v_mfma_f32_16x16x32_bf16 v[40:43], v[140:143], a[80:83], v[40:43]
    s_add_u32 m0, s38, 0
    s_add_u32 s32, s37, 1048576
    v_mfma_f32_16x16x32_bf16 v[44:47], v[136:139], a[68:71], v[44:47]
    buffer_load_dwordx4 v224, s[12:15], s32 offen lds
    v_mfma_f32_16x16x32_bf16 v[44:47], v[140:143], a[84:87], v[44:47]
    buffer_load_dwordx4 a[20:23], v227, s[8:11], s35 offen offset:1024 sc1
    v_mfma_f32_16x16x32_bf16 v[72:75], v[136:139], a[72:75], v[72:75]
    v_mfma_f32_16x16x32_bf16 v[72:75], v[140:143], a[88:91], v[72:75]
    buffer_load_dwordx4 v225, s[12:15], s32 offen offset:1024 lds
    v_mfma_f32_16x16x32_bf16 v[76:79], v[136:139], a[76:79], v[76:79]
    v_mfma_f32_16x16x32_bf16 v[76:79], v[140:143], a[92:95], v[76:79]
    s_waitcnt lgkmcnt(0)
    v_mfma_f32_16x16x32_bf16 v[48:51], v[144:147], a[64:67], v[48:51]
    ds_read_b64_tr_b16 v[128:129], v220 offset:32768
    v_mfma_f32_16x16x32_bf16 v[48:51], v[148:151], a[80:83], v[48:51]
    ds_read_b64_tr_b16 v[130:131], v220 offset:34816
    v_mfma_f32_16x16x32_bf16 v[52:55], v[144:147], a[68:71], v[52:55]
    ds_read_b64_tr_b16 v[132:133], v220 offset:40960
    v_mfma_f32_16x16x32_bf16 v[52:55], v[148:151], a[84:87], v[52:55]
    ds_read_b64_tr_b16 v[134:135], v220 offset:43008
    v_mfma_f32_16x16x32_bf16 v[80:83], v[144:147], a[72:75], v[80:83]
    ds_read_b64_tr_b16 v[136:137], v221 offset:32768
    v_mfma_f32_16x16x32_bf16 v[80:83], v[148:151], a[88:91], v[80:83]
    ds_read_b64_tr_b16 v[138:139], v221 offset:34816
    v_mfma_f32_16x16x32_bf16 v[84:87], v[144:147], a[76:79], v[84:87]
    ds_read_b64_tr_b16 v[140:141], v221 offset:40960
    v_mfma_f32_16x16x32_bf16 v[84:87], v[148:151], a[92:95], v[84:87]
    ds_read_b64_tr_b16 v[142:143], v221 offset:43008
    v_mfma_f32_16x16x32_bf16 v[56:59], v[152:155], a[64:67], v[56:59]
    buffer_load_dwordx4 a[24:27], v245, s[8:11], s35 offen offset:1024 sc1
    v_mfma_f32_16x16x32_bf16 v[56:59], v[156:159], a[80:83], v[56:59]
    v_mfma_f32_16x16x32_bf16 v[60:63], v[152:155], a[68:71], v[60:63]
    buffer_load_dwordx4 a[28:31], v246, s[8:11], s35 offen offset:1024 sc1
    v_mfma_f32_16x16x32_bf16 v[60:63], v[156:159], a[84:87], v[60:63]
    v_mfma_f32_16x16x32_bf16 v[88:91], v[152:155], a[72:75], v[88:91]
    v_mfma_f32_16x16x32_bf16 v[88:91], v[156:159], a[88:91], v[88:91]
    v_mfma_f32_16x16x32_bf16 v[92:95], v[152:155], a[76:79], v[92:95]
    v_mfma_f32_16x16x32_bf16 v[92:95], v[156:159], a[92:95], v[92:95]
    buffer_load_dwordx4 a[32:35], v226, s[8:11], s35 offen offset:2048 sc1
    s_waitcnt lgkmcnt(0)
    v_mfma_f32_16x16x32_bf16 v[0:3], v[128:131], a[64:67], v[0:3]
    ds_read_b64_tr_b16 v[144:145], v222 offset:32768
    v_mfma_f32_16x16x32_bf16 v[0:3], v[132:135], a[80:83], v[0:3]
    ds_read_b64_tr_b16 v[146:147], v222 offset:34816
    v_mfma_f32_16x16x32_bf16 v[4:7], v[128:131], a[68:71], v[4:7]
    ds_read_b64_tr_b16 v[148:149], v222 offset:40960
    v_mfma_f32_16x16x32_bf16 v[4:7], v[132:135], a[84:87], v[4:7]
    ds_read_b64_tr_b16 v[150:151], v222 offset:43008
    v_mfma_f32_16x16x32_bf16 v[96:99], v[128:131], a[72:75], v[96:99]
    ds_read_b64_tr_b16 v[152:153], v223 offset:32768
    v_mfma_f32_16x16x32_bf16 v[96:99], v[132:135], a[88:91], v[96:99]
    ds_read_b64_tr_b16 v[154:155], v223 offset:34816
    v_mfma_f32_16x16x32_bf16 v[100:103], v[128:131], a[76:79], v[100:103]
    ds_read_b64_tr_b16 v[156:157], v223 offset:40960
    v_mfma_f32_16x16x32_bf16 v[100:103], v[132:135], a[92:95], v[100:103]
    ds_read_b64_tr_b16 v[158:159], v223 offset:43008
    v_mfma_f32_16x16x32_bf16 v[8:11], v[136:139], a[64:67], v[8:11]
    buffer_load_dwordx4 a[36:39], v227, s[8:11], s35 offen offset:2048 sc1
    v_mfma_f32_16x16x32_bf16 v[8:11], v[140:143], a[80:83], v[8:11]
    s_add_u32 m0, s38, 8192
    s_add_u32 s32, s37, 1114112
    v_mfma_f32_16x16x32_bf16 v[12:15], v[136:139], a[68:71], v[12:15]
    buffer_load_dwordx4 v224, s[12:15], s32 offen lds
    v_mfma_f32_16x16x32_bf16 v[12:15], v[140:143], a[84:87], v[12:15]
    buffer_load_dwordx4 a[40:43], v245, s[8:11], s35 offen offset:2048 sc1
    v_mfma_f32_16x16x32_bf16 v[104:107], v[136:139], a[72:75], v[104:107]
    v_mfma_f32_16x16x32_bf16 v[104:107], v[140:143], a[88:91], v[104:107]
    buffer_load_dwordx4 v225, s[12:15], s32 offen offset:1024 lds
    v_mfma_f32_16x16x32_bf16 v[108:111], v[136:139], a[76:79], v[108:111]
    v_mfma_f32_16x16x32_bf16 v[108:111], v[140:143], a[92:95], v[108:111]
    s_waitcnt lgkmcnt(0)
    v_mfma_f32_16x16x32_bf16 v[16:19], v[144:147], a[64:67], v[16:19]
    ds_read_b64_tr_b16 v[128:129], v216 offset:49152
    v_mfma_f32_16x16x32_bf16 v[16:19], v[148:151], a[80:83], v[16:19]
    ds_read_b64_tr_b16 v[130:131], v216 offset:51200
    v_mfma_f32_16x16x32_bf16 v[20:23], v[144:147], a[68:71], v[20:23]
    ds_read_b64_tr_b16 v[132:133], v216 offset:57344
    v_mfma_f32_16x16x32_bf16 v[20:23], v[148:151], a[84:87], v[20:23]
    ds_read_b64_tr_b16 v[134:135], v216 offset:59392
    v_mfma_f32_16x16x32_bf16 v[112:115], v[144:147], a[72:75], v[112:115]
    ds_read_b64_tr_b16 v[136:137], v217 offset:49152
    v_mfma_f32_16x16x32_bf16 v[112:115], v[148:151], a[88:91], v[112:115]
    ds_read_b64_tr_b16 v[138:139], v217 offset:51200
    v_mfma_f32_16x16x32_bf16 v[116:119], v[144:147], a[76:79], v[116:119]
    ds_read_b64_tr_b16 v[140:141], v217 offset:57344
    v_mfma_f32_16x16x32_bf16 v[116:119], v[148:151], a[92:95], v[116:119]
    ds_read_b64_tr_b16 v[142:143], v217 offset:59392
    v_mfma_f32_16x16x32_bf16 v[24:27], v[152:155], a[64:67], v[24:27]
    buffer_load_dwordx4 a[44:47], v246, s[8:11], s35 offen offset:2048 sc1
    v_mfma_f32_16x16x32_bf16 v[24:27], v[156:159], a[80:83], v[24:27]
    v_mfma_f32_16x16x32_bf16 v[28:31], v[152:155], a[68:71], v[28:31]
    buffer_load_dwordx4 a[48:51], v226, s[8:11], s35 offen offset:3072 sc1
    v_mfma_f32_16x16x32_bf16 v[28:31], v[156:159], a[84:87], v[28:31]
    v_mfma_f32_16x16x32_bf16 v[120:123], v[152:155], a[72:75], v[120:123]
    v_mfma_f32_16x16x32_bf16 v[120:123], v[156:159], a[88:91], v[120:123]
    v_mfma_f32_16x16x32_bf16 v[124:127], v[152:155], a[76:79], v[124:127]
    v_mfma_f32_16x16x32_bf16 v[124:127], v[156:159], a[92:95], v[124:127]
    buffer_load_dwordx4 a[52:55], v227, s[8:11], s35 offen offset:3072 sc1
    s_waitcnt vmcnt(18) lgkmcnt(0)
    v_mfma_f32_16x16x32_bf16 v[32:35], v[128:131], a[96:99], v[32:35]
    ds_read_b64_tr_b16 v[144:145], v218 offset:49152
    v_mfma_f32_16x16x32_bf16 v[32:35], v[132:135], a[112:115], v[32:35]
    ds_read_b64_tr_b16 v[146:147], v218 offset:51200
    v_mfma_f32_16x16x32_bf16 v[36:39], v[128:131], a[100:103], v[36:39]
    ds_read_b64_tr_b16 v[148:149], v218 offset:57344
    v_mfma_f32_16x16x32_bf16 v[36:39], v[132:135], a[116:119], v[36:39]
    ds_read_b64_tr_b16 v[150:151], v218 offset:59392
    v_mfma_f32_16x16x32_bf16 v[64:67], v[128:131], a[104:107], v[64:67]
    ds_read_b64_tr_b16 v[152:153], v219 offset:49152
    v_mfma_f32_16x16x32_bf16 v[64:67], v[132:135], a[120:123], v[64:67]
    ds_read_b64_tr_b16 v[154:155], v219 offset:51200
    v_mfma_f32_16x16x32_bf16 v[68:71], v[128:131], a[108:111], v[68:71]
    ds_read_b64_tr_b16 v[156:157], v219 offset:57344
    v_mfma_f32_16x16x32_bf16 v[68:71], v[132:135], a[124:127], v[68:71]
    ds_read_b64_tr_b16 v[158:159], v219 offset:59392
    v_mfma_f32_16x16x32_bf16 v[40:43], v[136:139], a[96:99], v[40:43]
    buffer_load_dwordx4 a[56:59], v245, s[8:11], s35 offen offset:3072 sc1
    v_mfma_f32_16x16x32_bf16 v[40:43], v[140:143], a[112:115], v[40:43]
    s_add_u32 m0, s38, 16384
    s_add_u32 s32, s37, 1179648
    v_mfma_f32_16x16x32_bf16 v[44:47], v[136:139], a[100:103], v[44:47]
    buffer_load_dwordx4 v224, s[12:15], s32 offen lds
    v_mfma_f32_16x16x32_bf16 v[44:47], v[140:143], a[116:119], v[44:47]
    buffer_load_dwordx4 a[60:63], v246, s[8:11], s35 offen offset:3072 sc1
    v_mfma_f32_16x16x32_bf16 v[72:75], v[136:139], a[104:107], v[72:75]
    v_mfma_f32_16x16x32_bf16 v[72:75], v[140:143], a[120:123], v[72:75]
    buffer_load_dwordx4 v225, s[12:15], s32 offen offset:1024 lds
    v_mfma_f32_16x16x32_bf16 v[76:79], v[136:139], a[108:111], v[76:79]
    v_mfma_f32_16x16x32_bf16 v[76:79], v[140:143], a[124:127], v[76:79]
    s_waitcnt lgkmcnt(0)
    v_mfma_f32_16x16x32_bf16 v[48:51], v[144:147], a[96:99], v[48:51]
    ds_read_b64_tr_b16 v[128:129], v220 offset:49152
    v_mfma_f32_16x16x32_bf16 v[48:51], v[148:151], a[112:115], v[48:51]
    ds_read_b64_tr_b16 v[130:131], v220 offset:51200
    v_mfma_f32_16x16x32_bf16 v[52:55], v[144:147], a[100:103], v[52:55]
    ds_read_b64_tr_b16 v[132:133], v220 offset:57344
    v_mfma_f32_16x16x32_bf16 v[52:55], v[148:151], a[116:119], v[52:55]
    ds_read_b64_tr_b16 v[134:135], v220 offset:59392
    v_mfma_f32_16x16x32_bf16 v[80:83], v[144:147], a[104:107], v[80:83]
    ds_read_b64_tr_b16 v[136:137], v221 offset:49152
    v_mfma_f32_16x16x32_bf16 v[80:83], v[148:151], a[120:123], v[80:83]
    ds_read_b64_tr_b16 v[138:139], v221 offset:51200
    v_mfma_f32_16x16x32_bf16 v[84:87], v[144:147], a[108:111], v[84:87]
    ds_read_b64_tr_b16 v[140:141], v221 offset:57344
    v_mfma_f32_16x16x32_bf16 v[84:87], v[148:151], a[124:127], v[84:87]
    ds_read_b64_tr_b16 v[142:143], v221 offset:59392
    v_mfma_f32_16x16x32_bf16 v[56:59], v[152:155], a[96:99], v[56:59]
    s_add_u32 s35, s35, 4096
    buffer_load_dwordx4 a[64:67], v226, s[8:11], s35 offen offset:0 sc1
    v_mfma_f32_16x16x32_bf16 v[56:59], v[156:159], a[112:115], v[56:59]
    v_mfma_f32_16x16x32_bf16 v[60:63], v[152:155], a[100:103], v[60:63]
    buffer_load_dwordx4 a[68:71], v227, s[8:11], s35 offen offset:0 sc1
    v_mfma_f32_16x16x32_bf16 v[60:63], v[156:159], a[116:119], v[60:63]
    v_mfma_f32_16x16x32_bf16 v[88:91], v[152:155], a[104:107], v[88:91]
    v_mfma_f32_16x16x32_bf16 v[88:91], v[156:159], a[120:123], v[88:91]
    v_mfma_f32_16x16x32_bf16 v[92:95], v[152:155], a[108:111], v[92:95]
    v_mfma_f32_16x16x32_bf16 v[92:95], v[156:159], a[124:127], v[92:95]
    buffer_load_dwordx4 a[72:75], v245, s[8:11], s35 offen offset:0 sc1
    s_waitcnt lgkmcnt(0)
    v_mfma_f32_16x16x32_bf16 v[0:3], v[128:131], a[96:99], v[0:3]
    ds_read_b64_tr_b16 v[144:145], v222 offset:49152
    v_mfma_f32_16x16x32_bf16 v[0:3], v[132:135], a[112:115], v[0:3]
    ds_read_b64_tr_b16 v[146:147], v222 offset:51200
    v_mfma_f32_16x16x32_bf16 v[4:7], v[128:131], a[100:103], v[4:7]
    ds_read_b64_tr_b16 v[148:149], v222 offset:57344
    v_mfma_f32_16x16x32_bf16 v[4:7], v[132:135], a[116:119], v[4:7]
    ds_read_b64_tr_b16 v[150:151], v222 offset:59392
    v_mfma_f32_16x16x32_bf16 v[96:99], v[128:131], a[104:107], v[96:99]
    ds_read_b64_tr_b16 v[152:153], v223 offset:49152
    v_mfma_f32_16x16x32_bf16 v[96:99], v[132:135], a[120:123], v[96:99]
    ds_read_b64_tr_b16 v[154:155], v223 offset:51200
    v_mfma_f32_16x16x32_bf16 v[100:103], v[128:131], a[108:111], v[100:103]
    ds_read_b64_tr_b16 v[156:157], v223 offset:57344
    v_mfma_f32_16x16x32_bf16 v[100:103], v[132:135], a[124:127], v[100:103]
    ds_read_b64_tr_b16 v[158:159], v223 offset:59392
    v_mfma_f32_16x16x32_bf16 v[8:11], v[136:139], a[96:99], v[8:11]
    buffer_load_dwordx4 a[76:79], v246, s[8:11], s35 offen offset:0 sc1
    v_mfma_f32_16x16x32_bf16 v[8:11], v[140:143], a[112:115], v[8:11]
    s_add_u32 m0, s38, 24576
    s_add_u32 s32, s37, 1245184
    v_mfma_f32_16x16x32_bf16 v[12:15], v[136:139], a[100:103], v[12:15]
    buffer_load_dwordx4 v224, s[12:15], s32 offen lds
    v_mfma_f32_16x16x32_bf16 v[12:15], v[140:143], a[116:119], v[12:15]
    v_mfma_f32_16x16x32_bf16 v[104:107], v[136:139], a[104:107], v[104:107]
    v_mfma_f32_16x16x32_bf16 v[104:107], v[140:143], a[120:123], v[104:107]
    buffer_load_dwordx4 v225, s[12:15], s32 offen offset:1024 lds
    v_mfma_f32_16x16x32_bf16 v[108:111], v[136:139], a[108:111], v[108:111]
    v_mfma_f32_16x16x32_bf16 v[108:111], v[140:143], a[124:127], v[108:111]
    buffer_load_dwordx4 a[80:83], v226, s[8:11], s35 offen offset:1024 sc1
    s_waitcnt lgkmcnt(0)
    s_barrier
    v_mfma_f32_16x16x32_bf16 v[16:19], v[144:147], a[96:99], v[16:19]
    v_xor_b32 v216, 0x10000, v216
    ds_read_b64_tr_b16 v[128:129], v216 offset:0
    v_mfma_f32_16x16x32_bf16 v[16:19], v[148:151], a[112:115], v[16:19]
    ds_read_b64_tr_b16 v[130:131], v216 offset:2048
    v_mfma_f32_16x16x32_bf16 v[20:23], v[144:147], a[100:103], v[20:23]
    ds_read_b64_tr_b16 v[132:133], v216 offset:8192
    v_mfma_f32_16x16x32_bf16 v[20:23], v[148:151], a[116:119], v[20:23]
    ds_read_b64_tr_b16 v[134:135], v216 offset:10240
    v_mfma_f32_16x16x32_bf16 v[112:115], v[144:147], a[104:107], v[112:115]
    v_xor_b32 v217, 0x10000, v217
    ds_read_b64_tr_b16 v[136:137], v217 offset:0
    v_mfma_f32_16x16x32_bf16 v[112:115], v[148:151], a[120:123], v[112:115]
    ds_read_b64_tr_b16 v[138:139], v217 offset:2048
    v_mfma_f32_16x16x32_bf16 v[116:119], v[144:147], a[108:111], v[116:119]
    ds_read_b64_tr_b16 v[140:141], v217 offset:8192
    v_mfma_f32_16x16x32_bf16 v[116:119], v[148:151], a[124:127], v[116:119]
    ds_read_b64_tr_b16 v[142:143], v217 offset:10240
    v_mfma_f32_16x16x32_bf16 v[24:27], v[152:155], a[96:99], v[24:27]
    buffer_load_dwordx4 a[84:87], v227, s[8:11], s35 offen offset:1024 sc1
    v_mfma_f32_16x16x32_bf16 v[24:27], v[156:159], a[112:115], v[24:27]
    v_mfma_f32_16x16x32_bf16 v[28:31], v[152:155], a[100:103], v[28:31]
    buffer_load_dwordx4 a[88:91], v245, s[8:11], s35 offen offset:1024 sc1
    v_mfma_f32_16x16x32_bf16 v[28:31], v[156:159], a[116:119], v[28:31]
    v_mfma_f32_16x16x32_bf16 v[120:123], v[152:155], a[104:107], v[120:123]
    v_mfma_f32_16x16x32_bf16 v[120:123], v[156:159], a[120:123], v[120:123]
    v_mfma_f32_16x16x32_bf16 v[124:127], v[152:155], a[108:111], v[124:127]
    v_mfma_f32_16x16x32_bf16 v[124:127], v[156:159], a[124:127], v[124:127]
    s_waitcnt vmcnt(21) lgkmcnt(0)
    v_mfma_f32_16x16x32_bf16 v[32:35], v[128:131], a[0:3], v[32:35]
    v_xor_b32 v218, 0x10000, v218
    ds_read_b64_tr_b16 v[144:145], v218 offset:0
    v_mfma_f32_16x16x32_bf16 v[32:35], v[132:135], a[16:19], v[32:35]
    ds_read_b64_tr_b16 v[146:147], v218 offset:2048
    v_mfma_f32_16x16x32_bf16 v[36:39], v[128:131], a[4:7], v[36:39]
    ds_read_b64_tr_b16 v[148:149], v218 offset:8192
    v_mfma_f32_16x16x32_bf16 v[36:39], v[132:135], a[20:23], v[36:39]
    ds_read_b64_tr_b16 v[150:151], v218 offset:10240
    v_mfma_f32_16x16x32_bf16 v[64:67], v[128:131], a[8:11], v[64:67]
    v_xor_b32 v219, 0x10000, v219
    ds_read_b64_tr_b16 v[152:153], v219 offset:0
    v_mfma_f32_16x16x32_bf16 v[64:67], v[132:135], a[24:27], v[64:67]
    ds_read_b64_tr_b16 v[154:155], v219 offset:2048
    v_mfma_f32_16x16x32_bf16 v[68:71], v[128:131], a[12:15], v[68:71]
    ds_read_b64_tr_b16 v[156:157], v219 offset:8192
    v_mfma_f32_16x16x32_bf16 v[68:71], v[132:135], a[28:31], v[68:71]
    ds_read_b64_tr_b16 v[158:159], v219 offset:10240
    v_mfma_f32_16x16x32_bf16 v[40:43], v[136:139], a[0:3], v[40:43]
    buffer_load_dwordx4 a[92:95], v246, s[8:11], s35 offen offset:1024 sc1
    v_mfma_f32_16x16x32_bf16 v[40:43], v[140:143], a[16:19], v[40:43]
    s_add_u32 m0, s38, 32768
    s_add_u32 s32, s37, 1310720
    v_mfma_f32_16x16x32_bf16 v[44:47], v[136:139], a[4:7], v[44:47]
    buffer_load_dwordx4 v224, s[12:15], s32 offen lds
    v_mfma_f32_16x16x32_bf16 v[44:47], v[140:143], a[20:23], v[44:47]
    buffer_load_dwordx4 a[96:99], v226, s[8:11], s35 offen offset:2048 sc1
    v_mfma_f32_16x16x32_bf16 v[72:75], v[136:139], a[8:11], v[72:75]
    v_mfma_f32_16x16x32_bf16 v[72:75], v[140:143], a[24:27], v[72:75]
    buffer_load_dwordx4 v225, s[12:15], s32 offen offset:1024 lds
    v_mfma_f32_16x16x32_bf16 v[76:79], v[136:139], a[12:15], v[76:79]
    s_lshl_b32 s45, s52, 7
    s_add_u32 s45, s45, 0x38a1400
    v_mfma_f32_16x16x32_bf16 v[76:79], v[140:143], a[28:31], v[76:79]
    buffer_load_dwordx4 a[100:103], v227, s[8:11], s35 offen offset:2048 sc1
    s_waitcnt lgkmcnt(0)
    v_mfma_f32_16x16x32_bf16 v[48:51], v[144:147], a[0:3], v[48:51]
    v_xor_b32 v220, 0x10000, v220
    ds_read_b64_tr_b16 v[128:129], v220 offset:0
    v_mfma_f32_16x16x32_bf16 v[48:51], v[148:151], a[16:19], v[48:51]
    ds_read_b64_tr_b16 v[130:131], v220 offset:2048
    v_mfma_f32_16x16x32_bf16 v[52:55], v[144:147], a[4:7], v[52:55]
    ds_read_b64_tr_b16 v[132:133], v220 offset:8192
    v_mfma_f32_16x16x32_bf16 v[52:55], v[148:151], a[20:23], v[52:55]
    ds_read_b64_tr_b16 v[134:135], v220 offset:10240
    v_mfma_f32_16x16x32_bf16 v[80:83], v[144:147], a[8:11], v[80:83]
    v_xor_b32 v221, 0x10000, v221
    ds_read_b64_tr_b16 v[136:137], v221 offset:0
    v_mfma_f32_16x16x32_bf16 v[80:83], v[148:151], a[24:27], v[80:83]
    ds_read_b64_tr_b16 v[138:139], v221 offset:2048
    v_mfma_f32_16x16x32_bf16 v[84:87], v[144:147], a[12:15], v[84:87]
    ds_read_b64_tr_b16 v[140:141], v221 offset:8192
    v_mfma_f32_16x16x32_bf16 v[84:87], v[148:151], a[28:31], v[84:87]
    ds_read_b64_tr_b16 v[142:143], v221 offset:10240
    v_mfma_f32_16x16x32_bf16 v[56:59], v[152:155], a[0:3], v[56:59]
    buffer_load_dwordx4 a[104:107], v245, s[8:11], s35 offen offset:2048 sc1
    v_mfma_f32_16x16x32_bf16 v[56:59], v[156:159], a[16:19], v[56:59]
    s_cmp_eq_u32 s3, 0
    s_cselect_b32 s45, s45, 0x40000000
    v_mfma_f32_16x16x32_bf16 v[60:63], v[152:155], a[4:7], v[60:63]
    buffer_load_dwordx4 a[108:111], v246, s[8:11], s35 offen offset:2048 sc1
    buffer_load_dword v235, off, s[8:11], s45 sc1
    v_mfma_f32_16x16x32_bf16 v[60:63], v[156:159], a[20:23], v[60:63]
    v_mfma_f32_16x16x32_bf16 v[88:91], v[152:155], a[8:11], v[88:91]
    v_mfma_f32_16x16x32_bf16 v[88:91], v[156:159], a[24:27], v[88:91]
    v_mfma_f32_16x16x32_bf16 v[92:95], v[152:155], a[12:15], v[92:95]
    v_mfma_f32_16x16x32_bf16 v[92:95], v[156:159], a[28:31], v[92:95]
    s_waitcnt lgkmcnt(0)
    v_mfma_f32_16x16x32_bf16 v[0:3], v[128:131], a[0:3], v[0:3]
    v_xor_b32 v222, 0x10000, v222
    ds_read_b64_tr_b16 v[144:145], v222 offset:0
    v_mfma_f32_16x16x32_bf16 v[0:3], v[132:135], a[16:19], v[0:3]
    ds_read_b64_tr_b16 v[146:147], v222 offset:2048
    v_mfma_f32_16x16x32_bf16 v[4:7], v[128:131], a[4:7], v[4:7]
    ds_read_b64_tr_b16 v[148:149], v222 offset:8192
    v_mfma_f32_16x16x32_bf16 v[4:7], v[132:135], a[20:23], v[4:7]
    ds_read_b64_tr_b16 v[150:151], v222 offset:10240
    v_mfma_f32_16x16x32_bf16 v[96:99], v[128:131], a[8:11], v[96:99]
    v_xor_b32 v223, 0x10000, v223
    ds_read_b64_tr_b16 v[152:153], v223 offset:0
    v_mfma_f32_16x16x32_bf16 v[96:99], v[132:135], a[24:27], v[96:99]
    ds_read_b64_tr_b16 v[154:155], v223 offset:2048
    v_mfma_f32_16x16x32_bf16 v[100:103], v[128:131], a[12:15], v[100:103]
    ds_read_b64_tr_b16 v[156:157], v223 offset:8192
    v_mfma_f32_16x16x32_bf16 v[100:103], v[132:135], a[28:31], v[100:103]
    ds_read_b64_tr_b16 v[158:159], v223 offset:10240
    v_mfma_f32_16x16x32_bf16 v[8:11], v[136:139], a[0:3], v[8:11]
    buffer_load_dwordx4 a[112:115], v226, s[8:11], s35 offen offset:3072 sc1
    v_mfma_f32_16x16x32_bf16 v[8:11], v[140:143], a[16:19], v[8:11]
    s_add_u32 m0, s38, 40960
    s_add_u32 s32, s37, 1376256
    v_mfma_f32_16x16x32_bf16 v[12:15], v[136:139], a[4:7], v[12:15]
    buffer_load_dwordx4 v224, s[12:15], s32 offen lds
    v_mfma_f32_16x16x32_bf16 v[12:15], v[140:143], a[20:23], v[12:15]
    buffer_load_dwordx4 a[116:119], v227, s[8:11], s35 offen offset:3072 sc1
    v_mfma_f32_16x16x32_bf16 v[104:107], v[136:139], a[8:11], v[104:107]
    v_mfma_f32_16x16x32_bf16 v[104:107], v[140:143], a[24:27], v[104:107]
    buffer_load_dwordx4 v225, s[12:15], s32 offen offset:1024 lds
    v_mfma_f32_16x16x32_bf16 v[108:111], v[136:139], a[12:15], v[108:111]
    v_mfma_f32_16x16x32_bf16 v[108:111], v[140:143], a[28:31], v[108:111]
    buffer_load_dwordx4 a[120:123], v245, s[8:11], s35 offen offset:3072 sc1
    s_waitcnt lgkmcnt(0)
    v_mfma_f32_16x16x32_bf16 v[16:19], v[144:147], a[0:3], v[16:19]
    ds_read_b64_tr_b16 v[128:129], v216 offset:16384
    v_mfma_f32_16x16x32_bf16 v[16:19], v[148:151], a[16:19], v[16:19]
    ds_read_b64_tr_b16 v[130:131], v216 offset:18432
    v_mfma_f32_16x16x32_bf16 v[20:23], v[144:147], a[4:7], v[20:23]
    ds_read_b64_tr_b16 v[132:133], v216 offset:24576
    v_mfma_f32_16x16x32_bf16 v[20:23], v[148:151], a[20:23], v[20:23]
    ds_read_b64_tr_b16 v[134:135], v216 offset:26624
    v_mfma_f32_16x16x32_bf16 v[112:115], v[144:147], a[8:11], v[112:115]
    ds_read_b64_tr_b16 v[136:137], v217 offset:16384
    v_mfma_f32_16x16x32_bf16 v[112:115], v[148:151], a[24:27], v[112:115]
    ds_read_b64_tr_b16 v[138:139], v217 offset:18432
    v_mfma_f32_16x16x32_bf16 v[116:119], v[144:147], a[12:15], v[116:119]
    ds_read_b64_tr_b16 v[140:141], v217 offset:24576
    v_mfma_f32_16x16x32_bf16 v[116:119], v[148:151], a[28:31], v[116:119]
    ds_read_b64_tr_b16 v[142:143], v217 offset:26624
    v_mfma_f32_16x16x32_bf16 v[24:27], v[152:155], a[0:3], v[24:27]
    buffer_load_dwordx4 a[124:127], v246, s[8:11], s35 offen offset:3072 sc1
    v_mfma_f32_16x16x32_bf16 v[24:27], v[156:159], a[16:19], v[24:27]
    v_mfma_f32_16x16x32_bf16 v[28:31], v[152:155], a[4:7], v[28:31]
    v_mfma_f32_16x16x32_bf16 v[28:31], v[156:159], a[20:23], v[28:31]
    v_mfma_f32_16x16x32_bf16 v[120:123], v[152:155], a[8:11], v[120:123]
    v_mfma_f32_16x16x32_bf16 v[120:123], v[156:159], a[24:27], v[120:123]
    v_mfma_f32_16x16x32_bf16 v[124:127], v[152:155], a[12:15], v[124:127]
    v_mfma_f32_16x16x32_bf16 v[124:127], v[156:159], a[28:31], v[124:127]
    s_add_u32 s35, s35, 4096
    buffer_load_dwordx4 a[0:3], v226, s[8:11], s35 offen offset:0 sc1
    s_waitcnt vmcnt(25) lgkmcnt(0)
    v_mfma_f32_16x16x32_bf16 v[32:35], v[128:131], a[32:35], v[32:35]
    ds_read_b64_tr_b16 v[144:145], v218 offset:16384
    v_mfma_f32_16x16x32_bf16 v[32:35], v[132:135], a[48:51], v[32:35]
    ds_read_b64_tr_b16 v[146:147], v218 offset:18432
    v_mfma_f32_16x16x32_bf16 v[36:39], v[128:131], a[36:39], v[36:39]
    ds_read_b64_tr_b16 v[148:149], v218 offset:24576
    v_mfma_f32_16x16x32_bf16 v[36:39], v[132:135], a[52:55], v[36:39]
    ds_read_b64_tr_b16 v[150:151], v218 offset:26624
    v_mfma_f32_16x16x32_bf16 v[64:67], v[128:131], a[40:43], v[64:67]
    ds_read_b64_tr_b16 v[152:153], v219 offset:16384
    v_mfma_f32_16x16x32_bf16 v[64:67], v[132:135], a[56:59], v[64:67]
    ds_read_b64_tr_b16 v[154:155], v219 offset:18432
    v_mfma_f32_16x16x32_bf16 v[68:71], v[128:131], a[44:47], v[68:71]
    ds_read_b64_tr_b16 v[156:157], v219 offset:24576
    v_mfma_f32_16x16x32_bf16 v[68:71], v[132:135], a[60:63], v[68:71]
    ds_read_b64_tr_b16 v[158:159], v219 offset:26624
    v_mfma_f32_16x16x32_bf16 v[40:43], v[136:139], a[32:35], v[40:43]
    buffer_load_dwordx4 a[4:7], v227, s[8:11], s35 offen offset:0 sc1
    v_mfma_f32_16x16x32_bf16 v[40:43], v[140:143], a[48:51], v[40:43]
    s_add_u32 m0, s38, 49152
    s_add_u32 s32, s37, 1441792
    v_mfma_f32_16x16x32_bf16 v[44:47], v[136:139], a[36:39], v[44:47]
    buffer_load_dwordx4 v224, s[12:15], s32 offen lds
    v_mfma_f32_16x16x32_bf16 v[44:47], v[140:143], a[52:55], v[44:47]
    buffer_load_dwordx4 a[8:11], v245, s[8:11], s35 offen offset:0 sc1
    v_mfma_f32_16x16x32_bf16 v[72:75], v[136:139], a[40:43], v[72:75]
    v_mfma_f32_16x16x32_bf16 v[72:75], v[140:143], a[56:59], v[72:75]
    buffer_load_dwordx4 v225, s[12:15], s32 offen offset:1024 lds
    v_mfma_f32_16x16x32_bf16 v[76:79], v[136:139], a[44:47], v[76:79]
    v_mfma_f32_16x16x32_bf16 v[76:79], v[140:143], a[60:63], v[76:79]
    buffer_load_dwordx4 a[12:15], v246, s[8:11], s35 offen offset:0 sc1
    s_waitcnt lgkmcnt(0)
    v_mfma_f32_16x16x32_bf16 v[48:51], v[144:147], a[32:35], v[48:51]
    ds_read_b64_tr_b16 v[128:129], v220 offset:16384
    v_mfma_f32_16x16x32_bf16 v[48:51], v[148:151], a[48:51], v[48:51]
    ds_read_b64_tr_b16 v[130:131], v220 offset:18432
    v_mfma_f32_16x16x32_bf16 v[52:55], v[144:147], a[36:39], v[52:55]
    ds_read_b64_tr_b16 v[132:133], v220 offset:24576
    v_mfma_f32_16x16x32_bf16 v[52:55], v[148:151], a[52:55], v[52:55]
    ds_read_b64_tr_b16 v[134:135], v220 offset:26624
    v_mfma_f32_16x16x32_bf16 v[80:83], v[144:147], a[40:43], v[80:83]
    ds_read_b64_tr_b16 v[136:137], v221 offset:16384
    v_mfma_f32_16x16x32_bf16 v[80:83], v[148:151], a[56:59], v[80:83]
    ds_read_b64_tr_b16 v[138:139], v221 offset:18432
    v_mfma_f32_16x16x32_bf16 v[84:87], v[144:147], a[44:47], v[84:87]
    ds_read_b64_tr_b16 v[140:141], v221 offset:24576
    v_mfma_f32_16x16x32_bf16 v[84:87], v[148:151], a[60:63], v[84:87]
    ds_read_b64_tr_b16 v[142:143], v221 offset:26624
    v_mfma_f32_16x16x32_bf16 v[56:59], v[152:155], a[32:35], v[56:59]
    buffer_load_dwordx4 a[16:19], v226, s[8:11], s35 offen offset:1024 sc1
    v_mfma_f32_16x16x32_bf16 v[56:59], v[156:159], a[48:51], v[56:59]
    v_mfma_f32_16x16x32_bf16 v[60:63], v[152:155], a[36:39], v[60:63]
    v_mfma_f32_16x16x32_bf16 v[60:63], v[156:159], a[52:55], v[60:63]
    v_mfma_f32_16x16x32_bf16 v[88:91], v[152:155], a[40:43], v[88:91]
    buffer_load_dwordx4 a[20:23], v227, s[8:11], s35 offen offset:1024 sc1
    v_mfma_f32_16x16x32_bf16 v[88:91], v[156:159], a[56:59], v[88:91]
    v_mfma_f32_16x16x32_bf16 v[92:95], v[152:155], a[44:47], v[92:95]
    v_mfma_f32_16x16x32_bf16 v[92:95], v[156:159], a[60:63], v[92:95]
    s_waitcnt lgkmcnt(0)
    v_mfma_f32_16x16x32_bf16 v[0:3], v[128:131], a[32:35], v[0:3]
    ds_read_b64_tr_b16 v[144:145], v222 offset:16384
    v_mfma_f32_16x16x32_bf16 v[0:3], v[132:135], a[48:51], v[0:3]
    ds_read_b64_tr_b16 v[146:147], v222 offset:18432
    v_mfma_f32_16x16x32_bf16 v[4:7], v[128:131], a[36:39], v[4:7]
    ds_read_b64_tr_b16 v[148:149], v222 offset:24576
    v_mfma_f32_16x16x32_bf16 v[4:7], v[132:135], a[52:55], v[4:7]
    ds_read_b64_tr_b16 v[150:151], v222 offset:26624
    v_mfma_f32_16x16x32_bf16 v[96:99], v[128:131], a[40:43], v[96:99]
    ds_read_b64_tr_b16 v[152:153], v223 offset:16384
    v_mfma_f32_16x16x32_bf16 v[96:99], v[132:135], a[56:59], v[96:99]
    ds_read_b64_tr_b16 v[154:155], v223 offset:18432
    v_mfma_f32_16x16x32_bf16 v[100:103], v[128:131], a[44:47], v[100:103]
    ds_read_b64_tr_b16 v[156:157], v223 offset:24576
    v_mfma_f32_16x16x32_bf16 v[100:103], v[132:135], a[60:63], v[100:103]
    ds_read_b64_tr_b16 v[158:159], v223 offset:26624
    v_mfma_f32_16x16x32_bf16 v[8:11], v[136:139], a[32:35], v[8:11]
    buffer_load_dwordx4 a[24:27], v245, s[8:11], s35 offen offset:1024 sc1
    v_mfma_f32_16x16x32_bf16 v[8:11], v[140:143], a[48:51], v[8:11]
    s_add_u32 m0, s38, 57344
    s_add_u32 s32, s37, 1507328
    v_mfma_f32_16x16x32_bf16 v[12:15], v[136:139], a[36:39], v[12:15]
    buffer_load_dwordx4 v224, s[12:15], s32 offen lds
    v_mfma_f32_16x16x32_bf16 v[12:15], v[140:143], a[52:55], v[12:15]
    buffer_load_dwordx4 a[28:31], v246, s[8:11], s35 offen offset:1024 sc1
    v_mfma_f32_16x16x32_bf16 v[104:107], v[136:139], a[40:43], v[104:107]
    v_mfma_f32_16x16x32_bf16 v[104:107], v[140:143], a[56:59], v[104:107]
    buffer_load_dwordx4 v225, s[12:15], s32 offen offset:1024 lds
    v_mfma_f32_16x16x32_bf16 v[108:111], v[136:139], a[44:47], v[108:111]
    s_waitcnt vmcnt(18)
    v_readfirstlane_b32 s36, v235
    s_lshl_b32 s34, s3, 8
    s_add_u32 s36, s36, s34
    s_cmp_ge_u32 s36, 8
    s_cbranch_scc0 kc_g
kc_gr:
    v_mfma_f32_16x16x32_bf16 v[108:111], v[140:143], a[60:63], v[108:111]
    s_waitcnt lgkmcnt(0)
    s_barrier
    v_mfma_f32_16x16x32_bf16 v[16:19], v[144:147], a[32:35], v[16:19]
    ds_read_b64_tr_b16 v[128:129], v216 offset:32768
    v_mfma_f32_16x16x32_bf16 v[16:19], v[148:151], a[48:51], v[16:19]
    ds_read_b64_tr_b16 v[130:131], v216 offset:34816
    v_mfma_f32_16x16x32_bf16 v[20:23], v[144:147], a[36:39], v[20:23]
    ds_read_b64_tr_b16 v[132:133], v216 offset:40960
    v_mfma_f32_16x16x32_bf16 v[20:23], v[148:151], a[52:55], v[20:23]
    ds_read_b64_tr_b16 v[134:135], v216 offset:43008
    v_mfma_f32_16x16x32_bf16 v[112:115], v[144:147], a[40:43], v[112:115]
    ds_read_b64_tr_b16 v[136:137], v217 offset:32768
    v_mfma_f32_16x16x32_bf16 v[112:115], v[148:151], a[56:59], v[112:115]
    ds_read_b64_tr_b16 v[138:139], v217 offset:34816
    v_mfma_f32_16x16x32_bf16 v[116:119], v[144:147], a[44:47], v[116:119]
    ds_read_b64_tr_b16 v[140:141], v217 offset:40960
    v_mfma_f32_16x16x32_bf16 v[116:119], v[148:151], a[60:63], v[116:119]
    ds_read_b64_tr_b16 v[142:143], v217 offset:43008
    v_mfma_f32_16x16x32_bf16 v[24:27], v[152:155], a[32:35], v[24:27]
    v_mfma_f32_16x16x32_bf16 v[24:27], v[156:159], a[48:51], v[24:27]
    v_mfma_f32_16x16x32_bf16 v[28:31], v[152:155], a[36:39], v[28:31]
    v_mfma_f32_16x16x32_bf16 v[28:31], v[156:159], a[52:55], v[28:31]
    v_mfma_f32_16x16x32_bf16 v[120:123], v[152:155], a[40:43], v[120:123]
    v_mfma_f32_16x16x32_bf16 v[120:123], v[156:159], a[56:59], v[120:123]
    v_mfma_f32_16x16x32_bf16 v[124:127], v[152:155], a[44:47], v[124:127]
    v_mfma_f32_16x16x32_bf16 v[124:127], v[156:159], a[60:63], v[124:127]
    buffer_load_dwordx4 a[32:35], v226, s[8:11], s35 offen offset:2048 sc1
    s_waitcnt vmcnt(26) lgkmcnt(0)
    v_mfma_f32_16x16x32_bf16 v[32:35], v[128:131], a[64:67], v[32:35]
    ds_read_b64_tr_b16 v[144:145], v218 offset:32768
    v_mfma_f32_16x16x32_bf16 v[32:35], v[132:135], a[80:83], v[32:35]
    ds_read_b64_tr_b16 v[146:147], v218 offset:34816
    v_mfma_f32_16x16x32_bf16 v[36:39], v[128:131], a[68:71], v[36:39]
    ds_read_b64_tr_b16 v[148:149], v218 offset:40960
    v_mfma_f32_16x16x32_bf16 v[36:39], v[132:135], a[84:87], v[36:39]
    ds_read_b64_tr_b16 v[150:151], v218 offset:43008
    v_mfma_f32_16x16x32_bf16 v[64:67], v[128:131], a[72:75], v[64:67]
    ds_read_b64_tr_b16 v[152:153], v219 offset:32768
    v_mfma_f32_16x16x32_bf16 v[64:67], v[132:135], a[88:91], v[64:67]
    ds_read_b64_tr_b16 v[154:155], v219 offset:34816
    v_mfma_f32_16x16x32_bf16 v[68:71], v[128:131], a[76:79], v[68:71]
    ds_read_b64_tr_b16 v[156:157], v219 offset:40960
    v_mfma_f32_16x16x32_bf16 v[68:71], v[132:135], a[92:95], v[68:71]
    ds_read_b64_tr_b16 v[158:159], v219 offset:43008
    v_mfma_f32_16x16x32_bf16 v[40:43], v[136:139], a[64:67], v[40:43]
    buffer_load_dwordx4 a[36:39], v227, s[8:11], s35 offen offset:2048 sc1
    v_mfma_f32_16x16x32_bf16 v[40:43], v[140:143], a[80:83], v[40:43]
    s_add_u32 m0, s38, 65536
    s_add_u32 s32, s37, 1572864
    v_mfma_f32_16x16x32_bf16 v[44:47], v[136:139], a[68:71], v[44:47]
    buffer_load_dwordx4 v224, s[12:15], s32 offen lds
    v_mfma_f32_16x16x32_bf16 v[44:47], v[140:143], a[84:87], v[44:47]
    buffer_load_dwordx4 a[40:43], v245, s[8:11], s35 offen offset:2048 sc1
    v_mfma_f32_16x16x32_bf16 v[72:75], v[136:139], a[72:75], v[72:75]
    v_mfma_f32_16x16x32_bf16 v[72:75], v[140:143], a[88:91], v[72:75]
    buffer_load_dwordx4 v225, s[12:15], s32 offen offset:1024 lds
    v_mfma_f32_16x16x32_bf16 v[76:79], v[136:139], a[76:79], v[76:79]
    s_add_u32 s33, s55, 0
    buffer_load_dwordx4 a[128:131], v228, s[8:11], s33 offen offset:0 sc1
    v_mfma_f32_16x16x32_bf16 v[76:79], v[140:143], a[92:95], v[76:79]
    buffer_load_dwordx4 a[44:47], v246, s[8:11], s35 offen offset:2048 sc1
    s_waitcnt lgkmcnt(0)
    v_mfma_f32_16x16x32_bf16 v[48:51], v[144:147], a[64:67], v[48:51]
    ds_read_b64_tr_b16 v[128:129], v220 offset:32768
    v_mfma_f32_16x16x32_bf16 v[48:51], v[148:151], a[80:83], v[48:51]
    ds_read_b64_tr_b16 v[130:131], v220 offset:34816
    v_mfma_f32_16x16x32_bf16 v[52:55], v[144:147], a[68:71], v[52:55]
    ds_read_b64_tr_b16 v[132:133], v220 offset:40960
    v_mfma_f32_16x16x32_bf16 v[52:55], v[148:151], a[84:87], v[52:55]
    ds_read_b64_tr_b16 v[134:135], v220 offset:43008
    v_mfma_f32_16x16x32_bf16 v[80:83], v[144:147], a[72:75], v[80:83]
    ds_read_b64_tr_b16 v[136:137], v221 offset:32768
    v_mfma_f32_16x16x32_bf16 v[80:83], v[148:151], a[88:91], v[80:83]
    ds_read_b64_tr_b16 v[138:139], v221 offset:34816
    v_mfma_f32_16x16x32_bf16 v[84:87], v[144:147], a[76:79], v[84:87]
    ds_read_b64_tr_b16 v[140:141], v221 offset:40960
    v_mfma_f32_16x16x32_bf16 v[84:87], v[148:151], a[92:95], v[84:87]
    ds_read_b64_tr_b16 v[142:143], v221 offset:43008
    v_mfma_f32_16x16x32_bf16 v[56:59], v[152:155], a[64:67], v[56:59]
    buffer_load_dwordx4 a[48:51], v226, s[8:11], s35 offen offset:3072 sc1
    v_mfma_f32_16x16x32_bf16 v[56:59], v[156:159], a[80:83], v[56:59]
    v_mfma_f32_16x16x32_bf16 v[60:63], v[152:155], a[68:71], v[60:63]
    buffer_load_dwordx4 a[52:55], v227, s[8:11], s35 offen offset:3072 sc1
    v_mfma_f32_16x16x32_bf16 v[60:63], v[156:159], a[84:87], v[60:63]
    v_mfma_f32_16x16x32_bf16 v[88:91], v[152:155], a[72:75], v[88:91]
    buffer_load_dwordx4 a[56:59], v245, s[8:11], s35 offen offset:3072 sc1
    v_mfma_f32_16x16x32_bf16 v[88:91], v[156:159], a[88:91], v[88:91]
    v_mfma_f32_16x16x32_bf16 v[92:95], v[152:155], a[76:79], v[92:95]
    buffer_load_dwordx4 a[132:135], v228, s[8:11], s33 offen offset:1024 sc1
    v_mfma_f32_16x16x32_bf16 v[92:95], v[156:159], a[92:95], v[92:95]
    buffer_load_dwordx4 a[60:63], v246, s[8:11], s35 offen offset:3072 sc1
    s_waitcnt lgkmcnt(0)
    v_mfma_f32_16x16x32_bf16 v[0:3], v[128:131], a[64:67], v[0:3]
    ds_read_b64_tr_b16 v[144:145], v222 offset:32768
    v_mfma_f32_16x16x32_bf16 v[0:3], v[132:135], a[80:83], v[0:3]
    ds_read_b64_tr_b16 v[146:147], v222 offset:34816
    v_mfma_f32_16x16x32_bf16 v[4:7], v[128:131], a[68:71], v[4:7]
    ds_read_b64_tr_b16 v[148:149], v222 offset:40960
    v_mfma_f32_16x16x32_bf16 v[4:7], v[132:135], a[84:87], v[4:7]
    ds_read_b64_tr_b16 v[150:151], v222 offset:43008
    v_mfma_f32_16x16x32_bf16 v[96:99], v[128:131], a[72:75], v[96:99]
    ds_read_b64_tr_b16 v[152:153], v223 offset:32768
    v_mfma_f32_16x16x32_bf16 v[96:99], v[132:135], a[88:91], v[96:99]
    ds_read_b64_tr_b16 v[154:155], v223 offset:34816
    v_mfma_f32_16x16x32_bf16 v[100:103], v[128:131], a[76:79], v[100:103]
    ds_read_b64_tr_b16 v[156:157], v223 offset:40960
    v_mfma_f32_16x16x32_bf16 v[100:103], v[132:135], a[92:95], v[100:103]
    ds_read_b64_tr_b16 v[158:159], v223 offset:43008
    v_mfma_f32_16x16x32_bf16 v[8:11], v[136:139], a[64:67], v[8:11]
    v_mfma_f32_16x16x32_bf16 v[8:11], v[140:143], a[80:83], v[8:11]
    s_add_u32 m0, s38, 73728
    s_add_u32 s32, s37, 1638400
    v_mfma_f32_16x16x32_bf16 v[12:15], v[136:139], a[68:71], v[12:15]
    buffer_load_dwordx4 v224, s[12:15], s32 offen lds
    v_mfma_f32_16x16x32_bf16 v[12:15], v[140:143], a[84:87], v[12:15]
    v_mfma_f32_16x16x32_bf16 v[104:107], v[136:139], a[72:75], v[104:107]
    v_mfma_f32_16x16x32_bf16 v[104:107], v[140:143], a[88:91], v[104:107]
    buffer_load_dwordx4 v225, s[12:15], s32 offen offset:1024 lds
    v_mfma_f32_16x16x32_bf16 v[108:111], v[136:139], a[76:79], v[108:111]
    buffer_load_dwordx4 a[136:139], v228, s[8:11], s33 offen offset:2048 sc1
    v_mfma_f32_16x16x32_bf16 v[108:111], v[140:143], a[92:95], v[108:111]
    s_waitcnt lgkmcnt(0)
    v_mfma_f32_16x16x32_bf16 v[16:19], v[144:147], a[64:67], v[16:19]
    ds_read_b64_tr_b16 v[128:129], v216 offset:49152
    v_mfma_f32_16x16x32_bf16 v[16:19], v[148:151], a[80:83], v[16:19]
    ds_read_b64_tr_b16 v[130:131], v216 offset:51200
    v_mfma_f32_16x16x32_bf16 v[20:23], v[144:147], a[68:71], v[20:23]
    ds_read_b64_tr_b16 v[132:133], v216 offset:57344
    v_mfma_f32_16x16x32_bf16 v[20:23], v[148:151], a[84:87], v[20:23]
    ds_read_b64_tr_b16 v[134:135], v216 offset:59392
    v_mfma_f32_16x16x32_bf16 v[112:115], v[144:147], a[72:75], v[112:115]
    ds_read_b64_tr_b16 v[136:137], v217 offset:49152
    v_mfma_f32_16x16x32_bf16 v[112:115], v[148:151], a[88:91], v[112:115]
    ds_read_b64_tr_b16 v[138:139], v217 offset:51200
    v_mfma_f32_16x16x32_bf16 v[116:119], v[144:147], a[76:79], v[116:119]
    ds_read_b64_tr_b16 v[140:141], v217 offset:57344
    v_mfma_f32_16x16x32_bf16 v[116:119], v[148:151], a[92:95], v[116:119]
    ds_read_b64_tr_b16 v[142:143], v217 offset:59392
    v_mfma_f32_16x16x32_bf16 v[24:27], v[152:155], a[64:67], v[24:27]
    v_mfma_f32_16x16x32_bf16 v[24:27], v[156:159], a[80:83], v[24:27]
    v_mfma_f32_16x16x32_bf16 v[28:31], v[152:155], a[68:71], v[28:31]
    v_mfma_f32_16x16x32_bf16 v[28:31], v[156:159], a[84:87], v[28:31]
    v_mfma_f32_16x16x32_bf16 v[120:123], v[152:155], a[72:75], v[120:123]
    v_mfma_f32_16x16x32_bf16 v[120:123], v[156:159], a[88:91], v[120:123]
    v_mfma_f32_16x16x32_bf16 v[124:127], v[152:155], a[76:79], v[124:127]
    buffer_load_dwordx4 a[140:143], v228, s[8:11], s33 offen offset:3072 sc1
    v_mfma_f32_16x16x32_bf16 v[124:127], v[156:159], a[92:95], v[124:127]
    s_add_u32 s35, s35, 4096
    buffer_load_dwordx4 a[224:227], v226, s[8:11], s35 offen offset:0 sc1
    s_waitcnt vmcnt(29) lgkmcnt(0)
    v_mfma_f32_16x16x32_bf16 v[32:35], v[128:131], a[96:99], v[32:35]
    ds_read_b64_tr_b16 v[144:145], v218 offset:49152
    v_mfma_f32_16x16x32_bf16 v[32:35], v[132:135], a[112:115], v[32:35]
    ds_read_b64_tr_b16 v[146:147], v218 offset:51200
    v_mfma_f32_16x16x32_bf16 v[36:39], v[128:131], a[100:103], v[36:39]
    ds_read_b64_tr_b16 v[148:149], v218 offset:57344
    v_mfma_f32_16x16x32_bf16 v[36:39], v[132:135], a[116:119], v[36:39]
    ds_read_b64_tr_b16 v[150:151], v218 offset:59392
    v_mfma_f32_16x16x32_bf16 v[64:67], v[128:131], a[104:107], v[64:67]
    ds_read_b64_tr_b16 v[152:153], v219 offset:49152
    v_mfma_f32_16x16x32_bf16 v[64:67], v[132:135], a[120:123], v[64:67]
    ds_read_b64_tr_b16 v[154:155], v219 offset:51200
    v_mfma_f32_16x16x32_bf16 v[68:71], v[128:131], a[108:111], v[68:71]
    ds_read_b64_tr_b16 v[156:157], v219 offset:57344
    v_mfma_f32_16x16x32_bf16 v[68:71], v[132:135], a[124:127], v[68:71]
    ds_read_b64_tr_b16 v[158:159], v219 offset:59392
    v_mfma_f32_16x16x32_bf16 v[40:43], v[136:139], a[96:99], v[40:43]
    buffer_load_dwordx4 a[228:231], v227, s[8:11], s35 offen offset:0 sc1
    v_mfma_f32_16x16x32_bf16 v[40:43], v[140:143], a[112:115], v[40:43]
    s_add_u32 m0, s38, 81920
    s_add_u32 s32, s37, 1703936
    v_mfma_f32_16x16x32_bf16 v[44:47], v[136:139], a[100:103], v[44:47]
    buffer_load_dwordx4 v224, s[12:15], s32 offen lds
    v_mfma_f32_16x16x32_bf16 v[44:47], v[140:143], a[116:119], v[44:47]
    buffer_load_dwordx4 a[72:75], v245, s[8:11], s35 offen offset:0 sc1
    v_mfma_f32_16x16x32_bf16 v[72:75], v[136:139], a[104:107], v[72:75]
    v_mfma_f32_16x16x32_bf16 v[72:75], v[140:143], a[120:123], v[72:75]
    buffer_load_dwordx4 v225, s[12:15], s32 offen offset:1024 lds
    v_mfma_f32_16x16x32_bf16 v[76:79], v[136:139], a[108:111], v[76:79]
    s_add_u32 s33, s55, 4096
    buffer_load_dwordx4 a[144:147], v228, s[8:11], s33 offen offset:0 sc1
    v_mfma_f32_16x16x32_bf16 v[76:79], v[140:143], a[124:127], v[76:79]
    buffer_load_dwordx4 a[76:79], v246, s[8:11], s35 offen offset:0 sc1
    s_waitcnt lgkmcnt(0)
    v_mfma_f32_16x16x32_bf16 v[48:51], v[144:147], a[96:99], v[48:51]
    ds_read_b64_tr_b16 v[128:129], v220 offset:49152
    v_mfma_f32_16x16x32_bf16 v[48:51], v[148:151], a[112:115], v[48:51]
    ds_read_b64_tr_b16 v[130:131], v220 offset:51200
    v_mfma_f32_16x16x32_bf16 v[52:55], v[144:147], a[100:103], v[52:55]
    ds_read_b64_tr_b16 v[132:133], v220 offset:57344
    v_mfma_f32_16x16x32_bf16 v[52:55], v[148:151], a[116:119], v[52:55]
    ds_read_b64_tr_b16 v[134:135], v220 offset:59392
    v_mfma_f32_16x16x32_bf16 v[80:83], v[144:147], a[104:107], v[80:83]
    ds_read_b64_tr_b16 v[136:137], v221 offset:49152
    v_mfma_f32_16x16x32_bf16 v[80:83], v[148:151], a[120:123], v[80:83]
    ds_read_b64_tr_b16 v[138:139], v221 offset:51200
    v_mfma_f32_16x16x32_bf16 v[84:87], v[144:147], a[108:111], v[84:87]
    ds_read_b64_tr_b16 v[140:141], v221 offset:57344
    v_mfma_f32_16x16x32_bf16 v[84:87], v[148:151], a[124:127], v[84:87]
    ds_read_b64_tr_b16 v[142:143], v221 offset:59392
    v_mfma_f32_16x16x32_bf16 v[56:59], v[152:155], a[96:99], v[56:59]
    buffer_load_dwordx4 a[232:235], v226, s[8:11], s35 offen offset:1024 sc1
    v_mfma_f32_16x16x32_bf16 v[56:59], v[156:159], a[112:115], v[56:59]
    v_mfma_f32_16x16x32_bf16 v[60:63], v[152:155], a[100:103], v[60:63]
    buffer_load_dwordx4 a[236:239], v227, s[8:11], s35 offen offset:1024 sc1
    v_mfma_f32_16x16x32_bf16 v[60:63], v[156:159], a[116:119], v[60:63]
    v_mfma_f32_16x16x32_bf16 v[88:91], v[152:155], a[104:107], v[88:91]
    buffer_load_dwordx4 a[88:91], v245, s[8:11], s35 offen offset:1024 sc1
    v_mfma_f32_16x16x32_bf16 v[88:91], v[156:159], a[120:123], v[88:91]
    v_mfma_f32_16x16x32_bf16 v[92:95], v[152:155], a[108:111], v[92:95]
    buffer_load_dwordx4 a[148:151], v228, s[8:11], s33 offen offset:1024 sc1
    v_mfma_f32_16x16x32_bf16 v[92:95], v[156:159], a[124:127], v[92:95]
    buffer_load_dwordx4 a[92:95], v246, s[8:11], s35 offen offset:1024 sc1
    s_waitcnt lgkmcnt(0)
    v_mfma_f32_16x16x32_bf16 v[0:3], v[128:131], a[96:99], v[0:3]
    ds_read_b64_tr_b16 v[144:145], v222 offset:49152
    v_mfma_f32_16x16x32_bf16 v[0:3], v[132:135], a[112:115], v[0:3]
    ds_read_b64_tr_b16 v[146:147], v222 offset:51200
    v_mfma_f32_16x16x32_bf16 v[4:7], v[128:131], a[100:103], v[4:7]
    ds_read_b64_tr_b16 v[148:149], v222 offset:57344
    v_mfma_f32_16x16x32_bf16 v[4:7], v[132:135], a[116:119], v[4:7]
    ds_read_b64_tr_b16 v[150:151], v222 offset:59392
    v_mfma_f32_16x16x32_bf16 v[96:99], v[128:131], a[104:107], v[96:99]
    ds_read_b64_tr_b16 v[152:153], v223 offset:49152
    v_mfma_f32_16x16x32_bf16 v[96:99], v[132:135], a[120:123], v[96:99]
    ds_read_b64_tr_b16 v[154:155], v223 offset:51200
    v_mfma_f32_16x16x32_bf16 v[100:103], v[128:131], a[108:111], v[100:103]
    ds_read_b64_tr_b16 v[156:157], v223 offset:57344
    v_mfma_f32_16x16x32_bf16 v[100:103], v[132:135], a[124:127], v[100:103]
    ds_read_b64_tr_b16 v[158:159], v223 offset:59392
    v_mfma_f32_16x16x32_bf16 v[8:11], v[136:139], a[96:99], v[8:11]
    v_mfma_f32_16x16x32_bf16 v[8:11], v[140:143], a[112:115], v[8:11]
    s_add_u32 m0, s38, 90112
    s_add_u32 s32, s37, 1769472
    v_mfma_f32_16x16x32_bf16 v[12:15], v[136:139], a[100:103], v[12:15]
    buffer_load_dwordx4 v224, s[12:15], s32 offen lds
    v_mfma_f32_16x16x32_bf16 v[12:15], v[140:143], a[116:119], v[12:15]
    v_mfma_f32_16x16x32_bf16 v[104:107], v[136:139], a[104:107], v[104:107]
    v_mfma_f32_16x16x32_bf16 v[104:107], v[140:143], a[120:123], v[104:107]
    buffer_load_dwordx4 v225, s[12:15], s32 offen offset:1024 lds
    v_mfma_f32_16x16x32_bf16 v[108:111], v[136:139], a[108:111], v[108:111]
    buffer_load_dwordx4 a[152:155], v228, s[8:11], s33 offen offset:2048 sc1
    v_mfma_f32_16x16x32_bf16 v[108:111], v[140:143], a[124:127], v[108:111]
    s_waitcnt vmcnt(60) lgkmcnt(0)
    s_barrier
    v_mfma_f32_16x16x32_bf16 v[16:19], v[144:147], a[96:99], v[16:19]
    v_xor_b32 v216, 0x10000, v216
    ds_read_b64_tr_b16 v[128:129], v216 offset:0
    v_mfma_f32_16x16x32_bf16 v[16:19], v[148:151], a[112:115], v[16:19]
    ds_read_b64_tr_b16 v[130:131], v216 offset:2048
    v_mfma_f32_16x16x32_bf16 v[20:23], v[144:147], a[100:103], v[20:23]
    ds_read_b64_tr_b16 v[132:133], v216 offset:8192
    v_mfma_f32_16x16x32_bf16 v[20:23], v[148:151], a[116:119], v[20:23]
    ds_read_b64_tr_b16 v[134:135], v216 offset:10240
    v_mfma_f32_16x16x32_bf16 v[112:115], v[144:147], a[104:107], v[112:115]
    v_xor_b32 v217, 0x10000, v217
    ds_read_b64_tr_b16 v[136:137], v217 offset:0
    v_mfma_f32_16x16x32_bf16 v[112:115], v[148:151], a[120:123], v[112:115]
    ds_read_b64_tr_b16 v[138:139], v217 offset:2048
    v_mfma_f32_16x16x32_bf16 v[116:119], v[144:147], a[108:111], v[116:119]
    ds_read_b64_tr_b16 v[140:141], v217 offset:8192
    v_mfma_f32_16x16x32_bf16 v[116:119], v[148:151], a[124:127], v[116:119]
    ds_read_b64_tr_b16 v[142:143], v217 offset:10240
    v_mfma_f32_16x16x32_bf16 v[24:27], v[152:155], a[96:99], v[24:27]
    v_mfma_f32_16x16x32_bf16 v[24:27], v[156:159], a[112:115], v[24:27]
    v_mfma_f32_16x16x32_bf16 v[28:31], v[152:155], a[100:103], v[28:31]
    v_mfma_f32_16x16x32_bf16 v[28:31], v[156:159], a[116:119], v[28:31]
    v_mfma_f32_16x16x32_bf16 v[120:123], v[152:155], a[104:107], v[120:123]
    v_mfma_f32_16x16x32_bf16 v[120:123], v[156:159], a[120:123], v[120:123]
    v_mfma_f32_16x16x32_bf16 v[124:127], v[152:155], a[108:111], v[124:127]
    buffer_load_dwordx4 a[156:159], v228, s[8:11], s33 offen offset:3072 sc1
    v_mfma_f32_16x16x32_bf16 v[124:127], v[156:159], a[124:127], v[124:127]
    buffer_load_dwordx4 a[240:243], v226, s[8:11], s35 offen offset:2048 sc1
    s_waitcnt vmcnt(34) lgkmcnt(0)
    v_mfma_f32_16x16x32_bf16 v[32:35], v[128:131], a[0:3], v[32:35]
    v_xor_b32 v218, 0x10000, v218
    ds_read_b64_tr_b16 v[144:145], v218 offset:0
    v_mfma_f32_16x16x32_bf16 v[32:35], v[132:135], a[16:19], v[32:35]
    ds_read_b64_tr_b16 v[146:147], v218 offset:2048
    v_mfma_f32_16x16x32_bf16 v[36:39], v[128:131], a[4:7], v[36:39]
    ds_read_b64_tr_b16 v[148:149], v218 offset:8192
    v_mfma_f32_16x16x32_bf16 v[36:39], v[132:135], a[20:23], v[36:39]
    ds_read_b64_tr_b16 v[150:151], v218 offset:10240
    v_mfma_f32_16x16x32_bf16 v[64:67], v[128:131], a[8:11], v[64:67]
    v_xor_b32 v219, 0x10000, v219
    ds_read_b64_tr_b16 v[152:153], v219 offset:0
    v_mfma_f32_16x16x32_bf16 v[64:67], v[132:135], a[24:27], v[64:67]
    ds_read_b64_tr_b16 v[154:155], v219 offset:2048
    v_mfma_f32_16x16x32_bf16 v[68:71], v[128:131], a[12:15], v[68:71]
    ds_read_b64_tr_b16 v[156:157], v219 offset:8192
    v_mfma_f32_16x16x32_bf16 v[68:71], v[132:135], a[28:31], v[68:71]
    ds_read_b64_tr_b16 v[158:159], v219 offset:10240
    v_mfma_f32_16x16x32_bf16 v[40:43], v[136:139], a[0:3], v[40:43]
    buffer_load_dwordx4 a[244:247], v227, s[8:11], s35 offen offset:2048 sc1
    v_mfma_f32_16x16x32_bf16 v[40:43], v[140:143], a[16:19], v[40:43]
    s_add_u32 m0, s38, 98304
    s_add_u32 s32, s37, 1835008
    v_mfma_f32_16x16x32_bf16 v[44:47], v[136:139], a[4:7], v[44:47]
    buffer_load_dwordx4 v224, s[12:15], s32 offen lds
    v_mfma_f32_16x16x32_bf16 v[44:47], v[140:143], a[20:23], v[44:47]
    buffer_load_dwordx4 a[104:107], v245, s[8:11], s35 offen offset:2048 sc1
    v_mfma_f32_16x16x32_bf16 v[72:75], v[136:139], a[8:11], v[72:75]
    v_mfma_f32_16x16x32_bf16 v[72:75], v[140:143], a[24:27], v[72:75]
    buffer_load_dwordx4 v225, s[12:15], s32 offen offset:1024 lds
    v_mfma_f32_16x16x32_bf16 v[76:79], v[136:139], a[12:15], v[76:79]
    s_add_u32 s33, s55, 32768
    buffer_load_dwordx4 a[160:163], v228, s[8:11], s33 offen offset:0 sc1
    v_mfma_f32_16x16x32_bf16 v[76:79], v[140:143], a[28:31], v[76:79]
    buffer_load_dwordx4 a[108:111], v246, s[8:11], s35 offen offset:2048 sc1
    s_waitcnt lgkmcnt(0)
    v_mfma_f32_16x16x32_bf16 v[48:51], v[144:147], a[0:3], v[48:51]
    v_xor_b32 v220, 0x10000, v220
    ds_read_b64_tr_b16 v[128:129], v220 offset:0
    v_mfma_f32_16x16x32_bf16 v[48:51], v[148:151], a[16:19], v[48:51]
    ds_read_b64_tr_b16 v[130:131], v220 offset:2048
    v_mfma_f32_16x16x32_bf16 v[52:55], v[144:147], a[4:7], v[52:55]
    ds_read_b64_tr_b16 v[132:133], v220 offset:8192
    v_mfma_f32_16x16x32_bf16 v[52:55], v[148:151], a[20:23], v[52:55]
    ds_read_b64_tr_b16 v[134:135], v220 offset:10240
    v_mfma_f32_16x16x32_bf16 v[80:83], v[144:147], a[8:11], v[80:83]
    v_xor_b32 v221, 0x10000, v221
    ds_read_b64_tr_b16 v[136:137], v221 offset:0
    v_mfma_f32_16x16x32_bf16 v[80:83], v[148:151], a[24:27], v[80:83]
    ds_read_b64_tr_b16 v[138:139], v221 offset:2048
    v_mfma_f32_16x16x32_bf16 v[84:87], v[144:147], a[12:15], v[84:87]
    ds_read_b64_tr_b16 v[140:141], v221 offset:8192
    v_mfma_f32_16x16x32_bf16 v[84:87], v[148:151], a[28:31], v[84:87]
    ds_read_b64_tr_b16 v[142:143], v221 offset:10240
    v_mfma_f32_16x16x32_bf16 v[56:59], v[152:155], a[0:3], v[56:59]
    buffer_load_dwordx4 a[248:251], v226, s[8:11], s35 offen offset:3072 sc1
    v_mfma_f32_16x16x32_bf16 v[56:59], v[156:159], a[16:19], v[56:59]
    v_mfma_f32_16x16x32_bf16 v[60:63], v[152:155], a[4:7], v[60:63]
    buffer_load_dwordx4 a[252:255], v227, s[8:11], s35 offen offset:3072 sc1
    v_mfma_f32_16x16x32_bf16 v[60:63], v[156:159], a[20:23], v[60:63]
    v_mfma_f32_16x16x32_bf16 v[88:91], v[152:155], a[8:11], v[88:91]
    buffer_load_dwordx4 a[120:123], v245, s[8:11], s35 offen offset:3072 sc1
    v_mfma_f32_16x16x32_bf16 v[88:91], v[156:159], a[24:27], v[88:91]
    v_mfma_f32_16x16x32_bf16 v[92:95], v[152:155], a[12:15], v[92:95]
    buffer_load_dwordx4 a[164:167], v228, s[8:11], s33 offen offset:1024 sc1
    v_mfma_f32_16x16x32_bf16 v[92:95], v[156:159], a[28:31], v[92:95]
    buffer_load_dwordx4 a[124:127], v246, s[8:11], s35 offen offset:3072 sc1
    s_waitcnt lgkmcnt(0)
    v_mfma_f32_16x16x32_bf16 v[0:3], v[128:131], a[0:3], v[0:3]
    v_xor_b32 v222, 0x10000, v222
    ds_read_b64_tr_b16 v[144:145], v222 offset:0
    v_mfma_f32_16x16x32_bf16 v[0:3], v[132:135], a[16:19], v[0:3]
    ds_read_b64_tr_b16 v[146:147], v222 offset:2048
    v_mfma_f32_16x16x32_bf16 v[4:7], v[128:131], a[4:7], v[4:7]
    ds_read_b64_tr_b16 v[148:149], v222 offset:8192
    v_mfma_f32_16x16x32_bf16 v[4:7], v[132:135], a[20:23], v[4:7]
    ds_read_b64_tr_b16 v[150:151], v222 offset:10240
    v_mfma_f32_16x16x32_bf16 v[96:99], v[128:131], a[8:11], v[96:99]
    v_xor_b32 v223, 0x10000, v223
    ds_read_b64_tr_b16 v[152:153], v223 offset:0
    v_mfma_f32_16x16x32_bf16 v[96:99], v[132:135], a[24:27], v[96:99]
    ds_read_b64_tr_b16 v[154:155], v223 offset:2048
    v_mfma_f32_16x16x32_bf16 v[100:103], v[128:131], a[12:15], v[100:103]
    ds_read_b64_tr_b16 v[156:157], v223 offset:8192
    v_mfma_f32_16x16x32_bf16 v[100:103], v[132:135], a[28:31], v[100:103]
    ds_read_b64_tr_b16 v[158:159], v223 offset:10240
    v_mfma_f32_16x16x32_bf16 v[8:11], v[136:139], a[0:3], v[8:11]
    v_mfma_f32_16x16x32_bf16 v[8:11], v[140:143], a[16:19], v[8:11]
    s_add_u32 m0, s38, 106496
    s_add_u32 s32, s37, 1900544
    v_mfma_f32_16x16x32_bf16 v[12:15], v[136:139], a[4:7], v[12:15]
    buffer_load_dwordx4 v224, s[12:15], s32 offen lds
    v_mfma_f32_16x16x32_bf16 v[12:15], v[140:143], a[20:23], v[12:15]
    v_mfma_f32_16x16x32_bf16 v[104:107], v[136:139], a[8:11], v[104:107]
    v_mfma_f32_16x16x32_bf16 v[104:107], v[140:143], a[24:27], v[104:107]
    buffer_load_dwordx4 v225, s[12:15], s32 offen offset:1024 lds
    v_mfma_f32_16x16x32_bf16 v[108:111], v[136:139], a[12:15], v[108:111]
    buffer_load_dwordx4 a[168:171], v228, s[8:11], s33 offen offset:2048 sc1
    v_mfma_f32_16x16x32_bf16 v[108:111], v[140:143], a[28:31], v[108:111]
    s_waitcnt lgkmcnt(0)
    v_mfma_f32_16x16x32_bf16 v[16:19], v[144:147], a[0:3], v[16:19]
    ds_read_b64_tr_b16 v[128:129], v216 offset:16384
    v_mfma_f32_16x16x32_bf16 v[16:19], v[148:151], a[16:19], v[16:19]
    ds_read_b64_tr_b16 v[130:131], v216 offset:18432
    v_mfma_f32_16x16x32_bf16 v[20:23], v[144:147], a[4:7], v[20:23]
    ds_read_b64_tr_b16 v[132:133], v216 offset:24576
    v_mfma_f32_16x16x32_bf16 v[20:23], v[148:151], a[20:23], v[20:23]
    ds_read_b64_tr_b16 v[134:135], v216 offset:26624
    v_mfma_f32_16x16x32_bf16 v[112:115], v[144:147], a[8:11], v[112:115]
    ds_read_b64_tr_b16 v[136:137], v217 offset:16384
    v_mfma_f32_16x16x32_bf16 v[112:115], v[148:151], a[24:27], v[112:115]
    ds_read_b64_tr_b16 v[138:139], v217 offset:18432
    v_mfma_f32_16x16x32_bf16 v[116:119], v[144:147], a[12:15], v[116:119]
    ds_read_b64_tr_b16 v[140:141], v217 offset:24576
    v_mfma_f32_16x16x32_bf16 v[116:119], v[148:151], a[28:31], v[116:119]
    ds_read_b64_tr_b16 v[142:143], v217 offset:26624
    v_mfma_f32_16x16x32_bf16 v[24:27], v[152:155], a[0:3], v[24:27]
    v_mfma_f32_16x16x32_bf16 v[24:27], v[156:159], a[16:19], v[24:27]
    v_mfma_f32_16x16x32_bf16 v[28:31], v[152:155], a[4:7], v[28:31]
    v_mfma_f32_16x16x32_bf16 v[28:31], v[156:159], a[20:23], v[28:31]
    v_mfma_f32_16x16x32_bf16 v[120:123], v[152:155], a[8:11], v[120:123]
    v_mfma_f32_16x16x32_bf16 v[120:123], v[156:159], a[24:27], v[120:123]
    v_mfma_f32_16x16x32_bf16 v[124:127], v[152:155], a[12:15], v[124:127]
    buffer_load_dwordx4 a[172:175], v228, s[8:11], s33 offen offset:3072 sc1
    v_mfma_f32_16x16x32_bf16 v[124:127], v[156:159], a[28:31], v[124:127]
    s_add_u32 s35, s35, 4096
    buffer_load_dwordx4 a[0:3], v226, s[8:11], s35 offen offset:0 sc1
    s_waitcnt vmcnt(37) lgkmcnt(0)
    v_mfma_f32_16x16x32_bf16 v[32:35], v[128:131], a[32:35], v[32:35]
    ds_read_b64_tr_b16 v[144:145], v218 offset:16384
    v_mfma_f32_16x16x32_bf16 v[32:35], v[132:135], a[48:51], v[32:35]
    ds_read_b64_tr_b16 v[146:147], v218 offset:18432
    v_mfma_f32_16x16x32_bf16 v[36:39], v[128:131], a[36:39], v[36:39]
    ds_read_b64_tr_b16 v[148:149], v218 offset:24576
    v_mfma_f32_16x16x32_bf16 v[36:39], v[132:135], a[52:55], v[36:39]
    ds_read_b64_tr_b16 v[150:151], v218 offset:26624
    v_mfma_f32_16x16x32_bf16 v[64:67], v[128:131], a[40:43], v[64:67]
    ds_read_b64_tr_b16 v[152:153], v219 offset:16384
    v_mfma_f32_16x16x32_bf16 v[64:67], v[132:135], a[56:59], v[64:67]
    ds_read_b64_tr_b16 v[154:155], v219 offset:18432
    v_mfma_f32_16x16x32_bf16 v[68:71], v[128:131], a[44:47], v[68:71]
    ds_read_b64_tr_b16 v[156:157], v219 offset:24576
    v_mfma_f32_16x16x32_bf16 v[68:71], v[132:135], a[60:63], v[68:71]
    ds_read_b64_tr_b16 v[158:159], v219 offset:26624
    v_mfma_f32_16x16x32_bf16 v[40:43], v[136:139], a[32:35], v[40:43]
    buffer_load_dwordx4 a[4:7], v227, s[8:11], s35 offen offset:0 sc1
    v_mfma_f32_16x16x32_bf16 v[40:43], v[140:143], a[48:51], v[40:43]
    s_add_u32 m0, s38, 114688
    s_add_u32 s32, s37, 1966080
    v_mfma_f32_16x16x32_bf16 v[44:47], v[136:139], a[36:39], v[44:47]
    buffer_load_dwordx4 v224, s[12:15], s32 offen lds
    v_mfma_f32_16x16x32_bf16 v[44:47], v[140:143], a[52:55], v[44:47]
    buffer_load_dwordx4 a[8:11], v245, s[8:11], s35 offen offset:0 sc1
    v_mfma_f32_16x16x32_bf16 v[72:75], v[136:139], a[40:43], v[72:75]
    v_mfma_f32_16x16x32_bf16 v[72:75], v[140:143], a[56:59], v[72:75]
    buffer_load_dwordx4 v225, s[12:15], s32 offen offset:1024 lds
    v_mfma_f32_16x16x32_bf16 v[76:79], v[136:139], a[44:47], v[76:79]
    s_add_u32 s33, s55, 36864
    buffer_load_dwordx4 a[176:179], v228, s[8:11], s33 offen offset:0 sc1
    v_mfma_f32_16x16x32_bf16 v[76:79], v[140:143], a[60:63], v[76:79]
    buffer_load_dwordx4 a[12:15], v246, s[8:11], s35 offen offset:0 sc1
    s_waitcnt lgkmcnt(0)
    v_mfma_f32_16x16x32_bf16 v[48:51], v[144:147], a[32:35], v[48:51]
    ds_read_b64_tr_b16 v[128:129], v220 offset:16384
    v_mfma_f32_16x16x32_bf16 v[48:51], v[148:151], a[48:51], v[48:51]
    ds_read_b64_tr_b16 v[130:131], v220 offset:18432
    v_mfma_f32_16x16x32_bf16 v[52:55], v[144:147], a[36:39], v[52:55]
    ds_read_b64_tr_b16 v[132:133], v220 offset:24576
    v_mfma_f32_16x16x32_bf16 v[52:55], v[148:151], a[52:55], v[52:55]
    ds_read_b64_tr_b16 v[134:135], v220 offset:26624
    v_mfma_f32_16x16x32_bf16 v[80:83], v[144:147], a[40:43], v[80:83]
    ds_read_b64_tr_b16 v[136:137], v221 offset:16384
    v_mfma_f32_16x16x32_bf16 v[80:83], v[148:151], a[56:59], v[80:83]
    ds_read_b64_tr_b16 v[138:139], v221 offset:18432
    v_mfma_f32_16x16x32_bf16 v[84:87], v[144:147], a[44:47], v[84:87]
    ds_read_b64_tr_b16 v[140:141], v221 offset:24576
    v_mfma_f32_16x16x32_bf16 v[84:87], v[148:151], a[60:63], v[84:87]
    ds_read_b64_tr_b16 v[142:143], v221 offset:26624
    v_mfma_f32_16x16x32_bf16 v[56:59], v[152:155], a[32:35], v[56:59]
    buffer_load_dwordx4 a[16:19], v226, s[8:11], s35 offen offset:1024 sc1
    v_mfma_f32_16x16x32_bf16 v[56:59], v[156:159], a[48:51], v[56:59]
    v_mfma_f32_16x16x32_bf16 v[60:63], v[152:155], a[36:39], v[60:63]
    buffer_load_dwordx4 a[20:23], v227, s[8:11], s35 offen offset:1024 sc1
    v_mfma_f32_16x16x32_bf16 v[60:63], v[156:159], a[52:55], v[60:63]
    v_mfma_f32_16x16x32_bf16 v[88:91], v[152:155], a[40:43], v[88:91]
    buffer_load_dwordx4 a[24:27], v245, s[8:11], s35 offen offset:1024 sc1
    v_mfma_f32_16x16x32_bf16 v[88:91], v[156:159], a[56:59], v[88:91]
    v_mfma_f32_16x16x32_bf16 v[92:95], v[152:155], a[44:47], v[92:95]
    buffer_load_dwordx4 a[180:183], v228, s[8:11], s33 offen offset:1024 sc1
    v_mfma_f32_16x16x32_bf16 v[92:95], v[156:159], a[60:63], v[92:95]
    buffer_load_dwordx4 a[28:31], v246, s[8:11], s35 offen offset:1024 sc1
    s_waitcnt lgkmcnt(0)
    v_mfma_f32_16x16x32_bf16 v[0:3], v[128:131], a[32:35], v[0:3]
    ds_read_b64_tr_b16 v[144:145], v222 offset:16384
    v_mfma_f32_16x16x32_bf16 v[0:3], v[132:135], a[48:51], v[0:3]
    ds_read_b64_tr_b16 v[146:147], v222 offset:18432
    v_mfma_f32_16x16x32_bf16 v[4:7], v[128:131], a[36:39], v[4:7]
    ds_read_b64_tr_b16 v[148:149], v222 offset:24576
    v_mfma_f32_16x16x32_bf16 v[4:7], v[132:135], a[52:55], v[4:7]
    ds_read_b64_tr_b16 v[150:151], v222 offset:26624
    v_mfma_f32_16x16x32_bf16 v[96:99], v[128:131], a[40:43], v[96:99]
    ds_read_b64_tr_b16 v[152:153], v223 offset:16384
    v_mfma_f32_16x16x32_bf16 v[96:99], v[132:135], a[56:59], v[96:99]
    ds_read_b64_tr_b16 v[154:155], v223 offset:18432
    v_mfma_f32_16x16x32_bf16 v[100:103], v[128:131], a[44:47], v[100:103]
    ds_read_b64_tr_b16 v[156:157], v223 offset:24576
    v_mfma_f32_16x16x32_bf16 v[100:103], v[132:135], a[60:63], v[100:103]
    ds_read_b64_tr_b16 v[158:159], v223 offset:26624
    v_mfma_f32_16x16x32_bf16 v[8:11], v[136:139], a[32:35], v[8:11]
    v_mfma_f32_16x16x32_bf16 v[8:11], v[140:143], a[48:51], v[8:11]
    s_add_u32 m0, s38, 122880
    s_add_u32 s32, s37, 2031616
    v_mfma_f32_16x16x32_bf16 v[12:15], v[136:139], a[36:39], v[12:15]
    buffer_load_dwordx4 v224, s[12:15], s32 offen lds
    v_mfma_f32_16x16x32_bf16 v[12:15], v[140:143], a[52:55], v[12:15]
    v_mfma_f32_16x16x32_bf16 v[104:107], v[136:139], a[40:43], v[104:107]
    v_mfma_f32_16x16x32_bf16 v[104:107], v[140:143], a[56:59], v[104:107]
    buffer_load_dwordx4 v225, s[12:15], s32 offen offset:1024 lds
    v_mfma_f32_16x16x32_bf16 v[108:111], v[136:139], a[44:47], v[108:111]
    buffer_load_dwordx4 a[184:187], v228, s[8:11], s33 offen offset:2048 sc1
    v_mfma_f32_16x16x32_bf16 v[108:111], v[140:143], a[60:63], v[108:111]
    s_waitcnt vmcnt(63) lgkmcnt(0)
    s_barrier
    v_mfma_f32_16x16x32_bf16 v[16:19], v[144:147], a[32:35], v[16:19]
    ds_read_b64_tr_b16 v[128:129], v216 offset:32768
    v_mfma_f32_16x16x32_bf16 v[16:19], v[148:151], a[48:51], v[16:19]
    ds_read_b64_tr_b16 v[130:131], v216 offset:34816
    v_mfma_f32_16x16x32_bf16 v[20:23], v[144:147], a[36:39], v[20:23]
    ds_read_b64_tr_b16 v[132:133], v216 offset:40960
    v_mfma_f32_16x16x32_bf16 v[20:23], v[148:151], a[52:55], v[20:23]
    ds_read_b64_tr_b16 v[134:135], v216 offset:43008
    v_mfma_f32_16x16x32_bf16 v[112:115], v[144:147], a[40:43], v[112:115]
    ds_read_b64_tr_b16 v[136:137], v217 offset:32768
    v_mfma_f32_16x16x32_bf16 v[112:115], v[148:151], a[56:59], v[112:115]
    ds_read_b64_tr_b16 v[138:139], v217 offset:34816
    v_mfma_f32_16x16x32_bf16 v[116:119], v[144:147], a[44:47], v[116:119]
    ds_read_b64_tr_b16 v[140:141], v217 offset:40960
    v_mfma_f32_16x16x32_bf16 v[116:119], v[148:151], a[60:63], v[116:119]
    ds_read_b64_tr_b16 v[142:143], v217 offset:43008
    v_mfma_f32_16x16x32_bf16 v[24:27], v[152:155], a[32:35], v[24:27]
    v_mfma_f32_16x16x32_bf16 v[24:27], v[156:159], a[48:51], v[24:27]
    v_mfma_f32_16x16x32_bf16 v[28:31], v[152:155], a[36:39], v[28:31]
    v_mfma_f32_16x16x32_bf16 v[28:31], v[156:159], a[52:55], v[28:31]
    v_mfma_f32_16x16x32_bf16 v[120:123], v[152:155], a[40:43], v[120:123]
    v_mfma_f32_16x16x32_bf16 v[120:123], v[156:159], a[56:59], v[120:123]
    v_mfma_f32_16x16x32_bf16 v[124:127], v[152:155], a[44:47], v[124:127]
    buffer_load_dwordx4 a[188:191], v228, s[8:11], s33 offen offset:3072 sc1
    v_mfma_f32_16x16x32_bf16 v[124:127], v[156:159], a[60:63], v[124:127]
    buffer_load_dwordx4 a[32:35], v226, s[8:11], s35 offen offset:2048 sc1
    s_waitcnt vmcnt(37) lgkmcnt(0)
    v_mfma_f32_16x16x32_bf16 v[64:67], v[128:131], a[72:75], v[64:67]
    ds_read_b64_tr_b16 v[144:145], v218 offset:32768
    v_mfma_f32_16x16x32_bf16 v[64:67], v[132:135], a[88:91], v[64:67]
    ds_read_b64_tr_b16 v[146:147], v218 offset:34816
    v_mfma_f32_16x16x32_bf16 v[68:71], v[128:131], a[76:79], v[68:71]
    ds_read_b64_tr_b16 v[148:149], v218 offset:40960
    buffer_load_dwordx4 a[36:39], v227, s[8:11], s35 offen offset:2048 sc1
    v_mfma_f32_16x16x32_bf16 v[68:71], v[132:135], a[92:95], v[68:71]
    ds_read_b64_tr_b16 v[150:151], v218 offset:43008
    v_mfma_f32_16x16x32_bf16 v[72:75], v[136:139], a[72:75], v[72:75]
    ds_read_b64_tr_b16 v[152:153], v219 offset:32768
    v_mfma_f32_16x16x32_bf16 v[72:75], v[140:143], a[88:91], v[72:75]
    ds_read_b64_tr_b16 v[154:155], v219 offset:34816
    v_mfma_f32_16x16x32_bf16 v[76:79], v[136:139], a[76:79], v[76:79]
    ds_read_b64_tr_b16 v[156:157], v219 offset:40960
    buffer_load_dwordx4 a[40:43], v245, s[8:11], s35 offen offset:2048 sc1
    v_mfma_f32_16x16x32_bf16 v[76:79], v[140:143], a[92:95], v[76:79]
    ds_read_b64_tr_b16 v[158:159], v219 offset:43008
    s_waitcnt lgkmcnt(4)
    v_mfma_f32_16x16x32_bf16 v[80:83], v[144:147], a[72:75], v[80:83]
    ds_read_b64_tr_b16 v[128:129], v220 offset:32768
    v_mfma_f32_16x16x32_bf16 v[80:83], v[148:151], a[88:91], v[80:83]
    ds_read_b64_tr_b16 v[130:131], v220 offset:34816
    v_mfma_f32_16x16x32_bf16 v[84:87], v[144:147], a[76:79], v[84:87]
    ds_read_b64_tr_b16 v[132:133], v220 offset:40960
    buffer_load_dwordx4 a[44:47], v246, s[8:11], s35 offen offset:2048 sc1
    v_mfma_f32_16x16x32_bf16 v[84:87], v[148:151], a[92:95], v[84:87]
    ds_read_b64_tr_b16 v[134:135], v220 offset:43008
    s_waitcnt lgkmcnt(4)
    v_mfma_f32_16x16x32_bf16 v[88:91], v[152:155], a[72:75], v[88:91]
    ds_read_b64_tr_b16 v[136:137], v221 offset:32768
    v_mfma_f32_16x16x32_bf16 v[88:91], v[156:159], a[88:91], v[88:91]
    ds_read_b64_tr_b16 v[138:139], v221 offset:34816
    s_mov_b32 s32, 0
    buffer_load_dwordx4 v[192:195], v229, s[16:19], s32 offen
    v_mfma_f32_16x16x32_bf16 v[92:95], v[152:155], a[76:79], v[92:95]
    ds_read_b64_tr_b16 v[140:141], v221 offset:40960
    buffer_load_dwordx4 a[48:51], v226, s[8:11], s35 offen offset:3072 sc1
    v_mfma_f32_16x16x32_bf16 v[92:95], v[156:159], a[92:95], v[92:95]
    ds_read_b64_tr_b16 v[142:143], v221 offset:43008
    s_waitcnt lgkmcnt(4)
    v_mfma_f32_16x16x32_bf16 v[0:3], v[128:131], a[224:227], v[0:3]
    ds_read_b64_tr_b16 v[144:145], v222 offset:32768
    v_mfma_f32_16x16x32_bf16 v[0:3], v[132:135], a[232:235], v[0:3]
    ds_read_b64_tr_b16 v[146:147], v222 offset:34816
    v_mfma_f32_16x16x32_bf16 v[4:7], v[128:131], a[228:231], v[4:7]
    ds_read_b64_tr_b16 v[148:149], v222 offset:40960
    v_mfma_f32_16x16x32_bf16 v[4:7], v[132:135], a[236:239], v[4:7]
    ds_read_b64_tr_b16 v[150:151], v222 offset:43008
    v_mfma_f32_16x16x32_bf16 v[96:99], v[128:131], a[72:75], v[96:99]
    ds_read_b64_tr_b16 v[152:153], v223 offset:32768
    v_mfma_f32_16x16x32_bf16 v[96:99], v[132:135], a[88:91], v[96:99]
    ds_read_b64_tr_b16 v[154:155], v223 offset:34816
    s_mov_b32 s32, 16384
    buffer_load_dwordx4 v[196:199], v229, s[16:19], s32 offen
    v_mfma_f32_16x16x32_bf16 v[100:103], v[128:131], a[76:79], v[100:103]
    ds_read_b64_tr_b16 v[156:157], v223 offset:40960
    v_mfma_f32_16x16x32_bf16 v[100:103], v[132:135], a[92:95], v[100:103]
    ds_read_b64_tr_b16 v[158:159], v223 offset:43008
    s_waitcnt lgkmcnt(8)
    v_mfma_f32_16x16x32_bf16 v[8:11], v[136:139], a[224:227], v[8:11]
    buffer_load_dwordx4 a[52:55], v227, s[8:11], s35 offen offset:3072 sc1
    v_mfma_f32_16x16x32_bf16 v[8:11], v[140:143], a[232:235], v[8:11]
    v_mfma_f32_16x16x32_bf16 v[12:15], v[136:139], a[228:231], v[12:15]
    v_mfma_f32_16x16x32_bf16 v[12:15], v[140:143], a[236:239], v[12:15]
    buffer_load_dwordx4 a[56:59], v245, s[8:11], s35 offen offset:3072 sc1
    v_mfma_f32_16x16x32_bf16 v[104:107], v[136:139], a[72:75], v[104:107]
    v_mfma_f32_16x16x32_bf16 v[104:107], v[140:143], a[88:91], v[104:107]
    s_mov_b32 s32, 32768
    buffer_load_dwordx4 v[200:203], v229, s[16:19], s32 offen
    v_mfma_f32_16x16x32_bf16 v[108:111], v[136:139], a[76:79], v[108:111]
    v_mfma_f32_16x16x32_bf16 v[108:111], v[140:143], a[92:95], v[108:111]
    buffer_load_dwordx4 a[60:63], v246, s[8:11], s35 offen offset:3072 sc1
    s_waitcnt lgkmcnt(0)
    v_mfma_f32_16x16x32_bf16 v[16:19], v[144:147], a[224:227], v[16:19]
    ds_read_b64_tr_b16 v[128:129], v216 offset:49152
    v_mfma_f32_16x16x32_bf16 v[16:19], v[148:151], a[232:235], v[16:19]
    ds_read_b64_tr_b16 v[130:131], v216 offset:51200
    v_mfma_f32_16x16x32_bf16 v[20:23], v[144:147], a[228:231], v[20:23]
    ds_read_b64_tr_b16 v[132:133], v216 offset:57344
    v_mfma_f32_16x16x32_bf16 v[20:23], v[148:151], a[236:239], v[20:23]
    ds_read_b64_tr_b16 v[134:135], v216 offset:59392
    v_mfma_f32_16x16x32_bf16 v[112:115], v[144:147], a[72:75], v[112:115]
    ds_read_b64_tr_b16 v[136:137], v217 offset:49152
    v_mfma_f32_16x16x32_bf16 v[112:115], v[148:151], a[88:91], v[112:115]
    ds_read_b64_tr_b16 v[138:139], v217 offset:51200
    v_mfma_f32_16x16x32_bf16 v[116:119], v[144:147], a[76:79], v[116:119]
    ds_read_b64_tr_b16 v[140:141], v217 offset:57344
    v_mfma_f32_16x16x32_bf16 v[116:119], v[148:151], a[92:95], v[116:119]
    ds_read_b64_tr_b16 v[142:143], v217 offset:59392
    v_mfma_f32_16x16x32_bf16 v[24:27], v[152:155], a[224:227], v[24:27]
    v_mfma_f32_16x16x32_bf16 v[24:27], v[156:159], a[232:235], v[24:27]
    v_mfma_f32_16x16x32_bf16 v[28:31], v[152:155], a[228:231], v[28:31]
    v_mfma_f32_16x16x32_bf16 v[28:31], v[156:159], a[236:239], v[28:31]
    v_mfma_f32_16x16x32_bf16 v[120:123], v[152:155], a[72:75], v[120:123]
    v_mfma_f32_16x16x32_bf16 v[120:123], v[156:159], a[88:91], v[120:123]
    s_mov_b32 s32, 49152
    buffer_load_dwordx4 v[204:207], v229, s[16:19], s32 offen
    v_mfma_f32_16x16x32_bf16 v[124:127], v[152:155], a[76:79], v[124:127]
    v_mfma_f32_16x16x32_bf16 v[124:127], v[156:159], a[92:95], v[124:127]
    s_add_u32 s35, s35, 4096
    buffer_load_dwordx4 a[64:67], v226, s[8:11], s35 offen offset:0 sc1
    s_waitcnt vmcnt(33) lgkmcnt(0)
    v_mfma_f32_16x16x32_bf16 v[64:67], v[128:131], a[104:107], v[64:67]
    ds_read_b64_tr_b16 v[144:145], v218 offset:49152
    v_mfma_f32_16x16x32_bf16 v[64:67], v[132:135], a[120:123], v[64:67]
    ds_read_b64_tr_b16 v[146:147], v218 offset:51200
    v_mfma_f32_16x16x32_bf16 v[68:71], v[128:131], a[108:111], v[68:71]
    ds_read_b64_tr_b16 v[148:149], v218 offset:57344
    buffer_load_dwordx4 a[68:71], v227, s[8:11], s35 offen offset:0 sc1
    v_mfma_f32_16x16x32_bf16 v[68:71], v[132:135], a[124:127], v[68:71]
    ds_read_b64_tr_b16 v[150:151], v218 offset:59392
    v_mfma_f32_16x16x32_bf16 v[72:75], v[136:139], a[104:107], v[72:75]
    ds_read_b64_tr_b16 v[152:153], v219 offset:49152
    v_mfma_f32_16x16x32_bf16 v[72:75], v[140:143], a[120:123], v[72:75]
    ds_read_b64_tr_b16 v[154:155], v219 offset:51200
    v_mfma_f32_16x16x32_bf16 v[76:79], v[136:139], a[108:111], v[76:79]
    ds_read_b64_tr_b16 v[156:157], v219 offset:57344
    buffer_load_dwordx4 a[72:75], v245, s[8:11], s35 offen offset:0 sc1
    v_mfma_f32_16x16x32_bf16 v[76:79], v[140:143], a[124:127], v[76:79]
    ds_read_b64_tr_b16 v[158:159], v219 offset:59392
    s_waitcnt lgkmcnt(4)
    v_mfma_f32_16x16x32_bf16 v[80:83], v[144:147], a[104:107], v[80:83]
    ds_read_b64_tr_b16 v[128:129], v220 offset:49152
    v_mfma_f32_16x16x32_bf16 v[80:83], v[148:151], a[120:123], v[80:83]
    ds_read_b64_tr_b16 v[130:131], v220 offset:51200
    v_mfma_f32_16x16x32_bf16 v[84:87], v[144:147], a[108:111], v[84:87]
    ds_read_b64_tr_b16 v[132:133], v220 offset:57344
    buffer_load_dwordx4 a[76:79], v246, s[8:11], s35 offen offset:0 sc1
    v_mfma_f32_16x16x32_bf16 v[84:87], v[148:151], a[124:127], v[84:87]
    ds_read_b64_tr_b16 v[134:135], v220 offset:59392
    s_waitcnt lgkmcnt(4)
    v_mfma_f32_16x16x32_bf16 v[88:91], v[152:155], a[104:107], v[88:91]
    ds_read_b64_tr_b16 v[136:137], v221 offset:49152
    v_mfma_f32_16x16x32_bf16 v[88:91], v[156:159], a[120:123], v[88:91]
    ds_read_b64_tr_b16 v[138:139], v221 offset:51200
    buffer_load_dwordx4 v[208:211], v240, s[20:23], 0 offen
    v_mfma_f32_16x16x32_bf16 v[92:95], v[152:155], a[108:111], v[92:95]
    ds_read_b64_tr_b16 v[140:141], v221 offset:57344
    buffer_load_dwordx4 a[80:83], v226, s[8:11], s35 offen offset:1024 sc1
    v_mfma_f32_16x16x32_bf16 v[92:95], v[156:159], a[124:127], v[92:95]
    ds_read_b64_tr_b16 v[142:143], v221 offset:59392
    s_waitcnt lgkmcnt(4)
    v_mfma_f32_16x16x32_bf16 v[0:3], v[128:131], a[240:243], v[0:3]
    ds_read_b64_tr_b16 v[144:145], v222 offset:49152
    v_mfma_f32_16x16x32_bf16 v[0:3], v[132:135], a[248:251], v[0:3]
    ds_read_b64_tr_b16 v[146:147], v222 offset:51200
    v_mfma_f32_16x16x32_bf16 v[4:7], v[128:131], a[244:247], v[4:7]
    ds_read_b64_tr_b16 v[148:149], v222 offset:57344
    v_mfma_f32_16x16x32_bf16 v[4:7], v[132:135], a[252:255], v[4:7]
    ds_read_b64_tr_b16 v[150:151], v222 offset:59392
    v_mfma_f32_16x16x32_bf16 v[96:99], v[128:131], a[104:107], v[96:99]
    ds_read_b64_tr_b16 v[152:153], v223 offset:49152
    v_mfma_f32_16x16x32_bf16 v[96:99], v[132:135], a[120:123], v[96:99]
    ds_read_b64_tr_b16 v[154:155], v223 offset:51200
    s_mov_b32 s32, kc_tail-kc_pc0
    v_lshlrev_b32 v234, 7, v230
    buffer_load_dword v241, v234, s[56:59], s32 offen
    v_mfma_f32_16x16x32_bf16 v[100:103], v[128:131], a[108:111], v[100:103]
    ds_read_b64_tr_b16 v[156:157], v223 offset:57344
    v_mfma_f32_16x16x32_bf16 v[100:103], v[132:135], a[124:127], v[100:103]
    ds_read_b64_tr_b16 v[158:159], v223 offset:59392
    s_waitcnt lgkmcnt(8)
    v_mfma_f32_16x16x32_bf16 v[8:11], v[136:139], a[240:243], v[8:11]
    buffer_load_dwordx4 a[84:87], v227, s[8:11], s35 offen offset:1024 sc1
    v_mfma_f32_16x16x32_bf16 v[8:11], v[140:143], a[248:251], v[8:11]
    v_mfma_f32_16x16x32_bf16 v[12:15], v[136:139], a[244:247], v[12:15]
    v_mfma_f32_16x16x32_bf16 v[12:15], v[140:143], a[252:255], v[12:15]
    buffer_load_dwordx4 a[88:91], v245, s[8:11], s35 offen offset:1024 sc1
    v_mfma_f32_16x16x32_bf16 v[104:107], v[136:139], a[104:107], v[104:107]
    v_mfma_f32_16x16x32_bf16 v[104:107], v[140:143], a[120:123], v[104:107]
    v_mfma_f32_16x16x32_bf16 v[108:111], v[136:139], a[108:111], v[108:111]
    v_mfma_f32_16x16x32_bf16 v[108:111], v[140:143], a[124:127], v[108:111]
    buffer_load_dwordx4 a[92:95], v246, s[8:11], s35 offen offset:1024 sc1
    s_waitcnt vmcnt(24) lgkmcnt(0)
    s_barrier
    v_mfma_f32_16x16x32_bf16 v[16:19], v[144:147], a[240:243], v[16:19]
    v_xor_b32 v220, 0x10000, v220
    ds_read_b64_tr_b16 v[128:129], v220 offset:0
    v_mfma_f32_16x16x32_bf16 v[16:19], v[148:151], a[248:251], v[16:19]
    ds_read_b64_tr_b16 v[130:131], v220 offset:2048
    v_mfma_f32_16x16x32_bf16 v[20:23], v[144:147], a[244:247], v[20:23]
    ds_read_b64_tr_b16 v[132:133], v220 offset:8192
    v_mfma_f32_16x16x32_bf16 v[20:23], v[148:151], a[252:255], v[20:23]
    ds_read_b64_tr_b16 v[134:135], v220 offset:10240
    v_mfma_f32_16x16x32_bf16 v[112:115], v[144:147], a[104:107], v[112:115]
    v_xor_b32 v221, 0x10000, v221
    ds_read_b64_tr_b16 v[136:137], v221 offset:0
    v_mfma_f32_16x16x32_bf16 v[112:115], v[148:151], a[120:123], v[112:115]
    ds_read_b64_tr_b16 v[138:139], v221 offset:2048
    v_mfma_f32_16x16x32_bf16 v[116:119], v[144:147], a[108:111], v[116:119]
    ds_read_b64_tr_b16 v[140:141], v221 offset:8192
    v_mfma_f32_16x16x32_bf16 v[116:119], v[148:151], a[124:127], v[116:119]
    ds_read_b64_tr_b16 v[142:143], v221 offset:10240
    v_mfma_f32_16x16x32_bf16 v[24:27], v[152:155], a[240:243], v[24:27]
    v_mfma_f32_16x16x32_bf16 v[24:27], v[156:159], a[248:251], v[24:27]
    v_mfma_f32_16x16x32_bf16 v[28:31], v[152:155], a[244:247], v[28:31]
    v_mfma_f32_16x16x32_bf16 v[28:31], v[156:159], a[252:255], v[28:31]
    v_mfma_f32_16x16x32_bf16 v[120:123], v[152:155], a[104:107], v[120:123]
    v_mfma_f32_16x16x32_bf16 v[120:123], v[156:159], a[120:123], v[120:123]
    v_mfma_f32_16x16x32_bf16 v[124:127], v[152:155], a[108:111], v[124:127]
    v_mfma_f32_16x16x32_bf16 v[124:127], v[156:159], a[124:127], v[124:127]
    buffer_load_dwordx4 a[96:99], v226, s[8:11], s35 offen offset:2048 sc1
    s_waitcnt vmcnt(27) lgkmcnt(4)
    v_mfma_f32_16x16x32_bf16 v[96:99], v[128:131], a[8:11], v[96:99]
    v_xor_b32 v222, 0x10000, v222
    ds_read_b64_tr_b16 v[144:145], v222 offset:0
    v_mfma_f32_16x16x32_bf16 v[96:99], v[132:135], a[24:27], v[96:99]
    ds_read_b64_tr_b16 v[146:147], v222 offset:2048
    v_mfma_f32_16x16x32_bf16 v[100:103], v[128:131], a[12:15], v[100:103]
    ds_read_b64_tr_b16 v[148:149], v222 offset:8192
    buffer_load_dwordx4 a[100:103], v227, s[8:11], s35 offen offset:2048 sc1
    v_mfma_f32_16x16x32_bf16 v[100:103], v[132:135], a[28:31], v[100:103]
    ds_read_b64_tr_b16 v[150:151], v222 offset:10240
    s_waitcnt lgkmcnt(4)
    v_mfma_f32_16x16x32_bf16 v[104:107], v[136:139], a[8:11], v[104:107]
    v_xor_b32 v223, 0x10000, v223
    ds_read_b64_tr_b16 v[152:153], v223 offset:0
    v_mfma_f32_16x16x32_bf16 v[104:107], v[140:143], a[24:27], v[104:107]
    ds_read_b64_tr_b16 v[154:155], v223 offset:2048
    v_mfma_f32_16x16x32_bf16 v[108:111], v[136:139], a[12:15], v[108:111]
    ds_read_b64_tr_b16 v[156:157], v223 offset:8192
    buffer_load_dwordx4 a[104:107], v245, s[8:11], s35 offen offset:2048 sc1
    v_mfma_f32_16x16x32_bf16 v[108:111], v[140:143], a[28:31], v[108:111]
    ds_read_b64_tr_b16 v[158:159], v223 offset:10240
    s_waitcnt lgkmcnt(4)
    v_mfma_f32_16x16x32_bf16 v[112:115], v[144:147], a[8:11], v[112:115]
    ds_read_b64_tr_b16 v[128:129], v220 offset:16384
    v_mfma_f32_16x16x32_bf16 v[112:115], v[148:151], a[24:27], v[112:115]
    ds_read_b64_tr_b16 v[130:131], v220 offset:18432
    v_mfma_f32_16x16x32_bf16 v[116:119], v[144:147], a[12:15], v[116:119]
    ds_read_b64_tr_b16 v[132:133], v220 offset:24576
    buffer_load_dwordx4 a[108:111], v246, s[8:11], s35 offen offset:2048 sc1
    v_mfma_f32_16x16x32_bf16 v[116:119], v[148:151], a[28:31], v[116:119]
    ds_read_b64_tr_b16 v[134:135], v220 offset:26624
    s_waitcnt lgkmcnt(4)
    v_mfma_f32_16x16x32_bf16 v[120:123], v[152:155], a[8:11], v[120:123]
    ds_read_b64_tr_b16 v[136:137], v221 offset:16384
    v_mfma_f32_16x16x32_bf16 v[120:123], v[156:159], a[24:27], v[120:123]
    ds_read_b64_tr_b16 v[138:139], v221 offset:18432
    v_mfma_f32_16x16x32_bf16 v[124:127], v[152:155], a[12:15], v[124:127]
    ds_read_b64_tr_b16 v[140:141], v221 offset:24576
    buffer_load_dwordx4 a[112:115], v226, s[8:11], s35 offen offset:3072 sc1
    v_mfma_f32_16x16x32_bf16 v[124:127], v[156:159], a[28:31], v[124:127]
    ds_read_b64_tr_b16 v[142:143], v221 offset:26624
    s_waitcnt vmcnt(16) lgkmcnt(4)
    v_mfma_f32_16x16x32_bf16 v[96:99], v[128:131], a[40:43], v[96:99]
    ds_read_b64_tr_b16 v[144:145], v222 offset:16384
    v_mfma_f32_16x16x32_bf16 v[96:99], v[132:135], a[56:59], v[96:99]
    ds_read_b64_tr_b16 v[146:147], v222 offset:18432
    v_mfma_f32_16x16x32_bf16 v[100:103], v[128:131], a[44:47], v[100:103]
    ds_read_b64_tr_b16 v[148:149], v222 offset:24576
    buffer_load_dwordx4 a[116:119], v227, s[8:11], s35 offen offset:3072 sc1
    v_mfma_f32_16x16x32_bf16 v[100:103], v[132:135], a[60:63], v[100:103]
    ds_read_b64_tr_b16 v[150:151], v222 offset:26624
    s_waitcnt lgkmcnt(4)
    v_mfma_f32_16x16x32_bf16 v[104:107], v[136:139], a[40:43], v[104:107]
    ds_read_b64_tr_b16 v[152:153], v223 offset:16384
    v_mfma_f32_16x16x32_bf16 v[104:107], v[140:143], a[56:59], v[104:107]
    ds_read_b64_tr_b16 v[154:155], v223 offset:18432
    v_mfma_f32_16x16x32_bf16 v[108:111], v[136:139], a[44:47], v[108:111]
    ds_read_b64_tr_b16 v[156:157], v223 offset:24576
    buffer_load_dwordx4 a[120:123], v245, s[8:11], s35 offen offset:3072 sc1
    v_mfma_f32_16x16x32_bf16 v[108:111], v[140:143], a[60:63], v[108:111]
    ds_read_b64_tr_b16 v[158:159], v223 offset:26624
    s_waitcnt lgkmcnt(4)
    v_mfma_f32_16x16x32_bf16 v[112:115], v[144:147], a[40:43], v[112:115]
    ds_read_b64_tr_b16 v[128:129], v220 offset:32768
    v_mfma_f32_16x16x32_bf16 v[112:115], v[148:151], a[56:59], v[112:115]
    ds_read_b64_tr_b16 v[130:131], v220 offset:34816
    v_mfma_f32_16x16x32_bf16 v[116:119], v[144:147], a[44:47], v[116:119]
    ds_read_b64_tr_b16 v[132:133], v220 offset:40960
    buffer_load_dwordx4 a[124:127], v246, s[8:11], s35 offen offset:3072 sc1
    v_mfma_f32_16x16x32_bf16 v[116:119], v[148:151], a[60:63], v[116:119]
    ds_read_b64_tr_b16 v[134:135], v220 offset:43008
    s_waitcnt lgkmcnt(4)
    v_mfma_f32_16x16x32_bf16 v[120:123], v[152:155], a[40:43], v[120:123]
    ds_read_b64_tr_b16 v[136:137], v221 offset:32768
    v_mfma_f32_16x16x32_bf16 v[120:123], v[156:159], a[56:59], v[120:123]
    ds_read_b64_tr_b16 v[138:139], v221 offset:34816
    v_mfma_f32_16x16x32_bf16 v[124:127], v[152:155], a[44:47], v[124:127]
    ds_read_b64_tr_b16 v[140:141], v221 offset:40960
    v_mfma_f32_16x16x32_bf16 v[124:127], v[156:159], a[60:63], v[124:127]
    ds_read_b64_tr_b16 v[142:143], v221 offset:43008
    s_waitcnt vmcnt(8) lgkmcnt(4)
    v_mfma_f32_16x16x32_bf16 v[96:99], v[128:131], a[72:75], v[96:99]
    ds_read_b64_tr_b16 v[144:145], v222 offset:32768
    v_mfma_f32_16x16x32_bf16 v[96:99], v[132:135], a[88:91], v[96:99]
    ds_read_b64_tr_b16 v[146:147], v222 offset:34816
    s_xor_b32 s7, s39, 24
    v_mfma_f32_16x16x32_bf16 v[100:103], v[128:131], a[76:79], v[100:103]
    ds_read_b64_tr_b16 v[148:149], v222 offset:40960
    v_mfma_f32_16x16x32_bf16 v[100:103], v[132:135], a[92:95], v[100:103]
    ds_read_b64_tr_b16 v[150:151], v222 offset:43008
    s_waitcnt lgkmcnt(4)
    v_mfma_f32_16x16x32_bf16 v[104:107], v[136:139], a[72:75], v[104:107]
    ds_read_b64_tr_b16 v[152:153], v223 offset:32768
    v_mfma_f32_16x16x32_bf16 v[104:107], v[140:143], a[88:91], v[104:107]
    ds_read_b64_tr_b16 v[154:155], v223 offset:34816
    s_mul_i32 s7, s7, 12288
    v_mfma_f32_16x16x32_bf16 v[108:111], v[136:139], a[76:79], v[108:111]
    ds_read_b64_tr_b16 v[156:157], v223 offset:40960
    s_add_u32 s7, s7, 0x5002000
    v_mfma_f32_16x16x32_bf16 v[108:111], v[140:143], a[92:95], v[108:111]
    ds_read_b64_tr_b16 v[158:159], v223 offset:43008
    s_waitcnt lgkmcnt(4)
    v_mfma_f32_16x16x32_bf16 v[112:115], v[144:147], a[72:75], v[112:115]
    ds_read_b64_tr_b16 v[128:129], v220 offset:49152
    v_mfma_f32_16x16x32_bf16 v[112:115], v[148:151], a[88:91], v[112:115]
    ds_read_b64_tr_b16 v[130:131], v220 offset:51200
    s_xor_b32 s37, s39, 8
    v_mfma_f32_16x16x32_bf16 v[116:119], v[144:147], a[76:79], v[116:119]
    ds_read_b64_tr_b16 v[132:133], v220 offset:57344
    v_mfma_f32_16x16x32_bf16 v[116:119], v[148:151], a[92:95], v[116:119]
    ds_read_b64_tr_b16 v[134:135], v220 offset:59392
    s_waitcnt lgkmcnt(4)
    v_mfma_f32_16x16x32_bf16 v[120:123], v[152:155], a[72:75], v[120:123]
    ds_read_b64_tr_b16 v[136:137], v221 offset:49152
    v_mfma_f32_16x16x32_bf16 v[120:123], v[156:159], a[88:91], v[120:123]
    ds_read_b64_tr_b16 v[138:139], v221 offset:51200
    s_mul_i32 s37, s37, 12288
    v_mfma_f32_16x16x32_bf16 v[124:127], v[152:155], a[76:79], v[124:127]
    ds_read_b64_tr_b16 v[140:141], v221 offset:57344
    s_add_u32 s37, s37, 0x5000000
    v_mfma_f32_16x16x32_bf16 v[124:127], v[156:159], a[92:95], v[124:127]
    ds_read_b64_tr_b16 v[142:143], v221 offset:59392
    s_waitcnt vmcnt(0) lgkmcnt(4)
    v_mfma_f32_16x16x32_bf16 v[96:99], v[128:131], a[104:107], v[96:99]
    ds_read_b64_tr_b16 v[144:145], v222 offset:49152
    v_mfma_f32_16x16x32_bf16 v[96:99], v[132:135], a[120:123], v[96:99]
    ds_read_b64_tr_b16 v[146:147], v222 offset:51200
    s_xor_b32 s38, s39, 16
    v_mfma_f32_16x16x32_bf16 v[100:103], v[128:131], a[108:111], v[100:103]
    ds_read_b64_tr_b16 v[148:149], v222 offset:57344
    v_mfma_f32_16x16x32_bf16 v[100:103], v[132:135], a[124:127], v[100:103]
    ds_read_b64_tr_b16 v[150:151], v222 offset:59392
    s_waitcnt lgkmcnt(4)
    v_mfma_f32_16x16x32_bf16 v[104:107], v[136:139], a[104:107], v[104:107]
    ds_read_b64_tr_b16 v[152:153], v223 offset:49152
    v_mfma_f32_16x16x32_bf16 v[104:107], v[140:143], a[120:123], v[104:107]
    ds_read_b64_tr_b16 v[154:155], v223 offset:51200
    s_mul_i32 s38, s38, 12288
    v_mfma_f32_16x16x32_bf16 v[108:111], v[136:139], a[108:111], v[108:111]
    ds_read_b64_tr_b16 v[156:157], v223 offset:57344
    s_add_u32 s38, s38, 0x5001000
    v_mfma_f32_16x16x32_bf16 v[108:111], v[140:143], a[124:127], v[108:111]
    ds_read_b64_tr_b16 v[158:159], v223 offset:59392
    s_waitcnt lgkmcnt(4)
    v_mfma_f32_16x16x32_bf16 v[112:115], v[144:147], a[104:107], v[112:115]
    ds_read_b64_tr_b16 v[128:129], v220 offset:0
    v_mfma_f32_16x16x32_bf16 v[112:115], v[148:151], a[120:123], v[112:115]
    ds_read_b64_tr_b16 v[130:131], v220 offset:2048
    v_mfma_f32_16x16x32_bf16 v[116:119], v[144:147], a[108:111], v[116:119]
    ds_read_b64_tr_b16 v[132:133], v220 offset:8192
    v_mfma_f32_16x16x32_bf16 v[116:119], v[148:151], a[124:127], v[116:119]
    ds_read_b64_tr_b16 v[134:135], v220 offset:10240
    s_waitcnt lgkmcnt(4)
    v_mfma_f32_16x16x32_bf16 v[120:123], v[152:155], a[104:107], v[120:123]
    ds_read_b64_tr_b16 v[136:137], v221 offset:0
    v_mfma_f32_16x16x32_bf16 v[120:123], v[156:159], a[120:123], v[120:123]
    ds_read_b64_tr_b16 v[138:139], v221 offset:2048
    v_mfma_f32_16x16x32_bf16 v[124:127], v[152:155], a[108:111], v[124:127]
    ds_read_b64_tr_b16 v[140:141], v221 offset:8192
    v_mfma_f32_16x16x32_bf16 v[124:127], v[156:159], a[124:127], v[124:127]
    ds_read_b64_tr_b16 v[142:143], v221 offset:10240
    s_waitcnt lgkmcnt(4)
    v_mfma_f32_16x16x32_bf16 v[0:3], v[128:131], a[0:3], v[0:3]
    ds_read_b64_tr_b16 v[144:145], v222 offset:0
    v_mfma_f32_16x16x32_bf16 v[0:3], v[132:135], a[16:19], v[0:3]
    ds_read_b64_tr_b16 v[146:147], v222 offset:2048
    v_mfma_f32_16x16x32_bf16 v[4:7], v[128:131], a[4:7], v[4:7]
    ds_read_b64_tr_b16 v[148:149], v222 offset:8192
    v_mfma_f32_16x16x32_bf16 v[4:7], v[132:135], a[20:23], v[4:7]
    ds_read_b64_tr_b16 v[150:151], v222 offset:10240
    s_waitcnt lgkmcnt(4)
    v_mfma_f32_16x16x32_bf16 v[8:11], v[136:139], a[0:3], v[8:11]
    ds_read_b64_tr_b16 v[152:153], v223 offset:0
    v_mfma_f32_16x16x32_bf16 v[8:11], v[140:143], a[16:19], v[8:11]
    ds_read_b64_tr_b16 v[154:155], v223 offset:2048
    v_mfma_f32_16x16x32_bf16 v[12:15], v[136:139], a[4:7], v[12:15]
    ds_read_b64_tr_b16 v[156:157], v223 offset:8192
    v_mfma_f32_16x16x32_bf16 v[12:15], v[140:143], a[20:23], v[12:15]
    ds_read_b64_tr_b16 v[158:159], v223 offset:10240
    s_waitcnt lgkmcnt(4)
    v_mfma_f32_16x16x32_bf16 v[16:19], v[144:147], a[0:3], v[16:19]
    ds_read_b64_tr_b16 v[128:129], v220 offset:16384
    s_mul_i32 s33, s39, 12288
    s_add_u32 s33, s33, 0x5002000
    v_mfma_f32_16x16x32_bf16 v[16:19], v[148:151], a[16:19], v[16:19]
    ds_read_b64_tr_b16 v[130:131], v220 offset:18432
    v_mfma_f32_16x16x32_bf16 v[20:23], v[144:147], a[4:7], v[20:23]
    ds_read_b64_tr_b16 v[132:133], v220 offset:24576
    v_cvt_pk_bf16_f32 v96, v96, v97
    v_mfma_f32_16x16x32_bf16 v[20:23], v[148:151], a[20:23], v[20:23]
    ds_read_b64_tr_b16 v[134:135], v220 offset:26624
    v_cvt_pk_bf16_f32 v97, v98, v99
    s_waitcnt lgkmcnt(4)
    v_mfma_f32_16x16x32_bf16 v[24:27], v[152:155], a[0:3], v[24:27]
    ds_read_b64_tr_b16 v[136:137], v221 offset:16384
    v_cvt_pk_bf16_f32 v98, v100, v101
    v_mfma_f32_16x16x32_bf16 v[24:27], v[156:159], a[16:19], v[24:27]
    ds_read_b64_tr_b16 v[138:139], v221 offset:18432
    v_cvt_pk_bf16_f32 v99, v102, v103
    v_mfma_f32_16x16x32_bf16 v[28:31], v[152:155], a[4:7], v[28:31]
    ds_read_b64_tr_b16 v[140:141], v221 offset:24576
    v_min_u32_e64 v96, -2, v96
    v_mfma_f32_16x16x32_bf16 v[28:31], v[156:159], a[20:23], v[28:31]
    ds_read_b64_tr_b16 v[142:143], v221 offset:26624
    v_min_u32 v97, -2, v97
    s_waitcnt lgkmcnt(4)
    v_mfma_f32_16x16x32_bf16 v[0:3], v[128:131], a[32:35], v[0:3]
    ds_read_b64_tr_b16 v[144:145], v222 offset:16384
    v_min_u32_e64 v98, -2, v98
    v_mfma_f32_16x16x32_bf16 v[0:3], v[132:135], a[48:51], v[0:3]
    ds_read_b64_tr_b16 v[146:147], v222 offset:18432
    v_min_u32_e64 v99, -2, v99
    v_mfma_f32_16x16x32_bf16 v[4:7], v[128:131], a[36:39], v[4:7]
    ds_read_b64_tr_b16 v[148:149], v222 offset:24576
    buffer_store_dwordx4 v[96:99], v228, s[8:11], s33 offen offset:0 sc1
    v_mfma_f32_16x16x32_bf16 v[4:7], v[132:135], a[52:55], v[4:7]
    ds_read_b64_tr_b16 v[150:151], v222 offset:26624
    s_waitcnt lgkmcnt(4)
    v_mfma_f32_16x16x32_bf16 v[8:11], v[136:139], a[32:35], v[8:11]
    ds_read_b64_tr_b16 v[152:153], v223 offset:16384
    v_mfma_f32_16x16x32_bf16 v[8:11], v[140:143], a[48:51], v[8:11]
    ds_read_b64_tr_b16 v[154:155], v223 offset:18432
    v_mfma_f32_16x16x32_bf16 v[12:15], v[136:139], a[36:39], v[12:15]
    ds_read_b64_tr_b16 v[156:157], v223 offset:24576
    v_cvt_pk_bf16_f32 v100, v104, v105
    v_mfma_f32_16x16x32_bf16 v[12:15], v[140:143], a[52:55], v[12:15]
    ds_read_b64_tr_b16 v[158:159], v223 offset:26624
    v_cvt_pk_bf16_f32 v101, v106, v107
    s_waitcnt lgkmcnt(4)
    v_mfma_f32_16x16x32_bf16 v[16:19], v[144:147], a[32:35], v[16:19]
    ds_read_b64_tr_b16 v[128:129], v220 offset:32768
    v_cvt_pk_bf16_f32 v102, v108, v109
    v_mfma_f32_16x16x32_bf16 v[16:19], v[148:151], a[48:51], v[16:19]
    ds_read_b64_tr_b16 v[130:131], v220 offset:34816
    v_cvt_pk_bf16_f32 v103, v110, v111
    v_mfma_f32_16x16x32_bf16 v[20:23], v[144:147], a[36:39], v[20:23]
    ds_read_b64_tr_b16 v[132:133], v220 offset:40960
    v_min_u32_e64 v100, -2, v100
    v_mfma_f32_16x16x32_bf16 v[20:23], v[148:151], a[52:55], v[20:23]
    ds_read_b64_tr_b16 v[134:135], v220 offset:43008
    v_min_u32 v101, -2, v101
    s_waitcnt lgkmcnt(4)
    v_mfma_f32_16x16x32_bf16 v[24:27], v[152:155], a[32:35], v[24:27]
    ds_read_b64_tr_b16 v[136:137], v221 offset:32768
    v_min_u32_e64 v102, -2, v102
    v_mfma_f32_16x16x32_bf16 v[24:27], v[156:159], a[48:51], v[24:27]
    ds_read_b64_tr_b16 v[138:139], v221 offset:34816
    v_min_u32_e64 v103, -2, v103
    v_mfma_f32_16x16x32_bf16 v[28:31], v[152:155], a[36:39], v[28:31]
    ds_read_b64_tr_b16 v[140:141], v221 offset:40960
    buffer_store_dwordx4 v[100:103], v228, s[8:11], s33 offen offset:1024 sc1
    v_mfma_f32_16x16x32_bf16 v[28:31], v[156:159], a[52:55], v[28:31]
    ds_read_b64_tr_b16 v[142:143], v221 offset:43008
    s_waitcnt lgkmcnt(4)
    v_mfma_f32_16x16x32_bf16 v[0:3], v[128:131], a[64:67], v[0:3]
    ds_read_b64_tr_b16 v[144:145], v222 offset:32768
    v_mfma_f32_16x16x32_bf16 v[0:3], v[132:135], a[80:83], v[0:3]
    ds_read_b64_tr_b16 v[146:147], v222 offset:34816
    v_mfma_f32_16x16x32_bf16 v[4:7], v[128:131], a[68:71], v[4:7]
    ds_read_b64_tr_b16 v[148:149], v222 offset:40960
    v_cvt_pk_bf16_f32 v104, v112, v113
    v_mfma_f32_16x16x32_bf16 v[4:7], v[132:135], a[84:87], v[4:7]
    ds_read_b64_tr_b16 v[150:151], v222 offset:43008
    v_cvt_pk_bf16_f32 v105, v114, v115
    s_waitcnt lgkmcnt(4)
    v_mfma_f32_16x16x32_bf16 v[8:11], v[136:139], a[64:67], v[8:11]
    ds_read_b64_tr_b16 v[152:153], v223 offset:32768
    v_cvt_pk_bf16_f32 v106, v116, v117
    v_mfma_f32_16x16x32_bf16 v[8:11], v[140:143], a[80:83], v[8:11]
    ds_read_b64_tr_b16 v[154:155], v223 offset:34816
    v_cvt_pk_bf16_f32 v107, v118, v119
    v_mfma_f32_16x16x32_bf16 v[12:15], v[136:139], a[68:71], v[12:15]
    ds_read_b64_tr_b16 v[156:157], v223 offset:40960
    v_min_u32_e64 v104, -2, v104
    v_mfma_f32_16x16x32_bf16 v[12:15], v[140:143], a[84:87], v[12:15]
    ds_read_b64_tr_b16 v[158:159], v223 offset:43008
    v_min_u32 v105, -2, v105
    s_waitcnt lgkmcnt(4)
    v_mfma_f32_16x16x32_bf16 v[16:19], v[144:147], a[64:67], v[16:19]
    ds_read_b64_tr_b16 v[128:129], v220 offset:49152
    v_min_u32_e64 v106, -2, v106
    v_mfma_f32_16x16x32_bf16 v[16:19], v[148:151], a[80:83], v[16:19]
    ds_read_b64_tr_b16 v[130:131], v220 offset:51200
    v_min_u32_e64 v107, -2, v107
    v_mfma_f32_16x16x32_bf16 v[20:23], v[144:147], a[68:71], v[20:23]
    ds_read_b64_tr_b16 v[132:133], v220 offset:57344
    buffer_store_dwordx4 v[104:107], v228, s[8:11], s33 offen offset:2048 sc1
    v_mfma_f32_16x16x32_bf16 v[20:23], v[148:151], a[84:87], v[20:23]
    ds_read_b64_tr_b16 v[134:135], v220 offset:59392
    s_waitcnt lgkmcnt(4)
    v_mfma_f32_16x16x32_bf16 v[24:27], v[152:155], a[64:67], v[24:27]
    ds_read_b64_tr_b16 v[136:137], v221 offset:49152
    v_mfma_f32_16x16x32_bf16 v[24:27], v[156:159], a[80:83], v[24:27]
    ds_read_b64_tr_b16 v[138:139], v221 offset:51200
    v_mfma_f32_16x16x32_bf16 v[28:31], v[152:155], a[68:71], v[28:31]
    ds_read_b64_tr_b16 v[140:141], v221 offset:57344
    v_cvt_pk_bf16_f32 v108, v120, v121
    v_mfma_f32_16x16x32_bf16 v[28:31], v[156:159], a[84:87], v[28:31]
    ds_read_b64_tr_b16 v[142:143], v221 offset:59392
    v_cvt_pk_bf16_f32 v109, v122, v123
    s_waitcnt lgkmcnt(4)
    v_mfma_f32_16x16x32_bf16 v[0:3], v[128:131], a[96:99], v[0:3]
    ds_read_b64_tr_b16 v[144:145], v222 offset:49152
    v_cvt_pk_bf16_f32 v110, v124, v125
    v_mfma_f32_16x16x32_bf16 v[0:3], v[132:135], a[112:115], v[0:3]
    ds_read_b64_tr_b16 v[146:147], v222 offset:51200
    v_cvt_pk_bf16_f32 v111, v126, v127
    v_mfma_f32_16x16x32_bf16 v[4:7], v[128:131], a[100:103], v[4:7]
    ds_read_b64_tr_b16 v[148:149], v222 offset:57344
    v_min_u32_e64 v108, -2, v108
    v_mfma_f32_16x16x32_bf16 v[4:7], v[132:135], a[116:119], v[4:7]
    ds_read_b64_tr_b16 v[150:151], v222 offset:59392
    v_min_u32 v109, -2, v109
    s_waitcnt lgkmcnt(4)
    v_mfma_f32_16x16x32_bf16 v[8:11], v[136:139], a[96:99], v[8:11]
    ds_read_b64_tr_b16 v[152:153], v223 offset:49152
    v_min_u32_e64 v110, -2, v110
    v_mfma_f32_16x16x32_bf16 v[8:11], v[140:143], a[112:115], v[8:11]
    ds_read_b64_tr_b16 v[154:155], v223 offset:51200
    v_min_u32_e64 v111, -2, v111
    v_mfma_f32_16x16x32_bf16 v[12:15], v[136:139], a[100:103], v[12:15]
    ds_read_b64_tr_b16 v[156:157], v223 offset:57344
    buffer_store_dwordx4 v[108:111], v228, s[8:11], s33 offen offset:3072 sc1
    v_mfma_f32_16x16x32_bf16 v[12:15], v[140:143], a[116:119], v[12:15]
    ds_read_b64_tr_b16 v[158:159], v223 offset:59392
    s_waitcnt lgkmcnt(4)
    v_mfma_f32_16x16x32_bf16 v[16:19], v[144:147], a[96:99], v[16:19]
    v_xor_b32 v216, 0x10000, v216
    ds_read_b64_tr_b16 v[128:129], v216 offset:0
    v_mfma_f32_16x16x32_bf16 v[16:19], v[148:151], a[112:115], v[16:19]
    ds_read_b64_tr_b16 v[130:131], v216 offset:2048
    v_mfma_f32_16x16x32_bf16 v[20:23], v[144:147], a[100:103], v[20:23]
    ds_read_b64_tr_b16 v[132:133], v216 offset:8192
    v_mfma_f32_16x16x32_bf16 v[20:23], v[148:151], a[116:119], v[20:23]
    ds_read_b64_tr_b16 v[134:135], v216 offset:10240
    s_waitcnt lgkmcnt(4)
    v_mfma_f32_16x16x32_bf16 v[24:27], v[152:155], a[96:99], v[24:27]
    v_xor_b32 v217, 0x10000, v217
    ds_read_b64_tr_b16 v[136:137], v217 offset:0
    v_mfma_f32_16x16x32_bf16 v[24:27], v[156:159], a[112:115], v[24:27]
    ds_read_b64_tr_b16 v[138:139], v217 offset:2048
    v_mfma_f32_16x16x32_bf16 v[28:31], v[152:155], a[100:103], v[28:31]
    ds_read_b64_tr_b16 v[140:141], v217 offset:8192
    v_mfma_f32_16x16x32_bf16 v[28:31], v[156:159], a[116:119], v[28:31]
    ds_read_b64_tr_b16 v[142:143], v217 offset:10240
    s_waitcnt lgkmcnt(4)
    v_mfma_f32_16x16x32_bf16 v[64:67], v[128:131], a[8:11], v[64:67]
    v_xor_b32 v218, 0x10000, v218
    ds_read_b64_tr_b16 v[144:145], v218 offset:0
    v_mfma_f32_16x16x32_bf16 v[64:67], v[132:135], a[24:27], v[64:67]
    ds_read_b64_tr_b16 v[146:147], v218 offset:2048
    v_mfma_f32_16x16x32_bf16 v[68:71], v[128:131], a[12:15], v[68:71]
    ds_read_b64_tr_b16 v[148:149], v218 offset:8192
    v_mfma_f32_16x16x32_bf16 v[68:71], v[132:135], a[28:31], v[68:71]
    ds_read_b64_tr_b16 v[150:151], v218 offset:10240
    s_waitcnt lgkmcnt(4)
    v_mfma_f32_16x16x32_bf16 v[72:75], v[136:139], a[8:11], v[72:75]
    v_xor_b32 v219, 0x10000, v219
    ds_read_b64_tr_b16 v[152:153], v219 offset:0
    v_mfma_f32_16x16x32_bf16 v[72:75], v[140:143], a[24:27], v[72:75]
    ds_read_b64_tr_b16 v[154:155], v219 offset:2048
    v_mfma_f32_16x16x32_bf16 v[76:79], v[136:139], a[12:15], v[76:79]
    ds_read_b64_tr_b16 v[156:157], v219 offset:8192
    v_mfma_f32_16x16x32_bf16 v[76:79], v[140:143], a[28:31], v[76:79]
    ds_read_b64_tr_b16 v[158:159], v219 offset:10240
    s_waitcnt lgkmcnt(4)
    v_mfma_f32_16x16x32_bf16 v[80:83], v[144:147], a[8:11], v[80:83]
    ds_read_b64_tr_b16 v[128:129], v216 offset:16384
    s_mul_i32 s33, s39, 12288
    s_add_u32 s33, s33, 0x5000000
    v_mfma_f32_16x16x32_bf16 v[80:83], v[148:151], a[24:27], v[80:83]
    ds_read_b64_tr_b16 v[130:131], v216 offset:18432
    v_mfma_f32_16x16x32_bf16 v[84:87], v[144:147], a[12:15], v[84:87]
    ds_read_b64_tr_b16 v[132:133], v216 offset:24576
    v_cvt_pk_bf16_f32 v0, v0, v1
    v_mfma_f32_16x16x32_bf16 v[84:87], v[148:151], a[28:31], v[84:87]
    ds_read_b64_tr_b16 v[134:135], v216 offset:26624
    v_cvt_pk_bf16_f32 v1, v2, v3
    s_waitcnt lgkmcnt(4)
    v_mfma_f32_16x16x32_bf16 v[88:91], v[152:155], a[8:11], v[88:91]
    ds_read_b64_tr_b16 v[136:137], v217 offset:16384
    v_cvt_pk_bf16_f32 v2, v4, v5
    v_mfma_f32_16x16x32_bf16 v[88:91], v[156:159], a[24:27], v[88:91]
    ds_read_b64_tr_b16 v[138:139], v217 offset:18432
    v_cvt_pk_bf16_f32 v3, v6, v7
    v_mfma_f32_16x16x32_bf16 v[92:95], v[152:155], a[12:15], v[92:95]
    ds_read_b64_tr_b16 v[140:141], v217 offset:24576
    v_min_u32_e64 v0, -2, v0
    v_mfma_f32_16x16x32_bf16 v[92:95], v[156:159], a[28:31], v[92:95]
    ds_read_b64_tr_b16 v[142:143], v217 offset:26624
    v_min_u32 v1, -2, v1
    s_waitcnt lgkmcnt(4)
    v_mfma_f32_16x16x32_bf16 v[64:67], v[128:131], a[40:43], v[64:67]
    ds_read_b64_tr_b16 v[144:145], v218 offset:16384
    v_min_u32_e64 v2, -2, v2
    v_mfma_f32_16x16x32_bf16 v[64:67], v[132:135], a[56:59], v[64:67]
    ds_read_b64_tr_b16 v[146:147], v218 offset:18432
    v_min_u32_e64 v3, -2, v3
    v_mfma_f32_16x16x32_bf16 v[68:71], v[128:131], a[44:47], v[68:71]
    ds_read_b64_tr_b16 v[148:149], v218 offset:24576
    buffer_store_dwordx4 v[0:3], v228, s[8:11], s33 offen offset:0 sc1
    v_mfma_f32_16x16x32_bf16 v[68:71], v[132:135], a[60:63], v[68:71]
    ds_read_b64_tr_b16 v[150:151], v218 offset:26624
    s_waitcnt lgkmcnt(4)
    v_mfma_f32_16x16x32_bf16 v[72:75], v[136:139], a[40:43], v[72:75]
    ds_read_b64_tr_b16 v[152:153], v219 offset:16384
    v_mfma_f32_16x16x32_bf16 v[72:75], v[140:143], a[56:59], v[72:75]
    ds_read_b64_tr_b16 v[154:155], v219 offset:18432
    v_mfma_f32_16x16x32_bf16 v[76:79], v[136:139], a[44:47], v[76:79]
    ds_read_b64_tr_b16 v[156:157], v219 offset:24576
    v_cvt_pk_bf16_f32 v4, v8, v9
    v_mfma_f32_16x16x32_bf16 v[76:79], v[140:143], a[60:63], v[76:79]
    ds_read_b64_tr_b16 v[158:159], v219 offset:26624
    v_cvt_pk_bf16_f32 v5, v10, v11
    s_waitcnt lgkmcnt(4)
    v_mfma_f32_16x16x32_bf16 v[80:83], v[144:147], a[40:43], v[80:83]
    ds_read_b64_tr_b16 v[128:129], v216 offset:32768
    v_cvt_pk_bf16_f32 v6, v12, v13
    v_mfma_f32_16x16x32_bf16 v[80:83], v[148:151], a[56:59], v[80:83]
    ds_read_b64_tr_b16 v[130:131], v216 offset:34816
    v_cvt_pk_bf16_f32 v7, v14, v15
    v_mfma_f32_16x16x32_bf16 v[84:87], v[144:147], a[44:47], v[84:87]
    ds_read_b64_tr_b16 v[132:133], v216 offset:40960
    v_min_u32_e64 v4, -2, v4
    v_mfma_f32_16x16x32_bf16 v[84:87], v[148:151], a[60:63], v[84:87]
    ds_read_b64_tr_b16 v[134:135], v216 offset:43008
    v_min_u32 v5, -2, v5
    s_waitcnt lgkmcnt(4)
    v_mfma_f32_16x16x32_bf16 v[88:91], v[152:155], a[40:43], v[88:91]
    ds_read_b64_tr_b16 v[136:137], v217 offset:32768
    v_min_u32_e64 v6, -2, v6
    v_mfma_f32_16x16x32_bf16 v[88:91], v[156:159], a[56:59], v[88:91]
    ds_read_b64_tr_b16 v[138:139], v217 offset:34816
    v_min_u32_e64 v7, -2, v7
    v_mfma_f32_16x16x32_bf16 v[92:95], v[152:155], a[44:47], v[92:95]
    ds_read_b64_tr_b16 v[140:141], v217 offset:40960
    buffer_store_dwordx4 v[4:7], v228, s[8:11], s33 offen offset:1024 sc1
    v_mfma_f32_16x16x32_bf16 v[92:95], v[156:159], a[60:63], v[92:95]
    ds_read_b64_tr_b16 v[142:143], v217 offset:43008
    s_waitcnt lgkmcnt(4)
    v_mfma_f32_16x16x32_bf16 v[64:67], v[128:131], a[72:75], v[64:67]
    ds_read_b64_tr_b16 v[144:145], v218 offset:32768
    v_mfma_f32_16x16x32_bf16 v[64:67], v[132:135], a[88:91], v[64:67]
    ds_read_b64_tr_b16 v[146:147], v218 offset:34816
    v_mfma_f32_16x16x32_bf16 v[68:71], v[128:131], a[76:79], v[68:71]
    ds_read_b64_tr_b16 v[148:149], v218 offset:40960
    v_cvt_pk_bf16_f32 v8, v16, v17
    v_mfma_f32_16x16x32_bf16 v[68:71], v[132:135], a[92:95], v[68:71]
    ds_read_b64_tr_b16 v[150:151], v218 offset:43008
    v_cvt_pk_bf16_f32 v9, v18, v19
    s_waitcnt lgkmcnt(4)
    v_mfma_f32_16x16x32_bf16 v[72:75], v[136:139], a[72:75], v[72:75]
    ds_read_b64_tr_b16 v[152:153], v219 offset:32768
    v_cvt_pk_bf16_f32 v10, v20, v21
    v_mfma_f32_16x16x32_bf16 v[72:75], v[140:143], a[88:91], v[72:75]
    ds_read_b64_tr_b16 v[154:155], v219 offset:34816
    v_cvt_pk_bf16_f32 v11, v22, v23
    v_mfma_f32_16x16x32_bf16 v[76:79], v[136:139], a[76:79], v[76:79]
    ds_read_b64_tr_b16 v[156:157], v219 offset:40960
    v_min_u32_e64 v8, -2, v8
    v_mfma_f32_16x16x32_bf16 v[76:79], v[140:143], a[92:95], v[76:79]
    ds_read_b64_tr_b16 v[158:159], v219 offset:43008
    v_min_u32 v9, -2, v9
    s_waitcnt lgkmcnt(4)
    v_mfma_f32_16x16x32_bf16 v[80:83], v[144:147], a[72:75], v[80:83]
    ds_read_b64_tr_b16 v[128:129], v216 offset:49152
    v_min_u32_e64 v10, -2, v10
    v_mfma_f32_16x16x32_bf16 v[80:83], v[148:151], a[88:91], v[80:83]
    ds_read_b64_tr_b16 v[130:131], v216 offset:51200
    v_min_u32_e64 v11, -2, v11
    v_mfma_f32_16x16x32_bf16 v[84:87], v[144:147], a[76:79], v[84:87]
    ds_read_b64_tr_b16 v[132:133], v216 offset:57344
    buffer_store_dwordx4 v[8:11], v228, s[8:11], s33 offen offset:2048 sc1
    v_mfma_f32_16x16x32_bf16 v[84:87], v[148:151], a[92:95], v[84:87]
    ds_read_b64_tr_b16 v[134:135], v216 offset:59392
    s_waitcnt lgkmcnt(4)
    v_mfma_f32_16x16x32_bf16 v[88:91], v[152:155], a[72:75], v[88:91]
    ds_read_b64_tr_b16 v[136:137], v217 offset:49152
    v_mfma_f32_16x16x32_bf16 v[88:91], v[156:159], a[88:91], v[88:91]
    ds_read_b64_tr_b16 v[138:139], v217 offset:51200
    v_mfma_f32_16x16x32_bf16 v[92:95], v[152:155], a[76:79], v[92:95]
    ds_read_b64_tr_b16 v[140:141], v217 offset:57344
    v_cvt_pk_bf16_f32 v12, v24, v25
    v_mfma_f32_16x16x32_bf16 v[92:95], v[156:159], a[92:95], v[92:95]
    ds_read_b64_tr_b16 v[142:143], v217 offset:59392
    v_cvt_pk_bf16_f32 v13, v26, v27
    s_waitcnt lgkmcnt(4)
    v_mfma_f32_16x16x32_bf16 v[64:67], v[128:131], a[104:107], v[64:67]
    ds_read_b64_tr_b16 v[144:145], v218 offset:49152
    v_cvt_pk_bf16_f32 v14, v28, v29
    v_mfma_f32_16x16x32_bf16 v[64:67], v[132:135], a[120:123], v[64:67]
    ds_read_b64_tr_b16 v[146:147], v218 offset:51200
    v_cvt_pk_bf16_f32 v15, v30, v31
    v_mfma_f32_16x16x32_bf16 v[68:71], v[128:131], a[108:111], v[68:71]
    ds_read_b64_tr_b16 v[148:149], v218 offset:57344
    v_min_u32_e64 v12, -2, v12
    v_mfma_f32_16x16x32_bf16 v[68:71], v[132:135], a[124:127], v[68:71]
    ds_read_b64_tr_b16 v[150:151], v218 offset:59392
    v_min_u32 v13, -2, v13
    s_waitcnt lgkmcnt(4)
    v_mfma_f32_16x16x32_bf16 v[72:75], v[136:139], a[104:107], v[72:75]
    ds_read_b64_tr_b16 v[152:153], v219 offset:49152
    v_min_u32_e64 v14, -2, v14
    v_mfma_f32_16x16x32_bf16 v[72:75], v[140:143], a[120:123], v[72:75]
    ds_read_b64_tr_b16 v[154:155], v219 offset:51200
    v_min_u32_e64 v15, -2, v15
    v_mfma_f32_16x16x32_bf16 v[76:79], v[136:139], a[108:111], v[76:79]
    ds_read_b64_tr_b16 v[156:157], v219 offset:57344
    buffer_store_dwordx4 v[12:15], v228, s[8:11], s33 offen offset:3072 sc1
    v_mfma_f32_16x16x32_bf16 v[76:79], v[140:143], a[124:127], v[76:79]
    ds_read_b64_tr_b16 v[158:159], v219 offset:59392
    s_waitcnt lgkmcnt(4)
    v_mfma_f32_16x16x32_bf16 v[80:83], v[144:147], a[104:107], v[80:83]
    v_xor_b32 v216, 0x10000, v216
    ds_read_b64_tr_b16 v[128:129], v216 offset:32768
    v_mfma_f32_16x16x32_bf16 v[80:83], v[148:151], a[120:123], v[80:83]
    ds_read_b64_tr_b16 v[130:131], v216 offset:34816
    v_mfma_f32_16x16x32_bf16 v[84:87], v[144:147], a[108:111], v[84:87]
    ds_read_b64_tr_b16 v[132:133], v216 offset:40960
    v_mfma_f32_16x16x32_bf16 v[84:87], v[148:151], a[124:127], v[84:87]
    ds_read_b64_tr_b16 v[134:135], v216 offset:43008
    s_waitcnt lgkmcnt(4)
    v_mfma_f32_16x16x32_bf16 v[88:91], v[152:155], a[104:107], v[88:91]
    v_xor_b32 v217, 0x10000, v217
    ds_read_b64_tr_b16 v[136:137], v217 offset:32768
    v_mfma_f32_16x16x32_bf16 v[88:91], v[156:159], a[120:123], v[88:91]
    ds_read_b64_tr_b16 v[138:139], v217 offset:34816
    v_mfma_f32_16x16x32_bf16 v[92:95], v[152:155], a[108:111], v[92:95]
    ds_read_b64_tr_b16 v[140:141], v217 offset:40960
    v_mfma_f32_16x16x32_bf16 v[92:95], v[156:159], a[124:127], v[92:95]
    ds_read_b64_tr_b16 v[142:143], v217 offset:43008
    s_waitcnt lgkmcnt(4)
    v_mfma_f32_16x16x32_bf16 v[32:35], v[128:131], a[224:227], v[32:35]
    v_xor_b32 v218, 0x10000, v218
    ds_read_b64_tr_b16 v[144:145], v218 offset:32768
    v_mfma_f32_16x16x32_bf16 v[32:35], v[132:135], a[232:235], v[32:35]
    ds_read_b64_tr_b16 v[146:147], v218 offset:34816
    buffer_load_dwordx4 v[176:179], v228, s[8:11], s7 offen offset:0 sc1
    v_mfma_f32_16x16x32_bf16 v[36:39], v[128:131], a[228:231], v[36:39]
    ds_read_b64_tr_b16 v[148:149], v218 offset:40960
    v_mfma_f32_16x16x32_bf16 v[36:39], v[132:135], a[236:239], v[36:39]
    ds_read_b64_tr_b16 v[150:151], v218 offset:43008
    buffer_load_dwordx4 v[180:183], v228, s[8:11], s7 offen offset:1024 sc1
    s_waitcnt lgkmcnt(4)
    v_mfma_f32_16x16x32_bf16 v[40:43], v[136:139], a[224:227], v[40:43]
    v_xor_b32 v219, 0x10000, v219
    ds_read_b64_tr_b16 v[152:153], v219 offset:32768
    v_mfma_f32_16x16x32_bf16 v[40:43], v[140:143], a[232:235], v[40:43]
    ds_read_b64_tr_b16 v[154:155], v219 offset:34816
    buffer_load_dwordx4 v[184:187], v228, s[8:11], s7 offen offset:2048 sc1
    v_mfma_f32_16x16x32_bf16 v[44:47], v[136:139], a[228:231], v[44:47]
    ds_read_b64_tr_b16 v[156:157], v219 offset:40960
    v_mfma_f32_16x16x32_bf16 v[44:47], v[140:143], a[236:239], v[44:47]
    ds_read_b64_tr_b16 v[158:159], v219 offset:43008
    buffer_load_dwordx4 v[188:191], v228, s[8:11], s7 offen offset:3072 sc1
    s_waitcnt lgkmcnt(4)
    v_mfma_f32_16x16x32_bf16 v[48:51], v[144:147], a[224:227], v[48:51]
    ds_read_b64_tr_b16 v[128:129], v216 offset:49152
    s_mul_i32 s33, s39, 12288
    s_add_u32 s33, s33, 0x5001000
    v_mfma_f32_16x16x32_bf16 v[48:51], v[148:151], a[232:235], v[48:51]
    ds_read_b64_tr_b16 v[130:131], v216 offset:51200
    v_mfma_f32_16x16x32_bf16 v[52:55], v[144:147], a[228:231], v[52:55]
    ds_read_b64_tr_b16 v[132:133], v216 offset:57344
    v_cvt_pk_bf16_f32 v64, v64, v65
    v_mfma_f32_16x16x32_bf16 v[52:55], v[148:151], a[236:239], v[52:55]
    ds_read_b64_tr_b16 v[134:135], v216 offset:59392
    v_cvt_pk_bf16_f32 v65, v66, v67
    s_waitcnt lgkmcnt(4)
    v_mfma_f32_16x16x32_bf16 v[56:59], v[152:155], a[224:227], v[56:59]
    ds_read_b64_tr_b16 v[136:137], v217 offset:49152
    v_cvt_pk_bf16_f32 v66, v68, v69
    v_mfma_f32_16x16x32_bf16 v[56:59], v[156:159], a[232:235], v[56:59]
    ds_read_b64_tr_b16 v[138:139], v217 offset:51200
    v_cvt_pk_bf16_f32 v67, v70, v71
    v_mfma_f32_16x16x32_bf16 v[60:63], v[152:155], a[228:231], v[60:63]
    ds_read_b64_tr_b16 v[140:141], v217 offset:57344
    v_min_u32_e64 v64, -2, v64
    v_mfma_f32_16x16x32_bf16 v[60:63], v[156:159], a[236:239], v[60:63]
    ds_read_b64_tr_b16 v[142:143], v217 offset:59392
    v_min_u32 v65, -2, v65
    s_waitcnt lgkmcnt(4)
    v_mfma_f32_16x16x32_bf16 v[32:35], v[128:131], a[240:243], v[32:35]
    ds_read_b64_tr_b16 v[144:145], v218 offset:49152
    v_min_u32_e64 v66, -2, v66
    v_mfma_f32_16x16x32_bf16 v[32:35], v[132:135], a[248:251], v[32:35]
    ds_read_b64_tr_b16 v[146:147], v218 offset:51200
    v_min_u32_e64 v67, -2, v67
    v_mfma_f32_16x16x32_bf16 v[36:39], v[128:131], a[244:247], v[36:39]
    ds_read_b64_tr_b16 v[148:149], v218 offset:57344
    buffer_store_dwordx4 v[64:67], v228, s[8:11], s33 offen offset:0 sc1
    v_mfma_f32_16x16x32_bf16 v[36:39], v[132:135], a[252:255], v[36:39]
    ds_read_b64_tr_b16 v[150:151], v218 offset:59392
    s_waitcnt lgkmcnt(4)
    v_mfma_f32_16x16x32_bf16 v[40:43], v[136:139], a[240:243], v[40:43]
    ds_read_b64_tr_b16 v[152:153], v219 offset:49152
    v_mfma_f32_16x16x32_bf16 v[40:43], v[140:143], a[248:251], v[40:43]
    ds_read_b64_tr_b16 v[154:155], v219 offset:51200
    v_mfma_f32_16x16x32_bf16 v[44:47], v[136:139], a[244:247], v[44:47]
    ds_read_b64_tr_b16 v[156:157], v219 offset:57344
    v_cvt_pk_bf16_f32 v68, v72, v73
    v_mfma_f32_16x16x32_bf16 v[44:47], v[140:143], a[252:255], v[44:47]
    ds_read_b64_tr_b16 v[158:159], v219 offset:59392
    v_cvt_pk_bf16_f32 v69, v74, v75
    s_waitcnt lgkmcnt(4)
    v_mfma_f32_16x16x32_bf16 v[48:51], v[144:147], a[240:243], v[48:51]
    v_xor_b32 v216, 0x10000, v216
    ds_read_b64_tr_b16 v[128:129], v216 offset:0
    v_cvt_pk_bf16_f32 v70, v76, v77
    v_mfma_f32_16x16x32_bf16 v[48:51], v[148:151], a[248:251], v[48:51]
    ds_read_b64_tr_b16 v[130:131], v216 offset:2048
    v_cvt_pk_bf16_f32 v71, v78, v79
    v_mfma_f32_16x16x32_bf16 v[52:55], v[144:147], a[244:247], v[52:55]
    ds_read_b64_tr_b16 v[132:133], v216 offset:8192
    v_min_u32_e64 v68, -2, v68
    v_mfma_f32_16x16x32_bf16 v[52:55], v[148:151], a[252:255], v[52:55]
    ds_read_b64_tr_b16 v[134:135], v216 offset:10240
    v_min_u32 v69, -2, v69
    s_waitcnt lgkmcnt(4)
    v_mfma_f32_16x16x32_bf16 v[56:59], v[152:155], a[240:243], v[56:59]
    v_xor_b32 v217, 0x10000, v217
    ds_read_b64_tr_b16 v[136:137], v217 offset:0
    v_min_u32_e64 v70, -2, v70
    v_mfma_f32_16x16x32_bf16 v[56:59], v[156:159], a[248:251], v[56:59]
    ds_read_b64_tr_b16 v[138:139], v217 offset:2048
    v_min_u32_e64 v71, -2, v71
    v_mfma_f32_16x16x32_bf16 v[60:63], v[152:155], a[244:247], v[60:63]
    ds_read_b64_tr_b16 v[140:141], v217 offset:8192
    buffer_store_dwordx4 v[68:71], v228, s[8:11], s33 offen offset:1024 sc1
    v_mfma_f32_16x16x32_bf16 v[60:63], v[156:159], a[252:255], v[60:63]
    ds_read_b64_tr_b16 v[142:143], v217 offset:10240
    s_waitcnt lgkmcnt(4)
    v_mfma_f32_16x16x32_bf16 v[32:35], v[128:131], a[0:3], v[32:35]
    v_xor_b32 v218, 0x10000, v218
    ds_read_b64_tr_b16 v[144:145], v218 offset:0
    v_mfma_f32_16x16x32_bf16 v[32:35], v[132:135], a[16:19], v[32:35]
    ds_read_b64_tr_b16 v[146:147], v218 offset:2048
    v_mfma_f32_16x16x32_bf16 v[36:39], v[128:131], a[4:7], v[36:39]
    ds_read_b64_tr_b16 v[148:149], v218 offset:8192
    v_cvt_pk_bf16_f32 v72, v80, v81
    v_mfma_f32_16x16x32_bf16 v[36:39], v[132:135], a[20:23], v[36:39]
    ds_read_b64_tr_b16 v[150:151], v218 offset:10240
    v_cvt_pk_bf16_f32 v73, v82, v83
    s_waitcnt lgkmcnt(4)
    v_mfma_f32_16x16x32_bf16 v[40:43], v[136:139], a[0:3], v[40:43]
    v_xor_b32 v219, 0x10000, v219
    ds_read_b64_tr_b16 v[152:153], v219 offset:0
    v_cvt_pk_bf16_f32 v74, v84, v85
    v_mfma_f32_16x16x32_bf16 v[40:43], v[140:143], a[16:19], v[40:43]
    ds_read_b64_tr_b16 v[154:155], v219 offset:2048
    v_cvt_pk_bf16_f32 v75, v86, v87
    v_mfma_f32_16x16x32_bf16 v[44:47], v[136:139], a[4:7], v[44:47]
    ds_read_b64_tr_b16 v[156:157], v219 offset:8192
    v_min_u32_e64 v72, -2, v72
    v_mfma_f32_16x16x32_bf16 v[44:47], v[140:143], a[20:23], v[44:47]
    ds_read_b64_tr_b16 v[158:159], v219 offset:10240
    v_min_u32 v73, -2, v73
    s_waitcnt lgkmcnt(4)
    v_mfma_f32_16x16x32_bf16 v[48:51], v[144:147], a[0:3], v[48:51]
    ds_read_b64_tr_b16 v[128:129], v216 offset:16384
    v_min_u32_e64 v74, -2, v74
    v_mfma_f32_16x16x32_bf16 v[48:51], v[148:151], a[16:19], v[48:51]
    ds_read_b64_tr_b16 v[130:131], v216 offset:18432
    v_min_u32_e64 v75, -2, v75
    v_mfma_f32_16x16x32_bf16 v[52:55], v[144:147], a[4:7], v[52:55]
    ds_read_b64_tr_b16 v[132:133], v216 offset:24576
    buffer_store_dwordx4 v[72:75], v228, s[8:11], s33 offen offset:2048 sc1
    v_mfma_f32_16x16x32_bf16 v[52:55], v[148:151], a[20:23], v[52:55]
    ds_read_b64_tr_b16 v[134:135], v216 offset:26624
    s_waitcnt lgkmcnt(4)
    v_mfma_f32_16x16x32_bf16 v[56:59], v[152:155], a[0:3], v[56:59]
    ds_read_b64_tr_b16 v[136:137], v217 offset:16384
    v_mfma_f32_16x16x32_bf16 v[56:59], v[156:159], a[16:19], v[56:59]
    ds_read_b64_tr_b16 v[138:139], v217 offset:18432
    v_mfma_f32_16x16x32_bf16 v[60:63], v[152:155], a[4:7], v[60:63]
    ds_read_b64_tr_b16 v[140:141], v217 offset:24576
    v_cvt_pk_bf16_f32 v76, v88, v89
    v_mfma_f32_16x16x32_bf16 v[60:63], v[156:159], a[20:23], v[60:63]
    ds_read_b64_tr_b16 v[142:143], v217 offset:26624
    v_cvt_pk_bf16_f32 v77, v90, v91
    s_waitcnt lgkmcnt(4)
    v_mfma_f32_16x16x32_bf16 v[32:35], v[128:131], a[32:35], v[32:35]
    ds_read_b64_tr_b16 v[144:145], v218 offset:16384
    v_cvt_pk_bf16_f32 v78, v92, v93
    v_mfma_f32_16x16x32_bf16 v[32:35], v[132:135], a[48:51], v[32:35]
    ds_read_b64_tr_b16 v[146:147], v218 offset:18432
    v_cvt_pk_bf16_f32 v79, v94, v95
    v_mfma_f32_16x16x32_bf16 v[36:39], v[128:131], a[36:39], v[36:39]
    ds_read_b64_tr_b16 v[148:149], v218 offset:24576
    v_min_u32_e64 v76, -2, v76
    v_mfma_f32_16x16x32_bf16 v[36:39], v[132:135], a[52:55], v[36:39]
    ds_read_b64_tr_b16 v[150:151], v218 offset:26624
    v_min_u32 v77, -2, v77
    s_waitcnt lgkmcnt(4)
    v_mfma_f32_16x16x32_bf16 v[40:43], v[136:139], a[32:35], v[40:43]
    ds_read_b64_tr_b16 v[152:153], v219 offset:16384
    v_min_u32_e64 v78, -2, v78
    v_mfma_f32_16x16x32_bf16 v[40:43], v[140:143], a[48:51], v[40:43]
    ds_read_b64_tr_b16 v[154:155], v219 offset:18432
    v_min_u32_e64 v79, -2, v79
    v_mfma_f32_16x16x32_bf16 v[44:47], v[136:139], a[36:39], v[44:47]
    ds_read_b64_tr_b16 v[156:157], v219 offset:24576
    buffer_store_dwordx4 v[76:79], v228, s[8:11], s33 offen offset:3072 sc1
    v_mfma_f32_16x16x32_bf16 v[44:47], v[140:143], a[52:55], v[44:47]
    ds_read_b64_tr_b16 v[158:159], v219 offset:26624
    s_waitcnt lgkmcnt(4)
    v_mfma_f32_16x16x32_bf16 v[48:51], v[144:147], a[32:35], v[48:51]
    ds_read_b64_tr_b16 v[128:129], v216 offset:32768
    v_mfma_f32_16x16x32_bf16 v[48:51], v[148:151], a[48:51], v[48:51]
    ds_read_b64_tr_b16 v[130:131], v216 offset:34816
    v_mfma_f32_16x16x32_bf16 v[52:55], v[144:147], a[36:39], v[52:55]
    ds_read_b64_tr_b16 v[132:133], v216 offset:40960
    v_mfma_f32_16x16x32_bf16 v[52:55], v[148:151], a[52:55], v[52:55]
    ds_read_b64_tr_b16 v[134:135], v216 offset:43008
    s_waitcnt lgkmcnt(4)
    v_mfma_f32_16x16x32_bf16 v[56:59], v[152:155], a[32:35], v[56:59]
    ds_read_b64_tr_b16 v[136:137], v217 offset:32768
    v_mfma_f32_16x16x32_bf16 v[56:59], v[156:159], a[48:51], v[56:59]
    ds_read_b64_tr_b16 v[138:139], v217 offset:34816
    v_mfma_f32_16x16x32_bf16 v[60:63], v[152:155], a[36:39], v[60:63]
    ds_read_b64_tr_b16 v[140:141], v217 offset:40960
    v_mfma_f32_16x16x32_bf16 v[60:63], v[156:159], a[52:55], v[60:63]
    ds_read_b64_tr_b16 v[142:143], v217 offset:43008
    s_waitcnt lgkmcnt(4)
    v_mfma_f32_16x16x32_bf16 v[32:35], v[128:131], a[64:67], v[32:35]
    ds_read_b64_tr_b16 v[144:145], v218 offset:32768
    v_mfma_f32_16x16x32_bf16 v[32:35], v[132:135], a[80:83], v[32:35]
    ds_read_b64_tr_b16 v[146:147], v218 offset:34816
    v_mfma_f32_16x16x32_bf16 v[36:39], v[128:131], a[68:71], v[36:39]
    ds_read_b64_tr_b16 v[148:149], v218 offset:40960
    v_mfma_f32_16x16x32_bf16 v[36:39], v[132:135], a[84:87], v[36:39]
    ds_read_b64_tr_b16 v[150:151], v218 offset:43008
    s_waitcnt lgkmcnt(4)
    v_mfma_f32_16x16x32_bf16 v[40:43], v[136:139], a[64:67], v[40:43]
    ds_read_b64_tr_b16 v[152:153], v219 offset:32768
    v_mfma_f32_16x16x32_bf16 v[40:43], v[140:143], a[80:83], v[40:43]
    ds_read_b64_tr_b16 v[154:155], v219 offset:34816
    v_mfma_f32_16x16x32_bf16 v[44:47], v[136:139], a[68:71], v[44:47]
    ds_read_b64_tr_b16 v[156:157], v219 offset:40960
    v_mfma_f32_16x16x32_bf16 v[44:47], v[140:143], a[84:87], v[44:47]
    ds_read_b64_tr_b16 v[158:159], v219 offset:43008
    s_waitcnt lgkmcnt(4)
    v_mfma_f32_16x16x32_bf16 v[48:51], v[144:147], a[64:67], v[48:51]
    ds_read_b64_tr_b16 v[128:129], v216 offset:49152
    v_mfma_f32_16x16x32_bf16 v[48:51], v[148:151], a[80:83], v[48:51]
    ds_read_b64_tr_b16 v[130:131], v216 offset:51200
    v_mfma_f32_16x16x32_bf16 v[52:55], v[144:147], a[68:71], v[52:55]
    ds_read_b64_tr_b16 v[132:133], v216 offset:57344
    v_mfma_f32_16x16x32_bf16 v[52:55], v[148:151], a[84:87], v[52:55]
    ds_read_b64_tr_b16 v[134:135], v216 offset:59392
    s_waitcnt lgkmcnt(4)
    v_mfma_f32_16x16x32_bf16 v[56:59], v[152:155], a[64:67], v[56:59]
    ds_read_b64_tr_b16 v[136:137], v217 offset:49152
    v_mfma_f32_16x16x32_bf16 v[56:59], v[156:159], a[80:83], v[56:59]
    ds_read_b64_tr_b16 v[138:139], v217 offset:51200
    v_mfma_f32_16x16x32_bf16 v[60:63], v[152:155], a[68:71], v[60:63]
    ds_read_b64_tr_b16 v[140:141], v217 offset:57344
    v_mfma_f32_16x16x32_bf16 v[60:63], v[156:159], a[84:87], v[60:63]
    ds_read_b64_tr_b16 v[142:143], v217 offset:59392
    s_waitcnt lgkmcnt(4)
    v_mfma_f32_16x16x32_bf16 v[32:35], v[128:131], a[96:99], v[32:35]
    ds_read_b64_tr_b16 v[144:145], v218 offset:49152
    v_mfma_f32_16x16x32_bf16 v[32:35], v[132:135], a[112:115], v[32:35]
    ds_read_b64_tr_b16 v[146:147], v218 offset:51200
    v_mfma_f32_16x16x32_bf16 v[36:39], v[128:131], a[100:103], v[36:39]
    ds_read_b64_tr_b16 v[148:149], v218 offset:57344
    v_mfma_f32_16x16x32_bf16 v[36:39], v[132:135], a[116:119], v[36:39]
    ds_read_b64_tr_b16 v[150:151], v218 offset:59392
    s_waitcnt lgkmcnt(4)
    v_mfma_f32_16x16x32_bf16 v[40:43], v[136:139], a[96:99], v[40:43]
    ds_read_b64_tr_b16 v[152:153], v219 offset:49152
    v_mfma_f32_16x16x32_bf16 v[40:43], v[140:143], a[112:115], v[40:43]
    ds_read_b64_tr_b16 v[154:155], v219 offset:51200
    v_mfma_f32_16x16x32_bf16 v[44:47], v[136:139], a[100:103], v[44:47]
    ds_read_b64_tr_b16 v[156:157], v219 offset:57344
    v_mfma_f32_16x16x32_bf16 v[44:47], v[140:143], a[116:119], v[44:47]
    ds_read_b64_tr_b16 v[158:159], v219 offset:59392
    s_waitcnt lgkmcnt(4)
    v_mfma_f32_16x16x32_bf16 v[48:51], v[144:147], a[96:99], v[48:51]
    buffer_load_dwordx4 v[96:99], v228, s[8:11], s37 offen offset:0 sc1
    v_mfma_f32_16x16x32_bf16 v[48:51], v[148:151], a[112:115], v[48:51]
    v_mfma_f32_16x16x32_bf16 v[52:55], v[144:147], a[100:103], v[52:55]
    buffer_load_dwordx4 v[100:103], v228, s[8:11], s37 offen offset:1024 sc1
    v_mfma_f32_16x16x32_bf16 v[52:55], v[148:151], a[116:119], v[52:55]
    s_waitcnt lgkmcnt(0)
    v_mfma_f32_16x16x32_bf16 v[56:59], v[152:155], a[96:99], v[56:59]
    buffer_load_dwordx4 v[104:107], v228, s[8:11], s37 offen offset:2048 sc1
    v_mfma_f32_16x16x32_bf16 v[56:59], v[156:159], a[112:115], v[56:59]
    v_mfma_f32_16x16x32_bf16 v[60:63], v[152:155], a[100:103], v[60:63]
    buffer_load_dwordx4 v[108:111], v228, s[8:11], s37 offen offset:3072 sc1
    v_mfma_f32_16x16x32_bf16 v[60:63], v[156:159], a[116:119], v[60:63]
kc_tail:
    buffer_load_dwordx4 v[160:163], v228, s[8:11], s38 offen offset:0 sc1
    buffer_load_dwordx4 v[164:167], v228, s[8:11], s38 offen offset:1024 sc1
    buffer_load_dwordx4 v[168:171], v228, s[8:11], s38 offen offset:2048 sc1
    buffer_load_dwordx4 v[172:175], v228, s[8:11], s38 offen offset:3072 sc1
    v_lshlrev_b32_e64 v128, 16, v192
    v_and_b32 v129, 0xffff0000, v192
    v_lshlrev_b32_e64 v130, 16, v193
    v_and_b32 v131, 0xffff0000, v193
    v_lshlrev_b32_e64 v132, 16, v194
    v_and_b32 v133, 0xffff0000, v194
    v_lshlrev_b32_e64 v134, 16, v195
    v_and_b32 v135, 0xffff0000, v195
    v_lshlrev_b32_e64 v136, 16, v196
    v_and_b32 v137, 0xffff0000, v196
    v_lshlrev_b32_e64 v138, 16, v197
    v_and_b32 v139, 0xffff0000, v197
    v_lshlrev_b32_e64 v140, 16, v198
    v_and_b32 v141, 0xffff0000, v198
    v_lshlrev_b32_e64 v142, 16, v199
    v_and_b32 v143, 0xffff0000, v199
    v_lshlrev_b32_e64 v144, 16, v200
    v_and_b32 v145, 0xffff0000, v200
    v_lshlrev_b32_e64 v146, 16, v201
    v_and_b32 v147, 0xffff0000, v201
    v_lshlrev_b32_e64 v148, 16, v202
    v_and_b32 v149, 0xffff0000, v202
    v_lshlrev_b32_e64 v150, 16, v203
    v_and_b32 v151, 0xffff0000, v203
    v_lshlrev_b32_e64 v152, 16, v204
    v_and_b32 v153, 0xffff0000, v204
    v_lshlrev_b32_e64 v154, 16, v205
    v_and_b32 v155, 0xffff0000, v205
    v_lshlrev_b32_e64 v156, 16, v206
    v_and_b32 v157, 0xffff0000, v206
    v_lshlrev_b32_e64 v158, 16, v207
    v_and_b32 v159, 0xffff0000, v207
    v_lshlrev_b32_e64 v112, 16, v208
    v_and_b32 v113, 0xffff0000, v208
    v_lshlrev_b32_e64 v114, 16, v209
    v_and_b32 v115, 0xffff0000, v209
    v_lshlrev_b32_e64 v116, 16, v210
    v_and_b32 v117, 0xffff0000, v210
    v_lshlrev_b32_e64 v118, 16, v211
    v_and_b32 v119, 0xffff0000, v211
    v_pk_add_f32 v[120:121], v[112:113], v[114:115]
    v_pk_add_f32 v[122:123], v[116:117], v[118:119]
    v_pk_add_f32 v[120:121], v[120:121], v[122:123]
    v_add_f32_e64 v196, v120, v121
    s_barrier
    s_waitcnt vmcnt(12)
    v_max3_u32 v235, v176, v177, v178
    v_max3_u32 v235, v235, v179, v180
    v_max3_u32 v235, v235, v181, v182
    v_max3_u32 v235, v235, v183, v184
    v_max3_u32 v235, v235, v185, v186
    v_max3_u32 v235, v235, v187, v188
    v_max3_u32 v235, v235, v189, v190
    v_max_u32 v235, v235, v191
    v_cmp_eq_u32 vcc, -1, v235
    s_cbranch_vccnz kc_r3
kc_r3o:
    v_lshlrev_b32 v64, 16, v176
    v_and_b32 v65, 0xffff0000, v176
    v_lshlrev_b32_e64 v66, 16, v177
    v_and_b32 v67, 0xffff0000, v177
    v_pk_add_f32 v[32:33], v[32:33], v[64:65]
    v_pk_add_f32 v[34:35], v[34:35], v[66:67]
    v_lshlrev_b32_e64 v68, 16, v178
    v_and_b32 v69, 0xffff0000, v178
    v_lshlrev_b32_e64 v70, 16, v179
    v_and_b32 v71, 0xffff0000, v179
    v_pk_add_f32 v[36:37], v[36:37], v[68:69]
    v_pk_add_f32 v[38:39], v[38:39], v[70:71]
    v_lshlrev_b32_e64 v72, 16, v180
    v_and_b32 v73, 0xffff0000, v180
    v_lshlrev_b32_e64 v74, 16, v181
    v_and_b32 v75, 0xffff0000, v181
    v_pk_add_f32 v[40:41], v[40:41], v[72:73]
    v_pk_add_f32 v[42:43], v[42:43], v[74:75]
    v_lshlrev_b32_e64 v76, 16, v182
    v_and_b32 v77, 0xffff0000, v182
    v_lshlrev_b32_e64 v78, 16, v183
    v_and_b32 v79, 0xffff0000, v183
    v_pk_add_f32 v[44:45], v[44:45], v[76:77]
    v_pk_add_f32 v[46:47], v[46:47], v[78:79]
    v_lshlrev_b32_e64 v80, 16, v184
    v_and_b32 v81, 0xffff0000, v184
    v_lshlrev_b32_e64 v82, 16, v185
    v_and_b32 v83, 0xffff0000, v185
    v_pk_add_f32 v[48:49], v[48:49], v[80:81]
    v_pk_add_f32 v[50:51], v[50:51], v[82:83]
    v_lshlrev_b32_e64 v84, 16, v186
    v_and_b32 v85, 0xffff0000, v186
    v_lshlrev_b32_e64 v86, 16, v187
    v_and_b32 v87, 0xffff0000, v187
    v_pk_add_f32 v[52:53], v[52:53], v[84:85]
    v_pk_add_f32 v[54:55], v[54:55], v[86:87]
    v_lshlrev_b32_e64 v88, 16, v188
    v_and_b32 v89, 0xffff0000, v188
    v_lshlrev_b32_e64 v90, 16, v189
    v_and_b32 v91, 0xffff0000, v189
    v_pk_add_f32 v[56:57], v[56:57], v[88:89]
    v_pk_add_f32 v[58:59], v[58:59], v[90:91]
    v_lshlrev_b32_e64 v92, 16, v190
    v_and_b32 v93, 0xffff0000, v190
    v_lshlrev_b32_e64 v94, 16, v191
    v_and_b32 v95, 0xffff0000, v191
    v_pk_add_f32 v[60:61], v[60:61], v[92:93]
    v_pk_add_f32 v[62:63], v[62:63], v[94:95]
    s_waitcnt vmcnt(4)
    v_max3_u32 v235, v96, v97, v98
    v_max3_u32 v235, v235, v99, v100
    v_max3_u32 v235, v235, v101, v102
    v_max3_u32 v235, v235, v103, v104
    v_max3_u32 v235, v235, v105, v106
    v_max3_u32 v235, v235, v107, v108
    v_max3_u32 v235, v235, v109, v110
    v_max_u32 v235, v235, v111
    v_cmp_eq_u32 vcc, -1, v235
    s_cbranch_vccnz kc_r1
kc_r1o:
    v_lshlrev_b32_e64 v64, 16, v96
    v_and_b32 v65, 0xffff0000, v96
    v_lshlrev_b32_e64 v66, 16, v97
    v_and_b32 v67, 0xffff0000, v97
    v_pk_add_f32 v[32:33], v[32:33], v[64:65]
    v_pk_add_f32 v[34:35], v[34:35], v[66:67]
    v_lshlrev_b32_e64 v68, 16, v98
    v_and_b32 v69, 0xffff0000, v98
    v_lshlrev_b32_e64 v70, 16, v99
    v_and_b32 v71, 0xffff0000, v99
    v_pk_add_f32 v[36:37], v[36:37], v[68:69]
    v_pk_add_f32 v[38:39], v[38:39], v[70:71]
    v_lshlrev_b32_e64 v72, 16, v100
    v_and_b32 v73, 0xffff0000, v100
    v_lshlrev_b32_e64 v74, 16, v101
    v_and_b32 v75, 0xffff0000, v101
    v_pk_add_f32 v[40:41], v[40:41], v[72:73]
    v_pk_add_f32 v[42:43], v[42:43], v[74:75]
    v_lshlrev_b32_e64 v76, 16, v102
    v_and_b32 v77, 0xffff0000, v102
    v_lshlrev_b32_e64 v78, 16, v103
    v_and_b32 v79, 0xffff0000, v103
    v_pk_add_f32 v[44:45], v[44:45], v[76:77]
    v_pk_add_f32 v[46:47], v[46:47], v[78:79]
    v_lshlrev_b32_e64 v80, 16, v104
    v_and_b32 v81, 0xffff0000, v104
    v_lshlrev_b32_e64 v82, 16, v105
    v_and_b32 v83, 0xffff0000, v105
    v_pk_add_f32 v[48:49], v[48:49], v[80:81]
    v_pk_add_f32 v[50:51], v[50:51], v[82:83]
    v_lshlrev_b32_e64 v84, 16, v106
    v_and_b32 v85, 0xffff0000, v106
    v_lshlrev_b32_e64 v86, 16, v107
    v_and_b32 v87, 0xffff0000, v107
    v_pk_add_f32 v[52:53], v[52:53], v[84:85]
    v_pk_add_f32 v[54:55], v[54:55], v[86:87]
    v_lshlrev_b32_e64 v88, 16, v108
    v_and_b32 v89, 0xffff0000, v108
    v_lshlrev_b32_e64 v90, 16, v109
    v_and_b32 v91, 0xffff0000, v109
    v_pk_add_f32 v[56:57], v[56:57], v[88:89]
    v_pk_add_f32 v[58:59], v[58:59], v[90:91]
    v_lshlrev_b32_e64 v92, 16, v110
    v_and_b32 v93, 0xffff0000, v110
    v_lshlrev_b32_e64 v94, 16, v111
    v_and_b32 v95, 0xffff0000, v111
    v_pk_add_f32 v[60:61], v[60:61], v[92:93]
    v_pk_add_f32 v[62:63], v[62:63], v[94:95]
    s_waitcnt vmcnt(0)
    v_max3_u32 v235, v160, v161, v162
    v_max3_u32 v235, v235, v163, v164
    v_max3_u32 v235, v235, v165, v166
    v_max3_u32 v235, v235, v167, v168
    v_max3_u32 v235, v235, v169, v170
    v_max3_u32 v235, v235, v171, v172
    v_max3_u32 v235, v235, v173, v174
    v_max_u32 v235, v235, v175
    v_cmp_eq_u32 vcc, -1, v235
    s_cbranch_vccnz kc_r2
kc_r2o:
    v_lshlrev_b32_e64 v64, 16, v160
    v_and_b32 v65, 0xffff0000, v160
    v_lshlrev_b32_e64 v66, 16, v161
    v_and_b32 v67, 0xffff0000, v161
    v_pk_add_f32 v[32:33], v[32:33], v[64:65]
    v_pk_add_f32 v[34:35], v[34:35], v[66:67]
    v_cvt_pk_bf16_f32 v0, v32, v33
    v_cvt_pk_bf16_f32 v1, v34, v35
    ds_write_b64 v238, v[0:1] offset:0
    v_lshlrev_b32_e64 v68, 16, v162
    v_and_b32 v69, 0xffff0000, v162
    v_lshlrev_b32_e64 v70, 16, v163
    v_and_b32 v71, 0xffff0000, v163
    v_pk_add_f32 v[36:37], v[36:37], v[68:69]
    v_pk_add_f32 v[38:39], v[38:39], v[70:71]
    v_cvt_pk_bf16_f32 v2, v36, v37
    v_cvt_pk_bf16_f32 v3, v38, v39
    ds_write_b64 v238, v[2:3] offset:2304
    v_lshlrev_b32_e64 v72, 16, v164
    v_and_b32 v73, 0xffff0000, v164
    v_lshlrev_b32_e64 v74, 16, v165
    v_and_b32 v75, 0xffff0000, v165
    v_pk_add_f32 v[40:41], v[40:41], v[72:73]
    v_pk_add_f32 v[42:43], v[42:43], v[74:75]
    v_cvt_pk_bf16_f32 v4, v40, v41
    v_cvt_pk_bf16_f32 v5, v42, v43
    ds_write_b64 v238, v[4:5] offset:32
    v_lshlrev_b32_e64 v76, 16, v166
    v_and_b32 v77, 0xffff0000, v166
    v_lshlrev_b32_e64 v78, 16, v167
    v_and_b32 v79, 0xffff0000, v167
    v_pk_add_f32 v[44:45], v[44:45], v[76:77]
    v_pk_add_f32 v[46:47], v[46:47], v[78:79]
    v_cvt_pk_bf16_f32 v6, v44, v45
    v_cvt_pk_bf16_f32 v7, v46, v47
    ds_write_b64 v238, v[6:7] offset:2336
    v_lshlrev_b32_e64 v80, 16, v168
    v_and_b32 v81, 0xffff0000, v168
    v_lshlrev_b32_e64 v82, 16, v169
    v_and_b32 v83, 0xffff0000, v169
    v_pk_add_f32 v[48:49], v[48:49], v[80:81]
    v_pk_add_f32 v[50:51], v[50:51], v[82:83]
    v_cvt_pk_bf16_f32 v8, v48, v49
    v_cvt_pk_bf16_f32 v9, v50, v51
    ds_write_b64 v238, v[8:9] offset:64
    v_lshlrev_b32_e64 v84, 16, v170
    v_and_b32 v85, 0xffff0000, v170
    v_lshlrev_b32_e64 v86, 16, v171
    v_and_b32 v87, 0xffff0000, v171
    v_pk_add_f32 v[52:53], v[52:53], v[84:85]
    v_pk_add_f32 v[54:55], v[54:55], v[86:87]
    v_cvt_pk_bf16_f32 v10, v52, v53
    v_cvt_pk_bf16_f32 v11, v54, v55
    ds_write_b64 v238, v[10:11] offset:2368
    v_lshlrev_b32_e64 v88, 16, v172
    v_and_b32 v89, 0xffff0000, v172
    v_lshlrev_b32_e64 v90, 16, v173
    v_and_b32 v91, 0xffff0000, v173
    v_pk_add_f32 v[56:57], v[56:57], v[88:89]
    v_pk_add_f32 v[58:59], v[58:59], v[90:91]
    v_cvt_pk_bf16_f32 v12, v56, v57
    v_cvt_pk_bf16_f32 v13, v58, v59
    ds_write_b64 v238, v[12:13] offset:96
    v_lshlrev_b32_e64 v92, 16, v174
    v_and_b32 v93, 0xffff0000, v174
    v_lshlrev_b32_e64 v94, 16, v175
    v_and_b32 v95, 0xffff0000, v175
    v_pk_add_f32 v[60:61], v[60:61], v[92:93]
    v_pk_add_f32 v[62:63], v[62:63], v[94:95]
    v_cvt_pk_bf16_f32 v14, v60, v61
    v_cvt_pk_bf16_f32 v15, v62, v63
    ds_write_b64 v238, v[14:15] offset:2400
    s_waitcnt lgkmcnt(0)
    ds_read_b128 v[16:19], v239 offset:0
    ds_read_b128 v[20:23], v239 offset:1152
    ds_read_b128 v[24:27], v239 offset:2304
    ds_read_b128 v[28:31], v239 offset:3456
    s_waitcnt lgkmcnt(3)
    v_lshlrev_b32 v64, 16, v16
    v_lshlrev_b32 v66, 16, v17
    v_lshlrev_b32 v68, 16, v18
    v_lshlrev_b32 v70, 16, v19
    v_and_b32 v65, 0xffff0000, v16
    v_and_b32 v67, 0xffff0000, v17
    v_and_b32 v69, 0xffff0000, v18
    v_and_b32 v71, 0xffff0000, v19
    v_pk_add_f32 v[64:65], v[64:65], v[128:129]
    v_pk_add_f32 v[66:67], v[66:67], v[130:131]
    v_pk_add_f32 v[68:69], v[68:69], v[132:133]
    v_pk_add_f32 v[70:71], v[70:71], v[134:135]
    v_cvt_pk_bf16_f32 v16, v64, v65
    v_cvt_pk_bf16_f32 v17, v66, v67
    v_cvt_pk_bf16_f32 v18, v68, v69
    v_cvt_pk_bf16_f32 v19, v70, v71
    v_lshlrev_b32 v64, 16, v16
    v_lshlrev_b32 v66, 16, v17
    v_lshlrev_b32 v68, 16, v18
    v_lshlrev_b32 v70, 16, v19
    v_and_b32 v65, 0xffff0000, v16
    v_and_b32 v67, 0xffff0000, v17
    v_and_b32 v69, 0xffff0000, v18
    v_and_b32 v71, 0xffff0000, v19
    s_mov_b32 s32, 0x3400000
    buffer_store_dwordx4 v[16:19], v229, s[8:11], s32 offen sc1
    v_pk_add_f32 v[160:161], v[64:65], v[66:67]
    v_pk_mul_f32 v[162:163], v[64:65], v[64:65]
    v_pk_mul_f32 v[164:165], v[64:65], v[112:113]
    v_pk_fma_f32 v[162:163], v[66:67], v[66:67], v[162:163]
    v_pk_fma_f32 v[164:165], v[66:67], v[114:115], v[164:165]
    v_pk_add_f32 v[160:161], v[160:161], v[68:69]
    v_pk_fma_f32 v[162:163], v[68:69], v[68:69], v[162:163]
    v_pk_fma_f32 v[164:165], v[68:69], v[116:117], v[164:165]
    v_pk_add_f32 v[160:161], v[160:161], v[70:71]
    v_pk_fma_f32 v[162:163], v[70:71], v[70:71], v[162:163]
    v_pk_fma_f32 v[164:165], v[70:71], v[118:119], v[164:165]
    v_add_f32 v184, v160, v161
    v_add_f32 v185, v162, v163
    v_add_f32 v186, v164, v165
    s_waitcnt lgkmcnt(2)
    v_lshlrev_b32 v72, 16, v20
    v_lshlrev_b32 v74, 16, v21
    v_lshlrev_b32 v76, 16, v22
    v_lshlrev_b32 v78, 16, v23
    v_and_b32 v73, 0xffff0000, v20
    v_and_b32 v75, 0xffff0000, v21
    v_and_b32 v77, 0xffff0000, v22
    v_and_b32 v79, 0xffff0000, v23
    v_pk_add_f32 v[72:73], v[72:73], v[136:137]
    v_pk_add_f32 v[74:75], v[74:75], v[138:139]
    v_pk_add_f32 v[76:77], v[76:77], v[140:141]
    v_pk_add_f32 v[78:79], v[78:79], v[142:143]
    v_cvt_pk_bf16_f32 v20, v72, v73
    v_cvt_pk_bf16_f32 v21, v74, v75
    v_cvt_pk_bf16_f32 v22, v76, v77
    v_cvt_pk_bf16_f32 v23, v78, v79
    v_lshlrev_b32 v72, 16, v20
    v_lshlrev_b32 v74, 16, v21
    v_lshlrev_b32 v76, 16, v22
    v_lshlrev_b32 v78, 16, v23
    v_and_b32 v73, 0xffff0000, v20
    v_and_b32 v75, 0xffff0000, v21
    v_and_b32 v77, 0xffff0000, v22
    v_and_b32 v79, 0xffff0000, v23
    s_mov_b32 s32, 0x3404000
    buffer_store_dwordx4 v[20:23], v229, s[8:11], s32 offen sc1
    v_pk_add_f32 v[166:167], v[72:73], v[74:75]
    v_pk_mul_f32 v[168:169], v[72:73], v[72:73]
    v_pk_mul_f32 v[170:171], v[72:73], v[112:113]
    v_pk_fma_f32 v[168:169], v[74:75], v[74:75], v[168:169]
    v_pk_fma_f32 v[170:171], v[74:75], v[114:115], v[170:171]
    v_pk_add_f32 v[166:167], v[166:167], v[76:77]
    v_pk_fma_f32 v[168:169], v[76:77], v[76:77], v[168:169]
    v_pk_fma_f32 v[170:171], v[76:77], v[116:117], v[170:171]
    v_pk_add_f32 v[166:167], v[166:167], v[78:79]
    v_pk_fma_f32 v[168:169], v[78:79], v[78:79], v[168:169]
    v_pk_fma_f32 v[170:171], v[78:79], v[118:119], v[170:171]
    v_add_f32 v187, v166, v167
    v_add_f32 v188, v168, v169
    v_add_f32 v189, v170, v171
    s_waitcnt lgkmcnt(1)
    v_lshlrev_b32 v80, 16, v24
    v_lshlrev_b32 v82, 16, v25
    v_lshlrev_b32 v84, 16, v26
    v_lshlrev_b32 v86, 16, v27
    v_and_b32 v81, 0xffff0000, v24
    v_and_b32 v83, 0xffff0000, v25
    v_and_b32 v85, 0xffff0000, v26
    v_and_b32 v87, 0xffff0000, v27
    v_pk_add_f32 v[80:81], v[80:81], v[144:145]
    v_pk_add_f32 v[82:83], v[82:83], v[146:147]
    v_pk_add_f32 v[84:85], v[84:85], v[148:149]
    v_pk_add_f32 v[86:87], v[86:87], v[150:151]
    v_cvt_pk_bf16_f32 v24, v80, v81
    v_cvt_pk_bf16_f32 v25, v82, v83
    v_cvt_pk_bf16_f32 v26, v84, v85
    v_cvt_pk_bf16_f32 v27, v86, v87
    v_lshlrev_b32 v80, 16, v24
    v_lshlrev_b32 v82, 16, v25
    v_lshlrev_b32 v84, 16, v26
    v_lshlrev_b32 v86, 16, v27
    v_and_b32 v81, 0xffff0000, v24
    v_and_b32 v83, 0xffff0000, v25
    v_and_b32 v85, 0xffff0000, v26
    v_and_b32 v87, 0xffff0000, v27
    s_mov_b32 s32, 0x3408000
    buffer_store_dwordx4 v[24:27], v229, s[8:11], s32 offen sc1
    v_pk_add_f32 v[172:173], v[80:81], v[82:83]
    v_pk_mul_f32 v[174:175], v[80:81], v[80:81]
    v_pk_mul_f32 v[176:177], v[80:81], v[112:113]
    v_pk_fma_f32 v[174:175], v[82:83], v[82:83], v[174:175]
    v_pk_fma_f32 v[176:177], v[82:83], v[114:115], v[176:177]
    v_pk_add_f32 v[172:173], v[172:173], v[84:85]
    v_pk_fma_f32 v[174:175], v[84:85], v[84:85], v[174:175]
    v_pk_fma_f32 v[176:177], v[84:85], v[116:117], v[176:177]
    v_pk_add_f32 v[172:173], v[172:173], v[86:87]
    v_pk_fma_f32 v[174:175], v[86:87], v[86:87], v[174:175]
    v_pk_fma_f32 v[176:177], v[86:87], v[118:119], v[176:177]
    v_add_f32 v190, v172, v173
    v_add_f32 v191, v174, v175
    v_add_f32 v192, v176, v177
    s_waitcnt lgkmcnt(0)
    v_lshlrev_b32 v88, 16, v28
    v_lshlrev_b32 v90, 16, v29
    v_lshlrev_b32 v92, 16, v30
    v_lshlrev_b32 v94, 16, v31
    v_and_b32 v89, 0xffff0000, v28
    v_and_b32 v91, 0xffff0000, v29
    v_and_b32 v93, 0xffff0000, v30
    v_and_b32 v95, 0xffff0000, v31
    v_pk_add_f32 v[88:89], v[88:89], v[152:153]
    v_pk_add_f32 v[90:91], v[90:91], v[154:155]
    v_pk_add_f32 v[92:93], v[92:93], v[156:157]
    v_pk_add_f32 v[94:95], v[94:95], v[158:159]
    v_cvt_pk_bf16_f32 v28, v88, v89
    v_cvt_pk_bf16_f32 v29, v90, v91
    v_cvt_pk_bf16_f32 v30, v92, v93
    v_cvt_pk_bf16_f32 v31, v94, v95
    v_lshlrev_b32 v88, 16, v28
    v_lshlrev_b32 v90, 16, v29
    v_lshlrev_b32 v92, 16, v30
    v_lshlrev_b32 v94, 16, v31
    v_and_b32 v89, 0xffff0000, v28
    v_and_b32 v91, 0xffff0000, v29
    v_and_b32 v93, 0xffff0000, v30
    v_and_b32 v95, 0xffff0000, v31
    s_mov_b32 s32, 0x340c000
    buffer_store_dwordx4 v[28:31], v229, s[8:11], s32 offen sc1
    v_pk_add_f32 v[178:179], v[88:89], v[90:91]
    v_pk_mul_f32 v[180:181], v[88:89], v[88:89]
    v_pk_mul_f32 v[182:183], v[88:89], v[112:113]
    v_pk_fma_f32 v[180:181], v[90:91], v[90:91], v[180:181]
    v_pk_fma_f32 v[182:183], v[90:91], v[114:115], v[182:183]
    v_pk_add_f32 v[178:179], v[178:179], v[92:93]
    v_pk_fma_f32 v[180:181], v[92:93], v[92:93], v[180:181]
    v_pk_fma_f32 v[182:183], v[92:93], v[116:117], v[182:183]
    v_pk_add_f32 v[178:179], v[178:179], v[94:95]
    v_pk_fma_f32 v[180:181], v[94:95], v[94:95], v[180:181]
    v_pk_fma_f32 v[182:183], v[94:95], v[118:119], v[182:183]
    v_add_f32 v193, v178, v179
    v_add_f32 v194, v180, v181
    v_add_f32_e64 v195, v182, v183
    v_add_f32_dpp v196, v196, v196 quad_perm:[1,0,3,2] row_mask:0xf bank_mask:0xf
    v_add_f32_dpp v184, v184, v184 quad_perm:[1,0,3,2] row_mask:0xf bank_mask:0xf
    v_add_f32_dpp v185, v185, v185 quad_perm:[1,0,3,2] row_mask:0xf bank_mask:0xf
    v_add_f32_dpp v186, v186, v186 quad_perm:[1,0,3,2] row_mask:0xf bank_mask:0xf
    v_add_f32_dpp v187, v187, v187 quad_perm:[1,0,3,2] row_mask:0xf bank_mask:0xf
    v_add_f32_dpp v188, v188, v188 quad_perm:[1,0,3,2] row_mask:0xf bank_mask:0xf
    v_add_f32_dpp v189, v189, v189 quad_perm:[1,0,3,2] row_mask:0xf bank_mask:0xf
    v_add_f32_dpp v190, v190, v190 quad_perm:[1,0,3,2] row_mask:0xf bank_mask:0xf
    v_add_f32_dpp v191, v191, v191 quad_perm:[1,0,3,2] row_mask:0xf bank_mask:0xf
    v_add_f32_dpp v192, v192, v192 quad_perm:[1,0,3,2] row_mask:0xf bank_mask:0xf
    v_add_f32_dpp v193, v193, v193 quad_perm:[1,0,3,2] row_mask:0xf bank_mask:0xf
    v_add_f32_dpp v194, v194, v194 quad_perm:[1,0,3,2] row_mask:0xf bank_mask:0xf
    v_add_f32_dpp v195, v195, v195 quad_perm:[1,0,3,2] row_mask:0xf bank_mask:0xf
    v_add_f32_dpp v196, v196, v196 quad_perm:[2,3,0,1] row_mask:0xf bank_mask:0xf
    v_add_f32_dpp v184, v184, v184 quad_perm:[2,3,0,1] row_mask:0xf bank_mask:0xf
    v_add_f32_dpp v185, v185, v185 quad_perm:[2,3,0,1] row_mask:0xf bank_mask:0xf
    v_add_f32_dpp v186, v186, v186 quad_perm:[2,3,0,1] row_mask:0xf bank_mask:0xf
    v_add_f32_dpp v187, v187, v187 quad_perm:[2,3,0,1] row_mask:0xf bank_mask:0xf
    v_add_f32_dpp v188, v188, v188 quad_perm:[2,3,0,1] row_mask:0xf bank_mask:0xf
    v_add_f32_dpp v189, v189, v189 quad_perm:[2,3,0,1] row_mask:0xf bank_mask:0xf
    v_add_f32_dpp v190, v190, v190 quad_perm:[2,3,0,1] row_mask:0xf bank_mask:0xf
    v_add_f32_dpp v191, v191, v191 quad_perm:[2,3,0,1] row_mask:0xf bank_mask:0xf
    v_add_f32_dpp v192, v192, v192 quad_perm:[2,3,0,1] row_mask:0xf bank_mask:0xf
    v_add_f32_dpp v193, v193, v193 quad_perm:[2,3,0,1] row_mask:0xf bank_mask:0xf
    v_add_f32_dpp v194, v194, v194 quad_perm:[2,3,0,1] row_mask:0xf bank_mask:0xf
    v_add_f32_dpp v195, v195, v195 quad_perm:[2,3,0,1] row_mask:0xf bank_mask:0xf
    v_add_f32_dpp v196, v196, v196 row_half_mirror row_mask:0xf bank_mask:0xf
    v_add_f32_dpp v184, v184, v184 row_half_mirror row_mask:0xf bank_mask:0xf
    v_add_f32_dpp v185, v185, v185 row_half_mirror row_mask:0xf bank_mask:0xf
    v_add_f32_dpp v186, v186, v186 row_half_mirror row_mask:0xf bank_mask:0xf
    v_add_f32_dpp v187, v187, v187 row_half_mirror row_mask:0xf bank_mask:0xf
    v_add_f32_dpp v188, v188, v188 row_half_mirror row_mask:0xf bank_mask:0xf
    v_add_f32_dpp v189, v189, v189 row_half_mirror row_mask:0xf bank_mask:0xf
    v_add_f32_dpp v190, v190, v190 row_half_mirror row_mask:0xf bank_mask:0xf
    v_add_f32_dpp v191, v191, v191 row_half_mirror row_mask:0xf bank_mask:0xf
    v_add_f32_dpp v192, v192, v192 row_half_mirror row_mask:0xf bank_mask:0xf
    v_add_f32_dpp v193, v193, v193 row_half_mirror row_mask:0xf bank_mask:0xf
    v_add_f32_dpp v194, v194, v194 row_half_mirror row_mask:0xf bank_mask:0xf
    v_add_f32_dpp v195, v195, v195 row_half_mirror row_mask:0xf bank_mask:0xf
    v_cndmask_b32 v184, v184, v187, s[60:61]
    v_cndmask_b32 v190, v190, v193, s[60:61]
    v_cndmask_b32 v185, v185, v188, s[60:61]
    v_cndmask_b32 v191, v191, v194, s[60:61]
    v_cndmask_b32 v186, v186, v189, s[60:61]
    v_cndmask_b32 v192, v192, v195, s[60:61]
    v_cndmask_b32 v184, v184, v190, s[62:63]
    v_cndmask_b32 v185, v185, v191, s[62:63]
    v_cndmask_b32 v186, v186, v192, s[62:63]
    v_cndmask_b32 v184, v184, v185, s[40:41]
    v_cndmask_b32 v186, v186, v196, s[40:41]
    buffer_atomic_add_f32 v184, v231, s[8:11], s48 offen
    buffer_atomic_add_f32 v186, v232, s[8:11], s48 offen
    s_lshl_b32 s32, s3, 13
    v_add_u32 v234, s32, v228
    v_add_u32 v235, 65536, v234
    ds_write_b128 v234, a[128:131] offset:0
    ds_write_b128 v234, a[132:135] offset:1024
    ds_write_b128 v234, a[136:139] offset:2048
    ds_write_b128 v234, a[140:143] offset:3072
    ds_write_b128 v234, a[144:147] offset:4096
    ds_write_b128 v234, a[148:151] offset:5120
    ds_write_b128 v234, a[152:155] offset:6144
    ds_write_b128 v234, a[156:159] offset:7168
    s_waitcnt lgkmcnt(4)
    ds_write_b128 v234, a[160:163] offset:32768
    ds_write_b128 v234, a[164:167] offset:33792
    ds_write_b128 v234, a[168:171] offset:34816
    ds_write_b128 v234, a[172:175] offset:35840
    ds_write_b128 v234, a[176:179] offset:36864
    ds_write_b128 v234, a[180:183] offset:37888
    ds_write_b128 v234, a[184:187] offset:38912
    ds_write_b128 v234, a[188:191] offset:39936
    s_waitcnt lgkmcnt(4)
    ds_write_b128 v235, a[192:195] offset:0
    ds_write_b128 v235, a[196:199] offset:1024
    ds_write_b128 v235, a[200:203] offset:2048
    ds_write_b128 v235, a[204:207] offset:3072
    ds_write_b128 v235, a[208:211] offset:4096
    ds_write_b128 v235, a[212:215] offset:5120
    ds_write_b128 v235, a[216:219] offset:6144
    ds_write_b128 v235, a[220:223] offset:7168
    s_waitcnt lgkmcnt(4)
    s_lshl_b32 s35, s3, 13
    v_bfe_u32 v234, v237, 2, 3
    v_lshrrev_b32_e64 v235, 5, v237
    v_lshl_add_u32 v234, v235, 4, v234
    v_lshlrev_b32 v234, 5, v234
    v_and_b32 v236, 3, v237
    v_lshl_add_u32 v234, v236, 3, v234
    v_add_u32 v217, s35, v234
    v_lshlrev_b32 v235, 5, v235
    v_bfe_u32 v236, v237, 4, 1
    v_lshl_add_u32 v235, v236, 3, v235
    v_and_b32_e64 v236, 1, v237
    v_lshl_add_u32 v235, v236, 11, v235
    s_lshl_b32 s32, s3, 9
    s_add_u32 s32, s32, 98304
    v_add_u32 v218, s32, v235
    v_lshlrev_b32_e64 v234, 4, v230
    v_add_u32 v220, 106752, v234
    v_add_u32 v221, 106752, v228
    v_lshrrev_b32 v236, 2, v237
    v_lshlrev_b32 v236, 7, v236
    v_and_b32_e64 v234, 3, v237
    v_lshl_add_u32 v236, v234, 3, v236
    s_add_u32 s32, s35, 65536
    v_add_u32 v219, s32, v236
    s_lshl_b32 s32, s3, 12
    s_add_u32 s32, s32, 114944
    v_and_b32 v234, 15, v237
    v_min_u32 v234, 2, v234
    v_lshlrev_b32 v234, 10, v234
    v_lshrrev_b32 v235, 4, v237
    v_lshl_add_u32 v234, v235, 4, v234
    v_add_u32 v222, s32, v234
    v_add_u32 v223, s32, v228
    s_mov_b32 s12, 0x00030003
    s_mov_b32 s13, 0x00030003
    s_lshl_b64 s[14:15], s[12:13], 2
    s_lshl_b64 s[16:17], s[12:13], 4
    s_lshl_b64 s[18:19], s[12:13], 6
    s_lshl_b64 s[20:21], s[12:13], 8
    s_lshl_b64 s[22:23], s[12:13], 10
    s_lshl_b64 s[24:25], s[12:13], 12
    s_lshl_b64 s[26:27], s[12:13], 14
    v_and_b32 v234, 1, v237
    v_lshlrev_b32_e64 v234, 12, v234
    v_bfe_u32 v235, v237, 1, 3
    v_lshl_add_u32 v234, v235, 6, v234
    v_lshrrev_b32_e64 v235, 4, v237
    v_lshl_add_u32 v222, v235, 4, v234
    s_lshl_b32 s38, s54, 13
    s_lshl_b32 s33, s3, 10
    s_add_u32 s38, s38, s33
    s_add_u32 s38, s38, 0x3900000
    s_waitcnt vmcnt(0)
    s_barrier
    s_cmp_lg_u32 s3, 0
    s_cbranch_scc1 kc_a1
    s_lshl_b32 s32, s52, 7
    s_add_u32 s32, s32, 0x38a0000
    v_mov_b32_e64 v235, 1
    buffer_atomic_add v235, v243, s[8:11], s32 offen sc0 sc1
    v_lshlrev_b32 v234, 7, v237
    v_cmp_gt_u32 vcc, 8, v237
    v_mov_b32_e64 v236, 0x40000000
    s_mov_b32 s34, 0x38a0400
    v_cndmask_b32 v234, v236, v234, vcc
    s_waitcnt vmcnt(0)
    v_readfirstlane_b32 s36, v235
    s_cmp_lg_u32 s36, 31
    s_cbranch_scc1 kc_a1
    buffer_atomic_add v233, v234, s[8:11], s34 offen sc1
kc_a1:
    s_waitcnt lgkmcnt(0)
    ds_read_b64_tr_b16 a[0:1], v217 offset:0
    ds_read_b64_tr_b16 a[2:3], v217 offset:256
    ds_read_b64_tr_b16 a[32:33], v217 offset:32768
    ds_read_b64_tr_b16 a[34:35], v217 offset:33024
    ds_read_b64_tr_b16 a[4:5], v217 offset:1024
    ds_read_b64_tr_b16 a[6:7], v217 offset:1280
    ds_read_b64_tr_b16 a[36:37], v217 offset:33792
    ds_read_b64_tr_b16 a[38:39], v217 offset:34048
    s_waitcnt lgkmcnt(6)
    ds_read_b64_tr_b16 a[8:9], v217 offset:2048
    ds_read_b64_tr_b16 a[10:11], v217 offset:2304
    ds_read_b64_tr_b16 a[40:41], v217 offset:34816
    ds_read_b64_tr_b16 a[42:43], v217 offset:35072
    ds_read_b64_tr_b16 a[12:13], v217 offset:3072
    ds_read_b64_tr_b16 a[14:15], v217 offset:3328
    ds_read_b64_tr_b16 a[44:45], v217 offset:35840
    ds_read_b64_tr_b16 a[46:47], v217 offset:36096
    s_waitcnt lgkmcnt(6)
    ds_read_b64_tr_b16 a[16:17], v217 offset:4096
    ds_read_b64_tr_b16 a[18:19], v217 offset:4352
    ds_read_b64_tr_b16 a[48:49], v217 offset:36864
    ds_read_b64_tr_b16 a[50:51], v217 offset:37120
    ds_read_b64_tr_b16 a[20:21], v217 offset:5120
    ds_read_b64_tr_b16 a[22:23], v217 offset:5376
    ds_read_b64_tr_b16 a[52:53], v217 offset:37888
    ds_read_b64_tr_b16 a[54:55], v217 offset:38144
    s_waitcnt lgkmcnt(6)
    ds_read_b64_tr_b16 a[24:25], v217 offset:6144
    ds_read_b64_tr_b16 a[26:27], v217 offset:6400
    ds_read_b64_tr_b16 a[56:57], v217 offset:38912
    ds_read_b64_tr_b16 a[58:59], v217 offset:39168
    ds_read_b64_tr_b16 a[28:29], v217 offset:7168
    ds_read_b64_tr_b16 a[30:31], v217 offset:7424
    ds_read_b64_tr_b16 a[60:61], v217 offset:39936
    ds_read_b64_tr_b16 a[62:63], v217 offset:40192
    s_waitcnt lgkmcnt(6)
    ds_read_b64_tr_b16 a[64:65], v219 offset:0
    ds_read_b64_tr_b16 a[66:67], v219 offset:32
    ds_read_b64_tr_b16 a[68:69], v219 offset:64
    ds_read_b64_tr_b16 a[70:71], v219 offset:96
    ds_read_b64_tr_b16 a[72:73], v219 offset:2048
    ds_read_b64_tr_b16 a[74:75], v219 offset:2080
    ds_read_b64_tr_b16 a[76:77], v219 offset:2112
    ds_read_b64_tr_b16 a[78:79], v219 offset:2144
    s_waitcnt lgkmcnt(6)
    ds_read_b64_tr_b16 a[80:81], v219 offset:4096
    ds_read_b64_tr_b16 a[82:83], v219 offset:4128
    ds_read_b64_tr_b16 a[84:85], v219 offset:4160
    ds_read_b64_tr_b16 a[86:87], v219 offset:4192
    ds_read_b64_tr_b16 a[88:89], v219 offset:6144
    ds_read_b64_tr_b16 a[90:91], v219 offset:6176
    ds_read_b64_tr_b16 a[92:93], v219 offset:6208
    ds_read_b64_tr_b16 a[94:95], v219 offset:6240
    s_waitcnt lgkmcnt(6)
    v_mov_b32 v130, 0x3a800000
    v_mov_b32 v131, 0x3a800000
    v_mov_b32 v132, 0x3727c5ac
    v_mov_b32 v133, 0x3727c5ac
    s_mov_b32 s33, 0xfffff800
    s_lshl_b32 s39, s3, 11
    v_add_u32 v238, s39, v228
    v_lshlrev_b32 v239, 2, v242
    s_lshl_b32 s39, s3, 3
    s_add_u32 s7, s39, 106512
    v_lshlrev_b32 v141, 5, v237
    v_or_b32_e64 v141, s39, v141
    s_cmp_lg_u32 s3, 0
    s_cbranch_scc1 kc_b12
    s_lshl_b32 s32, s52, 7
    s_add_u32 s32, s32, 0x38a0400
    s_mov_b32 s34, 0x400000
    s_branch kc_b11
kc_b10:
    s_sleep 2
kc_b11:
    buffer_load_dword v235, off, s[8:11], s32 sc1
    s_waitcnt vmcnt(0)
    v_cmp_ne_u32 vcc, 8, v235
    s_sub_u32 s34, s34, 1
    s_cbranch_scc1 kc_b12
    s_cbranch_vccnz kc_b10
kc_b12:
    s_barrier
    s_add_u32 s32, s48, 24576
    buffer_load_dword v128, off, s[8:11], s32 sc1
    buffer_load_dwordx4 v[32:35], v238, s[8:11], s48 offen offset:0 sc1
    buffer_load_dwordx4 v[40:43], v238, s[8:11], s49 offen offset:0 sc1
    buffer_load_dwordx4 v[48:51], v238, s[8:11], s50 offen offset:0 sc1
    buffer_load_dwordx4 v[36:39], v238, s[8:11], s48 offen offset:1024 sc1
    buffer_load_dwordx4 v[44:47], v238, s[8:11], s49 offen offset:1024 sc1
    buffer_load_dwordx4 v[52:55], v238, s[8:11], s50 offen offset:1024 sc1
    buffer_load_dword v0, v239, s[8:11], s48 offen offset:0 sc1
    buffer_load_dword v4, v239, s[8:11], s49 offen offset:0 sc1
    buffer_load_dword v1, v239, s[8:11], s48 offen offset:32 sc1
    buffer_load_dword v5, v239, s[8:11], s49 offen offset:32 sc1
    buffer_load_dword v2, v239, s[8:11], s48 offen offset:64 sc1
    buffer_load_dword v6, v239, s[8:11], s49 offen offset:64 sc1
    buffer_load_dword v3, v239, s[8:11], s48 offen offset:96 sc1
    buffer_load_dword v7, v239, s[8:11], s49 offen offset:96 sc1
    s_waitcnt vmcnt(8)
    v_mov_b32 v129, v128
    v_pk_mul_f32 v[32:33], v[32:33], v[130:131]
    v_pk_mul_f32 v[34:35], v[34:35], v[130:131]
    v_pk_mul_f32 v[36:37], v[36:37], v[130:131]
    v_pk_mul_f32 v[38:39], v[38:39], v[130:131]
    v_pk_fma_f32 v[40:41], v[40:41], v[130:131], v[132:133]
    v_pk_fma_f32 v[42:43], v[42:43], v[130:131], v[132:133]
    v_pk_fma_f32 v[44:45], v[44:45], v[130:131], v[132:133]
    v_pk_fma_f32 v[46:47], v[46:47], v[130:131], v[132:133]
    v_pk_fma_f32 v[40:41], v[32:33], v[32:33], v[40:41] neg_lo:[1,0,0] neg_hi:[1,0,0]
    v_pk_fma_f32 v[42:43], v[34:35], v[34:35], v[42:43] neg_lo:[1,0,0] neg_hi:[1,0,0]
    v_pk_fma_f32 v[44:45], v[36:37], v[36:37], v[44:45] neg_lo:[1,0,0] neg_hi:[1,0,0]
    v_pk_fma_f32 v[46:47], v[38:39], v[38:39], v[46:47] neg_lo:[1,0,0] neg_hi:[1,0,0]
    v_pk_fma_f32 v[48:49], v[32:33], v[128:129], v[48:49] neg_lo:[1,0,0] neg_hi:[1,0,0]
    v_pk_fma_f32 v[50:51], v[34:35], v[128:129], v[50:51] neg_lo:[1,0,0] neg_hi:[1,0,0]
    v_pk_fma_f32 v[52:53], v[36:37], v[128:129], v[52:53] neg_lo:[1,0,0] neg_hi:[1,0,0]
    v_pk_fma_f32 v[54:55], v[38:39], v[128:129], v[54:55] neg_lo:[1,0,0] neg_hi:[1,0,0]
    v_max_f32 v40, v40, v132
    v_max_f32 v42, v42, v132
    v_max_f32 v44, v44, v132
    v_max_f32 v46, v46, v132
    v_max_f32 v41, v41, v132
    v_max_f32 v43, v43, v132
    v_max_f32 v45, v45, v132
    v_max_f32 v47, v47, v132
    v_rsq_f32 v40, v40
    v_rsq_f32 v42, v42
    v_rsq_f32 v44, v44
    v_rsq_f32 v46, v46
    v_rsq_f32 v41, v41
    v_rsq_f32 v43, v43
    v_rsq_f32 v45, v45
    v_rsq_f32 v47, v47
    v_pk_mul_f32 v[48:49], v[48:49], v[40:41]
    v_pk_mul_f32 v[50:51], v[50:51], v[42:43]
    v_pk_mul_f32 v[52:53], v[52:53], v[44:45]
    v_pk_mul_f32 v[54:55], v[54:55], v[46:47]
    v_and_or_b32 v48, v48, s33, 0
    v_and_or_b32 v50, v50, s33, 2
    v_and_or_b32 v52, v52, s33, 4
    v_and_or_b32 v54, v54, s33, 6
    v_and_or_b32 v49, v49, s33, 1
    v_and_or_b32 v51, v51, s33, 3
    v_and_or_b32 v53, v53, s33, 5
    v_and_or_b32 v55, v55, s33, 7
    v_max_f32 v136, v48, v49
    v_min_f32 v137, v48, v49
    v_med3_f32 v137, v136, v50, v137
    v_max_f32_e64 v136, v136, v50
    v_med3_f32 v137, v136, v51, v137
    v_max_f32_e64 v136, v136, v51
    v_med3_f32 v137, v136, v52, v137
    v_max_f32_e64 v136, v136, v52
    v_med3_f32 v137, v136, v53, v137
    v_max_f32_e64 v136, v136, v53
    v_med3_f32 v137, v136, v54, v137
    v_max_f32_e64 v136, v136, v54
    v_med3_f32 v137, v136, v55, v137
    v_max_f32 v136, v136, v55
    v_or_b32 v136, v141, v136
    v_or_b32 v137, v141, v137
    s_nop 1
    v_mov_b32_dpp v138, v136 quad_perm:[1,0,3,2] row_mask:0xf bank_mask:0xf
    v_mov_b32_dpp v139, v137 quad_perm:[1,0,3,2] row_mask:0xf bank_mask:0xf
    v_min_f32 v140, v136, v138
    v_max_f32 v136, v136, v138
    v_max3_f32 v137, v140, v137, v139
    s_nop 1
    v_mov_b32_dpp v138, v136 quad_perm:[2,3,0,1] row_mask:0xf bank_mask:0xf
    v_mov_b32_dpp v139, v137 quad_perm:[2,3,0,1] row_mask:0xf bank_mask:0xf
    v_min_f32 v140, v136, v138
    v_max_f32_e64 v136, v136, v138
    v_max3_f32 v137, v140, v137, v139
    s_nop 1
    v_mov_b32_dpp v138, v136 row_half_mirror row_mask:0xf bank_mask:0xf
    v_mov_b32_dpp v139, v137 row_half_mirror row_mask:0xf bank_mask:0xf
    v_min_f32 v140, v136, v138
    v_max_f32_e64 v136, v136, v138
    v_max3_f32 v137, v140, v137, v139
    s_nop 1
    v_mov_b32_dpp v138, v136 row_mirror row_mask:0xf bank_mask:0xf
    v_mov_b32_dpp v139, v137 row_mirror row_mask:0xf bank_mask:0xf
    v_min_f32 v140, v136, v138
    v_max_f32_e64 v136, v136, v138
    v_max3_f32 v137, v140, v137, v139
    v_mov_b32 v138, v136
    v_mov_b32 v139, v137
    s_nop 1
    v_permlane16_swap_b32 v136, v138
    v_permlane16_swap_b32 v137, v139
    s_nop 0
    v_min_f32 v140, v136, v138
    v_max_f32 v136, v136, v138
    v_max3_f32 v137, v140, v137, v139
    v_mov_b32 v138, v136
    v_mov_b32 v139, v137
    s_nop 1
    v_permlane32_swap_b32 v136, v138
    v_permlane32_swap_b32 v137, v139
    s_nop 0
    v_min_f32 v140, v136, v138
    v_max_f32 v136, v136, v138
    v_max3_f32 v137, v140, v137, v139
    v_mov_b32_e64 v234, s7
    ds_write_b64 v234, v[136:137]
    v_mov_b32 v234, 106512
    s_waitcnt lgkmcnt(0)
    s_barrier
    ds_read_b128 v[56:59], v234
    ds_read_b128 v[60:63], v234 offset:16
    s_waitcnt lgkmcnt(0)
    v_min_f32 v140, v56, v58
    v_max_f32_e64 v56, v56, v58
    v_max3_f32 v57, v140, v57, v59
    v_min_f32 v140, v60, v62
    v_max_f32 v60, v60, v62
    v_max3_f32 v61, v140, v61, v63
    v_min_f32 v140, v56, v60
    v_max_f32 v56, v56, v60
    v_max3_f32 v57, v140, v57, v61
    v_bfe_u32 v234, v56, 5, 6
    v_bfe_u32 v235, v56, 2, 3
    v_and_b32_e64 v8, 3, v56
    v_lshl_add_u32 v8, v234, 2, v8
    v_lshl_add_u32 v8, v235, 8, v8
    v_bfe_u32 v234, v57, 5, 6
    v_bfe_u32 v235, v57, 2, 3
    v_and_b32_e64 v10, 3, v57
    v_lshl_add_u32 v10, v234, 2, v10
    v_lshl_add_u32 v10, v235, 8, v10
    s_cmp_lt_u32 s3, 2
    s_cselect_b64 vcc, -1, 0
    v_lshlrev_b32 v236, 4, v230
    v_cndmask_b32 v142, v10, v8, vcc
    v_lshlrev_b32_e64 v234, 2, v142
    v_and_b32 v235, 2047, v236
    v_lshl_add_u32 v235, v142, 11, v235
    s_mov_b32 s32, 0x3400000
    buffer_load_dwordx4 v[32:35], v235, s[8:11], s32 offen sc1
    buffer_load_dword v144, v234, s[8:11], s48 offen sc1
    buffer_load_dword v145, v234, s[8:11], s49 offen sc1
    buffer_load_dword v146, v234, s[8:11], s50 offen sc1
    v_add_u32 v236, 98304, v236
    s_lshr_b32 s32, s3, 1
    s_lshl_b32 s32, s32, 2
    s_add_u32 s32, s32, 106496
    v_mov_b32 v234, s32
    s_waitcnt vmcnt(4)
    v_mul_f32 v0, 0x3a800000, v0
    v_mul_f32 v1, 0x3a800000, v1
    v_mul_f32 v2, 0x3a800000, v2
    v_mul_f32 v3, 0x3a800000, v3
    v_mul_f32 v4, 0x3a800000, v4
    v_mul_f32 v5, 0x3a800000, v5
    v_mul_f32 v6, 0x3a800000, v6
    v_mul_f32 v7, 0x3a800000, v7
    v_fma_f32 v4, -v0, v0, v4
    v_fma_f32 v5, -v1, v1, v5
    v_fma_f32 v6, -v2, v2, v6
    v_fma_f32 v7, -v3, v3, v7
    v_max_f32 v4, 0, v4
    v_max_f32 v5, 0, v5
    v_max_f32 v6, 0, v6
    v_max_f32 v7, 0, v7
    v_cvt_pk_bf16_f32 v12, v0, v4
    v_cvt_pk_bf16_f32 v13, v1, v5
    v_cvt_pk_bf16_f32 v14, v2, v6
    v_cvt_pk_bf16_f32 v15, v3, v7
    v_lshlrev_b32 v0, 16, v12
    v_lshlrev_b32 v1, 16, v13
    v_lshlrev_b32 v2, 16, v14
    v_lshlrev_b32 v3, 16, v15
    v_and_b32 v4, 0xffff0000, v12
    v_and_b32 v5, 0xffff0000, v13
    v_and_b32 v6, 0xffff0000, v14
    v_and_b32 v7, 0xffff0000, v15
    v_add_f32 v4, 0x3727c5ac, v4
    v_add_f32 v5, 0x3727c5ac, v5
    v_add_f32 v6, 0x3727c5ac, v6
    v_add_f32 v7, 0x3727c5ac, v7
    v_cvt_pk_bf16_f32 v4, v4, v4
    v_cvt_pk_bf16_f32 v5, v5, v5
    v_cvt_pk_bf16_f32 v6, v6, v6
    v_cvt_pk_bf16_f32 v7, v7, v7
    v_lshlrev_b32 v4, 16, v4
    v_lshlrev_b32 v5, 16, v5
    v_lshlrev_b32 v6, 16, v6
    v_lshlrev_b32 v7, 16, v7
    v_sqrt_f32 v4, v4
    v_sqrt_f32 v5, v5
    v_sqrt_f32 v6, v6
    v_sqrt_f32 v7, v7
    v_cvt_pk_bf16_f32 v4, v4, v4
    v_cvt_pk_bf16_f32 v5, v5, v5
    v_cvt_pk_bf16_f32 v6, v6, v6
    v_cvt_pk_bf16_f32 v7, v7, v7
    v_lshlrev_b32 v4, 16, v4
    v_lshlrev_b32 v5, 16, v5
    v_lshlrev_b32 v6, 16, v6
    v_lshlrev_b32 v7, 16, v7
    v_rcp_f32 v4, v4
    v_rcp_f32 v5, v5
    v_rcp_f32 v6, v6
    v_rcp_f32_e64 v7, v7
    s_waitcnt vmcnt(0)
    v_mul_f32 v144, 0x3a800000, v144
    v_mul_f32 v145, 0x3a800000, v145
    v_fma_f32 v145, -v144, v144, v145
    v_max_f32_e64 v145, 0, v145
    v_cvt_pk_bf16_f32 v140, v144, v145
    v_lshlrev_b32_e64 v144, 16, v140
    v_and_b32 v145, 0xffff0000, v140
    v_add_f32 v145, 0x3727c5ac, v145
    v_cvt_pk_bf16_f32 v145, v145, v145
    v_lshlrev_b32_e64 v145, 16, v145
    v_sqrt_f32 v145, v145
    s_nop 0
    v_cvt_pk_bf16_f32 v145, v145, v145
    v_lshlrev_b32 v145, 16, v145
    v_rcp_f32 v145, v145
    s_nop 0
    v_lshlrev_b32 v64, 16, v32
    v_lshlrev_b32 v66, 16, v33
    v_lshlrev_b32 v68, 16, v34
    v_lshlrev_b32_e64 v70, 16, v35
    v_and_b32 v65, 0xffff0000, v32
    v_and_b32 v67, 0xffff0000, v33
    v_and_b32 v69, 0xffff0000, v34
    v_and_b32 v71, 0xffff0000, v35
    v_sub_f32 v64, v64, v144
    v_sub_f32 v66, v66, v144
    v_sub_f32 v68, v68, v144
    v_sub_f32 v70, v70, v144
    v_sub_f32 v65, v65, v144
    v_sub_f32 v67, v67, v144
    v_sub_f32 v69, v69, v144
    v_sub_f32 v71, v71, v144
    v_cvt_pk_bf16_f32 v65, v64, v65
    v_cvt_pk_bf16_f32 v67, v66, v67
    v_cvt_pk_bf16_f32 v69, v68, v69
    v_cvt_pk_bf16_f32 v71, v70, v71
    v_lshlrev_b32 v64, 16, v65
    v_lshlrev_b32 v66, 16, v67
    v_lshlrev_b32 v68, 16, v69
    v_lshlrev_b32 v70, 16, v71
    v_and_b32 v65, 0xffff0000, v65
    v_and_b32 v67, 0xffff0000, v67
    v_and_b32 v69, 0xffff0000, v69
    v_and_b32 v71, 0xffff0000, v71
    v_mul_f32 v64, v64, v145
    v_mul_f32 v66, v66, v145
    v_mul_f32 v68, v68, v145
    v_mul_f32 v70, v70, v145
    v_mul_f32 v65, v65, v145
    v_mul_f32 v67, v67, v145
    v_mul_f32 v69, v69, v145
    v_mul_f32 v71, v71, v145
    v_cvt_pk_bf16_f32 v48, v64, v65
    v_cvt_pk_bf16_f32 v49, v66, v67
    v_cvt_pk_bf16_f32 v50, v68, v69
    v_cvt_pk_bf16_f32 v51, v70, v71
    ds_write_b128 v236, v[48:51]
    ds_write_b128 v236, v[32:35] offset:4096
    v_fma_f32 v143, -v144, v128, v146
    v_mul_f32_e64 v143, v143, v145
    ds_write_b32 v234, v143
    s_waitcnt lgkmcnt(0)
kc_com:
    s_barrier
    s_cmp_ge_u32 s53, 28
    s_cbranch_scc1 kc_red
    ds_read_b64 v[96:97], v218 offset:0
    ds_read_b64 v[98:99], v218 offset:16
    ds_read_b64 v[100:101], v218 offset:64
    ds_read_b64 v[102:103], v218 offset:80
    ds_read_b64 v[104:105], v218 offset:128
    ds_read_b64 v[106:107], v218 offset:144
    ds_read_b64 v[108:109], v218 offset:192
    ds_read_b64 v[110:111], v218 offset:208
    ds_read_b64 v[112:113], v218 offset:256
    ds_read_b64 v[114:115], v218 offset:272
    ds_read_b64 v[116:117], v218 offset:320
    ds_read_b64 v[118:119], v218 offset:336
    ds_read_b64 v[120:121], v218 offset:384
    ds_read_b64 v[122:123], v218 offset:400
    s_waitcnt lgkmcnt(12)
    ds_read_b64 v[124:125], v218 offset:448
    ds_read_b64 v[126:127], v218 offset:464
    v_mfma_f32_16x16x32_bf16 v[128:131], a[0:3], v[96:99], 0
    v_mfma_f32_16x16x32_bf16 v[132:135], a[32:35], v[96:99], 0
    s_waitcnt lgkmcnt(12)
    v_mfma_f32_16x16x32_bf16 v[128:131], a[4:7], v[100:103], v[128:131]
    v_mfma_f32_16x16x32_bf16 v[132:135], a[36:39], v[100:103], v[132:135]
    s_waitcnt lgkmcnt(10)
    v_mfma_f32_16x16x32_bf16 v[128:131], a[8:11], v[104:107], v[128:131]
    v_mfma_f32_16x16x32_bf16 v[132:135], a[40:43], v[104:107], v[132:135]
    s_waitcnt lgkmcnt(8)
    v_mfma_f32_16x16x32_bf16 v[128:131], a[12:15], v[108:111], v[128:131]
    v_mfma_f32_16x16x32_bf16 v[132:135], a[44:47], v[108:111], v[132:135]
    s_waitcnt lgkmcnt(6)
    v_mfma_f32_16x16x32_bf16 v[128:131], a[16:19], v[112:115], v[128:131]
    v_mfma_f32_16x16x32_bf16 v[132:135], a[48:51], v[112:115], v[132:135]
    s_waitcnt lgkmcnt(4)
    v_mfma_f32_16x16x32_bf16 v[128:131], a[20:23], v[116:119], v[128:131]
    v_mfma_f32_16x16x32_bf16 v[132:135], a[52:55], v[116:119], v[132:135]
    s_waitcnt lgkmcnt(2)
    v_mfma_f32_16x16x32_bf16 v[128:131], a[24:27], v[120:123], v[128:131]
    v_mfma_f32_16x16x32_bf16 v[132:135], a[56:59], v[120:123], v[132:135]
    s_waitcnt lgkmcnt(0)
    v_mfma_f32_16x16x32_bf16 v[128:131], a[28:31], v[124:127], v[128:131]
    v_mfma_f32_16x16x32_bf16 v[132:135], a[60:63], v[124:127], v[132:135]
    s_nop 6
    ds_write_b128 v220, v[128:131]
    ds_write_b128 v220, v[132:135] offset:4096
    s_waitcnt lgkmcnt(0)
    s_barrier
    ds_read_b128 v[32:35], v221 offset:0
    ds_read_b128 v[48:51], v221 offset:4096
    ds_read_b128 v[36:39], v221 offset:1024
    ds_read_b128 v[52:55], v221 offset:5120
    ds_read_b128 v[40:43], v221 offset:2048
    ds_read_b128 v[56:59], v221 offset:6144
    ds_read_b128 v[44:47], v221 offset:3072
    ds_read_b128 v[60:63], v221 offset:7168
    s_waitcnt lgkmcnt(0)
    v_pk_add_f32 v[32:33], v[32:33], v[36:37]
    v_pk_add_f32 v[34:35], v[34:35], v[38:39]
    v_pk_add_f32 v[40:41], v[40:41], v[44:45]
    v_pk_add_f32 v[42:43], v[42:43], v[46:47]
    v_pk_add_f32 v[48:49], v[48:49], v[52:53]
    v_pk_add_f32 v[50:51], v[50:51], v[54:55]
    v_pk_add_f32 v[56:57], v[56:57], v[60:61]
    v_pk_add_f32 v[58:59], v[58:59], v[62:63]
    v_pk_add_f32 v[32:33], v[32:33], v[40:41]
    v_pk_add_f32 v[34:35], v[34:35], v[42:43]
    v_pk_add_f32 v[48:49], v[48:49], v[56:57]
    v_pk_add_f32 v[50:51], v[50:51], v[58:59]
    v_cvt_pk_bf16_f32 v48, v32, v48
    v_cvt_pk_bf16_f32 v49, v33, v49
    v_cvt_pk_bf16_f32 v50, v34, v50
    v_cvt_pk_bf16_f32 v51, v35, v51
    v_lshlrev_b32 v32, 16, v48
    v_lshlrev_b32 v33, 16, v49
    v_lshlrev_b32 v34, 16, v50
    v_lshlrev_b32 v35, 16, v51
    v_and_b32 v48, 0xffff0000, v48
    v_and_b32 v49, 0xffff0000, v49
    v_and_b32 v50, 0xffff0000, v50
    v_and_b32 v51, 0xffff0000, v51
    v_mul_f32 v136, 0xbfb8aa3b, v32
    v_mul_f32 v137, 0xbfb8aa3b, v33
    v_mul_f32 v138, 0xbfb8aa3b, v34
    v_mul_f32 v139, 0xbfb8aa3b, v35
    v_exp_f32 v136, v136
    v_exp_f32 v137, v137
    v_exp_f32 v138, v138
    v_exp_f32 v139, v139
    v_add_f32 v136, 1.0, v136
    v_add_f32 v137, 1.0, v137
    v_add_f32 v138, 1.0, v138
    v_add_f32 v139, 1.0, v139
    v_rcp_f32 v136, v136
    v_rcp_f32 v137, v137
    v_rcp_f32 v138, v138
    v_rcp_f32 v139, v139
    v_mul_f32 v32, v32, v136
    v_mul_f32 v33, v33, v137
    v_mul_f32 v34, v34, v138
    v_mul_f32 v35, v35, v139
    v_cvt_pk_bf16_f32 v32, v32, v32
    v_cvt_pk_bf16_f32 v33, v33, v33
    v_cvt_pk_bf16_f32 v34, v34, v34
    v_cvt_pk_bf16_f32 v35, v35, v35
    v_lshlrev_b32 v32, 16, v32
    v_lshlrev_b32 v33, 16, v33
    v_lshlrev_b32 v34, 16, v34
    v_lshlrev_b32 v35, 16, v35
    v_mul_f32 v32, v32, v48
    v_mul_f32 v33, v33, v49
    v_mul_f32 v34, v34, v50
    v_mul_f32 v35, v35, v51
    v_cvt_pk_bf16_f32 v128, v32, v33
    v_cvt_pk_bf16_f32 v129, v34, v35
    v_cndmask_b32 v64, 0, v128, s[12:13]
    v_cndmask_b32 v65, 0, v129, s[12:13]
    v_cndmask_b32 v66, 0, v128, s[14:15]
    v_cndmask_b32 v67, 0, v129, s[14:15]
    v_cndmask_b32 v68, 0, v128, s[16:17]
    v_cndmask_b32 v69, 0, v129, s[16:17]
    v_cndmask_b32 v70, 0, v128, s[18:19]
    v_cndmask_b32 v71, 0, v129, s[18:19]
    v_cndmask_b32 v72, 0, v128, s[20:21]
    v_cndmask_b32 v73, 0, v129, s[20:21]
    v_cndmask_b32 v74, 0, v128, s[22:23]
    v_cndmask_b32 v75, 0, v129, s[22:23]
    v_cndmask_b32 v76, 0, v128, s[24:25]
    v_cndmask_b32 v77, 0, v129, s[24:25]
    v_cndmask_b32 v78, 0, v128, s[26:27]
    v_cndmask_b32 v79, 0, v129, s[26:27]
    v_mfma_f32_16x16x32_bf16 v[32:35], a[64:67], v[64:67], 0
    v_mfma_f32_16x16x32_bf16 v[36:39], a[80:83], v[64:67], 0
    v_mfma_f32_16x16x32_bf16 v[32:35], a[68:71], v[68:71], v[32:35]
    v_mfma_f32_16x16x32_bf16 v[36:39], a[84:87], v[68:71], v[36:39]
    v_mfma_f32_16x16x32_bf16 v[32:35], a[72:75], v[72:75], v[32:35]
    v_mfma_f32_16x16x32_bf16 v[36:39], a[88:91], v[72:75], v[36:39]
    v_mfma_f32_16x16x32_bf16 v[32:35], a[76:79], v[76:79], v[32:35]
    v_mfma_f32_16x16x32_bf16 v[36:39], a[92:95], v[76:79], v[36:39]
    s_nop 6
    buffer_store_dwordx4 v[32:35], v222, s[8:11], s38 offen sc1
    buffer_store_dwordx4 v[36:39], v222, s[8:11], s38 offen offset:512 sc1
    v_lshlrev_b32 v144, 16, v16
    v_lshlrev_b32 v148, 16, v17
    v_lshlrev_b32 v152, 16, v18
    v_lshlrev_b32_e64 v156, 16, v19
    v_and_b32 v145, 0xffff0000, v16
    v_and_b32 v149, 0xffff0000, v17
    v_and_b32 v153, 0xffff0000, v18
    v_and_b32 v157, 0xffff0000, v19
    v_sub_f32 v144, v144, v0
    v_sub_f32 v148, v148, v0
    v_sub_f32 v152, v152, v0
    v_sub_f32 v156, v156, v0
    v_sub_f32 v145, v145, v0
    v_sub_f32 v149, v149, v0
    v_sub_f32 v153, v153, v0
    v_sub_f32 v157, v157, v0
    v_cvt_pk_bf16_f32 v145, v144, v145
    v_cvt_pk_bf16_f32 v149, v148, v149
    v_cvt_pk_bf16_f32 v153, v152, v153
    v_cvt_pk_bf16_f32 v157, v156, v157
    v_lshlrev_b32 v144, 16, v145
    v_lshlrev_b32 v148, 16, v149
    v_lshlrev_b32 v152, 16, v153
    v_lshlrev_b32 v156, 16, v157
    v_and_b32 v145, 0xffff0000, v145
    v_and_b32 v149, 0xffff0000, v149
    v_and_b32 v153, 0xffff0000, v153
    v_and_b32 v157, 0xffff0000, v157
    v_mul_f32 v144, v144, v4
    v_mul_f32 v148, v148, v4
    v_mul_f32 v152, v152, v4
    v_mul_f32 v156, v156, v4
    v_mul_f32 v145, v145, v4
    v_mul_f32 v149, v149, v4
    v_mul_f32 v153, v153, v4
    v_mul_f32 v157, v157, v4
    v_cvt_pk_bf16_f32 v146, v144, v145
    v_cvt_pk_bf16_f32 v150, v148, v149
    v_cvt_pk_bf16_f32 v154, v152, v153
    v_cvt_pk_bf16_f32 v158, v156, v157
    v_lshlrev_b32 v144, 16, v146
    v_lshlrev_b32 v148, 16, v150
    v_lshlrev_b32 v152, 16, v154
    v_lshlrev_b32 v156, 16, v158
    v_and_b32 v145, 0xffff0000, v146
    v_and_b32 v149, 0xffff0000, v150
    v_and_b32 v153, 0xffff0000, v154
    v_and_b32 v157, 0xffff0000, v158
    v_lshlrev_b32 v146, 16, v16
    v_lshlrev_b32 v150, 16, v17
    v_lshlrev_b32 v154, 16, v18
    v_lshlrev_b32 v158, 16, v19
    v_and_b32 v147, 0xffff0000, v16
    v_and_b32 v151, 0xffff0000, v17
    v_and_b32 v155, 0xffff0000, v18
    v_and_b32 v159, 0xffff0000, v19
    v_pk_add_f32 v[144:145], v[144:145], v[146:147]
    v_pk_add_f32 v[148:149], v[148:149], v[150:151]
    v_pk_add_f32 v[152:153], v[152:153], v[154:155]
    v_pk_add_f32 v[156:157], v[156:157], v[158:159]
    v_cvt_pk_bf16_f32 v16, v144, v145
    v_cvt_pk_bf16_f32 v17, v148, v149
    v_cvt_pk_bf16_f32 v18, v152, v153
    v_cvt_pk_bf16_f32 v19, v156, v157
    v_add_u32 v160, 0, v242
    v_cmp_eq_u32 vcc, v160, v8
    v_cmp_eq_u32 s[60:61], v160, v10
    v_mov_b32 v161, 0x40000000
    s_or_b64 vcc, vcc, s[60:61]
    v_cndmask_b32 v12, v229, v161, vcc
    s_waitcnt vmcnt(0)
    s_barrier
    s_cmp_lg_u32 s3, 0
    s_cbranch_scc1 kc_a2
    s_lshl_b32 s32, s52, 7
    s_add_u32 s32, s32, 0x38a0800
    v_mov_b32_e64 v235, 1
    buffer_atomic_add v235, v243, s[8:11], s32 offen sc0 sc1
    v_lshlrev_b32 v234, 7, v237
    v_cmp_gt_u32 vcc, 8, v237
    v_mov_b32_e64 v236, 0x40000000
    s_mov_b32 s34, 0x38a0c00
    v_cndmask_b32 v234, v236, v234, vcc
    s_waitcnt vmcnt(0)
    v_readfirstlane_b32 s36, v235
    s_cmp_lg_u32 s36, 27
    s_cbranch_scc1 kc_a2
    buffer_atomic_add v233, v234, s[8:11], s34 offen sc1
kc_a2:
    v_lshlrev_b32 v144, 16, v20
    v_lshlrev_b32 v148, 16, v21
    v_lshlrev_b32 v152, 16, v22
    v_lshlrev_b32_e64 v156, 16, v23
    v_and_b32 v145, 0xffff0000, v20
    v_and_b32 v149, 0xffff0000, v21
    v_and_b32 v153, 0xffff0000, v22
    v_and_b32 v157, 0xffff0000, v23
    v_sub_f32 v144, v144, v1
    v_sub_f32 v148, v148, v1
    v_sub_f32 v152, v152, v1
    v_sub_f32 v156, v156, v1
    v_sub_f32 v145, v145, v1
    v_sub_f32 v149, v149, v1
    v_sub_f32 v153, v153, v1
    v_sub_f32 v157, v157, v1
    v_cvt_pk_bf16_f32 v145, v144, v145
    v_cvt_pk_bf16_f32 v149, v148, v149
    v_cvt_pk_bf16_f32 v153, v152, v153
    v_cvt_pk_bf16_f32 v157, v156, v157
    v_lshlrev_b32 v144, 16, v145
    v_lshlrev_b32 v148, 16, v149
    v_lshlrev_b32 v152, 16, v153
    v_lshlrev_b32 v156, 16, v157
    v_and_b32 v145, 0xffff0000, v145
    v_and_b32 v149, 0xffff0000, v149
    v_and_b32 v153, 0xffff0000, v153
    v_and_b32 v157, 0xffff0000, v157
    v_mul_f32 v144, v144, v5
    v_mul_f32 v148, v148, v5
    v_mul_f32 v152, v152, v5
    v_mul_f32 v156, v156, v5
    v_mul_f32 v145, v145, v5
    v_mul_f32 v149, v149, v5
    v_mul_f32 v153, v153, v5
    v_mul_f32 v157, v157, v5
    v_cvt_pk_bf16_f32 v146, v144, v145
    v_cvt_pk_bf16_f32 v150, v148, v149
    v_cvt_pk_bf16_f32 v154, v152, v153
    v_cvt_pk_bf16_f32 v158, v156, v157
    v_lshlrev_b32 v144, 16, v146
    v_lshlrev_b32 v148, 16, v150
    v_lshlrev_b32 v152, 16, v154
    v_lshlrev_b32 v156, 16, v158
    v_and_b32 v145, 0xffff0000, v146
    v_and_b32 v149, 0xffff0000, v150
    v_and_b32 v153, 0xffff0000, v154
    v_and_b32 v157, 0xffff0000, v158
    v_lshlrev_b32 v146, 16, v20
    v_lshlrev_b32 v150, 16, v21
    v_lshlrev_b32 v154, 16, v22
    v_lshlrev_b32 v158, 16, v23
    v_and_b32 v147, 0xffff0000, v20
    v_and_b32 v151, 0xffff0000, v21
    v_and_b32 v155, 0xffff0000, v22
    v_and_b32 v159, 0xffff0000, v23
    v_pk_add_f32 v[144:145], v[144:145], v[146:147]
    v_pk_add_f32 v[148:149], v[148:149], v[150:151]
    v_pk_add_f32 v[152:153], v[152:153], v[154:155]
    v_pk_add_f32 v[156:157], v[156:157], v[158:159]
    v_cvt_pk_bf16_f32 v20, v144, v145
    v_cvt_pk_bf16_f32 v21, v148, v149
    v_cvt_pk_bf16_f32 v22, v152, v153
    v_cvt_pk_bf16_f32 v23, v156, v157
    v_add_u32 v160, 8, v242
    v_cmp_eq_u32 vcc, v160, v8
    v_cmp_eq_u32 s[60:61], v160, v10
    v_mov_b32 v161, 0x40000000
    s_or_b64 vcc, vcc, s[60:61]
    v_cndmask_b32 v13, v229, v161, vcc
    v_lshlrev_b32 v144, 16, v24
    v_lshlrev_b32 v148, 16, v25
    v_lshlrev_b32 v152, 16, v26
    v_lshlrev_b32_e64 v156, 16, v27
    v_and_b32 v145, 0xffff0000, v24
    v_and_b32 v149, 0xffff0000, v25
    v_and_b32 v153, 0xffff0000, v26
    v_and_b32 v157, 0xffff0000, v27
    v_sub_f32 v144, v144, v2
    v_sub_f32 v148, v148, v2
    v_sub_f32 v152, v152, v2
    v_sub_f32 v156, v156, v2
    v_sub_f32 v145, v145, v2
    v_sub_f32 v149, v149, v2
    v_sub_f32 v153, v153, v2
    v_sub_f32 v157, v157, v2
    v_cvt_pk_bf16_f32 v145, v144, v145
    v_cvt_pk_bf16_f32 v149, v148, v149
    v_cvt_pk_bf16_f32 v153, v152, v153
    v_cvt_pk_bf16_f32 v157, v156, v157
    v_lshlrev_b32 v144, 16, v145
    v_lshlrev_b32 v148, 16, v149
    v_lshlrev_b32 v152, 16, v153
    v_lshlrev_b32 v156, 16, v157
    v_and_b32 v145, 0xffff0000, v145
    v_and_b32 v149, 0xffff0000, v149
    v_and_b32 v153, 0xffff0000, v153
    v_and_b32 v157, 0xffff0000, v157
    v_mul_f32 v144, v144, v6
    v_mul_f32 v148, v148, v6
    v_mul_f32 v152, v152, v6
    v_mul_f32 v156, v156, v6
    v_mul_f32 v145, v145, v6
    v_mul_f32 v149, v149, v6
    v_mul_f32 v153, v153, v6
    v_mul_f32 v157, v157, v6
    v_cvt_pk_bf16_f32 v146, v144, v145
    v_cvt_pk_bf16_f32 v150, v148, v149
    v_cvt_pk_bf16_f32 v154, v152, v153
    v_cvt_pk_bf16_f32 v158, v156, v157
    v_lshlrev_b32 v144, 16, v146
    v_lshlrev_b32 v148, 16, v150
    v_lshlrev_b32 v152, 16, v154
    v_lshlrev_b32 v156, 16, v158
    v_and_b32 v145, 0xffff0000, v146
    v_and_b32 v149, 0xffff0000, v150
    v_and_b32 v153, 0xffff0000, v154
    v_and_b32 v157, 0xffff0000, v158
    v_lshlrev_b32 v146, 16, v24
    v_lshlrev_b32 v150, 16, v25
    v_lshlrev_b32 v154, 16, v26
    v_lshlrev_b32 v158, 16, v27
    v_and_b32 v147, 0xffff0000, v24
    v_and_b32 v151, 0xffff0000, v25
    v_and_b32 v155, 0xffff0000, v26
    v_and_b32 v159, 0xffff0000, v27
    v_pk_add_f32 v[144:145], v[144:145], v[146:147]
    v_pk_add_f32 v[148:149], v[148:149], v[150:151]
    v_pk_add_f32 v[152:153], v[152:153], v[154:155]
    v_pk_add_f32 v[156:157], v[156:157], v[158:159]
    v_cvt_pk_bf16_f32 v24, v144, v145
    v_cvt_pk_bf16_f32 v25, v148, v149
    v_cvt_pk_bf16_f32 v26, v152, v153
    v_cvt_pk_bf16_f32 v27, v156, v157
    v_add_u32 v160, 16, v242
    v_cmp_eq_u32 vcc, v160, v8
    v_cmp_eq_u32 s[60:61], v160, v10
    v_mov_b32 v161, 0x40000000
    s_or_b64 vcc, vcc, s[60:61]
    v_cndmask_b32 v14, v229, v161, vcc
    v_lshlrev_b32 v144, 16, v28
    v_lshlrev_b32 v148, 16, v29
    v_lshlrev_b32 v152, 16, v30
    v_lshlrev_b32_e64 v156, 16, v31
    v_and_b32 v145, 0xffff0000, v28
    v_and_b32 v149, 0xffff0000, v29
    v_and_b32 v153, 0xffff0000, v30
    v_and_b32 v157, 0xffff0000, v31
    v_sub_f32 v144, v144, v3
    v_sub_f32 v148, v148, v3
    v_sub_f32 v152, v152, v3
    v_sub_f32 v156, v156, v3
    v_sub_f32 v145, v145, v3
    v_sub_f32 v149, v149, v3
    v_sub_f32 v153, v153, v3
    v_sub_f32 v157, v157, v3
    v_cvt_pk_bf16_f32 v145, v144, v145
    v_cvt_pk_bf16_f32 v149, v148, v149
    v_cvt_pk_bf16_f32 v153, v152, v153
    v_cvt_pk_bf16_f32 v157, v156, v157
    v_lshlrev_b32 v144, 16, v145
    v_lshlrev_b32 v148, 16, v149
    v_lshlrev_b32 v152, 16, v153
    v_lshlrev_b32 v156, 16, v157
    v_and_b32 v145, 0xffff0000, v145
    v_and_b32 v149, 0xffff0000, v149
    v_and_b32 v153, 0xffff0000, v153
    v_and_b32 v157, 0xffff0000, v157
    v_mul_f32 v144, v144, v7
    v_mul_f32 v148, v148, v7
    v_mul_f32 v152, v152, v7
    v_mul_f32 v156, v156, v7
    v_mul_f32 v145, v145, v7
    v_mul_f32 v149, v149, v7
    v_mul_f32 v153, v153, v7
    v_mul_f32 v157, v157, v7
    v_cvt_pk_bf16_f32 v146, v144, v145
    v_cvt_pk_bf16_f32 v150, v148, v149
    v_cvt_pk_bf16_f32 v154, v152, v153
    v_cvt_pk_bf16_f32 v158, v156, v157
    v_lshlrev_b32 v144, 16, v146
    v_lshlrev_b32 v148, 16, v150
    v_lshlrev_b32 v152, 16, v154
    v_lshlrev_b32 v156, 16, v158
    v_and_b32 v145, 0xffff0000, v146
    v_and_b32 v149, 0xffff0000, v150
    v_and_b32 v153, 0xffff0000, v154
    v_and_b32 v157, 0xffff0000, v158
    v_lshlrev_b32 v146, 16, v28
    v_lshlrev_b32 v150, 16, v29
    v_lshlrev_b32 v154, 16, v30
    v_lshlrev_b32 v158, 16, v31
    v_and_b32 v147, 0xffff0000, v28
    v_and_b32 v151, 0xffff0000, v29
    v_and_b32 v155, 0xffff0000, v30
    v_and_b32 v159, 0xffff0000, v31
    v_pk_add_f32 v[144:145], v[144:145], v[146:147]
    v_pk_add_f32 v[148:149], v[148:149], v[150:151]
    v_pk_add_f32 v[152:153], v[152:153], v[154:155]
    v_pk_add_f32 v[156:157], v[156:157], v[158:159]
    v_cvt_pk_bf16_f32 v28, v144, v145
    v_cvt_pk_bf16_f32 v29, v148, v149
    v_cvt_pk_bf16_f32 v30, v152, v153
    v_cvt_pk_bf16_f32 v31, v156, v157
    v_add_u32 v160, 24, v242
    v_cmp_eq_u32 vcc, v160, v8
    v_cmp_eq_u32 s[60:61], v160, v10
    v_mov_b32 v161, 0x40000000
    s_or_b64 vcc, vcc, s[60:61]
    v_cndmask_b32 v15, v229, v161, vcc
    s_mov_b32 s32, 0
    buffer_store_dwordx4 v[16:19], v12, s[28:31], s32 offen nt
    s_mov_b32 s32, 16384
    buffer_store_dwordx4 v[20:23], v13, s[28:31], s32 offen nt
    s_mov_b32 s32, 32768
    buffer_store_dwordx4 v[24:27], v14, s[28:31], s32 offen nt
    s_mov_b32 s32, 49152
    buffer_store_dwordx4 v[28:31], v15, s[28:31], s32 offen nt
    s_branch kc_fin
kc_red:
    v_lshlrev_b32 v144, 16, v16
    v_lshlrev_b32 v148, 16, v17
    v_lshlrev_b32 v152, 16, v18
    v_lshlrev_b32_e64 v156, 16, v19
    v_and_b32 v145, 0xffff0000, v16
    v_and_b32 v149, 0xffff0000, v17
    v_and_b32 v153, 0xffff0000, v18
    v_and_b32 v157, 0xffff0000, v19
    v_sub_f32 v144, v144, v0
    v_sub_f32 v148, v148, v0
    v_sub_f32 v152, v152, v0
    v_sub_f32 v156, v156, v0
    v_sub_f32 v145, v145, v0
    v_sub_f32 v149, v149, v0
    v_sub_f32 v153, v153, v0
    v_sub_f32 v157, v157, v0
    v_cvt_pk_bf16_f32 v145, v144, v145
    v_cvt_pk_bf16_f32 v149, v148, v149
    v_cvt_pk_bf16_f32 v153, v152, v153
    v_cvt_pk_bf16_f32 v157, v156, v157
    v_lshlrev_b32 v144, 16, v145
    v_lshlrev_b32 v148, 16, v149
    v_lshlrev_b32 v152, 16, v153
    v_lshlrev_b32 v156, 16, v157
    v_and_b32 v145, 0xffff0000, v145
    v_and_b32 v149, 0xffff0000, v149
    v_and_b32 v153, 0xffff0000, v153
    v_and_b32 v157, 0xffff0000, v157
    v_mul_f32 v144, v144, v4
    v_mul_f32 v148, v148, v4
    v_mul_f32 v152, v152, v4
    v_mul_f32 v156, v156, v4
    v_mul_f32 v145, v145, v4
    v_mul_f32 v149, v149, v4
    v_mul_f32 v153, v153, v4
    v_mul_f32 v157, v157, v4
    v_cvt_pk_bf16_f32 v146, v144, v145
    v_cvt_pk_bf16_f32 v150, v148, v149
    v_cvt_pk_bf16_f32 v154, v152, v153
    v_cvt_pk_bf16_f32 v158, v156, v157
    v_lshlrev_b32 v144, 16, v146
    v_lshlrev_b32 v148, 16, v150
    v_lshlrev_b32 v152, 16, v154
    v_lshlrev_b32 v156, 16, v158
    v_and_b32 v145, 0xffff0000, v146
    v_and_b32 v149, 0xffff0000, v150
    v_and_b32 v153, 0xffff0000, v154
    v_and_b32 v157, 0xffff0000, v158
    v_lshlrev_b32 v146, 16, v16
    v_lshlrev_b32 v150, 16, v17
    v_lshlrev_b32 v154, 16, v18
    v_lshlrev_b32 v158, 16, v19
    v_and_b32 v147, 0xffff0000, v16
    v_and_b32 v151, 0xffff0000, v17
    v_and_b32 v155, 0xffff0000, v18
    v_and_b32 v159, 0xffff0000, v19
    v_pk_add_f32 v[144:145], v[144:145], v[146:147]
    v_pk_add_f32 v[148:149], v[148:149], v[150:151]
    v_pk_add_f32 v[152:153], v[152:153], v[154:155]
    v_pk_add_f32 v[156:157], v[156:157], v[158:159]
    v_cvt_pk_bf16_f32 v16, v144, v145
    v_cvt_pk_bf16_f32 v17, v148, v149
    v_cvt_pk_bf16_f32 v18, v152, v153
    v_cvt_pk_bf16_f32 v19, v156, v157
    v_add_u32 v160, 0, v242
    v_cmp_eq_u32 vcc, v160, v8
    v_cmp_eq_u32 s[60:61], v160, v10
    v_mov_b32 v161, 0x40000000
    s_or_b64 vcc, vcc, s[60:61]
    v_cndmask_b32 v12, v229, v161, vcc
    v_lshlrev_b32 v144, 16, v20
    v_lshlrev_b32 v148, 16, v21
    v_lshlrev_b32 v152, 16, v22
    v_lshlrev_b32_e64 v156, 16, v23
    v_and_b32 v145, 0xffff0000, v20
    v_and_b32 v149, 0xffff0000, v21
    v_and_b32 v153, 0xffff0000, v22
    v_and_b32 v157, 0xffff0000, v23
    v_sub_f32 v144, v144, v1
    v_sub_f32 v148, v148, v1
    v_sub_f32 v152, v152, v1
    v_sub_f32 v156, v156, v1
    v_sub_f32 v145, v145, v1
    v_sub_f32 v149, v149, v1
    v_sub_f32 v153, v153, v1
    v_sub_f32 v157, v157, v1
    v_cvt_pk_bf16_f32 v145, v144, v145
    v_cvt_pk_bf16_f32 v149, v148, v149
    v_cvt_pk_bf16_f32 v153, v152, v153
    v_cvt_pk_bf16_f32 v157, v156, v157
    v_lshlrev_b32 v144, 16, v145
    v_lshlrev_b32 v148, 16, v149
    v_lshlrev_b32 v152, 16, v153
    v_lshlrev_b32 v156, 16, v157
    v_and_b32 v145, 0xffff0000, v145
    v_and_b32 v149, 0xffff0000, v149
    v_and_b32 v153, 0xffff0000, v153
    v_and_b32 v157, 0xffff0000, v157
    v_mul_f32 v144, v144, v5
    v_mul_f32 v148, v148, v5
    v_mul_f32 v152, v152, v5
    v_mul_f32 v156, v156, v5
    v_mul_f32 v145, v145, v5
    v_mul_f32 v149, v149, v5
    v_mul_f32 v153, v153, v5
    v_mul_f32 v157, v157, v5
    v_cvt_pk_bf16_f32 v146, v144, v145
    v_cvt_pk_bf16_f32 v150, v148, v149
    v_cvt_pk_bf16_f32 v154, v152, v153
    v_cvt_pk_bf16_f32 v158, v156, v157
    v_lshlrev_b32 v144, 16, v146
    v_lshlrev_b32 v148, 16, v150
    v_lshlrev_b32 v152, 16, v154
    v_lshlrev_b32 v156, 16, v158
    v_and_b32 v145, 0xffff0000, v146
    v_and_b32 v149, 0xffff0000, v150
    v_and_b32 v153, 0xffff0000, v154
    v_and_b32 v157, 0xffff0000, v158
    v_lshlrev_b32 v146, 16, v20
    v_lshlrev_b32 v150, 16, v21
    v_lshlrev_b32 v154, 16, v22
    v_lshlrev_b32 v158, 16, v23
    v_and_b32 v147, 0xffff0000, v20
    v_and_b32 v151, 0xffff0000, v21
    v_and_b32 v155, 0xffff0000, v22
    v_and_b32 v159, 0xffff0000, v23
    v_pk_add_f32 v[144:145], v[144:145], v[146:147]
    v_pk_add_f32 v[148:149], v[148:149], v[150:151]
    v_pk_add_f32 v[152:153], v[152:153], v[154:155]
    v_pk_add_f32 v[156:157], v[156:157], v[158:159]
    v_cvt_pk_bf16_f32 v20, v144, v145
    v_cvt_pk_bf16_f32 v21, v148, v149
    v_cvt_pk_bf16_f32 v22, v152, v153
    v_cvt_pk_bf16_f32 v23, v156, v157
    v_add_u32 v160, 8, v242
    v_cmp_eq_u32 vcc, v160, v8
    v_cmp_eq_u32 s[60:61], v160, v10
    v_mov_b32 v161, 0x40000000
    s_or_b64 vcc, vcc, s[60:61]
    v_cndmask_b32 v13, v229, v161, vcc
    v_lshlrev_b32 v144, 16, v24
    v_lshlrev_b32 v148, 16, v25
    v_lshlrev_b32 v152, 16, v26
    v_lshlrev_b32_e64 v156, 16, v27
    v_and_b32 v145, 0xffff0000, v24
    v_and_b32 v149, 0xffff0000, v25
    v_and_b32 v153, 0xffff0000, v26
    v_and_b32 v157, 0xffff0000, v27
    v_sub_f32 v144, v144, v2
    v_sub_f32 v148, v148, v2
    v_sub_f32 v152, v152, v2
    v_sub_f32 v156, v156, v2
    v_sub_f32 v145, v145, v2
    v_sub_f32 v149, v149, v2
    v_sub_f32 v153, v153, v2
    v_sub_f32 v157, v157, v2
    v_cvt_pk_bf16_f32 v145, v144, v145
    v_cvt_pk_bf16_f32 v149, v148, v149
    v_cvt_pk_bf16_f32 v153, v152, v153
    v_cvt_pk_bf16_f32 v157, v156, v157
    v_lshlrev_b32 v144, 16, v145
    v_lshlrev_b32 v148, 16, v149
    v_lshlrev_b32 v152, 16, v153
    v_lshlrev_b32 v156, 16, v157
    v_and_b32 v145, 0xffff0000, v145
    v_and_b32 v149, 0xffff0000, v149
    v_and_b32 v153, 0xffff0000, v153
    v_and_b32 v157, 0xffff0000, v157
    v_mul_f32 v144, v144, v6
    v_mul_f32 v148, v148, v6
    v_mul_f32 v152, v152, v6
    v_mul_f32 v156, v156, v6
    v_mul_f32 v145, v145, v6
    v_mul_f32 v149, v149, v6
    v_mul_f32 v153, v153, v6
    v_mul_f32 v157, v157, v6
    v_cvt_pk_bf16_f32 v146, v144, v145
    v_cvt_pk_bf16_f32 v150, v148, v149
    v_cvt_pk_bf16_f32 v154, v152, v153
    v_cvt_pk_bf16_f32 v158, v156, v157
    v_lshlrev_b32 v144, 16, v146
    v_lshlrev_b32 v148, 16, v150
    v_lshlrev_b32 v152, 16, v154
    v_lshlrev_b32 v156, 16, v158
    v_and_b32 v145, 0xffff0000, v146
    v_and_b32 v149, 0xffff0000, v150
    v_and_b32 v153, 0xffff0000, v154
    v_and_b32 v157, 0xffff0000, v158
    v_lshlrev_b32 v146, 16, v24
    v_lshlrev_b32 v150, 16, v25
    v_lshlrev_b32 v154, 16, v26
    v_lshlrev_b32 v158, 16, v27
    v_and_b32 v147, 0xffff0000, v24
    v_and_b32 v151, 0xffff0000, v25
    v_and_b32 v155, 0xffff0000, v26
    v_and_b32 v159, 0xffff0000, v27
    v_pk_add_f32 v[144:145], v[144:145], v[146:147]
    v_pk_add_f32 v[148:149], v[148:149], v[150:151]
    v_pk_add_f32 v[152:153], v[152:153], v[154:155]
    v_pk_add_f32 v[156:157], v[156:157], v[158:159]
    v_cvt_pk_bf16_f32 v24, v144, v145
    v_cvt_pk_bf16_f32 v25, v148, v149
    v_cvt_pk_bf16_f32 v26, v152, v153
    v_cvt_pk_bf16_f32 v27, v156, v157
    v_add_u32 v160, 16, v242
    v_cmp_eq_u32 vcc, v160, v8
    v_cmp_eq_u32 s[60:61], v160, v10
    v_mov_b32 v161, 0x40000000
    s_or_b64 vcc, vcc, s[60:61]
    v_cndmask_b32 v14, v229, v161, vcc
    v_lshlrev_b32 v144, 16, v28
    v_lshlrev_b32 v148, 16, v29
    v_lshlrev_b32 v152, 16, v30
    v_lshlrev_b32_e64 v156, 16, v31
    v_and_b32 v145, 0xffff0000, v28
    v_and_b32 v149, 0xffff0000, v29
    v_and_b32 v153, 0xffff0000, v30
    v_and_b32 v157, 0xffff0000, v31
    v_sub_f32 v144, v144, v3
    v_sub_f32 v148, v148, v3
    v_sub_f32 v152, v152, v3
    v_sub_f32 v156, v156, v3
    v_sub_f32 v145, v145, v3
    v_sub_f32 v149, v149, v3
    v_sub_f32 v153, v153, v3
    v_sub_f32 v157, v157, v3
    v_cvt_pk_bf16_f32 v145, v144, v145
    v_cvt_pk_bf16_f32 v149, v148, v149
    v_cvt_pk_bf16_f32 v153, v152, v153
    v_cvt_pk_bf16_f32 v157, v156, v157
    v_lshlrev_b32 v144, 16, v145
    v_lshlrev_b32 v148, 16, v149
    v_lshlrev_b32 v152, 16, v153
    v_lshlrev_b32 v156, 16, v157
    v_and_b32 v145, 0xffff0000, v145
    v_and_b32 v149, 0xffff0000, v149
    v_and_b32 v153, 0xffff0000, v153
    v_and_b32 v157, 0xffff0000, v157
    v_mul_f32 v144, v144, v7
    v_mul_f32 v148, v148, v7
    v_mul_f32 v152, v152, v7
    v_mul_f32 v156, v156, v7
    v_mul_f32 v145, v145, v7
    v_mul_f32 v149, v149, v7
    v_mul_f32 v153, v153, v7
    v_mul_f32 v157, v157, v7
    v_cvt_pk_bf16_f32 v146, v144, v145
    v_cvt_pk_bf16_f32 v150, v148, v149
    v_cvt_pk_bf16_f32 v154, v152, v153
    v_cvt_pk_bf16_f32 v158, v156, v157
    v_lshlrev_b32 v144, 16, v146
    v_lshlrev_b32 v148, 16, v150
    v_lshlrev_b32 v152, 16, v154
    v_lshlrev_b32 v156, 16, v158
    v_and_b32 v145, 0xffff0000, v146
    v_and_b32 v149, 0xffff0000, v150
    v_and_b32 v153, 0xffff0000, v154
    v_and_b32 v157, 0xffff0000, v158
    v_lshlrev_b32 v146, 16, v28
    v_lshlrev_b32 v150, 16, v29
    v_lshlrev_b32 v154, 16, v30
    v_lshlrev_b32 v158, 16, v31
    v_and_b32 v147, 0xffff0000, v28
    v_and_b32 v151, 0xffff0000, v29
    v_and_b32 v155, 0xffff0000, v30
    v_and_b32 v159, 0xffff0000, v31
    v_pk_add_f32 v[144:145], v[144:145], v[146:147]
    v_pk_add_f32 v[148:149], v[148:149], v[150:151]
    v_pk_add_f32 v[152:153], v[152:153], v[154:155]
    v_pk_add_f32 v[156:157], v[156:157], v[158:159]
    v_cvt_pk_bf16_f32 v28, v144, v145
    v_cvt_pk_bf16_f32 v29, v148, v149
    v_cvt_pk_bf16_f32 v30, v152, v153
    v_cvt_pk_bf16_f32 v31, v156, v157
    v_add_u32 v160, 24, v242
    v_cmp_eq_u32 vcc, v160, v8
    v_cmp_eq_u32 s[60:61], v160, v10
    v_mov_b32 v161, 0x40000000
    s_or_b64 vcc, vcc, s[60:61]
    v_cndmask_b32 v15, v229, v161, vcc
    s_mov_b32 s32, 0
    buffer_store_dwordx4 v[16:19], v12, s[28:31], s32 offen nt
    s_mov_b32 s32, 16384
    buffer_store_dwordx4 v[20:23], v13, s[28:31], s32 offen nt
    s_mov_b32 s32, 32768
    buffer_store_dwordx4 v[24:27], v14, s[28:31], s32 offen nt
    s_mov_b32 s32, 49152
    buffer_store_dwordx4 v[28:31], v15, s[28:31], s32 offen nt
    s_sub_u32 s54, s2, 224
    v_lshrrev_b32 v234, 4, v230
    v_lshlrev_b32 v234, 13, v234
    v_and_b32_e64 v235, 15, v237
    v_lshl_add_u32 v217, v235, 4, v234
    s_lshl_b32 s35, s54, 8
    s_add_u32 s35, s35, 0x3900000
    v_bfe_u32 v234, v237, 4, 1
    v_lshrrev_b32 v236, 5, v237
    v_lshl_add_u32 v234, v234, 1, v236
    v_lshl_add_u32 v234, v235, 2, v234
    s_lshl_b32 s32, s54, 6
    v_add_u32 v234, s32, v234
    v_lshlrev_b32_e64 v218, 1, v234
    v_add_u32 v234, 98304, v218
    ds_read_u16 v100, v234
    ds_read_u16 v101, v234 offset:4096
    s_cmp_lt_u32 s54, 16
    s_cselect_b64 vcc, -1, 0
    v_cndmask_b32 v102, v10, v8, vcc
    s_cselect_b32 s32, 0, 4
    s_add_u32 s32, s32, 106496
    v_mov_b32_e64 v234, s32
    ds_read_b32 v103, v234
    s_waitcnt lgkmcnt(0)
    v_cvt_pk_bf16_f32 v103, v103, v103
    v_lshlrev_b32 v103, 16, v103
    v_mul_f32 v103, 0xbfb8aa3b, v103
    v_exp_f32 v103, v103
    s_nop 0
    v_add_f32 v103, 1.0, v103
    v_rcp_f32_e64 v103, v103
    s_nop 0
    v_cvt_pk_bf16_f32 v103, v103, v103
    v_lshlrev_b32_e64 v103, 16, v103
    v_and_b32 v218, 2047, v218
    v_lshl_add_u32 v218, v102, 11, v218
    v_lshlrev_b32_e64 v220, 2, v230
    v_add_u32 v220, 106752, v220
    v_lshlrev_b32_e64 v221, 2, v237
    v_add_u32 v221, 106752, v221
    s_cmp_lg_u32 s3, 0
    s_cbranch_scc1 kc_b22
    s_lshl_b32 s32, s52, 7
    s_add_u32 s32, s32, 0x38a0c00
    s_mov_b32 s34, 0x400000
    s_branch kc_b21
kc_b20:
    s_sleep 2
kc_b21:
    buffer_load_dword v235, off, s[8:11], s32 sc1
    s_waitcnt vmcnt(0)
    v_cmp_ne_u32 vcc, 8, v235
    s_sub_u32 s34, s34, 1
    s_cbranch_scc1 kc_b22
    s_cbranch_vccnz kc_b20
kc_b22:
    s_barrier
    s_add_u32 s32, s35, 0
    buffer_load_dwordx4 v[32:35], v217, s[8:11], s32 offen sc1
    s_add_u32 s32, s35, 131072
    buffer_load_dwordx4 v[36:39], v217, s[8:11], s32 offen sc1
    s_add_u32 s32, s35, 262144
    buffer_load_dwordx4 v[40:43], v217, s[8:11], s32 offen sc1
    s_add_u32 s32, s35, 393216
    buffer_load_dwordx4 v[44:47], v217, s[8:11], s32 offen sc1
    s_add_u32 s32, s35, 524288
    buffer_load_dwordx4 v[48:51], v217, s[8:11], s32 offen sc1
    s_add_u32 s32, s35, 655360
    buffer_load_dwordx4 v[52:55], v217, s[8:11], s32 offen sc1
    s_add_u32 s32, s35, 786432
    buffer_load_dwordx4 v[56:59], v217, s[8:11], s32 offen sc1
    s_add_u32 s32, s35, 917504
    buffer_load_dwordx4 v[60:63], v217, s[8:11], s32 offen sc1
    s_add_u32 s32, s35, 1048576
    buffer_load_dwordx4 v[64:67], v217, s[8:11], s32 offen sc1
    s_add_u32 s32, s35, 1179648
    buffer_load_dwordx4 v[68:71], v217, s[8:11], s32 offen sc1
    s_add_u32 s32, s35, 1310720
    buffer_load_dwordx4 v[72:75], v217, s[8:11], s32 offen sc1
    s_add_u32 s32, s35, 1441792
    buffer_load_dwordx4 v[76:79], v217, s[8:11], s32 offen sc1
    s_add_u32 s32, s35, 1572864
    buffer_load_dwordx4 v[80:83], v217, s[8:11], s32 offen sc1
    s_add_u32 s32, s35, 1703936
    buffer_load_dwordx4 v[84:87], v217, s[8:11], s32 offen sc1
    s_waitcnt vmcnt(12)
    v_pk_add_f32 v[32:33], v[32:33], v[36:37]
    v_pk_add_f32 v[34:35], v[34:35], v[38:39]
    s_waitcnt vmcnt(11)
    v_pk_add_f32 v[32:33], v[32:33], v[40:41]
    v_pk_add_f32 v[34:35], v[34:35], v[42:43]
    s_waitcnt vmcnt(10)
    v_pk_add_f32 v[32:33], v[32:33], v[44:45]
    v_pk_add_f32 v[34:35], v[34:35], v[46:47]
    s_waitcnt vmcnt(9)
    v_pk_add_f32 v[32:33], v[32:33], v[48:49]
    v_pk_add_f32 v[34:35], v[34:35], v[50:51]
    s_waitcnt vmcnt(8)
    v_pk_add_f32 v[32:33], v[32:33], v[52:53]
    v_pk_add_f32 v[34:35], v[34:35], v[54:55]
    s_waitcnt vmcnt(7)
    v_pk_add_f32 v[32:33], v[32:33], v[56:57]
    v_pk_add_f32 v[34:35], v[34:35], v[58:59]
    s_waitcnt vmcnt(6)
    v_pk_add_f32 v[32:33], v[32:33], v[60:61]
    v_pk_add_f32 v[34:35], v[34:35], v[62:63]
    s_waitcnt vmcnt(5)
    v_pk_add_f32 v[32:33], v[32:33], v[64:65]
    v_pk_add_f32 v[34:35], v[34:35], v[66:67]
    s_waitcnt vmcnt(4)
    v_pk_add_f32 v[32:33], v[32:33], v[68:69]
    v_pk_add_f32 v[34:35], v[34:35], v[70:71]
    s_waitcnt vmcnt(3)
    v_pk_add_f32 v[32:33], v[32:33], v[72:73]
    v_pk_add_f32 v[34:35], v[34:35], v[74:75]
    s_waitcnt vmcnt(2)
    v_pk_add_f32 v[32:33], v[32:33], v[76:77]
    v_pk_add_f32 v[34:35], v[34:35], v[78:79]
    s_waitcnt vmcnt(1)
    v_pk_add_f32 v[32:33], v[32:33], v[80:81]
    v_pk_add_f32 v[34:35], v[34:35], v[82:83]
    s_waitcnt vmcnt(0)
    v_pk_add_f32 v[32:33], v[32:33], v[84:85]
    v_pk_add_f32 v[34:35], v[34:35], v[86:87]
    s_nop 1
    v_permlane32_swap_b32 v32, v33
    v_permlane32_swap_b32 v34, v35
    s_nop 0
    v_add_f32 v32, v32, v33
    v_add_f32 v34, v34, v35
    s_nop 1
    v_permlane16_swap_b32 v32, v34
    s_nop 0
    v_add_f32_e64 v32, v32, v34
    ds_write_b32 v220, v32
    s_waitcnt lgkmcnt(0)
    s_barrier
    s_cmp_lg_u32 s3, 0
    s_cbranch_scc1 kc_fin
    ds_read_b32 v32, v221
    ds_read_b32 v33, v221 offset:256
    ds_read_b32 v34, v221 offset:512
    ds_read_b32 v35, v221 offset:768
    v_lshlrev_b32 v100, 16, v100
    v_lshlrev_b32 v101, 16, v101
    s_waitcnt lgkmcnt(0)
    v_add_f32 v32, v32, v33
    v_add_f32 v34, v34, v35
    v_add_f32 v32, v32, v34
    v_cvt_pk_bf16_f32 v32, v32, v32
    v_lshlrev_b32 v32, 16, v32
    v_mul_f32 v32, v32, v103
    v_cvt_pk_bf16_f32 v32, v32, v32
    v_lshlrev_b32 v32, 16, v32
    v_add_f32 v32, v32, v100
    v_cvt_pk_bf16_f32 v32, v32, v32
    v_lshlrev_b32 v32, 16, v32
    v_add_f32 v32, v32, v101
    v_cvt_pk_bf16_f32 v32, v32, v32
    buffer_store_short v32, v218, s[28:31], 0 offen
kc_fin:
    s_endpgm
kc_r3:
    s_mov_b32 s34, 0x400000
kc_r3l:
    s_sleep 4
    buffer_load_dwordx4 v[176:179], v228, s[8:11], s7 offen offset:0 sc1
    buffer_load_dwordx4 v[180:183], v228, s[8:11], s7 offen offset:1024 sc1
    buffer_load_dwordx4 v[184:187], v228, s[8:11], s7 offen offset:2048 sc1
    buffer_load_dwordx4 v[188:191], v228, s[8:11], s7 offen offset:3072 sc1
    s_waitcnt vmcnt(0)
    v_max3_u32 v235, v176, v177, v178
    v_max3_u32 v235, v235, v179, v180
    v_max3_u32 v235, v235, v181, v182
    v_max3_u32 v235, v235, v183, v184
    v_max3_u32 v235, v235, v185, v186
    v_max3_u32 v235, v235, v187, v188
    v_max3_u32 v235, v235, v189, v190
    v_max_u32 v235, v235, v191
    v_cmp_eq_u32 vcc, -1, v235
    s_sub_u32 s34, s34, 1
    s_cbranch_scc1 kc_r3o
    s_cbranch_vccnz kc_r3l
    s_branch kc_r3o
kc_r1:
    s_mov_b32 s34, 0x400000
kc_r1l:
    s_sleep 4
    buffer_load_dwordx4 v[96:99], v228, s[8:11], s37 offen offset:0 sc1
    buffer_load_dwordx4 v[100:103], v228, s[8:11], s37 offen offset:1024 sc1
    buffer_load_dwordx4 v[104:107], v228, s[8:11], s37 offen offset:2048 sc1
    buffer_load_dwordx4 v[108:111], v228, s[8:11], s37 offen offset:3072 sc1
    s_waitcnt vmcnt(0)
    v_max3_u32 v235, v96, v97, v98
    v_max3_u32 v235, v235, v99, v100
    v_max3_u32 v235, v235, v101, v102
    v_max3_u32 v235, v235, v103, v104
    v_max3_u32 v235, v235, v105, v106
    v_max3_u32 v235, v235, v107, v108
    v_max3_u32 v235, v235, v109, v110
    v_max_u32 v235, v235, v111
    v_cmp_eq_u32 vcc, -1, v235
    s_sub_u32 s34, s34, 1
    s_cbranch_scc1 kc_r1o
    s_cbranch_vccnz kc_r1l
    s_branch kc_r1o
kc_r2:
    s_mov_b32 s34, 0x400000
kc_r2l:
    s_sleep 4
    buffer_load_dwordx4 v[160:163], v228, s[8:11], s38 offen offset:0 sc1
    buffer_load_dwordx4 v[164:167], v228, s[8:11], s38 offen offset:1024 sc1
    buffer_load_dwordx4 v[168:171], v228, s[8:11], s38 offen offset:2048 sc1
    buffer_load_dwordx4 v[172:175], v228, s[8:11], s38 offen offset:3072 sc1
    s_waitcnt vmcnt(0)
    v_max3_u32 v235, v160, v161, v162
    v_max3_u32 v235, v235, v163, v164
    v_max3_u32 v235, v235, v165, v166
    v_max3_u32 v235, v235, v167, v168
    v_max3_u32 v235, v235, v169, v170
    v_max3_u32 v235, v235, v171, v172
    v_max3_u32 v235, v235, v173, v174
    v_max_u32 v235, v235, v175
    v_cmp_eq_u32 vcc, -1, v235
    s_sub_u32 s34, s34, 1
    s_cbranch_scc1 kc_r2o
    s_cbranch_vccnz kc_r2l
    s_branch kc_r2o
kc_g:
    s_mov_b32 s34, 0x400000
    s_branch kc_gs1
kc_gs0:
    s_sleep 2
kc_gs1:
    buffer_load_dword v235, off, s[8:11], s45 sc1
    s_waitcnt vmcnt(0)
    v_cmp_ne_u32_e64 vcc, 8, v235
    s_sub_u32 s34, s34, 1
    s_cbranch_scc1 kc_gs2
    s_cbranch_vccnz kc_gs0
kc_gs2:
    s_branch kc_gr
kc_end:
ka_done:
    s_endpgm
kf_fix1:
    s_cmp_eq_u32 s33, 0
    s_cselect_b32 s24, 0, 0x74000000
    s_cselect_b32 s36, 0, 0x1000
    s_mov_b32 s33, 1
    v_subrev_f32 v230, s24, v243
    v_add_f32 v231, 0, v230
    v_min_f32 v64, v224, v231
    v_add_f32 v232, 0xf1800000, v230
    v_min_f32_e64 v65, v224, v232
    v_add_f32 v231, 0xf2000000, v230
    v_min_f32_e64 v66, v224, v231
    v_add_f32 v232, 0xf2400000, v230
    v_min_f32_e64 v67, v224, v232
    v_add_f32 v231, 0xf3000000, v230
    v_min_f32_e64 v68, v224, v231
    v_add_f32 v232, 0xf3100000, v230
    v_min_f32_e64 v69, v224, v232
    v_add_f32 v231, 0xf3200000, v230
    v_min_f32_e64 v70, v224, v231
    v_add_f32 v232, 0xf3300000, v230
    v_min_f32_e64 v71, v224, v232
    v_add_f32 v231, 0x73800000, v230
    v_min_f32_e64 v72, v225, v231
    v_add_f32 v232, 0x73700000, v230
    v_min_f32_e64 v73, v225, v232
    v_add_f32 v231, 0x73600000, v230
    v_min_f32_e64 v74, v225, v231
    v_add_f32 v232, 0x73500000, v230
    v_min_f32_e64 v75, v225, v232
    v_add_f32 v231, 0x73000000, v230
    v_min_f32_e64 v76, v225, v231
    v_add_f32 v232, 0x72e00000, v230
    v_min_f32_e64 v77, v225, v232
    v_add_f32 v231, 0x72c00000, v230
    v_min_f32_e64 v78, v225, v231
    v_add_f32 v232, 0x72a00000, v230
    v_min_f32 v79, v225, v232
    s_nop 1
    s_branch kf_fixr2
kf_fix3:
    s_cmp_eq_u32 s33, 0
    s_cselect_b32 s24, 0, 0x74000000
    s_cselect_b32 s36, 0, 0x1000
    s_mov_b32 s33, 1
    v_subrev_f32 v230, s24, v243
    v_add_f32 v231, 0, v230
    v_min_f32 v64, v224, v231
    v_add_f32 v232, 0xf1800000, v230
    v_min_f32_e64 v65, v224, v232
    v_add_f32 v231, 0xf2000000, v230
    v_min_f32_e64 v66, v224, v231
    v_add_f32 v232, 0xf2400000, v230
    v_min_f32_e64 v67, v224, v232
    v_add_f32 v231, 0xf3000000, v230
    v_min_f32_e64 v68, v224, v231
    v_add_f32 v232, 0xf3100000, v230
    v_min_f32_e64 v69, v224, v232
    v_add_f32 v231, 0xf3200000, v230
    v_min_f32_e64 v70, v224, v231
    v_add_f32 v232, 0xf3300000, v230
    v_min_f32_e64 v71, v224, v232
    v_add_f32 v231, 0x73800000, v230
    v_min_f32_e64 v72, v225, v231
    v_add_f32 v232, 0x73700000, v230
    v_min_f32_e64 v73, v225, v232
    v_add_f32 v231, 0x73600000, v230
    v_min_f32_e64 v74, v225, v231
    v_add_f32 v232, 0x73500000, v230
    v_min_f32_e64 v75, v225, v232
    v_add_f32 v231, 0x73000000, v230
    v_min_f32_e64 v76, v225, v231
    v_add_f32 v232, 0x72e00000, v230
    v_min_f32_e64 v77, v225, v232
    v_add_f32 v231, 0x72c00000, v230
    v_min_f32_e64 v78, v225, v231
    v_add_f32 v232, 0x72a00000, v230
    v_min_f32 v79, v225, v232
    s_nop 1
    s_branch kf_fixr4
kf_rare6:
    s_nop 15
    v_max3_f32 v230, v32, v33, v34
    v_max3_f32 v230, v230, v35, v36
    v_max3_f32 v230, v230, v37, v38
    v_max_f32 v230, v230, v39
    v_mov_b32 v231, v230
    s_nop 1
    v_permlane16_swap_b32 v230, v231
    s_nop 0
    v_max_f32 v230, v230, v231
    v_mov_b32 v231, v230
    s_nop 1
    v_permlane32_swap_b32 v230, v231
    s_nop 0
    v_max_f32_e64 v230, v230, v231
    v_add_f32 v230, 0x41800000, v230
    v_max_f32 v230, 0, v230
    v_sub_f32 v232, 0, v230
    v_exp_f32 v232, v232
    v_sub_f32 v224, v224, v230
    v_sub_f32 v64, v64, v230
    v_sub_f32 v0, v0, v230
    v_sub_f32 v32, v32, v230
    v_sub_f32 v65, v65, v230
    v_sub_f32 v1, v1, v230
    v_sub_f32 v33, v33, v230
    v_sub_f32 v66, v66, v230
    v_sub_f32 v2, v2, v230
    v_sub_f32 v34, v34, v230
    v_sub_f32 v67, v67, v230
    v_sub_f32 v3, v3, v230
    v_sub_f32 v35, v35, v230
    v_sub_f32 v68, v68, v230
    v_sub_f32 v4, v4, v230
    v_sub_f32 v36, v36, v230
    v_sub_f32 v69, v69, v230
    v_sub_f32 v5, v5, v230
    v_sub_f32 v37, v37, v230
    v_sub_f32 v70, v70, v230
    v_sub_f32 v6, v6, v230
    v_sub_f32 v38, v38, v230
    v_sub_f32 v71, v71, v230
    v_sub_f32 v7, v7, v230
    v_sub_f32 v39, v39, v230
    v_mul_f32 v144, v144, v232
    v_mul_f32 v145, v145, v232
    v_mul_f32 v146, v146, v232
    v_mul_f32 v147, v147, v232
    v_accvgpr_read_b32 v233, a0
    v_mul_f32_e64 v233, v233, v232
    v_accvgpr_write_b32 a0, v233
    v_accvgpr_read_b32 v234, a1
    v_mul_f32_e64 v234, v234, v232
    v_accvgpr_write_b32 a1, v234
    v_accvgpr_read_b32 v235, a2
    v_mul_f32_e64 v235, v235, v232
    v_accvgpr_write_b32 a2, v235
    v_accvgpr_read_b32 v236, a3
    v_mul_f32_e64 v236, v236, v232
    v_accvgpr_write_b32 a3, v236
    v_accvgpr_read_b32 v233, a4
    v_mul_f32_e64 v233, v233, v232
    v_accvgpr_write_b32 a4, v233
    v_accvgpr_read_b32 v234, a5
    v_mul_f32_e64 v234, v234, v232
    v_accvgpr_write_b32 a5, v234
    v_accvgpr_read_b32 v235, a6
    v_mul_f32_e64 v235, v235, v232
    v_accvgpr_write_b32 a6, v235
    v_accvgpr_read_b32 v236, a7
    v_mul_f32_e64 v236, v236, v232
    v_accvgpr_write_b32 a7, v236
    v_accvgpr_read_b32 v233, a8
    v_mul_f32_e64 v233, v233, v232
    v_accvgpr_write_b32 a8, v233
    v_accvgpr_read_b32 v234, a9
    v_mul_f32_e64 v234, v234, v232
    v_accvgpr_write_b32 a9, v234
    v_accvgpr_read_b32 v235, a10
    v_mul_f32_e64 v235, v235, v232
    v_accvgpr_write_b32 a10, v235
    v_accvgpr_read_b32 v236, a11
    v_mul_f32_e64 v236, v236, v232
    v_accvgpr_write_b32 a11, v236
    v_accvgpr_read_b32 v233, a12
    v_mul_f32_e64 v233, v233, v232
    v_accvgpr_write_b32 a12, v233
    v_accvgpr_read_b32 v234, a13
    v_mul_f32_e64 v234, v234, v232
    v_accvgpr_write_b32 a13, v234
    v_accvgpr_read_b32 v235, a14
    v_mul_f32_e64 v235, v235, v232
    v_accvgpr_write_b32 a14, v235
    v_accvgpr_read_b32 v236, a15
    v_mul_f32_e64 v236, v236, v232
    v_accvgpr_write_b32 a15, v236
    v_accvgpr_read_b32 v233, a16
    v_mul_f32_e64 v233, v233, v232
    v_accvgpr_write_b32 a16, v233
    v_accvgpr_read_b32 v234, a17
    v_mul_f32_e64 v234, v234, v232
    v_accvgpr_write_b32 a17, v234
    v_accvgpr_read_b32 v235, a18
    v_mul_f32_e64 v235, v235, v232
    v_accvgpr_write_b32 a18, v235
    v_accvgpr_read_b32 v236, a19
    v_mul_f32_e64 v236, v236, v232
    v_accvgpr_write_b32 a19, v236
    v_accvgpr_read_b32 v233, a20
    v_mul_f32_e64 v233, v233, v232
    v_accvgpr_write_b32 a20, v233
    v_accvgpr_read_b32 v234, a21
    v_mul_f32_e64 v234, v234, v232
    v_accvgpr_write_b32 a21, v234
    v_accvgpr_read_b32 v235, a22
    v_mul_f32_e64 v235, v235, v232
    v_accvgpr_write_b32 a22, v235
    v_accvgpr_read_b32 v236, a23
    v_mul_f32_e64 v236, v236, v232
    v_accvgpr_write_b32 a23, v236
    v_accvgpr_read_b32 v233, a24
    v_mul_f32_e64 v233, v233, v232
    v_accvgpr_write_b32 a24, v233
    v_accvgpr_read_b32 v234, a25
    v_mul_f32_e64 v234, v234, v232
    v_accvgpr_write_b32 a25, v234
    v_accvgpr_read_b32 v235, a26
    v_mul_f32_e64 v235, v235, v232
    v_accvgpr_write_b32 a26, v235
    v_accvgpr_read_b32 v236, a27
    v_mul_f32_e64 v236, v236, v232
    v_accvgpr_write_b32 a27, v236
    v_accvgpr_read_b32 v233, a28
    v_mul_f32_e64 v233, v233, v232
    v_accvgpr_write_b32 a28, v233
    v_accvgpr_read_b32 v234, a29
    v_mul_f32_e64 v234, v234, v232
    v_accvgpr_write_b32 a29, v234
    v_accvgpr_read_b32 v235, a30
    v_mul_f32_e64 v235, v235, v232
    v_accvgpr_write_b32 a30, v235
    v_accvgpr_read_b32 v236, a31
    v_mul_f32_e64 v236, v236, v232
    v_accvgpr_write_b32 a31, v236
    v_exp_f32 v128, v32
    v_exp_f32 v129, v33
    v_exp_f32 v130, v34
    v_exp_f32 v131, v35
    v_exp_f32 v132, v36
    v_exp_f32 v133, v37
    v_exp_f32 v134, v38
    v_exp_f32_e64 v135, v39
    s_nop 0
    v_cvt_pk_bf16_f32 v112, v128, v129
    v_cvt_pk_bf16_f32 v113, v130, v131
    v_cvt_pk_bf16_f32 v114, v132, v133
    v_cvt_pk_bf16_f32 v115, v134, v135
    v_max3_f32 v230, v40, v41, v42
    v_max3_f32 v230, v230, v43, v44
    v_max3_f32 v230, v230, v45, v46
    v_max_f32 v230, v230, v47
    v_mov_b32 v231, v230
    s_nop 1
    v_permlane16_swap_b32 v230, v231
    s_nop 0
    v_max_f32 v230, v230, v231
    v_mov_b32 v231, v230
    s_nop 1
    v_permlane32_swap_b32 v230, v231
    s_nop 0
    v_max_f32_e64 v230, v230, v231
    v_add_f32 v230, 0x41800000, v230
    v_max_f32 v230, 0, v230
    v_sub_f32 v232, 0, v230
    v_exp_f32 v232, v232
    v_sub_f32 v225, v225, v230
    v_sub_f32 v72, v72, v230
    v_sub_f32 v8, v8, v230
    v_sub_f32 v40, v40, v230
    v_sub_f32 v73, v73, v230
    v_sub_f32 v9, v9, v230
    v_sub_f32 v41, v41, v230
    v_sub_f32 v74, v74, v230
    v_sub_f32 v10, v10, v230
    v_sub_f32 v42, v42, v230
    v_sub_f32 v75, v75, v230
    v_sub_f32 v11, v11, v230
    v_sub_f32 v43, v43, v230
    v_sub_f32 v76, v76, v230
    v_sub_f32 v12, v12, v230
    v_sub_f32 v44, v44, v230
    v_sub_f32 v77, v77, v230
    v_sub_f32 v13, v13, v230
    v_sub_f32 v45, v45, v230
    v_sub_f32 v78, v78, v230
    v_sub_f32 v14, v14, v230
    v_sub_f32 v46, v46, v230
    v_sub_f32 v79, v79, v230
    v_sub_f32 v15, v15, v230
    v_sub_f32 v47, v47, v230
    v_mul_f32 v148, v148, v232
    v_mul_f32 v149, v149, v232
    v_mul_f32 v150, v150, v232
    v_mul_f32 v151, v151, v232
    v_accvgpr_read_b32 v233, a32
    v_mul_f32_e64 v233, v233, v232
    v_accvgpr_write_b32 a32, v233
    v_accvgpr_read_b32 v234, a33
    v_mul_f32_e64 v234, v234, v232
    v_accvgpr_write_b32 a33, v234
    v_accvgpr_read_b32 v235, a34
    v_mul_f32_e64 v235, v235, v232
    v_accvgpr_write_b32 a34, v235
    v_accvgpr_read_b32 v236, a35
    v_mul_f32_e64 v236, v236, v232
    v_accvgpr_write_b32 a35, v236
    v_accvgpr_read_b32 v233, a36
    v_mul_f32_e64 v233, v233, v232
    v_accvgpr_write_b32 a36, v233
    v_accvgpr_read_b32 v234, a37
    v_mul_f32_e64 v234, v234, v232
    v_accvgpr_write_b32 a37, v234
    v_accvgpr_read_b32 v235, a38
    v_mul_f32_e64 v235, v235, v232
    v_accvgpr_write_b32 a38, v235
    v_accvgpr_read_b32 v236, a39
    v_mul_f32_e64 v236, v236, v232
    v_accvgpr_write_b32 a39, v236
    v_accvgpr_read_b32 v233, a40
    v_mul_f32_e64 v233, v233, v232
    v_accvgpr_write_b32 a40, v233
    v_accvgpr_read_b32 v234, a41
    v_mul_f32_e64 v234, v234, v232
    v_accvgpr_write_b32 a41, v234
    v_accvgpr_read_b32 v235, a42
    v_mul_f32_e64 v235, v235, v232
    v_accvgpr_write_b32 a42, v235
    v_accvgpr_read_b32 v236, a43
    v_mul_f32_e64 v236, v236, v232
    v_accvgpr_write_b32 a43, v236
    v_accvgpr_read_b32 v233, a44
    v_mul_f32_e64 v233, v233, v232
    v_accvgpr_write_b32 a44, v233
    v_accvgpr_read_b32 v234, a45
    v_mul_f32_e64 v234, v234, v232
    v_accvgpr_write_b32 a45, v234
    v_accvgpr_read_b32 v235, a46
    v_mul_f32_e64 v235, v235, v232
    v_accvgpr_write_b32 a46, v235
    v_accvgpr_read_b32 v236, a47
    v_mul_f32_e64 v236, v236, v232
    v_accvgpr_write_b32 a47, v236
    v_accvgpr_read_b32 v233, a48
    v_mul_f32_e64 v233, v233, v232
    v_accvgpr_write_b32 a48, v233
    v_accvgpr_read_b32 v234, a49
    v_mul_f32_e64 v234, v234, v232
    v_accvgpr_write_b32 a49, v234
    v_accvgpr_read_b32 v235, a50
    v_mul_f32_e64 v235, v235, v232
    v_accvgpr_write_b32 a50, v235
    v_accvgpr_read_b32 v236, a51
    v_mul_f32_e64 v236, v236, v232
    v_accvgpr_write_b32 a51, v236
    v_accvgpr_read_b32 v233, a52
    v_mul_f32_e64 v233, v233, v232
    v_accvgpr_write_b32 a52, v233
    v_accvgpr_read_b32 v234, a53
    v_mul_f32_e64 v234, v234, v232
    v_accvgpr_write_b32 a53, v234
    v_accvgpr_read_b32 v235, a54
    v_mul_f32_e64 v235, v235, v232
    v_accvgpr_write_b32 a54, v235
    v_accvgpr_read_b32 v236, a55
    v_mul_f32_e64 v236, v236, v232
    v_accvgpr_write_b32 a55, v236
    v_accvgpr_read_b32 v233, a56
    v_mul_f32_e64 v233, v233, v232
    v_accvgpr_write_b32 a56, v233
    v_accvgpr_read_b32 v234, a57
    v_mul_f32_e64 v234, v234, v232
    v_accvgpr_write_b32 a57, v234
    v_accvgpr_read_b32 v235, a58
    v_mul_f32_e64 v235, v235, v232
    v_accvgpr_write_b32 a58, v235
    v_accvgpr_read_b32 v236, a59
    v_mul_f32_e64 v236, v236, v232
    v_accvgpr_write_b32 a59, v236
    v_accvgpr_read_b32 v233, a60
    v_mul_f32_e64 v233, v233, v232
    v_accvgpr_write_b32 a60, v233
    v_accvgpr_read_b32 v234, a61
    v_mul_f32_e64 v234, v234, v232
    v_accvgpr_write_b32 a61, v234
    v_accvgpr_read_b32 v235, a62
    v_mul_f32_e64 v235, v235, v232
    v_accvgpr_write_b32 a62, v235
    v_accvgpr_read_b32 v236, a63
    v_mul_f32_e64 v236, v236, v232
    v_accvgpr_write_b32 a63, v236
    v_exp_f32 v128, v40
    v_exp_f32 v129, v41
    v_exp_f32 v130, v42
    v_exp_f32 v131, v43
    v_exp_f32 v132, v44
    v_exp_f32 v133, v45
    v_exp_f32 v134, v46
    v_exp_f32_e64 v135, v47
    s_nop 0
    v_cvt_pk_bf16_f32 v116, v128, v129
    v_cvt_pk_bf16_f32 v117, v130, v131
    v_cvt_pk_bf16_f32 v118, v132, v133
    v_cvt_pk_bf16_f32 v119, v134, v135
    v_max3_f32 v230, v48, v49, v50
    v_max3_f32 v230, v230, v51, v52
    v_max3_f32 v230, v230, v53, v54
    v_max_f32 v230, v230, v55
    v_mov_b32 v231, v230
    s_nop 1
    v_permlane16_swap_b32 v230, v231
    s_nop 0
    v_max_f32 v230, v230, v231
    v_mov_b32 v231, v230
    s_nop 1
    v_permlane32_swap_b32 v230, v231
    s_nop 0
    v_max_f32_e64 v230, v230, v231
    v_add_f32 v230, 0x41800000, v230
    v_max_f32 v230, 0, v230
    v_sub_f32 v232, 0, v230
    v_exp_f32 v232, v232
    v_sub_f32 v226, v226, v230
    v_sub_f32 v80, v80, v230
    v_sub_f32 v16, v16, v230
    v_sub_f32 v48, v48, v230
    v_sub_f32 v81, v81, v230
    v_sub_f32 v17, v17, v230
    v_sub_f32 v49, v49, v230
    v_sub_f32 v82, v82, v230
    v_sub_f32 v18, v18, v230
    v_sub_f32 v50, v50, v230
    v_sub_f32 v83, v83, v230
    v_sub_f32 v19, v19, v230
    v_sub_f32 v51, v51, v230
    v_sub_f32 v84, v84, v230
    v_sub_f32 v20, v20, v230
    v_sub_f32 v52, v52, v230
    v_sub_f32 v85, v85, v230
    v_sub_f32 v21, v21, v230
    v_sub_f32 v53, v53, v230
    v_sub_f32 v86, v86, v230
    v_sub_f32 v22, v22, v230
    v_sub_f32 v54, v54, v230
    v_sub_f32 v87, v87, v230
    v_sub_f32 v23, v23, v230
    v_sub_f32 v55, v55, v230
    v_mul_f32 v152, v152, v232
    v_mul_f32 v153, v153, v232
    v_mul_f32 v154, v154, v232
    v_mul_f32 v155, v155, v232
    v_accvgpr_read_b32 v233, a64
    v_mul_f32_e64 v233, v233, v232
    v_accvgpr_write_b32 a64, v233
    v_accvgpr_read_b32 v234, a65
    v_mul_f32_e64 v234, v234, v232
    v_accvgpr_write_b32 a65, v234
    v_accvgpr_read_b32 v235, a66
    v_mul_f32_e64 v235, v235, v232
    v_accvgpr_write_b32 a66, v235
    v_accvgpr_read_b32 v236, a67
    v_mul_f32_e64 v236, v236, v232
    v_accvgpr_write_b32 a67, v236
    v_accvgpr_read_b32 v233, a68
    v_mul_f32_e64 v233, v233, v232
    v_accvgpr_write_b32 a68, v233
    v_accvgpr_read_b32 v234, a69
    v_mul_f32_e64 v234, v234, v232
    v_accvgpr_write_b32 a69, v234
    v_accvgpr_read_b32 v235, a70
    v_mul_f32_e64 v235, v235, v232
    v_accvgpr_write_b32 a70, v235
    v_accvgpr_read_b32 v236, a71
    v_mul_f32_e64 v236, v236, v232
    v_accvgpr_write_b32 a71, v236
    v_accvgpr_read_b32 v233, a72
    v_mul_f32_e64 v233, v233, v232
    v_accvgpr_write_b32 a72, v233
    v_accvgpr_read_b32 v234, a73
    v_mul_f32_e64 v234, v234, v232
    v_accvgpr_write_b32 a73, v234
    v_accvgpr_read_b32 v235, a74
    v_mul_f32_e64 v235, v235, v232
    v_accvgpr_write_b32 a74, v235
    v_accvgpr_read_b32 v236, a75
    v_mul_f32_e64 v236, v236, v232
    v_accvgpr_write_b32 a75, v236
    v_accvgpr_read_b32 v233, a76
    v_mul_f32_e64 v233, v233, v232
    v_accvgpr_write_b32 a76, v233
    v_accvgpr_read_b32 v234, a77
    v_mul_f32_e64 v234, v234, v232
    v_accvgpr_write_b32 a77, v234
    v_accvgpr_read_b32 v235, a78
    v_mul_f32_e64 v235, v235, v232
    v_accvgpr_write_b32 a78, v235
    v_accvgpr_read_b32 v236, a79
    v_mul_f32_e64 v236, v236, v232
    v_accvgpr_write_b32 a79, v236
    v_accvgpr_read_b32 v233, a80
    v_mul_f32_e64 v233, v233, v232
    v_accvgpr_write_b32 a80, v233
    v_accvgpr_read_b32 v234, a81
    v_mul_f32_e64 v234, v234, v232
    v_accvgpr_write_b32 a81, v234
    v_accvgpr_read_b32 v235, a82
    v_mul_f32_e64 v235, v235, v232
    v_accvgpr_write_b32 a82, v235
    v_accvgpr_read_b32 v236, a83
    v_mul_f32_e64 v236, v236, v232
    v_accvgpr_write_b32 a83, v236
    v_accvgpr_read_b32 v233, a84
    v_mul_f32_e64 v233, v233, v232
    v_accvgpr_write_b32 a84, v233
    v_accvgpr_read_b32 v234, a85
    v_mul_f32_e64 v234, v234, v232
    v_accvgpr_write_b32 a85, v234
    v_accvgpr_read_b32 v235, a86
    v_mul_f32_e64 v235, v235, v232
    v_accvgpr_write_b32 a86, v235
    v_accvgpr_read_b32 v236, a87
    v_mul_f32_e64 v236, v236, v232
    v_accvgpr_write_b32 a87, v236
    v_accvgpr_read_b32 v233, a88
    v_mul_f32_e64 v233, v233, v232
    v_accvgpr_write_b32 a88, v233
    v_accvgpr_read_b32 v234, a89
    v_mul_f32_e64 v234, v234, v232
    v_accvgpr_write_b32 a89, v234
    v_accvgpr_read_b32 v235, a90
    v_mul_f32_e64 v235, v235, v232
    v_accvgpr_write_b32 a90, v235
    v_accvgpr_read_b32 v236, a91
    v_mul_f32_e64 v236, v236, v232
    v_accvgpr_write_b32 a91, v236
    v_accvgpr_read_b32 v233, a92
    v_mul_f32_e64 v233, v233, v232
    v_accvgpr_write_b32 a92, v233
    v_accvgpr_read_b32 v234, a93
    v_mul_f32_e64 v234, v234, v232
    v_accvgpr_write_b32 a93, v234
    v_accvgpr_read_b32 v235, a94
    v_mul_f32_e64 v235, v235, v232
    v_accvgpr_write_b32 a94, v235
    v_accvgpr_read_b32 v236, a95
    v_mul_f32_e64 v236, v236, v232
    v_accvgpr_write_b32 a95, v236
    v_exp_f32 v128, v48
    v_exp_f32 v129, v49
    v_exp_f32 v130, v50
    v_exp_f32 v131, v51
    v_exp_f32 v132, v52
    v_exp_f32 v133, v53
    v_exp_f32 v134, v54
    v_exp_f32_e64 v135, v55
    s_nop 0
    v_cvt_pk_bf16_f32 v120, v128, v129
    v_cvt_pk_bf16_f32 v121, v130, v131
    v_cvt_pk_bf16_f32 v122, v132, v133
    v_cvt_pk_bf16_f32 v123, v134, v135
    v_max3_f32 v230, v56, v57, v58
    v_max3_f32 v230, v230, v59, v60
    v_max3_f32 v230, v230, v61, v62
    v_max_f32 v230, v230, v63
    v_mov_b32 v231, v230
    s_nop 1
    v_permlane16_swap_b32 v230, v231
    s_nop 0
    v_max_f32 v230, v230, v231
    v_mov_b32 v231, v230
    s_nop 1
    v_permlane32_swap_b32 v230, v231
    s_nop 0
    v_max_f32_e64 v230, v230, v231
    v_add_f32 v230, 0x41800000, v230
    v_max_f32 v230, 0, v230
    v_sub_f32 v232, 0, v230
    v_exp_f32 v232, v232
    v_sub_f32 v227, v227, v230
    v_sub_f32 v88, v88, v230
    v_sub_f32 v24, v24, v230
    v_sub_f32 v56, v56, v230
    v_sub_f32 v89, v89, v230
    v_sub_f32 v25, v25, v230
    v_sub_f32 v57, v57, v230
    v_sub_f32 v90, v90, v230
    v_sub_f32 v26, v26, v230
    v_sub_f32 v58, v58, v230
    v_sub_f32 v91, v91, v230
    v_sub_f32 v27, v27, v230
    v_sub_f32 v59, v59, v230
    v_sub_f32 v92, v92, v230
    v_sub_f32 v28, v28, v230
    v_sub_f32 v60, v60, v230
    v_sub_f32 v93, v93, v230
    v_sub_f32 v29, v29, v230
    v_sub_f32 v61, v61, v230
    v_sub_f32 v94, v94, v230
    v_sub_f32 v30, v30, v230
    v_sub_f32 v62, v62, v230
    v_sub_f32 v95, v95, v230
    v_sub_f32 v31, v31, v230
    v_sub_f32 v63, v63, v230
    v_mul_f32 v156, v156, v232
    v_mul_f32 v157, v157, v232
    v_mul_f32 v158, v158, v232
    v_mul_f32 v159, v159, v232
    v_accvgpr_read_b32 v233, a96
    v_mul_f32_e64 v233, v233, v232
    v_accvgpr_write_b32 a96, v233
    v_accvgpr_read_b32 v234, a97
    v_mul_f32_e64 v234, v234, v232
    v_accvgpr_write_b32 a97, v234
    v_accvgpr_read_b32 v235, a98
    v_mul_f32_e64 v235, v235, v232
    v_accvgpr_write_b32 a98, v235
    v_accvgpr_read_b32 v236, a99
    v_mul_f32_e64 v236, v236, v232
    v_accvgpr_write_b32 a99, v236
    v_accvgpr_read_b32 v233, a100
    v_mul_f32_e64 v233, v233, v232
    v_accvgpr_write_b32 a100, v233
    v_accvgpr_read_b32 v234, a101
    v_mul_f32_e64 v234, v234, v232
    v_accvgpr_write_b32 a101, v234
    v_accvgpr_read_b32 v235, a102
    v_mul_f32_e64 v235, v235, v232
    v_accvgpr_write_b32 a102, v235
    v_accvgpr_read_b32 v236, a103
    v_mul_f32_e64 v236, v236, v232
    v_accvgpr_write_b32 a103, v236
    v_accvgpr_read_b32 v233, a104
    v_mul_f32_e64 v233, v233, v232
    v_accvgpr_write_b32 a104, v233
    v_accvgpr_read_b32 v234, a105
    v_mul_f32_e64 v234, v234, v232
    v_accvgpr_write_b32 a105, v234
    v_accvgpr_read_b32 v235, a106
    v_mul_f32_e64 v235, v235, v232
    v_accvgpr_write_b32 a106, v235
    v_accvgpr_read_b32 v236, a107
    v_mul_f32_e64 v236, v236, v232
    v_accvgpr_write_b32 a107, v236
    v_accvgpr_read_b32 v233, a108
    v_mul_f32_e64 v233, v233, v232
    v_accvgpr_write_b32 a108, v233
    v_accvgpr_read_b32 v234, a109
    v_mul_f32_e64 v234, v234, v232
    v_accvgpr_write_b32 a109, v234
    v_accvgpr_read_b32 v235, a110
    v_mul_f32_e64 v235, v235, v232
    v_accvgpr_write_b32 a110, v235
    v_accvgpr_read_b32 v236, a111
    v_mul_f32_e64 v236, v236, v232
    v_accvgpr_write_b32 a111, v236
    v_accvgpr_read_b32 v233, a112
    v_mul_f32_e64 v233, v233, v232
    v_accvgpr_write_b32 a112, v233
    v_accvgpr_read_b32 v234, a113
    v_mul_f32_e64 v234, v234, v232
    v_accvgpr_write_b32 a113, v234
    v_accvgpr_read_b32 v235, a114
    v_mul_f32_e64 v235, v235, v232
    v_accvgpr_write_b32 a114, v235
    v_accvgpr_read_b32 v236, a115
    v_mul_f32_e64 v236, v236, v232
    v_accvgpr_write_b32 a115, v236
    v_accvgpr_read_b32 v233, a116
    v_mul_f32_e64 v233, v233, v232
    v_accvgpr_write_b32 a116, v233
    v_accvgpr_read_b32 v234, a117
    v_mul_f32_e64 v234, v234, v232
    v_accvgpr_write_b32 a117, v234
    v_accvgpr_read_b32 v235, a118
    v_mul_f32_e64 v235, v235, v232
    v_accvgpr_write_b32 a118, v235
    v_accvgpr_read_b32 v236, a119
    v_mul_f32_e64 v236, v236, v232
    v_accvgpr_write_b32 a119, v236
    v_accvgpr_read_b32 v233, a120
    v_mul_f32_e64 v233, v233, v232
    v_accvgpr_write_b32 a120, v233
    v_accvgpr_read_b32 v234, a121
    v_mul_f32_e64 v234, v234, v232
    v_accvgpr_write_b32 a121, v234
    v_accvgpr_read_b32 v235, a122
    v_mul_f32_e64 v235, v235, v232
    v_accvgpr_write_b32 a122, v235
    v_accvgpr_read_b32 v236, a123
    v_mul_f32_e64 v236, v236, v232
    v_accvgpr_write_b32 a123, v236
    v_accvgpr_read_b32 v233, a124
    v_mul_f32_e64 v233, v233, v232
    v_accvgpr_write_b32 a124, v233
    v_accvgpr_read_b32 v234, a125
    v_mul_f32_e64 v234, v234, v232
    v_accvgpr_write_b32 a125, v234
    v_accvgpr_read_b32 v235, a126
    v_mul_f32_e64 v235, v235, v232
    v_accvgpr_write_b32 a126, v235
    v_accvgpr_read_b32 v236, a127
    v_mul_f32_e64 v236, v236, v232
    v_accvgpr_write_b32 a127, v236
    v_exp_f32 v128, v56
    v_exp_f32 v129, v57
    v_exp_f32 v130, v58
    v_exp_f32 v131, v59
    v_exp_f32 v132, v60
    v_exp_f32 v133, v61
    v_exp_f32 v134, v62
    v_exp_f32_e64 v135, v63
    s_nop 0
    v_cvt_pk_bf16_f32 v124, v128, v129
    v_cvt_pk_bf16_f32 v125, v130, v131
    v_cvt_pk_bf16_f32 v126, v132, v133
    v_cvt_pk_bf16_f32 v127, v134, v135
    s_nop 1
    s_branch kf_rr5
kf_rare10:
    s_nop 15
    v_max3_f32 v230, v0, v1, v2
    v_max3_f32 v230, v230, v3, v4
    v_max3_f32 v230, v230, v5, v6
    v_max_f32 v230, v230, v7
    v_mov_b32 v231, v230
    s_nop 1
    v_permlane16_swap_b32 v230, v231
    s_nop 0
    v_max_f32 v230, v230, v231
    v_mov_b32 v231, v230
    s_nop 1
    v_permlane32_swap_b32 v230, v231
    s_nop 0
    v_max_f32 v230, v230, v231
    v_add_f32 v230, 0x41800000, v230
    v_max_f32 v230, 0, v230
    v_sub_f32 v232, 0, v230
    v_exp_f32 v232, v232
    v_sub_f32 v224, v224, v230
    v_sub_f32 v64, v64, v230
    v_sub_f32 v32, v32, v230
    v_sub_f32 v0, v0, v230
    v_sub_f32 v65, v65, v230
    v_sub_f32 v33, v33, v230
    v_sub_f32 v1, v1, v230
    v_sub_f32 v66, v66, v230
    v_sub_f32 v34, v34, v230
    v_sub_f32 v2, v2, v230
    v_sub_f32 v67, v67, v230
    v_sub_f32 v35, v35, v230
    v_sub_f32 v3, v3, v230
    v_sub_f32 v68, v68, v230
    v_sub_f32 v36, v36, v230
    v_sub_f32 v4, v4, v230
    v_sub_f32 v69, v69, v230
    v_sub_f32 v37, v37, v230
    v_sub_f32 v5, v5, v230
    v_sub_f32 v70, v70, v230
    v_sub_f32 v38, v38, v230
    v_sub_f32 v6, v6, v230
    v_sub_f32 v71, v71, v230
    v_sub_f32 v39, v39, v230
    v_sub_f32 v7, v7, v230
    v_mul_f32 v144, v144, v232
    v_mul_f32 v145, v145, v232
    v_mul_f32 v146, v146, v232
    v_mul_f32 v147, v147, v232
    v_accvgpr_read_b32 v233, a0
    v_mul_f32_e64 v233, v233, v232
    v_accvgpr_write_b32 a0, v233
    v_accvgpr_read_b32 v234, a1
    v_mul_f32_e64 v234, v234, v232
    v_accvgpr_write_b32 a1, v234
    v_accvgpr_read_b32 v235, a2
    v_mul_f32_e64 v235, v235, v232
    v_accvgpr_write_b32 a2, v235
    v_accvgpr_read_b32 v236, a3
    v_mul_f32_e64 v236, v236, v232
    v_accvgpr_write_b32 a3, v236
    v_accvgpr_read_b32 v233, a4
    v_mul_f32_e64 v233, v233, v232
    v_accvgpr_write_b32 a4, v233
    v_accvgpr_read_b32 v234, a5
    v_mul_f32_e64 v234, v234, v232
    v_accvgpr_write_b32 a5, v234
    v_accvgpr_read_b32 v235, a6
    v_mul_f32_e64 v235, v235, v232
    v_accvgpr_write_b32 a6, v235
    v_accvgpr_read_b32 v236, a7
    v_mul_f32_e64 v236, v236, v232
    v_accvgpr_write_b32 a7, v236
    v_accvgpr_read_b32 v233, a8
    v_mul_f32_e64 v233, v233, v232
    v_accvgpr_write_b32 a8, v233
    v_accvgpr_read_b32 v234, a9
    v_mul_f32_e64 v234, v234, v232
    v_accvgpr_write_b32 a9, v234
    v_accvgpr_read_b32 v235, a10
    v_mul_f32_e64 v235, v235, v232
    v_accvgpr_write_b32 a10, v235
    v_accvgpr_read_b32 v236, a11
    v_mul_f32_e64 v236, v236, v232
    v_accvgpr_write_b32 a11, v236
    v_accvgpr_read_b32 v233, a12
    v_mul_f32_e64 v233, v233, v232
    v_accvgpr_write_b32 a12, v233
    v_accvgpr_read_b32 v234, a13
    v_mul_f32_e64 v234, v234, v232
    v_accvgpr_write_b32 a13, v234
    v_accvgpr_read_b32 v235, a14
    v_mul_f32_e64 v235, v235, v232
    v_accvgpr_write_b32 a14, v235
    v_accvgpr_read_b32 v236, a15
    v_mul_f32_e64 v236, v236, v232
    v_accvgpr_write_b32 a15, v236
    v_accvgpr_read_b32 v233, a16
    v_mul_f32_e64 v233, v233, v232
    v_accvgpr_write_b32 a16, v233
    v_accvgpr_read_b32 v234, a17
    v_mul_f32_e64 v234, v234, v232
    v_accvgpr_write_b32 a17, v234
    v_accvgpr_read_b32 v235, a18
    v_mul_f32_e64 v235, v235, v232
    v_accvgpr_write_b32 a18, v235
    v_accvgpr_read_b32 v236, a19
    v_mul_f32_e64 v236, v236, v232
    v_accvgpr_write_b32 a19, v236
    v_accvgpr_read_b32 v233, a20
    v_mul_f32_e64 v233, v233, v232
    v_accvgpr_write_b32 a20, v233
    v_accvgpr_read_b32 v234, a21
    v_mul_f32_e64 v234, v234, v232
    v_accvgpr_write_b32 a21, v234
    v_accvgpr_read_b32 v235, a22
    v_mul_f32_e64 v235, v235, v232
    v_accvgpr_write_b32 a22, v235
    v_accvgpr_read_b32 v236, a23
    v_mul_f32_e64 v236, v236, v232
    v_accvgpr_write_b32 a23, v236
    v_accvgpr_read_b32 v233, a24
    v_mul_f32_e64 v233, v233, v232
    v_accvgpr_write_b32 a24, v233
    v_accvgpr_read_b32 v234, a25
    v_mul_f32_e64 v234, v234, v232
    v_accvgpr_write_b32 a25, v234
    v_accvgpr_read_b32 v235, a26
    v_mul_f32_e64 v235, v235, v232
    v_accvgpr_write_b32 a26, v235
    v_accvgpr_read_b32 v236, a27
    v_mul_f32_e64 v236, v236, v232
    v_accvgpr_write_b32 a27, v236
    v_accvgpr_read_b32 v233, a28
    v_mul_f32_e64 v233, v233, v232
    v_accvgpr_write_b32 a28, v233
    v_accvgpr_read_b32 v234, a29
    v_mul_f32_e64 v234, v234, v232
    v_accvgpr_write_b32 a29, v234
    v_accvgpr_read_b32 v235, a30
    v_mul_f32_e64 v235, v235, v232
    v_accvgpr_write_b32 a30, v235
    v_accvgpr_read_b32 v236, a31
    v_mul_f32_e64 v236, v236, v232
    v_accvgpr_write_b32 a31, v236
    v_exp_f32 v128, v0
    v_exp_f32 v129, v1
    v_exp_f32 v130, v2
    v_exp_f32 v131, v3
    v_exp_f32 v132, v4
    v_exp_f32 v133, v5
    v_exp_f32 v134, v6
    v_exp_f32_e64 v135, v7
    s_nop 0
    v_cvt_pk_bf16_f32 v96, v128, v129
    v_cvt_pk_bf16_f32 v97, v130, v131
    v_cvt_pk_bf16_f32 v98, v132, v133
    v_cvt_pk_bf16_f32 v99, v134, v135
    v_max3_f32 v230, v8, v9, v10
    v_max3_f32 v230, v230, v11, v12
    v_max3_f32 v230, v230, v13, v14
    v_max_f32 v230, v230, v15
    v_mov_b32 v231, v230
    s_nop 1
    v_permlane16_swap_b32 v230, v231
    s_nop 0
    v_max_f32 v230, v230, v231
    v_mov_b32 v231, v230
    s_nop 1
    v_permlane32_swap_b32 v230, v231
    s_nop 0
    v_max_f32_e64 v230, v230, v231
    v_add_f32 v230, 0x41800000, v230
    v_max_f32 v230, 0, v230
    v_sub_f32 v232, 0, v230
    v_exp_f32 v232, v232
    v_sub_f32 v225, v225, v230
    v_sub_f32 v72, v72, v230
    v_sub_f32 v40, v40, v230
    v_sub_f32 v8, v8, v230
    v_sub_f32 v73, v73, v230
    v_sub_f32 v41, v41, v230
    v_sub_f32 v9, v9, v230
    v_sub_f32 v74, v74, v230
    v_sub_f32 v42, v42, v230
    v_sub_f32 v10, v10, v230
    v_sub_f32 v75, v75, v230
    v_sub_f32 v43, v43, v230
    v_sub_f32 v11, v11, v230
    v_sub_f32 v76, v76, v230
    v_sub_f32 v44, v44, v230
    v_sub_f32 v12, v12, v230
    v_sub_f32 v77, v77, v230
    v_sub_f32 v45, v45, v230
    v_sub_f32 v13, v13, v230
    v_sub_f32 v78, v78, v230
    v_sub_f32 v46, v46, v230
    v_sub_f32 v14, v14, v230
    v_sub_f32 v79, v79, v230
    v_sub_f32 v47, v47, v230
    v_sub_f32 v15, v15, v230
    v_mul_f32 v148, v148, v232
    v_mul_f32 v149, v149, v232
    v_mul_f32 v150, v150, v232
    v_mul_f32 v151, v151, v232
    v_accvgpr_read_b32 v233, a32
    v_mul_f32_e64 v233, v233, v232
    v_accvgpr_write_b32 a32, v233
    v_accvgpr_read_b32 v234, a33
    v_mul_f32_e64 v234, v234, v232
    v_accvgpr_write_b32 a33, v234
    v_accvgpr_read_b32 v235, a34
    v_mul_f32_e64 v235, v235, v232
    v_accvgpr_write_b32 a34, v235
    v_accvgpr_read_b32 v236, a35
    v_mul_f32_e64 v236, v236, v232
    v_accvgpr_write_b32 a35, v236
    v_accvgpr_read_b32 v233, a36
    v_mul_f32_e64 v233, v233, v232
    v_accvgpr_write_b32 a36, v233
    v_accvgpr_read_b32 v234, a37
    v_mul_f32_e64 v234, v234, v232
    v_accvgpr_write_b32 a37, v234
    v_accvgpr_read_b32 v235, a38
    v_mul_f32_e64 v235, v235, v232
    v_accvgpr_write_b32 a38, v235
    v_accvgpr_read_b32 v236, a39
    v_mul_f32_e64 v236, v236, v232
    v_accvgpr_write_b32 a39, v236
    v_accvgpr_read_b32 v233, a40
    v_mul_f32_e64 v233, v233, v232
    v_accvgpr_write_b32 a40, v233
    v_accvgpr_read_b32 v234, a41
    v_mul_f32_e64 v234, v234, v232
    v_accvgpr_write_b32 a41, v234
    v_accvgpr_read_b32 v235, a42
    v_mul_f32_e64 v235, v235, v232
    v_accvgpr_write_b32 a42, v235
    v_accvgpr_read_b32 v236, a43
    v_mul_f32_e64 v236, v236, v232
    v_accvgpr_write_b32 a43, v236
    v_accvgpr_read_b32 v233, a44
    v_mul_f32_e64 v233, v233, v232
    v_accvgpr_write_b32 a44, v233
    v_accvgpr_read_b32 v234, a45
    v_mul_f32_e64 v234, v234, v232
    v_accvgpr_write_b32 a45, v234
    v_accvgpr_read_b32 v235, a46
    v_mul_f32_e64 v235, v235, v232
    v_accvgpr_write_b32 a46, v235
    v_accvgpr_read_b32 v236, a47
    v_mul_f32_e64 v236, v236, v232
    v_accvgpr_write_b32 a47, v236
    v_accvgpr_read_b32 v233, a48
    v_mul_f32_e64 v233, v233, v232
    v_accvgpr_write_b32 a48, v233
    v_accvgpr_read_b32 v234, a49
    v_mul_f32_e64 v234, v234, v232
    v_accvgpr_write_b32 a49, v234
    v_accvgpr_read_b32 v235, a50
    v_mul_f32_e64 v235, v235, v232
    v_accvgpr_write_b32 a50, v235
    v_accvgpr_read_b32 v236, a51
    v_mul_f32_e64 v236, v236, v232
    v_accvgpr_write_b32 a51, v236
    v_accvgpr_read_b32 v233, a52
    v_mul_f32_e64 v233, v233, v232
    v_accvgpr_write_b32 a52, v233
    v_accvgpr_read_b32 v234, a53
    v_mul_f32_e64 v234, v234, v232
    v_accvgpr_write_b32 a53, v234
    v_accvgpr_read_b32 v235, a54
    v_mul_f32_e64 v235, v235, v232
    v_accvgpr_write_b32 a54, v235
    v_accvgpr_read_b32 v236, a55
    v_mul_f32_e64 v236, v236, v232
    v_accvgpr_write_b32 a55, v236
    v_accvgpr_read_b32 v233, a56
    v_mul_f32_e64 v233, v233, v232
    v_accvgpr_write_b32 a56, v233
    v_accvgpr_read_b32 v234, a57
    v_mul_f32_e64 v234, v234, v232
    v_accvgpr_write_b32 a57, v234
    v_accvgpr_read_b32 v235, a58
    v_mul_f32_e64 v235, v235, v232
    v_accvgpr_write_b32 a58, v235
    v_accvgpr_read_b32 v236, a59
    v_mul_f32_e64 v236, v236, v232
    v_accvgpr_write_b32 a59, v236
    v_accvgpr_read_b32 v233, a60
    v_mul_f32_e64 v233, v233, v232
    v_accvgpr_write_b32 a60, v233
    v_accvgpr_read_b32 v234, a61
    v_mul_f32_e64 v234, v234, v232
    v_accvgpr_write_b32 a61, v234
    v_accvgpr_read_b32 v235, a62
    v_mul_f32_e64 v235, v235, v232
    v_accvgpr_write_b32 a62, v235
    v_accvgpr_read_b32 v236, a63
    v_mul_f32_e64 v236, v236, v232
    v_accvgpr_write_b32 a63, v236
    v_exp_f32 v128, v8
    v_exp_f32 v129, v9
    v_exp_f32 v130, v10
    v_exp_f32 v131, v11
    v_exp_f32 v132, v12
    v_exp_f32 v133, v13
    v_exp_f32 v134, v14
    v_exp_f32_e64 v135, v15
    s_nop 0
    v_cvt_pk_bf16_f32 v100, v128, v129
    v_cvt_pk_bf16_f32 v101, v130, v131
    v_cvt_pk_bf16_f32 v102, v132, v133
    v_cvt_pk_bf16_f32 v103, v134, v135
    v_max3_f32 v230, v16, v17, v18
    v_max3_f32 v230, v230, v19, v20
    v_max3_f32 v230, v230, v21, v22
    v_max_f32 v230, v230, v23
    v_mov_b32 v231, v230
    s_nop 1
    v_permlane16_swap_b32 v230, v231
    s_nop 0
    v_max_f32 v230, v230, v231
    v_mov_b32 v231, v230
    s_nop 1
    v_permlane32_swap_b32 v230, v231
    s_nop 0
    v_max_f32_e64 v230, v230, v231
    v_add_f32 v230, 0x41800000, v230
    v_max_f32 v230, 0, v230
    v_sub_f32 v232, 0, v230
    v_exp_f32 v232, v232
    v_sub_f32 v226, v226, v230
    v_sub_f32 v80, v80, v230
    v_sub_f32 v48, v48, v230
    v_sub_f32 v16, v16, v230
    v_sub_f32 v81, v81, v230
    v_sub_f32 v49, v49, v230
    v_sub_f32 v17, v17, v230
    v_sub_f32 v82, v82, v230
    v_sub_f32 v50, v50, v230
    v_sub_f32 v18, v18, v230
    v_sub_f32 v83, v83, v230
    v_sub_f32 v51, v51, v230
    v_sub_f32 v19, v19, v230
    v_sub_f32 v84, v84, v230
    v_sub_f32 v52, v52, v230
    v_sub_f32 v20, v20, v230
    v_sub_f32 v85, v85, v230
    v_sub_f32 v53, v53, v230
    v_sub_f32 v21, v21, v230
    v_sub_f32 v86, v86, v230
    v_sub_f32 v54, v54, v230
    v_sub_f32 v22, v22, v230
    v_sub_f32 v87, v87, v230
    v_sub_f32 v55, v55, v230
    v_sub_f32 v23, v23, v230
    v_mul_f32 v152, v152, v232
    v_mul_f32 v153, v153, v232
    v_mul_f32 v154, v154, v232
    v_mul_f32 v155, v155, v232
    v_accvgpr_read_b32 v233, a64
    v_mul_f32_e64 v233, v233, v232
    v_accvgpr_write_b32 a64, v233
    v_accvgpr_read_b32 v234, a65
    v_mul_f32_e64 v234, v234, v232
    v_accvgpr_write_b32 a65, v234
    v_accvgpr_read_b32 v235, a66
    v_mul_f32_e64 v235, v235, v232
    v_accvgpr_write_b32 a66, v235
    v_accvgpr_read_b32 v236, a67
    v_mul_f32_e64 v236, v236, v232
    v_accvgpr_write_b32 a67, v236
    v_accvgpr_read_b32 v233, a68
    v_mul_f32_e64 v233, v233, v232
    v_accvgpr_write_b32 a68, v233
    v_accvgpr_read_b32 v234, a69
    v_mul_f32_e64 v234, v234, v232
    v_accvgpr_write_b32 a69, v234
    v_accvgpr_read_b32 v235, a70
    v_mul_f32_e64 v235, v235, v232
    v_accvgpr_write_b32 a70, v235
    v_accvgpr_read_b32 v236, a71
    v_mul_f32_e64 v236, v236, v232
    v_accvgpr_write_b32 a71, v236
    v_accvgpr_read_b32 v233, a72
    v_mul_f32_e64 v233, v233, v232
    v_accvgpr_write_b32 a72, v233
    v_accvgpr_read_b32 v234, a73
    v_mul_f32_e64 v234, v234, v232
    v_accvgpr_write_b32 a73, v234
    v_accvgpr_read_b32 v235, a74
    v_mul_f32_e64 v235, v235, v232
    v_accvgpr_write_b32 a74, v235
    v_accvgpr_read_b32 v236, a75
    v_mul_f32_e64 v236, v236, v232
    v_accvgpr_write_b32 a75, v236
    v_accvgpr_read_b32 v233, a76
    v_mul_f32_e64 v233, v233, v232
    v_accvgpr_write_b32 a76, v233
    v_accvgpr_read_b32 v234, a77
    v_mul_f32_e64 v234, v234, v232
    v_accvgpr_write_b32 a77, v234
    v_accvgpr_read_b32 v235, a78
    v_mul_f32_e64 v235, v235, v232
    v_accvgpr_write_b32 a78, v235
    v_accvgpr_read_b32 v236, a79
    v_mul_f32_e64 v236, v236, v232
    v_accvgpr_write_b32 a79, v236
    v_accvgpr_read_b32 v233, a80
    v_mul_f32_e64 v233, v233, v232
    v_accvgpr_write_b32 a80, v233
    v_accvgpr_read_b32 v234, a81
    v_mul_f32_e64 v234, v234, v232
    v_accvgpr_write_b32 a81, v234
    v_accvgpr_read_b32 v235, a82
    v_mul_f32_e64 v235, v235, v232
    v_accvgpr_write_b32 a82, v235
    v_accvgpr_read_b32 v236, a83
    v_mul_f32_e64 v236, v236, v232
    v_accvgpr_write_b32 a83, v236
    v_accvgpr_read_b32 v233, a84
    v_mul_f32_e64 v233, v233, v232
    v_accvgpr_write_b32 a84, v233
    v_accvgpr_read_b32 v234, a85
    v_mul_f32_e64 v234, v234, v232
    v_accvgpr_write_b32 a85, v234
    v_accvgpr_read_b32 v235, a86
    v_mul_f32_e64 v235, v235, v232
    v_accvgpr_write_b32 a86, v235
    v_accvgpr_read_b32 v236, a87
    v_mul_f32_e64 v236, v236, v232
    v_accvgpr_write_b32 a87, v236
    v_accvgpr_read_b32 v233, a88
    v_mul_f32_e64 v233, v233, v232
    v_accvgpr_write_b32 a88, v233
    v_accvgpr_read_b32 v234, a89
    v_mul_f32_e64 v234, v234, v232
    v_accvgpr_write_b32 a89, v234
    v_accvgpr_read_b32 v235, a90
    v_mul_f32_e64 v235, v235, v232
    v_accvgpr_write_b32 a90, v235
    v_accvgpr_read_b32 v236, a91
    v_mul_f32_e64 v236, v236, v232
    v_accvgpr_write_b32 a91, v236
    v_accvgpr_read_b32 v233, a92
    v_mul_f32_e64 v233, v233, v232
    v_accvgpr_write_b32 a92, v233
    v_accvgpr_read_b32 v234, a93
    v_mul_f32_e64 v234, v234, v232
    v_accvgpr_write_b32 a93, v234
    v_accvgpr_read_b32 v235, a94
    v_mul_f32_e64 v235, v235, v232
    v_accvgpr_write_b32 a94, v235
    v_accvgpr_read_b32 v236, a95
    v_mul_f32_e64 v236, v236, v232
    v_accvgpr_write_b32 a95, v236
    v_exp_f32 v128, v16
    v_exp_f32 v129, v17
    v_exp_f32 v130, v18
    v_exp_f32 v131, v19
    v_exp_f32 v132, v20
    v_exp_f32 v133, v21
    v_exp_f32 v134, v22
    v_exp_f32_e64 v135, v23
    s_nop 0
    v_cvt_pk_bf16_f32 v104, v128, v129
    v_cvt_pk_bf16_f32 v105, v130, v131
    v_cvt_pk_bf16_f32 v106, v132, v133
    v_cvt_pk_bf16_f32 v107, v134, v135
    v_max3_f32 v230, v24, v25, v26
    v_max3_f32 v230, v230, v27, v28
    v_max3_f32 v230, v230, v29, v30
    v_max_f32 v230, v230, v31
    v_mov_b32 v231, v230
    s_nop 1
    v_permlane16_swap_b32 v230, v231
    s_nop 0
    v_max_f32 v230, v230, v231
    v_mov_b32 v231, v230
    s_nop 1
    v_permlane32_swap_b32 v230, v231
    s_nop 0
    v_max_f32_e64 v230, v230, v231
    v_add_f32 v230, 0x41800000, v230
    v_max_f32 v230, 0, v230
    v_sub_f32 v232, 0, v230
    v_exp_f32 v232, v232
    v_sub_f32 v227, v227, v230
    v_sub_f32 v88, v88, v230
    v_sub_f32 v56, v56, v230
    v_sub_f32 v24, v24, v230
    v_sub_f32 v89, v89, v230
    v_sub_f32 v57, v57, v230
    v_sub_f32 v25, v25, v230
    v_sub_f32 v90, v90, v230
    v_sub_f32 v58, v58, v230
    v_sub_f32 v26, v26, v230
    v_sub_f32 v91, v91, v230
    v_sub_f32 v59, v59, v230
    v_sub_f32 v27, v27, v230
    v_sub_f32 v92, v92, v230
    v_sub_f32 v60, v60, v230
    v_sub_f32 v28, v28, v230
    v_sub_f32 v93, v93, v230
    v_sub_f32 v61, v61, v230
    v_sub_f32 v29, v29, v230
    v_sub_f32 v94, v94, v230
    v_sub_f32 v62, v62, v230
    v_sub_f32 v30, v30, v230
    v_sub_f32 v95, v95, v230
    v_sub_f32 v63, v63, v230
    v_sub_f32 v31, v31, v230
    v_mul_f32 v156, v156, v232
    v_mul_f32 v157, v157, v232
    v_mul_f32 v158, v158, v232
    v_mul_f32 v159, v159, v232
    v_accvgpr_read_b32 v233, a96
    v_mul_f32_e64 v233, v233, v232
    v_accvgpr_write_b32 a96, v233
    v_accvgpr_read_b32 v234, a97
    v_mul_f32_e64 v234, v234, v232
    v_accvgpr_write_b32 a97, v234
    v_accvgpr_read_b32 v235, a98
    v_mul_f32_e64 v235, v235, v232
    v_accvgpr_write_b32 a98, v235
    v_accvgpr_read_b32 v236, a99
    v_mul_f32_e64 v236, v236, v232
    v_accvgpr_write_b32 a99, v236
    v_accvgpr_read_b32 v233, a100
    v_mul_f32_e64 v233, v233, v232
    v_accvgpr_write_b32 a100, v233
    v_accvgpr_read_b32 v234, a101
    v_mul_f32_e64 v234, v234, v232
    v_accvgpr_write_b32 a101, v234
    v_accvgpr_read_b32 v235, a102
    v_mul_f32_e64 v235, v235, v232
    v_accvgpr_write_b32 a102, v235
    v_accvgpr_read_b32 v236, a103
    v_mul_f32_e64 v236, v236, v232
    v_accvgpr_write_b32 a103, v236
    v_accvgpr_read_b32 v233, a104
    v_mul_f32_e64 v233, v233, v232
    v_accvgpr_write_b32 a104, v233
    v_accvgpr_read_b32 v234, a105
    v_mul_f32_e64 v234, v234, v232
    v_accvgpr_write_b32 a105, v234
    v_accvgpr_read_b32 v235, a106
    v_mul_f32_e64 v235, v235, v232
    v_accvgpr_write_b32 a106, v235
    v_accvgpr_read_b32 v236, a107
    v_mul_f32_e64 v236, v236, v232
    v_accvgpr_write_b32 a107, v236
    v_accvgpr_read_b32 v233, a108
    v_mul_f32_e64 v233, v233, v232
    v_accvgpr_write_b32 a108, v233
    v_accvgpr_read_b32 v234, a109
    v_mul_f32_e64 v234, v234, v232
    v_accvgpr_write_b32 a109, v234
    v_accvgpr_read_b32 v235, a110
    v_mul_f32_e64 v235, v235, v232
    v_accvgpr_write_b32 a110, v235
    v_accvgpr_read_b32 v236, a111
    v_mul_f32_e64 v236, v236, v232
    v_accvgpr_write_b32 a111, v236
    v_accvgpr_read_b32 v233, a112
    v_mul_f32_e64 v233, v233, v232
    v_accvgpr_write_b32 a112, v233
    v_accvgpr_read_b32 v234, a113
    v_mul_f32_e64 v234, v234, v232
    v_accvgpr_write_b32 a113, v234
    v_accvgpr_read_b32 v235, a114
    v_mul_f32_e64 v235, v235, v232
    v_accvgpr_write_b32 a114, v235
    v_accvgpr_read_b32 v236, a115
    v_mul_f32_e64 v236, v236, v232
    v_accvgpr_write_b32 a115, v236
    v_accvgpr_read_b32 v233, a116
    v_mul_f32_e64 v233, v233, v232
    v_accvgpr_write_b32 a116, v233
    v_accvgpr_read_b32 v234, a117
    v_mul_f32_e64 v234, v234, v232
    v_accvgpr_write_b32 a117, v234
    v_accvgpr_read_b32 v235, a118
    v_mul_f32_e64 v235, v235, v232
    v_accvgpr_write_b32 a118, v235
    v_accvgpr_read_b32 v236, a119
    v_mul_f32_e64 v236, v236, v232
    v_accvgpr_write_b32 a119, v236
    v_accvgpr_read_b32 v233, a120
    v_mul_f32_e64 v233, v233, v232
    v_accvgpr_write_b32 a120, v233
    v_accvgpr_read_b32 v234, a121
    v_mul_f32_e64 v234, v234, v232
    v_accvgpr_write_b32 a121, v234
    v_accvgpr_read_b32 v235, a122
    v_mul_f32_e64 v235, v235, v232
    v_accvgpr_write_b32 a122, v235
    v_accvgpr_read_b32 v236, a123
    v_mul_f32_e64 v236, v236, v232
    v_accvgpr_write_b32 a123, v236
    v_accvgpr_read_b32 v233, a124
    v_mul_f32_e64 v233, v233, v232
    v_accvgpr_write_b32 a124, v233
    v_accvgpr_read_b32 v234, a125
    v_mul_f32_e64 v234, v234, v232
    v_accvgpr_write_b32 a125, v234
    v_accvgpr_read_b32 v235, a126
    v_mul_f32_e64 v235, v235, v232
    v_accvgpr_write_b32 a126, v235
    v_accvgpr_read_b32 v236, a127
    v_mul_f32_e64 v236, v236, v232
    v_accvgpr_write_b32 a127, v236
    v_exp_f32 v128, v24
    v_exp_f32 v129, v25
    v_exp_f32 v130, v26
    v_exp_f32 v131, v27
    v_exp_f32 v132, v28
    v_exp_f32 v133, v29
    v_exp_f32 v134, v30
    v_exp_f32_e64 v135, v31
    s_nop 0
    v_cvt_pk_bf16_f32 v108, v128, v129
    v_cvt_pk_bf16_f32 v109, v130, v131
    v_cvt_pk_bf16_f32 v110, v132, v133
    v_cvt_pk_bf16_f32 v111, v134, v135
    s_nop 1
    s_branch kf_rr9
kf_rare14:
    s_nop 15
    v_max3_f32 v230, v32, v33, v34
    v_max3_f32 v230, v230, v35, v36
    v_max3_f32 v230, v230, v37, v38
    v_max_f32 v230, v230, v39
    v_mov_b32 v231, v230
    s_nop 1
    v_permlane16_swap_b32 v230, v231
    s_nop 0
    v_max_f32 v230, v230, v231
    v_mov_b32 v231, v230
    s_nop 1
    v_permlane32_swap_b32 v230, v231
    s_nop 0
    v_max_f32 v230, v230, v231
    v_add_f32 v230, 0x41800000, v230
    v_max_f32 v230, 0, v230
    v_sub_f32 v232, 0, v230
    v_exp_f32 v232, v232
    v_sub_f32 v224, v224, v230
    v_sub_f32 v64, v64, v230
    v_sub_f32 v0, v0, v230
    v_sub_f32 v32, v32, v230
    v_sub_f32 v65, v65, v230
    v_sub_f32 v1, v1, v230
    v_sub_f32 v33, v33, v230
    v_sub_f32 v66, v66, v230
    v_sub_f32 v2, v2, v230
    v_sub_f32 v34, v34, v230
    v_sub_f32 v67, v67, v230
    v_sub_f32 v3, v3, v230
    v_sub_f32 v35, v35, v230
    v_sub_f32 v68, v68, v230
    v_sub_f32 v4, v4, v230
    v_sub_f32 v36, v36, v230
    v_sub_f32 v69, v69, v230
    v_sub_f32 v5, v5, v230
    v_sub_f32 v37, v37, v230
    v_sub_f32 v70, v70, v230
    v_sub_f32 v6, v6, v230
    v_sub_f32 v38, v38, v230
    v_sub_f32 v71, v71, v230
    v_sub_f32 v7, v7, v230
    v_sub_f32 v39, v39, v230
    v_mul_f32 v144, v144, v232
    v_mul_f32 v145, v145, v232
    v_mul_f32 v146, v146, v232
    v_mul_f32 v147, v147, v232
    v_accvgpr_read_b32 v233, a0
    v_mul_f32_e64 v233, v233, v232
    v_accvgpr_write_b32 a0, v233
    v_accvgpr_read_b32 v234, a1
    v_mul_f32_e64 v234, v234, v232
    v_accvgpr_write_b32 a1, v234
    v_accvgpr_read_b32 v235, a2
    v_mul_f32_e64 v235, v235, v232
    v_accvgpr_write_b32 a2, v235
    v_accvgpr_read_b32 v236, a3
    v_mul_f32_e64 v236, v236, v232
    v_accvgpr_write_b32 a3, v236
    v_accvgpr_read_b32 v233, a4
    v_mul_f32_e64 v233, v233, v232
    v_accvgpr_write_b32 a4, v233
    v_accvgpr_read_b32 v234, a5
    v_mul_f32_e64 v234, v234, v232
    v_accvgpr_write_b32 a5, v234
    v_accvgpr_read_b32 v235, a6
    v_mul_f32_e64 v235, v235, v232
    v_accvgpr_write_b32 a6, v235
    v_accvgpr_read_b32 v236, a7
    v_mul_f32_e64 v236, v236, v232
    v_accvgpr_write_b32 a7, v236
    v_accvgpr_read_b32 v233, a8
    v_mul_f32_e64 v233, v233, v232
    v_accvgpr_write_b32 a8, v233
    v_accvgpr_read_b32 v234, a9
    v_mul_f32_e64 v234, v234, v232
    v_accvgpr_write_b32 a9, v234
    v_accvgpr_read_b32 v235, a10
    v_mul_f32_e64 v235, v235, v232
    v_accvgpr_write_b32 a10, v235
    v_accvgpr_read_b32 v236, a11
    v_mul_f32_e64 v236, v236, v232
    v_accvgpr_write_b32 a11, v236
    v_accvgpr_read_b32 v233, a12
    v_mul_f32_e64 v233, v233, v232
    v_accvgpr_write_b32 a12, v233
    v_accvgpr_read_b32 v234, a13
    v_mul_f32_e64 v234, v234, v232
    v_accvgpr_write_b32 a13, v234
    v_accvgpr_read_b32 v235, a14
    v_mul_f32_e64 v235, v235, v232
    v_accvgpr_write_b32 a14, v235
    v_accvgpr_read_b32 v236, a15
    v_mul_f32_e64 v236, v236, v232
    v_accvgpr_write_b32 a15, v236
    v_accvgpr_read_b32 v233, a16
    v_mul_f32_e64 v233, v233, v232
    v_accvgpr_write_b32 a16, v233
    v_accvgpr_read_b32 v234, a17
    v_mul_f32_e64 v234, v234, v232
    v_accvgpr_write_b32 a17, v234
    v_accvgpr_read_b32 v235, a18
    v_mul_f32_e64 v235, v235, v232
    v_accvgpr_write_b32 a18, v235
    v_accvgpr_read_b32 v236, a19
    v_mul_f32_e64 v236, v236, v232
    v_accvgpr_write_b32 a19, v236
    v_accvgpr_read_b32 v233, a20
    v_mul_f32_e64 v233, v233, v232
    v_accvgpr_write_b32 a20, v233
    v_accvgpr_read_b32 v234, a21
    v_mul_f32_e64 v234, v234, v232
    v_accvgpr_write_b32 a21, v234
    v_accvgpr_read_b32 v235, a22
    v_mul_f32_e64 v235, v235, v232
    v_accvgpr_write_b32 a22, v235
    v_accvgpr_read_b32 v236, a23
    v_mul_f32_e64 v236, v236, v232
    v_accvgpr_write_b32 a23, v236
    v_accvgpr_read_b32 v233, a24
    v_mul_f32_e64 v233, v233, v232
    v_accvgpr_write_b32 a24, v233
    v_accvgpr_read_b32 v234, a25
    v_mul_f32_e64 v234, v234, v232
    v_accvgpr_write_b32 a25, v234
    v_accvgpr_read_b32 v235, a26
    v_mul_f32_e64 v235, v235, v232
    v_accvgpr_write_b32 a26, v235
    v_accvgpr_read_b32 v236, a27
    v_mul_f32_e64 v236, v236, v232
    v_accvgpr_write_b32 a27, v236
    v_accvgpr_read_b32 v233, a28
    v_mul_f32_e64 v233, v233, v232
    v_accvgpr_write_b32 a28, v233
    v_accvgpr_read_b32 v234, a29
    v_mul_f32_e64 v234, v234, v232
    v_accvgpr_write_b32 a29, v234
    v_accvgpr_read_b32 v235, a30
    v_mul_f32_e64 v235, v235, v232
    v_accvgpr_write_b32 a30, v235
    v_accvgpr_read_b32 v236, a31
    v_mul_f32_e64 v236, v236, v232
    v_accvgpr_write_b32 a31, v236
    v_exp_f32 v128, v32
    v_exp_f32 v129, v33
    v_exp_f32 v130, v34
    v_exp_f32 v131, v35
    v_exp_f32 v132, v36
    v_exp_f32 v133, v37
    v_exp_f32 v134, v38
    v_exp_f32_e64 v135, v39
    s_nop 0
    v_cvt_pk_bf16_f32 v112, v128, v129
    v_cvt_pk_bf16_f32 v113, v130, v131
    v_cvt_pk_bf16_f32 v114, v132, v133
    v_cvt_pk_bf16_f32 v115, v134, v135
    v_max3_f32 v230, v40, v41, v42
    v_max3_f32 v230, v230, v43, v44
    v_max3_f32 v230, v230, v45, v46
    v_max_f32 v230, v230, v47
    v_mov_b32 v231, v230
    s_nop 1
    v_permlane16_swap_b32 v230, v231
    s_nop 0
    v_max_f32 v230, v230, v231
    v_mov_b32 v231, v230
    s_nop 1
    v_permlane32_swap_b32 v230, v231
    s_nop 0
    v_max_f32_e64 v230, v230, v231
    v_add_f32 v230, 0x41800000, v230
    v_max_f32 v230, 0, v230
    v_sub_f32 v232, 0, v230
    v_exp_f32 v232, v232
    v_sub_f32 v225, v225, v230
    v_sub_f32 v72, v72, v230
    v_sub_f32 v8, v8, v230
    v_sub_f32 v40, v40, v230
    v_sub_f32 v73, v73, v230
    v_sub_f32 v9, v9, v230
    v_sub_f32 v41, v41, v230
    v_sub_f32 v74, v74, v230
    v_sub_f32 v10, v10, v230
    v_sub_f32 v42, v42, v230
    v_sub_f32 v75, v75, v230
    v_sub_f32 v11, v11, v230
    v_sub_f32 v43, v43, v230
    v_sub_f32 v76, v76, v230
    v_sub_f32 v12, v12, v230
    v_sub_f32 v44, v44, v230
    v_sub_f32 v77, v77, v230
    v_sub_f32 v13, v13, v230
    v_sub_f32 v45, v45, v230
    v_sub_f32 v78, v78, v230
    v_sub_f32 v14, v14, v230
    v_sub_f32 v46, v46, v230
    v_sub_f32 v79, v79, v230
    v_sub_f32 v15, v15, v230
    v_sub_f32 v47, v47, v230
    v_mul_f32 v148, v148, v232
    v_mul_f32 v149, v149, v232
    v_mul_f32 v150, v150, v232
    v_mul_f32 v151, v151, v232
    v_accvgpr_read_b32 v233, a32
    v_mul_f32_e64 v233, v233, v232
    v_accvgpr_write_b32 a32, v233
    v_accvgpr_read_b32 v234, a33
    v_mul_f32_e64 v234, v234, v232
    v_accvgpr_write_b32 a33, v234
    v_accvgpr_read_b32 v235, a34
    v_mul_f32_e64 v235, v235, v232
    v_accvgpr_write_b32 a34, v235
    v_accvgpr_read_b32 v236, a35
    v_mul_f32_e64 v236, v236, v232
    v_accvgpr_write_b32 a35, v236
    v_accvgpr_read_b32 v233, a36
    v_mul_f32_e64 v233, v233, v232
    v_accvgpr_write_b32 a36, v233
    v_accvgpr_read_b32 v234, a37
    v_mul_f32_e64 v234, v234, v232
    v_accvgpr_write_b32 a37, v234
    v_accvgpr_read_b32 v235, a38
    v_mul_f32_e64 v235, v235, v232
    v_accvgpr_write_b32 a38, v235
    v_accvgpr_read_b32 v236, a39
    v_mul_f32_e64 v236, v236, v232
    v_accvgpr_write_b32 a39, v236
    v_accvgpr_read_b32 v233, a40
    v_mul_f32_e64 v233, v233, v232
    v_accvgpr_write_b32 a40, v233
    v_accvgpr_read_b32 v234, a41
    v_mul_f32_e64 v234, v234, v232
    v_accvgpr_write_b32 a41, v234
    v_accvgpr_read_b32 v235, a42
    v_mul_f32_e64 v235, v235, v232
    v_accvgpr_write_b32 a42, v235
    v_accvgpr_read_b32 v236, a43
    v_mul_f32_e64 v236, v236, v232
    v_accvgpr_write_b32 a43, v236
    v_accvgpr_read_b32 v233, a44
    v_mul_f32_e64 v233, v233, v232
    v_accvgpr_write_b32 a44, v233
    v_accvgpr_read_b32 v234, a45
    v_mul_f32_e64 v234, v234, v232
    v_accvgpr_write_b32 a45, v234
    v_accvgpr_read_b32 v235, a46
    v_mul_f32_e64 v235, v235, v232
    v_accvgpr_write_b32 a46, v235
    v_accvgpr_read_b32 v236, a47
    v_mul_f32_e64 v236, v236, v232
    v_accvgpr_write_b32 a47, v236
    v_accvgpr_read_b32 v233, a48
    v_mul_f32_e64 v233, v233, v232
    v_accvgpr_write_b32 a48, v233
    v_accvgpr_read_b32 v234, a49
    v_mul_f32_e64 v234, v234, v232
    v_accvgpr_write_b32 a49, v234
    v_accvgpr_read_b32 v235, a50
    v_mul_f32_e64 v235, v235, v232
    v_accvgpr_write_b32 a50, v235
    v_accvgpr_read_b32 v236, a51
    v_mul_f32_e64 v236, v236, v232
    v_accvgpr_write_b32 a51, v236
    v_accvgpr_read_b32 v233, a52
    v_mul_f32_e64 v233, v233, v232
    v_accvgpr_write_b32 a52, v233
    v_accvgpr_read_b32 v234, a53
    v_mul_f32_e64 v234, v234, v232
    v_accvgpr_write_b32 a53, v234
    v_accvgpr_read_b32 v235, a54
    v_mul_f32_e64 v235, v235, v232
    v_accvgpr_write_b32 a54, v235
    v_accvgpr_read_b32 v236, a55
    v_mul_f32_e64 v236, v236, v232
    v_accvgpr_write_b32 a55, v236
    v_accvgpr_read_b32 v233, a56
    v_mul_f32_e64 v233, v233, v232
    v_accvgpr_write_b32 a56, v233
    v_accvgpr_read_b32 v234, a57
    v_mul_f32_e64 v234, v234, v232
    v_accvgpr_write_b32 a57, v234
    v_accvgpr_read_b32 v235, a58
    v_mul_f32_e64 v235, v235, v232
    v_accvgpr_write_b32 a58, v235
    v_accvgpr_read_b32 v236, a59
    v_mul_f32_e64 v236, v236, v232
    v_accvgpr_write_b32 a59, v236
    v_accvgpr_read_b32 v233, a60
    v_mul_f32_e64 v233, v233, v232
    v_accvgpr_write_b32 a60, v233
    v_accvgpr_read_b32 v234, a61
    v_mul_f32_e64 v234, v234, v232
    v_accvgpr_write_b32 a61, v234
    v_accvgpr_read_b32 v235, a62
    v_mul_f32_e64 v235, v235, v232
    v_accvgpr_write_b32 a62, v235
    v_accvgpr_read_b32 v236, a63
    v_mul_f32_e64 v236, v236, v232
    v_accvgpr_write_b32 a63, v236
    v_exp_f32 v128, v40
    v_exp_f32 v129, v41
    v_exp_f32 v130, v42
    v_exp_f32 v131, v43
    v_exp_f32 v132, v44
    v_exp_f32 v133, v45
    v_exp_f32 v134, v46
    v_exp_f32_e64 v135, v47
    s_nop 0
    v_cvt_pk_bf16_f32 v116, v128, v129
    v_cvt_pk_bf16_f32 v117, v130, v131
    v_cvt_pk_bf16_f32 v118, v132, v133
    v_cvt_pk_bf16_f32 v119, v134, v135
    v_max3_f32 v230, v48, v49, v50
    v_max3_f32 v230, v230, v51, v52
    v_max3_f32 v230, v230, v53, v54
    v_max_f32 v230, v230, v55
    v_mov_b32 v231, v230
    s_nop 1
    v_permlane16_swap_b32 v230, v231
    s_nop 0
    v_max_f32 v230, v230, v231
    v_mov_b32 v231, v230
    s_nop 1
    v_permlane32_swap_b32 v230, v231
    s_nop 0
    v_max_f32_e64 v230, v230, v231
    v_add_f32 v230, 0x41800000, v230
    v_max_f32 v230, 0, v230
    v_sub_f32 v232, 0, v230
    v_exp_f32 v232, v232
    v_sub_f32 v226, v226, v230
    v_sub_f32 v80, v80, v230
    v_sub_f32 v16, v16, v230
    v_sub_f32 v48, v48, v230
    v_sub_f32 v81, v81, v230
    v_sub_f32 v17, v17, v230
    v_sub_f32 v49, v49, v230
    v_sub_f32 v82, v82, v230
    v_sub_f32 v18, v18, v230
    v_sub_f32 v50, v50, v230
    v_sub_f32 v83, v83, v230
    v_sub_f32 v19, v19, v230
    v_sub_f32 v51, v51, v230
    v_sub_f32 v84, v84, v230
    v_sub_f32 v20, v20, v230
    v_sub_f32 v52, v52, v230
    v_sub_f32 v85, v85, v230
    v_sub_f32 v21, v21, v230
    v_sub_f32 v53, v53, v230
    v_sub_f32 v86, v86, v230
    v_sub_f32 v22, v22, v230
    v_sub_f32 v54, v54, v230
    v_sub_f32 v87, v87, v230
    v_sub_f32 v23, v23, v230
    v_sub_f32 v55, v55, v230
    v_mul_f32 v152, v152, v232
    v_mul_f32 v153, v153, v232
    v_mul_f32 v154, v154, v232
    v_mul_f32 v155, v155, v232
    v_accvgpr_read_b32 v233, a64
    v_mul_f32_e64 v233, v233, v232
    v_accvgpr_write_b32 a64, v233
    v_accvgpr_read_b32 v234, a65
    v_mul_f32_e64 v234, v234, v232
    v_accvgpr_write_b32 a65, v234
    v_accvgpr_read_b32 v235, a66
    v_mul_f32_e64 v235, v235, v232
    v_accvgpr_write_b32 a66, v235
    v_accvgpr_read_b32 v236, a67
    v_mul_f32_e64 v236, v236, v232
    v_accvgpr_write_b32 a67, v236
    v_accvgpr_read_b32 v233, a68
    v_mul_f32_e64 v233, v233, v232
    v_accvgpr_write_b32 a68, v233
    v_accvgpr_read_b32 v234, a69
    v_mul_f32_e64 v234, v234, v232
    v_accvgpr_write_b32 a69, v234
    v_accvgpr_read_b32 v235, a70
    v_mul_f32_e64 v235, v235, v232
    v_accvgpr_write_b32 a70, v235
    v_accvgpr_read_b32 v236, a71
    v_mul_f32_e64 v236, v236, v232
    v_accvgpr_write_b32 a71, v236
    v_accvgpr_read_b32 v233, a72
    v_mul_f32_e64 v233, v233, v232
    v_accvgpr_write_b32 a72, v233
    v_accvgpr_read_b32 v234, a73
    v_mul_f32_e64 v234, v234, v232
    v_accvgpr_write_b32 a73, v234
    v_accvgpr_read_b32 v235, a74
    v_mul_f32_e64 v235, v235, v232
    v_accvgpr_write_b32 a74, v235
    v_accvgpr_read_b32 v236, a75
    v_mul_f32_e64 v236, v236, v232
    v_accvgpr_write_b32 a75, v236
    v_accvgpr_read_b32 v233, a76
    v_mul_f32_e64 v233, v233, v232
    v_accvgpr_write_b32 a76, v233
    v_accvgpr_read_b32 v234, a77
    v_mul_f32_e64 v234, v234, v232
    v_accvgpr_write_b32 a77, v234
    v_accvgpr_read_b32 v235, a78
    v_mul_f32_e64 v235, v235, v232
    v_accvgpr_write_b32 a78, v235
    v_accvgpr_read_b32 v236, a79
    v_mul_f32_e64 v236, v236, v232
    v_accvgpr_write_b32 a79, v236
    v_accvgpr_read_b32 v233, a80
    v_mul_f32_e64 v233, v233, v232
    v_accvgpr_write_b32 a80, v233
    v_accvgpr_read_b32 v234, a81
    v_mul_f32_e64 v234, v234, v232
    v_accvgpr_write_b32 a81, v234
    v_accvgpr_read_b32 v235, a82
    v_mul_f32_e64 v235, v235, v232
    v_accvgpr_write_b32 a82, v235
    v_accvgpr_read_b32 v236, a83
    v_mul_f32_e64 v236, v236, v232
    v_accvgpr_write_b32 a83, v236
    v_accvgpr_read_b32 v233, a84
    v_mul_f32_e64 v233, v233, v232
    v_accvgpr_write_b32 a84, v233
    v_accvgpr_read_b32 v234, a85
    v_mul_f32_e64 v234, v234, v232
    v_accvgpr_write_b32 a85, v234
    v_accvgpr_read_b32 v235, a86
    v_mul_f32_e64 v235, v235, v232
    v_accvgpr_write_b32 a86, v235
    v_accvgpr_read_b32 v236, a87
    v_mul_f32_e64 v236, v236, v232
    v_accvgpr_write_b32 a87, v236
    v_accvgpr_read_b32 v233, a88
    v_mul_f32_e64 v233, v233, v232
    v_accvgpr_write_b32 a88, v233
    v_accvgpr_read_b32 v234, a89
    v_mul_f32_e64 v234, v234, v232
    v_accvgpr_write_b32 a89, v234
    v_accvgpr_read_b32 v235, a90
    v_mul_f32_e64 v235, v235, v232
    v_accvgpr_write_b32 a90, v235
    v_accvgpr_read_b32 v236, a91
    v_mul_f32_e64 v236, v236, v232
    v_accvgpr_write_b32 a91, v236
    v_accvgpr_read_b32 v233, a92
    v_mul_f32_e64 v233, v233, v232
    v_accvgpr_write_b32 a92, v233
    v_accvgpr_read_b32 v234, a93
    v_mul_f32_e64 v234, v234, v232
    v_accvgpr_write_b32 a93, v234
    v_accvgpr_read_b32 v235, a94
    v_mul_f32_e64 v235, v235, v232
    v_accvgpr_write_b32 a94, v235
    v_accvgpr_read_b32 v236, a95
    v_mul_f32_e64 v236, v236, v232
    v_accvgpr_write_b32 a95, v236
    v_exp_f32 v128, v48
    v_exp_f32 v129, v49
    v_exp_f32 v130, v50
    v_exp_f32 v131, v51
    v_exp_f32 v132, v52
    v_exp_f32 v133, v53
    v_exp_f32 v134, v54
    v_exp_f32_e64 v135, v55
    s_nop 0
    v_cvt_pk_bf16_f32 v120, v128, v129
    v_cvt_pk_bf16_f32 v121, v130, v131
    v_cvt_pk_bf16_f32 v122, v132, v133
    v_cvt_pk_bf16_f32 v123, v134, v135
    v_max3_f32 v230, v56, v57, v58
    v_max3_f32 v230, v230, v59, v60
    v_max3_f32 v230, v230, v61, v62
    v_max_f32 v230, v230, v63
    v_mov_b32 v231, v230
    s_nop 1
    v_permlane16_swap_b32 v230, v231
    s_nop 0
    v_max_f32 v230, v230, v231
    v_mov_b32 v231, v230
    s_nop 1
    v_permlane32_swap_b32 v230, v231
    s_nop 0
    v_max_f32_e64 v230, v230, v231
    v_add_f32 v230, 0x41800000, v230
    v_max_f32 v230, 0, v230
    v_sub_f32 v232, 0, v230
    v_exp_f32 v232, v232
    v_sub_f32 v227, v227, v230
    v_sub_f32 v88, v88, v230
    v_sub_f32 v24, v24, v230
    v_sub_f32 v56, v56, v230
    v_sub_f32 v89, v89, v230
    v_sub_f32 v25, v25, v230
    v_sub_f32 v57, v57, v230
    v_sub_f32 v90, v90, v230
    v_sub_f32 v26, v26, v230
    v_sub_f32 v58, v58, v230
    v_sub_f32 v91, v91, v230
    v_sub_f32 v27, v27, v230
    v_sub_f32 v59, v59, v230
    v_sub_f32 v92, v92, v230
    v_sub_f32 v28, v28, v230
    v_sub_f32 v60, v60, v230
    v_sub_f32 v93, v93, v230
    v_sub_f32 v29, v29, v230
    v_sub_f32 v61, v61, v230
    v_sub_f32 v94, v94, v230
    v_sub_f32 v30, v30, v230
    v_sub_f32 v62, v62, v230
    v_sub_f32 v95, v95, v230
    v_sub_f32 v31, v31, v230
    v_sub_f32 v63, v63, v230
    v_mul_f32 v156, v156, v232
    v_mul_f32 v157, v157, v232
    v_mul_f32 v158, v158, v232
    v_mul_f32 v159, v159, v232
    v_accvgpr_read_b32 v233, a96
    v_mul_f32_e64 v233, v233, v232
    v_accvgpr_write_b32 a96, v233
    v_accvgpr_read_b32 v234, a97
    v_mul_f32_e64 v234, v234, v232
    v_accvgpr_write_b32 a97, v234
    v_accvgpr_read_b32 v235, a98
    v_mul_f32_e64 v235, v235, v232
    v_accvgpr_write_b32 a98, v235
    v_accvgpr_read_b32 v236, a99
    v_mul_f32_e64 v236, v236, v232
    v_accvgpr_write_b32 a99, v236
    v_accvgpr_read_b32 v233, a100
    v_mul_f32_e64 v233, v233, v232
    v_accvgpr_write_b32 a100, v233
    v_accvgpr_read_b32 v234, a101
    v_mul_f32_e64 v234, v234, v232
    v_accvgpr_write_b32 a101, v234
    v_accvgpr_read_b32 v235, a102
    v_mul_f32_e64 v235, v235, v232
    v_accvgpr_write_b32 a102, v235
    v_accvgpr_read_b32 v236, a103
    v_mul_f32_e64 v236, v236, v232
    v_accvgpr_write_b32 a103, v236
    v_accvgpr_read_b32 v233, a104
    v_mul_f32_e64 v233, v233, v232
    v_accvgpr_write_b32 a104, v233
    v_accvgpr_read_b32 v234, a105
    v_mul_f32_e64 v234, v234, v232
    v_accvgpr_write_b32 a105, v234
    v_accvgpr_read_b32 v235, a106
    v_mul_f32_e64 v235, v235, v232
    v_accvgpr_write_b32 a106, v235
    v_accvgpr_read_b32 v236, a107
    v_mul_f32_e64 v236, v236, v232
    v_accvgpr_write_b32 a107, v236
    v_accvgpr_read_b32 v233, a108
    v_mul_f32_e64 v233, v233, v232
    v_accvgpr_write_b32 a108, v233
    v_accvgpr_read_b32 v234, a109
    v_mul_f32_e64 v234, v234, v232
    v_accvgpr_write_b32 a109, v234
    v_accvgpr_read_b32 v235, a110
    v_mul_f32_e64 v235, v235, v232
    v_accvgpr_write_b32 a110, v235
    v_accvgpr_read_b32 v236, a111
    v_mul_f32_e64 v236, v236, v232
    v_accvgpr_write_b32 a111, v236
    v_accvgpr_read_b32 v233, a112
    v_mul_f32_e64 v233, v233, v232
    v_accvgpr_write_b32 a112, v233
    v_accvgpr_read_b32 v234, a113
    v_mul_f32_e64 v234, v234, v232
    v_accvgpr_write_b32 a113, v234
    v_accvgpr_read_b32 v235, a114
    v_mul_f32_e64 v235, v235, v232
    v_accvgpr_write_b32 a114, v235
    v_accvgpr_read_b32 v236, a115
    v_mul_f32_e64 v236, v236, v232
    v_accvgpr_write_b32 a115, v236
    v_accvgpr_read_b32 v233, a116
    v_mul_f32_e64 v233, v233, v232
    v_accvgpr_write_b32 a116, v233
    v_accvgpr_read_b32 v234, a117
    v_mul_f32_e64 v234, v234, v232
    v_accvgpr_write_b32 a117, v234
    v_accvgpr_read_b32 v235, a118
    v_mul_f32_e64 v235, v235, v232
    v_accvgpr_write_b32 a118, v235
    v_accvgpr_read_b32 v236, a119
    v_mul_f32_e64 v236, v236, v232
    v_accvgpr_write_b32 a119, v236
    v_accvgpr_read_b32 v233, a120
    v_mul_f32_e64 v233, v233, v232
    v_accvgpr_write_b32 a120, v233
    v_accvgpr_read_b32 v234, a121
    v_mul_f32_e64 v234, v234, v232
    v_accvgpr_write_b32 a121, v234
    v_accvgpr_read_b32 v235, a122
    v_mul_f32_e64 v235, v235, v232
    v_accvgpr_write_b32 a122, v235
    v_accvgpr_read_b32 v236, a123
    v_mul_f32_e64 v236, v236, v232
    v_accvgpr_write_b32 a123, v236
    v_accvgpr_read_b32 v233, a124
    v_mul_f32_e64 v233, v233, v232
    v_accvgpr_write_b32 a124, v233
    v_accvgpr_read_b32 v234, a125
    v_mul_f32_e64 v234, v234, v232
    v_accvgpr_write_b32 a125, v234
    v_accvgpr_read_b32 v235, a126
    v_mul_f32_e64 v235, v235, v232
    v_accvgpr_write_b32 a126, v235
    v_accvgpr_read_b32 v236, a127
    v_mul_f32_e64 v236, v236, v232
    v_accvgpr_write_b32 a127, v236
    v_exp_f32 v128, v56
    v_exp_f32 v129, v57
    v_exp_f32 v130, v58
    v_exp_f32 v131, v59
    v_exp_f32 v132, v60
    v_exp_f32 v133, v61
    v_exp_f32 v134, v62
    v_exp_f32_e64 v135, v63
    s_nop 0
    v_cvt_pk_bf16_f32 v124, v128, v129
    v_cvt_pk_bf16_f32 v125, v130, v131
    v_cvt_pk_bf16_f32 v126, v132, v133
    v_cvt_pk_bf16_f32 v127, v134, v135
    s_nop 1
    s_branch kf_rr13
kf_rare18:
    s_nop 15
    v_max3_f32 v230, v16, v17, v18
    v_max3_f32 v230, v230, v19, v20
    v_max3_f32 v230, v230, v21, v22
    v_max_f32 v230, v230, v23
    v_mov_b32 v231, v230
    s_nop 1
    v_permlane16_swap_b32 v230, v231
    s_nop 0
    v_max_f32 v230, v230, v231
    v_mov_b32 v231, v230
    s_nop 1
    v_permlane32_swap_b32 v230, v231
    s_nop 0
    v_max_f32 v230, v230, v231
    v_add_f32 v230, 0x41800000, v230
    v_max_f32 v230, 0, v230
    v_sub_f32 v232, 0, v230
    v_exp_f32 v232, v232
    v_sub_f32 v226, v226, v230
    v_sub_f32 v80, v80, v230
    v_sub_f32 v48, v48, v230
    v_sub_f32 v16, v16, v230
    v_sub_f32 v81, v81, v230
    v_sub_f32 v49, v49, v230
    v_sub_f32 v17, v17, v230
    v_sub_f32 v82, v82, v230
    v_sub_f32 v50, v50, v230
    v_sub_f32 v18, v18, v230
    v_sub_f32 v83, v83, v230
    v_sub_f32 v51, v51, v230
    v_sub_f32 v19, v19, v230
    v_sub_f32 v84, v84, v230
    v_sub_f32 v52, v52, v230
    v_sub_f32 v20, v20, v230
    v_sub_f32 v85, v85, v230
    v_sub_f32 v53, v53, v230
    v_sub_f32 v21, v21, v230
    v_sub_f32 v86, v86, v230
    v_sub_f32 v54, v54, v230
    v_sub_f32 v22, v22, v230
    v_sub_f32 v87, v87, v230
    v_sub_f32 v55, v55, v230
    v_sub_f32 v23, v23, v230
    v_mul_f32 v152, v152, v232
    v_mul_f32 v153, v153, v232
    v_mul_f32 v154, v154, v232
    v_mul_f32 v155, v155, v232
    v_accvgpr_read_b32 v233, a64
    v_mul_f32_e64 v233, v233, v232
    v_accvgpr_write_b32 a64, v233
    v_accvgpr_read_b32 v234, a65
    v_mul_f32_e64 v234, v234, v232
    v_accvgpr_write_b32 a65, v234
    v_accvgpr_read_b32 v235, a66
    v_mul_f32_e64 v235, v235, v232
    v_accvgpr_write_b32 a66, v235
    v_accvgpr_read_b32 v236, a67
    v_mul_f32_e64 v236, v236, v232
    v_accvgpr_write_b32 a67, v236
    v_accvgpr_read_b32 v233, a68
    v_mul_f32_e64 v233, v233, v232
    v_accvgpr_write_b32 a68, v233
    v_accvgpr_read_b32 v234, a69
    v_mul_f32_e64 v234, v234, v232
    v_accvgpr_write_b32 a69, v234
    v_accvgpr_read_b32 v235, a70
    v_mul_f32_e64 v235, v235, v232
    v_accvgpr_write_b32 a70, v235
    v_accvgpr_read_b32 v236, a71
    v_mul_f32_e64 v236, v236, v232
    v_accvgpr_write_b32 a71, v236
    v_accvgpr_read_b32 v233, a72
    v_mul_f32_e64 v233, v233, v232
    v_accvgpr_write_b32 a72, v233
    v_accvgpr_read_b32 v234, a73
    v_mul_f32_e64 v234, v234, v232
    v_accvgpr_write_b32 a73, v234
    v_accvgpr_read_b32 v235, a74
    v_mul_f32_e64 v235, v235, v232
    v_accvgpr_write_b32 a74, v235
    v_accvgpr_read_b32 v236, a75
    v_mul_f32_e64 v236, v236, v232
    v_accvgpr_write_b32 a75, v236
    v_accvgpr_read_b32 v233, a76
    v_mul_f32_e64 v233, v233, v232
    v_accvgpr_write_b32 a76, v233
    v_accvgpr_read_b32 v234, a77
    v_mul_f32_e64 v234, v234, v232
    v_accvgpr_write_b32 a77, v234
    v_accvgpr_read_b32 v235, a78
    v_mul_f32_e64 v235, v235, v232
    v_accvgpr_write_b32 a78, v235
    v_accvgpr_read_b32 v236, a79
    v_mul_f32_e64 v236, v236, v232
    v_accvgpr_write_b32 a79, v236
    v_accvgpr_read_b32 v233, a80
    v_mul_f32_e64 v233, v233, v232
    v_accvgpr_write_b32 a80, v233
    v_accvgpr_read_b32 v234, a81
    v_mul_f32_e64 v234, v234, v232
    v_accvgpr_write_b32 a81, v234
    v_accvgpr_read_b32 v235, a82
    v_mul_f32_e64 v235, v235, v232
    v_accvgpr_write_b32 a82, v235
    v_accvgpr_read_b32 v236, a83
    v_mul_f32_e64 v236, v236, v232
    v_accvgpr_write_b32 a83, v236
    v_accvgpr_read_b32 v233, a84
    v_mul_f32_e64 v233, v233, v232
    v_accvgpr_write_b32 a84, v233
    v_accvgpr_read_b32 v234, a85
    v_mul_f32_e64 v234, v234, v232
    v_accvgpr_write_b32 a85, v234
    v_accvgpr_read_b32 v235, a86
    v_mul_f32_e64 v235, v235, v232
    v_accvgpr_write_b32 a86, v235
    v_accvgpr_read_b32 v236, a87
    v_mul_f32_e64 v236, v236, v232
    v_accvgpr_write_b32 a87, v236
    v_accvgpr_read_b32 v233, a88
    v_mul_f32_e64 v233, v233, v232
    v_accvgpr_write_b32 a88, v233
    v_accvgpr_read_b32 v234, a89
    v_mul_f32_e64 v234, v234, v232
    v_accvgpr_write_b32 a89, v234
    v_accvgpr_read_b32 v235, a90
    v_mul_f32_e64 v235, v235, v232
    v_accvgpr_write_b32 a90, v235
    v_accvgpr_read_b32 v236, a91
    v_mul_f32_e64 v236, v236, v232
    v_accvgpr_write_b32 a91, v236
    v_accvgpr_read_b32 v233, a92
    v_mul_f32_e64 v233, v233, v232
    v_accvgpr_write_b32 a92, v233
    v_accvgpr_read_b32 v234, a93
    v_mul_f32_e64 v234, v234, v232
    v_accvgpr_write_b32 a93, v234
    v_accvgpr_read_b32 v235, a94
    v_mul_f32_e64 v235, v235, v232
    v_accvgpr_write_b32 a94, v235
    v_accvgpr_read_b32 v236, a95
    v_mul_f32_e64 v236, v236, v232
    v_accvgpr_write_b32 a95, v236
    v_exp_f32 v128, v16
    v_exp_f32 v129, v17
    v_exp_f32 v130, v18
    v_exp_f32 v131, v19
    v_exp_f32 v132, v20
    v_exp_f32 v133, v21
    v_exp_f32 v134, v22
    v_exp_f32_e64 v135, v23
    s_nop 0
    v_cvt_pk_bf16_f32 v104, v128, v129
    v_cvt_pk_bf16_f32 v105, v130, v131
    v_cvt_pk_bf16_f32 v106, v132, v133
    v_cvt_pk_bf16_f32 v107, v134, v135
    v_max3_f32 v230, v24, v25, v26
    v_max3_f32 v230, v230, v27, v28
    v_max3_f32 v230, v230, v29, v30
    v_max_f32 v230, v230, v31
    v_mov_b32 v231, v230
    s_nop 1
    v_permlane16_swap_b32 v230, v231
    s_nop 0
    v_max_f32 v230, v230, v231
    v_mov_b32 v231, v230
    s_nop 1
    v_permlane32_swap_b32 v230, v231
    s_nop 0
    v_max_f32_e64 v230, v230, v231
    v_add_f32 v230, 0x41800000, v230
    v_max_f32 v230, 0, v230
    v_sub_f32 v232, 0, v230
    v_exp_f32 v232, v232
    v_sub_f32 v227, v227, v230
    v_sub_f32 v88, v88, v230
    v_sub_f32 v56, v56, v230
    v_sub_f32 v24, v24, v230
    v_sub_f32 v89, v89, v230
    v_sub_f32 v57, v57, v230
    v_sub_f32 v25, v25, v230
    v_sub_f32 v90, v90, v230
    v_sub_f32 v58, v58, v230
    v_sub_f32 v26, v26, v230
    v_sub_f32 v91, v91, v230
    v_sub_f32 v59, v59, v230
    v_sub_f32 v27, v27, v230
    v_sub_f32 v92, v92, v230
    v_sub_f32 v60, v60, v230
    v_sub_f32 v28, v28, v230
    v_sub_f32 v93, v93, v230
    v_sub_f32 v61, v61, v230
    v_sub_f32 v29, v29, v230
    v_sub_f32 v94, v94, v230
    v_sub_f32 v62, v62, v230
    v_sub_f32 v30, v30, v230
    v_sub_f32 v95, v95, v230
    v_sub_f32 v63, v63, v230
    v_sub_f32 v31, v31, v230
    v_mul_f32 v156, v156, v232
    v_mul_f32 v157, v157, v232
    v_mul_f32 v158, v158, v232
    v_mul_f32 v159, v159, v232
    v_accvgpr_read_b32 v233, a96
    v_mul_f32_e64 v233, v233, v232
    v_accvgpr_write_b32 a96, v233
    v_accvgpr_read_b32 v234, a97
    v_mul_f32_e64 v234, v234, v232
    v_accvgpr_write_b32 a97, v234
    v_accvgpr_read_b32 v235, a98
    v_mul_f32_e64 v235, v235, v232
    v_accvgpr_write_b32 a98, v235
    v_accvgpr_read_b32 v236, a99
    v_mul_f32_e64 v236, v236, v232
    v_accvgpr_write_b32 a99, v236
    v_accvgpr_read_b32 v233, a100
    v_mul_f32_e64 v233, v233, v232
    v_accvgpr_write_b32 a100, v233
    v_accvgpr_read_b32 v234, a101
    v_mul_f32_e64 v234, v234, v232
    v_accvgpr_write_b32 a101, v234
    v_accvgpr_read_b32 v235, a102
    v_mul_f32_e64 v235, v235, v232
    v_accvgpr_write_b32 a102, v235
    v_accvgpr_read_b32 v236, a103
    v_mul_f32_e64 v236, v236, v232
    v_accvgpr_write_b32 a103, v236
    v_accvgpr_read_b32 v233, a104
    v_mul_f32_e64 v233, v233, v232
    v_accvgpr_write_b32 a104, v233
    v_accvgpr_read_b32 v234, a105
    v_mul_f32_e64 v234, v234, v232
    v_accvgpr_write_b32 a105, v234
    v_accvgpr_read_b32 v235, a106
    v_mul_f32_e64 v235, v235, v232
    v_accvgpr_write_b32 a106, v235
    v_accvgpr_read_b32 v236, a107
    v_mul_f32_e64 v236, v236, v232
    v_accvgpr_write_b32 a107, v236
    v_accvgpr_read_b32 v233, a108
    v_mul_f32_e64 v233, v233, v232
    v_accvgpr_write_b32 a108, v233
    v_accvgpr_read_b32 v234, a109
    v_mul_f32_e64 v234, v234, v232
    v_accvgpr_write_b32 a109, v234
    v_accvgpr_read_b32 v235, a110
    v_mul_f32_e64 v235, v235, v232
    v_accvgpr_write_b32 a110, v235
    v_accvgpr_read_b32 v236, a111
    v_mul_f32_e64 v236, v236, v232
    v_accvgpr_write_b32 a111, v236
    v_accvgpr_read_b32 v233, a112
    v_mul_f32_e64 v233, v233, v232
    v_accvgpr_write_b32 a112, v233
    v_accvgpr_read_b32 v234, a113
    v_mul_f32_e64 v234, v234, v232
    v_accvgpr_write_b32 a113, v234
    v_accvgpr_read_b32 v235, a114
    v_mul_f32_e64 v235, v235, v232
    v_accvgpr_write_b32 a114, v235
    v_accvgpr_read_b32 v236, a115
    v_mul_f32_e64 v236, v236, v232
    v_accvgpr_write_b32 a115, v236
    v_accvgpr_read_b32 v233, a116
    v_mul_f32_e64 v233, v233, v232
    v_accvgpr_write_b32 a116, v233
    v_accvgpr_read_b32 v234, a117
    v_mul_f32_e64 v234, v234, v232
    v_accvgpr_write_b32 a117, v234
    v_accvgpr_read_b32 v235, a118
    v_mul_f32_e64 v235, v235, v232
    v_accvgpr_write_b32 a118, v235
    v_accvgpr_read_b32 v236, a119
    v_mul_f32_e64 v236, v236, v232
    v_accvgpr_write_b32 a119, v236
    v_accvgpr_read_b32 v233, a120
    v_mul_f32_e64 v233, v233, v232
    v_accvgpr_write_b32 a120, v233
    v_accvgpr_read_b32 v234, a121
    v_mul_f32_e64 v234, v234, v232
    v_accvgpr_write_b32 a121, v234
    v_accvgpr_read_b32 v235, a122
    v_mul_f32_e64 v235, v235, v232
    v_accvgpr_write_b32 a122, v235
    v_accvgpr_read_b32 v236, a123
    v_mul_f32_e64 v236, v236, v232
    v_accvgpr_write_b32 a123, v236
    v_accvgpr_read_b32 v233, a124
    v_mul_f32_e64 v233, v233, v232
    v_accvgpr_write_b32 a124, v233
    v_accvgpr_read_b32 v234, a125
    v_mul_f32_e64 v234, v234, v232
    v_accvgpr_write_b32 a125, v234
    v_accvgpr_read_b32 v235, a126
    v_mul_f32_e64 v235, v235, v232
    v_accvgpr_write_b32 a126, v235
    v_accvgpr_read_b32 v236, a127
    v_mul_f32_e64 v236, v236, v232
    v_accvgpr_write_b32 a127, v236
    v_exp_f32 v128, v24
    v_exp_f32 v129, v25
    v_exp_f32 v130, v26
    v_exp_f32 v131, v27
    v_exp_f32 v132, v28
    v_exp_f32 v133, v29
    v_exp_f32 v134, v30
    v_exp_f32_e64 v135, v31
    s_nop 0
    v_cvt_pk_bf16_f32 v108, v128, v129
    v_cvt_pk_bf16_f32 v109, v130, v131
    v_cvt_pk_bf16_f32 v110, v132, v133
    v_cvt_pk_bf16_f32 v111, v134, v135
    s_nop 1
    s_branch kf_rr17
kf_rare22:
    s_nop 15
    v_max3_f32 v230, v48, v49, v50
    v_max3_f32 v230, v230, v51, v52
    v_max3_f32 v230, v230, v53, v54
    v_max_f32 v230, v230, v55
    v_mov_b32 v231, v230
    s_nop 1
    v_permlane16_swap_b32 v230, v231
    s_nop 0
    v_max_f32 v230, v230, v231
    v_mov_b32 v231, v230
    s_nop 1
    v_permlane32_swap_b32 v230, v231
    s_nop 0
    v_max_f32 v230, v230, v231
    v_add_f32 v230, 0x41800000, v230
    v_max_f32 v230, 0, v230
    v_sub_f32 v232, 0, v230
    v_exp_f32 v232, v232
    v_sub_f32 v226, v226, v230
    v_sub_f32 v80, v80, v230
    v_sub_f32 v16, v16, v230
    v_sub_f32 v48, v48, v230
    v_sub_f32 v81, v81, v230
    v_sub_f32 v17, v17, v230
    v_sub_f32 v49, v49, v230
    v_sub_f32 v82, v82, v230
    v_sub_f32 v18, v18, v230
    v_sub_f32 v50, v50, v230
    v_sub_f32 v83, v83, v230
    v_sub_f32 v19, v19, v230
    v_sub_f32 v51, v51, v230
    v_sub_f32 v84, v84, v230
    v_sub_f32 v20, v20, v230
    v_sub_f32 v52, v52, v230
    v_sub_f32 v85, v85, v230
    v_sub_f32 v21, v21, v230
    v_sub_f32 v53, v53, v230
    v_sub_f32 v86, v86, v230
    v_sub_f32 v22, v22, v230
    v_sub_f32 v54, v54, v230
    v_sub_f32 v87, v87, v230
    v_sub_f32 v23, v23, v230
    v_sub_f32 v55, v55, v230
    v_mul_f32 v152, v152, v232
    v_mul_f32 v153, v153, v232
    v_mul_f32 v154, v154, v232
    v_mul_f32 v155, v155, v232
    v_accvgpr_read_b32 v233, a64
    v_mul_f32_e64 v233, v233, v232
    v_accvgpr_write_b32 a64, v233
    v_accvgpr_read_b32 v234, a65
    v_mul_f32_e64 v234, v234, v232
    v_accvgpr_write_b32 a65, v234
    v_accvgpr_read_b32 v235, a66
    v_mul_f32_e64 v235, v235, v232
    v_accvgpr_write_b32 a66, v235
    v_accvgpr_read_b32 v236, a67
    v_mul_f32_e64 v236, v236, v232
    v_accvgpr_write_b32 a67, v236
    v_accvgpr_read_b32 v233, a68
    v_mul_f32_e64 v233, v233, v232
    v_accvgpr_write_b32 a68, v233
    v_accvgpr_read_b32 v234, a69
    v_mul_f32_e64 v234, v234, v232
    v_accvgpr_write_b32 a69, v234
    v_accvgpr_read_b32 v235, a70
    v_mul_f32_e64 v235, v235, v232
    v_accvgpr_write_b32 a70, v235
    v_accvgpr_read_b32 v236, a71
    v_mul_f32_e64 v236, v236, v232
    v_accvgpr_write_b32 a71, v236
    v_accvgpr_read_b32 v233, a72
    v_mul_f32_e64 v233, v233, v232
    v_accvgpr_write_b32 a72, v233
    v_accvgpr_read_b32 v234, a73
    v_mul_f32_e64 v234, v234, v232
    v_accvgpr_write_b32 a73, v234
    v_accvgpr_read_b32 v235, a74
    v_mul_f32_e64 v235, v235, v232
    v_accvgpr_write_b32 a74, v235
    v_accvgpr_read_b32 v236, a75
    v_mul_f32_e64 v236, v236, v232
    v_accvgpr_write_b32 a75, v236
    v_accvgpr_read_b32 v233, a76
    v_mul_f32_e64 v233, v233, v232
    v_accvgpr_write_b32 a76, v233
    v_accvgpr_read_b32 v234, a77
    v_mul_f32_e64 v234, v234, v232
    v_accvgpr_write_b32 a77, v234
    v_accvgpr_read_b32 v235, a78
    v_mul_f32_e64 v235, v235, v232
    v_accvgpr_write_b32 a78, v235
    v_accvgpr_read_b32 v236, a79
    v_mul_f32_e64 v236, v236, v232
    v_accvgpr_write_b32 a79, v236
    v_accvgpr_read_b32 v233, a80
    v_mul_f32_e64 v233, v233, v232
    v_accvgpr_write_b32 a80, v233
    v_accvgpr_read_b32 v234, a81
    v_mul_f32_e64 v234, v234, v232
    v_accvgpr_write_b32 a81, v234
    v_accvgpr_read_b32 v235, a82
    v_mul_f32_e64 v235, v235, v232
    v_accvgpr_write_b32 a82, v235
    v_accvgpr_read_b32 v236, a83
    v_mul_f32_e64 v236, v236, v232
    v_accvgpr_write_b32 a83, v236
    v_accvgpr_read_b32 v233, a84
    v_mul_f32_e64 v233, v233, v232
    v_accvgpr_write_b32 a84, v233
    v_accvgpr_read_b32 v234, a85
    v_mul_f32_e64 v234, v234, v232
    v_accvgpr_write_b32 a85, v234
    v_accvgpr_read_b32 v235, a86
    v_mul_f32_e64 v235, v235, v232
    v_accvgpr_write_b32 a86, v235
    v_accvgpr_read_b32 v236, a87
    v_mul_f32_e64 v236, v236, v232
    v_accvgpr_write_b32 a87, v236
    v_accvgpr_read_b32 v233, a88
    v_mul_f32_e64 v233, v233, v232
    v_accvgpr_write_b32 a88, v233
    v_accvgpr_read_b32 v234, a89
    v_mul_f32_e64 v234, v234, v232
    v_accvgpr_write_b32 a89, v234
    v_accvgpr_read_b32 v235, a90
    v_mul_f32_e64 v235, v235, v232
    v_accvgpr_write_b32 a90, v235
    v_accvgpr_read_b32 v236, a91
    v_mul_f32_e64 v236, v236, v232
    v_accvgpr_write_b32 a91, v236
    v_accvgpr_read_b32 v233, a92
    v_mul_f32_e64 v233, v233, v232
    v_accvgpr_write_b32 a92, v233
    v_accvgpr_read_b32 v234, a93
    v_mul_f32_e64 v234, v234, v232
    v_accvgpr_write_b32 a93, v234
    v_accvgpr_read_b32 v235, a94
    v_mul_f32_e64 v235, v235, v232
    v_accvgpr_write_b32 a94, v235
    v_accvgpr_read_b32 v236, a95
    v_mul_f32_e64 v236, v236, v232
    v_accvgpr_write_b32 a95, v236
    v_exp_f32 v128, v48
    v_exp_f32 v129, v49
    v_exp_f32 v130, v50
    v_exp_f32 v131, v51
    v_exp_f32 v132, v52
    v_exp_f32 v133, v53
    v_exp_f32 v134, v54
    v_exp_f32_e64 v135, v55
    s_nop 0
    v_cvt_pk_bf16_f32 v120, v128, v129
    v_cvt_pk_bf16_f32 v121, v130, v131
    v_cvt_pk_bf16_f32 v122, v132, v133
    v_cvt_pk_bf16_f32 v123, v134, v135
    v_max3_f32 v230, v56, v57, v58
    v_max3_f32 v230, v230, v59, v60
    v_max3_f32 v230, v230, v61, v62
    v_max_f32 v230, v230, v63
    v_mov_b32 v231, v230
    s_nop 1
    v_permlane16_swap_b32 v230, v231
    s_nop 0
    v_max_f32 v230, v230, v231
    v_mov_b32 v231, v230
    s_nop 1
    v_permlane32_swap_b32 v230, v231
    s_nop 0
    v_max_f32_e64 v230, v230, v231
    v_add_f32 v230, 0x41800000, v230
    v_max_f32 v230, 0, v230
    v_sub_f32 v232, 0, v230
    v_exp_f32 v232, v232
    v_sub_f32 v227, v227, v230
    v_sub_f32 v88, v88, v230
    v_sub_f32 v24, v24, v230
    v_sub_f32 v56, v56, v230
    v_sub_f32 v89, v89, v230
    v_sub_f32 v25, v25, v230
    v_sub_f32 v57, v57, v230
    v_sub_f32 v90, v90, v230
    v_sub_f32 v26, v26, v230
    v_sub_f32 v58, v58, v230
    v_sub_f32 v91, v91, v230
    v_sub_f32 v27, v27, v230
    v_sub_f32 v59, v59, v230
    v_sub_f32 v92, v92, v230
    v_sub_f32 v28, v28, v230
    v_sub_f32 v60, v60, v230
    v_sub_f32 v93, v93, v230
    v_sub_f32 v29, v29, v230
    v_sub_f32 v61, v61, v230
    v_sub_f32 v94, v94, v230
    v_sub_f32 v30, v30, v230
    v_sub_f32 v62, v62, v230
    v_sub_f32 v95, v95, v230
    v_sub_f32 v31, v31, v230
    v_sub_f32 v63, v63, v230
    v_mul_f32 v156, v156, v232
    v_mul_f32 v157, v157, v232
    v_mul_f32 v158, v158, v232
    v_mul_f32 v159, v159, v232
    v_accvgpr_read_b32 v233, a96
    v_mul_f32_e64 v233, v233, v232
    v_accvgpr_write_b32 a96, v233
    v_accvgpr_read_b32 v234, a97
    v_mul_f32_e64 v234, v234, v232
    v_accvgpr_write_b32 a97, v234
    v_accvgpr_read_b32 v235, a98
    v_mul_f32_e64 v235, v235, v232
    v_accvgpr_write_b32 a98, v235
    v_accvgpr_read_b32 v236, a99
    v_mul_f32_e64 v236, v236, v232
    v_accvgpr_write_b32 a99, v236
    v_accvgpr_read_b32 v233, a100
    v_mul_f32_e64 v233, v233, v232
    v_accvgpr_write_b32 a100, v233
    v_accvgpr_read_b32 v234, a101
    v_mul_f32_e64 v234, v234, v232
    v_accvgpr_write_b32 a101, v234
    v_accvgpr_read_b32 v235, a102
    v_mul_f32_e64 v235, v235, v232
    v_accvgpr_write_b32 a102, v235
    v_accvgpr_read_b32 v236, a103
    v_mul_f32_e64 v236, v236, v232
    v_accvgpr_write_b32 a103, v236
    v_accvgpr_read_b32 v233, a104
    v_mul_f32_e64 v233, v233, v232
    v_accvgpr_write_b32 a104, v233
    v_accvgpr_read_b32 v234, a105
    v_mul_f32_e64 v234, v234, v232
    v_accvgpr_write_b32 a105, v234
    v_accvgpr_read_b32 v235, a106
    v_mul_f32_e64 v235, v235, v232
    v_accvgpr_write_b32 a106, v235
    v_accvgpr_read_b32 v236, a107
    v_mul_f32_e64 v236, v236, v232
    v_accvgpr_write_b32 a107, v236
    v_accvgpr_read_b32 v233, a108
    v_mul_f32_e64 v233, v233, v232
    v_accvgpr_write_b32 a108, v233
    v_accvgpr_read_b32 v234, a109
    v_mul_f32_e64 v234, v234, v232
    v_accvgpr_write_b32 a109, v234
    v_accvgpr_read_b32 v235, a110
    v_mul_f32_e64 v235, v235, v232
    v_accvgpr_write_b32 a110, v235
    v_accvgpr_read_b32 v236, a111
    v_mul_f32_e64 v236, v236, v232
    v_accvgpr_write_b32 a111, v236
    v_accvgpr_read_b32 v233, a112
    v_mul_f32_e64 v233, v233, v232
    v_accvgpr_write_b32 a112, v233
    v_accvgpr_read_b32 v234, a113
    v_mul_f32_e64 v234, v234, v232
    v_accvgpr_write_b32 a113, v234
    v_accvgpr_read_b32 v235, a114
    v_mul_f32_e64 v235, v235, v232
    v_accvgpr_write_b32 a114, v235
    v_accvgpr_read_b32 v236, a115
    v_mul_f32_e64 v236, v236, v232
    v_accvgpr_write_b32 a115, v236
    v_accvgpr_read_b32 v233, a116
    v_mul_f32_e64 v233, v233, v232
    v_accvgpr_write_b32 a116, v233
    v_accvgpr_read_b32 v234, a117
    v_mul_f32_e64 v234, v234, v232
    v_accvgpr_write_b32 a117, v234
    v_accvgpr_read_b32 v235, a118
    v_mul_f32_e64 v235, v235, v232
    v_accvgpr_write_b32 a118, v235
    v_accvgpr_read_b32 v236, a119
    v_mul_f32_e64 v236, v236, v232
    v_accvgpr_write_b32 a119, v236
    v_accvgpr_read_b32 v233, a120
    v_mul_f32_e64 v233, v233, v232
    v_accvgpr_write_b32 a120, v233
    v_accvgpr_read_b32 v234, a121
    v_mul_f32_e64 v234, v234, v232
    v_accvgpr_write_b32 a121, v234
    v_accvgpr_read_b32 v235, a122
    v_mul_f32_e64 v235, v235, v232
    v_accvgpr_write_b32 a122, v235
    v_accvgpr_read_b32 v236, a123
    v_mul_f32_e64 v236, v236, v232
    v_accvgpr_write_b32 a123, v236
    v_accvgpr_read_b32 v233, a124
    v_mul_f32_e64 v233, v233, v232
    v_accvgpr_write_b32 a124, v233
    v_accvgpr_read_b32 v234, a125
    v_mul_f32_e64 v234, v234, v232
    v_accvgpr_write_b32 a125, v234
    v_accvgpr_read_b32 v235, a126
    v_mul_f32_e64 v235, v235, v232
    v_accvgpr_write_b32 a126, v235
    v_accvgpr_read_b32 v236, a127
    v_mul_f32_e64 v236, v236, v232
    v_accvgpr_write_b32 a127, v236
    v_exp_f32 v128, v56
    v_exp_f32 v129, v57
    v_exp_f32 v130, v58
    v_exp_f32 v131, v59
    v_exp_f32 v132, v60
    v_exp_f32 v133, v61
    v_exp_f32 v134, v62
    v_exp_f32_e64 v135, v63
    s_nop 0
    v_cvt_pk_bf16_f32 v124, v128, v129
    v_cvt_pk_bf16_f32 v125, v130, v131
    v_cvt_pk_bf16_f32 v126, v132, v133
    v_cvt_pk_bf16_f32 v127, v134, v135
    s_nop 1
    s_branch kf_rr21
kf_rare26:
    s_nop 15
    v_max3_f32 v230, v16, v17, v18
    v_max3_f32 v230, v230, v19, v20
    v_max3_f32 v230, v230, v21, v22
    v_max_f32 v230, v230, v23
    v_mov_b32 v231, v230
    s_nop 1
    v_permlane16_swap_b32 v230, v231
    s_nop 0
    v_max_f32 v230, v230, v231
    v_mov_b32 v231, v230
    s_nop 1
    v_permlane32_swap_b32 v230, v231
    s_nop 0
    v_max_f32 v230, v230, v231
    v_add_f32 v230, 0x41800000, v230
    v_max_f32 v230, 0, v230
    v_sub_f32 v232, 0, v230
    v_exp_f32 v232, v232
    v_sub_f32 v226, v226, v230
    v_sub_f32 v80, v80, v230
    v_sub_f32 v48, v48, v230
    v_sub_f32 v16, v16, v230
    v_sub_f32 v81, v81, v230
    v_sub_f32 v49, v49, v230
    v_sub_f32 v17, v17, v230
    v_sub_f32 v82, v82, v230
    v_sub_f32 v50, v50, v230
    v_sub_f32 v18, v18, v230
    v_sub_f32 v83, v83, v230
    v_sub_f32 v51, v51, v230
    v_sub_f32 v19, v19, v230
    v_sub_f32 v84, v84, v230
    v_sub_f32 v52, v52, v230
    v_sub_f32 v20, v20, v230
    v_sub_f32 v85, v85, v230
    v_sub_f32 v53, v53, v230
    v_sub_f32 v21, v21, v230
    v_sub_f32 v86, v86, v230
    v_sub_f32 v54, v54, v230
    v_sub_f32 v22, v22, v230
    v_sub_f32 v87, v87, v230
    v_sub_f32 v55, v55, v230
    v_sub_f32 v23, v23, v230
    v_mul_f32 v152, v152, v232
    v_mul_f32 v153, v153, v232
    v_mul_f32 v154, v154, v232
    v_mul_f32 v155, v155, v232
    v_accvgpr_read_b32 v233, a64
    v_mul_f32_e64 v233, v233, v232
    v_accvgpr_write_b32 a64, v233
    v_accvgpr_read_b32 v234, a65
    v_mul_f32_e64 v234, v234, v232
    v_accvgpr_write_b32 a65, v234
    v_accvgpr_read_b32 v235, a66
    v_mul_f32_e64 v235, v235, v232
    v_accvgpr_write_b32 a66, v235
    v_accvgpr_read_b32 v236, a67
    v_mul_f32_e64 v236, v236, v232
    v_accvgpr_write_b32 a67, v236
    v_accvgpr_read_b32 v233, a68
    v_mul_f32_e64 v233, v233, v232
    v_accvgpr_write_b32 a68, v233
    v_accvgpr_read_b32 v234, a69
    v_mul_f32_e64 v234, v234, v232
    v_accvgpr_write_b32 a69, v234
    v_accvgpr_read_b32 v235, a70
    v_mul_f32_e64 v235, v235, v232
    v_accvgpr_write_b32 a70, v235
    v_accvgpr_read_b32 v236, a71
    v_mul_f32_e64 v236, v236, v232
    v_accvgpr_write_b32 a71, v236
    v_accvgpr_read_b32 v233, a72
    v_mul_f32_e64 v233, v233, v232
    v_accvgpr_write_b32 a72, v233
    v_accvgpr_read_b32 v234, a73
    v_mul_f32_e64 v234, v234, v232
    v_accvgpr_write_b32 a73, v234
    v_accvgpr_read_b32 v235, a74
    v_mul_f32_e64 v235, v235, v232
    v_accvgpr_write_b32 a74, v235
    v_accvgpr_read_b32 v236, a75
    v_mul_f32_e64 v236, v236, v232
    v_accvgpr_write_b32 a75, v236
    v_accvgpr_read_b32 v233, a76
    v_mul_f32_e64 v233, v233, v232
    v_accvgpr_write_b32 a76, v233
    v_accvgpr_read_b32 v234, a77
    v_mul_f32_e64 v234, v234, v232
    v_accvgpr_write_b32 a77, v234
    v_accvgpr_read_b32 v235, a78
    v_mul_f32_e64 v235, v235, v232
    v_accvgpr_write_b32 a78, v235
    v_accvgpr_read_b32 v236, a79
    v_mul_f32_e64 v236, v236, v232
    v_accvgpr_write_b32 a79, v236
    v_accvgpr_read_b32 v233, a80
    v_mul_f32_e64 v233, v233, v232
    v_accvgpr_write_b32 a80, v233
    v_accvgpr_read_b32 v234, a81
    v_mul_f32_e64 v234, v234, v232
    v_accvgpr_write_b32 a81, v234
    v_accvgpr_read_b32 v235, a82
    v_mul_f32_e64 v235, v235, v232
    v_accvgpr_write_b32 a82, v235
    v_accvgpr_read_b32 v236, a83
    v_mul_f32_e64 v236, v236, v232
    v_accvgpr_write_b32 a83, v236
    v_accvgpr_read_b32 v233, a84
    v_mul_f32_e64 v233, v233, v232
    v_accvgpr_write_b32 a84, v233
    v_accvgpr_read_b32 v234, a85
    v_mul_f32_e64 v234, v234, v232
    v_accvgpr_write_b32 a85, v234
    v_accvgpr_read_b32 v235, a86
    v_mul_f32_e64 v235, v235, v232
    v_accvgpr_write_b32 a86, v235
    v_accvgpr_read_b32 v236, a87
    v_mul_f32_e64 v236, v236, v232
    v_accvgpr_write_b32 a87, v236
    v_accvgpr_read_b32 v233, a88
    v_mul_f32_e64 v233, v233, v232
    v_accvgpr_write_b32 a88, v233
    v_accvgpr_read_b32 v234, a89
    v_mul_f32_e64 v234, v234, v232
    v_accvgpr_write_b32 a89, v234
    v_accvgpr_read_b32 v235, a90
    v_mul_f32_e64 v235, v235, v232
    v_accvgpr_write_b32 a90, v235
    v_accvgpr_read_b32 v236, a91
    v_mul_f32_e64 v236, v236, v232
    v_accvgpr_write_b32 a91, v236
    v_accvgpr_read_b32 v233, a92
    v_mul_f32_e64 v233, v233, v232
    v_accvgpr_write_b32 a92, v233
    v_accvgpr_read_b32 v234, a93
    v_mul_f32_e64 v234, v234, v232
    v_accvgpr_write_b32 a93, v234
    v_accvgpr_read_b32 v235, a94
    v_mul_f32_e64 v235, v235, v232
    v_accvgpr_write_b32 a94, v235
    v_accvgpr_read_b32 v236, a95
    v_mul_f32_e64 v236, v236, v232
    v_accvgpr_write_b32 a95, v236
    v_exp_f32 v128, v16
    v_exp_f32 v129, v17
    v_exp_f32 v130, v18
    v_exp_f32 v131, v19
    v_exp_f32 v132, v20
    v_exp_f32 v133, v21
    v_exp_f32 v134, v22
    v_exp_f32_e64 v135, v23
    s_nop 0
    v_cvt_pk_bf16_f32 v104, v128, v129
    v_cvt_pk_bf16_f32 v105, v130, v131
    v_cvt_pk_bf16_f32 v106, v132, v133
    v_cvt_pk_bf16_f32 v107, v134, v135
    v_max3_f32 v230, v24, v25, v26
    v_max3_f32 v230, v230, v27, v28
    v_max3_f32 v230, v230, v29, v30
    v_max_f32 v230, v230, v31
    v_mov_b32 v231, v230
    s_nop 1
    v_permlane16_swap_b32 v230, v231
    s_nop 0
    v_max_f32 v230, v230, v231
    v_mov_b32 v231, v230
    s_nop 1
    v_permlane32_swap_b32 v230, v231
    s_nop 0
    v_max_f32_e64 v230, v230, v231
    v_add_f32 v230, 0x41800000, v230
    v_max_f32 v230, 0, v230
    v_sub_f32 v232, 0, v230
    v_exp_f32 v232, v232
    v_sub_f32 v227, v227, v230
    v_sub_f32 v88, v88, v230
    v_sub_f32 v56, v56, v230
    v_sub_f32 v24, v24, v230
    v_sub_f32 v89, v89, v230
    v_sub_f32 v57, v57, v230
    v_sub_f32 v25, v25, v230
    v_sub_f32 v90, v90, v230
    v_sub_f32 v58, v58, v230
    v_sub_f32 v26, v26, v230
    v_sub_f32 v91, v91, v230
    v_sub_f32 v59, v59, v230
    v_sub_f32 v27, v27, v230
    v_sub_f32 v92, v92, v230
    v_sub_f32 v60, v60, v230
    v_sub_f32 v28, v28, v230
    v_sub_f32 v93, v93, v230
    v_sub_f32 v61, v61, v230
    v_sub_f32 v29, v29, v230
    v_sub_f32 v94, v94, v230
    v_sub_f32 v62, v62, v230
    v_sub_f32 v30, v30, v230
    v_sub_f32 v95, v95, v230
    v_sub_f32 v63, v63, v230
    v_sub_f32 v31, v31, v230
    v_mul_f32 v156, v156, v232
    v_mul_f32 v157, v157, v232
    v_mul_f32 v158, v158, v232
    v_mul_f32 v159, v159, v232
    v_accvgpr_read_b32 v233, a96
    v_mul_f32_e64 v233, v233, v232
    v_accvgpr_write_b32 a96, v233
    v_accvgpr_read_b32 v234, a97
    v_mul_f32_e64 v234, v234, v232
    v_accvgpr_write_b32 a97, v234
    v_accvgpr_read_b32 v235, a98
    v_mul_f32_e64 v235, v235, v232
    v_accvgpr_write_b32 a98, v235
    v_accvgpr_read_b32 v236, a99
    v_mul_f32_e64 v236, v236, v232
    v_accvgpr_write_b32 a99, v236
    v_accvgpr_read_b32 v233, a100
    v_mul_f32_e64 v233, v233, v232
    v_accvgpr_write_b32 a100, v233
    v_accvgpr_read_b32 v234, a101
    v_mul_f32_e64 v234, v234, v232
    v_accvgpr_write_b32 a101, v234
    v_accvgpr_read_b32 v235, a102
    v_mul_f32_e64 v235, v235, v232
    v_accvgpr_write_b32 a102, v235
    v_accvgpr_read_b32 v236, a103
    v_mul_f32_e64 v236, v236, v232
    v_accvgpr_write_b32 a103, v236
    v_accvgpr_read_b32 v233, a104
    v_mul_f32_e64 v233, v233, v232
    v_accvgpr_write_b32 a104, v233
    v_accvgpr_read_b32 v234, a105
    v_mul_f32_e64 v234, v234, v232
    v_accvgpr_write_b32 a105, v234
    v_accvgpr_read_b32 v235, a106
    v_mul_f32_e64 v235, v235, v232
    v_accvgpr_write_b32 a106, v235
    v_accvgpr_read_b32 v236, a107
    v_mul_f32_e64 v236, v236, v232
    v_accvgpr_write_b32 a107, v236
    v_accvgpr_read_b32 v233, a108
    v_mul_f32_e64 v233, v233, v232
    v_accvgpr_write_b32 a108, v233
    v_accvgpr_read_b32 v234, a109
    v_mul_f32_e64 v234, v234, v232
    v_accvgpr_write_b32 a109, v234
    v_accvgpr_read_b32 v235, a110
    v_mul_f32_e64 v235, v235, v232
    v_accvgpr_write_b32 a110, v235
    v_accvgpr_read_b32 v236, a111
    v_mul_f32_e64 v236, v236, v232
    v_accvgpr_write_b32 a111, v236
    v_accvgpr_read_b32 v233, a112
    v_mul_f32_e64 v233, v233, v232
    v_accvgpr_write_b32 a112, v233
    v_accvgpr_read_b32 v234, a113
    v_mul_f32_e64 v234, v234, v232
    v_accvgpr_write_b32 a113, v234
    v_accvgpr_read_b32 v235, a114
    v_mul_f32_e64 v235, v235, v232
    v_accvgpr_write_b32 a114, v235
    v_accvgpr_read_b32 v236, a115
    v_mul_f32_e64 v236, v236, v232
    v_accvgpr_write_b32 a115, v236
    v_accvgpr_read_b32 v233, a116
    v_mul_f32_e64 v233, v233, v232
    v_accvgpr_write_b32 a116, v233
    v_accvgpr_read_b32 v234, a117
    v_mul_f32_e64 v234, v234, v232
    v_accvgpr_write_b32 a117, v234
    v_accvgpr_read_b32 v235, a118
    v_mul_f32_e64 v235, v235, v232
    v_accvgpr_write_b32 a118, v235
    v_accvgpr_read_b32 v236, a119
    v_mul_f32_e64 v236, v236, v232
    v_accvgpr_write_b32 a119, v236
    v_accvgpr_read_b32 v233, a120
    v_mul_f32_e64 v233, v233, v232
    v_accvgpr_write_b32 a120, v233
    v_accvgpr_read_b32 v234, a121
    v_mul_f32_e64 v234, v234, v232
    v_accvgpr_write_b32 a121, v234
    v_accvgpr_read_b32 v235, a122
    v_mul_f32_e64 v235, v235, v232
    v_accvgpr_write_b32 a122, v235
    v_accvgpr_read_b32 v236, a123
    v_mul_f32_e64 v236, v236, v232
    v_accvgpr_write_b32 a123, v236
    v_accvgpr_read_b32 v233, a124
    v_mul_f32_e64 v233, v233, v232
    v_accvgpr_write_b32 a124, v233
    v_accvgpr_read_b32 v234, a125
    v_mul_f32_e64 v234, v234, v232
    v_accvgpr_write_b32 a125, v234
    v_accvgpr_read_b32 v235, a126
    v_mul_f32_e64 v235, v235, v232
    v_accvgpr_write_b32 a126, v235
    v_accvgpr_read_b32 v236, a127
    v_mul_f32_e64 v236, v236, v232
    v_accvgpr_write_b32 a127, v236
    v_exp_f32 v128, v24
    v_exp_f32 v129, v25
    v_exp_f32 v130, v26
    v_exp_f32 v131, v27
    v_exp_f32 v132, v28
    v_exp_f32 v133, v29
    v_exp_f32 v134, v30
    v_exp_f32_e64 v135, v31
    s_nop 0
    v_cvt_pk_bf16_f32 v108, v128, v129
    v_cvt_pk_bf16_f32 v109, v130, v131
    v_cvt_pk_bf16_f32 v110, v132, v133
    v_cvt_pk_bf16_f32 v111, v134, v135
    s_nop 1
    s_branch kf_rr25
kf_rare30:
    s_nop 15
    v_max3_f32 v230, v48, v49, v50
    v_max3_f32 v230, v230, v51, v52
    v_max3_f32 v230, v230, v53, v54
    v_max_f32 v230, v230, v55
    v_mov_b32 v231, v230
    s_nop 1
    v_permlane16_swap_b32 v230, v231
    s_nop 0
    v_max_f32 v230, v230, v231
    v_mov_b32 v231, v230
    s_nop 1
    v_permlane32_swap_b32 v230, v231
    s_nop 0
    v_max_f32 v230, v230, v231
    v_add_f32 v230, 0x41800000, v230
    v_max_f32 v230, 0, v230
    v_sub_f32 v232, 0, v230
    v_exp_f32 v232, v232
    v_sub_f32 v226, v226, v230
    v_sub_f32 v80, v80, v230
    v_sub_f32 v16, v16, v230
    v_sub_f32 v48, v48, v230
    v_sub_f32 v81, v81, v230
    v_sub_f32 v17, v17, v230
    v_sub_f32 v49, v49, v230
    v_sub_f32 v82, v82, v230
    v_sub_f32 v18, v18, v230
    v_sub_f32 v50, v50, v230
    v_sub_f32 v83, v83, v230
    v_sub_f32 v19, v19, v230
    v_sub_f32 v51, v51, v230
    v_sub_f32 v84, v84, v230
    v_sub_f32 v20, v20, v230
    v_sub_f32 v52, v52, v230
    v_sub_f32 v85, v85, v230
    v_sub_f32 v21, v21, v230
    v_sub_f32 v53, v53, v230
    v_sub_f32 v86, v86, v230
    v_sub_f32 v22, v22, v230
    v_sub_f32 v54, v54, v230
    v_sub_f32 v87, v87, v230
    v_sub_f32 v23, v23, v230
    v_sub_f32 v55, v55, v230
    v_mul_f32 v152, v152, v232
    v_mul_f32 v153, v153, v232
    v_mul_f32 v154, v154, v232
    v_mul_f32 v155, v155, v232
    v_accvgpr_read_b32 v233, a64
    v_mul_f32_e64 v233, v233, v232
    v_accvgpr_write_b32 a64, v233
    v_accvgpr_read_b32 v234, a65
    v_mul_f32_e64 v234, v234, v232
    v_accvgpr_write_b32 a65, v234
    v_accvgpr_read_b32 v235, a66
    v_mul_f32_e64 v235, v235, v232
    v_accvgpr_write_b32 a66, v235
    v_accvgpr_read_b32 v236, a67
    v_mul_f32_e64 v236, v236, v232
    v_accvgpr_write_b32 a67, v236
    v_accvgpr_read_b32 v233, a68
    v_mul_f32_e64 v233, v233, v232
    v_accvgpr_write_b32 a68, v233
    v_accvgpr_read_b32 v234, a69
    v_mul_f32_e64 v234, v234, v232
    v_accvgpr_write_b32 a69, v234
    v_accvgpr_read_b32 v235, a70
    v_mul_f32_e64 v235, v235, v232
    v_accvgpr_write_b32 a70, v235
    v_accvgpr_read_b32 v236, a71
    v_mul_f32_e64 v236, v236, v232
    v_accvgpr_write_b32 a71, v236
    v_accvgpr_read_b32 v233, a72
    v_mul_f32_e64 v233, v233, v232
    v_accvgpr_write_b32 a72, v233
    v_accvgpr_read_b32 v234, a73
    v_mul_f32_e64 v234, v234, v232
    v_accvgpr_write_b32 a73, v234
    v_accvgpr_read_b32 v235, a74
    v_mul_f32_e64 v235, v235, v232
    v_accvgpr_write_b32 a74, v235
    v_accvgpr_read_b32 v236, a75
    v_mul_f32_e64 v236, v236, v232
    v_accvgpr_write_b32 a75, v236
    v_accvgpr_read_b32 v233, a76
    v_mul_f32_e64 v233, v233, v232
    v_accvgpr_write_b32 a76, v233
    v_accvgpr_read_b32 v234, a77
    v_mul_f32_e64 v234, v234, v232
    v_accvgpr_write_b32 a77, v234
    v_accvgpr_read_b32 v235, a78
    v_mul_f32_e64 v235, v235, v232
    v_accvgpr_write_b32 a78, v235
    v_accvgpr_read_b32 v236, a79
    v_mul_f32_e64 v236, v236, v232
    v_accvgpr_write_b32 a79, v236
    v_accvgpr_read_b32 v233, a80
    v_mul_f32_e64 v233, v233, v232
    v_accvgpr_write_b32 a80, v233
    v_accvgpr_read_b32 v234, a81
    v_mul_f32_e64 v234, v234, v232
    v_accvgpr_write_b32 a81, v234
    v_accvgpr_read_b32 v235, a82
    v_mul_f32_e64 v235, v235, v232
    v_accvgpr_write_b32 a82, v235
    v_accvgpr_read_b32 v236, a83
    v_mul_f32_e64 v236, v236, v232
    v_accvgpr_write_b32 a83, v236
    v_accvgpr_read_b32 v233, a84
    v_mul_f32_e64 v233, v233, v232
    v_accvgpr_write_b32 a84, v233
    v_accvgpr_read_b32 v234, a85
    v_mul_f32_e64 v234, v234, v232
    v_accvgpr_write_b32 a85, v234
    v_accvgpr_read_b32 v235, a86
    v_mul_f32_e64 v235, v235, v232
    v_accvgpr_write_b32 a86, v235
    v_accvgpr_read_b32 v236, a87
    v_mul_f32_e64 v236, v236, v232
    v_accvgpr_write_b32 a87, v236
    v_accvgpr_read_b32 v233, a88
    v_mul_f32_e64 v233, v233, v232
    v_accvgpr_write_b32 a88, v233
    v_accvgpr_read_b32 v234, a89
    v_mul_f32_e64 v234, v234, v232
    v_accvgpr_write_b32 a89, v234
    v_accvgpr_read_b32 v235, a90
    v_mul_f32_e64 v235, v235, v232
    v_accvgpr_write_b32 a90, v235
    v_accvgpr_read_b32 v236, a91
    v_mul_f32_e64 v236, v236, v232
    v_accvgpr_write_b32 a91, v236
    v_accvgpr_read_b32 v233, a92
    v_mul_f32_e64 v233, v233, v232
    v_accvgpr_write_b32 a92, v233
    v_accvgpr_read_b32 v234, a93
    v_mul_f32_e64 v234, v234, v232
    v_accvgpr_write_b32 a93, v234
    v_accvgpr_read_b32 v235, a94
    v_mul_f32_e64 v235, v235, v232
    v_accvgpr_write_b32 a94, v235
    v_accvgpr_read_b32 v236, a95
    v_mul_f32_e64 v236, v236, v232
    v_accvgpr_write_b32 a95, v236
    v_exp_f32 v128, v48
    v_exp_f32 v129, v49
    v_exp_f32 v130, v50
    v_exp_f32 v131, v51
    v_exp_f32 v132, v52
    v_exp_f32 v133, v53
    v_exp_f32 v134, v54
    v_exp_f32_e64 v135, v55
    s_nop 0
    v_cvt_pk_bf16_f32 v120, v128, v129
    v_cvt_pk_bf16_f32 v121, v130, v131
    v_cvt_pk_bf16_f32 v122, v132, v133
    v_cvt_pk_bf16_f32 v123, v134, v135
    v_max3_f32 v230, v56, v57, v58
    v_max3_f32 v230, v230, v59, v60
    v_max3_f32 v230, v230, v61, v62
    v_max_f32 v230, v230, v63
    v_mov_b32 v231, v230
    s_nop 1
    v_permlane16_swap_b32 v230, v231
    s_nop 0
    v_max_f32 v230, v230, v231
    v_mov_b32 v231, v230
    s_nop 1
    v_permlane32_swap_b32 v230, v231
    s_nop 0
    v_max_f32_e64 v230, v230, v231
    v_add_f32 v230, 0x41800000, v230
    v_max_f32 v230, 0, v230
    v_sub_f32 v232, 0, v230
    v_exp_f32 v232, v232
    v_sub_f32 v227, v227, v230
    v_sub_f32 v88, v88, v230
    v_sub_f32 v24, v24, v230
    v_sub_f32 v56, v56, v230
    v_sub_f32 v89, v89, v230
    v_sub_f32 v25, v25, v230
    v_sub_f32 v57, v57, v230
    v_sub_f32 v90, v90, v230
    v_sub_f32 v26, v26, v230
    v_sub_f32 v58, v58, v230
    v_sub_f32 v91, v91, v230
    v_sub_f32 v27, v27, v230
    v_sub_f32 v59, v59, v230
    v_sub_f32 v92, v92, v230
    v_sub_f32 v28, v28, v230
    v_sub_f32 v60, v60, v230
    v_sub_f32 v93, v93, v230
    v_sub_f32 v29, v29, v230
    v_sub_f32 v61, v61, v230
    v_sub_f32 v94, v94, v230
    v_sub_f32 v30, v30, v230
    v_sub_f32 v62, v62, v230
    v_sub_f32 v95, v95, v230
    v_sub_f32 v31, v31, v230
    v_sub_f32 v63, v63, v230
    v_mul_f32 v156, v156, v232
    v_mul_f32 v157, v157, v232
    v_mul_f32 v158, v158, v232
    v_mul_f32 v159, v159, v232
    v_accvgpr_read_b32 v233, a96
    v_mul_f32_e64 v233, v233, v232
    v_accvgpr_write_b32 a96, v233
    v_accvgpr_read_b32 v234, a97
    v_mul_f32_e64 v234, v234, v232
    v_accvgpr_write_b32 a97, v234
    v_accvgpr_read_b32 v235, a98
    v_mul_f32_e64 v235, v235, v232
    v_accvgpr_write_b32 a98, v235
    v_accvgpr_read_b32 v236, a99
    v_mul_f32_e64 v236, v236, v232
    v_accvgpr_write_b32 a99, v236
    v_accvgpr_read_b32 v233, a100
    v_mul_f32_e64 v233, v233, v232
    v_accvgpr_write_b32 a100, v233
    v_accvgpr_read_b32 v234, a101
    v_mul_f32_e64 v234, v234, v232
    v_accvgpr_write_b32 a101, v234
    v_accvgpr_read_b32 v235, a102
    v_mul_f32_e64 v235, v235, v232
    v_accvgpr_write_b32 a102, v235
    v_accvgpr_read_b32 v236, a103
    v_mul_f32_e64 v236, v236, v232
    v_accvgpr_write_b32 a103, v236
    v_accvgpr_read_b32 v233, a104
    v_mul_f32_e64 v233, v233, v232
    v_accvgpr_write_b32 a104, v233
    v_accvgpr_read_b32 v234, a105
    v_mul_f32_e64 v234, v234, v232
    v_accvgpr_write_b32 a105, v234
    v_accvgpr_read_b32 v235, a106
    v_mul_f32_e64 v235, v235, v232
    v_accvgpr_write_b32 a106, v235
    v_accvgpr_read_b32 v236, a107
    v_mul_f32_e64 v236, v236, v232
    v_accvgpr_write_b32 a107, v236
    v_accvgpr_read_b32 v233, a108
    v_mul_f32_e64 v233, v233, v232
    v_accvgpr_write_b32 a108, v233
    v_accvgpr_read_b32 v234, a109
    v_mul_f32_e64 v234, v234, v232
    v_accvgpr_write_b32 a109, v234
    v_accvgpr_read_b32 v235, a110
    v_mul_f32_e64 v235, v235, v232
    v_accvgpr_write_b32 a110, v235
    v_accvgpr_read_b32 v236, a111
    v_mul_f32_e64 v236, v236, v232
    v_accvgpr_write_b32 a111, v236
    v_accvgpr_read_b32 v233, a112
    v_mul_f32_e64 v233, v233, v232
    v_accvgpr_write_b32 a112, v233
    v_accvgpr_read_b32 v234, a113
    v_mul_f32_e64 v234, v234, v232
    v_accvgpr_write_b32 a113, v234
    v_accvgpr_read_b32 v235, a114
    v_mul_f32_e64 v235, v235, v232
    v_accvgpr_write_b32 a114, v235
    v_accvgpr_read_b32 v236, a115
    v_mul_f32_e64 v236, v236, v232
    v_accvgpr_write_b32 a115, v236
    v_accvgpr_read_b32 v233, a116
    v_mul_f32_e64 v233, v233, v232
    v_accvgpr_write_b32 a116, v233
    v_accvgpr_read_b32 v234, a117
    v_mul_f32_e64 v234, v234, v232
    v_accvgpr_write_b32 a117, v234
    v_accvgpr_read_b32 v235, a118
    v_mul_f32_e64 v235, v235, v232
    v_accvgpr_write_b32 a118, v235
    v_accvgpr_read_b32 v236, a119
    v_mul_f32_e64 v236, v236, v232
    v_accvgpr_write_b32 a119, v236
    v_accvgpr_read_b32 v233, a120
    v_mul_f32_e64 v233, v233, v232
    v_accvgpr_write_b32 a120, v233
    v_accvgpr_read_b32 v234, a121
    v_mul_f32_e64 v234, v234, v232
    v_accvgpr_write_b32 a121, v234
    v_accvgpr_read_b32 v235, a122
    v_mul_f32_e64 v235, v235, v232
    v_accvgpr_write_b32 a122, v235
    v_accvgpr_read_b32 v236, a123
    v_mul_f32_e64 v236, v236, v232
    v_accvgpr_write_b32 a123, v236
    v_accvgpr_read_b32 v233, a124
    v_mul_f32_e64 v233, v233, v232
    v_accvgpr_write_b32 a124, v233
    v_accvgpr_read_b32 v234, a125
    v_mul_f32_e64 v234, v234, v232
    v_accvgpr_write_b32 a125, v234
    v_accvgpr_read_b32 v235, a126
    v_mul_f32_e64 v235, v235, v232
    v_accvgpr_write_b32 a126, v235
    v_accvgpr_read_b32 v236, a127
    v_mul_f32_e64 v236, v236, v232
    v_accvgpr_write_b32 a127, v236
    v_exp_f32 v128, v56
    v_exp_f32 v129, v57
    v_exp_f32 v130, v58
    v_exp_f32 v131, v59
    v_exp_f32 v132, v60
    v_exp_f32 v133, v61
    v_exp_f32 v134, v62
    v_exp_f32_e64 v135, v63
    s_nop 0
    v_cvt_pk_bf16_f32 v124, v128, v129
    v_cvt_pk_bf16_f32 v125, v130, v131
    v_cvt_pk_bf16_f32 v126, v132, v133
    v_cvt_pk_bf16_f32 v127, v134, v135
    s_nop 1
    s_branch kf_rr29
kf_spin31:
    s_mov_b32 s25, 0x400000
kf_spin31_l:
    s_sleep 2
    buffer_load_dword v254, off, s[88:91], s97 sc1
    s_waitcnt vmcnt(0)
    v_readfirstlane_b32 s24, v254
    s_sub_u32 s25, s25, 1
    s_cbranch_scc1 kf_spinr32
    s_cmp_ge_u32 s24, 1
    s_cbranch_scc0 kf_spin31_l
    s_branch kf_spinr32
kf_spin33:
    s_mov_b32 s25, 0x400000
kf_spin33_l:
    s_sleep 2
    buffer_load_dword v254, off, s[88:91], s39 sc1
    s_waitcnt vmcnt(0)
    v_readfirstlane_b32 s24, v254
    s_sub_u32 s25, s25, 1
    s_cbranch_scc1 kf_spinr34
    s_cmp_ge_u32 s24, 32
    s_cbranch_scc0 kf_spin33_l
    s_branch kf_spinr34
kf_spin35:
    s_mov_b32 s25, 0x400000
kf_spin35_l:
    s_sleep 2
    buffer_load_dword v254, off, s[88:91], s97 sc1
    s_waitcnt vmcnt(0)
    v_readfirstlane_b32 s24, v254
    s_sub_u32 s25, s25, 1
    s_cbranch_scc1 kf_spinr36
    s_cmp_ge_u32 s24, 1
    s_cbranch_scc0 kf_spin35_l
    s_branch kf_spinr36
kf_spin37:
    s_mov_b32 s25, 0x400000
kf_spin37_l:
    s_sleep 2
    buffer_load_dword v254, off, s[88:91], s39 sc1
    s_waitcnt vmcnt(0)
    v_readfirstlane_b32 s24, v254
    s_sub_u32 s25, s25, 1
    s_cbranch_scc1 kf_spinr38
    s_cmp_ge_u32 s24, 32
    s_cbranch_scc0 kf_spin37_l
    s_branch kf_spinr38
kf_spin39:
    s_mov_b32 s25, 0x400000
kf_spin39_l:
    s_sleep 2
    buffer_load_dword v254, off, s[88:91], s35 sc1
    s_waitcnt vmcnt(0)
    v_readfirstlane_b32 s24, v254
    s_sub_u32 s25, s25, 1
    s_cbranch_scc1 kf_spinr40
    s_cmp_ge_u32 s24, 8
    s_cbranch_scc0 kf_spin39_l
    s_branch kf_spinr40

code_end:
.section .rodata,"a"
.p2align 6
.amdhsa_kernel sequential_preLN__compressed_kv_cla__moe_arch_mod__prompt_kernel
  .amdhsa_next_free_vgpr 512
  .amdhsa_next_free_sgpr 102
  .amdhsa_accum_offset 256
  .amdhsa_group_segment_fixed_size 0
  .amdhsa_kernarg_size 112
  .amdhsa_user_sgpr_count 2
  .amdhsa_user_sgpr_kernarg_segment_ptr 1
  .amdhsa_system_sgpr_workgroup_id_x 1
  .amdhsa_float_denorm_mode_32 3
.end_amdhsa_kernel
```

```asm
; @launch grid=(256,1,1) block=(256,1,1) lds=163840
.amdgcn_target "amdgcn-amd-amdhsa--gfx950"
.text
.globl sequential_preLN__compressed_kv_cla__moe_arch_mod__prompt_kernel
.p2align 8
.type sequential_preLN__compressed_kv_cla__moe_arch_mod__prompt_kernel,@function
sequential_preLN__compressed_kv_cla__moe_arch_mod__prompt_kernel:
    s_cmp_ge_u32 s2, 256
    s_cbranch_scc1 ka_done
    s_load_dwordx8 s[64:71], s[0:1], 0
    s_load_dwordx4 s[72:75], s[0:1], 32
    s_load_dwordx4 s[76:79], s[0:1], 64
    s_load_dwordx8 s[8:15], s[0:1], 80
    v_lshrrev_b32 v1, 6, v0
    v_and_b32 v2, 63, v0
    v_readfirstlane_b32 s3, v1
    v_mov_b32_e64 v253, v0
    s_and_b32 s4, s2, 7
    s_lshl_b32 s4, s4, 2
    s_lshr_b32 s24, s2, 3
    s_and_b32 s24, s24, 3
    s_add_u32 s4, s4, s24
    s_lshr_b32 s5, s2, 5
    s_lshl2_add_u32 s6, s5, s3
    s_getpc_b64 s[56:57]
ka_pc:
    s_mov_b32 s58, code_end-ka_pc
    s_mov_b32 s59, 0x00020000
    s_lshr_b32 s24, s2, 3
    s_xor_b32 s24, s24, 31
    s_lshl2_add_u32 s24, s24, s3
    s_lshl_b32 s24, s24, 13
    v_lshlrev_b32_e64 v3, 7, v2
    buffer_load_dword v252, v3, s[56:59], s24 offen
    v_mov_b32 v192, v2
    v_lshrrev_b32 v198, 3, v192
    v_and_b32 v199, 7, v192
    s_lshr_b32 s24, s3, 1
    s_lshl_b32 s24, s24, 5
    s_and_b32 s25, s3, 1
    s_lshl_b32 s26, s25, 3
    s_add_u32 s24, s24, s26
    v_add_u32 v194, s24, v198
    v_lshlrev_b32 v194, 10, v194
    v_lshrrev_b32 v195, 1, v198
    v_xor_b32 v195, v199, v195
    v_lshl_add_u32 v232, v195, 4, v194
    v_xor_b32_e64 v195, 4, v195
    v_lshl_add_u32 v233, v195, 4, v194
    v_add_u32 v233, 15360, v233
    s_lshl_b32 s24, s4, 8
    s_lshl_b32 s26, s25, 7
    s_add_u32 s24, s24, s26
    v_lshlrev_b32 v194, 13, v198
    v_add_u32_e64 v194, s24, v194
    v_bfe_u32 v195, v198, 1, 1
    v_xor_b32_e64 v195, v199, v195
    v_lshl_add_u32 v234, v195, 4, v194
    v_xor_b32_e64 v195, 4, v195
    v_lshl_add_u32 v235, v195, 4, v194
    v_add_u32 v235, 64512, v235
    s_lshl_b32 s34, s3, 11
    s_mul_i32 s35, s3, 24576
    s_add_u32 s35, s35, 65536
    s_lshl_b32 s32, s5, 18
    s_and_b32 s7, s4, 3
    s_lshl1_add_u32 s7, s7, s5
    s_add_u32 s80, s7, 0
    s_and_b32 s80, s80, 7
    s_lshl_b32 s80, s80, 7
    s_add_u32 s80, s80, s32
    s_waitcnt lgkmcnt(0)
    s_cmp_lt_u32 s3, 2
    s_cselect_b32 s48, s70, s72
    s_cselect_b32 s49, s71, s73
    s_mov_b32 s50, 0x400000
    s_mov_b32 s51, 0x00020000
    s_mov_b32 s44, s66
    s_mov_b32 s45, s67
    s_mov_b32 s46, 0x200000
    s_mov_b32 s47, 0x00020000
    s_add_u32 m0, s35, 0
    s_and_b32 s33, s80, 1023
    s_lshl_b32 s33, s33, 12
    buffer_load_dwordx4 v234, s[48:51], s33 offen lds
    buffer_load_dwordx4 v235, s[48:51], s33 offen offset:1024 lds
    s_add_u32 m0, s35, 2048
    s_add_u32 s33, s33, 131072
    buffer_load_dwordx4 v234, s[48:51], s33 offen lds
    buffer_load_dwordx4 v235, s[48:51], s33 offen offset:1024 lds
    s_add_u32 m0, s34, 0
    s_add_u32 s37, s80, 0
    buffer_load_dwordx4 v232, s[44:47], s37 offen lds
    buffer_load_dwordx4 v233, s[44:47], s37 offen offset:1024 lds
    s_add_u32 m0, s34, 8192
    s_add_u32 s37, s80, 65536
    buffer_load_dwordx4 v232, s[44:47], s37 offen lds
    buffer_load_dwordx4 v233, s[44:47], s37 offen offset:1024 lds
    s_add_u32 m0, s35, 4096
    s_add_u32 s33, s33, 131072
    buffer_load_dwordx4 v234, s[48:51], s33 offen lds
    buffer_load_dwordx4 v235, s[48:51], s33 offen offset:1024 lds
    s_add_u32 m0, s35, 6144
    s_add_u32 s33, s33, 131072
    buffer_load_dwordx4 v234, s[48:51], s33 offen lds
    buffer_load_dwordx4 v235, s[48:51], s33 offen offset:1024 lds
    s_mov_b32 s52, s64
    s_mov_b32 s53, s65
    s_mov_b32 s54, 0x400000
    s_mov_b32 s55, 0x00020000
    s_add_u32 s16, s14, 0x5c00000
    s_addc_u32 s17, s15, 0
    s_mov_b32 s18, 0x2140000
    s_mov_b32 s19, 0x00020000
    s_add_u32 s56, s14, 0x3800000
    s_addc_u32 s57, s15, 0
    s_mov_b32 s58, 0x6040
    s_mov_b32 s59, 0x00020000
    s_add_u32 s20, s14, 0x2400000
    s_addc_u32 s21, s15, 0
    s_mov_b32 s22, 0x1000000
    s_mov_b32 s23, 0x00020000
    s_mov_b32 s88, s12
    s_mov_b32 s89, s13
    s_mov_b32 s90, 0x100
    s_mov_b32 s91, 0x00020000
    s_cmp_lt_u32 s3, 2
    s_cselect_b32 s60, s8, s74
    s_cselect_b32 s61, s9, s75
    s_mov_b32 s62, 0x800000
    s_cselect_b32 s62, 0x700000, s62
    s_mov_b32 s63, 0x00020000
    s_cselect_b32 s41, s76, s78
    s_cselect_b32 s42, s77, s79
    s_mov_b32 s8, s14
    s_mov_b32 s9, s15
    s_mov_b32 s10, 0x400000
    s_mov_b32 s11, 0x00020000
    s_mov_b32 s12, s68
    s_mov_b32 s13, s69
    s_mov_b32 s14, 0x800000
    s_mov_b32 s15, 0x00020000
    s_add_u32 s81, s7, 1
    s_and_b32 s81, s81, 7
    s_lshl_b32 s81, s81, 7
    s_add_u32 s81, s81, s32
    s_add_u32 s82, s7, 2
    s_and_b32 s82, s82, 7
    s_lshl_b32 s82, s82, 7
    s_add_u32 s82, s82, s32
    s_add_u32 s83, s7, 3
    s_and_b32 s83, s83, 7
    s_lshl_b32 s83, s83, 7
    s_add_u32 s83, s83, s32
    s_add_u32 s84, s7, 4
    s_and_b32 s84, s84, 7
    s_lshl_b32 s84, s84, 7
    s_add_u32 s84, s84, s32
    s_add_u32 s85, s7, 5
    s_and_b32 s85, s85, 7
    s_lshl_b32 s85, s85, 7
    s_add_u32 s85, s85, s32
    s_add_u32 s86, s7, 6
    s_and_b32 s86, s86, 7
    s_lshl_b32 s86, s86, 7
    s_add_u32 s86, s86, s32
    s_add_u32 s87, s7, 7
    s_and_b32 s87, s87, 7
    s_lshl_b32 s87, s87, 7
    s_add_u32 s87, s87, s32
    s_cmp_eq_u32 s2, 200
    s_mov_b32 s97, 0x40000000
    s_cselect_b32 s97, 0xa0000, s97
    s_mov_b32 s58, 0xa5000
    v_lshlrev_b32 v194, 7, v253
    v_mov_b32_e64 v195, 0
    buffer_store_dword v195, v194, s[56:59], s97 offen sc1
    s_cselect_b32 s97, 0, 0x40000000
    s_mov_b32 s58, 0x6040
    v_and_b32 v200, 15, v192
    v_lshrrev_b32 v201, 4, v192
    v_lshrrev_b32 v194, 1, v200
    v_xor_b32 v194, v201, v194
    v_lshlrev_b32 v194, 4, v194
    v_lshl_add_u32 v224, v200, 7, v194
    v_xor_b32 v225, 64, v224
    v_lshrrev_b32 v194, 2, v200
    v_lshl_add_u32 v195, v201, 3, v194
    v_lshlrev_b32 v195, 7, v195
    v_add_u32 v195, s35, v195
    v_and_b32_e64 v196, 1, v200
    v_lshl_add_u32 v195, v196, 3, v195
    v_lshrrev_b32 v194, 1, v194
    v_and_b32 v196, 1, v201
    v_lshl_or_b32 v194, v196, 2, v194
    v_and_b32 v196, 2, v200
    v_xor_b32 v194, v194, v196
    v_xor_b32_e64 v196, 0, v194
    v_lshl_add_u32 v228, v196, 4, v195
    v_xor_b32_e64 v196, 1, v194
    v_lshl_add_u32 v229, v196, 4, v195
    v_xor_b32_e64 v196, 4, v194
    v_lshl_add_u32 v230, v196, 4, v195
    v_xor_b32_e64 v196, 5, v194
    v_lshl_add_u32 v231, v196, 4, v195
    s_mul_i32 s36, s4, 1089536
    s_mul_i32 s24, s5, 136192
    s_add_u32 s36, s36, s24
    s_and_b32 s24, s3, 1
    s_lshl_b32 s24, s24, 12
    s_and_b32 s26, s3, 2
    s_lshl_b32 s26, s26, 13
    s_add_u32 s36, s36, s24
    s_add_u32 s36, s36, s26
    s_lshl_b32 s24, s5, 7
    s_sub_u32 s26, 1792, s24
    s_cmp_lt_u32 s4, 16
    s_cselect_b32 s24, s24, s26
    s_lshl_b32 s26, s4, 3
    s_add_u32 s24, s24, s26
    v_lshrrev_b32 v194, 5, v253
    v_add_u32 v196, s24, v194
    v_and_b32 v195, 31, v192
    v_lshlrev_b32 v196, 11, v196
    v_lshl_add_u32 v236, v195, 4, v196
    v_xor_b32 v194, v194, v199
    v_lshlrev_b32 v194, 4, v194
    v_lshl_add_u32 v194, v195, 7, v194
    v_add_u32 v237, 81920, v194
    s_lshr_b32 s26, s24, 4
    s_lshl_b32 s26, s26, 15
    s_and_b32 s24, s24, 15
    s_lshl_b32 s24, s24, 4
    s_add_u32 s24, s24, s26
    v_lshrrev_b32 v194, 3, v253
    v_lshlrev_b32 v194, 8, v194
    v_xor_b32 v195, v199, v198
    v_lshl_add_u32 v194, v195, 4, v194
    v_add_u32 v238, s24, v194
    v_lshlrev_b32 v240, 4, v192
    s_lshl_b32 s24, s3, 12
    v_add_u32 v242, s24, v240
    s_lshl_b32 s24, s6, 16
    v_add_u32 v248, s24, v240
    s_sub_u32 s25, 63, s6
    s_lshl_b32 s24, s25, 16
    v_add_u32_e64 v249, s24, v240
    v_bfe_u32 v194, v192, 2, 2
    v_lshlrev_b32_e64 v194, 13, v194
    v_lshl_add_u32 v194, v201, 6, v194
    v_and_b32_e64 v195, 3, v192
    v_lshl_add_u32 v194, v195, 4, v194
    s_lshl_b32 s24, s4, 8
    s_lshl_b32 s25, s3, 18
    s_add_u32 s24, s24, s25
    v_add_u32_e64 v245, s24, v194
    s_lshl_b32 s31, s3, 13
    s_add_u32 s31, s31, 65536
    s_lshl_b32 s27, s5, 20
    s_mov_b32 s7, s27
    s_mov_b32 s43, 0x40000000
    s_lshr_b32 s28, s27, 8
    s_add_u32 s29, s28, 32768
    s_nop 0
    v_lshlrev_b32 v194, 11, v201
    v_bfe_u32 v195, v192, 2, 2
    v_lshl_add_u32 v194, v195, 6, v194
    v_bfe_u32 v195, v192, 4, 1
    v_lshl_add_u32 v194, v195, 4, v194
    v_and_b32_e64 v195, 1, v192
    v_lshl_add_u32 v194, v195, 3, v194
    v_bfe_u32 v195, v192, 1, 1
    v_lshl_add_u32 v247, v195, 5, v194
    s_mov_b32 s30, 65536
    v_add_u32 v246, s30, v247
    v_lshrrev_b32 v195, 5, v192
    v_lshlrev_b32 v195, 4, v195
    v_sub_u32 v194, v200, v195
    v_bfe_u32 v195, v192, 4, 1
    v_lshlrev_b32 v195, 2, v195
    v_sub_u32 v194, v194, v195
    v_cvt_f32_i32 v194, v194
    v_add_f32 v194, 0.5, v194
    v_mul_f32 v243, 0x71800000, v194
    v_add_u32 v244, 0x20000, v240
    v_lshlrev_b32 v251, 7, v192
    v_cmp_gt_u32 vcc, 16, v192
    v_mov_b32 v194, 0x40000000
    v_mov_b32 v255, 1
    v_cndmask_b32 v251, v194, v251, vcc
    v_cmp_eq_u32 vcc, 0, v253
    s_nop 1
    v_cndmask_b32 v250, v194, v253, vcc
    s_add_u32 m0, s35, 8192
    s_and_b32 s33, s81, 1023
    s_lshl_b32 s33, s33, 12
    buffer_load_dwordx4 v234, s[48:51], s33 offen lds
    buffer_load_dwordx4 v235, s[48:51], s33 offen offset:1024 lds
    s_add_u32 m0, s35, 10240
    s_add_u32 s33, s33, 131072
    buffer_load_dwordx4 v234, s[48:51], s33 offen lds
    buffer_load_dwordx4 v235, s[48:51], s33 offen offset:1024 lds
    s_add_u32 m0, s35, 12288
    s_add_u32 s33, s33, 131072
    buffer_load_dwordx4 v234, s[48:51], s33 offen lds
    buffer_load_dwordx4 v235, s[48:51], s33 offen offset:1024 lds
    s_add_u32 m0, s35, 14336
    s_add_u32 s33, s33, 131072
    buffer_load_dwordx4 v234, s[48:51], s33 offen lds
    buffer_load_dwordx4 v235, s[48:51], s33 offen offset:1024 lds
    s_add_u32 m0, s34, 16384
    s_add_u32 s37, s81, 0
    buffer_load_dwordx4 v232, s[44:47], s37 offen lds
    buffer_load_dwordx4 v233, s[44:47], s37 offen offset:1024 lds
    s_add_u32 m0, s34, 24576
    s_add_u32 s37, s81, 65536
    buffer_load_dwordx4 v232, s[44:47], s37 offen lds
    buffer_load_dwordx4 v233, s[44:47], s37 offen offset:1024 lds
    s_waitcnt vmcnt(19)
    s_barrier
    ds_read_b128 v[64:67], v224 offset:0
    ds_read_b128 v[68:71], v224 offset:2048
    ds_read_b128 v[72:75], v224 offset:4096
    ds_read_b128 v[76:79], v224 offset:6144
    ds_read_b64_tr_b16 a[0:1], v228 offset:0
    ds_read_b64_tr_b16 a[2:3], v228 offset:512
    ds_read_b64_tr_b16 a[4:5], v229 offset:0
    ds_read_b64_tr_b16 a[6:7], v229 offset:512
    ds_read_b64_tr_b16 a[8:9], v230 offset:0
    ds_read_b64_tr_b16 a[10:11], v230 offset:512
    ds_read_b64_tr_b16 a[12:13], v231 offset:0
    ds_read_b64_tr_b16 a[14:15], v231 offset:512
    s_waitcnt vmcnt(12)
    s_barrier
    buffer_store_dword v255, v250, s[88:91], s97 offen sc1
    s_cmp_eq_u32 s3, 0
    s_cselect_b32 s97, 0, s43
    s_cmp_lt_u32 s3, 2
    s_cbranch_scc0 ka_V
    s_waitcnt lgkmcnt(0)
    v_mfma_f32_16x16x32_bf16 v[96:99], a[0:3], v[64:67], 0
    ds_read_b128 v[80:83], v224 offset:8192
    v_mfma_f32_16x16x32_bf16 v[100:103], a[4:7], v[64:67], 0
    ds_read_b128 v[84:87], v224 offset:10240
    v_mfma_f32_16x16x32_bf16 v[104:107], a[8:11], v[64:67], 0
    ds_read_b128 v[88:91], v224 offset:12288
    v_mfma_f32_16x16x32_bf16 v[108:111], a[12:15], v[64:67], 0
    ds_read_b128 v[92:95], v224 offset:14336
    v_mfma_f32_16x16x32_bf16 v[112:115], a[0:3], v[68:71], 0
    ds_read_b64_tr_b16 a[16:17], v228 offset:4096
    v_mfma_f32_16x16x32_bf16 v[116:119], a[4:7], v[68:71], 0
    ds_read_b64_tr_b16 a[18:19], v228 offset:4608
    v_mfma_f32_16x16x32_bf16 v[120:123], a[8:11], v[68:71], 0
    ds_read_b64_tr_b16 a[20:21], v229 offset:4096
    v_mfma_f32_16x16x32_bf16 v[124:127], a[12:15], v[68:71], 0
    ds_read_b64_tr_b16 a[22:23], v229 offset:4608
    v_mfma_f32_16x16x32_bf16 v[128:131], a[0:3], v[72:75], 0
    s_add_u32 m0, s35, 16384
    s_and_b32 s33, s82, 1023
    s_lshl_b32 s33, s33, 12
    buffer_load_dwordx4 v234, s[48:51], s33 offen lds
    v_mfma_f32_16x16x32_bf16 v[132:135], a[4:7], v[72:75], 0
    v_mfma_f32_16x16x32_bf16 v[136:139], a[8:11], v[72:75], 0
    buffer_load_dwordx4 v235, s[48:51], s33 offen offset:1024 lds
    v_mfma_f32_16x16x32_bf16 v[140:143], a[12:15], v[72:75], 0
    v_mfma_f32_16x16x32_bf16 v[144:147], a[0:3], v[76:79], 0
    s_add_u32 m0, s35, 18432
    s_add_u32 s33, s33, 131072
    buffer_load_dwordx4 v234, s[48:51], s33 offen lds
    v_mfma_f32_16x16x32_bf16 v[148:151], a[4:7], v[76:79], 0
    v_mfma_f32_16x16x32_bf16 v[152:155], a[8:11], v[76:79], 0
    buffer_load_dwordx4 v235, s[48:51], s33 offen offset:1024 lds
    v_mfma_f32_16x16x32_bf16 v[156:159], a[12:15], v[76:79], 0
    s_waitcnt lgkmcnt(0)
    v_mfma_f32_16x16x32_bf16 v[160:163], a[0:3], v[80:83], 0
    ds_read_b128 v[64:67], v225 offset:0
    v_mfma_f32_16x16x32_bf16 v[164:167], a[4:7], v[80:83], 0
    ds_read_b128 v[68:71], v225 offset:2048
    v_mfma_f32_16x16x32_bf16 v[168:171], a[8:11], v[80:83], 0
    ds_read_b128 v[72:75], v225 offset:4096
    v_mfma_f32_16x16x32_bf16 v[172:175], a[12:15], v[80:83], 0
    ds_read_b128 v[76:79], v225 offset:6144
    v_mfma_f32_16x16x32_bf16 v[176:179], a[0:3], v[84:87], 0
    ds_read_b64_tr_b16 a[24:25], v230 offset:4096
    v_mfma_f32_16x16x32_bf16 v[180:183], a[4:7], v[84:87], 0
    ds_read_b64_tr_b16 a[26:27], v230 offset:4608
    v_mfma_f32_16x16x32_bf16 v[184:187], a[8:11], v[84:87], 0
    ds_read_b64_tr_b16 a[28:29], v231 offset:4096
    v_mfma_f32_16x16x32_bf16 v[188:191], a[12:15], v[84:87], 0
    ds_read_b64_tr_b16 a[30:31], v231 offset:4608
    v_mfma_f32_16x16x32_bf16 v[192:195], a[0:3], v[88:91], 0
    s_add_u32 m0, s35, 20480
    s_add_u32 s33, s33, 131072
    buffer_load_dwordx4 v234, s[48:51], s33 offen lds
    v_mfma_f32_16x16x32_bf16 v[196:199], a[4:7], v[88:91], 0
    v_mfma_f32_16x16x32_bf16 v[200:203], a[8:11], v[88:91], 0
    buffer_load_dwordx4 v235, s[48:51], s33 offen offset:1024 lds
    v_mfma_f32_16x16x32_bf16 v[204:207], a[12:15], v[88:91], 0
    v_mfma_f32_16x16x32_bf16 v[208:211], a[0:3], v[92:95], 0
    s_add_u32 m0, s35, 22528
    s_add_u32 s33, s33, 131072
    buffer_load_dwordx4 v234, s[48:51], s33 offen lds
    v_mfma_f32_16x16x32_bf16 v[212:215], a[4:7], v[92:95], 0
    v_mfma_f32_16x16x32_bf16 v[216:219], a[8:11], v[92:95], 0
    buffer_load_dwordx4 v235, s[48:51], s33 offen offset:1024 lds
    v_mfma_f32_16x16x32_bf16 v[220:223], a[12:15], v[92:95], 0
    s_waitcnt vmcnt(13) lgkmcnt(0)
    v_mfma_f32_16x16x32_bf16 v[96:99], a[16:19], v[64:67], v[96:99]
    ds_read_b128 v[80:83], v225 offset:8192
    v_mfma_f32_16x16x32_bf16 v[100:103], a[20:23], v[64:67], v[100:103]
    ds_read_b128 v[84:87], v225 offset:10240
    v_mfma_f32_16x16x32_bf16 v[104:107], a[24:27], v[64:67], v[104:107]
    ds_read_b128 v[88:91], v225 offset:12288
    v_mfma_f32_16x16x32_bf16 v[108:111], a[28:31], v[64:67], v[108:111]
    ds_read_b128 v[92:95], v225 offset:14336
    v_mfma_f32_16x16x32_bf16 v[112:115], a[16:19], v[68:71], v[112:115]
    ds_read_b64_tr_b16 a[32:33], v228 offset:8192
    v_mfma_f32_16x16x32_bf16 v[116:119], a[20:23], v[68:71], v[116:119]
    ds_read_b64_tr_b16 a[34:35], v228 offset:8704
    v_mfma_f32_16x16x32_bf16 v[120:123], a[24:27], v[68:71], v[120:123]
    ds_read_b64_tr_b16 a[36:37], v229 offset:8192
    v_mfma_f32_16x16x32_bf16 v[124:127], a[28:31], v[68:71], v[124:127]
    ds_read_b64_tr_b16 a[38:39], v229 offset:8704
    v_mfma_f32_16x16x32_bf16 v[128:131], a[16:19], v[72:75], v[128:131]
    ds_read_b64_tr_b16 a[40:41], v230 offset:8192
    s_add_u32 m0, s34, 32768
    s_add_u32 s37, s82, 0
    buffer_load_dwordx4 v232, s[44:47], s37 offen lds
    v_mfma_f32_16x16x32_bf16 v[132:135], a[20:23], v[72:75], v[132:135]
    ds_read_b64_tr_b16 a[42:43], v230 offset:8704
    buffer_load_dwordx4 v233, s[44:47], s37 offen offset:1024 lds
    v_mfma_f32_16x16x32_bf16 v[136:139], a[24:27], v[72:75], v[136:139]
    ds_read_b64_tr_b16 a[44:45], v231 offset:8192
    s_add_u32 m0, s34, 40960
    s_add_u32 s37, s82, 65536
    buffer_load_dwordx4 v232, s[44:47], s37 offen lds
    v_mfma_f32_16x16x32_bf16 v[140:143], a[28:31], v[72:75], v[140:143]
    ds_read_b64_tr_b16 a[46:47], v231 offset:8704
    buffer_load_dwordx4 v233, s[44:47], s37 offen offset:1024 lds
    v_mfma_f32_16x16x32_bf16 v[144:147], a[16:19], v[76:79], v[144:147]
    s_add_u32 m0, s35, 0
    s_and_b32 s33, s83, 1023
    s_lshl_b32 s33, s33, 12
    buffer_load_dwordx4 v234, s[48:51], s33 offen lds
    v_mfma_f32_16x16x32_bf16 v[148:151], a[20:23], v[76:79], v[148:151]
    buffer_load_dwordx4 v235, s[48:51], s33 offen offset:1024 lds
    v_mfma_f32_16x16x32_bf16 v[152:155], a[24:27], v[76:79], v[152:155]
    s_add_u32 m0, s35, 2048
    s_add_u32 s33, s33, 131072
    buffer_load_dwordx4 v234, s[48:51], s33 offen lds
    v_mfma_f32_16x16x32_bf16 v[156:159], a[28:31], v[76:79], v[156:159]
    buffer_load_dwordx4 v235, s[48:51], s33 offen offset:1024 lds
    s_waitcnt vmcnt(17) lgkmcnt(0)
    s_barrier
    v_mfma_f32_16x16x32_bf16 v[160:163], a[16:19], v[80:83], v[160:163]
    ds_read_b128 v[64:67], v224 offset:16384
    v_mfma_f32_16x16x32_bf16 v[164:167], a[20:23], v[80:83], v[164:167]
    ds_read_b128 v[68:71], v225 offset:16384
    v_mfma_f32_16x16x32_bf16 v[168:171], a[24:27], v[80:83], v[168:171]
    ds_read_b128 v[72:75], v224 offset:18432
    v_mfma_f32_16x16x32_bf16 v[172:175], a[28:31], v[80:83], v[172:175]
    ds_read_b128 v[76:79], v225 offset:18432
    v_mfma_f32_16x16x32_bf16 v[176:179], a[16:19], v[84:87], v[176:179]
    ds_read_b64_tr_b16 a[48:49], v228 offset:12288
    s_add_u32 m0, s34, 49152
    s_add_u32 s37, s83, 0
    buffer_load_dwordx4 v232, s[44:47], s37 offen lds
    v_mfma_f32_16x16x32_bf16 v[180:183], a[20:23], v[84:87], v[180:183]
    ds_read_b64_tr_b16 a[50:51], v228 offset:12800
    buffer_load_dwordx4 v233, s[44:47], s37 offen offset:1024 lds
    v_mfma_f32_16x16x32_bf16 v[184:187], a[24:27], v[84:87], v[184:187]
    ds_read_b64_tr_b16 a[52:53], v229 offset:12288
    s_add_u32 m0, s34, 57344
    s_add_u32 s37, s83, 65536
    buffer_load_dwordx4 v232, s[44:47], s37 offen lds
    v_mfma_f32_16x16x32_bf16 v[188:191], a[28:31], v[84:87], v[188:191]
    ds_read_b64_tr_b16 a[54:55], v229 offset:12800
    buffer_load_dwordx4 v233, s[44:47], s37 offen offset:1024 lds
    v_mfma_f32_16x16x32_bf16 v[192:195], a[16:19], v[88:91], v[192:195]
    ds_read_b64_tr_b16 a[56:57], v230 offset:12288
    s_add_u32 m0, s34, 0
    s_add_u32 s37, s84, 0
    buffer_load_dwordx4 v232, s[44:47], s37 offen lds
    v_mfma_f32_16x16x32_bf16 v[196:199], a[20:23], v[88:91], v[196:199]
    ds_read_b64_tr_b16 a[58:59], v230 offset:12800
    v_mfma_f32_16x16x32_bf16 v[200:203], a[24:27], v[88:91], v[200:203]
    ds_read_b64_tr_b16 a[60:61], v231 offset:12288
    buffer_load_dwordx4 v233, s[44:47], s37 offen offset:1024 lds
    v_mfma_f32_16x16x32_bf16 v[204:207], a[28:31], v[88:91], v[204:207]
    ds_read_b64_tr_b16 a[62:63], v231 offset:12800
    buffer_load_dwordx4 v[0:3], v236, s[52:55], 0 offen offset:0
    v_mfma_f32_16x16x32_bf16 v[208:211], a[16:19], v[92:95], v[208:211]
    buffer_load_dwordx4 v[4:7], v236, s[52:55], 0 offen offset:512
    v_mfma_f32_16x16x32_bf16 v[212:215], a[20:23], v[92:95], v[212:215]
    buffer_load_dwordx4 v[8:11], v236, s[52:55], 0 offen offset:1024
    v_mfma_f32_16x16x32_bf16 v[216:219], a[24:27], v[92:95], v[216:219]
    buffer_load_dwordx4 v[12:15], v236, s[52:55], 0 offen offset:1536
    v_mfma_f32_16x16x32_bf16 v[220:223], a[28:31], v[92:95], v[220:223]
    s_waitcnt lgkmcnt(0)
    v_mfma_f32_16x16x32_bf16 v[96:99], a[32:35], v[64:67], v[96:99]
    ds_read_b128 v[80:83], v224 offset:20480
    v_mfma_f32_16x16x32_bf16 v[96:99], a[48:51], v[68:71], v[96:99]
    ds_read_b128 v[84:87], v225 offset:20480
    v_mfma_f32_16x16x32_bf16 v[100:103], a[36:39], v[64:67], v[100:103]
    ds_read_b128 v[88:91], v224 offset:22528
    v_mfma_f32_16x16x32_bf16 v[100:103], a[52:55], v[68:71], v[100:103]
    ds_read_b128 v[92:95], v225 offset:22528
    v_mfma_f32_16x16x32_bf16 v[104:107], a[40:43], v[64:67], v[104:107]
    v_mfma_f32_16x16x32_bf16 v[104:107], a[56:59], v[68:71], v[104:107]
    v_mfma_f32_16x16x32_bf16 v[108:111], a[44:47], v[64:67], v[108:111]
    v_mfma_f32_16x16x32_bf16 v[108:111], a[60:63], v[68:71], v[108:111]
    v_mfma_f32_16x16x32_bf16 v[112:115], a[32:35], v[72:75], v[112:115]
    s_add_u32 m0, s35, 4096
    s_add_u32 s33, s33, 131072
    buffer_load_dwordx4 v234, s[48:51], s33 offen lds
    v_mfma_f32_16x16x32_bf16 v[112:115], a[48:51], v[76:79], v[112:115]
    v_mfma_f32_16x16x32_bf16 v[116:119], a[36:39], v[72:75], v[116:119]
    buffer_load_dwordx4 v235, s[48:51], s33 offen offset:1024 lds
    v_mfma_f32_16x16x32_bf16 v[116:119], a[52:55], v[76:79], v[116:119]
    v_mfma_f32_16x16x32_bf16 v[120:123], a[40:43], v[72:75], v[120:123]
    s_add_u32 m0, s35, 6144
    s_add_u32 s33, s33, 131072
    buffer_load_dwordx4 v234, s[48:51], s33 offen lds
    v_mfma_f32_16x16x32_bf16 v[120:123], a[56:59], v[76:79], v[120:123]
    v_mfma_f32_16x16x32_bf16 v[124:127], a[44:47], v[72:75], v[124:127]
    buffer_load_dwordx4 v235, s[48:51], s33 offen offset:1024 lds
    v_mfma_f32_16x16x32_bf16 v[124:127], a[60:63], v[76:79], v[124:127]
    s_waitcnt lgkmcnt(0)
    v_mfma_f32_16x16x32_bf16 v[128:131], a[32:35], v[80:83], v[128:131]
    ds_read_b128 v[64:67], v224 offset:24576
    v_mfma_f32_16x16x32_bf16 v[128:131], a[48:51], v[84:87], v[128:131]
    ds_read_b128 v[68:71], v225 offset:24576
    v_mfma_f32_16x16x32_bf16 v[132:135], a[36:39], v[80:83], v[132:135]
    ds_read_b128 v[72:75], v224 offset:26624
    v_mfma_f32_16x16x32_bf16 v[132:135], a[52:55], v[84:87], v[132:135]
    ds_read_b128 v[76:79], v225 offset:26624
    v_mfma_f32_16x16x32_bf16 v[136:139], a[40:43], v[80:83], v[136:139]
    v_mfma_f32_16x16x32_bf16 v[136:139], a[56:59], v[84:87], v[136:139]
    v_mfma_f32_16x16x32_bf16 v[140:143], a[44:47], v[80:83], v[140:143]
    v_mfma_f32_16x16x32_bf16 v[140:143], a[60:63], v[84:87], v[140:143]
    v_mfma_f32_16x16x32_bf16 v[144:147], a[32:35], v[88:91], v[144:147]
    s_add_u32 m0, s34, 8192
    s_add_u32 s37, s84, 65536
    buffer_load_dwordx4 v232, s[44:47], s37 offen lds
    v_mfma_f32_16x16x32_bf16 v[144:147], a[48:51], v[92:95], v[144:147]
    v_mfma_f32_16x16x32_bf16 v[148:151], a[36:39], v[88:91], v[148:151]
    v_mfma_f32_16x16x32_bf16 v[148:151], a[52:55], v[92:95], v[148:151]
    v_mfma_f32_16x16x32_bf16 v[152:155], a[40:43], v[88:91], v[152:155]
    buffer_load_dwordx4 v233, s[44:47], s37 offen offset:1024 lds
    v_mfma_f32_16x16x32_bf16 v[152:155], a[56:59], v[92:95], v[152:155]
    v_mfma_f32_16x16x32_bf16 v[156:159], a[44:47], v[88:91], v[156:159]
    v_mfma_f32_16x16x32_bf16 v[156:159], a[60:63], v[92:95], v[156:159]
    s_waitcnt vmcnt(24) lgkmcnt(0)
    v_mfma_f32_16x16x32_bf16 v[160:163], a[32:35], v[64:67], v[160:163]
    ds_read_b128 v[80:83], v224 offset:28672
    v_mfma_f32_16x16x32_bf16 v[160:163], a[48:51], v[68:71], v[160:163]
    ds_read_b128 v[84:87], v225 offset:28672
    v_mfma_f32_16x16x32_bf16 v[164:167], a[36:39], v[64:67], v[164:167]
    ds_read_b128 v[88:91], v224 offset:30720
    v_mfma_f32_16x16x32_bf16 v[164:167], a[52:55], v[68:71], v[164:167]
    ds_read_b128 v[92:95], v225 offset:30720
    v_mfma_f32_16x16x32_bf16 v[168:171], a[40:43], v[64:67], v[168:171]
    ds_read_b64_tr_b16 a[64:65], v228 offset:16384
    v_mfma_f32_16x16x32_bf16 v[168:171], a[56:59], v[68:71], v[168:171]
    ds_read_b64_tr_b16 a[66:67], v228 offset:16896
    v_mfma_f32_16x16x32_bf16 v[172:175], a[44:47], v[64:67], v[172:175]
    ds_read_b64_tr_b16 a[68:69], v229 offset:16384
    v_mfma_f32_16x16x32_bf16 v[172:175], a[60:63], v[68:71], v[172:175]
    ds_read_b64_tr_b16 a[70:71], v229 offset:16896
    v_mfma_f32_16x16x32_bf16 v[176:179], a[32:35], v[72:75], v[176:179]
    ds_read_b64_tr_b16 a[72:73], v230 offset:16384
    s_add_u32 m0, s35, 8192
    s_and_b32 s33, s84, 1023
    s_lshl_b32 s33, s33, 12
    buffer_load_dwordx4 v234, s[48:51], s33 offen lds
    v_mfma_f32_16x16x32_bf16 v[176:179], a[48:51], v[76:79], v[176:179]
    ds_read_b64_tr_b16 a[74:75], v230 offset:16896
    v_mfma_f32_16x16x32_bf16 v[180:183], a[36:39], v[72:75], v[180:183]
    ds_read_b64_tr_b16 a[76:77], v231 offset:16384
    buffer_load_dwordx4 v235, s[48:51], s33 offen offset:1024 lds
    v_mfma_f32_16x16x32_bf16 v[180:183], a[52:55], v[76:79], v[180:183]
    ds_read_b64_tr_b16 a[78:79], v231 offset:16896
    v_mfma_f32_16x16x32_bf16 v[184:187], a[40:43], v[72:75], v[184:187]
    s_add_u32 m0, s35, 10240
    s_add_u32 s33, s33, 131072
    buffer_load_dwordx4 v234, s[48:51], s33 offen lds
    v_mfma_f32_16x16x32_bf16 v[184:187], a[56:59], v[76:79], v[184:187]
    v_mfma_f32_16x16x32_bf16 v[188:191], a[44:47], v[72:75], v[188:191]
    buffer_load_dwordx4 v235, s[48:51], s33 offen offset:1024 lds
    v_mfma_f32_16x16x32_bf16 v[188:191], a[60:63], v[76:79], v[188:191]
    s_waitcnt vmcnt(24) lgkmcnt(0)
    s_barrier
    v_mfma_f32_16x16x32_bf16 v[192:195], a[32:35], v[80:83], v[192:195]
    ds_read_b128 v[64:67], v224 offset:32768
    v_mfma_f32_16x16x32_bf16 v[192:195], a[48:51], v[84:87], v[192:195]
    ds_read_b128 v[68:71], v225 offset:32768
    v_mfma_f32_16x16x32_bf16 v[196:199], a[36:39], v[80:83], v[196:199]
    ds_read_b128 v[72:75], v224 offset:34816
    v_mfma_f32_16x16x32_bf16 v[196:199], a[52:55], v[84:87], v[196:199]
    ds_read_b128 v[76:79], v225 offset:34816
    v_mfma_f32_16x16x32_bf16 v[200:203], a[40:43], v[80:83], v[200:203]
    ds_read_b64_tr_b16 a[80:81], v228 offset:20480
    v_mfma_f32_16x16x32_bf16 v[200:203], a[56:59], v[84:87], v[200:203]
    ds_read_b64_tr_b16 a[82:83], v228 offset:20992
    v_mfma_f32_16x16x32_bf16 v[204:207], a[44:47], v[80:83], v[204:207]
    ds_read_b64_tr_b16 a[84:85], v229 offset:20480
    v_mfma_f32_16x16x32_bf16 v[204:207], a[60:63], v[84:87], v[204:207]
    ds_read_b64_tr_b16 a[86:87], v229 offset:20992
    v_mfma_f32_16x16x32_bf16 v[208:211], a[32:35], v[88:91], v[208:211]
    ds_read_b64_tr_b16 a[88:89], v230 offset:20480
    s_add_u32 m0, s34, 16384
    s_add_u32 s37, s85, 0
    buffer_load_dwordx4 v232, s[44:47], s37 offen lds
    v_mfma_f32_16x16x32_bf16 v[208:211], a[48:51], v[92:95], v[208:211]
    ds_read_b64_tr_b16 a[90:91], v230 offset:20992
    v_mfma_f32_16x16x32_bf16 v[212:215], a[36:39], v[88:91], v[212:215]
    ds_read_b64_tr_b16 a[92:93], v231 offset:20480
    v_mfma_f32_16x16x32_bf16 v[212:215], a[52:55], v[92:95], v[212:215]
    ds_read_b64_tr_b16 a[94:95], v231 offset:20992
    v_mfma_f32_16x16x32_bf16 v[216:219], a[40:43], v[88:91], v[216:219]
    buffer_load_dwordx4 v233, s[44:47], s37 offen offset:1024 lds
    v_mfma_f32_16x16x32_bf16 v[216:219], a[56:59], v[92:95], v[216:219]
    v_mfma_f32_16x16x32_bf16 v[220:223], a[44:47], v[88:91], v[220:223]
    v_mfma_f32_16x16x32_bf16 v[220:223], a[60:63], v[92:95], v[220:223]
    s_waitcnt lgkmcnt(0)
    v_mfma_f32_16x16x32_bf16 v[96:99], a[64:67], v[64:67], v[96:99]
    ds_read_b128 v[80:83], v224 offset:36864
    v_mfma_f32_16x16x32_bf16 v[96:99], a[80:83], v[68:71], v[96:99]
    ds_read_b128 v[84:87], v225 offset:36864
    v_mfma_f32_16x16x32_bf16 v[100:103], a[68:71], v[64:67], v[100:103]
    ds_read_b128 v[88:91], v224 offset:38912
    v_mfma_f32_16x16x32_bf16 v[100:103], a[84:87], v[68:71], v[100:103]
    ds_read_b128 v[92:95], v225 offset:38912
    v_mfma_f32_16x16x32_bf16 v[104:107], a[72:75], v[64:67], v[104:107]
    v_mfma_f32_16x16x32_bf16 v[104:107], a[88:91], v[68:71], v[104:107]
    v_mfma_f32_16x16x32_bf16 v[108:111], a[76:79], v[64:67], v[108:111]
    v_mfma_f32_16x16x32_bf16 v[108:111], a[92:95], v[68:71], v[108:111]
    v_mfma_f32_16x16x32_bf16 v[112:115], a[64:67], v[72:75], v[112:115]
    s_add_u32 m0, s35, 12288
    s_add_u32 s33, s33, 131072
    buffer_load_dwordx4 v234, s[48:51], s33 offen lds
    v_mfma_f32_16x16x32_bf16 v[112:115], a[80:83], v[76:79], v[112:115]
    v_mfma_f32_16x16x32_bf16 v[116:119], a[68:71], v[72:75], v[116:119]
    buffer_load_dwordx4 v235, s[48:51], s33 offen offset:1024 lds
    v_mfma_f32_16x16x32_bf16 v[116:119], a[84:87], v[76:79], v[116:119]
    v_mfma_f32_16x16x32_bf16 v[120:123], a[72:75], v[72:75], v[120:123]
    s_add_u32 m0, s35, 14336
    s_add_u32 s33, s33, 131072
    buffer_load_dwordx4 v234, s[48:51], s33 offen lds
    v_mfma_f32_16x16x32_bf16 v[120:123], a[88:91], v[76:79], v[120:123]
    v_mfma_f32_16x16x32_bf16 v[124:127], a[76:79], v[72:75], v[124:127]
    buffer_load_dwordx4 v235, s[48:51], s33 offen offset:1024 lds
    v_mfma_f32_16x16x32_bf16 v[124:127], a[92:95], v[76:79], v[124:127]
    s_waitcnt lgkmcnt(0)
    v_mfma_f32_16x16x32_bf16 v[128:131], a[64:67], v[80:83], v[128:131]
    ds_read_b128 v[64:67], v224 offset:40960
    v_mfma_f32_16x16x32_bf16 v[128:131], a[80:83], v[84:87], v[128:131]
    ds_read_b128 v[68:71], v225 offset:40960
    v_mfma_f32_16x16x32_bf16 v[132:135], a[68:71], v[80:83], v[132:135]
    ds_read_b128 v[72:75], v224 offset:43008
    v_mfma_f32_16x16x32_bf16 v[132:135], a[84:87], v[84:87], v[132:135]
    ds_read_b128 v[76:79], v225 offset:43008
    v_mfma_f32_16x16x32_bf16 v[136:139], a[72:75], v[80:83], v[136:139]
    v_mfma_f32_16x16x32_bf16 v[136:139], a[88:91], v[84:87], v[136:139]
    v_mfma_f32_16x16x32_bf16 v[140:143], a[76:79], v[80:83], v[140:143]
    v_mfma_f32_16x16x32_bf16 v[140:143], a[92:95], v[84:87], v[140:143]
    v_mfma_f32_16x16x32_bf16 v[144:147], a[64:67], v[88:91], v[144:147]
    s_add_u32 m0, s34, 24576
    s_add_u32 s37, s85, 65536
    buffer_load_dwordx4 v232, s[44:47], s37 offen lds
    v_mfma_f32_16x16x32_bf16 v[144:147], a[80:83], v[92:95], v[144:147]
    v_mfma_f32_16x16x32_bf16 v[148:151], a[68:71], v[88:91], v[148:151]
    v_mfma_f32_16x16x32_bf16 v[148:151], a[84:87], v[92:95], v[148:151]
    v_mfma_f32_16x16x32_bf16 v[152:155], a[72:75], v[88:91], v[152:155]
    buffer_load_dwordx4 v233, s[44:47], s37 offen offset:1024 lds
    v_mfma_f32_16x16x32_bf16 v[152:155], a[88:91], v[92:95], v[152:155]
    v_mfma_f32_16x16x32_bf16 v[156:159], a[76:79], v[88:91], v[156:159]
    v_mfma_f32_16x16x32_bf16 v[156:159], a[92:95], v[92:95], v[156:159]
    s_waitcnt vmcnt(14) lgkmcnt(0)
    v_mfma_f32_16x16x32_bf16 v[160:163], a[64:67], v[64:67], v[160:163]
    ds_read_b128 v[80:83], v224 offset:45056
    s_waitcnt vmcnt(18)
    v_mfma_f32_16x16x32_bf16 v[160:163], a[80:83], v[68:71], v[160:163]
    ds_read_b128 v[84:87], v225 offset:45056
    v_lshlrev_b32 v16, 16, v0
    v_mfma_f32_16x16x32_bf16 v[164:167], a[68:71], v[64:67], v[164:167]
    ds_read_b128 v[88:91], v224 offset:47104
    v_and_b32 v17, 0xffff0000, v0
    v_lshlrev_b32_e64 v18, 16, v1
    v_mfma_f32_16x16x32_bf16 v[164:167], a[84:87], v[68:71], v[164:167]
    ds_read_b128 v[92:95], v225 offset:47104
    v_and_b32 v19, 0xffff0000, v1
    v_mfma_f32_16x16x32_bf16 v[168:171], a[72:75], v[64:67], v[168:171]
    ds_read_b64_tr_b16 a[96:97], v228 offset:0
    v_lshlrev_b32_e64 v20, 16, v2
    v_mfma_f32_16x16x32_bf16 v[168:171], a[88:91], v[68:71], v[168:171]
    ds_read_b64_tr_b16 a[98:99], v228 offset:512
    v_and_b32 v21, 0xffff0000, v2
    v_mfma_f32_16x16x32_bf16 v[172:175], a[76:79], v[64:67], v[172:175]
    ds_read_b64_tr_b16 a[100:101], v229 offset:0
    v_lshlrev_b32_e64 v22, 16, v3
    v_mfma_f32_16x16x32_bf16 v[172:175], a[92:95], v[68:71], v[172:175]
    ds_read_b64_tr_b16 a[102:103], v229 offset:512
    v_and_b32 v23, 0xffff0000, v3
    v_mfma_f32_16x16x32_bf16 v[176:179], a[64:67], v[72:75], v[176:179]
    ds_read_b64_tr_b16 a[104:105], v230 offset:0
    s_add_u32 m0, s35, 16384
    s_and_b32 s33, s85, 1023
    s_lshl_b32 s33, s33, 12
    buffer_load_dwordx4 v234, s[48:51], s33 offen lds
    v_mfma_f32_16x16x32_bf16 v[176:179], a[80:83], v[76:79], v[176:179]
    ds_read_b64_tr_b16 a[106:107], v230 offset:512
    buffer_load_dwordx4 v235, s[48:51], s33 offen offset:1024 lds
    v_mfma_f32_16x16x32_bf16 v[180:183], a[68:71], v[72:75], v[180:183]
    ds_read_b64_tr_b16 a[108:109], v231 offset:0
    s_add_u32 m0, s35, 18432
    s_add_u32 s33, s33, 131072
    buffer_load_dwordx4 v234, s[48:51], s33 offen lds
    v_mfma_f32_16x16x32_bf16 v[180:183], a[84:87], v[76:79], v[180:183]
    ds_read_b64_tr_b16 a[110:111], v231 offset:512
    v_lshlrev_b32 v24, 16, v4
    v_and_b32 v25, 0xffff0000, v4
    v_mfma_f32_16x16x32_bf16 v[184:187], a[72:75], v[72:75], v[184:187]
    buffer_load_dwordx4 v235, s[48:51], s33 offen offset:1024 lds
    v_lshlrev_b32_e64 v26, 16, v5
    v_mfma_f32_16x16x32_bf16 v[184:187], a[88:91], v[76:79], v[184:187]
    s_lshl2_add_u32 s26, s4, s3
    s_lshl_b32 s26, s26, 10
    s_add_u32 s26, s26, s32
    s_add_u32 s26, s26, 131072
    v_mfma_f32_16x16x32_bf16 v[188:191], a[76:79], v[72:75], v[188:191]
    v_and_b32 v226, 0x40000380, v251
    buffer_load_dword v241, v226, s[44:47], s26 offen
    v_mfma_f32_16x16x32_bf16 v[188:191], a[92:95], v[76:79], v[188:191]
    s_waitcnt vmcnt(29) lgkmcnt(0)
    s_barrier
    v_mfma_f32_16x16x32_bf16 v[192:195], a[64:67], v[80:83], v[192:195]
    ds_read_b128 v[64:67], v224 offset:49152
    v_and_b32 v27, 0xffff0000, v5
    v_mfma_f32_16x16x32_bf16 v[192:195], a[80:83], v[84:87], v[192:195]
    ds_read_b128 v[68:71], v225 offset:49152
    v_lshlrev_b32 v28, 16, v6
    v_mfma_f32_16x16x32_bf16 v[196:199], a[68:71], v[80:83], v[196:199]
    ds_read_b128 v[72:75], v224 offset:51200
    v_and_b32 v29, 0xffff0000, v6
    v_mfma_f32_16x16x32_bf16 v[196:199], a[84:87], v[84:87], v[196:199]
    ds_read_b128 v[76:79], v225 offset:51200
    v_lshlrev_b32_e64 v30, 16, v7
    v_and_b32 v31, 0xffff0000, v7
    v_mfma_f32_16x16x32_bf16 v[200:203], a[72:75], v[80:83], v[200:203]
    ds_read_b64_tr_b16 a[112:113], v228 offset:4096
    v_lshlrev_b32_e64 v32, 16, v8
    v_mfma_f32_16x16x32_bf16 v[200:203], a[88:91], v[84:87], v[200:203]
    ds_read_b64_tr_b16 a[114:115], v228 offset:4608
    v_and_b32 v33, 0xffff0000, v8
    v_mfma_f32_16x16x32_bf16 v[204:207], a[76:79], v[80:83], v[204:207]
    ds_read_b64_tr_b16 a[116:117], v229 offset:4096
    v_lshlrev_b32_e64 v34, 16, v9
    v_mfma_f32_16x16x32_bf16 v[204:207], a[92:95], v[84:87], v[204:207]
    ds_read_b64_tr_b16 a[118:119], v229 offset:4608
    v_and_b32 v35, 0xffff0000, v9
    v_mfma_f32_16x16x32_bf16 v[208:211], a[64:67], v[88:91], v[208:211]
    ds_read_b64_tr_b16 a[120:121], v230 offset:4096
    s_add_u32 m0, s34, 32768
    s_add_u32 s37, s86, 0
    buffer_load_dwordx4 v232, s[44:47], s37 offen lds
    v_mfma_f32_16x16x32_bf16 v[208:211], a[80:83], v[92:95], v[208:211]
    ds_read_b64_tr_b16 a[122:123], v230 offset:4608
    v_lshlrev_b32 v36, 16, v10
    v_mfma_f32_16x16x32_bf16 v[212:215], a[68:71], v[88:91], v[212:215]
    ds_read_b64_tr_b16 a[124:125], v231 offset:4096
    v_and_b32 v37, 0xffff0000, v10
    v_lshlrev_b32_e64 v38, 16, v11
    v_mfma_f32_16x16x32_bf16 v[212:215], a[84:87], v[92:95], v[212:215]
    ds_read_b64_tr_b16 a[126:127], v231 offset:4608
    v_and_b32 v39, 0xffff0000, v11
    v_mfma_f32_16x16x32_bf16 v[216:219], a[72:75], v[88:91], v[216:219]
    buffer_load_dwordx4 v233, s[44:47], s37 offen offset:1024 lds
    v_lshlrev_b32_e64 v40, 16, v12
    v_mfma_f32_16x16x32_bf16 v[216:219], a[88:91], v[92:95], v[216:219]
    v_and_b32 v41, 0xffff0000, v12
    v_lshlrev_b32_e64 v42, 16, v13
    v_mfma_f32_16x16x32_bf16 v[220:223], a[76:79], v[88:91], v[220:223]
    v_and_b32 v43, 0xffff0000, v13
    v_lshlrev_b32_e64 v44, 16, v14
    v_and_b32 v45, 0xffff0000, v14
    v_mfma_f32_16x16x32_bf16 v[220:223], a[92:95], v[92:95], v[220:223]
    v_lshlrev_b32 v46, 16, v15
    s_waitcnt lgkmcnt(0)
    v_mfma_f32_16x16x32_bf16 v[96:99], a[96:99], v[64:67], v[96:99]
    ds_read_b128 v[80:83], v224 offset:53248
    v_and_b32 v47, 0xffff0000, v15
    v_mfma_f32_16x16x32_bf16 v[96:99], a[112:115], v[68:71], v[96:99]
    ds_read_b128 v[84:87], v225 offset:53248
    v_add_f32_e64 v52, v16, v20
    v_mfma_f32_16x16x32_bf16 v[100:103], a[100:103], v[64:67], v[100:103]
    ds_read_b128 v[88:91], v224 offset:55296
    v_add_f32_e64 v53, v17, v21
    v_mfma_f32_16x16x32_bf16 v[100:103], a[116:119], v[68:71], v[100:103]
    ds_read_b128 v[92:95], v225 offset:55296
    v_add_f32 v54, v18, v22
    v_add_f32 v55, v19, v23
    v_mfma_f32_16x16x32_bf16 v[104:107], a[104:107], v[64:67], v[104:107]
    v_add_f32 v52, v52, v24
    v_add_f32 v53, v53, v25
    v_mfma_f32_16x16x32_bf16 v[104:107], a[120:123], v[68:71], v[104:107]
    v_add_f32 v54, v54, v26
    v_add_f32 v55, v55, v27
    v_mfma_f32_16x16x32_bf16 v[108:111], a[108:111], v[64:67], v[108:111]
    v_add_f32 v52, v52, v28
    v_add_f32 v53, v53, v29
    v_add_f32_e64 v54, v54, v30
    v_mfma_f32_16x16x32_bf16 v[108:111], a[124:127], v[68:71], v[108:111]
    v_add_f32 v55, v55, v31
    v_add_f32 v52, v52, v32
    v_mfma_f32_16x16x32_bf16 v[112:115], a[96:99], v[72:75], v[112:115]
    s_add_u32 m0, s35, 20480
    s_add_u32 s33, s33, 131072
    buffer_load_dwordx4 v234, s[48:51], s33 offen lds
    v_mfma_f32_16x16x32_bf16 v[112:115], a[112:115], v[76:79], v[112:115]
    v_add_f32 v53, v53, v33
    v_add_f32 v54, v54, v34
    v_mfma_f32_16x16x32_bf16 v[116:119], a[100:103], v[72:75], v[116:119]
    buffer_load_dwordx4 v235, s[48:51], s33 offen offset:1024 lds
    v_add_f32 v55, v55, v35
    v_add_f32 v52, v52, v36
    v_mfma_f32_16x16x32_bf16 v[116:119], a[116:119], v[76:79], v[116:119]
    v_add_f32 v53, v53, v37
    v_add_f32 v54, v54, v38
    v_mfma_f32_16x16x32_bf16 v[120:123], a[104:107], v[72:75], v[120:123]
    s_add_u32 m0, s35, 22528
    s_add_u32 s33, s33, 131072
    buffer_load_dwordx4 v234, s[48:51], s33 offen lds
    v_mfma_f32_16x16x32_bf16 v[120:123], a[120:123], v[76:79], v[120:123]
    v_add_f32 v55, v55, v39
    v_add_f32 v52, v52, v40
    v_mfma_f32_16x16x32_bf16 v[124:127], a[108:111], v[72:75], v[124:127]
    buffer_load_dwordx4 v235, s[48:51], s33 offen offset:1024 lds
    v_add_f32 v53, v53, v41
    v_add_f32 v54, v54, v42
    v_mfma_f32_16x16x32_bf16 v[124:127], a[124:127], v[76:79], v[124:127]
    v_add_f32 v55, v55, v43
    s_waitcnt lgkmcnt(0)
    v_mfma_f32_16x16x32_bf16 v[128:131], a[96:99], v[80:83], v[128:131]
    ds_read_b128 v[64:67], v224 offset:57344
    v_add_f32_e64 v52, v52, v44
    v_mfma_f32_16x16x32_bf16 v[128:131], a[112:115], v[84:87], v[128:131]
    ds_read_b128 v[68:71], v225 offset:57344
    v_add_f32_e64 v53, v53, v45
    v_mfma_f32_16x16x32_bf16 v[132:135], a[100:103], v[80:83], v[132:135]
    ds_read_b128 v[72:75], v224 offset:59392
    v_add_f32_e64 v54, v54, v46
    v_mfma_f32_16x16x32_bf16 v[132:135], a[116:119], v[84:87], v[132:135]
    ds_read_b128 v[76:79], v225 offset:59392
    v_add_f32 v55, v55, v47
    v_add_f32 v52, v52, v53
    v_mfma_f32_16x16x32_bf16 v[136:139], a[104:107], v[80:83], v[136:139]
    v_add_f32 v54, v54, v55
    v_add_f32 v48, v52, v54
    v_mfma_f32_16x16x32_bf16 v[136:139], a[120:123], v[84:87], v[136:139]
    s_nop 1
    v_add_f32_dpp v48, v48, v48 quad_perm:[1,0,3,2] row_mask:0xf bank_mask:0xf
    v_mfma_f32_16x16x32_bf16 v[140:143], a[108:111], v[80:83], v[140:143]
    s_nop 1
    v_add_f32_dpp v48, v48, v48 quad_perm:[2,3,0,1] row_mask:0xf bank_mask:0xf
    s_nop 1
    v_mfma_f32_16x16x32_bf16 v[140:143], a[124:127], v[84:87], v[140:143]
    v_add_f32_dpp v48, v48, v48 row_half_mirror row_mask:0xf bank_mask:0xf
    s_nop 1
    v_mfma_f32_16x16x32_bf16 v[144:147], a[96:99], v[88:91], v[144:147]
    s_add_u32 m0, s34, 40960
    s_add_u32 s37, s86, 65536
    buffer_load_dwordx4 v232, s[44:47], s37 offen lds
    v_mfma_f32_16x16x32_bf16 v[144:147], a[112:115], v[92:95], v[144:147]
    v_add_f32_dpp v48, v48, v48 row_mirror row_mask:0xf bank_mask:0xf
    s_nop 0
    v_mfma_f32_16x16x32_bf16 v[148:151], a[100:103], v[88:91], v[148:151]
    buffer_load_dwordx4 v233, s[44:47], s37 offen offset:1024 lds
    v_mov_b32_e64 v49, v48
    s_nop 1
    v_mfma_f32_16x16x32_bf16 v[148:151], a[116:119], v[92:95], v[148:151]
    v_permlane16_swap_b32 v48, v49
    s_nop 0
    v_mfma_f32_16x16x32_bf16 v[152:155], a[104:107], v[88:91], v[152:155]
    v_lshlrev_b32_e64 v227, 3, v240
    v_min_u32 v227, 1920, v227
    s_lshl2_add_u32 s25, s2, s3
    v_mfma_f32_16x16x32_bf16 v[152:155], a[120:123], v[92:95], v[152:155]
    v_add_f32 v48, v48, v49
    v_mul_f32 v48, 0x3a800000, v48
    v_mfma_f32_16x16x32_bf16 v[156:159], a[108:111], v[88:91], v[156:159]
    s_lshl_b32 s25, s25, 13
    s_add_u32 s25, s25, 0
    buffer_load_dword v241, v227, s[12:15], s25 offen
    v_mfma_f32_16x16x32_bf16 v[156:159], a[124:127], v[92:95], v[156:159]
    v_sub_f32 v56, v16, v48
    s_waitcnt vmcnt(16) lgkmcnt(0)
    v_mfma_f32_16x16x32_bf16 v[160:163], a[96:99], v[64:67], v[160:163]
    ds_read_b128 v[80:83], v224 offset:61440
    v_mul_f32 v52, v56, v56
    v_sub_f32 v57, v17, v48
    v_mfma_f32_16x16x32_bf16 v[160:163], a[112:115], v[68:71], v[160:163]
    ds_read_b128 v[84:87], v225 offset:61440
    v_mul_f32_e64 v53, v57, v57
    v_mfma_f32_16x16x32_bf16 v[164:167], a[100:103], v[64:67], v[164:167]
    ds_read_b128 v[88:91], v224 offset:63488
    v_sub_f32_e64 v58, v18, v48
    v_mfma_f32_16x16x32_bf16 v[164:167], a[116:119], v[68:71], v[164:167]
    ds_read_b128 v[92:95], v225 offset:63488
    v_mul_f32_e64 v54, v58, v58
    v_mfma_f32_16x16x32_bf16 v[168:171], a[104:107], v[64:67], v[168:171]
    ds_read_b64_tr_b16 a[128:129], v228 offset:8192
    v_sub_f32_e64 v59, v19, v48
    v_mfma_f32_16x16x32_bf16 v[168:171], a[120:123], v[68:71], v[168:171]
    ds_read_b64_tr_b16 a[130:131], v228 offset:8704
    v_mul_f32 v55, v59, v59
    v_sub_f32 v56, v20, v48
    v_mfma_f32_16x16x32_bf16 v[172:175], a[108:111], v[64:67], v[172:175]
    ds_read_b64_tr_b16 a[132:133], v229 offset:8192
    v_fmac_f32_e64 v52, v56, v56
    v_mfma_f32_16x16x32_bf16 v[172:175], a[124:127], v[68:71], v[172:175]
    ds_read_b64_tr_b16 a[134:135], v229 offset:8704
    v_sub_f32_e64 v57, v21, v48
    v_mfma_f32_16x16x32_bf16 v[176:179], a[96:99], v[72:75], v[176:179]
    ds_read_b64_tr_b16 a[136:137], v230 offset:8192
    s_add_u32 m0, s35, 0
    s_and_b32 s33, s86, 1023
    s_lshl_b32 s33, s33, 12
    buffer_load_dwordx4 v234, s[48:51], s33 offen lds
    v_mfma_f32_16x16x32_bf16 v[176:179], a[112:115], v[76:79], v[176:179]
    ds_read_b64_tr_b16 a[138:139], v230 offset:8704
    v_fmac_f32_e64 v53, v57, v57
    v_mfma_f32_16x16x32_bf16 v[180:183], a[100:103], v[72:75], v[180:183]
    ds_read_b64_tr_b16 a[140:141], v231 offset:8192
    buffer_load_dwordx4 v235, s[48:51], s33 offen offset:1024 lds
    v_mfma_f32_16x16x32_bf16 v[180:183], a[116:119], v[76:79], v[180:183]
    ds_read_b64_tr_b16 a[142:143], v231 offset:8704
    v_sub_f32_e64 v58, v22, v48
    v_mfma_f32_16x16x32_bf16 v[184:187], a[104:107], v[72:75], v[184:187]
    s_add_u32 m0, s35, 2048
    s_add_u32 s33, s33, 131072
    buffer_load_dwordx4 v234, s[48:51], s33 offen lds
    v_mfma_f32_16x16x32_bf16 v[184:187], a[120:123], v[76:79], v[184:187]
    v_fmac_f32 v54, v58, v58
    v_sub_f32 v59, v23, v48
    v_fmac_f32_e64 v55, v59, v59
    v_mfma_f32_16x16x32_bf16 v[188:191], a[108:111], v[72:75], v[188:191]
    buffer_load_dwordx4 v235, s[48:51], s33 offen offset:1024 lds
    v_sub_f32_e64 v56, v24, v48
    v_mfma_f32_16x16x32_bf16 v[188:191], a[124:127], v[76:79], v[188:191]
    s_waitcnt vmcnt(30) lgkmcnt(0)
    s_barrier
    v_mfma_f32_16x16x32_bf16 v[192:195], a[96:99], v[80:83], v[192:195]
    ds_read_b128 v[64:67], v224 offset:0
    v_fmac_f32_e64 v52, v56, v56
    v_mfma_f32_16x16x32_bf16 v[192:195], a[112:115], v[84:87], v[192:195]
    ds_read_b128 v[68:71], v225 offset:0
    v_sub_f32_e64 v57, v25, v48
    v_mfma_f32_16x16x32_bf16 v[196:199], a[100:103], v[80:83], v[196:199]
    ds_read_b128 v[72:75], v224 offset:2048
    v_fmac_f32_e64 v53, v57, v57
    v_mfma_f32_16x16x32_bf16 v[196:199], a[116:119], v[84:87], v[196:199]
    ds_read_b128 v[76:79], v225 offset:2048
    v_sub_f32 v58, v26, v48
    v_fmac_f32 v54, v58, v58
    v_mfma_f32_16x16x32_bf16 v[200:203], a[104:107], v[80:83], v[200:203]
    ds_read_b64_tr_b16 a[144:145], v228 offset:12288
    v_sub_f32_e64 v59, v27, v48
    v_mfma_f32_16x16x32_bf16 v[200:203], a[120:123], v[84:87], v[200:203]
    ds_read_b64_tr_b16 a[146:147], v228 offset:12800
    v_fmac_f32_e64 v55, v59, v59
    v_mfma_f32_16x16x32_bf16 v[204:207], a[108:111], v[80:83], v[204:207]
    ds_read_b64_tr_b16 a[148:149], v229 offset:12288
    v_sub_f32_e64 v56, v28, v48
    v_mfma_f32_16x16x32_bf16 v[204:207], a[124:127], v[84:87], v[204:207]
    ds_read_b64_tr_b16 a[150:151], v229 offset:12800
    v_fmac_f32_e64 v52, v56, v56
    v_mfma_f32_16x16x32_bf16 v[208:211], a[96:99], v[88:91], v[208:211]
    ds_read_b64_tr_b16 a[152:153], v230 offset:12288
    s_add_u32 m0, s34, 49152
    s_add_u32 s37, s87, 0
    buffer_load_dwordx4 v232, s[44:47], s37 offen lds
    v_mfma_f32_16x16x32_bf16 v[208:211], a[112:115], v[92:95], v[208:211]
    ds_read_b64_tr_b16 a[154:155], v230 offset:12800
    v_sub_f32 v57, v29, v48
    v_mfma_f32_16x16x32_bf16 v[212:215], a[100:103], v[88:91], v[212:215]
    ds_read_b64_tr_b16 a[156:157], v231 offset:12288
    v_fmac_f32 v53, v57, v57
    v_sub_f32 v58, v30, v48
    v_mfma_f32_16x16x32_bf16 v[212:215], a[116:119], v[92:95], v[212:215]
    ds_read_b64_tr_b16 a[158:159], v231 offset:12800
    v_fmac_f32_e64 v54, v58, v58
    v_mfma_f32_16x16x32_bf16 v[216:219], a[104:107], v[88:91], v[216:219]
    buffer_load_dwordx4 v233, s[44:47], s37 offen offset:1024 lds
    v_sub_f32_e64 v59, v31, v48
    v_mfma_f32_16x16x32_bf16 v[216:219], a[120:123], v[92:95], v[216:219]
    v_fmac_f32 v55, v59, v59
    v_sub_f32 v56, v32, v48
    v_mfma_f32_16x16x32_bf16 v[220:223], a[108:111], v[88:91], v[220:223]
    v_fmac_f32 v52, v56, v56
    v_sub_f32 v57, v33, v48
    v_fmac_f32_e64 v53, v57, v57
    v_mfma_f32_16x16x32_bf16 v[220:223], a[124:127], v[92:95], v[220:223]
    v_sub_f32 v58, v34, v48
    s_waitcnt lgkmcnt(0)
    v_mfma_f32_16x16x32_bf16 v[96:99], a[128:131], v[64:67], v[96:99]
    ds_read_b128 v[80:83], v224 offset:4096
    v_fmac_f32_e64 v54, v58, v58
    v_mfma_f32_16x16x32_bf16 v[96:99], a[144:147], v[68:71], v[96:99]
    ds_read_b128 v[84:87], v225 offset:4096
    v_sub_f32_e64 v59, v35, v48
    v_mfma_f32_16x16x32_bf16 v[100:103], a[132:135], v[64:67], v[100:103]
    ds_read_b128 v[88:91], v224 offset:6144
    v_fmac_f32_e64 v55, v59, v59
    v_mfma_f32_16x16x32_bf16 v[100:103], a[148:151], v[68:71], v[100:103]
    ds_read_b128 v[92:95], v225 offset:6144
    v_sub_f32 v56, v36, v48
    v_fmac_f32 v52, v56, v56
    v_mfma_f32_16x16x32_bf16 v[104:107], a[136:139], v[64:67], v[104:107]
    v_sub_f32 v57, v37, v48
    v_fmac_f32 v53, v57, v57
    v_mfma_f32_16x16x32_bf16 v[104:107], a[152:155], v[68:71], v[104:107]
    v_sub_f32 v58, v38, v48
    v_fmac_f32 v54, v58, v58
    v_mfma_f32_16x16x32_bf16 v[108:111], a[140:143], v[64:67], v[108:111]
    v_sub_f32 v59, v39, v48
    v_fmac_f32 v55, v59, v59
    v_sub_f32_e64 v56, v40, v48
    v_mfma_f32_16x16x32_bf16 v[108:111], a[156:159], v[68:71], v[108:111]
    v_fmac_f32 v52, v56, v56
    v_sub_f32 v57, v41, v48
    v_mfma_f32_16x16x32_bf16 v[112:115], a[128:131], v[72:75], v[112:115]
    s_add_u32 m0, s35, 4096
    s_add_u32 s33, s33, 131072
    buffer_load_dwordx4 v234, s[48:51], s33 offen lds
    v_mfma_f32_16x16x32_bf16 v[112:115], a[144:147], v[76:79], v[112:115]
    v_fmac_f32 v53, v57, v57
    v_sub_f32 v58, v42, v48
    v_mfma_f32_16x16x32_bf16 v[116:119], a[132:135], v[72:75], v[116:119]
    buffer_load_dwordx4 v235, s[48:51], s33 offen offset:1024 lds
    v_fmac_f32 v54, v58, v58
    v_sub_f32 v59, v43, v48
    v_mfma_f32_16x16x32_bf16 v[116:119], a[148:151], v[76:79], v[116:119]
    v_fmac_f32 v55, v59, v59
    v_sub_f32 v56, v44, v48
    v_mfma_f32_16x16x32_bf16 v[120:123], a[136:139], v[72:75], v[120:123]
    s_add_u32 m0, s35, 6144
    s_add_u32 s33, s33, 131072
    buffer_load_dwordx4 v234, s[48:51], s33 offen lds
    v_mfma_f32_16x16x32_bf16 v[120:123], a[152:155], v[76:79], v[120:123]
    v_fmac_f32 v52, v56, v56
    v_sub_f32 v57, v45, v48
    v_mfma_f32_16x16x32_bf16 v[124:127], a[140:143], v[72:75], v[124:127]
    buffer_load_dwordx4 v235, s[48:51], s33 offen offset:1024 lds
    v_fmac_f32 v53, v57, v57
    v_sub_f32 v58, v46, v48
    v_mfma_f32_16x16x32_bf16 v[124:127], a[156:159], v[76:79], v[124:127]
    v_fmac_f32 v54, v58, v58
    s_waitcnt lgkmcnt(0)
    v_mfma_f32_16x16x32_bf16 v[128:131], a[128:131], v[80:83], v[128:131]
    ds_read_b128 v[64:67], v224 offset:8192
    v_sub_f32_e64 v59, v47, v48
    v_mfma_f32_16x16x32_bf16 v[128:131], a[144:147], v[84:87], v[128:131]
    ds_read_b128 v[68:71], v225 offset:8192
    v_fmac_f32_e64 v55, v59, v59
    v_mfma_f32_16x16x32_bf16 v[132:135], a[132:135], v[80:83], v[132:135]
    ds_read_b128 v[72:75], v224 offset:10240
    v_add_f32_e64 v52, v52, v53
    v_mfma_f32_16x16x32_bf16 v[132:135], a[148:151], v[84:87], v[132:135]
    ds_read_b128 v[76:79], v225 offset:10240
    v_add_f32_e64 v54, v54, v55
    v_mfma_f32_16x16x32_bf16 v[136:139], a[136:139], v[80:83], v[136:139]
    v_add_f32 v51, v52, v54
    s_nop 1
    v_add_f32_dpp v51, v51, v51 quad_perm:[1,0,3,2] row_mask:0xf bank_mask:0xf
    v_mfma_f32_16x16x32_bf16 v[136:139], a[152:155], v[84:87], v[136:139]
    s_nop 1
    v_add_f32_dpp v51, v51, v51 quad_perm:[2,3,0,1] row_mask:0xf bank_mask:0xf
    v_mfma_f32_16x16x32_bf16 v[140:143], a[140:143], v[80:83], v[140:143]
    s_nop 1
    v_add_f32_dpp v51, v51, v51 row_half_mirror row_mask:0xf bank_mask:0xf
    s_nop 1
    v_mfma_f32_16x16x32_bf16 v[140:143], a[156:159], v[84:87], v[140:143]
    v_add_f32_dpp v51, v51, v51 row_mirror row_mask:0xf bank_mask:0xf
    s_nop 0
    v_mfma_f32_16x16x32_bf16 v[144:147], a[128:131], v[88:91], v[144:147]
    s_add_u32 m0, s34, 57344
    s_add_u32 s37, s87, 65536
    buffer_load_dwordx4 v232, s[44:47], s37 offen lds
    v_mfma_f32_16x16x32_bf16 v[144:147], a[144:147], v[92:95], v[144:147]
    v_mov_b32 v49, v51
    s_nop 1
    v_mfma_f32_16x16x32_bf16 v[148:151], a[132:135], v[88:91], v[148:151]
    buffer_load_dwordx4 v233, s[44:47], s37 offen offset:1024 lds
    v_permlane16_swap_b32 v51, v49
    s_nop 0
    v_mfma_f32_16x16x32_bf16 v[148:151], a[148:151], v[92:95], v[148:151]
    v_add_f32_e64 v51, v51, v49
    v_mul_f32 v51, 0x3a800000, v51
    v_mfma_f32_16x16x32_bf16 v[152:155], a[136:139], v[88:91], v[152:155]
    v_lshlrev_b32_e64 v227, 3, v240
    v_min_u32 v227, 1920, v227
    s_lshl2_add_u32 s25, s2, s3
    v_mfma_f32_16x16x32_bf16 v[152:155], a[152:155], v[92:95], v[152:155]
    v_cvt_pk_bf16_f32 v50, v48, v51
    v_and_b32 v51, 0xffff0000, v50
    v_mfma_f32_16x16x32_bf16 v[156:159], a[140:143], v[88:91], v[156:159]
    s_lshl_b32 s25, s25, 13
    s_add_u32 s25, s25, 2048
    buffer_load_dword v241, v227, s[12:15], s25 offen
    v_mfma_f32_16x16x32_bf16 v[156:159], a[156:159], v[92:95], v[156:159]
    v_lshlrev_b32 v50, 16, v50
    s_waitcnt vmcnt(16) lgkmcnt(0)
    v_mfma_f32_16x16x32_bf16 v[160:163], a[128:131], v[64:67], v[160:163]
    ds_read_b128 v[80:83], v224 offset:12288
    v_add_f32 v51, 0x3727c5ac, v51
    v_cvt_pk_bf16_f32 v51, v51, v51
    v_mfma_f32_16x16x32_bf16 v[160:163], a[144:147], v[68:71], v[160:163]
    ds_read_b128 v[84:87], v225 offset:12288
    v_lshlrev_b32_e64 v51, 16, v51
    v_mfma_f32_16x16x32_bf16 v[164:167], a[132:135], v[64:67], v[164:167]
    ds_read_b128 v[88:91], v224 offset:14336
    v_mfma_f32_16x16x32_bf16 v[164:167], a[148:151], v[68:71], v[164:167]
    ds_read_b128 v[92:95], v225 offset:14336
    v_sqrt_f32 v51, v51
    v_mfma_f32_16x16x32_bf16 v[168:171], a[136:139], v[64:67], v[168:171]
    ds_read_b64_tr_b16 a[160:161], v228 offset:16384
    s_nop 0
    v_mfma_f32_16x16x32_bf16 v[168:171], a[152:155], v[68:71], v[168:171]
    ds_read_b64_tr_b16 a[162:163], v228 offset:16896
    v_cvt_pk_bf16_f32 v51, v51, v51
    v_lshlrev_b32_e64 v51, 16, v51
    v_mfma_f32_16x16x32_bf16 v[172:175], a[140:143], v[64:67], v[172:175]
    ds_read_b64_tr_b16 a[164:165], v229 offset:16384
    v_mfma_f32_16x16x32_bf16 v[172:175], a[156:159], v[68:71], v[172:175]
    ds_read_b64_tr_b16 a[166:167], v229 offset:16896
    v_rcp_f32_e64 v51, v51
    v_mfma_f32_16x16x32_bf16 v[176:179], a[128:131], v[72:75], v[176:179]
    ds_read_b64_tr_b16 a[168:169], v230 offset:16384
    s_add_u32 m0, s35, 8192
    s_and_b32 s33, s87, 1023
    s_lshl_b32 s33, s33, 12
    buffer_load_dwordx4 v234, s[48:51], s33 offen lds
    v_mfma_f32_16x16x32_bf16 v[176:179], a[144:147], v[76:79], v[176:179]
    ds_read_b64_tr_b16 a[170:171], v230 offset:16896
    s_nop 0
    v_mfma_f32_16x16x32_bf16 v[180:183], a[132:135], v[72:75], v[180:183]
    ds_read_b64_tr_b16 a[172:173], v231 offset:16384
    buffer_load_dwordx4 v235, s[48:51], s33 offen offset:1024 lds
    v_mfma_f32_16x16x32_bf16 v[180:183], a[148:151], v[76:79], v[180:183]
    ds_read_b64_tr_b16 a[174:175], v231 offset:16896
    v_mul_f32 v51, 0x3e0293ee, v51
    v_mfma_f32_16x16x32_bf16 v[184:187], a[136:139], v[72:75], v[184:187]
    s_add_u32 m0, s35, 10240
    s_add_u32 s33, s33, 131072
    buffer_load_dwordx4 v234, s[48:51], s33 offen lds
    v_mfma_f32_16x16x32_bf16 v[184:187], a[152:155], v[76:79], v[184:187]
    v_sub_f32 v16, v16, v50
    v_sub_f32 v17, v17, v50
    v_cvt_pk_bf16_f32 v17, v16, v17
    v_mfma_f32_16x16x32_bf16 v[188:191], a[140:143], v[72:75], v[188:191]
    buffer_load_dwordx4 v235, s[48:51], s33 offen offset:1024 lds
    v_lshlrev_b32_e64 v16, 16, v17
    v_mfma_f32_16x16x32_bf16 v[188:191], a[156:159], v[76:79], v[188:191]
    s_waitcnt vmcnt(31) lgkmcnt(0)
    s_barrier
    v_mfma_f32_16x16x32_bf16 v[192:195], a[128:131], v[80:83], v[192:195]
    ds_read_b128 v[64:67], v224 offset:16384
    v_and_b32 v17, 0xffff0000, v17
    v_mfma_f32_16x16x32_bf16 v[192:195], a[144:147], v[84:87], v[192:195]
    ds_read_b128 v[68:71], v225 offset:16384
    v_mul_f32_e64 v16, v16, v51
    v_mfma_f32_16x16x32_bf16 v[196:199], a[132:135], v[80:83], v[196:199]
    ds_read_b128 v[72:75], v224 offset:18432
    v_mul_f32_e64 v17, v17, v51
    v_mfma_f32_16x16x32_bf16 v[196:199], a[148:151], v[84:87], v[196:199]
    ds_read_b128 v[76:79], v225 offset:18432
    v_cvt_pk_bf16_f32 v0, v16, v17
    v_sub_f32_e64 v18, v18, v50
    v_mfma_f32_16x16x32_bf16 v[200:203], a[136:139], v[80:83], v[200:203]
    ds_read_b64_tr_b16 a[176:177], v228 offset:20480
    v_sub_f32_e64 v19, v19, v50
    v_mfma_f32_16x16x32_bf16 v[200:203], a[152:155], v[84:87], v[200:203]
    ds_read_b64_tr_b16 a[178:179], v228 offset:20992
    v_cvt_pk_bf16_f32 v19, v18, v19
    v_mfma_f32_16x16x32_bf16 v[204:207], a[140:143], v[80:83], v[204:207]
    ds_read_b64_tr_b16 a[180:181], v229 offset:20480
    v_lshlrev_b32_e64 v18, 16, v19
    v_mfma_f32_16x16x32_bf16 v[204:207], a[156:159], v[84:87], v[204:207]
    ds_read_b64_tr_b16 a[182:183], v229 offset:20992
    v_and_b32 v19, 0xffff0000, v19
    v_mfma_f32_16x16x32_bf16 v[208:211], a[128:131], v[88:91], v[208:211]
    ds_read_b64_tr_b16 a[184:185], v230 offset:20480
    s_add_u32 m0, s34, 0
    s_add_u32 s37, s80, 131072
    buffer_load_dwordx4 v232, s[44:47], s37 offen lds
    v_mfma_f32_16x16x32_bf16 v[208:211], a[144:147], v[92:95], v[208:211]
    ds_read_b64_tr_b16 a[186:187], v230 offset:20992
    v_mul_f32 v18, v18, v51
    v_mfma_f32_16x16x32_bf16 v[212:215], a[132:135], v[88:91], v[212:215]
    ds_read_b64_tr_b16 a[188:189], v231 offset:20480
    v_mul_f32_e64 v19, v19, v51
    v_cvt_pk_bf16_f32 v1, v18, v19
    v_mfma_f32_16x16x32_bf16 v[212:215], a[148:151], v[92:95], v[212:215]
    ds_read_b64_tr_b16 a[190:191], v231 offset:20992
    v_sub_f32_e64 v20, v20, v50
    v_mfma_f32_16x16x32_bf16 v[216:219], a[136:139], v[88:91], v[216:219]
    buffer_load_dwordx4 v233, s[44:47], s37 offen offset:1024 lds
    v_sub_f32_e64 v21, v21, v50
    v_mfma_f32_16x16x32_bf16 v[216:219], a[152:155], v[92:95], v[216:219]
    v_cvt_pk_bf16_f32 v21, v20, v21
    v_lshlrev_b32_e64 v20, 16, v21
    v_mfma_f32_16x16x32_bf16 v[220:223], a[140:143], v[88:91], v[220:223]
    v_and_b32 v21, 0xffff0000, v21
    v_mul_f32 v20, v20, v51
    v_mul_f32 v21, v21, v51
    v_mfma_f32_16x16x32_bf16 v[220:223], a[156:159], v[92:95], v[220:223]
    v_cvt_pk_bf16_f32 v2, v20, v21
    s_waitcnt lgkmcnt(0)
    v_mfma_f32_16x16x32_bf16 v[96:99], a[160:163], v[64:67], v[96:99]
    ds_read_b128 v[80:83], v224 offset:20480
    v_sub_f32 v22, v22, v50
    v_mfma_f32_16x16x32_bf16 v[96:99], a[176:179], v[68:71], v[96:99]
    ds_read_b128 v[84:87], v225 offset:20480
    v_sub_f32_e64 v23, v23, v50
    v_mfma_f32_16x16x32_bf16 v[100:103], a[164:167], v[64:67], v[100:103]
    ds_read_b128 v[88:91], v224 offset:22528
    v_cvt_pk_bf16_f32 v23, v22, v23
    v_mfma_f32_16x16x32_bf16 v[100:103], a[180:183], v[68:71], v[100:103]
    ds_read_b128 v[92:95], v225 offset:22528
    v_lshlrev_b32_e64 v22, 16, v23
    v_and_b32 v23, 0xffff0000, v23
    v_mfma_f32_16x16x32_bf16 v[104:107], a[168:171], v[64:67], v[104:107]
    v_mul_f32 v22, v22, v51
    v_mul_f32 v23, v23, v51
    v_mfma_f32_16x16x32_bf16 v[104:107], a[184:187], v[68:71], v[104:107]
    v_cvt_pk_bf16_f32 v3, v22, v23
    v_sub_f32_e64 v24, v24, v50
    v_mfma_f32_16x16x32_bf16 v[108:111], a[172:175], v[64:67], v[108:111]
    v_sub_f32_e64 v25, v25, v50
    v_cvt_pk_bf16_f32 v25, v24, v25
    v_lshlrev_b32_e64 v24, 16, v25
    v_mfma_f32_16x16x32_bf16 v[108:111], a[188:191], v[68:71], v[108:111]
    v_and_b32 v25, 0xffff0000, v25
    v_mul_f32_e64 v24, v24, v51
    v_mfma_f32_16x16x32_bf16 v[112:115], a[160:163], v[72:75], v[112:115]
    s_add_u32 m0, s35, 12288
    s_add_u32 s33, s33, 131072
    buffer_load_dwordx4 v234, s[48:51], s33 offen lds
    v_mfma_f32_16x16x32_bf16 v[112:115], a[176:179], v[76:79], v[112:115]
    v_mul_f32_e64 v25, v25, v51
    v_cvt_pk_bf16_f32 v4, v24, v25
    v_mfma_f32_16x16x32_bf16 v[116:119], a[164:167], v[72:75], v[116:119]
    buffer_load_dwordx4 v235, s[48:51], s33 offen offset:1024 lds
    v_sub_f32 v26, v26, v50
    v_sub_f32 v27, v27, v50
    v_mfma_f32_16x16x32_bf16 v[116:119], a[180:183], v[76:79], v[116:119]
    v_cvt_pk_bf16_f32 v27, v26, v27
    v_lshlrev_b32_e64 v26, 16, v27
    v_mfma_f32_16x16x32_bf16 v[120:123], a[168:171], v[72:75], v[120:123]
    s_add_u32 m0, s35, 14336
    s_add_u32 s33, s33, 131072
    buffer_load_dwordx4 v234, s[48:51], s33 offen lds
    v_mfma_f32_16x16x32_bf16 v[120:123], a[184:187], v[76:79], v[120:123]
    v_and_b32 v27, 0xffff0000, v27
    v_mul_f32_e64 v26, v26, v51
    v_mfma_f32_16x16x32_bf16 v[124:127], a[172:175], v[72:75], v[124:127]
    buffer_load_dwordx4 v235, s[48:51], s33 offen offset:1024 lds
    v_mul_f32_e64 v27, v27, v51
    v_cvt_pk_bf16_f32 v5, v26, v27
    v_mfma_f32_16x16x32_bf16 v[124:127], a[188:191], v[76:79], v[124:127]
    v_sub_f32 v28, v28, v50
    s_waitcnt lgkmcnt(0)
    v_mfma_f32_16x16x32_bf16 v[128:131], a[160:163], v[80:83], v[128:131]
    ds_read_b128 v[64:67], v224 offset:24576
    v_sub_f32_e64 v29, v29, v50
    v_mfma_f32_16x16x32_bf16 v[128:131], a[176:179], v[84:87], v[128:131]
    ds_read_b128 v[68:71], v225 offset:24576
    v_cvt_pk_bf16_f32 v29, v28, v29
    v_mfma_f32_16x16x32_bf16 v[132:135], a[164:167], v[80:83], v[132:135]
    ds_read_b128 v[72:75], v224 offset:26624
    v_lshlrev_b32_e64 v28, 16, v29
    v_mfma_f32_16x16x32_bf16 v[132:135], a[180:183], v[84:87], v[132:135]
    ds_read_b128 v[76:79], v225 offset:26624
    v_and_b32 v29, 0xffff0000, v29
    v_mfma_f32_16x16x32_bf16 v[136:139], a[168:171], v[80:83], v[136:139]
    v_mul_f32 v28, v28, v51
    v_mul_f32 v29, v29, v51
    v_cvt_pk_bf16_f32 v6, v28, v29
    v_mfma_f32_16x16x32_bf16 v[136:139], a[184:187], v[84:87], v[136:139]
    v_sub_f32 v30, v30, v50
    v_sub_f32 v31, v31, v50
    v_mfma_f32_16x16x32_bf16 v[140:143], a[172:175], v[80:83], v[140:143]
    v_cvt_pk_bf16_f32 v31, v30, v31
    v_lshlrev_b32_e64 v30, 16, v31
    v_and_b32 v31, 0xffff0000, v31
    v_mfma_f32_16x16x32_bf16 v[140:143], a[188:191], v[84:87], v[140:143]
    v_mul_f32 v30, v30, v51
    v_mul_f32 v31, v31, v51
    v_mfma_f32_16x16x32_bf16 v[144:147], a[160:163], v[88:91], v[144:147]
    s_add_u32 m0, s34, 8192
    s_add_u32 s37, s81, 131072
    buffer_load_dwordx4 v232, s[44:47], s37 offen lds
    v_mfma_f32_16x16x32_bf16 v[144:147], a[176:179], v[92:95], v[144:147]
    v_cvt_pk_bf16_f32 v7, v30, v31
    v_sub_f32_e64 v32, v32, v50
    v_mfma_f32_16x16x32_bf16 v[148:151], a[164:167], v[88:91], v[148:151]
    buffer_load_dwordx4 v233, s[44:47], s37 offen offset:1024 lds
    v_sub_f32_e64 v33, v33, v50
    v_mfma_f32_16x16x32_bf16 v[148:151], a[180:183], v[92:95], v[148:151]
    v_cvt_pk_bf16_f32 v33, v32, v33
    v_lshlrev_b32_e64 v32, 16, v33
    v_and_b32 v33, 0xffff0000, v33
    v_mfma_f32_16x16x32_bf16 v[152:155], a[168:171], v[88:91], v[152:155]
    v_lshlrev_b32_e64 v227, 3, v240
    v_min_u32 v227, 1920, v227
    s_lshl2_add_u32 s25, s2, s3
    v_mfma_f32_16x16x32_bf16 v[152:155], a[184:187], v[92:95], v[152:155]
    v_mul_f32 v32, v32, v51
    v_mul_f32_e64 v33, v33, v51
    v_mfma_f32_16x16x32_bf16 v[156:159], a[172:175], v[88:91], v[156:159]
    s_lshl_b32 s25, s25, 13
    s_add_u32 s25, s25, 4096
    buffer_load_dword v241, v227, s[12:15], s25 offen
    v_mfma_f32_16x16x32_bf16 v[156:159], a[188:191], v[92:95], v[156:159]
    v_cvt_pk_bf16_f32 v8, v32, v33
    s_waitcnt vmcnt(16) lgkmcnt(0)
    v_mfma_f32_16x16x32_bf16 v[160:163], a[160:163], v[64:67], v[160:163]
    ds_read_b128 v[80:83], v224 offset:28672
    v_sub_f32 v34, v34, v50
    v_sub_f32 v35, v35, v50
    v_mfma_f32_16x16x32_bf16 v[160:163], a[176:179], v[68:71], v[160:163]
    ds_read_b128 v[84:87], v225 offset:28672
    v_cvt_pk_bf16_f32 v35, v34, v35
    v_mfma_f32_16x16x32_bf16 v[164:167], a[164:167], v[64:67], v[164:167]
    ds_read_b128 v[88:91], v224 offset:30720
    v_lshlrev_b32_e64 v34, 16, v35
    v_mfma_f32_16x16x32_bf16 v[164:167], a[180:183], v[68:71], v[164:167]
    ds_read_b128 v[92:95], v225 offset:30720
    v_and_b32 v35, 0xffff0000, v35
    v_mfma_f32_16x16x32_bf16 v[168:171], a[168:171], v[64:67], v[168:171]
    ds_read_b64_tr_b16 a[192:193], v228 offset:0
    v_mul_f32_e64 v34, v34, v51
    v_mfma_f32_16x16x32_bf16 v[168:171], a[184:187], v[68:71], v[168:171]
    ds_read_b64_tr_b16 a[194:195], v228 offset:512
    v_mul_f32_e64 v35, v35, v51
    v_cvt_pk_bf16_f32 v9, v34, v35
    v_mfma_f32_16x16x32_bf16 v[172:175], a[172:175], v[64:67], v[172:175]
    ds_read_b64_tr_b16 a[196:197], v229 offset:0
    v_sub_f32_e64 v36, v36, v50
    v_mfma_f32_16x16x32_bf16 v[172:175], a[188:191], v[68:71], v[172:175]
    ds_read_b64_tr_b16 a[198:199], v229 offset:512
    v_sub_f32_e64 v37, v37, v50
    v_mfma_f32_16x16x32_bf16 v[176:179], a[160:163], v[72:75], v[176:179]
    ds_read_b64_tr_b16 a[200:201], v230 offset:0
    v_cvt_pk_bf16_f32 v37, v36, v37
    v_mfma_f32_16x16x32_bf16 v[176:179], a[176:179], v[76:79], v[176:179]
    ds_read_b64_tr_b16 a[202:203], v230 offset:512
    v_lshlrev_b32_e64 v36, 16, v37
    v_mfma_f32_16x16x32_bf16 v[180:183], a[164:167], v[72:75], v[180:183]
    ds_read_b64_tr_b16 a[204:205], v231 offset:0
    v_and_b32 v37, 0xffff0000, v37
    v_mfma_f32_16x16x32_bf16 v[180:183], a[180:183], v[76:79], v[180:183]
    ds_read_b64_tr_b16 a[206:207], v231 offset:512
    v_mul_f32 v36, v36, v51
    v_mul_f32 v37, v37, v51
    v_mfma_f32_16x16x32_bf16 v[184:187], a[168:171], v[72:75], v[184:187]
    v_cvt_pk_bf16_f32 v10, v36, v37
    v_sub_f32_e64 v38, v38, v50
    v_mfma_f32_16x16x32_bf16 v[184:187], a[184:187], v[76:79], v[184:187]
    v_sub_f32_e64 v39, v39, v50
    v_cvt_pk_bf16_f32 v39, v38, v39
    v_mfma_f32_16x16x32_bf16 v[188:191], a[172:175], v[72:75], v[188:191]
    v_lshlrev_b32_e64 v38, 16, v39
    v_and_b32 v39, 0xffff0000, v39
    v_mul_f32_e64 v38, v38, v51
    v_mfma_f32_16x16x32_bf16 v[188:191], a[188:191], v[76:79], v[188:191]
    s_waitcnt vmcnt(27) lgkmcnt(0)
    s_barrier
    v_mfma_f32_16x16x32_bf16 v[192:195], a[160:163], v[80:83], v[192:195]
    ds_read_b128 v[64:67], v224 offset:32768
    v_mul_f32_e64 v39, v39, v51
    v_mfma_f32_16x16x32_bf16 v[192:195], a[176:179], v[84:87], v[192:195]
    ds_read_b128 v[68:71], v225 offset:32768
    v_cvt_pk_bf16_f32 v11, v38, v39
    v_mfma_f32_16x16x32_bf16 v[196:199], a[164:167], v[80:83], v[196:199]
    ds_read_b128 v[72:75], v224 offset:34816
    v_sub_f32_e64 v40, v40, v50
    v_mfma_f32_16x16x32_bf16 v[196:199], a[180:183], v[84:87], v[196:199]
    ds_read_b128 v[76:79], v225 offset:34816
    v_sub_f32_e64 v41, v41, v50
    v_mfma_f32_16x16x32_bf16 v[200:203], a[168:171], v[80:83], v[200:203]
    ds_read_b64_tr_b16 a[208:209], v228 offset:4096
    v_cvt_pk_bf16_f32 v41, v40, v41
    v_lshlrev_b32_e64 v40, 16, v41
    v_mfma_f32_16x16x32_bf16 v[200:203], a[184:187], v[84:87], v[200:203]
    ds_read_b64_tr_b16 a[210:211], v228 offset:4608
    v_and_b32 v41, 0xffff0000, v41
    v_mfma_f32_16x16x32_bf16 v[204:207], a[172:175], v[80:83], v[204:207]
    ds_read_b64_tr_b16 a[212:213], v229 offset:4096
    v_mul_f32_e64 v40, v40, v51
    v_mfma_f32_16x16x32_bf16 v[204:207], a[188:191], v[84:87], v[204:207]
    ds_read_b64_tr_b16 a[214:215], v229 offset:4608
    v_mul_f32_e64 v41, v41, v51
    v_mfma_f32_16x16x32_bf16 v[208:211], a[160:163], v[88:91], v[208:211]
    ds_read_b64_tr_b16 a[216:217], v230 offset:4096
    s_add_u32 m0, s34, 16384
    s_add_u32 s37, s82, 131072
    buffer_load_dwordx4 v232, s[44:47], s37 offen lds
    v_mfma_f32_16x16x32_bf16 v[208:211], a[176:179], v[92:95], v[208:211]
    ds_read_b64_tr_b16 a[218:219], v230 offset:4608
    v_cvt_pk_bf16_f32 v12, v40, v41
    v_mfma_f32_16x16x32_bf16 v[212:215], a[164:167], v[88:91], v[212:215]
    ds_read_b64_tr_b16 a[220:221], v231 offset:4096
    v_sub_f32 v42, v42, v50
    v_sub_f32 v43, v43, v50
    v_mfma_f32_16x16x32_bf16 v[212:215], a[180:183], v[92:95], v[212:215]
    ds_read_b64_tr_b16 a[222:223], v231 offset:4608
    v_cvt_pk_bf16_f32 v43, v42, v43
    v_mfma_f32_16x16x32_bf16 v[216:219], a[168:171], v[88:91], v[216:219]
    buffer_load_dwordx4 v233, s[44:47], s37 offen offset:1024 lds
    v_lshlrev_b32_e64 v42, 16, v43
    v_mfma_f32_16x16x32_bf16 v[216:219], a[184:187], v[92:95], v[216:219]
    v_and_b32 v43, 0xffff0000, v43
    v_mul_f32_e64 v42, v42, v51
    v_mfma_f32_16x16x32_bf16 v[220:223], a[172:175], v[88:91], v[220:223]
    v_mul_f32_e64 v43, v43, v51
    v_cvt_pk_bf16_f32 v13, v42, v43
    v_sub_f32_e64 v44, v44, v50
    v_mfma_f32_16x16x32_bf16 v[220:223], a[188:191], v[92:95], v[220:223]
    v_sub_f32 v45, v45, v50
    s_waitcnt lgkmcnt(0)
    v_mfma_f32_16x16x32_bf16 v[96:99], a[192:195], v[64:67], v[96:99]
    ds_read_b128 v[80:83], v224 offset:36864
    v_cvt_pk_bf16_f32 v45, v44, v45
    v_mfma_f32_16x16x32_bf16 v[96:99], a[208:211], v[68:71], v[96:99]
    ds_read_b128 v[84:87], v225 offset:36864
    v_lshlrev_b32_e64 v44, 16, v45
    v_mfma_f32_16x16x32_bf16 v[100:103], a[196:199], v[64:67], v[100:103]
    ds_read_b128 v[88:91], v224 offset:38912
    v_and_b32 v45, 0xffff0000, v45
    v_mfma_f32_16x16x32_bf16 v[100:103], a[212:215], v[68:71], v[100:103]
    ds_read_b128 v[92:95], v225 offset:38912
    v_mul_f32 v44, v44, v51
    v_mul_f32 v45, v45, v51
    v_mfma_f32_16x16x32_bf16 v[104:107], a[200:203], v[64:67], v[104:107]
    v_cvt_pk_bf16_f32 v14, v44, v45
    v_sub_f32_e64 v46, v46, v50
    v_mfma_f32_16x16x32_bf16 v[104:107], a[216:219], v[68:71], v[104:107]
    v_sub_f32_e64 v47, v47, v50
    v_cvt_pk_bf16_f32 v47, v46, v47
    v_mfma_f32_16x16x32_bf16 v[108:111], a[204:207], v[64:67], v[108:111]
    v_lshlrev_b32_e64 v46, 16, v47
    v_and_b32 v47, 0xffff0000, v47
    v_mul_f32_e64 v46, v46, v51
    v_mfma_f32_16x16x32_bf16 v[108:111], a[220:223], v[68:71], v[108:111]
    v_mul_f32_e64 v47, v47, v51
    v_cvt_pk_bf16_f32 v15, v46, v47
    v_mfma_f32_16x16x32_bf16 v[112:115], a[192:195], v[72:75], v[112:115]
    v_mfma_f32_16x16x32_bf16 v[112:115], a[208:211], v[76:79], v[112:115]
    ds_write_b128 v237, v[0:3] offset:0
    v_mfma_f32_16x16x32_bf16 v[116:119], a[196:199], v[72:75], v[116:119]
    ds_write_b128 v237, v[4:7] offset:4096
    v_mfma_f32_16x16x32_bf16 v[116:119], a[212:215], v[76:79], v[116:119]
    ds_write_b128 v237, v[8:11] offset:24576
    v_mfma_f32_16x16x32_bf16 v[120:123], a[200:203], v[72:75], v[120:123]
    ds_write_b128 v237, v[12:15] offset:28672
    v_mfma_f32_16x16x32_bf16 v[120:123], a[216:219], v[76:79], v[120:123]
    v_mfma_f32_16x16x32_bf16 v[124:127], a[204:207], v[72:75], v[124:127]
    v_mfma_f32_16x16x32_bf16 v[124:127], a[220:223], v[76:79], v[124:127]
    s_waitcnt lgkmcnt(0)
    v_mfma_f32_16x16x32_bf16 v[128:131], a[192:195], v[80:83], v[128:131]
    ds_read_b128 v[64:67], v224 offset:40960
    v_mfma_f32_16x16x32_bf16 v[128:131], a[208:211], v[84:87], v[128:131]
    ds_read_b128 v[68:71], v225 offset:40960
    v_mfma_f32_16x16x32_bf16 v[132:135], a[196:199], v[80:83], v[132:135]
    ds_read_b128 v[72:75], v224 offset:43008
    v_mfma_f32_16x16x32_bf16 v[132:135], a[212:215], v[84:87], v[132:135]
    ds_read_b128 v[76:79], v225 offset:43008
    v_mfma_f32_16x16x32_bf16 v[136:139], a[200:203], v[80:83], v[136:139]
    v_mfma_f32_16x16x32_bf16 v[136:139], a[216:219], v[84:87], v[136:139]
    v_mfma_f32_16x16x32_bf16 v[140:143], a[204:207], v[80:83], v[140:143]
    v_mfma_f32_16x16x32_bf16 v[140:143], a[220:223], v[84:87], v[140:143]
    v_mfma_f32_16x16x32_bf16 v[144:147], a[192:195], v[88:91], v[144:147]
    s_add_u32 m0, s34, 24576
    s_add_u32 s37, s83, 131072
    buffer_load_dwordx4 v232, s[44:47], s37 offen lds
    v_mfma_f32_16x16x32_bf16 v[144:147], a[208:211], v[92:95], v[144:147]
    buffer_load_dwordx4 v233, s[44:47], s37 offen offset:1024 lds
    v_mfma_f32_16x16x32_bf16 v[148:151], a[196:199], v[88:91], v[148:151]
    v_mfma_f32_16x16x32_bf16 v[148:151], a[212:215], v[92:95], v[148:151]
    v_lshlrev_b32 v227, 3, v240
    v_min_u32 v227, 1920, v227
    s_lshl2_add_u32 s25, s2, s3
    v_mfma_f32_16x16x32_bf16 v[152:155], a[200:203], v[88:91], v[152:155]
    s_lshl_b32 s25, s25, 13
    s_add_u32 s25, s25, 6144
    buffer_load_dword v241, v227, s[12:15], s25 offen
    v_mfma_f32_16x16x32_bf16 v[152:155], a[216:219], v[92:95], v[152:155]
    v_mfma_f32_16x16x32_bf16 v[156:159], a[204:207], v[88:91], v[156:159]
    buffer_load_dword v254, off, s[88:91], s97 sc1
    v_mfma_f32_16x16x32_bf16 v[156:159], a[220:223], v[92:95], v[156:159]
    s_waitcnt vmcnt(9) lgkmcnt(0)
    v_mfma_f32_16x16x32_bf16 v[160:163], a[192:195], v[64:67], v[160:163]
    ds_read_b128 v[80:83], v224 offset:45056
    v_mfma_f32_16x16x32_bf16 v[160:163], a[208:211], v[68:71], v[160:163]
    ds_read_b128 v[84:87], v225 offset:45056
    s_mul_i32 s38, s2, 100
    v_mfma_f32_16x16x32_bf16 v[164:167], a[196:199], v[64:67], v[164:167]
    ds_read_b128 v[88:91], v224 offset:47104
    v_mfma_f32_16x16x32_bf16 v[164:167], a[212:215], v[68:71], v[164:167]
    ds_read_b128 v[92:95], v225 offset:47104
    v_lshl_add_u32 v60, v253, 2, s38
    v_mfma_f32_16x16x32_bf16 v[168:171], a[200:203], v[64:67], v[168:171]
    ds_read_b64_tr_b16 a[224:225], v228 offset:8192
    v_mfma_f32_16x16x32_bf16 v[168:171], a[216:219], v[68:71], v[168:171]
    ds_read_b64_tr_b16 a[226:227], v228 offset:8704
    v_cmp_gt_u32 vcc, 25, v253
    v_mfma_f32_16x16x32_bf16 v[172:175], a[204:207], v[64:67], v[172:175]
    ds_read_b64_tr_b16 a[228:229], v229 offset:8192
    v_mfma_f32_16x16x32_bf16 v[172:175], a[220:223], v[68:71], v[172:175]
    ds_read_b64_tr_b16 a[230:231], v229 offset:8704
    v_mov_b32_e64 v61, 0
    v_mfma_f32_16x16x32_bf16 v[176:179], a[192:195], v[72:75], v[176:179]
    ds_read_b64_tr_b16 a[232:233], v230 offset:8192
    v_mfma_f32_16x16x32_bf16 v[176:179], a[208:211], v[76:79], v[176:179]
    ds_read_b64_tr_b16 a[234:235], v230 offset:8704
    v_mfma_f32_16x16x32_bf16 v[180:183], a[196:199], v[72:75], v[180:183]
    ds_read_b64_tr_b16 a[236:237], v231 offset:8192
    v_mov_b32 v62, 0x7ffffff0
    v_mfma_f32_16x16x32_bf16 v[180:183], a[212:215], v[76:79], v[180:183]
    ds_read_b64_tr_b16 a[238:239], v231 offset:8704
    v_mfma_f32_16x16x32_bf16 v[184:187], a[200:203], v[72:75], v[184:187]
    v_cndmask_b32 v60, v62, v60, vcc
    v_mfma_f32_16x16x32_bf16 v[184:187], a[216:219], v[76:79], v[184:187]
    buffer_store_dword v61, v60, s[56:59], 0 offen sc1
    v_mfma_f32_16x16x32_bf16 v[188:191], a[204:207], v[72:75], v[188:191]
    v_mfma_f32_16x16x32_bf16 v[188:191], a[220:223], v[76:79], v[188:191]
    s_waitcnt vmcnt(21) lgkmcnt(0)
    s_barrier
    v_mfma_f32_16x16x32_bf16 v[192:195], a[192:195], v[80:83], v[192:195]
    ds_read_b128 v[64:67], v224 offset:49152
    v_mfma_f32_16x16x32_bf16 v[192:195], a[208:211], v[84:87], v[192:195]
    ds_read_b128 v[68:71], v225 offset:49152
    v_mfma_f32_16x16x32_bf16 v[196:199], a[196:199], v[80:83], v[196:199]
    ds_read_b128 v[72:75], v224 offset:51200
    v_mfma_f32_16x16x32_bf16 v[196:199], a[212:215], v[84:87], v[196:199]
    ds_read_b128 v[76:79], v225 offset:51200
    v_mfma_f32_16x16x32_bf16 v[200:203], a[200:203], v[80:83], v[200:203]
    ds_read_b64_tr_b16 a[240:241], v228 offset:12288
    v_mfma_f32_16x16x32_bf16 v[200:203], a[216:219], v[84:87], v[200:203]
    ds_read_b64_tr_b16 a[242:243], v228 offset:12800
    v_mfma_f32_16x16x32_bf16 v[204:207], a[204:207], v[80:83], v[204:207]
    ds_read_b64_tr_b16 a[244:245], v229 offset:12288
    v_mfma_f32_16x16x32_bf16 v[204:207], a[220:223], v[84:87], v[204:207]
    ds_read_b64_tr_b16 a[246:247], v229 offset:12800
    v_mfma_f32_16x16x32_bf16 v[208:211], a[192:195], v[88:91], v[208:211]
    ds_read_b64_tr_b16 a[248:249], v230 offset:12288
    v_lshlrev_b32 v237, 4, v253
    v_add_u32 v237, 81920, v237
    ds_read_b128 v[16:19], v237 offset:0
    ds_read_b128 v[20:23], v237 offset:4096
    ds_read_b128 v[24:27], v237 offset:24576
    ds_read_b128 v[28:31], v237 offset:28672
    s_add_u32 m0, s34, 32768
    s_add_u32 s37, s84, 131072
    buffer_load_dwordx4 v232, s[44:47], s37 offen lds
    v_mfma_f32_16x16x32_bf16 v[208:211], a[208:211], v[92:95], v[208:211]
    ds_read_b64_tr_b16 a[250:251], v230 offset:12800
    v_mfma_f32_16x16x32_bf16 v[212:215], a[196:199], v[88:91], v[212:215]
    ds_read_b64_tr_b16 a[252:253], v231 offset:12288
    v_mfma_f32_16x16x32_bf16 v[212:215], a[212:215], v[92:95], v[212:215]
    ds_read_b64_tr_b16 a[254:255], v231 offset:12800
    v_mfma_f32_16x16x32_bf16 v[216:219], a[200:203], v[88:91], v[216:219]
    buffer_load_dwordx4 v233, s[44:47], s37 offen offset:1024 lds
    v_mfma_f32_16x16x32_bf16 v[216:219], a[216:219], v[92:95], v[216:219]
    v_mfma_f32_16x16x32_bf16 v[220:223], a[204:207], v[88:91], v[220:223]
    v_mfma_f32_16x16x32_bf16 v[220:223], a[220:223], v[92:95], v[220:223]
    s_waitcnt lgkmcnt(0)
    v_mfma_f32_16x16x32_bf16 v[96:99], a[224:227], v[64:67], v[96:99]
    ds_read_b128 v[80:83], v224 offset:53248
    v_mfma_f32_16x16x32_bf16 v[96:99], a[240:243], v[68:71], v[96:99]
    ds_read_b128 v[84:87], v225 offset:53248
    v_mfma_f32_16x16x32_bf16 v[100:103], a[228:231], v[64:67], v[100:103]
    ds_read_b128 v[88:91], v224 offset:55296
    v_mfma_f32_16x16x32_bf16 v[100:103], a[244:247], v[68:71], v[100:103]
    ds_read_b128 v[92:95], v225 offset:55296
    v_mfma_f32_16x16x32_bf16 v[104:107], a[232:235], v[64:67], v[104:107]
    v_mfma_f32_16x16x32_bf16 v[104:107], a[248:251], v[68:71], v[104:107]
    s_mov_b32 s39, 0
    buffer_store_dwordx4 v[16:19], v238, s[8:11], s39 offen sc1
    v_mfma_f32_16x16x32_bf16 v[108:111], a[236:239], v[64:67], v[108:111]
    v_mfma_f32_16x16x32_bf16 v[108:111], a[252:255], v[68:71], v[108:111]
    v_mfma_f32_16x16x32_bf16 v[112:115], a[224:227], v[72:75], v[112:115]
    v_mfma_f32_16x16x32_bf16 v[112:115], a[240:243], v[76:79], v[112:115]
    v_mfma_f32_16x16x32_bf16 v[116:119], a[228:231], v[72:75], v[116:119]
    v_mfma_f32_16x16x32_bf16 v[116:119], a[244:247], v[76:79], v[116:119]
    v_mfma_f32_16x16x32_bf16 v[120:123], a[232:235], v[72:75], v[120:123]
    v_mfma_f32_16x16x32_bf16 v[120:123], a[248:251], v[76:79], v[120:123]
    s_mov_b32 s39, 8192
    buffer_store_dwordx4 v[20:23], v238, s[8:11], s39 offen sc1
    v_mfma_f32_16x16x32_bf16 v[124:127], a[236:239], v[72:75], v[124:127]
    v_mfma_f32_16x16x32_bf16 v[124:127], a[252:255], v[76:79], v[124:127]
    s_waitcnt lgkmcnt(0)
    v_mfma_f32_16x16x32_bf16 v[128:131], a[224:227], v[80:83], v[128:131]
    ds_read_b128 v[64:67], v224 offset:57344
    v_mfma_f32_16x16x32_bf16 v[128:131], a[240:243], v[84:87], v[128:131]
    ds_read_b128 v[68:71], v225 offset:57344
    v_mfma_f32_16x16x32_bf16 v[132:135], a[228:231], v[80:83], v[132:135]
    ds_read_b128 v[72:75], v224 offset:59392
    v_mfma_f32_16x16x32_bf16 v[132:135], a[244:247], v[84:87], v[132:135]
    ds_read_b128 v[76:79], v225 offset:59392
    v_mfma_f32_16x16x32_bf16 v[136:139], a[232:235], v[80:83], v[136:139]
    v_mfma_f32_16x16x32_bf16 v[136:139], a[248:251], v[84:87], v[136:139]
    s_mov_b32 s39, 16384
    buffer_store_dwordx4 v[24:27], v238, s[8:11], s39 offen sc1
    v_mfma_f32_16x16x32_bf16 v[140:143], a[236:239], v[80:83], v[140:143]
    v_mfma_f32_16x16x32_bf16 v[140:143], a[252:255], v[84:87], v[140:143]
    v_mfma_f32_16x16x32_bf16 v[144:147], a[224:227], v[88:91], v[144:147]
    s_add_u32 m0, s34, 40960
    s_add_u32 s37, s85, 131072
    buffer_load_dwordx4 v232, s[44:47], s37 offen lds
    v_mfma_f32_16x16x32_bf16 v[144:147], a[240:243], v[92:95], v[144:147]
    v_mfma_f32_16x16x32_bf16 v[148:151], a[228:231], v[88:91], v[148:151]
    v_mfma_f32_16x16x32_bf16 v[148:151], a[244:247], v[92:95], v[148:151]
    v_mfma_f32_16x16x32_bf16 v[152:155], a[232:235], v[88:91], v[152:155]
    buffer_load_dwordx4 v233, s[44:47], s37 offen offset:1024 lds
    v_mfma_f32_16x16x32_bf16 v[152:155], a[248:251], v[92:95], v[152:155]
    s_mov_b32 s39, 24576
    buffer_store_dwordx4 v[28:31], v238, s[8:11], s39 offen sc1
    v_mfma_f32_16x16x32_bf16 v[156:159], a[236:239], v[88:91], v[156:159]
    v_mfma_f32_16x16x32_bf16 v[156:159], a[252:255], v[92:95], v[156:159]
    s_waitcnt lgkmcnt(0)
    v_mfma_f32_16x16x32_bf16 v[160:163], a[224:227], v[64:67], v[160:163]
    ds_read_b128 v[80:83], v224 offset:61440
    v_mfma_f32_16x16x32_bf16 v[160:163], a[240:243], v[68:71], v[160:163]
    ds_read_b128 v[84:87], v225 offset:61440
    v_mfma_f32_16x16x32_bf16 v[164:167], a[228:231], v[64:67], v[164:167]
    ds_read_b128 v[88:91], v224 offset:63488
    v_mfma_f32_16x16x32_bf16 v[164:167], a[244:247], v[68:71], v[164:167]
    ds_read_b128 v[92:95], v225 offset:63488
    v_mfma_f32_16x16x32_bf16 v[168:171], a[232:235], v[64:67], v[168:171]
    v_mfma_f32_16x16x32_bf16 v[168:171], a[248:251], v[68:71], v[168:171]
    v_mfma_f32_16x16x32_bf16 v[172:175], a[236:239], v[64:67], v[172:175]
    v_mfma_f32_16x16x32_bf16 v[172:175], a[252:255], v[68:71], v[172:175]
    v_mfma_f32_16x16x32_bf16 v[176:179], a[224:227], v[72:75], v[176:179]
    v_mfma_f32_16x16x32_bf16 v[176:179], a[240:243], v[76:79], v[176:179]
    v_cvt_pk_bf16_f32 v0, v96, v97
    v_cvt_pk_bf16_f32 v1, v98, v99
    v_mfma_f32_16x16x32_bf16 v[180:183], a[228:231], v[72:75], v[180:183]
    v_cvt_pk_bf16_f32 v2, v100, v101
    v_cvt_pk_bf16_f32 v3, v102, v103
    v_mfma_f32_16x16x32_bf16 v[180:183], a[244:247], v[76:79], v[180:183]
    v_cvt_pk_bf16_f32 v4, v104, v105
    v_cvt_pk_bf16_f32 v5, v106, v107
    v_mfma_f32_16x16x32_bf16 v[184:187], a[232:235], v[72:75], v[184:187]
    v_cvt_pk_bf16_f32 v6, v108, v109
    v_cvt_pk_bf16_f32 v7, v110, v111
    v_mfma_f32_16x16x32_bf16 v[184:187], a[248:251], v[76:79], v[184:187]
    v_cvt_pk_bf16_f32 v8, v112, v113
    v_cvt_pk_bf16_f32 v9, v114, v115
    v_mfma_f32_16x16x32_bf16 v[188:191], a[236:239], v[72:75], v[188:191]
    v_cvt_pk_bf16_f32 v10, v116, v117
    v_cvt_pk_bf16_f32 v11, v118, v119
    v_mfma_f32_16x16x32_bf16 v[188:191], a[252:255], v[76:79], v[188:191]
    v_cvt_pk_bf16_f32 v12, v120, v121
    v_cvt_pk_bf16_f32 v13, v122, v123
    s_waitcnt vmcnt(16) lgkmcnt(0)
    s_barrier
    v_mfma_f32_16x16x32_bf16 v[192:195], a[224:227], v[80:83], v[192:195]
    ds_read_b128 v[64:67], v224 offset:0
    v_cvt_pk_bf16_f32 v14, v124, v125
    v_cvt_pk_bf16_f32 v15, v126, v127
    v_mfma_f32_16x16x32_bf16 v[192:195], a[240:243], v[84:87], v[192:195]
    ds_read_b128 v[68:71], v225 offset:0
    v_cvt_pk_bf16_f32 v16, v128, v129
    v_cvt_pk_bf16_f32 v17, v130, v131
    v_mfma_f32_16x16x32_bf16 v[196:199], a[228:231], v[80:83], v[196:199]
    ds_read_b128 v[72:75], v224 offset:8192
    v_cvt_pk_bf16_f32 v18, v132, v133
    v_cvt_pk_bf16_f32 v19, v134, v135
    v_mfma_f32_16x16x32_bf16 v[196:199], a[244:247], v[84:87], v[196:199]
    ds_read_b128 v[76:79], v225 offset:8192
    v_cvt_pk_bf16_f32 v20, v136, v137
    v_cvt_pk_bf16_f32 v21, v138, v139
    v_mfma_f32_16x16x32_bf16 v[200:203], a[232:235], v[80:83], v[200:203]
    v_cvt_pk_bf16_f32 v22, v140, v141
    v_cvt_pk_bf16_f32 v23, v142, v143
    v_mfma_f32_16x16x32_bf16 v[200:203], a[248:251], v[84:87], v[200:203]
    v_cvt_pk_bf16_f32 v24, v144, v145
    v_cvt_pk_bf16_f32 v25, v146, v147
    v_mfma_f32_16x16x32_bf16 v[204:207], a[236:239], v[80:83], v[204:207]
    v_cvt_pk_bf16_f32 v26, v148, v149
    v_cvt_pk_bf16_f32 v27, v150, v151
    v_mfma_f32_16x16x32_bf16 v[204:207], a[252:255], v[84:87], v[204:207]
    v_cvt_pk_bf16_f32 v28, v152, v153
    v_cvt_pk_bf16_f32 v29, v154, v155
    v_mfma_f32_16x16x32_bf16 v[208:211], a[224:227], v[88:91], v[208:211]
    s_add_u32 m0, s34, 49152
    s_add_u32 s37, s86, 131072
    buffer_load_dwordx4 v232, s[44:47], s37 offen lds
    v_cvt_pk_bf16_f32 v30, v156, v157
    v_cvt_pk_bf16_f32 v31, v158, v159
    v_mfma_f32_16x16x32_bf16 v[208:211], a[240:243], v[92:95], v[208:211]
    v_cvt_pk_bf16_f32 v32, v160, v161
    v_cvt_pk_bf16_f32 v33, v162, v163
    v_mfma_f32_16x16x32_bf16 v[212:215], a[228:231], v[88:91], v[212:215]
    v_cvt_pk_bf16_f32 v34, v164, v165
    v_cvt_pk_bf16_f32 v35, v166, v167
    v_mfma_f32_16x16x32_bf16 v[212:215], a[244:247], v[92:95], v[212:215]
    v_cvt_pk_bf16_f32 v36, v168, v169
    v_cvt_pk_bf16_f32 v37, v170, v171
    v_mfma_f32_16x16x32_bf16 v[216:219], a[232:235], v[88:91], v[216:219]
    buffer_load_dwordx4 v233, s[44:47], s37 offen offset:1024 lds
    v_cvt_pk_bf16_f32 v38, v172, v173
    v_cvt_pk_bf16_f32 v39, v174, v175
    v_mfma_f32_16x16x32_bf16 v[216:219], a[248:251], v[92:95], v[216:219]
    v_cvt_pk_bf16_f32 v40, v176, v177
    v_cvt_pk_bf16_f32 v41, v178, v179
    v_mfma_f32_16x16x32_bf16 v[220:223], a[236:239], v[88:91], v[220:223]
    v_cvt_pk_bf16_f32 v42, v180, v181
    v_cvt_pk_bf16_f32 v43, v182, v183
    v_mfma_f32_16x16x32_bf16 v[220:223], a[252:255], v[92:95], v[220:223]
    v_cvt_pk_bf16_f32 v44, v184, v185
    v_cvt_pk_bf16_f32 v45, v186, v187
    s_waitcnt lgkmcnt(0)
    v_mfma_f32_16x16x32_bf16 v[96:99], a[0:3], v[64:67], 0
    ds_read_b128 v[80:83], v224 offset:2048
    v_cvt_pk_bf16_f32 v46, v188, v189
    v_cvt_pk_bf16_f32 v47, v190, v191
    v_mfma_f32_16x16x32_bf16 v[96:99], a[16:19], v[68:71], v[96:99]
    ds_read_b128 v[84:87], v225 offset:2048
    v_cvt_pk_bf16_f32 v48, v192, v193
    v_cvt_pk_bf16_f32 v49, v194, v195
    v_mfma_f32_16x16x32_bf16 v[96:99], a[32:35], v[72:75], v[96:99]
    ds_read_b128 v[88:91], v224 offset:10240
    v_cvt_pk_bf16_f32 v50, v196, v197
    v_cvt_pk_bf16_f32 v51, v198, v199
    v_mfma_f32_16x16x32_bf16 v[96:99], a[48:51], v[76:79], v[96:99]
    ds_read_b128 v[92:95], v225 offset:10240
    v_cvt_pk_bf16_f32 v52, v200, v201
    v_cvt_pk_bf16_f32 v53, v202, v203
    v_mfma_f32_16x16x32_bf16 v[100:103], a[4:7], v[64:67], 0
    v_cvt_pk_bf16_f32 v54, v204, v205
    v_cvt_pk_bf16_f32 v55, v206, v207
    s_add_u32 s38, s36, 0
    buffer_store_dwordx4 v[0:3], v240, s[16:19], s38 offen offset:0 sc1
    v_mfma_f32_16x16x32_bf16 v[100:103], a[20:23], v[68:71], v[100:103]
    v_cvt_pk_bf16_f32 v56, v208, v209
    v_cvt_pk_bf16_f32 v57, v210, v211
    v_mfma_f32_16x16x32_bf16 v[100:103], a[36:39], v[72:75], v[100:103]
    v_cvt_pk_bf16_f32 v58, v212, v213
    v_cvt_pk_bf16_f32 v59, v214, v215
    v_mfma_f32_16x16x32_bf16 v[100:103], a[52:55], v[76:79], v[100:103]
    v_cvt_pk_bf16_f32 v60, v216, v217
    v_cvt_pk_bf16_f32 v61, v218, v219
    v_mfma_f32_16x16x32_bf16 v[104:107], a[8:11], v[64:67], 0
    v_xor_b32 v237, 16, v245
    v_xor_b32 v238, 16, v246
    v_cvt_pk_bf16_f32 v62, v220, v221
    v_cvt_pk_bf16_f32 v63, v222, v223
    v_mfma_f32_16x16x32_bf16 v[104:107], a[24:27], v[68:71], v[104:107]
    v_mfma_f32_16x16x32_bf16 v[104:107], a[40:43], v[72:75], v[104:107]
    v_mfma_f32_16x16x32_bf16 v[104:107], a[56:59], v[76:79], v[104:107]
    v_mfma_f32_16x16x32_bf16 v[108:111], a[12:15], v[64:67], 0
    v_mfma_f32_16x16x32_bf16 v[108:111], a[28:31], v[68:71], v[108:111]
    v_mfma_f32_16x16x32_bf16 v[108:111], a[44:47], v[72:75], v[108:111]
    v_mfma_f32_16x16x32_bf16 v[108:111], a[60:63], v[76:79], v[108:111]
    s_waitcnt lgkmcnt(0)
    v_mfma_f32_16x16x32_bf16 v[112:115], a[0:3], v[80:83], 0
    ds_read_b128 v[64:67], v224 offset:4096
    v_mfma_f32_16x16x32_bf16 v[112:115], a[16:19], v[84:87], v[112:115]
    ds_read_b128 v[68:71], v225 offset:4096
    v_mfma_f32_16x16x32_bf16 v[112:115], a[32:35], v[88:91], v[112:115]
    ds_read_b128 v[72:75], v224 offset:12288
    v_mfma_f32_16x16x32_bf16 v[112:115], a[48:51], v[92:95], v[112:115]
    ds_read_b128 v[76:79], v225 offset:12288
    v_mfma_f32_16x16x32_bf16 v[116:119], a[4:7], v[80:83], 0
    v_mfma_f32_16x16x32_bf16 v[116:119], a[20:23], v[84:87], v[116:119]
    v_mfma_f32_16x16x32_bf16 v[116:119], a[36:39], v[88:91], v[116:119]
    v_mfma_f32_16x16x32_bf16 v[116:119], a[52:55], v[92:95], v[116:119]
    v_mfma_f32_16x16x32_bf16 v[120:123], a[8:11], v[80:83], 0
    s_add_u32 m0, s34, 57344
    s_add_u32 s37, s87, 131072
    buffer_load_dwordx4 v232, s[44:47], s37 offen lds
    v_mfma_f32_16x16x32_bf16 v[120:123], a[24:27], v[84:87], v[120:123]
    s_add_u32 s38, s36, 0
    buffer_store_dwordx4 v[4:7], v240, s[16:19], s38 offen offset:2048 sc1
    v_mfma_f32_16x16x32_bf16 v[120:123], a[40:43], v[88:91], v[120:123]
    v_mfma_f32_16x16x32_bf16 v[120:123], a[56:59], v[92:95], v[120:123]
    v_mfma_f32_16x16x32_bf16 v[124:127], a[12:15], v[80:83], 0
    buffer_load_dwordx4 v233, s[44:47], s37 offen offset:1024 lds
    v_mfma_f32_16x16x32_bf16 v[124:127], a[28:31], v[84:87], v[124:127]
    v_mfma_f32_16x16x32_bf16 v[124:127], a[44:47], v[88:91], v[124:127]
    v_mfma_f32_16x16x32_bf16 v[124:127], a[60:63], v[92:95], v[124:127]
    s_waitcnt lgkmcnt(0)
    v_mfma_f32_16x16x32_bf16 v[128:131], a[0:3], v[64:67], 0
    ds_read_b128 v[80:83], v224 offset:6144
    v_mfma_f32_16x16x32_bf16 v[128:131], a[16:19], v[68:71], v[128:131]
    ds_read_b128 v[84:87], v225 offset:6144
    v_mfma_f32_16x16x32_bf16 v[128:131], a[32:35], v[72:75], v[128:131]
    ds_read_b128 v[88:91], v224 offset:14336
    v_mfma_f32_16x16x32_bf16 v[128:131], a[48:51], v[76:79], v[128:131]
    ds_read_b128 v[92:95], v225 offset:14336
    v_mfma_f32_16x16x32_bf16 v[132:135], a[4:7], v[64:67], 0
    v_mfma_f32_16x16x32_bf16 v[132:135], a[20:23], v[68:71], v[132:135]
    v_mfma_f32_16x16x32_bf16 v[132:135], a[36:39], v[72:75], v[132:135]
    v_mfma_f32_16x16x32_bf16 v[132:135], a[52:55], v[76:79], v[132:135]
    v_mfma_f32_16x16x32_bf16 v[136:139], a[8:11], v[64:67], 0
    s_waitcnt vmcnt(15)
    v_readfirstlane_b32 s24, v254
    s_lshl_b32 s25, s3, 16
    s_add_u32 s24, s24, s25
    s_cmp_ge_u32 s24, 1
    s_cbranch_scc0 kf_spin31
kf_spinr32:
    v_mfma_f32_16x16x32_bf16 v[136:139], a[24:27], v[68:71], v[136:139]
    v_mfma_f32_16x16x32_bf16 v[136:139], a[40:43], v[72:75], v[136:139]
    v_mfma_f32_16x16x32_bf16 v[136:139], a[56:59], v[76:79], v[136:139]
    v_mfma_f32_16x16x32_bf16 v[140:143], a[12:15], v[64:67], 0
    s_add_u32 s88, s20, 0x14a0000
    s_addc_u32 s89, s21, 0
    s_mov_b32 s90, 20480
    v_mfma_f32_16x16x32_bf16 v[140:143], a[28:31], v[68:71], v[140:143]
    v_mfma_f32_16x16x32_bf16 v[140:143], a[44:47], v[72:75], v[140:143]
    v_mfma_f32_16x16x32_bf16 v[140:143], a[60:63], v[76:79], v[140:143]
    s_add_u32 s38, s36, 0
    buffer_store_dwordx4 v[8:11], v240, s[16:19], s38 offen offset:1024 sc1
    s_waitcnt vmcnt(7) lgkmcnt(0)
    s_barrier
    v_mfma_f32_16x16x32_bf16 v[144:147], a[0:3], v[80:83], 0
    ds_read_b128 v[64:67], v224 offset:16384
    v_mfma_f32_16x16x32_bf16 v[144:147], a[16:19], v[84:87], v[144:147]
    ds_read_b128 v[68:71], v225 offset:16384
    v_mfma_f32_16x16x32_bf16 v[144:147], a[32:35], v[88:91], v[144:147]
    ds_read_b128 v[72:75], v224 offset:24576
    v_mfma_f32_16x16x32_bf16 v[144:147], a[48:51], v[92:95], v[144:147]
    ds_read_b128 v[76:79], v225 offset:24576
    v_mfma_f32_16x16x32_bf16 v[148:151], a[4:7], v[80:83], 0
    v_mfma_f32_16x16x32_bf16 v[148:151], a[20:23], v[84:87], v[148:151]
    v_mfma_f32_16x16x32_bf16 v[148:151], a[36:39], v[88:91], v[148:151]
    v_mfma_f32_16x16x32_bf16 v[148:151], a[52:55], v[92:95], v[148:151]
    v_mfma_f32_16x16x32_bf16 v[152:155], a[8:11], v[80:83], 0
    s_add_u32 m0, s34, 0
    s_add_u32 s37, s80, 196608
    buffer_load_dwordx4 v232, s[44:47], s37 offen lds
    v_mfma_f32_16x16x32_bf16 v[152:155], a[24:27], v[84:87], v[152:155]
    v_mfma_f32_16x16x32_bf16 v[152:155], a[40:43], v[88:91], v[152:155]
    buffer_load_dwordx4 v233, s[44:47], s37 offen offset:1024 lds
    v_mfma_f32_16x16x32_bf16 v[152:155], a[56:59], v[92:95], v[152:155]
    v_mfma_f32_16x16x32_bf16 v[156:159], a[12:15], v[80:83], 0
    v_mfma_f32_16x16x32_bf16 v[156:159], a[28:31], v[84:87], v[156:159]
    s_lshl_b32 s39, s5, 7
    s_add_u32 s39, s39, 8192
    buffer_atomic_add v255, v250, s[88:91], s39 offen sc1
    s_cmp_eq_u32 s3, 0
    s_cselect_b32 s39, s39, s43
    v_mfma_f32_16x16x32_bf16 v[156:159], a[44:47], v[88:91], v[156:159]
    v_mfma_f32_16x16x32_bf16 v[156:159], a[60:63], v[92:95], v[156:159]
    s_waitcnt lgkmcnt(0)
    v_mfma_f32_16x16x32_bf16 v[96:99], a[64:67], v[64:67], v[96:99]
    ds_read_b128 v[80:83], v224 offset:18432
    v_mfma_f32_16x16x32_bf16 v[96:99], a[80:83], v[68:71], v[96:99]
    ds_read_b128 v[84:87], v225 offset:18432
    v_mfma_f32_16x16x32_bf16 v[96:99], a[96:99], v[72:75], v[96:99]
    ds_read_b128 v[88:91], v224 offset:26624
    v_mfma_f32_16x16x32_bf16 v[96:99], a[112:115], v[76:79], v[96:99]
    ds_read_b128 v[92:95], v225 offset:26624
    v_mfma_f32_16x16x32_bf16 v[100:103], a[68:71], v[64:67], v[100:103]
    s_add_u32 s38, s36, 0
    buffer_store_dwordx4 v[12:15], v240, s[16:19], s38 offen offset:3072 sc1
    v_mfma_f32_16x16x32_bf16 v[100:103], a[84:87], v[68:71], v[100:103]
    v_mfma_f32_16x16x32_bf16 v[100:103], a[100:103], v[72:75], v[100:103]
    v_mfma_f32_16x16x32_bf16 v[100:103], a[116:119], v[76:79], v[100:103]
    v_mfma_f32_16x16x32_bf16 v[104:107], a[72:75], v[64:67], v[104:107]
    s_add_u32 m0, s31, 0
    s_add_u32 s24, s27, 0
    buffer_load_dwordx4 v245, s[12:15], s24 offen lds
    v_mfma_f32_16x16x32_bf16 v[104:107], a[88:91], v[68:71], v[104:107]
    v_mfma_f32_16x16x32_bf16 v[104:107], a[104:107], v[72:75], v[104:107]
    v_mfma_f32_16x16x32_bf16 v[104:107], a[120:123], v[76:79], v[104:107]
    v_mfma_f32_16x16x32_bf16 v[108:111], a[76:79], v[64:67], v[108:111]
    v_mfma_f32_16x16x32_bf16 v[108:111], a[92:95], v[68:71], v[108:111]
    v_mfma_f32_16x16x32_bf16 v[108:111], a[108:111], v[72:75], v[108:111]
    v_mfma_f32_16x16x32_bf16 v[108:111], a[124:127], v[76:79], v[108:111]
    s_waitcnt lgkmcnt(0)
    v_mfma_f32_16x16x32_bf16 v[112:115], a[64:67], v[80:83], v[112:115]
    ds_read_b128 v[64:67], v224 offset:20480
    v_mfma_f32_16x16x32_bf16 v[112:115], a[80:83], v[84:87], v[112:115]
    ds_read_b128 v[68:71], v225 offset:20480
    v_mfma_f32_16x16x32_bf16 v[112:115], a[96:99], v[88:91], v[112:115]
    ds_read_b128 v[72:75], v224 offset:28672
    v_mfma_f32_16x16x32_bf16 v[112:115], a[112:115], v[92:95], v[112:115]
    ds_read_b128 v[76:79], v225 offset:28672
    v_mfma_f32_16x16x32_bf16 v[116:119], a[68:71], v[80:83], v[116:119]
    v_mfma_f32_16x16x32_bf16 v[116:119], a[84:87], v[84:87], v[116:119]
    v_mfma_f32_16x16x32_bf16 v[116:119], a[100:103], v[88:91], v[116:119]
    v_mfma_f32_16x16x32_bf16 v[116:119], a[116:119], v[92:95], v[116:119]
    v_mfma_f32_16x16x32_bf16 v[120:123], a[72:75], v[80:83], v[120:123]
    s_add_u32 m0, s34, 8192
    s_add_u32 s37, s81, 196608
    buffer_load_dwordx4 v232, s[44:47], s37 offen lds
    v_mfma_f32_16x16x32_bf16 v[120:123], a[88:91], v[84:87], v[120:123]
    v_mfma_f32_16x16x32_bf16 v[120:123], a[104:107], v[88:91], v[120:123]
    buffer_load_dwordx4 v233, s[44:47], s37 offen offset:1024 lds
    s_add_u32 s38, s36, 8192
    buffer_store_dwordx4 v[16:19], v240, s[16:19], s38 offen offset:0 sc1
    v_mfma_f32_16x16x32_bf16 v[120:123], a[120:123], v[92:95], v[120:123]
    v_mfma_f32_16x16x32_bf16 v[124:127], a[76:79], v[80:83], v[124:127]
    v_mfma_f32_16x16x32_bf16 v[124:127], a[92:95], v[84:87], v[124:127]
    s_add_u32 m0, s31, 1024
    s_add_u32 s24, s27, 32768
    buffer_load_dwordx4 v245, s[12:15], s24 offen lds
    v_mfma_f32_16x16x32_bf16 v[124:127], a[108:111], v[88:91], v[124:127]
    v_mfma_f32_16x16x32_bf16 v[124:127], a[124:127], v[92:95], v[124:127]
    s_waitcnt lgkmcnt(0)
    v_mfma_f32_16x16x32_bf16 v[128:131], a[64:67], v[64:67], v[128:131]
    ds_read_b128 v[80:83], v224 offset:22528
    v_mfma_f32_16x16x32_bf16 v[128:131], a[80:83], v[68:71], v[128:131]
    ds_read_b128 v[84:87], v225 offset:22528
    v_mfma_f32_16x16x32_bf16 v[128:131], a[96:99], v[72:75], v[128:131]
    ds_read_b128 v[88:91], v224 offset:30720
    v_mfma_f32_16x16x32_bf16 v[128:131], a[112:115], v[76:79], v[128:131]
    ds_read_b128 v[92:95], v225 offset:30720
    v_mfma_f32_16x16x32_bf16 v[132:135], a[68:71], v[64:67], v[132:135]
    v_mfma_f32_16x16x32_bf16 v[132:135], a[84:87], v[68:71], v[132:135]
    v_mfma_f32_16x16x32_bf16 v[132:135], a[100:103], v[72:75], v[132:135]
    v_mfma_f32_16x16x32_bf16 v[132:135], a[116:119], v[76:79], v[132:135]
    v_mfma_f32_16x16x32_bf16 v[136:139], a[72:75], v[64:67], v[136:139]
    s_add_u32 m0, s31, 2048
    s_add_u32 s24, s27, 65536
    buffer_load_dwordx4 v237, s[12:15], s24 offen lds
    v_mfma_f32_16x16x32_bf16 v[136:139], a[88:91], v[68:71], v[136:139]
    v_mfma_f32_16x16x32_bf16 v[136:139], a[104:107], v[72:75], v[136:139]
    v_mfma_f32_16x16x32_bf16 v[136:139], a[120:123], v[76:79], v[136:139]
    v_mfma_f32_16x16x32_bf16 v[140:143], a[76:79], v[64:67], v[140:143]
    v_mfma_f32_16x16x32_bf16 v[140:143], a[92:95], v[68:71], v[140:143]
    v_mfma_f32_16x16x32_bf16 v[140:143], a[108:111], v[72:75], v[140:143]
    v_mfma_f32_16x16x32_bf16 v[140:143], a[124:127], v[76:79], v[140:143]
    s_add_u32 s38, s36, 8192
    buffer_store_dwordx4 v[20:23], v240, s[16:19], s38 offen offset:2048 sc1
    s_waitcnt vmcnt(19) lgkmcnt(0)
    s_barrier
    v_mfma_f32_16x16x32_bf16 v[144:147], a[64:67], v[80:83], v[144:147]
    ds_read_b128 v[64:67], v224 offset:32768
    v_mfma_f32_16x16x32_bf16 v[144:147], a[80:83], v[84:87], v[144:147]
    ds_read_b128 v[68:71], v225 offset:32768
    v_mfma_f32_16x16x32_bf16 v[144:147], a[96:99], v[88:91], v[144:147]
    ds_read_b128 v[72:75], v224 offset:40960
    v_mfma_f32_16x16x32_bf16 v[144:147], a[112:115], v[92:95], v[144:147]
    ds_read_b128 v[76:79], v225 offset:40960
    v_mfma_f32_16x16x32_bf16 v[148:151], a[68:71], v[80:83], v[148:151]
    v_mfma_f32_16x16x32_bf16 v[148:151], a[84:87], v[84:87], v[148:151]
    v_mfma_f32_16x16x32_bf16 v[148:151], a[100:103], v[88:91], v[148:151]
    v_mfma_f32_16x16x32_bf16 v[148:151], a[116:119], v[92:95], v[148:151]
    v_mfma_f32_16x16x32_bf16 v[152:155], a[72:75], v[80:83], v[152:155]
    s_add_u32 m0, s34, 16384
    s_add_u32 s37, s82, 196608
    buffer_load_dwordx4 v232, s[44:47], s37 offen lds
    v_mfma_f32_16x16x32_bf16 v[152:155], a[88:91], v[84:87], v[152:155]
    v_mfma_f32_16x16x32_bf16 v[152:155], a[104:107], v[88:91], v[152:155]
    buffer_load_dwordx4 v233, s[44:47], s37 offen offset:1024 lds
    v_mfma_f32_16x16x32_bf16 v[152:155], a[120:123], v[92:95], v[152:155]
    v_mfma_f32_16x16x32_bf16 v[156:159], a[76:79], v[80:83], v[156:159]
    v_mfma_f32_16x16x32_bf16 v[156:159], a[92:95], v[84:87], v[156:159]
    s_add_u32 m0, s31, 3072
    s_add_u32 s24, s27, 98304
    buffer_load_dwordx4 v237, s[12:15], s24 offen lds
    v_mfma_f32_16x16x32_bf16 v[156:159], a[108:111], v[88:91], v[156:159]
    v_mfma_f32_16x16x32_bf16 v[156:159], a[124:127], v[92:95], v[156:159]
    s_waitcnt lgkmcnt(0)
    v_mfma_f32_16x16x32_bf16 v[96:99], a[128:131], v[64:67], v[96:99]
    ds_read_b128 v[80:83], v224 offset:34816
    v_mfma_f32_16x16x32_bf16 v[96:99], a[144:147], v[68:71], v[96:99]
    ds_read_b128 v[84:87], v225 offset:34816
    v_mfma_f32_16x16x32_bf16 v[96:99], a[160:163], v[72:75], v[96:99]
    ds_read_b128 v[88:91], v224 offset:43008
    v_mfma_f32_16x16x32_bf16 v[96:99], a[176:179], v[76:79], v[96:99]
    ds_read_b128 v[92:95], v225 offset:43008
    v_mfma_f32_16x16x32_bf16 v[100:103], a[132:135], v[64:67], v[100:103]
    v_mfma_f32_16x16x32_bf16 v[100:103], a[148:151], v[68:71], v[100:103]
    s_add_u32 s38, s36, 8192
    buffer_store_dwordx4 v[24:27], v240, s[16:19], s38 offen offset:1024 sc1
    v_mfma_f32_16x16x32_bf16 v[100:103], a[164:167], v[72:75], v[100:103]
    v_mfma_f32_16x16x32_bf16 v[100:103], a[180:183], v[76:79], v[100:103]
    v_mfma_f32_16x16x32_bf16 v[104:107], a[136:139], v[64:67], v[104:107]
    s_add_u32 m0, s31, 4096
    s_add_u32 s24, s27, 131072
    buffer_load_dwordx4 v245, s[12:15], s24 offen lds
    v_mfma_f32_16x16x32_bf16 v[104:107], a[152:155], v[68:71], v[104:107]
    v_mfma_f32_16x16x32_bf16 v[104:107], a[168:171], v[72:75], v[104:107]
    v_mfma_f32_16x16x32_bf16 v[104:107], a[184:187], v[76:79], v[104:107]
    v_mfma_f32_16x16x32_bf16 v[108:111], a[140:143], v[64:67], v[108:111]
    v_mfma_f32_16x16x32_bf16 v[108:111], a[156:159], v[68:71], v[108:111]
    v_mfma_f32_16x16x32_bf16 v[108:111], a[172:175], v[72:75], v[108:111]
    v_mfma_f32_16x16x32_bf16 v[108:111], a[188:191], v[76:79], v[108:111]
    s_waitcnt lgkmcnt(0)
    v_mfma_f32_16x16x32_bf16 v[112:115], a[128:131], v[80:83], v[112:115]
    ds_read_b128 v[64:67], v224 offset:36864
    v_mfma_f32_16x16x32_bf16 v[112:115], a[144:147], v[84:87], v[112:115]
    ds_read_b128 v[68:71], v225 offset:36864
    v_mfma_f32_16x16x32_bf16 v[112:115], a[160:163], v[88:91], v[112:115]
    ds_read_b128 v[72:75], v224 offset:45056
    v_mfma_f32_16x16x32_bf16 v[112:115], a[176:179], v[92:95], v[112:115]
    ds_read_b128 v[76:79], v225 offset:45056
    v_mfma_f32_16x16x32_bf16 v[116:119], a[132:135], v[80:83], v[116:119]
    v_mfma_f32_16x16x32_bf16 v[116:119], a[148:151], v[84:87], v[116:119]
    v_mfma_f32_16x16x32_bf16 v[116:119], a[164:167], v[88:91], v[116:119]
    v_mfma_f32_16x16x32_bf16 v[116:119], a[180:183], v[92:95], v[116:119]
    v_mfma_f32_16x16x32_bf16 v[120:123], a[136:139], v[80:83], v[120:123]
    s_add_u32 m0, s34, 24576
    s_add_u32 s37, s83, 196608
    buffer_load_dwordx4 v232, s[44:47], s37 offen lds
    v_mfma_f32_16x16x32_bf16 v[120:123], a[152:155], v[84:87], v[120:123]
    v_mfma_f32_16x16x32_bf16 v[120:123], a[168:171], v[88:91], v[120:123]
    buffer_load_dwordx4 v233, s[44:47], s37 offen offset:1024 lds
    s_add_u32 s38, s36, 8192
    buffer_store_dwordx4 v[28:31], v240, s[16:19], s38 offen offset:3072 sc1
    v_mfma_f32_16x16x32_bf16 v[120:123], a[184:187], v[92:95], v[120:123]
    v_mfma_f32_16x16x32_bf16 v[124:127], a[140:143], v[80:83], v[124:127]
    v_mfma_f32_16x16x32_bf16 v[124:127], a[156:159], v[84:87], v[124:127]
    s_add_u32 m0, s31, 5120
    s_add_u32 s24, s27, 163840
    buffer_load_dwordx4 v245, s[12:15], s24 offen lds
    v_mfma_f32_16x16x32_bf16 v[124:127], a[172:175], v[88:91], v[124:127]
    v_mfma_f32_16x16x32_bf16 v[124:127], a[188:191], v[92:95], v[124:127]
    s_waitcnt lgkmcnt(0)
    v_mfma_f32_16x16x32_bf16 v[128:131], a[128:131], v[64:67], v[128:131]
    ds_read_b128 v[80:83], v224 offset:38912
    v_mfma_f32_16x16x32_bf16 v[128:131], a[144:147], v[68:71], v[128:131]
    ds_read_b128 v[84:87], v225 offset:38912
    v_mfma_f32_16x16x32_bf16 v[128:131], a[160:163], v[72:75], v[128:131]
    ds_read_b128 v[88:91], v224 offset:47104
    v_mfma_f32_16x16x32_bf16 v[128:131], a[176:179], v[76:79], v[128:131]
    ds_read_b128 v[92:95], v225 offset:47104
    v_mfma_f32_16x16x32_bf16 v[132:135], a[132:135], v[64:67], v[132:135]
    v_mfma_f32_16x16x32_bf16 v[132:135], a[148:151], v[68:71], v[132:135]
    v_mfma_f32_16x16x32_bf16 v[132:135], a[164:167], v[72:75], v[132:135]
    v_mfma_f32_16x16x32_bf16 v[132:135], a[180:183], v[76:79], v[132:135]
    v_mfma_f32_16x16x32_bf16 v[136:139], a[136:139], v[64:67], v[136:139]
    s_add_u32 m0, s31, 6144
    s_add_u32 s24, s27, 196608
    buffer_load_dwordx4 v237, s[12:15], s24 offen lds
    v_mfma_f32_16x16x32_bf16 v[136:139], a[152:155], v[68:71], v[136:139]
    v_mfma_f32_16x16x32_bf16 v[136:139], a[168:171], v[72:75], v[136:139]
    v_mfma_f32_16x16x32_bf16 v[136:139], a[184:187], v[76:79], v[136:139]
    v_mfma_f32_16x16x32_bf16 v[140:143], a[140:143], v[64:67], v[140:143]
    v_mfma_f32_16x16x32_bf16 v[140:143], a[156:159], v[68:71], v[140:143]
    v_mfma_f32_16x16x32_bf16 v[140:143], a[172:175], v[72:75], v[140:143]
    v_mfma_f32_16x16x32_bf16 v[140:143], a[188:191], v[76:79], v[140:143]
    s_waitcnt vmcnt(22) lgkmcnt(0)
    s_barrier
    v_mfma_f32_16x16x32_bf16 v[144:147], a[128:131], v[80:83], v[144:147]
    ds_read_b128 v[64:67], v224 offset:49152
    s_add_u32 s38, s36, 32768
    buffer_store_dwordx4 v[32:35], v240, s[16:19], s38 offen offset:1280 sc1
    v_mfma_f32_16x16x32_bf16 v[144:147], a[144:147], v[84:87], v[144:147]
    ds_read_b128 v[68:71], v225 offset:49152
    v_mfma_f32_16x16x32_bf16 v[144:147], a[160:163], v[88:91], v[144:147]
    ds_read_b128 v[72:75], v224 offset:57344
    v_mfma_f32_16x16x32_bf16 v[144:147], a[176:179], v[92:95], v[144:147]
    ds_read_b128 v[76:79], v225 offset:57344
    v_mfma_f32_16x16x32_bf16 v[148:151], a[132:135], v[80:83], v[148:151]
    v_mfma_f32_16x16x32_bf16 v[148:151], a[148:151], v[84:87], v[148:151]
    v_mfma_f32_16x16x32_bf16 v[148:151], a[164:167], v[88:91], v[148:151]
    v_mfma_f32_16x16x32_bf16 v[148:151], a[180:183], v[92:95], v[148:151]
    v_mfma_f32_16x16x32_bf16 v[152:155], a[136:139], v[80:83], v[152:155]
    s_add_u32 m0, s34, 32768
    s_add_u32 s37, s84, 196608
    buffer_load_dwordx4 v232, s[44:47], s37 offen lds
    v_mfma_f32_16x16x32_bf16 v[152:155], a[152:155], v[84:87], v[152:155]
    buffer_load_dwordx4 v233, s[44:47], s37 offen offset:1024 lds
    v_mfma_f32_16x16x32_bf16 v[152:155], a[168:171], v[88:91], v[152:155]
    v_mfma_f32_16x16x32_bf16 v[152:155], a[184:187], v[92:95], v[152:155]
    s_add_u32 m0, s31, 7168
    s_add_u32 s24, s27, 229376
    buffer_load_dwordx4 v237, s[12:15], s24 offen lds
    v_mfma_f32_16x16x32_bf16 v[156:159], a[140:143], v[80:83], v[156:159]
    s_add_u32 s27, s27, 1048576
    s_and_b32 s27, s27, 0x407fffff
    s_cmp_eq_u32 s27, s7
    s_cselect_b32 s27, s43, s27
    v_mfma_f32_16x16x32_bf16 v[156:159], a[156:159], v[84:87], v[156:159]
    v_mfma_f32_16x16x32_bf16 v[156:159], a[172:175], v[88:91], v[156:159]
    s_add_u32 s31, s31, 32768
    s_cmp_ge_u32 s31, 163840
    s_cselect_b32 s24, 98304, 0
    s_sub_u32 s31, s31, s24
    v_mfma_f32_16x16x32_bf16 v[156:159], a[188:191], v[92:95], v[156:159]
    s_waitcnt lgkmcnt(0)
    v_mfma_f32_16x16x32_bf16 v[96:99], a[192:195], v[64:67], v[96:99]
    ds_read_b128 v[80:83], v224 offset:51200
    v_mfma_f32_16x16x32_bf16 v[96:99], a[208:211], v[68:71], v[96:99]
    ds_read_b128 v[84:87], v225 offset:51200
    v_mfma_f32_16x16x32_bf16 v[96:99], a[224:227], v[72:75], v[96:99]
    ds_read_b128 v[88:91], v224 offset:59392
    v_mfma_f32_16x16x32_bf16 v[96:99], a[240:243], v[76:79], v[96:99]
    ds_read_b128 v[92:95], v225 offset:59392
    v_mfma_f32_16x16x32_bf16 v[100:103], a[196:199], v[64:67], v[100:103]
    v_mfma_f32_16x16x32_bf16 v[100:103], a[212:215], v[68:71], v[100:103]
    v_mfma_f32_16x16x32_bf16 v[100:103], a[228:231], v[72:75], v[100:103]
    s_add_u32 s38, s36, 32768
    buffer_store_dwordx4 v[36:39], v240, s[16:19], s38 offen offset:3328 sc1
    v_mfma_f32_16x16x32_bf16 v[100:103], a[244:247], v[76:79], v[100:103]
    v_mfma_f32_16x16x32_bf16 v[104:107], a[200:203], v[64:67], v[104:107]
    v_mfma_f32_16x16x32_bf16 v[104:107], a[216:219], v[68:71], v[104:107]
    v_mfma_f32_16x16x32_bf16 v[104:107], a[232:235], v[72:75], v[104:107]
    v_mfma_f32_16x16x32_bf16 v[104:107], a[248:251], v[76:79], v[104:107]
    v_mfma_f32_16x16x32_bf16 v[108:111], a[204:207], v[64:67], v[108:111]
    v_mfma_f32_16x16x32_bf16 v[108:111], a[220:223], v[68:71], v[108:111]
    v_mfma_f32_16x16x32_bf16 v[108:111], a[236:239], v[72:75], v[108:111]
    v_mfma_f32_16x16x32_bf16 v[108:111], a[252:255], v[76:79], v[108:111]
    s_waitcnt lgkmcnt(0)
    v_mfma_f32_16x16x32_bf16 v[112:115], a[192:195], v[80:83], v[112:115]
    ds_read_b128 v[64:67], v224 offset:53248
    v_mfma_f32_16x16x32_bf16 v[112:115], a[208:211], v[84:87], v[112:115]
    ds_read_b128 v[68:71], v225 offset:53248
    v_mfma_f32_16x16x32_bf16 v[112:115], a[224:227], v[88:91], v[112:115]
    ds_read_b128 v[72:75], v224 offset:61440
    v_mfma_f32_16x16x32_bf16 v[112:115], a[240:243], v[92:95], v[112:115]
    ds_read_b128 v[76:79], v225 offset:61440
    v_mfma_f32_16x16x32_bf16 v[116:119], a[196:199], v[80:83], v[116:119]
    v_mfma_f32_16x16x32_bf16 v[116:119], a[212:215], v[84:87], v[116:119]
    v_mfma_f32_16x16x32_bf16 v[116:119], a[228:231], v[88:91], v[116:119]
    v_mfma_f32_16x16x32_bf16 v[116:119], a[244:247], v[92:95], v[116:119]
    v_mfma_f32_16x16x32_bf16 v[120:123], a[200:203], v[80:83], v[120:123]
    s_add_u32 m0, s34, 40960
    s_add_u32 s37, s85, 196608
    buffer_load_dwordx4 v232, s[44:47], s37 offen lds
    v_mfma_f32_16x16x32_bf16 v[120:123], a[216:219], v[84:87], v[120:123]
    v_mfma_f32_16x16x32_bf16 v[120:123], a[232:235], v[88:91], v[120:123]
    v_mfma_f32_16x16x32_bf16 v[120:123], a[248:251], v[92:95], v[120:123]
    s_add_u32 s38, s36, 32768
    buffer_store_dwordx4 v[40:43], v240, s[16:19], s38 offen offset:2304 sc1
    v_mfma_f32_16x16x32_bf16 v[124:127], a[204:207], v[80:83], v[124:127]
    buffer_load_dwordx4 v233, s[44:47], s37 offen offset:1024 lds
    v_mfma_f32_16x16x32_bf16 v[124:127], a[220:223], v[84:87], v[124:127]
    v_mfma_f32_16x16x32_bf16 v[124:127], a[236:239], v[88:91], v[124:127]
    v_mfma_f32_16x16x32_bf16 v[124:127], a[252:255], v[92:95], v[124:127]
    s_waitcnt lgkmcnt(0)
    v_mfma_f32_16x16x32_bf16 v[128:131], a[192:195], v[64:67], v[128:131]
    ds_read_b128 v[80:83], v224 offset:55296
    v_mfma_f32_16x16x32_bf16 v[128:131], a[208:211], v[68:71], v[128:131]
    ds_read_b128 v[84:87], v225 offset:55296
    v_mfma_f32_16x16x32_bf16 v[128:131], a[224:227], v[72:75], v[128:131]
    ds_read_b128 v[88:91], v224 offset:63488
    v_mfma_f32_16x16x32_bf16 v[128:131], a[240:243], v[76:79], v[128:131]
    ds_read_b128 v[92:95], v225 offset:63488
    v_mfma_f32_16x16x32_bf16 v[132:135], a[196:199], v[64:67], v[132:135]
    v_mfma_f32_16x16x32_bf16 v[132:135], a[212:215], v[68:71], v[132:135]
    v_mfma_f32_16x16x32_bf16 v[132:135], a[228:231], v[72:75], v[132:135]
    v_mfma_f32_16x16x32_bf16 v[132:135], a[244:247], v[76:79], v[132:135]
    v_mfma_f32_16x16x32_bf16 v[136:139], a[200:203], v[64:67], v[136:139]
    s_add_u32 m0, s31, 0
    s_add_u32 s24, s27, 0
    buffer_load_dwordx4 v245, s[12:15], s24 offen lds
    v_mfma_f32_16x16x32_bf16 v[136:139], a[216:219], v[68:71], v[136:139]
    v_mfma_f32_16x16x32_bf16 v[136:139], a[232:235], v[72:75], v[136:139]
    v_mfma_f32_16x16x32_bf16 v[136:139], a[248:251], v[76:79], v[136:139]
    v_mfma_f32_16x16x32_bf16 v[140:143], a[204:207], v[64:67], v[140:143]
    v_mfma_f32_16x16x32_bf16 v[140:143], a[220:223], v[68:71], v[140:143]
    v_mfma_f32_16x16x32_bf16 v[140:143], a[236:239], v[72:75], v[140:143]
    v_mfma_f32_16x16x32_bf16 v[140:143], a[252:255], v[76:79], v[140:143]
    s_waitcnt vmcnt(23) lgkmcnt(0)
    s_barrier
    v_mfma_f32_16x16x32_bf16 v[144:147], a[192:195], v[80:83], v[144:147]
    ds_read_b128 v[64:67], v224 offset:0
    v_mfma_f32_16x16x32_bf16 v[144:147], a[208:211], v[84:87], v[144:147]
    ds_read_b128 v[68:71], v225 offset:0
    s_add_u32 s38, s36, 36864
    buffer_store_dwordx4 v[44:47], v240, s[16:19], s38 offen offset:256 sc1
    v_mfma_f32_16x16x32_bf16 v[144:147], a[224:227], v[88:91], v[144:147]
    ds_read_b128 v[72:75], v224 offset:8192
    v_mfma_f32_16x16x32_bf16 v[144:147], a[240:243], v[92:95], v[144:147]
    ds_read_b128 v[76:79], v225 offset:8192
    v_mfma_f32_16x16x32_bf16 v[148:151], a[196:199], v[80:83], v[148:151]
    v_mfma_f32_16x16x32_bf16 v[148:151], a[212:215], v[84:87], v[148:151]
    v_mfma_f32_16x16x32_bf16 v[148:151], a[228:231], v[88:91], v[148:151]
    v_mfma_f32_16x16x32_bf16 v[148:151], a[244:247], v[92:95], v[148:151]
    v_mfma_f32_16x16x32_bf16 v[152:155], a[200:203], v[80:83], v[152:155]
    s_add_u32 m0, s34, 49152
    s_add_u32 s37, s86, 196608
    buffer_load_dwordx4 v232, s[44:47], s37 offen lds
    v_mfma_f32_16x16x32_bf16 v[152:155], a[216:219], v[84:87], v[152:155]
    v_mfma_f32_16x16x32_bf16 v[152:155], a[232:235], v[88:91], v[152:155]
    buffer_load_dwordx4 v233, s[44:47], s37 offen offset:1024 lds
    v_mfma_f32_16x16x32_bf16 v[152:155], a[248:251], v[92:95], v[152:155]
    v_mfma_f32_16x16x32_bf16 v[156:159], a[204:207], v[80:83], v[156:159]
    v_mfma_f32_16x16x32_bf16 v[156:159], a[220:223], v[84:87], v[156:159]
    s_add_u32 m0, s31, 1024
    s_add_u32 s24, s27, 32768
    buffer_load_dwordx4 v245, s[12:15], s24 offen lds
    v_mfma_f32_16x16x32_bf16 v[156:159], a[236:239], v[88:91], v[156:159]
    v_mfma_f32_16x16x32_bf16 v[156:159], a[252:255], v[92:95], v[156:159]
    s_waitcnt lgkmcnt(0)
    v_mfma_f32_16x16x32_bf16 v[160:163], a[0:3], v[64:67], 0
    ds_read_b128 v[80:83], v224 offset:2048
    v_mfma_f32_16x16x32_bf16 v[160:163], a[16:19], v[68:71], v[160:163]
    ds_read_b128 v[84:87], v225 offset:2048
    v_mfma_f32_16x16x32_bf16 v[160:163], a[32:35], v[72:75], v[160:163]
    ds_read_b128 v[88:91], v224 offset:10240
    v_mfma_f32_16x16x32_bf16 v[160:163], a[48:51], v[76:79], v[160:163]
    ds_read_b128 v[92:95], v225 offset:10240
    v_mfma_f32_16x16x32_bf16 v[164:167], a[4:7], v[64:67], 0
    v_cvt_pk_bf16_f32 v0, v96, v97
    v_cvt_pk_bf16_f32 v1, v98, v99
    v_mfma_f32_16x16x32_bf16 v[164:167], a[20:23], v[68:71], v[164:167]
    v_mfma_f32_16x16x32_bf16 v[164:167], a[36:39], v[72:75], v[164:167]
    v_cvt_pk_bf16_f32 v2, v100, v101
    v_cvt_pk_bf16_f32 v3, v102, v103
    s_add_u32 s38, s36, 40960
    buffer_store_dwordx4 v[48:51], v240, s[16:19], s38 offen offset:1280 sc1
    v_mfma_f32_16x16x32_bf16 v[164:167], a[52:55], v[76:79], v[164:167]
    v_mfma_f32_16x16x32_bf16 v[168:171], a[8:11], v[64:67], 0
    s_add_u32 m0, s31, 2048
    s_add_u32 s24, s27, 65536
    buffer_load_dwordx4 v237, s[12:15], s24 offen lds
    v_cvt_pk_bf16_f32 v4, v104, v105
    v_cvt_pk_bf16_f32 v5, v106, v107
    v_mfma_f32_16x16x32_bf16 v[168:171], a[24:27], v[68:71], v[168:171]
    v_mfma_f32_16x16x32_bf16 v[168:171], a[40:43], v[72:75], v[168:171]
    v_cvt_pk_bf16_f32 v6, v108, v109
    v_cvt_pk_bf16_f32 v7, v110, v111
    v_mfma_f32_16x16x32_bf16 v[168:171], a[56:59], v[76:79], v[168:171]
    v_mfma_f32_16x16x32_bf16 v[172:175], a[12:15], v[64:67], 0
    v_cvt_pk_bf16_f32 v8, v112, v113
    v_cvt_pk_bf16_f32 v9, v114, v115
    v_mfma_f32_16x16x32_bf16 v[172:175], a[28:31], v[68:71], v[172:175]
    v_mfma_f32_16x16x32_bf16 v[172:175], a[44:47], v[72:75], v[172:175]
    v_cvt_pk_bf16_f32 v10, v116, v117
    v_cvt_pk_bf16_f32 v11, v118, v119
    v_mfma_f32_16x16x32_bf16 v[172:175], a[60:63], v[76:79], v[172:175]
    s_waitcnt lgkmcnt(0)
    v_mfma_f32_16x16x32_bf16 v[176:179], a[0:3], v[80:83], 0
    ds_read_b128 v[64:67], v224 offset:4096
    v_cvt_pk_bf16_f32 v12, v120, v121
    v_cvt_pk_bf16_f32 v13, v122, v123
    v_mfma_f32_16x16x32_bf16 v[176:179], a[16:19], v[84:87], v[176:179]
    ds_read_b128 v[68:71], v225 offset:4096
    v_mfma_f32_16x16x32_bf16 v[176:179], a[32:35], v[88:91], v[176:179]
    ds_read_b128 v[72:75], v224 offset:12288
    v_cvt_pk_bf16_f32 v14, v124, v125
    v_cvt_pk_bf16_f32 v15, v126, v127
    v_mfma_f32_16x16x32_bf16 v[176:179], a[48:51], v[92:95], v[176:179]
    ds_read_b128 v[76:79], v225 offset:12288
    v_mfma_f32_16x16x32_bf16 v[180:183], a[4:7], v[80:83], 0
    v_cvt_pk_bf16_f32 v16, v128, v129
    v_cvt_pk_bf16_f32 v17, v130, v131
    v_mfma_f32_16x16x32_bf16 v[180:183], a[20:23], v[84:87], v[180:183]
    v_mfma_f32_16x16x32_bf16 v[180:183], a[36:39], v[88:91], v[180:183]
    v_cvt_pk_bf16_f32 v18, v132, v133
    v_cvt_pk_bf16_f32 v19, v134, v135
    v_mfma_f32_16x16x32_bf16 v[180:183], a[52:55], v[92:95], v[180:183]
    v_mfma_f32_16x16x32_bf16 v[184:187], a[8:11], v[80:83], 0
    s_add_u32 m0, s34, 57344
    s_add_u32 s37, s87, 196608
    buffer_load_dwordx4 v232, s[44:47], s37 offen lds
    v_cvt_pk_bf16_f32 v20, v136, v137
    v_cvt_pk_bf16_f32 v21, v138, v139
    v_mfma_f32_16x16x32_bf16 v[184:187], a[24:27], v[84:87], v[184:187]
    v_mfma_f32_16x16x32_bf16 v[184:187], a[40:43], v[88:91], v[184:187]
    buffer_load_dwordx4 v233, s[44:47], s37 offen offset:1024 lds
    v_cvt_pk_bf16_f32 v22, v140, v141
    v_cvt_pk_bf16_f32 v23, v142, v143
    v_mfma_f32_16x16x32_bf16 v[184:187], a[56:59], v[92:95], v[184:187]
    v_mfma_f32_16x16x32_bf16 v[188:191], a[12:15], v[80:83], 0
    v_cvt_pk_bf16_f32 v24, v144, v145
    v_cvt_pk_bf16_f32 v25, v146, v147
    s_add_u32 s38, s36, 40960
    buffer_store_dwordx4 v[52:55], v240, s[16:19], s38 offen offset:3328 sc1
    v_mfma_f32_16x16x32_bf16 v[188:191], a[28:31], v[84:87], v[188:191]
    s_add_u32 m0, s31, 3072
    s_add_u32 s24, s27, 98304
    buffer_load_dwordx4 v237, s[12:15], s24 offen lds
    v_mfma_f32_16x16x32_bf16 v[188:191], a[44:47], v[88:91], v[188:191]
    v_cvt_pk_bf16_f32 v26, v148, v149
    v_cvt_pk_bf16_f32 v27, v150, v151
    v_mfma_f32_16x16x32_bf16 v[188:191], a[60:63], v[92:95], v[188:191]
    s_waitcnt lgkmcnt(0)
    v_mfma_f32_16x16x32_bf16 v[192:195], a[0:3], v[64:67], 0
    ds_read_b128 v[80:83], v224 offset:6144
    v_cvt_pk_bf16_f32 v28, v152, v153
    v_cvt_pk_bf16_f32 v29, v154, v155
    v_mfma_f32_16x16x32_bf16 v[192:195], a[16:19], v[68:71], v[192:195]
    ds_read_b128 v[84:87], v225 offset:6144
    v_mfma_f32_16x16x32_bf16 v[192:195], a[32:35], v[72:75], v[192:195]
    ds_read_b128 v[88:91], v224 offset:14336
    v_cvt_pk_bf16_f32 v30, v156, v157
    v_cvt_pk_bf16_f32 v31, v158, v159
    v_mfma_f32_16x16x32_bf16 v[192:195], a[48:51], v[76:79], v[192:195]
    ds_read_b128 v[92:95], v225 offset:14336
    v_mfma_f32_16x16x32_bf16 v[196:199], a[4:7], v[64:67], 0
    v_mfma_f32_16x16x32_bf16 v[196:199], a[20:23], v[68:71], v[196:199]
    v_mfma_f32_16x16x32_bf16 v[196:199], a[36:39], v[72:75], v[196:199]
    v_mfma_f32_16x16x32_bf16 v[196:199], a[52:55], v[76:79], v[196:199]
    v_mfma_f32_16x16x32_bf16 v[200:203], a[8:11], v[64:67], 0
    s_add_u32 m0, s31, 4096
    s_add_u32 s24, s27, 131072
    buffer_load_dwordx4 v245, s[12:15], s24 offen lds
    v_mfma_f32_16x16x32_bf16 v[200:203], a[24:27], v[68:71], v[200:203]
    v_mfma_f32_16x16x32_bf16 v[200:203], a[40:43], v[72:75], v[200:203]
    v_mfma_f32_16x16x32_bf16 v[200:203], a[56:59], v[76:79], v[200:203]
    v_mfma_f32_16x16x32_bf16 v[204:207], a[12:15], v[64:67], 0
    v_mfma_f32_16x16x32_bf16 v[204:207], a[28:31], v[68:71], v[204:207]
    v_mfma_f32_16x16x32_bf16 v[204:207], a[44:47], v[72:75], v[204:207]
    v_mfma_f32_16x16x32_bf16 v[204:207], a[60:63], v[76:79], v[204:207]
    s_waitcnt vmcnt(23) lgkmcnt(0)
    s_barrier
    v_mfma_f32_16x16x32_bf16 v[208:211], a[0:3], v[80:83], 0
    ds_read_b128 v[64:67], v224 offset:16384
    v_mfma_f32_16x16x32_bf16 v[208:211], a[16:19], v[84:87], v[208:211]
    ds_read_b128 v[68:71], v225 offset:16384
    s_add_u32 s38, s36, 40960
    buffer_store_dwordx4 v[56:59], v240, s[16:19], s38 offen offset:2304 sc1
    v_mfma_f32_16x16x32_bf16 v[208:211], a[32:35], v[88:91], v[208:211]
    ds_read_b128 v[72:75], v224 offset:24576
    v_mfma_f32_16x16x32_bf16 v[208:211], a[48:51], v[92:95], v[208:211]
    ds_read_b128 v[76:79], v225 offset:24576
    v_mfma_f32_16x16x32_bf16 v[212:215], a[4:7], v[80:83], 0
    v_mfma_f32_16x16x32_bf16 v[212:215], a[20:23], v[84:87], v[212:215]
    v_mfma_f32_16x16x32_bf16 v[212:215], a[36:39], v[88:91], v[212:215]
    v_mfma_f32_16x16x32_bf16 v[212:215], a[52:55], v[92:95], v[212:215]
    v_mfma_f32_16x16x32_bf16 v[216:219], a[8:11], v[80:83], 0
    s_add_u32 m0, s31, 5120
    s_add_u32 s24, s27, 163840
    buffer_load_dwordx4 v245, s[12:15], s24 offen lds
    v_mfma_f32_16x16x32_bf16 v[216:219], a[24:27], v[84:87], v[216:219]
    v_mfma_f32_16x16x32_bf16 v[216:219], a[40:43], v[88:91], v[216:219]
    v_mfma_f32_16x16x32_bf16 v[216:219], a[56:59], v[92:95], v[216:219]
    v_mfma_f32_16x16x32_bf16 v[220:223], a[12:15], v[80:83], 0
    v_mfma_f32_16x16x32_bf16 v[220:223], a[28:31], v[84:87], v[220:223]
    v_mfma_f32_16x16x32_bf16 v[220:223], a[44:47], v[88:91], v[220:223]
    v_mfma_f32_16x16x32_bf16 v[220:223], a[60:63], v[92:95], v[220:223]
    s_waitcnt lgkmcnt(0)
    v_mfma_f32_16x16x32_bf16 v[160:163], a[64:67], v[64:67], v[160:163]
    ds_read_b128 v[80:83], v224 offset:18432
    v_mfma_f32_16x16x32_bf16 v[160:163], a[80:83], v[68:71], v[160:163]
    ds_read_b128 v[84:87], v225 offset:18432
    v_mfma_f32_16x16x32_bf16 v[160:163], a[96:99], v[72:75], v[160:163]
    ds_read_b128 v[88:91], v224 offset:26624
    v_mfma_f32_16x16x32_bf16 v[160:163], a[112:115], v[76:79], v[160:163]
    ds_read_b128 v[92:95], v225 offset:26624
    v_mfma_f32_16x16x32_bf16 v[164:167], a[68:71], v[64:67], v[164:167]
    v_mfma_f32_16x16x32_bf16 v[164:167], a[84:87], v[68:71], v[164:167]
    v_mfma_f32_16x16x32_bf16 v[164:167], a[100:103], v[72:75], v[164:167]
    v_mfma_f32_16x16x32_bf16 v[164:167], a[116:119], v[76:79], v[164:167]
    s_add_u32 s38, s36, 45056
    buffer_store_dwordx4 v[60:63], v240, s[16:19], s38 offen offset:256 sc1
    v_mfma_f32_16x16x32_bf16 v[168:171], a[72:75], v[64:67], v[168:171]
    s_add_u32 m0, s31, 6144
    s_add_u32 s24, s27, 196608
    buffer_load_dwordx4 v237, s[12:15], s24 offen lds
    v_mfma_f32_16x16x32_bf16 v[168:171], a[88:91], v[68:71], v[168:171]
    v_mfma_f32_16x16x32_bf16 v[168:171], a[104:107], v[72:75], v[168:171]
    v_mfma_f32_16x16x32_bf16 v[168:171], a[120:123], v[76:79], v[168:171]
    v_mfma_f32_16x16x32_bf16 v[172:175], a[76:79], v[64:67], v[172:175]
    v_mfma_f32_16x16x32_bf16 v[172:175], a[92:95], v[68:71], v[172:175]
    v_mfma_f32_16x16x32_bf16 v[172:175], a[108:111], v[72:75], v[172:175]
    v_mfma_f32_16x16x32_bf16 v[172:175], a[124:127], v[76:79], v[172:175]
    s_waitcnt lgkmcnt(0)
    v_mfma_f32_16x16x32_bf16 v[176:179], a[64:67], v[80:83], v[176:179]
    ds_read_b128 v[64:67], v224 offset:20480
    v_mfma_f32_16x16x32_bf16 v[176:179], a[80:83], v[84:87], v[176:179]
    ds_read_b128 v[68:71], v225 offset:20480
    v_mfma_f32_16x16x32_bf16 v[176:179], a[96:99], v[88:91], v[176:179]
    ds_read_b128 v[72:75], v224 offset:28672
    v_mfma_f32_16x16x32_bf16 v[176:179], a[112:115], v[92:95], v[176:179]
    ds_read_b128 v[76:79], v225 offset:28672
    v_mfma_f32_16x16x32_bf16 v[180:183], a[68:71], v[80:83], v[180:183]
    v_mfma_f32_16x16x32_bf16 v[180:183], a[84:87], v[84:87], v[180:183]
    v_mfma_f32_16x16x32_bf16 v[180:183], a[100:103], v[88:91], v[180:183]
    v_mfma_f32_16x16x32_bf16 v[180:183], a[116:119], v[92:95], v[180:183]
    v_mfma_f32_16x16x32_bf16 v[184:187], a[72:75], v[80:83], v[184:187]
    s_add_u32 m0, s31, 7168
    s_add_u32 s24, s27, 229376
    buffer_load_dwordx4 v237, s[12:15], s24 offen lds
    v_mfma_f32_16x16x32_bf16 v[184:187], a[88:91], v[84:87], v[184:187]
    v_mfma_f32_16x16x32_bf16 v[184:187], a[104:107], v[88:91], v[184:187]
    s_add_u32 s27, s27, 1048576
    s_and_b32 s27, s27, 0x407fffff
    s_cmp_eq_u32 s27, s7
    s_cselect_b32 s27, s43, s27
    v_mfma_f32_16x16x32_bf16 v[184:187], a[120:123], v[92:95], v[184:187]
    v_mfma_f32_16x16x32_bf16 v[188:191], a[76:79], v[80:83], v[188:191]
    v_mfma_f32_16x16x32_bf16 v[188:191], a[92:95], v[84:87], v[188:191]
    s_add_u32 s31, s31, 32768
    s_cmp_ge_u32 s31, 163840
    s_cselect_b32 s24, 98304, 0
    s_sub_u32 s31, s31, s24
    s_add_u32 s38, s36, 65536
    buffer_store_dwordx4 v[0:3], v240, s[16:19], s38 offen offset:2560 sc1
    v_mfma_f32_16x16x32_bf16 v[188:191], a[108:111], v[88:91], v[188:191]
    v_mfma_f32_16x16x32_bf16 v[188:191], a[124:127], v[92:95], v[188:191]
    s_waitcnt lgkmcnt(0)
    v_mfma_f32_16x16x32_bf16 v[192:195], a[64:67], v[64:67], v[192:195]
    ds_read_b128 v[80:83], v224 offset:22528
    v_mfma_f32_16x16x32_bf16 v[192:195], a[80:83], v[68:71], v[192:195]
    ds_read_b128 v[84:87], v225 offset:22528
    v_mfma_f32_16x16x32_bf16 v[192:195], a[96:99], v[72:75], v[192:195]
    ds_read_b128 v[88:91], v224 offset:30720
    v_mfma_f32_16x16x32_bf16 v[192:195], a[112:115], v[76:79], v[192:195]
    ds_read_b128 v[92:95], v225 offset:30720
    v_mfma_f32_16x16x32_bf16 v[196:199], a[68:71], v[64:67], v[196:199]
    v_mfma_f32_16x16x32_bf16 v[196:199], a[84:87], v[68:71], v[196:199]
    v_mfma_f32_16x16x32_bf16 v[196:199], a[100:103], v[72:75], v[196:199]
    v_mfma_f32_16x16x32_bf16 v[196:199], a[116:119], v[76:79], v[196:199]
    v_mfma_f32_16x16x32_bf16 v[200:203], a[72:75], v[64:67], v[200:203]
    v_mfma_f32_16x16x32_bf16 v[200:203], a[88:91], v[68:71], v[200:203]
    v_mfma_f32_16x16x32_bf16 v[200:203], a[104:107], v[72:75], v[200:203]
    v_mfma_f32_16x16x32_bf16 v[200:203], a[120:123], v[76:79], v[200:203]
    v_mfma_f32_16x16x32_bf16 v[204:207], a[76:79], v[64:67], v[204:207]
    v_mfma_f32_16x16x32_bf16 v[204:207], a[92:95], v[68:71], v[204:207]
    v_mfma_f32_16x16x32_bf16 v[204:207], a[108:111], v[72:75], v[204:207]
    v_mfma_f32_16x16x32_bf16 v[204:207], a[124:127], v[76:79], v[204:207]
    s_waitcnt vmcnt(9) lgkmcnt(0)
    s_barrier
    v_mfma_f32_16x16x32_bf16 v[208:211], a[64:67], v[80:83], v[208:211]
    ds_read_b128 v[64:67], v224 offset:32768
    v_mfma_f32_16x16x32_bf16 v[208:211], a[80:83], v[84:87], v[208:211]
    ds_read_b128 v[68:71], v225 offset:32768
    v_mfma_f32_16x16x32_bf16 v[208:211], a[96:99], v[88:91], v[208:211]
    ds_read_b128 v[72:75], v224 offset:40960
    s_add_u32 s38, s36, 69632
    buffer_store_dwordx4 v[4:7], v240, s[16:19], s38 offen offset:512 sc1
    v_mfma_f32_16x16x32_bf16 v[208:211], a[112:115], v[92:95], v[208:211]
    ds_read_b128 v[76:79], v225 offset:40960
    v_mfma_f32_16x16x32_bf16 v[212:215], a[68:71], v[80:83], v[212:215]
    v_mfma_f32_16x16x32_bf16 v[212:215], a[84:87], v[84:87], v[212:215]
    v_mfma_f32_16x16x32_bf16 v[212:215], a[100:103], v[88:91], v[212:215]
    v_mfma_f32_16x16x32_bf16 v[212:215], a[116:119], v[92:95], v[212:215]
    v_mfma_f32_16x16x32_bf16 v[216:219], a[72:75], v[80:83], v[216:219]
    v_mfma_f32_16x16x32_bf16 v[216:219], a[88:91], v[84:87], v[216:219]
    v_mfma_f32_16x16x32_bf16 v[216:219], a[104:107], v[88:91], v[216:219]
    v_mfma_f32_16x16x32_bf16 v[216:219], a[120:123], v[92:95], v[216:219]
    v_mfma_f32_16x16x32_bf16 v[220:223], a[76:79], v[80:83], v[220:223]
    v_mfma_f32_16x16x32_bf16 v[220:223], a[92:95], v[84:87], v[220:223]
    v_mfma_f32_16x16x32_bf16 v[220:223], a[108:111], v[88:91], v[220:223]
    v_mfma_f32_16x16x32_bf16 v[220:223], a[124:127], v[92:95], v[220:223]
    s_waitcnt lgkmcnt(0)
    v_mfma_f32_16x16x32_bf16 v[160:163], a[128:131], v[64:67], v[160:163]
    ds_read_b128 v[80:83], v224 offset:34816
    v_mfma_f32_16x16x32_bf16 v[160:163], a[144:147], v[68:71], v[160:163]
    ds_read_b128 v[84:87], v225 offset:34816
    v_mfma_f32_16x16x32_bf16 v[160:163], a[160:163], v[72:75], v[160:163]
    ds_read_b128 v[88:91], v224 offset:43008
    v_mfma_f32_16x16x32_bf16 v[160:163], a[176:179], v[76:79], v[160:163]
    ds_read_b128 v[92:95], v225 offset:43008
    v_mfma_f32_16x16x32_bf16 v[164:167], a[132:135], v[64:67], v[164:167]
    v_mfma_f32_16x16x32_bf16 v[164:167], a[148:151], v[68:71], v[164:167]
    v_mfma_f32_16x16x32_bf16 v[164:167], a[164:167], v[72:75], v[164:167]
    v_mfma_f32_16x16x32_bf16 v[164:167], a[180:183], v[76:79], v[164:167]
    v_mfma_f32_16x16x32_bf16 v[168:171], a[136:139], v[64:67], v[168:171]
    buffer_load_dword v254, off, s[88:91], s39 sc1
    s_add_u32 s38, s36, 65536
    buffer_store_dwordx4 v[8:11], v240, s[16:19], s38 offen offset:3584 sc1
    v_mfma_f32_16x16x32_bf16 v[168:171], a[152:155], v[68:71], v[168:171]
    v_mfma_f32_16x16x32_bf16 v[168:171], a[168:171], v[72:75], v[168:171]
    v_mfma_f32_16x16x32_bf16 v[168:171], a[184:187], v[76:79], v[168:171]
    v_mfma_f32_16x16x32_bf16 v[172:175], a[140:143], v[64:67], v[172:175]
    v_mfma_f32_16x16x32_bf16 v[172:175], a[156:159], v[68:71], v[172:175]
    v_mfma_f32_16x16x32_bf16 v[172:175], a[172:175], v[72:75], v[172:175]
    v_mfma_f32_16x16x32_bf16 v[172:175], a[188:191], v[76:79], v[172:175]
    s_waitcnt lgkmcnt(0)
    v_mfma_f32_16x16x32_bf16 v[176:179], a[128:131], v[80:83], v[176:179]
    ds_read_b128 v[64:67], v224 offset:36864
    v_mfma_f32_16x16x32_bf16 v[176:179], a[144:147], v[84:87], v[176:179]
    ds_read_b128 v[68:71], v225 offset:36864
    v_mfma_f32_16x16x32_bf16 v[176:179], a[160:163], v[88:91], v[176:179]
    ds_read_b128 v[72:75], v224 offset:45056
    v_mfma_f32_16x16x32_bf16 v[176:179], a[176:179], v[92:95], v[176:179]
    ds_read_b128 v[76:79], v225 offset:45056
    v_mfma_f32_16x16x32_bf16 v[180:183], a[132:135], v[80:83], v[180:183]
    v_mfma_f32_16x16x32_bf16 v[180:183], a[148:151], v[84:87], v[180:183]
    v_mfma_f32_16x16x32_bf16 v[180:183], a[164:167], v[88:91], v[180:183]
    v_mfma_f32_16x16x32_bf16 v[180:183], a[180:183], v[92:95], v[180:183]
    v_mfma_f32_16x16x32_bf16 v[184:187], a[136:139], v[80:83], v[184:187]
    v_mfma_f32_16x16x32_bf16 v[184:187], a[152:155], v[84:87], v[184:187]
    v_mfma_f32_16x16x32_bf16 v[184:187], a[168:171], v[88:91], v[184:187]
    v_mfma_f32_16x16x32_bf16 v[184:187], a[184:187], v[92:95], v[184:187]
    v_mfma_f32_16x16x32_bf16 v[188:191], a[140:143], v[80:83], v[188:191]
    v_mfma_f32_16x16x32_bf16 v[188:191], a[156:159], v[84:87], v[188:191]
    s_add_u32 s38, s36, 69632
    buffer_store_dwordx4 v[12:15], v240, s[16:19], s38 offen offset:1536 sc1
    v_mfma_f32_16x16x32_bf16 v[188:191], a[172:175], v[88:91], v[188:191]
    v_mfma_f32_16x16x32_bf16 v[188:191], a[188:191], v[92:95], v[188:191]
    s_waitcnt lgkmcnt(0)
    v_mfma_f32_16x16x32_bf16 v[192:195], a[128:131], v[64:67], v[192:195]
    ds_read_b128 v[80:83], v224 offset:38912
    v_mfma_f32_16x16x32_bf16 v[192:195], a[144:147], v[68:71], v[192:195]
    ds_read_b128 v[84:87], v225 offset:38912
    v_mfma_f32_16x16x32_bf16 v[192:195], a[160:163], v[72:75], v[192:195]
    ds_read_b128 v[88:91], v224 offset:47104
    v_mfma_f32_16x16x32_bf16 v[192:195], a[176:179], v[76:79], v[192:195]
    ds_read_b128 v[92:95], v225 offset:47104
    v_mfma_f32_16x16x32_bf16 v[196:199], a[132:135], v[64:67], v[196:199]
    v_mfma_f32_16x16x32_bf16 v[196:199], a[148:151], v[68:71], v[196:199]
    v_mfma_f32_16x16x32_bf16 v[196:199], a[164:167], v[72:75], v[196:199]
    v_mfma_f32_16x16x32_bf16 v[196:199], a[180:183], v[76:79], v[196:199]
    v_mfma_f32_16x16x32_bf16 v[200:203], a[136:139], v[64:67], v[200:203]
    v_mfma_f32_16x16x32_bf16 v[200:203], a[152:155], v[68:71], v[200:203]
    v_mfma_f32_16x16x32_bf16 v[200:203], a[168:171], v[72:75], v[200:203]
    v_mfma_f32_16x16x32_bf16 v[200:203], a[184:187], v[76:79], v[200:203]
    v_mfma_f32_16x16x32_bf16 v[204:207], a[140:143], v[64:67], v[204:207]
    v_mfma_f32_16x16x32_bf16 v[204:207], a[156:159], v[68:71], v[204:207]
    v_mfma_f32_16x16x32_bf16 v[204:207], a[172:175], v[72:75], v[204:207]
    v_mfma_f32_16x16x32_bf16 v[204:207], a[188:191], v[76:79], v[204:207]
    s_waitcnt lgkmcnt(0)
    v_mfma_f32_16x16x32_bf16 v[208:211], a[128:131], v[80:83], v[208:211]
    ds_read_b128 v[64:67], v224 offset:49152
    v_mfma_f32_16x16x32_bf16 v[208:211], a[144:147], v[84:87], v[208:211]
    ds_read_b128 v[68:71], v224 offset:51200
    v_mfma_f32_16x16x32_bf16 v[208:211], a[160:163], v[88:91], v[208:211]
    ds_read_b128 v[72:75], v224 offset:53248
    v_mfma_f32_16x16x32_bf16 v[208:211], a[176:179], v[92:95], v[208:211]
    ds_read_b128 v[76:79], v224 offset:55296
    s_add_u32 s38, s36, 73728
    buffer_store_dwordx4 v[16:19], v240, s[16:19], s38 offen offset:2560 sc1
    v_mfma_f32_16x16x32_bf16 v[212:215], a[132:135], v[80:83], v[212:215]
    v_mfma_f32_16x16x32_bf16 v[212:215], a[148:151], v[84:87], v[212:215]
    v_mfma_f32_16x16x32_bf16 v[212:215], a[164:167], v[88:91], v[212:215]
    v_mfma_f32_16x16x32_bf16 v[212:215], a[180:183], v[92:95], v[212:215]
    v_mfma_f32_16x16x32_bf16 v[216:219], a[136:139], v[80:83], v[216:219]
    v_mfma_f32_16x16x32_bf16 v[216:219], a[152:155], v[84:87], v[216:219]
    v_mfma_f32_16x16x32_bf16 v[216:219], a[168:171], v[88:91], v[216:219]
    v_mfma_f32_16x16x32_bf16 v[216:219], a[184:187], v[92:95], v[216:219]
    v_mfma_f32_16x16x32_bf16 v[220:223], a[140:143], v[80:83], v[220:223]
    v_mfma_f32_16x16x32_bf16 v[220:223], a[156:159], v[84:87], v[220:223]
    v_mfma_f32_16x16x32_bf16 v[220:223], a[172:175], v[88:91], v[220:223]
    v_mfma_f32_16x16x32_bf16 v[220:223], a[188:191], v[92:95], v[220:223]
    s_waitcnt vmcnt(3)
    v_readfirstlane_b32 s24, v254
    s_lshl_b32 s25, s3, 16
    s_add_u32 s24, s24, s25
    s_cmp_ge_u32 s24, 32
    s_cbranch_scc0 kf_spin33
kf_spinr34:
    s_waitcnt lgkmcnt(0)
    s_barrier
    v_mfma_f32_16x16x32_bf16 v[160:163], a[192:195], v[64:67], v[160:163]
    ds_read_b128 v[80:83], v225 offset:49152
    v_mfma_f32_16x16x32_bf16 v[164:167], a[196:199], v[64:67], v[164:167]
    ds_read_b128 v[84:87], v225 offset:51200
    v_mfma_f32_16x16x32_bf16 v[168:171], a[200:203], v[64:67], v[168:171]
    ds_read_b128 v[88:91], v225 offset:53248
    v_mfma_f32_16x16x32_bf16 v[172:175], a[204:207], v[64:67], v[172:175]
    ds_read_b128 v[92:95], v225 offset:55296
    v_mfma_f32_16x16x32_bf16 v[176:179], a[192:195], v[68:71], v[176:179]
    v_mfma_f32_16x16x32_bf16 v[180:183], a[196:199], v[68:71], v[180:183]
    v_mfma_f32_16x16x32_bf16 v[184:187], a[200:203], v[68:71], v[184:187]
    v_mfma_f32_16x16x32_bf16 v[188:191], a[204:207], v[68:71], v[188:191]
    v_mfma_f32_16x16x32_bf16 v[192:195], a[192:195], v[72:75], v[192:195]
    buffer_load_dwordx4 a[128:131], v248, s[8:11], s28 offen offset:0 sc1
    s_add_u32 s38, s36, 77824
    buffer_store_dwordx4 v[20:23], v240, s[16:19], s38 offen offset:512 sc1
    v_mfma_f32_16x16x32_bf16 v[196:199], a[196:199], v[72:75], v[196:199]
    v_mfma_f32_16x16x32_bf16 v[200:203], a[200:203], v[72:75], v[200:203]
    buffer_load_dwordx4 a[132:135], v248, s[8:11], s29 offen offset:0 sc1
    v_mfma_f32_16x16x32_bf16 v[204:207], a[204:207], v[72:75], v[204:207]
    v_mfma_f32_16x16x32_bf16 v[208:211], a[192:195], v[76:79], v[208:211]
    v_mfma_f32_16x16x32_bf16 v[212:215], a[196:199], v[76:79], v[212:215]
    buffer_load_dwordx4 a[136:139], v249, s[8:11], s28 offen offset:0 sc1
    v_mfma_f32_16x16x32_bf16 v[216:219], a[200:203], v[76:79], v[216:219]
    v_mfma_f32_16x16x32_bf16 v[220:223], a[204:207], v[76:79], v[220:223]
    s_waitcnt lgkmcnt(0)
    v_mfma_f32_16x16x32_bf16 v[160:163], a[208:211], v[80:83], v[160:163]
    ds_read_b128 v[64:67], v224 offset:57344
    v_mfma_f32_16x16x32_bf16 v[164:167], a[212:215], v[80:83], v[164:167]
    ds_read_b128 v[68:71], v224 offset:59392
    v_mfma_f32_16x16x32_bf16 v[168:171], a[216:219], v[80:83], v[168:171]
    ds_read_b128 v[72:75], v224 offset:61440
    v_mfma_f32_16x16x32_bf16 v[172:175], a[220:223], v[80:83], v[172:175]
    ds_read_b128 v[76:79], v224 offset:63488
    v_mfma_f32_16x16x32_bf16 v[176:179], a[208:211], v[84:87], v[176:179]
    v_mfma_f32_16x16x32_bf16 v[180:183], a[212:215], v[84:87], v[180:183]
    v_mfma_f32_16x16x32_bf16 v[184:187], a[216:219], v[84:87], v[184:187]
    v_mfma_f32_16x16x32_bf16 v[188:191], a[220:223], v[84:87], v[188:191]
    v_mfma_f32_16x16x32_bf16 v[192:195], a[208:211], v[88:91], v[192:195]
    buffer_load_dwordx4 a[140:143], v249, s[8:11], s29 offen offset:0 sc1
    v_mfma_f32_16x16x32_bf16 v[196:199], a[212:215], v[88:91], v[196:199]
    v_mfma_f32_16x16x32_bf16 v[200:203], a[216:219], v[88:91], v[200:203]
    buffer_load_dwordx4 a[144:147], v248, s[8:11], s28 offen offset:1024 sc1
    v_mfma_f32_16x16x32_bf16 v[204:207], a[220:223], v[88:91], v[204:207]
    v_mfma_f32_16x16x32_bf16 v[208:211], a[208:211], v[92:95], v[208:211]
    v_mfma_f32_16x16x32_bf16 v[212:215], a[212:215], v[92:95], v[212:215]
    buffer_load_dwordx4 a[148:151], v248, s[8:11], s29 offen offset:1024 sc1
    v_mfma_f32_16x16x32_bf16 v[216:219], a[216:219], v[92:95], v[216:219]
    s_add_u32 s38, s36, 73728
    buffer_store_dwordx4 v[24:27], v240, s[16:19], s38 offen offset:3584 sc1
    v_mfma_f32_16x16x32_bf16 v[220:223], a[220:223], v[92:95], v[220:223]
    s_waitcnt lgkmcnt(0)
    v_mfma_f32_16x16x32_bf16 v[160:163], a[224:227], v[64:67], v[160:163]
    ds_read_b128 v[80:83], v225 offset:57344
    v_mfma_f32_16x16x32_bf16 v[164:167], a[228:231], v[64:67], v[164:167]
    ds_read_b128 v[84:87], v225 offset:59392
    v_mfma_f32_16x16x32_bf16 v[168:171], a[232:235], v[64:67], v[168:171]
    ds_read_b128 v[88:91], v225 offset:61440
    v_mfma_f32_16x16x32_bf16 v[172:175], a[236:239], v[64:67], v[172:175]
    ds_read_b128 v[92:95], v225 offset:63488
    v_mfma_f32_16x16x32_bf16 v[176:179], a[224:227], v[68:71], v[176:179]
    v_mfma_f32_16x16x32_bf16 v[180:183], a[228:231], v[68:71], v[180:183]
    v_mfma_f32_16x16x32_bf16 v[184:187], a[232:235], v[68:71], v[184:187]
    v_mfma_f32_16x16x32_bf16 v[188:191], a[236:239], v[68:71], v[188:191]
    v_mfma_f32_16x16x32_bf16 v[192:195], a[224:227], v[72:75], v[192:195]
    buffer_load_dwordx4 a[152:155], v249, s[8:11], s28 offen offset:1024 sc1
    v_mfma_f32_16x16x32_bf16 v[196:199], a[228:231], v[72:75], v[196:199]
    v_mfma_f32_16x16x32_bf16 v[200:203], a[232:235], v[72:75], v[200:203]
    buffer_load_dwordx4 a[156:159], v249, s[8:11], s29 offen offset:1024 sc1
    v_mfma_f32_16x16x32_bf16 v[204:207], a[236:239], v[72:75], v[204:207]
    v_mfma_f32_16x16x32_bf16 v[208:211], a[224:227], v[76:79], v[208:211]
    v_mfma_f32_16x16x32_bf16 v[212:215], a[228:231], v[76:79], v[212:215]
    buffer_load_dwordx4 a[160:163], v248, s[8:11], s28 offen offset:2048 sc1
    v_mfma_f32_16x16x32_bf16 v[216:219], a[232:235], v[76:79], v[216:219]
    v_mfma_f32_16x16x32_bf16 v[220:223], a[236:239], v[76:79], v[220:223]
    s_waitcnt vmcnt(38) lgkmcnt(0)
    s_barrier
    v_mfma_f32_16x16x32_bf16 v[160:163], a[240:243], v[80:83], v[160:163]
    ds_read_b64_tr_b16 a[192:193], v246 offset:0
    v_mfma_f32_16x16x32_bf16 v[164:167], a[244:247], v[80:83], v[164:167]
    ds_read_b64_tr_b16 a[194:195], v246 offset:1024
    v_mfma_f32_16x16x32_bf16 v[168:171], a[248:251], v[80:83], v[168:171]
    ds_read_b64_tr_b16 a[196:197], v238 offset:0
    v_mfma_f32_16x16x32_bf16 v[172:175], a[252:255], v[80:83], v[172:175]
    ds_read_b64_tr_b16 a[198:199], v238 offset:1024
    v_mfma_f32_16x16x32_bf16 v[176:179], a[240:243], v[84:87], v[176:179]
    ds_read_b64_tr_b16 a[200:201], v246 offset:256
    s_add_u32 s38, s36, 77824
    buffer_store_dwordx4 v[28:31], v240, s[16:19], s38 offen offset:1536 sc1
    v_mfma_f32_16x16x32_bf16 v[180:183], a[244:247], v[84:87], v[180:183]
    ds_read_b64_tr_b16 a[202:203], v246 offset:1280
    v_mfma_f32_16x16x32_bf16 v[184:187], a[248:251], v[84:87], v[184:187]
    ds_read_b64_tr_b16 a[204:205], v238 offset:256
    v_mfma_f32_16x16x32_bf16 v[188:191], a[252:255], v[84:87], v[188:191]
    ds_read_b64_tr_b16 a[206:207], v238 offset:1280
    v_mfma_f32_16x16x32_bf16 v[192:195], a[240:243], v[88:91], v[192:195]
    buffer_load_dwordx4 a[164:167], v248, s[8:11], s29 offen offset:2048 sc1
    v_mfma_f32_16x16x32_bf16 v[196:199], a[244:247], v[88:91], v[196:199]
    v_cvt_pk_bf16_f32 v32, v160, v161
    v_cvt_pk_bf16_f32 v33, v162, v163
    v_mfma_f32_16x16x32_bf16 v[200:203], a[248:251], v[88:91], v[200:203]
    buffer_load_dwordx4 a[168:171], v249, s[8:11], s28 offen offset:2048 sc1
    v_cvt_pk_bf16_f32 v34, v164, v165
    v_cvt_pk_bf16_f32 v35, v166, v167
    v_mfma_f32_16x16x32_bf16 v[204:207], a[252:255], v[88:91], v[204:207]
    v_cvt_pk_bf16_f32 v36, v168, v169
    v_cvt_pk_bf16_f32 v37, v170, v171
    v_mfma_f32_16x16x32_bf16 v[208:211], a[240:243], v[92:95], v[208:211]
    v_cvt_pk_bf16_f32 v38, v172, v173
    v_cvt_pk_bf16_f32 v39, v174, v175
    v_mfma_f32_16x16x32_bf16 v[212:215], a[244:247], v[92:95], v[212:215]
    buffer_load_dwordx4 a[172:175], v249, s[8:11], s29 offen offset:2048 sc1
    v_cvt_pk_bf16_f32 v40, v176, v177
    v_cvt_pk_bf16_f32 v41, v178, v179
    v_mfma_f32_16x16x32_bf16 v[216:219], a[248:251], v[92:95], v[216:219]
    v_cvt_pk_bf16_f32 v42, v180, v181
    v_cvt_pk_bf16_f32 v43, v182, v183
    v_mfma_f32_16x16x32_bf16 v[220:223], a[252:255], v[92:95], v[220:223]
    v_cvt_pk_bf16_f32 v44, v184, v185
    v_cvt_pk_bf16_f32 v45, v186, v187
    s_nop 3
    v_cvt_pk_bf16_f32 v46, v188, v189
    v_cvt_pk_bf16_f32 v47, v190, v191
    v_cvt_pk_bf16_f32 v48, v192, v193
    v_cvt_pk_bf16_f32 v49, v194, v195
    v_cvt_pk_bf16_f32 v50, v196, v197
    v_cvt_pk_bf16_f32 v51, v198, v199
    v_cvt_pk_bf16_f32 v52, v200, v201
    v_cvt_pk_bf16_f32 v53, v202, v203
    v_cvt_pk_bf16_f32 v54, v204, v205
    v_cvt_pk_bf16_f32 v55, v206, v207
    v_cvt_pk_bf16_f32 v56, v208, v209
    v_cvt_pk_bf16_f32 v57, v210, v211
    v_cvt_pk_bf16_f32 v58, v212, v213
    v_cvt_pk_bf16_f32 v59, v214, v215
    v_cvt_pk_bf16_f32 v60, v216, v217
    v_cvt_pk_bf16_f32 v61, v218, v219
    v_cvt_pk_bf16_f32 v62, v220, v221
    v_cvt_pk_bf16_f32 v63, v222, v223
    s_add_u32 s80, s36, 102144
    s_add_u32 s81, s36, 104192
    s_add_u32 s82, s36, 103168
    s_add_u32 s83, s36, 105216
    s_add_u32 s84, s36, 110336
    s_add_u32 s85, s36, 112384
    s_add_u32 s86, s36, 111360
    s_add_u32 s87, s36, 113408
    s_branch ka_Q
ka_V:
    s_waitcnt lgkmcnt(0)
    v_mfma_f32_16x16x32_bf16 v[96:99], v[64:67], a[0:3], 0
    ds_read_b128 v[80:83], v224 offset:8192
    v_mfma_f32_16x16x32_bf16 v[100:103], v[68:71], a[0:3], 0
    ds_read_b128 v[84:87], v224 offset:10240
    v_mfma_f32_16x16x32_bf16 v[104:107], v[64:67], a[4:7], 0
    ds_read_b128 v[88:91], v224 offset:12288
    v_mfma_f32_16x16x32_bf16 v[108:111], v[68:71], a[4:7], 0
    ds_read_b128 v[92:95], v224 offset:14336
    v_mfma_f32_16x16x32_bf16 v[112:115], v[64:67], a[8:11], 0
    ds_read_b64_tr_b16 a[16:17], v228 offset:4096
    v_mfma_f32_16x16x32_bf16 v[116:119], v[68:71], a[8:11], 0
    ds_read_b64_tr_b16 a[18:19], v228 offset:4608
    v_mfma_f32_16x16x32_bf16 v[120:123], v[64:67], a[12:15], 0
    ds_read_b64_tr_b16 a[20:21], v229 offset:4096
    v_mfma_f32_16x16x32_bf16 v[124:127], v[68:71], a[12:15], 0
    ds_read_b64_tr_b16 a[22:23], v229 offset:4608
    v_mfma_f32_16x16x32_bf16 v[128:131], v[72:75], a[0:3], 0
    s_add_u32 m0, s35, 16384
    s_and_b32 s33, s82, 1023
    s_lshl_b32 s33, s33, 12
    buffer_load_dwordx4 v234, s[48:51], s33 offen lds
    v_mfma_f32_16x16x32_bf16 v[132:135], v[76:79], a[0:3], 0
    v_mfma_f32_16x16x32_bf16 v[136:139], v[72:75], a[4:7], 0
    buffer_load_dwordx4 v235, s[48:51], s33 offen offset:1024 lds
    v_mfma_f32_16x16x32_bf16 v[140:143], v[76:79], a[4:7], 0
    v_mfma_f32_16x16x32_bf16 v[144:147], v[72:75], a[8:11], 0
    s_add_u32 m0, s35, 18432
    s_add_u32 s33, s33, 131072
    buffer_load_dwordx4 v234, s[48:51], s33 offen lds
    v_mfma_f32_16x16x32_bf16 v[148:151], v[76:79], a[8:11], 0
    v_mfma_f32_16x16x32_bf16 v[152:155], v[72:75], a[12:15], 0
    buffer_load_dwordx4 v235, s[48:51], s33 offen offset:1024 lds
    v_mfma_f32_16x16x32_bf16 v[156:159], v[76:79], a[12:15], 0
    s_waitcnt lgkmcnt(0)
    v_mfma_f32_16x16x32_bf16 v[160:163], v[80:83], a[0:3], 0
    ds_read_b128 v[64:67], v225 offset:0
    v_mfma_f32_16x16x32_bf16 v[164:167], v[84:87], a[0:3], 0
    ds_read_b128 v[68:71], v225 offset:2048
    v_mfma_f32_16x16x32_bf16 v[168:171], v[80:83], a[4:7], 0
    ds_read_b128 v[72:75], v225 offset:4096
    v_mfma_f32_16x16x32_bf16 v[172:175], v[84:87], a[4:7], 0
    ds_read_b128 v[76:79], v225 offset:6144
    v_mfma_f32_16x16x32_bf16 v[176:179], v[80:83], a[8:11], 0
    ds_read_b64_tr_b16 a[24:25], v230 offset:4096
    v_mfma_f32_16x16x32_bf16 v[180:183], v[84:87], a[8:11], 0
    ds_read_b64_tr_b16 a[26:27], v230 offset:4608
    v_mfma_f32_16x16x32_bf16 v[184:187], v[80:83], a[12:15], 0
    ds_read_b64_tr_b16 a[28:29], v231 offset:4096
    v_mfma_f32_16x16x32_bf16 v[188:191], v[84:87], a[12:15], 0
    ds_read_b64_tr_b16 a[30:31], v231 offset:4608
    v_mfma_f32_16x16x32_bf16 v[192:195], v[88:91], a[0:3], 0
    s_add_u32 m0, s35, 20480
    s_add_u32 s33, s33, 131072
    buffer_load_dwordx4 v234, s[48:51], s33 offen lds
    v_mfma_f32_16x16x32_bf16 v[196:199], v[92:95], a[0:3], 0
    v_mfma_f32_16x16x32_bf16 v[200:203], v[88:91], a[4:7], 0
    buffer_load_dwordx4 v235, s[48:51], s33 offen offset:1024 lds
    v_mfma_f32_16x16x32_bf16 v[204:207], v[92:95], a[4:7], 0
    v_mfma_f32_16x16x32_bf16 v[208:211], v[88:91], a[8:11], 0
    s_add_u32 m0, s35, 22528
    s_add_u32 s33, s33, 131072
    buffer_load_dwordx4 v234, s[48:51], s33 offen lds
    v_mfma_f32_16x16x32_bf16 v[212:215], v[92:95], a[8:11], 0
    v_mfma_f32_16x16x32_bf16 v[216:219], v[88:91], a[12:15], 0
    buffer_load_dwordx4 v235, s[48:51], s33 offen offset:1024 lds
    v_mfma_f32_16x16x32_bf16 v[220:223], v[92:95], a[12:15], 0
    s_waitcnt vmcnt(13) lgkmcnt(0)
    v_mfma_f32_16x16x32_bf16 v[96:99], v[64:67], a[16:19], v[96:99]
    ds_read_b128 v[80:83], v225 offset:8192
    v_mfma_f32_16x16x32_bf16 v[100:103], v[68:71], a[16:19], v[100:103]
    ds_read_b128 v[84:87], v225 offset:10240
    v_mfma_f32_16x16x32_bf16 v[104:107], v[64:67], a[20:23], v[104:107]
    ds_read_b128 v[88:91], v225 offset:12288
    v_mfma_f32_16x16x32_bf16 v[108:111], v[68:71], a[20:23], v[108:111]
    ds_read_b128 v[92:95], v225 offset:14336
    v_mfma_f32_16x16x32_bf16 v[112:115], v[64:67], a[24:27], v[112:115]
    ds_read_b64_tr_b16 a[32:33], v228 offset:8192
    v_mfma_f32_16x16x32_bf16 v[116:119], v[68:71], a[24:27], v[116:119]
    ds_read_b64_tr_b16 a[34:35], v228 offset:8704
    v_mfma_f32_16x16x32_bf16 v[120:123], v[64:67], a[28:31], v[120:123]
    ds_read_b64_tr_b16 a[36:37], v229 offset:8192
    v_mfma_f32_16x16x32_bf16 v[124:127], v[68:71], a[28:31], v[124:127]
    ds_read_b64_tr_b16 a[38:39], v229 offset:8704
    v_mfma_f32_16x16x32_bf16 v[128:131], v[72:75], a[16:19], v[128:131]
    ds_read_b64_tr_b16 a[40:41], v230 offset:8192
    s_add_u32 m0, s34, 32768
    s_add_u32 s37, s82, 0
    buffer_load_dwordx4 v232, s[44:47], s37 offen lds
    v_mfma_f32_16x16x32_bf16 v[132:135], v[76:79], a[16:19], v[132:135]
    ds_read_b64_tr_b16 a[42:43], v230 offset:8704
    buffer_load_dwordx4 v233, s[44:47], s37 offen offset:1024 lds
    v_mfma_f32_16x16x32_bf16 v[136:139], v[72:75], a[20:23], v[136:139]
    ds_read_b64_tr_b16 a[44:45], v231 offset:8192
    s_add_u32 m0, s34, 40960
    s_add_u32 s37, s82, 65536
    buffer_load_dwordx4 v232, s[44:47], s37 offen lds
    v_mfma_f32_16x16x32_bf16 v[140:143], v[76:79], a[20:23], v[140:143]
    ds_read_b64_tr_b16 a[46:47], v231 offset:8704
    buffer_load_dwordx4 v233, s[44:47], s37 offen offset:1024 lds
    v_mfma_f32_16x16x32_bf16 v[144:147], v[72:75], a[24:27], v[144:147]
    s_add_u32 m0, s35, 0
    s_and_b32 s33, s83, 1023
    s_lshl_b32 s33, s33, 12
    buffer_load_dwordx4 v234, s[48:51], s33 offen lds
    v_mfma_f32_16x16x32_bf16 v[148:151], v[76:79], a[24:27], v[148:151]
    buffer_load_dwordx4 v235, s[48:51], s33 offen offset:1024 lds
    v_mfma_f32_16x16x32_bf16 v[152:155], v[72:75], a[28:31], v[152:155]
    s_add_u32 m0, s35, 2048
    s_add_u32 s33, s33, 131072
    buffer_load_dwordx4 v234, s[48:51], s33 offen lds
    v_mfma_f32_16x16x32_bf16 v[156:159], v[76:79], a[28:31], v[156:159]
    buffer_load_dwordx4 v235, s[48:51], s33 offen offset:1024 lds
    s_waitcnt vmcnt(17) lgkmcnt(0)
    s_barrier
    v_mfma_f32_16x16x32_bf16 v[160:163], v[80:83], a[16:19], v[160:163]
    ds_read_b128 v[64:67], v224 offset:16384
    v_mfma_f32_16x16x32_bf16 v[164:167], v[84:87], a[16:19], v[164:167]
    ds_read_b128 v[68:71], v225 offset:16384
    v_mfma_f32_16x16x32_bf16 v[168:171], v[80:83], a[20:23], v[168:171]
    ds_read_b128 v[72:75], v224 offset:18432
    v_mfma_f32_16x16x32_bf16 v[172:175], v[84:87], a[20:23], v[172:175]
    ds_read_b128 v[76:79], v225 offset:18432
    v_mfma_f32_16x16x32_bf16 v[176:179], v[80:83], a[24:27], v[176:179]
    ds_read_b64_tr_b16 a[48:49], v228 offset:12288
    s_add_u32 m0, s34, 49152
    s_add_u32 s37, s83, 0
    buffer_load_dwordx4 v232, s[44:47], s37 offen lds
    v_mfma_f32_16x16x32_bf16 v[180:183], v[84:87], a[24:27], v[180:183]
    ds_read_b64_tr_b16 a[50:51], v228 offset:12800
    buffer_load_dwordx4 v233, s[44:47], s37 offen offset:1024 lds
    v_mfma_f32_16x16x32_bf16 v[184:187], v[80:83], a[28:31], v[184:187]
    ds_read_b64_tr_b16 a[52:53], v229 offset:12288
    s_add_u32 m0, s34, 57344
    s_add_u32 s37, s83, 65536
    buffer_load_dwordx4 v232, s[44:47], s37 offen lds
    v_mfma_f32_16x16x32_bf16 v[188:191], v[84:87], a[28:31], v[188:191]
    ds_read_b64_tr_b16 a[54:55], v229 offset:12800
    buffer_load_dwordx4 v233, s[44:47], s37 offen offset:1024 lds
    v_mfma_f32_16x16x32_bf16 v[192:195], v[88:91], a[16:19], v[192:195]
    ds_read_b64_tr_b16 a[56:57], v230 offset:12288
    s_add_u32 m0, s34, 0
    s_add_u32 s37, s84, 0
    buffer_load_dwordx4 v232, s[44:47], s37 offen lds
    v_mfma_f32_16x16x32_bf16 v[196:199], v[92:95], a[16:19], v[196:199]
    ds_read_b64_tr_b16 a[58:59], v230 offset:12800
    v_mfma_f32_16x16x32_bf16 v[200:203], v[88:91], a[20:23], v[200:203]
    ds_read_b64_tr_b16 a[60:61], v231 offset:12288
    buffer_load_dwordx4 v233, s[44:47], s37 offen offset:1024 lds
    v_mfma_f32_16x16x32_bf16 v[204:207], v[92:95], a[20:23], v[204:207]
    ds_read_b64_tr_b16 a[62:63], v231 offset:12800
    buffer_load_dwordx4 v[0:3], v236, s[52:55], 0 offen offset:0
    v_mfma_f32_16x16x32_bf16 v[208:211], v[88:91], a[24:27], v[208:211]
    buffer_load_dwordx4 v[4:7], v236, s[52:55], 0 offen offset:512
    v_mfma_f32_16x16x32_bf16 v[212:215], v[92:95], a[24:27], v[212:215]
    buffer_load_dwordx4 v[8:11], v236, s[52:55], 0 offen offset:1024
    v_mfma_f32_16x16x32_bf16 v[216:219], v[88:91], a[28:31], v[216:219]
    buffer_load_dwordx4 v[12:15], v236, s[52:55], 0 offen offset:1536
    v_mfma_f32_16x16x32_bf16 v[220:223], v[92:95], a[28:31], v[220:223]
    s_waitcnt lgkmcnt(0)
    v_mfma_f32_16x16x32_bf16 v[96:99], v[64:67], a[32:35], v[96:99]
    ds_read_b128 v[80:83], v224 offset:20480
    v_mfma_f32_16x16x32_bf16 v[96:99], v[68:71], a[48:51], v[96:99]
    ds_read_b128 v[84:87], v225 offset:20480
    v_mfma_f32_16x16x32_bf16 v[100:103], v[72:75], a[32:35], v[100:103]
    ds_read_b128 v[88:91], v224 offset:22528
    v_mfma_f32_16x16x32_bf16 v[100:103], v[76:79], a[48:51], v[100:103]
    ds_read_b128 v[92:95], v225 offset:22528
    v_mfma_f32_16x16x32_bf16 v[104:107], v[64:67], a[36:39], v[104:107]
    v_mfma_f32_16x16x32_bf16 v[104:107], v[68:71], a[52:55], v[104:107]
    v_mfma_f32_16x16x32_bf16 v[108:111], v[72:75], a[36:39], v[108:111]
    v_mfma_f32_16x16x32_bf16 v[108:111], v[76:79], a[52:55], v[108:111]
    v_mfma_f32_16x16x32_bf16 v[112:115], v[64:67], a[40:43], v[112:115]
    s_add_u32 m0, s35, 4096
    s_add_u32 s33, s33, 131072
    buffer_load_dwordx4 v234, s[48:51], s33 offen lds
    v_mfma_f32_16x16x32_bf16 v[112:115], v[68:71], a[56:59], v[112:115]
    v_mfma_f32_16x16x32_bf16 v[116:119], v[72:75], a[40:43], v[116:119]
    buffer_load_dwordx4 v235, s[48:51], s33 offen offset:1024 lds
    v_mfma_f32_16x16x32_bf16 v[116:119], v[76:79], a[56:59], v[116:119]
    v_mfma_f32_16x16x32_bf16 v[120:123], v[64:67], a[44:47], v[120:123]
    s_add_u32 m0, s35, 6144
    s_add_u32 s33, s33, 131072
    buffer_load_dwordx4 v234, s[48:51], s33 offen lds
    v_mfma_f32_16x16x32_bf16 v[120:123], v[68:71], a[60:63], v[120:123]
    v_mfma_f32_16x16x32_bf16 v[124:127], v[72:75], a[44:47], v[124:127]
    buffer_load_dwordx4 v235, s[48:51], s33 offen offset:1024 lds
    v_mfma_f32_16x16x32_bf16 v[124:127], v[76:79], a[60:63], v[124:127]
    s_waitcnt lgkmcnt(0)
    v_mfma_f32_16x16x32_bf16 v[128:131], v[80:83], a[32:35], v[128:131]
    ds_read_b128 v[64:67], v224 offset:24576
    v_mfma_f32_16x16x32_bf16 v[128:131], v[84:87], a[48:51], v[128:131]
    ds_read_b128 v[68:71], v225 offset:24576
    v_mfma_f32_16x16x32_bf16 v[132:135], v[88:91], a[32:35], v[132:135]
    ds_read_b128 v[72:75], v224 offset:26624
    v_mfma_f32_16x16x32_bf16 v[132:135], v[92:95], a[48:51], v[132:135]
    ds_read_b128 v[76:79], v225 offset:26624
    v_mfma_f32_16x16x32_bf16 v[136:139], v[80:83], a[36:39], v[136:139]
    v_mfma_f32_16x16x32_bf16 v[136:139], v[84:87], a[52:55], v[136:139]
    v_mfma_f32_16x16x32_bf16 v[140:143], v[88:91], a[36:39], v[140:143]
    v_mfma_f32_16x16x32_bf16 v[140:143], v[92:95], a[52:55], v[140:143]
    v_mfma_f32_16x16x32_bf16 v[144:147], v[80:83], a[40:43], v[144:147]
    s_add_u32 m0, s34, 8192
    s_add_u32 s37, s84, 65536
    buffer_load_dwordx4 v232, s[44:47], s37 offen lds
    v_mfma_f32_16x16x32_bf16 v[144:147], v[84:87], a[56:59], v[144:147]
    v_mfma_f32_16x16x32_bf16 v[148:151], v[88:91], a[40:43], v[148:151]
    v_mfma_f32_16x16x32_bf16 v[148:151], v[92:95], a[56:59], v[148:151]
    v_mfma_f32_16x16x32_bf16 v[152:155], v[80:83], a[44:47], v[152:155]
    buffer_load_dwordx4 v233, s[44:47], s37 offen offset:1024 lds
    v_mfma_f32_16x16x32_bf16 v[152:155], v[84:87], a[60:63], v[152:155]
    v_mfma_f32_16x16x32_bf16 v[156:159], v[88:91], a[44:47], v[156:159]
    v_mfma_f32_16x16x32_bf16 v[156:159], v[92:95], a[60:63], v[156:159]
    s_waitcnt vmcnt(24) lgkmcnt(0)
    v_mfma_f32_16x16x32_bf16 v[160:163], v[64:67], a[32:35], v[160:163]
    ds_read_b128 v[80:83], v224 offset:28672
    v_mfma_f32_16x16x32_bf16 v[160:163], v[68:71], a[48:51], v[160:163]
    ds_read_b128 v[84:87], v225 offset:28672
    v_mfma_f32_16x16x32_bf16 v[164:167], v[72:75], a[32:35], v[164:167]
    ds_read_b128 v[88:91], v224 offset:30720
    v_mfma_f32_16x16x32_bf16 v[164:167], v[76:79], a[48:51], v[164:167]
    ds_read_b128 v[92:95], v225 offset:30720
    v_mfma_f32_16x16x32_bf16 v[168:171], v[64:67], a[36:39], v[168:171]
    ds_read_b64_tr_b16 a[64:65], v228 offset:16384
    v_mfma_f32_16x16x32_bf16 v[168:171], v[68:71], a[52:55], v[168:171]
    ds_read_b64_tr_b16 a[66:67], v228 offset:16896
    v_mfma_f32_16x16x32_bf16 v[172:175], v[72:75], a[36:39], v[172:175]
    ds_read_b64_tr_b16 a[68:69], v229 offset:16384
    v_mfma_f32_16x16x32_bf16 v[172:175], v[76:79], a[52:55], v[172:175]
    ds_read_b64_tr_b16 a[70:71], v229 offset:16896
    v_mfma_f32_16x16x32_bf16 v[176:179], v[64:67], a[40:43], v[176:179]
    ds_read_b64_tr_b16 a[72:73], v230 offset:16384
    s_add_u32 m0, s35, 8192
    s_and_b32 s33, s84, 1023
    s_lshl_b32 s33, s33, 12
    buffer_load_dwordx4 v234, s[48:51], s33 offen lds
    v_mfma_f32_16x16x32_bf16 v[176:179], v[68:71], a[56:59], v[176:179]
    ds_read_b64_tr_b16 a[74:75], v230 offset:16896
    v_mfma_f32_16x16x32_bf16 v[180:183], v[72:75], a[40:43], v[180:183]
    ds_read_b64_tr_b16 a[76:77], v231 offset:16384
    buffer_load_dwordx4 v235, s[48:51], s33 offen offset:1024 lds
    v_mfma_f32_16x16x32_bf16 v[180:183], v[76:79], a[56:59], v[180:183]
    ds_read_b64_tr_b16 a[78:79], v231 offset:16896
    v_mfma_f32_16x16x32_bf16 v[184:187], v[64:67], a[44:47], v[184:187]
    s_add_u32 m0, s35, 10240
    s_add_u32 s33, s33, 131072
    buffer_load_dwordx4 v234, s[48:51], s33 offen lds
    v_mfma_f32_16x16x32_bf16 v[184:187], v[68:71], a[60:63], v[184:187]
    v_mfma_f32_16x16x32_bf16 v[188:191], v[72:75], a[44:47], v[188:191]
    buffer_load_dwordx4 v235, s[48:51], s33 offen offset:1024 lds
    v_mfma_f32_16x16x32_bf16 v[188:191], v[76:79], a[60:63], v[188:191]
    s_waitcnt vmcnt(24) lgkmcnt(0)
    s_barrier
    v_mfma_f32_16x16x32_bf16 v[192:195], v[80:83], a[32:35], v[192:195]
    ds_read_b128 v[64:67], v224 offset:32768
    v_mfma_f32_16x16x32_bf16 v[192:195], v[84:87], a[48:51], v[192:195]
    ds_read_b128 v[68:71], v225 offset:32768
    v_mfma_f32_16x16x32_bf16 v[196:199], v[88:91], a[32:35], v[196:199]
    ds_read_b128 v[72:75], v224 offset:34816
    v_mfma_f32_16x16x32_bf16 v[196:199], v[92:95], a[48:51], v[196:199]
    ds_read_b128 v[76:79], v225 offset:34816
    v_mfma_f32_16x16x32_bf16 v[200:203], v[80:83], a[36:39], v[200:203]
    ds_read_b64_tr_b16 a[80:81], v228 offset:20480
    v_mfma_f32_16x16x32_bf16 v[200:203], v[84:87], a[52:55], v[200:203]
    ds_read_b64_tr_b16 a[82:83], v228 offset:20992
    v_mfma_f32_16x16x32_bf16 v[204:207], v[88:91], a[36:39], v[204:207]
    ds_read_b64_tr_b16 a[84:85], v229 offset:20480
    v_mfma_f32_16x16x32_bf16 v[204:207], v[92:95], a[52:55], v[204:207]
    ds_read_b64_tr_b16 a[86:87], v229 offset:20992
    v_mfma_f32_16x16x32_bf16 v[208:211], v[80:83], a[40:43], v[208:211]
    ds_read_b64_tr_b16 a[88:89], v230 offset:20480
    s_add_u32 m0, s34, 16384
    s_add_u32 s37, s85, 0
    buffer_load_dwordx4 v232, s[44:47], s37 offen lds
    v_mfma_f32_16x16x32_bf16 v[208:211], v[84:87], a[56:59], v[208:211]
    ds_read_b64_tr_b16 a[90:91], v230 offset:20992
    v_mfma_f32_16x16x32_bf16 v[212:215], v[88:91], a[40:43], v[212:215]
    ds_read_b64_tr_b16 a[92:93], v231 offset:20480
    v_mfma_f32_16x16x32_bf16 v[212:215], v[92:95], a[56:59], v[212:215]
    ds_read_b64_tr_b16 a[94:95], v231 offset:20992
    v_mfma_f32_16x16x32_bf16 v[216:219], v[80:83], a[44:47], v[216:219]
    buffer_load_dwordx4 v233, s[44:47], s37 offen offset:1024 lds
    v_mfma_f32_16x16x32_bf16 v[216:219], v[84:87], a[60:63], v[216:219]
    v_mfma_f32_16x16x32_bf16 v[220:223], v[88:91], a[44:47], v[220:223]
    v_mfma_f32_16x16x32_bf16 v[220:223], v[92:95], a[60:63], v[220:223]
    s_waitcnt lgkmcnt(0)
    v_mfma_f32_16x16x32_bf16 v[96:99], v[64:67], a[64:67], v[96:99]
    ds_read_b128 v[80:83], v224 offset:36864
    v_mfma_f32_16x16x32_bf16 v[96:99], v[68:71], a[80:83], v[96:99]
    ds_read_b128 v[84:87], v225 offset:36864
    v_mfma_f32_16x16x32_bf16 v[100:103], v[72:75], a[64:67], v[100:103]
    ds_read_b128 v[88:91], v224 offset:38912
    v_mfma_f32_16x16x32_bf16 v[100:103], v[76:79], a[80:83], v[100:103]
    ds_read_b128 v[92:95], v225 offset:38912
    v_mfma_f32_16x16x32_bf16 v[104:107], v[64:67], a[68:71], v[104:107]
    v_mfma_f32_16x16x32_bf16 v[104:107], v[68:71], a[84:87], v[104:107]
    v_mfma_f32_16x16x32_bf16 v[108:111], v[72:75], a[68:71], v[108:111]
    v_mfma_f32_16x16x32_bf16 v[108:111], v[76:79], a[84:87], v[108:111]
    v_mfma_f32_16x16x32_bf16 v[112:115], v[64:67], a[72:75], v[112:115]
    s_add_u32 m0, s35, 12288
    s_add_u32 s33, s33, 131072
    buffer_load_dwordx4 v234, s[48:51], s33 offen lds
    v_mfma_f32_16x16x32_bf16 v[112:115], v[68:71], a[88:91], v[112:115]
    v_mfma_f32_16x16x32_bf16 v[116:119], v[72:75], a[72:75], v[116:119]
    buffer_load_dwordx4 v235, s[48:51], s33 offen offset:1024 lds
    v_mfma_f32_16x16x32_bf16 v[116:119], v[76:79], a[88:91], v[116:119]
    v_mfma_f32_16x16x32_bf16 v[120:123], v[64:67], a[76:79], v[120:123]
    s_add_u32 m0, s35, 14336
    s_add_u32 s33, s33, 131072
    buffer_load_dwordx4 v234, s[48:51], s33 offen lds
    v_mfma_f32_16x16x32_bf16 v[120:123], v[68:71], a[92:95], v[120:123]
    v_mfma_f32_16x16x32_bf16 v[124:127], v[72:75], a[76:79], v[124:127]
    buffer_load_dwordx4 v235, s[48:51], s33 offen offset:1024 lds
    v_mfma_f32_16x16x32_bf16 v[124:127], v[76:79], a[92:95], v[124:127]
    s_waitcnt lgkmcnt(0)
    v_mfma_f32_16x16x32_bf16 v[128:131], v[80:83], a[64:67], v[128:131]
    ds_read_b128 v[64:67], v224 offset:40960
    v_mfma_f32_16x16x32_bf16 v[128:131], v[84:87], a[80:83], v[128:131]
    ds_read_b128 v[68:71], v225 offset:40960
    v_mfma_f32_16x16x32_bf16 v[132:135], v[88:91], a[64:67], v[132:135]
    ds_read_b128 v[72:75], v224 offset:43008
    v_mfma_f32_16x16x32_bf16 v[132:135], v[92:95], a[80:83], v[132:135]
    ds_read_b128 v[76:79], v225 offset:43008
    v_mfma_f32_16x16x32_bf16 v[136:139], v[80:83], a[68:71], v[136:139]
    v_mfma_f32_16x16x32_bf16 v[136:139], v[84:87], a[84:87], v[136:139]
    v_mfma_f32_16x16x32_bf16 v[140:143], v[88:91], a[68:71], v[140:143]
    v_mfma_f32_16x16x32_bf16 v[140:143], v[92:95], a[84:87], v[140:143]
    v_mfma_f32_16x16x32_bf16 v[144:147], v[80:83], a[72:75], v[144:147]
    s_add_u32 m0, s34, 24576
    s_add_u32 s37, s85, 65536
    buffer_load_dwordx4 v232, s[44:47], s37 offen lds
    v_mfma_f32_16x16x32_bf16 v[144:147], v[84:87], a[88:91], v[144:147]
    v_mfma_f32_16x16x32_bf16 v[148:151], v[88:91], a[72:75], v[148:151]
    v_mfma_f32_16x16x32_bf16 v[148:151], v[92:95], a[88:91], v[148:151]
    v_mfma_f32_16x16x32_bf16 v[152:155], v[80:83], a[76:79], v[152:155]
    buffer_load_dwordx4 v233, s[44:47], s37 offen offset:1024 lds
    v_mfma_f32_16x16x32_bf16 v[152:155], v[84:87], a[92:95], v[152:155]
    v_mfma_f32_16x16x32_bf16 v[156:159], v[88:91], a[76:79], v[156:159]
    v_mfma_f32_16x16x32_bf16 v[156:159], v[92:95], a[92:95], v[156:159]
    s_waitcnt vmcnt(14) lgkmcnt(0)
    v_mfma_f32_16x16x32_bf16 v[160:163], v[64:67], a[64:67], v[160:163]
    ds_read_b128 v[80:83], v224 offset:45056
    s_waitcnt vmcnt(18)
    v_mfma_f32_16x16x32_bf16 v[160:163], v[68:71], a[80:83], v[160:163]
    ds_read_b128 v[84:87], v225 offset:45056
    v_lshlrev_b32_e64 v16, 16, v0
    v_mfma_f32_16x16x32_bf16 v[164:167], v[72:75], a[64:67], v[164:167]
    ds_read_b128 v[88:91], v224 offset:47104
    v_and_b32 v17, 0xffff0000, v0
    v_lshlrev_b32_e64 v18, 16, v1
    v_mfma_f32_16x16x32_bf16 v[164:167], v[76:79], a[80:83], v[164:167]
    ds_read_b128 v[92:95], v225 offset:47104
    v_and_b32 v19, 0xffff0000, v1
    v_mfma_f32_16x16x32_bf16 v[168:171], v[64:67], a[68:71], v[168:171]
    ds_read_b64_tr_b16 a[96:97], v228 offset:0
    v_lshlrev_b32_e64 v20, 16, v2
    v_mfma_f32_16x16x32_bf16 v[168:171], v[68:71], a[84:87], v[168:171]
    ds_read_b64_tr_b16 a[98:99], v228 offset:512
    v_and_b32 v21, 0xffff0000, v2
    v_mfma_f32_16x16x32_bf16 v[172:175], v[72:75], a[68:71], v[172:175]
    ds_read_b64_tr_b16 a[100:101], v229 offset:0
    v_lshlrev_b32_e64 v22, 16, v3
    v_mfma_f32_16x16x32_bf16 v[172:175], v[76:79], a[84:87], v[172:175]
    ds_read_b64_tr_b16 a[102:103], v229 offset:512
    v_and_b32 v23, 0xffff0000, v3
    v_mfma_f32_16x16x32_bf16 v[176:179], v[64:67], a[72:75], v[176:179]
    ds_read_b64_tr_b16 a[104:105], v230 offset:0
    s_add_u32 m0, s35, 16384
    s_and_b32 s33, s85, 1023
    s_lshl_b32 s33, s33, 12
    buffer_load_dwordx4 v234, s[48:51], s33 offen lds
    v_mfma_f32_16x16x32_bf16 v[176:179], v[68:71], a[88:91], v[176:179]
    ds_read_b64_tr_b16 a[106:107], v230 offset:512
    buffer_load_dwordx4 v235, s[48:51], s33 offen offset:1024 lds
    v_mfma_f32_16x16x32_bf16 v[180:183], v[72:75], a[72:75], v[180:183]
    ds_read_b64_tr_b16 a[108:109], v231 offset:0
    s_add_u32 m0, s35, 18432
    s_add_u32 s33, s33, 131072
    buffer_load_dwordx4 v234, s[48:51], s33 offen lds
    v_mfma_f32_16x16x32_bf16 v[180:183], v[76:79], a[88:91], v[180:183]
    ds_read_b64_tr_b16 a[110:111], v231 offset:512
    v_lshlrev_b32 v24, 16, v4
    v_and_b32 v25, 0xffff0000, v4
    v_mfma_f32_16x16x32_bf16 v[184:187], v[64:67], a[76:79], v[184:187]
    buffer_load_dwordx4 v235, s[48:51], s33 offen offset:1024 lds
    v_lshlrev_b32_e64 v26, 16, v5
    v_mfma_f32_16x16x32_bf16 v[184:187], v[68:71], a[92:95], v[184:187]
    s_lshl2_add_u32 s26, s4, s3
    s_lshl_b32 s26, s26, 10
    s_add_u32 s26, s26, s32
    s_add_u32 s26, s26, 131072
    v_mfma_f32_16x16x32_bf16 v[188:191], v[72:75], a[76:79], v[188:191]
    v_and_b32 v226, 0x40000380, v251
    buffer_load_dword v241, v226, s[44:47], s26 offen
    v_mfma_f32_16x16x32_bf16 v[188:191], v[76:79], a[92:95], v[188:191]
    s_waitcnt vmcnt(29) lgkmcnt(0)
    s_barrier
    v_mfma_f32_16x16x32_bf16 v[192:195], v[80:83], a[64:67], v[192:195]
    ds_read_b128 v[64:67], v224 offset:49152
    v_and_b32 v27, 0xffff0000, v5
    v_mfma_f32_16x16x32_bf16 v[192:195], v[84:87], a[80:83], v[192:195]
    ds_read_b128 v[68:71], v225 offset:49152
    v_lshlrev_b32 v28, 16, v6
    v_mfma_f32_16x16x32_bf16 v[196:199], v[88:91], a[64:67], v[196:199]
    ds_read_b128 v[72:75], v224 offset:51200
    v_and_b32 v29, 0xffff0000, v6
    v_mfma_f32_16x16x32_bf16 v[196:199], v[92:95], a[80:83], v[196:199]
    ds_read_b128 v[76:79], v225 offset:51200
    v_lshlrev_b32_e64 v30, 16, v7
    v_and_b32 v31, 0xffff0000, v7
    v_mfma_f32_16x16x32_bf16 v[200:203], v[80:83], a[68:71], v[200:203]
    ds_read_b64_tr_b16 a[112:113], v228 offset:4096
    v_lshlrev_b32_e64 v32, 16, v8
    v_mfma_f32_16x16x32_bf16 v[200:203], v[84:87], a[84:87], v[200:203]
    ds_read_b64_tr_b16 a[114:115], v228 offset:4608
    v_and_b32 v33, 0xffff0000, v8
    v_mfma_f32_16x16x32_bf16 v[204:207], v[88:91], a[68:71], v[204:207]
    ds_read_b64_tr_b16 a[116:117], v229 offset:4096
    v_lshlrev_b32_e64 v34, 16, v9
    v_mfma_f32_16x16x32_bf16 v[204:207], v[92:95], a[84:87], v[204:207]
    ds_read_b64_tr_b16 a[118:119], v229 offset:4608
    v_and_b32 v35, 0xffff0000, v9
    v_mfma_f32_16x16x32_bf16 v[208:211], v[80:83], a[72:75], v[208:211]
    ds_read_b64_tr_b16 a[120:121], v230 offset:4096
    s_add_u32 m0, s34, 32768
    s_add_u32 s37, s86, 0
    buffer_load_dwordx4 v232, s[44:47], s37 offen lds
    v_mfma_f32_16x16x32_bf16 v[208:211], v[84:87], a[88:91], v[208:211]
    ds_read_b64_tr_b16 a[122:123], v230 offset:4608
    v_lshlrev_b32 v36, 16, v10
    v_mfma_f32_16x16x32_bf16 v[212:215], v[88:91], a[72:75], v[212:215]
    ds_read_b64_tr_b16 a[124:125], v231 offset:4096
    v_and_b32 v37, 0xffff0000, v10
    v_lshlrev_b32_e64 v38, 16, v11
    v_mfma_f32_16x16x32_bf16 v[212:215], v[92:95], a[88:91], v[212:215]
    ds_read_b64_tr_b16 a[126:127], v231 offset:4608
    v_and_b32 v39, 0xffff0000, v11
    v_mfma_f32_16x16x32_bf16 v[216:219], v[80:83], a[76:79], v[216:219]
    buffer_load_dwordx4 v233, s[44:47], s37 offen offset:1024 lds
    v_lshlrev_b32_e64 v40, 16, v12
    v_mfma_f32_16x16x32_bf16 v[216:219], v[84:87], a[92:95], v[216:219]
    v_and_b32 v41, 0xffff0000, v12
    v_lshlrev_b32_e64 v42, 16, v13
    v_mfma_f32_16x16x32_bf16 v[220:223], v[88:91], a[76:79], v[220:223]
    v_and_b32 v43, 0xffff0000, v13
    v_lshlrev_b32_e64 v44, 16, v14
    v_and_b32 v45, 0xffff0000, v14
    v_mfma_f32_16x16x32_bf16 v[220:223], v[92:95], a[92:95], v[220:223]
    v_lshlrev_b32 v46, 16, v15
    s_waitcnt lgkmcnt(0)
    v_mfma_f32_16x16x32_bf16 v[96:99], v[64:67], a[96:99], v[96:99]
    ds_read_b128 v[80:83], v224 offset:53248
    v_and_b32 v47, 0xffff0000, v15
    v_mfma_f32_16x16x32_bf16 v[96:99], v[68:71], a[112:115], v[96:99]
    ds_read_b128 v[84:87], v225 offset:53248
    v_add_f32_e64 v52, v16, v20
    v_mfma_f32_16x16x32_bf16 v[100:103], v[72:75], a[96:99], v[100:103]
    ds_read_b128 v[88:91], v224 offset:55296
    v_add_f32_e64 v53, v17, v21
    v_mfma_f32_16x16x32_bf16 v[100:103], v[76:79], a[112:115], v[100:103]
    ds_read_b128 v[92:95], v225 offset:55296
    v_add_f32 v54, v18, v22
    v_add_f32 v55, v19, v23
    v_mfma_f32_16x16x32_bf16 v[104:107], v[64:67], a[100:103], v[104:107]
    v_add_f32 v52, v52, v24
    v_add_f32 v53, v53, v25
    v_mfma_f32_16x16x32_bf16 v[104:107], v[68:71], a[116:119], v[104:107]
    v_add_f32 v54, v54, v26
    v_add_f32 v55, v55, v27
    v_mfma_f32_16x16x32_bf16 v[108:111], v[72:75], a[100:103], v[108:111]
    v_add_f32 v52, v52, v28
    v_add_f32 v53, v53, v29
    v_add_f32_e64 v54, v54, v30
    v_mfma_f32_16x16x32_bf16 v[108:111], v[76:79], a[116:119], v[108:111]
    v_add_f32 v55, v55, v31
    v_add_f32 v52, v52, v32
    v_mfma_f32_16x16x32_bf16 v[112:115], v[64:67], a[104:107], v[112:115]
    s_add_u32 m0, s35, 20480
    s_add_u32 s33, s33, 131072
    buffer_load_dwordx4 v234, s[48:51], s33 offen lds
    v_mfma_f32_16x16x32_bf16 v[112:115], v[68:71], a[120:123], v[112:115]
    v_add_f32 v53, v53, v33
    v_add_f32 v54, v54, v34
    v_mfma_f32_16x16x32_bf16 v[116:119], v[72:75], a[104:107], v[116:119]
    buffer_load_dwordx4 v235, s[48:51], s33 offen offset:1024 lds
    v_add_f32 v55, v55, v35
    v_add_f32 v52, v52, v36
    v_mfma_f32_16x16x32_bf16 v[116:119], v[76:79], a[120:123], v[116:119]
    v_add_f32 v53, v53, v37
    v_add_f32 v54, v54, v38
    v_mfma_f32_16x16x32_bf16 v[120:123], v[64:67], a[108:111], v[120:123]
    s_add_u32 m0, s35, 22528
    s_add_u32 s33, s33, 131072
    buffer_load_dwordx4 v234, s[48:51], s33 offen lds
    v_mfma_f32_16x16x32_bf16 v[120:123], v[68:71], a[124:127], v[120:123]
    v_add_f32 v55, v55, v39
    v_add_f32 v52, v52, v40
    v_mfma_f32_16x16x32_bf16 v[124:127], v[72:75], a[108:111], v[124:127]
    buffer_load_dwordx4 v235, s[48:51], s33 offen offset:1024 lds
    v_add_f32 v53, v53, v41
    v_add_f32 v54, v54, v42
    v_mfma_f32_16x16x32_bf16 v[124:127], v[76:79], a[124:127], v[124:127]
    v_add_f32 v55, v55, v43
    s_waitcnt lgkmcnt(0)
    v_mfma_f32_16x16x32_bf16 v[128:131], v[80:83], a[96:99], v[128:131]
    ds_read_b128 v[64:67], v224 offset:57344
    v_add_f32_e64 v52, v52, v44
    v_mfma_f32_16x16x32_bf16 v[128:131], v[84:87], a[112:115], v[128:131]
    ds_read_b128 v[68:71], v225 offset:57344
    v_add_f32_e64 v53, v53, v45
    v_mfma_f32_16x16x32_bf16 v[132:135], v[88:91], a[96:99], v[132:135]
    ds_read_b128 v[72:75], v224 offset:59392
    v_add_f32_e64 v54, v54, v46
    v_mfma_f32_16x16x32_bf16 v[132:135], v[92:95], a[112:115], v[132:135]
    ds_read_b128 v[76:79], v225 offset:59392
    v_add_f32 v55, v55, v47
    v_add_f32 v52, v52, v53
    v_mfma_f32_16x16x32_bf16 v[136:139], v[80:83], a[100:103], v[136:139]
    v_add_f32 v54, v54, v55
    v_add_f32 v48, v52, v54
    v_mfma_f32_16x16x32_bf16 v[136:139], v[84:87], a[116:119], v[136:139]
    s_nop 1
    v_add_f32_dpp v48, v48, v48 quad_perm:[1,0,3,2] row_mask:0xf bank_mask:0xf
    v_mfma_f32_16x16x32_bf16 v[140:143], v[88:91], a[100:103], v[140:143]
    s_nop 1
    v_add_f32_dpp v48, v48, v48 quad_perm:[2,3,0,1] row_mask:0xf bank_mask:0xf
    s_nop 1
    v_mfma_f32_16x16x32_bf16 v[140:143], v[92:95], a[116:119], v[140:143]
    v_add_f32_dpp v48, v48, v48 row_half_mirror row_mask:0xf bank_mask:0xf
    s_nop 1
    v_mfma_f32_16x16x32_bf16 v[144:147], v[80:83], a[104:107], v[144:147]
    s_add_u32 m0, s34, 40960
    s_add_u32 s37, s86, 65536
    buffer_load_dwordx4 v232, s[44:47], s37 offen lds
    v_mfma_f32_16x16x32_bf16 v[144:147], v[84:87], a[120:123], v[144:147]
    v_add_f32_dpp v48, v48, v48 row_mirror row_mask:0xf bank_mask:0xf
    s_nop 0
    v_mfma_f32_16x16x32_bf16 v[148:151], v[88:91], a[104:107], v[148:151]
    buffer_load_dwordx4 v233, s[44:47], s37 offen offset:1024 lds
    v_mov_b32_e64 v49, v48
    s_nop 1
    v_mfma_f32_16x16x32_bf16 v[148:151], v[92:95], a[120:123], v[148:151]
    v_permlane16_swap_b32 v48, v49
    s_nop 0
    v_mfma_f32_16x16x32_bf16 v[152:155], v[80:83], a[108:111], v[152:155]
    v_lshlrev_b32_e64 v227, 3, v240
    v_min_u32 v227, 1920, v227
    s_lshl2_add_u32 s25, s2, s3
    v_mfma_f32_16x16x32_bf16 v[152:155], v[84:87], a[124:127], v[152:155]
    v_add_f32 v48, v48, v49
    v_mul_f32 v48, 0x3a800000, v48
    v_mfma_f32_16x16x32_bf16 v[156:159], v[88:91], a[108:111], v[156:159]
    s_lshl_b32 s25, s25, 13
    s_add_u32 s25, s25, 0
    buffer_load_dword v241, v227, s[12:15], s25 offen
    v_mfma_f32_16x16x32_bf16 v[156:159], v[92:95], a[124:127], v[156:159]
    v_sub_f32 v56, v16, v48
    s_waitcnt vmcnt(16) lgkmcnt(0)
    v_mfma_f32_16x16x32_bf16 v[160:163], v[64:67], a[96:99], v[160:163]
    ds_read_b128 v[80:83], v224 offset:61440
    v_mul_f32 v52, v56, v56
    v_sub_f32 v57, v17, v48
    v_mfma_f32_16x16x32_bf16 v[160:163], v[68:71], a[112:115], v[160:163]
    ds_read_b128 v[84:87], v225 offset:61440
    v_mul_f32_e64 v53, v57, v57
    v_mfma_f32_16x16x32_bf16 v[164:167], v[72:75], a[96:99], v[164:167]
    ds_read_b128 v[88:91], v224 offset:63488
    v_sub_f32_e64 v58, v18, v48
    v_mfma_f32_16x16x32_bf16 v[164:167], v[76:79], a[112:115], v[164:167]
    ds_read_b128 v[92:95], v225 offset:63488
    v_mul_f32_e64 v54, v58, v58
    v_mfma_f32_16x16x32_bf16 v[168:171], v[64:67], a[100:103], v[168:171]
    ds_read_b64_tr_b16 a[128:129], v228 offset:8192
    v_sub_f32_e64 v59, v19, v48
    v_mfma_f32_16x16x32_bf16 v[168:171], v[68:71], a[116:119], v[168:171]
    ds_read_b64_tr_b16 a[130:131], v228 offset:8704
    v_mul_f32 v55, v59, v59
    v_sub_f32 v56, v20, v48
    v_mfma_f32_16x16x32_bf16 v[172:175], v[72:75], a[100:103], v[172:175]
    ds_read_b64_tr_b16 a[132:133], v229 offset:8192
    v_fmac_f32_e64 v52, v56, v56
    v_mfma_f32_16x16x32_bf16 v[172:175], v[76:79], a[116:119], v[172:175]
    ds_read_b64_tr_b16 a[134:135], v229 offset:8704
    v_sub_f32_e64 v57, v21, v48
    v_mfma_f32_16x16x32_bf16 v[176:179], v[64:67], a[104:107], v[176:179]
    ds_read_b64_tr_b16 a[136:137], v230 offset:8192
    s_add_u32 m0, s35, 0
    s_and_b32 s33, s86, 1023
    s_lshl_b32 s33, s33, 12
    buffer_load_dwordx4 v234, s[48:51], s33 offen lds
    v_mfma_f32_16x16x32_bf16 v[176:179], v[68:71], a[120:123], v[176:179]
    ds_read_b64_tr_b16 a[138:139], v230 offset:8704
    v_fmac_f32_e64 v53, v57, v57
    v_mfma_f32_16x16x32_bf16 v[180:183], v[72:75], a[104:107], v[180:183]
    ds_read_b64_tr_b16 a[140:141], v231 offset:8192
    buffer_load_dwordx4 v235, s[48:51], s33 offen offset:1024 lds
    v_mfma_f32_16x16x32_bf16 v[180:183], v[76:79], a[120:123], v[180:183]
    ds_read_b64_tr_b16 a[142:143], v231 offset:8704
    v_sub_f32_e64 v58, v22, v48
    v_mfma_f32_16x16x32_bf16 v[184:187], v[64:67], a[108:111], v[184:187]
    s_add_u32 m0, s35, 2048
    s_add_u32 s33, s33, 131072
    buffer_load_dwordx4 v234, s[48:51], s33 offen lds
    v_mfma_f32_16x16x32_bf16 v[184:187], v[68:71], a[124:127], v[184:187]
    v_fmac_f32 v54, v58, v58
    v_sub_f32 v59, v23, v48
    v_fmac_f32_e64 v55, v59, v59
    v_mfma_f32_16x16x32_bf16 v[188:191], v[72:75], a[108:111], v[188:191]
    buffer_load_dwordx4 v235, s[48:51], s33 offen offset:1024 lds
    v_sub_f32_e64 v56, v24, v48
    v_mfma_f32_16x16x32_bf16 v[188:191], v[76:79], a[124:127], v[188:191]
    s_waitcnt vmcnt(30) lgkmcnt(0)
    s_barrier
    v_mfma_f32_16x16x32_bf16 v[192:195], v[80:83], a[96:99], v[192:195]
    ds_read_b128 v[64:67], v224 offset:0
    v_fmac_f32_e64 v52, v56, v56
    v_mfma_f32_16x16x32_bf16 v[192:195], v[84:87], a[112:115], v[192:195]
    ds_read_b128 v[68:71], v225 offset:0
    v_sub_f32_e64 v57, v25, v48
    v_mfma_f32_16x16x32_bf16 v[196:199], v[88:91], a[96:99], v[196:199]
    ds_read_b128 v[72:75], v224 offset:2048
    v_fmac_f32_e64 v53, v57, v57
    v_mfma_f32_16x16x32_bf16 v[196:199], v[92:95], a[112:115], v[196:199]
    ds_read_b128 v[76:79], v225 offset:2048
    v_sub_f32 v58, v26, v48
    v_fmac_f32 v54, v58, v58
    v_mfma_f32_16x16x32_bf16 v[200:203], v[80:83], a[100:103], v[200:203]
    ds_read_b64_tr_b16 a[144:145], v228 offset:12288
    v_sub_f32_e64 v59, v27, v48
    v_mfma_f32_16x16x32_bf16 v[200:203], v[84:87], a[116:119], v[200:203]
    ds_read_b64_tr_b16 a[146:147], v228 offset:12800
    v_fmac_f32_e64 v55, v59, v59
    v_mfma_f32_16x16x32_bf16 v[204:207], v[88:91], a[100:103], v[204:207]
    ds_read_b64_tr_b16 a[148:149], v229 offset:12288
    v_sub_f32_e64 v56, v28, v48
    v_mfma_f32_16x16x32_bf16 v[204:207], v[92:95], a[116:119], v[204:207]
    ds_read_b64_tr_b16 a[150:151], v229 offset:12800
    v_fmac_f32_e64 v52, v56, v56
    v_mfma_f32_16x16x32_bf16 v[208:211], v[80:83], a[104:107], v[208:211]
    ds_read_b64_tr_b16 a[152:153], v230 offset:12288
    s_add_u32 m0, s34, 49152
    s_add_u32 s37, s87, 0
    buffer_load_dwordx4 v232, s[44:47], s37 offen lds
    v_mfma_f32_16x16x32_bf16 v[208:211], v[84:87], a[120:123], v[208:211]
    ds_read_b64_tr_b16 a[154:155], v230 offset:12800
    v_sub_f32 v57, v29, v48
    v_mfma_f32_16x16x32_bf16 v[212:215], v[88:91], a[104:107], v[212:215]
    ds_read_b64_tr_b16 a[156:157], v231 offset:12288
    v_fmac_f32 v53, v57, v57
    v_sub_f32 v58, v30, v48
    v_mfma_f32_16x16x32_bf16 v[212:215], v[92:95], a[120:123], v[212:215]
    ds_read_b64_tr_b16 a[158:159], v231 offset:12800
    v_fmac_f32_e64 v54, v58, v58
    v_mfma_f32_16x16x32_bf16 v[216:219], v[80:83], a[108:111], v[216:219]
    buffer_load_dwordx4 v233, s[44:47], s37 offen offset:1024 lds
    v_sub_f32_e64 v59, v31, v48
    v_mfma_f32_16x16x32_bf16 v[216:219], v[84:87], a[124:127], v[216:219]
    v_fmac_f32 v55, v59, v59
    v_sub_f32 v56, v32, v48
    v_mfma_f32_16x16x32_bf16 v[220:223], v[88:91], a[108:111], v[220:223]
    v_fmac_f32 v52, v56, v56
    v_sub_f32 v57, v33, v48
    v_fmac_f32_e64 v53, v57, v57
    v_mfma_f32_16x16x32_bf16 v[220:223], v[92:95], a[124:127], v[220:223]
    v_sub_f32 v58, v34, v48
    s_waitcnt lgkmcnt(0)
    v_mfma_f32_16x16x32_bf16 v[96:99], v[64:67], a[128:131], v[96:99]
    ds_read_b128 v[80:83], v224 offset:4096
    v_fmac_f32_e64 v54, v58, v58
    v_mfma_f32_16x16x32_bf16 v[96:99], v[68:71], a[144:147], v[96:99]
    ds_read_b128 v[84:87], v225 offset:4096
    v_sub_f32_e64 v59, v35, v48
    v_mfma_f32_16x16x32_bf16 v[100:103], v[72:75], a[128:131], v[100:103]
    ds_read_b128 v[88:91], v224 offset:6144
    v_fmac_f32_e64 v55, v59, v59
    v_mfma_f32_16x16x32_bf16 v[100:103], v[76:79], a[144:147], v[100:103]
    ds_read_b128 v[92:95], v225 offset:6144
    v_sub_f32 v56, v36, v48
    v_fmac_f32 v52, v56, v56
    v_mfma_f32_16x16x32_bf16 v[104:107], v[64:67], a[132:135], v[104:107]
    v_sub_f32 v57, v37, v48
    v_fmac_f32 v53, v57, v57
    v_mfma_f32_16x16x32_bf16 v[104:107], v[68:71], a[148:151], v[104:107]
    v_sub_f32 v58, v38, v48
    v_fmac_f32 v54, v58, v58
    v_mfma_f32_16x16x32_bf16 v[108:111], v[72:75], a[132:135], v[108:111]
    v_sub_f32 v59, v39, v48
    v_fmac_f32 v55, v59, v59
    v_sub_f32_e64 v56, v40, v48
    v_mfma_f32_16x16x32_bf16 v[108:111], v[76:79], a[148:151], v[108:111]
    v_fmac_f32 v52, v56, v56
    v_sub_f32 v57, v41, v48
    v_mfma_f32_16x16x32_bf16 v[112:115], v[64:67], a[136:139], v[112:115]
    s_add_u32 m0, s35, 4096
    s_add_u32 s33, s33, 131072
    buffer_load_dwordx4 v234, s[48:51], s33 offen lds
    v_mfma_f32_16x16x32_bf16 v[112:115], v[68:71], a[152:155], v[112:115]
    v_fmac_f32 v53, v57, v57
    v_sub_f32 v58, v42, v48
    v_mfma_f32_16x16x32_bf16 v[116:119], v[72:75], a[136:139], v[116:119]
    buffer_load_dwordx4 v235, s[48:51], s33 offen offset:1024 lds
    v_fmac_f32 v54, v58, v58
    v_sub_f32 v59, v43, v48
    v_mfma_f32_16x16x32_bf16 v[116:119], v[76:79], a[152:155], v[116:119]
    v_fmac_f32 v55, v59, v59
    v_sub_f32 v56, v44, v48
    v_mfma_f32_16x16x32_bf16 v[120:123], v[64:67], a[140:143], v[120:123]
    s_add_u32 m0, s35, 6144
    s_add_u32 s33, s33, 131072
    buffer_load_dwordx4 v234, s[48:51], s33 offen lds
    v_mfma_f32_16x16x32_bf16 v[120:123], v[68:71], a[156:159], v[120:123]
    v_fmac_f32 v52, v56, v56
    v_sub_f32 v57, v45, v48
    v_mfma_f32_16x16x32_bf16 v[124:127], v[72:75], a[140:143], v[124:127]
    buffer_load_dwordx4 v235, s[48:51], s33 offen offset:1024 lds
    v_fmac_f32 v53, v57, v57
    v_sub_f32 v58, v46, v48
    v_mfma_f32_16x16x32_bf16 v[124:127], v[76:79], a[156:159], v[124:127]
    v_fmac_f32 v54, v58, v58
    s_waitcnt lgkmcnt(0)
    v_mfma_f32_16x16x32_bf16 v[128:131], v[80:83], a[128:131], v[128:131]
    ds_read_b128 v[64:67], v224 offset:8192
    v_sub_f32_e64 v59, v47, v48
    v_mfma_f32_16x16x32_bf16 v[128:131], v[84:87], a[144:147], v[128:131]
    ds_read_b128 v[68:71], v225 offset:8192
    v_fmac_f32_e64 v55, v59, v59
    v_mfma_f32_16x16x32_bf16 v[132:135], v[88:91], a[128:131], v[132:135]
    ds_read_b128 v[72:75], v224 offset:10240
    v_add_f32_e64 v52, v52, v53
    v_mfma_f32_16x16x32_bf16 v[132:135], v[92:95], a[144:147], v[132:135]
    ds_read_b128 v[76:79], v225 offset:10240
    v_add_f32_e64 v54, v54, v55
    v_mfma_f32_16x16x32_bf16 v[136:139], v[80:83], a[132:135], v[136:139]
    v_add_f32 v51, v52, v54
    s_nop 1
    v_add_f32_dpp v51, v51, v51 quad_perm:[1,0,3,2] row_mask:0xf bank_mask:0xf
    v_mfma_f32_16x16x32_bf16 v[136:139], v[84:87], a[148:151], v[136:139]
    s_nop 1
    v_add_f32_dpp v51, v51, v51 quad_perm:[2,3,0,1] row_mask:0xf bank_mask:0xf
    v_mfma_f32_16x16x32_bf16 v[140:143], v[88:91], a[132:135], v[140:143]
    s_nop 1
    v_add_f32_dpp v51, v51, v51 row_half_mirror row_mask:0xf bank_mask:0xf
    s_nop 1
    v_mfma_f32_16x16x32_bf16 v[140:143], v[92:95], a[148:151], v[140:143]
    v_add_f32_dpp v51, v51, v51 row_mirror row_mask:0xf bank_mask:0xf
    s_nop 0
    v_mfma_f32_16x16x32_bf16 v[144:147], v[80:83], a[136:139], v[144:147]
    s_add_u32 m0, s34, 57344
    s_add_u32 s37, s87, 65536
    buffer_load_dwordx4 v232, s[44:47], s37 offen lds
    v_mfma_f32_16x16x32_bf16 v[144:147], v[84:87], a[152:155], v[144:147]
    v_mov_b32 v49, v51
    s_nop 1
    v_mfma_f32_16x16x32_bf16 v[148:151], v[88:91], a[136:139], v[148:151]
    buffer_load_dwordx4 v233, s[44:47], s37 offen offset:1024 lds
    v_permlane16_swap_b32 v51, v49
    s_nop 0
    v_mfma_f32_16x16x32_bf16 v[148:151], v[92:95], a[152:155], v[148:151]
    v_add_f32_e64 v51, v51, v49
    v_mul_f32 v51, 0x3a800000, v51
    v_mfma_f32_16x16x32_bf16 v[152:155], v[80:83], a[140:143], v[152:155]
    v_lshlrev_b32_e64 v227, 3, v240
    v_min_u32 v227, 1920, v227
    s_lshl2_add_u32 s25, s2, s3
    v_mfma_f32_16x16x32_bf16 v[152:155], v[84:87], a[156:159], v[152:155]
    v_cvt_pk_bf16_f32 v50, v48, v51
    v_and_b32 v51, 0xffff0000, v50
    v_mfma_f32_16x16x32_bf16 v[156:159], v[88:91], a[140:143], v[156:159]
    s_lshl_b32 s25, s25, 13
    s_add_u32 s25, s25, 2048
    buffer_load_dword v241, v227, s[12:15], s25 offen
    v_mfma_f32_16x16x32_bf16 v[156:159], v[92:95], a[156:159], v[156:159]
    v_lshlrev_b32 v50, 16, v50
    s_waitcnt vmcnt(16) lgkmcnt(0)
    v_mfma_f32_16x16x32_bf16 v[160:163], v[64:67], a[128:131], v[160:163]
    ds_read_b128 v[80:83], v224 offset:12288
    v_add_f32 v51, 0x3727c5ac, v51
    v_cvt_pk_bf16_f32 v51, v51, v51
    v_mfma_f32_16x16x32_bf16 v[160:163], v[68:71], a[144:147], v[160:163]
    ds_read_b128 v[84:87], v225 offset:12288
    v_lshlrev_b32_e64 v51, 16, v51
    v_mfma_f32_16x16x32_bf16 v[164:167], v[72:75], a[128:131], v[164:167]
    ds_read_b128 v[88:91], v224 offset:14336
    v_mfma_f32_16x16x32_bf16 v[164:167], v[76:79], a[144:147], v[164:167]
    ds_read_b128 v[92:95], v225 offset:14336
    v_sqrt_f32 v51, v51
    v_mfma_f32_16x16x32_bf16 v[168:171], v[64:67], a[132:135], v[168:171]
    ds_read_b64_tr_b16 a[160:161], v228 offset:16384
    s_nop 0
    v_mfma_f32_16x16x32_bf16 v[168:171], v[68:71], a[148:151], v[168:171]
    ds_read_b64_tr_b16 a[162:163], v228 offset:16896
    v_cvt_pk_bf16_f32 v51, v51, v51
    v_lshlrev_b32_e64 v51, 16, v51
    v_mfma_f32_16x16x32_bf16 v[172:175], v[72:75], a[132:135], v[172:175]
    ds_read_b64_tr_b16 a[164:165], v229 offset:16384
    v_mfma_f32_16x16x32_bf16 v[172:175], v[76:79], a[148:151], v[172:175]
    ds_read_b64_tr_b16 a[166:167], v229 offset:16896
    v_rcp_f32_e64 v51, v51
    v_mfma_f32_16x16x32_bf16 v[176:179], v[64:67], a[136:139], v[176:179]
    ds_read_b64_tr_b16 a[168:169], v230 offset:16384
    s_add_u32 m0, s35, 8192
    s_and_b32 s33, s87, 1023
    s_lshl_b32 s33, s33, 12
    buffer_load_dwordx4 v234, s[48:51], s33 offen lds
    v_mfma_f32_16x16x32_bf16 v[176:179], v[68:71], a[152:155], v[176:179]
    ds_read_b64_tr_b16 a[170:171], v230 offset:16896
    s_nop 0
    v_mfma_f32_16x16x32_bf16 v[180:183], v[72:75], a[136:139], v[180:183]
    ds_read_b64_tr_b16 a[172:173], v231 offset:16384
    buffer_load_dwordx4 v235, s[48:51], s33 offen offset:1024 lds
    v_mfma_f32_16x16x32_bf16 v[180:183], v[76:79], a[152:155], v[180:183]
    ds_read_b64_tr_b16 a[174:175], v231 offset:16896
    v_mul_f32 v51, 0x3e0293ee, v51
    v_mfma_f32_16x16x32_bf16 v[184:187], v[64:67], a[140:143], v[184:187]
    s_add_u32 m0, s35, 10240
    s_add_u32 s33, s33, 131072
    buffer_load_dwordx4 v234, s[48:51], s33 offen lds
    v_mfma_f32_16x16x32_bf16 v[184:187], v[68:71], a[156:159], v[184:187]
    v_sub_f32 v16, v16, v50
    v_sub_f32 v17, v17, v50
    v_cvt_pk_bf16_f32 v17, v16, v17
    v_mfma_f32_16x16x32_bf16 v[188:191], v[72:75], a[140:143], v[188:191]
    buffer_load_dwordx4 v235, s[48:51], s33 offen offset:1024 lds
    v_lshlrev_b32_e64 v16, 16, v17
    v_mfma_f32_16x16x32_bf16 v[188:191], v[76:79], a[156:159], v[188:191]
    s_waitcnt vmcnt(31) lgkmcnt(0)
    s_barrier
    v_mfma_f32_16x16x32_bf16 v[192:195], v[80:83], a[128:131], v[192:195]
    ds_read_b128 v[64:67], v224 offset:16384
    v_and_b32 v17, 0xffff0000, v17
    v_mfma_f32_16x16x32_bf16 v[192:195], v[84:87], a[144:147], v[192:195]
    ds_read_b128 v[68:71], v225 offset:16384
    v_mul_f32_e64 v16, v16, v51
    v_mfma_f32_16x16x32_bf16 v[196:199], v[88:91], a[128:131], v[196:199]
    ds_read_b128 v[72:75], v224 offset:18432
    v_mul_f32_e64 v17, v17, v51
    v_mfma_f32_16x16x32_bf16 v[196:199], v[92:95], a[144:147], v[196:199]
    ds_read_b128 v[76:79], v225 offset:18432
    v_cvt_pk_bf16_f32 v0, v16, v17
    v_sub_f32_e64 v18, v18, v50
    v_mfma_f32_16x16x32_bf16 v[200:203], v[80:83], a[132:135], v[200:203]
    ds_read_b64_tr_b16 a[176:177], v228 offset:20480
    v_sub_f32_e64 v19, v19, v50
    v_mfma_f32_16x16x32_bf16 v[200:203], v[84:87], a[148:151], v[200:203]
    ds_read_b64_tr_b16 a[178:179], v228 offset:20992
    v_cvt_pk_bf16_f32 v19, v18, v19
    v_mfma_f32_16x16x32_bf16 v[204:207], v[88:91], a[132:135], v[204:207]
    ds_read_b64_tr_b16 a[180:181], v229 offset:20480
    v_lshlrev_b32_e64 v18, 16, v19
    v_mfma_f32_16x16x32_bf16 v[204:207], v[92:95], a[148:151], v[204:207]
    ds_read_b64_tr_b16 a[182:183], v229 offset:20992
    v_and_b32 v19, 0xffff0000, v19
    v_mfma_f32_16x16x32_bf16 v[208:211], v[80:83], a[136:139], v[208:211]
    ds_read_b64_tr_b16 a[184:185], v230 offset:20480
    s_add_u32 m0, s34, 0
    s_add_u32 s37, s80, 131072
    buffer_load_dwordx4 v232, s[44:47], s37 offen lds
    v_mfma_f32_16x16x32_bf16 v[208:211], v[84:87], a[152:155], v[208:211]
    ds_read_b64_tr_b16 a[186:187], v230 offset:20992
    v_mul_f32 v18, v18, v51
    v_mfma_f32_16x16x32_bf16 v[212:215], v[88:91], a[136:139], v[212:215]
    ds_read_b64_tr_b16 a[188:189], v231 offset:20480
    v_mul_f32_e64 v19, v19, v51
    v_cvt_pk_bf16_f32 v1, v18, v19
    v_mfma_f32_16x16x32_bf16 v[212:215], v[92:95], a[152:155], v[212:215]
    ds_read_b64_tr_b16 a[190:191], v231 offset:20992
    v_sub_f32_e64 v20, v20, v50
    v_mfma_f32_16x16x32_bf16 v[216:219], v[80:83], a[140:143], v[216:219]
    buffer_load_dwordx4 v233, s[44:47], s37 offen offset:1024 lds
    v_sub_f32_e64 v21, v21, v50
    v_mfma_f32_16x16x32_bf16 v[216:219], v[84:87], a[156:159], v[216:219]
    v_cvt_pk_bf16_f32 v21, v20, v21
    v_lshlrev_b32_e64 v20, 16, v21
    v_mfma_f32_16x16x32_bf16 v[220:223], v[88:91], a[140:143], v[220:223]
    v_and_b32 v21, 0xffff0000, v21
    v_mul_f32 v20, v20, v51
    v_mul_f32 v21, v21, v51
    v_mfma_f32_16x16x32_bf16 v[220:223], v[92:95], a[156:159], v[220:223]
    v_cvt_pk_bf16_f32 v2, v20, v21
    s_waitcnt lgkmcnt(0)
    v_mfma_f32_16x16x32_bf16 v[96:99], v[64:67], a[160:163], v[96:99]
    ds_read_b128 v[80:83], v224 offset:20480
    v_sub_f32 v22, v22, v50
    v_mfma_f32_16x16x32_bf16 v[96:99], v[68:71], a[176:179], v[96:99]
    ds_read_b128 v[84:87], v225 offset:20480
    v_sub_f32_e64 v23, v23, v50
    v_mfma_f32_16x16x32_bf16 v[100:103], v[72:75], a[160:163], v[100:103]
    ds_read_b128 v[88:91], v224 offset:22528
    v_cvt_pk_bf16_f32 v23, v22, v23
    v_mfma_f32_16x16x32_bf16 v[100:103], v[76:79], a[176:179], v[100:103]
    ds_read_b128 v[92:95], v225 offset:22528
    v_lshlrev_b32_e64 v22, 16, v23
    v_and_b32 v23, 0xffff0000, v23
    v_mfma_f32_16x16x32_bf16 v[104:107], v[64:67], a[164:167], v[104:107]
    v_mul_f32 v22, v22, v51
    v_mul_f32 v23, v23, v51
    v_mfma_f32_16x16x32_bf16 v[104:107], v[68:71], a[180:183], v[104:107]
    v_cvt_pk_bf16_f32 v3, v22, v23
    v_sub_f32_e64 v24, v24, v50
    v_mfma_f32_16x16x32_bf16 v[108:111], v[72:75], a[164:167], v[108:111]
    v_sub_f32_e64 v25, v25, v50
    v_cvt_pk_bf16_f32 v25, v24, v25
    v_lshlrev_b32_e64 v24, 16, v25
    v_mfma_f32_16x16x32_bf16 v[108:111], v[76:79], a[180:183], v[108:111]
    v_and_b32 v25, 0xffff0000, v25
    v_mul_f32_e64 v24, v24, v51
    v_mfma_f32_16x16x32_bf16 v[112:115], v[64:67], a[168:171], v[112:115]
    s_add_u32 m0, s35, 12288
    s_add_u32 s33, s33, 131072
    buffer_load_dwordx4 v234, s[48:51], s33 offen lds
    v_mfma_f32_16x16x32_bf16 v[112:115], v[68:71], a[184:187], v[112:115]
    v_mul_f32_e64 v25, v25, v51
    v_cvt_pk_bf16_f32 v4, v24, v25
    v_mfma_f32_16x16x32_bf16 v[116:119], v[72:75], a[168:171], v[116:119]
    buffer_load_dwordx4 v235, s[48:51], s33 offen offset:1024 lds
    v_sub_f32 v26, v26, v50
    v_sub_f32 v27, v27, v50
    v_mfma_f32_16x16x32_bf16 v[116:119], v[76:79], a[184:187], v[116:119]
    v_cvt_pk_bf16_f32 v27, v26, v27
    v_lshlrev_b32_e64 v26, 16, v27
    v_mfma_f32_16x16x32_bf16 v[120:123], v[64:67], a[172:175], v[120:123]
    s_add_u32 m0, s35, 14336
    s_add_u32 s33, s33, 131072
    buffer_load_dwordx4 v234, s[48:51], s33 offen lds
    v_mfma_f32_16x16x32_bf16 v[120:123], v[68:71], a[188:191], v[120:123]
    v_and_b32 v27, 0xffff0000, v27
    v_mul_f32_e64 v26, v26, v51
    v_mfma_f32_16x16x32_bf16 v[124:127], v[72:75], a[172:175], v[124:127]
    buffer_load_dwordx4 v235, s[48:51], s33 offen offset:1024 lds
    v_mul_f32_e64 v27, v27, v51
    v_cvt_pk_bf16_f32 v5, v26, v27
    v_mfma_f32_16x16x32_bf16 v[124:127], v[76:79], a[188:191], v[124:127]
    v_sub_f32 v28, v28, v50
    s_waitcnt lgkmcnt(0)
    v_mfma_f32_16x16x32_bf16 v[128:131], v[80:83], a[160:163], v[128:131]
    ds_read_b128 v[64:67], v224 offset:24576
    v_sub_f32_e64 v29, v29, v50
    v_mfma_f32_16x16x32_bf16 v[128:131], v[84:87], a[176:179], v[128:131]
    ds_read_b128 v[68:71], v225 offset:24576
    v_cvt_pk_bf16_f32 v29, v28, v29
    v_mfma_f32_16x16x32_bf16 v[132:135], v[88:91], a[160:163], v[132:135]
    ds_read_b128 v[72:75], v224 offset:26624
    v_lshlrev_b32_e64 v28, 16, v29
    v_mfma_f32_16x16x32_bf16 v[132:135], v[92:95], a[176:179], v[132:135]
    ds_read_b128 v[76:79], v225 offset:26624
    v_and_b32 v29, 0xffff0000, v29
    v_mfma_f32_16x16x32_bf16 v[136:139], v[80:83], a[164:167], v[136:139]
    v_mul_f32 v28, v28, v51
    v_mul_f32 v29, v29, v51
    v_cvt_pk_bf16_f32 v6, v28, v29
    v_mfma_f32_16x16x32_bf16 v[136:139], v[84:87], a[180:183], v[136:139]
    v_sub_f32 v30, v30, v50
    v_sub_f32 v31, v31, v50
    v_mfma_f32_16x16x32_bf16 v[140:143], v[88:91], a[164:167], v[140:143]
    v_cvt_pk_bf16_f32 v31, v30, v31
    v_lshlrev_b32_e64 v30, 16, v31
    v_and_b32 v31, 0xffff0000, v31
    v_mfma_f32_16x16x32_bf16 v[140:143], v[92:95], a[180:183], v[140:143]
    v_mul_f32 v30, v30, v51
    v_mul_f32 v31, v31, v51
    v_mfma_f32_16x16x32_bf16 v[144:147], v[80:83], a[168:171], v[144:147]
    s_add_u32 m0, s34, 8192
    s_add_u32 s37, s81, 131072
    buffer_load_dwordx4 v232, s[44:47], s37 offen lds
    v_mfma_f32_16x16x32_bf16 v[144:147], v[84:87], a[184:187], v[144:147]
    v_cvt_pk_bf16_f32 v7, v30, v31
    v_sub_f32_e64 v32, v32, v50
    v_mfma_f32_16x16x32_bf16 v[148:151], v[88:91], a[168:171], v[148:151]
    buffer_load_dwordx4 v233, s[44:47], s37 offen offset:1024 lds
    v_sub_f32_e64 v33, v33, v50
    v_mfma_f32_16x16x32_bf16 v[148:151], v[92:95], a[184:187], v[148:151]
    v_cvt_pk_bf16_f32 v33, v32, v33
    v_lshlrev_b32_e64 v32, 16, v33
    v_and_b32 v33, 0xffff0000, v33
    v_mfma_f32_16x16x32_bf16 v[152:155], v[80:83], a[172:175], v[152:155]
    v_lshlrev_b32_e64 v227, 3, v240
    v_min_u32 v227, 1920, v227
    s_lshl2_add_u32 s25, s2, s3
    v_mfma_f32_16x16x32_bf16 v[152:155], v[84:87], a[188:191], v[152:155]
    v_mul_f32 v32, v32, v51
    v_mul_f32_e64 v33, v33, v51
    v_mfma_f32_16x16x32_bf16 v[156:159], v[88:91], a[172:175], v[156:159]
    s_lshl_b32 s25, s25, 13
    s_add_u32 s25, s25, 4096
    buffer_load_dword v241, v227, s[12:15], s25 offen
    v_mfma_f32_16x16x32_bf16 v[156:159], v[92:95], a[188:191], v[156:159]
    v_cvt_pk_bf16_f32 v8, v32, v33
    s_waitcnt vmcnt(16) lgkmcnt(0)
    v_mfma_f32_16x16x32_bf16 v[160:163], v[64:67], a[160:163], v[160:163]
    ds_read_b128 v[80:83], v224 offset:28672
    v_sub_f32 v34, v34, v50
    v_sub_f32 v35, v35, v50
    v_mfma_f32_16x16x32_bf16 v[160:163], v[68:71], a[176:179], v[160:163]
    ds_read_b128 v[84:87], v225 offset:28672
    v_cvt_pk_bf16_f32 v35, v34, v35
    v_mfma_f32_16x16x32_bf16 v[164:167], v[72:75], a[160:163], v[164:167]
    ds_read_b128 v[88:91], v224 offset:30720
    v_lshlrev_b32_e64 v34, 16, v35
    v_mfma_f32_16x16x32_bf16 v[164:167], v[76:79], a[176:179], v[164:167]
    ds_read_b128 v[92:95], v225 offset:30720
    v_and_b32 v35, 0xffff0000, v35
    v_mfma_f32_16x16x32_bf16 v[168:171], v[64:67], a[164:167], v[168:171]
    ds_read_b64_tr_b16 a[192:193], v228 offset:0
    v_mul_f32_e64 v34, v34, v51
    v_mfma_f32_16x16x32_bf16 v[168:171], v[68:71], a[180:183], v[168:171]
    ds_read_b64_tr_b16 a[194:195], v228 offset:512
    v_mul_f32_e64 v35, v35, v51
    v_cvt_pk_bf16_f32 v9, v34, v35
    v_mfma_f32_16x16x32_bf16 v[172:175], v[72:75], a[164:167], v[172:175]
    ds_read_b64_tr_b16 a[196:197], v229 offset:0
    v_sub_f32_e64 v36, v36, v50
    v_mfma_f32_16x16x32_bf16 v[172:175], v[76:79], a[180:183], v[172:175]
    ds_read_b64_tr_b16 a[198:199], v229 offset:512
    v_sub_f32_e64 v37, v37, v50
    v_mfma_f32_16x16x32_bf16 v[176:179], v[64:67], a[168:171], v[176:179]
    ds_read_b64_tr_b16 a[200:201], v230 offset:0
    v_cvt_pk_bf16_f32 v37, v36, v37
    v_mfma_f32_16x16x32_bf16 v[176:179], v[68:71], a[184:187], v[176:179]
    ds_read_b64_tr_b16 a[202:203], v230 offset:512
    v_lshlrev_b32_e64 v36, 16, v37
    v_mfma_f32_16x16x32_bf16 v[180:183], v[72:75], a[168:171], v[180:183]
    ds_read_b64_tr_b16 a[204:205], v231 offset:0
    v_and_b32 v37, 0xffff0000, v37
    v_mfma_f32_16x16x32_bf16 v[180:183], v[76:79], a[184:187], v[180:183]
    ds_read_b64_tr_b16 a[206:207], v231 offset:512
    v_mul_f32 v36, v36, v51
    v_mul_f32 v37, v37, v51
    v_mfma_f32_16x16x32_bf16 v[184:187], v[64:67], a[172:175], v[184:187]
    v_cvt_pk_bf16_f32 v10, v36, v37
    v_sub_f32_e64 v38, v38, v50
    v_mfma_f32_16x16x32_bf16 v[184:187], v[68:71], a[188:191], v[184:187]
    v_sub_f32_e64 v39, v39, v50
    v_cvt_pk_bf16_f32 v39, v38, v39
    v_mfma_f32_16x16x32_bf16 v[188:191], v[72:75], a[172:175], v[188:191]
    v_lshlrev_b32_e64 v38, 16, v39
    v_and_b32 v39, 0xffff0000, v39
    v_mul_f32_e64 v38, v38, v51
    v_mfma_f32_16x16x32_bf16 v[188:191], v[76:79], a[188:191], v[188:191]
    s_waitcnt vmcnt(27) lgkmcnt(0)
    s_barrier
    v_mfma_f32_16x16x32_bf16 v[192:195], v[80:83], a[160:163], v[192:195]
    ds_read_b128 v[64:67], v224 offset:32768
    v_mul_f32_e64 v39, v39, v51
    v_mfma_f32_16x16x32_bf16 v[192:195], v[84:87], a[176:179], v[192:195]
    ds_read_b128 v[68:71], v225 offset:32768
    v_cvt_pk_bf16_f32 v11, v38, v39
    v_mfma_f32_16x16x32_bf16 v[196:199], v[88:91], a[160:163], v[196:199]
    ds_read_b128 v[72:75], v224 offset:34816
    v_sub_f32_e64 v40, v40, v50
    v_mfma_f32_16x16x32_bf16 v[196:199], v[92:95], a[176:179], v[196:199]
    ds_read_b128 v[76:79], v225 offset:34816
    v_sub_f32_e64 v41, v41, v50
    v_mfma_f32_16x16x32_bf16 v[200:203], v[80:83], a[164:167], v[200:203]
    ds_read_b64_tr_b16 a[208:209], v228 offset:4096
    v_cvt_pk_bf16_f32 v41, v40, v41
    v_lshlrev_b32_e64 v40, 16, v41
    v_mfma_f32_16x16x32_bf16 v[200:203], v[84:87], a[180:183], v[200:203]
    ds_read_b64_tr_b16 a[210:211], v228 offset:4608
    v_and_b32 v41, 0xffff0000, v41
    v_mfma_f32_16x16x32_bf16 v[204:207], v[88:91], a[164:167], v[204:207]
    ds_read_b64_tr_b16 a[212:213], v229 offset:4096
    v_mul_f32_e64 v40, v40, v51
    v_mfma_f32_16x16x32_bf16 v[204:207], v[92:95], a[180:183], v[204:207]
    ds_read_b64_tr_b16 a[214:215], v229 offset:4608
    v_mul_f32_e64 v41, v41, v51
    v_mfma_f32_16x16x32_bf16 v[208:211], v[80:83], a[168:171], v[208:211]
    ds_read_b64_tr_b16 a[216:217], v230 offset:4096
    s_add_u32 m0, s34, 16384
    s_add_u32 s37, s82, 131072
    buffer_load_dwordx4 v232, s[44:47], s37 offen lds
    v_mfma_f32_16x16x32_bf16 v[208:211], v[84:87], a[184:187], v[208:211]
    ds_read_b64_tr_b16 a[218:219], v230 offset:4608
    v_cvt_pk_bf16_f32 v12, v40, v41
    v_mfma_f32_16x16x32_bf16 v[212:215], v[88:91], a[168:171], v[212:215]
    ds_read_b64_tr_b16 a[220:221], v231 offset:4096
    v_sub_f32 v42, v42, v50
    v_sub_f32 v43, v43, v50
    v_mfma_f32_16x16x32_bf16 v[212:215], v[92:95], a[184:187], v[212:215]
    ds_read_b64_tr_b16 a[222:223], v231 offset:4608
    v_cvt_pk_bf16_f32 v43, v42, v43
    v_mfma_f32_16x16x32_bf16 v[216:219], v[80:83], a[172:175], v[216:219]
    buffer_load_dwordx4 v233, s[44:47], s37 offen offset:1024 lds
    v_lshlrev_b32_e64 v42, 16, v43
    v_mfma_f32_16x16x32_bf16 v[216:219], v[84:87], a[188:191], v[216:219]
    v_and_b32 v43, 0xffff0000, v43
    v_mul_f32_e64 v42, v42, v51
    v_mfma_f32_16x16x32_bf16 v[220:223], v[88:91], a[172:175], v[220:223]
    v_mul_f32_e64 v43, v43, v51
    v_cvt_pk_bf16_f32 v13, v42, v43
    v_sub_f32_e64 v44, v44, v50
    v_mfma_f32_16x16x32_bf16 v[220:223], v[92:95], a[188:191], v[220:223]
    v_sub_f32 v45, v45, v50
    s_waitcnt lgkmcnt(0)
    v_mfma_f32_16x16x32_bf16 v[96:99], v[64:67], a[192:195], v[96:99]
    ds_read_b128 v[80:83], v224 offset:36864
    v_cvt_pk_bf16_f32 v45, v44, v45
    v_mfma_f32_16x16x32_bf16 v[96:99], v[68:71], a[208:211], v[96:99]
    ds_read_b128 v[84:87], v225 offset:36864
    v_lshlrev_b32_e64 v44, 16, v45
    v_mfma_f32_16x16x32_bf16 v[100:103], v[72:75], a[192:195], v[100:103]
    ds_read_b128 v[88:91], v224 offset:38912
    v_and_b32 v45, 0xffff0000, v45
    v_mfma_f32_16x16x32_bf16 v[100:103], v[76:79], a[208:211], v[100:103]
    ds_read_b128 v[92:95], v225 offset:38912
    v_mul_f32 v44, v44, v51
    v_mul_f32 v45, v45, v51
    v_mfma_f32_16x16x32_bf16 v[104:107], v[64:67], a[196:199], v[104:107]
    v_cvt_pk_bf16_f32 v14, v44, v45
    v_sub_f32_e64 v46, v46, v50
    v_mfma_f32_16x16x32_bf16 v[104:107], v[68:71], a[212:215], v[104:107]
    v_sub_f32_e64 v47, v47, v50
    v_cvt_pk_bf16_f32 v47, v46, v47
    v_mfma_f32_16x16x32_bf16 v[108:111], v[72:75], a[196:199], v[108:111]
    v_lshlrev_b32_e64 v46, 16, v47
    v_and_b32 v47, 0xffff0000, v47
    v_mul_f32_e64 v46, v46, v51
    v_mfma_f32_16x16x32_bf16 v[108:111], v[76:79], a[212:215], v[108:111]
    v_mul_f32_e64 v47, v47, v51
    v_cvt_pk_bf16_f32 v15, v46, v47
    v_mfma_f32_16x16x32_bf16 v[112:115], v[64:67], a[200:203], v[112:115]
    v_mfma_f32_16x16x32_bf16 v[112:115], v[68:71], a[216:219], v[112:115]
    ds_write_b128 v237, v[0:3] offset:0
    v_mfma_f32_16x16x32_bf16 v[116:119], v[72:75], a[200:203], v[116:119]
    ds_write_b128 v237, v[4:7] offset:4096
    v_mfma_f32_16x16x32_bf16 v[116:119], v[76:79], a[216:219], v[116:119]
    ds_write_b128 v237, v[8:11] offset:24576
    v_mfma_f32_16x16x32_bf16 v[120:123], v[64:67], a[204:207], v[120:123]
    ds_write_b128 v237, v[12:15] offset:28672
    v_mfma_f32_16x16x32_bf16 v[120:123], v[68:71], a[220:223], v[120:123]
    v_mfma_f32_16x16x32_bf16 v[124:127], v[72:75], a[204:207], v[124:127]
    v_mfma_f32_16x16x32_bf16 v[124:127], v[76:79], a[220:223], v[124:127]
    s_waitcnt lgkmcnt(0)
    v_mfma_f32_16x16x32_bf16 v[128:131], v[80:83], a[192:195], v[128:131]
    ds_read_b128 v[64:67], v224 offset:40960
    v_mfma_f32_16x16x32_bf16 v[128:131], v[84:87], a[208:211], v[128:131]
    ds_read_b128 v[68:71], v225 offset:40960
    v_mfma_f32_16x16x32_bf16 v[132:135], v[88:91], a[192:195], v[132:135]
    ds_read_b128 v[72:75], v224 offset:43008
    v_mfma_f32_16x16x32_bf16 v[132:135], v[92:95], a[208:211], v[132:135]
    ds_read_b128 v[76:79], v225 offset:43008
    v_mfma_f32_16x16x32_bf16 v[136:139], v[80:83], a[196:199], v[136:139]
    v_mfma_f32_16x16x32_bf16 v[136:139], v[84:87], a[212:215], v[136:139]
    v_mfma_f32_16x16x32_bf16 v[140:143], v[88:91], a[196:199], v[140:143]
    v_mfma_f32_16x16x32_bf16 v[140:143], v[92:95], a[212:215], v[140:143]
    v_mfma_f32_16x16x32_bf16 v[144:147], v[80:83], a[200:203], v[144:147]
    s_add_u32 m0, s34, 24576
    s_add_u32 s37, s83, 131072
    buffer_load_dwordx4 v232, s[44:47], s37 offen lds
    v_mfma_f32_16x16x32_bf16 v[144:147], v[84:87], a[216:219], v[144:147]
    buffer_load_dwordx4 v233, s[44:47], s37 offen offset:1024 lds
    v_mfma_f32_16x16x32_bf16 v[148:151], v[88:91], a[200:203], v[148:151]
    v_mfma_f32_16x16x32_bf16 v[148:151], v[92:95], a[216:219], v[148:151]
    v_lshlrev_b32 v227, 3, v240
    v_min_u32 v227, 1920, v227
    s_lshl2_add_u32 s25, s2, s3
    v_mfma_f32_16x16x32_bf16 v[152:155], v[80:83], a[204:207], v[152:155]
    s_lshl_b32 s25, s25, 13
    s_add_u32 s25, s25, 6144
    buffer_load_dword v241, v227, s[12:15], s25 offen
    v_mfma_f32_16x16x32_bf16 v[152:155], v[84:87], a[220:223], v[152:155]
    v_mfma_f32_16x16x32_bf16 v[156:159], v[88:91], a[204:207], v[156:159]
    buffer_load_dword v254, off, s[88:91], s97 sc1
    v_mfma_f32_16x16x32_bf16 v[156:159], v[92:95], a[220:223], v[156:159]
    s_waitcnt vmcnt(9) lgkmcnt(0)
    v_mfma_f32_16x16x32_bf16 v[160:163], v[64:67], a[192:195], v[160:163]
    ds_read_b128 v[80:83], v224 offset:45056
    v_mfma_f32_16x16x32_bf16 v[160:163], v[68:71], a[208:211], v[160:163]
    ds_read_b128 v[84:87], v225 offset:45056
    s_mul_i32 s38, s2, 100
    v_mfma_f32_16x16x32_bf16 v[164:167], v[72:75], a[192:195], v[164:167]
    ds_read_b128 v[88:91], v224 offset:47104
    v_mfma_f32_16x16x32_bf16 v[164:167], v[76:79], a[208:211], v[164:167]
    ds_read_b128 v[92:95], v225 offset:47104
    v_lshl_add_u32 v60, v253, 2, s38
    v_mfma_f32_16x16x32_bf16 v[168:171], v[64:67], a[196:199], v[168:171]
    ds_read_b64_tr_b16 a[224:225], v228 offset:8192
    v_mfma_f32_16x16x32_bf16 v[168:171], v[68:71], a[212:215], v[168:171]
    ds_read_b64_tr_b16 a[226:227], v228 offset:8704
    v_cmp_gt_u32 vcc, 25, v253
    v_mfma_f32_16x16x32_bf16 v[172:175], v[72:75], a[196:199], v[172:175]
    ds_read_b64_tr_b16 a[228:229], v229 offset:8192
    v_mfma_f32_16x16x32_bf16 v[172:175], v[76:79], a[212:215], v[172:175]
    ds_read_b64_tr_b16 a[230:231], v229 offset:8704
    v_mov_b32_e64 v61, 0
    v_mfma_f32_16x16x32_bf16 v[176:179], v[64:67], a[200:203], v[176:179]
    ds_read_b64_tr_b16 a[232:233], v230 offset:8192
    v_mfma_f32_16x16x32_bf16 v[176:179], v[68:71], a[216:219], v[176:179]
    ds_read_b64_tr_b16 a[234:235], v230 offset:8704
    v_mfma_f32_16x16x32_bf16 v[180:183], v[72:75], a[200:203], v[180:183]
    ds_read_b64_tr_b16 a[236:237], v231 offset:8192
    v_mov_b32 v62, 0x7ffffff0
    v_mfma_f32_16x16x32_bf16 v[180:183], v[76:79], a[216:219], v[180:183]
    ds_read_b64_tr_b16 a[238:239], v231 offset:8704
    v_mfma_f32_16x16x32_bf16 v[184:187], v[64:67], a[204:207], v[184:187]
    v_cndmask_b32 v60, v62, v60, vcc
    v_mfma_f32_16x16x32_bf16 v[184:187], v[68:71], a[220:223], v[184:187]
    buffer_store_dword v61, v60, s[56:59], 0 offen sc1
    v_mfma_f32_16x16x32_bf16 v[188:191], v[72:75], a[204:207], v[188:191]
    v_mfma_f32_16x16x32_bf16 v[188:191], v[76:79], a[220:223], v[188:191]
    s_waitcnt vmcnt(21) lgkmcnt(0)
    s_barrier
    v_mfma_f32_16x16x32_bf16 v[192:195], v[80:83], a[192:195], v[192:195]
    ds_read_b128 v[64:67], v224 offset:49152
    v_mfma_f32_16x16x32_bf16 v[192:195], v[84:87], a[208:211], v[192:195]
    ds_read_b128 v[68:71], v225 offset:49152
    v_mfma_f32_16x16x32_bf16 v[196:199], v[88:91], a[192:195], v[196:199]
    ds_read_b128 v[72:75], v224 offset:51200
    v_mfma_f32_16x16x32_bf16 v[196:199], v[92:95], a[208:211], v[196:199]
    ds_read_b128 v[76:79], v225 offset:51200
    v_mfma_f32_16x16x32_bf16 v[200:203], v[80:83], a[196:199], v[200:203]
    ds_read_b64_tr_b16 a[240:241], v228 offset:12288
    v_mfma_f32_16x16x32_bf16 v[200:203], v[84:87], a[212:215], v[200:203]
    ds_read_b64_tr_b16 a[242:243], v228 offset:12800
    v_mfma_f32_16x16x32_bf16 v[204:207], v[88:91], a[196:199], v[204:207]
    ds_read_b64_tr_b16 a[244:245], v229 offset:12288
    v_mfma_f32_16x16x32_bf16 v[204:207], v[92:95], a[212:215], v[204:207]
    ds_read_b64_tr_b16 a[246:247], v229 offset:12800
    v_mfma_f32_16x16x32_bf16 v[208:211], v[80:83], a[200:203], v[208:211]
    ds_read_b64_tr_b16 a[248:249], v230 offset:12288
    v_lshlrev_b32 v237, 4, v253
    v_add_u32 v237, 81920, v237
    ds_read_b128 v[16:19], v237 offset:0
    ds_read_b128 v[20:23], v237 offset:4096
    ds_read_b128 v[24:27], v237 offset:24576
    ds_read_b128 v[28:31], v237 offset:28672
    s_add_u32 m0, s34, 32768
    s_add_u32 s37, s84, 131072
    buffer_load_dwordx4 v232, s[44:47], s37 offen lds
    v_mfma_f32_16x16x32_bf16 v[208:211], v[84:87], a[216:219], v[208:211]
    ds_read_b64_tr_b16 a[250:251], v230 offset:12800
    v_mfma_f32_16x16x32_bf16 v[212:215], v[88:91], a[200:203], v[212:215]
    ds_read_b64_tr_b16 a[252:253], v231 offset:12288
    v_mfma_f32_16x16x32_bf16 v[212:215], v[92:95], a[216:219], v[212:215]
    ds_read_b64_tr_b16 a[254:255], v231 offset:12800
    v_mfma_f32_16x16x32_bf16 v[216:219], v[80:83], a[204:207], v[216:219]
    buffer_load_dwordx4 v233, s[44:47], s37 offen offset:1024 lds
    v_mfma_f32_16x16x32_bf16 v[216:219], v[84:87], a[220:223], v[216:219]
    v_mfma_f32_16x16x32_bf16 v[220:223], v[88:91], a[204:207], v[220:223]
    v_mfma_f32_16x16x32_bf16 v[220:223], v[92:95], a[220:223], v[220:223]
    s_waitcnt lgkmcnt(0)
    v_mfma_f32_16x16x32_bf16 v[96:99], v[64:67], a[224:227], v[96:99]
    ds_read_b128 v[80:83], v224 offset:53248
    v_mfma_f32_16x16x32_bf16 v[96:99], v[68:71], a[240:243], v[96:99]
    ds_read_b128 v[84:87], v225 offset:53248
    v_mfma_f32_16x16x32_bf16 v[100:103], v[72:75], a[224:227], v[100:103]
    ds_read_b128 v[88:91], v224 offset:55296
    v_mfma_f32_16x16x32_bf16 v[100:103], v[76:79], a[240:243], v[100:103]
    ds_read_b128 v[92:95], v225 offset:55296
    v_mfma_f32_16x16x32_bf16 v[104:107], v[64:67], a[228:231], v[104:107]
    v_mfma_f32_16x16x32_bf16 v[104:107], v[68:71], a[244:247], v[104:107]
    s_mov_b32 s39, 0
    buffer_store_dwordx4 v[16:19], v238, s[8:11], s39 offen sc1
    v_mfma_f32_16x16x32_bf16 v[108:111], v[72:75], a[228:231], v[108:111]
    v_mfma_f32_16x16x32_bf16 v[108:111], v[76:79], a[244:247], v[108:111]
    v_mfma_f32_16x16x32_bf16 v[112:115], v[64:67], a[232:235], v[112:115]
    v_mfma_f32_16x16x32_bf16 v[112:115], v[68:71], a[248:251], v[112:115]
    v_mfma_f32_16x16x32_bf16 v[116:119], v[72:75], a[232:235], v[116:119]
    v_mfma_f32_16x16x32_bf16 v[116:119], v[76:79], a[248:251], v[116:119]
    v_mfma_f32_16x16x32_bf16 v[120:123], v[64:67], a[236:239], v[120:123]
    v_mfma_f32_16x16x32_bf16 v[120:123], v[68:71], a[252:255], v[120:123]
    s_mov_b32 s39, 8192
    buffer_store_dwordx4 v[20:23], v238, s[8:11], s39 offen sc1
    v_mfma_f32_16x16x32_bf16 v[124:127], v[72:75], a[236:239], v[124:127]
    v_mfma_f32_16x16x32_bf16 v[124:127], v[76:79], a[252:255], v[124:127]
    s_waitcnt lgkmcnt(0)
    v_mfma_f32_16x16x32_bf16 v[128:131], v[80:83], a[224:227], v[128:131]
    ds_read_b128 v[64:67], v224 offset:57344
    v_mfma_f32_16x16x32_bf16 v[128:131], v[84:87], a[240:243], v[128:131]
    ds_read_b128 v[68:71], v225 offset:57344
    v_mfma_f32_16x16x32_bf16 v[132:135], v[88:91], a[224:227], v[132:135]
    ds_read_b128 v[72:75], v224 offset:59392
    v_mfma_f32_16x16x32_bf16 v[132:135], v[92:95], a[240:243], v[132:135]
    ds_read_b128 v[76:79], v225 offset:59392
    v_mfma_f32_16x16x32_bf16 v[136:139], v[80:83], a[228:231], v[136:139]
    v_mfma_f32_16x16x32_bf16 v[136:139], v[84:87], a[244:247], v[136:139]
    s_mov_b32 s39, 16384
    buffer_store_dwordx4 v[24:27], v238, s[8:11], s39 offen sc1
    v_mfma_f32_16x16x32_bf16 v[140:143], v[88:91], a[228:231], v[140:143]
    v_mfma_f32_16x16x32_bf16 v[140:143], v[92:95], a[244:247], v[140:143]
    v_mfma_f32_16x16x32_bf16 v[144:147], v[80:83], a[232:235], v[144:147]
    s_add_u32 m0, s34, 40960
    s_add_u32 s37, s85, 131072
    buffer_load_dwordx4 v232, s[44:47], s37 offen lds
    v_mfma_f32_16x16x32_bf16 v[144:147], v[84:87], a[248:251], v[144:147]
    v_mfma_f32_16x16x32_bf16 v[148:151], v[88:91], a[232:235], v[148:151]
    v_mfma_f32_16x16x32_bf16 v[148:151], v[92:95], a[248:251], v[148:151]
    v_mfma_f32_16x16x32_bf16 v[152:155], v[80:83], a[236:239], v[152:155]
    buffer_load_dwordx4 v233, s[44:47], s37 offen offset:1024 lds
    v_mfma_f32_16x16x32_bf16 v[152:155], v[84:87], a[252:255], v[152:155]
    s_mov_b32 s39, 24576
    buffer_store_dwordx4 v[28:31], v238, s[8:11], s39 offen sc1
    v_mfma_f32_16x16x32_bf16 v[156:159], v[88:91], a[236:239], v[156:159]
    v_mfma_f32_16x16x32_bf16 v[156:159], v[92:95], a[252:255], v[156:159]
    s_waitcnt lgkmcnt(0)
    v_mfma_f32_16x16x32_bf16 v[160:163], v[64:67], a[224:227], v[160:163]
    ds_read_b128 v[80:83], v224 offset:61440
    v_mfma_f32_16x16x32_bf16 v[160:163], v[68:71], a[240:243], v[160:163]
    ds_read_b128 v[84:87], v225 offset:61440
    v_mfma_f32_16x16x32_bf16 v[164:167], v[72:75], a[224:227], v[164:167]
    ds_read_b128 v[88:91], v224 offset:63488
    v_mfma_f32_16x16x32_bf16 v[164:167], v[76:79], a[240:243], v[164:167]
    ds_read_b128 v[92:95], v225 offset:63488
    v_mfma_f32_16x16x32_bf16 v[168:171], v[64:67], a[228:231], v[168:171]
    v_mfma_f32_16x16x32_bf16 v[168:171], v[68:71], a[244:247], v[168:171]
    v_mfma_f32_16x16x32_bf16 v[172:175], v[72:75], a[228:231], v[172:175]
    v_mfma_f32_16x16x32_bf16 v[172:175], v[76:79], a[244:247], v[172:175]
    v_mfma_f32_16x16x32_bf16 v[176:179], v[64:67], a[232:235], v[176:179]
    v_mfma_f32_16x16x32_bf16 v[176:179], v[68:71], a[248:251], v[176:179]
    v_cvt_pk_bf16_f32 v0, v96, v97
    v_cvt_pk_bf16_f32 v1, v98, v99
    v_mfma_f32_16x16x32_bf16 v[180:183], v[72:75], a[232:235], v[180:183]
    v_cvt_pk_bf16_f32 v2, v100, v101
    v_cvt_pk_bf16_f32 v3, v102, v103
    v_mfma_f32_16x16x32_bf16 v[180:183], v[76:79], a[248:251], v[180:183]
    v_cvt_pk_bf16_f32 v4, v104, v105
    v_cvt_pk_bf16_f32 v5, v106, v107
    v_mfma_f32_16x16x32_bf16 v[184:187], v[64:67], a[236:239], v[184:187]
    v_cvt_pk_bf16_f32 v6, v108, v109
    v_cvt_pk_bf16_f32 v7, v110, v111
    v_mfma_f32_16x16x32_bf16 v[184:187], v[68:71], a[252:255], v[184:187]
    v_cvt_pk_bf16_f32 v8, v112, v113
    v_cvt_pk_bf16_f32 v9, v114, v115
    v_mfma_f32_16x16x32_bf16 v[188:191], v[72:75], a[236:239], v[188:191]
    v_cvt_pk_bf16_f32 v10, v116, v117
    v_cvt_pk_bf16_f32 v11, v118, v119
    v_mfma_f32_16x16x32_bf16 v[188:191], v[76:79], a[252:255], v[188:191]
    v_cvt_pk_bf16_f32 v12, v120, v121
    v_cvt_pk_bf16_f32 v13, v122, v123
    s_waitcnt vmcnt(16) lgkmcnt(0)
    s_barrier
    v_mfma_f32_16x16x32_bf16 v[192:195], v[80:83], a[224:227], v[192:195]
    ds_read_b128 v[64:67], v224 offset:0
    v_cvt_pk_bf16_f32 v14, v124, v125
    v_cvt_pk_bf16_f32 v15, v126, v127
    v_mfma_f32_16x16x32_bf16 v[192:195], v[84:87], a[240:243], v[192:195]
    ds_read_b128 v[68:71], v225 offset:0
    v_cvt_pk_bf16_f32 v16, v128, v129
    v_cvt_pk_bf16_f32 v17, v130, v131
    v_mfma_f32_16x16x32_bf16 v[196:199], v[88:91], a[224:227], v[196:199]
    ds_read_b128 v[72:75], v224 offset:8192
    v_cvt_pk_bf16_f32 v18, v132, v133
    v_cvt_pk_bf16_f32 v19, v134, v135
    v_mfma_f32_16x16x32_bf16 v[196:199], v[92:95], a[240:243], v[196:199]
    ds_read_b128 v[76:79], v225 offset:8192
    v_cvt_pk_bf16_f32 v20, v136, v137
    v_cvt_pk_bf16_f32 v21, v138, v139
    v_mfma_f32_16x16x32_bf16 v[200:203], v[80:83], a[228:231], v[200:203]
    v_cvt_pk_bf16_f32 v22, v140, v141
    v_cvt_pk_bf16_f32 v23, v142, v143
    v_mfma_f32_16x16x32_bf16 v[200:203], v[84:87], a[244:247], v[200:203]
    v_cvt_pk_bf16_f32 v24, v144, v145
    v_cvt_pk_bf16_f32 v25, v146, v147
    v_mfma_f32_16x16x32_bf16 v[204:207], v[88:91], a[228:231], v[204:207]
    v_cvt_pk_bf16_f32 v26, v148, v149
    v_cvt_pk_bf16_f32 v27, v150, v151
    v_mfma_f32_16x16x32_bf16 v[204:207], v[92:95], a[244:247], v[204:207]
    v_cvt_pk_bf16_f32 v28, v152, v153
    v_cvt_pk_bf16_f32 v29, v154, v155
    v_mfma_f32_16x16x32_bf16 v[208:211], v[80:83], a[232:235], v[208:211]
    s_add_u32 m0, s34, 49152
    s_add_u32 s37, s86, 131072
    buffer_load_dwordx4 v232, s[44:47], s37 offen lds
    v_cvt_pk_bf16_f32 v30, v156, v157
    v_cvt_pk_bf16_f32 v31, v158, v159
    v_mfma_f32_16x16x32_bf16 v[208:211], v[84:87], a[248:251], v[208:211]
    v_cvt_pk_bf16_f32 v32, v160, v161
    v_cvt_pk_bf16_f32 v33, v162, v163
    v_mfma_f32_16x16x32_bf16 v[212:215], v[88:91], a[232:235], v[212:215]
    v_cvt_pk_bf16_f32 v34, v164, v165
    v_cvt_pk_bf16_f32 v35, v166, v167
    v_mfma_f32_16x16x32_bf16 v[212:215], v[92:95], a[248:251], v[212:215]
    v_cvt_pk_bf16_f32 v36, v168, v169
    v_cvt_pk_bf16_f32 v37, v170, v171
    v_mfma_f32_16x16x32_bf16 v[216:219], v[80:83], a[236:239], v[216:219]
    buffer_load_dwordx4 v233, s[44:47], s37 offen offset:1024 lds
    v_cvt_pk_bf16_f32 v38, v172, v173
    v_cvt_pk_bf16_f32 v39, v174, v175
    v_mfma_f32_16x16x32_bf16 v[216:219], v[84:87], a[252:255], v[216:219]
    v_cvt_pk_bf16_f32 v40, v176, v177
    v_cvt_pk_bf16_f32 v41, v178, v179
    v_mfma_f32_16x16x32_bf16 v[220:223], v[88:91], a[236:239], v[220:223]
    v_cvt_pk_bf16_f32 v42, v180, v181
    v_cvt_pk_bf16_f32 v43, v182, v183
    v_mfma_f32_16x16x32_bf16 v[220:223], v[92:95], a[252:255], v[220:223]
    v_cvt_pk_bf16_f32 v44, v184, v185
    v_cvt_pk_bf16_f32 v45, v186, v187
    s_waitcnt lgkmcnt(0)
    v_mfma_f32_16x16x32_bf16 v[96:99], v[64:67], a[0:3], 0
    ds_read_b128 v[80:83], v224 offset:2048
    v_cvt_pk_bf16_f32 v46, v188, v189
    v_cvt_pk_bf16_f32 v47, v190, v191
    v_mfma_f32_16x16x32_bf16 v[96:99], v[68:71], a[16:19], v[96:99]
    ds_read_b128 v[84:87], v225 offset:2048
    v_cvt_pk_bf16_f32 v48, v192, v193
    v_cvt_pk_bf16_f32 v49, v194, v195
    v_mfma_f32_16x16x32_bf16 v[96:99], v[72:75], a[32:35], v[96:99]
    ds_read_b128 v[88:91], v224 offset:10240
    v_cvt_pk_bf16_f32 v50, v196, v197
    v_cvt_pk_bf16_f32 v51, v198, v199
    v_mfma_f32_16x16x32_bf16 v[96:99], v[76:79], a[48:51], v[96:99]
    ds_read_b128 v[92:95], v225 offset:10240
    v_cvt_pk_bf16_f32 v52, v200, v201
    v_cvt_pk_bf16_f32 v53, v202, v203
    v_mfma_f32_16x16x32_bf16 v[104:107], v[64:67], a[4:7], 0
    v_cvt_pk_bf16_f32 v54, v204, v205
    v_cvt_pk_bf16_f32 v55, v206, v207
    s_add_u32 s38, s36, 0
    buffer_store_dwordx4 v[0:3], v240, s[16:19], s38 offen offset:0 sc1
    v_mfma_f32_16x16x32_bf16 v[104:107], v[68:71], a[20:23], v[104:107]
    v_cvt_pk_bf16_f32 v56, v208, v209
    v_cvt_pk_bf16_f32 v57, v210, v211
    v_mfma_f32_16x16x32_bf16 v[104:107], v[72:75], a[36:39], v[104:107]
    v_cvt_pk_bf16_f32 v58, v212, v213
    v_cvt_pk_bf16_f32 v59, v214, v215
    v_mfma_f32_16x16x32_bf16 v[104:107], v[76:79], a[52:55], v[104:107]
    v_cvt_pk_bf16_f32 v60, v216, v217
    v_cvt_pk_bf16_f32 v61, v218, v219
    v_mfma_f32_16x16x32_bf16 v[112:115], v[64:67], a[8:11], 0
    v_xor_b32 v237, 16, v245
    v_xor_b32 v238, 16, v246
    v_cvt_pk_bf16_f32 v62, v220, v221
    v_cvt_pk_bf16_f32 v63, v222, v223
    v_mfma_f32_16x16x32_bf16 v[112:115], v[68:71], a[24:27], v[112:115]
    v_mfma_f32_16x16x32_bf16 v[112:115], v[72:75], a[40:43], v[112:115]
    v_mfma_f32_16x16x32_bf16 v[112:115], v[76:79], a[56:59], v[112:115]
    v_mfma_f32_16x16x32_bf16 v[120:123], v[64:67], a[12:15], 0
    v_mfma_f32_16x16x32_bf16 v[120:123], v[68:71], a[28:31], v[120:123]
    v_mfma_f32_16x16x32_bf16 v[120:123], v[72:75], a[44:47], v[120:123]
    v_mfma_f32_16x16x32_bf16 v[120:123], v[76:79], a[60:63], v[120:123]
    s_waitcnt lgkmcnt(0)
    v_mfma_f32_16x16x32_bf16 v[100:103], v[80:83], a[0:3], 0
    ds_read_b128 v[64:67], v224 offset:4096
    v_mfma_f32_16x16x32_bf16 v[100:103], v[84:87], a[16:19], v[100:103]
    ds_read_b128 v[68:71], v225 offset:4096
    v_mfma_f32_16x16x32_bf16 v[100:103], v[88:91], a[32:35], v[100:103]
    ds_read_b128 v[72:75], v224 offset:12288
    v_mfma_f32_16x16x32_bf16 v[100:103], v[92:95], a[48:51], v[100:103]
    ds_read_b128 v[76:79], v225 offset:12288
    v_mfma_f32_16x16x32_bf16 v[108:111], v[80:83], a[4:7], 0
    v_mfma_f32_16x16x32_bf16 v[108:111], v[84:87], a[20:23], v[108:111]
    v_mfma_f32_16x16x32_bf16 v[108:111], v[88:91], a[36:39], v[108:111]
    v_mfma_f32_16x16x32_bf16 v[108:111], v[92:95], a[52:55], v[108:111]
    v_mfma_f32_16x16x32_bf16 v[116:119], v[80:83], a[8:11], 0
    s_add_u32 m0, s34, 57344
    s_add_u32 s37, s87, 131072
    buffer_load_dwordx4 v232, s[44:47], s37 offen lds
    v_mfma_f32_16x16x32_bf16 v[116:119], v[84:87], a[24:27], v[116:119]
    s_add_u32 s38, s36, 0
    buffer_store_dwordx4 v[4:7], v240, s[16:19], s38 offen offset:1024 sc1
    v_mfma_f32_16x16x32_bf16 v[116:119], v[88:91], a[40:43], v[116:119]
    v_mfma_f32_16x16x32_bf16 v[116:119], v[92:95], a[56:59], v[116:119]
    v_mfma_f32_16x16x32_bf16 v[124:127], v[80:83], a[12:15], 0
    buffer_load_dwordx4 v233, s[44:47], s37 offen offset:1024 lds
    v_mfma_f32_16x16x32_bf16 v[124:127], v[84:87], a[28:31], v[124:127]
    v_mfma_f32_16x16x32_bf16 v[124:127], v[88:91], a[44:47], v[124:127]
    v_mfma_f32_16x16x32_bf16 v[124:127], v[92:95], a[60:63], v[124:127]
    s_waitcnt lgkmcnt(0)
    v_mfma_f32_16x16x32_bf16 v[128:131], v[64:67], a[0:3], 0
    ds_read_b128 v[80:83], v224 offset:6144
    v_mfma_f32_16x16x32_bf16 v[128:131], v[68:71], a[16:19], v[128:131]
    ds_read_b128 v[84:87], v225 offset:6144
    v_mfma_f32_16x16x32_bf16 v[128:131], v[72:75], a[32:35], v[128:131]
    ds_read_b128 v[88:91], v224 offset:14336
    v_mfma_f32_16x16x32_bf16 v[128:131], v[76:79], a[48:51], v[128:131]
    ds_read_b128 v[92:95], v225 offset:14336
    v_mfma_f32_16x16x32_bf16 v[136:139], v[64:67], a[4:7], 0
    v_mfma_f32_16x16x32_bf16 v[136:139], v[68:71], a[20:23], v[136:139]
    v_mfma_f32_16x16x32_bf16 v[136:139], v[72:75], a[36:39], v[136:139]
    v_mfma_f32_16x16x32_bf16 v[136:139], v[76:79], a[52:55], v[136:139]
    v_mfma_f32_16x16x32_bf16 v[144:147], v[64:67], a[8:11], 0
    s_waitcnt vmcnt(15)
    v_readfirstlane_b32 s24, v254
    s_lshl_b32 s25, s3, 16
    s_add_u32 s24, s24, s25
    s_cmp_ge_u32 s24, 1
    s_cbranch_scc0 kf_spin35
kf_spinr36:
    v_mfma_f32_16x16x32_bf16 v[144:147], v[68:71], a[24:27], v[144:147]
    v_mfma_f32_16x16x32_bf16 v[144:147], v[72:75], a[40:43], v[144:147]
    v_mfma_f32_16x16x32_bf16 v[144:147], v[76:79], a[56:59], v[144:147]
    v_mfma_f32_16x16x32_bf16 v[152:155], v[64:67], a[12:15], 0
    s_add_u32 s88, s20, 0x14a0000
    s_addc_u32 s89, s21, 0
    s_mov_b32 s90, 20480
    v_mfma_f32_16x16x32_bf16 v[152:155], v[68:71], a[28:31], v[152:155]
    v_mfma_f32_16x16x32_bf16 v[152:155], v[72:75], a[44:47], v[152:155]
    v_mfma_f32_16x16x32_bf16 v[152:155], v[76:79], a[60:63], v[152:155]
    s_add_u32 s38, s36, 0
    buffer_store_dwordx4 v[8:11], v240, s[16:19], s38 offen offset:2048 sc1
    s_waitcnt vmcnt(7) lgkmcnt(0)
    s_barrier
    v_mfma_f32_16x16x32_bf16 v[132:135], v[80:83], a[0:3], 0
    ds_read_b128 v[64:67], v224 offset:16384
    v_mfma_f32_16x16x32_bf16 v[132:135], v[84:87], a[16:19], v[132:135]
    ds_read_b128 v[68:71], v225 offset:16384
    v_mfma_f32_16x16x32_bf16 v[132:135], v[88:91], a[32:35], v[132:135]
    ds_read_b128 v[72:75], v224 offset:24576
    v_mfma_f32_16x16x32_bf16 v[132:135], v[92:95], a[48:51], v[132:135]
    ds_read_b128 v[76:79], v225 offset:24576
    v_mfma_f32_16x16x32_bf16 v[140:143], v[80:83], a[4:7], 0
    v_mfma_f32_16x16x32_bf16 v[140:143], v[84:87], a[20:23], v[140:143]
    v_mfma_f32_16x16x32_bf16 v[140:143], v[88:91], a[36:39], v[140:143]
    v_mfma_f32_16x16x32_bf16 v[140:143], v[92:95], a[52:55], v[140:143]
    v_mfma_f32_16x16x32_bf16 v[148:151], v[80:83], a[8:11], 0
    s_add_u32 m0, s34, 0
    s_add_u32 s37, s80, 196608
    buffer_load_dwordx4 v232, s[44:47], s37 offen lds
    v_mfma_f32_16x16x32_bf16 v[148:151], v[84:87], a[24:27], v[148:151]
    v_mfma_f32_16x16x32_bf16 v[148:151], v[88:91], a[40:43], v[148:151]
    buffer_load_dwordx4 v233, s[44:47], s37 offen offset:1024 lds
    v_mfma_f32_16x16x32_bf16 v[148:151], v[92:95], a[56:59], v[148:151]
    v_mfma_f32_16x16x32_bf16 v[156:159], v[80:83], a[12:15], 0
    v_mfma_f32_16x16x32_bf16 v[156:159], v[84:87], a[28:31], v[156:159]
    s_lshl_b32 s39, s5, 7
    s_add_u32 s39, s39, 8192
    buffer_atomic_add v255, v250, s[88:91], s39 offen sc1
    s_cmp_eq_u32 s3, 0
    s_cselect_b32 s39, s39, s43
    v_mfma_f32_16x16x32_bf16 v[156:159], v[88:91], a[44:47], v[156:159]
    v_mfma_f32_16x16x32_bf16 v[156:159], v[92:95], a[60:63], v[156:159]
    s_waitcnt lgkmcnt(0)
    v_mfma_f32_16x16x32_bf16 v[96:99], v[64:67], a[64:67], v[96:99]
    ds_read_b128 v[80:83], v224 offset:18432
    v_mfma_f32_16x16x32_bf16 v[96:99], v[68:71], a[80:83], v[96:99]
    ds_read_b128 v[84:87], v225 offset:18432
    v_mfma_f32_16x16x32_bf16 v[96:99], v[72:75], a[96:99], v[96:99]
    ds_read_b128 v[88:91], v224 offset:26624
    v_mfma_f32_16x16x32_bf16 v[96:99], v[76:79], a[112:115], v[96:99]
    ds_read_b128 v[92:95], v225 offset:26624
    v_mfma_f32_16x16x32_bf16 v[104:107], v[64:67], a[68:71], v[104:107]
    s_add_u32 s38, s36, 0
    buffer_store_dwordx4 v[12:15], v240, s[16:19], s38 offen offset:3072 sc1
    v_mfma_f32_16x16x32_bf16 v[104:107], v[68:71], a[84:87], v[104:107]
    v_mfma_f32_16x16x32_bf16 v[104:107], v[72:75], a[100:103], v[104:107]
    v_mfma_f32_16x16x32_bf16 v[104:107], v[76:79], a[116:119], v[104:107]
    v_mfma_f32_16x16x32_bf16 v[112:115], v[64:67], a[72:75], v[112:115]
    s_add_u32 m0, s31, 0
    s_add_u32 s24, s27, 0
    buffer_load_dwordx4 v245, s[12:15], s24 offen lds
    v_mfma_f32_16x16x32_bf16 v[112:115], v[68:71], a[88:91], v[112:115]
    v_mfma_f32_16x16x32_bf16 v[112:115], v[72:75], a[104:107], v[112:115]
    v_mfma_f32_16x16x32_bf16 v[112:115], v[76:79], a[120:123], v[112:115]
    v_mfma_f32_16x16x32_bf16 v[120:123], v[64:67], a[76:79], v[120:123]
    v_mfma_f32_16x16x32_bf16 v[120:123], v[68:71], a[92:95], v[120:123]
    v_mfma_f32_16x16x32_bf16 v[120:123], v[72:75], a[108:111], v[120:123]
    v_mfma_f32_16x16x32_bf16 v[120:123], v[76:79], a[124:127], v[120:123]
    s_waitcnt lgkmcnt(0)
    v_mfma_f32_16x16x32_bf16 v[100:103], v[80:83], a[64:67], v[100:103]
    ds_read_b128 v[64:67], v224 offset:20480
    v_mfma_f32_16x16x32_bf16 v[100:103], v[84:87], a[80:83], v[100:103]
    ds_read_b128 v[68:71], v225 offset:20480
    v_mfma_f32_16x16x32_bf16 v[100:103], v[88:91], a[96:99], v[100:103]
    ds_read_b128 v[72:75], v224 offset:28672
    v_mfma_f32_16x16x32_bf16 v[100:103], v[92:95], a[112:115], v[100:103]
    ds_read_b128 v[76:79], v225 offset:28672
    v_mfma_f32_16x16x32_bf16 v[108:111], v[80:83], a[68:71], v[108:111]
    v_mfma_f32_16x16x32_bf16 v[108:111], v[84:87], a[84:87], v[108:111]
    v_mfma_f32_16x16x32_bf16 v[108:111], v[88:91], a[100:103], v[108:111]
    v_mfma_f32_16x16x32_bf16 v[108:111], v[92:95], a[116:119], v[108:111]
    v_mfma_f32_16x16x32_bf16 v[116:119], v[80:83], a[72:75], v[116:119]
    s_add_u32 m0, s34, 8192
    s_add_u32 s37, s81, 196608
    buffer_load_dwordx4 v232, s[44:47], s37 offen lds
    v_mfma_f32_16x16x32_bf16 v[116:119], v[84:87], a[88:91], v[116:119]
    v_mfma_f32_16x16x32_bf16 v[116:119], v[88:91], a[104:107], v[116:119]
    buffer_load_dwordx4 v233, s[44:47], s37 offen offset:1024 lds
    s_add_u32 s38, s36, 8192
    buffer_store_dwordx4 v[16:19], v240, s[16:19], s38 offen offset:0 sc1
    v_mfma_f32_16x16x32_bf16 v[116:119], v[92:95], a[120:123], v[116:119]
    v_mfma_f32_16x16x32_bf16 v[124:127], v[80:83], a[76:79], v[124:127]
    v_mfma_f32_16x16x32_bf16 v[124:127], v[84:87], a[92:95], v[124:127]
    s_add_u32 m0, s31, 1024
    s_add_u32 s24, s27, 32768
    buffer_load_dwordx4 v245, s[12:15], s24 offen lds
    v_mfma_f32_16x16x32_bf16 v[124:127], v[88:91], a[108:111], v[124:127]
    v_mfma_f32_16x16x32_bf16 v[124:127], v[92:95], a[124:127], v[124:127]
    s_waitcnt lgkmcnt(0)
    v_mfma_f32_16x16x32_bf16 v[128:131], v[64:67], a[64:67], v[128:131]
    ds_read_b128 v[80:83], v224 offset:22528
    v_mfma_f32_16x16x32_bf16 v[128:131], v[68:71], a[80:83], v[128:131]
    ds_read_b128 v[84:87], v225 offset:22528
    v_mfma_f32_16x16x32_bf16 v[128:131], v[72:75], a[96:99], v[128:131]
    ds_read_b128 v[88:91], v224 offset:30720
    v_mfma_f32_16x16x32_bf16 v[128:131], v[76:79], a[112:115], v[128:131]
    ds_read_b128 v[92:95], v225 offset:30720
    v_mfma_f32_16x16x32_bf16 v[136:139], v[64:67], a[68:71], v[136:139]
    v_mfma_f32_16x16x32_bf16 v[136:139], v[68:71], a[84:87], v[136:139]
    v_mfma_f32_16x16x32_bf16 v[136:139], v[72:75], a[100:103], v[136:139]
    v_mfma_f32_16x16x32_bf16 v[136:139], v[76:79], a[116:119], v[136:139]
    v_mfma_f32_16x16x32_bf16 v[144:147], v[64:67], a[72:75], v[144:147]
    s_add_u32 m0, s31, 2048
    s_add_u32 s24, s27, 65536
    buffer_load_dwordx4 v237, s[12:15], s24 offen lds
    v_mfma_f32_16x16x32_bf16 v[144:147], v[68:71], a[88:91], v[144:147]
    v_mfma_f32_16x16x32_bf16 v[144:147], v[72:75], a[104:107], v[144:147]
    v_mfma_f32_16x16x32_bf16 v[144:147], v[76:79], a[120:123], v[144:147]
    v_mfma_f32_16x16x32_bf16 v[152:155], v[64:67], a[76:79], v[152:155]
    v_mfma_f32_16x16x32_bf16 v[152:155], v[68:71], a[92:95], v[152:155]
    v_mfma_f32_16x16x32_bf16 v[152:155], v[72:75], a[108:111], v[152:155]
    v_mfma_f32_16x16x32_bf16 v[152:155], v[76:79], a[124:127], v[152:155]
    s_add_u32 s38, s36, 8192
    buffer_store_dwordx4 v[20:23], v240, s[16:19], s38 offen offset:1024 sc1
    s_waitcnt vmcnt(19) lgkmcnt(0)
    s_barrier
    v_mfma_f32_16x16x32_bf16 v[132:135], v[80:83], a[64:67], v[132:135]
    ds_read_b128 v[64:67], v224 offset:32768
    v_mfma_f32_16x16x32_bf16 v[132:135], v[84:87], a[80:83], v[132:135]
    ds_read_b128 v[68:71], v225 offset:32768
    v_mfma_f32_16x16x32_bf16 v[132:135], v[88:91], a[96:99], v[132:135]
    ds_read_b128 v[72:75], v224 offset:40960
    v_mfma_f32_16x16x32_bf16 v[132:135], v[92:95], a[112:115], v[132:135]
    ds_read_b128 v[76:79], v225 offset:40960
    v_mfma_f32_16x16x32_bf16 v[140:143], v[80:83], a[68:71], v[140:143]
    v_mfma_f32_16x16x32_bf16 v[140:143], v[84:87], a[84:87], v[140:143]
    v_mfma_f32_16x16x32_bf16 v[140:143], v[88:91], a[100:103], v[140:143]
    v_mfma_f32_16x16x32_bf16 v[140:143], v[92:95], a[116:119], v[140:143]
    v_mfma_f32_16x16x32_bf16 v[148:151], v[80:83], a[72:75], v[148:151]
    s_add_u32 m0, s34, 16384
    s_add_u32 s37, s82, 196608
    buffer_load_dwordx4 v232, s[44:47], s37 offen lds
    v_mfma_f32_16x16x32_bf16 v[148:151], v[84:87], a[88:91], v[148:151]
    v_mfma_f32_16x16x32_bf16 v[148:151], v[88:91], a[104:107], v[148:151]
    buffer_load_dwordx4 v233, s[44:47], s37 offen offset:1024 lds
    v_mfma_f32_16x16x32_bf16 v[148:151], v[92:95], a[120:123], v[148:151]
    v_mfma_f32_16x16x32_bf16 v[156:159], v[80:83], a[76:79], v[156:159]
    v_mfma_f32_16x16x32_bf16 v[156:159], v[84:87], a[92:95], v[156:159]
    s_add_u32 m0, s31, 3072
    s_add_u32 s24, s27, 98304
    buffer_load_dwordx4 v237, s[12:15], s24 offen lds
    v_mfma_f32_16x16x32_bf16 v[156:159], v[88:91], a[108:111], v[156:159]
    v_mfma_f32_16x16x32_bf16 v[156:159], v[92:95], a[124:127], v[156:159]
    s_waitcnt lgkmcnt(0)
    v_mfma_f32_16x16x32_bf16 v[96:99], v[64:67], a[128:131], v[96:99]
    ds_read_b128 v[80:83], v224 offset:34816
    v_mfma_f32_16x16x32_bf16 v[96:99], v[68:71], a[144:147], v[96:99]
    ds_read_b128 v[84:87], v225 offset:34816
    v_mfma_f32_16x16x32_bf16 v[96:99], v[72:75], a[160:163], v[96:99]
    ds_read_b128 v[88:91], v224 offset:43008
    v_mfma_f32_16x16x32_bf16 v[96:99], v[76:79], a[176:179], v[96:99]
    ds_read_b128 v[92:95], v225 offset:43008
    v_mfma_f32_16x16x32_bf16 v[104:107], v[64:67], a[132:135], v[104:107]
    v_mfma_f32_16x16x32_bf16 v[104:107], v[68:71], a[148:151], v[104:107]
    s_add_u32 s38, s36, 8192
    buffer_store_dwordx4 v[24:27], v240, s[16:19], s38 offen offset:2048 sc1
    v_mfma_f32_16x16x32_bf16 v[104:107], v[72:75], a[164:167], v[104:107]
    v_mfma_f32_16x16x32_bf16 v[104:107], v[76:79], a[180:183], v[104:107]
    v_mfma_f32_16x16x32_bf16 v[112:115], v[64:67], a[136:139], v[112:115]
    s_add_u32 m0, s31, 4096
    s_add_u32 s24, s27, 131072
    buffer_load_dwordx4 v245, s[12:15], s24 offen lds
    v_mfma_f32_16x16x32_bf16 v[112:115], v[68:71], a[152:155], v[112:115]
    v_mfma_f32_16x16x32_bf16 v[112:115], v[72:75], a[168:171], v[112:115]
    v_mfma_f32_16x16x32_bf16 v[112:115], v[76:79], a[184:187], v[112:115]
    v_mfma_f32_16x16x32_bf16 v[120:123], v[64:67], a[140:143], v[120:123]
    v_mfma_f32_16x16x32_bf16 v[120:123], v[68:71], a[156:159], v[120:123]
    v_mfma_f32_16x16x32_bf16 v[120:123], v[72:75], a[172:175], v[120:123]
    v_mfma_f32_16x16x32_bf16 v[120:123], v[76:79], a[188:191], v[120:123]
    s_waitcnt lgkmcnt(0)
    v_mfma_f32_16x16x32_bf16 v[100:103], v[80:83], a[128:131], v[100:103]
    ds_read_b128 v[64:67], v224 offset:36864
    v_mfma_f32_16x16x32_bf16 v[100:103], v[84:87], a[144:147], v[100:103]
    ds_read_b128 v[68:71], v225 offset:36864
    v_mfma_f32_16x16x32_bf16 v[100:103], v[88:91], a[160:163], v[100:103]
    ds_read_b128 v[72:75], v224 offset:45056
    v_mfma_f32_16x16x32_bf16 v[100:103], v[92:95], a[176:179], v[100:103]
    ds_read_b128 v[76:79], v225 offset:45056
    v_mfma_f32_16x16x32_bf16 v[108:111], v[80:83], a[132:135], v[108:111]
    v_mfma_f32_16x16x32_bf16 v[108:111], v[84:87], a[148:151], v[108:111]
    v_mfma_f32_16x16x32_bf16 v[108:111], v[88:91], a[164:167], v[108:111]
    v_mfma_f32_16x16x32_bf16 v[108:111], v[92:95], a[180:183], v[108:111]
    v_mfma_f32_16x16x32_bf16 v[116:119], v[80:83], a[136:139], v[116:119]
    s_add_u32 m0, s34, 24576
    s_add_u32 s37, s83, 196608
    buffer_load_dwordx4 v232, s[44:47], s37 offen lds
    v_mfma_f32_16x16x32_bf16 v[116:119], v[84:87], a[152:155], v[116:119]
    v_mfma_f32_16x16x32_bf16 v[116:119], v[88:91], a[168:171], v[116:119]
    buffer_load_dwordx4 v233, s[44:47], s37 offen offset:1024 lds
    s_add_u32 s38, s36, 8192
    buffer_store_dwordx4 v[28:31], v240, s[16:19], s38 offen offset:3072 sc1
    v_mfma_f32_16x16x32_bf16 v[116:119], v[92:95], a[184:187], v[116:119]
    v_mfma_f32_16x16x32_bf16 v[124:127], v[80:83], a[140:143], v[124:127]
    v_mfma_f32_16x16x32_bf16 v[124:127], v[84:87], a[156:159], v[124:127]
    s_add_u32 m0, s31, 5120
    s_add_u32 s24, s27, 163840
    buffer_load_dwordx4 v245, s[12:15], s24 offen lds
    v_mfma_f32_16x16x32_bf16 v[124:127], v[88:91], a[172:175], v[124:127]
    v_mfma_f32_16x16x32_bf16 v[124:127], v[92:95], a[188:191], v[124:127]
    s_waitcnt lgkmcnt(0)
    v_mfma_f32_16x16x32_bf16 v[128:131], v[64:67], a[128:131], v[128:131]
    ds_read_b128 v[80:83], v224 offset:38912
    v_mfma_f32_16x16x32_bf16 v[128:131], v[68:71], a[144:147], v[128:131]
    ds_read_b128 v[84:87], v225 offset:38912
    v_mfma_f32_16x16x32_bf16 v[128:131], v[72:75], a[160:163], v[128:131]
    ds_read_b128 v[88:91], v224 offset:47104
    v_mfma_f32_16x16x32_bf16 v[128:131], v[76:79], a[176:179], v[128:131]
    ds_read_b128 v[92:95], v225 offset:47104
    v_mfma_f32_16x16x32_bf16 v[136:139], v[64:67], a[132:135], v[136:139]
    v_mfma_f32_16x16x32_bf16 v[136:139], v[68:71], a[148:151], v[136:139]
    v_mfma_f32_16x16x32_bf16 v[136:139], v[72:75], a[164:167], v[136:139]
    v_mfma_f32_16x16x32_bf16 v[136:139], v[76:79], a[180:183], v[136:139]
    v_mfma_f32_16x16x32_bf16 v[144:147], v[64:67], a[136:139], v[144:147]
    s_add_u32 m0, s31, 6144
    s_add_u32 s24, s27, 196608
    buffer_load_dwordx4 v237, s[12:15], s24 offen lds
    v_mfma_f32_16x16x32_bf16 v[144:147], v[68:71], a[152:155], v[144:147]
    v_mfma_f32_16x16x32_bf16 v[144:147], v[72:75], a[168:171], v[144:147]
    v_mfma_f32_16x16x32_bf16 v[144:147], v[76:79], a[184:187], v[144:147]
    v_mfma_f32_16x16x32_bf16 v[152:155], v[64:67], a[140:143], v[152:155]
    v_mfma_f32_16x16x32_bf16 v[152:155], v[68:71], a[156:159], v[152:155]
    v_mfma_f32_16x16x32_bf16 v[152:155], v[72:75], a[172:175], v[152:155]
    v_mfma_f32_16x16x32_bf16 v[152:155], v[76:79], a[188:191], v[152:155]
    s_waitcnt vmcnt(22) lgkmcnt(0)
    s_barrier
    v_mfma_f32_16x16x32_bf16 v[132:135], v[80:83], a[128:131], v[132:135]
    ds_read_b128 v[64:67], v224 offset:49152
    s_add_u32 s38, s36, 32768
    buffer_store_dwordx4 v[32:35], v240, s[16:19], s38 offen offset:1280 sc1
    v_mfma_f32_16x16x32_bf16 v[132:135], v[84:87], a[144:147], v[132:135]
    ds_read_b128 v[68:71], v225 offset:49152
    v_mfma_f32_16x16x32_bf16 v[132:135], v[88:91], a[160:163], v[132:135]
    ds_read_b128 v[72:75], v224 offset:57344
    v_mfma_f32_16x16x32_bf16 v[132:135], v[92:95], a[176:179], v[132:135]
    ds_read_b128 v[76:79], v225 offset:57344
    v_mfma_f32_16x16x32_bf16 v[140:143], v[80:83], a[132:135], v[140:143]
    v_mfma_f32_16x16x32_bf16 v[140:143], v[84:87], a[148:151], v[140:143]
    v_mfma_f32_16x16x32_bf16 v[140:143], v[88:91], a[164:167], v[140:143]
    v_mfma_f32_16x16x32_bf16 v[140:143], v[92:95], a[180:183], v[140:143]
    v_mfma_f32_16x16x32_bf16 v[148:151], v[80:83], a[136:139], v[148:151]
    s_add_u32 m0, s34, 32768
    s_add_u32 s37, s84, 196608
    buffer_load_dwordx4 v232, s[44:47], s37 offen lds
    v_mfma_f32_16x16x32_bf16 v[148:151], v[84:87], a[152:155], v[148:151]
    buffer_load_dwordx4 v233, s[44:47], s37 offen offset:1024 lds
    v_mfma_f32_16x16x32_bf16 v[148:151], v[88:91], a[168:171], v[148:151]
    v_mfma_f32_16x16x32_bf16 v[148:151], v[92:95], a[184:187], v[148:151]
    s_add_u32 m0, s31, 7168
    s_add_u32 s24, s27, 229376
    buffer_load_dwordx4 v237, s[12:15], s24 offen lds
    v_mfma_f32_16x16x32_bf16 v[156:159], v[80:83], a[140:143], v[156:159]
    s_add_u32 s27, s27, 1048576
    s_and_b32 s27, s27, 0x407fffff
    s_cmp_eq_u32 s27, s7
    s_cselect_b32 s27, s43, s27
    v_mfma_f32_16x16x32_bf16 v[156:159], v[84:87], a[156:159], v[156:159]
    v_mfma_f32_16x16x32_bf16 v[156:159], v[88:91], a[172:175], v[156:159]
    s_add_u32 s31, s31, 32768
    s_cmp_ge_u32 s31, 163840
    s_cselect_b32 s24, 98304, 0
    s_sub_u32 s31, s31, s24
    v_mfma_f32_16x16x32_bf16 v[156:159], v[92:95], a[188:191], v[156:159]
    s_waitcnt lgkmcnt(0)
    v_mfma_f32_16x16x32_bf16 v[96:99], v[64:67], a[192:195], v[96:99]
    ds_read_b128 v[80:83], v224 offset:51200
    v_mfma_f32_16x16x32_bf16 v[96:99], v[68:71], a[208:211], v[96:99]
    ds_read_b128 v[84:87], v225 offset:51200
    v_mfma_f32_16x16x32_bf16 v[96:99], v[72:75], a[224:227], v[96:99]
    ds_read_b128 v[88:91], v224 offset:59392
    v_mfma_f32_16x16x32_bf16 v[96:99], v[76:79], a[240:243], v[96:99]
    ds_read_b128 v[92:95], v225 offset:59392
    v_mfma_f32_16x16x32_bf16 v[104:107], v[64:67], a[196:199], v[104:107]
    v_mfma_f32_16x16x32_bf16 v[104:107], v[68:71], a[212:215], v[104:107]
    v_mfma_f32_16x16x32_bf16 v[104:107], v[72:75], a[228:231], v[104:107]
    s_add_u32 s38, s36, 32768
    buffer_store_dwordx4 v[36:39], v240, s[16:19], s38 offen offset:2304 sc1
    v_mfma_f32_16x16x32_bf16 v[104:107], v[76:79], a[244:247], v[104:107]
    v_mfma_f32_16x16x32_bf16 v[112:115], v[64:67], a[200:203], v[112:115]
    v_mfma_f32_16x16x32_bf16 v[112:115], v[68:71], a[216:219], v[112:115]
    v_mfma_f32_16x16x32_bf16 v[112:115], v[72:75], a[232:235], v[112:115]
    v_mfma_f32_16x16x32_bf16 v[112:115], v[76:79], a[248:251], v[112:115]
    v_mfma_f32_16x16x32_bf16 v[120:123], v[64:67], a[204:207], v[120:123]
    v_mfma_f32_16x16x32_bf16 v[120:123], v[68:71], a[220:223], v[120:123]
    v_mfma_f32_16x16x32_bf16 v[120:123], v[72:75], a[236:239], v[120:123]
    v_mfma_f32_16x16x32_bf16 v[120:123], v[76:79], a[252:255], v[120:123]
    s_waitcnt lgkmcnt(0)
    v_mfma_f32_16x16x32_bf16 v[100:103], v[80:83], a[192:195], v[100:103]
    ds_read_b128 v[64:67], v224 offset:53248
    v_mfma_f32_16x16x32_bf16 v[100:103], v[84:87], a[208:211], v[100:103]
    ds_read_b128 v[68:71], v225 offset:53248
    v_mfma_f32_16x16x32_bf16 v[100:103], v[88:91], a[224:227], v[100:103]
    ds_read_b128 v[72:75], v224 offset:61440
    v_mfma_f32_16x16x32_bf16 v[100:103], v[92:95], a[240:243], v[100:103]
    ds_read_b128 v[76:79], v225 offset:61440
    v_mfma_f32_16x16x32_bf16 v[108:111], v[80:83], a[196:199], v[108:111]
    v_mfma_f32_16x16x32_bf16 v[108:111], v[84:87], a[212:215], v[108:111]
    v_mfma_f32_16x16x32_bf16 v[108:111], v[88:91], a[228:231], v[108:111]
    v_mfma_f32_16x16x32_bf16 v[108:111], v[92:95], a[244:247], v[108:111]
    v_mfma_f32_16x16x32_bf16 v[116:119], v[80:83], a[200:203], v[116:119]
    s_add_u32 m0, s34, 40960
    s_add_u32 s37, s85, 196608
    buffer_load_dwordx4 v232, s[44:47], s37 offen lds
    v_mfma_f32_16x16x32_bf16 v[116:119], v[84:87], a[216:219], v[116:119]
    v_mfma_f32_16x16x32_bf16 v[116:119], v[88:91], a[232:235], v[116:119]
    v_mfma_f32_16x16x32_bf16 v[116:119], v[92:95], a[248:251], v[116:119]
    s_add_u32 s38, s36, 32768
    buffer_store_dwordx4 v[40:43], v240, s[16:19], s38 offen offset:3328 sc1
    v_mfma_f32_16x16x32_bf16 v[124:127], v[80:83], a[204:207], v[124:127]
    buffer_load_dwordx4 v233, s[44:47], s37 offen offset:1024 lds
    v_mfma_f32_16x16x32_bf16 v[124:127], v[84:87], a[220:223], v[124:127]
    v_mfma_f32_16x16x32_bf16 v[124:127], v[88:91], a[236:239], v[124:127]
    v_mfma_f32_16x16x32_bf16 v[124:127], v[92:95], a[252:255], v[124:127]
    s_waitcnt lgkmcnt(0)
    v_mfma_f32_16x16x32_bf16 v[128:131], v[64:67], a[192:195], v[128:131]
    ds_read_b128 v[80:83], v224 offset:55296
    v_mfma_f32_16x16x32_bf16 v[128:131], v[68:71], a[208:211], v[128:131]
    ds_read_b128 v[84:87], v225 offset:55296
    v_mfma_f32_16x16x32_bf16 v[128:131], v[72:75], a[224:227], v[128:131]
    ds_read_b128 v[88:91], v224 offset:63488
    v_mfma_f32_16x16x32_bf16 v[128:131], v[76:79], a[240:243], v[128:131]
    ds_read_b128 v[92:95], v225 offset:63488
    v_mfma_f32_16x16x32_bf16 v[136:139], v[64:67], a[196:199], v[136:139]
    v_mfma_f32_16x16x32_bf16 v[136:139], v[68:71], a[212:215], v[136:139]
    v_mfma_f32_16x16x32_bf16 v[136:139], v[72:75], a[228:231], v[136:139]
    v_mfma_f32_16x16x32_bf16 v[136:139], v[76:79], a[244:247], v[136:139]
    v_mfma_f32_16x16x32_bf16 v[144:147], v[64:67], a[200:203], v[144:147]
    s_add_u32 m0, s31, 0
    s_add_u32 s24, s27, 0
    buffer_load_dwordx4 v245, s[12:15], s24 offen lds
    v_mfma_f32_16x16x32_bf16 v[144:147], v[68:71], a[216:219], v[144:147]
    v_mfma_f32_16x16x32_bf16 v[144:147], v[72:75], a[232:235], v[144:147]
    v_mfma_f32_16x16x32_bf16 v[144:147], v[76:79], a[248:251], v[144:147]
    v_mfma_f32_16x16x32_bf16 v[152:155], v[64:67], a[204:207], v[152:155]
    v_mfma_f32_16x16x32_bf16 v[152:155], v[68:71], a[220:223], v[152:155]
    v_mfma_f32_16x16x32_bf16 v[152:155], v[72:75], a[236:239], v[152:155]
    v_mfma_f32_16x16x32_bf16 v[152:155], v[76:79], a[252:255], v[152:155]
    s_waitcnt vmcnt(23) lgkmcnt(0)
    s_barrier
    v_mfma_f32_16x16x32_bf16 v[132:135], v[80:83], a[192:195], v[132:135]
    ds_read_b128 v[64:67], v224 offset:0
    v_mfma_f32_16x16x32_bf16 v[132:135], v[84:87], a[208:211], v[132:135]
    ds_read_b128 v[68:71], v225 offset:0
    s_add_u32 s38, s36, 36864
    buffer_store_dwordx4 v[44:47], v240, s[16:19], s38 offen offset:256 sc1
    v_mfma_f32_16x16x32_bf16 v[132:135], v[88:91], a[224:227], v[132:135]
    ds_read_b128 v[72:75], v224 offset:8192
    v_mfma_f32_16x16x32_bf16 v[132:135], v[92:95], a[240:243], v[132:135]
    ds_read_b128 v[76:79], v225 offset:8192
    v_mfma_f32_16x16x32_bf16 v[140:143], v[80:83], a[196:199], v[140:143]
    v_mfma_f32_16x16x32_bf16 v[140:143], v[84:87], a[212:215], v[140:143]
    v_mfma_f32_16x16x32_bf16 v[140:143], v[88:91], a[228:231], v[140:143]
    v_mfma_f32_16x16x32_bf16 v[140:143], v[92:95], a[244:247], v[140:143]
    v_mfma_f32_16x16x32_bf16 v[148:151], v[80:83], a[200:203], v[148:151]
    s_add_u32 m0, s34, 49152
    s_add_u32 s37, s86, 196608
    buffer_load_dwordx4 v232, s[44:47], s37 offen lds
    v_mfma_f32_16x16x32_bf16 v[148:151], v[84:87], a[216:219], v[148:151]
    v_mfma_f32_16x16x32_bf16 v[148:151], v[88:91], a[232:235], v[148:151]
    buffer_load_dwordx4 v233, s[44:47], s37 offen offset:1024 lds
    v_mfma_f32_16x16x32_bf16 v[148:151], v[92:95], a[248:251], v[148:151]
    v_mfma_f32_16x16x32_bf16 v[156:159], v[80:83], a[204:207], v[156:159]
    v_mfma_f32_16x16x32_bf16 v[156:159], v[84:87], a[220:223], v[156:159]
    s_add_u32 m0, s31, 1024
    s_add_u32 s24, s27, 32768
    buffer_load_dwordx4 v245, s[12:15], s24 offen lds
    v_mfma_f32_16x16x32_bf16 v[156:159], v[88:91], a[236:239], v[156:159]
    v_mfma_f32_16x16x32_bf16 v[156:159], v[92:95], a[252:255], v[156:159]
    s_waitcnt lgkmcnt(0)
    v_mfma_f32_16x16x32_bf16 v[160:163], v[64:67], a[0:3], 0
    ds_read_b128 v[80:83], v224 offset:2048
    v_mfma_f32_16x16x32_bf16 v[160:163], v[68:71], a[16:19], v[160:163]
    ds_read_b128 v[84:87], v225 offset:2048
    v_mfma_f32_16x16x32_bf16 v[160:163], v[72:75], a[32:35], v[160:163]
    ds_read_b128 v[88:91], v224 offset:10240
    v_mfma_f32_16x16x32_bf16 v[160:163], v[76:79], a[48:51], v[160:163]
    ds_read_b128 v[92:95], v225 offset:10240
    v_mfma_f32_16x16x32_bf16 v[168:171], v[64:67], a[4:7], 0
    v_cvt_pk_bf16_f32 v0, v96, v97
    v_cvt_pk_bf16_f32 v1, v98, v99
    v_mfma_f32_16x16x32_bf16 v[168:171], v[68:71], a[20:23], v[168:171]
    v_mfma_f32_16x16x32_bf16 v[168:171], v[72:75], a[36:39], v[168:171]
    v_cvt_pk_bf16_f32 v2, v100, v101
    v_cvt_pk_bf16_f32 v3, v102, v103
    s_add_u32 s38, s36, 40960
    buffer_store_dwordx4 v[48:51], v240, s[16:19], s38 offen offset:1280 sc1
    v_mfma_f32_16x16x32_bf16 v[168:171], v[76:79], a[52:55], v[168:171]
    v_mfma_f32_16x16x32_bf16 v[176:179], v[64:67], a[8:11], 0
    s_add_u32 m0, s31, 2048
    s_add_u32 s24, s27, 65536
    buffer_load_dwordx4 v237, s[12:15], s24 offen lds
    v_cvt_pk_bf16_f32 v4, v104, v105
    v_cvt_pk_bf16_f32 v5, v106, v107
    v_mfma_f32_16x16x32_bf16 v[176:179], v[68:71], a[24:27], v[176:179]
    v_mfma_f32_16x16x32_bf16 v[176:179], v[72:75], a[40:43], v[176:179]
    v_cvt_pk_bf16_f32 v6, v108, v109
    v_cvt_pk_bf16_f32 v7, v110, v111
    v_mfma_f32_16x16x32_bf16 v[176:179], v[76:79], a[56:59], v[176:179]
    v_mfma_f32_16x16x32_bf16 v[184:187], v[64:67], a[12:15], 0
    v_cvt_pk_bf16_f32 v8, v112, v113
    v_cvt_pk_bf16_f32 v9, v114, v115
    v_mfma_f32_16x16x32_bf16 v[184:187], v[68:71], a[28:31], v[184:187]
    v_mfma_f32_16x16x32_bf16 v[184:187], v[72:75], a[44:47], v[184:187]
    v_cvt_pk_bf16_f32 v10, v116, v117
    v_cvt_pk_bf16_f32 v11, v118, v119
    v_mfma_f32_16x16x32_bf16 v[184:187], v[76:79], a[60:63], v[184:187]
    s_waitcnt lgkmcnt(0)
    v_mfma_f32_16x16x32_bf16 v[164:167], v[80:83], a[0:3], 0
    ds_read_b128 v[64:67], v224 offset:4096
    v_cvt_pk_bf16_f32 v12, v120, v121
    v_cvt_pk_bf16_f32 v13, v122, v123
    v_mfma_f32_16x16x32_bf16 v[164:167], v[84:87], a[16:19], v[164:167]
    ds_read_b128 v[68:71], v225 offset:4096
    v_mfma_f32_16x16x32_bf16 v[164:167], v[88:91], a[32:35], v[164:167]
    ds_read_b128 v[72:75], v224 offset:12288
    v_cvt_pk_bf16_f32 v14, v124, v125
    v_cvt_pk_bf16_f32 v15, v126, v127
    v_mfma_f32_16x16x32_bf16 v[164:167], v[92:95], a[48:51], v[164:167]
    ds_read_b128 v[76:79], v225 offset:12288
    v_mfma_f32_16x16x32_bf16 v[172:175], v[80:83], a[4:7], 0
    v_cvt_pk_bf16_f32 v16, v128, v129
    v_cvt_pk_bf16_f32 v17, v130, v131
    v_mfma_f32_16x16x32_bf16 v[172:175], v[84:87], a[20:23], v[172:175]
    v_mfma_f32_16x16x32_bf16 v[172:175], v[88:91], a[36:39], v[172:175]
    v_cvt_pk_bf16_f32 v18, v132, v133
    v_cvt_pk_bf16_f32 v19, v134, v135
    v_mfma_f32_16x16x32_bf16 v[172:175], v[92:95], a[52:55], v[172:175]
    v_mfma_f32_16x16x32_bf16 v[180:183], v[80:83], a[8:11], 0
    s_add_u32 m0, s34, 57344
    s_add_u32 s37, s87, 196608
    buffer_load_dwordx4 v232, s[44:47], s37 offen lds
    v_cvt_pk_bf16_f32 v20, v136, v137
    v_cvt_pk_bf16_f32 v21, v138, v139
    v_mfma_f32_16x16x32_bf16 v[180:183], v[84:87], a[24:27], v[180:183]
    v_mfma_f32_16x16x32_bf16 v[180:183], v[88:91], a[40:43], v[180:183]
    buffer_load_dwordx4 v233, s[44:47], s37 offen offset:1024 lds
    v_cvt_pk_bf16_f32 v22, v140, v141
    v_cvt_pk_bf16_f32 v23, v142, v143
    v_mfma_f32_16x16x32_bf16 v[180:183], v[92:95], a[56:59], v[180:183]
    v_mfma_f32_16x16x32_bf16 v[188:191], v[80:83], a[12:15], 0
    v_cvt_pk_bf16_f32 v24, v144, v145
    v_cvt_pk_bf16_f32 v25, v146, v147
    s_add_u32 s38, s36, 40960
    buffer_store_dwordx4 v[52:55], v240, s[16:19], s38 offen offset:2304 sc1
    v_mfma_f32_16x16x32_bf16 v[188:191], v[84:87], a[28:31], v[188:191]
    s_add_u32 m0, s31, 3072
    s_add_u32 s24, s27, 98304
    buffer_load_dwordx4 v237, s[12:15], s24 offen lds
    v_mfma_f32_16x16x32_bf16 v[188:191], v[88:91], a[44:47], v[188:191]
    v_cvt_pk_bf16_f32 v26, v148, v149
    v_cvt_pk_bf16_f32 v27, v150, v151
    v_mfma_f32_16x16x32_bf16 v[188:191], v[92:95], a[60:63], v[188:191]
    s_waitcnt lgkmcnt(0)
    v_mfma_f32_16x16x32_bf16 v[192:195], v[64:67], a[0:3], 0
    ds_read_b128 v[80:83], v224 offset:6144
    v_cvt_pk_bf16_f32 v28, v152, v153
    v_cvt_pk_bf16_f32 v29, v154, v155
    v_mfma_f32_16x16x32_bf16 v[192:195], v[68:71], a[16:19], v[192:195]
    ds_read_b128 v[84:87], v225 offset:6144
    v_mfma_f32_16x16x32_bf16 v[192:195], v[72:75], a[32:35], v[192:195]
    ds_read_b128 v[88:91], v224 offset:14336
    v_cvt_pk_bf16_f32 v30, v156, v157
    v_cvt_pk_bf16_f32 v31, v158, v159
    v_mfma_f32_16x16x32_bf16 v[192:195], v[76:79], a[48:51], v[192:195]
    ds_read_b128 v[92:95], v225 offset:14336
    v_mfma_f32_16x16x32_bf16 v[200:203], v[64:67], a[4:7], 0
    v_mfma_f32_16x16x32_bf16 v[200:203], v[68:71], a[20:23], v[200:203]
    v_mfma_f32_16x16x32_bf16 v[200:203], v[72:75], a[36:39], v[200:203]
    v_mfma_f32_16x16x32_bf16 v[200:203], v[76:79], a[52:55], v[200:203]
    v_mfma_f32_16x16x32_bf16 v[208:211], v[64:67], a[8:11], 0
    s_add_u32 m0, s31, 4096
    s_add_u32 s24, s27, 131072
    buffer_load_dwordx4 v245, s[12:15], s24 offen lds
    v_mfma_f32_16x16x32_bf16 v[208:211], v[68:71], a[24:27], v[208:211]
    v_mfma_f32_16x16x32_bf16 v[208:211], v[72:75], a[40:43], v[208:211]
    v_mfma_f32_16x16x32_bf16 v[208:211], v[76:79], a[56:59], v[208:211]
    v_mfma_f32_16x16x32_bf16 v[216:219], v[64:67], a[12:15], 0
    v_mfma_f32_16x16x32_bf16 v[216:219], v[68:71], a[28:31], v[216:219]
    v_mfma_f32_16x16x32_bf16 v[216:219], v[72:75], a[44:47], v[216:219]
    v_mfma_f32_16x16x32_bf16 v[216:219], v[76:79], a[60:63], v[216:219]
    s_waitcnt vmcnt(23) lgkmcnt(0)
    s_barrier
    v_mfma_f32_16x16x32_bf16 v[196:199], v[80:83], a[0:3], 0
    ds_read_b128 v[64:67], v224 offset:16384
    v_mfma_f32_16x16x32_bf16 v[196:199], v[84:87], a[16:19], v[196:199]
    ds_read_b128 v[68:71], v225 offset:16384
    s_add_u32 s38, s36, 40960
    buffer_store_dwordx4 v[56:59], v240, s[16:19], s38 offen offset:3328 sc1
    v_mfma_f32_16x16x32_bf16 v[196:199], v[88:91], a[32:35], v[196:199]
    ds_read_b128 v[72:75], v224 offset:24576
    v_mfma_f32_16x16x32_bf16 v[196:199], v[92:95], a[48:51], v[196:199]
    ds_read_b128 v[76:79], v225 offset:24576
    v_mfma_f32_16x16x32_bf16 v[204:207], v[80:83], a[4:7], 0
    v_mfma_f32_16x16x32_bf16 v[204:207], v[84:87], a[20:23], v[204:207]
    v_mfma_f32_16x16x32_bf16 v[204:207], v[88:91], a[36:39], v[204:207]
    v_mfma_f32_16x16x32_bf16 v[204:207], v[92:95], a[52:55], v[204:207]
    v_mfma_f32_16x16x32_bf16 v[212:215], v[80:83], a[8:11], 0
    s_add_u32 m0, s31, 5120
    s_add_u32 s24, s27, 163840
    buffer_load_dwordx4 v245, s[12:15], s24 offen lds
    v_mfma_f32_16x16x32_bf16 v[212:215], v[84:87], a[24:27], v[212:215]
    v_mfma_f32_16x16x32_bf16 v[212:215], v[88:91], a[40:43], v[212:215]
    v_mfma_f32_16x16x32_bf16 v[212:215], v[92:95], a[56:59], v[212:215]
    v_mfma_f32_16x16x32_bf16 v[220:223], v[80:83], a[12:15], 0
    v_mfma_f32_16x16x32_bf16 v[220:223], v[84:87], a[28:31], v[220:223]
    v_mfma_f32_16x16x32_bf16 v[220:223], v[88:91], a[44:47], v[220:223]
    v_mfma_f32_16x16x32_bf16 v[220:223], v[92:95], a[60:63], v[220:223]
    s_waitcnt lgkmcnt(0)
    v_mfma_f32_16x16x32_bf16 v[160:163], v[64:67], a[64:67], v[160:163]
    ds_read_b128 v[80:83], v224 offset:18432
    v_mfma_f32_16x16x32_bf16 v[160:163], v[68:71], a[80:83], v[160:163]
    ds_read_b128 v[84:87], v225 offset:18432
    v_mfma_f32_16x16x32_bf16 v[160:163], v[72:75], a[96:99], v[160:163]
    ds_read_b128 v[88:91], v224 offset:26624
    v_mfma_f32_16x16x32_bf16 v[160:163], v[76:79], a[112:115], v[160:163]
    ds_read_b128 v[92:95], v225 offset:26624
    v_mfma_f32_16x16x32_bf16 v[168:171], v[64:67], a[68:71], v[168:171]
    v_mfma_f32_16x16x32_bf16 v[168:171], v[68:71], a[84:87], v[168:171]
    v_mfma_f32_16x16x32_bf16 v[168:171], v[72:75], a[100:103], v[168:171]
    v_mfma_f32_16x16x32_bf16 v[168:171], v[76:79], a[116:119], v[168:171]
    s_add_u32 s38, s36, 45056
    buffer_store_dwordx4 v[60:63], v240, s[16:19], s38 offen offset:256 sc1
    v_mfma_f32_16x16x32_bf16 v[176:179], v[64:67], a[72:75], v[176:179]
    s_add_u32 m0, s31, 6144
    s_add_u32 s24, s27, 196608
    buffer_load_dwordx4 v237, s[12:15], s24 offen lds
    v_mfma_f32_16x16x32_bf16 v[176:179], v[68:71], a[88:91], v[176:179]
    v_mfma_f32_16x16x32_bf16 v[176:179], v[72:75], a[104:107], v[176:179]
    v_mfma_f32_16x16x32_bf16 v[176:179], v[76:79], a[120:123], v[176:179]
    v_mfma_f32_16x16x32_bf16 v[184:187], v[64:67], a[76:79], v[184:187]
    v_mfma_f32_16x16x32_bf16 v[184:187], v[68:71], a[92:95], v[184:187]
    v_mfma_f32_16x16x32_bf16 v[184:187], v[72:75], a[108:111], v[184:187]
    v_mfma_f32_16x16x32_bf16 v[184:187], v[76:79], a[124:127], v[184:187]
    s_waitcnt lgkmcnt(0)
    v_mfma_f32_16x16x32_bf16 v[164:167], v[80:83], a[64:67], v[164:167]
    ds_read_b128 v[64:67], v224 offset:20480
    v_mfma_f32_16x16x32_bf16 v[164:167], v[84:87], a[80:83], v[164:167]
    ds_read_b128 v[68:71], v225 offset:20480
    v_mfma_f32_16x16x32_bf16 v[164:167], v[88:91], a[96:99], v[164:167]
    ds_read_b128 v[72:75], v224 offset:28672
    v_mfma_f32_16x16x32_bf16 v[164:167], v[92:95], a[112:115], v[164:167]
    ds_read_b128 v[76:79], v225 offset:28672
    v_mfma_f32_16x16x32_bf16 v[172:175], v[80:83], a[68:71], v[172:175]
    v_mfma_f32_16x16x32_bf16 v[172:175], v[84:87], a[84:87], v[172:175]
    v_mfma_f32_16x16x32_bf16 v[172:175], v[88:91], a[100:103], v[172:175]
    v_mfma_f32_16x16x32_bf16 v[172:175], v[92:95], a[116:119], v[172:175]
    v_mfma_f32_16x16x32_bf16 v[180:183], v[80:83], a[72:75], v[180:183]
    s_add_u32 m0, s31, 7168
    s_add_u32 s24, s27, 229376
    buffer_load_dwordx4 v237, s[12:15], s24 offen lds
    v_mfma_f32_16x16x32_bf16 v[180:183], v[84:87], a[88:91], v[180:183]
    v_mfma_f32_16x16x32_bf16 v[180:183], v[88:91], a[104:107], v[180:183]
    s_add_u32 s27, s27, 1048576
    s_and_b32 s27, s27, 0x407fffff
    s_cmp_eq_u32 s27, s7
    s_cselect_b32 s27, s43, s27
    v_mfma_f32_16x16x32_bf16 v[180:183], v[92:95], a[120:123], v[180:183]
    v_mfma_f32_16x16x32_bf16 v[188:191], v[80:83], a[76:79], v[188:191]
    v_mfma_f32_16x16x32_bf16 v[188:191], v[84:87], a[92:95], v[188:191]
    s_add_u32 s31, s31, 32768
    s_cmp_ge_u32 s31, 163840
    s_cselect_b32 s24, 98304, 0
    s_sub_u32 s31, s31, s24
    s_add_u32 s38, s36, 65536
    buffer_store_dwordx4 v[0:3], v240, s[16:19], s38 offen offset:2560 sc1
    v_mfma_f32_16x16x32_bf16 v[188:191], v[88:91], a[108:111], v[188:191]
    v_mfma_f32_16x16x32_bf16 v[188:191], v[92:95], a[124:127], v[188:191]
    s_waitcnt lgkmcnt(0)
    v_mfma_f32_16x16x32_bf16 v[192:195], v[64:67], a[64:67], v[192:195]
    ds_read_b128 v[80:83], v224 offset:22528
    v_mfma_f32_16x16x32_bf16 v[192:195], v[68:71], a[80:83], v[192:195]
    ds_read_b128 v[84:87], v225 offset:22528
    v_mfma_f32_16x16x32_bf16 v[192:195], v[72:75], a[96:99], v[192:195]
    ds_read_b128 v[88:91], v224 offset:30720
    v_mfma_f32_16x16x32_bf16 v[192:195], v[76:79], a[112:115], v[192:195]
    ds_read_b128 v[92:95], v225 offset:30720
    v_mfma_f32_16x16x32_bf16 v[200:203], v[64:67], a[68:71], v[200:203]
    v_mfma_f32_16x16x32_bf16 v[200:203], v[68:71], a[84:87], v[200:203]
    v_mfma_f32_16x16x32_bf16 v[200:203], v[72:75], a[100:103], v[200:203]
    v_mfma_f32_16x16x32_bf16 v[200:203], v[76:79], a[116:119], v[200:203]
    v_mfma_f32_16x16x32_bf16 v[208:211], v[64:67], a[72:75], v[208:211]
    v_mfma_f32_16x16x32_bf16 v[208:211], v[68:71], a[88:91], v[208:211]
    v_mfma_f32_16x16x32_bf16 v[208:211], v[72:75], a[104:107], v[208:211]
    v_mfma_f32_16x16x32_bf16 v[208:211], v[76:79], a[120:123], v[208:211]
    v_mfma_f32_16x16x32_bf16 v[216:219], v[64:67], a[76:79], v[216:219]
    v_mfma_f32_16x16x32_bf16 v[216:219], v[68:71], a[92:95], v[216:219]
    v_mfma_f32_16x16x32_bf16 v[216:219], v[72:75], a[108:111], v[216:219]
    v_mfma_f32_16x16x32_bf16 v[216:219], v[76:79], a[124:127], v[216:219]
    s_waitcnt vmcnt(9) lgkmcnt(0)
    s_barrier
    v_mfma_f32_16x16x32_bf16 v[196:199], v[80:83], a[64:67], v[196:199]
    ds_read_b128 v[64:67], v224 offset:32768
    v_mfma_f32_16x16x32_bf16 v[196:199], v[84:87], a[80:83], v[196:199]
    ds_read_b128 v[68:71], v225 offset:32768
    v_mfma_f32_16x16x32_bf16 v[196:199], v[88:91], a[96:99], v[196:199]
    ds_read_b128 v[72:75], v224 offset:40960
    s_add_u32 s38, s36, 65536
    buffer_store_dwordx4 v[4:7], v240, s[16:19], s38 offen offset:3584 sc1
    v_mfma_f32_16x16x32_bf16 v[196:199], v[92:95], a[112:115], v[196:199]
    ds_read_b128 v[76:79], v225 offset:40960
    v_mfma_f32_16x16x32_bf16 v[204:207], v[80:83], a[68:71], v[204:207]
    v_mfma_f32_16x16x32_bf16 v[204:207], v[84:87], a[84:87], v[204:207]
    v_mfma_f32_16x16x32_bf16 v[204:207], v[88:91], a[100:103], v[204:207]
    v_mfma_f32_16x16x32_bf16 v[204:207], v[92:95], a[116:119], v[204:207]
    v_mfma_f32_16x16x32_bf16 v[212:215], v[80:83], a[72:75], v[212:215]
    v_mfma_f32_16x16x32_bf16 v[212:215], v[84:87], a[88:91], v[212:215]
    v_mfma_f32_16x16x32_bf16 v[212:215], v[88:91], a[104:107], v[212:215]
    v_mfma_f32_16x16x32_bf16 v[212:215], v[92:95], a[120:123], v[212:215]
    v_mfma_f32_16x16x32_bf16 v[220:223], v[80:83], a[76:79], v[220:223]
    v_mfma_f32_16x16x32_bf16 v[220:223], v[84:87], a[92:95], v[220:223]
    v_mfma_f32_16x16x32_bf16 v[220:223], v[88:91], a[108:111], v[220:223]
    v_mfma_f32_16x16x32_bf16 v[220:223], v[92:95], a[124:127], v[220:223]
    s_waitcnt lgkmcnt(0)
    v_mfma_f32_16x16x32_bf16 v[160:163], v[64:67], a[128:131], v[160:163]
    ds_read_b128 v[80:83], v224 offset:34816
    v_mfma_f32_16x16x32_bf16 v[160:163], v[68:71], a[144:147], v[160:163]
    ds_read_b128 v[84:87], v225 offset:34816
    v_mfma_f32_16x16x32_bf16 v[160:163], v[72:75], a[160:163], v[160:163]
    ds_read_b128 v[88:91], v224 offset:43008
    v_mfma_f32_16x16x32_bf16 v[160:163], v[76:79], a[176:179], v[160:163]
    ds_read_b128 v[92:95], v225 offset:43008
    v_mfma_f32_16x16x32_bf16 v[168:171], v[64:67], a[132:135], v[168:171]
    v_mfma_f32_16x16x32_bf16 v[168:171], v[68:71], a[148:151], v[168:171]
    v_mfma_f32_16x16x32_bf16 v[168:171], v[72:75], a[164:167], v[168:171]
    v_mfma_f32_16x16x32_bf16 v[168:171], v[76:79], a[180:183], v[168:171]
    v_mfma_f32_16x16x32_bf16 v[176:179], v[64:67], a[136:139], v[176:179]
    buffer_load_dword v254, off, s[88:91], s39 sc1
    s_add_u32 s38, s36, 69632
    buffer_store_dwordx4 v[8:11], v240, s[16:19], s38 offen offset:512 sc1
    v_mfma_f32_16x16x32_bf16 v[176:179], v[68:71], a[152:155], v[176:179]
    v_mfma_f32_16x16x32_bf16 v[176:179], v[72:75], a[168:171], v[176:179]
    v_mfma_f32_16x16x32_bf16 v[176:179], v[76:79], a[184:187], v[176:179]
    v_mfma_f32_16x16x32_bf16 v[184:187], v[64:67], a[140:143], v[184:187]
    v_mfma_f32_16x16x32_bf16 v[184:187], v[68:71], a[156:159], v[184:187]
    v_mfma_f32_16x16x32_bf16 v[184:187], v[72:75], a[172:175], v[184:187]
    v_mfma_f32_16x16x32_bf16 v[184:187], v[76:79], a[188:191], v[184:187]
    s_waitcnt lgkmcnt(0)
    v_mfma_f32_16x16x32_bf16 v[164:167], v[80:83], a[128:131], v[164:167]
    ds_read_b128 v[64:67], v224 offset:36864
    v_mfma_f32_16x16x32_bf16 v[164:167], v[84:87], a[144:147], v[164:167]
    ds_read_b128 v[68:71], v225 offset:36864
    v_mfma_f32_16x16x32_bf16 v[164:167], v[88:91], a[160:163], v[164:167]
    ds_read_b128 v[72:75], v224 offset:45056
    v_mfma_f32_16x16x32_bf16 v[164:167], v[92:95], a[176:179], v[164:167]
    ds_read_b128 v[76:79], v225 offset:45056
    v_mfma_f32_16x16x32_bf16 v[172:175], v[80:83], a[132:135], v[172:175]
    v_mfma_f32_16x16x32_bf16 v[172:175], v[84:87], a[148:151], v[172:175]
    v_mfma_f32_16x16x32_bf16 v[172:175], v[88:91], a[164:167], v[172:175]
    v_mfma_f32_16x16x32_bf16 v[172:175], v[92:95], a[180:183], v[172:175]
    v_mfma_f32_16x16x32_bf16 v[180:183], v[80:83], a[136:139], v[180:183]
    v_mfma_f32_16x16x32_bf16 v[180:183], v[84:87], a[152:155], v[180:183]
    v_mfma_f32_16x16x32_bf16 v[180:183], v[88:91], a[168:171], v[180:183]
    v_mfma_f32_16x16x32_bf16 v[180:183], v[92:95], a[184:187], v[180:183]
    v_mfma_f32_16x16x32_bf16 v[188:191], v[80:83], a[140:143], v[188:191]
    v_mfma_f32_16x16x32_bf16 v[188:191], v[84:87], a[156:159], v[188:191]
    s_add_u32 s38, s36, 69632
    buffer_store_dwordx4 v[12:15], v240, s[16:19], s38 offen offset:1536 sc1
    v_mfma_f32_16x16x32_bf16 v[188:191], v[88:91], a[172:175], v[188:191]
    v_mfma_f32_16x16x32_bf16 v[188:191], v[92:95], a[188:191], v[188:191]
    s_waitcnt lgkmcnt(0)
    v_mfma_f32_16x16x32_bf16 v[192:195], v[64:67], a[128:131], v[192:195]
    ds_read_b128 v[80:83], v224 offset:38912
    v_mfma_f32_16x16x32_bf16 v[192:195], v[68:71], a[144:147], v[192:195]
    ds_read_b128 v[84:87], v225 offset:38912
    v_mfma_f32_16x16x32_bf16 v[192:195], v[72:75], a[160:163], v[192:195]
    ds_read_b128 v[88:91], v224 offset:47104
    v_mfma_f32_16x16x32_bf16 v[192:195], v[76:79], a[176:179], v[192:195]
    ds_read_b128 v[92:95], v225 offset:47104
    v_mfma_f32_16x16x32_bf16 v[200:203], v[64:67], a[132:135], v[200:203]
    v_mfma_f32_16x16x32_bf16 v[200:203], v[68:71], a[148:151], v[200:203]
    v_mfma_f32_16x16x32_bf16 v[200:203], v[72:75], a[164:167], v[200:203]
    v_mfma_f32_16x16x32_bf16 v[200:203], v[76:79], a[180:183], v[200:203]
    v_mfma_f32_16x16x32_bf16 v[208:211], v[64:67], a[136:139], v[208:211]
    v_mfma_f32_16x16x32_bf16 v[208:211], v[68:71], a[152:155], v[208:211]
    v_mfma_f32_16x16x32_bf16 v[208:211], v[72:75], a[168:171], v[208:211]
    v_mfma_f32_16x16x32_bf16 v[208:211], v[76:79], a[184:187], v[208:211]
    v_mfma_f32_16x16x32_bf16 v[216:219], v[64:67], a[140:143], v[216:219]
    v_mfma_f32_16x16x32_bf16 v[216:219], v[68:71], a[156:159], v[216:219]
    v_mfma_f32_16x16x32_bf16 v[216:219], v[72:75], a[172:175], v[216:219]
    v_mfma_f32_16x16x32_bf16 v[216:219], v[76:79], a[188:191], v[216:219]
    s_waitcnt lgkmcnt(0)
    v_mfma_f32_16x16x32_bf16 v[196:199], v[80:83], a[128:131], v[196:199]
    ds_read_b128 v[64:67], v224 offset:49152
    v_mfma_f32_16x16x32_bf16 v[196:199], v[84:87], a[144:147], v[196:199]
    ds_read_b128 v[68:71], v224 offset:51200
    v_mfma_f32_16x16x32_bf16 v[196:199], v[88:91], a[160:163], v[196:199]
    ds_read_b128 v[72:75], v224 offset:53248
    v_mfma_f32_16x16x32_bf16 v[196:199], v[92:95], a[176:179], v[196:199]
    ds_read_b128 v[76:79], v224 offset:55296
    s_add_u32 s38, s36, 73728
    buffer_store_dwordx4 v[16:19], v240, s[16:19], s38 offen offset:2560 sc1
    v_mfma_f32_16x16x32_bf16 v[204:207], v[80:83], a[132:135], v[204:207]
    v_mfma_f32_16x16x32_bf16 v[204:207], v[84:87], a[148:151], v[204:207]
    v_mfma_f32_16x16x32_bf16 v[204:207], v[88:91], a[164:167], v[204:207]
    v_mfma_f32_16x16x32_bf16 v[204:207], v[92:95], a[180:183], v[204:207]
    v_mfma_f32_16x16x32_bf16 v[212:215], v[80:83], a[136:139], v[212:215]
    v_mfma_f32_16x16x32_bf16 v[212:215], v[84:87], a[152:155], v[212:215]
    v_mfma_f32_16x16x32_bf16 v[212:215], v[88:91], a[168:171], v[212:215]
    v_mfma_f32_16x16x32_bf16 v[212:215], v[92:95], a[184:187], v[212:215]
    v_mfma_f32_16x16x32_bf16 v[220:223], v[80:83], a[140:143], v[220:223]
    v_mfma_f32_16x16x32_bf16 v[220:223], v[84:87], a[156:159], v[220:223]
    v_mfma_f32_16x16x32_bf16 v[220:223], v[88:91], a[172:175], v[220:223]
    v_mfma_f32_16x16x32_bf16 v[220:223], v[92:95], a[188:191], v[220:223]
    s_waitcnt vmcnt(3)
    v_readfirstlane_b32 s24, v254
    s_lshl_b32 s25, s3, 16
    s_add_u32 s24, s24, s25
    s_cmp_ge_u32 s24, 32
    s_cbranch_scc0 kf_spin37
kf_spinr38:
    s_waitcnt lgkmcnt(0)
    s_barrier
    v_mfma_f32_16x16x32_bf16 v[160:163], v[64:67], a[192:195], v[160:163]
    ds_read_b128 v[80:83], v225 offset:49152
    v_mfma_f32_16x16x32_bf16 v[164:167], v[68:71], a[192:195], v[164:167]
    ds_read_b128 v[84:87], v225 offset:51200
    v_mfma_f32_16x16x32_bf16 v[168:171], v[64:67], a[196:199], v[168:171]
    ds_read_b128 v[88:91], v225 offset:53248
    v_mfma_f32_16x16x32_bf16 v[172:175], v[68:71], a[196:199], v[172:175]
    ds_read_b128 v[92:95], v225 offset:55296
    v_mfma_f32_16x16x32_bf16 v[176:179], v[64:67], a[200:203], v[176:179]
    v_mfma_f32_16x16x32_bf16 v[180:183], v[68:71], a[200:203], v[180:183]
    v_mfma_f32_16x16x32_bf16 v[184:187], v[64:67], a[204:207], v[184:187]
    v_mfma_f32_16x16x32_bf16 v[188:191], v[68:71], a[204:207], v[188:191]
    v_mfma_f32_16x16x32_bf16 v[192:195], v[72:75], a[192:195], v[192:195]
    buffer_load_dwordx4 a[128:131], v248, s[8:11], s28 offen offset:0 sc1
    s_add_u32 s38, s36, 73728
    buffer_store_dwordx4 v[20:23], v240, s[16:19], s38 offen offset:3584 sc1
    v_mfma_f32_16x16x32_bf16 v[196:199], v[76:79], a[192:195], v[196:199]
    v_mfma_f32_16x16x32_bf16 v[200:203], v[72:75], a[196:199], v[200:203]
    buffer_load_dwordx4 a[132:135], v248, s[8:11], s29 offen offset:0 sc1
    v_mfma_f32_16x16x32_bf16 v[204:207], v[76:79], a[196:199], v[204:207]
    v_mfma_f32_16x16x32_bf16 v[208:211], v[72:75], a[200:203], v[208:211]
    v_mfma_f32_16x16x32_bf16 v[212:215], v[76:79], a[200:203], v[212:215]
    buffer_load_dwordx4 a[136:139], v249, s[8:11], s28 offen offset:0 sc1
    v_mfma_f32_16x16x32_bf16 v[216:219], v[72:75], a[204:207], v[216:219]
    v_mfma_f32_16x16x32_bf16 v[220:223], v[76:79], a[204:207], v[220:223]
    s_waitcnt lgkmcnt(0)
    v_mfma_f32_16x16x32_bf16 v[160:163], v[80:83], a[208:211], v[160:163]
    ds_read_b128 v[64:67], v224 offset:57344
    v_mfma_f32_16x16x32_bf16 v[164:167], v[84:87], a[208:211], v[164:167]
    ds_read_b128 v[68:71], v224 offset:59392
    v_mfma_f32_16x16x32_bf16 v[168:171], v[80:83], a[212:215], v[168:171]
    ds_read_b128 v[72:75], v224 offset:61440
    v_mfma_f32_16x16x32_bf16 v[172:175], v[84:87], a[212:215], v[172:175]
    ds_read_b128 v[76:79], v224 offset:63488
    v_mfma_f32_16x16x32_bf16 v[176:179], v[80:83], a[216:219], v[176:179]
    v_mfma_f32_16x16x32_bf16 v[180:183], v[84:87], a[216:219], v[180:183]
    v_mfma_f32_16x16x32_bf16 v[184:187], v[80:83], a[220:223], v[184:187]
    v_mfma_f32_16x16x32_bf16 v[188:191], v[84:87], a[220:223], v[188:191]
    v_mfma_f32_16x16x32_bf16 v[192:195], v[88:91], a[208:211], v[192:195]
    buffer_load_dwordx4 a[140:143], v249, s[8:11], s29 offen offset:0 sc1
    v_mfma_f32_16x16x32_bf16 v[196:199], v[92:95], a[208:211], v[196:199]
    v_mfma_f32_16x16x32_bf16 v[200:203], v[88:91], a[212:215], v[200:203]
    buffer_load_dwordx4 a[144:147], v248, s[8:11], s28 offen offset:1024 sc1
    v_mfma_f32_16x16x32_bf16 v[204:207], v[92:95], a[212:215], v[204:207]
    v_mfma_f32_16x16x32_bf16 v[208:211], v[88:91], a[216:219], v[208:211]
    v_mfma_f32_16x16x32_bf16 v[212:215], v[92:95], a[216:219], v[212:215]
    buffer_load_dwordx4 a[148:151], v248, s[8:11], s29 offen offset:1024 sc1
    v_mfma_f32_16x16x32_bf16 v[216:219], v[88:91], a[220:223], v[216:219]
    s_add_u32 s38, s36, 77824
    buffer_store_dwordx4 v[24:27], v240, s[16:19], s38 offen offset:512 sc1
    v_mfma_f32_16x16x32_bf16 v[220:223], v[92:95], a[220:223], v[220:223]
    s_waitcnt lgkmcnt(0)
    v_mfma_f32_16x16x32_bf16 v[160:163], v[64:67], a[224:227], v[160:163]
    ds_read_b128 v[80:83], v225 offset:57344
    v_mfma_f32_16x16x32_bf16 v[164:167], v[68:71], a[224:227], v[164:167]
    ds_read_b128 v[84:87], v225 offset:59392
    v_mfma_f32_16x16x32_bf16 v[168:171], v[64:67], a[228:231], v[168:171]
    ds_read_b128 v[88:91], v225 offset:61440
    v_mfma_f32_16x16x32_bf16 v[172:175], v[68:71], a[228:231], v[172:175]
    ds_read_b128 v[92:95], v225 offset:63488
    v_mfma_f32_16x16x32_bf16 v[176:179], v[64:67], a[232:235], v[176:179]
    v_mfma_f32_16x16x32_bf16 v[180:183], v[68:71], a[232:235], v[180:183]
    v_mfma_f32_16x16x32_bf16 v[184:187], v[64:67], a[236:239], v[184:187]
    v_mfma_f32_16x16x32_bf16 v[188:191], v[68:71], a[236:239], v[188:191]
    v_mfma_f32_16x16x32_bf16 v[192:195], v[72:75], a[224:227], v[192:195]
    buffer_load_dwordx4 a[152:155], v249, s[8:11], s28 offen offset:1024 sc1
    v_mfma_f32_16x16x32_bf16 v[196:199], v[76:79], a[224:227], v[196:199]
    v_mfma_f32_16x16x32_bf16 v[200:203], v[72:75], a[228:231], v[200:203]
    buffer_load_dwordx4 a[156:159], v249, s[8:11], s29 offen offset:1024 sc1
    v_mfma_f32_16x16x32_bf16 v[204:207], v[76:79], a[228:231], v[204:207]
    v_mfma_f32_16x16x32_bf16 v[208:211], v[72:75], a[232:235], v[208:211]
    v_mfma_f32_16x16x32_bf16 v[212:215], v[76:79], a[232:235], v[212:215]
    buffer_load_dwordx4 a[160:163], v248, s[8:11], s28 offen offset:2048 sc1
    v_mfma_f32_16x16x32_bf16 v[216:219], v[72:75], a[236:239], v[216:219]
    v_mfma_f32_16x16x32_bf16 v[220:223], v[76:79], a[236:239], v[220:223]
    s_waitcnt vmcnt(38) lgkmcnt(0)
    s_barrier
    v_mfma_f32_16x16x32_bf16 v[160:163], v[80:83], a[240:243], v[160:163]
    ds_read_b64_tr_b16 a[192:193], v246 offset:0
    v_mfma_f32_16x16x32_bf16 v[164:167], v[84:87], a[240:243], v[164:167]
    ds_read_b64_tr_b16 a[194:195], v246 offset:1024
    v_mfma_f32_16x16x32_bf16 v[168:171], v[80:83], a[244:247], v[168:171]
    ds_read_b64_tr_b16 a[196:197], v238 offset:0
    v_mfma_f32_16x16x32_bf16 v[172:175], v[84:87], a[244:247], v[172:175]
    ds_read_b64_tr_b16 a[198:199], v238 offset:1024
    v_mfma_f32_16x16x32_bf16 v[176:179], v[80:83], a[248:251], v[176:179]
    ds_read_b64_tr_b16 a[200:201], v246 offset:256
    s_add_u32 s38, s36, 77824
    buffer_store_dwordx4 v[28:31], v240, s[16:19], s38 offen offset:1536 sc1
    v_mfma_f32_16x16x32_bf16 v[180:183], v[84:87], a[248:251], v[180:183]
    ds_read_b64_tr_b16 a[202:203], v246 offset:1280
    v_mfma_f32_16x16x32_bf16 v[184:187], v[80:83], a[252:255], v[184:187]
    ds_read_b64_tr_b16 a[204:205], v238 offset:256
    v_mfma_f32_16x16x32_bf16 v[188:191], v[84:87], a[252:255], v[188:191]
    ds_read_b64_tr_b16 a[206:207], v238 offset:1280
    v_mfma_f32_16x16x32_bf16 v[192:195], v[88:91], a[240:243], v[192:195]
    buffer_load_dwordx4 a[164:167], v248, s[8:11], s29 offen offset:2048 sc1
    v_mfma_f32_16x16x32_bf16 v[196:199], v[92:95], a[240:243], v[196:199]
    v_cvt_pk_bf16_f32 v32, v160, v161
    v_cvt_pk_bf16_f32 v33, v162, v163
    v_mfma_f32_16x16x32_bf16 v[200:203], v[88:91], a[244:247], v[200:203]
    buffer_load_dwordx4 a[168:171], v249, s[8:11], s28 offen offset:2048 sc1
    v_cvt_pk_bf16_f32 v34, v164, v165
    v_cvt_pk_bf16_f32 v35, v166, v167
    v_mfma_f32_16x16x32_bf16 v[204:207], v[92:95], a[244:247], v[204:207]
    v_cvt_pk_bf16_f32 v36, v168, v169
    v_cvt_pk_bf16_f32 v37, v170, v171
    v_mfma_f32_16x16x32_bf16 v[208:211], v[88:91], a[248:251], v[208:211]
    v_cvt_pk_bf16_f32 v38, v172, v173
    v_cvt_pk_bf16_f32 v39, v174, v175
    v_mfma_f32_16x16x32_bf16 v[212:215], v[92:95], a[248:251], v[212:215]
    buffer_load_dwordx4 a[172:175], v249, s[8:11], s29 offen offset:2048 sc1
    v_cvt_pk_bf16_f32 v40, v176, v177
    v_cvt_pk_bf16_f32 v41, v178, v179
    v_mfma_f32_16x16x32_bf16 v[216:219], v[88:91], a[252:255], v[216:219]
    v_cvt_pk_bf16_f32 v42, v180, v181
    v_cvt_pk_bf16_f32 v43, v182, v183
    v_mfma_f32_16x16x32_bf16 v[220:223], v[92:95], a[252:255], v[220:223]
    v_cvt_pk_bf16_f32 v44, v184, v185
    v_cvt_pk_bf16_f32 v45, v186, v187
    s_nop 3
    v_cvt_pk_bf16_f32 v46, v188, v189
    v_cvt_pk_bf16_f32 v47, v190, v191
    v_cvt_pk_bf16_f32 v48, v192, v193
    v_cvt_pk_bf16_f32 v49, v194, v195
    v_cvt_pk_bf16_f32 v50, v196, v197
    v_cvt_pk_bf16_f32 v51, v198, v199
    v_cvt_pk_bf16_f32 v52, v200, v201
    v_cvt_pk_bf16_f32 v53, v202, v203
    v_cvt_pk_bf16_f32 v54, v204, v205
    v_cvt_pk_bf16_f32 v55, v206, v207
    v_cvt_pk_bf16_f32 v56, v208, v209
    v_cvt_pk_bf16_f32 v57, v210, v211
    v_cvt_pk_bf16_f32 v58, v212, v213
    v_cvt_pk_bf16_f32 v59, v214, v215
    v_cvt_pk_bf16_f32 v60, v216, v217
    v_cvt_pk_bf16_f32 v61, v218, v219
    v_cvt_pk_bf16_f32 v62, v220, v221
    v_cvt_pk_bf16_f32 v63, v222, v223
    s_add_u32 s80, s36, 102144
    s_add_u32 s81, s36, 103168
    s_add_u32 s82, s36, 104192
    s_add_u32 s83, s36, 105216
    s_add_u32 s84, s36, 110336
    s_add_u32 s85, s36, 111360
    s_add_u32 s86, s36, 112384
    s_add_u32 s87, s36, 113408
ka_Q:
    s_waitcnt vmcnt(10) lgkmcnt(0)
    v_mfma_f32_16x16x32_bf16 v[96:99], a[192:195], a[128:131], 0
    ds_read_b64_tr_b16 a[208:209], v246 offset:512
    s_lshl_b32 s97, s4, 7
    v_mfma_f32_16x16x32_bf16 v[100:103], a[192:195], a[132:135], 0
    ds_read_b64_tr_b16 a[210:211], v246 offset:1536
    s_add_u32 s97, s97, 12288
    s_cmp_eq_u32 s3, 0
    s_cselect_b32 s35, s97, s43
    v_mfma_f32_16x16x32_bf16 v[104:107], a[192:195], a[136:139], 0
    ds_read_b64_tr_b16 a[212:213], v238 offset:512
    s_lshl_b32 s37, s3, 12
    v_mfma_f32_16x16x32_bf16 v[108:111], a[192:195], a[140:143], 0
    ds_read_b64_tr_b16 a[214:215], v238 offset:1536
    s_mov_b32 s34, s37
    s_mul_i32 s32, s4, 1089536
    v_mfma_f32_16x16x32_bf16 v[112:115], a[196:199], a[128:131], 0
    ds_read_b64_tr_b16 a[216:217], v246 offset:768
    s_mov_b32 s33, 0
    v_mfma_f32_16x16x32_bf16 v[116:119], a[196:199], a[132:135], 0
    ds_read_b64_tr_b16 a[218:219], v246 offset:1792
    s_lshl_b32 s39, s6, 18
    v_mfma_f32_16x16x32_bf16 v[120:123], a[196:199], a[136:139], 0
    ds_read_b64_tr_b16 a[220:221], v238 offset:768
    s_sub_u32 s25, 63, s6
    s_lshl_b32 s40, s25, 18
    v_mfma_f32_16x16x32_bf16 v[124:127], a[196:199], a[140:143], 0
    ds_read_b64_tr_b16 a[222:223], v238 offset:1792
    s_lshl_b32 s25, s4, 12
    v_mfma_f32_16x16x32_bf16 v[128:131], a[200:203], a[128:131], 0
    buffer_load_dwordx4 a[176:179], v248, s[8:11], s28 offen offset:3072 sc1
    s_add_u32 s39, s39, s25
    s_add_u32 s40, s40, s25
    v_mfma_f32_16x16x32_bf16 v[132:135], a[200:203], a[132:135], 0
    s_mov_b32 s38, 0x40004000
    s_mov_b32 s36, s6
    v_mfma_f32_16x16x32_bf16 v[136:139], a[200:203], a[136:139], 0
    buffer_load_dwordx4 a[180:183], v248, s[8:11], s29 offen offset:3072 sc1
    s_mov_b32 s26, 6
    v_mfma_f32_16x16x32_bf16 v[140:143], a[200:203], a[140:143], 0
    s_add_u32 m0, s31, 0
    s_add_u32 s24, s27, 0
    s_mov_b32 s52, s41
    v_mfma_f32_16x16x32_bf16 v[144:147], a[204:207], a[128:131], 0
    buffer_load_dwordx4 v245, s[12:15], s24 offen lds
    s_mov_b32 s53, s42
    v_mfma_f32_16x16x32_bf16 v[148:151], a[204:207], a[132:135], 0
    s_mov_b32 s54, 0x700000
    s_add_u32 s48, s20, 0x1c00000
    s_addc_u32 s49, s21, 0
    v_mfma_f32_16x16x32_bf16 v[152:155], a[204:207], a[136:139], 0
    buffer_store_dwordx4 v[32:35], v240, s[16:19], s80 offen sc1
    s_mov_b32 s50, 0x1c00000
    s_and_b32 s25, s3, 1
    v_mfma_f32_16x16x32_bf16 v[156:159], a[204:207], a[140:143], 0
    s_lshl1_add_u32 s47, s4, s25
    s_waitcnt lgkmcnt(0)
    v_mfma_f32_16x16x32_bf16 v[160:163], a[208:211], a[128:131], 0
    ds_read_b64_tr_b16 a[192:193], v246 offset:8192
    s_lshr_b32 s101, s3, 1
    v_mfma_f32_16x16x32_bf16 v[164:167], a[208:211], a[132:135], 0
    ds_read_b64_tr_b16 a[194:195], v246 offset:9216
    s_add_u32 s45, s5, s101
    s_sub_u32 s45, s45, 1
    v_mfma_f32_16x16x32_bf16 v[168:171], a[208:211], a[136:139], 0
    ds_read_b64_tr_b16 a[196:197], v238 offset:8192
    s_mul_i32 s45, s45, s5
    v_mfma_f32_16x16x32_bf16 v[172:175], a[208:211], a[140:143], 0
    ds_read_b64_tr_b16 a[198:199], v238 offset:9216
    s_lshl_b32 s100, s101, 14
    s_add_u32 s100, s100, 114688
    v_mfma_f32_16x16x32_bf16 v[176:179], a[212:215], a[128:131], 0
    ds_read_b64_tr_b16 a[200:201], v246 offset:8448
    s_mul_i32 s100, s100, s47
    v_mfma_f32_16x16x32_bf16 v[180:183], a[212:215], a[132:135], 0
    ds_read_b64_tr_b16 a[202:203], v246 offset:9472
    s_lshl_b32 s25, s45, 11
    v_mfma_f32_16x16x32_bf16 v[184:187], a[212:215], a[136:139], 0
    ds_read_b64_tr_b16 a[204:205], v238 offset:8448
    s_add_u32 s100, s100, s25
    s_lshl_b32 s46, s47, 9
    v_mfma_f32_16x16x32_bf16 v[188:191], a[212:215], a[140:143], 0
    ds_read_b64_tr_b16 a[206:207], v238 offset:9472
    s_mul_i32 s44, s47, 114688
    v_mfma_f32_16x16x32_bf16 v[192:195], a[216:219], a[128:131], 0
    buffer_load_dwordx4 a[184:187], v249, s[8:11], s28 offen offset:3072 sc1
    s_add_u32 s47, s44, 7168
    s_lshl_b32 s25, s45, 7
    v_mfma_f32_16x16x32_bf16 v[196:199], a[216:219], a[132:135], 0
    s_add_u32 s44, s44, s25
    s_lshl_b32 s45, s45, 18
    v_mfma_f32_16x16x32_bf16 v[200:203], a[216:219], a[136:139], 0
    buffer_load_dwordx4 a[188:191], v249, s[8:11], s29 offen offset:3072 sc1
    s_add_u32 s46, s46, s45
    v_mfma_f32_16x16x32_bf16 v[204:207], a[216:219], a[140:143], 0
    s_add_u32 m0, s31, 1024
    s_add_u32 s24, s27, 32768
    s_lshr_b32 s25, s3, 1
    v_mfma_f32_16x16x32_bf16 v[208:211], a[220:223], a[128:131], 0
    buffer_load_dwordx4 v245, s[12:15], s24 offen lds
    s_lshl_b32 s25, s25, 15
    v_mfma_f32_16x16x32_bf16 v[212:215], a[220:223], a[132:135], 0
    s_add_u32 s46, s46, s25
    s_mov_b32 s45, s43
    v_mfma_f32_16x16x32_bf16 v[216:219], a[220:223], a[136:139], 0
    s_add_u32 s28, s28, 4096
    s_and_b32 s28, s28, 32767
    buffer_store_dwordx4 v[36:39], v240, s[16:19], s81 offen sc1
    v_mfma_f32_16x16x32_bf16 v[220:223], a[220:223], a[140:143], 0
    s_add_u32 s29, s28, 32768
    v_accvgpr_write_b32 a0, 0
    s_waitcnt vmcnt(13) lgkmcnt(0)
    v_mfma_f32_16x16x32_bf16 v[96:99], a[192:195], a[144:147], v[96:99]
    ds_read_b64_tr_b16 a[208:209], v246 offset:8704
    s_load_dwordx2 s[56:57], s[0:1], 40
    v_accvgpr_write_b32 a1, 0
    v_mfma_f32_16x16x32_bf16 v[100:103], a[192:195], a[148:151], v[100:103]
    ds_read_b64_tr_b16 a[210:211], v246 offset:9728
    v_accvgpr_write_b32 a2, 0
    v_mfma_f32_16x16x32_bf16 v[104:107], a[192:195], a[152:155], v[104:107]
    ds_read_b64_tr_b16 a[212:213], v238 offset:8704
    v_accvgpr_write_b32 a3, 0
    v_mfma_f32_16x16x32_bf16 v[108:111], a[192:195], a[156:159], v[108:111]
    ds_read_b64_tr_b16 a[214:215], v238 offset:9728
    v_accvgpr_write_b32 a4, 0
    v_accvgpr_write_b32 a5, 0
    v_mfma_f32_16x16x32_bf16 v[112:115], a[196:199], a[144:147], v[112:115]
    ds_read_b64_tr_b16 a[216:217], v246 offset:8960
    v_accvgpr_write_b32 a6, 0
    v_mfma_f32_16x16x32_bf16 v[116:119], a[196:199], a[148:151], v[116:119]
    ds_read_b64_tr_b16 a[218:219], v246 offset:9984
    v_accvgpr_write_b32 a7, 0
    v_accvgpr_write_b32 a8, 0
    v_mfma_f32_16x16x32_bf16 v[120:123], a[196:199], a[152:155], v[120:123]
    ds_read_b64_tr_b16 a[220:221], v238 offset:8960
    v_accvgpr_write_b32 a9, 0
    v_mfma_f32_16x16x32_bf16 v[124:127], a[196:199], a[156:159], v[124:127]
    ds_read_b64_tr_b16 a[222:223], v238 offset:9984
    v_accvgpr_write_b32 a10, 0
    v_mfma_f32_16x16x32_bf16 v[128:131], a[200:203], a[144:147], v[128:131]
    buffer_load_dwordx4 a[128:131], v248, s[8:11], s28 offen offset:0 sc1
    v_accvgpr_write_b32 a11, 0
    v_accvgpr_write_b32 a12, 0
    v_mfma_f32_16x16x32_bf16 v[132:135], a[200:203], a[148:151], v[132:135]
    v_accvgpr_write_b32 a13, 0
    v_accvgpr_write_b32 a14, 0
    v_mfma_f32_16x16x32_bf16 v[136:139], a[200:203], a[152:155], v[136:139]
    buffer_load_dwordx4 a[132:135], v248, s[8:11], s29 offen offset:0 sc1
    v_accvgpr_write_b32 a15, 0
    v_mfma_f32_16x16x32_bf16 v[140:143], a[200:203], a[156:159], v[140:143]
    s_add_u32 m0, s31, 2048
    s_add_u32 s24, s27, 65536
    v_accvgpr_write_b32 a16, 0
    v_mfma_f32_16x16x32_bf16 v[144:147], a[204:207], a[144:147], v[144:147]
    buffer_load_dwordx4 v237, s[12:15], s24 offen lds
    v_accvgpr_write_b32 a17, 0
    v_mfma_f32_16x16x32_bf16 v[148:151], a[204:207], a[148:151], v[148:151]
    v_accvgpr_write_b32 a18, 0
    v_accvgpr_write_b32 a19, 0
    v_accvgpr_write_b32 a20, 0
    v_mfma_f32_16x16x32_bf16 v[152:155], a[204:207], a[152:155], v[152:155]
    buffer_store_dwordx4 v[40:43], v240, s[16:19], s82 offen sc1
    v_accvgpr_write_b32 a21, 0
    v_mfma_f32_16x16x32_bf16 v[156:159], a[204:207], a[156:159], v[156:159]
    v_accvgpr_write_b32 a22, 0
    s_waitcnt lgkmcnt(0)
    v_mfma_f32_16x16x32_bf16 v[160:163], a[208:211], a[144:147], v[160:163]
    ds_read_b64_tr_b16 a[192:193], v246 offset:16384
    v_accvgpr_write_b32 a23, 0
    v_accvgpr_write_b32 a24, 0
    v_mfma_f32_16x16x32_bf16 v[164:167], a[208:211], a[148:151], v[164:167]
    ds_read_b64_tr_b16 a[194:195], v246 offset:17408
    v_accvgpr_write_b32 a25, 0
    v_mfma_f32_16x16x32_bf16 v[168:171], a[208:211], a[152:155], v[168:171]
    ds_read_b64_tr_b16 a[196:197], v238 offset:16384
    v_accvgpr_write_b32 a26, 0
    v_mfma_f32_16x16x32_bf16 v[172:175], a[208:211], a[156:159], v[172:175]
    ds_read_b64_tr_b16 a[198:199], v238 offset:17408
    v_accvgpr_write_b32 a27, 0
    v_accvgpr_write_b32 a28, 0
    v_mfma_f32_16x16x32_bf16 v[176:179], a[212:215], a[144:147], v[176:179]
    ds_read_b64_tr_b16 a[200:201], v246 offset:16640
    v_accvgpr_write_b32 a29, 0
    v_mfma_f32_16x16x32_bf16 v[180:183], a[212:215], a[148:151], v[180:183]
    ds_read_b64_tr_b16 a[202:203], v246 offset:17664
    v_accvgpr_write_b32 a30, 0
    v_accvgpr_write_b32 a31, 0
    v_mfma_f32_16x16x32_bf16 v[184:187], a[212:215], a[152:155], v[184:187]
    ds_read_b64_tr_b16 a[204:205], v238 offset:16640
    v_accvgpr_write_b32 a32, 0
    v_mfma_f32_16x16x32_bf16 v[188:191], a[212:215], a[156:159], v[188:191]
    ds_read_b64_tr_b16 a[206:207], v238 offset:17664
    v_accvgpr_write_b32 a33, 0
    v_mfma_f32_16x16x32_bf16 v[192:195], a[216:219], a[144:147], v[192:195]
    buffer_load_dwordx4 a[136:139], v249, s[8:11], s28 offen offset:0 sc1
    v_accvgpr_write_b32 a34, 0
    v_accvgpr_write_b32 a35, 0
    v_mfma_f32_16x16x32_bf16 v[196:199], a[216:219], a[148:151], v[196:199]
    v_accvgpr_write_b32 a36, 0
    v_accvgpr_write_b32 a37, 0
    v_mfma_f32_16x16x32_bf16 v[200:203], a[216:219], a[152:155], v[200:203]
    buffer_load_dwordx4 a[140:143], v249, s[8:11], s29 offen offset:0 sc1
    v_accvgpr_write_b32 a38, 0
    v_mfma_f32_16x16x32_bf16 v[204:207], a[216:219], a[156:159], v[204:207]
    s_add_u32 m0, s31, 3072
    s_add_u32 s24, s27, 98304
    v_accvgpr_write_b32 a39, 0
    v_mfma_f32_16x16x32_bf16 v[208:211], a[220:223], a[144:147], v[208:211]
    buffer_load_dwordx4 v237, s[12:15], s24 offen lds
    v_accvgpr_write_b32 a40, 0
    v_mfma_f32_16x16x32_bf16 v[212:215], a[220:223], a[148:151], v[212:215]
    v_accvgpr_write_b32 a41, 0
    v_accvgpr_write_b32 a42, 0
    v_accvgpr_write_b32 a43, 0
    v_mfma_f32_16x16x32_bf16 v[216:219], a[220:223], a[152:155], v[216:219]
    buffer_store_dwordx4 v[44:47], v240, s[16:19], s83 offen sc1
    v_accvgpr_write_b32 a44, 0
    v_mfma_f32_16x16x32_bf16 v[220:223], a[220:223], a[156:159], v[220:223]
    v_accvgpr_write_b32 a45, 0
    s_waitcnt vmcnt(16) lgkmcnt(0)
    v_mfma_f32_16x16x32_bf16 v[96:99], a[192:195], a[160:163], v[96:99]
    ds_read_b64_tr_b16 a[208:209], v246 offset:16896
    v_accvgpr_write_b32 a46, 0
    v_accvgpr_write_b32 a47, 0
    v_mfma_f32_16x16x32_bf16 v[100:103], a[192:195], a[164:167], v[100:103]
    ds_read_b64_tr_b16 a[210:211], v246 offset:17920
    v_accvgpr_write_b32 a48, 0
    v_mfma_f32_16x16x32_bf16 v[104:107], a[192:195], a[168:171], v[104:107]
    ds_read_b64_tr_b16 a[212:213], v238 offset:16896
    v_accvgpr_write_b32 a49, 0
    v_accvgpr_write_b32 a50, 0
    v_mfma_f32_16x16x32_bf16 v[108:111], a[192:195], a[172:175], v[108:111]
    ds_read_b64_tr_b16 a[214:215], v238 offset:17920
    v_accvgpr_write_b32 a51, 0
    v_mfma_f32_16x16x32_bf16 v[112:115], a[196:199], a[160:163], v[112:115]
    ds_read_b64_tr_b16 a[216:217], v246 offset:17152
    v_accvgpr_write_b32 a52, 0
    v_mfma_f32_16x16x32_bf16 v[116:119], a[196:199], a[164:167], v[116:119]
    ds_read_b64_tr_b16 a[218:219], v246 offset:18176
    v_accvgpr_write_b32 a53, 0
    v_accvgpr_write_b32 a54, 0
    v_mfma_f32_16x16x32_bf16 v[120:123], a[196:199], a[168:171], v[120:123]
    ds_read_b64_tr_b16 a[220:221], v238 offset:17152
    v_accvgpr_write_b32 a55, 0
    v_mfma_f32_16x16x32_bf16 v[124:127], a[196:199], a[172:175], v[124:127]
    ds_read_b64_tr_b16 a[222:223], v238 offset:18176
    v_accvgpr_write_b32 a56, 0
    v_accvgpr_write_b32 a57, 0
    v_mfma_f32_16x16x32_bf16 v[128:131], a[200:203], a[160:163], v[128:131]
    buffer_load_dwordx4 a[144:147], v248, s[8:11], s28 offen offset:1024 sc1
    v_accvgpr_write_b32 a58, 0
    v_mfma_f32_16x16x32_bf16 v[132:135], a[200:203], a[164:167], v[132:135]
    v_accvgpr_write_b32 a59, 0
    v_accvgpr_write_b32 a60, 0
    v_mfma_f32_16x16x32_bf16 v[136:139], a[200:203], a[168:171], v[136:139]
    buffer_load_dwordx4 a[148:151], v248, s[8:11], s29 offen offset:1024 sc1
    v_accvgpr_write_b32 a61, 0
    v_mfma_f32_16x16x32_bf16 v[140:143], a[200:203], a[172:175], v[140:143]
    s_add_u32 m0, s31, 4096
    s_add_u32 s24, s27, 131072
    v_accvgpr_write_b32 a62, 0
    v_mfma_f32_16x16x32_bf16 v[144:147], a[204:207], a[160:163], v[144:147]
    buffer_load_dwordx4 v245, s[12:15], s24 offen lds
    v_accvgpr_write_b32 a63, 0
    v_mfma_f32_16x16x32_bf16 v[148:151], a[204:207], a[164:167], v[148:151]
    v_accvgpr_write_b32 a64, 0
    v_accvgpr_write_b32 a65, 0
    v_accvgpr_write_b32 a66, 0
    v_mfma_f32_16x16x32_bf16 v[152:155], a[204:207], a[168:171], v[152:155]
    buffer_store_dwordx4 v[48:51], v240, s[16:19], s84 offen sc1
    v_accvgpr_write_b32 a67, 0
    v_mfma_f32_16x16x32_bf16 v[156:159], a[204:207], a[172:175], v[156:159]
    v_accvgpr_write_b32 a68, 0
    s_waitcnt lgkmcnt(0)
    v_mfma_f32_16x16x32_bf16 v[160:163], a[208:211], a[160:163], v[160:163]
    ds_read_b64_tr_b16 a[192:193], v246 offset:24576
    v_accvgpr_write_b32 a69, 0
    v_accvgpr_write_b32 a70, 0
    v_mfma_f32_16x16x32_bf16 v[164:167], a[208:211], a[164:167], v[164:167]
    ds_read_b64_tr_b16 a[194:195], v246 offset:25600
    v_accvgpr_write_b32 a71, 0
    v_mfma_f32_16x16x32_bf16 v[168:171], a[208:211], a[168:171], v[168:171]
    ds_read_b64_tr_b16 a[196:197], v238 offset:24576
    v_accvgpr_write_b32 a72, 0
    v_accvgpr_write_b32 a73, 0
    v_mfma_f32_16x16x32_bf16 v[172:175], a[208:211], a[172:175], v[172:175]
    ds_read_b64_tr_b16 a[198:199], v238 offset:25600
    v_accvgpr_write_b32 a74, 0
    v_mfma_f32_16x16x32_bf16 v[176:179], a[212:215], a[160:163], v[176:179]
    ds_read_b64_tr_b16 a[200:201], v246 offset:24832
    v_accvgpr_write_b32 a75, 0
    v_mfma_f32_16x16x32_bf16 v[180:183], a[212:215], a[164:167], v[180:183]
    ds_read_b64_tr_b16 a[202:203], v246 offset:25856
    v_accvgpr_write_b32 a76, 0
    v_accvgpr_write_b32 a77, 0
    v_mfma_f32_16x16x32_bf16 v[184:187], a[212:215], a[168:171], v[184:187]
    ds_read_b64_tr_b16 a[204:205], v238 offset:24832
    v_accvgpr_write_b32 a78, 0
    v_mfma_f32_16x16x32_bf16 v[188:191], a[212:215], a[172:175], v[188:191]
    ds_read_b64_tr_b16 a[206:207], v238 offset:25856
    v_accvgpr_write_b32 a79, 0
    v_accvgpr_write_b32 a80, 0
    v_mfma_f32_16x16x32_bf16 v[192:195], a[216:219], a[160:163], v[192:195]
    buffer_load_dwordx4 a[152:155], v249, s[8:11], s28 offen offset:1024 sc1
    v_accvgpr_write_b32 a81, 0
    v_mfma_f32_16x16x32_bf16 v[196:199], a[216:219], a[164:167], v[196:199]
    v_accvgpr_write_b32 a82, 0
    v_accvgpr_write_b32 a83, 0
    v_mfma_f32_16x16x32_bf16 v[200:203], a[216:219], a[168:171], v[200:203]
    buffer_load_dwordx4 a[156:159], v249, s[8:11], s29 offen offset:1024 sc1
    v_accvgpr_write_b32 a84, 0
    v_mfma_f32_16x16x32_bf16 v[204:207], a[216:219], a[172:175], v[204:207]
    s_add_u32 m0, s31, 5120
    s_add_u32 s24, s27, 163840
    v_accvgpr_write_b32 a85, 0
    v_mfma_f32_16x16x32_bf16 v[208:211], a[220:223], a[160:163], v[208:211]
    buffer_load_dwordx4 v245, s[12:15], s24 offen lds
    v_accvgpr_write_b32 a86, 0
    v_accvgpr_write_b32 a87, 0
    v_mfma_f32_16x16x32_bf16 v[212:215], a[220:223], a[164:167], v[212:215]
    v_accvgpr_write_b32 a88, 0
    v_accvgpr_write_b32 a89, 0
    v_mfma_f32_16x16x32_bf16 v[216:219], a[220:223], a[168:171], v[216:219]
    s_add_u32 s30, s30, 32768
    buffer_store_dwordx4 v[52:55], v240, s[16:19], s85 offen sc1
    v_mfma_f32_16x16x32_bf16 v[220:223], a[220:223], a[172:175], v[220:223]
    s_cmp_ge_u32 s30, 163840
    s_cselect_b32 s30, 65536, s30
    s_waitcnt vmcnt(18) lgkmcnt(0)
    v_mfma_f32_16x16x32_bf16 v[96:99], a[192:195], a[176:179], v[96:99]
    ds_read_b64_tr_b16 a[208:209], v246 offset:25088
    v_accvgpr_write_b32 a90, 0
    v_accvgpr_write_b32 a91, 0
    v_mfma_f32_16x16x32_bf16 v[100:103], a[192:195], a[180:183], v[100:103]
    ds_read_b64_tr_b16 a[210:211], v246 offset:26112
    v_accvgpr_write_b32 a92, 0
    v_mfma_f32_16x16x32_bf16 v[104:107], a[192:195], a[184:187], v[104:107]
    ds_read_b64_tr_b16 a[212:213], v238 offset:25088
    v_accvgpr_write_b32 a93, 0
    v_mfma_f32_16x16x32_bf16 v[108:111], a[192:195], a[188:191], v[108:111]
    ds_read_b64_tr_b16 a[214:215], v238 offset:26112
    v_accvgpr_write_b32 a94, 0
    v_accvgpr_write_b32 a95, 0
    v_mfma_f32_16x16x32_bf16 v[112:115], a[196:199], a[176:179], v[112:115]
    ds_read_b64_tr_b16 a[216:217], v246 offset:25344
    v_accvgpr_write_b32 a96, 0
    v_mfma_f32_16x16x32_bf16 v[116:119], a[196:199], a[180:183], v[116:119]
    ds_read_b64_tr_b16 a[218:219], v246 offset:26368
    v_accvgpr_write_b32 a97, 0
    v_accvgpr_write_b32 a98, 0
    v_mfma_f32_16x16x32_bf16 v[120:123], a[196:199], a[184:187], v[120:123]
    ds_read_b64_tr_b16 a[220:221], v238 offset:25344
    v_accvgpr_write_b32 a99, 0
    v_mfma_f32_16x16x32_bf16 v[124:127], a[196:199], a[188:191], v[124:127]
    ds_read_b64_tr_b16 a[222:223], v238 offset:26368
    v_accvgpr_write_b32 a100, 0
    v_mfma_f32_16x16x32_bf16 v[128:131], a[200:203], a[176:179], v[128:131]
    buffer_load_dwordx4 a[160:163], v248, s[8:11], s28 offen offset:2048 sc1
    v_accvgpr_write_b32 a101, 0
    v_accvgpr_write_b32 a102, 0
    v_mfma_f32_16x16x32_bf16 v[132:135], a[200:203], a[180:183], v[132:135]
    v_accvgpr_write_b32 a103, 0
    v_accvgpr_write_b32 a104, 0
    v_mfma_f32_16x16x32_bf16 v[136:139], a[200:203], a[184:187], v[136:139]
    buffer_load_dwordx4 a[164:167], v248, s[8:11], s29 offen offset:2048 sc1
    v_accvgpr_write_b32 a105, 0
    v_mfma_f32_16x16x32_bf16 v[140:143], a[200:203], a[188:191], v[140:143]
    s_add_u32 m0, s31, 6144
    s_add_u32 s24, s27, 196608
    v_accvgpr_write_b32 a106, 0
    v_mfma_f32_16x16x32_bf16 v[144:147], a[204:207], a[176:179], v[144:147]
    buffer_load_dwordx4 v237, s[12:15], s24 offen lds
    v_accvgpr_write_b32 a107, 0
    v_mfma_f32_16x16x32_bf16 v[148:151], a[204:207], a[180:183], v[148:151]
    v_accvgpr_write_b32 a108, 0
    v_accvgpr_write_b32 a109, 0
    v_accvgpr_write_b32 a110, 0
    v_mfma_f32_16x16x32_bf16 v[152:155], a[204:207], a[184:187], v[152:155]
    buffer_store_dwordx4 v[56:59], v240, s[16:19], s86 offen sc1
    v_accvgpr_write_b32 a111, 0
    v_mfma_f32_16x16x32_bf16 v[156:159], a[204:207], a[188:191], v[156:159]
    s_waitcnt vmcnt(49) lgkmcnt(0)
    s_barrier
    v_add_u32 v246, s30, v247
    v_mfma_f32_16x16x32_bf16 v[160:163], a[208:211], a[176:179], v[160:163]
    v_xor_b32_e64 v238, 16, v246
    ds_read_b64_tr_b16 a[192:193], v246 offset:0
    v_accvgpr_write_b32 a112, 0
    v_mfma_f32_16x16x32_bf16 v[164:167], a[208:211], a[180:183], v[164:167]
    ds_read_b64_tr_b16 a[194:195], v246 offset:1024
    v_accvgpr_write_b32 a113, 0
    v_mfma_f32_16x16x32_bf16 v[168:171], a[208:211], a[184:187], v[168:171]
    ds_read_b64_tr_b16 a[196:197], v238 offset:0
    v_accvgpr_write_b32 a114, 0
    v_mfma_f32_16x16x32_bf16 v[172:175], a[208:211], a[188:191], v[172:175]
    ds_read_b64_tr_b16 a[198:199], v238 offset:1024
    v_accvgpr_write_b32 a115, 0
    v_accvgpr_write_b32 a116, 0
    v_mfma_f32_16x16x32_bf16 v[176:179], a[212:215], a[176:179], v[176:179]
    ds_read_b64_tr_b16 a[200:201], v246 offset:256
    v_accvgpr_write_b32 a117, 0
    v_mfma_f32_16x16x32_bf16 v[180:183], a[212:215], a[180:183], v[180:183]
    ds_read_b64_tr_b16 a[202:203], v246 offset:1280
    v_accvgpr_write_b32 a118, 0
    v_accvgpr_write_b32 a119, 0
    v_mfma_f32_16x16x32_bf16 v[184:187], a[212:215], a[184:187], v[184:187]
    ds_read_b64_tr_b16 a[204:205], v238 offset:256
    buffer_store_dwordx4 v[60:63], v240, s[16:19], s87 offen sc1
    v_mfma_f32_16x16x32_bf16 v[188:191], a[212:215], a[188:191], v[188:191]
    ds_read_b64_tr_b16 a[206:207], v238 offset:1280
    v_accvgpr_write_b32 a120, 0
    v_accvgpr_write_b32 a121, 0
    v_mfma_f32_16x16x32_bf16 v[192:195], a[216:219], a[176:179], v[192:195]
    buffer_load_dwordx4 a[168:171], v249, s[8:11], s28 offen offset:2048 sc1
    v_accvgpr_write_b32 a122, 0
    v_mfma_f32_16x16x32_bf16 v[196:199], a[216:219], a[180:183], v[196:199]
    s_lshl2_add_u32 s80, s2, s3
    s_mul_i32 s80, s80, 12288
    s_add_u32 s80, s80, 0x1000000
    v_mov_b32 v0, -1
    v_mov_b32 v1, -1
    v_mov_b32 v2, -1
    v_mov_b32_e64 v3, -1
    v_mfma_f32_16x16x32_bf16 v[200:203], a[216:219], a[184:187], v[200:203]
    buffer_load_dwordx4 a[172:175], v249, s[8:11], s29 offen offset:2048 sc1
    v_accvgpr_write_b32 a123, 0
    v_accvgpr_write_b32 a124, 0
    v_mfma_f32_16x16x32_bf16 v[204:207], a[216:219], a[188:191], v[204:207]
    s_add_u32 m0, s31, 7168
    s_add_u32 s24, s27, 229376
    v_mfma_f32_16x16x32_bf16 v[208:211], a[220:223], a[176:179], v[208:211]
    buffer_load_dwordx4 v237, s[12:15], s24 offen lds
    v_accvgpr_write_b32 a125, 0
    v_accvgpr_write_b32 a126, 0
    v_mfma_f32_16x16x32_bf16 v[212:215], a[220:223], a[180:183], v[212:215]
    s_add_u32 s27, s27, 1048576
    s_and_b32 s27, s27, 0x407fffff
    v_mfma_f32_16x16x32_bf16 v[216:219], a[220:223], a[184:187], v[216:219]
    s_cmp_eq_u32 s27, s7
    s_cselect_b32 s27, s43, s27
    v_accvgpr_write_b32 a127, 0
    v_mfma_f32_16x16x32_bf16 v[220:223], a[220:223], a[188:191], v[220:223]
    s_add_u32 s31, s31, 32768
    s_cmp_ge_u32 s31, 163840
    s_cselect_b32 s24, 98304, 0
    s_sub_u32 s31, s31, s24
.p2align 3
ka_qp:
    s_waitcnt vmcnt(15) lgkmcnt(0)
    v_mfma_f32_16x16x32_bf16 v[96:99], a[192:195], a[128:131], v[96:99]
    ds_read_b64_tr_b16 a[208:209], v246 offset:512
    v_mfma_f32_16x16x32_bf16 v[100:103], a[192:195], a[132:135], v[100:103]
    ds_read_b64_tr_b16 a[210:211], v246 offset:1536
    v_mfma_f32_16x16x32_bf16 v[104:107], a[192:195], a[136:139], v[104:107]
    ds_read_b64_tr_b16 a[212:213], v238 offset:512
    v_mfma_f32_16x16x32_bf16 v[108:111], a[192:195], a[140:143], v[108:111]
    ds_read_b64_tr_b16 a[214:215], v238 offset:1536
    v_mfma_f32_16x16x32_bf16 v[112:115], a[196:199], a[128:131], v[112:115]
    ds_read_b64_tr_b16 a[216:217], v246 offset:768
    v_mfma_f32_16x16x32_bf16 v[116:119], a[196:199], a[132:135], v[116:119]
    ds_read_b64_tr_b16 a[218:219], v246 offset:1792
    v_mfma_f32_16x16x32_bf16 v[120:123], a[196:199], a[136:139], v[120:123]
    ds_read_b64_tr_b16 a[220:221], v238 offset:768
    v_mfma_f32_16x16x32_bf16 v[124:127], a[196:199], a[140:143], v[124:127]
    ds_read_b64_tr_b16 a[222:223], v238 offset:1792
    v_mfma_f32_16x16x32_bf16 v[128:131], a[200:203], a[128:131], v[128:131]
    buffer_load_dwordx4 a[176:179], v248, s[8:11], s28 offen offset:3072 sc1
    s_cmp_eq_u32 s26, 1
    s_cselect_b32 s41, s35, s43
    buffer_load_dword v254, off, s[88:91], s41 sc1
    v_mfma_f32_16x16x32_bf16 v[132:135], a[200:203], a[132:135], v[132:135]
    v_mfma_f32_16x16x32_bf16 v[136:139], a[200:203], a[136:139], v[136:139]
    buffer_load_dwordx4 a[180:183], v248, s[8:11], s29 offen offset:3072 sc1
    v_mfma_f32_16x16x32_bf16 v[140:143], a[200:203], a[140:143], v[140:143]
    s_add_u32 m0, s31, 0
    s_add_u32 s24, s27, 0
    v_mfma_f32_16x16x32_bf16 v[144:147], a[204:207], a[128:131], v[144:147]
    buffer_load_dwordx4 v245, s[12:15], s24 offen lds
    v_mfma_f32_16x16x32_bf16 v[148:151], a[204:207], a[132:135], v[148:151]
    v_mfma_f32_16x16x32_bf16 v[152:155], a[204:207], a[136:139], v[152:155]
    v_mfma_f32_16x16x32_bf16 v[156:159], a[204:207], a[140:143], v[156:159]
    s_waitcnt lgkmcnt(0)
    v_mfma_f32_16x16x32_bf16 v[160:163], a[208:211], a[128:131], v[160:163]
    ds_read_b64_tr_b16 a[192:193], v246 offset:8192
    v_mfma_f32_16x16x32_bf16 v[164:167], a[208:211], a[132:135], v[164:167]
    ds_read_b64_tr_b16 a[194:195], v246 offset:9216
    v_mfma_f32_16x16x32_bf16 v[168:171], a[208:211], a[136:139], v[168:171]
    ds_read_b64_tr_b16 a[196:197], v238 offset:8192
    v_mfma_f32_16x16x32_bf16 v[172:175], a[208:211], a[140:143], v[172:175]
    ds_read_b64_tr_b16 a[198:199], v238 offset:9216
    v_mfma_f32_16x16x32_bf16 v[176:179], a[212:215], a[128:131], v[176:179]
    ds_read_b64_tr_b16 a[200:201], v246 offset:8448
    v_mfma_f32_16x16x32_bf16 v[180:183], a[212:215], a[132:135], v[180:183]
    ds_read_b64_tr_b16 a[202:203], v246 offset:9472
    v_mfma_f32_16x16x32_bf16 v[184:187], a[212:215], a[136:139], v[184:187]
    ds_read_b64_tr_b16 a[204:205], v238 offset:8448
    v_mfma_f32_16x16x32_bf16 v[188:191], a[212:215], a[140:143], v[188:191]
    ds_read_b64_tr_b16 a[206:207], v238 offset:9472
    v_mfma_f32_16x16x32_bf16 v[192:195], a[216:219], a[128:131], v[192:195]
    buffer_load_dwordx4 a[184:187], v249, s[8:11], s28 offen offset:3072 sc1
    v_mfma_f32_16x16x32_bf16 v[196:199], a[216:219], a[132:135], v[196:199]
    v_mfma_f32_16x16x32_bf16 v[200:203], a[216:219], a[136:139], v[200:203]
    buffer_load_dwordx4 a[188:191], v249, s[8:11], s29 offen offset:3072 sc1
    v_mfma_f32_16x16x32_bf16 v[204:207], a[216:219], a[140:143], v[204:207]
    s_add_u32 m0, s31, 1024
    s_add_u32 s24, s27, 32768
    v_mfma_f32_16x16x32_bf16 v[208:211], a[220:223], a[128:131], v[208:211]
    buffer_load_dwordx4 v245, s[12:15], s24 offen lds
    v_mfma_f32_16x16x32_bf16 v[212:215], a[220:223], a[132:135], v[212:215]
    v_mfma_f32_16x16x32_bf16 v[216:219], a[220:223], a[136:139], v[216:219]
    s_add_u32 s28, s28, 4096
    s_and_b32 s28, s28, 32767
    v_mfma_f32_16x16x32_bf16 v[220:223], a[220:223], a[140:143], v[220:223]
    s_add_u32 s29, s28, 32768
    s_waitcnt vmcnt(16) lgkmcnt(0)
    v_mfma_f32_16x16x32_bf16 v[96:99], a[192:195], a[144:147], v[96:99]
    ds_read_b64_tr_b16 a[208:209], v246 offset:8704
    v_mfma_f32_16x16x32_bf16 v[100:103], a[192:195], a[148:151], v[100:103]
    ds_read_b64_tr_b16 a[210:211], v246 offset:9728
    v_mfma_f32_16x16x32_bf16 v[104:107], a[192:195], a[152:155], v[104:107]
    ds_read_b64_tr_b16 a[212:213], v238 offset:8704
    v_mfma_f32_16x16x32_bf16 v[108:111], a[192:195], a[156:159], v[108:111]
    ds_read_b64_tr_b16 a[214:215], v238 offset:9728
    v_mfma_f32_16x16x32_bf16 v[112:115], a[196:199], a[144:147], v[112:115]
    ds_read_b64_tr_b16 a[216:217], v246 offset:8960
    v_mfma_f32_16x16x32_bf16 v[116:119], a[196:199], a[148:151], v[116:119]
    ds_read_b64_tr_b16 a[218:219], v246 offset:9984
    v_mfma_f32_16x16x32_bf16 v[120:123], a[196:199], a[152:155], v[120:123]
    ds_read_b64_tr_b16 a[220:221], v238 offset:8960
    v_mfma_f32_16x16x32_bf16 v[124:127], a[196:199], a[156:159], v[124:127]
    ds_read_b64_tr_b16 a[222:223], v238 offset:9984
    v_mfma_f32_16x16x32_bf16 v[128:131], a[200:203], a[144:147], v[128:131]
    buffer_load_dwordx4 a[128:131], v248, s[8:11], s28 offen offset:0 sc1
    v_mfma_f32_16x16x32_bf16 v[132:135], a[200:203], a[148:151], v[132:135]
    v_mfma_f32_16x16x32_bf16 v[136:139], a[200:203], a[152:155], v[136:139]
    buffer_load_dwordx4 a[132:135], v248, s[8:11], s29 offen offset:0 sc1
    v_mfma_f32_16x16x32_bf16 v[140:143], a[200:203], a[156:159], v[140:143]
    s_add_u32 m0, s31, 2048
    s_add_u32 s24, s27, 65536
    v_mfma_f32_16x16x32_bf16 v[144:147], a[204:207], a[144:147], v[144:147]
    buffer_load_dwordx4 v237, s[12:15], s24 offen lds
    v_mfma_f32_16x16x32_bf16 v[148:151], a[204:207], a[148:151], v[148:151]
    buffer_store_dwordx4 v[0:3], v240, s[48:51], s80 offen sc1
    s_add_u32 s80, s80, 1024
    v_mfma_f32_16x16x32_bf16 v[152:155], a[204:207], a[152:155], v[152:155]
    v_mfma_f32_16x16x32_bf16 v[156:159], a[204:207], a[156:159], v[156:159]
    s_waitcnt lgkmcnt(0)
    v_mfma_f32_16x16x32_bf16 v[160:163], a[208:211], a[144:147], v[160:163]
    ds_read_b64_tr_b16 a[192:193], v246 offset:16384
    v_mfma_f32_16x16x32_bf16 v[164:167], a[208:211], a[148:151], v[164:167]
    ds_read_b64_tr_b16 a[194:195], v246 offset:17408
    v_mfma_f32_16x16x32_bf16 v[168:171], a[208:211], a[152:155], v[168:171]
    ds_read_b64_tr_b16 a[196:197], v238 offset:16384
    v_mfma_f32_16x16x32_bf16 v[172:175], a[208:211], a[156:159], v[172:175]
    ds_read_b64_tr_b16 a[198:199], v238 offset:17408
    v_mfma_f32_16x16x32_bf16 v[176:179], a[212:215], a[144:147], v[176:179]
    ds_read_b64_tr_b16 a[200:201], v246 offset:16640
    v_mfma_f32_16x16x32_bf16 v[180:183], a[212:215], a[148:151], v[180:183]
    ds_read_b64_tr_b16 a[202:203], v246 offset:17664
    v_mfma_f32_16x16x32_bf16 v[184:187], a[212:215], a[152:155], v[184:187]
    ds_read_b64_tr_b16 a[204:205], v238 offset:16640
    v_mfma_f32_16x16x32_bf16 v[188:191], a[212:215], a[156:159], v[188:191]
    ds_read_b64_tr_b16 a[206:207], v238 offset:17664
    v_mfma_f32_16x16x32_bf16 v[192:195], a[216:219], a[144:147], v[192:195]
    buffer_load_dwordx4 a[136:139], v249, s[8:11], s28 offen offset:0 sc1
    v_mfma_f32_16x16x32_bf16 v[196:199], a[216:219], a[148:151], v[196:199]
    v_mfma_f32_16x16x32_bf16 v[200:203], a[216:219], a[152:155], v[200:203]
    buffer_load_dwordx4 a[140:143], v249, s[8:11], s29 offen offset:0 sc1
    v_mfma_f32_16x16x32_bf16 v[204:207], a[216:219], a[156:159], v[204:207]
    s_add_u32 m0, s31, 3072
    s_add_u32 s24, s27, 98304
    v_mfma_f32_16x16x32_bf16 v[208:211], a[220:223], a[144:147], v[208:211]
    buffer_load_dwordx4 v237, s[12:15], s24 offen lds
    v_mfma_f32_16x16x32_bf16 v[212:215], a[220:223], a[148:151], v[212:215]
    v_mfma_f32_16x16x32_bf16 v[216:219], a[220:223], a[152:155], v[216:219]
    v_mfma_f32_16x16x32_bf16 v[220:223], a[220:223], a[156:159], v[220:223]
    s_waitcnt vmcnt(15) lgkmcnt(0)
    v_mfma_f32_16x16x32_bf16 v[96:99], a[192:195], a[160:163], v[96:99]
    ds_read_b64_tr_b16 a[208:209], v246 offset:16896
    v_mfma_f32_16x16x32_bf16 v[100:103], a[192:195], a[164:167], v[100:103]
    ds_read_b64_tr_b16 a[210:211], v246 offset:17920
    v_mfma_f32_16x16x32_bf16 v[104:107], a[192:195], a[168:171], v[104:107]
    ds_read_b64_tr_b16 a[212:213], v238 offset:16896
    v_mfma_f32_16x16x32_bf16 v[108:111], a[192:195], a[172:175], v[108:111]
    ds_read_b64_tr_b16 a[214:215], v238 offset:17920
    v_mfma_f32_16x16x32_bf16 v[112:115], a[196:199], a[160:163], v[112:115]
    ds_read_b64_tr_b16 a[216:217], v246 offset:17152
    v_mfma_f32_16x16x32_bf16 v[116:119], a[196:199], a[164:167], v[116:119]
    ds_read_b64_tr_b16 a[218:219], v246 offset:18176
    v_mfma_f32_16x16x32_bf16 v[120:123], a[196:199], a[168:171], v[120:123]
    ds_read_b64_tr_b16 a[220:221], v238 offset:17152
    v_mfma_f32_16x16x32_bf16 v[124:127], a[196:199], a[172:175], v[124:127]
    ds_read_b64_tr_b16 a[222:223], v238 offset:18176
    v_mfma_f32_16x16x32_bf16 v[128:131], a[200:203], a[160:163], v[128:131]
    buffer_load_dwordx4 a[144:147], v248, s[8:11], s28 offen offset:1024 sc1
    v_mfma_f32_16x16x32_bf16 v[132:135], a[200:203], a[164:167], v[132:135]
    v_mfma_f32_16x16x32_bf16 v[136:139], a[200:203], a[168:171], v[136:139]
    buffer_load_dwordx4 a[148:151], v248, s[8:11], s29 offen offset:1024 sc1
    v_mfma_f32_16x16x32_bf16 v[140:143], a[200:203], a[172:175], v[140:143]
    s_add_u32 m0, s31, 4096
    s_add_u32 s24, s27, 131072
    v_mfma_f32_16x16x32_bf16 v[144:147], a[204:207], a[160:163], v[144:147]
    buffer_load_dwordx4 v245, s[12:15], s24 offen lds
    v_mfma_f32_16x16x32_bf16 v[148:151], a[204:207], a[164:167], v[148:151]
    v_mfma_f32_16x16x32_bf16 v[152:155], a[204:207], a[168:171], v[152:155]
    v_mfma_f32_16x16x32_bf16 v[156:159], a[204:207], a[172:175], v[156:159]
    s_waitcnt lgkmcnt(0)
    v_mfma_f32_16x16x32_bf16 v[160:163], a[208:211], a[160:163], v[160:163]
    ds_read_b64_tr_b16 a[192:193], v246 offset:24576
    v_mfma_f32_16x16x32_bf16 v[164:167], a[208:211], a[164:167], v[164:167]
    ds_read_b64_tr_b16 a[194:195], v246 offset:25600
    v_mfma_f32_16x16x32_bf16 v[168:171], a[208:211], a[168:171], v[168:171]
    ds_read_b64_tr_b16 a[196:197], v238 offset:24576
    v_mfma_f32_16x16x32_bf16 v[172:175], a[208:211], a[172:175], v[172:175]
    ds_read_b64_tr_b16 a[198:199], v238 offset:25600
    v_mfma_f32_16x16x32_bf16 v[176:179], a[212:215], a[160:163], v[176:179]
    ds_read_b64_tr_b16 a[200:201], v246 offset:24832
    v_mfma_f32_16x16x32_bf16 v[180:183], a[212:215], a[164:167], v[180:183]
    ds_read_b64_tr_b16 a[202:203], v246 offset:25856
    v_mfma_f32_16x16x32_bf16 v[184:187], a[212:215], a[168:171], v[184:187]
    ds_read_b64_tr_b16 a[204:205], v238 offset:24832
    v_mfma_f32_16x16x32_bf16 v[188:191], a[212:215], a[172:175], v[188:191]
    ds_read_b64_tr_b16 a[206:207], v238 offset:25856
    v_mfma_f32_16x16x32_bf16 v[192:195], a[216:219], a[160:163], v[192:195]
    buffer_load_dwordx4 a[152:155], v249, s[8:11], s28 offen offset:1024 sc1
    v_mfma_f32_16x16x32_bf16 v[196:199], a[216:219], a[164:167], v[196:199]
    v_mfma_f32_16x16x32_bf16 v[200:203], a[216:219], a[168:171], v[200:203]
    buffer_load_dwordx4 a[156:159], v249, s[8:11], s29 offen offset:1024 sc1
    v_mfma_f32_16x16x32_bf16 v[204:207], a[216:219], a[172:175], v[204:207]
    s_add_u32 m0, s31, 5120
    s_add_u32 s24, s27, 163840
    v_mfma_f32_16x16x32_bf16 v[208:211], a[220:223], a[160:163], v[208:211]
    buffer_load_dwordx4 v245, s[12:15], s24 offen lds
    v_mfma_f32_16x16x32_bf16 v[212:215], a[220:223], a[164:167], v[212:215]
    buffer_store_dwordx4 v[0:3], v240, s[48:51], s80 offen sc1
    s_add_u32 s80, s80, 1024
    v_mfma_f32_16x16x32_bf16 v[216:219], a[220:223], a[168:171], v[216:219]
    s_add_u32 s30, s30, 32768
    v_mfma_f32_16x16x32_bf16 v[220:223], a[220:223], a[172:175], v[220:223]
    s_cmp_ge_u32 s30, 163840
    s_cselect_b32 s30, 65536, s30
    s_waitcnt vmcnt(15) lgkmcnt(0)
    v_mfma_f32_16x16x32_bf16 v[96:99], a[192:195], a[176:179], v[96:99]
    ds_read_b64_tr_b16 a[208:209], v246 offset:25088
    v_mfma_f32_16x16x32_bf16 v[100:103], a[192:195], a[180:183], v[100:103]
    ds_read_b64_tr_b16 a[210:211], v246 offset:26112
    v_mfma_f32_16x16x32_bf16 v[104:107], a[192:195], a[184:187], v[104:107]
    ds_read_b64_tr_b16 a[212:213], v238 offset:25088
    v_mfma_f32_16x16x32_bf16 v[108:111], a[192:195], a[188:191], v[108:111]
    ds_read_b64_tr_b16 a[214:215], v238 offset:26112
    v_mfma_f32_16x16x32_bf16 v[112:115], a[196:199], a[176:179], v[112:115]
    ds_read_b64_tr_b16 a[216:217], v246 offset:25344
    v_mfma_f32_16x16x32_bf16 v[116:119], a[196:199], a[180:183], v[116:119]
    ds_read_b64_tr_b16 a[218:219], v246 offset:26368
    v_mfma_f32_16x16x32_bf16 v[120:123], a[196:199], a[184:187], v[120:123]
    ds_read_b64_tr_b16 a[220:221], v238 offset:25344
    v_mfma_f32_16x16x32_bf16 v[124:127], a[196:199], a[188:191], v[124:127]
    ds_read_b64_tr_b16 a[222:223], v238 offset:26368
    v_mfma_f32_16x16x32_bf16 v[128:131], a[200:203], a[176:179], v[128:131]
    buffer_load_dwordx4 a[160:163], v248, s[8:11], s28 offen offset:2048 sc1
    v_mfma_f32_16x16x32_bf16 v[132:135], a[200:203], a[180:183], v[132:135]
    v_mfma_f32_16x16x32_bf16 v[136:139], a[200:203], a[184:187], v[136:139]
    buffer_load_dwordx4 a[164:167], v248, s[8:11], s29 offen offset:2048 sc1
    v_mfma_f32_16x16x32_bf16 v[140:143], a[200:203], a[188:191], v[140:143]
    s_add_u32 m0, s31, 6144
    s_add_u32 s24, s27, 196608
    v_mfma_f32_16x16x32_bf16 v[144:147], a[204:207], a[176:179], v[144:147]
    buffer_load_dwordx4 v237, s[12:15], s24 offen lds
    v_mfma_f32_16x16x32_bf16 v[148:151], a[204:207], a[180:183], v[148:151]
    v_mfma_f32_16x16x32_bf16 v[152:155], a[204:207], a[184:187], v[152:155]
    s_cmp_eq_u32 s26, 1
    s_cbranch_scc0 ka_nopk
    s_waitcnt vmcnt(22)
    v_readfirstlane_b32 s24, v254
    s_lshl_b32 s25, s3, 16
    s_add_u32 s24, s24, s25
    s_cmp_ge_u32 s24, 8
    s_cbranch_scc0 kf_spin39
kf_spinr40:
ka_nopk:
    v_mfma_f32_16x16x32_bf16 v[156:159], a[204:207], a[188:191], v[156:159]
    s_waitcnt vmcnt(24) lgkmcnt(0)
    s_barrier
    v_add_u32 v246, s30, v247
    v_mfma_f32_16x16x32_bf16 v[160:163], a[208:211], a[176:179], v[160:163]
    v_xor_b32_e64 v238, 16, v246
    ds_read_b64_tr_b16 a[192:193], v246 offset:0
    v_mfma_f32_16x16x32_bf16 v[164:167], a[208:211], a[180:183], v[164:167]
    ds_read_b64_tr_b16 a[194:195], v246 offset:1024
    v_mfma_f32_16x16x32_bf16 v[168:171], a[208:211], a[184:187], v[168:171]
    ds_read_b64_tr_b16 a[196:197], v238 offset:0
    v_mfma_f32_16x16x32_bf16 v[172:175], a[208:211], a[188:191], v[172:175]
    ds_read_b64_tr_b16 a[198:199], v238 offset:1024
    v_mfma_f32_16x16x32_bf16 v[176:179], a[212:215], a[176:179], v[176:179]
    ds_read_b64_tr_b16 a[200:201], v246 offset:256
    v_mfma_f32_16x16x32_bf16 v[180:183], a[212:215], a[180:183], v[180:183]
    ds_read_b64_tr_b16 a[202:203], v246 offset:1280
    v_mfma_f32_16x16x32_bf16 v[184:187], a[212:215], a[184:187], v[184:187]
    ds_read_b64_tr_b16 a[204:205], v238 offset:256
    buffer_atomic_add v255, v250, s[88:91], s97 offen sc1
    s_mov_b32 s97, s43
    v_mfma_f32_16x16x32_bf16 v[188:191], a[212:215], a[188:191], v[188:191]
    ds_read_b64_tr_b16 a[206:207], v238 offset:1280
    v_mfma_f32_16x16x32_bf16 v[192:195], a[216:219], a[176:179], v[192:195]
    buffer_load_dwordx4 a[168:171], v249, s[8:11], s28 offen offset:2048 sc1
    v_mfma_f32_16x16x32_bf16 v[196:199], a[216:219], a[180:183], v[196:199]
    v_mfma_f32_16x16x32_bf16 v[200:203], a[216:219], a[184:187], v[200:203]
    buffer_load_dwordx4 a[172:175], v249, s[8:11], s29 offen offset:2048 sc1
    v_mfma_f32_16x16x32_bf16 v[204:207], a[216:219], a[188:191], v[204:207]
    s_add_u32 m0, s31, 7168
    s_add_u32 s24, s27, 229376
    v_mfma_f32_16x16x32_bf16 v[208:211], a[220:223], a[176:179], v[208:211]
    buffer_load_dwordx4 v237, s[12:15], s24 offen lds
    v_mfma_f32_16x16x32_bf16 v[212:215], a[220:223], a[180:183], v[212:215]
    s_add_u32 s27, s27, 1048576
    s_and_b32 s27, s27, 0x407fffff
    v_mfma_f32_16x16x32_bf16 v[216:219], a[220:223], a[184:187], v[216:219]
    s_cmp_eq_u32 s27, s7
    s_cselect_b32 s27, s43, s27
    v_mfma_f32_16x16x32_bf16 v[220:223], a[220:223], a[188:191], v[220:223]
    s_add_u32 s31, s31, 32768
    s_cmp_ge_u32 s31, 163840
    s_cselect_b32 s24, 98304, 0
    s_sub_u32 s31, s31, s24
    s_sub_u32 s26, s26, 1
    s_cmp_lg_u32 s26, 0
    s_cbranch_scc1 ka_qp
    s_waitcnt vmcnt(15) lgkmcnt(0)
    v_mfma_f32_16x16x32_bf16 v[96:99], a[192:195], a[128:131], v[96:99]
    ds_read_b64_tr_b16 a[208:209], v246 offset:512
    s_sub_u32 s42, s32, 17664
    v_mfma_f32_16x16x32_bf16 v[100:103], a[192:195], a[132:135], v[100:103]
    ds_read_b64_tr_b16 a[210:211], v246 offset:1536
    v_mfma_f32_16x16x32_bf16 v[104:107], a[192:195], a[136:139], v[104:107]
    ds_read_b64_tr_b16 a[212:213], v238 offset:512
    s_mov_b32 m0, s34
    s_add_u32 s41, s42, 17664
    v_mfma_f32_16x16x32_bf16 v[108:111], a[192:195], a[140:143], v[108:111]
    ds_read_b64_tr_b16 a[214:215], v238 offset:1536
    v_mfma_f32_16x16x32_bf16 v[112:115], a[196:199], a[128:131], v[112:115]
    ds_read_b64_tr_b16 a[216:217], v246 offset:768
    v_mfma_f32_16x16x32_bf16 v[116:119], a[196:199], a[132:135], v[116:119]
    ds_read_b64_tr_b16 a[218:219], v246 offset:1792
    buffer_load_dwordx4 v242, s[16:19], s41 offen offset:0 sc1 lds
    v_mfma_f32_16x16x32_bf16 v[120:123], a[196:199], a[136:139], v[120:123]
    ds_read_b64_tr_b16 a[220:221], v238 offset:768
    v_mfma_f32_16x16x32_bf16 v[124:127], a[196:199], a[140:143], v[124:127]
    ds_read_b64_tr_b16 a[222:223], v238 offset:1792
    v_mfma_f32_16x16x32_bf16 v[128:131], a[200:203], a[128:131], v[128:131]
    buffer_load_dwordx4 a[176:179], v248, s[8:11], s28 offen offset:3072 sc1
    buffer_load_dwordx4 v242, s[16:19], s41 offen offset:1024 sc1 lds
    v_mfma_f32_16x16x32_bf16 v[132:135], a[200:203], a[132:135], v[132:135]
    v_mfma_f32_16x16x32_bf16 v[136:139], a[200:203], a[136:139], v[136:139]
    buffer_load_dwordx4 a[180:183], v248, s[8:11], s29 offen offset:3072 sc1
    v_mfma_f32_16x16x32_bf16 v[140:143], a[200:203], a[140:143], v[140:143]
    buffer_load_dwordx4 v242, s[16:19], s41 offen offset:2048 sc1 lds
    v_mfma_f32_16x16x32_bf16 v[144:147], a[204:207], a[128:131], v[144:147]
    v_mfma_f32_16x16x32_bf16 v[148:151], a[204:207], a[132:135], v[148:151]
    v_mfma_f32_16x16x32_bf16 v[152:155], a[204:207], a[136:139], v[152:155]
    buffer_load_dwordx4 v242, s[16:19], s41 offen offset:3072 sc1 lds
    v_mfma_f32_16x16x32_bf16 v[156:159], a[204:207], a[140:143], v[156:159]
    s_waitcnt lgkmcnt(0)
    v_mfma_f32_16x16x32_bf16 v[160:163], a[208:211], a[128:131], v[160:163]
    ds_read_b64_tr_b16 a[192:193], v246 offset:8192
    v_mfma_f32_16x16x32_bf16 v[164:167], a[208:211], a[132:135], v[164:167]
    ds_read_b64_tr_b16 a[194:195], v246 offset:9216
    v_mfma_f32_16x16x32_bf16 v[168:171], a[208:211], a[136:139], v[168:171]
    ds_read_b64_tr_b16 a[196:197], v238 offset:8192
    s_add_u32 s34, s34, 32768
    s_cmp_ge_u32 s34, 163840
    s_cselect_b32 s34, s37, s34
    s_add_u32 s42, s42, 34048
    v_mfma_f32_16x16x32_bf16 v[172:175], a[208:211], a[140:143], v[172:175]
    ds_read_b64_tr_b16 a[198:199], v238 offset:9216
    v_mfma_f32_16x16x32_bf16 v[176:179], a[212:215], a[128:131], v[176:179]
    ds_read_b64_tr_b16 a[200:201], v246 offset:8448
    v_mfma_f32_16x16x32_bf16 v[180:183], a[212:215], a[132:135], v[180:183]
    ds_read_b64_tr_b16 a[202:203], v246 offset:9472
    s_mov_b32 m0, s34
    s_add_u32 s41, s42, 17664
    v_mfma_f32_16x16x32_bf16 v[184:187], a[212:215], a[136:139], v[184:187]
    ds_read_b64_tr_b16 a[204:205], v238 offset:8448
    v_mfma_f32_16x16x32_bf16 v[188:191], a[212:215], a[140:143], v[188:191]
    ds_read_b64_tr_b16 a[206:207], v238 offset:9472
    v_mfma_f32_16x16x32_bf16 v[192:195], a[216:219], a[128:131], v[192:195]
    buffer_load_dwordx4 a[184:187], v249, s[8:11], s28 offen offset:3072 sc1
    buffer_load_dwordx4 v242, s[16:19], s41 offen offset:0 sc1 lds
    v_mfma_f32_16x16x32_bf16 v[196:199], a[216:219], a[132:135], v[196:199]
    v_mfma_f32_16x16x32_bf16 v[200:203], a[216:219], a[136:139], v[200:203]
    buffer_load_dwordx4 a[188:191], v249, s[8:11], s29 offen offset:3072 sc1
    v_mfma_f32_16x16x32_bf16 v[204:207], a[216:219], a[140:143], v[204:207]
    buffer_load_dwordx4 v242, s[16:19], s41 offen offset:1024 sc1 lds
    v_mfma_f32_16x16x32_bf16 v[208:211], a[220:223], a[128:131], v[208:211]
    v_mfma_f32_16x16x32_bf16 v[212:215], a[220:223], a[132:135], v[212:215]
    v_mfma_f32_16x16x32_bf16 v[216:219], a[220:223], a[136:139], v[216:219]
    s_add_u32 s28, s28, 4096
    s_and_b32 s28, s28, 32767
    v_mfma_f32_16x16x32_bf16 v[220:223], a[220:223], a[140:143], v[220:223]
    s_add_u32 s29, s28, 32768
    buffer_load_dwordx4 v242, s[16:19], s41 offen offset:2048 sc1 lds
    s_waitcnt vmcnt(20) lgkmcnt(0)
    v_mfma_f32_16x16x32_bf16 v[96:99], a[192:195], a[144:147], v[96:99]
    ds_read_b64_tr_b16 a[208:209], v246 offset:8704
    s_load_dwordx2 s[80:81], s[0:1], 0
    s_load_dwordx2 s[82:83], s[0:1], 56
    s_load_dwordx4 s[84:87], s[0:1], 80
    v_mfma_f32_16x16x32_bf16 v[100:103], a[192:195], a[148:151], v[100:103]
    ds_read_b64_tr_b16 a[210:211], v246 offset:9728
    v_mfma_f32_16x16x32_bf16 v[104:107], a[192:195], a[152:155], v[104:107]
    ds_read_b64_tr_b16 a[212:213], v238 offset:8704
    buffer_load_dwordx4 v242, s[16:19], s41 offen offset:3072 sc1 lds
    v_mfma_f32_16x16x32_bf16 v[108:111], a[192:195], a[156:159], v[108:111]
    ds_read_b64_tr_b16 a[214:215], v238 offset:9728
    v_mfma_f32_16x16x32_bf16 v[112:115], a[196:199], a[144:147], v[112:115]
    ds_read_b64_tr_b16 a[216:217], v246 offset:8960
    v_mfma_f32_16x16x32_bf16 v[116:119], a[196:199], a[148:151], v[116:119]
    ds_read_b64_tr_b16 a[218:219], v246 offset:9984
    s_add_u32 m0, s34, 16384
    s_add_u32 s34, s34, 32768
    s_cmp_ge_u32 s34, 163840
    s_cselect_b32 s34, s37, s34
    v_mfma_f32_16x16x32_bf16 v[120:123], a[196:199], a[152:155], v[120:123]
    ds_read_b64_tr_b16 a[220:221], v238 offset:8960
    v_mfma_f32_16x16x32_bf16 v[124:127], a[196:199], a[156:159], v[124:127]
    ds_read_b64_tr_b16 a[222:223], v238 offset:9984
    v_mfma_f32_16x16x32_bf16 v[128:131], a[200:203], a[144:147], v[128:131]
    buffer_load_dwordx4 v242, s[16:19], s42 offen offset:0 sc1 lds
    v_mov_b32_e64 v241, v240
    v_mfma_f32_16x16x32_bf16 v[132:135], a[200:203], a[148:151], v[132:135]
    v_lshrrev_b32_e64 v230, 7, v240
    v_mfma_f32_16x16x32_bf16 v[136:139], a[200:203], a[152:155], v[136:139]
    v_mul_u32_u24 v253, 7168, v230
    v_mfma_f32_16x16x32_bf16 v[140:143], a[200:203], a[156:159], v[140:143]
    v_and_b32 v231, 0x70, v240
    v_mfma_f32_16x16x32_bf16 v[144:147], a[204:207], a[144:147], v[144:147]
    buffer_load_dwordx4 v242, s[16:19], s42 offen offset:1024 sc1 lds
    v_mfma_f32_16x16x32_bf16 v[148:151], a[204:207], a[148:151], v[148:151]
    v_add_u32_e64 v253, v253, v231
    v_mfma_f32_16x16x32_bf16 v[152:155], a[204:207], a[152:155], v[152:155]
    v_lshlrev_b32_e64 v255, 5, v230
    v_mfma_f32_16x16x32_bf16 v[156:159], a[204:207], a[156:159], v[156:159]
    buffer_load_dwordx4 v242, s[16:19], s42 offen offset:2048 sc1 lds
    s_waitcnt lgkmcnt(0)
    v_mfma_f32_16x16x32_bf16 v[160:163], a[208:211], a[144:147], v[160:163]
    ds_read_b64_tr_b16 a[192:193], v246 offset:16384
    v_and_b32 v230, 16, v240
    v_mfma_f32_16x16x32_bf16 v[164:167], a[208:211], a[148:151], v[164:167]
    ds_read_b64_tr_b16 a[194:195], v246 offset:17408
    v_mfma_f32_16x16x32_bf16 v[168:171], a[208:211], a[152:155], v[168:171]
    ds_read_b64_tr_b16 a[196:197], v238 offset:16384
    buffer_load_dwordx4 v242, s[16:19], s42 offen offset:3072 sc1 lds
    s_add_u32 s42, s42, 34048
    v_mfma_f32_16x16x32_bf16 v[172:175], a[208:211], a[156:159], v[172:175]
    ds_read_b64_tr_b16 a[198:199], v238 offset:17408
    v_add_u32_e64 v255, v255, v230
    v_mfma_f32_16x16x32_bf16 v[176:179], a[212:215], a[144:147], v[176:179]
    ds_read_b64_tr_b16 a[200:201], v246 offset:16640
    v_mfma_f32_16x16x32_bf16 v[180:183], a[212:215], a[148:151], v[180:183]
    ds_read_b64_tr_b16 a[202:203], v246 offset:17664
    s_mov_b32 m0, s34
    s_add_u32 s41, s42, 17664
    v_mfma_f32_16x16x32_bf16 v[184:187], a[212:215], a[152:155], v[184:187]
    ds_read_b64_tr_b16 a[204:205], v238 offset:16640
    v_lshrrev_b32 v231, 5, v231
    v_mfma_f32_16x16x32_bf16 v[188:191], a[212:215], a[156:159], v[188:191]
    ds_read_b64_tr_b16 a[206:207], v238 offset:17664
    v_mfma_f32_16x16x32_bf16 v[192:195], a[216:219], a[144:147], v[192:195]
    buffer_load_dwordx4 v242, s[16:19], s41 offen offset:0 sc1 lds
    v_lshl_add_u32 v255, v231, 16, v255
    v_mfma_f32_16x16x32_bf16 v[196:199], a[216:219], a[148:151], v[196:199]
    v_mov_b32_e64 v64, 0
    v_mfma_f32_16x16x32_bf16 v[200:203], a[216:219], a[152:155], v[200:203]
    v_mov_b32_e64 v65, 0
    v_mfma_f32_16x16x32_bf16 v[204:207], a[216:219], a[156:159], v[204:207]
    v_mov_b32_e64 v66, 0
    v_mfma_f32_16x16x32_bf16 v[208:211], a[220:223], a[144:147], v[208:211]
    buffer_load_dwordx4 v242, s[16:19], s41 offen offset:1024 sc1 lds
    v_mfma_f32_16x16x32_bf16 v[212:215], a[220:223], a[148:151], v[212:215]
    v_mov_b32_e64 v67, 0
    v_mfma_f32_16x16x32_bf16 v[216:219], a[220:223], a[152:155], v[216:219]
    v_mov_b32_e64 v68, 0
    v_mfma_f32_16x16x32_bf16 v[220:223], a[220:223], a[156:159], v[220:223]
    buffer_load_dwordx4 v242, s[16:19], s41 offen offset:2048 sc1 lds
    s_waitcnt vmcnt(20) lgkmcnt(0)
    v_mfma_f32_16x16x32_bf16 v[96:99], a[192:195], a[160:163], v[96:99]
    ds_read_b64_tr_b16 a[208:209], v246 offset:16896
    v_mov_b32 v69, 0
    v_mfma_f32_16x16x32_bf16 v[100:103], a[192:195], a[164:167], v[100:103]
    ds_read_b64_tr_b16 a[210:211], v246 offset:17920
    v_mfma_f32_16x16x32_bf16 v[104:107], a[192:195], a[168:171], v[104:107]
    ds_read_b64_tr_b16 a[212:213], v238 offset:16896
    buffer_load_dwordx4 v242, s[16:19], s41 offen offset:3072 sc1 lds
    v_mfma_f32_16x16x32_bf16 v[108:111], a[192:195], a[172:175], v[108:111]
    ds_read_b64_tr_b16 a[214:215], v238 offset:17920
    v_mov_b32_e64 v70, 0
    v_mfma_f32_16x16x32_bf16 v[112:115], a[196:199], a[160:163], v[112:115]
    ds_read_b64_tr_b16 a[216:217], v246 offset:17152
    v_mfma_f32_16x16x32_bf16 v[116:119], a[196:199], a[164:167], v[116:119]
    ds_read_b64_tr_b16 a[218:219], v246 offset:18176
    s_add_u32 m0, s34, 16384
    s_add_u32 s34, s34, 32768
    s_cmp_ge_u32 s34, 163840
    s_cselect_b32 s34, s37, s34
    v_mfma_f32_16x16x32_bf16 v[120:123], a[196:199], a[168:171], v[120:123]
    ds_read_b64_tr_b16 a[220:221], v238 offset:17152
    v_mov_b32 v71, 0
    v_mfma_f32_16x16x32_bf16 v[124:127], a[196:199], a[172:175], v[124:127]
    ds_read_b64_tr_b16 a[222:223], v238 offset:18176
    v_mfma_f32_16x16x32_bf16 v[128:131], a[200:203], a[160:163], v[128:131]
    v_mov_b32_e64 v72, 0
    v_mfma_f32_16x16x32_bf16 v[132:135], a[200:203], a[164:167], v[132:135]
    buffer_load_dwordx4 v242, s[16:19], s42 offen offset:0 sc1 lds
    v_mov_b32_e64 v73, 0
    v_mfma_f32_16x16x32_bf16 v[136:139], a[200:203], a[168:171], v[136:139]
    v_mov_b32_e64 v74, 0
    v_mfma_f32_16x16x32_bf16 v[140:143], a[200:203], a[172:175], v[140:143]
    v_mov_b32_e64 v75, 0
    v_mfma_f32_16x16x32_bf16 v[144:147], a[204:207], a[160:163], v[144:147]
    buffer_load_dwordx4 v242, s[16:19], s42 offen offset:1024 sc1 lds
    v_mfma_f32_16x16x32_bf16 v[148:151], a[204:207], a[164:167], v[148:151]
    v_mov_b32_e64 v76, 0
    v_mfma_f32_16x16x32_bf16 v[152:155], a[204:207], a[168:171], v[152:155]
    v_mov_b32_e64 v77, 0
    v_mfma_f32_16x16x32_bf16 v[156:159], a[204:207], a[172:175], v[156:159]
    buffer_load_dwordx4 v242, s[16:19], s42 offen offset:2048 sc1 lds
    s_waitcnt lgkmcnt(0)
    v_mfma_f32_16x16x32_bf16 v[160:163], a[208:211], a[160:163], v[160:163]
    ds_read_b64_tr_b16 a[192:193], v246 offset:24576
    v_mov_b32 v78, 0
    v_mfma_f32_16x16x32_bf16 v[164:167], a[208:211], a[164:167], v[164:167]
    ds_read_b64_tr_b16 a[194:195], v246 offset:25600
    v_mfma_f32_16x16x32_bf16 v[168:171], a[208:211], a[168:171], v[168:171]
    ds_read_b64_tr_b16 a[196:197], v238 offset:24576
    buffer_load_dwordx4 v242, s[16:19], s42 offen offset:3072 sc1 lds
    s_add_u32 s42, s42, 34048
    v_mfma_f32_16x16x32_bf16 v[172:175], a[208:211], a[172:175], v[172:175]
    ds_read_b64_tr_b16 a[198:199], v238 offset:25600
    v_mov_b32_e64 v79, 0
    v_mfma_f32_16x16x32_bf16 v[176:179], a[212:215], a[160:163], v[176:179]
    ds_read_b64_tr_b16 a[200:201], v246 offset:24832
    v_mfma_f32_16x16x32_bf16 v[180:183], a[212:215], a[164:167], v[180:183]
    ds_read_b64_tr_b16 a[202:203], v246 offset:25856
    v_mov_b32_e64 v80, 0
    v_mfma_f32_16x16x32_bf16 v[184:187], a[212:215], a[168:171], v[184:187]
    ds_read_b64_tr_b16 a[204:205], v238 offset:24832
    v_mfma_f32_16x16x32_bf16 v[188:191], a[212:215], a[172:175], v[188:191]
    ds_read_b64_tr_b16 a[206:207], v238 offset:25856
    v_mov_b32_e64 v81, 0
    v_mfma_f32_16x16x32_bf16 v[192:195], a[216:219], a[160:163], v[192:195]
    v_mov_b32_e64 v82, 0
    v_mfma_f32_16x16x32_bf16 v[196:199], a[216:219], a[164:167], v[196:199]
    v_mov_b32_e64 v83, 0
    v_mfma_f32_16x16x32_bf16 v[200:203], a[216:219], a[168:171], v[200:203]
    v_mov_b32_e64 v84, 0
    v_mfma_f32_16x16x32_bf16 v[204:207], a[216:219], a[172:175], v[204:207]
    v_mov_b32_e64 v85, 0
    v_mfma_f32_16x16x32_bf16 v[208:211], a[220:223], a[160:163], v[208:211]
    v_mov_b32_e64 v86, 0
    v_mfma_f32_16x16x32_bf16 v[212:215], a[220:223], a[164:167], v[212:215]
    v_mov_b32_e64 v87, 0
    v_mfma_f32_16x16x32_bf16 v[216:219], a[220:223], a[168:171], v[216:219]
    v_mov_b32_e64 v88, 0
    v_mfma_f32_16x16x32_bf16 v[220:223], a[220:223], a[172:175], v[220:223]
    s_waitcnt vmcnt(15) lgkmcnt(0)
    v_mfma_f32_16x16x32_bf16 v[96:99], a[192:195], a[176:179], v[96:99]
    ds_read_b64_tr_b16 a[208:209], v246 offset:25088
    v_mov_b32 v89, 0
    v_mfma_f32_16x16x32_bf16 v[100:103], a[192:195], a[180:183], v[100:103]
    ds_read_b64_tr_b16 a[210:211], v246 offset:26112
    v_mfma_f32_16x16x32_bf16 v[104:107], a[192:195], a[184:187], v[104:107]
    ds_read_b64_tr_b16 a[212:213], v238 offset:25088
    v_mov_b32_e64 v90, 0
    v_mfma_f32_16x16x32_bf16 v[108:111], a[192:195], a[188:191], v[108:111]
    ds_read_b64_tr_b16 a[214:215], v238 offset:26112
    v_mfma_f32_16x16x32_bf16 v[112:115], a[196:199], a[176:179], v[112:115]
    ds_read_b64_tr_b16 a[216:217], v246 offset:25344
    v_mov_b32_e64 v91, 0
    v_mfma_f32_16x16x32_bf16 v[116:119], a[196:199], a[180:183], v[116:119]
    ds_read_b64_tr_b16 a[218:219], v246 offset:26368
    v_mfma_f32_16x16x32_bf16 v[120:123], a[196:199], a[184:187], v[120:123]
    ds_read_b64_tr_b16 a[220:221], v238 offset:25344
    v_mov_b32_e64 v92, 0
    v_mfma_f32_16x16x32_bf16 v[124:127], a[196:199], a[188:191], v[124:127]
    ds_read_b64_tr_b16 a[222:223], v238 offset:26368
    v_mfma_f32_16x16x32_bf16 v[128:131], a[200:203], a[176:179], v[128:131]
    v_mov_b32_e64 v93, 0
    v_mfma_f32_16x16x32_bf16 v[132:135], a[200:203], a[180:183], v[132:135]
    v_mov_b32_e64 v94, 0
    v_mfma_f32_16x16x32_bf16 v[136:139], a[200:203], a[184:187], v[136:139]
    v_mov_b32_e64 v95, 0
    v_mfma_f32_16x16x32_bf16 v[140:143], a[200:203], a[188:191], v[140:143]
    v_mov_b32_e64 v224, 0
    v_mfma_f32_16x16x32_bf16 v[144:147], a[204:207], a[176:179], v[144:147]
    v_mov_b32_e64 v225, 0
    v_mfma_f32_16x16x32_bf16 v[148:151], a[204:207], a[180:183], v[148:151]
    v_mov_b32_e64 v226, 0
    v_mfma_f32_16x16x32_bf16 v[152:155], a[204:207], a[184:187], v[152:155]
    v_mov_b32_e64 v227, 0
    v_mfma_f32_16x16x32_bf16 v[156:159], a[204:207], a[188:191], v[156:159]
    s_waitcnt vmcnt(8) lgkmcnt(0)
    s_barrier
    v_mfma_f32_16x16x32_bf16 v[160:163], a[208:211], a[176:179], v[160:163]
    ds_read_b128 a[192:195], v241 offset:0
    s_mov_b32 m0, s34
    s_add_u32 s41, s42, 17664
    v_mfma_f32_16x16x32_bf16 v[164:167], a[208:211], a[180:183], v[164:167]
    ds_read_b128 a[196:199], v241 offset:2048
    buffer_load_dwordx4 v242, s[16:19], s41 offen offset:0 sc1 lds
    v_mfma_f32_16x16x32_bf16 v[168:171], a[208:211], a[184:187], v[168:171]
    ds_read_b128 a[200:203], v241 offset:4096
    v_mfma_f32_16x16x32_bf16 v[172:175], a[208:211], a[188:191], v[172:175]
    ds_read_b128 a[204:207], v241 offset:6144
    buffer_load_dwordx4 v242, s[16:19], s41 offen offset:1024 sc1 lds
    v_mfma_f32_16x16x32_bf16 v[176:179], a[212:215], a[176:179], v[176:179]
    ds_read_b128 a[224:227], v241 offset:8192
    buffer_load_dwordx4 v242, s[16:19], s41 offen offset:2048 sc1 lds
    v_mfma_f32_16x16x32_bf16 v[180:183], a[212:215], a[180:183], v[180:183]
    ds_read_b128 a[228:231], v241 offset:10240
    v_mfma_f32_16x16x32_bf16 v[184:187], a[212:215], a[184:187], v[184:187]
    ds_read_b128 a[232:235], v241 offset:12288
    buffer_load_dwordx4 v242, s[16:19], s41 offen offset:3072 sc1 lds
    v_mfma_f32_16x16x32_bf16 v[188:191], a[212:215], a[188:191], v[188:191]
    ds_read_b128 a[236:239], v241 offset:14336
    v_mfma_f32_16x16x32_bf16 v[192:195], a[216:219], a[176:179], v[192:195]
    ds_read_b128 a[240:243], v241 offset:9216
    s_add_u32 m0, s34, 16384
    s_add_u32 s34, s34, 32768
    s_cmp_ge_u32 s34, 163840
    s_cselect_b32 s34, s37, s34
    v_mfma_f32_16x16x32_bf16 v[196:199], a[216:219], a[180:183], v[196:199]
    ds_read_b128 a[244:247], v241 offset:11264
    buffer_load_dwordx4 v242, s[16:19], s42 offen offset:0 sc1 lds
    v_mfma_f32_16x16x32_bf16 v[200:203], a[216:219], a[184:187], v[200:203]
    ds_read_b128 a[248:251], v241 offset:13312
    v_mfma_f32_16x16x32_bf16 v[204:207], a[216:219], a[188:191], v[204:207]
    ds_read_b128 a[252:255], v241 offset:15360
    buffer_load_dwordx4 v242, s[16:19], s42 offen offset:1024 sc1 lds
    v_mfma_f32_16x16x32_bf16 v[208:211], a[220:223], a[176:179], v[208:211]
    buffer_load_dwordx4 v242, s[16:19], s42 offen offset:2048 sc1 lds
    v_mfma_f32_16x16x32_bf16 v[212:215], a[220:223], a[180:183], v[212:215]
    v_mfma_f32_16x16x32_bf16 v[216:219], a[220:223], a[184:187], v[216:219]
    buffer_load_dwordx4 v242, s[16:19], s42 offen offset:3072 sc1 lds
    s_add_u32 s42, s42, 34048
    v_mfma_f32_16x16x32_bf16 v[220:223], a[220:223], a[188:191], v[220:223]
    s_waitcnt lgkmcnt(8)
    ds_read_b128 a[208:211], v241 offset:1024
    ds_read_b128 a[212:215], v241 offset:3072
    ds_read_b128 a[216:219], v241 offset:5120
    ds_read_b128 a[220:223], v241 offset:7168
    s_sub_u32 s36, s36, 1
    s_cbranch_scc1 kf_fix1
kf_fixr2:
    v_cvt_pk_bf16_f32 v96, v96, v97
    v_cvt_pk_bf16_f32 v97, v98, v99
    v_cvt_pk_bf16_f32 v98, v112, v113
    v_cvt_pk_bf16_f32 v99, v114, v115
    v_accvgpr_write_b32 a128, v96
    v_accvgpr_write_b32 a129, v97
    v_accvgpr_write_b32 a130, v98
    v_accvgpr_write_b32 a131, v99
    v_cvt_pk_bf16_f32 v100, v100, v101
    v_cvt_pk_bf16_f32 v101, v102, v103
    v_cvt_pk_bf16_f32 v102, v116, v117
    v_cvt_pk_bf16_f32 v103, v118, v119
    v_accvgpr_write_b32 a144, v100
    v_accvgpr_write_b32 a145, v101
    v_accvgpr_write_b32 a146, v102
    v_accvgpr_write_b32 a147, v103
    v_cvt_pk_bf16_f32 v104, v104, v105
    v_cvt_pk_bf16_f32 v105, v106, v107
    v_cvt_pk_bf16_f32 v106, v120, v121
    v_cvt_pk_bf16_f32 v107, v122, v123
    v_accvgpr_write_b32 a160, v104
    v_accvgpr_write_b32 a161, v105
    v_accvgpr_write_b32 a162, v106
    v_accvgpr_write_b32 a163, v107
    v_cvt_pk_bf16_f32 v108, v108, v109
    v_cvt_pk_bf16_f32 v109, v110, v111
    v_cvt_pk_bf16_f32 v110, v124, v125
    v_cvt_pk_bf16_f32 v111, v126, v127
    v_accvgpr_write_b32 a176, v108
    v_accvgpr_write_b32 a177, v109
    v_accvgpr_write_b32 a178, v110
    v_accvgpr_write_b32 a179, v111
    s_nop 1
    s_waitcnt lgkmcnt(0)
    v_mfma_f32_16x16x32_bf16 v[0:3], a[192:195], a[128:131], v[64:67]
    v_cvt_pk_bf16_f32 v128, v128, v129
    v_cvt_pk_bf16_f32 v129, v130, v131
    v_cvt_pk_bf16_f32 v130, v144, v145
    v_cvt_pk_bf16_f32 v131, v146, v147
    v_mfma_f32_16x16x32_bf16 v[8:11], a[192:195], a[144:147], v[72:75]
    v_accvgpr_write_b32 a132, v128
    v_accvgpr_write_b32 a133, v129
    v_accvgpr_write_b32 a134, v130
    v_accvgpr_write_b32 a135, v131
    v_mfma_f32_16x16x32_bf16 v[16:19], a[192:195], a[160:163], v[80:83]
    v_cvt_pk_bf16_f32 v132, v132, v133
    v_cvt_pk_bf16_f32 v133, v134, v135
    v_cvt_pk_bf16_f32 v134, v148, v149
    v_cvt_pk_bf16_f32 v135, v150, v151
    v_mfma_f32_16x16x32_bf16 v[24:27], a[192:195], a[176:179], v[88:91]
    v_accvgpr_write_b32 a148, v132
    v_accvgpr_write_b32 a149, v133
    v_accvgpr_write_b32 a150, v134
    v_accvgpr_write_b32 a151, v135
    v_mfma_f32_16x16x32_bf16 v[4:7], a[208:211], a[128:131], v[68:71]
    v_cvt_pk_bf16_f32 v136, v136, v137
    v_cvt_pk_bf16_f32 v137, v138, v139
    v_cvt_pk_bf16_f32 v138, v152, v153
    v_cvt_pk_bf16_f32 v139, v154, v155
    v_mfma_f32_16x16x32_bf16 v[12:15], a[208:211], a[144:147], v[76:79]
    v_accvgpr_write_b32 a164, v136
    v_accvgpr_write_b32 a165, v137
    v_accvgpr_write_b32 a166, v138
    v_accvgpr_write_b32 a167, v139
    v_mfma_f32_16x16x32_bf16 v[20:23], a[208:211], a[160:163], v[84:87]
    v_cvt_pk_bf16_f32 v140, v140, v141
    v_cvt_pk_bf16_f32 v141, v142, v143
    v_cvt_pk_bf16_f32 v142, v156, v157
    v_cvt_pk_bf16_f32 v143, v158, v159
    v_mfma_f32_16x16x32_bf16 v[28:31], a[208:211], a[176:179], v[92:95]
    v_accvgpr_write_b32 a180, v140
    v_accvgpr_write_b32 a181, v141
    v_accvgpr_write_b32 a182, v142
    v_accvgpr_write_b32 a183, v143
    s_nop 1
    v_mfma_f32_16x16x32_bf16 v[0:3], a[196:199], a[132:135], v[0:3]
    v_cvt_pk_bf16_f32 v160, v160, v161
    v_cvt_pk_bf16_f32 v161, v162, v163
    v_cvt_pk_bf16_f32 v162, v176, v177
    v_cvt_pk_bf16_f32 v163, v178, v179
    v_mfma_f32_16x16x32_bf16 v[8:11], a[196:199], a[148:151], v[8:11]
    v_accvgpr_write_b32 a136, v160
    v_accvgpr_write_b32 a137, v161
    v_accvgpr_write_b32 a138, v162
    v_accvgpr_write_b32 a139, v163
    v_mfma_f32_16x16x32_bf16 v[16:19], a[196:199], a[164:167], v[16:19]
    v_cvt_pk_bf16_f32 v164, v164, v165
    v_cvt_pk_bf16_f32 v165, v166, v167
    v_cvt_pk_bf16_f32 v166, v180, v181
    v_cvt_pk_bf16_f32 v167, v182, v183
    v_mfma_f32_16x16x32_bf16 v[24:27], a[196:199], a[180:183], v[24:27]
    v_accvgpr_write_b32 a152, v164
    v_accvgpr_write_b32 a153, v165
    v_accvgpr_write_b32 a154, v166
    v_accvgpr_write_b32 a155, v167
    v_mfma_f32_16x16x32_bf16 v[4:7], a[212:215], a[132:135], v[4:7]
    v_cvt_pk_bf16_f32 v168, v168, v169
    v_cvt_pk_bf16_f32 v169, v170, v171
    v_cvt_pk_bf16_f32 v170, v184, v185
    v_cvt_pk_bf16_f32 v171, v186, v187
    v_mfma_f32_16x16x32_bf16 v[12:15], a[212:215], a[148:151], v[12:15]
    v_accvgpr_write_b32 a168, v168
    v_accvgpr_write_b32 a169, v169
    v_accvgpr_write_b32 a170, v170
    v_accvgpr_write_b32 a171, v171
    v_mfma_f32_16x16x32_bf16 v[20:23], a[212:215], a[164:167], v[20:23]
    v_cvt_pk_bf16_f32 v172, v172, v173
    v_cvt_pk_bf16_f32 v173, v174, v175
    v_cvt_pk_bf16_f32 v174, v188, v189
    v_cvt_pk_bf16_f32 v175, v190, v191
    v_mfma_f32_16x16x32_bf16 v[28:31], a[212:215], a[180:183], v[28:31]
    v_accvgpr_write_b32 a184, v172
    v_accvgpr_write_b32 a185, v173
    v_accvgpr_write_b32 a186, v174
    v_accvgpr_write_b32 a187, v175
    s_nop 1
    s_waitcnt lgkmcnt(0)
    v_mfma_f32_16x16x32_bf16 v[0:3], a[200:203], a[136:139], v[0:3]
    v_cvt_pk_bf16_f32 v192, v192, v193
    v_cvt_pk_bf16_f32 v193, v194, v195
    v_cvt_pk_bf16_f32 v194, v208, v209
    v_cvt_pk_bf16_f32 v195, v210, v211
    v_mfma_f32_16x16x32_bf16 v[8:11], a[200:203], a[152:155], v[8:11]
    v_accvgpr_write_b32 a140, v192
    v_accvgpr_write_b32 a141, v193
    v_accvgpr_write_b32 a142, v194
    v_accvgpr_write_b32 a143, v195
    v_mfma_f32_16x16x32_bf16 v[16:19], a[200:203], a[168:171], v[16:19]
    v_cvt_pk_bf16_f32 v196, v196, v197
    v_cvt_pk_bf16_f32 v197, v198, v199
    v_cvt_pk_bf16_f32 v198, v212, v213
    v_cvt_pk_bf16_f32 v199, v214, v215
    v_mfma_f32_16x16x32_bf16 v[24:27], a[200:203], a[184:187], v[24:27]
    v_accvgpr_write_b32 a156, v196
    v_accvgpr_write_b32 a157, v197
    v_accvgpr_write_b32 a158, v198
    v_accvgpr_write_b32 a159, v199
    v_mfma_f32_16x16x32_bf16 v[4:7], a[216:219], a[136:139], v[4:7]
    v_cvt_pk_bf16_f32 v200, v200, v201
    v_cvt_pk_bf16_f32 v201, v202, v203
    v_cvt_pk_bf16_f32 v202, v216, v217
    v_cvt_pk_bf16_f32 v203, v218, v219
    v_mfma_f32_16x16x32_bf16 v[12:15], a[216:219], a[152:155], v[12:15]
    v_accvgpr_write_b32 a172, v200
    v_accvgpr_write_b32 a173, v201
    v_accvgpr_write_b32 a174, v202
    v_accvgpr_write_b32 a175, v203
    v_mfma_f32_16x16x32_bf16 v[20:23], a[216:219], a[168:171], v[20:23]
    v_cvt_pk_bf16_f32 v204, v204, v205
    v_cvt_pk_bf16_f32 v205, v206, v207
    v_cvt_pk_bf16_f32 v206, v220, v221
    v_cvt_pk_bf16_f32 v207, v222, v223
    v_mfma_f32_16x16x32_bf16 v[28:31], a[216:219], a[184:187], v[28:31]
    v_accvgpr_write_b32 a188, v204
    v_accvgpr_write_b32 a189, v205
    v_accvgpr_write_b32 a190, v206
    v_accvgpr_write_b32 a191, v207
    s_nop 1
    v_mfma_f32_16x16x32_bf16 v[0:3], a[204:207], a[140:143], v[0:3]
    v_mov_b32 v144, 0
    v_mov_b32 v145, 0
    v_mov_b32 v146, 0
    v_mfma_f32_16x16x32_bf16 v[8:11], a[204:207], a[156:159], v[8:11]
    v_mov_b32 v147, 0
    v_mov_b32 v148, 0
    v_mfma_f32_16x16x32_bf16 v[16:19], a[204:207], a[172:175], v[16:19]
    v_mov_b32 v149, 0
    v_mov_b32 v150, 0
    v_mov_b32_e64 v151, 0
    v_mfma_f32_16x16x32_bf16 v[24:27], a[204:207], a[188:191], v[24:27]
    v_mov_b32 v152, 0
    v_mov_b32 v153, 0
    v_mfma_f32_16x16x32_bf16 v[4:7], a[220:223], a[140:143], v[4:7]
    v_mov_b32 v154, 0
    v_mov_b32 v155, 0
    v_mov_b32_e64 v156, 0
    v_mfma_f32_16x16x32_bf16 v[12:15], a[220:223], a[156:159], v[12:15]
    v_mov_b32 v157, 0
    v_mov_b32 v158, 0
    v_mfma_f32_16x16x32_bf16 v[20:23], a[220:223], a[172:175], v[20:23]
    v_mov_b32_e64 v159, 0
    v_mov_b32 v204, 0x3f803f80
    v_mov_b32 v205, 0x3f803f80
    v_mfma_f32_16x16x32_bf16 v[28:31], a[220:223], a[188:191], v[28:31]
    v_mov_b32 v206, 0x3f803f80
    v_mov_b32 v207, 0x3f803f80
    s_nop 4
    v_max3_f32 v128, v0, v1, v2
    v_max3_f32 v130, v8, v9, v10
    v_max3_f32 v132, v16, v17, v18
    v_max3_f32 v134, v24, v25, v26
    v_max3_f32 v128, v128, v3, v4
    v_max3_f32 v130, v130, v11, v12
    v_max3_f32 v132, v132, v19, v20
    v_max3_f32 v134, v134, v27, v28
    v_max3_f32 v128, v128, v5, v6
    v_max3_f32 v130, v130, v13, v14
    v_max3_f32 v132, v132, v21, v22
    v_max3_f32 v134, v134, v29, v30
    v_max_f32 v128, v128, v7
    v_max_f32 v130, v130, v15
    v_max_f32 v132, v132, v23
    v_max_f32 v134, v134, v31
    v_mov_b32 v129, v128
    v_mov_b32 v131, v130
    v_mov_b32 v133, v132
    v_mov_b32 v135, v134
    v_permlane16_swap_b32 v128, v129
    v_permlane16_swap_b32 v130, v131
    v_permlane16_swap_b32 v132, v133
    v_permlane16_swap_b32 v134, v135
    v_max_f32 v128, v128, v129
    v_max_f32 v130, v130, v131
    v_max_f32 v132, v132, v133
    v_max_f32 v134, v134, v135
    v_mov_b32 v129, v128
    v_mov_b32 v131, v130
    v_mov_b32 v133, v132
    v_mov_b32 v135, v134
    v_permlane32_swap_b32 v128, v129
    v_permlane32_swap_b32 v130, v131
    v_permlane32_swap_b32 v132, v133
    v_permlane32_swap_b32 v134, v135
    v_max_f32 v128, v128, v129
    v_max_f32 v130, v130, v131
    v_max_f32 v132, v132, v133
    v_max_f32_e64 v134, v134, v135
    v_add_f32 v128, 0x41800000, v128
    v_add_f32 v130, 0x41800000, v130
    v_add_f32 v132, 0x41800000, v132
    v_add_f32 v134, 0x41800000, v134
    v_sub_f32 v224, 0, v128
    v_sub_f32 v64, v64, v128
    v_sub_f32 v65, v65, v128
    v_sub_f32 v66, v66, v128
    v_sub_f32 v67, v67, v128
    v_sub_f32 v68, v68, v128
    v_sub_f32 v69, v69, v128
    v_sub_f32 v70, v70, v128
    v_sub_f32 v71, v71, v128
    v_sub_f32 v225, 0, v130
    v_sub_f32 v72, v72, v130
    v_sub_f32 v73, v73, v130
    v_sub_f32 v74, v74, v130
    v_sub_f32 v75, v75, v130
    v_sub_f32 v76, v76, v130
    v_sub_f32 v77, v77, v130
    v_sub_f32 v78, v78, v130
    v_sub_f32 v79, v79, v130
    v_sub_f32 v226, 0, v132
    v_sub_f32 v80, v80, v132
    v_sub_f32 v81, v81, v132
    v_sub_f32 v82, v82, v132
    v_sub_f32 v83, v83, v132
    v_sub_f32 v84, v84, v132
    v_sub_f32 v85, v85, v132
    v_sub_f32 v86, v86, v132
    v_sub_f32 v87, v87, v132
    v_sub_f32 v227, 0, v134
    v_sub_f32 v88, v88, v134
    v_sub_f32 v89, v89, v134
    v_sub_f32 v90, v90, v134
    v_sub_f32 v91, v91, v134
    v_sub_f32 v92, v92, v134
    v_sub_f32 v93, v93, v134
    v_sub_f32 v94, v94, v134
    v_sub_f32 v95, v95, v134
    v_sub_f32 v0, v0, v128
    v_sub_f32 v1, v1, v128
    v_sub_f32 v2, v2, v128
    v_sub_f32 v3, v3, v128
    v_sub_f32 v4, v4, v128
    v_sub_f32 v5, v5, v128
    v_sub_f32 v6, v6, v128
    v_sub_f32 v7, v7, v128
    v_sub_f32 v8, v8, v130
    v_sub_f32 v9, v9, v130
    v_sub_f32 v10, v10, v130
    v_sub_f32 v11, v11, v130
    v_sub_f32 v12, v12, v130
    v_sub_f32 v13, v13, v130
    v_sub_f32 v14, v14, v130
    v_sub_f32 v15, v15, v130
    v_sub_f32 v16, v16, v132
    v_sub_f32 v17, v17, v132
    v_sub_f32 v18, v18, v132
    v_sub_f32 v19, v19, v132
    v_sub_f32 v20, v20, v132
    v_sub_f32 v21, v21, v132
    v_sub_f32 v22, v22, v132
    v_sub_f32 v23, v23, v132
    v_sub_f32 v24, v24, v134
    v_sub_f32 v25, v25, v134
    v_sub_f32 v26, v26, v134
    v_sub_f32 v27, v27, v134
    v_sub_f32 v28, v28, v134
    v_sub_f32 v29, v29, v134
    v_sub_f32 v30, v30, v134
    v_sub_f32 v31, v31, v134
    s_mov_b32 s35, 32768
    v_add_u32_e64 v241, s35, v240
    s_sub_u32 s36, s36, 1
    s_cbranch_scc1 kf_fix3
kf_fixr4:
    v_mfma_f32_16x16x32_bf16 v[32:35], a[224:227], a[128:131], v[64:67]
    ds_read_b128 a[192:195], v241 offset:0
    v_exp_f32_e64 v128, v0
    v_mfma_f32_16x16x32_bf16 v[32:35], a[228:231], a[132:135], v[32:35]
    v_exp_f32_e64 v129, v1
    v_mfma_f32_16x16x32_bf16 v[32:35], a[232:235], a[136:139], v[32:35]
    v_exp_f32_e64 v130, v2
    v_cvt_pk_bf16_f32 v96, v128, v129
    v_mfma_f32_16x16x32_bf16 v[32:35], a[236:239], a[140:143], v[32:35]
    v_exp_f32_e64 v131, v3
    v_mfma_f32_16x16x32_bf16 v[40:43], a[224:227], a[144:147], v[72:75]
    ds_read_b128 a[196:199], v241 offset:2048
    v_exp_f32_e64 v132, v4
    v_mfma_f32_16x16x32_bf16 v[40:43], a[228:231], a[148:151], v[40:43]
    v_exp_f32_e64 v133, v5
    v_cvt_pk_bf16_f32 v97, v130, v131
    v_mfma_f32_16x16x32_bf16 v[40:43], a[232:235], a[152:155], v[40:43]
    v_exp_f32_e64 v134, v6
    v_cvt_pk_bf16_f32 v98, v132, v133
    v_mfma_f32_16x16x32_bf16 v[40:43], a[236:239], a[156:159], v[40:43]
    v_exp_f32_e64 v135, v7
    v_mfma_f32_16x16x32_bf16 v[48:51], a[224:227], a[160:163], v[80:83]
    ds_read_b128 a[200:203], v241 offset:4096
    v_exp_f32_e64 v136, v8
    v_mfma_f32_16x16x32_bf16 v[48:51], a[228:231], a[164:167], v[48:51]
    v_exp_f32_e64 v137, v9
    v_cvt_pk_bf16_f32 v99, v134, v135
    v_mfma_f32_16x16x32_bf16 v[48:51], a[232:235], a[168:171], v[48:51]
    v_exp_f32 v138, v10
    v_exp_f32 v139, v11
    v_mfma_f32_16x16x32_bf16 v[48:51], a[236:239], a[172:175], v[48:51]
    v_exp_f32_e64 v140, v12
    v_cvt_pk_bf16_f32 v100, v136, v137
    v_mfma_f32_16x16x32_bf16 v[56:59], a[224:227], a[176:179], v[88:91]
    ds_read_b128 a[204:207], v241 offset:6144
    v_exp_f32_e64 v141, v13
    v_mfma_f32_16x16x32_bf16 v[56:59], a[228:231], a[180:183], v[56:59]
    v_exp_f32_e64 v142, v14
    v_cvt_pk_bf16_f32 v101, v138, v139
    v_mfma_f32_16x16x32_bf16 v[56:59], a[232:235], a[184:187], v[56:59]
    v_exp_f32_e64 v143, v15
    v_cvt_pk_bf16_f32 v102, v140, v141
    v_mfma_f32_16x16x32_bf16 v[56:59], a[236:239], a[188:191], v[56:59]
    v_exp_f32_e64 v128, v16
    v_cvt_pk_bf16_f32 v103, v142, v143
    v_mfma_f32_16x16x32_bf16 v[36:39], a[240:243], a[128:131], v[68:71]
    ds_read_b128 a[208:211], v241 offset:1024
    v_exp_f32_e64 v129, v17
    v_mfma_f32_16x16x32_bf16 v[36:39], a[244:247], a[132:135], v[36:39]
    v_exp_f32_e64 v130, v18
    v_cvt_pk_bf16_f32 v104, v128, v129
    v_mfma_f32_16x16x32_bf16 v[36:39], a[248:251], a[136:139], v[36:39]
    v_exp_f32_e64 v131, v19
    v_mfma_f32_16x16x32_bf16 v[36:39], a[252:255], a[140:143], v[36:39]
    v_exp_f32_e64 v132, v20
    v_cvt_pk_bf16_f32 v105, v130, v131
    v_mfma_f32_16x16x32_bf16 v[44:47], a[240:243], a[144:147], v[76:79]
    ds_read_b128 a[212:215], v241 offset:3072
    v_exp_f32_e64 v133, v21
    v_mfma_f32_16x16x32_bf16 v[44:47], a[244:247], a[148:151], v[44:47]
    v_exp_f32 v134, v22
    v_exp_f32 v135, v23
    v_mfma_f32_16x16x32_bf16 v[44:47], a[248:251], a[152:155], v[44:47]
    v_exp_f32_e64 v136, v24
    v_cvt_pk_bf16_f32 v106, v132, v133
    v_mfma_f32_16x16x32_bf16 v[44:47], a[252:255], a[156:159], v[44:47]
    v_exp_f32_e64 v137, v25
    v_cvt_pk_bf16_f32 v107, v134, v135
    v_mfma_f32_16x16x32_bf16 v[52:55], a[240:243], a[160:163], v[84:87]
    ds_read_b128 a[216:219], v241 offset:5120
    v_exp_f32_e64 v138, v26
    v_mfma_f32_16x16x32_bf16 v[52:55], a[244:247], a[164:167], v[52:55]
    v_exp_f32_e64 v139, v27
    v_cvt_pk_bf16_f32 v108, v136, v137
    v_mfma_f32_16x16x32_bf16 v[52:55], a[248:251], a[168:171], v[52:55]
    v_exp_f32_e64 v140, v28
    v_cvt_pk_bf16_f32 v109, v138, v139
    v_mfma_f32_16x16x32_bf16 v[52:55], a[252:255], a[172:175], v[52:55]
    v_exp_f32_e64 v141, v29
    v_mfma_f32_16x16x32_bf16 v[60:63], a[240:243], a[176:179], v[92:95]
    ds_read_b128 a[220:223], v241 offset:7168
    v_exp_f32_e64 v142, v30
    v_mfma_f32_16x16x32_bf16 v[60:63], a[244:247], a[180:183], v[60:63]
    v_exp_f32_e64 v143, v31
    v_cvt_pk_bf16_f32 v110, v140, v141
    v_mfma_f32_16x16x32_bf16 v[60:63], a[248:251], a[184:187], v[60:63]
    v_cvt_pk_bf16_f32 v111, v142, v143
    v_mfma_f32_16x16x32_bf16 v[60:63], a[252:255], a[188:191], v[60:63]
    v_add_f32 v200, 0, v243
    v_min_f32 v200, 0, v200
    v_add_f32 v201, 0xf1800000, v243
    v_min_f32_e64 v201, 0, v201
    v_add_f32 v202, 0xf2000000, v243
    v_min_f32_e64 v202, 0, v202
    v_add_f32 v203, 0xf2400000, v243
    v_min_f32_e64 v203, 0, v203
    v_add_f32 v209, 0xf3000000, v243
    v_min_f32_e64 v209, 0, v209
    v_add_f32 v210, 0xf3100000, v243
    v_min_f32_e64 v210, 0, v210
    v_add_f32 v211, 0xf3200000, v243
    v_min_f32_e64 v211, 0, v211
    v_add_f32 v212, 0xf3300000, v243
    v_min_f32_e64 v212, 0, v212
    v_add_f32 v213, 0x73800000, v243
    v_min_f32_e64 v213, 0, v213
    v_add_f32 v214, 0x73700000, v243
    v_min_f32_e64 v214, 0, v214
    v_add_f32 v215, 0x73600000, v243
    v_min_f32_e64 v215, 0, v215
    v_add_f32 v216, 0x73500000, v243
    v_min_f32_e64 v216, 0, v216
    v_add_f32 v217, 0x73000000, v243
    v_min_f32_e64 v217, 0, v217
    v_add_f32 v218, 0x72e00000, v243
    v_min_f32_e64 v218, 0, v218
    v_add_f32 v219, 0x72c00000, v243
    v_min_f32_e64 v219, 0, v219
    v_add_f32 v220, 0x72a00000, v243
    v_min_f32_e64 v220, 0, v220
    ds_read_b128 a[224:227], v241 offset:16384
    ds_read_b128 a[228:231], v241 offset:17408
    ds_read_b128 a[232:235], v241 offset:18432
    ds_read_b128 a[236:239], v241 offset:19456
    s_mul_i32 s27, s5, 68096
    s_sub_u32 s27, s32, s27
    s_add_u32 s18, s27, 1089536
    s_mov_b32 s31, s101
    v_mul_u32_u24 v245, 448, v240
    v_and_b32 v230, 0x40000000, v251
    v_or_b32 v245, v245, v230
    s_lshl1_add_u32 s26, s5, s31
    s_branch ka_p1_e
.p2align 5
ka_p1:
    s_sub_u32 s36, s36, 1
    s_cbranch_scc1 kf_fix7
kf_fixr8:
    s_waitcnt lgkmcnt(8)
    v_mfma_f32_16x16x32_bf16 v[0:3], a[192:195], a[128:131], v[64:67]
    ds_read_b128 a[240:243], v241 offset:20480
    s_waitcnt vmcnt(11)
    v_mfma_f32_16x16x32_bf16 v[0:3], a[196:199], a[132:135], v[0:3]
    v_exp_f32_e64 v128, v32
    v_mfma_f32_16x16x32_bf16 v[0:3], a[200:203], a[136:139], v[0:3]
    v_exp_f32_e64 v129, v33
    v_mfma_f32_16x16x32_bf16 v[0:3], a[204:207], a[140:143], v[0:3]
    v_exp_f32_e64 v130, v34
    v_mfma_f32_16x16x32_bf16 v[8:11], a[192:195], a[144:147], v[72:75]
    ds_read_b128 a[244:247], v241 offset:21504
    buffer_store_dwordx4 v[192:195], v255, s[48:51], s45 offen offset:0 sc1
    v_mfma_f32_16x16x32_bf16 v[8:11], a[196:199], a[148:151], v[8:11]
    s_cmp_lt_u32 s44, s47
    s_cselect_b32 s101, s44, s43
    v_mfma_f32_16x16x32_bf16 v[8:11], a[200:203], a[152:155], v[8:11]
    buffer_load_dwordx4 v[192:195], v253, s[52:55], s101 offen
    v_cvt_pk_bf16_f32 v112, v128, v129
    v_mfma_f32_16x16x32_bf16 v[8:11], a[204:207], a[156:159], v[8:11]
    v_exp_f32_e64 v131, v35
    v_mfma_f32_16x16x32_bf16 v[16:19], a[192:195], a[160:163], v[80:83]
    ds_read_b128 a[248:251], v241 offset:22528
    v_cvt_pk_bf16_f32 v113, v130, v131
    v_mfma_f32_16x16x32_bf16 v[16:19], a[196:199], a[164:167], v[16:19]
    v_exp_f32_e64 v132, v36
    v_mfma_f32_16x16x32_bf16 v[16:19], a[200:203], a[168:171], v[16:19]
    v_exp_f32_e64 v133, v37
    v_mfma_f32_16x16x32_bf16 v[16:19], a[204:207], a[172:175], v[16:19]
    v_exp_f32_e64 v134, v38
    v_mfma_f32_16x16x32_bf16 v[24:27], a[192:195], a[176:179], v[88:91]
    ds_read_b128 a[252:255], v241 offset:23552
    s_mov_b32 m0, s34
    v_mfma_f32_16x16x32_bf16 v[24:27], a[196:199], a[180:183], v[24:27]
    s_add_u32 s41, s42, 17664
    v_cvt_pk_bf16_f32 v114, v132, v133
    v_mfma_f32_16x16x32_bf16 v[24:27], a[200:203], a[184:187], v[24:27]
    v_exp_f32 v135, v39
    v_mfma_f32_16x16x32_bf16 v[24:27], a[204:207], a[188:191], v[24:27]
    v_or3_b32 v208, v112, v113, v114
    s_waitcnt lgkmcnt(8)
    v_mfma_f32_16x16x32_bf16 v[4:7], a[208:211], a[128:131], v[68:71]
    ds_read_b128 a[192:195], v241 offset:8192
    v_cvt_pk_bf16_f32 v115, v134, v135
    v_mfma_f32_16x16x32_bf16 v[4:7], a[212:215], a[132:135], v[4:7]
    v_exp_f32 v136, v40
    v_mfma_f32_16x16x32_bf16 v[4:7], a[216:219], a[136:139], v[4:7]
    v_exp_f32_e64 v137, v41
    v_mfma_f32_16x16x32_bf16 v[4:7], a[220:223], a[140:143], v[4:7]
    v_exp_f32_e64 v138, v42
    v_mfma_f32_16x16x32_bf16 v[12:15], a[208:211], a[144:147], v[76:79]
    ds_read_b128 a[196:199], v241 offset:10240
    buffer_load_dwordx4 v242, s[16:19], s41 offen offset:0 sc1 lds
    v_mfma_f32_16x16x32_bf16 v[12:15], a[212:215], a[148:151], v[12:15]
    v_exp_f32_e64 v139, v43
    v_mfma_f32_16x16x32_bf16 v[12:15], a[216:219], a[152:155], v[12:15]
    v_exp_f32_e64 v140, v44
    v_mfma_f32_16x16x32_bf16 v[12:15], a[220:223], a[156:159], v[12:15]
    v_exp_f32_e64 v141, v45
    v_mfma_f32_16x16x32_bf16 v[20:23], a[208:211], a[160:163], v[84:87]
    ds_read_b128 a[200:203], v241 offset:12288
    v_cvt_pk_bf16_f32 v116, v136, v137
    v_mfma_f32_16x16x32_bf16 v[20:23], a[212:215], a[164:167], v[20:23]
    v_exp_f32_e64 v142, v46
    v_mfma_f32_16x16x32_bf16 v[20:23], a[216:219], a[168:171], v[20:23]
    v_exp_f32_e64 v143, v47
    v_mfma_f32_16x16x32_bf16 v[20:23], a[220:223], a[172:175], v[20:23]
    v_or3_b32 v208, v208, v115, v116
    v_cvt_pk_bf16_f32 v117, v138, v139
    v_mfma_f32_16x16x32_bf16 v[28:31], a[208:211], a[176:179], v[92:95]
    ds_read_b128 a[204:207], v241 offset:14336
    buffer_load_dwordx4 v242, s[16:19], s41 offen offset:1024 sc1 lds
    v_mfma_f32_16x16x32_bf16 v[28:31], a[212:215], a[180:183], v[28:31]
    v_exp_f32_e64 v128, v48
    v_mfma_f32_16x16x32_bf16 v[28:31], a[216:219], a[184:187], v[28:31]
    v_exp_f32_e64 v129, v49
    v_mfma_f32_16x16x32_bf16 v[28:31], a[220:223], a[188:191], v[28:31]
    v_cvt_pk_bf16_f32 v118, v140, v141
    s_waitcnt lgkmcnt(8)
    v_mfma_f32_16x16x32_bf16 a[0:3], a[224:227], v[96:99], a[0:3]
    ds_read_b128 a[208:211], v241 offset:9216
    v_or3_b32 v208, v208, v117, v118
    v_mfma_f32_16x16x32_bf16 a[32:35], a[224:227], v[100:103], a[32:35]
    v_exp_f32 v130, v50
    v_mfma_f32_16x16x32_bf16 a[64:67], a[224:227], v[104:107], a[64:67]
    v_exp_f32_e64 v131, v51
    v_mfma_f32_16x16x32_bf16 a[96:99], a[224:227], v[108:111], a[96:99]
    v_exp_f32_e64 v132, v52
    v_mfma_f32_16x16x32_bf16 a[4:7], a[228:231], v[96:99], a[4:7]
    ds_read_b128 a[212:215], v241 offset:11264
    v_cvt_pk_bf16_f32 v119, v142, v143
    v_mfma_f32_16x16x32_bf16 a[36:39], a[228:231], v[100:103], a[36:39]
    buffer_load_dwordx4 v242, s[16:19], s41 offen offset:2048 sc1 lds
    v_cvt_pk_bf16_f32 v120, v128, v129
    v_mfma_f32_16x16x32_bf16 a[68:71], a[228:231], v[104:107], a[68:71]
    v_exp_f32_e64 v133, v53
    v_mfma_f32_16x16x32_bf16 a[100:103], a[228:231], v[108:111], a[100:103]
    v_exp_f32_e64 v134, v54
    v_mfma_f32_16x16x32_bf16 a[8:11], a[232:235], v[96:99], a[8:11]
    ds_read_b128 a[216:219], v241 offset:13312
    v_or3_b32 v208, v208, v119, v120
    v_mfma_f32_16x16x32_bf16 a[40:43], a[232:235], v[100:103], a[40:43]
    v_exp_f32_e64 v135, v55
    v_mfma_f32_16x16x32_bf16 a[72:75], a[232:235], v[104:107], a[72:75]
    v_exp_f32_e64 v136, v56
    v_mfma_f32_16x16x32_bf16 a[104:107], a[232:235], v[108:111], a[104:107]
    v_exp_f32_e64 v137, v57
    v_mfma_f32_16x16x32_bf16 a[12:15], a[236:239], v[96:99], a[12:15]
    ds_read_b128 a[220:223], v241 offset:15360
    v_cvt_pk_bf16_f32 v121, v130, v131
    v_mfma_f32_16x16x32_bf16 a[44:47], a[236:239], v[100:103], a[44:47]
    v_cvt_pk_bf16_f32 v122, v132, v133
    v_or3_b32 v208, v208, v121, v122
    v_mfma_f32_16x16x32_bf16 a[76:79], a[236:239], v[104:107], a[76:79]
    buffer_load_dwordx4 v242, s[16:19], s41 offen offset:3072 sc1 lds
    v_cvt_pk_bf16_f32 v123, v134, v135
    v_mfma_f32_16x16x32_bf16 a[108:111], a[236:239], v[108:111], a[108:111]
    v_cvt_pk_bf16_f32 v124, v136, v137
    s_waitcnt lgkmcnt(8)
    v_mfma_f32_16x16x32_bf16 a[16:19], a[240:243], v[96:99], a[16:19]
    ds_read_b128 a[224:227], v241 offset:24576
    v_or3_b32 v208, v208, v123, v124
    v_mfma_f32_16x16x32_bf16 a[48:51], a[240:243], v[100:103], a[48:51]
    v_exp_f32 v138, v58
    v_mfma_f32_16x16x32_bf16 a[80:83], a[240:243], v[104:107], a[80:83]
    v_exp_f32_e64 v139, v59
    v_mfma_f32_16x16x32_bf16 a[112:115], a[240:243], v[108:111], a[112:115]
    v_exp_f32_e64 v140, v60
    v_mfma_f32_16x16x32_bf16 a[20:23], a[244:247], v[96:99], a[20:23]
    ds_read_b128 a[228:231], v241 offset:25600
    v_cvt_pk_bf16_f32 v125, v138, v139
    v_mfma_f32_16x16x32_bf16 a[52:55], a[244:247], v[100:103], a[52:55]
    v_exp_f32_e64 v141, v61
    v_mfma_f32_16x16x32_bf16 a[84:87], a[244:247], v[104:107], a[84:87]
    v_exp_f32_e64 v142, v62
    v_mfma_f32_16x16x32_bf16 a[116:119], a[244:247], v[108:111], a[116:119]
    s_add_u32 s35, s35, 32768
    v_cvt_pk_bf16_f32 v126, v140, v141
    v_mfma_f32_16x16x32_bf16 a[24:27], a[248:251], v[96:99], a[24:27]
    ds_read_b128 a[232:235], v241 offset:26624
    v_or3_b32 v208, v208, v125, v126
    v_mfma_f32_16x16x32_bf16 a[56:59], a[248:251], v[100:103], a[56:59]
    s_cmp_ge_u32 s35, 163840
    s_cselect_b32 s35, 0, s35
    v_mfma_f32_16x16x32_bf16 a[88:91], a[248:251], v[104:107], a[88:91]
    v_exp_f32 v143, v63
    v_mfma_f32_16x16x32_bf16 a[120:123], a[248:251], v[108:111], a[120:123]
    v_cvt_pk_bf16_f32 v127, v142, v143
    v_or_b32_e64 v208, v208, v127
    v_mfma_f32_16x16x32_bf16 a[28:31], a[252:255], v[96:99], a[28:31]
    ds_read_b128 a[236:239], v241 offset:27648
    v_and_b32_e64 v208, s38, v208
    v_mfma_f32_16x16x32_bf16 a[60:63], a[252:255], v[100:103], a[60:63]
    v_cmp_ne_u32_e64 vcc, 0, v208
    v_mfma_f32_16x16x32_bf16 a[92:95], a[252:255], v[104:107], a[92:95]
    v_mfma_f32_16x16x32_bf16 a[124:127], a[252:255], v[108:111], a[124:127]
    v_mfma_f32_16x16x32_bf16 v[144:147], v[204:207], v[96:99], v[144:147]
    v_mfma_f32_16x16x32_bf16 v[148:151], v[204:207], v[100:103], v[148:151]
    v_mfma_f32_16x16x32_bf16 v[152:155], v[204:207], v[104:107], v[152:155]
    v_mfma_f32_16x16x32_bf16 v[156:159], v[204:207], v[108:111], v[156:159]
    s_cbranch_vccnz kf_rare6
kf_rr5:
    s_sub_u32 s36, s36, 1
    s_cbranch_scc1 kf_fix11
kf_fixr12:
    s_waitcnt lgkmcnt(8)
    v_mfma_f32_16x16x32_bf16 v[32:35], a[192:195], a[128:131], v[64:67]
    ds_read_b128 a[240:243], v241 offset:28672
    s_waitcnt vmcnt(11)
    v_mfma_f32_16x16x32_bf16 v[32:35], a[196:199], a[132:135], v[32:35]
    v_exp_f32 v128, v0
    v_mfma_f32_16x16x32_bf16 v[32:35], a[200:203], a[136:139], v[32:35]
    v_exp_f32_e64 v129, v1
    v_mfma_f32_16x16x32_bf16 v[32:35], a[204:207], a[140:143], v[32:35]
    v_exp_f32_e64 v130, v2
    v_mfma_f32_16x16x32_bf16 v[40:43], a[192:195], a[144:147], v[72:75]
    ds_read_b128 a[244:247], v241 offset:29696
    buffer_store_dwordx4 v[196:199], v255, s[48:51], s45 offen offset:256 sc1
    v_mfma_f32_16x16x32_bf16 v[40:43], a[196:199], a[148:151], v[40:43]
    s_add_u32 s101, s101, 57344
    buffer_load_dwordx4 v[196:199], v253, s[52:55], s101 offen
    v_mfma_f32_16x16x32_bf16 v[40:43], a[200:203], a[152:155], v[40:43]
    v_exp_f32_e64 v131, v3
    v_mfma_f32_16x16x32_bf16 v[40:43], a[204:207], a[156:159], v[40:43]
    v_exp_f32_e64 v132, v4
    v_mfma_f32_16x16x32_bf16 v[48:51], a[192:195], a[160:163], v[80:83]
    ds_read_b128 a[248:251], v241 offset:30720
    v_cvt_pk_bf16_f32 v96, v128, v129
    v_mfma_f32_16x16x32_bf16 v[48:51], a[196:199], a[164:167], v[48:51]
    s_cmp_lt_u32 s44, s47
    s_cselect_b32 s45, s46, s43
    v_mfma_f32_16x16x32_bf16 v[48:51], a[200:203], a[168:171], v[48:51]
    v_exp_f32_e64 v133, v5
    v_mfma_f32_16x16x32_bf16 v[48:51], a[204:207], a[172:175], v[48:51]
    v_exp_f32_e64 v134, v6
    v_mfma_f32_16x16x32_bf16 v[56:59], a[192:195], a[176:179], v[88:91]
    ds_read_b128 a[252:255], v241 offset:31744
    s_add_u32 s44, s44, 128
    v_mfma_f32_16x16x32_bf16 v[56:59], a[196:199], a[180:183], v[56:59]
    s_add_u32 s46, s46, 262144
    v_cvt_pk_bf16_f32 v97, v130, v131
    v_mfma_f32_16x16x32_bf16 v[56:59], a[200:203], a[184:187], v[56:59]
    v_exp_f32_e64 v135, v7
    v_mfma_f32_16x16x32_bf16 v[56:59], a[204:207], a[188:191], v[56:59]
    v_cvt_pk_bf16_f32 v98, v132, v133
    s_waitcnt lgkmcnt(8)
    v_mfma_f32_16x16x32_bf16 v[36:39], a[208:211], a[128:131], v[68:71]
    s_waitcnt vmcnt(16)
    s_barrier
    v_add_u32 v241, s35, v240
    ds_read_b128 a[192:195], v241 offset:0
    v_mfma_f32_16x16x32_bf16 v[36:39], a[212:215], a[132:135], v[36:39]
    v_exp_f32_e64 v136, v8
    v_mfma_f32_16x16x32_bf16 v[36:39], a[216:219], a[136:139], v[36:39]
    v_exp_f32_e64 v137, v9
    v_mfma_f32_16x16x32_bf16 v[36:39], a[220:223], a[140:143], v[36:39]
    v_exp_f32_e64 v138, v10
    v_mfma_f32_16x16x32_bf16 v[44:47], a[208:211], a[144:147], v[76:79]
    ds_read_b128 a[196:199], v241 offset:2048
    s_add_u32 m0, s34, 16384
    v_mfma_f32_16x16x32_bf16 v[44:47], a[212:215], a[148:151], v[44:47]
    s_add_u32 s34, s34, 32768
    v_or3_b32 v208, v96, v97, v98
    v_mfma_f32_16x16x32_bf16 v[44:47], a[216:219], a[152:155], v[44:47]
    s_cmp_ge_u32 s34, 163840
    s_cselect_b32 s34, s37, s34
    v_mfma_f32_16x16x32_bf16 v[44:47], a[220:223], a[156:159], v[44:47]
    v_exp_f32 v139, v11
    v_mfma_f32_16x16x32_bf16 v[52:55], a[208:211], a[160:163], v[84:87]
    ds_read_b128 a[200:203], v241 offset:4096
    v_cvt_pk_bf16_f32 v99, v134, v135
    v_mfma_f32_16x16x32_bf16 v[52:55], a[212:215], a[164:167], v[52:55]
    v_exp_f32_e64 v140, v12
    v_mfma_f32_16x16x32_bf16 v[52:55], a[216:219], a[168:171], v[52:55]
    v_exp_f32_e64 v141, v13
    v_mfma_f32_16x16x32_bf16 v[52:55], a[220:223], a[172:175], v[52:55]
    v_cvt_pk_bf16_f32 v100, v136, v137
    buffer_load_dwordx4 v242, s[16:19], s42 offen offset:0 sc1 lds
    v_mfma_f32_16x16x32_bf16 v[60:63], a[208:211], a[176:179], v[92:95]
    ds_read_b128 a[204:207], v241 offset:6144
    v_or3_b32 v208, v208, v99, v100
    v_mfma_f32_16x16x32_bf16 v[60:63], a[212:215], a[180:183], v[60:63]
    v_exp_f32_e64 v142, v14
    v_mfma_f32_16x16x32_bf16 v[60:63], a[216:219], a[184:187], v[60:63]
    v_exp_f32_e64 v143, v15
    v_mfma_f32_16x16x32_bf16 v[60:63], a[220:223], a[188:191], v[60:63]
    v_cvt_pk_bf16_f32 v101, v138, v139
    s_waitcnt lgkmcnt(8)
    v_mfma_f32_16x16x32_bf16 a[0:3], a[224:227], v[112:115], a[0:3]
    ds_read_b128 a[208:211], v241 offset:1024
    v_cvt_pk_bf16_f32 v102, v140, v141
    v_mfma_f32_16x16x32_bf16 a[32:35], a[224:227], v[116:119], a[32:35]
    v_exp_f32 v128, v16
    v_mfma_f32_16x16x32_bf16 a[64:67], a[224:227], v[120:123], a[64:67]
    v_exp_f32_e64 v129, v17
    v_mfma_f32_16x16x32_bf16 a[96:99], a[224:227], v[124:127], a[96:99]
    v_exp_f32_e64 v130, v18
    v_mfma_f32_16x16x32_bf16 a[4:7], a[228:231], v[112:115], a[4:7]
    ds_read_b128 a[212:215], v241 offset:3072
    buffer_load_dwordx4 v242, s[16:19], s42 offen offset:1024 sc1 lds
    v_mfma_f32_16x16x32_bf16 a[36:39], a[228:231], v[116:119], a[36:39]
    v_exp_f32_e64 v131, v19
    v_mfma_f32_16x16x32_bf16 a[68:71], a[228:231], v[120:123], a[68:71]
    v_or3_b32 v208, v208, v101, v102
    v_cvt_pk_bf16_f32 v103, v142, v143
    v_mfma_f32_16x16x32_bf16 a[100:103], a[228:231], v[124:127], a[100:103]
    v_exp_f32_e64 v132, v20
    v_mfma_f32_16x16x32_bf16 a[8:11], a[232:235], v[112:115], a[8:11]
    ds_read_b128 a[216:219], v241 offset:5120
    v_cvt_pk_bf16_f32 v104, v128, v129
    v_mfma_f32_16x16x32_bf16 a[40:43], a[232:235], v[116:119], a[40:43]
    v_exp_f32_e64 v133, v21
    v_mfma_f32_16x16x32_bf16 a[72:75], a[232:235], v[120:123], a[72:75]
    v_exp_f32_e64 v134, v22
    v_mfma_f32_16x16x32_bf16 a[104:107], a[232:235], v[124:127], a[104:107]
    v_exp_f32_e64 v135, v23
    v_mfma_f32_16x16x32_bf16 a[12:15], a[236:239], v[112:115], a[12:15]
    ds_read_b128 a[220:223], v241 offset:7168
    buffer_load_dwordx4 v242, s[16:19], s42 offen offset:2048 sc1 lds
    v_mfma_f32_16x16x32_bf16 a[44:47], a[236:239], v[116:119], a[44:47]
    v_or3_b32 v208, v208, v103, v104
    v_cvt_pk_bf16_f32 v105, v130, v131
    v_mfma_f32_16x16x32_bf16 a[76:79], a[236:239], v[120:123], a[76:79]
    v_exp_f32_e64 v136, v24
    v_mfma_f32_16x16x32_bf16 a[108:111], a[236:239], v[124:127], a[108:111]
    v_cvt_pk_bf16_f32 v106, v132, v133
    s_waitcnt lgkmcnt(8)
    v_mfma_f32_16x16x32_bf16 a[16:19], a[240:243], v[112:115], a[16:19]
    ds_read_b128 a[224:227], v241 offset:16384
    v_or3_b32 v208, v208, v105, v106
    v_mfma_f32_16x16x32_bf16 a[48:51], a[240:243], v[116:119], a[48:51]
    v_exp_f32 v137, v25
    v_mfma_f32_16x16x32_bf16 a[80:83], a[240:243], v[120:123], a[80:83]
    v_exp_f32_e64 v138, v26
    v_mfma_f32_16x16x32_bf16 a[112:115], a[240:243], v[124:127], a[112:115]
    v_exp_f32_e64 v139, v27
    v_mfma_f32_16x16x32_bf16 a[20:23], a[244:247], v[112:115], a[20:23]
    ds_read_b128 a[228:231], v241 offset:17408
    buffer_load_dwordx4 v242, s[16:19], s42 offen offset:3072 sc1 lds
    v_mfma_f32_16x16x32_bf16 a[52:55], a[244:247], v[116:119], a[52:55]
    s_add_u32 s42, s42, 34048
    v_cvt_pk_bf16_f32 v107, v134, v135
    v_mfma_f32_16x16x32_bf16 a[84:87], a[244:247], v[120:123], a[84:87]
    v_exp_f32_e64 v140, v28
    v_mfma_f32_16x16x32_bf16 a[116:119], a[244:247], v[124:127], a[116:119]
    v_exp_f32_e64 v141, v29
    v_mfma_f32_16x16x32_bf16 a[24:27], a[248:251], v[112:115], a[24:27]
    ds_read_b128 a[232:235], v241 offset:18432
    v_cvt_pk_bf16_f32 v108, v136, v137
    v_mfma_f32_16x16x32_bf16 a[56:59], a[248:251], v[116:119], a[56:59]
    v_exp_f32_e64 v142, v30
    v_mfma_f32_16x16x32_bf16 a[88:91], a[248:251], v[120:123], a[88:91]
    v_exp_f32_e64 v143, v31
    v_mfma_f32_16x16x32_bf16 a[120:123], a[248:251], v[124:127], a[120:123]
    buffer_load_dword v252, v251, s[60:63], s100 offen
    s_add_u32 s100, s100, 2048
    v_mfma_f32_16x16x32_bf16 a[28:31], a[252:255], v[112:115], a[28:31]
    ds_read_b128 a[236:239], v241 offset:19456
    v_or3_b32 v208, v208, v107, v108
    v_mfma_f32_16x16x32_bf16 a[60:63], a[252:255], v[116:119], a[60:63]
    v_cvt_pk_bf16_f32 v109, v138, v139
    v_cvt_pk_bf16_f32 v110, v140, v141
    v_mfma_f32_16x16x32_bf16 a[92:95], a[252:255], v[120:123], a[92:95]
    v_or3_b32 v208, v208, v109, v110
    v_cvt_pk_bf16_f32 v111, v142, v143
    v_mfma_f32_16x16x32_bf16 a[124:127], a[252:255], v[124:127], a[124:127]
    v_or_b32 v208, v208, v111
    v_and_b32 v208, s38, v208
    v_mfma_f32_16x16x32_bf16 v[144:147], v[204:207], v[112:115], v[144:147]
    v_cmp_ne_u32_e64 vcc, 0, v208
    v_mfma_f32_16x16x32_bf16 v[148:151], v[204:207], v[116:119], v[148:151]
    v_mfma_f32_16x16x32_bf16 v[152:155], v[204:207], v[120:123], v[152:155]
    v_mfma_f32_16x16x32_bf16 v[156:159], v[204:207], v[124:127], v[156:159]
    s_cbranch_vccnz kf_rare10
kf_rr9:
ka_p1_e:
    s_sub_u32 s26, s26, 1
    s_cbranch_scc0 ka_p1
    s_branch ka_p1_x
kf_fix7:
    s_mov_b32 s24, 0
    s_branch kf_fix7c
kf_fix11:
    s_mov_b32 s24, 1
kf_fix7c:
    s_cmp_eq_u32 s33, 0
    s_cbranch_scc0 kf_fix7f
    s_mov_b32 s36, 0
    s_mov_b32 s33, 1
    v_add_f32 v64, v224, v200
    v_add_f32 v65, v224, v201
    v_add_f32 v66, v224, v202
    v_add_f32 v67, v224, v203
    v_add_f32 v68, v224, v209
    v_add_f32 v69, v224, v210
    v_add_f32 v70, v224, v211
    v_add_f32 v71, v224, v212
    v_add_f32 v72, v225, v213
    v_add_f32 v73, v225, v214
    v_add_f32 v74, v225, v215
    v_add_f32 v75, v225, v216
    v_add_f32 v76, v225, v217
    v_add_f32 v77, v225, v218
    v_add_f32 v78, v225, v219
    v_add_f32 v79, v225, v220
    s_cmp_eq_u32 s24, 0
    s_cbranch_scc1 kf_fixr8
    s_branch kf_fixr12
kf_fix7f:
    s_mov_b32 s36, 0x1000
    v_mov_b32 v64, 0xf1800000
    v_mov_b32 v65, v64
    v_mov_b32 v66, v64
    v_mov_b32 v67, v64
    v_mov_b32 v68, v64
    v_mov_b32 v69, v64
    v_mov_b32 v70, v64
    v_mov_b32 v71, v64
    v_mov_b32 v72, v64
    v_mov_b32 v73, v64
    v_mov_b32 v74, v64
    v_mov_b32 v75, v64
    v_mov_b32 v76, v64
    v_mov_b32 v77, v64
    v_mov_b32 v78, v64
    v_mov_b32 v79, v64
    s_cmp_eq_u32 s24, 0
    s_cbranch_scc1 kf_fixr8
    s_branch kf_fixr12
kf_fix15:
    s_mov_b32 s24, 0
    s_branch kf_fix15c
kf_fix19:
    s_mov_b32 s24, 1
kf_fix15c:
    s_cmp_eq_u32 s33, 0
    s_cbranch_scc0 kf_fix15f
    s_mov_b32 s36, 0
    s_mov_b32 s33, 1
    v_add_f32 v80, v226, v200
    v_add_f32 v81, v226, v201
    v_add_f32 v82, v226, v202
    v_add_f32 v83, v226, v203
    v_add_f32 v84, v226, v209
    v_add_f32 v85, v226, v210
    v_add_f32 v86, v226, v211
    v_add_f32 v87, v226, v212
    v_add_f32 v88, v227, v213
    v_add_f32 v89, v227, v214
    v_add_f32 v90, v227, v215
    v_add_f32 v91, v227, v216
    v_add_f32 v92, v227, v217
    v_add_f32 v93, v227, v218
    v_add_f32 v94, v227, v219
    v_add_f32 v95, v227, v220
    s_cmp_eq_u32 s24, 0
    s_cbranch_scc1 kf_fixr16
    s_branch kf_fixr20
kf_fix15f:
    s_mov_b32 s36, 0x1000
    v_mov_b32 v80, 0xf1800000
    v_mov_b32 v81, v80
    v_mov_b32 v82, v80
    v_mov_b32 v83, v80
    v_mov_b32 v84, v80
    v_mov_b32 v85, v80
    v_mov_b32 v86, v80
    v_mov_b32 v87, v80
    v_mov_b32 v88, v80
    v_mov_b32 v89, v80
    v_mov_b32 v90, v80
    v_mov_b32 v91, v80
    v_mov_b32 v92, v80
    v_mov_b32 v93, v80
    v_mov_b32 v94, v80
    v_mov_b32_e64 v95, v80
    s_cmp_eq_u32 s24, 0
    s_cbranch_scc1 kf_fixr16
    s_branch kf_fixr20
ka_p1_x:
    s_lshl2_add_u32 s36, s5, s6
    s_lshl1_add_u32 s36, s31, s36
    s_sub_u32 s36, 61, s36
    s_mov_b32 s33, 0
    s_sub_u32 s36, s36, 1
    s_cbranch_scc1 kf_fix15
kf_fixr16:
    s_waitcnt lgkmcnt(8)
    v_mfma_f32_16x16x32_bf16 v[16:19], a[192:195], a[160:163], v[80:83]
    ds_read_b128 a[240:243], v241 offset:20480
    ds_read_b128 a[244:247], v241 offset:21504
    v_mfma_f32_16x16x32_bf16 v[16:19], a[196:199], a[164:167], v[16:19]
    s_waitcnt vmcnt(11)
    v_exp_f32 v128, v32
    v_mfma_f32_16x16x32_bf16 v[16:19], a[200:203], a[168:171], v[16:19]
    v_exp_f32_e64 v129, v33
    v_mfma_f32_16x16x32_bf16 v[16:19], a[204:207], a[172:175], v[16:19]
    buffer_store_dwordx4 v[192:195], v255, s[48:51], s45 offen offset:0 sc1
    v_exp_f32_e64 v130, v34
    v_mfma_f32_16x16x32_bf16 v[24:27], a[192:195], a[176:179], v[88:91]
    ds_read_b128 a[248:251], v241 offset:22528
    ds_read_b128 a[252:255], v241 offset:23552
    v_mfma_f32_16x16x32_bf16 v[24:27], a[196:199], a[180:183], v[24:27]
    v_exp_f32_e64 v131, v35
    v_mfma_f32_16x16x32_bf16 v[24:27], a[200:203], a[184:187], v[24:27]
    v_exp_f32_e64 v132, v36
    v_cvt_pk_bf16_f32 v112, v128, v129
    v_mfma_f32_16x16x32_bf16 v[24:27], a[204:207], a[188:191], v[24:27]
    s_mov_b32 m0, s34
    s_waitcnt lgkmcnt(8)
    v_mfma_f32_16x16x32_bf16 v[20:23], a[208:211], a[160:163], v[84:87]
    ds_read_b128 a[192:195], v241 offset:8192
    ds_read_b128 a[196:199], v241 offset:10240
    v_mfma_f32_16x16x32_bf16 v[20:23], a[212:215], a[164:167], v[20:23]
    s_add_u32 s41, s42, 17664
    v_exp_f32_e64 v133, v37
    v_mfma_f32_16x16x32_bf16 v[20:23], a[216:219], a[168:171], v[20:23]
    v_exp_f32_e64 v134, v38
    v_mfma_f32_16x16x32_bf16 v[20:23], a[220:223], a[172:175], v[20:23]
    v_exp_f32_e64 v135, v39
    v_mfma_f32_16x16x32_bf16 v[28:31], a[208:211], a[176:179], v[92:95]
    ds_read_b128 a[200:203], v241 offset:12288
    ds_read_b128 a[204:207], v241 offset:14336
    v_cvt_pk_bf16_f32 v113, v130, v131
    v_mfma_f32_16x16x32_bf16 v[28:31], a[212:215], a[180:183], v[28:31]
    v_exp_f32_e64 v136, v40
    v_mfma_f32_16x16x32_bf16 v[28:31], a[216:219], a[184:187], v[28:31]
    v_exp_f32_e64 v137, v41
    v_mfma_f32_16x16x32_bf16 v[28:31], a[220:223], a[188:191], v[28:31]
    v_cvt_pk_bf16_f32 v114, v132, v133
    buffer_load_dwordx4 v242, s[16:19], s41 offen offset:0 sc1 lds
    s_waitcnt lgkmcnt(8)
    v_mfma_f32_16x16x32_bf16 a[0:3], a[224:227], v[96:99], a[0:3]
    ds_read_b128 a[208:211], v241 offset:9216
    v_or3_b32 v208, v112, v113, v114
    v_mfma_f32_16x16x32_bf16 a[32:35], a[224:227], v[100:103], a[32:35]
    v_exp_f32 v138, v42
    v_mfma_f32_16x16x32_bf16 a[64:67], a[224:227], v[104:107], a[64:67]
    v_exp_f32_e64 v139, v43
    v_cvt_pk_bf16_f32 v115, v134, v135
    v_mfma_f32_16x16x32_bf16 a[96:99], a[224:227], v[108:111], a[96:99]
    v_exp_f32_e64 v140, v44
    v_mfma_f32_16x16x32_bf16 a[4:7], a[228:231], v[96:99], a[4:7]
    ds_read_b128 a[212:215], v241 offset:11264
    v_cvt_pk_bf16_f32 v116, v136, v137
    v_mfma_f32_16x16x32_bf16 a[36:39], a[228:231], v[100:103], a[36:39]
    buffer_load_dwordx4 v242, s[16:19], s41 offen offset:1024 sc1 lds
    v_exp_f32_e64 v141, v45
    v_mfma_f32_16x16x32_bf16 a[68:71], a[228:231], v[104:107], a[68:71]
    v_exp_f32_e64 v142, v46
    v_mfma_f32_16x16x32_bf16 a[100:103], a[228:231], v[108:111], a[100:103]
    v_exp_f32_e64 v143, v47
    v_mfma_f32_16x16x32_bf16 a[8:11], a[232:235], v[96:99], a[8:11]
    ds_read_b128 a[216:219], v241 offset:13312
    v_or3_b32 v208, v208, v115, v116
    v_cvt_pk_bf16_f32 v117, v138, v139
    v_mfma_f32_16x16x32_bf16 a[40:43], a[232:235], v[100:103], a[40:43]
    v_exp_f32_e64 v128, v48
    v_mfma_f32_16x16x32_bf16 a[72:75], a[232:235], v[104:107], a[72:75]
    v_exp_f32_e64 v129, v49
    v_mfma_f32_16x16x32_bf16 a[104:107], a[232:235], v[108:111], a[104:107]
    v_cvt_pk_bf16_f32 v118, v140, v141
    v_exp_f32_e64 v130, v50
    v_mfma_f32_16x16x32_bf16 a[12:15], a[236:239], v[96:99], a[12:15]
    ds_read_b128 a[220:223], v241 offset:15360
    buffer_load_dwordx4 v242, s[16:19], s41 offen offset:2048 sc1 lds
    v_mfma_f32_16x16x32_bf16 a[44:47], a[236:239], v[100:103], a[44:47]
    v_exp_f32_e64 v131, v51
    v_or3_b32 v208, v208, v117, v118
    v_mfma_f32_16x16x32_bf16 a[76:79], a[236:239], v[104:107], a[76:79]
    v_exp_f32_e64 v132, v52
    v_mfma_f32_16x16x32_bf16 a[108:111], a[236:239], v[108:111], a[108:111]
    v_cvt_pk_bf16_f32 v119, v142, v143
    s_waitcnt lgkmcnt(8)
    v_mfma_f32_16x16x32_bf16 a[16:19], a[240:243], v[96:99], a[16:19]
    ds_read_b128 a[224:227], v241 offset:24576
    v_exp_f32 v133, v53
    v_mfma_f32_16x16x32_bf16 a[48:51], a[240:243], v[100:103], a[48:51]
    v_cvt_pk_bf16_f32 v120, v128, v129
    v_or3_b32 v208, v208, v119, v120
    v_mfma_f32_16x16x32_bf16 a[80:83], a[240:243], v[104:107], a[80:83]
    v_exp_f32_e64 v134, v54
    v_mfma_f32_16x16x32_bf16 a[112:115], a[240:243], v[108:111], a[112:115]
    buffer_load_dwordx4 v242, s[16:19], s41 offen offset:3072 sc1 lds
    v_exp_f32_e64 v135, v55
    v_mfma_f32_16x16x32_bf16 a[20:23], a[244:247], v[96:99], a[20:23]
    ds_read_b128 a[228:231], v241 offset:25600
    v_cvt_pk_bf16_f32 v121, v130, v131
    v_mfma_f32_16x16x32_bf16 a[52:55], a[244:247], v[100:103], a[52:55]
    v_exp_f32_e64 v136, v56
    v_mfma_f32_16x16x32_bf16 a[84:87], a[244:247], v[104:107], a[84:87]
    v_exp_f32_e64 v137, v57
    v_cvt_pk_bf16_f32 v122, v132, v133
    v_mfma_f32_16x16x32_bf16 a[116:119], a[244:247], v[108:111], a[116:119]
    v_exp_f32_e64 v138, v58
    v_mfma_f32_16x16x32_bf16 a[24:27], a[248:251], v[96:99], a[24:27]
    ds_read_b128 a[232:235], v241 offset:26624
    v_or3_b32 v208, v208, v121, v122
    v_mfma_f32_16x16x32_bf16 a[56:59], a[248:251], v[100:103], a[56:59]
    v_exp_f32_e64 v139, v59
    v_cvt_pk_bf16_f32 v123, v134, v135
    v_mfma_f32_16x16x32_bf16 a[88:91], a[248:251], v[104:107], a[88:91]
    v_exp_f32_e64 v140, v60
    v_mfma_f32_16x16x32_bf16 a[120:123], a[248:251], v[108:111], a[120:123]
    v_exp_f32_e64 v141, v61
    v_mfma_f32_16x16x32_bf16 a[28:31], a[252:255], v[96:99], a[28:31]
    ds_read_b128 a[236:239], v241 offset:27648
    v_cvt_pk_bf16_f32 v124, v136, v137
    s_add_u32 s35, s35, 32768
    v_mfma_f32_16x16x32_bf16 a[60:63], a[252:255], v[100:103], a[60:63]
    s_cmp_ge_u32 s35, 163840
    s_cselect_b32 s35, 0, s35
    v_mfma_f32_16x16x32_bf16 a[92:95], a[252:255], v[104:107], a[92:95]
    v_exp_f32 v142, v62
    v_mfma_f32_16x16x32_bf16 a[124:127], a[252:255], v[108:111], a[124:127]
    v_exp_f32_e64 v143, v63
    v_or3_b32 v208, v208, v123, v124
    v_mfma_f32_16x16x32_bf16 v[144:147], v[204:207], v[96:99], v[144:147]
    v_cvt_pk_bf16_f32 v125, v138, v139
    v_cvt_pk_bf16_f32 v126, v140, v141
    v_mfma_f32_16x16x32_bf16 v[148:151], v[204:207], v[100:103], v[148:151]
    v_or3_b32 v208, v208, v125, v126
    v_cvt_pk_bf16_f32 v127, v142, v143
    v_mfma_f32_16x16x32_bf16 v[152:155], v[204:207], v[104:107], v[152:155]
    v_or_b32 v208, v208, v127
    v_and_b32 v208, s38, v208
    v_cmp_ne_u32_e64 vcc, 0, v208
    v_mfma_f32_16x16x32_bf16 v[156:159], v[204:207], v[108:111], v[156:159]
    s_cbranch_vccnz kf_rare14
kf_rr13:
    s_sub_u32 s36, s36, 1
    s_cbranch_scc1 kf_fix19
kf_fixr20:
    s_waitcnt lgkmcnt(8)
    v_mfma_f32_16x16x32_bf16 v[48:51], a[192:195], a[160:163], v[80:83]
    ds_read_b128 a[240:243], v241 offset:28672
    ds_read_b128 a[244:247], v241 offset:29696
    v_mfma_f32_16x16x32_bf16 v[48:51], a[196:199], a[164:167], v[48:51]
    v_exp_f32_e64 v128, v16
    v_mfma_f32_16x16x32_bf16 v[48:51], a[200:203], a[168:171], v[48:51]
    v_exp_f32_e64 v129, v17
    v_mfma_f32_16x16x32_bf16 v[48:51], a[204:207], a[172:175], v[48:51]
    s_waitcnt vmcnt(10)
    buffer_store_dwordx4 v[196:199], v255, s[48:51], s45 offen offset:256 sc1
    v_mfma_f32_16x16x32_bf16 v[56:59], a[192:195], a[176:179], v[88:91]
    ds_read_b128 a[248:251], v241 offset:30720
    ds_read_b128 a[252:255], v241 offset:31744
    v_mfma_f32_16x16x32_bf16 v[56:59], a[196:199], a[180:183], v[56:59]
    v_exp_f32 v130, v18
    v_mfma_f32_16x16x32_bf16 v[56:59], a[200:203], a[184:187], v[56:59]
    v_exp_f32_e64 v131, v19
    v_mfma_f32_16x16x32_bf16 v[56:59], a[204:207], a[188:191], v[56:59]
    v_cvt_pk_bf16_f32 v104, v128, v129
    s_waitcnt lgkmcnt(8)
    v_mfma_f32_16x16x32_bf16 v[52:55], a[208:211], a[160:163], v[84:87]
    s_waitcnt vmcnt(14)
    s_barrier
    v_add_u32 v241, s35, v240
    ds_read_b128 a[192:195], v241 offset:0
    v_mfma_f32_16x16x32_bf16 v[52:55], a[212:215], a[164:167], v[52:55]
    s_add_u32 m0, s34, 16384
    s_add_u32 s34, s34, 32768
    v_mfma_f32_16x16x32_bf16 v[52:55], a[216:219], a[168:171], v[52:55]
    ds_read_b128 a[196:199], v241 offset:2048
    v_cvt_pk_bf16_f32 v105, v130, v131
    v_mfma_f32_16x16x32_bf16 v[52:55], a[220:223], a[172:175], v[52:55]
    s_cmp_ge_u32 s34, 163840
    s_cselect_b32 s34, s37, s34
    v_mfma_f32_16x16x32_bf16 v[60:63], a[208:211], a[176:179], v[92:95]
    ds_read_b128 a[200:203], v241 offset:4096
    ds_read_b128 a[204:207], v241 offset:6144
    v_mfma_f32_16x16x32_bf16 v[60:63], a[212:215], a[180:183], v[60:63]
    v_exp_f32 v132, v20
    v_mfma_f32_16x16x32_bf16 v[60:63], a[216:219], a[184:187], v[60:63]
    v_exp_f32_e64 v133, v21
    v_mfma_f32_16x16x32_bf16 v[60:63], a[220:223], a[188:191], v[60:63]
    v_cvt_pk_bf16_f32 v106, v132, v133
    s_waitcnt lgkmcnt(8)
    v_mfma_f32_16x16x32_bf16 a[0:3], a[224:227], v[112:115], a[0:3]
    ds_read_b128 a[208:211], v241 offset:1024
    v_or3_b32 v208, v104, v105, v106
    v_mfma_f32_16x16x32_bf16 a[32:35], a[224:227], v[116:119], a[32:35]
    v_exp_f32 v134, v22
    v_mfma_f32_16x16x32_bf16 a[64:67], a[224:227], v[120:123], a[64:67]
    buffer_load_dwordx4 v242, s[16:19], s42 offen offset:0 sc1 lds
    v_mfma_f32_16x16x32_bf16 a[96:99], a[224:227], v[124:127], a[96:99]
    v_exp_f32_e64 v135, v23
    v_mfma_f32_16x16x32_bf16 a[4:7], a[228:231], v[112:115], a[4:7]
    ds_read_b128 a[212:215], v241 offset:3072
    v_cvt_pk_bf16_f32 v107, v134, v135
    v_mfma_f32_16x16x32_bf16 a[36:39], a[228:231], v[116:119], a[36:39]
    v_exp_f32_e64 v136, v24
    v_mfma_f32_16x16x32_bf16 a[68:71], a[228:231], v[120:123], a[68:71]
    v_exp_f32_e64 v137, v25
    v_mfma_f32_16x16x32_bf16 a[100:103], a[228:231], v[124:127], a[100:103]
    v_exp_f32_e64 v138, v26
    v_mfma_f32_16x16x32_bf16 a[8:11], a[232:235], v[112:115], a[8:11]
    ds_read_b128 a[216:219], v241 offset:5120
    v_cvt_pk_bf16_f32 v108, v136, v137
    v_mfma_f32_16x16x32_bf16 a[40:43], a[232:235], v[116:119], a[40:43]
    buffer_load_dwordx4 v242, s[16:19], s42 offen offset:1024 sc1 lds
    v_or3_b32 v208, v208, v107, v108
    v_mfma_f32_16x16x32_bf16 a[72:75], a[232:235], v[120:123], a[72:75]
    v_exp_f32_e64 v139, v27
    v_mfma_f32_16x16x32_bf16 a[104:107], a[232:235], v[124:127], a[104:107]
    v_exp_f32_e64 v140, v28
    v_mfma_f32_16x16x32_bf16 a[12:15], a[236:239], v[112:115], a[12:15]
    ds_read_b128 a[220:223], v241 offset:7168
    v_cvt_pk_bf16_f32 v109, v138, v139
    v_mfma_f32_16x16x32_bf16 a[44:47], a[236:239], v[116:119], a[44:47]
    v_exp_f32_e64 v141, v29
    v_mfma_f32_16x16x32_bf16 a[76:79], a[236:239], v[120:123], a[76:79]
    v_exp_f32_e64 v142, v30
    v_mfma_f32_16x16x32_bf16 a[108:111], a[236:239], v[124:127], a[108:111]
    v_cvt_pk_bf16_f32 v110, v140, v141
    s_waitcnt lgkmcnt(8)
    v_mfma_f32_16x16x32_bf16 a[16:19], a[240:243], v[112:115], a[16:19]
    ds_read_b128 a[224:227], v241 offset:16384
    v_or3_b32 v208, v208, v109, v110
    v_mfma_f32_16x16x32_bf16 a[48:51], a[240:243], v[116:119], a[48:51]
    buffer_load_dwordx4 v242, s[16:19], s42 offen offset:2048 sc1 lds
    v_mfma_f32_16x16x32_bf16 a[80:83], a[240:243], v[120:123], a[80:83]
    v_exp_f32 v143, v31
    v_mfma_f32_16x16x32_bf16 a[112:115], a[240:243], v[124:127], a[112:115]
    v_cvt_pk_bf16_f32 v111, v142, v143
    v_or_b32_e64 v208, v208, v111
    v_mfma_f32_16x16x32_bf16 a[20:23], a[244:247], v[112:115], a[20:23]
    ds_read_b128 a[228:231], v241 offset:17408
    v_and_b32_e64 v208, s38, v208
    v_mfma_f32_16x16x32_bf16 a[52:55], a[244:247], v[116:119], a[52:55]
    v_cmp_ne_u32_e64 vcc, 0, v208
    buffer_load_dwordx4 v242, s[16:19], s42 offen offset:3072 sc1 lds
    v_mfma_f32_16x16x32_bf16 a[84:87], a[244:247], v[120:123], a[84:87]
    s_add_u32 s42, s42, 34048
    v_mfma_f32_16x16x32_bf16 a[116:119], a[244:247], v[124:127], a[116:119]
    v_mfma_f32_16x16x32_bf16 a[24:27], a[248:251], v[112:115], a[24:27]
    ds_read_b128 a[232:235], v241 offset:18432
    v_mfma_f32_16x16x32_bf16 a[56:59], a[248:251], v[116:119], a[56:59]
    v_mfma_f32_16x16x32_bf16 a[88:91], a[248:251], v[120:123], a[88:91]
    v_mfma_f32_16x16x32_bf16 a[120:123], a[248:251], v[124:127], a[120:123]
    v_mfma_f32_16x16x32_bf16 a[28:31], a[252:255], v[112:115], a[28:31]
    ds_read_b128 a[236:239], v241 offset:19456
    v_mfma_f32_16x16x32_bf16 a[60:63], a[252:255], v[116:119], a[60:63]
    v_mfma_f32_16x16x32_bf16 a[92:95], a[252:255], v[120:123], a[92:95]
    v_mfma_f32_16x16x32_bf16 a[124:127], a[252:255], v[124:127], a[124:127]
    v_mfma_f32_16x16x32_bf16 v[144:147], v[204:207], v[112:115], v[144:147]
    v_mfma_f32_16x16x32_bf16 v[148:151], v[204:207], v[116:119], v[148:151]
    v_mfma_f32_16x16x32_bf16 v[152:155], v[204:207], v[120:123], v[152:155]
    v_mfma_f32_16x16x32_bf16 v[156:159], v[204:207], v[124:127], v[156:159]
    s_cbranch_vccnz kf_rare18
kf_rr17:
    s_nop 6
    v_rcp_f32 v230, v144
    v_rcp_f32 v231, v148
    v_accvgpr_read_b32 v160, a0
    v_accvgpr_read_b32 v161, a1
    v_accvgpr_read_b32 v162, a2
    v_accvgpr_read_b32 v163, a3
    v_accvgpr_read_b32 v164, a4
    v_accvgpr_read_b32 v165, a5
    v_accvgpr_read_b32 v166, a6
    v_accvgpr_read_b32 v167, a7
    v_mul_f32 v160, v160, v230
    v_mul_f32 v161, v161, v230
    v_mul_f32 v162, v162, v230
    v_mul_f32 v163, v163, v230
    v_mul_f32 v164, v164, v230
    v_mul_f32 v165, v165, v230
    v_mul_f32 v166, v166, v230
    v_mul_f32 v167, v167, v230
    v_cvt_pk_bf16_f32 v176, v160, v161
    v_cvt_pk_bf16_f32 v177, v162, v163
    v_cvt_pk_bf16_f32 v178, v164, v165
    v_cvt_pk_bf16_f32 v179, v166, v167
    buffer_store_dwordx4 v[176:179], v240, s[20:23], s39 offen offset:0 sc1
    v_accvgpr_read_b32 v168, a8
    v_accvgpr_read_b32 v169, a9
    v_accvgpr_read_b32 v170, a10
    v_accvgpr_read_b32 v171, a11
    v_accvgpr_read_b32 v172, a12
    v_accvgpr_read_b32 v173, a13
    v_accvgpr_read_b32 v174, a14
    v_accvgpr_read_b32 v175, a15
    v_mul_f32 v168, v168, v230
    v_mul_f32 v169, v169, v230
    v_mul_f32 v170, v170, v230
    v_mul_f32 v171, v171, v230
    v_mul_f32 v172, v172, v230
    v_mul_f32 v173, v173, v230
    v_mul_f32 v174, v174, v230
    v_mul_f32 v175, v175, v230
    v_cvt_pk_bf16_f32 v180, v168, v169
    v_cvt_pk_bf16_f32 v181, v170, v171
    v_cvt_pk_bf16_f32 v182, v172, v173
    v_cvt_pk_bf16_f32 v183, v174, v175
    buffer_store_dwordx4 v[180:183], v240, s[20:23], s39 offen offset:1024 sc1
    v_accvgpr_read_b32 v160, a16
    v_accvgpr_read_b32 v161, a17
    v_accvgpr_read_b32 v162, a18
    v_accvgpr_read_b32 v163, a19
    v_accvgpr_read_b32 v164, a20
    v_accvgpr_read_b32 v165, a21
    v_accvgpr_read_b32 v166, a22
    v_accvgpr_read_b32 v167, a23
    v_mul_f32 v160, v160, v230
    v_mul_f32 v161, v161, v230
    v_mul_f32 v162, v162, v230
    v_mul_f32 v163, v163, v230
    v_mul_f32 v164, v164, v230
    v_mul_f32 v165, v165, v230
    v_mul_f32 v166, v166, v230
    v_mul_f32 v167, v167, v230
    v_cvt_pk_bf16_f32 v184, v160, v161
    v_cvt_pk_bf16_f32 v185, v162, v163
    v_cvt_pk_bf16_f32 v186, v164, v165
    v_cvt_pk_bf16_f32 v187, v166, v167
    buffer_store_dwordx4 v[184:187], v240, s[20:23], s39 offen offset:2048 sc1
    v_accvgpr_read_b32 v168, a24
    v_accvgpr_read_b32 v169, a25
    v_accvgpr_read_b32 v170, a26
    v_accvgpr_read_b32 v171, a27
    v_accvgpr_read_b32 v172, a28
    v_accvgpr_read_b32 v173, a29
    v_accvgpr_read_b32 v174, a30
    v_accvgpr_read_b32 v175, a31
    v_mul_f32 v168, v168, v230
    v_mul_f32 v169, v169, v230
    v_mul_f32 v170, v170, v230
    v_mul_f32 v171, v171, v230
    v_mul_f32 v172, v172, v230
    v_mul_f32 v173, v173, v230
    v_mul_f32 v174, v174, v230
    v_mul_f32 v175, v175, v230
    v_cvt_pk_bf16_f32 v188, v168, v169
    v_cvt_pk_bf16_f32 v189, v170, v171
    v_cvt_pk_bf16_f32 v190, v172, v173
    v_cvt_pk_bf16_f32 v191, v174, v175
    buffer_store_dwordx4 v[188:191], v240, s[20:23], s39 offen offset:3072 sc1
    v_accvgpr_read_b32 v160, a32
    v_accvgpr_read_b32 v161, a33
    v_accvgpr_read_b32 v162, a34
    v_accvgpr_read_b32 v163, a35
    v_accvgpr_read_b32 v164, a36
    v_accvgpr_read_b32 v165, a37
    v_accvgpr_read_b32 v166, a38
    v_accvgpr_read_b32 v167, a39
    v_mul_f32 v160, v160, v231
    v_mul_f32 v161, v161, v231
    v_mul_f32 v162, v162, v231
    v_mul_f32 v163, v163, v231
    v_mul_f32 v164, v164, v231
    v_mul_f32 v165, v165, v231
    v_mul_f32 v166, v166, v231
    v_mul_f32 v167, v167, v231
    v_cvt_pk_bf16_f32 v176, v160, v161
    v_cvt_pk_bf16_f32 v177, v162, v163
    v_cvt_pk_bf16_f32 v178, v164, v165
    v_cvt_pk_bf16_f32 v179, v166, v167
    buffer_store_dwordx4 v[176:179], v244, s[20:23], s39 offen offset:0 sc1
    v_accvgpr_read_b32 v168, a40
    v_accvgpr_read_b32 v169, a41
    v_accvgpr_read_b32 v170, a42
    v_accvgpr_read_b32 v171, a43
    v_accvgpr_read_b32 v172, a44
    v_accvgpr_read_b32 v173, a45
    v_accvgpr_read_b32 v174, a46
    v_accvgpr_read_b32 v175, a47
    v_mul_f32 v168, v168, v231
    v_mul_f32 v169, v169, v231
    v_mul_f32 v170, v170, v231
    v_mul_f32 v171, v171, v231
    v_mul_f32 v172, v172, v231
    v_mul_f32 v173, v173, v231
    v_mul_f32 v174, v174, v231
    v_mul_f32 v175, v175, v231
    v_cvt_pk_bf16_f32 v180, v168, v169
    v_cvt_pk_bf16_f32 v181, v170, v171
    v_cvt_pk_bf16_f32 v182, v172, v173
    v_cvt_pk_bf16_f32 v183, v174, v175
    buffer_store_dwordx4 v[180:183], v244, s[20:23], s39 offen offset:1024 sc1
    v_accvgpr_read_b32 v160, a48
    v_accvgpr_read_b32 v161, a49
    v_accvgpr_read_b32 v162, a50
    v_accvgpr_read_b32 v163, a51
    v_accvgpr_read_b32 v164, a52
    v_accvgpr_read_b32 v165, a53
    v_accvgpr_read_b32 v166, a54
    v_accvgpr_read_b32 v167, a55
    v_mul_f32 v160, v160, v231
    v_mul_f32 v161, v161, v231
    v_mul_f32 v162, v162, v231
    v_mul_f32 v163, v163, v231
    v_mul_f32 v164, v164, v231
    v_mul_f32 v165, v165, v231
    v_mul_f32 v166, v166, v231
    v_mul_f32 v167, v167, v231
    v_cvt_pk_bf16_f32 v184, v160, v161
    v_cvt_pk_bf16_f32 v185, v162, v163
    v_cvt_pk_bf16_f32 v186, v164, v165
    v_cvt_pk_bf16_f32 v187, v166, v167
    buffer_store_dwordx4 v[184:187], v244, s[20:23], s39 offen offset:2048 sc1
    v_accvgpr_read_b32 v168, a56
    v_accvgpr_read_b32 v169, a57
    v_accvgpr_read_b32 v170, a58
    v_accvgpr_read_b32 v171, a59
    v_accvgpr_read_b32 v172, a60
    v_accvgpr_read_b32 v173, a61
    v_accvgpr_read_b32 v174, a62
    v_accvgpr_read_b32 v175, a63
    v_mul_f32 v168, v168, v231
    v_mul_f32 v169, v169, v231
    v_mul_f32 v170, v170, v231
    v_mul_f32 v171, v171, v231
    v_mul_f32 v172, v172, v231
    v_mul_f32 v173, v173, v231
    v_mul_f32 v174, v174, v231
    v_mul_f32 v175, v175, v231
    v_cvt_pk_bf16_f32 v188, v168, v169
    v_cvt_pk_bf16_f32 v189, v170, v171
    v_cvt_pk_bf16_f32 v190, v172, v173
    v_cvt_pk_bf16_f32 v191, v174, v175
    buffer_store_dwordx4 v[188:191], v244, s[20:23], s39 offen offset:3072 sc1
ka_noe0:
    s_lshl1_add_u32 s26, s5, s31
    s_lshl_b32 s26, s26, 1
    s_sub_u32 s26, 30, s26
    s_branch ka_p2_e
.p2align 5
ka_p2:
    s_sub_u32 s36, s36, 1
    s_cbranch_scc1 kf_fix23
kf_fixr24:
    s_waitcnt lgkmcnt(8)
    v_mfma_f32_16x16x32_bf16 v[16:19], a[192:195], a[160:163], v[80:83]
    ds_read_b128 a[240:243], v241 offset:20480
    ds_read_b128 a[244:247], v241 offset:21504
    v_mfma_f32_16x16x32_bf16 v[16:19], a[196:199], a[164:167], v[16:19]
    v_exp_f32 v128, v48
    v_mfma_f32_16x16x32_bf16 v[16:19], a[200:203], a[168:171], v[16:19]
    s_mov_b32 m0, s34
    v_exp_f32 v129, v49
    v_mfma_f32_16x16x32_bf16 v[16:19], a[204:207], a[172:175], v[16:19]
    v_exp_f32_e64 v130, v50
    v_mfma_f32_16x16x32_bf16 v[24:27], a[192:195], a[176:179], v[88:91]
    ds_read_b128 a[248:251], v241 offset:22528
    ds_read_b128 a[252:255], v241 offset:23552
    v_mfma_f32_16x16x32_bf16 v[24:27], a[196:199], a[180:183], v[24:27]
    s_add_u32 s41, s42, 17664
    v_cvt_pk_bf16_f32 v120, v128, v129
    v_mfma_f32_16x16x32_bf16 v[24:27], a[200:203], a[184:187], v[24:27]
    buffer_load_dwordx4 v242, s[16:19], s41 offen offset:0 sc1 lds
    v_exp_f32_e64 v131, v51
    v_mfma_f32_16x16x32_bf16 v[24:27], a[204:207], a[188:191], v[24:27]
    v_cvt_pk_bf16_f32 v121, v130, v131
    s_waitcnt lgkmcnt(8)
    v_mfma_f32_16x16x32_bf16 v[20:23], a[208:211], a[160:163], v[84:87]
    ds_read_b128 a[192:195], v241 offset:8192
    ds_read_b128 a[196:199], v241 offset:10240
    v_mfma_f32_16x16x32_bf16 v[20:23], a[212:215], a[164:167], v[20:23]
    v_exp_f32 v132, v52
    v_mfma_f32_16x16x32_bf16 v[20:23], a[216:219], a[168:171], v[20:23]
    v_exp_f32_e64 v133, v53
    buffer_load_dwordx4 v242, s[16:19], s41 offen offset:1024 sc1 lds
    v_mfma_f32_16x16x32_bf16 v[20:23], a[220:223], a[172:175], v[20:23]
    v_exp_f32_e64 v134, v54
    v_mfma_f32_16x16x32_bf16 v[28:31], a[208:211], a[176:179], v[92:95]
    ds_read_b128 a[200:203], v241 offset:12288
    ds_read_b128 a[204:207], v241 offset:14336
    v_mfma_f32_16x16x32_bf16 v[28:31], a[212:215], a[180:183], v[28:31]
    v_exp_f32_e64 v135, v55
    v_mfma_f32_16x16x32_bf16 v[28:31], a[216:219], a[184:187], v[28:31]
    v_exp_f32_e64 v136, v56
    v_cvt_pk_bf16_f32 v122, v132, v133
    v_mfma_f32_16x16x32_bf16 v[28:31], a[220:223], a[188:191], v[28:31]
    v_or3_b32 v208, v120, v121, v122
    s_waitcnt lgkmcnt(8)
    v_mfma_f32_16x16x32_bf16 a[64:67], a[224:227], v[104:107], a[64:67]
    ds_read_b128 a[208:211], v241 offset:9216
    ds_read_b128 a[212:215], v241 offset:11264
    v_mfma_f32_16x16x32_bf16 a[96:99], a[224:227], v[108:111], a[96:99]
    v_exp_f32 v137, v57
    v_mfma_f32_16x16x32_bf16 a[68:71], a[228:231], v[104:107], a[68:71]
    v_exp_f32_e64 v138, v58
    v_mfma_f32_16x16x32_bf16 a[100:103], a[228:231], v[108:111], a[100:103]
    buffer_load_dwordx4 v242, s[16:19], s41 offen offset:2048 sc1 lds
    v_exp_f32_e64 v139, v59
    v_mfma_f32_16x16x32_bf16 a[72:75], a[232:235], v[104:107], a[72:75]
    ds_read_b128 a[216:219], v241 offset:13312
    ds_read_b128 a[220:223], v241 offset:15360
    v_mfma_f32_16x16x32_bf16 a[104:107], a[232:235], v[108:111], a[104:107]
    v_exp_f32_e64 v140, v60
    v_mfma_f32_16x16x32_bf16 a[76:79], a[236:239], v[104:107], a[76:79]
    buffer_load_dwordx4 v242, s[16:19], s41 offen offset:3072 sc1 lds
    v_cvt_pk_bf16_f32 v123, v134, v135
    v_mfma_f32_16x16x32_bf16 a[108:111], a[236:239], v[108:111], a[108:111]
    v_exp_f32 v141, v61
    s_waitcnt lgkmcnt(8)
    v_mfma_f32_16x16x32_bf16 a[80:83], a[240:243], v[104:107], a[80:83]
    ds_read_b128 a[224:227], v241 offset:24576
    ds_read_b128 a[228:231], v241 offset:25600
    v_mfma_f32_16x16x32_bf16 a[112:115], a[240:243], v[108:111], a[112:115]
    v_cvt_pk_bf16_f32 v124, v136, v137
    v_or3_b32 v208, v208, v123, v124
    v_mfma_f32_16x16x32_bf16 a[84:87], a[244:247], v[104:107], a[84:87]
    v_exp_f32_e64 v142, v62
    v_mfma_f32_16x16x32_bf16 a[116:119], a[244:247], v[108:111], a[116:119]
    s_add_u32 s35, s35, 32768
    s_cmp_ge_u32 s35, 163840
    s_cselect_b32 s35, 0, s35
    v_mfma_f32_16x16x32_bf16 a[88:91], a[248:251], v[104:107], a[88:91]
    ds_read_b128 a[232:235], v241 offset:26624
    ds_read_b128 a[236:239], v241 offset:27648
    v_mfma_f32_16x16x32_bf16 a[120:123], a[248:251], v[108:111], a[120:123]
    v_exp_f32 v143, v63
    v_mfma_f32_16x16x32_bf16 a[92:95], a[252:255], v[104:107], a[92:95]
    v_cvt_pk_bf16_f32 v125, v138, v139
    v_cvt_pk_bf16_f32 v126, v140, v141
    v_mfma_f32_16x16x32_bf16 a[124:127], a[252:255], v[108:111], a[124:127]
    v_or3_b32 v208, v208, v125, v126
    v_cvt_pk_bf16_f32 v127, v142, v143
    v_or_b32_e64 v208, v208, v127
    v_mfma_f32_16x16x32_bf16 v[152:155], v[204:207], v[104:107], v[152:155]
    v_and_b32 v208, s38, v208
    v_cmp_ne_u32 vcc, 0, v208
    v_mfma_f32_16x16x32_bf16 v[156:159], v[204:207], v[108:111], v[156:159]
    s_cbranch_vccnz kf_rare22
kf_rr21:
    s_sub_u32 s36, s36, 1
    s_cbranch_scc1 kf_fix27
kf_fixr28:
    s_waitcnt lgkmcnt(8)
    v_mfma_f32_16x16x32_bf16 v[48:51], a[192:195], a[160:163], v[80:83]
    ds_read_b128 a[240:243], v241 offset:28672
    ds_read_b128 a[244:247], v241 offset:29696
    v_mfma_f32_16x16x32_bf16 v[48:51], a[196:199], a[164:167], v[48:51]
    s_add_u32 m0, s34, 16384
    v_exp_f32_e64 v128, v16
    v_mfma_f32_16x16x32_bf16 v[48:51], a[200:203], a[168:171], v[48:51]
    v_exp_f32_e64 v129, v17
    v_mfma_f32_16x16x32_bf16 v[48:51], a[204:207], a[172:175], v[48:51]
    v_exp_f32_e64 v130, v18
    v_mfma_f32_16x16x32_bf16 v[56:59], a[192:195], a[176:179], v[88:91]
    ds_read_b128 a[248:251], v241 offset:30720
    ds_read_b128 a[252:255], v241 offset:31744
    s_add_u32 s34, s34, 32768
    v_mfma_f32_16x16x32_bf16 v[56:59], a[196:199], a[180:183], v[56:59]
    s_cmp_ge_u32 s34, 163840
    s_cselect_b32 s34, s37, s34
    v_mfma_f32_16x16x32_bf16 v[56:59], a[200:203], a[184:187], v[56:59]
    v_exp_f32 v131, v19
    v_mfma_f32_16x16x32_bf16 v[56:59], a[204:207], a[188:191], v[56:59]
    v_exp_f32 v132, v20
    s_waitcnt lgkmcnt(8)
    v_mfma_f32_16x16x32_bf16 v[52:55], a[208:211], a[160:163], v[84:87]
    s_waitcnt vmcnt(12)
    s_barrier
    v_add_u32_e64 v241, s35, v240
    ds_read_b128 a[192:195], v241 offset:0
    v_mfma_f32_16x16x32_bf16 v[52:55], a[212:215], a[164:167], v[52:55]
    v_exp_f32_e64 v133, v21
    v_mfma_f32_16x16x32_bf16 v[52:55], a[216:219], a[168:171], v[52:55]
    ds_read_b128 a[196:199], v241 offset:2048
    buffer_load_dwordx4 v242, s[16:19], s42 offen offset:0 sc1 lds
    v_mfma_f32_16x16x32_bf16 v[52:55], a[220:223], a[172:175], v[52:55]
    v_exp_f32_e64 v134, v22
    v_cvt_pk_bf16_f32 v104, v128, v129
    v_mfma_f32_16x16x32_bf16 v[60:63], a[208:211], a[176:179], v[92:95]
    ds_read_b128 a[200:203], v241 offset:4096
    ds_read_b128 a[204:207], v241 offset:6144
    v_mfma_f32_16x16x32_bf16 v[60:63], a[212:215], a[180:183], v[60:63]
    v_exp_f32_e64 v135, v23
    v_mfma_f32_16x16x32_bf16 v[60:63], a[216:219], a[184:187], v[60:63]
    buffer_load_dwordx4 v242, s[16:19], s42 offen offset:1024 sc1 lds
    v_exp_f32_e64 v136, v24
    v_mfma_f32_16x16x32_bf16 v[60:63], a[220:223], a[188:191], v[60:63]
    v_cvt_pk_bf16_f32 v105, v130, v131
    s_waitcnt lgkmcnt(8)
    v_mfma_f32_16x16x32_bf16 a[64:67], a[224:227], v[120:123], a[64:67]
    ds_read_b128 a[208:211], v241 offset:1024
    ds_read_b128 a[212:215], v241 offset:3072
    v_mfma_f32_16x16x32_bf16 a[96:99], a[224:227], v[124:127], a[96:99]
    v_exp_f32 v137, v25
    v_mfma_f32_16x16x32_bf16 a[68:71], a[228:231], v[120:123], a[68:71]
    v_cvt_pk_bf16_f32 v106, v132, v133
    v_exp_f32_e64 v138, v26
    v_mfma_f32_16x16x32_bf16 a[100:103], a[228:231], v[124:127], a[100:103]
    v_exp_f32_e64 v139, v27
    v_mfma_f32_16x16x32_bf16 a[72:75], a[232:235], v[120:123], a[72:75]
    ds_read_b128 a[216:219], v241 offset:5120
    ds_read_b128 a[220:223], v241 offset:7168
    v_mfma_f32_16x16x32_bf16 a[104:107], a[232:235], v[124:127], a[104:107]
    buffer_load_dwordx4 v242, s[16:19], s42 offen offset:2048 sc1 lds
    v_or3_b32 v208, v104, v105, v106
    v_cvt_pk_bf16_f32 v107, v134, v135
    v_mfma_f32_16x16x32_bf16 a[76:79], a[236:239], v[120:123], a[76:79]
    v_exp_f32_e64 v140, v28
    v_mfma_f32_16x16x32_bf16 a[108:111], a[236:239], v[124:127], a[108:111]
    v_cvt_pk_bf16_f32 v108, v136, v137
    s_waitcnt lgkmcnt(8)
    v_mfma_f32_16x16x32_bf16 a[80:83], a[240:243], v[120:123], a[80:83]
    ds_read_b128 a[224:227], v241 offset:16384
    ds_read_b128 a[228:231], v241 offset:17408
    v_or3_b32 v208, v208, v107, v108
    v_mfma_f32_16x16x32_bf16 a[112:115], a[240:243], v[124:127], a[112:115]
    v_exp_f32 v141, v29
    v_mfma_f32_16x16x32_bf16 a[84:87], a[244:247], v[120:123], a[84:87]
    v_exp_f32_e64 v142, v30
    v_mfma_f32_16x16x32_bf16 a[116:119], a[244:247], v[124:127], a[116:119]
    v_exp_f32_e64 v143, v31
    v_mfma_f32_16x16x32_bf16 a[88:91], a[248:251], v[120:123], a[88:91]
    ds_read_b128 a[232:235], v241 offset:18432
    ds_read_b128 a[236:239], v241 offset:19456
    buffer_load_dwordx4 v242, s[16:19], s42 offen offset:3072 sc1 lds
    v_mfma_f32_16x16x32_bf16 a[120:123], a[248:251], v[124:127], a[120:123]
    s_add_u32 s42, s42, 34048
    v_cvt_pk_bf16_f32 v109, v138, v139
    v_mfma_f32_16x16x32_bf16 a[92:95], a[252:255], v[120:123], a[92:95]
    v_cvt_pk_bf16_f32 v110, v140, v141
    v_or3_b32 v208, v208, v109, v110
    v_mfma_f32_16x16x32_bf16 a[124:127], a[252:255], v[124:127], a[124:127]
    v_cvt_pk_bf16_f32 v111, v142, v143
    v_or_b32 v208, v208, v111
    v_and_b32 v208, s38, v208
    v_mfma_f32_16x16x32_bf16 v[152:155], v[204:207], v[120:123], v[152:155]
    v_cmp_ne_u32_e64 vcc, 0, v208
    v_mfma_f32_16x16x32_bf16 v[156:159], v[204:207], v[124:127], v[156:159]
    s_cbranch_vccnz kf_rare26
kf_rr25:
ka_p2_e:
    s_sub_u32 s26, s26, 1
    s_cbranch_scc0 ka_p2
    s_branch ka_p2_x
kf_fix23:
    s_mov_b32 s24, 0
    s_branch kf_fix23c
kf_fix27:
    s_mov_b32 s24, 1
kf_fix23c:
    s_cmp_eq_u32 s33, 0
    s_cbranch_scc0 kf_fix23f
    s_mov_b32 s36, 0
    s_mov_b32 s33, 1
    v_add_f32 v80, v226, v200
    v_add_f32 v81, v226, v201
    v_add_f32 v82, v226, v202
    v_add_f32 v83, v226, v203
    v_add_f32 v84, v226, v209
    v_add_f32 v85, v226, v210
    v_add_f32 v86, v226, v211
    v_add_f32 v87, v226, v212
    v_add_f32 v88, v227, v213
    v_add_f32 v89, v227, v214
    v_add_f32 v90, v227, v215
    v_add_f32 v91, v227, v216
    v_add_f32 v92, v227, v217
    v_add_f32 v93, v227, v218
    v_add_f32 v94, v227, v219
    v_add_f32 v95, v227, v220
    s_cmp_eq_u32 s24, 0
    s_cbranch_scc1 kf_fixr24
    s_branch kf_fixr28
kf_fix23f:
    s_mov_b32 s36, 0x1000
    v_mov_b32 v80, 0xf1800000
    v_mov_b32 v81, v80
    v_mov_b32 v82, v80
    v_mov_b32 v83, v80
    v_mov_b32 v84, v80
    v_mov_b32 v85, v80
    v_mov_b32 v86, v80
    v_mov_b32 v87, v80
    v_mov_b32 v88, v80
    v_mov_b32 v89, v80
    v_mov_b32 v90, v80
    v_mov_b32 v91, v80
    v_mov_b32 v92, v80
    v_mov_b32 v93, v80
    v_mov_b32 v94, v80
    v_mov_b32_e64 v95, v80
    s_cmp_eq_u32 s24, 0
    s_cbranch_scc1 kf_fixr24
    s_branch kf_fixr28
ka_p2_x:
    s_waitcnt lgkmcnt(0)
    ds_read_b128 a[224:227], v241 offset:16384
    ds_read_b128 a[228:231], v241 offset:17408
    ds_read_b128 a[232:235], v241 offset:18432
    ds_read_b128 a[236:239], v241 offset:19456
    ds_read_b128 a[240:243], v241 offset:20480
    ds_read_b128 a[244:247], v241 offset:21504
    ds_read_b128 a[248:251], v241 offset:22528
    ds_read_b128 a[252:255], v241 offset:23552
    ds_read_b128 a[192:195], v241 offset:24576
    ds_read_b128 a[196:199], v241 offset:25600
    ds_read_b128 a[200:203], v241 offset:26624
    ds_read_b128 a[204:207], v241 offset:27648
    ds_read_b128 a[208:211], v241 offset:28672
    ds_read_b128 a[212:215], v241 offset:29696
    ds_read_b128 a[216:219], v241 offset:30720
    s_waitcnt lgkmcnt(7)
    ds_read_b128 a[220:223], v241 offset:31744
    v_mfma_f32_16x16x32_bf16 a[64:67], a[224:227], v[104:107], a[64:67]
    v_exp_f32 v128, v48
    v_exp_f32_e64 v129, v49
    v_mfma_f32_16x16x32_bf16 a[96:99], a[224:227], v[108:111], a[96:99]
    v_exp_f32_e64 v130, v50
    v_cvt_pk_bf16_f32 v120, v128, v129
    v_mfma_f32_16x16x32_bf16 a[68:71], a[228:231], v[104:107], a[68:71]
    v_exp_f32_e64 v131, v51
    v_mfma_f32_16x16x32_bf16 a[100:103], a[228:231], v[108:111], a[100:103]
    v_exp_f32_e64 v132, v52
    v_cvt_pk_bf16_f32 v121, v130, v131
    v_mfma_f32_16x16x32_bf16 a[72:75], a[232:235], v[104:107], a[72:75]
    v_exp_f32_e64 v133, v53
    v_mfma_f32_16x16x32_bf16 a[104:107], a[232:235], v[108:111], a[104:107]
    v_exp_f32_e64 v134, v54
    v_cvt_pk_bf16_f32 v122, v132, v133
    v_mfma_f32_16x16x32_bf16 a[76:79], a[236:239], v[104:107], a[76:79]
    v_exp_f32_e64 v135, v55
    v_or3_b32 v208, v120, v121, v122
    v_mfma_f32_16x16x32_bf16 a[108:111], a[236:239], v[108:111], a[108:111]
    v_exp_f32_e64 v136, v56
    v_cvt_pk_bf16_f32 v123, v134, v135
    v_mfma_f32_16x16x32_bf16 a[80:83], a[240:243], v[104:107], a[80:83]
    v_exp_f32_e64 v137, v57
    v_mfma_f32_16x16x32_bf16 a[112:115], a[240:243], v[108:111], a[112:115]
    v_exp_f32_e64 v138, v58
    v_cvt_pk_bf16_f32 v124, v136, v137
    v_mfma_f32_16x16x32_bf16 a[84:87], a[244:247], v[104:107], a[84:87]
    v_exp_f32_e64 v139, v59
    v_or3_b32 v208, v208, v123, v124
    v_mfma_f32_16x16x32_bf16 a[116:119], a[244:247], v[108:111], a[116:119]
    v_exp_f32_e64 v140, v60
    v_cvt_pk_bf16_f32 v125, v138, v139
    v_mfma_f32_16x16x32_bf16 a[88:91], a[248:251], v[104:107], a[88:91]
    v_exp_f32_e64 v141, v61
    v_mfma_f32_16x16x32_bf16 a[120:123], a[248:251], v[108:111], a[120:123]
    v_exp_f32_e64 v142, v62
    v_cvt_pk_bf16_f32 v126, v140, v141
    v_mfma_f32_16x16x32_bf16 a[92:95], a[252:255], v[104:107], a[92:95]
    v_exp_f32_e64 v143, v63
    v_or3_b32 v208, v208, v125, v126
    v_mfma_f32_16x16x32_bf16 a[124:127], a[252:255], v[108:111], a[124:127]
    v_cvt_pk_bf16_f32 v127, v142, v143
    v_or_b32 v208, v208, v127
    v_and_b32 v208, s38, v208
    v_mfma_f32_16x16x32_bf16 v[152:155], v[204:207], v[104:107], v[152:155]
    v_cmp_ne_u32_e64 vcc, 0, v208
    v_mfma_f32_16x16x32_bf16 v[156:159], v[204:207], v[108:111], v[156:159]
    s_cbranch_vccnz kf_rare30
kf_rr29:
    s_waitcnt lgkmcnt(0)
    s_nop 0
    v_mfma_f32_16x16x32_bf16 a[64:67], a[192:195], v[120:123], a[64:67]
    v_mfma_f32_16x16x32_bf16 a[96:99], a[192:195], v[124:127], a[96:99]
    v_mfma_f32_16x16x32_bf16 a[68:71], a[196:199], v[120:123], a[68:71]
    v_mfma_f32_16x16x32_bf16 a[100:103], a[196:199], v[124:127], a[100:103]
    v_mfma_f32_16x16x32_bf16 a[72:75], a[200:203], v[120:123], a[72:75]
    v_mfma_f32_16x16x32_bf16 a[104:107], a[200:203], v[124:127], a[104:107]
    v_mfma_f32_16x16x32_bf16 a[76:79], a[204:207], v[120:123], a[76:79]
    v_mfma_f32_16x16x32_bf16 a[108:111], a[204:207], v[124:127], a[108:111]
    v_mfma_f32_16x16x32_bf16 a[80:83], a[208:211], v[120:123], a[80:83]
    v_mfma_f32_16x16x32_bf16 a[112:115], a[208:211], v[124:127], a[112:115]
    v_mfma_f32_16x16x32_bf16 a[84:87], a[212:215], v[120:123], a[84:87]
    v_mfma_f32_16x16x32_bf16 a[116:119], a[212:215], v[124:127], a[116:119]
    v_mfma_f32_16x16x32_bf16 a[88:91], a[216:219], v[120:123], a[88:91]
    v_mfma_f32_16x16x32_bf16 a[120:123], a[216:219], v[124:127], a[120:123]
    v_mfma_f32_16x16x32_bf16 a[92:95], a[220:223], v[120:123], a[92:95]
    v_mfma_f32_16x16x32_bf16 a[124:127], a[220:223], v[124:127], a[124:127]
    v_mfma_f32_16x16x32_bf16 v[152:155], v[204:207], v[120:123], v[152:155]
    v_mfma_f32_16x16x32_bf16 v[156:159], v[204:207], v[124:127], v[156:159]
    s_cmp_eq_u32 s31, 0
    s_cbranch_scc1 ka_nox
    s_waitcnt vmcnt(8)
    s_barrier
ka_nox:
    s_nop 6
    v_rcp_f32 v230, v152
    v_rcp_f32 v231, v156
    v_accvgpr_read_b32 v160, a64
    v_accvgpr_read_b32 v161, a65
    v_accvgpr_read_b32 v162, a66
    v_accvgpr_read_b32 v163, a67
    v_accvgpr_read_b32 v164, a68
    v_accvgpr_read_b32 v165, a69
    v_accvgpr_read_b32 v166, a70
    v_accvgpr_read_b32 v167, a71
    v_mul_f32 v160, v160, v230
    v_mul_f32 v161, v161, v230
    v_mul_f32 v162, v162, v230
    v_mul_f32 v163, v163, v230
    v_mul_f32 v164, v164, v230
    v_mul_f32 v165, v165, v230
    v_mul_f32 v166, v166, v230
    v_mul_f32 v167, v167, v230
    v_cvt_pk_bf16_f32 v176, v160, v161
    v_cvt_pk_bf16_f32 v177, v162, v163
    v_cvt_pk_bf16_f32 v178, v164, v165
    v_cvt_pk_bf16_f32 v179, v166, v167
    buffer_store_dwordx4 v[176:179], v240, s[20:23], s40 offen offset:0 sc1
    v_accvgpr_read_b32 v168, a72
    v_accvgpr_read_b32 v169, a73
    v_accvgpr_read_b32 v170, a74
    v_accvgpr_read_b32 v171, a75
    v_accvgpr_read_b32 v172, a76
    v_accvgpr_read_b32 v173, a77
    v_accvgpr_read_b32 v174, a78
    v_accvgpr_read_b32 v175, a79
    v_mul_f32 v168, v168, v230
    v_mul_f32 v169, v169, v230
    v_mul_f32 v170, v170, v230
    v_mul_f32 v171, v171, v230
    v_mul_f32 v172, v172, v230
    v_mul_f32 v173, v173, v230
    v_mul_f32 v174, v174, v230
    v_mul_f32 v175, v175, v230
    v_cvt_pk_bf16_f32 v180, v168, v169
    v_cvt_pk_bf16_f32 v181, v170, v171
    v_cvt_pk_bf16_f32 v182, v172, v173
    v_cvt_pk_bf16_f32 v183, v174, v175
    buffer_store_dwordx4 v[180:183], v240, s[20:23], s40 offen offset:1024 sc1
    v_accvgpr_read_b32 v160, a80
    v_accvgpr_read_b32 v161, a81
    v_accvgpr_read_b32 v162, a82
    v_accvgpr_read_b32 v163, a83
    v_accvgpr_read_b32 v164, a84
    v_accvgpr_read_b32 v165, a85
    v_accvgpr_read_b32 v166, a86
    v_accvgpr_read_b32 v167, a87
    v_mul_f32 v160, v160, v230
    v_mul_f32 v161, v161, v230
    v_mul_f32 v162, v162, v230
    v_mul_f32 v163, v163, v230
    v_mul_f32 v164, v164, v230
    v_mul_f32 v165, v165, v230
    v_mul_f32 v166, v166, v230
    v_mul_f32 v167, v167, v230
    v_cvt_pk_bf16_f32 v184, v160, v161
    v_cvt_pk_bf16_f32 v185, v162, v163
    v_cvt_pk_bf16_f32 v186, v164, v165
    v_cvt_pk_bf16_f32 v187, v166, v167
    buffer_store_dwordx4 v[184:187], v240, s[20:23], s40 offen offset:2048 sc1
    v_accvgpr_read_b32 v168, a88
    v_accvgpr_read_b32 v169, a89
    v_accvgpr_read_b32 v170, a90
    v_accvgpr_read_b32 v171, a91
    v_accvgpr_read_b32 v172, a92
    v_accvgpr_read_b32 v173, a93
    v_accvgpr_read_b32 v174, a94
    v_accvgpr_read_b32 v175, a95
    v_mul_f32 v168, v168, v230
    v_mul_f32 v169, v169, v230
    v_mul_f32 v170, v170, v230
    v_mul_f32 v171, v171, v230
    v_mul_f32 v172, v172, v230
    v_mul_f32 v173, v173, v230
    v_mul_f32 v174, v174, v230
    v_mul_f32 v175, v175, v230
    v_cvt_pk_bf16_f32 v188, v168, v169
    v_cvt_pk_bf16_f32 v189, v170, v171
    v_cvt_pk_bf16_f32 v190, v172, v173
    v_cvt_pk_bf16_f32 v191, v174, v175
    buffer_store_dwordx4 v[188:191], v240, s[20:23], s40 offen offset:3072 sc1
    v_accvgpr_read_b32 v160, a96
    v_accvgpr_read_b32 v161, a97
    v_accvgpr_read_b32 v162, a98
    v_accvgpr_read_b32 v163, a99
    v_accvgpr_read_b32 v164, a100
    v_accvgpr_read_b32 v165, a101
    v_accvgpr_read_b32 v166, a102
    v_accvgpr_read_b32 v167, a103
    v_mul_f32 v160, v160, v231
    v_mul_f32 v161, v161, v231
    v_mul_f32 v162, v162, v231
    v_mul_f32 v163, v163, v231
    v_mul_f32 v164, v164, v231
    v_mul_f32 v165, v165, v231
    v_mul_f32 v166, v166, v231
    v_mul_f32 v167, v167, v231
    v_cvt_pk_bf16_f32 v176, v160, v161
    v_cvt_pk_bf16_f32 v177, v162, v163
    v_cvt_pk_bf16_f32 v178, v164, v165
    v_cvt_pk_bf16_f32 v179, v166, v167
    buffer_store_dwordx4 v[176:179], v244, s[20:23], s40 offen offset:0 sc1
    v_accvgpr_read_b32 v168, a104
    v_accvgpr_read_b32 v169, a105
    v_accvgpr_read_b32 v170, a106
    v_accvgpr_read_b32 v171, a107
    v_accvgpr_read_b32 v172, a108
    v_accvgpr_read_b32 v173, a109
    v_accvgpr_read_b32 v174, a110
    v_accvgpr_read_b32 v175, a111
    v_mul_f32 v168, v168, v231
    v_mul_f32 v169, v169, v231
    v_mul_f32 v170, v170, v231
    v_mul_f32 v171, v171, v231
    v_mul_f32 v172, v172, v231
    v_mul_f32 v173, v173, v231
    v_mul_f32 v174, v174, v231
    v_mul_f32 v175, v175, v231
    v_cvt_pk_bf16_f32 v180, v168, v169
    v_cvt_pk_bf16_f32 v181, v170, v171
    v_cvt_pk_bf16_f32 v182, v172, v173
    v_cvt_pk_bf16_f32 v183, v174, v175
    buffer_store_dwordx4 v[180:183], v244, s[20:23], s40 offen offset:1024 sc1
    v_accvgpr_read_b32 v160, a112
    v_accvgpr_read_b32 v161, a113
    v_accvgpr_read_b32 v162, a114
    v_accvgpr_read_b32 v163, a115
    v_accvgpr_read_b32 v164, a116
    v_accvgpr_read_b32 v165, a117
    v_accvgpr_read_b32 v166, a118
    v_accvgpr_read_b32 v167, a119
    v_mul_f32 v160, v160, v231
    v_mul_f32 v161, v161, v231
    v_mul_f32 v162, v162, v231
    v_mul_f32 v163, v163, v231
    v_mul_f32 v164, v164, v231
    v_mul_f32 v165, v165, v231
    v_mul_f32 v166, v166, v231
    v_mul_f32 v167, v167, v231
    v_cvt_pk_bf16_f32 v184, v160, v161
    v_cvt_pk_bf16_f32 v185, v162, v163
    v_cvt_pk_bf16_f32 v186, v164, v165
    v_cvt_pk_bf16_f32 v187, v166, v167
    buffer_store_dwordx4 v[184:187], v244, s[20:23], s40 offen offset:2048 sc1
    v_accvgpr_read_b32 v168, a120
    v_accvgpr_read_b32 v169, a121
    v_accvgpr_read_b32 v170, a122
    v_accvgpr_read_b32 v171, a123
    v_accvgpr_read_b32 v172, a124
    v_accvgpr_read_b32 v173, a125
    v_accvgpr_read_b32 v174, a126
    v_accvgpr_read_b32 v175, a127
    v_mul_f32 v168, v168, v231
    v_mul_f32 v169, v169, v231
    v_mul_f32 v170, v170, v231
    v_mul_f32 v171, v171, v231
    v_mul_f32 v172, v172, v231
    v_mul_f32 v173, v173, v231
    v_mul_f32 v174, v174, v231
    v_mul_f32 v175, v175, v231
    v_cvt_pk_bf16_f32 v188, v168, v169
    v_cvt_pk_bf16_f32 v189, v170, v171
    v_cvt_pk_bf16_f32 v190, v172, v173
    v_cvt_pk_bf16_f32 v191, v174, v175
    buffer_store_dwordx4 v[188:191], v244, s[20:23], s40 offen offset:3072 sc1
    s_sub_u32 s46, s20, 0x2400000
    s_subb_u32 s47, s21, 0
    s_mov_b64 s[42:43], s[56:57]
    s_mov_b64 s[40:41], s[80:81]
    s_mov_b64 s[44:45], s[82:83]
    s_mov_b64 s[60:61], s[84:85]
    s_mov_b64 s[62:63], s[86:87]
    v_mbcnt_lo_u32_b32 v237, -1, 0
    v_mbcnt_hi_u32_b32 v237, -1, v237
    s_lshl_b32 s32, s3, 6
    v_add_u32 v230, s32, v237
    s_lshr_b32 s53, s2, 3
    s_lshr_b32 s6, s2, 1
    s_and_b32 s6, s6, 3
    s_and_b32 s4, s2, 1
    s_lshl_b32 s4, s4, 2
    s_and_b32 s33, s53, 3
    s_add_u32 s4, s4, s33
    s_lshr_b32 s5, s53, 2
    v_lshlrev_b32 v228, 4, v237
    v_lshrrev_b32 v234, 4, v237
    v_and_b32 v235, 15, v237
    v_lshlrev_b32 v236, 1, v234
    v_xor_b32 v235, v235, v236
    v_lshlrev_b32 v234, 11, v234
    s_lshl_b32 s32, s3, 14
    s_lshl_b32 s33, s5, 8
    s_add_u32 s32, s32, s33
    v_add_u32 v234, s32, v234
    v_lshl_add_u32 v224, v235, 4, v234
    v_xor_b32_e64 v235, 8, v235
    v_lshl_add_u32 v225, v235, 4, v234
    v_add_u32 v225, 7168, v225
    s_lshl_b32 s37, s6, 21
    s_lshl_b32 s38, s3, 11
    s_lshl2_add_u32 s4, s4, s3
    s_sub_u32 s32, 63, s4
    s_cmp_lt_u32 s6, 2
    s_cselect_b32 s4, s4, s32
    s_lshl_b32 s32, s4, 18
    v_add_u32 v226, s32, v228
    v_add_u32 v227, 0x20000, v226
    v_xor_b32 v245, 0xfc0000, v226
    v_xor_b32 v246, 0xfc0000, v227
    s_lshl_b32 s35, s6, 15
    s_add_u32 s35, s35, 0x2400000
    s_getpc_b64 s[56:57]
kc_pc0:
    s_mov_b32 s58, kc_end-kc_pc0
    s_mov_b32 s59, 0x00020000
    v_lshlrev_b32_e64 v234, 7, v230
    buffer_load_dword v241, v234, s[56:59], 0 offen
    s_waitcnt lgkmcnt(0)
    s_mov_b32 s8, s46
    s_mov_b32 s9, s47
    s_mov_b32 s10, 0x10000000
    s_mov_b32 s11, 0x00020000
    s_mov_b32 s12, s42
    s_mov_b32 s13, s43
    s_mov_b32 s14, 0x800000
    s_mov_b32 s15, 0x00020000
    s_mov_b32 s16, s40
    s_mov_b32 s17, s41
    s_mov_b32 s18, 0x400000
    s_mov_b32 s19, 0x00020000
    s_mov_b32 s20, s44
    s_mov_b32 s21, s45
    s_mov_b32 s22, 0x800
    s_mov_b32 s23, 0x00020000
    s_mov_b32 s24, s60
    s_mov_b32 s25, s61
    s_mov_b32 s26, 0x700000
    s_mov_b32 s27, 0x00020000
    s_mov_b32 s28, s62
    s_mov_b32 s29, s63
    s_mov_b32 s30, 0x400000
    s_mov_b32 s31, 0x00020000
    s_lshr_b32 s44, s6, 1
    s_and_b32 s6, s6, 1
    v_bfe_u32 v234, v237, 2, 3
    v_lshrrev_b32 v235, 5, v237
    v_lshl_add_u32 v235, v235, 4, v234
    v_lshlrev_b32 v235, 8, v235
    v_and_b32 v236, 1, v237
    v_lshl_add_u32 v235, v236, 3, v235
    v_lshlrev_b32_e64 v234, 1, v234
    v_bfe_u32 v236, v237, 1, 1
    v_or_b32 v234, v234, v236
    s_lshl_b32 s32, s6, 3
    v_xor_b32 v234, s32, v234
    v_xor_b32 v236, 0, v234
    v_lshl_add_u32 v216, v236, 4, v235
    v_xor_b32_e64 v236, 2, v234
    v_lshl_add_u32 v217, v236, 4, v235
    v_xor_b32_e64 v236, 4, v234
    v_lshl_add_u32 v218, v236, 4, v235
    v_xor_b32_e64 v236, 6, v234
    v_lshl_add_u32 v219, v236, 4, v235
    v_xor_b32_e64 v236, 8, v234
    v_lshl_add_u32 v220, v236, 4, v235
    v_xor_b32_e64 v236, 10, v234
    v_lshl_add_u32 v221, v236, 4, v235
    v_xor_b32_e64 v236, 12, v234
    v_lshl_add_u32 v222, v236, 4, v235
    v_xor_b32_e64 v236, 14, v234
    v_lshl_add_u32 v223, v236, 4, v235
    s_lshl_b32 s44, s4, 5
    v_lshrrev_b32 v234, 3, v237
    v_add_u32 v242, s44, v234
    v_and_b32 v235, 7, v237
    s_lshl1_add_u32 s33, s5, s6
    s_lshl_b32 s33, s33, 7
    v_lshl_add_u32 v240, v235, 4, s33
    v_lshl_add_u32 v229, v242, 11, v240
    s_mul_i32 s32, s3, 4608
    s_add_u32 s32, s32, 131072
    v_mul_u32_u24 v234, 144, v234
    v_lshl_add_u32 v234, v235, 4, v234
    v_add_u32 v239, s32, v234
    v_and_b32 v234, 15, v237
    v_mul_u32_u24 v234, 144, v234
    v_lshrrev_b32_e64 v236, 4, v237
    v_lshl_add_u32 v234, v236, 3, v234
    v_add_u32 v238, s32, v234
    v_and_b32 v234, 3, v237
    v_lshl_add_u32 v234, v234, 3, v242
    v_lshlrev_b32 v234, 2, v234
    v_lshrrev_b32 v235, 2, v235
    v_lshl_add_u32 v231, v235, 13, v234
    v_lshlrev_b32_e64 v235, 30, v235
    v_add_u32 v235, 16384, v235
    v_add_u32 v232, v235, v234
    s_cmp_eq_u32 s44, 0
    s_cselect_b32 s32, 4, 64
    v_cmp_eq_u32 vcc, s32, v237
    v_mov_b32 v235, 24576
    v_mov_b32 v233, 1
    v_cndmask_b32 v232, v232, v235, vcc
    v_and_b32_e64 v234, 1, v237
    v_cmp_ne_u32 s[60:61], 0, v234
    v_and_b32_e64 v234, 2, v237
    v_cmp_ne_u32 s[62:63], 0, v234
    v_and_b32_e64 v234, 4, v237
    v_cmp_ne_u32 s[40:41], 0, v234
    v_cmp_eq_u32 vcc, 0, v237
    v_mov_b32_e64 v235, 0x40000000
    s_nop 0
    v_cndmask_b32 v243, v235, v237, vcc
    s_lshl2_add_u32 s39, s2, s3
    s_mov_b32 s48, 0x3800000
    s_mov_b32 s49, 0x3802000
    s_mov_b32 s50, 0x3804000
    s_and_b32 s52, s2, 7
    s_mul_i32 s54, s52, 28
    s_add_u32 s54, s54, s53
    v_lshrrev_b32 v234, 3, v237
    v_lshlrev_b32 v234, 11, v234
    v_and_b32 v235, 7, v237
    v_lshl_add_u32 v244, v235, 4, v234
    s_lshl_b32 s55, s54, 16
    s_lshl_b32 s32, s3, 13
    s_add_u32 s55, s55, s32
    s_add_u32 s55, s55, 0x4000000
    s_lshl_b32 s51, s54, 15
    s_lshl_b32 s32, s3, 9
    s_add_u32 s51, s51, s32
    s_cmp_ge_u32 s53, 28
    s_cselect_b32 s55, 0x40000000, s55
    s_cselect_b32 s51, 0x40000000, s51
    s_lshr_b32 s32, s2, 5
    s_lshl_b32 s32, s32, 9
    s_and_b32 s33, s2, 6
    s_lshl_b32 s33, s33, 6
    s_add_u32 s32, s32, s33
    s_add_u32 s32, s32, 0x38a4000
    s_waitcnt vmcnt(0)
    s_barrier
    s_cmp_lg_u32 s3, 0
    s_cbranch_scc1 kc_a0
    buffer_atomic_add v233, v243, s[8:11], s32 offen sc1
    s_lshl_b32 s32, s52, 7
    s_add_u32 s32, s32, 0x38a1000
    v_mov_b32 v235, 1
    buffer_atomic_add v235, v243, s[8:11], s32 offen sc0 sc1
    v_lshlrev_b32 v234, 7, v237
    v_cmp_gt_u32 vcc, 8, v237
    v_mov_b32_e64 v236, 0x40000000
    s_mov_b32 s34, 0x38a1400
    v_cndmask_b32 v234, v236, v234, vcc
    s_waitcnt vmcnt(0)
    v_readfirstlane_b32 s36, v235
    s_cmp_lg_u32 s36, 31
    s_cbranch_scc1 kc_a0
    buffer_atomic_add v233, v234, s[8:11], s34 offen sc1
kc_a0:
    s_add_u32 m0, s38, 0
    s_add_u32 s32, s37, 0
    buffer_load_dwordx4 v224, s[12:15], s32 offen lds
    buffer_load_dwordx4 v225, s[12:15], s32 offen offset:1024 lds
    s_add_u32 m0, s38, 8192
    s_add_u32 s32, s37, 65536
    buffer_load_dwordx4 v224, s[12:15], s32 offen lds
    buffer_load_dwordx4 v225, s[12:15], s32 offen offset:1024 lds
    s_add_u32 m0, s38, 16384
    s_add_u32 s32, s37, 131072
    buffer_load_dwordx4 v224, s[12:15], s32 offen lds
    buffer_load_dwordx4 v225, s[12:15], s32 offen offset:1024 lds
    s_add_u32 m0, s38, 24576
    s_add_u32 s32, s37, 196608
    buffer_load_dwordx4 v224, s[12:15], s32 offen lds
    buffer_load_dwordx4 v225, s[12:15], s32 offen offset:1024 lds
    s_add_u32 m0, s38, 32768
    s_add_u32 s32, s37, 262144
    buffer_load_dwordx4 v224, s[12:15], s32 offen lds
    buffer_load_dwordx4 v225, s[12:15], s32 offen offset:1024 lds
    s_add_u32 m0, s38, 40960
    s_add_u32 s32, s37, 327680
    buffer_load_dwordx4 v224, s[12:15], s32 offen lds
    buffer_load_dwordx4 v225, s[12:15], s32 offen offset:1024 lds
    s_add_u32 m0, s38, 49152
    s_add_u32 s32, s37, 393216
    buffer_load_dwordx4 v224, s[12:15], s32 offen lds
    buffer_load_dwordx4 v225, s[12:15], s32 offen offset:1024 lds
    s_add_u32 m0, s38, 57344
    s_add_u32 s32, s37, 458752
    buffer_load_dwordx4 v224, s[12:15], s32 offen lds
    buffer_load_dwordx4 v225, s[12:15], s32 offen offset:1024 lds
    s_add_u32 m0, s38, 65536
    s_add_u32 s32, s37, 524288
    buffer_load_dwordx4 v224, s[12:15], s32 offen lds
    buffer_load_dwordx4 v225, s[12:15], s32 offen offset:1024 lds
    s_add_u32 m0, s38, 73728
    s_add_u32 s32, s37, 589824
    buffer_load_dwordx4 v224, s[12:15], s32 offen lds
    buffer_load_dwordx4 v225, s[12:15], s32 offen offset:1024 lds
    s_add_u32 m0, s38, 81920
    s_add_u32 s32, s37, 655360
    buffer_load_dwordx4 v224, s[12:15], s32 offen lds
    buffer_load_dwordx4 v225, s[12:15], s32 offen offset:1024 lds
    s_add_u32 m0, s38, 90112
    s_add_u32 s32, s37, 720896
    buffer_load_dwordx4 v224, s[12:15], s32 offen lds
    buffer_load_dwordx4 v225, s[12:15], s32 offen offset:1024 lds
    s_add_u32 m0, s38, 98304
    s_add_u32 s32, s37, 786432
    buffer_load_dwordx4 v224, s[12:15], s32 offen lds
    buffer_load_dwordx4 v225, s[12:15], s32 offen offset:1024 lds
    s_add_u32 m0, s38, 106496
    s_add_u32 s32, s37, 851968
    buffer_load_dwordx4 v224, s[12:15], s32 offen lds
    buffer_load_dwordx4 v225, s[12:15], s32 offen offset:1024 lds
    s_add_u32 m0, s38, 114688
    s_add_u32 s32, s37, 917504
    buffer_load_dwordx4 v224, s[12:15], s32 offen lds
    buffer_load_dwordx4 v225, s[12:15], s32 offen offset:1024 lds
    s_add_u32 m0, s38, 122880
    s_add_u32 s32, s37, 983040
    buffer_load_dwordx4 v224, s[12:15], s32 offen lds
    buffer_load_dwordx4 v225, s[12:15], s32 offen offset:1024 lds
    s_add_u32 s33, s51, 0
    buffer_load_dwordx4 a[192:195], v244, s[24:27], s33 offen offset:0
    s_add_u32 s33, s51, 16384
    buffer_load_dwordx4 a[196:199], v244, s[24:27], s33 offen offset:0
    s_add_u32 s33, s51, 0
    buffer_load_dwordx4 a[200:203], v244, s[24:27], s33 offen offset:128
    s_add_u32 s33, s51, 16384
    buffer_load_dwordx4 a[204:207], v244, s[24:27], s33 offen offset:128
    s_add_u32 s33, s51, 0
    buffer_load_dwordx4 a[208:211], v244, s[24:27], s33 offen offset:256
    s_add_u32 s33, s51, 16384
    buffer_load_dwordx4 a[212:215], v244, s[24:27], s33 offen offset:256
    s_add_u32 s33, s51, 0
    buffer_load_dwordx4 a[216:219], v244, s[24:27], s33 offen offset:384
    s_add_u32 s33, s51, 16384
    buffer_load_dwordx4 a[220:223], v244, s[24:27], s33 offen offset:384
    s_cmp_lg_u32 s3, 0
    s_cbranch_scc1 kc_b03
    s_and_b32 s32, s2, 1
    s_lshl_b32 s32, s32, 2
    s_and_b32 s33, s53, 3
    s_add_u32 s32, s32, s33
    s_lshl_b32 s32, s32, 9
    s_and_b32 s33, s2, 6
    s_lshl_b32 s33, s33, 6
    s_add_u32 s32, s32, s33
    s_add_u32 s32, s32, 0x38a4000
    s_mov_b32 s34, 0x100000
    s_branch kc_b01
kc_b00:
    s_sleep 2
kc_b01:
    buffer_load_dword v235, off, s[8:11], s32 sc1
    s_waitcnt vmcnt(0)
    v_cmp_ne_u32 vcc, 8, v235
    s_sub_u32 s34, s34, 1
    s_cbranch_scc1 kc_b02
    s_cbranch_vccnz kc_b00
kc_b02:
kc_b03:
    s_waitcnt vmcnt(8)
    s_barrier
    buffer_load_dwordx4 a[0:3], v226, s[8:11], s35 offen offset:0 sc1
    buffer_load_dwordx4 a[4:7], v227, s[8:11], s35 offen offset:0 sc1
    buffer_load_dwordx4 a[8:11], v245, s[8:11], s35 offen offset:0 sc1
    buffer_load_dwordx4 a[12:15], v246, s[8:11], s35 offen offset:0 sc1
    buffer_load_dwordx4 a[16:19], v226, s[8:11], s35 offen offset:1024 sc1
    buffer_load_dwordx4 a[20:23], v227, s[8:11], s35 offen offset:1024 sc1
    buffer_load_dwordx4 a[24:27], v245, s[8:11], s35 offen offset:1024 sc1
    buffer_load_dwordx4 a[28:31], v246, s[8:11], s35 offen offset:1024 sc1
    buffer_load_dwordx4 a[32:35], v226, s[8:11], s35 offen offset:2048 sc1
    buffer_load_dwordx4 a[36:39], v227, s[8:11], s35 offen offset:2048 sc1
    buffer_load_dwordx4 a[40:43], v245, s[8:11], s35 offen offset:2048 sc1
    buffer_load_dwordx4 a[44:47], v246, s[8:11], s35 offen offset:2048 sc1
    buffer_load_dwordx4 a[48:51], v226, s[8:11], s35 offen offset:3072 sc1
    buffer_load_dwordx4 a[52:55], v227, s[8:11], s35 offen offset:3072 sc1
    buffer_load_dwordx4 a[56:59], v245, s[8:11], s35 offen offset:3072 sc1
    buffer_load_dwordx4 a[60:63], v246, s[8:11], s35 offen offset:3072 sc1
    ds_read_b64_tr_b16 v[128:129], v216 offset:0
    ds_read_b64_tr_b16 v[130:131], v216 offset:2048
    ds_read_b64_tr_b16 v[132:133], v217 offset:0
    ds_read_b64_tr_b16 v[134:135], v217 offset:2048
    ds_read_b64_tr_b16 v[136:137], v218 offset:0
    ds_read_b64_tr_b16 v[138:139], v218 offset:2048
    ds_read_b64_tr_b16 v[140:141], v219 offset:0
    ds_read_b64_tr_b16 v[142:143], v219 offset:2048
    s_waitcnt vmcnt(12) lgkmcnt(0)
    v_mfma_f32_16x16x32_bf16 v[32:35], v[128:131], a[0:3], 0
    ds_read_b64_tr_b16 v[144:145], v220 offset:0
    v_mfma_f32_16x16x32_bf16 v[36:39], v[128:131], a[4:7], 0
    ds_read_b64_tr_b16 v[146:147], v220 offset:2048
    v_mfma_f32_16x16x32_bf16 v[64:67], v[128:131], a[8:11], 0
    ds_read_b64_tr_b16 v[148:149], v221 offset:0
    v_mfma_f32_16x16x32_bf16 v[68:71], v[128:131], a[12:15], 0
    ds_read_b64_tr_b16 v[150:151], v221 offset:2048
    v_mfma_f32_16x16x32_bf16 v[40:43], v[132:135], a[0:3], 0
    ds_read_b64_tr_b16 v[152:153], v222 offset:0
    v_mfma_f32_16x16x32_bf16 v[44:47], v[132:135], a[4:7], 0
    ds_read_b64_tr_b16 v[154:155], v222 offset:2048
    v_mfma_f32_16x16x32_bf16 v[72:75], v[132:135], a[8:11], 0
    ds_read_b64_tr_b16 v[156:157], v223 offset:0
    v_mfma_f32_16x16x32_bf16 v[76:79], v[132:135], a[12:15], 0
    ds_read_b64_tr_b16 v[158:159], v223 offset:2048
    v_mfma_f32_16x16x32_bf16 v[48:51], v[136:139], a[0:3], 0
    s_add_u32 s35, s35, 4096
    buffer_load_dwordx4 a[64:67], v226, s[8:11], s35 offen offset:0 sc1
    v_mfma_f32_16x16x32_bf16 v[52:55], v[136:139], a[4:7], 0
    v_mfma_f32_16x16x32_bf16 v[80:83], v[136:139], a[8:11], 0
    v_mfma_f32_16x16x32_bf16 v[84:87], v[136:139], a[12:15], 0
    buffer_load_dwordx4 a[68:71], v227, s[8:11], s35 offen offset:0 sc1
    v_mfma_f32_16x16x32_bf16 v[56:59], v[140:143], a[0:3], 0
    v_mfma_f32_16x16x32_bf16 v[60:63], v[140:143], a[4:7], 0
    v_mfma_f32_16x16x32_bf16 v[88:91], v[140:143], a[8:11], 0
    v_mfma_f32_16x16x32_bf16 v[92:95], v[140:143], a[12:15], 0
    buffer_load_dwordx4 a[72:75], v245, s[8:11], s35 offen offset:0 sc1
    s_waitcnt lgkmcnt(0)
    v_mfma_f32_16x16x32_bf16 v[0:3], v[144:147], a[0:3], 0
    ds_read_b64_tr_b16 v[128:129], v216 offset:8192
    v_mfma_f32_16x16x32_bf16 v[4:7], v[144:147], a[4:7], 0
    ds_read_b64_tr_b16 v[130:131], v216 offset:10240
    v_mfma_f32_16x16x32_bf16 v[96:99], v[144:147], a[8:11], 0
    ds_read_b64_tr_b16 v[132:133], v217 offset:8192
    v_mfma_f32_16x16x32_bf16 v[100:103], v[144:147], a[12:15], 0
    ds_read_b64_tr_b16 v[134:135], v217 offset:10240
    v_mfma_f32_16x16x32_bf16 v[8:11], v[148:151], a[0:3], 0
    ds_read_b64_tr_b16 v[136:137], v218 offset:8192
    v_mfma_f32_16x16x32_bf16 v[12:15], v[148:151], a[4:7], 0
    ds_read_b64_tr_b16 v[138:139], v218 offset:10240
    v_mfma_f32_16x16x32_bf16 v[104:107], v[148:151], a[8:11], 0
    ds_read_b64_tr_b16 v[140:141], v219 offset:8192
    v_mfma_f32_16x16x32_bf16 v[108:111], v[148:151], a[12:15], 0
    ds_read_b64_tr_b16 v[142:143], v219 offset:10240
    v_mfma_f32_16x16x32_bf16 v[16:19], v[152:155], a[0:3], 0
    buffer_load_dwordx4 a[76:79], v246, s[8:11], s35 offen offset:0 sc1
    v_mfma_f32_16x16x32_bf16 v[20:23], v[152:155], a[4:7], 0
    v_mfma_f32_16x16x32_bf16 v[112:115], v[152:155], a[8:11], 0
    buffer_load_dwordx4 a[80:83], v226, s[8:11], s35 offen offset:1024 sc1
    v_mfma_f32_16x16x32_bf16 v[116:119], v[152:155], a[12:15], 0
    v_mfma_f32_16x16x32_bf16 v[24:27], v[156:159], a[0:3], 0
    v_mfma_f32_16x16x32_bf16 v[28:31], v[156:159], a[4:7], 0
    v_mfma_f32_16x16x32_bf16 v[120:123], v[156:159], a[8:11], 0
    v_mfma_f32_16x16x32_bf16 v[124:127], v[156:159], a[12:15], 0
    s_waitcnt vmcnt(13) lgkmcnt(0)
    v_mfma_f32_16x16x32_bf16 v[32:35], v[128:131], a[16:19], v[32:35]
    ds_read_b64_tr_b16 v[144:145], v220 offset:8192
    v_mfma_f32_16x16x32_bf16 v[36:39], v[128:131], a[20:23], v[36:39]
    ds_read_b64_tr_b16 v[146:147], v220 offset:10240
    v_mfma_f32_16x16x32_bf16 v[64:67], v[128:131], a[24:27], v[64:67]
    ds_read_b64_tr_b16 v[148:149], v221 offset:8192
    v_mfma_f32_16x16x32_bf16 v[68:71], v[128:131], a[28:31], v[68:71]
    ds_read_b64_tr_b16 v[150:151], v221 offset:10240
    v_mfma_f32_16x16x32_bf16 v[40:43], v[132:135], a[16:19], v[40:43]
    ds_read_b64_tr_b16 v[152:153], v222 offset:8192
    v_mfma_f32_16x16x32_bf16 v[44:47], v[132:135], a[20:23], v[44:47]
    ds_read_b64_tr_b16 v[154:155], v222 offset:10240
    v_mfma_f32_16x16x32_bf16 v[72:75], v[132:135], a[24:27], v[72:75]
    ds_read_b64_tr_b16 v[156:157], v223 offset:8192
    v_mfma_f32_16x16x32_bf16 v[76:79], v[132:135], a[28:31], v[76:79]
    ds_read_b64_tr_b16 v[158:159], v223 offset:10240
    v_mfma_f32_16x16x32_bf16 v[48:51], v[136:139], a[16:19], v[48:51]
    buffer_load_dwordx4 a[84:87], v227, s[8:11], s35 offen offset:1024 sc1
    v_mfma_f32_16x16x32_bf16 v[52:55], v[136:139], a[20:23], v[52:55]
    v_mfma_f32_16x16x32_bf16 v[80:83], v[136:139], a[24:27], v[80:83]
    v_mfma_f32_16x16x32_bf16 v[84:87], v[136:139], a[28:31], v[84:87]
    buffer_load_dwordx4 a[88:91], v245, s[8:11], s35 offen offset:1024 sc1
    v_mfma_f32_16x16x32_bf16 v[56:59], v[140:143], a[16:19], v[56:59]
    v_mfma_f32_16x16x32_bf16 v[60:63], v[140:143], a[20:23], v[60:63]
    v_mfma_f32_16x16x32_bf16 v[88:91], v[140:143], a[24:27], v[88:91]
    v_mfma_f32_16x16x32_bf16 v[92:95], v[140:143], a[28:31], v[92:95]
    buffer_load_dwordx4 a[92:95], v246, s[8:11], s35 offen offset:1024 sc1
    s_waitcnt lgkmcnt(0)
    v_mfma_f32_16x16x32_bf16 v[0:3], v[144:147], a[16:19], v[0:3]
    ds_read_b64_tr_b16 v[128:129], v216 offset:16384
    v_mfma_f32_16x16x32_bf16 v[4:7], v[144:147], a[20:23], v[4:7]
    ds_read_b64_tr_b16 v[130:131], v216 offset:18432
    v_mfma_f32_16x16x32_bf16 v[96:99], v[144:147], a[24:27], v[96:99]
    ds_read_b64_tr_b16 v[132:133], v217 offset:16384
    v_mfma_f32_16x16x32_bf16 v[100:103], v[144:147], a[28:31], v[100:103]
    ds_read_b64_tr_b16 v[134:135], v217 offset:18432
    v_mfma_f32_16x16x32_bf16 v[8:11], v[148:151], a[16:19], v[8:11]
    ds_read_b64_tr_b16 v[136:137], v218 offset:16384
    v_mfma_f32_16x16x32_bf16 v[12:15], v[148:151], a[20:23], v[12:15]
    ds_read_b64_tr_b16 v[138:139], v218 offset:18432
    v_mfma_f32_16x16x32_bf16 v[104:107], v[148:151], a[24:27], v[104:107]
    ds_read_b64_tr_b16 v[140:141], v219 offset:16384
    v_mfma_f32_16x16x32_bf16 v[108:111], v[148:151], a[28:31], v[108:111]
    ds_read_b64_tr_b16 v[142:143], v219 offset:18432
    v_mfma_f32_16x16x32_bf16 v[16:19], v[152:155], a[16:19], v[16:19]
    buffer_load_dwordx4 a[96:99], v226, s[8:11], s35 offen offset:2048 sc1
    v_mfma_f32_16x16x32_bf16 v[20:23], v[152:155], a[20:23], v[20:23]
    v_mfma_f32_16x16x32_bf16 v[112:115], v[152:155], a[24:27], v[112:115]
    v_mfma_f32_16x16x32_bf16 v[116:119], v[152:155], a[28:31], v[116:119]
    v_mfma_f32_16x16x32_bf16 v[24:27], v[156:159], a[16:19], v[24:27]
    buffer_load_dwordx4 a[100:103], v227, s[8:11], s35 offen offset:2048 sc1
    v_mfma_f32_16x16x32_bf16 v[28:31], v[156:159], a[20:23], v[28:31]
    v_mfma_f32_16x16x32_bf16 v[120:123], v[156:159], a[24:27], v[120:123]
    v_mfma_f32_16x16x32_bf16 v[124:127], v[156:159], a[28:31], v[124:127]
    s_waitcnt vmcnt(14) lgkmcnt(0)
    v_mfma_f32_16x16x32_bf16 v[32:35], v[128:131], a[32:35], v[32:35]
    ds_read_b64_tr_b16 v[144:145], v220 offset:16384
    v_mfma_f32_16x16x32_bf16 v[36:39], v[128:131], a[36:39], v[36:39]
    ds_read_b64_tr_b16 v[146:147], v220 offset:18432
    v_mfma_f32_16x16x32_bf16 v[64:67], v[128:131], a[40:43], v[64:67]
    ds_read_b64_tr_b16 v[148:149], v221 offset:16384
    v_mfma_f32_16x16x32_bf16 v[68:71], v[128:131], a[44:47], v[68:71]
    ds_read_b64_tr_b16 v[150:151], v221 offset:18432
    v_mfma_f32_16x16x32_bf16 v[40:43], v[132:135], a[32:35], v[40:43]
    ds_read_b64_tr_b16 v[152:153], v222 offset:16384
    v_mfma_f32_16x16x32_bf16 v[44:47], v[132:135], a[36:39], v[44:47]
    ds_read_b64_tr_b16 v[154:155], v222 offset:18432
    v_mfma_f32_16x16x32_bf16 v[72:75], v[132:135], a[40:43], v[72:75]
    ds_read_b64_tr_b16 v[156:157], v223 offset:16384
    v_mfma_f32_16x16x32_bf16 v[76:79], v[132:135], a[44:47], v[76:79]
    ds_read_b64_tr_b16 v[158:159], v223 offset:18432
    v_mfma_f32_16x16x32_bf16 v[48:51], v[136:139], a[32:35], v[48:51]
    buffer_load_dwordx4 a[104:107], v245, s[8:11], s35 offen offset:2048 sc1
    v_mfma_f32_16x16x32_bf16 v[52:55], v[136:139], a[36:39], v[52:55]
    v_mfma_f32_16x16x32_bf16 v[80:83], v[136:139], a[40:43], v[80:83]
    v_mfma_f32_16x16x32_bf16 v[84:87], v[136:139], a[44:47], v[84:87]
    buffer_load_dwordx4 a[108:111], v246, s[8:11], s35 offen offset:2048 sc1
    v_mfma_f32_16x16x32_bf16 v[56:59], v[140:143], a[32:35], v[56:59]
    v_mfma_f32_16x16x32_bf16 v[60:63], v[140:143], a[36:39], v[60:63]
    v_mfma_f32_16x16x32_bf16 v[88:91], v[140:143], a[40:43], v[88:91]
    v_mfma_f32_16x16x32_bf16 v[92:95], v[140:143], a[44:47], v[92:95]
    buffer_load_dwordx4 a[112:115], v226, s[8:11], s35 offen offset:3072 sc1
    s_waitcnt lgkmcnt(0)
    v_mfma_f32_16x16x32_bf16 v[0:3], v[144:147], a[32:35], v[0:3]
    ds_read_b64_tr_b16 v[128:129], v216 offset:24576
    v_mfma_f32_16x16x32_bf16 v[4:7], v[144:147], a[36:39], v[4:7]
    ds_read_b64_tr_b16 v[130:131], v216 offset:26624
    v_mfma_f32_16x16x32_bf16 v[96:99], v[144:147], a[40:43], v[96:99]
    ds_read_b64_tr_b16 v[132:133], v217 offset:24576
    v_mfma_f32_16x16x32_bf16 v[100:103], v[144:147], a[44:47], v[100:103]
    ds_read_b64_tr_b16 v[134:135], v217 offset:26624
    v_mfma_f32_16x16x32_bf16 v[8:11], v[148:151], a[32:35], v[8:11]
    ds_read_b64_tr_b16 v[136:137], v218 offset:24576
    v_mfma_f32_16x16x32_bf16 v[12:15], v[148:151], a[36:39], v[12:15]
    ds_read_b64_tr_b16 v[138:139], v218 offset:26624
    v_mfma_f32_16x16x32_bf16 v[104:107], v[148:151], a[40:43], v[104:107]
    ds_read_b64_tr_b16 v[140:141], v219 offset:24576
    v_mfma_f32_16x16x32_bf16 v[108:111], v[148:151], a[44:47], v[108:111]
    ds_read_b64_tr_b16 v[142:143], v219 offset:26624
    v_mfma_f32_16x16x32_bf16 v[16:19], v[152:155], a[32:35], v[16:19]
    buffer_load_dwordx4 a[116:119], v227, s[8:11], s35 offen offset:3072 sc1
    v_mfma_f32_16x16x32_bf16 v[20:23], v[152:155], a[36:39], v[20:23]
    v_mfma_f32_16x16x32_bf16 v[112:115], v[152:155], a[40:43], v[112:115]
    v_mfma_f32_16x16x32_bf16 v[116:119], v[152:155], a[44:47], v[116:119]
    v_mfma_f32_16x16x32_bf16 v[24:27], v[156:159], a[32:35], v[24:27]
    buffer_load_dwordx4 a[120:123], v245, s[8:11], s35 offen offset:3072 sc1
    v_mfma_f32_16x16x32_bf16 v[28:31], v[156:159], a[36:39], v[28:31]
    v_mfma_f32_16x16x32_bf16 v[120:123], v[156:159], a[40:43], v[120:123]
    v_mfma_f32_16x16x32_bf16 v[124:127], v[156:159], a[44:47], v[124:127]
    s_waitcnt vmcnt(15) lgkmcnt(0)
    v_mfma_f32_16x16x32_bf16 v[32:35], v[128:131], a[48:51], v[32:35]
    ds_read_b64_tr_b16 v[144:145], v220 offset:24576
    v_mfma_f32_16x16x32_bf16 v[36:39], v[128:131], a[52:55], v[36:39]
    ds_read_b64_tr_b16 v[146:147], v220 offset:26624
    v_mfma_f32_16x16x32_bf16 v[64:67], v[128:131], a[56:59], v[64:67]
    ds_read_b64_tr_b16 v[148:149], v221 offset:24576
    v_mfma_f32_16x16x32_bf16 v[68:71], v[128:131], a[60:63], v[68:71]
    ds_read_b64_tr_b16 v[150:151], v221 offset:26624
    v_mfma_f32_16x16x32_bf16 v[40:43], v[132:135], a[48:51], v[40:43]
    ds_read_b64_tr_b16 v[152:153], v222 offset:24576
    v_mfma_f32_16x16x32_bf16 v[44:47], v[132:135], a[52:55], v[44:47]
    ds_read_b64_tr_b16 v[154:155], v222 offset:26624
    v_mfma_f32_16x16x32_bf16 v[72:75], v[132:135], a[56:59], v[72:75]
    ds_read_b64_tr_b16 v[156:157], v223 offset:24576
    v_mfma_f32_16x16x32_bf16 v[76:79], v[132:135], a[60:63], v[76:79]
    ds_read_b64_tr_b16 v[158:159], v223 offset:26624
    v_mfma_f32_16x16x32_bf16 v[48:51], v[136:139], a[48:51], v[48:51]
    buffer_load_dwordx4 a[124:127], v246, s[8:11], s35 offen offset:3072 sc1
    v_mfma_f32_16x16x32_bf16 v[52:55], v[136:139], a[52:55], v[52:55]
    v_mfma_f32_16x16x32_bf16 v[80:83], v[136:139], a[56:59], v[80:83]
    v_mfma_f32_16x16x32_bf16 v[84:87], v[136:139], a[60:63], v[84:87]
    s_add_u32 s35, s35, 4096
    buffer_load_dwordx4 a[0:3], v226, s[8:11], s35 offen offset:0 sc1
    v_mfma_f32_16x16x32_bf16 v[56:59], v[140:143], a[48:51], v[56:59]
    v_mfma_f32_16x16x32_bf16 v[60:63], v[140:143], a[52:55], v[60:63]
    v_mfma_f32_16x16x32_bf16 v[88:91], v[140:143], a[56:59], v[88:91]
    v_mfma_f32_16x16x32_bf16 v[92:95], v[140:143], a[60:63], v[92:95]
    buffer_load_dwordx4 a[4:7], v227, s[8:11], s35 offen offset:0 sc1
    s_waitcnt lgkmcnt(0)
    s_barrier
    v_mfma_f32_16x16x32_bf16 v[0:3], v[144:147], a[48:51], v[0:3]
    ds_read_b64_tr_b16 v[128:129], v216 offset:32768
    v_mfma_f32_16x16x32_bf16 v[4:7], v[144:147], a[52:55], v[4:7]
    ds_read_b64_tr_b16 v[130:131], v216 offset:34816
    v_mfma_f32_16x16x32_bf16 v[96:99], v[144:147], a[56:59], v[96:99]
    ds_read_b64_tr_b16 v[132:133], v216 offset:40960
    v_mfma_f32_16x16x32_bf16 v[100:103], v[144:147], a[60:63], v[100:103]
    ds_read_b64_tr_b16 v[134:135], v216 offset:43008
    v_mfma_f32_16x16x32_bf16 v[8:11], v[148:151], a[48:51], v[8:11]
    ds_read_b64_tr_b16 v[136:137], v217 offset:32768
    v_mfma_f32_16x16x32_bf16 v[12:15], v[148:151], a[52:55], v[12:15]
    ds_read_b64_tr_b16 v[138:139], v217 offset:34816
    v_mfma_f32_16x16x32_bf16 v[104:107], v[148:151], a[56:59], v[104:107]
    ds_read_b64_tr_b16 v[140:141], v217 offset:40960
    v_mfma_f32_16x16x32_bf16 v[108:111], v[148:151], a[60:63], v[108:111]
    ds_read_b64_tr_b16 v[142:143], v217 offset:43008
    v_mfma_f32_16x16x32_bf16 v[16:19], v[152:155], a[48:51], v[16:19]
    buffer_load_dwordx4 a[8:11], v245, s[8:11], s35 offen offset:0 sc1
    v_mfma_f32_16x16x32_bf16 v[20:23], v[152:155], a[52:55], v[20:23]
    v_mfma_f32_16x16x32_bf16 v[112:115], v[152:155], a[56:59], v[112:115]
    v_mfma_f32_16x16x32_bf16 v[116:119], v[152:155], a[60:63], v[116:119]
    v_mfma_f32_16x16x32_bf16 v[24:27], v[156:159], a[48:51], v[24:27]
    buffer_load_dwordx4 a[12:15], v246, s[8:11], s35 offen offset:0 sc1
    v_mfma_f32_16x16x32_bf16 v[28:31], v[156:159], a[52:55], v[28:31]
    v_mfma_f32_16x16x32_bf16 v[120:123], v[156:159], a[56:59], v[120:123]
    v_mfma_f32_16x16x32_bf16 v[124:127], v[156:159], a[60:63], v[124:127]
    s_waitcnt vmcnt(12) lgkmcnt(0)
    v_mfma_f32_16x16x32_bf16 v[32:35], v[128:131], a[64:67], v[32:35]
    ds_read_b64_tr_b16 v[144:145], v218 offset:32768
    v_mfma_f32_16x16x32_bf16 v[32:35], v[132:135], a[80:83], v[32:35]
    ds_read_b64_tr_b16 v[146:147], v218 offset:34816
    v_mfma_f32_16x16x32_bf16 v[36:39], v[128:131], a[68:71], v[36:39]
    ds_read_b64_tr_b16 v[148:149], v218 offset:40960
    v_mfma_f32_16x16x32_bf16 v[36:39], v[132:135], a[84:87], v[36:39]
    ds_read_b64_tr_b16 v[150:151], v218 offset:43008
    v_mfma_f32_16x16x32_bf16 v[64:67], v[128:131], a[72:75], v[64:67]
    ds_read_b64_tr_b16 v[152:153], v219 offset:32768
    v_mfma_f32_16x16x32_bf16 v[64:67], v[132:135], a[88:91], v[64:67]
    ds_read_b64_tr_b16 v[154:155], v219 offset:34816
    v_mfma_f32_16x16x32_bf16 v[68:71], v[128:131], a[76:79], v[68:71]
    ds_read_b64_tr_b16 v[156:157], v219 offset:40960
    v_mfma_f32_16x16x32_bf16 v[68:71], v[132:135], a[92:95], v[68:71]
    ds_read_b64_tr_b16 v[158:159], v219 offset:43008
    v_mfma_f32_16x16x32_bf16 v[40:43], v[136:139], a[64:67], v[40:43]
    buffer_load_dwordx4 a[16:19], v226, s[8:11], s35 offen offset:1024 sc1
    v_mfma_f32_16x16x32_bf16 v[40:43], v[140:143], a[80:83], v[40:43]
    s_add_u32 m0, s38, 0
    s_add_u32 s32, s37, 1048576
    v_mfma_f32_16x16x32_bf16 v[44:47], v[136:139], a[68:71], v[44:47]
    buffer_load_dwordx4 v224, s[12:15], s32 offen lds
    v_mfma_f32_16x16x32_bf16 v[44:47], v[140:143], a[84:87], v[44:47]
    buffer_load_dwordx4 a[20:23], v227, s[8:11], s35 offen offset:1024 sc1
    v_mfma_f32_16x16x32_bf16 v[72:75], v[136:139], a[72:75], v[72:75]
    v_mfma_f32_16x16x32_bf16 v[72:75], v[140:143], a[88:91], v[72:75]
    buffer_load_dwordx4 v225, s[12:15], s32 offen offset:1024 lds
    v_mfma_f32_16x16x32_bf16 v[76:79], v[136:139], a[76:79], v[76:79]
    v_mfma_f32_16x16x32_bf16 v[76:79], v[140:143], a[92:95], v[76:79]
    s_waitcnt lgkmcnt(0)
    v_mfma_f32_16x16x32_bf16 v[48:51], v[144:147], a[64:67], v[48:51]
    ds_read_b64_tr_b16 v[128:129], v220 offset:32768
    v_mfma_f32_16x16x32_bf16 v[48:51], v[148:151], a[80:83], v[48:51]
    ds_read_b64_tr_b16 v[130:131], v220 offset:34816
    v_mfma_f32_16x16x32_bf16 v[52:55], v[144:147], a[68:71], v[52:55]
    ds_read_b64_tr_b16 v[132:133], v220 offset:40960
    v_mfma_f32_16x16x32_bf16 v[52:55], v[148:151], a[84:87], v[52:55]
    ds_read_b64_tr_b16 v[134:135], v220 offset:43008
    v_mfma_f32_16x16x32_bf16 v[80:83], v[144:147], a[72:75], v[80:83]
    ds_read_b64_tr_b16 v[136:137], v221 offset:32768
    v_mfma_f32_16x16x32_bf16 v[80:83], v[148:151], a[88:91], v[80:83]
    ds_read_b64_tr_b16 v[138:139], v221 offset:34816
    v_mfma_f32_16x16x32_bf16 v[84:87], v[144:147], a[76:79], v[84:87]
    ds_read_b64_tr_b16 v[140:141], v221 offset:40960
    v_mfma_f32_16x16x32_bf16 v[84:87], v[148:151], a[92:95], v[84:87]
    ds_read_b64_tr_b16 v[142:143], v221 offset:43008
    v_mfma_f32_16x16x32_bf16 v[56:59], v[152:155], a[64:67], v[56:59]
    buffer_load_dwordx4 a[24:27], v245, s[8:11], s35 offen offset:1024 sc1
    v_mfma_f32_16x16x32_bf16 v[56:59], v[156:159], a[80:83], v[56:59]
    v_mfma_f32_16x16x32_bf16 v[60:63], v[152:155], a[68:71], v[60:63]
    buffer_load_dwordx4 a[28:31], v246, s[8:11], s35 offen offset:1024 sc1
    v_mfma_f32_16x16x32_bf16 v[60:63], v[156:159], a[84:87], v[60:63]
    v_mfma_f32_16x16x32_bf16 v[88:91], v[152:155], a[72:75], v[88:91]
    v_mfma_f32_16x16x32_bf16 v[88:91], v[156:159], a[88:91], v[88:91]
    v_mfma_f32_16x16x32_bf16 v[92:95], v[152:155], a[76:79], v[92:95]
    v_mfma_f32_16x16x32_bf16 v[92:95], v[156:159], a[92:95], v[92:95]
    buffer_load_dwordx4 a[32:35], v226, s[8:11], s35 offen offset:2048 sc1
    s_waitcnt lgkmcnt(0)
    v_mfma_f32_16x16x32_bf16 v[0:3], v[128:131], a[64:67], v[0:3]
    ds_read_b64_tr_b16 v[144:145], v222 offset:32768
    v_mfma_f32_16x16x32_bf16 v[0:3], v[132:135], a[80:83], v[0:3]
    ds_read_b64_tr_b16 v[146:147], v222 offset:34816
    v_mfma_f32_16x16x32_bf16 v[4:7], v[128:131], a[68:71], v[4:7]
    ds_read_b64_tr_b16 v[148:149], v222 offset:40960
    v_mfma_f32_16x16x32_bf16 v[4:7], v[132:135], a[84:87], v[4:7]
    ds_read_b64_tr_b16 v[150:151], v222 offset:43008
    v_mfma_f32_16x16x32_bf16 v[96:99], v[128:131], a[72:75], v[96:99]
    ds_read_b64_tr_b16 v[152:153], v223 offset:32768
    v_mfma_f32_16x16x32_bf16 v[96:99], v[132:135], a[88:91], v[96:99]
    ds_read_b64_tr_b16 v[154:155], v223 offset:34816
    v_mfma_f32_16x16x32_bf16 v[100:103], v[128:131], a[76:79], v[100:103]
    ds_read_b64_tr_b16 v[156:157], v223 offset:40960
    v_mfma_f32_16x16x32_bf16 v[100:103], v[132:135], a[92:95], v[100:103]
    ds_read_b64_tr_b16 v[158:159], v223 offset:43008
    v_mfma_f32_16x16x32_bf16 v[8:11], v[136:139], a[64:67], v[8:11]
    buffer_load_dwordx4 a[36:39], v227, s[8:11], s35 offen offset:2048 sc1
    v_mfma_f32_16x16x32_bf16 v[8:11], v[140:143], a[80:83], v[8:11]
    s_add_u32 m0, s38, 8192
    s_add_u32 s32, s37, 1114112
    v_mfma_f32_16x16x32_bf16 v[12:15], v[136:139], a[68:71], v[12:15]
    buffer_load_dwordx4 v224, s[12:15], s32 offen lds
    v_mfma_f32_16x16x32_bf16 v[12:15], v[140:143], a[84:87], v[12:15]
    buffer_load_dwordx4 a[40:43], v245, s[8:11], s35 offen offset:2048 sc1
    v_mfma_f32_16x16x32_bf16 v[104:107], v[136:139], a[72:75], v[104:107]
    v_mfma_f32_16x16x32_bf16 v[104:107], v[140:143], a[88:91], v[104:107]
    buffer_load_dwordx4 v225, s[12:15], s32 offen offset:1024 lds
    v_mfma_f32_16x16x32_bf16 v[108:111], v[136:139], a[76:79], v[108:111]
    v_mfma_f32_16x16x32_bf16 v[108:111], v[140:143], a[92:95], v[108:111]
    s_waitcnt lgkmcnt(0)
    v_mfma_f32_16x16x32_bf16 v[16:19], v[144:147], a[64:67], v[16:19]
    ds_read_b64_tr_b16 v[128:129], v216 offset:49152
    v_mfma_f32_16x16x32_bf16 v[16:19], v[148:151], a[80:83], v[16:19]
    ds_read_b64_tr_b16 v[130:131], v216 offset:51200
    v_mfma_f32_16x16x32_bf16 v[20:23], v[144:147], a[68:71], v[20:23]
    ds_read_b64_tr_b16 v[132:133], v216 offset:57344
    v_mfma_f32_16x16x32_bf16 v[20:23], v[148:151], a[84:87], v[20:23]
    ds_read_b64_tr_b16 v[134:135], v216 offset:59392
    v_mfma_f32_16x16x32_bf16 v[112:115], v[144:147], a[72:75], v[112:115]
    ds_read_b64_tr_b16 v[136:137], v217 offset:49152
    v_mfma_f32_16x16x32_bf16 v[112:115], v[148:151], a[88:91], v[112:115]
    ds_read_b64_tr_b16 v[138:139], v217 offset:51200
    v_mfma_f32_16x16x32_bf16 v[116:119], v[144:147], a[76:79], v[116:119]
    ds_read_b64_tr_b16 v[140:141], v217 offset:57344
    v_mfma_f32_16x16x32_bf16 v[116:119], v[148:151], a[92:95], v[116:119]
    ds_read_b64_tr_b16 v[142:143], v217 offset:59392
    v_mfma_f32_16x16x32_bf16 v[24:27], v[152:155], a[64:67], v[24:27]
    buffer_load_dwordx4 a[44:47], v246, s[8:11], s35 offen offset:2048 sc1
    v_mfma_f32_16x16x32_bf16 v[24:27], v[156:159], a[80:83], v[24:27]
    v_mfma_f32_16x16x32_bf16 v[28:31], v[152:155], a[68:71], v[28:31]
    buffer_load_dwordx4 a[48:51], v226, s[8:11], s35 offen offset:3072 sc1
    v_mfma_f32_16x16x32_bf16 v[28:31], v[156:159], a[84:87], v[28:31]
    v_mfma_f32_16x16x32_bf16 v[120:123], v[152:155], a[72:75], v[120:123]
    v_mfma_f32_16x16x32_bf16 v[120:123], v[156:159], a[88:91], v[120:123]
    v_mfma_f32_16x16x32_bf16 v[124:127], v[152:155], a[76:79], v[124:127]
    v_mfma_f32_16x16x32_bf16 v[124:127], v[156:159], a[92:95], v[124:127]
    buffer_load_dwordx4 a[52:55], v227, s[8:11], s35 offen offset:3072 sc1
    s_waitcnt vmcnt(18) lgkmcnt(0)
    v_mfma_f32_16x16x32_bf16 v[32:35], v[128:131], a[96:99], v[32:35]
    ds_read_b64_tr_b16 v[144:145], v218 offset:49152
    v_mfma_f32_16x16x32_bf16 v[32:35], v[132:135], a[112:115], v[32:35]
    ds_read_b64_tr_b16 v[146:147], v218 offset:51200
    v_mfma_f32_16x16x32_bf16 v[36:39], v[128:131], a[100:103], v[36:39]
    ds_read_b64_tr_b16 v[148:149], v218 offset:57344
    v_mfma_f32_16x16x32_bf16 v[36:39], v[132:135], a[116:119], v[36:39]
    ds_read_b64_tr_b16 v[150:151], v218 offset:59392
    v_mfma_f32_16x16x32_bf16 v[64:67], v[128:131], a[104:107], v[64:67]
    ds_read_b64_tr_b16 v[152:153], v219 offset:49152
    v_mfma_f32_16x16x32_bf16 v[64:67], v[132:135], a[120:123], v[64:67]
    ds_read_b64_tr_b16 v[154:155], v219 offset:51200
    v_mfma_f32_16x16x32_bf16 v[68:71], v[128:131], a[108:111], v[68:71]
    ds_read_b64_tr_b16 v[156:157], v219 offset:57344
    v_mfma_f32_16x16x32_bf16 v[68:71], v[132:135], a[124:127], v[68:71]
    ds_read_b64_tr_b16 v[158:159], v219 offset:59392
    v_mfma_f32_16x16x32_bf16 v[40:43], v[136:139], a[96:99], v[40:43]
    buffer_load_dwordx4 a[56:59], v245, s[8:11], s35 offen offset:3072 sc1
    v_mfma_f32_16x16x32_bf16 v[40:43], v[140:143], a[112:115], v[40:43]
    s_add_u32 m0, s38, 16384
    s_add_u32 s32, s37, 1179648
    v_mfma_f32_16x16x32_bf16 v[44:47], v[136:139], a[100:103], v[44:47]
    buffer_load_dwordx4 v224, s[12:15], s32 offen lds
    v_mfma_f32_16x16x32_bf16 v[44:47], v[140:143], a[116:119], v[44:47]
    buffer_load_dwordx4 a[60:63], v246, s[8:11], s35 offen offset:3072 sc1
    v_mfma_f32_16x16x32_bf16 v[72:75], v[136:139], a[104:107], v[72:75]
    v_mfma_f32_16x16x32_bf16 v[72:75], v[140:143], a[120:123], v[72:75]
    buffer_load_dwordx4 v225, s[12:15], s32 offen offset:1024 lds
    v_mfma_f32_16x16x32_bf16 v[76:79], v[136:139], a[108:111], v[76:79]
    v_mfma_f32_16x16x32_bf16 v[76:79], v[140:143], a[124:127], v[76:79]
    s_waitcnt lgkmcnt(0)
    v_mfma_f32_16x16x32_bf16 v[48:51], v[144:147], a[96:99], v[48:51]
    ds_read_b64_tr_b16 v[128:129], v220 offset:49152
    v_mfma_f32_16x16x32_bf16 v[48:51], v[148:151], a[112:115], v[48:51]
    ds_read_b64_tr_b16 v[130:131], v220 offset:51200
    v_mfma_f32_16x16x32_bf16 v[52:55], v[144:147], a[100:103], v[52:55]
    ds_read_b64_tr_b16 v[132:133], v220 offset:57344
    v_mfma_f32_16x16x32_bf16 v[52:55], v[148:151], a[116:119], v[52:55]
    ds_read_b64_tr_b16 v[134:135], v220 offset:59392
    v_mfma_f32_16x16x32_bf16 v[80:83], v[144:147], a[104:107], v[80:83]
    ds_read_b64_tr_b16 v[136:137], v221 offset:49152
    v_mfma_f32_16x16x32_bf16 v[80:83], v[148:151], a[120:123], v[80:83]
    ds_read_b64_tr_b16 v[138:139], v221 offset:51200
    v_mfma_f32_16x16x32_bf16 v[84:87], v[144:147], a[108:111], v[84:87]
    ds_read_b64_tr_b16 v[140:141], v221 offset:57344
    v_mfma_f32_16x16x32_bf16 v[84:87], v[148:151], a[124:127], v[84:87]
    ds_read_b64_tr_b16 v[142:143], v221 offset:59392
    v_mfma_f32_16x16x32_bf16 v[56:59], v[152:155], a[96:99], v[56:59]
    s_add_u32 s35, s35, 4096
    buffer_load_dwordx4 a[64:67], v226, s[8:11], s35 offen offset:0 sc1
    v_mfma_f32_16x16x32_bf16 v[56:59], v[156:159], a[112:115], v[56:59]
    v_mfma_f32_16x16x32_bf16 v[60:63], v[152:155], a[100:103], v[60:63]
    buffer_load_dwordx4 a[68:71], v227, s[8:11], s35 offen offset:0 sc1
    v_mfma_f32_16x16x32_bf16 v[60:63], v[156:159], a[116:119], v[60:63]
    v_mfma_f32_16x16x32_bf16 v[88:91], v[152:155], a[104:107], v[88:91]
    v_mfma_f32_16x16x32_bf16 v[88:91], v[156:159], a[120:123], v[88:91]
    v_mfma_f32_16x16x32_bf16 v[92:95], v[152:155], a[108:111], v[92:95]
    v_mfma_f32_16x16x32_bf16 v[92:95], v[156:159], a[124:127], v[92:95]
    buffer_load_dwordx4 a[72:75], v245, s[8:11], s35 offen offset:0 sc1
    s_waitcnt lgkmcnt(0)
    v_mfma_f32_16x16x32_bf16 v[0:3], v[128:131], a[96:99], v[0:3]
    ds_read_b64_tr_b16 v[144:145], v222 offset:49152
    v_mfma_f32_16x16x32_bf16 v[0:3], v[132:135], a[112:115], v[0:3]
    ds_read_b64_tr_b16 v[146:147], v222 offset:51200
    v_mfma_f32_16x16x32_bf16 v[4:7], v[128:131], a[100:103], v[4:7]
    ds_read_b64_tr_b16 v[148:149], v222 offset:57344
    v_mfma_f32_16x16x32_bf16 v[4:7], v[132:135], a[116:119], v[4:7]
    ds_read_b64_tr_b16 v[150:151], v222 offset:59392
    v_mfma_f32_16x16x32_bf16 v[96:99], v[128:131], a[104:107], v[96:99]
    ds_read_b64_tr_b16 v[152:153], v223 offset:49152
    v_mfma_f32_16x16x32_bf16 v[96:99], v[132:135], a[120:123], v[96:99]
    ds_read_b64_tr_b16 v[154:155], v223 offset:51200
    v_mfma_f32_16x16x32_bf16 v[100:103], v[128:131], a[108:111], v[100:103]
    ds_read_b64_tr_b16 v[156:157], v223 offset:57344
    v_mfma_f32_16x16x32_bf16 v[100:103], v[132:135], a[124:127], v[100:103]
    ds_read_b64_tr_b16 v[158:159], v223 offset:59392
    v_mfma_f32_16x16x32_bf16 v[8:11], v[136:139], a[96:99], v[8:11]
    buffer_load_dwordx4 a[76:79], v246, s[8:11], s35 offen offset:0 sc1
    v_mfma_f32_16x16x32_bf16 v[8:11], v[140:143], a[112:115], v[8:11]
    s_add_u32 m0, s38, 24576
    s_add_u32 s32, s37, 1245184
    v_mfma_f32_16x16x32_bf16 v[12:15], v[136:139], a[100:103], v[12:15]
    buffer_load_dwordx4 v224, s[12:15], s32 offen lds
    v_mfma_f32_16x16x32_bf16 v[12:15], v[140:143], a[116:119], v[12:15]
    v_mfma_f32_16x16x32_bf16 v[104:107], v[136:139], a[104:107], v[104:107]
    v_mfma_f32_16x16x32_bf16 v[104:107], v[140:143], a[120:123], v[104:107]
    buffer_load_dwordx4 v225, s[12:15], s32 offen offset:1024 lds
    v_mfma_f32_16x16x32_bf16 v[108:111], v[136:139], a[108:111], v[108:111]
    v_mfma_f32_16x16x32_bf16 v[108:111], v[140:143], a[124:127], v[108:111]
    buffer_load_dwordx4 a[80:83], v226, s[8:11], s35 offen offset:1024 sc1
    s_waitcnt lgkmcnt(0)
    s_barrier
    v_mfma_f32_16x16x32_bf16 v[16:19], v[144:147], a[96:99], v[16:19]
    v_xor_b32 v216, 0x10000, v216
    ds_read_b64_tr_b16 v[128:129], v216 offset:0
    v_mfma_f32_16x16x32_bf16 v[16:19], v[148:151], a[112:115], v[16:19]
    ds_read_b64_tr_b16 v[130:131], v216 offset:2048
    v_mfma_f32_16x16x32_bf16 v[20:23], v[144:147], a[100:103], v[20:23]
    ds_read_b64_tr_b16 v[132:133], v216 offset:8192
    v_mfma_f32_16x16x32_bf16 v[20:23], v[148:151], a[116:119], v[20:23]
    ds_read_b64_tr_b16 v[134:135], v216 offset:10240
    v_mfma_f32_16x16x32_bf16 v[112:115], v[144:147], a[104:107], v[112:115]
    v_xor_b32 v217, 0x10000, v217
    ds_read_b64_tr_b16 v[136:137], v217 offset:0
    v_mfma_f32_16x16x32_bf16 v[112:115], v[148:151], a[120:123], v[112:115]
    ds_read_b64_tr_b16 v[138:139], v217 offset:2048
    v_mfma_f32_16x16x32_bf16 v[116:119], v[144:147], a[108:111], v[116:119]
    ds_read_b64_tr_b16 v[140:141], v217 offset:8192
    v_mfma_f32_16x16x32_bf16 v[116:119], v[148:151], a[124:127], v[116:119]
    ds_read_b64_tr_b16 v[142:143], v217 offset:10240
    v_mfma_f32_16x16x32_bf16 v[24:27], v[152:155], a[96:99], v[24:27]
    buffer_load_dwordx4 a[84:87], v227, s[8:11], s35 offen offset:1024 sc1
    v_mfma_f32_16x16x32_bf16 v[24:27], v[156:159], a[112:115], v[24:27]
    v_mfma_f32_16x16x32_bf16 v[28:31], v[152:155], a[100:103], v[28:31]
    buffer_load_dwordx4 a[88:91], v245, s[8:11], s35 offen offset:1024 sc1
    v_mfma_f32_16x16x32_bf16 v[28:31], v[156:159], a[116:119], v[28:31]
    v_mfma_f32_16x16x32_bf16 v[120:123], v[152:155], a[104:107], v[120:123]
    v_mfma_f32_16x16x32_bf16 v[120:123], v[156:159], a[120:123], v[120:123]
    v_mfma_f32_16x16x32_bf16 v[124:127], v[152:155], a[108:111], v[124:127]
    v_mfma_f32_16x16x32_bf16 v[124:127], v[156:159], a[124:127], v[124:127]
    s_waitcnt vmcnt(21) lgkmcnt(0)
    v_mfma_f32_16x16x32_bf16 v[32:35], v[128:131], a[0:3], v[32:35]
    v_xor_b32 v218, 0x10000, v218
    ds_read_b64_tr_b16 v[144:145], v218 offset:0
    v_mfma_f32_16x16x32_bf16 v[32:35], v[132:135], a[16:19], v[32:35]
    ds_read_b64_tr_b16 v[146:147], v218 offset:2048
    v_mfma_f32_16x16x32_bf16 v[36:39], v[128:131], a[4:7], v[36:39]
    ds_read_b64_tr_b16 v[148:149], v218 offset:8192
    v_mfma_f32_16x16x32_bf16 v[36:39], v[132:135], a[20:23], v[36:39]
    ds_read_b64_tr_b16 v[150:151], v218 offset:10240
    v_mfma_f32_16x16x32_bf16 v[64:67], v[128:131], a[8:11], v[64:67]
    v_xor_b32 v219, 0x10000, v219
    ds_read_b64_tr_b16 v[152:153], v219 offset:0
    v_mfma_f32_16x16x32_bf16 v[64:67], v[132:135], a[24:27], v[64:67]
    ds_read_b64_tr_b16 v[154:155], v219 offset:2048
    v_mfma_f32_16x16x32_bf16 v[68:71], v[128:131], a[12:15], v[68:71]
    ds_read_b64_tr_b16 v[156:157], v219 offset:8192
    v_mfma_f32_16x16x32_bf16 v[68:71], v[132:135], a[28:31], v[68:71]
    ds_read_b64_tr_b16 v[158:159], v219 offset:10240
    v_mfma_f32_16x16x32_bf16 v[40:43], v[136:139], a[0:3], v[40:43]
    buffer_load_dwordx4 a[92:95], v246, s[8:11], s35 offen offset:1024 sc1
    v_mfma_f32_16x16x32_bf16 v[40:43], v[140:143], a[16:19], v[40:43]
    s_add_u32 m0, s38, 32768
    s_add_u32 s32, s37, 1310720
    v_mfma_f32_16x16x32_bf16 v[44:47], v[136:139], a[4:7], v[44:47]
    buffer_load_dwordx4 v224, s[12:15], s32 offen lds
    v_mfma_f32_16x16x32_bf16 v[44:47], v[140:143], a[20:23], v[44:47]
    buffer_load_dwordx4 a[96:99], v226, s[8:11], s35 offen offset:2048 sc1
    v_mfma_f32_16x16x32_bf16 v[72:75], v[136:139], a[8:11], v[72:75]
    v_mfma_f32_16x16x32_bf16 v[72:75], v[140:143], a[24:27], v[72:75]
    buffer_load_dwordx4 v225, s[12:15], s32 offen offset:1024 lds
    v_mfma_f32_16x16x32_bf16 v[76:79], v[136:139], a[12:15], v[76:79]
    s_lshl_b32 s45, s52, 7
    s_add_u32 s45, s45, 0x38a1400
    v_mfma_f32_16x16x32_bf16 v[76:79], v[140:143], a[28:31], v[76:79]
    buffer_load_dwordx4 a[100:103], v227, s[8:11], s35 offen offset:2048 sc1
    s_waitcnt lgkmcnt(0)
    v_mfma_f32_16x16x32_bf16 v[48:51], v[144:147], a[0:3], v[48:51]
    v_xor_b32 v220, 0x10000, v220
    ds_read_b64_tr_b16 v[128:129], v220 offset:0
    v_mfma_f32_16x16x32_bf16 v[48:51], v[148:151], a[16:19], v[48:51]
    ds_read_b64_tr_b16 v[130:131], v220 offset:2048
    v_mfma_f32_16x16x32_bf16 v[52:55], v[144:147], a[4:7], v[52:55]
    ds_read_b64_tr_b16 v[132:133], v220 offset:8192
    v_mfma_f32_16x16x32_bf16 v[52:55], v[148:151], a[20:23], v[52:55]
    ds_read_b64_tr_b16 v[134:135], v220 offset:10240
    v_mfma_f32_16x16x32_bf16 v[80:83], v[144:147], a[8:11], v[80:83]
    v_xor_b32 v221, 0x10000, v221
    ds_read_b64_tr_b16 v[136:137], v221 offset:0
    v_mfma_f32_16x16x32_bf16 v[80:83], v[148:151], a[24:27], v[80:83]
    ds_read_b64_tr_b16 v[138:139], v221 offset:2048
    v_mfma_f32_16x16x32_bf16 v[84:87], v[144:147], a[12:15], v[84:87]
    ds_read_b64_tr_b16 v[140:141], v221 offset:8192
    v_mfma_f32_16x16x32_bf16 v[84:87], v[148:151], a[28:31], v[84:87]
    ds_read_b64_tr_b16 v[142:143], v221 offset:10240
    v_mfma_f32_16x16x32_bf16 v[56:59], v[152:155], a[0:3], v[56:59]
    buffer_load_dwordx4 a[104:107], v245, s[8:11], s35 offen offset:2048 sc1
    v_mfma_f32_16x16x32_bf16 v[56:59], v[156:159], a[16:19], v[56:59]
    s_cmp_eq_u32 s3, 0
    s_cselect_b32 s45, s45, 0x40000000
    v_mfma_f32_16x16x32_bf16 v[60:63], v[152:155], a[4:7], v[60:63]
    buffer_load_dwordx4 a[108:111], v246, s[8:11], s35 offen offset:2048 sc1
    buffer_load_dword v235, off, s[8:11], s45 sc1
    v_mfma_f32_16x16x32_bf16 v[60:63], v[156:159], a[20:23], v[60:63]
    v_mfma_f32_16x16x32_bf16 v[88:91], v[152:155], a[8:11], v[88:91]
    v_mfma_f32_16x16x32_bf16 v[88:91], v[156:159], a[24:27], v[88:91]
    v_mfma_f32_16x16x32_bf16 v[92:95], v[152:155], a[12:15], v[92:95]
    v_mfma_f32_16x16x32_bf16 v[92:95], v[156:159], a[28:31], v[92:95]
    s_waitcnt lgkmcnt(0)
    v_mfma_f32_16x16x32_bf16 v[0:3], v[128:131], a[0:3], v[0:3]
    v_xor_b32 v222, 0x10000, v222
    ds_read_b64_tr_b16 v[144:145], v222 offset:0
    v_mfma_f32_16x16x32_bf16 v[0:3], v[132:135], a[16:19], v[0:3]
    ds_read_b64_tr_b16 v[146:147], v222 offset:2048
    v_mfma_f32_16x16x32_bf16 v[4:7], v[128:131], a[4:7], v[4:7]
    ds_read_b64_tr_b16 v[148:149], v222 offset:8192
    v_mfma_f32_16x16x32_bf16 v[4:7], v[132:135], a[20:23], v[4:7]
    ds_read_b64_tr_b16 v[150:151], v222 offset:10240
    v_mfma_f32_16x16x32_bf16 v[96:99], v[128:131], a[8:11], v[96:99]
    v_xor_b32 v223, 0x10000, v223
    ds_read_b64_tr_b16 v[152:153], v223 offset:0
    v_mfma_f32_16x16x32_bf16 v[96:99], v[132:135], a[24:27], v[96:99]
    ds_read_b64_tr_b16 v[154:155], v223 offset:2048
    v_mfma_f32_16x16x32_bf16 v[100:103], v[128:131], a[12:15], v[100:103]
    ds_read_b64_tr_b16 v[156:157], v223 offset:8192
    v_mfma_f32_16x16x32_bf16 v[100:103], v[132:135], a[28:31], v[100:103]
    ds_read_b64_tr_b16 v[158:159], v223 offset:10240
    v_mfma_f32_16x16x32_bf16 v[8:11], v[136:139], a[0:3], v[8:11]
    buffer_load_dwordx4 a[112:115], v226, s[8:11], s35 offen offset:3072 sc1
    v_mfma_f32_16x16x32_bf16 v[8:11], v[140:143], a[16:19], v[8:11]
    s_add_u32 m0, s38, 40960
    s_add_u32 s32, s37, 1376256
    v_mfma_f32_16x16x32_bf16 v[12:15], v[136:139], a[4:7], v[12:15]
    buffer_load_dwordx4 v224, s[12:15], s32 offen lds
    v_mfma_f32_16x16x32_bf16 v[12:15], v[140:143], a[20:23], v[12:15]
    buffer_load_dwordx4 a[116:119], v227, s[8:11], s35 offen offset:3072 sc1
    v_mfma_f32_16x16x32_bf16 v[104:107], v[136:139], a[8:11], v[104:107]
    v_mfma_f32_16x16x32_bf16 v[104:107], v[140:143], a[24:27], v[104:107]
    buffer_load_dwordx4 v225, s[12:15], s32 offen offset:1024 lds
    v_mfma_f32_16x16x32_bf16 v[108:111], v[136:139], a[12:15], v[108:111]
    v_mfma_f32_16x16x32_bf16 v[108:111], v[140:143], a[28:31], v[108:111]
    buffer_load_dwordx4 a[120:123], v245, s[8:11], s35 offen offset:3072 sc1
    s_waitcnt lgkmcnt(0)
    v_mfma_f32_16x16x32_bf16 v[16:19], v[144:147], a[0:3], v[16:19]
    ds_read_b64_tr_b16 v[128:129], v216 offset:16384
    v_mfma_f32_16x16x32_bf16 v[16:19], v[148:151], a[16:19], v[16:19]
    ds_read_b64_tr_b16 v[130:131], v216 offset:18432
    v_mfma_f32_16x16x32_bf16 v[20:23], v[144:147], a[4:7], v[20:23]
    ds_read_b64_tr_b16 v[132:133], v216 offset:24576
    v_mfma_f32_16x16x32_bf16 v[20:23], v[148:151], a[20:23], v[20:23]
    ds_read_b64_tr_b16 v[134:135], v216 offset:26624
    v_mfma_f32_16x16x32_bf16 v[112:115], v[144:147], a[8:11], v[112:115]
    ds_read_b64_tr_b16 v[136:137], v217 offset:16384
    v_mfma_f32_16x16x32_bf16 v[112:115], v[148:151], a[24:27], v[112:115]
    ds_read_b64_tr_b16 v[138:139], v217 offset:18432
    v_mfma_f32_16x16x32_bf16 v[116:119], v[144:147], a[12:15], v[116:119]
    ds_read_b64_tr_b16 v[140:141], v217 offset:24576
    v_mfma_f32_16x16x32_bf16 v[116:119], v[148:151], a[28:31], v[116:119]
    ds_read_b64_tr_b16 v[142:143], v217 offset:26624
    v_mfma_f32_16x16x32_bf16 v[24:27], v[152:155], a[0:3], v[24:27]
    buffer_load_dwordx4 a[124:127], v246, s[8:11], s35 offen offset:3072 sc1
    v_mfma_f32_16x16x32_bf16 v[24:27], v[156:159], a[16:19], v[24:27]
    v_mfma_f32_16x16x32_bf16 v[28:31], v[152:155], a[4:7], v[28:31]
    v_mfma_f32_16x16x32_bf16 v[28:31], v[156:159], a[20:23], v[28:31]
    v_mfma_f32_16x16x32_bf16 v[120:123], v[152:155], a[8:11], v[120:123]
    v_mfma_f32_16x16x32_bf16 v[120:123], v[156:159], a[24:27], v[120:123]
    v_mfma_f32_16x16x32_bf16 v[124:127], v[152:155], a[12:15], v[124:127]
    v_mfma_f32_16x16x32_bf16 v[124:127], v[156:159], a[28:31], v[124:127]
    s_add_u32 s35, s35, 4096
    buffer_load_dwordx4 a[0:3], v226, s[8:11], s35 offen offset:0 sc1
    s_waitcnt vmcnt(25) lgkmcnt(0)
    v_mfma_f32_16x16x32_bf16 v[32:35], v[128:131], a[32:35], v[32:35]
    ds_read_b64_tr_b16 v[144:145], v218 offset:16384
    v_mfma_f32_16x16x32_bf16 v[32:35], v[132:135], a[48:51], v[32:35]
    ds_read_b64_tr_b16 v[146:147], v218 offset:18432
    v_mfma_f32_16x16x32_bf16 v[36:39], v[128:131], a[36:39], v[36:39]
    ds_read_b64_tr_b16 v[148:149], v218 offset:24576
    v_mfma_f32_16x16x32_bf16 v[36:39], v[132:135], a[52:55], v[36:39]
    ds_read_b64_tr_b16 v[150:151], v218 offset:26624
    v_mfma_f32_16x16x32_bf16 v[64:67], v[128:131], a[40:43], v[64:67]
    ds_read_b64_tr_b16 v[152:153], v219 offset:16384
    v_mfma_f32_16x16x32_bf16 v[64:67], v[132:135], a[56:59], v[64:67]
    ds_read_b64_tr_b16 v[154:155], v219 offset:18432
    v_mfma_f32_16x16x32_bf16 v[68:71], v[128:131], a[44:47], v[68:71]
    ds_read_b64_tr_b16 v[156:157], v219 offset:24576
    v_mfma_f32_16x16x32_bf16 v[68:71], v[132:135], a[60:63], v[68:71]
    ds_read_b64_tr_b16 v[158:159], v219 offset:26624
    v_mfma_f32_16x16x32_bf16 v[40:43], v[136:139], a[32:35], v[40:43]
    buffer_load_dwordx4 a[4:7], v227, s[8:11], s35 offen offset:0 sc1
    v_mfma_f32_16x16x32_bf16 v[40:43], v[140:143], a[48:51], v[40:43]
    s_add_u32 m0, s38, 49152
    s_add_u32 s32, s37, 1441792
    v_mfma_f32_16x16x32_bf16 v[44:47], v[136:139], a[36:39], v[44:47]
    buffer_load_dwordx4 v224, s[12:15], s32 offen lds
    v_mfma_f32_16x16x32_bf16 v[44:47], v[140:143], a[52:55], v[44:47]
    buffer_load_dwordx4 a[8:11], v245, s[8:11], s35 offen offset:0 sc1
    v_mfma_f32_16x16x32_bf16 v[72:75], v[136:139], a[40:43], v[72:75]
    v_mfma_f32_16x16x32_bf16 v[72:75], v[140:143], a[56:59], v[72:75]
    buffer_load_dwordx4 v225, s[12:15], s32 offen offset:1024 lds
    v_mfma_f32_16x16x32_bf16 v[76:79], v[136:139], a[44:47], v[76:79]
    v_mfma_f32_16x16x32_bf16 v[76:79], v[140:143], a[60:63], v[76:79]
    buffer_load_dwordx4 a[12:15], v246, s[8:11], s35 offen offset:0 sc1
    s_waitcnt lgkmcnt(0)
    v_mfma_f32_16x16x32_bf16 v[48:51], v[144:147], a[32:35], v[48:51]
    ds_read_b64_tr_b16 v[128:129], v220 offset:16384
    v_mfma_f32_16x16x32_bf16 v[48:51], v[148:151], a[48:51], v[48:51]
    ds_read_b64_tr_b16 v[130:131], v220 offset:18432
    v_mfma_f32_16x16x32_bf16 v[52:55], v[144:147], a[36:39], v[52:55]
    ds_read_b64_tr_b16 v[132:133], v220 offset:24576
    v_mfma_f32_16x16x32_bf16 v[52:55], v[148:151], a[52:55], v[52:55]
    ds_read_b64_tr_b16 v[134:135], v220 offset:26624
    v_mfma_f32_16x16x32_bf16 v[80:83], v[144:147], a[40:43], v[80:83]
    ds_read_b64_tr_b16 v[136:137], v221 offset:16384
    v_mfma_f32_16x16x32_bf16 v[80:83], v[148:151], a[56:59], v[80:83]
    ds_read_b64_tr_b16 v[138:139], v221 offset:18432
    v_mfma_f32_16x16x32_bf16 v[84:87], v[144:147], a[44:47], v[84:87]
    ds_read_b64_tr_b16 v[140:141], v221 offset:24576
    v_mfma_f32_16x16x32_bf16 v[84:87], v[148:151], a[60:63], v[84:87]
    ds_read_b64_tr_b16 v[142:143], v221 offset:26624
    v_mfma_f32_16x16x32_bf16 v[56:59], v[152:155], a[32:35], v[56:59]
    buffer_load_dwordx4 a[16:19], v226, s[8:11], s35 offen offset:1024 sc1
    v_mfma_f32_16x16x32_bf16 v[56:59], v[156:159], a[48:51], v[56:59]
    v_mfma_f32_16x16x32_bf16 v[60:63], v[152:155], a[36:39], v[60:63]
    v_mfma_f32_16x16x32_bf16 v[60:63], v[156:159], a[52:55], v[60:63]
    v_mfma_f32_16x16x32_bf16 v[88:91], v[152:155], a[40:43], v[88:91]
    buffer_load_dwordx4 a[20:23], v227, s[8:11], s35 offen offset:1024 sc1
    v_mfma_f32_16x16x32_bf16 v[88:91], v[156:159], a[56:59], v[88:91]
    v_mfma_f32_16x16x32_bf16 v[92:95], v[152:155], a[44:47], v[92:95]
    v_mfma_f32_16x16x32_bf16 v[92:95], v[156:159], a[60:63], v[92:95]
    s_waitcnt lgkmcnt(0)
    v_mfma_f32_16x16x32_bf16 v[0:3], v[128:131], a[32:35], v[0:3]
    ds_read_b64_tr_b16 v[144:145], v222 offset:16384
    v_mfma_f32_16x16x32_bf16 v[0:3], v[132:135], a[48:51], v[0:3]
    ds_read_b64_tr_b16 v[146:147], v222 offset:18432
    v_mfma_f32_16x16x32_bf16 v[4:7], v[128:131], a[36:39], v[4:7]
    ds_read_b64_tr_b16 v[148:149], v222 offset:24576
    v_mfma_f32_16x16x32_bf16 v[4:7], v[132:135], a[52:55], v[4:7]
    ds_read_b64_tr_b16 v[150:151], v222 offset:26624
    v_mfma_f32_16x16x32_bf16 v[96:99], v[128:131], a[40:43], v[96:99]
    ds_read_b64_tr_b16 v[152:153], v223 offset:16384
    v_mfma_f32_16x16x32_bf16 v[96:99], v[132:135], a[56:59], v[96:99]
    ds_read_b64_tr_b16 v[154:155], v223 offset:18432
    v_mfma_f32_16x16x32_bf16 v[100:103], v[128:131], a[44:47], v[100:103]
    ds_read_b64_tr_b16 v[156:157], v223 offset:24576
    v_mfma_f32_16x16x32_bf16 v[100:103], v[132:135], a[60:63], v[100:103]
    ds_read_b64_tr_b16 v[158:159], v223 offset:26624
    v_mfma_f32_16x16x32_bf16 v[8:11], v[136:139], a[32:35], v[8:11]
    buffer_load_dwordx4 a[24:27], v245, s[8:11], s35 offen offset:1024 sc1
    v_mfma_f32_16x16x32_bf16 v[8:11], v[140:143], a[48:51], v[8:11]
    s_add_u32 m0, s38, 57344
    s_add_u32 s32, s37, 1507328
    v_mfma_f32_16x16x32_bf16 v[12:15], v[136:139], a[36:39], v[12:15]
    buffer_load_dwordx4 v224, s[12:15], s32 offen lds
    v_mfma_f32_16x16x32_bf16 v[12:15], v[140:143], a[52:55], v[12:15]
    buffer_load_dwordx4 a[28:31], v246, s[8:11], s35 offen offset:1024 sc1
    v_mfma_f32_16x16x32_bf16 v[104:107], v[136:139], a[40:43], v[104:107]
    v_mfma_f32_16x16x32_bf16 v[104:107], v[140:143], a[56:59], v[104:107]
    buffer_load_dwordx4 v225, s[12:15], s32 offen offset:1024 lds
    v_mfma_f32_16x16x32_bf16 v[108:111], v[136:139], a[44:47], v[108:111]
    s_waitcnt vmcnt(18)
    v_readfirstlane_b32 s36, v235
    s_lshl_b32 s34, s3, 8
    s_add_u32 s36, s36, s34
    s_cmp_ge_u32 s36, 8
    s_cbranch_scc0 kc_g
kc_gr:
    v_mfma_f32_16x16x32_bf16 v[108:111], v[140:143], a[60:63], v[108:111]
    s_waitcnt lgkmcnt(0)
    s_barrier
    v_mfma_f32_16x16x32_bf16 v[16:19], v[144:147], a[32:35], v[16:19]
    ds_read_b64_tr_b16 v[128:129], v216 offset:32768
    v_mfma_f32_16x16x32_bf16 v[16:19], v[148:151], a[48:51], v[16:19]
    ds_read_b64_tr_b16 v[130:131], v216 offset:34816
    v_mfma_f32_16x16x32_bf16 v[20:23], v[144:147], a[36:39], v[20:23]
    ds_read_b64_tr_b16 v[132:133], v216 offset:40960
    v_mfma_f32_16x16x32_bf16 v[20:23], v[148:151], a[52:55], v[20:23]
    ds_read_b64_tr_b16 v[134:135], v216 offset:43008
    v_mfma_f32_16x16x32_bf16 v[112:115], v[144:147], a[40:43], v[112:115]
    ds_read_b64_tr_b16 v[136:137], v217 offset:32768
    v_mfma_f32_16x16x32_bf16 v[112:115], v[148:151], a[56:59], v[112:115]
    ds_read_b64_tr_b16 v[138:139], v217 offset:34816
    v_mfma_f32_16x16x32_bf16 v[116:119], v[144:147], a[44:47], v[116:119]
    ds_read_b64_tr_b16 v[140:141], v217 offset:40960
    v_mfma_f32_16x16x32_bf16 v[116:119], v[148:151], a[60:63], v[116:119]
    ds_read_b64_tr_b16 v[142:143], v217 offset:43008
    v_mfma_f32_16x16x32_bf16 v[24:27], v[152:155], a[32:35], v[24:27]
    v_mfma_f32_16x16x32_bf16 v[24:27], v[156:159], a[48:51], v[24:27]
    v_mfma_f32_16x16x32_bf16 v[28:31], v[152:155], a[36:39], v[28:31]
    v_mfma_f32_16x16x32_bf16 v[28:31], v[156:159], a[52:55], v[28:31]
    v_mfma_f32_16x16x32_bf16 v[120:123], v[152:155], a[40:43], v[120:123]
    v_mfma_f32_16x16x32_bf16 v[120:123], v[156:159], a[56:59], v[120:123]
    v_mfma_f32_16x16x32_bf16 v[124:127], v[152:155], a[44:47], v[124:127]
    v_mfma_f32_16x16x32_bf16 v[124:127], v[156:159], a[60:63], v[124:127]
    buffer_load_dwordx4 a[32:35], v226, s[8:11], s35 offen offset:2048 sc1
    s_waitcnt vmcnt(26) lgkmcnt(0)
    v_mfma_f32_16x16x32_bf16 v[32:35], v[128:131], a[64:67], v[32:35]
    ds_read_b64_tr_b16 v[144:145], v218 offset:32768
    v_mfma_f32_16x16x32_bf16 v[32:35], v[132:135], a[80:83], v[32:35]
    ds_read_b64_tr_b16 v[146:147], v218 offset:34816
    v_mfma_f32_16x16x32_bf16 v[36:39], v[128:131], a[68:71], v[36:39]
    ds_read_b64_tr_b16 v[148:149], v218 offset:40960
    v_mfma_f32_16x16x32_bf16 v[36:39], v[132:135], a[84:87], v[36:39]
    ds_read_b64_tr_b16 v[150:151], v218 offset:43008
    v_mfma_f32_16x16x32_bf16 v[64:67], v[128:131], a[72:75], v[64:67]
    ds_read_b64_tr_b16 v[152:153], v219 offset:32768
    v_mfma_f32_16x16x32_bf16 v[64:67], v[132:135], a[88:91], v[64:67]
    ds_read_b64_tr_b16 v[154:155], v219 offset:34816
    v_mfma_f32_16x16x32_bf16 v[68:71], v[128:131], a[76:79], v[68:71]
    ds_read_b64_tr_b16 v[156:157], v219 offset:40960
    v_mfma_f32_16x16x32_bf16 v[68:71], v[132:135], a[92:95], v[68:71]
    ds_read_b64_tr_b16 v[158:159], v219 offset:43008
    v_mfma_f32_16x16x32_bf16 v[40:43], v[136:139], a[64:67], v[40:43]
    buffer_load_dwordx4 a[36:39], v227, s[8:11], s35 offen offset:2048 sc1
    v_mfma_f32_16x16x32_bf16 v[40:43], v[140:143], a[80:83], v[40:43]
    s_add_u32 m0, s38, 65536
    s_add_u32 s32, s37, 1572864
    v_mfma_f32_16x16x32_bf16 v[44:47], v[136:139], a[68:71], v[44:47]
    buffer_load_dwordx4 v224, s[12:15], s32 offen lds
    v_mfma_f32_16x16x32_bf16 v[44:47], v[140:143], a[84:87], v[44:47]
    buffer_load_dwordx4 a[40:43], v245, s[8:11], s35 offen offset:2048 sc1
    v_mfma_f32_16x16x32_bf16 v[72:75], v[136:139], a[72:75], v[72:75]
    v_mfma_f32_16x16x32_bf16 v[72:75], v[140:143], a[88:91], v[72:75]
    buffer_load_dwordx4 v225, s[12:15], s32 offen offset:1024 lds
    v_mfma_f32_16x16x32_bf16 v[76:79], v[136:139], a[76:79], v[76:79]
    s_add_u32 s33, s55, 0
    buffer_load_dwordx4 a[128:131], v228, s[8:11], s33 offen offset:0 sc1
    v_mfma_f32_16x16x32_bf16 v[76:79], v[140:143], a[92:95], v[76:79]
    buffer_load_dwordx4 a[44:47], v246, s[8:11], s35 offen offset:2048 sc1
    s_waitcnt lgkmcnt(0)
    v_mfma_f32_16x16x32_bf16 v[48:51], v[144:147], a[64:67], v[48:51]
    ds_read_b64_tr_b16 v[128:129], v220 offset:32768
    v_mfma_f32_16x16x32_bf16 v[48:51], v[148:151], a[80:83], v[48:51]
    ds_read_b64_tr_b16 v[130:131], v220 offset:34816
    v_mfma_f32_16x16x32_bf16 v[52:55], v[144:147], a[68:71], v[52:55]
    ds_read_b64_tr_b16 v[132:133], v220 offset:40960
    v_mfma_f32_16x16x32_bf16 v[52:55], v[148:151], a[84:87], v[52:55]
    ds_read_b64_tr_b16 v[134:135], v220 offset:43008
    v_mfma_f32_16x16x32_bf16 v[80:83], v[144:147], a[72:75], v[80:83]
    ds_read_b64_tr_b16 v[136:137], v221 offset:32768
    v_mfma_f32_16x16x32_bf16 v[80:83], v[148:151], a[88:91], v[80:83]
    ds_read_b64_tr_b16 v[138:139], v221 offset:34816
    v_mfma_f32_16x16x32_bf16 v[84:87], v[144:147], a[76:79], v[84:87]
    ds_read_b64_tr_b16 v[140:141], v221 offset:40960
    v_mfma_f32_16x16x32_bf16 v[84:87], v[148:151], a[92:95], v[84:87]
    ds_read_b64_tr_b16 v[142:143], v221 offset:43008
    v_mfma_f32_16x16x32_bf16 v[56:59], v[152:155], a[64:67], v[56:59]
    buffer_load_dwordx4 a[48:51], v226, s[8:11], s35 offen offset:3072 sc1
    v_mfma_f32_16x16x32_bf16 v[56:59], v[156:159], a[80:83], v[56:59]
    v_mfma_f32_16x16x32_bf16 v[60:63], v[152:155], a[68:71], v[60:63]
    buffer_load_dwordx4 a[52:55], v227, s[8:11], s35 offen offset:3072 sc1
    v_mfma_f32_16x16x32_bf16 v[60:63], v[156:159], a[84:87], v[60:63]
    v_mfma_f32_16x16x32_bf16 v[88:91], v[152:155], a[72:75], v[88:91]
    buffer_load_dwordx4 a[56:59], v245, s[8:11], s35 offen offset:3072 sc1
    v_mfma_f32_16x16x32_bf16 v[88:91], v[156:159], a[88:91], v[88:91]
    v_mfma_f32_16x16x32_bf16 v[92:95], v[152:155], a[76:79], v[92:95]
    buffer_load_dwordx4 a[132:135], v228, s[8:11], s33 offen offset:1024 sc1
    v_mfma_f32_16x16x32_bf16 v[92:95], v[156:159], a[92:95], v[92:95]
    buffer_load_dwordx4 a[60:63], v246, s[8:11], s35 offen offset:3072 sc1
    s_waitcnt lgkmcnt(0)
    v_mfma_f32_16x16x32_bf16 v[0:3], v[128:131], a[64:67], v[0:3]
    ds_read_b64_tr_b16 v[144:145], v222 offset:32768
    v_mfma_f32_16x16x32_bf16 v[0:3], v[132:135], a[80:83], v[0:3]
    ds_read_b64_tr_b16 v[146:147], v222 offset:34816
    v_mfma_f32_16x16x32_bf16 v[4:7], v[128:131], a[68:71], v[4:7]
    ds_read_b64_tr_b16 v[148:149], v222 offset:40960
    v_mfma_f32_16x16x32_bf16 v[4:7], v[132:135], a[84:87], v[4:7]
    ds_read_b64_tr_b16 v[150:151], v222 offset:43008
    v_mfma_f32_16x16x32_bf16 v[96:99], v[128:131], a[72:75], v[96:99]
    ds_read_b64_tr_b16 v[152:153], v223 offset:32768
    v_mfma_f32_16x16x32_bf16 v[96:99], v[132:135], a[88:91], v[96:99]
    ds_read_b64_tr_b16 v[154:155], v223 offset:34816
    v_mfma_f32_16x16x32_bf16 v[100:103], v[128:131], a[76:79], v[100:103]
    ds_read_b64_tr_b16 v[156:157], v223 offset:40960
    v_mfma_f32_16x16x32_bf16 v[100:103], v[132:135], a[92:95], v[100:103]
    ds_read_b64_tr_b16 v[158:159], v223 offset:43008
    v_mfma_f32_16x16x32_bf16 v[8:11], v[136:139], a[64:67], v[8:11]
    v_mfma_f32_16x16x32_bf16 v[8:11], v[140:143], a[80:83], v[8:11]
    s_add_u32 m0, s38, 73728
    s_add_u32 s32, s37, 1638400
    v_mfma_f32_16x16x32_bf16 v[12:15], v[136:139], a[68:71], v[12:15]
    buffer_load_dwordx4 v224, s[12:15], s32 offen lds
    v_mfma_f32_16x16x32_bf16 v[12:15], v[140:143], a[84:87], v[12:15]
    v_mfma_f32_16x16x32_bf16 v[104:107], v[136:139], a[72:75], v[104:107]
    v_mfma_f32_16x16x32_bf16 v[104:107], v[140:143], a[88:91], v[104:107]
    buffer_load_dwordx4 v225, s[12:15], s32 offen offset:1024 lds
    v_mfma_f32_16x16x32_bf16 v[108:111], v[136:139], a[76:79], v[108:111]
    buffer_load_dwordx4 a[136:139], v228, s[8:11], s33 offen offset:2048 sc1
    v_mfma_f32_16x16x32_bf16 v[108:111], v[140:143], a[92:95], v[108:111]
    s_waitcnt lgkmcnt(0)
    v_mfma_f32_16x16x32_bf16 v[16:19], v[144:147], a[64:67], v[16:19]
    ds_read_b64_tr_b16 v[128:129], v216 offset:49152
    v_mfma_f32_16x16x32_bf16 v[16:19], v[148:151], a[80:83], v[16:19]
    ds_read_b64_tr_b16 v[130:131], v216 offset:51200
    v_mfma_f32_16x16x32_bf16 v[20:23], v[144:147], a[68:71], v[20:23]
    ds_read_b64_tr_b16 v[132:133], v216 offset:57344
    v_mfma_f32_16x16x32_bf16 v[20:23], v[148:151], a[84:87], v[20:23]
    ds_read_b64_tr_b16 v[134:135], v216 offset:59392
    v_mfma_f32_16x16x32_bf16 v[112:115], v[144:147], a[72:75], v[112:115]
    ds_read_b64_tr_b16 v[136:137], v217 offset:49152
    v_mfma_f32_16x16x32_bf16 v[112:115], v[148:151], a[88:91], v[112:115]
    ds_read_b64_tr_b16 v[138:139], v217 offset:51200
    v_mfma_f32_16x16x32_bf16 v[116:119], v[144:147], a[76:79], v[116:119]
    ds_read_b64_tr_b16 v[140:141], v217 offset:57344
    v_mfma_f32_16x16x32_bf16 v[116:119], v[148:151], a[92:95], v[116:119]
    ds_read_b64_tr_b16 v[142:143], v217 offset:59392
    v_mfma_f32_16x16x32_bf16 v[24:27], v[152:155], a[64:67], v[24:27]
    v_mfma_f32_16x16x32_bf16 v[24:27], v[156:159], a[80:83], v[24:27]
    v_mfma_f32_16x16x32_bf16 v[28:31], v[152:155], a[68:71], v[28:31]
    v_mfma_f32_16x16x32_bf16 v[28:31], v[156:159], a[84:87], v[28:31]
    v_mfma_f32_16x16x32_bf16 v[120:123], v[152:155], a[72:75], v[120:123]
    v_mfma_f32_16x16x32_bf16 v[120:123], v[156:159], a[88:91], v[120:123]
    v_mfma_f32_16x16x32_bf16 v[124:127], v[152:155], a[76:79], v[124:127]
    buffer_load_dwordx4 a[140:143], v228, s[8:11], s33 offen offset:3072 sc1
    v_mfma_f32_16x16x32_bf16 v[124:127], v[156:159], a[92:95], v[124:127]
    s_add_u32 s35, s35, 4096
    buffer_load_dwordx4 a[224:227], v226, s[8:11], s35 offen offset:0 sc1
    s_waitcnt vmcnt(29) lgkmcnt(0)
    v_mfma_f32_16x16x32_bf16 v[32:35], v[128:131], a[96:99], v[32:35]
    ds_read_b64_tr_b16 v[144:145], v218 offset:49152
    v_mfma_f32_16x16x32_bf16 v[32:35], v[132:135], a[112:115], v[32:35]
    ds_read_b64_tr_b16 v[146:147], v218 offset:51200
    v_mfma_f32_16x16x32_bf16 v[36:39], v[128:131], a[100:103], v[36:39]
    ds_read_b64_tr_b16 v[148:149], v218 offset:57344
    v_mfma_f32_16x16x32_bf16 v[36:39], v[132:135], a[116:119], v[36:39]
    ds_read_b64_tr_b16 v[150:151], v218 offset:59392
    v_mfma_f32_16x16x32_bf16 v[64:67], v[128:131], a[104:107], v[64:67]
    ds_read_b64_tr_b16 v[152:153], v219 offset:49152
    v_mfma_f32_16x16x32_bf16 v[64:67], v[132:135], a[120:123], v[64:67]
    ds_read_b64_tr_b16 v[154:155], v219 offset:51200
    v_mfma_f32_16x16x32_bf16 v[68:71], v[128:131], a[108:111], v[68:71]
    ds_read_b64_tr_b16 v[156:157], v219 offset:57344
    v_mfma_f32_16x16x32_bf16 v[68:71], v[132:135], a[124:127], v[68:71]
    ds_read_b64_tr_b16 v[158:159], v219 offset:59392
    v_mfma_f32_16x16x32_bf16 v[40:43], v[136:139], a[96:99], v[40:43]
    buffer_load_dwordx4 a[228:231], v227, s[8:11], s35 offen offset:0 sc1
    v_mfma_f32_16x16x32_bf16 v[40:43], v[140:143], a[112:115], v[40:43]
    s_add_u32 m0, s38, 81920
    s_add_u32 s32, s37, 1703936
    v_mfma_f32_16x16x32_bf16 v[44:47], v[136:139], a[100:103], v[44:47]
    buffer_load_dwordx4 v224, s[12:15], s32 offen lds
    v_mfma_f32_16x16x32_bf16 v[44:47], v[140:143], a[116:119], v[44:47]
    buffer_load_dwordx4 a[72:75], v245, s[8:11], s35 offen offset:0 sc1
    v_mfma_f32_16x16x32_bf16 v[72:75], v[136:139], a[104:107], v[72:75]
    v_mfma_f32_16x16x32_bf16 v[72:75], v[140:143], a[120:123], v[72:75]
    buffer_load_dwordx4 v225, s[12:15], s32 offen offset:1024 lds
    v_mfma_f32_16x16x32_bf16 v[76:79], v[136:139], a[108:111], v[76:79]
    s_add_u32 s33, s55, 4096
    buffer_load_dwordx4 a[144:147], v228, s[8:11], s33 offen offset:0 sc1
    v_mfma_f32_16x16x32_bf16 v[76:79], v[140:143], a[124:127], v[76:79]
    buffer_load_dwordx4 a[76:79], v246, s[8:11], s35 offen offset:0 sc1
    s_waitcnt lgkmcnt(0)
    v_mfma_f32_16x16x32_bf16 v[48:51], v[144:147], a[96:99], v[48:51]
    ds_read_b64_tr_b16 v[128:129], v220 offset:49152
    v_mfma_f32_16x16x32_bf16 v[48:51], v[148:151], a[112:115], v[48:51]
    ds_read_b64_tr_b16 v[130:131], v220 offset:51200
    v_mfma_f32_16x16x32_bf16 v[52:55], v[144:147], a[100:103], v[52:55]
    ds_read_b64_tr_b16 v[132:133], v220 offset:57344
    v_mfma_f32_16x16x32_bf16 v[52:55], v[148:151], a[116:119], v[52:55]
    ds_read_b64_tr_b16 v[134:135], v220 offset:59392
    v_mfma_f32_16x16x32_bf16 v[80:83], v[144:147], a[104:107], v[80:83]
    ds_read_b64_tr_b16 v[136:137], v221 offset:49152
    v_mfma_f32_16x16x32_bf16 v[80:83], v[148:151], a[120:123], v[80:83]
    ds_read_b64_tr_b16 v[138:139], v221 offset:51200
    v_mfma_f32_16x16x32_bf16 v[84:87], v[144:147], a[108:111], v[84:87]
    ds_read_b64_tr_b16 v[140:141], v221 offset:57344
    v_mfma_f32_16x16x32_bf16 v[84:87], v[148:151], a[124:127], v[84:87]
    ds_read_b64_tr_b16 v[142:143], v221 offset:59392
    v_mfma_f32_16x16x32_bf16 v[56:59], v[152:155], a[96:99], v[56:59]
    buffer_load_dwordx4 a[232:235], v226, s[8:11], s35 offen offset:1024 sc1
    v_mfma_f32_16x16x32_bf16 v[56:59], v[156:159], a[112:115], v[56:59]
    v_mfma_f32_16x16x32_bf16 v[60:63], v[152:155], a[100:103], v[60:63]
    buffer_load_dwordx4 a[236:239], v227, s[8:11], s35 offen offset:1024 sc1
    v_mfma_f32_16x16x32_bf16 v[60:63], v[156:159], a[116:119], v[60:63]
    v_mfma_f32_16x16x32_bf16 v[88:91], v[152:155], a[104:107], v[88:91]
    buffer_load_dwordx4 a[88:91], v245, s[8:11], s35 offen offset:1024 sc1
    v_mfma_f32_16x16x32_bf16 v[88:91], v[156:159], a[120:123], v[88:91]
    v_mfma_f32_16x16x32_bf16 v[92:95], v[152:155], a[108:111], v[92:95]
    buffer_load_dwordx4 a[148:151], v228, s[8:11], s33 offen offset:1024 sc1
    v_mfma_f32_16x16x32_bf16 v[92:95], v[156:159], a[124:127], v[92:95]
    buffer_load_dwordx4 a[92:95], v246, s[8:11], s35 offen offset:1024 sc1
    s_waitcnt lgkmcnt(0)
    v_mfma_f32_16x16x32_bf16 v[0:3], v[128:131], a[96:99], v[0:3]
    ds_read_b64_tr_b16 v[144:145], v222 offset:49152
    v_mfma_f32_16x16x32_bf16 v[0:3], v[132:135], a[112:115], v[0:3]
    ds_read_b64_tr_b16 v[146:147], v222 offset:51200
    v_mfma_f32_16x16x32_bf16 v[4:7], v[128:131], a[100:103], v[4:7]
    ds_read_b64_tr_b16 v[148:149], v222 offset:57344
    v_mfma_f32_16x16x32_bf16 v[4:7], v[132:135], a[116:119], v[4:7]
    ds_read_b64_tr_b16 v[150:151], v222 offset:59392
    v_mfma_f32_16x16x32_bf16 v[96:99], v[128:131], a[104:107], v[96:99]
    ds_read_b64_tr_b16 v[152:153], v223 offset:49152
    v_mfma_f32_16x16x32_bf16 v[96:99], v[132:135], a[120:123], v[96:99]
    ds_read_b64_tr_b16 v[154:155], v223 offset:51200
    v_mfma_f32_16x16x32_bf16 v[100:103], v[128:131], a[108:111], v[100:103]
    ds_read_b64_tr_b16 v[156:157], v223 offset:57344
    v_mfma_f32_16x16x32_bf16 v[100:103], v[132:135], a[124:127], v[100:103]
    ds_read_b64_tr_b16 v[158:159], v223 offset:59392
    v_mfma_f32_16x16x32_bf16 v[8:11], v[136:139], a[96:99], v[8:11]
    v_mfma_f32_16x16x32_bf16 v[8:11], v[140:143], a[112:115], v[8:11]
    s_add_u32 m0, s38, 90112
    s_add_u32 s32, s37, 1769472
    v_mfma_f32_16x16x32_bf16 v[12:15], v[136:139], a[100:103], v[12:15]
    buffer_load_dwordx4 v224, s[12:15], s32 offen lds
    v_mfma_f32_16x16x32_bf16 v[12:15], v[140:143], a[116:119], v[12:15]
    v_mfma_f32_16x16x32_bf16 v[104:107], v[136:139], a[104:107], v[104:107]
    v_mfma_f32_16x16x32_bf16 v[104:107], v[140:143], a[120:123], v[104:107]
    buffer_load_dwordx4 v225, s[12:15], s32 offen offset:1024 lds
    v_mfma_f32_16x16x32_bf16 v[108:111], v[136:139], a[108:111], v[108:111]
    buffer_load_dwordx4 a[152:155], v228, s[8:11], s33 offen offset:2048 sc1
    v_mfma_f32_16x16x32_bf16 v[108:111], v[140:143], a[124:127], v[108:111]
    s_waitcnt vmcnt(60) lgkmcnt(0)
    s_barrier
    v_mfma_f32_16x16x32_bf16 v[16:19], v[144:147], a[96:99], v[16:19]
    v_xor_b32 v216, 0x10000, v216
    ds_read_b64_tr_b16 v[128:129], v216 offset:0
    v_mfma_f32_16x16x32_bf16 v[16:19], v[148:151], a[112:115], v[16:19]
    ds_read_b64_tr_b16 v[130:131], v216 offset:2048
    v_mfma_f32_16x16x32_bf16 v[20:23], v[144:147], a[100:103], v[20:23]
    ds_read_b64_tr_b16 v[132:133], v216 offset:8192
    v_mfma_f32_16x16x32_bf16 v[20:23], v[148:151], a[116:119], v[20:23]
    ds_read_b64_tr_b16 v[134:135], v216 offset:10240
    v_mfma_f32_16x16x32_bf16 v[112:115], v[144:147], a[104:107], v[112:115]
    v_xor_b32 v217, 0x10000, v217
    ds_read_b64_tr_b16 v[136:137], v217 offset:0
    v_mfma_f32_16x16x32_bf16 v[112:115], v[148:151], a[120:123], v[112:115]
    ds_read_b64_tr_b16 v[138:139], v217 offset:2048
    v_mfma_f32_16x16x32_bf16 v[116:119], v[144:147], a[108:111], v[116:119]
    ds_read_b64_tr_b16 v[140:141], v217 offset:8192
    v_mfma_f32_16x16x32_bf16 v[116:119], v[148:151], a[124:127], v[116:119]
    ds_read_b64_tr_b16 v[142:143], v217 offset:10240
    v_mfma_f32_16x16x32_bf16 v[24:27], v[152:155], a[96:99], v[24:27]
    v_mfma_f32_16x16x32_bf16 v[24:27], v[156:159], a[112:115], v[24:27]
    v_mfma_f32_16x16x32_bf16 v[28:31], v[152:155], a[100:103], v[28:31]
    v_mfma_f32_16x16x32_bf16 v[28:31], v[156:159], a[116:119], v[28:31]
    v_mfma_f32_16x16x32_bf16 v[120:123], v[152:155], a[104:107], v[120:123]
    v_mfma_f32_16x16x32_bf16 v[120:123], v[156:159], a[120:123], v[120:123]
    v_mfma_f32_16x16x32_bf16 v[124:127], v[152:155], a[108:111], v[124:127]
    buffer_load_dwordx4 a[156:159], v228, s[8:11], s33 offen offset:3072 sc1
    v_mfma_f32_16x16x32_bf16 v[124:127], v[156:159], a[124:127], v[124:127]
    buffer_load_dwordx4 a[240:243], v226, s[8:11], s35 offen offset:2048 sc1
    s_waitcnt vmcnt(34) lgkmcnt(0)
    v_mfma_f32_16x16x32_bf16 v[32:35], v[128:131], a[0:3], v[32:35]
    v_xor_b32 v218, 0x10000, v218
    ds_read_b64_tr_b16 v[144:145], v218 offset:0
    v_mfma_f32_16x16x32_bf16 v[32:35], v[132:135], a[16:19], v[32:35]
    ds_read_b64_tr_b16 v[146:147], v218 offset:2048
    v_mfma_f32_16x16x32_bf16 v[36:39], v[128:131], a[4:7], v[36:39]
    ds_read_b64_tr_b16 v[148:149], v218 offset:8192
    v_mfma_f32_16x16x32_bf16 v[36:39], v[132:135], a[20:23], v[36:39]
    ds_read_b64_tr_b16 v[150:151], v218 offset:10240
    v_mfma_f32_16x16x32_bf16 v[64:67], v[128:131], a[8:11], v[64:67]
    v_xor_b32 v219, 0x10000, v219
    ds_read_b64_tr_b16 v[152:153], v219 offset:0
    v_mfma_f32_16x16x32_bf16 v[64:67], v[132:135], a[24:27], v[64:67]
    ds_read_b64_tr_b16 v[154:155], v219 offset:2048
    v_mfma_f32_16x16x32_bf16 v[68:71], v[128:131], a[12:15], v[68:71]
    ds_read_b64_tr_b16 v[156:157], v219 offset:8192
    v_mfma_f32_16x16x32_bf16 v[68:71], v[132:135], a[28:31], v[68:71]
    ds_read_b64_tr_b16 v[158:159], v219 offset:10240
    v_mfma_f32_16x16x32_bf16 v[40:43], v[136:139], a[0:3], v[40:43]
    buffer_load_dwordx4 a[244:247], v227, s[8:11], s35 offen offset:2048 sc1
    v_mfma_f32_16x16x32_bf16 v[40:43], v[140:143], a[16:19], v[40:43]
    s_add_u32 m0, s38, 98304
    s_add_u32 s32, s37, 1835008
    v_mfma_f32_16x16x32_bf16 v[44:47], v[136:139], a[4:7], v[44:47]
    buffer_load_dwordx4 v224, s[12:15], s32 offen lds
    v_mfma_f32_16x16x32_bf16 v[44:47], v[140:143], a[20:23], v[44:47]
    buffer_load_dwordx4 a[104:107], v245, s[8:11], s35 offen offset:2048 sc1
    v_mfma_f32_16x16x32_bf16 v[72:75], v[136:139], a[8:11], v[72:75]
    v_mfma_f32_16x16x32_bf16 v[72:75], v[140:143], a[24:27], v[72:75]
    buffer_load_dwordx4 v225, s[12:15], s32 offen offset:1024 lds
    v_mfma_f32_16x16x32_bf16 v[76:79], v[136:139], a[12:15], v[76:79]
    s_add_u32 s33, s55, 32768
    buffer_load_dwordx4 a[160:163], v228, s[8:11], s33 offen offset:0 sc1
    v_mfma_f32_16x16x32_bf16 v[76:79], v[140:143], a[28:31], v[76:79]
    buffer_load_dwordx4 a[108:111], v246, s[8:11], s35 offen offset:2048 sc1
    s_waitcnt lgkmcnt(0)
    v_mfma_f32_16x16x32_bf16 v[48:51], v[144:147], a[0:3], v[48:51]
    v_xor_b32 v220, 0x10000, v220
    ds_read_b64_tr_b16 v[128:129], v220 offset:0
    v_mfma_f32_16x16x32_bf16 v[48:51], v[148:151], a[16:19], v[48:51]
    ds_read_b64_tr_b16 v[130:131], v220 offset:2048
    v_mfma_f32_16x16x32_bf16 v[52:55], v[144:147], a[4:7], v[52:55]
    ds_read_b64_tr_b16 v[132:133], v220 offset:8192
    v_mfma_f32_16x16x32_bf16 v[52:55], v[148:151], a[20:23], v[52:55]
    ds_read_b64_tr_b16 v[134:135], v220 offset:10240
    v_mfma_f32_16x16x32_bf16 v[80:83], v[144:147], a[8:11], v[80:83]
    v_xor_b32 v221, 0x10000, v221
    ds_read_b64_tr_b16 v[136:137], v221 offset:0
    v_mfma_f32_16x16x32_bf16 v[80:83], v[148:151], a[24:27], v[80:83]
    ds_read_b64_tr_b16 v[138:139], v221 offset:2048
    v_mfma_f32_16x16x32_bf16 v[84:87], v[144:147], a[12:15], v[84:87]
    ds_read_b64_tr_b16 v[140:141], v221 offset:8192
    v_mfma_f32_16x16x32_bf16 v[84:87], v[148:151], a[28:31], v[84:87]
    ds_read_b64_tr_b16 v[142:143], v221 offset:10240
    v_mfma_f32_16x16x32_bf16 v[56:59], v[152:155], a[0:3], v[56:59]
    buffer_load_dwordx4 a[248:251], v226, s[8:11], s35 offen offset:3072 sc1
    v_mfma_f32_16x16x32_bf16 v[56:59], v[156:159], a[16:19], v[56:59]
    v_mfma_f32_16x16x32_bf16 v[60:63], v[152:155], a[4:7], v[60:63]
    buffer_load_dwordx4 a[252:255], v227, s[8:11], s35 offen offset:3072 sc1
    v_mfma_f32_16x16x32_bf16 v[60:63], v[156:159], a[20:23], v[60:63]
    v_mfma_f32_16x16x32_bf16 v[88:91], v[152:155], a[8:11], v[88:91]
    buffer_load_dwordx4 a[120:123], v245, s[8:11], s35 offen offset:3072 sc1
    v_mfma_f32_16x16x32_bf16 v[88:91], v[156:159], a[24:27], v[88:91]
    v_mfma_f32_16x16x32_bf16 v[92:95], v[152:155], a[12:15], v[92:95]
    buffer_load_dwordx4 a[164:167], v228, s[8:11], s33 offen offset:1024 sc1
    v_mfma_f32_16x16x32_bf16 v[92:95], v[156:159], a[28:31], v[92:95]
    buffer_load_dwordx4 a[124:127], v246, s[8:11], s35 offen offset:3072 sc1
    s_waitcnt lgkmcnt(0)
    v_mfma_f32_16x16x32_bf16 v[0:3], v[128:131], a[0:3], v[0:3]
    v_xor_b32 v222, 0x10000, v222
    ds_read_b64_tr_b16 v[144:145], v222 offset:0
    v_mfma_f32_16x16x32_bf16 v[0:3], v[132:135], a[16:19], v[0:3]
    ds_read_b64_tr_b16 v[146:147], v222 offset:2048
    v_mfma_f32_16x16x32_bf16 v[4:7], v[128:131], a[4:7], v[4:7]
    ds_read_b64_tr_b16 v[148:149], v222 offset:8192
    v_mfma_f32_16x16x32_bf16 v[4:7], v[132:135], a[20:23], v[4:7]
    ds_read_b64_tr_b16 v[150:151], v222 offset:10240
    v_mfma_f32_16x16x32_bf16 v[96:99], v[128:131], a[8:11], v[96:99]
    v_xor_b32 v223, 0x10000, v223
    ds_read_b64_tr_b16 v[152:153], v223 offset:0
    v_mfma_f32_16x16x32_bf16 v[96:99], v[132:135], a[24:27], v[96:99]
    ds_read_b64_tr_b16 v[154:155], v223 offset:2048
    v_mfma_f32_16x16x32_bf16 v[100:103], v[128:131], a[12:15], v[100:103]
    ds_read_b64_tr_b16 v[156:157], v223 offset:8192
    v_mfma_f32_16x16x32_bf16 v[100:103], v[132:135], a[28:31], v[100:103]
    ds_read_b64_tr_b16 v[158:159], v223 offset:10240
    v_mfma_f32_16x16x32_bf16 v[8:11], v[136:139], a[0:3], v[8:11]
    v_mfma_f32_16x16x32_bf16 v[8:11], v[140:143], a[16:19], v[8:11]
    s_add_u32 m0, s38, 106496
    s_add_u32 s32, s37, 1900544
    v_mfma_f32_16x16x32_bf16 v[12:15], v[136:139], a[4:7], v[12:15]
    buffer_load_dwordx4 v224, s[12:15], s32 offen lds
    v_mfma_f32_16x16x32_bf16 v[12:15], v[140:143], a[20:23], v[12:15]
    v_mfma_f32_16x16x32_bf16 v[104:107], v[136:139], a[8:11], v[104:107]
    v_mfma_f32_16x16x32_bf16 v[104:107], v[140:143], a[24:27], v[104:107]
    buffer_load_dwordx4 v225, s[12:15], s32 offen offset:1024 lds
    v_mfma_f32_16x16x32_bf16 v[108:111], v[136:139], a[12:15], v[108:111]
    buffer_load_dwordx4 a[168:171], v228, s[8:11], s33 offen offset:2048 sc1
    v_mfma_f32_16x16x32_bf16 v[108:111], v[140:143], a[28:31], v[108:111]
    s_waitcnt lgkmcnt(0)
    v_mfma_f32_16x16x32_bf16 v[16:19], v[144:147], a[0:3], v[16:19]
    ds_read_b64_tr_b16 v[128:129], v216 offset:16384
    v_mfma_f32_16x16x32_bf16 v[16:19], v[148:151], a[16:19], v[16:19]
    ds_read_b64_tr_b16 v[130:131], v216 offset:18432
    v_mfma_f32_16x16x32_bf16 v[20:23], v[144:147], a[4:7], v[20:23]
    ds_read_b64_tr_b16 v[132:133], v216 offset:24576
    v_mfma_f32_16x16x32_bf16 v[20:23], v[148:151], a[20:23], v[20:23]
    ds_read_b64_tr_b16 v[134:135], v216 offset:26624
    v_mfma_f32_16x16x32_bf16 v[112:115], v[144:147], a[8:11], v[112:115]
    ds_read_b64_tr_b16 v[136:137], v217 offset:16384
    v_mfma_f32_16x16x32_bf16 v[112:115], v[148:151], a[24:27], v[112:115]
    ds_read_b64_tr_b16 v[138:139], v217 offset:18432
    v_mfma_f32_16x16x32_bf16 v[116:119], v[144:147], a[12:15], v[116:119]
    ds_read_b64_tr_b16 v[140:141], v217 offset:24576
    v_mfma_f32_16x16x32_bf16 v[116:119], v[148:151], a[28:31], v[116:119]
    ds_read_b64_tr_b16 v[142:143], v217 offset:26624
    v_mfma_f32_16x16x32_bf16 v[24:27], v[152:155], a[0:3], v[24:27]
    v_mfma_f32_16x16x32_bf16 v[24:27], v[156:159], a[16:19], v[24:27]
    v_mfma_f32_16x16x32_bf16 v[28:31], v[152:155], a[4:7], v[28:31]
    v_mfma_f32_16x16x32_bf16 v[28:31], v[156:159], a[20:23], v[28:31]
    v_mfma_f32_16x16x32_bf16 v[120:123], v[152:155], a[8:11], v[120:123]
    v_mfma_f32_16x16x32_bf16 v[120:123], v[156:159], a[24:27], v[120:123]
    v_mfma_f32_16x16x32_bf16 v[124:127], v[152:155], a[12:15], v[124:127]
    buffer_load_dwordx4 a[172:175], v228, s[8:11], s33 offen offset:3072 sc1
    v_mfma_f32_16x16x32_bf16 v[124:127], v[156:159], a[28:31], v[124:127]
    s_add_u32 s35, s35, 4096
    buffer_load_dwordx4 a[0:3], v226, s[8:11], s35 offen offset:0 sc1
    s_waitcnt vmcnt(37) lgkmcnt(0)
    v_mfma_f32_16x16x32_bf16 v[32:35], v[128:131], a[32:35], v[32:35]
    ds_read_b64_tr_b16 v[144:145], v218 offset:16384
    v_mfma_f32_16x16x32_bf16 v[32:35], v[132:135], a[48:51], v[32:35]
    ds_read_b64_tr_b16 v[146:147], v218 offset:18432
    v_mfma_f32_16x16x32_bf16 v[36:39], v[128:131], a[36:39], v[36:39]
    ds_read_b64_tr_b16 v[148:149], v218 offset:24576
    v_mfma_f32_16x16x32_bf16 v[36:39], v[132:135], a[52:55], v[36:39]
    ds_read_b64_tr_b16 v[150:151], v218 offset:26624
    v_mfma_f32_16x16x32_bf16 v[64:67], v[128:131], a[40:43], v[64:67]
    ds_read_b64_tr_b16 v[152:153], v219 offset:16384
    v_mfma_f32_16x16x32_bf16 v[64:67], v[132:135], a[56:59], v[64:67]
    ds_read_b64_tr_b16 v[154:155], v219 offset:18432
    v_mfma_f32_16x16x32_bf16 v[68:71], v[128:131], a[44:47], v[68:71]
    ds_read_b64_tr_b16 v[156:157], v219 offset:24576
    v_mfma_f32_16x16x32_bf16 v[68:71], v[132:135], a[60:63], v[68:71]
    ds_read_b64_tr_b16 v[158:159], v219 offset:26624
    v_mfma_f32_16x16x32_bf16 v[40:43], v[136:139], a[32:35], v[40:43]
    buffer_load_dwordx4 a[4:7], v227, s[8:11], s35 offen offset:0 sc1
    v_mfma_f32_16x16x32_bf16 v[40:43], v[140:143], a[48:51], v[40:43]
    s_add_u32 m0, s38, 114688
    s_add_u32 s32, s37, 1966080
    v_mfma_f32_16x16x32_bf16 v[44:47], v[136:139], a[36:39], v[44:47]
    buffer_load_dwordx4 v224, s[12:15], s32 offen lds
    v_mfma_f32_16x16x32_bf16 v[44:47], v[140:143], a[52:55], v[44:47]
    buffer_load_dwordx4 a[8:11], v245, s[8:11], s35 offen offset:0 sc1
    v_mfma_f32_16x16x32_bf16 v[72:75], v[136:139], a[40:43], v[72:75]
    v_mfma_f32_16x16x32_bf16 v[72:75], v[140:143], a[56:59], v[72:75]
    buffer_load_dwordx4 v225, s[12:15], s32 offen offset:1024 lds
    v_mfma_f32_16x16x32_bf16 v[76:79], v[136:139], a[44:47], v[76:79]
    s_add_u32 s33, s55, 36864
    buffer_load_dwordx4 a[176:179], v228, s[8:11], s33 offen offset:0 sc1
    v_mfma_f32_16x16x32_bf16 v[76:79], v[140:143], a[60:63], v[76:79]
    buffer_load_dwordx4 a[12:15], v246, s[8:11], s35 offen offset:0 sc1
    s_waitcnt lgkmcnt(0)
    v_mfma_f32_16x16x32_bf16 v[48:51], v[144:147], a[32:35], v[48:51]
    ds_read_b64_tr_b16 v[128:129], v220 offset:16384
    v_mfma_f32_16x16x32_bf16 v[48:51], v[148:151], a[48:51], v[48:51]
    ds_read_b64_tr_b16 v[130:131], v220 offset:18432
    v_mfma_f32_16x16x32_bf16 v[52:55], v[144:147], a[36:39], v[52:55]
    ds_read_b64_tr_b16 v[132:133], v220 offset:24576
    v_mfma_f32_16x16x32_bf16 v[52:55], v[148:151], a[52:55], v[52:55]
    ds_read_b64_tr_b16 v[134:135], v220 offset:26624
    v_mfma_f32_16x16x32_bf16 v[80:83], v[144:147], a[40:43], v[80:83]
    ds_read_b64_tr_b16 v[136:137], v221 offset:16384
    v_mfma_f32_16x16x32_bf16 v[80:83], v[148:151], a[56:59], v[80:83]
    ds_read_b64_tr_b16 v[138:139], v221 offset:18432
    v_mfma_f32_16x16x32_bf16 v[84:87], v[144:147], a[44:47], v[84:87]
    ds_read_b64_tr_b16 v[140:141], v221 offset:24576
    v_mfma_f32_16x16x32_bf16 v[84:87], v[148:151], a[60:63], v[84:87]
    ds_read_b64_tr_b16 v[142:143], v221 offset:26624
    v_mfma_f32_16x16x32_bf16 v[56:59], v[152:155], a[32:35], v[56:59]
    buffer_load_dwordx4 a[16:19], v226, s[8:11], s35 offen offset:1024 sc1
    v_mfma_f32_16x16x32_bf16 v[56:59], v[156:159], a[48:51], v[56:59]
    v_mfma_f32_16x16x32_bf16 v[60:63], v[152:155], a[36:39], v[60:63]
    buffer_load_dwordx4 a[20:23], v227, s[8:11], s35 offen offset:1024 sc1
    v_mfma_f32_16x16x32_bf16 v[60:63], v[156:159], a[52:55], v[60:63]
    v_mfma_f32_16x16x32_bf16 v[88:91], v[152:155], a[40:43], v[88:91]
    buffer_load_dwordx4 a[24:27], v245, s[8:11], s35 offen offset:1024 sc1
    v_mfma_f32_16x16x32_bf16 v[88:91], v[156:159], a[56:59], v[88:91]
    v_mfma_f32_16x16x32_bf16 v[92:95], v[152:155], a[44:47], v[92:95]
    buffer_load_dwordx4 a[180:183], v228, s[8:11], s33 offen offset:1024 sc1
    v_mfma_f32_16x16x32_bf16 v[92:95], v[156:159], a[60:63], v[92:95]
    buffer_load_dwordx4 a[28:31], v246, s[8:11], s35 offen offset:1024 sc1
    s_waitcnt lgkmcnt(0)
    v_mfma_f32_16x16x32_bf16 v[0:3], v[128:131], a[32:35], v[0:3]
    ds_read_b64_tr_b16 v[144:145], v222 offset:16384
    v_mfma_f32_16x16x32_bf16 v[0:3], v[132:135], a[48:51], v[0:3]
    ds_read_b64_tr_b16 v[146:147], v222 offset:18432
    v_mfma_f32_16x16x32_bf16 v[4:7], v[128:131], a[36:39], v[4:7]
    ds_read_b64_tr_b16 v[148:149], v222 offset:24576
    v_mfma_f32_16x16x32_bf16 v[4:7], v[132:135], a[52:55], v[4:7]
    ds_read_b64_tr_b16 v[150:151], v222 offset:26624
    v_mfma_f32_16x16x32_bf16 v[96:99], v[128:131], a[40:43], v[96:99]
    ds_read_b64_tr_b16 v[152:153], v223 offset:16384
    v_mfma_f32_16x16x32_bf16 v[96:99], v[132:135], a[56:59], v[96:99]
    ds_read_b64_tr_b16 v[154:155], v223 offset:18432
    v_mfma_f32_16x16x32_bf16 v[100:103], v[128:131], a[44:47], v[100:103]
    ds_read_b64_tr_b16 v[156:157], v223 offset:24576
    v_mfma_f32_16x16x32_bf16 v[100:103], v[132:135], a[60:63], v[100:103]
    ds_read_b64_tr_b16 v[158:159], v223 offset:26624
    v_mfma_f32_16x16x32_bf16 v[8:11], v[136:139], a[32:35], v[8:11]
    v_mfma_f32_16x16x32_bf16 v[8:11], v[140:143], a[48:51], v[8:11]
    s_add_u32 m0, s38, 122880
    s_add_u32 s32, s37, 2031616
    v_mfma_f32_16x16x32_bf16 v[12:15], v[136:139], a[36:39], v[12:15]
    buffer_load_dwordx4 v224, s[12:15], s32 offen lds
    v_mfma_f32_16x16x32_bf16 v[12:15], v[140:143], a[52:55], v[12:15]
    v_mfma_f32_16x16x32_bf16 v[104:107], v[136:139], a[40:43], v[104:107]
    v_mfma_f32_16x16x32_bf16 v[104:107], v[140:143], a[56:59], v[104:107]
    buffer_load_dwordx4 v225, s[12:15], s32 offen offset:1024 lds
    v_mfma_f32_16x16x32_bf16 v[108:111], v[136:139], a[44:47], v[108:111]
    buffer_load_dwordx4 a[184:187], v228, s[8:11], s33 offen offset:2048 sc1
    v_mfma_f32_16x16x32_bf16 v[108:111], v[140:143], a[60:63], v[108:111]
    s_waitcnt vmcnt(63) lgkmcnt(0)
    s_barrier
    v_mfma_f32_16x16x32_bf16 v[16:19], v[144:147], a[32:35], v[16:19]
    ds_read_b64_tr_b16 v[128:129], v216 offset:32768
    v_mfma_f32_16x16x32_bf16 v[16:19], v[148:151], a[48:51], v[16:19]
    ds_read_b64_tr_b16 v[130:131], v216 offset:34816
    v_mfma_f32_16x16x32_bf16 v[20:23], v[144:147], a[36:39], v[20:23]
    ds_read_b64_tr_b16 v[132:133], v216 offset:40960
    v_mfma_f32_16x16x32_bf16 v[20:23], v[148:151], a[52:55], v[20:23]
    ds_read_b64_tr_b16 v[134:135], v216 offset:43008
    v_mfma_f32_16x16x32_bf16 v[112:115], v[144:147], a[40:43], v[112:115]
    ds_read_b64_tr_b16 v[136:137], v217 offset:32768
    v_mfma_f32_16x16x32_bf16 v[112:115], v[148:151], a[56:59], v[112:115]
    ds_read_b64_tr_b16 v[138:139], v217 offset:34816
    v_mfma_f32_16x16x32_bf16 v[116:119], v[144:147], a[44:47], v[116:119]
    ds_read_b64_tr_b16 v[140:141], v217 offset:40960
    v_mfma_f32_16x16x32_bf16 v[116:119], v[148:151], a[60:63], v[116:119]
    ds_read_b64_tr_b16 v[142:143], v217 offset:43008
    v_mfma_f32_16x16x32_bf16 v[24:27], v[152:155], a[32:35], v[24:27]
    v_mfma_f32_16x16x32_bf16 v[24:27], v[156:159], a[48:51], v[24:27]
    v_mfma_f32_16x16x32_bf16 v[28:31], v[152:155], a[36:39], v[28:31]
    v_mfma_f32_16x16x32_bf16 v[28:31], v[156:159], a[52:55], v[28:31]
    v_mfma_f32_16x16x32_bf16 v[120:123], v[152:155], a[40:43], v[120:123]
    v_mfma_f32_16x16x32_bf16 v[120:123], v[156:159], a[56:59], v[120:123]
    v_mfma_f32_16x16x32_bf16 v[124:127], v[152:155], a[44:47], v[124:127]
    buffer_load_dwordx4 a[188:191], v228, s[8:11], s33 offen offset:3072 sc1
    v_mfma_f32_16x16x32_bf16 v[124:127], v[156:159], a[60:63], v[124:127]
    buffer_load_dwordx4 a[32:35], v226, s[8:11], s35 offen offset:2048 sc1
    s_waitcnt vmcnt(37) lgkmcnt(0)
    v_mfma_f32_16x16x32_bf16 v[64:67], v[128:131], a[72:75], v[64:67]
    ds_read_b64_tr_b16 v[144:145], v218 offset:32768
    v_mfma_f32_16x16x32_bf16 v[64:67], v[132:135], a[88:91], v[64:67]
    ds_read_b64_tr_b16 v[146:147], v218 offset:34816
    v_mfma_f32_16x16x32_bf16 v[68:71], v[128:131], a[76:79], v[68:71]
    ds_read_b64_tr_b16 v[148:149], v218 offset:40960
    buffer_load_dwordx4 a[36:39], v227, s[8:11], s35 offen offset:2048 sc1
    v_mfma_f32_16x16x32_bf16 v[68:71], v[132:135], a[92:95], v[68:71]
    ds_read_b64_tr_b16 v[150:151], v218 offset:43008
    v_mfma_f32_16x16x32_bf16 v[72:75], v[136:139], a[72:75], v[72:75]
    ds_read_b64_tr_b16 v[152:153], v219 offset:32768
    v_mfma_f32_16x16x32_bf16 v[72:75], v[140:143], a[88:91], v[72:75]
    ds_read_b64_tr_b16 v[154:155], v219 offset:34816
    v_mfma_f32_16x16x32_bf16 v[76:79], v[136:139], a[76:79], v[76:79]
    ds_read_b64_tr_b16 v[156:157], v219 offset:40960
    buffer_load_dwordx4 a[40:43], v245, s[8:11], s35 offen offset:2048 sc1
    v_mfma_f32_16x16x32_bf16 v[76:79], v[140:143], a[92:95], v[76:79]
    ds_read_b64_tr_b16 v[158:159], v219 offset:43008
    s_waitcnt lgkmcnt(4)
    v_mfma_f32_16x16x32_bf16 v[80:83], v[144:147], a[72:75], v[80:83]
    ds_read_b64_tr_b16 v[128:129], v220 offset:32768
    v_mfma_f32_16x16x32_bf16 v[80:83], v[148:151], a[88:91], v[80:83]
    ds_read_b64_tr_b16 v[130:131], v220 offset:34816
    v_mfma_f32_16x16x32_bf16 v[84:87], v[144:147], a[76:79], v[84:87]
    ds_read_b64_tr_b16 v[132:133], v220 offset:40960
    buffer_load_dwordx4 a[44:47], v246, s[8:11], s35 offen offset:2048 sc1
    v_mfma_f32_16x16x32_bf16 v[84:87], v[148:151], a[92:95], v[84:87]
    ds_read_b64_tr_b16 v[134:135], v220 offset:43008
    s_waitcnt lgkmcnt(4)
    v_mfma_f32_16x16x32_bf16 v[88:91], v[152:155], a[72:75], v[88:91]
    ds_read_b64_tr_b16 v[136:137], v221 offset:32768
    v_mfma_f32_16x16x32_bf16 v[88:91], v[156:159], a[88:91], v[88:91]
    ds_read_b64_tr_b16 v[138:139], v221 offset:34816
    s_mov_b32 s32, 0
    buffer_load_dwordx4 v[192:195], v229, s[16:19], s32 offen
    v_mfma_f32_16x16x32_bf16 v[92:95], v[152:155], a[76:79], v[92:95]
    ds_read_b64_tr_b16 v[140:141], v221 offset:40960
    buffer_load_dwordx4 a[48:51], v226, s[8:11], s35 offen offset:3072 sc1
    v_mfma_f32_16x16x32_bf16 v[92:95], v[156:159], a[92:95], v[92:95]
    ds_read_b64_tr_b16 v[142:143], v221 offset:43008
    s_waitcnt lgkmcnt(4)
    v_mfma_f32_16x16x32_bf16 v[0:3], v[128:131], a[224:227], v[0:3]
    ds_read_b64_tr_b16 v[144:145], v222 offset:32768
    v_mfma_f32_16x16x32_bf16 v[0:3], v[132:135], a[232:235], v[0:3]
    ds_read_b64_tr_b16 v[146:147], v222 offset:34816
    v_mfma_f32_16x16x32_bf16 v[4:7], v[128:131], a[228:231], v[4:7]
    ds_read_b64_tr_b16 v[148:149], v222 offset:40960
    v_mfma_f32_16x16x32_bf16 v[4:7], v[132:135], a[236:239], v[4:7]
    ds_read_b64_tr_b16 v[150:151], v222 offset:43008
    v_mfma_f32_16x16x32_bf16 v[96:99], v[128:131], a[72:75], v[96:99]
    ds_read_b64_tr_b16 v[152:153], v223 offset:32768
    v_mfma_f32_16x16x32_bf16 v[96:99], v[132:135], a[88:91], v[96:99]
    ds_read_b64_tr_b16 v[154:155], v223 offset:34816
    s_mov_b32 s32, 16384
    buffer_load_dwordx4 v[196:199], v229, s[16:19], s32 offen
    v_mfma_f32_16x16x32_bf16 v[100:103], v[128:131], a[76:79], v[100:103]
    ds_read_b64_tr_b16 v[156:157], v223 offset:40960
    v_mfma_f32_16x16x32_bf16 v[100:103], v[132:135], a[92:95], v[100:103]
    ds_read_b64_tr_b16 v[158:159], v223 offset:43008
    s_waitcnt lgkmcnt(8)
    v_mfma_f32_16x16x32_bf16 v[8:11], v[136:139], a[224:227], v[8:11]
    buffer_load_dwordx4 a[52:55], v227, s[8:11], s35 offen offset:3072 sc1
    v_mfma_f32_16x16x32_bf16 v[8:11], v[140:143], a[232:235], v[8:11]
    v_mfma_f32_16x16x32_bf16 v[12:15], v[136:139], a[228:231], v[12:15]
    v_mfma_f32_16x16x32_bf16 v[12:15], v[140:143], a[236:239], v[12:15]
    buffer_load_dwordx4 a[56:59], v245, s[8:11], s35 offen offset:3072 sc1
    v_mfma_f32_16x16x32_bf16 v[104:107], v[136:139], a[72:75], v[104:107]
    v_mfma_f32_16x16x32_bf16 v[104:107], v[140:143], a[88:91], v[104:107]
    s_mov_b32 s32, 32768
    buffer_load_dwordx4 v[200:203], v229, s[16:19], s32 offen
    v_mfma_f32_16x16x32_bf16 v[108:111], v[136:139], a[76:79], v[108:111]
    v_mfma_f32_16x16x32_bf16 v[108:111], v[140:143], a[92:95], v[108:111]
    buffer_load_dwordx4 a[60:63], v246, s[8:11], s35 offen offset:3072 sc1
    s_waitcnt lgkmcnt(0)
    v_mfma_f32_16x16x32_bf16 v[16:19], v[144:147], a[224:227], v[16:19]
    ds_read_b64_tr_b16 v[128:129], v216 offset:49152
    v_mfma_f32_16x16x32_bf16 v[16:19], v[148:151], a[232:235], v[16:19]
    ds_read_b64_tr_b16 v[130:131], v216 offset:51200
    v_mfma_f32_16x16x32_bf16 v[20:23], v[144:147], a[228:231], v[20:23]
    ds_read_b64_tr_b16 v[132:133], v216 offset:57344
    v_mfma_f32_16x16x32_bf16 v[20:23], v[148:151], a[236:239], v[20:23]
    ds_read_b64_tr_b16 v[134:135], v216 offset:59392
    v_mfma_f32_16x16x32_bf16 v[112:115], v[144:147], a[72:75], v[112:115]
    ds_read_b64_tr_b16 v[136:137], v217 offset:49152
    v_mfma_f32_16x16x32_bf16 v[112:115], v[148:151], a[88:91], v[112:115]
    ds_read_b64_tr_b16 v[138:139], v217 offset:51200
    v_mfma_f32_16x16x32_bf16 v[116:119], v[144:147], a[76:79], v[116:119]
    ds_read_b64_tr_b16 v[140:141], v217 offset:57344
    v_mfma_f32_16x16x32_bf16 v[116:119], v[148:151], a[92:95], v[116:119]
    ds_read_b64_tr_b16 v[142:143], v217 offset:59392
    v_mfma_f32_16x16x32_bf16 v[24:27], v[152:155], a[224:227], v[24:27]
    v_mfma_f32_16x16x32_bf16 v[24:27], v[156:159], a[232:235], v[24:27]
    v_mfma_f32_16x16x32_bf16 v[28:31], v[152:155], a[228:231], v[28:31]
    v_mfma_f32_16x16x32_bf16 v[28:31], v[156:159], a[236:239], v[28:31]
    v_mfma_f32_16x16x32_bf16 v[120:123], v[152:155], a[72:75], v[120:123]
    v_mfma_f32_16x16x32_bf16 v[120:123], v[156:159], a[88:91], v[120:123]
    s_mov_b32 s32, 49152
    buffer_load_dwordx4 v[204:207], v229, s[16:19], s32 offen
    v_mfma_f32_16x16x32_bf16 v[124:127], v[152:155], a[76:79], v[124:127]
    v_mfma_f32_16x16x32_bf16 v[124:127], v[156:159], a[92:95], v[124:127]
    s_add_u32 s35, s35, 4096
    buffer_load_dwordx4 a[64:67], v226, s[8:11], s35 offen offset:0 sc1
    s_waitcnt vmcnt(33) lgkmcnt(0)
    v_mfma_f32_16x16x32_bf16 v[64:67], v[128:131], a[104:107], v[64:67]
    ds_read_b64_tr_b16 v[144:145], v218 offset:49152
    v_mfma_f32_16x16x32_bf16 v[64:67], v[132:135], a[120:123], v[64:67]
    ds_read_b64_tr_b16 v[146:147], v218 offset:51200
    v_mfma_f32_16x16x32_bf16 v[68:71], v[128:131], a[108:111], v[68:71]
    ds_read_b64_tr_b16 v[148:149], v218 offset:57344
    buffer_load_dwordx4 a[68:71], v227, s[8:11], s35 offen offset:0 sc1
    v_mfma_f32_16x16x32_bf16 v[68:71], v[132:135], a[124:127], v[68:71]
    ds_read_b64_tr_b16 v[150:151], v218 offset:59392
    v_mfma_f32_16x16x32_bf16 v[72:75], v[136:139], a[104:107], v[72:75]
    ds_read_b64_tr_b16 v[152:153], v219 offset:49152
    v_mfma_f32_16x16x32_bf16 v[72:75], v[140:143], a[120:123], v[72:75]
    ds_read_b64_tr_b16 v[154:155], v219 offset:51200
    v_mfma_f32_16x16x32_bf16 v[76:79], v[136:139], a[108:111], v[76:79]
    ds_read_b64_tr_b16 v[156:157], v219 offset:57344
    buffer_load_dwordx4 a[72:75], v245, s[8:11], s35 offen offset:0 sc1
    v_mfma_f32_16x16x32_bf16 v[76:79], v[140:143], a[124:127], v[76:79]
    ds_read_b64_tr_b16 v[158:159], v219 offset:59392
    s_waitcnt lgkmcnt(4)
    v_mfma_f32_16x16x32_bf16 v[80:83], v[144:147], a[104:107], v[80:83]
    ds_read_b64_tr_b16 v[128:129], v220 offset:49152
    v_mfma_f32_16x16x32_bf16 v[80:83], v[148:151], a[120:123], v[80:83]
    ds_read_b64_tr_b16 v[130:131], v220 offset:51200
    v_mfma_f32_16x16x32_bf16 v[84:87], v[144:147], a[108:111], v[84:87]
    ds_read_b64_tr_b16 v[132:133], v220 offset:57344
    buffer_load_dwordx4 a[76:79], v246, s[8:11], s35 offen offset:0 sc1
    v_mfma_f32_16x16x32_bf16 v[84:87], v[148:151], a[124:127], v[84:87]
    ds_read_b64_tr_b16 v[134:135], v220 offset:59392
    s_waitcnt lgkmcnt(4)
    v_mfma_f32_16x16x32_bf16 v[88:91], v[152:155], a[104:107], v[88:91]
    ds_read_b64_tr_b16 v[136:137], v221 offset:49152
    v_mfma_f32_16x16x32_bf16 v[88:91], v[156:159], a[120:123], v[88:91]
    ds_read_b64_tr_b16 v[138:139], v221 offset:51200
    buffer_load_dwordx4 v[208:211], v240, s[20:23], 0 offen
    v_mfma_f32_16x16x32_bf16 v[92:95], v[152:155], a[108:111], v[92:95]
    ds_read_b64_tr_b16 v[140:141], v221 offset:57344
    buffer_load_dwordx4 a[80:83], v226, s[8:11], s35 offen offset:1024 sc1
    v_mfma_f32_16x16x32_bf16 v[92:95], v[156:159], a[124:127], v[92:95]
    ds_read_b64_tr_b16 v[142:143], v221 offset:59392
    s_waitcnt lgkmcnt(4)
    v_mfma_f32_16x16x32_bf16 v[0:3], v[128:131], a[240:243], v[0:3]
    ds_read_b64_tr_b16 v[144:145], v222 offset:49152
    v_mfma_f32_16x16x32_bf16 v[0:3], v[132:135], a[248:251], v[0:3]
    ds_read_b64_tr_b16 v[146:147], v222 offset:51200
    v_mfma_f32_16x16x32_bf16 v[4:7], v[128:131], a[244:247], v[4:7]
    ds_read_b64_tr_b16 v[148:149], v222 offset:57344
    v_mfma_f32_16x16x32_bf16 v[4:7], v[132:135], a[252:255], v[4:7]
    ds_read_b64_tr_b16 v[150:151], v222 offset:59392
    v_mfma_f32_16x16x32_bf16 v[96:99], v[128:131], a[104:107], v[96:99]
    ds_read_b64_tr_b16 v[152:153], v223 offset:49152
    v_mfma_f32_16x16x32_bf16 v[96:99], v[132:135], a[120:123], v[96:99]
    ds_read_b64_tr_b16 v[154:155], v223 offset:51200
    s_mov_b32 s32, kc_tail-kc_pc0
    v_lshlrev_b32 v234, 7, v230
    buffer_load_dword v241, v234, s[56:59], s32 offen
    v_mfma_f32_16x16x32_bf16 v[100:103], v[128:131], a[108:111], v[100:103]
    ds_read_b64_tr_b16 v[156:157], v223 offset:57344
    v_mfma_f32_16x16x32_bf16 v[100:103], v[132:135], a[124:127], v[100:103]
    ds_read_b64_tr_b16 v[158:159], v223 offset:59392
    s_waitcnt lgkmcnt(8)
    v_mfma_f32_16x16x32_bf16 v[8:11], v[136:139], a[240:243], v[8:11]
    buffer_load_dwordx4 a[84:87], v227, s[8:11], s35 offen offset:1024 sc1
    v_mfma_f32_16x16x32_bf16 v[8:11], v[140:143], a[248:251], v[8:11]
    v_mfma_f32_16x16x32_bf16 v[12:15], v[136:139], a[244:247], v[12:15]
    v_mfma_f32_16x16x32_bf16 v[12:15], v[140:143], a[252:255], v[12:15]
    buffer_load_dwordx4 a[88:91], v245, s[8:11], s35 offen offset:1024 sc1
    v_mfma_f32_16x16x32_bf16 v[104:107], v[136:139], a[104:107], v[104:107]
    v_mfma_f32_16x16x32_bf16 v[104:107], v[140:143], a[120:123], v[104:107]
    v_mfma_f32_16x16x32_bf16 v[108:111], v[136:139], a[108:111], v[108:111]
    v_mfma_f32_16x16x32_bf16 v[108:111], v[140:143], a[124:127], v[108:111]
    buffer_load_dwordx4 a[92:95], v246, s[8:11], s35 offen offset:1024 sc1
    s_waitcnt vmcnt(24) lgkmcnt(0)
    s_barrier
    v_mfma_f32_16x16x32_bf16 v[16:19], v[144:147], a[240:243], v[16:19]
    v_xor_b32 v220, 0x10000, v220
    ds_read_b64_tr_b16 v[128:129], v220 offset:0
    v_mfma_f32_16x16x32_bf16 v[16:19], v[148:151], a[248:251], v[16:19]
    ds_read_b64_tr_b16 v[130:131], v220 offset:2048
    v_mfma_f32_16x16x32_bf16 v[20:23], v[144:147], a[244:247], v[20:23]
    ds_read_b64_tr_b16 v[132:133], v220 offset:8192
    v_mfma_f32_16x16x32_bf16 v[20:23], v[148:151], a[252:255], v[20:23]
    ds_read_b64_tr_b16 v[134:135], v220 offset:10240
    v_mfma_f32_16x16x32_bf16 v[112:115], v[144:147], a[104:107], v[112:115]
    v_xor_b32 v221, 0x10000, v221
    ds_read_b64_tr_b16 v[136:137], v221 offset:0
    v_mfma_f32_16x16x32_bf16 v[112:115], v[148:151], a[120:123], v[112:115]
    ds_read_b64_tr_b16 v[138:139], v221 offset:2048
    v_mfma_f32_16x16x32_bf16 v[116:119], v[144:147], a[108:111], v[116:119]
    ds_read_b64_tr_b16 v[140:141], v221 offset:8192
    v_mfma_f32_16x16x32_bf16 v[116:119], v[148:151], a[124:127], v[116:119]
    ds_read_b64_tr_b16 v[142:143], v221 offset:10240
    v_mfma_f32_16x16x32_bf16 v[24:27], v[152:155], a[240:243], v[24:27]
    v_mfma_f32_16x16x32_bf16 v[24:27], v[156:159], a[248:251], v[24:27]
    v_mfma_f32_16x16x32_bf16 v[28:31], v[152:155], a[244:247], v[28:31]
    v_mfma_f32_16x16x32_bf16 v[28:31], v[156:159], a[252:255], v[28:31]
    v_mfma_f32_16x16x32_bf16 v[120:123], v[152:155], a[104:107], v[120:123]
    v_mfma_f32_16x16x32_bf16 v[120:123], v[156:159], a[120:123], v[120:123]
    v_mfma_f32_16x16x32_bf16 v[124:127], v[152:155], a[108:111], v[124:127]
    v_mfma_f32_16x16x32_bf16 v[124:127], v[156:159], a[124:127], v[124:127]
    buffer_load_dwordx4 a[96:99], v226, s[8:11], s35 offen offset:2048 sc1
    s_waitcnt vmcnt(27) lgkmcnt(4)
    v_mfma_f32_16x16x32_bf16 v[96:99], v[128:131], a[8:11], v[96:99]
    v_xor_b32 v222, 0x10000, v222
    ds_read_b64_tr_b16 v[144:145], v222 offset:0
    v_mfma_f32_16x16x32_bf16 v[96:99], v[132:135], a[24:27], v[96:99]
    ds_read_b64_tr_b16 v[146:147], v222 offset:2048
    v_mfma_f32_16x16x32_bf16 v[100:103], v[128:131], a[12:15], v[100:103]
    ds_read_b64_tr_b16 v[148:149], v222 offset:8192
    buffer_load_dwordx4 a[100:103], v227, s[8:11], s35 offen offset:2048 sc1
    v_mfma_f32_16x16x32_bf16 v[100:103], v[132:135], a[28:31], v[100:103]
    ds_read_b64_tr_b16 v[150:151], v222 offset:10240
    s_waitcnt lgkmcnt(4)
    v_mfma_f32_16x16x32_bf16 v[104:107], v[136:139], a[8:11], v[104:107]
    v_xor_b32 v223, 0x10000, v223
    ds_read_b64_tr_b16 v[152:153], v223 offset:0
    v_mfma_f32_16x16x32_bf16 v[104:107], v[140:143], a[24:27], v[104:107]
    ds_read_b64_tr_b16 v[154:155], v223 offset:2048
    v_mfma_f32_16x16x32_bf16 v[108:111], v[136:139], a[12:15], v[108:111]
    ds_read_b64_tr_b16 v[156:157], v223 offset:8192
    buffer_load_dwordx4 a[104:107], v245, s[8:11], s35 offen offset:2048 sc1
    v_mfma_f32_16x16x32_bf16 v[108:111], v[140:143], a[28:31], v[108:111]
    ds_read_b64_tr_b16 v[158:159], v223 offset:10240
    s_waitcnt lgkmcnt(4)
    v_mfma_f32_16x16x32_bf16 v[112:115], v[144:147], a[8:11], v[112:115]
    ds_read_b64_tr_b16 v[128:129], v220 offset:16384
    v_mfma_f32_16x16x32_bf16 v[112:115], v[148:151], a[24:27], v[112:115]
    ds_read_b64_tr_b16 v[130:131], v220 offset:18432
    v_mfma_f32_16x16x32_bf16 v[116:119], v[144:147], a[12:15], v[116:119]
    ds_read_b64_tr_b16 v[132:133], v220 offset:24576
    buffer_load_dwordx4 a[108:111], v246, s[8:11], s35 offen offset:2048 sc1
    v_mfma_f32_16x16x32_bf16 v[116:119], v[148:151], a[28:31], v[116:119]
    ds_read_b64_tr_b16 v[134:135], v220 offset:26624
    s_waitcnt lgkmcnt(4)
    v_mfma_f32_16x16x32_bf16 v[120:123], v[152:155], a[8:11], v[120:123]
    ds_read_b64_tr_b16 v[136:137], v221 offset:16384
    v_mfma_f32_16x16x32_bf16 v[120:123], v[156:159], a[24:27], v[120:123]
    ds_read_b64_tr_b16 v[138:139], v221 offset:18432
    v_mfma_f32_16x16x32_bf16 v[124:127], v[152:155], a[12:15], v[124:127]
    ds_read_b64_tr_b16 v[140:141], v221 offset:24576
    buffer_load_dwordx4 a[112:115], v226, s[8:11], s35 offen offset:3072 sc1
    v_mfma_f32_16x16x32_bf16 v[124:127], v[156:159], a[28:31], v[124:127]
    ds_read_b64_tr_b16 v[142:143], v221 offset:26624
    s_waitcnt vmcnt(16) lgkmcnt(4)
    v_mfma_f32_16x16x32_bf16 v[96:99], v[128:131], a[40:43], v[96:99]
    ds_read_b64_tr_b16 v[144:145], v222 offset:16384
    v_mfma_f32_16x16x32_bf16 v[96:99], v[132:135], a[56:59], v[96:99]
    ds_read_b64_tr_b16 v[146:147], v222 offset:18432
    v_mfma_f32_16x16x32_bf16 v[100:103], v[128:131], a[44:47], v[100:103]
    ds_read_b64_tr_b16 v[148:149], v222 offset:24576
    buffer_load_dwordx4 a[116:119], v227, s[8:11], s35 offen offset:3072 sc1
    v_mfma_f32_16x16x32_bf16 v[100:103], v[132:135], a[60:63], v[100:103]
    ds_read_b64_tr_b16 v[150:151], v222 offset:26624
    s_waitcnt lgkmcnt(4)
    v_mfma_f32_16x16x32_bf16 v[104:107], v[136:139], a[40:43], v[104:107]
    ds_read_b64_tr_b16 v[152:153], v223 offset:16384
    v_mfma_f32_16x16x32_bf16 v[104:107], v[140:143], a[56:59], v[104:107]
    ds_read_b64_tr_b16 v[154:155], v223 offset:18432
    v_mfma_f32_16x16x32_bf16 v[108:111], v[136:139], a[44:47], v[108:111]
    ds_read_b64_tr_b16 v[156:157], v223 offset:24576
    buffer_load_dwordx4 a[120:123], v245, s[8:11], s35 offen offset:3072 sc1
    v_mfma_f32_16x16x32_bf16 v[108:111], v[140:143], a[60:63], v[108:111]
    ds_read_b64_tr_b16 v[158:159], v223 offset:26624
    s_waitcnt lgkmcnt(4)
    v_mfma_f32_16x16x32_bf16 v[112:115], v[144:147], a[40:43], v[112:115]
    ds_read_b64_tr_b16 v[128:129], v220 offset:32768
    v_mfma_f32_16x16x32_bf16 v[112:115], v[148:151], a[56:59], v[112:115]
    ds_read_b64_tr_b16 v[130:131], v220 offset:34816
    v_mfma_f32_16x16x32_bf16 v[116:119], v[144:147], a[44:47], v[116:119]
    ds_read_b64_tr_b16 v[132:133], v220 offset:40960
    buffer_load_dwordx4 a[124:127], v246, s[8:11], s35 offen offset:3072 sc1
    v_mfma_f32_16x16x32_bf16 v[116:119], v[148:151], a[60:63], v[116:119]
    ds_read_b64_tr_b16 v[134:135], v220 offset:43008
    s_waitcnt lgkmcnt(4)
    v_mfma_f32_16x16x32_bf16 v[120:123], v[152:155], a[40:43], v[120:123]
    ds_read_b64_tr_b16 v[136:137], v221 offset:32768
    v_mfma_f32_16x16x32_bf16 v[120:123], v[156:159], a[56:59], v[120:123]
    ds_read_b64_tr_b16 v[138:139], v221 offset:34816
    v_mfma_f32_16x16x32_bf16 v[124:127], v[152:155], a[44:47], v[124:127]
    ds_read_b64_tr_b16 v[140:141], v221 offset:40960
    v_mfma_f32_16x16x32_bf16 v[124:127], v[156:159], a[60:63], v[124:127]
    ds_read_b64_tr_b16 v[142:143], v221 offset:43008
    s_waitcnt vmcnt(8) lgkmcnt(4)
    v_mfma_f32_16x16x32_bf16 v[96:99], v[128:131], a[72:75], v[96:99]
    ds_read_b64_tr_b16 v[144:145], v222 offset:32768
    v_mfma_f32_16x16x32_bf16 v[96:99], v[132:135], a[88:91], v[96:99]
    ds_read_b64_tr_b16 v[146:147], v222 offset:34816
    s_xor_b32 s7, s39, 24
    v_mfma_f32_16x16x32_bf16 v[100:103], v[128:131], a[76:79], v[100:103]
    ds_read_b64_tr_b16 v[148:149], v222 offset:40960
    v_mfma_f32_16x16x32_bf16 v[100:103], v[132:135], a[92:95], v[100:103]
    ds_read_b64_tr_b16 v[150:151], v222 offset:43008
    s_waitcnt lgkmcnt(4)
    v_mfma_f32_16x16x32_bf16 v[104:107], v[136:139], a[72:75], v[104:107]
    ds_read_b64_tr_b16 v[152:153], v223 offset:32768
    v_mfma_f32_16x16x32_bf16 v[104:107], v[140:143], a[88:91], v[104:107]
    ds_read_b64_tr_b16 v[154:155], v223 offset:34816
    s_mul_i32 s7, s7, 12288
    v_mfma_f32_16x16x32_bf16 v[108:111], v[136:139], a[76:79], v[108:111]
    ds_read_b64_tr_b16 v[156:157], v223 offset:40960
    s_add_u32 s7, s7, 0x5002000
    v_mfma_f32_16x16x32_bf16 v[108:111], v[140:143], a[92:95], v[108:111]
    ds_read_b64_tr_b16 v[158:159], v223 offset:43008
    s_waitcnt lgkmcnt(4)
    v_mfma_f32_16x16x32_bf16 v[112:115], v[144:147], a[72:75], v[112:115]
    ds_read_b64_tr_b16 v[128:129], v220 offset:49152
    v_mfma_f32_16x16x32_bf16 v[112:115], v[148:151], a[88:91], v[112:115]
    ds_read_b64_tr_b16 v[130:131], v220 offset:51200
    s_xor_b32 s37, s39, 8
    v_mfma_f32_16x16x32_bf16 v[116:119], v[144:147], a[76:79], v[116:119]
    ds_read_b64_tr_b16 v[132:133], v220 offset:57344
    v_mfma_f32_16x16x32_bf16 v[116:119], v[148:151], a[92:95], v[116:119]
    ds_read_b64_tr_b16 v[134:135], v220 offset:59392
    s_waitcnt lgkmcnt(4)
    v_mfma_f32_16x16x32_bf16 v[120:123], v[152:155], a[72:75], v[120:123]
    ds_read_b64_tr_b16 v[136:137], v221 offset:49152
    v_mfma_f32_16x16x32_bf16 v[120:123], v[156:159], a[88:91], v[120:123]
    ds_read_b64_tr_b16 v[138:139], v221 offset:51200
    s_mul_i32 s37, s37, 12288
    v_mfma_f32_16x16x32_bf16 v[124:127], v[152:155], a[76:79], v[124:127]
    ds_read_b64_tr_b16 v[140:141], v221 offset:57344
    s_add_u32 s37, s37, 0x5000000
    v_mfma_f32_16x16x32_bf16 v[124:127], v[156:159], a[92:95], v[124:127]
    ds_read_b64_tr_b16 v[142:143], v221 offset:59392
    s_waitcnt vmcnt(0) lgkmcnt(4)
    v_mfma_f32_16x16x32_bf16 v[96:99], v[128:131], a[104:107], v[96:99]
    ds_read_b64_tr_b16 v[144:145], v222 offset:49152
    v_mfma_f32_16x16x32_bf16 v[96:99], v[132:135], a[120:123], v[96:99]
    ds_read_b64_tr_b16 v[146:147], v222 offset:51200
    s_xor_b32 s38, s39, 16
    v_mfma_f32_16x16x32_bf16 v[100:103], v[128:131], a[108:111], v[100:103]
    ds_read_b64_tr_b16 v[148:149], v222 offset:57344
    v_mfma_f32_16x16x32_bf16 v[100:103], v[132:135], a[124:127], v[100:103]
    ds_read_b64_tr_b16 v[150:151], v222 offset:59392
    s_waitcnt lgkmcnt(4)
    v_mfma_f32_16x16x32_bf16 v[104:107], v[136:139], a[104:107], v[104:107]
    ds_read_b64_tr_b16 v[152:153], v223 offset:49152
    v_mfma_f32_16x16x32_bf16 v[104:107], v[140:143], a[120:123], v[104:107]
    ds_read_b64_tr_b16 v[154:155], v223 offset:51200
    s_mul_i32 s38, s38, 12288
    v_mfma_f32_16x16x32_bf16 v[108:111], v[136:139], a[108:111], v[108:111]
    ds_read_b64_tr_b16 v[156:157], v223 offset:57344
    s_add_u32 s38, s38, 0x5001000
    v_mfma_f32_16x16x32_bf16 v[108:111], v[140:143], a[124:127], v[108:111]
    ds_read_b64_tr_b16 v[158:159], v223 offset:59392
    s_waitcnt lgkmcnt(4)
    v_mfma_f32_16x16x32_bf16 v[112:115], v[144:147], a[104:107], v[112:115]
    ds_read_b64_tr_b16 v[128:129], v220 offset:0
    v_mfma_f32_16x16x32_bf16 v[112:115], v[148:151], a[120:123], v[112:115]
    ds_read_b64_tr_b16 v[130:131], v220 offset:2048
    v_mfma_f32_16x16x32_bf16 v[116:119], v[144:147], a[108:111], v[116:119]
    ds_read_b64_tr_b16 v[132:133], v220 offset:8192
    v_mfma_f32_16x16x32_bf16 v[116:119], v[148:151], a[124:127], v[116:119]
    ds_read_b64_tr_b16 v[134:135], v220 offset:10240
    s_waitcnt lgkmcnt(4)
    v_mfma_f32_16x16x32_bf16 v[120:123], v[152:155], a[104:107], v[120:123]
    ds_read_b64_tr_b16 v[136:137], v221 offset:0
    v_mfma_f32_16x16x32_bf16 v[120:123], v[156:159], a[120:123], v[120:123]
    ds_read_b64_tr_b16 v[138:139], v221 offset:2048
    v_mfma_f32_16x16x32_bf16 v[124:127], v[152:155], a[108:111], v[124:127]
    ds_read_b64_tr_b16 v[140:141], v221 offset:8192
    v_mfma_f32_16x16x32_bf16 v[124:127], v[156:159], a[124:127], v[124:127]
    ds_read_b64_tr_b16 v[142:143], v221 offset:10240
    s_waitcnt lgkmcnt(4)
    v_mfma_f32_16x16x32_bf16 v[0:3], v[128:131], a[0:3], v[0:3]
    ds_read_b64_tr_b16 v[144:145], v222 offset:0
    v_mfma_f32_16x16x32_bf16 v[0:3], v[132:135], a[16:19], v[0:3]
    ds_read_b64_tr_b16 v[146:147], v222 offset:2048
    v_mfma_f32_16x16x32_bf16 v[4:7], v[128:131], a[4:7], v[4:7]
    ds_read_b64_tr_b16 v[148:149], v222 offset:8192
    v_mfma_f32_16x16x32_bf16 v[4:7], v[132:135], a[20:23], v[4:7]
    ds_read_b64_tr_b16 v[150:151], v222 offset:10240
    s_waitcnt lgkmcnt(4)
    v_mfma_f32_16x16x32_bf16 v[8:11], v[136:139], a[0:3], v[8:11]
    ds_read_b64_tr_b16 v[152:153], v223 offset:0
    v_mfma_f32_16x16x32_bf16 v[8:11], v[140:143], a[16:19], v[8:11]
    ds_read_b64_tr_b16 v[154:155], v223 offset:2048
    v_mfma_f32_16x16x32_bf16 v[12:15], v[136:139], a[4:7], v[12:15]
    ds_read_b64_tr_b16 v[156:157], v223 offset:8192
    v_mfma_f32_16x16x32_bf16 v[12:15], v[140:143], a[20:23], v[12:15]
    ds_read_b64_tr_b16 v[158:159], v223 offset:10240
    s_waitcnt lgkmcnt(4)
    v_mfma_f32_16x16x32_bf16 v[16:19], v[144:147], a[0:3], v[16:19]
    ds_read_b64_tr_b16 v[128:129], v220 offset:16384
    s_mul_i32 s33, s39, 12288
    s_add_u32 s33, s33, 0x5002000
    v_mfma_f32_16x16x32_bf16 v[16:19], v[148:151], a[16:19], v[16:19]
    ds_read_b64_tr_b16 v[130:131], v220 offset:18432
    v_mfma_f32_16x16x32_bf16 v[20:23], v[144:147], a[4:7], v[20:23]
    ds_read_b64_tr_b16 v[132:133], v220 offset:24576
    v_cvt_pk_bf16_f32 v96, v96, v97
    v_mfma_f32_16x16x32_bf16 v[20:23], v[148:151], a[20:23], v[20:23]
    ds_read_b64_tr_b16 v[134:135], v220 offset:26624
    v_cvt_pk_bf16_f32 v97, v98, v99
    s_waitcnt lgkmcnt(4)
    v_mfma_f32_16x16x32_bf16 v[24:27], v[152:155], a[0:3], v[24:27]
    ds_read_b64_tr_b16 v[136:137], v221 offset:16384
    v_cvt_pk_bf16_f32 v98, v100, v101
    v_mfma_f32_16x16x32_bf16 v[24:27], v[156:159], a[16:19], v[24:27]
    ds_read_b64_tr_b16 v[138:139], v221 offset:18432
    v_cvt_pk_bf16_f32 v99, v102, v103
    v_mfma_f32_16x16x32_bf16 v[28:31], v[152:155], a[4:7], v[28:31]
    ds_read_b64_tr_b16 v[140:141], v221 offset:24576
    v_min_u32_e64 v96, -2, v96
    v_mfma_f32_16x16x32_bf16 v[28:31], v[156:159], a[20:23], v[28:31]
    ds_read_b64_tr_b16 v[142:143], v221 offset:26624
    v_min_u32 v97, -2, v97
    s_waitcnt lgkmcnt(4)
    v_mfma_f32_16x16x32_bf16 v[0:3], v[128:131], a[32:35], v[0:3]
    ds_read_b64_tr_b16 v[144:145], v222 offset:16384
    v_min_u32_e64 v98, -2, v98
    v_mfma_f32_16x16x32_bf16 v[0:3], v[132:135], a[48:51], v[0:3]
    ds_read_b64_tr_b16 v[146:147], v222 offset:18432
    v_min_u32_e64 v99, -2, v99
    v_mfma_f32_16x16x32_bf16 v[4:7], v[128:131], a[36:39], v[4:7]
    ds_read_b64_tr_b16 v[148:149], v222 offset:24576
    buffer_store_dwordx4 v[96:99], v228, s[8:11], s33 offen offset:0 sc1
    v_mfma_f32_16x16x32_bf16 v[4:7], v[132:135], a[52:55], v[4:7]
    ds_read_b64_tr_b16 v[150:151], v222 offset:26624
    s_waitcnt lgkmcnt(4)
    v_mfma_f32_16x16x32_bf16 v[8:11], v[136:139], a[32:35], v[8:11]
    ds_read_b64_tr_b16 v[152:153], v223 offset:16384
    v_mfma_f32_16x16x32_bf16 v[8:11], v[140:143], a[48:51], v[8:11]
    ds_read_b64_tr_b16 v[154:155], v223 offset:18432
    v_mfma_f32_16x16x32_bf16 v[12:15], v[136:139], a[36:39], v[12:15]
    ds_read_b64_tr_b16 v[156:157], v223 offset:24576
    v_cvt_pk_bf16_f32 v100, v104, v105
    v_mfma_f32_16x16x32_bf16 v[12:15], v[140:143], a[52:55], v[12:15]
    ds_read_b64_tr_b16 v[158:159], v223 offset:26624
    v_cvt_pk_bf16_f32 v101, v106, v107
    s_waitcnt lgkmcnt(4)
    v_mfma_f32_16x16x32_bf16 v[16:19], v[144:147], a[32:35], v[16:19]
    ds_read_b64_tr_b16 v[128:129], v220 offset:32768
    v_cvt_pk_bf16_f32 v102, v108, v109
    v_mfma_f32_16x16x32_bf16 v[16:19], v[148:151], a[48:51], v[16:19]
    ds_read_b64_tr_b16 v[130:131], v220 offset:34816
    v_cvt_pk_bf16_f32 v103, v110, v111
    v_mfma_f32_16x16x32_bf16 v[20:23], v[144:147], a[36:39], v[20:23]
    ds_read_b64_tr_b16 v[132:133], v220 offset:40960
    v_min_u32_e64 v100, -2, v100
    v_mfma_f32_16x16x32_bf16 v[20:23], v[148:151], a[52:55], v[20:23]
    ds_read_b64_tr_b16 v[134:135], v220 offset:43008
    v_min_u32 v101, -2, v101
    s_waitcnt lgkmcnt(4)
    v_mfma_f32_16x16x32_bf16 v[24:27], v[152:155], a[32:35], v[24:27]
    ds_read_b64_tr_b16 v[136:137], v221 offset:32768
    v_min_u32_e64 v102, -2, v102
    v_mfma_f32_16x16x32_bf16 v[24:27], v[156:159], a[48:51], v[24:27]
    ds_read_b64_tr_b16 v[138:139], v221 offset:34816
    v_min_u32_e64 v103, -2, v103
    v_mfma_f32_16x16x32_bf16 v[28:31], v[152:155], a[36:39], v[28:31]
    ds_read_b64_tr_b16 v[140:141], v221 offset:40960
    buffer_store_dwordx4 v[100:103], v228, s[8:11], s33 offen offset:1024 sc1
    v_mfma_f32_16x16x32_bf16 v[28:31], v[156:159], a[52:55], v[28:31]
    ds_read_b64_tr_b16 v[142:143], v221 offset:43008
    s_waitcnt lgkmcnt(4)
    v_mfma_f32_16x16x32_bf16 v[0:3], v[128:131], a[64:67], v[0:3]
    ds_read_b64_tr_b16 v[144:145], v222 offset:32768
    v_mfma_f32_16x16x32_bf16 v[0:3], v[132:135], a[80:83], v[0:3]
    ds_read_b64_tr_b16 v[146:147], v222 offset:34816
    v_mfma_f32_16x16x32_bf16 v[4:7], v[128:131], a[68:71], v[4:7]
    ds_read_b64_tr_b16 v[148:149], v222 offset:40960
    v_cvt_pk_bf16_f32 v104, v112, v113
    v_mfma_f32_16x16x32_bf16 v[4:7], v[132:135], a[84:87], v[4:7]
    ds_read_b64_tr_b16 v[150:151], v222 offset:43008
    v_cvt_pk_bf16_f32 v105, v114, v115
    s_waitcnt lgkmcnt(4)
    v_mfma_f32_16x16x32_bf16 v[8:11], v[136:139], a[64:67], v[8:11]
    ds_read_b64_tr_b16 v[152:153], v223 offset:32768
    v_cvt_pk_bf16_f32 v106, v116, v117
    v_mfma_f32_16x16x32_bf16 v[8:11], v[140:143], a[80:83], v[8:11]
    ds_read_b64_tr_b16 v[154:155], v223 offset:34816
    v_cvt_pk_bf16_f32 v107, v118, v119
    v_mfma_f32_16x16x32_bf16 v[12:15], v[136:139], a[68:71], v[12:15]
    ds_read_b64_tr_b16 v[156:157], v223 offset:40960
    v_min_u32_e64 v104, -2, v104
    v_mfma_f32_16x16x32_bf16 v[12:15], v[140:143], a[84:87], v[12:15]
    ds_read_b64_tr_b16 v[158:159], v223 offset:43008
    v_min_u32 v105, -2, v105
    s_waitcnt lgkmcnt(4)
    v_mfma_f32_16x16x32_bf16 v[16:19], v[144:147], a[64:67], v[16:19]
    ds_read_b64_tr_b16 v[128:129], v220 offset:49152
    v_min_u32_e64 v106, -2, v106
    v_mfma_f32_16x16x32_bf16 v[16:19], v[148:151], a[80:83], v[16:19]
    ds_read_b64_tr_b16 v[130:131], v220 offset:51200
    v_min_u32_e64 v107, -2, v107
    v_mfma_f32_16x16x32_bf16 v[20:23], v[144:147], a[68:71], v[20:23]
    ds_read_b64_tr_b16 v[132:133], v220 offset:57344
    buffer_store_dwordx4 v[104:107], v228, s[8:11], s33 offen offset:2048 sc1
    v_mfma_f32_16x16x32_bf16 v[20:23], v[148:151], a[84:87], v[20:23]
    ds_read_b64_tr_b16 v[134:135], v220 offset:59392
    s_waitcnt lgkmcnt(4)
    v_mfma_f32_16x16x32_bf16 v[24:27], v[152:155], a[64:67], v[24:27]
    ds_read_b64_tr_b16 v[136:137], v221 offset:49152
    v_mfma_f32_16x16x32_bf16 v[24:27], v[156:159], a[80:83], v[24:27]
    ds_read_b64_tr_b16 v[138:139], v221 offset:51200
    v_mfma_f32_16x16x32_bf16 v[28:31], v[152:155], a[68:71], v[28:31]
    ds_read_b64_tr_b16 v[140:141], v221 offset:57344
    v_cvt_pk_bf16_f32 v108, v120, v121
    v_mfma_f32_16x16x32_bf16 v[28:31], v[156:159], a[84:87], v[28:31]
    ds_read_b64_tr_b16 v[142:143], v221 offset:59392
    v_cvt_pk_bf16_f32 v109, v122, v123
    s_waitcnt lgkmcnt(4)
    v_mfma_f32_16x16x32_bf16 v[0:3], v[128:131], a[96:99], v[0:3]
    ds_read_b64_tr_b16 v[144:145], v222 offset:49152
    v_cvt_pk_bf16_f32 v110, v124, v125
    v_mfma_f32_16x16x32_bf16 v[0:3], v[132:135], a[112:115], v[0:3]
    ds_read_b64_tr_b16 v[146:147], v222 offset:51200
    v_cvt_pk_bf16_f32 v111, v126, v127
    v_mfma_f32_16x16x32_bf16 v[4:7], v[128:131], a[100:103], v[4:7]
    ds_read_b64_tr_b16 v[148:149], v222 offset:57344
    v_min_u32_e64 v108, -2, v108
    v_mfma_f32_16x16x32_bf16 v[4:7], v[132:135], a[116:119], v[4:7]
    ds_read_b64_tr_b16 v[150:151], v222 offset:59392
    v_min_u32 v109, -2, v109
    s_waitcnt lgkmcnt(4)
    v_mfma_f32_16x16x32_bf16 v[8:11], v[136:139], a[96:99], v[8:11]
    ds_read_b64_tr_b16 v[152:153], v223 offset:49152
    v_min_u32_e64 v110, -2, v110
    v_mfma_f32_16x16x32_bf16 v[8:11], v[140:143], a[112:115], v[8:11]
    ds_read_b64_tr_b16 v[154:155], v223 offset:51200
    v_min_u32_e64 v111, -2, v111
    v_mfma_f32_16x16x32_bf16 v[12:15], v[136:139], a[100:103], v[12:15]
    ds_read_b64_tr_b16 v[156:157], v223 offset:57344
    buffer_store_dwordx4 v[108:111], v228, s[8:11], s33 offen offset:3072 sc1
    v_mfma_f32_16x16x32_bf16 v[12:15], v[140:143], a[116:119], v[12:15]
    ds_read_b64_tr_b16 v[158:159], v223 offset:59392
    s_waitcnt lgkmcnt(4)
    v_mfma_f32_16x16x32_bf16 v[16:19], v[144:147], a[96:99], v[16:19]
    v_xor_b32 v216, 0x10000, v216
    ds_read_b64_tr_b16 v[128:129], v216 offset:0
    v_mfma_f32_16x16x32_bf16 v[16:19], v[148:151], a[112:115], v[16:19]
    ds_read_b64_tr_b16 v[130:131], v216 offset:2048
    v_mfma_f32_16x16x32_bf16 v[20:23], v[144:147], a[100:103], v[20:23]
    ds_read_b64_tr_b16 v[132:133], v216 offset:8192
    v_mfma_f32_16x16x32_bf16 v[20:23], v[148:151], a[116:119], v[20:23]
    ds_read_b64_tr_b16 v[134:135], v216 offset:10240
    s_waitcnt lgkmcnt(4)
    v_mfma_f32_16x16x32_bf16 v[24:27], v[152:155], a[96:99], v[24:27]
    v_xor_b32 v217, 0x10000, v217
    ds_read_b64_tr_b16 v[136:137], v217 offset:0
    v_mfma_f32_16x16x32_bf16 v[24:27], v[156:159], a[112:115], v[24:27]
    ds_read_b64_tr_b16 v[138:139], v217 offset:2048
    v_mfma_f32_16x16x32_bf16 v[28:31], v[152:155], a[100:103], v[28:31]
    ds_read_b64_tr_b16 v[140:141], v217 offset:8192
    v_mfma_f32_16x16x32_bf16 v[28:31], v[156:159], a[116:119], v[28:31]
    ds_read_b64_tr_b16 v[142:143], v217 offset:10240
    s_waitcnt lgkmcnt(4)
    v_mfma_f32_16x16x32_bf16 v[64:67], v[128:131], a[8:11], v[64:67]
    v_xor_b32 v218, 0x10000, v218
    ds_read_b64_tr_b16 v[144:145], v218 offset:0
    v_mfma_f32_16x16x32_bf16 v[64:67], v[132:135], a[24:27], v[64:67]
    ds_read_b64_tr_b16 v[146:147], v218 offset:2048
    v_mfma_f32_16x16x32_bf16 v[68:71], v[128:131], a[12:15], v[68:71]
    ds_read_b64_tr_b16 v[148:149], v218 offset:8192
    v_mfma_f32_16x16x32_bf16 v[68:71], v[132:135], a[28:31], v[68:71]
    ds_read_b64_tr_b16 v[150:151], v218 offset:10240
    s_waitcnt lgkmcnt(4)
    v_mfma_f32_16x16x32_bf16 v[72:75], v[136:139], a[8:11], v[72:75]
    v_xor_b32 v219, 0x10000, v219
    ds_read_b64_tr_b16 v[152:153], v219 offset:0
    v_mfma_f32_16x16x32_bf16 v[72:75], v[140:143], a[24:27], v[72:75]
    ds_read_b64_tr_b16 v[154:155], v219 offset:2048
    v_mfma_f32_16x16x32_bf16 v[76:79], v[136:139], a[12:15], v[76:79]
    ds_read_b64_tr_b16 v[156:157], v219 offset:8192
    v_mfma_f32_16x16x32_bf16 v[76:79], v[140:143], a[28:31], v[76:79]
    ds_read_b64_tr_b16 v[158:159], v219 offset:10240
    s_waitcnt lgkmcnt(4)
    v_mfma_f32_16x16x32_bf16 v[80:83], v[144:147], a[8:11], v[80:83]
    ds_read_b64_tr_b16 v[128:129], v216 offset:16384
    s_mul_i32 s33, s39, 12288
    s_add_u32 s33, s33, 0x5000000
    v_mfma_f32_16x16x32_bf16 v[80:83], v[148:151], a[24:27], v[80:83]
    ds_read_b64_tr_b16 v[130:131], v216 offset:18432
    v_mfma_f32_16x16x32_bf16 v[84:87], v[144:147], a[12:15], v[84:87]
    ds_read_b64_tr_b16 v[132:133], v216 offset:24576
    v_cvt_pk_bf16_f32 v0, v0, v1
    v_mfma_f32_16x16x32_bf16 v[84:87], v[148:151], a[28:31], v[84:87]
    ds_read_b64_tr_b16 v[134:135], v216 offset:26624
    v_cvt_pk_bf16_f32 v1, v2, v3
    s_waitcnt lgkmcnt(4)
    v_mfma_f32_16x16x32_bf16 v[88:91], v[152:155], a[8:11], v[88:91]
    ds_read_b64_tr_b16 v[136:137], v217 offset:16384
    v_cvt_pk_bf16_f32 v2, v4, v5
    v_mfma_f32_16x16x32_bf16 v[88:91], v[156:159], a[24:27], v[88:91]
    ds_read_b64_tr_b16 v[138:139], v217 offset:18432
    v_cvt_pk_bf16_f32 v3, v6, v7
    v_mfma_f32_16x16x32_bf16 v[92:95], v[152:155], a[12:15], v[92:95]
    ds_read_b64_tr_b16 v[140:141], v217 offset:24576
    v_min_u32_e64 v0, -2, v0
    v_mfma_f32_16x16x32_bf16 v[92:95], v[156:159], a[28:31], v[92:95]
    ds_read_b64_tr_b16 v[142:143], v217 offset:26624
    v_min_u32 v1, -2, v1
    s_waitcnt lgkmcnt(4)
    v_mfma_f32_16x16x32_bf16 v[64:67], v[128:131], a[40:43], v[64:67]
    ds_read_b64_tr_b16 v[144:145], v218 offset:16384
    v_min_u32_e64 v2, -2, v2
    v_mfma_f32_16x16x32_bf16 v[64:67], v[132:135], a[56:59], v[64:67]
    ds_read_b64_tr_b16 v[146:147], v218 offset:18432
    v_min_u32_e64 v3, -2, v3
    v_mfma_f32_16x16x32_bf16 v[68:71], v[128:131], a[44:47], v[68:71]
    ds_read_b64_tr_b16 v[148:149], v218 offset:24576
    buffer_store_dwordx4 v[0:3], v228, s[8:11], s33 offen offset:0 sc1
    v_mfma_f32_16x16x32_bf16 v[68:71], v[132:135], a[60:63], v[68:71]
    ds_read_b64_tr_b16 v[150:151], v218 offset:26624
    s_waitcnt lgkmcnt(4)
    v_mfma_f32_16x16x32_bf16 v[72:75], v[136:139], a[40:43], v[72:75]
    ds_read_b64_tr_b16 v[152:153], v219 offset:16384
    v_mfma_f32_16x16x32_bf16 v[72:75], v[140:143], a[56:59], v[72:75]
    ds_read_b64_tr_b16 v[154:155], v219 offset:18432
    v_mfma_f32_16x16x32_bf16 v[76:79], v[136:139], a[44:47], v[76:79]
    ds_read_b64_tr_b16 v[156:157], v219 offset:24576
    v_cvt_pk_bf16_f32 v4, v8, v9
    v_mfma_f32_16x16x32_bf16 v[76:79], v[140:143], a[60:63], v[76:79]
    ds_read_b64_tr_b16 v[158:159], v219 offset:26624
    v_cvt_pk_bf16_f32 v5, v10, v11
    s_waitcnt lgkmcnt(4)
    v_mfma_f32_16x16x32_bf16 v[80:83], v[144:147], a[40:43], v[80:83]
    ds_read_b64_tr_b16 v[128:129], v216 offset:32768
    v_cvt_pk_bf16_f32 v6, v12, v13
    v_mfma_f32_16x16x32_bf16 v[80:83], v[148:151], a[56:59], v[80:83]
    ds_read_b64_tr_b16 v[130:131], v216 offset:34816
    v_cvt_pk_bf16_f32 v7, v14, v15
    v_mfma_f32_16x16x32_bf16 v[84:87], v[144:147], a[44:47], v[84:87]
    ds_read_b64_tr_b16 v[132:133], v216 offset:40960
    v_min_u32_e64 v4, -2, v4
    v_mfma_f32_16x16x32_bf16 v[84:87], v[148:151], a[60:63], v[84:87]
    ds_read_b64_tr_b16 v[134:135], v216 offset:43008
    v_min_u32 v5, -2, v5
    s_waitcnt lgkmcnt(4)
    v_mfma_f32_16x16x32_bf16 v[88:91], v[152:155], a[40:43], v[88:91]
    ds_read_b64_tr_b16 v[136:137], v217 offset:32768
    v_min_u32_e64 v6, -2, v6
    v_mfma_f32_16x16x32_bf16 v[88:91], v[156:159], a[56:59], v[88:91]
    ds_read_b64_tr_b16 v[138:139], v217 offset:34816
    v_min_u32_e64 v7, -2, v7
    v_mfma_f32_16x16x32_bf16 v[92:95], v[152:155], a[44:47], v[92:95]
    ds_read_b64_tr_b16 v[140:141], v217 offset:40960
    buffer_store_dwordx4 v[4:7], v228, s[8:11], s33 offen offset:1024 sc1
    v_mfma_f32_16x16x32_bf16 v[92:95], v[156:159], a[60:63], v[92:95]
    ds_read_b64_tr_b16 v[142:143], v217 offset:43008
    s_waitcnt lgkmcnt(4)
    v_mfma_f32_16x16x32_bf16 v[64:67], v[128:131], a[72:75], v[64:67]
    ds_read_b64_tr_b16 v[144:145], v218 offset:32768
    v_mfma_f32_16x16x32_bf16 v[64:67], v[132:135], a[88:91], v[64:67]
    ds_read_b64_tr_b16 v[146:147], v218 offset:34816
    v_mfma_f32_16x16x32_bf16 v[68:71], v[128:131], a[76:79], v[68:71]
    ds_read_b64_tr_b16 v[148:149], v218 offset:40960
    v_cvt_pk_bf16_f32 v8, v16, v17
    v_mfma_f32_16x16x32_bf16 v[68:71], v[132:135], a[92:95], v[68:71]
    ds_read_b64_tr_b16 v[150:151], v218 offset:43008
    v_cvt_pk_bf16_f32 v9, v18, v19
    s_waitcnt lgkmcnt(4)
    v_mfma_f32_16x16x32_bf16 v[72:75], v[136:139], a[72:75], v[72:75]
    ds_read_b64_tr_b16 v[152:153], v219 offset:32768
    v_cvt_pk_bf16_f32 v10, v20, v21
    v_mfma_f32_16x16x32_bf16 v[72:75], v[140:143], a[88:91], v[72:75]
    ds_read_b64_tr_b16 v[154:155], v219 offset:34816
    v_cvt_pk_bf16_f32 v11, v22, v23
    v_mfma_f32_16x16x32_bf16 v[76:79], v[136:139], a[76:79], v[76:79]
    ds_read_b64_tr_b16 v[156:157], v219 offset:40960
    v_min_u32_e64 v8, -2, v8
    v_mfma_f32_16x16x32_bf16 v[76:79], v[140:143], a[92:95], v[76:79]
    ds_read_b64_tr_b16 v[158:159], v219 offset:43008
    v_min_u32 v9, -2, v9
    s_waitcnt lgkmcnt(4)
    v_mfma_f32_16x16x32_bf16 v[80:83], v[144:147], a[72:75], v[80:83]
    ds_read_b64_tr_b16 v[128:129], v216 offset:49152
    v_min_u32_e64 v10, -2, v10
    v_mfma_f32_16x16x32_bf16 v[80:83], v[148:151], a[88:91], v[80:83]
    ds_read_b64_tr_b16 v[130:131], v216 offset:51200
    v_min_u32_e64 v11, -2, v11
    v_mfma_f32_16x16x32_bf16 v[84:87], v[144:147], a[76:79], v[84:87]
    ds_read_b64_tr_b16 v[132:133], v216 offset:57344
    buffer_store_dwordx4 v[8:11], v228, s[8:11], s33 offen offset:2048 sc1
    v_mfma_f32_16x16x32_bf16 v[84:87], v[148:151], a[92:95], v[84:87]
    ds_read_b64_tr_b16 v[134:135], v216 offset:59392
    s_waitcnt lgkmcnt(4)
    v_mfma_f32_16x16x32_bf16 v[88:91], v[152:155], a[72:75], v[88:91]
    ds_read_b64_tr_b16 v[136:137], v217 offset:49152
    v_mfma_f32_16x16x32_bf16 v[88:91], v[156:159], a[88:91], v[88:91]
    ds_read_b64_tr_b16 v[138:139], v217 offset:51200
    v_mfma_f32_16x16x32_bf16 v[92:95], v[152:155], a[76:79], v[92:95]
    ds_read_b64_tr_b16 v[140:141], v217 offset:57344
    v_cvt_pk_bf16_f32 v12, v24, v25
    v_mfma_f32_16x16x32_bf16 v[92:95], v[156:159], a[92:95], v[92:95]
    ds_read_b64_tr_b16 v[142:143], v217 offset:59392
    v_cvt_pk_bf16_f32 v13, v26, v27
    s_waitcnt lgkmcnt(4)
    v_mfma_f32_16x16x32_bf16 v[64:67], v[128:131], a[104:107], v[64:67]
    ds_read_b64_tr_b16 v[144:145], v218 offset:49152
    v_cvt_pk_bf16_f32 v14, v28, v29
    v_mfma_f32_16x16x32_bf16 v[64:67], v[132:135], a[120:123], v[64:67]
    ds_read_b64_tr_b16 v[146:147], v218 offset:51200
    v_cvt_pk_bf16_f32 v15, v30, v31
    v_mfma_f32_16x16x32_bf16 v[68:71], v[128:131], a[108:111], v[68:71]
    ds_read_b64_tr_b16 v[148:149], v218 offset:57344
    v_min_u32_e64 v12, -2, v12
    v_mfma_f32_16x16x32_bf16 v[68:71], v[132:135], a[124:127], v[68:71]
    ds_read_b64_tr_b16 v[150:151], v218 offset:59392
    v_min_u32 v13, -2, v13
    s_waitcnt lgkmcnt(4)
    v_mfma_f32_16x16x32_bf16 v[72:75], v[136:139], a[104:107], v[72:75]
    ds_read_b64_tr_b16 v[152:153], v219 offset:49152
    v_min_u32_e64 v14, -2, v14
    v_mfma_f32_16x16x32_bf16 v[72:75], v[140:143], a[120:123], v[72:75]
    ds_read_b64_tr_b16 v[154:155], v219 offset:51200
    v_min_u32_e64 v15, -2, v15
    v_mfma_f32_16x16x32_bf16 v[76:79], v[136:139], a[108:111], v[76:79]
    ds_read_b64_tr_b16 v[156:157], v219 offset:57344
    buffer_store_dwordx4 v[12:15], v228, s[8:11], s33 offen offset:3072 sc1
    v_mfma_f32_16x16x32_bf16 v[76:79], v[140:143], a[124:127], v[76:79]
    ds_read_b64_tr_b16 v[158:159], v219 offset:59392
    s_waitcnt lgkmcnt(4)
    v_mfma_f32_16x16x32_bf16 v[80:83], v[144:147], a[104:107], v[80:83]
    v_xor_b32 v216, 0x10000, v216
    ds_read_b64_tr_b16 v[128:129], v216 offset:32768
    v_mfma_f32_16x16x32_bf16 v[80:83], v[148:151], a[120:123], v[80:83]
    ds_read_b64_tr_b16 v[130:131], v216 offset:34816
    v_mfma_f32_16x16x32_bf16 v[84:87], v[144:147], a[108:111], v[84:87]
    ds_read_b64_tr_b16 v[132:133], v216 offset:40960
    v_mfma_f32_16x16x32_bf16 v[84:87], v[148:151], a[124:127], v[84:87]
    ds_read_b64_tr_b16 v[134:135], v216 offset:43008
    s_waitcnt lgkmcnt(4)
    v_mfma_f32_16x16x32_bf16 v[88:91], v[152:155], a[104:107], v[88:91]
    v_xor_b32 v217, 0x10000, v217
    ds_read_b64_tr_b16 v[136:137], v217 offset:32768
    v_mfma_f32_16x16x32_bf16 v[88:91], v[156:159], a[120:123], v[88:91]
    ds_read_b64_tr_b16 v[138:139], v217 offset:34816
    v_mfma_f32_16x16x32_bf16 v[92:95], v[152:155], a[108:111], v[92:95]
    ds_read_b64_tr_b16 v[140:141], v217 offset:40960
    v_mfma_f32_16x16x32_bf16 v[92:95], v[156:159], a[124:127], v[92:95]
    ds_read_b64_tr_b16 v[142:143], v217 offset:43008
    s_waitcnt lgkmcnt(4)
    v_mfma_f32_16x16x32_bf16 v[32:35], v[128:131], a[224:227], v[32:35]
    v_xor_b32 v218, 0x10000, v218
    ds_read_b64_tr_b16 v[144:145], v218 offset:32768
    v_mfma_f32_16x16x32_bf16 v[32:35], v[132:135], a[232:235], v[32:35]
    ds_read_b64_tr_b16 v[146:147], v218 offset:34816
    buffer_load_dwordx4 v[176:179], v228, s[8:11], s7 offen offset:0 sc1
    v_mfma_f32_16x16x32_bf16 v[36:39], v[128:131], a[228:231], v[36:39]
    ds_read_b64_tr_b16 v[148:149], v218 offset:40960
    v_mfma_f32_16x16x32_bf16 v[36:39], v[132:135], a[236:239], v[36:39]
    ds_read_b64_tr_b16 v[150:151], v218 offset:43008
    buffer_load_dwordx4 v[180:183], v228, s[8:11], s7 offen offset:1024 sc1
    s_waitcnt lgkmcnt(4)
    v_mfma_f32_16x16x32_bf16 v[40:43], v[136:139], a[224:227], v[40:43]
    v_xor_b32 v219, 0x10000, v219
    ds_read_b64_tr_b16 v[152:153], v219 offset:32768
    v_mfma_f32_16x16x32_bf16 v[40:43], v[140:143], a[232:235], v[40:43]
    ds_read_b64_tr_b16 v[154:155], v219 offset:34816
    buffer_load_dwordx4 v[184:187], v228, s[8:11], s7 offen offset:2048 sc1
    v_mfma_f32_16x16x32_bf16 v[44:47], v[136:139], a[228:231], v[44:47]
    ds_read_b64_tr_b16 v[156:157], v219 offset:40960
    v_mfma_f32_16x16x32_bf16 v[44:47], v[140:143], a[236:239], v[44:47]
    ds_read_b64_tr_b16 v[158:159], v219 offset:43008
    buffer_load_dwordx4 v[188:191], v228, s[8:11], s7 offen offset:3072 sc1
    s_waitcnt lgkmcnt(4)
    v_mfma_f32_16x16x32_bf16 v[48:51], v[144:147], a[224:227], v[48:51]
    ds_read_b64_tr_b16 v[128:129], v216 offset:49152
    s_mul_i32 s33, s39, 12288
    s_add_u32 s33, s33, 0x5001000
    v_mfma_f32_16x16x32_bf16 v[48:51], v[148:151], a[232:235], v[48:51]
    ds_read_b64_tr_b16 v[130:131], v216 offset:51200
    v_mfma_f32_16x16x32_bf16 v[52:55], v[144:147], a[228:231], v[52:55]
    ds_read_b64_tr_b16 v[132:133], v216 offset:57344
    v_cvt_pk_bf16_f32 v64, v64, v65
    v_mfma_f32_16x16x32_bf16 v[52:55], v[148:151], a[236:239], v[52:55]
    ds_read_b64_tr_b16 v[134:135], v216 offset:59392
    v_cvt_pk_bf16_f32 v65, v66, v67
    s_waitcnt lgkmcnt(4)
    v_mfma_f32_16x16x32_bf16 v[56:59], v[152:155], a[224:227], v[56:59]
    ds_read_b64_tr_b16 v[136:137], v217 offset:49152
    v_cvt_pk_bf16_f32 v66, v68, v69
    v_mfma_f32_16x16x32_bf16 v[56:59], v[156:159], a[232:235], v[56:59]
    ds_read_b64_tr_b16 v[138:139], v217 offset:51200
    v_cvt_pk_bf16_f32 v67, v70, v71
    v_mfma_f32_16x16x32_bf16 v[60:63], v[152:155], a[228:231], v[60:63]
    ds_read_b64_tr_b16 v[140:141], v217 offset:57344
    v_min_u32_e64 v64, -2, v64
    v_mfma_f32_16x16x32_bf16 v[60:63], v[156:159], a[236:239], v[60:63]
    ds_read_b64_tr_b16 v[142:143], v217 offset:59392
    v_min_u32 v65, -2, v65
    s_waitcnt lgkmcnt(4)
    v_mfma_f32_16x16x32_bf16 v[32:35], v[128:131], a[240:243], v[32:35]
    ds_read_b64_tr_b16 v[144:145], v218 offset:49152
    v_min_u32_e64 v66, -2, v66
    v_mfma_f32_16x16x32_bf16 v[32:35], v[132:135], a[248:251], v[32:35]
    ds_read_b64_tr_b16 v[146:147], v218 offset:51200
    v_min_u32_e64 v67, -2, v67
    v_mfma_f32_16x16x32_bf16 v[36:39], v[128:131], a[244:247], v[36:39]
    ds_read_b64_tr_b16 v[148:149], v218 offset:57344
    buffer_store_dwordx4 v[64:67], v228, s[8:11], s33 offen offset:0 sc1
    v_mfma_f32_16x16x32_bf16 v[36:39], v[132:135], a[252:255], v[36:39]
    ds_read_b64_tr_b16 v[150:151], v218 offset:59392
    s_waitcnt lgkmcnt(4)
    v_mfma_f32_16x16x32_bf16 v[40:43], v[136:139], a[240:243], v[40:43]
    ds_read_b64_tr_b16 v[152:153], v219 offset:49152
    v_mfma_f32_16x16x32_bf16 v[40:43], v[140:143], a[248:251], v[40:43]
    ds_read_b64_tr_b16 v[154:155], v219 offset:51200
    v_mfma_f32_16x16x32_bf16 v[44:47], v[136:139], a[244:247], v[44:47]
    ds_read_b64_tr_b16 v[156:157], v219 offset:57344
    v_cvt_pk_bf16_f32 v68, v72, v73
    v_mfma_f32_16x16x32_bf16 v[44:47], v[140:143], a[252:255], v[44:47]
    ds_read_b64_tr_b16 v[158:159], v219 offset:59392
    v_cvt_pk_bf16_f32 v69, v74, v75
    s_waitcnt lgkmcnt(4)
    v_mfma_f32_16x16x32_bf16 v[48:51], v[144:147], a[240:243], v[48:51]
    v_xor_b32 v216, 0x10000, v216
    ds_read_b64_tr_b16 v[128:129], v216 offset:0
    v_cvt_pk_bf16_f32 v70, v76, v77
    v_mfma_f32_16x16x32_bf16 v[48:51], v[148:151], a[248:251], v[48:51]
    ds_read_b64_tr_b16 v[130:131], v216 offset:2048
    v_cvt_pk_bf16_f32 v71, v78, v79
    v_mfma_f32_16x16x32_bf16 v[52:55], v[144:147], a[244:247], v[52:55]
    ds_read_b64_tr_b16 v[132:133], v216 offset:8192
    v_min_u32_e64 v68, -2, v68
    v_mfma_f32_16x16x32_bf16 v[52:55], v[148:151], a[252:255], v[52:55]
    ds_read_b64_tr_b16 v[134:135], v216 offset:10240
    v_min_u32 v69, -2, v69
    s_waitcnt lgkmcnt(4)
    v_mfma_f32_16x16x32_bf16 v[56:59], v[152:155], a[240:243], v[56:59]
    v_xor_b32 v217, 0x10000, v217
    ds_read_b64_tr_b16 v[136:137], v217 offset:0
    v_min_u32_e64 v70, -2, v70
    v_mfma_f32_16x16x32_bf16 v[56:59], v[156:159], a[248:251], v[56:59]
    ds_read_b64_tr_b16 v[138:139], v217 offset:2048
    v_min_u32_e64 v71, -2, v71
    v_mfma_f32_16x16x32_bf16 v[60:63], v[152:155], a[244:247], v[60:63]
    ds_read_b64_tr_b16 v[140:141], v217 offset:8192
    buffer_store_dwordx4 v[68:71], v228, s[8:11], s33 offen offset:1024 sc1
    v_mfma_f32_16x16x32_bf16 v[60:63], v[156:159], a[252:255], v[60:63]
    ds_read_b64_tr_b16 v[142:143], v217 offset:10240
    s_waitcnt lgkmcnt(4)
    v_mfma_f32_16x16x32_bf16 v[32:35], v[128:131], a[0:3], v[32:35]
    v_xor_b32 v218, 0x10000, v218
    ds_read_b64_tr_b16 v[144:145], v218 offset:0
    v_mfma_f32_16x16x32_bf16 v[32:35], v[132:135], a[16:19], v[32:35]
    ds_read_b64_tr_b16 v[146:147], v218 offset:2048
    v_mfma_f32_16x16x32_bf16 v[36:39], v[128:131], a[4:7], v[36:39]
    ds_read_b64_tr_b16 v[148:149], v218 offset:8192
    v_cvt_pk_bf16_f32 v72, v80, v81
    v_mfma_f32_16x16x32_bf16 v[36:39], v[132:135], a[20:23], v[36:39]
    ds_read_b64_tr_b16 v[150:151], v218 offset:10240
    v_cvt_pk_bf16_f32 v73, v82, v83
    s_waitcnt lgkmcnt(4)
    v_mfma_f32_16x16x32_bf16 v[40:43], v[136:139], a[0:3], v[40:43]
    v_xor_b32 v219, 0x10000, v219
    ds_read_b64_tr_b16 v[152:153], v219 offset:0
    v_cvt_pk_bf16_f32 v74, v84, v85
    v_mfma_f32_16x16x32_bf16 v[40:43], v[140:143], a[16:19], v[40:43]
    ds_read_b64_tr_b16 v[154:155], v219 offset:2048
    v_cvt_pk_bf16_f32 v75, v86, v87
    v_mfma_f32_16x16x32_bf16 v[44:47], v[136:139], a[4:7], v[44:47]
    ds_read_b64_tr_b16 v[156:157], v219 offset:8192
    v_min_u32_e64 v72, -2, v72
    v_mfma_f32_16x16x32_bf16 v[44:47], v[140:143], a[20:23], v[44:47]
    ds_read_b64_tr_b16 v[158:159], v219 offset:10240
    v_min_u32 v73, -2, v73
    s_waitcnt lgkmcnt(4)
    v_mfma_f32_16x16x32_bf16 v[48:51], v[144:147], a[0:3], v[48:51]
    ds_read_b64_tr_b16 v[128:129], v216 offset:16384
    v_min_u32_e64 v74, -2, v74
    v_mfma_f32_16x16x32_bf16 v[48:51], v[148:151], a[16:19], v[48:51]
    ds_read_b64_tr_b16 v[130:131], v216 offset:18432
    v_min_u32_e64 v75, -2, v75
    v_mfma_f32_16x16x32_bf16 v[52:55], v[144:147], a[4:7], v[52:55]
    ds_read_b64_tr_b16 v[132:133], v216 offset:24576
    buffer_store_dwordx4 v[72:75], v228, s[8:11], s33 offen offset:2048 sc1
    v_mfma_f32_16x16x32_bf16 v[52:55], v[148:151], a[20:23], v[52:55]
    ds_read_b64_tr_b16 v[134:135], v216 offset:26624
    s_waitcnt lgkmcnt(4)
    v_mfma_f32_16x16x32_bf16 v[56:59], v[152:155], a[0:3], v[56:59]
    ds_read_b64_tr_b16 v[136:137], v217 offset:16384
    v_mfma_f32_16x16x32_bf16 v[56:59], v[156:159], a[16:19], v[56:59]
    ds_read_b64_tr_b16 v[138:139], v217 offset:18432
    v_mfma_f32_16x16x32_bf16 v[60:63], v[152:155], a[4:7], v[60:63]
    ds_read_b64_tr_b16 v[140:141], v217 offset:24576
    v_cvt_pk_bf16_f32 v76, v88, v89
    v_mfma_f32_16x16x32_bf16 v[60:63], v[156:159], a[20:23], v[60:63]
    ds_read_b64_tr_b16 v[142:143], v217 offset:26624
    v_cvt_pk_bf16_f32 v77, v90, v91
    s_waitcnt lgkmcnt(4)
    v_mfma_f32_16x16x32_bf16 v[32:35], v[128:131], a[32:35], v[32:35]
    ds_read_b64_tr_b16 v[144:145], v218 offset:16384
    v_cvt_pk_bf16_f32 v78, v92, v93
    v_mfma_f32_16x16x32_bf16 v[32:35], v[132:135], a[48:51], v[32:35]
    ds_read_b64_tr_b16 v[146:147], v218 offset:18432
    v_cvt_pk_bf16_f32 v79, v94, v95
    v_mfma_f32_16x16x32_bf16 v[36:39], v[128:131], a[36:39], v[36:39]
    ds_read_b64_tr_b16 v[148:149], v218 offset:24576
    v_min_u32_e64 v76, -2, v76
    v_mfma_f32_16x16x32_bf16 v[36:39], v[132:135], a[52:55], v[36:39]
    ds_read_b64_tr_b16 v[150:151], v218 offset:26624
    v_min_u32 v77, -2, v77
    s_waitcnt lgkmcnt(4)
    v_mfma_f32_16x16x32_bf16 v[40:43], v[136:139], a[32:35], v[40:43]
    ds_read_b64_tr_b16 v[152:153], v219 offset:16384
    v_min_u32_e64 v78, -2, v78
    v_mfma_f32_16x16x32_bf16 v[40:43], v[140:143], a[48:51], v[40:43]
    ds_read_b64_tr_b16 v[154:155], v219 offset:18432
    v_min_u32_e64 v79, -2, v79
    v_mfma_f32_16x16x32_bf16 v[44:47], v[136:139], a[36:39], v[44:47]
    ds_read_b64_tr_b16 v[156:157], v219 offset:24576
    buffer_store_dwordx4 v[76:79], v228, s[8:11], s33 offen offset:3072 sc1
    v_mfma_f32_16x16x32_bf16 v[44:47], v[140:143], a[52:55], v[44:47]
    ds_read_b64_tr_b16 v[158:159], v219 offset:26624
    s_waitcnt lgkmcnt(4)
    v_mfma_f32_16x16x32_bf16 v[48:51], v[144:147], a[32:35], v[48:51]
    ds_read_b64_tr_b16 v[128:129], v216 offset:32768
    v_mfma_f32_16x16x32_bf16 v[48:51], v[148:151], a[48:51], v[48:51]
    ds_read_b64_tr_b16 v[130:131], v216 offset:34816
    v_mfma_f32_16x16x32_bf16 v[52:55], v[144:147], a[36:39], v[52:55]
    ds_read_b64_tr_b16 v[132:133], v216 offset:40960
    v_mfma_f32_16x16x32_bf16 v[52:55], v[148:151], a[52:55], v[52:55]
    ds_read_b64_tr_b16 v[134:135], v216 offset:43008
    s_waitcnt lgkmcnt(4)
    v_mfma_f32_16x16x32_bf16 v[56:59], v[152:155], a[32:35], v[56:59]
    ds_read_b64_tr_b16 v[136:137], v217 offset:32768
    v_mfma_f32_16x16x32_bf16 v[56:59], v[156:159], a[48:51], v[56:59]
    ds_read_b64_tr_b16 v[138:139], v217 offset:34816
    v_mfma_f32_16x16x32_bf16 v[60:63], v[152:155], a[36:39], v[60:63]
    ds_read_b64_tr_b16 v[140:141], v217 offset:40960
    v_mfma_f32_16x16x32_bf16 v[60:63], v[156:159], a[52:55], v[60:63]
    ds_read_b64_tr_b16 v[142:143], v217 offset:43008
    s_waitcnt lgkmcnt(4)
    v_mfma_f32_16x16x32_bf16 v[32:35], v[128:131], a[64:67], v[32:35]
    ds_read_b64_tr_b16 v[144:145], v218 offset:32768
    v_mfma_f32_16x16x32_bf16 v[32:35], v[132:135], a[80:83], v[32:35]
    ds_read_b64_tr_b16 v[146:147], v218 offset:34816
    v_mfma_f32_16x16x32_bf16 v[36:39], v[128:131], a[68:71], v[36:39]
    ds_read_b64_tr_b16 v[148:149], v218 offset:40960
    v_mfma_f32_16x16x32_bf16 v[36:39], v[132:135], a[84:87], v[36:39]
    ds_read_b64_tr_b16 v[150:151], v218 offset:43008
    s_waitcnt lgkmcnt(4)
    v_mfma_f32_16x16x32_bf16 v[40:43], v[136:139], a[64:67], v[40:43]
    ds_read_b64_tr_b16 v[152:153], v219 offset:32768
    v_mfma_f32_16x16x32_bf16 v[40:43], v[140:143], a[80:83], v[40:43]
    ds_read_b64_tr_b16 v[154:155], v219 offset:34816
    v_mfma_f32_16x16x32_bf16 v[44:47], v[136:139], a[68:71], v[44:47]
    ds_read_b64_tr_b16 v[156:157], v219 offset:40960
    v_mfma_f32_16x16x32_bf16 v[44:47], v[140:143], a[84:87], v[44:47]
    ds_read_b64_tr_b16 v[158:159], v219 offset:43008
    s_waitcnt lgkmcnt(4)
    v_mfma_f32_16x16x32_bf16 v[48:51], v[144:147], a[64:67], v[48:51]
    ds_read_b64_tr_b16 v[128:129], v216 offset:49152
    v_mfma_f32_16x16x32_bf16 v[48:51], v[148:151], a[80:83], v[48:51]
    ds_read_b64_tr_b16 v[130:131], v216 offset:51200
    v_mfma_f32_16x16x32_bf16 v[52:55], v[144:147], a[68:71], v[52:55]
    ds_read_b64_tr_b16 v[132:133], v216 offset:57344
    v_mfma_f32_16x16x32_bf16 v[52:55], v[148:151], a[84:87], v[52:55]
    ds_read_b64_tr_b16 v[134:135], v216 offset:59392
    s_waitcnt lgkmcnt(4)
    v_mfma_f32_16x16x32_bf16 v[56:59], v[152:155], a[64:67], v[56:59]
    ds_read_b64_tr_b16 v[136:137], v217 offset:49152
    v_mfma_f32_16x16x32_bf16 v[56:59], v[156:159], a[80:83], v[56:59]
    ds_read_b64_tr_b16 v[138:139], v217 offset:51200
    v_mfma_f32_16x16x32_bf16 v[60:63], v[152:155], a[68:71], v[60:63]
    ds_read_b64_tr_b16 v[140:141], v217 offset:57344
    v_mfma_f32_16x16x32_bf16 v[60:63], v[156:159], a[84:87], v[60:63]
    ds_read_b64_tr_b16 v[142:143], v217 offset:59392
    s_waitcnt lgkmcnt(4)
    v_mfma_f32_16x16x32_bf16 v[32:35], v[128:131], a[96:99], v[32:35]
    ds_read_b64_tr_b16 v[144:145], v218 offset:49152
    v_mfma_f32_16x16x32_bf16 v[32:35], v[132:135], a[112:115], v[32:35]
    ds_read_b64_tr_b16 v[146:147], v218 offset:51200
    v_mfma_f32_16x16x32_bf16 v[36:39], v[128:131], a[100:103], v[36:39]
    ds_read_b64_tr_b16 v[148:149], v218 offset:57344
    v_mfma_f32_16x16x32_bf16 v[36:39], v[132:135], a[116:119], v[36:39]
    ds_read_b64_tr_b16 v[150:151], v218 offset:59392
    s_waitcnt lgkmcnt(4)
    v_mfma_f32_16x16x32_bf16 v[40:43], v[136:139], a[96:99], v[40:43]
    ds_read_b64_tr_b16 v[152:153], v219 offset:49152
    v_mfma_f32_16x16x32_bf16 v[40:43], v[140:143], a[112:115], v[40:43]
    ds_read_b64_tr_b16 v[154:155], v219 offset:51200
    v_mfma_f32_16x16x32_bf16 v[44:47], v[136:139], a[100:103], v[44:47]
    ds_read_b64_tr_b16 v[156:157], v219 offset:57344
    v_mfma_f32_16x16x32_bf16 v[44:47], v[140:143], a[116:119], v[44:47]
    ds_read_b64_tr_b16 v[158:159], v219 offset:59392
    s_waitcnt lgkmcnt(4)
    v_mfma_f32_16x16x32_bf16 v[48:51], v[144:147], a[96:99], v[48:51]
    buffer_load_dwordx4 v[96:99], v228, s[8:11], s37 offen offset:0 sc1
    v_mfma_f32_16x16x32_bf16 v[48:51], v[148:151], a[112:115], v[48:51]
    v_mfma_f32_16x16x32_bf16 v[52:55], v[144:147], a[100:103], v[52:55]
    buffer_load_dwordx4 v[100:103], v228, s[8:11], s37 offen offset:1024 sc1
    v_mfma_f32_16x16x32_bf16 v[52:55], v[148:151], a[116:119], v[52:55]
    s_waitcnt lgkmcnt(0)
    v_mfma_f32_16x16x32_bf16 v[56:59], v[152:155], a[96:99], v[56:59]
    buffer_load_dwordx4 v[104:107], v228, s[8:11], s37 offen offset:2048 sc1
    v_mfma_f32_16x16x32_bf16 v[56:59], v[156:159], a[112:115], v[56:59]
    v_mfma_f32_16x16x32_bf16 v[60:63], v[152:155], a[100:103], v[60:63]
    buffer_load_dwordx4 v[108:111], v228, s[8:11], s37 offen offset:3072 sc1
    v_mfma_f32_16x16x32_bf16 v[60:63], v[156:159], a[116:119], v[60:63]
kc_tail:
    buffer_load_dwordx4 v[160:163], v228, s[8:11], s38 offen offset:0 sc1
    buffer_load_dwordx4 v[164:167], v228, s[8:11], s38 offen offset:1024 sc1
    buffer_load_dwordx4 v[168:171], v228, s[8:11], s38 offen offset:2048 sc1
    buffer_load_dwordx4 v[172:175], v228, s[8:11], s38 offen offset:3072 sc1
    v_lshlrev_b32_e64 v128, 16, v192
    v_and_b32 v129, 0xffff0000, v192
    v_lshlrev_b32_e64 v130, 16, v193
    v_and_b32 v131, 0xffff0000, v193
    v_lshlrev_b32_e64 v132, 16, v194
    v_and_b32 v133, 0xffff0000, v194
    v_lshlrev_b32_e64 v134, 16, v195
    v_and_b32 v135, 0xffff0000, v195
    v_lshlrev_b32_e64 v136, 16, v196
    v_and_b32 v137, 0xffff0000, v196
    v_lshlrev_b32_e64 v138, 16, v197
    v_and_b32 v139, 0xffff0000, v197
    v_lshlrev_b32_e64 v140, 16, v198
    v_and_b32 v141, 0xffff0000, v198
    v_lshlrev_b32_e64 v142, 16, v199
    v_and_b32 v143, 0xffff0000, v199
    v_lshlrev_b32_e64 v144, 16, v200
    v_and_b32 v145, 0xffff0000, v200
    v_lshlrev_b32_e64 v146, 16, v201
    v_and_b32 v147, 0xffff0000, v201
    v_lshlrev_b32_e64 v148, 16, v202
    v_and_b32 v149, 0xffff0000, v202
    v_lshlrev_b32_e64 v150, 16, v203
    v_and_b32 v151, 0xffff0000, v203
    v_lshlrev_b32_e64 v152, 16, v204
    v_and_b32 v153, 0xffff0000, v204
    v_lshlrev_b32_e64 v154, 16, v205
    v_and_b32 v155, 0xffff0000, v205
    v_lshlrev_b32_e64 v156, 16, v206
    v_and_b32 v157, 0xffff0000, v206
    v_lshlrev_b32_e64 v158, 16, v207
    v_and_b32 v159, 0xffff0000, v207
    v_lshlrev_b32_e64 v112, 16, v208
    v_and_b32 v113, 0xffff0000, v208
    v_lshlrev_b32_e64 v114, 16, v209
    v_and_b32 v115, 0xffff0000, v209
    v_lshlrev_b32_e64 v116, 16, v210
    v_and_b32 v117, 0xffff0000, v210
    v_lshlrev_b32_e64 v118, 16, v211
    v_and_b32 v119, 0xffff0000, v211
    v_pk_add_f32 v[120:121], v[112:113], v[114:115]
    v_pk_add_f32 v[122:123], v[116:117], v[118:119]
    v_pk_add_f32 v[120:121], v[120:121], v[122:123]
    v_add_f32_e64 v196, v120, v121
    s_barrier
    s_waitcnt vmcnt(12)
    v_max3_u32 v235, v176, v177, v178
    v_max3_u32 v235, v235, v179, v180
    v_max3_u32 v235, v235, v181, v182
    v_max3_u32 v235, v235, v183, v184
    v_max3_u32 v235, v235, v185, v186
    v_max3_u32 v235, v235, v187, v188
    v_max3_u32 v235, v235, v189, v190
    v_max_u32 v235, v235, v191
    v_cmp_eq_u32 vcc, -1, v235
    s_cbranch_vccnz kc_r3
kc_r3o:
    v_lshlrev_b32 v64, 16, v176
    v_and_b32 v65, 0xffff0000, v176
    v_lshlrev_b32_e64 v66, 16, v177
    v_and_b32 v67, 0xffff0000, v177
    v_pk_add_f32 v[32:33], v[32:33], v[64:65]
    v_pk_add_f32 v[34:35], v[34:35], v[66:67]
    v_lshlrev_b32_e64 v68, 16, v178
    v_and_b32 v69, 0xffff0000, v178
    v_lshlrev_b32_e64 v70, 16, v179
    v_and_b32 v71, 0xffff0000, v179
    v_pk_add_f32 v[36:37], v[36:37], v[68:69]
    v_pk_add_f32 v[38:39], v[38:39], v[70:71]
    v_lshlrev_b32_e64 v72, 16, v180
    v_and_b32 v73, 0xffff0000, v180
    v_lshlrev_b32_e64 v74, 16, v181
    v_and_b32 v75, 0xffff0000, v181
    v_pk_add_f32 v[40:41], v[40:41], v[72:73]
    v_pk_add_f32 v[42:43], v[42:43], v[74:75]
    v_lshlrev_b32_e64 v76, 16, v182
    v_and_b32 v77, 0xffff0000, v182
    v_lshlrev_b32_e64 v78, 16, v183
    v_and_b32 v79, 0xffff0000, v183
    v_pk_add_f32 v[44:45], v[44:45], v[76:77]
    v_pk_add_f32 v[46:47], v[46:47], v[78:79]
    v_lshlrev_b32_e64 v80, 16, v184
    v_and_b32 v81, 0xffff0000, v184
    v_lshlrev_b32_e64 v82, 16, v185
    v_and_b32 v83, 0xffff0000, v185
    v_pk_add_f32 v[48:49], v[48:49], v[80:81]
    v_pk_add_f32 v[50:51], v[50:51], v[82:83]
    v_lshlrev_b32_e64 v84, 16, v186
    v_and_b32 v85, 0xffff0000, v186
    v_lshlrev_b32_e64 v86, 16, v187
    v_and_b32 v87, 0xffff0000, v187
    v_pk_add_f32 v[52:53], v[52:53], v[84:85]
    v_pk_add_f32 v[54:55], v[54:55], v[86:87]
    v_lshlrev_b32_e64 v88, 16, v188
    v_and_b32 v89, 0xffff0000, v188
    v_lshlrev_b32_e64 v90, 16, v189
    v_and_b32 v91, 0xffff0000, v189
    v_pk_add_f32 v[56:57], v[56:57], v[88:89]
    v_pk_add_f32 v[58:59], v[58:59], v[90:91]
    v_lshlrev_b32_e64 v92, 16, v190
    v_and_b32 v93, 0xffff0000, v190
    v_lshlrev_b32_e64 v94, 16, v191
    v_and_b32 v95, 0xffff0000, v191
    v_pk_add_f32 v[60:61], v[60:61], v[92:93]
    v_pk_add_f32 v[62:63], v[62:63], v[94:95]
    s_waitcnt vmcnt(4)
    v_max3_u32 v235, v96, v97, v98
    v_max3_u32 v235, v235, v99, v100
    v_max3_u32 v235, v235, v101, v102
    v_max3_u32 v235, v235, v103, v104
    v_max3_u32 v235, v235, v105, v106
    v_max3_u32 v235, v235, v107, v108
    v_max3_u32 v235, v235, v109, v110
    v_max_u32 v235, v235, v111
    v_cmp_eq_u32 vcc, -1, v235
    s_cbranch_vccnz kc_r1
kc_r1o:
    v_lshlrev_b32_e64 v64, 16, v96
    v_and_b32 v65, 0xffff0000, v96
    v_lshlrev_b32_e64 v66, 16, v97
    v_and_b32 v67, 0xffff0000, v97
    v_pk_add_f32 v[32:33], v[32:33], v[64:65]
    v_pk_add_f32 v[34:35], v[34:35], v[66:67]
    v_lshlrev_b32_e64 v68, 16, v98
    v_and_b32 v69, 0xffff0000, v98
    v_lshlrev_b32_e64 v70, 16, v99
    v_and_b32 v71, 0xffff0000, v99
    v_pk_add_f32 v[36:37], v[36:37], v[68:69]
    v_pk_add_f32 v[38:39], v[38:39], v[70:71]
    v_lshlrev_b32_e64 v72, 16, v100
    v_and_b32 v73, 0xffff0000, v100
    v_lshlrev_b32_e64 v74, 16, v101
    v_and_b32 v75, 0xffff0000, v101
    v_pk_add_f32 v[40:41], v[40:41], v[72:73]
    v_pk_add_f32 v[42:43], v[42:43], v[74:75]
    v_lshlrev_b32_e64 v76, 16, v102
    v_and_b32 v77, 0xffff0000, v102
    v_lshlrev_b32_e64 v78, 16, v103
    v_and_b32 v79, 0xffff0000, v103
    v_pk_add_f32 v[44:45], v[44:45], v[76:77]
    v_pk_add_f32 v[46:47], v[46:47], v[78:79]
    v_lshlrev_b32_e64 v80, 16, v104
    v_and_b32 v81, 0xffff0000, v104
    v_lshlrev_b32_e64 v82, 16, v105
    v_and_b32 v83, 0xffff0000, v105
    v_pk_add_f32 v[48:49], v[48:49], v[80:81]
    v_pk_add_f32 v[50:51], v[50:51], v[82:83]
    v_lshlrev_b32_e64 v84, 16, v106
    v_and_b32 v85, 0xffff0000, v106
    v_lshlrev_b32_e64 v86, 16, v107
    v_and_b32 v87, 0xffff0000, v107
    v_pk_add_f32 v[52:53], v[52:53], v[84:85]
    v_pk_add_f32 v[54:55], v[54:55], v[86:87]
    v_lshlrev_b32_e64 v88, 16, v108
    v_and_b32 v89, 0xffff0000, v108
    v_lshlrev_b32_e64 v90, 16, v109
    v_and_b32 v91, 0xffff0000, v109
    v_pk_add_f32 v[56:57], v[56:57], v[88:89]
    v_pk_add_f32 v[58:59], v[58:59], v[90:91]
    v_lshlrev_b32_e64 v92, 16, v110
    v_and_b32 v93, 0xffff0000, v110
    v_lshlrev_b32_e64 v94, 16, v111
    v_and_b32 v95, 0xffff0000, v111
    v_pk_add_f32 v[60:61], v[60:61], v[92:93]
    v_pk_add_f32 v[62:63], v[62:63], v[94:95]
    s_waitcnt vmcnt(0)
    v_max3_u32 v235, v160, v161, v162
    v_max3_u32 v235, v235, v163, v164
    v_max3_u32 v235, v235, v165, v166
    v_max3_u32 v235, v235, v167, v168
    v_max3_u32 v235, v235, v169, v170
    v_max3_u32 v235, v235, v171, v172
    v_max3_u32 v235, v235, v173, v174
    v_max_u32 v235, v235, v175
    v_cmp_eq_u32 vcc, -1, v235
    s_cbranch_vccnz kc_r2
kc_r2o:
    v_lshlrev_b32_e64 v64, 16, v160
    v_and_b32 v65, 0xffff0000, v160
    v_lshlrev_b32_e64 v66, 16, v161
    v_and_b32 v67, 0xffff0000, v161
    v_pk_add_f32 v[32:33], v[32:33], v[64:65]
    v_pk_add_f32 v[34:35], v[34:35], v[66:67]
    v_cvt_pk_bf16_f32 v0, v32, v33
    v_cvt_pk_bf16_f32 v1, v34, v35
    ds_write_b64 v238, v[0:1] offset:0
    v_lshlrev_b32_e64 v68, 16, v162
    v_and_b32 v69, 0xffff0000, v162
    v_lshlrev_b32_e64 v70, 16, v163
    v_and_b32 v71, 0xffff0000, v163
    v_pk_add_f32 v[36:37], v[36:37], v[68:69]
    v_pk_add_f32 v[38:39], v[38:39], v[70:71]
    v_cvt_pk_bf16_f32 v2, v36, v37
    v_cvt_pk_bf16_f32 v3, v38, v39
    ds_write_b64 v238, v[2:3] offset:2304
    v_lshlrev_b32_e64 v72, 16, v164
    v_and_b32 v73, 0xffff0000, v164
    v_lshlrev_b32_e64 v74, 16, v165
    v_and_b32 v75, 0xffff0000, v165
    v_pk_add_f32 v[40:41], v[40:41], v[72:73]
    v_pk_add_f32 v[42:43], v[42:43], v[74:75]
    v_cvt_pk_bf16_f32 v4, v40, v41
    v_cvt_pk_bf16_f32 v5, v42, v43
    ds_write_b64 v238, v[4:5] offset:32
    v_lshlrev_b32_e64 v76, 16, v166
    v_and_b32 v77, 0xffff0000, v166
    v_lshlrev_b32_e64 v78, 16, v167
    v_and_b32 v79, 0xffff0000, v167
    v_pk_add_f32 v[44:45], v[44:45], v[76:77]
    v_pk_add_f32 v[46:47], v[46:47], v[78:79]
    v_cvt_pk_bf16_f32 v6, v44, v45
    v_cvt_pk_bf16_f32 v7, v46, v47
    ds_write_b64 v238, v[6:7] offset:2336
    v_lshlrev_b32_e64 v80, 16, v168
    v_and_b32 v81, 0xffff0000, v168
    v_lshlrev_b32_e64 v82, 16, v169
    v_and_b32 v83, 0xffff0000, v169
    v_pk_add_f32 v[48:49], v[48:49], v[80:81]
    v_pk_add_f32 v[50:51], v[50:51], v[82:83]
    v_cvt_pk_bf16_f32 v8, v48, v49
    v_cvt_pk_bf16_f32 v9, v50, v51
    ds_write_b64 v238, v[8:9] offset:64
    v_lshlrev_b32_e64 v84, 16, v170
    v_and_b32 v85, 0xffff0000, v170
    v_lshlrev_b32_e64 v86, 16, v171
    v_and_b32 v87, 0xffff0000, v171
    v_pk_add_f32 v[52:53], v[52:53], v[84:85]
    v_pk_add_f32 v[54:55], v[54:55], v[86:87]
    v_cvt_pk_bf16_f32 v10, v52, v53
    v_cvt_pk_bf16_f32 v11, v54, v55
    ds_write_b64 v238, v[10:11] offset:2368
    v_lshlrev_b32_e64 v88, 16, v172
    v_and_b32 v89, 0xffff0000, v172
    v_lshlrev_b32_e64 v90, 16, v173
    v_and_b32 v91, 0xffff0000, v173
    v_pk_add_f32 v[56:57], v[56:57], v[88:89]
    v_pk_add_f32 v[58:59], v[58:59], v[90:91]
    v_cvt_pk_bf16_f32 v12, v56, v57
    v_cvt_pk_bf16_f32 v13, v58, v59
    ds_write_b64 v238, v[12:13] offset:96
    v_lshlrev_b32_e64 v92, 16, v174
    v_and_b32 v93, 0xffff0000, v174
    v_lshlrev_b32_e64 v94, 16, v175
    v_and_b32 v95, 0xffff0000, v175
    v_pk_add_f32 v[60:61], v[60:61], v[92:93]
    v_pk_add_f32 v[62:63], v[62:63], v[94:95]
    v_cvt_pk_bf16_f32 v14, v60, v61
    v_cvt_pk_bf16_f32 v15, v62, v63
    ds_write_b64 v238, v[14:15] offset:2400
    s_waitcnt lgkmcnt(0)
    ds_read_b128 v[16:19], v239 offset:0
    ds_read_b128 v[20:23], v239 offset:1152
    ds_read_b128 v[24:27], v239 offset:2304
    ds_read_b128 v[28:31], v239 offset:3456
    s_waitcnt lgkmcnt(3)
    v_lshlrev_b32 v64, 16, v16
    v_lshlrev_b32 v66, 16, v17
    v_lshlrev_b32 v68, 16, v18
    v_lshlrev_b32 v70, 16, v19
    v_and_b32 v65, 0xffff0000, v16
    v_and_b32 v67, 0xffff0000, v17
    v_and_b32 v69, 0xffff0000, v18
    v_and_b32 v71, 0xffff0000, v19
    v_pk_add_f32 v[64:65], v[64:65], v[128:129]
    v_pk_add_f32 v[66:67], v[66:67], v[130:131]
    v_pk_add_f32 v[68:69], v[68:69], v[132:133]
    v_pk_add_f32 v[70:71], v[70:71], v[134:135]
    v_cvt_pk_bf16_f32 v16, v64, v65
    v_cvt_pk_bf16_f32 v17, v66, v67
    v_cvt_pk_bf16_f32 v18, v68, v69
    v_cvt_pk_bf16_f32 v19, v70, v71
    v_lshlrev_b32 v64, 16, v16
    v_lshlrev_b32 v66, 16, v17
    v_lshlrev_b32 v68, 16, v18
    v_lshlrev_b32 v70, 16, v19
    v_and_b32 v65, 0xffff0000, v16
    v_and_b32 v67, 0xffff0000, v17
    v_and_b32 v69, 0xffff0000, v18
    v_and_b32 v71, 0xffff0000, v19
    s_mov_b32 s32, 0x3400000
    buffer_store_dwordx4 v[16:19], v229, s[8:11], s32 offen sc1
    v_pk_add_f32 v[160:161], v[64:65], v[66:67]
    v_pk_mul_f32 v[162:163], v[64:65], v[64:65]
    v_pk_mul_f32 v[164:165], v[64:65], v[112:113]
    v_pk_fma_f32 v[162:163], v[66:67], v[66:67], v[162:163]
    v_pk_fma_f32 v[164:165], v[66:67], v[114:115], v[164:165]
    v_pk_add_f32 v[160:161], v[160:161], v[68:69]
    v_pk_fma_f32 v[162:163], v[68:69], v[68:69], v[162:163]
    v_pk_fma_f32 v[164:165], v[68:69], v[116:117], v[164:165]
    v_pk_add_f32 v[160:161], v[160:161], v[70:71]
    v_pk_fma_f32 v[162:163], v[70:71], v[70:71], v[162:163]
    v_pk_fma_f32 v[164:165], v[70:71], v[118:119], v[164:165]
    v_add_f32 v184, v160, v161
    v_add_f32 v185, v162, v163
    v_add_f32 v186, v164, v165
    s_waitcnt lgkmcnt(2)
    v_lshlrev_b32 v72, 16, v20
    v_lshlrev_b32 v74, 16, v21
    v_lshlrev_b32 v76, 16, v22
    v_lshlrev_b32 v78, 16, v23
    v_and_b32 v73, 0xffff0000, v20
    v_and_b32 v75, 0xffff0000, v21
    v_and_b32 v77, 0xffff0000, v22
    v_and_b32 v79, 0xffff0000, v23
    v_pk_add_f32 v[72:73], v[72:73], v[136:137]
    v_pk_add_f32 v[74:75], v[74:75], v[138:139]
    v_pk_add_f32 v[76:77], v[76:77], v[140:141]
    v_pk_add_f32 v[78:79], v[78:79], v[142:143]
    v_cvt_pk_bf16_f32 v20, v72, v73
    v_cvt_pk_bf16_f32 v21, v74, v75
    v_cvt_pk_bf16_f32 v22, v76, v77
    v_cvt_pk_bf16_f32 v23, v78, v79
    v_lshlrev_b32 v72, 16, v20
    v_lshlrev_b32 v74, 16, v21
    v_lshlrev_b32 v76, 16, v22
    v_lshlrev_b32 v78, 16, v23
    v_and_b32 v73, 0xffff0000, v20
    v_and_b32 v75, 0xffff0000, v21
    v_and_b32 v77, 0xffff0000, v22
    v_and_b32 v79, 0xffff0000, v23
    s_mov_b32 s32, 0x3404000
    buffer_store_dwordx4 v[20:23], v229, s[8:11], s32 offen sc1
    v_pk_add_f32 v[166:167], v[72:73], v[74:75]
    v_pk_mul_f32 v[168:169], v[72:73], v[72:73]
    v_pk_mul_f32 v[170:171], v[72:73], v[112:113]
    v_pk_fma_f32 v[168:169], v[74:75], v[74:75], v[168:169]
    v_pk_fma_f32 v[170:171], v[74:75], v[114:115], v[170:171]
    v_pk_add_f32 v[166:167], v[166:167], v[76:77]
    v_pk_fma_f32 v[168:169], v[76:77], v[76:77], v[168:169]
    v_pk_fma_f32 v[170:171], v[76:77], v[116:117], v[170:171]
    v_pk_add_f32 v[166:167], v[166:167], v[78:79]
    v_pk_fma_f32 v[168:169], v[78:79], v[78:79], v[168:169]
    v_pk_fma_f32 v[170:171], v[78:79], v[118:119], v[170:171]
    v_add_f32 v187, v166, v167
    v_add_f32 v188, v168, v169
    v_add_f32 v189, v170, v171
    s_waitcnt lgkmcnt(1)
    v_lshlrev_b32 v80, 16, v24
    v_lshlrev_b32 v82, 16, v25
    v_lshlrev_b32 v84, 16, v26
    v_lshlrev_b32 v86, 16, v27
    v_and_b32 v81, 0xffff0000, v24
    v_and_b32 v83, 0xffff0000, v25
    v_and_b32 v85, 0xffff0000, v26
    v_and_b32 v87, 0xffff0000, v27
    v_pk_add_f32 v[80:81], v[80:81], v[144:145]
    v_pk_add_f32 v[82:83], v[82:83], v[146:147]
    v_pk_add_f32 v[84:85], v[84:85], v[148:149]
    v_pk_add_f32 v[86:87], v[86:87], v[150:151]
    v_cvt_pk_bf16_f32 v24, v80, v81
    v_cvt_pk_bf16_f32 v25, v82, v83
    v_cvt_pk_bf16_f32 v26, v84, v85
    v_cvt_pk_bf16_f32 v27, v86, v87
    v_lshlrev_b32 v80, 16, v24
    v_lshlrev_b32 v82, 16, v25
    v_lshlrev_b32 v84, 16, v26
    v_lshlrev_b32 v86, 16, v27
    v_and_b32 v81, 0xffff0000, v24
    v_and_b32 v83, 0xffff0000, v25
    v_and_b32 v85, 0xffff0000, v26
    v_and_b32 v87, 0xffff0000, v27
    s_mov_b32 s32, 0x3408000
    buffer_store_dwordx4 v[24:27], v229, s[8:11], s32 offen sc1
    v_pk_add_f32 v[172:173], v[80:81], v[82:83]
    v_pk_mul_f32 v[174:175], v[80:81], v[80:81]
    v_pk_mul_f32 v[176:177], v[80:81], v[112:113]
    v_pk_fma_f32 v[174:175], v[82:83], v[82:83], v[174:175]
    v_pk_fma_f32 v[176:177], v[82:83], v[114:115], v[176:177]
    v_pk_add_f32 v[172:173], v[172:173], v[84:85]
    v_pk_fma_f32 v[174:175], v[84:85], v[84:85], v[174:175]
    v_pk_fma_f32 v[176:177], v[84:85], v[116:117], v[176:177]
    v_pk_add_f32 v[172:173], v[172:173], v[86:87]
    v_pk_fma_f32 v[174:175], v[86:87], v[86:87], v[174:175]
    v_pk_fma_f32 v[176:177], v[86:87], v[118:119], v[176:177]
    v_add_f32 v190, v172, v173
    v_add_f32 v191, v174, v175
    v_add_f32 v192, v176, v177
    s_waitcnt lgkmcnt(0)
    v_lshlrev_b32 v88, 16, v28
    v_lshlrev_b32 v90, 16, v29
    v_lshlrev_b32 v92, 16, v30
    v_lshlrev_b32 v94, 16, v31
    v_and_b32 v89, 0xffff0000, v28
    v_and_b32 v91, 0xffff0000, v29
    v_and_b32 v93, 0xffff0000, v30
    v_and_b32 v95, 0xffff0000, v31
    v_pk_add_f32 v[88:89], v[88:89], v[152:153]
    v_pk_add_f32 v[90:91], v[90:91], v[154:155]
    v_pk_add_f32 v[92:93], v[92:93], v[156:157]
    v_pk_add_f32 v[94:95], v[94:95], v[158:159]
    v_cvt_pk_bf16_f32 v28, v88, v89
    v_cvt_pk_bf16_f32 v29, v90, v91
    v_cvt_pk_bf16_f32 v30, v92, v93
    v_cvt_pk_bf16_f32 v31, v94, v95
    v_lshlrev_b32 v88, 16, v28
    v_lshlrev_b32 v90, 16, v29
    v_lshlrev_b32 v92, 16, v30
    v_lshlrev_b32 v94, 16, v31
    v_and_b32 v89, 0xffff0000, v28
    v_and_b32 v91, 0xffff0000, v29
    v_and_b32 v93, 0xffff0000, v30
    v_and_b32 v95, 0xffff0000, v31
    s_mov_b32 s32, 0x340c000
    buffer_store_dwordx4 v[28:31], v229, s[8:11], s32 offen sc1
    v_pk_add_f32 v[178:179], v[88:89], v[90:91]
    v_pk_mul_f32 v[180:181], v[88:89], v[88:89]
    v_pk_mul_f32 v[182:183], v[88:89], v[112:113]
    v_pk_fma_f32 v[180:181], v[90:91], v[90:91], v[180:181]
    v_pk_fma_f32 v[182:183], v[90:91], v[114:115], v[182:183]
    v_pk_add_f32 v[178:179], v[178:179], v[92:93]
    v_pk_fma_f32 v[180:181], v[92:93], v[92:93], v[180:181]
    v_pk_fma_f32 v[182:183], v[92:93], v[116:117], v[182:183]
    v_pk_add_f32 v[178:179], v[178:179], v[94:95]
    v_pk_fma_f32 v[180:181], v[94:95], v[94:95], v[180:181]
    v_pk_fma_f32 v[182:183], v[94:95], v[118:119], v[182:183]
    v_add_f32 v193, v178, v179
    v_add_f32 v194, v180, v181
    v_add_f32_e64 v195, v182, v183
    v_add_f32_dpp v196, v196, v196 quad_perm:[1,0,3,2] row_mask:0xf bank_mask:0xf
    v_add_f32_dpp v184, v184, v184 quad_perm:[1,0,3,2] row_mask:0xf bank_mask:0xf
    v_add_f32_dpp v185, v185, v185 quad_perm:[1,0,3,2] row_mask:0xf bank_mask:0xf
    v_add_f32_dpp v186, v186, v186 quad_perm:[1,0,3,2] row_mask:0xf bank_mask:0xf
    v_add_f32_dpp v187, v187, v187 quad_perm:[1,0,3,2] row_mask:0xf bank_mask:0xf
    v_add_f32_dpp v188, v188, v188 quad_perm:[1,0,3,2] row_mask:0xf bank_mask:0xf
    v_add_f32_dpp v189, v189, v189 quad_perm:[1,0,3,2] row_mask:0xf bank_mask:0xf
    v_add_f32_dpp v190, v190, v190 quad_perm:[1,0,3,2] row_mask:0xf bank_mask:0xf
    v_add_f32_dpp v191, v191, v191 quad_perm:[1,0,3,2] row_mask:0xf bank_mask:0xf
    v_add_f32_dpp v192, v192, v192 quad_perm:[1,0,3,2] row_mask:0xf bank_mask:0xf
    v_add_f32_dpp v193, v193, v193 quad_perm:[1,0,3,2] row_mask:0xf bank_mask:0xf
    v_add_f32_dpp v194, v194, v194 quad_perm:[1,0,3,2] row_mask:0xf bank_mask:0xf
    v_add_f32_dpp v195, v195, v195 quad_perm:[1,0,3,2] row_mask:0xf bank_mask:0xf
    v_add_f32_dpp v196, v196, v196 quad_perm:[2,3,0,1] row_mask:0xf bank_mask:0xf
    v_add_f32_dpp v184, v184, v184 quad_perm:[2,3,0,1] row_mask:0xf bank_mask:0xf
    v_add_f32_dpp v185, v185, v185 quad_perm:[2,3,0,1] row_mask:0xf bank_mask:0xf
    v_add_f32_dpp v186, v186, v186 quad_perm:[2,3,0,1] row_mask:0xf bank_mask:0xf
    v_add_f32_dpp v187, v187, v187 quad_perm:[2,3,0,1] row_mask:0xf bank_mask:0xf
    v_add_f32_dpp v188, v188, v188 quad_perm:[2,3,0,1] row_mask:0xf bank_mask:0xf
    v_add_f32_dpp v189, v189, v189 quad_perm:[2,3,0,1] row_mask:0xf bank_mask:0xf
    v_add_f32_dpp v190, v190, v190 quad_perm:[2,3,0,1] row_mask:0xf bank_mask:0xf
    v_add_f32_dpp v191, v191, v191 quad_perm:[2,3,0,1] row_mask:0xf bank_mask:0xf
    v_add_f32_dpp v192, v192, v192 quad_perm:[2,3,0,1] row_mask:0xf bank_mask:0xf
    v_add_f32_dpp v193, v193, v193 quad_perm:[2,3,0,1] row_mask:0xf bank_mask:0xf
    v_add_f32_dpp v194, v194, v194 quad_perm:[2,3,0,1] row_mask:0xf bank_mask:0xf
    v_add_f32_dpp v195, v195, v195 quad_perm:[2,3,0,1] row_mask:0xf bank_mask:0xf
    v_add_f32_dpp v196, v196, v196 row_half_mirror row_mask:0xf bank_mask:0xf
    v_add_f32_dpp v184, v184, v184 row_half_mirror row_mask:0xf bank_mask:0xf
    v_add_f32_dpp v185, v185, v185 row_half_mirror row_mask:0xf bank_mask:0xf
    v_add_f32_dpp v186, v186, v186 row_half_mirror row_mask:0xf bank_mask:0xf
    v_add_f32_dpp v187, v187, v187 row_half_mirror row_mask:0xf bank_mask:0xf
    v_add_f32_dpp v188, v188, v188 row_half_mirror row_mask:0xf bank_mask:0xf
    v_add_f32_dpp v189, v189, v189 row_half_mirror row_mask:0xf bank_mask:0xf
    v_add_f32_dpp v190, v190, v190 row_half_mirror row_mask:0xf bank_mask:0xf
    v_add_f32_dpp v191, v191, v191 row_half_mirror row_mask:0xf bank_mask:0xf
    v_add_f32_dpp v192, v192, v192 row_half_mirror row_mask:0xf bank_mask:0xf
    v_add_f32_dpp v193, v193, v193 row_half_mirror row_mask:0xf bank_mask:0xf
    v_add_f32_dpp v194, v194, v194 row_half_mirror row_mask:0xf bank_mask:0xf
    v_add_f32_dpp v195, v195, v195 row_half_mirror row_mask:0xf bank_mask:0xf
    v_cndmask_b32 v184, v184, v187, s[60:61]
    v_cndmask_b32 v190, v190, v193, s[60:61]
    v_cndmask_b32 v185, v185, v188, s[60:61]
    v_cndmask_b32 v191, v191, v194, s[60:61]
    v_cndmask_b32 v186, v186, v189, s[60:61]
    v_cndmask_b32 v192, v192, v195, s[60:61]
    v_cndmask_b32 v184, v184, v190, s[62:63]
    v_cndmask_b32 v185, v185, v191, s[62:63]
    v_cndmask_b32 v186, v186, v192, s[62:63]
    v_cndmask_b32 v184, v184, v185, s[40:41]
    v_cndmask_b32 v186, v186, v196, s[40:41]
    buffer_atomic_add_f32 v184, v231, s[8:11], s48 offen
    buffer_atomic_add_f32 v186, v232, s[8:11], s48 offen
    s_lshl_b32 s32, s3, 13
    v_add_u32 v234, s32, v228
    v_add_u32 v235, 65536, v234
    ds_write_b128 v234, a[128:131] offset:0
    ds_write_b128 v234, a[132:135] offset:1024
    ds_write_b128 v234, a[136:139] offset:2048
    ds_write_b128 v234, a[140:143] offset:3072
    ds_write_b128 v234, a[144:147] offset:4096
    ds_write_b128 v234, a[148:151] offset:5120
    ds_write_b128 v234, a[152:155] offset:6144
    ds_write_b128 v234, a[156:159] offset:7168
    s_waitcnt lgkmcnt(4)
    ds_write_b128 v234, a[160:163] offset:32768
    ds_write_b128 v234, a[164:167] offset:33792
    ds_write_b128 v234, a[168:171] offset:34816
    ds_write_b128 v234, a[172:175] offset:35840
    ds_write_b128 v234, a[176:179] offset:36864
    ds_write_b128 v234, a[180:183] offset:37888
    ds_write_b128 v234, a[184:187] offset:38912
    ds_write_b128 v234, a[188:191] offset:39936
    s_waitcnt lgkmcnt(4)
    ds_write_b128 v235, a[192:195] offset:0
    ds_write_b128 v235, a[196:199] offset:1024
    ds_write_b128 v235, a[200:203] offset:2048
    ds_write_b128 v235, a[204:207] offset:3072
    ds_write_b128 v235, a[208:211] offset:4096
    ds_write_b128 v235, a[212:215] offset:5120
    ds_write_b128 v235, a[216:219] offset:6144
    ds_write_b128 v235, a[220:223] offset:7168
    s_waitcnt lgkmcnt(4)
    s_lshl_b32 s35, s3, 13
    v_bfe_u32 v234, v237, 2, 3
    v_lshrrev_b32_e64 v235, 5, v237
    v_lshl_add_u32 v234, v235, 4, v234
    v_lshlrev_b32 v234, 5, v234
    v_and_b32 v236, 3, v237
    v_lshl_add_u32 v234, v236, 3, v234
    v_add_u32 v217, s35, v234
    v_lshlrev_b32 v235, 5, v235
    v_bfe_u32 v236, v237, 4, 1
    v_lshl_add_u32 v235, v236, 3, v235
    v_and_b32_e64 v236, 1, v237
    v_lshl_add_u32 v235, v236, 11, v235
    s_lshl_b32 s32, s3, 9
    s_add_u32 s32, s32, 98304
    v_add_u32 v218, s32, v235
    v_lshlrev_b32_e64 v234, 4, v230
    v_add_u32 v220, 106752, v234
    v_add_u32 v221, 106752, v228
    v_lshrrev_b32 v236, 2, v237
    v_lshlrev_b32 v236, 7, v236
    v_and_b32_e64 v234, 3, v237
    v_lshl_add_u32 v236, v234, 3, v236
    s_add_u32 s32, s35, 65536
    v_add_u32 v219, s32, v236
    s_lshl_b32 s32, s3, 12
    s_add_u32 s32, s32, 114944
    v_and_b32 v234, 15, v237
    v_min_u32 v234, 2, v234
    v_lshlrev_b32 v234, 10, v234
    v_lshrrev_b32 v235, 4, v237
    v_lshl_add_u32 v234, v235, 4, v234
    v_add_u32 v222, s32, v234
    v_add_u32 v223, s32, v228
    s_mov_b32 s12, 0x00030003
    s_mov_b32 s13, 0x00030003
    s_lshl_b64 s[14:15], s[12:13], 2
    s_lshl_b64 s[16:17], s[12:13], 4
    s_lshl_b64 s[18:19], s[12:13], 6
    s_lshl_b64 s[20:21], s[12:13], 8
    s_lshl_b64 s[22:23], s[12:13], 10
    s_lshl_b64 s[24:25], s[12:13], 12
    s_lshl_b64 s[26:27], s[12:13], 14
    v_and_b32 v234, 1, v237
    v_lshlrev_b32_e64 v234, 12, v234
    v_bfe_u32 v235, v237, 1, 3
    v_lshl_add_u32 v234, v235, 6, v234
    v_lshrrev_b32_e64 v235, 4, v237
    v_lshl_add_u32 v222, v235, 4, v234
    s_lshl_b32 s38, s54, 13
    s_lshl_b32 s33, s3, 10
    s_add_u32 s38, s38, s33
    s_add_u32 s38, s38, 0x3900000
    s_waitcnt vmcnt(0)
    s_barrier
    s_cmp_lg_u32 s3, 0
    s_cbranch_scc1 kc_a1
    s_lshl_b32 s32, s52, 7
    s_add_u32 s32, s32, 0x38a0000
    v_mov_b32_e64 v235, 1
    buffer_atomic_add v235, v243, s[8:11], s32 offen sc0 sc1
    v_lshlrev_b32 v234, 7, v237
    v_cmp_gt_u32 vcc, 8, v237
    v_mov_b32_e64 v236, 0x40000000
    s_mov_b32 s34, 0x38a0400
    v_cndmask_b32 v234, v236, v234, vcc
    s_waitcnt vmcnt(0)
    v_readfirstlane_b32 s36, v235
    s_cmp_lg_u32 s36, 31
    s_cbranch_scc1 kc_a1
    buffer_atomic_add v233, v234, s[8:11], s34 offen sc1
kc_a1:
    s_waitcnt lgkmcnt(0)
    ds_read_b64_tr_b16 a[0:1], v217 offset:0
    ds_read_b64_tr_b16 a[2:3], v217 offset:256
    ds_read_b64_tr_b16 a[32:33], v217 offset:32768
    ds_read_b64_tr_b16 a[34:35], v217 offset:33024
    ds_read_b64_tr_b16 a[4:5], v217 offset:1024
    ds_read_b64_tr_b16 a[6:7], v217 offset:1280
    ds_read_b64_tr_b16 a[36:37], v217 offset:33792
    ds_read_b64_tr_b16 a[38:39], v217 offset:34048
    s_waitcnt lgkmcnt(6)
    ds_read_b64_tr_b16 a[8:9], v217 offset:2048
    ds_read_b64_tr_b16 a[10:11], v217 offset:2304
    ds_read_b64_tr_b16 a[40:41], v217 offset:34816
    ds_read_b64_tr_b16 a[42:43], v217 offset:35072
    ds_read_b64_tr_b16 a[12:13], v217 offset:3072
    ds_read_b64_tr_b16 a[14:15], v217 offset:3328
    ds_read_b64_tr_b16 a[44:45], v217 offset:35840
    ds_read_b64_tr_b16 a[46:47], v217 offset:36096
    s_waitcnt lgkmcnt(6)
    ds_read_b64_tr_b16 a[16:17], v217 offset:4096
    ds_read_b64_tr_b16 a[18:19], v217 offset:4352
    ds_read_b64_tr_b16 a[48:49], v217 offset:36864
    ds_read_b64_tr_b16 a[50:51], v217 offset:37120
    ds_read_b64_tr_b16 a[20:21], v217 offset:5120
    ds_read_b64_tr_b16 a[22:23], v217 offset:5376
    ds_read_b64_tr_b16 a[52:53], v217 offset:37888
    ds_read_b64_tr_b16 a[54:55], v217 offset:38144
    s_waitcnt lgkmcnt(6)
    ds_read_b64_tr_b16 a[24:25], v217 offset:6144
    ds_read_b64_tr_b16 a[26:27], v217 offset:6400
    ds_read_b64_tr_b16 a[56:57], v217 offset:38912
    ds_read_b64_tr_b16 a[58:59], v217 offset:39168
    ds_read_b64_tr_b16 a[28:29], v217 offset:7168
    ds_read_b64_tr_b16 a[30:31], v217 offset:7424
    ds_read_b64_tr_b16 a[60:61], v217 offset:39936
    ds_read_b64_tr_b16 a[62:63], v217 offset:40192
    s_waitcnt lgkmcnt(6)
    ds_read_b64_tr_b16 a[64:65], v219 offset:0
    ds_read_b64_tr_b16 a[66:67], v219 offset:32
    ds_read_b64_tr_b16 a[68:69], v219 offset:64
    ds_read_b64_tr_b16 a[70:71], v219 offset:96
    ds_read_b64_tr_b16 a[72:73], v219 offset:2048
    ds_read_b64_tr_b16 a[74:75], v219 offset:2080
    ds_read_b64_tr_b16 a[76:77], v219 offset:2112
    ds_read_b64_tr_b16 a[78:79], v219 offset:2144
    s_waitcnt lgkmcnt(6)
    ds_read_b64_tr_b16 a[80:81], v219 offset:4096
    ds_read_b64_tr_b16 a[82:83], v219 offset:4128
    ds_read_b64_tr_b16 a[84:85], v219 offset:4160
    ds_read_b64_tr_b16 a[86:87], v219 offset:4192
    ds_read_b64_tr_b16 a[88:89], v219 offset:6144
    ds_read_b64_tr_b16 a[90:91], v219 offset:6176
    ds_read_b64_tr_b16 a[92:93], v219 offset:6208
    ds_read_b64_tr_b16 a[94:95], v219 offset:6240
    s_waitcnt lgkmcnt(6)
    v_mov_b32 v130, 0x3a800000
    v_mov_b32 v131, 0x3a800000
    v_mov_b32 v132, 0x3727c5ac
    v_mov_b32 v133, 0x3727c5ac
    s_mov_b32 s33, 0xfffff800
    s_lshl_b32 s39, s3, 11
    v_add_u32 v238, s39, v228
    v_lshlrev_b32 v239, 2, v242
    s_lshl_b32 s39, s3, 3
    s_add_u32 s7, s39, 106512
    v_lshlrev_b32 v141, 5, v237
    v_or_b32_e64 v141, s39, v141
    s_cmp_lg_u32 s3, 0
    s_cbranch_scc1 kc_b12
    s_lshl_b32 s32, s52, 7
    s_add_u32 s32, s32, 0x38a0400
    s_mov_b32 s34, 0x100000
    s_branch kc_b11
kc_b10:
    s_sleep 2
kc_b11:
    buffer_load_dword v235, off, s[8:11], s32 sc1
    s_waitcnt vmcnt(0)
    v_cmp_ne_u32 vcc, 8, v235
    s_sub_u32 s34, s34, 1
    s_cbranch_scc1 kc_b12
    s_cbranch_vccnz kc_b10
kc_b12:
    s_barrier
    s_add_u32 s32, s48, 24576
    buffer_load_dword v128, off, s[8:11], s32 sc1
    buffer_load_dwordx4 v[32:35], v238, s[8:11], s48 offen offset:0 sc1
    buffer_load_dwordx4 v[40:43], v238, s[8:11], s49 offen offset:0 sc1
    buffer_load_dwordx4 v[48:51], v238, s[8:11], s50 offen offset:0 sc1
    buffer_load_dwordx4 v[36:39], v238, s[8:11], s48 offen offset:1024 sc1
    buffer_load_dwordx4 v[44:47], v238, s[8:11], s49 offen offset:1024 sc1
    buffer_load_dwordx4 v[52:55], v238, s[8:11], s50 offen offset:1024 sc1
    buffer_load_dword v0, v239, s[8:11], s48 offen offset:0 sc1
    buffer_load_dword v4, v239, s[8:11], s49 offen offset:0 sc1
    buffer_load_dword v1, v239, s[8:11], s48 offen offset:32 sc1
    buffer_load_dword v5, v239, s[8:11], s49 offen offset:32 sc1
    buffer_load_dword v2, v239, s[8:11], s48 offen offset:64 sc1
    buffer_load_dword v6, v239, s[8:11], s49 offen offset:64 sc1
    buffer_load_dword v3, v239, s[8:11], s48 offen offset:96 sc1
    buffer_load_dword v7, v239, s[8:11], s49 offen offset:96 sc1
    s_waitcnt vmcnt(8)
    v_mov_b32 v129, v128
    v_pk_mul_f32 v[32:33], v[32:33], v[130:131]
    v_pk_mul_f32 v[34:35], v[34:35], v[130:131]
    v_pk_mul_f32 v[36:37], v[36:37], v[130:131]
    v_pk_mul_f32 v[38:39], v[38:39], v[130:131]
    v_pk_fma_f32 v[40:41], v[40:41], v[130:131], v[132:133]
    v_pk_fma_f32 v[42:43], v[42:43], v[130:131], v[132:133]
    v_pk_fma_f32 v[44:45], v[44:45], v[130:131], v[132:133]
    v_pk_fma_f32 v[46:47], v[46:47], v[130:131], v[132:133]
    v_pk_fma_f32 v[40:41], v[32:33], v[32:33], v[40:41] neg_lo:[1,0,0] neg_hi:[1,0,0]
    v_pk_fma_f32 v[42:43], v[34:35], v[34:35], v[42:43] neg_lo:[1,0,0] neg_hi:[1,0,0]
    v_pk_fma_f32 v[44:45], v[36:37], v[36:37], v[44:45] neg_lo:[1,0,0] neg_hi:[1,0,0]
    v_pk_fma_f32 v[46:47], v[38:39], v[38:39], v[46:47] neg_lo:[1,0,0] neg_hi:[1,0,0]
    v_pk_fma_f32 v[48:49], v[32:33], v[128:129], v[48:49] neg_lo:[1,0,0] neg_hi:[1,0,0]
    v_pk_fma_f32 v[50:51], v[34:35], v[128:129], v[50:51] neg_lo:[1,0,0] neg_hi:[1,0,0]
    v_pk_fma_f32 v[52:53], v[36:37], v[128:129], v[52:53] neg_lo:[1,0,0] neg_hi:[1,0,0]
    v_pk_fma_f32 v[54:55], v[38:39], v[128:129], v[54:55] neg_lo:[1,0,0] neg_hi:[1,0,0]
    v_max_f32 v40, v40, v132
    v_max_f32 v42, v42, v132
    v_max_f32 v44, v44, v132
    v_max_f32 v46, v46, v132
    v_max_f32 v41, v41, v132
    v_max_f32 v43, v43, v132
    v_max_f32 v45, v45, v132
    v_max_f32 v47, v47, v132
    v_rsq_f32 v40, v40
    v_rsq_f32 v42, v42
    v_rsq_f32 v44, v44
    v_rsq_f32 v46, v46
    v_rsq_f32 v41, v41
    v_rsq_f32 v43, v43
    v_rsq_f32 v45, v45
    v_rsq_f32 v47, v47
    v_pk_mul_f32 v[48:49], v[48:49], v[40:41]
    v_pk_mul_f32 v[50:51], v[50:51], v[42:43]
    v_pk_mul_f32 v[52:53], v[52:53], v[44:45]
    v_pk_mul_f32 v[54:55], v[54:55], v[46:47]
    v_and_or_b32 v48, v48, s33, 0
    v_and_or_b32 v50, v50, s33, 2
    v_and_or_b32 v52, v52, s33, 4
    v_and_or_b32 v54, v54, s33, 6
    v_and_or_b32 v49, v49, s33, 1
    v_and_or_b32 v51, v51, s33, 3
    v_and_or_b32 v53, v53, s33, 5
    v_and_or_b32 v55, v55, s33, 7
    v_max_f32 v136, v48, v49
    v_min_f32 v137, v48, v49
    v_med3_f32 v137, v136, v50, v137
    v_max_f32_e64 v136, v136, v50
    v_med3_f32 v137, v136, v51, v137
    v_max_f32_e64 v136, v136, v51
    v_med3_f32 v137, v136, v52, v137
    v_max_f32_e64 v136, v136, v52
    v_med3_f32 v137, v136, v53, v137
    v_max_f32_e64 v136, v136, v53
    v_med3_f32 v137, v136, v54, v137
    v_max_f32_e64 v136, v136, v54
    v_med3_f32 v137, v136, v55, v137
    v_max_f32 v136, v136, v55
    v_or_b32 v136, v141, v136
    v_or_b32 v137, v141, v137
    s_nop 1
    v_mov_b32_dpp v138, v136 quad_perm:[1,0,3,2] row_mask:0xf bank_mask:0xf
    v_mov_b32_dpp v139, v137 quad_perm:[1,0,3,2] row_mask:0xf bank_mask:0xf
    v_min_f32 v140, v136, v138
    v_max_f32 v136, v136, v138
    v_max3_f32 v137, v140, v137, v139
    s_nop 1
    v_mov_b32_dpp v138, v136 quad_perm:[2,3,0,1] row_mask:0xf bank_mask:0xf
    v_mov_b32_dpp v139, v137 quad_perm:[2,3,0,1] row_mask:0xf bank_mask:0xf
    v_min_f32 v140, v136, v138
    v_max_f32_e64 v136, v136, v138
    v_max3_f32 v137, v140, v137, v139
    s_nop 1
    v_mov_b32_dpp v138, v136 row_half_mirror row_mask:0xf bank_mask:0xf
    v_mov_b32_dpp v139, v137 row_half_mirror row_mask:0xf bank_mask:0xf
    v_min_f32 v140, v136, v138
    v_max_f32_e64 v136, v136, v138
    v_max3_f32 v137, v140, v137, v139
    s_nop 1
    v_mov_b32_dpp v138, v136 row_mirror row_mask:0xf bank_mask:0xf
    v_mov_b32_dpp v139, v137 row_mirror row_mask:0xf bank_mask:0xf
    v_min_f32 v140, v136, v138
    v_max_f32_e64 v136, v136, v138
    v_max3_f32 v137, v140, v137, v139
    v_mov_b32 v138, v136
    v_mov_b32 v139, v137
    s_nop 1
    v_permlane16_swap_b32 v136, v138
    v_permlane16_swap_b32 v137, v139
    s_nop 0
    v_min_f32 v140, v136, v138
    v_max_f32 v136, v136, v138
    v_max3_f32 v137, v140, v137, v139
    v_mov_b32 v138, v136
    v_mov_b32 v139, v137
    s_nop 1
    v_permlane32_swap_b32 v136, v138
    v_permlane32_swap_b32 v137, v139
    s_nop 0
    v_min_f32 v140, v136, v138
    v_max_f32 v136, v136, v138
    v_max3_f32 v137, v140, v137, v139
    v_mov_b32_e64 v234, s7
    ds_write_b64 v234, v[136:137]
    v_mov_b32 v234, 106512
    s_waitcnt lgkmcnt(0)
    s_barrier
    ds_read_b128 v[56:59], v234
    ds_read_b128 v[60:63], v234 offset:16
    s_waitcnt lgkmcnt(0)
    v_min_f32 v140, v56, v58
    v_max_f32_e64 v56, v56, v58
    v_max3_f32 v57, v140, v57, v59
    v_min_f32 v140, v60, v62
    v_max_f32 v60, v60, v62
    v_max3_f32 v61, v140, v61, v63
    v_min_f32 v140, v56, v60
    v_max_f32 v56, v56, v60
    v_max3_f32 v57, v140, v57, v61
    v_bfe_u32 v234, v56, 5, 6
    v_bfe_u32 v235, v56, 2, 3
    v_and_b32_e64 v8, 3, v56
    v_lshl_add_u32 v8, v234, 2, v8
    v_lshl_add_u32 v8, v235, 8, v8
    v_bfe_u32 v234, v57, 5, 6
    v_bfe_u32 v235, v57, 2, 3
    v_and_b32_e64 v10, 3, v57
    v_lshl_add_u32 v10, v234, 2, v10
    v_lshl_add_u32 v10, v235, 8, v10
    s_cmp_lt_u32 s3, 2
    s_cselect_b64 vcc, -1, 0
    v_lshlrev_b32 v236, 4, v230
    v_cndmask_b32 v142, v10, v8, vcc
    v_lshlrev_b32_e64 v234, 2, v142
    v_and_b32 v235, 2047, v236
    v_lshl_add_u32 v235, v142, 11, v235
    s_mov_b32 s32, 0x3400000
    buffer_load_dwordx4 v[32:35], v235, s[8:11], s32 offen sc1
    buffer_load_dword v144, v234, s[8:11], s48 offen sc1
    buffer_load_dword v145, v234, s[8:11], s49 offen sc1
    buffer_load_dword v146, v234, s[8:11], s50 offen sc1
    v_add_u32 v236, 98304, v236
    s_lshr_b32 s32, s3, 1
    s_lshl_b32 s32, s32, 2
    s_add_u32 s32, s32, 106496
    v_mov_b32 v234, s32
    s_waitcnt vmcnt(4)
    v_mul_f32 v0, 0x3a800000, v0
    v_mul_f32 v1, 0x3a800000, v1
    v_mul_f32 v2, 0x3a800000, v2
    v_mul_f32 v3, 0x3a800000, v3
    v_mul_f32 v4, 0x3a800000, v4
    v_mul_f32 v5, 0x3a800000, v5
    v_mul_f32 v6, 0x3a800000, v6
    v_mul_f32 v7, 0x3a800000, v7
    v_fma_f32 v4, -v0, v0, v4
    v_fma_f32 v5, -v1, v1, v5
    v_fma_f32 v6, -v2, v2, v6
    v_fma_f32 v7, -v3, v3, v7
    v_max_f32 v4, 0, v4
    v_max_f32 v5, 0, v5
    v_max_f32 v6, 0, v6
    v_max_f32 v7, 0, v7
    v_cvt_pk_bf16_f32 v12, v0, v4
    v_cvt_pk_bf16_f32 v13, v1, v5
    v_cvt_pk_bf16_f32 v14, v2, v6
    v_cvt_pk_bf16_f32 v15, v3, v7
    v_lshlrev_b32 v0, 16, v12
    v_lshlrev_b32 v1, 16, v13
    v_lshlrev_b32 v2, 16, v14
    v_lshlrev_b32 v3, 16, v15
    v_and_b32 v4, 0xffff0000, v12
    v_and_b32 v5, 0xffff0000, v13
    v_and_b32 v6, 0xffff0000, v14
    v_and_b32 v7, 0xffff0000, v15
    v_add_f32 v4, 0x3727c5ac, v4
    v_add_f32 v5, 0x3727c5ac, v5
    v_add_f32 v6, 0x3727c5ac, v6
    v_add_f32 v7, 0x3727c5ac, v7
    v_cvt_pk_bf16_f32 v4, v4, v4
    v_cvt_pk_bf16_f32 v5, v5, v5
    v_cvt_pk_bf16_f32 v6, v6, v6
    v_cvt_pk_bf16_f32 v7, v7, v7
    v_lshlrev_b32 v4, 16, v4
    v_lshlrev_b32 v5, 16, v5
    v_lshlrev_b32 v6, 16, v6
    v_lshlrev_b32 v7, 16, v7
    v_sqrt_f32 v4, v4
    v_sqrt_f32 v5, v5
    v_sqrt_f32 v6, v6
    v_sqrt_f32 v7, v7
    v_cvt_pk_bf16_f32 v4, v4, v4
    v_cvt_pk_bf16_f32 v5, v5, v5
    v_cvt_pk_bf16_f32 v6, v6, v6
    v_cvt_pk_bf16_f32 v7, v7, v7
    v_lshlrev_b32 v4, 16, v4
    v_lshlrev_b32 v5, 16, v5
    v_lshlrev_b32 v6, 16, v6
    v_lshlrev_b32 v7, 16, v7
    v_rcp_f32 v4, v4
    v_rcp_f32 v5, v5
    v_rcp_f32 v6, v6
    v_rcp_f32_e64 v7, v7
    s_waitcnt vmcnt(0)
    v_mul_f32 v144, 0x3a800000, v144
    v_mul_f32 v145, 0x3a800000, v145
    v_fma_f32 v145, -v144, v144, v145
    v_max_f32_e64 v145, 0, v145
    v_cvt_pk_bf16_f32 v140, v144, v145
    v_lshlrev_b32_e64 v144, 16, v140
    v_and_b32 v145, 0xffff0000, v140
    v_add_f32 v145, 0x3727c5ac, v145
    v_cvt_pk_bf16_f32 v145, v145, v145
    v_lshlrev_b32_e64 v145, 16, v145
    v_sqrt_f32 v145, v145
    s_nop 0
    v_cvt_pk_bf16_f32 v145, v145, v145
    v_lshlrev_b32 v145, 16, v145
    v_rcp_f32 v145, v145
    s_nop 0
    v_lshlrev_b32 v64, 16, v32
    v_lshlrev_b32 v66, 16, v33
    v_lshlrev_b32 v68, 16, v34
    v_lshlrev_b32_e64 v70, 16, v35
    v_and_b32 v65, 0xffff0000, v32
    v_and_b32 v67, 0xffff0000, v33
    v_and_b32 v69, 0xffff0000, v34
    v_and_b32 v71, 0xffff0000, v35
    v_sub_f32 v64, v64, v144
    v_sub_f32 v66, v66, v144
    v_sub_f32 v68, v68, v144
    v_sub_f32 v70, v70, v144
    v_sub_f32 v65, v65, v144
    v_sub_f32 v67, v67, v144
    v_sub_f32 v69, v69, v144
    v_sub_f32 v71, v71, v144
    v_cvt_pk_bf16_f32 v65, v64, v65
    v_cvt_pk_bf16_f32 v67, v66, v67
    v_cvt_pk_bf16_f32 v69, v68, v69
    v_cvt_pk_bf16_f32 v71, v70, v71
    v_lshlrev_b32 v64, 16, v65
    v_lshlrev_b32 v66, 16, v67
    v_lshlrev_b32 v68, 16, v69
    v_lshlrev_b32 v70, 16, v71
    v_and_b32 v65, 0xffff0000, v65
    v_and_b32 v67, 0xffff0000, v67
    v_and_b32 v69, 0xffff0000, v69
    v_and_b32 v71, 0xffff0000, v71
    v_mul_f32 v64, v64, v145
    v_mul_f32 v66, v66, v145
    v_mul_f32 v68, v68, v145
    v_mul_f32 v70, v70, v145
    v_mul_f32 v65, v65, v145
    v_mul_f32 v67, v67, v145
    v_mul_f32 v69, v69, v145
    v_mul_f32 v71, v71, v145
    v_cvt_pk_bf16_f32 v48, v64, v65
    v_cvt_pk_bf16_f32 v49, v66, v67
    v_cvt_pk_bf16_f32 v50, v68, v69
    v_cvt_pk_bf16_f32 v51, v70, v71
    ds_write_b128 v236, v[48:51]
    ds_write_b128 v236, v[32:35] offset:4096
    v_fma_f32 v143, -v144, v128, v146
    v_mul_f32_e64 v143, v143, v145
    ds_write_b32 v234, v143
    s_waitcnt lgkmcnt(0)
kc_com:
    s_barrier
    s_cmp_ge_u32 s53, 28
    s_cbranch_scc1 kc_red
    ds_read_b64 v[96:97], v218 offset:0
    ds_read_b64 v[98:99], v218 offset:16
    ds_read_b64 v[100:101], v218 offset:64
    ds_read_b64 v[102:103], v218 offset:80
    ds_read_b64 v[104:105], v218 offset:128
    ds_read_b64 v[106:107], v218 offset:144
    ds_read_b64 v[108:109], v218 offset:192
    ds_read_b64 v[110:111], v218 offset:208
    ds_read_b64 v[112:113], v218 offset:256
    ds_read_b64 v[114:115], v218 offset:272
    ds_read_b64 v[116:117], v218 offset:320
    ds_read_b64 v[118:119], v218 offset:336
    ds_read_b64 v[120:121], v218 offset:384
    ds_read_b64 v[122:123], v218 offset:400
    s_waitcnt lgkmcnt(12)
    ds_read_b64 v[124:125], v218 offset:448
    ds_read_b64 v[126:127], v218 offset:464
    v_mfma_f32_16x16x32_bf16 v[128:131], a[0:3], v[96:99], 0
    v_mfma_f32_16x16x32_bf16 v[132:135], a[32:35], v[96:99], 0
    s_waitcnt lgkmcnt(12)
    v_mfma_f32_16x16x32_bf16 v[128:131], a[4:7], v[100:103], v[128:131]
    v_mfma_f32_16x16x32_bf16 v[132:135], a[36:39], v[100:103], v[132:135]
    s_waitcnt lgkmcnt(10)
    v_mfma_f32_16x16x32_bf16 v[128:131], a[8:11], v[104:107], v[128:131]
    v_mfma_f32_16x16x32_bf16 v[132:135], a[40:43], v[104:107], v[132:135]
    s_waitcnt lgkmcnt(8)
    v_mfma_f32_16x16x32_bf16 v[128:131], a[12:15], v[108:111], v[128:131]
    v_mfma_f32_16x16x32_bf16 v[132:135], a[44:47], v[108:111], v[132:135]
    s_waitcnt lgkmcnt(6)
    v_mfma_f32_16x16x32_bf16 v[128:131], a[16:19], v[112:115], v[128:131]
    v_mfma_f32_16x16x32_bf16 v[132:135], a[48:51], v[112:115], v[132:135]
    s_waitcnt lgkmcnt(4)
    v_mfma_f32_16x16x32_bf16 v[128:131], a[20:23], v[116:119], v[128:131]
    v_mfma_f32_16x16x32_bf16 v[132:135], a[52:55], v[116:119], v[132:135]
    s_waitcnt lgkmcnt(2)
    v_mfma_f32_16x16x32_bf16 v[128:131], a[24:27], v[120:123], v[128:131]
    v_mfma_f32_16x16x32_bf16 v[132:135], a[56:59], v[120:123], v[132:135]
    s_waitcnt lgkmcnt(0)
    v_mfma_f32_16x16x32_bf16 v[128:131], a[28:31], v[124:127], v[128:131]
    v_mfma_f32_16x16x32_bf16 v[132:135], a[60:63], v[124:127], v[132:135]
    s_nop 6
    ds_write_b128 v220, v[128:131]
    ds_write_b128 v220, v[132:135] offset:4096
    s_waitcnt lgkmcnt(0)
    s_barrier
    ds_read_b128 v[32:35], v221 offset:0
    ds_read_b128 v[48:51], v221 offset:4096
    ds_read_b128 v[36:39], v221 offset:1024
    ds_read_b128 v[52:55], v221 offset:5120
    ds_read_b128 v[40:43], v221 offset:2048
    ds_read_b128 v[56:59], v221 offset:6144
    ds_read_b128 v[44:47], v221 offset:3072
    ds_read_b128 v[60:63], v221 offset:7168
    s_waitcnt lgkmcnt(0)
    v_pk_add_f32 v[32:33], v[32:33], v[36:37]
    v_pk_add_f32 v[34:35], v[34:35], v[38:39]
    v_pk_add_f32 v[40:41], v[40:41], v[44:45]
    v_pk_add_f32 v[42:43], v[42:43], v[46:47]
    v_pk_add_f32 v[48:49], v[48:49], v[52:53]
    v_pk_add_f32 v[50:51], v[50:51], v[54:55]
    v_pk_add_f32 v[56:57], v[56:57], v[60:61]
    v_pk_add_f32 v[58:59], v[58:59], v[62:63]
    v_pk_add_f32 v[32:33], v[32:33], v[40:41]
    v_pk_add_f32 v[34:35], v[34:35], v[42:43]
    v_pk_add_f32 v[48:49], v[48:49], v[56:57]
    v_pk_add_f32 v[50:51], v[50:51], v[58:59]
    v_cvt_pk_bf16_f32 v48, v32, v48
    v_cvt_pk_bf16_f32 v49, v33, v49
    v_cvt_pk_bf16_f32 v50, v34, v50
    v_cvt_pk_bf16_f32 v51, v35, v51
    v_lshlrev_b32 v32, 16, v48
    v_lshlrev_b32 v33, 16, v49
    v_lshlrev_b32 v34, 16, v50
    v_lshlrev_b32 v35, 16, v51
    v_and_b32 v48, 0xffff0000, v48
    v_and_b32 v49, 0xffff0000, v49
    v_and_b32 v50, 0xffff0000, v50
    v_and_b32 v51, 0xffff0000, v51
    v_mul_f32 v136, 0xbfb8aa3b, v32
    v_mul_f32 v137, 0xbfb8aa3b, v33
    v_mul_f32 v138, 0xbfb8aa3b, v34
    v_mul_f32 v139, 0xbfb8aa3b, v35
    v_exp_f32 v136, v136
    v_exp_f32 v137, v137
    v_exp_f32 v138, v138
    v_exp_f32 v139, v139
    v_add_f32 v136, 1.0, v136
    v_add_f32 v137, 1.0, v137
    v_add_f32 v138, 1.0, v138
    v_add_f32 v139, 1.0, v139
    v_rcp_f32 v136, v136
    v_rcp_f32 v137, v137
    v_rcp_f32 v138, v138
    v_rcp_f32 v139, v139
    v_mul_f32 v32, v32, v136
    v_mul_f32 v33, v33, v137
    v_mul_f32 v34, v34, v138
    v_mul_f32 v35, v35, v139
    v_cvt_pk_bf16_f32 v32, v32, v32
    v_cvt_pk_bf16_f32 v33, v33, v33
    v_cvt_pk_bf16_f32 v34, v34, v34
    v_cvt_pk_bf16_f32 v35, v35, v35
    v_lshlrev_b32 v32, 16, v32
    v_lshlrev_b32 v33, 16, v33
    v_lshlrev_b32 v34, 16, v34
    v_lshlrev_b32 v35, 16, v35
    v_mul_f32 v32, v32, v48
    v_mul_f32 v33, v33, v49
    v_mul_f32 v34, v34, v50
    v_mul_f32 v35, v35, v51
    v_cvt_pk_bf16_f32 v128, v32, v33
    v_cvt_pk_bf16_f32 v129, v34, v35
    v_cndmask_b32 v64, 0, v128, s[12:13]
    v_cndmask_b32 v65, 0, v129, s[12:13]
    v_cndmask_b32 v66, 0, v128, s[14:15]
    v_cndmask_b32 v67, 0, v129, s[14:15]
    v_cndmask_b32 v68, 0, v128, s[16:17]
    v_cndmask_b32 v69, 0, v129, s[16:17]
    v_cndmask_b32 v70, 0, v128, s[18:19]
    v_cndmask_b32 v71, 0, v129, s[18:19]
    v_cndmask_b32 v72, 0, v128, s[20:21]
    v_cndmask_b32 v73, 0, v129, s[20:21]
    v_cndmask_b32 v74, 0, v128, s[22:23]
    v_cndmask_b32 v75, 0, v129, s[22:23]
    v_cndmask_b32 v76, 0, v128, s[24:25]
    v_cndmask_b32 v77, 0, v129, s[24:25]
    v_cndmask_b32 v78, 0, v128, s[26:27]
    v_cndmask_b32 v79, 0, v129, s[26:27]
    v_mfma_f32_16x16x32_bf16 v[32:35], a[64:67], v[64:67], 0
    v_mfma_f32_16x16x32_bf16 v[36:39], a[80:83], v[64:67], 0
    v_mfma_f32_16x16x32_bf16 v[32:35], a[68:71], v[68:71], v[32:35]
    v_mfma_f32_16x16x32_bf16 v[36:39], a[84:87], v[68:71], v[36:39]
    v_mfma_f32_16x16x32_bf16 v[32:35], a[72:75], v[72:75], v[32:35]
    v_mfma_f32_16x16x32_bf16 v[36:39], a[88:91], v[72:75], v[36:39]
    v_mfma_f32_16x16x32_bf16 v[32:35], a[76:79], v[76:79], v[32:35]
    v_mfma_f32_16x16x32_bf16 v[36:39], a[92:95], v[76:79], v[36:39]
    s_nop 6
    buffer_store_dwordx4 v[32:35], v222, s[8:11], s38 offen sc1
    buffer_store_dwordx4 v[36:39], v222, s[8:11], s38 offen offset:512 sc1
    v_lshlrev_b32 v144, 16, v16
    v_lshlrev_b32 v148, 16, v17
    v_lshlrev_b32 v152, 16, v18
    v_lshlrev_b32_e64 v156, 16, v19
    v_and_b32 v145, 0xffff0000, v16
    v_and_b32 v149, 0xffff0000, v17
    v_and_b32 v153, 0xffff0000, v18
    v_and_b32 v157, 0xffff0000, v19
    v_sub_f32 v144, v144, v0
    v_sub_f32 v148, v148, v0
    v_sub_f32 v152, v152, v0
    v_sub_f32 v156, v156, v0
    v_sub_f32 v145, v145, v0
    v_sub_f32 v149, v149, v0
    v_sub_f32 v153, v153, v0
    v_sub_f32 v157, v157, v0
    v_cvt_pk_bf16_f32 v145, v144, v145
    v_cvt_pk_bf16_f32 v149, v148, v149
    v_cvt_pk_bf16_f32 v153, v152, v153
    v_cvt_pk_bf16_f32 v157, v156, v157
    v_lshlrev_b32 v144, 16, v145
    v_lshlrev_b32 v148, 16, v149
    v_lshlrev_b32 v152, 16, v153
    v_lshlrev_b32 v156, 16, v157
    v_and_b32 v145, 0xffff0000, v145
    v_and_b32 v149, 0xffff0000, v149
    v_and_b32 v153, 0xffff0000, v153
    v_and_b32 v157, 0xffff0000, v157
    v_mul_f32 v144, v144, v4
    v_mul_f32 v148, v148, v4
    v_mul_f32 v152, v152, v4
    v_mul_f32 v156, v156, v4
    v_mul_f32 v145, v145, v4
    v_mul_f32 v149, v149, v4
    v_mul_f32 v153, v153, v4
    v_mul_f32 v157, v157, v4
    v_cvt_pk_bf16_f32 v146, v144, v145
    v_cvt_pk_bf16_f32 v150, v148, v149
    v_cvt_pk_bf16_f32 v154, v152, v153
    v_cvt_pk_bf16_f32 v158, v156, v157
    v_lshlrev_b32 v144, 16, v146
    v_lshlrev_b32 v148, 16, v150
    v_lshlrev_b32 v152, 16, v154
    v_lshlrev_b32 v156, 16, v158
    v_and_b32 v145, 0xffff0000, v146
    v_and_b32 v149, 0xffff0000, v150
    v_and_b32 v153, 0xffff0000, v154
    v_and_b32 v157, 0xffff0000, v158
    v_lshlrev_b32 v146, 16, v16
    v_lshlrev_b32 v150, 16, v17
    v_lshlrev_b32 v154, 16, v18
    v_lshlrev_b32 v158, 16, v19
    v_and_b32 v147, 0xffff0000, v16
    v_and_b32 v151, 0xffff0000, v17
    v_and_b32 v155, 0xffff0000, v18
    v_and_b32 v159, 0xffff0000, v19
    v_pk_add_f32 v[144:145], v[144:145], v[146:147]
    v_pk_add_f32 v[148:149], v[148:149], v[150:151]
    v_pk_add_f32 v[152:153], v[152:153], v[154:155]
    v_pk_add_f32 v[156:157], v[156:157], v[158:159]
    v_cvt_pk_bf16_f32 v16, v144, v145
    v_cvt_pk_bf16_f32 v17, v148, v149
    v_cvt_pk_bf16_f32 v18, v152, v153
    v_cvt_pk_bf16_f32 v19, v156, v157
    v_add_u32 v160, 0, v242
    v_cmp_eq_u32 vcc, v160, v8
    v_cmp_eq_u32 s[60:61], v160, v10
    v_mov_b32 v161, 0x40000000
    s_or_b64 vcc, vcc, s[60:61]
    v_cndmask_b32 v12, v229, v161, vcc
    s_waitcnt vmcnt(0)
    s_barrier
    s_cmp_lg_u32 s3, 0
    s_cbranch_scc1 kc_a2
    s_lshl_b32 s32, s52, 7
    s_add_u32 s32, s32, 0x38a0800
    v_mov_b32_e64 v235, 1
    buffer_atomic_add v235, v243, s[8:11], s32 offen sc0 sc1
    v_lshlrev_b32 v234, 7, v237
    v_cmp_gt_u32 vcc, 8, v237
    v_mov_b32_e64 v236, 0x40000000
    s_mov_b32 s34, 0x38a0c00
    v_cndmask_b32 v234, v236, v234, vcc
    s_waitcnt vmcnt(0)
    v_readfirstlane_b32 s36, v235
    s_cmp_lg_u32 s36, 27
    s_cbranch_scc1 kc_a2
    buffer_atomic_add v233, v234, s[8:11], s34 offen sc1
kc_a2:
    v_lshlrev_b32 v144, 16, v20
    v_lshlrev_b32 v148, 16, v21
    v_lshlrev_b32 v152, 16, v22
    v_lshlrev_b32_e64 v156, 16, v23
    v_and_b32 v145, 0xffff0000, v20
    v_and_b32 v149, 0xffff0000, v21
    v_and_b32 v153, 0xffff0000, v22
    v_and_b32 v157, 0xffff0000, v23
    v_sub_f32 v144, v144, v1
    v_sub_f32 v148, v148, v1
    v_sub_f32 v152, v152, v1
    v_sub_f32 v156, v156, v1
    v_sub_f32 v145, v145, v1
    v_sub_f32 v149, v149, v1
    v_sub_f32 v153, v153, v1
    v_sub_f32 v157, v157, v1
    v_cvt_pk_bf16_f32 v145, v144, v145
    v_cvt_pk_bf16_f32 v149, v148, v149
    v_cvt_pk_bf16_f32 v153, v152, v153
    v_cvt_pk_bf16_f32 v157, v156, v157
    v_lshlrev_b32 v144, 16, v145
    v_lshlrev_b32 v148, 16, v149
    v_lshlrev_b32 v152, 16, v153
    v_lshlrev_b32 v156, 16, v157
    v_and_b32 v145, 0xffff0000, v145
    v_and_b32 v149, 0xffff0000, v149
    v_and_b32 v153, 0xffff0000, v153
    v_and_b32 v157, 0xffff0000, v157
    v_mul_f32 v144, v144, v5
    v_mul_f32 v148, v148, v5
    v_mul_f32 v152, v152, v5
    v_mul_f32 v156, v156, v5
    v_mul_f32 v145, v145, v5
    v_mul_f32 v149, v149, v5
    v_mul_f32 v153, v153, v5
    v_mul_f32 v157, v157, v5
    v_cvt_pk_bf16_f32 v146, v144, v145
    v_cvt_pk_bf16_f32 v150, v148, v149
    v_cvt_pk_bf16_f32 v154, v152, v153
    v_cvt_pk_bf16_f32 v158, v156, v157
    v_lshlrev_b32 v144, 16, v146
    v_lshlrev_b32 v148, 16, v150
    v_lshlrev_b32 v152, 16, v154
    v_lshlrev_b32 v156, 16, v158
    v_and_b32 v145, 0xffff0000, v146
    v_and_b32 v149, 0xffff0000, v150
    v_and_b32 v153, 0xffff0000, v154
    v_and_b32 v157, 0xffff0000, v158
    v_lshlrev_b32 v146, 16, v20
    v_lshlrev_b32 v150, 16, v21
    v_lshlrev_b32 v154, 16, v22
    v_lshlrev_b32 v158, 16, v23
    v_and_b32 v147, 0xffff0000, v20
    v_and_b32 v151, 0xffff0000, v21
    v_and_b32 v155, 0xffff0000, v22
    v_and_b32 v159, 0xffff0000, v23
    v_pk_add_f32 v[144:145], v[144:145], v[146:147]
    v_pk_add_f32 v[148:149], v[148:149], v[150:151]
    v_pk_add_f32 v[152:153], v[152:153], v[154:155]
    v_pk_add_f32 v[156:157], v[156:157], v[158:159]
    v_cvt_pk_bf16_f32 v20, v144, v145
    v_cvt_pk_bf16_f32 v21, v148, v149
    v_cvt_pk_bf16_f32 v22, v152, v153
    v_cvt_pk_bf16_f32 v23, v156, v157
    v_add_u32 v160, 8, v242
    v_cmp_eq_u32 vcc, v160, v8
    v_cmp_eq_u32 s[60:61], v160, v10
    v_mov_b32 v161, 0x40000000
    s_or_b64 vcc, vcc, s[60:61]
    v_cndmask_b32 v13, v229, v161, vcc
    v_lshlrev_b32 v144, 16, v24
    v_lshlrev_b32 v148, 16, v25
    v_lshlrev_b32 v152, 16, v26
    v_lshlrev_b32_e64 v156, 16, v27
    v_and_b32 v145, 0xffff0000, v24
    v_and_b32 v149, 0xffff0000, v25
    v_and_b32 v153, 0xffff0000, v26
    v_and_b32 v157, 0xffff0000, v27
    v_sub_f32 v144, v144, v2
    v_sub_f32 v148, v148, v2
    v_sub_f32 v152, v152, v2
    v_sub_f32 v156, v156, v2
    v_sub_f32 v145, v145, v2
    v_sub_f32 v149, v149, v2
    v_sub_f32 v153, v153, v2
    v_sub_f32 v157, v157, v2
    v_cvt_pk_bf16_f32 v145, v144, v145
    v_cvt_pk_bf16_f32 v149, v148, v149
    v_cvt_pk_bf16_f32 v153, v152, v153
    v_cvt_pk_bf16_f32 v157, v156, v157
    v_lshlrev_b32 v144, 16, v145
    v_lshlrev_b32 v148, 16, v149
    v_lshlrev_b32 v152, 16, v153
    v_lshlrev_b32 v156, 16, v157
    v_and_b32 v145, 0xffff0000, v145
    v_and_b32 v149, 0xffff0000, v149
    v_and_b32 v153, 0xffff0000, v153
    v_and_b32 v157, 0xffff0000, v157
    v_mul_f32 v144, v144, v6
    v_mul_f32 v148, v148, v6
    v_mul_f32 v152, v152, v6
    v_mul_f32 v156, v156, v6
    v_mul_f32 v145, v145, v6
    v_mul_f32 v149, v149, v6
    v_mul_f32 v153, v153, v6
    v_mul_f32 v157, v157, v6
    v_cvt_pk_bf16_f32 v146, v144, v145
    v_cvt_pk_bf16_f32 v150, v148, v149
    v_cvt_pk_bf16_f32 v154, v152, v153
    v_cvt_pk_bf16_f32 v158, v156, v157
    v_lshlrev_b32 v144, 16, v146
    v_lshlrev_b32 v148, 16, v150
    v_lshlrev_b32 v152, 16, v154
    v_lshlrev_b32 v156, 16, v158
    v_and_b32 v145, 0xffff0000, v146
    v_and_b32 v149, 0xffff0000, v150
    v_and_b32 v153, 0xffff0000, v154
    v_and_b32 v157, 0xffff0000, v158
    v_lshlrev_b32 v146, 16, v24
    v_lshlrev_b32 v150, 16, v25
    v_lshlrev_b32 v154, 16, v26
    v_lshlrev_b32 v158, 16, v27
    v_and_b32 v147, 0xffff0000, v24
    v_and_b32 v151, 0xffff0000, v25
    v_and_b32 v155, 0xffff0000, v26
    v_and_b32 v159, 0xffff0000, v27
    v_pk_add_f32 v[144:145], v[144:145], v[146:147]
    v_pk_add_f32 v[148:149], v[148:149], v[150:151]
    v_pk_add_f32 v[152:153], v[152:153], v[154:155]
    v_pk_add_f32 v[156:157], v[156:157], v[158:159]
    v_cvt_pk_bf16_f32 v24, v144, v145
    v_cvt_pk_bf16_f32 v25, v148, v149
    v_cvt_pk_bf16_f32 v26, v152, v153
    v_cvt_pk_bf16_f32 v27, v156, v157
    v_add_u32 v160, 16, v242
    v_cmp_eq_u32 vcc, v160, v8
    v_cmp_eq_u32 s[60:61], v160, v10
    v_mov_b32 v161, 0x40000000
    s_or_b64 vcc, vcc, s[60:61]
    v_cndmask_b32 v14, v229, v161, vcc
    v_lshlrev_b32 v144, 16, v28
    v_lshlrev_b32 v148, 16, v29
    v_lshlrev_b32 v152, 16, v30
    v_lshlrev_b32_e64 v156, 16, v31
    v_and_b32 v145, 0xffff0000, v28
    v_and_b32 v149, 0xffff0000, v29
    v_and_b32 v153, 0xffff0000, v30
    v_and_b32 v157, 0xffff0000, v31
    v_sub_f32 v144, v144, v3
    v_sub_f32 v148, v148, v3
    v_sub_f32 v152, v152, v3
    v_sub_f32 v156, v156, v3
    v_sub_f32 v145, v145, v3
    v_sub_f32 v149, v149, v3
    v_sub_f32 v153, v153, v3
    v_sub_f32 v157, v157, v3
    v_cvt_pk_bf16_f32 v145, v144, v145
    v_cvt_pk_bf16_f32 v149, v148, v149
    v_cvt_pk_bf16_f32 v153, v152, v153
    v_cvt_pk_bf16_f32 v157, v156, v157
    v_lshlrev_b32 v144, 16, v145
    v_lshlrev_b32 v148, 16, v149
    v_lshlrev_b32 v152, 16, v153
    v_lshlrev_b32 v156, 16, v157
    v_and_b32 v145, 0xffff0000, v145
    v_and_b32 v149, 0xffff0000, v149
    v_and_b32 v153, 0xffff0000, v153
    v_and_b32 v157, 0xffff0000, v157
    v_mul_f32 v144, v144, v7
    v_mul_f32 v148, v148, v7
    v_mul_f32 v152, v152, v7
    v_mul_f32 v156, v156, v7
    v_mul_f32 v145, v145, v7
    v_mul_f32 v149, v149, v7
    v_mul_f32 v153, v153, v7
    v_mul_f32 v157, v157, v7
    v_cvt_pk_bf16_f32 v146, v144, v145
    v_cvt_pk_bf16_f32 v150, v148, v149
    v_cvt_pk_bf16_f32 v154, v152, v153
    v_cvt_pk_bf16_f32 v158, v156, v157
    v_lshlrev_b32 v144, 16, v146
    v_lshlrev_b32 v148, 16, v150
    v_lshlrev_b32 v152, 16, v154
    v_lshlrev_b32 v156, 16, v158
    v_and_b32 v145, 0xffff0000, v146
    v_and_b32 v149, 0xffff0000, v150
    v_and_b32 v153, 0xffff0000, v154
    v_and_b32 v157, 0xffff0000, v158
    v_lshlrev_b32 v146, 16, v28
    v_lshlrev_b32 v150, 16, v29
    v_lshlrev_b32 v154, 16, v30
    v_lshlrev_b32 v158, 16, v31
    v_and_b32 v147, 0xffff0000, v28
    v_and_b32 v151, 0xffff0000, v29
    v_and_b32 v155, 0xffff0000, v30
    v_and_b32 v159, 0xffff0000, v31
    v_pk_add_f32 v[144:145], v[144:145], v[146:147]
    v_pk_add_f32 v[148:149], v[148:149], v[150:151]
    v_pk_add_f32 v[152:153], v[152:153], v[154:155]
    v_pk_add_f32 v[156:157], v[156:157], v[158:159]
    v_cvt_pk_bf16_f32 v28, v144, v145
    v_cvt_pk_bf16_f32 v29, v148, v149
    v_cvt_pk_bf16_f32 v30, v152, v153
    v_cvt_pk_bf16_f32 v31, v156, v157
    v_add_u32 v160, 24, v242
    v_cmp_eq_u32 vcc, v160, v8
    v_cmp_eq_u32 s[60:61], v160, v10
    v_mov_b32 v161, 0x40000000
    s_or_b64 vcc, vcc, s[60:61]
    v_cndmask_b32 v15, v229, v161, vcc
    s_mov_b32 s32, 0
    buffer_store_dwordx4 v[16:19], v12, s[28:31], s32 offen nt
    s_mov_b32 s32, 16384
    buffer_store_dwordx4 v[20:23], v13, s[28:31], s32 offen nt
    s_mov_b32 s32, 32768
    buffer_store_dwordx4 v[24:27], v14, s[28:31], s32 offen nt
    s_mov_b32 s32, 49152
    buffer_store_dwordx4 v[28:31], v15, s[28:31], s32 offen nt
    s_branch kc_fin
kc_red:
    v_lshlrev_b32 v144, 16, v16
    v_lshlrev_b32 v148, 16, v17
    v_lshlrev_b32 v152, 16, v18
    v_lshlrev_b32_e64 v156, 16, v19
    v_and_b32 v145, 0xffff0000, v16
    v_and_b32 v149, 0xffff0000, v17
    v_and_b32 v153, 0xffff0000, v18
    v_and_b32 v157, 0xffff0000, v19
    v_sub_f32 v144, v144, v0
    v_sub_f32 v148, v148, v0
    v_sub_f32 v152, v152, v0
    v_sub_f32 v156, v156, v0
    v_sub_f32 v145, v145, v0
    v_sub_f32 v149, v149, v0
    v_sub_f32 v153, v153, v0
    v_sub_f32 v157, v157, v0
    v_cvt_pk_bf16_f32 v145, v144, v145
    v_cvt_pk_bf16_f32 v149, v148, v149
    v_cvt_pk_bf16_f32 v153, v152, v153
    v_cvt_pk_bf16_f32 v157, v156, v157
    v_lshlrev_b32 v144, 16, v145
    v_lshlrev_b32 v148, 16, v149
    v_lshlrev_b32 v152, 16, v153
    v_lshlrev_b32 v156, 16, v157
    v_and_b32 v145, 0xffff0000, v145
    v_and_b32 v149, 0xffff0000, v149
    v_and_b32 v153, 0xffff0000, v153
    v_and_b32 v157, 0xffff0000, v157
    v_mul_f32 v144, v144, v4
    v_mul_f32 v148, v148, v4
    v_mul_f32 v152, v152, v4
    v_mul_f32 v156, v156, v4
    v_mul_f32 v145, v145, v4
    v_mul_f32 v149, v149, v4
    v_mul_f32 v153, v153, v4
    v_mul_f32 v157, v157, v4
    v_cvt_pk_bf16_f32 v146, v144, v145
    v_cvt_pk_bf16_f32 v150, v148, v149
    v_cvt_pk_bf16_f32 v154, v152, v153
    v_cvt_pk_bf16_f32 v158, v156, v157
    v_lshlrev_b32 v144, 16, v146
    v_lshlrev_b32 v148, 16, v150
    v_lshlrev_b32 v152, 16, v154
    v_lshlrev_b32 v156, 16, v158
    v_and_b32 v145, 0xffff0000, v146
    v_and_b32 v149, 0xffff0000, v150
    v_and_b32 v153, 0xffff0000, v154
    v_and_b32 v157, 0xffff0000, v158
    v_lshlrev_b32 v146, 16, v16
    v_lshlrev_b32 v150, 16, v17
    v_lshlrev_b32 v154, 16, v18
    v_lshlrev_b32 v158, 16, v19
    v_and_b32 v147, 0xffff0000, v16
    v_and_b32 v151, 0xffff0000, v17
    v_and_b32 v155, 0xffff0000, v18
    v_and_b32 v159, 0xffff0000, v19
    v_pk_add_f32 v[144:145], v[144:145], v[146:147]
    v_pk_add_f32 v[148:149], v[148:149], v[150:151]
    v_pk_add_f32 v[152:153], v[152:153], v[154:155]
    v_pk_add_f32 v[156:157], v[156:157], v[158:159]
    v_cvt_pk_bf16_f32 v16, v144, v145
    v_cvt_pk_bf16_f32 v17, v148, v149
    v_cvt_pk_bf16_f32 v18, v152, v153
    v_cvt_pk_bf16_f32 v19, v156, v157
    v_add_u32 v160, 0, v242
    v_cmp_eq_u32 vcc, v160, v8
    v_cmp_eq_u32 s[60:61], v160, v10
    v_mov_b32 v161, 0x40000000
    s_or_b64 vcc, vcc, s[60:61]
    v_cndmask_b32 v12, v229, v161, vcc
    v_lshlrev_b32 v144, 16, v20
    v_lshlrev_b32 v148, 16, v21
    v_lshlrev_b32 v152, 16, v22
    v_lshlrev_b32_e64 v156, 16, v23
    v_and_b32 v145, 0xffff0000, v20
    v_and_b32 v149, 0xffff0000, v21
    v_and_b32 v153, 0xffff0000, v22
    v_and_b32 v157, 0xffff0000, v23
    v_sub_f32 v144, v144, v1
    v_sub_f32 v148, v148, v1
    v_sub_f32 v152, v152, v1
    v_sub_f32 v156, v156, v1
    v_sub_f32 v145, v145, v1
    v_sub_f32 v149, v149, v1
    v_sub_f32 v153, v153, v1
    v_sub_f32 v157, v157, v1
    v_cvt_pk_bf16_f32 v145, v144, v145
    v_cvt_pk_bf16_f32 v149, v148, v149
    v_cvt_pk_bf16_f32 v153, v152, v153
    v_cvt_pk_bf16_f32 v157, v156, v157
    v_lshlrev_b32 v144, 16, v145
    v_lshlrev_b32 v148, 16, v149
    v_lshlrev_b32 v152, 16, v153
    v_lshlrev_b32 v156, 16, v157
    v_and_b32 v145, 0xffff0000, v145
    v_and_b32 v149, 0xffff0000, v149
    v_and_b32 v153, 0xffff0000, v153
    v_and_b32 v157, 0xffff0000, v157
    v_mul_f32 v144, v144, v5
    v_mul_f32 v148, v148, v5
    v_mul_f32 v152, v152, v5
    v_mul_f32 v156, v156, v5
    v_mul_f32 v145, v145, v5
    v_mul_f32 v149, v149, v5
    v_mul_f32 v153, v153, v5
    v_mul_f32 v157, v157, v5
    v_cvt_pk_bf16_f32 v146, v144, v145
    v_cvt_pk_bf16_f32 v150, v148, v149
    v_cvt_pk_bf16_f32 v154, v152, v153
    v_cvt_pk_bf16_f32 v158, v156, v157
    v_lshlrev_b32 v144, 16, v146
    v_lshlrev_b32 v148, 16, v150
    v_lshlrev_b32 v152, 16, v154
    v_lshlrev_b32 v156, 16, v158
    v_and_b32 v145, 0xffff0000, v146
    v_and_b32 v149, 0xffff0000, v150
    v_and_b32 v153, 0xffff0000, v154
    v_and_b32 v157, 0xffff0000, v158
    v_lshlrev_b32 v146, 16, v20
    v_lshlrev_b32 v150, 16, v21
    v_lshlrev_b32 v154, 16, v22
    v_lshlrev_b32 v158, 16, v23
    v_and_b32 v147, 0xffff0000, v20
    v_and_b32 v151, 0xffff0000, v21
    v_and_b32 v155, 0xffff0000, v22
    v_and_b32 v159, 0xffff0000, v23
    v_pk_add_f32 v[144:145], v[144:145], v[146:147]
    v_pk_add_f32 v[148:149], v[148:149], v[150:151]
    v_pk_add_f32 v[152:153], v[152:153], v[154:155]
    v_pk_add_f32 v[156:157], v[156:157], v[158:159]
    v_cvt_pk_bf16_f32 v20, v144, v145
    v_cvt_pk_bf16_f32 v21, v148, v149
    v_cvt_pk_bf16_f32 v22, v152, v153
    v_cvt_pk_bf16_f32 v23, v156, v157
    v_add_u32 v160, 8, v242
    v_cmp_eq_u32 vcc, v160, v8
    v_cmp_eq_u32 s[60:61], v160, v10
    v_mov_b32 v161, 0x40000000
    s_or_b64 vcc, vcc, s[60:61]
    v_cndmask_b32 v13, v229, v161, vcc
    v_lshlrev_b32 v144, 16, v24
    v_lshlrev_b32 v148, 16, v25
    v_lshlrev_b32 v152, 16, v26
    v_lshlrev_b32_e64 v156, 16, v27
    v_and_b32 v145, 0xffff0000, v24
    v_and_b32 v149, 0xffff0000, v25
    v_and_b32 v153, 0xffff0000, v26
    v_and_b32 v157, 0xffff0000, v27
    v_sub_f32 v144, v144, v2
    v_sub_f32 v148, v148, v2
    v_sub_f32 v152, v152, v2
    v_sub_f32 v156, v156, v2
    v_sub_f32 v145, v145, v2
    v_sub_f32 v149, v149, v2
    v_sub_f32 v153, v153, v2
    v_sub_f32 v157, v157, v2
    v_cvt_pk_bf16_f32 v145, v144, v145
    v_cvt_pk_bf16_f32 v149, v148, v149
    v_cvt_pk_bf16_f32 v153, v152, v153
    v_cvt_pk_bf16_f32 v157, v156, v157
    v_lshlrev_b32 v144, 16, v145
    v_lshlrev_b32 v148, 16, v149
    v_lshlrev_b32 v152, 16, v153
    v_lshlrev_b32 v156, 16, v157
    v_and_b32 v145, 0xffff0000, v145
    v_and_b32 v149, 0xffff0000, v149
    v_and_b32 v153, 0xffff0000, v153
    v_and_b32 v157, 0xffff0000, v157
    v_mul_f32 v144, v144, v6
    v_mul_f32 v148, v148, v6
    v_mul_f32 v152, v152, v6
    v_mul_f32 v156, v156, v6
    v_mul_f32 v145, v145, v6
    v_mul_f32 v149, v149, v6
    v_mul_f32 v153, v153, v6
    v_mul_f32 v157, v157, v6
    v_cvt_pk_bf16_f32 v146, v144, v145
    v_cvt_pk_bf16_f32 v150, v148, v149
    v_cvt_pk_bf16_f32 v154, v152, v153
    v_cvt_pk_bf16_f32 v158, v156, v157
    v_lshlrev_b32 v144, 16, v146
    v_lshlrev_b32 v148, 16, v150
    v_lshlrev_b32 v152, 16, v154
    v_lshlrev_b32 v156, 16, v158
    v_and_b32 v145, 0xffff0000, v146
    v_and_b32 v149, 0xffff0000, v150
    v_and_b32 v153, 0xffff0000, v154
    v_and_b32 v157, 0xffff0000, v158
    v_lshlrev_b32 v146, 16, v24
    v_lshlrev_b32 v150, 16, v25
    v_lshlrev_b32 v154, 16, v26
    v_lshlrev_b32 v158, 16, v27
    v_and_b32 v147, 0xffff0000, v24
    v_and_b32 v151, 0xffff0000, v25
    v_and_b32 v155, 0xffff0000, v26
    v_and_b32 v159, 0xffff0000, v27
    v_pk_add_f32 v[144:145], v[144:145], v[146:147]
    v_pk_add_f32 v[148:149], v[148:149], v[150:151]
    v_pk_add_f32 v[152:153], v[152:153], v[154:155]
    v_pk_add_f32 v[156:157], v[156:157], v[158:159]
    v_cvt_pk_bf16_f32 v24, v144, v145
    v_cvt_pk_bf16_f32 v25, v148, v149
    v_cvt_pk_bf16_f32 v26, v152, v153
    v_cvt_pk_bf16_f32 v27, v156, v157
    v_add_u32 v160, 16, v242
    v_cmp_eq_u32 vcc, v160, v8
    v_cmp_eq_u32 s[60:61], v160, v10
    v_mov_b32 v161, 0x40000000
    s_or_b64 vcc, vcc, s[60:61]
    v_cndmask_b32 v14, v229, v161, vcc
    v_lshlrev_b32 v144, 16, v28
    v_lshlrev_b32 v148, 16, v29
    v_lshlrev_b32 v152, 16, v30
    v_lshlrev_b32_e64 v156, 16, v31
    v_and_b32 v145, 0xffff0000, v28
    v_and_b32 v149, 0xffff0000, v29
    v_and_b32 v153, 0xffff0000, v30
    v_and_b32 v157, 0xffff0000, v31
    v_sub_f32 v144, v144, v3
    v_sub_f32 v148, v148, v3
    v_sub_f32 v152, v152, v3
    v_sub_f32 v156, v156, v3
    v_sub_f32 v145, v145, v3
    v_sub_f32 v149, v149, v3
    v_sub_f32 v153, v153, v3
    v_sub_f32 v157, v157, v3
    v_cvt_pk_bf16_f32 v145, v144, v145
    v_cvt_pk_bf16_f32 v149, v148, v149
    v_cvt_pk_bf16_f32 v153, v152, v153
    v_cvt_pk_bf16_f32 v157, v156, v157
    v_lshlrev_b32 v144, 16, v145
    v_lshlrev_b32 v148, 16, v149
    v_lshlrev_b32 v152, 16, v153
    v_lshlrev_b32 v156, 16, v157
    v_and_b32 v145, 0xffff0000, v145
    v_and_b32 v149, 0xffff0000, v149
    v_and_b32 v153, 0xffff0000, v153
    v_and_b32 v157, 0xffff0000, v157
    v_mul_f32 v144, v144, v7
    v_mul_f32 v148, v148, v7
    v_mul_f32 v152, v152, v7
    v_mul_f32 v156, v156, v7
    v_mul_f32 v145, v145, v7
    v_mul_f32 v149, v149, v7
    v_mul_f32 v153, v153, v7
    v_mul_f32 v157, v157, v7
    v_cvt_pk_bf16_f32 v146, v144, v145
    v_cvt_pk_bf16_f32 v150, v148, v149
    v_cvt_pk_bf16_f32 v154, v152, v153
    v_cvt_pk_bf16_f32 v158, v156, v157
    v_lshlrev_b32 v144, 16, v146
    v_lshlrev_b32 v148, 16, v150
    v_lshlrev_b32 v152, 16, v154
    v_lshlrev_b32 v156, 16, v158
    v_and_b32 v145, 0xffff0000, v146
    v_and_b32 v149, 0xffff0000, v150
    v_and_b32 v153, 0xffff0000, v154
    v_and_b32 v157, 0xffff0000, v158
    v_lshlrev_b32 v146, 16, v28
    v_lshlrev_b32 v150, 16, v29
    v_lshlrev_b32 v154, 16, v30
    v_lshlrev_b32 v158, 16, v31
    v_and_b32 v147, 0xffff0000, v28
    v_and_b32 v151, 0xffff0000, v29
    v_and_b32 v155, 0xffff0000, v30
    v_and_b32 v159, 0xffff0000, v31
    v_pk_add_f32 v[144:145], v[144:145], v[146:147]
    v_pk_add_f32 v[148:149], v[148:149], v[150:151]
    v_pk_add_f32 v[152:153], v[152:153], v[154:155]
    v_pk_add_f32 v[156:157], v[156:157], v[158:159]
    v_cvt_pk_bf16_f32 v28, v144, v145
    v_cvt_pk_bf16_f32 v29, v148, v149
    v_cvt_pk_bf16_f32 v30, v152, v153
    v_cvt_pk_bf16_f32 v31, v156, v157
    v_add_u32 v160, 24, v242
    v_cmp_eq_u32 vcc, v160, v8
    v_cmp_eq_u32 s[60:61], v160, v10
    v_mov_b32 v161, 0x40000000
    s_or_b64 vcc, vcc, s[60:61]
    v_cndmask_b32 v15, v229, v161, vcc
    s_mov_b32 s32, 0
    buffer_store_dwordx4 v[16:19], v12, s[28:31], s32 offen nt
    s_mov_b32 s32, 16384
    buffer_store_dwordx4 v[20:23], v13, s[28:31], s32 offen nt
    s_mov_b32 s32, 32768
    buffer_store_dwordx4 v[24:27], v14, s[28:31], s32 offen nt
    s_mov_b32 s32, 49152
    buffer_store_dwordx4 v[28:31], v15, s[28:31], s32 offen nt
    s_sub_u32 s54, s2, 224
    v_lshrrev_b32 v234, 4, v230
    v_lshlrev_b32 v234, 13, v234
    v_and_b32_e64 v235, 15, v237
    v_lshl_add_u32 v217, v235, 4, v234
    s_lshl_b32 s35, s54, 8
    s_add_u32 s35, s35, 0x3900000
    v_bfe_u32 v234, v237, 4, 1
    v_lshrrev_b32 v236, 5, v237
    v_lshl_add_u32 v234, v234, 1, v236
    v_lshl_add_u32 v234, v235, 2, v234
    s_lshl_b32 s32, s54, 6
    v_add_u32 v234, s32, v234
    v_lshlrev_b32_e64 v218, 1, v234
    v_add_u32 v234, 98304, v218
    ds_read_u16 v100, v234
    ds_read_u16 v101, v234 offset:4096
    s_cmp_lt_u32 s54, 16
    s_cselect_b64 vcc, -1, 0
    v_cndmask_b32 v102, v10, v8, vcc
    s_cselect_b32 s32, 0, 4
    s_add_u32 s32, s32, 106496
    v_mov_b32_e64 v234, s32
    ds_read_b32 v103, v234
    s_waitcnt lgkmcnt(0)
    v_cvt_pk_bf16_f32 v103, v103, v103
    v_lshlrev_b32 v103, 16, v103
    v_mul_f32 v103, 0xbfb8aa3b, v103
    v_exp_f32 v103, v103
    s_nop 0
    v_add_f32 v103, 1.0, v103
    v_rcp_f32_e64 v103, v103
    s_nop 0
    v_cvt_pk_bf16_f32 v103, v103, v103
    v_lshlrev_b32_e64 v103, 16, v103
    v_and_b32 v218, 2047, v218
    v_lshl_add_u32 v218, v102, 11, v218
    v_lshlrev_b32_e64 v220, 2, v230
    v_add_u32 v220, 106752, v220
    v_lshlrev_b32_e64 v221, 2, v237
    v_add_u32 v221, 106752, v221
    s_cmp_lg_u32 s3, 0
    s_cbranch_scc1 kc_b22
    s_lshl_b32 s32, s52, 7
    s_add_u32 s32, s32, 0x38a0c00
    s_mov_b32 s34, 0x100000
    s_branch kc_b21
kc_b20:
    s_sleep 2
kc_b21:
    buffer_load_dword v235, off, s[8:11], s32 sc1
    s_waitcnt vmcnt(0)
    v_cmp_ne_u32 vcc, 8, v235
    s_sub_u32 s34, s34, 1
    s_cbranch_scc1 kc_b22
    s_cbranch_vccnz kc_b20
kc_b22:
    s_barrier
    s_add_u32 s32, s35, 0
    buffer_load_dwordx4 v[32:35], v217, s[8:11], s32 offen sc1
    s_add_u32 s32, s35, 131072
    buffer_load_dwordx4 v[36:39], v217, s[8:11], s32 offen sc1
    s_add_u32 s32, s35, 262144
    buffer_load_dwordx4 v[40:43], v217, s[8:11], s32 offen sc1
    s_add_u32 s32, s35, 393216
    buffer_load_dwordx4 v[44:47], v217, s[8:11], s32 offen sc1
    s_add_u32 s32, s35, 524288
    buffer_load_dwordx4 v[48:51], v217, s[8:11], s32 offen sc1
    s_add_u32 s32, s35, 655360
    buffer_load_dwordx4 v[52:55], v217, s[8:11], s32 offen sc1
    s_add_u32 s32, s35, 786432
    buffer_load_dwordx4 v[56:59], v217, s[8:11], s32 offen sc1
    s_add_u32 s32, s35, 917504
    buffer_load_dwordx4 v[60:63], v217, s[8:11], s32 offen sc1
    s_add_u32 s32, s35, 1048576
    buffer_load_dwordx4 v[64:67], v217, s[8:11], s32 offen sc1
    s_add_u32 s32, s35, 1179648
    buffer_load_dwordx4 v[68:71], v217, s[8:11], s32 offen sc1
    s_add_u32 s32, s35, 1310720
    buffer_load_dwordx4 v[72:75], v217, s[8:11], s32 offen sc1
    s_add_u32 s32, s35, 1441792
    buffer_load_dwordx4 v[76:79], v217, s[8:11], s32 offen sc1
    s_add_u32 s32, s35, 1572864
    buffer_load_dwordx4 v[80:83], v217, s[8:11], s32 offen sc1
    s_add_u32 s32, s35, 1703936
    buffer_load_dwordx4 v[84:87], v217, s[8:11], s32 offen sc1
    s_waitcnt vmcnt(12)
    v_pk_add_f32 v[32:33], v[32:33], v[36:37]
    v_pk_add_f32 v[34:35], v[34:35], v[38:39]
    s_waitcnt vmcnt(11)
    v_pk_add_f32 v[32:33], v[32:33], v[40:41]
    v_pk_add_f32 v[34:35], v[34:35], v[42:43]
    s_waitcnt vmcnt(10)
    v_pk_add_f32 v[32:33], v[32:33], v[44:45]
    v_pk_add_f32 v[34:35], v[34:35], v[46:47]
    s_waitcnt vmcnt(9)
    v_pk_add_f32 v[32:33], v[32:33], v[48:49]
    v_pk_add_f32 v[34:35], v[34:35], v[50:51]
    s_waitcnt vmcnt(8)
    v_pk_add_f32 v[32:33], v[32:33], v[52:53]
    v_pk_add_f32 v[34:35], v[34:35], v[54:55]
    s_waitcnt vmcnt(7)
    v_pk_add_f32 v[32:33], v[32:33], v[56:57]
    v_pk_add_f32 v[34:35], v[34:35], v[58:59]
    s_waitcnt vmcnt(6)
    v_pk_add_f32 v[32:33], v[32:33], v[60:61]
    v_pk_add_f32 v[34:35], v[34:35], v[62:63]
    s_waitcnt vmcnt(5)
    v_pk_add_f32 v[32:33], v[32:33], v[64:65]
    v_pk_add_f32 v[34:35], v[34:35], v[66:67]
    s_waitcnt vmcnt(4)
    v_pk_add_f32 v[32:33], v[32:33], v[68:69]
    v_pk_add_f32 v[34:35], v[34:35], v[70:71]
    s_waitcnt vmcnt(3)
    v_pk_add_f32 v[32:33], v[32:33], v[72:73]
    v_pk_add_f32 v[34:35], v[34:35], v[74:75]
    s_waitcnt vmcnt(2)
    v_pk_add_f32 v[32:33], v[32:33], v[76:77]
    v_pk_add_f32 v[34:35], v[34:35], v[78:79]
    s_waitcnt vmcnt(1)
    v_pk_add_f32 v[32:33], v[32:33], v[80:81]
    v_pk_add_f32 v[34:35], v[34:35], v[82:83]
    s_waitcnt vmcnt(0)
    v_pk_add_f32 v[32:33], v[32:33], v[84:85]
    v_pk_add_f32 v[34:35], v[34:35], v[86:87]
    s_nop 1
    v_permlane32_swap_b32 v32, v33
    v_permlane32_swap_b32 v34, v35
    s_nop 0
    v_add_f32 v32, v32, v33
    v_add_f32 v34, v34, v35
    s_nop 1
    v_permlane16_swap_b32 v32, v34
    s_nop 0
    v_add_f32_e64 v32, v32, v34
    ds_write_b32 v220, v32
    s_waitcnt lgkmcnt(0)
    s_barrier
    s_cmp_lg_u32 s3, 0
    s_cbranch_scc1 kc_fin
    ds_read_b32 v32, v221
    ds_read_b32 v33, v221 offset:256
    ds_read_b32 v34, v221 offset:512
    ds_read_b32 v35, v221 offset:768
    v_lshlrev_b32 v100, 16, v100
    v_lshlrev_b32 v101, 16, v101
    s_waitcnt lgkmcnt(0)
    v_add_f32 v32, v32, v33
    v_add_f32 v34, v34, v35
    v_add_f32 v32, v32, v34
    v_cvt_pk_bf16_f32 v32, v32, v32
    v_lshlrev_b32 v32, 16, v32
    v_mul_f32 v32, v32, v103
    v_cvt_pk_bf16_f32 v32, v32, v32
    v_lshlrev_b32 v32, 16, v32
    v_add_f32 v32, v32, v100
    v_cvt_pk_bf16_f32 v32, v32, v32
    v_lshlrev_b32 v32, 16, v32
    v_add_f32 v32, v32, v101
    v_cvt_pk_bf16_f32 v32, v32, v32
    buffer_store_short v32, v218, s[28:31], 0 offen
kc_fin:
    s_endpgm
kc_r3:
    s_mov_b32 s34, 0x100000
kc_r3l:
    s_sleep 4
    buffer_load_dwordx4 v[176:179], v228, s[8:11], s7 offen offset:0 sc1
    buffer_load_dwordx4 v[180:183], v228, s[8:11], s7 offen offset:1024 sc1
    buffer_load_dwordx4 v[184:187], v228, s[8:11], s7 offen offset:2048 sc1
    buffer_load_dwordx4 v[188:191], v228, s[8:11], s7 offen offset:3072 sc1
    s_waitcnt vmcnt(0)
    v_max3_u32 v235, v176, v177, v178
    v_max3_u32 v235, v235, v179, v180
    v_max3_u32 v235, v235, v181, v182
    v_max3_u32 v235, v235, v183, v184
    v_max3_u32 v235, v235, v185, v186
    v_max3_u32 v235, v235, v187, v188
    v_max3_u32 v235, v235, v189, v190
    v_max_u32 v235, v235, v191
    v_cmp_eq_u32 vcc, -1, v235
    s_sub_u32 s34, s34, 1
    s_cbranch_scc1 kc_r3o
    s_cbranch_vccnz kc_r3l
    s_branch kc_r3o
kc_r1:
    s_mov_b32 s34, 0x100000
kc_r1l:
    s_sleep 4
    buffer_load_dwordx4 v[96:99], v228, s[8:11], s37 offen offset:0 sc1
    buffer_load_dwordx4 v[100:103], v228, s[8:11], s37 offen offset:1024 sc1
    buffer_load_dwordx4 v[104:107], v228, s[8:11], s37 offen offset:2048 sc1
    buffer_load_dwordx4 v[108:111], v228, s[8:11], s37 offen offset:3072 sc1
    s_waitcnt vmcnt(0)
    v_max3_u32 v235, v96, v97, v98
    v_max3_u32 v235, v235, v99, v100
    v_max3_u32 v235, v235, v101, v102
    v_max3_u32 v235, v235, v103, v104
    v_max3_u32 v235, v235, v105, v106
    v_max3_u32 v235, v235, v107, v108
    v_max3_u32 v235, v235, v109, v110
    v_max_u32 v235, v235, v111
    v_cmp_eq_u32 vcc, -1, v235
    s_sub_u32 s34, s34, 1
    s_cbranch_scc1 kc_r1o
    s_cbranch_vccnz kc_r1l
    s_branch kc_r1o
kc_r2:
    s_mov_b32 s34, 0x100000
kc_r2l:
    s_sleep 4
    buffer_load_dwordx4 v[160:163], v228, s[8:11], s38 offen offset:0 sc1
    buffer_load_dwordx4 v[164:167], v228, s[8:11], s38 offen offset:1024 sc1
    buffer_load_dwordx4 v[168:171], v228, s[8:11], s38 offen offset:2048 sc1
    buffer_load_dwordx4 v[172:175], v228, s[8:11], s38 offen offset:3072 sc1
    s_waitcnt vmcnt(0)
    v_max3_u32 v235, v160, v161, v162
    v_max3_u32 v235, v235, v163, v164
    v_max3_u32 v235, v235, v165, v166
    v_max3_u32 v235, v235, v167, v168
    v_max3_u32 v235, v235, v169, v170
    v_max3_u32 v235, v235, v171, v172
    v_max3_u32 v235, v235, v173, v174
    v_max_u32 v235, v235, v175
    v_cmp_eq_u32 vcc, -1, v235
    s_sub_u32 s34, s34, 1
    s_cbranch_scc1 kc_r2o
    s_cbranch_vccnz kc_r2l
    s_branch kc_r2o
kc_g:
    s_mov_b32 s34, 0x100000
    s_branch kc_gs1
kc_gs0:
    s_sleep 2
kc_gs1:
    buffer_load_dword v235, off, s[8:11], s45 sc1
    s_waitcnt vmcnt(0)
    v_cmp_ne_u32_e64 vcc, 8, v235
    s_sub_u32 s34, s34, 1
    s_cbranch_scc1 kc_gs2
    s_cbranch_vccnz kc_gs0
kc_gs2:
    s_branch kc_gr
kc_end:
ka_done:
    s_endpgm
kf_fix1:
    s_cmp_eq_u32 s33, 0
    s_cselect_b32 s24, 0, 0x74000000
    s_cselect_b32 s36, 0, 0x1000
    s_mov_b32 s33, 1
    v_subrev_f32 v230, s24, v243
    v_add_f32 v231, 0, v230
    v_min_f32 v64, v224, v231
    v_add_f32 v232, 0xf1800000, v230
    v_min_f32_e64 v65, v224, v232
    v_add_f32 v231, 0xf2000000, v230
    v_min_f32_e64 v66, v224, v231
    v_add_f32 v232, 0xf2400000, v230
    v_min_f32_e64 v67, v224, v232
    v_add_f32 v231, 0xf3000000, v230
    v_min_f32_e64 v68, v224, v231
    v_add_f32 v232, 0xf3100000, v230
    v_min_f32_e64 v69, v224, v232
    v_add_f32 v231, 0xf3200000, v230
    v_min_f32_e64 v70, v224, v231
    v_add_f32 v232, 0xf3300000, v230
    v_min_f32_e64 v71, v224, v232
    v_add_f32 v231, 0x73800000, v230
    v_min_f32_e64 v72, v225, v231
    v_add_f32 v232, 0x73700000, v230
    v_min_f32_e64 v73, v225, v232
    v_add_f32 v231, 0x73600000, v230
    v_min_f32_e64 v74, v225, v231
    v_add_f32 v232, 0x73500000, v230
    v_min_f32_e64 v75, v225, v232
    v_add_f32 v231, 0x73000000, v230
    v_min_f32_e64 v76, v225, v231
    v_add_f32 v232, 0x72e00000, v230
    v_min_f32_e64 v77, v225, v232
    v_add_f32 v231, 0x72c00000, v230
    v_min_f32_e64 v78, v225, v231
    v_add_f32 v232, 0x72a00000, v230
    v_min_f32 v79, v225, v232
    s_nop 1
    s_branch kf_fixr2
kf_fix3:
    s_cmp_eq_u32 s33, 0
    s_cselect_b32 s24, 0, 0x74000000
    s_cselect_b32 s36, 0, 0x1000
    s_mov_b32 s33, 1
    v_subrev_f32 v230, s24, v243
    v_add_f32 v231, 0, v230
    v_min_f32 v64, v224, v231
    v_add_f32 v232, 0xf1800000, v230
    v_min_f32_e64 v65, v224, v232
    v_add_f32 v231, 0xf2000000, v230
    v_min_f32_e64 v66, v224, v231
    v_add_f32 v232, 0xf2400000, v230
    v_min_f32_e64 v67, v224, v232
    v_add_f32 v231, 0xf3000000, v230
    v_min_f32_e64 v68, v224, v231
    v_add_f32 v232, 0xf3100000, v230
    v_min_f32_e64 v69, v224, v232
    v_add_f32 v231, 0xf3200000, v230
    v_min_f32_e64 v70, v224, v231
    v_add_f32 v232, 0xf3300000, v230
    v_min_f32_e64 v71, v224, v232
    v_add_f32 v231, 0x73800000, v230
    v_min_f32_e64 v72, v225, v231
    v_add_f32 v232, 0x73700000, v230
    v_min_f32_e64 v73, v225, v232
    v_add_f32 v231, 0x73600000, v230
    v_min_f32_e64 v74, v225, v231
    v_add_f32 v232, 0x73500000, v230
    v_min_f32_e64 v75, v225, v232
    v_add_f32 v231, 0x73000000, v230
    v_min_f32_e64 v76, v225, v231
    v_add_f32 v232, 0x72e00000, v230
    v_min_f32_e64 v77, v225, v232
    v_add_f32 v231, 0x72c00000, v230
    v_min_f32_e64 v78, v225, v231
    v_add_f32 v232, 0x72a00000, v230
    v_min_f32 v79, v225, v232
    s_nop 1
    s_branch kf_fixr4
kf_rare6:
    s_nop 15
    v_max3_f32 v230, v32, v33, v34
    v_max3_f32 v230, v230, v35, v36
    v_max3_f32 v230, v230, v37, v38
    v_max_f32 v230, v230, v39
    v_mov_b32 v231, v230
    s_nop 1
    v_permlane16_swap_b32 v230, v231
    s_nop 0
    v_max_f32 v230, v230, v231
    v_mov_b32 v231, v230
    s_nop 1
    v_permlane32_swap_b32 v230, v231
    s_nop 0
    v_max_f32_e64 v230, v230, v231
    v_add_f32 v230, 0x41800000, v230
    v_max_f32 v230, 0, v230
    v_sub_f32 v232, 0, v230
    v_exp_f32 v232, v232
    v_sub_f32 v224, v224, v230
    v_sub_f32 v64, v64, v230
    v_sub_f32 v0, v0, v230
    v_sub_f32 v32, v32, v230
    v_sub_f32 v65, v65, v230
    v_sub_f32 v1, v1, v230
    v_sub_f32 v33, v33, v230
    v_sub_f32 v66, v66, v230
    v_sub_f32 v2, v2, v230
    v_sub_f32 v34, v34, v230
    v_sub_f32 v67, v67, v230
    v_sub_f32 v3, v3, v230
    v_sub_f32 v35, v35, v230
    v_sub_f32 v68, v68, v230
    v_sub_f32 v4, v4, v230
    v_sub_f32 v36, v36, v230
    v_sub_f32 v69, v69, v230
    v_sub_f32 v5, v5, v230
    v_sub_f32 v37, v37, v230
    v_sub_f32 v70, v70, v230
    v_sub_f32 v6, v6, v230
    v_sub_f32 v38, v38, v230
    v_sub_f32 v71, v71, v230
    v_sub_f32 v7, v7, v230
    v_sub_f32 v39, v39, v230
    v_mul_f32 v144, v144, v232
    v_mul_f32 v145, v145, v232
    v_mul_f32 v146, v146, v232
    v_mul_f32 v147, v147, v232
    v_accvgpr_read_b32 v233, a0
    v_mul_f32_e64 v233, v233, v232
    v_accvgpr_write_b32 a0, v233
    v_accvgpr_read_b32 v234, a1
    v_mul_f32_e64 v234, v234, v232
    v_accvgpr_write_b32 a1, v234
    v_accvgpr_read_b32 v235, a2
    v_mul_f32_e64 v235, v235, v232
    v_accvgpr_write_b32 a2, v235
    v_accvgpr_read_b32 v236, a3
    v_mul_f32_e64 v236, v236, v232
    v_accvgpr_write_b32 a3, v236
    v_accvgpr_read_b32 v233, a4
    v_mul_f32_e64 v233, v233, v232
    v_accvgpr_write_b32 a4, v233
    v_accvgpr_read_b32 v234, a5
    v_mul_f32_e64 v234, v234, v232
    v_accvgpr_write_b32 a5, v234
    v_accvgpr_read_b32 v235, a6
    v_mul_f32_e64 v235, v235, v232
    v_accvgpr_write_b32 a6, v235
    v_accvgpr_read_b32 v236, a7
    v_mul_f32_e64 v236, v236, v232
    v_accvgpr_write_b32 a7, v236
    v_accvgpr_read_b32 v233, a8
    v_mul_f32_e64 v233, v233, v232
    v_accvgpr_write_b32 a8, v233
    v_accvgpr_read_b32 v234, a9
    v_mul_f32_e64 v234, v234, v232
    v_accvgpr_write_b32 a9, v234
    v_accvgpr_read_b32 v235, a10
    v_mul_f32_e64 v235, v235, v232
    v_accvgpr_write_b32 a10, v235
    v_accvgpr_read_b32 v236, a11
    v_mul_f32_e64 v236, v236, v232
    v_accvgpr_write_b32 a11, v236
    v_accvgpr_read_b32 v233, a12
    v_mul_f32_e64 v233, v233, v232
    v_accvgpr_write_b32 a12, v233
    v_accvgpr_read_b32 v234, a13
    v_mul_f32_e64 v234, v234, v232
    v_accvgpr_write_b32 a13, v234
    v_accvgpr_read_b32 v235, a14
    v_mul_f32_e64 v235, v235, v232
    v_accvgpr_write_b32 a14, v235
    v_accvgpr_read_b32 v236, a15
    v_mul_f32_e64 v236, v236, v232
    v_accvgpr_write_b32 a15, v236
    v_accvgpr_read_b32 v233, a16
    v_mul_f32_e64 v233, v233, v232
    v_accvgpr_write_b32 a16, v233
    v_accvgpr_read_b32 v234, a17
    v_mul_f32_e64 v234, v234, v232
    v_accvgpr_write_b32 a17, v234
    v_accvgpr_read_b32 v235, a18
    v_mul_f32_e64 v235, v235, v232
    v_accvgpr_write_b32 a18, v235
    v_accvgpr_read_b32 v236, a19
    v_mul_f32_e64 v236, v236, v232
    v_accvgpr_write_b32 a19, v236
    v_accvgpr_read_b32 v233, a20
    v_mul_f32_e64 v233, v233, v232
    v_accvgpr_write_b32 a20, v233
    v_accvgpr_read_b32 v234, a21
    v_mul_f32_e64 v234, v234, v232
    v_accvgpr_write_b32 a21, v234
    v_accvgpr_read_b32 v235, a22
    v_mul_f32_e64 v235, v235, v232
    v_accvgpr_write_b32 a22, v235
    v_accvgpr_read_b32 v236, a23
    v_mul_f32_e64 v236, v236, v232
    v_accvgpr_write_b32 a23, v236
    v_accvgpr_read_b32 v233, a24
    v_mul_f32_e64 v233, v233, v232
    v_accvgpr_write_b32 a24, v233
    v_accvgpr_read_b32 v234, a25
    v_mul_f32_e64 v234, v234, v232
    v_accvgpr_write_b32 a25, v234
    v_accvgpr_read_b32 v235, a26
    v_mul_f32_e64 v235, v235, v232
    v_accvgpr_write_b32 a26, v235
    v_accvgpr_read_b32 v236, a27
    v_mul_f32_e64 v236, v236, v232
    v_accvgpr_write_b32 a27, v236
    v_accvgpr_read_b32 v233, a28
    v_mul_f32_e64 v233, v233, v232
    v_accvgpr_write_b32 a28, v233
    v_accvgpr_read_b32 v234, a29
    v_mul_f32_e64 v234, v234, v232
    v_accvgpr_write_b32 a29, v234
    v_accvgpr_read_b32 v235, a30
    v_mul_f32_e64 v235, v235, v232
    v_accvgpr_write_b32 a30, v235
    v_accvgpr_read_b32 v236, a31
    v_mul_f32_e64 v236, v236, v232
    v_accvgpr_write_b32 a31, v236
    v_exp_f32 v128, v32
    v_exp_f32 v129, v33
    v_exp_f32 v130, v34
    v_exp_f32 v131, v35
    v_exp_f32 v132, v36
    v_exp_f32 v133, v37
    v_exp_f32 v134, v38
    v_exp_f32_e64 v135, v39
    s_nop 0
    v_cvt_pk_bf16_f32 v112, v128, v129
    v_cvt_pk_bf16_f32 v113, v130, v131
    v_cvt_pk_bf16_f32 v114, v132, v133
    v_cvt_pk_bf16_f32 v115, v134, v135
    v_max3_f32 v230, v40, v41, v42
    v_max3_f32 v230, v230, v43, v44
    v_max3_f32 v230, v230, v45, v46
    v_max_f32 v230, v230, v47
    v_mov_b32 v231, v230
    s_nop 1
    v_permlane16_swap_b32 v230, v231
    s_nop 0
    v_max_f32 v230, v230, v231
    v_mov_b32 v231, v230
    s_nop 1
    v_permlane32_swap_b32 v230, v231
    s_nop 0
    v_max_f32_e64 v230, v230, v231
    v_add_f32 v230, 0x41800000, v230
    v_max_f32 v230, 0, v230
    v_sub_f32 v232, 0, v230
    v_exp_f32 v232, v232
    v_sub_f32 v225, v225, v230
    v_sub_f32 v72, v72, v230
    v_sub_f32 v8, v8, v230
    v_sub_f32 v40, v40, v230
    v_sub_f32 v73, v73, v230
    v_sub_f32 v9, v9, v230
    v_sub_f32 v41, v41, v230
    v_sub_f32 v74, v74, v230
    v_sub_f32 v10, v10, v230
    v_sub_f32 v42, v42, v230
    v_sub_f32 v75, v75, v230
    v_sub_f32 v11, v11, v230
    v_sub_f32 v43, v43, v230
    v_sub_f32 v76, v76, v230
    v_sub_f32 v12, v12, v230
    v_sub_f32 v44, v44, v230
    v_sub_f32 v77, v77, v230
    v_sub_f32 v13, v13, v230
    v_sub_f32 v45, v45, v230
    v_sub_f32 v78, v78, v230
    v_sub_f32 v14, v14, v230
    v_sub_f32 v46, v46, v230
    v_sub_f32 v79, v79, v230
    v_sub_f32 v15, v15, v230
    v_sub_f32 v47, v47, v230
    v_mul_f32 v148, v148, v232
    v_mul_f32 v149, v149, v232
    v_mul_f32 v150, v150, v232
    v_mul_f32 v151, v151, v232
    v_accvgpr_read_b32 v233, a32
    v_mul_f32_e64 v233, v233, v232
    v_accvgpr_write_b32 a32, v233
    v_accvgpr_read_b32 v234, a33
    v_mul_f32_e64 v234, v234, v232
    v_accvgpr_write_b32 a33, v234
    v_accvgpr_read_b32 v235, a34
    v_mul_f32_e64 v235, v235, v232
    v_accvgpr_write_b32 a34, v235
    v_accvgpr_read_b32 v236, a35
    v_mul_f32_e64 v236, v236, v232
    v_accvgpr_write_b32 a35, v236
    v_accvgpr_read_b32 v233, a36
    v_mul_f32_e64 v233, v233, v232
    v_accvgpr_write_b32 a36, v233
    v_accvgpr_read_b32 v234, a37
    v_mul_f32_e64 v234, v234, v232
    v_accvgpr_write_b32 a37, v234
    v_accvgpr_read_b32 v235, a38
    v_mul_f32_e64 v235, v235, v232
    v_accvgpr_write_b32 a38, v235
    v_accvgpr_read_b32 v236, a39
    v_mul_f32_e64 v236, v236, v232
    v_accvgpr_write_b32 a39, v236
    v_accvgpr_read_b32 v233, a40
    v_mul_f32_e64 v233, v233, v232
    v_accvgpr_write_b32 a40, v233
    v_accvgpr_read_b32 v234, a41
    v_mul_f32_e64 v234, v234, v232
    v_accvgpr_write_b32 a41, v234
    v_accvgpr_read_b32 v235, a42
    v_mul_f32_e64 v235, v235, v232
    v_accvgpr_write_b32 a42, v235
    v_accvgpr_read_b32 v236, a43
    v_mul_f32_e64 v236, v236, v232
    v_accvgpr_write_b32 a43, v236
    v_accvgpr_read_b32 v233, a44
    v_mul_f32_e64 v233, v233, v232
    v_accvgpr_write_b32 a44, v233
    v_accvgpr_read_b32 v234, a45
    v_mul_f32_e64 v234, v234, v232
    v_accvgpr_write_b32 a45, v234
    v_accvgpr_read_b32 v235, a46
    v_mul_f32_e64 v235, v235, v232
    v_accvgpr_write_b32 a46, v235
    v_accvgpr_read_b32 v236, a47
    v_mul_f32_e64 v236, v236, v232
    v_accvgpr_write_b32 a47, v236
    v_accvgpr_read_b32 v233, a48
    v_mul_f32_e64 v233, v233, v232
    v_accvgpr_write_b32 a48, v233
    v_accvgpr_read_b32 v234, a49
    v_mul_f32_e64 v234, v234, v232
    v_accvgpr_write_b32 a49, v234
    v_accvgpr_read_b32 v235, a50
    v_mul_f32_e64 v235, v235, v232
    v_accvgpr_write_b32 a50, v235
    v_accvgpr_read_b32 v236, a51
    v_mul_f32_e64 v236, v236, v232
    v_accvgpr_write_b32 a51, v236
    v_accvgpr_read_b32 v233, a52
    v_mul_f32_e64 v233, v233, v232
    v_accvgpr_write_b32 a52, v233
    v_accvgpr_read_b32 v234, a53
    v_mul_f32_e64 v234, v234, v232
    v_accvgpr_write_b32 a53, v234
    v_accvgpr_read_b32 v235, a54
    v_mul_f32_e64 v235, v235, v232
    v_accvgpr_write_b32 a54, v235
    v_accvgpr_read_b32 v236, a55
    v_mul_f32_e64 v236, v236, v232
    v_accvgpr_write_b32 a55, v236
    v_accvgpr_read_b32 v233, a56
    v_mul_f32_e64 v233, v233, v232
    v_accvgpr_write_b32 a56, v233
    v_accvgpr_read_b32 v234, a57
    v_mul_f32_e64 v234, v234, v232
    v_accvgpr_write_b32 a57, v234
    v_accvgpr_read_b32 v235, a58
    v_mul_f32_e64 v235, v235, v232
    v_accvgpr_write_b32 a58, v235
    v_accvgpr_read_b32 v236, a59
    v_mul_f32_e64 v236, v236, v232
    v_accvgpr_write_b32 a59, v236
    v_accvgpr_read_b32 v233, a60
    v_mul_f32_e64 v233, v233, v232
    v_accvgpr_write_b32 a60, v233
    v_accvgpr_read_b32 v234, a61
    v_mul_f32_e64 v234, v234, v232
    v_accvgpr_write_b32 a61, v234
    v_accvgpr_read_b32 v235, a62
    v_mul_f32_e64 v235, v235, v232
    v_accvgpr_write_b32 a62, v235
    v_accvgpr_read_b32 v236, a63
    v_mul_f32_e64 v236, v236, v232
    v_accvgpr_write_b32 a63, v236
    v_exp_f32 v128, v40
    v_exp_f32 v129, v41
    v_exp_f32 v130, v42
    v_exp_f32 v131, v43
    v_exp_f32 v132, v44
    v_exp_f32 v133, v45
    v_exp_f32 v134, v46
    v_exp_f32_e64 v135, v47
    s_nop 0
    v_cvt_pk_bf16_f32 v116, v128, v129
    v_cvt_pk_bf16_f32 v117, v130, v131
    v_cvt_pk_bf16_f32 v118, v132, v133
    v_cvt_pk_bf16_f32 v119, v134, v135
    v_max3_f32 v230, v48, v49, v50
    v_max3_f32 v230, v230, v51, v52
    v_max3_f32 v230, v230, v53, v54
    v_max_f32 v230, v230, v55
    v_mov_b32 v231, v230
    s_nop 1
    v_permlane16_swap_b32 v230, v231
    s_nop 0
    v_max_f32 v230, v230, v231
    v_mov_b32 v231, v230
    s_nop 1
    v_permlane32_swap_b32 v230, v231
    s_nop 0
    v_max_f32_e64 v230, v230, v231
    v_add_f32 v230, 0x41800000, v230
    v_max_f32 v230, 0, v230
    v_sub_f32 v232, 0, v230
    v_exp_f32 v232, v232
    v_sub_f32 v226, v226, v230
    v_sub_f32 v80, v80, v230
    v_sub_f32 v16, v16, v230
    v_sub_f32 v48, v48, v230
    v_sub_f32 v81, v81, v230
    v_sub_f32 v17, v17, v230
    v_sub_f32 v49, v49, v230
    v_sub_f32 v82, v82, v230
    v_sub_f32 v18, v18, v230
    v_sub_f32 v50, v50, v230
    v_sub_f32 v83, v83, v230
    v_sub_f32 v19, v19, v230
    v_sub_f32 v51, v51, v230
    v_sub_f32 v84, v84, v230
    v_sub_f32 v20, v20, v230
    v_sub_f32 v52, v52, v230
    v_sub_f32 v85, v85, v230
    v_sub_f32 v21, v21, v230
    v_sub_f32 v53, v53, v230
    v_sub_f32 v86, v86, v230
    v_sub_f32 v22, v22, v230
    v_sub_f32 v54, v54, v230
    v_sub_f32 v87, v87, v230
    v_sub_f32 v23, v23, v230
    v_sub_f32 v55, v55, v230
    v_mul_f32 v152, v152, v232
    v_mul_f32 v153, v153, v232
    v_mul_f32 v154, v154, v232
    v_mul_f32 v155, v155, v232
    v_accvgpr_read_b32 v233, a64
    v_mul_f32_e64 v233, v233, v232
    v_accvgpr_write_b32 a64, v233
    v_accvgpr_read_b32 v234, a65
    v_mul_f32_e64 v234, v234, v232
    v_accvgpr_write_b32 a65, v234
    v_accvgpr_read_b32 v235, a66
    v_mul_f32_e64 v235, v235, v232
    v_accvgpr_write_b32 a66, v235
    v_accvgpr_read_b32 v236, a67
    v_mul_f32_e64 v236, v236, v232
    v_accvgpr_write_b32 a67, v236
    v_accvgpr_read_b32 v233, a68
    v_mul_f32_e64 v233, v233, v232
    v_accvgpr_write_b32 a68, v233
    v_accvgpr_read_b32 v234, a69
    v_mul_f32_e64 v234, v234, v232
    v_accvgpr_write_b32 a69, v234
    v_accvgpr_read_b32 v235, a70
    v_mul_f32_e64 v235, v235, v232
    v_accvgpr_write_b32 a70, v235
    v_accvgpr_read_b32 v236, a71
    v_mul_f32_e64 v236, v236, v232
    v_accvgpr_write_b32 a71, v236
    v_accvgpr_read_b32 v233, a72
    v_mul_f32_e64 v233, v233, v232
    v_accvgpr_write_b32 a72, v233
    v_accvgpr_read_b32 v234, a73
    v_mul_f32_e64 v234, v234, v232
    v_accvgpr_write_b32 a73, v234
    v_accvgpr_read_b32 v235, a74
    v_mul_f32_e64 v235, v235, v232
    v_accvgpr_write_b32 a74, v235
    v_accvgpr_read_b32 v236, a75
    v_mul_f32_e64 v236, v236, v232
    v_accvgpr_write_b32 a75, v236
    v_accvgpr_read_b32 v233, a76
    v_mul_f32_e64 v233, v233, v232
    v_accvgpr_write_b32 a76, v233
    v_accvgpr_read_b32 v234, a77
    v_mul_f32_e64 v234, v234, v232
    v_accvgpr_write_b32 a77, v234
    v_accvgpr_read_b32 v235, a78
    v_mul_f32_e64 v235, v235, v232
    v_accvgpr_write_b32 a78, v235
    v_accvgpr_read_b32 v236, a79
    v_mul_f32_e64 v236, v236, v232
    v_accvgpr_write_b32 a79, v236
    v_accvgpr_read_b32 v233, a80
    v_mul_f32_e64 v233, v233, v232
    v_accvgpr_write_b32 a80, v233
    v_accvgpr_read_b32 v234, a81
    v_mul_f32_e64 v234, v234, v232
    v_accvgpr_write_b32 a81, v234
    v_accvgpr_read_b32 v235, a82
    v_mul_f32_e64 v235, v235, v232
    v_accvgpr_write_b32 a82, v235
    v_accvgpr_read_b32 v236, a83
    v_mul_f32_e64 v236, v236, v232
    v_accvgpr_write_b32 a83, v236
    v_accvgpr_read_b32 v233, a84
    v_mul_f32_e64 v233, v233, v232
    v_accvgpr_write_b32 a84, v233
    v_accvgpr_read_b32 v234, a85
    v_mul_f32_e64 v234, v234, v232
    v_accvgpr_write_b32 a85, v234
    v_accvgpr_read_b32 v235, a86
    v_mul_f32_e64 v235, v235, v232
    v_accvgpr_write_b32 a86, v235
    v_accvgpr_read_b32 v236, a87
    v_mul_f32_e64 v236, v236, v232
    v_accvgpr_write_b32 a87, v236
    v_accvgpr_read_b32 v233, a88
    v_mul_f32_e64 v233, v233, v232
    v_accvgpr_write_b32 a88, v233
    v_accvgpr_read_b32 v234, a89
    v_mul_f32_e64 v234, v234, v232
    v_accvgpr_write_b32 a89, v234
    v_accvgpr_read_b32 v235, a90
    v_mul_f32_e64 v235, v235, v232
    v_accvgpr_write_b32 a90, v235
    v_accvgpr_read_b32 v236, a91
    v_mul_f32_e64 v236, v236, v232
    v_accvgpr_write_b32 a91, v236
    v_accvgpr_read_b32 v233, a92
    v_mul_f32_e64 v233, v233, v232
    v_accvgpr_write_b32 a92, v233
    v_accvgpr_read_b32 v234, a93
    v_mul_f32_e64 v234, v234, v232
    v_accvgpr_write_b32 a93, v234
    v_accvgpr_read_b32 v235, a94
    v_mul_f32_e64 v235, v235, v232
    v_accvgpr_write_b32 a94, v235
    v_accvgpr_read_b32 v236, a95
    v_mul_f32_e64 v236, v236, v232
    v_accvgpr_write_b32 a95, v236
    v_exp_f32 v128, v48
    v_exp_f32 v129, v49
    v_exp_f32 v130, v50
    v_exp_f32 v131, v51
    v_exp_f32 v132, v52
    v_exp_f32 v133, v53
    v_exp_f32 v134, v54
    v_exp_f32_e64 v135, v55
    s_nop 0
    v_cvt_pk_bf16_f32 v120, v128, v129
    v_cvt_pk_bf16_f32 v121, v130, v131
    v_cvt_pk_bf16_f32 v122, v132, v133
    v_cvt_pk_bf16_f32 v123, v134, v135
    v_max3_f32 v230, v56, v57, v58
    v_max3_f32 v230, v230, v59, v60
    v_max3_f32 v230, v230, v61, v62
    v_max_f32 v230, v230, v63
    v_mov_b32 v231, v230
    s_nop 1
    v_permlane16_swap_b32 v230, v231
    s_nop 0
    v_max_f32 v230, v230, v231
    v_mov_b32 v231, v230
    s_nop 1
    v_permlane32_swap_b32 v230, v231
    s_nop 0
    v_max_f32_e64 v230, v230, v231
    v_add_f32 v230, 0x41800000, v230
    v_max_f32 v230, 0, v230
    v_sub_f32 v232, 0, v230
    v_exp_f32 v232, v232
    v_sub_f32 v227, v227, v230
    v_sub_f32 v88, v88, v230
    v_sub_f32 v24, v24, v230
    v_sub_f32 v56, v56, v230
    v_sub_f32 v89, v89, v230
    v_sub_f32 v25, v25, v230
    v_sub_f32 v57, v57, v230
    v_sub_f32 v90, v90, v230
    v_sub_f32 v26, v26, v230
    v_sub_f32 v58, v58, v230
    v_sub_f32 v91, v91, v230
    v_sub_f32 v27, v27, v230
    v_sub_f32 v59, v59, v230
    v_sub_f32 v92, v92, v230
    v_sub_f32 v28, v28, v230
    v_sub_f32 v60, v60, v230
    v_sub_f32 v93, v93, v230
    v_sub_f32 v29, v29, v230
    v_sub_f32 v61, v61, v230
    v_sub_f32 v94, v94, v230
    v_sub_f32 v30, v30, v230
    v_sub_f32 v62, v62, v230
    v_sub_f32 v95, v95, v230
    v_sub_f32 v31, v31, v230
    v_sub_f32 v63, v63, v230
    v_mul_f32 v156, v156, v232
    v_mul_f32 v157, v157, v232
    v_mul_f32 v158, v158, v232
    v_mul_f32 v159, v159, v232
    v_accvgpr_read_b32 v233, a96
    v_mul_f32_e64 v233, v233, v232
    v_accvgpr_write_b32 a96, v233
    v_accvgpr_read_b32 v234, a97
    v_mul_f32_e64 v234, v234, v232
    v_accvgpr_write_b32 a97, v234
    v_accvgpr_read_b32 v235, a98
    v_mul_f32_e64 v235, v235, v232
    v_accvgpr_write_b32 a98, v235
    v_accvgpr_read_b32 v236, a99
    v_mul_f32_e64 v236, v236, v232
    v_accvgpr_write_b32 a99, v236
    v_accvgpr_read_b32 v233, a100
    v_mul_f32_e64 v233, v233, v232
    v_accvgpr_write_b32 a100, v233
    v_accvgpr_read_b32 v234, a101
    v_mul_f32_e64 v234, v234, v232
    v_accvgpr_write_b32 a101, v234
    v_accvgpr_read_b32 v235, a102
    v_mul_f32_e64 v235, v235, v232
    v_accvgpr_write_b32 a102, v235
    v_accvgpr_read_b32 v236, a103
    v_mul_f32_e64 v236, v236, v232
    v_accvgpr_write_b32 a103, v236
    v_accvgpr_read_b32 v233, a104
    v_mul_f32_e64 v233, v233, v232
    v_accvgpr_write_b32 a104, v233
    v_accvgpr_read_b32 v234, a105
    v_mul_f32_e64 v234, v234, v232
    v_accvgpr_write_b32 a105, v234
    v_accvgpr_read_b32 v235, a106
    v_mul_f32_e64 v235, v235, v232
    v_accvgpr_write_b32 a106, v235
    v_accvgpr_read_b32 v236, a107
    v_mul_f32_e64 v236, v236, v232
    v_accvgpr_write_b32 a107, v236
    v_accvgpr_read_b32 v233, a108
    v_mul_f32_e64 v233, v233, v232
    v_accvgpr_write_b32 a108, v233
    v_accvgpr_read_b32 v234, a109
    v_mul_f32_e64 v234, v234, v232
    v_accvgpr_write_b32 a109, v234
    v_accvgpr_read_b32 v235, a110
    v_mul_f32_e64 v235, v235, v232
    v_accvgpr_write_b32 a110, v235
    v_accvgpr_read_b32 v236, a111
    v_mul_f32_e64 v236, v236, v232
    v_accvgpr_write_b32 a111, v236
    v_accvgpr_read_b32 v233, a112
    v_mul_f32_e64 v233, v233, v232
    v_accvgpr_write_b32 a112, v233
    v_accvgpr_read_b32 v234, a113
    v_mul_f32_e64 v234, v234, v232
    v_accvgpr_write_b32 a113, v234
    v_accvgpr_read_b32 v235, a114
    v_mul_f32_e64 v235, v235, v232
    v_accvgpr_write_b32 a114, v235
    v_accvgpr_read_b32 v236, a115
    v_mul_f32_e64 v236, v236, v232
    v_accvgpr_write_b32 a115, v236
    v_accvgpr_read_b32 v233, a116
    v_mul_f32_e64 v233, v233, v232
    v_accvgpr_write_b32 a116, v233
    v_accvgpr_read_b32 v234, a117
    v_mul_f32_e64 v234, v234, v232
    v_accvgpr_write_b32 a117, v234
    v_accvgpr_read_b32 v235, a118
    v_mul_f32_e64 v235, v235, v232
    v_accvgpr_write_b32 a118, v235
    v_accvgpr_read_b32 v236, a119
    v_mul_f32_e64 v236, v236, v232
    v_accvgpr_write_b32 a119, v236
    v_accvgpr_read_b32 v233, a120
    v_mul_f32_e64 v233, v233, v232
    v_accvgpr_write_b32 a120, v233
    v_accvgpr_read_b32 v234, a121
    v_mul_f32_e64 v234, v234, v232
    v_accvgpr_write_b32 a121, v234
    v_accvgpr_read_b32 v235, a122
    v_mul_f32_e64 v235, v235, v232
    v_accvgpr_write_b32 a122, v235
    v_accvgpr_read_b32 v236, a123
    v_mul_f32_e64 v236, v236, v232
    v_accvgpr_write_b32 a123, v236
    v_accvgpr_read_b32 v233, a124
    v_mul_f32_e64 v233, v233, v232
    v_accvgpr_write_b32 a124, v233
    v_accvgpr_read_b32 v234, a125
    v_mul_f32_e64 v234, v234, v232
    v_accvgpr_write_b32 a125, v234
    v_accvgpr_read_b32 v235, a126
    v_mul_f32_e64 v235, v235, v232
    v_accvgpr_write_b32 a126, v235
    v_accvgpr_read_b32 v236, a127
    v_mul_f32_e64 v236, v236, v232
    v_accvgpr_write_b32 a127, v236
    v_exp_f32 v128, v56
    v_exp_f32 v129, v57
    v_exp_f32 v130, v58
    v_exp_f32 v131, v59
    v_exp_f32 v132, v60
    v_exp_f32 v133, v61
    v_exp_f32 v134, v62
    v_exp_f32_e64 v135, v63
    s_nop 0
    v_cvt_pk_bf16_f32 v124, v128, v129
    v_cvt_pk_bf16_f32 v125, v130, v131
    v_cvt_pk_bf16_f32 v126, v132, v133
    v_cvt_pk_bf16_f32 v127, v134, v135
    s_nop 1
    s_branch kf_rr5
kf_rare10:
    s_nop 15
    v_max3_f32 v230, v0, v1, v2
    v_max3_f32 v230, v230, v3, v4
    v_max3_f32 v230, v230, v5, v6
    v_max_f32 v230, v230, v7
    v_mov_b32 v231, v230
    s_nop 1
    v_permlane16_swap_b32 v230, v231
    s_nop 0
    v_max_f32 v230, v230, v231
    v_mov_b32 v231, v230
    s_nop 1
    v_permlane32_swap_b32 v230, v231
    s_nop 0
    v_max_f32 v230, v230, v231
    v_add_f32 v230, 0x41800000, v230
    v_max_f32 v230, 0, v230
    v_sub_f32 v232, 0, v230
    v_exp_f32 v232, v232
    v_sub_f32 v224, v224, v230
    v_sub_f32 v64, v64, v230
    v_sub_f32 v32, v32, v230
    v_sub_f32 v0, v0, v230
    v_sub_f32 v65, v65, v230
    v_sub_f32 v33, v33, v230
    v_sub_f32 v1, v1, v230
    v_sub_f32 v66, v66, v230
    v_sub_f32 v34, v34, v230
    v_sub_f32 v2, v2, v230
    v_sub_f32 v67, v67, v230
    v_sub_f32 v35, v35, v230
    v_sub_f32 v3, v3, v230
    v_sub_f32 v68, v68, v230
    v_sub_f32 v36, v36, v230
    v_sub_f32 v4, v4, v230
    v_sub_f32 v69, v69, v230
    v_sub_f32 v37, v37, v230
    v_sub_f32 v5, v5, v230
    v_sub_f32 v70, v70, v230
    v_sub_f32 v38, v38, v230
    v_sub_f32 v6, v6, v230
    v_sub_f32 v71, v71, v230
    v_sub_f32 v39, v39, v230
    v_sub_f32 v7, v7, v230
    v_mul_f32 v144, v144, v232
    v_mul_f32 v145, v145, v232
    v_mul_f32 v146, v146, v232
    v_mul_f32 v147, v147, v232
    v_accvgpr_read_b32 v233, a0
    v_mul_f32_e64 v233, v233, v232
    v_accvgpr_write_b32 a0, v233
    v_accvgpr_read_b32 v234, a1
    v_mul_f32_e64 v234, v234, v232
    v_accvgpr_write_b32 a1, v234
    v_accvgpr_read_b32 v235, a2
    v_mul_f32_e64 v235, v235, v232
    v_accvgpr_write_b32 a2, v235
    v_accvgpr_read_b32 v236, a3
    v_mul_f32_e64 v236, v236, v232
    v_accvgpr_write_b32 a3, v236
    v_accvgpr_read_b32 v233, a4
    v_mul_f32_e64 v233, v233, v232
    v_accvgpr_write_b32 a4, v233
    v_accvgpr_read_b32 v234, a5
    v_mul_f32_e64 v234, v234, v232
    v_accvgpr_write_b32 a5, v234
    v_accvgpr_read_b32 v235, a6
    v_mul_f32_e64 v235, v235, v232
    v_accvgpr_write_b32 a6, v235
    v_accvgpr_read_b32 v236, a7
    v_mul_f32_e64 v236, v236, v232
    v_accvgpr_write_b32 a7, v236
    v_accvgpr_read_b32 v233, a8
    v_mul_f32_e64 v233, v233, v232
    v_accvgpr_write_b32 a8, v233
    v_accvgpr_read_b32 v234, a9
    v_mul_f32_e64 v234, v234, v232
    v_accvgpr_write_b32 a9, v234
    v_accvgpr_read_b32 v235, a10
    v_mul_f32_e64 v235, v235, v232
    v_accvgpr_write_b32 a10, v235
    v_accvgpr_read_b32 v236, a11
    v_mul_f32_e64 v236, v236, v232
    v_accvgpr_write_b32 a11, v236
    v_accvgpr_read_b32 v233, a12
    v_mul_f32_e64 v233, v233, v232
    v_accvgpr_write_b32 a12, v233
    v_accvgpr_read_b32 v234, a13
    v_mul_f32_e64 v234, v234, v232
    v_accvgpr_write_b32 a13, v234
    v_accvgpr_read_b32 v235, a14
    v_mul_f32_e64 v235, v235, v232
    v_accvgpr_write_b32 a14, v235
    v_accvgpr_read_b32 v236, a15
    v_mul_f32_e64 v236, v236, v232
    v_accvgpr_write_b32 a15, v236
    v_accvgpr_read_b32 v233, a16
    v_mul_f32_e64 v233, v233, v232
    v_accvgpr_write_b32 a16, v233
    v_accvgpr_read_b32 v234, a17
    v_mul_f32_e64 v234, v234, v232
    v_accvgpr_write_b32 a17, v234
    v_accvgpr_read_b32 v235, a18
    v_mul_f32_e64 v235, v235, v232
    v_accvgpr_write_b32 a18, v235
    v_accvgpr_read_b32 v236, a19
    v_mul_f32_e64 v236, v236, v232
    v_accvgpr_write_b32 a19, v236
    v_accvgpr_read_b32 v233, a20
    v_mul_f32_e64 v233, v233, v232
    v_accvgpr_write_b32 a20, v233
    v_accvgpr_read_b32 v234, a21
    v_mul_f32_e64 v234, v234, v232
    v_accvgpr_write_b32 a21, v234
    v_accvgpr_read_b32 v235, a22
    v_mul_f32_e64 v235, v235, v232
    v_accvgpr_write_b32 a22, v235
    v_accvgpr_read_b32 v236, a23
    v_mul_f32_e64 v236, v236, v232
    v_accvgpr_write_b32 a23, v236
    v_accvgpr_read_b32 v233, a24
    v_mul_f32_e64 v233, v233, v232
    v_accvgpr_write_b32 a24, v233
    v_accvgpr_read_b32 v234, a25
    v_mul_f32_e64 v234, v234, v232
    v_accvgpr_write_b32 a25, v234
    v_accvgpr_read_b32 v235, a26
    v_mul_f32_e64 v235, v235, v232
    v_accvgpr_write_b32 a26, v235
    v_accvgpr_read_b32 v236, a27
    v_mul_f32_e64 v236, v236, v232
    v_accvgpr_write_b32 a27, v236
    v_accvgpr_read_b32 v233, a28
    v_mul_f32_e64 v233, v233, v232
    v_accvgpr_write_b32 a28, v233
    v_accvgpr_read_b32 v234, a29
    v_mul_f32_e64 v234, v234, v232
    v_accvgpr_write_b32 a29, v234
    v_accvgpr_read_b32 v235, a30
    v_mul_f32_e64 v235, v235, v232
    v_accvgpr_write_b32 a30, v235
    v_accvgpr_read_b32 v236, a31
    v_mul_f32_e64 v236, v236, v232
    v_accvgpr_write_b32 a31, v236
    v_exp_f32 v128, v0
    v_exp_f32 v129, v1
    v_exp_f32 v130, v2
    v_exp_f32 v131, v3
    v_exp_f32 v132, v4
    v_exp_f32 v133, v5
    v_exp_f32 v134, v6
    v_exp_f32_e64 v135, v7
    s_nop 0
    v_cvt_pk_bf16_f32 v96, v128, v129
    v_cvt_pk_bf16_f32 v97, v130, v131
    v_cvt_pk_bf16_f32 v98, v132, v133
    v_cvt_pk_bf16_f32 v99, v134, v135
    v_max3_f32 v230, v8, v9, v10
    v_max3_f32 v230, v230, v11, v12
    v_max3_f32 v230, v230, v13, v14
    v_max_f32 v230, v230, v15
    v_mov_b32 v231, v230
    s_nop 1
    v_permlane16_swap_b32 v230, v231
    s_nop 0
    v_max_f32 v230, v230, v231
    v_mov_b32 v231, v230
    s_nop 1
    v_permlane32_swap_b32 v230, v231
    s_nop 0
    v_max_f32_e64 v230, v230, v231
    v_add_f32 v230, 0x41800000, v230
    v_max_f32 v230, 0, v230
    v_sub_f32 v232, 0, v230
    v_exp_f32 v232, v232
    v_sub_f32 v225, v225, v230
    v_sub_f32 v72, v72, v230
    v_sub_f32 v40, v40, v230
    v_sub_f32 v8, v8, v230
    v_sub_f32 v73, v73, v230
    v_sub_f32 v41, v41, v230
    v_sub_f32 v9, v9, v230
    v_sub_f32 v74, v74, v230
    v_sub_f32 v42, v42, v230
    v_sub_f32 v10, v10, v230
    v_sub_f32 v75, v75, v230
    v_sub_f32 v43, v43, v230
    v_sub_f32 v11, v11, v230
    v_sub_f32 v76, v76, v230
    v_sub_f32 v44, v44, v230
    v_sub_f32 v12, v12, v230
    v_sub_f32 v77, v77, v230
    v_sub_f32 v45, v45, v230
    v_sub_f32 v13, v13, v230
    v_sub_f32 v78, v78, v230
    v_sub_f32 v46, v46, v230
    v_sub_f32 v14, v14, v230
    v_sub_f32 v79, v79, v230
    v_sub_f32 v47, v47, v230
    v_sub_f32 v15, v15, v230
    v_mul_f32 v148, v148, v232
    v_mul_f32 v149, v149, v232
    v_mul_f32 v150, v150, v232
    v_mul_f32 v151, v151, v232
    v_accvgpr_read_b32 v233, a32
    v_mul_f32_e64 v233, v233, v232
    v_accvgpr_write_b32 a32, v233
    v_accvgpr_read_b32 v234, a33
    v_mul_f32_e64 v234, v234, v232
    v_accvgpr_write_b32 a33, v234
    v_accvgpr_read_b32 v235, a34
    v_mul_f32_e64 v235, v235, v232
    v_accvgpr_write_b32 a34, v235
    v_accvgpr_read_b32 v236, a35
    v_mul_f32_e64 v236, v236, v232
    v_accvgpr_write_b32 a35, v236
    v_accvgpr_read_b32 v233, a36
    v_mul_f32_e64 v233, v233, v232
    v_accvgpr_write_b32 a36, v233
    v_accvgpr_read_b32 v234, a37
    v_mul_f32_e64 v234, v234, v232
    v_accvgpr_write_b32 a37, v234
    v_accvgpr_read_b32 v235, a38
    v_mul_f32_e64 v235, v235, v232
    v_accvgpr_write_b32 a38, v235
    v_accvgpr_read_b32 v236, a39
    v_mul_f32_e64 v236, v236, v232
    v_accvgpr_write_b32 a39, v236
    v_accvgpr_read_b32 v233, a40
    v_mul_f32_e64 v233, v233, v232
    v_accvgpr_write_b32 a40, v233
    v_accvgpr_read_b32 v234, a41
    v_mul_f32_e64 v234, v234, v232
    v_accvgpr_write_b32 a41, v234
    v_accvgpr_read_b32 v235, a42
    v_mul_f32_e64 v235, v235, v232
    v_accvgpr_write_b32 a42, v235
    v_accvgpr_read_b32 v236, a43
    v_mul_f32_e64 v236, v236, v232
    v_accvgpr_write_b32 a43, v236
    v_accvgpr_read_b32 v233, a44
    v_mul_f32_e64 v233, v233, v232
    v_accvgpr_write_b32 a44, v233
    v_accvgpr_read_b32 v234, a45
    v_mul_f32_e64 v234, v234, v232
    v_accvgpr_write_b32 a45, v234
    v_accvgpr_read_b32 v235, a46
    v_mul_f32_e64 v235, v235, v232
    v_accvgpr_write_b32 a46, v235
    v_accvgpr_read_b32 v236, a47
    v_mul_f32_e64 v236, v236, v232
    v_accvgpr_write_b32 a47, v236
    v_accvgpr_read_b32 v233, a48
    v_mul_f32_e64 v233, v233, v232
    v_accvgpr_write_b32 a48, v233
    v_accvgpr_read_b32 v234, a49
    v_mul_f32_e64 v234, v234, v232
    v_accvgpr_write_b32 a49, v234
    v_accvgpr_read_b32 v235, a50
    v_mul_f32_e64 v235, v235, v232
    v_accvgpr_write_b32 a50, v235
    v_accvgpr_read_b32 v236, a51
    v_mul_f32_e64 v236, v236, v232
    v_accvgpr_write_b32 a51, v236
    v_accvgpr_read_b32 v233, a52
    v_mul_f32_e64 v233, v233, v232
    v_accvgpr_write_b32 a52, v233
    v_accvgpr_read_b32 v234, a53
    v_mul_f32_e64 v234, v234, v232
    v_accvgpr_write_b32 a53, v234
    v_accvgpr_read_b32 v235, a54
    v_mul_f32_e64 v235, v235, v232
    v_accvgpr_write_b32 a54, v235
    v_accvgpr_read_b32 v236, a55
    v_mul_f32_e64 v236, v236, v232
    v_accvgpr_write_b32 a55, v236
    v_accvgpr_read_b32 v233, a56
    v_mul_f32_e64 v233, v233, v232
    v_accvgpr_write_b32 a56, v233
    v_accvgpr_read_b32 v234, a57
    v_mul_f32_e64 v234, v234, v232
    v_accvgpr_write_b32 a57, v234
    v_accvgpr_read_b32 v235, a58
    v_mul_f32_e64 v235, v235, v232
    v_accvgpr_write_b32 a58, v235
    v_accvgpr_read_b32 v236, a59
    v_mul_f32_e64 v236, v236, v232
    v_accvgpr_write_b32 a59, v236
    v_accvgpr_read_b32 v233, a60
    v_mul_f32_e64 v233, v233, v232
    v_accvgpr_write_b32 a60, v233
    v_accvgpr_read_b32 v234, a61
    v_mul_f32_e64 v234, v234, v232
    v_accvgpr_write_b32 a61, v234
    v_accvgpr_read_b32 v235, a62
    v_mul_f32_e64 v235, v235, v232
    v_accvgpr_write_b32 a62, v235
    v_accvgpr_read_b32 v236, a63
    v_mul_f32_e64 v236, v236, v232
    v_accvgpr_write_b32 a63, v236
    v_exp_f32 v128, v8
    v_exp_f32 v129, v9
    v_exp_f32 v130, v10
    v_exp_f32 v131, v11
    v_exp_f32 v132, v12
    v_exp_f32 v133, v13
    v_exp_f32 v134, v14
    v_exp_f32_e64 v135, v15
    s_nop 0
    v_cvt_pk_bf16_f32 v100, v128, v129
    v_cvt_pk_bf16_f32 v101, v130, v131
    v_cvt_pk_bf16_f32 v102, v132, v133
    v_cvt_pk_bf16_f32 v103, v134, v135
    v_max3_f32 v230, v16, v17, v18
    v_max3_f32 v230, v230, v19, v20
    v_max3_f32 v230, v230, v21, v22
    v_max_f32 v230, v230, v23
    v_mov_b32 v231, v230
    s_nop 1
    v_permlane16_swap_b32 v230, v231
    s_nop 0
    v_max_f32 v230, v230, v231
    v_mov_b32 v231, v230
    s_nop 1
    v_permlane32_swap_b32 v230, v231
    s_nop 0
    v_max_f32_e64 v230, v230, v231
    v_add_f32 v230, 0x41800000, v230
    v_max_f32 v230, 0, v230
    v_sub_f32 v232, 0, v230
    v_exp_f32 v232, v232
    v_sub_f32 v226, v226, v230
    v_sub_f32 v80, v80, v230
    v_sub_f32 v48, v48, v230
    v_sub_f32 v16, v16, v230
    v_sub_f32 v81, v81, v230
    v_sub_f32 v49, v49, v230
    v_sub_f32 v17, v17, v230
    v_sub_f32 v82, v82, v230
    v_sub_f32 v50, v50, v230
    v_sub_f32 v18, v18, v230
    v_sub_f32 v83, v83, v230
    v_sub_f32 v51, v51, v230
    v_sub_f32 v19, v19, v230
    v_sub_f32 v84, v84, v230
    v_sub_f32 v52, v52, v230
    v_sub_f32 v20, v20, v230
    v_sub_f32 v85, v85, v230
    v_sub_f32 v53, v53, v230
    v_sub_f32 v21, v21, v230
    v_sub_f32 v86, v86, v230
    v_sub_f32 v54, v54, v230
    v_sub_f32 v22, v22, v230
    v_sub_f32 v87, v87, v230
    v_sub_f32 v55, v55, v230
    v_sub_f32 v23, v23, v230
    v_mul_f32 v152, v152, v232
    v_mul_f32 v153, v153, v232
    v_mul_f32 v154, v154, v232
    v_mul_f32 v155, v155, v232
    v_accvgpr_read_b32 v233, a64
    v_mul_f32_e64 v233, v233, v232
    v_accvgpr_write_b32 a64, v233
    v_accvgpr_read_b32 v234, a65
    v_mul_f32_e64 v234, v234, v232
    v_accvgpr_write_b32 a65, v234
    v_accvgpr_read_b32 v235, a66
    v_mul_f32_e64 v235, v235, v232
    v_accvgpr_write_b32 a66, v235
    v_accvgpr_read_b32 v236, a67
    v_mul_f32_e64 v236, v236, v232
    v_accvgpr_write_b32 a67, v236
    v_accvgpr_read_b32 v233, a68
    v_mul_f32_e64 v233, v233, v232
    v_accvgpr_write_b32 a68, v233
    v_accvgpr_read_b32 v234, a69
    v_mul_f32_e64 v234, v234, v232
    v_accvgpr_write_b32 a69, v234
    v_accvgpr_read_b32 v235, a70
    v_mul_f32_e64 v235, v235, v232
    v_accvgpr_write_b32 a70, v235
    v_accvgpr_read_b32 v236, a71
    v_mul_f32_e64 v236, v236, v232
    v_accvgpr_write_b32 a71, v236
    v_accvgpr_read_b32 v233, a72
    v_mul_f32_e64 v233, v233, v232
    v_accvgpr_write_b32 a72, v233
    v_accvgpr_read_b32 v234, a73
    v_mul_f32_e64 v234, v234, v232
    v_accvgpr_write_b32 a73, v234
    v_accvgpr_read_b32 v235, a74
    v_mul_f32_e64 v235, v235, v232
    v_accvgpr_write_b32 a74, v235
    v_accvgpr_read_b32 v236, a75
    v_mul_f32_e64 v236, v236, v232
    v_accvgpr_write_b32 a75, v236
    v_accvgpr_read_b32 v233, a76
    v_mul_f32_e64 v233, v233, v232
    v_accvgpr_write_b32 a76, v233
    v_accvgpr_read_b32 v234, a77
    v_mul_f32_e64 v234, v234, v232
    v_accvgpr_write_b32 a77, v234
    v_accvgpr_read_b32 v235, a78
    v_mul_f32_e64 v235, v235, v232
    v_accvgpr_write_b32 a78, v235
    v_accvgpr_read_b32 v236, a79
    v_mul_f32_e64 v236, v236, v232
    v_accvgpr_write_b32 a79, v236
    v_accvgpr_read_b32 v233, a80
    v_mul_f32_e64 v233, v233, v232
    v_accvgpr_write_b32 a80, v233
    v_accvgpr_read_b32 v234, a81
    v_mul_f32_e64 v234, v234, v232
    v_accvgpr_write_b32 a81, v234
    v_accvgpr_read_b32 v235, a82
    v_mul_f32_e64 v235, v235, v232
    v_accvgpr_write_b32 a82, v235
    v_accvgpr_read_b32 v236, a83
    v_mul_f32_e64 v236, v236, v232
    v_accvgpr_write_b32 a83, v236
    v_accvgpr_read_b32 v233, a84
    v_mul_f32_e64 v233, v233, v232
    v_accvgpr_write_b32 a84, v233
    v_accvgpr_read_b32 v234, a85
    v_mul_f32_e64 v234, v234, v232
    v_accvgpr_write_b32 a85, v234
    v_accvgpr_read_b32 v235, a86
    v_mul_f32_e64 v235, v235, v232
    v_accvgpr_write_b32 a86, v235
    v_accvgpr_read_b32 v236, a87
    v_mul_f32_e64 v236, v236, v232
    v_accvgpr_write_b32 a87, v236
    v_accvgpr_read_b32 v233, a88
    v_mul_f32_e64 v233, v233, v232
    v_accvgpr_write_b32 a88, v233
    v_accvgpr_read_b32 v234, a89
    v_mul_f32_e64 v234, v234, v232
    v_accvgpr_write_b32 a89, v234
    v_accvgpr_read_b32 v235, a90
    v_mul_f32_e64 v235, v235, v232
    v_accvgpr_write_b32 a90, v235
    v_accvgpr_read_b32 v236, a91
    v_mul_f32_e64 v236, v236, v232
    v_accvgpr_write_b32 a91, v236
    v_accvgpr_read_b32 v233, a92
    v_mul_f32_e64 v233, v233, v232
    v_accvgpr_write_b32 a92, v233
    v_accvgpr_read_b32 v234, a93
    v_mul_f32_e64 v234, v234, v232
    v_accvgpr_write_b32 a93, v234
    v_accvgpr_read_b32 v235, a94
    v_mul_f32_e64 v235, v235, v232
    v_accvgpr_write_b32 a94, v235
    v_accvgpr_read_b32 v236, a95
    v_mul_f32_e64 v236, v236, v232
    v_accvgpr_write_b32 a95, v236
    v_exp_f32 v128, v16
    v_exp_f32 v129, v17
    v_exp_f32 v130, v18
    v_exp_f32 v131, v19
    v_exp_f32 v132, v20
    v_exp_f32 v133, v21
    v_exp_f32 v134, v22
    v_exp_f32_e64 v135, v23
    s_nop 0
    v_cvt_pk_bf16_f32 v104, v128, v129
    v_cvt_pk_bf16_f32 v105, v130, v131
    v_cvt_pk_bf16_f32 v106, v132, v133
    v_cvt_pk_bf16_f32 v107, v134, v135
    v_max3_f32 v230, v24, v25, v26
    v_max3_f32 v230, v230, v27, v28
    v_max3_f32 v230, v230, v29, v30
    v_max_f32 v230, v230, v31
    v_mov_b32 v231, v230
    s_nop 1
    v_permlane16_swap_b32 v230, v231
    s_nop 0
    v_max_f32 v230, v230, v231
    v_mov_b32 v231, v230
    s_nop 1
    v_permlane32_swap_b32 v230, v231
    s_nop 0
    v_max_f32_e64 v230, v230, v231
    v_add_f32 v230, 0x41800000, v230
    v_max_f32 v230, 0, v230
    v_sub_f32 v232, 0, v230
    v_exp_f32 v232, v232
    v_sub_f32 v227, v227, v230
    v_sub_f32 v88, v88, v230
    v_sub_f32 v56, v56, v230
    v_sub_f32 v24, v24, v230
    v_sub_f32 v89, v89, v230
    v_sub_f32 v57, v57, v230
    v_sub_f32 v25, v25, v230
    v_sub_f32 v90, v90, v230
    v_sub_f32 v58, v58, v230
    v_sub_f32 v26, v26, v230
    v_sub_f32 v91, v91, v230
    v_sub_f32 v59, v59, v230
    v_sub_f32 v27, v27, v230
    v_sub_f32 v92, v92, v230
    v_sub_f32 v60, v60, v230
    v_sub_f32 v28, v28, v230
    v_sub_f32 v93, v93, v230
    v_sub_f32 v61, v61, v230
    v_sub_f32 v29, v29, v230
    v_sub_f32 v94, v94, v230
    v_sub_f32 v62, v62, v230
    v_sub_f32 v30, v30, v230
    v_sub_f32 v95, v95, v230
    v_sub_f32 v63, v63, v230
    v_sub_f32 v31, v31, v230
    v_mul_f32 v156, v156, v232
    v_mul_f32 v157, v157, v232
    v_mul_f32 v158, v158, v232
    v_mul_f32 v159, v159, v232
    v_accvgpr_read_b32 v233, a96
    v_mul_f32_e64 v233, v233, v232
    v_accvgpr_write_b32 a96, v233
    v_accvgpr_read_b32 v234, a97
    v_mul_f32_e64 v234, v234, v232
    v_accvgpr_write_b32 a97, v234
    v_accvgpr_read_b32 v235, a98
    v_mul_f32_e64 v235, v235, v232
    v_accvgpr_write_b32 a98, v235
    v_accvgpr_read_b32 v236, a99
    v_mul_f32_e64 v236, v236, v232
    v_accvgpr_write_b32 a99, v236
    v_accvgpr_read_b32 v233, a100
    v_mul_f32_e64 v233, v233, v232
    v_accvgpr_write_b32 a100, v233
    v_accvgpr_read_b32 v234, a101
    v_mul_f32_e64 v234, v234, v232
    v_accvgpr_write_b32 a101, v234
    v_accvgpr_read_b32 v235, a102
    v_mul_f32_e64 v235, v235, v232
    v_accvgpr_write_b32 a102, v235
    v_accvgpr_read_b32 v236, a103
    v_mul_f32_e64 v236, v236, v232
    v_accvgpr_write_b32 a103, v236
    v_accvgpr_read_b32 v233, a104
    v_mul_f32_e64 v233, v233, v232
    v_accvgpr_write_b32 a104, v233
    v_accvgpr_read_b32 v234, a105
    v_mul_f32_e64 v234, v234, v232
    v_accvgpr_write_b32 a105, v234
    v_accvgpr_read_b32 v235, a106
    v_mul_f32_e64 v235, v235, v232
    v_accvgpr_write_b32 a106, v235
    v_accvgpr_read_b32 v236, a107
    v_mul_f32_e64 v236, v236, v232
    v_accvgpr_write_b32 a107, v236
    v_accvgpr_read_b32 v233, a108
    v_mul_f32_e64 v233, v233, v232
    v_accvgpr_write_b32 a108, v233
    v_accvgpr_read_b32 v234, a109
    v_mul_f32_e64 v234, v234, v232
    v_accvgpr_write_b32 a109, v234
    v_accvgpr_read_b32 v235, a110
    v_mul_f32_e64 v235, v235, v232
    v_accvgpr_write_b32 a110, v235
    v_accvgpr_read_b32 v236, a111
    v_mul_f32_e64 v236, v236, v232
    v_accvgpr_write_b32 a111, v236
    v_accvgpr_read_b32 v233, a112
    v_mul_f32_e64 v233, v233, v232
    v_accvgpr_write_b32 a112, v233
    v_accvgpr_read_b32 v234, a113
    v_mul_f32_e64 v234, v234, v232
    v_accvgpr_write_b32 a113, v234
    v_accvgpr_read_b32 v235, a114
    v_mul_f32_e64 v235, v235, v232
    v_accvgpr_write_b32 a114, v235
    v_accvgpr_read_b32 v236, a115
    v_mul_f32_e64 v236, v236, v232
    v_accvgpr_write_b32 a115, v236
    v_accvgpr_read_b32 v233, a116
    v_mul_f32_e64 v233, v233, v232
    v_accvgpr_write_b32 a116, v233
    v_accvgpr_read_b32 v234, a117
    v_mul_f32_e64 v234, v234, v232
    v_accvgpr_write_b32 a117, v234
    v_accvgpr_read_b32 v235, a118
    v_mul_f32_e64 v235, v235, v232
    v_accvgpr_write_b32 a118, v235
    v_accvgpr_read_b32 v236, a119
    v_mul_f32_e64 v236, v236, v232
    v_accvgpr_write_b32 a119, v236
    v_accvgpr_read_b32 v233, a120
    v_mul_f32_e64 v233, v233, v232
    v_accvgpr_write_b32 a120, v233
    v_accvgpr_read_b32 v234, a121
    v_mul_f32_e64 v234, v234, v232
    v_accvgpr_write_b32 a121, v234
    v_accvgpr_read_b32 v235, a122
    v_mul_f32_e64 v235, v235, v232
    v_accvgpr_write_b32 a122, v235
    v_accvgpr_read_b32 v236, a123
    v_mul_f32_e64 v236, v236, v232
    v_accvgpr_write_b32 a123, v236
    v_accvgpr_read_b32 v233, a124
    v_mul_f32_e64 v233, v233, v232
    v_accvgpr_write_b32 a124, v233
    v_accvgpr_read_b32 v234, a125
    v_mul_f32_e64 v234, v234, v232
    v_accvgpr_write_b32 a125, v234
    v_accvgpr_read_b32 v235, a126
    v_mul_f32_e64 v235, v235, v232
    v_accvgpr_write_b32 a126, v235
    v_accvgpr_read_b32 v236, a127
    v_mul_f32_e64 v236, v236, v232
    v_accvgpr_write_b32 a127, v236
    v_exp_f32 v128, v24
    v_exp_f32 v129, v25
    v_exp_f32 v130, v26
    v_exp_f32 v131, v27
    v_exp_f32 v132, v28
    v_exp_f32 v133, v29
    v_exp_f32 v134, v30
    v_exp_f32_e64 v135, v31
    s_nop 0
    v_cvt_pk_bf16_f32 v108, v128, v129
    v_cvt_pk_bf16_f32 v109, v130, v131
    v_cvt_pk_bf16_f32 v110, v132, v133
    v_cvt_pk_bf16_f32 v111, v134, v135
    s_nop 1
    s_branch kf_rr9
kf_rare14:
    s_nop 15
    v_max3_f32 v230, v32, v33, v34
    v_max3_f32 v230, v230, v35, v36
    v_max3_f32 v230, v230, v37, v38
    v_max_f32 v230, v230, v39
    v_mov_b32 v231, v230
    s_nop 1
    v_permlane16_swap_b32 v230, v231
    s_nop 0
    v_max_f32 v230, v230, v231
    v_mov_b32 v231, v230
    s_nop 1
    v_permlane32_swap_b32 v230, v231
    s_nop 0
    v_max_f32 v230, v230, v231
    v_add_f32 v230, 0x41800000, v230
    v_max_f32 v230, 0, v230
    v_sub_f32 v232, 0, v230
    v_exp_f32 v232, v232
    v_sub_f32 v224, v224, v230
    v_sub_f32 v64, v64, v230
    v_sub_f32 v0, v0, v230
    v_sub_f32 v32, v32, v230
    v_sub_f32 v65, v65, v230
    v_sub_f32 v1, v1, v230
    v_sub_f32 v33, v33, v230
    v_sub_f32 v66, v66, v230
    v_sub_f32 v2, v2, v230
    v_sub_f32 v34, v34, v230
    v_sub_f32 v67, v67, v230
    v_sub_f32 v3, v3, v230
    v_sub_f32 v35, v35, v230
    v_sub_f32 v68, v68, v230
    v_sub_f32 v4, v4, v230
    v_sub_f32 v36, v36, v230
    v_sub_f32 v69, v69, v230
    v_sub_f32 v5, v5, v230
    v_sub_f32 v37, v37, v230
    v_sub_f32 v70, v70, v230
    v_sub_f32 v6, v6, v230
    v_sub_f32 v38, v38, v230
    v_sub_f32 v71, v71, v230
    v_sub_f32 v7, v7, v230
    v_sub_f32 v39, v39, v230
    v_mul_f32 v144, v144, v232
    v_mul_f32 v145, v145, v232
    v_mul_f32 v146, v146, v232
    v_mul_f32 v147, v147, v232
    v_accvgpr_read_b32 v233, a0
    v_mul_f32_e64 v233, v233, v232
    v_accvgpr_write_b32 a0, v233
    v_accvgpr_read_b32 v234, a1
    v_mul_f32_e64 v234, v234, v232
    v_accvgpr_write_b32 a1, v234
    v_accvgpr_read_b32 v235, a2
    v_mul_f32_e64 v235, v235, v232
    v_accvgpr_write_b32 a2, v235
    v_accvgpr_read_b32 v236, a3
    v_mul_f32_e64 v236, v236, v232
    v_accvgpr_write_b32 a3, v236
    v_accvgpr_read_b32 v233, a4
    v_mul_f32_e64 v233, v233, v232
    v_accvgpr_write_b32 a4, v233
    v_accvgpr_read_b32 v234, a5
    v_mul_f32_e64 v234, v234, v232
    v_accvgpr_write_b32 a5, v234
    v_accvgpr_read_b32 v235, a6
    v_mul_f32_e64 v235, v235, v232
    v_accvgpr_write_b32 a6, v235
    v_accvgpr_read_b32 v236, a7
    v_mul_f32_e64 v236, v236, v232
    v_accvgpr_write_b32 a7, v236
    v_accvgpr_read_b32 v233, a8
    v_mul_f32_e64 v233, v233, v232
    v_accvgpr_write_b32 a8, v233
    v_accvgpr_read_b32 v234, a9
    v_mul_f32_e64 v234, v234, v232
    v_accvgpr_write_b32 a9, v234
    v_accvgpr_read_b32 v235, a10
    v_mul_f32_e64 v235, v235, v232
    v_accvgpr_write_b32 a10, v235
    v_accvgpr_read_b32 v236, a11
    v_mul_f32_e64 v236, v236, v232
    v_accvgpr_write_b32 a11, v236
    v_accvgpr_read_b32 v233, a12
    v_mul_f32_e64 v233, v233, v232
    v_accvgpr_write_b32 a12, v233
    v_accvgpr_read_b32 v234, a13
    v_mul_f32_e64 v234, v234, v232
    v_accvgpr_write_b32 a13, v234
    v_accvgpr_read_b32 v235, a14
    v_mul_f32_e64 v235, v235, v232
    v_accvgpr_write_b32 a14, v235
    v_accvgpr_read_b32 v236, a15
    v_mul_f32_e64 v236, v236, v232
    v_accvgpr_write_b32 a15, v236
    v_accvgpr_read_b32 v233, a16
    v_mul_f32_e64 v233, v233, v232
    v_accvgpr_write_b32 a16, v233
    v_accvgpr_read_b32 v234, a17
    v_mul_f32_e64 v234, v234, v232
    v_accvgpr_write_b32 a17, v234
    v_accvgpr_read_b32 v235, a18
    v_mul_f32_e64 v235, v235, v232
    v_accvgpr_write_b32 a18, v235
    v_accvgpr_read_b32 v236, a19
    v_mul_f32_e64 v236, v236, v232
    v_accvgpr_write_b32 a19, v236
    v_accvgpr_read_b32 v233, a20
    v_mul_f32_e64 v233, v233, v232
    v_accvgpr_write_b32 a20, v233
    v_accvgpr_read_b32 v234, a21
    v_mul_f32_e64 v234, v234, v232
    v_accvgpr_write_b32 a21, v234
    v_accvgpr_read_b32 v235, a22
    v_mul_f32_e64 v235, v235, v232
    v_accvgpr_write_b32 a22, v235
    v_accvgpr_read_b32 v236, a23
    v_mul_f32_e64 v236, v236, v232
    v_accvgpr_write_b32 a23, v236
    v_accvgpr_read_b32 v233, a24
    v_mul_f32_e64 v233, v233, v232
    v_accvgpr_write_b32 a24, v233
    v_accvgpr_read_b32 v234, a25
    v_mul_f32_e64 v234, v234, v232
    v_accvgpr_write_b32 a25, v234
    v_accvgpr_read_b32 v235, a26
    v_mul_f32_e64 v235, v235, v232
    v_accvgpr_write_b32 a26, v235
    v_accvgpr_read_b32 v236, a27
    v_mul_f32_e64 v236, v236, v232
    v_accvgpr_write_b32 a27, v236
    v_accvgpr_read_b32 v233, a28
    v_mul_f32_e64 v233, v233, v232
    v_accvgpr_write_b32 a28, v233
    v_accvgpr_read_b32 v234, a29
    v_mul_f32_e64 v234, v234, v232
    v_accvgpr_write_b32 a29, v234
    v_accvgpr_read_b32 v235, a30
    v_mul_f32_e64 v235, v235, v232
    v_accvgpr_write_b32 a30, v235
    v_accvgpr_read_b32 v236, a31
    v_mul_f32_e64 v236, v236, v232
    v_accvgpr_write_b32 a31, v236
    v_exp_f32 v128, v32
    v_exp_f32 v129, v33
    v_exp_f32 v130, v34
    v_exp_f32 v131, v35
    v_exp_f32 v132, v36
    v_exp_f32 v133, v37
    v_exp_f32 v134, v38
    v_exp_f32_e64 v135, v39
    s_nop 0
    v_cvt_pk_bf16_f32 v112, v128, v129
    v_cvt_pk_bf16_f32 v113, v130, v131
    v_cvt_pk_bf16_f32 v114, v132, v133
    v_cvt_pk_bf16_f32 v115, v134, v135
    v_max3_f32 v230, v40, v41, v42
    v_max3_f32 v230, v230, v43, v44
    v_max3_f32 v230, v230, v45, v46
    v_max_f32 v230, v230, v47
    v_mov_b32 v231, v230
    s_nop 1
    v_permlane16_swap_b32 v230, v231
    s_nop 0
    v_max_f32 v230, v230, v231
    v_mov_b32 v231, v230
    s_nop 1
    v_permlane32_swap_b32 v230, v231
    s_nop 0
    v_max_f32_e64 v230, v230, v231
    v_add_f32 v230, 0x41800000, v230
    v_max_f32 v230, 0, v230
    v_sub_f32 v232, 0, v230
    v_exp_f32 v232, v232
    v_sub_f32 v225, v225, v230
    v_sub_f32 v72, v72, v230
    v_sub_f32 v8, v8, v230
    v_sub_f32 v40, v40, v230
    v_sub_f32 v73, v73, v230
    v_sub_f32 v9, v9, v230
    v_sub_f32 v41, v41, v230
    v_sub_f32 v74, v74, v230
    v_sub_f32 v10, v10, v230
    v_sub_f32 v42, v42, v230
    v_sub_f32 v75, v75, v230
    v_sub_f32 v11, v11, v230
    v_sub_f32 v43, v43, v230
    v_sub_f32 v76, v76, v230
    v_sub_f32 v12, v12, v230
    v_sub_f32 v44, v44, v230
    v_sub_f32 v77, v77, v230
    v_sub_f32 v13, v13, v230
    v_sub_f32 v45, v45, v230
    v_sub_f32 v78, v78, v230
    v_sub_f32 v14, v14, v230
    v_sub_f32 v46, v46, v230
    v_sub_f32 v79, v79, v230
    v_sub_f32 v15, v15, v230
    v_sub_f32 v47, v47, v230
    v_mul_f32 v148, v148, v232
    v_mul_f32 v149, v149, v232
    v_mul_f32 v150, v150, v232
    v_mul_f32 v151, v151, v232
    v_accvgpr_read_b32 v233, a32
    v_mul_f32_e64 v233, v233, v232
    v_accvgpr_write_b32 a32, v233
    v_accvgpr_read_b32 v234, a33
    v_mul_f32_e64 v234, v234, v232
    v_accvgpr_write_b32 a33, v234
    v_accvgpr_read_b32 v235, a34
    v_mul_f32_e64 v235, v235, v232
    v_accvgpr_write_b32 a34, v235
    v_accvgpr_read_b32 v236, a35
    v_mul_f32_e64 v236, v236, v232
    v_accvgpr_write_b32 a35, v236
    v_accvgpr_read_b32 v233, a36
    v_mul_f32_e64 v233, v233, v232
    v_accvgpr_write_b32 a36, v233
    v_accvgpr_read_b32 v234, a37
    v_mul_f32_e64 v234, v234, v232
    v_accvgpr_write_b32 a37, v234
    v_accvgpr_read_b32 v235, a38
    v_mul_f32_e64 v235, v235, v232
    v_accvgpr_write_b32 a38, v235
    v_accvgpr_read_b32 v236, a39
    v_mul_f32_e64 v236, v236, v232
    v_accvgpr_write_b32 a39, v236
    v_accvgpr_read_b32 v233, a40
    v_mul_f32_e64 v233, v233, v232
    v_accvgpr_write_b32 a40, v233
    v_accvgpr_read_b32 v234, a41
    v_mul_f32_e64 v234, v234, v232
    v_accvgpr_write_b32 a41, v234
    v_accvgpr_read_b32 v235, a42
    v_mul_f32_e64 v235, v235, v232
    v_accvgpr_write_b32 a42, v235
    v_accvgpr_read_b32 v236, a43
    v_mul_f32_e64 v236, v236, v232
    v_accvgpr_write_b32 a43, v236
    v_accvgpr_read_b32 v233, a44
    v_mul_f32_e64 v233, v233, v232
    v_accvgpr_write_b32 a44, v233
    v_accvgpr_read_b32 v234, a45
    v_mul_f32_e64 v234, v234, v232
    v_accvgpr_write_b32 a45, v234
    v_accvgpr_read_b32 v235, a46
    v_mul_f32_e64 v235, v235, v232
    v_accvgpr_write_b32 a46, v235
    v_accvgpr_read_b32 v236, a47
    v_mul_f32_e64 v236, v236, v232
    v_accvgpr_write_b32 a47, v236
    v_accvgpr_read_b32 v233, a48
    v_mul_f32_e64 v233, v233, v232
    v_accvgpr_write_b32 a48, v233
    v_accvgpr_read_b32 v234, a49
    v_mul_f32_e64 v234, v234, v232
    v_accvgpr_write_b32 a49, v234
    v_accvgpr_read_b32 v235, a50
    v_mul_f32_e64 v235, v235, v232
    v_accvgpr_write_b32 a50, v235
    v_accvgpr_read_b32 v236, a51
    v_mul_f32_e64 v236, v236, v232
    v_accvgpr_write_b32 a51, v236
    v_accvgpr_read_b32 v233, a52
    v_mul_f32_e64 v233, v233, v232
    v_accvgpr_write_b32 a52, v233
    v_accvgpr_read_b32 v234, a53
    v_mul_f32_e64 v234, v234, v232
    v_accvgpr_write_b32 a53, v234
    v_accvgpr_read_b32 v235, a54
    v_mul_f32_e64 v235, v235, v232
    v_accvgpr_write_b32 a54, v235
    v_accvgpr_read_b32 v236, a55
    v_mul_f32_e64 v236, v236, v232
    v_accvgpr_write_b32 a55, v236
    v_accvgpr_read_b32 v233, a56
    v_mul_f32_e64 v233, v233, v232
    v_accvgpr_write_b32 a56, v233
    v_accvgpr_read_b32 v234, a57
    v_mul_f32_e64 v234, v234, v232
    v_accvgpr_write_b32 a57, v234
    v_accvgpr_read_b32 v235, a58
    v_mul_f32_e64 v235, v235, v232
    v_accvgpr_write_b32 a58, v235
    v_accvgpr_read_b32 v236, a59
    v_mul_f32_e64 v236, v236, v232
    v_accvgpr_write_b32 a59, v236
    v_accvgpr_read_b32 v233, a60
    v_mul_f32_e64 v233, v233, v232
    v_accvgpr_write_b32 a60, v233
    v_accvgpr_read_b32 v234, a61
    v_mul_f32_e64 v234, v234, v232
    v_accvgpr_write_b32 a61, v234
    v_accvgpr_read_b32 v235, a62
    v_mul_f32_e64 v235, v235, v232
    v_accvgpr_write_b32 a62, v235
    v_accvgpr_read_b32 v236, a63
    v_mul_f32_e64 v236, v236, v232
    v_accvgpr_write_b32 a63, v236
    v_exp_f32 v128, v40
    v_exp_f32 v129, v41
    v_exp_f32 v130, v42
    v_exp_f32 v131, v43
    v_exp_f32 v132, v44
    v_exp_f32 v133, v45
    v_exp_f32 v134, v46
    v_exp_f32_e64 v135, v47
    s_nop 0
    v_cvt_pk_bf16_f32 v116, v128, v129
    v_cvt_pk_bf16_f32 v117, v130, v131
    v_cvt_pk_bf16_f32 v118, v132, v133
    v_cvt_pk_bf16_f32 v119, v134, v135
    v_max3_f32 v230, v48, v49, v50
    v_max3_f32 v230, v230, v51, v52
    v_max3_f32 v230, v230, v53, v54
    v_max_f32 v230, v230, v55
    v_mov_b32 v231, v230
    s_nop 1
    v_permlane16_swap_b32 v230, v231
    s_nop 0
    v_max_f32 v230, v230, v231
    v_mov_b32 v231, v230
    s_nop 1
    v_permlane32_swap_b32 v230, v231
    s_nop 0
    v_max_f32_e64 v230, v230, v231
    v_add_f32 v230, 0x41800000, v230
    v_max_f32 v230, 0, v230
    v_sub_f32 v232, 0, v230
    v_exp_f32 v232, v232
    v_sub_f32 v226, v226, v230
    v_sub_f32 v80, v80, v230
    v_sub_f32 v16, v16, v230
    v_sub_f32 v48, v48, v230
    v_sub_f32 v81, v81, v230
    v_sub_f32 v17, v17, v230
    v_sub_f32 v49, v49, v230
    v_sub_f32 v82, v82, v230
    v_sub_f32 v18, v18, v230
    v_sub_f32 v50, v50, v230
    v_sub_f32 v83, v83, v230
    v_sub_f32 v19, v19, v230
    v_sub_f32 v51, v51, v230
    v_sub_f32 v84, v84, v230
    v_sub_f32 v20, v20, v230
    v_sub_f32 v52, v52, v230
    v_sub_f32 v85, v85, v230
    v_sub_f32 v21, v21, v230
    v_sub_f32 v53, v53, v230
    v_sub_f32 v86, v86, v230
    v_sub_f32 v22, v22, v230
    v_sub_f32 v54, v54, v230
    v_sub_f32 v87, v87, v230
    v_sub_f32 v23, v23, v230
    v_sub_f32 v55, v55, v230
    v_mul_f32 v152, v152, v232
    v_mul_f32 v153, v153, v232
    v_mul_f32 v154, v154, v232
    v_mul_f32 v155, v155, v232
    v_accvgpr_read_b32 v233, a64
    v_mul_f32_e64 v233, v233, v232
    v_accvgpr_write_b32 a64, v233
    v_accvgpr_read_b32 v234, a65
    v_mul_f32_e64 v234, v234, v232
    v_accvgpr_write_b32 a65, v234
    v_accvgpr_read_b32 v235, a66
    v_mul_f32_e64 v235, v235, v232
    v_accvgpr_write_b32 a66, v235
    v_accvgpr_read_b32 v236, a67
    v_mul_f32_e64 v236, v236, v232
    v_accvgpr_write_b32 a67, v236
    v_accvgpr_read_b32 v233, a68
    v_mul_f32_e64 v233, v233, v232
    v_accvgpr_write_b32 a68, v233
    v_accvgpr_read_b32 v234, a69
    v_mul_f32_e64 v234, v234, v232
    v_accvgpr_write_b32 a69, v234
    v_accvgpr_read_b32 v235, a70
    v_mul_f32_e64 v235, v235, v232
    v_accvgpr_write_b32 a70, v235
    v_accvgpr_read_b32 v236, a71
    v_mul_f32_e64 v236, v236, v232
    v_accvgpr_write_b32 a71, v236
    v_accvgpr_read_b32 v233, a72
    v_mul_f32_e64 v233, v233, v232
    v_accvgpr_write_b32 a72, v233
    v_accvgpr_read_b32 v234, a73
    v_mul_f32_e64 v234, v234, v232
    v_accvgpr_write_b32 a73, v234
    v_accvgpr_read_b32 v235, a74
    v_mul_f32_e64 v235, v235, v232
    v_accvgpr_write_b32 a74, v235
    v_accvgpr_read_b32 v236, a75
    v_mul_f32_e64 v236, v236, v232
    v_accvgpr_write_b32 a75, v236
    v_accvgpr_read_b32 v233, a76
    v_mul_f32_e64 v233, v233, v232
    v_accvgpr_write_b32 a76, v233
    v_accvgpr_read_b32 v234, a77
    v_mul_f32_e64 v234, v234, v232
    v_accvgpr_write_b32 a77, v234
    v_accvgpr_read_b32 v235, a78
    v_mul_f32_e64 v235, v235, v232
    v_accvgpr_write_b32 a78, v235
    v_accvgpr_read_b32 v236, a79
    v_mul_f32_e64 v236, v236, v232
    v_accvgpr_write_b32 a79, v236
    v_accvgpr_read_b32 v233, a80
    v_mul_f32_e64 v233, v233, v232
    v_accvgpr_write_b32 a80, v233
    v_accvgpr_read_b32 v234, a81
    v_mul_f32_e64 v234, v234, v232
    v_accvgpr_write_b32 a81, v234
    v_accvgpr_read_b32 v235, a82
    v_mul_f32_e64 v235, v235, v232
    v_accvgpr_write_b32 a82, v235
    v_accvgpr_read_b32 v236, a83
    v_mul_f32_e64 v236, v236, v232
    v_accvgpr_write_b32 a83, v236
    v_accvgpr_read_b32 v233, a84
    v_mul_f32_e64 v233, v233, v232
    v_accvgpr_write_b32 a84, v233
    v_accvgpr_read_b32 v234, a85
    v_mul_f32_e64 v234, v234, v232
    v_accvgpr_write_b32 a85, v234
    v_accvgpr_read_b32 v235, a86
    v_mul_f32_e64 v235, v235, v232
    v_accvgpr_write_b32 a86, v235
    v_accvgpr_read_b32 v236, a87
    v_mul_f32_e64 v236, v236, v232
    v_accvgpr_write_b32 a87, v236
    v_accvgpr_read_b32 v233, a88
    v_mul_f32_e64 v233, v233, v232
    v_accvgpr_write_b32 a88, v233
    v_accvgpr_read_b32 v234, a89
    v_mul_f32_e64 v234, v234, v232
    v_accvgpr_write_b32 a89, v234
    v_accvgpr_read_b32 v235, a90
    v_mul_f32_e64 v235, v235, v232
    v_accvgpr_write_b32 a90, v235
    v_accvgpr_read_b32 v236, a91
    v_mul_f32_e64 v236, v236, v232
    v_accvgpr_write_b32 a91, v236
    v_accvgpr_read_b32 v233, a92
    v_mul_f32_e64 v233, v233, v232
    v_accvgpr_write_b32 a92, v233
    v_accvgpr_read_b32 v234, a93
    v_mul_f32_e64 v234, v234, v232
    v_accvgpr_write_b32 a93, v234
    v_accvgpr_read_b32 v235, a94
    v_mul_f32_e64 v235, v235, v232
    v_accvgpr_write_b32 a94, v235
    v_accvgpr_read_b32 v236, a95
    v_mul_f32_e64 v236, v236, v232
    v_accvgpr_write_b32 a95, v236
    v_exp_f32 v128, v48
    v_exp_f32 v129, v49
    v_exp_f32 v130, v50
    v_exp_f32 v131, v51
    v_exp_f32 v132, v52
    v_exp_f32 v133, v53
    v_exp_f32 v134, v54
    v_exp_f32_e64 v135, v55
    s_nop 0
    v_cvt_pk_bf16_f32 v120, v128, v129
    v_cvt_pk_bf16_f32 v121, v130, v131
    v_cvt_pk_bf16_f32 v122, v132, v133
    v_cvt_pk_bf16_f32 v123, v134, v135
    v_max3_f32 v230, v56, v57, v58
    v_max3_f32 v230, v230, v59, v60
    v_max3_f32 v230, v230, v61, v62
    v_max_f32 v230, v230, v63
    v_mov_b32 v231, v230
    s_nop 1
    v_permlane16_swap_b32 v230, v231
    s_nop 0
    v_max_f32 v230, v230, v231
    v_mov_b32 v231, v230
    s_nop 1
    v_permlane32_swap_b32 v230, v231
    s_nop 0
    v_max_f32_e64 v230, v230, v231
    v_add_f32 v230, 0x41800000, v230
    v_max_f32 v230, 0, v230
    v_sub_f32 v232, 0, v230
    v_exp_f32 v232, v232
    v_sub_f32 v227, v227, v230
    v_sub_f32 v88, v88, v230
    v_sub_f32 v24, v24, v230
    v_sub_f32 v56, v56, v230
    v_sub_f32 v89, v89, v230
    v_sub_f32 v25, v25, v230
    v_sub_f32 v57, v57, v230
    v_sub_f32 v90, v90, v230
    v_sub_f32 v26, v26, v230
    v_sub_f32 v58, v58, v230
    v_sub_f32 v91, v91, v230
    v_sub_f32 v27, v27, v230
    v_sub_f32 v59, v59, v230
    v_sub_f32 v92, v92, v230
    v_sub_f32 v28, v28, v230
    v_sub_f32 v60, v60, v230
    v_sub_f32 v93, v93, v230
    v_sub_f32 v29, v29, v230
    v_sub_f32 v61, v61, v230
    v_sub_f32 v94, v94, v230
    v_sub_f32 v30, v30, v230
    v_sub_f32 v62, v62, v230
    v_sub_f32 v95, v95, v230
    v_sub_f32 v31, v31, v230
    v_sub_f32 v63, v63, v230
    v_mul_f32 v156, v156, v232
    v_mul_f32 v157, v157, v232
    v_mul_f32 v158, v158, v232
    v_mul_f32 v159, v159, v232
    v_accvgpr_read_b32 v233, a96
    v_mul_f32_e64 v233, v233, v232
    v_accvgpr_write_b32 a96, v233
    v_accvgpr_read_b32 v234, a97
    v_mul_f32_e64 v234, v234, v232
    v_accvgpr_write_b32 a97, v234
    v_accvgpr_read_b32 v235, a98
    v_mul_f32_e64 v235, v235, v232
    v_accvgpr_write_b32 a98, v235
    v_accvgpr_read_b32 v236, a99
    v_mul_f32_e64 v236, v236, v232
    v_accvgpr_write_b32 a99, v236
    v_accvgpr_read_b32 v233, a100
    v_mul_f32_e64 v233, v233, v232
    v_accvgpr_write_b32 a100, v233
    v_accvgpr_read_b32 v234, a101
    v_mul_f32_e64 v234, v234, v232
    v_accvgpr_write_b32 a101, v234
    v_accvgpr_read_b32 v235, a102
    v_mul_f32_e64 v235, v235, v232
    v_accvgpr_write_b32 a102, v235
    v_accvgpr_read_b32 v236, a103
    v_mul_f32_e64 v236, v236, v232
    v_accvgpr_write_b32 a103, v236
    v_accvgpr_read_b32 v233, a104
    v_mul_f32_e64 v233, v233, v232
    v_accvgpr_write_b32 a104, v233
    v_accvgpr_read_b32 v234, a105
    v_mul_f32_e64 v234, v234, v232
    v_accvgpr_write_b32 a105, v234
    v_accvgpr_read_b32 v235, a106
    v_mul_f32_e64 v235, v235, v232
    v_accvgpr_write_b32 a106, v235
    v_accvgpr_read_b32 v236, a107
    v_mul_f32_e64 v236, v236, v232
    v_accvgpr_write_b32 a107, v236
    v_accvgpr_read_b32 v233, a108
    v_mul_f32_e64 v233, v233, v232
    v_accvgpr_write_b32 a108, v233
    v_accvgpr_read_b32 v234, a109
    v_mul_f32_e64 v234, v234, v232
    v_accvgpr_write_b32 a109, v234
    v_accvgpr_read_b32 v235, a110
    v_mul_f32_e64 v235, v235, v232
    v_accvgpr_write_b32 a110, v235
    v_accvgpr_read_b32 v236, a111
    v_mul_f32_e64 v236, v236, v232
    v_accvgpr_write_b32 a111, v236
    v_accvgpr_read_b32 v233, a112
    v_mul_f32_e64 v233, v233, v232
    v_accvgpr_write_b32 a112, v233
    v_accvgpr_read_b32 v234, a113
    v_mul_f32_e64 v234, v234, v232
    v_accvgpr_write_b32 a113, v234
    v_accvgpr_read_b32 v235, a114
    v_mul_f32_e64 v235, v235, v232
    v_accvgpr_write_b32 a114, v235
    v_accvgpr_read_b32 v236, a115
    v_mul_f32_e64 v236, v236, v232
    v_accvgpr_write_b32 a115, v236
    v_accvgpr_read_b32 v233, a116
    v_mul_f32_e64 v233, v233, v232
    v_accvgpr_write_b32 a116, v233
    v_accvgpr_read_b32 v234, a117
    v_mul_f32_e64 v234, v234, v232
    v_accvgpr_write_b32 a117, v234
    v_accvgpr_read_b32 v235, a118
    v_mul_f32_e64 v235, v235, v232
    v_accvgpr_write_b32 a118, v235
    v_accvgpr_read_b32 v236, a119
    v_mul_f32_e64 v236, v236, v232
    v_accvgpr_write_b32 a119, v236
    v_accvgpr_read_b32 v233, a120
    v_mul_f32_e64 v233, v233, v232
    v_accvgpr_write_b32 a120, v233
    v_accvgpr_read_b32 v234, a121
    v_mul_f32_e64 v234, v234, v232
    v_accvgpr_write_b32 a121, v234
    v_accvgpr_read_b32 v235, a122
    v_mul_f32_e64 v235, v235, v232
    v_accvgpr_write_b32 a122, v235
    v_accvgpr_read_b32 v236, a123
    v_mul_f32_e64 v236, v236, v232
    v_accvgpr_write_b32 a123, v236
    v_accvgpr_read_b32 v233, a124
    v_mul_f32_e64 v233, v233, v232
    v_accvgpr_write_b32 a124, v233
    v_accvgpr_read_b32 v234, a125
    v_mul_f32_e64 v234, v234, v232
    v_accvgpr_write_b32 a125, v234
    v_accvgpr_read_b32 v235, a126
    v_mul_f32_e64 v235, v235, v232
    v_accvgpr_write_b32 a126, v235
    v_accvgpr_read_b32 v236, a127
    v_mul_f32_e64 v236, v236, v232
    v_accvgpr_write_b32 a127, v236
    v_exp_f32 v128, v56
    v_exp_f32 v129, v57
    v_exp_f32 v130, v58
    v_exp_f32 v131, v59
    v_exp_f32 v132, v60
    v_exp_f32 v133, v61
    v_exp_f32 v134, v62
    v_exp_f32_e64 v135, v63
    s_nop 0
    v_cvt_pk_bf16_f32 v124, v128, v129
    v_cvt_pk_bf16_f32 v125, v130, v131
    v_cvt_pk_bf16_f32 v126, v132, v133
    v_cvt_pk_bf16_f32 v127, v134, v135
    s_nop 1
    s_branch kf_rr13
kf_rare18:
    s_nop 15
    v_max3_f32 v230, v16, v17, v18
    v_max3_f32 v230, v230, v19, v20
    v_max3_f32 v230, v230, v21, v22
    v_max_f32 v230, v230, v23
    v_mov_b32 v231, v230
    s_nop 1
    v_permlane16_swap_b32 v230, v231
    s_nop 0
    v_max_f32 v230, v230, v231
    v_mov_b32 v231, v230
    s_nop 1
    v_permlane32_swap_b32 v230, v231
    s_nop 0
    v_max_f32 v230, v230, v231
    v_add_f32 v230, 0x41800000, v230
    v_max_f32 v230, 0, v230
    v_sub_f32 v232, 0, v230
    v_exp_f32 v232, v232
    v_sub_f32 v226, v226, v230
    v_sub_f32 v80, v80, v230
    v_sub_f32 v48, v48, v230
    v_sub_f32 v16, v16, v230
    v_sub_f32 v81, v81, v230
    v_sub_f32 v49, v49, v230
    v_sub_f32 v17, v17, v230
    v_sub_f32 v82, v82, v230
    v_sub_f32 v50, v50, v230
    v_sub_f32 v18, v18, v230
    v_sub_f32 v83, v83, v230
    v_sub_f32 v51, v51, v230
    v_sub_f32 v19, v19, v230
    v_sub_f32 v84, v84, v230
    v_sub_f32 v52, v52, v230
    v_sub_f32 v20, v20, v230
    v_sub_f32 v85, v85, v230
    v_sub_f32 v53, v53, v230
    v_sub_f32 v21, v21, v230
    v_sub_f32 v86, v86, v230
    v_sub_f32 v54, v54, v230
    v_sub_f32 v22, v22, v230
    v_sub_f32 v87, v87, v230
    v_sub_f32 v55, v55, v230
    v_sub_f32 v23, v23, v230
    v_mul_f32 v152, v152, v232
    v_mul_f32 v153, v153, v232
    v_mul_f32 v154, v154, v232
    v_mul_f32 v155, v155, v232
    v_accvgpr_read_b32 v233, a64
    v_mul_f32_e64 v233, v233, v232
    v_accvgpr_write_b32 a64, v233
    v_accvgpr_read_b32 v234, a65
    v_mul_f32_e64 v234, v234, v232
    v_accvgpr_write_b32 a65, v234
    v_accvgpr_read_b32 v235, a66
    v_mul_f32_e64 v235, v235, v232
    v_accvgpr_write_b32 a66, v235
    v_accvgpr_read_b32 v236, a67
    v_mul_f32_e64 v236, v236, v232
    v_accvgpr_write_b32 a67, v236
    v_accvgpr_read_b32 v233, a68
    v_mul_f32_e64 v233, v233, v232
    v_accvgpr_write_b32 a68, v233
    v_accvgpr_read_b32 v234, a69
    v_mul_f32_e64 v234, v234, v232
    v_accvgpr_write_b32 a69, v234
    v_accvgpr_read_b32 v235, a70
    v_mul_f32_e64 v235, v235, v232
    v_accvgpr_write_b32 a70, v235
    v_accvgpr_read_b32 v236, a71
    v_mul_f32_e64 v236, v236, v232
    v_accvgpr_write_b32 a71, v236
    v_accvgpr_read_b32 v233, a72
    v_mul_f32_e64 v233, v233, v232
    v_accvgpr_write_b32 a72, v233
    v_accvgpr_read_b32 v234, a73
    v_mul_f32_e64 v234, v234, v232
    v_accvgpr_write_b32 a73, v234
    v_accvgpr_read_b32 v235, a74
    v_mul_f32_e64 v235, v235, v232
    v_accvgpr_write_b32 a74, v235
    v_accvgpr_read_b32 v236, a75
    v_mul_f32_e64 v236, v236, v232
    v_accvgpr_write_b32 a75, v236
    v_accvgpr_read_b32 v233, a76
    v_mul_f32_e64 v233, v233, v232
    v_accvgpr_write_b32 a76, v233
    v_accvgpr_read_b32 v234, a77
    v_mul_f32_e64 v234, v234, v232
    v_accvgpr_write_b32 a77, v234
    v_accvgpr_read_b32 v235, a78
    v_mul_f32_e64 v235, v235, v232
    v_accvgpr_write_b32 a78, v235
    v_accvgpr_read_b32 v236, a79
    v_mul_f32_e64 v236, v236, v232
    v_accvgpr_write_b32 a79, v236
    v_accvgpr_read_b32 v233, a80
    v_mul_f32_e64 v233, v233, v232
    v_accvgpr_write_b32 a80, v233
    v_accvgpr_read_b32 v234, a81
    v_mul_f32_e64 v234, v234, v232
    v_accvgpr_write_b32 a81, v234
    v_accvgpr_read_b32 v235, a82
    v_mul_f32_e64 v235, v235, v232
    v_accvgpr_write_b32 a82, v235
    v_accvgpr_read_b32 v236, a83
    v_mul_f32_e64 v236, v236, v232
    v_accvgpr_write_b32 a83, v236
    v_accvgpr_read_b32 v233, a84
    v_mul_f32_e64 v233, v233, v232
    v_accvgpr_write_b32 a84, v233
    v_accvgpr_read_b32 v234, a85
    v_mul_f32_e64 v234, v234, v232
    v_accvgpr_write_b32 a85, v234
    v_accvgpr_read_b32 v235, a86
    v_mul_f32_e64 v235, v235, v232
    v_accvgpr_write_b32 a86, v235
    v_accvgpr_read_b32 v236, a87
    v_mul_f32_e64 v236, v236, v232
    v_accvgpr_write_b32 a87, v236
    v_accvgpr_read_b32 v233, a88
    v_mul_f32_e64 v233, v233, v232
    v_accvgpr_write_b32 a88, v233
    v_accvgpr_read_b32 v234, a89
    v_mul_f32_e64 v234, v234, v232
    v_accvgpr_write_b32 a89, v234
    v_accvgpr_read_b32 v235, a90
    v_mul_f32_e64 v235, v235, v232
    v_accvgpr_write_b32 a90, v235
    v_accvgpr_read_b32 v236, a91
    v_mul_f32_e64 v236, v236, v232
    v_accvgpr_write_b32 a91, v236
    v_accvgpr_read_b32 v233, a92
    v_mul_f32_e64 v233, v233, v232
    v_accvgpr_write_b32 a92, v233
    v_accvgpr_read_b32 v234, a93
    v_mul_f32_e64 v234, v234, v232
    v_accvgpr_write_b32 a93, v234
    v_accvgpr_read_b32 v235, a94
    v_mul_f32_e64 v235, v235, v232
    v_accvgpr_write_b32 a94, v235
    v_accvgpr_read_b32 v236, a95
    v_mul_f32_e64 v236, v236, v232
    v_accvgpr_write_b32 a95, v236
    v_exp_f32 v128, v16
    v_exp_f32 v129, v17
    v_exp_f32 v130, v18
    v_exp_f32 v131, v19
    v_exp_f32 v132, v20
    v_exp_f32 v133, v21
    v_exp_f32 v134, v22
    v_exp_f32_e64 v135, v23
    s_nop 0
    v_cvt_pk_bf16_f32 v104, v128, v129
    v_cvt_pk_bf16_f32 v105, v130, v131
    v_cvt_pk_bf16_f32 v106, v132, v133
    v_cvt_pk_bf16_f32 v107, v134, v135
    v_max3_f32 v230, v24, v25, v26
    v_max3_f32 v230, v230, v27, v28
    v_max3_f32 v230, v230, v29, v30
    v_max_f32 v230, v230, v31
    v_mov_b32 v231, v230
    s_nop 1
    v_permlane16_swap_b32 v230, v231
    s_nop 0
    v_max_f32 v230, v230, v231
    v_mov_b32 v231, v230
    s_nop 1
    v_permlane32_swap_b32 v230, v231
    s_nop 0
    v_max_f32_e64 v230, v230, v231
    v_add_f32 v230, 0x41800000, v230
    v_max_f32 v230, 0, v230
    v_sub_f32 v232, 0, v230
    v_exp_f32 v232, v232
    v_sub_f32 v227, v227, v230
    v_sub_f32 v88, v88, v230
    v_sub_f32 v56, v56, v230
    v_sub_f32 v24, v24, v230
    v_sub_f32 v89, v89, v230
    v_sub_f32 v57, v57, v230
    v_sub_f32 v25, v25, v230
    v_sub_f32 v90, v90, v230
    v_sub_f32 v58, v58, v230
    v_sub_f32 v26, v26, v230
    v_sub_f32 v91, v91, v230
    v_sub_f32 v59, v59, v230
    v_sub_f32 v27, v27, v230
    v_sub_f32 v92, v92, v230
    v_sub_f32 v60, v60, v230
    v_sub_f32 v28, v28, v230
    v_sub_f32 v93, v93, v230
    v_sub_f32 v61, v61, v230
    v_sub_f32 v29, v29, v230
    v_sub_f32 v94, v94, v230
    v_sub_f32 v62, v62, v230
    v_sub_f32 v30, v30, v230
    v_sub_f32 v95, v95, v230
    v_sub_f32 v63, v63, v230
    v_sub_f32 v31, v31, v230
    v_mul_f32 v156, v156, v232
    v_mul_f32 v157, v157, v232
    v_mul_f32 v158, v158, v232
    v_mul_f32 v159, v159, v232
    v_accvgpr_read_b32 v233, a96
    v_mul_f32_e64 v233, v233, v232
    v_accvgpr_write_b32 a96, v233
    v_accvgpr_read_b32 v234, a97
    v_mul_f32_e64 v234, v234, v232
    v_accvgpr_write_b32 a97, v234
    v_accvgpr_read_b32 v235, a98
    v_mul_f32_e64 v235, v235, v232
    v_accvgpr_write_b32 a98, v235
    v_accvgpr_read_b32 v236, a99
    v_mul_f32_e64 v236, v236, v232
    v_accvgpr_write_b32 a99, v236
    v_accvgpr_read_b32 v233, a100
    v_mul_f32_e64 v233, v233, v232
    v_accvgpr_write_b32 a100, v233
    v_accvgpr_read_b32 v234, a101
    v_mul_f32_e64 v234, v234, v232
    v_accvgpr_write_b32 a101, v234
    v_accvgpr_read_b32 v235, a102
    v_mul_f32_e64 v235, v235, v232
    v_accvgpr_write_b32 a102, v235
    v_accvgpr_read_b32 v236, a103
    v_mul_f32_e64 v236, v236, v232
    v_accvgpr_write_b32 a103, v236
    v_accvgpr_read_b32 v233, a104
    v_mul_f32_e64 v233, v233, v232
    v_accvgpr_write_b32 a104, v233
    v_accvgpr_read_b32 v234, a105
    v_mul_f32_e64 v234, v234, v232
    v_accvgpr_write_b32 a105, v234
    v_accvgpr_read_b32 v235, a106
    v_mul_f32_e64 v235, v235, v232
    v_accvgpr_write_b32 a106, v235
    v_accvgpr_read_b32 v236, a107
    v_mul_f32_e64 v236, v236, v232
    v_accvgpr_write_b32 a107, v236
    v_accvgpr_read_b32 v233, a108
    v_mul_f32_e64 v233, v233, v232
    v_accvgpr_write_b32 a108, v233
    v_accvgpr_read_b32 v234, a109
    v_mul_f32_e64 v234, v234, v232
    v_accvgpr_write_b32 a109, v234
    v_accvgpr_read_b32 v235, a110
    v_mul_f32_e64 v235, v235, v232
    v_accvgpr_write_b32 a110, v235
    v_accvgpr_read_b32 v236, a111
    v_mul_f32_e64 v236, v236, v232
    v_accvgpr_write_b32 a111, v236
    v_accvgpr_read_b32 v233, a112
    v_mul_f32_e64 v233, v233, v232
    v_accvgpr_write_b32 a112, v233
    v_accvgpr_read_b32 v234, a113
    v_mul_f32_e64 v234, v234, v232
    v_accvgpr_write_b32 a113, v234
    v_accvgpr_read_b32 v235, a114
    v_mul_f32_e64 v235, v235, v232
    v_accvgpr_write_b32 a114, v235
    v_accvgpr_read_b32 v236, a115
    v_mul_f32_e64 v236, v236, v232
    v_accvgpr_write_b32 a115, v236
    v_accvgpr_read_b32 v233, a116
    v_mul_f32_e64 v233, v233, v232
    v_accvgpr_write_b32 a116, v233
    v_accvgpr_read_b32 v234, a117
    v_mul_f32_e64 v234, v234, v232
    v_accvgpr_write_b32 a117, v234
    v_accvgpr_read_b32 v235, a118
    v_mul_f32_e64 v235, v235, v232
    v_accvgpr_write_b32 a118, v235
    v_accvgpr_read_b32 v236, a119
    v_mul_f32_e64 v236, v236, v232
    v_accvgpr_write_b32 a119, v236
    v_accvgpr_read_b32 v233, a120
    v_mul_f32_e64 v233, v233, v232
    v_accvgpr_write_b32 a120, v233
    v_accvgpr_read_b32 v234, a121
    v_mul_f32_e64 v234, v234, v232
    v_accvgpr_write_b32 a121, v234
    v_accvgpr_read_b32 v235, a122
    v_mul_f32_e64 v235, v235, v232
    v_accvgpr_write_b32 a122, v235
    v_accvgpr_read_b32 v236, a123
    v_mul_f32_e64 v236, v236, v232
    v_accvgpr_write_b32 a123, v236
    v_accvgpr_read_b32 v233, a124
    v_mul_f32_e64 v233, v233, v232
    v_accvgpr_write_b32 a124, v233
    v_accvgpr_read_b32 v234, a125
    v_mul_f32_e64 v234, v234, v232
    v_accvgpr_write_b32 a125, v234
    v_accvgpr_read_b32 v235, a126
    v_mul_f32_e64 v235, v235, v232
    v_accvgpr_write_b32 a126, v235
    v_accvgpr_read_b32 v236, a127
    v_mul_f32_e64 v236, v236, v232
    v_accvgpr_write_b32 a127, v236
    v_exp_f32 v128, v24
    v_exp_f32 v129, v25
    v_exp_f32 v130, v26
    v_exp_f32 v131, v27
    v_exp_f32 v132, v28
    v_exp_f32 v133, v29
    v_exp_f32 v134, v30
    v_exp_f32_e64 v135, v31
    s_nop 0
    v_cvt_pk_bf16_f32 v108, v128, v129
    v_cvt_pk_bf16_f32 v109, v130, v131
    v_cvt_pk_bf16_f32 v110, v132, v133
    v_cvt_pk_bf16_f32 v111, v134, v135
    s_nop 1
    s_branch kf_rr17
kf_rare22:
    s_nop 15
    v_max3_f32 v230, v48, v49, v50
    v_max3_f32 v230, v230, v51, v52
    v_max3_f32 v230, v230, v53, v54
    v_max_f32 v230, v230, v55
    v_mov_b32 v231, v230
    s_nop 1
    v_permlane16_swap_b32 v230, v231
    s_nop 0
    v_max_f32 v230, v230, v231
    v_mov_b32 v231, v230
    s_nop 1
    v_permlane32_swap_b32 v230, v231
    s_nop 0
    v_max_f32 v230, v230, v231
    v_add_f32 v230, 0x41800000, v230
    v_max_f32 v230, 0, v230
    v_sub_f32 v232, 0, v230
    v_exp_f32 v232, v232
    v_sub_f32 v226, v226, v230
    v_sub_f32 v80, v80, v230
    v_sub_f32 v16, v16, v230
    v_sub_f32 v48, v48, v230
    v_sub_f32 v81, v81, v230
    v_sub_f32 v17, v17, v230
    v_sub_f32 v49, v49, v230
    v_sub_f32 v82, v82, v230
    v_sub_f32 v18, v18, v230
    v_sub_f32 v50, v50, v230
    v_sub_f32 v83, v83, v230
    v_sub_f32 v19, v19, v230
    v_sub_f32 v51, v51, v230
    v_sub_f32 v84, v84, v230
    v_sub_f32 v20, v20, v230
    v_sub_f32 v52, v52, v230
    v_sub_f32 v85, v85, v230
    v_sub_f32 v21, v21, v230
    v_sub_f32 v53, v53, v230
    v_sub_f32 v86, v86, v230
    v_sub_f32 v22, v22, v230
    v_sub_f32 v54, v54, v230
    v_sub_f32 v87, v87, v230
    v_sub_f32 v23, v23, v230
    v_sub_f32 v55, v55, v230
    v_mul_f32 v152, v152, v232
    v_mul_f32 v153, v153, v232
    v_mul_f32 v154, v154, v232
    v_mul_f32 v155, v155, v232
    v_accvgpr_read_b32 v233, a64
    v_mul_f32_e64 v233, v233, v232
    v_accvgpr_write_b32 a64, v233
    v_accvgpr_read_b32 v234, a65
    v_mul_f32_e64 v234, v234, v232
    v_accvgpr_write_b32 a65, v234
    v_accvgpr_read_b32 v235, a66
    v_mul_f32_e64 v235, v235, v232
    v_accvgpr_write_b32 a66, v235
    v_accvgpr_read_b32 v236, a67
    v_mul_f32_e64 v236, v236, v232
    v_accvgpr_write_b32 a67, v236
    v_accvgpr_read_b32 v233, a68
    v_mul_f32_e64 v233, v233, v232
    v_accvgpr_write_b32 a68, v233
    v_accvgpr_read_b32 v234, a69
    v_mul_f32_e64 v234, v234, v232
    v_accvgpr_write_b32 a69, v234
    v_accvgpr_read_b32 v235, a70
    v_mul_f32_e64 v235, v235, v232
    v_accvgpr_write_b32 a70, v235
    v_accvgpr_read_b32 v236, a71
    v_mul_f32_e64 v236, v236, v232
    v_accvgpr_write_b32 a71, v236
    v_accvgpr_read_b32 v233, a72
    v_mul_f32_e64 v233, v233, v232
    v_accvgpr_write_b32 a72, v233
    v_accvgpr_read_b32 v234, a73
    v_mul_f32_e64 v234, v234, v232
    v_accvgpr_write_b32 a73, v234
    v_accvgpr_read_b32 v235, a74
    v_mul_f32_e64 v235, v235, v232
    v_accvgpr_write_b32 a74, v235
    v_accvgpr_read_b32 v236, a75
    v_mul_f32_e64 v236, v236, v232
    v_accvgpr_write_b32 a75, v236
    v_accvgpr_read_b32 v233, a76
    v_mul_f32_e64 v233, v233, v232
    v_accvgpr_write_b32 a76, v233
    v_accvgpr_read_b32 v234, a77
    v_mul_f32_e64 v234, v234, v232
    v_accvgpr_write_b32 a77, v234
    v_accvgpr_read_b32 v235, a78
    v_mul_f32_e64 v235, v235, v232
    v_accvgpr_write_b32 a78, v235
    v_accvgpr_read_b32 v236, a79
    v_mul_f32_e64 v236, v236, v232
    v_accvgpr_write_b32 a79, v236
    v_accvgpr_read_b32 v233, a80
    v_mul_f32_e64 v233, v233, v232
    v_accvgpr_write_b32 a80, v233
    v_accvgpr_read_b32 v234, a81
    v_mul_f32_e64 v234, v234, v232
    v_accvgpr_write_b32 a81, v234
    v_accvgpr_read_b32 v235, a82
    v_mul_f32_e64 v235, v235, v232
    v_accvgpr_write_b32 a82, v235
    v_accvgpr_read_b32 v236, a83
    v_mul_f32_e64 v236, v236, v232
    v_accvgpr_write_b32 a83, v236
    v_accvgpr_read_b32 v233, a84
    v_mul_f32_e64 v233, v233, v232
    v_accvgpr_write_b32 a84, v233
    v_accvgpr_read_b32 v234, a85
    v_mul_f32_e64 v234, v234, v232
    v_accvgpr_write_b32 a85, v234
    v_accvgpr_read_b32 v235, a86
    v_mul_f32_e64 v235, v235, v232
    v_accvgpr_write_b32 a86, v235
    v_accvgpr_read_b32 v236, a87
    v_mul_f32_e64 v236, v236, v232
    v_accvgpr_write_b32 a87, v236
    v_accvgpr_read_b32 v233, a88
    v_mul_f32_e64 v233, v233, v232
    v_accvgpr_write_b32 a88, v233
    v_accvgpr_read_b32 v234, a89
    v_mul_f32_e64 v234, v234, v232
    v_accvgpr_write_b32 a89, v234
    v_accvgpr_read_b32 v235, a90
    v_mul_f32_e64 v235, v235, v232
    v_accvgpr_write_b32 a90, v235
    v_accvgpr_read_b32 v236, a91
    v_mul_f32_e64 v236, v236, v232
    v_accvgpr_write_b32 a91, v236
    v_accvgpr_read_b32 v233, a92
    v_mul_f32_e64 v233, v233, v232
    v_accvgpr_write_b32 a92, v233
    v_accvgpr_read_b32 v234, a93
    v_mul_f32_e64 v234, v234, v232
    v_accvgpr_write_b32 a93, v234
    v_accvgpr_read_b32 v235, a94
    v_mul_f32_e64 v235, v235, v232
    v_accvgpr_write_b32 a94, v235
    v_accvgpr_read_b32 v236, a95
    v_mul_f32_e64 v236, v236, v232
    v_accvgpr_write_b32 a95, v236
    v_exp_f32 v128, v48
    v_exp_f32 v129, v49
    v_exp_f32 v130, v50
    v_exp_f32 v131, v51
    v_exp_f32 v132, v52
    v_exp_f32 v133, v53
    v_exp_f32 v134, v54
    v_exp_f32_e64 v135, v55
    s_nop 0
    v_cvt_pk_bf16_f32 v120, v128, v129
    v_cvt_pk_bf16_f32 v121, v130, v131
    v_cvt_pk_bf16_f32 v122, v132, v133
    v_cvt_pk_bf16_f32 v123, v134, v135
    v_max3_f32 v230, v56, v57, v58
    v_max3_f32 v230, v230, v59, v60
    v_max3_f32 v230, v230, v61, v62
    v_max_f32 v230, v230, v63
    v_mov_b32 v231, v230
    s_nop 1
    v_permlane16_swap_b32 v230, v231
    s_nop 0
    v_max_f32 v230, v230, v231
    v_mov_b32 v231, v230
    s_nop 1
    v_permlane32_swap_b32 v230, v231
    s_nop 0
    v_max_f32_e64 v230, v230, v231
    v_add_f32 v230, 0x41800000, v230
    v_max_f32 v230, 0, v230
    v_sub_f32 v232, 0, v230
    v_exp_f32 v232, v232
    v_sub_f32 v227, v227, v230
    v_sub_f32 v88, v88, v230
    v_sub_f32 v24, v24, v230
    v_sub_f32 v56, v56, v230
    v_sub_f32 v89, v89, v230
    v_sub_f32 v25, v25, v230
    v_sub_f32 v57, v57, v230
    v_sub_f32 v90, v90, v230
    v_sub_f32 v26, v26, v230
    v_sub_f32 v58, v58, v230
    v_sub_f32 v91, v91, v230
    v_sub_f32 v27, v27, v230
    v_sub_f32 v59, v59, v230
    v_sub_f32 v92, v92, v230
    v_sub_f32 v28, v28, v230
    v_sub_f32 v60, v60, v230
    v_sub_f32 v93, v93, v230
    v_sub_f32 v29, v29, v230
    v_sub_f32 v61, v61, v230
    v_sub_f32 v94, v94, v230
    v_sub_f32 v30, v30, v230
    v_sub_f32 v62, v62, v230
    v_sub_f32 v95, v95, v230
    v_sub_f32 v31, v31, v230
    v_sub_f32 v63, v63, v230
    v_mul_f32 v156, v156, v232
    v_mul_f32 v157, v157, v232
    v_mul_f32 v158, v158, v232
    v_mul_f32 v159, v159, v232
    v_accvgpr_read_b32 v233, a96
    v_mul_f32_e64 v233, v233, v232
    v_accvgpr_write_b32 a96, v233
    v_accvgpr_read_b32 v234, a97
    v_mul_f32_e64 v234, v234, v232
    v_accvgpr_write_b32 a97, v234
    v_accvgpr_read_b32 v235, a98
    v_mul_f32_e64 v235, v235, v232
    v_accvgpr_write_b32 a98, v235
    v_accvgpr_read_b32 v236, a99
    v_mul_f32_e64 v236, v236, v232
    v_accvgpr_write_b32 a99, v236
    v_accvgpr_read_b32 v233, a100
    v_mul_f32_e64 v233, v233, v232
    v_accvgpr_write_b32 a100, v233
    v_accvgpr_read_b32 v234, a101
    v_mul_f32_e64 v234, v234, v232
    v_accvgpr_write_b32 a101, v234
    v_accvgpr_read_b32 v235, a102
    v_mul_f32_e64 v235, v235, v232
    v_accvgpr_write_b32 a102, v235
    v_accvgpr_read_b32 v236, a103
    v_mul_f32_e64 v236, v236, v232
    v_accvgpr_write_b32 a103, v236
    v_accvgpr_read_b32 v233, a104
    v_mul_f32_e64 v233, v233, v232
    v_accvgpr_write_b32 a104, v233
    v_accvgpr_read_b32 v234, a105
    v_mul_f32_e64 v234, v234, v232
    v_accvgpr_write_b32 a105, v234
    v_accvgpr_read_b32 v235, a106
    v_mul_f32_e64 v235, v235, v232
    v_accvgpr_write_b32 a106, v235
    v_accvgpr_read_b32 v236, a107
    v_mul_f32_e64 v236, v236, v232
    v_accvgpr_write_b32 a107, v236
    v_accvgpr_read_b32 v233, a108
    v_mul_f32_e64 v233, v233, v232
    v_accvgpr_write_b32 a108, v233
    v_accvgpr_read_b32 v234, a109
    v_mul_f32_e64 v234, v234, v232
    v_accvgpr_write_b32 a109, v234
    v_accvgpr_read_b32 v235, a110
    v_mul_f32_e64 v235, v235, v232
    v_accvgpr_write_b32 a110, v235
    v_accvgpr_read_b32 v236, a111
    v_mul_f32_e64 v236, v236, v232
    v_accvgpr_write_b32 a111, v236
    v_accvgpr_read_b32 v233, a112
    v_mul_f32_e64 v233, v233, v232
    v_accvgpr_write_b32 a112, v233
    v_accvgpr_read_b32 v234, a113
    v_mul_f32_e64 v234, v234, v232
    v_accvgpr_write_b32 a113, v234
    v_accvgpr_read_b32 v235, a114
    v_mul_f32_e64 v235, v235, v232
    v_accvgpr_write_b32 a114, v235
    v_accvgpr_read_b32 v236, a115
    v_mul_f32_e64 v236, v236, v232
    v_accvgpr_write_b32 a115, v236
    v_accvgpr_read_b32 v233, a116
    v_mul_f32_e64 v233, v233, v232
    v_accvgpr_write_b32 a116, v233
    v_accvgpr_read_b32 v234, a117
    v_mul_f32_e64 v234, v234, v232
    v_accvgpr_write_b32 a117, v234
    v_accvgpr_read_b32 v235, a118
    v_mul_f32_e64 v235, v235, v232
    v_accvgpr_write_b32 a118, v235
    v_accvgpr_read_b32 v236, a119
    v_mul_f32_e64 v236, v236, v232
    v_accvgpr_write_b32 a119, v236
    v_accvgpr_read_b32 v233, a120
    v_mul_f32_e64 v233, v233, v232
    v_accvgpr_write_b32 a120, v233
    v_accvgpr_read_b32 v234, a121
    v_mul_f32_e64 v234, v234, v232
    v_accvgpr_write_b32 a121, v234
    v_accvgpr_read_b32 v235, a122
    v_mul_f32_e64 v235, v235, v232
    v_accvgpr_write_b32 a122, v235
    v_accvgpr_read_b32 v236, a123
    v_mul_f32_e64 v236, v236, v232
    v_accvgpr_write_b32 a123, v236
    v_accvgpr_read_b32 v233, a124
    v_mul_f32_e64 v233, v233, v232
    v_accvgpr_write_b32 a124, v233
    v_accvgpr_read_b32 v234, a125
    v_mul_f32_e64 v234, v234, v232
    v_accvgpr_write_b32 a125, v234
    v_accvgpr_read_b32 v235, a126
    v_mul_f32_e64 v235, v235, v232
    v_accvgpr_write_b32 a126, v235
    v_accvgpr_read_b32 v236, a127
    v_mul_f32_e64 v236, v236, v232
    v_accvgpr_write_b32 a127, v236
    v_exp_f32 v128, v56
    v_exp_f32 v129, v57
    v_exp_f32 v130, v58
    v_exp_f32 v131, v59
    v_exp_f32 v132, v60
    v_exp_f32 v133, v61
    v_exp_f32 v134, v62
    v_exp_f32_e64 v135, v63
    s_nop 0
    v_cvt_pk_bf16_f32 v124, v128, v129
    v_cvt_pk_bf16_f32 v125, v130, v131
    v_cvt_pk_bf16_f32 v126, v132, v133
    v_cvt_pk_bf16_f32 v127, v134, v135
    s_nop 1
    s_branch kf_rr21
kf_rare26:
    s_nop 15
    v_max3_f32 v230, v16, v17, v18
    v_max3_f32 v230, v230, v19, v20
    v_max3_f32 v230, v230, v21, v22
    v_max_f32 v230, v230, v23
    v_mov_b32 v231, v230
    s_nop 1
    v_permlane16_swap_b32 v230, v231
    s_nop 0
    v_max_f32 v230, v230, v231
    v_mov_b32 v231, v230
    s_nop 1
    v_permlane32_swap_b32 v230, v231
    s_nop 0
    v_max_f32 v230, v230, v231
    v_add_f32 v230, 0x41800000, v230
    v_max_f32 v230, 0, v230
    v_sub_f32 v232, 0, v230
    v_exp_f32 v232, v232
    v_sub_f32 v226, v226, v230
    v_sub_f32 v80, v80, v230
    v_sub_f32 v48, v48, v230
    v_sub_f32 v16, v16, v230
    v_sub_f32 v81, v81, v230
    v_sub_f32 v49, v49, v230
    v_sub_f32 v17, v17, v230
    v_sub_f32 v82, v82, v230
    v_sub_f32 v50, v50, v230
    v_sub_f32 v18, v18, v230
    v_sub_f32 v83, v83, v230
    v_sub_f32 v51, v51, v230
    v_sub_f32 v19, v19, v230
    v_sub_f32 v84, v84, v230
    v_sub_f32 v52, v52, v230
    v_sub_f32 v20, v20, v230
    v_sub_f32 v85, v85, v230
    v_sub_f32 v53, v53, v230
    v_sub_f32 v21, v21, v230
    v_sub_f32 v86, v86, v230
    v_sub_f32 v54, v54, v230
    v_sub_f32 v22, v22, v230
    v_sub_f32 v87, v87, v230
    v_sub_f32 v55, v55, v230
    v_sub_f32 v23, v23, v230
    v_mul_f32 v152, v152, v232
    v_mul_f32 v153, v153, v232
    v_mul_f32 v154, v154, v232
    v_mul_f32 v155, v155, v232
    v_accvgpr_read_b32 v233, a64
    v_mul_f32_e64 v233, v233, v232
    v_accvgpr_write_b32 a64, v233
    v_accvgpr_read_b32 v234, a65
    v_mul_f32_e64 v234, v234, v232
    v_accvgpr_write_b32 a65, v234
    v_accvgpr_read_b32 v235, a66
    v_mul_f32_e64 v235, v235, v232
    v_accvgpr_write_b32 a66, v235
    v_accvgpr_read_b32 v236, a67
    v_mul_f32_e64 v236, v236, v232
    v_accvgpr_write_b32 a67, v236
    v_accvgpr_read_b32 v233, a68
    v_mul_f32_e64 v233, v233, v232
    v_accvgpr_write_b32 a68, v233
    v_accvgpr_read_b32 v234, a69
    v_mul_f32_e64 v234, v234, v232
    v_accvgpr_write_b32 a69, v234
    v_accvgpr_read_b32 v235, a70
    v_mul_f32_e64 v235, v235, v232
    v_accvgpr_write_b32 a70, v235
    v_accvgpr_read_b32 v236, a71
    v_mul_f32_e64 v236, v236, v232
    v_accvgpr_write_b32 a71, v236
    v_accvgpr_read_b32 v233, a72
    v_mul_f32_e64 v233, v233, v232
    v_accvgpr_write_b32 a72, v233
    v_accvgpr_read_b32 v234, a73
    v_mul_f32_e64 v234, v234, v232
    v_accvgpr_write_b32 a73, v234
    v_accvgpr_read_b32 v235, a74
    v_mul_f32_e64 v235, v235, v232
    v_accvgpr_write_b32 a74, v235
    v_accvgpr_read_b32 v236, a75
    v_mul_f32_e64 v236, v236, v232
    v_accvgpr_write_b32 a75, v236
    v_accvgpr_read_b32 v233, a76
    v_mul_f32_e64 v233, v233, v232
    v_accvgpr_write_b32 a76, v233
    v_accvgpr_read_b32 v234, a77
    v_mul_f32_e64 v234, v234, v232
    v_accvgpr_write_b32 a77, v234
    v_accvgpr_read_b32 v235, a78
    v_mul_f32_e64 v235, v235, v232
    v_accvgpr_write_b32 a78, v235
    v_accvgpr_read_b32 v236, a79
    v_mul_f32_e64 v236, v236, v232
    v_accvgpr_write_b32 a79, v236
    v_accvgpr_read_b32 v233, a80
    v_mul_f32_e64 v233, v233, v232
    v_accvgpr_write_b32 a80, v233
    v_accvgpr_read_b32 v234, a81
    v_mul_f32_e64 v234, v234, v232
    v_accvgpr_write_b32 a81, v234
    v_accvgpr_read_b32 v235, a82
    v_mul_f32_e64 v235, v235, v232
    v_accvgpr_write_b32 a82, v235
    v_accvgpr_read_b32 v236, a83
    v_mul_f32_e64 v236, v236, v232
    v_accvgpr_write_b32 a83, v236
    v_accvgpr_read_b32 v233, a84
    v_mul_f32_e64 v233, v233, v232
    v_accvgpr_write_b32 a84, v233
    v_accvgpr_read_b32 v234, a85
    v_mul_f32_e64 v234, v234, v232
    v_accvgpr_write_b32 a85, v234
    v_accvgpr_read_b32 v235, a86
    v_mul_f32_e64 v235, v235, v232
    v_accvgpr_write_b32 a86, v235
    v_accvgpr_read_b32 v236, a87
    v_mul_f32_e64 v236, v236, v232
    v_accvgpr_write_b32 a87, v236
    v_accvgpr_read_b32 v233, a88
    v_mul_f32_e64 v233, v233, v232
    v_accvgpr_write_b32 a88, v233
    v_accvgpr_read_b32 v234, a89
    v_mul_f32_e64 v234, v234, v232
    v_accvgpr_write_b32 a89, v234
    v_accvgpr_read_b32 v235, a90
    v_mul_f32_e64 v235, v235, v232
    v_accvgpr_write_b32 a90, v235
    v_accvgpr_read_b32 v236, a91
    v_mul_f32_e64 v236, v236, v232
    v_accvgpr_write_b32 a91, v236
    v_accvgpr_read_b32 v233, a92
    v_mul_f32_e64 v233, v233, v232
    v_accvgpr_write_b32 a92, v233
    v_accvgpr_read_b32 v234, a93
    v_mul_f32_e64 v234, v234, v232
    v_accvgpr_write_b32 a93, v234
    v_accvgpr_read_b32 v235, a94
    v_mul_f32_e64 v235, v235, v232
    v_accvgpr_write_b32 a94, v235
    v_accvgpr_read_b32 v236, a95
    v_mul_f32_e64 v236, v236, v232
    v_accvgpr_write_b32 a95, v236
    v_exp_f32 v128, v16
    v_exp_f32 v129, v17
    v_exp_f32 v130, v18
    v_exp_f32 v131, v19
    v_exp_f32 v132, v20
    v_exp_f32 v133, v21
    v_exp_f32 v134, v22
    v_exp_f32_e64 v135, v23
    s_nop 0
    v_cvt_pk_bf16_f32 v104, v128, v129
    v_cvt_pk_bf16_f32 v105, v130, v131
    v_cvt_pk_bf16_f32 v106, v132, v133
    v_cvt_pk_bf16_f32 v107, v134, v135
    v_max3_f32 v230, v24, v25, v26
    v_max3_f32 v230, v230, v27, v28
    v_max3_f32 v230, v230, v29, v30
    v_max_f32 v230, v230, v31
    v_mov_b32 v231, v230
    s_nop 1
    v_permlane16_swap_b32 v230, v231
    s_nop 0
    v_max_f32 v230, v230, v231
    v_mov_b32 v231, v230
    s_nop 1
    v_permlane32_swap_b32 v230, v231
    s_nop 0
    v_max_f32_e64 v230, v230, v231
    v_add_f32 v230, 0x41800000, v230
    v_max_f32 v230, 0, v230
    v_sub_f32 v232, 0, v230
    v_exp_f32 v232, v232
    v_sub_f32 v227, v227, v230
    v_sub_f32 v88, v88, v230
    v_sub_f32 v56, v56, v230
    v_sub_f32 v24, v24, v230
    v_sub_f32 v89, v89, v230
    v_sub_f32 v57, v57, v230
    v_sub_f32 v25, v25, v230
    v_sub_f32 v90, v90, v230
    v_sub_f32 v58, v58, v230
    v_sub_f32 v26, v26, v230
    v_sub_f32 v91, v91, v230
    v_sub_f32 v59, v59, v230
    v_sub_f32 v27, v27, v230
    v_sub_f32 v92, v92, v230
    v_sub_f32 v60, v60, v230
    v_sub_f32 v28, v28, v230
    v_sub_f32 v93, v93, v230
    v_sub_f32 v61, v61, v230
    v_sub_f32 v29, v29, v230
    v_sub_f32 v94, v94, v230
    v_sub_f32 v62, v62, v230
    v_sub_f32 v30, v30, v230
    v_sub_f32 v95, v95, v230
    v_sub_f32 v63, v63, v230
    v_sub_f32 v31, v31, v230
    v_mul_f32 v156, v156, v232
    v_mul_f32 v157, v157, v232
    v_mul_f32 v158, v158, v232
    v_mul_f32 v159, v159, v232
    v_accvgpr_read_b32 v233, a96
    v_mul_f32_e64 v233, v233, v232
    v_accvgpr_write_b32 a96, v233
    v_accvgpr_read_b32 v234, a97
    v_mul_f32_e64 v234, v234, v232
    v_accvgpr_write_b32 a97, v234
    v_accvgpr_read_b32 v235, a98
    v_mul_f32_e64 v235, v235, v232
    v_accvgpr_write_b32 a98, v235
    v_accvgpr_read_b32 v236, a99
    v_mul_f32_e64 v236, v236, v232
    v_accvgpr_write_b32 a99, v236
    v_accvgpr_read_b32 v233, a100
    v_mul_f32_e64 v233, v233, v232
    v_accvgpr_write_b32 a100, v233
    v_accvgpr_read_b32 v234, a101
    v_mul_f32_e64 v234, v234, v232
    v_accvgpr_write_b32 a101, v234
    v_accvgpr_read_b32 v235, a102
    v_mul_f32_e64 v235, v235, v232
    v_accvgpr_write_b32 a102, v235
    v_accvgpr_read_b32 v236, a103
    v_mul_f32_e64 v236, v236, v232
    v_accvgpr_write_b32 a103, v236
    v_accvgpr_read_b32 v233, a104
    v_mul_f32_e64 v233, v233, v232
    v_accvgpr_write_b32 a104, v233
    v_accvgpr_read_b32 v234, a105
    v_mul_f32_e64 v234, v234, v232
    v_accvgpr_write_b32 a105, v234
    v_accvgpr_read_b32 v235, a106
    v_mul_f32_e64 v235, v235, v232
    v_accvgpr_write_b32 a106, v235
    v_accvgpr_read_b32 v236, a107
    v_mul_f32_e64 v236, v236, v232
    v_accvgpr_write_b32 a107, v236
    v_accvgpr_read_b32 v233, a108
    v_mul_f32_e64 v233, v233, v232
    v_accvgpr_write_b32 a108, v233
    v_accvgpr_read_b32 v234, a109
    v_mul_f32_e64 v234, v234, v232
    v_accvgpr_write_b32 a109, v234
    v_accvgpr_read_b32 v235, a110
    v_mul_f32_e64 v235, v235, v232
    v_accvgpr_write_b32 a110, v235
    v_accvgpr_read_b32 v236, a111
    v_mul_f32_e64 v236, v236, v232
    v_accvgpr_write_b32 a111, v236
    v_accvgpr_read_b32 v233, a112
    v_mul_f32_e64 v233, v233, v232
    v_accvgpr_write_b32 a112, v233
    v_accvgpr_read_b32 v234, a113
    v_mul_f32_e64 v234, v234, v232
    v_accvgpr_write_b32 a113, v234
    v_accvgpr_read_b32 v235, a114
    v_mul_f32_e64 v235, v235, v232
    v_accvgpr_write_b32 a114, v235
    v_accvgpr_read_b32 v236, a115
    v_mul_f32_e64 v236, v236, v232
    v_accvgpr_write_b32 a115, v236
    v_accvgpr_read_b32 v233, a116
    v_mul_f32_e64 v233, v233, v232
    v_accvgpr_write_b32 a116, v233
    v_accvgpr_read_b32 v234, a117
    v_mul_f32_e64 v234, v234, v232
    v_accvgpr_write_b32 a117, v234
    v_accvgpr_read_b32 v235, a118
    v_mul_f32_e64 v235, v235, v232
    v_accvgpr_write_b32 a118, v235
    v_accvgpr_read_b32 v236, a119
    v_mul_f32_e64 v236, v236, v232
    v_accvgpr_write_b32 a119, v236
    v_accvgpr_read_b32 v233, a120
    v_mul_f32_e64 v233, v233, v232
    v_accvgpr_write_b32 a120, v233
    v_accvgpr_read_b32 v234, a121
    v_mul_f32_e64 v234, v234, v232
    v_accvgpr_write_b32 a121, v234
    v_accvgpr_read_b32 v235, a122
    v_mul_f32_e64 v235, v235, v232
    v_accvgpr_write_b32 a122, v235
    v_accvgpr_read_b32 v236, a123
    v_mul_f32_e64 v236, v236, v232
    v_accvgpr_write_b32 a123, v236
    v_accvgpr_read_b32 v233, a124
    v_mul_f32_e64 v233, v233, v232
    v_accvgpr_write_b32 a124, v233
    v_accvgpr_read_b32 v234, a125
    v_mul_f32_e64 v234, v234, v232
    v_accvgpr_write_b32 a125, v234
    v_accvgpr_read_b32 v235, a126
    v_mul_f32_e64 v235, v235, v232
    v_accvgpr_write_b32 a126, v235
    v_accvgpr_read_b32 v236, a127
    v_mul_f32_e64 v236, v236, v232
    v_accvgpr_write_b32 a127, v236
    v_exp_f32 v128, v24
    v_exp_f32 v129, v25
    v_exp_f32 v130, v26
    v_exp_f32 v131, v27
    v_exp_f32 v132, v28
    v_exp_f32 v133, v29
    v_exp_f32 v134, v30
    v_exp_f32_e64 v135, v31
    s_nop 0
    v_cvt_pk_bf16_f32 v108, v128, v129
    v_cvt_pk_bf16_f32 v109, v130, v131
    v_cvt_pk_bf16_f32 v110, v132, v133
    v_cvt_pk_bf16_f32 v111, v134, v135
    s_nop 1
    s_branch kf_rr25
kf_rare30:
    s_nop 15
    v_max3_f32 v230, v48, v49, v50
    v_max3_f32 v230, v230, v51, v52
    v_max3_f32 v230, v230, v53, v54
    v_max_f32 v230, v230, v55
    v_mov_b32 v231, v230
    s_nop 1
    v_permlane16_swap_b32 v230, v231
    s_nop 0
    v_max_f32 v230, v230, v231
    v_mov_b32 v231, v230
    s_nop 1
    v_permlane32_swap_b32 v230, v231
    s_nop 0
    v_max_f32 v230, v230, v231
    v_add_f32 v230, 0x41800000, v230
    v_max_f32 v230, 0, v230
    v_sub_f32 v232, 0, v230
    v_exp_f32 v232, v232
    v_sub_f32 v226, v226, v230
    v_sub_f32 v80, v80, v230
    v_sub_f32 v16, v16, v230
    v_sub_f32 v48, v48, v230
    v_sub_f32 v81, v81, v230
    v_sub_f32 v17, v17, v230
    v_sub_f32 v49, v49, v230
    v_sub_f32 v82, v82, v230
    v_sub_f32 v18, v18, v230
    v_sub_f32 v50, v50, v230
    v_sub_f32 v83, v83, v230
    v_sub_f32 v19, v19, v230
    v_sub_f32 v51, v51, v230
    v_sub_f32 v84, v84, v230
    v_sub_f32 v20, v20, v230
    v_sub_f32 v52, v52, v230
    v_sub_f32 v85, v85, v230
    v_sub_f32 v21, v21, v230
    v_sub_f32 v53, v53, v230
    v_sub_f32 v86, v86, v230
    v_sub_f32 v22, v22, v230
    v_sub_f32 v54, v54, v230
    v_sub_f32 v87, v87, v230
    v_sub_f32 v23, v23, v230
    v_sub_f32 v55, v55, v230
    v_mul_f32 v152, v152, v232
    v_mul_f32 v153, v153, v232
    v_mul_f32 v154, v154, v232
    v_mul_f32 v155, v155, v232
    v_accvgpr_read_b32 v233, a64
    v_mul_f32_e64 v233, v233, v232
    v_accvgpr_write_b32 a64, v233
    v_accvgpr_read_b32 v234, a65
    v_mul_f32_e64 v234, v234, v232
    v_accvgpr_write_b32 a65, v234
    v_accvgpr_read_b32 v235, a66
    v_mul_f32_e64 v235, v235, v232
    v_accvgpr_write_b32 a66, v235
    v_accvgpr_read_b32 v236, a67
    v_mul_f32_e64 v236, v236, v232
    v_accvgpr_write_b32 a67, v236
    v_accvgpr_read_b32 v233, a68
    v_mul_f32_e64 v233, v233, v232
    v_accvgpr_write_b32 a68, v233
    v_accvgpr_read_b32 v234, a69
    v_mul_f32_e64 v234, v234, v232
    v_accvgpr_write_b32 a69, v234
    v_accvgpr_read_b32 v235, a70
    v_mul_f32_e64 v235, v235, v232
    v_accvgpr_write_b32 a70, v235
    v_accvgpr_read_b32 v236, a71
    v_mul_f32_e64 v236, v236, v232
    v_accvgpr_write_b32 a71, v236
    v_accvgpr_read_b32 v233, a72
    v_mul_f32_e64 v233, v233, v232
    v_accvgpr_write_b32 a72, v233
    v_accvgpr_read_b32 v234, a73
    v_mul_f32_e64 v234, v234, v232
    v_accvgpr_write_b32 a73, v234
    v_accvgpr_read_b32 v235, a74
    v_mul_f32_e64 v235, v235, v232
    v_accvgpr_write_b32 a74, v235
    v_accvgpr_read_b32 v236, a75
    v_mul_f32_e64 v236, v236, v232
    v_accvgpr_write_b32 a75, v236
    v_accvgpr_read_b32 v233, a76
    v_mul_f32_e64 v233, v233, v232
    v_accvgpr_write_b32 a76, v233
    v_accvgpr_read_b32 v234, a77
    v_mul_f32_e64 v234, v234, v232
    v_accvgpr_write_b32 a77, v234
    v_accvgpr_read_b32 v235, a78
    v_mul_f32_e64 v235, v235, v232
    v_accvgpr_write_b32 a78, v235
    v_accvgpr_read_b32 v236, a79
    v_mul_f32_e64 v236, v236, v232
    v_accvgpr_write_b32 a79, v236
    v_accvgpr_read_b32 v233, a80
    v_mul_f32_e64 v233, v233, v232
    v_accvgpr_write_b32 a80, v233
    v_accvgpr_read_b32 v234, a81
    v_mul_f32_e64 v234, v234, v232
    v_accvgpr_write_b32 a81, v234
    v_accvgpr_read_b32 v235, a82
    v_mul_f32_e64 v235, v235, v232
    v_accvgpr_write_b32 a82, v235
    v_accvgpr_read_b32 v236, a83
    v_mul_f32_e64 v236, v236, v232
    v_accvgpr_write_b32 a83, v236
    v_accvgpr_read_b32 v233, a84
    v_mul_f32_e64 v233, v233, v232
    v_accvgpr_write_b32 a84, v233
    v_accvgpr_read_b32 v234, a85
    v_mul_f32_e64 v234, v234, v232
    v_accvgpr_write_b32 a85, v234
    v_accvgpr_read_b32 v235, a86
    v_mul_f32_e64 v235, v235, v232
    v_accvgpr_write_b32 a86, v235
    v_accvgpr_read_b32 v236, a87
    v_mul_f32_e64 v236, v236, v232
    v_accvgpr_write_b32 a87, v236
    v_accvgpr_read_b32 v233, a88
    v_mul_f32_e64 v233, v233, v232
    v_accvgpr_write_b32 a88, v233
    v_accvgpr_read_b32 v234, a89
    v_mul_f32_e64 v234, v234, v232
    v_accvgpr_write_b32 a89, v234
    v_accvgpr_read_b32 v235, a90
    v_mul_f32_e64 v235, v235, v232
    v_accvgpr_write_b32 a90, v235
    v_accvgpr_read_b32 v236, a91
    v_mul_f32_e64 v236, v236, v232
    v_accvgpr_write_b32 a91, v236
    v_accvgpr_read_b32 v233, a92
    v_mul_f32_e64 v233, v233, v232
    v_accvgpr_write_b32 a92, v233
    v_accvgpr_read_b32 v234, a93
    v_mul_f32_e64 v234, v234, v232
    v_accvgpr_write_b32 a93, v234
    v_accvgpr_read_b32 v235, a94
    v_mul_f32_e64 v235, v235, v232
    v_accvgpr_write_b32 a94, v235
    v_accvgpr_read_b32 v236, a95
    v_mul_f32_e64 v236, v236, v232
    v_accvgpr_write_b32 a95, v236
    v_exp_f32 v128, v48
    v_exp_f32 v129, v49
    v_exp_f32 v130, v50
    v_exp_f32 v131, v51
    v_exp_f32 v132, v52
    v_exp_f32 v133, v53
    v_exp_f32 v134, v54
    v_exp_f32_e64 v135, v55
    s_nop 0
    v_cvt_pk_bf16_f32 v120, v128, v129
    v_cvt_pk_bf16_f32 v121, v130, v131
    v_cvt_pk_bf16_f32 v122, v132, v133
    v_cvt_pk_bf16_f32 v123, v134, v135
    v_max3_f32 v230, v56, v57, v58
    v_max3_f32 v230, v230, v59, v60
    v_max3_f32 v230, v230, v61, v62
    v_max_f32 v230, v230, v63
    v_mov_b32 v231, v230
    s_nop 1
    v_permlane16_swap_b32 v230, v231
    s_nop 0
    v_max_f32 v230, v230, v231
    v_mov_b32 v231, v230
    s_nop 1
    v_permlane32_swap_b32 v230, v231
    s_nop 0
    v_max_f32_e64 v230, v230, v231
    v_add_f32 v230, 0x41800000, v230
    v_max_f32 v230, 0, v230
    v_sub_f32 v232, 0, v230
    v_exp_f32 v232, v232
    v_sub_f32 v227, v227, v230
    v_sub_f32 v88, v88, v230
    v_sub_f32 v24, v24, v230
    v_sub_f32 v56, v56, v230
    v_sub_f32 v89, v89, v230
    v_sub_f32 v25, v25, v230
    v_sub_f32 v57, v57, v230
    v_sub_f32 v90, v90, v230
    v_sub_f32 v26, v26, v230
    v_sub_f32 v58, v58, v230
    v_sub_f32 v91, v91, v230
    v_sub_f32 v27, v27, v230
    v_sub_f32 v59, v59, v230
    v_sub_f32 v92, v92, v230
    v_sub_f32 v28, v28, v230
    v_sub_f32 v60, v60, v230
    v_sub_f32 v93, v93, v230
    v_sub_f32 v29, v29, v230
    v_sub_f32 v61, v61, v230
    v_sub_f32 v94, v94, v230
    v_sub_f32 v30, v30, v230
    v_sub_f32 v62, v62, v230
    v_sub_f32 v95, v95, v230
    v_sub_f32 v31, v31, v230
    v_sub_f32 v63, v63, v230
    v_mul_f32 v156, v156, v232
    v_mul_f32 v157, v157, v232
    v_mul_f32 v158, v158, v232
    v_mul_f32 v159, v159, v232
    v_accvgpr_read_b32 v233, a96
    v_mul_f32_e64 v233, v233, v232
    v_accvgpr_write_b32 a96, v233
    v_accvgpr_read_b32 v234, a97
    v_mul_f32_e64 v234, v234, v232
    v_accvgpr_write_b32 a97, v234
    v_accvgpr_read_b32 v235, a98
    v_mul_f32_e64 v235, v235, v232
    v_accvgpr_write_b32 a98, v235
    v_accvgpr_read_b32 v236, a99
    v_mul_f32_e64 v236, v236, v232
    v_accvgpr_write_b32 a99, v236
    v_accvgpr_read_b32 v233, a100
    v_mul_f32_e64 v233, v233, v232
    v_accvgpr_write_b32 a100, v233
    v_accvgpr_read_b32 v234, a101
    v_mul_f32_e64 v234, v234, v232
    v_accvgpr_write_b32 a101, v234
    v_accvgpr_read_b32 v235, a102
    v_mul_f32_e64 v235, v235, v232
    v_accvgpr_write_b32 a102, v235
    v_accvgpr_read_b32 v236, a103
    v_mul_f32_e64 v236, v236, v232
    v_accvgpr_write_b32 a103, v236
    v_accvgpr_read_b32 v233, a104
    v_mul_f32_e64 v233, v233, v232
    v_accvgpr_write_b32 a104, v233
    v_accvgpr_read_b32 v234, a105
    v_mul_f32_e64 v234, v234, v232
    v_accvgpr_write_b32 a105, v234
    v_accvgpr_read_b32 v235, a106
    v_mul_f32_e64 v235, v235, v232
    v_accvgpr_write_b32 a106, v235
    v_accvgpr_read_b32 v236, a107
    v_mul_f32_e64 v236, v236, v232
    v_accvgpr_write_b32 a107, v236
    v_accvgpr_read_b32 v233, a108
    v_mul_f32_e64 v233, v233, v232
    v_accvgpr_write_b32 a108, v233
    v_accvgpr_read_b32 v234, a109
    v_mul_f32_e64 v234, v234, v232
    v_accvgpr_write_b32 a109, v234
    v_accvgpr_read_b32 v235, a110
    v_mul_f32_e64 v235, v235, v232
    v_accvgpr_write_b32 a110, v235
    v_accvgpr_read_b32 v236, a111
    v_mul_f32_e64 v236, v236, v232
    v_accvgpr_write_b32 a111, v236
    v_accvgpr_read_b32 v233, a112
    v_mul_f32_e64 v233, v233, v232
    v_accvgpr_write_b32 a112, v233
    v_accvgpr_read_b32 v234, a113
    v_mul_f32_e64 v234, v234, v232
    v_accvgpr_write_b32 a113, v234
    v_accvgpr_read_b32 v235, a114
    v_mul_f32_e64 v235, v235, v232
    v_accvgpr_write_b32 a114, v235
    v_accvgpr_read_b32 v236, a115
    v_mul_f32_e64 v236, v236, v232
    v_accvgpr_write_b32 a115, v236
    v_accvgpr_read_b32 v233, a116
    v_mul_f32_e64 v233, v233, v232
    v_accvgpr_write_b32 a116, v233
    v_accvgpr_read_b32 v234, a117
    v_mul_f32_e64 v234, v234, v232
    v_accvgpr_write_b32 a117, v234
    v_accvgpr_read_b32 v235, a118
    v_mul_f32_e64 v235, v235, v232
    v_accvgpr_write_b32 a118, v235
    v_accvgpr_read_b32 v236, a119
    v_mul_f32_e64 v236, v236, v232
    v_accvgpr_write_b32 a119, v236
    v_accvgpr_read_b32 v233, a120
    v_mul_f32_e64 v233, v233, v232
    v_accvgpr_write_b32 a120, v233
    v_accvgpr_read_b32 v234, a121
    v_mul_f32_e64 v234, v234, v232
    v_accvgpr_write_b32 a121, v234
    v_accvgpr_read_b32 v235, a122
    v_mul_f32_e64 v235, v235, v232
    v_accvgpr_write_b32 a122, v235
    v_accvgpr_read_b32 v236, a123
    v_mul_f32_e64 v236, v236, v232
    v_accvgpr_write_b32 a123, v236
    v_accvgpr_read_b32 v233, a124
    v_mul_f32_e64 v233, v233, v232
    v_accvgpr_write_b32 a124, v233
    v_accvgpr_read_b32 v234, a125
    v_mul_f32_e64 v234, v234, v232
    v_accvgpr_write_b32 a125, v234
    v_accvgpr_read_b32 v235, a126
    v_mul_f32_e64 v235, v235, v232
    v_accvgpr_write_b32 a126, v235
    v_accvgpr_read_b32 v236, a127
    v_mul_f32_e64 v236, v236, v232
    v_accvgpr_write_b32 a127, v236
    v_exp_f32 v128, v56
    v_exp_f32 v129, v57
    v_exp_f32 v130, v58
    v_exp_f32 v131, v59
    v_exp_f32 v132, v60
    v_exp_f32 v133, v61
    v_exp_f32 v134, v62
    v_exp_f32_e64 v135, v63
    s_nop 0
    v_cvt_pk_bf16_f32 v124, v128, v129
    v_cvt_pk_bf16_f32 v125, v130, v131
    v_cvt_pk_bf16_f32 v126, v132, v133
    v_cvt_pk_bf16_f32 v127, v134, v135
    s_nop 1
    s_branch kf_rr29
kf_spin31:
    s_mov_b32 s25, 0x100000
kf_spin31_l:
    s_sleep 2
    buffer_load_dword v254, off, s[88:91], s97 sc1
    s_waitcnt vmcnt(0)
    v_readfirstlane_b32 s24, v254
    s_sub_u32 s25, s25, 1
    s_cbranch_scc1 kf_spinr32
    s_cmp_ge_u32 s24, 1
    s_cbranch_scc0 kf_spin31_l
    s_branch kf_spinr32
kf_spin33:
    s_mov_b32 s25, 0x100000
kf_spin33_l:
    s_sleep 2
    buffer_load_dword v254, off, s[88:91], s39 sc1
    s_waitcnt vmcnt(0)
    v_readfirstlane_b32 s24, v254
    s_sub_u32 s25, s25, 1
    s_cbranch_scc1 kf_spinr34
    s_cmp_ge_u32 s24, 32
    s_cbranch_scc0 kf_spin33_l
    s_branch kf_spinr34
kf_spin35:
    s_mov_b32 s25, 0x100000
kf_spin35_l:
    s_sleep 2
    buffer_load_dword v254, off, s[88:91], s97 sc1
    s_waitcnt vmcnt(0)
    v_readfirstlane_b32 s24, v254
    s_sub_u32 s25, s25, 1
    s_cbranch_scc1 kf_spinr36
    s_cmp_ge_u32 s24, 1
    s_cbranch_scc0 kf_spin35_l
    s_branch kf_spinr36
kf_spin37:
    s_mov_b32 s25, 0x100000
kf_spin37_l:
    s_sleep 2
    buffer_load_dword v254, off, s[88:91], s39 sc1
    s_waitcnt vmcnt(0)
    v_readfirstlane_b32 s24, v254
    s_sub_u32 s25, s25, 1
    s_cbranch_scc1 kf_spinr38
    s_cmp_ge_u32 s24, 32
    s_cbranch_scc0 kf_spin37_l
    s_branch kf_spinr38
kf_spin39:
    s_mov_b32 s25, 0x100000
kf_spin39_l:
    s_sleep 2
    buffer_load_dword v254, off, s[88:91], s35 sc1
    s_waitcnt vmcnt(0)
    v_readfirstlane_b32 s24, v254
    s_sub_u32 s25, s25, 1
    s_cbranch_scc1 kf_spinr40
    s_cmp_ge_u32 s24, 8
    s_cbranch_scc0 kf_spin39_l
    s_branch kf_spinr40

code_end:
.section .rodata,"a"
.p2align 6
.amdhsa_kernel sequential_preLN__compressed_kv_cla__moe_arch_mod__prompt_kernel
  .amdhsa_next_free_vgpr 512
  .amdhsa_next_free_sgpr 102
  .amdhsa_accum_offset 256
  .amdhsa_group_segment_fixed_size 0
  .amdhsa_kernarg_size 112
  .amdhsa_user_sgpr_count 2
  .amdhsa_user_sgpr_kernarg_segment_ptr 1
  .amdhsa_system_sgpr_workgroup_id_x 1
  .amdhsa_float_denorm_mode_32 3
.end_amdhsa_kernel
```

```asm
; @launch grid=(256,1,1) block=(256,1,1) lds=163840
.amdgcn_target "amdgcn-amd-amdhsa--gfx950"
.text
.globl sequential_preLN__compressed_kv_cla__moe_arch_mod__prompt_kernel
.p2align 8
.type sequential_preLN__compressed_kv_cla__moe_arch_mod__prompt_kernel,@function
sequential_preLN__compressed_kv_cla__moe_arch_mod__prompt_kernel:
    s_cmp_ge_u32 s2, 256
    s_cbranch_scc1 ka_done
    s_load_dwordx8 s[64:71], s[0:1], 0
    s_load_dwordx4 s[72:75], s[0:1], 32
    s_load_dwordx4 s[76:79], s[0:1], 64
    s_load_dwordx8 s[8:15], s[0:1], 80
    v_lshrrev_b32 v1, 6, v0
    v_and_b32 v2, 63, v0
    v_readfirstlane_b32 s3, v1
    v_mov_b32_e64 v253, v0
    s_and_b32 s4, s2, 7
    s_lshl_b32 s4, s4, 2
    s_lshr_b32 s24, s2, 3
    s_and_b32 s24, s24, 3
    s_add_u32 s4, s4, s24
    s_lshr_b32 s5, s2, 5
    s_lshl2_add_u32 s6, s5, s3
    s_getpc_b64 s[56:57]
ka_pc:
    s_mov_b32 s58, hot_end-ka_pc
    s_mov_b32 s59, 0x00020000
    s_lshr_b32 s24, s2, 3
    s_xor_b32 s24, s24, 31
    s_lshl2_add_u32 s24, s24, s3
    s_lshl_b32 s24, s24, 13
    v_lshlrev_b32_e64 v3, 7, v2
    buffer_load_dword v252, v3, s[56:59], s24 offen
    v_mov_b32 v192, v2
    v_lshrrev_b32 v198, 3, v192
    v_and_b32 v199, 7, v192
    s_lshr_b32 s24, s3, 1
    s_lshl_b32 s24, s24, 5
    s_and_b32 s25, s3, 1
    s_lshl_b32 s26, s25, 3
    s_add_u32 s24, s24, s26
    v_add_u32 v194, s24, v198
    v_lshlrev_b32 v194, 10, v194
    v_lshrrev_b32 v195, 1, v198
    v_xor_b32 v195, v199, v195
    v_lshl_add_u32 v232, v195, 4, v194
    v_xor_b32_e64 v195, 4, v195
    v_lshl_add_u32 v233, v195, 4, v194
    v_add_u32 v233, 15360, v233
    s_lshl_b32 s24, s4, 8
    s_lshl_b32 s26, s25, 7
    s_add_u32 s24, s24, s26
    v_lshlrev_b32 v194, 13, v198
    v_add_u32_e64 v194, s24, v194
    v_bfe_u32 v195, v198, 1, 1
    v_xor_b32_e64 v195, v199, v195
    v_lshl_add_u32 v234, v195, 4, v194
    v_xor_b32_e64 v195, 4, v195
    v_lshl_add_u32 v235, v195, 4, v194
    v_add_u32 v235, 64512, v235
    s_lshl_b32 s34, s3, 11
    s_mul_i32 s35, s3, 24576
    s_add_u32 s35, s35, 65536
    s_lshl_b32 s32, s5, 18
    s_and_b32 s7, s4, 3
    s_lshl1_add_u32 s7, s7, s5
    s_add_u32 s80, s7, 0
    s_and_b32 s80, s80, 7
    s_lshl_b32 s80, s80, 7
    s_add_u32 s80, s80, s32
    s_waitcnt lgkmcnt(0)
    s_cmp_lt_u32 s3, 2
    s_cselect_b32 s48, s70, s72
    s_cselect_b32 s49, s71, s73
    s_mov_b32 s50, 0x400000
    s_mov_b32 s51, 0x00020000
    s_mov_b32 s44, s66
    s_mov_b32 s45, s67
    s_mov_b32 s46, 0x200000
    s_mov_b32 s47, 0x00020000
    s_add_u32 m0, s35, 0
    s_and_b32 s33, s80, 1023
    s_lshl_b32 s33, s33, 12
    buffer_load_dwordx4 v234, s[48:51], s33 offen lds
    buffer_load_dwordx4 v235, s[48:51], s33 offen offset:1024 lds
    s_add_u32 m0, s35, 2048
    s_add_u32 s33, s33, 131072
    buffer_load_dwordx4 v234, s[48:51], s33 offen lds
    buffer_load_dwordx4 v235, s[48:51], s33 offen offset:1024 lds
    s_add_u32 m0, s34, 0
    s_add_u32 s37, s80, 0
    buffer_load_dwordx4 v232, s[44:47], s37 offen lds
    buffer_load_dwordx4 v233, s[44:47], s37 offen offset:1024 lds
    s_add_u32 m0, s34, 8192
    s_add_u32 s37, s80, 65536
    buffer_load_dwordx4 v232, s[44:47], s37 offen lds
    buffer_load_dwordx4 v233, s[44:47], s37 offen offset:1024 lds
    s_add_u32 m0, s35, 4096
    s_add_u32 s33, s33, 131072
    buffer_load_dwordx4 v234, s[48:51], s33 offen lds
    buffer_load_dwordx4 v235, s[48:51], s33 offen offset:1024 lds
    s_add_u32 m0, s35, 6144
    s_add_u32 s33, s33, 131072
    buffer_load_dwordx4 v234, s[48:51], s33 offen lds
    buffer_load_dwordx4 v235, s[48:51], s33 offen offset:1024 lds
    s_mov_b32 s52, s64
    s_mov_b32 s53, s65
    s_mov_b32 s54, 0x400000
    s_mov_b32 s55, 0x00020000
    s_add_u32 s16, s14, 0x5c00000
    s_addc_u32 s17, s15, 0
    s_mov_b32 s18, 0x2140000
    s_mov_b32 s19, 0x00020000
    s_add_u32 s56, s14, 0x3800000
    s_addc_u32 s57, s15, 0
    s_mov_b32 s58, 0x6040
    s_mov_b32 s59, 0x00020000
    s_add_u32 s20, s14, 0x2400000
    s_addc_u32 s21, s15, 0
    s_mov_b32 s22, 0x1000000
    s_mov_b32 s23, 0x00020000
    s_mov_b32 s88, s12
    s_mov_b32 s89, s13
    s_mov_b32 s90, 0x100
    s_mov_b32 s91, 0x00020000
    s_cmp_lt_u32 s3, 2
    s_cselect_b32 s60, s8, s74
    s_cselect_b32 s61, s9, s75
    s_mov_b32 s62, 0x800000
    s_cselect_b32 s62, 0x700000, s62
    s_mov_b32 s63, 0x00020000
    s_cselect_b32 s41, s76, s78
    s_cselect_b32 s42, s77, s79
    s_mov_b32 s8, s14
    s_mov_b32 s9, s15
    s_mov_b32 s10, 0x400000
    s_mov_b32 s11, 0x00020000
    s_mov_b32 s12, s68
    s_mov_b32 s13, s69
    s_mov_b32 s14, 0x800000
    s_mov_b32 s15, 0x00020000
    s_add_u32 s81, s7, 1
    s_and_b32 s81, s81, 7
    s_lshl_b32 s81, s81, 7
    s_add_u32 s81, s81, s32
    s_add_u32 s82, s7, 2
    s_and_b32 s82, s82, 7
    s_lshl_b32 s82, s82, 7
    s_add_u32 s82, s82, s32
    s_add_u32 s83, s7, 3
    s_and_b32 s83, s83, 7
    s_lshl_b32 s83, s83, 7
    s_add_u32 s83, s83, s32
    s_add_u32 s84, s7, 4
    s_and_b32 s84, s84, 7
    s_lshl_b32 s84, s84, 7
    s_add_u32 s84, s84, s32
    s_add_u32 s85, s7, 5
    s_and_b32 s85, s85, 7
    s_lshl_b32 s85, s85, 7
    s_add_u32 s85, s85, s32
    s_add_u32 s86, s7, 6
    s_and_b32 s86, s86, 7
    s_lshl_b32 s86, s86, 7
    s_add_u32 s86, s86, s32
    s_add_u32 s87, s7, 7
    s_and_b32 s87, s87, 7
    s_lshl_b32 s87, s87, 7
    s_add_u32 s87, s87, s32
    s_cmp_eq_u32 s2, 200
    s_mov_b32 s97, 0x40000000
    s_cselect_b32 s97, 0xa0000, s97
    s_mov_b32 s58, 0xa5000
    v_lshlrev_b32 v194, 7, v253
    v_mov_b32_e64 v195, 0
    buffer_store_dword v195, v194, s[56:59], s97 offen sc1
    s_cselect_b32 s97, 0, 0x40000000
    s_mov_b32 s58, 0x6040
    v_and_b32 v200, 15, v192
    v_lshrrev_b32 v201, 4, v192
    v_lshrrev_b32 v194, 1, v200
    v_xor_b32 v194, v201, v194
    v_lshlrev_b32 v194, 4, v194
    v_lshl_add_u32 v224, v200, 7, v194
    v_xor_b32 v225, 64, v224
    v_lshrrev_b32 v194, 2, v200
    v_lshl_add_u32 v195, v201, 3, v194
    v_lshlrev_b32 v195, 7, v195
    v_add_u32 v195, s35, v195
    v_and_b32_e64 v196, 1, v200
    v_lshl_add_u32 v195, v196, 3, v195
    v_lshrrev_b32 v194, 1, v194
    v_and_b32 v196, 1, v201
    v_lshl_or_b32 v194, v196, 2, v194
    v_and_b32 v196, 2, v200
    v_xor_b32 v194, v194, v196
    v_xor_b32_e64 v196, 0, v194
    v_lshl_add_u32 v228, v196, 4, v195
    v_xor_b32_e64 v196, 1, v194
    v_lshl_add_u32 v229, v196, 4, v195
    v_xor_b32_e64 v196, 4, v194
    v_lshl_add_u32 v230, v196, 4, v195
    v_xor_b32_e64 v196, 5, v194
    v_lshl_add_u32 v231, v196, 4, v195
    s_mul_i32 s36, s4, 1089536
    s_mul_i32 s24, s5, 136192
    s_add_u32 s36, s36, s24
    s_and_b32 s24, s3, 1
    s_lshl_b32 s24, s24, 12
    s_and_b32 s26, s3, 2
    s_lshl_b32 s26, s26, 13
    s_add_u32 s36, s36, s24
    s_add_u32 s36, s36, s26
    s_lshl_b32 s24, s5, 7
    s_sub_u32 s26, 1792, s24
    s_cmp_lt_u32 s4, 16
    s_cselect_b32 s24, s24, s26
    s_lshl_b32 s26, s4, 3
    s_add_u32 s24, s24, s26
    v_lshrrev_b32 v194, 5, v253
    v_add_u32 v196, s24, v194
    v_and_b32 v195, 31, v192
    v_lshlrev_b32 v196, 11, v196
    v_lshl_add_u32 v236, v195, 4, v196
    v_xor_b32 v194, v194, v199
    v_lshlrev_b32 v194, 4, v194
    v_lshl_add_u32 v194, v195, 7, v194
    v_add_u32 v237, 81920, v194
    s_lshr_b32 s26, s24, 4
    s_lshl_b32 s26, s26, 15
    s_and_b32 s24, s24, 15
    s_lshl_b32 s24, s24, 4
    s_add_u32 s24, s24, s26
    v_lshrrev_b32 v194, 3, v253
    v_lshlrev_b32 v194, 8, v194
    v_xor_b32 v195, v199, v198
    v_lshl_add_u32 v194, v195, 4, v194
    v_add_u32 v238, s24, v194
    v_lshlrev_b32 v240, 4, v192
    s_lshl_b32 s24, s3, 12
    v_add_u32 v242, s24, v240
    s_lshl_b32 s24, s6, 16
    v_add_u32 v248, s24, v240
    s_sub_u32 s25, 63, s6
    s_lshl_b32 s24, s25, 16
    v_add_u32_e64 v249, s24, v240
    v_bfe_u32 v194, v192, 2, 2
    v_lshlrev_b32_e64 v194, 13, v194
    v_lshl_add_u32 v194, v201, 6, v194
    v_and_b32_e64 v195, 3, v192
    v_lshl_add_u32 v194, v195, 4, v194
    s_lshl_b32 s24, s4, 8
    s_lshl_b32 s25, s3, 18
    s_add_u32 s24, s24, s25
    v_add_u32_e64 v245, s24, v194
    s_lshl_b32 s31, s3, 13
    s_add_u32 s31, s31, 65536
    s_lshl_b32 s27, s5, 20
    s_mov_b32 s7, s27
    s_mov_b32 s43, 0x40000000
    s_lshr_b32 s28, s27, 8
    s_add_u32 s29, s28, 32768
    s_nop 0
    v_lshlrev_b32 v194, 11, v201
    v_bfe_u32 v195, v192, 2, 2
    v_lshl_add_u32 v194, v195, 6, v194
    v_bfe_u32 v195, v192, 4, 1
    v_lshl_add_u32 v194, v195, 4, v194
    v_and_b32_e64 v195, 1, v192
    v_lshl_add_u32 v194, v195, 3, v194
    v_bfe_u32 v195, v192, 1, 1
    v_lshl_add_u32 v247, v195, 5, v194
    s_mov_b32 s30, 65536
    v_add_u32 v246, s30, v247
    v_lshrrev_b32 v195, 5, v192
    v_lshlrev_b32 v195, 4, v195
    v_sub_u32 v194, v200, v195
    v_bfe_u32 v195, v192, 4, 1
    v_lshlrev_b32 v195, 2, v195
    v_sub_u32 v194, v194, v195
    v_cvt_f32_i32 v194, v194
    v_add_f32 v194, 0.5, v194
    v_mul_f32 v243, 0x71800000, v194
    v_add_u32 v244, 0x20000, v240
    v_lshlrev_b32 v251, 7, v192
    v_cmp_gt_u32 vcc, 16, v192
    v_mov_b32 v194, 0x40000000
    v_mov_b32 v255, 1
    v_cndmask_b32 v251, v194, v251, vcc
    v_cmp_eq_u32 vcc, 0, v253
    s_nop 1
    v_cndmask_b32 v250, v194, v253, vcc
    s_add_u32 m0, s35, 8192
    s_and_b32 s33, s81, 1023
    s_lshl_b32 s33, s33, 12
    buffer_load_dwordx4 v234, s[48:51], s33 offen lds
    buffer_load_dwordx4 v235, s[48:51], s33 offen offset:1024 lds
    s_add_u32 m0, s35, 10240
    s_add_u32 s33, s33, 131072
    buffer_load_dwordx4 v234, s[48:51], s33 offen lds
    buffer_load_dwordx4 v235, s[48:51], s33 offen offset:1024 lds
    s_add_u32 m0, s35, 12288
    s_add_u32 s33, s33, 131072
    buffer_load_dwordx4 v234, s[48:51], s33 offen lds
    buffer_load_dwordx4 v235, s[48:51], s33 offen offset:1024 lds
    s_add_u32 m0, s35, 14336
    s_add_u32 s33, s33, 131072
    buffer_load_dwordx4 v234, s[48:51], s33 offen lds
    buffer_load_dwordx4 v235, s[48:51], s33 offen offset:1024 lds
    s_add_u32 m0, s34, 16384
    s_add_u32 s37, s81, 0
    buffer_load_dwordx4 v232, s[44:47], s37 offen lds
    buffer_load_dwordx4 v233, s[44:47], s37 offen offset:1024 lds
    s_add_u32 m0, s34, 24576
    s_add_u32 s37, s81, 65536
    buffer_load_dwordx4 v232, s[44:47], s37 offen lds
    buffer_load_dwordx4 v233, s[44:47], s37 offen offset:1024 lds
    s_waitcnt vmcnt(19)
    s_barrier
    ds_read_b128 v[64:67], v224 offset:0
    ds_read_b128 v[68:71], v224 offset:2048
    ds_read_b128 v[72:75], v224 offset:4096
    ds_read_b128 v[76:79], v224 offset:6144
    ds_read_b64_tr_b16 a[0:1], v228 offset:0
    ds_read_b64_tr_b16 a[2:3], v228 offset:512
    ds_read_b64_tr_b16 a[4:5], v229 offset:0
    ds_read_b64_tr_b16 a[6:7], v229 offset:512
    ds_read_b64_tr_b16 a[8:9], v230 offset:0
    ds_read_b64_tr_b16 a[10:11], v230 offset:512
    ds_read_b64_tr_b16 a[12:13], v231 offset:0
    ds_read_b64_tr_b16 a[14:15], v231 offset:512
    s_waitcnt vmcnt(12)
    s_barrier
    buffer_store_dword v255, v250, s[88:91], s97 offen sc1
    s_cmp_eq_u32 s3, 0
    s_cselect_b32 s97, 0, s43
    s_cmp_lt_u32 s3, 2
    s_cbranch_scc0 ka_V
    s_waitcnt lgkmcnt(0)
    v_mfma_f32_16x16x32_bf16 v[96:99], a[0:3], v[64:67], 0
    ds_read_b128 v[80:83], v224 offset:8192
    v_mfma_f32_16x16x32_bf16 v[100:103], a[4:7], v[64:67], 0
    ds_read_b128 v[84:87], v224 offset:10240
    v_mfma_f32_16x16x32_bf16 v[104:107], a[8:11], v[64:67], 0
    ds_read_b128 v[88:91], v224 offset:12288
    v_mfma_f32_16x16x32_bf16 v[108:111], a[12:15], v[64:67], 0
    ds_read_b128 v[92:95], v224 offset:14336
    v_mfma_f32_16x16x32_bf16 v[112:115], a[0:3], v[68:71], 0
    ds_read_b64_tr_b16 a[16:17], v228 offset:4096
    v_mfma_f32_16x16x32_bf16 v[116:119], a[4:7], v[68:71], 0
    ds_read_b64_tr_b16 a[18:19], v228 offset:4608
    v_mfma_f32_16x16x32_bf16 v[120:123], a[8:11], v[68:71], 0
    ds_read_b64_tr_b16 a[20:21], v229 offset:4096
    v_mfma_f32_16x16x32_bf16 v[124:127], a[12:15], v[68:71], 0
    ds_read_b64_tr_b16 a[22:23], v229 offset:4608
    v_mfma_f32_16x16x32_bf16 v[128:131], a[0:3], v[72:75], 0
    s_add_u32 m0, s35, 16384
    s_and_b32 s33, s82, 1023
    s_lshl_b32 s33, s33, 12
    buffer_load_dwordx4 v234, s[48:51], s33 offen lds
    v_mfma_f32_16x16x32_bf16 v[132:135], a[4:7], v[72:75], 0
    v_mfma_f32_16x16x32_bf16 v[136:139], a[8:11], v[72:75], 0
    buffer_load_dwordx4 v235, s[48:51], s33 offen offset:1024 lds
    v_mfma_f32_16x16x32_bf16 v[140:143], a[12:15], v[72:75], 0
    v_mfma_f32_16x16x32_bf16 v[144:147], a[0:3], v[76:79], 0
    s_add_u32 m0, s35, 18432
    s_add_u32 s33, s33, 131072
    buffer_load_dwordx4 v234, s[48:51], s33 offen lds
    v_mfma_f32_16x16x32_bf16 v[148:151], a[4:7], v[76:79], 0
    v_mfma_f32_16x16x32_bf16 v[152:155], a[8:11], v[76:79], 0
    buffer_load_dwordx4 v235, s[48:51], s33 offen offset:1024 lds
    v_mfma_f32_16x16x32_bf16 v[156:159], a[12:15], v[76:79], 0
    s_waitcnt lgkmcnt(0)
    v_mfma_f32_16x16x32_bf16 v[160:163], a[0:3], v[80:83], 0
    ds_read_b128 v[64:67], v225 offset:0
    v_mfma_f32_16x16x32_bf16 v[164:167], a[4:7], v[80:83], 0
    ds_read_b128 v[68:71], v225 offset:2048
    v_mfma_f32_16x16x32_bf16 v[168:171], a[8:11], v[80:83], 0
    ds_read_b128 v[72:75], v225 offset:4096
    v_mfma_f32_16x16x32_bf16 v[172:175], a[12:15], v[80:83], 0
    ds_read_b128 v[76:79], v225 offset:6144
    v_mfma_f32_16x16x32_bf16 v[176:179], a[0:3], v[84:87], 0
    ds_read_b64_tr_b16 a[24:25], v230 offset:4096
    v_mfma_f32_16x16x32_bf16 v[180:183], a[4:7], v[84:87], 0
    ds_read_b64_tr_b16 a[26:27], v230 offset:4608
    v_mfma_f32_16x16x32_bf16 v[184:187], a[8:11], v[84:87], 0
    ds_read_b64_tr_b16 a[28:29], v231 offset:4096
    v_mfma_f32_16x16x32_bf16 v[188:191], a[12:15], v[84:87], 0
    ds_read_b64_tr_b16 a[30:31], v231 offset:4608
    v_mfma_f32_16x16x32_bf16 v[192:195], a[0:3], v[88:91], 0
    s_add_u32 m0, s35, 20480
    s_add_u32 s33, s33, 131072
    buffer_load_dwordx4 v234, s[48:51], s33 offen lds
    v_mfma_f32_16x16x32_bf16 v[196:199], a[4:7], v[88:91], 0
    v_mfma_f32_16x16x32_bf16 v[200:203], a[8:11], v[88:91], 0
    buffer_load_dwordx4 v235, s[48:51], s33 offen offset:1024 lds
    v_mfma_f32_16x16x32_bf16 v[204:207], a[12:15], v[88:91], 0
    v_mfma_f32_16x16x32_bf16 v[208:211], a[0:3], v[92:95], 0
    s_add_u32 m0, s35, 22528
    s_add_u32 s33, s33, 131072
    buffer_load_dwordx4 v234, s[48:51], s33 offen lds
    v_mfma_f32_16x16x32_bf16 v[212:215], a[4:7], v[92:95], 0
    v_mfma_f32_16x16x32_bf16 v[216:219], a[8:11], v[92:95], 0
    buffer_load_dwordx4 v235, s[48:51], s33 offen offset:1024 lds
    v_mfma_f32_16x16x32_bf16 v[220:223], a[12:15], v[92:95], 0
    s_waitcnt vmcnt(13) lgkmcnt(0)
    v_mfma_f32_16x16x32_bf16 v[96:99], a[16:19], v[64:67], v[96:99]
    ds_read_b128 v[80:83], v225 offset:8192
    v_mfma_f32_16x16x32_bf16 v[100:103], a[20:23], v[64:67], v[100:103]
    ds_read_b128 v[84:87], v225 offset:10240
    v_mfma_f32_16x16x32_bf16 v[104:107], a[24:27], v[64:67], v[104:107]
    ds_read_b128 v[88:91], v225 offset:12288
    v_mfma_f32_16x16x32_bf16 v[108:111], a[28:31], v[64:67], v[108:111]
    ds_read_b128 v[92:95], v225 offset:14336
    v_mfma_f32_16x16x32_bf16 v[112:115], a[16:19], v[68:71], v[112:115]
    ds_read_b64_tr_b16 a[32:33], v228 offset:8192
    v_mfma_f32_16x16x32_bf16 v[116:119], a[20:23], v[68:71], v[116:119]
    ds_read_b64_tr_b16 a[34:35], v228 offset:8704
    v_mfma_f32_16x16x32_bf16 v[120:123], a[24:27], v[68:71], v[120:123]
    ds_read_b64_tr_b16 a[36:37], v229 offset:8192
    v_mfma_f32_16x16x32_bf16 v[124:127], a[28:31], v[68:71], v[124:127]
    ds_read_b64_tr_b16 a[38:39], v229 offset:8704
    v_mfma_f32_16x16x32_bf16 v[128:131], a[16:19], v[72:75], v[128:131]
    ds_read_b64_tr_b16 a[40:41], v230 offset:8192
    s_add_u32 m0, s34, 32768
    s_add_u32 s37, s82, 0
    buffer_load_dwordx4 v232, s[44:47], s37 offen lds
    v_mfma_f32_16x16x32_bf16 v[132:135], a[20:23], v[72:75], v[132:135]
    ds_read_b64_tr_b16 a[42:43], v230 offset:8704
    buffer_load_dwordx4 v233, s[44:47], s37 offen offset:1024 lds
    v_mfma_f32_16x16x32_bf16 v[136:139], a[24:27], v[72:75], v[136:139]
    ds_read_b64_tr_b16 a[44:45], v231 offset:8192
    s_add_u32 m0, s34, 40960
    s_add_u32 s37, s82, 65536
    buffer_load_dwordx4 v232, s[44:47], s37 offen lds
    v_mfma_f32_16x16x32_bf16 v[140:143], a[28:31], v[72:75], v[140:143]
    ds_read_b64_tr_b16 a[46:47], v231 offset:8704
    buffer_load_dwordx4 v233, s[44:47], s37 offen offset:1024 lds
    v_mfma_f32_16x16x32_bf16 v[144:147], a[16:19], v[76:79], v[144:147]
    s_add_u32 m0, s35, 0
    s_and_b32 s33, s83, 1023
    s_lshl_b32 s33, s33, 12
    buffer_load_dwordx4 v234, s[48:51], s33 offen lds
    v_mfma_f32_16x16x32_bf16 v[148:151], a[20:23], v[76:79], v[148:151]
    buffer_load_dwordx4 v235, s[48:51], s33 offen offset:1024 lds
    v_mfma_f32_16x16x32_bf16 v[152:155], a[24:27], v[76:79], v[152:155]
    s_add_u32 m0, s35, 2048
    s_add_u32 s33, s33, 131072
    buffer_load_dwordx4 v234, s[48:51], s33 offen lds
    v_mfma_f32_16x16x32_bf16 v[156:159], a[28:31], v[76:79], v[156:159]
    buffer_load_dwordx4 v235, s[48:51], s33 offen offset:1024 lds
    s_waitcnt vmcnt(17) lgkmcnt(0)
    s_barrier
    v_mfma_f32_16x16x32_bf16 v[160:163], a[16:19], v[80:83], v[160:163]
    ds_read_b128 v[64:67], v224 offset:16384
    v_mfma_f32_16x16x32_bf16 v[164:167], a[20:23], v[80:83], v[164:167]
    ds_read_b128 v[68:71], v225 offset:16384
    v_mfma_f32_16x16x32_bf16 v[168:171], a[24:27], v[80:83], v[168:171]
    ds_read_b128 v[72:75], v224 offset:18432
    v_mfma_f32_16x16x32_bf16 v[172:175], a[28:31], v[80:83], v[172:175]
    ds_read_b128 v[76:79], v225 offset:18432
    v_mfma_f32_16x16x32_bf16 v[176:179], a[16:19], v[84:87], v[176:179]
    ds_read_b64_tr_b16 a[48:49], v228 offset:12288
    s_add_u32 m0, s34, 49152
    s_add_u32 s37, s83, 0
    buffer_load_dwordx4 v232, s[44:47], s37 offen lds
    v_mfma_f32_16x16x32_bf16 v[180:183], a[20:23], v[84:87], v[180:183]
    ds_read_b64_tr_b16 a[50:51], v228 offset:12800
    buffer_load_dwordx4 v233, s[44:47], s37 offen offset:1024 lds
    v_mfma_f32_16x16x32_bf16 v[184:187], a[24:27], v[84:87], v[184:187]
    ds_read_b64_tr_b16 a[52:53], v229 offset:12288
    s_add_u32 m0, s34, 57344
    s_add_u32 s37, s83, 65536
    buffer_load_dwordx4 v232, s[44:47], s37 offen lds
    v_mfma_f32_16x16x32_bf16 v[188:191], a[28:31], v[84:87], v[188:191]
    ds_read_b64_tr_b16 a[54:55], v229 offset:12800
    buffer_load_dwordx4 v233, s[44:47], s37 offen offset:1024 lds
    v_mfma_f32_16x16x32_bf16 v[192:195], a[16:19], v[88:91], v[192:195]
    ds_read_b64_tr_b16 a[56:57], v230 offset:12288
    s_add_u32 m0, s34, 0
    s_add_u32 s37, s84, 0
    buffer_load_dwordx4 v232, s[44:47], s37 offen lds
    v_mfma_f32_16x16x32_bf16 v[196:199], a[20:23], v[88:91], v[196:199]
    ds_read_b64_tr_b16 a[58:59], v230 offset:12800
    v_mfma_f32_16x16x32_bf16 v[200:203], a[24:27], v[88:91], v[200:203]
    ds_read_b64_tr_b16 a[60:61], v231 offset:12288
    buffer_load_dwordx4 v233, s[44:47], s37 offen offset:1024 lds
    v_mfma_f32_16x16x32_bf16 v[204:207], a[28:31], v[88:91], v[204:207]
    ds_read_b64_tr_b16 a[62:63], v231 offset:12800
    buffer_load_dwordx4 v[0:3], v236, s[52:55], 0 offen offset:0
    v_mfma_f32_16x16x32_bf16 v[208:211], a[16:19], v[92:95], v[208:211]
    buffer_load_dwordx4 v[4:7], v236, s[52:55], 0 offen offset:512
    v_mfma_f32_16x16x32_bf16 v[212:215], a[20:23], v[92:95], v[212:215]
    buffer_load_dwordx4 v[8:11], v236, s[52:55], 0 offen offset:1024
    v_mfma_f32_16x16x32_bf16 v[216:219], a[24:27], v[92:95], v[216:219]
    buffer_load_dwordx4 v[12:15], v236, s[52:55], 0 offen offset:1536
    v_mfma_f32_16x16x32_bf16 v[220:223], a[28:31], v[92:95], v[220:223]
    s_waitcnt lgkmcnt(0)
    v_mfma_f32_16x16x32_bf16 v[96:99], a[32:35], v[64:67], v[96:99]
    ds_read_b128 v[80:83], v224 offset:20480
    v_mfma_f32_16x16x32_bf16 v[96:99], a[48:51], v[68:71], v[96:99]
    ds_read_b128 v[84:87], v225 offset:20480
    v_mfma_f32_16x16x32_bf16 v[100:103], a[36:39], v[64:67], v[100:103]
    ds_read_b128 v[88:91], v224 offset:22528
    v_mfma_f32_16x16x32_bf16 v[100:103], a[52:55], v[68:71], v[100:103]
    ds_read_b128 v[92:95], v225 offset:22528
    v_mfma_f32_16x16x32_bf16 v[104:107], a[40:43], v[64:67], v[104:107]
    v_mfma_f32_16x16x32_bf16 v[104:107], a[56:59], v[68:71], v[104:107]
    v_mfma_f32_16x16x32_bf16 v[108:111], a[44:47], v[64:67], v[108:111]
    v_mfma_f32_16x16x32_bf16 v[108:111], a[60:63], v[68:71], v[108:111]
    v_mfma_f32_16x16x32_bf16 v[112:115], a[32:35], v[72:75], v[112:115]
    s_add_u32 m0, s35, 4096
    s_add_u32 s33, s33, 131072
    buffer_load_dwordx4 v234, s[48:51], s33 offen lds
    v_mfma_f32_16x16x32_bf16 v[112:115], a[48:51], v[76:79], v[112:115]
    v_mfma_f32_16x16x32_bf16 v[116:119], a[36:39], v[72:75], v[116:119]
    buffer_load_dwordx4 v235, s[48:51], s33 offen offset:1024 lds
    v_mfma_f32_16x16x32_bf16 v[116:119], a[52:55], v[76:79], v[116:119]
    v_mfma_f32_16x16x32_bf16 v[120:123], a[40:43], v[72:75], v[120:123]
    s_add_u32 m0, s35, 6144
    s_add_u32 s33, s33, 131072
    buffer_load_dwordx4 v234, s[48:51], s33 offen lds
    v_mfma_f32_16x16x32_bf16 v[120:123], a[56:59], v[76:79], v[120:123]
    v_mfma_f32_16x16x32_bf16 v[124:127], a[44:47], v[72:75], v[124:127]
    buffer_load_dwordx4 v235, s[48:51], s33 offen offset:1024 lds
    v_mfma_f32_16x16x32_bf16 v[124:127], a[60:63], v[76:79], v[124:127]
    s_waitcnt lgkmcnt(0)
    v_mfma_f32_16x16x32_bf16 v[128:131], a[32:35], v[80:83], v[128:131]
    ds_read_b128 v[64:67], v224 offset:24576
    v_mfma_f32_16x16x32_bf16 v[128:131], a[48:51], v[84:87], v[128:131]
    ds_read_b128 v[68:71], v225 offset:24576
    v_mfma_f32_16x16x32_bf16 v[132:135], a[36:39], v[80:83], v[132:135]
    ds_read_b128 v[72:75], v224 offset:26624
    v_mfma_f32_16x16x32_bf16 v[132:135], a[52:55], v[84:87], v[132:135]
    ds_read_b128 v[76:79], v225 offset:26624
    v_mfma_f32_16x16x32_bf16 v[136:139], a[40:43], v[80:83], v[136:139]
    v_mfma_f32_16x16x32_bf16 v[136:139], a[56:59], v[84:87], v[136:139]
    v_mfma_f32_16x16x32_bf16 v[140:143], a[44:47], v[80:83], v[140:143]
    v_mfma_f32_16x16x32_bf16 v[140:143], a[60:63], v[84:87], v[140:143]
    v_mfma_f32_16x16x32_bf16 v[144:147], a[32:35], v[88:91], v[144:147]
    s_add_u32 m0, s34, 8192
    s_add_u32 s37, s84, 65536
    buffer_load_dwordx4 v232, s[44:47], s37 offen lds
    v_mfma_f32_16x16x32_bf16 v[144:147], a[48:51], v[92:95], v[144:147]
    v_mfma_f32_16x16x32_bf16 v[148:151], a[36:39], v[88:91], v[148:151]
    v_mfma_f32_16x16x32_bf16 v[148:151], a[52:55], v[92:95], v[148:151]
    v_mfma_f32_16x16x32_bf16 v[152:155], a[40:43], v[88:91], v[152:155]
    buffer_load_dwordx4 v233, s[44:47], s37 offen offset:1024 lds
    v_mfma_f32_16x16x32_bf16 v[152:155], a[56:59], v[92:95], v[152:155]
    v_mfma_f32_16x16x32_bf16 v[156:159], a[44:47], v[88:91], v[156:159]
    v_mfma_f32_16x16x32_bf16 v[156:159], a[60:63], v[92:95], v[156:159]
    s_waitcnt vmcnt(24) lgkmcnt(0)
    v_mfma_f32_16x16x32_bf16 v[160:163], a[32:35], v[64:67], v[160:163]
    ds_read_b128 v[80:83], v224 offset:28672
    v_mfma_f32_16x16x32_bf16 v[160:163], a[48:51], v[68:71], v[160:163]
    ds_read_b128 v[84:87], v225 offset:28672
    v_mfma_f32_16x16x32_bf16 v[164:167], a[36:39], v[64:67], v[164:167]
    ds_read_b128 v[88:91], v224 offset:30720
    v_mfma_f32_16x16x32_bf16 v[164:167], a[52:55], v[68:71], v[164:167]
    ds_read_b128 v[92:95], v225 offset:30720
    v_mfma_f32_16x16x32_bf16 v[168:171], a[40:43], v[64:67], v[168:171]
    ds_read_b64_tr_b16 a[64:65], v228 offset:16384
    v_mfma_f32_16x16x32_bf16 v[168:171], a[56:59], v[68:71], v[168:171]
    ds_read_b64_tr_b16 a[66:67], v228 offset:16896
    v_mfma_f32_16x16x32_bf16 v[172:175], a[44:47], v[64:67], v[172:175]
    ds_read_b64_tr_b16 a[68:69], v229 offset:16384
    v_mfma_f32_16x16x32_bf16 v[172:175], a[60:63], v[68:71], v[172:175]
    ds_read_b64_tr_b16 a[70:71], v229 offset:16896
    v_mfma_f32_16x16x32_bf16 v[176:179], a[32:35], v[72:75], v[176:179]
    ds_read_b64_tr_b16 a[72:73], v230 offset:16384
    s_add_u32 m0, s35, 8192
    s_and_b32 s33, s84, 1023
    s_lshl_b32 s33, s33, 12
    buffer_load_dwordx4 v234, s[48:51], s33 offen lds
    v_mfma_f32_16x16x32_bf16 v[176:179], a[48:51], v[76:79], v[176:179]
    ds_read_b64_tr_b16 a[74:75], v230 offset:16896
    v_mfma_f32_16x16x32_bf16 v[180:183], a[36:39], v[72:75], v[180:183]
    ds_read_b64_tr_b16 a[76:77], v231 offset:16384
    buffer_load_dwordx4 v235, s[48:51], s33 offen offset:1024 lds
    v_mfma_f32_16x16x32_bf16 v[180:183], a[52:55], v[76:79], v[180:183]
    ds_read_b64_tr_b16 a[78:79], v231 offset:16896
    v_mfma_f32_16x16x32_bf16 v[184:187], a[40:43], v[72:75], v[184:187]
    s_add_u32 m0, s35, 10240
    s_add_u32 s33, s33, 131072
    buffer_load_dwordx4 v234, s[48:51], s33 offen lds
    v_mfma_f32_16x16x32_bf16 v[184:187], a[56:59], v[76:79], v[184:187]
    v_mfma_f32_16x16x32_bf16 v[188:191], a[44:47], v[72:75], v[188:191]
    buffer_load_dwordx4 v235, s[48:51], s33 offen offset:1024 lds
    v_mfma_f32_16x16x32_bf16 v[188:191], a[60:63], v[76:79], v[188:191]
    s_waitcnt vmcnt(24) lgkmcnt(0)
    s_barrier
    v_mfma_f32_16x16x32_bf16 v[192:195], a[32:35], v[80:83], v[192:195]
    ds_read_b128 v[64:67], v224 offset:32768
    v_mfma_f32_16x16x32_bf16 v[192:195], a[48:51], v[84:87], v[192:195]
    ds_read_b128 v[68:71], v225 offset:32768
    v_mfma_f32_16x16x32_bf16 v[196:199], a[36:39], v[80:83], v[196:199]
    ds_read_b128 v[72:75], v224 offset:34816
    v_mfma_f32_16x16x32_bf16 v[196:199], a[52:55], v[84:87], v[196:199]
    ds_read_b128 v[76:79], v225 offset:34816
    v_mfma_f32_16x16x32_bf16 v[200:203], a[40:43], v[80:83], v[200:203]
    ds_read_b64_tr_b16 a[80:81], v228 offset:20480
    v_mfma_f32_16x16x32_bf16 v[200:203], a[56:59], v[84:87], v[200:203]
    ds_read_b64_tr_b16 a[82:83], v228 offset:20992
    v_mfma_f32_16x16x32_bf16 v[204:207], a[44:47], v[80:83], v[204:207]
    ds_read_b64_tr_b16 a[84:85], v229 offset:20480
    v_mfma_f32_16x16x32_bf16 v[204:207], a[60:63], v[84:87], v[204:207]
    ds_read_b64_tr_b16 a[86:87], v229 offset:20992
    v_mfma_f32_16x16x32_bf16 v[208:211], a[32:35], v[88:91], v[208:211]
    ds_read_b64_tr_b16 a[88:89], v230 offset:20480
    s_add_u32 m0, s34, 16384
    s_add_u32 s37, s85, 0
    buffer_load_dwordx4 v232, s[44:47], s37 offen lds
    v_mfma_f32_16x16x32_bf16 v[208:211], a[48:51], v[92:95], v[208:211]
    ds_read_b64_tr_b16 a[90:91], v230 offset:20992
    v_mfma_f32_16x16x32_bf16 v[212:215], a[36:39], v[88:91], v[212:215]
    ds_read_b64_tr_b16 a[92:93], v231 offset:20480
    v_mfma_f32_16x16x32_bf16 v[212:215], a[52:55], v[92:95], v[212:215]
    ds_read_b64_tr_b16 a[94:95], v231 offset:20992
    v_mfma_f32_16x16x32_bf16 v[216:219], a[40:43], v[88:91], v[216:219]
    buffer_load_dwordx4 v233, s[44:47], s37 offen offset:1024 lds
    v_mfma_f32_16x16x32_bf16 v[216:219], a[56:59], v[92:95], v[216:219]
    v_mfma_f32_16x16x32_bf16 v[220:223], a[44:47], v[88:91], v[220:223]
    v_mfma_f32_16x16x32_bf16 v[220:223], a[60:63], v[92:95], v[220:223]
    s_waitcnt lgkmcnt(0)
    v_mfma_f32_16x16x32_bf16 v[96:99], a[64:67], v[64:67], v[96:99]
    ds_read_b128 v[80:83], v224 offset:36864
    v_mfma_f32_16x16x32_bf16 v[96:99], a[80:83], v[68:71], v[96:99]
    ds_read_b128 v[84:87], v225 offset:36864
    v_mfma_f32_16x16x32_bf16 v[100:103], a[68:71], v[64:67], v[100:103]
    ds_read_b128 v[88:91], v224 offset:38912
    v_mfma_f32_16x16x32_bf16 v[100:103], a[84:87], v[68:71], v[100:103]
    ds_read_b128 v[92:95], v225 offset:38912
    v_mfma_f32_16x16x32_bf16 v[104:107], a[72:75], v[64:67], v[104:107]
    v_mfma_f32_16x16x32_bf16 v[104:107], a[88:91], v[68:71], v[104:107]
    v_mfma_f32_16x16x32_bf16 v[108:111], a[76:79], v[64:67], v[108:111]
    v_mfma_f32_16x16x32_bf16 v[108:111], a[92:95], v[68:71], v[108:111]
    v_mfma_f32_16x16x32_bf16 v[112:115], a[64:67], v[72:75], v[112:115]
    s_add_u32 m0, s35, 12288
    s_add_u32 s33, s33, 131072
    buffer_load_dwordx4 v234, s[48:51], s33 offen lds
    v_mfma_f32_16x16x32_bf16 v[112:115], a[80:83], v[76:79], v[112:115]
    v_mfma_f32_16x16x32_bf16 v[116:119], a[68:71], v[72:75], v[116:119]
    buffer_load_dwordx4 v235, s[48:51], s33 offen offset:1024 lds
    v_mfma_f32_16x16x32_bf16 v[116:119], a[84:87], v[76:79], v[116:119]
    v_mfma_f32_16x16x32_bf16 v[120:123], a[72:75], v[72:75], v[120:123]
    s_add_u32 m0, s35, 14336
    s_add_u32 s33, s33, 131072
    buffer_load_dwordx4 v234, s[48:51], s33 offen lds
    v_mfma_f32_16x16x32_bf16 v[120:123], a[88:91], v[76:79], v[120:123]
    v_mfma_f32_16x16x32_bf16 v[124:127], a[76:79], v[72:75], v[124:127]
    buffer_load_dwordx4 v235, s[48:51], s33 offen offset:1024 lds
    v_mfma_f32_16x16x32_bf16 v[124:127], a[92:95], v[76:79], v[124:127]
    s_waitcnt lgkmcnt(0)
    v_mfma_f32_16x16x32_bf16 v[128:131], a[64:67], v[80:83], v[128:131]
    ds_read_b128 v[64:67], v224 offset:40960
    v_mfma_f32_16x16x32_bf16 v[128:131], a[80:83], v[84:87], v[128:131]
    ds_read_b128 v[68:71], v225 offset:40960
    v_mfma_f32_16x16x32_bf16 v[132:135], a[68:71], v[80:83], v[132:135]
    ds_read_b128 v[72:75], v224 offset:43008
    v_mfma_f32_16x16x32_bf16 v[132:135], a[84:87], v[84:87], v[132:135]
    ds_read_b128 v[76:79], v225 offset:43008
    v_mfma_f32_16x16x32_bf16 v[136:139], a[72:75], v[80:83], v[136:139]
    v_mfma_f32_16x16x32_bf16 v[136:139], a[88:91], v[84:87], v[136:139]
    v_mfma_f32_16x16x32_bf16 v[140:143], a[76:79], v[80:83], v[140:143]
    v_mfma_f32_16x16x32_bf16 v[140:143], a[92:95], v[84:87], v[140:143]
    v_mfma_f32_16x16x32_bf16 v[144:147], a[64:67], v[88:91], v[144:147]
    s_add_u32 m0, s34, 24576
    s_add_u32 s37, s85, 65536
    buffer_load_dwordx4 v232, s[44:47], s37 offen lds
    v_mfma_f32_16x16x32_bf16 v[144:147], a[80:83], v[92:95], v[144:147]
    v_mfma_f32_16x16x32_bf16 v[148:151], a[68:71], v[88:91], v[148:151]
    v_mfma_f32_16x16x32_bf16 v[148:151], a[84:87], v[92:95], v[148:151]
    v_mfma_f32_16x16x32_bf16 v[152:155], a[72:75], v[88:91], v[152:155]
    buffer_load_dwordx4 v233, s[44:47], s37 offen offset:1024 lds
    v_mfma_f32_16x16x32_bf16 v[152:155], a[88:91], v[92:95], v[152:155]
    v_mfma_f32_16x16x32_bf16 v[156:159], a[76:79], v[88:91], v[156:159]
    v_mfma_f32_16x16x32_bf16 v[156:159], a[92:95], v[92:95], v[156:159]
    s_waitcnt vmcnt(14) lgkmcnt(0)
    v_mfma_f32_16x16x32_bf16 v[160:163], a[64:67], v[64:67], v[160:163]
    ds_read_b128 v[80:83], v224 offset:45056
    s_waitcnt vmcnt(18)
    v_mfma_f32_16x16x32_bf16 v[160:163], a[80:83], v[68:71], v[160:163]
    ds_read_b128 v[84:87], v225 offset:45056
    v_lshlrev_b32 v16, 16, v0
    v_mfma_f32_16x16x32_bf16 v[164:167], a[68:71], v[64:67], v[164:167]
    ds_read_b128 v[88:91], v224 offset:47104
    v_and_b32 v17, 0xffff0000, v0
    v_lshlrev_b32_e64 v18, 16, v1
    v_mfma_f32_16x16x32_bf16 v[164:167], a[84:87], v[68:71], v[164:167]
    ds_read_b128 v[92:95], v225 offset:47104
    v_and_b32 v19, 0xffff0000, v1
    v_mfma_f32_16x16x32_bf16 v[168:171], a[72:75], v[64:67], v[168:171]
    ds_read_b64_tr_b16 a[96:97], v228 offset:0
    v_lshlrev_b32_e64 v20, 16, v2
    v_mfma_f32_16x16x32_bf16 v[168:171], a[88:91], v[68:71], v[168:171]
    ds_read_b64_tr_b16 a[98:99], v228 offset:512
    v_and_b32 v21, 0xffff0000, v2
    v_mfma_f32_16x16x32_bf16 v[172:175], a[76:79], v[64:67], v[172:175]
    ds_read_b64_tr_b16 a[100:101], v229 offset:0
    v_lshlrev_b32_e64 v22, 16, v3
    v_mfma_f32_16x16x32_bf16 v[172:175], a[92:95], v[68:71], v[172:175]
    ds_read_b64_tr_b16 a[102:103], v229 offset:512
    v_and_b32 v23, 0xffff0000, v3
    v_mfma_f32_16x16x32_bf16 v[176:179], a[64:67], v[72:75], v[176:179]
    ds_read_b64_tr_b16 a[104:105], v230 offset:0
    s_add_u32 m0, s35, 16384
    s_and_b32 s33, s85, 1023
    s_lshl_b32 s33, s33, 12
    buffer_load_dwordx4 v234, s[48:51], s33 offen lds
    v_mfma_f32_16x16x32_bf16 v[176:179], a[80:83], v[76:79], v[176:179]
    ds_read_b64_tr_b16 a[106:107], v230 offset:512
    buffer_load_dwordx4 v235, s[48:51], s33 offen offset:1024 lds
    v_mfma_f32_16x16x32_bf16 v[180:183], a[68:71], v[72:75], v[180:183]
    ds_read_b64_tr_b16 a[108:109], v231 offset:0
    s_add_u32 m0, s35, 18432
    s_add_u32 s33, s33, 131072
    buffer_load_dwordx4 v234, s[48:51], s33 offen lds
    v_mfma_f32_16x16x32_bf16 v[180:183], a[84:87], v[76:79], v[180:183]
    ds_read_b64_tr_b16 a[110:111], v231 offset:512
    v_lshlrev_b32 v24, 16, v4
    v_and_b32 v25, 0xffff0000, v4
    v_mfma_f32_16x16x32_bf16 v[184:187], a[72:75], v[72:75], v[184:187]
    buffer_load_dwordx4 v235, s[48:51], s33 offen offset:1024 lds
    v_lshlrev_b32_e64 v26, 16, v5
    v_mfma_f32_16x16x32_bf16 v[184:187], a[88:91], v[76:79], v[184:187]
    s_lshl2_add_u32 s26, s4, s3
    s_lshl_b32 s26, s26, 10
    s_add_u32 s26, s26, s32
    s_add_u32 s26, s26, 131072
    v_mfma_f32_16x16x32_bf16 v[188:191], a[76:79], v[72:75], v[188:191]
    v_and_b32 v226, 0x40000380, v251
    buffer_load_dword v241, v226, s[44:47], s26 offen
    v_mfma_f32_16x16x32_bf16 v[188:191], a[92:95], v[76:79], v[188:191]
    s_waitcnt vmcnt(29) lgkmcnt(0)
    s_barrier
    v_mfma_f32_16x16x32_bf16 v[192:195], a[64:67], v[80:83], v[192:195]
    ds_read_b128 v[64:67], v224 offset:49152
    v_and_b32 v27, 0xffff0000, v5
    v_mfma_f32_16x16x32_bf16 v[192:195], a[80:83], v[84:87], v[192:195]
    ds_read_b128 v[68:71], v225 offset:49152
    v_lshlrev_b32 v28, 16, v6
    v_mfma_f32_16x16x32_bf16 v[196:199], a[68:71], v[80:83], v[196:199]
    ds_read_b128 v[72:75], v224 offset:51200
    v_and_b32 v29, 0xffff0000, v6
    v_mfma_f32_16x16x32_bf16 v[196:199], a[84:87], v[84:87], v[196:199]
    ds_read_b128 v[76:79], v225 offset:51200
    v_lshlrev_b32_e64 v30, 16, v7
    v_and_b32 v31, 0xffff0000, v7
    v_mfma_f32_16x16x32_bf16 v[200:203], a[72:75], v[80:83], v[200:203]
    ds_read_b64_tr_b16 a[112:113], v228 offset:4096
    v_lshlrev_b32_e64 v32, 16, v8
    v_mfma_f32_16x16x32_bf16 v[200:203], a[88:91], v[84:87], v[200:203]
    ds_read_b64_tr_b16 a[114:115], v228 offset:4608
    v_and_b32 v33, 0xffff0000, v8
    v_mfma_f32_16x16x32_bf16 v[204:207], a[76:79], v[80:83], v[204:207]
    ds_read_b64_tr_b16 a[116:117], v229 offset:4096
    v_lshlrev_b32_e64 v34, 16, v9
    v_mfma_f32_16x16x32_bf16 v[204:207], a[92:95], v[84:87], v[204:207]
    ds_read_b64_tr_b16 a[118:119], v229 offset:4608
    v_and_b32 v35, 0xffff0000, v9
    v_mfma_f32_16x16x32_bf16 v[208:211], a[64:67], v[88:91], v[208:211]
    ds_read_b64_tr_b16 a[120:121], v230 offset:4096
    s_add_u32 m0, s34, 32768
    s_add_u32 s37, s86, 0
    buffer_load_dwordx4 v232, s[44:47], s37 offen lds
    v_mfma_f32_16x16x32_bf16 v[208:211], a[80:83], v[92:95], v[208:211]
    ds_read_b64_tr_b16 a[122:123], v230 offset:4608
    v_lshlrev_b32 v36, 16, v10
    v_mfma_f32_16x16x32_bf16 v[212:215], a[68:71], v[88:91], v[212:215]
    ds_read_b64_tr_b16 a[124:125], v231 offset:4096
    v_and_b32 v37, 0xffff0000, v10
    v_lshlrev_b32_e64 v38, 16, v11
    v_mfma_f32_16x16x32_bf16 v[212:215], a[84:87], v[92:95], v[212:215]
    ds_read_b64_tr_b16 a[126:127], v231 offset:4608
    v_and_b32 v39, 0xffff0000, v11
    v_mfma_f32_16x16x32_bf16 v[216:219], a[72:75], v[88:91], v[216:219]
    buffer_load_dwordx4 v233, s[44:47], s37 offen offset:1024 lds
    v_lshlrev_b32_e64 v40, 16, v12
    v_mfma_f32_16x16x32_bf16 v[216:219], a[88:91], v[92:95], v[216:219]
    v_and_b32 v41, 0xffff0000, v12
    v_lshlrev_b32_e64 v42, 16, v13
    v_mfma_f32_16x16x32_bf16 v[220:223], a[76:79], v[88:91], v[220:223]
    v_and_b32 v43, 0xffff0000, v13
    v_lshlrev_b32_e64 v44, 16, v14
    v_and_b32 v45, 0xffff0000, v14
    v_mfma_f32_16x16x32_bf16 v[220:223], a[92:95], v[92:95], v[220:223]
    v_lshlrev_b32 v46, 16, v15
    s_waitcnt lgkmcnt(0)
    v_mfma_f32_16x16x32_bf16 v[96:99], a[96:99], v[64:67], v[96:99]
    ds_read_b128 v[80:83], v224 offset:53248
    v_and_b32 v47, 0xffff0000, v15
    v_mfma_f32_16x16x32_bf16 v[96:99], a[112:115], v[68:71], v[96:99]
    ds_read_b128 v[84:87], v225 offset:53248
    v_add_f32_e64 v52, v16, v20
    v_mfma_f32_16x16x32_bf16 v[100:103], a[100:103], v[64:67], v[100:103]
    ds_read_b128 v[88:91], v224 offset:55296
    v_add_f32_e64 v53, v17, v21
    v_mfma_f32_16x16x32_bf16 v[100:103], a[116:119], v[68:71], v[100:103]
    ds_read_b128 v[92:95], v225 offset:55296
    v_add_f32 v54, v18, v22
    v_add_f32 v55, v19, v23
    v_mfma_f32_16x16x32_bf16 v[104:107], a[104:107], v[64:67], v[104:107]
    v_add_f32 v52, v52, v24
    v_add_f32 v53, v53, v25
    v_mfma_f32_16x16x32_bf16 v[104:107], a[120:123], v[68:71], v[104:107]
    v_add_f32 v54, v54, v26
    v_add_f32 v55, v55, v27
    v_mfma_f32_16x16x32_bf16 v[108:111], a[108:111], v[64:67], v[108:111]
    v_add_f32 v52, v52, v28
    v_add_f32 v53, v53, v29
    v_add_f32_e64 v54, v54, v30
    v_mfma_f32_16x16x32_bf16 v[108:111], a[124:127], v[68:71], v[108:111]
    v_add_f32 v55, v55, v31
    v_add_f32 v52, v52, v32
    v_mfma_f32_16x16x32_bf16 v[112:115], a[96:99], v[72:75], v[112:115]
    s_add_u32 m0, s35, 20480
    s_add_u32 s33, s33, 131072
    buffer_load_dwordx4 v234, s[48:51], s33 offen lds
    v_mfma_f32_16x16x32_bf16 v[112:115], a[112:115], v[76:79], v[112:115]
    v_add_f32 v53, v53, v33
    v_add_f32 v54, v54, v34
    v_mfma_f32_16x16x32_bf16 v[116:119], a[100:103], v[72:75], v[116:119]
    buffer_load_dwordx4 v235, s[48:51], s33 offen offset:1024 lds
    v_add_f32 v55, v55, v35
    v_add_f32 v52, v52, v36
    v_mfma_f32_16x16x32_bf16 v[116:119], a[116:119], v[76:79], v[116:119]
    v_add_f32 v53, v53, v37
    v_add_f32 v54, v54, v38
    v_mfma_f32_16x16x32_bf16 v[120:123], a[104:107], v[72:75], v[120:123]
    s_add_u32 m0, s35, 22528
    s_add_u32 s33, s33, 131072
    buffer_load_dwordx4 v234, s[48:51], s33 offen lds
    v_mfma_f32_16x16x32_bf16 v[120:123], a[120:123], v[76:79], v[120:123]
    v_add_f32 v55, v55, v39
    v_add_f32 v52, v52, v40
    v_mfma_f32_16x16x32_bf16 v[124:127], a[108:111], v[72:75], v[124:127]
    buffer_load_dwordx4 v235, s[48:51], s33 offen offset:1024 lds
    v_add_f32 v53, v53, v41
    v_add_f32 v54, v54, v42
    v_mfma_f32_16x16x32_bf16 v[124:127], a[124:127], v[76:79], v[124:127]
    v_add_f32 v55, v55, v43
    s_waitcnt lgkmcnt(0)
    v_mfma_f32_16x16x32_bf16 v[128:131], a[96:99], v[80:83], v[128:131]
    ds_read_b128 v[64:67], v224 offset:57344
    v_add_f32_e64 v52, v52, v44
    v_mfma_f32_16x16x32_bf16 v[128:131], a[112:115], v[84:87], v[128:131]
    ds_read_b128 v[68:71], v225 offset:57344
    v_add_f32_e64 v53, v53, v45
    v_mfma_f32_16x16x32_bf16 v[132:135], a[100:103], v[80:83], v[132:135]
    ds_read_b128 v[72:75], v224 offset:59392
    v_add_f32_e64 v54, v54, v46
    v_mfma_f32_16x16x32_bf16 v[132:135], a[116:119], v[84:87], v[132:135]
    ds_read_b128 v[76:79], v225 offset:59392
    v_add_f32 v55, v55, v47
    v_add_f32 v52, v52, v53
    v_mfma_f32_16x16x32_bf16 v[136:139], a[104:107], v[80:83], v[136:139]
    v_add_f32 v54, v54, v55
    v_add_f32 v48, v52, v54
    v_mfma_f32_16x16x32_bf16 v[136:139], a[120:123], v[84:87], v[136:139]
    s_nop 1
    v_add_f32_dpp v48, v48, v48 quad_perm:[1,0,3,2] row_mask:0xf bank_mask:0xf
    v_mfma_f32_16x16x32_bf16 v[140:143], a[108:111], v[80:83], v[140:143]
    s_nop 1
    v_add_f32_dpp v48, v48, v48 quad_perm:[2,3,0,1] row_mask:0xf bank_mask:0xf
    s_nop 1
    v_mfma_f32_16x16x32_bf16 v[140:143], a[124:127], v[84:87], v[140:143]
    v_add_f32_dpp v48, v48, v48 row_half_mirror row_mask:0xf bank_mask:0xf
    s_nop 1
    v_mfma_f32_16x16x32_bf16 v[144:147], a[96:99], v[88:91], v[144:147]
    s_add_u32 m0, s34, 40960
    s_add_u32 s37, s86, 65536
    buffer_load_dwordx4 v232, s[44:47], s37 offen lds
    v_mfma_f32_16x16x32_bf16 v[144:147], a[112:115], v[92:95], v[144:147]
    v_add_f32_dpp v48, v48, v48 row_mirror row_mask:0xf bank_mask:0xf
    s_nop 0
    v_mfma_f32_16x16x32_bf16 v[148:151], a[100:103], v[88:91], v[148:151]
    buffer_load_dwordx4 v233, s[44:47], s37 offen offset:1024 lds
    v_mov_b32_e64 v49, v48
    s_nop 1
    v_mfma_f32_16x16x32_bf16 v[148:151], a[116:119], v[92:95], v[148:151]
    v_permlane16_swap_b32 v48, v49
    s_nop 0
    v_mfma_f32_16x16x32_bf16 v[152:155], a[104:107], v[88:91], v[152:155]
    v_lshlrev_b32_e64 v227, 3, v240
    v_min_u32 v227, 1920, v227
    s_lshl2_add_u32 s25, s2, s3
    v_mfma_f32_16x16x32_bf16 v[152:155], a[120:123], v[92:95], v[152:155]
    v_add_f32 v48, v48, v49
    v_mul_f32 v48, 0x3a800000, v48
    v_mfma_f32_16x16x32_bf16 v[156:159], a[108:111], v[88:91], v[156:159]
    s_lshl_b32 s25, s25, 13
    s_add_u32 s25, s25, 0
    buffer_load_dword v241, v227, s[12:15], s25 offen
    v_mfma_f32_16x16x32_bf16 v[156:159], a[124:127], v[92:95], v[156:159]
    v_sub_f32 v56, v16, v48
    s_waitcnt vmcnt(16) lgkmcnt(0)
    v_mfma_f32_16x16x32_bf16 v[160:163], a[96:99], v[64:67], v[160:163]
    ds_read_b128 v[80:83], v224 offset:61440
    v_mul_f32 v52, v56, v56
    v_sub_f32 v57, v17, v48
    v_mfma_f32_16x16x32_bf16 v[160:163], a[112:115], v[68:71], v[160:163]
    ds_read_b128 v[84:87], v225 offset:61440
    v_mul_f32_e64 v53, v57, v57
    v_mfma_f32_16x16x32_bf16 v[164:167], a[100:103], v[64:67], v[164:167]
    ds_read_b128 v[88:91], v224 offset:63488
    v_sub_f32_e64 v58, v18, v48
    v_mfma_f32_16x16x32_bf16 v[164:167], a[116:119], v[68:71], v[164:167]
    ds_read_b128 v[92:95], v225 offset:63488
    v_mul_f32_e64 v54, v58, v58
    v_mfma_f32_16x16x32_bf16 v[168:171], a[104:107], v[64:67], v[168:171]
    ds_read_b64_tr_b16 a[128:129], v228 offset:8192
    v_sub_f32_e64 v59, v19, v48
    v_mfma_f32_16x16x32_bf16 v[168:171], a[120:123], v[68:71], v[168:171]
    ds_read_b64_tr_b16 a[130:131], v228 offset:8704
    v_mul_f32 v55, v59, v59
    v_sub_f32 v56, v20, v48
    v_mfma_f32_16x16x32_bf16 v[172:175], a[108:111], v[64:67], v[172:175]
    ds_read_b64_tr_b16 a[132:133], v229 offset:8192
    v_fmac_f32_e64 v52, v56, v56
    v_mfma_f32_16x16x32_bf16 v[172:175], a[124:127], v[68:71], v[172:175]
    ds_read_b64_tr_b16 a[134:135], v229 offset:8704
    v_sub_f32_e64 v57, v21, v48
    v_mfma_f32_16x16x32_bf16 v[176:179], a[96:99], v[72:75], v[176:179]
    ds_read_b64_tr_b16 a[136:137], v230 offset:8192
    s_add_u32 m0, s35, 0
    s_and_b32 s33, s86, 1023
    s_lshl_b32 s33, s33, 12
    buffer_load_dwordx4 v234, s[48:51], s33 offen lds
    v_mfma_f32_16x16x32_bf16 v[176:179], a[112:115], v[76:79], v[176:179]
    ds_read_b64_tr_b16 a[138:139], v230 offset:8704
    v_fmac_f32_e64 v53, v57, v57
    v_mfma_f32_16x16x32_bf16 v[180:183], a[100:103], v[72:75], v[180:183]
    ds_read_b64_tr_b16 a[140:141], v231 offset:8192
    buffer_load_dwordx4 v235, s[48:51], s33 offen offset:1024 lds
    v_mfma_f32_16x16x32_bf16 v[180:183], a[116:119], v[76:79], v[180:183]
    ds_read_b64_tr_b16 a[142:143], v231 offset:8704
    v_sub_f32_e64 v58, v22, v48
    v_mfma_f32_16x16x32_bf16 v[184:187], a[104:107], v[72:75], v[184:187]
    s_add_u32 m0, s35, 2048
    s_add_u32 s33, s33, 131072
    buffer_load_dwordx4 v234, s[48:51], s33 offen lds
    v_mfma_f32_16x16x32_bf16 v[184:187], a[120:123], v[76:79], v[184:187]
    v_fmac_f32 v54, v58, v58
    v_sub_f32 v59, v23, v48
    v_fmac_f32_e64 v55, v59, v59
    v_mfma_f32_16x16x32_bf16 v[188:191], a[108:111], v[72:75], v[188:191]
    buffer_load_dwordx4 v235, s[48:51], s33 offen offset:1024 lds
    v_sub_f32_e64 v56, v24, v48
    v_mfma_f32_16x16x32_bf16 v[188:191], a[124:127], v[76:79], v[188:191]
    s_waitcnt vmcnt(30) lgkmcnt(0)
    s_barrier
    v_mfma_f32_16x16x32_bf16 v[192:195], a[96:99], v[80:83], v[192:195]
    ds_read_b128 v[64:67], v224 offset:0
    v_fmac_f32_e64 v52, v56, v56
    v_mfma_f32_16x16x32_bf16 v[192:195], a[112:115], v[84:87], v[192:195]
    ds_read_b128 v[68:71], v225 offset:0
    v_sub_f32_e64 v57, v25, v48
    v_mfma_f32_16x16x32_bf16 v[196:199], a[100:103], v[80:83], v[196:199]
    ds_read_b128 v[72:75], v224 offset:2048
    v_fmac_f32_e64 v53, v57, v57
    v_mfma_f32_16x16x32_bf16 v[196:199], a[116:119], v[84:87], v[196:199]
    ds_read_b128 v[76:79], v225 offset:2048
    v_sub_f32 v58, v26, v48
    v_fmac_f32 v54, v58, v58
    v_mfma_f32_16x16x32_bf16 v[200:203], a[104:107], v[80:83], v[200:203]
    ds_read_b64_tr_b16 a[144:145], v228 offset:12288
    v_sub_f32_e64 v59, v27, v48
    v_mfma_f32_16x16x32_bf16 v[200:203], a[120:123], v[84:87], v[200:203]
    ds_read_b64_tr_b16 a[146:147], v228 offset:12800
    v_fmac_f32_e64 v55, v59, v59
    v_mfma_f32_16x16x32_bf16 v[204:207], a[108:111], v[80:83], v[204:207]
    ds_read_b64_tr_b16 a[148:149], v229 offset:12288
    v_sub_f32_e64 v56, v28, v48
    v_mfma_f32_16x16x32_bf16 v[204:207], a[124:127], v[84:87], v[204:207]
    ds_read_b64_tr_b16 a[150:151], v229 offset:12800
    v_fmac_f32_e64 v52, v56, v56
    v_mfma_f32_16x16x32_bf16 v[208:211], a[96:99], v[88:91], v[208:211]
    ds_read_b64_tr_b16 a[152:153], v230 offset:12288
    s_add_u32 m0, s34, 49152
    s_add_u32 s37, s87, 0
    buffer_load_dwordx4 v232, s[44:47], s37 offen lds
    v_mfma_f32_16x16x32_bf16 v[208:211], a[112:115], v[92:95], v[208:211]
    ds_read_b64_tr_b16 a[154:155], v230 offset:12800
    v_sub_f32 v57, v29, v48
    v_mfma_f32_16x16x32_bf16 v[212:215], a[100:103], v[88:91], v[212:215]
    ds_read_b64_tr_b16 a[156:157], v231 offset:12288
    v_fmac_f32 v53, v57, v57
    v_sub_f32 v58, v30, v48
    v_mfma_f32_16x16x32_bf16 v[212:215], a[116:119], v[92:95], v[212:215]
    ds_read_b64_tr_b16 a[158:159], v231 offset:12800
    v_fmac_f32_e64 v54, v58, v58
    v_mfma_f32_16x16x32_bf16 v[216:219], a[104:107], v[88:91], v[216:219]
    buffer_load_dwordx4 v233, s[44:47], s37 offen offset:1024 lds
    v_sub_f32_e64 v59, v31, v48
    v_mfma_f32_16x16x32_bf16 v[216:219], a[120:123], v[92:95], v[216:219]
    v_fmac_f32 v55, v59, v59
    v_sub_f32 v56, v32, v48
    v_mfma_f32_16x16x32_bf16 v[220:223], a[108:111], v[88:91], v[220:223]
    v_fmac_f32 v52, v56, v56
    v_sub_f32 v57, v33, v48
    v_fmac_f32_e64 v53, v57, v57
    v_mfma_f32_16x16x32_bf16 v[220:223], a[124:127], v[92:95], v[220:223]
    v_sub_f32 v58, v34, v48
    s_waitcnt lgkmcnt(0)
    v_mfma_f32_16x16x32_bf16 v[96:99], a[128:131], v[64:67], v[96:99]
    ds_read_b128 v[80:83], v224 offset:4096
    v_fmac_f32_e64 v54, v58, v58
    v_mfma_f32_16x16x32_bf16 v[96:99], a[144:147], v[68:71], v[96:99]
    ds_read_b128 v[84:87], v225 offset:4096
    v_sub_f32_e64 v59, v35, v48
    v_mfma_f32_16x16x32_bf16 v[100:103], a[132:135], v[64:67], v[100:103]
    ds_read_b128 v[88:91], v224 offset:6144
    v_fmac_f32_e64 v55, v59, v59
    v_mfma_f32_16x16x32_bf16 v[100:103], a[148:151], v[68:71], v[100:103]
    ds_read_b128 v[92:95], v225 offset:6144
    v_sub_f32 v56, v36, v48
    v_fmac_f32 v52, v56, v56
    v_mfma_f32_16x16x32_bf16 v[104:107], a[136:139], v[64:67], v[104:107]
    v_sub_f32 v57, v37, v48
    v_fmac_f32 v53, v57, v57
    v_mfma_f32_16x16x32_bf16 v[104:107], a[152:155], v[68:71], v[104:107]
    v_sub_f32 v58, v38, v48
    v_fmac_f32 v54, v58, v58
    v_mfma_f32_16x16x32_bf16 v[108:111], a[140:143], v[64:67], v[108:111]
    v_sub_f32 v59, v39, v48
    v_fmac_f32 v55, v59, v59
    v_sub_f32_e64 v56, v40, v48
    v_mfma_f32_16x16x32_bf16 v[108:111], a[156:159], v[68:71], v[108:111]
    v_fmac_f32 v52, v56, v56
    v_sub_f32 v57, v41, v48
    v_mfma_f32_16x16x32_bf16 v[112:115], a[128:131], v[72:75], v[112:115]
    s_add_u32 m0, s35, 4096
    s_add_u32 s33, s33, 131072
    buffer_load_dwordx4 v234, s[48:51], s33 offen lds
    v_mfma_f32_16x16x32_bf16 v[112:115], a[144:147], v[76:79], v[112:115]
    v_fmac_f32 v53, v57, v57
    v_sub_f32 v58, v42, v48
    v_mfma_f32_16x16x32_bf16 v[116:119], a[132:135], v[72:75], v[116:119]
    buffer_load_dwordx4 v235, s[48:51], s33 offen offset:1024 lds
    v_fmac_f32 v54, v58, v58
    v_sub_f32 v59, v43, v48
    v_mfma_f32_16x16x32_bf16 v[116:119], a[148:151], v[76:79], v[116:119]
    v_fmac_f32 v55, v59, v59
    v_sub_f32 v56, v44, v48
    v_mfma_f32_16x16x32_bf16 v[120:123], a[136:139], v[72:75], v[120:123]
    s_add_u32 m0, s35, 6144
    s_add_u32 s33, s33, 131072
    buffer_load_dwordx4 v234, s[48:51], s33 offen lds
    v_mfma_f32_16x16x32_bf16 v[120:123], a[152:155], v[76:79], v[120:123]
    v_fmac_f32 v52, v56, v56
    v_sub_f32 v57, v45, v48
    v_mfma_f32_16x16x32_bf16 v[124:127], a[140:143], v[72:75], v[124:127]
    buffer_load_dwordx4 v235, s[48:51], s33 offen offset:1024 lds
    v_fmac_f32 v53, v57, v57
    v_sub_f32 v58, v46, v48
    v_mfma_f32_16x16x32_bf16 v[124:127], a[156:159], v[76:79], v[124:127]
    v_fmac_f32 v54, v58, v58
    s_waitcnt lgkmcnt(0)
    v_mfma_f32_16x16x32_bf16 v[128:131], a[128:131], v[80:83], v[128:131]
    ds_read_b128 v[64:67], v224 offset:8192
    v_sub_f32_e64 v59, v47, v48
    v_mfma_f32_16x16x32_bf16 v[128:131], a[144:147], v[84:87], v[128:131]
    ds_read_b128 v[68:71], v225 offset:8192
    v_fmac_f32_e64 v55, v59, v59
    v_mfma_f32_16x16x32_bf16 v[132:135], a[132:135], v[80:83], v[132:135]
    ds_read_b128 v[72:75], v224 offset:10240
    v_add_f32_e64 v52, v52, v53
    v_mfma_f32_16x16x32_bf16 v[132:135], a[148:151], v[84:87], v[132:135]
    ds_read_b128 v[76:79], v225 offset:10240
    v_add_f32_e64 v54, v54, v55
    v_mfma_f32_16x16x32_bf16 v[136:139], a[136:139], v[80:83], v[136:139]
    v_add_f32 v51, v52, v54
    s_nop 1
    v_add_f32_dpp v51, v51, v51 quad_perm:[1,0,3,2] row_mask:0xf bank_mask:0xf
    v_mfma_f32_16x16x32_bf16 v[136:139], a[152:155], v[84:87], v[136:139]
    s_nop 1
    v_add_f32_dpp v51, v51, v51 quad_perm:[2,3,0,1] row_mask:0xf bank_mask:0xf
    v_mfma_f32_16x16x32_bf16 v[140:143], a[140:143], v[80:83], v[140:143]
    s_nop 1
    v_add_f32_dpp v51, v51, v51 row_half_mirror row_mask:0xf bank_mask:0xf
    s_nop 1
    v_mfma_f32_16x16x32_bf16 v[140:143], a[156:159], v[84:87], v[140:143]
    v_add_f32_dpp v51, v51, v51 row_mirror row_mask:0xf bank_mask:0xf
    s_nop 0
    v_mfma_f32_16x16x32_bf16 v[144:147], a[128:131], v[88:91], v[144:147]
    s_add_u32 m0, s34, 57344
    s_add_u32 s37, s87, 65536
    buffer_load_dwordx4 v232, s[44:47], s37 offen lds
    v_mfma_f32_16x16x32_bf16 v[144:147], a[144:147], v[92:95], v[144:147]
    v_mov_b32 v49, v51
    s_nop 1
    v_mfma_f32_16x16x32_bf16 v[148:151], a[132:135], v[88:91], v[148:151]
    buffer_load_dwordx4 v233, s[44:47], s37 offen offset:1024 lds
    v_permlane16_swap_b32 v51, v49
    s_nop 0
    v_mfma_f32_16x16x32_bf16 v[148:151], a[148:151], v[92:95], v[148:151]
    v_add_f32_e64 v51, v51, v49
    v_mul_f32 v51, 0x3a800000, v51
    v_mfma_f32_16x16x32_bf16 v[152:155], a[136:139], v[88:91], v[152:155]
    v_lshlrev_b32_e64 v227, 3, v240
    v_min_u32 v227, 1920, v227
    s_lshl2_add_u32 s25, s2, s3
    v_mfma_f32_16x16x32_bf16 v[152:155], a[152:155], v[92:95], v[152:155]
    v_cvt_pk_bf16_f32 v50, v48, v51
    v_and_b32 v51, 0xffff0000, v50
    v_mfma_f32_16x16x32_bf16 v[156:159], a[140:143], v[88:91], v[156:159]
    s_lshl_b32 s25, s25, 13
    s_add_u32 s25, s25, 2048
    buffer_load_dword v241, v227, s[12:15], s25 offen
    v_mfma_f32_16x16x32_bf16 v[156:159], a[156:159], v[92:95], v[156:159]
    v_lshlrev_b32 v50, 16, v50
    s_waitcnt vmcnt(16) lgkmcnt(0)
    v_mfma_f32_16x16x32_bf16 v[160:163], a[128:131], v[64:67], v[160:163]
    ds_read_b128 v[80:83], v224 offset:12288
    v_add_f32 v51, 0x3727c5ac, v51
    v_cvt_pk_bf16_f32 v51, v51, v51
    v_mfma_f32_16x16x32_bf16 v[160:163], a[144:147], v[68:71], v[160:163]
    ds_read_b128 v[84:87], v225 offset:12288
    v_lshlrev_b32_e64 v51, 16, v51
    v_mfma_f32_16x16x32_bf16 v[164:167], a[132:135], v[64:67], v[164:167]
    ds_read_b128 v[88:91], v224 offset:14336
    v_mfma_f32_16x16x32_bf16 v[164:167], a[148:151], v[68:71], v[164:167]
    ds_read_b128 v[92:95], v225 offset:14336
    v_sqrt_f32 v51, v51
    v_mfma_f32_16x16x32_bf16 v[168:171], a[136:139], v[64:67], v[168:171]
    ds_read_b64_tr_b16 a[160:161], v228 offset:16384
    s_nop 0
    v_mfma_f32_16x16x32_bf16 v[168:171], a[152:155], v[68:71], v[168:171]
    ds_read_b64_tr_b16 a[162:163], v228 offset:16896
    v_cvt_pk_bf16_f32 v51, v51, v51
    v_lshlrev_b32_e64 v51, 16, v51
    v_mfma_f32_16x16x32_bf16 v[172:175], a[140:143], v[64:67], v[172:175]
    ds_read_b64_tr_b16 a[164:165], v229 offset:16384
    v_mfma_f32_16x16x32_bf16 v[172:175], a[156:159], v[68:71], v[172:175]
    ds_read_b64_tr_b16 a[166:167], v229 offset:16896
    v_rcp_f32_e64 v51, v51
    v_mfma_f32_16x16x32_bf16 v[176:179], a[128:131], v[72:75], v[176:179]
    ds_read_b64_tr_b16 a[168:169], v230 offset:16384
    s_add_u32 m0, s35, 8192
    s_and_b32 s33, s87, 1023
    s_lshl_b32 s33, s33, 12
    buffer_load_dwordx4 v234, s[48:51], s33 offen lds
    v_mfma_f32_16x16x32_bf16 v[176:179], a[144:147], v[76:79], v[176:179]
    ds_read_b64_tr_b16 a[170:171], v230 offset:16896
    s_nop 0
    v_mfma_f32_16x16x32_bf16 v[180:183], a[132:135], v[72:75], v[180:183]
    ds_read_b64_tr_b16 a[172:173], v231 offset:16384
    buffer_load_dwordx4 v235, s[48:51], s33 offen offset:1024 lds
    v_mfma_f32_16x16x32_bf16 v[180:183], a[148:151], v[76:79], v[180:183]
    ds_read_b64_tr_b16 a[174:175], v231 offset:16896
    v_mul_f32 v51, 0x3e0293ee, v51
    v_mfma_f32_16x16x32_bf16 v[184:187], a[136:139], v[72:75], v[184:187]
    s_add_u32 m0, s35, 10240
    s_add_u32 s33, s33, 131072
    buffer_load_dwordx4 v234, s[48:51], s33 offen lds
    v_mfma_f32_16x16x32_bf16 v[184:187], a[152:155], v[76:79], v[184:187]
    v_sub_f32 v16, v16, v50
    v_sub_f32 v17, v17, v50
    v_cvt_pk_bf16_f32 v17, v16, v17
    v_mfma_f32_16x16x32_bf16 v[188:191], a[140:143], v[72:75], v[188:191]
    buffer_load_dwordx4 v235, s[48:51], s33 offen offset:1024 lds
    v_lshlrev_b32_e64 v16, 16, v17
    v_mfma_f32_16x16x32_bf16 v[188:191], a[156:159], v[76:79], v[188:191]
    s_waitcnt vmcnt(31) lgkmcnt(0)
    s_barrier
    v_mfma_f32_16x16x32_bf16 v[192:195], a[128:131], v[80:83], v[192:195]
    ds_read_b128 v[64:67], v224 offset:16384
    v_and_b32 v17, 0xffff0000, v17
    v_mfma_f32_16x16x32_bf16 v[192:195], a[144:147], v[84:87], v[192:195]
    ds_read_b128 v[68:71], v225 offset:16384
    v_mul_f32_e64 v16, v16, v51
    v_mfma_f32_16x16x32_bf16 v[196:199], a[132:135], v[80:83], v[196:199]
    ds_read_b128 v[72:75], v224 offset:18432
    v_mul_f32_e64 v17, v17, v51
    v_mfma_f32_16x16x32_bf16 v[196:199], a[148:151], v[84:87], v[196:199]
    ds_read_b128 v[76:79], v225 offset:18432
    v_cvt_pk_bf16_f32 v0, v16, v17
    v_sub_f32_e64 v18, v18, v50
    v_mfma_f32_16x16x32_bf16 v[200:203], a[136:139], v[80:83], v[200:203]
    ds_read_b64_tr_b16 a[176:177], v228 offset:20480
    v_sub_f32_e64 v19, v19, v50
    v_mfma_f32_16x16x32_bf16 v[200:203], a[152:155], v[84:87], v[200:203]
    ds_read_b64_tr_b16 a[178:179], v228 offset:20992
    v_cvt_pk_bf16_f32 v19, v18, v19
    v_mfma_f32_16x16x32_bf16 v[204:207], a[140:143], v[80:83], v[204:207]
    ds_read_b64_tr_b16 a[180:181], v229 offset:20480
    v_lshlrev_b32_e64 v18, 16, v19
    v_mfma_f32_16x16x32_bf16 v[204:207], a[156:159], v[84:87], v[204:207]
    ds_read_b64_tr_b16 a[182:183], v229 offset:20992
    v_and_b32 v19, 0xffff0000, v19
    v_mfma_f32_16x16x32_bf16 v[208:211], a[128:131], v[88:91], v[208:211]
    ds_read_b64_tr_b16 a[184:185], v230 offset:20480
    s_add_u32 m0, s34, 0
    s_add_u32 s37, s80, 131072
    buffer_load_dwordx4 v232, s[44:47], s37 offen lds
    v_mfma_f32_16x16x32_bf16 v[208:211], a[144:147], v[92:95], v[208:211]
    ds_read_b64_tr_b16 a[186:187], v230 offset:20992
    v_mul_f32 v18, v18, v51
    v_mfma_f32_16x16x32_bf16 v[212:215], a[132:135], v[88:91], v[212:215]
    ds_read_b64_tr_b16 a[188:189], v231 offset:20480
    v_mul_f32_e64 v19, v19, v51
    v_cvt_pk_bf16_f32 v1, v18, v19
    v_mfma_f32_16x16x32_bf16 v[212:215], a[148:151], v[92:95], v[212:215]
    ds_read_b64_tr_b16 a[190:191], v231 offset:20992
    v_sub_f32_e64 v20, v20, v50
    v_mfma_f32_16x16x32_bf16 v[216:219], a[136:139], v[88:91], v[216:219]
    buffer_load_dwordx4 v233, s[44:47], s37 offen offset:1024 lds
    v_sub_f32_e64 v21, v21, v50
    v_mfma_f32_16x16x32_bf16 v[216:219], a[152:155], v[92:95], v[216:219]
    v_cvt_pk_bf16_f32 v21, v20, v21
    v_lshlrev_b32_e64 v20, 16, v21
    v_mfma_f32_16x16x32_bf16 v[220:223], a[140:143], v[88:91], v[220:223]
    v_and_b32 v21, 0xffff0000, v21
    v_mul_f32 v20, v20, v51
    v_mul_f32 v21, v21, v51
    v_mfma_f32_16x16x32_bf16 v[220:223], a[156:159], v[92:95], v[220:223]
    v_cvt_pk_bf16_f32 v2, v20, v21
    s_waitcnt lgkmcnt(0)
    v_mfma_f32_16x16x32_bf16 v[96:99], a[160:163], v[64:67], v[96:99]
    ds_read_b128 v[80:83], v224 offset:20480
    v_sub_f32 v22, v22, v50
    v_mfma_f32_16x16x32_bf16 v[96:99], a[176:179], v[68:71], v[96:99]
    ds_read_b128 v[84:87], v225 offset:20480
    v_sub_f32_e64 v23, v23, v50
    v_mfma_f32_16x16x32_bf16 v[100:103], a[164:167], v[64:67], v[100:103]
    ds_read_b128 v[88:91], v224 offset:22528
    v_cvt_pk_bf16_f32 v23, v22, v23
    v_mfma_f32_16x16x32_bf16 v[100:103], a[180:183], v[68:71], v[100:103]
    ds_read_b128 v[92:95], v225 offset:22528
    v_lshlrev_b32_e64 v22, 16, v23
    v_and_b32 v23, 0xffff0000, v23
    v_mfma_f32_16x16x32_bf16 v[104:107], a[168:171], v[64:67], v[104:107]
    v_mul_f32 v22, v22, v51
    v_mul_f32 v23, v23, v51
    v_mfma_f32_16x16x32_bf16 v[104:107], a[184:187], v[68:71], v[104:107]
    v_cvt_pk_bf16_f32 v3, v22, v23
    v_sub_f32_e64 v24, v24, v50
    v_mfma_f32_16x16x32_bf16 v[108:111], a[172:175], v[64:67], v[108:111]
    v_sub_f32_e64 v25, v25, v50
    v_cvt_pk_bf16_f32 v25, v24, v25
    v_lshlrev_b32_e64 v24, 16, v25
    v_mfma_f32_16x16x32_bf16 v[108:111], a[188:191], v[68:71], v[108:111]
    v_and_b32 v25, 0xffff0000, v25
    v_mul_f32_e64 v24, v24, v51
    v_mfma_f32_16x16x32_bf16 v[112:115], a[160:163], v[72:75], v[112:115]
    s_add_u32 m0, s35, 12288
    s_add_u32 s33, s33, 131072
    buffer_load_dwordx4 v234, s[48:51], s33 offen lds
    v_mfma_f32_16x16x32_bf16 v[112:115], a[176:179], v[76:79], v[112:115]
    v_mul_f32_e64 v25, v25, v51
    v_cvt_pk_bf16_f32 v4, v24, v25
    v_mfma_f32_16x16x32_bf16 v[116:119], a[164:167], v[72:75], v[116:119]
    buffer_load_dwordx4 v235, s[48:51], s33 offen offset:1024 lds
    v_sub_f32 v26, v26, v50
    v_sub_f32 v27, v27, v50
    v_mfma_f32_16x16x32_bf16 v[116:119], a[180:183], v[76:79], v[116:119]
    v_cvt_pk_bf16_f32 v27, v26, v27
    v_lshlrev_b32_e64 v26, 16, v27
    v_mfma_f32_16x16x32_bf16 v[120:123], a[168:171], v[72:75], v[120:123]
    s_add_u32 m0, s35, 14336
    s_add_u32 s33, s33, 131072
    buffer_load_dwordx4 v234, s[48:51], s33 offen lds
    v_mfma_f32_16x16x32_bf16 v[120:123], a[184:187], v[76:79], v[120:123]
    v_and_b32 v27, 0xffff0000, v27
    v_mul_f32_e64 v26, v26, v51
    v_mfma_f32_16x16x32_bf16 v[124:127], a[172:175], v[72:75], v[124:127]
    buffer_load_dwordx4 v235, s[48:51], s33 offen offset:1024 lds
    v_mul_f32_e64 v27, v27, v51
    v_cvt_pk_bf16_f32 v5, v26, v27
    v_mfma_f32_16x16x32_bf16 v[124:127], a[188:191], v[76:79], v[124:127]
    v_sub_f32 v28, v28, v50
    s_waitcnt lgkmcnt(0)
    v_mfma_f32_16x16x32_bf16 v[128:131], a[160:163], v[80:83], v[128:131]
    ds_read_b128 v[64:67], v224 offset:24576
    v_sub_f32_e64 v29, v29, v50
    v_mfma_f32_16x16x32_bf16 v[128:131], a[176:179], v[84:87], v[128:131]
    ds_read_b128 v[68:71], v225 offset:24576
    v_cvt_pk_bf16_f32 v29, v28, v29
    v_mfma_f32_16x16x32_bf16 v[132:135], a[164:167], v[80:83], v[132:135]
    ds_read_b128 v[72:75], v224 offset:26624
    v_lshlrev_b32_e64 v28, 16, v29
    v_mfma_f32_16x16x32_bf16 v[132:135], a[180:183], v[84:87], v[132:135]
    ds_read_b128 v[76:79], v225 offset:26624
    v_and_b32 v29, 0xffff0000, v29
    v_mfma_f32_16x16x32_bf16 v[136:139], a[168:171], v[80:83], v[136:139]
    v_mul_f32 v28, v28, v51
    v_mul_f32 v29, v29, v51
    v_cvt_pk_bf16_f32 v6, v28, v29
    v_mfma_f32_16x16x32_bf16 v[136:139], a[184:187], v[84:87], v[136:139]
    v_sub_f32 v30, v30, v50
    v_sub_f32 v31, v31, v50
    v_mfma_f32_16x16x32_bf16 v[140:143], a[172:175], v[80:83], v[140:143]
    v_cvt_pk_bf16_f32 v31, v30, v31
    v_lshlrev_b32_e64 v30, 16, v31
    v_and_b32 v31, 0xffff0000, v31
    v_mfma_f32_16x16x32_bf16 v[140:143], a[188:191], v[84:87], v[140:143]
    v_mul_f32 v30, v30, v51
    v_mul_f32 v31, v31, v51
    v_mfma_f32_16x16x32_bf16 v[144:147], a[160:163], v[88:91], v[144:147]
    s_add_u32 m0, s34, 8192
    s_add_u32 s37, s81, 131072
    buffer_load_dwordx4 v232, s[44:47], s37 offen lds
    v_mfma_f32_16x16x32_bf16 v[144:147], a[176:179], v[92:95], v[144:147]
    v_cvt_pk_bf16_f32 v7, v30, v31
    v_sub_f32_e64 v32, v32, v50
    v_mfma_f32_16x16x32_bf16 v[148:151], a[164:167], v[88:91], v[148:151]
    buffer_load_dwordx4 v233, s[44:47], s37 offen offset:1024 lds
    v_sub_f32_e64 v33, v33, v50
    v_mfma_f32_16x16x32_bf16 v[148:151], a[180:183], v[92:95], v[148:151]
    v_cvt_pk_bf16_f32 v33, v32, v33
    v_lshlrev_b32_e64 v32, 16, v33
    v_and_b32 v33, 0xffff0000, v33
    v_mfma_f32_16x16x32_bf16 v[152:155], a[168:171], v[88:91], v[152:155]
    v_lshlrev_b32_e64 v227, 3, v240
    v_min_u32 v227, 1920, v227
    s_lshl2_add_u32 s25, s2, s3
    v_mfma_f32_16x16x32_bf16 v[152:155], a[184:187], v[92:95], v[152:155]
    v_mul_f32 v32, v32, v51
    v_mul_f32_e64 v33, v33, v51
    v_mfma_f32_16x16x32_bf16 v[156:159], a[172:175], v[88:91], v[156:159]
    s_lshl_b32 s25, s25, 13
    s_add_u32 s25, s25, 4096
    buffer_load_dword v241, v227, s[12:15], s25 offen
    v_mfma_f32_16x16x32_bf16 v[156:159], a[188:191], v[92:95], v[156:159]
    v_cvt_pk_bf16_f32 v8, v32, v33
    s_waitcnt vmcnt(16) lgkmcnt(0)
    v_mfma_f32_16x16x32_bf16 v[160:163], a[160:163], v[64:67], v[160:163]
    ds_read_b128 v[80:83], v224 offset:28672
    v_sub_f32 v34, v34, v50
    v_sub_f32 v35, v35, v50
    v_mfma_f32_16x16x32_bf16 v[160:163], a[176:179], v[68:71], v[160:163]
    ds_read_b128 v[84:87], v225 offset:28672
    v_cvt_pk_bf16_f32 v35, v34, v35
    v_mfma_f32_16x16x32_bf16 v[164:167], a[164:167], v[64:67], v[164:167]
    ds_read_b128 v[88:91], v224 offset:30720
    v_lshlrev_b32_e64 v34, 16, v35
    v_mfma_f32_16x16x32_bf16 v[164:167], a[180:183], v[68:71], v[164:167]
    ds_read_b128 v[92:95], v225 offset:30720
    v_and_b32 v35, 0xffff0000, v35
    v_mfma_f32_16x16x32_bf16 v[168:171], a[168:171], v[64:67], v[168:171]
    ds_read_b64_tr_b16 a[192:193], v228 offset:0
    v_mul_f32_e64 v34, v34, v51
    v_mfma_f32_16x16x32_bf16 v[168:171], a[184:187], v[68:71], v[168:171]
    ds_read_b64_tr_b16 a[194:195], v228 offset:512
    v_mul_f32_e64 v35, v35, v51
    v_cvt_pk_bf16_f32 v9, v34, v35
    v_mfma_f32_16x16x32_bf16 v[172:175], a[172:175], v[64:67], v[172:175]
    ds_read_b64_tr_b16 a[196:197], v229 offset:0
    v_sub_f32_e64 v36, v36, v50
    v_mfma_f32_16x16x32_bf16 v[172:175], a[188:191], v[68:71], v[172:175]
    ds_read_b64_tr_b16 a[198:199], v229 offset:512
    v_sub_f32_e64 v37, v37, v50
    v_mfma_f32_16x16x32_bf16 v[176:179], a[160:163], v[72:75], v[176:179]
    ds_read_b64_tr_b16 a[200:201], v230 offset:0
    v_cvt_pk_bf16_f32 v37, v36, v37
    v_mfma_f32_16x16x32_bf16 v[176:179], a[176:179], v[76:79], v[176:179]
    ds_read_b64_tr_b16 a[202:203], v230 offset:512
    v_lshlrev_b32_e64 v36, 16, v37
    v_mfma_f32_16x16x32_bf16 v[180:183], a[164:167], v[72:75], v[180:183]
    ds_read_b64_tr_b16 a[204:205], v231 offset:0
    v_and_b32 v37, 0xffff0000, v37
    v_mfma_f32_16x16x32_bf16 v[180:183], a[180:183], v[76:79], v[180:183]
    ds_read_b64_tr_b16 a[206:207], v231 offset:512
    v_mul_f32 v36, v36, v51
    v_mul_f32 v37, v37, v51
    v_mfma_f32_16x16x32_bf16 v[184:187], a[168:171], v[72:75], v[184:187]
    v_cvt_pk_bf16_f32 v10, v36, v37
    v_sub_f32_e64 v38, v38, v50
    v_mfma_f32_16x16x32_bf16 v[184:187], a[184:187], v[76:79], v[184:187]
    v_sub_f32_e64 v39, v39, v50
    v_cvt_pk_bf16_f32 v39, v38, v39
    v_mfma_f32_16x16x32_bf16 v[188:191], a[172:175], v[72:75], v[188:191]
    v_lshlrev_b32_e64 v38, 16, v39
    v_and_b32 v39, 0xffff0000, v39
    v_mul_f32_e64 v38, v38, v51
    v_mfma_f32_16x16x32_bf16 v[188:191], a[188:191], v[76:79], v[188:191]
    s_waitcnt vmcnt(27) lgkmcnt(0)
    s_barrier
    v_mfma_f32_16x16x32_bf16 v[192:195], a[160:163], v[80:83], v[192:195]
    ds_read_b128 v[64:67], v224 offset:32768
    v_mul_f32_e64 v39, v39, v51
    v_mfma_f32_16x16x32_bf16 v[192:195], a[176:179], v[84:87], v[192:195]
    ds_read_b128 v[68:71], v225 offset:32768
    v_cvt_pk_bf16_f32 v11, v38, v39
    v_mfma_f32_16x16x32_bf16 v[196:199], a[164:167], v[80:83], v[196:199]
    ds_read_b128 v[72:75], v224 offset:34816
    v_sub_f32_e64 v40, v40, v50
    v_mfma_f32_16x16x32_bf16 v[196:199], a[180:183], v[84:87], v[196:199]
    ds_read_b128 v[76:79], v225 offset:34816
    v_sub_f32_e64 v41, v41, v50
    v_mfma_f32_16x16x32_bf16 v[200:203], a[168:171], v[80:83], v[200:203]
    ds_read_b64_tr_b16 a[208:209], v228 offset:4096
    v_cvt_pk_bf16_f32 v41, v40, v41
    v_lshlrev_b32_e64 v40, 16, v41
    v_mfma_f32_16x16x32_bf16 v[200:203], a[184:187], v[84:87], v[200:203]
    ds_read_b64_tr_b16 a[210:211], v228 offset:4608
    v_and_b32 v41, 0xffff0000, v41
    v_mfma_f32_16x16x32_bf16 v[204:207], a[172:175], v[80:83], v[204:207]
    ds_read_b64_tr_b16 a[212:213], v229 offset:4096
    v_mul_f32_e64 v40, v40, v51
    v_mfma_f32_16x16x32_bf16 v[204:207], a[188:191], v[84:87], v[204:207]
    ds_read_b64_tr_b16 a[214:215], v229 offset:4608
    v_mul_f32_e64 v41, v41, v51
    v_mfma_f32_16x16x32_bf16 v[208:211], a[160:163], v[88:91], v[208:211]
    ds_read_b64_tr_b16 a[216:217], v230 offset:4096
    s_add_u32 m0, s34, 16384
    s_add_u32 s37, s82, 131072
    buffer_load_dwordx4 v232, s[44:47], s37 offen lds
    v_mfma_f32_16x16x32_bf16 v[208:211], a[176:179], v[92:95], v[208:211]
    ds_read_b64_tr_b16 a[218:219], v230 offset:4608
    v_cvt_pk_bf16_f32 v12, v40, v41
    v_mfma_f32_16x16x32_bf16 v[212:215], a[164:167], v[88:91], v[212:215]
    ds_read_b64_tr_b16 a[220:221], v231 offset:4096
    v_sub_f32 v42, v42, v50
    v_sub_f32 v43, v43, v50
    v_mfma_f32_16x16x32_bf16 v[212:215], a[180:183], v[92:95], v[212:215]
    ds_read_b64_tr_b16 a[222:223], v231 offset:4608
    v_cvt_pk_bf16_f32 v43, v42, v43
    v_mfma_f32_16x16x32_bf16 v[216:219], a[168:171], v[88:91], v[216:219]
    buffer_load_dwordx4 v233, s[44:47], s37 offen offset:1024 lds
    v_lshlrev_b32_e64 v42, 16, v43
    v_mfma_f32_16x16x32_bf16 v[216:219], a[184:187], v[92:95], v[216:219]
    v_and_b32 v43, 0xffff0000, v43
    v_mul_f32_e64 v42, v42, v51
    v_mfma_f32_16x16x32_bf16 v[220:223], a[172:175], v[88:91], v[220:223]
    v_mul_f32_e64 v43, v43, v51
    v_cvt_pk_bf16_f32 v13, v42, v43
    v_sub_f32_e64 v44, v44, v50
    v_mfma_f32_16x16x32_bf16 v[220:223], a[188:191], v[92:95], v[220:223]
    v_sub_f32 v45, v45, v50
    s_waitcnt lgkmcnt(0)
    v_mfma_f32_16x16x32_bf16 v[96:99], a[192:195], v[64:67], v[96:99]
    ds_read_b128 v[80:83], v224 offset:36864
    v_cvt_pk_bf16_f32 v45, v44, v45
    v_mfma_f32_16x16x32_bf16 v[96:99], a[208:211], v[68:71], v[96:99]
    ds_read_b128 v[84:87], v225 offset:36864
    v_lshlrev_b32_e64 v44, 16, v45
    v_mfma_f32_16x16x32_bf16 v[100:103], a[196:199], v[64:67], v[100:103]
    ds_read_b128 v[88:91], v224 offset:38912
    v_and_b32 v45, 0xffff0000, v45
    v_mfma_f32_16x16x32_bf16 v[100:103], a[212:215], v[68:71], v[100:103]
    ds_read_b128 v[92:95], v225 offset:38912
    v_mul_f32 v44, v44, v51
    v_mul_f32 v45, v45, v51
    v_mfma_f32_16x16x32_bf16 v[104:107], a[200:203], v[64:67], v[104:107]
    v_cvt_pk_bf16_f32 v14, v44, v45
    v_sub_f32_e64 v46, v46, v50
    v_mfma_f32_16x16x32_bf16 v[104:107], a[216:219], v[68:71], v[104:107]
    v_sub_f32_e64 v47, v47, v50
    v_cvt_pk_bf16_f32 v47, v46, v47
    v_mfma_f32_16x16x32_bf16 v[108:111], a[204:207], v[64:67], v[108:111]
    v_lshlrev_b32_e64 v46, 16, v47
    v_and_b32 v47, 0xffff0000, v47
    v_mul_f32_e64 v46, v46, v51
    v_mfma_f32_16x16x32_bf16 v[108:111], a[220:223], v[68:71], v[108:111]
    v_mul_f32_e64 v47, v47, v51
    v_cvt_pk_bf16_f32 v15, v46, v47
    v_mfma_f32_16x16x32_bf16 v[112:115], a[192:195], v[72:75], v[112:115]
    v_mfma_f32_16x16x32_bf16 v[112:115], a[208:211], v[76:79], v[112:115]
    ds_write_b128 v237, v[0:3] offset:0
    v_mfma_f32_16x16x32_bf16 v[116:119], a[196:199], v[72:75], v[116:119]
    ds_write_b128 v237, v[4:7] offset:4096
    v_mfma_f32_16x16x32_bf16 v[116:119], a[212:215], v[76:79], v[116:119]
    ds_write_b128 v237, v[8:11] offset:24576
    v_mfma_f32_16x16x32_bf16 v[120:123], a[200:203], v[72:75], v[120:123]
    ds_write_b128 v237, v[12:15] offset:28672
    v_mfma_f32_16x16x32_bf16 v[120:123], a[216:219], v[76:79], v[120:123]
    v_mfma_f32_16x16x32_bf16 v[124:127], a[204:207], v[72:75], v[124:127]
    v_mfma_f32_16x16x32_bf16 v[124:127], a[220:223], v[76:79], v[124:127]
    s_waitcnt lgkmcnt(0)
    v_mfma_f32_16x16x32_bf16 v[128:131], a[192:195], v[80:83], v[128:131]
    ds_read_b128 v[64:67], v224 offset:40960
    v_mfma_f32_16x16x32_bf16 v[128:131], a[208:211], v[84:87], v[128:131]
    ds_read_b128 v[68:71], v225 offset:40960
    v_mfma_f32_16x16x32_bf16 v[132:135], a[196:199], v[80:83], v[132:135]
    ds_read_b128 v[72:75], v224 offset:43008
    v_mfma_f32_16x16x32_bf16 v[132:135], a[212:215], v[84:87], v[132:135]
    ds_read_b128 v[76:79], v225 offset:43008
    v_mfma_f32_16x16x32_bf16 v[136:139], a[200:203], v[80:83], v[136:139]
    v_mfma_f32_16x16x32_bf16 v[136:139], a[216:219], v[84:87], v[136:139]
    v_mfma_f32_16x16x32_bf16 v[140:143], a[204:207], v[80:83], v[140:143]
    v_mfma_f32_16x16x32_bf16 v[140:143], a[220:223], v[84:87], v[140:143]
    v_mfma_f32_16x16x32_bf16 v[144:147], a[192:195], v[88:91], v[144:147]
    s_add_u32 m0, s34, 24576
    s_add_u32 s37, s83, 131072
    buffer_load_dwordx4 v232, s[44:47], s37 offen lds
    v_mfma_f32_16x16x32_bf16 v[144:147], a[208:211], v[92:95], v[144:147]
    buffer_load_dwordx4 v233, s[44:47], s37 offen offset:1024 lds
    v_mfma_f32_16x16x32_bf16 v[148:151], a[196:199], v[88:91], v[148:151]
    v_mfma_f32_16x16x32_bf16 v[148:151], a[212:215], v[92:95], v[148:151]
    v_lshlrev_b32 v227, 3, v240
    v_min_u32 v227, 1920, v227
    s_lshl2_add_u32 s25, s2, s3
    v_mfma_f32_16x16x32_bf16 v[152:155], a[200:203], v[88:91], v[152:155]
    s_lshl_b32 s25, s25, 13
    s_add_u32 s25, s25, 6144
    buffer_load_dword v241, v227, s[12:15], s25 offen
    v_mfma_f32_16x16x32_bf16 v[152:155], a[216:219], v[92:95], v[152:155]
    v_mfma_f32_16x16x32_bf16 v[156:159], a[204:207], v[88:91], v[156:159]
    buffer_load_dword v254, off, s[88:91], s97 sc1
    v_mfma_f32_16x16x32_bf16 v[156:159], a[220:223], v[92:95], v[156:159]
    s_waitcnt vmcnt(9) lgkmcnt(0)
    v_mfma_f32_16x16x32_bf16 v[160:163], a[192:195], v[64:67], v[160:163]
    ds_read_b128 v[80:83], v224 offset:45056
    v_mfma_f32_16x16x32_bf16 v[160:163], a[208:211], v[68:71], v[160:163]
    ds_read_b128 v[84:87], v225 offset:45056
    s_mul_i32 s38, s2, 100
    v_mfma_f32_16x16x32_bf16 v[164:167], a[196:199], v[64:67], v[164:167]
    ds_read_b128 v[88:91], v224 offset:47104
    v_mfma_f32_16x16x32_bf16 v[164:167], a[212:215], v[68:71], v[164:167]
    ds_read_b128 v[92:95], v225 offset:47104
    v_lshl_add_u32 v60, v253, 2, s38
    v_mfma_f32_16x16x32_bf16 v[168:171], a[200:203], v[64:67], v[168:171]
    ds_read_b64_tr_b16 a[224:225], v228 offset:8192
    v_mfma_f32_16x16x32_bf16 v[168:171], a[216:219], v[68:71], v[168:171]
    ds_read_b64_tr_b16 a[226:227], v228 offset:8704
    v_cmp_gt_u32 vcc, 25, v253
    v_mfma_f32_16x16x32_bf16 v[172:175], a[204:207], v[64:67], v[172:175]
    ds_read_b64_tr_b16 a[228:229], v229 offset:8192
    v_mfma_f32_16x16x32_bf16 v[172:175], a[220:223], v[68:71], v[172:175]
    ds_read_b64_tr_b16 a[230:231], v229 offset:8704
    v_mov_b32_e64 v61, 0
    v_mfma_f32_16x16x32_bf16 v[176:179], a[192:195], v[72:75], v[176:179]
    ds_read_b64_tr_b16 a[232:233], v230 offset:8192
    v_mfma_f32_16x16x32_bf16 v[176:179], a[208:211], v[76:79], v[176:179]
    ds_read_b64_tr_b16 a[234:235], v230 offset:8704
    v_mfma_f32_16x16x32_bf16 v[180:183], a[196:199], v[72:75], v[180:183]
    ds_read_b64_tr_b16 a[236:237], v231 offset:8192
    v_mov_b32 v62, 0x7ffffff0
    v_mfma_f32_16x16x32_bf16 v[180:183], a[212:215], v[76:79], v[180:183]
    ds_read_b64_tr_b16 a[238:239], v231 offset:8704
    v_mfma_f32_16x16x32_bf16 v[184:187], a[200:203], v[72:75], v[184:187]
    v_cndmask_b32 v60, v62, v60, vcc
    v_mfma_f32_16x16x32_bf16 v[184:187], a[216:219], v[76:79], v[184:187]
    buffer_store_dword v61, v60, s[56:59], 0 offen sc1
    v_mfma_f32_16x16x32_bf16 v[188:191], a[204:207], v[72:75], v[188:191]
    v_mfma_f32_16x16x32_bf16 v[188:191], a[220:223], v[76:79], v[188:191]
    s_waitcnt vmcnt(21) lgkmcnt(0)
    s_barrier
    v_mfma_f32_16x16x32_bf16 v[192:195], a[192:195], v[80:83], v[192:195]
    ds_read_b128 v[64:67], v224 offset:49152
    v_mfma_f32_16x16x32_bf16 v[192:195], a[208:211], v[84:87], v[192:195]
    ds_read_b128 v[68:71], v225 offset:49152
    v_mfma_f32_16x16x32_bf16 v[196:199], a[196:199], v[80:83], v[196:199]
    ds_read_b128 v[72:75], v224 offset:51200
    v_mfma_f32_16x16x32_bf16 v[196:199], a[212:215], v[84:87], v[196:199]
    ds_read_b128 v[76:79], v225 offset:51200
    v_mfma_f32_16x16x32_bf16 v[200:203], a[200:203], v[80:83], v[200:203]
    ds_read_b64_tr_b16 a[240:241], v228 offset:12288
    v_mfma_f32_16x16x32_bf16 v[200:203], a[216:219], v[84:87], v[200:203]
    ds_read_b64_tr_b16 a[242:243], v228 offset:12800
    v_mfma_f32_16x16x32_bf16 v[204:207], a[204:207], v[80:83], v[204:207]
    ds_read_b64_tr_b16 a[244:245], v229 offset:12288
    v_mfma_f32_16x16x32_bf16 v[204:207], a[220:223], v[84:87], v[204:207]
    ds_read_b64_tr_b16 a[246:247], v229 offset:12800
    v_mfma_f32_16x16x32_bf16 v[208:211], a[192:195], v[88:91], v[208:211]
    ds_read_b64_tr_b16 a[248:249], v230 offset:12288
    v_lshlrev_b32 v237, 4, v253
    v_add_u32 v237, 81920, v237
    ds_read_b128 v[16:19], v237 offset:0
    ds_read_b128 v[20:23], v237 offset:4096
    ds_read_b128 v[24:27], v237 offset:24576
    ds_read_b128 v[28:31], v237 offset:28672
    s_add_u32 m0, s34, 32768
    s_add_u32 s37, s84, 131072
    buffer_load_dwordx4 v232, s[44:47], s37 offen lds
    v_mfma_f32_16x16x32_bf16 v[208:211], a[208:211], v[92:95], v[208:211]
    ds_read_b64_tr_b16 a[250:251], v230 offset:12800
    v_mfma_f32_16x16x32_bf16 v[212:215], a[196:199], v[88:91], v[212:215]
    ds_read_b64_tr_b16 a[252:253], v231 offset:12288
    v_mfma_f32_16x16x32_bf16 v[212:215], a[212:215], v[92:95], v[212:215]
    ds_read_b64_tr_b16 a[254:255], v231 offset:12800
    v_mfma_f32_16x16x32_bf16 v[216:219], a[200:203], v[88:91], v[216:219]
    buffer_load_dwordx4 v233, s[44:47], s37 offen offset:1024 lds
    v_mfma_f32_16x16x32_bf16 v[216:219], a[216:219], v[92:95], v[216:219]
    v_mfma_f32_16x16x32_bf16 v[220:223], a[204:207], v[88:91], v[220:223]
    v_mfma_f32_16x16x32_bf16 v[220:223], a[220:223], v[92:95], v[220:223]
    s_waitcnt lgkmcnt(0)
    v_mfma_f32_16x16x32_bf16 v[96:99], a[224:227], v[64:67], v[96:99]
    ds_read_b128 v[80:83], v224 offset:53248
    v_mfma_f32_16x16x32_bf16 v[96:99], a[240:243], v[68:71], v[96:99]
    ds_read_b128 v[84:87], v225 offset:53248
    v_mfma_f32_16x16x32_bf16 v[100:103], a[228:231], v[64:67], v[100:103]
    ds_read_b128 v[88:91], v224 offset:55296
    v_mfma_f32_16x16x32_bf16 v[100:103], a[244:247], v[68:71], v[100:103]
    ds_read_b128 v[92:95], v225 offset:55296
    v_mfma_f32_16x16x32_bf16 v[104:107], a[232:235], v[64:67], v[104:107]
    v_mfma_f32_16x16x32_bf16 v[104:107], a[248:251], v[68:71], v[104:107]
    s_mov_b32 s39, 0
    buffer_store_dwordx4 v[16:19], v238, s[8:11], s39 offen sc1
    v_mfma_f32_16x16x32_bf16 v[108:111], a[236:239], v[64:67], v[108:111]
    v_mfma_f32_16x16x32_bf16 v[108:111], a[252:255], v[68:71], v[108:111]
    v_mfma_f32_16x16x32_bf16 v[112:115], a[224:227], v[72:75], v[112:115]
    v_mfma_f32_16x16x32_bf16 v[112:115], a[240:243], v[76:79], v[112:115]
    v_mfma_f32_16x16x32_bf16 v[116:119], a[228:231], v[72:75], v[116:119]
    v_mfma_f32_16x16x32_bf16 v[116:119], a[244:247], v[76:79], v[116:119]
    v_mfma_f32_16x16x32_bf16 v[120:123], a[232:235], v[72:75], v[120:123]
    v_mfma_f32_16x16x32_bf16 v[120:123], a[248:251], v[76:79], v[120:123]
    s_mov_b32 s39, 8192
    buffer_store_dwordx4 v[20:23], v238, s[8:11], s39 offen sc1
    v_mfma_f32_16x16x32_bf16 v[124:127], a[236:239], v[72:75], v[124:127]
    v_mfma_f32_16x16x32_bf16 v[124:127], a[252:255], v[76:79], v[124:127]
    s_waitcnt lgkmcnt(0)
    v_mfma_f32_16x16x32_bf16 v[128:131], a[224:227], v[80:83], v[128:131]
    ds_read_b128 v[64:67], v224 offset:57344
    v_mfma_f32_16x16x32_bf16 v[128:131], a[240:243], v[84:87], v[128:131]
    ds_read_b128 v[68:71], v225 offset:57344
    v_mfma_f32_16x16x32_bf16 v[132:135], a[228:231], v[80:83], v[132:135]
    ds_read_b128 v[72:75], v224 offset:59392
    v_mfma_f32_16x16x32_bf16 v[132:135], a[244:247], v[84:87], v[132:135]
    ds_read_b128 v[76:79], v225 offset:59392
    v_mfma_f32_16x16x32_bf16 v[136:139], a[232:235], v[80:83], v[136:139]
    v_mfma_f32_16x16x32_bf16 v[136:139], a[248:251], v[84:87], v[136:139]
    s_mov_b32 s39, 16384
    buffer_store_dwordx4 v[24:27], v238, s[8:11], s39 offen sc1
    v_mfma_f32_16x16x32_bf16 v[140:143], a[236:239], v[80:83], v[140:143]
    v_mfma_f32_16x16x32_bf16 v[140:143], a[252:255], v[84:87], v[140:143]
    v_mfma_f32_16x16x32_bf16 v[144:147], a[224:227], v[88:91], v[144:147]
    s_add_u32 m0, s34, 40960
    s_add_u32 s37, s85, 131072
    buffer_load_dwordx4 v232, s[44:47], s37 offen lds
    v_mfma_f32_16x16x32_bf16 v[144:147], a[240:243], v[92:95], v[144:147]
    v_mfma_f32_16x16x32_bf16 v[148:151], a[228:231], v[88:91], v[148:151]
    v_mfma_f32_16x16x32_bf16 v[148:151], a[244:247], v[92:95], v[148:151]
    v_mfma_f32_16x16x32_bf16 v[152:155], a[232:235], v[88:91], v[152:155]
    buffer_load_dwordx4 v233, s[44:47], s37 offen offset:1024 lds
    v_mfma_f32_16x16x32_bf16 v[152:155], a[248:251], v[92:95], v[152:155]
    s_mov_b32 s39, 24576
    buffer_store_dwordx4 v[28:31], v238, s[8:11], s39 offen sc1
    v_mfma_f32_16x16x32_bf16 v[156:159], a[236:239], v[88:91], v[156:159]
    v_mfma_f32_16x16x32_bf16 v[156:159], a[252:255], v[92:95], v[156:159]
    s_waitcnt lgkmcnt(0)
    v_mfma_f32_16x16x32_bf16 v[160:163], a[224:227], v[64:67], v[160:163]
    ds_read_b128 v[80:83], v224 offset:61440
    v_mfma_f32_16x16x32_bf16 v[160:163], a[240:243], v[68:71], v[160:163]
    ds_read_b128 v[84:87], v225 offset:61440
    v_mfma_f32_16x16x32_bf16 v[164:167], a[228:231], v[64:67], v[164:167]
    ds_read_b128 v[88:91], v224 offset:63488
    v_mfma_f32_16x16x32_bf16 v[164:167], a[244:247], v[68:71], v[164:167]
    ds_read_b128 v[92:95], v225 offset:63488
    v_mfma_f32_16x16x32_bf16 v[168:171], a[232:235], v[64:67], v[168:171]
    v_mfma_f32_16x16x32_bf16 v[168:171], a[248:251], v[68:71], v[168:171]
    v_mfma_f32_16x16x32_bf16 v[172:175], a[236:239], v[64:67], v[172:175]
    v_mfma_f32_16x16x32_bf16 v[172:175], a[252:255], v[68:71], v[172:175]
    v_mfma_f32_16x16x32_bf16 v[176:179], a[224:227], v[72:75], v[176:179]
    v_mfma_f32_16x16x32_bf16 v[176:179], a[240:243], v[76:79], v[176:179]
    v_cvt_pk_bf16_f32 v0, v96, v97
    v_cvt_pk_bf16_f32 v1, v98, v99
    v_mfma_f32_16x16x32_bf16 v[180:183], a[228:231], v[72:75], v[180:183]
    v_cvt_pk_bf16_f32 v2, v100, v101
    v_cvt_pk_bf16_f32 v3, v102, v103
    v_mfma_f32_16x16x32_bf16 v[180:183], a[244:247], v[76:79], v[180:183]
    v_cvt_pk_bf16_f32 v4, v104, v105
    v_cvt_pk_bf16_f32 v5, v106, v107
    v_mfma_f32_16x16x32_bf16 v[184:187], a[232:235], v[72:75], v[184:187]
    v_cvt_pk_bf16_f32 v6, v108, v109
    v_cvt_pk_bf16_f32 v7, v110, v111
    v_mfma_f32_16x16x32_bf16 v[184:187], a[248:251], v[76:79], v[184:187]
    v_cvt_pk_bf16_f32 v8, v112, v113
    v_cvt_pk_bf16_f32 v9, v114, v115
    v_mfma_f32_16x16x32_bf16 v[188:191], a[236:239], v[72:75], v[188:191]
    v_cvt_pk_bf16_f32 v10, v116, v117
    v_cvt_pk_bf16_f32 v11, v118, v119
    v_mfma_f32_16x16x32_bf16 v[188:191], a[252:255], v[76:79], v[188:191]
    v_cvt_pk_bf16_f32 v12, v120, v121
    v_cvt_pk_bf16_f32 v13, v122, v123
    s_waitcnt vmcnt(16) lgkmcnt(0)
    s_barrier
    v_mfma_f32_16x16x32_bf16 v[192:195], a[224:227], v[80:83], v[192:195]
    ds_read_b128 v[64:67], v224 offset:0
    v_cvt_pk_bf16_f32 v14, v124, v125
    v_cvt_pk_bf16_f32 v15, v126, v127
    v_mfma_f32_16x16x32_bf16 v[192:195], a[240:243], v[84:87], v[192:195]
    ds_read_b128 v[68:71], v225 offset:0
    v_cvt_pk_bf16_f32 v16, v128, v129
    v_cvt_pk_bf16_f32 v17, v130, v131
    v_mfma_f32_16x16x32_bf16 v[196:199], a[228:231], v[80:83], v[196:199]
    ds_read_b128 v[72:75], v224 offset:8192
    v_cvt_pk_bf16_f32 v18, v132, v133
    v_cvt_pk_bf16_f32 v19, v134, v135
    v_mfma_f32_16x16x32_bf16 v[196:199], a[244:247], v[84:87], v[196:199]
    ds_read_b128 v[76:79], v225 offset:8192
    v_cvt_pk_bf16_f32 v20, v136, v137
    v_cvt_pk_bf16_f32 v21, v138, v139
    v_mfma_f32_16x16x32_bf16 v[200:203], a[232:235], v[80:83], v[200:203]
    v_cvt_pk_bf16_f32 v22, v140, v141
    v_cvt_pk_bf16_f32 v23, v142, v143
    v_mfma_f32_16x16x32_bf16 v[200:203], a[248:251], v[84:87], v[200:203]
    v_cvt_pk_bf16_f32 v24, v144, v145
    v_cvt_pk_bf16_f32 v25, v146, v147
    v_mfma_f32_16x16x32_bf16 v[204:207], a[236:239], v[80:83], v[204:207]
    v_cvt_pk_bf16_f32 v26, v148, v149
    v_cvt_pk_bf16_f32 v27, v150, v151
    v_mfma_f32_16x16x32_bf16 v[204:207], a[252:255], v[84:87], v[204:207]
    v_cvt_pk_bf16_f32 v28, v152, v153
    v_cvt_pk_bf16_f32 v29, v154, v155
    v_mfma_f32_16x16x32_bf16 v[208:211], a[224:227], v[88:91], v[208:211]
    s_add_u32 m0, s34, 49152
    s_add_u32 s37, s86, 131072
    buffer_load_dwordx4 v232, s[44:47], s37 offen lds
    v_cvt_pk_bf16_f32 v30, v156, v157
    v_cvt_pk_bf16_f32 v31, v158, v159
    v_mfma_f32_16x16x32_bf16 v[208:211], a[240:243], v[92:95], v[208:211]
    v_cvt_pk_bf16_f32 v32, v160, v161
    v_cvt_pk_bf16_f32 v33, v162, v163
    v_mfma_f32_16x16x32_bf16 v[212:215], a[228:231], v[88:91], v[212:215]
    v_cvt_pk_bf16_f32 v34, v164, v165
    v_cvt_pk_bf16_f32 v35, v166, v167
    v_mfma_f32_16x16x32_bf16 v[212:215], a[244:247], v[92:95], v[212:215]
    v_cvt_pk_bf16_f32 v36, v168, v169
    v_cvt_pk_bf16_f32 v37, v170, v171
    v_mfma_f32_16x16x32_bf16 v[216:219], a[232:235], v[88:91], v[216:219]
    buffer_load_dwordx4 v233, s[44:47], s37 offen offset:1024 lds
    v_cvt_pk_bf16_f32 v38, v172, v173
    v_cvt_pk_bf16_f32 v39, v174, v175
    v_mfma_f32_16x16x32_bf16 v[216:219], a[248:251], v[92:95], v[216:219]
    v_cvt_pk_bf16_f32 v40, v176, v177
    v_cvt_pk_bf16_f32 v41, v178, v179
    v_mfma_f32_16x16x32_bf16 v[220:223], a[236:239], v[88:91], v[220:223]
    v_cvt_pk_bf16_f32 v42, v180, v181
    v_cvt_pk_bf16_f32 v43, v182, v183
    v_mfma_f32_16x16x32_bf16 v[220:223], a[252:255], v[92:95], v[220:223]
    v_cvt_pk_bf16_f32 v44, v184, v185
    v_cvt_pk_bf16_f32 v45, v186, v187
    s_waitcnt lgkmcnt(0)
    v_mfma_f32_16x16x32_bf16 v[96:99], a[0:3], v[64:67], 0
    ds_read_b128 v[80:83], v224 offset:2048
    v_cvt_pk_bf16_f32 v46, v188, v189
    v_cvt_pk_bf16_f32 v47, v190, v191
    v_mfma_f32_16x16x32_bf16 v[96:99], a[16:19], v[68:71], v[96:99]
    ds_read_b128 v[84:87], v225 offset:2048
    v_cvt_pk_bf16_f32 v48, v192, v193
    v_cvt_pk_bf16_f32 v49, v194, v195
    v_mfma_f32_16x16x32_bf16 v[96:99], a[32:35], v[72:75], v[96:99]
    ds_read_b128 v[88:91], v224 offset:10240
    v_cvt_pk_bf16_f32 v50, v196, v197
    v_cvt_pk_bf16_f32 v51, v198, v199
    v_mfma_f32_16x16x32_bf16 v[96:99], a[48:51], v[76:79], v[96:99]
    ds_read_b128 v[92:95], v225 offset:10240
    v_cvt_pk_bf16_f32 v52, v200, v201
    v_cvt_pk_bf16_f32 v53, v202, v203
    v_mfma_f32_16x16x32_bf16 v[100:103], a[4:7], v[64:67], 0
    v_cvt_pk_bf16_f32 v54, v204, v205
    v_cvt_pk_bf16_f32 v55, v206, v207
    s_add_u32 s38, s36, 0
    buffer_store_dwordx4 v[0:3], v240, s[16:19], s38 offen offset:0 sc1
    v_mfma_f32_16x16x32_bf16 v[100:103], a[20:23], v[68:71], v[100:103]
    v_cvt_pk_bf16_f32 v56, v208, v209
    v_cvt_pk_bf16_f32 v57, v210, v211
    v_mfma_f32_16x16x32_bf16 v[100:103], a[36:39], v[72:75], v[100:103]
    v_cvt_pk_bf16_f32 v58, v212, v213
    v_cvt_pk_bf16_f32 v59, v214, v215
    v_mfma_f32_16x16x32_bf16 v[100:103], a[52:55], v[76:79], v[100:103]
    v_cvt_pk_bf16_f32 v60, v216, v217
    v_cvt_pk_bf16_f32 v61, v218, v219
    v_mfma_f32_16x16x32_bf16 v[104:107], a[8:11], v[64:67], 0
    v_xor_b32 v237, 16, v245
    v_xor_b32 v238, 16, v246
    v_cvt_pk_bf16_f32 v62, v220, v221
    v_cvt_pk_bf16_f32 v63, v222, v223
    v_mfma_f32_16x16x32_bf16 v[104:107], a[24:27], v[68:71], v[104:107]
    v_mfma_f32_16x16x32_bf16 v[104:107], a[40:43], v[72:75], v[104:107]
    v_mfma_f32_16x16x32_bf16 v[104:107], a[56:59], v[76:79], v[104:107]
    v_mfma_f32_16x16x32_bf16 v[108:111], a[12:15], v[64:67], 0
    v_mfma_f32_16x16x32_bf16 v[108:111], a[28:31], v[68:71], v[108:111]
    v_mfma_f32_16x16x32_bf16 v[108:111], a[44:47], v[72:75], v[108:111]
    v_mfma_f32_16x16x32_bf16 v[108:111], a[60:63], v[76:79], v[108:111]
    s_waitcnt lgkmcnt(0)
    v_mfma_f32_16x16x32_bf16 v[112:115], a[0:3], v[80:83], 0
    ds_read_b128 v[64:67], v224 offset:4096
    v_mfma_f32_16x16x32_bf16 v[112:115], a[16:19], v[84:87], v[112:115]
    ds_read_b128 v[68:71], v225 offset:4096
    v_mfma_f32_16x16x32_bf16 v[112:115], a[32:35], v[88:91], v[112:115]
    ds_read_b128 v[72:75], v224 offset:12288
    v_mfma_f32_16x16x32_bf16 v[112:115], a[48:51], v[92:95], v[112:115]
    ds_read_b128 v[76:79], v225 offset:12288
    v_mfma_f32_16x16x32_bf16 v[116:119], a[4:7], v[80:83], 0
    v_mfma_f32_16x16x32_bf16 v[116:119], a[20:23], v[84:87], v[116:119]
    v_mfma_f32_16x16x32_bf16 v[116:119], a[36:39], v[88:91], v[116:119]
    v_mfma_f32_16x16x32_bf16 v[116:119], a[52:55], v[92:95], v[116:119]
    v_mfma_f32_16x16x32_bf16 v[120:123], a[8:11], v[80:83], 0
    s_add_u32 m0, s34, 57344
    s_add_u32 s37, s87, 131072
    buffer_load_dwordx4 v232, s[44:47], s37 offen lds
    v_mfma_f32_16x16x32_bf16 v[120:123], a[24:27], v[84:87], v[120:123]
    s_add_u32 s38, s36, 0
    buffer_store_dwordx4 v[4:7], v240, s[16:19], s38 offen offset:2048 sc1
    v_mfma_f32_16x16x32_bf16 v[120:123], a[40:43], v[88:91], v[120:123]
    v_mfma_f32_16x16x32_bf16 v[120:123], a[56:59], v[92:95], v[120:123]
    v_mfma_f32_16x16x32_bf16 v[124:127], a[12:15], v[80:83], 0
    buffer_load_dwordx4 v233, s[44:47], s37 offen offset:1024 lds
    v_mfma_f32_16x16x32_bf16 v[124:127], a[28:31], v[84:87], v[124:127]
    v_mfma_f32_16x16x32_bf16 v[124:127], a[44:47], v[88:91], v[124:127]
    v_mfma_f32_16x16x32_bf16 v[124:127], a[60:63], v[92:95], v[124:127]
    s_waitcnt lgkmcnt(0)
    v_mfma_f32_16x16x32_bf16 v[128:131], a[0:3], v[64:67], 0
    ds_read_b128 v[80:83], v224 offset:6144
    v_mfma_f32_16x16x32_bf16 v[128:131], a[16:19], v[68:71], v[128:131]
    ds_read_b128 v[84:87], v225 offset:6144
    v_mfma_f32_16x16x32_bf16 v[128:131], a[32:35], v[72:75], v[128:131]
    ds_read_b128 v[88:91], v224 offset:14336
    v_mfma_f32_16x16x32_bf16 v[128:131], a[48:51], v[76:79], v[128:131]
    ds_read_b128 v[92:95], v225 offset:14336
    v_mfma_f32_16x16x32_bf16 v[132:135], a[4:7], v[64:67], 0
    v_mfma_f32_16x16x32_bf16 v[132:135], a[20:23], v[68:71], v[132:135]
    v_mfma_f32_16x16x32_bf16 v[132:135], a[36:39], v[72:75], v[132:135]
    v_mfma_f32_16x16x32_bf16 v[132:135], a[52:55], v[76:79], v[132:135]
    v_mfma_f32_16x16x32_bf16 v[136:139], a[8:11], v[64:67], 0
    s_waitcnt vmcnt(15)
    v_readfirstlane_b32 s24, v254
    s_lshl_b32 s25, s3, 16
    s_add_u32 s24, s24, s25
    s_cmp_ge_u32 s24, 1
    s_cbranch_scc0 kf_spin47
kf_spinr48:
    v_mfma_f32_16x16x32_bf16 v[136:139], a[24:27], v[68:71], v[136:139]
    v_mfma_f32_16x16x32_bf16 v[136:139], a[40:43], v[72:75], v[136:139]
    v_mfma_f32_16x16x32_bf16 v[136:139], a[56:59], v[76:79], v[136:139]
    v_mfma_f32_16x16x32_bf16 v[140:143], a[12:15], v[64:67], 0
    s_add_u32 s88, s20, 0x14a0000
    s_addc_u32 s89, s21, 0
    s_mov_b32 s90, 20480
    v_mfma_f32_16x16x32_bf16 v[140:143], a[28:31], v[68:71], v[140:143]
    v_mfma_f32_16x16x32_bf16 v[140:143], a[44:47], v[72:75], v[140:143]
    v_mfma_f32_16x16x32_bf16 v[140:143], a[60:63], v[76:79], v[140:143]
    s_add_u32 s38, s36, 0
    buffer_store_dwordx4 v[8:11], v240, s[16:19], s38 offen offset:1024 sc1
    s_waitcnt vmcnt(7) lgkmcnt(0)
    s_barrier
    v_mfma_f32_16x16x32_bf16 v[144:147], a[0:3], v[80:83], 0
    ds_read_b128 v[64:67], v224 offset:16384
    v_mfma_f32_16x16x32_bf16 v[144:147], a[16:19], v[84:87], v[144:147]
    ds_read_b128 v[68:71], v225 offset:16384
    v_mfma_f32_16x16x32_bf16 v[144:147], a[32:35], v[88:91], v[144:147]
    ds_read_b128 v[72:75], v224 offset:24576
    v_mfma_f32_16x16x32_bf16 v[144:147], a[48:51], v[92:95], v[144:147]
    ds_read_b128 v[76:79], v225 offset:24576
    v_mfma_f32_16x16x32_bf16 v[148:151], a[4:7], v[80:83], 0
    v_mfma_f32_16x16x32_bf16 v[148:151], a[20:23], v[84:87], v[148:151]
    v_mfma_f32_16x16x32_bf16 v[148:151], a[36:39], v[88:91], v[148:151]
    v_mfma_f32_16x16x32_bf16 v[148:151], a[52:55], v[92:95], v[148:151]
    v_mfma_f32_16x16x32_bf16 v[152:155], a[8:11], v[80:83], 0
    s_add_u32 m0, s34, 0
    s_add_u32 s37, s80, 196608
    buffer_load_dwordx4 v232, s[44:47], s37 offen lds
    v_mfma_f32_16x16x32_bf16 v[152:155], a[24:27], v[84:87], v[152:155]
    v_mfma_f32_16x16x32_bf16 v[152:155], a[40:43], v[88:91], v[152:155]
    buffer_load_dwordx4 v233, s[44:47], s37 offen offset:1024 lds
    v_mfma_f32_16x16x32_bf16 v[152:155], a[56:59], v[92:95], v[152:155]
    v_mfma_f32_16x16x32_bf16 v[156:159], a[12:15], v[80:83], 0
    v_mfma_f32_16x16x32_bf16 v[156:159], a[28:31], v[84:87], v[156:159]
    s_lshl_b32 s39, s5, 7
    s_add_u32 s39, s39, 8192
    buffer_atomic_add v255, v250, s[88:91], s39 offen sc1
    s_cmp_eq_u32 s3, 0
    s_cselect_b32 s39, s39, s43
    v_mfma_f32_16x16x32_bf16 v[156:159], a[44:47], v[88:91], v[156:159]
    v_mfma_f32_16x16x32_bf16 v[156:159], a[60:63], v[92:95], v[156:159]
    s_waitcnt lgkmcnt(0)
    v_mfma_f32_16x16x32_bf16 v[96:99], a[64:67], v[64:67], v[96:99]
    ds_read_b128 v[80:83], v224 offset:18432
    v_mfma_f32_16x16x32_bf16 v[96:99], a[80:83], v[68:71], v[96:99]
    ds_read_b128 v[84:87], v225 offset:18432
    v_mfma_f32_16x16x32_bf16 v[96:99], a[96:99], v[72:75], v[96:99]
    ds_read_b128 v[88:91], v224 offset:26624
    v_mfma_f32_16x16x32_bf16 v[96:99], a[112:115], v[76:79], v[96:99]
    ds_read_b128 v[92:95], v225 offset:26624
    v_mfma_f32_16x16x32_bf16 v[100:103], a[68:71], v[64:67], v[100:103]
    s_add_u32 s38, s36, 0
    buffer_store_dwordx4 v[12:15], v240, s[16:19], s38 offen offset:3072 sc1
    v_mfma_f32_16x16x32_bf16 v[100:103], a[84:87], v[68:71], v[100:103]
    v_mfma_f32_16x16x32_bf16 v[100:103], a[100:103], v[72:75], v[100:103]
    v_mfma_f32_16x16x32_bf16 v[100:103], a[116:119], v[76:79], v[100:103]
    v_mfma_f32_16x16x32_bf16 v[104:107], a[72:75], v[64:67], v[104:107]
    s_add_u32 m0, s31, 0
    s_add_u32 s24, s27, 0
    buffer_load_dwordx4 v245, s[12:15], s24 offen lds
    v_mfma_f32_16x16x32_bf16 v[104:107], a[88:91], v[68:71], v[104:107]
    v_mfma_f32_16x16x32_bf16 v[104:107], a[104:107], v[72:75], v[104:107]
    v_mfma_f32_16x16x32_bf16 v[104:107], a[120:123], v[76:79], v[104:107]
    v_mfma_f32_16x16x32_bf16 v[108:111], a[76:79], v[64:67], v[108:111]
    v_mfma_f32_16x16x32_bf16 v[108:111], a[92:95], v[68:71], v[108:111]
    v_mfma_f32_16x16x32_bf16 v[108:111], a[108:111], v[72:75], v[108:111]
    v_mfma_f32_16x16x32_bf16 v[108:111], a[124:127], v[76:79], v[108:111]
    s_waitcnt lgkmcnt(0)
    v_mfma_f32_16x16x32_bf16 v[112:115], a[64:67], v[80:83], v[112:115]
    ds_read_b128 v[64:67], v224 offset:20480
    v_mfma_f32_16x16x32_bf16 v[112:115], a[80:83], v[84:87], v[112:115]
    ds_read_b128 v[68:71], v225 offset:20480
    v_mfma_f32_16x16x32_bf16 v[112:115], a[96:99], v[88:91], v[112:115]
    ds_read_b128 v[72:75], v224 offset:28672
    v_mfma_f32_16x16x32_bf16 v[112:115], a[112:115], v[92:95], v[112:115]
    ds_read_b128 v[76:79], v225 offset:28672
    v_mfma_f32_16x16x32_bf16 v[116:119], a[68:71], v[80:83], v[116:119]
    v_mfma_f32_16x16x32_bf16 v[116:119], a[84:87], v[84:87], v[116:119]
    v_mfma_f32_16x16x32_bf16 v[116:119], a[100:103], v[88:91], v[116:119]
    v_mfma_f32_16x16x32_bf16 v[116:119], a[116:119], v[92:95], v[116:119]
    v_mfma_f32_16x16x32_bf16 v[120:123], a[72:75], v[80:83], v[120:123]
    s_add_u32 m0, s34, 8192
    s_add_u32 s37, s81, 196608
    buffer_load_dwordx4 v232, s[44:47], s37 offen lds
    v_mfma_f32_16x16x32_bf16 v[120:123], a[88:91], v[84:87], v[120:123]
    v_mfma_f32_16x16x32_bf16 v[120:123], a[104:107], v[88:91], v[120:123]
    buffer_load_dwordx4 v233, s[44:47], s37 offen offset:1024 lds
    s_add_u32 s38, s36, 8192
    buffer_store_dwordx4 v[16:19], v240, s[16:19], s38 offen offset:0 sc1
    v_mfma_f32_16x16x32_bf16 v[120:123], a[120:123], v[92:95], v[120:123]
    v_mfma_f32_16x16x32_bf16 v[124:127], a[76:79], v[80:83], v[124:127]
    v_mfma_f32_16x16x32_bf16 v[124:127], a[92:95], v[84:87], v[124:127]
    s_add_u32 m0, s31, 1024
    s_add_u32 s24, s27, 32768
    buffer_load_dwordx4 v245, s[12:15], s24 offen lds
    v_mfma_f32_16x16x32_bf16 v[124:127], a[108:111], v[88:91], v[124:127]
    v_mfma_f32_16x16x32_bf16 v[124:127], a[124:127], v[92:95], v[124:127]
    s_waitcnt lgkmcnt(0)
    v_mfma_f32_16x16x32_bf16 v[128:131], a[64:67], v[64:67], v[128:131]
    ds_read_b128 v[80:83], v224 offset:22528
    v_mfma_f32_16x16x32_bf16 v[128:131], a[80:83], v[68:71], v[128:131]
    ds_read_b128 v[84:87], v225 offset:22528
    v_mfma_f32_16x16x32_bf16 v[128:131], a[96:99], v[72:75], v[128:131]
    ds_read_b128 v[88:91], v224 offset:30720
    v_mfma_f32_16x16x32_bf16 v[128:131], a[112:115], v[76:79], v[128:131]
    ds_read_b128 v[92:95], v225 offset:30720
    v_mfma_f32_16x16x32_bf16 v[132:135], a[68:71], v[64:67], v[132:135]
    v_mfma_f32_16x16x32_bf16 v[132:135], a[84:87], v[68:71], v[132:135]
    v_mfma_f32_16x16x32_bf16 v[132:135], a[100:103], v[72:75], v[132:135]
    v_mfma_f32_16x16x32_bf16 v[132:135], a[116:119], v[76:79], v[132:135]
    v_mfma_f32_16x16x32_bf16 v[136:139], a[72:75], v[64:67], v[136:139]
    s_add_u32 m0, s31, 2048
    s_add_u32 s24, s27, 65536
    buffer_load_dwordx4 v237, s[12:15], s24 offen lds
    v_mfma_f32_16x16x32_bf16 v[136:139], a[88:91], v[68:71], v[136:139]
    v_mfma_f32_16x16x32_bf16 v[136:139], a[104:107], v[72:75], v[136:139]
    v_mfma_f32_16x16x32_bf16 v[136:139], a[120:123], v[76:79], v[136:139]
    v_mfma_f32_16x16x32_bf16 v[140:143], a[76:79], v[64:67], v[140:143]
    v_mfma_f32_16x16x32_bf16 v[140:143], a[92:95], v[68:71], v[140:143]
    v_mfma_f32_16x16x32_bf16 v[140:143], a[108:111], v[72:75], v[140:143]
    v_mfma_f32_16x16x32_bf16 v[140:143], a[124:127], v[76:79], v[140:143]
    s_add_u32 s38, s36, 8192
    buffer_store_dwordx4 v[20:23], v240, s[16:19], s38 offen offset:2048 sc1
    s_waitcnt vmcnt(19) lgkmcnt(0)
    s_barrier
    v_mfma_f32_16x16x32_bf16 v[144:147], a[64:67], v[80:83], v[144:147]
    ds_read_b128 v[64:67], v224 offset:32768
    v_mfma_f32_16x16x32_bf16 v[144:147], a[80:83], v[84:87], v[144:147]
    ds_read_b128 v[68:71], v225 offset:32768
    v_mfma_f32_16x16x32_bf16 v[144:147], a[96:99], v[88:91], v[144:147]
    ds_read_b128 v[72:75], v224 offset:40960
    v_mfma_f32_16x16x32_bf16 v[144:147], a[112:115], v[92:95], v[144:147]
    ds_read_b128 v[76:79], v225 offset:40960
    v_mfma_f32_16x16x32_bf16 v[148:151], a[68:71], v[80:83], v[148:151]
    v_mfma_f32_16x16x32_bf16 v[148:151], a[84:87], v[84:87], v[148:151]
    v_mfma_f32_16x16x32_bf16 v[148:151], a[100:103], v[88:91], v[148:151]
    v_mfma_f32_16x16x32_bf16 v[148:151], a[116:119], v[92:95], v[148:151]
    v_mfma_f32_16x16x32_bf16 v[152:155], a[72:75], v[80:83], v[152:155]
    s_add_u32 m0, s34, 16384
    s_add_u32 s37, s82, 196608
    buffer_load_dwordx4 v232, s[44:47], s37 offen lds
    v_mfma_f32_16x16x32_bf16 v[152:155], a[88:91], v[84:87], v[152:155]
    v_mfma_f32_16x16x32_bf16 v[152:155], a[104:107], v[88:91], v[152:155]
    buffer_load_dwordx4 v233, s[44:47], s37 offen offset:1024 lds
    v_mfma_f32_16x16x32_bf16 v[152:155], a[120:123], v[92:95], v[152:155]
    v_mfma_f32_16x16x32_bf16 v[156:159], a[76:79], v[80:83], v[156:159]
    v_mfma_f32_16x16x32_bf16 v[156:159], a[92:95], v[84:87], v[156:159]
    s_add_u32 m0, s31, 3072
    s_add_u32 s24, s27, 98304
    buffer_load_dwordx4 v237, s[12:15], s24 offen lds
    v_mfma_f32_16x16x32_bf16 v[156:159], a[108:111], v[88:91], v[156:159]
    v_mfma_f32_16x16x32_bf16 v[156:159], a[124:127], v[92:95], v[156:159]
    s_waitcnt lgkmcnt(0)
    v_mfma_f32_16x16x32_bf16 v[96:99], a[128:131], v[64:67], v[96:99]
    ds_read_b128 v[80:83], v224 offset:34816
    v_mfma_f32_16x16x32_bf16 v[96:99], a[144:147], v[68:71], v[96:99]
    ds_read_b128 v[84:87], v225 offset:34816
    v_mfma_f32_16x16x32_bf16 v[96:99], a[160:163], v[72:75], v[96:99]
    ds_read_b128 v[88:91], v224 offset:43008
    v_mfma_f32_16x16x32_bf16 v[96:99], a[176:179], v[76:79], v[96:99]
    ds_read_b128 v[92:95], v225 offset:43008
    v_mfma_f32_16x16x32_bf16 v[100:103], a[132:135], v[64:67], v[100:103]
    v_mfma_f32_16x16x32_bf16 v[100:103], a[148:151], v[68:71], v[100:103]
    s_add_u32 s38, s36, 8192
    buffer_store_dwordx4 v[24:27], v240, s[16:19], s38 offen offset:1024 sc1
    v_mfma_f32_16x16x32_bf16 v[100:103], a[164:167], v[72:75], v[100:103]
    v_mfma_f32_16x16x32_bf16 v[100:103], a[180:183], v[76:79], v[100:103]
    v_mfma_f32_16x16x32_bf16 v[104:107], a[136:139], v[64:67], v[104:107]
    s_add_u32 m0, s31, 4096
    s_add_u32 s24, s27, 131072
    buffer_load_dwordx4 v245, s[12:15], s24 offen lds
    v_mfma_f32_16x16x32_bf16 v[104:107], a[152:155], v[68:71], v[104:107]
    v_mfma_f32_16x16x32_bf16 v[104:107], a[168:171], v[72:75], v[104:107]
    v_mfma_f32_16x16x32_bf16 v[104:107], a[184:187], v[76:79], v[104:107]
    v_mfma_f32_16x16x32_bf16 v[108:111], a[140:143], v[64:67], v[108:111]
    v_mfma_f32_16x16x32_bf16 v[108:111], a[156:159], v[68:71], v[108:111]
    v_mfma_f32_16x16x32_bf16 v[108:111], a[172:175], v[72:75], v[108:111]
    v_mfma_f32_16x16x32_bf16 v[108:111], a[188:191], v[76:79], v[108:111]
    s_waitcnt lgkmcnt(0)
    v_mfma_f32_16x16x32_bf16 v[112:115], a[128:131], v[80:83], v[112:115]
    ds_read_b128 v[64:67], v224 offset:36864
    v_mfma_f32_16x16x32_bf16 v[112:115], a[144:147], v[84:87], v[112:115]
    ds_read_b128 v[68:71], v225 offset:36864
    v_mfma_f32_16x16x32_bf16 v[112:115], a[160:163], v[88:91], v[112:115]
    ds_read_b128 v[72:75], v224 offset:45056
    v_mfma_f32_16x16x32_bf16 v[112:115], a[176:179], v[92:95], v[112:115]
    ds_read_b128 v[76:79], v225 offset:45056
    v_mfma_f32_16x16x32_bf16 v[116:119], a[132:135], v[80:83], v[116:119]
    v_mfma_f32_16x16x32_bf16 v[116:119], a[148:151], v[84:87], v[116:119]
    v_mfma_f32_16x16x32_bf16 v[116:119], a[164:167], v[88:91], v[116:119]
    v_mfma_f32_16x16x32_bf16 v[116:119], a[180:183], v[92:95], v[116:119]
    v_mfma_f32_16x16x32_bf16 v[120:123], a[136:139], v[80:83], v[120:123]
    s_add_u32 m0, s34, 24576
    s_add_u32 s37, s83, 196608
    buffer_load_dwordx4 v232, s[44:47], s37 offen lds
    v_mfma_f32_16x16x32_bf16 v[120:123], a[152:155], v[84:87], v[120:123]
    v_mfma_f32_16x16x32_bf16 v[120:123], a[168:171], v[88:91], v[120:123]
    buffer_load_dwordx4 v233, s[44:47], s37 offen offset:1024 lds
    s_add_u32 s38, s36, 8192
    buffer_store_dwordx4 v[28:31], v240, s[16:19], s38 offen offset:3072 sc1
    v_mfma_f32_16x16x32_bf16 v[120:123], a[184:187], v[92:95], v[120:123]
    v_mfma_f32_16x16x32_bf16 v[124:127], a[140:143], v[80:83], v[124:127]
    v_mfma_f32_16x16x32_bf16 v[124:127], a[156:159], v[84:87], v[124:127]
    s_add_u32 m0, s31, 5120
    s_add_u32 s24, s27, 163840
    buffer_load_dwordx4 v245, s[12:15], s24 offen lds
    v_mfma_f32_16x16x32_bf16 v[124:127], a[172:175], v[88:91], v[124:127]
    v_mfma_f32_16x16x32_bf16 v[124:127], a[188:191], v[92:95], v[124:127]
    s_waitcnt lgkmcnt(0)
    v_mfma_f32_16x16x32_bf16 v[128:131], a[128:131], v[64:67], v[128:131]
    ds_read_b128 v[80:83], v224 offset:38912
    v_mfma_f32_16x16x32_bf16 v[128:131], a[144:147], v[68:71], v[128:131]
    ds_read_b128 v[84:87], v225 offset:38912
    v_mfma_f32_16x16x32_bf16 v[128:131], a[160:163], v[72:75], v[128:131]
    ds_read_b128 v[88:91], v224 offset:47104
    v_mfma_f32_16x16x32_bf16 v[128:131], a[176:179], v[76:79], v[128:131]
    ds_read_b128 v[92:95], v225 offset:47104
    v_mfma_f32_16x16x32_bf16 v[132:135], a[132:135], v[64:67], v[132:135]
    v_mfma_f32_16x16x32_bf16 v[132:135], a[148:151], v[68:71], v[132:135]
    v_mfma_f32_16x16x32_bf16 v[132:135], a[164:167], v[72:75], v[132:135]
    v_mfma_f32_16x16x32_bf16 v[132:135], a[180:183], v[76:79], v[132:135]
    v_mfma_f32_16x16x32_bf16 v[136:139], a[136:139], v[64:67], v[136:139]
    s_add_u32 m0, s31, 6144
    s_add_u32 s24, s27, 196608
    buffer_load_dwordx4 v237, s[12:15], s24 offen lds
    v_mfma_f32_16x16x32_bf16 v[136:139], a[152:155], v[68:71], v[136:139]
    v_mfma_f32_16x16x32_bf16 v[136:139], a[168:171], v[72:75], v[136:139]
    v_mfma_f32_16x16x32_bf16 v[136:139], a[184:187], v[76:79], v[136:139]
    v_mfma_f32_16x16x32_bf16 v[140:143], a[140:143], v[64:67], v[140:143]
    v_mfma_f32_16x16x32_bf16 v[140:143], a[156:159], v[68:71], v[140:143]
    v_mfma_f32_16x16x32_bf16 v[140:143], a[172:175], v[72:75], v[140:143]
    v_mfma_f32_16x16x32_bf16 v[140:143], a[188:191], v[76:79], v[140:143]
    s_waitcnt vmcnt(22) lgkmcnt(0)
    s_barrier
    v_mfma_f32_16x16x32_bf16 v[144:147], a[128:131], v[80:83], v[144:147]
    ds_read_b128 v[64:67], v224 offset:49152
    s_add_u32 s38, s36, 32768
    buffer_store_dwordx4 v[32:35], v240, s[16:19], s38 offen offset:1280 sc1
    v_mfma_f32_16x16x32_bf16 v[144:147], a[144:147], v[84:87], v[144:147]
    ds_read_b128 v[68:71], v225 offset:49152
    v_mfma_f32_16x16x32_bf16 v[144:147], a[160:163], v[88:91], v[144:147]
    ds_read_b128 v[72:75], v224 offset:57344
    v_mfma_f32_16x16x32_bf16 v[144:147], a[176:179], v[92:95], v[144:147]
    ds_read_b128 v[76:79], v225 offset:57344
    v_mfma_f32_16x16x32_bf16 v[148:151], a[132:135], v[80:83], v[148:151]
    v_mfma_f32_16x16x32_bf16 v[148:151], a[148:151], v[84:87], v[148:151]
    v_mfma_f32_16x16x32_bf16 v[148:151], a[164:167], v[88:91], v[148:151]
    v_mfma_f32_16x16x32_bf16 v[148:151], a[180:183], v[92:95], v[148:151]
    v_mfma_f32_16x16x32_bf16 v[152:155], a[136:139], v[80:83], v[152:155]
    s_add_u32 m0, s34, 32768
    s_add_u32 s37, s84, 196608
    buffer_load_dwordx4 v232, s[44:47], s37 offen lds
    v_mfma_f32_16x16x32_bf16 v[152:155], a[152:155], v[84:87], v[152:155]
    buffer_load_dwordx4 v233, s[44:47], s37 offen offset:1024 lds
    v_mfma_f32_16x16x32_bf16 v[152:155], a[168:171], v[88:91], v[152:155]
    v_mfma_f32_16x16x32_bf16 v[152:155], a[184:187], v[92:95], v[152:155]
    s_add_u32 m0, s31, 7168
    s_add_u32 s24, s27, 229376
    buffer_load_dwordx4 v237, s[12:15], s24 offen lds
    v_mfma_f32_16x16x32_bf16 v[156:159], a[140:143], v[80:83], v[156:159]
    s_add_u32 s27, s27, 1048576
    s_and_b32 s27, s27, 0x407fffff
    s_cmp_eq_u32 s27, s7
    s_cselect_b32 s27, s43, s27
    v_mfma_f32_16x16x32_bf16 v[156:159], a[156:159], v[84:87], v[156:159]
    v_mfma_f32_16x16x32_bf16 v[156:159], a[172:175], v[88:91], v[156:159]
    s_add_u32 s31, s31, 32768
    s_cmp_ge_u32 s31, 163840
    s_cselect_b32 s24, 98304, 0
    s_sub_u32 s31, s31, s24
    v_mfma_f32_16x16x32_bf16 v[156:159], a[188:191], v[92:95], v[156:159]
    s_waitcnt lgkmcnt(0)
    v_mfma_f32_16x16x32_bf16 v[96:99], a[192:195], v[64:67], v[96:99]
    ds_read_b128 v[80:83], v224 offset:51200
    v_mfma_f32_16x16x32_bf16 v[96:99], a[208:211], v[68:71], v[96:99]
    ds_read_b128 v[84:87], v225 offset:51200
    v_mfma_f32_16x16x32_bf16 v[96:99], a[224:227], v[72:75], v[96:99]
    ds_read_b128 v[88:91], v224 offset:59392
    v_mfma_f32_16x16x32_bf16 v[96:99], a[240:243], v[76:79], v[96:99]
    ds_read_b128 v[92:95], v225 offset:59392
    v_mfma_f32_16x16x32_bf16 v[100:103], a[196:199], v[64:67], v[100:103]
    v_mfma_f32_16x16x32_bf16 v[100:103], a[212:215], v[68:71], v[100:103]
    v_mfma_f32_16x16x32_bf16 v[100:103], a[228:231], v[72:75], v[100:103]
    s_add_u32 s38, s36, 32768
    buffer_store_dwordx4 v[36:39], v240, s[16:19], s38 offen offset:3328 sc1
    v_mfma_f32_16x16x32_bf16 v[100:103], a[244:247], v[76:79], v[100:103]
    v_mfma_f32_16x16x32_bf16 v[104:107], a[200:203], v[64:67], v[104:107]
    v_mfma_f32_16x16x32_bf16 v[104:107], a[216:219], v[68:71], v[104:107]
    v_mfma_f32_16x16x32_bf16 v[104:107], a[232:235], v[72:75], v[104:107]
    v_mfma_f32_16x16x32_bf16 v[104:107], a[248:251], v[76:79], v[104:107]
    v_mfma_f32_16x16x32_bf16 v[108:111], a[204:207], v[64:67], v[108:111]
    v_mfma_f32_16x16x32_bf16 v[108:111], a[220:223], v[68:71], v[108:111]
    v_mfma_f32_16x16x32_bf16 v[108:111], a[236:239], v[72:75], v[108:111]
    v_mfma_f32_16x16x32_bf16 v[108:111], a[252:255], v[76:79], v[108:111]
    s_waitcnt lgkmcnt(0)
    v_mfma_f32_16x16x32_bf16 v[112:115], a[192:195], v[80:83], v[112:115]
    ds_read_b128 v[64:67], v224 offset:53248
    v_mfma_f32_16x16x32_bf16 v[112:115], a[208:211], v[84:87], v[112:115]
    ds_read_b128 v[68:71], v225 offset:53248
    v_mfma_f32_16x16x32_bf16 v[112:115], a[224:227], v[88:91], v[112:115]
    ds_read_b128 v[72:75], v224 offset:61440
    v_mfma_f32_16x16x32_bf16 v[112:115], a[240:243], v[92:95], v[112:115]
    ds_read_b128 v[76:79], v225 offset:61440
    v_mfma_f32_16x16x32_bf16 v[116:119], a[196:199], v[80:83], v[116:119]
    v_mfma_f32_16x16x32_bf16 v[116:119], a[212:215], v[84:87], v[116:119]
    v_mfma_f32_16x16x32_bf16 v[116:119], a[228:231], v[88:91], v[116:119]
    v_mfma_f32_16x16x32_bf16 v[116:119], a[244:247], v[92:95], v[116:119]
    v_mfma_f32_16x16x32_bf16 v[120:123], a[200:203], v[80:83], v[120:123]
    s_add_u32 m0, s34, 40960
    s_add_u32 s37, s85, 196608
    buffer_load_dwordx4 v232, s[44:47], s37 offen lds
    v_mfma_f32_16x16x32_bf16 v[120:123], a[216:219], v[84:87], v[120:123]
    v_mfma_f32_16x16x32_bf16 v[120:123], a[232:235], v[88:91], v[120:123]
    v_mfma_f32_16x16x32_bf16 v[120:123], a[248:251], v[92:95], v[120:123]
    s_add_u32 s38, s36, 32768
    buffer_store_dwordx4 v[40:43], v240, s[16:19], s38 offen offset:2304 sc1
    v_mfma_f32_16x16x32_bf16 v[124:127], a[204:207], v[80:83], v[124:127]
    buffer_load_dwordx4 v233, s[44:47], s37 offen offset:1024 lds
    v_mfma_f32_16x16x32_bf16 v[124:127], a[220:223], v[84:87], v[124:127]
    v_mfma_f32_16x16x32_bf16 v[124:127], a[236:239], v[88:91], v[124:127]
    v_mfma_f32_16x16x32_bf16 v[124:127], a[252:255], v[92:95], v[124:127]
    s_waitcnt lgkmcnt(0)
    v_mfma_f32_16x16x32_bf16 v[128:131], a[192:195], v[64:67], v[128:131]
    ds_read_b128 v[80:83], v224 offset:55296
    v_mfma_f32_16x16x32_bf16 v[128:131], a[208:211], v[68:71], v[128:131]
    ds_read_b128 v[84:87], v225 offset:55296
    v_mfma_f32_16x16x32_bf16 v[128:131], a[224:227], v[72:75], v[128:131]
    ds_read_b128 v[88:91], v224 offset:63488
    v_mfma_f32_16x16x32_bf16 v[128:131], a[240:243], v[76:79], v[128:131]
    ds_read_b128 v[92:95], v225 offset:63488
    v_mfma_f32_16x16x32_bf16 v[132:135], a[196:199], v[64:67], v[132:135]
    v_mfma_f32_16x16x32_bf16 v[132:135], a[212:215], v[68:71], v[132:135]
    v_mfma_f32_16x16x32_bf16 v[132:135], a[228:231], v[72:75], v[132:135]
    v_mfma_f32_16x16x32_bf16 v[132:135], a[244:247], v[76:79], v[132:135]
    v_mfma_f32_16x16x32_bf16 v[136:139], a[200:203], v[64:67], v[136:139]
    s_add_u32 m0, s31, 0
    s_add_u32 s24, s27, 0
    buffer_load_dwordx4 v245, s[12:15], s24 offen lds
    v_mfma_f32_16x16x32_bf16 v[136:139], a[216:219], v[68:71], v[136:139]
    v_mfma_f32_16x16x32_bf16 v[136:139], a[232:235], v[72:75], v[136:139]
    v_mfma_f32_16x16x32_bf16 v[136:139], a[248:251], v[76:79], v[136:139]
    v_mfma_f32_16x16x32_bf16 v[140:143], a[204:207], v[64:67], v[140:143]
    v_mfma_f32_16x16x32_bf16 v[140:143], a[220:223], v[68:71], v[140:143]
    v_mfma_f32_16x16x32_bf16 v[140:143], a[236:239], v[72:75], v[140:143]
    v_mfma_f32_16x16x32_bf16 v[140:143], a[252:255], v[76:79], v[140:143]
    s_waitcnt vmcnt(23) lgkmcnt(0)
    s_barrier
    v_mfma_f32_16x16x32_bf16 v[144:147], a[192:195], v[80:83], v[144:147]
    ds_read_b128 v[64:67], v224 offset:0
    v_mfma_f32_16x16x32_bf16 v[144:147], a[208:211], v[84:87], v[144:147]
    ds_read_b128 v[68:71], v225 offset:0
    s_add_u32 s38, s36, 36864
    buffer_store_dwordx4 v[44:47], v240, s[16:19], s38 offen offset:256 sc1
    v_mfma_f32_16x16x32_bf16 v[144:147], a[224:227], v[88:91], v[144:147]
    ds_read_b128 v[72:75], v224 offset:8192
    v_mfma_f32_16x16x32_bf16 v[144:147], a[240:243], v[92:95], v[144:147]
    ds_read_b128 v[76:79], v225 offset:8192
    v_mfma_f32_16x16x32_bf16 v[148:151], a[196:199], v[80:83], v[148:151]
    v_mfma_f32_16x16x32_bf16 v[148:151], a[212:215], v[84:87], v[148:151]
    v_mfma_f32_16x16x32_bf16 v[148:151], a[228:231], v[88:91], v[148:151]
    v_mfma_f32_16x16x32_bf16 v[148:151], a[244:247], v[92:95], v[148:151]
    v_mfma_f32_16x16x32_bf16 v[152:155], a[200:203], v[80:83], v[152:155]
    s_add_u32 m0, s34, 49152
    s_add_u32 s37, s86, 196608
    buffer_load_dwordx4 v232, s[44:47], s37 offen lds
    v_mfma_f32_16x16x32_bf16 v[152:155], a[216:219], v[84:87], v[152:155]
    v_mfma_f32_16x16x32_bf16 v[152:155], a[232:235], v[88:91], v[152:155]
    buffer_load_dwordx4 v233, s[44:47], s37 offen offset:1024 lds
    v_mfma_f32_16x16x32_bf16 v[152:155], a[248:251], v[92:95], v[152:155]
    v_mfma_f32_16x16x32_bf16 v[156:159], a[204:207], v[80:83], v[156:159]
    v_mfma_f32_16x16x32_bf16 v[156:159], a[220:223], v[84:87], v[156:159]
    s_add_u32 m0, s31, 1024
    s_add_u32 s24, s27, 32768
    buffer_load_dwordx4 v245, s[12:15], s24 offen lds
    v_mfma_f32_16x16x32_bf16 v[156:159], a[236:239], v[88:91], v[156:159]
    v_mfma_f32_16x16x32_bf16 v[156:159], a[252:255], v[92:95], v[156:159]
    s_waitcnt lgkmcnt(0)
    v_mfma_f32_16x16x32_bf16 v[160:163], a[0:3], v[64:67], 0
    ds_read_b128 v[80:83], v224 offset:2048
    v_mfma_f32_16x16x32_bf16 v[160:163], a[16:19], v[68:71], v[160:163]
    ds_read_b128 v[84:87], v225 offset:2048
    v_mfma_f32_16x16x32_bf16 v[160:163], a[32:35], v[72:75], v[160:163]
    ds_read_b128 v[88:91], v224 offset:10240
    v_mfma_f32_16x16x32_bf16 v[160:163], a[48:51], v[76:79], v[160:163]
    ds_read_b128 v[92:95], v225 offset:10240
    v_mfma_f32_16x16x32_bf16 v[164:167], a[4:7], v[64:67], 0
    v_cvt_pk_bf16_f32 v0, v96, v97
    v_cvt_pk_bf16_f32 v1, v98, v99
    v_mfma_f32_16x16x32_bf16 v[164:167], a[20:23], v[68:71], v[164:167]
    v_mfma_f32_16x16x32_bf16 v[164:167], a[36:39], v[72:75], v[164:167]
    v_cvt_pk_bf16_f32 v2, v100, v101
    v_cvt_pk_bf16_f32 v3, v102, v103
    s_add_u32 s38, s36, 40960
    buffer_store_dwordx4 v[48:51], v240, s[16:19], s38 offen offset:1280 sc1
    v_mfma_f32_16x16x32_bf16 v[164:167], a[52:55], v[76:79], v[164:167]
    v_mfma_f32_16x16x32_bf16 v[168:171], a[8:11], v[64:67], 0
    s_add_u32 m0, s31, 2048
    s_add_u32 s24, s27, 65536
    buffer_load_dwordx4 v237, s[12:15], s24 offen lds
    v_cvt_pk_bf16_f32 v4, v104, v105
    v_cvt_pk_bf16_f32 v5, v106, v107
    v_mfma_f32_16x16x32_bf16 v[168:171], a[24:27], v[68:71], v[168:171]
    v_mfma_f32_16x16x32_bf16 v[168:171], a[40:43], v[72:75], v[168:171]
    v_cvt_pk_bf16_f32 v6, v108, v109
    v_cvt_pk_bf16_f32 v7, v110, v111
    v_mfma_f32_16x16x32_bf16 v[168:171], a[56:59], v[76:79], v[168:171]
    v_mfma_f32_16x16x32_bf16 v[172:175], a[12:15], v[64:67], 0
    v_cvt_pk_bf16_f32 v8, v112, v113
    v_cvt_pk_bf16_f32 v9, v114, v115
    v_mfma_f32_16x16x32_bf16 v[172:175], a[28:31], v[68:71], v[172:175]
    v_mfma_f32_16x16x32_bf16 v[172:175], a[44:47], v[72:75], v[172:175]
    v_cvt_pk_bf16_f32 v10, v116, v117
    v_cvt_pk_bf16_f32 v11, v118, v119
    v_mfma_f32_16x16x32_bf16 v[172:175], a[60:63], v[76:79], v[172:175]
    s_waitcnt lgkmcnt(0)
    v_mfma_f32_16x16x32_bf16 v[176:179], a[0:3], v[80:83], 0
    ds_read_b128 v[64:67], v224 offset:4096
    v_cvt_pk_bf16_f32 v12, v120, v121
    v_cvt_pk_bf16_f32 v13, v122, v123
    v_mfma_f32_16x16x32_bf16 v[176:179], a[16:19], v[84:87], v[176:179]
    ds_read_b128 v[68:71], v225 offset:4096
    v_mfma_f32_16x16x32_bf16 v[176:179], a[32:35], v[88:91], v[176:179]
    ds_read_b128 v[72:75], v224 offset:12288
    v_cvt_pk_bf16_f32 v14, v124, v125
    v_cvt_pk_bf16_f32 v15, v126, v127
    v_mfma_f32_16x16x32_bf16 v[176:179], a[48:51], v[92:95], v[176:179]
    ds_read_b128 v[76:79], v225 offset:12288
    v_mfma_f32_16x16x32_bf16 v[180:183], a[4:7], v[80:83], 0
    v_cvt_pk_bf16_f32 v16, v128, v129
    v_cvt_pk_bf16_f32 v17, v130, v131
    v_mfma_f32_16x16x32_bf16 v[180:183], a[20:23], v[84:87], v[180:183]
    v_mfma_f32_16x16x32_bf16 v[180:183], a[36:39], v[88:91], v[180:183]
    v_cvt_pk_bf16_f32 v18, v132, v133
    v_cvt_pk_bf16_f32 v19, v134, v135
    v_mfma_f32_16x16x32_bf16 v[180:183], a[52:55], v[92:95], v[180:183]
    v_mfma_f32_16x16x32_bf16 v[184:187], a[8:11], v[80:83], 0
    s_add_u32 m0, s34, 57344
    s_add_u32 s37, s87, 196608
    buffer_load_dwordx4 v232, s[44:47], s37 offen lds
    v_cvt_pk_bf16_f32 v20, v136, v137
    v_cvt_pk_bf16_f32 v21, v138, v139
    v_mfma_f32_16x16x32_bf16 v[184:187], a[24:27], v[84:87], v[184:187]
    v_mfma_f32_16x16x32_bf16 v[184:187], a[40:43], v[88:91], v[184:187]
    buffer_load_dwordx4 v233, s[44:47], s37 offen offset:1024 lds
    v_cvt_pk_bf16_f32 v22, v140, v141
    v_cvt_pk_bf16_f32 v23, v142, v143
    v_mfma_f32_16x16x32_bf16 v[184:187], a[56:59], v[92:95], v[184:187]
    v_mfma_f32_16x16x32_bf16 v[188:191], a[12:15], v[80:83], 0
    v_cvt_pk_bf16_f32 v24, v144, v145
    v_cvt_pk_bf16_f32 v25, v146, v147
    s_add_u32 s38, s36, 40960
    buffer_store_dwordx4 v[52:55], v240, s[16:19], s38 offen offset:3328 sc1
    v_mfma_f32_16x16x32_bf16 v[188:191], a[28:31], v[84:87], v[188:191]
    s_add_u32 m0, s31, 3072
    s_add_u32 s24, s27, 98304
    buffer_load_dwordx4 v237, s[12:15], s24 offen lds
    v_mfma_f32_16x16x32_bf16 v[188:191], a[44:47], v[88:91], v[188:191]
    v_cvt_pk_bf16_f32 v26, v148, v149
    v_cvt_pk_bf16_f32 v27, v150, v151
    v_mfma_f32_16x16x32_bf16 v[188:191], a[60:63], v[92:95], v[188:191]
    s_waitcnt lgkmcnt(0)
    v_mfma_f32_16x16x32_bf16 v[192:195], a[0:3], v[64:67], 0
    ds_read_b128 v[80:83], v224 offset:6144
    v_cvt_pk_bf16_f32 v28, v152, v153
    v_cvt_pk_bf16_f32 v29, v154, v155
    v_mfma_f32_16x16x32_bf16 v[192:195], a[16:19], v[68:71], v[192:195]
    ds_read_b128 v[84:87], v225 offset:6144
    v_mfma_f32_16x16x32_bf16 v[192:195], a[32:35], v[72:75], v[192:195]
    ds_read_b128 v[88:91], v224 offset:14336
    v_cvt_pk_bf16_f32 v30, v156, v157
    v_cvt_pk_bf16_f32 v31, v158, v159
    v_mfma_f32_16x16x32_bf16 v[192:195], a[48:51], v[76:79], v[192:195]
    ds_read_b128 v[92:95], v225 offset:14336
    v_mfma_f32_16x16x32_bf16 v[196:199], a[4:7], v[64:67], 0
    v_mfma_f32_16x16x32_bf16 v[196:199], a[20:23], v[68:71], v[196:199]
    v_mfma_f32_16x16x32_bf16 v[196:199], a[36:39], v[72:75], v[196:199]
    v_mfma_f32_16x16x32_bf16 v[196:199], a[52:55], v[76:79], v[196:199]
    v_mfma_f32_16x16x32_bf16 v[200:203], a[8:11], v[64:67], 0
    s_add_u32 m0, s31, 4096
    s_add_u32 s24, s27, 131072
    buffer_load_dwordx4 v245, s[12:15], s24 offen lds
    v_mfma_f32_16x16x32_bf16 v[200:203], a[24:27], v[68:71], v[200:203]
    v_mfma_f32_16x16x32_bf16 v[200:203], a[40:43], v[72:75], v[200:203]
    v_mfma_f32_16x16x32_bf16 v[200:203], a[56:59], v[76:79], v[200:203]
    v_mfma_f32_16x16x32_bf16 v[204:207], a[12:15], v[64:67], 0
    v_mfma_f32_16x16x32_bf16 v[204:207], a[28:31], v[68:71], v[204:207]
    v_mfma_f32_16x16x32_bf16 v[204:207], a[44:47], v[72:75], v[204:207]
    v_mfma_f32_16x16x32_bf16 v[204:207], a[60:63], v[76:79], v[204:207]
    s_waitcnt vmcnt(23) lgkmcnt(0)
    s_barrier
    v_mfma_f32_16x16x32_bf16 v[208:211], a[0:3], v[80:83], 0
    ds_read_b128 v[64:67], v224 offset:16384
    v_mfma_f32_16x16x32_bf16 v[208:211], a[16:19], v[84:87], v[208:211]
    ds_read_b128 v[68:71], v225 offset:16384
    s_add_u32 s38, s36, 40960
    buffer_store_dwordx4 v[56:59], v240, s[16:19], s38 offen offset:2304 sc1
    v_mfma_f32_16x16x32_bf16 v[208:211], a[32:35], v[88:91], v[208:211]
    ds_read_b128 v[72:75], v224 offset:24576
    v_mfma_f32_16x16x32_bf16 v[208:211], a[48:51], v[92:95], v[208:211]
    ds_read_b128 v[76:79], v225 offset:24576
    v_mfma_f32_16x16x32_bf16 v[212:215], a[4:7], v[80:83], 0
    v_mfma_f32_16x16x32_bf16 v[212:215], a[20:23], v[84:87], v[212:215]
    v_mfma_f32_16x16x32_bf16 v[212:215], a[36:39], v[88:91], v[212:215]
    v_mfma_f32_16x16x32_bf16 v[212:215], a[52:55], v[92:95], v[212:215]
    v_mfma_f32_16x16x32_bf16 v[216:219], a[8:11], v[80:83], 0
    s_add_u32 m0, s31, 5120
    s_add_u32 s24, s27, 163840
    buffer_load_dwordx4 v245, s[12:15], s24 offen lds
    v_mfma_f32_16x16x32_bf16 v[216:219], a[24:27], v[84:87], v[216:219]
    v_mfma_f32_16x16x32_bf16 v[216:219], a[40:43], v[88:91], v[216:219]
    v_mfma_f32_16x16x32_bf16 v[216:219], a[56:59], v[92:95], v[216:219]
    v_mfma_f32_16x16x32_bf16 v[220:223], a[12:15], v[80:83], 0
    v_mfma_f32_16x16x32_bf16 v[220:223], a[28:31], v[84:87], v[220:223]
    v_mfma_f32_16x16x32_bf16 v[220:223], a[44:47], v[88:91], v[220:223]
    v_mfma_f32_16x16x32_bf16 v[220:223], a[60:63], v[92:95], v[220:223]
    s_waitcnt lgkmcnt(0)
    v_mfma_f32_16x16x32_bf16 v[160:163], a[64:67], v[64:67], v[160:163]
    ds_read_b128 v[80:83], v224 offset:18432
    v_mfma_f32_16x16x32_bf16 v[160:163], a[80:83], v[68:71], v[160:163]
    ds_read_b128 v[84:87], v225 offset:18432
    v_mfma_f32_16x16x32_bf16 v[160:163], a[96:99], v[72:75], v[160:163]
    ds_read_b128 v[88:91], v224 offset:26624
    v_mfma_f32_16x16x32_bf16 v[160:163], a[112:115], v[76:79], v[160:163]
    ds_read_b128 v[92:95], v225 offset:26624
    v_mfma_f32_16x16x32_bf16 v[164:167], a[68:71], v[64:67], v[164:167]
    v_mfma_f32_16x16x32_bf16 v[164:167], a[84:87], v[68:71], v[164:167]
    v_mfma_f32_16x16x32_bf16 v[164:167], a[100:103], v[72:75], v[164:167]
    v_mfma_f32_16x16x32_bf16 v[164:167], a[116:119], v[76:79], v[164:167]
    s_add_u32 s38, s36, 45056
    buffer_store_dwordx4 v[60:63], v240, s[16:19], s38 offen offset:256 sc1
    v_mfma_f32_16x16x32_bf16 v[168:171], a[72:75], v[64:67], v[168:171]
    s_add_u32 m0, s31, 6144
    s_add_u32 s24, s27, 196608
    buffer_load_dwordx4 v237, s[12:15], s24 offen lds
    v_mfma_f32_16x16x32_bf16 v[168:171], a[88:91], v[68:71], v[168:171]
    v_mfma_f32_16x16x32_bf16 v[168:171], a[104:107], v[72:75], v[168:171]
    v_mfma_f32_16x16x32_bf16 v[168:171], a[120:123], v[76:79], v[168:171]
    v_mfma_f32_16x16x32_bf16 v[172:175], a[76:79], v[64:67], v[172:175]
    v_mfma_f32_16x16x32_bf16 v[172:175], a[92:95], v[68:71], v[172:175]
    v_mfma_f32_16x16x32_bf16 v[172:175], a[108:111], v[72:75], v[172:175]
    v_mfma_f32_16x16x32_bf16 v[172:175], a[124:127], v[76:79], v[172:175]
    s_waitcnt lgkmcnt(0)
    v_mfma_f32_16x16x32_bf16 v[176:179], a[64:67], v[80:83], v[176:179]
    ds_read_b128 v[64:67], v224 offset:20480
    v_mfma_f32_16x16x32_bf16 v[176:179], a[80:83], v[84:87], v[176:179]
    ds_read_b128 v[68:71], v225 offset:20480
    v_mfma_f32_16x16x32_bf16 v[176:179], a[96:99], v[88:91], v[176:179]
    ds_read_b128 v[72:75], v224 offset:28672
    v_mfma_f32_16x16x32_bf16 v[176:179], a[112:115], v[92:95], v[176:179]
    ds_read_b128 v[76:79], v225 offset:28672
    v_mfma_f32_16x16x32_bf16 v[180:183], a[68:71], v[80:83], v[180:183]
    v_mfma_f32_16x16x32_bf16 v[180:183], a[84:87], v[84:87], v[180:183]
    v_mfma_f32_16x16x32_bf16 v[180:183], a[100:103], v[88:91], v[180:183]
    v_mfma_f32_16x16x32_bf16 v[180:183], a[116:119], v[92:95], v[180:183]
    v_mfma_f32_16x16x32_bf16 v[184:187], a[72:75], v[80:83], v[184:187]
    s_add_u32 m0, s31, 7168
    s_add_u32 s24, s27, 229376
    buffer_load_dwordx4 v237, s[12:15], s24 offen lds
    v_mfma_f32_16x16x32_bf16 v[184:187], a[88:91], v[84:87], v[184:187]
    v_mfma_f32_16x16x32_bf16 v[184:187], a[104:107], v[88:91], v[184:187]
    s_add_u32 s27, s27, 1048576
    s_and_b32 s27, s27, 0x407fffff
    s_cmp_eq_u32 s27, s7
    s_cselect_b32 s27, s43, s27
    v_mfma_f32_16x16x32_bf16 v[184:187], a[120:123], v[92:95], v[184:187]
    v_mfma_f32_16x16x32_bf16 v[188:191], a[76:79], v[80:83], v[188:191]
    v_mfma_f32_16x16x32_bf16 v[188:191], a[92:95], v[84:87], v[188:191]
    s_add_u32 s31, s31, 32768
    s_cmp_ge_u32 s31, 163840
    s_cselect_b32 s24, 98304, 0
    s_sub_u32 s31, s31, s24
    s_add_u32 s38, s36, 65536
    buffer_store_dwordx4 v[0:3], v240, s[16:19], s38 offen offset:2560 sc1
    v_mfma_f32_16x16x32_bf16 v[188:191], a[108:111], v[88:91], v[188:191]
    v_mfma_f32_16x16x32_bf16 v[188:191], a[124:127], v[92:95], v[188:191]
    s_waitcnt lgkmcnt(0)
    v_mfma_f32_16x16x32_bf16 v[192:195], a[64:67], v[64:67], v[192:195]
    ds_read_b128 v[80:83], v224 offset:22528
    v_mfma_f32_16x16x32_bf16 v[192:195], a[80:83], v[68:71], v[192:195]
    ds_read_b128 v[84:87], v225 offset:22528
    v_mfma_f32_16x16x32_bf16 v[192:195], a[96:99], v[72:75], v[192:195]
    ds_read_b128 v[88:91], v224 offset:30720
    v_mfma_f32_16x16x32_bf16 v[192:195], a[112:115], v[76:79], v[192:195]
    ds_read_b128 v[92:95], v225 offset:30720
    v_mfma_f32_16x16x32_bf16 v[196:199], a[68:71], v[64:67], v[196:199]
    v_mfma_f32_16x16x32_bf16 v[196:199], a[84:87], v[68:71], v[196:199]
    v_mfma_f32_16x16x32_bf16 v[196:199], a[100:103], v[72:75], v[196:199]
    v_mfma_f32_16x16x32_bf16 v[196:199], a[116:119], v[76:79], v[196:199]
    v_mfma_f32_16x16x32_bf16 v[200:203], a[72:75], v[64:67], v[200:203]
    v_mfma_f32_16x16x32_bf16 v[200:203], a[88:91], v[68:71], v[200:203]
    v_mfma_f32_16x16x32_bf16 v[200:203], a[104:107], v[72:75], v[200:203]
    v_mfma_f32_16x16x32_bf16 v[200:203], a[120:123], v[76:79], v[200:203]
    v_mfma_f32_16x16x32_bf16 v[204:207], a[76:79], v[64:67], v[204:207]
    v_mfma_f32_16x16x32_bf16 v[204:207], a[92:95], v[68:71], v[204:207]
    v_mfma_f32_16x16x32_bf16 v[204:207], a[108:111], v[72:75], v[204:207]
    v_mfma_f32_16x16x32_bf16 v[204:207], a[124:127], v[76:79], v[204:207]
    s_waitcnt vmcnt(9) lgkmcnt(0)
    s_barrier
    v_mfma_f32_16x16x32_bf16 v[208:211], a[64:67], v[80:83], v[208:211]
    ds_read_b128 v[64:67], v224 offset:32768
    v_mfma_f32_16x16x32_bf16 v[208:211], a[80:83], v[84:87], v[208:211]
    ds_read_b128 v[68:71], v225 offset:32768
    v_mfma_f32_16x16x32_bf16 v[208:211], a[96:99], v[88:91], v[208:211]
    ds_read_b128 v[72:75], v224 offset:40960
    s_add_u32 s38, s36, 69632
    buffer_store_dwordx4 v[4:7], v240, s[16:19], s38 offen offset:512 sc1
    v_mfma_f32_16x16x32_bf16 v[208:211], a[112:115], v[92:95], v[208:211]
    ds_read_b128 v[76:79], v225 offset:40960
    v_mfma_f32_16x16x32_bf16 v[212:215], a[68:71], v[80:83], v[212:215]
    v_mfma_f32_16x16x32_bf16 v[212:215], a[84:87], v[84:87], v[212:215]
    v_mfma_f32_16x16x32_bf16 v[212:215], a[100:103], v[88:91], v[212:215]
    v_mfma_f32_16x16x32_bf16 v[212:215], a[116:119], v[92:95], v[212:215]
    v_mfma_f32_16x16x32_bf16 v[216:219], a[72:75], v[80:83], v[216:219]
    v_mfma_f32_16x16x32_bf16 v[216:219], a[88:91], v[84:87], v[216:219]
    v_mfma_f32_16x16x32_bf16 v[216:219], a[104:107], v[88:91], v[216:219]
    v_mfma_f32_16x16x32_bf16 v[216:219], a[120:123], v[92:95], v[216:219]
    v_mfma_f32_16x16x32_bf16 v[220:223], a[76:79], v[80:83], v[220:223]
    v_mfma_f32_16x16x32_bf16 v[220:223], a[92:95], v[84:87], v[220:223]
    v_mfma_f32_16x16x32_bf16 v[220:223], a[108:111], v[88:91], v[220:223]
    v_mfma_f32_16x16x32_bf16 v[220:223], a[124:127], v[92:95], v[220:223]
    s_waitcnt lgkmcnt(0)
    v_mfma_f32_16x16x32_bf16 v[160:163], a[128:131], v[64:67], v[160:163]
    ds_read_b128 v[80:83], v224 offset:34816
    v_mfma_f32_16x16x32_bf16 v[160:163], a[144:147], v[68:71], v[160:163]
    ds_read_b128 v[84:87], v225 offset:34816
    v_mfma_f32_16x16x32_bf16 v[160:163], a[160:163], v[72:75], v[160:163]
    ds_read_b128 v[88:91], v224 offset:43008
    v_mfma_f32_16x16x32_bf16 v[160:163], a[176:179], v[76:79], v[160:163]
    ds_read_b128 v[92:95], v225 offset:43008
    v_mfma_f32_16x16x32_bf16 v[164:167], a[132:135], v[64:67], v[164:167]
    v_mfma_f32_16x16x32_bf16 v[164:167], a[148:151], v[68:71], v[164:167]
    v_mfma_f32_16x16x32_bf16 v[164:167], a[164:167], v[72:75], v[164:167]
    v_mfma_f32_16x16x32_bf16 v[164:167], a[180:183], v[76:79], v[164:167]
    v_mfma_f32_16x16x32_bf16 v[168:171], a[136:139], v[64:67], v[168:171]
    buffer_load_dword v254, off, s[88:91], s39 sc1
    s_add_u32 s38, s36, 65536
    buffer_store_dwordx4 v[8:11], v240, s[16:19], s38 offen offset:3584 sc1
    v_mfma_f32_16x16x32_bf16 v[168:171], a[152:155], v[68:71], v[168:171]
    v_mfma_f32_16x16x32_bf16 v[168:171], a[168:171], v[72:75], v[168:171]
    v_mfma_f32_16x16x32_bf16 v[168:171], a[184:187], v[76:79], v[168:171]
    v_mfma_f32_16x16x32_bf16 v[172:175], a[140:143], v[64:67], v[172:175]
    v_mfma_f32_16x16x32_bf16 v[172:175], a[156:159], v[68:71], v[172:175]
    v_mfma_f32_16x16x32_bf16 v[172:175], a[172:175], v[72:75], v[172:175]
    v_mfma_f32_16x16x32_bf16 v[172:175], a[188:191], v[76:79], v[172:175]
    s_waitcnt lgkmcnt(0)
    v_mfma_f32_16x16x32_bf16 v[176:179], a[128:131], v[80:83], v[176:179]
    ds_read_b128 v[64:67], v224 offset:36864
    v_mfma_f32_16x16x32_bf16 v[176:179], a[144:147], v[84:87], v[176:179]
    ds_read_b128 v[68:71], v225 offset:36864
    v_mfma_f32_16x16x32_bf16 v[176:179], a[160:163], v[88:91], v[176:179]
    ds_read_b128 v[72:75], v224 offset:45056
    v_mfma_f32_16x16x32_bf16 v[176:179], a[176:179], v[92:95], v[176:179]
    ds_read_b128 v[76:79], v225 offset:45056
    v_mfma_f32_16x16x32_bf16 v[180:183], a[132:135], v[80:83], v[180:183]
    v_mfma_f32_16x16x32_bf16 v[180:183], a[148:151], v[84:87], v[180:183]
    v_mfma_f32_16x16x32_bf16 v[180:183], a[164:167], v[88:91], v[180:183]
    v_mfma_f32_16x16x32_bf16 v[180:183], a[180:183], v[92:95], v[180:183]
    v_mfma_f32_16x16x32_bf16 v[184:187], a[136:139], v[80:83], v[184:187]
    v_mfma_f32_16x16x32_bf16 v[184:187], a[152:155], v[84:87], v[184:187]
    v_mfma_f32_16x16x32_bf16 v[184:187], a[168:171], v[88:91], v[184:187]
    v_mfma_f32_16x16x32_bf16 v[184:187], a[184:187], v[92:95], v[184:187]
    v_mfma_f32_16x16x32_bf16 v[188:191], a[140:143], v[80:83], v[188:191]
    v_mfma_f32_16x16x32_bf16 v[188:191], a[156:159], v[84:87], v[188:191]
    s_add_u32 s38, s36, 69632
    buffer_store_dwordx4 v[12:15], v240, s[16:19], s38 offen offset:1536 sc1
    v_mfma_f32_16x16x32_bf16 v[188:191], a[172:175], v[88:91], v[188:191]
    v_mfma_f32_16x16x32_bf16 v[188:191], a[188:191], v[92:95], v[188:191]
    s_waitcnt lgkmcnt(0)
    v_mfma_f32_16x16x32_bf16 v[192:195], a[128:131], v[64:67], v[192:195]
    ds_read_b128 v[80:83], v224 offset:38912
    v_mfma_f32_16x16x32_bf16 v[192:195], a[144:147], v[68:71], v[192:195]
    ds_read_b128 v[84:87], v225 offset:38912
    v_mfma_f32_16x16x32_bf16 v[192:195], a[160:163], v[72:75], v[192:195]
    ds_read_b128 v[88:91], v224 offset:47104
    v_mfma_f32_16x16x32_bf16 v[192:195], a[176:179], v[76:79], v[192:195]
    ds_read_b128 v[92:95], v225 offset:47104
    v_mfma_f32_16x16x32_bf16 v[196:199], a[132:135], v[64:67], v[196:199]
    v_mfma_f32_16x16x32_bf16 v[196:199], a[148:151], v[68:71], v[196:199]
    v_mfma_f32_16x16x32_bf16 v[196:199], a[164:167], v[72:75], v[196:199]
    v_mfma_f32_16x16x32_bf16 v[196:199], a[180:183], v[76:79], v[196:199]
    v_mfma_f32_16x16x32_bf16 v[200:203], a[136:139], v[64:67], v[200:203]
    v_mfma_f32_16x16x32_bf16 v[200:203], a[152:155], v[68:71], v[200:203]
    v_mfma_f32_16x16x32_bf16 v[200:203], a[168:171], v[72:75], v[200:203]
    v_mfma_f32_16x16x32_bf16 v[200:203], a[184:187], v[76:79], v[200:203]
    v_mfma_f32_16x16x32_bf16 v[204:207], a[140:143], v[64:67], v[204:207]
    v_mfma_f32_16x16x32_bf16 v[204:207], a[156:159], v[68:71], v[204:207]
    v_mfma_f32_16x16x32_bf16 v[204:207], a[172:175], v[72:75], v[204:207]
    v_mfma_f32_16x16x32_bf16 v[204:207], a[188:191], v[76:79], v[204:207]
    s_waitcnt lgkmcnt(0)
    v_mfma_f32_16x16x32_bf16 v[208:211], a[128:131], v[80:83], v[208:211]
    ds_read_b128 v[64:67], v224 offset:49152
    v_mfma_f32_16x16x32_bf16 v[208:211], a[144:147], v[84:87], v[208:211]
    ds_read_b128 v[68:71], v224 offset:51200
    v_mfma_f32_16x16x32_bf16 v[208:211], a[160:163], v[88:91], v[208:211]
    ds_read_b128 v[72:75], v224 offset:53248
    v_mfma_f32_16x16x32_bf16 v[208:211], a[176:179], v[92:95], v[208:211]
    ds_read_b128 v[76:79], v224 offset:55296
    s_add_u32 s38, s36, 73728
    buffer_store_dwordx4 v[16:19], v240, s[16:19], s38 offen offset:2560 sc1
    v_mfma_f32_16x16x32_bf16 v[212:215], a[132:135], v[80:83], v[212:215]
    v_mfma_f32_16x16x32_bf16 v[212:215], a[148:151], v[84:87], v[212:215]
    v_mfma_f32_16x16x32_bf16 v[212:215], a[164:167], v[88:91], v[212:215]
    v_mfma_f32_16x16x32_bf16 v[212:215], a[180:183], v[92:95], v[212:215]
    v_mfma_f32_16x16x32_bf16 v[216:219], a[136:139], v[80:83], v[216:219]
    v_mfma_f32_16x16x32_bf16 v[216:219], a[152:155], v[84:87], v[216:219]
    v_mfma_f32_16x16x32_bf16 v[216:219], a[168:171], v[88:91], v[216:219]
    v_mfma_f32_16x16x32_bf16 v[216:219], a[184:187], v[92:95], v[216:219]
    v_mfma_f32_16x16x32_bf16 v[220:223], a[140:143], v[80:83], v[220:223]
    v_mfma_f32_16x16x32_bf16 v[220:223], a[156:159], v[84:87], v[220:223]
    v_mfma_f32_16x16x32_bf16 v[220:223], a[172:175], v[88:91], v[220:223]
    v_mfma_f32_16x16x32_bf16 v[220:223], a[188:191], v[92:95], v[220:223]
    s_waitcnt vmcnt(3)
    v_readfirstlane_b32 s24, v254
    s_lshl_b32 s25, s3, 16
    s_add_u32 s24, s24, s25
    s_cmp_ge_u32 s24, 32
    s_cbranch_scc0 kf_spin49
kf_spinr50:
    s_waitcnt lgkmcnt(0)
    s_barrier
    v_mfma_f32_16x16x32_bf16 v[160:163], a[192:195], v[64:67], v[160:163]
    ds_read_b128 v[80:83], v225 offset:49152
    v_mfma_f32_16x16x32_bf16 v[164:167], a[196:199], v[64:67], v[164:167]
    ds_read_b128 v[84:87], v225 offset:51200
    v_mfma_f32_16x16x32_bf16 v[168:171], a[200:203], v[64:67], v[168:171]
    ds_read_b128 v[88:91], v225 offset:53248
    v_mfma_f32_16x16x32_bf16 v[172:175], a[204:207], v[64:67], v[172:175]
    ds_read_b128 v[92:95], v225 offset:55296
    v_mfma_f32_16x16x32_bf16 v[176:179], a[192:195], v[68:71], v[176:179]
    v_mfma_f32_16x16x32_bf16 v[180:183], a[196:199], v[68:71], v[180:183]
    v_mfma_f32_16x16x32_bf16 v[184:187], a[200:203], v[68:71], v[184:187]
    v_mfma_f32_16x16x32_bf16 v[188:191], a[204:207], v[68:71], v[188:191]
    v_mfma_f32_16x16x32_bf16 v[192:195], a[192:195], v[72:75], v[192:195]
    buffer_load_dwordx4 a[128:131], v248, s[8:11], s28 offen offset:0 sc1
    s_add_u32 s38, s36, 77824
    buffer_store_dwordx4 v[20:23], v240, s[16:19], s38 offen offset:512 sc1
    v_mfma_f32_16x16x32_bf16 v[196:199], a[196:199], v[72:75], v[196:199]
    v_mfma_f32_16x16x32_bf16 v[200:203], a[200:203], v[72:75], v[200:203]
    buffer_load_dwordx4 a[132:135], v248, s[8:11], s29 offen offset:0 sc1
    v_mfma_f32_16x16x32_bf16 v[204:207], a[204:207], v[72:75], v[204:207]
    v_mfma_f32_16x16x32_bf16 v[208:211], a[192:195], v[76:79], v[208:211]
    v_mfma_f32_16x16x32_bf16 v[212:215], a[196:199], v[76:79], v[212:215]
    buffer_load_dwordx4 a[136:139], v249, s[8:11], s28 offen offset:0 sc1
    v_mfma_f32_16x16x32_bf16 v[216:219], a[200:203], v[76:79], v[216:219]
    v_mfma_f32_16x16x32_bf16 v[220:223], a[204:207], v[76:79], v[220:223]
    s_waitcnt lgkmcnt(0)
    v_mfma_f32_16x16x32_bf16 v[160:163], a[208:211], v[80:83], v[160:163]
    ds_read_b128 v[64:67], v224 offset:57344
    v_mfma_f32_16x16x32_bf16 v[164:167], a[212:215], v[80:83], v[164:167]
    ds_read_b128 v[68:71], v224 offset:59392
    v_mfma_f32_16x16x32_bf16 v[168:171], a[216:219], v[80:83], v[168:171]
    ds_read_b128 v[72:75], v224 offset:61440
    v_mfma_f32_16x16x32_bf16 v[172:175], a[220:223], v[80:83], v[172:175]
    ds_read_b128 v[76:79], v224 offset:63488
    v_mfma_f32_16x16x32_bf16 v[176:179], a[208:211], v[84:87], v[176:179]
    v_mfma_f32_16x16x32_bf16 v[180:183], a[212:215], v[84:87], v[180:183]
    v_mfma_f32_16x16x32_bf16 v[184:187], a[216:219], v[84:87], v[184:187]
    v_mfma_f32_16x16x32_bf16 v[188:191], a[220:223], v[84:87], v[188:191]
    v_mfma_f32_16x16x32_bf16 v[192:195], a[208:211], v[88:91], v[192:195]
    buffer_load_dwordx4 a[140:143], v249, s[8:11], s29 offen offset:0 sc1
    v_mfma_f32_16x16x32_bf16 v[196:199], a[212:215], v[88:91], v[196:199]
    v_mfma_f32_16x16x32_bf16 v[200:203], a[216:219], v[88:91], v[200:203]
    buffer_load_dwordx4 a[144:147], v248, s[8:11], s28 offen offset:1024 sc1
    v_mfma_f32_16x16x32_bf16 v[204:207], a[220:223], v[88:91], v[204:207]
    v_mfma_f32_16x16x32_bf16 v[208:211], a[208:211], v[92:95], v[208:211]
    v_mfma_f32_16x16x32_bf16 v[212:215], a[212:215], v[92:95], v[212:215]
    buffer_load_dwordx4 a[148:151], v248, s[8:11], s29 offen offset:1024 sc1
    v_mfma_f32_16x16x32_bf16 v[216:219], a[216:219], v[92:95], v[216:219]
    s_add_u32 s38, s36, 73728
    buffer_store_dwordx4 v[24:27], v240, s[16:19], s38 offen offset:3584 sc1
    v_mfma_f32_16x16x32_bf16 v[220:223], a[220:223], v[92:95], v[220:223]
    s_waitcnt lgkmcnt(0)
    v_mfma_f32_16x16x32_bf16 v[160:163], a[224:227], v[64:67], v[160:163]
    ds_read_b128 v[80:83], v225 offset:57344
    v_mfma_f32_16x16x32_bf16 v[164:167], a[228:231], v[64:67], v[164:167]
    ds_read_b128 v[84:87], v225 offset:59392
    v_mfma_f32_16x16x32_bf16 v[168:171], a[232:235], v[64:67], v[168:171]
    ds_read_b128 v[88:91], v225 offset:61440
    v_mfma_f32_16x16x32_bf16 v[172:175], a[236:239], v[64:67], v[172:175]
    ds_read_b128 v[92:95], v225 offset:63488
    v_mfma_f32_16x16x32_bf16 v[176:179], a[224:227], v[68:71], v[176:179]
    v_mfma_f32_16x16x32_bf16 v[180:183], a[228:231], v[68:71], v[180:183]
    v_mfma_f32_16x16x32_bf16 v[184:187], a[232:235], v[68:71], v[184:187]
    v_mfma_f32_16x16x32_bf16 v[188:191], a[236:239], v[68:71], v[188:191]
    v_mfma_f32_16x16x32_bf16 v[192:195], a[224:227], v[72:75], v[192:195]
    buffer_load_dwordx4 a[152:155], v249, s[8:11], s28 offen offset:1024 sc1
    v_mfma_f32_16x16x32_bf16 v[196:199], a[228:231], v[72:75], v[196:199]
    v_mfma_f32_16x16x32_bf16 v[200:203], a[232:235], v[72:75], v[200:203]
    buffer_load_dwordx4 a[156:159], v249, s[8:11], s29 offen offset:1024 sc1
    v_mfma_f32_16x16x32_bf16 v[204:207], a[236:239], v[72:75], v[204:207]
    v_mfma_f32_16x16x32_bf16 v[208:211], a[224:227], v[76:79], v[208:211]
    v_mfma_f32_16x16x32_bf16 v[212:215], a[228:231], v[76:79], v[212:215]
    buffer_load_dwordx4 a[160:163], v248, s[8:11], s28 offen offset:2048 sc1
    v_mfma_f32_16x16x32_bf16 v[216:219], a[232:235], v[76:79], v[216:219]
    v_mfma_f32_16x16x32_bf16 v[220:223], a[236:239], v[76:79], v[220:223]
    s_waitcnt vmcnt(38) lgkmcnt(0)
    s_barrier
    v_mfma_f32_16x16x32_bf16 v[160:163], a[240:243], v[80:83], v[160:163]
    ds_read_b64_tr_b16 a[192:193], v246 offset:0
    v_mfma_f32_16x16x32_bf16 v[164:167], a[244:247], v[80:83], v[164:167]
    ds_read_b64_tr_b16 a[194:195], v246 offset:1024
    v_mfma_f32_16x16x32_bf16 v[168:171], a[248:251], v[80:83], v[168:171]
    ds_read_b64_tr_b16 a[196:197], v238 offset:0
    v_mfma_f32_16x16x32_bf16 v[172:175], a[252:255], v[80:83], v[172:175]
    ds_read_b64_tr_b16 a[198:199], v238 offset:1024
    v_mfma_f32_16x16x32_bf16 v[176:179], a[240:243], v[84:87], v[176:179]
    ds_read_b64_tr_b16 a[200:201], v246 offset:256
    s_add_u32 s38, s36, 77824
    buffer_store_dwordx4 v[28:31], v240, s[16:19], s38 offen offset:1536 sc1
    v_mfma_f32_16x16x32_bf16 v[180:183], a[244:247], v[84:87], v[180:183]
    ds_read_b64_tr_b16 a[202:203], v246 offset:1280
    v_mfma_f32_16x16x32_bf16 v[184:187], a[248:251], v[84:87], v[184:187]
    ds_read_b64_tr_b16 a[204:205], v238 offset:256
    v_mfma_f32_16x16x32_bf16 v[188:191], a[252:255], v[84:87], v[188:191]
    ds_read_b64_tr_b16 a[206:207], v238 offset:1280
    v_mfma_f32_16x16x32_bf16 v[192:195], a[240:243], v[88:91], v[192:195]
    buffer_load_dwordx4 a[164:167], v248, s[8:11], s29 offen offset:2048 sc1
    v_mfma_f32_16x16x32_bf16 v[196:199], a[244:247], v[88:91], v[196:199]
    v_cvt_pk_bf16_f32 v32, v160, v161
    v_cvt_pk_bf16_f32 v33, v162, v163
    v_mfma_f32_16x16x32_bf16 v[200:203], a[248:251], v[88:91], v[200:203]
    buffer_load_dwordx4 a[168:171], v249, s[8:11], s28 offen offset:2048 sc1
    v_cvt_pk_bf16_f32 v34, v164, v165
    v_cvt_pk_bf16_f32 v35, v166, v167
    v_mfma_f32_16x16x32_bf16 v[204:207], a[252:255], v[88:91], v[204:207]
    v_cvt_pk_bf16_f32 v36, v168, v169
    v_cvt_pk_bf16_f32 v37, v170, v171
    v_mfma_f32_16x16x32_bf16 v[208:211], a[240:243], v[92:95], v[208:211]
    v_cvt_pk_bf16_f32 v38, v172, v173
    v_cvt_pk_bf16_f32 v39, v174, v175
    v_mfma_f32_16x16x32_bf16 v[212:215], a[244:247], v[92:95], v[212:215]
    buffer_load_dwordx4 a[172:175], v249, s[8:11], s29 offen offset:2048 sc1
    v_cvt_pk_bf16_f32 v40, v176, v177
    v_cvt_pk_bf16_f32 v41, v178, v179
    v_mfma_f32_16x16x32_bf16 v[216:219], a[248:251], v[92:95], v[216:219]
    v_cvt_pk_bf16_f32 v42, v180, v181
    v_cvt_pk_bf16_f32 v43, v182, v183
    v_mfma_f32_16x16x32_bf16 v[220:223], a[252:255], v[92:95], v[220:223]
    v_cvt_pk_bf16_f32 v44, v184, v185
    v_cvt_pk_bf16_f32 v45, v186, v187
    s_nop 3
    v_cvt_pk_bf16_f32 v46, v188, v189
    v_cvt_pk_bf16_f32 v47, v190, v191
    v_cvt_pk_bf16_f32 v48, v192, v193
    v_cvt_pk_bf16_f32 v49, v194, v195
    v_cvt_pk_bf16_f32 v50, v196, v197
    v_cvt_pk_bf16_f32 v51, v198, v199
    v_cvt_pk_bf16_f32 v52, v200, v201
    v_cvt_pk_bf16_f32 v53, v202, v203
    v_cvt_pk_bf16_f32 v54, v204, v205
    v_cvt_pk_bf16_f32 v55, v206, v207
    v_cvt_pk_bf16_f32 v56, v208, v209
    v_cvt_pk_bf16_f32 v57, v210, v211
    v_cvt_pk_bf16_f32 v58, v212, v213
    v_cvt_pk_bf16_f32 v59, v214, v215
    v_cvt_pk_bf16_f32 v60, v216, v217
    v_cvt_pk_bf16_f32 v61, v218, v219
    v_cvt_pk_bf16_f32 v62, v220, v221
    v_cvt_pk_bf16_f32 v63, v222, v223
    s_add_u32 s80, s36, 102144
    s_add_u32 s81, s36, 104192
    s_add_u32 s82, s36, 103168
    s_add_u32 s83, s36, 105216
    s_add_u32 s84, s36, 110336
    s_add_u32 s85, s36, 112384
    s_add_u32 s86, s36, 111360
    s_add_u32 s87, s36, 113408
    s_branch ka_Q
ka_V:
    s_waitcnt lgkmcnt(0)
    v_mfma_f32_16x16x32_bf16 v[96:99], v[64:67], a[0:3], 0
    ds_read_b128 v[80:83], v224 offset:8192
    v_mfma_f32_16x16x32_bf16 v[100:103], v[68:71], a[0:3], 0
    ds_read_b128 v[84:87], v224 offset:10240
    v_mfma_f32_16x16x32_bf16 v[104:107], v[64:67], a[4:7], 0
    ds_read_b128 v[88:91], v224 offset:12288
    v_mfma_f32_16x16x32_bf16 v[108:111], v[68:71], a[4:7], 0
    ds_read_b128 v[92:95], v224 offset:14336
    v_mfma_f32_16x16x32_bf16 v[112:115], v[64:67], a[8:11], 0
    ds_read_b64_tr_b16 a[16:17], v228 offset:4096
    v_mfma_f32_16x16x32_bf16 v[116:119], v[68:71], a[8:11], 0
    ds_read_b64_tr_b16 a[18:19], v228 offset:4608
    v_mfma_f32_16x16x32_bf16 v[120:123], v[64:67], a[12:15], 0
    ds_read_b64_tr_b16 a[20:21], v229 offset:4096
    v_mfma_f32_16x16x32_bf16 v[124:127], v[68:71], a[12:15], 0
    ds_read_b64_tr_b16 a[22:23], v229 offset:4608
    v_mfma_f32_16x16x32_bf16 v[128:131], v[72:75], a[0:3], 0
    s_add_u32 m0, s35, 16384
    s_and_b32 s33, s82, 1023
    s_lshl_b32 s33, s33, 12
    buffer_load_dwordx4 v234, s[48:51], s33 offen lds
    v_mfma_f32_16x16x32_bf16 v[132:135], v[76:79], a[0:3], 0
    v_mfma_f32_16x16x32_bf16 v[136:139], v[72:75], a[4:7], 0
    buffer_load_dwordx4 v235, s[48:51], s33 offen offset:1024 lds
    v_mfma_f32_16x16x32_bf16 v[140:143], v[76:79], a[4:7], 0
    v_mfma_f32_16x16x32_bf16 v[144:147], v[72:75], a[8:11], 0
    s_add_u32 m0, s35, 18432
    s_add_u32 s33, s33, 131072
    buffer_load_dwordx4 v234, s[48:51], s33 offen lds
    v_mfma_f32_16x16x32_bf16 v[148:151], v[76:79], a[8:11], 0
    v_mfma_f32_16x16x32_bf16 v[152:155], v[72:75], a[12:15], 0
    buffer_load_dwordx4 v235, s[48:51], s33 offen offset:1024 lds
    v_mfma_f32_16x16x32_bf16 v[156:159], v[76:79], a[12:15], 0
    s_waitcnt lgkmcnt(0)
    v_mfma_f32_16x16x32_bf16 v[160:163], v[80:83], a[0:3], 0
    ds_read_b128 v[64:67], v225 offset:0
    v_mfma_f32_16x16x32_bf16 v[164:167], v[84:87], a[0:3], 0
    ds_read_b128 v[68:71], v225 offset:2048
    v_mfma_f32_16x16x32_bf16 v[168:171], v[80:83], a[4:7], 0
    ds_read_b128 v[72:75], v225 offset:4096
    v_mfma_f32_16x16x32_bf16 v[172:175], v[84:87], a[4:7], 0
    ds_read_b128 v[76:79], v225 offset:6144
    v_mfma_f32_16x16x32_bf16 v[176:179], v[80:83], a[8:11], 0
    ds_read_b64_tr_b16 a[24:25], v230 offset:4096
    v_mfma_f32_16x16x32_bf16 v[180:183], v[84:87], a[8:11], 0
    ds_read_b64_tr_b16 a[26:27], v230 offset:4608
    v_mfma_f32_16x16x32_bf16 v[184:187], v[80:83], a[12:15], 0
    ds_read_b64_tr_b16 a[28:29], v231 offset:4096
    v_mfma_f32_16x16x32_bf16 v[188:191], v[84:87], a[12:15], 0
    ds_read_b64_tr_b16 a[30:31], v231 offset:4608
    v_mfma_f32_16x16x32_bf16 v[192:195], v[88:91], a[0:3], 0
    s_add_u32 m0, s35, 20480
    s_add_u32 s33, s33, 131072
    buffer_load_dwordx4 v234, s[48:51], s33 offen lds
    v_mfma_f32_16x16x32_bf16 v[196:199], v[92:95], a[0:3], 0
    v_mfma_f32_16x16x32_bf16 v[200:203], v[88:91], a[4:7], 0
    buffer_load_dwordx4 v235, s[48:51], s33 offen offset:1024 lds
    v_mfma_f32_16x16x32_bf16 v[204:207], v[92:95], a[4:7], 0
    v_mfma_f32_16x16x32_bf16 v[208:211], v[88:91], a[8:11], 0
    s_add_u32 m0, s35, 22528
    s_add_u32 s33, s33, 131072
    buffer_load_dwordx4 v234, s[48:51], s33 offen lds
    v_mfma_f32_16x16x32_bf16 v[212:215], v[92:95], a[8:11], 0
    v_mfma_f32_16x16x32_bf16 v[216:219], v[88:91], a[12:15], 0
    buffer_load_dwordx4 v235, s[48:51], s33 offen offset:1024 lds
    v_mfma_f32_16x16x32_bf16 v[220:223], v[92:95], a[12:15], 0
    s_waitcnt vmcnt(13) lgkmcnt(0)
    v_mfma_f32_16x16x32_bf16 v[96:99], v[64:67], a[16:19], v[96:99]
    ds_read_b128 v[80:83], v225 offset:8192
    v_mfma_f32_16x16x32_bf16 v[100:103], v[68:71], a[16:19], v[100:103]
    ds_read_b128 v[84:87], v225 offset:10240
    v_mfma_f32_16x16x32_bf16 v[104:107], v[64:67], a[20:23], v[104:107]
    ds_read_b128 v[88:91], v225 offset:12288
    v_mfma_f32_16x16x32_bf16 v[108:111], v[68:71], a[20:23], v[108:111]
    ds_read_b128 v[92:95], v225 offset:14336
    v_mfma_f32_16x16x32_bf16 v[112:115], v[64:67], a[24:27], v[112:115]
    ds_read_b64_tr_b16 a[32:33], v228 offset:8192
    v_mfma_f32_16x16x32_bf16 v[116:119], v[68:71], a[24:27], v[116:119]
    ds_read_b64_tr_b16 a[34:35], v228 offset:8704
    v_mfma_f32_16x16x32_bf16 v[120:123], v[64:67], a[28:31], v[120:123]
    ds_read_b64_tr_b16 a[36:37], v229 offset:8192
    v_mfma_f32_16x16x32_bf16 v[124:127], v[68:71], a[28:31], v[124:127]
    ds_read_b64_tr_b16 a[38:39], v229 offset:8704
    v_mfma_f32_16x16x32_bf16 v[128:131], v[72:75], a[16:19], v[128:131]
    ds_read_b64_tr_b16 a[40:41], v230 offset:8192
    s_add_u32 m0, s34, 32768
    s_add_u32 s37, s82, 0
    buffer_load_dwordx4 v232, s[44:47], s37 offen lds
    v_mfma_f32_16x16x32_bf16 v[132:135], v[76:79], a[16:19], v[132:135]
    ds_read_b64_tr_b16 a[42:43], v230 offset:8704
    buffer_load_dwordx4 v233, s[44:47], s37 offen offset:1024 lds
    v_mfma_f32_16x16x32_bf16 v[136:139], v[72:75], a[20:23], v[136:139]
    ds_read_b64_tr_b16 a[44:45], v231 offset:8192
    s_add_u32 m0, s34, 40960
    s_add_u32 s37, s82, 65536
    buffer_load_dwordx4 v232, s[44:47], s37 offen lds
    v_mfma_f32_16x16x32_bf16 v[140:143], v[76:79], a[20:23], v[140:143]
    ds_read_b64_tr_b16 a[46:47], v231 offset:8704
    buffer_load_dwordx4 v233, s[44:47], s37 offen offset:1024 lds
    v_mfma_f32_16x16x32_bf16 v[144:147], v[72:75], a[24:27], v[144:147]
    s_add_u32 m0, s35, 0
    s_and_b32 s33, s83, 1023
    s_lshl_b32 s33, s33, 12
    buffer_load_dwordx4 v234, s[48:51], s33 offen lds
    v_mfma_f32_16x16x32_bf16 v[148:151], v[76:79], a[24:27], v[148:151]
    buffer_load_dwordx4 v235, s[48:51], s33 offen offset:1024 lds
    v_mfma_f32_16x16x32_bf16 v[152:155], v[72:75], a[28:31], v[152:155]
    s_add_u32 m0, s35, 2048
    s_add_u32 s33, s33, 131072
    buffer_load_dwordx4 v234, s[48:51], s33 offen lds
    v_mfma_f32_16x16x32_bf16 v[156:159], v[76:79], a[28:31], v[156:159]
    buffer_load_dwordx4 v235, s[48:51], s33 offen offset:1024 lds
    s_waitcnt vmcnt(17) lgkmcnt(0)
    s_barrier
    v_mfma_f32_16x16x32_bf16 v[160:163], v[80:83], a[16:19], v[160:163]
    ds_read_b128 v[64:67], v224 offset:16384
    v_mfma_f32_16x16x32_bf16 v[164:167], v[84:87], a[16:19], v[164:167]
    ds_read_b128 v[68:71], v225 offset:16384
    v_mfma_f32_16x16x32_bf16 v[168:171], v[80:83], a[20:23], v[168:171]
    ds_read_b128 v[72:75], v224 offset:18432
    v_mfma_f32_16x16x32_bf16 v[172:175], v[84:87], a[20:23], v[172:175]
    ds_read_b128 v[76:79], v225 offset:18432
    v_mfma_f32_16x16x32_bf16 v[176:179], v[80:83], a[24:27], v[176:179]
    ds_read_b64_tr_b16 a[48:49], v228 offset:12288
    s_add_u32 m0, s34, 49152
    s_add_u32 s37, s83, 0
    buffer_load_dwordx4 v232, s[44:47], s37 offen lds
    v_mfma_f32_16x16x32_bf16 v[180:183], v[84:87], a[24:27], v[180:183]
    ds_read_b64_tr_b16 a[50:51], v228 offset:12800
    buffer_load_dwordx4 v233, s[44:47], s37 offen offset:1024 lds
    v_mfma_f32_16x16x32_bf16 v[184:187], v[80:83], a[28:31], v[184:187]
    ds_read_b64_tr_b16 a[52:53], v229 offset:12288
    s_add_u32 m0, s34, 57344
    s_add_u32 s37, s83, 65536
    buffer_load_dwordx4 v232, s[44:47], s37 offen lds
    v_mfma_f32_16x16x32_bf16 v[188:191], v[84:87], a[28:31], v[188:191]
    ds_read_b64_tr_b16 a[54:55], v229 offset:12800
    buffer_load_dwordx4 v233, s[44:47], s37 offen offset:1024 lds
    v_mfma_f32_16x16x32_bf16 v[192:195], v[88:91], a[16:19], v[192:195]
    ds_read_b64_tr_b16 a[56:57], v230 offset:12288
    s_add_u32 m0, s34, 0
    s_add_u32 s37, s84, 0
    buffer_load_dwordx4 v232, s[44:47], s37 offen lds
    v_mfma_f32_16x16x32_bf16 v[196:199], v[92:95], a[16:19], v[196:199]
    ds_read_b64_tr_b16 a[58:59], v230 offset:12800
    v_mfma_f32_16x16x32_bf16 v[200:203], v[88:91], a[20:23], v[200:203]
    ds_read_b64_tr_b16 a[60:61], v231 offset:12288
    buffer_load_dwordx4 v233, s[44:47], s37 offen offset:1024 lds
    v_mfma_f32_16x16x32_bf16 v[204:207], v[92:95], a[20:23], v[204:207]
    ds_read_b64_tr_b16 a[62:63], v231 offset:12800
    buffer_load_dwordx4 v[0:3], v236, s[52:55], 0 offen offset:0
    v_mfma_f32_16x16x32_bf16 v[208:211], v[88:91], a[24:27], v[208:211]
    buffer_load_dwordx4 v[4:7], v236, s[52:55], 0 offen offset:512
    v_mfma_f32_16x16x32_bf16 v[212:215], v[92:95], a[24:27], v[212:215]
    buffer_load_dwordx4 v[8:11], v236, s[52:55], 0 offen offset:1024
    v_mfma_f32_16x16x32_bf16 v[216:219], v[88:91], a[28:31], v[216:219]
    buffer_load_dwordx4 v[12:15], v236, s[52:55], 0 offen offset:1536
    v_mfma_f32_16x16x32_bf16 v[220:223], v[92:95], a[28:31], v[220:223]
    s_waitcnt lgkmcnt(0)
    v_mfma_f32_16x16x32_bf16 v[96:99], v[64:67], a[32:35], v[96:99]
    ds_read_b128 v[80:83], v224 offset:20480
    v_mfma_f32_16x16x32_bf16 v[96:99], v[68:71], a[48:51], v[96:99]
    ds_read_b128 v[84:87], v225 offset:20480
    v_mfma_f32_16x16x32_bf16 v[100:103], v[72:75], a[32:35], v[100:103]
    ds_read_b128 v[88:91], v224 offset:22528
    v_mfma_f32_16x16x32_bf16 v[100:103], v[76:79], a[48:51], v[100:103]
    ds_read_b128 v[92:95], v225 offset:22528
    v_mfma_f32_16x16x32_bf16 v[104:107], v[64:67], a[36:39], v[104:107]
    v_mfma_f32_16x16x32_bf16 v[104:107], v[68:71], a[52:55], v[104:107]
    v_mfma_f32_16x16x32_bf16 v[108:111], v[72:75], a[36:39], v[108:111]
    v_mfma_f32_16x16x32_bf16 v[108:111], v[76:79], a[52:55], v[108:111]
    v_mfma_f32_16x16x32_bf16 v[112:115], v[64:67], a[40:43], v[112:115]
    s_add_u32 m0, s35, 4096
    s_add_u32 s33, s33, 131072
    buffer_load_dwordx4 v234, s[48:51], s33 offen lds
    v_mfma_f32_16x16x32_bf16 v[112:115], v[68:71], a[56:59], v[112:115]
    v_mfma_f32_16x16x32_bf16 v[116:119], v[72:75], a[40:43], v[116:119]
    buffer_load_dwordx4 v235, s[48:51], s33 offen offset:1024 lds
    v_mfma_f32_16x16x32_bf16 v[116:119], v[76:79], a[56:59], v[116:119]
    v_mfma_f32_16x16x32_bf16 v[120:123], v[64:67], a[44:47], v[120:123]
    s_add_u32 m0, s35, 6144
    s_add_u32 s33, s33, 131072
    buffer_load_dwordx4 v234, s[48:51], s33 offen lds
    v_mfma_f32_16x16x32_bf16 v[120:123], v[68:71], a[60:63], v[120:123]
    v_mfma_f32_16x16x32_bf16 v[124:127], v[72:75], a[44:47], v[124:127]
    buffer_load_dwordx4 v235, s[48:51], s33 offen offset:1024 lds
    v_mfma_f32_16x16x32_bf16 v[124:127], v[76:79], a[60:63], v[124:127]
    s_waitcnt lgkmcnt(0)
    v_mfma_f32_16x16x32_bf16 v[128:131], v[80:83], a[32:35], v[128:131]
    ds_read_b128 v[64:67], v224 offset:24576
    v_mfma_f32_16x16x32_bf16 v[128:131], v[84:87], a[48:51], v[128:131]
    ds_read_b128 v[68:71], v225 offset:24576
    v_mfma_f32_16x16x32_bf16 v[132:135], v[88:91], a[32:35], v[132:135]
    ds_read_b128 v[72:75], v224 offset:26624
    v_mfma_f32_16x16x32_bf16 v[132:135], v[92:95], a[48:51], v[132:135]
    ds_read_b128 v[76:79], v225 offset:26624
    v_mfma_f32_16x16x32_bf16 v[136:139], v[80:83], a[36:39], v[136:139]
    v_mfma_f32_16x16x32_bf16 v[136:139], v[84:87], a[52:55], v[136:139]
    v_mfma_f32_16x16x32_bf16 v[140:143], v[88:91], a[36:39], v[140:143]
    v_mfma_f32_16x16x32_bf16 v[140:143], v[92:95], a[52:55], v[140:143]
    v_mfma_f32_16x16x32_bf16 v[144:147], v[80:83], a[40:43], v[144:147]
    s_add_u32 m0, s34, 8192
    s_add_u32 s37, s84, 65536
    buffer_load_dwordx4 v232, s[44:47], s37 offen lds
    v_mfma_f32_16x16x32_bf16 v[144:147], v[84:87], a[56:59], v[144:147]
    v_mfma_f32_16x16x32_bf16 v[148:151], v[88:91], a[40:43], v[148:151]
    v_mfma_f32_16x16x32_bf16 v[148:151], v[92:95], a[56:59], v[148:151]
    v_mfma_f32_16x16x32_bf16 v[152:155], v[80:83], a[44:47], v[152:155]
    buffer_load_dwordx4 v233, s[44:47], s37 offen offset:1024 lds
    v_mfma_f32_16x16x32_bf16 v[152:155], v[84:87], a[60:63], v[152:155]
    v_mfma_f32_16x16x32_bf16 v[156:159], v[88:91], a[44:47], v[156:159]
    v_mfma_f32_16x16x32_bf16 v[156:159], v[92:95], a[60:63], v[156:159]
    s_waitcnt vmcnt(24) lgkmcnt(0)
    v_mfma_f32_16x16x32_bf16 v[160:163], v[64:67], a[32:35], v[160:163]
    ds_read_b128 v[80:83], v224 offset:28672
    v_mfma_f32_16x16x32_bf16 v[160:163], v[68:71], a[48:51], v[160:163]
    ds_read_b128 v[84:87], v225 offset:28672
    v_mfma_f32_16x16x32_bf16 v[164:167], v[72:75], a[32:35], v[164:167]
    ds_read_b128 v[88:91], v224 offset:30720
    v_mfma_f32_16x16x32_bf16 v[164:167], v[76:79], a[48:51], v[164:167]
    ds_read_b128 v[92:95], v225 offset:30720
    v_mfma_f32_16x16x32_bf16 v[168:171], v[64:67], a[36:39], v[168:171]
    ds_read_b64_tr_b16 a[64:65], v228 offset:16384
    v_mfma_f32_16x16x32_bf16 v[168:171], v[68:71], a[52:55], v[168:171]
    ds_read_b64_tr_b16 a[66:67], v228 offset:16896
    v_mfma_f32_16x16x32_bf16 v[172:175], v[72:75], a[36:39], v[172:175]
    ds_read_b64_tr_b16 a[68:69], v229 offset:16384
    v_mfma_f32_16x16x32_bf16 v[172:175], v[76:79], a[52:55], v[172:175]
    ds_read_b64_tr_b16 a[70:71], v229 offset:16896
    v_mfma_f32_16x16x32_bf16 v[176:179], v[64:67], a[40:43], v[176:179]
    ds_read_b64_tr_b16 a[72:73], v230 offset:16384
    s_add_u32 m0, s35, 8192
    s_and_b32 s33, s84, 1023
    s_lshl_b32 s33, s33, 12
    buffer_load_dwordx4 v234, s[48:51], s33 offen lds
    v_mfma_f32_16x16x32_bf16 v[176:179], v[68:71], a[56:59], v[176:179]
    ds_read_b64_tr_b16 a[74:75], v230 offset:16896
    v_mfma_f32_16x16x32_bf16 v[180:183], v[72:75], a[40:43], v[180:183]
    ds_read_b64_tr_b16 a[76:77], v231 offset:16384
    buffer_load_dwordx4 v235, s[48:51], s33 offen offset:1024 lds
    v_mfma_f32_16x16x32_bf16 v[180:183], v[76:79], a[56:59], v[180:183]
    ds_read_b64_tr_b16 a[78:79], v231 offset:16896
    v_mfma_f32_16x16x32_bf16 v[184:187], v[64:67], a[44:47], v[184:187]
    s_add_u32 m0, s35, 10240
    s_add_u32 s33, s33, 131072
    buffer_load_dwordx4 v234, s[48:51], s33 offen lds
    v_mfma_f32_16x16x32_bf16 v[184:187], v[68:71], a[60:63], v[184:187]
    v_mfma_f32_16x16x32_bf16 v[188:191], v[72:75], a[44:47], v[188:191]
    buffer_load_dwordx4 v235, s[48:51], s33 offen offset:1024 lds
    v_mfma_f32_16x16x32_bf16 v[188:191], v[76:79], a[60:63], v[188:191]
    s_waitcnt vmcnt(24) lgkmcnt(0)
    s_barrier
    v_mfma_f32_16x16x32_bf16 v[192:195], v[80:83], a[32:35], v[192:195]
    ds_read_b128 v[64:67], v224 offset:32768
    v_mfma_f32_16x16x32_bf16 v[192:195], v[84:87], a[48:51], v[192:195]
    ds_read_b128 v[68:71], v225 offset:32768
    v_mfma_f32_16x16x32_bf16 v[196:199], v[88:91], a[32:35], v[196:199]
    ds_read_b128 v[72:75], v224 offset:34816
    v_mfma_f32_16x16x32_bf16 v[196:199], v[92:95], a[48:51], v[196:199]
    ds_read_b128 v[76:79], v225 offset:34816
    v_mfma_f32_16x16x32_bf16 v[200:203], v[80:83], a[36:39], v[200:203]
    ds_read_b64_tr_b16 a[80:81], v228 offset:20480
    v_mfma_f32_16x16x32_bf16 v[200:203], v[84:87], a[52:55], v[200:203]
    ds_read_b64_tr_b16 a[82:83], v228 offset:20992
    v_mfma_f32_16x16x32_bf16 v[204:207], v[88:91], a[36:39], v[204:207]
    ds_read_b64_tr_b16 a[84:85], v229 offset:20480
    v_mfma_f32_16x16x32_bf16 v[204:207], v[92:95], a[52:55], v[204:207]
    ds_read_b64_tr_b16 a[86:87], v229 offset:20992
    v_mfma_f32_16x16x32_bf16 v[208:211], v[80:83], a[40:43], v[208:211]
    ds_read_b64_tr_b16 a[88:89], v230 offset:20480
    s_add_u32 m0, s34, 16384
    s_add_u32 s37, s85, 0
    buffer_load_dwordx4 v232, s[44:47], s37 offen lds
    v_mfma_f32_16x16x32_bf16 v[208:211], v[84:87], a[56:59], v[208:211]
    ds_read_b64_tr_b16 a[90:91], v230 offset:20992
    v_mfma_f32_16x16x32_bf16 v[212:215], v[88:91], a[40:43], v[212:215]
    ds_read_b64_tr_b16 a[92:93], v231 offset:20480
    v_mfma_f32_16x16x32_bf16 v[212:215], v[92:95], a[56:59], v[212:215]
    ds_read_b64_tr_b16 a[94:95], v231 offset:20992
    v_mfma_f32_16x16x32_bf16 v[216:219], v[80:83], a[44:47], v[216:219]
    buffer_load_dwordx4 v233, s[44:47], s37 offen offset:1024 lds
    v_mfma_f32_16x16x32_bf16 v[216:219], v[84:87], a[60:63], v[216:219]
    v_mfma_f32_16x16x32_bf16 v[220:223], v[88:91], a[44:47], v[220:223]
    v_mfma_f32_16x16x32_bf16 v[220:223], v[92:95], a[60:63], v[220:223]
    s_waitcnt lgkmcnt(0)
    v_mfma_f32_16x16x32_bf16 v[96:99], v[64:67], a[64:67], v[96:99]
    ds_read_b128 v[80:83], v224 offset:36864
    v_mfma_f32_16x16x32_bf16 v[96:99], v[68:71], a[80:83], v[96:99]
    ds_read_b128 v[84:87], v225 offset:36864
    v_mfma_f32_16x16x32_bf16 v[100:103], v[72:75], a[64:67], v[100:103]
    ds_read_b128 v[88:91], v224 offset:38912
    v_mfma_f32_16x16x32_bf16 v[100:103], v[76:79], a[80:83], v[100:103]
    ds_read_b128 v[92:95], v225 offset:38912
    v_mfma_f32_16x16x32_bf16 v[104:107], v[64:67], a[68:71], v[104:107]
    v_mfma_f32_16x16x32_bf16 v[104:107], v[68:71], a[84:87], v[104:107]
    v_mfma_f32_16x16x32_bf16 v[108:111], v[72:75], a[68:71], v[108:111]
    v_mfma_f32_16x16x32_bf16 v[108:111], v[76:79], a[84:87], v[108:111]
    v_mfma_f32_16x16x32_bf16 v[112:115], v[64:67], a[72:75], v[112:115]
    s_add_u32 m0, s35, 12288
    s_add_u32 s33, s33, 131072
    buffer_load_dwordx4 v234, s[48:51], s33 offen lds
    v_mfma_f32_16x16x32_bf16 v[112:115], v[68:71], a[88:91], v[112:115]
    v_mfma_f32_16x16x32_bf16 v[116:119], v[72:75], a[72:75], v[116:119]
    buffer_load_dwordx4 v235, s[48:51], s33 offen offset:1024 lds
    v_mfma_f32_16x16x32_bf16 v[116:119], v[76:79], a[88:91], v[116:119]
    v_mfma_f32_16x16x32_bf16 v[120:123], v[64:67], a[76:79], v[120:123]
    s_add_u32 m0, s35, 14336
    s_add_u32 s33, s33, 131072
    buffer_load_dwordx4 v234, s[48:51], s33 offen lds
    v_mfma_f32_16x16x32_bf16 v[120:123], v[68:71], a[92:95], v[120:123]
    v_mfma_f32_16x16x32_bf16 v[124:127], v[72:75], a[76:79], v[124:127]
    buffer_load_dwordx4 v235, s[48:51], s33 offen offset:1024 lds
    v_mfma_f32_16x16x32_bf16 v[124:127], v[76:79], a[92:95], v[124:127]
    s_waitcnt lgkmcnt(0)
    v_mfma_f32_16x16x32_bf16 v[128:131], v[80:83], a[64:67], v[128:131]
    ds_read_b128 v[64:67], v224 offset:40960
    v_mfma_f32_16x16x32_bf16 v[128:131], v[84:87], a[80:83], v[128:131]
    ds_read_b128 v[68:71], v225 offset:40960
    v_mfma_f32_16x16x32_bf16 v[132:135], v[88:91], a[64:67], v[132:135]
    ds_read_b128 v[72:75], v224 offset:43008
    v_mfma_f32_16x16x32_bf16 v[132:135], v[92:95], a[80:83], v[132:135]
    ds_read_b128 v[76:79], v225 offset:43008
    v_mfma_f32_16x16x32_bf16 v[136:139], v[80:83], a[68:71], v[136:139]
    v_mfma_f32_16x16x32_bf16 v[136:139], v[84:87], a[84:87], v[136:139]
    v_mfma_f32_16x16x32_bf16 v[140:143], v[88:91], a[68:71], v[140:143]
    v_mfma_f32_16x16x32_bf16 v[140:143], v[92:95], a[84:87], v[140:143]
    v_mfma_f32_16x16x32_bf16 v[144:147], v[80:83], a[72:75], v[144:147]
    s_add_u32 m0, s34, 24576
    s_add_u32 s37, s85, 65536
    buffer_load_dwordx4 v232, s[44:47], s37 offen lds
    v_mfma_f32_16x16x32_bf16 v[144:147], v[84:87], a[88:91], v[144:147]
    v_mfma_f32_16x16x32_bf16 v[148:151], v[88:91], a[72:75], v[148:151]
    v_mfma_f32_16x16x32_bf16 v[148:151], v[92:95], a[88:91], v[148:151]
    v_mfma_f32_16x16x32_bf16 v[152:155], v[80:83], a[76:79], v[152:155]
    buffer_load_dwordx4 v233, s[44:47], s37 offen offset:1024 lds
    v_mfma_f32_16x16x32_bf16 v[152:155], v[84:87], a[92:95], v[152:155]
    v_mfma_f32_16x16x32_bf16 v[156:159], v[88:91], a[76:79], v[156:159]
    v_mfma_f32_16x16x32_bf16 v[156:159], v[92:95], a[92:95], v[156:159]
    s_waitcnt vmcnt(14) lgkmcnt(0)
    v_mfma_f32_16x16x32_bf16 v[160:163], v[64:67], a[64:67], v[160:163]
    ds_read_b128 v[80:83], v224 offset:45056
    s_waitcnt vmcnt(18)
    v_mfma_f32_16x16x32_bf16 v[160:163], v[68:71], a[80:83], v[160:163]
    ds_read_b128 v[84:87], v225 offset:45056
    v_lshlrev_b32_e64 v16, 16, v0
    v_mfma_f32_16x16x32_bf16 v[164:167], v[72:75], a[64:67], v[164:167]
    ds_read_b128 v[88:91], v224 offset:47104
    v_and_b32 v17, 0xffff0000, v0
    v_lshlrev_b32_e64 v18, 16, v1
    v_mfma_f32_16x16x32_bf16 v[164:167], v[76:79], a[80:83], v[164:167]
    ds_read_b128 v[92:95], v225 offset:47104
    v_and_b32 v19, 0xffff0000, v1
    v_mfma_f32_16x16x32_bf16 v[168:171], v[64:67], a[68:71], v[168:171]
    ds_read_b64_tr_b16 a[96:97], v228 offset:0
    v_lshlrev_b32_e64 v20, 16, v2
    v_mfma_f32_16x16x32_bf16 v[168:171], v[68:71], a[84:87], v[168:171]
    ds_read_b64_tr_b16 a[98:99], v228 offset:512
    v_and_b32 v21, 0xffff0000, v2
    v_mfma_f32_16x16x32_bf16 v[172:175], v[72:75], a[68:71], v[172:175]
    ds_read_b64_tr_b16 a[100:101], v229 offset:0
    v_lshlrev_b32_e64 v22, 16, v3
    v_mfma_f32_16x16x32_bf16 v[172:175], v[76:79], a[84:87], v[172:175]
    ds_read_b64_tr_b16 a[102:103], v229 offset:512
    v_and_b32 v23, 0xffff0000, v3
    v_mfma_f32_16x16x32_bf16 v[176:179], v[64:67], a[72:75], v[176:179]
    ds_read_b64_tr_b16 a[104:105], v230 offset:0
    s_add_u32 m0, s35, 16384
    s_and_b32 s33, s85, 1023
    s_lshl_b32 s33, s33, 12
    buffer_load_dwordx4 v234, s[48:51], s33 offen lds
    v_mfma_f32_16x16x32_bf16 v[176:179], v[68:71], a[88:91], v[176:179]
    ds_read_b64_tr_b16 a[106:107], v230 offset:512
    buffer_load_dwordx4 v235, s[48:51], s33 offen offset:1024 lds
    v_mfma_f32_16x16x32_bf16 v[180:183], v[72:75], a[72:75], v[180:183]
    ds_read_b64_tr_b16 a[108:109], v231 offset:0
    s_add_u32 m0, s35, 18432
    s_add_u32 s33, s33, 131072
    buffer_load_dwordx4 v234, s[48:51], s33 offen lds
    v_mfma_f32_16x16x32_bf16 v[180:183], v[76:79], a[88:91], v[180:183]
    ds_read_b64_tr_b16 a[110:111], v231 offset:512
    v_lshlrev_b32 v24, 16, v4
    v_and_b32 v25, 0xffff0000, v4
    v_mfma_f32_16x16x32_bf16 v[184:187], v[64:67], a[76:79], v[184:187]
    buffer_load_dwordx4 v235, s[48:51], s33 offen offset:1024 lds
    v_lshlrev_b32_e64 v26, 16, v5
    v_mfma_f32_16x16x32_bf16 v[184:187], v[68:71], a[92:95], v[184:187]
    s_lshl2_add_u32 s26, s4, s3
    s_lshl_b32 s26, s26, 10
    s_add_u32 s26, s26, s32
    s_add_u32 s26, s26, 131072
    v_mfma_f32_16x16x32_bf16 v[188:191], v[72:75], a[76:79], v[188:191]
    v_and_b32 v226, 0x40000380, v251
    buffer_load_dword v241, v226, s[44:47], s26 offen
    v_mfma_f32_16x16x32_bf16 v[188:191], v[76:79], a[92:95], v[188:191]
    s_waitcnt vmcnt(29) lgkmcnt(0)
    s_barrier
    v_mfma_f32_16x16x32_bf16 v[192:195], v[80:83], a[64:67], v[192:195]
    ds_read_b128 v[64:67], v224 offset:49152
    v_and_b32 v27, 0xffff0000, v5
    v_mfma_f32_16x16x32_bf16 v[192:195], v[84:87], a[80:83], v[192:195]
    ds_read_b128 v[68:71], v225 offset:49152
    v_lshlrev_b32 v28, 16, v6
    v_mfma_f32_16x16x32_bf16 v[196:199], v[88:91], a[64:67], v[196:199]
    ds_read_b128 v[72:75], v224 offset:51200
    v_and_b32 v29, 0xffff0000, v6
    v_mfma_f32_16x16x32_bf16 v[196:199], v[92:95], a[80:83], v[196:199]
    ds_read_b128 v[76:79], v225 offset:51200
    v_lshlrev_b32_e64 v30, 16, v7
    v_and_b32 v31, 0xffff0000, v7
    v_mfma_f32_16x16x32_bf16 v[200:203], v[80:83], a[68:71], v[200:203]
    ds_read_b64_tr_b16 a[112:113], v228 offset:4096
    v_lshlrev_b32_e64 v32, 16, v8
    v_mfma_f32_16x16x32_bf16 v[200:203], v[84:87], a[84:87], v[200:203]
    ds_read_b64_tr_b16 a[114:115], v228 offset:4608
    v_and_b32 v33, 0xffff0000, v8
    v_mfma_f32_16x16x32_bf16 v[204:207], v[88:91], a[68:71], v[204:207]
    ds_read_b64_tr_b16 a[116:117], v229 offset:4096
    v_lshlrev_b32_e64 v34, 16, v9
    v_mfma_f32_16x16x32_bf16 v[204:207], v[92:95], a[84:87], v[204:207]
    ds_read_b64_tr_b16 a[118:119], v229 offset:4608
    v_and_b32 v35, 0xffff0000, v9
    v_mfma_f32_16x16x32_bf16 v[208:211], v[80:83], a[72:75], v[208:211]
    ds_read_b64_tr_b16 a[120:121], v230 offset:4096
    s_add_u32 m0, s34, 32768
    s_add_u32 s37, s86, 0
    buffer_load_dwordx4 v232, s[44:47], s37 offen lds
    v_mfma_f32_16x16x32_bf16 v[208:211], v[84:87], a[88:91], v[208:211]
    ds_read_b64_tr_b16 a[122:123], v230 offset:4608
    v_lshlrev_b32 v36, 16, v10
    v_mfma_f32_16x16x32_bf16 v[212:215], v[88:91], a[72:75], v[212:215]
    ds_read_b64_tr_b16 a[124:125], v231 offset:4096
    v_and_b32 v37, 0xffff0000, v10
    v_lshlrev_b32_e64 v38, 16, v11
    v_mfma_f32_16x16x32_bf16 v[212:215], v[92:95], a[88:91], v[212:215]
    ds_read_b64_tr_b16 a[126:127], v231 offset:4608
    v_and_b32 v39, 0xffff0000, v11
    v_mfma_f32_16x16x32_bf16 v[216:219], v[80:83], a[76:79], v[216:219]
    buffer_load_dwordx4 v233, s[44:47], s37 offen offset:1024 lds
    v_lshlrev_b32_e64 v40, 16, v12
    v_mfma_f32_16x16x32_bf16 v[216:219], v[84:87], a[92:95], v[216:219]
    v_and_b32 v41, 0xffff0000, v12
    v_lshlrev_b32_e64 v42, 16, v13
    v_mfma_f32_16x16x32_bf16 v[220:223], v[88:91], a[76:79], v[220:223]
    v_and_b32 v43, 0xffff0000, v13
    v_lshlrev_b32_e64 v44, 16, v14
    v_and_b32 v45, 0xffff0000, v14
    v_mfma_f32_16x16x32_bf16 v[220:223], v[92:95], a[92:95], v[220:223]
    v_lshlrev_b32 v46, 16, v15
    s_waitcnt lgkmcnt(0)
    v_mfma_f32_16x16x32_bf16 v[96:99], v[64:67], a[96:99], v[96:99]
    ds_read_b128 v[80:83], v224 offset:53248
    v_and_b32 v47, 0xffff0000, v15
    v_mfma_f32_16x16x32_bf16 v[96:99], v[68:71], a[112:115], v[96:99]
    ds_read_b128 v[84:87], v225 offset:53248
    v_add_f32_e64 v52, v16, v20
    v_mfma_f32_16x16x32_bf16 v[100:103], v[72:75], a[96:99], v[100:103]
    ds_read_b128 v[88:91], v224 offset:55296
    v_add_f32_e64 v53, v17, v21
    v_mfma_f32_16x16x32_bf16 v[100:103], v[76:79], a[112:115], v[100:103]
    ds_read_b128 v[92:95], v225 offset:55296
    v_add_f32 v54, v18, v22
    v_add_f32 v55, v19, v23
    v_mfma_f32_16x16x32_bf16 v[104:107], v[64:67], a[100:103], v[104:107]
    v_add_f32 v52, v52, v24
    v_add_f32 v53, v53, v25
    v_mfma_f32_16x16x32_bf16 v[104:107], v[68:71], a[116:119], v[104:107]
    v_add_f32 v54, v54, v26
    v_add_f32 v55, v55, v27
    v_mfma_f32_16x16x32_bf16 v[108:111], v[72:75], a[100:103], v[108:111]
    v_add_f32 v52, v52, v28
    v_add_f32 v53, v53, v29
    v_add_f32_e64 v54, v54, v30
    v_mfma_f32_16x16x32_bf16 v[108:111], v[76:79], a[116:119], v[108:111]
    v_add_f32 v55, v55, v31
    v_add_f32 v52, v52, v32
    v_mfma_f32_16x16x32_bf16 v[112:115], v[64:67], a[104:107], v[112:115]
    s_add_u32 m0, s35, 20480
    s_add_u32 s33, s33, 131072
    buffer_load_dwordx4 v234, s[48:51], s33 offen lds
    v_mfma_f32_16x16x32_bf16 v[112:115], v[68:71], a[120:123], v[112:115]
    v_add_f32 v53, v53, v33
    v_add_f32 v54, v54, v34
    v_mfma_f32_16x16x32_bf16 v[116:119], v[72:75], a[104:107], v[116:119]
    buffer_load_dwordx4 v235, s[48:51], s33 offen offset:1024 lds
    v_add_f32 v55, v55, v35
    v_add_f32 v52, v52, v36
    v_mfma_f32_16x16x32_bf16 v[116:119], v[76:79], a[120:123], v[116:119]
    v_add_f32 v53, v53, v37
    v_add_f32 v54, v54, v38
    v_mfma_f32_16x16x32_bf16 v[120:123], v[64:67], a[108:111], v[120:123]
    s_add_u32 m0, s35, 22528
    s_add_u32 s33, s33, 131072
    buffer_load_dwordx4 v234, s[48:51], s33 offen lds
    v_mfma_f32_16x16x32_bf16 v[120:123], v[68:71], a[124:127], v[120:123]
    v_add_f32 v55, v55, v39
    v_add_f32 v52, v52, v40
    v_mfma_f32_16x16x32_bf16 v[124:127], v[72:75], a[108:111], v[124:127]
    buffer_load_dwordx4 v235, s[48:51], s33 offen offset:1024 lds
    v_add_f32 v53, v53, v41
    v_add_f32 v54, v54, v42
    v_mfma_f32_16x16x32_bf16 v[124:127], v[76:79], a[124:127], v[124:127]
    v_add_f32 v55, v55, v43
    s_waitcnt lgkmcnt(0)
    v_mfma_f32_16x16x32_bf16 v[128:131], v[80:83], a[96:99], v[128:131]
    ds_read_b128 v[64:67], v224 offset:57344
    v_add_f32_e64 v52, v52, v44
    v_mfma_f32_16x16x32_bf16 v[128:131], v[84:87], a[112:115], v[128:131]
    ds_read_b128 v[68:71], v225 offset:57344
    v_add_f32_e64 v53, v53, v45
    v_mfma_f32_16x16x32_bf16 v[132:135], v[88:91], a[96:99], v[132:135]
    ds_read_b128 v[72:75], v224 offset:59392
    v_add_f32_e64 v54, v54, v46
    v_mfma_f32_16x16x32_bf16 v[132:135], v[92:95], a[112:115], v[132:135]
    ds_read_b128 v[76:79], v225 offset:59392
    v_add_f32 v55, v55, v47
    v_add_f32 v52, v52, v53
    v_mfma_f32_16x16x32_bf16 v[136:139], v[80:83], a[100:103], v[136:139]
    v_add_f32 v54, v54, v55
    v_add_f32 v48, v52, v54
    v_mfma_f32_16x16x32_bf16 v[136:139], v[84:87], a[116:119], v[136:139]
    s_nop 1
    v_add_f32_dpp v48, v48, v48 quad_perm:[1,0,3,2] row_mask:0xf bank_mask:0xf
    v_mfma_f32_16x16x32_bf16 v[140:143], v[88:91], a[100:103], v[140:143]
    s_nop 1
    v_add_f32_dpp v48, v48, v48 quad_perm:[2,3,0,1] row_mask:0xf bank_mask:0xf
    s_nop 1
    v_mfma_f32_16x16x32_bf16 v[140:143], v[92:95], a[116:119], v[140:143]
    v_add_f32_dpp v48, v48, v48 row_half_mirror row_mask:0xf bank_mask:0xf
    s_nop 1
    v_mfma_f32_16x16x32_bf16 v[144:147], v[80:83], a[104:107], v[144:147]
    s_add_u32 m0, s34, 40960
    s_add_u32 s37, s86, 65536
    buffer_load_dwordx4 v232, s[44:47], s37 offen lds
    v_mfma_f32_16x16x32_bf16 v[144:147], v[84:87], a[120:123], v[144:147]
    v_add_f32_dpp v48, v48, v48 row_mirror row_mask:0xf bank_mask:0xf
    s_nop 0
    v_mfma_f32_16x16x32_bf16 v[148:151], v[88:91], a[104:107], v[148:151]
    buffer_load_dwordx4 v233, s[44:47], s37 offen offset:1024 lds
    v_mov_b32_e64 v49, v48
    s_nop 1
    v_mfma_f32_16x16x32_bf16 v[148:151], v[92:95], a[120:123], v[148:151]
    v_permlane16_swap_b32 v48, v49
    s_nop 0
    v_mfma_f32_16x16x32_bf16 v[152:155], v[80:83], a[108:111], v[152:155]
    v_lshlrev_b32_e64 v227, 3, v240
    v_min_u32 v227, 1920, v227
    s_lshl2_add_u32 s25, s2, s3
    v_mfma_f32_16x16x32_bf16 v[152:155], v[84:87], a[124:127], v[152:155]
    v_add_f32 v48, v48, v49
    v_mul_f32 v48, 0x3a800000, v48
    v_mfma_f32_16x16x32_bf16 v[156:159], v[88:91], a[108:111], v[156:159]
    s_lshl_b32 s25, s25, 13
    s_add_u32 s25, s25, 0
    buffer_load_dword v241, v227, s[12:15], s25 offen
    v_mfma_f32_16x16x32_bf16 v[156:159], v[92:95], a[124:127], v[156:159]
    v_sub_f32 v56, v16, v48
    s_waitcnt vmcnt(16) lgkmcnt(0)
    v_mfma_f32_16x16x32_bf16 v[160:163], v[64:67], a[96:99], v[160:163]
    ds_read_b128 v[80:83], v224 offset:61440
    v_mul_f32 v52, v56, v56
    v_sub_f32 v57, v17, v48
    v_mfma_f32_16x16x32_bf16 v[160:163], v[68:71], a[112:115], v[160:163]
    ds_read_b128 v[84:87], v225 offset:61440
    v_mul_f32_e64 v53, v57, v57
    v_mfma_f32_16x16x32_bf16 v[164:167], v[72:75], a[96:99], v[164:167]
    ds_read_b128 v[88:91], v224 offset:63488
    v_sub_f32_e64 v58, v18, v48
    v_mfma_f32_16x16x32_bf16 v[164:167], v[76:79], a[112:115], v[164:167]
    ds_read_b128 v[92:95], v225 offset:63488
    v_mul_f32_e64 v54, v58, v58
    v_mfma_f32_16x16x32_bf16 v[168:171], v[64:67], a[100:103], v[168:171]
    ds_read_b64_tr_b16 a[128:129], v228 offset:8192
    v_sub_f32_e64 v59, v19, v48
    v_mfma_f32_16x16x32_bf16 v[168:171], v[68:71], a[116:119], v[168:171]
    ds_read_b64_tr_b16 a[130:131], v228 offset:8704
    v_mul_f32 v55, v59, v59
    v_sub_f32 v56, v20, v48
    v_mfma_f32_16x16x32_bf16 v[172:175], v[72:75], a[100:103], v[172:175]
    ds_read_b64_tr_b16 a[132:133], v229 offset:8192
    v_fmac_f32_e64 v52, v56, v56
    v_mfma_f32_16x16x32_bf16 v[172:175], v[76:79], a[116:119], v[172:175]
    ds_read_b64_tr_b16 a[134:135], v229 offset:8704
    v_sub_f32_e64 v57, v21, v48
    v_mfma_f32_16x16x32_bf16 v[176:179], v[64:67], a[104:107], v[176:179]
    ds_read_b64_tr_b16 a[136:137], v230 offset:8192
    s_add_u32 m0, s35, 0
    s_and_b32 s33, s86, 1023
    s_lshl_b32 s33, s33, 12
    buffer_load_dwordx4 v234, s[48:51], s33 offen lds
    v_mfma_f32_16x16x32_bf16 v[176:179], v[68:71], a[120:123], v[176:179]
    ds_read_b64_tr_b16 a[138:139], v230 offset:8704
    v_fmac_f32_e64 v53, v57, v57
    v_mfma_f32_16x16x32_bf16 v[180:183], v[72:75], a[104:107], v[180:183]
    ds_read_b64_tr_b16 a[140:141], v231 offset:8192
    buffer_load_dwordx4 v235, s[48:51], s33 offen offset:1024 lds
    v_mfma_f32_16x16x32_bf16 v[180:183], v[76:79], a[120:123], v[180:183]
    ds_read_b64_tr_b16 a[142:143], v231 offset:8704
    v_sub_f32_e64 v58, v22, v48
    v_mfma_f32_16x16x32_bf16 v[184:187], v[64:67], a[108:111], v[184:187]
    s_add_u32 m0, s35, 2048
    s_add_u32 s33, s33, 131072
    buffer_load_dwordx4 v234, s[48:51], s33 offen lds
    v_mfma_f32_16x16x32_bf16 v[184:187], v[68:71], a[124:127], v[184:187]
    v_fmac_f32 v54, v58, v58
    v_sub_f32 v59, v23, v48
    v_fmac_f32_e64 v55, v59, v59
    v_mfma_f32_16x16x32_bf16 v[188:191], v[72:75], a[108:111], v[188:191]
    buffer_load_dwordx4 v235, s[48:51], s33 offen offset:1024 lds
    v_sub_f32_e64 v56, v24, v48
    v_mfma_f32_16x16x32_bf16 v[188:191], v[76:79], a[124:127], v[188:191]
    s_waitcnt vmcnt(30) lgkmcnt(0)
    s_barrier
    v_mfma_f32_16x16x32_bf16 v[192:195], v[80:83], a[96:99], v[192:195]
    ds_read_b128 v[64:67], v224 offset:0
    v_fmac_f32_e64 v52, v56, v56
    v_mfma_f32_16x16x32_bf16 v[192:195], v[84:87], a[112:115], v[192:195]
    ds_read_b128 v[68:71], v225 offset:0
    v_sub_f32_e64 v57, v25, v48
    v_mfma_f32_16x16x32_bf16 v[196:199], v[88:91], a[96:99], v[196:199]
    ds_read_b128 v[72:75], v224 offset:2048
    v_fmac_f32_e64 v53, v57, v57
    v_mfma_f32_16x16x32_bf16 v[196:199], v[92:95], a[112:115], v[196:199]
    ds_read_b128 v[76:79], v225 offset:2048
    v_sub_f32 v58, v26, v48
    v_fmac_f32 v54, v58, v58
    v_mfma_f32_16x16x32_bf16 v[200:203], v[80:83], a[100:103], v[200:203]
    ds_read_b64_tr_b16 a[144:145], v228 offset:12288
    v_sub_f32_e64 v59, v27, v48
    v_mfma_f32_16x16x32_bf16 v[200:203], v[84:87], a[116:119], v[200:203]
    ds_read_b64_tr_b16 a[146:147], v228 offset:12800
    v_fmac_f32_e64 v55, v59, v59
    v_mfma_f32_16x16x32_bf16 v[204:207], v[88:91], a[100:103], v[204:207]
    ds_read_b64_tr_b16 a[148:149], v229 offset:12288
    v_sub_f32_e64 v56, v28, v48
    v_mfma_f32_16x16x32_bf16 v[204:207], v[92:95], a[116:119], v[204:207]
    ds_read_b64_tr_b16 a[150:151], v229 offset:12800
    v_fmac_f32_e64 v52, v56, v56
    v_mfma_f32_16x16x32_bf16 v[208:211], v[80:83], a[104:107], v[208:211]
    ds_read_b64_tr_b16 a[152:153], v230 offset:12288
    s_add_u32 m0, s34, 49152
    s_add_u32 s37, s87, 0
    buffer_load_dwordx4 v232, s[44:47], s37 offen lds
    v_mfma_f32_16x16x32_bf16 v[208:211], v[84:87], a[120:123], v[208:211]
    ds_read_b64_tr_b16 a[154:155], v230 offset:12800
    v_sub_f32 v57, v29, v48
    v_mfma_f32_16x16x32_bf16 v[212:215], v[88:91], a[104:107], v[212:215]
    ds_read_b64_tr_b16 a[156:157], v231 offset:12288
    v_fmac_f32 v53, v57, v57
    v_sub_f32 v58, v30, v48
    v_mfma_f32_16x16x32_bf16 v[212:215], v[92:95], a[120:123], v[212:215]
    ds_read_b64_tr_b16 a[158:159], v231 offset:12800
    v_fmac_f32_e64 v54, v58, v58
    v_mfma_f32_16x16x32_bf16 v[216:219], v[80:83], a[108:111], v[216:219]
    buffer_load_dwordx4 v233, s[44:47], s37 offen offset:1024 lds
    v_sub_f32_e64 v59, v31, v48
    v_mfma_f32_16x16x32_bf16 v[216:219], v[84:87], a[124:127], v[216:219]
    v_fmac_f32 v55, v59, v59
    v_sub_f32 v56, v32, v48
    v_mfma_f32_16x16x32_bf16 v[220:223], v[88:91], a[108:111], v[220:223]
    v_fmac_f32 v52, v56, v56
    v_sub_f32 v57, v33, v48
    v_fmac_f32_e64 v53, v57, v57
    v_mfma_f32_16x16x32_bf16 v[220:223], v[92:95], a[124:127], v[220:223]
    v_sub_f32 v58, v34, v48
    s_waitcnt lgkmcnt(0)
    v_mfma_f32_16x16x32_bf16 v[96:99], v[64:67], a[128:131], v[96:99]
    ds_read_b128 v[80:83], v224 offset:4096
    v_fmac_f32_e64 v54, v58, v58
    v_mfma_f32_16x16x32_bf16 v[96:99], v[68:71], a[144:147], v[96:99]
    ds_read_b128 v[84:87], v225 offset:4096
    v_sub_f32_e64 v59, v35, v48
    v_mfma_f32_16x16x32_bf16 v[100:103], v[72:75], a[128:131], v[100:103]
    ds_read_b128 v[88:91], v224 offset:6144
    v_fmac_f32_e64 v55, v59, v59
    v_mfma_f32_16x16x32_bf16 v[100:103], v[76:79], a[144:147], v[100:103]
    ds_read_b128 v[92:95], v225 offset:6144
    v_sub_f32 v56, v36, v48
    v_fmac_f32 v52, v56, v56
    v_mfma_f32_16x16x32_bf16 v[104:107], v[64:67], a[132:135], v[104:107]
    v_sub_f32 v57, v37, v48
    v_fmac_f32 v53, v57, v57
    v_mfma_f32_16x16x32_bf16 v[104:107], v[68:71], a[148:151], v[104:107]
    v_sub_f32 v58, v38, v48
    v_fmac_f32 v54, v58, v58
    v_mfma_f32_16x16x32_bf16 v[108:111], v[72:75], a[132:135], v[108:111]
    v_sub_f32 v59, v39, v48
    v_fmac_f32 v55, v59, v59
    v_sub_f32_e64 v56, v40, v48
    v_mfma_f32_16x16x32_bf16 v[108:111], v[76:79], a[148:151], v[108:111]
    v_fmac_f32 v52, v56, v56
    v_sub_f32 v57, v41, v48
    v_mfma_f32_16x16x32_bf16 v[112:115], v[64:67], a[136:139], v[112:115]
    s_add_u32 m0, s35, 4096
    s_add_u32 s33, s33, 131072
    buffer_load_dwordx4 v234, s[48:51], s33 offen lds
    v_mfma_f32_16x16x32_bf16 v[112:115], v[68:71], a[152:155], v[112:115]
    v_fmac_f32 v53, v57, v57
    v_sub_f32 v58, v42, v48
    v_mfma_f32_16x16x32_bf16 v[116:119], v[72:75], a[136:139], v[116:119]
    buffer_load_dwordx4 v235, s[48:51], s33 offen offset:1024 lds
    v_fmac_f32 v54, v58, v58
    v_sub_f32 v59, v43, v48
    v_mfma_f32_16x16x32_bf16 v[116:119], v[76:79], a[152:155], v[116:119]
    v_fmac_f32 v55, v59, v59
    v_sub_f32 v56, v44, v48
    v_mfma_f32_16x16x32_bf16 v[120:123], v[64:67], a[140:143], v[120:123]
    s_add_u32 m0, s35, 6144
    s_add_u32 s33, s33, 131072
    buffer_load_dwordx4 v234, s[48:51], s33 offen lds
    v_mfma_f32_16x16x32_bf16 v[120:123], v[68:71], a[156:159], v[120:123]
    v_fmac_f32 v52, v56, v56
    v_sub_f32 v57, v45, v48
    v_mfma_f32_16x16x32_bf16 v[124:127], v[72:75], a[140:143], v[124:127]
    buffer_load_dwordx4 v235, s[48:51], s33 offen offset:1024 lds
    v_fmac_f32 v53, v57, v57
    v_sub_f32 v58, v46, v48
    v_mfma_f32_16x16x32_bf16 v[124:127], v[76:79], a[156:159], v[124:127]
    v_fmac_f32 v54, v58, v58
    s_waitcnt lgkmcnt(0)
    v_mfma_f32_16x16x32_bf16 v[128:131], v[80:83], a[128:131], v[128:131]
    ds_read_b128 v[64:67], v224 offset:8192
    v_sub_f32_e64 v59, v47, v48
    v_mfma_f32_16x16x32_bf16 v[128:131], v[84:87], a[144:147], v[128:131]
    ds_read_b128 v[68:71], v225 offset:8192
    v_fmac_f32_e64 v55, v59, v59
    v_mfma_f32_16x16x32_bf16 v[132:135], v[88:91], a[128:131], v[132:135]
    ds_read_b128 v[72:75], v224 offset:10240
    v_add_f32_e64 v52, v52, v53
    v_mfma_f32_16x16x32_bf16 v[132:135], v[92:95], a[144:147], v[132:135]
    ds_read_b128 v[76:79], v225 offset:10240
    v_add_f32_e64 v54, v54, v55
    v_mfma_f32_16x16x32_bf16 v[136:139], v[80:83], a[132:135], v[136:139]
    v_add_f32 v51, v52, v54
    s_nop 1
    v_add_f32_dpp v51, v51, v51 quad_perm:[1,0,3,2] row_mask:0xf bank_mask:0xf
    v_mfma_f32_16x16x32_bf16 v[136:139], v[84:87], a[148:151], v[136:139]
    s_nop 1
    v_add_f32_dpp v51, v51, v51 quad_perm:[2,3,0,1] row_mask:0xf bank_mask:0xf
    v_mfma_f32_16x16x32_bf16 v[140:143], v[88:91], a[132:135], v[140:143]
    s_nop 1
    v_add_f32_dpp v51, v51, v51 row_half_mirror row_mask:0xf bank_mask:0xf
    s_nop 1
    v_mfma_f32_16x16x32_bf16 v[140:143], v[92:95], a[148:151], v[140:143]
    v_add_f32_dpp v51, v51, v51 row_mirror row_mask:0xf bank_mask:0xf
    s_nop 0
    v_mfma_f32_16x16x32_bf16 v[144:147], v[80:83], a[136:139], v[144:147]
    s_add_u32 m0, s34, 57344
    s_add_u32 s37, s87, 65536
    buffer_load_dwordx4 v232, s[44:47], s37 offen lds
    v_mfma_f32_16x16x32_bf16 v[144:147], v[84:87], a[152:155], v[144:147]
    v_mov_b32 v49, v51
    s_nop 1
    v_mfma_f32_16x16x32_bf16 v[148:151], v[88:91], a[136:139], v[148:151]
    buffer_load_dwordx4 v233, s[44:47], s37 offen offset:1024 lds
    v_permlane16_swap_b32 v51, v49
    s_nop 0
    v_mfma_f32_16x16x32_bf16 v[148:151], v[92:95], a[152:155], v[148:151]
    v_add_f32_e64 v51, v51, v49
    v_mul_f32 v51, 0x3a800000, v51
    v_mfma_f32_16x16x32_bf16 v[152:155], v[80:83], a[140:143], v[152:155]
    v_lshlrev_b32_e64 v227, 3, v240
    v_min_u32 v227, 1920, v227
    s_lshl2_add_u32 s25, s2, s3
    v_mfma_f32_16x16x32_bf16 v[152:155], v[84:87], a[156:159], v[152:155]
    v_cvt_pk_bf16_f32 v50, v48, v51
    v_and_b32 v51, 0xffff0000, v50
    v_mfma_f32_16x16x32_bf16 v[156:159], v[88:91], a[140:143], v[156:159]
    s_lshl_b32 s25, s25, 13
    s_add_u32 s25, s25, 2048
    buffer_load_dword v241, v227, s[12:15], s25 offen
    v_mfma_f32_16x16x32_bf16 v[156:159], v[92:95], a[156:159], v[156:159]
    v_lshlrev_b32 v50, 16, v50
    s_waitcnt vmcnt(16) lgkmcnt(0)
    v_mfma_f32_16x16x32_bf16 v[160:163], v[64:67], a[128:131], v[160:163]
    ds_read_b128 v[80:83], v224 offset:12288
    v_add_f32 v51, 0x3727c5ac, v51
    v_cvt_pk_bf16_f32 v51, v51, v51
    v_mfma_f32_16x16x32_bf16 v[160:163], v[68:71], a[144:147], v[160:163]
    ds_read_b128 v[84:87], v225 offset:12288
    v_lshlrev_b32_e64 v51, 16, v51
    v_mfma_f32_16x16x32_bf16 v[164:167], v[72:75], a[128:131], v[164:167]
    ds_read_b128 v[88:91], v224 offset:14336
    v_mfma_f32_16x16x32_bf16 v[164:167], v[76:79], a[144:147], v[164:167]
    ds_read_b128 v[92:95], v225 offset:14336
    v_sqrt_f32 v51, v51
    v_mfma_f32_16x16x32_bf16 v[168:171], v[64:67], a[132:135], v[168:171]
    ds_read_b64_tr_b16 a[160:161], v228 offset:16384
    s_nop 0
    v_mfma_f32_16x16x32_bf16 v[168:171], v[68:71], a[148:151], v[168:171]
    ds_read_b64_tr_b16 a[162:163], v228 offset:16896
    v_cvt_pk_bf16_f32 v51, v51, v51
    v_lshlrev_b32_e64 v51, 16, v51
    v_mfma_f32_16x16x32_bf16 v[172:175], v[72:75], a[132:135], v[172:175]
    ds_read_b64_tr_b16 a[164:165], v229 offset:16384
    v_mfma_f32_16x16x32_bf16 v[172:175], v[76:79], a[148:151], v[172:175]
    ds_read_b64_tr_b16 a[166:167], v229 offset:16896
    v_rcp_f32_e64 v51, v51
    v_mfma_f32_16x16x32_bf16 v[176:179], v[64:67], a[136:139], v[176:179]
    ds_read_b64_tr_b16 a[168:169], v230 offset:16384
    s_add_u32 m0, s35, 8192
    s_and_b32 s33, s87, 1023
    s_lshl_b32 s33, s33, 12
    buffer_load_dwordx4 v234, s[48:51], s33 offen lds
    v_mfma_f32_16x16x32_bf16 v[176:179], v[68:71], a[152:155], v[176:179]
    ds_read_b64_tr_b16 a[170:171], v230 offset:16896
    s_nop 0
    v_mfma_f32_16x16x32_bf16 v[180:183], v[72:75], a[136:139], v[180:183]
    ds_read_b64_tr_b16 a[172:173], v231 offset:16384
    buffer_load_dwordx4 v235, s[48:51], s33 offen offset:1024 lds
    v_mfma_f32_16x16x32_bf16 v[180:183], v[76:79], a[152:155], v[180:183]
    ds_read_b64_tr_b16 a[174:175], v231 offset:16896
    v_mul_f32 v51, 0x3e0293ee, v51
    v_mfma_f32_16x16x32_bf16 v[184:187], v[64:67], a[140:143], v[184:187]
    s_add_u32 m0, s35, 10240
    s_add_u32 s33, s33, 131072
    buffer_load_dwordx4 v234, s[48:51], s33 offen lds
    v_mfma_f32_16x16x32_bf16 v[184:187], v[68:71], a[156:159], v[184:187]
    v_sub_f32 v16, v16, v50
    v_sub_f32 v17, v17, v50
    v_cvt_pk_bf16_f32 v17, v16, v17
    v_mfma_f32_16x16x32_bf16 v[188:191], v[72:75], a[140:143], v[188:191]
    buffer_load_dwordx4 v235, s[48:51], s33 offen offset:1024 lds
    v_lshlrev_b32_e64 v16, 16, v17
    v_mfma_f32_16x16x32_bf16 v[188:191], v[76:79], a[156:159], v[188:191]
    s_waitcnt vmcnt(31) lgkmcnt(0)
    s_barrier
    v_mfma_f32_16x16x32_bf16 v[192:195], v[80:83], a[128:131], v[192:195]
    ds_read_b128 v[64:67], v224 offset:16384
    v_and_b32 v17, 0xffff0000, v17
    v_mfma_f32_16x16x32_bf16 v[192:195], v[84:87], a[144:147], v[192:195]
    ds_read_b128 v[68:71], v225 offset:16384
    v_mul_f32_e64 v16, v16, v51
    v_mfma_f32_16x16x32_bf16 v[196:199], v[88:91], a[128:131], v[196:199]
    ds_read_b128 v[72:75], v224 offset:18432
    v_mul_f32_e64 v17, v17, v51
    v_mfma_f32_16x16x32_bf16 v[196:199], v[92:95], a[144:147], v[196:199]
    ds_read_b128 v[76:79], v225 offset:18432
    v_cvt_pk_bf16_f32 v0, v16, v17
    v_sub_f32_e64 v18, v18, v50
    v_mfma_f32_16x16x32_bf16 v[200:203], v[80:83], a[132:135], v[200:203]
    ds_read_b64_tr_b16 a[176:177], v228 offset:20480
    v_sub_f32_e64 v19, v19, v50
    v_mfma_f32_16x16x32_bf16 v[200:203], v[84:87], a[148:151], v[200:203]
    ds_read_b64_tr_b16 a[178:179], v228 offset:20992
    v_cvt_pk_bf16_f32 v19, v18, v19
    v_mfma_f32_16x16x32_bf16 v[204:207], v[88:91], a[132:135], v[204:207]
    ds_read_b64_tr_b16 a[180:181], v229 offset:20480
    v_lshlrev_b32_e64 v18, 16, v19
    v_mfma_f32_16x16x32_bf16 v[204:207], v[92:95], a[148:151], v[204:207]
    ds_read_b64_tr_b16 a[182:183], v229 offset:20992
    v_and_b32 v19, 0xffff0000, v19
    v_mfma_f32_16x16x32_bf16 v[208:211], v[80:83], a[136:139], v[208:211]
    ds_read_b64_tr_b16 a[184:185], v230 offset:20480
    s_add_u32 m0, s34, 0
    s_add_u32 s37, s80, 131072
    buffer_load_dwordx4 v232, s[44:47], s37 offen lds
    v_mfma_f32_16x16x32_bf16 v[208:211], v[84:87], a[152:155], v[208:211]
    ds_read_b64_tr_b16 a[186:187], v230 offset:20992
    v_mul_f32 v18, v18, v51
    v_mfma_f32_16x16x32_bf16 v[212:215], v[88:91], a[136:139], v[212:215]
    ds_read_b64_tr_b16 a[188:189], v231 offset:20480
    v_mul_f32_e64 v19, v19, v51
    v_cvt_pk_bf16_f32 v1, v18, v19
    v_mfma_f32_16x16x32_bf16 v[212:215], v[92:95], a[152:155], v[212:215]
    ds_read_b64_tr_b16 a[190:191], v231 offset:20992
    v_sub_f32_e64 v20, v20, v50
    v_mfma_f32_16x16x32_bf16 v[216:219], v[80:83], a[140:143], v[216:219]
    buffer_load_dwordx4 v233, s[44:47], s37 offen offset:1024 lds
    v_sub_f32_e64 v21, v21, v50
    v_mfma_f32_16x16x32_bf16 v[216:219], v[84:87], a[156:159], v[216:219]
    v_cvt_pk_bf16_f32 v21, v20, v21
    v_lshlrev_b32_e64 v20, 16, v21
    v_mfma_f32_16x16x32_bf16 v[220:223], v[88:91], a[140:143], v[220:223]
    v_and_b32 v21, 0xffff0000, v21
    v_mul_f32 v20, v20, v51
    v_mul_f32 v21, v21, v51
    v_mfma_f32_16x16x32_bf16 v[220:223], v[92:95], a[156:159], v[220:223]
    v_cvt_pk_bf16_f32 v2, v20, v21
    s_waitcnt lgkmcnt(0)
    v_mfma_f32_16x16x32_bf16 v[96:99], v[64:67], a[160:163], v[96:99]
    ds_read_b128 v[80:83], v224 offset:20480
    v_sub_f32 v22, v22, v50
    v_mfma_f32_16x16x32_bf16 v[96:99], v[68:71], a[176:179], v[96:99]
    ds_read_b128 v[84:87], v225 offset:20480
    v_sub_f32_e64 v23, v23, v50
    v_mfma_f32_16x16x32_bf16 v[100:103], v[72:75], a[160:163], v[100:103]
    ds_read_b128 v[88:91], v224 offset:22528
    v_cvt_pk_bf16_f32 v23, v22, v23
    v_mfma_f32_16x16x32_bf16 v[100:103], v[76:79], a[176:179], v[100:103]
    ds_read_b128 v[92:95], v225 offset:22528
    v_lshlrev_b32_e64 v22, 16, v23
    v_and_b32 v23, 0xffff0000, v23
    v_mfma_f32_16x16x32_bf16 v[104:107], v[64:67], a[164:167], v[104:107]
    v_mul_f32 v22, v22, v51
    v_mul_f32 v23, v23, v51
    v_mfma_f32_16x16x32_bf16 v[104:107], v[68:71], a[180:183], v[104:107]
    v_cvt_pk_bf16_f32 v3, v22, v23
    v_sub_f32_e64 v24, v24, v50
    v_mfma_f32_16x16x32_bf16 v[108:111], v[72:75], a[164:167], v[108:111]
    v_sub_f32_e64 v25, v25, v50
    v_cvt_pk_bf16_f32 v25, v24, v25
    v_lshlrev_b32_e64 v24, 16, v25
    v_mfma_f32_16x16x32_bf16 v[108:111], v[76:79], a[180:183], v[108:111]
    v_and_b32 v25, 0xffff0000, v25
    v_mul_f32_e64 v24, v24, v51
    v_mfma_f32_16x16x32_bf16 v[112:115], v[64:67], a[168:171], v[112:115]
    s_add_u32 m0, s35, 12288
    s_add_u32 s33, s33, 131072
    buffer_load_dwordx4 v234, s[48:51], s33 offen lds
    v_mfma_f32_16x16x32_bf16 v[112:115], v[68:71], a[184:187], v[112:115]
    v_mul_f32_e64 v25, v25, v51
    v_cvt_pk_bf16_f32 v4, v24, v25
    v_mfma_f32_16x16x32_bf16 v[116:119], v[72:75], a[168:171], v[116:119]
    buffer_load_dwordx4 v235, s[48:51], s33 offen offset:1024 lds
    v_sub_f32 v26, v26, v50
    v_sub_f32 v27, v27, v50
    v_mfma_f32_16x16x32_bf16 v[116:119], v[76:79], a[184:187], v[116:119]
    v_cvt_pk_bf16_f32 v27, v26, v27
    v_lshlrev_b32_e64 v26, 16, v27
    v_mfma_f32_16x16x32_bf16 v[120:123], v[64:67], a[172:175], v[120:123]
    s_add_u32 m0, s35, 14336
    s_add_u32 s33, s33, 131072
    buffer_load_dwordx4 v234, s[48:51], s33 offen lds
    v_mfma_f32_16x16x32_bf16 v[120:123], v[68:71], a[188:191], v[120:123]
    v_and_b32 v27, 0xffff0000, v27
    v_mul_f32_e64 v26, v26, v51
    v_mfma_f32_16x16x32_bf16 v[124:127], v[72:75], a[172:175], v[124:127]
    buffer_load_dwordx4 v235, s[48:51], s33 offen offset:1024 lds
    v_mul_f32_e64 v27, v27, v51
    v_cvt_pk_bf16_f32 v5, v26, v27
    v_mfma_f32_16x16x32_bf16 v[124:127], v[76:79], a[188:191], v[124:127]
    v_sub_f32 v28, v28, v50
    s_waitcnt lgkmcnt(0)
    v_mfma_f32_16x16x32_bf16 v[128:131], v[80:83], a[160:163], v[128:131]
    ds_read_b128 v[64:67], v224 offset:24576
    v_sub_f32_e64 v29, v29, v50
    v_mfma_f32_16x16x32_bf16 v[128:131], v[84:87], a[176:179], v[128:131]
    ds_read_b128 v[68:71], v225 offset:24576
    v_cvt_pk_bf16_f32 v29, v28, v29
    v_mfma_f32_16x16x32_bf16 v[132:135], v[88:91], a[160:163], v[132:135]
    ds_read_b128 v[72:75], v224 offset:26624
    v_lshlrev_b32_e64 v28, 16, v29
    v_mfma_f32_16x16x32_bf16 v[132:135], v[92:95], a[176:179], v[132:135]
    ds_read_b128 v[76:79], v225 offset:26624
    v_and_b32 v29, 0xffff0000, v29
    v_mfma_f32_16x16x32_bf16 v[136:139], v[80:83], a[164:167], v[136:139]
    v_mul_f32 v28, v28, v51
    v_mul_f32 v29, v29, v51
    v_cvt_pk_bf16_f32 v6, v28, v29
    v_mfma_f32_16x16x32_bf16 v[136:139], v[84:87], a[180:183], v[136:139]
    v_sub_f32 v30, v30, v50
    v_sub_f32 v31, v31, v50
    v_mfma_f32_16x16x32_bf16 v[140:143], v[88:91], a[164:167], v[140:143]
    v_cvt_pk_bf16_f32 v31, v30, v31
    v_lshlrev_b32_e64 v30, 16, v31
    v_and_b32 v31, 0xffff0000, v31
    v_mfma_f32_16x16x32_bf16 v[140:143], v[92:95], a[180:183], v[140:143]
    v_mul_f32 v30, v30, v51
    v_mul_f32 v31, v31, v51
    v_mfma_f32_16x16x32_bf16 v[144:147], v[80:83], a[168:171], v[144:147]
    s_add_u32 m0, s34, 8192
    s_add_u32 s37, s81, 131072
    buffer_load_dwordx4 v232, s[44:47], s37 offen lds
    v_mfma_f32_16x16x32_bf16 v[144:147], v[84:87], a[184:187], v[144:147]
    v_cvt_pk_bf16_f32 v7, v30, v31
    v_sub_f32_e64 v32, v32, v50
    v_mfma_f32_16x16x32_bf16 v[148:151], v[88:91], a[168:171], v[148:151]
    buffer_load_dwordx4 v233, s[44:47], s37 offen offset:1024 lds
    v_sub_f32_e64 v33, v33, v50
    v_mfma_f32_16x16x32_bf16 v[148:151], v[92:95], a[184:187], v[148:151]
    v_cvt_pk_bf16_f32 v33, v32, v33
    v_lshlrev_b32_e64 v32, 16, v33
    v_and_b32 v33, 0xffff0000, v33
    v_mfma_f32_16x16x32_bf16 v[152:155], v[80:83], a[172:175], v[152:155]
    v_lshlrev_b32_e64 v227, 3, v240
    v_min_u32 v227, 1920, v227
    s_lshl2_add_u32 s25, s2, s3
    v_mfma_f32_16x16x32_bf16 v[152:155], v[84:87], a[188:191], v[152:155]
    v_mul_f32 v32, v32, v51
    v_mul_f32_e64 v33, v33, v51
    v_mfma_f32_16x16x32_bf16 v[156:159], v[88:91], a[172:175], v[156:159]
    s_lshl_b32 s25, s25, 13
    s_add_u32 s25, s25, 4096
    buffer_load_dword v241, v227, s[12:15], s25 offen
    v_mfma_f32_16x16x32_bf16 v[156:159], v[92:95], a[188:191], v[156:159]
    v_cvt_pk_bf16_f32 v8, v32, v33
    s_waitcnt vmcnt(16) lgkmcnt(0)
    v_mfma_f32_16x16x32_bf16 v[160:163], v[64:67], a[160:163], v[160:163]
    ds_read_b128 v[80:83], v224 offset:28672
    v_sub_f32 v34, v34, v50
    v_sub_f32 v35, v35, v50
    v_mfma_f32_16x16x32_bf16 v[160:163], v[68:71], a[176:179], v[160:163]
    ds_read_b128 v[84:87], v225 offset:28672
    v_cvt_pk_bf16_f32 v35, v34, v35
    v_mfma_f32_16x16x32_bf16 v[164:167], v[72:75], a[160:163], v[164:167]
    ds_read_b128 v[88:91], v224 offset:30720
    v_lshlrev_b32_e64 v34, 16, v35
    v_mfma_f32_16x16x32_bf16 v[164:167], v[76:79], a[176:179], v[164:167]
    ds_read_b128 v[92:95], v225 offset:30720
    v_and_b32 v35, 0xffff0000, v35
    v_mfma_f32_16x16x32_bf16 v[168:171], v[64:67], a[164:167], v[168:171]
    ds_read_b64_tr_b16 a[192:193], v228 offset:0
    v_mul_f32_e64 v34, v34, v51
    v_mfma_f32_16x16x32_bf16 v[168:171], v[68:71], a[180:183], v[168:171]
    ds_read_b64_tr_b16 a[194:195], v228 offset:512
    v_mul_f32_e64 v35, v35, v51
    v_cvt_pk_bf16_f32 v9, v34, v35
    v_mfma_f32_16x16x32_bf16 v[172:175], v[72:75], a[164:167], v[172:175]
    ds_read_b64_tr_b16 a[196:197], v229 offset:0
    v_sub_f32_e64 v36, v36, v50
    v_mfma_f32_16x16x32_bf16 v[172:175], v[76:79], a[180:183], v[172:175]
    ds_read_b64_tr_b16 a[198:199], v229 offset:512
    v_sub_f32_e64 v37, v37, v50
    v_mfma_f32_16x16x32_bf16 v[176:179], v[64:67], a[168:171], v[176:179]
    ds_read_b64_tr_b16 a[200:201], v230 offset:0
    v_cvt_pk_bf16_f32 v37, v36, v37
    v_mfma_f32_16x16x32_bf16 v[176:179], v[68:71], a[184:187], v[176:179]
    ds_read_b64_tr_b16 a[202:203], v230 offset:512
    v_lshlrev_b32_e64 v36, 16, v37
    v_mfma_f32_16x16x32_bf16 v[180:183], v[72:75], a[168:171], v[180:183]
    ds_read_b64_tr_b16 a[204:205], v231 offset:0
    v_and_b32 v37, 0xffff0000, v37
    v_mfma_f32_16x16x32_bf16 v[180:183], v[76:79], a[184:187], v[180:183]
    ds_read_b64_tr_b16 a[206:207], v231 offset:512
    v_mul_f32 v36, v36, v51
    v_mul_f32 v37, v37, v51
    v_mfma_f32_16x16x32_bf16 v[184:187], v[64:67], a[172:175], v[184:187]
    v_cvt_pk_bf16_f32 v10, v36, v37
    v_sub_f32_e64 v38, v38, v50
    v_mfma_f32_16x16x32_bf16 v[184:187], v[68:71], a[188:191], v[184:187]
    v_sub_f32_e64 v39, v39, v50
    v_cvt_pk_bf16_f32 v39, v38, v39
    v_mfma_f32_16x16x32_bf16 v[188:191], v[72:75], a[172:175], v[188:191]
    v_lshlrev_b32_e64 v38, 16, v39
    v_and_b32 v39, 0xffff0000, v39
    v_mul_f32_e64 v38, v38, v51
    v_mfma_f32_16x16x32_bf16 v[188:191], v[76:79], a[188:191], v[188:191]
    s_waitcnt vmcnt(27) lgkmcnt(0)
    s_barrier
    v_mfma_f32_16x16x32_bf16 v[192:195], v[80:83], a[160:163], v[192:195]
    ds_read_b128 v[64:67], v224 offset:32768
    v_mul_f32_e64 v39, v39, v51
    v_mfma_f32_16x16x32_bf16 v[192:195], v[84:87], a[176:179], v[192:195]
    ds_read_b128 v[68:71], v225 offset:32768
    v_cvt_pk_bf16_f32 v11, v38, v39
    v_mfma_f32_16x16x32_bf16 v[196:199], v[88:91], a[160:163], v[196:199]
    ds_read_b128 v[72:75], v224 offset:34816
    v_sub_f32_e64 v40, v40, v50
    v_mfma_f32_16x16x32_bf16 v[196:199], v[92:95], a[176:179], v[196:199]
    ds_read_b128 v[76:79], v225 offset:34816
    v_sub_f32_e64 v41, v41, v50
    v_mfma_f32_16x16x32_bf16 v[200:203], v[80:83], a[164:167], v[200:203]
    ds_read_b64_tr_b16 a[208:209], v228 offset:4096
    v_cvt_pk_bf16_f32 v41, v40, v41
    v_lshlrev_b32_e64 v40, 16, v41
    v_mfma_f32_16x16x32_bf16 v[200:203], v[84:87], a[180:183], v[200:203]
    ds_read_b64_tr_b16 a[210:211], v228 offset:4608
    v_and_b32 v41, 0xffff0000, v41
    v_mfma_f32_16x16x32_bf16 v[204:207], v[88:91], a[164:167], v[204:207]
    ds_read_b64_tr_b16 a[212:213], v229 offset:4096
    v_mul_f32_e64 v40, v40, v51
    v_mfma_f32_16x16x32_bf16 v[204:207], v[92:95], a[180:183], v[204:207]
    ds_read_b64_tr_b16 a[214:215], v229 offset:4608
    v_mul_f32_e64 v41, v41, v51
    v_mfma_f32_16x16x32_bf16 v[208:211], v[80:83], a[168:171], v[208:211]
    ds_read_b64_tr_b16 a[216:217], v230 offset:4096
    s_add_u32 m0, s34, 16384
    s_add_u32 s37, s82, 131072
    buffer_load_dwordx4 v232, s[44:47], s37 offen lds
    v_mfma_f32_16x16x32_bf16 v[208:211], v[84:87], a[184:187], v[208:211]
    ds_read_b64_tr_b16 a[218:219], v230 offset:4608
    v_cvt_pk_bf16_f32 v12, v40, v41
    v_mfma_f32_16x16x32_bf16 v[212:215], v[88:91], a[168:171], v[212:215]
    ds_read_b64_tr_b16 a[220:221], v231 offset:4096
    v_sub_f32 v42, v42, v50
    v_sub_f32 v43, v43, v50
    v_mfma_f32_16x16x32_bf16 v[212:215], v[92:95], a[184:187], v[212:215]
    ds_read_b64_tr_b16 a[222:223], v231 offset:4608
    v_cvt_pk_bf16_f32 v43, v42, v43
    v_mfma_f32_16x16x32_bf16 v[216:219], v[80:83], a[172:175], v[216:219]
    buffer_load_dwordx4 v233, s[44:47], s37 offen offset:1024 lds
    v_lshlrev_b32_e64 v42, 16, v43
    v_mfma_f32_16x16x32_bf16 v[216:219], v[84:87], a[188:191], v[216:219]
    v_and_b32 v43, 0xffff0000, v43
    v_mul_f32_e64 v42, v42, v51
    v_mfma_f32_16x16x32_bf16 v[220:223], v[88:91], a[172:175], v[220:223]
    v_mul_f32_e64 v43, v43, v51
    v_cvt_pk_bf16_f32 v13, v42, v43
    v_sub_f32_e64 v44, v44, v50
    v_mfma_f32_16x16x32_bf16 v[220:223], v[92:95], a[188:191], v[220:223]
    v_sub_f32 v45, v45, v50
    s_waitcnt lgkmcnt(0)
    v_mfma_f32_16x16x32_bf16 v[96:99], v[64:67], a[192:195], v[96:99]
    ds_read_b128 v[80:83], v224 offset:36864
    v_cvt_pk_bf16_f32 v45, v44, v45
    v_mfma_f32_16x16x32_bf16 v[96:99], v[68:71], a[208:211], v[96:99]
    ds_read_b128 v[84:87], v225 offset:36864
    v_lshlrev_b32_e64 v44, 16, v45
    v_mfma_f32_16x16x32_bf16 v[100:103], v[72:75], a[192:195], v[100:103]
    ds_read_b128 v[88:91], v224 offset:38912
    v_and_b32 v45, 0xffff0000, v45
    v_mfma_f32_16x16x32_bf16 v[100:103], v[76:79], a[208:211], v[100:103]
    ds_read_b128 v[92:95], v225 offset:38912
    v_mul_f32 v44, v44, v51
    v_mul_f32 v45, v45, v51
    v_mfma_f32_16x16x32_bf16 v[104:107], v[64:67], a[196:199], v[104:107]
    v_cvt_pk_bf16_f32 v14, v44, v45
    v_sub_f32_e64 v46, v46, v50
    v_mfma_f32_16x16x32_bf16 v[104:107], v[68:71], a[212:215], v[104:107]
    v_sub_f32_e64 v47, v47, v50
    v_cvt_pk_bf16_f32 v47, v46, v47
    v_mfma_f32_16x16x32_bf16 v[108:111], v[72:75], a[196:199], v[108:111]
    v_lshlrev_b32_e64 v46, 16, v47
    v_and_b32 v47, 0xffff0000, v47
    v_mul_f32_e64 v46, v46, v51
    v_mfma_f32_16x16x32_bf16 v[108:111], v[76:79], a[212:215], v[108:111]
    v_mul_f32_e64 v47, v47, v51
    v_cvt_pk_bf16_f32 v15, v46, v47
    v_mfma_f32_16x16x32_bf16 v[112:115], v[64:67], a[200:203], v[112:115]
    v_mfma_f32_16x16x32_bf16 v[112:115], v[68:71], a[216:219], v[112:115]
    ds_write_b128 v237, v[0:3] offset:0
    v_mfma_f32_16x16x32_bf16 v[116:119], v[72:75], a[200:203], v[116:119]
    ds_write_b128 v237, v[4:7] offset:4096
    v_mfma_f32_16x16x32_bf16 v[116:119], v[76:79], a[216:219], v[116:119]
    ds_write_b128 v237, v[8:11] offset:24576
    v_mfma_f32_16x16x32_bf16 v[120:123], v[64:67], a[204:207], v[120:123]
    ds_write_b128 v237, v[12:15] offset:28672
    v_mfma_f32_16x16x32_bf16 v[120:123], v[68:71], a[220:223], v[120:123]
    v_mfma_f32_16x16x32_bf16 v[124:127], v[72:75], a[204:207], v[124:127]
    v_mfma_f32_16x16x32_bf16 v[124:127], v[76:79], a[220:223], v[124:127]
    s_waitcnt lgkmcnt(0)
    v_mfma_f32_16x16x32_bf16 v[128:131], v[80:83], a[192:195], v[128:131]
    ds_read_b128 v[64:67], v224 offset:40960
    v_mfma_f32_16x16x32_bf16 v[128:131], v[84:87], a[208:211], v[128:131]
    ds_read_b128 v[68:71], v225 offset:40960
    v_mfma_f32_16x16x32_bf16 v[132:135], v[88:91], a[192:195], v[132:135]
    ds_read_b128 v[72:75], v224 offset:43008
    v_mfma_f32_16x16x32_bf16 v[132:135], v[92:95], a[208:211], v[132:135]
    ds_read_b128 v[76:79], v225 offset:43008
    v_mfma_f32_16x16x32_bf16 v[136:139], v[80:83], a[196:199], v[136:139]
    v_mfma_f32_16x16x32_bf16 v[136:139], v[84:87], a[212:215], v[136:139]
    v_mfma_f32_16x16x32_bf16 v[140:143], v[88:91], a[196:199], v[140:143]
    v_mfma_f32_16x16x32_bf16 v[140:143], v[92:95], a[212:215], v[140:143]
    v_mfma_f32_16x16x32_bf16 v[144:147], v[80:83], a[200:203], v[144:147]
    s_add_u32 m0, s34, 24576
    s_add_u32 s37, s83, 131072
    buffer_load_dwordx4 v232, s[44:47], s37 offen lds
    v_mfma_f32_16x16x32_bf16 v[144:147], v[84:87], a[216:219], v[144:147]
    buffer_load_dwordx4 v233, s[44:47], s37 offen offset:1024 lds
    v_mfma_f32_16x16x32_bf16 v[148:151], v[88:91], a[200:203], v[148:151]
    v_mfma_f32_16x16x32_bf16 v[148:151], v[92:95], a[216:219], v[148:151]
    v_lshlrev_b32 v227, 3, v240
    v_min_u32 v227, 1920, v227
    s_lshl2_add_u32 s25, s2, s3
    v_mfma_f32_16x16x32_bf16 v[152:155], v[80:83], a[204:207], v[152:155]
    s_lshl_b32 s25, s25, 13
    s_add_u32 s25, s25, 6144
    buffer_load_dword v241, v227, s[12:15], s25 offen
    v_mfma_f32_16x16x32_bf16 v[152:155], v[84:87], a[220:223], v[152:155]
    v_mfma_f32_16x16x32_bf16 v[156:159], v[88:91], a[204:207], v[156:159]
    buffer_load_dword v254, off, s[88:91], s97 sc1
    v_mfma_f32_16x16x32_bf16 v[156:159], v[92:95], a[220:223], v[156:159]
    s_waitcnt vmcnt(9) lgkmcnt(0)
    v_mfma_f32_16x16x32_bf16 v[160:163], v[64:67], a[192:195], v[160:163]
    ds_read_b128 v[80:83], v224 offset:45056
    v_mfma_f32_16x16x32_bf16 v[160:163], v[68:71], a[208:211], v[160:163]
    ds_read_b128 v[84:87], v225 offset:45056
    s_mul_i32 s38, s2, 100
    v_mfma_f32_16x16x32_bf16 v[164:167], v[72:75], a[192:195], v[164:167]
    ds_read_b128 v[88:91], v224 offset:47104
    v_mfma_f32_16x16x32_bf16 v[164:167], v[76:79], a[208:211], v[164:167]
    ds_read_b128 v[92:95], v225 offset:47104
    v_lshl_add_u32 v60, v253, 2, s38
    v_mfma_f32_16x16x32_bf16 v[168:171], v[64:67], a[196:199], v[168:171]
    ds_read_b64_tr_b16 a[224:225], v228 offset:8192
    v_mfma_f32_16x16x32_bf16 v[168:171], v[68:71], a[212:215], v[168:171]
    ds_read_b64_tr_b16 a[226:227], v228 offset:8704
    v_cmp_gt_u32 vcc, 25, v253
    v_mfma_f32_16x16x32_bf16 v[172:175], v[72:75], a[196:199], v[172:175]
    ds_read_b64_tr_b16 a[228:229], v229 offset:8192
    v_mfma_f32_16x16x32_bf16 v[172:175], v[76:79], a[212:215], v[172:175]
    ds_read_b64_tr_b16 a[230:231], v229 offset:8704
    v_mov_b32_e64 v61, 0
    v_mfma_f32_16x16x32_bf16 v[176:179], v[64:67], a[200:203], v[176:179]
    ds_read_b64_tr_b16 a[232:233], v230 offset:8192
    v_mfma_f32_16x16x32_bf16 v[176:179], v[68:71], a[216:219], v[176:179]
    ds_read_b64_tr_b16 a[234:235], v230 offset:8704
    v_mfma_f32_16x16x32_bf16 v[180:183], v[72:75], a[200:203], v[180:183]
    ds_read_b64_tr_b16 a[236:237], v231 offset:8192
    v_mov_b32 v62, 0x7ffffff0
    v_mfma_f32_16x16x32_bf16 v[180:183], v[76:79], a[216:219], v[180:183]
    ds_read_b64_tr_b16 a[238:239], v231 offset:8704
    v_mfma_f32_16x16x32_bf16 v[184:187], v[64:67], a[204:207], v[184:187]
    v_cndmask_b32 v60, v62, v60, vcc
    v_mfma_f32_16x16x32_bf16 v[184:187], v[68:71], a[220:223], v[184:187]
    buffer_store_dword v61, v60, s[56:59], 0 offen sc1
    v_mfma_f32_16x16x32_bf16 v[188:191], v[72:75], a[204:207], v[188:191]
    v_mfma_f32_16x16x32_bf16 v[188:191], v[76:79], a[220:223], v[188:191]
    s_waitcnt vmcnt(21) lgkmcnt(0)
    s_barrier
    v_mfma_f32_16x16x32_bf16 v[192:195], v[80:83], a[192:195], v[192:195]
    ds_read_b128 v[64:67], v224 offset:49152
    v_mfma_f32_16x16x32_bf16 v[192:195], v[84:87], a[208:211], v[192:195]
    ds_read_b128 v[68:71], v225 offset:49152
    v_mfma_f32_16x16x32_bf16 v[196:199], v[88:91], a[192:195], v[196:199]
    ds_read_b128 v[72:75], v224 offset:51200
    v_mfma_f32_16x16x32_bf16 v[196:199], v[92:95], a[208:211], v[196:199]
    ds_read_b128 v[76:79], v225 offset:51200
    v_mfma_f32_16x16x32_bf16 v[200:203], v[80:83], a[196:199], v[200:203]
    ds_read_b64_tr_b16 a[240:241], v228 offset:12288
    v_mfma_f32_16x16x32_bf16 v[200:203], v[84:87], a[212:215], v[200:203]
    ds_read_b64_tr_b16 a[242:243], v228 offset:12800
    v_mfma_f32_16x16x32_bf16 v[204:207], v[88:91], a[196:199], v[204:207]
    ds_read_b64_tr_b16 a[244:245], v229 offset:12288
    v_mfma_f32_16x16x32_bf16 v[204:207], v[92:95], a[212:215], v[204:207]
    ds_read_b64_tr_b16 a[246:247], v229 offset:12800
    v_mfma_f32_16x16x32_bf16 v[208:211], v[80:83], a[200:203], v[208:211]
    ds_read_b64_tr_b16 a[248:249], v230 offset:12288
    v_lshlrev_b32 v237, 4, v253
    v_add_u32 v237, 81920, v237
    ds_read_b128 v[16:19], v237 offset:0
    ds_read_b128 v[20:23], v237 offset:4096
    ds_read_b128 v[24:27], v237 offset:24576
    ds_read_b128 v[28:31], v237 offset:28672
    s_add_u32 m0, s34, 32768
    s_add_u32 s37, s84, 131072
    buffer_load_dwordx4 v232, s[44:47], s37 offen lds
    v_mfma_f32_16x16x32_bf16 v[208:211], v[84:87], a[216:219], v[208:211]
    ds_read_b64_tr_b16 a[250:251], v230 offset:12800
    v_mfma_f32_16x16x32_bf16 v[212:215], v[88:91], a[200:203], v[212:215]
    ds_read_b64_tr_b16 a[252:253], v231 offset:12288
    v_mfma_f32_16x16x32_bf16 v[212:215], v[92:95], a[216:219], v[212:215]
    ds_read_b64_tr_b16 a[254:255], v231 offset:12800
    v_mfma_f32_16x16x32_bf16 v[216:219], v[80:83], a[204:207], v[216:219]
    buffer_load_dwordx4 v233, s[44:47], s37 offen offset:1024 lds
    v_mfma_f32_16x16x32_bf16 v[216:219], v[84:87], a[220:223], v[216:219]
    v_mfma_f32_16x16x32_bf16 v[220:223], v[88:91], a[204:207], v[220:223]
    v_mfma_f32_16x16x32_bf16 v[220:223], v[92:95], a[220:223], v[220:223]
    s_waitcnt lgkmcnt(0)
    v_mfma_f32_16x16x32_bf16 v[96:99], v[64:67], a[224:227], v[96:99]
    ds_read_b128 v[80:83], v224 offset:53248
    v_mfma_f32_16x16x32_bf16 v[96:99], v[68:71], a[240:243], v[96:99]
    ds_read_b128 v[84:87], v225 offset:53248
    v_mfma_f32_16x16x32_bf16 v[100:103], v[72:75], a[224:227], v[100:103]
    ds_read_b128 v[88:91], v224 offset:55296
    v_mfma_f32_16x16x32_bf16 v[100:103], v[76:79], a[240:243], v[100:103]
    ds_read_b128 v[92:95], v225 offset:55296
    v_mfma_f32_16x16x32_bf16 v[104:107], v[64:67], a[228:231], v[104:107]
    v_mfma_f32_16x16x32_bf16 v[104:107], v[68:71], a[244:247], v[104:107]
    s_mov_b32 s39, 0
    buffer_store_dwordx4 v[16:19], v238, s[8:11], s39 offen sc1
    v_mfma_f32_16x16x32_bf16 v[108:111], v[72:75], a[228:231], v[108:111]
    v_mfma_f32_16x16x32_bf16 v[108:111], v[76:79], a[244:247], v[108:111]
    v_mfma_f32_16x16x32_bf16 v[112:115], v[64:67], a[232:235], v[112:115]
    v_mfma_f32_16x16x32_bf16 v[112:115], v[68:71], a[248:251], v[112:115]
    v_mfma_f32_16x16x32_bf16 v[116:119], v[72:75], a[232:235], v[116:119]
    v_mfma_f32_16x16x32_bf16 v[116:119], v[76:79], a[248:251], v[116:119]
    v_mfma_f32_16x16x32_bf16 v[120:123], v[64:67], a[236:239], v[120:123]
    v_mfma_f32_16x16x32_bf16 v[120:123], v[68:71], a[252:255], v[120:123]
    s_mov_b32 s39, 8192
    buffer_store_dwordx4 v[20:23], v238, s[8:11], s39 offen sc1
    v_mfma_f32_16x16x32_bf16 v[124:127], v[72:75], a[236:239], v[124:127]
    v_mfma_f32_16x16x32_bf16 v[124:127], v[76:79], a[252:255], v[124:127]
    s_waitcnt lgkmcnt(0)
    v_mfma_f32_16x16x32_bf16 v[128:131], v[80:83], a[224:227], v[128:131]
    ds_read_b128 v[64:67], v224 offset:57344
    v_mfma_f32_16x16x32_bf16 v[128:131], v[84:87], a[240:243], v[128:131]
    ds_read_b128 v[68:71], v225 offset:57344
    v_mfma_f32_16x16x32_bf16 v[132:135], v[88:91], a[224:227], v[132:135]
    ds_read_b128 v[72:75], v224 offset:59392
    v_mfma_f32_16x16x32_bf16 v[132:135], v[92:95], a[240:243], v[132:135]
    ds_read_b128 v[76:79], v225 offset:59392
    v_mfma_f32_16x16x32_bf16 v[136:139], v[80:83], a[228:231], v[136:139]
    v_mfma_f32_16x16x32_bf16 v[136:139], v[84:87], a[244:247], v[136:139]
    s_mov_b32 s39, 16384
    buffer_store_dwordx4 v[24:27], v238, s[8:11], s39 offen sc1
    v_mfma_f32_16x16x32_bf16 v[140:143], v[88:91], a[228:231], v[140:143]
    v_mfma_f32_16x16x32_bf16 v[140:143], v[92:95], a[244:247], v[140:143]
    v_mfma_f32_16x16x32_bf16 v[144:147], v[80:83], a[232:235], v[144:147]
    s_add_u32 m0, s34, 40960
    s_add_u32 s37, s85, 131072
    buffer_load_dwordx4 v232, s[44:47], s37 offen lds
    v_mfma_f32_16x16x32_bf16 v[144:147], v[84:87], a[248:251], v[144:147]
    v_mfma_f32_16x16x32_bf16 v[148:151], v[88:91], a[232:235], v[148:151]
    v_mfma_f32_16x16x32_bf16 v[148:151], v[92:95], a[248:251], v[148:151]
    v_mfma_f32_16x16x32_bf16 v[152:155], v[80:83], a[236:239], v[152:155]
    buffer_load_dwordx4 v233, s[44:47], s37 offen offset:1024 lds
    v_mfma_f32_16x16x32_bf16 v[152:155], v[84:87], a[252:255], v[152:155]
    s_mov_b32 s39, 24576
    buffer_store_dwordx4 v[28:31], v238, s[8:11], s39 offen sc1
    v_mfma_f32_16x16x32_bf16 v[156:159], v[88:91], a[236:239], v[156:159]
    v_mfma_f32_16x16x32_bf16 v[156:159], v[92:95], a[252:255], v[156:159]
    s_waitcnt lgkmcnt(0)
    v_mfma_f32_16x16x32_bf16 v[160:163], v[64:67], a[224:227], v[160:163]
    ds_read_b128 v[80:83], v224 offset:61440
    v_mfma_f32_16x16x32_bf16 v[160:163], v[68:71], a[240:243], v[160:163]
    ds_read_b128 v[84:87], v225 offset:61440
    v_mfma_f32_16x16x32_bf16 v[164:167], v[72:75], a[224:227], v[164:167]
    ds_read_b128 v[88:91], v224 offset:63488
    v_mfma_f32_16x16x32_bf16 v[164:167], v[76:79], a[240:243], v[164:167]
    ds_read_b128 v[92:95], v225 offset:63488
    v_mfma_f32_16x16x32_bf16 v[168:171], v[64:67], a[228:231], v[168:171]
    v_mfma_f32_16x16x32_bf16 v[168:171], v[68:71], a[244:247], v[168:171]
    v_mfma_f32_16x16x32_bf16 v[172:175], v[72:75], a[228:231], v[172:175]
    v_mfma_f32_16x16x32_bf16 v[172:175], v[76:79], a[244:247], v[172:175]
    v_mfma_f32_16x16x32_bf16 v[176:179], v[64:67], a[232:235], v[176:179]
    v_mfma_f32_16x16x32_bf16 v[176:179], v[68:71], a[248:251], v[176:179]
    v_cvt_pk_bf16_f32 v0, v96, v97
    v_cvt_pk_bf16_f32 v1, v98, v99
    v_mfma_f32_16x16x32_bf16 v[180:183], v[72:75], a[232:235], v[180:183]
    v_cvt_pk_bf16_f32 v2, v100, v101
    v_cvt_pk_bf16_f32 v3, v102, v103
    v_mfma_f32_16x16x32_bf16 v[180:183], v[76:79], a[248:251], v[180:183]
    v_cvt_pk_bf16_f32 v4, v104, v105
    v_cvt_pk_bf16_f32 v5, v106, v107
    v_mfma_f32_16x16x32_bf16 v[184:187], v[64:67], a[236:239], v[184:187]
    v_cvt_pk_bf16_f32 v6, v108, v109
    v_cvt_pk_bf16_f32 v7, v110, v111
    v_mfma_f32_16x16x32_bf16 v[184:187], v[68:71], a[252:255], v[184:187]
    v_cvt_pk_bf16_f32 v8, v112, v113
    v_cvt_pk_bf16_f32 v9, v114, v115
    v_mfma_f32_16x16x32_bf16 v[188:191], v[72:75], a[236:239], v[188:191]
    v_cvt_pk_bf16_f32 v10, v116, v117
    v_cvt_pk_bf16_f32 v11, v118, v119
    v_mfma_f32_16x16x32_bf16 v[188:191], v[76:79], a[252:255], v[188:191]
    v_cvt_pk_bf16_f32 v12, v120, v121
    v_cvt_pk_bf16_f32 v13, v122, v123
    s_waitcnt vmcnt(16) lgkmcnt(0)
    s_barrier
    v_mfma_f32_16x16x32_bf16 v[192:195], v[80:83], a[224:227], v[192:195]
    ds_read_b128 v[64:67], v224 offset:0
    v_cvt_pk_bf16_f32 v14, v124, v125
    v_cvt_pk_bf16_f32 v15, v126, v127
    v_mfma_f32_16x16x32_bf16 v[192:195], v[84:87], a[240:243], v[192:195]
    ds_read_b128 v[68:71], v225 offset:0
    v_cvt_pk_bf16_f32 v16, v128, v129
    v_cvt_pk_bf16_f32 v17, v130, v131
    v_mfma_f32_16x16x32_bf16 v[196:199], v[88:91], a[224:227], v[196:199]
    ds_read_b128 v[72:75], v224 offset:8192
    v_cvt_pk_bf16_f32 v18, v132, v133
    v_cvt_pk_bf16_f32 v19, v134, v135
    v_mfma_f32_16x16x32_bf16 v[196:199], v[92:95], a[240:243], v[196:199]
    ds_read_b128 v[76:79], v225 offset:8192
    v_cvt_pk_bf16_f32 v20, v136, v137
    v_cvt_pk_bf16_f32 v21, v138, v139
    v_mfma_f32_16x16x32_bf16 v[200:203], v[80:83], a[228:231], v[200:203]
    v_cvt_pk_bf16_f32 v22, v140, v141
    v_cvt_pk_bf16_f32 v23, v142, v143
    v_mfma_f32_16x16x32_bf16 v[200:203], v[84:87], a[244:247], v[200:203]
    v_cvt_pk_bf16_f32 v24, v144, v145
    v_cvt_pk_bf16_f32 v25, v146, v147
    v_mfma_f32_16x16x32_bf16 v[204:207], v[88:91], a[228:231], v[204:207]
    v_cvt_pk_bf16_f32 v26, v148, v149
    v_cvt_pk_bf16_f32 v27, v150, v151
    v_mfma_f32_16x16x32_bf16 v[204:207], v[92:95], a[244:247], v[204:207]
    v_cvt_pk_bf16_f32 v28, v152, v153
    v_cvt_pk_bf16_f32 v29, v154, v155
    v_mfma_f32_16x16x32_bf16 v[208:211], v[80:83], a[232:235], v[208:211]
    s_add_u32 m0, s34, 49152
    s_add_u32 s37, s86, 131072
    buffer_load_dwordx4 v232, s[44:47], s37 offen lds
    v_cvt_pk_bf16_f32 v30, v156, v157
    v_cvt_pk_bf16_f32 v31, v158, v159
    v_mfma_f32_16x16x32_bf16 v[208:211], v[84:87], a[248:251], v[208:211]
    v_cvt_pk_bf16_f32 v32, v160, v161
    v_cvt_pk_bf16_f32 v33, v162, v163
    v_mfma_f32_16x16x32_bf16 v[212:215], v[88:91], a[232:235], v[212:215]
    v_cvt_pk_bf16_f32 v34, v164, v165
    v_cvt_pk_bf16_f32 v35, v166, v167
    v_mfma_f32_16x16x32_bf16 v[212:215], v[92:95], a[248:251], v[212:215]
    v_cvt_pk_bf16_f32 v36, v168, v169
    v_cvt_pk_bf16_f32 v37, v170, v171
    v_mfma_f32_16x16x32_bf16 v[216:219], v[80:83], a[236:239], v[216:219]
    buffer_load_dwordx4 v233, s[44:47], s37 offen offset:1024 lds
    v_cvt_pk_bf16_f32 v38, v172, v173
    v_cvt_pk_bf16_f32 v39, v174, v175
    v_mfma_f32_16x16x32_bf16 v[216:219], v[84:87], a[252:255], v[216:219]
    v_cvt_pk_bf16_f32 v40, v176, v177
    v_cvt_pk_bf16_f32 v41, v178, v179
    v_mfma_f32_16x16x32_bf16 v[220:223], v[88:91], a[236:239], v[220:223]
    v_cvt_pk_bf16_f32 v42, v180, v181
    v_cvt_pk_bf16_f32 v43, v182, v183
    v_mfma_f32_16x16x32_bf16 v[220:223], v[92:95], a[252:255], v[220:223]
    v_cvt_pk_bf16_f32 v44, v184, v185
    v_cvt_pk_bf16_f32 v45, v186, v187
    s_waitcnt lgkmcnt(0)
    v_mfma_f32_16x16x32_bf16 v[96:99], v[64:67], a[0:3], 0
    ds_read_b128 v[80:83], v224 offset:2048
    v_cvt_pk_bf16_f32 v46, v188, v189
    v_cvt_pk_bf16_f32 v47, v190, v191
    v_mfma_f32_16x16x32_bf16 v[96:99], v[68:71], a[16:19], v[96:99]
    ds_read_b128 v[84:87], v225 offset:2048
    v_cvt_pk_bf16_f32 v48, v192, v193
    v_cvt_pk_bf16_f32 v49, v194, v195
    v_mfma_f32_16x16x32_bf16 v[96:99], v[72:75], a[32:35], v[96:99]
    ds_read_b128 v[88:91], v224 offset:10240
    v_cvt_pk_bf16_f32 v50, v196, v197
    v_cvt_pk_bf16_f32 v51, v198, v199
    v_mfma_f32_16x16x32_bf16 v[96:99], v[76:79], a[48:51], v[96:99]
    ds_read_b128 v[92:95], v225 offset:10240
    v_cvt_pk_bf16_f32 v52, v200, v201
    v_cvt_pk_bf16_f32 v53, v202, v203
    v_mfma_f32_16x16x32_bf16 v[104:107], v[64:67], a[4:7], 0
    v_cvt_pk_bf16_f32 v54, v204, v205
    v_cvt_pk_bf16_f32 v55, v206, v207
    s_add_u32 s38, s36, 0
    buffer_store_dwordx4 v[0:3], v240, s[16:19], s38 offen offset:0 sc1
    v_mfma_f32_16x16x32_bf16 v[104:107], v[68:71], a[20:23], v[104:107]
    v_cvt_pk_bf16_f32 v56, v208, v209
    v_cvt_pk_bf16_f32 v57, v210, v211
    v_mfma_f32_16x16x32_bf16 v[104:107], v[72:75], a[36:39], v[104:107]
    v_cvt_pk_bf16_f32 v58, v212, v213
    v_cvt_pk_bf16_f32 v59, v214, v215
    v_mfma_f32_16x16x32_bf16 v[104:107], v[76:79], a[52:55], v[104:107]
    v_cvt_pk_bf16_f32 v60, v216, v217
    v_cvt_pk_bf16_f32 v61, v218, v219
    v_mfma_f32_16x16x32_bf16 v[112:115], v[64:67], a[8:11], 0
    v_xor_b32 v237, 16, v245
    v_xor_b32 v238, 16, v246
    v_cvt_pk_bf16_f32 v62, v220, v221
    v_cvt_pk_bf16_f32 v63, v222, v223
    v_mfma_f32_16x16x32_bf16 v[112:115], v[68:71], a[24:27], v[112:115]
    v_mfma_f32_16x16x32_bf16 v[112:115], v[72:75], a[40:43], v[112:115]
    v_mfma_f32_16x16x32_bf16 v[112:115], v[76:79], a[56:59], v[112:115]
    v_mfma_f32_16x16x32_bf16 v[120:123], v[64:67], a[12:15], 0
    v_mfma_f32_16x16x32_bf16 v[120:123], v[68:71], a[28:31], v[120:123]
    v_mfma_f32_16x16x32_bf16 v[120:123], v[72:75], a[44:47], v[120:123]
    v_mfma_f32_16x16x32_bf16 v[120:123], v[76:79], a[60:63], v[120:123]
    s_waitcnt lgkmcnt(0)
    v_mfma_f32_16x16x32_bf16 v[100:103], v[80:83], a[0:3], 0
    ds_read_b128 v[64:67], v224 offset:4096
    v_mfma_f32_16x16x32_bf16 v[100:103], v[84:87], a[16:19], v[100:103]
    ds_read_b128 v[68:71], v225 offset:4096
    v_mfma_f32_16x16x32_bf16 v[100:103], v[88:91], a[32:35], v[100:103]
    ds_read_b128 v[72:75], v224 offset:12288
    v_mfma_f32_16x16x32_bf16 v[100:103], v[92:95], a[48:51], v[100:103]
    ds_read_b128 v[76:79], v225 offset:12288
    v_mfma_f32_16x16x32_bf16 v[108:111], v[80:83], a[4:7], 0
    v_mfma_f32_16x16x32_bf16 v[108:111], v[84:87], a[20:23], v[108:111]
    v_mfma_f32_16x16x32_bf16 v[108:111], v[88:91], a[36:39], v[108:111]
    v_mfma_f32_16x16x32_bf16 v[108:111], v[92:95], a[52:55], v[108:111]
    v_mfma_f32_16x16x32_bf16 v[116:119], v[80:83], a[8:11], 0
    s_add_u32 m0, s34, 57344
    s_add_u32 s37, s87, 131072
    buffer_load_dwordx4 v232, s[44:47], s37 offen lds
    v_mfma_f32_16x16x32_bf16 v[116:119], v[84:87], a[24:27], v[116:119]
    s_add_u32 s38, s36, 0
    buffer_store_dwordx4 v[4:7], v240, s[16:19], s38 offen offset:1024 sc1
    v_mfma_f32_16x16x32_bf16 v[116:119], v[88:91], a[40:43], v[116:119]
    v_mfma_f32_16x16x32_bf16 v[116:119], v[92:95], a[56:59], v[116:119]
    v_mfma_f32_16x16x32_bf16 v[124:127], v[80:83], a[12:15], 0
    buffer_load_dwordx4 v233, s[44:47], s37 offen offset:1024 lds
    v_mfma_f32_16x16x32_bf16 v[124:127], v[84:87], a[28:31], v[124:127]
    v_mfma_f32_16x16x32_bf16 v[124:127], v[88:91], a[44:47], v[124:127]
    v_mfma_f32_16x16x32_bf16 v[124:127], v[92:95], a[60:63], v[124:127]
    s_waitcnt lgkmcnt(0)
    v_mfma_f32_16x16x32_bf16 v[128:131], v[64:67], a[0:3], 0
    ds_read_b128 v[80:83], v224 offset:6144
    v_mfma_f32_16x16x32_bf16 v[128:131], v[68:71], a[16:19], v[128:131]
    ds_read_b128 v[84:87], v225 offset:6144
    v_mfma_f32_16x16x32_bf16 v[128:131], v[72:75], a[32:35], v[128:131]
    ds_read_b128 v[88:91], v224 offset:14336
    v_mfma_f32_16x16x32_bf16 v[128:131], v[76:79], a[48:51], v[128:131]
    ds_read_b128 v[92:95], v225 offset:14336
    v_mfma_f32_16x16x32_bf16 v[136:139], v[64:67], a[4:7], 0
    v_mfma_f32_16x16x32_bf16 v[136:139], v[68:71], a[20:23], v[136:139]
    v_mfma_f32_16x16x32_bf16 v[136:139], v[72:75], a[36:39], v[136:139]
    v_mfma_f32_16x16x32_bf16 v[136:139], v[76:79], a[52:55], v[136:139]
    v_mfma_f32_16x16x32_bf16 v[144:147], v[64:67], a[8:11], 0
    s_waitcnt vmcnt(15)
    v_readfirstlane_b32 s24, v254
    s_lshl_b32 s25, s3, 16
    s_add_u32 s24, s24, s25
    s_cmp_ge_u32 s24, 1
    s_cbranch_scc0 kf_spin51
kf_spinr52:
    v_mfma_f32_16x16x32_bf16 v[144:147], v[68:71], a[24:27], v[144:147]
    v_mfma_f32_16x16x32_bf16 v[144:147], v[72:75], a[40:43], v[144:147]
    v_mfma_f32_16x16x32_bf16 v[144:147], v[76:79], a[56:59], v[144:147]
    v_mfma_f32_16x16x32_bf16 v[152:155], v[64:67], a[12:15], 0
    s_add_u32 s88, s20, 0x14a0000
    s_addc_u32 s89, s21, 0
    s_mov_b32 s90, 20480
    v_mfma_f32_16x16x32_bf16 v[152:155], v[68:71], a[28:31], v[152:155]
    v_mfma_f32_16x16x32_bf16 v[152:155], v[72:75], a[44:47], v[152:155]
    v_mfma_f32_16x16x32_bf16 v[152:155], v[76:79], a[60:63], v[152:155]
    s_add_u32 s38, s36, 0
    buffer_store_dwordx4 v[8:11], v240, s[16:19], s38 offen offset:2048 sc1
    s_waitcnt vmcnt(7) lgkmcnt(0)
    s_barrier
    v_mfma_f32_16x16x32_bf16 v[132:135], v[80:83], a[0:3], 0
    ds_read_b128 v[64:67], v224 offset:16384
    v_mfma_f32_16x16x32_bf16 v[132:135], v[84:87], a[16:19], v[132:135]
    ds_read_b128 v[68:71], v225 offset:16384
    v_mfma_f32_16x16x32_bf16 v[132:135], v[88:91], a[32:35], v[132:135]
    ds_read_b128 v[72:75], v224 offset:24576
    v_mfma_f32_16x16x32_bf16 v[132:135], v[92:95], a[48:51], v[132:135]
    ds_read_b128 v[76:79], v225 offset:24576
    v_mfma_f32_16x16x32_bf16 v[140:143], v[80:83], a[4:7], 0
    v_mfma_f32_16x16x32_bf16 v[140:143], v[84:87], a[20:23], v[140:143]
    v_mfma_f32_16x16x32_bf16 v[140:143], v[88:91], a[36:39], v[140:143]
    v_mfma_f32_16x16x32_bf16 v[140:143], v[92:95], a[52:55], v[140:143]
    v_mfma_f32_16x16x32_bf16 v[148:151], v[80:83], a[8:11], 0
    s_add_u32 m0, s34, 0
    s_add_u32 s37, s80, 196608
    buffer_load_dwordx4 v232, s[44:47], s37 offen lds
    v_mfma_f32_16x16x32_bf16 v[148:151], v[84:87], a[24:27], v[148:151]
    v_mfma_f32_16x16x32_bf16 v[148:151], v[88:91], a[40:43], v[148:151]
    buffer_load_dwordx4 v233, s[44:47], s37 offen offset:1024 lds
    v_mfma_f32_16x16x32_bf16 v[148:151], v[92:95], a[56:59], v[148:151]
    v_mfma_f32_16x16x32_bf16 v[156:159], v[80:83], a[12:15], 0
    v_mfma_f32_16x16x32_bf16 v[156:159], v[84:87], a[28:31], v[156:159]
    s_lshl_b32 s39, s5, 7
    s_add_u32 s39, s39, 8192
    buffer_atomic_add v255, v250, s[88:91], s39 offen sc1
    s_cmp_eq_u32 s3, 0
    s_cselect_b32 s39, s39, s43
    v_mfma_f32_16x16x32_bf16 v[156:159], v[88:91], a[44:47], v[156:159]
    v_mfma_f32_16x16x32_bf16 v[156:159], v[92:95], a[60:63], v[156:159]
    s_waitcnt lgkmcnt(0)
    v_mfma_f32_16x16x32_bf16 v[96:99], v[64:67], a[64:67], v[96:99]
    ds_read_b128 v[80:83], v224 offset:18432
    v_mfma_f32_16x16x32_bf16 v[96:99], v[68:71], a[80:83], v[96:99]
    ds_read_b128 v[84:87], v225 offset:18432
    v_mfma_f32_16x16x32_bf16 v[96:99], v[72:75], a[96:99], v[96:99]
    ds_read_b128 v[88:91], v224 offset:26624
    v_mfma_f32_16x16x32_bf16 v[96:99], v[76:79], a[112:115], v[96:99]
    ds_read_b128 v[92:95], v225 offset:26624
    v_mfma_f32_16x16x32_bf16 v[104:107], v[64:67], a[68:71], v[104:107]
    s_add_u32 s38, s36, 0
    buffer_store_dwordx4 v[12:15], v240, s[16:19], s38 offen offset:3072 sc1
    v_mfma_f32_16x16x32_bf16 v[104:107], v[68:71], a[84:87], v[104:107]
    v_mfma_f32_16x16x32_bf16 v[104:107], v[72:75], a[100:103], v[104:107]
    v_mfma_f32_16x16x32_bf16 v[104:107], v[76:79], a[116:119], v[104:107]
    v_mfma_f32_16x16x32_bf16 v[112:115], v[64:67], a[72:75], v[112:115]
    s_add_u32 m0, s31, 0
    s_add_u32 s24, s27, 0
    buffer_load_dwordx4 v245, s[12:15], s24 offen lds
    v_mfma_f32_16x16x32_bf16 v[112:115], v[68:71], a[88:91], v[112:115]
    v_mfma_f32_16x16x32_bf16 v[112:115], v[72:75], a[104:107], v[112:115]
    v_mfma_f32_16x16x32_bf16 v[112:115], v[76:79], a[120:123], v[112:115]
    v_mfma_f32_16x16x32_bf16 v[120:123], v[64:67], a[76:79], v[120:123]
    v_mfma_f32_16x16x32_bf16 v[120:123], v[68:71], a[92:95], v[120:123]
    v_mfma_f32_16x16x32_bf16 v[120:123], v[72:75], a[108:111], v[120:123]
    v_mfma_f32_16x16x32_bf16 v[120:123], v[76:79], a[124:127], v[120:123]
    s_waitcnt lgkmcnt(0)
    v_mfma_f32_16x16x32_bf16 v[100:103], v[80:83], a[64:67], v[100:103]
    ds_read_b128 v[64:67], v224 offset:20480
    v_mfma_f32_16x16x32_bf16 v[100:103], v[84:87], a[80:83], v[100:103]
    ds_read_b128 v[68:71], v225 offset:20480
    v_mfma_f32_16x16x32_bf16 v[100:103], v[88:91], a[96:99], v[100:103]
    ds_read_b128 v[72:75], v224 offset:28672
    v_mfma_f32_16x16x32_bf16 v[100:103], v[92:95], a[112:115], v[100:103]
    ds_read_b128 v[76:79], v225 offset:28672
    v_mfma_f32_16x16x32_bf16 v[108:111], v[80:83], a[68:71], v[108:111]
    v_mfma_f32_16x16x32_bf16 v[108:111], v[84:87], a[84:87], v[108:111]
    v_mfma_f32_16x16x32_bf16 v[108:111], v[88:91], a[100:103], v[108:111]
    v_mfma_f32_16x16x32_bf16 v[108:111], v[92:95], a[116:119], v[108:111]
    v_mfma_f32_16x16x32_bf16 v[116:119], v[80:83], a[72:75], v[116:119]
    s_add_u32 m0, s34, 8192
    s_add_u32 s37, s81, 196608
    buffer_load_dwordx4 v232, s[44:47], s37 offen lds
    v_mfma_f32_16x16x32_bf16 v[116:119], v[84:87], a[88:91], v[116:119]
    v_mfma_f32_16x16x32_bf16 v[116:119], v[88:91], a[104:107], v[116:119]
    buffer_load_dwordx4 v233, s[44:47], s37 offen offset:1024 lds
    s_add_u32 s38, s36, 8192
    buffer_store_dwordx4 v[16:19], v240, s[16:19], s38 offen offset:0 sc1
    v_mfma_f32_16x16x32_bf16 v[116:119], v[92:95], a[120:123], v[116:119]
    v_mfma_f32_16x16x32_bf16 v[124:127], v[80:83], a[76:79], v[124:127]
    v_mfma_f32_16x16x32_bf16 v[124:127], v[84:87], a[92:95], v[124:127]
    s_add_u32 m0, s31, 1024
    s_add_u32 s24, s27, 32768
    buffer_load_dwordx4 v245, s[12:15], s24 offen lds
    v_mfma_f32_16x16x32_bf16 v[124:127], v[88:91], a[108:111], v[124:127]
    v_mfma_f32_16x16x32_bf16 v[124:127], v[92:95], a[124:127], v[124:127]
    s_waitcnt lgkmcnt(0)
    v_mfma_f32_16x16x32_bf16 v[128:131], v[64:67], a[64:67], v[128:131]
    ds_read_b128 v[80:83], v224 offset:22528
    v_mfma_f32_16x16x32_bf16 v[128:131], v[68:71], a[80:83], v[128:131]
    ds_read_b128 v[84:87], v225 offset:22528
    v_mfma_f32_16x16x32_bf16 v[128:131], v[72:75], a[96:99], v[128:131]
    ds_read_b128 v[88:91], v224 offset:30720
    v_mfma_f32_16x16x32_bf16 v[128:131], v[76:79], a[112:115], v[128:131]
    ds_read_b128 v[92:95], v225 offset:30720
    v_mfma_f32_16x16x32_bf16 v[136:139], v[64:67], a[68:71], v[136:139]
    v_mfma_f32_16x16x32_bf16 v[136:139], v[68:71], a[84:87], v[136:139]
    v_mfma_f32_16x16x32_bf16 v[136:139], v[72:75], a[100:103], v[136:139]
    v_mfma_f32_16x16x32_bf16 v[136:139], v[76:79], a[116:119], v[136:139]
    v_mfma_f32_16x16x32_bf16 v[144:147], v[64:67], a[72:75], v[144:147]
    s_add_u32 m0, s31, 2048
    s_add_u32 s24, s27, 65536
    buffer_load_dwordx4 v237, s[12:15], s24 offen lds
    v_mfma_f32_16x16x32_bf16 v[144:147], v[68:71], a[88:91], v[144:147]
    v_mfma_f32_16x16x32_bf16 v[144:147], v[72:75], a[104:107], v[144:147]
    v_mfma_f32_16x16x32_bf16 v[144:147], v[76:79], a[120:123], v[144:147]
    v_mfma_f32_16x16x32_bf16 v[152:155], v[64:67], a[76:79], v[152:155]
    v_mfma_f32_16x16x32_bf16 v[152:155], v[68:71], a[92:95], v[152:155]
    v_mfma_f32_16x16x32_bf16 v[152:155], v[72:75], a[108:111], v[152:155]
    v_mfma_f32_16x16x32_bf16 v[152:155], v[76:79], a[124:127], v[152:155]
    s_add_u32 s38, s36, 8192
    buffer_store_dwordx4 v[20:23], v240, s[16:19], s38 offen offset:1024 sc1
    s_waitcnt vmcnt(19) lgkmcnt(0)
    s_barrier
    v_mfma_f32_16x16x32_bf16 v[132:135], v[80:83], a[64:67], v[132:135]
    ds_read_b128 v[64:67], v224 offset:32768
    v_mfma_f32_16x16x32_bf16 v[132:135], v[84:87], a[80:83], v[132:135]
    ds_read_b128 v[68:71], v225 offset:32768
    v_mfma_f32_16x16x32_bf16 v[132:135], v[88:91], a[96:99], v[132:135]
    ds_read_b128 v[72:75], v224 offset:40960
    v_mfma_f32_16x16x32_bf16 v[132:135], v[92:95], a[112:115], v[132:135]
    ds_read_b128 v[76:79], v225 offset:40960
    v_mfma_f32_16x16x32_bf16 v[140:143], v[80:83], a[68:71], v[140:143]
    v_mfma_f32_16x16x32_bf16 v[140:143], v[84:87], a[84:87], v[140:143]
    v_mfma_f32_16x16x32_bf16 v[140:143], v[88:91], a[100:103], v[140:143]
    v_mfma_f32_16x16x32_bf16 v[140:143], v[92:95], a[116:119], v[140:143]
    v_mfma_f32_16x16x32_bf16 v[148:151], v[80:83], a[72:75], v[148:151]
    s_add_u32 m0, s34, 16384
    s_add_u32 s37, s82, 196608
    buffer_load_dwordx4 v232, s[44:47], s37 offen lds
    v_mfma_f32_16x16x32_bf16 v[148:151], v[84:87], a[88:91], v[148:151]
    v_mfma_f32_16x16x32_bf16 v[148:151], v[88:91], a[104:107], v[148:151]
    buffer_load_dwordx4 v233, s[44:47], s37 offen offset:1024 lds
    v_mfma_f32_16x16x32_bf16 v[148:151], v[92:95], a[120:123], v[148:151]
    v_mfma_f32_16x16x32_bf16 v[156:159], v[80:83], a[76:79], v[156:159]
    v_mfma_f32_16x16x32_bf16 v[156:159], v[84:87], a[92:95], v[156:159]
    s_add_u32 m0, s31, 3072
    s_add_u32 s24, s27, 98304
    buffer_load_dwordx4 v237, s[12:15], s24 offen lds
    v_mfma_f32_16x16x32_bf16 v[156:159], v[88:91], a[108:111], v[156:159]
    v_mfma_f32_16x16x32_bf16 v[156:159], v[92:95], a[124:127], v[156:159]
    s_waitcnt lgkmcnt(0)
    v_mfma_f32_16x16x32_bf16 v[96:99], v[64:67], a[128:131], v[96:99]
    ds_read_b128 v[80:83], v224 offset:34816
    v_mfma_f32_16x16x32_bf16 v[96:99], v[68:71], a[144:147], v[96:99]
    ds_read_b128 v[84:87], v225 offset:34816
    v_mfma_f32_16x16x32_bf16 v[96:99], v[72:75], a[160:163], v[96:99]
    ds_read_b128 v[88:91], v224 offset:43008
    v_mfma_f32_16x16x32_bf16 v[96:99], v[76:79], a[176:179], v[96:99]
    ds_read_b128 v[92:95], v225 offset:43008
    v_mfma_f32_16x16x32_bf16 v[104:107], v[64:67], a[132:135], v[104:107]
    v_mfma_f32_16x16x32_bf16 v[104:107], v[68:71], a[148:151], v[104:107]
    s_add_u32 s38, s36, 8192
    buffer_store_dwordx4 v[24:27], v240, s[16:19], s38 offen offset:2048 sc1
    v_mfma_f32_16x16x32_bf16 v[104:107], v[72:75], a[164:167], v[104:107]
    v_mfma_f32_16x16x32_bf16 v[104:107], v[76:79], a[180:183], v[104:107]
    v_mfma_f32_16x16x32_bf16 v[112:115], v[64:67], a[136:139], v[112:115]
    s_add_u32 m0, s31, 4096
    s_add_u32 s24, s27, 131072
    buffer_load_dwordx4 v245, s[12:15], s24 offen lds
    v_mfma_f32_16x16x32_bf16 v[112:115], v[68:71], a[152:155], v[112:115]
    v_mfma_f32_16x16x32_bf16 v[112:115], v[72:75], a[168:171], v[112:115]
    v_mfma_f32_16x16x32_bf16 v[112:115], v[76:79], a[184:187], v[112:115]
    v_mfma_f32_16x16x32_bf16 v[120:123], v[64:67], a[140:143], v[120:123]
    v_mfma_f32_16x16x32_bf16 v[120:123], v[68:71], a[156:159], v[120:123]
    v_mfma_f32_16x16x32_bf16 v[120:123], v[72:75], a[172:175], v[120:123]
    v_mfma_f32_16x16x32_bf16 v[120:123], v[76:79], a[188:191], v[120:123]
    s_waitcnt lgkmcnt(0)
    v_mfma_f32_16x16x32_bf16 v[100:103], v[80:83], a[128:131], v[100:103]
    ds_read_b128 v[64:67], v224 offset:36864
    v_mfma_f32_16x16x32_bf16 v[100:103], v[84:87], a[144:147], v[100:103]
    ds_read_b128 v[68:71], v225 offset:36864
    v_mfma_f32_16x16x32_bf16 v[100:103], v[88:91], a[160:163], v[100:103]
    ds_read_b128 v[72:75], v224 offset:45056
    v_mfma_f32_16x16x32_bf16 v[100:103], v[92:95], a[176:179], v[100:103]
    ds_read_b128 v[76:79], v225 offset:45056
    v_mfma_f32_16x16x32_bf16 v[108:111], v[80:83], a[132:135], v[108:111]
    v_mfma_f32_16x16x32_bf16 v[108:111], v[84:87], a[148:151], v[108:111]
    v_mfma_f32_16x16x32_bf16 v[108:111], v[88:91], a[164:167], v[108:111]
    v_mfma_f32_16x16x32_bf16 v[108:111], v[92:95], a[180:183], v[108:111]
    v_mfma_f32_16x16x32_bf16 v[116:119], v[80:83], a[136:139], v[116:119]
    s_add_u32 m0, s34, 24576
    s_add_u32 s37, s83, 196608
    buffer_load_dwordx4 v232, s[44:47], s37 offen lds
    v_mfma_f32_16x16x32_bf16 v[116:119], v[84:87], a[152:155], v[116:119]
    v_mfma_f32_16x16x32_bf16 v[116:119], v[88:91], a[168:171], v[116:119]
    buffer_load_dwordx4 v233, s[44:47], s37 offen offset:1024 lds
    s_add_u32 s38, s36, 8192
    buffer_store_dwordx4 v[28:31], v240, s[16:19], s38 offen offset:3072 sc1
    v_mfma_f32_16x16x32_bf16 v[116:119], v[92:95], a[184:187], v[116:119]
    v_mfma_f32_16x16x32_bf16 v[124:127], v[80:83], a[140:143], v[124:127]
    v_mfma_f32_16x16x32_bf16 v[124:127], v[84:87], a[156:159], v[124:127]
    s_add_u32 m0, s31, 5120
    s_add_u32 s24, s27, 163840
    buffer_load_dwordx4 v245, s[12:15], s24 offen lds
    v_mfma_f32_16x16x32_bf16 v[124:127], v[88:91], a[172:175], v[124:127]
    v_mfma_f32_16x16x32_bf16 v[124:127], v[92:95], a[188:191], v[124:127]
    s_waitcnt lgkmcnt(0)
    v_mfma_f32_16x16x32_bf16 v[128:131], v[64:67], a[128:131], v[128:131]
    ds_read_b128 v[80:83], v224 offset:38912
    v_mfma_f32_16x16x32_bf16 v[128:131], v[68:71], a[144:147], v[128:131]
    ds_read_b128 v[84:87], v225 offset:38912
    v_mfma_f32_16x16x32_bf16 v[128:131], v[72:75], a[160:163], v[128:131]
    ds_read_b128 v[88:91], v224 offset:47104
    v_mfma_f32_16x16x32_bf16 v[128:131], v[76:79], a[176:179], v[128:131]
    ds_read_b128 v[92:95], v225 offset:47104
    v_mfma_f32_16x16x32_bf16 v[136:139], v[64:67], a[132:135], v[136:139]
    v_mfma_f32_16x16x32_bf16 v[136:139], v[68:71], a[148:151], v[136:139]
    v_mfma_f32_16x16x32_bf16 v[136:139], v[72:75], a[164:167], v[136:139]
    v_mfma_f32_16x16x32_bf16 v[136:139], v[76:79], a[180:183], v[136:139]
    v_mfma_f32_16x16x32_bf16 v[144:147], v[64:67], a[136:139], v[144:147]
    s_add_u32 m0, s31, 6144
    s_add_u32 s24, s27, 196608
    buffer_load_dwordx4 v237, s[12:15], s24 offen lds
    v_mfma_f32_16x16x32_bf16 v[144:147], v[68:71], a[152:155], v[144:147]
    v_mfma_f32_16x16x32_bf16 v[144:147], v[72:75], a[168:171], v[144:147]
    v_mfma_f32_16x16x32_bf16 v[144:147], v[76:79], a[184:187], v[144:147]
    v_mfma_f32_16x16x32_bf16 v[152:155], v[64:67], a[140:143], v[152:155]
    v_mfma_f32_16x16x32_bf16 v[152:155], v[68:71], a[156:159], v[152:155]
    v_mfma_f32_16x16x32_bf16 v[152:155], v[72:75], a[172:175], v[152:155]
    v_mfma_f32_16x16x32_bf16 v[152:155], v[76:79], a[188:191], v[152:155]
    s_waitcnt vmcnt(22) lgkmcnt(0)
    s_barrier
    v_mfma_f32_16x16x32_bf16 v[132:135], v[80:83], a[128:131], v[132:135]
    ds_read_b128 v[64:67], v224 offset:49152
    s_add_u32 s38, s36, 32768
    buffer_store_dwordx4 v[32:35], v240, s[16:19], s38 offen offset:1280 sc1
    v_mfma_f32_16x16x32_bf16 v[132:135], v[84:87], a[144:147], v[132:135]
    ds_read_b128 v[68:71], v225 offset:49152
    v_mfma_f32_16x16x32_bf16 v[132:135], v[88:91], a[160:163], v[132:135]
    ds_read_b128 v[72:75], v224 offset:57344
    v_mfma_f32_16x16x32_bf16 v[132:135], v[92:95], a[176:179], v[132:135]
    ds_read_b128 v[76:79], v225 offset:57344
    v_mfma_f32_16x16x32_bf16 v[140:143], v[80:83], a[132:135], v[140:143]
    v_mfma_f32_16x16x32_bf16 v[140:143], v[84:87], a[148:151], v[140:143]
    v_mfma_f32_16x16x32_bf16 v[140:143], v[88:91], a[164:167], v[140:143]
    v_mfma_f32_16x16x32_bf16 v[140:143], v[92:95], a[180:183], v[140:143]
    v_mfma_f32_16x16x32_bf16 v[148:151], v[80:83], a[136:139], v[148:151]
    s_add_u32 m0, s34, 32768
    s_add_u32 s37, s84, 196608
    buffer_load_dwordx4 v232, s[44:47], s37 offen lds
    v_mfma_f32_16x16x32_bf16 v[148:151], v[84:87], a[152:155], v[148:151]
    buffer_load_dwordx4 v233, s[44:47], s37 offen offset:1024 lds
    v_mfma_f32_16x16x32_bf16 v[148:151], v[88:91], a[168:171], v[148:151]
    v_mfma_f32_16x16x32_bf16 v[148:151], v[92:95], a[184:187], v[148:151]
    s_add_u32 m0, s31, 7168
    s_add_u32 s24, s27, 229376
    buffer_load_dwordx4 v237, s[12:15], s24 offen lds
    v_mfma_f32_16x16x32_bf16 v[156:159], v[80:83], a[140:143], v[156:159]
    s_add_u32 s27, s27, 1048576
    s_and_b32 s27, s27, 0x407fffff
    s_cmp_eq_u32 s27, s7
    s_cselect_b32 s27, s43, s27
    v_mfma_f32_16x16x32_bf16 v[156:159], v[84:87], a[156:159], v[156:159]
    v_mfma_f32_16x16x32_bf16 v[156:159], v[88:91], a[172:175], v[156:159]
    s_add_u32 s31, s31, 32768
    s_cmp_ge_u32 s31, 163840
    s_cselect_b32 s24, 98304, 0
    s_sub_u32 s31, s31, s24
    v_mfma_f32_16x16x32_bf16 v[156:159], v[92:95], a[188:191], v[156:159]
    s_waitcnt lgkmcnt(0)
    v_mfma_f32_16x16x32_bf16 v[96:99], v[64:67], a[192:195], v[96:99]
    ds_read_b128 v[80:83], v224 offset:51200
    v_mfma_f32_16x16x32_bf16 v[96:99], v[68:71], a[208:211], v[96:99]
    ds_read_b128 v[84:87], v225 offset:51200
    v_mfma_f32_16x16x32_bf16 v[96:99], v[72:75], a[224:227], v[96:99]
    ds_read_b128 v[88:91], v224 offset:59392
    v_mfma_f32_16x16x32_bf16 v[96:99], v[76:79], a[240:243], v[96:99]
    ds_read_b128 v[92:95], v225 offset:59392
    v_mfma_f32_16x16x32_bf16 v[104:107], v[64:67], a[196:199], v[104:107]
    v_mfma_f32_16x16x32_bf16 v[104:107], v[68:71], a[212:215], v[104:107]
    v_mfma_f32_16x16x32_bf16 v[104:107], v[72:75], a[228:231], v[104:107]
    s_add_u32 s38, s36, 32768
    buffer_store_dwordx4 v[36:39], v240, s[16:19], s38 offen offset:2304 sc1
    v_mfma_f32_16x16x32_bf16 v[104:107], v[76:79], a[244:247], v[104:107]
    v_mfma_f32_16x16x32_bf16 v[112:115], v[64:67], a[200:203], v[112:115]
    v_mfma_f32_16x16x32_bf16 v[112:115], v[68:71], a[216:219], v[112:115]
    v_mfma_f32_16x16x32_bf16 v[112:115], v[72:75], a[232:235], v[112:115]
    v_mfma_f32_16x16x32_bf16 v[112:115], v[76:79], a[248:251], v[112:115]
    v_mfma_f32_16x16x32_bf16 v[120:123], v[64:67], a[204:207], v[120:123]
    v_mfma_f32_16x16x32_bf16 v[120:123], v[68:71], a[220:223], v[120:123]
    v_mfma_f32_16x16x32_bf16 v[120:123], v[72:75], a[236:239], v[120:123]
    v_mfma_f32_16x16x32_bf16 v[120:123], v[76:79], a[252:255], v[120:123]
    s_waitcnt lgkmcnt(0)
    v_mfma_f32_16x16x32_bf16 v[100:103], v[80:83], a[192:195], v[100:103]
    ds_read_b128 v[64:67], v224 offset:53248
    v_mfma_f32_16x16x32_bf16 v[100:103], v[84:87], a[208:211], v[100:103]
    ds_read_b128 v[68:71], v225 offset:53248
    v_mfma_f32_16x16x32_bf16 v[100:103], v[88:91], a[224:227], v[100:103]
    ds_read_b128 v[72:75], v224 offset:61440
    v_mfma_f32_16x16x32_bf16 v[100:103], v[92:95], a[240:243], v[100:103]
    ds_read_b128 v[76:79], v225 offset:61440
    v_mfma_f32_16x16x32_bf16 v[108:111], v[80:83], a[196:199], v[108:111]
    v_mfma_f32_16x16x32_bf16 v[108:111], v[84:87], a[212:215], v[108:111]
    v_mfma_f32_16x16x32_bf16 v[108:111], v[88:91], a[228:231], v[108:111]
    v_mfma_f32_16x16x32_bf16 v[108:111], v[92:95], a[244:247], v[108:111]
    v_mfma_f32_16x16x32_bf16 v[116:119], v[80:83], a[200:203], v[116:119]
    s_add_u32 m0, s34, 40960
    s_add_u32 s37, s85, 196608
    buffer_load_dwordx4 v232, s[44:47], s37 offen lds
    v_mfma_f32_16x16x32_bf16 v[116:119], v[84:87], a[216:219], v[116:119]
    v_mfma_f32_16x16x32_bf16 v[116:119], v[88:91], a[232:235], v[116:119]
    v_mfma_f32_16x16x32_bf16 v[116:119], v[92:95], a[248:251], v[116:119]
    s_add_u32 s38, s36, 32768
    buffer_store_dwordx4 v[40:43], v240, s[16:19], s38 offen offset:3328 sc1
    v_mfma_f32_16x16x32_bf16 v[124:127], v[80:83], a[204:207], v[124:127]
    buffer_load_dwordx4 v233, s[44:47], s37 offen offset:1024 lds
    v_mfma_f32_16x16x32_bf16 v[124:127], v[84:87], a[220:223], v[124:127]
    v_mfma_f32_16x16x32_bf16 v[124:127], v[88:91], a[236:239], v[124:127]
    v_mfma_f32_16x16x32_bf16 v[124:127], v[92:95], a[252:255], v[124:127]
    s_waitcnt lgkmcnt(0)
    v_mfma_f32_16x16x32_bf16 v[128:131], v[64:67], a[192:195], v[128:131]
    ds_read_b128 v[80:83], v224 offset:55296
    v_mfma_f32_16x16x32_bf16 v[128:131], v[68:71], a[208:211], v[128:131]
    ds_read_b128 v[84:87], v225 offset:55296
    v_mfma_f32_16x16x32_bf16 v[128:131], v[72:75], a[224:227], v[128:131]
    ds_read_b128 v[88:91], v224 offset:63488
    v_mfma_f32_16x16x32_bf16 v[128:131], v[76:79], a[240:243], v[128:131]
    ds_read_b128 v[92:95], v225 offset:63488
    v_mfma_f32_16x16x32_bf16 v[136:139], v[64:67], a[196:199], v[136:139]
    v_mfma_f32_16x16x32_bf16 v[136:139], v[68:71], a[212:215], v[136:139]
    v_mfma_f32_16x16x32_bf16 v[136:139], v[72:75], a[228:231], v[136:139]
    v_mfma_f32_16x16x32_bf16 v[136:139], v[76:79], a[244:247], v[136:139]
    v_mfma_f32_16x16x32_bf16 v[144:147], v[64:67], a[200:203], v[144:147]
    s_add_u32 m0, s31, 0
    s_add_u32 s24, s27, 0
    buffer_load_dwordx4 v245, s[12:15], s24 offen lds
    v_mfma_f32_16x16x32_bf16 v[144:147], v[68:71], a[216:219], v[144:147]
    v_mfma_f32_16x16x32_bf16 v[144:147], v[72:75], a[232:235], v[144:147]
    v_mfma_f32_16x16x32_bf16 v[144:147], v[76:79], a[248:251], v[144:147]
    v_mfma_f32_16x16x32_bf16 v[152:155], v[64:67], a[204:207], v[152:155]
    v_mfma_f32_16x16x32_bf16 v[152:155], v[68:71], a[220:223], v[152:155]
    v_mfma_f32_16x16x32_bf16 v[152:155], v[72:75], a[236:239], v[152:155]
    v_mfma_f32_16x16x32_bf16 v[152:155], v[76:79], a[252:255], v[152:155]
    s_waitcnt vmcnt(23) lgkmcnt(0)
    s_barrier
    v_mfma_f32_16x16x32_bf16 v[132:135], v[80:83], a[192:195], v[132:135]
    ds_read_b128 v[64:67], v224 offset:0
    v_mfma_f32_16x16x32_bf16 v[132:135], v[84:87], a[208:211], v[132:135]
    ds_read_b128 v[68:71], v225 offset:0
    s_add_u32 s38, s36, 36864
    buffer_store_dwordx4 v[44:47], v240, s[16:19], s38 offen offset:256 sc1
    v_mfma_f32_16x16x32_bf16 v[132:135], v[88:91], a[224:227], v[132:135]
    ds_read_b128 v[72:75], v224 offset:8192
    v_mfma_f32_16x16x32_bf16 v[132:135], v[92:95], a[240:243], v[132:135]
    ds_read_b128 v[76:79], v225 offset:8192
    v_mfma_f32_16x16x32_bf16 v[140:143], v[80:83], a[196:199], v[140:143]
    v_mfma_f32_16x16x32_bf16 v[140:143], v[84:87], a[212:215], v[140:143]
    v_mfma_f32_16x16x32_bf16 v[140:143], v[88:91], a[228:231], v[140:143]
    v_mfma_f32_16x16x32_bf16 v[140:143], v[92:95], a[244:247], v[140:143]
    v_mfma_f32_16x16x32_bf16 v[148:151], v[80:83], a[200:203], v[148:151]
    s_add_u32 m0, s34, 49152
    s_add_u32 s37, s86, 196608
    buffer_load_dwordx4 v232, s[44:47], s37 offen lds
    v_mfma_f32_16x16x32_bf16 v[148:151], v[84:87], a[216:219], v[148:151]
    v_mfma_f32_16x16x32_bf16 v[148:151], v[88:91], a[232:235], v[148:151]
    buffer_load_dwordx4 v233, s[44:47], s37 offen offset:1024 lds
    v_mfma_f32_16x16x32_bf16 v[148:151], v[92:95], a[248:251], v[148:151]
    v_mfma_f32_16x16x32_bf16 v[156:159], v[80:83], a[204:207], v[156:159]
    v_mfma_f32_16x16x32_bf16 v[156:159], v[84:87], a[220:223], v[156:159]
    s_add_u32 m0, s31, 1024
    s_add_u32 s24, s27, 32768
    buffer_load_dwordx4 v245, s[12:15], s24 offen lds
    v_mfma_f32_16x16x32_bf16 v[156:159], v[88:91], a[236:239], v[156:159]
    v_mfma_f32_16x16x32_bf16 v[156:159], v[92:95], a[252:255], v[156:159]
    s_waitcnt lgkmcnt(0)
    v_mfma_f32_16x16x32_bf16 v[160:163], v[64:67], a[0:3], 0
    ds_read_b128 v[80:83], v224 offset:2048
    v_mfma_f32_16x16x32_bf16 v[160:163], v[68:71], a[16:19], v[160:163]
    ds_read_b128 v[84:87], v225 offset:2048
    v_mfma_f32_16x16x32_bf16 v[160:163], v[72:75], a[32:35], v[160:163]
    ds_read_b128 v[88:91], v224 offset:10240
    v_mfma_f32_16x16x32_bf16 v[160:163], v[76:79], a[48:51], v[160:163]
    ds_read_b128 v[92:95], v225 offset:10240
    v_mfma_f32_16x16x32_bf16 v[168:171], v[64:67], a[4:7], 0
    v_cvt_pk_bf16_f32 v0, v96, v97
    v_cvt_pk_bf16_f32 v1, v98, v99
    v_mfma_f32_16x16x32_bf16 v[168:171], v[68:71], a[20:23], v[168:171]
    v_mfma_f32_16x16x32_bf16 v[168:171], v[72:75], a[36:39], v[168:171]
    v_cvt_pk_bf16_f32 v2, v100, v101
    v_cvt_pk_bf16_f32 v3, v102, v103
    s_add_u32 s38, s36, 40960
    buffer_store_dwordx4 v[48:51], v240, s[16:19], s38 offen offset:1280 sc1
    v_mfma_f32_16x16x32_bf16 v[168:171], v[76:79], a[52:55], v[168:171]
    v_mfma_f32_16x16x32_bf16 v[176:179], v[64:67], a[8:11], 0
    s_add_u32 m0, s31, 2048
    s_add_u32 s24, s27, 65536
    buffer_load_dwordx4 v237, s[12:15], s24 offen lds
    v_cvt_pk_bf16_f32 v4, v104, v105
    v_cvt_pk_bf16_f32 v5, v106, v107
    v_mfma_f32_16x16x32_bf16 v[176:179], v[68:71], a[24:27], v[176:179]
    v_mfma_f32_16x16x32_bf16 v[176:179], v[72:75], a[40:43], v[176:179]
    v_cvt_pk_bf16_f32 v6, v108, v109
    v_cvt_pk_bf16_f32 v7, v110, v111
    v_mfma_f32_16x16x32_bf16 v[176:179], v[76:79], a[56:59], v[176:179]
    v_mfma_f32_16x16x32_bf16 v[184:187], v[64:67], a[12:15], 0
    v_cvt_pk_bf16_f32 v8, v112, v113
    v_cvt_pk_bf16_f32 v9, v114, v115
    v_mfma_f32_16x16x32_bf16 v[184:187], v[68:71], a[28:31], v[184:187]
    v_mfma_f32_16x16x32_bf16 v[184:187], v[72:75], a[44:47], v[184:187]
    v_cvt_pk_bf16_f32 v10, v116, v117
    v_cvt_pk_bf16_f32 v11, v118, v119
    v_mfma_f32_16x16x32_bf16 v[184:187], v[76:79], a[60:63], v[184:187]
    s_waitcnt lgkmcnt(0)
    v_mfma_f32_16x16x32_bf16 v[164:167], v[80:83], a[0:3], 0
    ds_read_b128 v[64:67], v224 offset:4096
    v_cvt_pk_bf16_f32 v12, v120, v121
    v_cvt_pk_bf16_f32 v13, v122, v123
    v_mfma_f32_16x16x32_bf16 v[164:167], v[84:87], a[16:19], v[164:167]
    ds_read_b128 v[68:71], v225 offset:4096
    v_mfma_f32_16x16x32_bf16 v[164:167], v[88:91], a[32:35], v[164:167]
    ds_read_b128 v[72:75], v224 offset:12288
    v_cvt_pk_bf16_f32 v14, v124, v125
    v_cvt_pk_bf16_f32 v15, v126, v127
    v_mfma_f32_16x16x32_bf16 v[164:167], v[92:95], a[48:51], v[164:167]
    ds_read_b128 v[76:79], v225 offset:12288
    v_mfma_f32_16x16x32_bf16 v[172:175], v[80:83], a[4:7], 0
    v_cvt_pk_bf16_f32 v16, v128, v129
    v_cvt_pk_bf16_f32 v17, v130, v131
    v_mfma_f32_16x16x32_bf16 v[172:175], v[84:87], a[20:23], v[172:175]
    v_mfma_f32_16x16x32_bf16 v[172:175], v[88:91], a[36:39], v[172:175]
    v_cvt_pk_bf16_f32 v18, v132, v133
    v_cvt_pk_bf16_f32 v19, v134, v135
    v_mfma_f32_16x16x32_bf16 v[172:175], v[92:95], a[52:55], v[172:175]
    v_mfma_f32_16x16x32_bf16 v[180:183], v[80:83], a[8:11], 0
    s_add_u32 m0, s34, 57344
    s_add_u32 s37, s87, 196608
    buffer_load_dwordx4 v232, s[44:47], s37 offen lds
    v_cvt_pk_bf16_f32 v20, v136, v137
    v_cvt_pk_bf16_f32 v21, v138, v139
    v_mfma_f32_16x16x32_bf16 v[180:183], v[84:87], a[24:27], v[180:183]
    v_mfma_f32_16x16x32_bf16 v[180:183], v[88:91], a[40:43], v[180:183]
    buffer_load_dwordx4 v233, s[44:47], s37 offen offset:1024 lds
    v_cvt_pk_bf16_f32 v22, v140, v141
    v_cvt_pk_bf16_f32 v23, v142, v143
    v_mfma_f32_16x16x32_bf16 v[180:183], v[92:95], a[56:59], v[180:183]
    v_mfma_f32_16x16x32_bf16 v[188:191], v[80:83], a[12:15], 0
    v_cvt_pk_bf16_f32 v24, v144, v145
    v_cvt_pk_bf16_f32 v25, v146, v147
    s_add_u32 s38, s36, 40960
    buffer_store_dwordx4 v[52:55], v240, s[16:19], s38 offen offset:2304 sc1
    v_mfma_f32_16x16x32_bf16 v[188:191], v[84:87], a[28:31], v[188:191]
    s_add_u32 m0, s31, 3072
    s_add_u32 s24, s27, 98304
    buffer_load_dwordx4 v237, s[12:15], s24 offen lds
    v_mfma_f32_16x16x32_bf16 v[188:191], v[88:91], a[44:47], v[188:191]
    v_cvt_pk_bf16_f32 v26, v148, v149
    v_cvt_pk_bf16_f32 v27, v150, v151
    v_mfma_f32_16x16x32_bf16 v[188:191], v[92:95], a[60:63], v[188:191]
    s_waitcnt lgkmcnt(0)
    v_mfma_f32_16x16x32_bf16 v[192:195], v[64:67], a[0:3], 0
    ds_read_b128 v[80:83], v224 offset:6144
    v_cvt_pk_bf16_f32 v28, v152, v153
    v_cvt_pk_bf16_f32 v29, v154, v155
    v_mfma_f32_16x16x32_bf16 v[192:195], v[68:71], a[16:19], v[192:195]
    ds_read_b128 v[84:87], v225 offset:6144
    v_mfma_f32_16x16x32_bf16 v[192:195], v[72:75], a[32:35], v[192:195]
    ds_read_b128 v[88:91], v224 offset:14336
    v_cvt_pk_bf16_f32 v30, v156, v157
    v_cvt_pk_bf16_f32 v31, v158, v159
    v_mfma_f32_16x16x32_bf16 v[192:195], v[76:79], a[48:51], v[192:195]
    ds_read_b128 v[92:95], v225 offset:14336
    v_mfma_f32_16x16x32_bf16 v[200:203], v[64:67], a[4:7], 0
    v_mfma_f32_16x16x32_bf16 v[200:203], v[68:71], a[20:23], v[200:203]
    v_mfma_f32_16x16x32_bf16 v[200:203], v[72:75], a[36:39], v[200:203]
    v_mfma_f32_16x16x32_bf16 v[200:203], v[76:79], a[52:55], v[200:203]
    v_mfma_f32_16x16x32_bf16 v[208:211], v[64:67], a[8:11], 0
    s_add_u32 m0, s31, 4096
    s_add_u32 s24, s27, 131072
    buffer_load_dwordx4 v245, s[12:15], s24 offen lds
    v_mfma_f32_16x16x32_bf16 v[208:211], v[68:71], a[24:27], v[208:211]
    v_mfma_f32_16x16x32_bf16 v[208:211], v[72:75], a[40:43], v[208:211]
    v_mfma_f32_16x16x32_bf16 v[208:211], v[76:79], a[56:59], v[208:211]
    v_mfma_f32_16x16x32_bf16 v[216:219], v[64:67], a[12:15], 0
    v_mfma_f32_16x16x32_bf16 v[216:219], v[68:71], a[28:31], v[216:219]
    v_mfma_f32_16x16x32_bf16 v[216:219], v[72:75], a[44:47], v[216:219]
    v_mfma_f32_16x16x32_bf16 v[216:219], v[76:79], a[60:63], v[216:219]
    s_waitcnt vmcnt(23) lgkmcnt(0)
    s_barrier
    v_mfma_f32_16x16x32_bf16 v[196:199], v[80:83], a[0:3], 0
    ds_read_b128 v[64:67], v224 offset:16384
    v_mfma_f32_16x16x32_bf16 v[196:199], v[84:87], a[16:19], v[196:199]
    ds_read_b128 v[68:71], v225 offset:16384
    s_add_u32 s38, s36, 40960
    buffer_store_dwordx4 v[56:59], v240, s[16:19], s38 offen offset:3328 sc1
    v_mfma_f32_16x16x32_bf16 v[196:199], v[88:91], a[32:35], v[196:199]
    ds_read_b128 v[72:75], v224 offset:24576
    v_mfma_f32_16x16x32_bf16 v[196:199], v[92:95], a[48:51], v[196:199]
    ds_read_b128 v[76:79], v225 offset:24576
    v_mfma_f32_16x16x32_bf16 v[204:207], v[80:83], a[4:7], 0
    v_mfma_f32_16x16x32_bf16 v[204:207], v[84:87], a[20:23], v[204:207]
    v_mfma_f32_16x16x32_bf16 v[204:207], v[88:91], a[36:39], v[204:207]
    v_mfma_f32_16x16x32_bf16 v[204:207], v[92:95], a[52:55], v[204:207]
    v_mfma_f32_16x16x32_bf16 v[212:215], v[80:83], a[8:11], 0
    s_add_u32 m0, s31, 5120
    s_add_u32 s24, s27, 163840
    buffer_load_dwordx4 v245, s[12:15], s24 offen lds
    v_mfma_f32_16x16x32_bf16 v[212:215], v[84:87], a[24:27], v[212:215]
    v_mfma_f32_16x16x32_bf16 v[212:215], v[88:91], a[40:43], v[212:215]
    v_mfma_f32_16x16x32_bf16 v[212:215], v[92:95], a[56:59], v[212:215]
    v_mfma_f32_16x16x32_bf16 v[220:223], v[80:83], a[12:15], 0
    v_mfma_f32_16x16x32_bf16 v[220:223], v[84:87], a[28:31], v[220:223]
    v_mfma_f32_16x16x32_bf16 v[220:223], v[88:91], a[44:47], v[220:223]
    v_mfma_f32_16x16x32_bf16 v[220:223], v[92:95], a[60:63], v[220:223]
    s_waitcnt lgkmcnt(0)
    v_mfma_f32_16x16x32_bf16 v[160:163], v[64:67], a[64:67], v[160:163]
    ds_read_b128 v[80:83], v224 offset:18432
    v_mfma_f32_16x16x32_bf16 v[160:163], v[68:71], a[80:83], v[160:163]
    ds_read_b128 v[84:87], v225 offset:18432
    v_mfma_f32_16x16x32_bf16 v[160:163], v[72:75], a[96:99], v[160:163]
    ds_read_b128 v[88:91], v224 offset:26624
    v_mfma_f32_16x16x32_bf16 v[160:163], v[76:79], a[112:115], v[160:163]
    ds_read_b128 v[92:95], v225 offset:26624
    v_mfma_f32_16x16x32_bf16 v[168:171], v[64:67], a[68:71], v[168:171]
    v_mfma_f32_16x16x32_bf16 v[168:171], v[68:71], a[84:87], v[168:171]
    v_mfma_f32_16x16x32_bf16 v[168:171], v[72:75], a[100:103], v[168:171]
    v_mfma_f32_16x16x32_bf16 v[168:171], v[76:79], a[116:119], v[168:171]
    s_add_u32 s38, s36, 45056
    buffer_store_dwordx4 v[60:63], v240, s[16:19], s38 offen offset:256 sc1
    v_mfma_f32_16x16x32_bf16 v[176:179], v[64:67], a[72:75], v[176:179]
    s_add_u32 m0, s31, 6144
    s_add_u32 s24, s27, 196608
    buffer_load_dwordx4 v237, s[12:15], s24 offen lds
    v_mfma_f32_16x16x32_bf16 v[176:179], v[68:71], a[88:91], v[176:179]
    v_mfma_f32_16x16x32_bf16 v[176:179], v[72:75], a[104:107], v[176:179]
    v_mfma_f32_16x16x32_bf16 v[176:179], v[76:79], a[120:123], v[176:179]
    v_mfma_f32_16x16x32_bf16 v[184:187], v[64:67], a[76:79], v[184:187]
    v_mfma_f32_16x16x32_bf16 v[184:187], v[68:71], a[92:95], v[184:187]
    v_mfma_f32_16x16x32_bf16 v[184:187], v[72:75], a[108:111], v[184:187]
    v_mfma_f32_16x16x32_bf16 v[184:187], v[76:79], a[124:127], v[184:187]
    s_waitcnt lgkmcnt(0)
    v_mfma_f32_16x16x32_bf16 v[164:167], v[80:83], a[64:67], v[164:167]
    ds_read_b128 v[64:67], v224 offset:20480
    v_mfma_f32_16x16x32_bf16 v[164:167], v[84:87], a[80:83], v[164:167]
    ds_read_b128 v[68:71], v225 offset:20480
    v_mfma_f32_16x16x32_bf16 v[164:167], v[88:91], a[96:99], v[164:167]
    ds_read_b128 v[72:75], v224 offset:28672
    v_mfma_f32_16x16x32_bf16 v[164:167], v[92:95], a[112:115], v[164:167]
    ds_read_b128 v[76:79], v225 offset:28672
    v_mfma_f32_16x16x32_bf16 v[172:175], v[80:83], a[68:71], v[172:175]
    v_mfma_f32_16x16x32_bf16 v[172:175], v[84:87], a[84:87], v[172:175]
    v_mfma_f32_16x16x32_bf16 v[172:175], v[88:91], a[100:103], v[172:175]
    v_mfma_f32_16x16x32_bf16 v[172:175], v[92:95], a[116:119], v[172:175]
    v_mfma_f32_16x16x32_bf16 v[180:183], v[80:83], a[72:75], v[180:183]
    s_add_u32 m0, s31, 7168
    s_add_u32 s24, s27, 229376
    buffer_load_dwordx4 v237, s[12:15], s24 offen lds
    v_mfma_f32_16x16x32_bf16 v[180:183], v[84:87], a[88:91], v[180:183]
    v_mfma_f32_16x16x32_bf16 v[180:183], v[88:91], a[104:107], v[180:183]
    s_add_u32 s27, s27, 1048576
    s_and_b32 s27, s27, 0x407fffff
    s_cmp_eq_u32 s27, s7
    s_cselect_b32 s27, s43, s27
    v_mfma_f32_16x16x32_bf16 v[180:183], v[92:95], a[120:123], v[180:183]
    v_mfma_f32_16x16x32_bf16 v[188:191], v[80:83], a[76:79], v[188:191]
    v_mfma_f32_16x16x32_bf16 v[188:191], v[84:87], a[92:95], v[188:191]
    s_add_u32 s31, s31, 32768
    s_cmp_ge_u32 s31, 163840
    s_cselect_b32 s24, 98304, 0
    s_sub_u32 s31, s31, s24
    s_add_u32 s38, s36, 65536
    buffer_store_dwordx4 v[0:3], v240, s[16:19], s38 offen offset:2560 sc1
    v_mfma_f32_16x16x32_bf16 v[188:191], v[88:91], a[108:111], v[188:191]
    v_mfma_f32_16x16x32_bf16 v[188:191], v[92:95], a[124:127], v[188:191]
    s_waitcnt lgkmcnt(0)
    v_mfma_f32_16x16x32_bf16 v[192:195], v[64:67], a[64:67], v[192:195]
    ds_read_b128 v[80:83], v224 offset:22528
    v_mfma_f32_16x16x32_bf16 v[192:195], v[68:71], a[80:83], v[192:195]
    ds_read_b128 v[84:87], v225 offset:22528
    v_mfma_f32_16x16x32_bf16 v[192:195], v[72:75], a[96:99], v[192:195]
    ds_read_b128 v[88:91], v224 offset:30720
    v_mfma_f32_16x16x32_bf16 v[192:195], v[76:79], a[112:115], v[192:195]
    ds_read_b128 v[92:95], v225 offset:30720
    v_mfma_f32_16x16x32_bf16 v[200:203], v[64:67], a[68:71], v[200:203]
    v_mfma_f32_16x16x32_bf16 v[200:203], v[68:71], a[84:87], v[200:203]
    v_mfma_f32_16x16x32_bf16 v[200:203], v[72:75], a[100:103], v[200:203]
    v_mfma_f32_16x16x32_bf16 v[200:203], v[76:79], a[116:119], v[200:203]
    v_mfma_f32_16x16x32_bf16 v[208:211], v[64:67], a[72:75], v[208:211]
    v_mfma_f32_16x16x32_bf16 v[208:211], v[68:71], a[88:91], v[208:211]
    v_mfma_f32_16x16x32_bf16 v[208:211], v[72:75], a[104:107], v[208:211]
    v_mfma_f32_16x16x32_bf16 v[208:211], v[76:79], a[120:123], v[208:211]
    v_mfma_f32_16x16x32_bf16 v[216:219], v[64:67], a[76:79], v[216:219]
    v_mfma_f32_16x16x32_bf16 v[216:219], v[68:71], a[92:95], v[216:219]
    v_mfma_f32_16x16x32_bf16 v[216:219], v[72:75], a[108:111], v[216:219]
    v_mfma_f32_16x16x32_bf16 v[216:219], v[76:79], a[124:127], v[216:219]
    s_waitcnt vmcnt(9) lgkmcnt(0)
    s_barrier
    v_mfma_f32_16x16x32_bf16 v[196:199], v[80:83], a[64:67], v[196:199]
    ds_read_b128 v[64:67], v224 offset:32768
    v_mfma_f32_16x16x32_bf16 v[196:199], v[84:87], a[80:83], v[196:199]
    ds_read_b128 v[68:71], v225 offset:32768
    v_mfma_f32_16x16x32_bf16 v[196:199], v[88:91], a[96:99], v[196:199]
    ds_read_b128 v[72:75], v224 offset:40960
    s_add_u32 s38, s36, 65536
    buffer_store_dwordx4 v[4:7], v240, s[16:19], s38 offen offset:3584 sc1
    v_mfma_f32_16x16x32_bf16 v[196:199], v[92:95], a[112:115], v[196:199]
    ds_read_b128 v[76:79], v225 offset:40960
    v_mfma_f32_16x16x32_bf16 v[204:207], v[80:83], a[68:71], v[204:207]
    v_mfma_f32_16x16x32_bf16 v[204:207], v[84:87], a[84:87], v[204:207]
    v_mfma_f32_16x16x32_bf16 v[204:207], v[88:91], a[100:103], v[204:207]
    v_mfma_f32_16x16x32_bf16 v[204:207], v[92:95], a[116:119], v[204:207]
    v_mfma_f32_16x16x32_bf16 v[212:215], v[80:83], a[72:75], v[212:215]
    v_mfma_f32_16x16x32_bf16 v[212:215], v[84:87], a[88:91], v[212:215]
    v_mfma_f32_16x16x32_bf16 v[212:215], v[88:91], a[104:107], v[212:215]
    v_mfma_f32_16x16x32_bf16 v[212:215], v[92:95], a[120:123], v[212:215]
    v_mfma_f32_16x16x32_bf16 v[220:223], v[80:83], a[76:79], v[220:223]
    v_mfma_f32_16x16x32_bf16 v[220:223], v[84:87], a[92:95], v[220:223]
    v_mfma_f32_16x16x32_bf16 v[220:223], v[88:91], a[108:111], v[220:223]
    v_mfma_f32_16x16x32_bf16 v[220:223], v[92:95], a[124:127], v[220:223]
    s_waitcnt lgkmcnt(0)
    v_mfma_f32_16x16x32_bf16 v[160:163], v[64:67], a[128:131], v[160:163]
    ds_read_b128 v[80:83], v224 offset:34816
    v_mfma_f32_16x16x32_bf16 v[160:163], v[68:71], a[144:147], v[160:163]
    ds_read_b128 v[84:87], v225 offset:34816
    v_mfma_f32_16x16x32_bf16 v[160:163], v[72:75], a[160:163], v[160:163]
    ds_read_b128 v[88:91], v224 offset:43008
    v_mfma_f32_16x16x32_bf16 v[160:163], v[76:79], a[176:179], v[160:163]
    ds_read_b128 v[92:95], v225 offset:43008
    v_mfma_f32_16x16x32_bf16 v[168:171], v[64:67], a[132:135], v[168:171]
    v_mfma_f32_16x16x32_bf16 v[168:171], v[68:71], a[148:151], v[168:171]
    v_mfma_f32_16x16x32_bf16 v[168:171], v[72:75], a[164:167], v[168:171]
    v_mfma_f32_16x16x32_bf16 v[168:171], v[76:79], a[180:183], v[168:171]
    v_mfma_f32_16x16x32_bf16 v[176:179], v[64:67], a[136:139], v[176:179]
    buffer_load_dword v254, off, s[88:91], s39 sc1
    s_add_u32 s38, s36, 69632
    buffer_store_dwordx4 v[8:11], v240, s[16:19], s38 offen offset:512 sc1
    v_mfma_f32_16x16x32_bf16 v[176:179], v[68:71], a[152:155], v[176:179]
    v_mfma_f32_16x16x32_bf16 v[176:179], v[72:75], a[168:171], v[176:179]
    v_mfma_f32_16x16x32_bf16 v[176:179], v[76:79], a[184:187], v[176:179]
    v_mfma_f32_16x16x32_bf16 v[184:187], v[64:67], a[140:143], v[184:187]
    v_mfma_f32_16x16x32_bf16 v[184:187], v[68:71], a[156:159], v[184:187]
    v_mfma_f32_16x16x32_bf16 v[184:187], v[72:75], a[172:175], v[184:187]
    v_mfma_f32_16x16x32_bf16 v[184:187], v[76:79], a[188:191], v[184:187]
    s_waitcnt lgkmcnt(0)
    v_mfma_f32_16x16x32_bf16 v[164:167], v[80:83], a[128:131], v[164:167]
    ds_read_b128 v[64:67], v224 offset:36864
    v_mfma_f32_16x16x32_bf16 v[164:167], v[84:87], a[144:147], v[164:167]
    ds_read_b128 v[68:71], v225 offset:36864
    v_mfma_f32_16x16x32_bf16 v[164:167], v[88:91], a[160:163], v[164:167]
    ds_read_b128 v[72:75], v224 offset:45056
    v_mfma_f32_16x16x32_bf16 v[164:167], v[92:95], a[176:179], v[164:167]
    ds_read_b128 v[76:79], v225 offset:45056
    v_mfma_f32_16x16x32_bf16 v[172:175], v[80:83], a[132:135], v[172:175]
    v_mfma_f32_16x16x32_bf16 v[172:175], v[84:87], a[148:151], v[172:175]
    v_mfma_f32_16x16x32_bf16 v[172:175], v[88:91], a[164:167], v[172:175]
    v_mfma_f32_16x16x32_bf16 v[172:175], v[92:95], a[180:183], v[172:175]
    v_mfma_f32_16x16x32_bf16 v[180:183], v[80:83], a[136:139], v[180:183]
    v_mfma_f32_16x16x32_bf16 v[180:183], v[84:87], a[152:155], v[180:183]
    v_mfma_f32_16x16x32_bf16 v[180:183], v[88:91], a[168:171], v[180:183]
    v_mfma_f32_16x16x32_bf16 v[180:183], v[92:95], a[184:187], v[180:183]
    v_mfma_f32_16x16x32_bf16 v[188:191], v[80:83], a[140:143], v[188:191]
    v_mfma_f32_16x16x32_bf16 v[188:191], v[84:87], a[156:159], v[188:191]
    s_add_u32 s38, s36, 69632
    buffer_store_dwordx4 v[12:15], v240, s[16:19], s38 offen offset:1536 sc1
    v_mfma_f32_16x16x32_bf16 v[188:191], v[88:91], a[172:175], v[188:191]
    v_mfma_f32_16x16x32_bf16 v[188:191], v[92:95], a[188:191], v[188:191]
    s_waitcnt lgkmcnt(0)
    v_mfma_f32_16x16x32_bf16 v[192:195], v[64:67], a[128:131], v[192:195]
    ds_read_b128 v[80:83], v224 offset:38912
    v_mfma_f32_16x16x32_bf16 v[192:195], v[68:71], a[144:147], v[192:195]
    ds_read_b128 v[84:87], v225 offset:38912
    v_mfma_f32_16x16x32_bf16 v[192:195], v[72:75], a[160:163], v[192:195]
    ds_read_b128 v[88:91], v224 offset:47104
    v_mfma_f32_16x16x32_bf16 v[192:195], v[76:79], a[176:179], v[192:195]
    ds_read_b128 v[92:95], v225 offset:47104
    v_mfma_f32_16x16x32_bf16 v[200:203], v[64:67], a[132:135], v[200:203]
    v_mfma_f32_16x16x32_bf16 v[200:203], v[68:71], a[148:151], v[200:203]
    v_mfma_f32_16x16x32_bf16 v[200:203], v[72:75], a[164:167], v[200:203]
    v_mfma_f32_16x16x32_bf16 v[200:203], v[76:79], a[180:183], v[200:203]
    v_mfma_f32_16x16x32_bf16 v[208:211], v[64:67], a[136:139], v[208:211]
    v_mfma_f32_16x16x32_bf16 v[208:211], v[68:71], a[152:155], v[208:211]
    v_mfma_f32_16x16x32_bf16 v[208:211], v[72:75], a[168:171], v[208:211]
    v_mfma_f32_16x16x32_bf16 v[208:211], v[76:79], a[184:187], v[208:211]
    v_mfma_f32_16x16x32_bf16 v[216:219], v[64:67], a[140:143], v[216:219]
    v_mfma_f32_16x16x32_bf16 v[216:219], v[68:71], a[156:159], v[216:219]
    v_mfma_f32_16x16x32_bf16 v[216:219], v[72:75], a[172:175], v[216:219]
    v_mfma_f32_16x16x32_bf16 v[216:219], v[76:79], a[188:191], v[216:219]
    s_waitcnt lgkmcnt(0)
    v_mfma_f32_16x16x32_bf16 v[196:199], v[80:83], a[128:131], v[196:199]
    ds_read_b128 v[64:67], v224 offset:49152
    v_mfma_f32_16x16x32_bf16 v[196:199], v[84:87], a[144:147], v[196:199]
    ds_read_b128 v[68:71], v224 offset:51200
    v_mfma_f32_16x16x32_bf16 v[196:199], v[88:91], a[160:163], v[196:199]
    ds_read_b128 v[72:75], v224 offset:53248
    v_mfma_f32_16x16x32_bf16 v[196:199], v[92:95], a[176:179], v[196:199]
    ds_read_b128 v[76:79], v224 offset:55296
    s_add_u32 s38, s36, 73728
    buffer_store_dwordx4 v[16:19], v240, s[16:19], s38 offen offset:2560 sc1
    v_mfma_f32_16x16x32_bf16 v[204:207], v[80:83], a[132:135], v[204:207]
    v_mfma_f32_16x16x32_bf16 v[204:207], v[84:87], a[148:151], v[204:207]
    v_mfma_f32_16x16x32_bf16 v[204:207], v[88:91], a[164:167], v[204:207]
    v_mfma_f32_16x16x32_bf16 v[204:207], v[92:95], a[180:183], v[204:207]
    v_mfma_f32_16x16x32_bf16 v[212:215], v[80:83], a[136:139], v[212:215]
    v_mfma_f32_16x16x32_bf16 v[212:215], v[84:87], a[152:155], v[212:215]
    v_mfma_f32_16x16x32_bf16 v[212:215], v[88:91], a[168:171], v[212:215]
    v_mfma_f32_16x16x32_bf16 v[212:215], v[92:95], a[184:187], v[212:215]
    v_mfma_f32_16x16x32_bf16 v[220:223], v[80:83], a[140:143], v[220:223]
    v_mfma_f32_16x16x32_bf16 v[220:223], v[84:87], a[156:159], v[220:223]
    v_mfma_f32_16x16x32_bf16 v[220:223], v[88:91], a[172:175], v[220:223]
    v_mfma_f32_16x16x32_bf16 v[220:223], v[92:95], a[188:191], v[220:223]
    s_waitcnt vmcnt(3)
    v_readfirstlane_b32 s24, v254
    s_lshl_b32 s25, s3, 16
    s_add_u32 s24, s24, s25
    s_cmp_ge_u32 s24, 32
    s_cbranch_scc0 kf_spin53
kf_spinr54:
    s_waitcnt lgkmcnt(0)
    s_barrier
    v_mfma_f32_16x16x32_bf16 v[160:163], v[64:67], a[192:195], v[160:163]
    ds_read_b128 v[80:83], v225 offset:49152
    v_mfma_f32_16x16x32_bf16 v[164:167], v[68:71], a[192:195], v[164:167]
    ds_read_b128 v[84:87], v225 offset:51200
    v_mfma_f32_16x16x32_bf16 v[168:171], v[64:67], a[196:199], v[168:171]
    ds_read_b128 v[88:91], v225 offset:53248
    v_mfma_f32_16x16x32_bf16 v[172:175], v[68:71], a[196:199], v[172:175]
    ds_read_b128 v[92:95], v225 offset:55296
    v_mfma_f32_16x16x32_bf16 v[176:179], v[64:67], a[200:203], v[176:179]
    v_mfma_f32_16x16x32_bf16 v[180:183], v[68:71], a[200:203], v[180:183]
    v_mfma_f32_16x16x32_bf16 v[184:187], v[64:67], a[204:207], v[184:187]
    v_mfma_f32_16x16x32_bf16 v[188:191], v[68:71], a[204:207], v[188:191]
    v_mfma_f32_16x16x32_bf16 v[192:195], v[72:75], a[192:195], v[192:195]
    buffer_load_dwordx4 a[128:131], v248, s[8:11], s28 offen offset:0 sc1
    s_add_u32 s38, s36, 73728
    buffer_store_dwordx4 v[20:23], v240, s[16:19], s38 offen offset:3584 sc1
    v_mfma_f32_16x16x32_bf16 v[196:199], v[76:79], a[192:195], v[196:199]
    v_mfma_f32_16x16x32_bf16 v[200:203], v[72:75], a[196:199], v[200:203]
    buffer_load_dwordx4 a[132:135], v248, s[8:11], s29 offen offset:0 sc1
    v_mfma_f32_16x16x32_bf16 v[204:207], v[76:79], a[196:199], v[204:207]
    v_mfma_f32_16x16x32_bf16 v[208:211], v[72:75], a[200:203], v[208:211]
    v_mfma_f32_16x16x32_bf16 v[212:215], v[76:79], a[200:203], v[212:215]
    buffer_load_dwordx4 a[136:139], v249, s[8:11], s28 offen offset:0 sc1
    v_mfma_f32_16x16x32_bf16 v[216:219], v[72:75], a[204:207], v[216:219]
    v_mfma_f32_16x16x32_bf16 v[220:223], v[76:79], a[204:207], v[220:223]
    s_waitcnt lgkmcnt(0)
    v_mfma_f32_16x16x32_bf16 v[160:163], v[80:83], a[208:211], v[160:163]
    ds_read_b128 v[64:67], v224 offset:57344
    v_mfma_f32_16x16x32_bf16 v[164:167], v[84:87], a[208:211], v[164:167]
    ds_read_b128 v[68:71], v224 offset:59392
    v_mfma_f32_16x16x32_bf16 v[168:171], v[80:83], a[212:215], v[168:171]
    ds_read_b128 v[72:75], v224 offset:61440
    v_mfma_f32_16x16x32_bf16 v[172:175], v[84:87], a[212:215], v[172:175]
    ds_read_b128 v[76:79], v224 offset:63488
    v_mfma_f32_16x16x32_bf16 v[176:179], v[80:83], a[216:219], v[176:179]
    v_mfma_f32_16x16x32_bf16 v[180:183], v[84:87], a[216:219], v[180:183]
    v_mfma_f32_16x16x32_bf16 v[184:187], v[80:83], a[220:223], v[184:187]
    v_mfma_f32_16x16x32_bf16 v[188:191], v[84:87], a[220:223], v[188:191]
    v_mfma_f32_16x16x32_bf16 v[192:195], v[88:91], a[208:211], v[192:195]
    buffer_load_dwordx4 a[140:143], v249, s[8:11], s29 offen offset:0 sc1
    v_mfma_f32_16x16x32_bf16 v[196:199], v[92:95], a[208:211], v[196:199]
    v_mfma_f32_16x16x32_bf16 v[200:203], v[88:91], a[212:215], v[200:203]
    buffer_load_dwordx4 a[144:147], v248, s[8:11], s28 offen offset:1024 sc1
    v_mfma_f32_16x16x32_bf16 v[204:207], v[92:95], a[212:215], v[204:207]
    v_mfma_f32_16x16x32_bf16 v[208:211], v[88:91], a[216:219], v[208:211]
    v_mfma_f32_16x16x32_bf16 v[212:215], v[92:95], a[216:219], v[212:215]
    buffer_load_dwordx4 a[148:151], v248, s[8:11], s29 offen offset:1024 sc1
    v_mfma_f32_16x16x32_bf16 v[216:219], v[88:91], a[220:223], v[216:219]
    s_add_u32 s38, s36, 77824
    buffer_store_dwordx4 v[24:27], v240, s[16:19], s38 offen offset:512 sc1
    v_mfma_f32_16x16x32_bf16 v[220:223], v[92:95], a[220:223], v[220:223]
    s_waitcnt lgkmcnt(0)
    v_mfma_f32_16x16x32_bf16 v[160:163], v[64:67], a[224:227], v[160:163]
    ds_read_b128 v[80:83], v225 offset:57344
    v_mfma_f32_16x16x32_bf16 v[164:167], v[68:71], a[224:227], v[164:167]
    ds_read_b128 v[84:87], v225 offset:59392
    v_mfma_f32_16x16x32_bf16 v[168:171], v[64:67], a[228:231], v[168:171]
    ds_read_b128 v[88:91], v225 offset:61440
    v_mfma_f32_16x16x32_bf16 v[172:175], v[68:71], a[228:231], v[172:175]
    ds_read_b128 v[92:95], v225 offset:63488
    v_mfma_f32_16x16x32_bf16 v[176:179], v[64:67], a[232:235], v[176:179]
    v_mfma_f32_16x16x32_bf16 v[180:183], v[68:71], a[232:235], v[180:183]
    v_mfma_f32_16x16x32_bf16 v[184:187], v[64:67], a[236:239], v[184:187]
    v_mfma_f32_16x16x32_bf16 v[188:191], v[68:71], a[236:239], v[188:191]
    v_mfma_f32_16x16x32_bf16 v[192:195], v[72:75], a[224:227], v[192:195]
    buffer_load_dwordx4 a[152:155], v249, s[8:11], s28 offen offset:1024 sc1
    v_mfma_f32_16x16x32_bf16 v[196:199], v[76:79], a[224:227], v[196:199]
    v_mfma_f32_16x16x32_bf16 v[200:203], v[72:75], a[228:231], v[200:203]
    buffer_load_dwordx4 a[156:159], v249, s[8:11], s29 offen offset:1024 sc1
    v_mfma_f32_16x16x32_bf16 v[204:207], v[76:79], a[228:231], v[204:207]
    v_mfma_f32_16x16x32_bf16 v[208:211], v[72:75], a[232:235], v[208:211]
    v_mfma_f32_16x16x32_bf16 v[212:215], v[76:79], a[232:235], v[212:215]
    buffer_load_dwordx4 a[160:163], v248, s[8:11], s28 offen offset:2048 sc1
    v_mfma_f32_16x16x32_bf16 v[216:219], v[72:75], a[236:239], v[216:219]
    v_mfma_f32_16x16x32_bf16 v[220:223], v[76:79], a[236:239], v[220:223]
    s_waitcnt vmcnt(38) lgkmcnt(0)
    s_barrier
    v_mfma_f32_16x16x32_bf16 v[160:163], v[80:83], a[240:243], v[160:163]
    ds_read_b64_tr_b16 a[192:193], v246 offset:0
    v_mfma_f32_16x16x32_bf16 v[164:167], v[84:87], a[240:243], v[164:167]
    ds_read_b64_tr_b16 a[194:195], v246 offset:1024
    v_mfma_f32_16x16x32_bf16 v[168:171], v[80:83], a[244:247], v[168:171]
    ds_read_b64_tr_b16 a[196:197], v238 offset:0
    v_mfma_f32_16x16x32_bf16 v[172:175], v[84:87], a[244:247], v[172:175]
    ds_read_b64_tr_b16 a[198:199], v238 offset:1024
    v_mfma_f32_16x16x32_bf16 v[176:179], v[80:83], a[248:251], v[176:179]
    ds_read_b64_tr_b16 a[200:201], v246 offset:256
    s_add_u32 s38, s36, 77824
    buffer_store_dwordx4 v[28:31], v240, s[16:19], s38 offen offset:1536 sc1
    v_mfma_f32_16x16x32_bf16 v[180:183], v[84:87], a[248:251], v[180:183]
    ds_read_b64_tr_b16 a[202:203], v246 offset:1280
    v_mfma_f32_16x16x32_bf16 v[184:187], v[80:83], a[252:255], v[184:187]
    ds_read_b64_tr_b16 a[204:205], v238 offset:256
    v_mfma_f32_16x16x32_bf16 v[188:191], v[84:87], a[252:255], v[188:191]
    ds_read_b64_tr_b16 a[206:207], v238 offset:1280
    v_mfma_f32_16x16x32_bf16 v[192:195], v[88:91], a[240:243], v[192:195]
    buffer_load_dwordx4 a[164:167], v248, s[8:11], s29 offen offset:2048 sc1
    v_mfma_f32_16x16x32_bf16 v[196:199], v[92:95], a[240:243], v[196:199]
    v_cvt_pk_bf16_f32 v32, v160, v161
    v_cvt_pk_bf16_f32 v33, v162, v163
    v_mfma_f32_16x16x32_bf16 v[200:203], v[88:91], a[244:247], v[200:203]
    buffer_load_dwordx4 a[168:171], v249, s[8:11], s28 offen offset:2048 sc1
    v_cvt_pk_bf16_f32 v34, v164, v165
    v_cvt_pk_bf16_f32 v35, v166, v167
    v_mfma_f32_16x16x32_bf16 v[204:207], v[92:95], a[244:247], v[204:207]
    v_cvt_pk_bf16_f32 v36, v168, v169
    v_cvt_pk_bf16_f32 v37, v170, v171
    v_mfma_f32_16x16x32_bf16 v[208:211], v[88:91], a[248:251], v[208:211]
    v_cvt_pk_bf16_f32 v38, v172, v173
    v_cvt_pk_bf16_f32 v39, v174, v175
    v_mfma_f32_16x16x32_bf16 v[212:215], v[92:95], a[248:251], v[212:215]
    buffer_load_dwordx4 a[172:175], v249, s[8:11], s29 offen offset:2048 sc1
    v_cvt_pk_bf16_f32 v40, v176, v177
    v_cvt_pk_bf16_f32 v41, v178, v179
    v_mfma_f32_16x16x32_bf16 v[216:219], v[88:91], a[252:255], v[216:219]
    v_cvt_pk_bf16_f32 v42, v180, v181
    v_cvt_pk_bf16_f32 v43, v182, v183
    v_mfma_f32_16x16x32_bf16 v[220:223], v[92:95], a[252:255], v[220:223]
    v_cvt_pk_bf16_f32 v44, v184, v185
    v_cvt_pk_bf16_f32 v45, v186, v187
    s_nop 3
    v_cvt_pk_bf16_f32 v46, v188, v189
    v_cvt_pk_bf16_f32 v47, v190, v191
    v_cvt_pk_bf16_f32 v48, v192, v193
    v_cvt_pk_bf16_f32 v49, v194, v195
    v_cvt_pk_bf16_f32 v50, v196, v197
    v_cvt_pk_bf16_f32 v51, v198, v199
    v_cvt_pk_bf16_f32 v52, v200, v201
    v_cvt_pk_bf16_f32 v53, v202, v203
    v_cvt_pk_bf16_f32 v54, v204, v205
    v_cvt_pk_bf16_f32 v55, v206, v207
    v_cvt_pk_bf16_f32 v56, v208, v209
    v_cvt_pk_bf16_f32 v57, v210, v211
    v_cvt_pk_bf16_f32 v58, v212, v213
    v_cvt_pk_bf16_f32 v59, v214, v215
    v_cvt_pk_bf16_f32 v60, v216, v217
    v_cvt_pk_bf16_f32 v61, v218, v219
    v_cvt_pk_bf16_f32 v62, v220, v221
    v_cvt_pk_bf16_f32 v63, v222, v223
    s_add_u32 s80, s36, 102144
    s_add_u32 s81, s36, 103168
    s_add_u32 s82, s36, 104192
    s_add_u32 s83, s36, 105216
    s_add_u32 s84, s36, 110336
    s_add_u32 s85, s36, 111360
    s_add_u32 s86, s36, 112384
    s_add_u32 s87, s36, 113408
ka_Q:
    s_waitcnt vmcnt(10) lgkmcnt(0)
    v_mfma_f32_16x16x32_bf16 v[96:99], a[192:195], a[128:131], 0
    ds_read_b64_tr_b16 a[208:209], v246 offset:512
    s_lshl_b32 s97, s4, 7
    v_mfma_f32_16x16x32_bf16 v[100:103], a[192:195], a[132:135], 0
    ds_read_b64_tr_b16 a[210:211], v246 offset:1536
    s_add_u32 s97, s97, 12288
    s_cmp_eq_u32 s3, 0
    s_cselect_b32 s35, s97, s43
    v_mfma_f32_16x16x32_bf16 v[104:107], a[192:195], a[136:139], 0
    ds_read_b64_tr_b16 a[212:213], v238 offset:512
    s_lshl_b32 s37, s3, 12
    v_mfma_f32_16x16x32_bf16 v[108:111], a[192:195], a[140:143], 0
    ds_read_b64_tr_b16 a[214:215], v238 offset:1536
    s_mov_b32 s34, s37
    s_mul_i32 s32, s4, 1089536
    v_mfma_f32_16x16x32_bf16 v[112:115], a[196:199], a[128:131], 0
    ds_read_b64_tr_b16 a[216:217], v246 offset:768
    s_mov_b32 s33, 0
    v_mfma_f32_16x16x32_bf16 v[116:119], a[196:199], a[132:135], 0
    ds_read_b64_tr_b16 a[218:219], v246 offset:1792
    s_lshl_b32 s39, s6, 18
    v_mfma_f32_16x16x32_bf16 v[120:123], a[196:199], a[136:139], 0
    ds_read_b64_tr_b16 a[220:221], v238 offset:768
    s_sub_u32 s25, 63, s6
    s_lshl_b32 s40, s25, 18
    v_mfma_f32_16x16x32_bf16 v[124:127], a[196:199], a[140:143], 0
    ds_read_b64_tr_b16 a[222:223], v238 offset:1792
    s_lshl_b32 s25, s4, 12
    v_mfma_f32_16x16x32_bf16 v[128:131], a[200:203], a[128:131], 0
    buffer_load_dwordx4 a[176:179], v248, s[8:11], s28 offen offset:3072 sc1
    s_add_u32 s39, s39, s25
    s_add_u32 s40, s40, s25
    v_mfma_f32_16x16x32_bf16 v[132:135], a[200:203], a[132:135], 0
    s_mov_b32 s38, 0x40004000
    s_mov_b32 s36, s6
    v_mfma_f32_16x16x32_bf16 v[136:139], a[200:203], a[136:139], 0
    buffer_load_dwordx4 a[180:183], v248, s[8:11], s29 offen offset:3072 sc1
    s_mov_b32 s26, 6
    v_mfma_f32_16x16x32_bf16 v[140:143], a[200:203], a[140:143], 0
    s_add_u32 m0, s31, 0
    s_add_u32 s24, s27, 0
    s_mov_b32 s52, s41
    v_mfma_f32_16x16x32_bf16 v[144:147], a[204:207], a[128:131], 0
    buffer_load_dwordx4 v245, s[12:15], s24 offen lds
    s_mov_b32 s53, s42
    v_mfma_f32_16x16x32_bf16 v[148:151], a[204:207], a[132:135], 0
    s_mov_b32 s54, 0x700000
    s_add_u32 s48, s20, 0x1c00000
    s_addc_u32 s49, s21, 0
    v_mfma_f32_16x16x32_bf16 v[152:155], a[204:207], a[136:139], 0
    buffer_store_dwordx4 v[32:35], v240, s[16:19], s80 offen sc1
    s_mov_b32 s50, 0x1c00000
    s_and_b32 s25, s3, 1
    v_mfma_f32_16x16x32_bf16 v[156:159], a[204:207], a[140:143], 0
    s_lshl1_add_u32 s47, s4, s25
    s_waitcnt lgkmcnt(0)
    v_mfma_f32_16x16x32_bf16 v[160:163], a[208:211], a[128:131], 0
    ds_read_b64_tr_b16 a[192:193], v246 offset:8192
    s_lshr_b32 s101, s3, 1
    v_mfma_f32_16x16x32_bf16 v[164:167], a[208:211], a[132:135], 0
    ds_read_b64_tr_b16 a[194:195], v246 offset:9216
    s_add_u32 s45, s5, s101
    s_sub_u32 s45, s45, 1
    v_mfma_f32_16x16x32_bf16 v[168:171], a[208:211], a[136:139], 0
    ds_read_b64_tr_b16 a[196:197], v238 offset:8192
    s_mul_i32 s45, s45, s5
    v_mfma_f32_16x16x32_bf16 v[172:175], a[208:211], a[140:143], 0
    ds_read_b64_tr_b16 a[198:199], v238 offset:9216
    s_lshl_b32 s100, s101, 14
    s_add_u32 s100, s100, 114688
    v_mfma_f32_16x16x32_bf16 v[176:179], a[212:215], a[128:131], 0
    ds_read_b64_tr_b16 a[200:201], v246 offset:8448
    s_mul_i32 s100, s100, s47
    v_mfma_f32_16x16x32_bf16 v[180:183], a[212:215], a[132:135], 0
    ds_read_b64_tr_b16 a[202:203], v246 offset:9472
    s_lshl_b32 s25, s45, 11
    v_mfma_f32_16x16x32_bf16 v[184:187], a[212:215], a[136:139], 0
    ds_read_b64_tr_b16 a[204:205], v238 offset:8448
    s_add_u32 s100, s100, s25
    s_lshl_b32 s46, s47, 9
    v_mfma_f32_16x16x32_bf16 v[188:191], a[212:215], a[140:143], 0
    ds_read_b64_tr_b16 a[206:207], v238 offset:9472
    s_mul_i32 s44, s47, 114688
    v_mfma_f32_16x16x32_bf16 v[192:195], a[216:219], a[128:131], 0
    buffer_load_dwordx4 a[184:187], v249, s[8:11], s28 offen offset:3072 sc1
    s_add_u32 s47, s44, 7168
    s_lshl_b32 s25, s45, 7
    v_mfma_f32_16x16x32_bf16 v[196:199], a[216:219], a[132:135], 0
    s_add_u32 s44, s44, s25
    s_lshl_b32 s45, s45, 18
    v_mfma_f32_16x16x32_bf16 v[200:203], a[216:219], a[136:139], 0
    buffer_load_dwordx4 a[188:191], v249, s[8:11], s29 offen offset:3072 sc1
    s_add_u32 s46, s46, s45
    v_mfma_f32_16x16x32_bf16 v[204:207], a[216:219], a[140:143], 0
    s_add_u32 m0, s31, 1024
    s_add_u32 s24, s27, 32768
    s_lshr_b32 s25, s3, 1
    v_mfma_f32_16x16x32_bf16 v[208:211], a[220:223], a[128:131], 0
    buffer_load_dwordx4 v245, s[12:15], s24 offen lds
    s_lshl_b32 s25, s25, 15
    v_mfma_f32_16x16x32_bf16 v[212:215], a[220:223], a[132:135], 0
    s_add_u32 s46, s46, s25
    s_mov_b32 s45, s43
    v_mfma_f32_16x16x32_bf16 v[216:219], a[220:223], a[136:139], 0
    s_add_u32 s28, s28, 4096
    s_and_b32 s28, s28, 32767
    buffer_store_dwordx4 v[36:39], v240, s[16:19], s81 offen sc1
    v_mfma_f32_16x16x32_bf16 v[220:223], a[220:223], a[140:143], 0
    s_add_u32 s29, s28, 32768
    v_accvgpr_write_b32 a0, 0
    s_waitcnt vmcnt(13) lgkmcnt(0)
    v_mfma_f32_16x16x32_bf16 v[96:99], a[192:195], a[144:147], v[96:99]
    ds_read_b64_tr_b16 a[208:209], v246 offset:8704
    s_load_dwordx2 s[56:57], s[0:1], 40
    v_accvgpr_write_b32 a1, 0
    v_mfma_f32_16x16x32_bf16 v[100:103], a[192:195], a[148:151], v[100:103]
    ds_read_b64_tr_b16 a[210:211], v246 offset:9728
    v_accvgpr_write_b32 a2, 0
    v_mfma_f32_16x16x32_bf16 v[104:107], a[192:195], a[152:155], v[104:107]
    ds_read_b64_tr_b16 a[212:213], v238 offset:8704
    v_accvgpr_write_b32 a3, 0
    v_mfma_f32_16x16x32_bf16 v[108:111], a[192:195], a[156:159], v[108:111]
    ds_read_b64_tr_b16 a[214:215], v238 offset:9728
    v_accvgpr_write_b32 a4, 0
    v_accvgpr_write_b32 a5, 0
    v_mfma_f32_16x16x32_bf16 v[112:115], a[196:199], a[144:147], v[112:115]
    ds_read_b64_tr_b16 a[216:217], v246 offset:8960
    v_accvgpr_write_b32 a6, 0
    v_mfma_f32_16x16x32_bf16 v[116:119], a[196:199], a[148:151], v[116:119]
    ds_read_b64_tr_b16 a[218:219], v246 offset:9984
    v_accvgpr_write_b32 a7, 0
    v_accvgpr_write_b32 a8, 0
    v_mfma_f32_16x16x32_bf16 v[120:123], a[196:199], a[152:155], v[120:123]
    ds_read_b64_tr_b16 a[220:221], v238 offset:8960
    v_accvgpr_write_b32 a9, 0
    v_mfma_f32_16x16x32_bf16 v[124:127], a[196:199], a[156:159], v[124:127]
    ds_read_b64_tr_b16 a[222:223], v238 offset:9984
    v_accvgpr_write_b32 a10, 0
    v_mfma_f32_16x16x32_bf16 v[128:131], a[200:203], a[144:147], v[128:131]
    buffer_load_dwordx4 a[128:131], v248, s[8:11], s28 offen offset:0 sc1
    v_accvgpr_write_b32 a11, 0
    v_accvgpr_write_b32 a12, 0
    v_mfma_f32_16x16x32_bf16 v[132:135], a[200:203], a[148:151], v[132:135]
    v_accvgpr_write_b32 a13, 0
    v_accvgpr_write_b32 a14, 0
    v_mfma_f32_16x16x32_bf16 v[136:139], a[200:203], a[152:155], v[136:139]
    buffer_load_dwordx4 a[132:135], v248, s[8:11], s29 offen offset:0 sc1
    v_accvgpr_write_b32 a15, 0
    v_mfma_f32_16x16x32_bf16 v[140:143], a[200:203], a[156:159], v[140:143]
    s_add_u32 m0, s31, 2048
    s_add_u32 s24, s27, 65536
    v_accvgpr_write_b32 a16, 0
    v_mfma_f32_16x16x32_bf16 v[144:147], a[204:207], a[144:147], v[144:147]
    buffer_load_dwordx4 v237, s[12:15], s24 offen lds
    v_accvgpr_write_b32 a17, 0
    v_mfma_f32_16x16x32_bf16 v[148:151], a[204:207], a[148:151], v[148:151]
    v_accvgpr_write_b32 a18, 0
    v_accvgpr_write_b32 a19, 0
    v_accvgpr_write_b32 a20, 0
    v_mfma_f32_16x16x32_bf16 v[152:155], a[204:207], a[152:155], v[152:155]
    buffer_store_dwordx4 v[40:43], v240, s[16:19], s82 offen sc1
    v_accvgpr_write_b32 a21, 0
    v_mfma_f32_16x16x32_bf16 v[156:159], a[204:207], a[156:159], v[156:159]
    v_accvgpr_write_b32 a22, 0
    s_waitcnt lgkmcnt(0)
    v_mfma_f32_16x16x32_bf16 v[160:163], a[208:211], a[144:147], v[160:163]
    ds_read_b64_tr_b16 a[192:193], v246 offset:16384
    v_accvgpr_write_b32 a23, 0
    v_accvgpr_write_b32 a24, 0
    v_mfma_f32_16x16x32_bf16 v[164:167], a[208:211], a[148:151], v[164:167]
    ds_read_b64_tr_b16 a[194:195], v246 offset:17408
    v_accvgpr_write_b32 a25, 0
    v_mfma_f32_16x16x32_bf16 v[168:171], a[208:211], a[152:155], v[168:171]
    ds_read_b64_tr_b16 a[196:197], v238 offset:16384
    v_accvgpr_write_b32 a26, 0
    v_mfma_f32_16x16x32_bf16 v[172:175], a[208:211], a[156:159], v[172:175]
    ds_read_b64_tr_b16 a[198:199], v238 offset:17408
    v_accvgpr_write_b32 a27, 0
    v_accvgpr_write_b32 a28, 0
    v_mfma_f32_16x16x32_bf16 v[176:179], a[212:215], a[144:147], v[176:179]
    ds_read_b64_tr_b16 a[200:201], v246 offset:16640
    v_accvgpr_write_b32 a29, 0
    v_mfma_f32_16x16x32_bf16 v[180:183], a[212:215], a[148:151], v[180:183]
    ds_read_b64_tr_b16 a[202:203], v246 offset:17664
    v_accvgpr_write_b32 a30, 0
    v_accvgpr_write_b32 a31, 0
    v_mfma_f32_16x16x32_bf16 v[184:187], a[212:215], a[152:155], v[184:187]
    ds_read_b64_tr_b16 a[204:205], v238 offset:16640
    v_accvgpr_write_b32 a32, 0
    v_mfma_f32_16x16x32_bf16 v[188:191], a[212:215], a[156:159], v[188:191]
    ds_read_b64_tr_b16 a[206:207], v238 offset:17664
    v_accvgpr_write_b32 a33, 0
    v_mfma_f32_16x16x32_bf16 v[192:195], a[216:219], a[144:147], v[192:195]
    buffer_load_dwordx4 a[136:139], v249, s[8:11], s28 offen offset:0 sc1
    v_accvgpr_write_b32 a34, 0
    v_accvgpr_write_b32 a35, 0
    v_mfma_f32_16x16x32_bf16 v[196:199], a[216:219], a[148:151], v[196:199]
    v_accvgpr_write_b32 a36, 0
    v_accvgpr_write_b32 a37, 0
    v_mfma_f32_16x16x32_bf16 v[200:203], a[216:219], a[152:155], v[200:203]
    buffer_load_dwordx4 a[140:143], v249, s[8:11], s29 offen offset:0 sc1
    v_accvgpr_write_b32 a38, 0
    v_mfma_f32_16x16x32_bf16 v[204:207], a[216:219], a[156:159], v[204:207]
    s_add_u32 m0, s31, 3072
    s_add_u32 s24, s27, 98304
    v_accvgpr_write_b32 a39, 0
    v_mfma_f32_16x16x32_bf16 v[208:211], a[220:223], a[144:147], v[208:211]
    buffer_load_dwordx4 v237, s[12:15], s24 offen lds
    v_accvgpr_write_b32 a40, 0
    v_mfma_f32_16x16x32_bf16 v[212:215], a[220:223], a[148:151], v[212:215]
    v_accvgpr_write_b32 a41, 0
    v_accvgpr_write_b32 a42, 0
    v_accvgpr_write_b32 a43, 0
    v_mfma_f32_16x16x32_bf16 v[216:219], a[220:223], a[152:155], v[216:219]
    buffer_store_dwordx4 v[44:47], v240, s[16:19], s83 offen sc1
    v_accvgpr_write_b32 a44, 0
    v_mfma_f32_16x16x32_bf16 v[220:223], a[220:223], a[156:159], v[220:223]
    v_accvgpr_write_b32 a45, 0
    s_waitcnt vmcnt(16) lgkmcnt(0)
    v_mfma_f32_16x16x32_bf16 v[96:99], a[192:195], a[160:163], v[96:99]
    ds_read_b64_tr_b16 a[208:209], v246 offset:16896
    v_accvgpr_write_b32 a46, 0
    v_accvgpr_write_b32 a47, 0
    v_mfma_f32_16x16x32_bf16 v[100:103], a[192:195], a[164:167], v[100:103]
    ds_read_b64_tr_b16 a[210:211], v246 offset:17920
    v_accvgpr_write_b32 a48, 0
    v_mfma_f32_16x16x32_bf16 v[104:107], a[192:195], a[168:171], v[104:107]
    ds_read_b64_tr_b16 a[212:213], v238 offset:16896
    v_accvgpr_write_b32 a49, 0
    v_accvgpr_write_b32 a50, 0
    v_mfma_f32_16x16x32_bf16 v[108:111], a[192:195], a[172:175], v[108:111]
    ds_read_b64_tr_b16 a[214:215], v238 offset:17920
    v_accvgpr_write_b32 a51, 0
    v_mfma_f32_16x16x32_bf16 v[112:115], a[196:199], a[160:163], v[112:115]
    ds_read_b64_tr_b16 a[216:217], v246 offset:17152
    v_accvgpr_write_b32 a52, 0
    v_mfma_f32_16x16x32_bf16 v[116:119], a[196:199], a[164:167], v[116:119]
    ds_read_b64_tr_b16 a[218:219], v246 offset:18176
    v_accvgpr_write_b32 a53, 0
    v_accvgpr_write_b32 a54, 0
    v_mfma_f32_16x16x32_bf16 v[120:123], a[196:199], a[168:171], v[120:123]
    ds_read_b64_tr_b16 a[220:221], v238 offset:17152
    v_accvgpr_write_b32 a55, 0
    v_mfma_f32_16x16x32_bf16 v[124:127], a[196:199], a[172:175], v[124:127]
    ds_read_b64_tr_b16 a[222:223], v238 offset:18176
    v_accvgpr_write_b32 a56, 0
    v_accvgpr_write_b32 a57, 0
    v_mfma_f32_16x16x32_bf16 v[128:131], a[200:203], a[160:163], v[128:131]
    buffer_load_dwordx4 a[144:147], v248, s[8:11], s28 offen offset:1024 sc1
    v_accvgpr_write_b32 a58, 0
    v_mfma_f32_16x16x32_bf16 v[132:135], a[200:203], a[164:167], v[132:135]
    v_accvgpr_write_b32 a59, 0
    v_accvgpr_write_b32 a60, 0
    v_mfma_f32_16x16x32_bf16 v[136:139], a[200:203], a[168:171], v[136:139]
    buffer_load_dwordx4 a[148:151], v248, s[8:11], s29 offen offset:1024 sc1
    v_accvgpr_write_b32 a61, 0
    v_mfma_f32_16x16x32_bf16 v[140:143], a[200:203], a[172:175], v[140:143]
    s_add_u32 m0, s31, 4096
    s_add_u32 s24, s27, 131072
    v_accvgpr_write_b32 a62, 0
    v_mfma_f32_16x16x32_bf16 v[144:147], a[204:207], a[160:163], v[144:147]
    buffer_load_dwordx4 v245, s[12:15], s24 offen lds
    v_accvgpr_write_b32 a63, 0
    v_mfma_f32_16x16x32_bf16 v[148:151], a[204:207], a[164:167], v[148:151]
    v_accvgpr_write_b32 a64, 0
    v_accvgpr_write_b32 a65, 0
    v_accvgpr_write_b32 a66, 0
    v_mfma_f32_16x16x32_bf16 v[152:155], a[204:207], a[168:171], v[152:155]
    buffer_store_dwordx4 v[48:51], v240, s[16:19], s84 offen sc1
    v_accvgpr_write_b32 a67, 0
    v_mfma_f32_16x16x32_bf16 v[156:159], a[204:207], a[172:175], v[156:159]
    v_accvgpr_write_b32 a68, 0
    s_waitcnt lgkmcnt(0)
    v_mfma_f32_16x16x32_bf16 v[160:163], a[208:211], a[160:163], v[160:163]
    ds_read_b64_tr_b16 a[192:193], v246 offset:24576
    v_accvgpr_write_b32 a69, 0
    v_accvgpr_write_b32 a70, 0
    v_mfma_f32_16x16x32_bf16 v[164:167], a[208:211], a[164:167], v[164:167]
    ds_read_b64_tr_b16 a[194:195], v246 offset:25600
    v_accvgpr_write_b32 a71, 0
    v_mfma_f32_16x16x32_bf16 v[168:171], a[208:211], a[168:171], v[168:171]
    ds_read_b64_tr_b16 a[196:197], v238 offset:24576
    v_accvgpr_write_b32 a72, 0
    v_accvgpr_write_b32 a73, 0
    v_mfma_f32_16x16x32_bf16 v[172:175], a[208:211], a[172:175], v[172:175]
    ds_read_b64_tr_b16 a[198:199], v238 offset:25600
    v_accvgpr_write_b32 a74, 0
    v_mfma_f32_16x16x32_bf16 v[176:179], a[212:215], a[160:163], v[176:179]
    ds_read_b64_tr_b16 a[200:201], v246 offset:24832
    v_accvgpr_write_b32 a75, 0
    v_mfma_f32_16x16x32_bf16 v[180:183], a[212:215], a[164:167], v[180:183]
    ds_read_b64_tr_b16 a[202:203], v246 offset:25856
    v_accvgpr_write_b32 a76, 0
    v_accvgpr_write_b32 a77, 0
    v_mfma_f32_16x16x32_bf16 v[184:187], a[212:215], a[168:171], v[184:187]
    ds_read_b64_tr_b16 a[204:205], v238 offset:24832
    v_accvgpr_write_b32 a78, 0
    v_mfma_f32_16x16x32_bf16 v[188:191], a[212:215], a[172:175], v[188:191]
    ds_read_b64_tr_b16 a[206:207], v238 offset:25856
    v_accvgpr_write_b32 a79, 0
    v_accvgpr_write_b32 a80, 0
    v_mfma_f32_16x16x32_bf16 v[192:195], a[216:219], a[160:163], v[192:195]
    buffer_load_dwordx4 a[152:155], v249, s[8:11], s28 offen offset:1024 sc1
    v_accvgpr_write_b32 a81, 0
    v_mfma_f32_16x16x32_bf16 v[196:199], a[216:219], a[164:167], v[196:199]
    v_accvgpr_write_b32 a82, 0
    v_accvgpr_write_b32 a83, 0
    v_mfma_f32_16x16x32_bf16 v[200:203], a[216:219], a[168:171], v[200:203]
    buffer_load_dwordx4 a[156:159], v249, s[8:11], s29 offen offset:1024 sc1
    v_accvgpr_write_b32 a84, 0
    v_mfma_f32_16x16x32_bf16 v[204:207], a[216:219], a[172:175], v[204:207]
    s_add_u32 m0, s31, 5120
    s_add_u32 s24, s27, 163840
    v_accvgpr_write_b32 a85, 0
    v_mfma_f32_16x16x32_bf16 v[208:211], a[220:223], a[160:163], v[208:211]
    buffer_load_dwordx4 v245, s[12:15], s24 offen lds
    v_accvgpr_write_b32 a86, 0
    v_accvgpr_write_b32 a87, 0
    v_mfma_f32_16x16x32_bf16 v[212:215], a[220:223], a[164:167], v[212:215]
    v_accvgpr_write_b32 a88, 0
    v_accvgpr_write_b32 a89, 0
    v_mfma_f32_16x16x32_bf16 v[216:219], a[220:223], a[168:171], v[216:219]
    s_add_u32 s30, s30, 32768
    buffer_store_dwordx4 v[52:55], v240, s[16:19], s85 offen sc1
    v_mfma_f32_16x16x32_bf16 v[220:223], a[220:223], a[172:175], v[220:223]
    s_cmp_ge_u32 s30, 163840
    s_cselect_b32 s30, 65536, s30
    s_waitcnt vmcnt(18) lgkmcnt(0)
    v_mfma_f32_16x16x32_bf16 v[96:99], a[192:195], a[176:179], v[96:99]
    ds_read_b64_tr_b16 a[208:209], v246 offset:25088
    v_accvgpr_write_b32 a90, 0
    v_accvgpr_write_b32 a91, 0
    v_mfma_f32_16x16x32_bf16 v[100:103], a[192:195], a[180:183], v[100:103]
    ds_read_b64_tr_b16 a[210:211], v246 offset:26112
    v_accvgpr_write_b32 a92, 0
    v_mfma_f32_16x16x32_bf16 v[104:107], a[192:195], a[184:187], v[104:107]
    ds_read_b64_tr_b16 a[212:213], v238 offset:25088
    v_accvgpr_write_b32 a93, 0
    v_mfma_f32_16x16x32_bf16 v[108:111], a[192:195], a[188:191], v[108:111]
    ds_read_b64_tr_b16 a[214:215], v238 offset:26112
    v_accvgpr_write_b32 a94, 0
    v_accvgpr_write_b32 a95, 0
    v_mfma_f32_16x16x32_bf16 v[112:115], a[196:199], a[176:179], v[112:115]
    ds_read_b64_tr_b16 a[216:217], v246 offset:25344
    v_accvgpr_write_b32 a96, 0
    v_mfma_f32_16x16x32_bf16 v[116:119], a[196:199], a[180:183], v[116:119]
    ds_read_b64_tr_b16 a[218:219], v246 offset:26368
    v_accvgpr_write_b32 a97, 0
    v_accvgpr_write_b32 a98, 0
    v_mfma_f32_16x16x32_bf16 v[120:123], a[196:199], a[184:187], v[120:123]
    ds_read_b64_tr_b16 a[220:221], v238 offset:25344
    v_accvgpr_write_b32 a99, 0
    v_mfma_f32_16x16x32_bf16 v[124:127], a[196:199], a[188:191], v[124:127]
    ds_read_b64_tr_b16 a[222:223], v238 offset:26368
    v_accvgpr_write_b32 a100, 0
    v_mfma_f32_16x16x32_bf16 v[128:131], a[200:203], a[176:179], v[128:131]
    buffer_load_dwordx4 a[160:163], v248, s[8:11], s28 offen offset:2048 sc1
    v_accvgpr_write_b32 a101, 0
    v_accvgpr_write_b32 a102, 0
    v_mfma_f32_16x16x32_bf16 v[132:135], a[200:203], a[180:183], v[132:135]
    v_accvgpr_write_b32 a103, 0
    v_accvgpr_write_b32 a104, 0
    v_mfma_f32_16x16x32_bf16 v[136:139], a[200:203], a[184:187], v[136:139]
    buffer_load_dwordx4 a[164:167], v248, s[8:11], s29 offen offset:2048 sc1
    v_accvgpr_write_b32 a105, 0
    v_mfma_f32_16x16x32_bf16 v[140:143], a[200:203], a[188:191], v[140:143]
    s_add_u32 m0, s31, 6144
    s_add_u32 s24, s27, 196608
    v_accvgpr_write_b32 a106, 0
    v_mfma_f32_16x16x32_bf16 v[144:147], a[204:207], a[176:179], v[144:147]
    buffer_load_dwordx4 v237, s[12:15], s24 offen lds
    v_accvgpr_write_b32 a107, 0
    v_mfma_f32_16x16x32_bf16 v[148:151], a[204:207], a[180:183], v[148:151]
    v_accvgpr_write_b32 a108, 0
    v_accvgpr_write_b32 a109, 0
    v_accvgpr_write_b32 a110, 0
    v_mfma_f32_16x16x32_bf16 v[152:155], a[204:207], a[184:187], v[152:155]
    buffer_store_dwordx4 v[56:59], v240, s[16:19], s86 offen sc1
    v_accvgpr_write_b32 a111, 0
    v_mfma_f32_16x16x32_bf16 v[156:159], a[204:207], a[188:191], v[156:159]
    s_waitcnt vmcnt(49) lgkmcnt(0)
    s_barrier
    v_add_u32 v246, s30, v247
    v_mfma_f32_16x16x32_bf16 v[160:163], a[208:211], a[176:179], v[160:163]
    v_xor_b32_e64 v238, 16, v246
    ds_read_b64_tr_b16 a[192:193], v246 offset:0
    v_accvgpr_write_b32 a112, 0
    v_mfma_f32_16x16x32_bf16 v[164:167], a[208:211], a[180:183], v[164:167]
    ds_read_b64_tr_b16 a[194:195], v246 offset:1024
    v_accvgpr_write_b32 a113, 0
    v_mfma_f32_16x16x32_bf16 v[168:171], a[208:211], a[184:187], v[168:171]
    ds_read_b64_tr_b16 a[196:197], v238 offset:0
    v_accvgpr_write_b32 a114, 0
    v_mfma_f32_16x16x32_bf16 v[172:175], a[208:211], a[188:191], v[172:175]
    ds_read_b64_tr_b16 a[198:199], v238 offset:1024
    v_accvgpr_write_b32 a115, 0
    v_accvgpr_write_b32 a116, 0
    v_mfma_f32_16x16x32_bf16 v[176:179], a[212:215], a[176:179], v[176:179]
    ds_read_b64_tr_b16 a[200:201], v246 offset:256
    v_accvgpr_write_b32 a117, 0
    v_mfma_f32_16x16x32_bf16 v[180:183], a[212:215], a[180:183], v[180:183]
    ds_read_b64_tr_b16 a[202:203], v246 offset:1280
    v_accvgpr_write_b32 a118, 0
    v_accvgpr_write_b32 a119, 0
    v_mfma_f32_16x16x32_bf16 v[184:187], a[212:215], a[184:187], v[184:187]
    ds_read_b64_tr_b16 a[204:205], v238 offset:256
    buffer_store_dwordx4 v[60:63], v240, s[16:19], s87 offen sc1
    v_mfma_f32_16x16x32_bf16 v[188:191], a[212:215], a[188:191], v[188:191]
    ds_read_b64_tr_b16 a[206:207], v238 offset:1280
    v_accvgpr_write_b32 a120, 0
    v_accvgpr_write_b32 a121, 0
    v_mfma_f32_16x16x32_bf16 v[192:195], a[216:219], a[176:179], v[192:195]
    buffer_load_dwordx4 a[168:171], v249, s[8:11], s28 offen offset:2048 sc1
    v_accvgpr_write_b32 a122, 0
    v_mfma_f32_16x16x32_bf16 v[196:199], a[216:219], a[180:183], v[196:199]
    s_lshl2_add_u32 s80, s2, s3
    s_mul_i32 s80, s80, 12288
    s_add_u32 s80, s80, 0x1000000
    v_mov_b32 v0, -1
    v_mov_b32 v1, -1
    v_mov_b32 v2, -1
    v_mov_b32_e64 v3, -1
    v_mfma_f32_16x16x32_bf16 v[200:203], a[216:219], a[184:187], v[200:203]
    buffer_load_dwordx4 a[172:175], v249, s[8:11], s29 offen offset:2048 sc1
    v_accvgpr_write_b32 a123, 0
    v_accvgpr_write_b32 a124, 0
    v_mfma_f32_16x16x32_bf16 v[204:207], a[216:219], a[188:191], v[204:207]
    s_add_u32 m0, s31, 7168
    s_add_u32 s24, s27, 229376
    v_mfma_f32_16x16x32_bf16 v[208:211], a[220:223], a[176:179], v[208:211]
    buffer_load_dwordx4 v237, s[12:15], s24 offen lds
    v_accvgpr_write_b32 a125, 0
    v_accvgpr_write_b32 a126, 0
    v_mfma_f32_16x16x32_bf16 v[212:215], a[220:223], a[180:183], v[212:215]
    s_add_u32 s27, s27, 1048576
    s_and_b32 s27, s27, 0x407fffff
    v_mfma_f32_16x16x32_bf16 v[216:219], a[220:223], a[184:187], v[216:219]
    s_cmp_eq_u32 s27, s7
    s_cselect_b32 s27, s43, s27
    v_accvgpr_write_b32 a127, 0
    v_mfma_f32_16x16x32_bf16 v[220:223], a[220:223], a[188:191], v[220:223]
    s_add_u32 s31, s31, 32768
    s_cmp_ge_u32 s31, 163840
    s_cselect_b32 s24, 98304, 0
    s_sub_u32 s31, s31, s24
.p2align 3
ka_qp:
    s_waitcnt vmcnt(15) lgkmcnt(0)
    v_mfma_f32_16x16x32_bf16 v[96:99], a[192:195], a[128:131], v[96:99]
    ds_read_b64_tr_b16 a[208:209], v246 offset:512
    v_mfma_f32_16x16x32_bf16 v[100:103], a[192:195], a[132:135], v[100:103]
    ds_read_b64_tr_b16 a[210:211], v246 offset:1536
    v_mfma_f32_16x16x32_bf16 v[104:107], a[192:195], a[136:139], v[104:107]
    ds_read_b64_tr_b16 a[212:213], v238 offset:512
    v_mfma_f32_16x16x32_bf16 v[108:111], a[192:195], a[140:143], v[108:111]
    ds_read_b64_tr_b16 a[214:215], v238 offset:1536
    v_mfma_f32_16x16x32_bf16 v[112:115], a[196:199], a[128:131], v[112:115]
    ds_read_b64_tr_b16 a[216:217], v246 offset:768
    v_mfma_f32_16x16x32_bf16 v[116:119], a[196:199], a[132:135], v[116:119]
    ds_read_b64_tr_b16 a[218:219], v246 offset:1792
    v_mfma_f32_16x16x32_bf16 v[120:123], a[196:199], a[136:139], v[120:123]
    ds_read_b64_tr_b16 a[220:221], v238 offset:768
    v_mfma_f32_16x16x32_bf16 v[124:127], a[196:199], a[140:143], v[124:127]
    ds_read_b64_tr_b16 a[222:223], v238 offset:1792
    v_mfma_f32_16x16x32_bf16 v[128:131], a[200:203], a[128:131], v[128:131]
    buffer_load_dwordx4 a[176:179], v248, s[8:11], s28 offen offset:3072 sc1
    s_cmp_eq_u32 s26, 1
    s_cselect_b32 s41, s35, s43
    buffer_load_dword v254, off, s[88:91], s41 sc1
    v_mfma_f32_16x16x32_bf16 v[132:135], a[200:203], a[132:135], v[132:135]
    v_mfma_f32_16x16x32_bf16 v[136:139], a[200:203], a[136:139], v[136:139]
    buffer_load_dwordx4 a[180:183], v248, s[8:11], s29 offen offset:3072 sc1
    v_mfma_f32_16x16x32_bf16 v[140:143], a[200:203], a[140:143], v[140:143]
    s_add_u32 m0, s31, 0
    s_add_u32 s24, s27, 0
    v_mfma_f32_16x16x32_bf16 v[144:147], a[204:207], a[128:131], v[144:147]
    buffer_load_dwordx4 v245, s[12:15], s24 offen lds
    v_mfma_f32_16x16x32_bf16 v[148:151], a[204:207], a[132:135], v[148:151]
    v_mfma_f32_16x16x32_bf16 v[152:155], a[204:207], a[136:139], v[152:155]
    v_mfma_f32_16x16x32_bf16 v[156:159], a[204:207], a[140:143], v[156:159]
    s_waitcnt lgkmcnt(0)
    v_mfma_f32_16x16x32_bf16 v[160:163], a[208:211], a[128:131], v[160:163]
    ds_read_b64_tr_b16 a[192:193], v246 offset:8192
    v_mfma_f32_16x16x32_bf16 v[164:167], a[208:211], a[132:135], v[164:167]
    ds_read_b64_tr_b16 a[194:195], v246 offset:9216
    v_mfma_f32_16x16x32_bf16 v[168:171], a[208:211], a[136:139], v[168:171]
    ds_read_b64_tr_b16 a[196:197], v238 offset:8192
    v_mfma_f32_16x16x32_bf16 v[172:175], a[208:211], a[140:143], v[172:175]
    ds_read_b64_tr_b16 a[198:199], v238 offset:9216
    v_mfma_f32_16x16x32_bf16 v[176:179], a[212:215], a[128:131], v[176:179]
    ds_read_b64_tr_b16 a[200:201], v246 offset:8448
    v_mfma_f32_16x16x32_bf16 v[180:183], a[212:215], a[132:135], v[180:183]
    ds_read_b64_tr_b16 a[202:203], v246 offset:9472
    v_mfma_f32_16x16x32_bf16 v[184:187], a[212:215], a[136:139], v[184:187]
    ds_read_b64_tr_b16 a[204:205], v238 offset:8448
    v_mfma_f32_16x16x32_bf16 v[188:191], a[212:215], a[140:143], v[188:191]
    ds_read_b64_tr_b16 a[206:207], v238 offset:9472
    v_mfma_f32_16x16x32_bf16 v[192:195], a[216:219], a[128:131], v[192:195]
    buffer_load_dwordx4 a[184:187], v249, s[8:11], s28 offen offset:3072 sc1
    v_mfma_f32_16x16x32_bf16 v[196:199], a[216:219], a[132:135], v[196:199]
    v_mfma_f32_16x16x32_bf16 v[200:203], a[216:219], a[136:139], v[200:203]
    buffer_load_dwordx4 a[188:191], v249, s[8:11], s29 offen offset:3072 sc1
    v_mfma_f32_16x16x32_bf16 v[204:207], a[216:219], a[140:143], v[204:207]
    s_add_u32 m0, s31, 1024
    s_add_u32 s24, s27, 32768
    v_mfma_f32_16x16x32_bf16 v[208:211], a[220:223], a[128:131], v[208:211]
    buffer_load_dwordx4 v245, s[12:15], s24 offen lds
    v_mfma_f32_16x16x32_bf16 v[212:215], a[220:223], a[132:135], v[212:215]
    v_mfma_f32_16x16x32_bf16 v[216:219], a[220:223], a[136:139], v[216:219]
    s_add_u32 s28, s28, 4096
    s_and_b32 s28, s28, 32767
    v_mfma_f32_16x16x32_bf16 v[220:223], a[220:223], a[140:143], v[220:223]
    s_add_u32 s29, s28, 32768
    s_waitcnt vmcnt(16) lgkmcnt(0)
    v_mfma_f32_16x16x32_bf16 v[96:99], a[192:195], a[144:147], v[96:99]
    ds_read_b64_tr_b16 a[208:209], v246 offset:8704
    v_mfma_f32_16x16x32_bf16 v[100:103], a[192:195], a[148:151], v[100:103]
    ds_read_b64_tr_b16 a[210:211], v246 offset:9728
    v_mfma_f32_16x16x32_bf16 v[104:107], a[192:195], a[152:155], v[104:107]
    ds_read_b64_tr_b16 a[212:213], v238 offset:8704
    v_mfma_f32_16x16x32_bf16 v[108:111], a[192:195], a[156:159], v[108:111]
    ds_read_b64_tr_b16 a[214:215], v238 offset:9728
    v_mfma_f32_16x16x32_bf16 v[112:115], a[196:199], a[144:147], v[112:115]
    ds_read_b64_tr_b16 a[216:217], v246 offset:8960
    v_mfma_f32_16x16x32_bf16 v[116:119], a[196:199], a[148:151], v[116:119]
    ds_read_b64_tr_b16 a[218:219], v246 offset:9984
    v_mfma_f32_16x16x32_bf16 v[120:123], a[196:199], a[152:155], v[120:123]
    ds_read_b64_tr_b16 a[220:221], v238 offset:8960
    v_mfma_f32_16x16x32_bf16 v[124:127], a[196:199], a[156:159], v[124:127]
    ds_read_b64_tr_b16 a[222:223], v238 offset:9984
    v_mfma_f32_16x16x32_bf16 v[128:131], a[200:203], a[144:147], v[128:131]
    buffer_load_dwordx4 a[128:131], v248, s[8:11], s28 offen offset:0 sc1
    v_mfma_f32_16x16x32_bf16 v[132:135], a[200:203], a[148:151], v[132:135]
    v_mfma_f32_16x16x32_bf16 v[136:139], a[200:203], a[152:155], v[136:139]
    buffer_load_dwordx4 a[132:135], v248, s[8:11], s29 offen offset:0 sc1
    v_mfma_f32_16x16x32_bf16 v[140:143], a[200:203], a[156:159], v[140:143]
    s_add_u32 m0, s31, 2048
    s_add_u32 s24, s27, 65536
    v_mfma_f32_16x16x32_bf16 v[144:147], a[204:207], a[144:147], v[144:147]
    buffer_load_dwordx4 v237, s[12:15], s24 offen lds
    v_mfma_f32_16x16x32_bf16 v[148:151], a[204:207], a[148:151], v[148:151]
    buffer_store_dwordx4 v[0:3], v240, s[48:51], s80 offen sc1
    s_add_u32 s80, s80, 1024
    v_mfma_f32_16x16x32_bf16 v[152:155], a[204:207], a[152:155], v[152:155]
    v_mfma_f32_16x16x32_bf16 v[156:159], a[204:207], a[156:159], v[156:159]
    s_waitcnt lgkmcnt(0)
    v_mfma_f32_16x16x32_bf16 v[160:163], a[208:211], a[144:147], v[160:163]
    ds_read_b64_tr_b16 a[192:193], v246 offset:16384
    v_mfma_f32_16x16x32_bf16 v[164:167], a[208:211], a[148:151], v[164:167]
    ds_read_b64_tr_b16 a[194:195], v246 offset:17408
    v_mfma_f32_16x16x32_bf16 v[168:171], a[208:211], a[152:155], v[168:171]
    ds_read_b64_tr_b16 a[196:197], v238 offset:16384
    v_mfma_f32_16x16x32_bf16 v[172:175], a[208:211], a[156:159], v[172:175]
    ds_read_b64_tr_b16 a[198:199], v238 offset:17408
    v_mfma_f32_16x16x32_bf16 v[176:179], a[212:215], a[144:147], v[176:179]
    ds_read_b64_tr_b16 a[200:201], v246 offset:16640
    v_mfma_f32_16x16x32_bf16 v[180:183], a[212:215], a[148:151], v[180:183]
    ds_read_b64_tr_b16 a[202:203], v246 offset:17664
    v_mfma_f32_16x16x32_bf16 v[184:187], a[212:215], a[152:155], v[184:187]
    ds_read_b64_tr_b16 a[204:205], v238 offset:16640
    v_mfma_f32_16x16x32_bf16 v[188:191], a[212:215], a[156:159], v[188:191]
    ds_read_b64_tr_b16 a[206:207], v238 offset:17664
    v_mfma_f32_16x16x32_bf16 v[192:195], a[216:219], a[144:147], v[192:195]
    buffer_load_dwordx4 a[136:139], v249, s[8:11], s28 offen offset:0 sc1
    v_mfma_f32_16x16x32_bf16 v[196:199], a[216:219], a[148:151], v[196:199]
    v_mfma_f32_16x16x32_bf16 v[200:203], a[216:219], a[152:155], v[200:203]
    buffer_load_dwordx4 a[140:143], v249, s[8:11], s29 offen offset:0 sc1
    v_mfma_f32_16x16x32_bf16 v[204:207], a[216:219], a[156:159], v[204:207]
    s_add_u32 m0, s31, 3072
    s_add_u32 s24, s27, 98304
    v_mfma_f32_16x16x32_bf16 v[208:211], a[220:223], a[144:147], v[208:211]
    buffer_load_dwordx4 v237, s[12:15], s24 offen lds
    v_mfma_f32_16x16x32_bf16 v[212:215], a[220:223], a[148:151], v[212:215]
    v_mfma_f32_16x16x32_bf16 v[216:219], a[220:223], a[152:155], v[216:219]
    v_mfma_f32_16x16x32_bf16 v[220:223], a[220:223], a[156:159], v[220:223]
    s_waitcnt vmcnt(15) lgkmcnt(0)
    v_mfma_f32_16x16x32_bf16 v[96:99], a[192:195], a[160:163], v[96:99]
    ds_read_b64_tr_b16 a[208:209], v246 offset:16896
    v_mfma_f32_16x16x32_bf16 v[100:103], a[192:195], a[164:167], v[100:103]
    ds_read_b64_tr_b16 a[210:211], v246 offset:17920
    v_mfma_f32_16x16x32_bf16 v[104:107], a[192:195], a[168:171], v[104:107]
    ds_read_b64_tr_b16 a[212:213], v238 offset:16896
    v_mfma_f32_16x16x32_bf16 v[108:111], a[192:195], a[172:175], v[108:111]
    ds_read_b64_tr_b16 a[214:215], v238 offset:17920
    v_mfma_f32_16x16x32_bf16 v[112:115], a[196:199], a[160:163], v[112:115]
    ds_read_b64_tr_b16 a[216:217], v246 offset:17152
    v_mfma_f32_16x16x32_bf16 v[116:119], a[196:199], a[164:167], v[116:119]
    ds_read_b64_tr_b16 a[218:219], v246 offset:18176
    v_mfma_f32_16x16x32_bf16 v[120:123], a[196:199], a[168:171], v[120:123]
    ds_read_b64_tr_b16 a[220:221], v238 offset:17152
    v_mfma_f32_16x16x32_bf16 v[124:127], a[196:199], a[172:175], v[124:127]
    ds_read_b64_tr_b16 a[222:223], v238 offset:18176
    v_mfma_f32_16x16x32_bf16 v[128:131], a[200:203], a[160:163], v[128:131]
    buffer_load_dwordx4 a[144:147], v248, s[8:11], s28 offen offset:1024 sc1
    v_mfma_f32_16x16x32_bf16 v[132:135], a[200:203], a[164:167], v[132:135]
    v_mfma_f32_16x16x32_bf16 v[136:139], a[200:203], a[168:171], v[136:139]
    buffer_load_dwordx4 a[148:151], v248, s[8:11], s29 offen offset:1024 sc1
    v_mfma_f32_16x16x32_bf16 v[140:143], a[200:203], a[172:175], v[140:143]
    s_add_u32 m0, s31, 4096
    s_add_u32 s24, s27, 131072
    v_mfma_f32_16x16x32_bf16 v[144:147], a[204:207], a[160:163], v[144:147]
    buffer_load_dwordx4 v245, s[12:15], s24 offen lds
    v_mfma_f32_16x16x32_bf16 v[148:151], a[204:207], a[164:167], v[148:151]
    v_mfma_f32_16x16x32_bf16 v[152:155], a[204:207], a[168:171], v[152:155]
    v_mfma_f32_16x16x32_bf16 v[156:159], a[204:207], a[172:175], v[156:159]
    s_waitcnt lgkmcnt(0)
    v_mfma_f32_16x16x32_bf16 v[160:163], a[208:211], a[160:163], v[160:163]
    ds_read_b64_tr_b16 a[192:193], v246 offset:24576
    v_mfma_f32_16x16x32_bf16 v[164:167], a[208:211], a[164:167], v[164:167]
    ds_read_b64_tr_b16 a[194:195], v246 offset:25600
    v_mfma_f32_16x16x32_bf16 v[168:171], a[208:211], a[168:171], v[168:171]
    ds_read_b64_tr_b16 a[196:197], v238 offset:24576
    v_mfma_f32_16x16x32_bf16 v[172:175], a[208:211], a[172:175], v[172:175]
    ds_read_b64_tr_b16 a[198:199], v238 offset:25600
    v_mfma_f32_16x16x32_bf16 v[176:179], a[212:215], a[160:163], v[176:179]
    ds_read_b64_tr_b16 a[200:201], v246 offset:24832
    v_mfma_f32_16x16x32_bf16 v[180:183], a[212:215], a[164:167], v[180:183]
    ds_read_b64_tr_b16 a[202:203], v246 offset:25856
    v_mfma_f32_16x16x32_bf16 v[184:187], a[212:215], a[168:171], v[184:187]
    ds_read_b64_tr_b16 a[204:205], v238 offset:24832
    v_mfma_f32_16x16x32_bf16 v[188:191], a[212:215], a[172:175], v[188:191]
    ds_read_b64_tr_b16 a[206:207], v238 offset:25856
    v_mfma_f32_16x16x32_bf16 v[192:195], a[216:219], a[160:163], v[192:195]
    buffer_load_dwordx4 a[152:155], v249, s[8:11], s28 offen offset:1024 sc1
    v_mfma_f32_16x16x32_bf16 v[196:199], a[216:219], a[164:167], v[196:199]
    v_mfma_f32_16x16x32_bf16 v[200:203], a[216:219], a[168:171], v[200:203]
    buffer_load_dwordx4 a[156:159], v249, s[8:11], s29 offen offset:1024 sc1
    v_mfma_f32_16x16x32_bf16 v[204:207], a[216:219], a[172:175], v[204:207]
    s_add_u32 m0, s31, 5120
    s_add_u32 s24, s27, 163840
    v_mfma_f32_16x16x32_bf16 v[208:211], a[220:223], a[160:163], v[208:211]
    buffer_load_dwordx4 v245, s[12:15], s24 offen lds
    v_mfma_f32_16x16x32_bf16 v[212:215], a[220:223], a[164:167], v[212:215]
    buffer_store_dwordx4 v[0:3], v240, s[48:51], s80 offen sc1
    s_add_u32 s80, s80, 1024
    v_mfma_f32_16x16x32_bf16 v[216:219], a[220:223], a[168:171], v[216:219]
    s_add_u32 s30, s30, 32768
    v_mfma_f32_16x16x32_bf16 v[220:223], a[220:223], a[172:175], v[220:223]
    s_cmp_ge_u32 s30, 163840
    s_cselect_b32 s30, 65536, s30
    s_waitcnt vmcnt(15) lgkmcnt(0)
    v_mfma_f32_16x16x32_bf16 v[96:99], a[192:195], a[176:179], v[96:99]
    ds_read_b64_tr_b16 a[208:209], v246 offset:25088
    v_mfma_f32_16x16x32_bf16 v[100:103], a[192:195], a[180:183], v[100:103]
    ds_read_b64_tr_b16 a[210:211], v246 offset:26112
    v_mfma_f32_16x16x32_bf16 v[104:107], a[192:195], a[184:187], v[104:107]
    ds_read_b64_tr_b16 a[212:213], v238 offset:25088
    v_mfma_f32_16x16x32_bf16 v[108:111], a[192:195], a[188:191], v[108:111]
    ds_read_b64_tr_b16 a[214:215], v238 offset:26112
    v_mfma_f32_16x16x32_bf16 v[112:115], a[196:199], a[176:179], v[112:115]
    ds_read_b64_tr_b16 a[216:217], v246 offset:25344
    v_mfma_f32_16x16x32_bf16 v[116:119], a[196:199], a[180:183], v[116:119]
    ds_read_b64_tr_b16 a[218:219], v246 offset:26368
    v_mfma_f32_16x16x32_bf16 v[120:123], a[196:199], a[184:187], v[120:123]
    ds_read_b64_tr_b16 a[220:221], v238 offset:25344
    v_mfma_f32_16x16x32_bf16 v[124:127], a[196:199], a[188:191], v[124:127]
    ds_read_b64_tr_b16 a[222:223], v238 offset:26368
    v_mfma_f32_16x16x32_bf16 v[128:131], a[200:203], a[176:179], v[128:131]
    buffer_load_dwordx4 a[160:163], v248, s[8:11], s28 offen offset:2048 sc1
    v_mfma_f32_16x16x32_bf16 v[132:135], a[200:203], a[180:183], v[132:135]
    v_mfma_f32_16x16x32_bf16 v[136:139], a[200:203], a[184:187], v[136:139]
    buffer_load_dwordx4 a[164:167], v248, s[8:11], s29 offen offset:2048 sc1
    v_mfma_f32_16x16x32_bf16 v[140:143], a[200:203], a[188:191], v[140:143]
    s_add_u32 m0, s31, 6144
    s_add_u32 s24, s27, 196608
    v_mfma_f32_16x16x32_bf16 v[144:147], a[204:207], a[176:179], v[144:147]
    buffer_load_dwordx4 v237, s[12:15], s24 offen lds
    v_mfma_f32_16x16x32_bf16 v[148:151], a[204:207], a[180:183], v[148:151]
    v_mfma_f32_16x16x32_bf16 v[152:155], a[204:207], a[184:187], v[152:155]
    s_cmp_eq_u32 s26, 1
    s_cbranch_scc0 ka_nopk
    s_waitcnt vmcnt(22)
    v_readfirstlane_b32 s24, v254
    s_lshl_b32 s25, s3, 16
    s_add_u32 s24, s24, s25
    s_cmp_ge_u32 s24, 8
    s_cbranch_scc0 kf_spin55
kf_spinr56:
ka_nopk:
    v_mfma_f32_16x16x32_bf16 v[156:159], a[204:207], a[188:191], v[156:159]
    s_waitcnt vmcnt(24) lgkmcnt(0)
    s_barrier
    v_add_u32 v246, s30, v247
    v_mfma_f32_16x16x32_bf16 v[160:163], a[208:211], a[176:179], v[160:163]
    v_xor_b32_e64 v238, 16, v246
    ds_read_b64_tr_b16 a[192:193], v246 offset:0
    v_mfma_f32_16x16x32_bf16 v[164:167], a[208:211], a[180:183], v[164:167]
    ds_read_b64_tr_b16 a[194:195], v246 offset:1024
    v_mfma_f32_16x16x32_bf16 v[168:171], a[208:211], a[184:187], v[168:171]
    ds_read_b64_tr_b16 a[196:197], v238 offset:0
    v_mfma_f32_16x16x32_bf16 v[172:175], a[208:211], a[188:191], v[172:175]
    ds_read_b64_tr_b16 a[198:199], v238 offset:1024
    v_mfma_f32_16x16x32_bf16 v[176:179], a[212:215], a[176:179], v[176:179]
    ds_read_b64_tr_b16 a[200:201], v246 offset:256
    v_mfma_f32_16x16x32_bf16 v[180:183], a[212:215], a[180:183], v[180:183]
    ds_read_b64_tr_b16 a[202:203], v246 offset:1280
    v_mfma_f32_16x16x32_bf16 v[184:187], a[212:215], a[184:187], v[184:187]
    ds_read_b64_tr_b16 a[204:205], v238 offset:256
    buffer_atomic_add v255, v250, s[88:91], s97 offen sc1
    s_mov_b32 s97, s43
    v_mfma_f32_16x16x32_bf16 v[188:191], a[212:215], a[188:191], v[188:191]
    ds_read_b64_tr_b16 a[206:207], v238 offset:1280
    v_mfma_f32_16x16x32_bf16 v[192:195], a[216:219], a[176:179], v[192:195]
    buffer_load_dwordx4 a[168:171], v249, s[8:11], s28 offen offset:2048 sc1
    v_mfma_f32_16x16x32_bf16 v[196:199], a[216:219], a[180:183], v[196:199]
    v_mfma_f32_16x16x32_bf16 v[200:203], a[216:219], a[184:187], v[200:203]
    buffer_load_dwordx4 a[172:175], v249, s[8:11], s29 offen offset:2048 sc1
    v_mfma_f32_16x16x32_bf16 v[204:207], a[216:219], a[188:191], v[204:207]
    s_add_u32 m0, s31, 7168
    s_add_u32 s24, s27, 229376
    v_mfma_f32_16x16x32_bf16 v[208:211], a[220:223], a[176:179], v[208:211]
    buffer_load_dwordx4 v237, s[12:15], s24 offen lds
    v_mfma_f32_16x16x32_bf16 v[212:215], a[220:223], a[180:183], v[212:215]
    s_add_u32 s27, s27, 1048576
    s_and_b32 s27, s27, 0x407fffff
    v_mfma_f32_16x16x32_bf16 v[216:219], a[220:223], a[184:187], v[216:219]
    s_cmp_eq_u32 s27, s7
    s_cselect_b32 s27, s43, s27
    v_mfma_f32_16x16x32_bf16 v[220:223], a[220:223], a[188:191], v[220:223]
    s_add_u32 s31, s31, 32768
    s_cmp_ge_u32 s31, 163840
    s_cselect_b32 s24, 98304, 0
    s_sub_u32 s31, s31, s24
    s_sub_u32 s26, s26, 1
    s_cmp_lg_u32 s26, 0
    s_cbranch_scc1 ka_qp
    s_waitcnt vmcnt(15) lgkmcnt(0)
    v_mfma_f32_16x16x32_bf16 v[96:99], a[192:195], a[128:131], v[96:99]
    ds_read_b64_tr_b16 a[208:209], v246 offset:512
    s_sub_u32 s42, s32, 17664
    v_mfma_f32_16x16x32_bf16 v[100:103], a[192:195], a[132:135], v[100:103]
    ds_read_b64_tr_b16 a[210:211], v246 offset:1536
    v_mfma_f32_16x16x32_bf16 v[104:107], a[192:195], a[136:139], v[104:107]
    ds_read_b64_tr_b16 a[212:213], v238 offset:512
    s_mov_b32 m0, s34
    s_add_u32 s41, s42, 17664
    v_mfma_f32_16x16x32_bf16 v[108:111], a[192:195], a[140:143], v[108:111]
    ds_read_b64_tr_b16 a[214:215], v238 offset:1536
    v_mfma_f32_16x16x32_bf16 v[112:115], a[196:199], a[128:131], v[112:115]
    ds_read_b64_tr_b16 a[216:217], v246 offset:768
    v_mfma_f32_16x16x32_bf16 v[116:119], a[196:199], a[132:135], v[116:119]
    ds_read_b64_tr_b16 a[218:219], v246 offset:1792
    buffer_load_dwordx4 v242, s[16:19], s41 offen offset:0 sc1 lds
    v_mfma_f32_16x16x32_bf16 v[120:123], a[196:199], a[136:139], v[120:123]
    ds_read_b64_tr_b16 a[220:221], v238 offset:768
    v_mfma_f32_16x16x32_bf16 v[124:127], a[196:199], a[140:143], v[124:127]
    ds_read_b64_tr_b16 a[222:223], v238 offset:1792
    v_mfma_f32_16x16x32_bf16 v[128:131], a[200:203], a[128:131], v[128:131]
    buffer_load_dwordx4 a[176:179], v248, s[8:11], s28 offen offset:3072 sc1
    buffer_load_dwordx4 v242, s[16:19], s41 offen offset:1024 sc1 lds
    v_mfma_f32_16x16x32_bf16 v[132:135], a[200:203], a[132:135], v[132:135]
    v_mfma_f32_16x16x32_bf16 v[136:139], a[200:203], a[136:139], v[136:139]
    buffer_load_dwordx4 a[180:183], v248, s[8:11], s29 offen offset:3072 sc1
    v_mfma_f32_16x16x32_bf16 v[140:143], a[200:203], a[140:143], v[140:143]
    buffer_load_dwordx4 v242, s[16:19], s41 offen offset:2048 sc1 lds
    v_mfma_f32_16x16x32_bf16 v[144:147], a[204:207], a[128:131], v[144:147]
    v_mfma_f32_16x16x32_bf16 v[148:151], a[204:207], a[132:135], v[148:151]
    v_mfma_f32_16x16x32_bf16 v[152:155], a[204:207], a[136:139], v[152:155]
    buffer_load_dwordx4 v242, s[16:19], s41 offen offset:3072 sc1 lds
    v_mfma_f32_16x16x32_bf16 v[156:159], a[204:207], a[140:143], v[156:159]
    s_waitcnt lgkmcnt(0)
    v_mfma_f32_16x16x32_bf16 v[160:163], a[208:211], a[128:131], v[160:163]
    ds_read_b64_tr_b16 a[192:193], v246 offset:8192
    v_mfma_f32_16x16x32_bf16 v[164:167], a[208:211], a[132:135], v[164:167]
    ds_read_b64_tr_b16 a[194:195], v246 offset:9216
    v_mfma_f32_16x16x32_bf16 v[168:171], a[208:211], a[136:139], v[168:171]
    ds_read_b64_tr_b16 a[196:197], v238 offset:8192
    s_add_u32 s34, s34, 32768
    s_cmp_ge_u32 s34, 163840
    s_cselect_b32 s34, s37, s34
    s_add_u32 s42, s42, 34048
    v_mfma_f32_16x16x32_bf16 v[172:175], a[208:211], a[140:143], v[172:175]
    ds_read_b64_tr_b16 a[198:199], v238 offset:9216
    v_mfma_f32_16x16x32_bf16 v[176:179], a[212:215], a[128:131], v[176:179]
    ds_read_b64_tr_b16 a[200:201], v246 offset:8448
    v_mfma_f32_16x16x32_bf16 v[180:183], a[212:215], a[132:135], v[180:183]
    ds_read_b64_tr_b16 a[202:203], v246 offset:9472
    s_mov_b32 m0, s34
    s_add_u32 s41, s42, 17664
    v_mfma_f32_16x16x32_bf16 v[184:187], a[212:215], a[136:139], v[184:187]
    ds_read_b64_tr_b16 a[204:205], v238 offset:8448
    v_mfma_f32_16x16x32_bf16 v[188:191], a[212:215], a[140:143], v[188:191]
    ds_read_b64_tr_b16 a[206:207], v238 offset:9472
    v_mfma_f32_16x16x32_bf16 v[192:195], a[216:219], a[128:131], v[192:195]
    buffer_load_dwordx4 a[184:187], v249, s[8:11], s28 offen offset:3072 sc1
    buffer_load_dwordx4 v242, s[16:19], s41 offen offset:0 sc1 lds
    v_mfma_f32_16x16x32_bf16 v[196:199], a[216:219], a[132:135], v[196:199]
    v_mfma_f32_16x16x32_bf16 v[200:203], a[216:219], a[136:139], v[200:203]
    buffer_load_dwordx4 a[188:191], v249, s[8:11], s29 offen offset:3072 sc1
    v_mfma_f32_16x16x32_bf16 v[204:207], a[216:219], a[140:143], v[204:207]
    buffer_load_dwordx4 v242, s[16:19], s41 offen offset:1024 sc1 lds
    v_mfma_f32_16x16x32_bf16 v[208:211], a[220:223], a[128:131], v[208:211]
    v_mfma_f32_16x16x32_bf16 v[212:215], a[220:223], a[132:135], v[212:215]
    v_mfma_f32_16x16x32_bf16 v[216:219], a[220:223], a[136:139], v[216:219]
    s_add_u32 s28, s28, 4096
    s_and_b32 s28, s28, 32767
    v_mfma_f32_16x16x32_bf16 v[220:223], a[220:223], a[140:143], v[220:223]
    s_add_u32 s29, s28, 32768
    buffer_load_dwordx4 v242, s[16:19], s41 offen offset:2048 sc1 lds
    s_waitcnt vmcnt(20) lgkmcnt(0)
    v_mfma_f32_16x16x32_bf16 v[96:99], a[192:195], a[144:147], v[96:99]
    ds_read_b64_tr_b16 a[208:209], v246 offset:8704
    s_load_dwordx2 s[80:81], s[0:1], 0
    s_load_dwordx2 s[82:83], s[0:1], 56
    s_load_dwordx4 s[84:87], s[0:1], 80
    v_mfma_f32_16x16x32_bf16 v[100:103], a[192:195], a[148:151], v[100:103]
    ds_read_b64_tr_b16 a[210:211], v246 offset:9728
    v_mfma_f32_16x16x32_bf16 v[104:107], a[192:195], a[152:155], v[104:107]
    ds_read_b64_tr_b16 a[212:213], v238 offset:8704
    buffer_load_dwordx4 v242, s[16:19], s41 offen offset:3072 sc1 lds
    v_mfma_f32_16x16x32_bf16 v[108:111], a[192:195], a[156:159], v[108:111]
    ds_read_b64_tr_b16 a[214:215], v238 offset:9728
    v_mfma_f32_16x16x32_bf16 v[112:115], a[196:199], a[144:147], v[112:115]
    ds_read_b64_tr_b16 a[216:217], v246 offset:8960
    v_mfma_f32_16x16x32_bf16 v[116:119], a[196:199], a[148:151], v[116:119]
    ds_read_b64_tr_b16 a[218:219], v246 offset:9984
    s_add_u32 m0, s34, 16384
    s_add_u32 s34, s34, 32768
    s_cmp_ge_u32 s34, 163840
    s_cselect_b32 s34, s37, s34
    v_mfma_f32_16x16x32_bf16 v[120:123], a[196:199], a[152:155], v[120:123]
    ds_read_b64_tr_b16 a[220:221], v238 offset:8960
    v_mfma_f32_16x16x32_bf16 v[124:127], a[196:199], a[156:159], v[124:127]
    ds_read_b64_tr_b16 a[222:223], v238 offset:9984
    v_mfma_f32_16x16x32_bf16 v[128:131], a[200:203], a[144:147], v[128:131]
    buffer_load_dwordx4 v242, s[16:19], s42 offen offset:0 sc1 lds
    v_mov_b32_e64 v241, v240
    v_mfma_f32_16x16x32_bf16 v[132:135], a[200:203], a[148:151], v[132:135]
    v_lshrrev_b32_e64 v230, 7, v240
    v_mfma_f32_16x16x32_bf16 v[136:139], a[200:203], a[152:155], v[136:139]
    v_mul_u32_u24 v253, 7168, v230
    v_mfma_f32_16x16x32_bf16 v[140:143], a[200:203], a[156:159], v[140:143]
    v_and_b32 v231, 0x70, v240
    v_mfma_f32_16x16x32_bf16 v[144:147], a[204:207], a[144:147], v[144:147]
    buffer_load_dwordx4 v242, s[16:19], s42 offen offset:1024 sc1 lds
    v_mfma_f32_16x16x32_bf16 v[148:151], a[204:207], a[148:151], v[148:151]
    v_add_u32_e64 v253, v253, v231
    v_mfma_f32_16x16x32_bf16 v[152:155], a[204:207], a[152:155], v[152:155]
    v_lshlrev_b32_e64 v255, 5, v230
    v_mfma_f32_16x16x32_bf16 v[156:159], a[204:207], a[156:159], v[156:159]
    buffer_load_dwordx4 v242, s[16:19], s42 offen offset:2048 sc1 lds
    s_waitcnt lgkmcnt(0)
    v_mfma_f32_16x16x32_bf16 v[160:163], a[208:211], a[144:147], v[160:163]
    ds_read_b64_tr_b16 a[192:193], v246 offset:16384
    v_and_b32 v230, 16, v240
    v_mfma_f32_16x16x32_bf16 v[164:167], a[208:211], a[148:151], v[164:167]
    ds_read_b64_tr_b16 a[194:195], v246 offset:17408
    v_mfma_f32_16x16x32_bf16 v[168:171], a[208:211], a[152:155], v[168:171]
    ds_read_b64_tr_b16 a[196:197], v238 offset:16384
    buffer_load_dwordx4 v242, s[16:19], s42 offen offset:3072 sc1 lds
    s_add_u32 s42, s42, 34048
    v_mfma_f32_16x16x32_bf16 v[172:175], a[208:211], a[156:159], v[172:175]
    ds_read_b64_tr_b16 a[198:199], v238 offset:17408
    v_add_u32_e64 v255, v255, v230
    v_mfma_f32_16x16x32_bf16 v[176:179], a[212:215], a[144:147], v[176:179]
    ds_read_b64_tr_b16 a[200:201], v246 offset:16640
    v_lshrrev_b32_e64 v231, 5, v231
    v_mfma_f32_16x16x32_bf16 v[180:183], a[212:215], a[148:151], v[180:183]
    ds_read_b64_tr_b16 a[202:203], v246 offset:17664
    s_mov_b32 m0, s34
    s_add_u32 s41, s42, 17664
    v_mfma_f32_16x16x32_bf16 v[184:187], a[212:215], a[152:155], v[184:187]
    ds_read_b64_tr_b16 a[204:205], v238 offset:16640
    v_mfma_f32_16x16x32_bf16 v[188:191], a[212:215], a[156:159], v[188:191]
    ds_read_b64_tr_b16 a[206:207], v238 offset:17664
    v_lshl_add_u32 v255, v231, 16, v255
    v_mfma_f32_16x16x32_bf16 v[192:195], a[216:219], a[144:147], v[192:195]
    buffer_load_dwordx4 v242, s[16:19], s41 offen offset:0 sc1 lds
    v_mfma_f32_16x16x32_bf16 v[196:199], a[216:219], a[148:151], v[196:199]
    v_mov_b32 v64, 0
    v_mfma_f32_16x16x32_bf16 v[200:203], a[216:219], a[152:155], v[200:203]
    v_mov_b32_e64 v65, 0
    v_mfma_f32_16x16x32_bf16 v[204:207], a[216:219], a[156:159], v[204:207]
    v_mov_b32_e64 v66, 0
    v_mfma_f32_16x16x32_bf16 v[208:211], a[220:223], a[144:147], v[208:211]
    buffer_load_dwordx4 v242, s[16:19], s41 offen offset:1024 sc1 lds
    v_mov_b32_e64 v67, 0
    v_mfma_f32_16x16x32_bf16 v[212:215], a[220:223], a[148:151], v[212:215]
    v_mov_b32_e64 v68, 0
    v_mfma_f32_16x16x32_bf16 v[216:219], a[220:223], a[152:155], v[216:219]
    v_mov_b32_e64 v69, 0
    v_mfma_f32_16x16x32_bf16 v[220:223], a[220:223], a[156:159], v[220:223]
    buffer_load_dwordx4 v242, s[16:19], s41 offen offset:2048 sc1 lds
    s_waitcnt vmcnt(20) lgkmcnt(0)
    v_mfma_f32_16x16x32_bf16 v[96:99], a[192:195], a[160:163], v[96:99]
    ds_read_b64_tr_b16 a[208:209], v246 offset:16896
    v_mov_b32 v70, 0
    v_mfma_f32_16x16x32_bf16 v[100:103], a[192:195], a[164:167], v[100:103]
    ds_read_b64_tr_b16 a[210:211], v246 offset:17920
    v_mfma_f32_16x16x32_bf16 v[104:107], a[192:195], a[168:171], v[104:107]
    ds_read_b64_tr_b16 a[212:213], v238 offset:16896
    buffer_load_dwordx4 v242, s[16:19], s41 offen offset:3072 sc1 lds
    v_mfma_f32_16x16x32_bf16 v[108:111], a[192:195], a[172:175], v[108:111]
    ds_read_b64_tr_b16 a[214:215], v238 offset:17920
    v_mov_b32_e64 v71, 0
    v_mfma_f32_16x16x32_bf16 v[112:115], a[196:199], a[160:163], v[112:115]
    ds_read_b64_tr_b16 a[216:217], v246 offset:17152
    v_mfma_f32_16x16x32_bf16 v[116:119], a[196:199], a[164:167], v[116:119]
    ds_read_b64_tr_b16 a[218:219], v246 offset:18176
    s_add_u32 m0, s34, 16384
    s_add_u32 s34, s34, 32768
    s_cmp_ge_u32 s34, 163840
    s_cselect_b32 s34, s37, s34
    v_mfma_f32_16x16x32_bf16 v[120:123], a[196:199], a[168:171], v[120:123]
    ds_read_b64_tr_b16 a[220:221], v238 offset:17152
    v_mov_b32 v72, 0
    v_mfma_f32_16x16x32_bf16 v[124:127], a[196:199], a[172:175], v[124:127]
    ds_read_b64_tr_b16 a[222:223], v238 offset:18176
    v_mfma_f32_16x16x32_bf16 v[128:131], a[200:203], a[160:163], v[128:131]
    v_mov_b32_e64 v73, 0
    v_mfma_f32_16x16x32_bf16 v[132:135], a[200:203], a[164:167], v[132:135]
    buffer_load_dwordx4 v242, s[16:19], s42 offen offset:0 sc1 lds
    v_mov_b32_e64 v74, 0
    v_mfma_f32_16x16x32_bf16 v[136:139], a[200:203], a[168:171], v[136:139]
    v_mov_b32_e64 v75, 0
    v_mfma_f32_16x16x32_bf16 v[140:143], a[200:203], a[172:175], v[140:143]
    v_mov_b32_e64 v76, 0
    v_mfma_f32_16x16x32_bf16 v[144:147], a[204:207], a[160:163], v[144:147]
    buffer_load_dwordx4 v242, s[16:19], s42 offen offset:1024 sc1 lds
    v_mov_b32_e64 v77, 0
    v_mfma_f32_16x16x32_bf16 v[148:151], a[204:207], a[164:167], v[148:151]
    v_mov_b32_e64 v78, 0
    v_mfma_f32_16x16x32_bf16 v[152:155], a[204:207], a[168:171], v[152:155]
    v_mov_b32_e64 v79, 0
    v_mfma_f32_16x16x32_bf16 v[156:159], a[204:207], a[172:175], v[156:159]
    buffer_load_dwordx4 v242, s[16:19], s42 offen offset:2048 sc1 lds
    s_waitcnt lgkmcnt(0)
    v_mfma_f32_16x16x32_bf16 v[160:163], a[208:211], a[160:163], v[160:163]
    ds_read_b64_tr_b16 a[192:193], v246 offset:24576
    v_mfma_f32_16x16x32_bf16 v[164:167], a[208:211], a[164:167], v[164:167]
    ds_read_b64_tr_b16 a[194:195], v246 offset:25600
    v_mov_b32 v80, 0
    v_mfma_f32_16x16x32_bf16 v[168:171], a[208:211], a[168:171], v[168:171]
    ds_read_b64_tr_b16 a[196:197], v238 offset:24576
    buffer_load_dwordx4 v242, s[16:19], s42 offen offset:3072 sc1 lds
    s_add_u32 s42, s42, 34048
    v_mfma_f32_16x16x32_bf16 v[172:175], a[208:211], a[172:175], v[172:175]
    ds_read_b64_tr_b16 a[198:199], v238 offset:25600
    v_mfma_f32_16x16x32_bf16 v[176:179], a[212:215], a[160:163], v[176:179]
    ds_read_b64_tr_b16 a[200:201], v246 offset:24832
    v_mov_b32_e64 v81, 0
    v_mfma_f32_16x16x32_bf16 v[180:183], a[212:215], a[164:167], v[180:183]
    ds_read_b64_tr_b16 a[202:203], v246 offset:25856
    v_mfma_f32_16x16x32_bf16 v[184:187], a[212:215], a[168:171], v[184:187]
    ds_read_b64_tr_b16 a[204:205], v238 offset:24832
    v_mov_b32_e64 v82, 0
    v_mfma_f32_16x16x32_bf16 v[188:191], a[212:215], a[172:175], v[188:191]
    ds_read_b64_tr_b16 a[206:207], v238 offset:25856
    v_mfma_f32_16x16x32_bf16 v[192:195], a[216:219], a[160:163], v[192:195]
    v_mov_b32_e64 v83, 0
    v_mfma_f32_16x16x32_bf16 v[196:199], a[216:219], a[164:167], v[196:199]
    v_mov_b32 v84, 0
    v_mov_b32 v85, 0
    v_mfma_f32_16x16x32_bf16 v[200:203], a[216:219], a[168:171], v[200:203]
    v_mov_b32_e64 v86, 0
    v_mfma_f32_16x16x32_bf16 v[204:207], a[216:219], a[172:175], v[204:207]
    v_mov_b32_e64 v87, 0
    v_mfma_f32_16x16x32_bf16 v[208:211], a[220:223], a[160:163], v[208:211]
    v_mov_b32_e64 v88, 0
    v_mfma_f32_16x16x32_bf16 v[212:215], a[220:223], a[164:167], v[212:215]
    v_mov_b32_e64 v89, 0
    v_mfma_f32_16x16x32_bf16 v[216:219], a[220:223], a[168:171], v[216:219]
    v_mov_b32_e64 v90, 0
    v_mfma_f32_16x16x32_bf16 v[220:223], a[220:223], a[172:175], v[220:223]
    s_waitcnt vmcnt(15) lgkmcnt(0)
    v_mfma_f32_16x16x32_bf16 v[96:99], a[192:195], a[176:179], v[96:99]
    ds_read_b64_tr_b16 a[208:209], v246 offset:25088
    v_mov_b32 v91, 0
    v_mfma_f32_16x16x32_bf16 v[100:103], a[192:195], a[180:183], v[100:103]
    ds_read_b64_tr_b16 a[210:211], v246 offset:26112
    v_mov_b32_e64 v92, 0
    v_mfma_f32_16x16x32_bf16 v[104:107], a[192:195], a[184:187], v[104:107]
    ds_read_b64_tr_b16 a[212:213], v238 offset:25088
    v_mfma_f32_16x16x32_bf16 v[108:111], a[192:195], a[188:191], v[108:111]
    ds_read_b64_tr_b16 a[214:215], v238 offset:26112
    v_mov_b32_e64 v93, 0
    v_mfma_f32_16x16x32_bf16 v[112:115], a[196:199], a[176:179], v[112:115]
    ds_read_b64_tr_b16 a[216:217], v246 offset:25344
    v_mfma_f32_16x16x32_bf16 v[116:119], a[196:199], a[180:183], v[116:119]
    ds_read_b64_tr_b16 a[218:219], v246 offset:26368
    v_mov_b32_e64 v94, 0
    v_mfma_f32_16x16x32_bf16 v[120:123], a[196:199], a[184:187], v[120:123]
    ds_read_b64_tr_b16 a[220:221], v238 offset:25344
    v_mfma_f32_16x16x32_bf16 v[124:127], a[196:199], a[188:191], v[124:127]
    ds_read_b64_tr_b16 a[222:223], v238 offset:26368
    v_mov_b32_e64 v95, 0
    v_mfma_f32_16x16x32_bf16 v[128:131], a[200:203], a[176:179], v[128:131]
    v_mov_b32_e64 v224, 0
    v_mfma_f32_16x16x32_bf16 v[132:135], a[200:203], a[180:183], v[132:135]
    s_and_b32 s28, s3, 1
    s_lshl1_add_u32 s28, s2, s28
    v_mfma_f32_16x16x32_bf16 v[136:139], a[200:203], a[184:187], v[136:139]
    s_sub_u32 s28, s28, 0
    v_lshlrev_b32 v4, 3, v240
    v_mfma_f32_16x16x32_bf16 v[140:143], a[200:203], a[188:191], v[140:143]
    v_min_u32 v4, 7040, v4
    s_mul_i32 s28, s28, 14336
    v_mfma_f32_16x16x32_bf16 v[144:147], a[204:207], a[176:179], v[144:147]
    v_mov_b32_e64 v225, 0
    v_mfma_f32_16x16x32_bf16 v[148:151], a[204:207], a[180:183], v[148:151]
    v_mov_b32_e64 v226, 0
    v_mfma_f32_16x16x32_bf16 v[152:155], a[204:207], a[184:187], v[152:155]
    v_mov_b32_e64 v227, 0
    v_mfma_f32_16x16x32_bf16 v[156:159], a[204:207], a[188:191], v[156:159]
    s_waitcnt vmcnt(8) lgkmcnt(0)
    s_barrier
    v_mfma_f32_16x16x32_bf16 v[160:163], a[208:211], a[176:179], v[160:163]
    ds_read_b128 a[192:195], v241 offset:0
    s_mov_b32 m0, s34
    s_add_u32 s41, s42, 17664
    v_mfma_f32_16x16x32_bf16 v[164:167], a[208:211], a[180:183], v[164:167]
    ds_read_b128 a[196:199], v241 offset:2048
    buffer_load_dwordx4 v242, s[16:19], s41 offen offset:0 sc1 lds
    v_mfma_f32_16x16x32_bf16 v[168:171], a[208:211], a[184:187], v[168:171]
    ds_read_b128 a[200:203], v241 offset:4096
    v_mfma_f32_16x16x32_bf16 v[172:175], a[208:211], a[188:191], v[172:175]
    ds_read_b128 a[204:207], v241 offset:6144
    buffer_load_dwordx4 v242, s[16:19], s41 offen offset:1024 sc1 lds
    v_mfma_f32_16x16x32_bf16 v[176:179], a[212:215], a[176:179], v[176:179]
    ds_read_b128 a[224:227], v241 offset:8192
    buffer_load_dwordx4 v242, s[16:19], s41 offen offset:2048 sc1 lds
    v_mfma_f32_16x16x32_bf16 v[180:183], a[212:215], a[180:183], v[180:183]
    ds_read_b128 a[228:231], v241 offset:10240
    v_mfma_f32_16x16x32_bf16 v[184:187], a[212:215], a[184:187], v[184:187]
    ds_read_b128 a[232:235], v241 offset:12288
    buffer_load_dwordx4 v242, s[16:19], s41 offen offset:3072 sc1 lds
    v_mfma_f32_16x16x32_bf16 v[188:191], a[212:215], a[188:191], v[188:191]
    ds_read_b128 a[236:239], v241 offset:14336
    v_mfma_f32_16x16x32_bf16 v[192:195], a[216:219], a[176:179], v[192:195]
    ds_read_b128 a[240:243], v241 offset:9216
    s_add_u32 m0, s34, 16384
    s_add_u32 s34, s34, 32768
    s_cmp_ge_u32 s34, 163840
    s_cselect_b32 s34, s37, s34
    v_mfma_f32_16x16x32_bf16 v[196:199], a[216:219], a[180:183], v[196:199]
    ds_read_b128 a[244:247], v241 offset:11264
    buffer_load_dwordx4 v242, s[16:19], s42 offen offset:0 sc1 lds
    v_mfma_f32_16x16x32_bf16 v[200:203], a[216:219], a[184:187], v[200:203]
    ds_read_b128 a[248:251], v241 offset:13312
    v_mfma_f32_16x16x32_bf16 v[204:207], a[216:219], a[188:191], v[204:207]
    ds_read_b128 a[252:255], v241 offset:15360
    buffer_load_dwordx4 v242, s[16:19], s42 offen offset:1024 sc1 lds
    v_mfma_f32_16x16x32_bf16 v[208:211], a[220:223], a[176:179], v[208:211]
    buffer_load_dwordx4 v242, s[16:19], s42 offen offset:2048 sc1 lds
    v_mfma_f32_16x16x32_bf16 v[212:215], a[220:223], a[180:183], v[212:215]
    v_mfma_f32_16x16x32_bf16 v[216:219], a[220:223], a[184:187], v[216:219]
    buffer_load_dwordx4 v242, s[16:19], s42 offen offset:3072 sc1 lds
    s_add_u32 s42, s42, 34048
    v_mfma_f32_16x16x32_bf16 v[220:223], a[220:223], a[188:191], v[220:223]
    s_cmp_lt_u32 s2, 0
    s_cbranch_scc1 ka_nogu
    buffer_load_dword v252, v4, s[52:55], s28 offen
    s_add_u32 s28, s28, 7168
    buffer_load_dword v252, v4, s[52:55], s28 offen
    s_add_u32 s28, s28, 7168
ka_nogu:
    s_waitcnt lgkmcnt(8)
    ds_read_b128 a[208:211], v241 offset:1024
    ds_read_b128 a[212:215], v241 offset:3072
    ds_read_b128 a[216:219], v241 offset:5120
    ds_read_b128 a[220:223], v241 offset:7168
    s_sub_u32 s36, s36, 1
    s_cbranch_scc1 kf_fix1
kf_fixr2:
    v_cvt_pk_bf16_f32 v96, v96, v97
    v_cvt_pk_bf16_f32 v97, v98, v99
    v_cvt_pk_bf16_f32 v98, v112, v113
    v_cvt_pk_bf16_f32 v99, v114, v115
    v_accvgpr_write_b32 a128, v96
    v_accvgpr_write_b32 a129, v97
    v_accvgpr_write_b32 a130, v98
    v_accvgpr_write_b32 a131, v99
    v_cvt_pk_bf16_f32 v100, v100, v101
    v_cvt_pk_bf16_f32 v101, v102, v103
    v_cvt_pk_bf16_f32 v102, v116, v117
    v_cvt_pk_bf16_f32 v103, v118, v119
    v_accvgpr_write_b32 a144, v100
    v_accvgpr_write_b32 a145, v101
    v_accvgpr_write_b32 a146, v102
    v_accvgpr_write_b32 a147, v103
    v_cvt_pk_bf16_f32 v104, v104, v105
    v_cvt_pk_bf16_f32 v105, v106, v107
    v_cvt_pk_bf16_f32 v106, v120, v121
    v_cvt_pk_bf16_f32 v107, v122, v123
    v_accvgpr_write_b32 a160, v104
    v_accvgpr_write_b32 a161, v105
    v_accvgpr_write_b32 a162, v106
    v_accvgpr_write_b32 a163, v107
    v_cvt_pk_bf16_f32 v108, v108, v109
    v_cvt_pk_bf16_f32 v109, v110, v111
    v_cvt_pk_bf16_f32 v110, v124, v125
    v_cvt_pk_bf16_f32 v111, v126, v127
    v_accvgpr_write_b32 a176, v108
    v_accvgpr_write_b32 a177, v109
    v_accvgpr_write_b32 a178, v110
    v_accvgpr_write_b32 a179, v111
    s_nop 1
    s_waitcnt lgkmcnt(0)
    v_mfma_f32_16x16x32_bf16 v[0:3], a[192:195], a[128:131], v[64:67]
    v_cvt_pk_bf16_f32 v128, v128, v129
    v_cvt_pk_bf16_f32 v129, v130, v131
    v_cvt_pk_bf16_f32 v130, v144, v145
    v_cvt_pk_bf16_f32 v131, v146, v147
    v_mfma_f32_16x16x32_bf16 v[8:11], a[192:195], a[144:147], v[72:75]
    v_accvgpr_write_b32 a132, v128
    v_accvgpr_write_b32 a133, v129
    v_accvgpr_write_b32 a134, v130
    v_accvgpr_write_b32 a135, v131
    v_mfma_f32_16x16x32_bf16 v[16:19], a[192:195], a[160:163], v[80:83]
    v_cvt_pk_bf16_f32 v132, v132, v133
    v_cvt_pk_bf16_f32 v133, v134, v135
    v_cvt_pk_bf16_f32 v134, v148, v149
    v_cvt_pk_bf16_f32 v135, v150, v151
    v_mfma_f32_16x16x32_bf16 v[24:27], a[192:195], a[176:179], v[88:91]
    v_accvgpr_write_b32 a148, v132
    v_accvgpr_write_b32 a149, v133
    v_accvgpr_write_b32 a150, v134
    v_accvgpr_write_b32 a151, v135
    v_mfma_f32_16x16x32_bf16 v[4:7], a[208:211], a[128:131], v[68:71]
    v_cvt_pk_bf16_f32 v136, v136, v137
    v_cvt_pk_bf16_f32 v137, v138, v139
    v_cvt_pk_bf16_f32 v138, v152, v153
    v_cvt_pk_bf16_f32 v139, v154, v155
    v_mfma_f32_16x16x32_bf16 v[12:15], a[208:211], a[144:147], v[76:79]
    v_accvgpr_write_b32 a164, v136
    v_accvgpr_write_b32 a165, v137
    v_accvgpr_write_b32 a166, v138
    v_accvgpr_write_b32 a167, v139
    v_mfma_f32_16x16x32_bf16 v[20:23], a[208:211], a[160:163], v[84:87]
    v_cvt_pk_bf16_f32 v140, v140, v141
    v_cvt_pk_bf16_f32 v141, v142, v143
    v_cvt_pk_bf16_f32 v142, v156, v157
    v_cvt_pk_bf16_f32 v143, v158, v159
    v_mfma_f32_16x16x32_bf16 v[28:31], a[208:211], a[176:179], v[92:95]
    v_accvgpr_write_b32 a180, v140
    v_accvgpr_write_b32 a181, v141
    v_accvgpr_write_b32 a182, v142
    v_accvgpr_write_b32 a183, v143
    s_nop 1
    v_mfma_f32_16x16x32_bf16 v[0:3], a[196:199], a[132:135], v[0:3]
    v_cvt_pk_bf16_f32 v160, v160, v161
    v_cvt_pk_bf16_f32 v161, v162, v163
    v_cvt_pk_bf16_f32 v162, v176, v177
    v_cvt_pk_bf16_f32 v163, v178, v179
    v_mfma_f32_16x16x32_bf16 v[8:11], a[196:199], a[148:151], v[8:11]
    v_accvgpr_write_b32 a136, v160
    v_accvgpr_write_b32 a137, v161
    v_accvgpr_write_b32 a138, v162
    v_accvgpr_write_b32 a139, v163
    v_mfma_f32_16x16x32_bf16 v[16:19], a[196:199], a[164:167], v[16:19]
    v_cvt_pk_bf16_f32 v164, v164, v165
    v_cvt_pk_bf16_f32 v165, v166, v167
    v_cvt_pk_bf16_f32 v166, v180, v181
    v_cvt_pk_bf16_f32 v167, v182, v183
    v_mfma_f32_16x16x32_bf16 v[24:27], a[196:199], a[180:183], v[24:27]
    v_accvgpr_write_b32 a152, v164
    v_accvgpr_write_b32 a153, v165
    v_accvgpr_write_b32 a154, v166
    v_accvgpr_write_b32 a155, v167
    v_mfma_f32_16x16x32_bf16 v[4:7], a[212:215], a[132:135], v[4:7]
    v_cvt_pk_bf16_f32 v168, v168, v169
    v_cvt_pk_bf16_f32 v169, v170, v171
    v_cvt_pk_bf16_f32 v170, v184, v185
    v_cvt_pk_bf16_f32 v171, v186, v187
    v_mfma_f32_16x16x32_bf16 v[12:15], a[212:215], a[148:151], v[12:15]
    v_accvgpr_write_b32 a168, v168
    v_accvgpr_write_b32 a169, v169
    v_accvgpr_write_b32 a170, v170
    v_accvgpr_write_b32 a171, v171
    v_mfma_f32_16x16x32_bf16 v[20:23], a[212:215], a[164:167], v[20:23]
    v_cvt_pk_bf16_f32 v172, v172, v173
    v_cvt_pk_bf16_f32 v173, v174, v175
    v_cvt_pk_bf16_f32 v174, v188, v189
    v_cvt_pk_bf16_f32 v175, v190, v191
    v_mfma_f32_16x16x32_bf16 v[28:31], a[212:215], a[180:183], v[28:31]
    v_accvgpr_write_b32 a184, v172
    v_accvgpr_write_b32 a185, v173
    v_accvgpr_write_b32 a186, v174
    v_accvgpr_write_b32 a187, v175
    s_nop 1
    s_waitcnt lgkmcnt(0)
    v_mfma_f32_16x16x32_bf16 v[0:3], a[200:203], a[136:139], v[0:3]
    v_cvt_pk_bf16_f32 v192, v192, v193
    v_cvt_pk_bf16_f32 v193, v194, v195
    v_cvt_pk_bf16_f32 v194, v208, v209
    v_cvt_pk_bf16_f32 v195, v210, v211
    v_mfma_f32_16x16x32_bf16 v[8:11], a[200:203], a[152:155], v[8:11]
    v_accvgpr_write_b32 a140, v192
    v_accvgpr_write_b32 a141, v193
    v_accvgpr_write_b32 a142, v194
    v_accvgpr_write_b32 a143, v195
    v_mfma_f32_16x16x32_bf16 v[16:19], a[200:203], a[168:171], v[16:19]
    v_cvt_pk_bf16_f32 v196, v196, v197
    v_cvt_pk_bf16_f32 v197, v198, v199
    v_cvt_pk_bf16_f32 v198, v212, v213
    v_cvt_pk_bf16_f32 v199, v214, v215
    v_mfma_f32_16x16x32_bf16 v[24:27], a[200:203], a[184:187], v[24:27]
    v_accvgpr_write_b32 a156, v196
    v_accvgpr_write_b32 a157, v197
    v_accvgpr_write_b32 a158, v198
    v_accvgpr_write_b32 a159, v199
    v_mfma_f32_16x16x32_bf16 v[4:7], a[216:219], a[136:139], v[4:7]
    v_cvt_pk_bf16_f32 v200, v200, v201
    v_cvt_pk_bf16_f32 v201, v202, v203
    v_cvt_pk_bf16_f32 v202, v216, v217
    v_cvt_pk_bf16_f32 v203, v218, v219
    v_mfma_f32_16x16x32_bf16 v[12:15], a[216:219], a[152:155], v[12:15]
    v_accvgpr_write_b32 a172, v200
    v_accvgpr_write_b32 a173, v201
    v_accvgpr_write_b32 a174, v202
    v_accvgpr_write_b32 a175, v203
    v_mfma_f32_16x16x32_bf16 v[20:23], a[216:219], a[168:171], v[20:23]
    v_cvt_pk_bf16_f32 v204, v204, v205
    v_cvt_pk_bf16_f32 v205, v206, v207
    v_cvt_pk_bf16_f32 v206, v220, v221
    v_cvt_pk_bf16_f32 v207, v222, v223
    v_mfma_f32_16x16x32_bf16 v[28:31], a[216:219], a[184:187], v[28:31]
    v_accvgpr_write_b32 a188, v204
    v_accvgpr_write_b32 a189, v205
    v_accvgpr_write_b32 a190, v206
    v_accvgpr_write_b32 a191, v207
    s_nop 1
    v_mfma_f32_16x16x32_bf16 v[0:3], a[204:207], a[140:143], v[0:3]
    v_mov_b32 v144, 0
    v_mov_b32 v145, 0
    v_mov_b32 v146, 0
    v_mfma_f32_16x16x32_bf16 v[8:11], a[204:207], a[156:159], v[8:11]
    v_mov_b32 v147, 0
    v_mov_b32 v148, 0
    v_mfma_f32_16x16x32_bf16 v[16:19], a[204:207], a[172:175], v[16:19]
    v_mov_b32 v149, 0
    v_mov_b32 v150, 0
    v_mov_b32_e64 v151, 0
    v_mfma_f32_16x16x32_bf16 v[24:27], a[204:207], a[188:191], v[24:27]
    v_mov_b32 v152, 0
    v_mov_b32 v153, 0
    v_mfma_f32_16x16x32_bf16 v[4:7], a[220:223], a[140:143], v[4:7]
    v_mov_b32 v154, 0
    v_mov_b32 v155, 0
    v_mov_b32_e64 v156, 0
    v_mfma_f32_16x16x32_bf16 v[12:15], a[220:223], a[156:159], v[12:15]
    v_mov_b32 v157, 0
    v_mov_b32 v158, 0
    v_mfma_f32_16x16x32_bf16 v[20:23], a[220:223], a[172:175], v[20:23]
    v_mov_b32_e64 v159, 0
    v_mov_b32 v204, 0x3f803f80
    v_mov_b32 v205, 0x3f803f80
    v_mfma_f32_16x16x32_bf16 v[28:31], a[220:223], a[188:191], v[28:31]
    v_mov_b32 v206, 0x3f803f80
    v_mov_b32 v207, 0x3f803f80
    s_nop 4
    v_max3_f32 v128, v0, v1, v2
    v_max3_f32 v130, v8, v9, v10
    v_max3_f32 v132, v16, v17, v18
    v_max3_f32 v134, v24, v25, v26
    v_max3_f32 v128, v128, v3, v4
    v_max3_f32 v130, v130, v11, v12
    v_max3_f32 v132, v132, v19, v20
    v_max3_f32 v134, v134, v27, v28
    v_max3_f32 v128, v128, v5, v6
    v_max3_f32 v130, v130, v13, v14
    v_max3_f32 v132, v132, v21, v22
    v_max3_f32 v134, v134, v29, v30
    v_max_f32 v128, v128, v7
    v_max_f32 v130, v130, v15
    v_max_f32 v132, v132, v23
    v_max_f32 v134, v134, v31
    v_mov_b32 v129, v128
    v_mov_b32 v131, v130
    v_mov_b32 v133, v132
    v_mov_b32 v135, v134
    v_permlane16_swap_b32 v128, v129
    v_permlane16_swap_b32 v130, v131
    v_permlane16_swap_b32 v132, v133
    v_permlane16_swap_b32 v134, v135
    v_max_f32 v128, v128, v129
    v_max_f32 v130, v130, v131
    v_max_f32 v132, v132, v133
    v_max_f32 v134, v134, v135
    v_mov_b32 v129, v128
    v_mov_b32 v131, v130
    v_mov_b32 v133, v132
    v_mov_b32 v135, v134
    v_permlane32_swap_b32 v128, v129
    v_permlane32_swap_b32 v130, v131
    v_permlane32_swap_b32 v132, v133
    v_permlane32_swap_b32 v134, v135
    v_max_f32 v128, v128, v129
    v_max_f32 v130, v130, v131
    v_max_f32 v132, v132, v133
    v_max_f32_e64 v134, v134, v135
    v_add_f32 v128, 0x41800000, v128
    v_add_f32 v130, 0x41800000, v130
    v_add_f32 v132, 0x41800000, v132
    v_add_f32 v134, 0x41800000, v134
    v_sub_f32 v224, 0, v128
    v_sub_f32 v64, v64, v128
    v_sub_f32 v65, v65, v128
    v_sub_f32 v66, v66, v128
    v_sub_f32 v67, v67, v128
    v_sub_f32 v68, v68, v128
    v_sub_f32 v69, v69, v128
    v_sub_f32 v70, v70, v128
    v_sub_f32 v71, v71, v128
    v_sub_f32 v225, 0, v130
    v_sub_f32 v72, v72, v130
    v_sub_f32 v73, v73, v130
    v_sub_f32 v74, v74, v130
    v_sub_f32 v75, v75, v130
    v_sub_f32 v76, v76, v130
    v_sub_f32 v77, v77, v130
    v_sub_f32 v78, v78, v130
    v_sub_f32 v79, v79, v130
    v_sub_f32 v226, 0, v132
    v_sub_f32 v80, v80, v132
    v_sub_f32 v81, v81, v132
    v_sub_f32 v82, v82, v132
    v_sub_f32 v83, v83, v132
    v_sub_f32 v84, v84, v132
    v_sub_f32 v85, v85, v132
    v_sub_f32 v86, v86, v132
    v_sub_f32 v87, v87, v132
    v_sub_f32 v227, 0, v134
    v_sub_f32 v88, v88, v134
    v_sub_f32 v89, v89, v134
    v_sub_f32 v90, v90, v134
    v_sub_f32 v91, v91, v134
    v_sub_f32 v92, v92, v134
    v_sub_f32 v93, v93, v134
    v_sub_f32 v94, v94, v134
    v_sub_f32 v95, v95, v134
    v_sub_f32 v0, v0, v128
    v_sub_f32 v1, v1, v128
    v_sub_f32 v2, v2, v128
    v_sub_f32 v3, v3, v128
    v_sub_f32 v4, v4, v128
    v_sub_f32 v5, v5, v128
    v_sub_f32 v6, v6, v128
    v_sub_f32 v7, v7, v128
    v_sub_f32 v8, v8, v130
    v_sub_f32 v9, v9, v130
    v_sub_f32 v10, v10, v130
    v_sub_f32 v11, v11, v130
    v_sub_f32 v12, v12, v130
    v_sub_f32 v13, v13, v130
    v_sub_f32 v14, v14, v130
    v_sub_f32 v15, v15, v130
    v_sub_f32 v16, v16, v132
    v_sub_f32 v17, v17, v132
    v_sub_f32 v18, v18, v132
    v_sub_f32 v19, v19, v132
    v_sub_f32 v20, v20, v132
    v_sub_f32 v21, v21, v132
    v_sub_f32 v22, v22, v132
    v_sub_f32 v23, v23, v132
    v_sub_f32 v24, v24, v134
    v_sub_f32 v25, v25, v134
    v_sub_f32 v26, v26, v134
    v_sub_f32 v27, v27, v134
    v_sub_f32 v28, v28, v134
    v_sub_f32 v29, v29, v134
    v_sub_f32 v30, v30, v134
    v_sub_f32 v31, v31, v134
    s_mov_b32 s35, 32768
    v_add_u32_e64 v241, s35, v240
    s_sub_u32 s36, s36, 1
    s_cbranch_scc1 kf_fix3
kf_fixr4:
    v_mfma_f32_16x16x32_bf16 v[32:35], a[224:227], a[128:131], v[64:67]
    ds_read_b128 a[192:195], v241 offset:0
    v_exp_f32_e64 v128, v0
    v_mfma_f32_16x16x32_bf16 v[32:35], a[228:231], a[132:135], v[32:35]
    v_exp_f32_e64 v129, v1
    v_mfma_f32_16x16x32_bf16 v[32:35], a[232:235], a[136:139], v[32:35]
    v_exp_f32_e64 v130, v2
    v_cvt_pk_bf16_f32 v96, v128, v129
    v_mfma_f32_16x16x32_bf16 v[32:35], a[236:239], a[140:143], v[32:35]
    v_exp_f32_e64 v131, v3
    v_mfma_f32_16x16x32_bf16 v[40:43], a[224:227], a[144:147], v[72:75]
    ds_read_b128 a[196:199], v241 offset:2048
    v_exp_f32_e64 v132, v4
    v_mfma_f32_16x16x32_bf16 v[40:43], a[228:231], a[148:151], v[40:43]
    v_exp_f32_e64 v133, v5
    v_cvt_pk_bf16_f32 v97, v130, v131
    v_mfma_f32_16x16x32_bf16 v[40:43], a[232:235], a[152:155], v[40:43]
    v_exp_f32_e64 v134, v6
    v_cvt_pk_bf16_f32 v98, v132, v133
    v_mfma_f32_16x16x32_bf16 v[40:43], a[236:239], a[156:159], v[40:43]
    v_exp_f32_e64 v135, v7
    v_mfma_f32_16x16x32_bf16 v[48:51], a[224:227], a[160:163], v[80:83]
    ds_read_b128 a[200:203], v241 offset:4096
    v_exp_f32_e64 v136, v8
    v_mfma_f32_16x16x32_bf16 v[48:51], a[228:231], a[164:167], v[48:51]
    v_exp_f32_e64 v137, v9
    v_cvt_pk_bf16_f32 v99, v134, v135
    v_mfma_f32_16x16x32_bf16 v[48:51], a[232:235], a[168:171], v[48:51]
    v_exp_f32 v138, v10
    v_exp_f32 v139, v11
    v_mfma_f32_16x16x32_bf16 v[48:51], a[236:239], a[172:175], v[48:51]
    v_exp_f32_e64 v140, v12
    v_cvt_pk_bf16_f32 v100, v136, v137
    v_mfma_f32_16x16x32_bf16 v[56:59], a[224:227], a[176:179], v[88:91]
    ds_read_b128 a[204:207], v241 offset:6144
    v_exp_f32_e64 v141, v13
    v_mfma_f32_16x16x32_bf16 v[56:59], a[228:231], a[180:183], v[56:59]
    v_exp_f32_e64 v142, v14
    v_cvt_pk_bf16_f32 v101, v138, v139
    v_mfma_f32_16x16x32_bf16 v[56:59], a[232:235], a[184:187], v[56:59]
    v_exp_f32_e64 v143, v15
    v_cvt_pk_bf16_f32 v102, v140, v141
    v_mfma_f32_16x16x32_bf16 v[56:59], a[236:239], a[188:191], v[56:59]
    v_exp_f32_e64 v128, v16
    v_cvt_pk_bf16_f32 v103, v142, v143
    v_mfma_f32_16x16x32_bf16 v[36:39], a[240:243], a[128:131], v[68:71]
    ds_read_b128 a[208:211], v241 offset:1024
    v_exp_f32_e64 v129, v17
    v_mfma_f32_16x16x32_bf16 v[36:39], a[244:247], a[132:135], v[36:39]
    v_exp_f32_e64 v130, v18
    v_cvt_pk_bf16_f32 v104, v128, v129
    v_mfma_f32_16x16x32_bf16 v[36:39], a[248:251], a[136:139], v[36:39]
    v_exp_f32_e64 v131, v19
    v_mfma_f32_16x16x32_bf16 v[36:39], a[252:255], a[140:143], v[36:39]
    v_exp_f32_e64 v132, v20
    v_cvt_pk_bf16_f32 v105, v130, v131
    v_mfma_f32_16x16x32_bf16 v[44:47], a[240:243], a[144:147], v[76:79]
    ds_read_b128 a[212:215], v241 offset:3072
    v_exp_f32_e64 v133, v21
    v_mfma_f32_16x16x32_bf16 v[44:47], a[244:247], a[148:151], v[44:47]
    v_exp_f32 v134, v22
    v_exp_f32 v135, v23
    v_mfma_f32_16x16x32_bf16 v[44:47], a[248:251], a[152:155], v[44:47]
    v_exp_f32_e64 v136, v24
    v_cvt_pk_bf16_f32 v106, v132, v133
    v_mfma_f32_16x16x32_bf16 v[44:47], a[252:255], a[156:159], v[44:47]
    v_exp_f32_e64 v137, v25
    v_cvt_pk_bf16_f32 v107, v134, v135
    v_mfma_f32_16x16x32_bf16 v[52:55], a[240:243], a[160:163], v[84:87]
    ds_read_b128 a[216:219], v241 offset:5120
    v_exp_f32_e64 v138, v26
    v_mfma_f32_16x16x32_bf16 v[52:55], a[244:247], a[164:167], v[52:55]
    v_exp_f32_e64 v139, v27
    v_cvt_pk_bf16_f32 v108, v136, v137
    v_mfma_f32_16x16x32_bf16 v[52:55], a[248:251], a[168:171], v[52:55]
    v_exp_f32_e64 v140, v28
    v_cvt_pk_bf16_f32 v109, v138, v139
    v_mfma_f32_16x16x32_bf16 v[52:55], a[252:255], a[172:175], v[52:55]
    v_exp_f32_e64 v141, v29
    v_mfma_f32_16x16x32_bf16 v[60:63], a[240:243], a[176:179], v[92:95]
    ds_read_b128 a[220:223], v241 offset:7168
    v_exp_f32_e64 v142, v30
    v_mfma_f32_16x16x32_bf16 v[60:63], a[244:247], a[180:183], v[60:63]
    v_exp_f32_e64 v143, v31
    v_cvt_pk_bf16_f32 v110, v140, v141
    v_mfma_f32_16x16x32_bf16 v[60:63], a[248:251], a[184:187], v[60:63]
    v_cvt_pk_bf16_f32 v111, v142, v143
    v_mfma_f32_16x16x32_bf16 v[60:63], a[252:255], a[188:191], v[60:63]
    v_add_f32 v200, 0, v243
    v_min_f32 v200, 0, v200
    v_add_f32 v201, 0xf1800000, v243
    v_min_f32_e64 v201, 0, v201
    v_add_f32 v202, 0xf2000000, v243
    v_min_f32_e64 v202, 0, v202
    v_add_f32 v203, 0xf2400000, v243
    v_min_f32_e64 v203, 0, v203
    v_add_f32 v209, 0xf3000000, v243
    v_min_f32_e64 v209, 0, v209
    v_add_f32 v210, 0xf3100000, v243
    v_min_f32_e64 v210, 0, v210
    v_add_f32 v211, 0xf3200000, v243
    v_min_f32_e64 v211, 0, v211
    v_add_f32 v212, 0xf3300000, v243
    v_min_f32_e64 v212, 0, v212
    v_add_f32 v213, 0x73800000, v243
    v_min_f32_e64 v213, 0, v213
    v_add_f32 v214, 0x73700000, v243
    v_min_f32_e64 v214, 0, v214
    v_add_f32 v215, 0x73600000, v243
    v_min_f32_e64 v215, 0, v215
    v_add_f32 v216, 0x73500000, v243
    v_min_f32_e64 v216, 0, v216
    v_add_f32 v217, 0x73000000, v243
    v_min_f32_e64 v217, 0, v217
    v_add_f32 v218, 0x72e00000, v243
    v_min_f32_e64 v218, 0, v218
    v_add_f32 v219, 0x72c00000, v243
    v_min_f32_e64 v219, 0, v219
    v_add_f32 v220, 0x72a00000, v243
    v_min_f32_e64 v220, 0, v220
    ds_read_b128 a[224:227], v241 offset:16384
    ds_read_b128 a[228:231], v241 offset:17408
    ds_read_b128 a[232:235], v241 offset:18432
    ds_read_b128 a[236:239], v241 offset:19456
    s_mul_i32 s27, s5, 68096
    s_sub_u32 s27, s32, s27
    s_add_u32 s18, s27, 1089536
    s_mov_b32 s31, s101
    v_mul_u32_u24 v245, 448, v240
    v_and_b32 v230, 0x40000000, v251
    v_or_b32 v245, v245, v230
    s_lshl1_add_u32 s26, s5, s31
    s_branch ka_p1_e
.p2align 5
ka_p1:
    s_sub_u32 s36, s36, 1
    s_cbranch_scc1 kf_fix5
kf_fixr6:
    s_waitcnt lgkmcnt(8)
    v_mfma_f32_16x16x32_bf16 v[0:3], a[192:195], a[128:131], v[64:67]
    ds_read_b128 a[240:243], v241 offset:20480
    s_waitcnt vmcnt(11)
    v_mfma_f32_16x16x32_bf16 v[0:3], a[196:199], a[132:135], v[0:3]
    v_exp_f32_e64 v128, v32
    v_mfma_f32_16x16x32_bf16 v[0:3], a[200:203], a[136:139], v[0:3]
    v_exp_f32_e64 v129, v33
    v_mfma_f32_16x16x32_bf16 v[0:3], a[204:207], a[140:143], v[0:3]
    v_exp_f32_e64 v130, v34
    v_mfma_f32_16x16x32_bf16 v[8:11], a[192:195], a[144:147], v[72:75]
    ds_read_b128 a[244:247], v241 offset:21504
    buffer_store_dwordx4 v[192:195], v255, s[48:51], s45 offen offset:0 sc1
    v_mfma_f32_16x16x32_bf16 v[8:11], a[196:199], a[148:151], v[8:11]
    s_cmp_lt_u32 s44, s47
    s_cselect_b32 s101, s44, s43
    v_mfma_f32_16x16x32_bf16 v[8:11], a[200:203], a[152:155], v[8:11]
    buffer_load_dwordx4 v[192:195], v253, s[52:55], s101 offen
    v_cvt_pk_bf16_f32 v112, v128, v129
    v_mfma_f32_16x16x32_bf16 v[8:11], a[204:207], a[156:159], v[8:11]
    v_exp_f32_e64 v131, v35
    v_mfma_f32_16x16x32_bf16 v[16:19], a[192:195], a[160:163], v[80:83]
    ds_read_b128 a[248:251], v241 offset:22528
    v_cvt_pk_bf16_f32 v113, v130, v131
    v_mfma_f32_16x16x32_bf16 v[16:19], a[196:199], a[164:167], v[16:19]
    v_exp_f32_e64 v132, v36
    v_mfma_f32_16x16x32_bf16 v[16:19], a[200:203], a[168:171], v[16:19]
    v_exp_f32_e64 v133, v37
    v_mfma_f32_16x16x32_bf16 v[16:19], a[204:207], a[172:175], v[16:19]
    v_exp_f32_e64 v134, v38
    v_mfma_f32_16x16x32_bf16 v[24:27], a[192:195], a[176:179], v[88:91]
    ds_read_b128 a[252:255], v241 offset:23552
    s_mov_b32 m0, s34
    v_mfma_f32_16x16x32_bf16 v[24:27], a[196:199], a[180:183], v[24:27]
    s_add_u32 s41, s42, 17664
    v_cvt_pk_bf16_f32 v114, v132, v133
    v_mfma_f32_16x16x32_bf16 v[24:27], a[200:203], a[184:187], v[24:27]
    v_exp_f32 v135, v39
    v_mfma_f32_16x16x32_bf16 v[24:27], a[204:207], a[188:191], v[24:27]
    v_cvt_pk_bf16_f32 v115, v134, v135
    s_waitcnt lgkmcnt(8)
    v_mfma_f32_16x16x32_bf16 v[4:7], a[208:211], a[128:131], v[68:71]
    ds_read_b128 a[192:195], v241 offset:8192
    buffer_load_dwordx4 v242, s[16:19], s41 offen offset:0 sc1 lds
    v_mfma_f32_16x16x32_bf16 v[4:7], a[212:215], a[132:135], v[4:7]
    v_exp_f32 v136, v40
    v_mfma_f32_16x16x32_bf16 v[4:7], a[216:219], a[136:139], v[4:7]
    v_exp_f32_e64 v137, v41
    v_mfma_f32_16x16x32_bf16 v[4:7], a[220:223], a[140:143], v[4:7]
    v_exp_f32_e64 v138, v42
    v_mfma_f32_16x16x32_bf16 v[12:15], a[208:211], a[144:147], v[76:79]
    ds_read_b128 a[196:199], v241 offset:10240
    v_cvt_pk_bf16_f32 v116, v136, v137
    v_mfma_f32_16x16x32_bf16 v[12:15], a[212:215], a[148:151], v[12:15]
    v_exp_f32_e64 v139, v43
    v_mfma_f32_16x16x32_bf16 v[12:15], a[216:219], a[152:155], v[12:15]
    v_exp_f32_e64 v140, v44
    v_mfma_f32_16x16x32_bf16 v[12:15], a[220:223], a[156:159], v[12:15]
    v_exp_f32_e64 v141, v45
    v_mfma_f32_16x16x32_bf16 v[20:23], a[208:211], a[160:163], v[84:87]
    ds_read_b128 a[200:203], v241 offset:12288
    v_cvt_pk_bf16_f32 v117, v138, v139
    v_mfma_f32_16x16x32_bf16 v[20:23], a[212:215], a[164:167], v[20:23]
    v_exp_f32_e64 v142, v46
    v_mfma_f32_16x16x32_bf16 v[20:23], a[216:219], a[168:171], v[20:23]
    v_exp_f32_e64 v143, v47
    v_mfma_f32_16x16x32_bf16 v[20:23], a[220:223], a[172:175], v[20:23]
    v_exp_f32_e64 v128, v48
    v_mfma_f32_16x16x32_bf16 v[28:31], a[208:211], a[176:179], v[92:95]
    ds_read_b128 a[204:207], v241 offset:14336
    buffer_load_dwordx4 v242, s[16:19], s41 offen offset:1024 sc1 lds
    v_mfma_f32_16x16x32_bf16 v[28:31], a[212:215], a[180:183], v[28:31]
    v_exp_f32_e64 v129, v49
    v_mfma_f32_16x16x32_bf16 v[28:31], a[216:219], a[184:187], v[28:31]
    v_exp_f32_e64 v130, v50
    v_mfma_f32_16x16x32_bf16 v[28:31], a[220:223], a[188:191], v[28:31]
    v_cvt_pk_bf16_f32 v118, v140, v141
    s_waitcnt lgkmcnt(8)
    v_mfma_f32_16x16x32_bf16 a[0:3], a[224:227], v[96:99], a[0:3]
    ds_read_b128 a[208:211], v241 offset:9216
    v_cvt_pk_bf16_f32 v119, v142, v143
    v_mfma_f32_16x16x32_bf16 a[32:35], a[224:227], v[100:103], a[32:35]
    v_exp_f32 v131, v51
    v_mfma_f32_16x16x32_bf16 a[64:67], a[224:227], v[104:107], a[64:67]
    v_exp_f32_e64 v132, v52
    v_mfma_f32_16x16x32_bf16 a[96:99], a[224:227], v[108:111], a[96:99]
    v_exp_f32_e64 v133, v53
    v_mfma_f32_16x16x32_bf16 a[4:7], a[228:231], v[96:99], a[4:7]
    ds_read_b128 a[212:215], v241 offset:11264
    v_cvt_pk_bf16_f32 v120, v128, v129
    v_mfma_f32_16x16x32_bf16 a[36:39], a[228:231], v[100:103], a[36:39]
    buffer_load_dwordx4 v242, s[16:19], s41 offen offset:2048 sc1 lds
    v_cvt_pk_bf16_f32 v121, v130, v131
    v_mfma_f32_16x16x32_bf16 a[68:71], a[228:231], v[104:107], a[68:71]
    v_exp_f32_e64 v134, v54
    v_mfma_f32_16x16x32_bf16 a[100:103], a[228:231], v[108:111], a[100:103]
    v_exp_f32_e64 v135, v55
    v_mfma_f32_16x16x32_bf16 a[8:11], a[232:235], v[96:99], a[8:11]
    ds_read_b128 a[216:219], v241 offset:13312
    v_cvt_pk_bf16_f32 v122, v132, v133
    v_mfma_f32_16x16x32_bf16 a[40:43], a[232:235], v[100:103], a[40:43]
    v_exp_f32_e64 v136, v56
    v_mfma_f32_16x16x32_bf16 a[72:75], a[232:235], v[104:107], a[72:75]
    v_exp_f32_e64 v137, v57
    v_mfma_f32_16x16x32_bf16 a[104:107], a[232:235], v[108:111], a[104:107]
    v_exp_f32_e64 v138, v58
    v_mfma_f32_16x16x32_bf16 a[12:15], a[236:239], v[96:99], a[12:15]
    ds_read_b128 a[220:223], v241 offset:15360
    v_cvt_pk_bf16_f32 v123, v134, v135
    v_mfma_f32_16x16x32_bf16 a[44:47], a[236:239], v[100:103], a[44:47]
    v_exp_f32_e64 v139, v59
    v_mfma_f32_16x16x32_bf16 a[76:79], a[236:239], v[104:107], a[76:79]
    buffer_load_dwordx4 v242, s[16:19], s41 offen offset:3072 sc1 lds
    v_cvt_pk_bf16_f32 v124, v136, v137
    v_mfma_f32_16x16x32_bf16 a[108:111], a[236:239], v[108:111], a[108:111]
    v_cvt_pk_bf16_f32 v125, v138, v139
    s_waitcnt lgkmcnt(8)
    v_mfma_f32_16x16x32_bf16 a[16:19], a[240:243], v[96:99], a[16:19]
    ds_read_b128 a[224:227], v241 offset:24576
    v_mfma_f32_16x16x32_bf16 a[48:51], a[240:243], v[100:103], a[48:51]
    v_exp_f32 v140, v60
    v_mfma_f32_16x16x32_bf16 a[80:83], a[240:243], v[104:107], a[80:83]
    v_exp_f32_e64 v141, v61
    v_mfma_f32_16x16x32_bf16 a[112:115], a[240:243], v[108:111], a[112:115]
    v_exp_f32_e64 v142, v62
    v_mfma_f32_16x16x32_bf16 a[20:23], a[244:247], v[96:99], a[20:23]
    ds_read_b128 a[228:231], v241 offset:25600
    v_cvt_pk_bf16_f32 v126, v140, v141
    v_mfma_f32_16x16x32_bf16 a[52:55], a[244:247], v[100:103], a[52:55]
    v_exp_f32_e64 v143, v63
    v_mfma_f32_16x16x32_bf16 a[84:87], a[244:247], v[104:107], a[84:87]
    v_cvt_pk_bf16_f32 v127, v142, v143
    s_add_u32 s35, s35, 32768
    v_mfma_f32_16x16x32_bf16 a[116:119], a[244:247], v[108:111], a[116:119]
    s_cmp_ge_u32 s35, 163840
    s_cselect_b32 s35, 0, s35
    v_mfma_f32_16x16x32_bf16 a[24:27], a[248:251], v[96:99], a[24:27]
    ds_read_b128 a[232:235], v241 offset:26624
    v_mfma_f32_16x16x32_bf16 a[56:59], a[248:251], v[100:103], a[56:59]
    v_mfma_f32_16x16x32_bf16 a[88:91], a[248:251], v[104:107], a[88:91]
    v_mfma_f32_16x16x32_bf16 a[120:123], a[248:251], v[108:111], a[120:123]
    v_mfma_f32_16x16x32_bf16 a[28:31], a[252:255], v[96:99], a[28:31]
    ds_read_b128 a[236:239], v241 offset:27648
    v_mfma_f32_16x16x32_bf16 a[60:63], a[252:255], v[100:103], a[60:63]
    v_mfma_f32_16x16x32_bf16 a[92:95], a[252:255], v[104:107], a[92:95]
    v_mfma_f32_16x16x32_bf16 a[124:127], a[252:255], v[108:111], a[124:127]
    v_mfma_f32_16x16x32_bf16 v[144:147], v[204:207], v[96:99], v[144:147]
    v_mfma_f32_16x16x32_bf16 v[148:151], v[204:207], v[100:103], v[148:151]
    v_mfma_f32_16x16x32_bf16 v[152:155], v[204:207], v[104:107], v[152:155]
    v_mfma_f32_16x16x32_bf16 v[156:159], v[204:207], v[108:111], v[156:159]
    s_sub_u32 s36, s36, 1
    s_cbranch_scc1 kf_fix7
kf_fixr8:
    s_waitcnt lgkmcnt(8)
    v_mfma_f32_16x16x32_bf16 v[32:35], a[192:195], a[128:131], v[64:67]
    ds_read_b128 a[240:243], v241 offset:28672
    s_waitcnt vmcnt(11)
    v_mfma_f32_16x16x32_bf16 v[32:35], a[196:199], a[132:135], v[32:35]
    v_exp_f32 v128, v0
    v_mfma_f32_16x16x32_bf16 v[32:35], a[200:203], a[136:139], v[32:35]
    v_exp_f32_e64 v129, v1
    v_mfma_f32_16x16x32_bf16 v[32:35], a[204:207], a[140:143], v[32:35]
    v_exp_f32_e64 v130, v2
    v_mfma_f32_16x16x32_bf16 v[40:43], a[192:195], a[144:147], v[72:75]
    ds_read_b128 a[244:247], v241 offset:29696
    buffer_store_dwordx4 v[196:199], v255, s[48:51], s45 offen offset:256 sc1
    v_mfma_f32_16x16x32_bf16 v[40:43], a[196:199], a[148:151], v[40:43]
    s_add_u32 s101, s101, 57344
    buffer_load_dwordx4 v[196:199], v253, s[52:55], s101 offen
    v_mfma_f32_16x16x32_bf16 v[40:43], a[200:203], a[152:155], v[40:43]
    v_exp_f32_e64 v131, v3
    v_mfma_f32_16x16x32_bf16 v[40:43], a[204:207], a[156:159], v[40:43]
    v_exp_f32_e64 v132, v4
    v_mfma_f32_16x16x32_bf16 v[48:51], a[192:195], a[160:163], v[80:83]
    ds_read_b128 a[248:251], v241 offset:30720
    v_cvt_pk_bf16_f32 v96, v128, v129
    v_mfma_f32_16x16x32_bf16 v[48:51], a[196:199], a[164:167], v[48:51]
    s_cmp_lt_u32 s44, s47
    s_cselect_b32 s45, s46, s43
    v_mfma_f32_16x16x32_bf16 v[48:51], a[200:203], a[168:171], v[48:51]
    v_exp_f32_e64 v133, v5
    v_mfma_f32_16x16x32_bf16 v[48:51], a[204:207], a[172:175], v[48:51]
    v_exp_f32_e64 v134, v6
    v_mfma_f32_16x16x32_bf16 v[56:59], a[192:195], a[176:179], v[88:91]
    ds_read_b128 a[252:255], v241 offset:31744
    s_add_u32 s44, s44, 128
    v_mfma_f32_16x16x32_bf16 v[56:59], a[196:199], a[180:183], v[56:59]
    s_add_u32 s46, s46, 262144
    v_cvt_pk_bf16_f32 v97, v130, v131
    v_mfma_f32_16x16x32_bf16 v[56:59], a[200:203], a[184:187], v[56:59]
    v_exp_f32_e64 v135, v7
    v_mfma_f32_16x16x32_bf16 v[56:59], a[204:207], a[188:191], v[56:59]
    v_cvt_pk_bf16_f32 v98, v132, v133
    s_waitcnt lgkmcnt(8)
    v_mfma_f32_16x16x32_bf16 v[36:39], a[208:211], a[128:131], v[68:71]
    s_waitcnt vmcnt(16)
    s_barrier
    v_add_u32 v241, s35, v240
    ds_read_b128 a[192:195], v241 offset:0
    v_mfma_f32_16x16x32_bf16 v[36:39], a[212:215], a[132:135], v[36:39]
    v_exp_f32_e64 v136, v8
    v_mfma_f32_16x16x32_bf16 v[36:39], a[216:219], a[136:139], v[36:39]
    v_exp_f32_e64 v137, v9
    v_mfma_f32_16x16x32_bf16 v[36:39], a[220:223], a[140:143], v[36:39]
    v_exp_f32_e64 v138, v10
    v_mfma_f32_16x16x32_bf16 v[44:47], a[208:211], a[144:147], v[76:79]
    ds_read_b128 a[196:199], v241 offset:2048
    s_add_u32 m0, s34, 16384
    v_mfma_f32_16x16x32_bf16 v[44:47], a[212:215], a[148:151], v[44:47]
    s_add_u32 s34, s34, 32768
    v_cvt_pk_bf16_f32 v99, v134, v135
    v_mfma_f32_16x16x32_bf16 v[44:47], a[216:219], a[152:155], v[44:47]
    s_cmp_ge_u32 s34, 163840
    s_cselect_b32 s34, s37, s34
    v_mfma_f32_16x16x32_bf16 v[44:47], a[220:223], a[156:159], v[44:47]
    v_exp_f32 v139, v11
    v_mfma_f32_16x16x32_bf16 v[52:55], a[208:211], a[160:163], v[84:87]
    ds_read_b128 a[200:203], v241 offset:4096
    v_cvt_pk_bf16_f32 v100, v136, v137
    v_mfma_f32_16x16x32_bf16 v[52:55], a[212:215], a[164:167], v[52:55]
    v_exp_f32_e64 v140, v12
    v_mfma_f32_16x16x32_bf16 v[52:55], a[216:219], a[168:171], v[52:55]
    v_exp_f32_e64 v141, v13
    v_mfma_f32_16x16x32_bf16 v[52:55], a[220:223], a[172:175], v[52:55]
    v_exp_f32_e64 v142, v14
    v_mfma_f32_16x16x32_bf16 v[60:63], a[208:211], a[176:179], v[92:95]
    ds_read_b128 a[204:207], v241 offset:6144
    buffer_load_dwordx4 v242, s[16:19], s42 offen offset:0 sc1 lds
    v_mfma_f32_16x16x32_bf16 v[60:63], a[212:215], a[180:183], v[60:63]
    v_exp_f32_e64 v143, v15
    v_mfma_f32_16x16x32_bf16 v[60:63], a[216:219], a[184:187], v[60:63]
    v_exp_f32_e64 v128, v16
    v_mfma_f32_16x16x32_bf16 v[60:63], a[220:223], a[188:191], v[60:63]
    v_cvt_pk_bf16_f32 v101, v138, v139
    s_waitcnt lgkmcnt(8)
    v_mfma_f32_16x16x32_bf16 a[0:3], a[224:227], v[112:115], a[0:3]
    ds_read_b128 a[208:211], v241 offset:1024
    v_cvt_pk_bf16_f32 v102, v140, v141
    v_mfma_f32_16x16x32_bf16 a[32:35], a[224:227], v[116:119], a[32:35]
    v_exp_f32 v129, v17
    v_mfma_f32_16x16x32_bf16 a[64:67], a[224:227], v[120:123], a[64:67]
    v_exp_f32_e64 v130, v18
    v_mfma_f32_16x16x32_bf16 a[96:99], a[224:227], v[124:127], a[96:99]
    v_exp_f32_e64 v131, v19
    v_mfma_f32_16x16x32_bf16 a[4:7], a[228:231], v[112:115], a[4:7]
    ds_read_b128 a[212:215], v241 offset:3072
    buffer_load_dwordx4 v242, s[16:19], s42 offen offset:1024 sc1 lds
    v_mfma_f32_16x16x32_bf16 a[36:39], a[228:231], v[116:119], a[36:39]
    v_exp_f32_e64 v132, v20
    v_mfma_f32_16x16x32_bf16 a[68:71], a[228:231], v[120:123], a[68:71]
    v_exp_f32_e64 v133, v21
    v_mfma_f32_16x16x32_bf16 a[100:103], a[228:231], v[124:127], a[100:103]
    v_cvt_pk_bf16_f32 v103, v142, v143
    v_cvt_pk_bf16_f32 v104, v128, v129
    v_mfma_f32_16x16x32_bf16 a[8:11], a[232:235], v[112:115], a[8:11]
    ds_read_b128 a[216:219], v241 offset:5120
    v_cvt_pk_bf16_f32 v105, v130, v131
    v_mfma_f32_16x16x32_bf16 a[40:43], a[232:235], v[116:119], a[40:43]
    v_exp_f32_e64 v134, v22
    v_mfma_f32_16x16x32_bf16 a[72:75], a[232:235], v[120:123], a[72:75]
    buffer_load_dwordx4 v242, s[16:19], s42 offen offset:2048 sc1 lds
    v_cvt_pk_bf16_f32 v106, v132, v133
    v_mfma_f32_16x16x32_bf16 a[104:107], a[232:235], v[124:127], a[104:107]
    v_exp_f32_e64 v135, v23
    v_mfma_f32_16x16x32_bf16 a[12:15], a[236:239], v[112:115], a[12:15]
    ds_read_b128 a[220:223], v241 offset:7168
    v_cvt_pk_bf16_f32 v107, v134, v135
    v_mfma_f32_16x16x32_bf16 a[44:47], a[236:239], v[116:119], a[44:47]
    v_exp_f32_e64 v136, v24
    v_mfma_f32_16x16x32_bf16 a[76:79], a[236:239], v[120:123], a[76:79]
    v_exp_f32_e64 v137, v25
    v_mfma_f32_16x16x32_bf16 a[108:111], a[236:239], v[124:127], a[108:111]
    v_cvt_pk_bf16_f32 v108, v136, v137
    s_waitcnt lgkmcnt(8)
    v_mfma_f32_16x16x32_bf16 a[16:19], a[240:243], v[112:115], a[16:19]
    ds_read_b128 a[224:227], v241 offset:16384
    buffer_load_dwordx4 v242, s[16:19], s42 offen offset:3072 sc1 lds
    v_mfma_f32_16x16x32_bf16 a[48:51], a[240:243], v[116:119], a[48:51]
    v_exp_f32 v138, v26
    v_mfma_f32_16x16x32_bf16 a[80:83], a[240:243], v[120:123], a[80:83]
    s_add_u32 s42, s42, 34048
    v_mfma_f32_16x16x32_bf16 a[112:115], a[240:243], v[124:127], a[112:115]
    v_exp_f32_e64 v139, v27
    v_mfma_f32_16x16x32_bf16 a[20:23], a[244:247], v[112:115], a[20:23]
    ds_read_b128 a[228:231], v241 offset:17408
    v_cvt_pk_bf16_f32 v109, v138, v139
    v_mfma_f32_16x16x32_bf16 a[52:55], a[244:247], v[116:119], a[52:55]
    v_exp_f32_e64 v140, v28
    v_mfma_f32_16x16x32_bf16 a[84:87], a[244:247], v[120:123], a[84:87]
    v_exp_f32_e64 v141, v29
    v_mfma_f32_16x16x32_bf16 a[116:119], a[244:247], v[124:127], a[116:119]
    v_exp_f32_e64 v142, v30
    v_mfma_f32_16x16x32_bf16 a[24:27], a[248:251], v[112:115], a[24:27]
    ds_read_b128 a[232:235], v241 offset:18432
    v_cvt_pk_bf16_f32 v110, v140, v141
    v_mfma_f32_16x16x32_bf16 a[56:59], a[248:251], v[116:119], a[56:59]
    buffer_load_dword v252, v251, s[60:63], s100 offen
    s_add_u32 s100, s100, 2048
    v_mfma_f32_16x16x32_bf16 a[88:91], a[248:251], v[120:123], a[88:91]
    v_exp_f32_e64 v143, v31
    v_mfma_f32_16x16x32_bf16 a[120:123], a[248:251], v[124:127], a[120:123]
    v_cvt_pk_bf16_f32 v111, v142, v143
    v_mfma_f32_16x16x32_bf16 a[28:31], a[252:255], v[112:115], a[28:31]
    ds_read_b128 a[236:239], v241 offset:19456
    v_mfma_f32_16x16x32_bf16 a[60:63], a[252:255], v[116:119], a[60:63]
    v_mfma_f32_16x16x32_bf16 a[92:95], a[252:255], v[120:123], a[92:95]
    v_mfma_f32_16x16x32_bf16 a[124:127], a[252:255], v[124:127], a[124:127]
    v_mfma_f32_16x16x32_bf16 v[144:147], v[204:207], v[112:115], v[144:147]
    v_mfma_f32_16x16x32_bf16 v[148:151], v[204:207], v[116:119], v[148:151]
    v_mfma_f32_16x16x32_bf16 v[152:155], v[204:207], v[120:123], v[152:155]
    v_mfma_f32_16x16x32_bf16 v[156:159], v[204:207], v[124:127], v[156:159]
ka_p1_e:
    s_sub_u32 s26, s26, 1
    s_cbranch_scc0 ka_p1
    s_branch ka_p1_x
kf_fix5:
    s_mov_b32 s24, 0
    s_branch kf_fix5c
kf_fix7:
    s_mov_b32 s24, 1
kf_fix5c:
    s_cmp_eq_u32 s33, 0
    s_cbranch_scc0 kf_fix5f
    s_mov_b32 s36, 0
    s_mov_b32 s33, 1
    v_add_f32 v64, v224, v200
    v_add_f32 v65, v224, v201
    v_add_f32 v66, v224, v202
    v_add_f32 v67, v224, v203
    v_add_f32 v68, v224, v209
    v_add_f32 v69, v224, v210
    v_add_f32 v70, v224, v211
    v_add_f32 v71, v224, v212
    v_add_f32 v72, v225, v213
    v_add_f32 v73, v225, v214
    v_add_f32 v74, v225, v215
    v_add_f32 v75, v225, v216
    v_add_f32 v76, v225, v217
    v_add_f32 v77, v225, v218
    v_add_f32 v78, v225, v219
    v_add_f32_e64 v79, v225, v220
    s_cmp_eq_u32 s24, 0
    s_cbranch_scc1 kf_fixr6
    s_branch kf_fixr8
kf_fix5f:
    s_mov_b32 s36, 0x1000
    v_mov_b32 v64, 0xf1800000
    v_mov_b32 v65, v64
    v_mov_b32 v66, v64
    v_mov_b32 v67, v64
    v_mov_b32 v68, v64
    v_mov_b32 v69, v64
    v_mov_b32 v70, v64
    v_mov_b32 v71, v64
    v_mov_b32 v72, v64
    v_mov_b32 v73, v64
    v_mov_b32 v74, v64
    v_mov_b32 v75, v64
    v_mov_b32 v76, v64
    v_mov_b32 v77, v64
    v_mov_b32 v78, v64
    v_mov_b32 v79, v64
    s_cmp_eq_u32 s24, 0
    s_cbranch_scc1 kf_fixr6
    s_branch kf_fixr8
kf_fix9:
    s_mov_b32 s24, 0
    s_branch kf_fix9c
kf_fix11:
    s_mov_b32 s24, 1
kf_fix9c:
    s_cmp_eq_u32 s33, 0
    s_cbranch_scc0 kf_fix9f
    s_mov_b32 s36, 0
    s_mov_b32 s33, 1
    v_add_f32 v80, v226, v200
    v_add_f32 v81, v226, v201
    v_add_f32 v82, v226, v202
    v_add_f32 v83, v226, v203
    v_add_f32 v84, v226, v209
    v_add_f32 v85, v226, v210
    v_add_f32 v86, v226, v211
    v_add_f32 v87, v226, v212
    v_add_f32 v88, v227, v213
    v_add_f32 v89, v227, v214
    v_add_f32 v90, v227, v215
    v_add_f32 v91, v227, v216
    v_add_f32 v92, v227, v217
    v_add_f32 v93, v227, v218
    v_add_f32 v94, v227, v219
    v_add_f32 v95, v227, v220
    s_cmp_eq_u32 s24, 0
    s_cbranch_scc1 kf_fixr10
    s_branch kf_fixr12
kf_fix9f:
    s_mov_b32 s36, 0x1000
    v_mov_b32 v80, 0xf1800000
    v_mov_b32 v81, v80
    v_mov_b32 v82, v80
    v_mov_b32 v83, v80
    v_mov_b32 v84, v80
    v_mov_b32 v85, v80
    v_mov_b32 v86, v80
    v_mov_b32 v87, v80
    v_mov_b32 v88, v80
    v_mov_b32 v89, v80
    v_mov_b32 v90, v80
    v_mov_b32 v91, v80
    v_mov_b32 v92, v80
    v_mov_b32 v93, v80
    v_mov_b32 v94, v80
    v_mov_b32_e64 v95, v80
    s_cmp_eq_u32 s24, 0
    s_cbranch_scc1 kf_fixr10
    s_branch kf_fixr12
ka_p1_x:
    s_lshl2_add_u32 s36, s5, s6
    s_lshl1_add_u32 s36, s31, s36
    s_sub_u32 s36, 61, s36
    s_mov_b32 s33, 0
    s_sub_u32 s36, s36, 1
    s_cbranch_scc1 kf_fix9
kf_fixr10:
    s_waitcnt lgkmcnt(8)
    v_mfma_f32_16x16x32_bf16 v[16:19], a[192:195], a[160:163], v[80:83]
    ds_read_b128 a[240:243], v241 offset:20480
    ds_read_b128 a[244:247], v241 offset:21504
    v_mfma_f32_16x16x32_bf16 v[16:19], a[196:199], a[164:167], v[16:19]
    v_exp_f32_e64 v128, v32
    v_mfma_f32_16x16x32_bf16 v[16:19], a[200:203], a[168:171], v[16:19]
    v_exp_f32_e64 v129, v33
    v_mfma_f32_16x16x32_bf16 v[16:19], a[204:207], a[172:175], v[16:19]
    s_waitcnt vmcnt(11)
    v_exp_f32 v130, v34
    v_mfma_f32_16x16x32_bf16 v[24:27], a[192:195], a[176:179], v[88:91]
    ds_read_b128 a[248:251], v241 offset:22528
    ds_read_b128 a[252:255], v241 offset:23552
    v_mfma_f32_16x16x32_bf16 v[24:27], a[196:199], a[180:183], v[24:27]
    buffer_store_dwordx4 v[192:195], v255, s[48:51], s45 offen offset:0 sc1
    v_cvt_pk_bf16_f32 v112, v128, v129
    v_mfma_f32_16x16x32_bf16 v[24:27], a[200:203], a[184:187], v[24:27]
    v_exp_f32_e64 v131, v35
    v_mfma_f32_16x16x32_bf16 v[24:27], a[204:207], a[188:191], v[24:27]
    s_mov_b32 m0, s34
    s_waitcnt lgkmcnt(8)
    v_mfma_f32_16x16x32_bf16 v[20:23], a[208:211], a[160:163], v[84:87]
    ds_read_b128 a[192:195], v241 offset:8192
    ds_read_b128 a[196:199], v241 offset:10240
    v_mfma_f32_16x16x32_bf16 v[20:23], a[212:215], a[164:167], v[20:23]
    s_add_u32 s41, s42, 17664
    v_exp_f32_e64 v132, v36
    v_mfma_f32_16x16x32_bf16 v[20:23], a[216:219], a[168:171], v[20:23]
    v_exp_f32_e64 v133, v37
    v_mfma_f32_16x16x32_bf16 v[20:23], a[220:223], a[172:175], v[20:23]
    v_exp_f32_e64 v134, v38
    v_mfma_f32_16x16x32_bf16 v[28:31], a[208:211], a[176:179], v[92:95]
    ds_read_b128 a[200:203], v241 offset:12288
    ds_read_b128 a[204:207], v241 offset:14336
    v_mfma_f32_16x16x32_bf16 v[28:31], a[212:215], a[180:183], v[28:31]
    v_exp_f32_e64 v135, v39
    v_mfma_f32_16x16x32_bf16 v[28:31], a[216:219], a[184:187], v[28:31]
    v_exp_f32_e64 v136, v40
    v_mfma_f32_16x16x32_bf16 v[28:31], a[220:223], a[188:191], v[28:31]
    buffer_load_dwordx4 v242, s[16:19], s41 offen offset:0 sc1 lds
    s_waitcnt lgkmcnt(8)
    v_mfma_f32_16x16x32_bf16 a[0:3], a[224:227], v[96:99], a[0:3]
    ds_read_b128 a[208:211], v241 offset:9216
    v_exp_f32 v137, v41
    v_mfma_f32_16x16x32_bf16 a[32:35], a[224:227], v[100:103], a[32:35]
    v_cvt_pk_bf16_f32 v113, v130, v131
    v_cvt_pk_bf16_f32 v114, v132, v133
    v_mfma_f32_16x16x32_bf16 a[64:67], a[224:227], v[104:107], a[64:67]
    v_exp_f32_e64 v138, v42
    v_mfma_f32_16x16x32_bf16 a[96:99], a[224:227], v[108:111], a[96:99]
    v_exp_f32_e64 v139, v43
    v_mfma_f32_16x16x32_bf16 a[4:7], a[228:231], v[96:99], a[4:7]
    ds_read_b128 a[212:215], v241 offset:11264
    v_cvt_pk_bf16_f32 v115, v134, v135
    v_mfma_f32_16x16x32_bf16 a[36:39], a[228:231], v[100:103], a[36:39]
    v_exp_f32_e64 v140, v44
    v_mfma_f32_16x16x32_bf16 a[68:71], a[228:231], v[104:107], a[68:71]
    buffer_load_dwordx4 v242, s[16:19], s41 offen offset:1024 sc1 lds
    v_exp_f32_e64 v141, v45
    v_mfma_f32_16x16x32_bf16 a[100:103], a[228:231], v[108:111], a[100:103]
    v_exp_f32_e64 v142, v46
    v_mfma_f32_16x16x32_bf16 a[8:11], a[232:235], v[96:99], a[8:11]
    ds_read_b128 a[216:219], v241 offset:13312
    v_cvt_pk_bf16_f32 v116, v136, v137
    v_mfma_f32_16x16x32_bf16 a[40:43], a[232:235], v[100:103], a[40:43]
    v_exp_f32_e64 v143, v47
    v_mfma_f32_16x16x32_bf16 a[72:75], a[232:235], v[104:107], a[72:75]
    v_exp_f32_e64 v128, v48
    v_mfma_f32_16x16x32_bf16 a[104:107], a[232:235], v[108:111], a[104:107]
    v_exp_f32_e64 v129, v49
    v_mfma_f32_16x16x32_bf16 a[12:15], a[236:239], v[96:99], a[12:15]
    ds_read_b128 a[220:223], v241 offset:15360
    buffer_load_dwordx4 v242, s[16:19], s41 offen offset:2048 sc1 lds
    v_mfma_f32_16x16x32_bf16 a[44:47], a[236:239], v[100:103], a[44:47]
    v_cvt_pk_bf16_f32 v117, v138, v139
    v_exp_f32_e64 v130, v50
    v_mfma_f32_16x16x32_bf16 a[76:79], a[236:239], v[104:107], a[76:79]
    v_exp_f32_e64 v131, v51
    v_mfma_f32_16x16x32_bf16 a[108:111], a[236:239], v[108:111], a[108:111]
    v_cvt_pk_bf16_f32 v118, v140, v141
    s_waitcnt lgkmcnt(8)
    v_mfma_f32_16x16x32_bf16 a[16:19], a[240:243], v[96:99], a[16:19]
    ds_read_b128 a[224:227], v241 offset:24576
    v_cvt_pk_bf16_f32 v119, v142, v143
    v_mfma_f32_16x16x32_bf16 a[48:51], a[240:243], v[100:103], a[48:51]
    v_exp_f32 v132, v52
    v_mfma_f32_16x16x32_bf16 a[80:83], a[240:243], v[104:107], a[80:83]
    v_exp_f32_e64 v133, v53
    v_mfma_f32_16x16x32_bf16 a[112:115], a[240:243], v[108:111], a[112:115]
    buffer_load_dwordx4 v242, s[16:19], s41 offen offset:3072 sc1 lds
    v_exp_f32_e64 v134, v54
    v_mfma_f32_16x16x32_bf16 a[20:23], a[244:247], v[96:99], a[20:23]
    ds_read_b128 a[228:231], v241 offset:25600
    v_cvt_pk_bf16_f32 v120, v128, v129
    v_mfma_f32_16x16x32_bf16 a[52:55], a[244:247], v[100:103], a[52:55]
    v_exp_f32_e64 v135, v55
    v_mfma_f32_16x16x32_bf16 a[84:87], a[244:247], v[104:107], a[84:87]
    v_exp_f32_e64 v136, v56
    v_mfma_f32_16x16x32_bf16 a[116:119], a[244:247], v[108:111], a[116:119]
    v_exp_f32_e64 v137, v57
    v_mfma_f32_16x16x32_bf16 a[24:27], a[248:251], v[96:99], a[24:27]
    ds_read_b128 a[232:235], v241 offset:26624
    v_cvt_pk_bf16_f32 v121, v130, v131
    v_mfma_f32_16x16x32_bf16 a[56:59], a[248:251], v[100:103], a[56:59]
    v_exp_f32_e64 v138, v58
    v_mfma_f32_16x16x32_bf16 a[88:91], a[248:251], v[104:107], a[88:91]
    s_add_u32 s35, s35, 32768
    s_cmp_ge_u32 s35, 163840
    s_cselect_b32 s35, 0, s35
    v_mfma_f32_16x16x32_bf16 a[120:123], a[248:251], v[108:111], a[120:123]
    v_exp_f32 v139, v59
    v_mfma_f32_16x16x32_bf16 a[28:31], a[252:255], v[96:99], a[28:31]
    ds_read_b128 a[236:239], v241 offset:27648
    v_cvt_pk_bf16_f32 v122, v132, v133
    v_mfma_f32_16x16x32_bf16 a[60:63], a[252:255], v[100:103], a[60:63]
    v_exp_f32_e64 v140, v60
    v_mfma_f32_16x16x32_bf16 a[92:95], a[252:255], v[104:107], a[92:95]
    v_exp_f32_e64 v141, v61
    v_mfma_f32_16x16x32_bf16 a[124:127], a[252:255], v[108:111], a[124:127]
    v_cvt_pk_bf16_f32 v123, v134, v135
    v_cvt_pk_bf16_f32 v124, v136, v137
    v_mfma_f32_16x16x32_bf16 v[144:147], v[204:207], v[96:99], v[144:147]
    v_exp_f32_e64 v142, v62
    v_cvt_pk_bf16_f32 v125, v138, v139
    v_mfma_f32_16x16x32_bf16 v[148:151], v[204:207], v[100:103], v[148:151]
    v_exp_f32_e64 v143, v63
    v_mfma_f32_16x16x32_bf16 v[152:155], v[204:207], v[104:107], v[152:155]
    v_cvt_pk_bf16_f32 v126, v140, v141
    v_cvt_pk_bf16_f32 v127, v142, v143
    v_mfma_f32_16x16x32_bf16 v[156:159], v[204:207], v[108:111], v[156:159]
    s_sub_u32 s36, s36, 1
    s_cbranch_scc1 kf_fix11
kf_fixr12:
    s_waitcnt lgkmcnt(8)
    v_mfma_f32_16x16x32_bf16 v[48:51], a[192:195], a[160:163], v[80:83]
    ds_read_b128 a[240:243], v241 offset:28672
    ds_read_b128 a[244:247], v241 offset:29696
    v_mfma_f32_16x16x32_bf16 v[48:51], a[196:199], a[164:167], v[48:51]
    v_exp_f32 v128, v16
    v_mfma_f32_16x16x32_bf16 v[48:51], a[200:203], a[168:171], v[48:51]
    v_exp_f32_e64 v129, v17
    v_mfma_f32_16x16x32_bf16 v[48:51], a[204:207], a[172:175], v[48:51]
    s_waitcnt vmcnt(10)
    buffer_store_dwordx4 v[196:199], v255, s[48:51], s45 offen offset:256 sc1
    v_mfma_f32_16x16x32_bf16 v[56:59], a[192:195], a[176:179], v[88:91]
    ds_read_b128 a[248:251], v241 offset:30720
    ds_read_b128 a[252:255], v241 offset:31744
    v_mfma_f32_16x16x32_bf16 v[56:59], a[196:199], a[180:183], v[56:59]
    v_exp_f32 v130, v18
    v_mfma_f32_16x16x32_bf16 v[56:59], a[200:203], a[184:187], v[56:59]
    v_exp_f32_e64 v131, v19
    v_mfma_f32_16x16x32_bf16 v[56:59], a[204:207], a[188:191], v[56:59]
    v_cvt_pk_bf16_f32 v104, v128, v129
    s_waitcnt lgkmcnt(8)
    v_mfma_f32_16x16x32_bf16 v[52:55], a[208:211], a[160:163], v[84:87]
    s_waitcnt vmcnt(14)
    s_barrier
    v_add_u32 v241, s35, v240
    ds_read_b128 a[192:195], v241 offset:0
    v_mfma_f32_16x16x32_bf16 v[52:55], a[212:215], a[164:167], v[52:55]
    s_add_u32 m0, s34, 16384
    s_add_u32 s34, s34, 32768
    v_mfma_f32_16x16x32_bf16 v[52:55], a[216:219], a[168:171], v[52:55]
    ds_read_b128 a[196:199], v241 offset:2048
    v_cvt_pk_bf16_f32 v105, v130, v131
    v_mfma_f32_16x16x32_bf16 v[52:55], a[220:223], a[172:175], v[52:55]
    s_cmp_ge_u32 s34, 163840
    s_cselect_b32 s34, s37, s34
    v_mfma_f32_16x16x32_bf16 v[60:63], a[208:211], a[176:179], v[92:95]
    ds_read_b128 a[200:203], v241 offset:4096
    ds_read_b128 a[204:207], v241 offset:6144
    v_mfma_f32_16x16x32_bf16 v[60:63], a[212:215], a[180:183], v[60:63]
    v_exp_f32 v132, v20
    v_mfma_f32_16x16x32_bf16 v[60:63], a[216:219], a[184:187], v[60:63]
    v_exp_f32_e64 v133, v21
    v_mfma_f32_16x16x32_bf16 v[60:63], a[220:223], a[188:191], v[60:63]
    v_cvt_pk_bf16_f32 v106, v132, v133
    s_waitcnt lgkmcnt(8)
    v_mfma_f32_16x16x32_bf16 a[0:3], a[224:227], v[112:115], a[0:3]
    ds_read_b128 a[208:211], v241 offset:1024
    buffer_load_dwordx4 v242, s[16:19], s42 offen offset:0 sc1 lds
    v_mfma_f32_16x16x32_bf16 a[32:35], a[224:227], v[116:119], a[32:35]
    v_exp_f32 v134, v22
    v_mfma_f32_16x16x32_bf16 a[64:67], a[224:227], v[120:123], a[64:67]
    v_exp_f32_e64 v135, v23
    v_mfma_f32_16x16x32_bf16 a[96:99], a[224:227], v[124:127], a[96:99]
    v_exp_f32_e64 v136, v24
    v_mfma_f32_16x16x32_bf16 a[4:7], a[228:231], v[112:115], a[4:7]
    ds_read_b128 a[212:215], v241 offset:3072
    v_cvt_pk_bf16_f32 v107, v134, v135
    v_mfma_f32_16x16x32_bf16 a[36:39], a[228:231], v[116:119], a[36:39]
    v_exp_f32_e64 v137, v25
    v_mfma_f32_16x16x32_bf16 a[68:71], a[228:231], v[120:123], a[68:71]
    v_exp_f32_e64 v138, v26
    v_mfma_f32_16x16x32_bf16 a[100:103], a[228:231], v[124:127], a[100:103]
    v_exp_f32_e64 v139, v27
    v_mfma_f32_16x16x32_bf16 a[8:11], a[232:235], v[112:115], a[8:11]
    ds_read_b128 a[216:219], v241 offset:5120
    v_cvt_pk_bf16_f32 v108, v136, v137
    v_mfma_f32_16x16x32_bf16 a[40:43], a[232:235], v[116:119], a[40:43]
    buffer_load_dwordx4 v242, s[16:19], s42 offen offset:1024 sc1 lds
    v_cvt_pk_bf16_f32 v109, v138, v139
    v_mfma_f32_16x16x32_bf16 a[72:75], a[232:235], v[120:123], a[72:75]
    v_exp_f32_e64 v140, v28
    v_mfma_f32_16x16x32_bf16 a[104:107], a[232:235], v[124:127], a[104:107]
    v_exp_f32_e64 v141, v29
    v_mfma_f32_16x16x32_bf16 a[12:15], a[236:239], v[112:115], a[12:15]
    ds_read_b128 a[220:223], v241 offset:7168
    v_cvt_pk_bf16_f32 v110, v140, v141
    v_mfma_f32_16x16x32_bf16 a[44:47], a[236:239], v[116:119], a[44:47]
    v_exp_f32_e64 v142, v30
    v_mfma_f32_16x16x32_bf16 a[76:79], a[236:239], v[120:123], a[76:79]
    v_exp_f32_e64 v143, v31
    v_mfma_f32_16x16x32_bf16 a[108:111], a[236:239], v[124:127], a[108:111]
    v_cvt_pk_bf16_f32 v111, v142, v143
    s_waitcnt lgkmcnt(8)
    v_mfma_f32_16x16x32_bf16 a[16:19], a[240:243], v[112:115], a[16:19]
    ds_read_b128 a[224:227], v241 offset:16384
    buffer_load_dwordx4 v242, s[16:19], s42 offen offset:2048 sc1 lds
    v_mfma_f32_16x16x32_bf16 a[48:51], a[240:243], v[116:119], a[48:51]
    v_mfma_f32_16x16x32_bf16 a[80:83], a[240:243], v[120:123], a[80:83]
    v_mfma_f32_16x16x32_bf16 a[112:115], a[240:243], v[124:127], a[112:115]
    v_mfma_f32_16x16x32_bf16 a[20:23], a[244:247], v[112:115], a[20:23]
    ds_read_b128 a[228:231], v241 offset:17408
    v_mfma_f32_16x16x32_bf16 a[52:55], a[244:247], v[116:119], a[52:55]
    buffer_load_dwordx4 v242, s[16:19], s42 offen offset:3072 sc1 lds
    s_add_u32 s42, s42, 34048
    v_mfma_f32_16x16x32_bf16 a[84:87], a[244:247], v[120:123], a[84:87]
    v_mfma_f32_16x16x32_bf16 a[116:119], a[244:247], v[124:127], a[116:119]
    v_mfma_f32_16x16x32_bf16 a[24:27], a[248:251], v[112:115], a[24:27]
    ds_read_b128 a[232:235], v241 offset:18432
    v_mfma_f32_16x16x32_bf16 a[56:59], a[248:251], v[116:119], a[56:59]
    v_mfma_f32_16x16x32_bf16 a[88:91], a[248:251], v[120:123], a[88:91]
    v_mfma_f32_16x16x32_bf16 a[120:123], a[248:251], v[124:127], a[120:123]
    v_mfma_f32_16x16x32_bf16 a[28:31], a[252:255], v[112:115], a[28:31]
    ds_read_b128 a[236:239], v241 offset:19456
    v_mfma_f32_16x16x32_bf16 a[60:63], a[252:255], v[116:119], a[60:63]
    v_mfma_f32_16x16x32_bf16 a[92:95], a[252:255], v[120:123], a[92:95]
    v_mfma_f32_16x16x32_bf16 a[124:127], a[252:255], v[124:127], a[124:127]
    v_mfma_f32_16x16x32_bf16 v[144:147], v[204:207], v[112:115], v[144:147]
    v_mfma_f32_16x16x32_bf16 v[148:151], v[204:207], v[116:119], v[148:151]
    v_mfma_f32_16x16x32_bf16 v[152:155], v[204:207], v[120:123], v[152:155]
    v_mfma_f32_16x16x32_bf16 v[156:159], v[204:207], v[124:127], v[156:159]
    s_nop 6
    v_rcp_f32 v230, v144
    v_rcp_f32 v231, v148
    v_accvgpr_read_b32 v160, a0
    v_accvgpr_read_b32 v161, a1
    v_accvgpr_read_b32 v162, a2
    v_accvgpr_read_b32 v163, a3
    v_accvgpr_read_b32 v164, a4
    v_accvgpr_read_b32 v165, a5
    v_accvgpr_read_b32 v166, a6
    v_accvgpr_read_b32 v167, a7
    v_mul_f32 v160, v160, v230
    v_mul_f32 v161, v161, v230
    v_mul_f32 v162, v162, v230
    v_mul_f32 v163, v163, v230
    v_mul_f32 v164, v164, v230
    v_mul_f32 v165, v165, v230
    v_mul_f32 v166, v166, v230
    v_mul_f32 v167, v167, v230
    v_cvt_pk_bf16_f32 v176, v160, v161
    v_cvt_pk_bf16_f32 v177, v162, v163
    v_cvt_pk_bf16_f32 v178, v164, v165
    v_cvt_pk_bf16_f32 v179, v166, v167
    buffer_store_dwordx4 v[176:179], v240, s[20:23], s39 offen offset:0 sc1
    v_accvgpr_read_b32 v168, a8
    v_accvgpr_read_b32 v169, a9
    v_accvgpr_read_b32 v170, a10
    v_accvgpr_read_b32 v171, a11
    v_accvgpr_read_b32 v172, a12
    v_accvgpr_read_b32 v173, a13
    v_accvgpr_read_b32 v174, a14
    v_accvgpr_read_b32 v175, a15
    v_mul_f32 v168, v168, v230
    v_mul_f32 v169, v169, v230
    v_mul_f32 v170, v170, v230
    v_mul_f32 v171, v171, v230
    v_mul_f32 v172, v172, v230
    v_mul_f32 v173, v173, v230
    v_mul_f32 v174, v174, v230
    v_mul_f32 v175, v175, v230
    v_cvt_pk_bf16_f32 v180, v168, v169
    v_cvt_pk_bf16_f32 v181, v170, v171
    v_cvt_pk_bf16_f32 v182, v172, v173
    v_cvt_pk_bf16_f32 v183, v174, v175
    buffer_store_dwordx4 v[180:183], v240, s[20:23], s39 offen offset:1024 sc1
    v_accvgpr_read_b32 v160, a16
    v_accvgpr_read_b32 v161, a17
    v_accvgpr_read_b32 v162, a18
    v_accvgpr_read_b32 v163, a19
    v_accvgpr_read_b32 v164, a20
    v_accvgpr_read_b32 v165, a21
    v_accvgpr_read_b32 v166, a22
    v_accvgpr_read_b32 v167, a23
    v_mul_f32 v160, v160, v230
    v_mul_f32 v161, v161, v230
    v_mul_f32 v162, v162, v230
    v_mul_f32 v163, v163, v230
    v_mul_f32 v164, v164, v230
    v_mul_f32 v165, v165, v230
    v_mul_f32 v166, v166, v230
    v_mul_f32 v167, v167, v230
    v_cvt_pk_bf16_f32 v184, v160, v161
    v_cvt_pk_bf16_f32 v185, v162, v163
    v_cvt_pk_bf16_f32 v186, v164, v165
    v_cvt_pk_bf16_f32 v187, v166, v167
    buffer_store_dwordx4 v[184:187], v240, s[20:23], s39 offen offset:2048 sc1
    v_accvgpr_read_b32 v168, a24
    v_accvgpr_read_b32 v169, a25
    v_accvgpr_read_b32 v170, a26
    v_accvgpr_read_b32 v171, a27
    v_accvgpr_read_b32 v172, a28
    v_accvgpr_read_b32 v173, a29
    v_accvgpr_read_b32 v174, a30
    v_accvgpr_read_b32 v175, a31
    v_mul_f32 v168, v168, v230
    v_mul_f32 v169, v169, v230
    v_mul_f32 v170, v170, v230
    v_mul_f32 v171, v171, v230
    v_mul_f32 v172, v172, v230
    v_mul_f32 v173, v173, v230
    v_mul_f32 v174, v174, v230
    v_mul_f32 v175, v175, v230
    v_cvt_pk_bf16_f32 v188, v168, v169
    v_cvt_pk_bf16_f32 v189, v170, v171
    v_cvt_pk_bf16_f32 v190, v172, v173
    v_cvt_pk_bf16_f32 v191, v174, v175
    buffer_store_dwordx4 v[188:191], v240, s[20:23], s39 offen offset:3072 sc1
    v_accvgpr_read_b32 v160, a32
    v_accvgpr_read_b32 v161, a33
    v_accvgpr_read_b32 v162, a34
    v_accvgpr_read_b32 v163, a35
    v_accvgpr_read_b32 v164, a36
    v_accvgpr_read_b32 v165, a37
    v_accvgpr_read_b32 v166, a38
    v_accvgpr_read_b32 v167, a39
    v_mul_f32 v160, v160, v231
    v_mul_f32 v161, v161, v231
    v_mul_f32 v162, v162, v231
    v_mul_f32 v163, v163, v231
    v_mul_f32 v164, v164, v231
    v_mul_f32 v165, v165, v231
    v_mul_f32 v166, v166, v231
    v_mul_f32 v167, v167, v231
    v_cvt_pk_bf16_f32 v176, v160, v161
    v_cvt_pk_bf16_f32 v177, v162, v163
    v_cvt_pk_bf16_f32 v178, v164, v165
    v_cvt_pk_bf16_f32 v179, v166, v167
    buffer_store_dwordx4 v[176:179], v244, s[20:23], s39 offen offset:0 sc1
    v_accvgpr_read_b32 v168, a40
    v_accvgpr_read_b32 v169, a41
    v_accvgpr_read_b32 v170, a42
    v_accvgpr_read_b32 v171, a43
    v_accvgpr_read_b32 v172, a44
    v_accvgpr_read_b32 v173, a45
    v_accvgpr_read_b32 v174, a46
    v_accvgpr_read_b32 v175, a47
    v_mul_f32 v168, v168, v231
    v_mul_f32 v169, v169, v231
    v_mul_f32 v170, v170, v231
    v_mul_f32 v171, v171, v231
    v_mul_f32 v172, v172, v231
    v_mul_f32 v173, v173, v231
    v_mul_f32 v174, v174, v231
    v_mul_f32 v175, v175, v231
    v_cvt_pk_bf16_f32 v180, v168, v169
    v_cvt_pk_bf16_f32 v181, v170, v171
    v_cvt_pk_bf16_f32 v182, v172, v173
    v_cvt_pk_bf16_f32 v183, v174, v175
    buffer_store_dwordx4 v[180:183], v244, s[20:23], s39 offen offset:1024 sc1
    v_accvgpr_read_b32 v160, a48
    v_accvgpr_read_b32 v161, a49
    v_accvgpr_read_b32 v162, a50
    v_accvgpr_read_b32 v163, a51
    v_accvgpr_read_b32 v164, a52
    v_accvgpr_read_b32 v165, a53
    v_accvgpr_read_b32 v166, a54
    v_accvgpr_read_b32 v167, a55
    v_mul_f32 v160, v160, v231
    v_mul_f32 v161, v161, v231
    v_mul_f32 v162, v162, v231
    v_mul_f32 v163, v163, v231
    v_mul_f32 v164, v164, v231
    v_mul_f32 v165, v165, v231
    v_mul_f32 v166, v166, v231
    v_mul_f32 v167, v167, v231
    v_cvt_pk_bf16_f32 v184, v160, v161
    v_cvt_pk_bf16_f32 v185, v162, v163
    v_cvt_pk_bf16_f32 v186, v164, v165
    v_cvt_pk_bf16_f32 v187, v166, v167
    buffer_store_dwordx4 v[184:187], v244, s[20:23], s39 offen offset:2048 sc1
    v_accvgpr_read_b32 v168, a56
    v_accvgpr_read_b32 v169, a57
    v_accvgpr_read_b32 v170, a58
    v_accvgpr_read_b32 v171, a59
    v_accvgpr_read_b32 v172, a60
    v_accvgpr_read_b32 v173, a61
    v_accvgpr_read_b32 v174, a62
    v_accvgpr_read_b32 v175, a63
    v_mul_f32 v168, v168, v231
    v_mul_f32 v169, v169, v231
    v_mul_f32 v170, v170, v231
    v_mul_f32 v171, v171, v231
    v_mul_f32 v172, v172, v231
    v_mul_f32 v173, v173, v231
    v_mul_f32 v174, v174, v231
    v_mul_f32 v175, v175, v231
    v_cvt_pk_bf16_f32 v188, v168, v169
    v_cvt_pk_bf16_f32 v189, v170, v171
    v_cvt_pk_bf16_f32 v190, v172, v173
    v_cvt_pk_bf16_f32 v191, v174, v175
    buffer_store_dwordx4 v[188:191], v244, s[20:23], s39 offen offset:3072 sc1
    s_lshl1_add_u32 s26, s5, s31
    s_lshl_b32 s26, s26, 1
    s_sub_u32 s26, 30, s26
    s_branch ka_p2_e
.p2align 5
ka_p2:
    s_sub_u32 s36, s36, 1
    s_cbranch_scc1 kf_fix13
kf_fixr14:
    s_waitcnt lgkmcnt(8)
    v_mfma_f32_16x16x32_bf16 v[16:19], a[192:195], a[160:163], v[80:83]
    ds_read_b128 a[240:243], v241 offset:20480
    ds_read_b128 a[244:247], v241 offset:21504
    v_mfma_f32_16x16x32_bf16 v[16:19], a[196:199], a[164:167], v[16:19]
    v_exp_f32 v128, v48
    v_mfma_f32_16x16x32_bf16 v[16:19], a[200:203], a[168:171], v[16:19]
    v_exp_f32_e64 v129, v49
    v_mfma_f32_16x16x32_bf16 v[16:19], a[204:207], a[172:175], v[16:19]
    v_exp_f32_e64 v130, v50
    v_mfma_f32_16x16x32_bf16 v[24:27], a[192:195], a[176:179], v[88:91]
    ds_read_b128 a[248:251], v241 offset:22528
    ds_read_b128 a[252:255], v241 offset:23552
    v_mfma_f32_16x16x32_bf16 v[24:27], a[196:199], a[180:183], v[24:27]
    s_mov_b32 m0, s34
    s_add_u32 s41, s42, 17664
    v_mfma_f32_16x16x32_bf16 v[24:27], a[200:203], a[184:187], v[24:27]
    v_exp_f32 v131, v51
    v_mfma_f32_16x16x32_bf16 v[24:27], a[204:207], a[188:191], v[24:27]
    buffer_load_dwordx4 v242, s[16:19], s41 offen offset:0 sc1 lds
    s_waitcnt lgkmcnt(8)
    v_mfma_f32_16x16x32_bf16 v[20:23], a[208:211], a[160:163], v[84:87]
    ds_read_b128 a[192:195], v241 offset:8192
    ds_read_b128 a[196:199], v241 offset:10240
    v_cvt_pk_bf16_f32 v120, v128, v129
    v_mfma_f32_16x16x32_bf16 v[20:23], a[212:215], a[164:167], v[20:23]
    v_exp_f32 v132, v52
    v_mfma_f32_16x16x32_bf16 v[20:23], a[216:219], a[168:171], v[20:23]
    v_exp_f32_e64 v133, v53
    v_mfma_f32_16x16x32_bf16 v[20:23], a[220:223], a[172:175], v[20:23]
    v_exp_f32_e64 v134, v54
    v_mfma_f32_16x16x32_bf16 v[28:31], a[208:211], a[176:179], v[92:95]
    ds_read_b128 a[200:203], v241 offset:12288
    ds_read_b128 a[204:207], v241 offset:14336
    v_mfma_f32_16x16x32_bf16 v[28:31], a[212:215], a[180:183], v[28:31]
    v_exp_f32_e64 v135, v55
    v_mfma_f32_16x16x32_bf16 v[28:31], a[216:219], a[184:187], v[28:31]
    buffer_load_dwordx4 v242, s[16:19], s41 offen offset:1024 sc1 lds
    v_cvt_pk_bf16_f32 v121, v130, v131
    v_mfma_f32_16x16x32_bf16 v[28:31], a[220:223], a[188:191], v[28:31]
    v_cvt_pk_bf16_f32 v122, v132, v133
    s_waitcnt lgkmcnt(8)
    v_mfma_f32_16x16x32_bf16 a[64:67], a[224:227], v[104:107], a[64:67]
    ds_read_b128 a[208:211], v241 offset:9216
    ds_read_b128 a[212:215], v241 offset:11264
    v_mfma_f32_16x16x32_bf16 a[96:99], a[224:227], v[108:111], a[96:99]
    v_exp_f32 v136, v56
    v_mfma_f32_16x16x32_bf16 a[68:71], a[228:231], v[104:107], a[68:71]
    v_exp_f32_e64 v137, v57
    v_mfma_f32_16x16x32_bf16 a[100:103], a[228:231], v[108:111], a[100:103]
    buffer_load_dwordx4 v242, s[16:19], s41 offen offset:2048 sc1 lds
    v_cvt_pk_bf16_f32 v123, v134, v135
    v_mfma_f32_16x16x32_bf16 a[72:75], a[232:235], v[104:107], a[72:75]
    ds_read_b128 a[216:219], v241 offset:13312
    ds_read_b128 a[220:223], v241 offset:15360
    v_mfma_f32_16x16x32_bf16 a[104:107], a[232:235], v[108:111], a[104:107]
    v_exp_f32_e64 v138, v58
    v_mfma_f32_16x16x32_bf16 a[76:79], a[236:239], v[104:107], a[76:79]
    v_exp_f32_e64 v139, v59
    v_mfma_f32_16x16x32_bf16 a[108:111], a[236:239], v[108:111], a[108:111]
    buffer_load_dwordx4 v242, s[16:19], s41 offen offset:3072 sc1 lds
    s_waitcnt lgkmcnt(8)
    v_mfma_f32_16x16x32_bf16 a[80:83], a[240:243], v[104:107], a[80:83]
    ds_read_b128 a[224:227], v241 offset:24576
    ds_read_b128 a[228:231], v241 offset:25600
    v_mfma_f32_16x16x32_bf16 a[112:115], a[240:243], v[108:111], a[112:115]
    v_exp_f32 v140, v60
    v_cvt_pk_bf16_f32 v124, v136, v137
    v_mfma_f32_16x16x32_bf16 a[84:87], a[244:247], v[104:107], a[84:87]
    v_exp_f32_e64 v141, v61
    v_mfma_f32_16x16x32_bf16 a[116:119], a[244:247], v[108:111], a[116:119]
    v_exp_f32_e64 v142, v62
    v_mfma_f32_16x16x32_bf16 a[88:91], a[248:251], v[104:107], a[88:91]
    ds_read_b128 a[232:235], v241 offset:26624
    ds_read_b128 a[236:239], v241 offset:27648
    v_mfma_f32_16x16x32_bf16 a[120:123], a[248:251], v[108:111], a[120:123]
    s_add_u32 s35, s35, 32768
    v_cvt_pk_bf16_f32 v125, v138, v139
    v_mfma_f32_16x16x32_bf16 a[92:95], a[252:255], v[104:107], a[92:95]
    s_cmp_ge_u32 s35, 163840
    s_cselect_b32 s35, 0, s35
    v_mfma_f32_16x16x32_bf16 a[124:127], a[252:255], v[108:111], a[124:127]
    v_exp_f32 v143, v63
    v_mfma_f32_16x16x32_bf16 v[152:155], v[204:207], v[104:107], v[152:155]
    v_cvt_pk_bf16_f32 v126, v140, v141
    v_cvt_pk_bf16_f32 v127, v142, v143
    v_mfma_f32_16x16x32_bf16 v[156:159], v[204:207], v[108:111], v[156:159]
    s_sub_u32 s36, s36, 1
    s_cbranch_scc1 kf_fix15
kf_fixr16:
    s_waitcnt lgkmcnt(8)
    v_mfma_f32_16x16x32_bf16 v[48:51], a[192:195], a[160:163], v[80:83]
    ds_read_b128 a[240:243], v241 offset:28672
    ds_read_b128 a[244:247], v241 offset:29696
    v_mfma_f32_16x16x32_bf16 v[48:51], a[196:199], a[164:167], v[48:51]
    v_exp_f32 v128, v16
    v_mfma_f32_16x16x32_bf16 v[48:51], a[200:203], a[168:171], v[48:51]
    v_exp_f32_e64 v129, v17
    v_mfma_f32_16x16x32_bf16 v[48:51], a[204:207], a[172:175], v[48:51]
    v_exp_f32_e64 v130, v18
    v_mfma_f32_16x16x32_bf16 v[56:59], a[192:195], a[176:179], v[88:91]
    ds_read_b128 a[248:251], v241 offset:30720
    ds_read_b128 a[252:255], v241 offset:31744
    v_mfma_f32_16x16x32_bf16 v[56:59], a[196:199], a[180:183], v[56:59]
    s_add_u32 m0, s34, 16384
    s_add_u32 s34, s34, 32768
    v_cvt_pk_bf16_f32 v104, v128, v129
    v_mfma_f32_16x16x32_bf16 v[56:59], a[200:203], a[184:187], v[56:59]
    s_cmp_ge_u32 s34, 163840
    s_cselect_b32 s34, s37, s34
    v_mfma_f32_16x16x32_bf16 v[56:59], a[204:207], a[188:191], v[56:59]
    buffer_load_dwordx4 v242, s[16:19], s42 offen offset:0 sc1 lds
    s_waitcnt lgkmcnt(8)
    v_mfma_f32_16x16x32_bf16 v[52:55], a[208:211], a[160:163], v[84:87]
    s_waitcnt vmcnt(13)
    s_barrier
    v_add_u32_e64 v241, s35, v240
    ds_read_b128 a[192:195], v241 offset:0
    v_mfma_f32_16x16x32_bf16 v[52:55], a[212:215], a[164:167], v[52:55]
    v_exp_f32_e64 v131, v19
    v_mfma_f32_16x16x32_bf16 v[52:55], a[216:219], a[168:171], v[52:55]
    ds_read_b128 a[196:199], v241 offset:2048
    v_cvt_pk_bf16_f32 v105, v130, v131
    v_mfma_f32_16x16x32_bf16 v[52:55], a[220:223], a[172:175], v[52:55]
    v_exp_f32_e64 v132, v20
    v_mfma_f32_16x16x32_bf16 v[60:63], a[208:211], a[176:179], v[92:95]
    ds_read_b128 a[200:203], v241 offset:4096
    ds_read_b128 a[204:207], v241 offset:6144
    v_mfma_f32_16x16x32_bf16 v[60:63], a[212:215], a[180:183], v[60:63]
    v_exp_f32_e64 v133, v21
    v_mfma_f32_16x16x32_bf16 v[60:63], a[216:219], a[184:187], v[60:63]
    v_exp_f32_e64 v134, v22
    v_mfma_f32_16x16x32_bf16 v[60:63], a[220:223], a[188:191], v[60:63]
    buffer_load_dwordx4 v242, s[16:19], s42 offen offset:1024 sc1 lds
    s_waitcnt lgkmcnt(8)
    v_mfma_f32_16x16x32_bf16 a[64:67], a[224:227], v[120:123], a[64:67]
    ds_read_b128 a[208:211], v241 offset:1024
    ds_read_b128 a[212:215], v241 offset:3072
    v_cvt_pk_bf16_f32 v106, v132, v133
    v_mfma_f32_16x16x32_bf16 a[96:99], a[224:227], v[124:127], a[96:99]
    v_exp_f32 v135, v23
    v_mfma_f32_16x16x32_bf16 a[68:71], a[228:231], v[120:123], a[68:71]
    v_exp_f32_e64 v136, v24
    v_mfma_f32_16x16x32_bf16 a[100:103], a[228:231], v[124:127], a[100:103]
    v_exp_f32_e64 v137, v25
    v_mfma_f32_16x16x32_bf16 a[72:75], a[232:235], v[120:123], a[72:75]
    ds_read_b128 a[216:219], v241 offset:5120
    ds_read_b128 a[220:223], v241 offset:7168
    v_mfma_f32_16x16x32_bf16 a[104:107], a[232:235], v[124:127], a[104:107]
    v_exp_f32_e64 v138, v26
    v_mfma_f32_16x16x32_bf16 a[76:79], a[236:239], v[120:123], a[76:79]
    buffer_load_dwordx4 v242, s[16:19], s42 offen offset:2048 sc1 lds
    v_cvt_pk_bf16_f32 v107, v134, v135
    v_mfma_f32_16x16x32_bf16 a[108:111], a[236:239], v[124:127], a[108:111]
    v_cvt_pk_bf16_f32 v108, v136, v137
    s_waitcnt lgkmcnt(8)
    v_mfma_f32_16x16x32_bf16 a[80:83], a[240:243], v[120:123], a[80:83]
    ds_read_b128 a[224:227], v241 offset:16384
    ds_read_b128 a[228:231], v241 offset:17408
    v_mfma_f32_16x16x32_bf16 a[112:115], a[240:243], v[124:127], a[112:115]
    v_exp_f32 v139, v27
    v_mfma_f32_16x16x32_bf16 a[84:87], a[244:247], v[120:123], a[84:87]
    v_exp_f32_e64 v140, v28
    v_mfma_f32_16x16x32_bf16 a[116:119], a[244:247], v[124:127], a[116:119]
    buffer_load_dwordx4 v242, s[16:19], s42 offen offset:3072 sc1 lds
    v_exp_f32_e64 v141, v29
    v_mfma_f32_16x16x32_bf16 a[88:91], a[248:251], v[120:123], a[88:91]
    ds_read_b128 a[232:235], v241 offset:18432
    ds_read_b128 a[236:239], v241 offset:19456
    v_mfma_f32_16x16x32_bf16 a[120:123], a[248:251], v[124:127], a[120:123]
    s_add_u32 s42, s42, 34048
    v_cvt_pk_bf16_f32 v109, v138, v139
    v_mfma_f32_16x16x32_bf16 a[92:95], a[252:255], v[120:123], a[92:95]
    v_exp_f32_e64 v142, v30
    v_mfma_f32_16x16x32_bf16 a[124:127], a[252:255], v[124:127], a[124:127]
    v_exp_f32_e64 v143, v31
    v_mfma_f32_16x16x32_bf16 v[152:155], v[204:207], v[120:123], v[152:155]
    v_cvt_pk_bf16_f32 v110, v140, v141
    v_cvt_pk_bf16_f32 v111, v142, v143
    v_mfma_f32_16x16x32_bf16 v[156:159], v[204:207], v[124:127], v[156:159]
ka_p2_e:
    s_sub_u32 s26, s26, 1
    s_cbranch_scc0 ka_p2
    s_branch ka_p2_x
kf_fix13:
    s_mov_b32 s24, 0
    s_branch kf_fix13c
kf_fix15:
    s_mov_b32 s24, 1
kf_fix13c:
    s_cmp_eq_u32 s33, 0
    s_cbranch_scc0 kf_fix13f
    s_mov_b32 s36, 0
    s_mov_b32 s33, 1
    v_add_f32 v80, v226, v200
    v_add_f32 v81, v226, v201
    v_add_f32 v82, v226, v202
    v_add_f32 v83, v226, v203
    v_add_f32 v84, v226, v209
    v_add_f32 v85, v226, v210
    v_add_f32 v86, v226, v211
    v_add_f32 v87, v226, v212
    v_add_f32 v88, v227, v213
    v_add_f32 v89, v227, v214
    v_add_f32 v90, v227, v215
    v_add_f32 v91, v227, v216
    v_add_f32 v92, v227, v217
    v_add_f32 v93, v227, v218
    v_add_f32 v94, v227, v219
    v_add_f32_e64 v95, v227, v220
    s_cmp_eq_u32 s24, 0
    s_cbranch_scc1 kf_fixr14
    s_branch kf_fixr16
kf_fix13f:
    s_mov_b32 s36, 0x1000
    v_mov_b32 v80, 0xf1800000
    v_mov_b32 v81, v80
    v_mov_b32 v82, v80
    v_mov_b32 v83, v80
    v_mov_b32 v84, v80
    v_mov_b32 v85, v80
    v_mov_b32 v86, v80
    v_mov_b32 v87, v80
    v_mov_b32 v88, v80
    v_mov_b32 v89, v80
    v_mov_b32 v90, v80
    v_mov_b32 v91, v80
    v_mov_b32 v92, v80
    v_mov_b32 v93, v80
    v_mov_b32 v94, v80
    v_mov_b32_e64 v95, v80
    s_cmp_eq_u32 s24, 0
    s_cbranch_scc1 kf_fixr14
    s_branch kf_fixr16
ka_p2_x:
    s_waitcnt lgkmcnt(0)
    ds_read_b128 a[224:227], v241 offset:16384
    ds_read_b128 a[228:231], v241 offset:17408
    ds_read_b128 a[232:235], v241 offset:18432
    ds_read_b128 a[236:239], v241 offset:19456
    ds_read_b128 a[240:243], v241 offset:20480
    ds_read_b128 a[244:247], v241 offset:21504
    ds_read_b128 a[248:251], v241 offset:22528
    ds_read_b128 a[252:255], v241 offset:23552
    ds_read_b128 a[192:195], v241 offset:24576
    ds_read_b128 a[196:199], v241 offset:25600
    ds_read_b128 a[200:203], v241 offset:26624
    ds_read_b128 a[204:207], v241 offset:27648
    ds_read_b128 a[208:211], v241 offset:28672
    ds_read_b128 a[212:215], v241 offset:29696
    ds_read_b128 a[216:219], v241 offset:30720
    s_waitcnt lgkmcnt(7)
    ds_read_b128 a[220:223], v241 offset:31744
    v_mfma_f32_16x16x32_bf16 a[64:67], a[224:227], v[104:107], a[64:67]
    v_exp_f32 v128, v48
    v_mfma_f32_16x16x32_bf16 a[96:99], a[224:227], v[108:111], a[96:99]
    v_exp_f32_e64 v129, v49
    v_mfma_f32_16x16x32_bf16 a[68:71], a[228:231], v[104:107], a[68:71]
    v_exp_f32_e64 v130, v50
    v_mfma_f32_16x16x32_bf16 a[100:103], a[228:231], v[108:111], a[100:103]
    v_exp_f32_e64 v131, v51
    v_cvt_pk_bf16_f32 v120, v128, v129
    v_mfma_f32_16x16x32_bf16 a[72:75], a[232:235], v[104:107], a[72:75]
    v_exp_f32_e64 v132, v52
    v_mfma_f32_16x16x32_bf16 a[104:107], a[232:235], v[108:111], a[104:107]
    v_exp_f32_e64 v133, v53
    v_mfma_f32_16x16x32_bf16 a[76:79], a[236:239], v[104:107], a[76:79]
    v_exp_f32_e64 v134, v54
    v_cvt_pk_bf16_f32 v121, v130, v131
    v_mfma_f32_16x16x32_bf16 a[108:111], a[236:239], v[108:111], a[108:111]
    v_exp_f32_e64 v135, v55
    v_mfma_f32_16x16x32_bf16 a[80:83], a[240:243], v[104:107], a[80:83]
    v_exp_f32_e64 v136, v56
    v_cvt_pk_bf16_f32 v122, v132, v133
    v_mfma_f32_16x16x32_bf16 a[112:115], a[240:243], v[108:111], a[112:115]
    v_exp_f32_e64 v137, v57
    v_mfma_f32_16x16x32_bf16 a[84:87], a[244:247], v[104:107], a[84:87]
    v_exp_f32_e64 v138, v58
    v_mfma_f32_16x16x32_bf16 a[116:119], a[244:247], v[108:111], a[116:119]
    v_exp_f32_e64 v139, v59
    v_cvt_pk_bf16_f32 v123, v134, v135
    v_mfma_f32_16x16x32_bf16 a[88:91], a[248:251], v[104:107], a[88:91]
    v_exp_f32_e64 v140, v60
    v_mfma_f32_16x16x32_bf16 a[120:123], a[248:251], v[108:111], a[120:123]
    v_exp_f32_e64 v141, v61
    v_cvt_pk_bf16_f32 v124, v136, v137
    v_mfma_f32_16x16x32_bf16 a[92:95], a[252:255], v[104:107], a[92:95]
    v_exp_f32_e64 v142, v62
    v_mfma_f32_16x16x32_bf16 a[124:127], a[252:255], v[108:111], a[124:127]
    v_exp_f32_e64 v143, v63
    v_mfma_f32_16x16x32_bf16 v[152:155], v[204:207], v[104:107], v[152:155]
    v_cvt_pk_bf16_f32 v125, v138, v139
    v_cvt_pk_bf16_f32 v126, v140, v141
    v_cvt_pk_bf16_f32 v127, v142, v143
    v_mfma_f32_16x16x32_bf16 v[156:159], v[204:207], v[108:111], v[156:159]
    s_waitcnt lgkmcnt(0)
    s_nop 0
    v_mfma_f32_16x16x32_bf16 a[64:67], a[192:195], v[120:123], a[64:67]
    v_mfma_f32_16x16x32_bf16 a[96:99], a[192:195], v[124:127], a[96:99]
    v_mfma_f32_16x16x32_bf16 a[68:71], a[196:199], v[120:123], a[68:71]
    v_mfma_f32_16x16x32_bf16 a[100:103], a[196:199], v[124:127], a[100:103]
    v_mfma_f32_16x16x32_bf16 a[72:75], a[200:203], v[120:123], a[72:75]
    v_mfma_f32_16x16x32_bf16 a[104:107], a[200:203], v[124:127], a[104:107]
    v_mfma_f32_16x16x32_bf16 a[76:79], a[204:207], v[120:123], a[76:79]
    v_mfma_f32_16x16x32_bf16 a[108:111], a[204:207], v[124:127], a[108:111]
    v_mfma_f32_16x16x32_bf16 a[80:83], a[208:211], v[120:123], a[80:83]
    v_mfma_f32_16x16x32_bf16 a[112:115], a[208:211], v[124:127], a[112:115]
    v_mfma_f32_16x16x32_bf16 a[84:87], a[212:215], v[120:123], a[84:87]
    v_mfma_f32_16x16x32_bf16 a[116:119], a[212:215], v[124:127], a[116:119]
    v_mfma_f32_16x16x32_bf16 a[88:91], a[216:219], v[120:123], a[88:91]
    v_mfma_f32_16x16x32_bf16 a[120:123], a[216:219], v[124:127], a[120:123]
    v_mfma_f32_16x16x32_bf16 a[92:95], a[220:223], v[120:123], a[92:95]
    v_mfma_f32_16x16x32_bf16 a[124:127], a[220:223], v[124:127], a[124:127]
    v_mfma_f32_16x16x32_bf16 v[152:155], v[204:207], v[120:123], v[152:155]
    v_mfma_f32_16x16x32_bf16 v[156:159], v[204:207], v[124:127], v[156:159]
    s_cmp_eq_u32 s31, 0
    s_cbranch_scc1 ka_nox
    s_waitcnt vmcnt(8)
    s_barrier
ka_nox:
    s_nop 6
    v_rcp_f32 v230, v152
    v_rcp_f32_e64 v231, v156
    v_accvgpr_read_b32 v160, a64
    v_accvgpr_read_b32 v161, a65
    v_accvgpr_read_b32 v162, a66
    v_accvgpr_read_b32 v163, a67
    v_accvgpr_read_b32 v164, a68
    v_accvgpr_read_b32 v165, a69
    v_accvgpr_read_b32 v166, a70
    v_accvgpr_read_b32 v167, a71
    v_mul_f32 v160, v160, v230
    v_mul_f32 v161, v161, v230
    v_mul_f32 v162, v162, v230
    v_mul_f32 v163, v163, v230
    v_mul_f32 v164, v164, v230
    v_mul_f32 v165, v165, v230
    v_mul_f32 v166, v166, v230
    v_mul_f32 v167, v167, v230
    v_cvt_pk_bf16_f32 v176, v160, v161
    v_cvt_pk_bf16_f32 v177, v162, v163
    v_cvt_pk_bf16_f32 v178, v164, v165
    v_cvt_pk_bf16_f32 v179, v166, v167
    buffer_store_dwordx4 v[176:179], v240, s[20:23], s40 offen offset:0 sc1
    v_accvgpr_read_b32 v168, a72
    v_accvgpr_read_b32 v169, a73
    v_accvgpr_read_b32 v170, a74
    v_accvgpr_read_b32 v171, a75
    v_accvgpr_read_b32 v172, a76
    v_accvgpr_read_b32 v173, a77
    v_accvgpr_read_b32 v174, a78
    v_accvgpr_read_b32 v175, a79
    v_mul_f32 v168, v168, v230
    v_mul_f32 v169, v169, v230
    v_mul_f32 v170, v170, v230
    v_mul_f32 v171, v171, v230
    v_mul_f32 v172, v172, v230
    v_mul_f32 v173, v173, v230
    v_mul_f32 v174, v174, v230
    v_mul_f32 v175, v175, v230
    v_cvt_pk_bf16_f32 v180, v168, v169
    v_cvt_pk_bf16_f32 v181, v170, v171
    v_cvt_pk_bf16_f32 v182, v172, v173
    v_cvt_pk_bf16_f32 v183, v174, v175
    buffer_store_dwordx4 v[180:183], v240, s[20:23], s40 offen offset:1024 sc1
    v_accvgpr_read_b32 v160, a80
    v_accvgpr_read_b32 v161, a81
    v_accvgpr_read_b32 v162, a82
    v_accvgpr_read_b32 v163, a83
    v_accvgpr_read_b32 v164, a84
    v_accvgpr_read_b32 v165, a85
    v_accvgpr_read_b32 v166, a86
    v_accvgpr_read_b32 v167, a87
    v_mul_f32 v160, v160, v230
    v_mul_f32 v161, v161, v230
    v_mul_f32 v162, v162, v230
    v_mul_f32 v163, v163, v230
    v_mul_f32 v164, v164, v230
    v_mul_f32 v165, v165, v230
    v_mul_f32 v166, v166, v230
    v_mul_f32 v167, v167, v230
    v_cvt_pk_bf16_f32 v184, v160, v161
    v_cvt_pk_bf16_f32 v185, v162, v163
    v_cvt_pk_bf16_f32 v186, v164, v165
    v_cvt_pk_bf16_f32 v187, v166, v167
    buffer_store_dwordx4 v[184:187], v240, s[20:23], s40 offen offset:2048 sc1
    v_accvgpr_read_b32 v168, a88
    v_accvgpr_read_b32 v169, a89
    v_accvgpr_read_b32 v170, a90
    v_accvgpr_read_b32 v171, a91
    v_accvgpr_read_b32 v172, a92
    v_accvgpr_read_b32 v173, a93
    v_accvgpr_read_b32 v174, a94
    v_accvgpr_read_b32 v175, a95
    v_mul_f32 v168, v168, v230
    v_mul_f32 v169, v169, v230
    v_mul_f32 v170, v170, v230
    v_mul_f32 v171, v171, v230
    v_mul_f32 v172, v172, v230
    v_mul_f32 v173, v173, v230
    v_mul_f32 v174, v174, v230
    v_mul_f32 v175, v175, v230
    v_cvt_pk_bf16_f32 v188, v168, v169
    v_cvt_pk_bf16_f32 v189, v170, v171
    v_cvt_pk_bf16_f32 v190, v172, v173
    v_cvt_pk_bf16_f32 v191, v174, v175
    buffer_store_dwordx4 v[188:191], v240, s[20:23], s40 offen offset:3072 sc1
    v_accvgpr_read_b32 v160, a96
    v_accvgpr_read_b32 v161, a97
    v_accvgpr_read_b32 v162, a98
    v_accvgpr_read_b32 v163, a99
    v_accvgpr_read_b32 v164, a100
    v_accvgpr_read_b32 v165, a101
    v_accvgpr_read_b32 v166, a102
    v_accvgpr_read_b32 v167, a103
    v_mul_f32 v160, v160, v231
    v_mul_f32 v161, v161, v231
    v_mul_f32 v162, v162, v231
    v_mul_f32 v163, v163, v231
    v_mul_f32 v164, v164, v231
    v_mul_f32 v165, v165, v231
    v_mul_f32 v166, v166, v231
    v_mul_f32 v167, v167, v231
    v_cvt_pk_bf16_f32 v176, v160, v161
    v_cvt_pk_bf16_f32 v177, v162, v163
    v_cvt_pk_bf16_f32 v178, v164, v165
    v_cvt_pk_bf16_f32 v179, v166, v167
    buffer_store_dwordx4 v[176:179], v244, s[20:23], s40 offen offset:0 sc1
    v_accvgpr_read_b32 v168, a104
    v_accvgpr_read_b32 v169, a105
    v_accvgpr_read_b32 v170, a106
    v_accvgpr_read_b32 v171, a107
    v_accvgpr_read_b32 v172, a108
    v_accvgpr_read_b32 v173, a109
    v_accvgpr_read_b32 v174, a110
    v_accvgpr_read_b32 v175, a111
    v_mul_f32 v168, v168, v231
    v_mul_f32 v169, v169, v231
    v_mul_f32 v170, v170, v231
    v_mul_f32 v171, v171, v231
    v_mul_f32 v172, v172, v231
    v_mul_f32 v173, v173, v231
    v_mul_f32 v174, v174, v231
    v_mul_f32 v175, v175, v231
    v_cvt_pk_bf16_f32 v180, v168, v169
    v_cvt_pk_bf16_f32 v181, v170, v171
    v_cvt_pk_bf16_f32 v182, v172, v173
    v_cvt_pk_bf16_f32 v183, v174, v175
    buffer_store_dwordx4 v[180:183], v244, s[20:23], s40 offen offset:1024 sc1
    v_accvgpr_read_b32 v160, a112
    v_accvgpr_read_b32 v161, a113
    v_accvgpr_read_b32 v162, a114
    v_accvgpr_read_b32 v163, a115
    v_accvgpr_read_b32 v164, a116
    v_accvgpr_read_b32 v165, a117
    v_accvgpr_read_b32 v166, a118
    v_accvgpr_read_b32 v167, a119
    v_mul_f32 v160, v160, v231
    v_mul_f32 v161, v161, v231
    v_mul_f32 v162, v162, v231
    v_mul_f32 v163, v163, v231
    v_mul_f32 v164, v164, v231
    v_mul_f32 v165, v165, v231
    v_mul_f32 v166, v166, v231
    v_mul_f32 v167, v167, v231
    v_cvt_pk_bf16_f32 v184, v160, v161
    v_cvt_pk_bf16_f32 v185, v162, v163
    v_cvt_pk_bf16_f32 v186, v164, v165
    v_cvt_pk_bf16_f32 v187, v166, v167
    buffer_store_dwordx4 v[184:187], v244, s[20:23], s40 offen offset:2048 sc1
    v_accvgpr_read_b32 v168, a120
    v_accvgpr_read_b32 v169, a121
    v_accvgpr_read_b32 v170, a122
    v_accvgpr_read_b32 v171, a123
    v_accvgpr_read_b32 v172, a124
    v_accvgpr_read_b32 v173, a125
    v_accvgpr_read_b32 v174, a126
    v_accvgpr_read_b32 v175, a127
    v_mul_f32 v168, v168, v231
    v_mul_f32 v169, v169, v231
    v_mul_f32 v170, v170, v231
    v_mul_f32 v171, v171, v231
    v_mul_f32 v172, v172, v231
    v_mul_f32 v173, v173, v231
    v_mul_f32 v174, v174, v231
    v_mul_f32 v175, v175, v231
    v_cvt_pk_bf16_f32 v188, v168, v169
    v_cvt_pk_bf16_f32 v189, v170, v171
    v_cvt_pk_bf16_f32 v190, v172, v173
    v_cvt_pk_bf16_f32 v191, v174, v175
    buffer_store_dwordx4 v[188:191], v244, s[20:23], s40 offen offset:3072 sc1
    s_mov_b32 s24, 0x5d800000
    v_cmp_nlt_f32 s[42:43], v144, s24
    v_cmp_nlt_f32 vcc, v148, s24
    s_or_b64 s[42:43], s[42:43], vcc
    v_cmp_nlt_f32 vcc, v152, s24
    s_or_b64 s[42:43], s[42:43], vcc
    v_cmp_nlt_f32 vcc, v156, s24
    s_or_b64 s[42:43], s[42:43], vcc
    s_cselect_b32 s24, 1, 0
    s_lshl_b32 s25, s31, 15
    s_add_u32 s25, s25, s35
    s_cmp_ge_u32 s25, 163840
    s_cselect_b32 s25, 0, s25
    v_mov_b32 v230, s25
    s_lshl2_add_u32 s25, s3, s25
    v_mov_b32 v231, s25
    v_mov_b32_e64 v232, s24
    ds_write_b32 v231, v232
    s_waitcnt lgkmcnt(0)
    s_barrier
    ds_read_b128 v[128:131], v230
    s_waitcnt lgkmcnt(0)
    v_or3_b32 v128, v128, v129, v130
    v_or_b32 v128, v128, v131
    v_cmp_ne_u32 vcc, 0, v128
    s_cbranch_vccnz ka_redo
ka_ok:
    s_sub_u32 s46, s20, 0x2400000
    s_subb_u32 s47, s21, 0
    s_mov_b64 s[42:43], s[56:57]
    s_mov_b64 s[40:41], s[80:81]
    s_mov_b64 s[44:45], s[82:83]
    s_mov_b64 s[60:61], s[84:85]
    s_mov_b64 s[62:63], s[86:87]
    v_mbcnt_lo_u32_b32 v237, -1, 0
    v_mbcnt_hi_u32_b32 v237, -1, v237
    s_lshl_b32 s32, s3, 6
    v_add_u32 v230, s32, v237
    s_lshr_b32 s53, s2, 3
    s_lshr_b32 s6, s2, 1
    s_and_b32 s6, s6, 3
    s_and_b32 s4, s2, 1
    s_lshl_b32 s4, s4, 2
    s_and_b32 s33, s53, 3
    s_add_u32 s4, s4, s33
    s_lshr_b32 s5, s53, 2
    v_lshlrev_b32 v228, 4, v237
    v_lshrrev_b32 v234, 4, v237
    v_and_b32 v235, 15, v237
    v_lshlrev_b32 v236, 1, v234
    v_xor_b32 v235, v235, v236
    v_lshlrev_b32 v234, 11, v234
    s_lshl_b32 s32, s3, 14
    s_lshl_b32 s33, s5, 8
    s_add_u32 s32, s32, s33
    v_add_u32 v234, s32, v234
    v_lshl_add_u32 v224, v235, 4, v234
    v_xor_b32_e64 v235, 8, v235
    v_lshl_add_u32 v225, v235, 4, v234
    v_add_u32 v225, 7168, v225
    s_lshl_b32 s37, s6, 21
    s_lshl_b32 s38, s3, 11
    s_lshl2_add_u32 s4, s4, s3
    s_sub_u32 s32, 63, s4
    s_cmp_lt_u32 s6, 2
    s_cselect_b32 s4, s4, s32
    s_lshl_b32 s32, s4, 18
    v_add_u32 v226, s32, v228
    v_add_u32 v227, 0x20000, v226
    v_xor_b32 v245, 0xfc0000, v226
    v_xor_b32 v246, 0xfc0000, v227
    s_lshl_b32 s35, s6, 15
    s_add_u32 s35, s35, 0x2400000
    s_getpc_b64 s[56:57]
kc_pc0:
    s_mov_b32 s58, kc_end-kc_pc0
    s_mov_b32 s59, 0x00020000
    v_lshlrev_b32_e64 v234, 7, v230
    buffer_load_dword v241, v234, s[56:59], 0 offen
    s_waitcnt lgkmcnt(0)
    s_mov_b32 s8, s46
    s_mov_b32 s9, s47
    s_mov_b32 s10, 0x10000000
    s_mov_b32 s11, 0x00020000
    s_mov_b32 s12, s42
    s_mov_b32 s13, s43
    s_mov_b32 s14, 0x800000
    s_mov_b32 s15, 0x00020000
    s_mov_b32 s16, s40
    s_mov_b32 s17, s41
    s_mov_b32 s18, 0x400000
    s_mov_b32 s19, 0x00020000
    s_mov_b32 s20, s44
    s_mov_b32 s21, s45
    s_mov_b32 s22, 0x800
    s_mov_b32 s23, 0x00020000
    s_mov_b32 s24, s60
    s_mov_b32 s25, s61
    s_mov_b32 s26, 0x700000
    s_mov_b32 s27, 0x00020000
    s_mov_b32 s28, s62
    s_mov_b32 s29, s63
    s_mov_b32 s30, 0x400000
    s_mov_b32 s31, 0x00020000
    s_lshr_b32 s44, s6, 1
    s_and_b32 s6, s6, 1
    v_bfe_u32 v234, v237, 2, 3
    v_lshrrev_b32 v235, 5, v237
    v_lshl_add_u32 v235, v235, 4, v234
    v_lshlrev_b32 v235, 8, v235
    v_and_b32 v236, 1, v237
    v_lshl_add_u32 v235, v236, 3, v235
    v_lshlrev_b32_e64 v234, 1, v234
    v_bfe_u32 v236, v237, 1, 1
    v_or_b32 v234, v234, v236
    s_lshl_b32 s32, s6, 3
    v_xor_b32 v234, s32, v234
    v_xor_b32 v236, 0, v234
    v_lshl_add_u32 v216, v236, 4, v235
    v_xor_b32_e64 v236, 2, v234
    v_lshl_add_u32 v217, v236, 4, v235
    v_xor_b32_e64 v236, 4, v234
    v_lshl_add_u32 v218, v236, 4, v235
    v_xor_b32_e64 v236, 6, v234
    v_lshl_add_u32 v219, v236, 4, v235
    v_xor_b32_e64 v236, 8, v234
    v_lshl_add_u32 v220, v236, 4, v235
    v_xor_b32_e64 v236, 10, v234
    v_lshl_add_u32 v221, v236, 4, v235
    v_xor_b32_e64 v236, 12, v234
    v_lshl_add_u32 v222, v236, 4, v235
    v_xor_b32_e64 v236, 14, v234
    v_lshl_add_u32 v223, v236, 4, v235
    s_lshl_b32 s44, s4, 5
    v_lshrrev_b32 v234, 3, v237
    v_add_u32 v242, s44, v234
    v_and_b32 v235, 7, v237
    s_lshl1_add_u32 s33, s5, s6
    s_lshl_b32 s33, s33, 7
    v_lshl_add_u32 v240, v235, 4, s33
    v_lshl_add_u32 v229, v242, 11, v240
    s_mul_i32 s32, s3, 4608
    s_add_u32 s32, s32, 131072
    v_mul_u32_u24 v234, 144, v234
    v_lshl_add_u32 v234, v235, 4, v234
    v_add_u32 v239, s32, v234
    v_and_b32 v234, 15, v237
    v_mul_u32_u24 v234, 144, v234
    v_lshrrev_b32_e64 v236, 4, v237
    v_lshl_add_u32 v234, v236, 3, v234
    v_add_u32 v238, s32, v234
    v_and_b32 v234, 3, v237
    v_lshl_add_u32 v234, v234, 3, v242
    v_lshlrev_b32 v234, 2, v234
    v_lshrrev_b32 v235, 2, v235
    v_lshl_add_u32 v231, v235, 13, v234
    v_lshlrev_b32_e64 v235, 30, v235
    v_add_u32 v235, 16384, v235
    v_add_u32 v232, v235, v234
    s_cmp_eq_u32 s44, 0
    s_cselect_b32 s32, 4, 64
    v_cmp_eq_u32 vcc, s32, v237
    v_mov_b32 v235, 24576
    v_mov_b32 v233, 1
    v_cndmask_b32 v232, v232, v235, vcc
    v_and_b32_e64 v234, 1, v237
    v_cmp_ne_u32 s[60:61], 0, v234
    v_and_b32_e64 v234, 2, v237
    v_cmp_ne_u32 s[62:63], 0, v234
    v_and_b32_e64 v234, 4, v237
    v_cmp_ne_u32 s[40:41], 0, v234
    v_cmp_eq_u32 vcc, 0, v237
    v_mov_b32_e64 v235, 0x40000000
    s_nop 0
    v_cndmask_b32 v243, v235, v237, vcc
    s_lshl2_add_u32 s39, s2, s3
    s_mov_b32 s48, 0x3800000
    s_mov_b32 s49, 0x3802000
    s_mov_b32 s50, 0x3804000
    s_and_b32 s52, s2, 7
    s_mul_i32 s54, s52, 28
    s_add_u32 s54, s54, s53
    v_lshrrev_b32 v234, 3, v237
    v_lshlrev_b32 v234, 11, v234
    v_and_b32 v235, 7, v237
    v_lshl_add_u32 v244, v235, 4, v234
    s_lshl_b32 s55, s54, 16
    s_lshl_b32 s32, s3, 13
    s_add_u32 s55, s55, s32
    s_add_u32 s55, s55, 0x4000000
    s_lshl_b32 s51, s54, 15
    s_lshl_b32 s32, s3, 9
    s_add_u32 s51, s51, s32
    s_cmp_ge_u32 s53, 28
    s_cselect_b32 s55, 0x40000000, s55
    s_cselect_b32 s51, 0x40000000, s51
    s_lshr_b32 s32, s2, 5
    s_lshl_b32 s32, s32, 9
    s_and_b32 s33, s2, 6
    s_lshl_b32 s33, s33, 6
    s_add_u32 s32, s32, s33
    s_add_u32 s32, s32, 0x38a4000
    s_waitcnt vmcnt(0)
    s_barrier
    s_cmp_lg_u32 s3, 0
    s_cbranch_scc1 kc_a0
    buffer_atomic_add v233, v243, s[8:11], s32 offen sc1
    s_lshl_b32 s32, s52, 7
    s_add_u32 s32, s32, 0x38a1000
    v_mov_b32 v235, 1
    buffer_atomic_add v235, v243, s[8:11], s32 offen sc0 sc1
    v_lshlrev_b32 v234, 7, v237
    v_cmp_gt_u32 vcc, 8, v237
    v_mov_b32_e64 v236, 0x40000000
    s_mov_b32 s34, 0x38a1400
    v_cndmask_b32 v234, v236, v234, vcc
    s_waitcnt vmcnt(0)
    v_readfirstlane_b32 s36, v235
    s_cmp_lg_u32 s36, 31
    s_cbranch_scc1 kc_a0
    buffer_atomic_add v233, v234, s[8:11], s34 offen sc1
kc_a0:
    s_add_u32 m0, s38, 0
    s_add_u32 s32, s37, 0
    buffer_load_dwordx4 v224, s[12:15], s32 offen lds
    buffer_load_dwordx4 v225, s[12:15], s32 offen offset:1024 lds
    s_add_u32 m0, s38, 8192
    s_add_u32 s32, s37, 65536
    buffer_load_dwordx4 v224, s[12:15], s32 offen lds
    buffer_load_dwordx4 v225, s[12:15], s32 offen offset:1024 lds
    s_add_u32 m0, s38, 16384
    s_add_u32 s32, s37, 131072
    buffer_load_dwordx4 v224, s[12:15], s32 offen lds
    buffer_load_dwordx4 v225, s[12:15], s32 offen offset:1024 lds
    s_add_u32 m0, s38, 24576
    s_add_u32 s32, s37, 196608
    buffer_load_dwordx4 v224, s[12:15], s32 offen lds
    buffer_load_dwordx4 v225, s[12:15], s32 offen offset:1024 lds
    s_add_u32 m0, s38, 32768
    s_add_u32 s32, s37, 262144
    buffer_load_dwordx4 v224, s[12:15], s32 offen lds
    buffer_load_dwordx4 v225, s[12:15], s32 offen offset:1024 lds
    s_add_u32 m0, s38, 40960
    s_add_u32 s32, s37, 327680
    buffer_load_dwordx4 v224, s[12:15], s32 offen lds
    buffer_load_dwordx4 v225, s[12:15], s32 offen offset:1024 lds
    s_add_u32 m0, s38, 49152
    s_add_u32 s32, s37, 393216
    buffer_load_dwordx4 v224, s[12:15], s32 offen lds
    buffer_load_dwordx4 v225, s[12:15], s32 offen offset:1024 lds
    s_add_u32 m0, s38, 57344
    s_add_u32 s32, s37, 458752
    buffer_load_dwordx4 v224, s[12:15], s32 offen lds
    buffer_load_dwordx4 v225, s[12:15], s32 offen offset:1024 lds
    s_add_u32 m0, s38, 65536
    s_add_u32 s32, s37, 524288
    buffer_load_dwordx4 v224, s[12:15], s32 offen lds
    buffer_load_dwordx4 v225, s[12:15], s32 offen offset:1024 lds
    s_add_u32 m0, s38, 73728
    s_add_u32 s32, s37, 589824
    buffer_load_dwordx4 v224, s[12:15], s32 offen lds
    buffer_load_dwordx4 v225, s[12:15], s32 offen offset:1024 lds
    s_add_u32 m0, s38, 81920
    s_add_u32 s32, s37, 655360
    buffer_load_dwordx4 v224, s[12:15], s32 offen lds
    buffer_load_dwordx4 v225, s[12:15], s32 offen offset:1024 lds
    s_add_u32 m0, s38, 90112
    s_add_u32 s32, s37, 720896
    buffer_load_dwordx4 v224, s[12:15], s32 offen lds
    buffer_load_dwordx4 v225, s[12:15], s32 offen offset:1024 lds
    s_add_u32 m0, s38, 98304
    s_add_u32 s32, s37, 786432
    buffer_load_dwordx4 v224, s[12:15], s32 offen lds
    buffer_load_dwordx4 v225, s[12:15], s32 offen offset:1024 lds
    s_add_u32 m0, s38, 106496
    s_add_u32 s32, s37, 851968
    buffer_load_dwordx4 v224, s[12:15], s32 offen lds
    buffer_load_dwordx4 v225, s[12:15], s32 offen offset:1024 lds
    s_add_u32 m0, s38, 114688
    s_add_u32 s32, s37, 917504
    buffer_load_dwordx4 v224, s[12:15], s32 offen lds
    buffer_load_dwordx4 v225, s[12:15], s32 offen offset:1024 lds
    s_add_u32 m0, s38, 122880
    s_add_u32 s32, s37, 983040
    buffer_load_dwordx4 v224, s[12:15], s32 offen lds
    buffer_load_dwordx4 v225, s[12:15], s32 offen offset:1024 lds
    s_add_u32 s33, s51, 0
    buffer_load_dwordx4 a[192:195], v244, s[24:27], s33 offen offset:0
    s_add_u32 s33, s51, 16384
    buffer_load_dwordx4 a[196:199], v244, s[24:27], s33 offen offset:0
    s_add_u32 s33, s51, 0
    buffer_load_dwordx4 a[200:203], v244, s[24:27], s33 offen offset:128
    s_add_u32 s33, s51, 16384
    buffer_load_dwordx4 a[204:207], v244, s[24:27], s33 offen offset:128
    s_add_u32 s33, s51, 0
    buffer_load_dwordx4 a[208:211], v244, s[24:27], s33 offen offset:256
    s_add_u32 s33, s51, 16384
    buffer_load_dwordx4 a[212:215], v244, s[24:27], s33 offen offset:256
    s_add_u32 s33, s51, 0
    buffer_load_dwordx4 a[216:219], v244, s[24:27], s33 offen offset:384
    s_add_u32 s33, s51, 16384
    buffer_load_dwordx4 a[220:223], v244, s[24:27], s33 offen offset:384
    s_cmp_lg_u32 s3, 0
    s_cbranch_scc1 kc_b03
    s_and_b32 s32, s2, 1
    s_lshl_b32 s32, s32, 2
    s_and_b32 s33, s53, 3
    s_add_u32 s32, s32, s33
    s_lshl_b32 s32, s32, 9
    s_and_b32 s33, s2, 6
    s_lshl_b32 s33, s33, 6
    s_add_u32 s32, s32, s33
    s_add_u32 s32, s32, 0x38a4000
    s_mov_b32 s34, 0x100000
    s_branch kc_b01
kc_b00:
    s_sleep 2
kc_b01:
    buffer_load_dword v235, off, s[8:11], s32 sc1
    s_waitcnt vmcnt(0)
    v_cmp_ne_u32 vcc, 8, v235
    s_sub_u32 s34, s34, 1
    s_cbranch_scc1 kc_b02
    s_cbranch_vccnz kc_b00
kc_b02:
kc_b03:
    s_waitcnt vmcnt(8)
    s_barrier
    buffer_load_dwordx4 a[0:3], v226, s[8:11], s35 offen offset:0 sc1
    buffer_load_dwordx4 a[4:7], v227, s[8:11], s35 offen offset:0 sc1
    buffer_load_dwordx4 a[8:11], v245, s[8:11], s35 offen offset:0 sc1
    buffer_load_dwordx4 a[12:15], v246, s[8:11], s35 offen offset:0 sc1
    buffer_load_dwordx4 a[16:19], v226, s[8:11], s35 offen offset:1024 sc1
    buffer_load_dwordx4 a[20:23], v227, s[8:11], s35 offen offset:1024 sc1
    buffer_load_dwordx4 a[24:27], v245, s[8:11], s35 offen offset:1024 sc1
    buffer_load_dwordx4 a[28:31], v246, s[8:11], s35 offen offset:1024 sc1
    buffer_load_dwordx4 a[32:35], v226, s[8:11], s35 offen offset:2048 sc1
    buffer_load_dwordx4 a[36:39], v227, s[8:11], s35 offen offset:2048 sc1
    buffer_load_dwordx4 a[40:43], v245, s[8:11], s35 offen offset:2048 sc1
    buffer_load_dwordx4 a[44:47], v246, s[8:11], s35 offen offset:2048 sc1
    buffer_load_dwordx4 a[48:51], v226, s[8:11], s35 offen offset:3072 sc1
    buffer_load_dwordx4 a[52:55], v227, s[8:11], s35 offen offset:3072 sc1
    buffer_load_dwordx4 a[56:59], v245, s[8:11], s35 offen offset:3072 sc1
    buffer_load_dwordx4 a[60:63], v246, s[8:11], s35 offen offset:3072 sc1
    ds_read_b64_tr_b16 v[128:129], v216 offset:0
    ds_read_b64_tr_b16 v[130:131], v216 offset:2048
    ds_read_b64_tr_b16 v[132:133], v217 offset:0
    ds_read_b64_tr_b16 v[134:135], v217 offset:2048
    ds_read_b64_tr_b16 v[136:137], v218 offset:0
    ds_read_b64_tr_b16 v[138:139], v218 offset:2048
    ds_read_b64_tr_b16 v[140:141], v219 offset:0
    ds_read_b64_tr_b16 v[142:143], v219 offset:2048
    s_waitcnt vmcnt(12) lgkmcnt(0)
    v_mfma_f32_16x16x32_bf16 v[32:35], v[128:131], a[0:3], 0
    ds_read_b64_tr_b16 v[144:145], v220 offset:0
    v_mfma_f32_16x16x32_bf16 v[36:39], v[128:131], a[4:7], 0
    ds_read_b64_tr_b16 v[146:147], v220 offset:2048
    v_mfma_f32_16x16x32_bf16 v[64:67], v[128:131], a[8:11], 0
    ds_read_b64_tr_b16 v[148:149], v221 offset:0
    v_mfma_f32_16x16x32_bf16 v[68:71], v[128:131], a[12:15], 0
    ds_read_b64_tr_b16 v[150:151], v221 offset:2048
    v_mfma_f32_16x16x32_bf16 v[40:43], v[132:135], a[0:3], 0
    ds_read_b64_tr_b16 v[152:153], v222 offset:0
    v_mfma_f32_16x16x32_bf16 v[44:47], v[132:135], a[4:7], 0
    ds_read_b64_tr_b16 v[154:155], v222 offset:2048
    v_mfma_f32_16x16x32_bf16 v[72:75], v[132:135], a[8:11], 0
    ds_read_b64_tr_b16 v[156:157], v223 offset:0
    v_mfma_f32_16x16x32_bf16 v[76:79], v[132:135], a[12:15], 0
    ds_read_b64_tr_b16 v[158:159], v223 offset:2048
    v_mfma_f32_16x16x32_bf16 v[48:51], v[136:139], a[0:3], 0
    s_add_u32 s35, s35, 4096
    buffer_load_dwordx4 a[64:67], v226, s[8:11], s35 offen offset:0 sc1
    v_mfma_f32_16x16x32_bf16 v[52:55], v[136:139], a[4:7], 0
    v_mfma_f32_16x16x32_bf16 v[80:83], v[136:139], a[8:11], 0
    v_mfma_f32_16x16x32_bf16 v[84:87], v[136:139], a[12:15], 0
    buffer_load_dwordx4 a[68:71], v227, s[8:11], s35 offen offset:0 sc1
    v_mfma_f32_16x16x32_bf16 v[56:59], v[140:143], a[0:3], 0
    v_mfma_f32_16x16x32_bf16 v[60:63], v[140:143], a[4:7], 0
    v_mfma_f32_16x16x32_bf16 v[88:91], v[140:143], a[8:11], 0
    v_mfma_f32_16x16x32_bf16 v[92:95], v[140:143], a[12:15], 0
    buffer_load_dwordx4 a[72:75], v245, s[8:11], s35 offen offset:0 sc1
    s_waitcnt lgkmcnt(0)
    v_mfma_f32_16x16x32_bf16 v[0:3], v[144:147], a[0:3], 0
    ds_read_b64_tr_b16 v[128:129], v216 offset:8192
    v_mfma_f32_16x16x32_bf16 v[4:7], v[144:147], a[4:7], 0
    ds_read_b64_tr_b16 v[130:131], v216 offset:10240
    v_mfma_f32_16x16x32_bf16 v[96:99], v[144:147], a[8:11], 0
    ds_read_b64_tr_b16 v[132:133], v217 offset:8192
    v_mfma_f32_16x16x32_bf16 v[100:103], v[144:147], a[12:15], 0
    ds_read_b64_tr_b16 v[134:135], v217 offset:10240
    v_mfma_f32_16x16x32_bf16 v[8:11], v[148:151], a[0:3], 0
    ds_read_b64_tr_b16 v[136:137], v218 offset:8192
    v_mfma_f32_16x16x32_bf16 v[12:15], v[148:151], a[4:7], 0
    ds_read_b64_tr_b16 v[138:139], v218 offset:10240
    v_mfma_f32_16x16x32_bf16 v[104:107], v[148:151], a[8:11], 0
    ds_read_b64_tr_b16 v[140:141], v219 offset:8192
    v_mfma_f32_16x16x32_bf16 v[108:111], v[148:151], a[12:15], 0
    ds_read_b64_tr_b16 v[142:143], v219 offset:10240
    v_mfma_f32_16x16x32_bf16 v[16:19], v[152:155], a[0:3], 0
    buffer_load_dwordx4 a[76:79], v246, s[8:11], s35 offen offset:0 sc1
    v_mfma_f32_16x16x32_bf16 v[20:23], v[152:155], a[4:7], 0
    v_mfma_f32_16x16x32_bf16 v[112:115], v[152:155], a[8:11], 0
    buffer_load_dwordx4 a[80:83], v226, s[8:11], s35 offen offset:1024 sc1
    v_mfma_f32_16x16x32_bf16 v[116:119], v[152:155], a[12:15], 0
    v_mfma_f32_16x16x32_bf16 v[24:27], v[156:159], a[0:3], 0
    v_mfma_f32_16x16x32_bf16 v[28:31], v[156:159], a[4:7], 0
    v_mfma_f32_16x16x32_bf16 v[120:123], v[156:159], a[8:11], 0
    v_mfma_f32_16x16x32_bf16 v[124:127], v[156:159], a[12:15], 0
    s_waitcnt vmcnt(13) lgkmcnt(0)
    v_mfma_f32_16x16x32_bf16 v[32:35], v[128:131], a[16:19], v[32:35]
    ds_read_b64_tr_b16 v[144:145], v220 offset:8192
    v_mfma_f32_16x16x32_bf16 v[36:39], v[128:131], a[20:23], v[36:39]
    ds_read_b64_tr_b16 v[146:147], v220 offset:10240
    v_mfma_f32_16x16x32_bf16 v[64:67], v[128:131], a[24:27], v[64:67]
    ds_read_b64_tr_b16 v[148:149], v221 offset:8192
    v_mfma_f32_16x16x32_bf16 v[68:71], v[128:131], a[28:31], v[68:71]
    ds_read_b64_tr_b16 v[150:151], v221 offset:10240
    v_mfma_f32_16x16x32_bf16 v[40:43], v[132:135], a[16:19], v[40:43]
    ds_read_b64_tr_b16 v[152:153], v222 offset:8192
    v_mfma_f32_16x16x32_bf16 v[44:47], v[132:135], a[20:23], v[44:47]
    ds_read_b64_tr_b16 v[154:155], v222 offset:10240
    v_mfma_f32_16x16x32_bf16 v[72:75], v[132:135], a[24:27], v[72:75]
    ds_read_b64_tr_b16 v[156:157], v223 offset:8192
    v_mfma_f32_16x16x32_bf16 v[76:79], v[132:135], a[28:31], v[76:79]
    ds_read_b64_tr_b16 v[158:159], v223 offset:10240
    v_mfma_f32_16x16x32_bf16 v[48:51], v[136:139], a[16:19], v[48:51]
    buffer_load_dwordx4 a[84:87], v227, s[8:11], s35 offen offset:1024 sc1
    v_mfma_f32_16x16x32_bf16 v[52:55], v[136:139], a[20:23], v[52:55]
    v_mfma_f32_16x16x32_bf16 v[80:83], v[136:139], a[24:27], v[80:83]
    v_mfma_f32_16x16x32_bf16 v[84:87], v[136:139], a[28:31], v[84:87]
    buffer_load_dwordx4 a[88:91], v245, s[8:11], s35 offen offset:1024 sc1
    v_mfma_f32_16x16x32_bf16 v[56:59], v[140:143], a[16:19], v[56:59]
    v_mfma_f32_16x16x32_bf16 v[60:63], v[140:143], a[20:23], v[60:63]
    v_mfma_f32_16x16x32_bf16 v[88:91], v[140:143], a[24:27], v[88:91]
    v_mfma_f32_16x16x32_bf16 v[92:95], v[140:143], a[28:31], v[92:95]
    buffer_load_dwordx4 a[92:95], v246, s[8:11], s35 offen offset:1024 sc1
    s_waitcnt lgkmcnt(0)
    v_mfma_f32_16x16x32_bf16 v[0:3], v[144:147], a[16:19], v[0:3]
    ds_read_b64_tr_b16 v[128:129], v216 offset:16384
    v_mfma_f32_16x16x32_bf16 v[4:7], v[144:147], a[20:23], v[4:7]
    ds_read_b64_tr_b16 v[130:131], v216 offset:18432
    v_mfma_f32_16x16x32_bf16 v[96:99], v[144:147], a[24:27], v[96:99]
    ds_read_b64_tr_b16 v[132:133], v217 offset:16384
    v_mfma_f32_16x16x32_bf16 v[100:103], v[144:147], a[28:31], v[100:103]
    ds_read_b64_tr_b16 v[134:135], v217 offset:18432
    v_mfma_f32_16x16x32_bf16 v[8:11], v[148:151], a[16:19], v[8:11]
    ds_read_b64_tr_b16 v[136:137], v218 offset:16384
    v_mfma_f32_16x16x32_bf16 v[12:15], v[148:151], a[20:23], v[12:15]
    ds_read_b64_tr_b16 v[138:139], v218 offset:18432
    v_mfma_f32_16x16x32_bf16 v[104:107], v[148:151], a[24:27], v[104:107]
    ds_read_b64_tr_b16 v[140:141], v219 offset:16384
    v_mfma_f32_16x16x32_bf16 v[108:111], v[148:151], a[28:31], v[108:111]
    ds_read_b64_tr_b16 v[142:143], v219 offset:18432
    v_mfma_f32_16x16x32_bf16 v[16:19], v[152:155], a[16:19], v[16:19]
    buffer_load_dwordx4 a[96:99], v226, s[8:11], s35 offen offset:2048 sc1
    v_mfma_f32_16x16x32_bf16 v[20:23], v[152:155], a[20:23], v[20:23]
    v_mfma_f32_16x16x32_bf16 v[112:115], v[152:155], a[24:27], v[112:115]
    v_mfma_f32_16x16x32_bf16 v[116:119], v[152:155], a[28:31], v[116:119]
    v_mfma_f32_16x16x32_bf16 v[24:27], v[156:159], a[16:19], v[24:27]
    buffer_load_dwordx4 a[100:103], v227, s[8:11], s35 offen offset:2048 sc1
    v_mfma_f32_16x16x32_bf16 v[28:31], v[156:159], a[20:23], v[28:31]
    v_mfma_f32_16x16x32_bf16 v[120:123], v[156:159], a[24:27], v[120:123]
    v_mfma_f32_16x16x32_bf16 v[124:127], v[156:159], a[28:31], v[124:127]
    s_waitcnt vmcnt(14) lgkmcnt(0)
    v_mfma_f32_16x16x32_bf16 v[32:35], v[128:131], a[32:35], v[32:35]
    ds_read_b64_tr_b16 v[144:145], v220 offset:16384
    v_mfma_f32_16x16x32_bf16 v[36:39], v[128:131], a[36:39], v[36:39]
    ds_read_b64_tr_b16 v[146:147], v220 offset:18432
    v_mfma_f32_16x16x32_bf16 v[64:67], v[128:131], a[40:43], v[64:67]
    ds_read_b64_tr_b16 v[148:149], v221 offset:16384
    v_mfma_f32_16x16x32_bf16 v[68:71], v[128:131], a[44:47], v[68:71]
    ds_read_b64_tr_b16 v[150:151], v221 offset:18432
    v_mfma_f32_16x16x32_bf16 v[40:43], v[132:135], a[32:35], v[40:43]
    ds_read_b64_tr_b16 v[152:153], v222 offset:16384
    v_mfma_f32_16x16x32_bf16 v[44:47], v[132:135], a[36:39], v[44:47]
    ds_read_b64_tr_b16 v[154:155], v222 offset:18432
    v_mfma_f32_16x16x32_bf16 v[72:75], v[132:135], a[40:43], v[72:75]
    ds_read_b64_tr_b16 v[156:157], v223 offset:16384
    v_mfma_f32_16x16x32_bf16 v[76:79], v[132:135], a[44:47], v[76:79]
    ds_read_b64_tr_b16 v[158:159], v223 offset:18432
    v_mfma_f32_16x16x32_bf16 v[48:51], v[136:139], a[32:35], v[48:51]
    buffer_load_dwordx4 a[104:107], v245, s[8:11], s35 offen offset:2048 sc1
    v_mfma_f32_16x16x32_bf16 v[52:55], v[136:139], a[36:39], v[52:55]
    v_mfma_f32_16x16x32_bf16 v[80:83], v[136:139], a[40:43], v[80:83]
    v_mfma_f32_16x16x32_bf16 v[84:87], v[136:139], a[44:47], v[84:87]
    buffer_load_dwordx4 a[108:111], v246, s[8:11], s35 offen offset:2048 sc1
    v_mfma_f32_16x16x32_bf16 v[56:59], v[140:143], a[32:35], v[56:59]
    v_mfma_f32_16x16x32_bf16 v[60:63], v[140:143], a[36:39], v[60:63]
    v_mfma_f32_16x16x32_bf16 v[88:91], v[140:143], a[40:43], v[88:91]
    v_mfma_f32_16x16x32_bf16 v[92:95], v[140:143], a[44:47], v[92:95]
    buffer_load_dwordx4 a[112:115], v226, s[8:11], s35 offen offset:3072 sc1
    s_waitcnt lgkmcnt(0)
    v_mfma_f32_16x16x32_bf16 v[0:3], v[144:147], a[32:35], v[0:3]
    ds_read_b64_tr_b16 v[128:129], v216 offset:24576
    v_mfma_f32_16x16x32_bf16 v[4:7], v[144:147], a[36:39], v[4:7]
    ds_read_b64_tr_b16 v[130:131], v216 offset:26624
    v_mfma_f32_16x16x32_bf16 v[96:99], v[144:147], a[40:43], v[96:99]
    ds_read_b64_tr_b16 v[132:133], v217 offset:24576
    v_mfma_f32_16x16x32_bf16 v[100:103], v[144:147], a[44:47], v[100:103]
    ds_read_b64_tr_b16 v[134:135], v217 offset:26624
    v_mfma_f32_16x16x32_bf16 v[8:11], v[148:151], a[32:35], v[8:11]
    ds_read_b64_tr_b16 v[136:137], v218 offset:24576
    v_mfma_f32_16x16x32_bf16 v[12:15], v[148:151], a[36:39], v[12:15]
    ds_read_b64_tr_b16 v[138:139], v218 offset:26624
    v_mfma_f32_16x16x32_bf16 v[104:107], v[148:151], a[40:43], v[104:107]
    ds_read_b64_tr_b16 v[140:141], v219 offset:24576
    v_mfma_f32_16x16x32_bf16 v[108:111], v[148:151], a[44:47], v[108:111]
    ds_read_b64_tr_b16 v[142:143], v219 offset:26624
    v_mfma_f32_16x16x32_bf16 v[16:19], v[152:155], a[32:35], v[16:19]
    buffer_load_dwordx4 a[116:119], v227, s[8:11], s35 offen offset:3072 sc1
    v_mfma_f32_16x16x32_bf16 v[20:23], v[152:155], a[36:39], v[20:23]
    v_mfma_f32_16x16x32_bf16 v[112:115], v[152:155], a[40:43], v[112:115]
    v_mfma_f32_16x16x32_bf16 v[116:119], v[152:155], a[44:47], v[116:119]
    v_mfma_f32_16x16x32_bf16 v[24:27], v[156:159], a[32:35], v[24:27]
    buffer_load_dwordx4 a[120:123], v245, s[8:11], s35 offen offset:3072 sc1
    v_mfma_f32_16x16x32_bf16 v[28:31], v[156:159], a[36:39], v[28:31]
    v_mfma_f32_16x16x32_bf16 v[120:123], v[156:159], a[40:43], v[120:123]
    v_mfma_f32_16x16x32_bf16 v[124:127], v[156:159], a[44:47], v[124:127]
    s_waitcnt vmcnt(15) lgkmcnt(0)
    v_mfma_f32_16x16x32_bf16 v[32:35], v[128:131], a[48:51], v[32:35]
    ds_read_b64_tr_b16 v[144:145], v220 offset:24576
    v_mfma_f32_16x16x32_bf16 v[36:39], v[128:131], a[52:55], v[36:39]
    ds_read_b64_tr_b16 v[146:147], v220 offset:26624
    v_mfma_f32_16x16x32_bf16 v[64:67], v[128:131], a[56:59], v[64:67]
    ds_read_b64_tr_b16 v[148:149], v221 offset:24576
    v_mfma_f32_16x16x32_bf16 v[68:71], v[128:131], a[60:63], v[68:71]
    ds_read_b64_tr_b16 v[150:151], v221 offset:26624
    v_mfma_f32_16x16x32_bf16 v[40:43], v[132:135], a[48:51], v[40:43]
    ds_read_b64_tr_b16 v[152:153], v222 offset:24576
    v_mfma_f32_16x16x32_bf16 v[44:47], v[132:135], a[52:55], v[44:47]
    ds_read_b64_tr_b16 v[154:155], v222 offset:26624
    v_mfma_f32_16x16x32_bf16 v[72:75], v[132:135], a[56:59], v[72:75]
    ds_read_b64_tr_b16 v[156:157], v223 offset:24576
    v_mfma_f32_16x16x32_bf16 v[76:79], v[132:135], a[60:63], v[76:79]
    ds_read_b64_tr_b16 v[158:159], v223 offset:26624
    v_mfma_f32_16x16x32_bf16 v[48:51], v[136:139], a[48:51], v[48:51]
    buffer_load_dwordx4 a[124:127], v246, s[8:11], s35 offen offset:3072 sc1
    v_mfma_f32_16x16x32_bf16 v[52:55], v[136:139], a[52:55], v[52:55]
    v_mfma_f32_16x16x32_bf16 v[80:83], v[136:139], a[56:59], v[80:83]
    v_mfma_f32_16x16x32_bf16 v[84:87], v[136:139], a[60:63], v[84:87]
    s_add_u32 s35, s35, 4096
    buffer_load_dwordx4 a[0:3], v226, s[8:11], s35 offen offset:0 sc1
    v_mfma_f32_16x16x32_bf16 v[56:59], v[140:143], a[48:51], v[56:59]
    v_mfma_f32_16x16x32_bf16 v[60:63], v[140:143], a[52:55], v[60:63]
    v_mfma_f32_16x16x32_bf16 v[88:91], v[140:143], a[56:59], v[88:91]
    v_mfma_f32_16x16x32_bf16 v[92:95], v[140:143], a[60:63], v[92:95]
    buffer_load_dwordx4 a[4:7], v227, s[8:11], s35 offen offset:0 sc1
    s_waitcnt lgkmcnt(0)
    s_barrier
    v_mfma_f32_16x16x32_bf16 v[0:3], v[144:147], a[48:51], v[0:3]
    ds_read_b64_tr_b16 v[128:129], v216 offset:32768
    v_mfma_f32_16x16x32_bf16 v[4:7], v[144:147], a[52:55], v[4:7]
    ds_read_b64_tr_b16 v[130:131], v216 offset:34816
    v_mfma_f32_16x16x32_bf16 v[96:99], v[144:147], a[56:59], v[96:99]
    ds_read_b64_tr_b16 v[132:133], v216 offset:40960
    v_mfma_f32_16x16x32_bf16 v[100:103], v[144:147], a[60:63], v[100:103]
    ds_read_b64_tr_b16 v[134:135], v216 offset:43008
    v_mfma_f32_16x16x32_bf16 v[8:11], v[148:151], a[48:51], v[8:11]
    ds_read_b64_tr_b16 v[136:137], v217 offset:32768
    v_mfma_f32_16x16x32_bf16 v[12:15], v[148:151], a[52:55], v[12:15]
    ds_read_b64_tr_b16 v[138:139], v217 offset:34816
    v_mfma_f32_16x16x32_bf16 v[104:107], v[148:151], a[56:59], v[104:107]
    ds_read_b64_tr_b16 v[140:141], v217 offset:40960
    v_mfma_f32_16x16x32_bf16 v[108:111], v[148:151], a[60:63], v[108:111]
    ds_read_b64_tr_b16 v[142:143], v217 offset:43008
    v_mfma_f32_16x16x32_bf16 v[16:19], v[152:155], a[48:51], v[16:19]
    buffer_load_dwordx4 a[8:11], v245, s[8:11], s35 offen offset:0 sc1
    v_mfma_f32_16x16x32_bf16 v[20:23], v[152:155], a[52:55], v[20:23]
    v_mfma_f32_16x16x32_bf16 v[112:115], v[152:155], a[56:59], v[112:115]
    v_mfma_f32_16x16x32_bf16 v[116:119], v[152:155], a[60:63], v[116:119]
    v_mfma_f32_16x16x32_bf16 v[24:27], v[156:159], a[48:51], v[24:27]
    buffer_load_dwordx4 a[12:15], v246, s[8:11], s35 offen offset:0 sc1
    v_mfma_f32_16x16x32_bf16 v[28:31], v[156:159], a[52:55], v[28:31]
    v_mfma_f32_16x16x32_bf16 v[120:123], v[156:159], a[56:59], v[120:123]
    v_mfma_f32_16x16x32_bf16 v[124:127], v[156:159], a[60:63], v[124:127]
    s_waitcnt vmcnt(12) lgkmcnt(0)
    v_mfma_f32_16x16x32_bf16 v[32:35], v[128:131], a[64:67], v[32:35]
    ds_read_b64_tr_b16 v[144:145], v218 offset:32768
    v_mfma_f32_16x16x32_bf16 v[32:35], v[132:135], a[80:83], v[32:35]
    ds_read_b64_tr_b16 v[146:147], v218 offset:34816
    v_mfma_f32_16x16x32_bf16 v[36:39], v[128:131], a[68:71], v[36:39]
    ds_read_b64_tr_b16 v[148:149], v218 offset:40960
    v_mfma_f32_16x16x32_bf16 v[36:39], v[132:135], a[84:87], v[36:39]
    ds_read_b64_tr_b16 v[150:151], v218 offset:43008
    v_mfma_f32_16x16x32_bf16 v[64:67], v[128:131], a[72:75], v[64:67]
    ds_read_b64_tr_b16 v[152:153], v219 offset:32768
    v_mfma_f32_16x16x32_bf16 v[64:67], v[132:135], a[88:91], v[64:67]
    ds_read_b64_tr_b16 v[154:155], v219 offset:34816
    v_mfma_f32_16x16x32_bf16 v[68:71], v[128:131], a[76:79], v[68:71]
    ds_read_b64_tr_b16 v[156:157], v219 offset:40960
    v_mfma_f32_16x16x32_bf16 v[68:71], v[132:135], a[92:95], v[68:71]
    ds_read_b64_tr_b16 v[158:159], v219 offset:43008
    v_mfma_f32_16x16x32_bf16 v[40:43], v[136:139], a[64:67], v[40:43]
    buffer_load_dwordx4 a[16:19], v226, s[8:11], s35 offen offset:1024 sc1
    v_mfma_f32_16x16x32_bf16 v[40:43], v[140:143], a[80:83], v[40:43]
    s_add_u32 m0, s38, 0
    s_add_u32 s32, s37, 1048576
    v_mfma_f32_16x16x32_bf16 v[44:47], v[136:139], a[68:71], v[44:47]
    buffer_load_dwordx4 v224, s[12:15], s32 offen lds
    v_mfma_f32_16x16x32_bf16 v[44:47], v[140:143], a[84:87], v[44:47]
    buffer_load_dwordx4 a[20:23], v227, s[8:11], s35 offen offset:1024 sc1
    v_mfma_f32_16x16x32_bf16 v[72:75], v[136:139], a[72:75], v[72:75]
    v_mfma_f32_16x16x32_bf16 v[72:75], v[140:143], a[88:91], v[72:75]
    buffer_load_dwordx4 v225, s[12:15], s32 offen offset:1024 lds
    v_mfma_f32_16x16x32_bf16 v[76:79], v[136:139], a[76:79], v[76:79]
    v_mfma_f32_16x16x32_bf16 v[76:79], v[140:143], a[92:95], v[76:79]
    s_waitcnt lgkmcnt(0)
    v_mfma_f32_16x16x32_bf16 v[48:51], v[144:147], a[64:67], v[48:51]
    ds_read_b64_tr_b16 v[128:129], v220 offset:32768
    v_mfma_f32_16x16x32_bf16 v[48:51], v[148:151], a[80:83], v[48:51]
    ds_read_b64_tr_b16 v[130:131], v220 offset:34816
    v_mfma_f32_16x16x32_bf16 v[52:55], v[144:147], a[68:71], v[52:55]
    ds_read_b64_tr_b16 v[132:133], v220 offset:40960
    v_mfma_f32_16x16x32_bf16 v[52:55], v[148:151], a[84:87], v[52:55]
    ds_read_b64_tr_b16 v[134:135], v220 offset:43008
    v_mfma_f32_16x16x32_bf16 v[80:83], v[144:147], a[72:75], v[80:83]
    ds_read_b64_tr_b16 v[136:137], v221 offset:32768
    v_mfma_f32_16x16x32_bf16 v[80:83], v[148:151], a[88:91], v[80:83]
    ds_read_b64_tr_b16 v[138:139], v221 offset:34816
    v_mfma_f32_16x16x32_bf16 v[84:87], v[144:147], a[76:79], v[84:87]
    ds_read_b64_tr_b16 v[140:141], v221 offset:40960
    v_mfma_f32_16x16x32_bf16 v[84:87], v[148:151], a[92:95], v[84:87]
    ds_read_b64_tr_b16 v[142:143], v221 offset:43008
    v_mfma_f32_16x16x32_bf16 v[56:59], v[152:155], a[64:67], v[56:59]
    buffer_load_dwordx4 a[24:27], v245, s[8:11], s35 offen offset:1024 sc1
    v_mfma_f32_16x16x32_bf16 v[56:59], v[156:159], a[80:83], v[56:59]
    v_mfma_f32_16x16x32_bf16 v[60:63], v[152:155], a[68:71], v[60:63]
    buffer_load_dwordx4 a[28:31], v246, s[8:11], s35 offen offset:1024 sc1
    v_mfma_f32_16x16x32_bf16 v[60:63], v[156:159], a[84:87], v[60:63]
    v_mfma_f32_16x16x32_bf16 v[88:91], v[152:155], a[72:75], v[88:91]
    v_mfma_f32_16x16x32_bf16 v[88:91], v[156:159], a[88:91], v[88:91]
    v_mfma_f32_16x16x32_bf16 v[92:95], v[152:155], a[76:79], v[92:95]
    v_mfma_f32_16x16x32_bf16 v[92:95], v[156:159], a[92:95], v[92:95]
    buffer_load_dwordx4 a[32:35], v226, s[8:11], s35 offen offset:2048 sc1
    s_waitcnt lgkmcnt(0)
    v_mfma_f32_16x16x32_bf16 v[0:3], v[128:131], a[64:67], v[0:3]
    ds_read_b64_tr_b16 v[144:145], v222 offset:32768
    v_mfma_f32_16x16x32_bf16 v[0:3], v[132:135], a[80:83], v[0:3]
    ds_read_b64_tr_b16 v[146:147], v222 offset:34816
    v_mfma_f32_16x16x32_bf16 v[4:7], v[128:131], a[68:71], v[4:7]
    ds_read_b64_tr_b16 v[148:149], v222 offset:40960
    v_mfma_f32_16x16x32_bf16 v[4:7], v[132:135], a[84:87], v[4:7]
    ds_read_b64_tr_b16 v[150:151], v222 offset:43008
    v_mfma_f32_16x16x32_bf16 v[96:99], v[128:131], a[72:75], v[96:99]
    ds_read_b64_tr_b16 v[152:153], v223 offset:32768
    v_mfma_f32_16x16x32_bf16 v[96:99], v[132:135], a[88:91], v[96:99]
    ds_read_b64_tr_b16 v[154:155], v223 offset:34816
    v_mfma_f32_16x16x32_bf16 v[100:103], v[128:131], a[76:79], v[100:103]
    ds_read_b64_tr_b16 v[156:157], v223 offset:40960
    v_mfma_f32_16x16x32_bf16 v[100:103], v[132:135], a[92:95], v[100:103]
    ds_read_b64_tr_b16 v[158:159], v223 offset:43008
    v_mfma_f32_16x16x32_bf16 v[8:11], v[136:139], a[64:67], v[8:11]
    buffer_load_dwordx4 a[36:39], v227, s[8:11], s35 offen offset:2048 sc1
    v_mfma_f32_16x16x32_bf16 v[8:11], v[140:143], a[80:83], v[8:11]
    s_add_u32 m0, s38, 8192
    s_add_u32 s32, s37, 1114112
    v_mfma_f32_16x16x32_bf16 v[12:15], v[136:139], a[68:71], v[12:15]
    buffer_load_dwordx4 v224, s[12:15], s32 offen lds
    v_mfma_f32_16x16x32_bf16 v[12:15], v[140:143], a[84:87], v[12:15]
    buffer_load_dwordx4 a[40:43], v245, s[8:11], s35 offen offset:2048 sc1
    v_mfma_f32_16x16x32_bf16 v[104:107], v[136:139], a[72:75], v[104:107]
    v_mfma_f32_16x16x32_bf16 v[104:107], v[140:143], a[88:91], v[104:107]
    buffer_load_dwordx4 v225, s[12:15], s32 offen offset:1024 lds
    v_mfma_f32_16x16x32_bf16 v[108:111], v[136:139], a[76:79], v[108:111]
    v_mfma_f32_16x16x32_bf16 v[108:111], v[140:143], a[92:95], v[108:111]
    s_waitcnt lgkmcnt(0)
    v_mfma_f32_16x16x32_bf16 v[16:19], v[144:147], a[64:67], v[16:19]
    ds_read_b64_tr_b16 v[128:129], v216 offset:49152
    v_mfma_f32_16x16x32_bf16 v[16:19], v[148:151], a[80:83], v[16:19]
    ds_read_b64_tr_b16 v[130:131], v216 offset:51200
    v_mfma_f32_16x16x32_bf16 v[20:23], v[144:147], a[68:71], v[20:23]
    ds_read_b64_tr_b16 v[132:133], v216 offset:57344
    v_mfma_f32_16x16x32_bf16 v[20:23], v[148:151], a[84:87], v[20:23]
    ds_read_b64_tr_b16 v[134:135], v216 offset:59392
    v_mfma_f32_16x16x32_bf16 v[112:115], v[144:147], a[72:75], v[112:115]
    ds_read_b64_tr_b16 v[136:137], v217 offset:49152
    v_mfma_f32_16x16x32_bf16 v[112:115], v[148:151], a[88:91], v[112:115]
    ds_read_b64_tr_b16 v[138:139], v217 offset:51200
    v_mfma_f32_16x16x32_bf16 v[116:119], v[144:147], a[76:79], v[116:119]
    ds_read_b64_tr_b16 v[140:141], v217 offset:57344
    v_mfma_f32_16x16x32_bf16 v[116:119], v[148:151], a[92:95], v[116:119]
    ds_read_b64_tr_b16 v[142:143], v217 offset:59392
    v_mfma_f32_16x16x32_bf16 v[24:27], v[152:155], a[64:67], v[24:27]
    buffer_load_dwordx4 a[44:47], v246, s[8:11], s35 offen offset:2048 sc1
    v_mfma_f32_16x16x32_bf16 v[24:27], v[156:159], a[80:83], v[24:27]
    v_mfma_f32_16x16x32_bf16 v[28:31], v[152:155], a[68:71], v[28:31]
    buffer_load_dwordx4 a[48:51], v226, s[8:11], s35 offen offset:3072 sc1
    v_mfma_f32_16x16x32_bf16 v[28:31], v[156:159], a[84:87], v[28:31]
    v_mfma_f32_16x16x32_bf16 v[120:123], v[152:155], a[72:75], v[120:123]
    v_mfma_f32_16x16x32_bf16 v[120:123], v[156:159], a[88:91], v[120:123]
    v_mfma_f32_16x16x32_bf16 v[124:127], v[152:155], a[76:79], v[124:127]
    v_mfma_f32_16x16x32_bf16 v[124:127], v[156:159], a[92:95], v[124:127]
    buffer_load_dwordx4 a[52:55], v227, s[8:11], s35 offen offset:3072 sc1
    s_waitcnt vmcnt(18) lgkmcnt(0)
    v_mfma_f32_16x16x32_bf16 v[32:35], v[128:131], a[96:99], v[32:35]
    ds_read_b64_tr_b16 v[144:145], v218 offset:49152
    v_mfma_f32_16x16x32_bf16 v[32:35], v[132:135], a[112:115], v[32:35]
    ds_read_b64_tr_b16 v[146:147], v218 offset:51200
    v_mfma_f32_16x16x32_bf16 v[36:39], v[128:131], a[100:103], v[36:39]
    ds_read_b64_tr_b16 v[148:149], v218 offset:57344
    v_mfma_f32_16x16x32_bf16 v[36:39], v[132:135], a[116:119], v[36:39]
    ds_read_b64_tr_b16 v[150:151], v218 offset:59392
    v_mfma_f32_16x16x32_bf16 v[64:67], v[128:131], a[104:107], v[64:67]
    ds_read_b64_tr_b16 v[152:153], v219 offset:49152
    v_mfma_f32_16x16x32_bf16 v[64:67], v[132:135], a[120:123], v[64:67]
    ds_read_b64_tr_b16 v[154:155], v219 offset:51200
    v_mfma_f32_16x16x32_bf16 v[68:71], v[128:131], a[108:111], v[68:71]
    ds_read_b64_tr_b16 v[156:157], v219 offset:57344
    v_mfma_f32_16x16x32_bf16 v[68:71], v[132:135], a[124:127], v[68:71]
    ds_read_b64_tr_b16 v[158:159], v219 offset:59392
    v_mfma_f32_16x16x32_bf16 v[40:43], v[136:139], a[96:99], v[40:43]
    buffer_load_dwordx4 a[56:59], v245, s[8:11], s35 offen offset:3072 sc1
    v_mfma_f32_16x16x32_bf16 v[40:43], v[140:143], a[112:115], v[40:43]
    s_add_u32 m0, s38, 16384
    s_add_u32 s32, s37, 1179648
    v_mfma_f32_16x16x32_bf16 v[44:47], v[136:139], a[100:103], v[44:47]
    buffer_load_dwordx4 v224, s[12:15], s32 offen lds
    v_mfma_f32_16x16x32_bf16 v[44:47], v[140:143], a[116:119], v[44:47]
    buffer_load_dwordx4 a[60:63], v246, s[8:11], s35 offen offset:3072 sc1
    v_mfma_f32_16x16x32_bf16 v[72:75], v[136:139], a[104:107], v[72:75]
    v_mfma_f32_16x16x32_bf16 v[72:75], v[140:143], a[120:123], v[72:75]
    buffer_load_dwordx4 v225, s[12:15], s32 offen offset:1024 lds
    v_mfma_f32_16x16x32_bf16 v[76:79], v[136:139], a[108:111], v[76:79]
    v_mfma_f32_16x16x32_bf16 v[76:79], v[140:143], a[124:127], v[76:79]
    s_waitcnt lgkmcnt(0)
    v_mfma_f32_16x16x32_bf16 v[48:51], v[144:147], a[96:99], v[48:51]
    ds_read_b64_tr_b16 v[128:129], v220 offset:49152
    v_mfma_f32_16x16x32_bf16 v[48:51], v[148:151], a[112:115], v[48:51]
    ds_read_b64_tr_b16 v[130:131], v220 offset:51200
    v_mfma_f32_16x16x32_bf16 v[52:55], v[144:147], a[100:103], v[52:55]
    ds_read_b64_tr_b16 v[132:133], v220 offset:57344
    v_mfma_f32_16x16x32_bf16 v[52:55], v[148:151], a[116:119], v[52:55]
    ds_read_b64_tr_b16 v[134:135], v220 offset:59392
    v_mfma_f32_16x16x32_bf16 v[80:83], v[144:147], a[104:107], v[80:83]
    ds_read_b64_tr_b16 v[136:137], v221 offset:49152
    v_mfma_f32_16x16x32_bf16 v[80:83], v[148:151], a[120:123], v[80:83]
    ds_read_b64_tr_b16 v[138:139], v221 offset:51200
    v_mfma_f32_16x16x32_bf16 v[84:87], v[144:147], a[108:111], v[84:87]
    ds_read_b64_tr_b16 v[140:141], v221 offset:57344
    v_mfma_f32_16x16x32_bf16 v[84:87], v[148:151], a[124:127], v[84:87]
    ds_read_b64_tr_b16 v[142:143], v221 offset:59392
    v_mfma_f32_16x16x32_bf16 v[56:59], v[152:155], a[96:99], v[56:59]
    s_add_u32 s35, s35, 4096
    buffer_load_dwordx4 a[64:67], v226, s[8:11], s35 offen offset:0 sc1
    v_mfma_f32_16x16x32_bf16 v[56:59], v[156:159], a[112:115], v[56:59]
    v_mfma_f32_16x16x32_bf16 v[60:63], v[152:155], a[100:103], v[60:63]
    buffer_load_dwordx4 a[68:71], v227, s[8:11], s35 offen offset:0 sc1
    v_mfma_f32_16x16x32_bf16 v[60:63], v[156:159], a[116:119], v[60:63]
    v_mfma_f32_16x16x32_bf16 v[88:91], v[152:155], a[104:107], v[88:91]
    v_mfma_f32_16x16x32_bf16 v[88:91], v[156:159], a[120:123], v[88:91]
    v_mfma_f32_16x16x32_bf16 v[92:95], v[152:155], a[108:111], v[92:95]
    v_mfma_f32_16x16x32_bf16 v[92:95], v[156:159], a[124:127], v[92:95]
    buffer_load_dwordx4 a[72:75], v245, s[8:11], s35 offen offset:0 sc1
    s_waitcnt lgkmcnt(0)
    v_mfma_f32_16x16x32_bf16 v[0:3], v[128:131], a[96:99], v[0:3]
    ds_read_b64_tr_b16 v[144:145], v222 offset:49152
    v_mfma_f32_16x16x32_bf16 v[0:3], v[132:135], a[112:115], v[0:3]
    ds_read_b64_tr_b16 v[146:147], v222 offset:51200
    v_mfma_f32_16x16x32_bf16 v[4:7], v[128:131], a[100:103], v[4:7]
    ds_read_b64_tr_b16 v[148:149], v222 offset:57344
    v_mfma_f32_16x16x32_bf16 v[4:7], v[132:135], a[116:119], v[4:7]
    ds_read_b64_tr_b16 v[150:151], v222 offset:59392
    v_mfma_f32_16x16x32_bf16 v[96:99], v[128:131], a[104:107], v[96:99]
    ds_read_b64_tr_b16 v[152:153], v223 offset:49152
    v_mfma_f32_16x16x32_bf16 v[96:99], v[132:135], a[120:123], v[96:99]
    ds_read_b64_tr_b16 v[154:155], v223 offset:51200
    v_mfma_f32_16x16x32_bf16 v[100:103], v[128:131], a[108:111], v[100:103]
    ds_read_b64_tr_b16 v[156:157], v223 offset:57344
    v_mfma_f32_16x16x32_bf16 v[100:103], v[132:135], a[124:127], v[100:103]
    ds_read_b64_tr_b16 v[158:159], v223 offset:59392
    v_mfma_f32_16x16x32_bf16 v[8:11], v[136:139], a[96:99], v[8:11]
    buffer_load_dwordx4 a[76:79], v246, s[8:11], s35 offen offset:0 sc1
    v_mfma_f32_16x16x32_bf16 v[8:11], v[140:143], a[112:115], v[8:11]
    s_add_u32 m0, s38, 24576
    s_add_u32 s32, s37, 1245184
    v_mfma_f32_16x16x32_bf16 v[12:15], v[136:139], a[100:103], v[12:15]
    buffer_load_dwordx4 v224, s[12:15], s32 offen lds
    v_mfma_f32_16x16x32_bf16 v[12:15], v[140:143], a[116:119], v[12:15]
    v_mfma_f32_16x16x32_bf16 v[104:107], v[136:139], a[104:107], v[104:107]
    v_mfma_f32_16x16x32_bf16 v[104:107], v[140:143], a[120:123], v[104:107]
    buffer_load_dwordx4 v225, s[12:15], s32 offen offset:1024 lds
    v_mfma_f32_16x16x32_bf16 v[108:111], v[136:139], a[108:111], v[108:111]
    v_mfma_f32_16x16x32_bf16 v[108:111], v[140:143], a[124:127], v[108:111]
    buffer_load_dwordx4 a[80:83], v226, s[8:11], s35 offen offset:1024 sc1
    s_waitcnt lgkmcnt(0)
    s_barrier
    v_mfma_f32_16x16x32_bf16 v[16:19], v[144:147], a[96:99], v[16:19]
    v_xor_b32 v216, 0x10000, v216
    ds_read_b64_tr_b16 v[128:129], v216 offset:0
    v_mfma_f32_16x16x32_bf16 v[16:19], v[148:151], a[112:115], v[16:19]
    ds_read_b64_tr_b16 v[130:131], v216 offset:2048
    v_mfma_f32_16x16x32_bf16 v[20:23], v[144:147], a[100:103], v[20:23]
    ds_read_b64_tr_b16 v[132:133], v216 offset:8192
    v_mfma_f32_16x16x32_bf16 v[20:23], v[148:151], a[116:119], v[20:23]
    ds_read_b64_tr_b16 v[134:135], v216 offset:10240
    v_mfma_f32_16x16x32_bf16 v[112:115], v[144:147], a[104:107], v[112:115]
    v_xor_b32 v217, 0x10000, v217
    ds_read_b64_tr_b16 v[136:137], v217 offset:0
    v_mfma_f32_16x16x32_bf16 v[112:115], v[148:151], a[120:123], v[112:115]
    ds_read_b64_tr_b16 v[138:139], v217 offset:2048
    v_mfma_f32_16x16x32_bf16 v[116:119], v[144:147], a[108:111], v[116:119]
    ds_read_b64_tr_b16 v[140:141], v217 offset:8192
    v_mfma_f32_16x16x32_bf16 v[116:119], v[148:151], a[124:127], v[116:119]
    ds_read_b64_tr_b16 v[142:143], v217 offset:10240
    v_mfma_f32_16x16x32_bf16 v[24:27], v[152:155], a[96:99], v[24:27]
    buffer_load_dwordx4 a[84:87], v227, s[8:11], s35 offen offset:1024 sc1
    v_mfma_f32_16x16x32_bf16 v[24:27], v[156:159], a[112:115], v[24:27]
    v_mfma_f32_16x16x32_bf16 v[28:31], v[152:155], a[100:103], v[28:31]
    buffer_load_dwordx4 a[88:91], v245, s[8:11], s35 offen offset:1024 sc1
    v_mfma_f32_16x16x32_bf16 v[28:31], v[156:159], a[116:119], v[28:31]
    v_mfma_f32_16x16x32_bf16 v[120:123], v[152:155], a[104:107], v[120:123]
    v_mfma_f32_16x16x32_bf16 v[120:123], v[156:159], a[120:123], v[120:123]
    v_mfma_f32_16x16x32_bf16 v[124:127], v[152:155], a[108:111], v[124:127]
    v_mfma_f32_16x16x32_bf16 v[124:127], v[156:159], a[124:127], v[124:127]
    s_waitcnt vmcnt(21) lgkmcnt(0)
    v_mfma_f32_16x16x32_bf16 v[32:35], v[128:131], a[0:3], v[32:35]
    v_xor_b32 v218, 0x10000, v218
    ds_read_b64_tr_b16 v[144:145], v218 offset:0
    v_mfma_f32_16x16x32_bf16 v[32:35], v[132:135], a[16:19], v[32:35]
    ds_read_b64_tr_b16 v[146:147], v218 offset:2048
    v_mfma_f32_16x16x32_bf16 v[36:39], v[128:131], a[4:7], v[36:39]
    ds_read_b64_tr_b16 v[148:149], v218 offset:8192
    v_mfma_f32_16x16x32_bf16 v[36:39], v[132:135], a[20:23], v[36:39]
    ds_read_b64_tr_b16 v[150:151], v218 offset:10240
    v_mfma_f32_16x16x32_bf16 v[64:67], v[128:131], a[8:11], v[64:67]
    v_xor_b32 v219, 0x10000, v219
    ds_read_b64_tr_b16 v[152:153], v219 offset:0
    v_mfma_f32_16x16x32_bf16 v[64:67], v[132:135], a[24:27], v[64:67]
    ds_read_b64_tr_b16 v[154:155], v219 offset:2048
    v_mfma_f32_16x16x32_bf16 v[68:71], v[128:131], a[12:15], v[68:71]
    ds_read_b64_tr_b16 v[156:157], v219 offset:8192
    v_mfma_f32_16x16x32_bf16 v[68:71], v[132:135], a[28:31], v[68:71]
    ds_read_b64_tr_b16 v[158:159], v219 offset:10240
    v_mfma_f32_16x16x32_bf16 v[40:43], v[136:139], a[0:3], v[40:43]
    buffer_load_dwordx4 a[92:95], v246, s[8:11], s35 offen offset:1024 sc1
    v_mfma_f32_16x16x32_bf16 v[40:43], v[140:143], a[16:19], v[40:43]
    s_add_u32 m0, s38, 32768
    s_add_u32 s32, s37, 1310720
    v_mfma_f32_16x16x32_bf16 v[44:47], v[136:139], a[4:7], v[44:47]
    buffer_load_dwordx4 v224, s[12:15], s32 offen lds
    v_mfma_f32_16x16x32_bf16 v[44:47], v[140:143], a[20:23], v[44:47]
    buffer_load_dwordx4 a[96:99], v226, s[8:11], s35 offen offset:2048 sc1
    v_mfma_f32_16x16x32_bf16 v[72:75], v[136:139], a[8:11], v[72:75]
    v_mfma_f32_16x16x32_bf16 v[72:75], v[140:143], a[24:27], v[72:75]
    buffer_load_dwordx4 v225, s[12:15], s32 offen offset:1024 lds
    v_mfma_f32_16x16x32_bf16 v[76:79], v[136:139], a[12:15], v[76:79]
    s_lshl_b32 s45, s52, 7
    s_add_u32 s45, s45, 0x38a1400
    v_mfma_f32_16x16x32_bf16 v[76:79], v[140:143], a[28:31], v[76:79]
    buffer_load_dwordx4 a[100:103], v227, s[8:11], s35 offen offset:2048 sc1
    s_waitcnt lgkmcnt(0)
    v_mfma_f32_16x16x32_bf16 v[48:51], v[144:147], a[0:3], v[48:51]
    v_xor_b32 v220, 0x10000, v220
    ds_read_b64_tr_b16 v[128:129], v220 offset:0
    v_mfma_f32_16x16x32_bf16 v[48:51], v[148:151], a[16:19], v[48:51]
    ds_read_b64_tr_b16 v[130:131], v220 offset:2048
    v_mfma_f32_16x16x32_bf16 v[52:55], v[144:147], a[4:7], v[52:55]
    ds_read_b64_tr_b16 v[132:133], v220 offset:8192
    v_mfma_f32_16x16x32_bf16 v[52:55], v[148:151], a[20:23], v[52:55]
    ds_read_b64_tr_b16 v[134:135], v220 offset:10240
    v_mfma_f32_16x16x32_bf16 v[80:83], v[144:147], a[8:11], v[80:83]
    v_xor_b32 v221, 0x10000, v221
    ds_read_b64_tr_b16 v[136:137], v221 offset:0
    v_mfma_f32_16x16x32_bf16 v[80:83], v[148:151], a[24:27], v[80:83]
    ds_read_b64_tr_b16 v[138:139], v221 offset:2048
    v_mfma_f32_16x16x32_bf16 v[84:87], v[144:147], a[12:15], v[84:87]
    ds_read_b64_tr_b16 v[140:141], v221 offset:8192
    v_mfma_f32_16x16x32_bf16 v[84:87], v[148:151], a[28:31], v[84:87]
    ds_read_b64_tr_b16 v[142:143], v221 offset:10240
    v_mfma_f32_16x16x32_bf16 v[56:59], v[152:155], a[0:3], v[56:59]
    buffer_load_dwordx4 a[104:107], v245, s[8:11], s35 offen offset:2048 sc1
    v_mfma_f32_16x16x32_bf16 v[56:59], v[156:159], a[16:19], v[56:59]
    s_cmp_eq_u32 s3, 0
    s_cselect_b32 s45, s45, 0x40000000
    v_mfma_f32_16x16x32_bf16 v[60:63], v[152:155], a[4:7], v[60:63]
    buffer_load_dwordx4 a[108:111], v246, s[8:11], s35 offen offset:2048 sc1
    buffer_load_dword v235, off, s[8:11], s45 sc1
    v_mfma_f32_16x16x32_bf16 v[60:63], v[156:159], a[20:23], v[60:63]
    v_mfma_f32_16x16x32_bf16 v[88:91], v[152:155], a[8:11], v[88:91]
    v_mfma_f32_16x16x32_bf16 v[88:91], v[156:159], a[24:27], v[88:91]
    v_mfma_f32_16x16x32_bf16 v[92:95], v[152:155], a[12:15], v[92:95]
    v_mfma_f32_16x16x32_bf16 v[92:95], v[156:159], a[28:31], v[92:95]
    s_waitcnt lgkmcnt(0)
    v_mfma_f32_16x16x32_bf16 v[0:3], v[128:131], a[0:3], v[0:3]
    v_xor_b32 v222, 0x10000, v222
    ds_read_b64_tr_b16 v[144:145], v222 offset:0
    v_mfma_f32_16x16x32_bf16 v[0:3], v[132:135], a[16:19], v[0:3]
    ds_read_b64_tr_b16 v[146:147], v222 offset:2048
    v_mfma_f32_16x16x32_bf16 v[4:7], v[128:131], a[4:7], v[4:7]
    ds_read_b64_tr_b16 v[148:149], v222 offset:8192
    v_mfma_f32_16x16x32_bf16 v[4:7], v[132:135], a[20:23], v[4:7]
    ds_read_b64_tr_b16 v[150:151], v222 offset:10240
    v_mfma_f32_16x16x32_bf16 v[96:99], v[128:131], a[8:11], v[96:99]
    v_xor_b32 v223, 0x10000, v223
    ds_read_b64_tr_b16 v[152:153], v223 offset:0
    v_mfma_f32_16x16x32_bf16 v[96:99], v[132:135], a[24:27], v[96:99]
    ds_read_b64_tr_b16 v[154:155], v223 offset:2048
    v_mfma_f32_16x16x32_bf16 v[100:103], v[128:131], a[12:15], v[100:103]
    ds_read_b64_tr_b16 v[156:157], v223 offset:8192
    v_mfma_f32_16x16x32_bf16 v[100:103], v[132:135], a[28:31], v[100:103]
    ds_read_b64_tr_b16 v[158:159], v223 offset:10240
    v_mfma_f32_16x16x32_bf16 v[8:11], v[136:139], a[0:3], v[8:11]
    buffer_load_dwordx4 a[112:115], v226, s[8:11], s35 offen offset:3072 sc1
    v_mfma_f32_16x16x32_bf16 v[8:11], v[140:143], a[16:19], v[8:11]
    s_add_u32 m0, s38, 40960
    s_add_u32 s32, s37, 1376256
    v_mfma_f32_16x16x32_bf16 v[12:15], v[136:139], a[4:7], v[12:15]
    buffer_load_dwordx4 v224, s[12:15], s32 offen lds
    v_mfma_f32_16x16x32_bf16 v[12:15], v[140:143], a[20:23], v[12:15]
    buffer_load_dwordx4 a[116:119], v227, s[8:11], s35 offen offset:3072 sc1
    v_mfma_f32_16x16x32_bf16 v[104:107], v[136:139], a[8:11], v[104:107]
    v_mfma_f32_16x16x32_bf16 v[104:107], v[140:143], a[24:27], v[104:107]
    buffer_load_dwordx4 v225, s[12:15], s32 offen offset:1024 lds
    v_mfma_f32_16x16x32_bf16 v[108:111], v[136:139], a[12:15], v[108:111]
    v_mfma_f32_16x16x32_bf16 v[108:111], v[140:143], a[28:31], v[108:111]
    buffer_load_dwordx4 a[120:123], v245, s[8:11], s35 offen offset:3072 sc1
    s_waitcnt lgkmcnt(0)
    v_mfma_f32_16x16x32_bf16 v[16:19], v[144:147], a[0:3], v[16:19]
    ds_read_b64_tr_b16 v[128:129], v216 offset:16384
    v_mfma_f32_16x16x32_bf16 v[16:19], v[148:151], a[16:19], v[16:19]
    ds_read_b64_tr_b16 v[130:131], v216 offset:18432
    v_mfma_f32_16x16x32_bf16 v[20:23], v[144:147], a[4:7], v[20:23]
    ds_read_b64_tr_b16 v[132:133], v216 offset:24576
    v_mfma_f32_16x16x32_bf16 v[20:23], v[148:151], a[20:23], v[20:23]
    ds_read_b64_tr_b16 v[134:135], v216 offset:26624
    v_mfma_f32_16x16x32_bf16 v[112:115], v[144:147], a[8:11], v[112:115]
    ds_read_b64_tr_b16 v[136:137], v217 offset:16384
    v_mfma_f32_16x16x32_bf16 v[112:115], v[148:151], a[24:27], v[112:115]
    ds_read_b64_tr_b16 v[138:139], v217 offset:18432
    v_mfma_f32_16x16x32_bf16 v[116:119], v[144:147], a[12:15], v[116:119]
    ds_read_b64_tr_b16 v[140:141], v217 offset:24576
    v_mfma_f32_16x16x32_bf16 v[116:119], v[148:151], a[28:31], v[116:119]
    ds_read_b64_tr_b16 v[142:143], v217 offset:26624
    v_mfma_f32_16x16x32_bf16 v[24:27], v[152:155], a[0:3], v[24:27]
    buffer_load_dwordx4 a[124:127], v246, s[8:11], s35 offen offset:3072 sc1
    v_mfma_f32_16x16x32_bf16 v[24:27], v[156:159], a[16:19], v[24:27]
    v_mfma_f32_16x16x32_bf16 v[28:31], v[152:155], a[4:7], v[28:31]
    v_mfma_f32_16x16x32_bf16 v[28:31], v[156:159], a[20:23], v[28:31]
    v_mfma_f32_16x16x32_bf16 v[120:123], v[152:155], a[8:11], v[120:123]
    v_mfma_f32_16x16x32_bf16 v[120:123], v[156:159], a[24:27], v[120:123]
    v_mfma_f32_16x16x32_bf16 v[124:127], v[152:155], a[12:15], v[124:127]
    v_mfma_f32_16x16x32_bf16 v[124:127], v[156:159], a[28:31], v[124:127]
    s_add_u32 s35, s35, 4096
    buffer_load_dwordx4 a[0:3], v226, s[8:11], s35 offen offset:0 sc1
    s_waitcnt vmcnt(25) lgkmcnt(0)
    v_mfma_f32_16x16x32_bf16 v[32:35], v[128:131], a[32:35], v[32:35]
    ds_read_b64_tr_b16 v[144:145], v218 offset:16384
    v_mfma_f32_16x16x32_bf16 v[32:35], v[132:135], a[48:51], v[32:35]
    ds_read_b64_tr_b16 v[146:147], v218 offset:18432
    v_mfma_f32_16x16x32_bf16 v[36:39], v[128:131], a[36:39], v[36:39]
    ds_read_b64_tr_b16 v[148:149], v218 offset:24576
    v_mfma_f32_16x16x32_bf16 v[36:39], v[132:135], a[52:55], v[36:39]
    ds_read_b64_tr_b16 v[150:151], v218 offset:26624
    v_mfma_f32_16x16x32_bf16 v[64:67], v[128:131], a[40:43], v[64:67]
    ds_read_b64_tr_b16 v[152:153], v219 offset:16384
    v_mfma_f32_16x16x32_bf16 v[64:67], v[132:135], a[56:59], v[64:67]
    ds_read_b64_tr_b16 v[154:155], v219 offset:18432
    v_mfma_f32_16x16x32_bf16 v[68:71], v[128:131], a[44:47], v[68:71]
    ds_read_b64_tr_b16 v[156:157], v219 offset:24576
    v_mfma_f32_16x16x32_bf16 v[68:71], v[132:135], a[60:63], v[68:71]
    ds_read_b64_tr_b16 v[158:159], v219 offset:26624
    v_mfma_f32_16x16x32_bf16 v[40:43], v[136:139], a[32:35], v[40:43]
    buffer_load_dwordx4 a[4:7], v227, s[8:11], s35 offen offset:0 sc1
    v_mfma_f32_16x16x32_bf16 v[40:43], v[140:143], a[48:51], v[40:43]
    s_add_u32 m0, s38, 49152
    s_add_u32 s32, s37, 1441792
    v_mfma_f32_16x16x32_bf16 v[44:47], v[136:139], a[36:39], v[44:47]
    buffer_load_dwordx4 v224, s[12:15], s32 offen lds
    v_mfma_f32_16x16x32_bf16 v[44:47], v[140:143], a[52:55], v[44:47]
    buffer_load_dwordx4 a[8:11], v245, s[8:11], s35 offen offset:0 sc1
    v_mfma_f32_16x16x32_bf16 v[72:75], v[136:139], a[40:43], v[72:75]
    v_mfma_f32_16x16x32_bf16 v[72:75], v[140:143], a[56:59], v[72:75]
    buffer_load_dwordx4 v225, s[12:15], s32 offen offset:1024 lds
    v_mfma_f32_16x16x32_bf16 v[76:79], v[136:139], a[44:47], v[76:79]
    v_mfma_f32_16x16x32_bf16 v[76:79], v[140:143], a[60:63], v[76:79]
    buffer_load_dwordx4 a[12:15], v246, s[8:11], s35 offen offset:0 sc1
    s_waitcnt lgkmcnt(0)
    v_mfma_f32_16x16x32_bf16 v[48:51], v[144:147], a[32:35], v[48:51]
    ds_read_b64_tr_b16 v[128:129], v220 offset:16384
    v_mfma_f32_16x16x32_bf16 v[48:51], v[148:151], a[48:51], v[48:51]
    ds_read_b64_tr_b16 v[130:131], v220 offset:18432
    v_mfma_f32_16x16x32_bf16 v[52:55], v[144:147], a[36:39], v[52:55]
    ds_read_b64_tr_b16 v[132:133], v220 offset:24576
    v_mfma_f32_16x16x32_bf16 v[52:55], v[148:151], a[52:55], v[52:55]
    ds_read_b64_tr_b16 v[134:135], v220 offset:26624
    v_mfma_f32_16x16x32_bf16 v[80:83], v[144:147], a[40:43], v[80:83]
    ds_read_b64_tr_b16 v[136:137], v221 offset:16384
    v_mfma_f32_16x16x32_bf16 v[80:83], v[148:151], a[56:59], v[80:83]
    ds_read_b64_tr_b16 v[138:139], v221 offset:18432
    v_mfma_f32_16x16x32_bf16 v[84:87], v[144:147], a[44:47], v[84:87]
    ds_read_b64_tr_b16 v[140:141], v221 offset:24576
    v_mfma_f32_16x16x32_bf16 v[84:87], v[148:151], a[60:63], v[84:87]
    ds_read_b64_tr_b16 v[142:143], v221 offset:26624
    v_mfma_f32_16x16x32_bf16 v[56:59], v[152:155], a[32:35], v[56:59]
    buffer_load_dwordx4 a[16:19], v226, s[8:11], s35 offen offset:1024 sc1
    v_mfma_f32_16x16x32_bf16 v[56:59], v[156:159], a[48:51], v[56:59]
    v_mfma_f32_16x16x32_bf16 v[60:63], v[152:155], a[36:39], v[60:63]
    v_mfma_f32_16x16x32_bf16 v[60:63], v[156:159], a[52:55], v[60:63]
    v_mfma_f32_16x16x32_bf16 v[88:91], v[152:155], a[40:43], v[88:91]
    buffer_load_dwordx4 a[20:23], v227, s[8:11], s35 offen offset:1024 sc1
    v_mfma_f32_16x16x32_bf16 v[88:91], v[156:159], a[56:59], v[88:91]
    v_mfma_f32_16x16x32_bf16 v[92:95], v[152:155], a[44:47], v[92:95]
    v_mfma_f32_16x16x32_bf16 v[92:95], v[156:159], a[60:63], v[92:95]
    s_waitcnt lgkmcnt(0)
    v_mfma_f32_16x16x32_bf16 v[0:3], v[128:131], a[32:35], v[0:3]
    ds_read_b64_tr_b16 v[144:145], v222 offset:16384
    v_mfma_f32_16x16x32_bf16 v[0:3], v[132:135], a[48:51], v[0:3]
    ds_read_b64_tr_b16 v[146:147], v222 offset:18432
    v_mfma_f32_16x16x32_bf16 v[4:7], v[128:131], a[36:39], v[4:7]
    ds_read_b64_tr_b16 v[148:149], v222 offset:24576
    v_mfma_f32_16x16x32_bf16 v[4:7], v[132:135], a[52:55], v[4:7]
    ds_read_b64_tr_b16 v[150:151], v222 offset:26624
    v_mfma_f32_16x16x32_bf16 v[96:99], v[128:131], a[40:43], v[96:99]
    ds_read_b64_tr_b16 v[152:153], v223 offset:16384
    v_mfma_f32_16x16x32_bf16 v[96:99], v[132:135], a[56:59], v[96:99]
    ds_read_b64_tr_b16 v[154:155], v223 offset:18432
    v_mfma_f32_16x16x32_bf16 v[100:103], v[128:131], a[44:47], v[100:103]
    ds_read_b64_tr_b16 v[156:157], v223 offset:24576
    v_mfma_f32_16x16x32_bf16 v[100:103], v[132:135], a[60:63], v[100:103]
    ds_read_b64_tr_b16 v[158:159], v223 offset:26624
    v_mfma_f32_16x16x32_bf16 v[8:11], v[136:139], a[32:35], v[8:11]
    buffer_load_dwordx4 a[24:27], v245, s[8:11], s35 offen offset:1024 sc1
    v_mfma_f32_16x16x32_bf16 v[8:11], v[140:143], a[48:51], v[8:11]
    s_add_u32 m0, s38, 57344
    s_add_u32 s32, s37, 1507328
    v_mfma_f32_16x16x32_bf16 v[12:15], v[136:139], a[36:39], v[12:15]
    buffer_load_dwordx4 v224, s[12:15], s32 offen lds
    v_mfma_f32_16x16x32_bf16 v[12:15], v[140:143], a[52:55], v[12:15]
    buffer_load_dwordx4 a[28:31], v246, s[8:11], s35 offen offset:1024 sc1
    v_mfma_f32_16x16x32_bf16 v[104:107], v[136:139], a[40:43], v[104:107]
    v_mfma_f32_16x16x32_bf16 v[104:107], v[140:143], a[56:59], v[104:107]
    buffer_load_dwordx4 v225, s[12:15], s32 offen offset:1024 lds
    v_mfma_f32_16x16x32_bf16 v[108:111], v[136:139], a[44:47], v[108:111]
    s_waitcnt vmcnt(18)
    v_readfirstlane_b32 s36, v235
    s_lshl_b32 s34, s3, 8
    s_add_u32 s36, s36, s34
    s_cmp_ge_u32 s36, 8
    s_cbranch_scc0 kc_g
kc_gr:
    v_mfma_f32_16x16x32_bf16 v[108:111], v[140:143], a[60:63], v[108:111]
    s_waitcnt lgkmcnt(0)
    s_barrier
    v_mfma_f32_16x16x32_bf16 v[16:19], v[144:147], a[32:35], v[16:19]
    ds_read_b64_tr_b16 v[128:129], v216 offset:32768
    v_mfma_f32_16x16x32_bf16 v[16:19], v[148:151], a[48:51], v[16:19]
    ds_read_b64_tr_b16 v[130:131], v216 offset:34816
    v_mfma_f32_16x16x32_bf16 v[20:23], v[144:147], a[36:39], v[20:23]
    ds_read_b64_tr_b16 v[132:133], v216 offset:40960
    v_mfma_f32_16x16x32_bf16 v[20:23], v[148:151], a[52:55], v[20:23]
    ds_read_b64_tr_b16 v[134:135], v216 offset:43008
    v_mfma_f32_16x16x32_bf16 v[112:115], v[144:147], a[40:43], v[112:115]
    ds_read_b64_tr_b16 v[136:137], v217 offset:32768
    v_mfma_f32_16x16x32_bf16 v[112:115], v[148:151], a[56:59], v[112:115]
    ds_read_b64_tr_b16 v[138:139], v217 offset:34816
    v_mfma_f32_16x16x32_bf16 v[116:119], v[144:147], a[44:47], v[116:119]
    ds_read_b64_tr_b16 v[140:141], v217 offset:40960
    v_mfma_f32_16x16x32_bf16 v[116:119], v[148:151], a[60:63], v[116:119]
    ds_read_b64_tr_b16 v[142:143], v217 offset:43008
    v_mfma_f32_16x16x32_bf16 v[24:27], v[152:155], a[32:35], v[24:27]
    v_mfma_f32_16x16x32_bf16 v[24:27], v[156:159], a[48:51], v[24:27]
    v_mfma_f32_16x16x32_bf16 v[28:31], v[152:155], a[36:39], v[28:31]
    v_mfma_f32_16x16x32_bf16 v[28:31], v[156:159], a[52:55], v[28:31]
    v_mfma_f32_16x16x32_bf16 v[120:123], v[152:155], a[40:43], v[120:123]
    v_mfma_f32_16x16x32_bf16 v[120:123], v[156:159], a[56:59], v[120:123]
    v_mfma_f32_16x16x32_bf16 v[124:127], v[152:155], a[44:47], v[124:127]
    v_mfma_f32_16x16x32_bf16 v[124:127], v[156:159], a[60:63], v[124:127]
    buffer_load_dwordx4 a[32:35], v226, s[8:11], s35 offen offset:2048 sc1
    s_waitcnt vmcnt(26) lgkmcnt(0)
    v_mfma_f32_16x16x32_bf16 v[32:35], v[128:131], a[64:67], v[32:35]
    ds_read_b64_tr_b16 v[144:145], v218 offset:32768
    v_mfma_f32_16x16x32_bf16 v[32:35], v[132:135], a[80:83], v[32:35]
    ds_read_b64_tr_b16 v[146:147], v218 offset:34816
    v_mfma_f32_16x16x32_bf16 v[36:39], v[128:131], a[68:71], v[36:39]
    ds_read_b64_tr_b16 v[148:149], v218 offset:40960
    v_mfma_f32_16x16x32_bf16 v[36:39], v[132:135], a[84:87], v[36:39]
    ds_read_b64_tr_b16 v[150:151], v218 offset:43008
    v_mfma_f32_16x16x32_bf16 v[64:67], v[128:131], a[72:75], v[64:67]
    ds_read_b64_tr_b16 v[152:153], v219 offset:32768
    v_mfma_f32_16x16x32_bf16 v[64:67], v[132:135], a[88:91], v[64:67]
    ds_read_b64_tr_b16 v[154:155], v219 offset:34816
    v_mfma_f32_16x16x32_bf16 v[68:71], v[128:131], a[76:79], v[68:71]
    ds_read_b64_tr_b16 v[156:157], v219 offset:40960
    v_mfma_f32_16x16x32_bf16 v[68:71], v[132:135], a[92:95], v[68:71]
    ds_read_b64_tr_b16 v[158:159], v219 offset:43008
    v_mfma_f32_16x16x32_bf16 v[40:43], v[136:139], a[64:67], v[40:43]
    buffer_load_dwordx4 a[36:39], v227, s[8:11], s35 offen offset:2048 sc1
    v_mfma_f32_16x16x32_bf16 v[40:43], v[140:143], a[80:83], v[40:43]
    s_add_u32 m0, s38, 65536
    s_add_u32 s32, s37, 1572864
    v_mfma_f32_16x16x32_bf16 v[44:47], v[136:139], a[68:71], v[44:47]
    buffer_load_dwordx4 v224, s[12:15], s32 offen lds
    v_mfma_f32_16x16x32_bf16 v[44:47], v[140:143], a[84:87], v[44:47]
    buffer_load_dwordx4 a[40:43], v245, s[8:11], s35 offen offset:2048 sc1
    v_mfma_f32_16x16x32_bf16 v[72:75], v[136:139], a[72:75], v[72:75]
    v_mfma_f32_16x16x32_bf16 v[72:75], v[140:143], a[88:91], v[72:75]
    buffer_load_dwordx4 v225, s[12:15], s32 offen offset:1024 lds
    v_mfma_f32_16x16x32_bf16 v[76:79], v[136:139], a[76:79], v[76:79]
    s_add_u32 s33, s55, 0
    buffer_load_dwordx4 a[128:131], v228, s[8:11], s33 offen offset:0 sc1
    v_mfma_f32_16x16x32_bf16 v[76:79], v[140:143], a[92:95], v[76:79]
    buffer_load_dwordx4 a[44:47], v246, s[8:11], s35 offen offset:2048 sc1
    s_waitcnt lgkmcnt(0)
    v_mfma_f32_16x16x32_bf16 v[48:51], v[144:147], a[64:67], v[48:51]
    ds_read_b64_tr_b16 v[128:129], v220 offset:32768
    v_mfma_f32_16x16x32_bf16 v[48:51], v[148:151], a[80:83], v[48:51]
    ds_read_b64_tr_b16 v[130:131], v220 offset:34816
    v_mfma_f32_16x16x32_bf16 v[52:55], v[144:147], a[68:71], v[52:55]
    ds_read_b64_tr_b16 v[132:133], v220 offset:40960
    v_mfma_f32_16x16x32_bf16 v[52:55], v[148:151], a[84:87], v[52:55]
    ds_read_b64_tr_b16 v[134:135], v220 offset:43008
    v_mfma_f32_16x16x32_bf16 v[80:83], v[144:147], a[72:75], v[80:83]
    ds_read_b64_tr_b16 v[136:137], v221 offset:32768
    v_mfma_f32_16x16x32_bf16 v[80:83], v[148:151], a[88:91], v[80:83]
    ds_read_b64_tr_b16 v[138:139], v221 offset:34816
    v_mfma_f32_16x16x32_bf16 v[84:87], v[144:147], a[76:79], v[84:87]
    ds_read_b64_tr_b16 v[140:141], v221 offset:40960
    v_mfma_f32_16x16x32_bf16 v[84:87], v[148:151], a[92:95], v[84:87]
    ds_read_b64_tr_b16 v[142:143], v221 offset:43008
    v_mfma_f32_16x16x32_bf16 v[56:59], v[152:155], a[64:67], v[56:59]
    buffer_load_dwordx4 a[48:51], v226, s[8:11], s35 offen offset:3072 sc1
    v_mfma_f32_16x16x32_bf16 v[56:59], v[156:159], a[80:83], v[56:59]
    v_mfma_f32_16x16x32_bf16 v[60:63], v[152:155], a[68:71], v[60:63]
    buffer_load_dwordx4 a[52:55], v227, s[8:11], s35 offen offset:3072 sc1
    v_mfma_f32_16x16x32_bf16 v[60:63], v[156:159], a[84:87], v[60:63]
    v_mfma_f32_16x16x32_bf16 v[88:91], v[152:155], a[72:75], v[88:91]
    buffer_load_dwordx4 a[56:59], v245, s[8:11], s35 offen offset:3072 sc1
    v_mfma_f32_16x16x32_bf16 v[88:91], v[156:159], a[88:91], v[88:91]
    v_mfma_f32_16x16x32_bf16 v[92:95], v[152:155], a[76:79], v[92:95]
    buffer_load_dwordx4 a[132:135], v228, s[8:11], s33 offen offset:1024 sc1
    v_mfma_f32_16x16x32_bf16 v[92:95], v[156:159], a[92:95], v[92:95]
    buffer_load_dwordx4 a[60:63], v246, s[8:11], s35 offen offset:3072 sc1
    s_waitcnt lgkmcnt(0)
    v_mfma_f32_16x16x32_bf16 v[0:3], v[128:131], a[64:67], v[0:3]
    ds_read_b64_tr_b16 v[144:145], v222 offset:32768
    v_mfma_f32_16x16x32_bf16 v[0:3], v[132:135], a[80:83], v[0:3]
    ds_read_b64_tr_b16 v[146:147], v222 offset:34816
    v_mfma_f32_16x16x32_bf16 v[4:7], v[128:131], a[68:71], v[4:7]
    ds_read_b64_tr_b16 v[148:149], v222 offset:40960
    v_mfma_f32_16x16x32_bf16 v[4:7], v[132:135], a[84:87], v[4:7]
    ds_read_b64_tr_b16 v[150:151], v222 offset:43008
    v_mfma_f32_16x16x32_bf16 v[96:99], v[128:131], a[72:75], v[96:99]
    ds_read_b64_tr_b16 v[152:153], v223 offset:32768
    v_mfma_f32_16x16x32_bf16 v[96:99], v[132:135], a[88:91], v[96:99]
    ds_read_b64_tr_b16 v[154:155], v223 offset:34816
    v_mfma_f32_16x16x32_bf16 v[100:103], v[128:131], a[76:79], v[100:103]
    ds_read_b64_tr_b16 v[156:157], v223 offset:40960
    v_mfma_f32_16x16x32_bf16 v[100:103], v[132:135], a[92:95], v[100:103]
    ds_read_b64_tr_b16 v[158:159], v223 offset:43008
    v_mfma_f32_16x16x32_bf16 v[8:11], v[136:139], a[64:67], v[8:11]
    v_mfma_f32_16x16x32_bf16 v[8:11], v[140:143], a[80:83], v[8:11]
    s_add_u32 m0, s38, 73728
    s_add_u32 s32, s37, 1638400
    v_mfma_f32_16x16x32_bf16 v[12:15], v[136:139], a[68:71], v[12:15]
    buffer_load_dwordx4 v224, s[12:15], s32 offen lds
    v_mfma_f32_16x16x32_bf16 v[12:15], v[140:143], a[84:87], v[12:15]
    v_mfma_f32_16x16x32_bf16 v[104:107], v[136:139], a[72:75], v[104:107]
    v_mfma_f32_16x16x32_bf16 v[104:107], v[140:143], a[88:91], v[104:107]
    buffer_load_dwordx4 v225, s[12:15], s32 offen offset:1024 lds
    v_mfma_f32_16x16x32_bf16 v[108:111], v[136:139], a[76:79], v[108:111]
    buffer_load_dwordx4 a[136:139], v228, s[8:11], s33 offen offset:2048 sc1
    v_mfma_f32_16x16x32_bf16 v[108:111], v[140:143], a[92:95], v[108:111]
    s_waitcnt lgkmcnt(0)
    v_mfma_f32_16x16x32_bf16 v[16:19], v[144:147], a[64:67], v[16:19]
    ds_read_b64_tr_b16 v[128:129], v216 offset:49152
    v_mfma_f32_16x16x32_bf16 v[16:19], v[148:151], a[80:83], v[16:19]
    ds_read_b64_tr_b16 v[130:131], v216 offset:51200
    v_mfma_f32_16x16x32_bf16 v[20:23], v[144:147], a[68:71], v[20:23]
    ds_read_b64_tr_b16 v[132:133], v216 offset:57344
    v_mfma_f32_16x16x32_bf16 v[20:23], v[148:151], a[84:87], v[20:23]
    ds_read_b64_tr_b16 v[134:135], v216 offset:59392
    v_mfma_f32_16x16x32_bf16 v[112:115], v[144:147], a[72:75], v[112:115]
    ds_read_b64_tr_b16 v[136:137], v217 offset:49152
    v_mfma_f32_16x16x32_bf16 v[112:115], v[148:151], a[88:91], v[112:115]
    ds_read_b64_tr_b16 v[138:139], v217 offset:51200
    v_mfma_f32_16x16x32_bf16 v[116:119], v[144:147], a[76:79], v[116:119]
    ds_read_b64_tr_b16 v[140:141], v217 offset:57344
    v_mfma_f32_16x16x32_bf16 v[116:119], v[148:151], a[92:95], v[116:119]
    ds_read_b64_tr_b16 v[142:143], v217 offset:59392
    v_mfma_f32_16x16x32_bf16 v[24:27], v[152:155], a[64:67], v[24:27]
    v_mfma_f32_16x16x32_bf16 v[24:27], v[156:159], a[80:83], v[24:27]
    v_mfma_f32_16x16x32_bf16 v[28:31], v[152:155], a[68:71], v[28:31]
    v_mfma_f32_16x16x32_bf16 v[28:31], v[156:159], a[84:87], v[28:31]
    v_mfma_f32_16x16x32_bf16 v[120:123], v[152:155], a[72:75], v[120:123]
    v_mfma_f32_16x16x32_bf16 v[120:123], v[156:159], a[88:91], v[120:123]
    v_mfma_f32_16x16x32_bf16 v[124:127], v[152:155], a[76:79], v[124:127]
    buffer_load_dwordx4 a[140:143], v228, s[8:11], s33 offen offset:3072 sc1
    v_mfma_f32_16x16x32_bf16 v[124:127], v[156:159], a[92:95], v[124:127]
    s_add_u32 s35, s35, 4096
    buffer_load_dwordx4 a[224:227], v226, s[8:11], s35 offen offset:0 sc1
    s_waitcnt vmcnt(29) lgkmcnt(0)
    v_mfma_f32_16x16x32_bf16 v[32:35], v[128:131], a[96:99], v[32:35]
    ds_read_b64_tr_b16 v[144:145], v218 offset:49152
    v_mfma_f32_16x16x32_bf16 v[32:35], v[132:135], a[112:115], v[32:35]
    ds_read_b64_tr_b16 v[146:147], v218 offset:51200
    v_mfma_f32_16x16x32_bf16 v[36:39], v[128:131], a[100:103], v[36:39]
    ds_read_b64_tr_b16 v[148:149], v218 offset:57344
    v_mfma_f32_16x16x32_bf16 v[36:39], v[132:135], a[116:119], v[36:39]
    ds_read_b64_tr_b16 v[150:151], v218 offset:59392
    v_mfma_f32_16x16x32_bf16 v[64:67], v[128:131], a[104:107], v[64:67]
    ds_read_b64_tr_b16 v[152:153], v219 offset:49152
    v_mfma_f32_16x16x32_bf16 v[64:67], v[132:135], a[120:123], v[64:67]
    ds_read_b64_tr_b16 v[154:155], v219 offset:51200
    v_mfma_f32_16x16x32_bf16 v[68:71], v[128:131], a[108:111], v[68:71]
    ds_read_b64_tr_b16 v[156:157], v219 offset:57344
    v_mfma_f32_16x16x32_bf16 v[68:71], v[132:135], a[124:127], v[68:71]
    ds_read_b64_tr_b16 v[158:159], v219 offset:59392
    v_mfma_f32_16x16x32_bf16 v[40:43], v[136:139], a[96:99], v[40:43]
    buffer_load_dwordx4 a[228:231], v227, s[8:11], s35 offen offset:0 sc1
    v_mfma_f32_16x16x32_bf16 v[40:43], v[140:143], a[112:115], v[40:43]
    s_add_u32 m0, s38, 81920
    s_add_u32 s32, s37, 1703936
    v_mfma_f32_16x16x32_bf16 v[44:47], v[136:139], a[100:103], v[44:47]
    buffer_load_dwordx4 v224, s[12:15], s32 offen lds
    v_mfma_f32_16x16x32_bf16 v[44:47], v[140:143], a[116:119], v[44:47]
    buffer_load_dwordx4 a[72:75], v245, s[8:11], s35 offen offset:0 sc1
    v_mfma_f32_16x16x32_bf16 v[72:75], v[136:139], a[104:107], v[72:75]
    v_mfma_f32_16x16x32_bf16 v[72:75], v[140:143], a[120:123], v[72:75]
    buffer_load_dwordx4 v225, s[12:15], s32 offen offset:1024 lds
    v_mfma_f32_16x16x32_bf16 v[76:79], v[136:139], a[108:111], v[76:79]
    s_add_u32 s33, s55, 4096
    buffer_load_dwordx4 a[144:147], v228, s[8:11], s33 offen offset:0 sc1
    v_mfma_f32_16x16x32_bf16 v[76:79], v[140:143], a[124:127], v[76:79]
    buffer_load_dwordx4 a[76:79], v246, s[8:11], s35 offen offset:0 sc1
    s_waitcnt lgkmcnt(0)
    v_mfma_f32_16x16x32_bf16 v[48:51], v[144:147], a[96:99], v[48:51]
    ds_read_b64_tr_b16 v[128:129], v220 offset:49152
    v_mfma_f32_16x16x32_bf16 v[48:51], v[148:151], a[112:115], v[48:51]
    ds_read_b64_tr_b16 v[130:131], v220 offset:51200
    v_mfma_f32_16x16x32_bf16 v[52:55], v[144:147], a[100:103], v[52:55]
    ds_read_b64_tr_b16 v[132:133], v220 offset:57344
    v_mfma_f32_16x16x32_bf16 v[52:55], v[148:151], a[116:119], v[52:55]
    ds_read_b64_tr_b16 v[134:135], v220 offset:59392
    v_mfma_f32_16x16x32_bf16 v[80:83], v[144:147], a[104:107], v[80:83]
    ds_read_b64_tr_b16 v[136:137], v221 offset:49152
    v_mfma_f32_16x16x32_bf16 v[80:83], v[148:151], a[120:123], v[80:83]
    ds_read_b64_tr_b16 v[138:139], v221 offset:51200
    v_mfma_f32_16x16x32_bf16 v[84:87], v[144:147], a[108:111], v[84:87]
    ds_read_b64_tr_b16 v[140:141], v221 offset:57344
    v_mfma_f32_16x16x32_bf16 v[84:87], v[148:151], a[124:127], v[84:87]
    ds_read_b64_tr_b16 v[142:143], v221 offset:59392
    v_mfma_f32_16x16x32_bf16 v[56:59], v[152:155], a[96:99], v[56:59]
    buffer_load_dwordx4 a[232:235], v226, s[8:11], s35 offen offset:1024 sc1
    v_mfma_f32_16x16x32_bf16 v[56:59], v[156:159], a[112:115], v[56:59]
    v_mfma_f32_16x16x32_bf16 v[60:63], v[152:155], a[100:103], v[60:63]
    buffer_load_dwordx4 a[236:239], v227, s[8:11], s35 offen offset:1024 sc1
    v_mfma_f32_16x16x32_bf16 v[60:63], v[156:159], a[116:119], v[60:63]
    v_mfma_f32_16x16x32_bf16 v[88:91], v[152:155], a[104:107], v[88:91]
    buffer_load_dwordx4 a[88:91], v245, s[8:11], s35 offen offset:1024 sc1
    v_mfma_f32_16x16x32_bf16 v[88:91], v[156:159], a[120:123], v[88:91]
    v_mfma_f32_16x16x32_bf16 v[92:95], v[152:155], a[108:111], v[92:95]
    buffer_load_dwordx4 a[148:151], v228, s[8:11], s33 offen offset:1024 sc1
    v_mfma_f32_16x16x32_bf16 v[92:95], v[156:159], a[124:127], v[92:95]
    buffer_load_dwordx4 a[92:95], v246, s[8:11], s35 offen offset:1024 sc1
    s_waitcnt lgkmcnt(0)
    v_mfma_f32_16x16x32_bf16 v[0:3], v[128:131], a[96:99], v[0:3]
    ds_read_b64_tr_b16 v[144:145], v222 offset:49152
    v_mfma_f32_16x16x32_bf16 v[0:3], v[132:135], a[112:115], v[0:3]
    ds_read_b64_tr_b16 v[146:147], v222 offset:51200
    v_mfma_f32_16x16x32_bf16 v[4:7], v[128:131], a[100:103], v[4:7]
    ds_read_b64_tr_b16 v[148:149], v222 offset:57344
    v_mfma_f32_16x16x32_bf16 v[4:7], v[132:135], a[116:119], v[4:7]
    ds_read_b64_tr_b16 v[150:151], v222 offset:59392
    v_mfma_f32_16x16x32_bf16 v[96:99], v[128:131], a[104:107], v[96:99]
    ds_read_b64_tr_b16 v[152:153], v223 offset:49152
    v_mfma_f32_16x16x32_bf16 v[96:99], v[132:135], a[120:123], v[96:99]
    ds_read_b64_tr_b16 v[154:155], v223 offset:51200
    v_mfma_f32_16x16x32_bf16 v[100:103], v[128:131], a[108:111], v[100:103]
    ds_read_b64_tr_b16 v[156:157], v223 offset:57344
    v_mfma_f32_16x16x32_bf16 v[100:103], v[132:135], a[124:127], v[100:103]
    ds_read_b64_tr_b16 v[158:159], v223 offset:59392
    v_mfma_f32_16x16x32_bf16 v[8:11], v[136:139], a[96:99], v[8:11]
    v_mfma_f32_16x16x32_bf16 v[8:11], v[140:143], a[112:115], v[8:11]
    s_add_u32 m0, s38, 90112
    s_add_u32 s32, s37, 1769472
    v_mfma_f32_16x16x32_bf16 v[12:15], v[136:139], a[100:103], v[12:15]
    buffer_load_dwordx4 v224, s[12:15], s32 offen lds
    v_mfma_f32_16x16x32_bf16 v[12:15], v[140:143], a[116:119], v[12:15]
    v_mfma_f32_16x16x32_bf16 v[104:107], v[136:139], a[104:107], v[104:107]
    v_mfma_f32_16x16x32_bf16 v[104:107], v[140:143], a[120:123], v[104:107]
    buffer_load_dwordx4 v225, s[12:15], s32 offen offset:1024 lds
    v_mfma_f32_16x16x32_bf16 v[108:111], v[136:139], a[108:111], v[108:111]
    buffer_load_dwordx4 a[152:155], v228, s[8:11], s33 offen offset:2048 sc1
    v_mfma_f32_16x16x32_bf16 v[108:111], v[140:143], a[124:127], v[108:111]
    s_waitcnt vmcnt(60) lgkmcnt(0)
    s_barrier
    v_mfma_f32_16x16x32_bf16 v[16:19], v[144:147], a[96:99], v[16:19]
    v_xor_b32 v216, 0x10000, v216
    ds_read_b64_tr_b16 v[128:129], v216 offset:0
    v_mfma_f32_16x16x32_bf16 v[16:19], v[148:151], a[112:115], v[16:19]
    ds_read_b64_tr_b16 v[130:131], v216 offset:2048
    v_mfma_f32_16x16x32_bf16 v[20:23], v[144:147], a[100:103], v[20:23]
    ds_read_b64_tr_b16 v[132:133], v216 offset:8192
    v_mfma_f32_16x16x32_bf16 v[20:23], v[148:151], a[116:119], v[20:23]
    ds_read_b64_tr_b16 v[134:135], v216 offset:10240
    v_mfma_f32_16x16x32_bf16 v[112:115], v[144:147], a[104:107], v[112:115]
    v_xor_b32 v217, 0x10000, v217
    ds_read_b64_tr_b16 v[136:137], v217 offset:0
    v_mfma_f32_16x16x32_bf16 v[112:115], v[148:151], a[120:123], v[112:115]
    ds_read_b64_tr_b16 v[138:139], v217 offset:2048
    v_mfma_f32_16x16x32_bf16 v[116:119], v[144:147], a[108:111], v[116:119]
    ds_read_b64_tr_b16 v[140:141], v217 offset:8192
    v_mfma_f32_16x16x32_bf16 v[116:119], v[148:151], a[124:127], v[116:119]
    ds_read_b64_tr_b16 v[142:143], v217 offset:10240
    v_mfma_f32_16x16x32_bf16 v[24:27], v[152:155], a[96:99], v[24:27]
    v_mfma_f32_16x16x32_bf16 v[24:27], v[156:159], a[112:115], v[24:27]
    v_mfma_f32_16x16x32_bf16 v[28:31], v[152:155], a[100:103], v[28:31]
    v_mfma_f32_16x16x32_bf16 v[28:31], v[156:159], a[116:119], v[28:31]
    v_mfma_f32_16x16x32_bf16 v[120:123], v[152:155], a[104:107], v[120:123]
    v_mfma_f32_16x16x32_bf16 v[120:123], v[156:159], a[120:123], v[120:123]
    v_mfma_f32_16x16x32_bf16 v[124:127], v[152:155], a[108:111], v[124:127]
    buffer_load_dwordx4 a[156:159], v228, s[8:11], s33 offen offset:3072 sc1
    v_mfma_f32_16x16x32_bf16 v[124:127], v[156:159], a[124:127], v[124:127]
    buffer_load_dwordx4 a[240:243], v226, s[8:11], s35 offen offset:2048 sc1
    s_waitcnt vmcnt(34) lgkmcnt(0)
    v_mfma_f32_16x16x32_bf16 v[32:35], v[128:131], a[0:3], v[32:35]
    v_xor_b32 v218, 0x10000, v218
    ds_read_b64_tr_b16 v[144:145], v218 offset:0
    v_mfma_f32_16x16x32_bf16 v[32:35], v[132:135], a[16:19], v[32:35]
    ds_read_b64_tr_b16 v[146:147], v218 offset:2048
    v_mfma_f32_16x16x32_bf16 v[36:39], v[128:131], a[4:7], v[36:39]
    ds_read_b64_tr_b16 v[148:149], v218 offset:8192
    v_mfma_f32_16x16x32_bf16 v[36:39], v[132:135], a[20:23], v[36:39]
    ds_read_b64_tr_b16 v[150:151], v218 offset:10240
    v_mfma_f32_16x16x32_bf16 v[64:67], v[128:131], a[8:11], v[64:67]
    v_xor_b32 v219, 0x10000, v219
    ds_read_b64_tr_b16 v[152:153], v219 offset:0
    v_mfma_f32_16x16x32_bf16 v[64:67], v[132:135], a[24:27], v[64:67]
    ds_read_b64_tr_b16 v[154:155], v219 offset:2048
    v_mfma_f32_16x16x32_bf16 v[68:71], v[128:131], a[12:15], v[68:71]
    ds_read_b64_tr_b16 v[156:157], v219 offset:8192
    v_mfma_f32_16x16x32_bf16 v[68:71], v[132:135], a[28:31], v[68:71]
    ds_read_b64_tr_b16 v[158:159], v219 offset:10240
    v_mfma_f32_16x16x32_bf16 v[40:43], v[136:139], a[0:3], v[40:43]
    buffer_load_dwordx4 a[244:247], v227, s[8:11], s35 offen offset:2048 sc1
    v_mfma_f32_16x16x32_bf16 v[40:43], v[140:143], a[16:19], v[40:43]
    s_add_u32 m0, s38, 98304
    s_add_u32 s32, s37, 1835008
    v_mfma_f32_16x16x32_bf16 v[44:47], v[136:139], a[4:7], v[44:47]
    buffer_load_dwordx4 v224, s[12:15], s32 offen lds
    v_mfma_f32_16x16x32_bf16 v[44:47], v[140:143], a[20:23], v[44:47]
    buffer_load_dwordx4 a[104:107], v245, s[8:11], s35 offen offset:2048 sc1
    v_mfma_f32_16x16x32_bf16 v[72:75], v[136:139], a[8:11], v[72:75]
    v_mfma_f32_16x16x32_bf16 v[72:75], v[140:143], a[24:27], v[72:75]
    buffer_load_dwordx4 v225, s[12:15], s32 offen offset:1024 lds
    v_mfma_f32_16x16x32_bf16 v[76:79], v[136:139], a[12:15], v[76:79]
    s_add_u32 s33, s55, 32768
    buffer_load_dwordx4 a[160:163], v228, s[8:11], s33 offen offset:0 sc1
    v_mfma_f32_16x16x32_bf16 v[76:79], v[140:143], a[28:31], v[76:79]
    buffer_load_dwordx4 a[108:111], v246, s[8:11], s35 offen offset:2048 sc1
    s_waitcnt lgkmcnt(0)
    v_mfma_f32_16x16x32_bf16 v[48:51], v[144:147], a[0:3], v[48:51]
    v_xor_b32 v220, 0x10000, v220
    ds_read_b64_tr_b16 v[128:129], v220 offset:0
    v_mfma_f32_16x16x32_bf16 v[48:51], v[148:151], a[16:19], v[48:51]
    ds_read_b64_tr_b16 v[130:131], v220 offset:2048
    v_mfma_f32_16x16x32_bf16 v[52:55], v[144:147], a[4:7], v[52:55]
    ds_read_b64_tr_b16 v[132:133], v220 offset:8192
    v_mfma_f32_16x16x32_bf16 v[52:55], v[148:151], a[20:23], v[52:55]
    ds_read_b64_tr_b16 v[134:135], v220 offset:10240
    v_mfma_f32_16x16x32_bf16 v[80:83], v[144:147], a[8:11], v[80:83]
    v_xor_b32 v221, 0x10000, v221
    ds_read_b64_tr_b16 v[136:137], v221 offset:0
    v_mfma_f32_16x16x32_bf16 v[80:83], v[148:151], a[24:27], v[80:83]
    ds_read_b64_tr_b16 v[138:139], v221 offset:2048
    v_mfma_f32_16x16x32_bf16 v[84:87], v[144:147], a[12:15], v[84:87]
    ds_read_b64_tr_b16 v[140:141], v221 offset:8192
    v_mfma_f32_16x16x32_bf16 v[84:87], v[148:151], a[28:31], v[84:87]
    ds_read_b64_tr_b16 v[142:143], v221 offset:10240
    v_mfma_f32_16x16x32_bf16 v[56:59], v[152:155], a[0:3], v[56:59]
    buffer_load_dwordx4 a[248:251], v226, s[8:11], s35 offen offset:3072 sc1
    v_mfma_f32_16x16x32_bf16 v[56:59], v[156:159], a[16:19], v[56:59]
    v_mfma_f32_16x16x32_bf16 v[60:63], v[152:155], a[4:7], v[60:63]
    buffer_load_dwordx4 a[252:255], v227, s[8:11], s35 offen offset:3072 sc1
    v_mfma_f32_16x16x32_bf16 v[60:63], v[156:159], a[20:23], v[60:63]
    v_mfma_f32_16x16x32_bf16 v[88:91], v[152:155], a[8:11], v[88:91]
    buffer_load_dwordx4 a[120:123], v245, s[8:11], s35 offen offset:3072 sc1
    v_mfma_f32_16x16x32_bf16 v[88:91], v[156:159], a[24:27], v[88:91]
    v_mfma_f32_16x16x32_bf16 v[92:95], v[152:155], a[12:15], v[92:95]
    buffer_load_dwordx4 a[164:167], v228, s[8:11], s33 offen offset:1024 sc1
    v_mfma_f32_16x16x32_bf16 v[92:95], v[156:159], a[28:31], v[92:95]
    buffer_load_dwordx4 a[124:127], v246, s[8:11], s35 offen offset:3072 sc1
    s_waitcnt lgkmcnt(0)
    v_mfma_f32_16x16x32_bf16 v[0:3], v[128:131], a[0:3], v[0:3]
    v_xor_b32 v222, 0x10000, v222
    ds_read_b64_tr_b16 v[144:145], v222 offset:0
    v_mfma_f32_16x16x32_bf16 v[0:3], v[132:135], a[16:19], v[0:3]
    ds_read_b64_tr_b16 v[146:147], v222 offset:2048
    v_mfma_f32_16x16x32_bf16 v[4:7], v[128:131], a[4:7], v[4:7]
    ds_read_b64_tr_b16 v[148:149], v222 offset:8192
    v_mfma_f32_16x16x32_bf16 v[4:7], v[132:135], a[20:23], v[4:7]
    ds_read_b64_tr_b16 v[150:151], v222 offset:10240
    v_mfma_f32_16x16x32_bf16 v[96:99], v[128:131], a[8:11], v[96:99]
    v_xor_b32 v223, 0x10000, v223
    ds_read_b64_tr_b16 v[152:153], v223 offset:0
    v_mfma_f32_16x16x32_bf16 v[96:99], v[132:135], a[24:27], v[96:99]
    ds_read_b64_tr_b16 v[154:155], v223 offset:2048
    v_mfma_f32_16x16x32_bf16 v[100:103], v[128:131], a[12:15], v[100:103]
    ds_read_b64_tr_b16 v[156:157], v223 offset:8192
    v_mfma_f32_16x16x32_bf16 v[100:103], v[132:135], a[28:31], v[100:103]
    ds_read_b64_tr_b16 v[158:159], v223 offset:10240
    v_mfma_f32_16x16x32_bf16 v[8:11], v[136:139], a[0:3], v[8:11]
    v_mfma_f32_16x16x32_bf16 v[8:11], v[140:143], a[16:19], v[8:11]
    s_add_u32 m0, s38, 106496
    s_add_u32 s32, s37, 1900544
    v_mfma_f32_16x16x32_bf16 v[12:15], v[136:139], a[4:7], v[12:15]
    buffer_load_dwordx4 v224, s[12:15], s32 offen lds
    v_mfma_f32_16x16x32_bf16 v[12:15], v[140:143], a[20:23], v[12:15]
    v_mfma_f32_16x16x32_bf16 v[104:107], v[136:139], a[8:11], v[104:107]
    v_mfma_f32_16x16x32_bf16 v[104:107], v[140:143], a[24:27], v[104:107]
    buffer_load_dwordx4 v225, s[12:15], s32 offen offset:1024 lds
    v_mfma_f32_16x16x32_bf16 v[108:111], v[136:139], a[12:15], v[108:111]
    buffer_load_dwordx4 a[168:171], v228, s[8:11], s33 offen offset:2048 sc1
    v_mfma_f32_16x16x32_bf16 v[108:111], v[140:143], a[28:31], v[108:111]
    s_waitcnt lgkmcnt(0)
    v_mfma_f32_16x16x32_bf16 v[16:19], v[144:147], a[0:3], v[16:19]
    ds_read_b64_tr_b16 v[128:129], v216 offset:16384
    v_mfma_f32_16x16x32_bf16 v[16:19], v[148:151], a[16:19], v[16:19]
    ds_read_b64_tr_b16 v[130:131], v216 offset:18432
    v_mfma_f32_16x16x32_bf16 v[20:23], v[144:147], a[4:7], v[20:23]
    ds_read_b64_tr_b16 v[132:133], v216 offset:24576
    v_mfma_f32_16x16x32_bf16 v[20:23], v[148:151], a[20:23], v[20:23]
    ds_read_b64_tr_b16 v[134:135], v216 offset:26624
    v_mfma_f32_16x16x32_bf16 v[112:115], v[144:147], a[8:11], v[112:115]
    ds_read_b64_tr_b16 v[136:137], v217 offset:16384
    v_mfma_f32_16x16x32_bf16 v[112:115], v[148:151], a[24:27], v[112:115]
    ds_read_b64_tr_b16 v[138:139], v217 offset:18432
    v_mfma_f32_16x16x32_bf16 v[116:119], v[144:147], a[12:15], v[116:119]
    ds_read_b64_tr_b16 v[140:141], v217 offset:24576
    v_mfma_f32_16x16x32_bf16 v[116:119], v[148:151], a[28:31], v[116:119]
    ds_read_b64_tr_b16 v[142:143], v217 offset:26624
    v_mfma_f32_16x16x32_bf16 v[24:27], v[152:155], a[0:3], v[24:27]
    v_mfma_f32_16x16x32_bf16 v[24:27], v[156:159], a[16:19], v[24:27]
    v_mfma_f32_16x16x32_bf16 v[28:31], v[152:155], a[4:7], v[28:31]
    v_mfma_f32_16x16x32_bf16 v[28:31], v[156:159], a[20:23], v[28:31]
    v_mfma_f32_16x16x32_bf16 v[120:123], v[152:155], a[8:11], v[120:123]
    v_mfma_f32_16x16x32_bf16 v[120:123], v[156:159], a[24:27], v[120:123]
    v_mfma_f32_16x16x32_bf16 v[124:127], v[152:155], a[12:15], v[124:127]
    buffer_load_dwordx4 a[172:175], v228, s[8:11], s33 offen offset:3072 sc1
    v_mfma_f32_16x16x32_bf16 v[124:127], v[156:159], a[28:31], v[124:127]
    s_add_u32 s35, s35, 4096
    buffer_load_dwordx4 a[0:3], v226, s[8:11], s35 offen offset:0 sc1
    s_waitcnt vmcnt(37) lgkmcnt(0)
    v_mfma_f32_16x16x32_bf16 v[32:35], v[128:131], a[32:35], v[32:35]
    ds_read_b64_tr_b16 v[144:145], v218 offset:16384
    v_mfma_f32_16x16x32_bf16 v[32:35], v[132:135], a[48:51], v[32:35]
    ds_read_b64_tr_b16 v[146:147], v218 offset:18432
    v_mfma_f32_16x16x32_bf16 v[36:39], v[128:131], a[36:39], v[36:39]
    ds_read_b64_tr_b16 v[148:149], v218 offset:24576
    v_mfma_f32_16x16x32_bf16 v[36:39], v[132:135], a[52:55], v[36:39]
    ds_read_b64_tr_b16 v[150:151], v218 offset:26624
    v_mfma_f32_16x16x32_bf16 v[64:67], v[128:131], a[40:43], v[64:67]
    ds_read_b64_tr_b16 v[152:153], v219 offset:16384
    v_mfma_f32_16x16x32_bf16 v[64:67], v[132:135], a[56:59], v[64:67]
    ds_read_b64_tr_b16 v[154:155], v219 offset:18432
    v_mfma_f32_16x16x32_bf16 v[68:71], v[128:131], a[44:47], v[68:71]
    ds_read_b64_tr_b16 v[156:157], v219 offset:24576
    v_mfma_f32_16x16x32_bf16 v[68:71], v[132:135], a[60:63], v[68:71]
    ds_read_b64_tr_b16 v[158:159], v219 offset:26624
    v_mfma_f32_16x16x32_bf16 v[40:43], v[136:139], a[32:35], v[40:43]
    buffer_load_dwordx4 a[4:7], v227, s[8:11], s35 offen offset:0 sc1
    v_mfma_f32_16x16x32_bf16 v[40:43], v[140:143], a[48:51], v[40:43]
    s_add_u32 m0, s38, 114688
    s_add_u32 s32, s37, 1966080
    v_mfma_f32_16x16x32_bf16 v[44:47], v[136:139], a[36:39], v[44:47]
    buffer_load_dwordx4 v224, s[12:15], s32 offen lds
    v_mfma_f32_16x16x32_bf16 v[44:47], v[140:143], a[52:55], v[44:47]
    buffer_load_dwordx4 a[8:11], v245, s[8:11], s35 offen offset:0 sc1
    v_mfma_f32_16x16x32_bf16 v[72:75], v[136:139], a[40:43], v[72:75]
    v_mfma_f32_16x16x32_bf16 v[72:75], v[140:143], a[56:59], v[72:75]
    buffer_load_dwordx4 v225, s[12:15], s32 offen offset:1024 lds
    v_mfma_f32_16x16x32_bf16 v[76:79], v[136:139], a[44:47], v[76:79]
    s_add_u32 s33, s55, 36864
    buffer_load_dwordx4 a[176:179], v228, s[8:11], s33 offen offset:0 sc1
    v_mfma_f32_16x16x32_bf16 v[76:79], v[140:143], a[60:63], v[76:79]
    buffer_load_dwordx4 a[12:15], v246, s[8:11], s35 offen offset:0 sc1
    s_waitcnt lgkmcnt(0)
    v_mfma_f32_16x16x32_bf16 v[48:51], v[144:147], a[32:35], v[48:51]
    ds_read_b64_tr_b16 v[128:129], v220 offset:16384
    v_mfma_f32_16x16x32_bf16 v[48:51], v[148:151], a[48:51], v[48:51]
    ds_read_b64_tr_b16 v[130:131], v220 offset:18432
    v_mfma_f32_16x16x32_bf16 v[52:55], v[144:147], a[36:39], v[52:55]
    ds_read_b64_tr_b16 v[132:133], v220 offset:24576
    v_mfma_f32_16x16x32_bf16 v[52:55], v[148:151], a[52:55], v[52:55]
    ds_read_b64_tr_b16 v[134:135], v220 offset:26624
    v_mfma_f32_16x16x32_bf16 v[80:83], v[144:147], a[40:43], v[80:83]
    ds_read_b64_tr_b16 v[136:137], v221 offset:16384
    v_mfma_f32_16x16x32_bf16 v[80:83], v[148:151], a[56:59], v[80:83]
    ds_read_b64_tr_b16 v[138:139], v221 offset:18432
    v_mfma_f32_16x16x32_bf16 v[84:87], v[144:147], a[44:47], v[84:87]
    ds_read_b64_tr_b16 v[140:141], v221 offset:24576
    v_mfma_f32_16x16x32_bf16 v[84:87], v[148:151], a[60:63], v[84:87]
    ds_read_b64_tr_b16 v[142:143], v221 offset:26624
    v_mfma_f32_16x16x32_bf16 v[56:59], v[152:155], a[32:35], v[56:59]
    buffer_load_dwordx4 a[16:19], v226, s[8:11], s35 offen offset:1024 sc1
    v_mfma_f32_16x16x32_bf16 v[56:59], v[156:159], a[48:51], v[56:59]
    v_mfma_f32_16x16x32_bf16 v[60:63], v[152:155], a[36:39], v[60:63]
    buffer_load_dwordx4 a[20:23], v227, s[8:11], s35 offen offset:1024 sc1
    v_mfma_f32_16x16x32_bf16 v[60:63], v[156:159], a[52:55], v[60:63]
    v_mfma_f32_16x16x32_bf16 v[88:91], v[152:155], a[40:43], v[88:91]
    buffer_load_dwordx4 a[24:27], v245, s[8:11], s35 offen offset:1024 sc1
    v_mfma_f32_16x16x32_bf16 v[88:91], v[156:159], a[56:59], v[88:91]
    v_mfma_f32_16x16x32_bf16 v[92:95], v[152:155], a[44:47], v[92:95]
    buffer_load_dwordx4 a[180:183], v228, s[8:11], s33 offen offset:1024 sc1
    v_mfma_f32_16x16x32_bf16 v[92:95], v[156:159], a[60:63], v[92:95]
    buffer_load_dwordx4 a[28:31], v246, s[8:11], s35 offen offset:1024 sc1
    s_waitcnt lgkmcnt(0)
    v_mfma_f32_16x16x32_bf16 v[0:3], v[128:131], a[32:35], v[0:3]
    ds_read_b64_tr_b16 v[144:145], v222 offset:16384
    v_mfma_f32_16x16x32_bf16 v[0:3], v[132:135], a[48:51], v[0:3]
    ds_read_b64_tr_b16 v[146:147], v222 offset:18432
    v_mfma_f32_16x16x32_bf16 v[4:7], v[128:131], a[36:39], v[4:7]
    ds_read_b64_tr_b16 v[148:149], v222 offset:24576
    v_mfma_f32_16x16x32_bf16 v[4:7], v[132:135], a[52:55], v[4:7]
    ds_read_b64_tr_b16 v[150:151], v222 offset:26624
    v_mfma_f32_16x16x32_bf16 v[96:99], v[128:131], a[40:43], v[96:99]
    ds_read_b64_tr_b16 v[152:153], v223 offset:16384
    v_mfma_f32_16x16x32_bf16 v[96:99], v[132:135], a[56:59], v[96:99]
    ds_read_b64_tr_b16 v[154:155], v223 offset:18432
    v_mfma_f32_16x16x32_bf16 v[100:103], v[128:131], a[44:47], v[100:103]
    ds_read_b64_tr_b16 v[156:157], v223 offset:24576
    v_mfma_f32_16x16x32_bf16 v[100:103], v[132:135], a[60:63], v[100:103]
    ds_read_b64_tr_b16 v[158:159], v223 offset:26624
    v_mfma_f32_16x16x32_bf16 v[8:11], v[136:139], a[32:35], v[8:11]
    v_mfma_f32_16x16x32_bf16 v[8:11], v[140:143], a[48:51], v[8:11]
    s_add_u32 m0, s38, 122880
    s_add_u32 s32, s37, 2031616
    v_mfma_f32_16x16x32_bf16 v[12:15], v[136:139], a[36:39], v[12:15]
    buffer_load_dwordx4 v224, s[12:15], s32 offen lds
    v_mfma_f32_16x16x32_bf16 v[12:15], v[140:143], a[52:55], v[12:15]
    v_mfma_f32_16x16x32_bf16 v[104:107], v[136:139], a[40:43], v[104:107]
    v_mfma_f32_16x16x32_bf16 v[104:107], v[140:143], a[56:59], v[104:107]
    buffer_load_dwordx4 v225, s[12:15], s32 offen offset:1024 lds
    v_mfma_f32_16x16x32_bf16 v[108:111], v[136:139], a[44:47], v[108:111]
    buffer_load_dwordx4 a[184:187], v228, s[8:11], s33 offen offset:2048 sc1
    v_mfma_f32_16x16x32_bf16 v[108:111], v[140:143], a[60:63], v[108:111]
    s_waitcnt vmcnt(63) lgkmcnt(0)
    s_barrier
    v_mfma_f32_16x16x32_bf16 v[16:19], v[144:147], a[32:35], v[16:19]
    ds_read_b64_tr_b16 v[128:129], v216 offset:32768
    v_mfma_f32_16x16x32_bf16 v[16:19], v[148:151], a[48:51], v[16:19]
    ds_read_b64_tr_b16 v[130:131], v216 offset:34816
    v_mfma_f32_16x16x32_bf16 v[20:23], v[144:147], a[36:39], v[20:23]
    ds_read_b64_tr_b16 v[132:133], v216 offset:40960
    v_mfma_f32_16x16x32_bf16 v[20:23], v[148:151], a[52:55], v[20:23]
    ds_read_b64_tr_b16 v[134:135], v216 offset:43008
    v_mfma_f32_16x16x32_bf16 v[112:115], v[144:147], a[40:43], v[112:115]
    ds_read_b64_tr_b16 v[136:137], v217 offset:32768
    v_mfma_f32_16x16x32_bf16 v[112:115], v[148:151], a[56:59], v[112:115]
    ds_read_b64_tr_b16 v[138:139], v217 offset:34816
    v_mfma_f32_16x16x32_bf16 v[116:119], v[144:147], a[44:47], v[116:119]
    ds_read_b64_tr_b16 v[140:141], v217 offset:40960
    v_mfma_f32_16x16x32_bf16 v[116:119], v[148:151], a[60:63], v[116:119]
    ds_read_b64_tr_b16 v[142:143], v217 offset:43008
    v_mfma_f32_16x16x32_bf16 v[24:27], v[152:155], a[32:35], v[24:27]
    v_mfma_f32_16x16x32_bf16 v[24:27], v[156:159], a[48:51], v[24:27]
    v_mfma_f32_16x16x32_bf16 v[28:31], v[152:155], a[36:39], v[28:31]
    v_mfma_f32_16x16x32_bf16 v[28:31], v[156:159], a[52:55], v[28:31]
    v_mfma_f32_16x16x32_bf16 v[120:123], v[152:155], a[40:43], v[120:123]
    v_mfma_f32_16x16x32_bf16 v[120:123], v[156:159], a[56:59], v[120:123]
    v_mfma_f32_16x16x32_bf16 v[124:127], v[152:155], a[44:47], v[124:127]
    buffer_load_dwordx4 a[188:191], v228, s[8:11], s33 offen offset:3072 sc1
    v_mfma_f32_16x16x32_bf16 v[124:127], v[156:159], a[60:63], v[124:127]
    buffer_load_dwordx4 a[32:35], v226, s[8:11], s35 offen offset:2048 sc1
    s_waitcnt vmcnt(37) lgkmcnt(0)
    v_mfma_f32_16x16x32_bf16 v[64:67], v[128:131], a[72:75], v[64:67]
    ds_read_b64_tr_b16 v[144:145], v218 offset:32768
    v_mfma_f32_16x16x32_bf16 v[64:67], v[132:135], a[88:91], v[64:67]
    ds_read_b64_tr_b16 v[146:147], v218 offset:34816
    v_mfma_f32_16x16x32_bf16 v[68:71], v[128:131], a[76:79], v[68:71]
    ds_read_b64_tr_b16 v[148:149], v218 offset:40960
    buffer_load_dwordx4 a[36:39], v227, s[8:11], s35 offen offset:2048 sc1
    v_mfma_f32_16x16x32_bf16 v[68:71], v[132:135], a[92:95], v[68:71]
    ds_read_b64_tr_b16 v[150:151], v218 offset:43008
    v_mfma_f32_16x16x32_bf16 v[72:75], v[136:139], a[72:75], v[72:75]
    ds_read_b64_tr_b16 v[152:153], v219 offset:32768
    v_mfma_f32_16x16x32_bf16 v[72:75], v[140:143], a[88:91], v[72:75]
    ds_read_b64_tr_b16 v[154:155], v219 offset:34816
    v_mfma_f32_16x16x32_bf16 v[76:79], v[136:139], a[76:79], v[76:79]
    ds_read_b64_tr_b16 v[156:157], v219 offset:40960
    buffer_load_dwordx4 a[40:43], v245, s[8:11], s35 offen offset:2048 sc1
    v_mfma_f32_16x16x32_bf16 v[76:79], v[140:143], a[92:95], v[76:79]
    ds_read_b64_tr_b16 v[158:159], v219 offset:43008
    s_waitcnt lgkmcnt(4)
    v_mfma_f32_16x16x32_bf16 v[80:83], v[144:147], a[72:75], v[80:83]
    ds_read_b64_tr_b16 v[128:129], v220 offset:32768
    v_mfma_f32_16x16x32_bf16 v[80:83], v[148:151], a[88:91], v[80:83]
    ds_read_b64_tr_b16 v[130:131], v220 offset:34816
    v_mfma_f32_16x16x32_bf16 v[84:87], v[144:147], a[76:79], v[84:87]
    ds_read_b64_tr_b16 v[132:133], v220 offset:40960
    buffer_load_dwordx4 a[44:47], v246, s[8:11], s35 offen offset:2048 sc1
    v_mfma_f32_16x16x32_bf16 v[84:87], v[148:151], a[92:95], v[84:87]
    ds_read_b64_tr_b16 v[134:135], v220 offset:43008
    s_waitcnt lgkmcnt(4)
    v_mfma_f32_16x16x32_bf16 v[88:91], v[152:155], a[72:75], v[88:91]
    ds_read_b64_tr_b16 v[136:137], v221 offset:32768
    v_mfma_f32_16x16x32_bf16 v[88:91], v[156:159], a[88:91], v[88:91]
    ds_read_b64_tr_b16 v[138:139], v221 offset:34816
    s_mov_b32 s32, 0
    buffer_load_dwordx4 v[192:195], v229, s[16:19], s32 offen
    v_mfma_f32_16x16x32_bf16 v[92:95], v[152:155], a[76:79], v[92:95]
    ds_read_b64_tr_b16 v[140:141], v221 offset:40960
    buffer_load_dwordx4 a[48:51], v226, s[8:11], s35 offen offset:3072 sc1
    v_mfma_f32_16x16x32_bf16 v[92:95], v[156:159], a[92:95], v[92:95]
    ds_read_b64_tr_b16 v[142:143], v221 offset:43008
    s_waitcnt lgkmcnt(4)
    v_mfma_f32_16x16x32_bf16 v[0:3], v[128:131], a[224:227], v[0:3]
    ds_read_b64_tr_b16 v[144:145], v222 offset:32768
    v_mfma_f32_16x16x32_bf16 v[0:3], v[132:135], a[232:235], v[0:3]
    ds_read_b64_tr_b16 v[146:147], v222 offset:34816
    v_mfma_f32_16x16x32_bf16 v[4:7], v[128:131], a[228:231], v[4:7]
    ds_read_b64_tr_b16 v[148:149], v222 offset:40960
    v_mfma_f32_16x16x32_bf16 v[4:7], v[132:135], a[236:239], v[4:7]
    ds_read_b64_tr_b16 v[150:151], v222 offset:43008
    v_mfma_f32_16x16x32_bf16 v[96:99], v[128:131], a[72:75], v[96:99]
    ds_read_b64_tr_b16 v[152:153], v223 offset:32768
    v_mfma_f32_16x16x32_bf16 v[96:99], v[132:135], a[88:91], v[96:99]
    ds_read_b64_tr_b16 v[154:155], v223 offset:34816
    s_mov_b32 s32, 16384
    buffer_load_dwordx4 v[196:199], v229, s[16:19], s32 offen
    v_mfma_f32_16x16x32_bf16 v[100:103], v[128:131], a[76:79], v[100:103]
    ds_read_b64_tr_b16 v[156:157], v223 offset:40960
    v_mfma_f32_16x16x32_bf16 v[100:103], v[132:135], a[92:95], v[100:103]
    ds_read_b64_tr_b16 v[158:159], v223 offset:43008
    s_waitcnt lgkmcnt(8)
    v_mfma_f32_16x16x32_bf16 v[8:11], v[136:139], a[224:227], v[8:11]
    buffer_load_dwordx4 a[52:55], v227, s[8:11], s35 offen offset:3072 sc1
    v_mfma_f32_16x16x32_bf16 v[8:11], v[140:143], a[232:235], v[8:11]
    v_mfma_f32_16x16x32_bf16 v[12:15], v[136:139], a[228:231], v[12:15]
    v_mfma_f32_16x16x32_bf16 v[12:15], v[140:143], a[236:239], v[12:15]
    buffer_load_dwordx4 a[56:59], v245, s[8:11], s35 offen offset:3072 sc1
    v_mfma_f32_16x16x32_bf16 v[104:107], v[136:139], a[72:75], v[104:107]
    v_mfma_f32_16x16x32_bf16 v[104:107], v[140:143], a[88:91], v[104:107]
    s_mov_b32 s32, 32768
    buffer_load_dwordx4 v[200:203], v229, s[16:19], s32 offen
    v_mfma_f32_16x16x32_bf16 v[108:111], v[136:139], a[76:79], v[108:111]
    v_mfma_f32_16x16x32_bf16 v[108:111], v[140:143], a[92:95], v[108:111]
    buffer_load_dwordx4 a[60:63], v246, s[8:11], s35 offen offset:3072 sc1
    s_waitcnt lgkmcnt(0)
    v_mfma_f32_16x16x32_bf16 v[16:19], v[144:147], a[224:227], v[16:19]
    ds_read_b64_tr_b16 v[128:129], v216 offset:49152
    v_mfma_f32_16x16x32_bf16 v[16:19], v[148:151], a[232:235], v[16:19]
    ds_read_b64_tr_b16 v[130:131], v216 offset:51200
    v_mfma_f32_16x16x32_bf16 v[20:23], v[144:147], a[228:231], v[20:23]
    ds_read_b64_tr_b16 v[132:133], v216 offset:57344
    v_mfma_f32_16x16x32_bf16 v[20:23], v[148:151], a[236:239], v[20:23]
    ds_read_b64_tr_b16 v[134:135], v216 offset:59392
    v_mfma_f32_16x16x32_bf16 v[112:115], v[144:147], a[72:75], v[112:115]
    ds_read_b64_tr_b16 v[136:137], v217 offset:49152
    v_mfma_f32_16x16x32_bf16 v[112:115], v[148:151], a[88:91], v[112:115]
    ds_read_b64_tr_b16 v[138:139], v217 offset:51200
    v_mfma_f32_16x16x32_bf16 v[116:119], v[144:147], a[76:79], v[116:119]
    ds_read_b64_tr_b16 v[140:141], v217 offset:57344
    v_mfma_f32_16x16x32_bf16 v[116:119], v[148:151], a[92:95], v[116:119]
    ds_read_b64_tr_b16 v[142:143], v217 offset:59392
    v_mfma_f32_16x16x32_bf16 v[24:27], v[152:155], a[224:227], v[24:27]
    v_mfma_f32_16x16x32_bf16 v[24:27], v[156:159], a[232:235], v[24:27]
    v_mfma_f32_16x16x32_bf16 v[28:31], v[152:155], a[228:231], v[28:31]
    v_mfma_f32_16x16x32_bf16 v[28:31], v[156:159], a[236:239], v[28:31]
    v_mfma_f32_16x16x32_bf16 v[120:123], v[152:155], a[72:75], v[120:123]
    v_mfma_f32_16x16x32_bf16 v[120:123], v[156:159], a[88:91], v[120:123]
    s_mov_b32 s32, 49152
    buffer_load_dwordx4 v[204:207], v229, s[16:19], s32 offen
    v_mfma_f32_16x16x32_bf16 v[124:127], v[152:155], a[76:79], v[124:127]
    v_mfma_f32_16x16x32_bf16 v[124:127], v[156:159], a[92:95], v[124:127]
    s_add_u32 s35, s35, 4096
    buffer_load_dwordx4 a[64:67], v226, s[8:11], s35 offen offset:0 sc1
    s_waitcnt vmcnt(33) lgkmcnt(0)
    v_mfma_f32_16x16x32_bf16 v[64:67], v[128:131], a[104:107], v[64:67]
    ds_read_b64_tr_b16 v[144:145], v218 offset:49152
    v_mfma_f32_16x16x32_bf16 v[64:67], v[132:135], a[120:123], v[64:67]
    ds_read_b64_tr_b16 v[146:147], v218 offset:51200
    v_mfma_f32_16x16x32_bf16 v[68:71], v[128:131], a[108:111], v[68:71]
    ds_read_b64_tr_b16 v[148:149], v218 offset:57344
    buffer_load_dwordx4 a[68:71], v227, s[8:11], s35 offen offset:0 sc1
    v_mfma_f32_16x16x32_bf16 v[68:71], v[132:135], a[124:127], v[68:71]
    ds_read_b64_tr_b16 v[150:151], v218 offset:59392
    v_mfma_f32_16x16x32_bf16 v[72:75], v[136:139], a[104:107], v[72:75]
    ds_read_b64_tr_b16 v[152:153], v219 offset:49152
    v_mfma_f32_16x16x32_bf16 v[72:75], v[140:143], a[120:123], v[72:75]
    ds_read_b64_tr_b16 v[154:155], v219 offset:51200
    v_mfma_f32_16x16x32_bf16 v[76:79], v[136:139], a[108:111], v[76:79]
    ds_read_b64_tr_b16 v[156:157], v219 offset:57344
    buffer_load_dwordx4 a[72:75], v245, s[8:11], s35 offen offset:0 sc1
    v_mfma_f32_16x16x32_bf16 v[76:79], v[140:143], a[124:127], v[76:79]
    ds_read_b64_tr_b16 v[158:159], v219 offset:59392
    s_waitcnt lgkmcnt(4)
    v_mfma_f32_16x16x32_bf16 v[80:83], v[144:147], a[104:107], v[80:83]
    ds_read_b64_tr_b16 v[128:129], v220 offset:49152
    v_mfma_f32_16x16x32_bf16 v[80:83], v[148:151], a[120:123], v[80:83]
    ds_read_b64_tr_b16 v[130:131], v220 offset:51200
    v_mfma_f32_16x16x32_bf16 v[84:87], v[144:147], a[108:111], v[84:87]
    ds_read_b64_tr_b16 v[132:133], v220 offset:57344
    buffer_load_dwordx4 a[76:79], v246, s[8:11], s35 offen offset:0 sc1
    v_mfma_f32_16x16x32_bf16 v[84:87], v[148:151], a[124:127], v[84:87]
    ds_read_b64_tr_b16 v[134:135], v220 offset:59392
    s_waitcnt lgkmcnt(4)
    v_mfma_f32_16x16x32_bf16 v[88:91], v[152:155], a[104:107], v[88:91]
    ds_read_b64_tr_b16 v[136:137], v221 offset:49152
    v_mfma_f32_16x16x32_bf16 v[88:91], v[156:159], a[120:123], v[88:91]
    ds_read_b64_tr_b16 v[138:139], v221 offset:51200
    buffer_load_dwordx4 v[208:211], v240, s[20:23], 0 offen
    v_mfma_f32_16x16x32_bf16 v[92:95], v[152:155], a[108:111], v[92:95]
    ds_read_b64_tr_b16 v[140:141], v221 offset:57344
    buffer_load_dwordx4 a[80:83], v226, s[8:11], s35 offen offset:1024 sc1
    v_mfma_f32_16x16x32_bf16 v[92:95], v[156:159], a[124:127], v[92:95]
    ds_read_b64_tr_b16 v[142:143], v221 offset:59392
    s_waitcnt lgkmcnt(4)
    v_mfma_f32_16x16x32_bf16 v[0:3], v[128:131], a[240:243], v[0:3]
    ds_read_b64_tr_b16 v[144:145], v222 offset:49152
    v_mfma_f32_16x16x32_bf16 v[0:3], v[132:135], a[248:251], v[0:3]
    ds_read_b64_tr_b16 v[146:147], v222 offset:51200
    v_mfma_f32_16x16x32_bf16 v[4:7], v[128:131], a[244:247], v[4:7]
    ds_read_b64_tr_b16 v[148:149], v222 offset:57344
    v_mfma_f32_16x16x32_bf16 v[4:7], v[132:135], a[252:255], v[4:7]
    ds_read_b64_tr_b16 v[150:151], v222 offset:59392
    v_mfma_f32_16x16x32_bf16 v[96:99], v[128:131], a[104:107], v[96:99]
    ds_read_b64_tr_b16 v[152:153], v223 offset:49152
    v_mfma_f32_16x16x32_bf16 v[96:99], v[132:135], a[120:123], v[96:99]
    ds_read_b64_tr_b16 v[154:155], v223 offset:51200
    s_mov_b32 s32, kc_tail-kc_pc0
    v_lshlrev_b32 v234, 7, v230
    buffer_load_dword v241, v234, s[56:59], s32 offen
    v_mfma_f32_16x16x32_bf16 v[100:103], v[128:131], a[108:111], v[100:103]
    ds_read_b64_tr_b16 v[156:157], v223 offset:57344
    v_mfma_f32_16x16x32_bf16 v[100:103], v[132:135], a[124:127], v[100:103]
    ds_read_b64_tr_b16 v[158:159], v223 offset:59392
    s_waitcnt lgkmcnt(8)
    v_mfma_f32_16x16x32_bf16 v[8:11], v[136:139], a[240:243], v[8:11]
    buffer_load_dwordx4 a[84:87], v227, s[8:11], s35 offen offset:1024 sc1
    v_mfma_f32_16x16x32_bf16 v[8:11], v[140:143], a[248:251], v[8:11]
    v_mfma_f32_16x16x32_bf16 v[12:15], v[136:139], a[244:247], v[12:15]
    v_mfma_f32_16x16x32_bf16 v[12:15], v[140:143], a[252:255], v[12:15]
    buffer_load_dwordx4 a[88:91], v245, s[8:11], s35 offen offset:1024 sc1
    v_mfma_f32_16x16x32_bf16 v[104:107], v[136:139], a[104:107], v[104:107]
    v_mfma_f32_16x16x32_bf16 v[104:107], v[140:143], a[120:123], v[104:107]
    v_mfma_f32_16x16x32_bf16 v[108:111], v[136:139], a[108:111], v[108:111]
    v_mfma_f32_16x16x32_bf16 v[108:111], v[140:143], a[124:127], v[108:111]
    buffer_load_dwordx4 a[92:95], v246, s[8:11], s35 offen offset:1024 sc1
    s_waitcnt vmcnt(24) lgkmcnt(0)
    s_barrier
    v_mfma_f32_16x16x32_bf16 v[16:19], v[144:147], a[240:243], v[16:19]
    v_xor_b32 v220, 0x10000, v220
    ds_read_b64_tr_b16 v[128:129], v220 offset:0
    v_mfma_f32_16x16x32_bf16 v[16:19], v[148:151], a[248:251], v[16:19]
    ds_read_b64_tr_b16 v[130:131], v220 offset:2048
    v_mfma_f32_16x16x32_bf16 v[20:23], v[144:147], a[244:247], v[20:23]
    ds_read_b64_tr_b16 v[132:133], v220 offset:8192
    v_mfma_f32_16x16x32_bf16 v[20:23], v[148:151], a[252:255], v[20:23]
    ds_read_b64_tr_b16 v[134:135], v220 offset:10240
    v_mfma_f32_16x16x32_bf16 v[112:115], v[144:147], a[104:107], v[112:115]
    v_xor_b32 v221, 0x10000, v221
    ds_read_b64_tr_b16 v[136:137], v221 offset:0
    v_mfma_f32_16x16x32_bf16 v[112:115], v[148:151], a[120:123], v[112:115]
    ds_read_b64_tr_b16 v[138:139], v221 offset:2048
    v_mfma_f32_16x16x32_bf16 v[116:119], v[144:147], a[108:111], v[116:119]
    ds_read_b64_tr_b16 v[140:141], v221 offset:8192
    v_mfma_f32_16x16x32_bf16 v[116:119], v[148:151], a[124:127], v[116:119]
    ds_read_b64_tr_b16 v[142:143], v221 offset:10240
    v_mfma_f32_16x16x32_bf16 v[24:27], v[152:155], a[240:243], v[24:27]
    v_mfma_f32_16x16x32_bf16 v[24:27], v[156:159], a[248:251], v[24:27]
    v_mfma_f32_16x16x32_bf16 v[28:31], v[152:155], a[244:247], v[28:31]
    v_mfma_f32_16x16x32_bf16 v[28:31], v[156:159], a[252:255], v[28:31]
    v_mfma_f32_16x16x32_bf16 v[120:123], v[152:155], a[104:107], v[120:123]
    v_mfma_f32_16x16x32_bf16 v[120:123], v[156:159], a[120:123], v[120:123]
    v_mfma_f32_16x16x32_bf16 v[124:127], v[152:155], a[108:111], v[124:127]
    v_mfma_f32_16x16x32_bf16 v[124:127], v[156:159], a[124:127], v[124:127]
    buffer_load_dwordx4 a[96:99], v226, s[8:11], s35 offen offset:2048 sc1
    s_waitcnt vmcnt(27) lgkmcnt(4)
    v_mfma_f32_16x16x32_bf16 v[96:99], v[128:131], a[8:11], v[96:99]
    v_xor_b32 v222, 0x10000, v222
    ds_read_b64_tr_b16 v[144:145], v222 offset:0
    v_mfma_f32_16x16x32_bf16 v[96:99], v[132:135], a[24:27], v[96:99]
    ds_read_b64_tr_b16 v[146:147], v222 offset:2048
    v_mfma_f32_16x16x32_bf16 v[100:103], v[128:131], a[12:15], v[100:103]
    ds_read_b64_tr_b16 v[148:149], v222 offset:8192
    buffer_load_dwordx4 a[100:103], v227, s[8:11], s35 offen offset:2048 sc1
    v_mfma_f32_16x16x32_bf16 v[100:103], v[132:135], a[28:31], v[100:103]
    ds_read_b64_tr_b16 v[150:151], v222 offset:10240
    s_waitcnt lgkmcnt(4)
    v_mfma_f32_16x16x32_bf16 v[104:107], v[136:139], a[8:11], v[104:107]
    v_xor_b32 v223, 0x10000, v223
    ds_read_b64_tr_b16 v[152:153], v223 offset:0
    v_mfma_f32_16x16x32_bf16 v[104:107], v[140:143], a[24:27], v[104:107]
    ds_read_b64_tr_b16 v[154:155], v223 offset:2048
    v_mfma_f32_16x16x32_bf16 v[108:111], v[136:139], a[12:15], v[108:111]
    ds_read_b64_tr_b16 v[156:157], v223 offset:8192
    buffer_load_dwordx4 a[104:107], v245, s[8:11], s35 offen offset:2048 sc1
    v_mfma_f32_16x16x32_bf16 v[108:111], v[140:143], a[28:31], v[108:111]
    ds_read_b64_tr_b16 v[158:159], v223 offset:10240
    s_waitcnt lgkmcnt(4)
    v_mfma_f32_16x16x32_bf16 v[112:115], v[144:147], a[8:11], v[112:115]
    ds_read_b64_tr_b16 v[128:129], v220 offset:16384
    v_mfma_f32_16x16x32_bf16 v[112:115], v[148:151], a[24:27], v[112:115]
    ds_read_b64_tr_b16 v[130:131], v220 offset:18432
    v_mfma_f32_16x16x32_bf16 v[116:119], v[144:147], a[12:15], v[116:119]
    ds_read_b64_tr_b16 v[132:133], v220 offset:24576
    buffer_load_dwordx4 a[108:111], v246, s[8:11], s35 offen offset:2048 sc1
    v_mfma_f32_16x16x32_bf16 v[116:119], v[148:151], a[28:31], v[116:119]
    ds_read_b64_tr_b16 v[134:135], v220 offset:26624
    s_waitcnt lgkmcnt(4)
    v_mfma_f32_16x16x32_bf16 v[120:123], v[152:155], a[8:11], v[120:123]
    ds_read_b64_tr_b16 v[136:137], v221 offset:16384
    v_mfma_f32_16x16x32_bf16 v[120:123], v[156:159], a[24:27], v[120:123]
    ds_read_b64_tr_b16 v[138:139], v221 offset:18432
    v_mfma_f32_16x16x32_bf16 v[124:127], v[152:155], a[12:15], v[124:127]
    ds_read_b64_tr_b16 v[140:141], v221 offset:24576
    buffer_load_dwordx4 a[112:115], v226, s[8:11], s35 offen offset:3072 sc1
    v_mfma_f32_16x16x32_bf16 v[124:127], v[156:159], a[28:31], v[124:127]
    ds_read_b64_tr_b16 v[142:143], v221 offset:26624
    s_waitcnt vmcnt(16) lgkmcnt(4)
    v_mfma_f32_16x16x32_bf16 v[96:99], v[128:131], a[40:43], v[96:99]
    ds_read_b64_tr_b16 v[144:145], v222 offset:16384
    v_mfma_f32_16x16x32_bf16 v[96:99], v[132:135], a[56:59], v[96:99]
    ds_read_b64_tr_b16 v[146:147], v222 offset:18432
    v_mfma_f32_16x16x32_bf16 v[100:103], v[128:131], a[44:47], v[100:103]
    ds_read_b64_tr_b16 v[148:149], v222 offset:24576
    buffer_load_dwordx4 a[116:119], v227, s[8:11], s35 offen offset:3072 sc1
    v_mfma_f32_16x16x32_bf16 v[100:103], v[132:135], a[60:63], v[100:103]
    ds_read_b64_tr_b16 v[150:151], v222 offset:26624
    s_waitcnt lgkmcnt(4)
    v_mfma_f32_16x16x32_bf16 v[104:107], v[136:139], a[40:43], v[104:107]
    ds_read_b64_tr_b16 v[152:153], v223 offset:16384
    v_mfma_f32_16x16x32_bf16 v[104:107], v[140:143], a[56:59], v[104:107]
    ds_read_b64_tr_b16 v[154:155], v223 offset:18432
    v_mfma_f32_16x16x32_bf16 v[108:111], v[136:139], a[44:47], v[108:111]
    ds_read_b64_tr_b16 v[156:157], v223 offset:24576
    buffer_load_dwordx4 a[120:123], v245, s[8:11], s35 offen offset:3072 sc1
    v_mfma_f32_16x16x32_bf16 v[108:111], v[140:143], a[60:63], v[108:111]
    ds_read_b64_tr_b16 v[158:159], v223 offset:26624
    s_waitcnt lgkmcnt(4)
    v_mfma_f32_16x16x32_bf16 v[112:115], v[144:147], a[40:43], v[112:115]
    ds_read_b64_tr_b16 v[128:129], v220 offset:32768
    v_mfma_f32_16x16x32_bf16 v[112:115], v[148:151], a[56:59], v[112:115]
    ds_read_b64_tr_b16 v[130:131], v220 offset:34816
    v_mfma_f32_16x16x32_bf16 v[116:119], v[144:147], a[44:47], v[116:119]
    ds_read_b64_tr_b16 v[132:133], v220 offset:40960
    buffer_load_dwordx4 a[124:127], v246, s[8:11], s35 offen offset:3072 sc1
    v_mfma_f32_16x16x32_bf16 v[116:119], v[148:151], a[60:63], v[116:119]
    ds_read_b64_tr_b16 v[134:135], v220 offset:43008
    s_waitcnt lgkmcnt(4)
    v_mfma_f32_16x16x32_bf16 v[120:123], v[152:155], a[40:43], v[120:123]
    ds_read_b64_tr_b16 v[136:137], v221 offset:32768
    v_mfma_f32_16x16x32_bf16 v[120:123], v[156:159], a[56:59], v[120:123]
    ds_read_b64_tr_b16 v[138:139], v221 offset:34816
    v_mfma_f32_16x16x32_bf16 v[124:127], v[152:155], a[44:47], v[124:127]
    ds_read_b64_tr_b16 v[140:141], v221 offset:40960
    v_mfma_f32_16x16x32_bf16 v[124:127], v[156:159], a[60:63], v[124:127]
    ds_read_b64_tr_b16 v[142:143], v221 offset:43008
    s_waitcnt vmcnt(8) lgkmcnt(4)
    v_mfma_f32_16x16x32_bf16 v[96:99], v[128:131], a[72:75], v[96:99]
    ds_read_b64_tr_b16 v[144:145], v222 offset:32768
    v_mfma_f32_16x16x32_bf16 v[96:99], v[132:135], a[88:91], v[96:99]
    ds_read_b64_tr_b16 v[146:147], v222 offset:34816
    s_xor_b32 s7, s39, 24
    v_mfma_f32_16x16x32_bf16 v[100:103], v[128:131], a[76:79], v[100:103]
    ds_read_b64_tr_b16 v[148:149], v222 offset:40960
    v_mfma_f32_16x16x32_bf16 v[100:103], v[132:135], a[92:95], v[100:103]
    ds_read_b64_tr_b16 v[150:151], v222 offset:43008
    s_waitcnt lgkmcnt(4)
    v_mfma_f32_16x16x32_bf16 v[104:107], v[136:139], a[72:75], v[104:107]
    ds_read_b64_tr_b16 v[152:153], v223 offset:32768
    v_mfma_f32_16x16x32_bf16 v[104:107], v[140:143], a[88:91], v[104:107]
    ds_read_b64_tr_b16 v[154:155], v223 offset:34816
    s_mul_i32 s7, s7, 12288
    v_mfma_f32_16x16x32_bf16 v[108:111], v[136:139], a[76:79], v[108:111]
    ds_read_b64_tr_b16 v[156:157], v223 offset:40960
    s_add_u32 s7, s7, 0x5002000
    v_mfma_f32_16x16x32_bf16 v[108:111], v[140:143], a[92:95], v[108:111]
    ds_read_b64_tr_b16 v[158:159], v223 offset:43008
    s_waitcnt lgkmcnt(4)
    v_mfma_f32_16x16x32_bf16 v[112:115], v[144:147], a[72:75], v[112:115]
    ds_read_b64_tr_b16 v[128:129], v220 offset:49152
    v_mfma_f32_16x16x32_bf16 v[112:115], v[148:151], a[88:91], v[112:115]
    ds_read_b64_tr_b16 v[130:131], v220 offset:51200
    s_xor_b32 s37, s39, 8
    v_mfma_f32_16x16x32_bf16 v[116:119], v[144:147], a[76:79], v[116:119]
    ds_read_b64_tr_b16 v[132:133], v220 offset:57344
    v_mfma_f32_16x16x32_bf16 v[116:119], v[148:151], a[92:95], v[116:119]
    ds_read_b64_tr_b16 v[134:135], v220 offset:59392
    s_waitcnt lgkmcnt(4)
    v_mfma_f32_16x16x32_bf16 v[120:123], v[152:155], a[72:75], v[120:123]
    ds_read_b64_tr_b16 v[136:137], v221 offset:49152
    v_mfma_f32_16x16x32_bf16 v[120:123], v[156:159], a[88:91], v[120:123]
    ds_read_b64_tr_b16 v[138:139], v221 offset:51200
    s_mul_i32 s37, s37, 12288
    v_mfma_f32_16x16x32_bf16 v[124:127], v[152:155], a[76:79], v[124:127]
    ds_read_b64_tr_b16 v[140:141], v221 offset:57344
    s_add_u32 s37, s37, 0x5000000
    v_mfma_f32_16x16x32_bf16 v[124:127], v[156:159], a[92:95], v[124:127]
    ds_read_b64_tr_b16 v[142:143], v221 offset:59392
    s_waitcnt vmcnt(0) lgkmcnt(4)
    v_mfma_f32_16x16x32_bf16 v[96:99], v[128:131], a[104:107], v[96:99]
    ds_read_b64_tr_b16 v[144:145], v222 offset:49152
    v_mfma_f32_16x16x32_bf16 v[96:99], v[132:135], a[120:123], v[96:99]
    ds_read_b64_tr_b16 v[146:147], v222 offset:51200
    s_xor_b32 s38, s39, 16
    v_mfma_f32_16x16x32_bf16 v[100:103], v[128:131], a[108:111], v[100:103]
    ds_read_b64_tr_b16 v[148:149], v222 offset:57344
    v_mfma_f32_16x16x32_bf16 v[100:103], v[132:135], a[124:127], v[100:103]
    ds_read_b64_tr_b16 v[150:151], v222 offset:59392
    s_waitcnt lgkmcnt(4)
    v_mfma_f32_16x16x32_bf16 v[104:107], v[136:139], a[104:107], v[104:107]
    ds_read_b64_tr_b16 v[152:153], v223 offset:49152
    v_mfma_f32_16x16x32_bf16 v[104:107], v[140:143], a[120:123], v[104:107]
    ds_read_b64_tr_b16 v[154:155], v223 offset:51200
    s_mul_i32 s38, s38, 12288
    v_mfma_f32_16x16x32_bf16 v[108:111], v[136:139], a[108:111], v[108:111]
    ds_read_b64_tr_b16 v[156:157], v223 offset:57344
    s_add_u32 s38, s38, 0x5001000
    v_mfma_f32_16x16x32_bf16 v[108:111], v[140:143], a[124:127], v[108:111]
    ds_read_b64_tr_b16 v[158:159], v223 offset:59392
    s_waitcnt lgkmcnt(4)
    v_mfma_f32_16x16x32_bf16 v[112:115], v[144:147], a[104:107], v[112:115]
    ds_read_b64_tr_b16 v[128:129], v220 offset:0
    v_mfma_f32_16x16x32_bf16 v[112:115], v[148:151], a[120:123], v[112:115]
    ds_read_b64_tr_b16 v[130:131], v220 offset:2048
    v_mfma_f32_16x16x32_bf16 v[116:119], v[144:147], a[108:111], v[116:119]
    ds_read_b64_tr_b16 v[132:133], v220 offset:8192
    v_mfma_f32_16x16x32_bf16 v[116:119], v[148:151], a[124:127], v[116:119]
    ds_read_b64_tr_b16 v[134:135], v220 offset:10240
    s_waitcnt lgkmcnt(4)
    v_mfma_f32_16x16x32_bf16 v[120:123], v[152:155], a[104:107], v[120:123]
    ds_read_b64_tr_b16 v[136:137], v221 offset:0
    v_mfma_f32_16x16x32_bf16 v[120:123], v[156:159], a[120:123], v[120:123]
    ds_read_b64_tr_b16 v[138:139], v221 offset:2048
    v_mfma_f32_16x16x32_bf16 v[124:127], v[152:155], a[108:111], v[124:127]
    ds_read_b64_tr_b16 v[140:141], v221 offset:8192
    v_mfma_f32_16x16x32_bf16 v[124:127], v[156:159], a[124:127], v[124:127]
    ds_read_b64_tr_b16 v[142:143], v221 offset:10240
    s_waitcnt lgkmcnt(4)
    v_mfma_f32_16x16x32_bf16 v[0:3], v[128:131], a[0:3], v[0:3]
    ds_read_b64_tr_b16 v[144:145], v222 offset:0
    v_mfma_f32_16x16x32_bf16 v[0:3], v[132:135], a[16:19], v[0:3]
    ds_read_b64_tr_b16 v[146:147], v222 offset:2048
    v_mfma_f32_16x16x32_bf16 v[4:7], v[128:131], a[4:7], v[4:7]
    ds_read_b64_tr_b16 v[148:149], v222 offset:8192
    v_mfma_f32_16x16x32_bf16 v[4:7], v[132:135], a[20:23], v[4:7]
    ds_read_b64_tr_b16 v[150:151], v222 offset:10240
    s_waitcnt lgkmcnt(4)
    v_mfma_f32_16x16x32_bf16 v[8:11], v[136:139], a[0:3], v[8:11]
    ds_read_b64_tr_b16 v[152:153], v223 offset:0
    v_mfma_f32_16x16x32_bf16 v[8:11], v[140:143], a[16:19], v[8:11]
    ds_read_b64_tr_b16 v[154:155], v223 offset:2048
    v_mfma_f32_16x16x32_bf16 v[12:15], v[136:139], a[4:7], v[12:15]
    ds_read_b64_tr_b16 v[156:157], v223 offset:8192
    v_mfma_f32_16x16x32_bf16 v[12:15], v[140:143], a[20:23], v[12:15]
    ds_read_b64_tr_b16 v[158:159], v223 offset:10240
    s_waitcnt lgkmcnt(4)
    v_mfma_f32_16x16x32_bf16 v[16:19], v[144:147], a[0:3], v[16:19]
    ds_read_b64_tr_b16 v[128:129], v220 offset:16384
    s_mul_i32 s33, s39, 12288
    s_add_u32 s33, s33, 0x5002000
    v_mfma_f32_16x16x32_bf16 v[16:19], v[148:151], a[16:19], v[16:19]
    ds_read_b64_tr_b16 v[130:131], v220 offset:18432
    v_mfma_f32_16x16x32_bf16 v[20:23], v[144:147], a[4:7], v[20:23]
    ds_read_b64_tr_b16 v[132:133], v220 offset:24576
    v_cvt_pk_bf16_f32 v96, v96, v97
    v_mfma_f32_16x16x32_bf16 v[20:23], v[148:151], a[20:23], v[20:23]
    ds_read_b64_tr_b16 v[134:135], v220 offset:26624
    v_cvt_pk_bf16_f32 v97, v98, v99
    s_waitcnt lgkmcnt(4)
    v_mfma_f32_16x16x32_bf16 v[24:27], v[152:155], a[0:3], v[24:27]
    ds_read_b64_tr_b16 v[136:137], v221 offset:16384
    v_cvt_pk_bf16_f32 v98, v100, v101
    v_mfma_f32_16x16x32_bf16 v[24:27], v[156:159], a[16:19], v[24:27]
    ds_read_b64_tr_b16 v[138:139], v221 offset:18432
    v_cvt_pk_bf16_f32 v99, v102, v103
    v_mfma_f32_16x16x32_bf16 v[28:31], v[152:155], a[4:7], v[28:31]
    ds_read_b64_tr_b16 v[140:141], v221 offset:24576
    v_min_u32_e64 v96, -2, v96
    v_mfma_f32_16x16x32_bf16 v[28:31], v[156:159], a[20:23], v[28:31]
    ds_read_b64_tr_b16 v[142:143], v221 offset:26624
    v_min_u32 v97, -2, v97
    s_waitcnt lgkmcnt(4)
    v_mfma_f32_16x16x32_bf16 v[0:3], v[128:131], a[32:35], v[0:3]
    ds_read_b64_tr_b16 v[144:145], v222 offset:16384
    v_min_u32_e64 v98, -2, v98
    v_mfma_f32_16x16x32_bf16 v[0:3], v[132:135], a[48:51], v[0:3]
    ds_read_b64_tr_b16 v[146:147], v222 offset:18432
    v_min_u32_e64 v99, -2, v99
    v_mfma_f32_16x16x32_bf16 v[4:7], v[128:131], a[36:39], v[4:7]
    ds_read_b64_tr_b16 v[148:149], v222 offset:24576
    buffer_store_dwordx4 v[96:99], v228, s[8:11], s33 offen offset:0 sc1
    v_mfma_f32_16x16x32_bf16 v[4:7], v[132:135], a[52:55], v[4:7]
    ds_read_b64_tr_b16 v[150:151], v222 offset:26624
    s_waitcnt lgkmcnt(4)
    v_mfma_f32_16x16x32_bf16 v[8:11], v[136:139], a[32:35], v[8:11]
    ds_read_b64_tr_b16 v[152:153], v223 offset:16384
    v_mfma_f32_16x16x32_bf16 v[8:11], v[140:143], a[48:51], v[8:11]
    ds_read_b64_tr_b16 v[154:155], v223 offset:18432
    v_mfma_f32_16x16x32_bf16 v[12:15], v[136:139], a[36:39], v[12:15]
    ds_read_b64_tr_b16 v[156:157], v223 offset:24576
    v_cvt_pk_bf16_f32 v100, v104, v105
    v_mfma_f32_16x16x32_bf16 v[12:15], v[140:143], a[52:55], v[12:15]
    ds_read_b64_tr_b16 v[158:159], v223 offset:26624
    v_cvt_pk_bf16_f32 v101, v106, v107
    s_waitcnt lgkmcnt(4)
    v_mfma_f32_16x16x32_bf16 v[16:19], v[144:147], a[32:35], v[16:19]
    ds_read_b64_tr_b16 v[128:129], v220 offset:32768
    v_cvt_pk_bf16_f32 v102, v108, v109
    v_mfma_f32_16x16x32_bf16 v[16:19], v[148:151], a[48:51], v[16:19]
    ds_read_b64_tr_b16 v[130:131], v220 offset:34816
    v_cvt_pk_bf16_f32 v103, v110, v111
    v_mfma_f32_16x16x32_bf16 v[20:23], v[144:147], a[36:39], v[20:23]
    ds_read_b64_tr_b16 v[132:133], v220 offset:40960
    v_min_u32_e64 v100, -2, v100
    v_mfma_f32_16x16x32_bf16 v[20:23], v[148:151], a[52:55], v[20:23]
    ds_read_b64_tr_b16 v[134:135], v220 offset:43008
    v_min_u32 v101, -2, v101
    s_waitcnt lgkmcnt(4)
    v_mfma_f32_16x16x32_bf16 v[24:27], v[152:155], a[32:35], v[24:27]
    ds_read_b64_tr_b16 v[136:137], v221 offset:32768
    v_min_u32_e64 v102, -2, v102
    v_mfma_f32_16x16x32_bf16 v[24:27], v[156:159], a[48:51], v[24:27]
    ds_read_b64_tr_b16 v[138:139], v221 offset:34816
    v_min_u32_e64 v103, -2, v103
    v_mfma_f32_16x16x32_bf16 v[28:31], v[152:155], a[36:39], v[28:31]
    ds_read_b64_tr_b16 v[140:141], v221 offset:40960
    buffer_store_dwordx4 v[100:103], v228, s[8:11], s33 offen offset:1024 sc1
    v_mfma_f32_16x16x32_bf16 v[28:31], v[156:159], a[52:55], v[28:31]
    ds_read_b64_tr_b16 v[142:143], v221 offset:43008
    s_waitcnt lgkmcnt(4)
    v_mfma_f32_16x16x32_bf16 v[0:3], v[128:131], a[64:67], v[0:3]
    ds_read_b64_tr_b16 v[144:145], v222 offset:32768
    v_mfma_f32_16x16x32_bf16 v[0:3], v[132:135], a[80:83], v[0:3]
    ds_read_b64_tr_b16 v[146:147], v222 offset:34816
    v_mfma_f32_16x16x32_bf16 v[4:7], v[128:131], a[68:71], v[4:7]
    ds_read_b64_tr_b16 v[148:149], v222 offset:40960
    v_cvt_pk_bf16_f32 v104, v112, v113
    v_mfma_f32_16x16x32_bf16 v[4:7], v[132:135], a[84:87], v[4:7]
    ds_read_b64_tr_b16 v[150:151], v222 offset:43008
    v_cvt_pk_bf16_f32 v105, v114, v115
    s_waitcnt lgkmcnt(4)
    v_mfma_f32_16x16x32_bf16 v[8:11], v[136:139], a[64:67], v[8:11]
    ds_read_b64_tr_b16 v[152:153], v223 offset:32768
    v_cvt_pk_bf16_f32 v106, v116, v117
    v_mfma_f32_16x16x32_bf16 v[8:11], v[140:143], a[80:83], v[8:11]
    ds_read_b64_tr_b16 v[154:155], v223 offset:34816
    v_cvt_pk_bf16_f32 v107, v118, v119
    v_mfma_f32_16x16x32_bf16 v[12:15], v[136:139], a[68:71], v[12:15]
    ds_read_b64_tr_b16 v[156:157], v223 offset:40960
    v_min_u32_e64 v104, -2, v104
    v_mfma_f32_16x16x32_bf16 v[12:15], v[140:143], a[84:87], v[12:15]
    ds_read_b64_tr_b16 v[158:159], v223 offset:43008
    v_min_u32 v105, -2, v105
    s_waitcnt lgkmcnt(4)
    v_mfma_f32_16x16x32_bf16 v[16:19], v[144:147], a[64:67], v[16:19]
    ds_read_b64_tr_b16 v[128:129], v220 offset:49152
    v_min_u32_e64 v106, -2, v106
    v_mfma_f32_16x16x32_bf16 v[16:19], v[148:151], a[80:83], v[16:19]
    ds_read_b64_tr_b16 v[130:131], v220 offset:51200
    v_min_u32_e64 v107, -2, v107
    v_mfma_f32_16x16x32_bf16 v[20:23], v[144:147], a[68:71], v[20:23]
    ds_read_b64_tr_b16 v[132:133], v220 offset:57344
    buffer_store_dwordx4 v[104:107], v228, s[8:11], s33 offen offset:2048 sc1
    v_mfma_f32_16x16x32_bf16 v[20:23], v[148:151], a[84:87], v[20:23]
    ds_read_b64_tr_b16 v[134:135], v220 offset:59392
    s_waitcnt lgkmcnt(4)
    v_mfma_f32_16x16x32_bf16 v[24:27], v[152:155], a[64:67], v[24:27]
    ds_read_b64_tr_b16 v[136:137], v221 offset:49152
    v_mfma_f32_16x16x32_bf16 v[24:27], v[156:159], a[80:83], v[24:27]
    ds_read_b64_tr_b16 v[138:139], v221 offset:51200
    v_mfma_f32_16x16x32_bf16 v[28:31], v[152:155], a[68:71], v[28:31]
    ds_read_b64_tr_b16 v[140:141], v221 offset:57344
    v_cvt_pk_bf16_f32 v108, v120, v121
    v_mfma_f32_16x16x32_bf16 v[28:31], v[156:159], a[84:87], v[28:31]
    ds_read_b64_tr_b16 v[142:143], v221 offset:59392
    v_cvt_pk_bf16_f32 v109, v122, v123
    s_waitcnt lgkmcnt(4)
    v_mfma_f32_16x16x32_bf16 v[0:3], v[128:131], a[96:99], v[0:3]
    ds_read_b64_tr_b16 v[144:145], v222 offset:49152
    v_cvt_pk_bf16_f32 v110, v124, v125
    v_mfma_f32_16x16x32_bf16 v[0:3], v[132:135], a[112:115], v[0:3]
    ds_read_b64_tr_b16 v[146:147], v222 offset:51200
    v_cvt_pk_bf16_f32 v111, v126, v127
    v_mfma_f32_16x16x32_bf16 v[4:7], v[128:131], a[100:103], v[4:7]
    ds_read_b64_tr_b16 v[148:149], v222 offset:57344
    v_min_u32_e64 v108, -2, v108
    v_mfma_f32_16x16x32_bf16 v[4:7], v[132:135], a[116:119], v[4:7]
    ds_read_b64_tr_b16 v[150:151], v222 offset:59392
    v_min_u32 v109, -2, v109
    s_waitcnt lgkmcnt(4)
    v_mfma_f32_16x16x32_bf16 v[8:11], v[136:139], a[96:99], v[8:11]
    ds_read_b64_tr_b16 v[152:153], v223 offset:49152
    v_min_u32_e64 v110, -2, v110
    v_mfma_f32_16x16x32_bf16 v[8:11], v[140:143], a[112:115], v[8:11]
    ds_read_b64_tr_b16 v[154:155], v223 offset:51200
    v_min_u32_e64 v111, -2, v111
    v_mfma_f32_16x16x32_bf16 v[12:15], v[136:139], a[100:103], v[12:15]
    ds_read_b64_tr_b16 v[156:157], v223 offset:57344
    buffer_store_dwordx4 v[108:111], v228, s[8:11], s33 offen offset:3072 sc1
    v_mfma_f32_16x16x32_bf16 v[12:15], v[140:143], a[116:119], v[12:15]
    ds_read_b64_tr_b16 v[158:159], v223 offset:59392
    s_waitcnt lgkmcnt(4)
    v_mfma_f32_16x16x32_bf16 v[16:19], v[144:147], a[96:99], v[16:19]
    v_xor_b32 v216, 0x10000, v216
    ds_read_b64_tr_b16 v[128:129], v216 offset:0
    v_mfma_f32_16x16x32_bf16 v[16:19], v[148:151], a[112:115], v[16:19]
    ds_read_b64_tr_b16 v[130:131], v216 offset:2048
    v_mfma_f32_16x16x32_bf16 v[20:23], v[144:147], a[100:103], v[20:23]
    ds_read_b64_tr_b16 v[132:133], v216 offset:8192
    v_mfma_f32_16x16x32_bf16 v[20:23], v[148:151], a[116:119], v[20:23]
    ds_read_b64_tr_b16 v[134:135], v216 offset:10240
    s_waitcnt lgkmcnt(4)
    v_mfma_f32_16x16x32_bf16 v[24:27], v[152:155], a[96:99], v[24:27]
    v_xor_b32 v217, 0x10000, v217
    ds_read_b64_tr_b16 v[136:137], v217 offset:0
    v_mfma_f32_16x16x32_bf16 v[24:27], v[156:159], a[112:115], v[24:27]
    ds_read_b64_tr_b16 v[138:139], v217 offset:2048
    v_mfma_f32_16x16x32_bf16 v[28:31], v[152:155], a[100:103], v[28:31]
    ds_read_b64_tr_b16 v[140:141], v217 offset:8192
    v_mfma_f32_16x16x32_bf16 v[28:31], v[156:159], a[116:119], v[28:31]
    ds_read_b64_tr_b16 v[142:143], v217 offset:10240
    s_waitcnt lgkmcnt(4)
    v_mfma_f32_16x16x32_bf16 v[64:67], v[128:131], a[8:11], v[64:67]
    v_xor_b32 v218, 0x10000, v218
    ds_read_b64_tr_b16 v[144:145], v218 offset:0
    v_mfma_f32_16x16x32_bf16 v[64:67], v[132:135], a[24:27], v[64:67]
    ds_read_b64_tr_b16 v[146:147], v218 offset:2048
    v_mfma_f32_16x16x32_bf16 v[68:71], v[128:131], a[12:15], v[68:71]
    ds_read_b64_tr_b16 v[148:149], v218 offset:8192
    v_mfma_f32_16x16x32_bf16 v[68:71], v[132:135], a[28:31], v[68:71]
    ds_read_b64_tr_b16 v[150:151], v218 offset:10240
    s_waitcnt lgkmcnt(4)
    v_mfma_f32_16x16x32_bf16 v[72:75], v[136:139], a[8:11], v[72:75]
    v_xor_b32 v219, 0x10000, v219
    ds_read_b64_tr_b16 v[152:153], v219 offset:0
    v_mfma_f32_16x16x32_bf16 v[72:75], v[140:143], a[24:27], v[72:75]
    ds_read_b64_tr_b16 v[154:155], v219 offset:2048
    v_mfma_f32_16x16x32_bf16 v[76:79], v[136:139], a[12:15], v[76:79]
    ds_read_b64_tr_b16 v[156:157], v219 offset:8192
    v_mfma_f32_16x16x32_bf16 v[76:79], v[140:143], a[28:31], v[76:79]
    ds_read_b64_tr_b16 v[158:159], v219 offset:10240
    s_waitcnt lgkmcnt(4)
    v_mfma_f32_16x16x32_bf16 v[80:83], v[144:147], a[8:11], v[80:83]
    ds_read_b64_tr_b16 v[128:129], v216 offset:16384
    s_mul_i32 s33, s39, 12288
    s_add_u32 s33, s33, 0x5000000
    v_mfma_f32_16x16x32_bf16 v[80:83], v[148:151], a[24:27], v[80:83]
    ds_read_b64_tr_b16 v[130:131], v216 offset:18432
    v_mfma_f32_16x16x32_bf16 v[84:87], v[144:147], a[12:15], v[84:87]
    ds_read_b64_tr_b16 v[132:133], v216 offset:24576
    v_cvt_pk_bf16_f32 v0, v0, v1
    v_mfma_f32_16x16x32_bf16 v[84:87], v[148:151], a[28:31], v[84:87]
    ds_read_b64_tr_b16 v[134:135], v216 offset:26624
    v_cvt_pk_bf16_f32 v1, v2, v3
    s_waitcnt lgkmcnt(4)
    v_mfma_f32_16x16x32_bf16 v[88:91], v[152:155], a[8:11], v[88:91]
    ds_read_b64_tr_b16 v[136:137], v217 offset:16384
    v_cvt_pk_bf16_f32 v2, v4, v5
    v_mfma_f32_16x16x32_bf16 v[88:91], v[156:159], a[24:27], v[88:91]
    ds_read_b64_tr_b16 v[138:139], v217 offset:18432
    v_cvt_pk_bf16_f32 v3, v6, v7
    v_mfma_f32_16x16x32_bf16 v[92:95], v[152:155], a[12:15], v[92:95]
    ds_read_b64_tr_b16 v[140:141], v217 offset:24576
    v_min_u32_e64 v0, -2, v0
    v_mfma_f32_16x16x32_bf16 v[92:95], v[156:159], a[28:31], v[92:95]
    ds_read_b64_tr_b16 v[142:143], v217 offset:26624
    v_min_u32 v1, -2, v1
    s_waitcnt lgkmcnt(4)
    v_mfma_f32_16x16x32_bf16 v[64:67], v[128:131], a[40:43], v[64:67]
    ds_read_b64_tr_b16 v[144:145], v218 offset:16384
    v_min_u32_e64 v2, -2, v2
    v_mfma_f32_16x16x32_bf16 v[64:67], v[132:135], a[56:59], v[64:67]
    ds_read_b64_tr_b16 v[146:147], v218 offset:18432
    v_min_u32_e64 v3, -2, v3
    v_mfma_f32_16x16x32_bf16 v[68:71], v[128:131], a[44:47], v[68:71]
    ds_read_b64_tr_b16 v[148:149], v218 offset:24576
    buffer_store_dwordx4 v[0:3], v228, s[8:11], s33 offen offset:0 sc1
    v_mfma_f32_16x16x32_bf16 v[68:71], v[132:135], a[60:63], v[68:71]
    ds_read_b64_tr_b16 v[150:151], v218 offset:26624
    s_waitcnt lgkmcnt(4)
    v_mfma_f32_16x16x32_bf16 v[72:75], v[136:139], a[40:43], v[72:75]
    ds_read_b64_tr_b16 v[152:153], v219 offset:16384
    v_mfma_f32_16x16x32_bf16 v[72:75], v[140:143], a[56:59], v[72:75]
    ds_read_b64_tr_b16 v[154:155], v219 offset:18432
    v_mfma_f32_16x16x32_bf16 v[76:79], v[136:139], a[44:47], v[76:79]
    ds_read_b64_tr_b16 v[156:157], v219 offset:24576
    v_cvt_pk_bf16_f32 v4, v8, v9
    v_mfma_f32_16x16x32_bf16 v[76:79], v[140:143], a[60:63], v[76:79]
    ds_read_b64_tr_b16 v[158:159], v219 offset:26624
    v_cvt_pk_bf16_f32 v5, v10, v11
    s_waitcnt lgkmcnt(4)
    v_mfma_f32_16x16x32_bf16 v[80:83], v[144:147], a[40:43], v[80:83]
    ds_read_b64_tr_b16 v[128:129], v216 offset:32768
    v_cvt_pk_bf16_f32 v6, v12, v13
    v_mfma_f32_16x16x32_bf16 v[80:83], v[148:151], a[56:59], v[80:83]
    ds_read_b64_tr_b16 v[130:131], v216 offset:34816
    v_cvt_pk_bf16_f32 v7, v14, v15
    v_mfma_f32_16x16x32_bf16 v[84:87], v[144:147], a[44:47], v[84:87]
    ds_read_b64_tr_b16 v[132:133], v216 offset:40960
    v_min_u32_e64 v4, -2, v4
    v_mfma_f32_16x16x32_bf16 v[84:87], v[148:151], a[60:63], v[84:87]
    ds_read_b64_tr_b16 v[134:135], v216 offset:43008
    v_min_u32 v5, -2, v5
    s_waitcnt lgkmcnt(4)
    v_mfma_f32_16x16x32_bf16 v[88:91], v[152:155], a[40:43], v[88:91]
    ds_read_b64_tr_b16 v[136:137], v217 offset:32768
    v_min_u32_e64 v6, -2, v6
    v_mfma_f32_16x16x32_bf16 v[88:91], v[156:159], a[56:59], v[88:91]
    ds_read_b64_tr_b16 v[138:139], v217 offset:34816
    v_min_u32_e64 v7, -2, v7
    v_mfma_f32_16x16x32_bf16 v[92:95], v[152:155], a[44:47], v[92:95]
    ds_read_b64_tr_b16 v[140:141], v217 offset:40960
    buffer_store_dwordx4 v[4:7], v228, s[8:11], s33 offen offset:1024 sc1
    v_mfma_f32_16x16x32_bf16 v[92:95], v[156:159], a[60:63], v[92:95]
    ds_read_b64_tr_b16 v[142:143], v217 offset:43008
    s_waitcnt lgkmcnt(4)
    v_mfma_f32_16x16x32_bf16 v[64:67], v[128:131], a[72:75], v[64:67]
    ds_read_b64_tr_b16 v[144:145], v218 offset:32768
    v_mfma_f32_16x16x32_bf16 v[64:67], v[132:135], a[88:91], v[64:67]
    ds_read_b64_tr_b16 v[146:147], v218 offset:34816
    v_mfma_f32_16x16x32_bf16 v[68:71], v[128:131], a[76:79], v[68:71]
    ds_read_b64_tr_b16 v[148:149], v218 offset:40960
    v_cvt_pk_bf16_f32 v8, v16, v17
    v_mfma_f32_16x16x32_bf16 v[68:71], v[132:135], a[92:95], v[68:71]
    ds_read_b64_tr_b16 v[150:151], v218 offset:43008
    v_cvt_pk_bf16_f32 v9, v18, v19
    s_waitcnt lgkmcnt(4)
    v_mfma_f32_16x16x32_bf16 v[72:75], v[136:139], a[72:75], v[72:75]
    ds_read_b64_tr_b16 v[152:153], v219 offset:32768
    v_cvt_pk_bf16_f32 v10, v20, v21
    v_mfma_f32_16x16x32_bf16 v[72:75], v[140:143], a[88:91], v[72:75]
    ds_read_b64_tr_b16 v[154:155], v219 offset:34816
    v_cvt_pk_bf16_f32 v11, v22, v23
    v_mfma_f32_16x16x32_bf16 v[76:79], v[136:139], a[76:79], v[76:79]
    ds_read_b64_tr_b16 v[156:157], v219 offset:40960
    v_min_u32_e64 v8, -2, v8
    v_mfma_f32_16x16x32_bf16 v[76:79], v[140:143], a[92:95], v[76:79]
    ds_read_b64_tr_b16 v[158:159], v219 offset:43008
    v_min_u32 v9, -2, v9
    s_waitcnt lgkmcnt(4)
    v_mfma_f32_16x16x32_bf16 v[80:83], v[144:147], a[72:75], v[80:83]
    ds_read_b64_tr_b16 v[128:129], v216 offset:49152
    v_min_u32_e64 v10, -2, v10
    v_mfma_f32_16x16x32_bf16 v[80:83], v[148:151], a[88:91], v[80:83]
    ds_read_b64_tr_b16 v[130:131], v216 offset:51200
    v_min_u32_e64 v11, -2, v11
    v_mfma_f32_16x16x32_bf16 v[84:87], v[144:147], a[76:79], v[84:87]
    ds_read_b64_tr_b16 v[132:133], v216 offset:57344
    buffer_store_dwordx4 v[8:11], v228, s[8:11], s33 offen offset:2048 sc1
    v_mfma_f32_16x16x32_bf16 v[84:87], v[148:151], a[92:95], v[84:87]
    ds_read_b64_tr_b16 v[134:135], v216 offset:59392
    s_waitcnt lgkmcnt(4)
    v_mfma_f32_16x16x32_bf16 v[88:91], v[152:155], a[72:75], v[88:91]
    ds_read_b64_tr_b16 v[136:137], v217 offset:49152
    v_mfma_f32_16x16x32_bf16 v[88:91], v[156:159], a[88:91], v[88:91]
    ds_read_b64_tr_b16 v[138:139], v217 offset:51200
    v_mfma_f32_16x16x32_bf16 v[92:95], v[152:155], a[76:79], v[92:95]
    ds_read_b64_tr_b16 v[140:141], v217 offset:57344
    v_cvt_pk_bf16_f32 v12, v24, v25
    v_mfma_f32_16x16x32_bf16 v[92:95], v[156:159], a[92:95], v[92:95]
    ds_read_b64_tr_b16 v[142:143], v217 offset:59392
    v_cvt_pk_bf16_f32 v13, v26, v27
    s_waitcnt lgkmcnt(4)
    v_mfma_f32_16x16x32_bf16 v[64:67], v[128:131], a[104:107], v[64:67]
    ds_read_b64_tr_b16 v[144:145], v218 offset:49152
    v_cvt_pk_bf16_f32 v14, v28, v29
    v_mfma_f32_16x16x32_bf16 v[64:67], v[132:135], a[120:123], v[64:67]
    ds_read_b64_tr_b16 v[146:147], v218 offset:51200
    v_cvt_pk_bf16_f32 v15, v30, v31
    v_mfma_f32_16x16x32_bf16 v[68:71], v[128:131], a[108:111], v[68:71]
    ds_read_b64_tr_b16 v[148:149], v218 offset:57344
    v_min_u32_e64 v12, -2, v12
    v_mfma_f32_16x16x32_bf16 v[68:71], v[132:135], a[124:127], v[68:71]
    ds_read_b64_tr_b16 v[150:151], v218 offset:59392
    v_min_u32 v13, -2, v13
    s_waitcnt lgkmcnt(4)
    v_mfma_f32_16x16x32_bf16 v[72:75], v[136:139], a[104:107], v[72:75]
    ds_read_b64_tr_b16 v[152:153], v219 offset:49152
    v_min_u32_e64 v14, -2, v14
    v_mfma_f32_16x16x32_bf16 v[72:75], v[140:143], a[120:123], v[72:75]
    ds_read_b64_tr_b16 v[154:155], v219 offset:51200
    v_min_u32_e64 v15, -2, v15
    v_mfma_f32_16x16x32_bf16 v[76:79], v[136:139], a[108:111], v[76:79]
    ds_read_b64_tr_b16 v[156:157], v219 offset:57344
    buffer_store_dwordx4 v[12:15], v228, s[8:11], s33 offen offset:3072 sc1
    v_mfma_f32_16x16x32_bf16 v[76:79], v[140:143], a[124:127], v[76:79]
    ds_read_b64_tr_b16 v[158:159], v219 offset:59392
    s_waitcnt lgkmcnt(4)
    v_mfma_f32_16x16x32_bf16 v[80:83], v[144:147], a[104:107], v[80:83]
    v_xor_b32 v216, 0x10000, v216
    ds_read_b64_tr_b16 v[128:129], v216 offset:32768
    v_mfma_f32_16x16x32_bf16 v[80:83], v[148:151], a[120:123], v[80:83]
    ds_read_b64_tr_b16 v[130:131], v216 offset:34816
    v_mfma_f32_16x16x32_bf16 v[84:87], v[144:147], a[108:111], v[84:87]
    ds_read_b64_tr_b16 v[132:133], v216 offset:40960
    v_mfma_f32_16x16x32_bf16 v[84:87], v[148:151], a[124:127], v[84:87]
    ds_read_b64_tr_b16 v[134:135], v216 offset:43008
    s_waitcnt lgkmcnt(4)
    v_mfma_f32_16x16x32_bf16 v[88:91], v[152:155], a[104:107], v[88:91]
    v_xor_b32 v217, 0x10000, v217
    ds_read_b64_tr_b16 v[136:137], v217 offset:32768
    v_mfma_f32_16x16x32_bf16 v[88:91], v[156:159], a[120:123], v[88:91]
    ds_read_b64_tr_b16 v[138:139], v217 offset:34816
    v_mfma_f32_16x16x32_bf16 v[92:95], v[152:155], a[108:111], v[92:95]
    ds_read_b64_tr_b16 v[140:141], v217 offset:40960
    v_mfma_f32_16x16x32_bf16 v[92:95], v[156:159], a[124:127], v[92:95]
    ds_read_b64_tr_b16 v[142:143], v217 offset:43008
    s_waitcnt lgkmcnt(4)
    v_mfma_f32_16x16x32_bf16 v[32:35], v[128:131], a[224:227], v[32:35]
    v_xor_b32 v218, 0x10000, v218
    ds_read_b64_tr_b16 v[144:145], v218 offset:32768
    v_mfma_f32_16x16x32_bf16 v[32:35], v[132:135], a[232:235], v[32:35]
    ds_read_b64_tr_b16 v[146:147], v218 offset:34816
    buffer_load_dwordx4 v[176:179], v228, s[8:11], s7 offen offset:0 sc1
    v_mfma_f32_16x16x32_bf16 v[36:39], v[128:131], a[228:231], v[36:39]
    ds_read_b64_tr_b16 v[148:149], v218 offset:40960
    v_mfma_f32_16x16x32_bf16 v[36:39], v[132:135], a[236:239], v[36:39]
    ds_read_b64_tr_b16 v[150:151], v218 offset:43008
    buffer_load_dwordx4 v[180:183], v228, s[8:11], s7 offen offset:1024 sc1
    s_waitcnt lgkmcnt(4)
    v_mfma_f32_16x16x32_bf16 v[40:43], v[136:139], a[224:227], v[40:43]
    v_xor_b32 v219, 0x10000, v219
    ds_read_b64_tr_b16 v[152:153], v219 offset:32768
    v_mfma_f32_16x16x32_bf16 v[40:43], v[140:143], a[232:235], v[40:43]
    ds_read_b64_tr_b16 v[154:155], v219 offset:34816
    buffer_load_dwordx4 v[184:187], v228, s[8:11], s7 offen offset:2048 sc1
    v_mfma_f32_16x16x32_bf16 v[44:47], v[136:139], a[228:231], v[44:47]
    ds_read_b64_tr_b16 v[156:157], v219 offset:40960
    v_mfma_f32_16x16x32_bf16 v[44:47], v[140:143], a[236:239], v[44:47]
    ds_read_b64_tr_b16 v[158:159], v219 offset:43008
    buffer_load_dwordx4 v[188:191], v228, s[8:11], s7 offen offset:3072 sc1
    s_waitcnt lgkmcnt(4)
    v_mfma_f32_16x16x32_bf16 v[48:51], v[144:147], a[224:227], v[48:51]
    ds_read_b64_tr_b16 v[128:129], v216 offset:49152
    s_mul_i32 s33, s39, 12288
    s_add_u32 s33, s33, 0x5001000
    v_mfma_f32_16x16x32_bf16 v[48:51], v[148:151], a[232:235], v[48:51]
    ds_read_b64_tr_b16 v[130:131], v216 offset:51200
    v_mfma_f32_16x16x32_bf16 v[52:55], v[144:147], a[228:231], v[52:55]
    ds_read_b64_tr_b16 v[132:133], v216 offset:57344
    v_cvt_pk_bf16_f32 v64, v64, v65
    v_mfma_f32_16x16x32_bf16 v[52:55], v[148:151], a[236:239], v[52:55]
    ds_read_b64_tr_b16 v[134:135], v216 offset:59392
    v_cvt_pk_bf16_f32 v65, v66, v67
    s_waitcnt lgkmcnt(4)
    v_mfma_f32_16x16x32_bf16 v[56:59], v[152:155], a[224:227], v[56:59]
    ds_read_b64_tr_b16 v[136:137], v217 offset:49152
    v_cvt_pk_bf16_f32 v66, v68, v69
    v_mfma_f32_16x16x32_bf16 v[56:59], v[156:159], a[232:235], v[56:59]
    ds_read_b64_tr_b16 v[138:139], v217 offset:51200
    v_cvt_pk_bf16_f32 v67, v70, v71
    v_mfma_f32_16x16x32_bf16 v[60:63], v[152:155], a[228:231], v[60:63]
    ds_read_b64_tr_b16 v[140:141], v217 offset:57344
    v_min_u32_e64 v64, -2, v64
    v_mfma_f32_16x16x32_bf16 v[60:63], v[156:159], a[236:239], v[60:63]
    ds_read_b64_tr_b16 v[142:143], v217 offset:59392
    v_min_u32 v65, -2, v65
    s_waitcnt lgkmcnt(4)
    v_mfma_f32_16x16x32_bf16 v[32:35], v[128:131], a[240:243], v[32:35]
    ds_read_b64_tr_b16 v[144:145], v218 offset:49152
    v_min_u32_e64 v66, -2, v66
    v_mfma_f32_16x16x32_bf16 v[32:35], v[132:135], a[248:251], v[32:35]
    ds_read_b64_tr_b16 v[146:147], v218 offset:51200
    v_min_u32_e64 v67, -2, v67
    v_mfma_f32_16x16x32_bf16 v[36:39], v[128:131], a[244:247], v[36:39]
    ds_read_b64_tr_b16 v[148:149], v218 offset:57344
    buffer_store_dwordx4 v[64:67], v228, s[8:11], s33 offen offset:0 sc1
    v_mfma_f32_16x16x32_bf16 v[36:39], v[132:135], a[252:255], v[36:39]
    ds_read_b64_tr_b16 v[150:151], v218 offset:59392
    s_waitcnt lgkmcnt(4)
    v_mfma_f32_16x16x32_bf16 v[40:43], v[136:139], a[240:243], v[40:43]
    ds_read_b64_tr_b16 v[152:153], v219 offset:49152
    v_mfma_f32_16x16x32_bf16 v[40:43], v[140:143], a[248:251], v[40:43]
    ds_read_b64_tr_b16 v[154:155], v219 offset:51200
    v_mfma_f32_16x16x32_bf16 v[44:47], v[136:139], a[244:247], v[44:47]
    ds_read_b64_tr_b16 v[156:157], v219 offset:57344
    v_cvt_pk_bf16_f32 v68, v72, v73
    v_mfma_f32_16x16x32_bf16 v[44:47], v[140:143], a[252:255], v[44:47]
    ds_read_b64_tr_b16 v[158:159], v219 offset:59392
    v_cvt_pk_bf16_f32 v69, v74, v75
    s_waitcnt lgkmcnt(4)
    v_mfma_f32_16x16x32_bf16 v[48:51], v[144:147], a[240:243], v[48:51]
    v_xor_b32 v216, 0x10000, v216
    ds_read_b64_tr_b16 v[128:129], v216 offset:0
    v_cvt_pk_bf16_f32 v70, v76, v77
    v_mfma_f32_16x16x32_bf16 v[48:51], v[148:151], a[248:251], v[48:51]
    ds_read_b64_tr_b16 v[130:131], v216 offset:2048
    v_cvt_pk_bf16_f32 v71, v78, v79
    v_mfma_f32_16x16x32_bf16 v[52:55], v[144:147], a[244:247], v[52:55]
    ds_read_b64_tr_b16 v[132:133], v216 offset:8192
    v_min_u32_e64 v68, -2, v68
    v_mfma_f32_16x16x32_bf16 v[52:55], v[148:151], a[252:255], v[52:55]
    ds_read_b64_tr_b16 v[134:135], v216 offset:10240
    v_min_u32 v69, -2, v69
    s_waitcnt lgkmcnt(4)
    v_mfma_f32_16x16x32_bf16 v[56:59], v[152:155], a[240:243], v[56:59]
    v_xor_b32 v217, 0x10000, v217
    ds_read_b64_tr_b16 v[136:137], v217 offset:0
    v_min_u32_e64 v70, -2, v70
    v_mfma_f32_16x16x32_bf16 v[56:59], v[156:159], a[248:251], v[56:59]
    ds_read_b64_tr_b16 v[138:139], v217 offset:2048
    v_min_u32_e64 v71, -2, v71
    v_mfma_f32_16x16x32_bf16 v[60:63], v[152:155], a[244:247], v[60:63]
    ds_read_b64_tr_b16 v[140:141], v217 offset:8192
    buffer_store_dwordx4 v[68:71], v228, s[8:11], s33 offen offset:1024 sc1
    v_mfma_f32_16x16x32_bf16 v[60:63], v[156:159], a[252:255], v[60:63]
    ds_read_b64_tr_b16 v[142:143], v217 offset:10240
    s_waitcnt lgkmcnt(4)
    v_mfma_f32_16x16x32_bf16 v[32:35], v[128:131], a[0:3], v[32:35]
    v_xor_b32 v218, 0x10000, v218
    ds_read_b64_tr_b16 v[144:145], v218 offset:0
    v_mfma_f32_16x16x32_bf16 v[32:35], v[132:135], a[16:19], v[32:35]
    ds_read_b64_tr_b16 v[146:147], v218 offset:2048
    v_mfma_f32_16x16x32_bf16 v[36:39], v[128:131], a[4:7], v[36:39]
    ds_read_b64_tr_b16 v[148:149], v218 offset:8192
    v_cvt_pk_bf16_f32 v72, v80, v81
    v_mfma_f32_16x16x32_bf16 v[36:39], v[132:135], a[20:23], v[36:39]
    ds_read_b64_tr_b16 v[150:151], v218 offset:10240
    v_cvt_pk_bf16_f32 v73, v82, v83
    s_waitcnt lgkmcnt(4)
    v_mfma_f32_16x16x32_bf16 v[40:43], v[136:139], a[0:3], v[40:43]
    v_xor_b32 v219, 0x10000, v219
    ds_read_b64_tr_b16 v[152:153], v219 offset:0
    v_cvt_pk_bf16_f32 v74, v84, v85
    v_mfma_f32_16x16x32_bf16 v[40:43], v[140:143], a[16:19], v[40:43]
    ds_read_b64_tr_b16 v[154:155], v219 offset:2048
    v_cvt_pk_bf16_f32 v75, v86, v87
    v_mfma_f32_16x16x32_bf16 v[44:47], v[136:139], a[4:7], v[44:47]
    ds_read_b64_tr_b16 v[156:157], v219 offset:8192
    v_min_u32_e64 v72, -2, v72
    v_mfma_f32_16x16x32_bf16 v[44:47], v[140:143], a[20:23], v[44:47]
    ds_read_b64_tr_b16 v[158:159], v219 offset:10240
    v_min_u32 v73, -2, v73
    s_waitcnt lgkmcnt(4)
    v_mfma_f32_16x16x32_bf16 v[48:51], v[144:147], a[0:3], v[48:51]
    ds_read_b64_tr_b16 v[128:129], v216 offset:16384
    v_min_u32_e64 v74, -2, v74
    v_mfma_f32_16x16x32_bf16 v[48:51], v[148:151], a[16:19], v[48:51]
    ds_read_b64_tr_b16 v[130:131], v216 offset:18432
    v_min_u32_e64 v75, -2, v75
    v_mfma_f32_16x16x32_bf16 v[52:55], v[144:147], a[4:7], v[52:55]
    ds_read_b64_tr_b16 v[132:133], v216 offset:24576
    buffer_store_dwordx4 v[72:75], v228, s[8:11], s33 offen offset:2048 sc1
    v_mfma_f32_16x16x32_bf16 v[52:55], v[148:151], a[20:23], v[52:55]
    ds_read_b64_tr_b16 v[134:135], v216 offset:26624
    s_waitcnt lgkmcnt(4)
    v_mfma_f32_16x16x32_bf16 v[56:59], v[152:155], a[0:3], v[56:59]
    ds_read_b64_tr_b16 v[136:137], v217 offset:16384
    v_mfma_f32_16x16x32_bf16 v[56:59], v[156:159], a[16:19], v[56:59]
    ds_read_b64_tr_b16 v[138:139], v217 offset:18432
    v_mfma_f32_16x16x32_bf16 v[60:63], v[152:155], a[4:7], v[60:63]
    ds_read_b64_tr_b16 v[140:141], v217 offset:24576
    v_cvt_pk_bf16_f32 v76, v88, v89
    v_mfma_f32_16x16x32_bf16 v[60:63], v[156:159], a[20:23], v[60:63]
    ds_read_b64_tr_b16 v[142:143], v217 offset:26624
    v_cvt_pk_bf16_f32 v77, v90, v91
    s_waitcnt lgkmcnt(4)
    v_mfma_f32_16x16x32_bf16 v[32:35], v[128:131], a[32:35], v[32:35]
    ds_read_b64_tr_b16 v[144:145], v218 offset:16384
    v_cvt_pk_bf16_f32 v78, v92, v93
    v_mfma_f32_16x16x32_bf16 v[32:35], v[132:135], a[48:51], v[32:35]
    ds_read_b64_tr_b16 v[146:147], v218 offset:18432
    v_cvt_pk_bf16_f32 v79, v94, v95
    v_mfma_f32_16x16x32_bf16 v[36:39], v[128:131], a[36:39], v[36:39]
    ds_read_b64_tr_b16 v[148:149], v218 offset:24576
    v_min_u32_e64 v76, -2, v76
    v_mfma_f32_16x16x32_bf16 v[36:39], v[132:135], a[52:55], v[36:39]
    ds_read_b64_tr_b16 v[150:151], v218 offset:26624
    v_min_u32 v77, -2, v77
    s_waitcnt lgkmcnt(4)
    v_mfma_f32_16x16x32_bf16 v[40:43], v[136:139], a[32:35], v[40:43]
    ds_read_b64_tr_b16 v[152:153], v219 offset:16384
    v_min_u32_e64 v78, -2, v78
    v_mfma_f32_16x16x32_bf16 v[40:43], v[140:143], a[48:51], v[40:43]
    ds_read_b64_tr_b16 v[154:155], v219 offset:18432
    v_min_u32_e64 v79, -2, v79
    v_mfma_f32_16x16x32_bf16 v[44:47], v[136:139], a[36:39], v[44:47]
    ds_read_b64_tr_b16 v[156:157], v219 offset:24576
    buffer_store_dwordx4 v[76:79], v228, s[8:11], s33 offen offset:3072 sc1
    v_mfma_f32_16x16x32_bf16 v[44:47], v[140:143], a[52:55], v[44:47]
    ds_read_b64_tr_b16 v[158:159], v219 offset:26624
    s_waitcnt lgkmcnt(4)
    v_mfma_f32_16x16x32_bf16 v[48:51], v[144:147], a[32:35], v[48:51]
    ds_read_b64_tr_b16 v[128:129], v216 offset:32768
    v_mfma_f32_16x16x32_bf16 v[48:51], v[148:151], a[48:51], v[48:51]
    ds_read_b64_tr_b16 v[130:131], v216 offset:34816
    v_mfma_f32_16x16x32_bf16 v[52:55], v[144:147], a[36:39], v[52:55]
    ds_read_b64_tr_b16 v[132:133], v216 offset:40960
    v_mfma_f32_16x16x32_bf16 v[52:55], v[148:151], a[52:55], v[52:55]
    ds_read_b64_tr_b16 v[134:135], v216 offset:43008
    s_waitcnt lgkmcnt(4)
    v_mfma_f32_16x16x32_bf16 v[56:59], v[152:155], a[32:35], v[56:59]
    ds_read_b64_tr_b16 v[136:137], v217 offset:32768
    v_mfma_f32_16x16x32_bf16 v[56:59], v[156:159], a[48:51], v[56:59]
    ds_read_b64_tr_b16 v[138:139], v217 offset:34816
    v_mfma_f32_16x16x32_bf16 v[60:63], v[152:155], a[36:39], v[60:63]
    ds_read_b64_tr_b16 v[140:141], v217 offset:40960
    v_mfma_f32_16x16x32_bf16 v[60:63], v[156:159], a[52:55], v[60:63]
    ds_read_b64_tr_b16 v[142:143], v217 offset:43008
    s_waitcnt lgkmcnt(4)
    v_mfma_f32_16x16x32_bf16 v[32:35], v[128:131], a[64:67], v[32:35]
    ds_read_b64_tr_b16 v[144:145], v218 offset:32768
    v_mfma_f32_16x16x32_bf16 v[32:35], v[132:135], a[80:83], v[32:35]
    ds_read_b64_tr_b16 v[146:147], v218 offset:34816
    v_mfma_f32_16x16x32_bf16 v[36:39], v[128:131], a[68:71], v[36:39]
    ds_read_b64_tr_b16 v[148:149], v218 offset:40960
    v_mfma_f32_16x16x32_bf16 v[36:39], v[132:135], a[84:87], v[36:39]
    ds_read_b64_tr_b16 v[150:151], v218 offset:43008
    s_waitcnt lgkmcnt(4)
    v_mfma_f32_16x16x32_bf16 v[40:43], v[136:139], a[64:67], v[40:43]
    ds_read_b64_tr_b16 v[152:153], v219 offset:32768
    v_mfma_f32_16x16x32_bf16 v[40:43], v[140:143], a[80:83], v[40:43]
    ds_read_b64_tr_b16 v[154:155], v219 offset:34816
    v_mfma_f32_16x16x32_bf16 v[44:47], v[136:139], a[68:71], v[44:47]
    ds_read_b64_tr_b16 v[156:157], v219 offset:40960
    v_mfma_f32_16x16x32_bf16 v[44:47], v[140:143], a[84:87], v[44:47]
    ds_read_b64_tr_b16 v[158:159], v219 offset:43008
    s_waitcnt lgkmcnt(4)
    v_mfma_f32_16x16x32_bf16 v[48:51], v[144:147], a[64:67], v[48:51]
    ds_read_b64_tr_b16 v[128:129], v216 offset:49152
    v_mfma_f32_16x16x32_bf16 v[48:51], v[148:151], a[80:83], v[48:51]
    ds_read_b64_tr_b16 v[130:131], v216 offset:51200
    v_mfma_f32_16x16x32_bf16 v[52:55], v[144:147], a[68:71], v[52:55]
    ds_read_b64_tr_b16 v[132:133], v216 offset:57344
    v_mfma_f32_16x16x32_bf16 v[52:55], v[148:151], a[84:87], v[52:55]
    ds_read_b64_tr_b16 v[134:135], v216 offset:59392
    s_waitcnt lgkmcnt(4)
    v_mfma_f32_16x16x32_bf16 v[56:59], v[152:155], a[64:67], v[56:59]
    ds_read_b64_tr_b16 v[136:137], v217 offset:49152
    v_mfma_f32_16x16x32_bf16 v[56:59], v[156:159], a[80:83], v[56:59]
    ds_read_b64_tr_b16 v[138:139], v217 offset:51200
    v_mfma_f32_16x16x32_bf16 v[60:63], v[152:155], a[68:71], v[60:63]
    ds_read_b64_tr_b16 v[140:141], v217 offset:57344
    v_mfma_f32_16x16x32_bf16 v[60:63], v[156:159], a[84:87], v[60:63]
    ds_read_b64_tr_b16 v[142:143], v217 offset:59392
    s_waitcnt lgkmcnt(4)
    v_mfma_f32_16x16x32_bf16 v[32:35], v[128:131], a[96:99], v[32:35]
    ds_read_b64_tr_b16 v[144:145], v218 offset:49152
    v_mfma_f32_16x16x32_bf16 v[32:35], v[132:135], a[112:115], v[32:35]
    ds_read_b64_tr_b16 v[146:147], v218 offset:51200
    v_mfma_f32_16x16x32_bf16 v[36:39], v[128:131], a[100:103], v[36:39]
    ds_read_b64_tr_b16 v[148:149], v218 offset:57344
    v_mfma_f32_16x16x32_bf16 v[36:39], v[132:135], a[116:119], v[36:39]
    ds_read_b64_tr_b16 v[150:151], v218 offset:59392
    s_waitcnt lgkmcnt(4)
    v_mfma_f32_16x16x32_bf16 v[40:43], v[136:139], a[96:99], v[40:43]
    ds_read_b64_tr_b16 v[152:153], v219 offset:49152
    v_mfma_f32_16x16x32_bf16 v[40:43], v[140:143], a[112:115], v[40:43]
    ds_read_b64_tr_b16 v[154:155], v219 offset:51200
    v_mfma_f32_16x16x32_bf16 v[44:47], v[136:139], a[100:103], v[44:47]
    ds_read_b64_tr_b16 v[156:157], v219 offset:57344
    v_mfma_f32_16x16x32_bf16 v[44:47], v[140:143], a[116:119], v[44:47]
    ds_read_b64_tr_b16 v[158:159], v219 offset:59392
    s_waitcnt lgkmcnt(4)
    v_mfma_f32_16x16x32_bf16 v[48:51], v[144:147], a[96:99], v[48:51]
    buffer_load_dwordx4 v[96:99], v228, s[8:11], s37 offen offset:0 sc1
    v_mfma_f32_16x16x32_bf16 v[48:51], v[148:151], a[112:115], v[48:51]
    v_mfma_f32_16x16x32_bf16 v[52:55], v[144:147], a[100:103], v[52:55]
    buffer_load_dwordx4 v[100:103], v228, s[8:11], s37 offen offset:1024 sc1
    v_mfma_f32_16x16x32_bf16 v[52:55], v[148:151], a[116:119], v[52:55]
    s_waitcnt lgkmcnt(0)
    v_mfma_f32_16x16x32_bf16 v[56:59], v[152:155], a[96:99], v[56:59]
    buffer_load_dwordx4 v[104:107], v228, s[8:11], s37 offen offset:2048 sc1
    v_mfma_f32_16x16x32_bf16 v[56:59], v[156:159], a[112:115], v[56:59]
    v_mfma_f32_16x16x32_bf16 v[60:63], v[152:155], a[100:103], v[60:63]
    buffer_load_dwordx4 v[108:111], v228, s[8:11], s37 offen offset:3072 sc1
    v_mfma_f32_16x16x32_bf16 v[60:63], v[156:159], a[116:119], v[60:63]
kc_tail:
    buffer_load_dwordx4 v[160:163], v228, s[8:11], s38 offen offset:0 sc1
    buffer_load_dwordx4 v[164:167], v228, s[8:11], s38 offen offset:1024 sc1
    buffer_load_dwordx4 v[168:171], v228, s[8:11], s38 offen offset:2048 sc1
    buffer_load_dwordx4 v[172:175], v228, s[8:11], s38 offen offset:3072 sc1
    v_lshlrev_b32_e64 v128, 16, v192
    v_and_b32 v129, 0xffff0000, v192
    v_lshlrev_b32_e64 v130, 16, v193
    v_and_b32 v131, 0xffff0000, v193
    v_lshlrev_b32_e64 v132, 16, v194
    v_and_b32 v133, 0xffff0000, v194
    v_lshlrev_b32_e64 v134, 16, v195
    v_and_b32 v135, 0xffff0000, v195
    v_lshlrev_b32_e64 v136, 16, v196
    v_and_b32 v137, 0xffff0000, v196
    v_lshlrev_b32_e64 v138, 16, v197
    v_and_b32 v139, 0xffff0000, v197
    v_lshlrev_b32_e64 v140, 16, v198
    v_and_b32 v141, 0xffff0000, v198
    v_lshlrev_b32_e64 v142, 16, v199
    v_and_b32 v143, 0xffff0000, v199
    v_lshlrev_b32_e64 v144, 16, v200
    v_and_b32 v145, 0xffff0000, v200
    v_lshlrev_b32_e64 v146, 16, v201
    v_and_b32 v147, 0xffff0000, v201
    v_lshlrev_b32_e64 v148, 16, v202
    v_and_b32 v149, 0xffff0000, v202
    v_lshlrev_b32_e64 v150, 16, v203
    v_and_b32 v151, 0xffff0000, v203
    v_lshlrev_b32_e64 v152, 16, v204
    v_and_b32 v153, 0xffff0000, v204
    v_lshlrev_b32_e64 v154, 16, v205
    v_and_b32 v155, 0xffff0000, v205
    v_lshlrev_b32_e64 v156, 16, v206
    v_and_b32 v157, 0xffff0000, v206
    v_lshlrev_b32_e64 v158, 16, v207
    v_and_b32 v159, 0xffff0000, v207
    v_lshlrev_b32_e64 v112, 16, v208
    v_and_b32 v113, 0xffff0000, v208
    v_lshlrev_b32_e64 v114, 16, v209
    v_and_b32 v115, 0xffff0000, v209
    v_lshlrev_b32_e64 v116, 16, v210
    v_and_b32 v117, 0xffff0000, v210
    v_lshlrev_b32_e64 v118, 16, v211
    v_and_b32 v119, 0xffff0000, v211
    v_pk_add_f32 v[120:121], v[112:113], v[114:115]
    v_pk_add_f32 v[122:123], v[116:117], v[118:119]
    v_pk_add_f32 v[120:121], v[120:121], v[122:123]
    v_add_f32_e64 v196, v120, v121
    s_barrier
    s_waitcnt vmcnt(12)
    v_max3_u32 v235, v176, v177, v178
    v_max3_u32 v235, v235, v179, v180
    v_max3_u32 v235, v235, v181, v182
    v_max3_u32 v235, v235, v183, v184
    v_max3_u32 v235, v235, v185, v186
    v_max3_u32 v235, v235, v187, v188
    v_max3_u32 v235, v235, v189, v190
    v_max_u32 v235, v235, v191
    v_cmp_eq_u32 vcc, -1, v235
    s_cbranch_vccnz kc_r3
kc_r3o:
    v_lshlrev_b32 v64, 16, v176
    v_and_b32 v65, 0xffff0000, v176
    v_lshlrev_b32_e64 v66, 16, v177
    v_and_b32 v67, 0xffff0000, v177
    v_pk_add_f32 v[32:33], v[32:33], v[64:65]
    v_pk_add_f32 v[34:35], v[34:35], v[66:67]
    v_lshlrev_b32_e64 v68, 16, v178
    v_and_b32 v69, 0xffff0000, v178
    v_lshlrev_b32_e64 v70, 16, v179
    v_and_b32 v71, 0xffff0000, v179
    v_pk_add_f32 v[36:37], v[36:37], v[68:69]
    v_pk_add_f32 v[38:39], v[38:39], v[70:71]
    v_lshlrev_b32_e64 v72, 16, v180
    v_and_b32 v73, 0xffff0000, v180
    v_lshlrev_b32_e64 v74, 16, v181
    v_and_b32 v75, 0xffff0000, v181
    v_pk_add_f32 v[40:41], v[40:41], v[72:73]
    v_pk_add_f32 v[42:43], v[42:43], v[74:75]
    v_lshlrev_b32_e64 v76, 16, v182
    v_and_b32 v77, 0xffff0000, v182
    v_lshlrev_b32_e64 v78, 16, v183
    v_and_b32 v79, 0xffff0000, v183
    v_pk_add_f32 v[44:45], v[44:45], v[76:77]
    v_pk_add_f32 v[46:47], v[46:47], v[78:79]
    v_lshlrev_b32_e64 v80, 16, v184
    v_and_b32 v81, 0xffff0000, v184
    v_lshlrev_b32_e64 v82, 16, v185
    v_and_b32 v83, 0xffff0000, v185
    v_pk_add_f32 v[48:49], v[48:49], v[80:81]
    v_pk_add_f32 v[50:51], v[50:51], v[82:83]
    v_lshlrev_b32_e64 v84, 16, v186
    v_and_b32 v85, 0xffff0000, v186
    v_lshlrev_b32_e64 v86, 16, v187
    v_and_b32 v87, 0xffff0000, v187
    v_pk_add_f32 v[52:53], v[52:53], v[84:85]
    v_pk_add_f32 v[54:55], v[54:55], v[86:87]
    v_lshlrev_b32_e64 v88, 16, v188
    v_and_b32 v89, 0xffff0000, v188
    v_lshlrev_b32_e64 v90, 16, v189
    v_and_b32 v91, 0xffff0000, v189
    v_pk_add_f32 v[56:57], v[56:57], v[88:89]
    v_pk_add_f32 v[58:59], v[58:59], v[90:91]
    v_lshlrev_b32_e64 v92, 16, v190
    v_and_b32 v93, 0xffff0000, v190
    v_lshlrev_b32_e64 v94, 16, v191
    v_and_b32 v95, 0xffff0000, v191
    v_pk_add_f32 v[60:61], v[60:61], v[92:93]
    v_pk_add_f32 v[62:63], v[62:63], v[94:95]
    s_waitcnt vmcnt(4)
    v_max3_u32 v235, v96, v97, v98
    v_max3_u32 v235, v235, v99, v100
    v_max3_u32 v235, v235, v101, v102
    v_max3_u32 v235, v235, v103, v104
    v_max3_u32 v235, v235, v105, v106
    v_max3_u32 v235, v235, v107, v108
    v_max3_u32 v235, v235, v109, v110
    v_max_u32 v235, v235, v111
    v_cmp_eq_u32 vcc, -1, v235
    s_cbranch_vccnz kc_r1
kc_r1o:
    v_lshlrev_b32_e64 v64, 16, v96
    v_and_b32 v65, 0xffff0000, v96
    v_lshlrev_b32_e64 v66, 16, v97
    v_and_b32 v67, 0xffff0000, v97
    v_pk_add_f32 v[32:33], v[32:33], v[64:65]
    v_pk_add_f32 v[34:35], v[34:35], v[66:67]
    v_lshlrev_b32_e64 v68, 16, v98
    v_and_b32 v69, 0xffff0000, v98
    v_lshlrev_b32_e64 v70, 16, v99
    v_and_b32 v71, 0xffff0000, v99
    v_pk_add_f32 v[36:37], v[36:37], v[68:69]
    v_pk_add_f32 v[38:39], v[38:39], v[70:71]
    v_lshlrev_b32_e64 v72, 16, v100
    v_and_b32 v73, 0xffff0000, v100
    v_lshlrev_b32_e64 v74, 16, v101
    v_and_b32 v75, 0xffff0000, v101
    v_pk_add_f32 v[40:41], v[40:41], v[72:73]
    v_pk_add_f32 v[42:43], v[42:43], v[74:75]
    v_lshlrev_b32_e64 v76, 16, v102
    v_and_b32 v77, 0xffff0000, v102
    v_lshlrev_b32_e64 v78, 16, v103
    v_and_b32 v79, 0xffff0000, v103
    v_pk_add_f32 v[44:45], v[44:45], v[76:77]
    v_pk_add_f32 v[46:47], v[46:47], v[78:79]
    v_lshlrev_b32_e64 v80, 16, v104
    v_and_b32 v81, 0xffff0000, v104
    v_lshlrev_b32_e64 v82, 16, v105
    v_and_b32 v83, 0xffff0000, v105
    v_pk_add_f32 v[48:49], v[48:49], v[80:81]
    v_pk_add_f32 v[50:51], v[50:51], v[82:83]
    v_lshlrev_b32_e64 v84, 16, v106
    v_and_b32 v85, 0xffff0000, v106
    v_lshlrev_b32_e64 v86, 16, v107
    v_and_b32 v87, 0xffff0000, v107
    v_pk_add_f32 v[52:53], v[52:53], v[84:85]
    v_pk_add_f32 v[54:55], v[54:55], v[86:87]
    v_lshlrev_b32_e64 v88, 16, v108
    v_and_b32 v89, 0xffff0000, v108
    v_lshlrev_b32_e64 v90, 16, v109
    v_and_b32 v91, 0xffff0000, v109
    v_pk_add_f32 v[56:57], v[56:57], v[88:89]
    v_pk_add_f32 v[58:59], v[58:59], v[90:91]
    v_lshlrev_b32_e64 v92, 16, v110
    v_and_b32 v93, 0xffff0000, v110
    v_lshlrev_b32_e64 v94, 16, v111
    v_and_b32 v95, 0xffff0000, v111
    v_pk_add_f32 v[60:61], v[60:61], v[92:93]
    v_pk_add_f32 v[62:63], v[62:63], v[94:95]
    s_waitcnt vmcnt(0)
    v_max3_u32 v235, v160, v161, v162
    v_max3_u32 v235, v235, v163, v164
    v_max3_u32 v235, v235, v165, v166
    v_max3_u32 v235, v235, v167, v168
    v_max3_u32 v235, v235, v169, v170
    v_max3_u32 v235, v235, v171, v172
    v_max3_u32 v235, v235, v173, v174
    v_max_u32 v235, v235, v175
    v_cmp_eq_u32 vcc, -1, v235
    s_cbranch_vccnz kc_r2
kc_r2o:
    v_lshlrev_b32_e64 v64, 16, v160
    v_and_b32 v65, 0xffff0000, v160
    v_lshlrev_b32_e64 v66, 16, v161
    v_and_b32 v67, 0xffff0000, v161
    v_pk_add_f32 v[32:33], v[32:33], v[64:65]
    v_pk_add_f32 v[34:35], v[34:35], v[66:67]
    v_cvt_pk_bf16_f32 v0, v32, v33
    v_cvt_pk_bf16_f32 v1, v34, v35
    ds_write_b64 v238, v[0:1] offset:0
    v_lshlrev_b32_e64 v68, 16, v162
    v_and_b32 v69, 0xffff0000, v162
    v_lshlrev_b32_e64 v70, 16, v163
    v_and_b32 v71, 0xffff0000, v163
    v_pk_add_f32 v[36:37], v[36:37], v[68:69]
    v_pk_add_f32 v[38:39], v[38:39], v[70:71]
    v_cvt_pk_bf16_f32 v2, v36, v37
    v_cvt_pk_bf16_f32 v3, v38, v39
    ds_write_b64 v238, v[2:3] offset:2304
    v_lshlrev_b32_e64 v72, 16, v164
    v_and_b32 v73, 0xffff0000, v164
    v_lshlrev_b32_e64 v74, 16, v165
    v_and_b32 v75, 0xffff0000, v165
    v_pk_add_f32 v[40:41], v[40:41], v[72:73]
    v_pk_add_f32 v[42:43], v[42:43], v[74:75]
    v_cvt_pk_bf16_f32 v4, v40, v41
    v_cvt_pk_bf16_f32 v5, v42, v43
    ds_write_b64 v238, v[4:5] offset:32
    v_lshlrev_b32_e64 v76, 16, v166
    v_and_b32 v77, 0xffff0000, v166
    v_lshlrev_b32_e64 v78, 16, v167
    v_and_b32 v79, 0xffff0000, v167
    v_pk_add_f32 v[44:45], v[44:45], v[76:77]
    v_pk_add_f32 v[46:47], v[46:47], v[78:79]
    v_cvt_pk_bf16_f32 v6, v44, v45
    v_cvt_pk_bf16_f32 v7, v46, v47
    ds_write_b64 v238, v[6:7] offset:2336
    v_lshlrev_b32_e64 v80, 16, v168
    v_and_b32 v81, 0xffff0000, v168
    v_lshlrev_b32_e64 v82, 16, v169
    v_and_b32 v83, 0xffff0000, v169
    v_pk_add_f32 v[48:49], v[48:49], v[80:81]
    v_pk_add_f32 v[50:51], v[50:51], v[82:83]
    v_cvt_pk_bf16_f32 v8, v48, v49
    v_cvt_pk_bf16_f32 v9, v50, v51
    ds_write_b64 v238, v[8:9] offset:64
    v_lshlrev_b32_e64 v84, 16, v170
    v_and_b32 v85, 0xffff0000, v170
    v_lshlrev_b32_e64 v86, 16, v171
    v_and_b32 v87, 0xffff0000, v171
    v_pk_add_f32 v[52:53], v[52:53], v[84:85]
    v_pk_add_f32 v[54:55], v[54:55], v[86:87]
    v_cvt_pk_bf16_f32 v10, v52, v53
    v_cvt_pk_bf16_f32 v11, v54, v55
    ds_write_b64 v238, v[10:11] offset:2368
    v_lshlrev_b32_e64 v88, 16, v172
    v_and_b32 v89, 0xffff0000, v172
    v_lshlrev_b32_e64 v90, 16, v173
    v_and_b32 v91, 0xffff0000, v173
    v_pk_add_f32 v[56:57], v[56:57], v[88:89]
    v_pk_add_f32 v[58:59], v[58:59], v[90:91]
    v_cvt_pk_bf16_f32 v12, v56, v57
    v_cvt_pk_bf16_f32 v13, v58, v59
    ds_write_b64 v238, v[12:13] offset:96
    v_lshlrev_b32_e64 v92, 16, v174
    v_and_b32 v93, 0xffff0000, v174
    v_lshlrev_b32_e64 v94, 16, v175
    v_and_b32 v95, 0xffff0000, v175
    v_pk_add_f32 v[60:61], v[60:61], v[92:93]
    v_pk_add_f32 v[62:63], v[62:63], v[94:95]
    v_cvt_pk_bf16_f32 v14, v60, v61
    v_cvt_pk_bf16_f32 v15, v62, v63
    ds_write_b64 v238, v[14:15] offset:2400
    s_waitcnt lgkmcnt(0)
    ds_read_b128 v[16:19], v239 offset:0
    ds_read_b128 v[20:23], v239 offset:1152
    ds_read_b128 v[24:27], v239 offset:2304
    ds_read_b128 v[28:31], v239 offset:3456
    s_waitcnt lgkmcnt(3)
    v_lshlrev_b32 v64, 16, v16
    v_lshlrev_b32 v66, 16, v17
    v_lshlrev_b32 v68, 16, v18
    v_lshlrev_b32 v70, 16, v19
    v_and_b32 v65, 0xffff0000, v16
    v_and_b32 v67, 0xffff0000, v17
    v_and_b32 v69, 0xffff0000, v18
    v_and_b32 v71, 0xffff0000, v19
    v_pk_add_f32 v[64:65], v[64:65], v[128:129]
    v_pk_add_f32 v[66:67], v[66:67], v[130:131]
    v_pk_add_f32 v[68:69], v[68:69], v[132:133]
    v_pk_add_f32 v[70:71], v[70:71], v[134:135]
    v_cvt_pk_bf16_f32 v16, v64, v65
    v_cvt_pk_bf16_f32 v17, v66, v67
    v_cvt_pk_bf16_f32 v18, v68, v69
    v_cvt_pk_bf16_f32 v19, v70, v71
    v_lshlrev_b32 v64, 16, v16
    v_lshlrev_b32 v66, 16, v17
    v_lshlrev_b32 v68, 16, v18
    v_lshlrev_b32 v70, 16, v19
    v_and_b32 v65, 0xffff0000, v16
    v_and_b32 v67, 0xffff0000, v17
    v_and_b32 v69, 0xffff0000, v18
    v_and_b32 v71, 0xffff0000, v19
    s_mov_b32 s32, 0x3400000
    buffer_store_dwordx4 v[16:19], v229, s[8:11], s32 offen sc1
    v_pk_add_f32 v[160:161], v[64:65], v[66:67]
    v_pk_mul_f32 v[162:163], v[64:65], v[64:65]
    v_pk_mul_f32 v[164:165], v[64:65], v[112:113]
    v_pk_fma_f32 v[162:163], v[66:67], v[66:67], v[162:163]
    v_pk_fma_f32 v[164:165], v[66:67], v[114:115], v[164:165]
    v_pk_add_f32 v[160:161], v[160:161], v[68:69]
    v_pk_fma_f32 v[162:163], v[68:69], v[68:69], v[162:163]
    v_pk_fma_f32 v[164:165], v[68:69], v[116:117], v[164:165]
    v_pk_add_f32 v[160:161], v[160:161], v[70:71]
    v_pk_fma_f32 v[162:163], v[70:71], v[70:71], v[162:163]
    v_pk_fma_f32 v[164:165], v[70:71], v[118:119], v[164:165]
    v_add_f32 v184, v160, v161
    v_add_f32 v185, v162, v163
    v_add_f32 v186, v164, v165
    s_waitcnt lgkmcnt(2)
    v_lshlrev_b32 v72, 16, v20
    v_lshlrev_b32 v74, 16, v21
    v_lshlrev_b32 v76, 16, v22
    v_lshlrev_b32 v78, 16, v23
    v_and_b32 v73, 0xffff0000, v20
    v_and_b32 v75, 0xffff0000, v21
    v_and_b32 v77, 0xffff0000, v22
    v_and_b32 v79, 0xffff0000, v23
    v_pk_add_f32 v[72:73], v[72:73], v[136:137]
    v_pk_add_f32 v[74:75], v[74:75], v[138:139]
    v_pk_add_f32 v[76:77], v[76:77], v[140:141]
    v_pk_add_f32 v[78:79], v[78:79], v[142:143]
    v_cvt_pk_bf16_f32 v20, v72, v73
    v_cvt_pk_bf16_f32 v21, v74, v75
    v_cvt_pk_bf16_f32 v22, v76, v77
    v_cvt_pk_bf16_f32 v23, v78, v79
    v_lshlrev_b32 v72, 16, v20
    v_lshlrev_b32 v74, 16, v21
    v_lshlrev_b32 v76, 16, v22
    v_lshlrev_b32 v78, 16, v23
    v_and_b32 v73, 0xffff0000, v20
    v_and_b32 v75, 0xffff0000, v21
    v_and_b32 v77, 0xffff0000, v22
    v_and_b32 v79, 0xffff0000, v23
    s_mov_b32 s32, 0x3404000
    buffer_store_dwordx4 v[20:23], v229, s[8:11], s32 offen sc1
    v_pk_add_f32 v[166:167], v[72:73], v[74:75]
    v_pk_mul_f32 v[168:169], v[72:73], v[72:73]
    v_pk_mul_f32 v[170:171], v[72:73], v[112:113]
    v_pk_fma_f32 v[168:169], v[74:75], v[74:75], v[168:169]
    v_pk_fma_f32 v[170:171], v[74:75], v[114:115], v[170:171]
    v_pk_add_f32 v[166:167], v[166:167], v[76:77]
    v_pk_fma_f32 v[168:169], v[76:77], v[76:77], v[168:169]
    v_pk_fma_f32 v[170:171], v[76:77], v[116:117], v[170:171]
    v_pk_add_f32 v[166:167], v[166:167], v[78:79]
    v_pk_fma_f32 v[168:169], v[78:79], v[78:79], v[168:169]
    v_pk_fma_f32 v[170:171], v[78:79], v[118:119], v[170:171]
    v_add_f32 v187, v166, v167
    v_add_f32 v188, v168, v169
    v_add_f32 v189, v170, v171
    s_waitcnt lgkmcnt(1)
    v_lshlrev_b32 v80, 16, v24
    v_lshlrev_b32 v82, 16, v25
    v_lshlrev_b32 v84, 16, v26
    v_lshlrev_b32 v86, 16, v27
    v_and_b32 v81, 0xffff0000, v24
    v_and_b32 v83, 0xffff0000, v25
    v_and_b32 v85, 0xffff0000, v26
    v_and_b32 v87, 0xffff0000, v27
    v_pk_add_f32 v[80:81], v[80:81], v[144:145]
    v_pk_add_f32 v[82:83], v[82:83], v[146:147]
    v_pk_add_f32 v[84:85], v[84:85], v[148:149]
    v_pk_add_f32 v[86:87], v[86:87], v[150:151]
    v_cvt_pk_bf16_f32 v24, v80, v81
    v_cvt_pk_bf16_f32 v25, v82, v83
    v_cvt_pk_bf16_f32 v26, v84, v85
    v_cvt_pk_bf16_f32 v27, v86, v87
    v_lshlrev_b32 v80, 16, v24
    v_lshlrev_b32 v82, 16, v25
    v_lshlrev_b32 v84, 16, v26
    v_lshlrev_b32 v86, 16, v27
    v_and_b32 v81, 0xffff0000, v24
    v_and_b32 v83, 0xffff0000, v25
    v_and_b32 v85, 0xffff0000, v26
    v_and_b32 v87, 0xffff0000, v27
    s_mov_b32 s32, 0x3408000
    buffer_store_dwordx4 v[24:27], v229, s[8:11], s32 offen sc1
    v_pk_add_f32 v[172:173], v[80:81], v[82:83]
    v_pk_mul_f32 v[174:175], v[80:81], v[80:81]
    v_pk_mul_f32 v[176:177], v[80:81], v[112:113]
    v_pk_fma_f32 v[174:175], v[82:83], v[82:83], v[174:175]
    v_pk_fma_f32 v[176:177], v[82:83], v[114:115], v[176:177]
    v_pk_add_f32 v[172:173], v[172:173], v[84:85]
    v_pk_fma_f32 v[174:175], v[84:85], v[84:85], v[174:175]
    v_pk_fma_f32 v[176:177], v[84:85], v[116:117], v[176:177]
    v_pk_add_f32 v[172:173], v[172:173], v[86:87]
    v_pk_fma_f32 v[174:175], v[86:87], v[86:87], v[174:175]
    v_pk_fma_f32 v[176:177], v[86:87], v[118:119], v[176:177]
    v_add_f32 v190, v172, v173
    v_add_f32 v191, v174, v175
    v_add_f32 v192, v176, v177
    s_waitcnt lgkmcnt(0)
    v_lshlrev_b32 v88, 16, v28
    v_lshlrev_b32 v90, 16, v29
    v_lshlrev_b32 v92, 16, v30
    v_lshlrev_b32 v94, 16, v31
    v_and_b32 v89, 0xffff0000, v28
    v_and_b32 v91, 0xffff0000, v29
    v_and_b32 v93, 0xffff0000, v30
    v_and_b32 v95, 0xffff0000, v31
    v_pk_add_f32 v[88:89], v[88:89], v[152:153]
    v_pk_add_f32 v[90:91], v[90:91], v[154:155]
    v_pk_add_f32 v[92:93], v[92:93], v[156:157]
    v_pk_add_f32 v[94:95], v[94:95], v[158:159]
    v_cvt_pk_bf16_f32 v28, v88, v89
    v_cvt_pk_bf16_f32 v29, v90, v91
    v_cvt_pk_bf16_f32 v30, v92, v93
    v_cvt_pk_bf16_f32 v31, v94, v95
    v_lshlrev_b32 v88, 16, v28
    v_lshlrev_b32 v90, 16, v29
    v_lshlrev_b32 v92, 16, v30
    v_lshlrev_b32 v94, 16, v31
    v_and_b32 v89, 0xffff0000, v28
    v_and_b32 v91, 0xffff0000, v29
    v_and_b32 v93, 0xffff0000, v30
    v_and_b32 v95, 0xffff0000, v31
    s_mov_b32 s32, 0x340c000
    buffer_store_dwordx4 v[28:31], v229, s[8:11], s32 offen sc1
    v_pk_add_f32 v[178:179], v[88:89], v[90:91]
    v_pk_mul_f32 v[180:181], v[88:89], v[88:89]
    v_pk_mul_f32 v[182:183], v[88:89], v[112:113]
    v_pk_fma_f32 v[180:181], v[90:91], v[90:91], v[180:181]
    v_pk_fma_f32 v[182:183], v[90:91], v[114:115], v[182:183]
    v_pk_add_f32 v[178:179], v[178:179], v[92:93]
    v_pk_fma_f32 v[180:181], v[92:93], v[92:93], v[180:181]
    v_pk_fma_f32 v[182:183], v[92:93], v[116:117], v[182:183]
    v_pk_add_f32 v[178:179], v[178:179], v[94:95]
    v_pk_fma_f32 v[180:181], v[94:95], v[94:95], v[180:181]
    v_pk_fma_f32 v[182:183], v[94:95], v[118:119], v[182:183]
    v_add_f32 v193, v178, v179
    v_add_f32 v194, v180, v181
    v_add_f32_e64 v195, v182, v183
    v_add_f32_dpp v196, v196, v196 quad_perm:[1,0,3,2] row_mask:0xf bank_mask:0xf
    v_add_f32_dpp v184, v184, v184 quad_perm:[1,0,3,2] row_mask:0xf bank_mask:0xf
    v_add_f32_dpp v185, v185, v185 quad_perm:[1,0,3,2] row_mask:0xf bank_mask:0xf
    v_add_f32_dpp v186, v186, v186 quad_perm:[1,0,3,2] row_mask:0xf bank_mask:0xf
    v_add_f32_dpp v187, v187, v187 quad_perm:[1,0,3,2] row_mask:0xf bank_mask:0xf
    v_add_f32_dpp v188, v188, v188 quad_perm:[1,0,3,2] row_mask:0xf bank_mask:0xf
    v_add_f32_dpp v189, v189, v189 quad_perm:[1,0,3,2] row_mask:0xf bank_mask:0xf
    v_add_f32_dpp v190, v190, v190 quad_perm:[1,0,3,2] row_mask:0xf bank_mask:0xf
    v_add_f32_dpp v191, v191, v191 quad_perm:[1,0,3,2] row_mask:0xf bank_mask:0xf
    v_add_f32_dpp v192, v192, v192 quad_perm:[1,0,3,2] row_mask:0xf bank_mask:0xf
    v_add_f32_dpp v193, v193, v193 quad_perm:[1,0,3,2] row_mask:0xf bank_mask:0xf
    v_add_f32_dpp v194, v194, v194 quad_perm:[1,0,3,2] row_mask:0xf bank_mask:0xf
    v_add_f32_dpp v195, v195, v195 quad_perm:[1,0,3,2] row_mask:0xf bank_mask:0xf
    v_add_f32_dpp v196, v196, v196 quad_perm:[2,3,0,1] row_mask:0xf bank_mask:0xf
    v_add_f32_dpp v184, v184, v184 quad_perm:[2,3,0,1] row_mask:0xf bank_mask:0xf
    v_add_f32_dpp v185, v185, v185 quad_perm:[2,3,0,1] row_mask:0xf bank_mask:0xf
    v_add_f32_dpp v186, v186, v186 quad_perm:[2,3,0,1] row_mask:0xf bank_mask:0xf
    v_add_f32_dpp v187, v187, v187 quad_perm:[2,3,0,1] row_mask:0xf bank_mask:0xf
    v_add_f32_dpp v188, v188, v188 quad_perm:[2,3,0,1] row_mask:0xf bank_mask:0xf
    v_add_f32_dpp v189, v189, v189 quad_perm:[2,3,0,1] row_mask:0xf bank_mask:0xf
    v_add_f32_dpp v190, v190, v190 quad_perm:[2,3,0,1] row_mask:0xf bank_mask:0xf
    v_add_f32_dpp v191, v191, v191 quad_perm:[2,3,0,1] row_mask:0xf bank_mask:0xf
    v_add_f32_dpp v192, v192, v192 quad_perm:[2,3,0,1] row_mask:0xf bank_mask:0xf
    v_add_f32_dpp v193, v193, v193 quad_perm:[2,3,0,1] row_mask:0xf bank_mask:0xf
    v_add_f32_dpp v194, v194, v194 quad_perm:[2,3,0,1] row_mask:0xf bank_mask:0xf
    v_add_f32_dpp v195, v195, v195 quad_perm:[2,3,0,1] row_mask:0xf bank_mask:0xf
    v_add_f32_dpp v196, v196, v196 row_half_mirror row_mask:0xf bank_mask:0xf
    v_add_f32_dpp v184, v184, v184 row_half_mirror row_mask:0xf bank_mask:0xf
    v_add_f32_dpp v185, v185, v185 row_half_mirror row_mask:0xf bank_mask:0xf
    v_add_f32_dpp v186, v186, v186 row_half_mirror row_mask:0xf bank_mask:0xf
    v_add_f32_dpp v187, v187, v187 row_half_mirror row_mask:0xf bank_mask:0xf
    v_add_f32_dpp v188, v188, v188 row_half_mirror row_mask:0xf bank_mask:0xf
    v_add_f32_dpp v189, v189, v189 row_half_mirror row_mask:0xf bank_mask:0xf
    v_add_f32_dpp v190, v190, v190 row_half_mirror row_mask:0xf bank_mask:0xf
    v_add_f32_dpp v191, v191, v191 row_half_mirror row_mask:0xf bank_mask:0xf
    v_add_f32_dpp v192, v192, v192 row_half_mirror row_mask:0xf bank_mask:0xf
    v_add_f32_dpp v193, v193, v193 row_half_mirror row_mask:0xf bank_mask:0xf
    v_add_f32_dpp v194, v194, v194 row_half_mirror row_mask:0xf bank_mask:0xf
    v_add_f32_dpp v195, v195, v195 row_half_mirror row_mask:0xf bank_mask:0xf
    v_cndmask_b32 v184, v184, v187, s[60:61]
    v_cndmask_b32 v190, v190, v193, s[60:61]
    v_cndmask_b32 v185, v185, v188, s[60:61]
    v_cndmask_b32 v191, v191, v194, s[60:61]
    v_cndmask_b32 v186, v186, v189, s[60:61]
    v_cndmask_b32 v192, v192, v195, s[60:61]
    v_cndmask_b32 v184, v184, v190, s[62:63]
    v_cndmask_b32 v185, v185, v191, s[62:63]
    v_cndmask_b32 v186, v186, v192, s[62:63]
    v_cndmask_b32 v184, v184, v185, s[40:41]
    v_cndmask_b32 v186, v186, v196, s[40:41]
    buffer_atomic_add_f32 v184, v231, s[8:11], s48 offen
    buffer_atomic_add_f32 v186, v232, s[8:11], s48 offen
    s_lshl_b32 s32, s3, 13
    v_add_u32 v234, s32, v228
    v_add_u32 v235, 65536, v234
    ds_write_b128 v234, a[128:131] offset:0
    ds_write_b128 v234, a[132:135] offset:1024
    ds_write_b128 v234, a[136:139] offset:2048
    ds_write_b128 v234, a[140:143] offset:3072
    ds_write_b128 v234, a[144:147] offset:4096
    ds_write_b128 v234, a[148:151] offset:5120
    ds_write_b128 v234, a[152:155] offset:6144
    ds_write_b128 v234, a[156:159] offset:7168
    s_waitcnt lgkmcnt(4)
    ds_write_b128 v234, a[160:163] offset:32768
    ds_write_b128 v234, a[164:167] offset:33792
    ds_write_b128 v234, a[168:171] offset:34816
    ds_write_b128 v234, a[172:175] offset:35840
    ds_write_b128 v234, a[176:179] offset:36864
    ds_write_b128 v234, a[180:183] offset:37888
    ds_write_b128 v234, a[184:187] offset:38912
    ds_write_b128 v234, a[188:191] offset:39936
    s_waitcnt lgkmcnt(4)
    ds_write_b128 v235, a[192:195] offset:0
    ds_write_b128 v235, a[196:199] offset:1024
    ds_write_b128 v235, a[200:203] offset:2048
    ds_write_b128 v235, a[204:207] offset:3072
    ds_write_b128 v235, a[208:211] offset:4096
    ds_write_b128 v235, a[212:215] offset:5120
    ds_write_b128 v235, a[216:219] offset:6144
    ds_write_b128 v235, a[220:223] offset:7168
    s_waitcnt lgkmcnt(4)
    s_lshl_b32 s35, s3, 13
    v_bfe_u32 v234, v237, 2, 3
    v_lshrrev_b32_e64 v235, 5, v237
    v_lshl_add_u32 v234, v235, 4, v234
    v_lshlrev_b32 v234, 5, v234
    v_and_b32 v236, 3, v237
    v_lshl_add_u32 v234, v236, 3, v234
    v_add_u32 v217, s35, v234
    v_lshlrev_b32 v235, 5, v235
    v_bfe_u32 v236, v237, 4, 1
    v_lshl_add_u32 v235, v236, 3, v235
    v_and_b32_e64 v236, 1, v237
    v_lshl_add_u32 v235, v236, 11, v235
    s_lshl_b32 s32, s3, 9
    s_add_u32 s32, s32, 98304
    v_add_u32 v218, s32, v235
    v_lshlrev_b32_e64 v234, 4, v230
    v_add_u32 v220, 106752, v234
    v_add_u32 v221, 106752, v228
    v_lshrrev_b32 v236, 2, v237
    v_lshlrev_b32 v236, 7, v236
    v_and_b32_e64 v234, 3, v237
    v_lshl_add_u32 v236, v234, 3, v236
    s_add_u32 s32, s35, 65536
    v_add_u32 v219, s32, v236
    s_lshl_b32 s32, s3, 12
    s_add_u32 s32, s32, 114944
    v_and_b32 v234, 15, v237
    v_min_u32 v234, 2, v234
    v_lshlrev_b32 v234, 10, v234
    v_lshrrev_b32 v235, 4, v237
    v_lshl_add_u32 v234, v235, 4, v234
    v_add_u32 v222, s32, v234
    v_add_u32 v223, s32, v228
    s_mov_b32 s12, 0x00030003
    s_mov_b32 s13, 0x00030003
    s_lshl_b64 s[14:15], s[12:13], 2
    s_lshl_b64 s[16:17], s[12:13], 4
    s_lshl_b64 s[18:19], s[12:13], 6
    s_lshl_b64 s[20:21], s[12:13], 8
    s_lshl_b64 s[22:23], s[12:13], 10
    s_lshl_b64 s[24:25], s[12:13], 12
    s_lshl_b64 s[26:27], s[12:13], 14
    v_and_b32 v234, 1, v237
    v_lshlrev_b32_e64 v234, 12, v234
    v_bfe_u32 v235, v237, 1, 3
    v_lshl_add_u32 v234, v235, 6, v234
    v_lshrrev_b32_e64 v235, 4, v237
    v_lshl_add_u32 v222, v235, 4, v234
    s_lshl_b32 s38, s54, 13
    s_lshl_b32 s33, s3, 10
    s_add_u32 s38, s38, s33
    s_add_u32 s38, s38, 0x3900000
    s_waitcnt vmcnt(0)
    s_barrier
    s_cmp_lg_u32 s3, 0
    s_cbranch_scc1 kc_a1
    s_lshl_b32 s32, s52, 7
    s_add_u32 s32, s32, 0x38a0000
    v_mov_b32_e64 v235, 1
    buffer_atomic_add v235, v243, s[8:11], s32 offen sc0 sc1
    v_lshlrev_b32 v234, 7, v237
    v_cmp_gt_u32 vcc, 8, v237
    v_mov_b32_e64 v236, 0x40000000
    s_mov_b32 s34, 0x38a0400
    v_cndmask_b32 v234, v236, v234, vcc
    s_waitcnt vmcnt(0)
    v_readfirstlane_b32 s36, v235
    s_cmp_lg_u32 s36, 31
    s_cbranch_scc1 kc_a1
    buffer_atomic_add v233, v234, s[8:11], s34 offen sc1
kc_a1:
    s_waitcnt lgkmcnt(0)
    ds_read_b64_tr_b16 a[0:1], v217 offset:0
    ds_read_b64_tr_b16 a[2:3], v217 offset:256
    ds_read_b64_tr_b16 a[32:33], v217 offset:32768
    ds_read_b64_tr_b16 a[34:35], v217 offset:33024
    ds_read_b64_tr_b16 a[4:5], v217 offset:1024
    ds_read_b64_tr_b16 a[6:7], v217 offset:1280
    ds_read_b64_tr_b16 a[36:37], v217 offset:33792
    ds_read_b64_tr_b16 a[38:39], v217 offset:34048
    s_waitcnt lgkmcnt(6)
    ds_read_b64_tr_b16 a[8:9], v217 offset:2048
    ds_read_b64_tr_b16 a[10:11], v217 offset:2304
    ds_read_b64_tr_b16 a[40:41], v217 offset:34816
    ds_read_b64_tr_b16 a[42:43], v217 offset:35072
    ds_read_b64_tr_b16 a[12:13], v217 offset:3072
    ds_read_b64_tr_b16 a[14:15], v217 offset:3328
    ds_read_b64_tr_b16 a[44:45], v217 offset:35840
    ds_read_b64_tr_b16 a[46:47], v217 offset:36096
    s_waitcnt lgkmcnt(6)
    ds_read_b64_tr_b16 a[16:17], v217 offset:4096
    ds_read_b64_tr_b16 a[18:19], v217 offset:4352
    ds_read_b64_tr_b16 a[48:49], v217 offset:36864
    ds_read_b64_tr_b16 a[50:51], v217 offset:37120
    ds_read_b64_tr_b16 a[20:21], v217 offset:5120
    ds_read_b64_tr_b16 a[22:23], v217 offset:5376
    ds_read_b64_tr_b16 a[52:53], v217 offset:37888
    ds_read_b64_tr_b16 a[54:55], v217 offset:38144
    s_waitcnt lgkmcnt(6)
    ds_read_b64_tr_b16 a[24:25], v217 offset:6144
    ds_read_b64_tr_b16 a[26:27], v217 offset:6400
    ds_read_b64_tr_b16 a[56:57], v217 offset:38912
    ds_read_b64_tr_b16 a[58:59], v217 offset:39168
    ds_read_b64_tr_b16 a[28:29], v217 offset:7168
    ds_read_b64_tr_b16 a[30:31], v217 offset:7424
    ds_read_b64_tr_b16 a[60:61], v217 offset:39936
    ds_read_b64_tr_b16 a[62:63], v217 offset:40192
    s_waitcnt lgkmcnt(6)
    ds_read_b64_tr_b16 a[64:65], v219 offset:0
    ds_read_b64_tr_b16 a[66:67], v219 offset:32
    ds_read_b64_tr_b16 a[68:69], v219 offset:64
    ds_read_b64_tr_b16 a[70:71], v219 offset:96
    ds_read_b64_tr_b16 a[72:73], v219 offset:2048
    ds_read_b64_tr_b16 a[74:75], v219 offset:2080
    ds_read_b64_tr_b16 a[76:77], v219 offset:2112
    ds_read_b64_tr_b16 a[78:79], v219 offset:2144
    s_waitcnt lgkmcnt(6)
    ds_read_b64_tr_b16 a[80:81], v219 offset:4096
    ds_read_b64_tr_b16 a[82:83], v219 offset:4128
    ds_read_b64_tr_b16 a[84:85], v219 offset:4160
    ds_read_b64_tr_b16 a[86:87], v219 offset:4192
    ds_read_b64_tr_b16 a[88:89], v219 offset:6144
    ds_read_b64_tr_b16 a[90:91], v219 offset:6176
    ds_read_b64_tr_b16 a[92:93], v219 offset:6208
    ds_read_b64_tr_b16 a[94:95], v219 offset:6240
    s_waitcnt lgkmcnt(6)
    v_mov_b32 v130, 0x3a800000
    v_mov_b32 v131, 0x3a800000
    v_mov_b32 v132, 0x3727c5ac
    v_mov_b32 v133, 0x3727c5ac
    s_mov_b32 s33, 0xfffff800
    s_lshl_b32 s39, s3, 11
    v_add_u32 v238, s39, v228
    v_lshlrev_b32 v239, 2, v242
    s_lshl_b32 s39, s3, 3
    s_add_u32 s7, s39, 106512
    v_lshlrev_b32 v141, 5, v237
    v_or_b32_e64 v141, s39, v141
    s_cmp_lg_u32 s3, 0
    s_cbranch_scc1 kc_b12
    s_lshl_b32 s32, s52, 7
    s_add_u32 s32, s32, 0x38a0400
    s_mov_b32 s34, 0x100000
    s_branch kc_b11
kc_b10:
    s_sleep 2
kc_b11:
    buffer_load_dword v235, off, s[8:11], s32 sc1
    s_waitcnt vmcnt(0)
    v_cmp_ne_u32 vcc, 8, v235
    s_sub_u32 s34, s34, 1
    s_cbranch_scc1 kc_b12
    s_cbranch_vccnz kc_b10
kc_b12:
    s_barrier
    s_add_u32 s32, s48, 24576
    buffer_load_dword v128, off, s[8:11], s32 sc1
    buffer_load_dwordx4 v[32:35], v238, s[8:11], s48 offen offset:0 sc1
    buffer_load_dwordx4 v[40:43], v238, s[8:11], s49 offen offset:0 sc1
    buffer_load_dwordx4 v[48:51], v238, s[8:11], s50 offen offset:0 sc1
    buffer_load_dwordx4 v[36:39], v238, s[8:11], s48 offen offset:1024 sc1
    buffer_load_dwordx4 v[44:47], v238, s[8:11], s49 offen offset:1024 sc1
    buffer_load_dwordx4 v[52:55], v238, s[8:11], s50 offen offset:1024 sc1
    buffer_load_dword v0, v239, s[8:11], s48 offen offset:0 sc1
    buffer_load_dword v4, v239, s[8:11], s49 offen offset:0 sc1
    buffer_load_dword v1, v239, s[8:11], s48 offen offset:32 sc1
    buffer_load_dword v5, v239, s[8:11], s49 offen offset:32 sc1
    buffer_load_dword v2, v239, s[8:11], s48 offen offset:64 sc1
    buffer_load_dword v6, v239, s[8:11], s49 offen offset:64 sc1
    buffer_load_dword v3, v239, s[8:11], s48 offen offset:96 sc1
    buffer_load_dword v7, v239, s[8:11], s49 offen offset:96 sc1
    s_waitcnt vmcnt(8)
    v_mov_b32 v129, v128
    v_pk_mul_f32 v[32:33], v[32:33], v[130:131]
    v_pk_mul_f32 v[34:35], v[34:35], v[130:131]
    v_pk_mul_f32 v[36:37], v[36:37], v[130:131]
    v_pk_mul_f32 v[38:39], v[38:39], v[130:131]
    v_pk_fma_f32 v[40:41], v[40:41], v[130:131], v[132:133]
    v_pk_fma_f32 v[42:43], v[42:43], v[130:131], v[132:133]
    v_pk_fma_f32 v[44:45], v[44:45], v[130:131], v[132:133]
    v_pk_fma_f32 v[46:47], v[46:47], v[130:131], v[132:133]
    v_pk_fma_f32 v[40:41], v[32:33], v[32:33], v[40:41] neg_lo:[1,0,0] neg_hi:[1,0,0]
    v_pk_fma_f32 v[42:43], v[34:35], v[34:35], v[42:43] neg_lo:[1,0,0] neg_hi:[1,0,0]
    v_pk_fma_f32 v[44:45], v[36:37], v[36:37], v[44:45] neg_lo:[1,0,0] neg_hi:[1,0,0]
    v_pk_fma_f32 v[46:47], v[38:39], v[38:39], v[46:47] neg_lo:[1,0,0] neg_hi:[1,0,0]
    v_pk_fma_f32 v[48:49], v[32:33], v[128:129], v[48:49] neg_lo:[1,0,0] neg_hi:[1,0,0]
    v_pk_fma_f32 v[50:51], v[34:35], v[128:129], v[50:51] neg_lo:[1,0,0] neg_hi:[1,0,0]
    v_pk_fma_f32 v[52:53], v[36:37], v[128:129], v[52:53] neg_lo:[1,0,0] neg_hi:[1,0,0]
    v_pk_fma_f32 v[54:55], v[38:39], v[128:129], v[54:55] neg_lo:[1,0,0] neg_hi:[1,0,0]
    v_max_f32 v40, v40, v132
    v_max_f32 v42, v42, v132
    v_max_f32 v44, v44, v132
    v_max_f32 v46, v46, v132
    v_max_f32 v41, v41, v132
    v_max_f32 v43, v43, v132
    v_max_f32 v45, v45, v132
    v_max_f32 v47, v47, v132
    v_rsq_f32 v40, v40
    v_rsq_f32 v42, v42
    v_rsq_f32 v44, v44
    v_rsq_f32 v46, v46
    v_rsq_f32 v41, v41
    v_rsq_f32 v43, v43
    v_rsq_f32 v45, v45
    v_rsq_f32 v47, v47
    v_pk_mul_f32 v[48:49], v[48:49], v[40:41]
    v_pk_mul_f32 v[50:51], v[50:51], v[42:43]
    v_pk_mul_f32 v[52:53], v[52:53], v[44:45]
    v_pk_mul_f32 v[54:55], v[54:55], v[46:47]
    v_and_or_b32 v48, v48, s33, 0
    v_and_or_b32 v50, v50, s33, 2
    v_and_or_b32 v52, v52, s33, 4
    v_and_or_b32 v54, v54, s33, 6
    v_and_or_b32 v49, v49, s33, 1
    v_and_or_b32 v51, v51, s33, 3
    v_and_or_b32 v53, v53, s33, 5
    v_and_or_b32 v55, v55, s33, 7
    v_max_f32 v136, v48, v49
    v_min_f32 v137, v48, v49
    v_med3_f32 v137, v136, v50, v137
    v_max_f32_e64 v136, v136, v50
    v_med3_f32 v137, v136, v51, v137
    v_max_f32_e64 v136, v136, v51
    v_med3_f32 v137, v136, v52, v137
    v_max_f32_e64 v136, v136, v52
    v_med3_f32 v137, v136, v53, v137
    v_max_f32_e64 v136, v136, v53
    v_med3_f32 v137, v136, v54, v137
    v_max_f32_e64 v136, v136, v54
    v_med3_f32 v137, v136, v55, v137
    v_max_f32 v136, v136, v55
    v_or_b32 v136, v141, v136
    v_or_b32 v137, v141, v137
    s_nop 1
    v_mov_b32_dpp v138, v136 quad_perm:[1,0,3,2] row_mask:0xf bank_mask:0xf
    v_mov_b32_dpp v139, v137 quad_perm:[1,0,3,2] row_mask:0xf bank_mask:0xf
    v_min_f32 v140, v136, v138
    v_max_f32 v136, v136, v138
    v_max3_f32 v137, v140, v137, v139
    s_nop 1
    v_mov_b32_dpp v138, v136 quad_perm:[2,3,0,1] row_mask:0xf bank_mask:0xf
    v_mov_b32_dpp v139, v137 quad_perm:[2,3,0,1] row_mask:0xf bank_mask:0xf
    v_min_f32 v140, v136, v138
    v_max_f32_e64 v136, v136, v138
    v_max3_f32 v137, v140, v137, v139
    s_nop 1
    v_mov_b32_dpp v138, v136 row_half_mirror row_mask:0xf bank_mask:0xf
    v_mov_b32_dpp v139, v137 row_half_mirror row_mask:0xf bank_mask:0xf
    v_min_f32 v140, v136, v138
    v_max_f32_e64 v136, v136, v138
    v_max3_f32 v137, v140, v137, v139
    s_nop 1
    v_mov_b32_dpp v138, v136 row_mirror row_mask:0xf bank_mask:0xf
    v_mov_b32_dpp v139, v137 row_mirror row_mask:0xf bank_mask:0xf
    v_min_f32 v140, v136, v138
    v_max_f32_e64 v136, v136, v138
    v_max3_f32 v137, v140, v137, v139
    v_mov_b32 v138, v136
    v_mov_b32 v139, v137
    s_nop 1
    v_permlane16_swap_b32 v136, v138
    v_permlane16_swap_b32 v137, v139
    s_nop 0
    v_min_f32 v140, v136, v138
    v_max_f32 v136, v136, v138
    v_max3_f32 v137, v140, v137, v139
    v_mov_b32 v138, v136
    v_mov_b32 v139, v137
    s_nop 1
    v_permlane32_swap_b32 v136, v138
    v_permlane32_swap_b32 v137, v139
    s_nop 0
    v_min_f32 v140, v136, v138
    v_max_f32 v136, v136, v138
    v_max3_f32 v137, v140, v137, v139
    v_mov_b32_e64 v234, s7
    ds_write_b64 v234, v[136:137]
    v_mov_b32 v234, 106512
    s_waitcnt lgkmcnt(0)
    s_barrier
    ds_read_b128 v[56:59], v234
    ds_read_b128 v[60:63], v234 offset:16
    s_waitcnt lgkmcnt(0)
    v_min_f32 v140, v56, v58
    v_max_f32_e64 v56, v56, v58
    v_max3_f32 v57, v140, v57, v59
    v_min_f32 v140, v60, v62
    v_max_f32 v60, v60, v62
    v_max3_f32 v61, v140, v61, v63
    v_min_f32 v140, v56, v60
    v_max_f32 v56, v56, v60
    v_max3_f32 v57, v140, v57, v61
    v_bfe_u32 v234, v56, 5, 6
    v_bfe_u32 v235, v56, 2, 3
    v_and_b32_e64 v8, 3, v56
    v_lshl_add_u32 v8, v234, 2, v8
    v_lshl_add_u32 v8, v235, 8, v8
    v_bfe_u32 v234, v57, 5, 6
    v_bfe_u32 v235, v57, 2, 3
    v_and_b32_e64 v10, 3, v57
    v_lshl_add_u32 v10, v234, 2, v10
    v_lshl_add_u32 v10, v235, 8, v10
    s_cmp_lt_u32 s3, 2
    s_cselect_b64 vcc, -1, 0
    v_lshlrev_b32 v236, 4, v230
    v_cndmask_b32 v142, v10, v8, vcc
    v_lshlrev_b32_e64 v234, 2, v142
    v_and_b32 v235, 2047, v236
    v_lshl_add_u32 v235, v142, 11, v235
    s_mov_b32 s32, 0x3400000
    buffer_load_dwordx4 v[32:35], v235, s[8:11], s32 offen sc1
    buffer_load_dword v144, v234, s[8:11], s48 offen sc1
    buffer_load_dword v145, v234, s[8:11], s49 offen sc1
    buffer_load_dword v146, v234, s[8:11], s50 offen sc1
    v_add_u32 v236, 98304, v236
    s_lshr_b32 s32, s3, 1
    s_lshl_b32 s32, s32, 2
    s_add_u32 s32, s32, 106496
    v_mov_b32 v234, s32
    s_waitcnt vmcnt(4)
    v_mul_f32 v0, 0x3a800000, v0
    v_mul_f32 v1, 0x3a800000, v1
    v_mul_f32 v2, 0x3a800000, v2
    v_mul_f32 v3, 0x3a800000, v3
    v_mul_f32 v4, 0x3a800000, v4
    v_mul_f32 v5, 0x3a800000, v5
    v_mul_f32 v6, 0x3a800000, v6
    v_mul_f32 v7, 0x3a800000, v7
    v_fma_f32 v4, -v0, v0, v4
    v_fma_f32 v5, -v1, v1, v5
    v_fma_f32 v6, -v2, v2, v6
    v_fma_f32 v7, -v3, v3, v7
    v_max_f32 v4, 0, v4
    v_max_f32 v5, 0, v5
    v_max_f32 v6, 0, v6
    v_max_f32 v7, 0, v7
    v_cvt_pk_bf16_f32 v12, v0, v4
    v_cvt_pk_bf16_f32 v13, v1, v5
    v_cvt_pk_bf16_f32 v14, v2, v6
    v_cvt_pk_bf16_f32 v15, v3, v7
    v_lshlrev_b32 v0, 16, v12
    v_lshlrev_b32 v1, 16, v13
    v_lshlrev_b32 v2, 16, v14
    v_lshlrev_b32 v3, 16, v15
    v_and_b32 v4, 0xffff0000, v12
    v_and_b32 v5, 0xffff0000, v13
    v_and_b32 v6, 0xffff0000, v14
    v_and_b32 v7, 0xffff0000, v15
    v_add_f32 v4, 0x3727c5ac, v4
    v_add_f32 v5, 0x3727c5ac, v5
    v_add_f32 v6, 0x3727c5ac, v6
    v_add_f32 v7, 0x3727c5ac, v7
    v_cvt_pk_bf16_f32 v4, v4, v4
    v_cvt_pk_bf16_f32 v5, v5, v5
    v_cvt_pk_bf16_f32 v6, v6, v6
    v_cvt_pk_bf16_f32 v7, v7, v7
    v_lshlrev_b32 v4, 16, v4
    v_lshlrev_b32 v5, 16, v5
    v_lshlrev_b32 v6, 16, v6
    v_lshlrev_b32 v7, 16, v7
    v_sqrt_f32 v4, v4
    v_sqrt_f32 v5, v5
    v_sqrt_f32 v6, v6
    v_sqrt_f32 v7, v7
    v_cvt_pk_bf16_f32 v4, v4, v4
    v_cvt_pk_bf16_f32 v5, v5, v5
    v_cvt_pk_bf16_f32 v6, v6, v6
    v_cvt_pk_bf16_f32 v7, v7, v7
    v_lshlrev_b32 v4, 16, v4
    v_lshlrev_b32 v5, 16, v5
    v_lshlrev_b32 v6, 16, v6
    v_lshlrev_b32 v7, 16, v7
    v_rcp_f32 v4, v4
    v_rcp_f32 v5, v5
    v_rcp_f32 v6, v6
    v_rcp_f32_e64 v7, v7
    s_waitcnt vmcnt(0)
    v_mul_f32 v144, 0x3a800000, v144
    v_mul_f32 v145, 0x3a800000, v145
    v_fma_f32 v145, -v144, v144, v145
    v_max_f32_e64 v145, 0, v145
    v_cvt_pk_bf16_f32 v140, v144, v145
    v_lshlrev_b32_e64 v144, 16, v140
    v_and_b32 v145, 0xffff0000, v140
    v_add_f32 v145, 0x3727c5ac, v145
    v_cvt_pk_bf16_f32 v145, v145, v145
    v_lshlrev_b32_e64 v145, 16, v145
    v_sqrt_f32 v145, v145
    s_nop 0
    v_cvt_pk_bf16_f32 v145, v145, v145
    v_lshlrev_b32 v145, 16, v145
    v_rcp_f32 v145, v145
    s_nop 0
    v_lshlrev_b32 v64, 16, v32
    v_lshlrev_b32 v66, 16, v33
    v_lshlrev_b32 v68, 16, v34
    v_lshlrev_b32_e64 v70, 16, v35
    v_and_b32 v65, 0xffff0000, v32
    v_and_b32 v67, 0xffff0000, v33
    v_and_b32 v69, 0xffff0000, v34
    v_and_b32 v71, 0xffff0000, v35
    v_sub_f32 v64, v64, v144
    v_sub_f32 v66, v66, v144
    v_sub_f32 v68, v68, v144
    v_sub_f32 v70, v70, v144
    v_sub_f32 v65, v65, v144
    v_sub_f32 v67, v67, v144
    v_sub_f32 v69, v69, v144
    v_sub_f32 v71, v71, v144
    v_cvt_pk_bf16_f32 v65, v64, v65
    v_cvt_pk_bf16_f32 v67, v66, v67
    v_cvt_pk_bf16_f32 v69, v68, v69
    v_cvt_pk_bf16_f32 v71, v70, v71
    v_lshlrev_b32 v64, 16, v65
    v_lshlrev_b32 v66, 16, v67
    v_lshlrev_b32 v68, 16, v69
    v_lshlrev_b32 v70, 16, v71
    v_and_b32 v65, 0xffff0000, v65
    v_and_b32 v67, 0xffff0000, v67
    v_and_b32 v69, 0xffff0000, v69
    v_and_b32 v71, 0xffff0000, v71
    v_mul_f32 v64, v64, v145
    v_mul_f32 v66, v66, v145
    v_mul_f32 v68, v68, v145
    v_mul_f32 v70, v70, v145
    v_mul_f32 v65, v65, v145
    v_mul_f32 v67, v67, v145
    v_mul_f32 v69, v69, v145
    v_mul_f32 v71, v71, v145
    v_cvt_pk_bf16_f32 v48, v64, v65
    v_cvt_pk_bf16_f32 v49, v66, v67
    v_cvt_pk_bf16_f32 v50, v68, v69
    v_cvt_pk_bf16_f32 v51, v70, v71
    ds_write_b128 v236, v[48:51]
    ds_write_b128 v236, v[32:35] offset:4096
    v_fma_f32 v143, -v144, v128, v146
    v_mul_f32_e64 v143, v143, v145
    ds_write_b32 v234, v143
    s_waitcnt lgkmcnt(0)
kc_com:
    s_barrier
    s_cmp_ge_u32 s53, 28
    s_cbranch_scc1 kc_red
    ds_read_b64 v[96:97], v218 offset:0
    ds_read_b64 v[98:99], v218 offset:16
    ds_read_b64 v[100:101], v218 offset:64
    ds_read_b64 v[102:103], v218 offset:80
    ds_read_b64 v[104:105], v218 offset:128
    ds_read_b64 v[106:107], v218 offset:144
    ds_read_b64 v[108:109], v218 offset:192
    ds_read_b64 v[110:111], v218 offset:208
    ds_read_b64 v[112:113], v218 offset:256
    ds_read_b64 v[114:115], v218 offset:272
    ds_read_b64 v[116:117], v218 offset:320
    ds_read_b64 v[118:119], v218 offset:336
    ds_read_b64 v[120:121], v218 offset:384
    ds_read_b64 v[122:123], v218 offset:400
    s_waitcnt lgkmcnt(12)
    ds_read_b64 v[124:125], v218 offset:448
    ds_read_b64 v[126:127], v218 offset:464
    v_mfma_f32_16x16x32_bf16 v[128:131], a[0:3], v[96:99], 0
    v_mfma_f32_16x16x32_bf16 v[132:135], a[32:35], v[96:99], 0
    s_waitcnt lgkmcnt(12)
    v_mfma_f32_16x16x32_bf16 v[128:131], a[4:7], v[100:103], v[128:131]
    v_mfma_f32_16x16x32_bf16 v[132:135], a[36:39], v[100:103], v[132:135]
    s_waitcnt lgkmcnt(10)
    v_mfma_f32_16x16x32_bf16 v[128:131], a[8:11], v[104:107], v[128:131]
    v_mfma_f32_16x16x32_bf16 v[132:135], a[40:43], v[104:107], v[132:135]
    s_waitcnt lgkmcnt(8)
    v_mfma_f32_16x16x32_bf16 v[128:131], a[12:15], v[108:111], v[128:131]
    v_mfma_f32_16x16x32_bf16 v[132:135], a[44:47], v[108:111], v[132:135]
    s_waitcnt lgkmcnt(6)
    v_mfma_f32_16x16x32_bf16 v[128:131], a[16:19], v[112:115], v[128:131]
    v_mfma_f32_16x16x32_bf16 v[132:135], a[48:51], v[112:115], v[132:135]
    s_waitcnt lgkmcnt(4)
    v_mfma_f32_16x16x32_bf16 v[128:131], a[20:23], v[116:119], v[128:131]
    v_mfma_f32_16x16x32_bf16 v[132:135], a[52:55], v[116:119], v[132:135]
    s_waitcnt lgkmcnt(2)
    v_mfma_f32_16x16x32_bf16 v[128:131], a[24:27], v[120:123], v[128:131]
    v_mfma_f32_16x16x32_bf16 v[132:135], a[56:59], v[120:123], v[132:135]
    s_waitcnt lgkmcnt(0)
    v_mfma_f32_16x16x32_bf16 v[128:131], a[28:31], v[124:127], v[128:131]
    v_mfma_f32_16x16x32_bf16 v[132:135], a[60:63], v[124:127], v[132:135]
    s_nop 6
    ds_write_b128 v220, v[128:131]
    ds_write_b128 v220, v[132:135] offset:4096
    s_waitcnt lgkmcnt(0)
    s_barrier
    ds_read_b128 v[32:35], v221 offset:0
    ds_read_b128 v[48:51], v221 offset:4096
    ds_read_b128 v[36:39], v221 offset:1024
    ds_read_b128 v[52:55], v221 offset:5120
    ds_read_b128 v[40:43], v221 offset:2048
    ds_read_b128 v[56:59], v221 offset:6144
    ds_read_b128 v[44:47], v221 offset:3072
    ds_read_b128 v[60:63], v221 offset:7168
    s_waitcnt lgkmcnt(0)
    v_pk_add_f32 v[32:33], v[32:33], v[36:37]
    v_pk_add_f32 v[34:35], v[34:35], v[38:39]
    v_pk_add_f32 v[40:41], v[40:41], v[44:45]
    v_pk_add_f32 v[42:43], v[42:43], v[46:47]
    v_pk_add_f32 v[48:49], v[48:49], v[52:53]
    v_pk_add_f32 v[50:51], v[50:51], v[54:55]
    v_pk_add_f32 v[56:57], v[56:57], v[60:61]
    v_pk_add_f32 v[58:59], v[58:59], v[62:63]
    v_pk_add_f32 v[32:33], v[32:33], v[40:41]
    v_pk_add_f32 v[34:35], v[34:35], v[42:43]
    v_pk_add_f32 v[48:49], v[48:49], v[56:57]
    v_pk_add_f32 v[50:51], v[50:51], v[58:59]
    v_cvt_pk_bf16_f32 v48, v32, v48
    v_cvt_pk_bf16_f32 v49, v33, v49
    v_cvt_pk_bf16_f32 v50, v34, v50
    v_cvt_pk_bf16_f32 v51, v35, v51
    v_lshlrev_b32 v32, 16, v48
    v_lshlrev_b32 v33, 16, v49
    v_lshlrev_b32 v34, 16, v50
    v_lshlrev_b32 v35, 16, v51
    v_and_b32 v48, 0xffff0000, v48
    v_and_b32 v49, 0xffff0000, v49
    v_and_b32 v50, 0xffff0000, v50
    v_and_b32 v51, 0xffff0000, v51
    v_mul_f32 v136, 0xbfb8aa3b, v32
    v_mul_f32 v137, 0xbfb8aa3b, v33
    v_mul_f32 v138, 0xbfb8aa3b, v34
    v_mul_f32 v139, 0xbfb8aa3b, v35
    v_exp_f32 v136, v136
    v_exp_f32 v137, v137
    v_exp_f32 v138, v138
    v_exp_f32 v139, v139
    v_add_f32 v136, 1.0, v136
    v_add_f32 v137, 1.0, v137
    v_add_f32 v138, 1.0, v138
    v_add_f32 v139, 1.0, v139
    v_rcp_f32 v136, v136
    v_rcp_f32 v137, v137
    v_rcp_f32 v138, v138
    v_rcp_f32 v139, v139
    v_mul_f32 v32, v32, v136
    v_mul_f32 v33, v33, v137
    v_mul_f32 v34, v34, v138
    v_mul_f32 v35, v35, v139
    v_cvt_pk_bf16_f32 v32, v32, v32
    v_cvt_pk_bf16_f32 v33, v33, v33
    v_cvt_pk_bf16_f32 v34, v34, v34
    v_cvt_pk_bf16_f32 v35, v35, v35
    v_lshlrev_b32 v32, 16, v32
    v_lshlrev_b32 v33, 16, v33
    v_lshlrev_b32 v34, 16, v34
    v_lshlrev_b32 v35, 16, v35
    v_mul_f32 v32, v32, v48
    v_mul_f32 v33, v33, v49
    v_mul_f32 v34, v34, v50
    v_mul_f32 v35, v35, v51
    v_cvt_pk_bf16_f32 v128, v32, v33
    v_cvt_pk_bf16_f32 v129, v34, v35
    v_cndmask_b32 v64, 0, v128, s[12:13]
    v_cndmask_b32 v65, 0, v129, s[12:13]
    v_cndmask_b32 v66, 0, v128, s[14:15]
    v_cndmask_b32 v67, 0, v129, s[14:15]
    v_cndmask_b32 v68, 0, v128, s[16:17]
    v_cndmask_b32 v69, 0, v129, s[16:17]
    v_cndmask_b32 v70, 0, v128, s[18:19]
    v_cndmask_b32 v71, 0, v129, s[18:19]
    v_cndmask_b32 v72, 0, v128, s[20:21]
    v_cndmask_b32 v73, 0, v129, s[20:21]
    v_cndmask_b32 v74, 0, v128, s[22:23]
    v_cndmask_b32 v75, 0, v129, s[22:23]
    v_cndmask_b32 v76, 0, v128, s[24:25]
    v_cndmask_b32 v77, 0, v129, s[24:25]
    v_cndmask_b32 v78, 0, v128, s[26:27]
    v_cndmask_b32 v79, 0, v129, s[26:27]
    v_mfma_f32_16x16x32_bf16 v[32:35], a[64:67], v[64:67], 0
    v_mfma_f32_16x16x32_bf16 v[36:39], a[80:83], v[64:67], 0
    v_mfma_f32_16x16x32_bf16 v[32:35], a[68:71], v[68:71], v[32:35]
    v_mfma_f32_16x16x32_bf16 v[36:39], a[84:87], v[68:71], v[36:39]
    v_mfma_f32_16x16x32_bf16 v[32:35], a[72:75], v[72:75], v[32:35]
    v_mfma_f32_16x16x32_bf16 v[36:39], a[88:91], v[72:75], v[36:39]
    v_mfma_f32_16x16x32_bf16 v[32:35], a[76:79], v[76:79], v[32:35]
    v_mfma_f32_16x16x32_bf16 v[36:39], a[92:95], v[76:79], v[36:39]
    s_nop 6
    buffer_store_dwordx4 v[32:35], v222, s[8:11], s38 offen sc1
    buffer_store_dwordx4 v[36:39], v222, s[8:11], s38 offen offset:512 sc1
    v_lshlrev_b32 v144, 16, v16
    v_lshlrev_b32 v148, 16, v17
    v_lshlrev_b32 v152, 16, v18
    v_lshlrev_b32_e64 v156, 16, v19
    v_and_b32 v145, 0xffff0000, v16
    v_and_b32 v149, 0xffff0000, v17
    v_and_b32 v153, 0xffff0000, v18
    v_and_b32 v157, 0xffff0000, v19
    v_sub_f32 v144, v144, v0
    v_sub_f32 v148, v148, v0
    v_sub_f32 v152, v152, v0
    v_sub_f32 v156, v156, v0
    v_sub_f32 v145, v145, v0
    v_sub_f32 v149, v149, v0
    v_sub_f32 v153, v153, v0
    v_sub_f32 v157, v157, v0
    v_cvt_pk_bf16_f32 v145, v144, v145
    v_cvt_pk_bf16_f32 v149, v148, v149
    v_cvt_pk_bf16_f32 v153, v152, v153
    v_cvt_pk_bf16_f32 v157, v156, v157
    v_lshlrev_b32 v144, 16, v145
    v_lshlrev_b32 v148, 16, v149
    v_lshlrev_b32 v152, 16, v153
    v_lshlrev_b32 v156, 16, v157
    v_and_b32 v145, 0xffff0000, v145
    v_and_b32 v149, 0xffff0000, v149
    v_and_b32 v153, 0xffff0000, v153
    v_and_b32 v157, 0xffff0000, v157
    v_mul_f32 v144, v144, v4
    v_mul_f32 v148, v148, v4
    v_mul_f32 v152, v152, v4
    v_mul_f32 v156, v156, v4
    v_mul_f32 v145, v145, v4
    v_mul_f32 v149, v149, v4
    v_mul_f32 v153, v153, v4
    v_mul_f32 v157, v157, v4
    v_cvt_pk_bf16_f32 v146, v144, v145
    v_cvt_pk_bf16_f32 v150, v148, v149
    v_cvt_pk_bf16_f32 v154, v152, v153
    v_cvt_pk_bf16_f32 v158, v156, v157
    v_lshlrev_b32 v144, 16, v146
    v_lshlrev_b32 v148, 16, v150
    v_lshlrev_b32 v152, 16, v154
    v_lshlrev_b32 v156, 16, v158
    v_and_b32 v145, 0xffff0000, v146
    v_and_b32 v149, 0xffff0000, v150
    v_and_b32 v153, 0xffff0000, v154
    v_and_b32 v157, 0xffff0000, v158
    v_lshlrev_b32 v146, 16, v16
    v_lshlrev_b32 v150, 16, v17
    v_lshlrev_b32 v154, 16, v18
    v_lshlrev_b32 v158, 16, v19
    v_and_b32 v147, 0xffff0000, v16
    v_and_b32 v151, 0xffff0000, v17
    v_and_b32 v155, 0xffff0000, v18
    v_and_b32 v159, 0xffff0000, v19
    v_pk_add_f32 v[144:145], v[144:145], v[146:147]
    v_pk_add_f32 v[148:149], v[148:149], v[150:151]
    v_pk_add_f32 v[152:153], v[152:153], v[154:155]
    v_pk_add_f32 v[156:157], v[156:157], v[158:159]
    v_cvt_pk_bf16_f32 v16, v144, v145
    v_cvt_pk_bf16_f32 v17, v148, v149
    v_cvt_pk_bf16_f32 v18, v152, v153
    v_cvt_pk_bf16_f32 v19, v156, v157
    v_add_u32 v160, 0, v242
    v_cmp_eq_u32 vcc, v160, v8
    v_cmp_eq_u32 s[60:61], v160, v10
    v_mov_b32 v161, 0x40000000
    s_or_b64 vcc, vcc, s[60:61]
    v_cndmask_b32 v12, v229, v161, vcc
    s_waitcnt vmcnt(0)
    s_barrier
    s_cmp_lg_u32 s3, 0
    s_cbranch_scc1 kc_a2
    s_lshl_b32 s32, s52, 7
    s_add_u32 s32, s32, 0x38a0800
    v_mov_b32_e64 v235, 1
    buffer_atomic_add v235, v243, s[8:11], s32 offen sc0 sc1
    v_lshlrev_b32 v234, 7, v237
    v_cmp_gt_u32 vcc, 8, v237
    v_mov_b32_e64 v236, 0x40000000
    s_mov_b32 s34, 0x38a0c00
    v_cndmask_b32 v234, v236, v234, vcc
    s_waitcnt vmcnt(0)
    v_readfirstlane_b32 s36, v235
    s_cmp_lg_u32 s36, 27
    s_cbranch_scc1 kc_a2
    buffer_atomic_add v233, v234, s[8:11], s34 offen sc1
kc_a2:
    v_lshlrev_b32 v144, 16, v20
    v_lshlrev_b32 v148, 16, v21
    v_lshlrev_b32 v152, 16, v22
    v_lshlrev_b32_e64 v156, 16, v23
    v_and_b32 v145, 0xffff0000, v20
    v_and_b32 v149, 0xffff0000, v21
    v_and_b32 v153, 0xffff0000, v22
    v_and_b32 v157, 0xffff0000, v23
    v_sub_f32 v144, v144, v1
    v_sub_f32 v148, v148, v1
    v_sub_f32 v152, v152, v1
    v_sub_f32 v156, v156, v1
    v_sub_f32 v145, v145, v1
    v_sub_f32 v149, v149, v1
    v_sub_f32 v153, v153, v1
    v_sub_f32 v157, v157, v1
    v_cvt_pk_bf16_f32 v145, v144, v145
    v_cvt_pk_bf16_f32 v149, v148, v149
    v_cvt_pk_bf16_f32 v153, v152, v153
    v_cvt_pk_bf16_f32 v157, v156, v157
    v_lshlrev_b32 v144, 16, v145
    v_lshlrev_b32 v148, 16, v149
    v_lshlrev_b32 v152, 16, v153
    v_lshlrev_b32 v156, 16, v157
    v_and_b32 v145, 0xffff0000, v145
    v_and_b32 v149, 0xffff0000, v149
    v_and_b32 v153, 0xffff0000, v153
    v_and_b32 v157, 0xffff0000, v157
    v_mul_f32 v144, v144, v5
    v_mul_f32 v148, v148, v5
    v_mul_f32 v152, v152, v5
    v_mul_f32 v156, v156, v5
    v_mul_f32 v145, v145, v5
    v_mul_f32 v149, v149, v5
    v_mul_f32 v153, v153, v5
    v_mul_f32 v157, v157, v5
    v_cvt_pk_bf16_f32 v146, v144, v145
    v_cvt_pk_bf16_f32 v150, v148, v149
    v_cvt_pk_bf16_f32 v154, v152, v153
    v_cvt_pk_bf16_f32 v158, v156, v157
    v_lshlrev_b32 v144, 16, v146
    v_lshlrev_b32 v148, 16, v150
    v_lshlrev_b32 v152, 16, v154
    v_lshlrev_b32 v156, 16, v158
    v_and_b32 v145, 0xffff0000, v146
    v_and_b32 v149, 0xffff0000, v150
    v_and_b32 v153, 0xffff0000, v154
    v_and_b32 v157, 0xffff0000, v158
    v_lshlrev_b32 v146, 16, v20
    v_lshlrev_b32 v150, 16, v21
    v_lshlrev_b32 v154, 16, v22
    v_lshlrev_b32 v158, 16, v23
    v_and_b32 v147, 0xffff0000, v20
    v_and_b32 v151, 0xffff0000, v21
    v_and_b32 v155, 0xffff0000, v22
    v_and_b32 v159, 0xffff0000, v23
    v_pk_add_f32 v[144:145], v[144:145], v[146:147]
    v_pk_add_f32 v[148:149], v[148:149], v[150:151]
    v_pk_add_f32 v[152:153], v[152:153], v[154:155]
    v_pk_add_f32 v[156:157], v[156:157], v[158:159]
    v_cvt_pk_bf16_f32 v20, v144, v145
    v_cvt_pk_bf16_f32 v21, v148, v149
    v_cvt_pk_bf16_f32 v22, v152, v153
    v_cvt_pk_bf16_f32 v23, v156, v157
    v_add_u32 v160, 8, v242
    v_cmp_eq_u32 vcc, v160, v8
    v_cmp_eq_u32 s[60:61], v160, v10
    v_mov_b32 v161, 0x40000000
    s_or_b64 vcc, vcc, s[60:61]
    v_cndmask_b32 v13, v229, v161, vcc
    v_lshlrev_b32 v144, 16, v24
    v_lshlrev_b32 v148, 16, v25
    v_lshlrev_b32 v152, 16, v26
    v_lshlrev_b32_e64 v156, 16, v27
    v_and_b32 v145, 0xffff0000, v24
    v_and_b32 v149, 0xffff0000, v25
    v_and_b32 v153, 0xffff0000, v26
    v_and_b32 v157, 0xffff0000, v27
    v_sub_f32 v144, v144, v2
    v_sub_f32 v148, v148, v2
    v_sub_f32 v152, v152, v2
    v_sub_f32 v156, v156, v2
    v_sub_f32 v145, v145, v2
    v_sub_f32 v149, v149, v2
    v_sub_f32 v153, v153, v2
    v_sub_f32 v157, v157, v2
    v_cvt_pk_bf16_f32 v145, v144, v145
    v_cvt_pk_bf16_f32 v149, v148, v149
    v_cvt_pk_bf16_f32 v153, v152, v153
    v_cvt_pk_bf16_f32 v157, v156, v157
    v_lshlrev_b32 v144, 16, v145
    v_lshlrev_b32 v148, 16, v149
    v_lshlrev_b32 v152, 16, v153
    v_lshlrev_b32 v156, 16, v157
    v_and_b32 v145, 0xffff0000, v145
    v_and_b32 v149, 0xffff0000, v149
    v_and_b32 v153, 0xffff0000, v153
    v_and_b32 v157, 0xffff0000, v157
    v_mul_f32 v144, v144, v6
    v_mul_f32 v148, v148, v6
    v_mul_f32 v152, v152, v6
    v_mul_f32 v156, v156, v6
    v_mul_f32 v145, v145, v6
    v_mul_f32 v149, v149, v6
    v_mul_f32 v153, v153, v6
    v_mul_f32 v157, v157, v6
    v_cvt_pk_bf16_f32 v146, v144, v145
    v_cvt_pk_bf16_f32 v150, v148, v149
    v_cvt_pk_bf16_f32 v154, v152, v153
    v_cvt_pk_bf16_f32 v158, v156, v157
    v_lshlrev_b32 v144, 16, v146
    v_lshlrev_b32 v148, 16, v150
    v_lshlrev_b32 v152, 16, v154
    v_lshlrev_b32 v156, 16, v158
    v_and_b32 v145, 0xffff0000, v146
    v_and_b32 v149, 0xffff0000, v150
    v_and_b32 v153, 0xffff0000, v154
    v_and_b32 v157, 0xffff0000, v158
    v_lshlrev_b32 v146, 16, v24
    v_lshlrev_b32 v150, 16, v25
    v_lshlrev_b32 v154, 16, v26
    v_lshlrev_b32 v158, 16, v27
    v_and_b32 v147, 0xffff0000, v24
    v_and_b32 v151, 0xffff0000, v25
    v_and_b32 v155, 0xffff0000, v26
    v_and_b32 v159, 0xffff0000, v27
    v_pk_add_f32 v[144:145], v[144:145], v[146:147]
    v_pk_add_f32 v[148:149], v[148:149], v[150:151]
    v_pk_add_f32 v[152:153], v[152:153], v[154:155]
    v_pk_add_f32 v[156:157], v[156:157], v[158:159]
    v_cvt_pk_bf16_f32 v24, v144, v145
    v_cvt_pk_bf16_f32 v25, v148, v149
    v_cvt_pk_bf16_f32 v26, v152, v153
    v_cvt_pk_bf16_f32 v27, v156, v157
    v_add_u32 v160, 16, v242
    v_cmp_eq_u32 vcc, v160, v8
    v_cmp_eq_u32 s[60:61], v160, v10
    v_mov_b32 v161, 0x40000000
    s_or_b64 vcc, vcc, s[60:61]
    v_cndmask_b32 v14, v229, v161, vcc
    v_lshlrev_b32 v144, 16, v28
    v_lshlrev_b32 v148, 16, v29
    v_lshlrev_b32 v152, 16, v30
    v_lshlrev_b32_e64 v156, 16, v31
    v_and_b32 v145, 0xffff0000, v28
    v_and_b32 v149, 0xffff0000, v29
    v_and_b32 v153, 0xffff0000, v30
    v_and_b32 v157, 0xffff0000, v31
    v_sub_f32 v144, v144, v3
    v_sub_f32 v148, v148, v3
    v_sub_f32 v152, v152, v3
    v_sub_f32 v156, v156, v3
    v_sub_f32 v145, v145, v3
    v_sub_f32 v149, v149, v3
    v_sub_f32 v153, v153, v3
    v_sub_f32 v157, v157, v3
    v_cvt_pk_bf16_f32 v145, v144, v145
    v_cvt_pk_bf16_f32 v149, v148, v149
    v_cvt_pk_bf16_f32 v153, v152, v153
    v_cvt_pk_bf16_f32 v157, v156, v157
    v_lshlrev_b32 v144, 16, v145
    v_lshlrev_b32 v148, 16, v149
    v_lshlrev_b32 v152, 16, v153
    v_lshlrev_b32 v156, 16, v157
    v_and_b32 v145, 0xffff0000, v145
    v_and_b32 v149, 0xffff0000, v149
    v_and_b32 v153, 0xffff0000, v153
    v_and_b32 v157, 0xffff0000, v157
    v_mul_f32 v144, v144, v7
    v_mul_f32 v148, v148, v7
    v_mul_f32 v152, v152, v7
    v_mul_f32 v156, v156, v7
    v_mul_f32 v145, v145, v7
    v_mul_f32 v149, v149, v7
    v_mul_f32 v153, v153, v7
    v_mul_f32 v157, v157, v7
    v_cvt_pk_bf16_f32 v146, v144, v145
    v_cvt_pk_bf16_f32 v150, v148, v149
    v_cvt_pk_bf16_f32 v154, v152, v153
    v_cvt_pk_bf16_f32 v158, v156, v157
    v_lshlrev_b32 v144, 16, v146
    v_lshlrev_b32 v148, 16, v150
    v_lshlrev_b32 v152, 16, v154
    v_lshlrev_b32 v156, 16, v158
    v_and_b32 v145, 0xffff0000, v146
    v_and_b32 v149, 0xffff0000, v150
    v_and_b32 v153, 0xffff0000, v154
    v_and_b32 v157, 0xffff0000, v158
    v_lshlrev_b32 v146, 16, v28
    v_lshlrev_b32 v150, 16, v29
    v_lshlrev_b32 v154, 16, v30
    v_lshlrev_b32 v158, 16, v31
    v_and_b32 v147, 0xffff0000, v28
    v_and_b32 v151, 0xffff0000, v29
    v_and_b32 v155, 0xffff0000, v30
    v_and_b32 v159, 0xffff0000, v31
    v_pk_add_f32 v[144:145], v[144:145], v[146:147]
    v_pk_add_f32 v[148:149], v[148:149], v[150:151]
    v_pk_add_f32 v[152:153], v[152:153], v[154:155]
    v_pk_add_f32 v[156:157], v[156:157], v[158:159]
    v_cvt_pk_bf16_f32 v28, v144, v145
    v_cvt_pk_bf16_f32 v29, v148, v149
    v_cvt_pk_bf16_f32 v30, v152, v153
    v_cvt_pk_bf16_f32 v31, v156, v157
    v_add_u32 v160, 24, v242
    v_cmp_eq_u32 vcc, v160, v8
    v_cmp_eq_u32 s[60:61], v160, v10
    v_mov_b32 v161, 0x40000000
    s_or_b64 vcc, vcc, s[60:61]
    v_cndmask_b32 v15, v229, v161, vcc
    s_mov_b32 s32, 0
    buffer_store_dwordx4 v[16:19], v12, s[28:31], s32 offen nt
    s_mov_b32 s32, 16384
    buffer_store_dwordx4 v[20:23], v13, s[28:31], s32 offen nt
    s_mov_b32 s32, 32768
    buffer_store_dwordx4 v[24:27], v14, s[28:31], s32 offen nt
    s_mov_b32 s32, 49152
    buffer_store_dwordx4 v[28:31], v15, s[28:31], s32 offen nt
    s_branch kc_fin
kc_red:
    v_lshlrev_b32 v144, 16, v16
    v_lshlrev_b32 v148, 16, v17
    v_lshlrev_b32 v152, 16, v18
    v_lshlrev_b32_e64 v156, 16, v19
    v_and_b32 v145, 0xffff0000, v16
    v_and_b32 v149, 0xffff0000, v17
    v_and_b32 v153, 0xffff0000, v18
    v_and_b32 v157, 0xffff0000, v19
    v_sub_f32 v144, v144, v0
    v_sub_f32 v148, v148, v0
    v_sub_f32 v152, v152, v0
    v_sub_f32 v156, v156, v0
    v_sub_f32 v145, v145, v0
    v_sub_f32 v149, v149, v0
    v_sub_f32 v153, v153, v0
    v_sub_f32 v157, v157, v0
    v_cvt_pk_bf16_f32 v145, v144, v145
    v_cvt_pk_bf16_f32 v149, v148, v149
    v_cvt_pk_bf16_f32 v153, v152, v153
    v_cvt_pk_bf16_f32 v157, v156, v157
    v_lshlrev_b32 v144, 16, v145
    v_lshlrev_b32 v148, 16, v149
    v_lshlrev_b32 v152, 16, v153
    v_lshlrev_b32 v156, 16, v157
    v_and_b32 v145, 0xffff0000, v145
    v_and_b32 v149, 0xffff0000, v149
    v_and_b32 v153, 0xffff0000, v153
    v_and_b32 v157, 0xffff0000, v157
    v_mul_f32 v144, v144, v4
    v_mul_f32 v148, v148, v4
    v_mul_f32 v152, v152, v4
    v_mul_f32 v156, v156, v4
    v_mul_f32 v145, v145, v4
    v_mul_f32 v149, v149, v4
    v_mul_f32 v153, v153, v4
    v_mul_f32 v157, v157, v4
    v_cvt_pk_bf16_f32 v146, v144, v145
    v_cvt_pk_bf16_f32 v150, v148, v149
    v_cvt_pk_bf16_f32 v154, v152, v153
    v_cvt_pk_bf16_f32 v158, v156, v157
    v_lshlrev_b32 v144, 16, v146
    v_lshlrev_b32 v148, 16, v150
    v_lshlrev_b32 v152, 16, v154
    v_lshlrev_b32 v156, 16, v158
    v_and_b32 v145, 0xffff0000, v146
    v_and_b32 v149, 0xffff0000, v150
    v_and_b32 v153, 0xffff0000, v154
    v_and_b32 v157, 0xffff0000, v158
    v_lshlrev_b32 v146, 16, v16
    v_lshlrev_b32 v150, 16, v17
    v_lshlrev_b32 v154, 16, v18
    v_lshlrev_b32 v158, 16, v19
    v_and_b32 v147, 0xffff0000, v16
    v_and_b32 v151, 0xffff0000, v17
    v_and_b32 v155, 0xffff0000, v18
    v_and_b32 v159, 0xffff0000, v19
    v_pk_add_f32 v[144:145], v[144:145], v[146:147]
    v_pk_add_f32 v[148:149], v[148:149], v[150:151]
    v_pk_add_f32 v[152:153], v[152:153], v[154:155]
    v_pk_add_f32 v[156:157], v[156:157], v[158:159]
    v_cvt_pk_bf16_f32 v16, v144, v145
    v_cvt_pk_bf16_f32 v17, v148, v149
    v_cvt_pk_bf16_f32 v18, v152, v153
    v_cvt_pk_bf16_f32 v19, v156, v157
    v_add_u32 v160, 0, v242
    v_cmp_eq_u32 vcc, v160, v8
    v_cmp_eq_u32 s[60:61], v160, v10
    v_mov_b32 v161, 0x40000000
    s_or_b64 vcc, vcc, s[60:61]
    v_cndmask_b32 v12, v229, v161, vcc
    v_lshlrev_b32 v144, 16, v20
    v_lshlrev_b32 v148, 16, v21
    v_lshlrev_b32 v152, 16, v22
    v_lshlrev_b32_e64 v156, 16, v23
    v_and_b32 v145, 0xffff0000, v20
    v_and_b32 v149, 0xffff0000, v21
    v_and_b32 v153, 0xffff0000, v22
    v_and_b32 v157, 0xffff0000, v23
    v_sub_f32 v144, v144, v1
    v_sub_f32 v148, v148, v1
    v_sub_f32 v152, v152, v1
    v_sub_f32 v156, v156, v1
    v_sub_f32 v145, v145, v1
    v_sub_f32 v149, v149, v1
    v_sub_f32 v153, v153, v1
    v_sub_f32 v157, v157, v1
    v_cvt_pk_bf16_f32 v145, v144, v145
    v_cvt_pk_bf16_f32 v149, v148, v149
    v_cvt_pk_bf16_f32 v153, v152, v153
    v_cvt_pk_bf16_f32 v157, v156, v157
    v_lshlrev_b32 v144, 16, v145
    v_lshlrev_b32 v148, 16, v149
    v_lshlrev_b32 v152, 16, v153
    v_lshlrev_b32 v156, 16, v157
    v_and_b32 v145, 0xffff0000, v145
    v_and_b32 v149, 0xffff0000, v149
    v_and_b32 v153, 0xffff0000, v153
    v_and_b32 v157, 0xffff0000, v157
    v_mul_f32 v144, v144, v5
    v_mul_f32 v148, v148, v5
    v_mul_f32 v152, v152, v5
    v_mul_f32 v156, v156, v5
    v_mul_f32 v145, v145, v5
    v_mul_f32 v149, v149, v5
    v_mul_f32 v153, v153, v5
    v_mul_f32 v157, v157, v5
    v_cvt_pk_bf16_f32 v146, v144, v145
    v_cvt_pk_bf16_f32 v150, v148, v149
    v_cvt_pk_bf16_f32 v154, v152, v153
    v_cvt_pk_bf16_f32 v158, v156, v157
    v_lshlrev_b32 v144, 16, v146
    v_lshlrev_b32 v148, 16, v150
    v_lshlrev_b32 v152, 16, v154
    v_lshlrev_b32 v156, 16, v158
    v_and_b32 v145, 0xffff0000, v146
    v_and_b32 v149, 0xffff0000, v150
    v_and_b32 v153, 0xffff0000, v154
    v_and_b32 v157, 0xffff0000, v158
    v_lshlrev_b32 v146, 16, v20
    v_lshlrev_b32 v150, 16, v21
    v_lshlrev_b32 v154, 16, v22
    v_lshlrev_b32 v158, 16, v23
    v_and_b32 v147, 0xffff0000, v20
    v_and_b32 v151, 0xffff0000, v21
    v_and_b32 v155, 0xffff0000, v22
    v_and_b32 v159, 0xffff0000, v23
    v_pk_add_f32 v[144:145], v[144:145], v[146:147]
    v_pk_add_f32 v[148:149], v[148:149], v[150:151]
    v_pk_add_f32 v[152:153], v[152:153], v[154:155]
    v_pk_add_f32 v[156:157], v[156:157], v[158:159]
    v_cvt_pk_bf16_f32 v20, v144, v145
    v_cvt_pk_bf16_f32 v21, v148, v149
    v_cvt_pk_bf16_f32 v22, v152, v153
    v_cvt_pk_bf16_f32 v23, v156, v157
    v_add_u32 v160, 8, v242
    v_cmp_eq_u32 vcc, v160, v8
    v_cmp_eq_u32 s[60:61], v160, v10
    v_mov_b32 v161, 0x40000000
    s_or_b64 vcc, vcc, s[60:61]
    v_cndmask_b32 v13, v229, v161, vcc
    v_lshlrev_b32 v144, 16, v24
    v_lshlrev_b32 v148, 16, v25
    v_lshlrev_b32 v152, 16, v26
    v_lshlrev_b32_e64 v156, 16, v27
    v_and_b32 v145, 0xffff0000, v24
    v_and_b32 v149, 0xffff0000, v25
    v_and_b32 v153, 0xffff0000, v26
    v_and_b32 v157, 0xffff0000, v27
    v_sub_f32 v144, v144, v2
    v_sub_f32 v148, v148, v2
    v_sub_f32 v152, v152, v2
    v_sub_f32 v156, v156, v2
    v_sub_f32 v145, v145, v2
    v_sub_f32 v149, v149, v2
    v_sub_f32 v153, v153, v2
    v_sub_f32 v157, v157, v2
    v_cvt_pk_bf16_f32 v145, v144, v145
    v_cvt_pk_bf16_f32 v149, v148, v149
    v_cvt_pk_bf16_f32 v153, v152, v153
    v_cvt_pk_bf16_f32 v157, v156, v157
    v_lshlrev_b32 v144, 16, v145
    v_lshlrev_b32 v148, 16, v149
    v_lshlrev_b32 v152, 16, v153
    v_lshlrev_b32 v156, 16, v157
    v_and_b32 v145, 0xffff0000, v145
    v_and_b32 v149, 0xffff0000, v149
    v_and_b32 v153, 0xffff0000, v153
    v_and_b32 v157, 0xffff0000, v157
    v_mul_f32 v144, v144, v6
    v_mul_f32 v148, v148, v6
    v_mul_f32 v152, v152, v6
    v_mul_f32 v156, v156, v6
    v_mul_f32 v145, v145, v6
    v_mul_f32 v149, v149, v6
    v_mul_f32 v153, v153, v6
    v_mul_f32 v157, v157, v6
    v_cvt_pk_bf16_f32 v146, v144, v145
    v_cvt_pk_bf16_f32 v150, v148, v149
    v_cvt_pk_bf16_f32 v154, v152, v153
    v_cvt_pk_bf16_f32 v158, v156, v157
    v_lshlrev_b32 v144, 16, v146
    v_lshlrev_b32 v148, 16, v150
    v_lshlrev_b32 v152, 16, v154
    v_lshlrev_b32 v156, 16, v158
    v_and_b32 v145, 0xffff0000, v146
    v_and_b32 v149, 0xffff0000, v150
    v_and_b32 v153, 0xffff0000, v154
    v_and_b32 v157, 0xffff0000, v158
    v_lshlrev_b32 v146, 16, v24
    v_lshlrev_b32 v150, 16, v25
    v_lshlrev_b32 v154, 16, v26
    v_lshlrev_b32 v158, 16, v27
    v_and_b32 v147, 0xffff0000, v24
    v_and_b32 v151, 0xffff0000, v25
    v_and_b32 v155, 0xffff0000, v26
    v_and_b32 v159, 0xffff0000, v27
    v_pk_add_f32 v[144:145], v[144:145], v[146:147]
    v_pk_add_f32 v[148:149], v[148:149], v[150:151]
    v_pk_add_f32 v[152:153], v[152:153], v[154:155]
    v_pk_add_f32 v[156:157], v[156:157], v[158:159]
    v_cvt_pk_bf16_f32 v24, v144, v145
    v_cvt_pk_bf16_f32 v25, v148, v149
    v_cvt_pk_bf16_f32 v26, v152, v153
    v_cvt_pk_bf16_f32 v27, v156, v157
    v_add_u32 v160, 16, v242
    v_cmp_eq_u32 vcc, v160, v8
    v_cmp_eq_u32 s[60:61], v160, v10
    v_mov_b32 v161, 0x40000000
    s_or_b64 vcc, vcc, s[60:61]
    v_cndmask_b32 v14, v229, v161, vcc
    v_lshlrev_b32 v144, 16, v28
    v_lshlrev_b32 v148, 16, v29
    v_lshlrev_b32 v152, 16, v30
    v_lshlrev_b32_e64 v156, 16, v31
    v_and_b32 v145, 0xffff0000, v28
    v_and_b32 v149, 0xffff0000, v29
    v_and_b32 v153, 0xffff0000, v30
    v_and_b32 v157, 0xffff0000, v31
    v_sub_f32 v144, v144, v3
    v_sub_f32 v148, v148, v3
    v_sub_f32 v152, v152, v3
    v_sub_f32 v156, v156, v3
    v_sub_f32 v145, v145, v3
    v_sub_f32 v149, v149, v3
    v_sub_f32 v153, v153, v3
    v_sub_f32 v157, v157, v3
    v_cvt_pk_bf16_f32 v145, v144, v145
    v_cvt_pk_bf16_f32 v149, v148, v149
    v_cvt_pk_bf16_f32 v153, v152, v153
    v_cvt_pk_bf16_f32 v157, v156, v157
    v_lshlrev_b32 v144, 16, v145
    v_lshlrev_b32 v148, 16, v149
    v_lshlrev_b32 v152, 16, v153
    v_lshlrev_b32 v156, 16, v157
    v_and_b32 v145, 0xffff0000, v145
    v_and_b32 v149, 0xffff0000, v149
    v_and_b32 v153, 0xffff0000, v153
    v_and_b32 v157, 0xffff0000, v157
    v_mul_f32 v144, v144, v7
    v_mul_f32 v148, v148, v7
    v_mul_f32 v152, v152, v7
    v_mul_f32 v156, v156, v7
    v_mul_f32 v145, v145, v7
    v_mul_f32 v149, v149, v7
    v_mul_f32 v153, v153, v7
    v_mul_f32 v157, v157, v7
    v_cvt_pk_bf16_f32 v146, v144, v145
    v_cvt_pk_bf16_f32 v150, v148, v149
    v_cvt_pk_bf16_f32 v154, v152, v153
    v_cvt_pk_bf16_f32 v158, v156, v157
    v_lshlrev_b32 v144, 16, v146
    v_lshlrev_b32 v148, 16, v150
    v_lshlrev_b32 v152, 16, v154
    v_lshlrev_b32 v156, 16, v158
    v_and_b32 v145, 0xffff0000, v146
    v_and_b32 v149, 0xffff0000, v150
    v_and_b32 v153, 0xffff0000, v154
    v_and_b32 v157, 0xffff0000, v158
    v_lshlrev_b32 v146, 16, v28
    v_lshlrev_b32 v150, 16, v29
    v_lshlrev_b32 v154, 16, v30
    v_lshlrev_b32 v158, 16, v31
    v_and_b32 v147, 0xffff0000, v28
    v_and_b32 v151, 0xffff0000, v29
    v_and_b32 v155, 0xffff0000, v30
    v_and_b32 v159, 0xffff0000, v31
    v_pk_add_f32 v[144:145], v[144:145], v[146:147]
    v_pk_add_f32 v[148:149], v[148:149], v[150:151]
    v_pk_add_f32 v[152:153], v[152:153], v[154:155]
    v_pk_add_f32 v[156:157], v[156:157], v[158:159]
    v_cvt_pk_bf16_f32 v28, v144, v145
    v_cvt_pk_bf16_f32 v29, v148, v149
    v_cvt_pk_bf16_f32 v30, v152, v153
    v_cvt_pk_bf16_f32 v31, v156, v157
    v_add_u32 v160, 24, v242
    v_cmp_eq_u32 vcc, v160, v8
    v_cmp_eq_u32 s[60:61], v160, v10
    v_mov_b32 v161, 0x40000000
    s_or_b64 vcc, vcc, s[60:61]
    v_cndmask_b32 v15, v229, v161, vcc
    s_mov_b32 s32, 0
    buffer_store_dwordx4 v[16:19], v12, s[28:31], s32 offen nt
    s_mov_b32 s32, 16384
    buffer_store_dwordx4 v[20:23], v13, s[28:31], s32 offen nt
    s_mov_b32 s32, 32768
    buffer_store_dwordx4 v[24:27], v14, s[28:31], s32 offen nt
    s_mov_b32 s32, 49152
    buffer_store_dwordx4 v[28:31], v15, s[28:31], s32 offen nt
    s_sub_u32 s54, s2, 224
    v_lshrrev_b32 v234, 4, v230
    v_lshlrev_b32 v234, 13, v234
    v_and_b32_e64 v235, 15, v237
    v_lshl_add_u32 v217, v235, 4, v234
    s_lshl_b32 s35, s54, 8
    s_add_u32 s35, s35, 0x3900000
    v_bfe_u32 v234, v237, 4, 1
    v_lshrrev_b32 v236, 5, v237
    v_lshl_add_u32 v234, v234, 1, v236
    v_lshl_add_u32 v234, v235, 2, v234
    s_lshl_b32 s32, s54, 6
    v_add_u32 v234, s32, v234
    v_lshlrev_b32_e64 v218, 1, v234
    v_add_u32 v234, 98304, v218
    ds_read_u16 v100, v234
    ds_read_u16 v101, v234 offset:4096
    s_cmp_lt_u32 s54, 16
    s_cselect_b64 vcc, -1, 0
    v_cndmask_b32 v102, v10, v8, vcc
    s_cselect_b32 s32, 0, 4
    s_add_u32 s32, s32, 106496
    v_mov_b32_e64 v234, s32
    ds_read_b32 v103, v234
    s_waitcnt lgkmcnt(0)
    v_cvt_pk_bf16_f32 v103, v103, v103
    v_lshlrev_b32 v103, 16, v103
    v_mul_f32 v103, 0xbfb8aa3b, v103
    v_exp_f32 v103, v103
    s_nop 0
    v_add_f32 v103, 1.0, v103
    v_rcp_f32_e64 v103, v103
    s_nop 0
    v_cvt_pk_bf16_f32 v103, v103, v103
    v_lshlrev_b32_e64 v103, 16, v103
    v_and_b32 v218, 2047, v218
    v_lshl_add_u32 v218, v102, 11, v218
    v_lshlrev_b32_e64 v220, 2, v230
    v_add_u32 v220, 106752, v220
    v_lshlrev_b32_e64 v221, 2, v237
    v_add_u32 v221, 106752, v221
    s_cmp_lg_u32 s3, 0
    s_cbranch_scc1 kc_b22
    s_lshl_b32 s32, s52, 7
    s_add_u32 s32, s32, 0x38a0c00
    s_mov_b32 s34, 0x100000
    s_branch kc_b21
kc_b20:
    s_sleep 2
kc_b21:
    buffer_load_dword v235, off, s[8:11], s32 sc1
    s_waitcnt vmcnt(0)
    v_cmp_ne_u32 vcc, 8, v235
    s_sub_u32 s34, s34, 1
    s_cbranch_scc1 kc_b22
    s_cbranch_vccnz kc_b20
kc_b22:
    s_barrier
    s_add_u32 s32, s35, 0
    buffer_load_dwordx4 v[32:35], v217, s[8:11], s32 offen sc1
    s_add_u32 s32, s35, 131072
    buffer_load_dwordx4 v[36:39], v217, s[8:11], s32 offen sc1
    s_add_u32 s32, s35, 262144
    buffer_load_dwordx4 v[40:43], v217, s[8:11], s32 offen sc1
    s_add_u32 s32, s35, 393216
    buffer_load_dwordx4 v[44:47], v217, s[8:11], s32 offen sc1
    s_add_u32 s32, s35, 524288
    buffer_load_dwordx4 v[48:51], v217, s[8:11], s32 offen sc1
    s_add_u32 s32, s35, 655360
    buffer_load_dwordx4 v[52:55], v217, s[8:11], s32 offen sc1
    s_add_u32 s32, s35, 786432
    buffer_load_dwordx4 v[56:59], v217, s[8:11], s32 offen sc1
    s_add_u32 s32, s35, 917504
    buffer_load_dwordx4 v[60:63], v217, s[8:11], s32 offen sc1
    s_add_u32 s32, s35, 1048576
    buffer_load_dwordx4 v[64:67], v217, s[8:11], s32 offen sc1
    s_add_u32 s32, s35, 1179648
    buffer_load_dwordx4 v[68:71], v217, s[8:11], s32 offen sc1
    s_add_u32 s32, s35, 1310720
    buffer_load_dwordx4 v[72:75], v217, s[8:11], s32 offen sc1
    s_add_u32 s32, s35, 1441792
    buffer_load_dwordx4 v[76:79], v217, s[8:11], s32 offen sc1
    s_add_u32 s32, s35, 1572864
    buffer_load_dwordx4 v[80:83], v217, s[8:11], s32 offen sc1
    s_add_u32 s32, s35, 1703936
    buffer_load_dwordx4 v[84:87], v217, s[8:11], s32 offen sc1
    s_waitcnt vmcnt(12)
    v_pk_add_f32 v[32:33], v[32:33], v[36:37]
    v_pk_add_f32 v[34:35], v[34:35], v[38:39]
    s_waitcnt vmcnt(11)
    v_pk_add_f32 v[32:33], v[32:33], v[40:41]
    v_pk_add_f32 v[34:35], v[34:35], v[42:43]
    s_waitcnt vmcnt(10)
    v_pk_add_f32 v[32:33], v[32:33], v[44:45]
    v_pk_add_f32 v[34:35], v[34:35], v[46:47]
    s_waitcnt vmcnt(9)
    v_pk_add_f32 v[32:33], v[32:33], v[48:49]
    v_pk_add_f32 v[34:35], v[34:35], v[50:51]
    s_waitcnt vmcnt(8)
    v_pk_add_f32 v[32:33], v[32:33], v[52:53]
    v_pk_add_f32 v[34:35], v[34:35], v[54:55]
    s_waitcnt vmcnt(7)
    v_pk_add_f32 v[32:33], v[32:33], v[56:57]
    v_pk_add_f32 v[34:35], v[34:35], v[58:59]
    s_waitcnt vmcnt(6)
    v_pk_add_f32 v[32:33], v[32:33], v[60:61]
    v_pk_add_f32 v[34:35], v[34:35], v[62:63]
    s_waitcnt vmcnt(5)
    v_pk_add_f32 v[32:33], v[32:33], v[64:65]
    v_pk_add_f32 v[34:35], v[34:35], v[66:67]
    s_waitcnt vmcnt(4)
    v_pk_add_f32 v[32:33], v[32:33], v[68:69]
    v_pk_add_f32 v[34:35], v[34:35], v[70:71]
    s_waitcnt vmcnt(3)
    v_pk_add_f32 v[32:33], v[32:33], v[72:73]
    v_pk_add_f32 v[34:35], v[34:35], v[74:75]
    s_waitcnt vmcnt(2)
    v_pk_add_f32 v[32:33], v[32:33], v[76:77]
    v_pk_add_f32 v[34:35], v[34:35], v[78:79]
    s_waitcnt vmcnt(1)
    v_pk_add_f32 v[32:33], v[32:33], v[80:81]
    v_pk_add_f32 v[34:35], v[34:35], v[82:83]
    s_waitcnt vmcnt(0)
    v_pk_add_f32 v[32:33], v[32:33], v[84:85]
    v_pk_add_f32 v[34:35], v[34:35], v[86:87]
    s_nop 1
    v_permlane32_swap_b32 v32, v33
    v_permlane32_swap_b32 v34, v35
    s_nop 0
    v_add_f32 v32, v32, v33
    v_add_f32 v34, v34, v35
    s_nop 1
    v_permlane16_swap_b32 v32, v34
    s_nop 0
    v_add_f32_e64 v32, v32, v34
    ds_write_b32 v220, v32
    s_waitcnt lgkmcnt(0)
    s_barrier
    s_cmp_lg_u32 s3, 0
    s_cbranch_scc1 kc_fin
    ds_read_b32 v32, v221
    ds_read_b32 v33, v221 offset:256
    ds_read_b32 v34, v221 offset:512
    ds_read_b32 v35, v221 offset:768
    v_lshlrev_b32 v100, 16, v100
    v_lshlrev_b32 v101, 16, v101
    s_waitcnt lgkmcnt(0)
    v_add_f32 v32, v32, v33
    v_add_f32 v34, v34, v35
    v_add_f32 v32, v32, v34
    v_cvt_pk_bf16_f32 v32, v32, v32
    v_lshlrev_b32 v32, 16, v32
    v_mul_f32 v32, v32, v103
    v_cvt_pk_bf16_f32 v32, v32, v32
    v_lshlrev_b32 v32, 16, v32
    v_add_f32 v32, v32, v100
    v_cvt_pk_bf16_f32 v32, v32, v32
    v_lshlrev_b32 v32, 16, v32
    v_add_f32 v32, v32, v101
    v_cvt_pk_bf16_f32 v32, v32, v32
    buffer_store_short v32, v218, s[28:31], 0 offen
kc_fin:
    s_endpgm
kc_r3:
    s_mov_b32 s34, 0x100000
kc_r3l:
    s_sleep 4
    buffer_load_dwordx4 v[176:179], v228, s[8:11], s7 offen offset:0 sc1
    buffer_load_dwordx4 v[180:183], v228, s[8:11], s7 offen offset:1024 sc1
    buffer_load_dwordx4 v[184:187], v228, s[8:11], s7 offen offset:2048 sc1
    buffer_load_dwordx4 v[188:191], v228, s[8:11], s7 offen offset:3072 sc1
    s_waitcnt vmcnt(0)
    v_max3_u32 v235, v176, v177, v178
    v_max3_u32 v235, v235, v179, v180
    v_max3_u32 v235, v235, v181, v182
    v_max3_u32 v235, v235, v183, v184
    v_max3_u32 v235, v235, v185, v186
    v_max3_u32 v235, v235, v187, v188
    v_max3_u32 v235, v235, v189, v190
    v_max_u32 v235, v235, v191
    v_cmp_eq_u32 vcc, -1, v235
    s_sub_u32 s34, s34, 1
    s_cbranch_scc1 kc_r3o
    s_cbranch_vccnz kc_r3l
    s_branch kc_r3o
kc_r1:
    s_mov_b32 s34, 0x100000
kc_r1l:
    s_sleep 4
    buffer_load_dwordx4 v[96:99], v228, s[8:11], s37 offen offset:0 sc1
    buffer_load_dwordx4 v[100:103], v228, s[8:11], s37 offen offset:1024 sc1
    buffer_load_dwordx4 v[104:107], v228, s[8:11], s37 offen offset:2048 sc1
    buffer_load_dwordx4 v[108:111], v228, s[8:11], s37 offen offset:3072 sc1
    s_waitcnt vmcnt(0)
    v_max3_u32 v235, v96, v97, v98
    v_max3_u32 v235, v235, v99, v100
    v_max3_u32 v235, v235, v101, v102
    v_max3_u32 v235, v235, v103, v104
    v_max3_u32 v235, v235, v105, v106
    v_max3_u32 v235, v235, v107, v108
    v_max3_u32 v235, v235, v109, v110
    v_max_u32 v235, v235, v111
    v_cmp_eq_u32 vcc, -1, v235
    s_sub_u32 s34, s34, 1
    s_cbranch_scc1 kc_r1o
    s_cbranch_vccnz kc_r1l
    s_branch kc_r1o
kc_r2:
    s_mov_b32 s34, 0x100000
kc_r2l:
    s_sleep 4
    buffer_load_dwordx4 v[160:163], v228, s[8:11], s38 offen offset:0 sc1
    buffer_load_dwordx4 v[164:167], v228, s[8:11], s38 offen offset:1024 sc1
    buffer_load_dwordx4 v[168:171], v228, s[8:11], s38 offen offset:2048 sc1
    buffer_load_dwordx4 v[172:175], v228, s[8:11], s38 offen offset:3072 sc1
    s_waitcnt vmcnt(0)
    v_max3_u32 v235, v160, v161, v162
    v_max3_u32 v235, v235, v163, v164
    v_max3_u32 v235, v235, v165, v166
    v_max3_u32 v235, v235, v167, v168
    v_max3_u32 v235, v235, v169, v170
    v_max3_u32 v235, v235, v171, v172
    v_max3_u32 v235, v235, v173, v174
    v_max_u32 v235, v235, v175
    v_cmp_eq_u32 vcc, -1, v235
    s_sub_u32 s34, s34, 1
    s_cbranch_scc1 kc_r2o
    s_cbranch_vccnz kc_r2l
    s_branch kc_r2o
kc_g:
    s_mov_b32 s34, 0x100000
    s_branch kc_gs1
kc_gs0:
    s_sleep 2
kc_gs1:
    buffer_load_dword v235, off, s[8:11], s45 sc1
    s_waitcnt vmcnt(0)
    v_cmp_ne_u32_e64 vcc, 8, v235
    s_sub_u32 s34, s34, 1
    s_cbranch_scc1 kc_gs2
    s_cbranch_vccnz kc_gs0
kc_gs2:
    s_branch kc_gr
kc_end:
ka_done:
    s_endpgm
kf_fix1:
    s_cmp_eq_u32 s33, 0
    s_cselect_b32 s24, 0, 0x74000000
    s_cselect_b32 s36, 0, 0x1000
    s_mov_b32 s33, 1
    v_subrev_f32 v230, s24, v243
    v_add_f32 v231, 0, v230
    v_min_f32 v64, v224, v231
    v_add_f32 v232, 0xf1800000, v230
    v_min_f32_e64 v65, v224, v232
    v_add_f32 v231, 0xf2000000, v230
    v_min_f32_e64 v66, v224, v231
    v_add_f32 v232, 0xf2400000, v230
    v_min_f32_e64 v67, v224, v232
    v_add_f32 v231, 0xf3000000, v230
    v_min_f32_e64 v68, v224, v231
    v_add_f32 v232, 0xf3100000, v230
    v_min_f32_e64 v69, v224, v232
    v_add_f32 v231, 0xf3200000, v230
    v_min_f32_e64 v70, v224, v231
    v_add_f32 v232, 0xf3300000, v230
    v_min_f32_e64 v71, v224, v232
    v_add_f32 v231, 0x73800000, v230
    v_min_f32_e64 v72, v225, v231
    v_add_f32 v232, 0x73700000, v230
    v_min_f32_e64 v73, v225, v232
    v_add_f32 v231, 0x73600000, v230
    v_min_f32_e64 v74, v225, v231
    v_add_f32 v232, 0x73500000, v230
    v_min_f32_e64 v75, v225, v232
    v_add_f32 v231, 0x73000000, v230
    v_min_f32_e64 v76, v225, v231
    v_add_f32 v232, 0x72e00000, v230
    v_min_f32_e64 v77, v225, v232
    v_add_f32 v231, 0x72c00000, v230
    v_min_f32_e64 v78, v225, v231
    v_add_f32 v232, 0x72a00000, v230
    v_min_f32 v79, v225, v232
    s_nop 1
    s_branch kf_fixr2
kf_fix3:
    s_cmp_eq_u32 s33, 0
    s_cselect_b32 s24, 0, 0x74000000
    s_cselect_b32 s36, 0, 0x1000
    s_mov_b32 s33, 1
    v_subrev_f32 v230, s24, v243
    v_add_f32 v231, 0, v230
    v_min_f32 v64, v224, v231
    v_add_f32 v232, 0xf1800000, v230
    v_min_f32_e64 v65, v224, v232
    v_add_f32 v231, 0xf2000000, v230
    v_min_f32_e64 v66, v224, v231
    v_add_f32 v232, 0xf2400000, v230
    v_min_f32_e64 v67, v224, v232
    v_add_f32 v231, 0xf3000000, v230
    v_min_f32_e64 v68, v224, v231
    v_add_f32 v232, 0xf3100000, v230
    v_min_f32_e64 v69, v224, v232
    v_add_f32 v231, 0xf3200000, v230
    v_min_f32_e64 v70, v224, v231
    v_add_f32 v232, 0xf3300000, v230
    v_min_f32_e64 v71, v224, v232
    v_add_f32 v231, 0x73800000, v230
    v_min_f32_e64 v72, v225, v231
    v_add_f32 v232, 0x73700000, v230
    v_min_f32_e64 v73, v225, v232
    v_add_f32 v231, 0x73600000, v230
    v_min_f32_e64 v74, v225, v231
    v_add_f32 v232, 0x73500000, v230
    v_min_f32_e64 v75, v225, v232
    v_add_f32 v231, 0x73000000, v230
    v_min_f32_e64 v76, v225, v231
    v_add_f32 v232, 0x72e00000, v230
    v_min_f32_e64 v77, v225, v232
    v_add_f32 v231, 0x72c00000, v230
    v_min_f32_e64 v78, v225, v231
    v_add_f32 v232, 0x72a00000, v230
    v_min_f32 v79, v225, v232
    s_nop 1
    s_branch kf_fixr4
hot_end:
ka_redo:
    s_waitcnt vmcnt(0) lgkmcnt(0)
    s_barrier
    s_mov_b32 s34, s37
    s_sub_u32 s42, s32, 17664
    s_mov_b32 s36, s6
    s_mov_b32 s33, 0
    s_mov_b32 m0, s34
    s_add_u32 s41, s42, 17664
    buffer_load_dwordx4 v242, s[16:19], s41 offen offset:0 sc1 lds
    buffer_load_dwordx4 v242, s[16:19], s41 offen offset:1024 sc1 lds
    buffer_load_dwordx4 v242, s[16:19], s41 offen offset:2048 sc1 lds
    buffer_load_dwordx4 v242, s[16:19], s41 offen offset:3072 sc1 lds
    s_add_u32 s34, s34, 32768
    s_cmp_ge_u32 s34, 163840
    s_cselect_b32 s34, s37, s34
    s_add_u32 s42, s42, 34048
    s_mov_b32 m0, s34
    s_add_u32 s41, s42, 17664
    buffer_load_dwordx4 v242, s[16:19], s41 offen offset:0 sc1 lds
    buffer_load_dwordx4 v242, s[16:19], s41 offen offset:1024 sc1 lds
    buffer_load_dwordx4 v242, s[16:19], s41 offen offset:2048 sc1 lds
    buffer_load_dwordx4 v242, s[16:19], s41 offen offset:3072 sc1 lds
    s_add_u32 m0, s34, 16384
    s_add_u32 s34, s34, 32768
    s_cmp_ge_u32 s34, 163840
    s_cselect_b32 s34, s37, s34
    buffer_load_dwordx4 v242, s[16:19], s42 offen offset:0 sc1 lds
    buffer_load_dwordx4 v242, s[16:19], s42 offen offset:1024 sc1 lds
    buffer_load_dwordx4 v242, s[16:19], s42 offen offset:2048 sc1 lds
    buffer_load_dwordx4 v242, s[16:19], s42 offen offset:3072 sc1 lds
    s_add_u32 s42, s42, 34048
    s_mov_b32 m0, s34
    s_add_u32 s41, s42, 17664
    buffer_load_dwordx4 v242, s[16:19], s41 offen offset:0 sc1 lds
    buffer_load_dwordx4 v242, s[16:19], s41 offen offset:1024 sc1 lds
    buffer_load_dwordx4 v242, s[16:19], s41 offen offset:2048 sc1 lds
    buffer_load_dwordx4 v242, s[16:19], s41 offen offset:3072 sc1 lds
    s_add_u32 m0, s34, 16384
    s_add_u32 s34, s34, 32768
    s_cmp_ge_u32 s34, 163840
    s_cselect_b32 s34, s37, s34
    buffer_load_dwordx4 v242, s[16:19], s42 offen offset:0 sc1 lds
    buffer_load_dwordx4 v242, s[16:19], s42 offen offset:1024 sc1 lds
    buffer_load_dwordx4 v242, s[16:19], s42 offen offset:2048 sc1 lds
    buffer_load_dwordx4 v242, s[16:19], s42 offen offset:3072 sc1 lds
    s_add_u32 s42, s42, 34048
    s_mov_b32 m0, s34
    s_add_u32 s41, s42, 17664
    buffer_load_dwordx4 v242, s[16:19], s41 offen offset:0 sc1 lds
    buffer_load_dwordx4 v242, s[16:19], s41 offen offset:1024 sc1 lds
    buffer_load_dwordx4 v242, s[16:19], s41 offen offset:2048 sc1 lds
    buffer_load_dwordx4 v242, s[16:19], s41 offen offset:3072 sc1 lds
    s_add_u32 m0, s34, 16384
    s_add_u32 s34, s34, 32768
    s_cmp_ge_u32 s34, 163840
    s_cselect_b32 s34, s37, s34
    buffer_load_dwordx4 v242, s[16:19], s42 offen offset:0 sc1 lds
    buffer_load_dwordx4 v242, s[16:19], s42 offen offset:1024 sc1 lds
    buffer_load_dwordx4 v242, s[16:19], s42 offen offset:2048 sc1 lds
    buffer_load_dwordx4 v242, s[16:19], s42 offen offset:3072 sc1 lds
    s_add_u32 s42, s42, 34048
    v_accvgpr_write_b32 a0, 0
    v_accvgpr_write_b32 a1, 0
    v_accvgpr_write_b32 a2, 0
    v_accvgpr_write_b32 a3, 0
    v_accvgpr_write_b32 a4, 0
    v_accvgpr_write_b32 a5, 0
    v_accvgpr_write_b32 a6, 0
    v_accvgpr_write_b32 a7, 0
    v_accvgpr_write_b32 a8, 0
    v_accvgpr_write_b32 a9, 0
    v_accvgpr_write_b32 a10, 0
    v_accvgpr_write_b32 a11, 0
    v_accvgpr_write_b32 a12, 0
    v_accvgpr_write_b32 a13, 0
    v_accvgpr_write_b32 a14, 0
    v_accvgpr_write_b32 a15, 0
    v_accvgpr_write_b32 a16, 0
    v_accvgpr_write_b32 a17, 0
    v_accvgpr_write_b32 a18, 0
    v_accvgpr_write_b32 a19, 0
    v_accvgpr_write_b32 a20, 0
    v_accvgpr_write_b32 a21, 0
    v_accvgpr_write_b32 a22, 0
    v_accvgpr_write_b32 a23, 0
    v_accvgpr_write_b32 a24, 0
    v_accvgpr_write_b32 a25, 0
    v_accvgpr_write_b32 a26, 0
    v_accvgpr_write_b32 a27, 0
    v_accvgpr_write_b32 a28, 0
    v_accvgpr_write_b32 a29, 0
    v_accvgpr_write_b32 a30, 0
    v_accvgpr_write_b32 a31, 0
    v_accvgpr_write_b32 a32, 0
    v_accvgpr_write_b32 a33, 0
    v_accvgpr_write_b32 a34, 0
    v_accvgpr_write_b32 a35, 0
    v_accvgpr_write_b32 a36, 0
    v_accvgpr_write_b32 a37, 0
    v_accvgpr_write_b32 a38, 0
    v_accvgpr_write_b32 a39, 0
    v_accvgpr_write_b32 a40, 0
    v_accvgpr_write_b32 a41, 0
    v_accvgpr_write_b32 a42, 0
    v_accvgpr_write_b32 a43, 0
    v_accvgpr_write_b32 a44, 0
    v_accvgpr_write_b32 a45, 0
    v_accvgpr_write_b32 a46, 0
    v_accvgpr_write_b32 a47, 0
    v_accvgpr_write_b32 a48, 0
    v_accvgpr_write_b32 a49, 0
    v_accvgpr_write_b32 a50, 0
    v_accvgpr_write_b32 a51, 0
    v_accvgpr_write_b32 a52, 0
    v_accvgpr_write_b32 a53, 0
    v_accvgpr_write_b32 a54, 0
    v_accvgpr_write_b32 a55, 0
    v_accvgpr_write_b32 a56, 0
    v_accvgpr_write_b32 a57, 0
    v_accvgpr_write_b32 a58, 0
    v_accvgpr_write_b32 a59, 0
    v_accvgpr_write_b32 a60, 0
    v_accvgpr_write_b32 a61, 0
    v_accvgpr_write_b32 a62, 0
    v_accvgpr_write_b32 a63, 0
    v_accvgpr_write_b32 a64, 0
    v_accvgpr_write_b32 a65, 0
    v_accvgpr_write_b32 a66, 0
    v_accvgpr_write_b32 a67, 0
    v_accvgpr_write_b32 a68, 0
    v_accvgpr_write_b32 a69, 0
    v_accvgpr_write_b32 a70, 0
    v_accvgpr_write_b32 a71, 0
    v_accvgpr_write_b32 a72, 0
    v_accvgpr_write_b32 a73, 0
    v_accvgpr_write_b32 a74, 0
    v_accvgpr_write_b32 a75, 0
    v_accvgpr_write_b32 a76, 0
    v_accvgpr_write_b32 a77, 0
    v_accvgpr_write_b32 a78, 0
    v_accvgpr_write_b32 a79, 0
    v_accvgpr_write_b32 a80, 0
    v_accvgpr_write_b32 a81, 0
    v_accvgpr_write_b32 a82, 0
    v_accvgpr_write_b32 a83, 0
    v_accvgpr_write_b32 a84, 0
    v_accvgpr_write_b32 a85, 0
    v_accvgpr_write_b32 a86, 0
    v_accvgpr_write_b32 a87, 0
    v_accvgpr_write_b32 a88, 0
    v_accvgpr_write_b32 a89, 0
    v_accvgpr_write_b32 a90, 0
    v_accvgpr_write_b32 a91, 0
    v_accvgpr_write_b32 a92, 0
    v_accvgpr_write_b32 a93, 0
    v_accvgpr_write_b32 a94, 0
    v_accvgpr_write_b32 a95, 0
    v_accvgpr_write_b32 a96, 0
    v_accvgpr_write_b32 a97, 0
    v_accvgpr_write_b32 a98, 0
    v_accvgpr_write_b32 a99, 0
    v_accvgpr_write_b32 a100, 0
    v_accvgpr_write_b32 a101, 0
    v_accvgpr_write_b32 a102, 0
    v_accvgpr_write_b32 a103, 0
    v_accvgpr_write_b32 a104, 0
    v_accvgpr_write_b32 a105, 0
    v_accvgpr_write_b32 a106, 0
    v_accvgpr_write_b32 a107, 0
    v_accvgpr_write_b32 a108, 0
    v_accvgpr_write_b32 a109, 0
    v_accvgpr_write_b32 a110, 0
    v_accvgpr_write_b32 a111, 0
    v_accvgpr_write_b32 a112, 0
    v_accvgpr_write_b32 a113, 0
    v_accvgpr_write_b32 a114, 0
    v_accvgpr_write_b32 a115, 0
    v_accvgpr_write_b32 a116, 0
    v_accvgpr_write_b32 a117, 0
    v_accvgpr_write_b32 a118, 0
    v_accvgpr_write_b32 a119, 0
    v_accvgpr_write_b32 a120, 0
    v_accvgpr_write_b32 a121, 0
    v_accvgpr_write_b32 a122, 0
    v_accvgpr_write_b32 a123, 0
    v_accvgpr_write_b32 a124, 0
    v_accvgpr_write_b32 a125, 0
    v_accvgpr_write_b32 a126, 0
    v_accvgpr_write_b32 a127, 0
    v_mov_b32 v64, 0
    v_mov_b32 v65, 0
    v_mov_b32 v66, 0
    v_mov_b32 v67, 0
    v_mov_b32 v68, 0
    v_mov_b32 v69, 0
    v_mov_b32 v70, 0
    v_mov_b32 v71, 0
    v_mov_b32 v72, 0
    v_mov_b32 v73, 0
    v_mov_b32 v74, 0
    v_mov_b32 v75, 0
    v_mov_b32 v76, 0
    v_mov_b32 v77, 0
    v_mov_b32 v78, 0
    v_mov_b32 v79, 0
    v_mov_b32 v80, 0
    v_mov_b32 v81, 0
    v_mov_b32 v82, 0
    v_mov_b32 v83, 0
    v_mov_b32 v84, 0
    v_mov_b32 v85, 0
    v_mov_b32 v86, 0
    v_mov_b32 v87, 0
    v_mov_b32 v88, 0
    v_mov_b32 v89, 0
    v_mov_b32 v90, 0
    v_mov_b32 v91, 0
    v_mov_b32 v92, 0
    v_mov_b32 v93, 0
    v_mov_b32 v94, 0
    v_mov_b32 v95, 0
    v_mov_b32 v224, 0
    v_mov_b32 v225, 0
    v_mov_b32 v226, 0
    v_mov_b32 v227, 0
    v_mov_b32_e64 v241, v240
    s_waitcnt vmcnt(16)
    s_barrier
    ds_read_b128 a[192:195], v241 offset:0
    ds_read_b128 a[196:199], v241 offset:2048
    ds_read_b128 a[200:203], v241 offset:4096
    ds_read_b128 a[204:207], v241 offset:6144
    ds_read_b128 a[208:211], v241 offset:1024
    ds_read_b128 a[212:215], v241 offset:3072
    ds_read_b128 a[216:219], v241 offset:5120
    ds_read_b128 a[220:223], v241 offset:7168
    s_waitcnt lgkmcnt(0)
    ds_read_b128 a[224:227], v241 offset:8192
    ds_read_b128 a[228:231], v241 offset:10240
    ds_read_b128 a[232:235], v241 offset:12288
    ds_read_b128 a[236:239], v241 offset:14336
    ds_read_b128 a[240:243], v241 offset:9216
    ds_read_b128 a[244:247], v241 offset:11264
    ds_read_b128 a[248:251], v241 offset:13312
    ds_read_b128 a[252:255], v241 offset:15360
    s_sub_u32 s36, s36, 1
    s_cbranch_scc1 kf_fix17
kf_fixr18:
    s_waitcnt lgkmcnt(0)
    v_mfma_f32_16x16x32_bf16 v[0:3], a[192:195], a[128:131], v[64:67]
    v_mfma_f32_16x16x32_bf16 v[8:11], a[192:195], a[144:147], v[72:75]
    v_mfma_f32_16x16x32_bf16 v[16:19], a[192:195], a[160:163], v[80:83]
    v_mfma_f32_16x16x32_bf16 v[24:27], a[192:195], a[176:179], v[88:91]
    v_mfma_f32_16x16x32_bf16 v[4:7], a[208:211], a[128:131], v[68:71]
    v_mfma_f32_16x16x32_bf16 v[12:15], a[208:211], a[144:147], v[76:79]
    v_mfma_f32_16x16x32_bf16 v[20:23], a[208:211], a[160:163], v[84:87]
    v_mfma_f32_16x16x32_bf16 v[28:31], a[208:211], a[176:179], v[92:95]
    v_mfma_f32_16x16x32_bf16 v[0:3], a[196:199], a[132:135], v[0:3]
    v_mfma_f32_16x16x32_bf16 v[8:11], a[196:199], a[148:151], v[8:11]
    v_mfma_f32_16x16x32_bf16 v[16:19], a[196:199], a[164:167], v[16:19]
    v_mfma_f32_16x16x32_bf16 v[24:27], a[196:199], a[180:183], v[24:27]
    v_mfma_f32_16x16x32_bf16 v[4:7], a[212:215], a[132:135], v[4:7]
    v_mfma_f32_16x16x32_bf16 v[12:15], a[212:215], a[148:151], v[12:15]
    v_mfma_f32_16x16x32_bf16 v[20:23], a[212:215], a[164:167], v[20:23]
    v_mfma_f32_16x16x32_bf16 v[28:31], a[212:215], a[180:183], v[28:31]
    v_mfma_f32_16x16x32_bf16 v[0:3], a[200:203], a[136:139], v[0:3]
    v_mfma_f32_16x16x32_bf16 v[8:11], a[200:203], a[152:155], v[8:11]
    v_mfma_f32_16x16x32_bf16 v[16:19], a[200:203], a[168:171], v[16:19]
    v_mfma_f32_16x16x32_bf16 v[24:27], a[200:203], a[184:187], v[24:27]
    v_mfma_f32_16x16x32_bf16 v[4:7], a[216:219], a[136:139], v[4:7]
    v_mfma_f32_16x16x32_bf16 v[12:15], a[216:219], a[152:155], v[12:15]
    v_mfma_f32_16x16x32_bf16 v[20:23], a[216:219], a[168:171], v[20:23]
    v_mfma_f32_16x16x32_bf16 v[28:31], a[216:219], a[184:187], v[28:31]
    v_mfma_f32_16x16x32_bf16 v[0:3], a[204:207], a[140:143], v[0:3]
    v_mov_b32 v144, 0
    v_mov_b32 v145, 0
    v_mov_b32_e64 v146, 0
    v_mfma_f32_16x16x32_bf16 v[8:11], a[204:207], a[156:159], v[8:11]
    v_mov_b32 v147, 0
    v_mov_b32 v148, 0
    v_mfma_f32_16x16x32_bf16 v[16:19], a[204:207], a[172:175], v[16:19]
    v_mov_b32 v149, 0
    v_mov_b32 v150, 0
    v_mov_b32_e64 v151, 0
    v_mfma_f32_16x16x32_bf16 v[24:27], a[204:207], a[188:191], v[24:27]
    v_mov_b32 v152, 0
    v_mov_b32 v153, 0
    v_mfma_f32_16x16x32_bf16 v[4:7], a[220:223], a[140:143], v[4:7]
    v_mov_b32 v154, 0
    v_mov_b32 v155, 0
    v_mov_b32_e64 v156, 0
    v_mfma_f32_16x16x32_bf16 v[12:15], a[220:223], a[156:159], v[12:15]
    v_mov_b32 v157, 0
    v_mov_b32 v158, 0
    v_mfma_f32_16x16x32_bf16 v[20:23], a[220:223], a[172:175], v[20:23]
    v_mov_b32_e64 v159, 0
    v_mov_b32 v204, 0x3f803f80
    v_mov_b32 v205, 0x3f803f80
    v_mfma_f32_16x16x32_bf16 v[28:31], a[220:223], a[188:191], v[28:31]
    v_mov_b32 v206, 0x3f803f80
    v_mov_b32 v207, 0x3f803f80
    s_nop 4
    v_max3_f32 v128, v0, v1, v2
    v_max3_f32 v130, v8, v9, v10
    v_max3_f32 v132, v16, v17, v18
    v_max3_f32 v134, v24, v25, v26
    v_max3_f32 v128, v128, v3, v4
    v_max3_f32 v130, v130, v11, v12
    v_max3_f32 v132, v132, v19, v20
    v_max3_f32 v134, v134, v27, v28
    v_max3_f32 v128, v128, v5, v6
    v_max3_f32 v130, v130, v13, v14
    v_max3_f32 v132, v132, v21, v22
    v_max3_f32 v134, v134, v29, v30
    v_max_f32 v128, v128, v7
    v_max_f32 v130, v130, v15
    v_max_f32 v132, v132, v23
    v_max_f32 v134, v134, v31
    v_mov_b32 v129, v128
    v_mov_b32 v131, v130
    v_mov_b32 v133, v132
    v_mov_b32 v135, v134
    v_permlane16_swap_b32 v128, v129
    v_permlane16_swap_b32 v130, v131
    v_permlane16_swap_b32 v132, v133
    v_permlane16_swap_b32 v134, v135
    v_max_f32 v128, v128, v129
    v_max_f32 v130, v130, v131
    v_max_f32 v132, v132, v133
    v_max_f32 v134, v134, v135
    v_mov_b32 v129, v128
    v_mov_b32 v131, v130
    v_mov_b32 v133, v132
    v_mov_b32 v135, v134
    v_permlane32_swap_b32 v128, v129
    v_permlane32_swap_b32 v130, v131
    v_permlane32_swap_b32 v132, v133
    v_permlane32_swap_b32 v134, v135
    v_max_f32 v128, v128, v129
    v_max_f32 v130, v130, v131
    v_max_f32 v132, v132, v133
    v_max_f32_e64 v134, v134, v135
    v_add_f32 v128, 0x41800000, v128
    v_add_f32 v130, 0x41800000, v130
    v_add_f32 v132, 0x41800000, v132
    v_add_f32 v134, 0x41800000, v134
    v_sub_f32 v224, 0, v128
    v_sub_f32 v64, v64, v128
    v_sub_f32 v65, v65, v128
    v_sub_f32 v66, v66, v128
    v_sub_f32 v67, v67, v128
    v_sub_f32 v68, v68, v128
    v_sub_f32 v69, v69, v128
    v_sub_f32 v70, v70, v128
    v_sub_f32 v71, v71, v128
    v_sub_f32 v225, 0, v130
    v_sub_f32 v72, v72, v130
    v_sub_f32 v73, v73, v130
    v_sub_f32 v74, v74, v130
    v_sub_f32 v75, v75, v130
    v_sub_f32 v76, v76, v130
    v_sub_f32 v77, v77, v130
    v_sub_f32 v78, v78, v130
    v_sub_f32 v79, v79, v130
    v_sub_f32 v226, 0, v132
    v_sub_f32 v80, v80, v132
    v_sub_f32 v81, v81, v132
    v_sub_f32 v82, v82, v132
    v_sub_f32 v83, v83, v132
    v_sub_f32 v84, v84, v132
    v_sub_f32 v85, v85, v132
    v_sub_f32 v86, v86, v132
    v_sub_f32 v87, v87, v132
    v_sub_f32 v227, 0, v134
    v_sub_f32 v88, v88, v134
    v_sub_f32 v89, v89, v134
    v_sub_f32 v90, v90, v134
    v_sub_f32 v91, v91, v134
    v_sub_f32 v92, v92, v134
    v_sub_f32 v93, v93, v134
    v_sub_f32 v94, v94, v134
    v_sub_f32 v95, v95, v134
    v_sub_f32 v0, v0, v128
    v_sub_f32 v1, v1, v128
    v_sub_f32 v2, v2, v128
    v_sub_f32 v3, v3, v128
    v_sub_f32 v4, v4, v128
    v_sub_f32 v5, v5, v128
    v_sub_f32 v6, v6, v128
    v_sub_f32 v7, v7, v128
    v_sub_f32 v8, v8, v130
    v_sub_f32 v9, v9, v130
    v_sub_f32 v10, v10, v130
    v_sub_f32 v11, v11, v130
    v_sub_f32 v12, v12, v130
    v_sub_f32 v13, v13, v130
    v_sub_f32 v14, v14, v130
    v_sub_f32 v15, v15, v130
    v_sub_f32 v16, v16, v132
    v_sub_f32 v17, v17, v132
    v_sub_f32 v18, v18, v132
    v_sub_f32 v19, v19, v132
    v_sub_f32 v20, v20, v132
    v_sub_f32 v21, v21, v132
    v_sub_f32 v22, v22, v132
    v_sub_f32 v23, v23, v132
    v_sub_f32 v24, v24, v134
    v_sub_f32 v25, v25, v134
    v_sub_f32 v26, v26, v134
    v_sub_f32 v27, v27, v134
    v_sub_f32 v28, v28, v134
    v_sub_f32 v29, v29, v134
    v_sub_f32 v30, v30, v134
    v_sub_f32 v31, v31, v134
    s_mov_b32 s35, 32768
    v_add_u32_e64 v241, s35, v240
    s_sub_u32 s36, s36, 1
    s_cbranch_scc1 kf_fix19
kf_fixr20:
    v_mfma_f32_16x16x32_bf16 v[32:35], a[224:227], a[128:131], v[64:67]
    ds_read_b128 a[192:195], v241 offset:0
    v_exp_f32_e64 v128, v0
    v_mfma_f32_16x16x32_bf16 v[32:35], a[228:231], a[132:135], v[32:35]
    v_exp_f32_e64 v129, v1
    v_mfma_f32_16x16x32_bf16 v[32:35], a[232:235], a[136:139], v[32:35]
    v_exp_f32_e64 v130, v2
    v_cvt_pk_bf16_f32 v96, v128, v129
    v_mfma_f32_16x16x32_bf16 v[32:35], a[236:239], a[140:143], v[32:35]
    v_exp_f32_e64 v131, v3
    v_mfma_f32_16x16x32_bf16 v[40:43], a[224:227], a[144:147], v[72:75]
    ds_read_b128 a[196:199], v241 offset:2048
    v_exp_f32_e64 v132, v4
    v_mfma_f32_16x16x32_bf16 v[40:43], a[228:231], a[148:151], v[40:43]
    v_exp_f32_e64 v133, v5
    v_cvt_pk_bf16_f32 v97, v130, v131
    v_mfma_f32_16x16x32_bf16 v[40:43], a[232:235], a[152:155], v[40:43]
    v_exp_f32_e64 v134, v6
    v_cvt_pk_bf16_f32 v98, v132, v133
    v_mfma_f32_16x16x32_bf16 v[40:43], a[236:239], a[156:159], v[40:43]
    v_exp_f32_e64 v135, v7
    v_mfma_f32_16x16x32_bf16 v[48:51], a[224:227], a[160:163], v[80:83]
    ds_read_b128 a[200:203], v241 offset:4096
    v_exp_f32_e64 v136, v8
    v_mfma_f32_16x16x32_bf16 v[48:51], a[228:231], a[164:167], v[48:51]
    v_exp_f32_e64 v137, v9
    v_cvt_pk_bf16_f32 v99, v134, v135
    v_mfma_f32_16x16x32_bf16 v[48:51], a[232:235], a[168:171], v[48:51]
    v_exp_f32 v138, v10
    v_exp_f32 v139, v11
    v_mfma_f32_16x16x32_bf16 v[48:51], a[236:239], a[172:175], v[48:51]
    v_exp_f32_e64 v140, v12
    v_cvt_pk_bf16_f32 v100, v136, v137
    v_mfma_f32_16x16x32_bf16 v[56:59], a[224:227], a[176:179], v[88:91]
    ds_read_b128 a[204:207], v241 offset:6144
    v_exp_f32_e64 v141, v13
    v_mfma_f32_16x16x32_bf16 v[56:59], a[228:231], a[180:183], v[56:59]
    v_exp_f32_e64 v142, v14
    v_cvt_pk_bf16_f32 v101, v138, v139
    v_mfma_f32_16x16x32_bf16 v[56:59], a[232:235], a[184:187], v[56:59]
    v_exp_f32_e64 v143, v15
    v_cvt_pk_bf16_f32 v102, v140, v141
    v_mfma_f32_16x16x32_bf16 v[56:59], a[236:239], a[188:191], v[56:59]
    v_exp_f32_e64 v128, v16
    v_cvt_pk_bf16_f32 v103, v142, v143
    v_mfma_f32_16x16x32_bf16 v[36:39], a[240:243], a[128:131], v[68:71]
    ds_read_b128 a[208:211], v241 offset:1024
    v_exp_f32_e64 v129, v17
    v_mfma_f32_16x16x32_bf16 v[36:39], a[244:247], a[132:135], v[36:39]
    v_exp_f32_e64 v130, v18
    v_cvt_pk_bf16_f32 v104, v128, v129
    v_mfma_f32_16x16x32_bf16 v[36:39], a[248:251], a[136:139], v[36:39]
    v_exp_f32_e64 v131, v19
    v_mfma_f32_16x16x32_bf16 v[36:39], a[252:255], a[140:143], v[36:39]
    v_exp_f32_e64 v132, v20
    v_cvt_pk_bf16_f32 v105, v130, v131
    v_mfma_f32_16x16x32_bf16 v[44:47], a[240:243], a[144:147], v[76:79]
    ds_read_b128 a[212:215], v241 offset:3072
    v_exp_f32_e64 v133, v21
    v_mfma_f32_16x16x32_bf16 v[44:47], a[244:247], a[148:151], v[44:47]
    v_exp_f32 v134, v22
    v_exp_f32 v135, v23
    v_mfma_f32_16x16x32_bf16 v[44:47], a[248:251], a[152:155], v[44:47]
    v_exp_f32_e64 v136, v24
    v_cvt_pk_bf16_f32 v106, v132, v133
    v_mfma_f32_16x16x32_bf16 v[44:47], a[252:255], a[156:159], v[44:47]
    v_exp_f32_e64 v137, v25
    v_cvt_pk_bf16_f32 v107, v134, v135
    v_mfma_f32_16x16x32_bf16 v[52:55], a[240:243], a[160:163], v[84:87]
    ds_read_b128 a[216:219], v241 offset:5120
    v_exp_f32_e64 v138, v26
    v_mfma_f32_16x16x32_bf16 v[52:55], a[244:247], a[164:167], v[52:55]
    v_exp_f32_e64 v139, v27
    v_cvt_pk_bf16_f32 v108, v136, v137
    v_mfma_f32_16x16x32_bf16 v[52:55], a[248:251], a[168:171], v[52:55]
    v_exp_f32_e64 v140, v28
    v_cvt_pk_bf16_f32 v109, v138, v139
    v_mfma_f32_16x16x32_bf16 v[52:55], a[252:255], a[172:175], v[52:55]
    v_exp_f32_e64 v141, v29
    v_mfma_f32_16x16x32_bf16 v[60:63], a[240:243], a[176:179], v[92:95]
    ds_read_b128 a[220:223], v241 offset:7168
    v_exp_f32_e64 v142, v30
    v_mfma_f32_16x16x32_bf16 v[60:63], a[244:247], a[180:183], v[60:63]
    v_exp_f32_e64 v143, v31
    v_cvt_pk_bf16_f32 v110, v140, v141
    v_mfma_f32_16x16x32_bf16 v[60:63], a[248:251], a[184:187], v[60:63]
    v_cvt_pk_bf16_f32 v111, v142, v143
    v_mfma_f32_16x16x32_bf16 v[60:63], a[252:255], a[188:191], v[60:63]
    ds_read_b128 a[224:227], v241 offset:16384
    ds_read_b128 a[228:231], v241 offset:17408
    ds_read_b128 a[232:235], v241 offset:18432
    ds_read_b128 a[236:239], v241 offset:19456
    s_lshl1_add_u32 s26, s5, s31
    s_branch ka_p1r_e
.p2align 5
ka_p1r:
    s_sub_u32 s36, s36, 1
    s_cbranch_scc1 kf_fix23
kf_fixr24:
    s_waitcnt lgkmcnt(8)
    v_mfma_f32_16x16x32_bf16 v[0:3], a[192:195], a[128:131], v[64:67]
    ds_read_b128 a[240:243], v241 offset:20480
    s_mov_b32 m0, s34
    v_mfma_f32_16x16x32_bf16 v[0:3], a[196:199], a[132:135], v[0:3]
    v_exp_f32_e64 v128, v32
    v_mfma_f32_16x16x32_bf16 v[0:3], a[200:203], a[136:139], v[0:3]
    v_exp_f32_e64 v129, v33
    v_mfma_f32_16x16x32_bf16 v[0:3], a[204:207], a[140:143], v[0:3]
    v_exp_f32_e64 v130, v34
    v_mfma_f32_16x16x32_bf16 v[8:11], a[192:195], a[144:147], v[72:75]
    ds_read_b128 a[244:247], v241 offset:21504
    s_add_u32 s41, s42, 17664
    v_mfma_f32_16x16x32_bf16 v[8:11], a[196:199], a[148:151], v[8:11]
    v_exp_f32_e64 v131, v35
    v_mfma_f32_16x16x32_bf16 v[8:11], a[200:203], a[152:155], v[8:11]
    v_exp_f32_e64 v132, v36
    v_mfma_f32_16x16x32_bf16 v[8:11], a[204:207], a[156:159], v[8:11]
    v_exp_f32_e64 v133, v37
    v_mfma_f32_16x16x32_bf16 v[16:19], a[192:195], a[160:163], v[80:83]
    ds_read_b128 a[248:251], v241 offset:22528
    v_cvt_pk_bf16_f32 v112, v128, v129
    v_mfma_f32_16x16x32_bf16 v[16:19], a[196:199], a[164:167], v[16:19]
    v_exp_f32_e64 v134, v38
    v_mfma_f32_16x16x32_bf16 v[16:19], a[200:203], a[168:171], v[16:19]
    v_exp_f32_e64 v135, v39
    v_mfma_f32_16x16x32_bf16 v[16:19], a[204:207], a[172:175], v[16:19]
    buffer_load_dwordx4 v242, s[16:19], s41 offen offset:0 sc1 lds
    v_cvt_pk_bf16_f32 v113, v130, v131
    v_mfma_f32_16x16x32_bf16 v[24:27], a[192:195], a[176:179], v[88:91]
    ds_read_b128 a[252:255], v241 offset:23552
    v_cvt_pk_bf16_f32 v114, v132, v133
    v_mfma_f32_16x16x32_bf16 v[24:27], a[196:199], a[180:183], v[24:27]
    v_exp_f32_e64 v136, v40
    v_mfma_f32_16x16x32_bf16 v[24:27], a[200:203], a[184:187], v[24:27]
    v_exp_f32_e64 v137, v41
    v_mfma_f32_16x16x32_bf16 v[24:27], a[204:207], a[188:191], v[24:27]
    v_or3_b32 v208, v112, v113, v114
    s_waitcnt lgkmcnt(8)
    v_mfma_f32_16x16x32_bf16 v[4:7], a[208:211], a[128:131], v[68:71]
    ds_read_b128 a[192:195], v241 offset:8192
    v_cvt_pk_bf16_f32 v115, v134, v135
    v_mfma_f32_16x16x32_bf16 v[4:7], a[212:215], a[132:135], v[4:7]
    v_exp_f32 v138, v42
    v_mfma_f32_16x16x32_bf16 v[4:7], a[216:219], a[136:139], v[4:7]
    v_exp_f32_e64 v139, v43
    v_mfma_f32_16x16x32_bf16 v[4:7], a[220:223], a[140:143], v[4:7]
    v_exp_f32_e64 v140, v44
    v_mfma_f32_16x16x32_bf16 v[12:15], a[208:211], a[144:147], v[76:79]
    ds_read_b128 a[196:199], v241 offset:10240
    v_cvt_pk_bf16_f32 v116, v136, v137
    v_mfma_f32_16x16x32_bf16 v[12:15], a[212:215], a[148:151], v[12:15]
    v_exp_f32_e64 v141, v45
    v_mfma_f32_16x16x32_bf16 v[12:15], a[216:219], a[152:155], v[12:15]
    buffer_load_dwordx4 v242, s[16:19], s41 offen offset:1024 sc1 lds
    v_or3_b32 v208, v208, v115, v116
    v_mfma_f32_16x16x32_bf16 v[12:15], a[220:223], a[156:159], v[12:15]
    v_exp_f32_e64 v142, v46
    v_mfma_f32_16x16x32_bf16 v[20:23], a[208:211], a[160:163], v[84:87]
    ds_read_b128 a[200:203], v241 offset:12288
    v_cvt_pk_bf16_f32 v117, v138, v139
    v_mfma_f32_16x16x32_bf16 v[20:23], a[212:215], a[164:167], v[20:23]
    v_exp_f32_e64 v143, v47
    v_mfma_f32_16x16x32_bf16 v[20:23], a[216:219], a[168:171], v[20:23]
    v_exp_f32_e64 v128, v48
    v_mfma_f32_16x16x32_bf16 v[20:23], a[220:223], a[172:175], v[20:23]
    v_exp_f32_e64 v129, v49
    v_mfma_f32_16x16x32_bf16 v[28:31], a[208:211], a[176:179], v[92:95]
    ds_read_b128 a[204:207], v241 offset:14336
    v_cvt_pk_bf16_f32 v118, v140, v141
    v_mfma_f32_16x16x32_bf16 v[28:31], a[212:215], a[180:183], v[28:31]
    v_exp_f32_e64 v130, v50
    v_mfma_f32_16x16x32_bf16 v[28:31], a[216:219], a[184:187], v[28:31]
    v_exp_f32_e64 v131, v51
    v_mfma_f32_16x16x32_bf16 v[28:31], a[220:223], a[188:191], v[28:31]
    v_or3_b32 v208, v208, v117, v118
    s_waitcnt lgkmcnt(8)
    v_mfma_f32_16x16x32_bf16 a[0:3], a[224:227], v[96:99], a[0:3]
    ds_read_b128 a[208:211], v241 offset:9216
    v_cvt_pk_bf16_f32 v119, v142, v143
    v_mfma_f32_16x16x32_bf16 a[32:35], a[224:227], v[100:103], a[32:35]
    buffer_load_dwordx4 v242, s[16:19], s41 offen offset:2048 sc1 lds
    v_cvt_pk_bf16_f32 v120, v128, v129
    v_mfma_f32_16x16x32_bf16 a[64:67], a[224:227], v[104:107], a[64:67]
    v_exp_f32 v132, v52
    v_mfma_f32_16x16x32_bf16 a[96:99], a[224:227], v[108:111], a[96:99]
    v_exp_f32_e64 v133, v53
    v_mfma_f32_16x16x32_bf16 a[4:7], a[228:231], v[96:99], a[4:7]
    ds_read_b128 a[212:215], v241 offset:11264
    v_or3_b32 v208, v208, v119, v120
    v_mfma_f32_16x16x32_bf16 a[36:39], a[228:231], v[100:103], a[36:39]
    v_exp_f32_e64 v134, v54
    v_mfma_f32_16x16x32_bf16 a[68:71], a[228:231], v[104:107], a[68:71]
    v_exp_f32_e64 v135, v55
    v_mfma_f32_16x16x32_bf16 a[100:103], a[228:231], v[108:111], a[100:103]
    v_exp_f32_e64 v136, v56
    v_mfma_f32_16x16x32_bf16 a[8:11], a[232:235], v[96:99], a[8:11]
    ds_read_b128 a[216:219], v241 offset:13312
    v_cvt_pk_bf16_f32 v121, v130, v131
    v_mfma_f32_16x16x32_bf16 a[40:43], a[232:235], v[100:103], a[40:43]
    v_exp_f32_e64 v137, v57
    v_mfma_f32_16x16x32_bf16 a[72:75], a[232:235], v[104:107], a[72:75]
    v_cvt_pk_bf16_f32 v122, v132, v133
    v_or3_b32 v208, v208, v121, v122
    v_mfma_f32_16x16x32_bf16 a[104:107], a[232:235], v[108:111], a[104:107]
    buffer_load_dwordx4 v242, s[16:19], s41 offen offset:3072 sc1 lds
    v_cvt_pk_bf16_f32 v123, v134, v135
    v_mfma_f32_16x16x32_bf16 a[12:15], a[236:239], v[96:99], a[12:15]
    ds_read_b128 a[220:223], v241 offset:15360
    v_cvt_pk_bf16_f32 v124, v136, v137
    v_mfma_f32_16x16x32_bf16 a[44:47], a[236:239], v[100:103], a[44:47]
    v_exp_f32_e64 v138, v58
    v_mfma_f32_16x16x32_bf16 a[76:79], a[236:239], v[104:107], a[76:79]
    v_exp_f32_e64 v139, v59
    v_mfma_f32_16x16x32_bf16 a[108:111], a[236:239], v[108:111], a[108:111]
    v_or3_b32 v208, v208, v123, v124
    s_waitcnt lgkmcnt(8)
    v_mfma_f32_16x16x32_bf16 a[16:19], a[240:243], v[96:99], a[16:19]
    ds_read_b128 a[224:227], v241 offset:24576
    v_cvt_pk_bf16_f32 v125, v138, v139
    v_mfma_f32_16x16x32_bf16 a[48:51], a[240:243], v[100:103], a[48:51]
    v_exp_f32 v140, v60
    v_mfma_f32_16x16x32_bf16 a[80:83], a[240:243], v[104:107], a[80:83]
    v_exp_f32_e64 v141, v61
    v_mfma_f32_16x16x32_bf16 a[112:115], a[240:243], v[108:111], a[112:115]
    v_exp_f32_e64 v142, v62
    v_mfma_f32_16x16x32_bf16 a[20:23], a[244:247], v[96:99], a[20:23]
    ds_read_b128 a[228:231], v241 offset:25600
    v_cvt_pk_bf16_f32 v126, v140, v141
    v_mfma_f32_16x16x32_bf16 a[52:55], a[244:247], v[100:103], a[52:55]
    v_exp_f32_e64 v143, v63
    v_mfma_f32_16x16x32_bf16 a[84:87], a[244:247], v[104:107], a[84:87]
    s_add_u32 s35, s35, 32768
    v_or3_b32 v208, v208, v125, v126
    v_mfma_f32_16x16x32_bf16 a[116:119], a[244:247], v[108:111], a[116:119]
    s_cmp_ge_u32 s35, 163840
    s_cselect_b32 s35, 0, s35
    v_mfma_f32_16x16x32_bf16 a[24:27], a[248:251], v[96:99], a[24:27]
    ds_read_b128 a[232:235], v241 offset:26624
    v_cvt_pk_bf16_f32 v127, v142, v143
    v_mfma_f32_16x16x32_bf16 a[56:59], a[248:251], v[100:103], a[56:59]
    v_or_b32 v208, v208, v127
    v_and_b32_e64 v208, s38, v208
    v_mfma_f32_16x16x32_bf16 a[88:91], a[248:251], v[104:107], a[88:91]
    v_cmp_ne_u32_e64 vcc, 0, v208
    v_mfma_f32_16x16x32_bf16 a[120:123], a[248:251], v[108:111], a[120:123]
    v_mfma_f32_16x16x32_bf16 a[28:31], a[252:255], v[96:99], a[28:31]
    ds_read_b128 a[236:239], v241 offset:27648
    v_mfma_f32_16x16x32_bf16 a[60:63], a[252:255], v[100:103], a[60:63]
    v_mfma_f32_16x16x32_bf16 a[92:95], a[252:255], v[104:107], a[92:95]
    v_mfma_f32_16x16x32_bf16 a[124:127], a[252:255], v[108:111], a[124:127]
    v_mfma_f32_16x16x32_bf16 v[144:147], v[204:207], v[96:99], v[144:147]
    v_mfma_f32_16x16x32_bf16 v[148:151], v[204:207], v[100:103], v[148:151]
    v_mfma_f32_16x16x32_bf16 v[152:155], v[204:207], v[104:107], v[152:155]
    v_mfma_f32_16x16x32_bf16 v[156:159], v[204:207], v[108:111], v[156:159]
    s_cbranch_vccnz kf_rare22
kf_rr21:
    s_sub_u32 s36, s36, 1
    s_cbranch_scc1 kf_fix27
kf_fixr28:
    s_waitcnt lgkmcnt(8)
    v_mfma_f32_16x16x32_bf16 v[32:35], a[192:195], a[128:131], v[64:67]
    ds_read_b128 a[240:243], v241 offset:28672
    s_add_u32 m0, s34, 16384
    v_mfma_f32_16x16x32_bf16 v[32:35], a[196:199], a[132:135], v[32:35]
    v_exp_f32_e64 v128, v0
    v_mfma_f32_16x16x32_bf16 v[32:35], a[200:203], a[136:139], v[32:35]
    v_exp_f32_e64 v129, v1
    v_mfma_f32_16x16x32_bf16 v[32:35], a[204:207], a[140:143], v[32:35]
    v_exp_f32_e64 v130, v2
    v_mfma_f32_16x16x32_bf16 v[40:43], a[192:195], a[144:147], v[72:75]
    ds_read_b128 a[244:247], v241 offset:29696
    s_add_u32 s34, s34, 32768
    v_mfma_f32_16x16x32_bf16 v[40:43], a[196:199], a[148:151], v[40:43]
    s_cmp_ge_u32 s34, 163840
    s_cselect_b32 s34, s37, s34
    v_mfma_f32_16x16x32_bf16 v[40:43], a[200:203], a[152:155], v[40:43]
    v_exp_f32 v131, v3
    v_mfma_f32_16x16x32_bf16 v[40:43], a[204:207], a[156:159], v[40:43]
    v_exp_f32_e64 v132, v4
    v_mfma_f32_16x16x32_bf16 v[48:51], a[192:195], a[160:163], v[80:83]
    ds_read_b128 a[248:251], v241 offset:30720
    v_cvt_pk_bf16_f32 v96, v128, v129
    v_mfma_f32_16x16x32_bf16 v[48:51], a[196:199], a[164:167], v[48:51]
    v_exp_f32_e64 v133, v5
    v_mfma_f32_16x16x32_bf16 v[48:51], a[200:203], a[168:171], v[48:51]
    v_exp_f32_e64 v134, v6
    v_mfma_f32_16x16x32_bf16 v[48:51], a[204:207], a[172:175], v[48:51]
    v_exp_f32_e64 v135, v7
    v_mfma_f32_16x16x32_bf16 v[56:59], a[192:195], a[176:179], v[88:91]
    ds_read_b128 a[252:255], v241 offset:31744
    v_cvt_pk_bf16_f32 v97, v130, v131
    v_mfma_f32_16x16x32_bf16 v[56:59], a[196:199], a[180:183], v[56:59]
    v_exp_f32_e64 v136, v8
    v_mfma_f32_16x16x32_bf16 v[56:59], a[200:203], a[184:187], v[56:59]
    buffer_load_dwordx4 v242, s[16:19], s42 offen offset:0 sc1 lds
    v_cvt_pk_bf16_f32 v98, v132, v133
    v_mfma_f32_16x16x32_bf16 v[56:59], a[204:207], a[188:191], v[56:59]
    v_or3_b32 v208, v96, v97, v98
    s_waitcnt lgkmcnt(8)
    v_mfma_f32_16x16x32_bf16 v[36:39], a[208:211], a[128:131], v[68:71]
    s_waitcnt vmcnt(13)
    s_barrier
    v_add_u32 v241, s35, v240
    ds_read_b128 a[192:195], v241 offset:0
    v_mfma_f32_16x16x32_bf16 v[36:39], a[212:215], a[132:135], v[36:39]
    v_exp_f32_e64 v137, v9
    v_mfma_f32_16x16x32_bf16 v[36:39], a[216:219], a[136:139], v[36:39]
    v_exp_f32_e64 v138, v10
    v_mfma_f32_16x16x32_bf16 v[36:39], a[220:223], a[140:143], v[36:39]
    v_exp_f32_e64 v139, v11
    v_mfma_f32_16x16x32_bf16 v[44:47], a[208:211], a[144:147], v[76:79]
    ds_read_b128 a[196:199], v241 offset:2048
    v_cvt_pk_bf16_f32 v99, v134, v135
    v_mfma_f32_16x16x32_bf16 v[44:47], a[212:215], a[148:151], v[44:47]
    v_exp_f32_e64 v140, v12
    v_mfma_f32_16x16x32_bf16 v[44:47], a[216:219], a[152:155], v[44:47]
    v_exp_f32_e64 v141, v13
    v_mfma_f32_16x16x32_bf16 v[44:47], a[220:223], a[156:159], v[44:47]
    v_cvt_pk_bf16_f32 v100, v136, v137
    v_or3_b32 v208, v208, v99, v100
    v_mfma_f32_16x16x32_bf16 v[52:55], a[208:211], a[160:163], v[84:87]
    ds_read_b128 a[200:203], v241 offset:4096
    v_cvt_pk_bf16_f32 v101, v138, v139
    v_mfma_f32_16x16x32_bf16 v[52:55], a[212:215], a[164:167], v[52:55]
    v_exp_f32_e64 v142, v14
    v_mfma_f32_16x16x32_bf16 v[52:55], a[216:219], a[168:171], v[52:55]
    buffer_load_dwordx4 v242, s[16:19], s42 offen offset:1024 sc1 lds
    v_cvt_pk_bf16_f32 v102, v140, v141
    v_mfma_f32_16x16x32_bf16 v[52:55], a[220:223], a[172:175], v[52:55]
    v_exp_f32_e64 v143, v15
    v_mfma_f32_16x16x32_bf16 v[60:63], a[208:211], a[176:179], v[92:95]
    ds_read_b128 a[204:207], v241 offset:6144
    v_or3_b32 v208, v208, v101, v102
    v_mfma_f32_16x16x32_bf16 v[60:63], a[212:215], a[180:183], v[60:63]
    v_exp_f32_e64 v128, v16
    v_mfma_f32_16x16x32_bf16 v[60:63], a[216:219], a[184:187], v[60:63]
    v_exp_f32_e64 v129, v17
    v_mfma_f32_16x16x32_bf16 v[60:63], a[220:223], a[188:191], v[60:63]
    v_cvt_pk_bf16_f32 v103, v142, v143
    s_waitcnt lgkmcnt(8)
    v_mfma_f32_16x16x32_bf16 a[0:3], a[224:227], v[112:115], a[0:3]
    ds_read_b128 a[208:211], v241 offset:1024
    v_cvt_pk_bf16_f32 v104, v128, v129
    v_mfma_f32_16x16x32_bf16 a[32:35], a[224:227], v[116:119], a[32:35]
    v_exp_f32 v130, v18
    v_mfma_f32_16x16x32_bf16 a[64:67], a[224:227], v[120:123], a[64:67]
    v_exp_f32_e64 v131, v19
    v_mfma_f32_16x16x32_bf16 a[96:99], a[224:227], v[124:127], a[96:99]
    v_exp_f32_e64 v132, v20
    v_mfma_f32_16x16x32_bf16 a[4:7], a[228:231], v[112:115], a[4:7]
    ds_read_b128 a[212:215], v241 offset:3072
    v_or3_b32 v208, v208, v103, v104
    v_mfma_f32_16x16x32_bf16 a[36:39], a[228:231], v[116:119], a[36:39]
    v_exp_f32_e64 v133, v21
    v_mfma_f32_16x16x32_bf16 a[68:71], a[228:231], v[120:123], a[68:71]
    v_exp_f32_e64 v134, v22
    v_mfma_f32_16x16x32_bf16 a[100:103], a[228:231], v[124:127], a[100:103]
    buffer_load_dwordx4 v242, s[16:19], s42 offen offset:2048 sc1 lds
    v_cvt_pk_bf16_f32 v105, v130, v131
    v_mfma_f32_16x16x32_bf16 a[8:11], a[232:235], v[112:115], a[8:11]
    ds_read_b128 a[216:219], v241 offset:5120
    v_cvt_pk_bf16_f32 v106, v132, v133
    v_mfma_f32_16x16x32_bf16 a[40:43], a[232:235], v[116:119], a[40:43]
    v_exp_f32_e64 v135, v23
    v_mfma_f32_16x16x32_bf16 a[72:75], a[232:235], v[120:123], a[72:75]
    v_exp_f32_e64 v136, v24
    v_mfma_f32_16x16x32_bf16 a[104:107], a[232:235], v[124:127], a[104:107]
    v_exp_f32_e64 v137, v25
    v_mfma_f32_16x16x32_bf16 a[12:15], a[236:239], v[112:115], a[12:15]
    ds_read_b128 a[220:223], v241 offset:7168
    v_or3_b32 v208, v208, v105, v106
    v_mfma_f32_16x16x32_bf16 a[44:47], a[236:239], v[116:119], a[44:47]
    v_exp_f32_e64 v138, v26
    v_mfma_f32_16x16x32_bf16 a[76:79], a[236:239], v[120:123], a[76:79]
    v_exp_f32_e64 v139, v27
    v_mfma_f32_16x16x32_bf16 a[108:111], a[236:239], v[124:127], a[108:111]
    v_cvt_pk_bf16_f32 v107, v134, v135
    s_waitcnt lgkmcnt(8)
    v_mfma_f32_16x16x32_bf16 a[16:19], a[240:243], v[112:115], a[16:19]
    ds_read_b128 a[224:227], v241 offset:16384
    v_cvt_pk_bf16_f32 v108, v136, v137
    v_mfma_f32_16x16x32_bf16 a[48:51], a[240:243], v[116:119], a[48:51]
    v_exp_f32 v140, v28
    v_mfma_f32_16x16x32_bf16 a[80:83], a[240:243], v[120:123], a[80:83]
    v_exp_f32_e64 v141, v29
    v_mfma_f32_16x16x32_bf16 a[112:115], a[240:243], v[124:127], a[112:115]
    v_exp_f32_e64 v142, v30
    v_mfma_f32_16x16x32_bf16 a[20:23], a[244:247], v[112:115], a[20:23]
    ds_read_b128 a[228:231], v241 offset:17408
    buffer_load_dwordx4 v242, s[16:19], s42 offen offset:3072 sc1 lds
    v_mfma_f32_16x16x32_bf16 a[52:55], a[244:247], v[116:119], a[52:55]
    s_add_u32 s42, s42, 34048
    v_or3_b32 v208, v208, v107, v108
    v_mfma_f32_16x16x32_bf16 a[84:87], a[244:247], v[120:123], a[84:87]
    v_exp_f32_e64 v143, v31
    v_mfma_f32_16x16x32_bf16 a[116:119], a[244:247], v[124:127], a[116:119]
    v_cvt_pk_bf16_f32 v109, v138, v139
    v_cvt_pk_bf16_f32 v110, v140, v141
    v_mfma_f32_16x16x32_bf16 a[24:27], a[248:251], v[112:115], a[24:27]
    ds_read_b128 a[232:235], v241 offset:18432
    v_or3_b32 v208, v208, v109, v110
    v_mfma_f32_16x16x32_bf16 a[56:59], a[248:251], v[116:119], a[56:59]
    v_cvt_pk_bf16_f32 v111, v142, v143
    v_or_b32_e64 v208, v208, v111
    v_mfma_f32_16x16x32_bf16 a[88:91], a[248:251], v[120:123], a[88:91]
    v_and_b32 v208, s38, v208
    v_cmp_ne_u32 vcc, 0, v208
    v_mfma_f32_16x16x32_bf16 a[120:123], a[248:251], v[124:127], a[120:123]
    v_mfma_f32_16x16x32_bf16 a[28:31], a[252:255], v[112:115], a[28:31]
    ds_read_b128 a[236:239], v241 offset:19456
    v_mfma_f32_16x16x32_bf16 a[60:63], a[252:255], v[116:119], a[60:63]
    v_mfma_f32_16x16x32_bf16 a[92:95], a[252:255], v[120:123], a[92:95]
    v_mfma_f32_16x16x32_bf16 a[124:127], a[252:255], v[124:127], a[124:127]
    v_mfma_f32_16x16x32_bf16 v[144:147], v[204:207], v[112:115], v[144:147]
    v_mfma_f32_16x16x32_bf16 v[148:151], v[204:207], v[116:119], v[148:151]
    v_mfma_f32_16x16x32_bf16 v[152:155], v[204:207], v[120:123], v[152:155]
    v_mfma_f32_16x16x32_bf16 v[156:159], v[204:207], v[124:127], v[156:159]
    s_cbranch_vccnz kf_rare26
kf_rr25:
ka_p1r_e:
    s_sub_u32 s26, s26, 1
    s_cbranch_scc0 ka_p1r
    s_branch ka_p1r_x
kf_fix23:
    s_mov_b32 s24, 0
    s_branch kf_fix23c
kf_fix27:
    s_mov_b32 s24, 1
kf_fix23c:
    s_cmp_eq_u32 s33, 0
    s_cbranch_scc0 kf_fix23f
    s_mov_b32 s36, 0
    s_mov_b32 s33, 1
    v_add_f32 v64, v224, v200
    v_add_f32 v65, v224, v201
    v_add_f32 v66, v224, v202
    v_add_f32 v67, v224, v203
    v_add_f32 v68, v224, v209
    v_add_f32 v69, v224, v210
    v_add_f32 v70, v224, v211
    v_add_f32 v71, v224, v212
    v_add_f32 v72, v225, v213
    v_add_f32 v73, v225, v214
    v_add_f32 v74, v225, v215
    v_add_f32 v75, v225, v216
    v_add_f32 v76, v225, v217
    v_add_f32 v77, v225, v218
    v_add_f32 v78, v225, v219
    v_add_f32 v79, v225, v220
    s_cmp_eq_u32 s24, 0
    s_cbranch_scc1 kf_fixr24
    s_branch kf_fixr28
kf_fix23f:
    s_mov_b32 s36, 0x1000
    v_mov_b32 v64, 0xf1800000
    v_mov_b32 v65, v64
    v_mov_b32 v66, v64
    v_mov_b32 v67, v64
    v_mov_b32 v68, v64
    v_mov_b32 v69, v64
    v_mov_b32 v70, v64
    v_mov_b32 v71, v64
    v_mov_b32 v72, v64
    v_mov_b32 v73, v64
    v_mov_b32 v74, v64
    v_mov_b32 v75, v64
    v_mov_b32 v76, v64
    v_mov_b32 v77, v64
    v_mov_b32 v78, v64
    v_mov_b32 v79, v64
    s_cmp_eq_u32 s24, 0
    s_cbranch_scc1 kf_fixr24
    s_branch kf_fixr28
kf_fix31:
    s_mov_b32 s24, 0
    s_branch kf_fix31c
kf_fix35:
    s_mov_b32 s24, 1
kf_fix31c:
    s_cmp_eq_u32 s33, 0
    s_cbranch_scc0 kf_fix31f
    s_mov_b32 s36, 0
    s_mov_b32 s33, 1
    v_add_f32 v80, v226, v200
    v_add_f32 v81, v226, v201
    v_add_f32 v82, v226, v202
    v_add_f32 v83, v226, v203
    v_add_f32 v84, v226, v209
    v_add_f32 v85, v226, v210
    v_add_f32 v86, v226, v211
    v_add_f32 v87, v226, v212
    v_add_f32 v88, v227, v213
    v_add_f32 v89, v227, v214
    v_add_f32 v90, v227, v215
    v_add_f32 v91, v227, v216
    v_add_f32 v92, v227, v217
    v_add_f32 v93, v227, v218
    v_add_f32 v94, v227, v219
    v_add_f32 v95, v227, v220
    s_cmp_eq_u32 s24, 0
    s_cbranch_scc1 kf_fixr32
    s_branch kf_fixr36
kf_fix31f:
    s_mov_b32 s36, 0x1000
    v_mov_b32 v80, 0xf1800000
    v_mov_b32 v81, v80
    v_mov_b32 v82, v80
    v_mov_b32 v83, v80
    v_mov_b32 v84, v80
    v_mov_b32 v85, v80
    v_mov_b32 v86, v80
    v_mov_b32 v87, v80
    v_mov_b32 v88, v80
    v_mov_b32 v89, v80
    v_mov_b32 v90, v80
    v_mov_b32 v91, v80
    v_mov_b32 v92, v80
    v_mov_b32 v93, v80
    v_mov_b32 v94, v80
    v_mov_b32_e64 v95, v80
    s_cmp_eq_u32 s24, 0
    s_cbranch_scc1 kf_fixr32
    s_branch kf_fixr36
ka_p1r_x:
    s_lshl2_add_u32 s36, s5, s6
    s_lshl1_add_u32 s36, s31, s36
    s_sub_u32 s36, 61, s36
    s_mov_b32 s33, 0
    s_sub_u32 s36, s36, 1
    s_cbranch_scc1 kf_fix31
kf_fixr32:
    s_waitcnt lgkmcnt(8)
    v_mfma_f32_16x16x32_bf16 v[16:19], a[192:195], a[160:163], v[80:83]
    ds_read_b128 a[240:243], v241 offset:20480
    ds_read_b128 a[244:247], v241 offset:21504
    v_mfma_f32_16x16x32_bf16 v[16:19], a[196:199], a[164:167], v[16:19]
    s_mov_b32 m0, s34
    v_exp_f32 v128, v32
    v_mfma_f32_16x16x32_bf16 v[16:19], a[200:203], a[168:171], v[16:19]
    v_exp_f32_e64 v129, v33
    v_mfma_f32_16x16x32_bf16 v[16:19], a[204:207], a[172:175], v[16:19]
    v_exp_f32_e64 v130, v34
    v_mfma_f32_16x16x32_bf16 v[24:27], a[192:195], a[176:179], v[88:91]
    ds_read_b128 a[248:251], v241 offset:22528
    ds_read_b128 a[252:255], v241 offset:23552
    s_add_u32 s41, s42, 17664
    v_mfma_f32_16x16x32_bf16 v[24:27], a[196:199], a[180:183], v[24:27]
    v_exp_f32_e64 v131, v35
    v_mfma_f32_16x16x32_bf16 v[24:27], a[200:203], a[184:187], v[24:27]
    v_exp_f32_e64 v132, v36
    v_mfma_f32_16x16x32_bf16 v[24:27], a[204:207], a[188:191], v[24:27]
    v_exp_f32 v133, v37
    s_waitcnt lgkmcnt(8)
    v_mfma_f32_16x16x32_bf16 v[20:23], a[208:211], a[160:163], v[84:87]
    ds_read_b128 a[192:195], v241 offset:8192
    ds_read_b128 a[196:199], v241 offset:10240
    v_mfma_f32_16x16x32_bf16 v[20:23], a[212:215], a[164:167], v[20:23]
    v_exp_f32_e64 v134, v38
    v_mfma_f32_16x16x32_bf16 v[20:23], a[216:219], a[168:171], v[20:23]
    buffer_load_dwordx4 v242, s[16:19], s41 offen offset:0 sc1 lds
    v_exp_f32_e64 v135, v39
    v_mfma_f32_16x16x32_bf16 v[20:23], a[220:223], a[172:175], v[20:23]
    v_cvt_pk_bf16_f32 v112, v128, v129
    v_cvt_pk_bf16_f32 v113, v130, v131
    v_mfma_f32_16x16x32_bf16 v[28:31], a[208:211], a[176:179], v[92:95]
    ds_read_b128 a[200:203], v241 offset:12288
    ds_read_b128 a[204:207], v241 offset:14336
    v_mfma_f32_16x16x32_bf16 v[28:31], a[212:215], a[180:183], v[28:31]
    v_exp_f32_e64 v136, v40
    v_mfma_f32_16x16x32_bf16 v[28:31], a[216:219], a[184:187], v[28:31]
    v_exp_f32_e64 v137, v41
    v_cvt_pk_bf16_f32 v114, v132, v133
    v_mfma_f32_16x16x32_bf16 v[28:31], a[220:223], a[188:191], v[28:31]
    v_or3_b32 v208, v112, v113, v114
    s_waitcnt lgkmcnt(8)
    v_mfma_f32_16x16x32_bf16 a[0:3], a[224:227], v[96:99], a[0:3]
    ds_read_b128 a[208:211], v241 offset:9216
    v_cvt_pk_bf16_f32 v115, v134, v135
    v_mfma_f32_16x16x32_bf16 a[32:35], a[224:227], v[100:103], a[32:35]
    buffer_load_dwordx4 v242, s[16:19], s41 offen offset:1024 sc1 lds
    v_exp_f32 v138, v42
    v_mfma_f32_16x16x32_bf16 a[64:67], a[224:227], v[104:107], a[64:67]
    v_exp_f32_e64 v139, v43
    v_mfma_f32_16x16x32_bf16 a[96:99], a[224:227], v[108:111], a[96:99]
    v_exp_f32_e64 v140, v44
    v_mfma_f32_16x16x32_bf16 a[4:7], a[228:231], v[96:99], a[4:7]
    ds_read_b128 a[212:215], v241 offset:11264
    v_exp_f32_e64 v141, v45
    v_mfma_f32_16x16x32_bf16 a[36:39], a[228:231], v[100:103], a[36:39]
    v_cvt_pk_bf16_f32 v116, v136, v137
    v_or3_b32 v208, v208, v115, v116
    v_mfma_f32_16x16x32_bf16 a[68:71], a[228:231], v[104:107], a[68:71]
    v_exp_f32_e64 v142, v46
    v_mfma_f32_16x16x32_bf16 a[100:103], a[228:231], v[108:111], a[100:103]
    v_exp_f32_e64 v143, v47
    v_cvt_pk_bf16_f32 v117, v138, v139
    v_mfma_f32_16x16x32_bf16 a[8:11], a[232:235], v[96:99], a[8:11]
    ds_read_b128 a[216:219], v241 offset:13312
    v_cvt_pk_bf16_f32 v118, v140, v141
    v_mfma_f32_16x16x32_bf16 a[40:43], a[232:235], v[100:103], a[40:43]
    v_exp_f32_e64 v128, v48
    v_mfma_f32_16x16x32_bf16 a[72:75], a[232:235], v[104:107], a[72:75]
    v_exp_f32_e64 v129, v49
    v_mfma_f32_16x16x32_bf16 a[104:107], a[232:235], v[108:111], a[104:107]
    buffer_load_dwordx4 v242, s[16:19], s41 offen offset:2048 sc1 lds
    v_exp_f32_e64 v130, v50
    v_mfma_f32_16x16x32_bf16 a[12:15], a[236:239], v[96:99], a[12:15]
    ds_read_b128 a[220:223], v241 offset:15360
    v_or3_b32 v208, v208, v117, v118
    v_mfma_f32_16x16x32_bf16 a[44:47], a[236:239], v[100:103], a[44:47]
    v_exp_f32_e64 v131, v51
    v_mfma_f32_16x16x32_bf16 a[76:79], a[236:239], v[104:107], a[76:79]
    v_exp_f32_e64 v132, v52
    v_cvt_pk_bf16_f32 v119, v142, v143
    v_mfma_f32_16x16x32_bf16 a[108:111], a[236:239], v[108:111], a[108:111]
    v_cvt_pk_bf16_f32 v120, v128, v129
    s_waitcnt lgkmcnt(8)
    v_mfma_f32_16x16x32_bf16 a[16:19], a[240:243], v[96:99], a[16:19]
    ds_read_b128 a[224:227], v241 offset:24576
    v_or3_b32 v208, v208, v119, v120
    v_mfma_f32_16x16x32_bf16 a[48:51], a[240:243], v[100:103], a[48:51]
    buffer_load_dwordx4 v242, s[16:19], s41 offen offset:3072 sc1 lds
    v_exp_f32 v133, v53
    v_mfma_f32_16x16x32_bf16 a[80:83], a[240:243], v[104:107], a[80:83]
    v_exp_f32_e64 v134, v54
    v_mfma_f32_16x16x32_bf16 a[112:115], a[240:243], v[108:111], a[112:115]
    v_exp_f32_e64 v135, v55
    v_mfma_f32_16x16x32_bf16 a[20:23], a[244:247], v[96:99], a[20:23]
    ds_read_b128 a[228:231], v241 offset:25600
    v_exp_f32_e64 v136, v56
    v_mfma_f32_16x16x32_bf16 a[52:55], a[244:247], v[100:103], a[52:55]
    v_exp_f32_e64 v137, v57
    v_mfma_f32_16x16x32_bf16 a[84:87], a[244:247], v[104:107], a[84:87]
    v_cvt_pk_bf16_f32 v121, v130, v131
    v_cvt_pk_bf16_f32 v122, v132, v133
    v_mfma_f32_16x16x32_bf16 a[116:119], a[244:247], v[108:111], a[116:119]
    v_exp_f32_e64 v138, v58
    v_mfma_f32_16x16x32_bf16 a[24:27], a[248:251], v[96:99], a[24:27]
    ds_read_b128 a[232:235], v241 offset:26624
    v_exp_f32_e64 v139, v59
    v_mfma_f32_16x16x32_bf16 a[56:59], a[248:251], v[100:103], a[56:59]
    v_or3_b32 v208, v208, v121, v122
    s_add_u32 s35, s35, 32768
    v_mfma_f32_16x16x32_bf16 a[88:91], a[248:251], v[104:107], a[88:91]
    s_cmp_ge_u32 s35, 163840
    s_cselect_b32 s35, 0, s35
    v_mfma_f32_16x16x32_bf16 a[120:123], a[248:251], v[108:111], a[120:123]
    v_exp_f32 v140, v60
    v_cvt_pk_bf16_f32 v123, v134, v135
    v_mfma_f32_16x16x32_bf16 a[28:31], a[252:255], v[96:99], a[28:31]
    ds_read_b128 a[236:239], v241 offset:27648
    v_cvt_pk_bf16_f32 v124, v136, v137
    v_mfma_f32_16x16x32_bf16 a[60:63], a[252:255], v[100:103], a[60:63]
    v_exp_f32_e64 v141, v61
    v_mfma_f32_16x16x32_bf16 a[92:95], a[252:255], v[104:107], a[92:95]
    v_exp_f32_e64 v142, v62
    v_or3_b32 v208, v208, v123, v124
    v_mfma_f32_16x16x32_bf16 a[124:127], a[252:255], v[108:111], a[124:127]
    v_exp_f32_e64 v143, v63
    v_mfma_f32_16x16x32_bf16 v[144:147], v[204:207], v[96:99], v[144:147]
    v_cvt_pk_bf16_f32 v125, v138, v139
    v_cvt_pk_bf16_f32 v126, v140, v141
    v_mfma_f32_16x16x32_bf16 v[148:151], v[204:207], v[100:103], v[148:151]
    v_or3_b32 v208, v208, v125, v126
    v_cvt_pk_bf16_f32 v127, v142, v143
    v_or_b32_e64 v208, v208, v127
    v_mfma_f32_16x16x32_bf16 v[152:155], v[204:207], v[104:107], v[152:155]
    v_and_b32 v208, s38, v208
    v_cmp_ne_u32 vcc, 0, v208
    v_mfma_f32_16x16x32_bf16 v[156:159], v[204:207], v[108:111], v[156:159]
    s_cbranch_vccnz kf_rare30
kf_rr29:
    s_sub_u32 s36, s36, 1
    s_cbranch_scc1 kf_fix35
kf_fixr36:
    s_waitcnt lgkmcnt(8)
    v_mfma_f32_16x16x32_bf16 v[48:51], a[192:195], a[160:163], v[80:83]
    ds_read_b128 a[240:243], v241 offset:28672
    ds_read_b128 a[244:247], v241 offset:29696
    v_mfma_f32_16x16x32_bf16 v[48:51], a[196:199], a[164:167], v[48:51]
    v_exp_f32_e64 v128, v16
    v_mfma_f32_16x16x32_bf16 v[48:51], a[200:203], a[168:171], v[48:51]
    v_exp_f32_e64 v129, v17
    v_mfma_f32_16x16x32_bf16 v[48:51], a[204:207], a[172:175], v[48:51]
    s_add_u32 m0, s34, 16384
    s_add_u32 s34, s34, 32768
    v_mfma_f32_16x16x32_bf16 v[56:59], a[192:195], a[176:179], v[88:91]
    ds_read_b128 a[248:251], v241 offset:30720
    ds_read_b128 a[252:255], v241 offset:31744
    v_mfma_f32_16x16x32_bf16 v[56:59], a[196:199], a[180:183], v[56:59]
    s_cmp_ge_u32 s34, 163840
    s_cselect_b32 s34, s37, s34
    v_mfma_f32_16x16x32_bf16 v[56:59], a[200:203], a[184:187], v[56:59]
    v_exp_f32 v130, v18
    v_mfma_f32_16x16x32_bf16 v[56:59], a[204:207], a[188:191], v[56:59]
    v_cvt_pk_bf16_f32 v104, v128, v129
    s_waitcnt lgkmcnt(8)
    v_mfma_f32_16x16x32_bf16 v[52:55], a[208:211], a[160:163], v[84:87]
    s_waitcnt vmcnt(12)
    s_barrier
    v_add_u32 v241, s35, v240
    ds_read_b128 a[192:195], v241 offset:0
    v_mfma_f32_16x16x32_bf16 v[52:55], a[212:215], a[164:167], v[52:55]
    v_exp_f32_e64 v131, v19
    v_mfma_f32_16x16x32_bf16 v[52:55], a[216:219], a[168:171], v[52:55]
    ds_read_b128 a[196:199], v241 offset:2048
    buffer_load_dwordx4 v242, s[16:19], s42 offen offset:0 sc1 lds
    v_mfma_f32_16x16x32_bf16 v[52:55], a[220:223], a[172:175], v[52:55]
    v_exp_f32_e64 v132, v20
    v_mfma_f32_16x16x32_bf16 v[60:63], a[208:211], a[176:179], v[92:95]
    ds_read_b128 a[200:203], v241 offset:4096
    ds_read_b128 a[204:207], v241 offset:6144
    v_mfma_f32_16x16x32_bf16 v[60:63], a[212:215], a[180:183], v[60:63]
    v_exp_f32_e64 v133, v21
    v_mfma_f32_16x16x32_bf16 v[60:63], a[216:219], a[184:187], v[60:63]
    v_exp_f32_e64 v134, v22
    v_mfma_f32_16x16x32_bf16 v[60:63], a[220:223], a[188:191], v[60:63]
    v_cvt_pk_bf16_f32 v105, v130, v131
    s_waitcnt lgkmcnt(8)
    v_mfma_f32_16x16x32_bf16 a[0:3], a[224:227], v[112:115], a[0:3]
    ds_read_b128 a[208:211], v241 offset:1024
    v_cvt_pk_bf16_f32 v106, v132, v133
    v_mfma_f32_16x16x32_bf16 a[32:35], a[224:227], v[116:119], a[32:35]
    v_exp_f32 v135, v23
    v_mfma_f32_16x16x32_bf16 a[64:67], a[224:227], v[120:123], a[64:67]
    v_exp_f32_e64 v136, v24
    v_mfma_f32_16x16x32_bf16 a[96:99], a[224:227], v[124:127], a[96:99]
    v_exp_f32_e64 v137, v25
    v_mfma_f32_16x16x32_bf16 a[4:7], a[228:231], v[112:115], a[4:7]
    ds_read_b128 a[212:215], v241 offset:3072
    buffer_load_dwordx4 v242, s[16:19], s42 offen offset:1024 sc1 lds
    v_mfma_f32_16x16x32_bf16 a[36:39], a[228:231], v[116:119], a[36:39]
    v_exp_f32_e64 v138, v26
    v_mfma_f32_16x16x32_bf16 a[68:71], a[228:231], v[120:123], a[68:71]
    v_exp_f32_e64 v139, v27
    v_mfma_f32_16x16x32_bf16 a[100:103], a[228:231], v[124:127], a[100:103]
    v_or3_b32 v208, v104, v105, v106
    v_cvt_pk_bf16_f32 v107, v134, v135
    v_mfma_f32_16x16x32_bf16 a[8:11], a[232:235], v[112:115], a[8:11]
    ds_read_b128 a[216:219], v241 offset:5120
    v_cvt_pk_bf16_f32 v108, v136, v137
    v_mfma_f32_16x16x32_bf16 a[40:43], a[232:235], v[116:119], a[40:43]
    v_exp_f32_e64 v140, v28
    v_mfma_f32_16x16x32_bf16 a[72:75], a[232:235], v[120:123], a[72:75]
    v_exp_f32_e64 v141, v29
    v_mfma_f32_16x16x32_bf16 a[104:107], a[232:235], v[124:127], a[104:107]
    v_exp_f32_e64 v142, v30
    v_mfma_f32_16x16x32_bf16 a[12:15], a[236:239], v[112:115], a[12:15]
    ds_read_b128 a[220:223], v241 offset:7168
    v_or3_b32 v208, v208, v107, v108
    v_mfma_f32_16x16x32_bf16 a[44:47], a[236:239], v[116:119], a[44:47]
    buffer_load_dwordx4 v242, s[16:19], s42 offen offset:2048 sc1 lds
    v_cvt_pk_bf16_f32 v109, v138, v139
    v_mfma_f32_16x16x32_bf16 a[76:79], a[236:239], v[120:123], a[76:79]
    v_exp_f32_e64 v143, v31
    v_mfma_f32_16x16x32_bf16 a[108:111], a[236:239], v[124:127], a[108:111]
    v_cvt_pk_bf16_f32 v110, v140, v141
    s_waitcnt lgkmcnt(8)
    v_mfma_f32_16x16x32_bf16 a[16:19], a[240:243], v[112:115], a[16:19]
    ds_read_b128 a[224:227], v241 offset:16384
    v_or3_b32 v208, v208, v109, v110
    v_mfma_f32_16x16x32_bf16 a[48:51], a[240:243], v[116:119], a[48:51]
    v_cvt_pk_bf16_f32 v111, v142, v143
    v_or_b32 v208, v208, v111
    v_mfma_f32_16x16x32_bf16 a[80:83], a[240:243], v[120:123], a[80:83]
    v_and_b32 v208, s38, v208
    v_cmp_ne_u32 vcc, 0, v208
    v_mfma_f32_16x16x32_bf16 a[112:115], a[240:243], v[124:127], a[112:115]
    buffer_load_dwordx4 v242, s[16:19], s42 offen offset:3072 sc1 lds
    s_add_u32 s42, s42, 34048
    v_mfma_f32_16x16x32_bf16 a[20:23], a[244:247], v[112:115], a[20:23]
    ds_read_b128 a[228:231], v241 offset:17408
    v_mfma_f32_16x16x32_bf16 a[52:55], a[244:247], v[116:119], a[52:55]
    v_mfma_f32_16x16x32_bf16 a[84:87], a[244:247], v[120:123], a[84:87]
    v_mfma_f32_16x16x32_bf16 a[116:119], a[244:247], v[124:127], a[116:119]
    v_mfma_f32_16x16x32_bf16 a[24:27], a[248:251], v[112:115], a[24:27]
    ds_read_b128 a[232:235], v241 offset:18432
    v_mfma_f32_16x16x32_bf16 a[56:59], a[248:251], v[116:119], a[56:59]
    v_mfma_f32_16x16x32_bf16 a[88:91], a[248:251], v[120:123], a[88:91]
    v_mfma_f32_16x16x32_bf16 a[120:123], a[248:251], v[124:127], a[120:123]
    v_mfma_f32_16x16x32_bf16 a[28:31], a[252:255], v[112:115], a[28:31]
    ds_read_b128 a[236:239], v241 offset:19456
    v_mfma_f32_16x16x32_bf16 a[60:63], a[252:255], v[116:119], a[60:63]
    v_mfma_f32_16x16x32_bf16 a[92:95], a[252:255], v[120:123], a[92:95]
    v_mfma_f32_16x16x32_bf16 a[124:127], a[252:255], v[124:127], a[124:127]
    v_mfma_f32_16x16x32_bf16 v[144:147], v[204:207], v[112:115], v[144:147]
    v_mfma_f32_16x16x32_bf16 v[148:151], v[204:207], v[116:119], v[148:151]
    v_mfma_f32_16x16x32_bf16 v[152:155], v[204:207], v[120:123], v[152:155]
    v_mfma_f32_16x16x32_bf16 v[156:159], v[204:207], v[124:127], v[156:159]
    s_cbranch_vccnz kf_rare34
kf_rr33:
    s_nop 6
    v_rcp_f32 v230, v144
    v_rcp_f32 v231, v148
    v_accvgpr_read_b32 v160, a0
    v_accvgpr_read_b32 v161, a1
    v_accvgpr_read_b32 v162, a2
    v_accvgpr_read_b32 v163, a3
    v_accvgpr_read_b32 v164, a4
    v_accvgpr_read_b32 v165, a5
    v_accvgpr_read_b32 v166, a6
    v_accvgpr_read_b32 v167, a7
    v_mul_f32 v160, v160, v230
    v_mul_f32 v161, v161, v230
    v_mul_f32 v162, v162, v230
    v_mul_f32 v163, v163, v230
    v_mul_f32 v164, v164, v230
    v_mul_f32 v165, v165, v230
    v_mul_f32 v166, v166, v230
    v_mul_f32 v167, v167, v230
    v_cvt_pk_bf16_f32 v176, v160, v161
    v_cvt_pk_bf16_f32 v177, v162, v163
    v_cvt_pk_bf16_f32 v178, v164, v165
    v_cvt_pk_bf16_f32 v179, v166, v167
    buffer_store_dwordx4 v[176:179], v240, s[20:23], s39 offen offset:0 sc1
    v_accvgpr_read_b32 v168, a8
    v_accvgpr_read_b32 v169, a9
    v_accvgpr_read_b32 v170, a10
    v_accvgpr_read_b32 v171, a11
    v_accvgpr_read_b32 v172, a12
    v_accvgpr_read_b32 v173, a13
    v_accvgpr_read_b32 v174, a14
    v_accvgpr_read_b32 v175, a15
    v_mul_f32 v168, v168, v230
    v_mul_f32 v169, v169, v230
    v_mul_f32 v170, v170, v230
    v_mul_f32 v171, v171, v230
    v_mul_f32 v172, v172, v230
    v_mul_f32 v173, v173, v230
    v_mul_f32 v174, v174, v230
    v_mul_f32 v175, v175, v230
    v_cvt_pk_bf16_f32 v180, v168, v169
    v_cvt_pk_bf16_f32 v181, v170, v171
    v_cvt_pk_bf16_f32 v182, v172, v173
    v_cvt_pk_bf16_f32 v183, v174, v175
    buffer_store_dwordx4 v[180:183], v240, s[20:23], s39 offen offset:1024 sc1
    v_accvgpr_read_b32 v160, a16
    v_accvgpr_read_b32 v161, a17
    v_accvgpr_read_b32 v162, a18
    v_accvgpr_read_b32 v163, a19
    v_accvgpr_read_b32 v164, a20
    v_accvgpr_read_b32 v165, a21
    v_accvgpr_read_b32 v166, a22
    v_accvgpr_read_b32 v167, a23
    v_mul_f32 v160, v160, v230
    v_mul_f32 v161, v161, v230
    v_mul_f32 v162, v162, v230
    v_mul_f32 v163, v163, v230
    v_mul_f32 v164, v164, v230
    v_mul_f32 v165, v165, v230
    v_mul_f32 v166, v166, v230
    v_mul_f32 v167, v167, v230
    v_cvt_pk_bf16_f32 v184, v160, v161
    v_cvt_pk_bf16_f32 v185, v162, v163
    v_cvt_pk_bf16_f32 v186, v164, v165
    v_cvt_pk_bf16_f32 v187, v166, v167
    buffer_store_dwordx4 v[184:187], v240, s[20:23], s39 offen offset:2048 sc1
    v_accvgpr_read_b32 v168, a24
    v_accvgpr_read_b32 v169, a25
    v_accvgpr_read_b32 v170, a26
    v_accvgpr_read_b32 v171, a27
    v_accvgpr_read_b32 v172, a28
    v_accvgpr_read_b32 v173, a29
    v_accvgpr_read_b32 v174, a30
    v_accvgpr_read_b32 v175, a31
    v_mul_f32 v168, v168, v230
    v_mul_f32 v169, v169, v230
    v_mul_f32 v170, v170, v230
    v_mul_f32 v171, v171, v230
    v_mul_f32 v172, v172, v230
    v_mul_f32 v173, v173, v230
    v_mul_f32 v174, v174, v230
    v_mul_f32 v175, v175, v230
    v_cvt_pk_bf16_f32 v188, v168, v169
    v_cvt_pk_bf16_f32 v189, v170, v171
    v_cvt_pk_bf16_f32 v190, v172, v173
    v_cvt_pk_bf16_f32 v191, v174, v175
    buffer_store_dwordx4 v[188:191], v240, s[20:23], s39 offen offset:3072 sc1
    v_accvgpr_read_b32 v160, a32
    v_accvgpr_read_b32 v161, a33
    v_accvgpr_read_b32 v162, a34
    v_accvgpr_read_b32 v163, a35
    v_accvgpr_read_b32 v164, a36
    v_accvgpr_read_b32 v165, a37
    v_accvgpr_read_b32 v166, a38
    v_accvgpr_read_b32 v167, a39
    v_mul_f32 v160, v160, v231
    v_mul_f32 v161, v161, v231
    v_mul_f32 v162, v162, v231
    v_mul_f32 v163, v163, v231
    v_mul_f32 v164, v164, v231
    v_mul_f32 v165, v165, v231
    v_mul_f32 v166, v166, v231
    v_mul_f32 v167, v167, v231
    v_cvt_pk_bf16_f32 v176, v160, v161
    v_cvt_pk_bf16_f32 v177, v162, v163
    v_cvt_pk_bf16_f32 v178, v164, v165
    v_cvt_pk_bf16_f32 v179, v166, v167
    buffer_store_dwordx4 v[176:179], v244, s[20:23], s39 offen offset:0 sc1
    v_accvgpr_read_b32 v168, a40
    v_accvgpr_read_b32 v169, a41
    v_accvgpr_read_b32 v170, a42
    v_accvgpr_read_b32 v171, a43
    v_accvgpr_read_b32 v172, a44
    v_accvgpr_read_b32 v173, a45
    v_accvgpr_read_b32 v174, a46
    v_accvgpr_read_b32 v175, a47
    v_mul_f32 v168, v168, v231
    v_mul_f32 v169, v169, v231
    v_mul_f32 v170, v170, v231
    v_mul_f32 v171, v171, v231
    v_mul_f32 v172, v172, v231
    v_mul_f32 v173, v173, v231
    v_mul_f32 v174, v174, v231
    v_mul_f32 v175, v175, v231
    v_cvt_pk_bf16_f32 v180, v168, v169
    v_cvt_pk_bf16_f32 v181, v170, v171
    v_cvt_pk_bf16_f32 v182, v172, v173
    v_cvt_pk_bf16_f32 v183, v174, v175
    buffer_store_dwordx4 v[180:183], v244, s[20:23], s39 offen offset:1024 sc1
    v_accvgpr_read_b32 v160, a48
    v_accvgpr_read_b32 v161, a49
    v_accvgpr_read_b32 v162, a50
    v_accvgpr_read_b32 v163, a51
    v_accvgpr_read_b32 v164, a52
    v_accvgpr_read_b32 v165, a53
    v_accvgpr_read_b32 v166, a54
    v_accvgpr_read_b32 v167, a55
    v_mul_f32 v160, v160, v231
    v_mul_f32 v161, v161, v231
    v_mul_f32 v162, v162, v231
    v_mul_f32 v163, v163, v231
    v_mul_f32 v164, v164, v231
    v_mul_f32 v165, v165, v231
    v_mul_f32 v166, v166, v231
    v_mul_f32 v167, v167, v231
    v_cvt_pk_bf16_f32 v184, v160, v161
    v_cvt_pk_bf16_f32 v185, v162, v163
    v_cvt_pk_bf16_f32 v186, v164, v165
    v_cvt_pk_bf16_f32 v187, v166, v167
    buffer_store_dwordx4 v[184:187], v244, s[20:23], s39 offen offset:2048 sc1
    v_accvgpr_read_b32 v168, a56
    v_accvgpr_read_b32 v169, a57
    v_accvgpr_read_b32 v170, a58
    v_accvgpr_read_b32 v171, a59
    v_accvgpr_read_b32 v172, a60
    v_accvgpr_read_b32 v173, a61
    v_accvgpr_read_b32 v174, a62
    v_accvgpr_read_b32 v175, a63
    v_mul_f32 v168, v168, v231
    v_mul_f32 v169, v169, v231
    v_mul_f32 v170, v170, v231
    v_mul_f32 v171, v171, v231
    v_mul_f32 v172, v172, v231
    v_mul_f32 v173, v173, v231
    v_mul_f32 v174, v174, v231
    v_mul_f32 v175, v175, v231
    v_cvt_pk_bf16_f32 v188, v168, v169
    v_cvt_pk_bf16_f32 v189, v170, v171
    v_cvt_pk_bf16_f32 v190, v172, v173
    v_cvt_pk_bf16_f32 v191, v174, v175
    buffer_store_dwordx4 v[188:191], v244, s[20:23], s39 offen offset:3072 sc1
    s_lshl1_add_u32 s26, s5, s31
    s_lshl_b32 s26, s26, 1
    s_sub_u32 s26, 30, s26
    s_branch ka_p2r_e
.p2align 5
ka_p2r:
    s_sub_u32 s36, s36, 1
    s_cbranch_scc1 kf_fix39
kf_fixr40:
    s_waitcnt lgkmcnt(8)
    v_mfma_f32_16x16x32_bf16 v[16:19], a[192:195], a[160:163], v[80:83]
    ds_read_b128 a[240:243], v241 offset:20480
    ds_read_b128 a[244:247], v241 offset:21504
    v_mfma_f32_16x16x32_bf16 v[16:19], a[196:199], a[164:167], v[16:19]
    v_exp_f32 v128, v48
    v_mfma_f32_16x16x32_bf16 v[16:19], a[200:203], a[168:171], v[16:19]
    s_mov_b32 m0, s34
    v_exp_f32 v129, v49
    v_mfma_f32_16x16x32_bf16 v[16:19], a[204:207], a[172:175], v[16:19]
    v_exp_f32_e64 v130, v50
    v_mfma_f32_16x16x32_bf16 v[24:27], a[192:195], a[176:179], v[88:91]
    ds_read_b128 a[248:251], v241 offset:22528
    ds_read_b128 a[252:255], v241 offset:23552
    v_mfma_f32_16x16x32_bf16 v[24:27], a[196:199], a[180:183], v[24:27]
    s_add_u32 s41, s42, 17664
    v_cvt_pk_bf16_f32 v120, v128, v129
    v_mfma_f32_16x16x32_bf16 v[24:27], a[200:203], a[184:187], v[24:27]
    buffer_load_dwordx4 v242, s[16:19], s41 offen offset:0 sc1 lds
    v_exp_f32_e64 v131, v51
    v_mfma_f32_16x16x32_bf16 v[24:27], a[204:207], a[188:191], v[24:27]
    v_cvt_pk_bf16_f32 v121, v130, v131
    s_waitcnt lgkmcnt(8)
    v_mfma_f32_16x16x32_bf16 v[20:23], a[208:211], a[160:163], v[84:87]
    ds_read_b128 a[192:195], v241 offset:8192
    ds_read_b128 a[196:199], v241 offset:10240
    v_mfma_f32_16x16x32_bf16 v[20:23], a[212:215], a[164:167], v[20:23]
    v_exp_f32 v132, v52
    v_mfma_f32_16x16x32_bf16 v[20:23], a[216:219], a[168:171], v[20:23]
    v_exp_f32_e64 v133, v53
    buffer_load_dwordx4 v242, s[16:19], s41 offen offset:1024 sc1 lds
    v_mfma_f32_16x16x32_bf16 v[20:23], a[220:223], a[172:175], v[20:23]
    v_exp_f32_e64 v134, v54
    v_mfma_f32_16x16x32_bf16 v[28:31], a[208:211], a[176:179], v[92:95]
    ds_read_b128 a[200:203], v241 offset:12288
    ds_read_b128 a[204:207], v241 offset:14336
    v_mfma_f32_16x16x32_bf16 v[28:31], a[212:215], a[180:183], v[28:31]
    v_exp_f32_e64 v135, v55
    v_mfma_f32_16x16x32_bf16 v[28:31], a[216:219], a[184:187], v[28:31]
    v_exp_f32_e64 v136, v56
    v_cvt_pk_bf16_f32 v122, v132, v133
    v_mfma_f32_16x16x32_bf16 v[28:31], a[220:223], a[188:191], v[28:31]
    v_or3_b32 v208, v120, v121, v122
    s_waitcnt lgkmcnt(8)
    v_mfma_f32_16x16x32_bf16 a[64:67], a[224:227], v[104:107], a[64:67]
    ds_read_b128 a[208:211], v241 offset:9216
    ds_read_b128 a[212:215], v241 offset:11264
    v_mfma_f32_16x16x32_bf16 a[96:99], a[224:227], v[108:111], a[96:99]
    v_exp_f32 v137, v57
    v_mfma_f32_16x16x32_bf16 a[68:71], a[228:231], v[104:107], a[68:71]
    v_exp_f32_e64 v138, v58
    v_mfma_f32_16x16x32_bf16 a[100:103], a[228:231], v[108:111], a[100:103]
    buffer_load_dwordx4 v242, s[16:19], s41 offen offset:2048 sc1 lds
    v_exp_f32_e64 v139, v59
    v_mfma_f32_16x16x32_bf16 a[72:75], a[232:235], v[104:107], a[72:75]
    ds_read_b128 a[216:219], v241 offset:13312
    ds_read_b128 a[220:223], v241 offset:15360
    v_mfma_f32_16x16x32_bf16 a[104:107], a[232:235], v[108:111], a[104:107]
    v_exp_f32_e64 v140, v60
    v_mfma_f32_16x16x32_bf16 a[76:79], a[236:239], v[104:107], a[76:79]
    buffer_load_dwordx4 v242, s[16:19], s41 offen offset:3072 sc1 lds
    v_cvt_pk_bf16_f32 v123, v134, v135
    v_mfma_f32_16x16x32_bf16 a[108:111], a[236:239], v[108:111], a[108:111]
    v_exp_f32 v141, v61
    s_waitcnt lgkmcnt(8)
    v_mfma_f32_16x16x32_bf16 a[80:83], a[240:243], v[104:107], a[80:83]
    ds_read_b128 a[224:227], v241 offset:24576
    ds_read_b128 a[228:231], v241 offset:25600
    v_mfma_f32_16x16x32_bf16 a[112:115], a[240:243], v[108:111], a[112:115]
    v_cvt_pk_bf16_f32 v124, v136, v137
    v_or3_b32 v208, v208, v123, v124
    v_mfma_f32_16x16x32_bf16 a[84:87], a[244:247], v[104:107], a[84:87]
    v_exp_f32_e64 v142, v62
    v_mfma_f32_16x16x32_bf16 a[116:119], a[244:247], v[108:111], a[116:119]
    s_add_u32 s35, s35, 32768
    s_cmp_ge_u32 s35, 163840
    s_cselect_b32 s35, 0, s35
    v_mfma_f32_16x16x32_bf16 a[88:91], a[248:251], v[104:107], a[88:91]
    ds_read_b128 a[232:235], v241 offset:26624
    ds_read_b128 a[236:239], v241 offset:27648
    v_mfma_f32_16x16x32_bf16 a[120:123], a[248:251], v[108:111], a[120:123]
    v_exp_f32 v143, v63
    v_mfma_f32_16x16x32_bf16 a[92:95], a[252:255], v[104:107], a[92:95]
    v_cvt_pk_bf16_f32 v125, v138, v139
    v_cvt_pk_bf16_f32 v126, v140, v141
    v_mfma_f32_16x16x32_bf16 a[124:127], a[252:255], v[108:111], a[124:127]
    v_or3_b32 v208, v208, v125, v126
    v_cvt_pk_bf16_f32 v127, v142, v143
    v_or_b32_e64 v208, v208, v127
    v_mfma_f32_16x16x32_bf16 v[152:155], v[204:207], v[104:107], v[152:155]
    v_and_b32 v208, s38, v208
    v_cmp_ne_u32 vcc, 0, v208
    v_mfma_f32_16x16x32_bf16 v[156:159], v[204:207], v[108:111], v[156:159]
    s_cbranch_vccnz kf_rare38
kf_rr37:
    s_sub_u32 s36, s36, 1
    s_cbranch_scc1 kf_fix43
kf_fixr44:
    s_waitcnt lgkmcnt(8)
    v_mfma_f32_16x16x32_bf16 v[48:51], a[192:195], a[160:163], v[80:83]
    ds_read_b128 a[240:243], v241 offset:28672
    ds_read_b128 a[244:247], v241 offset:29696
    v_mfma_f32_16x16x32_bf16 v[48:51], a[196:199], a[164:167], v[48:51]
    s_add_u32 m0, s34, 16384
    v_exp_f32_e64 v128, v16
    v_mfma_f32_16x16x32_bf16 v[48:51], a[200:203], a[168:171], v[48:51]
    v_exp_f32_e64 v129, v17
    v_mfma_f32_16x16x32_bf16 v[48:51], a[204:207], a[172:175], v[48:51]
    v_exp_f32_e64 v130, v18
    v_mfma_f32_16x16x32_bf16 v[56:59], a[192:195], a[176:179], v[88:91]
    ds_read_b128 a[248:251], v241 offset:30720
    ds_read_b128 a[252:255], v241 offset:31744
    s_add_u32 s34, s34, 32768
    v_mfma_f32_16x16x32_bf16 v[56:59], a[196:199], a[180:183], v[56:59]
    s_cmp_ge_u32 s34, 163840
    s_cselect_b32 s34, s37, s34
    v_mfma_f32_16x16x32_bf16 v[56:59], a[200:203], a[184:187], v[56:59]
    v_exp_f32 v131, v19
    v_mfma_f32_16x16x32_bf16 v[56:59], a[204:207], a[188:191], v[56:59]
    v_exp_f32 v132, v20
    s_waitcnt lgkmcnt(8)
    v_mfma_f32_16x16x32_bf16 v[52:55], a[208:211], a[160:163], v[84:87]
    s_waitcnt vmcnt(12)
    s_barrier
    v_add_u32_e64 v241, s35, v240
    ds_read_b128 a[192:195], v241 offset:0
    v_mfma_f32_16x16x32_bf16 v[52:55], a[212:215], a[164:167], v[52:55]
    v_exp_f32_e64 v133, v21
    v_mfma_f32_16x16x32_bf16 v[52:55], a[216:219], a[168:171], v[52:55]
    ds_read_b128 a[196:199], v241 offset:2048
    buffer_load_dwordx4 v242, s[16:19], s42 offen offset:0 sc1 lds
    v_mfma_f32_16x16x32_bf16 v[52:55], a[220:223], a[172:175], v[52:55]
    v_exp_f32_e64 v134, v22
    v_cvt_pk_bf16_f32 v104, v128, v129
    v_mfma_f32_16x16x32_bf16 v[60:63], a[208:211], a[176:179], v[92:95]
    ds_read_b128 a[200:203], v241 offset:4096
    ds_read_b128 a[204:207], v241 offset:6144
    v_mfma_f32_16x16x32_bf16 v[60:63], a[212:215], a[180:183], v[60:63]
    v_exp_f32_e64 v135, v23
    v_mfma_f32_16x16x32_bf16 v[60:63], a[216:219], a[184:187], v[60:63]
    buffer_load_dwordx4 v242, s[16:19], s42 offen offset:1024 sc1 lds
    v_exp_f32_e64 v136, v24
    v_mfma_f32_16x16x32_bf16 v[60:63], a[220:223], a[188:191], v[60:63]
    v_cvt_pk_bf16_f32 v105, v130, v131
    s_waitcnt lgkmcnt(8)
    v_mfma_f32_16x16x32_bf16 a[64:67], a[224:227], v[120:123], a[64:67]
    ds_read_b128 a[208:211], v241 offset:1024
    ds_read_b128 a[212:215], v241 offset:3072
    v_mfma_f32_16x16x32_bf16 a[96:99], a[224:227], v[124:127], a[96:99]
    v_exp_f32 v137, v25
    v_mfma_f32_16x16x32_bf16 a[68:71], a[228:231], v[120:123], a[68:71]
    v_cvt_pk_bf16_f32 v106, v132, v133
    v_exp_f32_e64 v138, v26
    v_mfma_f32_16x16x32_bf16 a[100:103], a[228:231], v[124:127], a[100:103]
    v_exp_f32_e64 v139, v27
    v_mfma_f32_16x16x32_bf16 a[72:75], a[232:235], v[120:123], a[72:75]
    ds_read_b128 a[216:219], v241 offset:5120
    ds_read_b128 a[220:223], v241 offset:7168
    v_mfma_f32_16x16x32_bf16 a[104:107], a[232:235], v[124:127], a[104:107]
    buffer_load_dwordx4 v242, s[16:19], s42 offen offset:2048 sc1 lds
    v_or3_b32 v208, v104, v105, v106
    v_cvt_pk_bf16_f32 v107, v134, v135
    v_mfma_f32_16x16x32_bf16 a[76:79], a[236:239], v[120:123], a[76:79]
    v_exp_f32_e64 v140, v28
    v_mfma_f32_16x16x32_bf16 a[108:111], a[236:239], v[124:127], a[108:111]
    v_cvt_pk_bf16_f32 v108, v136, v137
    s_waitcnt lgkmcnt(8)
    v_mfma_f32_16x16x32_bf16 a[80:83], a[240:243], v[120:123], a[80:83]
    ds_read_b128 a[224:227], v241 offset:16384
    ds_read_b128 a[228:231], v241 offset:17408
    v_or3_b32 v208, v208, v107, v108
    v_mfma_f32_16x16x32_bf16 a[112:115], a[240:243], v[124:127], a[112:115]
    v_exp_f32 v141, v29
    v_mfma_f32_16x16x32_bf16 a[84:87], a[244:247], v[120:123], a[84:87]
    v_exp_f32_e64 v142, v30
    v_mfma_f32_16x16x32_bf16 a[116:119], a[244:247], v[124:127], a[116:119]
    v_exp_f32_e64 v143, v31
    v_mfma_f32_16x16x32_bf16 a[88:91], a[248:251], v[120:123], a[88:91]
    ds_read_b128 a[232:235], v241 offset:18432
    ds_read_b128 a[236:239], v241 offset:19456
    buffer_load_dwordx4 v242, s[16:19], s42 offen offset:3072 sc1 lds
    v_mfma_f32_16x16x32_bf16 a[120:123], a[248:251], v[124:127], a[120:123]
    s_add_u32 s42, s42, 34048
    v_cvt_pk_bf16_f32 v109, v138, v139
    v_mfma_f32_16x16x32_bf16 a[92:95], a[252:255], v[120:123], a[92:95]
    v_cvt_pk_bf16_f32 v110, v140, v141
    v_or3_b32 v208, v208, v109, v110
    v_mfma_f32_16x16x32_bf16 a[124:127], a[252:255], v[124:127], a[124:127]
    v_cvt_pk_bf16_f32 v111, v142, v143
    v_or_b32 v208, v208, v111
    v_and_b32 v208, s38, v208
    v_mfma_f32_16x16x32_bf16 v[152:155], v[204:207], v[120:123], v[152:155]
    v_cmp_ne_u32_e64 vcc, 0, v208
    v_mfma_f32_16x16x32_bf16 v[156:159], v[204:207], v[124:127], v[156:159]
    s_cbranch_vccnz kf_rare42
kf_rr41:
ka_p2r_e:
    s_sub_u32 s26, s26, 1
    s_cbranch_scc0 ka_p2r
    s_branch ka_p2r_x
kf_fix39:
    s_mov_b32 s24, 0
    s_branch kf_fix39c
kf_fix43:
    s_mov_b32 s24, 1
kf_fix39c:
    s_cmp_eq_u32 s33, 0
    s_cbranch_scc0 kf_fix39f
    s_mov_b32 s36, 0
    s_mov_b32 s33, 1
    v_add_f32 v80, v226, v200
    v_add_f32 v81, v226, v201
    v_add_f32 v82, v226, v202
    v_add_f32 v83, v226, v203
    v_add_f32 v84, v226, v209
    v_add_f32 v85, v226, v210
    v_add_f32 v86, v226, v211
    v_add_f32 v87, v226, v212
    v_add_f32 v88, v227, v213
    v_add_f32 v89, v227, v214
    v_add_f32 v90, v227, v215
    v_add_f32 v91, v227, v216
    v_add_f32 v92, v227, v217
    v_add_f32 v93, v227, v218
    v_add_f32 v94, v227, v219
    v_add_f32 v95, v227, v220
    s_cmp_eq_u32 s24, 0
    s_cbranch_scc1 kf_fixr40
    s_branch kf_fixr44
kf_fix39f:
    s_mov_b32 s36, 0x1000
    v_mov_b32 v80, 0xf1800000
    v_mov_b32 v81, v80
    v_mov_b32 v82, v80
    v_mov_b32 v83, v80
    v_mov_b32 v84, v80
    v_mov_b32 v85, v80
    v_mov_b32 v86, v80
    v_mov_b32 v87, v80
    v_mov_b32 v88, v80
    v_mov_b32 v89, v80
    v_mov_b32 v90, v80
    v_mov_b32 v91, v80
    v_mov_b32 v92, v80
    v_mov_b32 v93, v80
    v_mov_b32 v94, v80
    v_mov_b32_e64 v95, v80
    s_cmp_eq_u32 s24, 0
    s_cbranch_scc1 kf_fixr40
    s_branch kf_fixr44
ka_p2r_x:
    s_waitcnt lgkmcnt(0)
    ds_read_b128 a[224:227], v241 offset:16384
    ds_read_b128 a[228:231], v241 offset:17408
    ds_read_b128 a[232:235], v241 offset:18432
    ds_read_b128 a[236:239], v241 offset:19456
    ds_read_b128 a[240:243], v241 offset:20480
    ds_read_b128 a[244:247], v241 offset:21504
    ds_read_b128 a[248:251], v241 offset:22528
    ds_read_b128 a[252:255], v241 offset:23552
    ds_read_b128 a[192:195], v241 offset:24576
    ds_read_b128 a[196:199], v241 offset:25600
    ds_read_b128 a[200:203], v241 offset:26624
    ds_read_b128 a[204:207], v241 offset:27648
    ds_read_b128 a[208:211], v241 offset:28672
    ds_read_b128 a[212:215], v241 offset:29696
    ds_read_b128 a[216:219], v241 offset:30720
    s_waitcnt lgkmcnt(7)
    ds_read_b128 a[220:223], v241 offset:31744
    v_mfma_f32_16x16x32_bf16 a[64:67], a[224:227], v[104:107], a[64:67]
    v_exp_f32 v128, v48
    v_exp_f32_e64 v129, v49
    v_mfma_f32_16x16x32_bf16 a[96:99], a[224:227], v[108:111], a[96:99]
    v_exp_f32_e64 v130, v50
    v_cvt_pk_bf16_f32 v120, v128, v129
    v_mfma_f32_16x16x32_bf16 a[68:71], a[228:231], v[104:107], a[68:71]
    v_exp_f32_e64 v131, v51
    v_mfma_f32_16x16x32_bf16 a[100:103], a[228:231], v[108:111], a[100:103]
    v_exp_f32_e64 v132, v52
    v_cvt_pk_bf16_f32 v121, v130, v131
    v_mfma_f32_16x16x32_bf16 a[72:75], a[232:235], v[104:107], a[72:75]
    v_exp_f32_e64 v133, v53
    v_mfma_f32_16x16x32_bf16 a[104:107], a[232:235], v[108:111], a[104:107]
    v_exp_f32_e64 v134, v54
    v_cvt_pk_bf16_f32 v122, v132, v133
    v_mfma_f32_16x16x32_bf16 a[76:79], a[236:239], v[104:107], a[76:79]
    v_exp_f32_e64 v135, v55
    v_or3_b32 v208, v120, v121, v122
    v_mfma_f32_16x16x32_bf16 a[108:111], a[236:239], v[108:111], a[108:111]
    v_exp_f32_e64 v136, v56
    v_cvt_pk_bf16_f32 v123, v134, v135
    v_mfma_f32_16x16x32_bf16 a[80:83], a[240:243], v[104:107], a[80:83]
    v_exp_f32_e64 v137, v57
    v_mfma_f32_16x16x32_bf16 a[112:115], a[240:243], v[108:111], a[112:115]
    v_exp_f32_e64 v138, v58
    v_cvt_pk_bf16_f32 v124, v136, v137
    v_mfma_f32_16x16x32_bf16 a[84:87], a[244:247], v[104:107], a[84:87]
    v_exp_f32_e64 v139, v59
    v_or3_b32 v208, v208, v123, v124
    v_mfma_f32_16x16x32_bf16 a[116:119], a[244:247], v[108:111], a[116:119]
    v_exp_f32_e64 v140, v60
    v_cvt_pk_bf16_f32 v125, v138, v139
    v_mfma_f32_16x16x32_bf16 a[88:91], a[248:251], v[104:107], a[88:91]
    v_exp_f32_e64 v141, v61
    v_mfma_f32_16x16x32_bf16 a[120:123], a[248:251], v[108:111], a[120:123]
    v_exp_f32_e64 v142, v62
    v_cvt_pk_bf16_f32 v126, v140, v141
    v_mfma_f32_16x16x32_bf16 a[92:95], a[252:255], v[104:107], a[92:95]
    v_exp_f32_e64 v143, v63
    v_or3_b32 v208, v208, v125, v126
    v_mfma_f32_16x16x32_bf16 a[124:127], a[252:255], v[108:111], a[124:127]
    v_cvt_pk_bf16_f32 v127, v142, v143
    v_or_b32 v208, v208, v127
    v_and_b32 v208, s38, v208
    v_mfma_f32_16x16x32_bf16 v[152:155], v[204:207], v[104:107], v[152:155]
    v_cmp_ne_u32_e64 vcc, 0, v208
    v_mfma_f32_16x16x32_bf16 v[156:159], v[204:207], v[108:111], v[156:159]
    s_cbranch_vccnz kf_rare46
kf_rr45:
    s_waitcnt lgkmcnt(0)
    s_nop 0
    v_mfma_f32_16x16x32_bf16 a[64:67], a[192:195], v[120:123], a[64:67]
    v_mfma_f32_16x16x32_bf16 a[96:99], a[192:195], v[124:127], a[96:99]
    v_mfma_f32_16x16x32_bf16 a[68:71], a[196:199], v[120:123], a[68:71]
    v_mfma_f32_16x16x32_bf16 a[100:103], a[196:199], v[124:127], a[100:103]
    v_mfma_f32_16x16x32_bf16 a[72:75], a[200:203], v[120:123], a[72:75]
    v_mfma_f32_16x16x32_bf16 a[104:107], a[200:203], v[124:127], a[104:107]
    v_mfma_f32_16x16x32_bf16 a[76:79], a[204:207], v[120:123], a[76:79]
    v_mfma_f32_16x16x32_bf16 a[108:111], a[204:207], v[124:127], a[108:111]
    v_mfma_f32_16x16x32_bf16 a[80:83], a[208:211], v[120:123], a[80:83]
    v_mfma_f32_16x16x32_bf16 a[112:115], a[208:211], v[124:127], a[112:115]
    v_mfma_f32_16x16x32_bf16 a[84:87], a[212:215], v[120:123], a[84:87]
    v_mfma_f32_16x16x32_bf16 a[116:119], a[212:215], v[124:127], a[116:119]
    v_mfma_f32_16x16x32_bf16 a[88:91], a[216:219], v[120:123], a[88:91]
    v_mfma_f32_16x16x32_bf16 a[120:123], a[216:219], v[124:127], a[120:123]
    v_mfma_f32_16x16x32_bf16 a[92:95], a[220:223], v[120:123], a[92:95]
    v_mfma_f32_16x16x32_bf16 a[124:127], a[220:223], v[124:127], a[124:127]
    v_mfma_f32_16x16x32_bf16 v[152:155], v[204:207], v[120:123], v[152:155]
    v_mfma_f32_16x16x32_bf16 v[156:159], v[204:207], v[124:127], v[156:159]
    s_cmp_eq_u32 s31, 0
    s_cbranch_scc1 ka_noxr
    s_waitcnt vmcnt(8)
    s_barrier
ka_noxr:
    s_nop 6
    v_rcp_f32 v230, v152
    v_rcp_f32 v231, v156
    v_accvgpr_read_b32 v160, a64
    v_accvgpr_read_b32 v161, a65
    v_accvgpr_read_b32 v162, a66
    v_accvgpr_read_b32 v163, a67
    v_accvgpr_read_b32 v164, a68
    v_accvgpr_read_b32 v165, a69
    v_accvgpr_read_b32 v166, a70
    v_accvgpr_read_b32 v167, a71
    v_mul_f32 v160, v160, v230
    v_mul_f32 v161, v161, v230
    v_mul_f32 v162, v162, v230
    v_mul_f32 v163, v163, v230
    v_mul_f32 v164, v164, v230
    v_mul_f32 v165, v165, v230
    v_mul_f32 v166, v166, v230
    v_mul_f32 v167, v167, v230
    v_cvt_pk_bf16_f32 v176, v160, v161
    v_cvt_pk_bf16_f32 v177, v162, v163
    v_cvt_pk_bf16_f32 v178, v164, v165
    v_cvt_pk_bf16_f32 v179, v166, v167
    buffer_store_dwordx4 v[176:179], v240, s[20:23], s40 offen offset:0 sc1
    v_accvgpr_read_b32 v168, a72
    v_accvgpr_read_b32 v169, a73
    v_accvgpr_read_b32 v170, a74
    v_accvgpr_read_b32 v171, a75
    v_accvgpr_read_b32 v172, a76
    v_accvgpr_read_b32 v173, a77
    v_accvgpr_read_b32 v174, a78
    v_accvgpr_read_b32 v175, a79
    v_mul_f32 v168, v168, v230
    v_mul_f32 v169, v169, v230
    v_mul_f32 v170, v170, v230
    v_mul_f32 v171, v171, v230
    v_mul_f32 v172, v172, v230
    v_mul_f32 v173, v173, v230
    v_mul_f32 v174, v174, v230
    v_mul_f32 v175, v175, v230
    v_cvt_pk_bf16_f32 v180, v168, v169
    v_cvt_pk_bf16_f32 v181, v170, v171
    v_cvt_pk_bf16_f32 v182, v172, v173
    v_cvt_pk_bf16_f32 v183, v174, v175
    buffer_store_dwordx4 v[180:183], v240, s[20:23], s40 offen offset:1024 sc1
    v_accvgpr_read_b32 v160, a80
    v_accvgpr_read_b32 v161, a81
    v_accvgpr_read_b32 v162, a82
    v_accvgpr_read_b32 v163, a83
    v_accvgpr_read_b32 v164, a84
    v_accvgpr_read_b32 v165, a85
    v_accvgpr_read_b32 v166, a86
    v_accvgpr_read_b32 v167, a87
    v_mul_f32 v160, v160, v230
    v_mul_f32 v161, v161, v230
    v_mul_f32 v162, v162, v230
    v_mul_f32 v163, v163, v230
    v_mul_f32 v164, v164, v230
    v_mul_f32 v165, v165, v230
    v_mul_f32 v166, v166, v230
    v_mul_f32 v167, v167, v230
    v_cvt_pk_bf16_f32 v184, v160, v161
    v_cvt_pk_bf16_f32 v185, v162, v163
    v_cvt_pk_bf16_f32 v186, v164, v165
    v_cvt_pk_bf16_f32 v187, v166, v167
    buffer_store_dwordx4 v[184:187], v240, s[20:23], s40 offen offset:2048 sc1
    v_accvgpr_read_b32 v168, a88
    v_accvgpr_read_b32 v169, a89
    v_accvgpr_read_b32 v170, a90
    v_accvgpr_read_b32 v171, a91
    v_accvgpr_read_b32 v172, a92
    v_accvgpr_read_b32 v173, a93
    v_accvgpr_read_b32 v174, a94
    v_accvgpr_read_b32 v175, a95
    v_mul_f32 v168, v168, v230
    v_mul_f32 v169, v169, v230
    v_mul_f32 v170, v170, v230
    v_mul_f32 v171, v171, v230
    v_mul_f32 v172, v172, v230
    v_mul_f32 v173, v173, v230
    v_mul_f32 v174, v174, v230
    v_mul_f32 v175, v175, v230
    v_cvt_pk_bf16_f32 v188, v168, v169
    v_cvt_pk_bf16_f32 v189, v170, v171
    v_cvt_pk_bf16_f32 v190, v172, v173
    v_cvt_pk_bf16_f32 v191, v174, v175
    buffer_store_dwordx4 v[188:191], v240, s[20:23], s40 offen offset:3072 sc1
    v_accvgpr_read_b32 v160, a96
    v_accvgpr_read_b32 v161, a97
    v_accvgpr_read_b32 v162, a98
    v_accvgpr_read_b32 v163, a99
    v_accvgpr_read_b32 v164, a100
    v_accvgpr_read_b32 v165, a101
    v_accvgpr_read_b32 v166, a102
    v_accvgpr_read_b32 v167, a103
    v_mul_f32 v160, v160, v231
    v_mul_f32 v161, v161, v231
    v_mul_f32 v162, v162, v231
    v_mul_f32 v163, v163, v231
    v_mul_f32 v164, v164, v231
    v_mul_f32 v165, v165, v231
    v_mul_f32 v166, v166, v231
    v_mul_f32 v167, v167, v231
    v_cvt_pk_bf16_f32 v176, v160, v161
    v_cvt_pk_bf16_f32 v177, v162, v163
    v_cvt_pk_bf16_f32 v178, v164, v165
    v_cvt_pk_bf16_f32 v179, v166, v167
    buffer_store_dwordx4 v[176:179], v244, s[20:23], s40 offen offset:0 sc1
    v_accvgpr_read_b32 v168, a104
    v_accvgpr_read_b32 v169, a105
    v_accvgpr_read_b32 v170, a106
    v_accvgpr_read_b32 v171, a107
    v_accvgpr_read_b32 v172, a108
    v_accvgpr_read_b32 v173, a109
    v_accvgpr_read_b32 v174, a110
    v_accvgpr_read_b32 v175, a111
    v_mul_f32 v168, v168, v231
    v_mul_f32 v169, v169, v231
    v_mul_f32 v170, v170, v231
    v_mul_f32 v171, v171, v231
    v_mul_f32 v172, v172, v231
    v_mul_f32 v173, v173, v231
    v_mul_f32 v174, v174, v231
    v_mul_f32 v175, v175, v231
    v_cvt_pk_bf16_f32 v180, v168, v169
    v_cvt_pk_bf16_f32 v181, v170, v171
    v_cvt_pk_bf16_f32 v182, v172, v173
    v_cvt_pk_bf16_f32 v183, v174, v175
    buffer_store_dwordx4 v[180:183], v244, s[20:23], s40 offen offset:1024 sc1
    v_accvgpr_read_b32 v160, a112
    v_accvgpr_read_b32 v161, a113
    v_accvgpr_read_b32 v162, a114
    v_accvgpr_read_b32 v163, a115
    v_accvgpr_read_b32 v164, a116
    v_accvgpr_read_b32 v165, a117
    v_accvgpr_read_b32 v166, a118
    v_accvgpr_read_b32 v167, a119
    v_mul_f32 v160, v160, v231
    v_mul_f32 v161, v161, v231
    v_mul_f32 v162, v162, v231
    v_mul_f32 v163, v163, v231
    v_mul_f32 v164, v164, v231
    v_mul_f32 v165, v165, v231
    v_mul_f32 v166, v166, v231
    v_mul_f32 v167, v167, v231
    v_cvt_pk_bf16_f32 v184, v160, v161
    v_cvt_pk_bf16_f32 v185, v162, v163
    v_cvt_pk_bf16_f32 v186, v164, v165
    v_cvt_pk_bf16_f32 v187, v166, v167
    buffer_store_dwordx4 v[184:187], v244, s[20:23], s40 offen offset:2048 sc1
    v_accvgpr_read_b32 v168, a120
    v_accvgpr_read_b32 v169, a121
    v_accvgpr_read_b32 v170, a122
    v_accvgpr_read_b32 v171, a123
    v_accvgpr_read_b32 v172, a124
    v_accvgpr_read_b32 v173, a125
    v_accvgpr_read_b32 v174, a126
    v_accvgpr_read_b32 v175, a127
    v_mul_f32 v168, v168, v231
    v_mul_f32 v169, v169, v231
    v_mul_f32 v170, v170, v231
    v_mul_f32 v171, v171, v231
    v_mul_f32 v172, v172, v231
    v_mul_f32 v173, v173, v231
    v_mul_f32 v174, v174, v231
    v_mul_f32 v175, v175, v231
    v_cvt_pk_bf16_f32 v188, v168, v169
    v_cvt_pk_bf16_f32 v189, v170, v171
    v_cvt_pk_bf16_f32 v190, v172, v173
    v_cvt_pk_bf16_f32 v191, v174, v175
    buffer_store_dwordx4 v[188:191], v244, s[20:23], s40 offen offset:3072 sc1
    s_branch ka_ok
kf_fix17:
    s_cmp_eq_u32 s33, 0
    s_cselect_b32 s24, 0, 0x74000000
    s_cselect_b32 s36, 0, 0x1000
    s_mov_b32 s33, 1
    v_subrev_f32 v230, s24, v243
    v_add_f32 v231, 0, v230
    v_min_f32 v64, v224, v231
    v_add_f32 v232, 0xf1800000, v230
    v_min_f32_e64 v65, v224, v232
    v_add_f32 v231, 0xf2000000, v230
    v_min_f32_e64 v66, v224, v231
    v_add_f32 v232, 0xf2400000, v230
    v_min_f32_e64 v67, v224, v232
    v_add_f32 v231, 0xf3000000, v230
    v_min_f32_e64 v68, v224, v231
    v_add_f32 v232, 0xf3100000, v230
    v_min_f32_e64 v69, v224, v232
    v_add_f32 v231, 0xf3200000, v230
    v_min_f32_e64 v70, v224, v231
    v_add_f32 v232, 0xf3300000, v230
    v_min_f32_e64 v71, v224, v232
    v_add_f32 v231, 0x73800000, v230
    v_min_f32_e64 v72, v225, v231
    v_add_f32 v232, 0x73700000, v230
    v_min_f32_e64 v73, v225, v232
    v_add_f32 v231, 0x73600000, v230
    v_min_f32_e64 v74, v225, v231
    v_add_f32 v232, 0x73500000, v230
    v_min_f32_e64 v75, v225, v232
    v_add_f32 v231, 0x73000000, v230
    v_min_f32_e64 v76, v225, v231
    v_add_f32 v232, 0x72e00000, v230
    v_min_f32_e64 v77, v225, v232
    v_add_f32 v231, 0x72c00000, v230
    v_min_f32_e64 v78, v225, v231
    v_add_f32 v232, 0x72a00000, v230
    v_min_f32 v79, v225, v232
    s_nop 1
    s_branch kf_fixr18
kf_fix19:
    s_cmp_eq_u32 s33, 0
    s_cselect_b32 s24, 0, 0x74000000
    s_cselect_b32 s36, 0, 0x1000
    s_mov_b32 s33, 1
    v_subrev_f32 v230, s24, v243
    v_add_f32 v231, 0, v230
    v_min_f32 v64, v224, v231
    v_add_f32 v232, 0xf1800000, v230
    v_min_f32_e64 v65, v224, v232
    v_add_f32 v231, 0xf2000000, v230
    v_min_f32_e64 v66, v224, v231
    v_add_f32 v232, 0xf2400000, v230
    v_min_f32_e64 v67, v224, v232
    v_add_f32 v231, 0xf3000000, v230
    v_min_f32_e64 v68, v224, v231
    v_add_f32 v232, 0xf3100000, v230
    v_min_f32_e64 v69, v224, v232
    v_add_f32 v231, 0xf3200000, v230
    v_min_f32_e64 v70, v224, v231
    v_add_f32 v232, 0xf3300000, v230
    v_min_f32_e64 v71, v224, v232
    v_add_f32 v231, 0x73800000, v230
    v_min_f32_e64 v72, v225, v231
    v_add_f32 v232, 0x73700000, v230
    v_min_f32_e64 v73, v225, v232
    v_add_f32 v231, 0x73600000, v230
    v_min_f32_e64 v74, v225, v231
    v_add_f32 v232, 0x73500000, v230
    v_min_f32_e64 v75, v225, v232
    v_add_f32 v231, 0x73000000, v230
    v_min_f32_e64 v76, v225, v231
    v_add_f32 v232, 0x72e00000, v230
    v_min_f32_e64 v77, v225, v232
    v_add_f32 v231, 0x72c00000, v230
    v_min_f32_e64 v78, v225, v231
    v_add_f32 v232, 0x72a00000, v230
    v_min_f32 v79, v225, v232
    s_nop 1
    s_branch kf_fixr20
kf_rare22:
    s_nop 15
    v_max3_f32 v230, v32, v33, v34
    v_max3_f32 v230, v230, v35, v36
    v_max3_f32 v230, v230, v37, v38
    v_max_f32 v230, v230, v39
    v_mov_b32 v231, v230
    s_nop 1
    v_permlane16_swap_b32 v230, v231
    s_nop 0
    v_max_f32 v230, v230, v231
    v_mov_b32 v231, v230
    s_nop 1
    v_permlane32_swap_b32 v230, v231
    s_nop 0
    v_max_f32_e64 v230, v230, v231
    v_add_f32 v230, 0x41800000, v230
    v_max_f32 v230, 0, v230
    v_sub_f32 v232, 0, v230
    v_exp_f32 v232, v232
    v_sub_f32 v224, v224, v230
    v_sub_f32 v64, v64, v230
    v_sub_f32 v0, v0, v230
    v_sub_f32 v32, v32, v230
    v_sub_f32 v65, v65, v230
    v_sub_f32 v1, v1, v230
    v_sub_f32 v33, v33, v230
    v_sub_f32 v66, v66, v230
    v_sub_f32 v2, v2, v230
    v_sub_f32 v34, v34, v230
    v_sub_f32 v67, v67, v230
    v_sub_f32 v3, v3, v230
    v_sub_f32 v35, v35, v230
    v_sub_f32 v68, v68, v230
    v_sub_f32 v4, v4, v230
    v_sub_f32 v36, v36, v230
    v_sub_f32 v69, v69, v230
    v_sub_f32 v5, v5, v230
    v_sub_f32 v37, v37, v230
    v_sub_f32 v70, v70, v230
    v_sub_f32 v6, v6, v230
    v_sub_f32 v38, v38, v230
    v_sub_f32 v71, v71, v230
    v_sub_f32 v7, v7, v230
    v_sub_f32 v39, v39, v230
    v_mul_f32 v144, v144, v232
    v_mul_f32 v145, v145, v232
    v_mul_f32 v146, v146, v232
    v_mul_f32 v147, v147, v232
    v_accvgpr_read_b32 v233, a0
    v_mul_f32_e64 v233, v233, v232
    v_accvgpr_write_b32 a0, v233
    v_accvgpr_read_b32 v234, a1
    v_mul_f32_e64 v234, v234, v232
    v_accvgpr_write_b32 a1, v234
    v_accvgpr_read_b32 v235, a2
    v_mul_f32_e64 v235, v235, v232
    v_accvgpr_write_b32 a2, v235
    v_accvgpr_read_b32 v236, a3
    v_mul_f32_e64 v236, v236, v232
    v_accvgpr_write_b32 a3, v236
    v_accvgpr_read_b32 v233, a4
    v_mul_f32_e64 v233, v233, v232
    v_accvgpr_write_b32 a4, v233
    v_accvgpr_read_b32 v234, a5
    v_mul_f32_e64 v234, v234, v232
    v_accvgpr_write_b32 a5, v234
    v_accvgpr_read_b32 v235, a6
    v_mul_f32_e64 v235, v235, v232
    v_accvgpr_write_b32 a6, v235
    v_accvgpr_read_b32 v236, a7
    v_mul_f32_e64 v236, v236, v232
    v_accvgpr_write_b32 a7, v236
    v_accvgpr_read_b32 v233, a8
    v_mul_f32_e64 v233, v233, v232
    v_accvgpr_write_b32 a8, v233
    v_accvgpr_read_b32 v234, a9
    v_mul_f32_e64 v234, v234, v232
    v_accvgpr_write_b32 a9, v234
    v_accvgpr_read_b32 v235, a10
    v_mul_f32_e64 v235, v235, v232
    v_accvgpr_write_b32 a10, v235
    v_accvgpr_read_b32 v236, a11
    v_mul_f32_e64 v236, v236, v232
    v_accvgpr_write_b32 a11, v236
    v_accvgpr_read_b32 v233, a12
    v_mul_f32_e64 v233, v233, v232
    v_accvgpr_write_b32 a12, v233
    v_accvgpr_read_b32 v234, a13
    v_mul_f32_e64 v234, v234, v232
    v_accvgpr_write_b32 a13, v234
    v_accvgpr_read_b32 v235, a14
    v_mul_f32_e64 v235, v235, v232
    v_accvgpr_write_b32 a14, v235
    v_accvgpr_read_b32 v236, a15
    v_mul_f32_e64 v236, v236, v232
    v_accvgpr_write_b32 a15, v236
    v_accvgpr_read_b32 v233, a16
    v_mul_f32_e64 v233, v233, v232
    v_accvgpr_write_b32 a16, v233
    v_accvgpr_read_b32 v234, a17
    v_mul_f32_e64 v234, v234, v232
    v_accvgpr_write_b32 a17, v234
    v_accvgpr_read_b32 v235, a18
    v_mul_f32_e64 v235, v235, v232
    v_accvgpr_write_b32 a18, v235
    v_accvgpr_read_b32 v236, a19
    v_mul_f32_e64 v236, v236, v232
    v_accvgpr_write_b32 a19, v236
    v_accvgpr_read_b32 v233, a20
    v_mul_f32_e64 v233, v233, v232
    v_accvgpr_write_b32 a20, v233
    v_accvgpr_read_b32 v234, a21
    v_mul_f32_e64 v234, v234, v232
    v_accvgpr_write_b32 a21, v234
    v_accvgpr_read_b32 v235, a22
    v_mul_f32_e64 v235, v235, v232
    v_accvgpr_write_b32 a22, v235
    v_accvgpr_read_b32 v236, a23
    v_mul_f32_e64 v236, v236, v232
    v_accvgpr_write_b32 a23, v236
    v_accvgpr_read_b32 v233, a24
    v_mul_f32_e64 v233, v233, v232
    v_accvgpr_write_b32 a24, v233
    v_accvgpr_read_b32 v234, a25
    v_mul_f32_e64 v234, v234, v232
    v_accvgpr_write_b32 a25, v234
    v_accvgpr_read_b32 v235, a26
    v_mul_f32_e64 v235, v235, v232
    v_accvgpr_write_b32 a26, v235
    v_accvgpr_read_b32 v236, a27
    v_mul_f32_e64 v236, v236, v232
    v_accvgpr_write_b32 a27, v236
    v_accvgpr_read_b32 v233, a28
    v_mul_f32_e64 v233, v233, v232
    v_accvgpr_write_b32 a28, v233
    v_accvgpr_read_b32 v234, a29
    v_mul_f32_e64 v234, v234, v232
    v_accvgpr_write_b32 a29, v234
    v_accvgpr_read_b32 v235, a30
    v_mul_f32_e64 v235, v235, v232
    v_accvgpr_write_b32 a30, v235
    v_accvgpr_read_b32 v236, a31
    v_mul_f32_e64 v236, v236, v232
    v_accvgpr_write_b32 a31, v236
    v_exp_f32 v128, v32
    v_exp_f32 v129, v33
    v_exp_f32 v130, v34
    v_exp_f32 v131, v35
    v_exp_f32 v132, v36
    v_exp_f32 v133, v37
    v_exp_f32 v134, v38
    v_exp_f32_e64 v135, v39
    s_nop 0
    v_cvt_pk_bf16_f32 v112, v128, v129
    v_cvt_pk_bf16_f32 v113, v130, v131
    v_cvt_pk_bf16_f32 v114, v132, v133
    v_cvt_pk_bf16_f32 v115, v134, v135
    v_max3_f32 v230, v40, v41, v42
    v_max3_f32 v230, v230, v43, v44
    v_max3_f32 v230, v230, v45, v46
    v_max_f32 v230, v230, v47
    v_mov_b32 v231, v230
    s_nop 1
    v_permlane16_swap_b32 v230, v231
    s_nop 0
    v_max_f32 v230, v230, v231
    v_mov_b32 v231, v230
    s_nop 1
    v_permlane32_swap_b32 v230, v231
    s_nop 0
    v_max_f32_e64 v230, v230, v231
    v_add_f32 v230, 0x41800000, v230
    v_max_f32 v230, 0, v230
    v_sub_f32 v232, 0, v230
    v_exp_f32 v232, v232
    v_sub_f32 v225, v225, v230
    v_sub_f32 v72, v72, v230
    v_sub_f32 v8, v8, v230
    v_sub_f32 v40, v40, v230
    v_sub_f32 v73, v73, v230
    v_sub_f32 v9, v9, v230
    v_sub_f32 v41, v41, v230
    v_sub_f32 v74, v74, v230
    v_sub_f32 v10, v10, v230
    v_sub_f32 v42, v42, v230
    v_sub_f32 v75, v75, v230
    v_sub_f32 v11, v11, v230
    v_sub_f32 v43, v43, v230
    v_sub_f32 v76, v76, v230
    v_sub_f32 v12, v12, v230
    v_sub_f32 v44, v44, v230
    v_sub_f32 v77, v77, v230
    v_sub_f32 v13, v13, v230
    v_sub_f32 v45, v45, v230
    v_sub_f32 v78, v78, v230
    v_sub_f32 v14, v14, v230
    v_sub_f32 v46, v46, v230
    v_sub_f32 v79, v79, v230
    v_sub_f32 v15, v15, v230
    v_sub_f32 v47, v47, v230
    v_mul_f32 v148, v148, v232
    v_mul_f32 v149, v149, v232
    v_mul_f32 v150, v150, v232
    v_mul_f32 v151, v151, v232
    v_accvgpr_read_b32 v233, a32
    v_mul_f32_e64 v233, v233, v232
    v_accvgpr_write_b32 a32, v233
    v_accvgpr_read_b32 v234, a33
    v_mul_f32_e64 v234, v234, v232
    v_accvgpr_write_b32 a33, v234
    v_accvgpr_read_b32 v235, a34
    v_mul_f32_e64 v235, v235, v232
    v_accvgpr_write_b32 a34, v235
    v_accvgpr_read_b32 v236, a35
    v_mul_f32_e64 v236, v236, v232
    v_accvgpr_write_b32 a35, v236
    v_accvgpr_read_b32 v233, a36
    v_mul_f32_e64 v233, v233, v232
    v_accvgpr_write_b32 a36, v233
    v_accvgpr_read_b32 v234, a37
    v_mul_f32_e64 v234, v234, v232
    v_accvgpr_write_b32 a37, v234
    v_accvgpr_read_b32 v235, a38
    v_mul_f32_e64 v235, v235, v232
    v_accvgpr_write_b32 a38, v235
    v_accvgpr_read_b32 v236, a39
    v_mul_f32_e64 v236, v236, v232
    v_accvgpr_write_b32 a39, v236
    v_accvgpr_read_b32 v233, a40
    v_mul_f32_e64 v233, v233, v232
    v_accvgpr_write_b32 a40, v233
    v_accvgpr_read_b32 v234, a41
    v_mul_f32_e64 v234, v234, v232
    v_accvgpr_write_b32 a41, v234
    v_accvgpr_read_b32 v235, a42
    v_mul_f32_e64 v235, v235, v232
    v_accvgpr_write_b32 a42, v235
    v_accvgpr_read_b32 v236, a43
    v_mul_f32_e64 v236, v236, v232
    v_accvgpr_write_b32 a43, v236
    v_accvgpr_read_b32 v233, a44
    v_mul_f32_e64 v233, v233, v232
    v_accvgpr_write_b32 a44, v233
    v_accvgpr_read_b32 v234, a45
    v_mul_f32_e64 v234, v234, v232
    v_accvgpr_write_b32 a45, v234
    v_accvgpr_read_b32 v235, a46
    v_mul_f32_e64 v235, v235, v232
    v_accvgpr_write_b32 a46, v235
    v_accvgpr_read_b32 v236, a47
    v_mul_f32_e64 v236, v236, v232
    v_accvgpr_write_b32 a47, v236
    v_accvgpr_read_b32 v233, a48
    v_mul_f32_e64 v233, v233, v232
    v_accvgpr_write_b32 a48, v233
    v_accvgpr_read_b32 v234, a49
    v_mul_f32_e64 v234, v234, v232
    v_accvgpr_write_b32 a49, v234
    v_accvgpr_read_b32 v235, a50
    v_mul_f32_e64 v235, v235, v232
    v_accvgpr_write_b32 a50, v235
    v_accvgpr_read_b32 v236, a51
    v_mul_f32_e64 v236, v236, v232
    v_accvgpr_write_b32 a51, v236
    v_accvgpr_read_b32 v233, a52
    v_mul_f32_e64 v233, v233, v232
    v_accvgpr_write_b32 a52, v233
    v_accvgpr_read_b32 v234, a53
    v_mul_f32_e64 v234, v234, v232
    v_accvgpr_write_b32 a53, v234
    v_accvgpr_read_b32 v235, a54
    v_mul_f32_e64 v235, v235, v232
    v_accvgpr_write_b32 a54, v235
    v_accvgpr_read_b32 v236, a55
    v_mul_f32_e64 v236, v236, v232
    v_accvgpr_write_b32 a55, v236
    v_accvgpr_read_b32 v233, a56
    v_mul_f32_e64 v233, v233, v232
    v_accvgpr_write_b32 a56, v233
    v_accvgpr_read_b32 v234, a57
    v_mul_f32_e64 v234, v234, v232
    v_accvgpr_write_b32 a57, v234
    v_accvgpr_read_b32 v235, a58
    v_mul_f32_e64 v235, v235, v232
    v_accvgpr_write_b32 a58, v235
    v_accvgpr_read_b32 v236, a59
    v_mul_f32_e64 v236, v236, v232
    v_accvgpr_write_b32 a59, v236
    v_accvgpr_read_b32 v233, a60
    v_mul_f32_e64 v233, v233, v232
    v_accvgpr_write_b32 a60, v233
    v_accvgpr_read_b32 v234, a61
    v_mul_f32_e64 v234, v234, v232
    v_accvgpr_write_b32 a61, v234
    v_accvgpr_read_b32 v235, a62
    v_mul_f32_e64 v235, v235, v232
    v_accvgpr_write_b32 a62, v235
    v_accvgpr_read_b32 v236, a63
    v_mul_f32_e64 v236, v236, v232
    v_accvgpr_write_b32 a63, v236
    v_exp_f32 v128, v40
    v_exp_f32 v129, v41
    v_exp_f32 v130, v42
    v_exp_f32 v131, v43
    v_exp_f32 v132, v44
    v_exp_f32 v133, v45
    v_exp_f32 v134, v46
    v_exp_f32_e64 v135, v47
    s_nop 0
    v_cvt_pk_bf16_f32 v116, v128, v129
    v_cvt_pk_bf16_f32 v117, v130, v131
    v_cvt_pk_bf16_f32 v118, v132, v133
    v_cvt_pk_bf16_f32 v119, v134, v135
    v_max3_f32 v230, v48, v49, v50
    v_max3_f32 v230, v230, v51, v52
    v_max3_f32 v230, v230, v53, v54
    v_max_f32 v230, v230, v55
    v_mov_b32 v231, v230
    s_nop 1
    v_permlane16_swap_b32 v230, v231
    s_nop 0
    v_max_f32 v230, v230, v231
    v_mov_b32 v231, v230
    s_nop 1
    v_permlane32_swap_b32 v230, v231
    s_nop 0
    v_max_f32_e64 v230, v230, v231
    v_add_f32 v230, 0x41800000, v230
    v_max_f32 v230, 0, v230
    v_sub_f32 v232, 0, v230
    v_exp_f32 v232, v232
    v_sub_f32 v226, v226, v230
    v_sub_f32 v80, v80, v230
    v_sub_f32 v16, v16, v230
    v_sub_f32 v48, v48, v230
    v_sub_f32 v81, v81, v230
    v_sub_f32 v17, v17, v230
    v_sub_f32 v49, v49, v230
    v_sub_f32 v82, v82, v230
    v_sub_f32 v18, v18, v230
    v_sub_f32 v50, v50, v230
    v_sub_f32 v83, v83, v230
    v_sub_f32 v19, v19, v230
    v_sub_f32 v51, v51, v230
    v_sub_f32 v84, v84, v230
    v_sub_f32 v20, v20, v230
    v_sub_f32 v52, v52, v230
    v_sub_f32 v85, v85, v230
    v_sub_f32 v21, v21, v230
    v_sub_f32 v53, v53, v230
    v_sub_f32 v86, v86, v230
    v_sub_f32 v22, v22, v230
    v_sub_f32 v54, v54, v230
    v_sub_f32 v87, v87, v230
    v_sub_f32 v23, v23, v230
    v_sub_f32 v55, v55, v230
    v_mul_f32 v152, v152, v232
    v_mul_f32 v153, v153, v232
    v_mul_f32 v154, v154, v232
    v_mul_f32 v155, v155, v232
    v_accvgpr_read_b32 v233, a64
    v_mul_f32_e64 v233, v233, v232
    v_accvgpr_write_b32 a64, v233
    v_accvgpr_read_b32 v234, a65
    v_mul_f32_e64 v234, v234, v232
    v_accvgpr_write_b32 a65, v234
    v_accvgpr_read_b32 v235, a66
    v_mul_f32_e64 v235, v235, v232
    v_accvgpr_write_b32 a66, v235
    v_accvgpr_read_b32 v236, a67
    v_mul_f32_e64 v236, v236, v232
    v_accvgpr_write_b32 a67, v236
    v_accvgpr_read_b32 v233, a68
    v_mul_f32_e64 v233, v233, v232
    v_accvgpr_write_b32 a68, v233
    v_accvgpr_read_b32 v234, a69
    v_mul_f32_e64 v234, v234, v232
    v_accvgpr_write_b32 a69, v234
    v_accvgpr_read_b32 v235, a70
    v_mul_f32_e64 v235, v235, v232
    v_accvgpr_write_b32 a70, v235
    v_accvgpr_read_b32 v236, a71
    v_mul_f32_e64 v236, v236, v232
    v_accvgpr_write_b32 a71, v236
    v_accvgpr_read_b32 v233, a72
    v_mul_f32_e64 v233, v233, v232
    v_accvgpr_write_b32 a72, v233
    v_accvgpr_read_b32 v234, a73
    v_mul_f32_e64 v234, v234, v232
    v_accvgpr_write_b32 a73, v234
    v_accvgpr_read_b32 v235, a74
    v_mul_f32_e64 v235, v235, v232
    v_accvgpr_write_b32 a74, v235
    v_accvgpr_read_b32 v236, a75
    v_mul_f32_e64 v236, v236, v232
    v_accvgpr_write_b32 a75, v236
    v_accvgpr_read_b32 v233, a76
    v_mul_f32_e64 v233, v233, v232
    v_accvgpr_write_b32 a76, v233
    v_accvgpr_read_b32 v234, a77
    v_mul_f32_e64 v234, v234, v232
    v_accvgpr_write_b32 a77, v234
    v_accvgpr_read_b32 v235, a78
    v_mul_f32_e64 v235, v235, v232
    v_accvgpr_write_b32 a78, v235
    v_accvgpr_read_b32 v236, a79
    v_mul_f32_e64 v236, v236, v232
    v_accvgpr_write_b32 a79, v236
    v_accvgpr_read_b32 v233, a80
    v_mul_f32_e64 v233, v233, v232
    v_accvgpr_write_b32 a80, v233
    v_accvgpr_read_b32 v234, a81
    v_mul_f32_e64 v234, v234, v232
    v_accvgpr_write_b32 a81, v234
    v_accvgpr_read_b32 v235, a82
    v_mul_f32_e64 v235, v235, v232
    v_accvgpr_write_b32 a82, v235
    v_accvgpr_read_b32 v236, a83
    v_mul_f32_e64 v236, v236, v232
    v_accvgpr_write_b32 a83, v236
    v_accvgpr_read_b32 v233, a84
    v_mul_f32_e64 v233, v233, v232
    v_accvgpr_write_b32 a84, v233
    v_accvgpr_read_b32 v234, a85
    v_mul_f32_e64 v234, v234, v232
    v_accvgpr_write_b32 a85, v234
    v_accvgpr_read_b32 v235, a86
    v_mul_f32_e64 v235, v235, v232
    v_accvgpr_write_b32 a86, v235
    v_accvgpr_read_b32 v236, a87
    v_mul_f32_e64 v236, v236, v232
    v_accvgpr_write_b32 a87, v236
    v_accvgpr_read_b32 v233, a88
    v_mul_f32_e64 v233, v233, v232
    v_accvgpr_write_b32 a88, v233
    v_accvgpr_read_b32 v234, a89
    v_mul_f32_e64 v234, v234, v232
    v_accvgpr_write_b32 a89, v234
    v_accvgpr_read_b32 v235, a90
    v_mul_f32_e64 v235, v235, v232
    v_accvgpr_write_b32 a90, v235
    v_accvgpr_read_b32 v236, a91
    v_mul_f32_e64 v236, v236, v232
    v_accvgpr_write_b32 a91, v236
    v_accvgpr_read_b32 v233, a92
    v_mul_f32_e64 v233, v233, v232
    v_accvgpr_write_b32 a92, v233
    v_accvgpr_read_b32 v234, a93
    v_mul_f32_e64 v234, v234, v232
    v_accvgpr_write_b32 a93, v234
    v_accvgpr_read_b32 v235, a94
    v_mul_f32_e64 v235, v235, v232
    v_accvgpr_write_b32 a94, v235
    v_accvgpr_read_b32 v236, a95
    v_mul_f32_e64 v236, v236, v232
    v_accvgpr_write_b32 a95, v236
    v_exp_f32 v128, v48
    v_exp_f32 v129, v49
    v_exp_f32 v130, v50
    v_exp_f32 v131, v51
    v_exp_f32 v132, v52
    v_exp_f32 v133, v53
    v_exp_f32 v134, v54
    v_exp_f32_e64 v135, v55
    s_nop 0
    v_cvt_pk_bf16_f32 v120, v128, v129
    v_cvt_pk_bf16_f32 v121, v130, v131
    v_cvt_pk_bf16_f32 v122, v132, v133
    v_cvt_pk_bf16_f32 v123, v134, v135
    v_max3_f32 v230, v56, v57, v58
    v_max3_f32 v230, v230, v59, v60
    v_max3_f32 v230, v230, v61, v62
    v_max_f32 v230, v230, v63
    v_mov_b32 v231, v230
    s_nop 1
    v_permlane16_swap_b32 v230, v231
    s_nop 0
    v_max_f32 v230, v230, v231
    v_mov_b32 v231, v230
    s_nop 1
    v_permlane32_swap_b32 v230, v231
    s_nop 0
    v_max_f32_e64 v230, v230, v231
    v_add_f32 v230, 0x41800000, v230
    v_max_f32 v230, 0, v230
    v_sub_f32 v232, 0, v230
    v_exp_f32 v232, v232
    v_sub_f32 v227, v227, v230
    v_sub_f32 v88, v88, v230
    v_sub_f32 v24, v24, v230
    v_sub_f32 v56, v56, v230
    v_sub_f32 v89, v89, v230
    v_sub_f32 v25, v25, v230
    v_sub_f32 v57, v57, v230
    v_sub_f32 v90, v90, v230
    v_sub_f32 v26, v26, v230
    v_sub_f32 v58, v58, v230
    v_sub_f32 v91, v91, v230
    v_sub_f32 v27, v27, v230
    v_sub_f32 v59, v59, v230
    v_sub_f32 v92, v92, v230
    v_sub_f32 v28, v28, v230
    v_sub_f32 v60, v60, v230
    v_sub_f32 v93, v93, v230
    v_sub_f32 v29, v29, v230
    v_sub_f32 v61, v61, v230
    v_sub_f32 v94, v94, v230
    v_sub_f32 v30, v30, v230
    v_sub_f32 v62, v62, v230
    v_sub_f32 v95, v95, v230
    v_sub_f32 v31, v31, v230
    v_sub_f32 v63, v63, v230
    v_mul_f32 v156, v156, v232
    v_mul_f32 v157, v157, v232
    v_mul_f32 v158, v158, v232
    v_mul_f32 v159, v159, v232
    v_accvgpr_read_b32 v233, a96
    v_mul_f32_e64 v233, v233, v232
    v_accvgpr_write_b32 a96, v233
    v_accvgpr_read_b32 v234, a97
    v_mul_f32_e64 v234, v234, v232
    v_accvgpr_write_b32 a97, v234
    v_accvgpr_read_b32 v235, a98
    v_mul_f32_e64 v235, v235, v232
    v_accvgpr_write_b32 a98, v235
    v_accvgpr_read_b32 v236, a99
    v_mul_f32_e64 v236, v236, v232
    v_accvgpr_write_b32 a99, v236
    v_accvgpr_read_b32 v233, a100
    v_mul_f32_e64 v233, v233, v232
    v_accvgpr_write_b32 a100, v233
    v_accvgpr_read_b32 v234, a101
    v_mul_f32_e64 v234, v234, v232
    v_accvgpr_write_b32 a101, v234
    v_accvgpr_read_b32 v235, a102
    v_mul_f32_e64 v235, v235, v232
    v_accvgpr_write_b32 a102, v235
    v_accvgpr_read_b32 v236, a103
    v_mul_f32_e64 v236, v236, v232
    v_accvgpr_write_b32 a103, v236
    v_accvgpr_read_b32 v233, a104
    v_mul_f32_e64 v233, v233, v232
    v_accvgpr_write_b32 a104, v233
    v_accvgpr_read_b32 v234, a105
    v_mul_f32_e64 v234, v234, v232
    v_accvgpr_write_b32 a105, v234
    v_accvgpr_read_b32 v235, a106
    v_mul_f32_e64 v235, v235, v232
    v_accvgpr_write_b32 a106, v235
    v_accvgpr_read_b32 v236, a107
    v_mul_f32_e64 v236, v236, v232
    v_accvgpr_write_b32 a107, v236
    v_accvgpr_read_b32 v233, a108
    v_mul_f32_e64 v233, v233, v232
    v_accvgpr_write_b32 a108, v233
    v_accvgpr_read_b32 v234, a109
    v_mul_f32_e64 v234, v234, v232
    v_accvgpr_write_b32 a109, v234
    v_accvgpr_read_b32 v235, a110
    v_mul_f32_e64 v235, v235, v232
    v_accvgpr_write_b32 a110, v235
    v_accvgpr_read_b32 v236, a111
    v_mul_f32_e64 v236, v236, v232
    v_accvgpr_write_b32 a111, v236
    v_accvgpr_read_b32 v233, a112
    v_mul_f32_e64 v233, v233, v232
    v_accvgpr_write_b32 a112, v233
    v_accvgpr_read_b32 v234, a113
    v_mul_f32_e64 v234, v234, v232
    v_accvgpr_write_b32 a113, v234
    v_accvgpr_read_b32 v235, a114
    v_mul_f32_e64 v235, v235, v232
    v_accvgpr_write_b32 a114, v235
    v_accvgpr_read_b32 v236, a115
    v_mul_f32_e64 v236, v236, v232
    v_accvgpr_write_b32 a115, v236
    v_accvgpr_read_b32 v233, a116
    v_mul_f32_e64 v233, v233, v232
    v_accvgpr_write_b32 a116, v233
    v_accvgpr_read_b32 v234, a117
    v_mul_f32_e64 v234, v234, v232
    v_accvgpr_write_b32 a117, v234
    v_accvgpr_read_b32 v235, a118
    v_mul_f32_e64 v235, v235, v232
    v_accvgpr_write_b32 a118, v235
    v_accvgpr_read_b32 v236, a119
    v_mul_f32_e64 v236, v236, v232
    v_accvgpr_write_b32 a119, v236
    v_accvgpr_read_b32 v233, a120
    v_mul_f32_e64 v233, v233, v232
    v_accvgpr_write_b32 a120, v233
    v_accvgpr_read_b32 v234, a121
    v_mul_f32_e64 v234, v234, v232
    v_accvgpr_write_b32 a121, v234
    v_accvgpr_read_b32 v235, a122
    v_mul_f32_e64 v235, v235, v232
    v_accvgpr_write_b32 a122, v235
    v_accvgpr_read_b32 v236, a123
    v_mul_f32_e64 v236, v236, v232
    v_accvgpr_write_b32 a123, v236
    v_accvgpr_read_b32 v233, a124
    v_mul_f32_e64 v233, v233, v232
    v_accvgpr_write_b32 a124, v233
    v_accvgpr_read_b32 v234, a125
    v_mul_f32_e64 v234, v234, v232
    v_accvgpr_write_b32 a125, v234
    v_accvgpr_read_b32 v235, a126
    v_mul_f32_e64 v235, v235, v232
    v_accvgpr_write_b32 a126, v235
    v_accvgpr_read_b32 v236, a127
    v_mul_f32_e64 v236, v236, v232
    v_accvgpr_write_b32 a127, v236
    v_exp_f32 v128, v56
    v_exp_f32 v129, v57
    v_exp_f32 v130, v58
    v_exp_f32 v131, v59
    v_exp_f32 v132, v60
    v_exp_f32 v133, v61
    v_exp_f32 v134, v62
    v_exp_f32_e64 v135, v63
    s_nop 0
    v_cvt_pk_bf16_f32 v124, v128, v129
    v_cvt_pk_bf16_f32 v125, v130, v131
    v_cvt_pk_bf16_f32 v126, v132, v133
    v_cvt_pk_bf16_f32 v127, v134, v135
    s_nop 1
    s_branch kf_rr21
kf_rare26:
    s_nop 15
    v_max3_f32 v230, v0, v1, v2
    v_max3_f32 v230, v230, v3, v4
    v_max3_f32 v230, v230, v5, v6
    v_max_f32 v230, v230, v7
    v_mov_b32 v231, v230
    s_nop 1
    v_permlane16_swap_b32 v230, v231
    s_nop 0
    v_max_f32 v230, v230, v231
    v_mov_b32 v231, v230
    s_nop 1
    v_permlane32_swap_b32 v230, v231
    s_nop 0
    v_max_f32 v230, v230, v231
    v_add_f32 v230, 0x41800000, v230
    v_max_f32 v230, 0, v230
    v_sub_f32 v232, 0, v230
    v_exp_f32 v232, v232
    v_sub_f32 v224, v224, v230
    v_sub_f32 v64, v64, v230
    v_sub_f32 v32, v32, v230
    v_sub_f32 v0, v0, v230
    v_sub_f32 v65, v65, v230
    v_sub_f32 v33, v33, v230
    v_sub_f32 v1, v1, v230
    v_sub_f32 v66, v66, v230
    v_sub_f32 v34, v34, v230
    v_sub_f32 v2, v2, v230
    v_sub_f32 v67, v67, v230
    v_sub_f32 v35, v35, v230
    v_sub_f32 v3, v3, v230
    v_sub_f32 v68, v68, v230
    v_sub_f32 v36, v36, v230
    v_sub_f32 v4, v4, v230
    v_sub_f32 v69, v69, v230
    v_sub_f32 v37, v37, v230
    v_sub_f32 v5, v5, v230
    v_sub_f32 v70, v70, v230
    v_sub_f32 v38, v38, v230
    v_sub_f32 v6, v6, v230
    v_sub_f32 v71, v71, v230
    v_sub_f32 v39, v39, v230
    v_sub_f32 v7, v7, v230
    v_mul_f32 v144, v144, v232
    v_mul_f32 v145, v145, v232
    v_mul_f32 v146, v146, v232
    v_mul_f32 v147, v147, v232
    v_accvgpr_read_b32 v233, a0
    v_mul_f32_e64 v233, v233, v232
    v_accvgpr_write_b32 a0, v233
    v_accvgpr_read_b32 v234, a1
    v_mul_f32_e64 v234, v234, v232
    v_accvgpr_write_b32 a1, v234
    v_accvgpr_read_b32 v235, a2
    v_mul_f32_e64 v235, v235, v232
    v_accvgpr_write_b32 a2, v235
    v_accvgpr_read_b32 v236, a3
    v_mul_f32_e64 v236, v236, v232
    v_accvgpr_write_b32 a3, v236
    v_accvgpr_read_b32 v233, a4
    v_mul_f32_e64 v233, v233, v232
    v_accvgpr_write_b32 a4, v233
    v_accvgpr_read_b32 v234, a5
    v_mul_f32_e64 v234, v234, v232
    v_accvgpr_write_b32 a5, v234
    v_accvgpr_read_b32 v235, a6
    v_mul_f32_e64 v235, v235, v232
    v_accvgpr_write_b32 a6, v235
    v_accvgpr_read_b32 v236, a7
    v_mul_f32_e64 v236, v236, v232
    v_accvgpr_write_b32 a7, v236
    v_accvgpr_read_b32 v233, a8
    v_mul_f32_e64 v233, v233, v232
    v_accvgpr_write_b32 a8, v233
    v_accvgpr_read_b32 v234, a9
    v_mul_f32_e64 v234, v234, v232
    v_accvgpr_write_b32 a9, v234
    v_accvgpr_read_b32 v235, a10
    v_mul_f32_e64 v235, v235, v232
    v_accvgpr_write_b32 a10, v235
    v_accvgpr_read_b32 v236, a11
    v_mul_f32_e64 v236, v236, v232
    v_accvgpr_write_b32 a11, v236
    v_accvgpr_read_b32 v233, a12
    v_mul_f32_e64 v233, v233, v232
    v_accvgpr_write_b32 a12, v233
    v_accvgpr_read_b32 v234, a13
    v_mul_f32_e64 v234, v234, v232
    v_accvgpr_write_b32 a13, v234
    v_accvgpr_read_b32 v235, a14
    v_mul_f32_e64 v235, v235, v232
    v_accvgpr_write_b32 a14, v235
    v_accvgpr_read_b32 v236, a15
    v_mul_f32_e64 v236, v236, v232
    v_accvgpr_write_b32 a15, v236
    v_accvgpr_read_b32 v233, a16
    v_mul_f32_e64 v233, v233, v232
    v_accvgpr_write_b32 a16, v233
    v_accvgpr_read_b32 v234, a17
    v_mul_f32_e64 v234, v234, v232
    v_accvgpr_write_b32 a17, v234
    v_accvgpr_read_b32 v235, a18
    v_mul_f32_e64 v235, v235, v232
    v_accvgpr_write_b32 a18, v235
    v_accvgpr_read_b32 v236, a19
    v_mul_f32_e64 v236, v236, v232
    v_accvgpr_write_b32 a19, v236
    v_accvgpr_read_b32 v233, a20
    v_mul_f32_e64 v233, v233, v232
    v_accvgpr_write_b32 a20, v233
    v_accvgpr_read_b32 v234, a21
    v_mul_f32_e64 v234, v234, v232
    v_accvgpr_write_b32 a21, v234
    v_accvgpr_read_b32 v235, a22
    v_mul_f32_e64 v235, v235, v232
    v_accvgpr_write_b32 a22, v235
    v_accvgpr_read_b32 v236, a23
    v_mul_f32_e64 v236, v236, v232
    v_accvgpr_write_b32 a23, v236
    v_accvgpr_read_b32 v233, a24
    v_mul_f32_e64 v233, v233, v232
    v_accvgpr_write_b32 a24, v233
    v_accvgpr_read_b32 v234, a25
    v_mul_f32_e64 v234, v234, v232
    v_accvgpr_write_b32 a25, v234
    v_accvgpr_read_b32 v235, a26
    v_mul_f32_e64 v235, v235, v232
    v_accvgpr_write_b32 a26, v235
    v_accvgpr_read_b32 v236, a27
    v_mul_f32_e64 v236, v236, v232
    v_accvgpr_write_b32 a27, v236
    v_accvgpr_read_b32 v233, a28
    v_mul_f32_e64 v233, v233, v232
    v_accvgpr_write_b32 a28, v233
    v_accvgpr_read_b32 v234, a29
    v_mul_f32_e64 v234, v234, v232
    v_accvgpr_write_b32 a29, v234
    v_accvgpr_read_b32 v235, a30
    v_mul_f32_e64 v235, v235, v232
    v_accvgpr_write_b32 a30, v235
    v_accvgpr_read_b32 v236, a31
    v_mul_f32_e64 v236, v236, v232
    v_accvgpr_write_b32 a31, v236
    v_exp_f32 v128, v0
    v_exp_f32 v129, v1
    v_exp_f32 v130, v2
    v_exp_f32 v131, v3
    v_exp_f32 v132, v4
    v_exp_f32 v133, v5
    v_exp_f32 v134, v6
    v_exp_f32_e64 v135, v7
    s_nop 0
    v_cvt_pk_bf16_f32 v96, v128, v129
    v_cvt_pk_bf16_f32 v97, v130, v131
    v_cvt_pk_bf16_f32 v98, v132, v133
    v_cvt_pk_bf16_f32 v99, v134, v135
    v_max3_f32 v230, v8, v9, v10
    v_max3_f32 v230, v230, v11, v12
    v_max3_f32 v230, v230, v13, v14
    v_max_f32 v230, v230, v15
    v_mov_b32 v231, v230
    s_nop 1
    v_permlane16_swap_b32 v230, v231
    s_nop 0
    v_max_f32 v230, v230, v231
    v_mov_b32 v231, v230
    s_nop 1
    v_permlane32_swap_b32 v230, v231
    s_nop 0
    v_max_f32_e64 v230, v230, v231
    v_add_f32 v230, 0x41800000, v230
    v_max_f32 v230, 0, v230
    v_sub_f32 v232, 0, v230
    v_exp_f32 v232, v232
    v_sub_f32 v225, v225, v230
    v_sub_f32 v72, v72, v230
    v_sub_f32 v40, v40, v230
    v_sub_f32 v8, v8, v230
    v_sub_f32 v73, v73, v230
    v_sub_f32 v41, v41, v230
    v_sub_f32 v9, v9, v230
    v_sub_f32 v74, v74, v230
    v_sub_f32 v42, v42, v230
    v_sub_f32 v10, v10, v230
    v_sub_f32 v75, v75, v230
    v_sub_f32 v43, v43, v230
    v_sub_f32 v11, v11, v230
    v_sub_f32 v76, v76, v230
    v_sub_f32 v44, v44, v230
    v_sub_f32 v12, v12, v230
    v_sub_f32 v77, v77, v230
    v_sub_f32 v45, v45, v230
    v_sub_f32 v13, v13, v230
    v_sub_f32 v78, v78, v230
    v_sub_f32 v46, v46, v230
    v_sub_f32 v14, v14, v230
    v_sub_f32 v79, v79, v230
    v_sub_f32 v47, v47, v230
    v_sub_f32 v15, v15, v230
    v_mul_f32 v148, v148, v232
    v_mul_f32 v149, v149, v232
    v_mul_f32 v150, v150, v232
    v_mul_f32 v151, v151, v232
    v_accvgpr_read_b32 v233, a32
    v_mul_f32_e64 v233, v233, v232
    v_accvgpr_write_b32 a32, v233
    v_accvgpr_read_b32 v234, a33
    v_mul_f32_e64 v234, v234, v232
    v_accvgpr_write_b32 a33, v234
    v_accvgpr_read_b32 v235, a34
    v_mul_f32_e64 v235, v235, v232
    v_accvgpr_write_b32 a34, v235
    v_accvgpr_read_b32 v236, a35
    v_mul_f32_e64 v236, v236, v232
    v_accvgpr_write_b32 a35, v236
    v_accvgpr_read_b32 v233, a36
    v_mul_f32_e64 v233, v233, v232
    v_accvgpr_write_b32 a36, v233
    v_accvgpr_read_b32 v234, a37
    v_mul_f32_e64 v234, v234, v232
    v_accvgpr_write_b32 a37, v234
    v_accvgpr_read_b32 v235, a38
    v_mul_f32_e64 v235, v235, v232
    v_accvgpr_write_b32 a38, v235
    v_accvgpr_read_b32 v236, a39
    v_mul_f32_e64 v236, v236, v232
    v_accvgpr_write_b32 a39, v236
    v_accvgpr_read_b32 v233, a40
    v_mul_f32_e64 v233, v233, v232
    v_accvgpr_write_b32 a40, v233
    v_accvgpr_read_b32 v234, a41
    v_mul_f32_e64 v234, v234, v232
    v_accvgpr_write_b32 a41, v234
    v_accvgpr_read_b32 v235, a42
    v_mul_f32_e64 v235, v235, v232
    v_accvgpr_write_b32 a42, v235
    v_accvgpr_read_b32 v236, a43
    v_mul_f32_e64 v236, v236, v232
    v_accvgpr_write_b32 a43, v236
    v_accvgpr_read_b32 v233, a44
    v_mul_f32_e64 v233, v233, v232
    v_accvgpr_write_b32 a44, v233
    v_accvgpr_read_b32 v234, a45
    v_mul_f32_e64 v234, v234, v232
    v_accvgpr_write_b32 a45, v234
    v_accvgpr_read_b32 v235, a46
    v_mul_f32_e64 v235, v235, v232
    v_accvgpr_write_b32 a46, v235
    v_accvgpr_read_b32 v236, a47
    v_mul_f32_e64 v236, v236, v232
    v_accvgpr_write_b32 a47, v236
    v_accvgpr_read_b32 v233, a48
    v_mul_f32_e64 v233, v233, v232
    v_accvgpr_write_b32 a48, v233
    v_accvgpr_read_b32 v234, a49
    v_mul_f32_e64 v234, v234, v232
    v_accvgpr_write_b32 a49, v234
    v_accvgpr_read_b32 v235, a50
    v_mul_f32_e64 v235, v235, v232
    v_accvgpr_write_b32 a50, v235
    v_accvgpr_read_b32 v236, a51
    v_mul_f32_e64 v236, v236, v232
    v_accvgpr_write_b32 a51, v236
    v_accvgpr_read_b32 v233, a52
    v_mul_f32_e64 v233, v233, v232
    v_accvgpr_write_b32 a52, v233
    v_accvgpr_read_b32 v234, a53
    v_mul_f32_e64 v234, v234, v232
    v_accvgpr_write_b32 a53, v234
    v_accvgpr_read_b32 v235, a54
    v_mul_f32_e64 v235, v235, v232
    v_accvgpr_write_b32 a54, v235
    v_accvgpr_read_b32 v236, a55
    v_mul_f32_e64 v236, v236, v232
    v_accvgpr_write_b32 a55, v236
    v_accvgpr_read_b32 v233, a56
    v_mul_f32_e64 v233, v233, v232
    v_accvgpr_write_b32 a56, v233
    v_accvgpr_read_b32 v234, a57
    v_mul_f32_e64 v234, v234, v232
    v_accvgpr_write_b32 a57, v234
    v_accvgpr_read_b32 v235, a58
    v_mul_f32_e64 v235, v235, v232
    v_accvgpr_write_b32 a58, v235
    v_accvgpr_read_b32 v236, a59
    v_mul_f32_e64 v236, v236, v232
    v_accvgpr_write_b32 a59, v236
    v_accvgpr_read_b32 v233, a60
    v_mul_f32_e64 v233, v233, v232
    v_accvgpr_write_b32 a60, v233
    v_accvgpr_read_b32 v234, a61
    v_mul_f32_e64 v234, v234, v232
    v_accvgpr_write_b32 a61, v234
    v_accvgpr_read_b32 v235, a62
    v_mul_f32_e64 v235, v235, v232
    v_accvgpr_write_b32 a62, v235
    v_accvgpr_read_b32 v236, a63
    v_mul_f32_e64 v236, v236, v232
    v_accvgpr_write_b32 a63, v236
    v_exp_f32 v128, v8
    v_exp_f32 v129, v9
    v_exp_f32 v130, v10
    v_exp_f32 v131, v11
    v_exp_f32 v132, v12
    v_exp_f32 v133, v13
    v_exp_f32 v134, v14
    v_exp_f32_e64 v135, v15
    s_nop 0
    v_cvt_pk_bf16_f32 v100, v128, v129
    v_cvt_pk_bf16_f32 v101, v130, v131
    v_cvt_pk_bf16_f32 v102, v132, v133
    v_cvt_pk_bf16_f32 v103, v134, v135
    v_max3_f32 v230, v16, v17, v18
    v_max3_f32 v230, v230, v19, v20
    v_max3_f32 v230, v230, v21, v22
    v_max_f32 v230, v230, v23
    v_mov_b32 v231, v230
    s_nop 1
    v_permlane16_swap_b32 v230, v231
    s_nop 0
    v_max_f32 v230, v230, v231
    v_mov_b32 v231, v230
    s_nop 1
    v_permlane32_swap_b32 v230, v231
    s_nop 0
    v_max_f32_e64 v230, v230, v231
    v_add_f32 v230, 0x41800000, v230
    v_max_f32 v230, 0, v230
    v_sub_f32 v232, 0, v230
    v_exp_f32 v232, v232
    v_sub_f32 v226, v226, v230
    v_sub_f32 v80, v80, v230
    v_sub_f32 v48, v48, v230
    v_sub_f32 v16, v16, v230
    v_sub_f32 v81, v81, v230
    v_sub_f32 v49, v49, v230
    v_sub_f32 v17, v17, v230
    v_sub_f32 v82, v82, v230
    v_sub_f32 v50, v50, v230
    v_sub_f32 v18, v18, v230
    v_sub_f32 v83, v83, v230
    v_sub_f32 v51, v51, v230
    v_sub_f32 v19, v19, v230
    v_sub_f32 v84, v84, v230
    v_sub_f32 v52, v52, v230
    v_sub_f32 v20, v20, v230
    v_sub_f32 v85, v85, v230
    v_sub_f32 v53, v53, v230
    v_sub_f32 v21, v21, v230
    v_sub_f32 v86, v86, v230
    v_sub_f32 v54, v54, v230
    v_sub_f32 v22, v22, v230
    v_sub_f32 v87, v87, v230
    v_sub_f32 v55, v55, v230
    v_sub_f32 v23, v23, v230
    v_mul_f32 v152, v152, v232
    v_mul_f32 v153, v153, v232
    v_mul_f32 v154, v154, v232
    v_mul_f32 v155, v155, v232
    v_accvgpr_read_b32 v233, a64
    v_mul_f32_e64 v233, v233, v232
    v_accvgpr_write_b32 a64, v233
    v_accvgpr_read_b32 v234, a65
    v_mul_f32_e64 v234, v234, v232
    v_accvgpr_write_b32 a65, v234
    v_accvgpr_read_b32 v235, a66
    v_mul_f32_e64 v235, v235, v232
    v_accvgpr_write_b32 a66, v235
    v_accvgpr_read_b32 v236, a67
    v_mul_f32_e64 v236, v236, v232
    v_accvgpr_write_b32 a67, v236
    v_accvgpr_read_b32 v233, a68
    v_mul_f32_e64 v233, v233, v232
    v_accvgpr_write_b32 a68, v233
    v_accvgpr_read_b32 v234, a69
    v_mul_f32_e64 v234, v234, v232
    v_accvgpr_write_b32 a69, v234
    v_accvgpr_read_b32 v235, a70
    v_mul_f32_e64 v235, v235, v232
    v_accvgpr_write_b32 a70, v235
    v_accvgpr_read_b32 v236, a71
    v_mul_f32_e64 v236, v236, v232
    v_accvgpr_write_b32 a71, v236
    v_accvgpr_read_b32 v233, a72
    v_mul_f32_e64 v233, v233, v232
    v_accvgpr_write_b32 a72, v233
    v_accvgpr_read_b32 v234, a73
    v_mul_f32_e64 v234, v234, v232
    v_accvgpr_write_b32 a73, v234
    v_accvgpr_read_b32 v235, a74
    v_mul_f32_e64 v235, v235, v232
    v_accvgpr_write_b32 a74, v235
    v_accvgpr_read_b32 v236, a75
    v_mul_f32_e64 v236, v236, v232
    v_accvgpr_write_b32 a75, v236
    v_accvgpr_read_b32 v233, a76
    v_mul_f32_e64 v233, v233, v232
    v_accvgpr_write_b32 a76, v233
    v_accvgpr_read_b32 v234, a77
    v_mul_f32_e64 v234, v234, v232
    v_accvgpr_write_b32 a77, v234
    v_accvgpr_read_b32 v235, a78
    v_mul_f32_e64 v235, v235, v232
    v_accvgpr_write_b32 a78, v235
    v_accvgpr_read_b32 v236, a79
    v_mul_f32_e64 v236, v236, v232
    v_accvgpr_write_b32 a79, v236
    v_accvgpr_read_b32 v233, a80
    v_mul_f32_e64 v233, v233, v232
    v_accvgpr_write_b32 a80, v233
    v_accvgpr_read_b32 v234, a81
    v_mul_f32_e64 v234, v234, v232
    v_accvgpr_write_b32 a81, v234
    v_accvgpr_read_b32 v235, a82
    v_mul_f32_e64 v235, v235, v232
    v_accvgpr_write_b32 a82, v235
    v_accvgpr_read_b32 v236, a83
    v_mul_f32_e64 v236, v236, v232
    v_accvgpr_write_b32 a83, v236
    v_accvgpr_read_b32 v233, a84
    v_mul_f32_e64 v233, v233, v232
    v_accvgpr_write_b32 a84, v233
    v_accvgpr_read_b32 v234, a85
    v_mul_f32_e64 v234, v234, v232
    v_accvgpr_write_b32 a85, v234
    v_accvgpr_read_b32 v235, a86
    v_mul_f32_e64 v235, v235, v232
    v_accvgpr_write_b32 a86, v235
    v_accvgpr_read_b32 v236, a87
    v_mul_f32_e64 v236, v236, v232
    v_accvgpr_write_b32 a87, v236
    v_accvgpr_read_b32 v233, a88
    v_mul_f32_e64 v233, v233, v232
    v_accvgpr_write_b32 a88, v233
    v_accvgpr_read_b32 v234, a89
    v_mul_f32_e64 v234, v234, v232
    v_accvgpr_write_b32 a89, v234
    v_accvgpr_read_b32 v235, a90
    v_mul_f32_e64 v235, v235, v232
    v_accvgpr_write_b32 a90, v235
    v_accvgpr_read_b32 v236, a91
    v_mul_f32_e64 v236, v236, v232
    v_accvgpr_write_b32 a91, v236
    v_accvgpr_read_b32 v233, a92
    v_mul_f32_e64 v233, v233, v232
    v_accvgpr_write_b32 a92, v233
    v_accvgpr_read_b32 v234, a93
    v_mul_f32_e64 v234, v234, v232
    v_accvgpr_write_b32 a93, v234
    v_accvgpr_read_b32 v235, a94
    v_mul_f32_e64 v235, v235, v232
    v_accvgpr_write_b32 a94, v235
    v_accvgpr_read_b32 v236, a95
    v_mul_f32_e64 v236, v236, v232
    v_accvgpr_write_b32 a95, v236
    v_exp_f32 v128, v16
    v_exp_f32 v129, v17
    v_exp_f32 v130, v18
    v_exp_f32 v131, v19
    v_exp_f32 v132, v20
    v_exp_f32 v133, v21
    v_exp_f32 v134, v22
    v_exp_f32_e64 v135, v23
    s_nop 0
    v_cvt_pk_bf16_f32 v104, v128, v129
    v_cvt_pk_bf16_f32 v105, v130, v131
    v_cvt_pk_bf16_f32 v106, v132, v133
    v_cvt_pk_bf16_f32 v107, v134, v135
    v_max3_f32 v230, v24, v25, v26
    v_max3_f32 v230, v230, v27, v28
    v_max3_f32 v230, v230, v29, v30
    v_max_f32 v230, v230, v31
    v_mov_b32 v231, v230
    s_nop 1
    v_permlane16_swap_b32 v230, v231
    s_nop 0
    v_max_f32 v230, v230, v231
    v_mov_b32 v231, v230
    s_nop 1
    v_permlane32_swap_b32 v230, v231
    s_nop 0
    v_max_f32_e64 v230, v230, v231
    v_add_f32 v230, 0x41800000, v230
    v_max_f32 v230, 0, v230
    v_sub_f32 v232, 0, v230
    v_exp_f32 v232, v232
    v_sub_f32 v227, v227, v230
    v_sub_f32 v88, v88, v230
    v_sub_f32 v56, v56, v230
    v_sub_f32 v24, v24, v230
    v_sub_f32 v89, v89, v230
    v_sub_f32 v57, v57, v230
    v_sub_f32 v25, v25, v230
    v_sub_f32 v90, v90, v230
    v_sub_f32 v58, v58, v230
    v_sub_f32 v26, v26, v230
    v_sub_f32 v91, v91, v230
    v_sub_f32 v59, v59, v230
    v_sub_f32 v27, v27, v230
    v_sub_f32 v92, v92, v230
    v_sub_f32 v60, v60, v230
    v_sub_f32 v28, v28, v230
    v_sub_f32 v93, v93, v230
    v_sub_f32 v61, v61, v230
    v_sub_f32 v29, v29, v230
    v_sub_f32 v94, v94, v230
    v_sub_f32 v62, v62, v230
    v_sub_f32 v30, v30, v230
    v_sub_f32 v95, v95, v230
    v_sub_f32 v63, v63, v230
    v_sub_f32 v31, v31, v230
    v_mul_f32 v156, v156, v232
    v_mul_f32 v157, v157, v232
    v_mul_f32 v158, v158, v232
    v_mul_f32 v159, v159, v232
    v_accvgpr_read_b32 v233, a96
    v_mul_f32_e64 v233, v233, v232
    v_accvgpr_write_b32 a96, v233
    v_accvgpr_read_b32 v234, a97
    v_mul_f32_e64 v234, v234, v232
    v_accvgpr_write_b32 a97, v234
    v_accvgpr_read_b32 v235, a98
    v_mul_f32_e64 v235, v235, v232
    v_accvgpr_write_b32 a98, v235
    v_accvgpr_read_b32 v236, a99
    v_mul_f32_e64 v236, v236, v232
    v_accvgpr_write_b32 a99, v236
    v_accvgpr_read_b32 v233, a100
    v_mul_f32_e64 v233, v233, v232
    v_accvgpr_write_b32 a100, v233
    v_accvgpr_read_b32 v234, a101
    v_mul_f32_e64 v234, v234, v232
    v_accvgpr_write_b32 a101, v234
    v_accvgpr_read_b32 v235, a102
    v_mul_f32_e64 v235, v235, v232
    v_accvgpr_write_b32 a102, v235
    v_accvgpr_read_b32 v236, a103
    v_mul_f32_e64 v236, v236, v232
    v_accvgpr_write_b32 a103, v236
    v_accvgpr_read_b32 v233, a104
    v_mul_f32_e64 v233, v233, v232
    v_accvgpr_write_b32 a104, v233
    v_accvgpr_read_b32 v234, a105
    v_mul_f32_e64 v234, v234, v232
    v_accvgpr_write_b32 a105, v234
    v_accvgpr_read_b32 v235, a106
    v_mul_f32_e64 v235, v235, v232
    v_accvgpr_write_b32 a106, v235
    v_accvgpr_read_b32 v236, a107
    v_mul_f32_e64 v236, v236, v232
    v_accvgpr_write_b32 a107, v236
    v_accvgpr_read_b32 v233, a108
    v_mul_f32_e64 v233, v233, v232
    v_accvgpr_write_b32 a108, v233
    v_accvgpr_read_b32 v234, a109
    v_mul_f32_e64 v234, v234, v232
    v_accvgpr_write_b32 a109, v234
    v_accvgpr_read_b32 v235, a110
    v_mul_f32_e64 v235, v235, v232
    v_accvgpr_write_b32 a110, v235
    v_accvgpr_read_b32 v236, a111
    v_mul_f32_e64 v236, v236, v232
    v_accvgpr_write_b32 a111, v236
    v_accvgpr_read_b32 v233, a112
    v_mul_f32_e64 v233, v233, v232
    v_accvgpr_write_b32 a112, v233
    v_accvgpr_read_b32 v234, a113
    v_mul_f32_e64 v234, v234, v232
    v_accvgpr_write_b32 a113, v234
    v_accvgpr_read_b32 v235, a114
    v_mul_f32_e64 v235, v235, v232
    v_accvgpr_write_b32 a114, v235
    v_accvgpr_read_b32 v236, a115
    v_mul_f32_e64 v236, v236, v232
    v_accvgpr_write_b32 a115, v236
    v_accvgpr_read_b32 v233, a116
    v_mul_f32_e64 v233, v233, v232
    v_accvgpr_write_b32 a116, v233
    v_accvgpr_read_b32 v234, a117
    v_mul_f32_e64 v234, v234, v232
    v_accvgpr_write_b32 a117, v234
    v_accvgpr_read_b32 v235, a118
    v_mul_f32_e64 v235, v235, v232
    v_accvgpr_write_b32 a118, v235
    v_accvgpr_read_b32 v236, a119
    v_mul_f32_e64 v236, v236, v232
    v_accvgpr_write_b32 a119, v236
    v_accvgpr_read_b32 v233, a120
    v_mul_f32_e64 v233, v233, v232
    v_accvgpr_write_b32 a120, v233
    v_accvgpr_read_b32 v234, a121
    v_mul_f32_e64 v234, v234, v232
    v_accvgpr_write_b32 a121, v234
    v_accvgpr_read_b32 v235, a122
    v_mul_f32_e64 v235, v235, v232
    v_accvgpr_write_b32 a122, v235
    v_accvgpr_read_b32 v236, a123
    v_mul_f32_e64 v236, v236, v232
    v_accvgpr_write_b32 a123, v236
    v_accvgpr_read_b32 v233, a124
    v_mul_f32_e64 v233, v233, v232
    v_accvgpr_write_b32 a124, v233
    v_accvgpr_read_b32 v234, a125
    v_mul_f32_e64 v234, v234, v232
    v_accvgpr_write_b32 a125, v234
    v_accvgpr_read_b32 v235, a126
    v_mul_f32_e64 v235, v235, v232
    v_accvgpr_write_b32 a126, v235
    v_accvgpr_read_b32 v236, a127
    v_mul_f32_e64 v236, v236, v232
    v_accvgpr_write_b32 a127, v236
    v_exp_f32 v128, v24
    v_exp_f32 v129, v25
    v_exp_f32 v130, v26
    v_exp_f32 v131, v27
    v_exp_f32 v132, v28
    v_exp_f32 v133, v29
    v_exp_f32 v134, v30
    v_exp_f32_e64 v135, v31
    s_nop 0
    v_cvt_pk_bf16_f32 v108, v128, v129
    v_cvt_pk_bf16_f32 v109, v130, v131
    v_cvt_pk_bf16_f32 v110, v132, v133
    v_cvt_pk_bf16_f32 v111, v134, v135
    s_nop 1
    s_branch kf_rr25
kf_rare30:
    s_nop 15
    v_max3_f32 v230, v32, v33, v34
    v_max3_f32 v230, v230, v35, v36
    v_max3_f32 v230, v230, v37, v38
    v_max_f32 v230, v230, v39
    v_mov_b32 v231, v230
    s_nop 1
    v_permlane16_swap_b32 v230, v231
    s_nop 0
    v_max_f32 v230, v230, v231
    v_mov_b32 v231, v230
    s_nop 1
    v_permlane32_swap_b32 v230, v231
    s_nop 0
    v_max_f32 v230, v230, v231
    v_add_f32 v230, 0x41800000, v230
    v_max_f32 v230, 0, v230
    v_sub_f32 v232, 0, v230
    v_exp_f32 v232, v232
    v_sub_f32 v224, v224, v230
    v_sub_f32 v64, v64, v230
    v_sub_f32 v0, v0, v230
    v_sub_f32 v32, v32, v230
    v_sub_f32 v65, v65, v230
    v_sub_f32 v1, v1, v230
    v_sub_f32 v33, v33, v230
    v_sub_f32 v66, v66, v230
    v_sub_f32 v2, v2, v230
    v_sub_f32 v34, v34, v230
    v_sub_f32 v67, v67, v230
    v_sub_f32 v3, v3, v230
    v_sub_f32 v35, v35, v230
    v_sub_f32 v68, v68, v230
    v_sub_f32 v4, v4, v230
    v_sub_f32 v36, v36, v230
    v_sub_f32 v69, v69, v230
    v_sub_f32 v5, v5, v230
    v_sub_f32 v37, v37, v230
    v_sub_f32 v70, v70, v230
    v_sub_f32 v6, v6, v230
    v_sub_f32 v38, v38, v230
    v_sub_f32 v71, v71, v230
    v_sub_f32 v7, v7, v230
    v_sub_f32 v39, v39, v230
    v_mul_f32 v144, v144, v232
    v_mul_f32 v145, v145, v232
    v_mul_f32 v146, v146, v232
    v_mul_f32 v147, v147, v232
    v_accvgpr_read_b32 v233, a0
    v_mul_f32_e64 v233, v233, v232
    v_accvgpr_write_b32 a0, v233
    v_accvgpr_read_b32 v234, a1
    v_mul_f32_e64 v234, v234, v232
    v_accvgpr_write_b32 a1, v234
    v_accvgpr_read_b32 v235, a2
    v_mul_f32_e64 v235, v235, v232
    v_accvgpr_write_b32 a2, v235
    v_accvgpr_read_b32 v236, a3
    v_mul_f32_e64 v236, v236, v232
    v_accvgpr_write_b32 a3, v236
    v_accvgpr_read_b32 v233, a4
    v_mul_f32_e64 v233, v233, v232
    v_accvgpr_write_b32 a4, v233
    v_accvgpr_read_b32 v234, a5
    v_mul_f32_e64 v234, v234, v232
    v_accvgpr_write_b32 a5, v234
    v_accvgpr_read_b32 v235, a6
    v_mul_f32_e64 v235, v235, v232
    v_accvgpr_write_b32 a6, v235
    v_accvgpr_read_b32 v236, a7
    v_mul_f32_e64 v236, v236, v232
    v_accvgpr_write_b32 a7, v236
    v_accvgpr_read_b32 v233, a8
    v_mul_f32_e64 v233, v233, v232
    v_accvgpr_write_b32 a8, v233
    v_accvgpr_read_b32 v234, a9
    v_mul_f32_e64 v234, v234, v232
    v_accvgpr_write_b32 a9, v234
    v_accvgpr_read_b32 v235, a10
    v_mul_f32_e64 v235, v235, v232
    v_accvgpr_write_b32 a10, v235
    v_accvgpr_read_b32 v236, a11
    v_mul_f32_e64 v236, v236, v232
    v_accvgpr_write_b32 a11, v236
    v_accvgpr_read_b32 v233, a12
    v_mul_f32_e64 v233, v233, v232
    v_accvgpr_write_b32 a12, v233
    v_accvgpr_read_b32 v234, a13
    v_mul_f32_e64 v234, v234, v232
    v_accvgpr_write_b32 a13, v234
    v_accvgpr_read_b32 v235, a14
    v_mul_f32_e64 v235, v235, v232
    v_accvgpr_write_b32 a14, v235
    v_accvgpr_read_b32 v236, a15
    v_mul_f32_e64 v236, v236, v232
    v_accvgpr_write_b32 a15, v236
    v_accvgpr_read_b32 v233, a16
    v_mul_f32_e64 v233, v233, v232
    v_accvgpr_write_b32 a16, v233
    v_accvgpr_read_b32 v234, a17
    v_mul_f32_e64 v234, v234, v232
    v_accvgpr_write_b32 a17, v234
    v_accvgpr_read_b32 v235, a18
    v_mul_f32_e64 v235, v235, v232
    v_accvgpr_write_b32 a18, v235
    v_accvgpr_read_b32 v236, a19
    v_mul_f32_e64 v236, v236, v232
    v_accvgpr_write_b32 a19, v236
    v_accvgpr_read_b32 v233, a20
    v_mul_f32_e64 v233, v233, v232
    v_accvgpr_write_b32 a20, v233
    v_accvgpr_read_b32 v234, a21
    v_mul_f32_e64 v234, v234, v232
    v_accvgpr_write_b32 a21, v234
    v_accvgpr_read_b32 v235, a22
    v_mul_f32_e64 v235, v235, v232
    v_accvgpr_write_b32 a22, v235
    v_accvgpr_read_b32 v236, a23
    v_mul_f32_e64 v236, v236, v232
    v_accvgpr_write_b32 a23, v236
    v_accvgpr_read_b32 v233, a24
    v_mul_f32_e64 v233, v233, v232
    v_accvgpr_write_b32 a24, v233
    v_accvgpr_read_b32 v234, a25
    v_mul_f32_e64 v234, v234, v232
    v_accvgpr_write_b32 a25, v234
    v_accvgpr_read_b32 v235, a26
    v_mul_f32_e64 v235, v235, v232
    v_accvgpr_write_b32 a26, v235
    v_accvgpr_read_b32 v236, a27
    v_mul_f32_e64 v236, v236, v232
    v_accvgpr_write_b32 a27, v236
    v_accvgpr_read_b32 v233, a28
    v_mul_f32_e64 v233, v233, v232
    v_accvgpr_write_b32 a28, v233
    v_accvgpr_read_b32 v234, a29
    v_mul_f32_e64 v234, v234, v232
    v_accvgpr_write_b32 a29, v234
    v_accvgpr_read_b32 v235, a30
    v_mul_f32_e64 v235, v235, v232
    v_accvgpr_write_b32 a30, v235
    v_accvgpr_read_b32 v236, a31
    v_mul_f32_e64 v236, v236, v232
    v_accvgpr_write_b32 a31, v236
    v_exp_f32 v128, v32
    v_exp_f32 v129, v33
    v_exp_f32 v130, v34
    v_exp_f32 v131, v35
    v_exp_f32 v132, v36
    v_exp_f32 v133, v37
    v_exp_f32 v134, v38
    v_exp_f32_e64 v135, v39
    s_nop 0
    v_cvt_pk_bf16_f32 v112, v128, v129
    v_cvt_pk_bf16_f32 v113, v130, v131
    v_cvt_pk_bf16_f32 v114, v132, v133
    v_cvt_pk_bf16_f32 v115, v134, v135
    v_max3_f32 v230, v40, v41, v42
    v_max3_f32 v230, v230, v43, v44
    v_max3_f32 v230, v230, v45, v46
    v_max_f32 v230, v230, v47
    v_mov_b32 v231, v230
    s_nop 1
    v_permlane16_swap_b32 v230, v231
    s_nop 0
    v_max_f32 v230, v230, v231
    v_mov_b32 v231, v230
    s_nop 1
    v_permlane32_swap_b32 v230, v231
    s_nop 0
    v_max_f32_e64 v230, v230, v231
    v_add_f32 v230, 0x41800000, v230
    v_max_f32 v230, 0, v230
    v_sub_f32 v232, 0, v230
    v_exp_f32 v232, v232
    v_sub_f32 v225, v225, v230
    v_sub_f32 v72, v72, v230
    v_sub_f32 v8, v8, v230
    v_sub_f32 v40, v40, v230
    v_sub_f32 v73, v73, v230
    v_sub_f32 v9, v9, v230
    v_sub_f32 v41, v41, v230
    v_sub_f32 v74, v74, v230
    v_sub_f32 v10, v10, v230
    v_sub_f32 v42, v42, v230
    v_sub_f32 v75, v75, v230
    v_sub_f32 v11, v11, v230
    v_sub_f32 v43, v43, v230
    v_sub_f32 v76, v76, v230
    v_sub_f32 v12, v12, v230
    v_sub_f32 v44, v44, v230
    v_sub_f32 v77, v77, v230
    v_sub_f32 v13, v13, v230
    v_sub_f32 v45, v45, v230
    v_sub_f32 v78, v78, v230
    v_sub_f32 v14, v14, v230
    v_sub_f32 v46, v46, v230
    v_sub_f32 v79, v79, v230
    v_sub_f32 v15, v15, v230
    v_sub_f32 v47, v47, v230
    v_mul_f32 v148, v148, v232
    v_mul_f32 v149, v149, v232
    v_mul_f32 v150, v150, v232
    v_mul_f32 v151, v151, v232
    v_accvgpr_read_b32 v233, a32
    v_mul_f32_e64 v233, v233, v232
    v_accvgpr_write_b32 a32, v233
    v_accvgpr_read_b32 v234, a33
    v_mul_f32_e64 v234, v234, v232
    v_accvgpr_write_b32 a33, v234
    v_accvgpr_read_b32 v235, a34
    v_mul_f32_e64 v235, v235, v232
    v_accvgpr_write_b32 a34, v235
    v_accvgpr_read_b32 v236, a35
    v_mul_f32_e64 v236, v236, v232
    v_accvgpr_write_b32 a35, v236
    v_accvgpr_read_b32 v233, a36
    v_mul_f32_e64 v233, v233, v232
    v_accvgpr_write_b32 a36, v233
    v_accvgpr_read_b32 v234, a37
    v_mul_f32_e64 v234, v234, v232
    v_accvgpr_write_b32 a37, v234
    v_accvgpr_read_b32 v235, a38
    v_mul_f32_e64 v235, v235, v232
    v_accvgpr_write_b32 a38, v235
    v_accvgpr_read_b32 v236, a39
    v_mul_f32_e64 v236, v236, v232
    v_accvgpr_write_b32 a39, v236
    v_accvgpr_read_b32 v233, a40
    v_mul_f32_e64 v233, v233, v232
    v_accvgpr_write_b32 a40, v233
    v_accvgpr_read_b32 v234, a41
    v_mul_f32_e64 v234, v234, v232
    v_accvgpr_write_b32 a41, v234
    v_accvgpr_read_b32 v235, a42
    v_mul_f32_e64 v235, v235, v232
    v_accvgpr_write_b32 a42, v235
    v_accvgpr_read_b32 v236, a43
    v_mul_f32_e64 v236, v236, v232
    v_accvgpr_write_b32 a43, v236
    v_accvgpr_read_b32 v233, a44
    v_mul_f32_e64 v233, v233, v232
    v_accvgpr_write_b32 a44, v233
    v_accvgpr_read_b32 v234, a45
    v_mul_f32_e64 v234, v234, v232
    v_accvgpr_write_b32 a45, v234
    v_accvgpr_read_b32 v235, a46
    v_mul_f32_e64 v235, v235, v232
    v_accvgpr_write_b32 a46, v235
    v_accvgpr_read_b32 v236, a47
    v_mul_f32_e64 v236, v236, v232
    v_accvgpr_write_b32 a47, v236
    v_accvgpr_read_b32 v233, a48
    v_mul_f32_e64 v233, v233, v232
    v_accvgpr_write_b32 a48, v233
    v_accvgpr_read_b32 v234, a49
    v_mul_f32_e64 v234, v234, v232
    v_accvgpr_write_b32 a49, v234
    v_accvgpr_read_b32 v235, a50
    v_mul_f32_e64 v235, v235, v232
    v_accvgpr_write_b32 a50, v235
    v_accvgpr_read_b32 v236, a51
    v_mul_f32_e64 v236, v236, v232
    v_accvgpr_write_b32 a51, v236
    v_accvgpr_read_b32 v233, a52
    v_mul_f32_e64 v233, v233, v232
    v_accvgpr_write_b32 a52, v233
    v_accvgpr_read_b32 v234, a53
    v_mul_f32_e64 v234, v234, v232
    v_accvgpr_write_b32 a53, v234
    v_accvgpr_read_b32 v235, a54
    v_mul_f32_e64 v235, v235, v232
    v_accvgpr_write_b32 a54, v235
    v_accvgpr_read_b32 v236, a55
    v_mul_f32_e64 v236, v236, v232
    v_accvgpr_write_b32 a55, v236
    v_accvgpr_read_b32 v233, a56
    v_mul_f32_e64 v233, v233, v232
    v_accvgpr_write_b32 a56, v233
    v_accvgpr_read_b32 v234, a57
    v_mul_f32_e64 v234, v234, v232
    v_accvgpr_write_b32 a57, v234
    v_accvgpr_read_b32 v235, a58
    v_mul_f32_e64 v235, v235, v232
    v_accvgpr_write_b32 a58, v235
    v_accvgpr_read_b32 v236, a59
    v_mul_f32_e64 v236, v236, v232
    v_accvgpr_write_b32 a59, v236
    v_accvgpr_read_b32 v233, a60
    v_mul_f32_e64 v233, v233, v232
    v_accvgpr_write_b32 a60, v233
    v_accvgpr_read_b32 v234, a61
    v_mul_f32_e64 v234, v234, v232
    v_accvgpr_write_b32 a61, v234
    v_accvgpr_read_b32 v235, a62
    v_mul_f32_e64 v235, v235, v232
    v_accvgpr_write_b32 a62, v235
    v_accvgpr_read_b32 v236, a63
    v_mul_f32_e64 v236, v236, v232
    v_accvgpr_write_b32 a63, v236
    v_exp_f32 v128, v40
    v_exp_f32 v129, v41
    v_exp_f32 v130, v42
    v_exp_f32 v131, v43
    v_exp_f32 v132, v44
    v_exp_f32 v133, v45
    v_exp_f32 v134, v46
    v_exp_f32_e64 v135, v47
    s_nop 0
    v_cvt_pk_bf16_f32 v116, v128, v129
    v_cvt_pk_bf16_f32 v117, v130, v131
    v_cvt_pk_bf16_f32 v118, v132, v133
    v_cvt_pk_bf16_f32 v119, v134, v135
    v_max3_f32 v230, v48, v49, v50
    v_max3_f32 v230, v230, v51, v52
    v_max3_f32 v230, v230, v53, v54
    v_max_f32 v230, v230, v55
    v_mov_b32 v231, v230
    s_nop 1
    v_permlane16_swap_b32 v230, v231
    s_nop 0
    v_max_f32 v230, v230, v231
    v_mov_b32 v231, v230
    s_nop 1
    v_permlane32_swap_b32 v230, v231
    s_nop 0
    v_max_f32_e64 v230, v230, v231
    v_add_f32 v230, 0x41800000, v230
    v_max_f32 v230, 0, v230
    v_sub_f32 v232, 0, v230
    v_exp_f32 v232, v232
    v_sub_f32 v226, v226, v230
    v_sub_f32 v80, v80, v230
    v_sub_f32 v16, v16, v230
    v_sub_f32 v48, v48, v230
    v_sub_f32 v81, v81, v230
    v_sub_f32 v17, v17, v230
    v_sub_f32 v49, v49, v230
    v_sub_f32 v82, v82, v230
    v_sub_f32 v18, v18, v230
    v_sub_f32 v50, v50, v230
    v_sub_f32 v83, v83, v230
    v_sub_f32 v19, v19, v230
    v_sub_f32 v51, v51, v230
    v_sub_f32 v84, v84, v230
    v_sub_f32 v20, v20, v230
    v_sub_f32 v52, v52, v230
    v_sub_f32 v85, v85, v230
    v_sub_f32 v21, v21, v230
    v_sub_f32 v53, v53, v230
    v_sub_f32 v86, v86, v230
    v_sub_f32 v22, v22, v230
    v_sub_f32 v54, v54, v230
    v_sub_f32 v87, v87, v230
    v_sub_f32 v23, v23, v230
    v_sub_f32 v55, v55, v230
    v_mul_f32 v152, v152, v232
    v_mul_f32 v153, v153, v232
    v_mul_f32 v154, v154, v232
    v_mul_f32 v155, v155, v232
    v_accvgpr_read_b32 v233, a64
    v_mul_f32_e64 v233, v233, v232
    v_accvgpr_write_b32 a64, v233
    v_accvgpr_read_b32 v234, a65
    v_mul_f32_e64 v234, v234, v232
    v_accvgpr_write_b32 a65, v234
    v_accvgpr_read_b32 v235, a66
    v_mul_f32_e64 v235, v235, v232
    v_accvgpr_write_b32 a66, v235
    v_accvgpr_read_b32 v236, a67
    v_mul_f32_e64 v236, v236, v232
    v_accvgpr_write_b32 a67, v236
    v_accvgpr_read_b32 v233, a68
    v_mul_f32_e64 v233, v233, v232
    v_accvgpr_write_b32 a68, v233
    v_accvgpr_read_b32 v234, a69
    v_mul_f32_e64 v234, v234, v232
    v_accvgpr_write_b32 a69, v234
    v_accvgpr_read_b32 v235, a70
    v_mul_f32_e64 v235, v235, v232
    v_accvgpr_write_b32 a70, v235
    v_accvgpr_read_b32 v236, a71
    v_mul_f32_e64 v236, v236, v232
    v_accvgpr_write_b32 a71, v236
    v_accvgpr_read_b32 v233, a72
    v_mul_f32_e64 v233, v233, v232
    v_accvgpr_write_b32 a72, v233
    v_accvgpr_read_b32 v234, a73
    v_mul_f32_e64 v234, v234, v232
    v_accvgpr_write_b32 a73, v234
    v_accvgpr_read_b32 v235, a74
    v_mul_f32_e64 v235, v235, v232
    v_accvgpr_write_b32 a74, v235
    v_accvgpr_read_b32 v236, a75
    v_mul_f32_e64 v236, v236, v232
    v_accvgpr_write_b32 a75, v236
    v_accvgpr_read_b32 v233, a76
    v_mul_f32_e64 v233, v233, v232
    v_accvgpr_write_b32 a76, v233
    v_accvgpr_read_b32 v234, a77
    v_mul_f32_e64 v234, v234, v232
    v_accvgpr_write_b32 a77, v234
    v_accvgpr_read_b32 v235, a78
    v_mul_f32_e64 v235, v235, v232
    v_accvgpr_write_b32 a78, v235
    v_accvgpr_read_b32 v236, a79
    v_mul_f32_e64 v236, v236, v232
    v_accvgpr_write_b32 a79, v236
    v_accvgpr_read_b32 v233, a80
    v_mul_f32_e64 v233, v233, v232
    v_accvgpr_write_b32 a80, v233
    v_accvgpr_read_b32 v234, a81
    v_mul_f32_e64 v234, v234, v232
    v_accvgpr_write_b32 a81, v234
    v_accvgpr_read_b32 v235, a82
    v_mul_f32_e64 v235, v235, v232
    v_accvgpr_write_b32 a82, v235
    v_accvgpr_read_b32 v236, a83
    v_mul_f32_e64 v236, v236, v232
    v_accvgpr_write_b32 a83, v236
    v_accvgpr_read_b32 v233, a84
    v_mul_f32_e64 v233, v233, v232
    v_accvgpr_write_b32 a84, v233
    v_accvgpr_read_b32 v234, a85
    v_mul_f32_e64 v234, v234, v232
    v_accvgpr_write_b32 a85, v234
    v_accvgpr_read_b32 v235, a86
    v_mul_f32_e64 v235, v235, v232
    v_accvgpr_write_b32 a86, v235
    v_accvgpr_read_b32 v236, a87
    v_mul_f32_e64 v236, v236, v232
    v_accvgpr_write_b32 a87, v236
    v_accvgpr_read_b32 v233, a88
    v_mul_f32_e64 v233, v233, v232
    v_accvgpr_write_b32 a88, v233
    v_accvgpr_read_b32 v234, a89
    v_mul_f32_e64 v234, v234, v232
    v_accvgpr_write_b32 a89, v234
    v_accvgpr_read_b32 v235, a90
    v_mul_f32_e64 v235, v235, v232
    v_accvgpr_write_b32 a90, v235
    v_accvgpr_read_b32 v236, a91
    v_mul_f32_e64 v236, v236, v232
    v_accvgpr_write_b32 a91, v236
    v_accvgpr_read_b32 v233, a92
    v_mul_f32_e64 v233, v233, v232
    v_accvgpr_write_b32 a92, v233
    v_accvgpr_read_b32 v234, a93
    v_mul_f32_e64 v234, v234, v232
    v_accvgpr_write_b32 a93, v234
    v_accvgpr_read_b32 v235, a94
    v_mul_f32_e64 v235, v235, v232
    v_accvgpr_write_b32 a94, v235
    v_accvgpr_read_b32 v236, a95
    v_mul_f32_e64 v236, v236, v232
    v_accvgpr_write_b32 a95, v236
    v_exp_f32 v128, v48
    v_exp_f32 v129, v49
    v_exp_f32 v130, v50
    v_exp_f32 v131, v51
    v_exp_f32 v132, v52
    v_exp_f32 v133, v53
    v_exp_f32 v134, v54
    v_exp_f32_e64 v135, v55
    s_nop 0
    v_cvt_pk_bf16_f32 v120, v128, v129
    v_cvt_pk_bf16_f32 v121, v130, v131
    v_cvt_pk_bf16_f32 v122, v132, v133
    v_cvt_pk_bf16_f32 v123, v134, v135
    v_max3_f32 v230, v56, v57, v58
    v_max3_f32 v230, v230, v59, v60
    v_max3_f32 v230, v230, v61, v62
    v_max_f32 v230, v230, v63
    v_mov_b32 v231, v230
    s_nop 1
    v_permlane16_swap_b32 v230, v231
    s_nop 0
    v_max_f32 v230, v230, v231
    v_mov_b32 v231, v230
    s_nop 1
    v_permlane32_swap_b32 v230, v231
    s_nop 0
    v_max_f32_e64 v230, v230, v231
    v_add_f32 v230, 0x41800000, v230
    v_max_f32 v230, 0, v230
    v_sub_f32 v232, 0, v230
    v_exp_f32 v232, v232
    v_sub_f32 v227, v227, v230
    v_sub_f32 v88, v88, v230
    v_sub_f32 v24, v24, v230
    v_sub_f32 v56, v56, v230
    v_sub_f32 v89, v89, v230
    v_sub_f32 v25, v25, v230
    v_sub_f32 v57, v57, v230
    v_sub_f32 v90, v90, v230
    v_sub_f32 v26, v26, v230
    v_sub_f32 v58, v58, v230
    v_sub_f32 v91, v91, v230
    v_sub_f32 v27, v27, v230
    v_sub_f32 v59, v59, v230
    v_sub_f32 v92, v92, v230
    v_sub_f32 v28, v28, v230
    v_sub_f32 v60, v60, v230
    v_sub_f32 v93, v93, v230
    v_sub_f32 v29, v29, v230
    v_sub_f32 v61, v61, v230
    v_sub_f32 v94, v94, v230
    v_sub_f32 v30, v30, v230
    v_sub_f32 v62, v62, v230
    v_sub_f32 v95, v95, v230
    v_sub_f32 v31, v31, v230
    v_sub_f32 v63, v63, v230
    v_mul_f32 v156, v156, v232
    v_mul_f32 v157, v157, v232
    v_mul_f32 v158, v158, v232
    v_mul_f32 v159, v159, v232
    v_accvgpr_read_b32 v233, a96
    v_mul_f32_e64 v233, v233, v232
    v_accvgpr_write_b32 a96, v233
    v_accvgpr_read_b32 v234, a97
    v_mul_f32_e64 v234, v234, v232
    v_accvgpr_write_b32 a97, v234
    v_accvgpr_read_b32 v235, a98
    v_mul_f32_e64 v235, v235, v232
    v_accvgpr_write_b32 a98, v235
    v_accvgpr_read_b32 v236, a99
    v_mul_f32_e64 v236, v236, v232
    v_accvgpr_write_b32 a99, v236
    v_accvgpr_read_b32 v233, a100
    v_mul_f32_e64 v233, v233, v232
    v_accvgpr_write_b32 a100, v233
    v_accvgpr_read_b32 v234, a101
    v_mul_f32_e64 v234, v234, v232
    v_accvgpr_write_b32 a101, v234
    v_accvgpr_read_b32 v235, a102
    v_mul_f32_e64 v235, v235, v232
    v_accvgpr_write_b32 a102, v235
    v_accvgpr_read_b32 v236, a103
    v_mul_f32_e64 v236, v236, v232
    v_accvgpr_write_b32 a103, v236
    v_accvgpr_read_b32 v233, a104
    v_mul_f32_e64 v233, v233, v232
    v_accvgpr_write_b32 a104, v233
    v_accvgpr_read_b32 v234, a105
    v_mul_f32_e64 v234, v234, v232
    v_accvgpr_write_b32 a105, v234
    v_accvgpr_read_b32 v235, a106
    v_mul_f32_e64 v235, v235, v232
    v_accvgpr_write_b32 a106, v235
    v_accvgpr_read_b32 v236, a107
    v_mul_f32_e64 v236, v236, v232
    v_accvgpr_write_b32 a107, v236
    v_accvgpr_read_b32 v233, a108
    v_mul_f32_e64 v233, v233, v232
    v_accvgpr_write_b32 a108, v233
    v_accvgpr_read_b32 v234, a109
    v_mul_f32_e64 v234, v234, v232
    v_accvgpr_write_b32 a109, v234
    v_accvgpr_read_b32 v235, a110
    v_mul_f32_e64 v235, v235, v232
    v_accvgpr_write_b32 a110, v235
    v_accvgpr_read_b32 v236, a111
    v_mul_f32_e64 v236, v236, v232
    v_accvgpr_write_b32 a111, v236
    v_accvgpr_read_b32 v233, a112
    v_mul_f32_e64 v233, v233, v232
    v_accvgpr_write_b32 a112, v233
    v_accvgpr_read_b32 v234, a113
    v_mul_f32_e64 v234, v234, v232
    v_accvgpr_write_b32 a113, v234
    v_accvgpr_read_b32 v235, a114
    v_mul_f32_e64 v235, v235, v232
    v_accvgpr_write_b32 a114, v235
    v_accvgpr_read_b32 v236, a115
    v_mul_f32_e64 v236, v236, v232
    v_accvgpr_write_b32 a115, v236
    v_accvgpr_read_b32 v233, a116
    v_mul_f32_e64 v233, v233, v232
    v_accvgpr_write_b32 a116, v233
    v_accvgpr_read_b32 v234, a117
    v_mul_f32_e64 v234, v234, v232
    v_accvgpr_write_b32 a117, v234
    v_accvgpr_read_b32 v235, a118
    v_mul_f32_e64 v235, v235, v232
    v_accvgpr_write_b32 a118, v235
    v_accvgpr_read_b32 v236, a119
    v_mul_f32_e64 v236, v236, v232
    v_accvgpr_write_b32 a119, v236
    v_accvgpr_read_b32 v233, a120
    v_mul_f32_e64 v233, v233, v232
    v_accvgpr_write_b32 a120, v233
    v_accvgpr_read_b32 v234, a121
    v_mul_f32_e64 v234, v234, v232
    v_accvgpr_write_b32 a121, v234
    v_accvgpr_read_b32 v235, a122
    v_mul_f32_e64 v235, v235, v232
    v_accvgpr_write_b32 a122, v235
    v_accvgpr_read_b32 v236, a123
    v_mul_f32_e64 v236, v236, v232
    v_accvgpr_write_b32 a123, v236
    v_accvgpr_read_b32 v233, a124
    v_mul_f32_e64 v233, v233, v232
    v_accvgpr_write_b32 a124, v233
    v_accvgpr_read_b32 v234, a125
    v_mul_f32_e64 v234, v234, v232
    v_accvgpr_write_b32 a125, v234
    v_accvgpr_read_b32 v235, a126
    v_mul_f32_e64 v235, v235, v232
    v_accvgpr_write_b32 a126, v235
    v_accvgpr_read_b32 v236, a127
    v_mul_f32_e64 v236, v236, v232
    v_accvgpr_write_b32 a127, v236
    v_exp_f32 v128, v56
    v_exp_f32 v129, v57
    v_exp_f32 v130, v58
    v_exp_f32 v131, v59
    v_exp_f32 v132, v60
    v_exp_f32 v133, v61
    v_exp_f32 v134, v62
    v_exp_f32_e64 v135, v63
    s_nop 0
    v_cvt_pk_bf16_f32 v124, v128, v129
    v_cvt_pk_bf16_f32 v125, v130, v131
    v_cvt_pk_bf16_f32 v126, v132, v133
    v_cvt_pk_bf16_f32 v127, v134, v135
    s_nop 1
    s_branch kf_rr29
kf_rare34:
    s_nop 15
    v_max3_f32 v230, v16, v17, v18
    v_max3_f32 v230, v230, v19, v20
    v_max3_f32 v230, v230, v21, v22
    v_max_f32 v230, v230, v23
    v_mov_b32 v231, v230
    s_nop 1
    v_permlane16_swap_b32 v230, v231
    s_nop 0
    v_max_f32 v230, v230, v231
    v_mov_b32 v231, v230
    s_nop 1
    v_permlane32_swap_b32 v230, v231
    s_nop 0
    v_max_f32 v230, v230, v231
    v_add_f32 v230, 0x41800000, v230
    v_max_f32 v230, 0, v230
    v_sub_f32 v232, 0, v230
    v_exp_f32 v232, v232
    v_sub_f32 v226, v226, v230
    v_sub_f32 v80, v80, v230
    v_sub_f32 v48, v48, v230
    v_sub_f32 v16, v16, v230
    v_sub_f32 v81, v81, v230
    v_sub_f32 v49, v49, v230
    v_sub_f32 v17, v17, v230
    v_sub_f32 v82, v82, v230
    v_sub_f32 v50, v50, v230
    v_sub_f32 v18, v18, v230
    v_sub_f32 v83, v83, v230
    v_sub_f32 v51, v51, v230
    v_sub_f32 v19, v19, v230
    v_sub_f32 v84, v84, v230
    v_sub_f32 v52, v52, v230
    v_sub_f32 v20, v20, v230
    v_sub_f32 v85, v85, v230
    v_sub_f32 v53, v53, v230
    v_sub_f32 v21, v21, v230
    v_sub_f32 v86, v86, v230
    v_sub_f32 v54, v54, v230
    v_sub_f32 v22, v22, v230
    v_sub_f32 v87, v87, v230
    v_sub_f32 v55, v55, v230
    v_sub_f32 v23, v23, v230
    v_mul_f32 v152, v152, v232
    v_mul_f32 v153, v153, v232
    v_mul_f32 v154, v154, v232
    v_mul_f32 v155, v155, v232
    v_accvgpr_read_b32 v233, a64
    v_mul_f32_e64 v233, v233, v232
    v_accvgpr_write_b32 a64, v233
    v_accvgpr_read_b32 v234, a65
    v_mul_f32_e64 v234, v234, v232
    v_accvgpr_write_b32 a65, v234
    v_accvgpr_read_b32 v235, a66
    v_mul_f32_e64 v235, v235, v232
    v_accvgpr_write_b32 a66, v235
    v_accvgpr_read_b32 v236, a67
    v_mul_f32_e64 v236, v236, v232
    v_accvgpr_write_b32 a67, v236
    v_accvgpr_read_b32 v233, a68
    v_mul_f32_e64 v233, v233, v232
    v_accvgpr_write_b32 a68, v233
    v_accvgpr_read_b32 v234, a69
    v_mul_f32_e64 v234, v234, v232
    v_accvgpr_write_b32 a69, v234
    v_accvgpr_read_b32 v235, a70
    v_mul_f32_e64 v235, v235, v232
    v_accvgpr_write_b32 a70, v235
    v_accvgpr_read_b32 v236, a71
    v_mul_f32_e64 v236, v236, v232
    v_accvgpr_write_b32 a71, v236
    v_accvgpr_read_b32 v233, a72
    v_mul_f32_e64 v233, v233, v232
    v_accvgpr_write_b32 a72, v233
    v_accvgpr_read_b32 v234, a73
    v_mul_f32_e64 v234, v234, v232
    v_accvgpr_write_b32 a73, v234
    v_accvgpr_read_b32 v235, a74
    v_mul_f32_e64 v235, v235, v232
    v_accvgpr_write_b32 a74, v235
    v_accvgpr_read_b32 v236, a75
    v_mul_f32_e64 v236, v236, v232
    v_accvgpr_write_b32 a75, v236
    v_accvgpr_read_b32 v233, a76
    v_mul_f32_e64 v233, v233, v232
    v_accvgpr_write_b32 a76, v233
    v_accvgpr_read_b32 v234, a77
    v_mul_f32_e64 v234, v234, v232
    v_accvgpr_write_b32 a77, v234
    v_accvgpr_read_b32 v235, a78
    v_mul_f32_e64 v235, v235, v232
    v_accvgpr_write_b32 a78, v235
    v_accvgpr_read_b32 v236, a79
    v_mul_f32_e64 v236, v236, v232
    v_accvgpr_write_b32 a79, v236
    v_accvgpr_read_b32 v233, a80
    v_mul_f32_e64 v233, v233, v232
    v_accvgpr_write_b32 a80, v233
    v_accvgpr_read_b32 v234, a81
    v_mul_f32_e64 v234, v234, v232
    v_accvgpr_write_b32 a81, v234
    v_accvgpr_read_b32 v235, a82
    v_mul_f32_e64 v235, v235, v232
    v_accvgpr_write_b32 a82, v235
    v_accvgpr_read_b32 v236, a83
    v_mul_f32_e64 v236, v236, v232
    v_accvgpr_write_b32 a83, v236
    v_accvgpr_read_b32 v233, a84
    v_mul_f32_e64 v233, v233, v232
    v_accvgpr_write_b32 a84, v233
    v_accvgpr_read_b32 v234, a85
    v_mul_f32_e64 v234, v234, v232
    v_accvgpr_write_b32 a85, v234
    v_accvgpr_read_b32 v235, a86
    v_mul_f32_e64 v235, v235, v232
    v_accvgpr_write_b32 a86, v235
    v_accvgpr_read_b32 v236, a87
    v_mul_f32_e64 v236, v236, v232
    v_accvgpr_write_b32 a87, v236
    v_accvgpr_read_b32 v233, a88
    v_mul_f32_e64 v233, v233, v232
    v_accvgpr_write_b32 a88, v233
    v_accvgpr_read_b32 v234, a89
    v_mul_f32_e64 v234, v234, v232
    v_accvgpr_write_b32 a89, v234
    v_accvgpr_read_b32 v235, a90
    v_mul_f32_e64 v235, v235, v232
    v_accvgpr_write_b32 a90, v235
    v_accvgpr_read_b32 v236, a91
    v_mul_f32_e64 v236, v236, v232
    v_accvgpr_write_b32 a91, v236
    v_accvgpr_read_b32 v233, a92
    v_mul_f32_e64 v233, v233, v232
    v_accvgpr_write_b32 a92, v233
    v_accvgpr_read_b32 v234, a93
    v_mul_f32_e64 v234, v234, v232
    v_accvgpr_write_b32 a93, v234
    v_accvgpr_read_b32 v235, a94
    v_mul_f32_e64 v235, v235, v232
    v_accvgpr_write_b32 a94, v235
    v_accvgpr_read_b32 v236, a95
    v_mul_f32_e64 v236, v236, v232
    v_accvgpr_write_b32 a95, v236
    v_exp_f32 v128, v16
    v_exp_f32 v129, v17
    v_exp_f32 v130, v18
    v_exp_f32 v131, v19
    v_exp_f32 v132, v20
    v_exp_f32 v133, v21
    v_exp_f32 v134, v22
    v_exp_f32_e64 v135, v23
    s_nop 0
    v_cvt_pk_bf16_f32 v104, v128, v129
    v_cvt_pk_bf16_f32 v105, v130, v131
    v_cvt_pk_bf16_f32 v106, v132, v133
    v_cvt_pk_bf16_f32 v107, v134, v135
    v_max3_f32 v230, v24, v25, v26
    v_max3_f32 v230, v230, v27, v28
    v_max3_f32 v230, v230, v29, v30
    v_max_f32 v230, v230, v31
    v_mov_b32 v231, v230
    s_nop 1
    v_permlane16_swap_b32 v230, v231
    s_nop 0
    v_max_f32 v230, v230, v231
    v_mov_b32 v231, v230
    s_nop 1
    v_permlane32_swap_b32 v230, v231
    s_nop 0
    v_max_f32_e64 v230, v230, v231
    v_add_f32 v230, 0x41800000, v230
    v_max_f32 v230, 0, v230
    v_sub_f32 v232, 0, v230
    v_exp_f32 v232, v232
    v_sub_f32 v227, v227, v230
    v_sub_f32 v88, v88, v230
    v_sub_f32 v56, v56, v230
    v_sub_f32 v24, v24, v230
    v_sub_f32 v89, v89, v230
    v_sub_f32 v57, v57, v230
    v_sub_f32 v25, v25, v230
    v_sub_f32 v90, v90, v230
    v_sub_f32 v58, v58, v230
    v_sub_f32 v26, v26, v230
    v_sub_f32 v91, v91, v230
    v_sub_f32 v59, v59, v230
    v_sub_f32 v27, v27, v230
    v_sub_f32 v92, v92, v230
    v_sub_f32 v60, v60, v230
    v_sub_f32 v28, v28, v230
    v_sub_f32 v93, v93, v230
    v_sub_f32 v61, v61, v230
    v_sub_f32 v29, v29, v230
    v_sub_f32 v94, v94, v230
    v_sub_f32 v62, v62, v230
    v_sub_f32 v30, v30, v230
    v_sub_f32 v95, v95, v230
    v_sub_f32 v63, v63, v230
    v_sub_f32 v31, v31, v230
    v_mul_f32 v156, v156, v232
    v_mul_f32 v157, v157, v232
    v_mul_f32 v158, v158, v232
    v_mul_f32 v159, v159, v232
    v_accvgpr_read_b32 v233, a96
    v_mul_f32_e64 v233, v233, v232
    v_accvgpr_write_b32 a96, v233
    v_accvgpr_read_b32 v234, a97
    v_mul_f32_e64 v234, v234, v232
    v_accvgpr_write_b32 a97, v234
    v_accvgpr_read_b32 v235, a98
    v_mul_f32_e64 v235, v235, v232
    v_accvgpr_write_b32 a98, v235
    v_accvgpr_read_b32 v236, a99
    v_mul_f32_e64 v236, v236, v232
    v_accvgpr_write_b32 a99, v236
    v_accvgpr_read_b32 v233, a100
    v_mul_f32_e64 v233, v233, v232
    v_accvgpr_write_b32 a100, v233
    v_accvgpr_read_b32 v234, a101
    v_mul_f32_e64 v234, v234, v232
    v_accvgpr_write_b32 a101, v234
    v_accvgpr_read_b32 v235, a102
    v_mul_f32_e64 v235, v235, v232
    v_accvgpr_write_b32 a102, v235
    v_accvgpr_read_b32 v236, a103
    v_mul_f32_e64 v236, v236, v232
    v_accvgpr_write_b32 a103, v236
    v_accvgpr_read_b32 v233, a104
    v_mul_f32_e64 v233, v233, v232
    v_accvgpr_write_b32 a104, v233
    v_accvgpr_read_b32 v234, a105
    v_mul_f32_e64 v234, v234, v232
    v_accvgpr_write_b32 a105, v234
    v_accvgpr_read_b32 v235, a106
    v_mul_f32_e64 v235, v235, v232
    v_accvgpr_write_b32 a106, v235
    v_accvgpr_read_b32 v236, a107
    v_mul_f32_e64 v236, v236, v232
    v_accvgpr_write_b32 a107, v236
    v_accvgpr_read_b32 v233, a108
    v_mul_f32_e64 v233, v233, v232
    v_accvgpr_write_b32 a108, v233
    v_accvgpr_read_b32 v234, a109
    v_mul_f32_e64 v234, v234, v232
    v_accvgpr_write_b32 a109, v234
    v_accvgpr_read_b32 v235, a110
    v_mul_f32_e64 v235, v235, v232
    v_accvgpr_write_b32 a110, v235
    v_accvgpr_read_b32 v236, a111
    v_mul_f32_e64 v236, v236, v232
    v_accvgpr_write_b32 a111, v236
    v_accvgpr_read_b32 v233, a112
    v_mul_f32_e64 v233, v233, v232
    v_accvgpr_write_b32 a112, v233
    v_accvgpr_read_b32 v234, a113
    v_mul_f32_e64 v234, v234, v232
    v_accvgpr_write_b32 a113, v234
    v_accvgpr_read_b32 v235, a114
    v_mul_f32_e64 v235, v235, v232
    v_accvgpr_write_b32 a114, v235
    v_accvgpr_read_b32 v236, a115
    v_mul_f32_e64 v236, v236, v232
    v_accvgpr_write_b32 a115, v236
    v_accvgpr_read_b32 v233, a116
    v_mul_f32_e64 v233, v233, v232
    v_accvgpr_write_b32 a116, v233
    v_accvgpr_read_b32 v234, a117
    v_mul_f32_e64 v234, v234, v232
    v_accvgpr_write_b32 a117, v234
    v_accvgpr_read_b32 v235, a118
    v_mul_f32_e64 v235, v235, v232
    v_accvgpr_write_b32 a118, v235
    v_accvgpr_read_b32 v236, a119
    v_mul_f32_e64 v236, v236, v232
    v_accvgpr_write_b32 a119, v236
    v_accvgpr_read_b32 v233, a120
    v_mul_f32_e64 v233, v233, v232
    v_accvgpr_write_b32 a120, v233
    v_accvgpr_read_b32 v234, a121
    v_mul_f32_e64 v234, v234, v232
    v_accvgpr_write_b32 a121, v234
    v_accvgpr_read_b32 v235, a122
    v_mul_f32_e64 v235, v235, v232
    v_accvgpr_write_b32 a122, v235
    v_accvgpr_read_b32 v236, a123
    v_mul_f32_e64 v236, v236, v232
    v_accvgpr_write_b32 a123, v236
    v_accvgpr_read_b32 v233, a124
    v_mul_f32_e64 v233, v233, v232
    v_accvgpr_write_b32 a124, v233
    v_accvgpr_read_b32 v234, a125
    v_mul_f32_e64 v234, v234, v232
    v_accvgpr_write_b32 a125, v234
    v_accvgpr_read_b32 v235, a126
    v_mul_f32_e64 v235, v235, v232
    v_accvgpr_write_b32 a126, v235
    v_accvgpr_read_b32 v236, a127
    v_mul_f32_e64 v236, v236, v232
    v_accvgpr_write_b32 a127, v236
    v_exp_f32 v128, v24
    v_exp_f32 v129, v25
    v_exp_f32 v130, v26
    v_exp_f32 v131, v27
    v_exp_f32 v132, v28
    v_exp_f32 v133, v29
    v_exp_f32 v134, v30
    v_exp_f32_e64 v135, v31
    s_nop 0
    v_cvt_pk_bf16_f32 v108, v128, v129
    v_cvt_pk_bf16_f32 v109, v130, v131
    v_cvt_pk_bf16_f32 v110, v132, v133
    v_cvt_pk_bf16_f32 v111, v134, v135
    s_nop 1
    s_branch kf_rr33
kf_rare38:
    s_nop 15
    v_max3_f32 v230, v48, v49, v50
    v_max3_f32 v230, v230, v51, v52
    v_max3_f32 v230, v230, v53, v54
    v_max_f32 v230, v230, v55
    v_mov_b32 v231, v230
    s_nop 1
    v_permlane16_swap_b32 v230, v231
    s_nop 0
    v_max_f32 v230, v230, v231
    v_mov_b32 v231, v230
    s_nop 1
    v_permlane32_swap_b32 v230, v231
    s_nop 0
    v_max_f32 v230, v230, v231
    v_add_f32 v230, 0x41800000, v230
    v_max_f32 v230, 0, v230
    v_sub_f32 v232, 0, v230
    v_exp_f32 v232, v232
    v_sub_f32 v226, v226, v230
    v_sub_f32 v80, v80, v230
    v_sub_f32 v16, v16, v230
    v_sub_f32 v48, v48, v230
    v_sub_f32 v81, v81, v230
    v_sub_f32 v17, v17, v230
    v_sub_f32 v49, v49, v230
    v_sub_f32 v82, v82, v230
    v_sub_f32 v18, v18, v230
    v_sub_f32 v50, v50, v230
    v_sub_f32 v83, v83, v230
    v_sub_f32 v19, v19, v230
    v_sub_f32 v51, v51, v230
    v_sub_f32 v84, v84, v230
    v_sub_f32 v20, v20, v230
    v_sub_f32 v52, v52, v230
    v_sub_f32 v85, v85, v230
    v_sub_f32 v21, v21, v230
    v_sub_f32 v53, v53, v230
    v_sub_f32 v86, v86, v230
    v_sub_f32 v22, v22, v230
    v_sub_f32 v54, v54, v230
    v_sub_f32 v87, v87, v230
    v_sub_f32 v23, v23, v230
    v_sub_f32 v55, v55, v230
    v_mul_f32 v152, v152, v232
    v_mul_f32 v153, v153, v232
    v_mul_f32 v154, v154, v232
    v_mul_f32 v155, v155, v232
    v_accvgpr_read_b32 v233, a64
    v_mul_f32_e64 v233, v233, v232
    v_accvgpr_write_b32 a64, v233
    v_accvgpr_read_b32 v234, a65
    v_mul_f32_e64 v234, v234, v232
    v_accvgpr_write_b32 a65, v234
    v_accvgpr_read_b32 v235, a66
    v_mul_f32_e64 v235, v235, v232
    v_accvgpr_write_b32 a66, v235
    v_accvgpr_read_b32 v236, a67
    v_mul_f32_e64 v236, v236, v232
    v_accvgpr_write_b32 a67, v236
    v_accvgpr_read_b32 v233, a68
    v_mul_f32_e64 v233, v233, v232
    v_accvgpr_write_b32 a68, v233
    v_accvgpr_read_b32 v234, a69
    v_mul_f32_e64 v234, v234, v232
    v_accvgpr_write_b32 a69, v234
    v_accvgpr_read_b32 v235, a70
    v_mul_f32_e64 v235, v235, v232
    v_accvgpr_write_b32 a70, v235
    v_accvgpr_read_b32 v236, a71
    v_mul_f32_e64 v236, v236, v232
    v_accvgpr_write_b32 a71, v236
    v_accvgpr_read_b32 v233, a72
    v_mul_f32_e64 v233, v233, v232
    v_accvgpr_write_b32 a72, v233
    v_accvgpr_read_b32 v234, a73
    v_mul_f32_e64 v234, v234, v232
    v_accvgpr_write_b32 a73, v234
    v_accvgpr_read_b32 v235, a74
    v_mul_f32_e64 v235, v235, v232
    v_accvgpr_write_b32 a74, v235
    v_accvgpr_read_b32 v236, a75
    v_mul_f32_e64 v236, v236, v232
    v_accvgpr_write_b32 a75, v236
    v_accvgpr_read_b32 v233, a76
    v_mul_f32_e64 v233, v233, v232
    v_accvgpr_write_b32 a76, v233
    v_accvgpr_read_b32 v234, a77
    v_mul_f32_e64 v234, v234, v232
    v_accvgpr_write_b32 a77, v234
    v_accvgpr_read_b32 v235, a78
    v_mul_f32_e64 v235, v235, v232
    v_accvgpr_write_b32 a78, v235
    v_accvgpr_read_b32 v236, a79
    v_mul_f32_e64 v236, v236, v232
    v_accvgpr_write_b32 a79, v236
    v_accvgpr_read_b32 v233, a80
    v_mul_f32_e64 v233, v233, v232
    v_accvgpr_write_b32 a80, v233
    v_accvgpr_read_b32 v234, a81
    v_mul_f32_e64 v234, v234, v232
    v_accvgpr_write_b32 a81, v234
    v_accvgpr_read_b32 v235, a82
    v_mul_f32_e64 v235, v235, v232
    v_accvgpr_write_b32 a82, v235
    v_accvgpr_read_b32 v236, a83
    v_mul_f32_e64 v236, v236, v232
    v_accvgpr_write_b32 a83, v236
    v_accvgpr_read_b32 v233, a84
    v_mul_f32_e64 v233, v233, v232
    v_accvgpr_write_b32 a84, v233
    v_accvgpr_read_b32 v234, a85
    v_mul_f32_e64 v234, v234, v232
    v_accvgpr_write_b32 a85, v234
    v_accvgpr_read_b32 v235, a86
    v_mul_f32_e64 v235, v235, v232
    v_accvgpr_write_b32 a86, v235
    v_accvgpr_read_b32 v236, a87
    v_mul_f32_e64 v236, v236, v232
    v_accvgpr_write_b32 a87, v236
    v_accvgpr_read_b32 v233, a88
    v_mul_f32_e64 v233, v233, v232
    v_accvgpr_write_b32 a88, v233
    v_accvgpr_read_b32 v234, a89
    v_mul_f32_e64 v234, v234, v232
    v_accvgpr_write_b32 a89, v234
    v_accvgpr_read_b32 v235, a90
    v_mul_f32_e64 v235, v235, v232
    v_accvgpr_write_b32 a90, v235
    v_accvgpr_read_b32 v236, a91
    v_mul_f32_e64 v236, v236, v232
    v_accvgpr_write_b32 a91, v236
    v_accvgpr_read_b32 v233, a92
    v_mul_f32_e64 v233, v233, v232
    v_accvgpr_write_b32 a92, v233
    v_accvgpr_read_b32 v234, a93
    v_mul_f32_e64 v234, v234, v232
    v_accvgpr_write_b32 a93, v234
    v_accvgpr_read_b32 v235, a94
    v_mul_f32_e64 v235, v235, v232
    v_accvgpr_write_b32 a94, v235
    v_accvgpr_read_b32 v236, a95
    v_mul_f32_e64 v236, v236, v232
    v_accvgpr_write_b32 a95, v236
    v_exp_f32 v128, v48
    v_exp_f32 v129, v49
    v_exp_f32 v130, v50
    v_exp_f32 v131, v51
    v_exp_f32 v132, v52
    v_exp_f32 v133, v53
    v_exp_f32 v134, v54
    v_exp_f32_e64 v135, v55
    s_nop 0
    v_cvt_pk_bf16_f32 v120, v128, v129
    v_cvt_pk_bf16_f32 v121, v130, v131
    v_cvt_pk_bf16_f32 v122, v132, v133
    v_cvt_pk_bf16_f32 v123, v134, v135
    v_max3_f32 v230, v56, v57, v58
    v_max3_f32 v230, v230, v59, v60
    v_max3_f32 v230, v230, v61, v62
    v_max_f32 v230, v230, v63
    v_mov_b32 v231, v230
    s_nop 1
    v_permlane16_swap_b32 v230, v231
    s_nop 0
    v_max_f32 v230, v230, v231
    v_mov_b32 v231, v230
    s_nop 1
    v_permlane32_swap_b32 v230, v231
    s_nop 0
    v_max_f32_e64 v230, v230, v231
    v_add_f32 v230, 0x41800000, v230
    v_max_f32 v230, 0, v230
    v_sub_f32 v232, 0, v230
    v_exp_f32 v232, v232
    v_sub_f32 v227, v227, v230
    v_sub_f32 v88, v88, v230
    v_sub_f32 v24, v24, v230
    v_sub_f32 v56, v56, v230
    v_sub_f32 v89, v89, v230
    v_sub_f32 v25, v25, v230
    v_sub_f32 v57, v57, v230
    v_sub_f32 v90, v90, v230
    v_sub_f32 v26, v26, v230
    v_sub_f32 v58, v58, v230
    v_sub_f32 v91, v91, v230
    v_sub_f32 v27, v27, v230
    v_sub_f32 v59, v59, v230
    v_sub_f32 v92, v92, v230
    v_sub_f32 v28, v28, v230
    v_sub_f32 v60, v60, v230
    v_sub_f32 v93, v93, v230
    v_sub_f32 v29, v29, v230
    v_sub_f32 v61, v61, v230
    v_sub_f32 v94, v94, v230
    v_sub_f32 v30, v30, v230
    v_sub_f32 v62, v62, v230
    v_sub_f32 v95, v95, v230
    v_sub_f32 v31, v31, v230
    v_sub_f32 v63, v63, v230
    v_mul_f32 v156, v156, v232
    v_mul_f32 v157, v157, v232
    v_mul_f32 v158, v158, v232
    v_mul_f32 v159, v159, v232
    v_accvgpr_read_b32 v233, a96
    v_mul_f32_e64 v233, v233, v232
    v_accvgpr_write_b32 a96, v233
    v_accvgpr_read_b32 v234, a97
    v_mul_f32_e64 v234, v234, v232
    v_accvgpr_write_b32 a97, v234
    v_accvgpr_read_b32 v235, a98
    v_mul_f32_e64 v235, v235, v232
    v_accvgpr_write_b32 a98, v235
    v_accvgpr_read_b32 v236, a99
    v_mul_f32_e64 v236, v236, v232
    v_accvgpr_write_b32 a99, v236
    v_accvgpr_read_b32 v233, a100
    v_mul_f32_e64 v233, v233, v232
    v_accvgpr_write_b32 a100, v233
    v_accvgpr_read_b32 v234, a101
    v_mul_f32_e64 v234, v234, v232
    v_accvgpr_write_b32 a101, v234
    v_accvgpr_read_b32 v235, a102
    v_mul_f32_e64 v235, v235, v232
    v_accvgpr_write_b32 a102, v235
    v_accvgpr_read_b32 v236, a103
    v_mul_f32_e64 v236, v236, v232
    v_accvgpr_write_b32 a103, v236
    v_accvgpr_read_b32 v233, a104
    v_mul_f32_e64 v233, v233, v232
    v_accvgpr_write_b32 a104, v233
    v_accvgpr_read_b32 v234, a105
    v_mul_f32_e64 v234, v234, v232
    v_accvgpr_write_b32 a105, v234
    v_accvgpr_read_b32 v235, a106
    v_mul_f32_e64 v235, v235, v232
    v_accvgpr_write_b32 a106, v235
    v_accvgpr_read_b32 v236, a107
    v_mul_f32_e64 v236, v236, v232
    v_accvgpr_write_b32 a107, v236
    v_accvgpr_read_b32 v233, a108
    v_mul_f32_e64 v233, v233, v232
    v_accvgpr_write_b32 a108, v233
    v_accvgpr_read_b32 v234, a109
    v_mul_f32_e64 v234, v234, v232
    v_accvgpr_write_b32 a109, v234
    v_accvgpr_read_b32 v235, a110
    v_mul_f32_e64 v235, v235, v232
    v_accvgpr_write_b32 a110, v235
    v_accvgpr_read_b32 v236, a111
    v_mul_f32_e64 v236, v236, v232
    v_accvgpr_write_b32 a111, v236
    v_accvgpr_read_b32 v233, a112
    v_mul_f32_e64 v233, v233, v232
    v_accvgpr_write_b32 a112, v233
    v_accvgpr_read_b32 v234, a113
    v_mul_f32_e64 v234, v234, v232
    v_accvgpr_write_b32 a113, v234
    v_accvgpr_read_b32 v235, a114
    v_mul_f32_e64 v235, v235, v232
    v_accvgpr_write_b32 a114, v235
    v_accvgpr_read_b32 v236, a115
    v_mul_f32_e64 v236, v236, v232
    v_accvgpr_write_b32 a115, v236
    v_accvgpr_read_b32 v233, a116
    v_mul_f32_e64 v233, v233, v232
    v_accvgpr_write_b32 a116, v233
    v_accvgpr_read_b32 v234, a117
    v_mul_f32_e64 v234, v234, v232
    v_accvgpr_write_b32 a117, v234
    v_accvgpr_read_b32 v235, a118
    v_mul_f32_e64 v235, v235, v232
    v_accvgpr_write_b32 a118, v235
    v_accvgpr_read_b32 v236, a119
    v_mul_f32_e64 v236, v236, v232
    v_accvgpr_write_b32 a119, v236
    v_accvgpr_read_b32 v233, a120
    v_mul_f32_e64 v233, v233, v232
    v_accvgpr_write_b32 a120, v233
    v_accvgpr_read_b32 v234, a121
    v_mul_f32_e64 v234, v234, v232
    v_accvgpr_write_b32 a121, v234
    v_accvgpr_read_b32 v235, a122
    v_mul_f32_e64 v235, v235, v232
    v_accvgpr_write_b32 a122, v235
    v_accvgpr_read_b32 v236, a123
    v_mul_f32_e64 v236, v236, v232
    v_accvgpr_write_b32 a123, v236
    v_accvgpr_read_b32 v233, a124
    v_mul_f32_e64 v233, v233, v232
    v_accvgpr_write_b32 a124, v233
    v_accvgpr_read_b32 v234, a125
    v_mul_f32_e64 v234, v234, v232
    v_accvgpr_write_b32 a125, v234
    v_accvgpr_read_b32 v235, a126
    v_mul_f32_e64 v235, v235, v232
    v_accvgpr_write_b32 a126, v235
    v_accvgpr_read_b32 v236, a127
    v_mul_f32_e64 v236, v236, v232
    v_accvgpr_write_b32 a127, v236
    v_exp_f32 v128, v56
    v_exp_f32 v129, v57
    v_exp_f32 v130, v58
    v_exp_f32 v131, v59
    v_exp_f32 v132, v60
    v_exp_f32 v133, v61
    v_exp_f32 v134, v62
    v_exp_f32_e64 v135, v63
    s_nop 0
    v_cvt_pk_bf16_f32 v124, v128, v129
    v_cvt_pk_bf16_f32 v125, v130, v131
    v_cvt_pk_bf16_f32 v126, v132, v133
    v_cvt_pk_bf16_f32 v127, v134, v135
    s_nop 1
    s_branch kf_rr37
kf_rare42:
    s_nop 15
    v_max3_f32 v230, v16, v17, v18
    v_max3_f32 v230, v230, v19, v20
    v_max3_f32 v230, v230, v21, v22
    v_max_f32 v230, v230, v23
    v_mov_b32 v231, v230
    s_nop 1
    v_permlane16_swap_b32 v230, v231
    s_nop 0
    v_max_f32 v230, v230, v231
    v_mov_b32 v231, v230
    s_nop 1
    v_permlane32_swap_b32 v230, v231
    s_nop 0
    v_max_f32 v230, v230, v231
    v_add_f32 v230, 0x41800000, v230
    v_max_f32 v230, 0, v230
    v_sub_f32 v232, 0, v230
    v_exp_f32 v232, v232
    v_sub_f32 v226, v226, v230
    v_sub_f32 v80, v80, v230
    v_sub_f32 v48, v48, v230
    v_sub_f32 v16, v16, v230
    v_sub_f32 v81, v81, v230
    v_sub_f32 v49, v49, v230
    v_sub_f32 v17, v17, v230
    v_sub_f32 v82, v82, v230
    v_sub_f32 v50, v50, v230
    v_sub_f32 v18, v18, v230
    v_sub_f32 v83, v83, v230
    v_sub_f32 v51, v51, v230
    v_sub_f32 v19, v19, v230
    v_sub_f32 v84, v84, v230
    v_sub_f32 v52, v52, v230
    v_sub_f32 v20, v20, v230
    v_sub_f32 v85, v85, v230
    v_sub_f32 v53, v53, v230
    v_sub_f32 v21, v21, v230
    v_sub_f32 v86, v86, v230
    v_sub_f32 v54, v54, v230
    v_sub_f32 v22, v22, v230
    v_sub_f32 v87, v87, v230
    v_sub_f32 v55, v55, v230
    v_sub_f32 v23, v23, v230
    v_mul_f32 v152, v152, v232
    v_mul_f32 v153, v153, v232
    v_mul_f32 v154, v154, v232
    v_mul_f32 v155, v155, v232
    v_accvgpr_read_b32 v233, a64
    v_mul_f32_e64 v233, v233, v232
    v_accvgpr_write_b32 a64, v233
    v_accvgpr_read_b32 v234, a65
    v_mul_f32_e64 v234, v234, v232
    v_accvgpr_write_b32 a65, v234
    v_accvgpr_read_b32 v235, a66
    v_mul_f32_e64 v235, v235, v232
    v_accvgpr_write_b32 a66, v235
    v_accvgpr_read_b32 v236, a67
    v_mul_f32_e64 v236, v236, v232
    v_accvgpr_write_b32 a67, v236
    v_accvgpr_read_b32 v233, a68
    v_mul_f32_e64 v233, v233, v232
    v_accvgpr_write_b32 a68, v233
    v_accvgpr_read_b32 v234, a69
    v_mul_f32_e64 v234, v234, v232
    v_accvgpr_write_b32 a69, v234
    v_accvgpr_read_b32 v235, a70
    v_mul_f32_e64 v235, v235, v232
    v_accvgpr_write_b32 a70, v235
    v_accvgpr_read_b32 v236, a71
    v_mul_f32_e64 v236, v236, v232
    v_accvgpr_write_b32 a71, v236
    v_accvgpr_read_b32 v233, a72
    v_mul_f32_e64 v233, v233, v232
    v_accvgpr_write_b32 a72, v233
    v_accvgpr_read_b32 v234, a73
    v_mul_f32_e64 v234, v234, v232
    v_accvgpr_write_b32 a73, v234
    v_accvgpr_read_b32 v235, a74
    v_mul_f32_e64 v235, v235, v232
    v_accvgpr_write_b32 a74, v235
    v_accvgpr_read_b32 v236, a75
    v_mul_f32_e64 v236, v236, v232
    v_accvgpr_write_b32 a75, v236
    v_accvgpr_read_b32 v233, a76
    v_mul_f32_e64 v233, v233, v232
    v_accvgpr_write_b32 a76, v233
    v_accvgpr_read_b32 v234, a77
    v_mul_f32_e64 v234, v234, v232
    v_accvgpr_write_b32 a77, v234
    v_accvgpr_read_b32 v235, a78
    v_mul_f32_e64 v235, v235, v232
    v_accvgpr_write_b32 a78, v235
    v_accvgpr_read_b32 v236, a79
    v_mul_f32_e64 v236, v236, v232
    v_accvgpr_write_b32 a79, v236
    v_accvgpr_read_b32 v233, a80
    v_mul_f32_e64 v233, v233, v232
    v_accvgpr_write_b32 a80, v233
    v_accvgpr_read_b32 v234, a81
    v_mul_f32_e64 v234, v234, v232
    v_accvgpr_write_b32 a81, v234
    v_accvgpr_read_b32 v235, a82
    v_mul_f32_e64 v235, v235, v232
    v_accvgpr_write_b32 a82, v235
    v_accvgpr_read_b32 v236, a83
    v_mul_f32_e64 v236, v236, v232
    v_accvgpr_write_b32 a83, v236
    v_accvgpr_read_b32 v233, a84
    v_mul_f32_e64 v233, v233, v232
    v_accvgpr_write_b32 a84, v233
    v_accvgpr_read_b32 v234, a85
    v_mul_f32_e64 v234, v234, v232
    v_accvgpr_write_b32 a85, v234
    v_accvgpr_read_b32 v235, a86
    v_mul_f32_e64 v235, v235, v232
    v_accvgpr_write_b32 a86, v235
    v_accvgpr_read_b32 v236, a87
    v_mul_f32_e64 v236, v236, v232
    v_accvgpr_write_b32 a87, v236
    v_accvgpr_read_b32 v233, a88
    v_mul_f32_e64 v233, v233, v232
    v_accvgpr_write_b32 a88, v233
    v_accvgpr_read_b32 v234, a89
    v_mul_f32_e64 v234, v234, v232
    v_accvgpr_write_b32 a89, v234
    v_accvgpr_read_b32 v235, a90
    v_mul_f32_e64 v235, v235, v232
    v_accvgpr_write_b32 a90, v235
    v_accvgpr_read_b32 v236, a91
    v_mul_f32_e64 v236, v236, v232
    v_accvgpr_write_b32 a91, v236
    v_accvgpr_read_b32 v233, a92
    v_mul_f32_e64 v233, v233, v232
    v_accvgpr_write_b32 a92, v233
    v_accvgpr_read_b32 v234, a93
    v_mul_f32_e64 v234, v234, v232
    v_accvgpr_write_b32 a93, v234
    v_accvgpr_read_b32 v235, a94
    v_mul_f32_e64 v235, v235, v232
    v_accvgpr_write_b32 a94, v235
    v_accvgpr_read_b32 v236, a95
    v_mul_f32_e64 v236, v236, v232
    v_accvgpr_write_b32 a95, v236
    v_exp_f32 v128, v16
    v_exp_f32 v129, v17
    v_exp_f32 v130, v18
    v_exp_f32 v131, v19
    v_exp_f32 v132, v20
    v_exp_f32 v133, v21
    v_exp_f32 v134, v22
    v_exp_f32_e64 v135, v23
    s_nop 0
    v_cvt_pk_bf16_f32 v104, v128, v129
    v_cvt_pk_bf16_f32 v105, v130, v131
    v_cvt_pk_bf16_f32 v106, v132, v133
    v_cvt_pk_bf16_f32 v107, v134, v135
    v_max3_f32 v230, v24, v25, v26
    v_max3_f32 v230, v230, v27, v28
    v_max3_f32 v230, v230, v29, v30
    v_max_f32 v230, v230, v31
    v_mov_b32 v231, v230
    s_nop 1
    v_permlane16_swap_b32 v230, v231
    s_nop 0
    v_max_f32 v230, v230, v231
    v_mov_b32 v231, v230
    s_nop 1
    v_permlane32_swap_b32 v230, v231
    s_nop 0
    v_max_f32_e64 v230, v230, v231
    v_add_f32 v230, 0x41800000, v230
    v_max_f32 v230, 0, v230
    v_sub_f32 v232, 0, v230
    v_exp_f32 v232, v232
    v_sub_f32 v227, v227, v230
    v_sub_f32 v88, v88, v230
    v_sub_f32 v56, v56, v230
    v_sub_f32 v24, v24, v230
    v_sub_f32 v89, v89, v230
    v_sub_f32 v57, v57, v230
    v_sub_f32 v25, v25, v230
    v_sub_f32 v90, v90, v230
    v_sub_f32 v58, v58, v230
    v_sub_f32 v26, v26, v230
    v_sub_f32 v91, v91, v230
    v_sub_f32 v59, v59, v230
    v_sub_f32 v27, v27, v230
    v_sub_f32 v92, v92, v230
    v_sub_f32 v60, v60, v230
    v_sub_f32 v28, v28, v230
    v_sub_f32 v93, v93, v230
    v_sub_f32 v61, v61, v230
    v_sub_f32 v29, v29, v230
    v_sub_f32 v94, v94, v230
    v_sub_f32 v62, v62, v230
    v_sub_f32 v30, v30, v230
    v_sub_f32 v95, v95, v230
    v_sub_f32 v63, v63, v230
    v_sub_f32 v31, v31, v230
    v_mul_f32 v156, v156, v232
    v_mul_f32 v157, v157, v232
    v_mul_f32 v158, v158, v232
    v_mul_f32 v159, v159, v232
    v_accvgpr_read_b32 v233, a96
    v_mul_f32_e64 v233, v233, v232
    v_accvgpr_write_b32 a96, v233
    v_accvgpr_read_b32 v234, a97
    v_mul_f32_e64 v234, v234, v232
    v_accvgpr_write_b32 a97, v234
    v_accvgpr_read_b32 v235, a98
    v_mul_f32_e64 v235, v235, v232
    v_accvgpr_write_b32 a98, v235
    v_accvgpr_read_b32 v236, a99
    v_mul_f32_e64 v236, v236, v232
    v_accvgpr_write_b32 a99, v236
    v_accvgpr_read_b32 v233, a100
    v_mul_f32_e64 v233, v233, v232
    v_accvgpr_write_b32 a100, v233
    v_accvgpr_read_b32 v234, a101
    v_mul_f32_e64 v234, v234, v232
    v_accvgpr_write_b32 a101, v234
    v_accvgpr_read_b32 v235, a102
    v_mul_f32_e64 v235, v235, v232
    v_accvgpr_write_b32 a102, v235
    v_accvgpr_read_b32 v236, a103
    v_mul_f32_e64 v236, v236, v232
    v_accvgpr_write_b32 a103, v236
    v_accvgpr_read_b32 v233, a104
    v_mul_f32_e64 v233, v233, v232
    v_accvgpr_write_b32 a104, v233
    v_accvgpr_read_b32 v234, a105
    v_mul_f32_e64 v234, v234, v232
    v_accvgpr_write_b32 a105, v234
    v_accvgpr_read_b32 v235, a106
    v_mul_f32_e64 v235, v235, v232
    v_accvgpr_write_b32 a106, v235
    v_accvgpr_read_b32 v236, a107
    v_mul_f32_e64 v236, v236, v232
    v_accvgpr_write_b32 a107, v236
    v_accvgpr_read_b32 v233, a108
    v_mul_f32_e64 v233, v233, v232
    v_accvgpr_write_b32 a108, v233
    v_accvgpr_read_b32 v234, a109
    v_mul_f32_e64 v234, v234, v232
    v_accvgpr_write_b32 a109, v234
    v_accvgpr_read_b32 v235, a110
    v_mul_f32_e64 v235, v235, v232
    v_accvgpr_write_b32 a110, v235
    v_accvgpr_read_b32 v236, a111
    v_mul_f32_e64 v236, v236, v232
    v_accvgpr_write_b32 a111, v236
    v_accvgpr_read_b32 v233, a112
    v_mul_f32_e64 v233, v233, v232
    v_accvgpr_write_b32 a112, v233
    v_accvgpr_read_b32 v234, a113
    v_mul_f32_e64 v234, v234, v232
    v_accvgpr_write_b32 a113, v234
    v_accvgpr_read_b32 v235, a114
    v_mul_f32_e64 v235, v235, v232
    v_accvgpr_write_b32 a114, v235
    v_accvgpr_read_b32 v236, a115
    v_mul_f32_e64 v236, v236, v232
    v_accvgpr_write_b32 a115, v236
    v_accvgpr_read_b32 v233, a116
    v_mul_f32_e64 v233, v233, v232
    v_accvgpr_write_b32 a116, v233
    v_accvgpr_read_b32 v234, a117
    v_mul_f32_e64 v234, v234, v232
    v_accvgpr_write_b32 a117, v234
    v_accvgpr_read_b32 v235, a118
    v_mul_f32_e64 v235, v235, v232
    v_accvgpr_write_b32 a118, v235
    v_accvgpr_read_b32 v236, a119
    v_mul_f32_e64 v236, v236, v232
    v_accvgpr_write_b32 a119, v236
    v_accvgpr_read_b32 v233, a120
    v_mul_f32_e64 v233, v233, v232
    v_accvgpr_write_b32 a120, v233
    v_accvgpr_read_b32 v234, a121
    v_mul_f32_e64 v234, v234, v232
    v_accvgpr_write_b32 a121, v234
    v_accvgpr_read_b32 v235, a122
    v_mul_f32_e64 v235, v235, v232
    v_accvgpr_write_b32 a122, v235
    v_accvgpr_read_b32 v236, a123
    v_mul_f32_e64 v236, v236, v232
    v_accvgpr_write_b32 a123, v236
    v_accvgpr_read_b32 v233, a124
    v_mul_f32_e64 v233, v233, v232
    v_accvgpr_write_b32 a124, v233
    v_accvgpr_read_b32 v234, a125
    v_mul_f32_e64 v234, v234, v232
    v_accvgpr_write_b32 a125, v234
    v_accvgpr_read_b32 v235, a126
    v_mul_f32_e64 v235, v235, v232
    v_accvgpr_write_b32 a126, v235
    v_accvgpr_read_b32 v236, a127
    v_mul_f32_e64 v236, v236, v232
    v_accvgpr_write_b32 a127, v236
    v_exp_f32 v128, v24
    v_exp_f32 v129, v25
    v_exp_f32 v130, v26
    v_exp_f32 v131, v27
    v_exp_f32 v132, v28
    v_exp_f32 v133, v29
    v_exp_f32 v134, v30
    v_exp_f32_e64 v135, v31
    s_nop 0
    v_cvt_pk_bf16_f32 v108, v128, v129
    v_cvt_pk_bf16_f32 v109, v130, v131
    v_cvt_pk_bf16_f32 v110, v132, v133
    v_cvt_pk_bf16_f32 v111, v134, v135
    s_nop 1
    s_branch kf_rr41
kf_rare46:
    s_nop 15
    v_max3_f32 v230, v48, v49, v50
    v_max3_f32 v230, v230, v51, v52
    v_max3_f32 v230, v230, v53, v54
    v_max_f32 v230, v230, v55
    v_mov_b32 v231, v230
    s_nop 1
    v_permlane16_swap_b32 v230, v231
    s_nop 0
    v_max_f32 v230, v230, v231
    v_mov_b32 v231, v230
    s_nop 1
    v_permlane32_swap_b32 v230, v231
    s_nop 0
    v_max_f32 v230, v230, v231
    v_add_f32 v230, 0x41800000, v230
    v_max_f32 v230, 0, v230
    v_sub_f32 v232, 0, v230
    v_exp_f32 v232, v232
    v_sub_f32 v226, v226, v230
    v_sub_f32 v80, v80, v230
    v_sub_f32 v16, v16, v230
    v_sub_f32 v48, v48, v230
    v_sub_f32 v81, v81, v230
    v_sub_f32 v17, v17, v230
    v_sub_f32 v49, v49, v230
    v_sub_f32 v82, v82, v230
    v_sub_f32 v18, v18, v230
    v_sub_f32 v50, v50, v230
    v_sub_f32 v83, v83, v230
    v_sub_f32 v19, v19, v230
    v_sub_f32 v51, v51, v230
    v_sub_f32 v84, v84, v230
    v_sub_f32 v20, v20, v230
    v_sub_f32 v52, v52, v230
    v_sub_f32 v85, v85, v230
    v_sub_f32 v21, v21, v230
    v_sub_f32 v53, v53, v230
    v_sub_f32 v86, v86, v230
    v_sub_f32 v22, v22, v230
    v_sub_f32 v54, v54, v230
    v_sub_f32 v87, v87, v230
    v_sub_f32 v23, v23, v230
    v_sub_f32 v55, v55, v230
    v_mul_f32 v152, v152, v232
    v_mul_f32 v153, v153, v232
    v_mul_f32 v154, v154, v232
    v_mul_f32 v155, v155, v232
    v_accvgpr_read_b32 v233, a64
    v_mul_f32_e64 v233, v233, v232
    v_accvgpr_write_b32 a64, v233
    v_accvgpr_read_b32 v234, a65
    v_mul_f32_e64 v234, v234, v232
    v_accvgpr_write_b32 a65, v234
    v_accvgpr_read_b32 v235, a66
    v_mul_f32_e64 v235, v235, v232
    v_accvgpr_write_b32 a66, v235
    v_accvgpr_read_b32 v236, a67
    v_mul_f32_e64 v236, v236, v232
    v_accvgpr_write_b32 a67, v236
    v_accvgpr_read_b32 v233, a68
    v_mul_f32_e64 v233, v233, v232
    v_accvgpr_write_b32 a68, v233
    v_accvgpr_read_b32 v234, a69
    v_mul_f32_e64 v234, v234, v232
    v_accvgpr_write_b32 a69, v234
    v_accvgpr_read_b32 v235, a70
    v_mul_f32_e64 v235, v235, v232
    v_accvgpr_write_b32 a70, v235
    v_accvgpr_read_b32 v236, a71
    v_mul_f32_e64 v236, v236, v232
    v_accvgpr_write_b32 a71, v236
    v_accvgpr_read_b32 v233, a72
    v_mul_f32_e64 v233, v233, v232
    v_accvgpr_write_b32 a72, v233
    v_accvgpr_read_b32 v234, a73
    v_mul_f32_e64 v234, v234, v232
    v_accvgpr_write_b32 a73, v234
    v_accvgpr_read_b32 v235, a74
    v_mul_f32_e64 v235, v235, v232
    v_accvgpr_write_b32 a74, v235
    v_accvgpr_read_b32 v236, a75
    v_mul_f32_e64 v236, v236, v232
    v_accvgpr_write_b32 a75, v236
    v_accvgpr_read_b32 v233, a76
    v_mul_f32_e64 v233, v233, v232
    v_accvgpr_write_b32 a76, v233
    v_accvgpr_read_b32 v234, a77
    v_mul_f32_e64 v234, v234, v232
    v_accvgpr_write_b32 a77, v234
    v_accvgpr_read_b32 v235, a78
    v_mul_f32_e64 v235, v235, v232
    v_accvgpr_write_b32 a78, v235
    v_accvgpr_read_b32 v236, a79
    v_mul_f32_e64 v236, v236, v232
    v_accvgpr_write_b32 a79, v236
    v_accvgpr_read_b32 v233, a80
    v_mul_f32_e64 v233, v233, v232
    v_accvgpr_write_b32 a80, v233
    v_accvgpr_read_b32 v234, a81
    v_mul_f32_e64 v234, v234, v232
    v_accvgpr_write_b32 a81, v234
    v_accvgpr_read_b32 v235, a82
    v_mul_f32_e64 v235, v235, v232
    v_accvgpr_write_b32 a82, v235
    v_accvgpr_read_b32 v236, a83
    v_mul_f32_e64 v236, v236, v232
    v_accvgpr_write_b32 a83, v236
    v_accvgpr_read_b32 v233, a84
    v_mul_f32_e64 v233, v233, v232
    v_accvgpr_write_b32 a84, v233
    v_accvgpr_read_b32 v234, a85
    v_mul_f32_e64 v234, v234, v232
    v_accvgpr_write_b32 a85, v234
    v_accvgpr_read_b32 v235, a86
    v_mul_f32_e64 v235, v235, v232
    v_accvgpr_write_b32 a86, v235
    v_accvgpr_read_b32 v236, a87
    v_mul_f32_e64 v236, v236, v232
    v_accvgpr_write_b32 a87, v236
    v_accvgpr_read_b32 v233, a88
    v_mul_f32_e64 v233, v233, v232
    v_accvgpr_write_b32 a88, v233
    v_accvgpr_read_b32 v234, a89
    v_mul_f32_e64 v234, v234, v232
    v_accvgpr_write_b32 a89, v234
    v_accvgpr_read_b32 v235, a90
    v_mul_f32_e64 v235, v235, v232
    v_accvgpr_write_b32 a90, v235
    v_accvgpr_read_b32 v236, a91
    v_mul_f32_e64 v236, v236, v232
    v_accvgpr_write_b32 a91, v236
    v_accvgpr_read_b32 v233, a92
    v_mul_f32_e64 v233, v233, v232
    v_accvgpr_write_b32 a92, v233
    v_accvgpr_read_b32 v234, a93
    v_mul_f32_e64 v234, v234, v232
    v_accvgpr_write_b32 a93, v234
    v_accvgpr_read_b32 v235, a94
    v_mul_f32_e64 v235, v235, v232
    v_accvgpr_write_b32 a94, v235
    v_accvgpr_read_b32 v236, a95
    v_mul_f32_e64 v236, v236, v232
    v_accvgpr_write_b32 a95, v236
    v_exp_f32 v128, v48
    v_exp_f32 v129, v49
    v_exp_f32 v130, v50
    v_exp_f32 v131, v51
    v_exp_f32 v132, v52
    v_exp_f32 v133, v53
    v_exp_f32 v134, v54
    v_exp_f32_e64 v135, v55
    s_nop 0
    v_cvt_pk_bf16_f32 v120, v128, v129
    v_cvt_pk_bf16_f32 v121, v130, v131
    v_cvt_pk_bf16_f32 v122, v132, v133
    v_cvt_pk_bf16_f32 v123, v134, v135
    v_max3_f32 v230, v56, v57, v58
    v_max3_f32 v230, v230, v59, v60
    v_max3_f32 v230, v230, v61, v62
    v_max_f32 v230, v230, v63
    v_mov_b32 v231, v230
    s_nop 1
    v_permlane16_swap_b32 v230, v231
    s_nop 0
    v_max_f32 v230, v230, v231
    v_mov_b32 v231, v230
    s_nop 1
    v_permlane32_swap_b32 v230, v231
    s_nop 0
    v_max_f32_e64 v230, v230, v231
    v_add_f32 v230, 0x41800000, v230
    v_max_f32 v230, 0, v230
    v_sub_f32 v232, 0, v230
    v_exp_f32 v232, v232
    v_sub_f32 v227, v227, v230
    v_sub_f32 v88, v88, v230
    v_sub_f32 v24, v24, v230
    v_sub_f32 v56, v56, v230
    v_sub_f32 v89, v89, v230
    v_sub_f32 v25, v25, v230
    v_sub_f32 v57, v57, v230
    v_sub_f32 v90, v90, v230
    v_sub_f32 v26, v26, v230
    v_sub_f32 v58, v58, v230
    v_sub_f32 v91, v91, v230
    v_sub_f32 v27, v27, v230
    v_sub_f32 v59, v59, v230
    v_sub_f32 v92, v92, v230
    v_sub_f32 v28, v28, v230
    v_sub_f32 v60, v60, v230
    v_sub_f32 v93, v93, v230
    v_sub_f32 v29, v29, v230
    v_sub_f32 v61, v61, v230
    v_sub_f32 v94, v94, v230
    v_sub_f32 v30, v30, v230
    v_sub_f32 v62, v62, v230
    v_sub_f32 v95, v95, v230
    v_sub_f32 v31, v31, v230
    v_sub_f32 v63, v63, v230
    v_mul_f32 v156, v156, v232
    v_mul_f32 v157, v157, v232
    v_mul_f32 v158, v158, v232
    v_mul_f32 v159, v159, v232
    v_accvgpr_read_b32 v233, a96
    v_mul_f32_e64 v233, v233, v232
    v_accvgpr_write_b32 a96, v233
    v_accvgpr_read_b32 v234, a97
    v_mul_f32_e64 v234, v234, v232
    v_accvgpr_write_b32 a97, v234
    v_accvgpr_read_b32 v235, a98
    v_mul_f32_e64 v235, v235, v232
    v_accvgpr_write_b32 a98, v235
    v_accvgpr_read_b32 v236, a99
    v_mul_f32_e64 v236, v236, v232
    v_accvgpr_write_b32 a99, v236
    v_accvgpr_read_b32 v233, a100
    v_mul_f32_e64 v233, v233, v232
    v_accvgpr_write_b32 a100, v233
    v_accvgpr_read_b32 v234, a101
    v_mul_f32_e64 v234, v234, v232
    v_accvgpr_write_b32 a101, v234
    v_accvgpr_read_b32 v235, a102
    v_mul_f32_e64 v235, v235, v232
    v_accvgpr_write_b32 a102, v235
    v_accvgpr_read_b32 v236, a103
    v_mul_f32_e64 v236, v236, v232
    v_accvgpr_write_b32 a103, v236
    v_accvgpr_read_b32 v233, a104
    v_mul_f32_e64 v233, v233, v232
    v_accvgpr_write_b32 a104, v233
    v_accvgpr_read_b32 v234, a105
    v_mul_f32_e64 v234, v234, v232
    v_accvgpr_write_b32 a105, v234
    v_accvgpr_read_b32 v235, a106
    v_mul_f32_e64 v235, v235, v232
    v_accvgpr_write_b32 a106, v235
    v_accvgpr_read_b32 v236, a107
    v_mul_f32_e64 v236, v236, v232
    v_accvgpr_write_b32 a107, v236
    v_accvgpr_read_b32 v233, a108
    v_mul_f32_e64 v233, v233, v232
    v_accvgpr_write_b32 a108, v233
    v_accvgpr_read_b32 v234, a109
    v_mul_f32_e64 v234, v234, v232
    v_accvgpr_write_b32 a109, v234
    v_accvgpr_read_b32 v235, a110
    v_mul_f32_e64 v235, v235, v232
    v_accvgpr_write_b32 a110, v235
    v_accvgpr_read_b32 v236, a111
    v_mul_f32_e64 v236, v236, v232
    v_accvgpr_write_b32 a111, v236
    v_accvgpr_read_b32 v233, a112
    v_mul_f32_e64 v233, v233, v232
    v_accvgpr_write_b32 a112, v233
    v_accvgpr_read_b32 v234, a113
    v_mul_f32_e64 v234, v234, v232
    v_accvgpr_write_b32 a113, v234
    v_accvgpr_read_b32 v235, a114
    v_mul_f32_e64 v235, v235, v232
    v_accvgpr_write_b32 a114, v235
    v_accvgpr_read_b32 v236, a115
    v_mul_f32_e64 v236, v236, v232
    v_accvgpr_write_b32 a115, v236
    v_accvgpr_read_b32 v233, a116
    v_mul_f32_e64 v233, v233, v232
    v_accvgpr_write_b32 a116, v233
    v_accvgpr_read_b32 v234, a117
    v_mul_f32_e64 v234, v234, v232
    v_accvgpr_write_b32 a117, v234
    v_accvgpr_read_b32 v235, a118
    v_mul_f32_e64 v235, v235, v232
    v_accvgpr_write_b32 a118, v235
    v_accvgpr_read_b32 v236, a119
    v_mul_f32_e64 v236, v236, v232
    v_accvgpr_write_b32 a119, v236
    v_accvgpr_read_b32 v233, a120
    v_mul_f32_e64 v233, v233, v232
    v_accvgpr_write_b32 a120, v233
    v_accvgpr_read_b32 v234, a121
    v_mul_f32_e64 v234, v234, v232
    v_accvgpr_write_b32 a121, v234
    v_accvgpr_read_b32 v235, a122
    v_mul_f32_e64 v235, v235, v232
    v_accvgpr_write_b32 a122, v235
    v_accvgpr_read_b32 v236, a123
    v_mul_f32_e64 v236, v236, v232
    v_accvgpr_write_b32 a123, v236
    v_accvgpr_read_b32 v233, a124
    v_mul_f32_e64 v233, v233, v232
    v_accvgpr_write_b32 a124, v233
    v_accvgpr_read_b32 v234, a125
    v_mul_f32_e64 v234, v234, v232
    v_accvgpr_write_b32 a125, v234
    v_accvgpr_read_b32 v235, a126
    v_mul_f32_e64 v235, v235, v232
    v_accvgpr_write_b32 a126, v235
    v_accvgpr_read_b32 v236, a127
    v_mul_f32_e64 v236, v236, v232
    v_accvgpr_write_b32 a127, v236
    v_exp_f32 v128, v56
    v_exp_f32 v129, v57
    v_exp_f32 v130, v58
    v_exp_f32 v131, v59
    v_exp_f32 v132, v60
    v_exp_f32 v133, v61
    v_exp_f32 v134, v62
    v_exp_f32_e64 v135, v63
    s_nop 0
    v_cvt_pk_bf16_f32 v124, v128, v129
    v_cvt_pk_bf16_f32 v125, v130, v131
    v_cvt_pk_bf16_f32 v126, v132, v133
    v_cvt_pk_bf16_f32 v127, v134, v135
    s_nop 1
    s_branch kf_rr45
kf_spin47:
    s_mov_b32 s25, 0x100000
kf_spin47_l:
    s_sleep 2
    buffer_load_dword v254, off, s[88:91], s97 sc1
    s_waitcnt vmcnt(0)
    v_readfirstlane_b32 s24, v254
    s_sub_u32 s25, s25, 1
    s_cbranch_scc1 kf_spinr48
    s_cmp_ge_u32 s24, 1
    s_cbranch_scc0 kf_spin47_l
    s_branch kf_spinr48
kf_spin49:
    s_mov_b32 s25, 0x100000
kf_spin49_l:
    s_sleep 2
    buffer_load_dword v254, off, s[88:91], s39 sc1
    s_waitcnt vmcnt(0)
    v_readfirstlane_b32 s24, v254
    s_sub_u32 s25, s25, 1
    s_cbranch_scc1 kf_spinr50
    s_cmp_ge_u32 s24, 32
    s_cbranch_scc0 kf_spin49_l
    s_branch kf_spinr50
kf_spin51:
    s_mov_b32 s25, 0x100000
kf_spin51_l:
    s_sleep 2
    buffer_load_dword v254, off, s[88:91], s97 sc1
    s_waitcnt vmcnt(0)
    v_readfirstlane_b32 s24, v254
    s_sub_u32 s25, s25, 1
    s_cbranch_scc1 kf_spinr52
    s_cmp_ge_u32 s24, 1
    s_cbranch_scc0 kf_spin51_l
    s_branch kf_spinr52
kf_spin53:
    s_mov_b32 s25, 0x100000
kf_spin53_l:
    s_sleep 2
    buffer_load_dword v254, off, s[88:91], s39 sc1
    s_waitcnt vmcnt(0)
    v_readfirstlane_b32 s24, v254
    s_sub_u32 s25, s25, 1
    s_cbranch_scc1 kf_spinr54
    s_cmp_ge_u32 s24, 32
    s_cbranch_scc0 kf_spin53_l
    s_branch kf_spinr54
kf_spin55:
    s_mov_b32 s25, 0x100000
kf_spin55_l:
    s_sleep 2
    buffer_load_dword v254, off, s[88:91], s35 sc1
    s_waitcnt vmcnt(0)
    v_readfirstlane_b32 s24, v254
    s_sub_u32 s25, s25, 1
    s_cbranch_scc1 kf_spinr56
    s_cmp_ge_u32 s24, 8
    s_cbranch_scc0 kf_spin55_l
    s_branch kf_spinr56

code_end:
.section .rodata,"a"
.p2align 6
.amdhsa_kernel sequential_preLN__compressed_kv_cla__moe_arch_mod__prompt_kernel
  .amdhsa_next_free_vgpr 512
  .amdhsa_next_free_sgpr 102
  .amdhsa_accum_offset 256
  .amdhsa_group_segment_fixed_size 0
  .amdhsa_kernarg_size 112
  .amdhsa_user_sgpr_count 2
  .amdhsa_user_sgpr_kernarg_segment_ptr 1
  .amdhsa_system_sgpr_workgroup_id_x 1
  .amdhsa_float_denorm_mode_32 3
.end_amdhsa_kernel
```

```asm
; @launch grid=(256,1,1) block=(256,1,1) lds=163840
.amdgcn_target "amdgcn-amd-amdhsa--gfx950"
.text
.globl sequential_preLN__compressed_kv_cla__moe_arch_mod__prompt_kernel
.p2align 8
.type sequential_preLN__compressed_kv_cla__moe_arch_mod__prompt_kernel,@function
sequential_preLN__compressed_kv_cla__moe_arch_mod__prompt_kernel:
    s_cmp_ge_u32 s2, 256
    s_cbranch_scc1 ka_done
    s_load_dwordx8 s[64:71], s[0:1], 0
    s_load_dwordx4 s[72:75], s[0:1], 32
    s_load_dwordx4 s[76:79], s[0:1], 64
    s_load_dwordx8 s[8:15], s[0:1], 80
    v_lshrrev_b32 v1, 6, v0
    v_and_b32 v2, 63, v0
    v_readfirstlane_b32 s3, v1
    v_mov_b32_e64 v253, v0
    s_and_b32 s4, s2, 7
    s_lshl_b32 s4, s4, 2
    s_lshr_b32 s24, s2, 3
    s_and_b32 s24, s24, 3
    s_add_u32 s4, s4, s24
    s_lshr_b32 s5, s2, 5
    s_lshl2_add_u32 s6, s5, s3
    s_getpc_b64 s[56:57]
ka_pc:
    s_mov_b32 s58, hot_end-ka_pc
    s_mov_b32 s59, 0x00020000
    s_lshr_b32 s24, s2, 3
    s_xor_b32 s24, s24, 31
    s_lshl2_add_u32 s24, s24, s3
    s_lshl_b32 s24, s24, 13
    v_lshlrev_b32_e64 v3, 7, v2
    buffer_load_dword v252, v3, s[56:59], s24 offen
    v_mov_b32 v192, v2
    v_lshrrev_b32 v198, 3, v192
    v_and_b32 v199, 7, v192
    s_lshr_b32 s24, s3, 1
    s_lshl_b32 s24, s24, 5
    s_and_b32 s25, s3, 1
    s_lshl_b32 s26, s25, 3
    s_add_u32 s24, s24, s26
    v_add_u32 v194, s24, v198
    v_lshlrev_b32 v194, 10, v194
    v_lshrrev_b32 v195, 1, v198
    v_xor_b32 v195, v199, v195
    v_lshl_add_u32 v232, v195, 4, v194
    v_xor_b32_e64 v195, 4, v195
    v_lshl_add_u32 v233, v195, 4, v194
    v_add_u32 v233, 15360, v233
    s_lshl_b32 s24, s4, 8
    s_lshl_b32 s26, s25, 7
    s_add_u32 s24, s24, s26
    v_lshlrev_b32 v194, 13, v198
    v_add_u32_e64 v194, s24, v194
    v_bfe_u32 v195, v198, 1, 1
    v_xor_b32_e64 v195, v199, v195
    v_lshl_add_u32 v234, v195, 4, v194
    v_xor_b32_e64 v195, 4, v195
    v_lshl_add_u32 v235, v195, 4, v194
    v_add_u32 v235, 64512, v235
    s_lshl_b32 s34, s3, 11
    s_mul_i32 s35, s3, 24576
    s_add_u32 s35, s35, 65536
    s_lshl_b32 s32, s5, 18
    s_and_b32 s7, s4, 3
    s_lshl1_add_u32 s7, s7, s5
    s_add_u32 s80, s7, 0
    s_and_b32 s80, s80, 7
    s_lshl_b32 s80, s80, 7
    s_add_u32 s80, s80, s32
    s_waitcnt lgkmcnt(0)
    s_cmp_lt_u32 s3, 2
    s_cselect_b32 s48, s70, s72
    s_cselect_b32 s49, s71, s73
    s_mov_b32 s50, 0x400000
    s_mov_b32 s51, 0x00020000
    s_mov_b32 s44, s66
    s_mov_b32 s45, s67
    s_mov_b32 s46, 0x200000
    s_mov_b32 s47, 0x00020000
    s_add_u32 m0, s35, 0
    s_and_b32 s33, s80, 1023
    s_lshl_b32 s33, s33, 12
    buffer_load_dwordx4 v234, s[48:51], s33 offen lds
    buffer_load_dwordx4 v235, s[48:51], s33 offen offset:1024 lds
    s_add_u32 m0, s35, 2048
    s_add_u32 s33, s33, 131072
    buffer_load_dwordx4 v234, s[48:51], s33 offen lds
    buffer_load_dwordx4 v235, s[48:51], s33 offen offset:1024 lds
    s_add_u32 m0, s34, 0
    s_add_u32 s37, s80, 0
    buffer_load_dwordx4 v232, s[44:47], s37 offen lds
    buffer_load_dwordx4 v233, s[44:47], s37 offen offset:1024 lds
    s_add_u32 m0, s34, 8192
    s_add_u32 s37, s80, 65536
    buffer_load_dwordx4 v232, s[44:47], s37 offen lds
    buffer_load_dwordx4 v233, s[44:47], s37 offen offset:1024 lds
    s_add_u32 m0, s35, 4096
    s_add_u32 s33, s33, 131072
    buffer_load_dwordx4 v234, s[48:51], s33 offen lds
    buffer_load_dwordx4 v235, s[48:51], s33 offen offset:1024 lds
    s_add_u32 m0, s35, 6144
    s_add_u32 s33, s33, 131072
    buffer_load_dwordx4 v234, s[48:51], s33 offen lds
    buffer_load_dwordx4 v235, s[48:51], s33 offen offset:1024 lds
    s_mov_b32 s52, s64
    s_mov_b32 s53, s65
    s_mov_b32 s54, 0x400000
    s_mov_b32 s55, 0x00020000
    s_add_u32 s16, s14, 0x5c00000
    s_addc_u32 s17, s15, 0
    s_mov_b32 s18, 0x2140000
    s_mov_b32 s19, 0x00020000
    s_add_u32 s56, s14, 0x3800000
    s_addc_u32 s57, s15, 0
    s_mov_b32 s58, 0x6040
    s_mov_b32 s59, 0x00020000
    s_add_u32 s20, s14, 0x2400000
    s_addc_u32 s21, s15, 0
    s_mov_b32 s22, 0x1000000
    s_mov_b32 s23, 0x00020000
    s_mov_b32 s88, s12
    s_mov_b32 s89, s13
    s_mov_b32 s90, 0x100
    s_mov_b32 s91, 0x00020000
    s_cmp_lt_u32 s3, 2
    s_cselect_b32 s60, s8, s74
    s_cselect_b32 s61, s9, s75
    s_mov_b32 s62, 0x800000
    s_cselect_b32 s62, 0x700000, s62
    s_mov_b32 s63, 0x00020000
    s_cselect_b32 s41, s76, s78
    s_cselect_b32 s42, s77, s79
    s_mov_b32 s8, s14
    s_mov_b32 s9, s15
    s_mov_b32 s10, 0x400000
    s_mov_b32 s11, 0x00020000
    s_mov_b32 s12, s68
    s_mov_b32 s13, s69
    s_mov_b32 s14, 0x800000
    s_mov_b32 s15, 0x00020000
    s_add_u32 s81, s7, 1
    s_and_b32 s81, s81, 7
    s_lshl_b32 s81, s81, 7
    s_add_u32 s81, s81, s32
    s_add_u32 s82, s7, 2
    s_and_b32 s82, s82, 7
    s_lshl_b32 s82, s82, 7
    s_add_u32 s82, s82, s32
    s_add_u32 s83, s7, 3
    s_and_b32 s83, s83, 7
    s_lshl_b32 s83, s83, 7
    s_add_u32 s83, s83, s32
    s_add_u32 s84, s7, 4
    s_and_b32 s84, s84, 7
    s_lshl_b32 s84, s84, 7
    s_add_u32 s84, s84, s32
    s_add_u32 s85, s7, 5
    s_and_b32 s85, s85, 7
    s_lshl_b32 s85, s85, 7
    s_add_u32 s85, s85, s32
    s_add_u32 s86, s7, 6
    s_and_b32 s86, s86, 7
    s_lshl_b32 s86, s86, 7
    s_add_u32 s86, s86, s32
    s_add_u32 s87, s7, 7
    s_and_b32 s87, s87, 7
    s_lshl_b32 s87, s87, 7
    s_add_u32 s87, s87, s32
    s_cmp_eq_u32 s2, 200
    s_mov_b32 s97, 0x40000000
    s_cselect_b32 s97, 0xa0000, s97
    s_mov_b32 s58, 0xa5000
    v_lshlrev_b32 v194, 7, v253
    v_mov_b32_e64 v195, 0
    buffer_store_dword v195, v194, s[56:59], s97 offen sc1
    s_cselect_b32 s97, 0, 0x40000000
    s_mov_b32 s58, 0x6040
    v_and_b32 v200, 15, v192
    v_lshrrev_b32 v201, 4, v192
    v_lshrrev_b32 v194, 1, v200
    v_xor_b32 v194, v201, v194
    v_lshlrev_b32 v194, 4, v194
    v_lshl_add_u32 v224, v200, 7, v194
    v_xor_b32 v225, 64, v224
    v_lshrrev_b32 v194, 2, v200
    v_lshl_add_u32 v195, v201, 3, v194
    v_lshlrev_b32 v195, 7, v195
    v_add_u32 v195, s35, v195
    v_and_b32_e64 v196, 1, v200
    v_lshl_add_u32 v195, v196, 3, v195
    v_lshrrev_b32 v194, 1, v194
    v_and_b32 v196, 1, v201
    v_lshl_or_b32 v194, v196, 2, v194
    v_and_b32 v196, 2, v200
    v_xor_b32 v194, v194, v196
    v_xor_b32_e64 v196, 0, v194
    v_lshl_add_u32 v228, v196, 4, v195
    v_xor_b32_e64 v196, 1, v194
    v_lshl_add_u32 v229, v196, 4, v195
    v_xor_b32_e64 v196, 4, v194
    v_lshl_add_u32 v230, v196, 4, v195
    v_xor_b32_e64 v196, 5, v194
    v_lshl_add_u32 v231, v196, 4, v195
    s_mul_i32 s36, s4, 1089536
    s_mul_i32 s24, s5, 136192
    s_add_u32 s36, s36, s24
    s_and_b32 s24, s3, 1
    s_lshl_b32 s24, s24, 12
    s_and_b32 s26, s3, 2
    s_lshl_b32 s26, s26, 13
    s_add_u32 s36, s36, s24
    s_add_u32 s36, s36, s26
    s_lshl_b32 s24, s5, 7
    s_sub_u32 s26, 1792, s24
    s_cmp_lt_u32 s4, 16
    s_cselect_b32 s24, s24, s26
    s_lshl_b32 s26, s4, 3
    s_add_u32 s24, s24, s26
    v_lshrrev_b32 v194, 5, v253
    v_add_u32 v196, s24, v194
    v_and_b32 v195, 31, v192
    v_lshlrev_b32 v196, 11, v196
    v_lshl_add_u32 v236, v195, 4, v196
    v_xor_b32 v194, v194, v199
    v_lshlrev_b32 v194, 4, v194
    v_lshl_add_u32 v194, v195, 7, v194
    v_add_u32 v237, 81920, v194
    s_lshr_b32 s26, s24, 4
    s_lshl_b32 s26, s26, 15
    s_and_b32 s24, s24, 15
    s_lshl_b32 s24, s24, 4
    s_add_u32 s24, s24, s26
    v_lshrrev_b32 v194, 3, v253
    v_lshlrev_b32 v194, 8, v194
    v_xor_b32 v195, v199, v198
    v_lshl_add_u32 v194, v195, 4, v194
    v_add_u32 v238, s24, v194
    v_lshlrev_b32 v240, 4, v192
    s_lshl_b32 s24, s3, 12
    v_add_u32 v242, s24, v240
    s_lshl_b32 s24, s6, 16
    v_add_u32 v248, s24, v240
    s_sub_u32 s25, 63, s6
    s_lshl_b32 s24, s25, 16
    v_add_u32_e64 v249, s24, v240
    v_bfe_u32 v194, v192, 2, 2
    v_lshlrev_b32_e64 v194, 13, v194
    v_lshl_add_u32 v194, v201, 6, v194
    v_and_b32_e64 v195, 3, v192
    v_lshl_add_u32 v194, v195, 4, v194
    s_lshl_b32 s24, s4, 8
    s_lshl_b32 s25, s3, 18
    s_add_u32 s24, s24, s25
    v_add_u32_e64 v245, s24, v194
    s_lshl_b32 s31, s3, 13
    s_add_u32 s31, s31, 65536
    s_lshl_b32 s27, s5, 20
    s_mov_b32 s7, s27
    s_mov_b32 s43, 0x40000000
    s_lshr_b32 s28, s27, 8
    s_add_u32 s29, s28, 32768
    s_nop 0
    v_lshlrev_b32 v194, 11, v201
    v_bfe_u32 v195, v192, 2, 2
    v_lshl_add_u32 v194, v195, 6, v194
    v_bfe_u32 v195, v192, 4, 1
    v_lshl_add_u32 v194, v195, 4, v194
    v_and_b32_e64 v195, 1, v192
    v_lshl_add_u32 v194, v195, 3, v194
    v_bfe_u32 v195, v192, 1, 1
    v_lshl_add_u32 v247, v195, 5, v194
    s_mov_b32 s30, 65536
    v_add_u32 v246, s30, v247
    v_lshrrev_b32 v195, 5, v192
    v_lshlrev_b32 v195, 4, v195
    v_sub_u32 v194, v200, v195
    v_bfe_u32 v195, v192, 4, 1
    v_lshlrev_b32 v195, 2, v195
    v_sub_u32 v194, v194, v195
    v_cvt_f32_i32 v194, v194
    v_add_f32 v194, 0.5, v194
    v_mul_f32 v243, 0x71800000, v194
    v_add_u32 v244, 0x20000, v240
    v_lshlrev_b32 v251, 7, v192
    v_cmp_gt_u32 vcc, 16, v192
    v_mov_b32 v194, 0x40000000
    v_mov_b32 v255, 1
    v_cndmask_b32 v251, v194, v251, vcc
    v_cmp_eq_u32 vcc, 0, v253
    s_nop 1
    v_cndmask_b32 v250, v194, v253, vcc
    s_add_u32 m0, s35, 8192
    s_and_b32 s33, s81, 1023
    s_lshl_b32 s33, s33, 12
    buffer_load_dwordx4 v234, s[48:51], s33 offen lds
    buffer_load_dwordx4 v235, s[48:51], s33 offen offset:1024 lds
    s_add_u32 m0, s35, 10240
    s_add_u32 s33, s33, 131072
    buffer_load_dwordx4 v234, s[48:51], s33 offen lds
    buffer_load_dwordx4 v235, s[48:51], s33 offen offset:1024 lds
    s_add_u32 m0, s35, 12288
    s_add_u32 s33, s33, 131072
    buffer_load_dwordx4 v234, s[48:51], s33 offen lds
    buffer_load_dwordx4 v235, s[48:51], s33 offen offset:1024 lds
    s_add_u32 m0, s35, 14336
    s_add_u32 s33, s33, 131072
    buffer_load_dwordx4 v234, s[48:51], s33 offen lds
    buffer_load_dwordx4 v235, s[48:51], s33 offen offset:1024 lds
    s_add_u32 m0, s34, 16384
    s_add_u32 s37, s81, 0
    buffer_load_dwordx4 v232, s[44:47], s37 offen lds
    buffer_load_dwordx4 v233, s[44:47], s37 offen offset:1024 lds
    s_add_u32 m0, s34, 24576
    s_add_u32 s37, s81, 65536
    buffer_load_dwordx4 v232, s[44:47], s37 offen lds
    buffer_load_dwordx4 v233, s[44:47], s37 offen offset:1024 lds
    s_waitcnt vmcnt(19)
    s_barrier
    ds_read_b128 v[64:67], v224 offset:0
    ds_read_b128 v[68:71], v224 offset:2048
    ds_read_b128 v[72:75], v224 offset:4096
    ds_read_b128 v[76:79], v224 offset:6144
    ds_read_b64_tr_b16 a[0:1], v228 offset:0
    ds_read_b64_tr_b16 a[2:3], v228 offset:512
    ds_read_b64_tr_b16 a[4:5], v229 offset:0
    ds_read_b64_tr_b16 a[6:7], v229 offset:512
    ds_read_b64_tr_b16 a[8:9], v230 offset:0
    ds_read_b64_tr_b16 a[10:11], v230 offset:512
    ds_read_b64_tr_b16 a[12:13], v231 offset:0
    ds_read_b64_tr_b16 a[14:15], v231 offset:512
    s_waitcnt vmcnt(12)
    s_barrier
    buffer_store_dword v255, v250, s[88:91], s97 offen sc1
    s_cmp_eq_u32 s3, 0
    s_cselect_b32 s97, 0, s43
    s_cmp_lt_u32 s3, 2
    s_cbranch_scc0 ka_V
    s_waitcnt lgkmcnt(0)
    v_mfma_f32_16x16x32_bf16 v[96:99], a[0:3], v[64:67], 0
    ds_read_b128 v[80:83], v224 offset:8192
    v_mfma_f32_16x16x32_bf16 v[100:103], a[4:7], v[64:67], 0
    ds_read_b128 v[84:87], v224 offset:10240
    v_mfma_f32_16x16x32_bf16 v[104:107], a[8:11], v[64:67], 0
    ds_read_b128 v[88:91], v224 offset:12288
    v_mfma_f32_16x16x32_bf16 v[108:111], a[12:15], v[64:67], 0
    ds_read_b128 v[92:95], v224 offset:14336
    v_mfma_f32_16x16x32_bf16 v[112:115], a[0:3], v[68:71], 0
    ds_read_b64_tr_b16 a[16:17], v228 offset:4096
    v_mfma_f32_16x16x32_bf16 v[116:119], a[4:7], v[68:71], 0
    ds_read_b64_tr_b16 a[18:19], v228 offset:4608
    v_mfma_f32_16x16x32_bf16 v[120:123], a[8:11], v[68:71], 0
    ds_read_b64_tr_b16 a[20:21], v229 offset:4096
    v_mfma_f32_16x16x32_bf16 v[124:127], a[12:15], v[68:71], 0
    ds_read_b64_tr_b16 a[22:23], v229 offset:4608
    v_mfma_f32_16x16x32_bf16 v[128:131], a[0:3], v[72:75], 0
    s_add_u32 m0, s35, 16384
    s_and_b32 s33, s82, 1023
    s_lshl_b32 s33, s33, 12
    buffer_load_dwordx4 v234, s[48:51], s33 offen lds
    v_mfma_f32_16x16x32_bf16 v[132:135], a[4:7], v[72:75], 0
    v_mfma_f32_16x16x32_bf16 v[136:139], a[8:11], v[72:75], 0
    buffer_load_dwordx4 v235, s[48:51], s33 offen offset:1024 lds
    v_mfma_f32_16x16x32_bf16 v[140:143], a[12:15], v[72:75], 0
    v_mfma_f32_16x16x32_bf16 v[144:147], a[0:3], v[76:79], 0
    s_add_u32 m0, s35, 18432
    s_add_u32 s33, s33, 131072
    buffer_load_dwordx4 v234, s[48:51], s33 offen lds
    v_mfma_f32_16x16x32_bf16 v[148:151], a[4:7], v[76:79], 0
    v_mfma_f32_16x16x32_bf16 v[152:155], a[8:11], v[76:79], 0
    buffer_load_dwordx4 v235, s[48:51], s33 offen offset:1024 lds
    v_mfma_f32_16x16x32_bf16 v[156:159], a[12:15], v[76:79], 0
    s_waitcnt lgkmcnt(0)
    v_mfma_f32_16x16x32_bf16 v[160:163], a[0:3], v[80:83], 0
    ds_read_b128 v[64:67], v225 offset:0
    v_mfma_f32_16x16x32_bf16 v[164:167], a[4:7], v[80:83], 0
    ds_read_b128 v[68:71], v225 offset:2048
    v_mfma_f32_16x16x32_bf16 v[168:171], a[8:11], v[80:83], 0
    ds_read_b128 v[72:75], v225 offset:4096
    v_mfma_f32_16x16x32_bf16 v[172:175], a[12:15], v[80:83], 0
    ds_read_b128 v[76:79], v225 offset:6144
    v_mfma_f32_16x16x32_bf16 v[176:179], a[0:3], v[84:87], 0
    ds_read_b64_tr_b16 a[24:25], v230 offset:4096
    v_mfma_f32_16x16x32_bf16 v[180:183], a[4:7], v[84:87], 0
    ds_read_b64_tr_b16 a[26:27], v230 offset:4608
    v_mfma_f32_16x16x32_bf16 v[184:187], a[8:11], v[84:87], 0
    ds_read_b64_tr_b16 a[28:29], v231 offset:4096
    v_mfma_f32_16x16x32_bf16 v[188:191], a[12:15], v[84:87], 0
    ds_read_b64_tr_b16 a[30:31], v231 offset:4608
    v_mfma_f32_16x16x32_bf16 v[192:195], a[0:3], v[88:91], 0
    s_add_u32 m0, s35, 20480
    s_add_u32 s33, s33, 131072
    buffer_load_dwordx4 v234, s[48:51], s33 offen lds
    v_mfma_f32_16x16x32_bf16 v[196:199], a[4:7], v[88:91], 0
    v_mfma_f32_16x16x32_bf16 v[200:203], a[8:11], v[88:91], 0
    buffer_load_dwordx4 v235, s[48:51], s33 offen offset:1024 lds
    v_mfma_f32_16x16x32_bf16 v[204:207], a[12:15], v[88:91], 0
    v_mfma_f32_16x16x32_bf16 v[208:211], a[0:3], v[92:95], 0
    s_add_u32 m0, s35, 22528
    s_add_u32 s33, s33, 131072
    buffer_load_dwordx4 v234, s[48:51], s33 offen lds
    v_mfma_f32_16x16x32_bf16 v[212:215], a[4:7], v[92:95], 0
    v_mfma_f32_16x16x32_bf16 v[216:219], a[8:11], v[92:95], 0
    buffer_load_dwordx4 v235, s[48:51], s33 offen offset:1024 lds
    v_mfma_f32_16x16x32_bf16 v[220:223], a[12:15], v[92:95], 0
    s_waitcnt vmcnt(13) lgkmcnt(0)
    v_mfma_f32_16x16x32_bf16 v[96:99], a[16:19], v[64:67], v[96:99]
    ds_read_b128 v[80:83], v225 offset:8192
    v_mfma_f32_16x16x32_bf16 v[100:103], a[20:23], v[64:67], v[100:103]
    ds_read_b128 v[84:87], v225 offset:10240
    v_mfma_f32_16x16x32_bf16 v[104:107], a[24:27], v[64:67], v[104:107]
    ds_read_b128 v[88:91], v225 offset:12288
    v_mfma_f32_16x16x32_bf16 v[108:111], a[28:31], v[64:67], v[108:111]
    ds_read_b128 v[92:95], v225 offset:14336
    v_mfma_f32_16x16x32_bf16 v[112:115], a[16:19], v[68:71], v[112:115]
    ds_read_b64_tr_b16 a[32:33], v228 offset:8192
    v_mfma_f32_16x16x32_bf16 v[116:119], a[20:23], v[68:71], v[116:119]
    ds_read_b64_tr_b16 a[34:35], v228 offset:8704
    v_mfma_f32_16x16x32_bf16 v[120:123], a[24:27], v[68:71], v[120:123]
    ds_read_b64_tr_b16 a[36:37], v229 offset:8192
    v_mfma_f32_16x16x32_bf16 v[124:127], a[28:31], v[68:71], v[124:127]
    ds_read_b64_tr_b16 a[38:39], v229 offset:8704
    v_mfma_f32_16x16x32_bf16 v[128:131], a[16:19], v[72:75], v[128:131]
    ds_read_b64_tr_b16 a[40:41], v230 offset:8192
    s_add_u32 m0, s34, 32768
    s_add_u32 s37, s82, 0
    buffer_load_dwordx4 v232, s[44:47], s37 offen lds
    v_mfma_f32_16x16x32_bf16 v[132:135], a[20:23], v[72:75], v[132:135]
    ds_read_b64_tr_b16 a[42:43], v230 offset:8704
    buffer_load_dwordx4 v233, s[44:47], s37 offen offset:1024 lds
    v_mfma_f32_16x16x32_bf16 v[136:139], a[24:27], v[72:75], v[136:139]
    ds_read_b64_tr_b16 a[44:45], v231 offset:8192
    s_add_u32 m0, s34, 40960
    s_add_u32 s37, s82, 65536
    buffer_load_dwordx4 v232, s[44:47], s37 offen lds
    v_mfma_f32_16x16x32_bf16 v[140:143], a[28:31], v[72:75], v[140:143]
    ds_read_b64_tr_b16 a[46:47], v231 offset:8704
    buffer_load_dwordx4 v233, s[44:47], s37 offen offset:1024 lds
    v_mfma_f32_16x16x32_bf16 v[144:147], a[16:19], v[76:79], v[144:147]
    s_add_u32 m0, s35, 0
    s_and_b32 s33, s83, 1023
    s_lshl_b32 s33, s33, 12
    buffer_load_dwordx4 v234, s[48:51], s33 offen lds
    v_mfma_f32_16x16x32_bf16 v[148:151], a[20:23], v[76:79], v[148:151]
    buffer_load_dwordx4 v235, s[48:51], s33 offen offset:1024 lds
    v_mfma_f32_16x16x32_bf16 v[152:155], a[24:27], v[76:79], v[152:155]
    s_add_u32 m0, s35, 2048
    s_add_u32 s33, s33, 131072
    buffer_load_dwordx4 v234, s[48:51], s33 offen lds
    v_mfma_f32_16x16x32_bf16 v[156:159], a[28:31], v[76:79], v[156:159]
    buffer_load_dwordx4 v235, s[48:51], s33 offen offset:1024 lds
    s_waitcnt vmcnt(17) lgkmcnt(0)
    s_barrier
    v_mfma_f32_16x16x32_bf16 v[160:163], a[16:19], v[80:83], v[160:163]
    ds_read_b128 v[64:67], v224 offset:16384
    v_mfma_f32_16x16x32_bf16 v[164:167], a[20:23], v[80:83], v[164:167]
    ds_read_b128 v[68:71], v225 offset:16384
    v_mfma_f32_16x16x32_bf16 v[168:171], a[24:27], v[80:83], v[168:171]
    ds_read_b128 v[72:75], v224 offset:18432
    v_mfma_f32_16x16x32_bf16 v[172:175], a[28:31], v[80:83], v[172:175]
    ds_read_b128 v[76:79], v225 offset:18432
    v_mfma_f32_16x16x32_bf16 v[176:179], a[16:19], v[84:87], v[176:179]
    ds_read_b64_tr_b16 a[48:49], v228 offset:12288
    s_add_u32 m0, s34, 49152
    s_add_u32 s37, s83, 0
    buffer_load_dwordx4 v232, s[44:47], s37 offen lds
    v_mfma_f32_16x16x32_bf16 v[180:183], a[20:23], v[84:87], v[180:183]
    ds_read_b64_tr_b16 a[50:51], v228 offset:12800
    buffer_load_dwordx4 v233, s[44:47], s37 offen offset:1024 lds
    v_mfma_f32_16x16x32_bf16 v[184:187], a[24:27], v[84:87], v[184:187]
    ds_read_b64_tr_b16 a[52:53], v229 offset:12288
    s_add_u32 m0, s34, 57344
    s_add_u32 s37, s83, 65536
    buffer_load_dwordx4 v232, s[44:47], s37 offen lds
    v_mfma_f32_16x16x32_bf16 v[188:191], a[28:31], v[84:87], v[188:191]
    ds_read_b64_tr_b16 a[54:55], v229 offset:12800
    buffer_load_dwordx4 v233, s[44:47], s37 offen offset:1024 lds
    v_mfma_f32_16x16x32_bf16 v[192:195], a[16:19], v[88:91], v[192:195]
    ds_read_b64_tr_b16 a[56:57], v230 offset:12288
    s_add_u32 m0, s34, 0
    s_add_u32 s37, s84, 0
    buffer_load_dwordx4 v232, s[44:47], s37 offen lds
    v_mfma_f32_16x16x32_bf16 v[196:199], a[20:23], v[88:91], v[196:199]
    ds_read_b64_tr_b16 a[58:59], v230 offset:12800
    v_mfma_f32_16x16x32_bf16 v[200:203], a[24:27], v[88:91], v[200:203]
    ds_read_b64_tr_b16 a[60:61], v231 offset:12288
    buffer_load_dwordx4 v233, s[44:47], s37 offen offset:1024 lds
    v_mfma_f32_16x16x32_bf16 v[204:207], a[28:31], v[88:91], v[204:207]
    ds_read_b64_tr_b16 a[62:63], v231 offset:12800
    buffer_load_dwordx4 v[0:3], v236, s[52:55], 0 offen offset:0
    v_mfma_f32_16x16x32_bf16 v[208:211], a[16:19], v[92:95], v[208:211]
    buffer_load_dwordx4 v[4:7], v236, s[52:55], 0 offen offset:512
    v_mfma_f32_16x16x32_bf16 v[212:215], a[20:23], v[92:95], v[212:215]
    buffer_load_dwordx4 v[8:11], v236, s[52:55], 0 offen offset:1024
    v_mfma_f32_16x16x32_bf16 v[216:219], a[24:27], v[92:95], v[216:219]
    buffer_load_dwordx4 v[12:15], v236, s[52:55], 0 offen offset:1536
    v_mfma_f32_16x16x32_bf16 v[220:223], a[28:31], v[92:95], v[220:223]
    s_waitcnt lgkmcnt(0)
    v_mfma_f32_16x16x32_bf16 v[96:99], a[32:35], v[64:67], v[96:99]
    ds_read_b128 v[80:83], v224 offset:20480
    v_mfma_f32_16x16x32_bf16 v[96:99], a[48:51], v[68:71], v[96:99]
    ds_read_b128 v[84:87], v225 offset:20480
    v_mfma_f32_16x16x32_bf16 v[100:103], a[36:39], v[64:67], v[100:103]
    ds_read_b128 v[88:91], v224 offset:22528
    v_mfma_f32_16x16x32_bf16 v[100:103], a[52:55], v[68:71], v[100:103]
    ds_read_b128 v[92:95], v225 offset:22528
    v_mfma_f32_16x16x32_bf16 v[104:107], a[40:43], v[64:67], v[104:107]
    v_mfma_f32_16x16x32_bf16 v[104:107], a[56:59], v[68:71], v[104:107]
    v_mfma_f32_16x16x32_bf16 v[108:111], a[44:47], v[64:67], v[108:111]
    v_mfma_f32_16x16x32_bf16 v[108:111], a[60:63], v[68:71], v[108:111]
    v_mfma_f32_16x16x32_bf16 v[112:115], a[32:35], v[72:75], v[112:115]
    s_add_u32 m0, s35, 4096
    s_add_u32 s33, s33, 131072
    buffer_load_dwordx4 v234, s[48:51], s33 offen lds
    v_mfma_f32_16x16x32_bf16 v[112:115], a[48:51], v[76:79], v[112:115]
    v_mfma_f32_16x16x32_bf16 v[116:119], a[36:39], v[72:75], v[116:119]
    buffer_load_dwordx4 v235, s[48:51], s33 offen offset:1024 lds
    v_mfma_f32_16x16x32_bf16 v[116:119], a[52:55], v[76:79], v[116:119]
    v_mfma_f32_16x16x32_bf16 v[120:123], a[40:43], v[72:75], v[120:123]
    s_add_u32 m0, s35, 6144
    s_add_u32 s33, s33, 131072
    buffer_load_dwordx4 v234, s[48:51], s33 offen lds
    v_mfma_f32_16x16x32_bf16 v[120:123], a[56:59], v[76:79], v[120:123]
    v_mfma_f32_16x16x32_bf16 v[124:127], a[44:47], v[72:75], v[124:127]
    buffer_load_dwordx4 v235, s[48:51], s33 offen offset:1024 lds
    v_mfma_f32_16x16x32_bf16 v[124:127], a[60:63], v[76:79], v[124:127]
    s_waitcnt lgkmcnt(0)
    v_mfma_f32_16x16x32_bf16 v[128:131], a[32:35], v[80:83], v[128:131]
    ds_read_b128 v[64:67], v224 offset:24576
    v_mfma_f32_16x16x32_bf16 v[128:131], a[48:51], v[84:87], v[128:131]
    ds_read_b128 v[68:71], v225 offset:24576
    v_mfma_f32_16x16x32_bf16 v[132:135], a[36:39], v[80:83], v[132:135]
    ds_read_b128 v[72:75], v224 offset:26624
    v_mfma_f32_16x16x32_bf16 v[132:135], a[52:55], v[84:87], v[132:135]
    ds_read_b128 v[76:79], v225 offset:26624
    v_mfma_f32_16x16x32_bf16 v[136:139], a[40:43], v[80:83], v[136:139]
    v_mfma_f32_16x16x32_bf16 v[136:139], a[56:59], v[84:87], v[136:139]
    v_mfma_f32_16x16x32_bf16 v[140:143], a[44:47], v[80:83], v[140:143]
    v_mfma_f32_16x16x32_bf16 v[140:143], a[60:63], v[84:87], v[140:143]
    v_mfma_f32_16x16x32_bf16 v[144:147], a[32:35], v[88:91], v[144:147]
    s_add_u32 m0, s34, 8192
    s_add_u32 s37, s84, 65536
    buffer_load_dwordx4 v232, s[44:47], s37 offen lds
    v_mfma_f32_16x16x32_bf16 v[144:147], a[48:51], v[92:95], v[144:147]
    v_mfma_f32_16x16x32_bf16 v[148:151], a[36:39], v[88:91], v[148:151]
    v_mfma_f32_16x16x32_bf16 v[148:151], a[52:55], v[92:95], v[148:151]
    v_mfma_f32_16x16x32_bf16 v[152:155], a[40:43], v[88:91], v[152:155]
    buffer_load_dwordx4 v233, s[44:47], s37 offen offset:1024 lds
    v_mfma_f32_16x16x32_bf16 v[152:155], a[56:59], v[92:95], v[152:155]
    v_mfma_f32_16x16x32_bf16 v[156:159], a[44:47], v[88:91], v[156:159]
    v_mfma_f32_16x16x32_bf16 v[156:159], a[60:63], v[92:95], v[156:159]
    s_waitcnt vmcnt(24) lgkmcnt(0)
    v_mfma_f32_16x16x32_bf16 v[160:163], a[32:35], v[64:67], v[160:163]
    ds_read_b128 v[80:83], v224 offset:28672
    v_mfma_f32_16x16x32_bf16 v[160:163], a[48:51], v[68:71], v[160:163]
    ds_read_b128 v[84:87], v225 offset:28672
    v_mfma_f32_16x16x32_bf16 v[164:167], a[36:39], v[64:67], v[164:167]
    ds_read_b128 v[88:91], v224 offset:30720
    v_mfma_f32_16x16x32_bf16 v[164:167], a[52:55], v[68:71], v[164:167]
    ds_read_b128 v[92:95], v225 offset:30720
    v_mfma_f32_16x16x32_bf16 v[168:171], a[40:43], v[64:67], v[168:171]
    ds_read_b64_tr_b16 a[64:65], v228 offset:16384
    v_mfma_f32_16x16x32_bf16 v[168:171], a[56:59], v[68:71], v[168:171]
    ds_read_b64_tr_b16 a[66:67], v228 offset:16896
    v_mfma_f32_16x16x32_bf16 v[172:175], a[44:47], v[64:67], v[172:175]
    ds_read_b64_tr_b16 a[68:69], v229 offset:16384
    v_mfma_f32_16x16x32_bf16 v[172:175], a[60:63], v[68:71], v[172:175]
    ds_read_b64_tr_b16 a[70:71], v229 offset:16896
    v_mfma_f32_16x16x32_bf16 v[176:179], a[32:35], v[72:75], v[176:179]
    ds_read_b64_tr_b16 a[72:73], v230 offset:16384
    s_add_u32 m0, s35, 8192
    s_and_b32 s33, s84, 1023
    s_lshl_b32 s33, s33, 12
    buffer_load_dwordx4 v234, s[48:51], s33 offen lds
    v_mfma_f32_16x16x32_bf16 v[176:179], a[48:51], v[76:79], v[176:179]
    ds_read_b64_tr_b16 a[74:75], v230 offset:16896
    v_mfma_f32_16x16x32_bf16 v[180:183], a[36:39], v[72:75], v[180:183]
    ds_read_b64_tr_b16 a[76:77], v231 offset:16384
    buffer_load_dwordx4 v235, s[48:51], s33 offen offset:1024 lds
    v_mfma_f32_16x16x32_bf16 v[180:183], a[52:55], v[76:79], v[180:183]
    ds_read_b64_tr_b16 a[78:79], v231 offset:16896
    v_mfma_f32_16x16x32_bf16 v[184:187], a[40:43], v[72:75], v[184:187]
    s_add_u32 m0, s35, 10240
    s_add_u32 s33, s33, 131072
    buffer_load_dwordx4 v234, s[48:51], s33 offen lds
    v_mfma_f32_16x16x32_bf16 v[184:187], a[56:59], v[76:79], v[184:187]
    v_mfma_f32_16x16x32_bf16 v[188:191], a[44:47], v[72:75], v[188:191]
    buffer_load_dwordx4 v235, s[48:51], s33 offen offset:1024 lds
    v_mfma_f32_16x16x32_bf16 v[188:191], a[60:63], v[76:79], v[188:191]
    s_waitcnt vmcnt(24) lgkmcnt(0)
    s_barrier
    v_mfma_f32_16x16x32_bf16 v[192:195], a[32:35], v[80:83], v[192:195]
    ds_read_b128 v[64:67], v224 offset:32768
    v_mfma_f32_16x16x32_bf16 v[192:195], a[48:51], v[84:87], v[192:195]
    ds_read_b128 v[68:71], v225 offset:32768
    v_mfma_f32_16x16x32_bf16 v[196:199], a[36:39], v[80:83], v[196:199]
    ds_read_b128 v[72:75], v224 offset:34816
    v_mfma_f32_16x16x32_bf16 v[196:199], a[52:55], v[84:87], v[196:199]
    ds_read_b128 v[76:79], v225 offset:34816
    v_mfma_f32_16x16x32_bf16 v[200:203], a[40:43], v[80:83], v[200:203]
    ds_read_b64_tr_b16 a[80:81], v228 offset:20480
    v_mfma_f32_16x16x32_bf16 v[200:203], a[56:59], v[84:87], v[200:203]
    ds_read_b64_tr_b16 a[82:83], v228 offset:20992
    v_mfma_f32_16x16x32_bf16 v[204:207], a[44:47], v[80:83], v[204:207]
    ds_read_b64_tr_b16 a[84:85], v229 offset:20480
    v_mfma_f32_16x16x32_bf16 v[204:207], a[60:63], v[84:87], v[204:207]
    ds_read_b64_tr_b16 a[86:87], v229 offset:20992
    v_mfma_f32_16x16x32_bf16 v[208:211], a[32:35], v[88:91], v[208:211]
    ds_read_b64_tr_b16 a[88:89], v230 offset:20480
    s_add_u32 m0, s34, 16384
    s_add_u32 s37, s85, 0
    buffer_load_dwordx4 v232, s[44:47], s37 offen lds
    v_mfma_f32_16x16x32_bf16 v[208:211], a[48:51], v[92:95], v[208:211]
    ds_read_b64_tr_b16 a[90:91], v230 offset:20992
    v_mfma_f32_16x16x32_bf16 v[212:215], a[36:39], v[88:91], v[212:215]
    ds_read_b64_tr_b16 a[92:93], v231 offset:20480
    v_mfma_f32_16x16x32_bf16 v[212:215], a[52:55], v[92:95], v[212:215]
    ds_read_b64_tr_b16 a[94:95], v231 offset:20992
    v_mfma_f32_16x16x32_bf16 v[216:219], a[40:43], v[88:91], v[216:219]
    buffer_load_dwordx4 v233, s[44:47], s37 offen offset:1024 lds
    v_mfma_f32_16x16x32_bf16 v[216:219], a[56:59], v[92:95], v[216:219]
    v_mfma_f32_16x16x32_bf16 v[220:223], a[44:47], v[88:91], v[220:223]
    v_mfma_f32_16x16x32_bf16 v[220:223], a[60:63], v[92:95], v[220:223]
    s_waitcnt lgkmcnt(0)
    v_mfma_f32_16x16x32_bf16 v[96:99], a[64:67], v[64:67], v[96:99]
    ds_read_b128 v[80:83], v224 offset:36864
    v_mfma_f32_16x16x32_bf16 v[96:99], a[80:83], v[68:71], v[96:99]
    ds_read_b128 v[84:87], v225 offset:36864
    v_mfma_f32_16x16x32_bf16 v[100:103], a[68:71], v[64:67], v[100:103]
    ds_read_b128 v[88:91], v224 offset:38912
    v_mfma_f32_16x16x32_bf16 v[100:103], a[84:87], v[68:71], v[100:103]
    ds_read_b128 v[92:95], v225 offset:38912
    v_mfma_f32_16x16x32_bf16 v[104:107], a[72:75], v[64:67], v[104:107]
    v_mfma_f32_16x16x32_bf16 v[104:107], a[88:91], v[68:71], v[104:107]
    v_mfma_f32_16x16x32_bf16 v[108:111], a[76:79], v[64:67], v[108:111]
    v_mfma_f32_16x16x32_bf16 v[108:111], a[92:95], v[68:71], v[108:111]
    v_mfma_f32_16x16x32_bf16 v[112:115], a[64:67], v[72:75], v[112:115]
    s_add_u32 m0, s35, 12288
    s_add_u32 s33, s33, 131072
    buffer_load_dwordx4 v234, s[48:51], s33 offen lds
    v_mfma_f32_16x16x32_bf16 v[112:115], a[80:83], v[76:79], v[112:115]
    v_mfma_f32_16x16x32_bf16 v[116:119], a[68:71], v[72:75], v[116:119]
    buffer_load_dwordx4 v235, s[48:51], s33 offen offset:1024 lds
    v_mfma_f32_16x16x32_bf16 v[116:119], a[84:87], v[76:79], v[116:119]
    v_mfma_f32_16x16x32_bf16 v[120:123], a[72:75], v[72:75], v[120:123]
    s_add_u32 m0, s35, 14336
    s_add_u32 s33, s33, 131072
    buffer_load_dwordx4 v234, s[48:51], s33 offen lds
    v_mfma_f32_16x16x32_bf16 v[120:123], a[88:91], v[76:79], v[120:123]
    v_mfma_f32_16x16x32_bf16 v[124:127], a[76:79], v[72:75], v[124:127]
    buffer_load_dwordx4 v235, s[48:51], s33 offen offset:1024 lds
    v_mfma_f32_16x16x32_bf16 v[124:127], a[92:95], v[76:79], v[124:127]
    s_waitcnt lgkmcnt(0)
    v_mfma_f32_16x16x32_bf16 v[128:131], a[64:67], v[80:83], v[128:131]
    ds_read_b128 v[64:67], v224 offset:40960
    v_mfma_f32_16x16x32_bf16 v[128:131], a[80:83], v[84:87], v[128:131]
    ds_read_b128 v[68:71], v225 offset:40960
    v_mfma_f32_16x16x32_bf16 v[132:135], a[68:71], v[80:83], v[132:135]
    ds_read_b128 v[72:75], v224 offset:43008
    v_mfma_f32_16x16x32_bf16 v[132:135], a[84:87], v[84:87], v[132:135]
    ds_read_b128 v[76:79], v225 offset:43008
    v_mfma_f32_16x16x32_bf16 v[136:139], a[72:75], v[80:83], v[136:139]
    v_mfma_f32_16x16x32_bf16 v[136:139], a[88:91], v[84:87], v[136:139]
    v_mfma_f32_16x16x32_bf16 v[140:143], a[76:79], v[80:83], v[140:143]
    v_mfma_f32_16x16x32_bf16 v[140:143], a[92:95], v[84:87], v[140:143]
    v_mfma_f32_16x16x32_bf16 v[144:147], a[64:67], v[88:91], v[144:147]
    s_add_u32 m0, s34, 24576
    s_add_u32 s37, s85, 65536
    buffer_load_dwordx4 v232, s[44:47], s37 offen lds
    v_mfma_f32_16x16x32_bf16 v[144:147], a[80:83], v[92:95], v[144:147]
    v_mfma_f32_16x16x32_bf16 v[148:151], a[68:71], v[88:91], v[148:151]
    v_mfma_f32_16x16x32_bf16 v[148:151], a[84:87], v[92:95], v[148:151]
    v_mfma_f32_16x16x32_bf16 v[152:155], a[72:75], v[88:91], v[152:155]
    buffer_load_dwordx4 v233, s[44:47], s37 offen offset:1024 lds
    v_mfma_f32_16x16x32_bf16 v[152:155], a[88:91], v[92:95], v[152:155]
    v_mfma_f32_16x16x32_bf16 v[156:159], a[76:79], v[88:91], v[156:159]
    v_mfma_f32_16x16x32_bf16 v[156:159], a[92:95], v[92:95], v[156:159]
    s_waitcnt vmcnt(14) lgkmcnt(0)
    v_mfma_f32_16x16x32_bf16 v[160:163], a[64:67], v[64:67], v[160:163]
    ds_read_b128 v[80:83], v224 offset:45056
    s_waitcnt vmcnt(18)
    v_mfma_f32_16x16x32_bf16 v[160:163], a[80:83], v[68:71], v[160:163]
    ds_read_b128 v[84:87], v225 offset:45056
    v_lshlrev_b32 v16, 16, v0
    v_mfma_f32_16x16x32_bf16 v[164:167], a[68:71], v[64:67], v[164:167]
    ds_read_b128 v[88:91], v224 offset:47104
    v_and_b32 v17, 0xffff0000, v0
    v_lshlrev_b32_e64 v18, 16, v1
    v_mfma_f32_16x16x32_bf16 v[164:167], a[84:87], v[68:71], v[164:167]
    ds_read_b128 v[92:95], v225 offset:47104
    v_and_b32 v19, 0xffff0000, v1
    v_mfma_f32_16x16x32_bf16 v[168:171], a[72:75], v[64:67], v[168:171]
    ds_read_b64_tr_b16 a[96:97], v228 offset:0
    v_lshlrev_b32_e64 v20, 16, v2
    v_mfma_f32_16x16x32_bf16 v[168:171], a[88:91], v[68:71], v[168:171]
    ds_read_b64_tr_b16 a[98:99], v228 offset:512
    v_and_b32 v21, 0xffff0000, v2
    v_mfma_f32_16x16x32_bf16 v[172:175], a[76:79], v[64:67], v[172:175]
    ds_read_b64_tr_b16 a[100:101], v229 offset:0
    v_lshlrev_b32_e64 v22, 16, v3
    v_mfma_f32_16x16x32_bf16 v[172:175], a[92:95], v[68:71], v[172:175]
    ds_read_b64_tr_b16 a[102:103], v229 offset:512
    v_and_b32 v23, 0xffff0000, v3
    v_mfma_f32_16x16x32_bf16 v[176:179], a[64:67], v[72:75], v[176:179]
    ds_read_b64_tr_b16 a[104:105], v230 offset:0
    s_add_u32 m0, s35, 16384
    s_and_b32 s33, s85, 1023
    s_lshl_b32 s33, s33, 12
    buffer_load_dwordx4 v234, s[48:51], s33 offen lds
    v_mfma_f32_16x16x32_bf16 v[176:179], a[80:83], v[76:79], v[176:179]
    ds_read_b64_tr_b16 a[106:107], v230 offset:512
    buffer_load_dwordx4 v235, s[48:51], s33 offen offset:1024 lds
    v_mfma_f32_16x16x32_bf16 v[180:183], a[68:71], v[72:75], v[180:183]
    ds_read_b64_tr_b16 a[108:109], v231 offset:0
    s_add_u32 m0, s35, 18432
    s_add_u32 s33, s33, 131072
    buffer_load_dwordx4 v234, s[48:51], s33 offen lds
    v_mfma_f32_16x16x32_bf16 v[180:183], a[84:87], v[76:79], v[180:183]
    ds_read_b64_tr_b16 a[110:111], v231 offset:512
    v_lshlrev_b32 v24, 16, v4
    v_and_b32 v25, 0xffff0000, v4
    v_mfma_f32_16x16x32_bf16 v[184:187], a[72:75], v[72:75], v[184:187]
    buffer_load_dwordx4 v235, s[48:51], s33 offen offset:1024 lds
    v_lshlrev_b32_e64 v26, 16, v5
    v_mfma_f32_16x16x32_bf16 v[184:187], a[88:91], v[76:79], v[184:187]
    s_lshl2_add_u32 s26, s4, s3
    s_lshl_b32 s26, s26, 10
    s_add_u32 s26, s26, s32
    s_add_u32 s26, s26, 131072
    v_mfma_f32_16x16x32_bf16 v[188:191], a[76:79], v[72:75], v[188:191]
    v_and_b32 v226, 0x40000380, v251
    buffer_load_dword v241, v226, s[44:47], s26 offen
    v_mfma_f32_16x16x32_bf16 v[188:191], a[92:95], v[76:79], v[188:191]
    s_waitcnt vmcnt(29) lgkmcnt(0)
    s_barrier
    v_mfma_f32_16x16x32_bf16 v[192:195], a[64:67], v[80:83], v[192:195]
    ds_read_b128 v[64:67], v224 offset:49152
    v_and_b32 v27, 0xffff0000, v5
    v_mfma_f32_16x16x32_bf16 v[192:195], a[80:83], v[84:87], v[192:195]
    ds_read_b128 v[68:71], v225 offset:49152
    v_lshlrev_b32 v28, 16, v6
    v_mfma_f32_16x16x32_bf16 v[196:199], a[68:71], v[80:83], v[196:199]
    ds_read_b128 v[72:75], v224 offset:51200
    v_and_b32 v29, 0xffff0000, v6
    v_mfma_f32_16x16x32_bf16 v[196:199], a[84:87], v[84:87], v[196:199]
    ds_read_b128 v[76:79], v225 offset:51200
    v_lshlrev_b32_e64 v30, 16, v7
    v_and_b32 v31, 0xffff0000, v7
    v_mfma_f32_16x16x32_bf16 v[200:203], a[72:75], v[80:83], v[200:203]
    ds_read_b64_tr_b16 a[112:113], v228 offset:4096
    v_lshlrev_b32_e64 v32, 16, v8
    v_mfma_f32_16x16x32_bf16 v[200:203], a[88:91], v[84:87], v[200:203]
    ds_read_b64_tr_b16 a[114:115], v228 offset:4608
    v_and_b32 v33, 0xffff0000, v8
    v_mfma_f32_16x16x32_bf16 v[204:207], a[76:79], v[80:83], v[204:207]
    ds_read_b64_tr_b16 a[116:117], v229 offset:4096
    v_lshlrev_b32_e64 v34, 16, v9
    v_mfma_f32_16x16x32_bf16 v[204:207], a[92:95], v[84:87], v[204:207]
    ds_read_b64_tr_b16 a[118:119], v229 offset:4608
    v_and_b32 v35, 0xffff0000, v9
    v_mfma_f32_16x16x32_bf16 v[208:211], a[64:67], v[88:91], v[208:211]
    ds_read_b64_tr_b16 a[120:121], v230 offset:4096
    s_add_u32 m0, s34, 32768
    s_add_u32 s37, s86, 0
    buffer_load_dwordx4 v232, s[44:47], s37 offen lds
    v_mfma_f32_16x16x32_bf16 v[208:211], a[80:83], v[92:95], v[208:211]
    ds_read_b64_tr_b16 a[122:123], v230 offset:4608
    v_lshlrev_b32 v36, 16, v10
    v_mfma_f32_16x16x32_bf16 v[212:215], a[68:71], v[88:91], v[212:215]
    ds_read_b64_tr_b16 a[124:125], v231 offset:4096
    v_and_b32 v37, 0xffff0000, v10
    v_lshlrev_b32_e64 v38, 16, v11
    v_mfma_f32_16x16x32_bf16 v[212:215], a[84:87], v[92:95], v[212:215]
    ds_read_b64_tr_b16 a[126:127], v231 offset:4608
    v_and_b32 v39, 0xffff0000, v11
    v_mfma_f32_16x16x32_bf16 v[216:219], a[72:75], v[88:91], v[216:219]
    buffer_load_dwordx4 v233, s[44:47], s37 offen offset:1024 lds
    v_lshlrev_b32_e64 v40, 16, v12
    v_mfma_f32_16x16x32_bf16 v[216:219], a[88:91], v[92:95], v[216:219]
    v_and_b32 v41, 0xffff0000, v12
    v_lshlrev_b32_e64 v42, 16, v13
    v_mfma_f32_16x16x32_bf16 v[220:223], a[76:79], v[88:91], v[220:223]
    v_and_b32 v43, 0xffff0000, v13
    v_lshlrev_b32_e64 v44, 16, v14
    v_and_b32 v45, 0xffff0000, v14
    v_mfma_f32_16x16x32_bf16 v[220:223], a[92:95], v[92:95], v[220:223]
    v_lshlrev_b32 v46, 16, v15
    s_waitcnt lgkmcnt(0)
    v_mfma_f32_16x16x32_bf16 v[96:99], a[96:99], v[64:67], v[96:99]
    ds_read_b128 v[80:83], v224 offset:53248
    v_and_b32 v47, 0xffff0000, v15
    v_mfma_f32_16x16x32_bf16 v[96:99], a[112:115], v[68:71], v[96:99]
    ds_read_b128 v[84:87], v225 offset:53248
    v_add_f32_e64 v52, v16, v20
    v_mfma_f32_16x16x32_bf16 v[100:103], a[100:103], v[64:67], v[100:103]
    ds_read_b128 v[88:91], v224 offset:55296
    v_add_f32_e64 v53, v17, v21
    v_mfma_f32_16x16x32_bf16 v[100:103], a[116:119], v[68:71], v[100:103]
    ds_read_b128 v[92:95], v225 offset:55296
    v_add_f32 v54, v18, v22
    v_add_f32 v55, v19, v23
    v_mfma_f32_16x16x32_bf16 v[104:107], a[104:107], v[64:67], v[104:107]
    v_add_f32 v52, v52, v24
    v_add_f32 v53, v53, v25
    v_mfma_f32_16x16x32_bf16 v[104:107], a[120:123], v[68:71], v[104:107]
    v_add_f32 v54, v54, v26
    v_add_f32 v55, v55, v27
    v_mfma_f32_16x16x32_bf16 v[108:111], a[108:111], v[64:67], v[108:111]
    v_add_f32 v52, v52, v28
    v_add_f32 v53, v53, v29
    v_add_f32_e64 v54, v54, v30
    v_mfma_f32_16x16x32_bf16 v[108:111], a[124:127], v[68:71], v[108:111]
    v_add_f32 v55, v55, v31
    v_add_f32 v52, v52, v32
    v_mfma_f32_16x16x32_bf16 v[112:115], a[96:99], v[72:75], v[112:115]
    s_add_u32 m0, s35, 20480
    s_add_u32 s33, s33, 131072
    buffer_load_dwordx4 v234, s[48:51], s33 offen lds
    v_mfma_f32_16x16x32_bf16 v[112:115], a[112:115], v[76:79], v[112:115]
    v_add_f32 v53, v53, v33
    v_add_f32 v54, v54, v34
    v_mfma_f32_16x16x32_bf16 v[116:119], a[100:103], v[72:75], v[116:119]
    buffer_load_dwordx4 v235, s[48:51], s33 offen offset:1024 lds
    v_add_f32 v55, v55, v35
    v_add_f32 v52, v52, v36
    v_mfma_f32_16x16x32_bf16 v[116:119], a[116:119], v[76:79], v[116:119]
    v_add_f32 v53, v53, v37
    v_add_f32 v54, v54, v38
    v_mfma_f32_16x16x32_bf16 v[120:123], a[104:107], v[72:75], v[120:123]
    s_add_u32 m0, s35, 22528
    s_add_u32 s33, s33, 131072
    buffer_load_dwordx4 v234, s[48:51], s33 offen lds
    v_mfma_f32_16x16x32_bf16 v[120:123], a[120:123], v[76:79], v[120:123]
    v_add_f32 v55, v55, v39
    v_add_f32 v52, v52, v40
    v_mfma_f32_16x16x32_bf16 v[124:127], a[108:111], v[72:75], v[124:127]
    buffer_load_dwordx4 v235, s[48:51], s33 offen offset:1024 lds
    v_add_f32 v53, v53, v41
    v_add_f32 v54, v54, v42
    v_mfma_f32_16x16x32_bf16 v[124:127], a[124:127], v[76:79], v[124:127]
    v_add_f32 v55, v55, v43
    s_waitcnt lgkmcnt(0)
    v_mfma_f32_16x16x32_bf16 v[128:131], a[96:99], v[80:83], v[128:131]
    ds_read_b128 v[64:67], v224 offset:57344
    v_add_f32_e64 v52, v52, v44
    v_mfma_f32_16x16x32_bf16 v[128:131], a[112:115], v[84:87], v[128:131]
    ds_read_b128 v[68:71], v225 offset:57344
    v_add_f32_e64 v53, v53, v45
    v_mfma_f32_16x16x32_bf16 v[132:135], a[100:103], v[80:83], v[132:135]
    ds_read_b128 v[72:75], v224 offset:59392
    v_add_f32_e64 v54, v54, v46
    v_mfma_f32_16x16x32_bf16 v[132:135], a[116:119], v[84:87], v[132:135]
    ds_read_b128 v[76:79], v225 offset:59392
    v_add_f32 v55, v55, v47
    v_add_f32 v52, v52, v53
    v_mfma_f32_16x16x32_bf16 v[136:139], a[104:107], v[80:83], v[136:139]
    v_add_f32 v54, v54, v55
    v_add_f32 v48, v52, v54
    v_mfma_f32_16x16x32_bf16 v[136:139], a[120:123], v[84:87], v[136:139]
    s_nop 1
    v_add_f32_dpp v48, v48, v48 quad_perm:[1,0,3,2] row_mask:0xf bank_mask:0xf
    v_mfma_f32_16x16x32_bf16 v[140:143], a[108:111], v[80:83], v[140:143]
    s_nop 1
    v_add_f32_dpp v48, v48, v48 quad_perm:[2,3,0,1] row_mask:0xf bank_mask:0xf
    s_nop 1
    v_mfma_f32_16x16x32_bf16 v[140:143], a[124:127], v[84:87], v[140:143]
    v_add_f32_dpp v48, v48, v48 row_half_mirror row_mask:0xf bank_mask:0xf
    s_nop 1
    v_mfma_f32_16x16x32_bf16 v[144:147], a[96:99], v[88:91], v[144:147]
    s_add_u32 m0, s34, 40960
    s_add_u32 s37, s86, 65536
    buffer_load_dwordx4 v232, s[44:47], s37 offen lds
    v_mfma_f32_16x16x32_bf16 v[144:147], a[112:115], v[92:95], v[144:147]
    v_add_f32_dpp v48, v48, v48 row_mirror row_mask:0xf bank_mask:0xf
    s_nop 0
    v_mfma_f32_16x16x32_bf16 v[148:151], a[100:103], v[88:91], v[148:151]
    buffer_load_dwordx4 v233, s[44:47], s37 offen offset:1024 lds
    v_mov_b32_e64 v49, v48
    s_nop 1
    v_mfma_f32_16x16x32_bf16 v[148:151], a[116:119], v[92:95], v[148:151]
    v_permlane16_swap_b32 v48, v49
    s_nop 0
    v_mfma_f32_16x16x32_bf16 v[152:155], a[104:107], v[88:91], v[152:155]
    v_lshlrev_b32_e64 v227, 3, v240
    v_min_u32 v227, 1920, v227
    s_lshl2_add_u32 s25, s2, s3
    v_mfma_f32_16x16x32_bf16 v[152:155], a[120:123], v[92:95], v[152:155]
    v_add_f32 v48, v48, v49
    v_mul_f32 v48, 0x3a800000, v48
    v_mfma_f32_16x16x32_bf16 v[156:159], a[108:111], v[88:91], v[156:159]
    s_lshl_b32 s25, s25, 13
    s_add_u32 s25, s25, 0
    buffer_load_dword v241, v227, s[12:15], s25 offen
    v_mfma_f32_16x16x32_bf16 v[156:159], a[124:127], v[92:95], v[156:159]
    v_sub_f32 v56, v16, v48
    s_waitcnt vmcnt(16) lgkmcnt(0)
    v_mfma_f32_16x16x32_bf16 v[160:163], a[96:99], v[64:67], v[160:163]
    ds_read_b128 v[80:83], v224 offset:61440
    v_mul_f32 v52, v56, v56
    v_sub_f32 v57, v17, v48
    v_mfma_f32_16x16x32_bf16 v[160:163], a[112:115], v[68:71], v[160:163]
    ds_read_b128 v[84:87], v225 offset:61440
    v_mul_f32_e64 v53, v57, v57
    v_mfma_f32_16x16x32_bf16 v[164:167], a[100:103], v[64:67], v[164:167]
    ds_read_b128 v[88:91], v224 offset:63488
    v_sub_f32_e64 v58, v18, v48
    v_mfma_f32_16x16x32_bf16 v[164:167], a[116:119], v[68:71], v[164:167]
    ds_read_b128 v[92:95], v225 offset:63488
    v_mul_f32_e64 v54, v58, v58
    v_mfma_f32_16x16x32_bf16 v[168:171], a[104:107], v[64:67], v[168:171]
    ds_read_b64_tr_b16 a[128:129], v228 offset:8192
    v_sub_f32_e64 v59, v19, v48
    v_mfma_f32_16x16x32_bf16 v[168:171], a[120:123], v[68:71], v[168:171]
    ds_read_b64_tr_b16 a[130:131], v228 offset:8704
    v_mul_f32 v55, v59, v59
    v_sub_f32 v56, v20, v48
    v_mfma_f32_16x16x32_bf16 v[172:175], a[108:111], v[64:67], v[172:175]
    ds_read_b64_tr_b16 a[132:133], v229 offset:8192
    v_fmac_f32_e64 v52, v56, v56
    v_mfma_f32_16x16x32_bf16 v[172:175], a[124:127], v[68:71], v[172:175]
    ds_read_b64_tr_b16 a[134:135], v229 offset:8704
    v_sub_f32_e64 v57, v21, v48
    v_mfma_f32_16x16x32_bf16 v[176:179], a[96:99], v[72:75], v[176:179]
    ds_read_b64_tr_b16 a[136:137], v230 offset:8192
    s_add_u32 m0, s35, 0
    s_and_b32 s33, s86, 1023
    s_lshl_b32 s33, s33, 12
    buffer_load_dwordx4 v234, s[48:51], s33 offen lds
    v_mfma_f32_16x16x32_bf16 v[176:179], a[112:115], v[76:79], v[176:179]
    ds_read_b64_tr_b16 a[138:139], v230 offset:8704
    v_fmac_f32_e64 v53, v57, v57
    v_mfma_f32_16x16x32_bf16 v[180:183], a[100:103], v[72:75], v[180:183]
    ds_read_b64_tr_b16 a[140:141], v231 offset:8192
    buffer_load_dwordx4 v235, s[48:51], s33 offen offset:1024 lds
    v_mfma_f32_16x16x32_bf16 v[180:183], a[116:119], v[76:79], v[180:183]
    ds_read_b64_tr_b16 a[142:143], v231 offset:8704
    v_sub_f32_e64 v58, v22, v48
    v_mfma_f32_16x16x32_bf16 v[184:187], a[104:107], v[72:75], v[184:187]
    s_add_u32 m0, s35, 2048
    s_add_u32 s33, s33, 131072
    buffer_load_dwordx4 v234, s[48:51], s33 offen lds
    v_mfma_f32_16x16x32_bf16 v[184:187], a[120:123], v[76:79], v[184:187]
    v_fmac_f32 v54, v58, v58
    v_sub_f32 v59, v23, v48
    v_fmac_f32_e64 v55, v59, v59
    v_mfma_f32_16x16x32_bf16 v[188:191], a[108:111], v[72:75], v[188:191]
    buffer_load_dwordx4 v235, s[48:51], s33 offen offset:1024 lds
    v_sub_f32_e64 v56, v24, v48
    v_mfma_f32_16x16x32_bf16 v[188:191], a[124:127], v[76:79], v[188:191]
    s_waitcnt vmcnt(30) lgkmcnt(0)
    s_barrier
    v_mfma_f32_16x16x32_bf16 v[192:195], a[96:99], v[80:83], v[192:195]
    ds_read_b128 v[64:67], v224 offset:0
    v_fmac_f32_e64 v52, v56, v56
    v_mfma_f32_16x16x32_bf16 v[192:195], a[112:115], v[84:87], v[192:195]
    ds_read_b128 v[68:71], v225 offset:0
    v_sub_f32_e64 v57, v25, v48
    v_mfma_f32_16x16x32_bf16 v[196:199], a[100:103], v[80:83], v[196:199]
    ds_read_b128 v[72:75], v224 offset:2048
    v_fmac_f32_e64 v53, v57, v57
    v_mfma_f32_16x16x32_bf16 v[196:199], a[116:119], v[84:87], v[196:199]
    ds_read_b128 v[76:79], v225 offset:2048
    v_sub_f32 v58, v26, v48
    v_fmac_f32 v54, v58, v58
    v_mfma_f32_16x16x32_bf16 v[200:203], a[104:107], v[80:83], v[200:203]
    ds_read_b64_tr_b16 a[144:145], v228 offset:12288
    v_sub_f32_e64 v59, v27, v48
    v_mfma_f32_16x16x32_bf16 v[200:203], a[120:123], v[84:87], v[200:203]
    ds_read_b64_tr_b16 a[146:147], v228 offset:12800
    v_fmac_f32_e64 v55, v59, v59
    v_mfma_f32_16x16x32_bf16 v[204:207], a[108:111], v[80:83], v[204:207]
    ds_read_b64_tr_b16 a[148:149], v229 offset:12288
    v_sub_f32_e64 v56, v28, v48
    v_mfma_f32_16x16x32_bf16 v[204:207], a[124:127], v[84:87], v[204:207]
    ds_read_b64_tr_b16 a[150:151], v229 offset:12800
    v_fmac_f32_e64 v52, v56, v56
    v_mfma_f32_16x16x32_bf16 v[208:211], a[96:99], v[88:91], v[208:211]
    ds_read_b64_tr_b16 a[152:153], v230 offset:12288
    s_add_u32 m0, s34, 49152
    s_add_u32 s37, s87, 0
    buffer_load_dwordx4 v232, s[44:47], s37 offen lds
    v_mfma_f32_16x16x32_bf16 v[208:211], a[112:115], v[92:95], v[208:211]
    ds_read_b64_tr_b16 a[154:155], v230 offset:12800
    v_sub_f32 v57, v29, v48
    v_mfma_f32_16x16x32_bf16 v[212:215], a[100:103], v[88:91], v[212:215]
    ds_read_b64_tr_b16 a[156:157], v231 offset:12288
    v_fmac_f32 v53, v57, v57
    v_sub_f32 v58, v30, v48
    v_mfma_f32_16x16x32_bf16 v[212:215], a[116:119], v[92:95], v[212:215]
    ds_read_b64_tr_b16 a[158:159], v231 offset:12800
    v_fmac_f32_e64 v54, v58, v58
    v_mfma_f32_16x16x32_bf16 v[216:219], a[104:107], v[88:91], v[216:219]
    buffer_load_dwordx4 v233, s[44:47], s37 offen offset:1024 lds
    v_sub_f32_e64 v59, v31, v48
    v_mfma_f32_16x16x32_bf16 v[216:219], a[120:123], v[92:95], v[216:219]
    v_fmac_f32 v55, v59, v59
    v_sub_f32 v56, v32, v48
    v_mfma_f32_16x16x32_bf16 v[220:223], a[108:111], v[88:91], v[220:223]
    v_fmac_f32 v52, v56, v56
    v_sub_f32 v57, v33, v48
    v_fmac_f32_e64 v53, v57, v57
    v_mfma_f32_16x16x32_bf16 v[220:223], a[124:127], v[92:95], v[220:223]
    v_sub_f32 v58, v34, v48
    s_waitcnt lgkmcnt(0)
    v_mfma_f32_16x16x32_bf16 v[96:99], a[128:131], v[64:67], v[96:99]
    ds_read_b128 v[80:83], v224 offset:4096
    v_fmac_f32_e64 v54, v58, v58
    v_mfma_f32_16x16x32_bf16 v[96:99], a[144:147], v[68:71], v[96:99]
    ds_read_b128 v[84:87], v225 offset:4096
    v_sub_f32_e64 v59, v35, v48
    v_mfma_f32_16x16x32_bf16 v[100:103], a[132:135], v[64:67], v[100:103]
    ds_read_b128 v[88:91], v224 offset:6144
    v_fmac_f32_e64 v55, v59, v59
    v_mfma_f32_16x16x32_bf16 v[100:103], a[148:151], v[68:71], v[100:103]
    ds_read_b128 v[92:95], v225 offset:6144
    v_sub_f32 v56, v36, v48
    v_fmac_f32 v52, v56, v56
    v_mfma_f32_16x16x32_bf16 v[104:107], a[136:139], v[64:67], v[104:107]
    v_sub_f32 v57, v37, v48
    v_fmac_f32 v53, v57, v57
    v_mfma_f32_16x16x32_bf16 v[104:107], a[152:155], v[68:71], v[104:107]
    v_sub_f32 v58, v38, v48
    v_fmac_f32 v54, v58, v58
    v_mfma_f32_16x16x32_bf16 v[108:111], a[140:143], v[64:67], v[108:111]
    v_sub_f32 v59, v39, v48
    v_fmac_f32 v55, v59, v59
    v_sub_f32_e64 v56, v40, v48
    v_mfma_f32_16x16x32_bf16 v[108:111], a[156:159], v[68:71], v[108:111]
    v_fmac_f32 v52, v56, v56
    v_sub_f32 v57, v41, v48
    v_mfma_f32_16x16x32_bf16 v[112:115], a[128:131], v[72:75], v[112:115]
    s_add_u32 m0, s35, 4096
    s_add_u32 s33, s33, 131072
    buffer_load_dwordx4 v234, s[48:51], s33 offen lds
    v_mfma_f32_16x16x32_bf16 v[112:115], a[144:147], v[76:79], v[112:115]
    v_fmac_f32 v53, v57, v57
    v_sub_f32 v58, v42, v48
    v_mfma_f32_16x16x32_bf16 v[116:119], a[132:135], v[72:75], v[116:119]
    buffer_load_dwordx4 v235, s[48:51], s33 offen offset:1024 lds
    v_fmac_f32 v54, v58, v58
    v_sub_f32 v59, v43, v48
    v_mfma_f32_16x16x32_bf16 v[116:119], a[148:151], v[76:79], v[116:119]
    v_fmac_f32 v55, v59, v59
    v_sub_f32 v56, v44, v48
    v_mfma_f32_16x16x32_bf16 v[120:123], a[136:139], v[72:75], v[120:123]
    s_add_u32 m0, s35, 6144
    s_add_u32 s33, s33, 131072
    buffer_load_dwordx4 v234, s[48:51], s33 offen lds
    v_mfma_f32_16x16x32_bf16 v[120:123], a[152:155], v[76:79], v[120:123]
    v_fmac_f32 v52, v56, v56
    v_sub_f32 v57, v45, v48
    v_mfma_f32_16x16x32_bf16 v[124:127], a[140:143], v[72:75], v[124:127]
    buffer_load_dwordx4 v235, s[48:51], s33 offen offset:1024 lds
    v_fmac_f32 v53, v57, v57
    v_sub_f32 v58, v46, v48
    v_mfma_f32_16x16x32_bf16 v[124:127], a[156:159], v[76:79], v[124:127]
    v_fmac_f32 v54, v58, v58
    s_waitcnt lgkmcnt(0)
    v_mfma_f32_16x16x32_bf16 v[128:131], a[128:131], v[80:83], v[128:131]
    ds_read_b128 v[64:67], v224 offset:8192
    v_sub_f32_e64 v59, v47, v48
    v_mfma_f32_16x16x32_bf16 v[128:131], a[144:147], v[84:87], v[128:131]
    ds_read_b128 v[68:71], v225 offset:8192
    v_fmac_f32_e64 v55, v59, v59
    v_mfma_f32_16x16x32_bf16 v[132:135], a[132:135], v[80:83], v[132:135]
    ds_read_b128 v[72:75], v224 offset:10240
    v_add_f32_e64 v52, v52, v53
    v_mfma_f32_16x16x32_bf16 v[132:135], a[148:151], v[84:87], v[132:135]
    ds_read_b128 v[76:79], v225 offset:10240
    v_add_f32_e64 v54, v54, v55
    v_mfma_f32_16x16x32_bf16 v[136:139], a[136:139], v[80:83], v[136:139]
    v_add_f32 v51, v52, v54
    s_nop 1
    v_add_f32_dpp v51, v51, v51 quad_perm:[1,0,3,2] row_mask:0xf bank_mask:0xf
    v_mfma_f32_16x16x32_bf16 v[136:139], a[152:155], v[84:87], v[136:139]
    s_nop 1
    v_add_f32_dpp v51, v51, v51 quad_perm:[2,3,0,1] row_mask:0xf bank_mask:0xf
    v_mfma_f32_16x16x32_bf16 v[140:143], a[140:143], v[80:83], v[140:143]
    s_nop 1
    v_add_f32_dpp v51, v51, v51 row_half_mirror row_mask:0xf bank_mask:0xf
    s_nop 1
    v_mfma_f32_16x16x32_bf16 v[140:143], a[156:159], v[84:87], v[140:143]
    v_add_f32_dpp v51, v51, v51 row_mirror row_mask:0xf bank_mask:0xf
    s_nop 0
    v_mfma_f32_16x16x32_bf16 v[144:147], a[128:131], v[88:91], v[144:147]
    s_add_u32 m0, s34, 57344
    s_add_u32 s37, s87, 65536
    buffer_load_dwordx4 v232, s[44:47], s37 offen lds
    v_mfma_f32_16x16x32_bf16 v[144:147], a[144:147], v[92:95], v[144:147]
    v_mov_b32 v49, v51
    s_nop 1
    v_mfma_f32_16x16x32_bf16 v[148:151], a[132:135], v[88:91], v[148:151]
    buffer_load_dwordx4 v233, s[44:47], s37 offen offset:1024 lds
    v_permlane16_swap_b32 v51, v49
    s_nop 0
    v_mfma_f32_16x16x32_bf16 v[148:151], a[148:151], v[92:95], v[148:151]
    v_add_f32_e64 v51, v51, v49
    v_mul_f32 v51, 0x3a800000, v51
    v_mfma_f32_16x16x32_bf16 v[152:155], a[136:139], v[88:91], v[152:155]
    v_lshlrev_b32_e64 v227, 3, v240
    v_min_u32 v227, 1920, v227
    s_lshl2_add_u32 s25, s2, s3
    v_mfma_f32_16x16x32_bf16 v[152:155], a[152:155], v[92:95], v[152:155]
    v_cvt_pk_bf16_f32 v50, v48, v51
    v_and_b32 v51, 0xffff0000, v50
    v_mfma_f32_16x16x32_bf16 v[156:159], a[140:143], v[88:91], v[156:159]
    s_lshl_b32 s25, s25, 13
    s_add_u32 s25, s25, 2048
    buffer_load_dword v241, v227, s[12:15], s25 offen
    v_mfma_f32_16x16x32_bf16 v[156:159], a[156:159], v[92:95], v[156:159]
    v_lshlrev_b32 v50, 16, v50
    s_waitcnt vmcnt(16) lgkmcnt(0)
    v_mfma_f32_16x16x32_bf16 v[160:163], a[128:131], v[64:67], v[160:163]
    ds_read_b128 v[80:83], v224 offset:12288
    v_add_f32 v51, 0x3727c5ac, v51
    v_cvt_pk_bf16_f32 v51, v51, v51
    v_mfma_f32_16x16x32_bf16 v[160:163], a[144:147], v[68:71], v[160:163]
    ds_read_b128 v[84:87], v225 offset:12288
    v_lshlrev_b32_e64 v51, 16, v51
    v_mfma_f32_16x16x32_bf16 v[164:167], a[132:135], v[64:67], v[164:167]
    ds_read_b128 v[88:91], v224 offset:14336
    v_mfma_f32_16x16x32_bf16 v[164:167], a[148:151], v[68:71], v[164:167]
    ds_read_b128 v[92:95], v225 offset:14336
    v_sqrt_f32 v51, v51
    v_mfma_f32_16x16x32_bf16 v[168:171], a[136:139], v[64:67], v[168:171]
    ds_read_b64_tr_b16 a[160:161], v228 offset:16384
    s_nop 0
    v_mfma_f32_16x16x32_bf16 v[168:171], a[152:155], v[68:71], v[168:171]
    ds_read_b64_tr_b16 a[162:163], v228 offset:16896
    v_cvt_pk_bf16_f32 v51, v51, v51
    v_lshlrev_b32_e64 v51, 16, v51
    v_mfma_f32_16x16x32_bf16 v[172:175], a[140:143], v[64:67], v[172:175]
    ds_read_b64_tr_b16 a[164:165], v229 offset:16384
    v_mfma_f32_16x16x32_bf16 v[172:175], a[156:159], v[68:71], v[172:175]
    ds_read_b64_tr_b16 a[166:167], v229 offset:16896
    v_rcp_f32_e64 v51, v51
    v_mfma_f32_16x16x32_bf16 v[176:179], a[128:131], v[72:75], v[176:179]
    ds_read_b64_tr_b16 a[168:169], v230 offset:16384
    s_add_u32 m0, s35, 8192
    s_and_b32 s33, s87, 1023
    s_lshl_b32 s33, s33, 12
    buffer_load_dwordx4 v234, s[48:51], s33 offen lds
    v_mfma_f32_16x16x32_bf16 v[176:179], a[144:147], v[76:79], v[176:179]
    ds_read_b64_tr_b16 a[170:171], v230 offset:16896
    s_nop 0
    v_mfma_f32_16x16x32_bf16 v[180:183], a[132:135], v[72:75], v[180:183]
    ds_read_b64_tr_b16 a[172:173], v231 offset:16384
    buffer_load_dwordx4 v235, s[48:51], s33 offen offset:1024 lds
    v_mfma_f32_16x16x32_bf16 v[180:183], a[148:151], v[76:79], v[180:183]
    ds_read_b64_tr_b16 a[174:175], v231 offset:16896
    v_mul_f32 v51, 0x3e0293ee, v51
    v_mfma_f32_16x16x32_bf16 v[184:187], a[136:139], v[72:75], v[184:187]
    s_add_u32 m0, s35, 10240
    s_add_u32 s33, s33, 131072
    buffer_load_dwordx4 v234, s[48:51], s33 offen lds
    v_mfma_f32_16x16x32_bf16 v[184:187], a[152:155], v[76:79], v[184:187]
    v_sub_f32 v16, v16, v50
    v_sub_f32 v17, v17, v50
    v_cvt_pk_bf16_f32 v17, v16, v17
    v_mfma_f32_16x16x32_bf16 v[188:191], a[140:143], v[72:75], v[188:191]
    buffer_load_dwordx4 v235, s[48:51], s33 offen offset:1024 lds
    v_lshlrev_b32_e64 v16, 16, v17
    v_mfma_f32_16x16x32_bf16 v[188:191], a[156:159], v[76:79], v[188:191]
    s_waitcnt vmcnt(31) lgkmcnt(0)
    s_barrier
    v_mfma_f32_16x16x32_bf16 v[192:195], a[128:131], v[80:83], v[192:195]
    ds_read_b128 v[64:67], v224 offset:16384
    v_and_b32 v17, 0xffff0000, v17
    v_mfma_f32_16x16x32_bf16 v[192:195], a[144:147], v[84:87], v[192:195]
    ds_read_b128 v[68:71], v225 offset:16384
    v_mul_f32_e64 v16, v16, v51
    v_mfma_f32_16x16x32_bf16 v[196:199], a[132:135], v[80:83], v[196:199]
    ds_read_b128 v[72:75], v224 offset:18432
    v_mul_f32_e64 v17, v17, v51
    v_mfma_f32_16x16x32_bf16 v[196:199], a[148:151], v[84:87], v[196:199]
    ds_read_b128 v[76:79], v225 offset:18432
    v_cvt_pk_bf16_f32 v0, v16, v17
    v_sub_f32_e64 v18, v18, v50
    v_mfma_f32_16x16x32_bf16 v[200:203], a[136:139], v[80:83], v[200:203]
    ds_read_b64_tr_b16 a[176:177], v228 offset:20480
    v_sub_f32_e64 v19, v19, v50
    v_mfma_f32_16x16x32_bf16 v[200:203], a[152:155], v[84:87], v[200:203]
    ds_read_b64_tr_b16 a[178:179], v228 offset:20992
    v_cvt_pk_bf16_f32 v19, v18, v19
    v_mfma_f32_16x16x32_bf16 v[204:207], a[140:143], v[80:83], v[204:207]
    ds_read_b64_tr_b16 a[180:181], v229 offset:20480
    v_lshlrev_b32_e64 v18, 16, v19
    v_mfma_f32_16x16x32_bf16 v[204:207], a[156:159], v[84:87], v[204:207]
    ds_read_b64_tr_b16 a[182:183], v229 offset:20992
    v_and_b32 v19, 0xffff0000, v19
    v_mfma_f32_16x16x32_bf16 v[208:211], a[128:131], v[88:91], v[208:211]
    ds_read_b64_tr_b16 a[184:185], v230 offset:20480
    s_add_u32 m0, s34, 0
    s_add_u32 s37, s80, 131072
    buffer_load_dwordx4 v232, s[44:47], s37 offen lds
    v_mfma_f32_16x16x32_bf16 v[208:211], a[144:147], v[92:95], v[208:211]
    ds_read_b64_tr_b16 a[186:187], v230 offset:20992
    v_mul_f32 v18, v18, v51
    v_mfma_f32_16x16x32_bf16 v[212:215], a[132:135], v[88:91], v[212:215]
    ds_read_b64_tr_b16 a[188:189], v231 offset:20480
    v_mul_f32_e64 v19, v19, v51
    v_cvt_pk_bf16_f32 v1, v18, v19
    v_mfma_f32_16x16x32_bf16 v[212:215], a[148:151], v[92:95], v[212:215]
    ds_read_b64_tr_b16 a[190:191], v231 offset:20992
    v_sub_f32_e64 v20, v20, v50
    v_mfma_f32_16x16x32_bf16 v[216:219], a[136:139], v[88:91], v[216:219]
    buffer_load_dwordx4 v233, s[44:47], s37 offen offset:1024 lds
    v_sub_f32_e64 v21, v21, v50
    v_mfma_f32_16x16x32_bf16 v[216:219], a[152:155], v[92:95], v[216:219]
    v_cvt_pk_bf16_f32 v21, v20, v21
    v_lshlrev_b32_e64 v20, 16, v21
    v_mfma_f32_16x16x32_bf16 v[220:223], a[140:143], v[88:91], v[220:223]
    v_and_b32 v21, 0xffff0000, v21
    v_mul_f32 v20, v20, v51
    v_mul_f32 v21, v21, v51
    v_mfma_f32_16x16x32_bf16 v[220:223], a[156:159], v[92:95], v[220:223]
    v_cvt_pk_bf16_f32 v2, v20, v21
    s_waitcnt lgkmcnt(0)
    v_mfma_f32_16x16x32_bf16 v[96:99], a[160:163], v[64:67], v[96:99]
    ds_read_b128 v[80:83], v224 offset:20480
    v_sub_f32 v22, v22, v50
    v_mfma_f32_16x16x32_bf16 v[96:99], a[176:179], v[68:71], v[96:99]
    ds_read_b128 v[84:87], v225 offset:20480
    v_sub_f32_e64 v23, v23, v50
    v_mfma_f32_16x16x32_bf16 v[100:103], a[164:167], v[64:67], v[100:103]
    ds_read_b128 v[88:91], v224 offset:22528
    v_cvt_pk_bf16_f32 v23, v22, v23
    v_mfma_f32_16x16x32_bf16 v[100:103], a[180:183], v[68:71], v[100:103]
    ds_read_b128 v[92:95], v225 offset:22528
    v_lshlrev_b32_e64 v22, 16, v23
    v_and_b32 v23, 0xffff0000, v23
    v_mfma_f32_16x16x32_bf16 v[104:107], a[168:171], v[64:67], v[104:107]
    v_mul_f32 v22, v22, v51
    v_mul_f32 v23, v23, v51
    v_mfma_f32_16x16x32_bf16 v[104:107], a[184:187], v[68:71], v[104:107]
    v_cvt_pk_bf16_f32 v3, v22, v23
    v_sub_f32_e64 v24, v24, v50
    v_mfma_f32_16x16x32_bf16 v[108:111], a[172:175], v[64:67], v[108:111]
    v_sub_f32_e64 v25, v25, v50
    v_cvt_pk_bf16_f32 v25, v24, v25
    v_lshlrev_b32_e64 v24, 16, v25
    v_mfma_f32_16x16x32_bf16 v[108:111], a[188:191], v[68:71], v[108:111]
    v_and_b32 v25, 0xffff0000, v25
    v_mul_f32_e64 v24, v24, v51
    v_mfma_f32_16x16x32_bf16 v[112:115], a[160:163], v[72:75], v[112:115]
    s_add_u32 m0, s35, 12288
    s_add_u32 s33, s33, 131072
    buffer_load_dwordx4 v234, s[48:51], s33 offen lds
    v_mfma_f32_16x16x32_bf16 v[112:115], a[176:179], v[76:79], v[112:115]
    v_mul_f32_e64 v25, v25, v51
    v_cvt_pk_bf16_f32 v4, v24, v25
    v_mfma_f32_16x16x32_bf16 v[116:119], a[164:167], v[72:75], v[116:119]
    buffer_load_dwordx4 v235, s[48:51], s33 offen offset:1024 lds
    v_sub_f32 v26, v26, v50
    v_sub_f32 v27, v27, v50
    v_mfma_f32_16x16x32_bf16 v[116:119], a[180:183], v[76:79], v[116:119]
    v_cvt_pk_bf16_f32 v27, v26, v27
    v_lshlrev_b32_e64 v26, 16, v27
    v_mfma_f32_16x16x32_bf16 v[120:123], a[168:171], v[72:75], v[120:123]
    s_add_u32 m0, s35, 14336
    s_add_u32 s33, s33, 131072
    buffer_load_dwordx4 v234, s[48:51], s33 offen lds
    v_mfma_f32_16x16x32_bf16 v[120:123], a[184:187], v[76:79], v[120:123]
    v_and_b32 v27, 0xffff0000, v27
    v_mul_f32_e64 v26, v26, v51
    v_mfma_f32_16x16x32_bf16 v[124:127], a[172:175], v[72:75], v[124:127]
    buffer_load_dwordx4 v235, s[48:51], s33 offen offset:1024 lds
    v_mul_f32_e64 v27, v27, v51
    v_cvt_pk_bf16_f32 v5, v26, v27
    v_mfma_f32_16x16x32_bf16 v[124:127], a[188:191], v[76:79], v[124:127]
    v_sub_f32 v28, v28, v50
    s_waitcnt lgkmcnt(0)
    v_mfma_f32_16x16x32_bf16 v[128:131], a[160:163], v[80:83], v[128:131]
    ds_read_b128 v[64:67], v224 offset:24576
    v_sub_f32_e64 v29, v29, v50
    v_mfma_f32_16x16x32_bf16 v[128:131], a[176:179], v[84:87], v[128:131]
    ds_read_b128 v[68:71], v225 offset:24576
    v_cvt_pk_bf16_f32 v29, v28, v29
    v_mfma_f32_16x16x32_bf16 v[132:135], a[164:167], v[80:83], v[132:135]
    ds_read_b128 v[72:75], v224 offset:26624
    v_lshlrev_b32_e64 v28, 16, v29
    v_mfma_f32_16x16x32_bf16 v[132:135], a[180:183], v[84:87], v[132:135]
    ds_read_b128 v[76:79], v225 offset:26624
    v_and_b32 v29, 0xffff0000, v29
    v_mfma_f32_16x16x32_bf16 v[136:139], a[168:171], v[80:83], v[136:139]
    v_mul_f32 v28, v28, v51
    v_mul_f32 v29, v29, v51
    v_cvt_pk_bf16_f32 v6, v28, v29
    v_mfma_f32_16x16x32_bf16 v[136:139], a[184:187], v[84:87], v[136:139]
    v_sub_f32 v30, v30, v50
    v_sub_f32 v31, v31, v50
    v_mfma_f32_16x16x32_bf16 v[140:143], a[172:175], v[80:83], v[140:143]
    v_cvt_pk_bf16_f32 v31, v30, v31
    v_lshlrev_b32_e64 v30, 16, v31
    v_and_b32 v31, 0xffff0000, v31
    v_mfma_f32_16x16x32_bf16 v[140:143], a[188:191], v[84:87], v[140:143]
    v_mul_f32 v30, v30, v51
    v_mul_f32 v31, v31, v51
    v_mfma_f32_16x16x32_bf16 v[144:147], a[160:163], v[88:91], v[144:147]
    s_add_u32 m0, s34, 8192
    s_add_u32 s37, s81, 131072
    buffer_load_dwordx4 v232, s[44:47], s37 offen lds
    v_mfma_f32_16x16x32_bf16 v[144:147], a[176:179], v[92:95], v[144:147]
    v_cvt_pk_bf16_f32 v7, v30, v31
    v_sub_f32_e64 v32, v32, v50
    v_mfma_f32_16x16x32_bf16 v[148:151], a[164:167], v[88:91], v[148:151]
    buffer_load_dwordx4 v233, s[44:47], s37 offen offset:1024 lds
    v_sub_f32_e64 v33, v33, v50
    v_mfma_f32_16x16x32_bf16 v[148:151], a[180:183], v[92:95], v[148:151]
    v_cvt_pk_bf16_f32 v33, v32, v33
    v_lshlrev_b32_e64 v32, 16, v33
    v_and_b32 v33, 0xffff0000, v33
    v_mfma_f32_16x16x32_bf16 v[152:155], a[168:171], v[88:91], v[152:155]
    v_lshlrev_b32_e64 v227, 3, v240
    v_min_u32 v227, 1920, v227
    s_lshl2_add_u32 s25, s2, s3
    v_mfma_f32_16x16x32_bf16 v[152:155], a[184:187], v[92:95], v[152:155]
    v_mul_f32 v32, v32, v51
    v_mul_f32_e64 v33, v33, v51
    v_mfma_f32_16x16x32_bf16 v[156:159], a[172:175], v[88:91], v[156:159]
    s_lshl_b32 s25, s25, 13
    s_add_u32 s25, s25, 4096
    buffer_load_dword v241, v227, s[12:15], s25 offen
    v_mfma_f32_16x16x32_bf16 v[156:159], a[188:191], v[92:95], v[156:159]
    v_cvt_pk_bf16_f32 v8, v32, v33
    s_waitcnt vmcnt(16) lgkmcnt(0)
    v_mfma_f32_16x16x32_bf16 v[160:163], a[160:163], v[64:67], v[160:163]
    ds_read_b128 v[80:83], v224 offset:28672
    v_sub_f32 v34, v34, v50
    v_sub_f32 v35, v35, v50
    v_mfma_f32_16x16x32_bf16 v[160:163], a[176:179], v[68:71], v[160:163]
    ds_read_b128 v[84:87], v225 offset:28672
    v_cvt_pk_bf16_f32 v35, v34, v35
    v_mfma_f32_16x16x32_bf16 v[164:167], a[164:167], v[64:67], v[164:167]
    ds_read_b128 v[88:91], v224 offset:30720
    v_lshlrev_b32_e64 v34, 16, v35
    v_mfma_f32_16x16x32_bf16 v[164:167], a[180:183], v[68:71], v[164:167]
    ds_read_b128 v[92:95], v225 offset:30720
    v_and_b32 v35, 0xffff0000, v35
    v_mfma_f32_16x16x32_bf16 v[168:171], a[168:171], v[64:67], v[168:171]
    ds_read_b64_tr_b16 a[192:193], v228 offset:0
    v_mul_f32_e64 v34, v34, v51
    v_mfma_f32_16x16x32_bf16 v[168:171], a[184:187], v[68:71], v[168:171]
    ds_read_b64_tr_b16 a[194:195], v228 offset:512
    v_mul_f32_e64 v35, v35, v51
    v_cvt_pk_bf16_f32 v9, v34, v35
    v_mfma_f32_16x16x32_bf16 v[172:175], a[172:175], v[64:67], v[172:175]
    ds_read_b64_tr_b16 a[196:197], v229 offset:0
    v_sub_f32_e64 v36, v36, v50
    v_mfma_f32_16x16x32_bf16 v[172:175], a[188:191], v[68:71], v[172:175]
    ds_read_b64_tr_b16 a[198:199], v229 offset:512
    v_sub_f32_e64 v37, v37, v50
    v_mfma_f32_16x16x32_bf16 v[176:179], a[160:163], v[72:75], v[176:179]
    ds_read_b64_tr_b16 a[200:201], v230 offset:0
    v_cvt_pk_bf16_f32 v37, v36, v37
    v_mfma_f32_16x16x32_bf16 v[176:179], a[176:179], v[76:79], v[176:179]
    ds_read_b64_tr_b16 a[202:203], v230 offset:512
    v_lshlrev_b32_e64 v36, 16, v37
    v_mfma_f32_16x16x32_bf16 v[180:183], a[164:167], v[72:75], v[180:183]
    ds_read_b64_tr_b16 a[204:205], v231 offset:0
    v_and_b32 v37, 0xffff0000, v37
    v_mfma_f32_16x16x32_bf16 v[180:183], a[180:183], v[76:79], v[180:183]
    ds_read_b64_tr_b16 a[206:207], v231 offset:512
    v_mul_f32 v36, v36, v51
    v_mul_f32 v37, v37, v51
    v_mfma_f32_16x16x32_bf16 v[184:187], a[168:171], v[72:75], v[184:187]
    v_cvt_pk_bf16_f32 v10, v36, v37
    v_sub_f32_e64 v38, v38, v50
    v_mfma_f32_16x16x32_bf16 v[184:187], a[184:187], v[76:79], v[184:187]
    v_sub_f32_e64 v39, v39, v50
    v_cvt_pk_bf16_f32 v39, v38, v39
    v_mfma_f32_16x16x32_bf16 v[188:191], a[172:175], v[72:75], v[188:191]
    v_lshlrev_b32_e64 v38, 16, v39
    v_and_b32 v39, 0xffff0000, v39
    v_mul_f32_e64 v38, v38, v51
    v_mfma_f32_16x16x32_bf16 v[188:191], a[188:191], v[76:79], v[188:191]
    s_waitcnt vmcnt(27) lgkmcnt(0)
    s_barrier
    v_mfma_f32_16x16x32_bf16 v[192:195], a[160:163], v[80:83], v[192:195]
    ds_read_b128 v[64:67], v224 offset:32768
    v_mul_f32_e64 v39, v39, v51
    v_mfma_f32_16x16x32_bf16 v[192:195], a[176:179], v[84:87], v[192:195]
    ds_read_b128 v[68:71], v225 offset:32768
    v_cvt_pk_bf16_f32 v11, v38, v39
    v_mfma_f32_16x16x32_bf16 v[196:199], a[164:167], v[80:83], v[196:199]
    ds_read_b128 v[72:75], v224 offset:34816
    v_sub_f32_e64 v40, v40, v50
    v_mfma_f32_16x16x32_bf16 v[196:199], a[180:183], v[84:87], v[196:199]
    ds_read_b128 v[76:79], v225 offset:34816
    v_sub_f32_e64 v41, v41, v50
    v_mfma_f32_16x16x32_bf16 v[200:203], a[168:171], v[80:83], v[200:203]
    ds_read_b64_tr_b16 a[208:209], v228 offset:4096
    v_cvt_pk_bf16_f32 v41, v40, v41
    v_lshlrev_b32_e64 v40, 16, v41
    v_mfma_f32_16x16x32_bf16 v[200:203], a[184:187], v[84:87], v[200:203]
    ds_read_b64_tr_b16 a[210:211], v228 offset:4608
    v_and_b32 v41, 0xffff0000, v41
    v_mfma_f32_16x16x32_bf16 v[204:207], a[172:175], v[80:83], v[204:207]
    ds_read_b64_tr_b16 a[212:213], v229 offset:4096
    v_mul_f32_e64 v40, v40, v51
    v_mfma_f32_16x16x32_bf16 v[204:207], a[188:191], v[84:87], v[204:207]
    ds_read_b64_tr_b16 a[214:215], v229 offset:4608
    v_mul_f32_e64 v41, v41, v51
    v_mfma_f32_16x16x32_bf16 v[208:211], a[160:163], v[88:91], v[208:211]
    ds_read_b64_tr_b16 a[216:217], v230 offset:4096
    s_add_u32 m0, s34, 16384
    s_add_u32 s37, s82, 131072
    buffer_load_dwordx4 v232, s[44:47], s37 offen lds
    v_mfma_f32_16x16x32_bf16 v[208:211], a[176:179], v[92:95], v[208:211]
    ds_read_b64_tr_b16 a[218:219], v230 offset:4608
    v_cvt_pk_bf16_f32 v12, v40, v41
    v_mfma_f32_16x16x32_bf16 v[212:215], a[164:167], v[88:91], v[212:215]
    ds_read_b64_tr_b16 a[220:221], v231 offset:4096
    v_sub_f32 v42, v42, v50
    v_sub_f32 v43, v43, v50
    v_mfma_f32_16x16x32_bf16 v[212:215], a[180:183], v[92:95], v[212:215]
    ds_read_b64_tr_b16 a[222:223], v231 offset:4608
    v_cvt_pk_bf16_f32 v43, v42, v43
    v_mfma_f32_16x16x32_bf16 v[216:219], a[168:171], v[88:91], v[216:219]
    buffer_load_dwordx4 v233, s[44:47], s37 offen offset:1024 lds
    v_lshlrev_b32_e64 v42, 16, v43
    v_mfma_f32_16x16x32_bf16 v[216:219], a[184:187], v[92:95], v[216:219]
    v_and_b32 v43, 0xffff0000, v43
    v_mul_f32_e64 v42, v42, v51
    v_mfma_f32_16x16x32_bf16 v[220:223], a[172:175], v[88:91], v[220:223]
    v_mul_f32_e64 v43, v43, v51
    v_cvt_pk_bf16_f32 v13, v42, v43
    v_sub_f32_e64 v44, v44, v50
    v_mfma_f32_16x16x32_bf16 v[220:223], a[188:191], v[92:95], v[220:223]
    v_sub_f32 v45, v45, v50
    s_waitcnt lgkmcnt(0)
    v_mfma_f32_16x16x32_bf16 v[96:99], a[192:195], v[64:67], v[96:99]
    ds_read_b128 v[80:83], v224 offset:36864
    v_cvt_pk_bf16_f32 v45, v44, v45
    v_mfma_f32_16x16x32_bf16 v[96:99], a[208:211], v[68:71], v[96:99]
    ds_read_b128 v[84:87], v225 offset:36864
    v_lshlrev_b32_e64 v44, 16, v45
    v_mfma_f32_16x16x32_bf16 v[100:103], a[196:199], v[64:67], v[100:103]
    ds_read_b128 v[88:91], v224 offset:38912
    v_and_b32 v45, 0xffff0000, v45
    v_mfma_f32_16x16x32_bf16 v[100:103], a[212:215], v[68:71], v[100:103]
    ds_read_b128 v[92:95], v225 offset:38912
    v_mul_f32 v44, v44, v51
    v_mul_f32 v45, v45, v51
    v_mfma_f32_16x16x32_bf16 v[104:107], a[200:203], v[64:67], v[104:107]
    v_cvt_pk_bf16_f32 v14, v44, v45
    v_sub_f32_e64 v46, v46, v50
    v_mfma_f32_16x16x32_bf16 v[104:107], a[216:219], v[68:71], v[104:107]
    v_sub_f32_e64 v47, v47, v50
    v_cvt_pk_bf16_f32 v47, v46, v47
    v_mfma_f32_16x16x32_bf16 v[108:111], a[204:207], v[64:67], v[108:111]
    v_lshlrev_b32_e64 v46, 16, v47
    v_and_b32 v47, 0xffff0000, v47
    v_mul_f32_e64 v46, v46, v51
    v_mfma_f32_16x16x32_bf16 v[108:111], a[220:223], v[68:71], v[108:111]
    v_mul_f32_e64 v47, v47, v51
    v_cvt_pk_bf16_f32 v15, v46, v47
    v_mfma_f32_16x16x32_bf16 v[112:115], a[192:195], v[72:75], v[112:115]
    v_mfma_f32_16x16x32_bf16 v[112:115], a[208:211], v[76:79], v[112:115]
    ds_write_b128 v237, v[0:3] offset:0
    v_mfma_f32_16x16x32_bf16 v[116:119], a[196:199], v[72:75], v[116:119]
    ds_write_b128 v237, v[4:7] offset:4096
    v_mfma_f32_16x16x32_bf16 v[116:119], a[212:215], v[76:79], v[116:119]
    ds_write_b128 v237, v[8:11] offset:24576
    v_mfma_f32_16x16x32_bf16 v[120:123], a[200:203], v[72:75], v[120:123]
    ds_write_b128 v237, v[12:15] offset:28672
    v_mfma_f32_16x16x32_bf16 v[120:123], a[216:219], v[76:79], v[120:123]
    v_mfma_f32_16x16x32_bf16 v[124:127], a[204:207], v[72:75], v[124:127]
    v_mfma_f32_16x16x32_bf16 v[124:127], a[220:223], v[76:79], v[124:127]
    s_waitcnt lgkmcnt(0)
    v_mfma_f32_16x16x32_bf16 v[128:131], a[192:195], v[80:83], v[128:131]
    ds_read_b128 v[64:67], v224 offset:40960
    v_mfma_f32_16x16x32_bf16 v[128:131], a[208:211], v[84:87], v[128:131]
    ds_read_b128 v[68:71], v225 offset:40960
    v_mfma_f32_16x16x32_bf16 v[132:135], a[196:199], v[80:83], v[132:135]
    ds_read_b128 v[72:75], v224 offset:43008
    v_mfma_f32_16x16x32_bf16 v[132:135], a[212:215], v[84:87], v[132:135]
    ds_read_b128 v[76:79], v225 offset:43008
    v_mfma_f32_16x16x32_bf16 v[136:139], a[200:203], v[80:83], v[136:139]
    v_mfma_f32_16x16x32_bf16 v[136:139], a[216:219], v[84:87], v[136:139]
    v_mfma_f32_16x16x32_bf16 v[140:143], a[204:207], v[80:83], v[140:143]
    v_mfma_f32_16x16x32_bf16 v[140:143], a[220:223], v[84:87], v[140:143]
    v_mfma_f32_16x16x32_bf16 v[144:147], a[192:195], v[88:91], v[144:147]
    s_add_u32 m0, s34, 24576
    s_add_u32 s37, s83, 131072
    buffer_load_dwordx4 v232, s[44:47], s37 offen lds
    v_mfma_f32_16x16x32_bf16 v[144:147], a[208:211], v[92:95], v[144:147]
    buffer_load_dwordx4 v233, s[44:47], s37 offen offset:1024 lds
    v_mfma_f32_16x16x32_bf16 v[148:151], a[196:199], v[88:91], v[148:151]
    v_mfma_f32_16x16x32_bf16 v[148:151], a[212:215], v[92:95], v[148:151]
    v_lshlrev_b32 v227, 3, v240
    v_min_u32 v227, 1920, v227
    s_lshl2_add_u32 s25, s2, s3
    v_mfma_f32_16x16x32_bf16 v[152:155], a[200:203], v[88:91], v[152:155]
    s_lshl_b32 s25, s25, 13
    s_add_u32 s25, s25, 6144
    buffer_load_dword v241, v227, s[12:15], s25 offen
    v_mfma_f32_16x16x32_bf16 v[152:155], a[216:219], v[92:95], v[152:155]
    v_mfma_f32_16x16x32_bf16 v[156:159], a[204:207], v[88:91], v[156:159]
    buffer_load_dword v254, off, s[88:91], s97 sc1
    v_mfma_f32_16x16x32_bf16 v[156:159], a[220:223], v[92:95], v[156:159]
    s_waitcnt vmcnt(9) lgkmcnt(0)
    v_mfma_f32_16x16x32_bf16 v[160:163], a[192:195], v[64:67], v[160:163]
    ds_read_b128 v[80:83], v224 offset:45056
    v_mfma_f32_16x16x32_bf16 v[160:163], a[208:211], v[68:71], v[160:163]
    ds_read_b128 v[84:87], v225 offset:45056
    s_mul_i32 s38, s2, 100
    v_mfma_f32_16x16x32_bf16 v[164:167], a[196:199], v[64:67], v[164:167]
    ds_read_b128 v[88:91], v224 offset:47104
    v_mfma_f32_16x16x32_bf16 v[164:167], a[212:215], v[68:71], v[164:167]
    ds_read_b128 v[92:95], v225 offset:47104
    v_lshl_add_u32 v60, v253, 2, s38
    v_mfma_f32_16x16x32_bf16 v[168:171], a[200:203], v[64:67], v[168:171]
    ds_read_b64_tr_b16 a[224:225], v228 offset:8192
    v_mfma_f32_16x16x32_bf16 v[168:171], a[216:219], v[68:71], v[168:171]
    ds_read_b64_tr_b16 a[226:227], v228 offset:8704
    v_cmp_gt_u32 vcc, 25, v253
    v_mfma_f32_16x16x32_bf16 v[172:175], a[204:207], v[64:67], v[172:175]
    ds_read_b64_tr_b16 a[228:229], v229 offset:8192
    v_mfma_f32_16x16x32_bf16 v[172:175], a[220:223], v[68:71], v[172:175]
    ds_read_b64_tr_b16 a[230:231], v229 offset:8704
    v_mov_b32_e64 v61, 0
    v_mfma_f32_16x16x32_bf16 v[176:179], a[192:195], v[72:75], v[176:179]
    ds_read_b64_tr_b16 a[232:233], v230 offset:8192
    v_mfma_f32_16x16x32_bf16 v[176:179], a[208:211], v[76:79], v[176:179]
    ds_read_b64_tr_b16 a[234:235], v230 offset:8704
    v_mfma_f32_16x16x32_bf16 v[180:183], a[196:199], v[72:75], v[180:183]
    ds_read_b64_tr_b16 a[236:237], v231 offset:8192
    v_mov_b32 v62, 0x7ffffff0
    v_mfma_f32_16x16x32_bf16 v[180:183], a[212:215], v[76:79], v[180:183]
    ds_read_b64_tr_b16 a[238:239], v231 offset:8704
    v_mfma_f32_16x16x32_bf16 v[184:187], a[200:203], v[72:75], v[184:187]
    v_cndmask_b32 v60, v62, v60, vcc
    v_mfma_f32_16x16x32_bf16 v[184:187], a[216:219], v[76:79], v[184:187]
    buffer_store_dword v61, v60, s[56:59], 0 offen sc1
    v_mfma_f32_16x16x32_bf16 v[188:191], a[204:207], v[72:75], v[188:191]
    v_mfma_f32_16x16x32_bf16 v[188:191], a[220:223], v[76:79], v[188:191]
    s_waitcnt vmcnt(21) lgkmcnt(0)
    s_barrier
    v_mfma_f32_16x16x32_bf16 v[192:195], a[192:195], v[80:83], v[192:195]
    ds_read_b128 v[64:67], v224 offset:49152
    v_mfma_f32_16x16x32_bf16 v[192:195], a[208:211], v[84:87], v[192:195]
    ds_read_b128 v[68:71], v225 offset:49152
    v_mfma_f32_16x16x32_bf16 v[196:199], a[196:199], v[80:83], v[196:199]
    ds_read_b128 v[72:75], v224 offset:51200
    v_mfma_f32_16x16x32_bf16 v[196:199], a[212:215], v[84:87], v[196:199]
    ds_read_b128 v[76:79], v225 offset:51200
    v_mfma_f32_16x16x32_bf16 v[200:203], a[200:203], v[80:83], v[200:203]
    ds_read_b64_tr_b16 a[240:241], v228 offset:12288
    v_mfma_f32_16x16x32_bf16 v[200:203], a[216:219], v[84:87], v[200:203]
    ds_read_b64_tr_b16 a[242:243], v228 offset:12800
    v_mfma_f32_16x16x32_bf16 v[204:207], a[204:207], v[80:83], v[204:207]
    ds_read_b64_tr_b16 a[244:245], v229 offset:12288
    v_mfma_f32_16x16x32_bf16 v[204:207], a[220:223], v[84:87], v[204:207]
    ds_read_b64_tr_b16 a[246:247], v229 offset:12800
    v_mfma_f32_16x16x32_bf16 v[208:211], a[192:195], v[88:91], v[208:211]
    ds_read_b64_tr_b16 a[248:249], v230 offset:12288
    v_lshlrev_b32 v237, 4, v253
    v_add_u32 v237, 81920, v237
    ds_read_b128 v[16:19], v237 offset:0
    ds_read_b128 v[20:23], v237 offset:4096
    ds_read_b128 v[24:27], v237 offset:24576
    ds_read_b128 v[28:31], v237 offset:28672
    s_add_u32 m0, s34, 32768
    s_add_u32 s37, s84, 131072
    buffer_load_dwordx4 v232, s[44:47], s37 offen lds
    v_mfma_f32_16x16x32_bf16 v[208:211], a[208:211], v[92:95], v[208:211]
    ds_read_b64_tr_b16 a[250:251], v230 offset:12800
    v_mfma_f32_16x16x32_bf16 v[212:215], a[196:199], v[88:91], v[212:215]
    ds_read_b64_tr_b16 a[252:253], v231 offset:12288
    v_mfma_f32_16x16x32_bf16 v[212:215], a[212:215], v[92:95], v[212:215]
    ds_read_b64_tr_b16 a[254:255], v231 offset:12800
    v_mfma_f32_16x16x32_bf16 v[216:219], a[200:203], v[88:91], v[216:219]
    buffer_load_dwordx4 v233, s[44:47], s37 offen offset:1024 lds
    v_mfma_f32_16x16x32_bf16 v[216:219], a[216:219], v[92:95], v[216:219]
    v_mfma_f32_16x16x32_bf16 v[220:223], a[204:207], v[88:91], v[220:223]
    v_mfma_f32_16x16x32_bf16 v[220:223], a[220:223], v[92:95], v[220:223]
    s_waitcnt lgkmcnt(0)
    v_mfma_f32_16x16x32_bf16 v[96:99], a[224:227], v[64:67], v[96:99]
    ds_read_b128 v[80:83], v224 offset:53248
    v_mfma_f32_16x16x32_bf16 v[96:99], a[240:243], v[68:71], v[96:99]
    ds_read_b128 v[84:87], v225 offset:53248
    v_mfma_f32_16x16x32_bf16 v[100:103], a[228:231], v[64:67], v[100:103]
    ds_read_b128 v[88:91], v224 offset:55296
    v_mfma_f32_16x16x32_bf16 v[100:103], a[244:247], v[68:71], v[100:103]
    ds_read_b128 v[92:95], v225 offset:55296
    v_mfma_f32_16x16x32_bf16 v[104:107], a[232:235], v[64:67], v[104:107]
    v_mfma_f32_16x16x32_bf16 v[104:107], a[248:251], v[68:71], v[104:107]
    s_mov_b32 s39, 0
    buffer_store_dwordx4 v[16:19], v238, s[8:11], s39 offen sc1
    v_mfma_f32_16x16x32_bf16 v[108:111], a[236:239], v[64:67], v[108:111]
    v_mfma_f32_16x16x32_bf16 v[108:111], a[252:255], v[68:71], v[108:111]
    v_mfma_f32_16x16x32_bf16 v[112:115], a[224:227], v[72:75], v[112:115]
    v_mfma_f32_16x16x32_bf16 v[112:115], a[240:243], v[76:79], v[112:115]
    v_mfma_f32_16x16x32_bf16 v[116:119], a[228:231], v[72:75], v[116:119]
    v_mfma_f32_16x16x32_bf16 v[116:119], a[244:247], v[76:79], v[116:119]
    v_mfma_f32_16x16x32_bf16 v[120:123], a[232:235], v[72:75], v[120:123]
    v_mfma_f32_16x16x32_bf16 v[120:123], a[248:251], v[76:79], v[120:123]
    s_mov_b32 s39, 8192
    buffer_store_dwordx4 v[20:23], v238, s[8:11], s39 offen sc1
    v_mfma_f32_16x16x32_bf16 v[124:127], a[236:239], v[72:75], v[124:127]
    v_mfma_f32_16x16x32_bf16 v[124:127], a[252:255], v[76:79], v[124:127]
    s_waitcnt lgkmcnt(0)
    v_mfma_f32_16x16x32_bf16 v[128:131], a[224:227], v[80:83], v[128:131]
    ds_read_b128 v[64:67], v224 offset:57344
    v_mfma_f32_16x16x32_bf16 v[128:131], a[240:243], v[84:87], v[128:131]
    ds_read_b128 v[68:71], v225 offset:57344
    v_mfma_f32_16x16x32_bf16 v[132:135], a[228:231], v[80:83], v[132:135]
    ds_read_b128 v[72:75], v224 offset:59392
    v_mfma_f32_16x16x32_bf16 v[132:135], a[244:247], v[84:87], v[132:135]
    ds_read_b128 v[76:79], v225 offset:59392
    v_mfma_f32_16x16x32_bf16 v[136:139], a[232:235], v[80:83], v[136:139]
    v_mfma_f32_16x16x32_bf16 v[136:139], a[248:251], v[84:87], v[136:139]
    s_mov_b32 s39, 16384
    buffer_store_dwordx4 v[24:27], v238, s[8:11], s39 offen sc1
    v_mfma_f32_16x16x32_bf16 v[140:143], a[236:239], v[80:83], v[140:143]
    v_mfma_f32_16x16x32_bf16 v[140:143], a[252:255], v[84:87], v[140:143]
    v_mfma_f32_16x16x32_bf16 v[144:147], a[224:227], v[88:91], v[144:147]
    s_add_u32 m0, s34, 40960
    s_add_u32 s37, s85, 131072
    buffer_load_dwordx4 v232, s[44:47], s37 offen lds
    v_mfma_f32_16x16x32_bf16 v[144:147], a[240:243], v[92:95], v[144:147]
    v_mfma_f32_16x16x32_bf16 v[148:151], a[228:231], v[88:91], v[148:151]
    v_mfma_f32_16x16x32_bf16 v[148:151], a[244:247], v[92:95], v[148:151]
    v_mfma_f32_16x16x32_bf16 v[152:155], a[232:235], v[88:91], v[152:155]
    buffer_load_dwordx4 v233, s[44:47], s37 offen offset:1024 lds
    v_mfma_f32_16x16x32_bf16 v[152:155], a[248:251], v[92:95], v[152:155]
    s_mov_b32 s39, 24576
    buffer_store_dwordx4 v[28:31], v238, s[8:11], s39 offen sc1
    v_mfma_f32_16x16x32_bf16 v[156:159], a[236:239], v[88:91], v[156:159]
    v_mfma_f32_16x16x32_bf16 v[156:159], a[252:255], v[92:95], v[156:159]
    s_waitcnt lgkmcnt(0)
    v_mfma_f32_16x16x32_bf16 v[160:163], a[224:227], v[64:67], v[160:163]
    ds_read_b128 v[80:83], v224 offset:61440
    v_mfma_f32_16x16x32_bf16 v[160:163], a[240:243], v[68:71], v[160:163]
    ds_read_b128 v[84:87], v225 offset:61440
    v_mfma_f32_16x16x32_bf16 v[164:167], a[228:231], v[64:67], v[164:167]
    ds_read_b128 v[88:91], v224 offset:63488
    v_mfma_f32_16x16x32_bf16 v[164:167], a[244:247], v[68:71], v[164:167]
    ds_read_b128 v[92:95], v225 offset:63488
    v_mfma_f32_16x16x32_bf16 v[168:171], a[232:235], v[64:67], v[168:171]
    v_mfma_f32_16x16x32_bf16 v[168:171], a[248:251], v[68:71], v[168:171]
    v_mfma_f32_16x16x32_bf16 v[172:175], a[236:239], v[64:67], v[172:175]
    v_mfma_f32_16x16x32_bf16 v[172:175], a[252:255], v[68:71], v[172:175]
    v_mfma_f32_16x16x32_bf16 v[176:179], a[224:227], v[72:75], v[176:179]
    v_mfma_f32_16x16x32_bf16 v[176:179], a[240:243], v[76:79], v[176:179]
    v_cvt_pk_bf16_f32 v0, v96, v97
    v_cvt_pk_bf16_f32 v1, v98, v99
    v_mfma_f32_16x16x32_bf16 v[180:183], a[228:231], v[72:75], v[180:183]
    v_cvt_pk_bf16_f32 v2, v100, v101
    v_cvt_pk_bf16_f32 v3, v102, v103
    v_mfma_f32_16x16x32_bf16 v[180:183], a[244:247], v[76:79], v[180:183]
    v_cvt_pk_bf16_f32 v4, v104, v105
    v_cvt_pk_bf16_f32 v5, v106, v107
    v_mfma_f32_16x16x32_bf16 v[184:187], a[232:235], v[72:75], v[184:187]
    v_cvt_pk_bf16_f32 v6, v108, v109
    v_cvt_pk_bf16_f32 v7, v110, v111
    v_mfma_f32_16x16x32_bf16 v[184:187], a[248:251], v[76:79], v[184:187]
    v_cvt_pk_bf16_f32 v8, v112, v113
    v_cvt_pk_bf16_f32 v9, v114, v115
    v_mfma_f32_16x16x32_bf16 v[188:191], a[236:239], v[72:75], v[188:191]
    v_cvt_pk_bf16_f32 v10, v116, v117
    v_cvt_pk_bf16_f32 v11, v118, v119
    v_mfma_f32_16x16x32_bf16 v[188:191], a[252:255], v[76:79], v[188:191]
    v_cvt_pk_bf16_f32 v12, v120, v121
    v_cvt_pk_bf16_f32 v13, v122, v123
    s_waitcnt vmcnt(16) lgkmcnt(0)
    s_barrier
    v_mfma_f32_16x16x32_bf16 v[192:195], a[224:227], v[80:83], v[192:195]
    ds_read_b128 v[64:67], v224 offset:0
    v_cvt_pk_bf16_f32 v14, v124, v125
    v_cvt_pk_bf16_f32 v15, v126, v127
    v_mfma_f32_16x16x32_bf16 v[192:195], a[240:243], v[84:87], v[192:195]
    ds_read_b128 v[68:71], v225 offset:0
    v_cvt_pk_bf16_f32 v16, v128, v129
    v_cvt_pk_bf16_f32 v17, v130, v131
    v_mfma_f32_16x16x32_bf16 v[196:199], a[228:231], v[80:83], v[196:199]
    ds_read_b128 v[72:75], v224 offset:8192
    v_cvt_pk_bf16_f32 v18, v132, v133
    v_cvt_pk_bf16_f32 v19, v134, v135
    v_mfma_f32_16x16x32_bf16 v[196:199], a[244:247], v[84:87], v[196:199]
    ds_read_b128 v[76:79], v225 offset:8192
    v_cvt_pk_bf16_f32 v20, v136, v137
    v_cvt_pk_bf16_f32 v21, v138, v139
    v_mfma_f32_16x16x32_bf16 v[200:203], a[232:235], v[80:83], v[200:203]
    v_cvt_pk_bf16_f32 v22, v140, v141
    v_cvt_pk_bf16_f32 v23, v142, v143
    v_mfma_f32_16x16x32_bf16 v[200:203], a[248:251], v[84:87], v[200:203]
    v_cvt_pk_bf16_f32 v24, v144, v145
    v_cvt_pk_bf16_f32 v25, v146, v147
    v_mfma_f32_16x16x32_bf16 v[204:207], a[236:239], v[80:83], v[204:207]
    v_cvt_pk_bf16_f32 v26, v148, v149
    v_cvt_pk_bf16_f32 v27, v150, v151
    v_mfma_f32_16x16x32_bf16 v[204:207], a[252:255], v[84:87], v[204:207]
    v_cvt_pk_bf16_f32 v28, v152, v153
    v_cvt_pk_bf16_f32 v29, v154, v155
    v_mfma_f32_16x16x32_bf16 v[208:211], a[224:227], v[88:91], v[208:211]
    s_add_u32 m0, s34, 49152
    s_add_u32 s37, s86, 131072
    buffer_load_dwordx4 v232, s[44:47], s37 offen lds
    v_cvt_pk_bf16_f32 v30, v156, v157
    v_cvt_pk_bf16_f32 v31, v158, v159
    v_mfma_f32_16x16x32_bf16 v[208:211], a[240:243], v[92:95], v[208:211]
    v_cvt_pk_bf16_f32 v32, v160, v161
    v_cvt_pk_bf16_f32 v33, v162, v163
    v_mfma_f32_16x16x32_bf16 v[212:215], a[228:231], v[88:91], v[212:215]
    v_cvt_pk_bf16_f32 v34, v164, v165
    v_cvt_pk_bf16_f32 v35, v166, v167
    v_mfma_f32_16x16x32_bf16 v[212:215], a[244:247], v[92:95], v[212:215]
    v_cvt_pk_bf16_f32 v36, v168, v169
    v_cvt_pk_bf16_f32 v37, v170, v171
    v_mfma_f32_16x16x32_bf16 v[216:219], a[232:235], v[88:91], v[216:219]
    buffer_load_dwordx4 v233, s[44:47], s37 offen offset:1024 lds
    v_cvt_pk_bf16_f32 v38, v172, v173
    v_cvt_pk_bf16_f32 v39, v174, v175
    v_mfma_f32_16x16x32_bf16 v[216:219], a[248:251], v[92:95], v[216:219]
    v_cvt_pk_bf16_f32 v40, v176, v177
    v_cvt_pk_bf16_f32 v41, v178, v179
    v_mfma_f32_16x16x32_bf16 v[220:223], a[236:239], v[88:91], v[220:223]
    v_cvt_pk_bf16_f32 v42, v180, v181
    v_cvt_pk_bf16_f32 v43, v182, v183
    v_mfma_f32_16x16x32_bf16 v[220:223], a[252:255], v[92:95], v[220:223]
    v_cvt_pk_bf16_f32 v44, v184, v185
    v_cvt_pk_bf16_f32 v45, v186, v187
    s_waitcnt lgkmcnt(0)
    v_mfma_f32_16x16x32_bf16 v[96:99], a[0:3], v[64:67], 0
    ds_read_b128 v[80:83], v224 offset:2048
    v_cvt_pk_bf16_f32 v46, v188, v189
    v_cvt_pk_bf16_f32 v47, v190, v191
    v_mfma_f32_16x16x32_bf16 v[96:99], a[16:19], v[68:71], v[96:99]
    ds_read_b128 v[84:87], v225 offset:2048
    v_cvt_pk_bf16_f32 v48, v192, v193
    v_cvt_pk_bf16_f32 v49, v194, v195
    v_mfma_f32_16x16x32_bf16 v[96:99], a[32:35], v[72:75], v[96:99]
    ds_read_b128 v[88:91], v224 offset:10240
    v_cvt_pk_bf16_f32 v50, v196, v197
    v_cvt_pk_bf16_f32 v51, v198, v199
    v_mfma_f32_16x16x32_bf16 v[96:99], a[48:51], v[76:79], v[96:99]
    ds_read_b128 v[92:95], v225 offset:10240
    v_cvt_pk_bf16_f32 v52, v200, v201
    v_cvt_pk_bf16_f32 v53, v202, v203
    v_mfma_f32_16x16x32_bf16 v[100:103], a[4:7], v[64:67], 0
    v_cvt_pk_bf16_f32 v54, v204, v205
    v_cvt_pk_bf16_f32 v55, v206, v207
    s_add_u32 s38, s36, 0
    buffer_store_dwordx4 v[0:3], v240, s[16:19], s38 offen offset:0 sc1
    v_mfma_f32_16x16x32_bf16 v[100:103], a[20:23], v[68:71], v[100:103]
    v_cvt_pk_bf16_f32 v56, v208, v209
    v_cvt_pk_bf16_f32 v57, v210, v211
    v_mfma_f32_16x16x32_bf16 v[100:103], a[36:39], v[72:75], v[100:103]
    v_cvt_pk_bf16_f32 v58, v212, v213
    v_cvt_pk_bf16_f32 v59, v214, v215
    v_mfma_f32_16x16x32_bf16 v[100:103], a[52:55], v[76:79], v[100:103]
    v_cvt_pk_bf16_f32 v60, v216, v217
    v_cvt_pk_bf16_f32 v61, v218, v219
    v_mfma_f32_16x16x32_bf16 v[104:107], a[8:11], v[64:67], 0
    v_xor_b32 v237, 16, v245
    v_xor_b32 v238, 16, v246
    v_cvt_pk_bf16_f32 v62, v220, v221
    v_cvt_pk_bf16_f32 v63, v222, v223
    v_mfma_f32_16x16x32_bf16 v[104:107], a[24:27], v[68:71], v[104:107]
    v_mfma_f32_16x16x32_bf16 v[104:107], a[40:43], v[72:75], v[104:107]
    v_mfma_f32_16x16x32_bf16 v[104:107], a[56:59], v[76:79], v[104:107]
    v_mfma_f32_16x16x32_bf16 v[108:111], a[12:15], v[64:67], 0
    v_mfma_f32_16x16x32_bf16 v[108:111], a[28:31], v[68:71], v[108:111]
    v_mfma_f32_16x16x32_bf16 v[108:111], a[44:47], v[72:75], v[108:111]
    v_mfma_f32_16x16x32_bf16 v[108:111], a[60:63], v[76:79], v[108:111]
    s_waitcnt lgkmcnt(0)
    v_mfma_f32_16x16x32_bf16 v[112:115], a[0:3], v[80:83], 0
    ds_read_b128 v[64:67], v224 offset:4096
    v_mfma_f32_16x16x32_bf16 v[112:115], a[16:19], v[84:87], v[112:115]
    ds_read_b128 v[68:71], v225 offset:4096
    v_mfma_f32_16x16x32_bf16 v[112:115], a[32:35], v[88:91], v[112:115]
    ds_read_b128 v[72:75], v224 offset:12288
    v_mfma_f32_16x16x32_bf16 v[112:115], a[48:51], v[92:95], v[112:115]
    ds_read_b128 v[76:79], v225 offset:12288
    v_mfma_f32_16x16x32_bf16 v[116:119], a[4:7], v[80:83], 0
    v_mfma_f32_16x16x32_bf16 v[116:119], a[20:23], v[84:87], v[116:119]
    v_mfma_f32_16x16x32_bf16 v[116:119], a[36:39], v[88:91], v[116:119]
    v_mfma_f32_16x16x32_bf16 v[116:119], a[52:55], v[92:95], v[116:119]
    v_mfma_f32_16x16x32_bf16 v[120:123], a[8:11], v[80:83], 0
    s_add_u32 m0, s34, 57344
    s_add_u32 s37, s87, 131072
    buffer_load_dwordx4 v232, s[44:47], s37 offen lds
    v_mfma_f32_16x16x32_bf16 v[120:123], a[24:27], v[84:87], v[120:123]
    s_add_u32 s38, s36, 0
    buffer_store_dwordx4 v[4:7], v240, s[16:19], s38 offen offset:2048 sc1
    v_mfma_f32_16x16x32_bf16 v[120:123], a[40:43], v[88:91], v[120:123]
    v_mfma_f32_16x16x32_bf16 v[120:123], a[56:59], v[92:95], v[120:123]
    v_mfma_f32_16x16x32_bf16 v[124:127], a[12:15], v[80:83], 0
    buffer_load_dwordx4 v233, s[44:47], s37 offen offset:1024 lds
    v_mfma_f32_16x16x32_bf16 v[124:127], a[28:31], v[84:87], v[124:127]
    v_mfma_f32_16x16x32_bf16 v[124:127], a[44:47], v[88:91], v[124:127]
    v_mfma_f32_16x16x32_bf16 v[124:127], a[60:63], v[92:95], v[124:127]
    s_waitcnt lgkmcnt(0)
    v_mfma_f32_16x16x32_bf16 v[128:131], a[0:3], v[64:67], 0
    ds_read_b128 v[80:83], v224 offset:6144
    v_mfma_f32_16x16x32_bf16 v[128:131], a[16:19], v[68:71], v[128:131]
    ds_read_b128 v[84:87], v225 offset:6144
    v_mfma_f32_16x16x32_bf16 v[128:131], a[32:35], v[72:75], v[128:131]
    ds_read_b128 v[88:91], v224 offset:14336
    v_mfma_f32_16x16x32_bf16 v[128:131], a[48:51], v[76:79], v[128:131]
    ds_read_b128 v[92:95], v225 offset:14336
    v_mfma_f32_16x16x32_bf16 v[132:135], a[4:7], v[64:67], 0
    v_mfma_f32_16x16x32_bf16 v[132:135], a[20:23], v[68:71], v[132:135]
    v_mfma_f32_16x16x32_bf16 v[132:135], a[36:39], v[72:75], v[132:135]
    v_mfma_f32_16x16x32_bf16 v[132:135], a[52:55], v[76:79], v[132:135]
    v_mfma_f32_16x16x32_bf16 v[136:139], a[8:11], v[64:67], 0
    s_waitcnt vmcnt(15)
    v_readfirstlane_b32 s24, v254
    s_lshl_b32 s25, s3, 16
    s_add_u32 s24, s24, s25
    s_cmp_ge_u32 s24, 1
    s_cbranch_scc0 kf_spin47
kf_spinr48:
    v_mfma_f32_16x16x32_bf16 v[136:139], a[24:27], v[68:71], v[136:139]
    v_mfma_f32_16x16x32_bf16 v[136:139], a[40:43], v[72:75], v[136:139]
    v_mfma_f32_16x16x32_bf16 v[136:139], a[56:59], v[76:79], v[136:139]
    v_mfma_f32_16x16x32_bf16 v[140:143], a[12:15], v[64:67], 0
    s_add_u32 s88, s20, 0x14a0000
    s_addc_u32 s89, s21, 0
    s_mov_b32 s90, 20480
    v_mfma_f32_16x16x32_bf16 v[140:143], a[28:31], v[68:71], v[140:143]
    v_mfma_f32_16x16x32_bf16 v[140:143], a[44:47], v[72:75], v[140:143]
    v_mfma_f32_16x16x32_bf16 v[140:143], a[60:63], v[76:79], v[140:143]
    s_add_u32 s38, s36, 0
    buffer_store_dwordx4 v[8:11], v240, s[16:19], s38 offen offset:1024 sc1
    s_waitcnt vmcnt(7) lgkmcnt(0)
    s_barrier
    v_mfma_f32_16x16x32_bf16 v[144:147], a[0:3], v[80:83], 0
    ds_read_b128 v[64:67], v224 offset:16384
    v_mfma_f32_16x16x32_bf16 v[144:147], a[16:19], v[84:87], v[144:147]
    ds_read_b128 v[68:71], v225 offset:16384
    v_mfma_f32_16x16x32_bf16 v[144:147], a[32:35], v[88:91], v[144:147]
    ds_read_b128 v[72:75], v224 offset:24576
    v_mfma_f32_16x16x32_bf16 v[144:147], a[48:51], v[92:95], v[144:147]
    ds_read_b128 v[76:79], v225 offset:24576
    v_mfma_f32_16x16x32_bf16 v[148:151], a[4:7], v[80:83], 0
    v_mfma_f32_16x16x32_bf16 v[148:151], a[20:23], v[84:87], v[148:151]
    v_mfma_f32_16x16x32_bf16 v[148:151], a[36:39], v[88:91], v[148:151]
    v_mfma_f32_16x16x32_bf16 v[148:151], a[52:55], v[92:95], v[148:151]
    v_mfma_f32_16x16x32_bf16 v[152:155], a[8:11], v[80:83], 0
    s_add_u32 m0, s34, 0
    s_add_u32 s37, s80, 196608
    buffer_load_dwordx4 v232, s[44:47], s37 offen lds
    v_mfma_f32_16x16x32_bf16 v[152:155], a[24:27], v[84:87], v[152:155]
    v_mfma_f32_16x16x32_bf16 v[152:155], a[40:43], v[88:91], v[152:155]
    buffer_load_dwordx4 v233, s[44:47], s37 offen offset:1024 lds
    v_mfma_f32_16x16x32_bf16 v[152:155], a[56:59], v[92:95], v[152:155]
    v_mfma_f32_16x16x32_bf16 v[156:159], a[12:15], v[80:83], 0
    v_mfma_f32_16x16x32_bf16 v[156:159], a[28:31], v[84:87], v[156:159]
    s_lshl_b32 s39, s5, 7
    s_add_u32 s39, s39, 8192
    buffer_atomic_add v255, v250, s[88:91], s39 offen sc1
    s_cmp_eq_u32 s3, 0
    s_cselect_b32 s39, s39, s43
    v_mfma_f32_16x16x32_bf16 v[156:159], a[44:47], v[88:91], v[156:159]
    v_mfma_f32_16x16x32_bf16 v[156:159], a[60:63], v[92:95], v[156:159]
    s_waitcnt lgkmcnt(0)
    v_mfma_f32_16x16x32_bf16 v[96:99], a[64:67], v[64:67], v[96:99]
    ds_read_b128 v[80:83], v224 offset:18432
    v_mfma_f32_16x16x32_bf16 v[96:99], a[80:83], v[68:71], v[96:99]
    ds_read_b128 v[84:87], v225 offset:18432
    v_mfma_f32_16x16x32_bf16 v[96:99], a[96:99], v[72:75], v[96:99]
    ds_read_b128 v[88:91], v224 offset:26624
    v_mfma_f32_16x16x32_bf16 v[96:99], a[112:115], v[76:79], v[96:99]
    ds_read_b128 v[92:95], v225 offset:26624
    v_mfma_f32_16x16x32_bf16 v[100:103], a[68:71], v[64:67], v[100:103]
    s_add_u32 s38, s36, 0
    buffer_store_dwordx4 v[12:15], v240, s[16:19], s38 offen offset:3072 sc1
    v_mfma_f32_16x16x32_bf16 v[100:103], a[84:87], v[68:71], v[100:103]
    v_mfma_f32_16x16x32_bf16 v[100:103], a[100:103], v[72:75], v[100:103]
    v_mfma_f32_16x16x32_bf16 v[100:103], a[116:119], v[76:79], v[100:103]
    v_mfma_f32_16x16x32_bf16 v[104:107], a[72:75], v[64:67], v[104:107]
    s_add_u32 m0, s31, 0
    s_add_u32 s24, s27, 0
    buffer_load_dwordx4 v245, s[12:15], s24 offen lds
    v_mfma_f32_16x16x32_bf16 v[104:107], a[88:91], v[68:71], v[104:107]
    v_mfma_f32_16x16x32_bf16 v[104:107], a[104:107], v[72:75], v[104:107]
    v_mfma_f32_16x16x32_bf16 v[104:107], a[120:123], v[76:79], v[104:107]
    v_mfma_f32_16x16x32_bf16 v[108:111], a[76:79], v[64:67], v[108:111]
    v_mfma_f32_16x16x32_bf16 v[108:111], a[92:95], v[68:71], v[108:111]
    v_mfma_f32_16x16x32_bf16 v[108:111], a[108:111], v[72:75], v[108:111]
    v_mfma_f32_16x16x32_bf16 v[108:111], a[124:127], v[76:79], v[108:111]
    s_waitcnt lgkmcnt(0)
    v_mfma_f32_16x16x32_bf16 v[112:115], a[64:67], v[80:83], v[112:115]
    ds_read_b128 v[64:67], v224 offset:20480
    v_mfma_f32_16x16x32_bf16 v[112:115], a[80:83], v[84:87], v[112:115]
    ds_read_b128 v[68:71], v225 offset:20480
    v_mfma_f32_16x16x32_bf16 v[112:115], a[96:99], v[88:91], v[112:115]
    ds_read_b128 v[72:75], v224 offset:28672
    v_mfma_f32_16x16x32_bf16 v[112:115], a[112:115], v[92:95], v[112:115]
    ds_read_b128 v[76:79], v225 offset:28672
    v_mfma_f32_16x16x32_bf16 v[116:119], a[68:71], v[80:83], v[116:119]
    v_mfma_f32_16x16x32_bf16 v[116:119], a[84:87], v[84:87], v[116:119]
    v_mfma_f32_16x16x32_bf16 v[116:119], a[100:103], v[88:91], v[116:119]
    v_mfma_f32_16x16x32_bf16 v[116:119], a[116:119], v[92:95], v[116:119]
    v_mfma_f32_16x16x32_bf16 v[120:123], a[72:75], v[80:83], v[120:123]
    s_add_u32 m0, s34, 8192
    s_add_u32 s37, s81, 196608
    buffer_load_dwordx4 v232, s[44:47], s37 offen lds
    v_mfma_f32_16x16x32_bf16 v[120:123], a[88:91], v[84:87], v[120:123]
    v_mfma_f32_16x16x32_bf16 v[120:123], a[104:107], v[88:91], v[120:123]
    buffer_load_dwordx4 v233, s[44:47], s37 offen offset:1024 lds
    s_add_u32 s38, s36, 8192
    buffer_store_dwordx4 v[16:19], v240, s[16:19], s38 offen offset:0 sc1
    v_mfma_f32_16x16x32_bf16 v[120:123], a[120:123], v[92:95], v[120:123]
    v_mfma_f32_16x16x32_bf16 v[124:127], a[76:79], v[80:83], v[124:127]
    v_mfma_f32_16x16x32_bf16 v[124:127], a[92:95], v[84:87], v[124:127]
    s_add_u32 m0, s31, 1024
    s_add_u32 s24, s27, 32768
    buffer_load_dwordx4 v245, s[12:15], s24 offen lds
    v_mfma_f32_16x16x32_bf16 v[124:127], a[108:111], v[88:91], v[124:127]
    v_mfma_f32_16x16x32_bf16 v[124:127], a[124:127], v[92:95], v[124:127]
    s_waitcnt lgkmcnt(0)
    v_mfma_f32_16x16x32_bf16 v[128:131], a[64:67], v[64:67], v[128:131]
    ds_read_b128 v[80:83], v224 offset:22528
    v_mfma_f32_16x16x32_bf16 v[128:131], a[80:83], v[68:71], v[128:131]
    ds_read_b128 v[84:87], v225 offset:22528
    v_mfma_f32_16x16x32_bf16 v[128:131], a[96:99], v[72:75], v[128:131]
    ds_read_b128 v[88:91], v224 offset:30720
    v_mfma_f32_16x16x32_bf16 v[128:131], a[112:115], v[76:79], v[128:131]
    ds_read_b128 v[92:95], v225 offset:30720
    v_mfma_f32_16x16x32_bf16 v[132:135], a[68:71], v[64:67], v[132:135]
    v_mfma_f32_16x16x32_bf16 v[132:135], a[84:87], v[68:71], v[132:135]
    v_mfma_f32_16x16x32_bf16 v[132:135], a[100:103], v[72:75], v[132:135]
    v_mfma_f32_16x16x32_bf16 v[132:135], a[116:119], v[76:79], v[132:135]
    v_mfma_f32_16x16x32_bf16 v[136:139], a[72:75], v[64:67], v[136:139]
    s_add_u32 m0, s31, 2048
    s_add_u32 s24, s27, 65536
    buffer_load_dwordx4 v237, s[12:15], s24 offen lds
    v_mfma_f32_16x16x32_bf16 v[136:139], a[88:91], v[68:71], v[136:139]
    v_mfma_f32_16x16x32_bf16 v[136:139], a[104:107], v[72:75], v[136:139]
    v_mfma_f32_16x16x32_bf16 v[136:139], a[120:123], v[76:79], v[136:139]
    v_mfma_f32_16x16x32_bf16 v[140:143], a[76:79], v[64:67], v[140:143]
    v_mfma_f32_16x16x32_bf16 v[140:143], a[92:95], v[68:71], v[140:143]
    v_mfma_f32_16x16x32_bf16 v[140:143], a[108:111], v[72:75], v[140:143]
    v_mfma_f32_16x16x32_bf16 v[140:143], a[124:127], v[76:79], v[140:143]
    s_add_u32 s38, s36, 8192
    buffer_store_dwordx4 v[20:23], v240, s[16:19], s38 offen offset:2048 sc1
    s_waitcnt vmcnt(19) lgkmcnt(0)
    s_barrier
    v_mfma_f32_16x16x32_bf16 v[144:147], a[64:67], v[80:83], v[144:147]
    ds_read_b128 v[64:67], v224 offset:32768
    v_mfma_f32_16x16x32_bf16 v[144:147], a[80:83], v[84:87], v[144:147]
    ds_read_b128 v[68:71], v225 offset:32768
    v_mfma_f32_16x16x32_bf16 v[144:147], a[96:99], v[88:91], v[144:147]
    ds_read_b128 v[72:75], v224 offset:40960
    v_mfma_f32_16x16x32_bf16 v[144:147], a[112:115], v[92:95], v[144:147]
    ds_read_b128 v[76:79], v225 offset:40960
    v_mfma_f32_16x16x32_bf16 v[148:151], a[68:71], v[80:83], v[148:151]
    v_mfma_f32_16x16x32_bf16 v[148:151], a[84:87], v[84:87], v[148:151]
    v_mfma_f32_16x16x32_bf16 v[148:151], a[100:103], v[88:91], v[148:151]
    v_mfma_f32_16x16x32_bf16 v[148:151], a[116:119], v[92:95], v[148:151]
    v_mfma_f32_16x16x32_bf16 v[152:155], a[72:75], v[80:83], v[152:155]
    s_add_u32 m0, s34, 16384
    s_add_u32 s37, s82, 196608
    buffer_load_dwordx4 v232, s[44:47], s37 offen lds
    v_mfma_f32_16x16x32_bf16 v[152:155], a[88:91], v[84:87], v[152:155]
    v_mfma_f32_16x16x32_bf16 v[152:155], a[104:107], v[88:91], v[152:155]
    buffer_load_dwordx4 v233, s[44:47], s37 offen offset:1024 lds
    v_mfma_f32_16x16x32_bf16 v[152:155], a[120:123], v[92:95], v[152:155]
    v_mfma_f32_16x16x32_bf16 v[156:159], a[76:79], v[80:83], v[156:159]
    v_mfma_f32_16x16x32_bf16 v[156:159], a[92:95], v[84:87], v[156:159]
    s_add_u32 m0, s31, 3072
    s_add_u32 s24, s27, 98304
    buffer_load_dwordx4 v237, s[12:15], s24 offen lds
    v_mfma_f32_16x16x32_bf16 v[156:159], a[108:111], v[88:91], v[156:159]
    v_mfma_f32_16x16x32_bf16 v[156:159], a[124:127], v[92:95], v[156:159]
    s_waitcnt lgkmcnt(0)
    v_mfma_f32_16x16x32_bf16 v[96:99], a[128:131], v[64:67], v[96:99]
    ds_read_b128 v[80:83], v224 offset:34816
    v_mfma_f32_16x16x32_bf16 v[96:99], a[144:147], v[68:71], v[96:99]
    ds_read_b128 v[84:87], v225 offset:34816
    v_mfma_f32_16x16x32_bf16 v[96:99], a[160:163], v[72:75], v[96:99]
    ds_read_b128 v[88:91], v224 offset:43008
    v_mfma_f32_16x16x32_bf16 v[96:99], a[176:179], v[76:79], v[96:99]
    ds_read_b128 v[92:95], v225 offset:43008
    v_mfma_f32_16x16x32_bf16 v[100:103], a[132:135], v[64:67], v[100:103]
    v_mfma_f32_16x16x32_bf16 v[100:103], a[148:151], v[68:71], v[100:103]
    s_add_u32 s38, s36, 8192
    buffer_store_dwordx4 v[24:27], v240, s[16:19], s38 offen offset:1024 sc1
    v_mfma_f32_16x16x32_bf16 v[100:103], a[164:167], v[72:75], v[100:103]
    v_mfma_f32_16x16x32_bf16 v[100:103], a[180:183], v[76:79], v[100:103]
    v_mfma_f32_16x16x32_bf16 v[104:107], a[136:139], v[64:67], v[104:107]
    s_add_u32 m0, s31, 4096
    s_add_u32 s24, s27, 131072
    buffer_load_dwordx4 v245, s[12:15], s24 offen lds
    v_mfma_f32_16x16x32_bf16 v[104:107], a[152:155], v[68:71], v[104:107]
    v_mfma_f32_16x16x32_bf16 v[104:107], a[168:171], v[72:75], v[104:107]
    v_mfma_f32_16x16x32_bf16 v[104:107], a[184:187], v[76:79], v[104:107]
    v_mfma_f32_16x16x32_bf16 v[108:111], a[140:143], v[64:67], v[108:111]
    v_mfma_f32_16x16x32_bf16 v[108:111], a[156:159], v[68:71], v[108:111]
    v_mfma_f32_16x16x32_bf16 v[108:111], a[172:175], v[72:75], v[108:111]
    v_mfma_f32_16x16x32_bf16 v[108:111], a[188:191], v[76:79], v[108:111]
    s_waitcnt lgkmcnt(0)
    v_mfma_f32_16x16x32_bf16 v[112:115], a[128:131], v[80:83], v[112:115]
    ds_read_b128 v[64:67], v224 offset:36864
    v_mfma_f32_16x16x32_bf16 v[112:115], a[144:147], v[84:87], v[112:115]
    ds_read_b128 v[68:71], v225 offset:36864
    v_mfma_f32_16x16x32_bf16 v[112:115], a[160:163], v[88:91], v[112:115]
    ds_read_b128 v[72:75], v224 offset:45056
    v_mfma_f32_16x16x32_bf16 v[112:115], a[176:179], v[92:95], v[112:115]
    ds_read_b128 v[76:79], v225 offset:45056
    v_mfma_f32_16x16x32_bf16 v[116:119], a[132:135], v[80:83], v[116:119]
    v_mfma_f32_16x16x32_bf16 v[116:119], a[148:151], v[84:87], v[116:119]
    v_mfma_f32_16x16x32_bf16 v[116:119], a[164:167], v[88:91], v[116:119]
    v_mfma_f32_16x16x32_bf16 v[116:119], a[180:183], v[92:95], v[116:119]
    v_mfma_f32_16x16x32_bf16 v[120:123], a[136:139], v[80:83], v[120:123]
    s_add_u32 m0, s34, 24576
    s_add_u32 s37, s83, 196608
    buffer_load_dwordx4 v232, s[44:47], s37 offen lds
    v_mfma_f32_16x16x32_bf16 v[120:123], a[152:155], v[84:87], v[120:123]
    v_mfma_f32_16x16x32_bf16 v[120:123], a[168:171], v[88:91], v[120:123]
    buffer_load_dwordx4 v233, s[44:47], s37 offen offset:1024 lds
    s_add_u32 s38, s36, 8192
    buffer_store_dwordx4 v[28:31], v240, s[16:19], s38 offen offset:3072 sc1
    v_mfma_f32_16x16x32_bf16 v[120:123], a[184:187], v[92:95], v[120:123]
    v_mfma_f32_16x16x32_bf16 v[124:127], a[140:143], v[80:83], v[124:127]
    v_mfma_f32_16x16x32_bf16 v[124:127], a[156:159], v[84:87], v[124:127]
    s_add_u32 m0, s31, 5120
    s_add_u32 s24, s27, 163840
    buffer_load_dwordx4 v245, s[12:15], s24 offen lds
    v_mfma_f32_16x16x32_bf16 v[124:127], a[172:175], v[88:91], v[124:127]
    v_mfma_f32_16x16x32_bf16 v[124:127], a[188:191], v[92:95], v[124:127]
    s_waitcnt lgkmcnt(0)
    v_mfma_f32_16x16x32_bf16 v[128:131], a[128:131], v[64:67], v[128:131]
    ds_read_b128 v[80:83], v224 offset:38912
    v_mfma_f32_16x16x32_bf16 v[128:131], a[144:147], v[68:71], v[128:131]
    ds_read_b128 v[84:87], v225 offset:38912
    v_mfma_f32_16x16x32_bf16 v[128:131], a[160:163], v[72:75], v[128:131]
    ds_read_b128 v[88:91], v224 offset:47104
    v_mfma_f32_16x16x32_bf16 v[128:131], a[176:179], v[76:79], v[128:131]
    ds_read_b128 v[92:95], v225 offset:47104
    v_mfma_f32_16x16x32_bf16 v[132:135], a[132:135], v[64:67], v[132:135]
    v_mfma_f32_16x16x32_bf16 v[132:135], a[148:151], v[68:71], v[132:135]
    v_mfma_f32_16x16x32_bf16 v[132:135], a[164:167], v[72:75], v[132:135]
    v_mfma_f32_16x16x32_bf16 v[132:135], a[180:183], v[76:79], v[132:135]
    v_mfma_f32_16x16x32_bf16 v[136:139], a[136:139], v[64:67], v[136:139]
    s_add_u32 m0, s31, 6144
    s_add_u32 s24, s27, 196608
    buffer_load_dwordx4 v237, s[12:15], s24 offen lds
    v_mfma_f32_16x16x32_bf16 v[136:139], a[152:155], v[68:71], v[136:139]
    v_mfma_f32_16x16x32_bf16 v[136:139], a[168:171], v[72:75], v[136:139]
    v_mfma_f32_16x16x32_bf16 v[136:139], a[184:187], v[76:79], v[136:139]
    v_mfma_f32_16x16x32_bf16 v[140:143], a[140:143], v[64:67], v[140:143]
    v_mfma_f32_16x16x32_bf16 v[140:143], a[156:159], v[68:71], v[140:143]
    v_mfma_f32_16x16x32_bf16 v[140:143], a[172:175], v[72:75], v[140:143]
    v_mfma_f32_16x16x32_bf16 v[140:143], a[188:191], v[76:79], v[140:143]
    s_waitcnt vmcnt(22) lgkmcnt(0)
    s_barrier
    v_mfma_f32_16x16x32_bf16 v[144:147], a[128:131], v[80:83], v[144:147]
    ds_read_b128 v[64:67], v224 offset:49152
    s_add_u32 s38, s36, 32768
    buffer_store_dwordx4 v[32:35], v240, s[16:19], s38 offen offset:1280 sc1
    v_mfma_f32_16x16x32_bf16 v[144:147], a[144:147], v[84:87], v[144:147]
    ds_read_b128 v[68:71], v225 offset:49152
    v_mfma_f32_16x16x32_bf16 v[144:147], a[160:163], v[88:91], v[144:147]
    ds_read_b128 v[72:75], v224 offset:57344
    v_mfma_f32_16x16x32_bf16 v[144:147], a[176:179], v[92:95], v[144:147]
    ds_read_b128 v[76:79], v225 offset:57344
    v_mfma_f32_16x16x32_bf16 v[148:151], a[132:135], v[80:83], v[148:151]
    v_mfma_f32_16x16x32_bf16 v[148:151], a[148:151], v[84:87], v[148:151]
    v_mfma_f32_16x16x32_bf16 v[148:151], a[164:167], v[88:91], v[148:151]
    v_mfma_f32_16x16x32_bf16 v[148:151], a[180:183], v[92:95], v[148:151]
    v_mfma_f32_16x16x32_bf16 v[152:155], a[136:139], v[80:83], v[152:155]
    s_add_u32 m0, s34, 32768
    s_add_u32 s37, s84, 196608
    buffer_load_dwordx4 v232, s[44:47], s37 offen lds
    v_mfma_f32_16x16x32_bf16 v[152:155], a[152:155], v[84:87], v[152:155]
    buffer_load_dwordx4 v233, s[44:47], s37 offen offset:1024 lds
    v_mfma_f32_16x16x32_bf16 v[152:155], a[168:171], v[88:91], v[152:155]
    v_mfma_f32_16x16x32_bf16 v[152:155], a[184:187], v[92:95], v[152:155]
    s_add_u32 m0, s31, 7168
    s_add_u32 s24, s27, 229376
    buffer_load_dwordx4 v237, s[12:15], s24 offen lds
    v_mfma_f32_16x16x32_bf16 v[156:159], a[140:143], v[80:83], v[156:159]
    s_add_u32 s27, s27, 1048576
    s_and_b32 s27, s27, 0x407fffff
    s_cmp_eq_u32 s27, s7
    s_cselect_b32 s27, s43, s27
    v_mfma_f32_16x16x32_bf16 v[156:159], a[156:159], v[84:87], v[156:159]
    v_mfma_f32_16x16x32_bf16 v[156:159], a[172:175], v[88:91], v[156:159]
    s_add_u32 s31, s31, 32768
    s_cmp_ge_u32 s31, 163840
    s_cselect_b32 s24, 98304, 0
    s_sub_u32 s31, s31, s24
    v_mfma_f32_16x16x32_bf16 v[156:159], a[188:191], v[92:95], v[156:159]
    s_waitcnt lgkmcnt(0)
    v_mfma_f32_16x16x32_bf16 v[96:99], a[192:195], v[64:67], v[96:99]
    ds_read_b128 v[80:83], v224 offset:51200
    v_mfma_f32_16x16x32_bf16 v[96:99], a[208:211], v[68:71], v[96:99]
    ds_read_b128 v[84:87], v225 offset:51200
    v_mfma_f32_16x16x32_bf16 v[96:99], a[224:227], v[72:75], v[96:99]
    ds_read_b128 v[88:91], v224 offset:59392
    v_mfma_f32_16x16x32_bf16 v[96:99], a[240:243], v[76:79], v[96:99]
    ds_read_b128 v[92:95], v225 offset:59392
    v_mfma_f32_16x16x32_bf16 v[100:103], a[196:199], v[64:67], v[100:103]
    v_mfma_f32_16x16x32_bf16 v[100:103], a[212:215], v[68:71], v[100:103]
    v_mfma_f32_16x16x32_bf16 v[100:103], a[228:231], v[72:75], v[100:103]
    s_add_u32 s38, s36, 32768
    buffer_store_dwordx4 v[36:39], v240, s[16:19], s38 offen offset:3328 sc1
    v_mfma_f32_16x16x32_bf16 v[100:103], a[244:247], v[76:79], v[100:103]
    v_mfma_f32_16x16x32_bf16 v[104:107], a[200:203], v[64:67], v[104:107]
    v_mfma_f32_16x16x32_bf16 v[104:107], a[216:219], v[68:71], v[104:107]
    v_mfma_f32_16x16x32_bf16 v[104:107], a[232:235], v[72:75], v[104:107]
    v_mfma_f32_16x16x32_bf16 v[104:107], a[248:251], v[76:79], v[104:107]
    v_mfma_f32_16x16x32_bf16 v[108:111], a[204:207], v[64:67], v[108:111]
    v_mfma_f32_16x16x32_bf16 v[108:111], a[220:223], v[68:71], v[108:111]
    v_mfma_f32_16x16x32_bf16 v[108:111], a[236:239], v[72:75], v[108:111]
    v_mfma_f32_16x16x32_bf16 v[108:111], a[252:255], v[76:79], v[108:111]
    s_waitcnt lgkmcnt(0)
    v_mfma_f32_16x16x32_bf16 v[112:115], a[192:195], v[80:83], v[112:115]
    ds_read_b128 v[64:67], v224 offset:53248
    v_mfma_f32_16x16x32_bf16 v[112:115], a[208:211], v[84:87], v[112:115]
    ds_read_b128 v[68:71], v225 offset:53248
    v_mfma_f32_16x16x32_bf16 v[112:115], a[224:227], v[88:91], v[112:115]
    ds_read_b128 v[72:75], v224 offset:61440
    v_mfma_f32_16x16x32_bf16 v[112:115], a[240:243], v[92:95], v[112:115]
    ds_read_b128 v[76:79], v225 offset:61440
    v_mfma_f32_16x16x32_bf16 v[116:119], a[196:199], v[80:83], v[116:119]
    v_mfma_f32_16x16x32_bf16 v[116:119], a[212:215], v[84:87], v[116:119]
    v_mfma_f32_16x16x32_bf16 v[116:119], a[228:231], v[88:91], v[116:119]
    v_mfma_f32_16x16x32_bf16 v[116:119], a[244:247], v[92:95], v[116:119]
    v_mfma_f32_16x16x32_bf16 v[120:123], a[200:203], v[80:83], v[120:123]
    s_add_u32 m0, s34, 40960
    s_add_u32 s37, s85, 196608
    buffer_load_dwordx4 v232, s[44:47], s37 offen lds
    v_mfma_f32_16x16x32_bf16 v[120:123], a[216:219], v[84:87], v[120:123]
    v_mfma_f32_16x16x32_bf16 v[120:123], a[232:235], v[88:91], v[120:123]
    v_mfma_f32_16x16x32_bf16 v[120:123], a[248:251], v[92:95], v[120:123]
    s_add_u32 s38, s36, 32768
    buffer_store_dwordx4 v[40:43], v240, s[16:19], s38 offen offset:2304 sc1
    v_mfma_f32_16x16x32_bf16 v[124:127], a[204:207], v[80:83], v[124:127]
    buffer_load_dwordx4 v233, s[44:47], s37 offen offset:1024 lds
    v_mfma_f32_16x16x32_bf16 v[124:127], a[220:223], v[84:87], v[124:127]
    v_mfma_f32_16x16x32_bf16 v[124:127], a[236:239], v[88:91], v[124:127]
    v_mfma_f32_16x16x32_bf16 v[124:127], a[252:255], v[92:95], v[124:127]
    s_waitcnt lgkmcnt(0)
    v_mfma_f32_16x16x32_bf16 v[128:131], a[192:195], v[64:67], v[128:131]
    ds_read_b128 v[80:83], v224 offset:55296
    v_mfma_f32_16x16x32_bf16 v[128:131], a[208:211], v[68:71], v[128:131]
    ds_read_b128 v[84:87], v225 offset:55296
    v_mfma_f32_16x16x32_bf16 v[128:131], a[224:227], v[72:75], v[128:131]
    ds_read_b128 v[88:91], v224 offset:63488
    v_mfma_f32_16x16x32_bf16 v[128:131], a[240:243], v[76:79], v[128:131]
    ds_read_b128 v[92:95], v225 offset:63488
    v_mfma_f32_16x16x32_bf16 v[132:135], a[196:199], v[64:67], v[132:135]
    v_mfma_f32_16x16x32_bf16 v[132:135], a[212:215], v[68:71], v[132:135]
    v_mfma_f32_16x16x32_bf16 v[132:135], a[228:231], v[72:75], v[132:135]
    v_mfma_f32_16x16x32_bf16 v[132:135], a[244:247], v[76:79], v[132:135]
    v_mfma_f32_16x16x32_bf16 v[136:139], a[200:203], v[64:67], v[136:139]
    s_add_u32 m0, s31, 0
    s_add_u32 s24, s27, 0
    buffer_load_dwordx4 v245, s[12:15], s24 offen lds
    v_mfma_f32_16x16x32_bf16 v[136:139], a[216:219], v[68:71], v[136:139]
    v_mfma_f32_16x16x32_bf16 v[136:139], a[232:235], v[72:75], v[136:139]
    v_mfma_f32_16x16x32_bf16 v[136:139], a[248:251], v[76:79], v[136:139]
    v_mfma_f32_16x16x32_bf16 v[140:143], a[204:207], v[64:67], v[140:143]
    v_mfma_f32_16x16x32_bf16 v[140:143], a[220:223], v[68:71], v[140:143]
    v_mfma_f32_16x16x32_bf16 v[140:143], a[236:239], v[72:75], v[140:143]
    v_mfma_f32_16x16x32_bf16 v[140:143], a[252:255], v[76:79], v[140:143]
    s_waitcnt vmcnt(23) lgkmcnt(0)
    s_barrier
    v_mfma_f32_16x16x32_bf16 v[144:147], a[192:195], v[80:83], v[144:147]
    ds_read_b128 v[64:67], v224 offset:0
    v_mfma_f32_16x16x32_bf16 v[144:147], a[208:211], v[84:87], v[144:147]
    ds_read_b128 v[68:71], v225 offset:0
    s_add_u32 s38, s36, 36864
    buffer_store_dwordx4 v[44:47], v240, s[16:19], s38 offen offset:256 sc1
    v_mfma_f32_16x16x32_bf16 v[144:147], a[224:227], v[88:91], v[144:147]
    ds_read_b128 v[72:75], v224 offset:8192
    v_mfma_f32_16x16x32_bf16 v[144:147], a[240:243], v[92:95], v[144:147]
    ds_read_b128 v[76:79], v225 offset:8192
    v_mfma_f32_16x16x32_bf16 v[148:151], a[196:199], v[80:83], v[148:151]
    v_mfma_f32_16x16x32_bf16 v[148:151], a[212:215], v[84:87], v[148:151]
    v_mfma_f32_16x16x32_bf16 v[148:151], a[228:231], v[88:91], v[148:151]
    v_mfma_f32_16x16x32_bf16 v[148:151], a[244:247], v[92:95], v[148:151]
    v_mfma_f32_16x16x32_bf16 v[152:155], a[200:203], v[80:83], v[152:155]
    s_add_u32 m0, s34, 49152
    s_add_u32 s37, s86, 196608
    buffer_load_dwordx4 v232, s[44:47], s37 offen lds
    v_mfma_f32_16x16x32_bf16 v[152:155], a[216:219], v[84:87], v[152:155]
    v_mfma_f32_16x16x32_bf16 v[152:155], a[232:235], v[88:91], v[152:155]
    buffer_load_dwordx4 v233, s[44:47], s37 offen offset:1024 lds
    v_mfma_f32_16x16x32_bf16 v[152:155], a[248:251], v[92:95], v[152:155]
    v_mfma_f32_16x16x32_bf16 v[156:159], a[204:207], v[80:83], v[156:159]
    v_mfma_f32_16x16x32_bf16 v[156:159], a[220:223], v[84:87], v[156:159]
    s_add_u32 m0, s31, 1024
    s_add_u32 s24, s27, 32768
    buffer_load_dwordx4 v245, s[12:15], s24 offen lds
    v_mfma_f32_16x16x32_bf16 v[156:159], a[236:239], v[88:91], v[156:159]
    v_mfma_f32_16x16x32_bf16 v[156:159], a[252:255], v[92:95], v[156:159]
    s_waitcnt lgkmcnt(0)
    v_mfma_f32_16x16x32_bf16 v[160:163], a[0:3], v[64:67], 0
    ds_read_b128 v[80:83], v224 offset:2048
    v_mfma_f32_16x16x32_bf16 v[160:163], a[16:19], v[68:71], v[160:163]
    ds_read_b128 v[84:87], v225 offset:2048
    v_mfma_f32_16x16x32_bf16 v[160:163], a[32:35], v[72:75], v[160:163]
    ds_read_b128 v[88:91], v224 offset:10240
    v_mfma_f32_16x16x32_bf16 v[160:163], a[48:51], v[76:79], v[160:163]
    ds_read_b128 v[92:95], v225 offset:10240
    v_mfma_f32_16x16x32_bf16 v[164:167], a[4:7], v[64:67], 0
    v_cvt_pk_bf16_f32 v0, v96, v97
    v_cvt_pk_bf16_f32 v1, v98, v99
    v_mfma_f32_16x16x32_bf16 v[164:167], a[20:23], v[68:71], v[164:167]
    v_mfma_f32_16x16x32_bf16 v[164:167], a[36:39], v[72:75], v[164:167]
    v_cvt_pk_bf16_f32 v2, v100, v101
    v_cvt_pk_bf16_f32 v3, v102, v103
    s_add_u32 s38, s36, 40960
    buffer_store_dwordx4 v[48:51], v240, s[16:19], s38 offen offset:1280 sc1
    v_mfma_f32_16x16x32_bf16 v[164:167], a[52:55], v[76:79], v[164:167]
    v_mfma_f32_16x16x32_bf16 v[168:171], a[8:11], v[64:67], 0
    s_add_u32 m0, s31, 2048
    s_add_u32 s24, s27, 65536
    buffer_load_dwordx4 v237, s[12:15], s24 offen lds
    v_cvt_pk_bf16_f32 v4, v104, v105
    v_cvt_pk_bf16_f32 v5, v106, v107
    v_mfma_f32_16x16x32_bf16 v[168:171], a[24:27], v[68:71], v[168:171]
    v_mfma_f32_16x16x32_bf16 v[168:171], a[40:43], v[72:75], v[168:171]
    v_cvt_pk_bf16_f32 v6, v108, v109
    v_cvt_pk_bf16_f32 v7, v110, v111
    v_mfma_f32_16x16x32_bf16 v[168:171], a[56:59], v[76:79], v[168:171]
    v_mfma_f32_16x16x32_bf16 v[172:175], a[12:15], v[64:67], 0
    v_cvt_pk_bf16_f32 v8, v112, v113
    v_cvt_pk_bf16_f32 v9, v114, v115
    v_mfma_f32_16x16x32_bf16 v[172:175], a[28:31], v[68:71], v[172:175]
    v_mfma_f32_16x16x32_bf16 v[172:175], a[44:47], v[72:75], v[172:175]
    v_cvt_pk_bf16_f32 v10, v116, v117
    v_cvt_pk_bf16_f32 v11, v118, v119
    v_mfma_f32_16x16x32_bf16 v[172:175], a[60:63], v[76:79], v[172:175]
    s_waitcnt lgkmcnt(0)
    v_mfma_f32_16x16x32_bf16 v[176:179], a[0:3], v[80:83], 0
    ds_read_b128 v[64:67], v224 offset:4096
    v_cvt_pk_bf16_f32 v12, v120, v121
    v_cvt_pk_bf16_f32 v13, v122, v123
    v_mfma_f32_16x16x32_bf16 v[176:179], a[16:19], v[84:87], v[176:179]
    ds_read_b128 v[68:71], v225 offset:4096
    v_mfma_f32_16x16x32_bf16 v[176:179], a[32:35], v[88:91], v[176:179]
    ds_read_b128 v[72:75], v224 offset:12288
    v_cvt_pk_bf16_f32 v14, v124, v125
    v_cvt_pk_bf16_f32 v15, v126, v127
    v_mfma_f32_16x16x32_bf16 v[176:179], a[48:51], v[92:95], v[176:179]
    ds_read_b128 v[76:79], v225 offset:12288
    v_mfma_f32_16x16x32_bf16 v[180:183], a[4:7], v[80:83], 0
    v_cvt_pk_bf16_f32 v16, v128, v129
    v_cvt_pk_bf16_f32 v17, v130, v131
    v_mfma_f32_16x16x32_bf16 v[180:183], a[20:23], v[84:87], v[180:183]
    v_mfma_f32_16x16x32_bf16 v[180:183], a[36:39], v[88:91], v[180:183]
    v_cvt_pk_bf16_f32 v18, v132, v133
    v_cvt_pk_bf16_f32 v19, v134, v135
    v_mfma_f32_16x16x32_bf16 v[180:183], a[52:55], v[92:95], v[180:183]
    v_mfma_f32_16x16x32_bf16 v[184:187], a[8:11], v[80:83], 0
    s_add_u32 m0, s34, 57344
    s_add_u32 s37, s87, 196608
    buffer_load_dwordx4 v232, s[44:47], s37 offen lds
    v_cvt_pk_bf16_f32 v20, v136, v137
    v_cvt_pk_bf16_f32 v21, v138, v139
    v_mfma_f32_16x16x32_bf16 v[184:187], a[24:27], v[84:87], v[184:187]
    v_mfma_f32_16x16x32_bf16 v[184:187], a[40:43], v[88:91], v[184:187]
    buffer_load_dwordx4 v233, s[44:47], s37 offen offset:1024 lds
    v_cvt_pk_bf16_f32 v22, v140, v141
    v_cvt_pk_bf16_f32 v23, v142, v143
    v_mfma_f32_16x16x32_bf16 v[184:187], a[56:59], v[92:95], v[184:187]
    v_mfma_f32_16x16x32_bf16 v[188:191], a[12:15], v[80:83], 0
    v_cvt_pk_bf16_f32 v24, v144, v145
    v_cvt_pk_bf16_f32 v25, v146, v147
    s_add_u32 s38, s36, 40960
    buffer_store_dwordx4 v[52:55], v240, s[16:19], s38 offen offset:3328 sc1
    v_mfma_f32_16x16x32_bf16 v[188:191], a[28:31], v[84:87], v[188:191]
    s_add_u32 m0, s31, 3072
    s_add_u32 s24, s27, 98304
    buffer_load_dwordx4 v237, s[12:15], s24 offen lds
    v_mfma_f32_16x16x32_bf16 v[188:191], a[44:47], v[88:91], v[188:191]
    v_cvt_pk_bf16_f32 v26, v148, v149
    v_cvt_pk_bf16_f32 v27, v150, v151
    v_mfma_f32_16x16x32_bf16 v[188:191], a[60:63], v[92:95], v[188:191]
    s_waitcnt lgkmcnt(0)
    v_mfma_f32_16x16x32_bf16 v[192:195], a[0:3], v[64:67], 0
    ds_read_b128 v[80:83], v224 offset:6144
    v_cvt_pk_bf16_f32 v28, v152, v153
    v_cvt_pk_bf16_f32 v29, v154, v155
    v_mfma_f32_16x16x32_bf16 v[192:195], a[16:19], v[68:71], v[192:195]
    ds_read_b128 v[84:87], v225 offset:6144
    v_mfma_f32_16x16x32_bf16 v[192:195], a[32:35], v[72:75], v[192:195]
    ds_read_b128 v[88:91], v224 offset:14336
    v_cvt_pk_bf16_f32 v30, v156, v157
    v_cvt_pk_bf16_f32 v31, v158, v159
    v_mfma_f32_16x16x32_bf16 v[192:195], a[48:51], v[76:79], v[192:195]
    ds_read_b128 v[92:95], v225 offset:14336
    v_mfma_f32_16x16x32_bf16 v[196:199], a[4:7], v[64:67], 0
    v_mfma_f32_16x16x32_bf16 v[196:199], a[20:23], v[68:71], v[196:199]
    v_mfma_f32_16x16x32_bf16 v[196:199], a[36:39], v[72:75], v[196:199]
    v_mfma_f32_16x16x32_bf16 v[196:199], a[52:55], v[76:79], v[196:199]
    v_mfma_f32_16x16x32_bf16 v[200:203], a[8:11], v[64:67], 0
    s_add_u32 m0, s31, 4096
    s_add_u32 s24, s27, 131072
    buffer_load_dwordx4 v245, s[12:15], s24 offen lds
    v_mfma_f32_16x16x32_bf16 v[200:203], a[24:27], v[68:71], v[200:203]
    v_mfma_f32_16x16x32_bf16 v[200:203], a[40:43], v[72:75], v[200:203]
    v_mfma_f32_16x16x32_bf16 v[200:203], a[56:59], v[76:79], v[200:203]
    v_mfma_f32_16x16x32_bf16 v[204:207], a[12:15], v[64:67], 0
    v_mfma_f32_16x16x32_bf16 v[204:207], a[28:31], v[68:71], v[204:207]
    v_mfma_f32_16x16x32_bf16 v[204:207], a[44:47], v[72:75], v[204:207]
    v_mfma_f32_16x16x32_bf16 v[204:207], a[60:63], v[76:79], v[204:207]
    s_waitcnt vmcnt(23) lgkmcnt(0)
    s_barrier
    v_mfma_f32_16x16x32_bf16 v[208:211], a[0:3], v[80:83], 0
    ds_read_b128 v[64:67], v224 offset:16384
    v_mfma_f32_16x16x32_bf16 v[208:211], a[16:19], v[84:87], v[208:211]
    ds_read_b128 v[68:71], v225 offset:16384
    s_add_u32 s38, s36, 40960
    buffer_store_dwordx4 v[56:59], v240, s[16:19], s38 offen offset:2304 sc1
    v_mfma_f32_16x16x32_bf16 v[208:211], a[32:35], v[88:91], v[208:211]
    ds_read_b128 v[72:75], v224 offset:24576
    v_mfma_f32_16x16x32_bf16 v[208:211], a[48:51], v[92:95], v[208:211]
    ds_read_b128 v[76:79], v225 offset:24576
    v_mfma_f32_16x16x32_bf16 v[212:215], a[4:7], v[80:83], 0
    v_mfma_f32_16x16x32_bf16 v[212:215], a[20:23], v[84:87], v[212:215]
    v_mfma_f32_16x16x32_bf16 v[212:215], a[36:39], v[88:91], v[212:215]
    v_mfma_f32_16x16x32_bf16 v[212:215], a[52:55], v[92:95], v[212:215]
    v_mfma_f32_16x16x32_bf16 v[216:219], a[8:11], v[80:83], 0
    s_add_u32 m0, s31, 5120
    s_add_u32 s24, s27, 163840
    buffer_load_dwordx4 v245, s[12:15], s24 offen lds
    v_mfma_f32_16x16x32_bf16 v[216:219], a[24:27], v[84:87], v[216:219]
    v_mfma_f32_16x16x32_bf16 v[216:219], a[40:43], v[88:91], v[216:219]
    v_mfma_f32_16x16x32_bf16 v[216:219], a[56:59], v[92:95], v[216:219]
    v_mfma_f32_16x16x32_bf16 v[220:223], a[12:15], v[80:83], 0
    v_mfma_f32_16x16x32_bf16 v[220:223], a[28:31], v[84:87], v[220:223]
    v_mfma_f32_16x16x32_bf16 v[220:223], a[44:47], v[88:91], v[220:223]
    v_mfma_f32_16x16x32_bf16 v[220:223], a[60:63], v[92:95], v[220:223]
    s_waitcnt lgkmcnt(0)
    v_mfma_f32_16x16x32_bf16 v[160:163], a[64:67], v[64:67], v[160:163]
    ds_read_b128 v[80:83], v224 offset:18432
    v_mfma_f32_16x16x32_bf16 v[160:163], a[80:83], v[68:71], v[160:163]
    ds_read_b128 v[84:87], v225 offset:18432
    v_mfma_f32_16x16x32_bf16 v[160:163], a[96:99], v[72:75], v[160:163]
    ds_read_b128 v[88:91], v224 offset:26624
    v_mfma_f32_16x16x32_bf16 v[160:163], a[112:115], v[76:79], v[160:163]
    ds_read_b128 v[92:95], v225 offset:26624
    v_mfma_f32_16x16x32_bf16 v[164:167], a[68:71], v[64:67], v[164:167]
    v_mfma_f32_16x16x32_bf16 v[164:167], a[84:87], v[68:71], v[164:167]
    v_mfma_f32_16x16x32_bf16 v[164:167], a[100:103], v[72:75], v[164:167]
    v_mfma_f32_16x16x32_bf16 v[164:167], a[116:119], v[76:79], v[164:167]
    s_add_u32 s38, s36, 45056
    buffer_store_dwordx4 v[60:63], v240, s[16:19], s38 offen offset:256 sc1
    v_mfma_f32_16x16x32_bf16 v[168:171], a[72:75], v[64:67], v[168:171]
    s_add_u32 m0, s31, 6144
    s_add_u32 s24, s27, 196608
    buffer_load_dwordx4 v237, s[12:15], s24 offen lds
    v_mfma_f32_16x16x32_bf16 v[168:171], a[88:91], v[68:71], v[168:171]
    v_mfma_f32_16x16x32_bf16 v[168:171], a[104:107], v[72:75], v[168:171]
    v_mfma_f32_16x16x32_bf16 v[168:171], a[120:123], v[76:79], v[168:171]
    v_mfma_f32_16x16x32_bf16 v[172:175], a[76:79], v[64:67], v[172:175]
    v_mfma_f32_16x16x32_bf16 v[172:175], a[92:95], v[68:71], v[172:175]
    v_mfma_f32_16x16x32_bf16 v[172:175], a[108:111], v[72:75], v[172:175]
    v_mfma_f32_16x16x32_bf16 v[172:175], a[124:127], v[76:79], v[172:175]
    s_waitcnt lgkmcnt(0)
    v_mfma_f32_16x16x32_bf16 v[176:179], a[64:67], v[80:83], v[176:179]
    ds_read_b128 v[64:67], v224 offset:20480
    v_mfma_f32_16x16x32_bf16 v[176:179], a[80:83], v[84:87], v[176:179]
    ds_read_b128 v[68:71], v225 offset:20480
    v_mfma_f32_16x16x32_bf16 v[176:179], a[96:99], v[88:91], v[176:179]
    ds_read_b128 v[72:75], v224 offset:28672
    v_mfma_f32_16x16x32_bf16 v[176:179], a[112:115], v[92:95], v[176:179]
    ds_read_b128 v[76:79], v225 offset:28672
    v_mfma_f32_16x16x32_bf16 v[180:183], a[68:71], v[80:83], v[180:183]
    v_mfma_f32_16x16x32_bf16 v[180:183], a[84:87], v[84:87], v[180:183]
    v_mfma_f32_16x16x32_bf16 v[180:183], a[100:103], v[88:91], v[180:183]
    v_mfma_f32_16x16x32_bf16 v[180:183], a[116:119], v[92:95], v[180:183]
    v_mfma_f32_16x16x32_bf16 v[184:187], a[72:75], v[80:83], v[184:187]
    s_add_u32 m0, s31, 7168
    s_add_u32 s24, s27, 229376
    buffer_load_dwordx4 v237, s[12:15], s24 offen lds
    v_mfma_f32_16x16x32_bf16 v[184:187], a[88:91], v[84:87], v[184:187]
    v_mfma_f32_16x16x32_bf16 v[184:187], a[104:107], v[88:91], v[184:187]
    s_add_u32 s27, s27, 1048576
    s_and_b32 s27, s27, 0x407fffff
    s_cmp_eq_u32 s27, s7
    s_cselect_b32 s27, s43, s27
    v_mfma_f32_16x16x32_bf16 v[184:187], a[120:123], v[92:95], v[184:187]
    v_mfma_f32_16x16x32_bf16 v[188:191], a[76:79], v[80:83], v[188:191]
    v_mfma_f32_16x16x32_bf16 v[188:191], a[92:95], v[84:87], v[188:191]
    s_add_u32 s31, s31, 32768
    s_cmp_ge_u32 s31, 163840
    s_cselect_b32 s24, 98304, 0
    s_sub_u32 s31, s31, s24
    s_add_u32 s38, s36, 65536
    buffer_store_dwordx4 v[0:3], v240, s[16:19], s38 offen offset:2560 sc1
    v_mfma_f32_16x16x32_bf16 v[188:191], a[108:111], v[88:91], v[188:191]
    v_mfma_f32_16x16x32_bf16 v[188:191], a[124:127], v[92:95], v[188:191]
    s_waitcnt lgkmcnt(0)
    v_mfma_f32_16x16x32_bf16 v[192:195], a[64:67], v[64:67], v[192:195]
    ds_read_b128 v[80:83], v224 offset:22528
    v_mfma_f32_16x16x32_bf16 v[192:195], a[80:83], v[68:71], v[192:195]
    ds_read_b128 v[84:87], v225 offset:22528
    v_mfma_f32_16x16x32_bf16 v[192:195], a[96:99], v[72:75], v[192:195]
    ds_read_b128 v[88:91], v224 offset:30720
    v_mfma_f32_16x16x32_bf16 v[192:195], a[112:115], v[76:79], v[192:195]
    ds_read_b128 v[92:95], v225 offset:30720
    v_mfma_f32_16x16x32_bf16 v[196:199], a[68:71], v[64:67], v[196:199]
    v_mfma_f32_16x16x32_bf16 v[196:199], a[84:87], v[68:71], v[196:199]
    v_mfma_f32_16x16x32_bf16 v[196:199], a[100:103], v[72:75], v[196:199]
    v_mfma_f32_16x16x32_bf16 v[196:199], a[116:119], v[76:79], v[196:199]
    v_mfma_f32_16x16x32_bf16 v[200:203], a[72:75], v[64:67], v[200:203]
    v_mfma_f32_16x16x32_bf16 v[200:203], a[88:91], v[68:71], v[200:203]
    v_mfma_f32_16x16x32_bf16 v[200:203], a[104:107], v[72:75], v[200:203]
    v_mfma_f32_16x16x32_bf16 v[200:203], a[120:123], v[76:79], v[200:203]
    v_mfma_f32_16x16x32_bf16 v[204:207], a[76:79], v[64:67], v[204:207]
    v_mfma_f32_16x16x32_bf16 v[204:207], a[92:95], v[68:71], v[204:207]
    v_mfma_f32_16x16x32_bf16 v[204:207], a[108:111], v[72:75], v[204:207]
    v_mfma_f32_16x16x32_bf16 v[204:207], a[124:127], v[76:79], v[204:207]
    s_waitcnt vmcnt(9) lgkmcnt(0)
    s_barrier
    v_mfma_f32_16x16x32_bf16 v[208:211], a[64:67], v[80:83], v[208:211]
    ds_read_b128 v[64:67], v224 offset:32768
    v_mfma_f32_16x16x32_bf16 v[208:211], a[80:83], v[84:87], v[208:211]
    ds_read_b128 v[68:71], v225 offset:32768
    v_mfma_f32_16x16x32_bf16 v[208:211], a[96:99], v[88:91], v[208:211]
    ds_read_b128 v[72:75], v224 offset:40960
    s_add_u32 s38, s36, 69632
    buffer_store_dwordx4 v[4:7], v240, s[16:19], s38 offen offset:512 sc1
    v_mfma_f32_16x16x32_bf16 v[208:211], a[112:115], v[92:95], v[208:211]
    ds_read_b128 v[76:79], v225 offset:40960
    v_mfma_f32_16x16x32_bf16 v[212:215], a[68:71], v[80:83], v[212:215]
    v_mfma_f32_16x16x32_bf16 v[212:215], a[84:87], v[84:87], v[212:215]
    v_mfma_f32_16x16x32_bf16 v[212:215], a[100:103], v[88:91], v[212:215]
    v_mfma_f32_16x16x32_bf16 v[212:215], a[116:119], v[92:95], v[212:215]
    v_mfma_f32_16x16x32_bf16 v[216:219], a[72:75], v[80:83], v[216:219]
    v_mfma_f32_16x16x32_bf16 v[216:219], a[88:91], v[84:87], v[216:219]
    v_mfma_f32_16x16x32_bf16 v[216:219], a[104:107], v[88:91], v[216:219]
    v_mfma_f32_16x16x32_bf16 v[216:219], a[120:123], v[92:95], v[216:219]
    v_mfma_f32_16x16x32_bf16 v[220:223], a[76:79], v[80:83], v[220:223]
    v_mfma_f32_16x16x32_bf16 v[220:223], a[92:95], v[84:87], v[220:223]
    v_mfma_f32_16x16x32_bf16 v[220:223], a[108:111], v[88:91], v[220:223]
    v_mfma_f32_16x16x32_bf16 v[220:223], a[124:127], v[92:95], v[220:223]
    s_waitcnt lgkmcnt(0)
    v_mfma_f32_16x16x32_bf16 v[160:163], a[128:131], v[64:67], v[160:163]
    ds_read_b128 v[80:83], v224 offset:34816
    v_mfma_f32_16x16x32_bf16 v[160:163], a[144:147], v[68:71], v[160:163]
    ds_read_b128 v[84:87], v225 offset:34816
    v_mfma_f32_16x16x32_bf16 v[160:163], a[160:163], v[72:75], v[160:163]
    ds_read_b128 v[88:91], v224 offset:43008
    v_mfma_f32_16x16x32_bf16 v[160:163], a[176:179], v[76:79], v[160:163]
    ds_read_b128 v[92:95], v225 offset:43008
    v_mfma_f32_16x16x32_bf16 v[164:167], a[132:135], v[64:67], v[164:167]
    v_mfma_f32_16x16x32_bf16 v[164:167], a[148:151], v[68:71], v[164:167]
    v_mfma_f32_16x16x32_bf16 v[164:167], a[164:167], v[72:75], v[164:167]
    v_mfma_f32_16x16x32_bf16 v[164:167], a[180:183], v[76:79], v[164:167]
    v_mfma_f32_16x16x32_bf16 v[168:171], a[136:139], v[64:67], v[168:171]
    buffer_load_dword v254, off, s[88:91], s39 sc1
    s_add_u32 s38, s36, 65536
    buffer_store_dwordx4 v[8:11], v240, s[16:19], s38 offen offset:3584 sc1
    v_mfma_f32_16x16x32_bf16 v[168:171], a[152:155], v[68:71], v[168:171]
    v_mfma_f32_16x16x32_bf16 v[168:171], a[168:171], v[72:75], v[168:171]
    v_mfma_f32_16x16x32_bf16 v[168:171], a[184:187], v[76:79], v[168:171]
    v_mfma_f32_16x16x32_bf16 v[172:175], a[140:143], v[64:67], v[172:175]
    v_mfma_f32_16x16x32_bf16 v[172:175], a[156:159], v[68:71], v[172:175]
    v_mfma_f32_16x16x32_bf16 v[172:175], a[172:175], v[72:75], v[172:175]
    v_mfma_f32_16x16x32_bf16 v[172:175], a[188:191], v[76:79], v[172:175]
    s_waitcnt lgkmcnt(0)
    v_mfma_f32_16x16x32_bf16 v[176:179], a[128:131], v[80:83], v[176:179]
    ds_read_b128 v[64:67], v224 offset:36864
    v_mfma_f32_16x16x32_bf16 v[176:179], a[144:147], v[84:87], v[176:179]
    ds_read_b128 v[68:71], v225 offset:36864
    v_mfma_f32_16x16x32_bf16 v[176:179], a[160:163], v[88:91], v[176:179]
    ds_read_b128 v[72:75], v224 offset:45056
    v_mfma_f32_16x16x32_bf16 v[176:179], a[176:179], v[92:95], v[176:179]
    ds_read_b128 v[76:79], v225 offset:45056
    v_mfma_f32_16x16x32_bf16 v[180:183], a[132:135], v[80:83], v[180:183]
    v_mfma_f32_16x16x32_bf16 v[180:183], a[148:151], v[84:87], v[180:183]
    v_mfma_f32_16x16x32_bf16 v[180:183], a[164:167], v[88:91], v[180:183]
    v_mfma_f32_16x16x32_bf16 v[180:183], a[180:183], v[92:95], v[180:183]
    v_mfma_f32_16x16x32_bf16 v[184:187], a[136:139], v[80:83], v[184:187]
    v_mfma_f32_16x16x32_bf16 v[184:187], a[152:155], v[84:87], v[184:187]
    v_mfma_f32_16x16x32_bf16 v[184:187], a[168:171], v[88:91], v[184:187]
    v_mfma_f32_16x16x32_bf16 v[184:187], a[184:187], v[92:95], v[184:187]
    v_mfma_f32_16x16x32_bf16 v[188:191], a[140:143], v[80:83], v[188:191]
    v_mfma_f32_16x16x32_bf16 v[188:191], a[156:159], v[84:87], v[188:191]
    s_add_u32 s38, s36, 69632
    buffer_store_dwordx4 v[12:15], v240, s[16:19], s38 offen offset:1536 sc1
    v_mfma_f32_16x16x32_bf16 v[188:191], a[172:175], v[88:91], v[188:191]
    v_mfma_f32_16x16x32_bf16 v[188:191], a[188:191], v[92:95], v[188:191]
    s_waitcnt lgkmcnt(0)
    v_mfma_f32_16x16x32_bf16 v[192:195], a[128:131], v[64:67], v[192:195]
    ds_read_b128 v[80:83], v224 offset:38912
    v_mfma_f32_16x16x32_bf16 v[192:195], a[144:147], v[68:71], v[192:195]
    ds_read_b128 v[84:87], v225 offset:38912
    v_mfma_f32_16x16x32_bf16 v[192:195], a[160:163], v[72:75], v[192:195]
    ds_read_b128 v[88:91], v224 offset:47104
    v_mfma_f32_16x16x32_bf16 v[192:195], a[176:179], v[76:79], v[192:195]
    ds_read_b128 v[92:95], v225 offset:47104
    v_mfma_f32_16x16x32_bf16 v[196:199], a[132:135], v[64:67], v[196:199]
    v_mfma_f32_16x16x32_bf16 v[196:199], a[148:151], v[68:71], v[196:199]
    v_mfma_f32_16x16x32_bf16 v[196:199], a[164:167], v[72:75], v[196:199]
    v_mfma_f32_16x16x32_bf16 v[196:199], a[180:183], v[76:79], v[196:199]
    v_mfma_f32_16x16x32_bf16 v[200:203], a[136:139], v[64:67], v[200:203]
    v_mfma_f32_16x16x32_bf16 v[200:203], a[152:155], v[68:71], v[200:203]
    v_mfma_f32_16x16x32_bf16 v[200:203], a[168:171], v[72:75], v[200:203]
    v_mfma_f32_16x16x32_bf16 v[200:203], a[184:187], v[76:79], v[200:203]
    v_mfma_f32_16x16x32_bf16 v[204:207], a[140:143], v[64:67], v[204:207]
    v_mfma_f32_16x16x32_bf16 v[204:207], a[156:159], v[68:71], v[204:207]
    v_mfma_f32_16x16x32_bf16 v[204:207], a[172:175], v[72:75], v[204:207]
    v_mfma_f32_16x16x32_bf16 v[204:207], a[188:191], v[76:79], v[204:207]
    s_waitcnt lgkmcnt(0)
    v_mfma_f32_16x16x32_bf16 v[208:211], a[128:131], v[80:83], v[208:211]
    ds_read_b128 v[64:67], v224 offset:49152
    v_mfma_f32_16x16x32_bf16 v[208:211], a[144:147], v[84:87], v[208:211]
    ds_read_b128 v[68:71], v224 offset:51200
    v_mfma_f32_16x16x32_bf16 v[208:211], a[160:163], v[88:91], v[208:211]
    ds_read_b128 v[72:75], v224 offset:53248
    v_mfma_f32_16x16x32_bf16 v[208:211], a[176:179], v[92:95], v[208:211]
    ds_read_b128 v[76:79], v224 offset:55296
    s_add_u32 s38, s36, 73728
    buffer_store_dwordx4 v[16:19], v240, s[16:19], s38 offen offset:2560 sc1
    v_mfma_f32_16x16x32_bf16 v[212:215], a[132:135], v[80:83], v[212:215]
    v_mfma_f32_16x16x32_bf16 v[212:215], a[148:151], v[84:87], v[212:215]
    v_mfma_f32_16x16x32_bf16 v[212:215], a[164:167], v[88:91], v[212:215]
    v_mfma_f32_16x16x32_bf16 v[212:215], a[180:183], v[92:95], v[212:215]
    v_mfma_f32_16x16x32_bf16 v[216:219], a[136:139], v[80:83], v[216:219]
    v_mfma_f32_16x16x32_bf16 v[216:219], a[152:155], v[84:87], v[216:219]
    v_mfma_f32_16x16x32_bf16 v[216:219], a[168:171], v[88:91], v[216:219]
    v_mfma_f32_16x16x32_bf16 v[216:219], a[184:187], v[92:95], v[216:219]
    v_mfma_f32_16x16x32_bf16 v[220:223], a[140:143], v[80:83], v[220:223]
    v_mfma_f32_16x16x32_bf16 v[220:223], a[156:159], v[84:87], v[220:223]
    v_mfma_f32_16x16x32_bf16 v[220:223], a[172:175], v[88:91], v[220:223]
    v_mfma_f32_16x16x32_bf16 v[220:223], a[188:191], v[92:95], v[220:223]
    s_waitcnt vmcnt(3)
    v_readfirstlane_b32 s24, v254
    s_lshl_b32 s25, s3, 16
    s_add_u32 s24, s24, s25
    s_cmp_ge_u32 s24, 32
    s_cbranch_scc0 kf_spin49
kf_spinr50:
    s_waitcnt lgkmcnt(0)
    s_barrier
    v_mfma_f32_16x16x32_bf16 v[160:163], a[192:195], v[64:67], v[160:163]
    ds_read_b128 v[80:83], v225 offset:49152
    v_mfma_f32_16x16x32_bf16 v[164:167], a[196:199], v[64:67], v[164:167]
    ds_read_b128 v[84:87], v225 offset:51200
    v_mfma_f32_16x16x32_bf16 v[168:171], a[200:203], v[64:67], v[168:171]
    ds_read_b128 v[88:91], v225 offset:53248
    v_mfma_f32_16x16x32_bf16 v[172:175], a[204:207], v[64:67], v[172:175]
    ds_read_b128 v[92:95], v225 offset:55296
    v_mfma_f32_16x16x32_bf16 v[176:179], a[192:195], v[68:71], v[176:179]
    v_mfma_f32_16x16x32_bf16 v[180:183], a[196:199], v[68:71], v[180:183]
    v_mfma_f32_16x16x32_bf16 v[184:187], a[200:203], v[68:71], v[184:187]
    v_mfma_f32_16x16x32_bf16 v[188:191], a[204:207], v[68:71], v[188:191]
    v_mfma_f32_16x16x32_bf16 v[192:195], a[192:195], v[72:75], v[192:195]
    buffer_load_dwordx4 a[128:131], v248, s[8:11], s28 offen offset:0 sc1
    s_add_u32 s38, s36, 77824
    buffer_store_dwordx4 v[20:23], v240, s[16:19], s38 offen offset:512 sc1
    v_mfma_f32_16x16x32_bf16 v[196:199], a[196:199], v[72:75], v[196:199]
    v_mfma_f32_16x16x32_bf16 v[200:203], a[200:203], v[72:75], v[200:203]
    buffer_load_dwordx4 a[132:135], v248, s[8:11], s29 offen offset:0 sc1
    v_mfma_f32_16x16x32_bf16 v[204:207], a[204:207], v[72:75], v[204:207]
    v_mfma_f32_16x16x32_bf16 v[208:211], a[192:195], v[76:79], v[208:211]
    v_mfma_f32_16x16x32_bf16 v[212:215], a[196:199], v[76:79], v[212:215]
    buffer_load_dwordx4 a[136:139], v249, s[8:11], s28 offen offset:0 sc1
    v_mfma_f32_16x16x32_bf16 v[216:219], a[200:203], v[76:79], v[216:219]
    v_mfma_f32_16x16x32_bf16 v[220:223], a[204:207], v[76:79], v[220:223]
    s_waitcnt lgkmcnt(0)
    v_mfma_f32_16x16x32_bf16 v[160:163], a[208:211], v[80:83], v[160:163]
    ds_read_b128 v[64:67], v224 offset:57344
    v_mfma_f32_16x16x32_bf16 v[164:167], a[212:215], v[80:83], v[164:167]
    ds_read_b128 v[68:71], v224 offset:59392
    v_mfma_f32_16x16x32_bf16 v[168:171], a[216:219], v[80:83], v[168:171]
    ds_read_b128 v[72:75], v224 offset:61440
    v_mfma_f32_16x16x32_bf16 v[172:175], a[220:223], v[80:83], v[172:175]
    ds_read_b128 v[76:79], v224 offset:63488
    v_mfma_f32_16x16x32_bf16 v[176:179], a[208:211], v[84:87], v[176:179]
    v_mfma_f32_16x16x32_bf16 v[180:183], a[212:215], v[84:87], v[180:183]
    v_mfma_f32_16x16x32_bf16 v[184:187], a[216:219], v[84:87], v[184:187]
    v_mfma_f32_16x16x32_bf16 v[188:191], a[220:223], v[84:87], v[188:191]
    v_mfma_f32_16x16x32_bf16 v[192:195], a[208:211], v[88:91], v[192:195]
    buffer_load_dwordx4 a[140:143], v249, s[8:11], s29 offen offset:0 sc1
    v_mfma_f32_16x16x32_bf16 v[196:199], a[212:215], v[88:91], v[196:199]
    v_mfma_f32_16x16x32_bf16 v[200:203], a[216:219], v[88:91], v[200:203]
    buffer_load_dwordx4 a[144:147], v248, s[8:11], s28 offen offset:1024 sc1
    v_mfma_f32_16x16x32_bf16 v[204:207], a[220:223], v[88:91], v[204:207]
    v_mfma_f32_16x16x32_bf16 v[208:211], a[208:211], v[92:95], v[208:211]
    v_mfma_f32_16x16x32_bf16 v[212:215], a[212:215], v[92:95], v[212:215]
    buffer_load_dwordx4 a[148:151], v248, s[8:11], s29 offen offset:1024 sc1
    v_mfma_f32_16x16x32_bf16 v[216:219], a[216:219], v[92:95], v[216:219]
    s_add_u32 s38, s36, 73728
    buffer_store_dwordx4 v[24:27], v240, s[16:19], s38 offen offset:3584 sc1
    v_mfma_f32_16x16x32_bf16 v[220:223], a[220:223], v[92:95], v[220:223]
    s_waitcnt lgkmcnt(0)
    v_mfma_f32_16x16x32_bf16 v[160:163], a[224:227], v[64:67], v[160:163]
    ds_read_b128 v[80:83], v225 offset:57344
    v_mfma_f32_16x16x32_bf16 v[164:167], a[228:231], v[64:67], v[164:167]
    ds_read_b128 v[84:87], v225 offset:59392
    v_mfma_f32_16x16x32_bf16 v[168:171], a[232:235], v[64:67], v[168:171]
    ds_read_b128 v[88:91], v225 offset:61440
    v_mfma_f32_16x16x32_bf16 v[172:175], a[236:239], v[64:67], v[172:175]
    ds_read_b128 v[92:95], v225 offset:63488
    v_mfma_f32_16x16x32_bf16 v[176:179], a[224:227], v[68:71], v[176:179]
    v_mfma_f32_16x16x32_bf16 v[180:183], a[228:231], v[68:71], v[180:183]
    v_mfma_f32_16x16x32_bf16 v[184:187], a[232:235], v[68:71], v[184:187]
    v_mfma_f32_16x16x32_bf16 v[188:191], a[236:239], v[68:71], v[188:191]
    v_mfma_f32_16x16x32_bf16 v[192:195], a[224:227], v[72:75], v[192:195]
    buffer_load_dwordx4 a[152:155], v249, s[8:11], s28 offen offset:1024 sc1
    v_mfma_f32_16x16x32_bf16 v[196:199], a[228:231], v[72:75], v[196:199]
    v_mfma_f32_16x16x32_bf16 v[200:203], a[232:235], v[72:75], v[200:203]
    buffer_load_dwordx4 a[156:159], v249, s[8:11], s29 offen offset:1024 sc1
    v_mfma_f32_16x16x32_bf16 v[204:207], a[236:239], v[72:75], v[204:207]
    v_mfma_f32_16x16x32_bf16 v[208:211], a[224:227], v[76:79], v[208:211]
    v_mfma_f32_16x16x32_bf16 v[212:215], a[228:231], v[76:79], v[212:215]
    buffer_load_dwordx4 a[160:163], v248, s[8:11], s28 offen offset:2048 sc1
    v_mfma_f32_16x16x32_bf16 v[216:219], a[232:235], v[76:79], v[216:219]
    v_mfma_f32_16x16x32_bf16 v[220:223], a[236:239], v[76:79], v[220:223]
    s_waitcnt vmcnt(38) lgkmcnt(0)
    s_barrier
    v_mfma_f32_16x16x32_bf16 v[160:163], a[240:243], v[80:83], v[160:163]
    ds_read_b64_tr_b16 a[192:193], v246 offset:0
    v_mfma_f32_16x16x32_bf16 v[164:167], a[244:247], v[80:83], v[164:167]
    ds_read_b64_tr_b16 a[194:195], v246 offset:1024
    v_mfma_f32_16x16x32_bf16 v[168:171], a[248:251], v[80:83], v[168:171]
    ds_read_b64_tr_b16 a[196:197], v238 offset:0
    v_mfma_f32_16x16x32_bf16 v[172:175], a[252:255], v[80:83], v[172:175]
    ds_read_b64_tr_b16 a[198:199], v238 offset:1024
    v_mfma_f32_16x16x32_bf16 v[176:179], a[240:243], v[84:87], v[176:179]
    ds_read_b64_tr_b16 a[200:201], v246 offset:256
    s_add_u32 s38, s36, 77824
    buffer_store_dwordx4 v[28:31], v240, s[16:19], s38 offen offset:1536 sc1
    v_mfma_f32_16x16x32_bf16 v[180:183], a[244:247], v[84:87], v[180:183]
    ds_read_b64_tr_b16 a[202:203], v246 offset:1280
    v_mfma_f32_16x16x32_bf16 v[184:187], a[248:251], v[84:87], v[184:187]
    ds_read_b64_tr_b16 a[204:205], v238 offset:256
    v_mfma_f32_16x16x32_bf16 v[188:191], a[252:255], v[84:87], v[188:191]
    ds_read_b64_tr_b16 a[206:207], v238 offset:1280
    v_mfma_f32_16x16x32_bf16 v[192:195], a[240:243], v[88:91], v[192:195]
    buffer_load_dwordx4 a[164:167], v248, s[8:11], s29 offen offset:2048 sc1
    v_mfma_f32_16x16x32_bf16 v[196:199], a[244:247], v[88:91], v[196:199]
    v_cvt_pk_bf16_f32 v32, v160, v161
    v_cvt_pk_bf16_f32 v33, v162, v163
    v_mfma_f32_16x16x32_bf16 v[200:203], a[248:251], v[88:91], v[200:203]
    buffer_load_dwordx4 a[168:171], v249, s[8:11], s28 offen offset:2048 sc1
    v_cvt_pk_bf16_f32 v34, v164, v165
    v_cvt_pk_bf16_f32 v35, v166, v167
    v_mfma_f32_16x16x32_bf16 v[204:207], a[252:255], v[88:91], v[204:207]
    v_cvt_pk_bf16_f32 v36, v168, v169
    v_cvt_pk_bf16_f32 v37, v170, v171
    v_mfma_f32_16x16x32_bf16 v[208:211], a[240:243], v[92:95], v[208:211]
    v_cvt_pk_bf16_f32 v38, v172, v173
    v_cvt_pk_bf16_f32 v39, v174, v175
    v_mfma_f32_16x16x32_bf16 v[212:215], a[244:247], v[92:95], v[212:215]
    buffer_load_dwordx4 a[172:175], v249, s[8:11], s29 offen offset:2048 sc1
    v_cvt_pk_bf16_f32 v40, v176, v177
    v_cvt_pk_bf16_f32 v41, v178, v179
    v_mfma_f32_16x16x32_bf16 v[216:219], a[248:251], v[92:95], v[216:219]
    v_cvt_pk_bf16_f32 v42, v180, v181
    v_cvt_pk_bf16_f32 v43, v182, v183
    v_mfma_f32_16x16x32_bf16 v[220:223], a[252:255], v[92:95], v[220:223]
    v_cvt_pk_bf16_f32 v44, v184, v185
    v_cvt_pk_bf16_f32 v45, v186, v187
    s_nop 3
    v_cvt_pk_bf16_f32 v46, v188, v189
    v_cvt_pk_bf16_f32 v47, v190, v191
    v_cvt_pk_bf16_f32 v48, v192, v193
    v_cvt_pk_bf16_f32 v49, v194, v195
    v_cvt_pk_bf16_f32 v50, v196, v197
    v_cvt_pk_bf16_f32 v51, v198, v199
    v_cvt_pk_bf16_f32 v52, v200, v201
    v_cvt_pk_bf16_f32 v53, v202, v203
    v_cvt_pk_bf16_f32 v54, v204, v205
    v_cvt_pk_bf16_f32 v55, v206, v207
    v_cvt_pk_bf16_f32 v56, v208, v209
    v_cvt_pk_bf16_f32 v57, v210, v211
    v_cvt_pk_bf16_f32 v58, v212, v213
    v_cvt_pk_bf16_f32 v59, v214, v215
    v_cvt_pk_bf16_f32 v60, v216, v217
    v_cvt_pk_bf16_f32 v61, v218, v219
    v_cvt_pk_bf16_f32 v62, v220, v221
    v_cvt_pk_bf16_f32 v63, v222, v223
    s_add_u32 s80, s36, 102144
    s_add_u32 s81, s36, 104192
    s_add_u32 s82, s36, 103168
    s_add_u32 s83, s36, 105216
    s_add_u32 s84, s36, 110336
    s_add_u32 s85, s36, 112384
    s_add_u32 s86, s36, 111360
    s_add_u32 s87, s36, 113408
    s_branch ka_Q
ka_V:
    s_waitcnt lgkmcnt(0)
    v_mfma_f32_16x16x32_bf16 v[96:99], v[64:67], a[0:3], 0
    ds_read_b128 v[80:83], v224 offset:8192
    v_mfma_f32_16x16x32_bf16 v[100:103], v[68:71], a[0:3], 0
    ds_read_b128 v[84:87], v224 offset:10240
    v_mfma_f32_16x16x32_bf16 v[104:107], v[64:67], a[4:7], 0
    ds_read_b128 v[88:91], v224 offset:12288
    v_mfma_f32_16x16x32_bf16 v[108:111], v[68:71], a[4:7], 0
    ds_read_b128 v[92:95], v224 offset:14336
    v_mfma_f32_16x16x32_bf16 v[112:115], v[64:67], a[8:11], 0
    ds_read_b64_tr_b16 a[16:17], v228 offset:4096
    v_mfma_f32_16x16x32_bf16 v[116:119], v[68:71], a[8:11], 0
    ds_read_b64_tr_b16 a[18:19], v228 offset:4608
    v_mfma_f32_16x16x32_bf16 v[120:123], v[64:67], a[12:15], 0
    ds_read_b64_tr_b16 a[20:21], v229 offset:4096
    v_mfma_f32_16x16x32_bf16 v[124:127], v[68:71], a[12:15], 0
    ds_read_b64_tr_b16 a[22:23], v229 offset:4608
    v_mfma_f32_16x16x32_bf16 v[128:131], v[72:75], a[0:3], 0
    s_add_u32 m0, s35, 16384
    s_and_b32 s33, s82, 1023
    s_lshl_b32 s33, s33, 12
    buffer_load_dwordx4 v234, s[48:51], s33 offen lds
    v_mfma_f32_16x16x32_bf16 v[132:135], v[76:79], a[0:3], 0
    v_mfma_f32_16x16x32_bf16 v[136:139], v[72:75], a[4:7], 0
    buffer_load_dwordx4 v235, s[48:51], s33 offen offset:1024 lds
    v_mfma_f32_16x16x32_bf16 v[140:143], v[76:79], a[4:7], 0
    v_mfma_f32_16x16x32_bf16 v[144:147], v[72:75], a[8:11], 0
    s_add_u32 m0, s35, 18432
    s_add_u32 s33, s33, 131072
    buffer_load_dwordx4 v234, s[48:51], s33 offen lds
    v_mfma_f32_16x16x32_bf16 v[148:151], v[76:79], a[8:11], 0
    v_mfma_f32_16x16x32_bf16 v[152:155], v[72:75], a[12:15], 0
    buffer_load_dwordx4 v235, s[48:51], s33 offen offset:1024 lds
    v_mfma_f32_16x16x32_bf16 v[156:159], v[76:79], a[12:15], 0
    s_waitcnt lgkmcnt(0)
    v_mfma_f32_16x16x32_bf16 v[160:163], v[80:83], a[0:3], 0
    ds_read_b128 v[64:67], v225 offset:0
    v_mfma_f32_16x16x32_bf16 v[164:167], v[84:87], a[0:3], 0
    ds_read_b128 v[68:71], v225 offset:2048
    v_mfma_f32_16x16x32_bf16 v[168:171], v[80:83], a[4:7], 0
    ds_read_b128 v[72:75], v225 offset:4096
    v_mfma_f32_16x16x32_bf16 v[172:175], v[84:87], a[4:7], 0
    ds_read_b128 v[76:79], v225 offset:6144
    v_mfma_f32_16x16x32_bf16 v[176:179], v[80:83], a[8:11], 0
    ds_read_b64_tr_b16 a[24:25], v230 offset:4096
    v_mfma_f32_16x16x32_bf16 v[180:183], v[84:87], a[8:11], 0
    ds_read_b64_tr_b16 a[26:27], v230 offset:4608
    v_mfma_f32_16x16x32_bf16 v[184:187], v[80:83], a[12:15], 0
    ds_read_b64_tr_b16 a[28:29], v231 offset:4096
    v_mfma_f32_16x16x32_bf16 v[188:191], v[84:87], a[12:15], 0
    ds_read_b64_tr_b16 a[30:31], v231 offset:4608
    v_mfma_f32_16x16x32_bf16 v[192:195], v[88:91], a[0:3], 0
    s_add_u32 m0, s35, 20480
    s_add_u32 s33, s33, 131072
    buffer_load_dwordx4 v234, s[48:51], s33 offen lds
    v_mfma_f32_16x16x32_bf16 v[196:199], v[92:95], a[0:3], 0
    v_mfma_f32_16x16x32_bf16 v[200:203], v[88:91], a[4:7], 0
    buffer_load_dwordx4 v235, s[48:51], s33 offen offset:1024 lds
    v_mfma_f32_16x16x32_bf16 v[204:207], v[92:95], a[4:7], 0
    v_mfma_f32_16x16x32_bf16 v[208:211], v[88:91], a[8:11], 0
    s_add_u32 m0, s35, 22528
    s_add_u32 s33, s33, 131072
    buffer_load_dwordx4 v234, s[48:51], s33 offen lds
    v_mfma_f32_16x16x32_bf16 v[212:215], v[92:95], a[8:11], 0
    v_mfma_f32_16x16x32_bf16 v[216:219], v[88:91], a[12:15], 0
    buffer_load_dwordx4 v235, s[48:51], s33 offen offset:1024 lds
    v_mfma_f32_16x16x32_bf16 v[220:223], v[92:95], a[12:15], 0
    s_waitcnt vmcnt(13) lgkmcnt(0)
    v_mfma_f32_16x16x32_bf16 v[96:99], v[64:67], a[16:19], v[96:99]
    ds_read_b128 v[80:83], v225 offset:8192
    v_mfma_f32_16x16x32_bf16 v[100:103], v[68:71], a[16:19], v[100:103]
    ds_read_b128 v[84:87], v225 offset:10240
    v_mfma_f32_16x16x32_bf16 v[104:107], v[64:67], a[20:23], v[104:107]
    ds_read_b128 v[88:91], v225 offset:12288
    v_mfma_f32_16x16x32_bf16 v[108:111], v[68:71], a[20:23], v[108:111]
    ds_read_b128 v[92:95], v225 offset:14336
    v_mfma_f32_16x16x32_bf16 v[112:115], v[64:67], a[24:27], v[112:115]
    ds_read_b64_tr_b16 a[32:33], v228 offset:8192
    v_mfma_f32_16x16x32_bf16 v[116:119], v[68:71], a[24:27], v[116:119]
    ds_read_b64_tr_b16 a[34:35], v228 offset:8704
    v_mfma_f32_16x16x32_bf16 v[120:123], v[64:67], a[28:31], v[120:123]
    ds_read_b64_tr_b16 a[36:37], v229 offset:8192
    v_mfma_f32_16x16x32_bf16 v[124:127], v[68:71], a[28:31], v[124:127]
    ds_read_b64_tr_b16 a[38:39], v229 offset:8704
    v_mfma_f32_16x16x32_bf16 v[128:131], v[72:75], a[16:19], v[128:131]
    ds_read_b64_tr_b16 a[40:41], v230 offset:8192
    s_add_u32 m0, s34, 32768
    s_add_u32 s37, s82, 0
    buffer_load_dwordx4 v232, s[44:47], s37 offen lds
    v_mfma_f32_16x16x32_bf16 v[132:135], v[76:79], a[16:19], v[132:135]
    ds_read_b64_tr_b16 a[42:43], v230 offset:8704
    buffer_load_dwordx4 v233, s[44:47], s37 offen offset:1024 lds
    v_mfma_f32_16x16x32_bf16 v[136:139], v[72:75], a[20:23], v[136:139]
    ds_read_b64_tr_b16 a[44:45], v231 offset:8192
    s_add_u32 m0, s34, 40960
    s_add_u32 s37, s82, 65536
    buffer_load_dwordx4 v232, s[44:47], s37 offen lds
    v_mfma_f32_16x16x32_bf16 v[140:143], v[76:79], a[20:23], v[140:143]
    ds_read_b64_tr_b16 a[46:47], v231 offset:8704
    buffer_load_dwordx4 v233, s[44:47], s37 offen offset:1024 lds
    v_mfma_f32_16x16x32_bf16 v[144:147], v[72:75], a[24:27], v[144:147]
    s_add_u32 m0, s35, 0
    s_and_b32 s33, s83, 1023
    s_lshl_b32 s33, s33, 12
    buffer_load_dwordx4 v234, s[48:51], s33 offen lds
    v_mfma_f32_16x16x32_bf16 v[148:151], v[76:79], a[24:27], v[148:151]
    buffer_load_dwordx4 v235, s[48:51], s33 offen offset:1024 lds
    v_mfma_f32_16x16x32_bf16 v[152:155], v[72:75], a[28:31], v[152:155]
    s_add_u32 m0, s35, 2048
    s_add_u32 s33, s33, 131072
    buffer_load_dwordx4 v234, s[48:51], s33 offen lds
    v_mfma_f32_16x16x32_bf16 v[156:159], v[76:79], a[28:31], v[156:159]
    buffer_load_dwordx4 v235, s[48:51], s33 offen offset:1024 lds
    s_waitcnt vmcnt(17) lgkmcnt(0)
    s_barrier
    v_mfma_f32_16x16x32_bf16 v[160:163], v[80:83], a[16:19], v[160:163]
    ds_read_b128 v[64:67], v224 offset:16384
    v_mfma_f32_16x16x32_bf16 v[164:167], v[84:87], a[16:19], v[164:167]
    ds_read_b128 v[68:71], v225 offset:16384
    v_mfma_f32_16x16x32_bf16 v[168:171], v[80:83], a[20:23], v[168:171]
    ds_read_b128 v[72:75], v224 offset:18432
    v_mfma_f32_16x16x32_bf16 v[172:175], v[84:87], a[20:23], v[172:175]
    ds_read_b128 v[76:79], v225 offset:18432
    v_mfma_f32_16x16x32_bf16 v[176:179], v[80:83], a[24:27], v[176:179]
    ds_read_b64_tr_b16 a[48:49], v228 offset:12288
    s_add_u32 m0, s34, 49152
    s_add_u32 s37, s83, 0
    buffer_load_dwordx4 v232, s[44:47], s37 offen lds
    v_mfma_f32_16x16x32_bf16 v[180:183], v[84:87], a[24:27], v[180:183]
    ds_read_b64_tr_b16 a[50:51], v228 offset:12800
    buffer_load_dwordx4 v233, s[44:47], s37 offen offset:1024 lds
    v_mfma_f32_16x16x32_bf16 v[184:187], v[80:83], a[28:31], v[184:187]
    ds_read_b64_tr_b16 a[52:53], v229 offset:12288
    s_add_u32 m0, s34, 57344
    s_add_u32 s37, s83, 65536
    buffer_load_dwordx4 v232, s[44:47], s37 offen lds
    v_mfma_f32_16x16x32_bf16 v[188:191], v[84:87], a[28:31], v[188:191]
    ds_read_b64_tr_b16 a[54:55], v229 offset:12800
    buffer_load_dwordx4 v233, s[44:47], s37 offen offset:1024 lds
    v_mfma_f32_16x16x32_bf16 v[192:195], v[88:91], a[16:19], v[192:195]
    ds_read_b64_tr_b16 a[56:57], v230 offset:12288
    s_add_u32 m0, s34, 0
    s_add_u32 s37, s84, 0
    buffer_load_dwordx4 v232, s[44:47], s37 offen lds
    v_mfma_f32_16x16x32_bf16 v[196:199], v[92:95], a[16:19], v[196:199]
    ds_read_b64_tr_b16 a[58:59], v230 offset:12800
    v_mfma_f32_16x16x32_bf16 v[200:203], v[88:91], a[20:23], v[200:203]
    ds_read_b64_tr_b16 a[60:61], v231 offset:12288
    buffer_load_dwordx4 v233, s[44:47], s37 offen offset:1024 lds
    v_mfma_f32_16x16x32_bf16 v[204:207], v[92:95], a[20:23], v[204:207]
    ds_read_b64_tr_b16 a[62:63], v231 offset:12800
    buffer_load_dwordx4 v[0:3], v236, s[52:55], 0 offen offset:0
    v_mfma_f32_16x16x32_bf16 v[208:211], v[88:91], a[24:27], v[208:211]
    buffer_load_dwordx4 v[4:7], v236, s[52:55], 0 offen offset:512
    v_mfma_f32_16x16x32_bf16 v[212:215], v[92:95], a[24:27], v[212:215]
    buffer_load_dwordx4 v[8:11], v236, s[52:55], 0 offen offset:1024
    v_mfma_f32_16x16x32_bf16 v[216:219], v[88:91], a[28:31], v[216:219]
    buffer_load_dwordx4 v[12:15], v236, s[52:55], 0 offen offset:1536
    v_mfma_f32_16x16x32_bf16 v[220:223], v[92:95], a[28:31], v[220:223]
    s_waitcnt lgkmcnt(0)
    v_mfma_f32_16x16x32_bf16 v[96:99], v[64:67], a[32:35], v[96:99]
    ds_read_b128 v[80:83], v224 offset:20480
    v_mfma_f32_16x16x32_bf16 v[96:99], v[68:71], a[48:51], v[96:99]
    ds_read_b128 v[84:87], v225 offset:20480
    v_mfma_f32_16x16x32_bf16 v[100:103], v[72:75], a[32:35], v[100:103]
    ds_read_b128 v[88:91], v224 offset:22528
    v_mfma_f32_16x16x32_bf16 v[100:103], v[76:79], a[48:51], v[100:103]
    ds_read_b128 v[92:95], v225 offset:22528
    v_mfma_f32_16x16x32_bf16 v[104:107], v[64:67], a[36:39], v[104:107]
    v_mfma_f32_16x16x32_bf16 v[104:107], v[68:71], a[52:55], v[104:107]
    v_mfma_f32_16x16x32_bf16 v[108:111], v[72:75], a[36:39], v[108:111]
    v_mfma_f32_16x16x32_bf16 v[108:111], v[76:79], a[52:55], v[108:111]
    v_mfma_f32_16x16x32_bf16 v[112:115], v[64:67], a[40:43], v[112:115]
    s_add_u32 m0, s35, 4096
    s_add_u32 s33, s33, 131072
    buffer_load_dwordx4 v234, s[48:51], s33 offen lds
    v_mfma_f32_16x16x32_bf16 v[112:115], v[68:71], a[56:59], v[112:115]
    v_mfma_f32_16x16x32_bf16 v[116:119], v[72:75], a[40:43], v[116:119]
    buffer_load_dwordx4 v235, s[48:51], s33 offen offset:1024 lds
    v_mfma_f32_16x16x32_bf16 v[116:119], v[76:79], a[56:59], v[116:119]
    v_mfma_f32_16x16x32_bf16 v[120:123], v[64:67], a[44:47], v[120:123]
    s_add_u32 m0, s35, 6144
    s_add_u32 s33, s33, 131072
    buffer_load_dwordx4 v234, s[48:51], s33 offen lds
    v_mfma_f32_16x16x32_bf16 v[120:123], v[68:71], a[60:63], v[120:123]
    v_mfma_f32_16x16x32_bf16 v[124:127], v[72:75], a[44:47], v[124:127]
    buffer_load_dwordx4 v235, s[48:51], s33 offen offset:1024 lds
    v_mfma_f32_16x16x32_bf16 v[124:127], v[76:79], a[60:63], v[124:127]
    s_waitcnt lgkmcnt(0)
    v_mfma_f32_16x16x32_bf16 v[128:131], v[80:83], a[32:35], v[128:131]
    ds_read_b128 v[64:67], v224 offset:24576
    v_mfma_f32_16x16x32_bf16 v[128:131], v[84:87], a[48:51], v[128:131]
    ds_read_b128 v[68:71], v225 offset:24576
    v_mfma_f32_16x16x32_bf16 v[132:135], v[88:91], a[32:35], v[132:135]
    ds_read_b128 v[72:75], v224 offset:26624
    v_mfma_f32_16x16x32_bf16 v[132:135], v[92:95], a[48:51], v[132:135]
    ds_read_b128 v[76:79], v225 offset:26624
    v_mfma_f32_16x16x32_bf16 v[136:139], v[80:83], a[36:39], v[136:139]
    v_mfma_f32_16x16x32_bf16 v[136:139], v[84:87], a[52:55], v[136:139]
    v_mfma_f32_16x16x32_bf16 v[140:143], v[88:91], a[36:39], v[140:143]
    v_mfma_f32_16x16x32_bf16 v[140:143], v[92:95], a[52:55], v[140:143]
    v_mfma_f32_16x16x32_bf16 v[144:147], v[80:83], a[40:43], v[144:147]
    s_add_u32 m0, s34, 8192
    s_add_u32 s37, s84, 65536
    buffer_load_dwordx4 v232, s[44:47], s37 offen lds
    v_mfma_f32_16x16x32_bf16 v[144:147], v[84:87], a[56:59], v[144:147]
    v_mfma_f32_16x16x32_bf16 v[148:151], v[88:91], a[40:43], v[148:151]
    v_mfma_f32_16x16x32_bf16 v[148:151], v[92:95], a[56:59], v[148:151]
    v_mfma_f32_16x16x32_bf16 v[152:155], v[80:83], a[44:47], v[152:155]
    buffer_load_dwordx4 v233, s[44:47], s37 offen offset:1024 lds
    v_mfma_f32_16x16x32_bf16 v[152:155], v[84:87], a[60:63], v[152:155]
    v_mfma_f32_16x16x32_bf16 v[156:159], v[88:91], a[44:47], v[156:159]
    v_mfma_f32_16x16x32_bf16 v[156:159], v[92:95], a[60:63], v[156:159]
    s_waitcnt vmcnt(24) lgkmcnt(0)
    v_mfma_f32_16x16x32_bf16 v[160:163], v[64:67], a[32:35], v[160:163]
    ds_read_b128 v[80:83], v224 offset:28672
    v_mfma_f32_16x16x32_bf16 v[160:163], v[68:71], a[48:51], v[160:163]
    ds_read_b128 v[84:87], v225 offset:28672
    v_mfma_f32_16x16x32_bf16 v[164:167], v[72:75], a[32:35], v[164:167]
    ds_read_b128 v[88:91], v224 offset:30720
    v_mfma_f32_16x16x32_bf16 v[164:167], v[76:79], a[48:51], v[164:167]
    ds_read_b128 v[92:95], v225 offset:30720
    v_mfma_f32_16x16x32_bf16 v[168:171], v[64:67], a[36:39], v[168:171]
    ds_read_b64_tr_b16 a[64:65], v228 offset:16384
    v_mfma_f32_16x16x32_bf16 v[168:171], v[68:71], a[52:55], v[168:171]
    ds_read_b64_tr_b16 a[66:67], v228 offset:16896
    v_mfma_f32_16x16x32_bf16 v[172:175], v[72:75], a[36:39], v[172:175]
    ds_read_b64_tr_b16 a[68:69], v229 offset:16384
    v_mfma_f32_16x16x32_bf16 v[172:175], v[76:79], a[52:55], v[172:175]
    ds_read_b64_tr_b16 a[70:71], v229 offset:16896
    v_mfma_f32_16x16x32_bf16 v[176:179], v[64:67], a[40:43], v[176:179]
    ds_read_b64_tr_b16 a[72:73], v230 offset:16384
    s_add_u32 m0, s35, 8192
    s_and_b32 s33, s84, 1023
    s_lshl_b32 s33, s33, 12
    buffer_load_dwordx4 v234, s[48:51], s33 offen lds
    v_mfma_f32_16x16x32_bf16 v[176:179], v[68:71], a[56:59], v[176:179]
    ds_read_b64_tr_b16 a[74:75], v230 offset:16896
    v_mfma_f32_16x16x32_bf16 v[180:183], v[72:75], a[40:43], v[180:183]
    ds_read_b64_tr_b16 a[76:77], v231 offset:16384
    buffer_load_dwordx4 v235, s[48:51], s33 offen offset:1024 lds
    v_mfma_f32_16x16x32_bf16 v[180:183], v[76:79], a[56:59], v[180:183]
    ds_read_b64_tr_b16 a[78:79], v231 offset:16896
    v_mfma_f32_16x16x32_bf16 v[184:187], v[64:67], a[44:47], v[184:187]
    s_add_u32 m0, s35, 10240
    s_add_u32 s33, s33, 131072
    buffer_load_dwordx4 v234, s[48:51], s33 offen lds
    v_mfma_f32_16x16x32_bf16 v[184:187], v[68:71], a[60:63], v[184:187]
    v_mfma_f32_16x16x32_bf16 v[188:191], v[72:75], a[44:47], v[188:191]
    buffer_load_dwordx4 v235, s[48:51], s33 offen offset:1024 lds
    v_mfma_f32_16x16x32_bf16 v[188:191], v[76:79], a[60:63], v[188:191]
    s_waitcnt vmcnt(24) lgkmcnt(0)
    s_barrier
    v_mfma_f32_16x16x32_bf16 v[192:195], v[80:83], a[32:35], v[192:195]
    ds_read_b128 v[64:67], v224 offset:32768
    v_mfma_f32_16x16x32_bf16 v[192:195], v[84:87], a[48:51], v[192:195]
    ds_read_b128 v[68:71], v225 offset:32768
    v_mfma_f32_16x16x32_bf16 v[196:199], v[88:91], a[32:35], v[196:199]
    ds_read_b128 v[72:75], v224 offset:34816
    v_mfma_f32_16x16x32_bf16 v[196:199], v[92:95], a[48:51], v[196:199]
    ds_read_b128 v[76:79], v225 offset:34816
    v_mfma_f32_16x16x32_bf16 v[200:203], v[80:83], a[36:39], v[200:203]
    ds_read_b64_tr_b16 a[80:81], v228 offset:20480
    v_mfma_f32_16x16x32_bf16 v[200:203], v[84:87], a[52:55], v[200:203]
    ds_read_b64_tr_b16 a[82:83], v228 offset:20992
    v_mfma_f32_16x16x32_bf16 v[204:207], v[88:91], a[36:39], v[204:207]
    ds_read_b64_tr_b16 a[84:85], v229 offset:20480
    v_mfma_f32_16x16x32_bf16 v[204:207], v[92:95], a[52:55], v[204:207]
    ds_read_b64_tr_b16 a[86:87], v229 offset:20992
    v_mfma_f32_16x16x32_bf16 v[208:211], v[80:83], a[40:43], v[208:211]
    ds_read_b64_tr_b16 a[88:89], v230 offset:20480
    s_add_u32 m0, s34, 16384
    s_add_u32 s37, s85, 0
    buffer_load_dwordx4 v232, s[44:47], s37 offen lds
    v_mfma_f32_16x16x32_bf16 v[208:211], v[84:87], a[56:59], v[208:211]
    ds_read_b64_tr_b16 a[90:91], v230 offset:20992
    v_mfma_f32_16x16x32_bf16 v[212:215], v[88:91], a[40:43], v[212:215]
    ds_read_b64_tr_b16 a[92:93], v231 offset:20480
    v_mfma_f32_16x16x32_bf16 v[212:215], v[92:95], a[56:59], v[212:215]
    ds_read_b64_tr_b16 a[94:95], v231 offset:20992
    v_mfma_f32_16x16x32_bf16 v[216:219], v[80:83], a[44:47], v[216:219]
    buffer_load_dwordx4 v233, s[44:47], s37 offen offset:1024 lds
    v_mfma_f32_16x16x32_bf16 v[216:219], v[84:87], a[60:63], v[216:219]
    v_mfma_f32_16x16x32_bf16 v[220:223], v[88:91], a[44:47], v[220:223]
    v_mfma_f32_16x16x32_bf16 v[220:223], v[92:95], a[60:63], v[220:223]
    s_waitcnt lgkmcnt(0)
    v_mfma_f32_16x16x32_bf16 v[96:99], v[64:67], a[64:67], v[96:99]
    ds_read_b128 v[80:83], v224 offset:36864
    v_mfma_f32_16x16x32_bf16 v[96:99], v[68:71], a[80:83], v[96:99]
    ds_read_b128 v[84:87], v225 offset:36864
    v_mfma_f32_16x16x32_bf16 v[100:103], v[72:75], a[64:67], v[100:103]
    ds_read_b128 v[88:91], v224 offset:38912
    v_mfma_f32_16x16x32_bf16 v[100:103], v[76:79], a[80:83], v[100:103]
    ds_read_b128 v[92:95], v225 offset:38912
    v_mfma_f32_16x16x32_bf16 v[104:107], v[64:67], a[68:71], v[104:107]
    v_mfma_f32_16x16x32_bf16 v[104:107], v[68:71], a[84:87], v[104:107]
    v_mfma_f32_16x16x32_bf16 v[108:111], v[72:75], a[68:71], v[108:111]
    v_mfma_f32_16x16x32_bf16 v[108:111], v[76:79], a[84:87], v[108:111]
    v_mfma_f32_16x16x32_bf16 v[112:115], v[64:67], a[72:75], v[112:115]
    s_add_u32 m0, s35, 12288
    s_add_u32 s33, s33, 131072
    buffer_load_dwordx4 v234, s[48:51], s33 offen lds
    v_mfma_f32_16x16x32_bf16 v[112:115], v[68:71], a[88:91], v[112:115]
    v_mfma_f32_16x16x32_bf16 v[116:119], v[72:75], a[72:75], v[116:119]
    buffer_load_dwordx4 v235, s[48:51], s33 offen offset:1024 lds
    v_mfma_f32_16x16x32_bf16 v[116:119], v[76:79], a[88:91], v[116:119]
    v_mfma_f32_16x16x32_bf16 v[120:123], v[64:67], a[76:79], v[120:123]
    s_add_u32 m0, s35, 14336
    s_add_u32 s33, s33, 131072
    buffer_load_dwordx4 v234, s[48:51], s33 offen lds
    v_mfma_f32_16x16x32_bf16 v[120:123], v[68:71], a[92:95], v[120:123]
    v_mfma_f32_16x16x32_bf16 v[124:127], v[72:75], a[76:79], v[124:127]
    buffer_load_dwordx4 v235, s[48:51], s33 offen offset:1024 lds
    v_mfma_f32_16x16x32_bf16 v[124:127], v[76:79], a[92:95], v[124:127]
    s_waitcnt lgkmcnt(0)
    v_mfma_f32_16x16x32_bf16 v[128:131], v[80:83], a[64:67], v[128:131]
    ds_read_b128 v[64:67], v224 offset:40960
    v_mfma_f32_16x16x32_bf16 v[128:131], v[84:87], a[80:83], v[128:131]
    ds_read_b128 v[68:71], v225 offset:40960
    v_mfma_f32_16x16x32_bf16 v[132:135], v[88:91], a[64:67], v[132:135]
    ds_read_b128 v[72:75], v224 offset:43008
    v_mfma_f32_16x16x32_bf16 v[132:135], v[92:95], a[80:83], v[132:135]
    ds_read_b128 v[76:79], v225 offset:43008
    v_mfma_f32_16x16x32_bf16 v[136:139], v[80:83], a[68:71], v[136:139]
    v_mfma_f32_16x16x32_bf16 v[136:139], v[84:87], a[84:87], v[136:139]
    v_mfma_f32_16x16x32_bf16 v[140:143], v[88:91], a[68:71], v[140:143]
    v_mfma_f32_16x16x32_bf16 v[140:143], v[92:95], a[84:87], v[140:143]
    v_mfma_f32_16x16x32_bf16 v[144:147], v[80:83], a[72:75], v[144:147]
    s_add_u32 m0, s34, 24576
    s_add_u32 s37, s85, 65536
    buffer_load_dwordx4 v232, s[44:47], s37 offen lds
    v_mfma_f32_16x16x32_bf16 v[144:147], v[84:87], a[88:91], v[144:147]
    v_mfma_f32_16x16x32_bf16 v[148:151], v[88:91], a[72:75], v[148:151]
    v_mfma_f32_16x16x32_bf16 v[148:151], v[92:95], a[88:91], v[148:151]
    v_mfma_f32_16x16x32_bf16 v[152:155], v[80:83], a[76:79], v[152:155]
    buffer_load_dwordx4 v233, s[44:47], s37 offen offset:1024 lds
    v_mfma_f32_16x16x32_bf16 v[152:155], v[84:87], a[92:95], v[152:155]
    v_mfma_f32_16x16x32_bf16 v[156:159], v[88:91], a[76:79], v[156:159]
    v_mfma_f32_16x16x32_bf16 v[156:159], v[92:95], a[92:95], v[156:159]
    s_waitcnt vmcnt(14) lgkmcnt(0)
    v_mfma_f32_16x16x32_bf16 v[160:163], v[64:67], a[64:67], v[160:163]
    ds_read_b128 v[80:83], v224 offset:45056
    s_waitcnt vmcnt(18)
    v_mfma_f32_16x16x32_bf16 v[160:163], v[68:71], a[80:83], v[160:163]
    ds_read_b128 v[84:87], v225 offset:45056
    v_lshlrev_b32_e64 v16, 16, v0
    v_mfma_f32_16x16x32_bf16 v[164:167], v[72:75], a[64:67], v[164:167]
    ds_read_b128 v[88:91], v224 offset:47104
    v_and_b32 v17, 0xffff0000, v0
    v_lshlrev_b32_e64 v18, 16, v1
    v_mfma_f32_16x16x32_bf16 v[164:167], v[76:79], a[80:83], v[164:167]
    ds_read_b128 v[92:95], v225 offset:47104
    v_and_b32 v19, 0xffff0000, v1
    v_mfma_f32_16x16x32_bf16 v[168:171], v[64:67], a[68:71], v[168:171]
    ds_read_b64_tr_b16 a[96:97], v228 offset:0
    v_lshlrev_b32_e64 v20, 16, v2
    v_mfma_f32_16x16x32_bf16 v[168:171], v[68:71], a[84:87], v[168:171]
    ds_read_b64_tr_b16 a[98:99], v228 offset:512
    v_and_b32 v21, 0xffff0000, v2
    v_mfma_f32_16x16x32_bf16 v[172:175], v[72:75], a[68:71], v[172:175]
    ds_read_b64_tr_b16 a[100:101], v229 offset:0
    v_lshlrev_b32_e64 v22, 16, v3
    v_mfma_f32_16x16x32_bf16 v[172:175], v[76:79], a[84:87], v[172:175]
    ds_read_b64_tr_b16 a[102:103], v229 offset:512
    v_and_b32 v23, 0xffff0000, v3
    v_mfma_f32_16x16x32_bf16 v[176:179], v[64:67], a[72:75], v[176:179]
    ds_read_b64_tr_b16 a[104:105], v230 offset:0
    s_add_u32 m0, s35, 16384
    s_and_b32 s33, s85, 1023
    s_lshl_b32 s33, s33, 12
    buffer_load_dwordx4 v234, s[48:51], s33 offen lds
    v_mfma_f32_16x16x32_bf16 v[176:179], v[68:71], a[88:91], v[176:179]
    ds_read_b64_tr_b16 a[106:107], v230 offset:512
    buffer_load_dwordx4 v235, s[48:51], s33 offen offset:1024 lds
    v_mfma_f32_16x16x32_bf16 v[180:183], v[72:75], a[72:75], v[180:183]
    ds_read_b64_tr_b16 a[108:109], v231 offset:0
    s_add_u32 m0, s35, 18432
    s_add_u32 s33, s33, 131072
    buffer_load_dwordx4 v234, s[48:51], s33 offen lds
    v_mfma_f32_16x16x32_bf16 v[180:183], v[76:79], a[88:91], v[180:183]
    ds_read_b64_tr_b16 a[110:111], v231 offset:512
    v_lshlrev_b32 v24, 16, v4
    v_and_b32 v25, 0xffff0000, v4
    v_mfma_f32_16x16x32_bf16 v[184:187], v[64:67], a[76:79], v[184:187]
    buffer_load_dwordx4 v235, s[48:51], s33 offen offset:1024 lds
    v_lshlrev_b32_e64 v26, 16, v5
    v_mfma_f32_16x16x32_bf16 v[184:187], v[68:71], a[92:95], v[184:187]
    s_lshl2_add_u32 s26, s4, s3
    s_lshl_b32 s26, s26, 10
    s_add_u32 s26, s26, s32
    s_add_u32 s26, s26, 131072
    v_mfma_f32_16x16x32_bf16 v[188:191], v[72:75], a[76:79], v[188:191]
    v_and_b32 v226, 0x40000380, v251
    buffer_load_dword v241, v226, s[44:47], s26 offen
    v_mfma_f32_16x16x32_bf16 v[188:191], v[76:79], a[92:95], v[188:191]
    s_waitcnt vmcnt(29) lgkmcnt(0)
    s_barrier
    v_mfma_f32_16x16x32_bf16 v[192:195], v[80:83], a[64:67], v[192:195]
    ds_read_b128 v[64:67], v224 offset:49152
    v_and_b32 v27, 0xffff0000, v5
    v_mfma_f32_16x16x32_bf16 v[192:195], v[84:87], a[80:83], v[192:195]
    ds_read_b128 v[68:71], v225 offset:49152
    v_lshlrev_b32 v28, 16, v6
    v_mfma_f32_16x16x32_bf16 v[196:199], v[88:91], a[64:67], v[196:199]
    ds_read_b128 v[72:75], v224 offset:51200
    v_and_b32 v29, 0xffff0000, v6
    v_mfma_f32_16x16x32_bf16 v[196:199], v[92:95], a[80:83], v[196:199]
    ds_read_b128 v[76:79], v225 offset:51200
    v_lshlrev_b32_e64 v30, 16, v7
    v_and_b32 v31, 0xffff0000, v7
    v_mfma_f32_16x16x32_bf16 v[200:203], v[80:83], a[68:71], v[200:203]
    ds_read_b64_tr_b16 a[112:113], v228 offset:4096
    v_lshlrev_b32_e64 v32, 16, v8
    v_mfma_f32_16x16x32_bf16 v[200:203], v[84:87], a[84:87], v[200:203]
    ds_read_b64_tr_b16 a[114:115], v228 offset:4608
    v_and_b32 v33, 0xffff0000, v8
    v_mfma_f32_16x16x32_bf16 v[204:207], v[88:91], a[68:71], v[204:207]
    ds_read_b64_tr_b16 a[116:117], v229 offset:4096
    v_lshlrev_b32_e64 v34, 16, v9
    v_mfma_f32_16x16x32_bf16 v[204:207], v[92:95], a[84:87], v[204:207]
    ds_read_b64_tr_b16 a[118:119], v229 offset:4608
    v_and_b32 v35, 0xffff0000, v9
    v_mfma_f32_16x16x32_bf16 v[208:211], v[80:83], a[72:75], v[208:211]
    ds_read_b64_tr_b16 a[120:121], v230 offset:4096
    s_add_u32 m0, s34, 32768
    s_add_u32 s37, s86, 0
    buffer_load_dwordx4 v232, s[44:47], s37 offen lds
    v_mfma_f32_16x16x32_bf16 v[208:211], v[84:87], a[88:91], v[208:211]
    ds_read_b64_tr_b16 a[122:123], v230 offset:4608
    v_lshlrev_b32 v36, 16, v10
    v_mfma_f32_16x16x32_bf16 v[212:215], v[88:91], a[72:75], v[212:215]
    ds_read_b64_tr_b16 a[124:125], v231 offset:4096
    v_and_b32 v37, 0xffff0000, v10
    v_lshlrev_b32_e64 v38, 16, v11
    v_mfma_f32_16x16x32_bf16 v[212:215], v[92:95], a[88:91], v[212:215]
    ds_read_b64_tr_b16 a[126:127], v231 offset:4608
    v_and_b32 v39, 0xffff0000, v11
    v_mfma_f32_16x16x32_bf16 v[216:219], v[80:83], a[76:79], v[216:219]
    buffer_load_dwordx4 v233, s[44:47], s37 offen offset:1024 lds
    v_lshlrev_b32_e64 v40, 16, v12
    v_mfma_f32_16x16x32_bf16 v[216:219], v[84:87], a[92:95], v[216:219]
    v_and_b32 v41, 0xffff0000, v12
    v_lshlrev_b32_e64 v42, 16, v13
    v_mfma_f32_16x16x32_bf16 v[220:223], v[88:91], a[76:79], v[220:223]
    v_and_b32 v43, 0xffff0000, v13
    v_lshlrev_b32_e64 v44, 16, v14
    v_and_b32 v45, 0xffff0000, v14
    v_mfma_f32_16x16x32_bf16 v[220:223], v[92:95], a[92:95], v[220:223]
    v_lshlrev_b32 v46, 16, v15
    s_waitcnt lgkmcnt(0)
    v_mfma_f32_16x16x32_bf16 v[96:99], v[64:67], a[96:99], v[96:99]
    ds_read_b128 v[80:83], v224 offset:53248
    v_and_b32 v47, 0xffff0000, v15
    v_mfma_f32_16x16x32_bf16 v[96:99], v[68:71], a[112:115], v[96:99]
    ds_read_b128 v[84:87], v225 offset:53248
    v_add_f32_e64 v52, v16, v20
    v_mfma_f32_16x16x32_bf16 v[100:103], v[72:75], a[96:99], v[100:103]
    ds_read_b128 v[88:91], v224 offset:55296
    v_add_f32_e64 v53, v17, v21
    v_mfma_f32_16x16x32_bf16 v[100:103], v[76:79], a[112:115], v[100:103]
    ds_read_b128 v[92:95], v225 offset:55296
    v_add_f32 v54, v18, v22
    v_add_f32 v55, v19, v23
    v_mfma_f32_16x16x32_bf16 v[104:107], v[64:67], a[100:103], v[104:107]
    v_add_f32 v52, v52, v24
    v_add_f32 v53, v53, v25
    v_mfma_f32_16x16x32_bf16 v[104:107], v[68:71], a[116:119], v[104:107]
    v_add_f32 v54, v54, v26
    v_add_f32 v55, v55, v27
    v_mfma_f32_16x16x32_bf16 v[108:111], v[72:75], a[100:103], v[108:111]
    v_add_f32 v52, v52, v28
    v_add_f32 v53, v53, v29
    v_add_f32_e64 v54, v54, v30
    v_mfma_f32_16x16x32_bf16 v[108:111], v[76:79], a[116:119], v[108:111]
    v_add_f32 v55, v55, v31
    v_add_f32 v52, v52, v32
    v_mfma_f32_16x16x32_bf16 v[112:115], v[64:67], a[104:107], v[112:115]
    s_add_u32 m0, s35, 20480
    s_add_u32 s33, s33, 131072
    buffer_load_dwordx4 v234, s[48:51], s33 offen lds
    v_mfma_f32_16x16x32_bf16 v[112:115], v[68:71], a[120:123], v[112:115]
    v_add_f32 v53, v53, v33
    v_add_f32 v54, v54, v34
    v_mfma_f32_16x16x32_bf16 v[116:119], v[72:75], a[104:107], v[116:119]
    buffer_load_dwordx4 v235, s[48:51], s33 offen offset:1024 lds
    v_add_f32 v55, v55, v35
    v_add_f32 v52, v52, v36
    v_mfma_f32_16x16x32_bf16 v[116:119], v[76:79], a[120:123], v[116:119]
    v_add_f32 v53, v53, v37
    v_add_f32 v54, v54, v38
    v_mfma_f32_16x16x32_bf16 v[120:123], v[64:67], a[108:111], v[120:123]
    s_add_u32 m0, s35, 22528
    s_add_u32 s33, s33, 131072
    buffer_load_dwordx4 v234, s[48:51], s33 offen lds
    v_mfma_f32_16x16x32_bf16 v[120:123], v[68:71], a[124:127], v[120:123]
    v_add_f32 v55, v55, v39
    v_add_f32 v52, v52, v40
    v_mfma_f32_16x16x32_bf16 v[124:127], v[72:75], a[108:111], v[124:127]
    buffer_load_dwordx4 v235, s[48:51], s33 offen offset:1024 lds
    v_add_f32 v53, v53, v41
    v_add_f32 v54, v54, v42
    v_mfma_f32_16x16x32_bf16 v[124:127], v[76:79], a[124:127], v[124:127]
    v_add_f32 v55, v55, v43
    s_waitcnt lgkmcnt(0)
    v_mfma_f32_16x16x32_bf16 v[128:131], v[80:83], a[96:99], v[128:131]
    ds_read_b128 v[64:67], v224 offset:57344
    v_add_f32_e64 v52, v52, v44
    v_mfma_f32_16x16x32_bf16 v[128:131], v[84:87], a[112:115], v[128:131]
    ds_read_b128 v[68:71], v225 offset:57344
    v_add_f32_e64 v53, v53, v45
    v_mfma_f32_16x16x32_bf16 v[132:135], v[88:91], a[96:99], v[132:135]
    ds_read_b128 v[72:75], v224 offset:59392
    v_add_f32_e64 v54, v54, v46
    v_mfma_f32_16x16x32_bf16 v[132:135], v[92:95], a[112:115], v[132:135]
    ds_read_b128 v[76:79], v225 offset:59392
    v_add_f32 v55, v55, v47
    v_add_f32 v52, v52, v53
    v_mfma_f32_16x16x32_bf16 v[136:139], v[80:83], a[100:103], v[136:139]
    v_add_f32 v54, v54, v55
    v_add_f32 v48, v52, v54
    v_mfma_f32_16x16x32_bf16 v[136:139], v[84:87], a[116:119], v[136:139]
    s_nop 1
    v_add_f32_dpp v48, v48, v48 quad_perm:[1,0,3,2] row_mask:0xf bank_mask:0xf
    v_mfma_f32_16x16x32_bf16 v[140:143], v[88:91], a[100:103], v[140:143]
    s_nop 1
    v_add_f32_dpp v48, v48, v48 quad_perm:[2,3,0,1] row_mask:0xf bank_mask:0xf
    s_nop 1
    v_mfma_f32_16x16x32_bf16 v[140:143], v[92:95], a[116:119], v[140:143]
    v_add_f32_dpp v48, v48, v48 row_half_mirror row_mask:0xf bank_mask:0xf
    s_nop 1
    v_mfma_f32_16x16x32_bf16 v[144:147], v[80:83], a[104:107], v[144:147]
    s_add_u32 m0, s34, 40960
    s_add_u32 s37, s86, 65536
    buffer_load_dwordx4 v232, s[44:47], s37 offen lds
    v_mfma_f32_16x16x32_bf16 v[144:147], v[84:87], a[120:123], v[144:147]
    v_add_f32_dpp v48, v48, v48 row_mirror row_mask:0xf bank_mask:0xf
    s_nop 0
    v_mfma_f32_16x16x32_bf16 v[148:151], v[88:91], a[104:107], v[148:151]
    buffer_load_dwordx4 v233, s[44:47], s37 offen offset:1024 lds
    v_mov_b32_e64 v49, v48
    s_nop 1
    v_mfma_f32_16x16x32_bf16 v[148:151], v[92:95], a[120:123], v[148:151]
    v_permlane16_swap_b32 v48, v49
    s_nop 0
    v_mfma_f32_16x16x32_bf16 v[152:155], v[80:83], a[108:111], v[152:155]
    v_lshlrev_b32_e64 v227, 3, v240
    v_min_u32 v227, 1920, v227
    s_lshl2_add_u32 s25, s2, s3
    v_mfma_f32_16x16x32_bf16 v[152:155], v[84:87], a[124:127], v[152:155]
    v_add_f32 v48, v48, v49
    v_mul_f32 v48, 0x3a800000, v48
    v_mfma_f32_16x16x32_bf16 v[156:159], v[88:91], a[108:111], v[156:159]
    s_lshl_b32 s25, s25, 13
    s_add_u32 s25, s25, 0
    buffer_load_dword v241, v227, s[12:15], s25 offen
    v_mfma_f32_16x16x32_bf16 v[156:159], v[92:95], a[124:127], v[156:159]
    v_sub_f32 v56, v16, v48
    s_waitcnt vmcnt(16) lgkmcnt(0)
    v_mfma_f32_16x16x32_bf16 v[160:163], v[64:67], a[96:99], v[160:163]
    ds_read_b128 v[80:83], v224 offset:61440
    v_mul_f32 v52, v56, v56
    v_sub_f32 v57, v17, v48
    v_mfma_f32_16x16x32_bf16 v[160:163], v[68:71], a[112:115], v[160:163]
    ds_read_b128 v[84:87], v225 offset:61440
    v_mul_f32_e64 v53, v57, v57
    v_mfma_f32_16x16x32_bf16 v[164:167], v[72:75], a[96:99], v[164:167]
    ds_read_b128 v[88:91], v224 offset:63488
    v_sub_f32_e64 v58, v18, v48
    v_mfma_f32_16x16x32_bf16 v[164:167], v[76:79], a[112:115], v[164:167]
    ds_read_b128 v[92:95], v225 offset:63488
    v_mul_f32_e64 v54, v58, v58
    v_mfma_f32_16x16x32_bf16 v[168:171], v[64:67], a[100:103], v[168:171]
    ds_read_b64_tr_b16 a[128:129], v228 offset:8192
    v_sub_f32_e64 v59, v19, v48
    v_mfma_f32_16x16x32_bf16 v[168:171], v[68:71], a[116:119], v[168:171]
    ds_read_b64_tr_b16 a[130:131], v228 offset:8704
    v_mul_f32 v55, v59, v59
    v_sub_f32 v56, v20, v48
    v_mfma_f32_16x16x32_bf16 v[172:175], v[72:75], a[100:103], v[172:175]
    ds_read_b64_tr_b16 a[132:133], v229 offset:8192
    v_fmac_f32_e64 v52, v56, v56
    v_mfma_f32_16x16x32_bf16 v[172:175], v[76:79], a[116:119], v[172:175]
    ds_read_b64_tr_b16 a[134:135], v229 offset:8704
    v_sub_f32_e64 v57, v21, v48
    v_mfma_f32_16x16x32_bf16 v[176:179], v[64:67], a[104:107], v[176:179]
    ds_read_b64_tr_b16 a[136:137], v230 offset:8192
    s_add_u32 m0, s35, 0
    s_and_b32 s33, s86, 1023
    s_lshl_b32 s33, s33, 12
    buffer_load_dwordx4 v234, s[48:51], s33 offen lds
    v_mfma_f32_16x16x32_bf16 v[176:179], v[68:71], a[120:123], v[176:179]
    ds_read_b64_tr_b16 a[138:139], v230 offset:8704
    v_fmac_f32_e64 v53, v57, v57
    v_mfma_f32_16x16x32_bf16 v[180:183], v[72:75], a[104:107], v[180:183]
    ds_read_b64_tr_b16 a[140:141], v231 offset:8192
    buffer_load_dwordx4 v235, s[48:51], s33 offen offset:1024 lds
    v_mfma_f32_16x16x32_bf16 v[180:183], v[76:79], a[120:123], v[180:183]
    ds_read_b64_tr_b16 a[142:143], v231 offset:8704
    v_sub_f32_e64 v58, v22, v48
    v_mfma_f32_16x16x32_bf16 v[184:187], v[64:67], a[108:111], v[184:187]
    s_add_u32 m0, s35, 2048
    s_add_u32 s33, s33, 131072
    buffer_load_dwordx4 v234, s[48:51], s33 offen lds
    v_mfma_f32_16x16x32_bf16 v[184:187], v[68:71], a[124:127], v[184:187]
    v_fmac_f32 v54, v58, v58
    v_sub_f32 v59, v23, v48
    v_fmac_f32_e64 v55, v59, v59
    v_mfma_f32_16x16x32_bf16 v[188:191], v[72:75], a[108:111], v[188:191]
    buffer_load_dwordx4 v235, s[48:51], s33 offen offset:1024 lds
    v_sub_f32_e64 v56, v24, v48
    v_mfma_f32_16x16x32_bf16 v[188:191], v[76:79], a[124:127], v[188:191]
    s_waitcnt vmcnt(30) lgkmcnt(0)
    s_barrier
    v_mfma_f32_16x16x32_bf16 v[192:195], v[80:83], a[96:99], v[192:195]
    ds_read_b128 v[64:67], v224 offset:0
    v_fmac_f32_e64 v52, v56, v56
    v_mfma_f32_16x16x32_bf16 v[192:195], v[84:87], a[112:115], v[192:195]
    ds_read_b128 v[68:71], v225 offset:0
    v_sub_f32_e64 v57, v25, v48
    v_mfma_f32_16x16x32_bf16 v[196:199], v[88:91], a[96:99], v[196:199]
    ds_read_b128 v[72:75], v224 offset:2048
    v_fmac_f32_e64 v53, v57, v57
    v_mfma_f32_16x16x32_bf16 v[196:199], v[92:95], a[112:115], v[196:199]
    ds_read_b128 v[76:79], v225 offset:2048
    v_sub_f32 v58, v26, v48
    v_fmac_f32 v54, v58, v58
    v_mfma_f32_16x16x32_bf16 v[200:203], v[80:83], a[100:103], v[200:203]
    ds_read_b64_tr_b16 a[144:145], v228 offset:12288
    v_sub_f32_e64 v59, v27, v48
    v_mfma_f32_16x16x32_bf16 v[200:203], v[84:87], a[116:119], v[200:203]
    ds_read_b64_tr_b16 a[146:147], v228 offset:12800
    v_fmac_f32_e64 v55, v59, v59
    v_mfma_f32_16x16x32_bf16 v[204:207], v[88:91], a[100:103], v[204:207]
    ds_read_b64_tr_b16 a[148:149], v229 offset:12288
    v_sub_f32_e64 v56, v28, v48
    v_mfma_f32_16x16x32_bf16 v[204:207], v[92:95], a[116:119], v[204:207]
    ds_read_b64_tr_b16 a[150:151], v229 offset:12800
    v_fmac_f32_e64 v52, v56, v56
    v_mfma_f32_16x16x32_bf16 v[208:211], v[80:83], a[104:107], v[208:211]
    ds_read_b64_tr_b16 a[152:153], v230 offset:12288
    s_add_u32 m0, s34, 49152
    s_add_u32 s37, s87, 0
    buffer_load_dwordx4 v232, s[44:47], s37 offen lds
    v_mfma_f32_16x16x32_bf16 v[208:211], v[84:87], a[120:123], v[208:211]
    ds_read_b64_tr_b16 a[154:155], v230 offset:12800
    v_sub_f32 v57, v29, v48
    v_mfma_f32_16x16x32_bf16 v[212:215], v[88:91], a[104:107], v[212:215]
    ds_read_b64_tr_b16 a[156:157], v231 offset:12288
    v_fmac_f32 v53, v57, v57
    v_sub_f32 v58, v30, v48
    v_mfma_f32_16x16x32_bf16 v[212:215], v[92:95], a[120:123], v[212:215]
    ds_read_b64_tr_b16 a[158:159], v231 offset:12800
    v_fmac_f32_e64 v54, v58, v58
    v_mfma_f32_16x16x32_bf16 v[216:219], v[80:83], a[108:111], v[216:219]
    buffer_load_dwordx4 v233, s[44:47], s37 offen offset:1024 lds
    v_sub_f32_e64 v59, v31, v48
    v_mfma_f32_16x16x32_bf16 v[216:219], v[84:87], a[124:127], v[216:219]
    v_fmac_f32 v55, v59, v59
    v_sub_f32 v56, v32, v48
    v_mfma_f32_16x16x32_bf16 v[220:223], v[88:91], a[108:111], v[220:223]
    v_fmac_f32 v52, v56, v56
    v_sub_f32 v57, v33, v48
    v_fmac_f32_e64 v53, v57, v57
    v_mfma_f32_16x16x32_bf16 v[220:223], v[92:95], a[124:127], v[220:223]
    v_sub_f32 v58, v34, v48
    s_waitcnt lgkmcnt(0)
    v_mfma_f32_16x16x32_bf16 v[96:99], v[64:67], a[128:131], v[96:99]
    ds_read_b128 v[80:83], v224 offset:4096
    v_fmac_f32_e64 v54, v58, v58
    v_mfma_f32_16x16x32_bf16 v[96:99], v[68:71], a[144:147], v[96:99]
    ds_read_b128 v[84:87], v225 offset:4096
    v_sub_f32_e64 v59, v35, v48
    v_mfma_f32_16x16x32_bf16 v[100:103], v[72:75], a[128:131], v[100:103]
    ds_read_b128 v[88:91], v224 offset:6144
    v_fmac_f32_e64 v55, v59, v59
    v_mfma_f32_16x16x32_bf16 v[100:103], v[76:79], a[144:147], v[100:103]
    ds_read_b128 v[92:95], v225 offset:6144
    v_sub_f32 v56, v36, v48
    v_fmac_f32 v52, v56, v56
    v_mfma_f32_16x16x32_bf16 v[104:107], v[64:67], a[132:135], v[104:107]
    v_sub_f32 v57, v37, v48
    v_fmac_f32 v53, v57, v57
    v_mfma_f32_16x16x32_bf16 v[104:107], v[68:71], a[148:151], v[104:107]
    v_sub_f32 v58, v38, v48
    v_fmac_f32 v54, v58, v58
    v_mfma_f32_16x16x32_bf16 v[108:111], v[72:75], a[132:135], v[108:111]
    v_sub_f32 v59, v39, v48
    v_fmac_f32 v55, v59, v59
    v_sub_f32_e64 v56, v40, v48
    v_mfma_f32_16x16x32_bf16 v[108:111], v[76:79], a[148:151], v[108:111]
    v_fmac_f32 v52, v56, v56
    v_sub_f32 v57, v41, v48
    v_mfma_f32_16x16x32_bf16 v[112:115], v[64:67], a[136:139], v[112:115]
    s_add_u32 m0, s35, 4096
    s_add_u32 s33, s33, 131072
    buffer_load_dwordx4 v234, s[48:51], s33 offen lds
    v_mfma_f32_16x16x32_bf16 v[112:115], v[68:71], a[152:155], v[112:115]
    v_fmac_f32 v53, v57, v57
    v_sub_f32 v58, v42, v48
    v_mfma_f32_16x16x32_bf16 v[116:119], v[72:75], a[136:139], v[116:119]
    buffer_load_dwordx4 v235, s[48:51], s33 offen offset:1024 lds
    v_fmac_f32 v54, v58, v58
    v_sub_f32 v59, v43, v48
    v_mfma_f32_16x16x32_bf16 v[116:119], v[76:79], a[152:155], v[116:119]
    v_fmac_f32 v55, v59, v59
    v_sub_f32 v56, v44, v48
    v_mfma_f32_16x16x32_bf16 v[120:123], v[64:67], a[140:143], v[120:123]
    s_add_u32 m0, s35, 6144
    s_add_u32 s33, s33, 131072
    buffer_load_dwordx4 v234, s[48:51], s33 offen lds
    v_mfma_f32_16x16x32_bf16 v[120:123], v[68:71], a[156:159], v[120:123]
    v_fmac_f32 v52, v56, v56
    v_sub_f32 v57, v45, v48
    v_mfma_f32_16x16x32_bf16 v[124:127], v[72:75], a[140:143], v[124:127]
    buffer_load_dwordx4 v235, s[48:51], s33 offen offset:1024 lds
    v_fmac_f32 v53, v57, v57
    v_sub_f32 v58, v46, v48
    v_mfma_f32_16x16x32_bf16 v[124:127], v[76:79], a[156:159], v[124:127]
    v_fmac_f32 v54, v58, v58
    s_waitcnt lgkmcnt(0)
    v_mfma_f32_16x16x32_bf16 v[128:131], v[80:83], a[128:131], v[128:131]
    ds_read_b128 v[64:67], v224 offset:8192
    v_sub_f32_e64 v59, v47, v48
    v_mfma_f32_16x16x32_bf16 v[128:131], v[84:87], a[144:147], v[128:131]
    ds_read_b128 v[68:71], v225 offset:8192
    v_fmac_f32_e64 v55, v59, v59
    v_mfma_f32_16x16x32_bf16 v[132:135], v[88:91], a[128:131], v[132:135]
    ds_read_b128 v[72:75], v224 offset:10240
    v_add_f32_e64 v52, v52, v53
    v_mfma_f32_16x16x32_bf16 v[132:135], v[92:95], a[144:147], v[132:135]
    ds_read_b128 v[76:79], v225 offset:10240
    v_add_f32_e64 v54, v54, v55
    v_mfma_f32_16x16x32_bf16 v[136:139], v[80:83], a[132:135], v[136:139]
    v_add_f32 v51, v52, v54
    s_nop 1
    v_add_f32_dpp v51, v51, v51 quad_perm:[1,0,3,2] row_mask:0xf bank_mask:0xf
    v_mfma_f32_16x16x32_bf16 v[136:139], v[84:87], a[148:151], v[136:139]
    s_nop 1
    v_add_f32_dpp v51, v51, v51 quad_perm:[2,3,0,1] row_mask:0xf bank_mask:0xf
    v_mfma_f32_16x16x32_bf16 v[140:143], v[88:91], a[132:135], v[140:143]
    s_nop 1
    v_add_f32_dpp v51, v51, v51 row_half_mirror row_mask:0xf bank_mask:0xf
    s_nop 1
    v_mfma_f32_16x16x32_bf16 v[140:143], v[92:95], a[148:151], v[140:143]
    v_add_f32_dpp v51, v51, v51 row_mirror row_mask:0xf bank_mask:0xf
    s_nop 0
    v_mfma_f32_16x16x32_bf16 v[144:147], v[80:83], a[136:139], v[144:147]
    s_add_u32 m0, s34, 57344
    s_add_u32 s37, s87, 65536
    buffer_load_dwordx4 v232, s[44:47], s37 offen lds
    v_mfma_f32_16x16x32_bf16 v[144:147], v[84:87], a[152:155], v[144:147]
    v_mov_b32 v49, v51
    s_nop 1
    v_mfma_f32_16x16x32_bf16 v[148:151], v[88:91], a[136:139], v[148:151]
    buffer_load_dwordx4 v233, s[44:47], s37 offen offset:1024 lds
    v_permlane16_swap_b32 v51, v49
    s_nop 0
    v_mfma_f32_16x16x32_bf16 v[148:151], v[92:95], a[152:155], v[148:151]
    v_add_f32_e64 v51, v51, v49
    v_mul_f32 v51, 0x3a800000, v51
    v_mfma_f32_16x16x32_bf16 v[152:155], v[80:83], a[140:143], v[152:155]
    v_lshlrev_b32_e64 v227, 3, v240
    v_min_u32 v227, 1920, v227
    s_lshl2_add_u32 s25, s2, s3
    v_mfma_f32_16x16x32_bf16 v[152:155], v[84:87], a[156:159], v[152:155]
    v_cvt_pk_bf16_f32 v50, v48, v51
    v_and_b32 v51, 0xffff0000, v50
    v_mfma_f32_16x16x32_bf16 v[156:159], v[88:91], a[140:143], v[156:159]
    s_lshl_b32 s25, s25, 13
    s_add_u32 s25, s25, 2048
    buffer_load_dword v241, v227, s[12:15], s25 offen
    v_mfma_f32_16x16x32_bf16 v[156:159], v[92:95], a[156:159], v[156:159]
    v_lshlrev_b32 v50, 16, v50
    s_waitcnt vmcnt(16) lgkmcnt(0)
    v_mfma_f32_16x16x32_bf16 v[160:163], v[64:67], a[128:131], v[160:163]
    ds_read_b128 v[80:83], v224 offset:12288
    v_add_f32 v51, 0x3727c5ac, v51
    v_cvt_pk_bf16_f32 v51, v51, v51
    v_mfma_f32_16x16x32_bf16 v[160:163], v[68:71], a[144:147], v[160:163]
    ds_read_b128 v[84:87], v225 offset:12288
    v_lshlrev_b32_e64 v51, 16, v51
    v_mfma_f32_16x16x32_bf16 v[164:167], v[72:75], a[128:131], v[164:167]
    ds_read_b128 v[88:91], v224 offset:14336
    v_mfma_f32_16x16x32_bf16 v[164:167], v[76:79], a[144:147], v[164:167]
    ds_read_b128 v[92:95], v225 offset:14336
    v_sqrt_f32 v51, v51
    v_mfma_f32_16x16x32_bf16 v[168:171], v[64:67], a[132:135], v[168:171]
    ds_read_b64_tr_b16 a[160:161], v228 offset:16384
    s_nop 0
    v_mfma_f32_16x16x32_bf16 v[168:171], v[68:71], a[148:151], v[168:171]
    ds_read_b64_tr_b16 a[162:163], v228 offset:16896
    v_cvt_pk_bf16_f32 v51, v51, v51
    v_lshlrev_b32_e64 v51, 16, v51
    v_mfma_f32_16x16x32_bf16 v[172:175], v[72:75], a[132:135], v[172:175]
    ds_read_b64_tr_b16 a[164:165], v229 offset:16384
    v_mfma_f32_16x16x32_bf16 v[172:175], v[76:79], a[148:151], v[172:175]
    ds_read_b64_tr_b16 a[166:167], v229 offset:16896
    v_rcp_f32_e64 v51, v51
    v_mfma_f32_16x16x32_bf16 v[176:179], v[64:67], a[136:139], v[176:179]
    ds_read_b64_tr_b16 a[168:169], v230 offset:16384
    s_add_u32 m0, s35, 8192
    s_and_b32 s33, s87, 1023
    s_lshl_b32 s33, s33, 12
    buffer_load_dwordx4 v234, s[48:51], s33 offen lds
    v_mfma_f32_16x16x32_bf16 v[176:179], v[68:71], a[152:155], v[176:179]
    ds_read_b64_tr_b16 a[170:171], v230 offset:16896
    s_nop 0
    v_mfma_f32_16x16x32_bf16 v[180:183], v[72:75], a[136:139], v[180:183]
    ds_read_b64_tr_b16 a[172:173], v231 offset:16384
    buffer_load_dwordx4 v235, s[48:51], s33 offen offset:1024 lds
    v_mfma_f32_16x16x32_bf16 v[180:183], v[76:79], a[152:155], v[180:183]
    ds_read_b64_tr_b16 a[174:175], v231 offset:16896
    v_mul_f32 v51, 0x3e0293ee, v51
    v_mfma_f32_16x16x32_bf16 v[184:187], v[64:67], a[140:143], v[184:187]
    s_add_u32 m0, s35, 10240
    s_add_u32 s33, s33, 131072
    buffer_load_dwordx4 v234, s[48:51], s33 offen lds
    v_mfma_f32_16x16x32_bf16 v[184:187], v[68:71], a[156:159], v[184:187]
    v_sub_f32 v16, v16, v50
    v_sub_f32 v17, v17, v50
    v_cvt_pk_bf16_f32 v17, v16, v17
    v_mfma_f32_16x16x32_bf16 v[188:191], v[72:75], a[140:143], v[188:191]
    buffer_load_dwordx4 v235, s[48:51], s33 offen offset:1024 lds
    v_lshlrev_b32_e64 v16, 16, v17
    v_mfma_f32_16x16x32_bf16 v[188:191], v[76:79], a[156:159], v[188:191]
    s_waitcnt vmcnt(31) lgkmcnt(0)
    s_barrier
    v_mfma_f32_16x16x32_bf16 v[192:195], v[80:83], a[128:131], v[192:195]
    ds_read_b128 v[64:67], v224 offset:16384
    v_and_b32 v17, 0xffff0000, v17
    v_mfma_f32_16x16x32_bf16 v[192:195], v[84:87], a[144:147], v[192:195]
    ds_read_b128 v[68:71], v225 offset:16384
    v_mul_f32_e64 v16, v16, v51
    v_mfma_f32_16x16x32_bf16 v[196:199], v[88:91], a[128:131], v[196:199]
    ds_read_b128 v[72:75], v224 offset:18432
    v_mul_f32_e64 v17, v17, v51
    v_mfma_f32_16x16x32_bf16 v[196:199], v[92:95], a[144:147], v[196:199]
    ds_read_b128 v[76:79], v225 offset:18432
    v_cvt_pk_bf16_f32 v0, v16, v17
    v_sub_f32_e64 v18, v18, v50
    v_mfma_f32_16x16x32_bf16 v[200:203], v[80:83], a[132:135], v[200:203]
    ds_read_b64_tr_b16 a[176:177], v228 offset:20480
    v_sub_f32_e64 v19, v19, v50
    v_mfma_f32_16x16x32_bf16 v[200:203], v[84:87], a[148:151], v[200:203]
    ds_read_b64_tr_b16 a[178:179], v228 offset:20992
    v_cvt_pk_bf16_f32 v19, v18, v19
    v_mfma_f32_16x16x32_bf16 v[204:207], v[88:91], a[132:135], v[204:207]
    ds_read_b64_tr_b16 a[180:181], v229 offset:20480
    v_lshlrev_b32_e64 v18, 16, v19
    v_mfma_f32_16x16x32_bf16 v[204:207], v[92:95], a[148:151], v[204:207]
    ds_read_b64_tr_b16 a[182:183], v229 offset:20992
    v_and_b32 v19, 0xffff0000, v19
    v_mfma_f32_16x16x32_bf16 v[208:211], v[80:83], a[136:139], v[208:211]
    ds_read_b64_tr_b16 a[184:185], v230 offset:20480
    s_add_u32 m0, s34, 0
    s_add_u32 s37, s80, 131072
    buffer_load_dwordx4 v232, s[44:47], s37 offen lds
    v_mfma_f32_16x16x32_bf16 v[208:211], v[84:87], a[152:155], v[208:211]
    ds_read_b64_tr_b16 a[186:187], v230 offset:20992
    v_mul_f32 v18, v18, v51
    v_mfma_f32_16x16x32_bf16 v[212:215], v[88:91], a[136:139], v[212:215]
    ds_read_b64_tr_b16 a[188:189], v231 offset:20480
    v_mul_f32_e64 v19, v19, v51
    v_cvt_pk_bf16_f32 v1, v18, v19
    v_mfma_f32_16x16x32_bf16 v[212:215], v[92:95], a[152:155], v[212:215]
    ds_read_b64_tr_b16 a[190:191], v231 offset:20992
    v_sub_f32_e64 v20, v20, v50
    v_mfma_f32_16x16x32_bf16 v[216:219], v[80:83], a[140:143], v[216:219]
    buffer_load_dwordx4 v233, s[44:47], s37 offen offset:1024 lds
    v_sub_f32_e64 v21, v21, v50
    v_mfma_f32_16x16x32_bf16 v[216:219], v[84:87], a[156:159], v[216:219]
    v_cvt_pk_bf16_f32 v21, v20, v21
    v_lshlrev_b32_e64 v20, 16, v21
    v_mfma_f32_16x16x32_bf16 v[220:223], v[88:91], a[140:143], v[220:223]
    v_and_b32 v21, 0xffff0000, v21
    v_mul_f32 v20, v20, v51
    v_mul_f32 v21, v21, v51
    v_mfma_f32_16x16x32_bf16 v[220:223], v[92:95], a[156:159], v[220:223]
    v_cvt_pk_bf16_f32 v2, v20, v21
    s_waitcnt lgkmcnt(0)
    v_mfma_f32_16x16x32_bf16 v[96:99], v[64:67], a[160:163], v[96:99]
    ds_read_b128 v[80:83], v224 offset:20480
    v_sub_f32 v22, v22, v50
    v_mfma_f32_16x16x32_bf16 v[96:99], v[68:71], a[176:179], v[96:99]
    ds_read_b128 v[84:87], v225 offset:20480
    v_sub_f32_e64 v23, v23, v50
    v_mfma_f32_16x16x32_bf16 v[100:103], v[72:75], a[160:163], v[100:103]
    ds_read_b128 v[88:91], v224 offset:22528
    v_cvt_pk_bf16_f32 v23, v22, v23
    v_mfma_f32_16x16x32_bf16 v[100:103], v[76:79], a[176:179], v[100:103]
    ds_read_b128 v[92:95], v225 offset:22528
    v_lshlrev_b32_e64 v22, 16, v23
    v_and_b32 v23, 0xffff0000, v23
    v_mfma_f32_16x16x32_bf16 v[104:107], v[64:67], a[164:167], v[104:107]
    v_mul_f32 v22, v22, v51
    v_mul_f32 v23, v23, v51
    v_mfma_f32_16x16x32_bf16 v[104:107], v[68:71], a[180:183], v[104:107]
    v_cvt_pk_bf16_f32 v3, v22, v23
    v_sub_f32_e64 v24, v24, v50
    v_mfma_f32_16x16x32_bf16 v[108:111], v[72:75], a[164:167], v[108:111]
    v_sub_f32_e64 v25, v25, v50
    v_cvt_pk_bf16_f32 v25, v24, v25
    v_lshlrev_b32_e64 v24, 16, v25
    v_mfma_f32_16x16x32_bf16 v[108:111], v[76:79], a[180:183], v[108:111]
    v_and_b32 v25, 0xffff0000, v25
    v_mul_f32_e64 v24, v24, v51
    v_mfma_f32_16x16x32_bf16 v[112:115], v[64:67], a[168:171], v[112:115]
    s_add_u32 m0, s35, 12288
    s_add_u32 s33, s33, 131072
    buffer_load_dwordx4 v234, s[48:51], s33 offen lds
    v_mfma_f32_16x16x32_bf16 v[112:115], v[68:71], a[184:187], v[112:115]
    v_mul_f32_e64 v25, v25, v51
    v_cvt_pk_bf16_f32 v4, v24, v25
    v_mfma_f32_16x16x32_bf16 v[116:119], v[72:75], a[168:171], v[116:119]
    buffer_load_dwordx4 v235, s[48:51], s33 offen offset:1024 lds
    v_sub_f32 v26, v26, v50
    v_sub_f32 v27, v27, v50
    v_mfma_f32_16x16x32_bf16 v[116:119], v[76:79], a[184:187], v[116:119]
    v_cvt_pk_bf16_f32 v27, v26, v27
    v_lshlrev_b32_e64 v26, 16, v27
    v_mfma_f32_16x16x32_bf16 v[120:123], v[64:67], a[172:175], v[120:123]
    s_add_u32 m0, s35, 14336
    s_add_u32 s33, s33, 131072
    buffer_load_dwordx4 v234, s[48:51], s33 offen lds
    v_mfma_f32_16x16x32_bf16 v[120:123], v[68:71], a[188:191], v[120:123]
    v_and_b32 v27, 0xffff0000, v27
    v_mul_f32_e64 v26, v26, v51
    v_mfma_f32_16x16x32_bf16 v[124:127], v[72:75], a[172:175], v[124:127]
    buffer_load_dwordx4 v235, s[48:51], s33 offen offset:1024 lds
    v_mul_f32_e64 v27, v27, v51
    v_cvt_pk_bf16_f32 v5, v26, v27
    v_mfma_f32_16x16x32_bf16 v[124:127], v[76:79], a[188:191], v[124:127]
    v_sub_f32 v28, v28, v50
    s_waitcnt lgkmcnt(0)
    v_mfma_f32_16x16x32_bf16 v[128:131], v[80:83], a[160:163], v[128:131]
    ds_read_b128 v[64:67], v224 offset:24576
    v_sub_f32_e64 v29, v29, v50
    v_mfma_f32_16x16x32_bf16 v[128:131], v[84:87], a[176:179], v[128:131]
    ds_read_b128 v[68:71], v225 offset:24576
    v_cvt_pk_bf16_f32 v29, v28, v29
    v_mfma_f32_16x16x32_bf16 v[132:135], v[88:91], a[160:163], v[132:135]
    ds_read_b128 v[72:75], v224 offset:26624
    v_lshlrev_b32_e64 v28, 16, v29
    v_mfma_f32_16x16x32_bf16 v[132:135], v[92:95], a[176:179], v[132:135]
    ds_read_b128 v[76:79], v225 offset:26624
    v_and_b32 v29, 0xffff0000, v29
    v_mfma_f32_16x16x32_bf16 v[136:139], v[80:83], a[164:167], v[136:139]
    v_mul_f32 v28, v28, v51
    v_mul_f32 v29, v29, v51
    v_cvt_pk_bf16_f32 v6, v28, v29
    v_mfma_f32_16x16x32_bf16 v[136:139], v[84:87], a[180:183], v[136:139]
    v_sub_f32 v30, v30, v50
    v_sub_f32 v31, v31, v50
    v_mfma_f32_16x16x32_bf16 v[140:143], v[88:91], a[164:167], v[140:143]
    v_cvt_pk_bf16_f32 v31, v30, v31
    v_lshlrev_b32_e64 v30, 16, v31
    v_and_b32 v31, 0xffff0000, v31
    v_mfma_f32_16x16x32_bf16 v[140:143], v[92:95], a[180:183], v[140:143]
    v_mul_f32 v30, v30, v51
    v_mul_f32 v31, v31, v51
    v_mfma_f32_16x16x32_bf16 v[144:147], v[80:83], a[168:171], v[144:147]
    s_add_u32 m0, s34, 8192
    s_add_u32 s37, s81, 131072
    buffer_load_dwordx4 v232, s[44:47], s37 offen lds
    v_mfma_f32_16x16x32_bf16 v[144:147], v[84:87], a[184:187], v[144:147]
    v_cvt_pk_bf16_f32 v7, v30, v31
    v_sub_f32_e64 v32, v32, v50
    v_mfma_f32_16x16x32_bf16 v[148:151], v[88:91], a[168:171], v[148:151]
    buffer_load_dwordx4 v233, s[44:47], s37 offen offset:1024 lds
    v_sub_f32_e64 v33, v33, v50
    v_mfma_f32_16x16x32_bf16 v[148:151], v[92:95], a[184:187], v[148:151]
    v_cvt_pk_bf16_f32 v33, v32, v33
    v_lshlrev_b32_e64 v32, 16, v33
    v_and_b32 v33, 0xffff0000, v33
    v_mfma_f32_16x16x32_bf16 v[152:155], v[80:83], a[172:175], v[152:155]
    v_lshlrev_b32_e64 v227, 3, v240
    v_min_u32 v227, 1920, v227
    s_lshl2_add_u32 s25, s2, s3
    v_mfma_f32_16x16x32_bf16 v[152:155], v[84:87], a[188:191], v[152:155]
    v_mul_f32 v32, v32, v51
    v_mul_f32_e64 v33, v33, v51
    v_mfma_f32_16x16x32_bf16 v[156:159], v[88:91], a[172:175], v[156:159]
    s_lshl_b32 s25, s25, 13
    s_add_u32 s25, s25, 4096
    buffer_load_dword v241, v227, s[12:15], s25 offen
    v_mfma_f32_16x16x32_bf16 v[156:159], v[92:95], a[188:191], v[156:159]
    v_cvt_pk_bf16_f32 v8, v32, v33
    s_waitcnt vmcnt(16) lgkmcnt(0)
    v_mfma_f32_16x16x32_bf16 v[160:163], v[64:67], a[160:163], v[160:163]
    ds_read_b128 v[80:83], v224 offset:28672
    v_sub_f32 v34, v34, v50
    v_sub_f32 v35, v35, v50
    v_mfma_f32_16x16x32_bf16 v[160:163], v[68:71], a[176:179], v[160:163]
    ds_read_b128 v[84:87], v225 offset:28672
    v_cvt_pk_bf16_f32 v35, v34, v35
    v_mfma_f32_16x16x32_bf16 v[164:167], v[72:75], a[160:163], v[164:167]
    ds_read_b128 v[88:91], v224 offset:30720
    v_lshlrev_b32_e64 v34, 16, v35
    v_mfma_f32_16x16x32_bf16 v[164:167], v[76:79], a[176:179], v[164:167]
    ds_read_b128 v[92:95], v225 offset:30720
    v_and_b32 v35, 0xffff0000, v35
    v_mfma_f32_16x16x32_bf16 v[168:171], v[64:67], a[164:167], v[168:171]
    ds_read_b64_tr_b16 a[192:193], v228 offset:0
    v_mul_f32_e64 v34, v34, v51
    v_mfma_f32_16x16x32_bf16 v[168:171], v[68:71], a[180:183], v[168:171]
    ds_read_b64_tr_b16 a[194:195], v228 offset:512
    v_mul_f32_e64 v35, v35, v51
    v_cvt_pk_bf16_f32 v9, v34, v35
    v_mfma_f32_16x16x32_bf16 v[172:175], v[72:75], a[164:167], v[172:175]
    ds_read_b64_tr_b16 a[196:197], v229 offset:0
    v_sub_f32_e64 v36, v36, v50
    v_mfma_f32_16x16x32_bf16 v[172:175], v[76:79], a[180:183], v[172:175]
    ds_read_b64_tr_b16 a[198:199], v229 offset:512
    v_sub_f32_e64 v37, v37, v50
    v_mfma_f32_16x16x32_bf16 v[176:179], v[64:67], a[168:171], v[176:179]
    ds_read_b64_tr_b16 a[200:201], v230 offset:0
    v_cvt_pk_bf16_f32 v37, v36, v37
    v_mfma_f32_16x16x32_bf16 v[176:179], v[68:71], a[184:187], v[176:179]
    ds_read_b64_tr_b16 a[202:203], v230 offset:512
    v_lshlrev_b32_e64 v36, 16, v37
    v_mfma_f32_16x16x32_bf16 v[180:183], v[72:75], a[168:171], v[180:183]
    ds_read_b64_tr_b16 a[204:205], v231 offset:0
    v_and_b32 v37, 0xffff0000, v37
    v_mfma_f32_16x16x32_bf16 v[180:183], v[76:79], a[184:187], v[180:183]
    ds_read_b64_tr_b16 a[206:207], v231 offset:512
    v_mul_f32 v36, v36, v51
    v_mul_f32 v37, v37, v51
    v_mfma_f32_16x16x32_bf16 v[184:187], v[64:67], a[172:175], v[184:187]
    v_cvt_pk_bf16_f32 v10, v36, v37
    v_sub_f32_e64 v38, v38, v50
    v_mfma_f32_16x16x32_bf16 v[184:187], v[68:71], a[188:191], v[184:187]
    v_sub_f32_e64 v39, v39, v50
    v_cvt_pk_bf16_f32 v39, v38, v39
    v_mfma_f32_16x16x32_bf16 v[188:191], v[72:75], a[172:175], v[188:191]
    v_lshlrev_b32_e64 v38, 16, v39
    v_and_b32 v39, 0xffff0000, v39
    v_mul_f32_e64 v38, v38, v51
    v_mfma_f32_16x16x32_bf16 v[188:191], v[76:79], a[188:191], v[188:191]
    s_waitcnt vmcnt(27) lgkmcnt(0)
    s_barrier
    v_mfma_f32_16x16x32_bf16 v[192:195], v[80:83], a[160:163], v[192:195]
    ds_read_b128 v[64:67], v224 offset:32768
    v_mul_f32_e64 v39, v39, v51
    v_mfma_f32_16x16x32_bf16 v[192:195], v[84:87], a[176:179], v[192:195]
    ds_read_b128 v[68:71], v225 offset:32768
    v_cvt_pk_bf16_f32 v11, v38, v39
    v_mfma_f32_16x16x32_bf16 v[196:199], v[88:91], a[160:163], v[196:199]
    ds_read_b128 v[72:75], v224 offset:34816
    v_sub_f32_e64 v40, v40, v50
    v_mfma_f32_16x16x32_bf16 v[196:199], v[92:95], a[176:179], v[196:199]
    ds_read_b128 v[76:79], v225 offset:34816
    v_sub_f32_e64 v41, v41, v50
    v_mfma_f32_16x16x32_bf16 v[200:203], v[80:83], a[164:167], v[200:203]
    ds_read_b64_tr_b16 a[208:209], v228 offset:4096
    v_cvt_pk_bf16_f32 v41, v40, v41
    v_lshlrev_b32_e64 v40, 16, v41
    v_mfma_f32_16x16x32_bf16 v[200:203], v[84:87], a[180:183], v[200:203]
    ds_read_b64_tr_b16 a[210:211], v228 offset:4608
    v_and_b32 v41, 0xffff0000, v41
    v_mfma_f32_16x16x32_bf16 v[204:207], v[88:91], a[164:167], v[204:207]
    ds_read_b64_tr_b16 a[212:213], v229 offset:4096
    v_mul_f32_e64 v40, v40, v51
    v_mfma_f32_16x16x32_bf16 v[204:207], v[92:95], a[180:183], v[204:207]
    ds_read_b64_tr_b16 a[214:215], v229 offset:4608
    v_mul_f32_e64 v41, v41, v51
    v_mfma_f32_16x16x32_bf16 v[208:211], v[80:83], a[168:171], v[208:211]
    ds_read_b64_tr_b16 a[216:217], v230 offset:4096
    s_add_u32 m0, s34, 16384
    s_add_u32 s37, s82, 131072
    buffer_load_dwordx4 v232, s[44:47], s37 offen lds
    v_mfma_f32_16x16x32_bf16 v[208:211], v[84:87], a[184:187], v[208:211]
    ds_read_b64_tr_b16 a[218:219], v230 offset:4608
    v_cvt_pk_bf16_f32 v12, v40, v41
    v_mfma_f32_16x16x32_bf16 v[212:215], v[88:91], a[168:171], v[212:215]
    ds_read_b64_tr_b16 a[220:221], v231 offset:4096
    v_sub_f32 v42, v42, v50
    v_sub_f32 v43, v43, v50
    v_mfma_f32_16x16x32_bf16 v[212:215], v[92:95], a[184:187], v[212:215]
    ds_read_b64_tr_b16 a[222:223], v231 offset:4608
    v_cvt_pk_bf16_f32 v43, v42, v43
    v_mfma_f32_16x16x32_bf16 v[216:219], v[80:83], a[172:175], v[216:219]
    buffer_load_dwordx4 v233, s[44:47], s37 offen offset:1024 lds
    v_lshlrev_b32_e64 v42, 16, v43
    v_mfma_f32_16x16x32_bf16 v[216:219], v[84:87], a[188:191], v[216:219]
    v_and_b32 v43, 0xffff0000, v43
    v_mul_f32_e64 v42, v42, v51
    v_mfma_f32_16x16x32_bf16 v[220:223], v[88:91], a[172:175], v[220:223]
    v_mul_f32_e64 v43, v43, v51
    v_cvt_pk_bf16_f32 v13, v42, v43
    v_sub_f32_e64 v44, v44, v50
    v_mfma_f32_16x16x32_bf16 v[220:223], v[92:95], a[188:191], v[220:223]
    v_sub_f32 v45, v45, v50
    s_waitcnt lgkmcnt(0)
    v_mfma_f32_16x16x32_bf16 v[96:99], v[64:67], a[192:195], v[96:99]
    ds_read_b128 v[80:83], v224 offset:36864
    v_cvt_pk_bf16_f32 v45, v44, v45
    v_mfma_f32_16x16x32_bf16 v[96:99], v[68:71], a[208:211], v[96:99]
    ds_read_b128 v[84:87], v225 offset:36864
    v_lshlrev_b32_e64 v44, 16, v45
    v_mfma_f32_16x16x32_bf16 v[100:103], v[72:75], a[192:195], v[100:103]
    ds_read_b128 v[88:91], v224 offset:38912
    v_and_b32 v45, 0xffff0000, v45
    v_mfma_f32_16x16x32_bf16 v[100:103], v[76:79], a[208:211], v[100:103]
    ds_read_b128 v[92:95], v225 offset:38912
    v_mul_f32 v44, v44, v51
    v_mul_f32 v45, v45, v51
    v_mfma_f32_16x16x32_bf16 v[104:107], v[64:67], a[196:199], v[104:107]
    v_cvt_pk_bf16_f32 v14, v44, v45
    v_sub_f32_e64 v46, v46, v50
    v_mfma_f32_16x16x32_bf16 v[104:107], v[68:71], a[212:215], v[104:107]
    v_sub_f32_e64 v47, v47, v50
    v_cvt_pk_bf16_f32 v47, v46, v47
    v_mfma_f32_16x16x32_bf16 v[108:111], v[72:75], a[196:199], v[108:111]
    v_lshlrev_b32_e64 v46, 16, v47
    v_and_b32 v47, 0xffff0000, v47
    v_mul_f32_e64 v46, v46, v51
    v_mfma_f32_16x16x32_bf16 v[108:111], v[76:79], a[212:215], v[108:111]
    v_mul_f32_e64 v47, v47, v51
    v_cvt_pk_bf16_f32 v15, v46, v47
    v_mfma_f32_16x16x32_bf16 v[112:115], v[64:67], a[200:203], v[112:115]
    v_mfma_f32_16x16x32_bf16 v[112:115], v[68:71], a[216:219], v[112:115]
    ds_write_b128 v237, v[0:3] offset:0
    v_mfma_f32_16x16x32_bf16 v[116:119], v[72:75], a[200:203], v[116:119]
    ds_write_b128 v237, v[4:7] offset:4096
    v_mfma_f32_16x16x32_bf16 v[116:119], v[76:79], a[216:219], v[116:119]
    ds_write_b128 v237, v[8:11] offset:24576
    v_mfma_f32_16x16x32_bf16 v[120:123], v[64:67], a[204:207], v[120:123]
    ds_write_b128 v237, v[12:15] offset:28672
    v_mfma_f32_16x16x32_bf16 v[120:123], v[68:71], a[220:223], v[120:123]
    v_mfma_f32_16x16x32_bf16 v[124:127], v[72:75], a[204:207], v[124:127]
    v_mfma_f32_16x16x32_bf16 v[124:127], v[76:79], a[220:223], v[124:127]
    s_waitcnt lgkmcnt(0)
    v_mfma_f32_16x16x32_bf16 v[128:131], v[80:83], a[192:195], v[128:131]
    ds_read_b128 v[64:67], v224 offset:40960
    v_mfma_f32_16x16x32_bf16 v[128:131], v[84:87], a[208:211], v[128:131]
    ds_read_b128 v[68:71], v225 offset:40960
    v_mfma_f32_16x16x32_bf16 v[132:135], v[88:91], a[192:195], v[132:135]
    ds_read_b128 v[72:75], v224 offset:43008
    v_mfma_f32_16x16x32_bf16 v[132:135], v[92:95], a[208:211], v[132:135]
    ds_read_b128 v[76:79], v225 offset:43008
    v_mfma_f32_16x16x32_bf16 v[136:139], v[80:83], a[196:199], v[136:139]
    v_mfma_f32_16x16x32_bf16 v[136:139], v[84:87], a[212:215], v[136:139]
    v_mfma_f32_16x16x32_bf16 v[140:143], v[88:91], a[196:199], v[140:143]
    v_mfma_f32_16x16x32_bf16 v[140:143], v[92:95], a[212:215], v[140:143]
    v_mfma_f32_16x16x32_bf16 v[144:147], v[80:83], a[200:203], v[144:147]
    s_add_u32 m0, s34, 24576
    s_add_u32 s37, s83, 131072
    buffer_load_dwordx4 v232, s[44:47], s37 offen lds
    v_mfma_f32_16x16x32_bf16 v[144:147], v[84:87], a[216:219], v[144:147]
    buffer_load_dwordx4 v233, s[44:47], s37 offen offset:1024 lds
    v_mfma_f32_16x16x32_bf16 v[148:151], v[88:91], a[200:203], v[148:151]
    v_mfma_f32_16x16x32_bf16 v[148:151], v[92:95], a[216:219], v[148:151]
    v_lshlrev_b32 v227, 3, v240
    v_min_u32 v227, 1920, v227
    s_lshl2_add_u32 s25, s2, s3
    v_mfma_f32_16x16x32_bf16 v[152:155], v[80:83], a[204:207], v[152:155]
    s_lshl_b32 s25, s25, 13
    s_add_u32 s25, s25, 6144
    buffer_load_dword v241, v227, s[12:15], s25 offen
    v_mfma_f32_16x16x32_bf16 v[152:155], v[84:87], a[220:223], v[152:155]
    v_mfma_f32_16x16x32_bf16 v[156:159], v[88:91], a[204:207], v[156:159]
    buffer_load_dword v254, off, s[88:91], s97 sc1
    v_mfma_f32_16x16x32_bf16 v[156:159], v[92:95], a[220:223], v[156:159]
    s_waitcnt vmcnt(9) lgkmcnt(0)
    v_mfma_f32_16x16x32_bf16 v[160:163], v[64:67], a[192:195], v[160:163]
    ds_read_b128 v[80:83], v224 offset:45056
    v_mfma_f32_16x16x32_bf16 v[160:163], v[68:71], a[208:211], v[160:163]
    ds_read_b128 v[84:87], v225 offset:45056
    s_mul_i32 s38, s2, 100
    v_mfma_f32_16x16x32_bf16 v[164:167], v[72:75], a[192:195], v[164:167]
    ds_read_b128 v[88:91], v224 offset:47104
    v_mfma_f32_16x16x32_bf16 v[164:167], v[76:79], a[208:211], v[164:167]
    ds_read_b128 v[92:95], v225 offset:47104
    v_lshl_add_u32 v60, v253, 2, s38
    v_mfma_f32_16x16x32_bf16 v[168:171], v[64:67], a[196:199], v[168:171]
    ds_read_b64_tr_b16 a[224:225], v228 offset:8192
    v_mfma_f32_16x16x32_bf16 v[168:171], v[68:71], a[212:215], v[168:171]
    ds_read_b64_tr_b16 a[226:227], v228 offset:8704
    v_cmp_gt_u32 vcc, 25, v253
    v_mfma_f32_16x16x32_bf16 v[172:175], v[72:75], a[196:199], v[172:175]
    ds_read_b64_tr_b16 a[228:229], v229 offset:8192
    v_mfma_f32_16x16x32_bf16 v[172:175], v[76:79], a[212:215], v[172:175]
    ds_read_b64_tr_b16 a[230:231], v229 offset:8704
    v_mov_b32_e64 v61, 0
    v_mfma_f32_16x16x32_bf16 v[176:179], v[64:67], a[200:203], v[176:179]
    ds_read_b64_tr_b16 a[232:233], v230 offset:8192
    v_mfma_f32_16x16x32_bf16 v[176:179], v[68:71], a[216:219], v[176:179]
    ds_read_b64_tr_b16 a[234:235], v230 offset:8704
    v_mfma_f32_16x16x32_bf16 v[180:183], v[72:75], a[200:203], v[180:183]
    ds_read_b64_tr_b16 a[236:237], v231 offset:8192
    v_mov_b32 v62, 0x7ffffff0
    v_mfma_f32_16x16x32_bf16 v[180:183], v[76:79], a[216:219], v[180:183]
    ds_read_b64_tr_b16 a[238:239], v231 offset:8704
    v_mfma_f32_16x16x32_bf16 v[184:187], v[64:67], a[204:207], v[184:187]
    v_cndmask_b32 v60, v62, v60, vcc
    v_mfma_f32_16x16x32_bf16 v[184:187], v[68:71], a[220:223], v[184:187]
    buffer_store_dword v61, v60, s[56:59], 0 offen sc1
    v_mfma_f32_16x16x32_bf16 v[188:191], v[72:75], a[204:207], v[188:191]
    v_mfma_f32_16x16x32_bf16 v[188:191], v[76:79], a[220:223], v[188:191]
    s_waitcnt vmcnt(21) lgkmcnt(0)
    s_barrier
    v_mfma_f32_16x16x32_bf16 v[192:195], v[80:83], a[192:195], v[192:195]
    ds_read_b128 v[64:67], v224 offset:49152
    v_mfma_f32_16x16x32_bf16 v[192:195], v[84:87], a[208:211], v[192:195]
    ds_read_b128 v[68:71], v225 offset:49152
    v_mfma_f32_16x16x32_bf16 v[196:199], v[88:91], a[192:195], v[196:199]
    ds_read_b128 v[72:75], v224 offset:51200
    v_mfma_f32_16x16x32_bf16 v[196:199], v[92:95], a[208:211], v[196:199]
    ds_read_b128 v[76:79], v225 offset:51200
    v_mfma_f32_16x16x32_bf16 v[200:203], v[80:83], a[196:199], v[200:203]
    ds_read_b64_tr_b16 a[240:241], v228 offset:12288
    v_mfma_f32_16x16x32_bf16 v[200:203], v[84:87], a[212:215], v[200:203]
    ds_read_b64_tr_b16 a[242:243], v228 offset:12800
    v_mfma_f32_16x16x32_bf16 v[204:207], v[88:91], a[196:199], v[204:207]
    ds_read_b64_tr_b16 a[244:245], v229 offset:12288
    v_mfma_f32_16x16x32_bf16 v[204:207], v[92:95], a[212:215], v[204:207]
    ds_read_b64_tr_b16 a[246:247], v229 offset:12800
    v_mfma_f32_16x16x32_bf16 v[208:211], v[80:83], a[200:203], v[208:211]
    ds_read_b64_tr_b16 a[248:249], v230 offset:12288
    v_lshlrev_b32 v237, 4, v253
    v_add_u32 v237, 81920, v237
    ds_read_b128 v[16:19], v237 offset:0
    ds_read_b128 v[20:23], v237 offset:4096
    ds_read_b128 v[24:27], v237 offset:24576
    ds_read_b128 v[28:31], v237 offset:28672
    s_add_u32 m0, s34, 32768
    s_add_u32 s37, s84, 131072
    buffer_load_dwordx4 v232, s[44:47], s37 offen lds
    v_mfma_f32_16x16x32_bf16 v[208:211], v[84:87], a[216:219], v[208:211]
    ds_read_b64_tr_b16 a[250:251], v230 offset:12800
    v_mfma_f32_16x16x32_bf16 v[212:215], v[88:91], a[200:203], v[212:215]
    ds_read_b64_tr_b16 a[252:253], v231 offset:12288
    v_mfma_f32_16x16x32_bf16 v[212:215], v[92:95], a[216:219], v[212:215]
    ds_read_b64_tr_b16 a[254:255], v231 offset:12800
    v_mfma_f32_16x16x32_bf16 v[216:219], v[80:83], a[204:207], v[216:219]
    buffer_load_dwordx4 v233, s[44:47], s37 offen offset:1024 lds
    v_mfma_f32_16x16x32_bf16 v[216:219], v[84:87], a[220:223], v[216:219]
    v_mfma_f32_16x16x32_bf16 v[220:223], v[88:91], a[204:207], v[220:223]
    v_mfma_f32_16x16x32_bf16 v[220:223], v[92:95], a[220:223], v[220:223]
    s_waitcnt lgkmcnt(0)
    v_mfma_f32_16x16x32_bf16 v[96:99], v[64:67], a[224:227], v[96:99]
    ds_read_b128 v[80:83], v224 offset:53248
    v_mfma_f32_16x16x32_bf16 v[96:99], v[68:71], a[240:243], v[96:99]
    ds_read_b128 v[84:87], v225 offset:53248
    v_mfma_f32_16x16x32_bf16 v[100:103], v[72:75], a[224:227], v[100:103]
    ds_read_b128 v[88:91], v224 offset:55296
    v_mfma_f32_16x16x32_bf16 v[100:103], v[76:79], a[240:243], v[100:103]
    ds_read_b128 v[92:95], v225 offset:55296
    v_mfma_f32_16x16x32_bf16 v[104:107], v[64:67], a[228:231], v[104:107]
    v_mfma_f32_16x16x32_bf16 v[104:107], v[68:71], a[244:247], v[104:107]
    s_mov_b32 s39, 0
    buffer_store_dwordx4 v[16:19], v238, s[8:11], s39 offen sc1
    v_mfma_f32_16x16x32_bf16 v[108:111], v[72:75], a[228:231], v[108:111]
    v_mfma_f32_16x16x32_bf16 v[108:111], v[76:79], a[244:247], v[108:111]
    v_mfma_f32_16x16x32_bf16 v[112:115], v[64:67], a[232:235], v[112:115]
    v_mfma_f32_16x16x32_bf16 v[112:115], v[68:71], a[248:251], v[112:115]
    v_mfma_f32_16x16x32_bf16 v[116:119], v[72:75], a[232:235], v[116:119]
    v_mfma_f32_16x16x32_bf16 v[116:119], v[76:79], a[248:251], v[116:119]
    v_mfma_f32_16x16x32_bf16 v[120:123], v[64:67], a[236:239], v[120:123]
    v_mfma_f32_16x16x32_bf16 v[120:123], v[68:71], a[252:255], v[120:123]
    s_mov_b32 s39, 8192
    buffer_store_dwordx4 v[20:23], v238, s[8:11], s39 offen sc1
    v_mfma_f32_16x16x32_bf16 v[124:127], v[72:75], a[236:239], v[124:127]
    v_mfma_f32_16x16x32_bf16 v[124:127], v[76:79], a[252:255], v[124:127]
    s_waitcnt lgkmcnt(0)
    v_mfma_f32_16x16x32_bf16 v[128:131], v[80:83], a[224:227], v[128:131]
    ds_read_b128 v[64:67], v224 offset:57344
    v_mfma_f32_16x16x32_bf16 v[128:131], v[84:87], a[240:243], v[128:131]
    ds_read_b128 v[68:71], v225 offset:57344
    v_mfma_f32_16x16x32_bf16 v[132:135], v[88:91], a[224:227], v[132:135]
    ds_read_b128 v[72:75], v224 offset:59392
    v_mfma_f32_16x16x32_bf16 v[132:135], v[92:95], a[240:243], v[132:135]
    ds_read_b128 v[76:79], v225 offset:59392
    v_mfma_f32_16x16x32_bf16 v[136:139], v[80:83], a[228:231], v[136:139]
    v_mfma_f32_16x16x32_bf16 v[136:139], v[84:87], a[244:247], v[136:139]
    s_mov_b32 s39, 16384
    buffer_store_dwordx4 v[24:27], v238, s[8:11], s39 offen sc1
    v_mfma_f32_16x16x32_bf16 v[140:143], v[88:91], a[228:231], v[140:143]
    v_mfma_f32_16x16x32_bf16 v[140:143], v[92:95], a[244:247], v[140:143]
    v_mfma_f32_16x16x32_bf16 v[144:147], v[80:83], a[232:235], v[144:147]
    s_add_u32 m0, s34, 40960
    s_add_u32 s37, s85, 131072
    buffer_load_dwordx4 v232, s[44:47], s37 offen lds
    v_mfma_f32_16x16x32_bf16 v[144:147], v[84:87], a[248:251], v[144:147]
    v_mfma_f32_16x16x32_bf16 v[148:151], v[88:91], a[232:235], v[148:151]
    v_mfma_f32_16x16x32_bf16 v[148:151], v[92:95], a[248:251], v[148:151]
    v_mfma_f32_16x16x32_bf16 v[152:155], v[80:83], a[236:239], v[152:155]
    buffer_load_dwordx4 v233, s[44:47], s37 offen offset:1024 lds
    v_mfma_f32_16x16x32_bf16 v[152:155], v[84:87], a[252:255], v[152:155]
    s_mov_b32 s39, 24576
    buffer_store_dwordx4 v[28:31], v238, s[8:11], s39 offen sc1
    v_mfma_f32_16x16x32_bf16 v[156:159], v[88:91], a[236:239], v[156:159]
    v_mfma_f32_16x16x32_bf16 v[156:159], v[92:95], a[252:255], v[156:159]
    s_waitcnt lgkmcnt(0)
    v_mfma_f32_16x16x32_bf16 v[160:163], v[64:67], a[224:227], v[160:163]
    ds_read_b128 v[80:83], v224 offset:61440
    v_mfma_f32_16x16x32_bf16 v[160:163], v[68:71], a[240:243], v[160:163]
    ds_read_b128 v[84:87], v225 offset:61440
    v_mfma_f32_16x16x32_bf16 v[164:167], v[72:75], a[224:227], v[164:167]
    ds_read_b128 v[88:91], v224 offset:63488
    v_mfma_f32_16x16x32_bf16 v[164:167], v[76:79], a[240:243], v[164:167]
    ds_read_b128 v[92:95], v225 offset:63488
    v_mfma_f32_16x16x32_bf16 v[168:171], v[64:67], a[228:231], v[168:171]
    v_mfma_f32_16x16x32_bf16 v[168:171], v[68:71], a[244:247], v[168:171]
    v_mfma_f32_16x16x32_bf16 v[172:175], v[72:75], a[228:231], v[172:175]
    v_mfma_f32_16x16x32_bf16 v[172:175], v[76:79], a[244:247], v[172:175]
    v_mfma_f32_16x16x32_bf16 v[176:179], v[64:67], a[232:235], v[176:179]
    v_mfma_f32_16x16x32_bf16 v[176:179], v[68:71], a[248:251], v[176:179]
    v_cvt_pk_bf16_f32 v0, v96, v97
    v_cvt_pk_bf16_f32 v1, v98, v99
    v_mfma_f32_16x16x32_bf16 v[180:183], v[72:75], a[232:235], v[180:183]
    v_cvt_pk_bf16_f32 v2, v100, v101
    v_cvt_pk_bf16_f32 v3, v102, v103
    v_mfma_f32_16x16x32_bf16 v[180:183], v[76:79], a[248:251], v[180:183]
    v_cvt_pk_bf16_f32 v4, v104, v105
    v_cvt_pk_bf16_f32 v5, v106, v107
    v_mfma_f32_16x16x32_bf16 v[184:187], v[64:67], a[236:239], v[184:187]
    v_cvt_pk_bf16_f32 v6, v108, v109
    v_cvt_pk_bf16_f32 v7, v110, v111
    v_mfma_f32_16x16x32_bf16 v[184:187], v[68:71], a[252:255], v[184:187]
    v_cvt_pk_bf16_f32 v8, v112, v113
    v_cvt_pk_bf16_f32 v9, v114, v115
    v_mfma_f32_16x16x32_bf16 v[188:191], v[72:75], a[236:239], v[188:191]
    v_cvt_pk_bf16_f32 v10, v116, v117
    v_cvt_pk_bf16_f32 v11, v118, v119
    v_mfma_f32_16x16x32_bf16 v[188:191], v[76:79], a[252:255], v[188:191]
    v_cvt_pk_bf16_f32 v12, v120, v121
    v_cvt_pk_bf16_f32 v13, v122, v123
    s_waitcnt vmcnt(16) lgkmcnt(0)
    s_barrier
    v_mfma_f32_16x16x32_bf16 v[192:195], v[80:83], a[224:227], v[192:195]
    ds_read_b128 v[64:67], v224 offset:0
    v_cvt_pk_bf16_f32 v14, v124, v125
    v_cvt_pk_bf16_f32 v15, v126, v127
    v_mfma_f32_16x16x32_bf16 v[192:195], v[84:87], a[240:243], v[192:195]
    ds_read_b128 v[68:71], v225 offset:0
    v_cvt_pk_bf16_f32 v16, v128, v129
    v_cvt_pk_bf16_f32 v17, v130, v131
    v_mfma_f32_16x16x32_bf16 v[196:199], v[88:91], a[224:227], v[196:199]
    ds_read_b128 v[72:75], v224 offset:8192
    v_cvt_pk_bf16_f32 v18, v132, v133
    v_cvt_pk_bf16_f32 v19, v134, v135
    v_mfma_f32_16x16x32_bf16 v[196:199], v[92:95], a[240:243], v[196:199]
    ds_read_b128 v[76:79], v225 offset:8192
    v_cvt_pk_bf16_f32 v20, v136, v137
    v_cvt_pk_bf16_f32 v21, v138, v139
    v_mfma_f32_16x16x32_bf16 v[200:203], v[80:83], a[228:231], v[200:203]
    v_cvt_pk_bf16_f32 v22, v140, v141
    v_cvt_pk_bf16_f32 v23, v142, v143
    v_mfma_f32_16x16x32_bf16 v[200:203], v[84:87], a[244:247], v[200:203]
    v_cvt_pk_bf16_f32 v24, v144, v145
    v_cvt_pk_bf16_f32 v25, v146, v147
    v_mfma_f32_16x16x32_bf16 v[204:207], v[88:91], a[228:231], v[204:207]
    v_cvt_pk_bf16_f32 v26, v148, v149
    v_cvt_pk_bf16_f32 v27, v150, v151
    v_mfma_f32_16x16x32_bf16 v[204:207], v[92:95], a[244:247], v[204:207]
    v_cvt_pk_bf16_f32 v28, v152, v153
    v_cvt_pk_bf16_f32 v29, v154, v155
    v_mfma_f32_16x16x32_bf16 v[208:211], v[80:83], a[232:235], v[208:211]
    s_add_u32 m0, s34, 49152
    s_add_u32 s37, s86, 131072
    buffer_load_dwordx4 v232, s[44:47], s37 offen lds
    v_cvt_pk_bf16_f32 v30, v156, v157
    v_cvt_pk_bf16_f32 v31, v158, v159
    v_mfma_f32_16x16x32_bf16 v[208:211], v[84:87], a[248:251], v[208:211]
    v_cvt_pk_bf16_f32 v32, v160, v161
    v_cvt_pk_bf16_f32 v33, v162, v163
    v_mfma_f32_16x16x32_bf16 v[212:215], v[88:91], a[232:235], v[212:215]
    v_cvt_pk_bf16_f32 v34, v164, v165
    v_cvt_pk_bf16_f32 v35, v166, v167
    v_mfma_f32_16x16x32_bf16 v[212:215], v[92:95], a[248:251], v[212:215]
    v_cvt_pk_bf16_f32 v36, v168, v169
    v_cvt_pk_bf16_f32 v37, v170, v171
    v_mfma_f32_16x16x32_bf16 v[216:219], v[80:83], a[236:239], v[216:219]
    buffer_load_dwordx4 v233, s[44:47], s37 offen offset:1024 lds
    v_cvt_pk_bf16_f32 v38, v172, v173
    v_cvt_pk_bf16_f32 v39, v174, v175
    v_mfma_f32_16x16x32_bf16 v[216:219], v[84:87], a[252:255], v[216:219]
    v_cvt_pk_bf16_f32 v40, v176, v177
    v_cvt_pk_bf16_f32 v41, v178, v179
    v_mfma_f32_16x16x32_bf16 v[220:223], v[88:91], a[236:239], v[220:223]
    v_cvt_pk_bf16_f32 v42, v180, v181
    v_cvt_pk_bf16_f32 v43, v182, v183
    v_mfma_f32_16x16x32_bf16 v[220:223], v[92:95], a[252:255], v[220:223]
    v_cvt_pk_bf16_f32 v44, v184, v185
    v_cvt_pk_bf16_f32 v45, v186, v187
    s_waitcnt lgkmcnt(0)
    v_mfma_f32_16x16x32_bf16 v[96:99], v[64:67], a[0:3], 0
    ds_read_b128 v[80:83], v224 offset:2048
    v_cvt_pk_bf16_f32 v46, v188, v189
    v_cvt_pk_bf16_f32 v47, v190, v191
    v_mfma_f32_16x16x32_bf16 v[96:99], v[68:71], a[16:19], v[96:99]
    ds_read_b128 v[84:87], v225 offset:2048
    v_cvt_pk_bf16_f32 v48, v192, v193
    v_cvt_pk_bf16_f32 v49, v194, v195
    v_mfma_f32_16x16x32_bf16 v[96:99], v[72:75], a[32:35], v[96:99]
    ds_read_b128 v[88:91], v224 offset:10240
    v_cvt_pk_bf16_f32 v50, v196, v197
    v_cvt_pk_bf16_f32 v51, v198, v199
    v_mfma_f32_16x16x32_bf16 v[96:99], v[76:79], a[48:51], v[96:99]
    ds_read_b128 v[92:95], v225 offset:10240
    v_cvt_pk_bf16_f32 v52, v200, v201
    v_cvt_pk_bf16_f32 v53, v202, v203
    v_mfma_f32_16x16x32_bf16 v[104:107], v[64:67], a[4:7], 0
    v_cvt_pk_bf16_f32 v54, v204, v205
    v_cvt_pk_bf16_f32 v55, v206, v207
    s_add_u32 s38, s36, 0
    buffer_store_dwordx4 v[0:3], v240, s[16:19], s38 offen offset:0 sc1
    v_mfma_f32_16x16x32_bf16 v[104:107], v[68:71], a[20:23], v[104:107]
    v_cvt_pk_bf16_f32 v56, v208, v209
    v_cvt_pk_bf16_f32 v57, v210, v211
    v_mfma_f32_16x16x32_bf16 v[104:107], v[72:75], a[36:39], v[104:107]
    v_cvt_pk_bf16_f32 v58, v212, v213
    v_cvt_pk_bf16_f32 v59, v214, v215
    v_mfma_f32_16x16x32_bf16 v[104:107], v[76:79], a[52:55], v[104:107]
    v_cvt_pk_bf16_f32 v60, v216, v217
    v_cvt_pk_bf16_f32 v61, v218, v219
    v_mfma_f32_16x16x32_bf16 v[112:115], v[64:67], a[8:11], 0
    v_xor_b32 v237, 16, v245
    v_xor_b32 v238, 16, v246
    v_cvt_pk_bf16_f32 v62, v220, v221
    v_cvt_pk_bf16_f32 v63, v222, v223
    v_mfma_f32_16x16x32_bf16 v[112:115], v[68:71], a[24:27], v[112:115]
    v_mfma_f32_16x16x32_bf16 v[112:115], v[72:75], a[40:43], v[112:115]
    v_mfma_f32_16x16x32_bf16 v[112:115], v[76:79], a[56:59], v[112:115]
    v_mfma_f32_16x16x32_bf16 v[120:123], v[64:67], a[12:15], 0
    v_mfma_f32_16x16x32_bf16 v[120:123], v[68:71], a[28:31], v[120:123]
    v_mfma_f32_16x16x32_bf16 v[120:123], v[72:75], a[44:47], v[120:123]
    v_mfma_f32_16x16x32_bf16 v[120:123], v[76:79], a[60:63], v[120:123]
    s_waitcnt lgkmcnt(0)
    v_mfma_f32_16x16x32_bf16 v[100:103], v[80:83], a[0:3], 0
    ds_read_b128 v[64:67], v224 offset:4096
    v_mfma_f32_16x16x32_bf16 v[100:103], v[84:87], a[16:19], v[100:103]
    ds_read_b128 v[68:71], v225 offset:4096
    v_mfma_f32_16x16x32_bf16 v[100:103], v[88:91], a[32:35], v[100:103]
    ds_read_b128 v[72:75], v224 offset:12288
    v_mfma_f32_16x16x32_bf16 v[100:103], v[92:95], a[48:51], v[100:103]
    ds_read_b128 v[76:79], v225 offset:12288
    v_mfma_f32_16x16x32_bf16 v[108:111], v[80:83], a[4:7], 0
    v_mfma_f32_16x16x32_bf16 v[108:111], v[84:87], a[20:23], v[108:111]
    v_mfma_f32_16x16x32_bf16 v[108:111], v[88:91], a[36:39], v[108:111]
    v_mfma_f32_16x16x32_bf16 v[108:111], v[92:95], a[52:55], v[108:111]
    v_mfma_f32_16x16x32_bf16 v[116:119], v[80:83], a[8:11], 0
    s_add_u32 m0, s34, 57344
    s_add_u32 s37, s87, 131072
    buffer_load_dwordx4 v232, s[44:47], s37 offen lds
    v_mfma_f32_16x16x32_bf16 v[116:119], v[84:87], a[24:27], v[116:119]
    s_add_u32 s38, s36, 0
    buffer_store_dwordx4 v[4:7], v240, s[16:19], s38 offen offset:1024 sc1
    v_mfma_f32_16x16x32_bf16 v[116:119], v[88:91], a[40:43], v[116:119]
    v_mfma_f32_16x16x32_bf16 v[116:119], v[92:95], a[56:59], v[116:119]
    v_mfma_f32_16x16x32_bf16 v[124:127], v[80:83], a[12:15], 0
    buffer_load_dwordx4 v233, s[44:47], s37 offen offset:1024 lds
    v_mfma_f32_16x16x32_bf16 v[124:127], v[84:87], a[28:31], v[124:127]
    v_mfma_f32_16x16x32_bf16 v[124:127], v[88:91], a[44:47], v[124:127]
    v_mfma_f32_16x16x32_bf16 v[124:127], v[92:95], a[60:63], v[124:127]
    s_waitcnt lgkmcnt(0)
    v_mfma_f32_16x16x32_bf16 v[128:131], v[64:67], a[0:3], 0
    ds_read_b128 v[80:83], v224 offset:6144
    v_mfma_f32_16x16x32_bf16 v[128:131], v[68:71], a[16:19], v[128:131]
    ds_read_b128 v[84:87], v225 offset:6144
    v_mfma_f32_16x16x32_bf16 v[128:131], v[72:75], a[32:35], v[128:131]
    ds_read_b128 v[88:91], v224 offset:14336
    v_mfma_f32_16x16x32_bf16 v[128:131], v[76:79], a[48:51], v[128:131]
    ds_read_b128 v[92:95], v225 offset:14336
    v_mfma_f32_16x16x32_bf16 v[136:139], v[64:67], a[4:7], 0
    v_mfma_f32_16x16x32_bf16 v[136:139], v[68:71], a[20:23], v[136:139]
    v_mfma_f32_16x16x32_bf16 v[136:139], v[72:75], a[36:39], v[136:139]
    v_mfma_f32_16x16x32_bf16 v[136:139], v[76:79], a[52:55], v[136:139]
    v_mfma_f32_16x16x32_bf16 v[144:147], v[64:67], a[8:11], 0
    s_waitcnt vmcnt(15)
    v_readfirstlane_b32 s24, v254
    s_lshl_b32 s25, s3, 16
    s_add_u32 s24, s24, s25
    s_cmp_ge_u32 s24, 1
    s_cbranch_scc0 kf_spin51
kf_spinr52:
    v_mfma_f32_16x16x32_bf16 v[144:147], v[68:71], a[24:27], v[144:147]
    v_mfma_f32_16x16x32_bf16 v[144:147], v[72:75], a[40:43], v[144:147]
    v_mfma_f32_16x16x32_bf16 v[144:147], v[76:79], a[56:59], v[144:147]
    v_mfma_f32_16x16x32_bf16 v[152:155], v[64:67], a[12:15], 0
    s_add_u32 s88, s20, 0x14a0000
    s_addc_u32 s89, s21, 0
    s_mov_b32 s90, 20480
    v_mfma_f32_16x16x32_bf16 v[152:155], v[68:71], a[28:31], v[152:155]
    v_mfma_f32_16x16x32_bf16 v[152:155], v[72:75], a[44:47], v[152:155]
    v_mfma_f32_16x16x32_bf16 v[152:155], v[76:79], a[60:63], v[152:155]
    s_add_u32 s38, s36, 0
    buffer_store_dwordx4 v[8:11], v240, s[16:19], s38 offen offset:2048 sc1
    s_waitcnt vmcnt(7) lgkmcnt(0)
    s_barrier
    v_mfma_f32_16x16x32_bf16 v[132:135], v[80:83], a[0:3], 0
    ds_read_b128 v[64:67], v224 offset:16384
    v_mfma_f32_16x16x32_bf16 v[132:135], v[84:87], a[16:19], v[132:135]
    ds_read_b128 v[68:71], v225 offset:16384
    v_mfma_f32_16x16x32_bf16 v[132:135], v[88:91], a[32:35], v[132:135]
    ds_read_b128 v[72:75], v224 offset:24576
    v_mfma_f32_16x16x32_bf16 v[132:135], v[92:95], a[48:51], v[132:135]
    ds_read_b128 v[76:79], v225 offset:24576
    v_mfma_f32_16x16x32_bf16 v[140:143], v[80:83], a[4:7], 0
    v_mfma_f32_16x16x32_bf16 v[140:143], v[84:87], a[20:23], v[140:143]
    v_mfma_f32_16x16x32_bf16 v[140:143], v[88:91], a[36:39], v[140:143]
    v_mfma_f32_16x16x32_bf16 v[140:143], v[92:95], a[52:55], v[140:143]
    v_mfma_f32_16x16x32_bf16 v[148:151], v[80:83], a[8:11], 0
    s_add_u32 m0, s34, 0
    s_add_u32 s37, s80, 196608
    buffer_load_dwordx4 v232, s[44:47], s37 offen lds
    v_mfma_f32_16x16x32_bf16 v[148:151], v[84:87], a[24:27], v[148:151]
    v_mfma_f32_16x16x32_bf16 v[148:151], v[88:91], a[40:43], v[148:151]
    buffer_load_dwordx4 v233, s[44:47], s37 offen offset:1024 lds
    v_mfma_f32_16x16x32_bf16 v[148:151], v[92:95], a[56:59], v[148:151]
    v_mfma_f32_16x16x32_bf16 v[156:159], v[80:83], a[12:15], 0
    v_mfma_f32_16x16x32_bf16 v[156:159], v[84:87], a[28:31], v[156:159]
    s_lshl_b32 s39, s5, 7
    s_add_u32 s39, s39, 8192
    buffer_atomic_add v255, v250, s[88:91], s39 offen sc1
    s_cmp_eq_u32 s3, 0
    s_cselect_b32 s39, s39, s43
    v_mfma_f32_16x16x32_bf16 v[156:159], v[88:91], a[44:47], v[156:159]
    v_mfma_f32_16x16x32_bf16 v[156:159], v[92:95], a[60:63], v[156:159]
    s_waitcnt lgkmcnt(0)
    v_mfma_f32_16x16x32_bf16 v[96:99], v[64:67], a[64:67], v[96:99]
    ds_read_b128 v[80:83], v224 offset:18432
    v_mfma_f32_16x16x32_bf16 v[96:99], v[68:71], a[80:83], v[96:99]
    ds_read_b128 v[84:87], v225 offset:18432
    v_mfma_f32_16x16x32_bf16 v[96:99], v[72:75], a[96:99], v[96:99]
    ds_read_b128 v[88:91], v224 offset:26624
    v_mfma_f32_16x16x32_bf16 v[96:99], v[76:79], a[112:115], v[96:99]
    ds_read_b128 v[92:95], v225 offset:26624
    v_mfma_f32_16x16x32_bf16 v[104:107], v[64:67], a[68:71], v[104:107]
    s_add_u32 s38, s36, 0
    buffer_store_dwordx4 v[12:15], v240, s[16:19], s38 offen offset:3072 sc1
    v_mfma_f32_16x16x32_bf16 v[104:107], v[68:71], a[84:87], v[104:107]
    v_mfma_f32_16x16x32_bf16 v[104:107], v[72:75], a[100:103], v[104:107]
    v_mfma_f32_16x16x32_bf16 v[104:107], v[76:79], a[116:119], v[104:107]
    v_mfma_f32_16x16x32_bf16 v[112:115], v[64:67], a[72:75], v[112:115]
    s_add_u32 m0, s31, 0
    s_add_u32 s24, s27, 0
    buffer_load_dwordx4 v245, s[12:15], s24 offen lds
    v_mfma_f32_16x16x32_bf16 v[112:115], v[68:71], a[88:91], v[112:115]
    v_mfma_f32_16x16x32_bf16 v[112:115], v[72:75], a[104:107], v[112:115]
    v_mfma_f32_16x16x32_bf16 v[112:115], v[76:79], a[120:123], v[112:115]
    v_mfma_f32_16x16x32_bf16 v[120:123], v[64:67], a[76:79], v[120:123]
    v_mfma_f32_16x16x32_bf16 v[120:123], v[68:71], a[92:95], v[120:123]
    v_mfma_f32_16x16x32_bf16 v[120:123], v[72:75], a[108:111], v[120:123]
    v_mfma_f32_16x16x32_bf16 v[120:123], v[76:79], a[124:127], v[120:123]
    s_waitcnt lgkmcnt(0)
    v_mfma_f32_16x16x32_bf16 v[100:103], v[80:83], a[64:67], v[100:103]
    ds_read_b128 v[64:67], v224 offset:20480
    v_mfma_f32_16x16x32_bf16 v[100:103], v[84:87], a[80:83], v[100:103]
    ds_read_b128 v[68:71], v225 offset:20480
    v_mfma_f32_16x16x32_bf16 v[100:103], v[88:91], a[96:99], v[100:103]
    ds_read_b128 v[72:75], v224 offset:28672
    v_mfma_f32_16x16x32_bf16 v[100:103], v[92:95], a[112:115], v[100:103]
    ds_read_b128 v[76:79], v225 offset:28672
    v_mfma_f32_16x16x32_bf16 v[108:111], v[80:83], a[68:71], v[108:111]
    v_mfma_f32_16x16x32_bf16 v[108:111], v[84:87], a[84:87], v[108:111]
    v_mfma_f32_16x16x32_bf16 v[108:111], v[88:91], a[100:103], v[108:111]
    v_mfma_f32_16x16x32_bf16 v[108:111], v[92:95], a[116:119], v[108:111]
    v_mfma_f32_16x16x32_bf16 v[116:119], v[80:83], a[72:75], v[116:119]
    s_add_u32 m0, s34, 8192
    s_add_u32 s37, s81, 196608
    buffer_load_dwordx4 v232, s[44:47], s37 offen lds
    v_mfma_f32_16x16x32_bf16 v[116:119], v[84:87], a[88:91], v[116:119]
    v_mfma_f32_16x16x32_bf16 v[116:119], v[88:91], a[104:107], v[116:119]
    buffer_load_dwordx4 v233, s[44:47], s37 offen offset:1024 lds
    s_add_u32 s38, s36, 8192
    buffer_store_dwordx4 v[16:19], v240, s[16:19], s38 offen offset:0 sc1
    v_mfma_f32_16x16x32_bf16 v[116:119], v[92:95], a[120:123], v[116:119]
    v_mfma_f32_16x16x32_bf16 v[124:127], v[80:83], a[76:79], v[124:127]
    v_mfma_f32_16x16x32_bf16 v[124:127], v[84:87], a[92:95], v[124:127]
    s_add_u32 m0, s31, 1024
    s_add_u32 s24, s27, 32768
    buffer_load_dwordx4 v245, s[12:15], s24 offen lds
    v_mfma_f32_16x16x32_bf16 v[124:127], v[88:91], a[108:111], v[124:127]
    v_mfma_f32_16x16x32_bf16 v[124:127], v[92:95], a[124:127], v[124:127]
    s_waitcnt lgkmcnt(0)
    v_mfma_f32_16x16x32_bf16 v[128:131], v[64:67], a[64:67], v[128:131]
    ds_read_b128 v[80:83], v224 offset:22528
    v_mfma_f32_16x16x32_bf16 v[128:131], v[68:71], a[80:83], v[128:131]
    ds_read_b128 v[84:87], v225 offset:22528
    v_mfma_f32_16x16x32_bf16 v[128:131], v[72:75], a[96:99], v[128:131]
    ds_read_b128 v[88:91], v224 offset:30720
    v_mfma_f32_16x16x32_bf16 v[128:131], v[76:79], a[112:115], v[128:131]
    ds_read_b128 v[92:95], v225 offset:30720
    v_mfma_f32_16x16x32_bf16 v[136:139], v[64:67], a[68:71], v[136:139]
    v_mfma_f32_16x16x32_bf16 v[136:139], v[68:71], a[84:87], v[136:139]
    v_mfma_f32_16x16x32_bf16 v[136:139], v[72:75], a[100:103], v[136:139]
    v_mfma_f32_16x16x32_bf16 v[136:139], v[76:79], a[116:119], v[136:139]
    v_mfma_f32_16x16x32_bf16 v[144:147], v[64:67], a[72:75], v[144:147]
    s_add_u32 m0, s31, 2048
    s_add_u32 s24, s27, 65536
    buffer_load_dwordx4 v237, s[12:15], s24 offen lds
    v_mfma_f32_16x16x32_bf16 v[144:147], v[68:71], a[88:91], v[144:147]
    v_mfma_f32_16x16x32_bf16 v[144:147], v[72:75], a[104:107], v[144:147]
    v_mfma_f32_16x16x32_bf16 v[144:147], v[76:79], a[120:123], v[144:147]
    v_mfma_f32_16x16x32_bf16 v[152:155], v[64:67], a[76:79], v[152:155]
    v_mfma_f32_16x16x32_bf16 v[152:155], v[68:71], a[92:95], v[152:155]
    v_mfma_f32_16x16x32_bf16 v[152:155], v[72:75], a[108:111], v[152:155]
    v_mfma_f32_16x16x32_bf16 v[152:155], v[76:79], a[124:127], v[152:155]
    s_add_u32 s38, s36, 8192
    buffer_store_dwordx4 v[20:23], v240, s[16:19], s38 offen offset:1024 sc1
    s_waitcnt vmcnt(19) lgkmcnt(0)
    s_barrier
    v_mfma_f32_16x16x32_bf16 v[132:135], v[80:83], a[64:67], v[132:135]
    ds_read_b128 v[64:67], v224 offset:32768
    v_mfma_f32_16x16x32_bf16 v[132:135], v[84:87], a[80:83], v[132:135]
    ds_read_b128 v[68:71], v225 offset:32768
    v_mfma_f32_16x16x32_bf16 v[132:135], v[88:91], a[96:99], v[132:135]
    ds_read_b128 v[72:75], v224 offset:40960
    v_mfma_f32_16x16x32_bf16 v[132:135], v[92:95], a[112:115], v[132:135]
    ds_read_b128 v[76:79], v225 offset:40960
    v_mfma_f32_16x16x32_bf16 v[140:143], v[80:83], a[68:71], v[140:143]
    v_mfma_f32_16x16x32_bf16 v[140:143], v[84:87], a[84:87], v[140:143]
    v_mfma_f32_16x16x32_bf16 v[140:143], v[88:91], a[100:103], v[140:143]
    v_mfma_f32_16x16x32_bf16 v[140:143], v[92:95], a[116:119], v[140:143]
    v_mfma_f32_16x16x32_bf16 v[148:151], v[80:83], a[72:75], v[148:151]
    s_add_u32 m0, s34, 16384
    s_add_u32 s37, s82, 196608
    buffer_load_dwordx4 v232, s[44:47], s37 offen lds
    v_mfma_f32_16x16x32_bf16 v[148:151], v[84:87], a[88:91], v[148:151]
    v_mfma_f32_16x16x32_bf16 v[148:151], v[88:91], a[104:107], v[148:151]
    buffer_load_dwordx4 v233, s[44:47], s37 offen offset:1024 lds
    v_mfma_f32_16x16x32_bf16 v[148:151], v[92:95], a[120:123], v[148:151]
    v_mfma_f32_16x16x32_bf16 v[156:159], v[80:83], a[76:79], v[156:159]
    v_mfma_f32_16x16x32_bf16 v[156:159], v[84:87], a[92:95], v[156:159]
    s_add_u32 m0, s31, 3072
    s_add_u32 s24, s27, 98304
    buffer_load_dwordx4 v237, s[12:15], s24 offen lds
    v_mfma_f32_16x16x32_bf16 v[156:159], v[88:91], a[108:111], v[156:159]
    v_mfma_f32_16x16x32_bf16 v[156:159], v[92:95], a[124:127], v[156:159]
    s_waitcnt lgkmcnt(0)
    v_mfma_f32_16x16x32_bf16 v[96:99], v[64:67], a[128:131], v[96:99]
    ds_read_b128 v[80:83], v224 offset:34816
    v_mfma_f32_16x16x32_bf16 v[96:99], v[68:71], a[144:147], v[96:99]
    ds_read_b128 v[84:87], v225 offset:34816
    v_mfma_f32_16x16x32_bf16 v[96:99], v[72:75], a[160:163], v[96:99]
    ds_read_b128 v[88:91], v224 offset:43008
    v_mfma_f32_16x16x32_bf16 v[96:99], v[76:79], a[176:179], v[96:99]
    ds_read_b128 v[92:95], v225 offset:43008
    v_mfma_f32_16x16x32_bf16 v[104:107], v[64:67], a[132:135], v[104:107]
    v_mfma_f32_16x16x32_bf16 v[104:107], v[68:71], a[148:151], v[104:107]
    s_add_u32 s38, s36, 8192
    buffer_store_dwordx4 v[24:27], v240, s[16:19], s38 offen offset:2048 sc1
    v_mfma_f32_16x16x32_bf16 v[104:107], v[72:75], a[164:167], v[104:107]
    v_mfma_f32_16x16x32_bf16 v[104:107], v[76:79], a[180:183], v[104:107]
    v_mfma_f32_16x16x32_bf16 v[112:115], v[64:67], a[136:139], v[112:115]
    s_add_u32 m0, s31, 4096
    s_add_u32 s24, s27, 131072
    buffer_load_dwordx4 v245, s[12:15], s24 offen lds
    v_mfma_f32_16x16x32_bf16 v[112:115], v[68:71], a[152:155], v[112:115]
    v_mfma_f32_16x16x32_bf16 v[112:115], v[72:75], a[168:171], v[112:115]
    v_mfma_f32_16x16x32_bf16 v[112:115], v[76:79], a[184:187], v[112:115]
    v_mfma_f32_16x16x32_bf16 v[120:123], v[64:67], a[140:143], v[120:123]
    v_mfma_f32_16x16x32_bf16 v[120:123], v[68:71], a[156:159], v[120:123]
    v_mfma_f32_16x16x32_bf16 v[120:123], v[72:75], a[172:175], v[120:123]
    v_mfma_f32_16x16x32_bf16 v[120:123], v[76:79], a[188:191], v[120:123]
    s_waitcnt lgkmcnt(0)
    v_mfma_f32_16x16x32_bf16 v[100:103], v[80:83], a[128:131], v[100:103]
    ds_read_b128 v[64:67], v224 offset:36864
    v_mfma_f32_16x16x32_bf16 v[100:103], v[84:87], a[144:147], v[100:103]
    ds_read_b128 v[68:71], v225 offset:36864
    v_mfma_f32_16x16x32_bf16 v[100:103], v[88:91], a[160:163], v[100:103]
    ds_read_b128 v[72:75], v224 offset:45056
    v_mfma_f32_16x16x32_bf16 v[100:103], v[92:95], a[176:179], v[100:103]
    ds_read_b128 v[76:79], v225 offset:45056
    v_mfma_f32_16x16x32_bf16 v[108:111], v[80:83], a[132:135], v[108:111]
    v_mfma_f32_16x16x32_bf16 v[108:111], v[84:87], a[148:151], v[108:111]
    v_mfma_f32_16x16x32_bf16 v[108:111], v[88:91], a[164:167], v[108:111]
    v_mfma_f32_16x16x32_bf16 v[108:111], v[92:95], a[180:183], v[108:111]
    v_mfma_f32_16x16x32_bf16 v[116:119], v[80:83], a[136:139], v[116:119]
    s_add_u32 m0, s34, 24576
    s_add_u32 s37, s83, 196608
    buffer_load_dwordx4 v232, s[44:47], s37 offen lds
    v_mfma_f32_16x16x32_bf16 v[116:119], v[84:87], a[152:155], v[116:119]
    v_mfma_f32_16x16x32_bf16 v[116:119], v[88:91], a[168:171], v[116:119]
    buffer_load_dwordx4 v233, s[44:47], s37 offen offset:1024 lds
    s_add_u32 s38, s36, 8192
    buffer_store_dwordx4 v[28:31], v240, s[16:19], s38 offen offset:3072 sc1
    v_mfma_f32_16x16x32_bf16 v[116:119], v[92:95], a[184:187], v[116:119]
    v_mfma_f32_16x16x32_bf16 v[124:127], v[80:83], a[140:143], v[124:127]
    v_mfma_f32_16x16x32_bf16 v[124:127], v[84:87], a[156:159], v[124:127]
    s_add_u32 m0, s31, 5120
    s_add_u32 s24, s27, 163840
    buffer_load_dwordx4 v245, s[12:15], s24 offen lds
    v_mfma_f32_16x16x32_bf16 v[124:127], v[88:91], a[172:175], v[124:127]
    v_mfma_f32_16x16x32_bf16 v[124:127], v[92:95], a[188:191], v[124:127]
    s_waitcnt lgkmcnt(0)
    v_mfma_f32_16x16x32_bf16 v[128:131], v[64:67], a[128:131], v[128:131]
    ds_read_b128 v[80:83], v224 offset:38912
    v_mfma_f32_16x16x32_bf16 v[128:131], v[68:71], a[144:147], v[128:131]
    ds_read_b128 v[84:87], v225 offset:38912
    v_mfma_f32_16x16x32_bf16 v[128:131], v[72:75], a[160:163], v[128:131]
    ds_read_b128 v[88:91], v224 offset:47104
    v_mfma_f32_16x16x32_bf16 v[128:131], v[76:79], a[176:179], v[128:131]
    ds_read_b128 v[92:95], v225 offset:47104
    v_mfma_f32_16x16x32_bf16 v[136:139], v[64:67], a[132:135], v[136:139]
    v_mfma_f32_16x16x32_bf16 v[136:139], v[68:71], a[148:151], v[136:139]
    v_mfma_f32_16x16x32_bf16 v[136:139], v[72:75], a[164:167], v[136:139]
    v_mfma_f32_16x16x32_bf16 v[136:139], v[76:79], a[180:183], v[136:139]
    v_mfma_f32_16x16x32_bf16 v[144:147], v[64:67], a[136:139], v[144:147]
    s_add_u32 m0, s31, 6144
    s_add_u32 s24, s27, 196608
    buffer_load_dwordx4 v237, s[12:15], s24 offen lds
    v_mfma_f32_16x16x32_bf16 v[144:147], v[68:71], a[152:155], v[144:147]
    v_mfma_f32_16x16x32_bf16 v[144:147], v[72:75], a[168:171], v[144:147]
    v_mfma_f32_16x16x32_bf16 v[144:147], v[76:79], a[184:187], v[144:147]
    v_mfma_f32_16x16x32_bf16 v[152:155], v[64:67], a[140:143], v[152:155]
    v_mfma_f32_16x16x32_bf16 v[152:155], v[68:71], a[156:159], v[152:155]
    v_mfma_f32_16x16x32_bf16 v[152:155], v[72:75], a[172:175], v[152:155]
    v_mfma_f32_16x16x32_bf16 v[152:155], v[76:79], a[188:191], v[152:155]
    s_waitcnt vmcnt(22) lgkmcnt(0)
    s_barrier
    v_mfma_f32_16x16x32_bf16 v[132:135], v[80:83], a[128:131], v[132:135]
    ds_read_b128 v[64:67], v224 offset:49152
    s_add_u32 s38, s36, 32768
    buffer_store_dwordx4 v[32:35], v240, s[16:19], s38 offen offset:1280 sc1
    v_mfma_f32_16x16x32_bf16 v[132:135], v[84:87], a[144:147], v[132:135]
    ds_read_b128 v[68:71], v225 offset:49152
    v_mfma_f32_16x16x32_bf16 v[132:135], v[88:91], a[160:163], v[132:135]
    ds_read_b128 v[72:75], v224 offset:57344
    v_mfma_f32_16x16x32_bf16 v[132:135], v[92:95], a[176:179], v[132:135]
    ds_read_b128 v[76:79], v225 offset:57344
    v_mfma_f32_16x16x32_bf16 v[140:143], v[80:83], a[132:135], v[140:143]
    v_mfma_f32_16x16x32_bf16 v[140:143], v[84:87], a[148:151], v[140:143]
    v_mfma_f32_16x16x32_bf16 v[140:143], v[88:91], a[164:167], v[140:143]
    v_mfma_f32_16x16x32_bf16 v[140:143], v[92:95], a[180:183], v[140:143]
    v_mfma_f32_16x16x32_bf16 v[148:151], v[80:83], a[136:139], v[148:151]
    s_add_u32 m0, s34, 32768
    s_add_u32 s37, s84, 196608
    buffer_load_dwordx4 v232, s[44:47], s37 offen lds
    v_mfma_f32_16x16x32_bf16 v[148:151], v[84:87], a[152:155], v[148:151]
    buffer_load_dwordx4 v233, s[44:47], s37 offen offset:1024 lds
    v_mfma_f32_16x16x32_bf16 v[148:151], v[88:91], a[168:171], v[148:151]
    v_mfma_f32_16x16x32_bf16 v[148:151], v[92:95], a[184:187], v[148:151]
    s_add_u32 m0, s31, 7168
    s_add_u32 s24, s27, 229376
    buffer_load_dwordx4 v237, s[12:15], s24 offen lds
    v_mfma_f32_16x16x32_bf16 v[156:159], v[80:83], a[140:143], v[156:159]
    s_add_u32 s27, s27, 1048576
    s_and_b32 s27, s27, 0x407fffff
    s_cmp_eq_u32 s27, s7
    s_cselect_b32 s27, s43, s27
    v_mfma_f32_16x16x32_bf16 v[156:159], v[84:87], a[156:159], v[156:159]
    v_mfma_f32_16x16x32_bf16 v[156:159], v[88:91], a[172:175], v[156:159]
    s_add_u32 s31, s31, 32768
    s_cmp_ge_u32 s31, 163840
    s_cselect_b32 s24, 98304, 0
    s_sub_u32 s31, s31, s24
    v_mfma_f32_16x16x32_bf16 v[156:159], v[92:95], a[188:191], v[156:159]
    s_waitcnt lgkmcnt(0)
    v_mfma_f32_16x16x32_bf16 v[96:99], v[64:67], a[192:195], v[96:99]
    ds_read_b128 v[80:83], v224 offset:51200
    v_mfma_f32_16x16x32_bf16 v[96:99], v[68:71], a[208:211], v[96:99]
    ds_read_b128 v[84:87], v225 offset:51200
    v_mfma_f32_16x16x32_bf16 v[96:99], v[72:75], a[224:227], v[96:99]
    ds_read_b128 v[88:91], v224 offset:59392
    v_mfma_f32_16x16x32_bf16 v[96:99], v[76:79], a[240:243], v[96:99]
    ds_read_b128 v[92:95], v225 offset:59392
    v_mfma_f32_16x16x32_bf16 v[104:107], v[64:67], a[196:199], v[104:107]
    v_mfma_f32_16x16x32_bf16 v[104:107], v[68:71], a[212:215], v[104:107]
    v_mfma_f32_16x16x32_bf16 v[104:107], v[72:75], a[228:231], v[104:107]
    s_add_u32 s38, s36, 32768
    buffer_store_dwordx4 v[36:39], v240, s[16:19], s38 offen offset:2304 sc1
    v_mfma_f32_16x16x32_bf16 v[104:107], v[76:79], a[244:247], v[104:107]
    v_mfma_f32_16x16x32_bf16 v[112:115], v[64:67], a[200:203], v[112:115]
    v_mfma_f32_16x16x32_bf16 v[112:115], v[68:71], a[216:219], v[112:115]
    v_mfma_f32_16x16x32_bf16 v[112:115], v[72:75], a[232:235], v[112:115]
    v_mfma_f32_16x16x32_bf16 v[112:115], v[76:79], a[248:251], v[112:115]
    v_mfma_f32_16x16x32_bf16 v[120:123], v[64:67], a[204:207], v[120:123]
    v_mfma_f32_16x16x32_bf16 v[120:123], v[68:71], a[220:223], v[120:123]
    v_mfma_f32_16x16x32_bf16 v[120:123], v[72:75], a[236:239], v[120:123]
    v_mfma_f32_16x16x32_bf16 v[120:123], v[76:79], a[252:255], v[120:123]
    s_waitcnt lgkmcnt(0)
    v_mfma_f32_16x16x32_bf16 v[100:103], v[80:83], a[192:195], v[100:103]
    ds_read_b128 v[64:67], v224 offset:53248
    v_mfma_f32_16x16x32_bf16 v[100:103], v[84:87], a[208:211], v[100:103]
    ds_read_b128 v[68:71], v225 offset:53248
    v_mfma_f32_16x16x32_bf16 v[100:103], v[88:91], a[224:227], v[100:103]
    ds_read_b128 v[72:75], v224 offset:61440
    v_mfma_f32_16x16x32_bf16 v[100:103], v[92:95], a[240:243], v[100:103]
    ds_read_b128 v[76:79], v225 offset:61440
    v_mfma_f32_16x16x32_bf16 v[108:111], v[80:83], a[196:199], v[108:111]
    v_mfma_f32_16x16x32_bf16 v[108:111], v[84:87], a[212:215], v[108:111]
    v_mfma_f32_16x16x32_bf16 v[108:111], v[88:91], a[228:231], v[108:111]
    v_mfma_f32_16x16x32_bf16 v[108:111], v[92:95], a[244:247], v[108:111]
    v_mfma_f32_16x16x32_bf16 v[116:119], v[80:83], a[200:203], v[116:119]
    s_add_u32 m0, s34, 40960
    s_add_u32 s37, s85, 196608
    buffer_load_dwordx4 v232, s[44:47], s37 offen lds
    v_mfma_f32_16x16x32_bf16 v[116:119], v[84:87], a[216:219], v[116:119]
    v_mfma_f32_16x16x32_bf16 v[116:119], v[88:91], a[232:235], v[116:119]
    v_mfma_f32_16x16x32_bf16 v[116:119], v[92:95], a[248:251], v[116:119]
    s_add_u32 s38, s36, 32768
    buffer_store_dwordx4 v[40:43], v240, s[16:19], s38 offen offset:3328 sc1
    v_mfma_f32_16x16x32_bf16 v[124:127], v[80:83], a[204:207], v[124:127]
    buffer_load_dwordx4 v233, s[44:47], s37 offen offset:1024 lds
    v_mfma_f32_16x16x32_bf16 v[124:127], v[84:87], a[220:223], v[124:127]
    v_mfma_f32_16x16x32_bf16 v[124:127], v[88:91], a[236:239], v[124:127]
    v_mfma_f32_16x16x32_bf16 v[124:127], v[92:95], a[252:255], v[124:127]
    s_waitcnt lgkmcnt(0)
    v_mfma_f32_16x16x32_bf16 v[128:131], v[64:67], a[192:195], v[128:131]
    ds_read_b128 v[80:83], v224 offset:55296
    v_mfma_f32_16x16x32_bf16 v[128:131], v[68:71], a[208:211], v[128:131]
    ds_read_b128 v[84:87], v225 offset:55296
    v_mfma_f32_16x16x32_bf16 v[128:131], v[72:75], a[224:227], v[128:131]
    ds_read_b128 v[88:91], v224 offset:63488
    v_mfma_f32_16x16x32_bf16 v[128:131], v[76:79], a[240:243], v[128:131]
    ds_read_b128 v[92:95], v225 offset:63488
    v_mfma_f32_16x16x32_bf16 v[136:139], v[64:67], a[196:199], v[136:139]
    v_mfma_f32_16x16x32_bf16 v[136:139], v[68:71], a[212:215], v[136:139]
    v_mfma_f32_16x16x32_bf16 v[136:139], v[72:75], a[228:231], v[136:139]
    v_mfma_f32_16x16x32_bf16 v[136:139], v[76:79], a[244:247], v[136:139]
    v_mfma_f32_16x16x32_bf16 v[144:147], v[64:67], a[200:203], v[144:147]
    s_add_u32 m0, s31, 0
    s_add_u32 s24, s27, 0
    buffer_load_dwordx4 v245, s[12:15], s24 offen lds
    v_mfma_f32_16x16x32_bf16 v[144:147], v[68:71], a[216:219], v[144:147]
    v_mfma_f32_16x16x32_bf16 v[144:147], v[72:75], a[232:235], v[144:147]
    v_mfma_f32_16x16x32_bf16 v[144:147], v[76:79], a[248:251], v[144:147]
    v_mfma_f32_16x16x32_bf16 v[152:155], v[64:67], a[204:207], v[152:155]
    v_mfma_f32_16x16x32_bf16 v[152:155], v[68:71], a[220:223], v[152:155]
    v_mfma_f32_16x16x32_bf16 v[152:155], v[72:75], a[236:239], v[152:155]
    v_mfma_f32_16x16x32_bf16 v[152:155], v[76:79], a[252:255], v[152:155]
    s_waitcnt vmcnt(23) lgkmcnt(0)
    s_barrier
    v_mfma_f32_16x16x32_bf16 v[132:135], v[80:83], a[192:195], v[132:135]
    ds_read_b128 v[64:67], v224 offset:0
    v_mfma_f32_16x16x32_bf16 v[132:135], v[84:87], a[208:211], v[132:135]
    ds_read_b128 v[68:71], v225 offset:0
    s_add_u32 s38, s36, 36864
    buffer_store_dwordx4 v[44:47], v240, s[16:19], s38 offen offset:256 sc1
    v_mfma_f32_16x16x32_bf16 v[132:135], v[88:91], a[224:227], v[132:135]
    ds_read_b128 v[72:75], v224 offset:8192
    v_mfma_f32_16x16x32_bf16 v[132:135], v[92:95], a[240:243], v[132:135]
    ds_read_b128 v[76:79], v225 offset:8192
    v_mfma_f32_16x16x32_bf16 v[140:143], v[80:83], a[196:199], v[140:143]
    v_mfma_f32_16x16x32_bf16 v[140:143], v[84:87], a[212:215], v[140:143]
    v_mfma_f32_16x16x32_bf16 v[140:143], v[88:91], a[228:231], v[140:143]
    v_mfma_f32_16x16x32_bf16 v[140:143], v[92:95], a[244:247], v[140:143]
    v_mfma_f32_16x16x32_bf16 v[148:151], v[80:83], a[200:203], v[148:151]
    s_add_u32 m0, s34, 49152
    s_add_u32 s37, s86, 196608
    buffer_load_dwordx4 v232, s[44:47], s37 offen lds
    v_mfma_f32_16x16x32_bf16 v[148:151], v[84:87], a[216:219], v[148:151]
    v_mfma_f32_16x16x32_bf16 v[148:151], v[88:91], a[232:235], v[148:151]
    buffer_load_dwordx4 v233, s[44:47], s37 offen offset:1024 lds
    v_mfma_f32_16x16x32_bf16 v[148:151], v[92:95], a[248:251], v[148:151]
    v_mfma_f32_16x16x32_bf16 v[156:159], v[80:83], a[204:207], v[156:159]
    v_mfma_f32_16x16x32_bf16 v[156:159], v[84:87], a[220:223], v[156:159]
    s_add_u32 m0, s31, 1024
    s_add_u32 s24, s27, 32768
    buffer_load_dwordx4 v245, s[12:15], s24 offen lds
    v_mfma_f32_16x16x32_bf16 v[156:159], v[88:91], a[236:239], v[156:159]
    v_mfma_f32_16x16x32_bf16 v[156:159], v[92:95], a[252:255], v[156:159]
    s_waitcnt lgkmcnt(0)
    v_mfma_f32_16x16x32_bf16 v[160:163], v[64:67], a[0:3], 0
    ds_read_b128 v[80:83], v224 offset:2048
    v_mfma_f32_16x16x32_bf16 v[160:163], v[68:71], a[16:19], v[160:163]
    ds_read_b128 v[84:87], v225 offset:2048
    v_mfma_f32_16x16x32_bf16 v[160:163], v[72:75], a[32:35], v[160:163]
    ds_read_b128 v[88:91], v224 offset:10240
    v_mfma_f32_16x16x32_bf16 v[160:163], v[76:79], a[48:51], v[160:163]
    ds_read_b128 v[92:95], v225 offset:10240
    v_mfma_f32_16x16x32_bf16 v[168:171], v[64:67], a[4:7], 0
    v_cvt_pk_bf16_f32 v0, v96, v97
    v_cvt_pk_bf16_f32 v1, v98, v99
    v_mfma_f32_16x16x32_bf16 v[168:171], v[68:71], a[20:23], v[168:171]
    v_mfma_f32_16x16x32_bf16 v[168:171], v[72:75], a[36:39], v[168:171]
    v_cvt_pk_bf16_f32 v2, v100, v101
    v_cvt_pk_bf16_f32 v3, v102, v103
    s_add_u32 s38, s36, 40960
    buffer_store_dwordx4 v[48:51], v240, s[16:19], s38 offen offset:1280 sc1
    v_mfma_f32_16x16x32_bf16 v[168:171], v[76:79], a[52:55], v[168:171]
    v_mfma_f32_16x16x32_bf16 v[176:179], v[64:67], a[8:11], 0
    s_add_u32 m0, s31, 2048
    s_add_u32 s24, s27, 65536
    buffer_load_dwordx4 v237, s[12:15], s24 offen lds
    v_cvt_pk_bf16_f32 v4, v104, v105
    v_cvt_pk_bf16_f32 v5, v106, v107
    v_mfma_f32_16x16x32_bf16 v[176:179], v[68:71], a[24:27], v[176:179]
    v_mfma_f32_16x16x32_bf16 v[176:179], v[72:75], a[40:43], v[176:179]
    v_cvt_pk_bf16_f32 v6, v108, v109
    v_cvt_pk_bf16_f32 v7, v110, v111
    v_mfma_f32_16x16x32_bf16 v[176:179], v[76:79], a[56:59], v[176:179]
    v_mfma_f32_16x16x32_bf16 v[184:187], v[64:67], a[12:15], 0
    v_cvt_pk_bf16_f32 v8, v112, v113
    v_cvt_pk_bf16_f32 v9, v114, v115
    v_mfma_f32_16x16x32_bf16 v[184:187], v[68:71], a[28:31], v[184:187]
    v_mfma_f32_16x16x32_bf16 v[184:187], v[72:75], a[44:47], v[184:187]
    v_cvt_pk_bf16_f32 v10, v116, v117
    v_cvt_pk_bf16_f32 v11, v118, v119
    v_mfma_f32_16x16x32_bf16 v[184:187], v[76:79], a[60:63], v[184:187]
    s_waitcnt lgkmcnt(0)
    v_mfma_f32_16x16x32_bf16 v[164:167], v[80:83], a[0:3], 0
    ds_read_b128 v[64:67], v224 offset:4096
    v_cvt_pk_bf16_f32 v12, v120, v121
    v_cvt_pk_bf16_f32 v13, v122, v123
    v_mfma_f32_16x16x32_bf16 v[164:167], v[84:87], a[16:19], v[164:167]
    ds_read_b128 v[68:71], v225 offset:4096
    v_mfma_f32_16x16x32_bf16 v[164:167], v[88:91], a[32:35], v[164:167]
    ds_read_b128 v[72:75], v224 offset:12288
    v_cvt_pk_bf16_f32 v14, v124, v125
    v_cvt_pk_bf16_f32 v15, v126, v127
    v_mfma_f32_16x16x32_bf16 v[164:167], v[92:95], a[48:51], v[164:167]
    ds_read_b128 v[76:79], v225 offset:12288
    v_mfma_f32_16x16x32_bf16 v[172:175], v[80:83], a[4:7], 0
    v_cvt_pk_bf16_f32 v16, v128, v129
    v_cvt_pk_bf16_f32 v17, v130, v131
    v_mfma_f32_16x16x32_bf16 v[172:175], v[84:87], a[20:23], v[172:175]
    v_mfma_f32_16x16x32_bf16 v[172:175], v[88:91], a[36:39], v[172:175]
    v_cvt_pk_bf16_f32 v18, v132, v133
    v_cvt_pk_bf16_f32 v19, v134, v135
    v_mfma_f32_16x16x32_bf16 v[172:175], v[92:95], a[52:55], v[172:175]
    v_mfma_f32_16x16x32_bf16 v[180:183], v[80:83], a[8:11], 0
    s_add_u32 m0, s34, 57344
    s_add_u32 s37, s87, 196608
    buffer_load_dwordx4 v232, s[44:47], s37 offen lds
    v_cvt_pk_bf16_f32 v20, v136, v137
    v_cvt_pk_bf16_f32 v21, v138, v139
    v_mfma_f32_16x16x32_bf16 v[180:183], v[84:87], a[24:27], v[180:183]
    v_mfma_f32_16x16x32_bf16 v[180:183], v[88:91], a[40:43], v[180:183]
    buffer_load_dwordx4 v233, s[44:47], s37 offen offset:1024 lds
    v_cvt_pk_bf16_f32 v22, v140, v141
    v_cvt_pk_bf16_f32 v23, v142, v143
    v_mfma_f32_16x16x32_bf16 v[180:183], v[92:95], a[56:59], v[180:183]
    v_mfma_f32_16x16x32_bf16 v[188:191], v[80:83], a[12:15], 0
    v_cvt_pk_bf16_f32 v24, v144, v145
    v_cvt_pk_bf16_f32 v25, v146, v147
    s_add_u32 s38, s36, 40960
    buffer_store_dwordx4 v[52:55], v240, s[16:19], s38 offen offset:2304 sc1
    v_mfma_f32_16x16x32_bf16 v[188:191], v[84:87], a[28:31], v[188:191]
    s_add_u32 m0, s31, 3072
    s_add_u32 s24, s27, 98304
    buffer_load_dwordx4 v237, s[12:15], s24 offen lds
    v_mfma_f32_16x16x32_bf16 v[188:191], v[88:91], a[44:47], v[188:191]
    v_cvt_pk_bf16_f32 v26, v148, v149
    v_cvt_pk_bf16_f32 v27, v150, v151
    v_mfma_f32_16x16x32_bf16 v[188:191], v[92:95], a[60:63], v[188:191]
    s_waitcnt lgkmcnt(0)
    v_mfma_f32_16x16x32_bf16 v[192:195], v[64:67], a[0:3], 0
    ds_read_b128 v[80:83], v224 offset:6144
    v_cvt_pk_bf16_f32 v28, v152, v153
    v_cvt_pk_bf16_f32 v29, v154, v155
    v_mfma_f32_16x16x32_bf16 v[192:195], v[68:71], a[16:19], v[192:195]
    ds_read_b128 v[84:87], v225 offset:6144
    v_mfma_f32_16x16x32_bf16 v[192:195], v[72:75], a[32:35], v[192:195]
    ds_read_b128 v[88:91], v224 offset:14336
    v_cvt_pk_bf16_f32 v30, v156, v157
    v_cvt_pk_bf16_f32 v31, v158, v159
    v_mfma_f32_16x16x32_bf16 v[192:195], v[76:79], a[48:51], v[192:195]
    ds_read_b128 v[92:95], v225 offset:14336
    v_mfma_f32_16x16x32_bf16 v[200:203], v[64:67], a[4:7], 0
    v_mfma_f32_16x16x32_bf16 v[200:203], v[68:71], a[20:23], v[200:203]
    v_mfma_f32_16x16x32_bf16 v[200:203], v[72:75], a[36:39], v[200:203]
    v_mfma_f32_16x16x32_bf16 v[200:203], v[76:79], a[52:55], v[200:203]
    v_mfma_f32_16x16x32_bf16 v[208:211], v[64:67], a[8:11], 0
    s_add_u32 m0, s31, 4096
    s_add_u32 s24, s27, 131072
    buffer_load_dwordx4 v245, s[12:15], s24 offen lds
    v_mfma_f32_16x16x32_bf16 v[208:211], v[68:71], a[24:27], v[208:211]
    v_mfma_f32_16x16x32_bf16 v[208:211], v[72:75], a[40:43], v[208:211]
    v_mfma_f32_16x16x32_bf16 v[208:211], v[76:79], a[56:59], v[208:211]
    v_mfma_f32_16x16x32_bf16 v[216:219], v[64:67], a[12:15], 0
    v_mfma_f32_16x16x32_bf16 v[216:219], v[68:71], a[28:31], v[216:219]
    v_mfma_f32_16x16x32_bf16 v[216:219], v[72:75], a[44:47], v[216:219]
    v_mfma_f32_16x16x32_bf16 v[216:219], v[76:79], a[60:63], v[216:219]
    s_waitcnt vmcnt(23) lgkmcnt(0)
    s_barrier
    v_mfma_f32_16x16x32_bf16 v[196:199], v[80:83], a[0:3], 0
    ds_read_b128 v[64:67], v224 offset:16384
    v_mfma_f32_16x16x32_bf16 v[196:199], v[84:87], a[16:19], v[196:199]
    ds_read_b128 v[68:71], v225 offset:16384
    s_add_u32 s38, s36, 40960
    buffer_store_dwordx4 v[56:59], v240, s[16:19], s38 offen offset:3328 sc1
    v_mfma_f32_16x16x32_bf16 v[196:199], v[88:91], a[32:35], v[196:199]
    ds_read_b128 v[72:75], v224 offset:24576
    v_mfma_f32_16x16x32_bf16 v[196:199], v[92:95], a[48:51], v[196:199]
    ds_read_b128 v[76:79], v225 offset:24576
    v_mfma_f32_16x16x32_bf16 v[204:207], v[80:83], a[4:7], 0
    v_mfma_f32_16x16x32_bf16 v[204:207], v[84:87], a[20:23], v[204:207]
    v_mfma_f32_16x16x32_bf16 v[204:207], v[88:91], a[36:39], v[204:207]
    v_mfma_f32_16x16x32_bf16 v[204:207], v[92:95], a[52:55], v[204:207]
    v_mfma_f32_16x16x32_bf16 v[212:215], v[80:83], a[8:11], 0
    s_add_u32 m0, s31, 5120
    s_add_u32 s24, s27, 163840
    buffer_load_dwordx4 v245, s[12:15], s24 offen lds
    v_mfma_f32_16x16x32_bf16 v[212:215], v[84:87], a[24:27], v[212:215]
    v_mfma_f32_16x16x32_bf16 v[212:215], v[88:91], a[40:43], v[212:215]
    v_mfma_f32_16x16x32_bf16 v[212:215], v[92:95], a[56:59], v[212:215]
    v_mfma_f32_16x16x32_bf16 v[220:223], v[80:83], a[12:15], 0
    v_mfma_f32_16x16x32_bf16 v[220:223], v[84:87], a[28:31], v[220:223]
    v_mfma_f32_16x16x32_bf16 v[220:223], v[88:91], a[44:47], v[220:223]
    v_mfma_f32_16x16x32_bf16 v[220:223], v[92:95], a[60:63], v[220:223]
    s_waitcnt lgkmcnt(0)
    v_mfma_f32_16x16x32_bf16 v[160:163], v[64:67], a[64:67], v[160:163]
    ds_read_b128 v[80:83], v224 offset:18432
    v_mfma_f32_16x16x32_bf16 v[160:163], v[68:71], a[80:83], v[160:163]
    ds_read_b128 v[84:87], v225 offset:18432
    v_mfma_f32_16x16x32_bf16 v[160:163], v[72:75], a[96:99], v[160:163]
    ds_read_b128 v[88:91], v224 offset:26624
    v_mfma_f32_16x16x32_bf16 v[160:163], v[76:79], a[112:115], v[160:163]
    ds_read_b128 v[92:95], v225 offset:26624
    v_mfma_f32_16x16x32_bf16 v[168:171], v[64:67], a[68:71], v[168:171]
    v_mfma_f32_16x16x32_bf16 v[168:171], v[68:71], a[84:87], v[168:171]
    v_mfma_f32_16x16x32_bf16 v[168:171], v[72:75], a[100:103], v[168:171]
    v_mfma_f32_16x16x32_bf16 v[168:171], v[76:79], a[116:119], v[168:171]
    s_add_u32 s38, s36, 45056
    buffer_store_dwordx4 v[60:63], v240, s[16:19], s38 offen offset:256 sc1
    v_mfma_f32_16x16x32_bf16 v[176:179], v[64:67], a[72:75], v[176:179]
    s_add_u32 m0, s31, 6144
    s_add_u32 s24, s27, 196608
    buffer_load_dwordx4 v237, s[12:15], s24 offen lds
    v_mfma_f32_16x16x32_bf16 v[176:179], v[68:71], a[88:91], v[176:179]
    v_mfma_f32_16x16x32_bf16 v[176:179], v[72:75], a[104:107], v[176:179]
    v_mfma_f32_16x16x32_bf16 v[176:179], v[76:79], a[120:123], v[176:179]
    v_mfma_f32_16x16x32_bf16 v[184:187], v[64:67], a[76:79], v[184:187]
    v_mfma_f32_16x16x32_bf16 v[184:187], v[68:71], a[92:95], v[184:187]
    v_mfma_f32_16x16x32_bf16 v[184:187], v[72:75], a[108:111], v[184:187]
    v_mfma_f32_16x16x32_bf16 v[184:187], v[76:79], a[124:127], v[184:187]
    s_waitcnt lgkmcnt(0)
    v_mfma_f32_16x16x32_bf16 v[164:167], v[80:83], a[64:67], v[164:167]
    ds_read_b128 v[64:67], v224 offset:20480
    v_mfma_f32_16x16x32_bf16 v[164:167], v[84:87], a[80:83], v[164:167]
    ds_read_b128 v[68:71], v225 offset:20480
    v_mfma_f32_16x16x32_bf16 v[164:167], v[88:91], a[96:99], v[164:167]
    ds_read_b128 v[72:75], v224 offset:28672
    v_mfma_f32_16x16x32_bf16 v[164:167], v[92:95], a[112:115], v[164:167]
    ds_read_b128 v[76:79], v225 offset:28672
    v_mfma_f32_16x16x32_bf16 v[172:175], v[80:83], a[68:71], v[172:175]
    v_mfma_f32_16x16x32_bf16 v[172:175], v[84:87], a[84:87], v[172:175]
    v_mfma_f32_16x16x32_bf16 v[172:175], v[88:91], a[100:103], v[172:175]
    v_mfma_f32_16x16x32_bf16 v[172:175], v[92:95], a[116:119], v[172:175]
    v_mfma_f32_16x16x32_bf16 v[180:183], v[80:83], a[72:75], v[180:183]
    s_add_u32 m0, s31, 7168
    s_add_u32 s24, s27, 229376
    buffer_load_dwordx4 v237, s[12:15], s24 offen lds
    v_mfma_f32_16x16x32_bf16 v[180:183], v[84:87], a[88:91], v[180:183]
    v_mfma_f32_16x16x32_bf16 v[180:183], v[88:91], a[104:107], v[180:183]
    s_add_u32 s27, s27, 1048576
    s_and_b32 s27, s27, 0x407fffff
    s_cmp_eq_u32 s27, s7
    s_cselect_b32 s27, s43, s27
    v_mfma_f32_16x16x32_bf16 v[180:183], v[92:95], a[120:123], v[180:183]
    v_mfma_f32_16x16x32_bf16 v[188:191], v[80:83], a[76:79], v[188:191]
    v_mfma_f32_16x16x32_bf16 v[188:191], v[84:87], a[92:95], v[188:191]
    s_add_u32 s31, s31, 32768
    s_cmp_ge_u32 s31, 163840
    s_cselect_b32 s24, 98304, 0
    s_sub_u32 s31, s31, s24
    s_add_u32 s38, s36, 65536
    buffer_store_dwordx4 v[0:3], v240, s[16:19], s38 offen offset:2560 sc1
    v_mfma_f32_16x16x32_bf16 v[188:191], v[88:91], a[108:111], v[188:191]
    v_mfma_f32_16x16x32_bf16 v[188:191], v[92:95], a[124:127], v[188:191]
    s_waitcnt lgkmcnt(0)
    v_mfma_f32_16x16x32_bf16 v[192:195], v[64:67], a[64:67], v[192:195]
    ds_read_b128 v[80:83], v224 offset:22528
    v_mfma_f32_16x16x32_bf16 v[192:195], v[68:71], a[80:83], v[192:195]
    ds_read_b128 v[84:87], v225 offset:22528
    v_mfma_f32_16x16x32_bf16 v[192:195], v[72:75], a[96:99], v[192:195]
    ds_read_b128 v[88:91], v224 offset:30720
    v_mfma_f32_16x16x32_bf16 v[192:195], v[76:79], a[112:115], v[192:195]
    ds_read_b128 v[92:95], v225 offset:30720
    v_mfma_f32_16x16x32_bf16 v[200:203], v[64:67], a[68:71], v[200:203]
    v_mfma_f32_16x16x32_bf16 v[200:203], v[68:71], a[84:87], v[200:203]
    v_mfma_f32_16x16x32_bf16 v[200:203], v[72:75], a[100:103], v[200:203]
    v_mfma_f32_16x16x32_bf16 v[200:203], v[76:79], a[116:119], v[200:203]
    v_mfma_f32_16x16x32_bf16 v[208:211], v[64:67], a[72:75], v[208:211]
    v_mfma_f32_16x16x32_bf16 v[208:211], v[68:71], a[88:91], v[208:211]
    v_mfma_f32_16x16x32_bf16 v[208:211], v[72:75], a[104:107], v[208:211]
    v_mfma_f32_16x16x32_bf16 v[208:211], v[76:79], a[120:123], v[208:211]
    v_mfma_f32_16x16x32_bf16 v[216:219], v[64:67], a[76:79], v[216:219]
    v_mfma_f32_16x16x32_bf16 v[216:219], v[68:71], a[92:95], v[216:219]
    v_mfma_f32_16x16x32_bf16 v[216:219], v[72:75], a[108:111], v[216:219]
    v_mfma_f32_16x16x32_bf16 v[216:219], v[76:79], a[124:127], v[216:219]
    s_waitcnt vmcnt(9) lgkmcnt(0)
    s_barrier
    v_mfma_f32_16x16x32_bf16 v[196:199], v[80:83], a[64:67], v[196:199]
    ds_read_b128 v[64:67], v224 offset:32768
    v_mfma_f32_16x16x32_bf16 v[196:199], v[84:87], a[80:83], v[196:199]
    ds_read_b128 v[68:71], v225 offset:32768
    v_mfma_f32_16x16x32_bf16 v[196:199], v[88:91], a[96:99], v[196:199]
    ds_read_b128 v[72:75], v224 offset:40960
    s_add_u32 s38, s36, 65536
    buffer_store_dwordx4 v[4:7], v240, s[16:19], s38 offen offset:3584 sc1
    v_mfma_f32_16x16x32_bf16 v[196:199], v[92:95], a[112:115], v[196:199]
    ds_read_b128 v[76:79], v225 offset:40960
    v_mfma_f32_16x16x32_bf16 v[204:207], v[80:83], a[68:71], v[204:207]
    v_mfma_f32_16x16x32_bf16 v[204:207], v[84:87], a[84:87], v[204:207]
    v_mfma_f32_16x16x32_bf16 v[204:207], v[88:91], a[100:103], v[204:207]
    v_mfma_f32_16x16x32_bf16 v[204:207], v[92:95], a[116:119], v[204:207]
    v_mfma_f32_16x16x32_bf16 v[212:215], v[80:83], a[72:75], v[212:215]
    v_mfma_f32_16x16x32_bf16 v[212:215], v[84:87], a[88:91], v[212:215]
    v_mfma_f32_16x16x32_bf16 v[212:215], v[88:91], a[104:107], v[212:215]
    v_mfma_f32_16x16x32_bf16 v[212:215], v[92:95], a[120:123], v[212:215]
    v_mfma_f32_16x16x32_bf16 v[220:223], v[80:83], a[76:79], v[220:223]
    v_mfma_f32_16x16x32_bf16 v[220:223], v[84:87], a[92:95], v[220:223]
    v_mfma_f32_16x16x32_bf16 v[220:223], v[88:91], a[108:111], v[220:223]
    v_mfma_f32_16x16x32_bf16 v[220:223], v[92:95], a[124:127], v[220:223]
    s_waitcnt lgkmcnt(0)
    v_mfma_f32_16x16x32_bf16 v[160:163], v[64:67], a[128:131], v[160:163]
    ds_read_b128 v[80:83], v224 offset:34816
    v_mfma_f32_16x16x32_bf16 v[160:163], v[68:71], a[144:147], v[160:163]
    ds_read_b128 v[84:87], v225 offset:34816
    v_mfma_f32_16x16x32_bf16 v[160:163], v[72:75], a[160:163], v[160:163]
    ds_read_b128 v[88:91], v224 offset:43008
    v_mfma_f32_16x16x32_bf16 v[160:163], v[76:79], a[176:179], v[160:163]
    ds_read_b128 v[92:95], v225 offset:43008
    v_mfma_f32_16x16x32_bf16 v[168:171], v[64:67], a[132:135], v[168:171]
    v_mfma_f32_16x16x32_bf16 v[168:171], v[68:71], a[148:151], v[168:171]
    v_mfma_f32_16x16x32_bf16 v[168:171], v[72:75], a[164:167], v[168:171]
    v_mfma_f32_16x16x32_bf16 v[168:171], v[76:79], a[180:183], v[168:171]
    v_mfma_f32_16x16x32_bf16 v[176:179], v[64:67], a[136:139], v[176:179]
    buffer_load_dword v254, off, s[88:91], s39 sc1
    s_add_u32 s38, s36, 69632
    buffer_store_dwordx4 v[8:11], v240, s[16:19], s38 offen offset:512 sc1
    v_mfma_f32_16x16x32_bf16 v[176:179], v[68:71], a[152:155], v[176:179]
    v_mfma_f32_16x16x32_bf16 v[176:179], v[72:75], a[168:171], v[176:179]
    v_mfma_f32_16x16x32_bf16 v[176:179], v[76:79], a[184:187], v[176:179]
    v_mfma_f32_16x16x32_bf16 v[184:187], v[64:67], a[140:143], v[184:187]
    v_mfma_f32_16x16x32_bf16 v[184:187], v[68:71], a[156:159], v[184:187]
    v_mfma_f32_16x16x32_bf16 v[184:187], v[72:75], a[172:175], v[184:187]
    v_mfma_f32_16x16x32_bf16 v[184:187], v[76:79], a[188:191], v[184:187]
    s_waitcnt lgkmcnt(0)
    v_mfma_f32_16x16x32_bf16 v[164:167], v[80:83], a[128:131], v[164:167]
    ds_read_b128 v[64:67], v224 offset:36864
    v_mfma_f32_16x16x32_bf16 v[164:167], v[84:87], a[144:147], v[164:167]
    ds_read_b128 v[68:71], v225 offset:36864
    v_mfma_f32_16x16x32_bf16 v[164:167], v[88:91], a[160:163], v[164:167]
    ds_read_b128 v[72:75], v224 offset:45056
    v_mfma_f32_16x16x32_bf16 v[164:167], v[92:95], a[176:179], v[164:167]
    ds_read_b128 v[76:79], v225 offset:45056
    v_mfma_f32_16x16x32_bf16 v[172:175], v[80:83], a[132:135], v[172:175]
    v_mfma_f32_16x16x32_bf16 v[172:175], v[84:87], a[148:151], v[172:175]
    v_mfma_f32_16x16x32_bf16 v[172:175], v[88:91], a[164:167], v[172:175]
    v_mfma_f32_16x16x32_bf16 v[172:175], v[92:95], a[180:183], v[172:175]
    v_mfma_f32_16x16x32_bf16 v[180:183], v[80:83], a[136:139], v[180:183]
    v_mfma_f32_16x16x32_bf16 v[180:183], v[84:87], a[152:155], v[180:183]
    v_mfma_f32_16x16x32_bf16 v[180:183], v[88:91], a[168:171], v[180:183]
    v_mfma_f32_16x16x32_bf16 v[180:183], v[92:95], a[184:187], v[180:183]
    v_mfma_f32_16x16x32_bf16 v[188:191], v[80:83], a[140:143], v[188:191]
    v_mfma_f32_16x16x32_bf16 v[188:191], v[84:87], a[156:159], v[188:191]
    s_add_u32 s38, s36, 69632
    buffer_store_dwordx4 v[12:15], v240, s[16:19], s38 offen offset:1536 sc1
    v_mfma_f32_16x16x32_bf16 v[188:191], v[88:91], a[172:175], v[188:191]
    v_mfma_f32_16x16x32_bf16 v[188:191], v[92:95], a[188:191], v[188:191]
    s_waitcnt lgkmcnt(0)
    v_mfma_f32_16x16x32_bf16 v[192:195], v[64:67], a[128:131], v[192:195]
    ds_read_b128 v[80:83], v224 offset:38912
    v_mfma_f32_16x16x32_bf16 v[192:195], v[68:71], a[144:147], v[192:195]
    ds_read_b128 v[84:87], v225 offset:38912
    v_mfma_f32_16x16x32_bf16 v[192:195], v[72:75], a[160:163], v[192:195]
    ds_read_b128 v[88:91], v224 offset:47104
    v_mfma_f32_16x16x32_bf16 v[192:195], v[76:79], a[176:179], v[192:195]
    ds_read_b128 v[92:95], v225 offset:47104
    v_mfma_f32_16x16x32_bf16 v[200:203], v[64:67], a[132:135], v[200:203]
    v_mfma_f32_16x16x32_bf16 v[200:203], v[68:71], a[148:151], v[200:203]
    v_mfma_f32_16x16x32_bf16 v[200:203], v[72:75], a[164:167], v[200:203]
    v_mfma_f32_16x16x32_bf16 v[200:203], v[76:79], a[180:183], v[200:203]
    v_mfma_f32_16x16x32_bf16 v[208:211], v[64:67], a[136:139], v[208:211]
    v_mfma_f32_16x16x32_bf16 v[208:211], v[68:71], a[152:155], v[208:211]
    v_mfma_f32_16x16x32_bf16 v[208:211], v[72:75], a[168:171], v[208:211]
    v_mfma_f32_16x16x32_bf16 v[208:211], v[76:79], a[184:187], v[208:211]
    v_mfma_f32_16x16x32_bf16 v[216:219], v[64:67], a[140:143], v[216:219]
    v_mfma_f32_16x16x32_bf16 v[216:219], v[68:71], a[156:159], v[216:219]
    v_mfma_f32_16x16x32_bf16 v[216:219], v[72:75], a[172:175], v[216:219]
    v_mfma_f32_16x16x32_bf16 v[216:219], v[76:79], a[188:191], v[216:219]
    s_waitcnt lgkmcnt(0)
    v_mfma_f32_16x16x32_bf16 v[196:199], v[80:83], a[128:131], v[196:199]
    ds_read_b128 v[64:67], v224 offset:49152
    v_mfma_f32_16x16x32_bf16 v[196:199], v[84:87], a[144:147], v[196:199]
    ds_read_b128 v[68:71], v224 offset:51200
    v_mfma_f32_16x16x32_bf16 v[196:199], v[88:91], a[160:163], v[196:199]
    ds_read_b128 v[72:75], v224 offset:53248
    v_mfma_f32_16x16x32_bf16 v[196:199], v[92:95], a[176:179], v[196:199]
    ds_read_b128 v[76:79], v224 offset:55296
    s_add_u32 s38, s36, 73728
    buffer_store_dwordx4 v[16:19], v240, s[16:19], s38 offen offset:2560 sc1
    v_mfma_f32_16x16x32_bf16 v[204:207], v[80:83], a[132:135], v[204:207]
    v_mfma_f32_16x16x32_bf16 v[204:207], v[84:87], a[148:151], v[204:207]
    v_mfma_f32_16x16x32_bf16 v[204:207], v[88:91], a[164:167], v[204:207]
    v_mfma_f32_16x16x32_bf16 v[204:207], v[92:95], a[180:183], v[204:207]
    v_mfma_f32_16x16x32_bf16 v[212:215], v[80:83], a[136:139], v[212:215]
    v_mfma_f32_16x16x32_bf16 v[212:215], v[84:87], a[152:155], v[212:215]
    v_mfma_f32_16x16x32_bf16 v[212:215], v[88:91], a[168:171], v[212:215]
    v_mfma_f32_16x16x32_bf16 v[212:215], v[92:95], a[184:187], v[212:215]
    v_mfma_f32_16x16x32_bf16 v[220:223], v[80:83], a[140:143], v[220:223]
    v_mfma_f32_16x16x32_bf16 v[220:223], v[84:87], a[156:159], v[220:223]
    v_mfma_f32_16x16x32_bf16 v[220:223], v[88:91], a[172:175], v[220:223]
    v_mfma_f32_16x16x32_bf16 v[220:223], v[92:95], a[188:191], v[220:223]
    s_waitcnt vmcnt(3)
    v_readfirstlane_b32 s24, v254
    s_lshl_b32 s25, s3, 16
    s_add_u32 s24, s24, s25
    s_cmp_ge_u32 s24, 32
    s_cbranch_scc0 kf_spin53
kf_spinr54:
    s_waitcnt lgkmcnt(0)
    s_barrier
    v_mfma_f32_16x16x32_bf16 v[160:163], v[64:67], a[192:195], v[160:163]
    ds_read_b128 v[80:83], v225 offset:49152
    v_mfma_f32_16x16x32_bf16 v[164:167], v[68:71], a[192:195], v[164:167]
    ds_read_b128 v[84:87], v225 offset:51200
    v_mfma_f32_16x16x32_bf16 v[168:171], v[64:67], a[196:199], v[168:171]
    ds_read_b128 v[88:91], v225 offset:53248
    v_mfma_f32_16x16x32_bf16 v[172:175], v[68:71], a[196:199], v[172:175]
    ds_read_b128 v[92:95], v225 offset:55296
    v_mfma_f32_16x16x32_bf16 v[176:179], v[64:67], a[200:203], v[176:179]
    v_mfma_f32_16x16x32_bf16 v[180:183], v[68:71], a[200:203], v[180:183]
    v_mfma_f32_16x16x32_bf16 v[184:187], v[64:67], a[204:207], v[184:187]
    v_mfma_f32_16x16x32_bf16 v[188:191], v[68:71], a[204:207], v[188:191]
    v_mfma_f32_16x16x32_bf16 v[192:195], v[72:75], a[192:195], v[192:195]
    buffer_load_dwordx4 a[128:131], v248, s[8:11], s28 offen offset:0 sc1
    s_add_u32 s38, s36, 73728
    buffer_store_dwordx4 v[20:23], v240, s[16:19], s38 offen offset:3584 sc1
    v_mfma_f32_16x16x32_bf16 v[196:199], v[76:79], a[192:195], v[196:199]
    v_mfma_f32_16x16x32_bf16 v[200:203], v[72:75], a[196:199], v[200:203]
    buffer_load_dwordx4 a[132:135], v248, s[8:11], s29 offen offset:0 sc1
    v_mfma_f32_16x16x32_bf16 v[204:207], v[76:79], a[196:199], v[204:207]
    v_mfma_f32_16x16x32_bf16 v[208:211], v[72:75], a[200:203], v[208:211]
    v_mfma_f32_16x16x32_bf16 v[212:215], v[76:79], a[200:203], v[212:215]
    buffer_load_dwordx4 a[136:139], v249, s[8:11], s28 offen offset:0 sc1
    v_mfma_f32_16x16x32_bf16 v[216:219], v[72:75], a[204:207], v[216:219]
    v_mfma_f32_16x16x32_bf16 v[220:223], v[76:79], a[204:207], v[220:223]
    s_waitcnt lgkmcnt(0)
    v_mfma_f32_16x16x32_bf16 v[160:163], v[80:83], a[208:211], v[160:163]
    ds_read_b128 v[64:67], v224 offset:57344
    v_mfma_f32_16x16x32_bf16 v[164:167], v[84:87], a[208:211], v[164:167]
    ds_read_b128 v[68:71], v224 offset:59392
    v_mfma_f32_16x16x32_bf16 v[168:171], v[80:83], a[212:215], v[168:171]
    ds_read_b128 v[72:75], v224 offset:61440
    v_mfma_f32_16x16x32_bf16 v[172:175], v[84:87], a[212:215], v[172:175]
    ds_read_b128 v[76:79], v224 offset:63488
    v_mfma_f32_16x16x32_bf16 v[176:179], v[80:83], a[216:219], v[176:179]
    v_mfma_f32_16x16x32_bf16 v[180:183], v[84:87], a[216:219], v[180:183]
    v_mfma_f32_16x16x32_bf16 v[184:187], v[80:83], a[220:223], v[184:187]
    v_mfma_f32_16x16x32_bf16 v[188:191], v[84:87], a[220:223], v[188:191]
    v_mfma_f32_16x16x32_bf16 v[192:195], v[88:91], a[208:211], v[192:195]
    buffer_load_dwordx4 a[140:143], v249, s[8:11], s29 offen offset:0 sc1
    v_mfma_f32_16x16x32_bf16 v[196:199], v[92:95], a[208:211], v[196:199]
    v_mfma_f32_16x16x32_bf16 v[200:203], v[88:91], a[212:215], v[200:203]
    buffer_load_dwordx4 a[144:147], v248, s[8:11], s28 offen offset:1024 sc1
    v_mfma_f32_16x16x32_bf16 v[204:207], v[92:95], a[212:215], v[204:207]
    v_mfma_f32_16x16x32_bf16 v[208:211], v[88:91], a[216:219], v[208:211]
    v_mfma_f32_16x16x32_bf16 v[212:215], v[92:95], a[216:219], v[212:215]
    buffer_load_dwordx4 a[148:151], v248, s[8:11], s29 offen offset:1024 sc1
    v_mfma_f32_16x16x32_bf16 v[216:219], v[88:91], a[220:223], v[216:219]
    s_add_u32 s38, s36, 77824
    buffer_store_dwordx4 v[24:27], v240, s[16:19], s38 offen offset:512 sc1
    v_mfma_f32_16x16x32_bf16 v[220:223], v[92:95], a[220:223], v[220:223]
    s_waitcnt lgkmcnt(0)
    v_mfma_f32_16x16x32_bf16 v[160:163], v[64:67], a[224:227], v[160:163]
    ds_read_b128 v[80:83], v225 offset:57344
    v_mfma_f32_16x16x32_bf16 v[164:167], v[68:71], a[224:227], v[164:167]
    ds_read_b128 v[84:87], v225 offset:59392
    v_mfma_f32_16x16x32_bf16 v[168:171], v[64:67], a[228:231], v[168:171]
    ds_read_b128 v[88:91], v225 offset:61440
    v_mfma_f32_16x16x32_bf16 v[172:175], v[68:71], a[228:231], v[172:175]
    ds_read_b128 v[92:95], v225 offset:63488
    v_mfma_f32_16x16x32_bf16 v[176:179], v[64:67], a[232:235], v[176:179]
    v_mfma_f32_16x16x32_bf16 v[180:183], v[68:71], a[232:235], v[180:183]
    v_mfma_f32_16x16x32_bf16 v[184:187], v[64:67], a[236:239], v[184:187]
    v_mfma_f32_16x16x32_bf16 v[188:191], v[68:71], a[236:239], v[188:191]
    v_mfma_f32_16x16x32_bf16 v[192:195], v[72:75], a[224:227], v[192:195]
    buffer_load_dwordx4 a[152:155], v249, s[8:11], s28 offen offset:1024 sc1
    v_mfma_f32_16x16x32_bf16 v[196:199], v[76:79], a[224:227], v[196:199]
    v_mfma_f32_16x16x32_bf16 v[200:203], v[72:75], a[228:231], v[200:203]
    buffer_load_dwordx4 a[156:159], v249, s[8:11], s29 offen offset:1024 sc1
    v_mfma_f32_16x16x32_bf16 v[204:207], v[76:79], a[228:231], v[204:207]
    v_mfma_f32_16x16x32_bf16 v[208:211], v[72:75], a[232:235], v[208:211]
    v_mfma_f32_16x16x32_bf16 v[212:215], v[76:79], a[232:235], v[212:215]
    buffer_load_dwordx4 a[160:163], v248, s[8:11], s28 offen offset:2048 sc1
    v_mfma_f32_16x16x32_bf16 v[216:219], v[72:75], a[236:239], v[216:219]
    v_mfma_f32_16x16x32_bf16 v[220:223], v[76:79], a[236:239], v[220:223]
    s_waitcnt vmcnt(38) lgkmcnt(0)
    s_barrier
    v_mfma_f32_16x16x32_bf16 v[160:163], v[80:83], a[240:243], v[160:163]
    ds_read_b64_tr_b16 a[192:193], v246 offset:0
    v_mfma_f32_16x16x32_bf16 v[164:167], v[84:87], a[240:243], v[164:167]
    ds_read_b64_tr_b16 a[194:195], v246 offset:1024
    v_mfma_f32_16x16x32_bf16 v[168:171], v[80:83], a[244:247], v[168:171]
    ds_read_b64_tr_b16 a[196:197], v238 offset:0
    v_mfma_f32_16x16x32_bf16 v[172:175], v[84:87], a[244:247], v[172:175]
    ds_read_b64_tr_b16 a[198:199], v238 offset:1024
    v_mfma_f32_16x16x32_bf16 v[176:179], v[80:83], a[248:251], v[176:179]
    ds_read_b64_tr_b16 a[200:201], v246 offset:256
    s_add_u32 s38, s36, 77824
    buffer_store_dwordx4 v[28:31], v240, s[16:19], s38 offen offset:1536 sc1
    v_mfma_f32_16x16x32_bf16 v[180:183], v[84:87], a[248:251], v[180:183]
    ds_read_b64_tr_b16 a[202:203], v246 offset:1280
    v_mfma_f32_16x16x32_bf16 v[184:187], v[80:83], a[252:255], v[184:187]
    ds_read_b64_tr_b16 a[204:205], v238 offset:256
    v_mfma_f32_16x16x32_bf16 v[188:191], v[84:87], a[252:255], v[188:191]
    ds_read_b64_tr_b16 a[206:207], v238 offset:1280
    v_mfma_f32_16x16x32_bf16 v[192:195], v[88:91], a[240:243], v[192:195]
    buffer_load_dwordx4 a[164:167], v248, s[8:11], s29 offen offset:2048 sc1
    v_mfma_f32_16x16x32_bf16 v[196:199], v[92:95], a[240:243], v[196:199]
    v_cvt_pk_bf16_f32 v32, v160, v161
    v_cvt_pk_bf16_f32 v33, v162, v163
    v_mfma_f32_16x16x32_bf16 v[200:203], v[88:91], a[244:247], v[200:203]
    buffer_load_dwordx4 a[168:171], v249, s[8:11], s28 offen offset:2048 sc1
    v_cvt_pk_bf16_f32 v34, v164, v165
    v_cvt_pk_bf16_f32 v35, v166, v167
    v_mfma_f32_16x16x32_bf16 v[204:207], v[92:95], a[244:247], v[204:207]
    v_cvt_pk_bf16_f32 v36, v168, v169
    v_cvt_pk_bf16_f32 v37, v170, v171
    v_mfma_f32_16x16x32_bf16 v[208:211], v[88:91], a[248:251], v[208:211]
    v_cvt_pk_bf16_f32 v38, v172, v173
    v_cvt_pk_bf16_f32 v39, v174, v175
    v_mfma_f32_16x16x32_bf16 v[212:215], v[92:95], a[248:251], v[212:215]
    buffer_load_dwordx4 a[172:175], v249, s[8:11], s29 offen offset:2048 sc1
    v_cvt_pk_bf16_f32 v40, v176, v177
    v_cvt_pk_bf16_f32 v41, v178, v179
    v_mfma_f32_16x16x32_bf16 v[216:219], v[88:91], a[252:255], v[216:219]
    v_cvt_pk_bf16_f32 v42, v180, v181
    v_cvt_pk_bf16_f32 v43, v182, v183
    v_mfma_f32_16x16x32_bf16 v[220:223], v[92:95], a[252:255], v[220:223]
    v_cvt_pk_bf16_f32 v44, v184, v185
    v_cvt_pk_bf16_f32 v45, v186, v187
    s_nop 3
    v_cvt_pk_bf16_f32 v46, v188, v189
    v_cvt_pk_bf16_f32 v47, v190, v191
    v_cvt_pk_bf16_f32 v48, v192, v193
    v_cvt_pk_bf16_f32 v49, v194, v195
    v_cvt_pk_bf16_f32 v50, v196, v197
    v_cvt_pk_bf16_f32 v51, v198, v199
    v_cvt_pk_bf16_f32 v52, v200, v201
    v_cvt_pk_bf16_f32 v53, v202, v203
    v_cvt_pk_bf16_f32 v54, v204, v205
    v_cvt_pk_bf16_f32 v55, v206, v207
    v_cvt_pk_bf16_f32 v56, v208, v209
    v_cvt_pk_bf16_f32 v57, v210, v211
    v_cvt_pk_bf16_f32 v58, v212, v213
    v_cvt_pk_bf16_f32 v59, v214, v215
    v_cvt_pk_bf16_f32 v60, v216, v217
    v_cvt_pk_bf16_f32 v61, v218, v219
    v_cvt_pk_bf16_f32 v62, v220, v221
    v_cvt_pk_bf16_f32 v63, v222, v223
    s_add_u32 s80, s36, 102144
    s_add_u32 s81, s36, 103168
    s_add_u32 s82, s36, 104192
    s_add_u32 s83, s36, 105216
    s_add_u32 s84, s36, 110336
    s_add_u32 s85, s36, 111360
    s_add_u32 s86, s36, 112384
    s_add_u32 s87, s36, 113408
ka_Q:
    s_waitcnt vmcnt(10) lgkmcnt(0)
    v_mfma_f32_16x16x32_bf16 v[96:99], a[192:195], a[128:131], 0
    ds_read_b64_tr_b16 a[208:209], v246 offset:512
    s_lshl_b32 s97, s4, 7
    v_mfma_f32_16x16x32_bf16 v[100:103], a[192:195], a[132:135], 0
    ds_read_b64_tr_b16 a[210:211], v246 offset:1536
    s_add_u32 s97, s97, 12288
    s_cmp_eq_u32 s3, 0
    s_cselect_b32 s35, s97, s43
    v_mfma_f32_16x16x32_bf16 v[104:107], a[192:195], a[136:139], 0
    ds_read_b64_tr_b16 a[212:213], v238 offset:512
    s_lshl_b32 s37, s3, 12
    v_mfma_f32_16x16x32_bf16 v[108:111], a[192:195], a[140:143], 0
    ds_read_b64_tr_b16 a[214:215], v238 offset:1536
    s_mov_b32 s34, s37
    s_mul_i32 s32, s4, 1089536
    v_mfma_f32_16x16x32_bf16 v[112:115], a[196:199], a[128:131], 0
    ds_read_b64_tr_b16 a[216:217], v246 offset:768
    s_mov_b32 s33, 0
    v_mfma_f32_16x16x32_bf16 v[116:119], a[196:199], a[132:135], 0
    ds_read_b64_tr_b16 a[218:219], v246 offset:1792
    s_lshl_b32 s39, s6, 18
    v_mfma_f32_16x16x32_bf16 v[120:123], a[196:199], a[136:139], 0
    ds_read_b64_tr_b16 a[220:221], v238 offset:768
    s_sub_u32 s25, 63, s6
    s_lshl_b32 s40, s25, 18
    v_mfma_f32_16x16x32_bf16 v[124:127], a[196:199], a[140:143], 0
    ds_read_b64_tr_b16 a[222:223], v238 offset:1792
    s_lshl_b32 s25, s4, 12
    v_mfma_f32_16x16x32_bf16 v[128:131], a[200:203], a[128:131], 0
    buffer_load_dwordx4 a[176:179], v248, s[8:11], s28 offen offset:3072 sc1
    s_add_u32 s39, s39, s25
    s_add_u32 s40, s40, s25
    v_mfma_f32_16x16x32_bf16 v[132:135], a[200:203], a[132:135], 0
    s_mov_b32 s38, 0x40004000
    s_mov_b32 s36, s6
    v_mfma_f32_16x16x32_bf16 v[136:139], a[200:203], a[136:139], 0
    buffer_load_dwordx4 a[180:183], v248, s[8:11], s29 offen offset:3072 sc1
    s_mov_b32 s26, 6
    v_mfma_f32_16x16x32_bf16 v[140:143], a[200:203], a[140:143], 0
    s_add_u32 m0, s31, 0
    s_add_u32 s24, s27, 0
    s_mov_b32 s52, s41
    v_mfma_f32_16x16x32_bf16 v[144:147], a[204:207], a[128:131], 0
    buffer_load_dwordx4 v245, s[12:15], s24 offen lds
    s_mov_b32 s53, s42
    v_mfma_f32_16x16x32_bf16 v[148:151], a[204:207], a[132:135], 0
    s_mov_b32 s54, 0x700000
    s_add_u32 s48, s20, 0x1c00000
    s_addc_u32 s49, s21, 0
    v_mfma_f32_16x16x32_bf16 v[152:155], a[204:207], a[136:139], 0
    buffer_store_dwordx4 v[32:35], v240, s[16:19], s80 offen sc1
    s_mov_b32 s50, 0x1c00000
    s_and_b32 s25, s3, 1
    v_mfma_f32_16x16x32_bf16 v[156:159], a[204:207], a[140:143], 0
    s_lshl1_add_u32 s47, s4, s25
    s_waitcnt lgkmcnt(0)
    v_mfma_f32_16x16x32_bf16 v[160:163], a[208:211], a[128:131], 0
    ds_read_b64_tr_b16 a[192:193], v246 offset:8192
    s_lshr_b32 s101, s3, 1
    v_mfma_f32_16x16x32_bf16 v[164:167], a[208:211], a[132:135], 0
    ds_read_b64_tr_b16 a[194:195], v246 offset:9216
    s_add_u32 s45, s5, s101
    s_sub_u32 s45, s45, 1
    v_mfma_f32_16x16x32_bf16 v[168:171], a[208:211], a[136:139], 0
    ds_read_b64_tr_b16 a[196:197], v238 offset:8192
    s_mul_i32 s45, s45, s5
    v_mfma_f32_16x16x32_bf16 v[172:175], a[208:211], a[140:143], 0
    ds_read_b64_tr_b16 a[198:199], v238 offset:9216
    s_lshl_b32 s100, s101, 14
    s_add_u32 s100, s100, 114688
    v_mfma_f32_16x16x32_bf16 v[176:179], a[212:215], a[128:131], 0
    ds_read_b64_tr_b16 a[200:201], v246 offset:8448
    s_mul_i32 s100, s100, s47
    v_mfma_f32_16x16x32_bf16 v[180:183], a[212:215], a[132:135], 0
    ds_read_b64_tr_b16 a[202:203], v246 offset:9472
    s_lshl_b32 s25, s45, 11
    v_mfma_f32_16x16x32_bf16 v[184:187], a[212:215], a[136:139], 0
    ds_read_b64_tr_b16 a[204:205], v238 offset:8448
    s_add_u32 s100, s100, s25
    s_lshl_b32 s46, s47, 9
    v_mfma_f32_16x16x32_bf16 v[188:191], a[212:215], a[140:143], 0
    ds_read_b64_tr_b16 a[206:207], v238 offset:9472
    s_mul_i32 s44, s47, 114688
    v_mfma_f32_16x16x32_bf16 v[192:195], a[216:219], a[128:131], 0
    buffer_load_dwordx4 a[184:187], v249, s[8:11], s28 offen offset:3072 sc1
    s_add_u32 s47, s44, 7168
    s_lshl_b32 s25, s45, 7
    v_mfma_f32_16x16x32_bf16 v[196:199], a[216:219], a[132:135], 0
    s_add_u32 s44, s44, s25
    s_lshl_b32 s45, s45, 18
    v_mfma_f32_16x16x32_bf16 v[200:203], a[216:219], a[136:139], 0
    buffer_load_dwordx4 a[188:191], v249, s[8:11], s29 offen offset:3072 sc1
    s_add_u32 s46, s46, s45
    v_mfma_f32_16x16x32_bf16 v[204:207], a[216:219], a[140:143], 0
    s_add_u32 m0, s31, 1024
    s_add_u32 s24, s27, 32768
    s_lshr_b32 s25, s3, 1
    v_mfma_f32_16x16x32_bf16 v[208:211], a[220:223], a[128:131], 0
    buffer_load_dwordx4 v245, s[12:15], s24 offen lds
    s_lshl_b32 s25, s25, 15
    v_mfma_f32_16x16x32_bf16 v[212:215], a[220:223], a[132:135], 0
    s_add_u32 s46, s46, s25
    s_mov_b32 s45, s43
    v_mfma_f32_16x16x32_bf16 v[216:219], a[220:223], a[136:139], 0
    s_add_u32 s28, s28, 4096
    s_and_b32 s28, s28, 32767
    buffer_store_dwordx4 v[36:39], v240, s[16:19], s81 offen sc1
    v_mfma_f32_16x16x32_bf16 v[220:223], a[220:223], a[140:143], 0
    s_add_u32 s29, s28, 32768
    v_accvgpr_write_b32 a0, 0
    s_waitcnt vmcnt(13) lgkmcnt(0)
    v_mfma_f32_16x16x32_bf16 v[96:99], a[192:195], a[144:147], v[96:99]
    ds_read_b64_tr_b16 a[208:209], v246 offset:8704
    s_load_dwordx2 s[56:57], s[0:1], 40
    v_accvgpr_write_b32 a1, 0
    v_mfma_f32_16x16x32_bf16 v[100:103], a[192:195], a[148:151], v[100:103]
    ds_read_b64_tr_b16 a[210:211], v246 offset:9728
    v_accvgpr_write_b32 a2, 0
    v_mfma_f32_16x16x32_bf16 v[104:107], a[192:195], a[152:155], v[104:107]
    ds_read_b64_tr_b16 a[212:213], v238 offset:8704
    v_accvgpr_write_b32 a3, 0
    v_mfma_f32_16x16x32_bf16 v[108:111], a[192:195], a[156:159], v[108:111]
    ds_read_b64_tr_b16 a[214:215], v238 offset:9728
    v_accvgpr_write_b32 a4, 0
    v_accvgpr_write_b32 a5, 0
    v_mfma_f32_16x16x32_bf16 v[112:115], a[196:199], a[144:147], v[112:115]
    ds_read_b64_tr_b16 a[216:217], v246 offset:8960
    v_accvgpr_write_b32 a6, 0
    v_mfma_f32_16x16x32_bf16 v[116:119], a[196:199], a[148:151], v[116:119]
    ds_read_b64_tr_b16 a[218:219], v246 offset:9984
    v_accvgpr_write_b32 a7, 0
    v_accvgpr_write_b32 a8, 0
    v_mfma_f32_16x16x32_bf16 v[120:123], a[196:199], a[152:155], v[120:123]
    ds_read_b64_tr_b16 a[220:221], v238 offset:8960
    v_accvgpr_write_b32 a9, 0
    v_mfma_f32_16x16x32_bf16 v[124:127], a[196:199], a[156:159], v[124:127]
    ds_read_b64_tr_b16 a[222:223], v238 offset:9984
    v_accvgpr_write_b32 a10, 0
    v_mfma_f32_16x16x32_bf16 v[128:131], a[200:203], a[144:147], v[128:131]
    buffer_load_dwordx4 a[128:131], v248, s[8:11], s28 offen offset:0 sc1
    v_accvgpr_write_b32 a11, 0
    v_accvgpr_write_b32 a12, 0
    v_mfma_f32_16x16x32_bf16 v[132:135], a[200:203], a[148:151], v[132:135]
    v_accvgpr_write_b32 a13, 0
    v_accvgpr_write_b32 a14, 0
    v_mfma_f32_16x16x32_bf16 v[136:139], a[200:203], a[152:155], v[136:139]
    buffer_load_dwordx4 a[132:135], v248, s[8:11], s29 offen offset:0 sc1
    v_accvgpr_write_b32 a15, 0
    v_mfma_f32_16x16x32_bf16 v[140:143], a[200:203], a[156:159], v[140:143]
    s_add_u32 m0, s31, 2048
    s_add_u32 s24, s27, 65536
    v_accvgpr_write_b32 a16, 0
    v_mfma_f32_16x16x32_bf16 v[144:147], a[204:207], a[144:147], v[144:147]
    buffer_load_dwordx4 v237, s[12:15], s24 offen lds
    v_accvgpr_write_b32 a17, 0
    v_mfma_f32_16x16x32_bf16 v[148:151], a[204:207], a[148:151], v[148:151]
    v_accvgpr_write_b32 a18, 0
    v_accvgpr_write_b32 a19, 0
    v_accvgpr_write_b32 a20, 0
    v_mfma_f32_16x16x32_bf16 v[152:155], a[204:207], a[152:155], v[152:155]
    buffer_store_dwordx4 v[40:43], v240, s[16:19], s82 offen sc1
    v_accvgpr_write_b32 a21, 0
    v_mfma_f32_16x16x32_bf16 v[156:159], a[204:207], a[156:159], v[156:159]
    v_accvgpr_write_b32 a22, 0
    s_waitcnt lgkmcnt(0)
    v_mfma_f32_16x16x32_bf16 v[160:163], a[208:211], a[144:147], v[160:163]
    ds_read_b64_tr_b16 a[192:193], v246 offset:16384
    v_accvgpr_write_b32 a23, 0
    v_accvgpr_write_b32 a24, 0
    v_mfma_f32_16x16x32_bf16 v[164:167], a[208:211], a[148:151], v[164:167]
    ds_read_b64_tr_b16 a[194:195], v246 offset:17408
    v_accvgpr_write_b32 a25, 0
    v_mfma_f32_16x16x32_bf16 v[168:171], a[208:211], a[152:155], v[168:171]
    ds_read_b64_tr_b16 a[196:197], v238 offset:16384
    v_accvgpr_write_b32 a26, 0
    v_mfma_f32_16x16x32_bf16 v[172:175], a[208:211], a[156:159], v[172:175]
    ds_read_b64_tr_b16 a[198:199], v238 offset:17408
    v_accvgpr_write_b32 a27, 0
    v_accvgpr_write_b32 a28, 0
    v_mfma_f32_16x16x32_bf16 v[176:179], a[212:215], a[144:147], v[176:179]
    ds_read_b64_tr_b16 a[200:201], v246 offset:16640
    v_accvgpr_write_b32 a29, 0
    v_mfma_f32_16x16x32_bf16 v[180:183], a[212:215], a[148:151], v[180:183]
    ds_read_b64_tr_b16 a[202:203], v246 offset:17664
    v_accvgpr_write_b32 a30, 0
    v_accvgpr_write_b32 a31, 0
    v_mfma_f32_16x16x32_bf16 v[184:187], a[212:215], a[152:155], v[184:187]
    ds_read_b64_tr_b16 a[204:205], v238 offset:16640
    v_accvgpr_write_b32 a32, 0
    v_mfma_f32_16x16x32_bf16 v[188:191], a[212:215], a[156:159], v[188:191]
    ds_read_b64_tr_b16 a[206:207], v238 offset:17664
    v_accvgpr_write_b32 a33, 0
    v_mfma_f32_16x16x32_bf16 v[192:195], a[216:219], a[144:147], v[192:195]
    buffer_load_dwordx4 a[136:139], v249, s[8:11], s28 offen offset:0 sc1
    v_accvgpr_write_b32 a34, 0
    v_accvgpr_write_b32 a35, 0
    v_mfma_f32_16x16x32_bf16 v[196:199], a[216:219], a[148:151], v[196:199]
    v_accvgpr_write_b32 a36, 0
    v_accvgpr_write_b32 a37, 0
    v_mfma_f32_16x16x32_bf16 v[200:203], a[216:219], a[152:155], v[200:203]
    buffer_load_dwordx4 a[140:143], v249, s[8:11], s29 offen offset:0 sc1
    v_accvgpr_write_b32 a38, 0
    v_mfma_f32_16x16x32_bf16 v[204:207], a[216:219], a[156:159], v[204:207]
    s_add_u32 m0, s31, 3072
    s_add_u32 s24, s27, 98304
    v_accvgpr_write_b32 a39, 0
    v_mfma_f32_16x16x32_bf16 v[208:211], a[220:223], a[144:147], v[208:211]
    buffer_load_dwordx4 v237, s[12:15], s24 offen lds
    v_accvgpr_write_b32 a40, 0
    v_mfma_f32_16x16x32_bf16 v[212:215], a[220:223], a[148:151], v[212:215]
    v_accvgpr_write_b32 a41, 0
    v_accvgpr_write_b32 a42, 0
    v_accvgpr_write_b32 a43, 0
    v_mfma_f32_16x16x32_bf16 v[216:219], a[220:223], a[152:155], v[216:219]
    buffer_store_dwordx4 v[44:47], v240, s[16:19], s83 offen sc1
    v_accvgpr_write_b32 a44, 0
    v_mfma_f32_16x16x32_bf16 v[220:223], a[220:223], a[156:159], v[220:223]
    v_accvgpr_write_b32 a45, 0
    s_waitcnt vmcnt(16) lgkmcnt(0)
    v_mfma_f32_16x16x32_bf16 v[96:99], a[192:195], a[160:163], v[96:99]
    ds_read_b64_tr_b16 a[208:209], v246 offset:16896
    v_accvgpr_write_b32 a46, 0
    v_accvgpr_write_b32 a47, 0
    v_mfma_f32_16x16x32_bf16 v[100:103], a[192:195], a[164:167], v[100:103]
    ds_read_b64_tr_b16 a[210:211], v246 offset:17920
    v_accvgpr_write_b32 a48, 0
    v_mfma_f32_16x16x32_bf16 v[104:107], a[192:195], a[168:171], v[104:107]
    ds_read_b64_tr_b16 a[212:213], v238 offset:16896
    v_accvgpr_write_b32 a49, 0
    v_accvgpr_write_b32 a50, 0
    v_mfma_f32_16x16x32_bf16 v[108:111], a[192:195], a[172:175], v[108:111]
    ds_read_b64_tr_b16 a[214:215], v238 offset:17920
    v_accvgpr_write_b32 a51, 0
    v_mfma_f32_16x16x32_bf16 v[112:115], a[196:199], a[160:163], v[112:115]
    ds_read_b64_tr_b16 a[216:217], v246 offset:17152
    v_accvgpr_write_b32 a52, 0
    v_mfma_f32_16x16x32_bf16 v[116:119], a[196:199], a[164:167], v[116:119]
    ds_read_b64_tr_b16 a[218:219], v246 offset:18176
    v_accvgpr_write_b32 a53, 0
    v_accvgpr_write_b32 a54, 0
    v_mfma_f32_16x16x32_bf16 v[120:123], a[196:199], a[168:171], v[120:123]
    ds_read_b64_tr_b16 a[220:221], v238 offset:17152
    v_accvgpr_write_b32 a55, 0
    v_mfma_f32_16x16x32_bf16 v[124:127], a[196:199], a[172:175], v[124:127]
    ds_read_b64_tr_b16 a[222:223], v238 offset:18176
    v_accvgpr_write_b32 a56, 0
    v_accvgpr_write_b32 a57, 0
    v_mfma_f32_16x16x32_bf16 v[128:131], a[200:203], a[160:163], v[128:131]
    buffer_load_dwordx4 a[144:147], v248, s[8:11], s28 offen offset:1024 sc1
    v_accvgpr_write_b32 a58, 0
    v_mfma_f32_16x16x32_bf16 v[132:135], a[200:203], a[164:167], v[132:135]
    v_accvgpr_write_b32 a59, 0
    v_accvgpr_write_b32 a60, 0
    v_mfma_f32_16x16x32_bf16 v[136:139], a[200:203], a[168:171], v[136:139]
    buffer_load_dwordx4 a[148:151], v248, s[8:11], s29 offen offset:1024 sc1
    v_accvgpr_write_b32 a61, 0
    v_mfma_f32_16x16x32_bf16 v[140:143], a[200:203], a[172:175], v[140:143]
    s_add_u32 m0, s31, 4096
    s_add_u32 s24, s27, 131072
    v_accvgpr_write_b32 a62, 0
    v_mfma_f32_16x16x32_bf16 v[144:147], a[204:207], a[160:163], v[144:147]
    buffer_load_dwordx4 v245, s[12:15], s24 offen lds
    v_accvgpr_write_b32 a63, 0
    v_mfma_f32_16x16x32_bf16 v[148:151], a[204:207], a[164:167], v[148:151]
    v_accvgpr_write_b32 a64, 0
    v_accvgpr_write_b32 a65, 0
    v_accvgpr_write_b32 a66, 0
    v_mfma_f32_16x16x32_bf16 v[152:155], a[204:207], a[168:171], v[152:155]
    buffer_store_dwordx4 v[48:51], v240, s[16:19], s84 offen sc1
    v_accvgpr_write_b32 a67, 0
    v_mfma_f32_16x16x32_bf16 v[156:159], a[204:207], a[172:175], v[156:159]
    v_accvgpr_write_b32 a68, 0
    s_waitcnt lgkmcnt(0)
    v_mfma_f32_16x16x32_bf16 v[160:163], a[208:211], a[160:163], v[160:163]
    ds_read_b64_tr_b16 a[192:193], v246 offset:24576
    v_accvgpr_write_b32 a69, 0
    v_accvgpr_write_b32 a70, 0
    v_mfma_f32_16x16x32_bf16 v[164:167], a[208:211], a[164:167], v[164:167]
    ds_read_b64_tr_b16 a[194:195], v246 offset:25600
    v_accvgpr_write_b32 a71, 0
    v_mfma_f32_16x16x32_bf16 v[168:171], a[208:211], a[168:171], v[168:171]
    ds_read_b64_tr_b16 a[196:197], v238 offset:24576
    v_accvgpr_write_b32 a72, 0
    v_accvgpr_write_b32 a73, 0
    v_mfma_f32_16x16x32_bf16 v[172:175], a[208:211], a[172:175], v[172:175]
    ds_read_b64_tr_b16 a[198:199], v238 offset:25600
    v_accvgpr_write_b32 a74, 0
    v_mfma_f32_16x16x32_bf16 v[176:179], a[212:215], a[160:163], v[176:179]
    ds_read_b64_tr_b16 a[200:201], v246 offset:24832
    v_accvgpr_write_b32 a75, 0
    v_mfma_f32_16x16x32_bf16 v[180:183], a[212:215], a[164:167], v[180:183]
    ds_read_b64_tr_b16 a[202:203], v246 offset:25856
    v_accvgpr_write_b32 a76, 0
    v_accvgpr_write_b32 a77, 0
    v_mfma_f32_16x16x32_bf16 v[184:187], a[212:215], a[168:171], v[184:187]
    ds_read_b64_tr_b16 a[204:205], v238 offset:24832
    v_accvgpr_write_b32 a78, 0
    v_mfma_f32_16x16x32_bf16 v[188:191], a[212:215], a[172:175], v[188:191]
    ds_read_b64_tr_b16 a[206:207], v238 offset:25856
    v_accvgpr_write_b32 a79, 0
    v_accvgpr_write_b32 a80, 0
    v_mfma_f32_16x16x32_bf16 v[192:195], a[216:219], a[160:163], v[192:195]
    buffer_load_dwordx4 a[152:155], v249, s[8:11], s28 offen offset:1024 sc1
    v_accvgpr_write_b32 a81, 0
    v_mfma_f32_16x16x32_bf16 v[196:199], a[216:219], a[164:167], v[196:199]
    v_accvgpr_write_b32 a82, 0
    v_accvgpr_write_b32 a83, 0
    v_mfma_f32_16x16x32_bf16 v[200:203], a[216:219], a[168:171], v[200:203]
    buffer_load_dwordx4 a[156:159], v249, s[8:11], s29 offen offset:1024 sc1
    v_accvgpr_write_b32 a84, 0
    v_mfma_f32_16x16x32_bf16 v[204:207], a[216:219], a[172:175], v[204:207]
    s_add_u32 m0, s31, 5120
    s_add_u32 s24, s27, 163840
    v_accvgpr_write_b32 a85, 0
    v_mfma_f32_16x16x32_bf16 v[208:211], a[220:223], a[160:163], v[208:211]
    buffer_load_dwordx4 v245, s[12:15], s24 offen lds
    v_accvgpr_write_b32 a86, 0
    v_accvgpr_write_b32 a87, 0
    v_mfma_f32_16x16x32_bf16 v[212:215], a[220:223], a[164:167], v[212:215]
    v_accvgpr_write_b32 a88, 0
    v_accvgpr_write_b32 a89, 0
    v_mfma_f32_16x16x32_bf16 v[216:219], a[220:223], a[168:171], v[216:219]
    s_add_u32 s30, s30, 32768
    buffer_store_dwordx4 v[52:55], v240, s[16:19], s85 offen sc1
    v_mfma_f32_16x16x32_bf16 v[220:223], a[220:223], a[172:175], v[220:223]
    s_cmp_ge_u32 s30, 163840
    s_cselect_b32 s30, 65536, s30
    s_waitcnt vmcnt(18) lgkmcnt(0)
    v_mfma_f32_16x16x32_bf16 v[96:99], a[192:195], a[176:179], v[96:99]
    ds_read_b64_tr_b16 a[208:209], v246 offset:25088
    v_accvgpr_write_b32 a90, 0
    v_accvgpr_write_b32 a91, 0
    v_mfma_f32_16x16x32_bf16 v[100:103], a[192:195], a[180:183], v[100:103]
    ds_read_b64_tr_b16 a[210:211], v246 offset:26112
    v_accvgpr_write_b32 a92, 0
    v_mfma_f32_16x16x32_bf16 v[104:107], a[192:195], a[184:187], v[104:107]
    ds_read_b64_tr_b16 a[212:213], v238 offset:25088
    v_accvgpr_write_b32 a93, 0
    v_mfma_f32_16x16x32_bf16 v[108:111], a[192:195], a[188:191], v[108:111]
    ds_read_b64_tr_b16 a[214:215], v238 offset:26112
    v_accvgpr_write_b32 a94, 0
    v_accvgpr_write_b32 a95, 0
    v_mfma_f32_16x16x32_bf16 v[112:115], a[196:199], a[176:179], v[112:115]
    ds_read_b64_tr_b16 a[216:217], v246 offset:25344
    v_accvgpr_write_b32 a96, 0
    v_mfma_f32_16x16x32_bf16 v[116:119], a[196:199], a[180:183], v[116:119]
    ds_read_b64_tr_b16 a[218:219], v246 offset:26368
    v_accvgpr_write_b32 a97, 0
    v_accvgpr_write_b32 a98, 0
    v_mfma_f32_16x16x32_bf16 v[120:123], a[196:199], a[184:187], v[120:123]
    ds_read_b64_tr_b16 a[220:221], v238 offset:25344
    v_accvgpr_write_b32 a99, 0
    v_mfma_f32_16x16x32_bf16 v[124:127], a[196:199], a[188:191], v[124:127]
    ds_read_b64_tr_b16 a[222:223], v238 offset:26368
    v_accvgpr_write_b32 a100, 0
    v_mfma_f32_16x16x32_bf16 v[128:131], a[200:203], a[176:179], v[128:131]
    buffer_load_dwordx4 a[160:163], v248, s[8:11], s28 offen offset:2048 sc1
    v_accvgpr_write_b32 a101, 0
    v_accvgpr_write_b32 a102, 0
    v_mfma_f32_16x16x32_bf16 v[132:135], a[200:203], a[180:183], v[132:135]
    v_accvgpr_write_b32 a103, 0
    v_accvgpr_write_b32 a104, 0
    v_mfma_f32_16x16x32_bf16 v[136:139], a[200:203], a[184:187], v[136:139]
    buffer_load_dwordx4 a[164:167], v248, s[8:11], s29 offen offset:2048 sc1
    v_accvgpr_write_b32 a105, 0
    v_mfma_f32_16x16x32_bf16 v[140:143], a[200:203], a[188:191], v[140:143]
    s_add_u32 m0, s31, 6144
    s_add_u32 s24, s27, 196608
    v_accvgpr_write_b32 a106, 0
    v_mfma_f32_16x16x32_bf16 v[144:147], a[204:207], a[176:179], v[144:147]
    buffer_load_dwordx4 v237, s[12:15], s24 offen lds
    v_accvgpr_write_b32 a107, 0
    v_mfma_f32_16x16x32_bf16 v[148:151], a[204:207], a[180:183], v[148:151]
    v_accvgpr_write_b32 a108, 0
    v_accvgpr_write_b32 a109, 0
    v_accvgpr_write_b32 a110, 0
    v_mfma_f32_16x16x32_bf16 v[152:155], a[204:207], a[184:187], v[152:155]
    buffer_store_dwordx4 v[56:59], v240, s[16:19], s86 offen sc1
    v_accvgpr_write_b32 a111, 0
    v_mfma_f32_16x16x32_bf16 v[156:159], a[204:207], a[188:191], v[156:159]
    s_waitcnt vmcnt(49) lgkmcnt(0)
    s_barrier
    v_add_u32 v246, s30, v247
    v_mfma_f32_16x16x32_bf16 v[160:163], a[208:211], a[176:179], v[160:163]
    v_xor_b32_e64 v238, 16, v246
    ds_read_b64_tr_b16 a[192:193], v246 offset:0
    v_accvgpr_write_b32 a112, 0
    v_mfma_f32_16x16x32_bf16 v[164:167], a[208:211], a[180:183], v[164:167]
    ds_read_b64_tr_b16 a[194:195], v246 offset:1024
    v_accvgpr_write_b32 a113, 0
    v_mfma_f32_16x16x32_bf16 v[168:171], a[208:211], a[184:187], v[168:171]
    ds_read_b64_tr_b16 a[196:197], v238 offset:0
    v_accvgpr_write_b32 a114, 0
    v_mfma_f32_16x16x32_bf16 v[172:175], a[208:211], a[188:191], v[172:175]
    ds_read_b64_tr_b16 a[198:199], v238 offset:1024
    v_accvgpr_write_b32 a115, 0
    v_accvgpr_write_b32 a116, 0
    v_mfma_f32_16x16x32_bf16 v[176:179], a[212:215], a[176:179], v[176:179]
    ds_read_b64_tr_b16 a[200:201], v246 offset:256
    v_accvgpr_write_b32 a117, 0
    v_mfma_f32_16x16x32_bf16 v[180:183], a[212:215], a[180:183], v[180:183]
    ds_read_b64_tr_b16 a[202:203], v246 offset:1280
    v_accvgpr_write_b32 a118, 0
    v_accvgpr_write_b32 a119, 0
    v_mfma_f32_16x16x32_bf16 v[184:187], a[212:215], a[184:187], v[184:187]
    ds_read_b64_tr_b16 a[204:205], v238 offset:256
    buffer_store_dwordx4 v[60:63], v240, s[16:19], s87 offen sc1
    v_mfma_f32_16x16x32_bf16 v[188:191], a[212:215], a[188:191], v[188:191]
    ds_read_b64_tr_b16 a[206:207], v238 offset:1280
    v_accvgpr_write_b32 a120, 0
    v_accvgpr_write_b32 a121, 0
    v_mfma_f32_16x16x32_bf16 v[192:195], a[216:219], a[176:179], v[192:195]
    buffer_load_dwordx4 a[168:171], v249, s[8:11], s28 offen offset:2048 sc1
    v_accvgpr_write_b32 a122, 0
    v_mfma_f32_16x16x32_bf16 v[196:199], a[216:219], a[180:183], v[196:199]
    s_lshl2_add_u32 s80, s2, s3
    s_mul_i32 s80, s80, 12288
    s_add_u32 s80, s80, 0x1000000
    v_mov_b32 v0, -1
    v_mov_b32 v1, -1
    v_mov_b32 v2, -1
    v_mov_b32_e64 v3, -1
    v_mfma_f32_16x16x32_bf16 v[200:203], a[216:219], a[184:187], v[200:203]
    buffer_load_dwordx4 a[172:175], v249, s[8:11], s29 offen offset:2048 sc1
    v_accvgpr_write_b32 a123, 0
    v_accvgpr_write_b32 a124, 0
    v_mfma_f32_16x16x32_bf16 v[204:207], a[216:219], a[188:191], v[204:207]
    s_add_u32 m0, s31, 7168
    s_add_u32 s24, s27, 229376
    v_mfma_f32_16x16x32_bf16 v[208:211], a[220:223], a[176:179], v[208:211]
    buffer_load_dwordx4 v237, s[12:15], s24 offen lds
    v_accvgpr_write_b32 a125, 0
    v_accvgpr_write_b32 a126, 0
    v_mfma_f32_16x16x32_bf16 v[212:215], a[220:223], a[180:183], v[212:215]
    s_add_u32 s27, s27, 1048576
    s_and_b32 s27, s27, 0x407fffff
    v_mfma_f32_16x16x32_bf16 v[216:219], a[220:223], a[184:187], v[216:219]
    s_cmp_eq_u32 s27, s7
    s_cselect_b32 s27, s43, s27
    v_accvgpr_write_b32 a127, 0
    v_mfma_f32_16x16x32_bf16 v[220:223], a[220:223], a[188:191], v[220:223]
    s_add_u32 s31, s31, 32768
    s_cmp_ge_u32 s31, 163840
    s_cselect_b32 s24, 98304, 0
    s_sub_u32 s31, s31, s24
.p2align 3
ka_qp:
    s_waitcnt vmcnt(15) lgkmcnt(0)
    v_mfma_f32_16x16x32_bf16 v[96:99], a[192:195], a[128:131], v[96:99]
    ds_read_b64_tr_b16 a[208:209], v246 offset:512
    v_mfma_f32_16x16x32_bf16 v[100:103], a[192:195], a[132:135], v[100:103]
    ds_read_b64_tr_b16 a[210:211], v246 offset:1536
    v_mfma_f32_16x16x32_bf16 v[104:107], a[192:195], a[136:139], v[104:107]
    ds_read_b64_tr_b16 a[212:213], v238 offset:512
    v_mfma_f32_16x16x32_bf16 v[108:111], a[192:195], a[140:143], v[108:111]
    ds_read_b64_tr_b16 a[214:215], v238 offset:1536
    v_mfma_f32_16x16x32_bf16 v[112:115], a[196:199], a[128:131], v[112:115]
    ds_read_b64_tr_b16 a[216:217], v246 offset:768
    v_mfma_f32_16x16x32_bf16 v[116:119], a[196:199], a[132:135], v[116:119]
    ds_read_b64_tr_b16 a[218:219], v246 offset:1792
    v_mfma_f32_16x16x32_bf16 v[120:123], a[196:199], a[136:139], v[120:123]
    ds_read_b64_tr_b16 a[220:221], v238 offset:768
    v_mfma_f32_16x16x32_bf16 v[124:127], a[196:199], a[140:143], v[124:127]
    ds_read_b64_tr_b16 a[222:223], v238 offset:1792
    v_mfma_f32_16x16x32_bf16 v[128:131], a[200:203], a[128:131], v[128:131]
    buffer_load_dwordx4 a[176:179], v248, s[8:11], s28 offen offset:3072 sc1
    s_cmp_eq_u32 s26, 1
    s_cselect_b32 s41, s35, s43
    buffer_load_dword v254, off, s[88:91], s41 sc1
    v_mfma_f32_16x16x32_bf16 v[132:135], a[200:203], a[132:135], v[132:135]
    v_mfma_f32_16x16x32_bf16 v[136:139], a[200:203], a[136:139], v[136:139]
    buffer_load_dwordx4 a[180:183], v248, s[8:11], s29 offen offset:3072 sc1
    v_mfma_f32_16x16x32_bf16 v[140:143], a[200:203], a[140:143], v[140:143]
    s_add_u32 m0, s31, 0
    s_add_u32 s24, s27, 0
    v_mfma_f32_16x16x32_bf16 v[144:147], a[204:207], a[128:131], v[144:147]
    buffer_load_dwordx4 v245, s[12:15], s24 offen lds
    v_mfma_f32_16x16x32_bf16 v[148:151], a[204:207], a[132:135], v[148:151]
    v_mfma_f32_16x16x32_bf16 v[152:155], a[204:207], a[136:139], v[152:155]
    v_mfma_f32_16x16x32_bf16 v[156:159], a[204:207], a[140:143], v[156:159]
    s_waitcnt lgkmcnt(0)
    v_mfma_f32_16x16x32_bf16 v[160:163], a[208:211], a[128:131], v[160:163]
    ds_read_b64_tr_b16 a[192:193], v246 offset:8192
    v_mfma_f32_16x16x32_bf16 v[164:167], a[208:211], a[132:135], v[164:167]
    ds_read_b64_tr_b16 a[194:195], v246 offset:9216
    v_mfma_f32_16x16x32_bf16 v[168:171], a[208:211], a[136:139], v[168:171]
    ds_read_b64_tr_b16 a[196:197], v238 offset:8192
    v_mfma_f32_16x16x32_bf16 v[172:175], a[208:211], a[140:143], v[172:175]
    ds_read_b64_tr_b16 a[198:199], v238 offset:9216
    v_mfma_f32_16x16x32_bf16 v[176:179], a[212:215], a[128:131], v[176:179]
    ds_read_b64_tr_b16 a[200:201], v246 offset:8448
    v_mfma_f32_16x16x32_bf16 v[180:183], a[212:215], a[132:135], v[180:183]
    ds_read_b64_tr_b16 a[202:203], v246 offset:9472
    v_mfma_f32_16x16x32_bf16 v[184:187], a[212:215], a[136:139], v[184:187]
    ds_read_b64_tr_b16 a[204:205], v238 offset:8448
    v_mfma_f32_16x16x32_bf16 v[188:191], a[212:215], a[140:143], v[188:191]
    ds_read_b64_tr_b16 a[206:207], v238 offset:9472
    v_mfma_f32_16x16x32_bf16 v[192:195], a[216:219], a[128:131], v[192:195]
    buffer_load_dwordx4 a[184:187], v249, s[8:11], s28 offen offset:3072 sc1
    v_mfma_f32_16x16x32_bf16 v[196:199], a[216:219], a[132:135], v[196:199]
    v_mfma_f32_16x16x32_bf16 v[200:203], a[216:219], a[136:139], v[200:203]
    buffer_load_dwordx4 a[188:191], v249, s[8:11], s29 offen offset:3072 sc1
    v_mfma_f32_16x16x32_bf16 v[204:207], a[216:219], a[140:143], v[204:207]
    s_add_u32 m0, s31, 1024
    s_add_u32 s24, s27, 32768
    v_mfma_f32_16x16x32_bf16 v[208:211], a[220:223], a[128:131], v[208:211]
    buffer_load_dwordx4 v245, s[12:15], s24 offen lds
    v_mfma_f32_16x16x32_bf16 v[212:215], a[220:223], a[132:135], v[212:215]
    v_mfma_f32_16x16x32_bf16 v[216:219], a[220:223], a[136:139], v[216:219]
    s_add_u32 s28, s28, 4096
    s_and_b32 s28, s28, 32767
    v_mfma_f32_16x16x32_bf16 v[220:223], a[220:223], a[140:143], v[220:223]
    s_add_u32 s29, s28, 32768
    s_waitcnt vmcnt(16) lgkmcnt(0)
    v_mfma_f32_16x16x32_bf16 v[96:99], a[192:195], a[144:147], v[96:99]
    ds_read_b64_tr_b16 a[208:209], v246 offset:8704
    v_mfma_f32_16x16x32_bf16 v[100:103], a[192:195], a[148:151], v[100:103]
    ds_read_b64_tr_b16 a[210:211], v246 offset:9728
    v_mfma_f32_16x16x32_bf16 v[104:107], a[192:195], a[152:155], v[104:107]
    ds_read_b64_tr_b16 a[212:213], v238 offset:8704
    v_mfma_f32_16x16x32_bf16 v[108:111], a[192:195], a[156:159], v[108:111]
    ds_read_b64_tr_b16 a[214:215], v238 offset:9728
    v_mfma_f32_16x16x32_bf16 v[112:115], a[196:199], a[144:147], v[112:115]
    ds_read_b64_tr_b16 a[216:217], v246 offset:8960
    v_mfma_f32_16x16x32_bf16 v[116:119], a[196:199], a[148:151], v[116:119]
    ds_read_b64_tr_b16 a[218:219], v246 offset:9984
    v_mfma_f32_16x16x32_bf16 v[120:123], a[196:199], a[152:155], v[120:123]
    ds_read_b64_tr_b16 a[220:221], v238 offset:8960
    v_mfma_f32_16x16x32_bf16 v[124:127], a[196:199], a[156:159], v[124:127]
    ds_read_b64_tr_b16 a[222:223], v238 offset:9984
    v_mfma_f32_16x16x32_bf16 v[128:131], a[200:203], a[144:147], v[128:131]
    buffer_load_dwordx4 a[128:131], v248, s[8:11], s28 offen offset:0 sc1
    v_mfma_f32_16x16x32_bf16 v[132:135], a[200:203], a[148:151], v[132:135]
    v_mfma_f32_16x16x32_bf16 v[136:139], a[200:203], a[152:155], v[136:139]
    buffer_load_dwordx4 a[132:135], v248, s[8:11], s29 offen offset:0 sc1
    v_mfma_f32_16x16x32_bf16 v[140:143], a[200:203], a[156:159], v[140:143]
    s_add_u32 m0, s31, 2048
    s_add_u32 s24, s27, 65536
    v_mfma_f32_16x16x32_bf16 v[144:147], a[204:207], a[144:147], v[144:147]
    buffer_load_dwordx4 v237, s[12:15], s24 offen lds
    v_mfma_f32_16x16x32_bf16 v[148:151], a[204:207], a[148:151], v[148:151]
    buffer_store_dwordx4 v[0:3], v240, s[48:51], s80 offen sc1
    s_add_u32 s80, s80, 1024
    v_mfma_f32_16x16x32_bf16 v[152:155], a[204:207], a[152:155], v[152:155]
    v_mfma_f32_16x16x32_bf16 v[156:159], a[204:207], a[156:159], v[156:159]
    s_waitcnt lgkmcnt(0)
    v_mfma_f32_16x16x32_bf16 v[160:163], a[208:211], a[144:147], v[160:163]
    ds_read_b64_tr_b16 a[192:193], v246 offset:16384
    v_mfma_f32_16x16x32_bf16 v[164:167], a[208:211], a[148:151], v[164:167]
    ds_read_b64_tr_b16 a[194:195], v246 offset:17408
    v_mfma_f32_16x16x32_bf16 v[168:171], a[208:211], a[152:155], v[168:171]
    ds_read_b64_tr_b16 a[196:197], v238 offset:16384
    v_mfma_f32_16x16x32_bf16 v[172:175], a[208:211], a[156:159], v[172:175]
    ds_read_b64_tr_b16 a[198:199], v238 offset:17408
    v_mfma_f32_16x16x32_bf16 v[176:179], a[212:215], a[144:147], v[176:179]
    ds_read_b64_tr_b16 a[200:201], v246 offset:16640
    v_mfma_f32_16x16x32_bf16 v[180:183], a[212:215], a[148:151], v[180:183]
    ds_read_b64_tr_b16 a[202:203], v246 offset:17664
    v_mfma_f32_16x16x32_bf16 v[184:187], a[212:215], a[152:155], v[184:187]
    ds_read_b64_tr_b16 a[204:205], v238 offset:16640
    v_mfma_f32_16x16x32_bf16 v[188:191], a[212:215], a[156:159], v[188:191]
    ds_read_b64_tr_b16 a[206:207], v238 offset:17664
    v_mfma_f32_16x16x32_bf16 v[192:195], a[216:219], a[144:147], v[192:195]
    buffer_load_dwordx4 a[136:139], v249, s[8:11], s28 offen offset:0 sc1
    v_mfma_f32_16x16x32_bf16 v[196:199], a[216:219], a[148:151], v[196:199]
    v_mfma_f32_16x16x32_bf16 v[200:203], a[216:219], a[152:155], v[200:203]
    buffer_load_dwordx4 a[140:143], v249, s[8:11], s29 offen offset:0 sc1
    v_mfma_f32_16x16x32_bf16 v[204:207], a[216:219], a[156:159], v[204:207]
    s_add_u32 m0, s31, 3072
    s_add_u32 s24, s27, 98304
    v_mfma_f32_16x16x32_bf16 v[208:211], a[220:223], a[144:147], v[208:211]
    buffer_load_dwordx4 v237, s[12:15], s24 offen lds
    v_mfma_f32_16x16x32_bf16 v[212:215], a[220:223], a[148:151], v[212:215]
    v_mfma_f32_16x16x32_bf16 v[216:219], a[220:223], a[152:155], v[216:219]
    v_mfma_f32_16x16x32_bf16 v[220:223], a[220:223], a[156:159], v[220:223]
    s_waitcnt vmcnt(15) lgkmcnt(0)
    v_mfma_f32_16x16x32_bf16 v[96:99], a[192:195], a[160:163], v[96:99]
    ds_read_b64_tr_b16 a[208:209], v246 offset:16896
    v_mfma_f32_16x16x32_bf16 v[100:103], a[192:195], a[164:167], v[100:103]
    ds_read_b64_tr_b16 a[210:211], v246 offset:17920
    v_mfma_f32_16x16x32_bf16 v[104:107], a[192:195], a[168:171], v[104:107]
    ds_read_b64_tr_b16 a[212:213], v238 offset:16896
    v_mfma_f32_16x16x32_bf16 v[108:111], a[192:195], a[172:175], v[108:111]
    ds_read_b64_tr_b16 a[214:215], v238 offset:17920
    v_mfma_f32_16x16x32_bf16 v[112:115], a[196:199], a[160:163], v[112:115]
    ds_read_b64_tr_b16 a[216:217], v246 offset:17152
    v_mfma_f32_16x16x32_bf16 v[116:119], a[196:199], a[164:167], v[116:119]
    ds_read_b64_tr_b16 a[218:219], v246 offset:18176
    v_mfma_f32_16x16x32_bf16 v[120:123], a[196:199], a[168:171], v[120:123]
    ds_read_b64_tr_b16 a[220:221], v238 offset:17152
    v_mfma_f32_16x16x32_bf16 v[124:127], a[196:199], a[172:175], v[124:127]
    ds_read_b64_tr_b16 a[222:223], v238 offset:18176
    v_mfma_f32_16x16x32_bf16 v[128:131], a[200:203], a[160:163], v[128:131]
    buffer_load_dwordx4 a[144:147], v248, s[8:11], s28 offen offset:1024 sc1
    v_mfma_f32_16x16x32_bf16 v[132:135], a[200:203], a[164:167], v[132:135]
    v_mfma_f32_16x16x32_bf16 v[136:139], a[200:203], a[168:171], v[136:139]
    buffer_load_dwordx4 a[148:151], v248, s[8:11], s29 offen offset:1024 sc1
    v_mfma_f32_16x16x32_bf16 v[140:143], a[200:203], a[172:175], v[140:143]
    s_add_u32 m0, s31, 4096
    s_add_u32 s24, s27, 131072
    v_mfma_f32_16x16x32_bf16 v[144:147], a[204:207], a[160:163], v[144:147]
    buffer_load_dwordx4 v245, s[12:15], s24 offen lds
    v_mfma_f32_16x16x32_bf16 v[148:151], a[204:207], a[164:167], v[148:151]
    v_mfma_f32_16x16x32_bf16 v[152:155], a[204:207], a[168:171], v[152:155]
    v_mfma_f32_16x16x32_bf16 v[156:159], a[204:207], a[172:175], v[156:159]
    s_waitcnt lgkmcnt(0)
    v_mfma_f32_16x16x32_bf16 v[160:163], a[208:211], a[160:163], v[160:163]
    ds_read_b64_tr_b16 a[192:193], v246 offset:24576
    v_mfma_f32_16x16x32_bf16 v[164:167], a[208:211], a[164:167], v[164:167]
    ds_read_b64_tr_b16 a[194:195], v246 offset:25600
    v_mfma_f32_16x16x32_bf16 v[168:171], a[208:211], a[168:171], v[168:171]
    ds_read_b64_tr_b16 a[196:197], v238 offset:24576
    v_mfma_f32_16x16x32_bf16 v[172:175], a[208:211], a[172:175], v[172:175]
    ds_read_b64_tr_b16 a[198:199], v238 offset:25600
    v_mfma_f32_16x16x32_bf16 v[176:179], a[212:215], a[160:163], v[176:179]
    ds_read_b64_tr_b16 a[200:201], v246 offset:24832
    v_mfma_f32_16x16x32_bf16 v[180:183], a[212:215], a[164:167], v[180:183]
    ds_read_b64_tr_b16 a[202:203], v246 offset:25856
    v_mfma_f32_16x16x32_bf16 v[184:187], a[212:215], a[168:171], v[184:187]
    ds_read_b64_tr_b16 a[204:205], v238 offset:24832
    v_mfma_f32_16x16x32_bf16 v[188:191], a[212:215], a[172:175], v[188:191]
    ds_read_b64_tr_b16 a[206:207], v238 offset:25856
    v_mfma_f32_16x16x32_bf16 v[192:195], a[216:219], a[160:163], v[192:195]
    buffer_load_dwordx4 a[152:155], v249, s[8:11], s28 offen offset:1024 sc1
    v_mfma_f32_16x16x32_bf16 v[196:199], a[216:219], a[164:167], v[196:199]
    v_mfma_f32_16x16x32_bf16 v[200:203], a[216:219], a[168:171], v[200:203]
    buffer_load_dwordx4 a[156:159], v249, s[8:11], s29 offen offset:1024 sc1
    v_mfma_f32_16x16x32_bf16 v[204:207], a[216:219], a[172:175], v[204:207]
    s_add_u32 m0, s31, 5120
    s_add_u32 s24, s27, 163840
    v_mfma_f32_16x16x32_bf16 v[208:211], a[220:223], a[160:163], v[208:211]
    buffer_load_dwordx4 v245, s[12:15], s24 offen lds
    v_mfma_f32_16x16x32_bf16 v[212:215], a[220:223], a[164:167], v[212:215]
    buffer_store_dwordx4 v[0:3], v240, s[48:51], s80 offen sc1
    s_add_u32 s80, s80, 1024
    v_mfma_f32_16x16x32_bf16 v[216:219], a[220:223], a[168:171], v[216:219]
    s_add_u32 s30, s30, 32768
    v_mfma_f32_16x16x32_bf16 v[220:223], a[220:223], a[172:175], v[220:223]
    s_cmp_ge_u32 s30, 163840
    s_cselect_b32 s30, 65536, s30
    s_waitcnt vmcnt(15) lgkmcnt(0)
    v_mfma_f32_16x16x32_bf16 v[96:99], a[192:195], a[176:179], v[96:99]
    ds_read_b64_tr_b16 a[208:209], v246 offset:25088
    v_mfma_f32_16x16x32_bf16 v[100:103], a[192:195], a[180:183], v[100:103]
    ds_read_b64_tr_b16 a[210:211], v246 offset:26112
    v_mfma_f32_16x16x32_bf16 v[104:107], a[192:195], a[184:187], v[104:107]
    ds_read_b64_tr_b16 a[212:213], v238 offset:25088
    v_mfma_f32_16x16x32_bf16 v[108:111], a[192:195], a[188:191], v[108:111]
    ds_read_b64_tr_b16 a[214:215], v238 offset:26112
    v_mfma_f32_16x16x32_bf16 v[112:115], a[196:199], a[176:179], v[112:115]
    ds_read_b64_tr_b16 a[216:217], v246 offset:25344
    v_mfma_f32_16x16x32_bf16 v[116:119], a[196:199], a[180:183], v[116:119]
    ds_read_b64_tr_b16 a[218:219], v246 offset:26368
    v_mfma_f32_16x16x32_bf16 v[120:123], a[196:199], a[184:187], v[120:123]
    ds_read_b64_tr_b16 a[220:221], v238 offset:25344
    v_mfma_f32_16x16x32_bf16 v[124:127], a[196:199], a[188:191], v[124:127]
    ds_read_b64_tr_b16 a[222:223], v238 offset:26368
    v_mfma_f32_16x16x32_bf16 v[128:131], a[200:203], a[176:179], v[128:131]
    buffer_load_dwordx4 a[160:163], v248, s[8:11], s28 offen offset:2048 sc1
    v_mfma_f32_16x16x32_bf16 v[132:135], a[200:203], a[180:183], v[132:135]
    v_mfma_f32_16x16x32_bf16 v[136:139], a[200:203], a[184:187], v[136:139]
    buffer_load_dwordx4 a[164:167], v248, s[8:11], s29 offen offset:2048 sc1
    v_mfma_f32_16x16x32_bf16 v[140:143], a[200:203], a[188:191], v[140:143]
    s_add_u32 m0, s31, 6144
    s_add_u32 s24, s27, 196608
    v_mfma_f32_16x16x32_bf16 v[144:147], a[204:207], a[176:179], v[144:147]
    buffer_load_dwordx4 v237, s[12:15], s24 offen lds
    v_mfma_f32_16x16x32_bf16 v[148:151], a[204:207], a[180:183], v[148:151]
    v_mfma_f32_16x16x32_bf16 v[152:155], a[204:207], a[184:187], v[152:155]
    s_cmp_eq_u32 s26, 1
    s_cbranch_scc0 ka_nopk
    s_waitcnt vmcnt(22)
    v_readfirstlane_b32 s24, v254
    s_lshl_b32 s25, s3, 16
    s_add_u32 s24, s24, s25
    s_cmp_ge_u32 s24, 8
    s_cbranch_scc0 kf_spin55
kf_spinr56:
ka_nopk:
    v_mfma_f32_16x16x32_bf16 v[156:159], a[204:207], a[188:191], v[156:159]
    s_waitcnt vmcnt(24) lgkmcnt(0)
    s_barrier
    v_add_u32 v246, s30, v247
    v_mfma_f32_16x16x32_bf16 v[160:163], a[208:211], a[176:179], v[160:163]
    v_xor_b32_e64 v238, 16, v246
    ds_read_b64_tr_b16 a[192:193], v246 offset:0
    v_mfma_f32_16x16x32_bf16 v[164:167], a[208:211], a[180:183], v[164:167]
    ds_read_b64_tr_b16 a[194:195], v246 offset:1024
    v_mfma_f32_16x16x32_bf16 v[168:171], a[208:211], a[184:187], v[168:171]
    ds_read_b64_tr_b16 a[196:197], v238 offset:0
    v_mfma_f32_16x16x32_bf16 v[172:175], a[208:211], a[188:191], v[172:175]
    ds_read_b64_tr_b16 a[198:199], v238 offset:1024
    v_mfma_f32_16x16x32_bf16 v[176:179], a[212:215], a[176:179], v[176:179]
    ds_read_b64_tr_b16 a[200:201], v246 offset:256
    v_mfma_f32_16x16x32_bf16 v[180:183], a[212:215], a[180:183], v[180:183]
    ds_read_b64_tr_b16 a[202:203], v246 offset:1280
    v_mfma_f32_16x16x32_bf16 v[184:187], a[212:215], a[184:187], v[184:187]
    ds_read_b64_tr_b16 a[204:205], v238 offset:256
    buffer_atomic_add v255, v250, s[88:91], s97 offen sc1
    s_mov_b32 s97, s43
    v_mfma_f32_16x16x32_bf16 v[188:191], a[212:215], a[188:191], v[188:191]
    ds_read_b64_tr_b16 a[206:207], v238 offset:1280
    v_mfma_f32_16x16x32_bf16 v[192:195], a[216:219], a[176:179], v[192:195]
    buffer_load_dwordx4 a[168:171], v249, s[8:11], s28 offen offset:2048 sc1
    v_mfma_f32_16x16x32_bf16 v[196:199], a[216:219], a[180:183], v[196:199]
    v_mfma_f32_16x16x32_bf16 v[200:203], a[216:219], a[184:187], v[200:203]
    buffer_load_dwordx4 a[172:175], v249, s[8:11], s29 offen offset:2048 sc1
    v_mfma_f32_16x16x32_bf16 v[204:207], a[216:219], a[188:191], v[204:207]
    s_add_u32 m0, s31, 7168
    s_add_u32 s24, s27, 229376
    v_mfma_f32_16x16x32_bf16 v[208:211], a[220:223], a[176:179], v[208:211]
    buffer_load_dwordx4 v237, s[12:15], s24 offen lds
    v_mfma_f32_16x16x32_bf16 v[212:215], a[220:223], a[180:183], v[212:215]
    s_add_u32 s27, s27, 1048576
    s_and_b32 s27, s27, 0x407fffff
    v_mfma_f32_16x16x32_bf16 v[216:219], a[220:223], a[184:187], v[216:219]
    s_cmp_eq_u32 s27, s7
    s_cselect_b32 s27, s43, s27
    v_mfma_f32_16x16x32_bf16 v[220:223], a[220:223], a[188:191], v[220:223]
    s_add_u32 s31, s31, 32768
    s_cmp_ge_u32 s31, 163840
    s_cselect_b32 s24, 98304, 0
    s_sub_u32 s31, s31, s24
    s_sub_u32 s26, s26, 1
    s_cmp_lg_u32 s26, 0
    s_cbranch_scc1 ka_qp
    s_waitcnt vmcnt(15) lgkmcnt(0)
    v_mfma_f32_16x16x32_bf16 v[96:99], a[192:195], a[128:131], v[96:99]
    ds_read_b64_tr_b16 a[208:209], v246 offset:512
    s_sub_u32 s42, s32, 17664
    v_mfma_f32_16x16x32_bf16 v[100:103], a[192:195], a[132:135], v[100:103]
    ds_read_b64_tr_b16 a[210:211], v246 offset:1536
    v_mfma_f32_16x16x32_bf16 v[104:107], a[192:195], a[136:139], v[104:107]
    ds_read_b64_tr_b16 a[212:213], v238 offset:512
    s_mov_b32 m0, s34
    s_add_u32 s41, s42, 17664
    v_mfma_f32_16x16x32_bf16 v[108:111], a[192:195], a[140:143], v[108:111]
    ds_read_b64_tr_b16 a[214:215], v238 offset:1536
    v_mfma_f32_16x16x32_bf16 v[112:115], a[196:199], a[128:131], v[112:115]
    ds_read_b64_tr_b16 a[216:217], v246 offset:768
    v_mfma_f32_16x16x32_bf16 v[116:119], a[196:199], a[132:135], v[116:119]
    ds_read_b64_tr_b16 a[218:219], v246 offset:1792
    buffer_load_dwordx4 v242, s[16:19], s41 offen offset:0 sc1 lds
    v_mfma_f32_16x16x32_bf16 v[120:123], a[196:199], a[136:139], v[120:123]
    ds_read_b64_tr_b16 a[220:221], v238 offset:768
    v_mfma_f32_16x16x32_bf16 v[124:127], a[196:199], a[140:143], v[124:127]
    ds_read_b64_tr_b16 a[222:223], v238 offset:1792
    v_mfma_f32_16x16x32_bf16 v[128:131], a[200:203], a[128:131], v[128:131]
    buffer_load_dwordx4 a[176:179], v248, s[8:11], s28 offen offset:3072 sc1
    buffer_load_dwordx4 v242, s[16:19], s41 offen offset:1024 sc1 lds
    v_mfma_f32_16x16x32_bf16 v[132:135], a[200:203], a[132:135], v[132:135]
    v_mfma_f32_16x16x32_bf16 v[136:139], a[200:203], a[136:139], v[136:139]
    buffer_load_dwordx4 a[180:183], v248, s[8:11], s29 offen offset:3072 sc1
    v_mfma_f32_16x16x32_bf16 v[140:143], a[200:203], a[140:143], v[140:143]
    buffer_load_dwordx4 v242, s[16:19], s41 offen offset:2048 sc1 lds
    v_mfma_f32_16x16x32_bf16 v[144:147], a[204:207], a[128:131], v[144:147]
    v_mfma_f32_16x16x32_bf16 v[148:151], a[204:207], a[132:135], v[148:151]
    v_mfma_f32_16x16x32_bf16 v[152:155], a[204:207], a[136:139], v[152:155]
    buffer_load_dwordx4 v242, s[16:19], s41 offen offset:3072 sc1 lds
    v_mfma_f32_16x16x32_bf16 v[156:159], a[204:207], a[140:143], v[156:159]
    s_waitcnt lgkmcnt(0)
    v_mfma_f32_16x16x32_bf16 v[160:163], a[208:211], a[128:131], v[160:163]
    ds_read_b64_tr_b16 a[192:193], v246 offset:8192
    v_mfma_f32_16x16x32_bf16 v[164:167], a[208:211], a[132:135], v[164:167]
    ds_read_b64_tr_b16 a[194:195], v246 offset:9216
    v_mfma_f32_16x16x32_bf16 v[168:171], a[208:211], a[136:139], v[168:171]
    ds_read_b64_tr_b16 a[196:197], v238 offset:8192
    s_add_u32 s34, s34, 32768
    s_cmp_ge_u32 s34, 163840
    s_cselect_b32 s34, s37, s34
    s_add_u32 s42, s42, 34048
    v_mfma_f32_16x16x32_bf16 v[172:175], a[208:211], a[140:143], v[172:175]
    ds_read_b64_tr_b16 a[198:199], v238 offset:9216
    v_mfma_f32_16x16x32_bf16 v[176:179], a[212:215], a[128:131], v[176:179]
    ds_read_b64_tr_b16 a[200:201], v246 offset:8448
    v_mfma_f32_16x16x32_bf16 v[180:183], a[212:215], a[132:135], v[180:183]
    ds_read_b64_tr_b16 a[202:203], v246 offset:9472
    s_mov_b32 m0, s34
    s_add_u32 s41, s42, 17664
    v_mfma_f32_16x16x32_bf16 v[184:187], a[212:215], a[136:139], v[184:187]
    ds_read_b64_tr_b16 a[204:205], v238 offset:8448
    v_mfma_f32_16x16x32_bf16 v[188:191], a[212:215], a[140:143], v[188:191]
    ds_read_b64_tr_b16 a[206:207], v238 offset:9472
    v_mfma_f32_16x16x32_bf16 v[192:195], a[216:219], a[128:131], v[192:195]
    buffer_load_dwordx4 a[184:187], v249, s[8:11], s28 offen offset:3072 sc1
    buffer_load_dwordx4 v242, s[16:19], s41 offen offset:0 sc1 lds
    v_mfma_f32_16x16x32_bf16 v[196:199], a[216:219], a[132:135], v[196:199]
    v_mfma_f32_16x16x32_bf16 v[200:203], a[216:219], a[136:139], v[200:203]
    buffer_load_dwordx4 a[188:191], v249, s[8:11], s29 offen offset:3072 sc1
    v_mfma_f32_16x16x32_bf16 v[204:207], a[216:219], a[140:143], v[204:207]
    buffer_load_dwordx4 v242, s[16:19], s41 offen offset:1024 sc1 lds
    v_mfma_f32_16x16x32_bf16 v[208:211], a[220:223], a[128:131], v[208:211]
    v_mfma_f32_16x16x32_bf16 v[212:215], a[220:223], a[132:135], v[212:215]
    v_mfma_f32_16x16x32_bf16 v[216:219], a[220:223], a[136:139], v[216:219]
    s_add_u32 s28, s28, 4096
    s_and_b32 s28, s28, 32767
    v_mfma_f32_16x16x32_bf16 v[220:223], a[220:223], a[140:143], v[220:223]
    s_add_u32 s29, s28, 32768
    buffer_load_dwordx4 v242, s[16:19], s41 offen offset:2048 sc1 lds
    s_waitcnt vmcnt(20) lgkmcnt(0)
    v_mfma_f32_16x16x32_bf16 v[96:99], a[192:195], a[144:147], v[96:99]
    ds_read_b64_tr_b16 a[208:209], v246 offset:8704
    s_load_dwordx2 s[80:81], s[0:1], 0
    s_load_dwordx2 s[82:83], s[0:1], 56
    s_load_dwordx4 s[84:87], s[0:1], 80
    v_mfma_f32_16x16x32_bf16 v[100:103], a[192:195], a[148:151], v[100:103]
    ds_read_b64_tr_b16 a[210:211], v246 offset:9728
    v_mfma_f32_16x16x32_bf16 v[104:107], a[192:195], a[152:155], v[104:107]
    ds_read_b64_tr_b16 a[212:213], v238 offset:8704
    buffer_load_dwordx4 v242, s[16:19], s41 offen offset:3072 sc1 lds
    v_mfma_f32_16x16x32_bf16 v[108:111], a[192:195], a[156:159], v[108:111]
    ds_read_b64_tr_b16 a[214:215], v238 offset:9728
    v_mfma_f32_16x16x32_bf16 v[112:115], a[196:199], a[144:147], v[112:115]
    ds_read_b64_tr_b16 a[216:217], v246 offset:8960
    v_mfma_f32_16x16x32_bf16 v[116:119], a[196:199], a[148:151], v[116:119]
    ds_read_b64_tr_b16 a[218:219], v246 offset:9984
    s_add_u32 m0, s34, 16384
    s_add_u32 s34, s34, 32768
    s_cmp_ge_u32 s34, 163840
    s_cselect_b32 s34, s37, s34
    v_mfma_f32_16x16x32_bf16 v[120:123], a[196:199], a[152:155], v[120:123]
    ds_read_b64_tr_b16 a[220:221], v238 offset:8960
    v_mfma_f32_16x16x32_bf16 v[124:127], a[196:199], a[156:159], v[124:127]
    ds_read_b64_tr_b16 a[222:223], v238 offset:9984
    v_mfma_f32_16x16x32_bf16 v[128:131], a[200:203], a[144:147], v[128:131]
    buffer_load_dwordx4 v242, s[16:19], s42 offen offset:0 sc1 lds
    v_mov_b32_e64 v241, v240
    v_mfma_f32_16x16x32_bf16 v[132:135], a[200:203], a[148:151], v[132:135]
    v_lshrrev_b32_e64 v230, 7, v240
    v_mfma_f32_16x16x32_bf16 v[136:139], a[200:203], a[152:155], v[136:139]
    v_mul_u32_u24 v253, 7168, v230
    v_mfma_f32_16x16x32_bf16 v[140:143], a[200:203], a[156:159], v[140:143]
    v_and_b32 v231, 0x70, v240
    v_mfma_f32_16x16x32_bf16 v[144:147], a[204:207], a[144:147], v[144:147]
    buffer_load_dwordx4 v242, s[16:19], s42 offen offset:1024 sc1 lds
    v_mfma_f32_16x16x32_bf16 v[148:151], a[204:207], a[148:151], v[148:151]
    v_add_u32_e64 v253, v253, v231
    v_mfma_f32_16x16x32_bf16 v[152:155], a[204:207], a[152:155], v[152:155]
    v_lshlrev_b32_e64 v255, 5, v230
    v_mfma_f32_16x16x32_bf16 v[156:159], a[204:207], a[156:159], v[156:159]
    buffer_load_dwordx4 v242, s[16:19], s42 offen offset:2048 sc1 lds
    s_waitcnt lgkmcnt(0)
    v_mfma_f32_16x16x32_bf16 v[160:163], a[208:211], a[144:147], v[160:163]
    ds_read_b64_tr_b16 a[192:193], v246 offset:16384
    v_and_b32 v230, 16, v240
    v_mfma_f32_16x16x32_bf16 v[164:167], a[208:211], a[148:151], v[164:167]
    ds_read_b64_tr_b16 a[194:195], v246 offset:17408
    v_mfma_f32_16x16x32_bf16 v[168:171], a[208:211], a[152:155], v[168:171]
    ds_read_b64_tr_b16 a[196:197], v238 offset:16384
    buffer_load_dwordx4 v242, s[16:19], s42 offen offset:3072 sc1 lds
    s_add_u32 s42, s42, 34048
    v_mfma_f32_16x16x32_bf16 v[172:175], a[208:211], a[156:159], v[172:175]
    ds_read_b64_tr_b16 a[198:199], v238 offset:17408
    v_add_u32_e64 v255, v255, v230
    v_mfma_f32_16x16x32_bf16 v[176:179], a[212:215], a[144:147], v[176:179]
    ds_read_b64_tr_b16 a[200:201], v246 offset:16640
    v_lshrrev_b32_e64 v231, 5, v231
    v_mfma_f32_16x16x32_bf16 v[180:183], a[212:215], a[148:151], v[180:183]
    ds_read_b64_tr_b16 a[202:203], v246 offset:17664
    s_mov_b32 m0, s34
    s_add_u32 s41, s42, 17664
    v_mfma_f32_16x16x32_bf16 v[184:187], a[212:215], a[152:155], v[184:187]
    ds_read_b64_tr_b16 a[204:205], v238 offset:16640
    v_mfma_f32_16x16x32_bf16 v[188:191], a[212:215], a[156:159], v[188:191]
    ds_read_b64_tr_b16 a[206:207], v238 offset:17664
    v_lshl_add_u32 v255, v231, 16, v255
    v_mfma_f32_16x16x32_bf16 v[192:195], a[216:219], a[144:147], v[192:195]
    buffer_load_dwordx4 v242, s[16:19], s41 offen offset:0 sc1 lds
    v_mfma_f32_16x16x32_bf16 v[196:199], a[216:219], a[148:151], v[196:199]
    v_mov_b32 v64, 0
    v_mfma_f32_16x16x32_bf16 v[200:203], a[216:219], a[152:155], v[200:203]
    v_mov_b32_e64 v65, 0
    v_mfma_f32_16x16x32_bf16 v[204:207], a[216:219], a[156:159], v[204:207]
    v_mov_b32_e64 v66, 0
    v_mfma_f32_16x16x32_bf16 v[208:211], a[220:223], a[144:147], v[208:211]
    buffer_load_dwordx4 v242, s[16:19], s41 offen offset:1024 sc1 lds
    v_mov_b32_e64 v67, 0
    v_mfma_f32_16x16x32_bf16 v[212:215], a[220:223], a[148:151], v[212:215]
    v_mov_b32_e64 v68, 0
    v_mfma_f32_16x16x32_bf16 v[216:219], a[220:223], a[152:155], v[216:219]
    v_mov_b32_e64 v69, 0
    v_mfma_f32_16x16x32_bf16 v[220:223], a[220:223], a[156:159], v[220:223]
    buffer_load_dwordx4 v242, s[16:19], s41 offen offset:2048 sc1 lds
    s_waitcnt vmcnt(20) lgkmcnt(0)
    v_mfma_f32_16x16x32_bf16 v[96:99], a[192:195], a[160:163], v[96:99]
    ds_read_b64_tr_b16 a[208:209], v246 offset:16896
    v_mov_b32 v70, 0
    v_mfma_f32_16x16x32_bf16 v[100:103], a[192:195], a[164:167], v[100:103]
    ds_read_b64_tr_b16 a[210:211], v246 offset:17920
    v_mfma_f32_16x16x32_bf16 v[104:107], a[192:195], a[168:171], v[104:107]
    ds_read_b64_tr_b16 a[212:213], v238 offset:16896
    buffer_load_dwordx4 v242, s[16:19], s41 offen offset:3072 sc1 lds
    v_mfma_f32_16x16x32_bf16 v[108:111], a[192:195], a[172:175], v[108:111]
    ds_read_b64_tr_b16 a[214:215], v238 offset:17920
    v_mov_b32_e64 v71, 0
    v_mfma_f32_16x16x32_bf16 v[112:115], a[196:199], a[160:163], v[112:115]
    ds_read_b64_tr_b16 a[216:217], v246 offset:17152
    v_mfma_f32_16x16x32_bf16 v[116:119], a[196:199], a[164:167], v[116:119]
    ds_read_b64_tr_b16 a[218:219], v246 offset:18176
    s_add_u32 m0, s34, 16384
    s_add_u32 s34, s34, 32768
    s_cmp_ge_u32 s34, 163840
    s_cselect_b32 s34, s37, s34
    v_mfma_f32_16x16x32_bf16 v[120:123], a[196:199], a[168:171], v[120:123]
    ds_read_b64_tr_b16 a[220:221], v238 offset:17152
    v_mov_b32 v72, 0
    v_mfma_f32_16x16x32_bf16 v[124:127], a[196:199], a[172:175], v[124:127]
    ds_read_b64_tr_b16 a[222:223], v238 offset:18176
    v_mfma_f32_16x16x32_bf16 v[128:131], a[200:203], a[160:163], v[128:131]
    v_mov_b32_e64 v73, 0
    v_mfma_f32_16x16x32_bf16 v[132:135], a[200:203], a[164:167], v[132:135]
    buffer_load_dwordx4 v242, s[16:19], s42 offen offset:0 sc1 lds
    v_mov_b32_e64 v74, 0
    v_mfma_f32_16x16x32_bf16 v[136:139], a[200:203], a[168:171], v[136:139]
    v_mov_b32_e64 v75, 0
    v_mfma_f32_16x16x32_bf16 v[140:143], a[200:203], a[172:175], v[140:143]
    v_mov_b32_e64 v76, 0
    v_mfma_f32_16x16x32_bf16 v[144:147], a[204:207], a[160:163], v[144:147]
    buffer_load_dwordx4 v242, s[16:19], s42 offen offset:1024 sc1 lds
    v_mov_b32_e64 v77, 0
    v_mfma_f32_16x16x32_bf16 v[148:151], a[204:207], a[164:167], v[148:151]
    v_mov_b32_e64 v78, 0
    v_mfma_f32_16x16x32_bf16 v[152:155], a[204:207], a[168:171], v[152:155]
    v_mov_b32_e64 v79, 0
    v_mfma_f32_16x16x32_bf16 v[156:159], a[204:207], a[172:175], v[156:159]
    buffer_load_dwordx4 v242, s[16:19], s42 offen offset:2048 sc1 lds
    s_waitcnt lgkmcnt(0)
    v_mfma_f32_16x16x32_bf16 v[160:163], a[208:211], a[160:163], v[160:163]
    ds_read_b64_tr_b16 a[192:193], v246 offset:24576
    v_mfma_f32_16x16x32_bf16 v[164:167], a[208:211], a[164:167], v[164:167]
    ds_read_b64_tr_b16 a[194:195], v246 offset:25600
    v_mov_b32 v80, 0
    v_mfma_f32_16x16x32_bf16 v[168:171], a[208:211], a[168:171], v[168:171]
    ds_read_b64_tr_b16 a[196:197], v238 offset:24576
    buffer_load_dwordx4 v242, s[16:19], s42 offen offset:3072 sc1 lds
    s_add_u32 s42, s42, 34048
    v_mfma_f32_16x16x32_bf16 v[172:175], a[208:211], a[172:175], v[172:175]
    ds_read_b64_tr_b16 a[198:199], v238 offset:25600
    v_mfma_f32_16x16x32_bf16 v[176:179], a[212:215], a[160:163], v[176:179]
    ds_read_b64_tr_b16 a[200:201], v246 offset:24832
    v_mov_b32_e64 v81, 0
    v_mfma_f32_16x16x32_bf16 v[180:183], a[212:215], a[164:167], v[180:183]
    ds_read_b64_tr_b16 a[202:203], v246 offset:25856
    v_mfma_f32_16x16x32_bf16 v[184:187], a[212:215], a[168:171], v[184:187]
    ds_read_b64_tr_b16 a[204:205], v238 offset:24832
    v_mov_b32_e64 v82, 0
    v_mfma_f32_16x16x32_bf16 v[188:191], a[212:215], a[172:175], v[188:191]
    ds_read_b64_tr_b16 a[206:207], v238 offset:25856
    v_mfma_f32_16x16x32_bf16 v[192:195], a[216:219], a[160:163], v[192:195]
    v_mov_b32_e64 v83, 0
    v_mfma_f32_16x16x32_bf16 v[196:199], a[216:219], a[164:167], v[196:199]
    v_mov_b32 v84, 0
    v_mov_b32 v85, 0
    v_mfma_f32_16x16x32_bf16 v[200:203], a[216:219], a[168:171], v[200:203]
    v_mov_b32_e64 v86, 0
    v_mfma_f32_16x16x32_bf16 v[204:207], a[216:219], a[172:175], v[204:207]
    v_mov_b32_e64 v87, 0
    v_mfma_f32_16x16x32_bf16 v[208:211], a[220:223], a[160:163], v[208:211]
    v_mov_b32_e64 v88, 0
    v_mfma_f32_16x16x32_bf16 v[212:215], a[220:223], a[164:167], v[212:215]
    v_mov_b32_e64 v89, 0
    v_mfma_f32_16x16x32_bf16 v[216:219], a[220:223], a[168:171], v[216:219]
    v_mov_b32_e64 v90, 0
    v_mfma_f32_16x16x32_bf16 v[220:223], a[220:223], a[172:175], v[220:223]
    s_waitcnt vmcnt(15) lgkmcnt(0)
    v_mfma_f32_16x16x32_bf16 v[96:99], a[192:195], a[176:179], v[96:99]
    ds_read_b64_tr_b16 a[208:209], v246 offset:25088
    v_mov_b32 v91, 0
    v_mfma_f32_16x16x32_bf16 v[100:103], a[192:195], a[180:183], v[100:103]
    ds_read_b64_tr_b16 a[210:211], v246 offset:26112
    v_mov_b32_e64 v92, 0
    v_mfma_f32_16x16x32_bf16 v[104:107], a[192:195], a[184:187], v[104:107]
    ds_read_b64_tr_b16 a[212:213], v238 offset:25088
    v_mfma_f32_16x16x32_bf16 v[108:111], a[192:195], a[188:191], v[108:111]
    ds_read_b64_tr_b16 a[214:215], v238 offset:26112
    v_mov_b32_e64 v93, 0
    v_mfma_f32_16x16x32_bf16 v[112:115], a[196:199], a[176:179], v[112:115]
    ds_read_b64_tr_b16 a[216:217], v246 offset:25344
    v_mfma_f32_16x16x32_bf16 v[116:119], a[196:199], a[180:183], v[116:119]
    ds_read_b64_tr_b16 a[218:219], v246 offset:26368
    v_mov_b32_e64 v94, 0
    v_mfma_f32_16x16x32_bf16 v[120:123], a[196:199], a[184:187], v[120:123]
    ds_read_b64_tr_b16 a[220:221], v238 offset:25344
    v_mfma_f32_16x16x32_bf16 v[124:127], a[196:199], a[188:191], v[124:127]
    ds_read_b64_tr_b16 a[222:223], v238 offset:26368
    v_mov_b32_e64 v95, 0
    v_mfma_f32_16x16x32_bf16 v[128:131], a[200:203], a[176:179], v[128:131]
    v_mov_b32_e64 v224, 0
    v_mfma_f32_16x16x32_bf16 v[132:135], a[200:203], a[180:183], v[132:135]
    s_and_b32 s28, s3, 1
    s_lshl1_add_u32 s28, s2, s28
    v_mfma_f32_16x16x32_bf16 v[136:139], a[200:203], a[184:187], v[136:139]
    s_sub_u32 s28, s28, 0
    v_lshlrev_b32 v4, 3, v240
    v_mfma_f32_16x16x32_bf16 v[140:143], a[200:203], a[188:191], v[140:143]
    v_min_u32 v4, 7040, v4
    s_mul_i32 s28, s28, 14336
    v_mfma_f32_16x16x32_bf16 v[144:147], a[204:207], a[176:179], v[144:147]
    v_mov_b32_e64 v225, 0
    v_mfma_f32_16x16x32_bf16 v[148:151], a[204:207], a[180:183], v[148:151]
    v_mov_b32_e64 v226, 0
    v_mfma_f32_16x16x32_bf16 v[152:155], a[204:207], a[184:187], v[152:155]
    v_mov_b32_e64 v227, 0
    v_mfma_f32_16x16x32_bf16 v[156:159], a[204:207], a[188:191], v[156:159]
    s_waitcnt vmcnt(8) lgkmcnt(0)
    s_barrier
    v_mfma_f32_16x16x32_bf16 v[160:163], a[208:211], a[176:179], v[160:163]
    ds_read_b128 a[192:195], v241 offset:0
    s_mov_b32 m0, s34
    s_add_u32 s41, s42, 17664
    v_mfma_f32_16x16x32_bf16 v[164:167], a[208:211], a[180:183], v[164:167]
    ds_read_b128 a[196:199], v241 offset:2048
    buffer_load_dwordx4 v242, s[16:19], s41 offen offset:0 sc1 lds
    v_mfma_f32_16x16x32_bf16 v[168:171], a[208:211], a[184:187], v[168:171]
    ds_read_b128 a[200:203], v241 offset:4096
    v_mfma_f32_16x16x32_bf16 v[172:175], a[208:211], a[188:191], v[172:175]
    ds_read_b128 a[204:207], v241 offset:6144
    buffer_load_dwordx4 v242, s[16:19], s41 offen offset:1024 sc1 lds
    v_mfma_f32_16x16x32_bf16 v[176:179], a[212:215], a[176:179], v[176:179]
    ds_read_b128 a[224:227], v241 offset:8192
    buffer_load_dwordx4 v242, s[16:19], s41 offen offset:2048 sc1 lds
    v_mfma_f32_16x16x32_bf16 v[180:183], a[212:215], a[180:183], v[180:183]
    ds_read_b128 a[228:231], v241 offset:10240
    v_mfma_f32_16x16x32_bf16 v[184:187], a[212:215], a[184:187], v[184:187]
    ds_read_b128 a[232:235], v241 offset:12288
    buffer_load_dwordx4 v242, s[16:19], s41 offen offset:3072 sc1 lds
    v_mfma_f32_16x16x32_bf16 v[188:191], a[212:215], a[188:191], v[188:191]
    ds_read_b128 a[236:239], v241 offset:14336
    v_mfma_f32_16x16x32_bf16 v[192:195], a[216:219], a[176:179], v[192:195]
    ds_read_b128 a[240:243], v241 offset:9216
    s_add_u32 m0, s34, 16384
    s_add_u32 s34, s34, 32768
    s_cmp_ge_u32 s34, 163840
    s_cselect_b32 s34, s37, s34
    v_mfma_f32_16x16x32_bf16 v[196:199], a[216:219], a[180:183], v[196:199]
    ds_read_b128 a[244:247], v241 offset:11264
    buffer_load_dwordx4 v242, s[16:19], s42 offen offset:0 sc1 lds
    v_mfma_f32_16x16x32_bf16 v[200:203], a[216:219], a[184:187], v[200:203]
    ds_read_b128 a[248:251], v241 offset:13312
    v_mfma_f32_16x16x32_bf16 v[204:207], a[216:219], a[188:191], v[204:207]
    ds_read_b128 a[252:255], v241 offset:15360
    buffer_load_dwordx4 v242, s[16:19], s42 offen offset:1024 sc1 lds
    v_mfma_f32_16x16x32_bf16 v[208:211], a[220:223], a[176:179], v[208:211]
    buffer_load_dwordx4 v242, s[16:19], s42 offen offset:2048 sc1 lds
    v_mfma_f32_16x16x32_bf16 v[212:215], a[220:223], a[180:183], v[212:215]
    v_mfma_f32_16x16x32_bf16 v[216:219], a[220:223], a[184:187], v[216:219]
    buffer_load_dwordx4 v242, s[16:19], s42 offen offset:3072 sc1 lds
    s_add_u32 s42, s42, 34048
    v_mfma_f32_16x16x32_bf16 v[220:223], a[220:223], a[188:191], v[220:223]
    s_cmp_lt_u32 s2, 0
    s_cbranch_scc1 ka_nogu
    buffer_load_dword v252, v4, s[52:55], s28 offen
    s_add_u32 s28, s28, 7168
    buffer_load_dword v252, v4, s[52:55], s28 offen
    s_add_u32 s28, s28, 7168
ka_nogu:
    s_waitcnt lgkmcnt(8)
    ds_read_b128 a[208:211], v241 offset:1024
    ds_read_b128 a[212:215], v241 offset:3072
    ds_read_b128 a[216:219], v241 offset:5120
    ds_read_b128 a[220:223], v241 offset:7168
    s_sub_u32 s36, s36, 1
    s_cbranch_scc1 kf_fix1
kf_fixr2:
    v_cvt_pk_bf16_f32 v96, v96, v97
    v_cvt_pk_bf16_f32 v97, v98, v99
    v_cvt_pk_bf16_f32 v98, v112, v113
    v_cvt_pk_bf16_f32 v99, v114, v115
    v_accvgpr_write_b32 a128, v96
    v_accvgpr_write_b32 a129, v97
    v_accvgpr_write_b32 a130, v98
    v_accvgpr_write_b32 a131, v99
    v_cvt_pk_bf16_f32 v100, v100, v101
    v_cvt_pk_bf16_f32 v101, v102, v103
    v_cvt_pk_bf16_f32 v102, v116, v117
    v_cvt_pk_bf16_f32 v103, v118, v119
    v_accvgpr_write_b32 a144, v100
    v_accvgpr_write_b32 a145, v101
    v_accvgpr_write_b32 a146, v102
    v_accvgpr_write_b32 a147, v103
    v_cvt_pk_bf16_f32 v104, v104, v105
    v_cvt_pk_bf16_f32 v105, v106, v107
    v_cvt_pk_bf16_f32 v106, v120, v121
    v_cvt_pk_bf16_f32 v107, v122, v123
    v_accvgpr_write_b32 a160, v104
    v_accvgpr_write_b32 a161, v105
    v_accvgpr_write_b32 a162, v106
    v_accvgpr_write_b32 a163, v107
    v_cvt_pk_bf16_f32 v108, v108, v109
    v_cvt_pk_bf16_f32 v109, v110, v111
    v_cvt_pk_bf16_f32 v110, v124, v125
    v_cvt_pk_bf16_f32 v111, v126, v127
    v_accvgpr_write_b32 a176, v108
    v_accvgpr_write_b32 a177, v109
    v_accvgpr_write_b32 a178, v110
    v_accvgpr_write_b32 a179, v111
    s_nop 1
    s_waitcnt lgkmcnt(0)
    v_mfma_f32_16x16x32_bf16 v[0:3], a[192:195], a[128:131], v[64:67]
    v_cvt_pk_bf16_f32 v128, v128, v129
    v_cvt_pk_bf16_f32 v129, v130, v131
    v_cvt_pk_bf16_f32 v130, v144, v145
    v_cvt_pk_bf16_f32 v131, v146, v147
    v_mfma_f32_16x16x32_bf16 v[8:11], a[192:195], a[144:147], v[72:75]
    v_accvgpr_write_b32 a132, v128
    v_accvgpr_write_b32 a133, v129
    v_accvgpr_write_b32 a134, v130
    v_accvgpr_write_b32 a135, v131
    v_mfma_f32_16x16x32_bf16 v[16:19], a[192:195], a[160:163], v[80:83]
    v_cvt_pk_bf16_f32 v132, v132, v133
    v_cvt_pk_bf16_f32 v133, v134, v135
    v_cvt_pk_bf16_f32 v134, v148, v149
    v_cvt_pk_bf16_f32 v135, v150, v151
    v_mfma_f32_16x16x32_bf16 v[24:27], a[192:195], a[176:179], v[88:91]
    v_accvgpr_write_b32 a148, v132
    v_accvgpr_write_b32 a149, v133
    v_accvgpr_write_b32 a150, v134
    v_accvgpr_write_b32 a151, v135
    v_mfma_f32_16x16x32_bf16 v[4:7], a[208:211], a[128:131], v[68:71]
    v_cvt_pk_bf16_f32 v136, v136, v137
    v_cvt_pk_bf16_f32 v137, v138, v139
    v_cvt_pk_bf16_f32 v138, v152, v153
    v_cvt_pk_bf16_f32 v139, v154, v155
    v_mfma_f32_16x16x32_bf16 v[12:15], a[208:211], a[144:147], v[76:79]
    v_accvgpr_write_b32 a164, v136
    v_accvgpr_write_b32 a165, v137
    v_accvgpr_write_b32 a166, v138
    v_accvgpr_write_b32 a167, v139
    v_mfma_f32_16x16x32_bf16 v[20:23], a[208:211], a[160:163], v[84:87]
    v_cvt_pk_bf16_f32 v140, v140, v141
    v_cvt_pk_bf16_f32 v141, v142, v143
    v_cvt_pk_bf16_f32 v142, v156, v157
    v_cvt_pk_bf16_f32 v143, v158, v159
    v_mfma_f32_16x16x32_bf16 v[28:31], a[208:211], a[176:179], v[92:95]
    v_accvgpr_write_b32 a180, v140
    v_accvgpr_write_b32 a181, v141
    v_accvgpr_write_b32 a182, v142
    v_accvgpr_write_b32 a183, v143
    s_nop 1
    v_mfma_f32_16x16x32_bf16 v[0:3], a[196:199], a[132:135], v[0:3]
    v_cvt_pk_bf16_f32 v160, v160, v161
    v_cvt_pk_bf16_f32 v161, v162, v163
    v_cvt_pk_bf16_f32 v162, v176, v177
    v_cvt_pk_bf16_f32 v163, v178, v179
    v_mfma_f32_16x16x32_bf16 v[8:11], a[196:199], a[148:151], v[8:11]
    v_accvgpr_write_b32 a136, v160
    v_accvgpr_write_b32 a137, v161
    v_accvgpr_write_b32 a138, v162
    v_accvgpr_write_b32 a139, v163
    v_mfma_f32_16x16x32_bf16 v[16:19], a[196:199], a[164:167], v[16:19]
    v_cvt_pk_bf16_f32 v164, v164, v165
    v_cvt_pk_bf16_f32 v165, v166, v167
    v_cvt_pk_bf16_f32 v166, v180, v181
    v_cvt_pk_bf16_f32 v167, v182, v183
    v_mfma_f32_16x16x32_bf16 v[24:27], a[196:199], a[180:183], v[24:27]
    v_accvgpr_write_b32 a152, v164
    v_accvgpr_write_b32 a153, v165
    v_accvgpr_write_b32 a154, v166
    v_accvgpr_write_b32 a155, v167
    v_mfma_f32_16x16x32_bf16 v[4:7], a[212:215], a[132:135], v[4:7]
    v_cvt_pk_bf16_f32 v168, v168, v169
    v_cvt_pk_bf16_f32 v169, v170, v171
    v_cvt_pk_bf16_f32 v170, v184, v185
    v_cvt_pk_bf16_f32 v171, v186, v187
    v_mfma_f32_16x16x32_bf16 v[12:15], a[212:215], a[148:151], v[12:15]
    v_accvgpr_write_b32 a168, v168
    v_accvgpr_write_b32 a169, v169
    v_accvgpr_write_b32 a170, v170
    v_accvgpr_write_b32 a171, v171
    v_mfma_f32_16x16x32_bf16 v[20:23], a[212:215], a[164:167], v[20:23]
    v_cvt_pk_bf16_f32 v172, v172, v173
    v_cvt_pk_bf16_f32 v173, v174, v175
    v_cvt_pk_bf16_f32 v174, v188, v189
    v_cvt_pk_bf16_f32 v175, v190, v191
    v_mfma_f32_16x16x32_bf16 v[28:31], a[212:215], a[180:183], v[28:31]
    v_accvgpr_write_b32 a184, v172
    v_accvgpr_write_b32 a185, v173
    v_accvgpr_write_b32 a186, v174
    v_accvgpr_write_b32 a187, v175
    s_nop 1
    s_waitcnt lgkmcnt(0)
    v_mfma_f32_16x16x32_bf16 v[0:3], a[200:203], a[136:139], v[0:3]
    v_cvt_pk_bf16_f32 v192, v192, v193
    v_cvt_pk_bf16_f32 v193, v194, v195
    v_cvt_pk_bf16_f32 v194, v208, v209
    v_cvt_pk_bf16_f32 v195, v210, v211
    v_mfma_f32_16x16x32_bf16 v[8:11], a[200:203], a[152:155], v[8:11]
    v_accvgpr_write_b32 a140, v192
    v_accvgpr_write_b32 a141, v193
    v_accvgpr_write_b32 a142, v194
    v_accvgpr_write_b32 a143, v195
    v_mfma_f32_16x16x32_bf16 v[16:19], a[200:203], a[168:171], v[16:19]
    v_cvt_pk_bf16_f32 v196, v196, v197
    v_cvt_pk_bf16_f32 v197, v198, v199
    v_cvt_pk_bf16_f32 v198, v212, v213
    v_cvt_pk_bf16_f32 v199, v214, v215
    v_mfma_f32_16x16x32_bf16 v[24:27], a[200:203], a[184:187], v[24:27]
    v_accvgpr_write_b32 a156, v196
    v_accvgpr_write_b32 a157, v197
    v_accvgpr_write_b32 a158, v198
    v_accvgpr_write_b32 a159, v199
    v_mfma_f32_16x16x32_bf16 v[4:7], a[216:219], a[136:139], v[4:7]
    v_cvt_pk_bf16_f32 v200, v200, v201
    v_cvt_pk_bf16_f32 v201, v202, v203
    v_cvt_pk_bf16_f32 v202, v216, v217
    v_cvt_pk_bf16_f32 v203, v218, v219
    v_mfma_f32_16x16x32_bf16 v[12:15], a[216:219], a[152:155], v[12:15]
    v_accvgpr_write_b32 a172, v200
    v_accvgpr_write_b32 a173, v201
    v_accvgpr_write_b32 a174, v202
    v_accvgpr_write_b32 a175, v203
    v_mfma_f32_16x16x32_bf16 v[20:23], a[216:219], a[168:171], v[20:23]
    v_cvt_pk_bf16_f32 v204, v204, v205
    v_cvt_pk_bf16_f32 v205, v206, v207
    v_cvt_pk_bf16_f32 v206, v220, v221
    v_cvt_pk_bf16_f32 v207, v222, v223
    v_mfma_f32_16x16x32_bf16 v[28:31], a[216:219], a[184:187], v[28:31]
    v_accvgpr_write_b32 a188, v204
    v_accvgpr_write_b32 a189, v205
    v_accvgpr_write_b32 a190, v206
    v_accvgpr_write_b32 a191, v207
    s_nop 1
    v_mfma_f32_16x16x32_bf16 v[0:3], a[204:207], a[140:143], v[0:3]
    v_mov_b32 v144, 0
    v_mov_b32 v145, 0
    v_mov_b32 v146, 0
    v_mfma_f32_16x16x32_bf16 v[8:11], a[204:207], a[156:159], v[8:11]
    v_mov_b32 v147, 0
    v_mov_b32 v148, 0
    v_mfma_f32_16x16x32_bf16 v[16:19], a[204:207], a[172:175], v[16:19]
    v_mov_b32 v149, 0
    v_mov_b32 v150, 0
    v_mov_b32_e64 v151, 0
    v_mfma_f32_16x16x32_bf16 v[24:27], a[204:207], a[188:191], v[24:27]
    v_mov_b32 v152, 0
    v_mov_b32 v153, 0
    v_mfma_f32_16x16x32_bf16 v[4:7], a[220:223], a[140:143], v[4:7]
    v_mov_b32 v154, 0
    v_mov_b32 v155, 0
    v_mov_b32_e64 v156, 0
    v_mfma_f32_16x16x32_bf16 v[12:15], a[220:223], a[156:159], v[12:15]
    v_mov_b32 v157, 0
    v_mov_b32 v158, 0
    v_mfma_f32_16x16x32_bf16 v[20:23], a[220:223], a[172:175], v[20:23]
    v_mov_b32_e64 v159, 0
    v_mov_b32 v204, 0x3f803f80
    v_mov_b32 v205, 0x3f803f80
    v_mfma_f32_16x16x32_bf16 v[28:31], a[220:223], a[188:191], v[28:31]
    v_mov_b32 v206, 0x3f803f80
    v_mov_b32 v207, 0x3f803f80
    s_nop 4
    v_max3_f32 v128, v0, v1, v2
    v_max3_f32 v130, v8, v9, v10
    v_max3_f32 v132, v16, v17, v18
    v_max3_f32 v134, v24, v25, v26
    v_max3_f32 v128, v128, v3, v4
    v_max3_f32 v130, v130, v11, v12
    v_max3_f32 v132, v132, v19, v20
    v_max3_f32 v134, v134, v27, v28
    v_max3_f32 v128, v128, v5, v6
    v_max3_f32 v130, v130, v13, v14
    v_max3_f32 v132, v132, v21, v22
    v_max3_f32 v134, v134, v29, v30
    v_max_f32 v128, v128, v7
    v_max_f32 v130, v130, v15
    v_max_f32 v132, v132, v23
    v_max_f32 v134, v134, v31
    v_mov_b32 v129, v128
    v_mov_b32 v131, v130
    v_mov_b32 v133, v132
    v_mov_b32 v135, v134
    v_permlane16_swap_b32 v128, v129
    v_permlane16_swap_b32 v130, v131
    v_permlane16_swap_b32 v132, v133
    v_permlane16_swap_b32 v134, v135
    v_max_f32 v128, v128, v129
    v_max_f32 v130, v130, v131
    v_max_f32 v132, v132, v133
    v_max_f32 v134, v134, v135
    v_mov_b32 v129, v128
    v_mov_b32 v131, v130
    v_mov_b32 v133, v132
    v_mov_b32 v135, v134
    v_permlane32_swap_b32 v128, v129
    v_permlane32_swap_b32 v130, v131
    v_permlane32_swap_b32 v132, v133
    v_permlane32_swap_b32 v134, v135
    v_max_f32 v128, v128, v129
    v_max_f32 v130, v130, v131
    v_max_f32 v132, v132, v133
    v_max_f32_e64 v134, v134, v135
    v_add_f32 v128, 0x41800000, v128
    v_add_f32 v130, 0x41800000, v130
    v_add_f32 v132, 0x41800000, v132
    v_add_f32 v134, 0x41800000, v134
    v_sub_f32 v224, 0, v128
    v_sub_f32 v64, v64, v128
    v_sub_f32 v65, v65, v128
    v_sub_f32 v66, v66, v128
    v_sub_f32 v67, v67, v128
    v_sub_f32 v68, v68, v128
    v_sub_f32 v69, v69, v128
    v_sub_f32 v70, v70, v128
    v_sub_f32 v71, v71, v128
    v_sub_f32 v225, 0, v130
    v_sub_f32 v72, v72, v130
    v_sub_f32 v73, v73, v130
    v_sub_f32 v74, v74, v130
    v_sub_f32 v75, v75, v130
    v_sub_f32 v76, v76, v130
    v_sub_f32 v77, v77, v130
    v_sub_f32 v78, v78, v130
    v_sub_f32 v79, v79, v130
    v_sub_f32 v226, 0, v132
    v_sub_f32 v80, v80, v132
    v_sub_f32 v81, v81, v132
    v_sub_f32 v82, v82, v132
    v_sub_f32 v83, v83, v132
    v_sub_f32 v84, v84, v132
    v_sub_f32 v85, v85, v132
    v_sub_f32 v86, v86, v132
    v_sub_f32 v87, v87, v132
    v_sub_f32 v227, 0, v134
    v_sub_f32 v88, v88, v134
    v_sub_f32 v89, v89, v134
    v_sub_f32 v90, v90, v134
    v_sub_f32 v91, v91, v134
    v_sub_f32 v92, v92, v134
    v_sub_f32 v93, v93, v134
    v_sub_f32 v94, v94, v134
    v_sub_f32 v95, v95, v134
    v_sub_f32 v0, v0, v128
    v_sub_f32 v1, v1, v128
    v_sub_f32 v2, v2, v128
    v_sub_f32 v3, v3, v128
    v_sub_f32 v4, v4, v128
    v_sub_f32 v5, v5, v128
    v_sub_f32 v6, v6, v128
    v_sub_f32 v7, v7, v128
    v_sub_f32 v8, v8, v130
    v_sub_f32 v9, v9, v130
    v_sub_f32 v10, v10, v130
    v_sub_f32 v11, v11, v130
    v_sub_f32 v12, v12, v130
    v_sub_f32 v13, v13, v130
    v_sub_f32 v14, v14, v130
    v_sub_f32 v15, v15, v130
    v_sub_f32 v16, v16, v132
    v_sub_f32 v17, v17, v132
    v_sub_f32 v18, v18, v132
    v_sub_f32 v19, v19, v132
    v_sub_f32 v20, v20, v132
    v_sub_f32 v21, v21, v132
    v_sub_f32 v22, v22, v132
    v_sub_f32 v23, v23, v132
    v_sub_f32 v24, v24, v134
    v_sub_f32 v25, v25, v134
    v_sub_f32 v26, v26, v134
    v_sub_f32 v27, v27, v134
    v_sub_f32 v28, v28, v134
    v_sub_f32 v29, v29, v134
    v_sub_f32 v30, v30, v134
    v_sub_f32 v31, v31, v134
    s_mov_b32 s35, 32768
    v_add_u32_e64 v241, s35, v240
    s_sub_u32 s36, s36, 1
    s_cbranch_scc1 kf_fix3
kf_fixr4:
    v_mfma_f32_16x16x32_bf16 v[32:35], a[224:227], a[128:131], v[64:67]
    ds_read_b128 a[192:195], v241 offset:0
    v_exp_f32_e64 v128, v0
    v_mfma_f32_16x16x32_bf16 v[32:35], a[228:231], a[132:135], v[32:35]
    v_exp_f32_e64 v129, v1
    v_mfma_f32_16x16x32_bf16 v[32:35], a[232:235], a[136:139], v[32:35]
    v_exp_f32_e64 v130, v2
    v_cvt_pk_bf16_f32 v96, v128, v129
    v_mfma_f32_16x16x32_bf16 v[32:35], a[236:239], a[140:143], v[32:35]
    v_exp_f32_e64 v131, v3
    v_mfma_f32_16x16x32_bf16 v[40:43], a[224:227], a[144:147], v[72:75]
    ds_read_b128 a[196:199], v241 offset:2048
    v_exp_f32_e64 v132, v4
    v_mfma_f32_16x16x32_bf16 v[40:43], a[228:231], a[148:151], v[40:43]
    v_exp_f32_e64 v133, v5
    v_cvt_pk_bf16_f32 v97, v130, v131
    v_mfma_f32_16x16x32_bf16 v[40:43], a[232:235], a[152:155], v[40:43]
    v_exp_f32_e64 v134, v6
    v_cvt_pk_bf16_f32 v98, v132, v133
    v_mfma_f32_16x16x32_bf16 v[40:43], a[236:239], a[156:159], v[40:43]
    v_exp_f32_e64 v135, v7
    v_mfma_f32_16x16x32_bf16 v[48:51], a[224:227], a[160:163], v[80:83]
    ds_read_b128 a[200:203], v241 offset:4096
    v_exp_f32_e64 v136, v8
    v_mfma_f32_16x16x32_bf16 v[48:51], a[228:231], a[164:167], v[48:51]
    v_exp_f32_e64 v137, v9
    v_cvt_pk_bf16_f32 v99, v134, v135
    v_mfma_f32_16x16x32_bf16 v[48:51], a[232:235], a[168:171], v[48:51]
    v_exp_f32 v138, v10
    v_exp_f32 v139, v11
    v_mfma_f32_16x16x32_bf16 v[48:51], a[236:239], a[172:175], v[48:51]
    v_exp_f32_e64 v140, v12
    v_cvt_pk_bf16_f32 v100, v136, v137
    v_mfma_f32_16x16x32_bf16 v[56:59], a[224:227], a[176:179], v[88:91]
    ds_read_b128 a[204:207], v241 offset:6144
    v_exp_f32_e64 v141, v13
    v_mfma_f32_16x16x32_bf16 v[56:59], a[228:231], a[180:183], v[56:59]
    v_exp_f32_e64 v142, v14
    v_cvt_pk_bf16_f32 v101, v138, v139
    v_mfma_f32_16x16x32_bf16 v[56:59], a[232:235], a[184:187], v[56:59]
    v_exp_f32_e64 v143, v15
    v_cvt_pk_bf16_f32 v102, v140, v141
    v_mfma_f32_16x16x32_bf16 v[56:59], a[236:239], a[188:191], v[56:59]
    v_exp_f32_e64 v128, v16
    v_cvt_pk_bf16_f32 v103, v142, v143
    v_mfma_f32_16x16x32_bf16 v[36:39], a[240:243], a[128:131], v[68:71]
    ds_read_b128 a[208:211], v241 offset:1024
    v_exp_f32_e64 v129, v17
    v_mfma_f32_16x16x32_bf16 v[36:39], a[244:247], a[132:135], v[36:39]
    v_exp_f32_e64 v130, v18
    v_cvt_pk_bf16_f32 v104, v128, v129
    v_mfma_f32_16x16x32_bf16 v[36:39], a[248:251], a[136:139], v[36:39]
    v_exp_f32_e64 v131, v19
    v_mfma_f32_16x16x32_bf16 v[36:39], a[252:255], a[140:143], v[36:39]
    v_exp_f32_e64 v132, v20
    v_cvt_pk_bf16_f32 v105, v130, v131
    v_mfma_f32_16x16x32_bf16 v[44:47], a[240:243], a[144:147], v[76:79]
    ds_read_b128 a[212:215], v241 offset:3072
    v_exp_f32_e64 v133, v21
    v_mfma_f32_16x16x32_bf16 v[44:47], a[244:247], a[148:151], v[44:47]
    v_exp_f32 v134, v22
    v_exp_f32 v135, v23
    v_mfma_f32_16x16x32_bf16 v[44:47], a[248:251], a[152:155], v[44:47]
    v_exp_f32_e64 v136, v24
    v_cvt_pk_bf16_f32 v106, v132, v133
    v_mfma_f32_16x16x32_bf16 v[44:47], a[252:255], a[156:159], v[44:47]
    v_exp_f32_e64 v137, v25
    v_cvt_pk_bf16_f32 v107, v134, v135
    v_mfma_f32_16x16x32_bf16 v[52:55], a[240:243], a[160:163], v[84:87]
    ds_read_b128 a[216:219], v241 offset:5120
    v_exp_f32_e64 v138, v26
    v_mfma_f32_16x16x32_bf16 v[52:55], a[244:247], a[164:167], v[52:55]
    v_exp_f32_e64 v139, v27
    v_cvt_pk_bf16_f32 v108, v136, v137
    v_mfma_f32_16x16x32_bf16 v[52:55], a[248:251], a[168:171], v[52:55]
    v_exp_f32_e64 v140, v28
    v_cvt_pk_bf16_f32 v109, v138, v139
    v_mfma_f32_16x16x32_bf16 v[52:55], a[252:255], a[172:175], v[52:55]
    v_exp_f32_e64 v141, v29
    v_mfma_f32_16x16x32_bf16 v[60:63], a[240:243], a[176:179], v[92:95]
    ds_read_b128 a[220:223], v241 offset:7168
    v_exp_f32_e64 v142, v30
    v_mfma_f32_16x16x32_bf16 v[60:63], a[244:247], a[180:183], v[60:63]
    v_exp_f32_e64 v143, v31
    v_cvt_pk_bf16_f32 v110, v140, v141
    v_mfma_f32_16x16x32_bf16 v[60:63], a[248:251], a[184:187], v[60:63]
    v_cvt_pk_bf16_f32 v111, v142, v143
    v_mfma_f32_16x16x32_bf16 v[60:63], a[252:255], a[188:191], v[60:63]
    v_add_f32 v200, 0, v243
    v_min_f32 v200, 0, v200
    v_add_f32 v201, 0xf1800000, v243
    v_min_f32_e64 v201, 0, v201
    v_add_f32 v202, 0xf2000000, v243
    v_min_f32_e64 v202, 0, v202
    v_add_f32 v203, 0xf2400000, v243
    v_min_f32_e64 v203, 0, v203
    v_add_f32 v209, 0xf3000000, v243
    v_min_f32_e64 v209, 0, v209
    v_add_f32 v210, 0xf3100000, v243
    v_min_f32_e64 v210, 0, v210
    v_add_f32 v211, 0xf3200000, v243
    v_min_f32_e64 v211, 0, v211
    v_add_f32 v212, 0xf3300000, v243
    v_min_f32_e64 v212, 0, v212
    v_add_f32 v213, 0x73800000, v243
    v_min_f32_e64 v213, 0, v213
    v_add_f32 v214, 0x73700000, v243
    v_min_f32_e64 v214, 0, v214
    v_add_f32 v215, 0x73600000, v243
    v_min_f32_e64 v215, 0, v215
    v_add_f32 v216, 0x73500000, v243
    v_min_f32_e64 v216, 0, v216
    v_add_f32 v217, 0x73000000, v243
    v_min_f32_e64 v217, 0, v217
    v_add_f32 v218, 0x72e00000, v243
    v_min_f32_e64 v218, 0, v218
    v_add_f32 v219, 0x72c00000, v243
    v_min_f32_e64 v219, 0, v219
    v_add_f32 v220, 0x72a00000, v243
    v_min_f32_e64 v220, 0, v220
    ds_read_b128 a[224:227], v241 offset:16384
    ds_read_b128 a[228:231], v241 offset:17408
    ds_read_b128 a[232:235], v241 offset:18432
    ds_read_b128 a[236:239], v241 offset:19456
    s_mul_i32 s27, s5, 68096
    s_sub_u32 s27, s32, s27
    s_add_u32 s18, s27, 1089536
    s_mov_b32 s31, s101
    v_mul_u32_u24 v245, 448, v240
    v_and_b32 v230, 0x40000000, v251
    v_or_b32 v245, v245, v230
    s_lshl1_add_u32 s26, s5, s31
    s_branch ka_p1_e
.p2align 5
ka_p1:
    s_sub_u32 s36, s36, 1
    s_cbranch_scc1 kf_fix5
kf_fixr6:
    s_waitcnt lgkmcnt(4)
    v_mfma_f32_16x16x32_bf16 v[0:3], a[192:195], a[128:131], v[64:67]
    ds_read_b128 a[240:243], v241 offset:20480
    s_waitcnt vmcnt(11)
    v_mfma_f32_16x16x32_bf16 v[0:3], a[196:199], a[132:135], v[0:3]
    v_exp_f32_e64 v128, v32
    v_mfma_f32_16x16x32_bf16 v[0:3], a[200:203], a[136:139], v[0:3]
    v_exp_f32_e64 v129, v33
    v_mfma_f32_16x16x32_bf16 v[0:3], a[204:207], a[140:143], v[0:3]
    v_exp_f32_e64 v130, v34
    v_mfma_f32_16x16x32_bf16 v[8:11], a[192:195], a[144:147], v[72:75]
    ds_read_b128 a[244:247], v241 offset:21504
    buffer_store_dwordx4 v[192:195], v255, s[48:51], s45 offen offset:0 sc1
    v_mfma_f32_16x16x32_bf16 v[8:11], a[196:199], a[148:151], v[8:11]
    s_cmp_lt_u32 s44, s47
    s_cselect_b32 s101, s44, s43
    v_mfma_f32_16x16x32_bf16 v[8:11], a[200:203], a[152:155], v[8:11]
    buffer_load_dwordx4 v[192:195], v253, s[52:55], s101 offen
    v_cvt_pk_bf16_f32 v112, v128, v129
    v_mfma_f32_16x16x32_bf16 v[8:11], a[204:207], a[156:159], v[8:11]
    v_exp_f32_e64 v131, v35
    v_mfma_f32_16x16x32_bf16 v[16:19], a[192:195], a[160:163], v[80:83]
    ds_read_b128 a[248:251], v241 offset:22528
    v_cvt_pk_bf16_f32 v113, v130, v131
    v_mfma_f32_16x16x32_bf16 v[16:19], a[196:199], a[164:167], v[16:19]
    v_exp_f32_e64 v132, v36
    v_mfma_f32_16x16x32_bf16 v[16:19], a[200:203], a[168:171], v[16:19]
    v_exp_f32_e64 v133, v37
    v_mfma_f32_16x16x32_bf16 v[16:19], a[204:207], a[172:175], v[16:19]
    v_exp_f32_e64 v134, v38
    v_mfma_f32_16x16x32_bf16 v[24:27], a[192:195], a[176:179], v[88:91]
    ds_read_b128 a[252:255], v241 offset:23552
    s_mov_b32 m0, s34
    v_mfma_f32_16x16x32_bf16 v[24:27], a[196:199], a[180:183], v[24:27]
    s_add_u32 s41, s42, 17664
    v_cvt_pk_bf16_f32 v114, v132, v133
    v_mfma_f32_16x16x32_bf16 v[24:27], a[200:203], a[184:187], v[24:27]
    v_exp_f32 v135, v39
    v_mfma_f32_16x16x32_bf16 v[24:27], a[204:207], a[188:191], v[24:27]
    v_exp_f32_e64 v136, v40
    v_mfma_f32_16x16x32_bf16 v[4:7], a[208:211], a[128:131], v[68:71]
    ds_read_b128 a[192:195], v241 offset:8192
    v_cvt_pk_bf16_f32 v115, v134, v135
    v_mfma_f32_16x16x32_bf16 v[4:7], a[212:215], a[132:135], v[4:7]
    v_exp_f32_e64 v137, v41
    v_mfma_f32_16x16x32_bf16 v[4:7], a[216:219], a[136:139], v[4:7]
    v_exp_f32_e64 v138, v42
    v_mfma_f32_16x16x32_bf16 v[4:7], a[220:223], a[140:143], v[4:7]
    v_exp_f32_e64 v139, v43
    v_mfma_f32_16x16x32_bf16 v[12:15], a[208:211], a[144:147], v[76:79]
    ds_read_b128 a[196:199], v241 offset:10240
    buffer_load_dwordx4 v242, s[16:19], s41 offen offset:0 sc1 lds
    v_mfma_f32_16x16x32_bf16 v[12:15], a[212:215], a[148:151], v[12:15]
    v_exp_f32_e64 v140, v44
    v_mfma_f32_16x16x32_bf16 v[12:15], a[216:219], a[152:155], v[12:15]
    v_exp_f32_e64 v141, v45
    v_mfma_f32_16x16x32_bf16 v[12:15], a[220:223], a[156:159], v[12:15]
    v_exp_f32_e64 v142, v46
    v_mfma_f32_16x16x32_bf16 v[20:23], a[208:211], a[160:163], v[84:87]
    ds_read_b128 a[200:203], v241 offset:12288
    v_cvt_pk_bf16_f32 v116, v136, v137
    v_mfma_f32_16x16x32_bf16 v[20:23], a[212:215], a[164:167], v[20:23]
    v_exp_f32_e64 v143, v47
    v_mfma_f32_16x16x32_bf16 v[20:23], a[216:219], a[168:171], v[20:23]
    v_exp_f32_e64 v128, v48
    v_mfma_f32_16x16x32_bf16 v[20:23], a[220:223], a[172:175], v[20:23]
    v_exp_f32_e64 v129, v49
    v_mfma_f32_16x16x32_bf16 v[28:31], a[208:211], a[176:179], v[92:95]
    ds_read_b128 a[204:207], v241 offset:14336
    buffer_load_dwordx4 v242, s[16:19], s41 offen offset:1024 sc1 lds
    v_mfma_f32_16x16x32_bf16 v[28:31], a[212:215], a[180:183], v[28:31]
    v_cvt_pk_bf16_f32 v117, v138, v139
    v_cvt_pk_bf16_f32 v118, v140, v141
    v_mfma_f32_16x16x32_bf16 v[28:31], a[216:219], a[184:187], v[28:31]
    v_exp_f32_e64 v130, v50
    v_mfma_f32_16x16x32_bf16 v[28:31], a[220:223], a[188:191], v[28:31]
    v_cvt_pk_bf16_f32 v119, v142, v143
    s_waitcnt lgkmcnt(4)
    v_mfma_f32_16x16x32_bf16 a[0:3], a[224:227], v[96:99], a[0:3]
    ds_read_b128 a[208:211], v241 offset:9216
    v_cvt_pk_bf16_f32 v120, v128, v129
    v_mfma_f32_16x16x32_bf16 a[32:35], a[224:227], v[100:103], a[32:35]
    v_exp_f32 v131, v51
    v_mfma_f32_16x16x32_bf16 a[64:67], a[224:227], v[104:107], a[64:67]
    v_exp_f32_e64 v132, v52
    v_mfma_f32_16x16x32_bf16 a[96:99], a[224:227], v[108:111], a[96:99]
    v_exp_f32_e64 v133, v53
    v_mfma_f32_16x16x32_bf16 a[4:7], a[228:231], v[96:99], a[4:7]
    ds_read_b128 a[212:215], v241 offset:11264
    v_cvt_pk_bf16_f32 v121, v130, v131
    v_mfma_f32_16x16x32_bf16 a[36:39], a[228:231], v[100:103], a[36:39]
    buffer_load_dwordx4 v242, s[16:19], s41 offen offset:2048 sc1 lds
    v_cvt_pk_bf16_f32 v122, v132, v133
    v_mfma_f32_16x16x32_bf16 a[68:71], a[228:231], v[104:107], a[68:71]
    v_exp_f32_e64 v134, v54
    v_mfma_f32_16x16x32_bf16 a[100:103], a[228:231], v[108:111], a[100:103]
    v_exp_f32_e64 v135, v55
    v_mfma_f32_16x16x32_bf16 a[8:11], a[232:235], v[96:99], a[8:11]
    ds_read_b128 a[216:219], v241 offset:13312
    v_cvt_pk_bf16_f32 v123, v134, v135
    v_mfma_f32_16x16x32_bf16 a[40:43], a[232:235], v[100:103], a[40:43]
    v_exp_f32_e64 v136, v56
    v_mfma_f32_16x16x32_bf16 a[72:75], a[232:235], v[104:107], a[72:75]
    v_exp_f32_e64 v137, v57
    v_mfma_f32_16x16x32_bf16 a[104:107], a[232:235], v[108:111], a[104:107]
    v_exp_f32_e64 v138, v58
    v_mfma_f32_16x16x32_bf16 a[12:15], a[236:239], v[96:99], a[12:15]
    ds_read_b128 a[220:223], v241 offset:15360
    v_cvt_pk_bf16_f32 v124, v136, v137
    v_mfma_f32_16x16x32_bf16 a[44:47], a[236:239], v[100:103], a[44:47]
    v_exp_f32_e64 v139, v59
    v_mfma_f32_16x16x32_bf16 a[76:79], a[236:239], v[104:107], a[76:79]
    buffer_load_dwordx4 v242, s[16:19], s41 offen offset:3072 sc1 lds
    v_cvt_pk_bf16_f32 v125, v138, v139
    v_mfma_f32_16x16x32_bf16 a[108:111], a[236:239], v[108:111], a[108:111]
    v_exp_f32_e64 v140, v60
    v_mfma_f32_16x16x32_bf16 a[16:19], a[240:243], v[96:99], a[16:19]
    ds_read_b128 a[224:227], v241 offset:24576
    v_mfma_f32_16x16x32_bf16 a[48:51], a[240:243], v[100:103], a[48:51]
    v_exp_f32_e64 v141, v61
    v_mfma_f32_16x16x32_bf16 a[80:83], a[240:243], v[104:107], a[80:83]
    v_exp_f32_e64 v142, v62
    v_mfma_f32_16x16x32_bf16 a[112:115], a[240:243], v[108:111], a[112:115]
    v_exp_f32_e64 v143, v63
    v_mfma_f32_16x16x32_bf16 a[20:23], a[244:247], v[96:99], a[20:23]
    ds_read_b128 a[228:231], v241 offset:25600
    v_cvt_pk_bf16_f32 v126, v140, v141
    v_mfma_f32_16x16x32_bf16 a[52:55], a[244:247], v[100:103], a[52:55]
    v_cvt_pk_bf16_f32 v127, v142, v143
    s_add_u32 s35, s35, 32768
    v_mfma_f32_16x16x32_bf16 a[84:87], a[244:247], v[104:107], a[84:87]
    s_cmp_ge_u32 s35, 163840
    s_cselect_b32 s35, 0, s35
    v_mfma_f32_16x16x32_bf16 a[116:119], a[244:247], v[108:111], a[116:119]
    v_mfma_f32_16x16x32_bf16 a[24:27], a[248:251], v[96:99], a[24:27]
    ds_read_b128 a[232:235], v241 offset:26624
    v_mfma_f32_16x16x32_bf16 a[56:59], a[248:251], v[100:103], a[56:59]
    v_mfma_f32_16x16x32_bf16 a[88:91], a[248:251], v[104:107], a[88:91]
    v_mfma_f32_16x16x32_bf16 a[120:123], a[248:251], v[108:111], a[120:123]
    v_mfma_f32_16x16x32_bf16 a[28:31], a[252:255], v[96:99], a[28:31]
    ds_read_b128 a[236:239], v241 offset:27648
    v_mfma_f32_16x16x32_bf16 a[60:63], a[252:255], v[100:103], a[60:63]
    v_mfma_f32_16x16x32_bf16 a[92:95], a[252:255], v[104:107], a[92:95]
    v_mfma_f32_16x16x32_bf16 a[124:127], a[252:255], v[108:111], a[124:127]
    v_mfma_f32_16x16x32_bf16 v[144:147], v[204:207], v[96:99], v[144:147]
    v_mfma_f32_16x16x32_bf16 v[148:151], v[204:207], v[100:103], v[148:151]
    v_mfma_f32_16x16x32_bf16 v[152:155], v[204:207], v[104:107], v[152:155]
    v_mfma_f32_16x16x32_bf16 v[156:159], v[204:207], v[108:111], v[156:159]
    s_sub_u32 s36, s36, 1
    s_cbranch_scc1 kf_fix7
kf_fixr8:
    s_waitcnt lgkmcnt(4)
    v_mfma_f32_16x16x32_bf16 v[32:35], a[192:195], a[128:131], v[64:67]
    ds_read_b128 a[240:243], v241 offset:28672
    s_waitcnt vmcnt(11)
    v_mfma_f32_16x16x32_bf16 v[32:35], a[196:199], a[132:135], v[32:35]
    v_exp_f32 v128, v0
    v_mfma_f32_16x16x32_bf16 v[32:35], a[200:203], a[136:139], v[32:35]
    v_exp_f32_e64 v129, v1
    v_mfma_f32_16x16x32_bf16 v[32:35], a[204:207], a[140:143], v[32:35]
    v_exp_f32_e64 v130, v2
    v_mfma_f32_16x16x32_bf16 v[40:43], a[192:195], a[144:147], v[72:75]
    ds_read_b128 a[244:247], v241 offset:29696
    buffer_store_dwordx4 v[196:199], v255, s[48:51], s45 offen offset:256 sc1
    v_mfma_f32_16x16x32_bf16 v[40:43], a[196:199], a[148:151], v[40:43]
    s_add_u32 s101, s101, 57344
    buffer_load_dwordx4 v[196:199], v253, s[52:55], s101 offen
    v_mfma_f32_16x16x32_bf16 v[40:43], a[200:203], a[152:155], v[40:43]
    v_exp_f32_e64 v131, v3
    v_mfma_f32_16x16x32_bf16 v[40:43], a[204:207], a[156:159], v[40:43]
    v_exp_f32_e64 v132, v4
    v_mfma_f32_16x16x32_bf16 v[48:51], a[192:195], a[160:163], v[80:83]
    ds_read_b128 a[248:251], v241 offset:30720
    v_cvt_pk_bf16_f32 v96, v128, v129
    v_mfma_f32_16x16x32_bf16 v[48:51], a[196:199], a[164:167], v[48:51]
    s_cmp_lt_u32 s44, s47
    s_cselect_b32 s45, s46, s43
    v_mfma_f32_16x16x32_bf16 v[48:51], a[200:203], a[168:171], v[48:51]
    v_exp_f32_e64 v133, v5
    v_mfma_f32_16x16x32_bf16 v[48:51], a[204:207], a[172:175], v[48:51]
    v_exp_f32_e64 v134, v6
    v_mfma_f32_16x16x32_bf16 v[56:59], a[192:195], a[176:179], v[88:91]
    ds_read_b128 a[252:255], v241 offset:31744
    s_add_u32 s44, s44, 128
    v_mfma_f32_16x16x32_bf16 v[56:59], a[196:199], a[180:183], v[56:59]
    s_add_u32 s46, s46, 262144
    v_cvt_pk_bf16_f32 v97, v130, v131
    v_mfma_f32_16x16x32_bf16 v[56:59], a[200:203], a[184:187], v[56:59]
    v_exp_f32_e64 v135, v7
    v_mfma_f32_16x16x32_bf16 v[56:59], a[204:207], a[188:191], v[56:59]
    v_exp_f32_e64 v136, v8
    v_mfma_f32_16x16x32_bf16 v[36:39], a[208:211], a[128:131], v[68:71]
    s_waitcnt vmcnt(16)
    s_barrier
    v_add_u32_e64 v241, s35, v240
    ds_read_b128 a[192:195], v241 offset:0
    v_mfma_f32_16x16x32_bf16 v[36:39], a[212:215], a[132:135], v[36:39]
    v_exp_f32_e64 v137, v9
    v_mfma_f32_16x16x32_bf16 v[36:39], a[216:219], a[136:139], v[36:39]
    v_exp_f32_e64 v138, v10
    v_mfma_f32_16x16x32_bf16 v[36:39], a[220:223], a[140:143], v[36:39]
    v_exp_f32_e64 v139, v11
    v_mfma_f32_16x16x32_bf16 v[44:47], a[208:211], a[144:147], v[76:79]
    ds_read_b128 a[196:199], v241 offset:2048
    s_add_u32 m0, s34, 16384
    v_mfma_f32_16x16x32_bf16 v[44:47], a[212:215], a[148:151], v[44:47]
    s_add_u32 s34, s34, 32768
    v_cvt_pk_bf16_f32 v98, v132, v133
    v_mfma_f32_16x16x32_bf16 v[44:47], a[216:219], a[152:155], v[44:47]
    s_cmp_ge_u32 s34, 163840
    s_cselect_b32 s34, s37, s34
    v_mfma_f32_16x16x32_bf16 v[44:47], a[220:223], a[156:159], v[44:47]
    v_exp_f32 v140, v12
    v_mfma_f32_16x16x32_bf16 v[52:55], a[208:211], a[160:163], v[84:87]
    ds_read_b128 a[200:203], v241 offset:4096
    v_cvt_pk_bf16_f32 v99, v134, v135
    v_mfma_f32_16x16x32_bf16 v[52:55], a[212:215], a[164:167], v[52:55]
    v_exp_f32_e64 v141, v13
    v_mfma_f32_16x16x32_bf16 v[52:55], a[216:219], a[168:171], v[52:55]
    v_exp_f32_e64 v142, v14
    v_mfma_f32_16x16x32_bf16 v[52:55], a[220:223], a[172:175], v[52:55]
    v_exp_f32_e64 v143, v15
    v_mfma_f32_16x16x32_bf16 v[60:63], a[208:211], a[176:179], v[92:95]
    ds_read_b128 a[204:207], v241 offset:6144
    buffer_load_dwordx4 v242, s[16:19], s42 offen offset:0 sc1 lds
    v_mfma_f32_16x16x32_bf16 v[60:63], a[212:215], a[180:183], v[60:63]
    v_cvt_pk_bf16_f32 v100, v136, v137
    v_cvt_pk_bf16_f32 v101, v138, v139
    v_mfma_f32_16x16x32_bf16 v[60:63], a[216:219], a[184:187], v[60:63]
    v_exp_f32_e64 v128, v16
    v_mfma_f32_16x16x32_bf16 v[60:63], a[220:223], a[188:191], v[60:63]
    v_cvt_pk_bf16_f32 v102, v140, v141
    s_waitcnt lgkmcnt(4)
    v_mfma_f32_16x16x32_bf16 a[0:3], a[224:227], v[112:115], a[0:3]
    ds_read_b128 a[208:211], v241 offset:1024
    v_cvt_pk_bf16_f32 v103, v142, v143
    v_mfma_f32_16x16x32_bf16 a[32:35], a[224:227], v[116:119], a[32:35]
    v_exp_f32 v129, v17
    v_mfma_f32_16x16x32_bf16 a[64:67], a[224:227], v[120:123], a[64:67]
    v_exp_f32_e64 v130, v18
    v_mfma_f32_16x16x32_bf16 a[96:99], a[224:227], v[124:127], a[96:99]
    v_exp_f32_e64 v131, v19
    v_mfma_f32_16x16x32_bf16 a[4:7], a[228:231], v[112:115], a[4:7]
    ds_read_b128 a[212:215], v241 offset:3072
    buffer_load_dwordx4 v242, s[16:19], s42 offen offset:1024 sc1 lds
    v_mfma_f32_16x16x32_bf16 a[36:39], a[228:231], v[116:119], a[36:39]
    v_exp_f32_e64 v132, v20
    v_mfma_f32_16x16x32_bf16 a[68:71], a[228:231], v[120:123], a[68:71]
    v_exp_f32_e64 v133, v21
    v_mfma_f32_16x16x32_bf16 a[100:103], a[228:231], v[124:127], a[100:103]
    v_exp_f32_e64 v134, v22
    v_mfma_f32_16x16x32_bf16 a[8:11], a[232:235], v[112:115], a[8:11]
    ds_read_b128 a[216:219], v241 offset:5120
    v_cvt_pk_bf16_f32 v104, v128, v129
    v_mfma_f32_16x16x32_bf16 a[40:43], a[232:235], v[116:119], a[40:43]
    buffer_load_dwordx4 v242, s[16:19], s42 offen offset:2048 sc1 lds
    v_cvt_pk_bf16_f32 v105, v130, v131
    v_mfma_f32_16x16x32_bf16 a[72:75], a[232:235], v[120:123], a[72:75]
    v_exp_f32_e64 v135, v23
    v_mfma_f32_16x16x32_bf16 a[104:107], a[232:235], v[124:127], a[104:107]
    v_exp_f32_e64 v136, v24
    v_mfma_f32_16x16x32_bf16 a[12:15], a[236:239], v[112:115], a[12:15]
    ds_read_b128 a[220:223], v241 offset:7168
    v_cvt_pk_bf16_f32 v106, v132, v133
    v_mfma_f32_16x16x32_bf16 a[44:47], a[236:239], v[116:119], a[44:47]
    v_exp_f32_e64 v137, v25
    v_mfma_f32_16x16x32_bf16 a[76:79], a[236:239], v[120:123], a[76:79]
    v_exp_f32_e64 v138, v26
    v_mfma_f32_16x16x32_bf16 a[108:111], a[236:239], v[124:127], a[108:111]
    v_exp_f32_e64 v139, v27
    v_mfma_f32_16x16x32_bf16 a[16:19], a[240:243], v[112:115], a[16:19]
    ds_read_b128 a[224:227], v241 offset:16384
    v_cvt_pk_bf16_f32 v107, v134, v135
    v_mfma_f32_16x16x32_bf16 a[48:51], a[240:243], v[116:119], a[48:51]
    buffer_load_dwordx4 v242, s[16:19], s42 offen offset:3072 sc1 lds
    s_add_u32 s42, s42, 34048
    v_mfma_f32_16x16x32_bf16 a[80:83], a[240:243], v[120:123], a[80:83]
    v_exp_f32_e64 v140, v28
    v_mfma_f32_16x16x32_bf16 a[112:115], a[240:243], v[124:127], a[112:115]
    v_exp_f32_e64 v141, v29
    v_mfma_f32_16x16x32_bf16 a[20:23], a[244:247], v[112:115], a[20:23]
    ds_read_b128 a[228:231], v241 offset:17408
    v_cvt_pk_bf16_f32 v108, v136, v137
    v_mfma_f32_16x16x32_bf16 a[52:55], a[244:247], v[116:119], a[52:55]
    v_exp_f32_e64 v142, v30
    v_mfma_f32_16x16x32_bf16 a[84:87], a[244:247], v[120:123], a[84:87]
    v_exp_f32_e64 v143, v31
    v_mfma_f32_16x16x32_bf16 a[116:119], a[244:247], v[124:127], a[116:119]
    v_cvt_pk_bf16_f32 v109, v138, v139
    v_cvt_pk_bf16_f32 v110, v140, v141
    v_mfma_f32_16x16x32_bf16 a[24:27], a[248:251], v[112:115], a[24:27]
    ds_read_b128 a[232:235], v241 offset:18432
    v_cvt_pk_bf16_f32 v111, v142, v143
    v_mfma_f32_16x16x32_bf16 a[56:59], a[248:251], v[116:119], a[56:59]
    buffer_load_dword v252, v251, s[60:63], s100 offen
    s_add_u32 s100, s100, 2048
    v_mfma_f32_16x16x32_bf16 a[88:91], a[248:251], v[120:123], a[88:91]
    v_mfma_f32_16x16x32_bf16 a[120:123], a[248:251], v[124:127], a[120:123]
    v_mfma_f32_16x16x32_bf16 a[28:31], a[252:255], v[112:115], a[28:31]
    ds_read_b128 a[236:239], v241 offset:19456
    v_mfma_f32_16x16x32_bf16 a[60:63], a[252:255], v[116:119], a[60:63]
    v_mfma_f32_16x16x32_bf16 a[92:95], a[252:255], v[120:123], a[92:95]
    v_mfma_f32_16x16x32_bf16 a[124:127], a[252:255], v[124:127], a[124:127]
    v_mfma_f32_16x16x32_bf16 v[144:147], v[204:207], v[112:115], v[144:147]
    v_mfma_f32_16x16x32_bf16 v[148:151], v[204:207], v[116:119], v[148:151]
    v_mfma_f32_16x16x32_bf16 v[152:155], v[204:207], v[120:123], v[152:155]
    v_mfma_f32_16x16x32_bf16 v[156:159], v[204:207], v[124:127], v[156:159]
ka_p1_e:
    s_sub_u32 s26, s26, 1
    s_cbranch_scc0 ka_p1
    s_branch ka_p1_x
kf_fix5:
    s_mov_b32 s24, 0
    s_branch kf_fix5c
kf_fix7:
    s_mov_b32 s24, 1
kf_fix5c:
    s_cmp_eq_u32 s33, 0
    s_cbranch_scc0 kf_fix5f
    s_mov_b32 s36, 0
    s_mov_b32 s33, 1
    v_add_f32 v64, v224, v200
    v_add_f32 v65, v224, v201
    v_add_f32 v66, v224, v202
    v_add_f32 v67, v224, v203
    v_add_f32 v68, v224, v209
    v_add_f32 v69, v224, v210
    v_add_f32 v70, v224, v211
    v_add_f32 v71, v224, v212
    v_add_f32 v72, v225, v213
    v_add_f32 v73, v225, v214
    v_add_f32 v74, v225, v215
    v_add_f32 v75, v225, v216
    v_add_f32 v76, v225, v217
    v_add_f32 v77, v225, v218
    v_add_f32 v78, v225, v219
    v_add_f32_e64 v79, v225, v220
    s_cmp_eq_u32 s24, 0
    s_cbranch_scc1 kf_fixr6
    s_branch kf_fixr8
kf_fix5f:
    s_mov_b32 s36, 0x1000
    v_mov_b32 v64, 0xf1800000
    v_mov_b32 v65, v64
    v_mov_b32 v66, v64
    v_mov_b32 v67, v64
    v_mov_b32 v68, v64
    v_mov_b32 v69, v64
    v_mov_b32 v70, v64
    v_mov_b32 v71, v64
    v_mov_b32 v72, v64
    v_mov_b32 v73, v64
    v_mov_b32 v74, v64
    v_mov_b32 v75, v64
    v_mov_b32 v76, v64
    v_mov_b32 v77, v64
    v_mov_b32 v78, v64
    v_mov_b32 v79, v64
    s_cmp_eq_u32 s24, 0
    s_cbranch_scc1 kf_fixr6
    s_branch kf_fixr8
kf_fix9:
    s_mov_b32 s24, 0
    s_branch kf_fix9c
kf_fix11:
    s_mov_b32 s24, 1
kf_fix9c:
    s_cmp_eq_u32 s33, 0
    s_cbranch_scc0 kf_fix9f
    s_mov_b32 s36, 0
    s_mov_b32 s33, 1
    v_add_f32 v80, v226, v200
    v_add_f32 v81, v226, v201
    v_add_f32 v82, v226, v202
    v_add_f32 v83, v226, v203
    v_add_f32 v84, v226, v209
    v_add_f32 v85, v226, v210
    v_add_f32 v86, v226, v211
    v_add_f32 v87, v226, v212
    v_add_f32 v88, v227, v213
    v_add_f32 v89, v227, v214
    v_add_f32 v90, v227, v215
    v_add_f32 v91, v227, v216
    v_add_f32 v92, v227, v217
    v_add_f32 v93, v227, v218
    v_add_f32 v94, v227, v219
    v_add_f32 v95, v227, v220
    s_cmp_eq_u32 s24, 0
    s_cbranch_scc1 kf_fixr10
    s_branch kf_fixr12
kf_fix9f:
    s_mov_b32 s36, 0x1000
    v_mov_b32 v80, 0xf1800000
    v_mov_b32 v81, v80
    v_mov_b32 v82, v80
    v_mov_b32 v83, v80
    v_mov_b32 v84, v80
    v_mov_b32 v85, v80
    v_mov_b32 v86, v80
    v_mov_b32 v87, v80
    v_mov_b32 v88, v80
    v_mov_b32 v89, v80
    v_mov_b32 v90, v80
    v_mov_b32 v91, v80
    v_mov_b32 v92, v80
    v_mov_b32 v93, v80
    v_mov_b32 v94, v80
    v_mov_b32_e64 v95, v80
    s_cmp_eq_u32 s24, 0
    s_cbranch_scc1 kf_fixr10
    s_branch kf_fixr12
ka_p1_x:
    s_lshl2_add_u32 s36, s5, s6
    s_lshl1_add_u32 s36, s31, s36
    s_sub_u32 s36, 61, s36
    s_mov_b32 s33, 0
    s_sub_u32 s36, s36, 1
    s_cbranch_scc1 kf_fix9
kf_fixr10:
    s_waitcnt lgkmcnt(4)
    v_mfma_f32_16x16x32_bf16 v[16:19], a[192:195], a[160:163], v[80:83]
    ds_read_b128 a[240:243], v241 offset:20480
    ds_read_b128 a[244:247], v241 offset:21504
    v_mfma_f32_16x16x32_bf16 v[16:19], a[196:199], a[164:167], v[16:19]
    v_exp_f32_e64 v128, v32
    v_mfma_f32_16x16x32_bf16 v[16:19], a[200:203], a[168:171], v[16:19]
    v_exp_f32_e64 v129, v33
    v_mfma_f32_16x16x32_bf16 v[16:19], a[204:207], a[172:175], v[16:19]
    v_exp_f32_e64 v130, v34
    v_mfma_f32_16x16x32_bf16 v[24:27], a[192:195], a[176:179], v[88:91]
    ds_read_b128 a[248:251], v241 offset:22528
    ds_read_b128 a[252:255], v241 offset:23552
    s_waitcnt vmcnt(11)
    v_mfma_f32_16x16x32_bf16 v[24:27], a[196:199], a[180:183], v[24:27]
    buffer_store_dwordx4 v[192:195], v255, s[48:51], s45 offen offset:0 sc1
    v_cvt_pk_bf16_f32 v112, v128, v129
    v_mfma_f32_16x16x32_bf16 v[24:27], a[200:203], a[184:187], v[24:27]
    v_exp_f32 v131, v35
    v_mfma_f32_16x16x32_bf16 v[24:27], a[204:207], a[188:191], v[24:27]
    v_exp_f32_e64 v132, v36
    v_mfma_f32_16x16x32_bf16 v[20:23], a[208:211], a[160:163], v[84:87]
    ds_read_b128 a[192:195], v241 offset:8192
    ds_read_b128 a[196:199], v241 offset:10240
    v_mfma_f32_16x16x32_bf16 v[20:23], a[212:215], a[164:167], v[20:23]
    v_exp_f32_e64 v133, v37
    v_mfma_f32_16x16x32_bf16 v[20:23], a[216:219], a[168:171], v[20:23]
    s_mov_b32 m0, s34
    s_add_u32 s41, s42, 17664
    v_mfma_f32_16x16x32_bf16 v[20:23], a[220:223], a[172:175], v[20:23]
    v_exp_f32 v134, v38
    v_mfma_f32_16x16x32_bf16 v[28:31], a[208:211], a[176:179], v[92:95]
    ds_read_b128 a[200:203], v241 offset:12288
    ds_read_b128 a[204:207], v241 offset:14336
    v_cvt_pk_bf16_f32 v113, v130, v131
    v_mfma_f32_16x16x32_bf16 v[28:31], a[212:215], a[180:183], v[28:31]
    v_exp_f32_e64 v135, v39
    v_mfma_f32_16x16x32_bf16 v[28:31], a[216:219], a[184:187], v[28:31]
    v_exp_f32_e64 v136, v40
    v_mfma_f32_16x16x32_bf16 v[28:31], a[220:223], a[188:191], v[28:31]
    buffer_load_dwordx4 v242, s[16:19], s41 offen offset:0 sc1 lds
    s_waitcnt lgkmcnt(4)
    v_mfma_f32_16x16x32_bf16 a[0:3], a[224:227], v[96:99], a[0:3]
    ds_read_b128 a[208:211], v241 offset:9216
    v_cvt_pk_bf16_f32 v114, v132, v133
    v_mfma_f32_16x16x32_bf16 a[32:35], a[224:227], v[100:103], a[32:35]
    v_exp_f32 v137, v41
    v_mfma_f32_16x16x32_bf16 a[64:67], a[224:227], v[104:107], a[64:67]
    v_exp_f32_e64 v138, v42
    v_mfma_f32_16x16x32_bf16 a[96:99], a[224:227], v[108:111], a[96:99]
    v_exp_f32_e64 v139, v43
    v_mfma_f32_16x16x32_bf16 a[4:7], a[228:231], v[96:99], a[4:7]
    ds_read_b128 a[212:215], v241 offset:11264
    v_cvt_pk_bf16_f32 v115, v134, v135
    v_mfma_f32_16x16x32_bf16 a[36:39], a[228:231], v[100:103], a[36:39]
    buffer_load_dwordx4 v242, s[16:19], s41 offen offset:1024 sc1 lds
    v_exp_f32_e64 v140, v44
    v_mfma_f32_16x16x32_bf16 a[68:71], a[228:231], v[104:107], a[68:71]
    v_exp_f32_e64 v141, v45
    v_mfma_f32_16x16x32_bf16 a[100:103], a[228:231], v[108:111], a[100:103]
    v_exp_f32_e64 v142, v46
    v_mfma_f32_16x16x32_bf16 a[8:11], a[232:235], v[96:99], a[8:11]
    ds_read_b128 a[216:219], v241 offset:13312
    v_cvt_pk_bf16_f32 v116, v136, v137
    v_mfma_f32_16x16x32_bf16 a[40:43], a[232:235], v[100:103], a[40:43]
    v_exp_f32_e64 v143, v47
    v_mfma_f32_16x16x32_bf16 a[72:75], a[232:235], v[104:107], a[72:75]
    v_exp_f32_e64 v128, v48
    v_mfma_f32_16x16x32_bf16 a[104:107], a[232:235], v[108:111], a[104:107]
    v_exp_f32_e64 v129, v49
    v_mfma_f32_16x16x32_bf16 a[12:15], a[236:239], v[96:99], a[12:15]
    ds_read_b128 a[220:223], v241 offset:15360
    buffer_load_dwordx4 v242, s[16:19], s41 offen offset:2048 sc1 lds
    v_mfma_f32_16x16x32_bf16 a[44:47], a[236:239], v[100:103], a[44:47]
    v_cvt_pk_bf16_f32 v117, v138, v139
    v_cvt_pk_bf16_f32 v118, v140, v141
    v_mfma_f32_16x16x32_bf16 a[76:79], a[236:239], v[104:107], a[76:79]
    v_exp_f32_e64 v130, v50
    v_cvt_pk_bf16_f32 v119, v142, v143
    v_mfma_f32_16x16x32_bf16 a[108:111], a[236:239], v[108:111], a[108:111]
    v_exp_f32_e64 v131, v51
    v_mfma_f32_16x16x32_bf16 a[16:19], a[240:243], v[96:99], a[16:19]
    ds_read_b128 a[224:227], v241 offset:24576
    v_cvt_pk_bf16_f32 v120, v128, v129
    v_mfma_f32_16x16x32_bf16 a[48:51], a[240:243], v[100:103], a[48:51]
    v_exp_f32_e64 v132, v52
    v_mfma_f32_16x16x32_bf16 a[80:83], a[240:243], v[104:107], a[80:83]
    v_exp_f32_e64 v133, v53
    v_mfma_f32_16x16x32_bf16 a[112:115], a[240:243], v[108:111], a[112:115]
    v_exp_f32_e64 v134, v54
    v_mfma_f32_16x16x32_bf16 a[20:23], a[244:247], v[96:99], a[20:23]
    ds_read_b128 a[228:231], v241 offset:25600
    buffer_load_dwordx4 v242, s[16:19], s41 offen offset:3072 sc1 lds
    v_mfma_f32_16x16x32_bf16 a[52:55], a[244:247], v[100:103], a[52:55]
    v_exp_f32_e64 v135, v55
    v_mfma_f32_16x16x32_bf16 a[84:87], a[244:247], v[104:107], a[84:87]
    v_exp_f32_e64 v136, v56
    v_cvt_pk_bf16_f32 v121, v130, v131
    v_mfma_f32_16x16x32_bf16 a[116:119], a[244:247], v[108:111], a[116:119]
    v_exp_f32_e64 v137, v57
    v_mfma_f32_16x16x32_bf16 a[24:27], a[248:251], v[96:99], a[24:27]
    ds_read_b128 a[232:235], v241 offset:26624
    v_cvt_pk_bf16_f32 v122, v132, v133
    v_mfma_f32_16x16x32_bf16 a[56:59], a[248:251], v[100:103], a[56:59]
    v_exp_f32_e64 v138, v58
    v_mfma_f32_16x16x32_bf16 a[88:91], a[248:251], v[104:107], a[88:91]
    v_exp_f32_e64 v139, v59
    v_mfma_f32_16x16x32_bf16 a[120:123], a[248:251], v[108:111], a[120:123]
    v_exp_f32_e64 v140, v60
    v_mfma_f32_16x16x32_bf16 a[28:31], a[252:255], v[96:99], a[28:31]
    ds_read_b128 a[236:239], v241 offset:27648
    s_add_u32 s35, s35, 32768
    v_mfma_f32_16x16x32_bf16 a[60:63], a[252:255], v[100:103], a[60:63]
    s_cmp_ge_u32 s35, 163840
    s_cselect_b32 s35, 0, s35
    v_mfma_f32_16x16x32_bf16 a[92:95], a[252:255], v[104:107], a[92:95]
    v_exp_f32 v141, v61
    v_mfma_f32_16x16x32_bf16 a[124:127], a[252:255], v[108:111], a[124:127]
    v_cvt_pk_bf16_f32 v123, v134, v135
    v_exp_f32_e64 v142, v62
    v_mfma_f32_16x16x32_bf16 v[144:147], v[204:207], v[96:99], v[144:147]
    v_exp_f32_e64 v143, v63
    v_mfma_f32_16x16x32_bf16 v[148:151], v[204:207], v[100:103], v[148:151]
    v_cvt_pk_bf16_f32 v124, v136, v137
    v_cvt_pk_bf16_f32 v125, v138, v139
    v_mfma_f32_16x16x32_bf16 v[152:155], v[204:207], v[104:107], v[152:155]
    v_cvt_pk_bf16_f32 v126, v140, v141
    v_cvt_pk_bf16_f32 v127, v142, v143
    v_mfma_f32_16x16x32_bf16 v[156:159], v[204:207], v[108:111], v[156:159]
    s_sub_u32 s36, s36, 1
    s_cbranch_scc1 kf_fix11
kf_fixr12:
    s_waitcnt lgkmcnt(4)
    v_mfma_f32_16x16x32_bf16 v[48:51], a[192:195], a[160:163], v[80:83]
    ds_read_b128 a[240:243], v241 offset:28672
    ds_read_b128 a[244:247], v241 offset:29696
    v_mfma_f32_16x16x32_bf16 v[48:51], a[196:199], a[164:167], v[48:51]
    v_exp_f32 v128, v16
    v_mfma_f32_16x16x32_bf16 v[48:51], a[200:203], a[168:171], v[48:51]
    v_exp_f32_e64 v129, v17
    v_mfma_f32_16x16x32_bf16 v[48:51], a[204:207], a[172:175], v[48:51]
    s_waitcnt vmcnt(10)
    buffer_store_dwordx4 v[196:199], v255, s[48:51], s45 offen offset:256 sc1
    v_mfma_f32_16x16x32_bf16 v[56:59], a[192:195], a[176:179], v[88:91]
    ds_read_b128 a[248:251], v241 offset:30720
    ds_read_b128 a[252:255], v241 offset:31744
    v_mfma_f32_16x16x32_bf16 v[56:59], a[196:199], a[180:183], v[56:59]
    v_exp_f32 v130, v18
    v_mfma_f32_16x16x32_bf16 v[56:59], a[200:203], a[184:187], v[56:59]
    v_exp_f32_e64 v131, v19
    v_mfma_f32_16x16x32_bf16 v[56:59], a[204:207], a[188:191], v[56:59]
    v_exp_f32_e64 v132, v20
    v_mfma_f32_16x16x32_bf16 v[52:55], a[208:211], a[160:163], v[84:87]
    s_waitcnt vmcnt(14)
    s_barrier
    v_add_u32_e64 v241, s35, v240
    ds_read_b128 a[192:195], v241 offset:0
    v_mfma_f32_16x16x32_bf16 v[52:55], a[212:215], a[164:167], v[52:55]
    s_add_u32 m0, s34, 16384
    s_add_u32 s34, s34, 32768
    v_mfma_f32_16x16x32_bf16 v[52:55], a[216:219], a[168:171], v[52:55]
    ds_read_b128 a[196:199], v241 offset:2048
    v_cvt_pk_bf16_f32 v104, v128, v129
    v_mfma_f32_16x16x32_bf16 v[52:55], a[220:223], a[172:175], v[52:55]
    s_cmp_ge_u32 s34, 163840
    s_cselect_b32 s34, s37, s34
    v_mfma_f32_16x16x32_bf16 v[60:63], a[208:211], a[176:179], v[92:95]
    ds_read_b128 a[200:203], v241 offset:4096
    ds_read_b128 a[204:207], v241 offset:6144
    v_mfma_f32_16x16x32_bf16 v[60:63], a[212:215], a[180:183], v[60:63]
    v_exp_f32 v133, v21
    v_mfma_f32_16x16x32_bf16 v[60:63], a[216:219], a[184:187], v[60:63]
    v_exp_f32_e64 v134, v22
    v_mfma_f32_16x16x32_bf16 v[60:63], a[220:223], a[188:191], v[60:63]
    v_cvt_pk_bf16_f32 v105, v130, v131
    s_waitcnt lgkmcnt(4)
    v_mfma_f32_16x16x32_bf16 a[0:3], a[224:227], v[112:115], a[0:3]
    ds_read_b128 a[208:211], v241 offset:1024
    v_cvt_pk_bf16_f32 v106, v132, v133
    v_mfma_f32_16x16x32_bf16 a[32:35], a[224:227], v[116:119], a[32:35]
    buffer_load_dwordx4 v242, s[16:19], s42 offen offset:0 sc1 lds
    v_mfma_f32_16x16x32_bf16 a[64:67], a[224:227], v[120:123], a[64:67]
    v_exp_f32 v135, v23
    v_mfma_f32_16x16x32_bf16 a[96:99], a[224:227], v[124:127], a[96:99]
    v_exp_f32_e64 v136, v24
    v_mfma_f32_16x16x32_bf16 a[4:7], a[228:231], v[112:115], a[4:7]
    ds_read_b128 a[212:215], v241 offset:3072
    v_cvt_pk_bf16_f32 v107, v134, v135
    v_mfma_f32_16x16x32_bf16 a[36:39], a[228:231], v[116:119], a[36:39]
    v_exp_f32_e64 v137, v25
    v_mfma_f32_16x16x32_bf16 a[68:71], a[228:231], v[120:123], a[68:71]
    v_exp_f32_e64 v138, v26
    v_mfma_f32_16x16x32_bf16 a[100:103], a[228:231], v[124:127], a[100:103]
    v_exp_f32_e64 v139, v27
    v_mfma_f32_16x16x32_bf16 a[8:11], a[232:235], v[112:115], a[8:11]
    ds_read_b128 a[216:219], v241 offset:5120
    v_cvt_pk_bf16_f32 v108, v136, v137
    v_mfma_f32_16x16x32_bf16 a[40:43], a[232:235], v[116:119], a[40:43]
    buffer_load_dwordx4 v242, s[16:19], s42 offen offset:1024 sc1 lds
    v_cvt_pk_bf16_f32 v109, v138, v139
    v_mfma_f32_16x16x32_bf16 a[72:75], a[232:235], v[120:123], a[72:75]
    v_exp_f32_e64 v140, v28
    v_mfma_f32_16x16x32_bf16 a[104:107], a[232:235], v[124:127], a[104:107]
    v_exp_f32_e64 v141, v29
    v_mfma_f32_16x16x32_bf16 a[12:15], a[236:239], v[112:115], a[12:15]
    ds_read_b128 a[220:223], v241 offset:7168
    v_cvt_pk_bf16_f32 v110, v140, v141
    v_mfma_f32_16x16x32_bf16 a[44:47], a[236:239], v[116:119], a[44:47]
    v_exp_f32_e64 v142, v30
    v_mfma_f32_16x16x32_bf16 a[76:79], a[236:239], v[120:123], a[76:79]
    v_exp_f32_e64 v143, v31
    v_mfma_f32_16x16x32_bf16 a[108:111], a[236:239], v[124:127], a[108:111]
    v_cvt_pk_bf16_f32 v111, v142, v143
    buffer_load_dwordx4 v242, s[16:19], s42 offen offset:2048 sc1 lds
    v_mfma_f32_16x16x32_bf16 a[16:19], a[240:243], v[112:115], a[16:19]
    ds_read_b128 a[224:227], v241 offset:16384
    v_mfma_f32_16x16x32_bf16 a[48:51], a[240:243], v[116:119], a[48:51]
    v_mfma_f32_16x16x32_bf16 a[80:83], a[240:243], v[120:123], a[80:83]
    v_mfma_f32_16x16x32_bf16 a[112:115], a[240:243], v[124:127], a[112:115]
    v_mfma_f32_16x16x32_bf16 a[20:23], a[244:247], v[112:115], a[20:23]
    ds_read_b128 a[228:231], v241 offset:17408
    v_mfma_f32_16x16x32_bf16 a[52:55], a[244:247], v[116:119], a[52:55]
    buffer_load_dwordx4 v242, s[16:19], s42 offen offset:3072 sc1 lds
    s_add_u32 s42, s42, 34048
    v_mfma_f32_16x16x32_bf16 a[84:87], a[244:247], v[120:123], a[84:87]
    v_mfma_f32_16x16x32_bf16 a[116:119], a[244:247], v[124:127], a[116:119]
    v_mfma_f32_16x16x32_bf16 a[24:27], a[248:251], v[112:115], a[24:27]
    ds_read_b128 a[232:235], v241 offset:18432
    v_mfma_f32_16x16x32_bf16 a[56:59], a[248:251], v[116:119], a[56:59]
    v_mfma_f32_16x16x32_bf16 a[88:91], a[248:251], v[120:123], a[88:91]
    v_mfma_f32_16x16x32_bf16 a[120:123], a[248:251], v[124:127], a[120:123]
    v_mfma_f32_16x16x32_bf16 a[28:31], a[252:255], v[112:115], a[28:31]
    ds_read_b128 a[236:239], v241 offset:19456
    v_mfma_f32_16x16x32_bf16 a[60:63], a[252:255], v[116:119], a[60:63]
    v_mfma_f32_16x16x32_bf16 a[92:95], a[252:255], v[120:123], a[92:95]
    v_mfma_f32_16x16x32_bf16 a[124:127], a[252:255], v[124:127], a[124:127]
    v_mfma_f32_16x16x32_bf16 v[144:147], v[204:207], v[112:115], v[144:147]
    v_mfma_f32_16x16x32_bf16 v[148:151], v[204:207], v[116:119], v[148:151]
    v_mfma_f32_16x16x32_bf16 v[152:155], v[204:207], v[120:123], v[152:155]
    v_mfma_f32_16x16x32_bf16 v[156:159], v[204:207], v[124:127], v[156:159]
    s_nop 6
    v_rcp_f32 v230, v144
    v_rcp_f32_e64 v231, v148
    v_accvgpr_read_b32 v160, a0
    v_accvgpr_read_b32 v161, a1
    v_accvgpr_read_b32 v162, a2
    v_accvgpr_read_b32 v163, a3
    v_accvgpr_read_b32 v164, a4
    v_accvgpr_read_b32 v165, a5
    v_accvgpr_read_b32 v166, a6
    v_accvgpr_read_b32 v167, a7
    v_mul_f32 v160, v160, v230
    v_mul_f32 v161, v161, v230
    v_mul_f32 v162, v162, v230
    v_mul_f32 v163, v163, v230
    v_mul_f32 v164, v164, v230
    v_mul_f32 v165, v165, v230
    v_mul_f32 v166, v166, v230
    v_mul_f32 v167, v167, v230
    v_cvt_pk_bf16_f32 v176, v160, v161
    v_cvt_pk_bf16_f32 v177, v162, v163
    v_cvt_pk_bf16_f32 v178, v164, v165
    v_cvt_pk_bf16_f32 v179, v166, v167
    buffer_store_dwordx4 v[176:179], v240, s[20:23], s39 offen offset:0 sc1
    v_accvgpr_read_b32 v168, a8
    v_accvgpr_read_b32 v169, a9
    v_accvgpr_read_b32 v170, a10
    v_accvgpr_read_b32 v171, a11
    v_accvgpr_read_b32 v172, a12
    v_accvgpr_read_b32 v173, a13
    v_accvgpr_read_b32 v174, a14
    v_accvgpr_read_b32 v175, a15
    v_mul_f32 v168, v168, v230
    v_mul_f32 v169, v169, v230
    v_mul_f32 v170, v170, v230
    v_mul_f32 v171, v171, v230
    v_mul_f32 v172, v172, v230
    v_mul_f32 v173, v173, v230
    v_mul_f32 v174, v174, v230
    v_mul_f32 v175, v175, v230
    v_cvt_pk_bf16_f32 v180, v168, v169
    v_cvt_pk_bf16_f32 v181, v170, v171
    v_cvt_pk_bf16_f32 v182, v172, v173
    v_cvt_pk_bf16_f32 v183, v174, v175
    buffer_store_dwordx4 v[180:183], v240, s[20:23], s39 offen offset:1024 sc1
    v_accvgpr_read_b32 v160, a16
    v_accvgpr_read_b32 v161, a17
    v_accvgpr_read_b32 v162, a18
    v_accvgpr_read_b32 v163, a19
    v_accvgpr_read_b32 v164, a20
    v_accvgpr_read_b32 v165, a21
    v_accvgpr_read_b32 v166, a22
    v_accvgpr_read_b32 v167, a23
    v_mul_f32 v160, v160, v230
    v_mul_f32 v161, v161, v230
    v_mul_f32 v162, v162, v230
    v_mul_f32 v163, v163, v230
    v_mul_f32 v164, v164, v230
    v_mul_f32 v165, v165, v230
    v_mul_f32 v166, v166, v230
    v_mul_f32 v167, v167, v230
    v_cvt_pk_bf16_f32 v184, v160, v161
    v_cvt_pk_bf16_f32 v185, v162, v163
    v_cvt_pk_bf16_f32 v186, v164, v165
    v_cvt_pk_bf16_f32 v187, v166, v167
    buffer_store_dwordx4 v[184:187], v240, s[20:23], s39 offen offset:2048 sc1
    v_accvgpr_read_b32 v168, a24
    v_accvgpr_read_b32 v169, a25
    v_accvgpr_read_b32 v170, a26
    v_accvgpr_read_b32 v171, a27
    v_accvgpr_read_b32 v172, a28
    v_accvgpr_read_b32 v173, a29
    v_accvgpr_read_b32 v174, a30
    v_accvgpr_read_b32 v175, a31
    v_mul_f32 v168, v168, v230
    v_mul_f32 v169, v169, v230
    v_mul_f32 v170, v170, v230
    v_mul_f32 v171, v171, v230
    v_mul_f32 v172, v172, v230
    v_mul_f32 v173, v173, v230
    v_mul_f32 v174, v174, v230
    v_mul_f32 v175, v175, v230
    v_cvt_pk_bf16_f32 v188, v168, v169
    v_cvt_pk_bf16_f32 v189, v170, v171
    v_cvt_pk_bf16_f32 v190, v172, v173
    v_cvt_pk_bf16_f32 v191, v174, v175
    buffer_store_dwordx4 v[188:191], v240, s[20:23], s39 offen offset:3072 sc1
    v_accvgpr_read_b32 v160, a32
    v_accvgpr_read_b32 v161, a33
    v_accvgpr_read_b32 v162, a34
    v_accvgpr_read_b32 v163, a35
    v_accvgpr_read_b32 v164, a36
    v_accvgpr_read_b32 v165, a37
    v_accvgpr_read_b32 v166, a38
    v_accvgpr_read_b32 v167, a39
    v_mul_f32 v160, v160, v231
    v_mul_f32 v161, v161, v231
    v_mul_f32 v162, v162, v231
    v_mul_f32 v163, v163, v231
    v_mul_f32 v164, v164, v231
    v_mul_f32 v165, v165, v231
    v_mul_f32 v166, v166, v231
    v_mul_f32 v167, v167, v231
    v_cvt_pk_bf16_f32 v176, v160, v161
    v_cvt_pk_bf16_f32 v177, v162, v163
    v_cvt_pk_bf16_f32 v178, v164, v165
    v_cvt_pk_bf16_f32 v179, v166, v167
    buffer_store_dwordx4 v[176:179], v244, s[20:23], s39 offen offset:0 sc1
    v_accvgpr_read_b32 v168, a40
    v_accvgpr_read_b32 v169, a41
    v_accvgpr_read_b32 v170, a42
    v_accvgpr_read_b32 v171, a43
    v_accvgpr_read_b32 v172, a44
    v_accvgpr_read_b32 v173, a45
    v_accvgpr_read_b32 v174, a46
    v_accvgpr_read_b32 v175, a47
    v_mul_f32 v168, v168, v231
    v_mul_f32 v169, v169, v231
    v_mul_f32 v170, v170, v231
    v_mul_f32 v171, v171, v231
    v_mul_f32 v172, v172, v231
    v_mul_f32 v173, v173, v231
    v_mul_f32 v174, v174, v231
    v_mul_f32 v175, v175, v231
    v_cvt_pk_bf16_f32 v180, v168, v169
    v_cvt_pk_bf16_f32 v181, v170, v171
    v_cvt_pk_bf16_f32 v182, v172, v173
    v_cvt_pk_bf16_f32 v183, v174, v175
    buffer_store_dwordx4 v[180:183], v244, s[20:23], s39 offen offset:1024 sc1
    v_accvgpr_read_b32 v160, a48
    v_accvgpr_read_b32 v161, a49
    v_accvgpr_read_b32 v162, a50
    v_accvgpr_read_b32 v163, a51
    v_accvgpr_read_b32 v164, a52
    v_accvgpr_read_b32 v165, a53
    v_accvgpr_read_b32 v166, a54
    v_accvgpr_read_b32 v167, a55
    v_mul_f32 v160, v160, v231
    v_mul_f32 v161, v161, v231
    v_mul_f32 v162, v162, v231
    v_mul_f32 v163, v163, v231
    v_mul_f32 v164, v164, v231
    v_mul_f32 v165, v165, v231
    v_mul_f32 v166, v166, v231
    v_mul_f32 v167, v167, v231
    v_cvt_pk_bf16_f32 v184, v160, v161
    v_cvt_pk_bf16_f32 v185, v162, v163
    v_cvt_pk_bf16_f32 v186, v164, v165
    v_cvt_pk_bf16_f32 v187, v166, v167
    buffer_store_dwordx4 v[184:187], v244, s[20:23], s39 offen offset:2048 sc1
    v_accvgpr_read_b32 v168, a56
    v_accvgpr_read_b32 v169, a57
    v_accvgpr_read_b32 v170, a58
    v_accvgpr_read_b32 v171, a59
    v_accvgpr_read_b32 v172, a60
    v_accvgpr_read_b32 v173, a61
    v_accvgpr_read_b32 v174, a62
    v_accvgpr_read_b32 v175, a63
    v_mul_f32 v168, v168, v231
    v_mul_f32 v169, v169, v231
    v_mul_f32 v170, v170, v231
    v_mul_f32 v171, v171, v231
    v_mul_f32 v172, v172, v231
    v_mul_f32 v173, v173, v231
    v_mul_f32 v174, v174, v231
    v_mul_f32 v175, v175, v231
    v_cvt_pk_bf16_f32 v188, v168, v169
    v_cvt_pk_bf16_f32 v189, v170, v171
    v_cvt_pk_bf16_f32 v190, v172, v173
    v_cvt_pk_bf16_f32 v191, v174, v175
    buffer_store_dwordx4 v[188:191], v244, s[20:23], s39 offen offset:3072 sc1
    s_lshl1_add_u32 s26, s5, s31
    s_lshl_b32 s26, s26, 1
    s_sub_u32 s26, 30, s26
    s_branch ka_p2_e
.p2align 5
ka_p2:
    s_sub_u32 s36, s36, 1
    s_cbranch_scc1 kf_fix13
kf_fixr14:
    s_waitcnt lgkmcnt(4)
    v_mfma_f32_16x16x32_bf16 v[16:19], a[192:195], a[160:163], v[80:83]
    ds_read_b128 a[240:243], v241 offset:20480
    ds_read_b128 a[244:247], v241 offset:21504
    v_mfma_f32_16x16x32_bf16 v[16:19], a[196:199], a[164:167], v[16:19]
    v_exp_f32 v128, v48
    v_mfma_f32_16x16x32_bf16 v[16:19], a[200:203], a[168:171], v[16:19]
    v_exp_f32_e64 v129, v49
    v_mfma_f32_16x16x32_bf16 v[16:19], a[204:207], a[172:175], v[16:19]
    v_exp_f32_e64 v130, v50
    v_mfma_f32_16x16x32_bf16 v[24:27], a[192:195], a[176:179], v[88:91]
    ds_read_b128 a[248:251], v241 offset:22528
    ds_read_b128 a[252:255], v241 offset:23552
    v_mfma_f32_16x16x32_bf16 v[24:27], a[196:199], a[180:183], v[24:27]
    s_mov_b32 m0, s34
    s_add_u32 s41, s42, 17664
    v_mfma_f32_16x16x32_bf16 v[24:27], a[200:203], a[184:187], v[24:27]
    v_exp_f32 v131, v51
    v_mfma_f32_16x16x32_bf16 v[24:27], a[204:207], a[188:191], v[24:27]
    v_exp_f32_e64 v132, v52
    v_mfma_f32_16x16x32_bf16 v[20:23], a[208:211], a[160:163], v[84:87]
    ds_read_b128 a[192:195], v241 offset:8192
    ds_read_b128 a[196:199], v241 offset:10240
    v_mfma_f32_16x16x32_bf16 v[20:23], a[212:215], a[164:167], v[20:23]
    buffer_load_dwordx4 v242, s[16:19], s41 offen offset:0 sc1 lds
    v_cvt_pk_bf16_f32 v120, v128, v129
    v_mfma_f32_16x16x32_bf16 v[20:23], a[216:219], a[168:171], v[20:23]
    v_exp_f32_e64 v133, v53
    v_mfma_f32_16x16x32_bf16 v[20:23], a[220:223], a[172:175], v[20:23]
    v_exp_f32_e64 v134, v54
    v_mfma_f32_16x16x32_bf16 v[28:31], a[208:211], a[176:179], v[92:95]
    ds_read_b128 a[200:203], v241 offset:12288
    ds_read_b128 a[204:207], v241 offset:14336
    v_mfma_f32_16x16x32_bf16 v[28:31], a[212:215], a[180:183], v[28:31]
    v_exp_f32_e64 v135, v55
    v_mfma_f32_16x16x32_bf16 v[28:31], a[216:219], a[184:187], v[28:31]
    buffer_load_dwordx4 v242, s[16:19], s41 offen offset:1024 sc1 lds
    v_cvt_pk_bf16_f32 v121, v130, v131
    v_mfma_f32_16x16x32_bf16 v[28:31], a[220:223], a[188:191], v[28:31]
    v_cvt_pk_bf16_f32 v122, v132, v133
    s_waitcnt lgkmcnt(4)
    v_mfma_f32_16x16x32_bf16 a[64:67], a[224:227], v[104:107], a[64:67]
    ds_read_b128 a[208:211], v241 offset:9216
    ds_read_b128 a[212:215], v241 offset:11264
    v_mfma_f32_16x16x32_bf16 a[96:99], a[224:227], v[108:111], a[96:99]
    v_exp_f32 v136, v56
    v_mfma_f32_16x16x32_bf16 a[68:71], a[228:231], v[104:107], a[68:71]
    v_exp_f32_e64 v137, v57
    v_mfma_f32_16x16x32_bf16 a[100:103], a[228:231], v[108:111], a[100:103]
    buffer_load_dwordx4 v242, s[16:19], s41 offen offset:2048 sc1 lds
    v_cvt_pk_bf16_f32 v123, v134, v135
    v_mfma_f32_16x16x32_bf16 a[72:75], a[232:235], v[104:107], a[72:75]
    ds_read_b128 a[216:219], v241 offset:13312
    ds_read_b128 a[220:223], v241 offset:15360
    v_mfma_f32_16x16x32_bf16 a[104:107], a[232:235], v[108:111], a[104:107]
    v_exp_f32_e64 v138, v58
    v_mfma_f32_16x16x32_bf16 a[76:79], a[236:239], v[104:107], a[76:79]
    v_exp_f32_e64 v139, v59
    v_mfma_f32_16x16x32_bf16 a[108:111], a[236:239], v[108:111], a[108:111]
    v_exp_f32_e64 v140, v60
    v_mfma_f32_16x16x32_bf16 a[80:83], a[240:243], v[104:107], a[80:83]
    ds_read_b128 a[224:227], v241 offset:24576
    ds_read_b128 a[228:231], v241 offset:25600
    v_mfma_f32_16x16x32_bf16 a[112:115], a[240:243], v[108:111], a[112:115]
    buffer_load_dwordx4 v242, s[16:19], s41 offen offset:3072 sc1 lds
    v_cvt_pk_bf16_f32 v124, v136, v137
    v_mfma_f32_16x16x32_bf16 a[84:87], a[244:247], v[104:107], a[84:87]
    v_exp_f32_e64 v141, v61
    v_mfma_f32_16x16x32_bf16 a[116:119], a[244:247], v[108:111], a[116:119]
    v_exp_f32_e64 v142, v62
    v_mfma_f32_16x16x32_bf16 a[88:91], a[248:251], v[104:107], a[88:91]
    ds_read_b128 a[232:235], v241 offset:26624
    ds_read_b128 a[236:239], v241 offset:27648
    v_mfma_f32_16x16x32_bf16 a[120:123], a[248:251], v[108:111], a[120:123]
    s_add_u32 s35, s35, 32768
    v_cvt_pk_bf16_f32 v125, v138, v139
    v_mfma_f32_16x16x32_bf16 a[92:95], a[252:255], v[104:107], a[92:95]
    s_cmp_ge_u32 s35, 163840
    s_cselect_b32 s35, 0, s35
    v_mfma_f32_16x16x32_bf16 a[124:127], a[252:255], v[108:111], a[124:127]
    v_exp_f32 v143, v63
    v_mfma_f32_16x16x32_bf16 v[152:155], v[204:207], v[104:107], v[152:155]
    v_cvt_pk_bf16_f32 v126, v140, v141
    v_cvt_pk_bf16_f32 v127, v142, v143
    v_mfma_f32_16x16x32_bf16 v[156:159], v[204:207], v[108:111], v[156:159]
    s_sub_u32 s36, s36, 1
    s_cbranch_scc1 kf_fix15
kf_fixr16:
    s_waitcnt lgkmcnt(4)
    v_mfma_f32_16x16x32_bf16 v[48:51], a[192:195], a[160:163], v[80:83]
    ds_read_b128 a[240:243], v241 offset:28672
    ds_read_b128 a[244:247], v241 offset:29696
    v_mfma_f32_16x16x32_bf16 v[48:51], a[196:199], a[164:167], v[48:51]
    v_exp_f32 v128, v16
    v_mfma_f32_16x16x32_bf16 v[48:51], a[200:203], a[168:171], v[48:51]
    v_exp_f32_e64 v129, v17
    v_mfma_f32_16x16x32_bf16 v[48:51], a[204:207], a[172:175], v[48:51]
    v_exp_f32_e64 v130, v18
    v_mfma_f32_16x16x32_bf16 v[56:59], a[192:195], a[176:179], v[88:91]
    ds_read_b128 a[248:251], v241 offset:30720
    ds_read_b128 a[252:255], v241 offset:31744
    v_mfma_f32_16x16x32_bf16 v[56:59], a[196:199], a[180:183], v[56:59]
    s_add_u32 m0, s34, 16384
    s_add_u32 s34, s34, 32768
    v_mfma_f32_16x16x32_bf16 v[56:59], a[200:203], a[184:187], v[56:59]
    s_cmp_ge_u32 s34, 163840
    s_cselect_b32 s34, s37, s34
    v_mfma_f32_16x16x32_bf16 v[56:59], a[204:207], a[188:191], v[56:59]
    v_exp_f32 v131, v19
    v_mfma_f32_16x16x32_bf16 v[52:55], a[208:211], a[160:163], v[84:87]
    s_waitcnt vmcnt(12)
    s_barrier
    v_add_u32_e64 v241, s35, v240
    ds_read_b128 a[192:195], v241 offset:0
    v_mfma_f32_16x16x32_bf16 v[52:55], a[212:215], a[164:167], v[52:55]
    v_exp_f32_e64 v132, v20
    v_mfma_f32_16x16x32_bf16 v[52:55], a[216:219], a[168:171], v[52:55]
    ds_read_b128 a[196:199], v241 offset:2048
    buffer_load_dwordx4 v242, s[16:19], s42 offen offset:0 sc1 lds
    v_mfma_f32_16x16x32_bf16 v[52:55], a[220:223], a[172:175], v[52:55]
    v_exp_f32_e64 v133, v21
    v_mfma_f32_16x16x32_bf16 v[60:63], a[208:211], a[176:179], v[92:95]
    ds_read_b128 a[200:203], v241 offset:4096
    ds_read_b128 a[204:207], v241 offset:6144
    v_mfma_f32_16x16x32_bf16 v[60:63], a[212:215], a[180:183], v[60:63]
    v_exp_f32_e64 v134, v22
    v_mfma_f32_16x16x32_bf16 v[60:63], a[216:219], a[184:187], v[60:63]
    v_exp_f32_e64 v135, v23
    v_mfma_f32_16x16x32_bf16 v[60:63], a[220:223], a[188:191], v[60:63]
    buffer_load_dwordx4 v242, s[16:19], s42 offen offset:1024 sc1 lds
    s_waitcnt lgkmcnt(4)
    v_mfma_f32_16x16x32_bf16 a[64:67], a[224:227], v[120:123], a[64:67]
    ds_read_b128 a[208:211], v241 offset:1024
    ds_read_b128 a[212:215], v241 offset:3072
    v_mfma_f32_16x16x32_bf16 a[96:99], a[224:227], v[124:127], a[96:99]
    v_cvt_pk_bf16_f32 v104, v128, v129
    v_exp_f32 v136, v24
    v_mfma_f32_16x16x32_bf16 a[68:71], a[228:231], v[120:123], a[68:71]
    v_exp_f32_e64 v137, v25
    v_mfma_f32_16x16x32_bf16 a[100:103], a[228:231], v[124:127], a[100:103]
    v_cvt_pk_bf16_f32 v105, v130, v131
    buffer_load_dwordx4 v242, s[16:19], s42 offen offset:2048 sc1 lds
    v_mfma_f32_16x16x32_bf16 a[72:75], a[232:235], v[120:123], a[72:75]
    ds_read_b128 a[216:219], v241 offset:5120
    ds_read_b128 a[220:223], v241 offset:7168
    v_mfma_f32_16x16x32_bf16 a[104:107], a[232:235], v[124:127], a[104:107]
    v_exp_f32_e64 v138, v26
    v_mfma_f32_16x16x32_bf16 a[76:79], a[236:239], v[120:123], a[76:79]
    v_exp_f32_e64 v139, v27
    v_mfma_f32_16x16x32_bf16 a[108:111], a[236:239], v[124:127], a[108:111]
    v_cvt_pk_bf16_f32 v106, v132, v133
    v_cvt_pk_bf16_f32 v107, v134, v135
    v_mfma_f32_16x16x32_bf16 a[80:83], a[240:243], v[120:123], a[80:83]
    ds_read_b128 a[224:227], v241 offset:16384
    ds_read_b128 a[228:231], v241 offset:17408
    v_mfma_f32_16x16x32_bf16 a[112:115], a[240:243], v[124:127], a[112:115]
    v_exp_f32_e64 v140, v28
    v_mfma_f32_16x16x32_bf16 a[84:87], a[244:247], v[120:123], a[84:87]
    v_exp_f32_e64 v141, v29
    v_mfma_f32_16x16x32_bf16 a[116:119], a[244:247], v[124:127], a[116:119]
    v_exp_f32_e64 v142, v30
    v_mfma_f32_16x16x32_bf16 a[88:91], a[248:251], v[120:123], a[88:91]
    ds_read_b128 a[232:235], v241 offset:18432
    ds_read_b128 a[236:239], v241 offset:19456
    v_mfma_f32_16x16x32_bf16 a[120:123], a[248:251], v[124:127], a[120:123]
    buffer_load_dwordx4 v242, s[16:19], s42 offen offset:3072 sc1 lds
    s_add_u32 s42, s42, 34048
    v_mfma_f32_16x16x32_bf16 a[92:95], a[252:255], v[120:123], a[92:95]
    v_exp_f32_e64 v143, v31
    v_mfma_f32_16x16x32_bf16 a[124:127], a[252:255], v[124:127], a[124:127]
    v_cvt_pk_bf16_f32 v108, v136, v137
    v_cvt_pk_bf16_f32 v109, v138, v139
    v_mfma_f32_16x16x32_bf16 v[152:155], v[204:207], v[120:123], v[152:155]
    v_cvt_pk_bf16_f32 v110, v140, v141
    v_cvt_pk_bf16_f32 v111, v142, v143
    v_mfma_f32_16x16x32_bf16 v[156:159], v[204:207], v[124:127], v[156:159]
ka_p2_e:
    s_sub_u32 s26, s26, 1
    s_cbranch_scc0 ka_p2
    s_branch ka_p2_x
kf_fix13:
    s_mov_b32 s24, 0
    s_branch kf_fix13c
kf_fix15:
    s_mov_b32 s24, 1
kf_fix13c:
    s_cmp_eq_u32 s33, 0
    s_cbranch_scc0 kf_fix13f
    s_mov_b32 s36, 0
    s_mov_b32 s33, 1
    v_add_f32 v80, v226, v200
    v_add_f32 v81, v226, v201
    v_add_f32 v82, v226, v202
    v_add_f32 v83, v226, v203
    v_add_f32 v84, v226, v209
    v_add_f32 v85, v226, v210
    v_add_f32 v86, v226, v211
    v_add_f32 v87, v226, v212
    v_add_f32 v88, v227, v213
    v_add_f32 v89, v227, v214
    v_add_f32 v90, v227, v215
    v_add_f32 v91, v227, v216
    v_add_f32 v92, v227, v217
    v_add_f32 v93, v227, v218
    v_add_f32 v94, v227, v219
    v_add_f32_e64 v95, v227, v220
    s_cmp_eq_u32 s24, 0
    s_cbranch_scc1 kf_fixr14
    s_branch kf_fixr16
kf_fix13f:
    s_mov_b32 s36, 0x1000
    v_mov_b32 v80, 0xf1800000
    v_mov_b32 v81, v80
    v_mov_b32 v82, v80
    v_mov_b32 v83, v80
    v_mov_b32 v84, v80
    v_mov_b32 v85, v80
    v_mov_b32 v86, v80
    v_mov_b32 v87, v80
    v_mov_b32 v88, v80
    v_mov_b32 v89, v80
    v_mov_b32 v90, v80
    v_mov_b32 v91, v80
    v_mov_b32 v92, v80
    v_mov_b32 v93, v80
    v_mov_b32 v94, v80
    v_mov_b32_e64 v95, v80
    s_cmp_eq_u32 s24, 0
    s_cbranch_scc1 kf_fixr14
    s_branch kf_fixr16
ka_p2_x:
    s_waitcnt lgkmcnt(0)
    ds_read_b128 a[224:227], v241 offset:16384
    ds_read_b128 a[228:231], v241 offset:17408
    ds_read_b128 a[232:235], v241 offset:18432
    ds_read_b128 a[236:239], v241 offset:19456
    ds_read_b128 a[240:243], v241 offset:20480
    ds_read_b128 a[244:247], v241 offset:21504
    ds_read_b128 a[248:251], v241 offset:22528
    ds_read_b128 a[252:255], v241 offset:23552
    ds_read_b128 a[192:195], v241 offset:24576
    ds_read_b128 a[196:199], v241 offset:25600
    ds_read_b128 a[200:203], v241 offset:26624
    ds_read_b128 a[204:207], v241 offset:27648
    ds_read_b128 a[208:211], v241 offset:28672
    ds_read_b128 a[212:215], v241 offset:29696
    ds_read_b128 a[216:219], v241 offset:30720
    s_waitcnt lgkmcnt(7)
    ds_read_b128 a[220:223], v241 offset:31744
    v_mfma_f32_16x16x32_bf16 a[64:67], a[224:227], v[104:107], a[64:67]
    v_exp_f32 v128, v48
    v_mfma_f32_16x16x32_bf16 a[96:99], a[224:227], v[108:111], a[96:99]
    v_exp_f32_e64 v129, v49
    v_mfma_f32_16x16x32_bf16 a[68:71], a[228:231], v[104:107], a[68:71]
    v_exp_f32_e64 v130, v50
    v_mfma_f32_16x16x32_bf16 a[100:103], a[228:231], v[108:111], a[100:103]
    v_exp_f32_e64 v131, v51
    v_cvt_pk_bf16_f32 v120, v128, v129
    v_mfma_f32_16x16x32_bf16 a[72:75], a[232:235], v[104:107], a[72:75]
    v_exp_f32_e64 v132, v52
    v_mfma_f32_16x16x32_bf16 a[104:107], a[232:235], v[108:111], a[104:107]
    v_exp_f32_e64 v133, v53
    v_mfma_f32_16x16x32_bf16 a[76:79], a[236:239], v[104:107], a[76:79]
    v_exp_f32_e64 v134, v54
    v_cvt_pk_bf16_f32 v121, v130, v131
    v_mfma_f32_16x16x32_bf16 a[108:111], a[236:239], v[108:111], a[108:111]
    v_exp_f32_e64 v135, v55
    v_mfma_f32_16x16x32_bf16 a[80:83], a[240:243], v[104:107], a[80:83]
    v_exp_f32_e64 v136, v56
    v_cvt_pk_bf16_f32 v122, v132, v133
    v_mfma_f32_16x16x32_bf16 a[112:115], a[240:243], v[108:111], a[112:115]
    v_exp_f32_e64 v137, v57
    v_mfma_f32_16x16x32_bf16 a[84:87], a[244:247], v[104:107], a[84:87]
    v_exp_f32_e64 v138, v58
    v_mfma_f32_16x16x32_bf16 a[116:119], a[244:247], v[108:111], a[116:119]
    v_exp_f32_e64 v139, v59
    v_cvt_pk_bf16_f32 v123, v134, v135
    v_mfma_f32_16x16x32_bf16 a[88:91], a[248:251], v[104:107], a[88:91]
    v_exp_f32_e64 v140, v60
    v_mfma_f32_16x16x32_bf16 a[120:123], a[248:251], v[108:111], a[120:123]
    v_exp_f32_e64 v141, v61
    v_cvt_pk_bf16_f32 v124, v136, v137
    v_mfma_f32_16x16x32_bf16 a[92:95], a[252:255], v[104:107], a[92:95]
    v_exp_f32_e64 v142, v62
    v_mfma_f32_16x16x32_bf16 a[124:127], a[252:255], v[108:111], a[124:127]
    v_exp_f32_e64 v143, v63
    v_mfma_f32_16x16x32_bf16 v[152:155], v[204:207], v[104:107], v[152:155]
    v_cvt_pk_bf16_f32 v125, v138, v139
    v_cvt_pk_bf16_f32 v126, v140, v141
    v_cvt_pk_bf16_f32 v127, v142, v143
    v_mfma_f32_16x16x32_bf16 v[156:159], v[204:207], v[108:111], v[156:159]
    s_waitcnt lgkmcnt(0)
    s_nop 0
    v_mfma_f32_16x16x32_bf16 a[64:67], a[192:195], v[120:123], a[64:67]
    v_mfma_f32_16x16x32_bf16 a[96:99], a[192:195], v[124:127], a[96:99]
    v_mfma_f32_16x16x32_bf16 a[68:71], a[196:199], v[120:123], a[68:71]
    v_mfma_f32_16x16x32_bf16 a[100:103], a[196:199], v[124:127], a[100:103]
    v_mfma_f32_16x16x32_bf16 a[72:75], a[200:203], v[120:123], a[72:75]
    v_mfma_f32_16x16x32_bf16 a[104:107], a[200:203], v[124:127], a[104:107]
    v_mfma_f32_16x16x32_bf16 a[76:79], a[204:207], v[120:123], a[76:79]
    v_mfma_f32_16x16x32_bf16 a[108:111], a[204:207], v[124:127], a[108:111]
    v_mfma_f32_16x16x32_bf16 a[80:83], a[208:211], v[120:123], a[80:83]
    v_mfma_f32_16x16x32_bf16 a[112:115], a[208:211], v[124:127], a[112:115]
    v_mfma_f32_16x16x32_bf16 a[84:87], a[212:215], v[120:123], a[84:87]
    v_mfma_f32_16x16x32_bf16 a[116:119], a[212:215], v[124:127], a[116:119]
    v_mfma_f32_16x16x32_bf16 a[88:91], a[216:219], v[120:123], a[88:91]
    v_mfma_f32_16x16x32_bf16 a[120:123], a[216:219], v[124:127], a[120:123]
    v_mfma_f32_16x16x32_bf16 a[92:95], a[220:223], v[120:123], a[92:95]
    v_mfma_f32_16x16x32_bf16 a[124:127], a[220:223], v[124:127], a[124:127]
    v_mfma_f32_16x16x32_bf16 v[152:155], v[204:207], v[120:123], v[152:155]
    v_mfma_f32_16x16x32_bf16 v[156:159], v[204:207], v[124:127], v[156:159]
    s_cmp_eq_u32 s31, 0
    s_cbranch_scc1 ka_nox
    s_waitcnt vmcnt(8)
    s_barrier
ka_nox:
    s_nop 6
    v_rcp_f32 v230, v152
    v_rcp_f32_e64 v231, v156
    v_accvgpr_read_b32 v160, a64
    v_accvgpr_read_b32 v161, a65
    v_accvgpr_read_b32 v162, a66
    v_accvgpr_read_b32 v163, a67
    v_accvgpr_read_b32 v164, a68
    v_accvgpr_read_b32 v165, a69
    v_accvgpr_read_b32 v166, a70
    v_accvgpr_read_b32 v167, a71
    v_mul_f32 v160, v160, v230
    v_mul_f32 v161, v161, v230
    v_mul_f32 v162, v162, v230
    v_mul_f32 v163, v163, v230
    v_mul_f32 v164, v164, v230
    v_mul_f32 v165, v165, v230
    v_mul_f32 v166, v166, v230
    v_mul_f32 v167, v167, v230
    v_cvt_pk_bf16_f32 v176, v160, v161
    v_cvt_pk_bf16_f32 v177, v162, v163
    v_cvt_pk_bf16_f32 v178, v164, v165
    v_cvt_pk_bf16_f32 v179, v166, v167
    buffer_store_dwordx4 v[176:179], v240, s[20:23], s40 offen offset:0 sc1
    v_accvgpr_read_b32 v168, a72
    v_accvgpr_read_b32 v169, a73
    v_accvgpr_read_b32 v170, a74
    v_accvgpr_read_b32 v171, a75
    v_accvgpr_read_b32 v172, a76
    v_accvgpr_read_b32 v173, a77
    v_accvgpr_read_b32 v174, a78
    v_accvgpr_read_b32 v175, a79
    v_mul_f32 v168, v168, v230
    v_mul_f32 v169, v169, v230
    v_mul_f32 v170, v170, v230
    v_mul_f32 v171, v171, v230
    v_mul_f32 v172, v172, v230
    v_mul_f32 v173, v173, v230
    v_mul_f32 v174, v174, v230
    v_mul_f32 v175, v175, v230
    v_cvt_pk_bf16_f32 v180, v168, v169
    v_cvt_pk_bf16_f32 v181, v170, v171
    v_cvt_pk_bf16_f32 v182, v172, v173
    v_cvt_pk_bf16_f32 v183, v174, v175
    buffer_store_dwordx4 v[180:183], v240, s[20:23], s40 offen offset:1024 sc1
    v_accvgpr_read_b32 v160, a80
    v_accvgpr_read_b32 v161, a81
    v_accvgpr_read_b32 v162, a82
    v_accvgpr_read_b32 v163, a83
    v_accvgpr_read_b32 v164, a84
    v_accvgpr_read_b32 v165, a85
    v_accvgpr_read_b32 v166, a86
    v_accvgpr_read_b32 v167, a87
    v_mul_f32 v160, v160, v230
    v_mul_f32 v161, v161, v230
    v_mul_f32 v162, v162, v230
    v_mul_f32 v163, v163, v230
    v_mul_f32 v164, v164, v230
    v_mul_f32 v165, v165, v230
    v_mul_f32 v166, v166, v230
    v_mul_f32 v167, v167, v230
    v_cvt_pk_bf16_f32 v184, v160, v161
    v_cvt_pk_bf16_f32 v185, v162, v163
    v_cvt_pk_bf16_f32 v186, v164, v165
    v_cvt_pk_bf16_f32 v187, v166, v167
    buffer_store_dwordx4 v[184:187], v240, s[20:23], s40 offen offset:2048 sc1
    v_accvgpr_read_b32 v168, a88
    v_accvgpr_read_b32 v169, a89
    v_accvgpr_read_b32 v170, a90
    v_accvgpr_read_b32 v171, a91
    v_accvgpr_read_b32 v172, a92
    v_accvgpr_read_b32 v173, a93
    v_accvgpr_read_b32 v174, a94
    v_accvgpr_read_b32 v175, a95
    v_mul_f32 v168, v168, v230
    v_mul_f32 v169, v169, v230
    v_mul_f32 v170, v170, v230
    v_mul_f32 v171, v171, v230
    v_mul_f32 v172, v172, v230
    v_mul_f32 v173, v173, v230
    v_mul_f32 v174, v174, v230
    v_mul_f32 v175, v175, v230
    v_cvt_pk_bf16_f32 v188, v168, v169
    v_cvt_pk_bf16_f32 v189, v170, v171
    v_cvt_pk_bf16_f32 v190, v172, v173
    v_cvt_pk_bf16_f32 v191, v174, v175
    buffer_store_dwordx4 v[188:191], v240, s[20:23], s40 offen offset:3072 sc1
    v_accvgpr_read_b32 v160, a96
    v_accvgpr_read_b32 v161, a97
    v_accvgpr_read_b32 v162, a98
    v_accvgpr_read_b32 v163, a99
    v_accvgpr_read_b32 v164, a100
    v_accvgpr_read_b32 v165, a101
    v_accvgpr_read_b32 v166, a102
    v_accvgpr_read_b32 v167, a103
    v_mul_f32 v160, v160, v231
    v_mul_f32 v161, v161, v231
    v_mul_f32 v162, v162, v231
    v_mul_f32 v163, v163, v231
    v_mul_f32 v164, v164, v231
    v_mul_f32 v165, v165, v231
    v_mul_f32 v166, v166, v231
    v_mul_f32 v167, v167, v231
    v_cvt_pk_bf16_f32 v176, v160, v161
    v_cvt_pk_bf16_f32 v177, v162, v163
    v_cvt_pk_bf16_f32 v178, v164, v165
    v_cvt_pk_bf16_f32 v179, v166, v167
    buffer_store_dwordx4 v[176:179], v244, s[20:23], s40 offen offset:0 sc1
    v_accvgpr_read_b32 v168, a104
    v_accvgpr_read_b32 v169, a105
    v_accvgpr_read_b32 v170, a106
    v_accvgpr_read_b32 v171, a107
    v_accvgpr_read_b32 v172, a108
    v_accvgpr_read_b32 v173, a109
    v_accvgpr_read_b32 v174, a110
    v_accvgpr_read_b32 v175, a111
    v_mul_f32 v168, v168, v231
    v_mul_f32 v169, v169, v231
    v_mul_f32 v170, v170, v231
    v_mul_f32 v171, v171, v231
    v_mul_f32 v172, v172, v231
    v_mul_f32 v173, v173, v231
    v_mul_f32 v174, v174, v231
    v_mul_f32 v175, v175, v231
    v_cvt_pk_bf16_f32 v180, v168, v169
    v_cvt_pk_bf16_f32 v181, v170, v171
    v_cvt_pk_bf16_f32 v182, v172, v173
    v_cvt_pk_bf16_f32 v183, v174, v175
    buffer_store_dwordx4 v[180:183], v244, s[20:23], s40 offen offset:1024 sc1
    v_accvgpr_read_b32 v160, a112
    v_accvgpr_read_b32 v161, a113
    v_accvgpr_read_b32 v162, a114
    v_accvgpr_read_b32 v163, a115
    v_accvgpr_read_b32 v164, a116
    v_accvgpr_read_b32 v165, a117
    v_accvgpr_read_b32 v166, a118
    v_accvgpr_read_b32 v167, a119
    v_mul_f32 v160, v160, v231
    v_mul_f32 v161, v161, v231
    v_mul_f32 v162, v162, v231
    v_mul_f32 v163, v163, v231
    v_mul_f32 v164, v164, v231
    v_mul_f32 v165, v165, v231
    v_mul_f32 v166, v166, v231
    v_mul_f32 v167, v167, v231
    v_cvt_pk_bf16_f32 v184, v160, v161
    v_cvt_pk_bf16_f32 v185, v162, v163
    v_cvt_pk_bf16_f32 v186, v164, v165
    v_cvt_pk_bf16_f32 v187, v166, v167
    buffer_store_dwordx4 v[184:187], v244, s[20:23], s40 offen offset:2048 sc1
    v_accvgpr_read_b32 v168, a120
    v_accvgpr_read_b32 v169, a121
    v_accvgpr_read_b32 v170, a122
    v_accvgpr_read_b32 v171, a123
    v_accvgpr_read_b32 v172, a124
    v_accvgpr_read_b32 v173, a125
    v_accvgpr_read_b32 v174, a126
    v_accvgpr_read_b32 v175, a127
    v_mul_f32 v168, v168, v231
    v_mul_f32 v169, v169, v231
    v_mul_f32 v170, v170, v231
    v_mul_f32 v171, v171, v231
    v_mul_f32 v172, v172, v231
    v_mul_f32 v173, v173, v231
    v_mul_f32 v174, v174, v231
    v_mul_f32 v175, v175, v231
    v_cvt_pk_bf16_f32 v188, v168, v169
    v_cvt_pk_bf16_f32 v189, v170, v171
    v_cvt_pk_bf16_f32 v190, v172, v173
    v_cvt_pk_bf16_f32 v191, v174, v175
    buffer_store_dwordx4 v[188:191], v244, s[20:23], s40 offen offset:3072 sc1
    s_mov_b32 s24, 0x5d800000
    v_cmp_nlt_f32 s[42:43], v144, s24
    v_cmp_nlt_f32 vcc, v148, s24
    s_or_b64 s[42:43], s[42:43], vcc
    v_cmp_nlt_f32 vcc, v152, s24
    s_or_b64 s[42:43], s[42:43], vcc
    v_cmp_nlt_f32 vcc, v156, s24
    s_or_b64 s[42:43], s[42:43], vcc
    s_cselect_b32 s24, 1, 0
    s_lshl_b32 s25, s31, 15
    s_add_u32 s25, s25, s35
    s_cmp_ge_u32 s25, 163840
    s_cselect_b32 s25, 0, s25
    v_mov_b32 v230, s25
    s_lshl2_add_u32 s25, s3, s25
    v_mov_b32 v231, s25
    v_mov_b32_e64 v232, s24
    ds_write_b32 v231, v232
    s_waitcnt lgkmcnt(0)
    s_barrier
    ds_read_b128 v[128:131], v230
    s_waitcnt lgkmcnt(0)
    v_or3_b32 v128, v128, v129, v130
    v_or_b32 v128, v128, v131
    v_cmp_ne_u32 vcc, 0, v128
    s_cbranch_vccnz ka_redo
ka_ok:
    s_sub_u32 s46, s20, 0x2400000
    s_subb_u32 s47, s21, 0
    s_mov_b64 s[42:43], s[56:57]
    s_mov_b64 s[40:41], s[80:81]
    s_mov_b64 s[44:45], s[82:83]
    s_mov_b64 s[60:61], s[84:85]
    s_mov_b64 s[62:63], s[86:87]
    v_mbcnt_lo_u32_b32 v237, -1, 0
    v_mbcnt_hi_u32_b32 v237, -1, v237
    s_lshl_b32 s32, s3, 6
    v_add_u32 v230, s32, v237
    s_lshr_b32 s53, s2, 3
    s_lshr_b32 s6, s2, 1
    s_and_b32 s6, s6, 3
    s_and_b32 s4, s2, 1
    s_lshl_b32 s4, s4, 2
    s_and_b32 s33, s53, 3
    s_add_u32 s4, s4, s33
    s_lshr_b32 s5, s53, 2
    v_lshlrev_b32 v228, 4, v237
    v_lshrrev_b32 v234, 4, v237
    v_and_b32 v235, 15, v237
    v_lshlrev_b32 v236, 1, v234
    v_xor_b32 v235, v235, v236
    v_lshlrev_b32 v234, 11, v234
    s_lshl_b32 s32, s3, 14
    s_lshl_b32 s33, s5, 8
    s_add_u32 s32, s32, s33
    v_add_u32 v234, s32, v234
    v_lshl_add_u32 v224, v235, 4, v234
    v_xor_b32_e64 v235, 8, v235
    v_lshl_add_u32 v225, v235, 4, v234
    v_add_u32 v225, 7168, v225
    s_lshl_b32 s37, s6, 21
    s_lshl_b32 s38, s3, 11
    s_lshl2_add_u32 s4, s4, s3
    s_sub_u32 s32, 63, s4
    s_cmp_lt_u32 s6, 2
    s_cselect_b32 s4, s4, s32
    s_lshl_b32 s32, s4, 18
    v_add_u32 v226, s32, v228
    v_add_u32 v227, 0x20000, v226
    v_xor_b32 v245, 0xfc0000, v226
    v_xor_b32 v246, 0xfc0000, v227
    s_lshl_b32 s35, s6, 15
    s_add_u32 s35, s35, 0x2400000
    s_getpc_b64 s[56:57]
kc_pc0:
    s_mov_b32 s58, kc_end-kc_pc0
    s_mov_b32 s59, 0x00020000
    v_lshlrev_b32_e64 v234, 7, v230
    buffer_load_dword v241, v234, s[56:59], 0 offen
    s_waitcnt lgkmcnt(0)
    s_mov_b32 s8, s46
    s_mov_b32 s9, s47
    s_mov_b32 s10, 0x10000000
    s_mov_b32 s11, 0x00020000
    s_mov_b32 s12, s42
    s_mov_b32 s13, s43
    s_mov_b32 s14, 0x800000
    s_mov_b32 s15, 0x00020000
    s_mov_b32 s16, s40
    s_mov_b32 s17, s41
    s_mov_b32 s18, 0x400000
    s_mov_b32 s19, 0x00020000
    s_mov_b32 s20, s44
    s_mov_b32 s21, s45
    s_mov_b32 s22, 0x800
    s_mov_b32 s23, 0x00020000
    s_mov_b32 s24, s60
    s_mov_b32 s25, s61
    s_mov_b32 s26, 0x700000
    s_mov_b32 s27, 0x00020000
    s_mov_b32 s28, s62
    s_mov_b32 s29, s63
    s_mov_b32 s30, 0x400000
    s_mov_b32 s31, 0x00020000
    s_lshr_b32 s44, s6, 1
    s_and_b32 s6, s6, 1
    v_bfe_u32 v234, v237, 2, 3
    v_lshrrev_b32 v235, 5, v237
    v_lshl_add_u32 v235, v235, 4, v234
    v_lshlrev_b32 v235, 8, v235
    v_and_b32 v236, 1, v237
    v_lshl_add_u32 v235, v236, 3, v235
    v_lshlrev_b32_e64 v234, 1, v234
    v_bfe_u32 v236, v237, 1, 1
    v_or_b32 v234, v234, v236
    s_lshl_b32 s32, s6, 3
    v_xor_b32 v234, s32, v234
    v_xor_b32 v236, 0, v234
    v_lshl_add_u32 v216, v236, 4, v235
    v_xor_b32_e64 v236, 2, v234
    v_lshl_add_u32 v217, v236, 4, v235
    v_xor_b32_e64 v236, 4, v234
    v_lshl_add_u32 v218, v236, 4, v235
    v_xor_b32_e64 v236, 6, v234
    v_lshl_add_u32 v219, v236, 4, v235
    v_xor_b32_e64 v236, 8, v234
    v_lshl_add_u32 v220, v236, 4, v235
    v_xor_b32_e64 v236, 10, v234
    v_lshl_add_u32 v221, v236, 4, v235
    v_xor_b32_e64 v236, 12, v234
    v_lshl_add_u32 v222, v236, 4, v235
    v_xor_b32_e64 v236, 14, v234
    v_lshl_add_u32 v223, v236, 4, v235
    s_lshl_b32 s44, s4, 5
    v_lshrrev_b32 v234, 3, v237
    v_add_u32 v242, s44, v234
    v_and_b32 v235, 7, v237
    s_lshl1_add_u32 s33, s5, s6
    s_lshl_b32 s33, s33, 7
    v_lshl_add_u32 v240, v235, 4, s33
    v_lshl_add_u32 v229, v242, 11, v240
    s_mul_i32 s32, s3, 4608
    s_add_u32 s32, s32, 131072
    v_mul_u32_u24 v234, 144, v234
    v_lshl_add_u32 v234, v235, 4, v234
    v_add_u32 v239, s32, v234
    v_and_b32 v234, 15, v237
    v_mul_u32_u24 v234, 144, v234
    v_lshrrev_b32_e64 v236, 4, v237
    v_lshl_add_u32 v234, v236, 3, v234
    v_add_u32 v238, s32, v234
    v_and_b32 v234, 3, v237
    v_lshl_add_u32 v234, v234, 3, v242
    v_lshlrev_b32 v234, 2, v234
    v_lshrrev_b32 v235, 2, v235
    v_lshl_add_u32 v231, v235, 13, v234
    v_lshlrev_b32_e64 v235, 30, v235
    v_add_u32 v235, 16384, v235
    v_add_u32 v232, v235, v234
    s_cmp_eq_u32 s44, 0
    s_cselect_b32 s32, 4, 64
    v_cmp_eq_u32 vcc, s32, v237
    v_mov_b32 v235, 24576
    v_mov_b32 v233, 1
    v_cndmask_b32 v232, v232, v235, vcc
    v_and_b32_e64 v234, 1, v237
    v_cmp_ne_u32 s[60:61], 0, v234
    v_and_b32_e64 v234, 2, v237
    v_cmp_ne_u32 s[62:63], 0, v234
    v_and_b32_e64 v234, 4, v237
    v_cmp_ne_u32 s[40:41], 0, v234
    v_cmp_eq_u32 vcc, 0, v237
    v_mov_b32_e64 v235, 0x40000000
    s_nop 0
    v_cndmask_b32 v243, v235, v237, vcc
    s_lshl2_add_u32 s39, s2, s3
    s_mov_b32 s48, 0x3800000
    s_mov_b32 s49, 0x3802000
    s_mov_b32 s50, 0x3804000
    s_and_b32 s52, s2, 7
    s_mul_i32 s54, s52, 28
    s_add_u32 s54, s54, s53
    v_lshrrev_b32 v234, 3, v237
    v_lshlrev_b32 v234, 11, v234
    v_and_b32 v235, 7, v237
    v_lshl_add_u32 v244, v235, 4, v234
    s_lshl_b32 s55, s54, 16
    s_lshl_b32 s32, s3, 13
    s_add_u32 s55, s55, s32
    s_add_u32 s55, s55, 0x4000000
    s_lshl_b32 s51, s54, 15
    s_lshl_b32 s32, s3, 9
    s_add_u32 s51, s51, s32
    s_cmp_ge_u32 s53, 28
    s_cselect_b32 s55, 0x40000000, s55
    s_cselect_b32 s51, 0x40000000, s51
    s_lshr_b32 s32, s2, 5
    s_lshl_b32 s32, s32, 9
    s_and_b32 s33, s2, 6
    s_lshl_b32 s33, s33, 6
    s_add_u32 s32, s32, s33
    s_add_u32 s32, s32, 0x38a4000
    s_waitcnt vmcnt(0)
    s_barrier
    s_cmp_lg_u32 s3, 0
    s_cbranch_scc1 kc_a0
    buffer_atomic_add v233, v243, s[8:11], s32 offen sc1
    s_lshl_b32 s32, s52, 7
    s_add_u32 s32, s32, 0x38a1000
    v_mov_b32 v235, 1
    buffer_atomic_add v235, v243, s[8:11], s32 offen sc0 sc1
    v_lshlrev_b32 v234, 7, v237
    v_cmp_gt_u32 vcc, 8, v237
    v_mov_b32_e64 v236, 0x40000000
    s_mov_b32 s34, 0x38a1400
    v_cndmask_b32 v234, v236, v234, vcc
    s_waitcnt vmcnt(0)
    v_readfirstlane_b32 s36, v235
    s_cmp_lg_u32 s36, 31
    s_cbranch_scc1 kc_a0
    buffer_atomic_add v233, v234, s[8:11], s34 offen sc1
kc_a0:
    s_add_u32 m0, s38, 0
    s_add_u32 s32, s37, 0
    buffer_load_dwordx4 v224, s[12:15], s32 offen lds
    buffer_load_dwordx4 v225, s[12:15], s32 offen offset:1024 lds
    s_add_u32 m0, s38, 8192
    s_add_u32 s32, s37, 65536
    buffer_load_dwordx4 v224, s[12:15], s32 offen lds
    buffer_load_dwordx4 v225, s[12:15], s32 offen offset:1024 lds
    s_add_u32 m0, s38, 16384
    s_add_u32 s32, s37, 131072
    buffer_load_dwordx4 v224, s[12:15], s32 offen lds
    buffer_load_dwordx4 v225, s[12:15], s32 offen offset:1024 lds
    s_add_u32 m0, s38, 24576
    s_add_u32 s32, s37, 196608
    buffer_load_dwordx4 v224, s[12:15], s32 offen lds
    buffer_load_dwordx4 v225, s[12:15], s32 offen offset:1024 lds
    s_add_u32 m0, s38, 32768
    s_add_u32 s32, s37, 262144
    buffer_load_dwordx4 v224, s[12:15], s32 offen lds
    buffer_load_dwordx4 v225, s[12:15], s32 offen offset:1024 lds
    s_add_u32 m0, s38, 40960
    s_add_u32 s32, s37, 327680
    buffer_load_dwordx4 v224, s[12:15], s32 offen lds
    buffer_load_dwordx4 v225, s[12:15], s32 offen offset:1024 lds
    s_add_u32 m0, s38, 49152
    s_add_u32 s32, s37, 393216
    buffer_load_dwordx4 v224, s[12:15], s32 offen lds
    buffer_load_dwordx4 v225, s[12:15], s32 offen offset:1024 lds
    s_add_u32 m0, s38, 57344
    s_add_u32 s32, s37, 458752
    buffer_load_dwordx4 v224, s[12:15], s32 offen lds
    buffer_load_dwordx4 v225, s[12:15], s32 offen offset:1024 lds
    s_add_u32 m0, s38, 65536
    s_add_u32 s32, s37, 524288
    buffer_load_dwordx4 v224, s[12:15], s32 offen lds
    buffer_load_dwordx4 v225, s[12:15], s32 offen offset:1024 lds
    s_add_u32 m0, s38, 73728
    s_add_u32 s32, s37, 589824
    buffer_load_dwordx4 v224, s[12:15], s32 offen lds
    buffer_load_dwordx4 v225, s[12:15], s32 offen offset:1024 lds
    s_add_u32 m0, s38, 81920
    s_add_u32 s32, s37, 655360
    buffer_load_dwordx4 v224, s[12:15], s32 offen lds
    buffer_load_dwordx4 v225, s[12:15], s32 offen offset:1024 lds
    s_add_u32 m0, s38, 90112
    s_add_u32 s32, s37, 720896
    buffer_load_dwordx4 v224, s[12:15], s32 offen lds
    buffer_load_dwordx4 v225, s[12:15], s32 offen offset:1024 lds
    s_add_u32 m0, s38, 98304
    s_add_u32 s32, s37, 786432
    buffer_load_dwordx4 v224, s[12:15], s32 offen lds
    buffer_load_dwordx4 v225, s[12:15], s32 offen offset:1024 lds
    s_add_u32 m0, s38, 106496
    s_add_u32 s32, s37, 851968
    buffer_load_dwordx4 v224, s[12:15], s32 offen lds
    buffer_load_dwordx4 v225, s[12:15], s32 offen offset:1024 lds
    s_add_u32 m0, s38, 114688
    s_add_u32 s32, s37, 917504
    buffer_load_dwordx4 v224, s[12:15], s32 offen lds
    buffer_load_dwordx4 v225, s[12:15], s32 offen offset:1024 lds
    s_add_u32 m0, s38, 122880
    s_add_u32 s32, s37, 983040
    buffer_load_dwordx4 v224, s[12:15], s32 offen lds
    buffer_load_dwordx4 v225, s[12:15], s32 offen offset:1024 lds
    s_add_u32 s33, s51, 0
    buffer_load_dwordx4 a[192:195], v244, s[24:27], s33 offen offset:0
    s_add_u32 s33, s51, 16384
    buffer_load_dwordx4 a[196:199], v244, s[24:27], s33 offen offset:0
    s_add_u32 s33, s51, 0
    buffer_load_dwordx4 a[200:203], v244, s[24:27], s33 offen offset:128
    s_add_u32 s33, s51, 16384
    buffer_load_dwordx4 a[204:207], v244, s[24:27], s33 offen offset:128
    s_add_u32 s33, s51, 0
    buffer_load_dwordx4 a[208:211], v244, s[24:27], s33 offen offset:256
    s_add_u32 s33, s51, 16384
    buffer_load_dwordx4 a[212:215], v244, s[24:27], s33 offen offset:256
    s_add_u32 s33, s51, 0
    buffer_load_dwordx4 a[216:219], v244, s[24:27], s33 offen offset:384
    s_add_u32 s33, s51, 16384
    buffer_load_dwordx4 a[220:223], v244, s[24:27], s33 offen offset:384
    s_cmp_lg_u32 s3, 0
    s_cbranch_scc1 kc_b03
    s_and_b32 s32, s2, 1
    s_lshl_b32 s32, s32, 2
    s_and_b32 s33, s53, 3
    s_add_u32 s32, s32, s33
    s_lshl_b32 s32, s32, 9
    s_and_b32 s33, s2, 6
    s_lshl_b32 s33, s33, 6
    s_add_u32 s32, s32, s33
    s_add_u32 s32, s32, 0x38a4000
    s_mov_b32 s34, 0x100000
    s_branch kc_b01
kc_b00:
    s_sleep 2
kc_b01:
    buffer_load_dword v235, off, s[8:11], s32 sc1
    s_waitcnt vmcnt(0)
    v_cmp_ne_u32 vcc, 8, v235
    s_sub_u32 s34, s34, 1
    s_cbranch_scc1 kc_b02
    s_cbranch_vccnz kc_b00
kc_b02:
kc_b03:
    s_waitcnt vmcnt(8)
    s_barrier
    buffer_load_dwordx4 a[0:3], v226, s[8:11], s35 offen offset:0 sc1
    buffer_load_dwordx4 a[4:7], v227, s[8:11], s35 offen offset:0 sc1
    buffer_load_dwordx4 a[8:11], v245, s[8:11], s35 offen offset:0 sc1
    buffer_load_dwordx4 a[12:15], v246, s[8:11], s35 offen offset:0 sc1
    buffer_load_dwordx4 a[16:19], v226, s[8:11], s35 offen offset:1024 sc1
    buffer_load_dwordx4 a[20:23], v227, s[8:11], s35 offen offset:1024 sc1
    buffer_load_dwordx4 a[24:27], v245, s[8:11], s35 offen offset:1024 sc1
    buffer_load_dwordx4 a[28:31], v246, s[8:11], s35 offen offset:1024 sc1
    buffer_load_dwordx4 a[32:35], v226, s[8:11], s35 offen offset:2048 sc1
    buffer_load_dwordx4 a[36:39], v227, s[8:11], s35 offen offset:2048 sc1
    buffer_load_dwordx4 a[40:43], v245, s[8:11], s35 offen offset:2048 sc1
    buffer_load_dwordx4 a[44:47], v246, s[8:11], s35 offen offset:2048 sc1
    buffer_load_dwordx4 a[48:51], v226, s[8:11], s35 offen offset:3072 sc1
    buffer_load_dwordx4 a[52:55], v227, s[8:11], s35 offen offset:3072 sc1
    buffer_load_dwordx4 a[56:59], v245, s[8:11], s35 offen offset:3072 sc1
    buffer_load_dwordx4 a[60:63], v246, s[8:11], s35 offen offset:3072 sc1
    ds_read_b64_tr_b16 v[128:129], v216 offset:0
    ds_read_b64_tr_b16 v[130:131], v216 offset:2048
    ds_read_b64_tr_b16 v[132:133], v217 offset:0
    ds_read_b64_tr_b16 v[134:135], v217 offset:2048
    ds_read_b64_tr_b16 v[136:137], v218 offset:0
    ds_read_b64_tr_b16 v[138:139], v218 offset:2048
    ds_read_b64_tr_b16 v[140:141], v219 offset:0
    ds_read_b64_tr_b16 v[142:143], v219 offset:2048
    s_waitcnt vmcnt(12) lgkmcnt(0)
    v_mfma_f32_16x16x32_bf16 v[32:35], v[128:131], a[0:3], 0
    ds_read_b64_tr_b16 v[144:145], v220 offset:0
    v_mfma_f32_16x16x32_bf16 v[36:39], v[128:131], a[4:7], 0
    ds_read_b64_tr_b16 v[146:147], v220 offset:2048
    v_mfma_f32_16x16x32_bf16 v[64:67], v[128:131], a[8:11], 0
    ds_read_b64_tr_b16 v[148:149], v221 offset:0
    v_mfma_f32_16x16x32_bf16 v[68:71], v[128:131], a[12:15], 0
    ds_read_b64_tr_b16 v[150:151], v221 offset:2048
    v_mfma_f32_16x16x32_bf16 v[40:43], v[132:135], a[0:3], 0
    ds_read_b64_tr_b16 v[152:153], v222 offset:0
    v_mfma_f32_16x16x32_bf16 v[44:47], v[132:135], a[4:7], 0
    ds_read_b64_tr_b16 v[154:155], v222 offset:2048
    v_mfma_f32_16x16x32_bf16 v[72:75], v[132:135], a[8:11], 0
    ds_read_b64_tr_b16 v[156:157], v223 offset:0
    v_mfma_f32_16x16x32_bf16 v[76:79], v[132:135], a[12:15], 0
    ds_read_b64_tr_b16 v[158:159], v223 offset:2048
    v_mfma_f32_16x16x32_bf16 v[48:51], v[136:139], a[0:3], 0
    s_add_u32 s35, s35, 4096
    buffer_load_dwordx4 a[64:67], v226, s[8:11], s35 offen offset:0 sc1
    v_mfma_f32_16x16x32_bf16 v[52:55], v[136:139], a[4:7], 0
    v_mfma_f32_16x16x32_bf16 v[80:83], v[136:139], a[8:11], 0
    v_mfma_f32_16x16x32_bf16 v[84:87], v[136:139], a[12:15], 0
    buffer_load_dwordx4 a[68:71], v227, s[8:11], s35 offen offset:0 sc1
    v_mfma_f32_16x16x32_bf16 v[56:59], v[140:143], a[0:3], 0
    v_mfma_f32_16x16x32_bf16 v[60:63], v[140:143], a[4:7], 0
    v_mfma_f32_16x16x32_bf16 v[88:91], v[140:143], a[8:11], 0
    v_mfma_f32_16x16x32_bf16 v[92:95], v[140:143], a[12:15], 0
    buffer_load_dwordx4 a[72:75], v245, s[8:11], s35 offen offset:0 sc1
    s_waitcnt lgkmcnt(0)
    v_mfma_f32_16x16x32_bf16 v[0:3], v[144:147], a[0:3], 0
    ds_read_b64_tr_b16 v[128:129], v216 offset:8192
    v_mfma_f32_16x16x32_bf16 v[4:7], v[144:147], a[4:7], 0
    ds_read_b64_tr_b16 v[130:131], v216 offset:10240
    v_mfma_f32_16x16x32_bf16 v[96:99], v[144:147], a[8:11], 0
    ds_read_b64_tr_b16 v[132:133], v217 offset:8192
    v_mfma_f32_16x16x32_bf16 v[100:103], v[144:147], a[12:15], 0
    ds_read_b64_tr_b16 v[134:135], v217 offset:10240
    v_mfma_f32_16x16x32_bf16 v[8:11], v[148:151], a[0:3], 0
    ds_read_b64_tr_b16 v[136:137], v218 offset:8192
    v_mfma_f32_16x16x32_bf16 v[12:15], v[148:151], a[4:7], 0
    ds_read_b64_tr_b16 v[138:139], v218 offset:10240
    v_mfma_f32_16x16x32_bf16 v[104:107], v[148:151], a[8:11], 0
    ds_read_b64_tr_b16 v[140:141], v219 offset:8192
    v_mfma_f32_16x16x32_bf16 v[108:111], v[148:151], a[12:15], 0
    ds_read_b64_tr_b16 v[142:143], v219 offset:10240
    v_mfma_f32_16x16x32_bf16 v[16:19], v[152:155], a[0:3], 0
    buffer_load_dwordx4 a[76:79], v246, s[8:11], s35 offen offset:0 sc1
    v_mfma_f32_16x16x32_bf16 v[20:23], v[152:155], a[4:7], 0
    v_mfma_f32_16x16x32_bf16 v[112:115], v[152:155], a[8:11], 0
    buffer_load_dwordx4 a[80:83], v226, s[8:11], s35 offen offset:1024 sc1
    v_mfma_f32_16x16x32_bf16 v[116:119], v[152:155], a[12:15], 0
    v_mfma_f32_16x16x32_bf16 v[24:27], v[156:159], a[0:3], 0
    v_mfma_f32_16x16x32_bf16 v[28:31], v[156:159], a[4:7], 0
    v_mfma_f32_16x16x32_bf16 v[120:123], v[156:159], a[8:11], 0
    v_mfma_f32_16x16x32_bf16 v[124:127], v[156:159], a[12:15], 0
    s_waitcnt vmcnt(13) lgkmcnt(0)
    v_mfma_f32_16x16x32_bf16 v[32:35], v[128:131], a[16:19], v[32:35]
    ds_read_b64_tr_b16 v[144:145], v220 offset:8192
    v_mfma_f32_16x16x32_bf16 v[36:39], v[128:131], a[20:23], v[36:39]
    ds_read_b64_tr_b16 v[146:147], v220 offset:10240
    v_mfma_f32_16x16x32_bf16 v[64:67], v[128:131], a[24:27], v[64:67]
    ds_read_b64_tr_b16 v[148:149], v221 offset:8192
    v_mfma_f32_16x16x32_bf16 v[68:71], v[128:131], a[28:31], v[68:71]
    ds_read_b64_tr_b16 v[150:151], v221 offset:10240
    v_mfma_f32_16x16x32_bf16 v[40:43], v[132:135], a[16:19], v[40:43]
    ds_read_b64_tr_b16 v[152:153], v222 offset:8192
    v_mfma_f32_16x16x32_bf16 v[44:47], v[132:135], a[20:23], v[44:47]
    ds_read_b64_tr_b16 v[154:155], v222 offset:10240
    v_mfma_f32_16x16x32_bf16 v[72:75], v[132:135], a[24:27], v[72:75]
    ds_read_b64_tr_b16 v[156:157], v223 offset:8192
    v_mfma_f32_16x16x32_bf16 v[76:79], v[132:135], a[28:31], v[76:79]
    ds_read_b64_tr_b16 v[158:159], v223 offset:10240
    v_mfma_f32_16x16x32_bf16 v[48:51], v[136:139], a[16:19], v[48:51]
    buffer_load_dwordx4 a[84:87], v227, s[8:11], s35 offen offset:1024 sc1
    v_mfma_f32_16x16x32_bf16 v[52:55], v[136:139], a[20:23], v[52:55]
    v_mfma_f32_16x16x32_bf16 v[80:83], v[136:139], a[24:27], v[80:83]
    v_mfma_f32_16x16x32_bf16 v[84:87], v[136:139], a[28:31], v[84:87]
    buffer_load_dwordx4 a[88:91], v245, s[8:11], s35 offen offset:1024 sc1
    v_mfma_f32_16x16x32_bf16 v[56:59], v[140:143], a[16:19], v[56:59]
    v_mfma_f32_16x16x32_bf16 v[60:63], v[140:143], a[20:23], v[60:63]
    v_mfma_f32_16x16x32_bf16 v[88:91], v[140:143], a[24:27], v[88:91]
    v_mfma_f32_16x16x32_bf16 v[92:95], v[140:143], a[28:31], v[92:95]
    buffer_load_dwordx4 a[92:95], v246, s[8:11], s35 offen offset:1024 sc1
    s_waitcnt lgkmcnt(0)
    v_mfma_f32_16x16x32_bf16 v[0:3], v[144:147], a[16:19], v[0:3]
    ds_read_b64_tr_b16 v[128:129], v216 offset:16384
    v_mfma_f32_16x16x32_bf16 v[4:7], v[144:147], a[20:23], v[4:7]
    ds_read_b64_tr_b16 v[130:131], v216 offset:18432
    v_mfma_f32_16x16x32_bf16 v[96:99], v[144:147], a[24:27], v[96:99]
    ds_read_b64_tr_b16 v[132:133], v217 offset:16384
    v_mfma_f32_16x16x32_bf16 v[100:103], v[144:147], a[28:31], v[100:103]
    ds_read_b64_tr_b16 v[134:135], v217 offset:18432
    v_mfma_f32_16x16x32_bf16 v[8:11], v[148:151], a[16:19], v[8:11]
    ds_read_b64_tr_b16 v[136:137], v218 offset:16384
    v_mfma_f32_16x16x32_bf16 v[12:15], v[148:151], a[20:23], v[12:15]
    ds_read_b64_tr_b16 v[138:139], v218 offset:18432
    v_mfma_f32_16x16x32_bf16 v[104:107], v[148:151], a[24:27], v[104:107]
    ds_read_b64_tr_b16 v[140:141], v219 offset:16384
    v_mfma_f32_16x16x32_bf16 v[108:111], v[148:151], a[28:31], v[108:111]
    ds_read_b64_tr_b16 v[142:143], v219 offset:18432
    v_mfma_f32_16x16x32_bf16 v[16:19], v[152:155], a[16:19], v[16:19]
    buffer_load_dwordx4 a[96:99], v226, s[8:11], s35 offen offset:2048 sc1
    v_mfma_f32_16x16x32_bf16 v[20:23], v[152:155], a[20:23], v[20:23]
    v_mfma_f32_16x16x32_bf16 v[112:115], v[152:155], a[24:27], v[112:115]
    v_mfma_f32_16x16x32_bf16 v[116:119], v[152:155], a[28:31], v[116:119]
    v_mfma_f32_16x16x32_bf16 v[24:27], v[156:159], a[16:19], v[24:27]
    buffer_load_dwordx4 a[100:103], v227, s[8:11], s35 offen offset:2048 sc1
    v_mfma_f32_16x16x32_bf16 v[28:31], v[156:159], a[20:23], v[28:31]
    v_mfma_f32_16x16x32_bf16 v[120:123], v[156:159], a[24:27], v[120:123]
    v_mfma_f32_16x16x32_bf16 v[124:127], v[156:159], a[28:31], v[124:127]
    s_waitcnt vmcnt(14) lgkmcnt(0)
    v_mfma_f32_16x16x32_bf16 v[32:35], v[128:131], a[32:35], v[32:35]
    ds_read_b64_tr_b16 v[144:145], v220 offset:16384
    v_mfma_f32_16x16x32_bf16 v[36:39], v[128:131], a[36:39], v[36:39]
    ds_read_b64_tr_b16 v[146:147], v220 offset:18432
    v_mfma_f32_16x16x32_bf16 v[64:67], v[128:131], a[40:43], v[64:67]
    ds_read_b64_tr_b16 v[148:149], v221 offset:16384
    v_mfma_f32_16x16x32_bf16 v[68:71], v[128:131], a[44:47], v[68:71]
    ds_read_b64_tr_b16 v[150:151], v221 offset:18432
    v_mfma_f32_16x16x32_bf16 v[40:43], v[132:135], a[32:35], v[40:43]
    ds_read_b64_tr_b16 v[152:153], v222 offset:16384
    v_mfma_f32_16x16x32_bf16 v[44:47], v[132:135], a[36:39], v[44:47]
    ds_read_b64_tr_b16 v[154:155], v222 offset:18432
    v_mfma_f32_16x16x32_bf16 v[72:75], v[132:135], a[40:43], v[72:75]
    ds_read_b64_tr_b16 v[156:157], v223 offset:16384
    v_mfma_f32_16x16x32_bf16 v[76:79], v[132:135], a[44:47], v[76:79]
    ds_read_b64_tr_b16 v[158:159], v223 offset:18432
    v_mfma_f32_16x16x32_bf16 v[48:51], v[136:139], a[32:35], v[48:51]
    buffer_load_dwordx4 a[104:107], v245, s[8:11], s35 offen offset:2048 sc1
    v_mfma_f32_16x16x32_bf16 v[52:55], v[136:139], a[36:39], v[52:55]
    v_mfma_f32_16x16x32_bf16 v[80:83], v[136:139], a[40:43], v[80:83]
    v_mfma_f32_16x16x32_bf16 v[84:87], v[136:139], a[44:47], v[84:87]
    buffer_load_dwordx4 a[108:111], v246, s[8:11], s35 offen offset:2048 sc1
    v_mfma_f32_16x16x32_bf16 v[56:59], v[140:143], a[32:35], v[56:59]
    v_mfma_f32_16x16x32_bf16 v[60:63], v[140:143], a[36:39], v[60:63]
    v_mfma_f32_16x16x32_bf16 v[88:91], v[140:143], a[40:43], v[88:91]
    v_mfma_f32_16x16x32_bf16 v[92:95], v[140:143], a[44:47], v[92:95]
    buffer_load_dwordx4 a[112:115], v226, s[8:11], s35 offen offset:3072 sc1
    s_waitcnt lgkmcnt(0)
    v_mfma_f32_16x16x32_bf16 v[0:3], v[144:147], a[32:35], v[0:3]
    ds_read_b64_tr_b16 v[128:129], v216 offset:24576
    v_mfma_f32_16x16x32_bf16 v[4:7], v[144:147], a[36:39], v[4:7]
    ds_read_b64_tr_b16 v[130:131], v216 offset:26624
    v_mfma_f32_16x16x32_bf16 v[96:99], v[144:147], a[40:43], v[96:99]
    ds_read_b64_tr_b16 v[132:133], v217 offset:24576
    v_mfma_f32_16x16x32_bf16 v[100:103], v[144:147], a[44:47], v[100:103]
    ds_read_b64_tr_b16 v[134:135], v217 offset:26624
    v_mfma_f32_16x16x32_bf16 v[8:11], v[148:151], a[32:35], v[8:11]
    ds_read_b64_tr_b16 v[136:137], v218 offset:24576
    v_mfma_f32_16x16x32_bf16 v[12:15], v[148:151], a[36:39], v[12:15]
    ds_read_b64_tr_b16 v[138:139], v218 offset:26624
    v_mfma_f32_16x16x32_bf16 v[104:107], v[148:151], a[40:43], v[104:107]
    ds_read_b64_tr_b16 v[140:141], v219 offset:24576
    v_mfma_f32_16x16x32_bf16 v[108:111], v[148:151], a[44:47], v[108:111]
    ds_read_b64_tr_b16 v[142:143], v219 offset:26624
    v_mfma_f32_16x16x32_bf16 v[16:19], v[152:155], a[32:35], v[16:19]
    buffer_load_dwordx4 a[116:119], v227, s[8:11], s35 offen offset:3072 sc1
    v_mfma_f32_16x16x32_bf16 v[20:23], v[152:155], a[36:39], v[20:23]
    v_mfma_f32_16x16x32_bf16 v[112:115], v[152:155], a[40:43], v[112:115]
    v_mfma_f32_16x16x32_bf16 v[116:119], v[152:155], a[44:47], v[116:119]
    v_mfma_f32_16x16x32_bf16 v[24:27], v[156:159], a[32:35], v[24:27]
    buffer_load_dwordx4 a[120:123], v245, s[8:11], s35 offen offset:3072 sc1
    v_mfma_f32_16x16x32_bf16 v[28:31], v[156:159], a[36:39], v[28:31]
    v_mfma_f32_16x16x32_bf16 v[120:123], v[156:159], a[40:43], v[120:123]
    v_mfma_f32_16x16x32_bf16 v[124:127], v[156:159], a[44:47], v[124:127]
    s_waitcnt vmcnt(15) lgkmcnt(0)
    v_mfma_f32_16x16x32_bf16 v[32:35], v[128:131], a[48:51], v[32:35]
    ds_read_b64_tr_b16 v[144:145], v220 offset:24576
    v_mfma_f32_16x16x32_bf16 v[36:39], v[128:131], a[52:55], v[36:39]
    ds_read_b64_tr_b16 v[146:147], v220 offset:26624
    v_mfma_f32_16x16x32_bf16 v[64:67], v[128:131], a[56:59], v[64:67]
    ds_read_b64_tr_b16 v[148:149], v221 offset:24576
    v_mfma_f32_16x16x32_bf16 v[68:71], v[128:131], a[60:63], v[68:71]
    ds_read_b64_tr_b16 v[150:151], v221 offset:26624
    v_mfma_f32_16x16x32_bf16 v[40:43], v[132:135], a[48:51], v[40:43]
    ds_read_b64_tr_b16 v[152:153], v222 offset:24576
    v_mfma_f32_16x16x32_bf16 v[44:47], v[132:135], a[52:55], v[44:47]
    ds_read_b64_tr_b16 v[154:155], v222 offset:26624
    v_mfma_f32_16x16x32_bf16 v[72:75], v[132:135], a[56:59], v[72:75]
    ds_read_b64_tr_b16 v[156:157], v223 offset:24576
    v_mfma_f32_16x16x32_bf16 v[76:79], v[132:135], a[60:63], v[76:79]
    ds_read_b64_tr_b16 v[158:159], v223 offset:26624
    v_mfma_f32_16x16x32_bf16 v[48:51], v[136:139], a[48:51], v[48:51]
    buffer_load_dwordx4 a[124:127], v246, s[8:11], s35 offen offset:3072 sc1
    v_mfma_f32_16x16x32_bf16 v[52:55], v[136:139], a[52:55], v[52:55]
    v_mfma_f32_16x16x32_bf16 v[80:83], v[136:139], a[56:59], v[80:83]
    v_mfma_f32_16x16x32_bf16 v[84:87], v[136:139], a[60:63], v[84:87]
    s_add_u32 s35, s35, 4096
    buffer_load_dwordx4 a[0:3], v226, s[8:11], s35 offen offset:0 sc1
    v_mfma_f32_16x16x32_bf16 v[56:59], v[140:143], a[48:51], v[56:59]
    v_mfma_f32_16x16x32_bf16 v[60:63], v[140:143], a[52:55], v[60:63]
    v_mfma_f32_16x16x32_bf16 v[88:91], v[140:143], a[56:59], v[88:91]
    v_mfma_f32_16x16x32_bf16 v[92:95], v[140:143], a[60:63], v[92:95]
    buffer_load_dwordx4 a[4:7], v227, s[8:11], s35 offen offset:0 sc1
    s_waitcnt lgkmcnt(0)
    s_barrier
    v_mfma_f32_16x16x32_bf16 v[0:3], v[144:147], a[48:51], v[0:3]
    ds_read_b64_tr_b16 v[128:129], v216 offset:32768
    v_mfma_f32_16x16x32_bf16 v[4:7], v[144:147], a[52:55], v[4:7]
    ds_read_b64_tr_b16 v[130:131], v216 offset:34816
    v_mfma_f32_16x16x32_bf16 v[96:99], v[144:147], a[56:59], v[96:99]
    ds_read_b64_tr_b16 v[132:133], v216 offset:40960
    v_mfma_f32_16x16x32_bf16 v[100:103], v[144:147], a[60:63], v[100:103]
    ds_read_b64_tr_b16 v[134:135], v216 offset:43008
    v_mfma_f32_16x16x32_bf16 v[8:11], v[148:151], a[48:51], v[8:11]
    ds_read_b64_tr_b16 v[136:137], v217 offset:32768
    v_mfma_f32_16x16x32_bf16 v[12:15], v[148:151], a[52:55], v[12:15]
    ds_read_b64_tr_b16 v[138:139], v217 offset:34816
    v_mfma_f32_16x16x32_bf16 v[104:107], v[148:151], a[56:59], v[104:107]
    ds_read_b64_tr_b16 v[140:141], v217 offset:40960
    v_mfma_f32_16x16x32_bf16 v[108:111], v[148:151], a[60:63], v[108:111]
    ds_read_b64_tr_b16 v[142:143], v217 offset:43008
    v_mfma_f32_16x16x32_bf16 v[16:19], v[152:155], a[48:51], v[16:19]
    buffer_load_dwordx4 a[8:11], v245, s[8:11], s35 offen offset:0 sc1
    v_mfma_f32_16x16x32_bf16 v[20:23], v[152:155], a[52:55], v[20:23]
    v_mfma_f32_16x16x32_bf16 v[112:115], v[152:155], a[56:59], v[112:115]
    v_mfma_f32_16x16x32_bf16 v[116:119], v[152:155], a[60:63], v[116:119]
    v_mfma_f32_16x16x32_bf16 v[24:27], v[156:159], a[48:51], v[24:27]
    buffer_load_dwordx4 a[12:15], v246, s[8:11], s35 offen offset:0 sc1
    v_mfma_f32_16x16x32_bf16 v[28:31], v[156:159], a[52:55], v[28:31]
    v_mfma_f32_16x16x32_bf16 v[120:123], v[156:159], a[56:59], v[120:123]
    v_mfma_f32_16x16x32_bf16 v[124:127], v[156:159], a[60:63], v[124:127]
    s_waitcnt vmcnt(12) lgkmcnt(0)
    v_mfma_f32_16x16x32_bf16 v[32:35], v[128:131], a[64:67], v[32:35]
    ds_read_b64_tr_b16 v[144:145], v218 offset:32768
    v_mfma_f32_16x16x32_bf16 v[32:35], v[132:135], a[80:83], v[32:35]
    ds_read_b64_tr_b16 v[146:147], v218 offset:34816
    v_mfma_f32_16x16x32_bf16 v[36:39], v[128:131], a[68:71], v[36:39]
    ds_read_b64_tr_b16 v[148:149], v218 offset:40960
    v_mfma_f32_16x16x32_bf16 v[36:39], v[132:135], a[84:87], v[36:39]
    ds_read_b64_tr_b16 v[150:151], v218 offset:43008
    v_mfma_f32_16x16x32_bf16 v[64:67], v[128:131], a[72:75], v[64:67]
    ds_read_b64_tr_b16 v[152:153], v219 offset:32768
    v_mfma_f32_16x16x32_bf16 v[64:67], v[132:135], a[88:91], v[64:67]
    ds_read_b64_tr_b16 v[154:155], v219 offset:34816
    v_mfma_f32_16x16x32_bf16 v[68:71], v[128:131], a[76:79], v[68:71]
    ds_read_b64_tr_b16 v[156:157], v219 offset:40960
    v_mfma_f32_16x16x32_bf16 v[68:71], v[132:135], a[92:95], v[68:71]
    ds_read_b64_tr_b16 v[158:159], v219 offset:43008
    v_mfma_f32_16x16x32_bf16 v[40:43], v[136:139], a[64:67], v[40:43]
    buffer_load_dwordx4 a[16:19], v226, s[8:11], s35 offen offset:1024 sc1
    v_mfma_f32_16x16x32_bf16 v[40:43], v[140:143], a[80:83], v[40:43]
    s_add_u32 m0, s38, 0
    s_add_u32 s32, s37, 1048576
    v_mfma_f32_16x16x32_bf16 v[44:47], v[136:139], a[68:71], v[44:47]
    buffer_load_dwordx4 v224, s[12:15], s32 offen lds
    v_mfma_f32_16x16x32_bf16 v[44:47], v[140:143], a[84:87], v[44:47]
    buffer_load_dwordx4 a[20:23], v227, s[8:11], s35 offen offset:1024 sc1
    v_mfma_f32_16x16x32_bf16 v[72:75], v[136:139], a[72:75], v[72:75]
    v_mfma_f32_16x16x32_bf16 v[72:75], v[140:143], a[88:91], v[72:75]
    buffer_load_dwordx4 v225, s[12:15], s32 offen offset:1024 lds
    v_mfma_f32_16x16x32_bf16 v[76:79], v[136:139], a[76:79], v[76:79]
    v_mfma_f32_16x16x32_bf16 v[76:79], v[140:143], a[92:95], v[76:79]
    s_waitcnt lgkmcnt(0)
    v_mfma_f32_16x16x32_bf16 v[48:51], v[144:147], a[64:67], v[48:51]
    ds_read_b64_tr_b16 v[128:129], v220 offset:32768
    v_mfma_f32_16x16x32_bf16 v[48:51], v[148:151], a[80:83], v[48:51]
    ds_read_b64_tr_b16 v[130:131], v220 offset:34816
    v_mfma_f32_16x16x32_bf16 v[52:55], v[144:147], a[68:71], v[52:55]
    ds_read_b64_tr_b16 v[132:133], v220 offset:40960
    v_mfma_f32_16x16x32_bf16 v[52:55], v[148:151], a[84:87], v[52:55]
    ds_read_b64_tr_b16 v[134:135], v220 offset:43008
    v_mfma_f32_16x16x32_bf16 v[80:83], v[144:147], a[72:75], v[80:83]
    ds_read_b64_tr_b16 v[136:137], v221 offset:32768
    v_mfma_f32_16x16x32_bf16 v[80:83], v[148:151], a[88:91], v[80:83]
    ds_read_b64_tr_b16 v[138:139], v221 offset:34816
    v_mfma_f32_16x16x32_bf16 v[84:87], v[144:147], a[76:79], v[84:87]
    ds_read_b64_tr_b16 v[140:141], v221 offset:40960
    v_mfma_f32_16x16x32_bf16 v[84:87], v[148:151], a[92:95], v[84:87]
    ds_read_b64_tr_b16 v[142:143], v221 offset:43008
    v_mfma_f32_16x16x32_bf16 v[56:59], v[152:155], a[64:67], v[56:59]
    buffer_load_dwordx4 a[24:27], v245, s[8:11], s35 offen offset:1024 sc1
    v_mfma_f32_16x16x32_bf16 v[56:59], v[156:159], a[80:83], v[56:59]
    v_mfma_f32_16x16x32_bf16 v[60:63], v[152:155], a[68:71], v[60:63]
    buffer_load_dwordx4 a[28:31], v246, s[8:11], s35 offen offset:1024 sc1
    v_mfma_f32_16x16x32_bf16 v[60:63], v[156:159], a[84:87], v[60:63]
    v_mfma_f32_16x16x32_bf16 v[88:91], v[152:155], a[72:75], v[88:91]
    v_mfma_f32_16x16x32_bf16 v[88:91], v[156:159], a[88:91], v[88:91]
    v_mfma_f32_16x16x32_bf16 v[92:95], v[152:155], a[76:79], v[92:95]
    v_mfma_f32_16x16x32_bf16 v[92:95], v[156:159], a[92:95], v[92:95]
    buffer_load_dwordx4 a[32:35], v226, s[8:11], s35 offen offset:2048 sc1
    s_waitcnt lgkmcnt(0)
    v_mfma_f32_16x16x32_bf16 v[0:3], v[128:131], a[64:67], v[0:3]
    ds_read_b64_tr_b16 v[144:145], v222 offset:32768
    v_mfma_f32_16x16x32_bf16 v[0:3], v[132:135], a[80:83], v[0:3]
    ds_read_b64_tr_b16 v[146:147], v222 offset:34816
    v_mfma_f32_16x16x32_bf16 v[4:7], v[128:131], a[68:71], v[4:7]
    ds_read_b64_tr_b16 v[148:149], v222 offset:40960
    v_mfma_f32_16x16x32_bf16 v[4:7], v[132:135], a[84:87], v[4:7]
    ds_read_b64_tr_b16 v[150:151], v222 offset:43008
    v_mfma_f32_16x16x32_bf16 v[96:99], v[128:131], a[72:75], v[96:99]
    ds_read_b64_tr_b16 v[152:153], v223 offset:32768
    v_mfma_f32_16x16x32_bf16 v[96:99], v[132:135], a[88:91], v[96:99]
    ds_read_b64_tr_b16 v[154:155], v223 offset:34816
    v_mfma_f32_16x16x32_bf16 v[100:103], v[128:131], a[76:79], v[100:103]
    ds_read_b64_tr_b16 v[156:157], v223 offset:40960
    v_mfma_f32_16x16x32_bf16 v[100:103], v[132:135], a[92:95], v[100:103]
    ds_read_b64_tr_b16 v[158:159], v223 offset:43008
    v_mfma_f32_16x16x32_bf16 v[8:11], v[136:139], a[64:67], v[8:11]
    buffer_load_dwordx4 a[36:39], v227, s[8:11], s35 offen offset:2048 sc1
    v_mfma_f32_16x16x32_bf16 v[8:11], v[140:143], a[80:83], v[8:11]
    s_add_u32 m0, s38, 8192
    s_add_u32 s32, s37, 1114112
    v_mfma_f32_16x16x32_bf16 v[12:15], v[136:139], a[68:71], v[12:15]
    buffer_load_dwordx4 v224, s[12:15], s32 offen lds
    v_mfma_f32_16x16x32_bf16 v[12:15], v[140:143], a[84:87], v[12:15]
    buffer_load_dwordx4 a[40:43], v245, s[8:11], s35 offen offset:2048 sc1
    v_mfma_f32_16x16x32_bf16 v[104:107], v[136:139], a[72:75], v[104:107]
    v_mfma_f32_16x16x32_bf16 v[104:107], v[140:143], a[88:91], v[104:107]
    buffer_load_dwordx4 v225, s[12:15], s32 offen offset:1024 lds
    v_mfma_f32_16x16x32_bf16 v[108:111], v[136:139], a[76:79], v[108:111]
    v_mfma_f32_16x16x32_bf16 v[108:111], v[140:143], a[92:95], v[108:111]
    s_waitcnt lgkmcnt(0)
    v_mfma_f32_16x16x32_bf16 v[16:19], v[144:147], a[64:67], v[16:19]
    ds_read_b64_tr_b16 v[128:129], v216 offset:49152
    v_mfma_f32_16x16x32_bf16 v[16:19], v[148:151], a[80:83], v[16:19]
    ds_read_b64_tr_b16 v[130:131], v216 offset:51200
    v_mfma_f32_16x16x32_bf16 v[20:23], v[144:147], a[68:71], v[20:23]
    ds_read_b64_tr_b16 v[132:133], v216 offset:57344
    v_mfma_f32_16x16x32_bf16 v[20:23], v[148:151], a[84:87], v[20:23]
    ds_read_b64_tr_b16 v[134:135], v216 offset:59392
    v_mfma_f32_16x16x32_bf16 v[112:115], v[144:147], a[72:75], v[112:115]
    ds_read_b64_tr_b16 v[136:137], v217 offset:49152
    v_mfma_f32_16x16x32_bf16 v[112:115], v[148:151], a[88:91], v[112:115]
    ds_read_b64_tr_b16 v[138:139], v217 offset:51200
    v_mfma_f32_16x16x32_bf16 v[116:119], v[144:147], a[76:79], v[116:119]
    ds_read_b64_tr_b16 v[140:141], v217 offset:57344
    v_mfma_f32_16x16x32_bf16 v[116:119], v[148:151], a[92:95], v[116:119]
    ds_read_b64_tr_b16 v[142:143], v217 offset:59392
    v_mfma_f32_16x16x32_bf16 v[24:27], v[152:155], a[64:67], v[24:27]
    buffer_load_dwordx4 a[44:47], v246, s[8:11], s35 offen offset:2048 sc1
    v_mfma_f32_16x16x32_bf16 v[24:27], v[156:159], a[80:83], v[24:27]
    v_mfma_f32_16x16x32_bf16 v[28:31], v[152:155], a[68:71], v[28:31]
    buffer_load_dwordx4 a[48:51], v226, s[8:11], s35 offen offset:3072 sc1
    v_mfma_f32_16x16x32_bf16 v[28:31], v[156:159], a[84:87], v[28:31]
    v_mfma_f32_16x16x32_bf16 v[120:123], v[152:155], a[72:75], v[120:123]
    v_mfma_f32_16x16x32_bf16 v[120:123], v[156:159], a[88:91], v[120:123]
    v_mfma_f32_16x16x32_bf16 v[124:127], v[152:155], a[76:79], v[124:127]
    v_mfma_f32_16x16x32_bf16 v[124:127], v[156:159], a[92:95], v[124:127]
    buffer_load_dwordx4 a[52:55], v227, s[8:11], s35 offen offset:3072 sc1
    s_waitcnt vmcnt(18) lgkmcnt(0)
    v_mfma_f32_16x16x32_bf16 v[32:35], v[128:131], a[96:99], v[32:35]
    ds_read_b64_tr_b16 v[144:145], v218 offset:49152
    v_mfma_f32_16x16x32_bf16 v[32:35], v[132:135], a[112:115], v[32:35]
    ds_read_b64_tr_b16 v[146:147], v218 offset:51200
    v_mfma_f32_16x16x32_bf16 v[36:39], v[128:131], a[100:103], v[36:39]
    ds_read_b64_tr_b16 v[148:149], v218 offset:57344
    v_mfma_f32_16x16x32_bf16 v[36:39], v[132:135], a[116:119], v[36:39]
    ds_read_b64_tr_b16 v[150:151], v218 offset:59392
    v_mfma_f32_16x16x32_bf16 v[64:67], v[128:131], a[104:107], v[64:67]
    ds_read_b64_tr_b16 v[152:153], v219 offset:49152
    v_mfma_f32_16x16x32_bf16 v[64:67], v[132:135], a[120:123], v[64:67]
    ds_read_b64_tr_b16 v[154:155], v219 offset:51200
    v_mfma_f32_16x16x32_bf16 v[68:71], v[128:131], a[108:111], v[68:71]
    ds_read_b64_tr_b16 v[156:157], v219 offset:57344
    v_mfma_f32_16x16x32_bf16 v[68:71], v[132:135], a[124:127], v[68:71]
    ds_read_b64_tr_b16 v[158:159], v219 offset:59392
    v_mfma_f32_16x16x32_bf16 v[40:43], v[136:139], a[96:99], v[40:43]
    buffer_load_dwordx4 a[56:59], v245, s[8:11], s35 offen offset:3072 sc1
    v_mfma_f32_16x16x32_bf16 v[40:43], v[140:143], a[112:115], v[40:43]
    s_add_u32 m0, s38, 16384
    s_add_u32 s32, s37, 1179648
    v_mfma_f32_16x16x32_bf16 v[44:47], v[136:139], a[100:103], v[44:47]
    buffer_load_dwordx4 v224, s[12:15], s32 offen lds
    v_mfma_f32_16x16x32_bf16 v[44:47], v[140:143], a[116:119], v[44:47]
    buffer_load_dwordx4 a[60:63], v246, s[8:11], s35 offen offset:3072 sc1
    v_mfma_f32_16x16x32_bf16 v[72:75], v[136:139], a[104:107], v[72:75]
    v_mfma_f32_16x16x32_bf16 v[72:75], v[140:143], a[120:123], v[72:75]
    buffer_load_dwordx4 v225, s[12:15], s32 offen offset:1024 lds
    v_mfma_f32_16x16x32_bf16 v[76:79], v[136:139], a[108:111], v[76:79]
    v_mfma_f32_16x16x32_bf16 v[76:79], v[140:143], a[124:127], v[76:79]
    s_waitcnt lgkmcnt(0)
    v_mfma_f32_16x16x32_bf16 v[48:51], v[144:147], a[96:99], v[48:51]
    ds_read_b64_tr_b16 v[128:129], v220 offset:49152
    v_mfma_f32_16x16x32_bf16 v[48:51], v[148:151], a[112:115], v[48:51]
    ds_read_b64_tr_b16 v[130:131], v220 offset:51200
    v_mfma_f32_16x16x32_bf16 v[52:55], v[144:147], a[100:103], v[52:55]
    ds_read_b64_tr_b16 v[132:133], v220 offset:57344
    v_mfma_f32_16x16x32_bf16 v[52:55], v[148:151], a[116:119], v[52:55]
    ds_read_b64_tr_b16 v[134:135], v220 offset:59392
    v_mfma_f32_16x16x32_bf16 v[80:83], v[144:147], a[104:107], v[80:83]
    ds_read_b64_tr_b16 v[136:137], v221 offset:49152
    v_mfma_f32_16x16x32_bf16 v[80:83], v[148:151], a[120:123], v[80:83]
    ds_read_b64_tr_b16 v[138:139], v221 offset:51200
    v_mfma_f32_16x16x32_bf16 v[84:87], v[144:147], a[108:111], v[84:87]
    ds_read_b64_tr_b16 v[140:141], v221 offset:57344
    v_mfma_f32_16x16x32_bf16 v[84:87], v[148:151], a[124:127], v[84:87]
    ds_read_b64_tr_b16 v[142:143], v221 offset:59392
    v_mfma_f32_16x16x32_bf16 v[56:59], v[152:155], a[96:99], v[56:59]
    s_add_u32 s35, s35, 4096
    buffer_load_dwordx4 a[64:67], v226, s[8:11], s35 offen offset:0 sc1
    v_mfma_f32_16x16x32_bf16 v[56:59], v[156:159], a[112:115], v[56:59]
    v_mfma_f32_16x16x32_bf16 v[60:63], v[152:155], a[100:103], v[60:63]
    buffer_load_dwordx4 a[68:71], v227, s[8:11], s35 offen offset:0 sc1
    v_mfma_f32_16x16x32_bf16 v[60:63], v[156:159], a[116:119], v[60:63]
    v_mfma_f32_16x16x32_bf16 v[88:91], v[152:155], a[104:107], v[88:91]
    v_mfma_f32_16x16x32_bf16 v[88:91], v[156:159], a[120:123], v[88:91]
    v_mfma_f32_16x16x32_bf16 v[92:95], v[152:155], a[108:111], v[92:95]
    v_mfma_f32_16x16x32_bf16 v[92:95], v[156:159], a[124:127], v[92:95]
    buffer_load_dwordx4 a[72:75], v245, s[8:11], s35 offen offset:0 sc1
    s_waitcnt lgkmcnt(0)
    v_mfma_f32_16x16x32_bf16 v[0:3], v[128:131], a[96:99], v[0:3]
    ds_read_b64_tr_b16 v[144:145], v222 offset:49152
    v_mfma_f32_16x16x32_bf16 v[0:3], v[132:135], a[112:115], v[0:3]
    ds_read_b64_tr_b16 v[146:147], v222 offset:51200
    v_mfma_f32_16x16x32_bf16 v[4:7], v[128:131], a[100:103], v[4:7]
    ds_read_b64_tr_b16 v[148:149], v222 offset:57344
    v_mfma_f32_16x16x32_bf16 v[4:7], v[132:135], a[116:119], v[4:7]
    ds_read_b64_tr_b16 v[150:151], v222 offset:59392
    v_mfma_f32_16x16x32_bf16 v[96:99], v[128:131], a[104:107], v[96:99]
    ds_read_b64_tr_b16 v[152:153], v223 offset:49152
    v_mfma_f32_16x16x32_bf16 v[96:99], v[132:135], a[120:123], v[96:99]
    ds_read_b64_tr_b16 v[154:155], v223 offset:51200
    v_mfma_f32_16x16x32_bf16 v[100:103], v[128:131], a[108:111], v[100:103]
    ds_read_b64_tr_b16 v[156:157], v223 offset:57344
    v_mfma_f32_16x16x32_bf16 v[100:103], v[132:135], a[124:127], v[100:103]
    ds_read_b64_tr_b16 v[158:159], v223 offset:59392
    v_mfma_f32_16x16x32_bf16 v[8:11], v[136:139], a[96:99], v[8:11]
    buffer_load_dwordx4 a[76:79], v246, s[8:11], s35 offen offset:0 sc1
    v_mfma_f32_16x16x32_bf16 v[8:11], v[140:143], a[112:115], v[8:11]
    s_add_u32 m0, s38, 24576
    s_add_u32 s32, s37, 1245184
    v_mfma_f32_16x16x32_bf16 v[12:15], v[136:139], a[100:103], v[12:15]
    buffer_load_dwordx4 v224, s[12:15], s32 offen lds
    v_mfma_f32_16x16x32_bf16 v[12:15], v[140:143], a[116:119], v[12:15]
    v_mfma_f32_16x16x32_bf16 v[104:107], v[136:139], a[104:107], v[104:107]
    v_mfma_f32_16x16x32_bf16 v[104:107], v[140:143], a[120:123], v[104:107]
    buffer_load_dwordx4 v225, s[12:15], s32 offen offset:1024 lds
    v_mfma_f32_16x16x32_bf16 v[108:111], v[136:139], a[108:111], v[108:111]
    v_mfma_f32_16x16x32_bf16 v[108:111], v[140:143], a[124:127], v[108:111]
    buffer_load_dwordx4 a[80:83], v226, s[8:11], s35 offen offset:1024 sc1
    s_waitcnt lgkmcnt(0)
    s_barrier
    v_mfma_f32_16x16x32_bf16 v[16:19], v[144:147], a[96:99], v[16:19]
    v_xor_b32 v216, 0x10000, v216
    ds_read_b64_tr_b16 v[128:129], v216 offset:0
    v_mfma_f32_16x16x32_bf16 v[16:19], v[148:151], a[112:115], v[16:19]
    ds_read_b64_tr_b16 v[130:131], v216 offset:2048
    v_mfma_f32_16x16x32_bf16 v[20:23], v[144:147], a[100:103], v[20:23]
    ds_read_b64_tr_b16 v[132:133], v216 offset:8192
    v_mfma_f32_16x16x32_bf16 v[20:23], v[148:151], a[116:119], v[20:23]
    ds_read_b64_tr_b16 v[134:135], v216 offset:10240
    v_mfma_f32_16x16x32_bf16 v[112:115], v[144:147], a[104:107], v[112:115]
    v_xor_b32 v217, 0x10000, v217
    ds_read_b64_tr_b16 v[136:137], v217 offset:0
    v_mfma_f32_16x16x32_bf16 v[112:115], v[148:151], a[120:123], v[112:115]
    ds_read_b64_tr_b16 v[138:139], v217 offset:2048
    v_mfma_f32_16x16x32_bf16 v[116:119], v[144:147], a[108:111], v[116:119]
    ds_read_b64_tr_b16 v[140:141], v217 offset:8192
    v_mfma_f32_16x16x32_bf16 v[116:119], v[148:151], a[124:127], v[116:119]
    ds_read_b64_tr_b16 v[142:143], v217 offset:10240
    v_mfma_f32_16x16x32_bf16 v[24:27], v[152:155], a[96:99], v[24:27]
    buffer_load_dwordx4 a[84:87], v227, s[8:11], s35 offen offset:1024 sc1
    v_mfma_f32_16x16x32_bf16 v[24:27], v[156:159], a[112:115], v[24:27]
    v_mfma_f32_16x16x32_bf16 v[28:31], v[152:155], a[100:103], v[28:31]
    buffer_load_dwordx4 a[88:91], v245, s[8:11], s35 offen offset:1024 sc1
    v_mfma_f32_16x16x32_bf16 v[28:31], v[156:159], a[116:119], v[28:31]
    v_mfma_f32_16x16x32_bf16 v[120:123], v[152:155], a[104:107], v[120:123]
    v_mfma_f32_16x16x32_bf16 v[120:123], v[156:159], a[120:123], v[120:123]
    v_mfma_f32_16x16x32_bf16 v[124:127], v[152:155], a[108:111], v[124:127]
    v_mfma_f32_16x16x32_bf16 v[124:127], v[156:159], a[124:127], v[124:127]
    s_waitcnt vmcnt(21) lgkmcnt(0)
    v_mfma_f32_16x16x32_bf16 v[32:35], v[128:131], a[0:3], v[32:35]
    v_xor_b32 v218, 0x10000, v218
    ds_read_b64_tr_b16 v[144:145], v218 offset:0
    v_mfma_f32_16x16x32_bf16 v[32:35], v[132:135], a[16:19], v[32:35]
    ds_read_b64_tr_b16 v[146:147], v218 offset:2048
    v_mfma_f32_16x16x32_bf16 v[36:39], v[128:131], a[4:7], v[36:39]
    ds_read_b64_tr_b16 v[148:149], v218 offset:8192
    v_mfma_f32_16x16x32_bf16 v[36:39], v[132:135], a[20:23], v[36:39]
    ds_read_b64_tr_b16 v[150:151], v218 offset:10240
    v_mfma_f32_16x16x32_bf16 v[64:67], v[128:131], a[8:11], v[64:67]
    v_xor_b32 v219, 0x10000, v219
    ds_read_b64_tr_b16 v[152:153], v219 offset:0
    v_mfma_f32_16x16x32_bf16 v[64:67], v[132:135], a[24:27], v[64:67]
    ds_read_b64_tr_b16 v[154:155], v219 offset:2048
    v_mfma_f32_16x16x32_bf16 v[68:71], v[128:131], a[12:15], v[68:71]
    ds_read_b64_tr_b16 v[156:157], v219 offset:8192
    v_mfma_f32_16x16x32_bf16 v[68:71], v[132:135], a[28:31], v[68:71]
    ds_read_b64_tr_b16 v[158:159], v219 offset:10240
    v_mfma_f32_16x16x32_bf16 v[40:43], v[136:139], a[0:3], v[40:43]
    buffer_load_dwordx4 a[92:95], v246, s[8:11], s35 offen offset:1024 sc1
    v_mfma_f32_16x16x32_bf16 v[40:43], v[140:143], a[16:19], v[40:43]
    s_add_u32 m0, s38, 32768
    s_add_u32 s32, s37, 1310720
    v_mfma_f32_16x16x32_bf16 v[44:47], v[136:139], a[4:7], v[44:47]
    buffer_load_dwordx4 v224, s[12:15], s32 offen lds
    v_mfma_f32_16x16x32_bf16 v[44:47], v[140:143], a[20:23], v[44:47]
    buffer_load_dwordx4 a[96:99], v226, s[8:11], s35 offen offset:2048 sc1
    v_mfma_f32_16x16x32_bf16 v[72:75], v[136:139], a[8:11], v[72:75]
    v_mfma_f32_16x16x32_bf16 v[72:75], v[140:143], a[24:27], v[72:75]
    buffer_load_dwordx4 v225, s[12:15], s32 offen offset:1024 lds
    v_mfma_f32_16x16x32_bf16 v[76:79], v[136:139], a[12:15], v[76:79]
    s_lshl_b32 s45, s52, 7
    s_add_u32 s45, s45, 0x38a1400
    v_mfma_f32_16x16x32_bf16 v[76:79], v[140:143], a[28:31], v[76:79]
    buffer_load_dwordx4 a[100:103], v227, s[8:11], s35 offen offset:2048 sc1
    s_waitcnt lgkmcnt(0)
    v_mfma_f32_16x16x32_bf16 v[48:51], v[144:147], a[0:3], v[48:51]
    v_xor_b32 v220, 0x10000, v220
    ds_read_b64_tr_b16 v[128:129], v220 offset:0
    v_mfma_f32_16x16x32_bf16 v[48:51], v[148:151], a[16:19], v[48:51]
    ds_read_b64_tr_b16 v[130:131], v220 offset:2048
    v_mfma_f32_16x16x32_bf16 v[52:55], v[144:147], a[4:7], v[52:55]
    ds_read_b64_tr_b16 v[132:133], v220 offset:8192
    v_mfma_f32_16x16x32_bf16 v[52:55], v[148:151], a[20:23], v[52:55]
    ds_read_b64_tr_b16 v[134:135], v220 offset:10240
    v_mfma_f32_16x16x32_bf16 v[80:83], v[144:147], a[8:11], v[80:83]
    v_xor_b32 v221, 0x10000, v221
    ds_read_b64_tr_b16 v[136:137], v221 offset:0
    v_mfma_f32_16x16x32_bf16 v[80:83], v[148:151], a[24:27], v[80:83]
    ds_read_b64_tr_b16 v[138:139], v221 offset:2048
    v_mfma_f32_16x16x32_bf16 v[84:87], v[144:147], a[12:15], v[84:87]
    ds_read_b64_tr_b16 v[140:141], v221 offset:8192
    v_mfma_f32_16x16x32_bf16 v[84:87], v[148:151], a[28:31], v[84:87]
    ds_read_b64_tr_b16 v[142:143], v221 offset:10240
    v_mfma_f32_16x16x32_bf16 v[56:59], v[152:155], a[0:3], v[56:59]
    buffer_load_dwordx4 a[104:107], v245, s[8:11], s35 offen offset:2048 sc1
    v_mfma_f32_16x16x32_bf16 v[56:59], v[156:159], a[16:19], v[56:59]
    s_cmp_eq_u32 s3, 0
    s_cselect_b32 s45, s45, 0x40000000
    v_mfma_f32_16x16x32_bf16 v[60:63], v[152:155], a[4:7], v[60:63]
    buffer_load_dwordx4 a[108:111], v246, s[8:11], s35 offen offset:2048 sc1
    buffer_load_dword v235, off, s[8:11], s45 sc1
    v_mfma_f32_16x16x32_bf16 v[60:63], v[156:159], a[20:23], v[60:63]
    v_mfma_f32_16x16x32_bf16 v[88:91], v[152:155], a[8:11], v[88:91]
    v_mfma_f32_16x16x32_bf16 v[88:91], v[156:159], a[24:27], v[88:91]
    v_mfma_f32_16x16x32_bf16 v[92:95], v[152:155], a[12:15], v[92:95]
    v_mfma_f32_16x16x32_bf16 v[92:95], v[156:159], a[28:31], v[92:95]
    s_waitcnt lgkmcnt(0)
    v_mfma_f32_16x16x32_bf16 v[0:3], v[128:131], a[0:3], v[0:3]
    v_xor_b32 v222, 0x10000, v222
    ds_read_b64_tr_b16 v[144:145], v222 offset:0
    v_mfma_f32_16x16x32_bf16 v[0:3], v[132:135], a[16:19], v[0:3]
    ds_read_b64_tr_b16 v[146:147], v222 offset:2048
    v_mfma_f32_16x16x32_bf16 v[4:7], v[128:131], a[4:7], v[4:7]
    ds_read_b64_tr_b16 v[148:149], v222 offset:8192
    v_mfma_f32_16x16x32_bf16 v[4:7], v[132:135], a[20:23], v[4:7]
    ds_read_b64_tr_b16 v[150:151], v222 offset:10240
    v_mfma_f32_16x16x32_bf16 v[96:99], v[128:131], a[8:11], v[96:99]
    v_xor_b32 v223, 0x10000, v223
    ds_read_b64_tr_b16 v[152:153], v223 offset:0
    v_mfma_f32_16x16x32_bf16 v[96:99], v[132:135], a[24:27], v[96:99]
    ds_read_b64_tr_b16 v[154:155], v223 offset:2048
    v_mfma_f32_16x16x32_bf16 v[100:103], v[128:131], a[12:15], v[100:103]
    ds_read_b64_tr_b16 v[156:157], v223 offset:8192
    v_mfma_f32_16x16x32_bf16 v[100:103], v[132:135], a[28:31], v[100:103]
    ds_read_b64_tr_b16 v[158:159], v223 offset:10240
    v_mfma_f32_16x16x32_bf16 v[8:11], v[136:139], a[0:3], v[8:11]
    buffer_load_dwordx4 a[112:115], v226, s[8:11], s35 offen offset:3072 sc1
    v_mfma_f32_16x16x32_bf16 v[8:11], v[140:143], a[16:19], v[8:11]
    s_add_u32 m0, s38, 40960
    s_add_u32 s32, s37, 1376256
    v_mfma_f32_16x16x32_bf16 v[12:15], v[136:139], a[4:7], v[12:15]
    buffer_load_dwordx4 v224, s[12:15], s32 offen lds
    v_mfma_f32_16x16x32_bf16 v[12:15], v[140:143], a[20:23], v[12:15]
    buffer_load_dwordx4 a[116:119], v227, s[8:11], s35 offen offset:3072 sc1
    v_mfma_f32_16x16x32_bf16 v[104:107], v[136:139], a[8:11], v[104:107]
    v_mfma_f32_16x16x32_bf16 v[104:107], v[140:143], a[24:27], v[104:107]
    buffer_load_dwordx4 v225, s[12:15], s32 offen offset:1024 lds
    v_mfma_f32_16x16x32_bf16 v[108:111], v[136:139], a[12:15], v[108:111]
    v_mfma_f32_16x16x32_bf16 v[108:111], v[140:143], a[28:31], v[108:111]
    buffer_load_dwordx4 a[120:123], v245, s[8:11], s35 offen offset:3072 sc1
    s_waitcnt lgkmcnt(0)
    v_mfma_f32_16x16x32_bf16 v[16:19], v[144:147], a[0:3], v[16:19]
    ds_read_b64_tr_b16 v[128:129], v216 offset:16384
    v_mfma_f32_16x16x32_bf16 v[16:19], v[148:151], a[16:19], v[16:19]
    ds_read_b64_tr_b16 v[130:131], v216 offset:18432
    v_mfma_f32_16x16x32_bf16 v[20:23], v[144:147], a[4:7], v[20:23]
    ds_read_b64_tr_b16 v[132:133], v216 offset:24576
    v_mfma_f32_16x16x32_bf16 v[20:23], v[148:151], a[20:23], v[20:23]
    ds_read_b64_tr_b16 v[134:135], v216 offset:26624
    v_mfma_f32_16x16x32_bf16 v[112:115], v[144:147], a[8:11], v[112:115]
    ds_read_b64_tr_b16 v[136:137], v217 offset:16384
    v_mfma_f32_16x16x32_bf16 v[112:115], v[148:151], a[24:27], v[112:115]
    ds_read_b64_tr_b16 v[138:139], v217 offset:18432
    v_mfma_f32_16x16x32_bf16 v[116:119], v[144:147], a[12:15], v[116:119]
    ds_read_b64_tr_b16 v[140:141], v217 offset:24576
    v_mfma_f32_16x16x32_bf16 v[116:119], v[148:151], a[28:31], v[116:119]
    ds_read_b64_tr_b16 v[142:143], v217 offset:26624
    v_mfma_f32_16x16x32_bf16 v[24:27], v[152:155], a[0:3], v[24:27]
    buffer_load_dwordx4 a[124:127], v246, s[8:11], s35 offen offset:3072 sc1
    v_mfma_f32_16x16x32_bf16 v[24:27], v[156:159], a[16:19], v[24:27]
    v_mfma_f32_16x16x32_bf16 v[28:31], v[152:155], a[4:7], v[28:31]
    v_mfma_f32_16x16x32_bf16 v[28:31], v[156:159], a[20:23], v[28:31]
    v_mfma_f32_16x16x32_bf16 v[120:123], v[152:155], a[8:11], v[120:123]
    v_mfma_f32_16x16x32_bf16 v[120:123], v[156:159], a[24:27], v[120:123]
    v_mfma_f32_16x16x32_bf16 v[124:127], v[152:155], a[12:15], v[124:127]
    v_mfma_f32_16x16x32_bf16 v[124:127], v[156:159], a[28:31], v[124:127]
    s_add_u32 s35, s35, 4096
    buffer_load_dwordx4 a[0:3], v226, s[8:11], s35 offen offset:0 sc1
    s_waitcnt vmcnt(25) lgkmcnt(0)
    v_mfma_f32_16x16x32_bf16 v[32:35], v[128:131], a[32:35], v[32:35]
    ds_read_b64_tr_b16 v[144:145], v218 offset:16384
    v_mfma_f32_16x16x32_bf16 v[32:35], v[132:135], a[48:51], v[32:35]
    ds_read_b64_tr_b16 v[146:147], v218 offset:18432
    v_mfma_f32_16x16x32_bf16 v[36:39], v[128:131], a[36:39], v[36:39]
    ds_read_b64_tr_b16 v[148:149], v218 offset:24576
    v_mfma_f32_16x16x32_bf16 v[36:39], v[132:135], a[52:55], v[36:39]
    ds_read_b64_tr_b16 v[150:151], v218 offset:26624
    v_mfma_f32_16x16x32_bf16 v[64:67], v[128:131], a[40:43], v[64:67]
    ds_read_b64_tr_b16 v[152:153], v219 offset:16384
    v_mfma_f32_16x16x32_bf16 v[64:67], v[132:135], a[56:59], v[64:67]
    ds_read_b64_tr_b16 v[154:155], v219 offset:18432
    v_mfma_f32_16x16x32_bf16 v[68:71], v[128:131], a[44:47], v[68:71]
    ds_read_b64_tr_b16 v[156:157], v219 offset:24576
    v_mfma_f32_16x16x32_bf16 v[68:71], v[132:135], a[60:63], v[68:71]
    ds_read_b64_tr_b16 v[158:159], v219 offset:26624
    v_mfma_f32_16x16x32_bf16 v[40:43], v[136:139], a[32:35], v[40:43]
    buffer_load_dwordx4 a[4:7], v227, s[8:11], s35 offen offset:0 sc1
    v_mfma_f32_16x16x32_bf16 v[40:43], v[140:143], a[48:51], v[40:43]
    s_add_u32 m0, s38, 49152
    s_add_u32 s32, s37, 1441792
    v_mfma_f32_16x16x32_bf16 v[44:47], v[136:139], a[36:39], v[44:47]
    buffer_load_dwordx4 v224, s[12:15], s32 offen lds
    v_mfma_f32_16x16x32_bf16 v[44:47], v[140:143], a[52:55], v[44:47]
    buffer_load_dwordx4 a[8:11], v245, s[8:11], s35 offen offset:0 sc1
    v_mfma_f32_16x16x32_bf16 v[72:75], v[136:139], a[40:43], v[72:75]
    v_mfma_f32_16x16x32_bf16 v[72:75], v[140:143], a[56:59], v[72:75]
    buffer_load_dwordx4 v225, s[12:15], s32 offen offset:1024 lds
    v_mfma_f32_16x16x32_bf16 v[76:79], v[136:139], a[44:47], v[76:79]
    v_mfma_f32_16x16x32_bf16 v[76:79], v[140:143], a[60:63], v[76:79]
    buffer_load_dwordx4 a[12:15], v246, s[8:11], s35 offen offset:0 sc1
    s_waitcnt lgkmcnt(0)
    v_mfma_f32_16x16x32_bf16 v[48:51], v[144:147], a[32:35], v[48:51]
    ds_read_b64_tr_b16 v[128:129], v220 offset:16384
    v_mfma_f32_16x16x32_bf16 v[48:51], v[148:151], a[48:51], v[48:51]
    ds_read_b64_tr_b16 v[130:131], v220 offset:18432
    v_mfma_f32_16x16x32_bf16 v[52:55], v[144:147], a[36:39], v[52:55]
    ds_read_b64_tr_b16 v[132:133], v220 offset:24576
    v_mfma_f32_16x16x32_bf16 v[52:55], v[148:151], a[52:55], v[52:55]
    ds_read_b64_tr_b16 v[134:135], v220 offset:26624
    v_mfma_f32_16x16x32_bf16 v[80:83], v[144:147], a[40:43], v[80:83]
    ds_read_b64_tr_b16 v[136:137], v221 offset:16384
    v_mfma_f32_16x16x32_bf16 v[80:83], v[148:151], a[56:59], v[80:83]
    ds_read_b64_tr_b16 v[138:139], v221 offset:18432
    v_mfma_f32_16x16x32_bf16 v[84:87], v[144:147], a[44:47], v[84:87]
    ds_read_b64_tr_b16 v[140:141], v221 offset:24576
    v_mfma_f32_16x16x32_bf16 v[84:87], v[148:151], a[60:63], v[84:87]
    ds_read_b64_tr_b16 v[142:143], v221 offset:26624
    v_mfma_f32_16x16x32_bf16 v[56:59], v[152:155], a[32:35], v[56:59]
    buffer_load_dwordx4 a[16:19], v226, s[8:11], s35 offen offset:1024 sc1
    v_mfma_f32_16x16x32_bf16 v[56:59], v[156:159], a[48:51], v[56:59]
    v_mfma_f32_16x16x32_bf16 v[60:63], v[152:155], a[36:39], v[60:63]
    v_mfma_f32_16x16x32_bf16 v[60:63], v[156:159], a[52:55], v[60:63]
    v_mfma_f32_16x16x32_bf16 v[88:91], v[152:155], a[40:43], v[88:91]
    buffer_load_dwordx4 a[20:23], v227, s[8:11], s35 offen offset:1024 sc1
    v_mfma_f32_16x16x32_bf16 v[88:91], v[156:159], a[56:59], v[88:91]
    v_mfma_f32_16x16x32_bf16 v[92:95], v[152:155], a[44:47], v[92:95]
    v_mfma_f32_16x16x32_bf16 v[92:95], v[156:159], a[60:63], v[92:95]
    s_waitcnt lgkmcnt(0)
    v_mfma_f32_16x16x32_bf16 v[0:3], v[128:131], a[32:35], v[0:3]
    ds_read_b64_tr_b16 v[144:145], v222 offset:16384
    v_mfma_f32_16x16x32_bf16 v[0:3], v[132:135], a[48:51], v[0:3]
    ds_read_b64_tr_b16 v[146:147], v222 offset:18432
    v_mfma_f32_16x16x32_bf16 v[4:7], v[128:131], a[36:39], v[4:7]
    ds_read_b64_tr_b16 v[148:149], v222 offset:24576
    v_mfma_f32_16x16x32_bf16 v[4:7], v[132:135], a[52:55], v[4:7]
    ds_read_b64_tr_b16 v[150:151], v222 offset:26624
    v_mfma_f32_16x16x32_bf16 v[96:99], v[128:131], a[40:43], v[96:99]
    ds_read_b64_tr_b16 v[152:153], v223 offset:16384
    v_mfma_f32_16x16x32_bf16 v[96:99], v[132:135], a[56:59], v[96:99]
    ds_read_b64_tr_b16 v[154:155], v223 offset:18432
    v_mfma_f32_16x16x32_bf16 v[100:103], v[128:131], a[44:47], v[100:103]
    ds_read_b64_tr_b16 v[156:157], v223 offset:24576
    v_mfma_f32_16x16x32_bf16 v[100:103], v[132:135], a[60:63], v[100:103]
    ds_read_b64_tr_b16 v[158:159], v223 offset:26624
    v_mfma_f32_16x16x32_bf16 v[8:11], v[136:139], a[32:35], v[8:11]
    buffer_load_dwordx4 a[24:27], v245, s[8:11], s35 offen offset:1024 sc1
    v_mfma_f32_16x16x32_bf16 v[8:11], v[140:143], a[48:51], v[8:11]
    s_add_u32 m0, s38, 57344
    s_add_u32 s32, s37, 1507328
    v_mfma_f32_16x16x32_bf16 v[12:15], v[136:139], a[36:39], v[12:15]
    buffer_load_dwordx4 v224, s[12:15], s32 offen lds
    v_mfma_f32_16x16x32_bf16 v[12:15], v[140:143], a[52:55], v[12:15]
    buffer_load_dwordx4 a[28:31], v246, s[8:11], s35 offen offset:1024 sc1
    v_mfma_f32_16x16x32_bf16 v[104:107], v[136:139], a[40:43], v[104:107]
    v_mfma_f32_16x16x32_bf16 v[104:107], v[140:143], a[56:59], v[104:107]
    buffer_load_dwordx4 v225, s[12:15], s32 offen offset:1024 lds
    v_mfma_f32_16x16x32_bf16 v[108:111], v[136:139], a[44:47], v[108:111]
    s_waitcnt vmcnt(18)
    v_readfirstlane_b32 s36, v235
    s_lshl_b32 s34, s3, 8
    s_add_u32 s36, s36, s34
    s_cmp_ge_u32 s36, 8
    s_cbranch_scc0 kc_g
kc_gr:
    v_mfma_f32_16x16x32_bf16 v[108:111], v[140:143], a[60:63], v[108:111]
    s_waitcnt lgkmcnt(0)
    s_barrier
    v_mfma_f32_16x16x32_bf16 v[16:19], v[144:147], a[32:35], v[16:19]
    ds_read_b64_tr_b16 v[128:129], v216 offset:32768
    v_mfma_f32_16x16x32_bf16 v[16:19], v[148:151], a[48:51], v[16:19]
    ds_read_b64_tr_b16 v[130:131], v216 offset:34816
    v_mfma_f32_16x16x32_bf16 v[20:23], v[144:147], a[36:39], v[20:23]
    ds_read_b64_tr_b16 v[132:133], v216 offset:40960
    v_mfma_f32_16x16x32_bf16 v[20:23], v[148:151], a[52:55], v[20:23]
    ds_read_b64_tr_b16 v[134:135], v216 offset:43008
    v_mfma_f32_16x16x32_bf16 v[112:115], v[144:147], a[40:43], v[112:115]
    ds_read_b64_tr_b16 v[136:137], v217 offset:32768
    v_mfma_f32_16x16x32_bf16 v[112:115], v[148:151], a[56:59], v[112:115]
    ds_read_b64_tr_b16 v[138:139], v217 offset:34816
    v_mfma_f32_16x16x32_bf16 v[116:119], v[144:147], a[44:47], v[116:119]
    ds_read_b64_tr_b16 v[140:141], v217 offset:40960
    v_mfma_f32_16x16x32_bf16 v[116:119], v[148:151], a[60:63], v[116:119]
    ds_read_b64_tr_b16 v[142:143], v217 offset:43008
    v_mfma_f32_16x16x32_bf16 v[24:27], v[152:155], a[32:35], v[24:27]
    v_mfma_f32_16x16x32_bf16 v[24:27], v[156:159], a[48:51], v[24:27]
    v_mfma_f32_16x16x32_bf16 v[28:31], v[152:155], a[36:39], v[28:31]
    v_mfma_f32_16x16x32_bf16 v[28:31], v[156:159], a[52:55], v[28:31]
    v_mfma_f32_16x16x32_bf16 v[120:123], v[152:155], a[40:43], v[120:123]
    v_mfma_f32_16x16x32_bf16 v[120:123], v[156:159], a[56:59], v[120:123]
    v_mfma_f32_16x16x32_bf16 v[124:127], v[152:155], a[44:47], v[124:127]
    v_mfma_f32_16x16x32_bf16 v[124:127], v[156:159], a[60:63], v[124:127]
    buffer_load_dwordx4 a[32:35], v226, s[8:11], s35 offen offset:2048 sc1
    s_waitcnt vmcnt(26) lgkmcnt(0)
    v_mfma_f32_16x16x32_bf16 v[32:35], v[128:131], a[64:67], v[32:35]
    ds_read_b64_tr_b16 v[144:145], v218 offset:32768
    v_mfma_f32_16x16x32_bf16 v[32:35], v[132:135], a[80:83], v[32:35]
    ds_read_b64_tr_b16 v[146:147], v218 offset:34816
    v_mfma_f32_16x16x32_bf16 v[36:39], v[128:131], a[68:71], v[36:39]
    ds_read_b64_tr_b16 v[148:149], v218 offset:40960
    v_mfma_f32_16x16x32_bf16 v[36:39], v[132:135], a[84:87], v[36:39]
    ds_read_b64_tr_b16 v[150:151], v218 offset:43008
    v_mfma_f32_16x16x32_bf16 v[64:67], v[128:131], a[72:75], v[64:67]
    ds_read_b64_tr_b16 v[152:153], v219 offset:32768
    v_mfma_f32_16x16x32_bf16 v[64:67], v[132:135], a[88:91], v[64:67]
    ds_read_b64_tr_b16 v[154:155], v219 offset:34816
    v_mfma_f32_16x16x32_bf16 v[68:71], v[128:131], a[76:79], v[68:71]
    ds_read_b64_tr_b16 v[156:157], v219 offset:40960
    v_mfma_f32_16x16x32_bf16 v[68:71], v[132:135], a[92:95], v[68:71]
    ds_read_b64_tr_b16 v[158:159], v219 offset:43008
    v_mfma_f32_16x16x32_bf16 v[40:43], v[136:139], a[64:67], v[40:43]
    buffer_load_dwordx4 a[36:39], v227, s[8:11], s35 offen offset:2048 sc1
    v_mfma_f32_16x16x32_bf16 v[40:43], v[140:143], a[80:83], v[40:43]
    s_add_u32 m0, s38, 65536
    s_add_u32 s32, s37, 1572864
    v_mfma_f32_16x16x32_bf16 v[44:47], v[136:139], a[68:71], v[44:47]
    buffer_load_dwordx4 v224, s[12:15], s32 offen lds
    v_mfma_f32_16x16x32_bf16 v[44:47], v[140:143], a[84:87], v[44:47]
    buffer_load_dwordx4 a[40:43], v245, s[8:11], s35 offen offset:2048 sc1
    v_mfma_f32_16x16x32_bf16 v[72:75], v[136:139], a[72:75], v[72:75]
    v_mfma_f32_16x16x32_bf16 v[72:75], v[140:143], a[88:91], v[72:75]
    buffer_load_dwordx4 v225, s[12:15], s32 offen offset:1024 lds
    v_mfma_f32_16x16x32_bf16 v[76:79], v[136:139], a[76:79], v[76:79]
    s_add_u32 s33, s55, 0
    buffer_load_dwordx4 a[128:131], v228, s[8:11], s33 offen offset:0 sc1
    v_mfma_f32_16x16x32_bf16 v[76:79], v[140:143], a[92:95], v[76:79]
    buffer_load_dwordx4 a[44:47], v246, s[8:11], s35 offen offset:2048 sc1
    s_waitcnt lgkmcnt(0)
    v_mfma_f32_16x16x32_bf16 v[48:51], v[144:147], a[64:67], v[48:51]
    ds_read_b64_tr_b16 v[128:129], v220 offset:32768
    v_mfma_f32_16x16x32_bf16 v[48:51], v[148:151], a[80:83], v[48:51]
    ds_read_b64_tr_b16 v[130:131], v220 offset:34816
    v_mfma_f32_16x16x32_bf16 v[52:55], v[144:147], a[68:71], v[52:55]
    ds_read_b64_tr_b16 v[132:133], v220 offset:40960
    v_mfma_f32_16x16x32_bf16 v[52:55], v[148:151], a[84:87], v[52:55]
    ds_read_b64_tr_b16 v[134:135], v220 offset:43008
    v_mfma_f32_16x16x32_bf16 v[80:83], v[144:147], a[72:75], v[80:83]
    ds_read_b64_tr_b16 v[136:137], v221 offset:32768
    v_mfma_f32_16x16x32_bf16 v[80:83], v[148:151], a[88:91], v[80:83]
    ds_read_b64_tr_b16 v[138:139], v221 offset:34816
    v_mfma_f32_16x16x32_bf16 v[84:87], v[144:147], a[76:79], v[84:87]
    ds_read_b64_tr_b16 v[140:141], v221 offset:40960
    v_mfma_f32_16x16x32_bf16 v[84:87], v[148:151], a[92:95], v[84:87]
    ds_read_b64_tr_b16 v[142:143], v221 offset:43008
    v_mfma_f32_16x16x32_bf16 v[56:59], v[152:155], a[64:67], v[56:59]
    buffer_load_dwordx4 a[48:51], v226, s[8:11], s35 offen offset:3072 sc1
    v_mfma_f32_16x16x32_bf16 v[56:59], v[156:159], a[80:83], v[56:59]
    v_mfma_f32_16x16x32_bf16 v[60:63], v[152:155], a[68:71], v[60:63]
    buffer_load_dwordx4 a[52:55], v227, s[8:11], s35 offen offset:3072 sc1
    v_mfma_f32_16x16x32_bf16 v[60:63], v[156:159], a[84:87], v[60:63]
    v_mfma_f32_16x16x32_bf16 v[88:91], v[152:155], a[72:75], v[88:91]
    buffer_load_dwordx4 a[56:59], v245, s[8:11], s35 offen offset:3072 sc1
    v_mfma_f32_16x16x32_bf16 v[88:91], v[156:159], a[88:91], v[88:91]
    v_mfma_f32_16x16x32_bf16 v[92:95], v[152:155], a[76:79], v[92:95]
    buffer_load_dwordx4 a[132:135], v228, s[8:11], s33 offen offset:1024 sc1
    v_mfma_f32_16x16x32_bf16 v[92:95], v[156:159], a[92:95], v[92:95]
    buffer_load_dwordx4 a[60:63], v246, s[8:11], s35 offen offset:3072 sc1
    s_waitcnt lgkmcnt(0)
    v_mfma_f32_16x16x32_bf16 v[0:3], v[128:131], a[64:67], v[0:3]
    ds_read_b64_tr_b16 v[144:145], v222 offset:32768
    v_mfma_f32_16x16x32_bf16 v[0:3], v[132:135], a[80:83], v[0:3]
    ds_read_b64_tr_b16 v[146:147], v222 offset:34816
    v_mfma_f32_16x16x32_bf16 v[4:7], v[128:131], a[68:71], v[4:7]
    ds_read_b64_tr_b16 v[148:149], v222 offset:40960
    v_mfma_f32_16x16x32_bf16 v[4:7], v[132:135], a[84:87], v[4:7]
    ds_read_b64_tr_b16 v[150:151], v222 offset:43008
    v_mfma_f32_16x16x32_bf16 v[96:99], v[128:131], a[72:75], v[96:99]
    ds_read_b64_tr_b16 v[152:153], v223 offset:32768
    v_mfma_f32_16x16x32_bf16 v[96:99], v[132:135], a[88:91], v[96:99]
    ds_read_b64_tr_b16 v[154:155], v223 offset:34816
    v_mfma_f32_16x16x32_bf16 v[100:103], v[128:131], a[76:79], v[100:103]
    ds_read_b64_tr_b16 v[156:157], v223 offset:40960
    v_mfma_f32_16x16x32_bf16 v[100:103], v[132:135], a[92:95], v[100:103]
    ds_read_b64_tr_b16 v[158:159], v223 offset:43008
    v_mfma_f32_16x16x32_bf16 v[8:11], v[136:139], a[64:67], v[8:11]
    v_mfma_f32_16x16x32_bf16 v[8:11], v[140:143], a[80:83], v[8:11]
    s_add_u32 m0, s38, 73728
    s_add_u32 s32, s37, 1638400
    v_mfma_f32_16x16x32_bf16 v[12:15], v[136:139], a[68:71], v[12:15]
    buffer_load_dwordx4 v224, s[12:15], s32 offen lds
    v_mfma_f32_16x16x32_bf16 v[12:15], v[140:143], a[84:87], v[12:15]
    v_mfma_f32_16x16x32_bf16 v[104:107], v[136:139], a[72:75], v[104:107]
    v_mfma_f32_16x16x32_bf16 v[104:107], v[140:143], a[88:91], v[104:107]
    buffer_load_dwordx4 v225, s[12:15], s32 offen offset:1024 lds
    v_mfma_f32_16x16x32_bf16 v[108:111], v[136:139], a[76:79], v[108:111]
    buffer_load_dwordx4 a[136:139], v228, s[8:11], s33 offen offset:2048 sc1
    v_mfma_f32_16x16x32_bf16 v[108:111], v[140:143], a[92:95], v[108:111]
    s_waitcnt lgkmcnt(0)
    v_mfma_f32_16x16x32_bf16 v[16:19], v[144:147], a[64:67], v[16:19]
    ds_read_b64_tr_b16 v[128:129], v216 offset:49152
    v_mfma_f32_16x16x32_bf16 v[16:19], v[148:151], a[80:83], v[16:19]
    ds_read_b64_tr_b16 v[130:131], v216 offset:51200
    v_mfma_f32_16x16x32_bf16 v[20:23], v[144:147], a[68:71], v[20:23]
    ds_read_b64_tr_b16 v[132:133], v216 offset:57344
    v_mfma_f32_16x16x32_bf16 v[20:23], v[148:151], a[84:87], v[20:23]
    ds_read_b64_tr_b16 v[134:135], v216 offset:59392
    v_mfma_f32_16x16x32_bf16 v[112:115], v[144:147], a[72:75], v[112:115]
    ds_read_b64_tr_b16 v[136:137], v217 offset:49152
    v_mfma_f32_16x16x32_bf16 v[112:115], v[148:151], a[88:91], v[112:115]
    ds_read_b64_tr_b16 v[138:139], v217 offset:51200
    v_mfma_f32_16x16x32_bf16 v[116:119], v[144:147], a[76:79], v[116:119]
    ds_read_b64_tr_b16 v[140:141], v217 offset:57344
    v_mfma_f32_16x16x32_bf16 v[116:119], v[148:151], a[92:95], v[116:119]
    ds_read_b64_tr_b16 v[142:143], v217 offset:59392
    v_mfma_f32_16x16x32_bf16 v[24:27], v[152:155], a[64:67], v[24:27]
    v_mfma_f32_16x16x32_bf16 v[24:27], v[156:159], a[80:83], v[24:27]
    v_mfma_f32_16x16x32_bf16 v[28:31], v[152:155], a[68:71], v[28:31]
    v_mfma_f32_16x16x32_bf16 v[28:31], v[156:159], a[84:87], v[28:31]
    v_mfma_f32_16x16x32_bf16 v[120:123], v[152:155], a[72:75], v[120:123]
    v_mfma_f32_16x16x32_bf16 v[120:123], v[156:159], a[88:91], v[120:123]
    v_mfma_f32_16x16x32_bf16 v[124:127], v[152:155], a[76:79], v[124:127]
    buffer_load_dwordx4 a[140:143], v228, s[8:11], s33 offen offset:3072 sc1
    v_mfma_f32_16x16x32_bf16 v[124:127], v[156:159], a[92:95], v[124:127]
    s_add_u32 s35, s35, 4096
    buffer_load_dwordx4 a[224:227], v226, s[8:11], s35 offen offset:0 sc1
    s_waitcnt vmcnt(29) lgkmcnt(0)
    v_mfma_f32_16x16x32_bf16 v[32:35], v[128:131], a[96:99], v[32:35]
    ds_read_b64_tr_b16 v[144:145], v218 offset:49152
    v_mfma_f32_16x16x32_bf16 v[32:35], v[132:135], a[112:115], v[32:35]
    ds_read_b64_tr_b16 v[146:147], v218 offset:51200
    v_mfma_f32_16x16x32_bf16 v[36:39], v[128:131], a[100:103], v[36:39]
    ds_read_b64_tr_b16 v[148:149], v218 offset:57344
    v_mfma_f32_16x16x32_bf16 v[36:39], v[132:135], a[116:119], v[36:39]
    ds_read_b64_tr_b16 v[150:151], v218 offset:59392
    v_mfma_f32_16x16x32_bf16 v[64:67], v[128:131], a[104:107], v[64:67]
    ds_read_b64_tr_b16 v[152:153], v219 offset:49152
    v_mfma_f32_16x16x32_bf16 v[64:67], v[132:135], a[120:123], v[64:67]
    ds_read_b64_tr_b16 v[154:155], v219 offset:51200
    v_mfma_f32_16x16x32_bf16 v[68:71], v[128:131], a[108:111], v[68:71]
    ds_read_b64_tr_b16 v[156:157], v219 offset:57344
    v_mfma_f32_16x16x32_bf16 v[68:71], v[132:135], a[124:127], v[68:71]
    ds_read_b64_tr_b16 v[158:159], v219 offset:59392
    v_mfma_f32_16x16x32_bf16 v[40:43], v[136:139], a[96:99], v[40:43]
    buffer_load_dwordx4 a[228:231], v227, s[8:11], s35 offen offset:0 sc1
    v_mfma_f32_16x16x32_bf16 v[40:43], v[140:143], a[112:115], v[40:43]
    s_add_u32 m0, s38, 81920
    s_add_u32 s32, s37, 1703936
    v_mfma_f32_16x16x32_bf16 v[44:47], v[136:139], a[100:103], v[44:47]
    buffer_load_dwordx4 v224, s[12:15], s32 offen lds
    v_mfma_f32_16x16x32_bf16 v[44:47], v[140:143], a[116:119], v[44:47]
    buffer_load_dwordx4 a[72:75], v245, s[8:11], s35 offen offset:0 sc1
    v_mfma_f32_16x16x32_bf16 v[72:75], v[136:139], a[104:107], v[72:75]
    v_mfma_f32_16x16x32_bf16 v[72:75], v[140:143], a[120:123], v[72:75]
    buffer_load_dwordx4 v225, s[12:15], s32 offen offset:1024 lds
    v_mfma_f32_16x16x32_bf16 v[76:79], v[136:139], a[108:111], v[76:79]
    s_add_u32 s33, s55, 4096
    buffer_load_dwordx4 a[144:147], v228, s[8:11], s33 offen offset:0 sc1
    v_mfma_f32_16x16x32_bf16 v[76:79], v[140:143], a[124:127], v[76:79]
    buffer_load_dwordx4 a[76:79], v246, s[8:11], s35 offen offset:0 sc1
    s_waitcnt lgkmcnt(0)
    v_mfma_f32_16x16x32_bf16 v[48:51], v[144:147], a[96:99], v[48:51]
    ds_read_b64_tr_b16 v[128:129], v220 offset:49152
    v_mfma_f32_16x16x32_bf16 v[48:51], v[148:151], a[112:115], v[48:51]
    ds_read_b64_tr_b16 v[130:131], v220 offset:51200
    v_mfma_f32_16x16x32_bf16 v[52:55], v[144:147], a[100:103], v[52:55]
    ds_read_b64_tr_b16 v[132:133], v220 offset:57344
    v_mfma_f32_16x16x32_bf16 v[52:55], v[148:151], a[116:119], v[52:55]
    ds_read_b64_tr_b16 v[134:135], v220 offset:59392
    v_mfma_f32_16x16x32_bf16 v[80:83], v[144:147], a[104:107], v[80:83]
    ds_read_b64_tr_b16 v[136:137], v221 offset:49152
    v_mfma_f32_16x16x32_bf16 v[80:83], v[148:151], a[120:123], v[80:83]
    ds_read_b64_tr_b16 v[138:139], v221 offset:51200
    v_mfma_f32_16x16x32_bf16 v[84:87], v[144:147], a[108:111], v[84:87]
    ds_read_b64_tr_b16 v[140:141], v221 offset:57344
    v_mfma_f32_16x16x32_bf16 v[84:87], v[148:151], a[124:127], v[84:87]
    ds_read_b64_tr_b16 v[142:143], v221 offset:59392
    v_mfma_f32_16x16x32_bf16 v[56:59], v[152:155], a[96:99], v[56:59]
    buffer_load_dwordx4 a[232:235], v226, s[8:11], s35 offen offset:1024 sc1
    v_mfma_f32_16x16x32_bf16 v[56:59], v[156:159], a[112:115], v[56:59]
    v_mfma_f32_16x16x32_bf16 v[60:63], v[152:155], a[100:103], v[60:63]
    buffer_load_dwordx4 a[236:239], v227, s[8:11], s35 offen offset:1024 sc1
    v_mfma_f32_16x16x32_bf16 v[60:63], v[156:159], a[116:119], v[60:63]
    v_mfma_f32_16x16x32_bf16 v[88:91], v[152:155], a[104:107], v[88:91]
    buffer_load_dwordx4 a[88:91], v245, s[8:11], s35 offen offset:1024 sc1
    v_mfma_f32_16x16x32_bf16 v[88:91], v[156:159], a[120:123], v[88:91]
    v_mfma_f32_16x16x32_bf16 v[92:95], v[152:155], a[108:111], v[92:95]
    buffer_load_dwordx4 a[148:151], v228, s[8:11], s33 offen offset:1024 sc1
    v_mfma_f32_16x16x32_bf16 v[92:95], v[156:159], a[124:127], v[92:95]
    buffer_load_dwordx4 a[92:95], v246, s[8:11], s35 offen offset:1024 sc1
    s_waitcnt lgkmcnt(0)
    v_mfma_f32_16x16x32_bf16 v[0:3], v[128:131], a[96:99], v[0:3]
    ds_read_b64_tr_b16 v[144:145], v222 offset:49152
    v_mfma_f32_16x16x32_bf16 v[0:3], v[132:135], a[112:115], v[0:3]
    ds_read_b64_tr_b16 v[146:147], v222 offset:51200
    v_mfma_f32_16x16x32_bf16 v[4:7], v[128:131], a[100:103], v[4:7]
    ds_read_b64_tr_b16 v[148:149], v222 offset:57344
    v_mfma_f32_16x16x32_bf16 v[4:7], v[132:135], a[116:119], v[4:7]
    ds_read_b64_tr_b16 v[150:151], v222 offset:59392
    v_mfma_f32_16x16x32_bf16 v[96:99], v[128:131], a[104:107], v[96:99]
    ds_read_b64_tr_b16 v[152:153], v223 offset:49152
    v_mfma_f32_16x16x32_bf16 v[96:99], v[132:135], a[120:123], v[96:99]
    ds_read_b64_tr_b16 v[154:155], v223 offset:51200
    v_mfma_f32_16x16x32_bf16 v[100:103], v[128:131], a[108:111], v[100:103]
    ds_read_b64_tr_b16 v[156:157], v223 offset:57344
    v_mfma_f32_16x16x32_bf16 v[100:103], v[132:135], a[124:127], v[100:103]
    ds_read_b64_tr_b16 v[158:159], v223 offset:59392
    v_mfma_f32_16x16x32_bf16 v[8:11], v[136:139], a[96:99], v[8:11]
    v_mfma_f32_16x16x32_bf16 v[8:11], v[140:143], a[112:115], v[8:11]
    s_add_u32 m0, s38, 90112
    s_add_u32 s32, s37, 1769472
    v_mfma_f32_16x16x32_bf16 v[12:15], v[136:139], a[100:103], v[12:15]
    buffer_load_dwordx4 v224, s[12:15], s32 offen lds
    v_mfma_f32_16x16x32_bf16 v[12:15], v[140:143], a[116:119], v[12:15]
    v_mfma_f32_16x16x32_bf16 v[104:107], v[136:139], a[104:107], v[104:107]
    v_mfma_f32_16x16x32_bf16 v[104:107], v[140:143], a[120:123], v[104:107]
    buffer_load_dwordx4 v225, s[12:15], s32 offen offset:1024 lds
    v_mfma_f32_16x16x32_bf16 v[108:111], v[136:139], a[108:111], v[108:111]
    buffer_load_dwordx4 a[152:155], v228, s[8:11], s33 offen offset:2048 sc1
    v_mfma_f32_16x16x32_bf16 v[108:111], v[140:143], a[124:127], v[108:111]
    s_waitcnt vmcnt(60) lgkmcnt(0)
    s_barrier
    v_mfma_f32_16x16x32_bf16 v[16:19], v[144:147], a[96:99], v[16:19]
    v_xor_b32 v216, 0x10000, v216
    ds_read_b64_tr_b16 v[128:129], v216 offset:0
    v_mfma_f32_16x16x32_bf16 v[16:19], v[148:151], a[112:115], v[16:19]
    ds_read_b64_tr_b16 v[130:131], v216 offset:2048
    v_mfma_f32_16x16x32_bf16 v[20:23], v[144:147], a[100:103], v[20:23]
    ds_read_b64_tr_b16 v[132:133], v216 offset:8192
    v_mfma_f32_16x16x32_bf16 v[20:23], v[148:151], a[116:119], v[20:23]
    ds_read_b64_tr_b16 v[134:135], v216 offset:10240
    v_mfma_f32_16x16x32_bf16 v[112:115], v[144:147], a[104:107], v[112:115]
    v_xor_b32 v217, 0x10000, v217
    ds_read_b64_tr_b16 v[136:137], v217 offset:0
    v_mfma_f32_16x16x32_bf16 v[112:115], v[148:151], a[120:123], v[112:115]
    ds_read_b64_tr_b16 v[138:139], v217 offset:2048
    v_mfma_f32_16x16x32_bf16 v[116:119], v[144:147], a[108:111], v[116:119]
    ds_read_b64_tr_b16 v[140:141], v217 offset:8192
    v_mfma_f32_16x16x32_bf16 v[116:119], v[148:151], a[124:127], v[116:119]
    ds_read_b64_tr_b16 v[142:143], v217 offset:10240
    v_mfma_f32_16x16x32_bf16 v[24:27], v[152:155], a[96:99], v[24:27]
    v_mfma_f32_16x16x32_bf16 v[24:27], v[156:159], a[112:115], v[24:27]
    v_mfma_f32_16x16x32_bf16 v[28:31], v[152:155], a[100:103], v[28:31]
    v_mfma_f32_16x16x32_bf16 v[28:31], v[156:159], a[116:119], v[28:31]
    v_mfma_f32_16x16x32_bf16 v[120:123], v[152:155], a[104:107], v[120:123]
    v_mfma_f32_16x16x32_bf16 v[120:123], v[156:159], a[120:123], v[120:123]
    v_mfma_f32_16x16x32_bf16 v[124:127], v[152:155], a[108:111], v[124:127]
    buffer_load_dwordx4 a[156:159], v228, s[8:11], s33 offen offset:3072 sc1
    v_mfma_f32_16x16x32_bf16 v[124:127], v[156:159], a[124:127], v[124:127]
    buffer_load_dwordx4 a[240:243], v226, s[8:11], s35 offen offset:2048 sc1
    s_waitcnt vmcnt(34) lgkmcnt(0)
    v_mfma_f32_16x16x32_bf16 v[32:35], v[128:131], a[0:3], v[32:35]
    v_xor_b32 v218, 0x10000, v218
    ds_read_b64_tr_b16 v[144:145], v218 offset:0
    v_mfma_f32_16x16x32_bf16 v[32:35], v[132:135], a[16:19], v[32:35]
    ds_read_b64_tr_b16 v[146:147], v218 offset:2048
    v_mfma_f32_16x16x32_bf16 v[36:39], v[128:131], a[4:7], v[36:39]
    ds_read_b64_tr_b16 v[148:149], v218 offset:8192
    v_mfma_f32_16x16x32_bf16 v[36:39], v[132:135], a[20:23], v[36:39]
    ds_read_b64_tr_b16 v[150:151], v218 offset:10240
    v_mfma_f32_16x16x32_bf16 v[64:67], v[128:131], a[8:11], v[64:67]
    v_xor_b32 v219, 0x10000, v219
    ds_read_b64_tr_b16 v[152:153], v219 offset:0
    v_mfma_f32_16x16x32_bf16 v[64:67], v[132:135], a[24:27], v[64:67]
    ds_read_b64_tr_b16 v[154:155], v219 offset:2048
    v_mfma_f32_16x16x32_bf16 v[68:71], v[128:131], a[12:15], v[68:71]
    ds_read_b64_tr_b16 v[156:157], v219 offset:8192
    v_mfma_f32_16x16x32_bf16 v[68:71], v[132:135], a[28:31], v[68:71]
    ds_read_b64_tr_b16 v[158:159], v219 offset:10240
    v_mfma_f32_16x16x32_bf16 v[40:43], v[136:139], a[0:3], v[40:43]
    buffer_load_dwordx4 a[244:247], v227, s[8:11], s35 offen offset:2048 sc1
    v_mfma_f32_16x16x32_bf16 v[40:43], v[140:143], a[16:19], v[40:43]
    s_add_u32 m0, s38, 98304
    s_add_u32 s32, s37, 1835008
    v_mfma_f32_16x16x32_bf16 v[44:47], v[136:139], a[4:7], v[44:47]
    buffer_load_dwordx4 v224, s[12:15], s32 offen lds
    v_mfma_f32_16x16x32_bf16 v[44:47], v[140:143], a[20:23], v[44:47]
    buffer_load_dwordx4 a[104:107], v245, s[8:11], s35 offen offset:2048 sc1
    v_mfma_f32_16x16x32_bf16 v[72:75], v[136:139], a[8:11], v[72:75]
    v_mfma_f32_16x16x32_bf16 v[72:75], v[140:143], a[24:27], v[72:75]
    buffer_load_dwordx4 v225, s[12:15], s32 offen offset:1024 lds
    v_mfma_f32_16x16x32_bf16 v[76:79], v[136:139], a[12:15], v[76:79]
    s_add_u32 s33, s55, 32768
    buffer_load_dwordx4 a[160:163], v228, s[8:11], s33 offen offset:0 sc1
    v_mfma_f32_16x16x32_bf16 v[76:79], v[140:143], a[28:31], v[76:79]
    buffer_load_dwordx4 a[108:111], v246, s[8:11], s35 offen offset:2048 sc1
    s_waitcnt lgkmcnt(0)
    v_mfma_f32_16x16x32_bf16 v[48:51], v[144:147], a[0:3], v[48:51]
    v_xor_b32 v220, 0x10000, v220
    ds_read_b64_tr_b16 v[128:129], v220 offset:0
    v_mfma_f32_16x16x32_bf16 v[48:51], v[148:151], a[16:19], v[48:51]
    ds_read_b64_tr_b16 v[130:131], v220 offset:2048
    v_mfma_f32_16x16x32_bf16 v[52:55], v[144:147], a[4:7], v[52:55]
    ds_read_b64_tr_b16 v[132:133], v220 offset:8192
    v_mfma_f32_16x16x32_bf16 v[52:55], v[148:151], a[20:23], v[52:55]
    ds_read_b64_tr_b16 v[134:135], v220 offset:10240
    v_mfma_f32_16x16x32_bf16 v[80:83], v[144:147], a[8:11], v[80:83]
    v_xor_b32 v221, 0x10000, v221
    ds_read_b64_tr_b16 v[136:137], v221 offset:0
    v_mfma_f32_16x16x32_bf16 v[80:83], v[148:151], a[24:27], v[80:83]
    ds_read_b64_tr_b16 v[138:139], v221 offset:2048
    v_mfma_f32_16x16x32_bf16 v[84:87], v[144:147], a[12:15], v[84:87]
    ds_read_b64_tr_b16 v[140:141], v221 offset:8192
    v_mfma_f32_16x16x32_bf16 v[84:87], v[148:151], a[28:31], v[84:87]
    ds_read_b64_tr_b16 v[142:143], v221 offset:10240
    v_mfma_f32_16x16x32_bf16 v[56:59], v[152:155], a[0:3], v[56:59]
    buffer_load_dwordx4 a[248:251], v226, s[8:11], s35 offen offset:3072 sc1
    v_mfma_f32_16x16x32_bf16 v[56:59], v[156:159], a[16:19], v[56:59]
    v_mfma_f32_16x16x32_bf16 v[60:63], v[152:155], a[4:7], v[60:63]
    buffer_load_dwordx4 a[252:255], v227, s[8:11], s35 offen offset:3072 sc1
    v_mfma_f32_16x16x32_bf16 v[60:63], v[156:159], a[20:23], v[60:63]
    v_mfma_f32_16x16x32_bf16 v[88:91], v[152:155], a[8:11], v[88:91]
    buffer_load_dwordx4 a[120:123], v245, s[8:11], s35 offen offset:3072 sc1
    v_mfma_f32_16x16x32_bf16 v[88:91], v[156:159], a[24:27], v[88:91]
    v_mfma_f32_16x16x32_bf16 v[92:95], v[152:155], a[12:15], v[92:95]
    buffer_load_dwordx4 a[164:167], v228, s[8:11], s33 offen offset:1024 sc1
    v_mfma_f32_16x16x32_bf16 v[92:95], v[156:159], a[28:31], v[92:95]
    buffer_load_dwordx4 a[124:127], v246, s[8:11], s35 offen offset:3072 sc1
    s_waitcnt lgkmcnt(0)
    v_mfma_f32_16x16x32_bf16 v[0:3], v[128:131], a[0:3], v[0:3]
    v_xor_b32 v222, 0x10000, v222
    ds_read_b64_tr_b16 v[144:145], v222 offset:0
    v_mfma_f32_16x16x32_bf16 v[0:3], v[132:135], a[16:19], v[0:3]
    ds_read_b64_tr_b16 v[146:147], v222 offset:2048
    v_mfma_f32_16x16x32_bf16 v[4:7], v[128:131], a[4:7], v[4:7]
    ds_read_b64_tr_b16 v[148:149], v222 offset:8192
    v_mfma_f32_16x16x32_bf16 v[4:7], v[132:135], a[20:23], v[4:7]
    ds_read_b64_tr_b16 v[150:151], v222 offset:10240
    v_mfma_f32_16x16x32_bf16 v[96:99], v[128:131], a[8:11], v[96:99]
    v_xor_b32 v223, 0x10000, v223
    ds_read_b64_tr_b16 v[152:153], v223 offset:0
    v_mfma_f32_16x16x32_bf16 v[96:99], v[132:135], a[24:27], v[96:99]
    ds_read_b64_tr_b16 v[154:155], v223 offset:2048
    v_mfma_f32_16x16x32_bf16 v[100:103], v[128:131], a[12:15], v[100:103]
    ds_read_b64_tr_b16 v[156:157], v223 offset:8192
    v_mfma_f32_16x16x32_bf16 v[100:103], v[132:135], a[28:31], v[100:103]
    ds_read_b64_tr_b16 v[158:159], v223 offset:10240
    v_mfma_f32_16x16x32_bf16 v[8:11], v[136:139], a[0:3], v[8:11]
    v_mfma_f32_16x16x32_bf16 v[8:11], v[140:143], a[16:19], v[8:11]
    s_add_u32 m0, s38, 106496
    s_add_u32 s32, s37, 1900544
    v_mfma_f32_16x16x32_bf16 v[12:15], v[136:139], a[4:7], v[12:15]
    buffer_load_dwordx4 v224, s[12:15], s32 offen lds
    v_mfma_f32_16x16x32_bf16 v[12:15], v[140:143], a[20:23], v[12:15]
    v_mfma_f32_16x16x32_bf16 v[104:107], v[136:139], a[8:11], v[104:107]
    v_mfma_f32_16x16x32_bf16 v[104:107], v[140:143], a[24:27], v[104:107]
    buffer_load_dwordx4 v225, s[12:15], s32 offen offset:1024 lds
    v_mfma_f32_16x16x32_bf16 v[108:111], v[136:139], a[12:15], v[108:111]
    buffer_load_dwordx4 a[168:171], v228, s[8:11], s33 offen offset:2048 sc1
    v_mfma_f32_16x16x32_bf16 v[108:111], v[140:143], a[28:31], v[108:111]
    s_waitcnt lgkmcnt(0)
    v_mfma_f32_16x16x32_bf16 v[16:19], v[144:147], a[0:3], v[16:19]
    ds_read_b64_tr_b16 v[128:129], v216 offset:16384
    v_mfma_f32_16x16x32_bf16 v[16:19], v[148:151], a[16:19], v[16:19]
    ds_read_b64_tr_b16 v[130:131], v216 offset:18432
    v_mfma_f32_16x16x32_bf16 v[20:23], v[144:147], a[4:7], v[20:23]
    ds_read_b64_tr_b16 v[132:133], v216 offset:24576
    v_mfma_f32_16x16x32_bf16 v[20:23], v[148:151], a[20:23], v[20:23]
    ds_read_b64_tr_b16 v[134:135], v216 offset:26624
    v_mfma_f32_16x16x32_bf16 v[112:115], v[144:147], a[8:11], v[112:115]
    ds_read_b64_tr_b16 v[136:137], v217 offset:16384
    v_mfma_f32_16x16x32_bf16 v[112:115], v[148:151], a[24:27], v[112:115]
    ds_read_b64_tr_b16 v[138:139], v217 offset:18432
    v_mfma_f32_16x16x32_bf16 v[116:119], v[144:147], a[12:15], v[116:119]
    ds_read_b64_tr_b16 v[140:141], v217 offset:24576
    v_mfma_f32_16x16x32_bf16 v[116:119], v[148:151], a[28:31], v[116:119]
    ds_read_b64_tr_b16 v[142:143], v217 offset:26624
    v_mfma_f32_16x16x32_bf16 v[24:27], v[152:155], a[0:3], v[24:27]
    v_mfma_f32_16x16x32_bf16 v[24:27], v[156:159], a[16:19], v[24:27]
    v_mfma_f32_16x16x32_bf16 v[28:31], v[152:155], a[4:7], v[28:31]
    v_mfma_f32_16x16x32_bf16 v[28:31], v[156:159], a[20:23], v[28:31]
    v_mfma_f32_16x16x32_bf16 v[120:123], v[152:155], a[8:11], v[120:123]
    v_mfma_f32_16x16x32_bf16 v[120:123], v[156:159], a[24:27], v[120:123]
    v_mfma_f32_16x16x32_bf16 v[124:127], v[152:155], a[12:15], v[124:127]
    buffer_load_dwordx4 a[172:175], v228, s[8:11], s33 offen offset:3072 sc1
    v_mfma_f32_16x16x32_bf16 v[124:127], v[156:159], a[28:31], v[124:127]
    s_add_u32 s35, s35, 4096
    buffer_load_dwordx4 a[0:3], v226, s[8:11], s35 offen offset:0 sc1
    s_waitcnt vmcnt(37) lgkmcnt(0)
    v_mfma_f32_16x16x32_bf16 v[32:35], v[128:131], a[32:35], v[32:35]
    ds_read_b64_tr_b16 v[144:145], v218 offset:16384
    v_mfma_f32_16x16x32_bf16 v[32:35], v[132:135], a[48:51], v[32:35]
    ds_read_b64_tr_b16 v[146:147], v218 offset:18432
    v_mfma_f32_16x16x32_bf16 v[36:39], v[128:131], a[36:39], v[36:39]
    ds_read_b64_tr_b16 v[148:149], v218 offset:24576
    v_mfma_f32_16x16x32_bf16 v[36:39], v[132:135], a[52:55], v[36:39]
    ds_read_b64_tr_b16 v[150:151], v218 offset:26624
    v_mfma_f32_16x16x32_bf16 v[64:67], v[128:131], a[40:43], v[64:67]
    ds_read_b64_tr_b16 v[152:153], v219 offset:16384
    v_mfma_f32_16x16x32_bf16 v[64:67], v[132:135], a[56:59], v[64:67]
    ds_read_b64_tr_b16 v[154:155], v219 offset:18432
    v_mfma_f32_16x16x32_bf16 v[68:71], v[128:131], a[44:47], v[68:71]
    ds_read_b64_tr_b16 v[156:157], v219 offset:24576
    v_mfma_f32_16x16x32_bf16 v[68:71], v[132:135], a[60:63], v[68:71]
    ds_read_b64_tr_b16 v[158:159], v219 offset:26624
    v_mfma_f32_16x16x32_bf16 v[40:43], v[136:139], a[32:35], v[40:43]
    buffer_load_dwordx4 a[4:7], v227, s[8:11], s35 offen offset:0 sc1
    v_mfma_f32_16x16x32_bf16 v[40:43], v[140:143], a[48:51], v[40:43]
    s_add_u32 m0, s38, 114688
    s_add_u32 s32, s37, 1966080
    v_mfma_f32_16x16x32_bf16 v[44:47], v[136:139], a[36:39], v[44:47]
    buffer_load_dwordx4 v224, s[12:15], s32 offen lds
    v_mfma_f32_16x16x32_bf16 v[44:47], v[140:143], a[52:55], v[44:47]
    buffer_load_dwordx4 a[8:11], v245, s[8:11], s35 offen offset:0 sc1
    v_mfma_f32_16x16x32_bf16 v[72:75], v[136:139], a[40:43], v[72:75]
    v_mfma_f32_16x16x32_bf16 v[72:75], v[140:143], a[56:59], v[72:75]
    buffer_load_dwordx4 v225, s[12:15], s32 offen offset:1024 lds
    v_mfma_f32_16x16x32_bf16 v[76:79], v[136:139], a[44:47], v[76:79]
    s_add_u32 s33, s55, 36864
    buffer_load_dwordx4 a[176:179], v228, s[8:11], s33 offen offset:0 sc1
    v_mfma_f32_16x16x32_bf16 v[76:79], v[140:143], a[60:63], v[76:79]
    buffer_load_dwordx4 a[12:15], v246, s[8:11], s35 offen offset:0 sc1
    s_waitcnt lgkmcnt(0)
    v_mfma_f32_16x16x32_bf16 v[48:51], v[144:147], a[32:35], v[48:51]
    ds_read_b64_tr_b16 v[128:129], v220 offset:16384
    v_mfma_f32_16x16x32_bf16 v[48:51], v[148:151], a[48:51], v[48:51]
    ds_read_b64_tr_b16 v[130:131], v220 offset:18432
    v_mfma_f32_16x16x32_bf16 v[52:55], v[144:147], a[36:39], v[52:55]
    ds_read_b64_tr_b16 v[132:133], v220 offset:24576
    v_mfma_f32_16x16x32_bf16 v[52:55], v[148:151], a[52:55], v[52:55]
    ds_read_b64_tr_b16 v[134:135], v220 offset:26624
    v_mfma_f32_16x16x32_bf16 v[80:83], v[144:147], a[40:43], v[80:83]
    ds_read_b64_tr_b16 v[136:137], v221 offset:16384
    v_mfma_f32_16x16x32_bf16 v[80:83], v[148:151], a[56:59], v[80:83]
    ds_read_b64_tr_b16 v[138:139], v221 offset:18432
    v_mfma_f32_16x16x32_bf16 v[84:87], v[144:147], a[44:47], v[84:87]
    ds_read_b64_tr_b16 v[140:141], v221 offset:24576
    v_mfma_f32_16x16x32_bf16 v[84:87], v[148:151], a[60:63], v[84:87]
    ds_read_b64_tr_b16 v[142:143], v221 offset:26624
    v_mfma_f32_16x16x32_bf16 v[56:59], v[152:155], a[32:35], v[56:59]
    buffer_load_dwordx4 a[16:19], v226, s[8:11], s35 offen offset:1024 sc1
    v_mfma_f32_16x16x32_bf16 v[56:59], v[156:159], a[48:51], v[56:59]
    v_mfma_f32_16x16x32_bf16 v[60:63], v[152:155], a[36:39], v[60:63]
    buffer_load_dwordx4 a[20:23], v227, s[8:11], s35 offen offset:1024 sc1
    v_mfma_f32_16x16x32_bf16 v[60:63], v[156:159], a[52:55], v[60:63]
    v_mfma_f32_16x16x32_bf16 v[88:91], v[152:155], a[40:43], v[88:91]
    buffer_load_dwordx4 a[24:27], v245, s[8:11], s35 offen offset:1024 sc1
    v_mfma_f32_16x16x32_bf16 v[88:91], v[156:159], a[56:59], v[88:91]
    v_mfma_f32_16x16x32_bf16 v[92:95], v[152:155], a[44:47], v[92:95]
    buffer_load_dwordx4 a[180:183], v228, s[8:11], s33 offen offset:1024 sc1
    v_mfma_f32_16x16x32_bf16 v[92:95], v[156:159], a[60:63], v[92:95]
    buffer_load_dwordx4 a[28:31], v246, s[8:11], s35 offen offset:1024 sc1
    s_waitcnt lgkmcnt(0)
    v_mfma_f32_16x16x32_bf16 v[0:3], v[128:131], a[32:35], v[0:3]
    ds_read_b64_tr_b16 v[144:145], v222 offset:16384
    v_mfma_f32_16x16x32_bf16 v[0:3], v[132:135], a[48:51], v[0:3]
    ds_read_b64_tr_b16 v[146:147], v222 offset:18432
    v_mfma_f32_16x16x32_bf16 v[4:7], v[128:131], a[36:39], v[4:7]
    ds_read_b64_tr_b16 v[148:149], v222 offset:24576
    v_mfma_f32_16x16x32_bf16 v[4:7], v[132:135], a[52:55], v[4:7]
    ds_read_b64_tr_b16 v[150:151], v222 offset:26624
    v_mfma_f32_16x16x32_bf16 v[96:99], v[128:131], a[40:43], v[96:99]
    ds_read_b64_tr_b16 v[152:153], v223 offset:16384
    v_mfma_f32_16x16x32_bf16 v[96:99], v[132:135], a[56:59], v[96:99]
    ds_read_b64_tr_b16 v[154:155], v223 offset:18432
    v_mfma_f32_16x16x32_bf16 v[100:103], v[128:131], a[44:47], v[100:103]
    ds_read_b64_tr_b16 v[156:157], v223 offset:24576
    v_mfma_f32_16x16x32_bf16 v[100:103], v[132:135], a[60:63], v[100:103]
    ds_read_b64_tr_b16 v[158:159], v223 offset:26624
    v_mfma_f32_16x16x32_bf16 v[8:11], v[136:139], a[32:35], v[8:11]
    v_mfma_f32_16x16x32_bf16 v[8:11], v[140:143], a[48:51], v[8:11]
    s_add_u32 m0, s38, 122880
    s_add_u32 s32, s37, 2031616
    v_mfma_f32_16x16x32_bf16 v[12:15], v[136:139], a[36:39], v[12:15]
    buffer_load_dwordx4 v224, s[12:15], s32 offen lds
    v_mfma_f32_16x16x32_bf16 v[12:15], v[140:143], a[52:55], v[12:15]
    v_mfma_f32_16x16x32_bf16 v[104:107], v[136:139], a[40:43], v[104:107]
    v_mfma_f32_16x16x32_bf16 v[104:107], v[140:143], a[56:59], v[104:107]
    buffer_load_dwordx4 v225, s[12:15], s32 offen offset:1024 lds
    v_mfma_f32_16x16x32_bf16 v[108:111], v[136:139], a[44:47], v[108:111]
    buffer_load_dwordx4 a[184:187], v228, s[8:11], s33 offen offset:2048 sc1
    v_mfma_f32_16x16x32_bf16 v[108:111], v[140:143], a[60:63], v[108:111]
    s_waitcnt vmcnt(63) lgkmcnt(0)
    s_barrier
    v_mfma_f32_16x16x32_bf16 v[16:19], v[144:147], a[32:35], v[16:19]
    ds_read_b64_tr_b16 v[128:129], v216 offset:32768
    v_mfma_f32_16x16x32_bf16 v[16:19], v[148:151], a[48:51], v[16:19]
    ds_read_b64_tr_b16 v[130:131], v216 offset:34816
    v_mfma_f32_16x16x32_bf16 v[20:23], v[144:147], a[36:39], v[20:23]
    ds_read_b64_tr_b16 v[132:133], v216 offset:40960
    v_mfma_f32_16x16x32_bf16 v[20:23], v[148:151], a[52:55], v[20:23]
    ds_read_b64_tr_b16 v[134:135], v216 offset:43008
    v_mfma_f32_16x16x32_bf16 v[112:115], v[144:147], a[40:43], v[112:115]
    ds_read_b64_tr_b16 v[136:137], v217 offset:32768
    v_mfma_f32_16x16x32_bf16 v[112:115], v[148:151], a[56:59], v[112:115]
    ds_read_b64_tr_b16 v[138:139], v217 offset:34816
    v_mfma_f32_16x16x32_bf16 v[116:119], v[144:147], a[44:47], v[116:119]
    ds_read_b64_tr_b16 v[140:141], v217 offset:40960
    v_mfma_f32_16x16x32_bf16 v[116:119], v[148:151], a[60:63], v[116:119]
    ds_read_b64_tr_b16 v[142:143], v217 offset:43008
    v_mfma_f32_16x16x32_bf16 v[24:27], v[152:155], a[32:35], v[24:27]
    v_mfma_f32_16x16x32_bf16 v[24:27], v[156:159], a[48:51], v[24:27]
    v_mfma_f32_16x16x32_bf16 v[28:31], v[152:155], a[36:39], v[28:31]
    v_mfma_f32_16x16x32_bf16 v[28:31], v[156:159], a[52:55], v[28:31]
    v_mfma_f32_16x16x32_bf16 v[120:123], v[152:155], a[40:43], v[120:123]
    v_mfma_f32_16x16x32_bf16 v[120:123], v[156:159], a[56:59], v[120:123]
    v_mfma_f32_16x16x32_bf16 v[124:127], v[152:155], a[44:47], v[124:127]
    buffer_load_dwordx4 a[188:191], v228, s[8:11], s33 offen offset:3072 sc1
    v_mfma_f32_16x16x32_bf16 v[124:127], v[156:159], a[60:63], v[124:127]
    buffer_load_dwordx4 a[32:35], v226, s[8:11], s35 offen offset:2048 sc1
    s_waitcnt vmcnt(37) lgkmcnt(0)
    v_mfma_f32_16x16x32_bf16 v[64:67], v[128:131], a[72:75], v[64:67]
    ds_read_b64_tr_b16 v[144:145], v218 offset:32768
    v_mfma_f32_16x16x32_bf16 v[64:67], v[132:135], a[88:91], v[64:67]
    ds_read_b64_tr_b16 v[146:147], v218 offset:34816
    v_mfma_f32_16x16x32_bf16 v[68:71], v[128:131], a[76:79], v[68:71]
    ds_read_b64_tr_b16 v[148:149], v218 offset:40960
    buffer_load_dwordx4 a[36:39], v227, s[8:11], s35 offen offset:2048 sc1
    v_mfma_f32_16x16x32_bf16 v[68:71], v[132:135], a[92:95], v[68:71]
    ds_read_b64_tr_b16 v[150:151], v218 offset:43008
    v_mfma_f32_16x16x32_bf16 v[72:75], v[136:139], a[72:75], v[72:75]
    ds_read_b64_tr_b16 v[152:153], v219 offset:32768
    v_mfma_f32_16x16x32_bf16 v[72:75], v[140:143], a[88:91], v[72:75]
    ds_read_b64_tr_b16 v[154:155], v219 offset:34816
    v_mfma_f32_16x16x32_bf16 v[76:79], v[136:139], a[76:79], v[76:79]
    ds_read_b64_tr_b16 v[156:157], v219 offset:40960
    buffer_load_dwordx4 a[40:43], v245, s[8:11], s35 offen offset:2048 sc1
    v_mfma_f32_16x16x32_bf16 v[76:79], v[140:143], a[92:95], v[76:79]
    ds_read_b64_tr_b16 v[158:159], v219 offset:43008
    s_waitcnt lgkmcnt(4)
    v_mfma_f32_16x16x32_bf16 v[80:83], v[144:147], a[72:75], v[80:83]
    ds_read_b64_tr_b16 v[128:129], v220 offset:32768
    v_mfma_f32_16x16x32_bf16 v[80:83], v[148:151], a[88:91], v[80:83]
    ds_read_b64_tr_b16 v[130:131], v220 offset:34816
    v_mfma_f32_16x16x32_bf16 v[84:87], v[144:147], a[76:79], v[84:87]
    ds_read_b64_tr_b16 v[132:133], v220 offset:40960
    buffer_load_dwordx4 a[44:47], v246, s[8:11], s35 offen offset:2048 sc1
    v_mfma_f32_16x16x32_bf16 v[84:87], v[148:151], a[92:95], v[84:87]
    ds_read_b64_tr_b16 v[134:135], v220 offset:43008
    s_waitcnt lgkmcnt(4)
    v_mfma_f32_16x16x32_bf16 v[88:91], v[152:155], a[72:75], v[88:91]
    ds_read_b64_tr_b16 v[136:137], v221 offset:32768
    v_mfma_f32_16x16x32_bf16 v[88:91], v[156:159], a[88:91], v[88:91]
    ds_read_b64_tr_b16 v[138:139], v221 offset:34816
    s_mov_b32 s32, 0
    buffer_load_dwordx4 v[192:195], v229, s[16:19], s32 offen
    v_mfma_f32_16x16x32_bf16 v[92:95], v[152:155], a[76:79], v[92:95]
    ds_read_b64_tr_b16 v[140:141], v221 offset:40960
    buffer_load_dwordx4 a[48:51], v226, s[8:11], s35 offen offset:3072 sc1
    v_mfma_f32_16x16x32_bf16 v[92:95], v[156:159], a[92:95], v[92:95]
    ds_read_b64_tr_b16 v[142:143], v221 offset:43008
    s_waitcnt lgkmcnt(4)
    v_mfma_f32_16x16x32_bf16 v[0:3], v[128:131], a[224:227], v[0:3]
    ds_read_b64_tr_b16 v[144:145], v222 offset:32768
    v_mfma_f32_16x16x32_bf16 v[0:3], v[132:135], a[232:235], v[0:3]
    ds_read_b64_tr_b16 v[146:147], v222 offset:34816
    v_mfma_f32_16x16x32_bf16 v[4:7], v[128:131], a[228:231], v[4:7]
    ds_read_b64_tr_b16 v[148:149], v222 offset:40960
    v_mfma_f32_16x16x32_bf16 v[4:7], v[132:135], a[236:239], v[4:7]
    ds_read_b64_tr_b16 v[150:151], v222 offset:43008
    v_mfma_f32_16x16x32_bf16 v[96:99], v[128:131], a[72:75], v[96:99]
    ds_read_b64_tr_b16 v[152:153], v223 offset:32768
    v_mfma_f32_16x16x32_bf16 v[96:99], v[132:135], a[88:91], v[96:99]
    ds_read_b64_tr_b16 v[154:155], v223 offset:34816
    s_mov_b32 s32, 16384
    buffer_load_dwordx4 v[196:199], v229, s[16:19], s32 offen
    v_mfma_f32_16x16x32_bf16 v[100:103], v[128:131], a[76:79], v[100:103]
    ds_read_b64_tr_b16 v[156:157], v223 offset:40960
    v_mfma_f32_16x16x32_bf16 v[100:103], v[132:135], a[92:95], v[100:103]
    ds_read_b64_tr_b16 v[158:159], v223 offset:43008
    s_waitcnt lgkmcnt(8)
    v_mfma_f32_16x16x32_bf16 v[8:11], v[136:139], a[224:227], v[8:11]
    buffer_load_dwordx4 a[52:55], v227, s[8:11], s35 offen offset:3072 sc1
    v_mfma_f32_16x16x32_bf16 v[8:11], v[140:143], a[232:235], v[8:11]
    v_mfma_f32_16x16x32_bf16 v[12:15], v[136:139], a[228:231], v[12:15]
    v_mfma_f32_16x16x32_bf16 v[12:15], v[140:143], a[236:239], v[12:15]
    buffer_load_dwordx4 a[56:59], v245, s[8:11], s35 offen offset:3072 sc1
    v_mfma_f32_16x16x32_bf16 v[104:107], v[136:139], a[72:75], v[104:107]
    v_mfma_f32_16x16x32_bf16 v[104:107], v[140:143], a[88:91], v[104:107]
    s_mov_b32 s32, 32768
    buffer_load_dwordx4 v[200:203], v229, s[16:19], s32 offen
    v_mfma_f32_16x16x32_bf16 v[108:111], v[136:139], a[76:79], v[108:111]
    v_mfma_f32_16x16x32_bf16 v[108:111], v[140:143], a[92:95], v[108:111]
    buffer_load_dwordx4 a[60:63], v246, s[8:11], s35 offen offset:3072 sc1
    s_waitcnt lgkmcnt(0)
    v_mfma_f32_16x16x32_bf16 v[16:19], v[144:147], a[224:227], v[16:19]
    ds_read_b64_tr_b16 v[128:129], v216 offset:49152
    v_mfma_f32_16x16x32_bf16 v[16:19], v[148:151], a[232:235], v[16:19]
    ds_read_b64_tr_b16 v[130:131], v216 offset:51200
    v_mfma_f32_16x16x32_bf16 v[20:23], v[144:147], a[228:231], v[20:23]
    ds_read_b64_tr_b16 v[132:133], v216 offset:57344
    v_mfma_f32_16x16x32_bf16 v[20:23], v[148:151], a[236:239], v[20:23]
    ds_read_b64_tr_b16 v[134:135], v216 offset:59392
    v_mfma_f32_16x16x32_bf16 v[112:115], v[144:147], a[72:75], v[112:115]
    ds_read_b64_tr_b16 v[136:137], v217 offset:49152
    v_mfma_f32_16x16x32_bf16 v[112:115], v[148:151], a[88:91], v[112:115]
    ds_read_b64_tr_b16 v[138:139], v217 offset:51200
    v_mfma_f32_16x16x32_bf16 v[116:119], v[144:147], a[76:79], v[116:119]
    ds_read_b64_tr_b16 v[140:141], v217 offset:57344
    v_mfma_f32_16x16x32_bf16 v[116:119], v[148:151], a[92:95], v[116:119]
    ds_read_b64_tr_b16 v[142:143], v217 offset:59392
    v_mfma_f32_16x16x32_bf16 v[24:27], v[152:155], a[224:227], v[24:27]
    v_mfma_f32_16x16x32_bf16 v[24:27], v[156:159], a[232:235], v[24:27]
    v_mfma_f32_16x16x32_bf16 v[28:31], v[152:155], a[228:231], v[28:31]
    v_mfma_f32_16x16x32_bf16 v[28:31], v[156:159], a[236:239], v[28:31]
    v_mfma_f32_16x16x32_bf16 v[120:123], v[152:155], a[72:75], v[120:123]
    v_mfma_f32_16x16x32_bf16 v[120:123], v[156:159], a[88:91], v[120:123]
    s_mov_b32 s32, 49152
    buffer_load_dwordx4 v[204:207], v229, s[16:19], s32 offen
    v_mfma_f32_16x16x32_bf16 v[124:127], v[152:155], a[76:79], v[124:127]
    v_mfma_f32_16x16x32_bf16 v[124:127], v[156:159], a[92:95], v[124:127]
    s_add_u32 s35, s35, 4096
    buffer_load_dwordx4 a[64:67], v226, s[8:11], s35 offen offset:0 sc1
    s_waitcnt vmcnt(33) lgkmcnt(0)
    v_mfma_f32_16x16x32_bf16 v[64:67], v[128:131], a[104:107], v[64:67]
    ds_read_b64_tr_b16 v[144:145], v218 offset:49152
    v_mfma_f32_16x16x32_bf16 v[64:67], v[132:135], a[120:123], v[64:67]
    ds_read_b64_tr_b16 v[146:147], v218 offset:51200
    v_mfma_f32_16x16x32_bf16 v[68:71], v[128:131], a[108:111], v[68:71]
    ds_read_b64_tr_b16 v[148:149], v218 offset:57344
    buffer_load_dwordx4 a[68:71], v227, s[8:11], s35 offen offset:0 sc1
    v_mfma_f32_16x16x32_bf16 v[68:71], v[132:135], a[124:127], v[68:71]
    ds_read_b64_tr_b16 v[150:151], v218 offset:59392
    v_mfma_f32_16x16x32_bf16 v[72:75], v[136:139], a[104:107], v[72:75]
    ds_read_b64_tr_b16 v[152:153], v219 offset:49152
    v_mfma_f32_16x16x32_bf16 v[72:75], v[140:143], a[120:123], v[72:75]
    ds_read_b64_tr_b16 v[154:155], v219 offset:51200
    v_mfma_f32_16x16x32_bf16 v[76:79], v[136:139], a[108:111], v[76:79]
    ds_read_b64_tr_b16 v[156:157], v219 offset:57344
    buffer_load_dwordx4 a[72:75], v245, s[8:11], s35 offen offset:0 sc1
    v_mfma_f32_16x16x32_bf16 v[76:79], v[140:143], a[124:127], v[76:79]
    ds_read_b64_tr_b16 v[158:159], v219 offset:59392
    s_waitcnt lgkmcnt(4)
    v_mfma_f32_16x16x32_bf16 v[80:83], v[144:147], a[104:107], v[80:83]
    ds_read_b64_tr_b16 v[128:129], v220 offset:49152
    v_mfma_f32_16x16x32_bf16 v[80:83], v[148:151], a[120:123], v[80:83]
    ds_read_b64_tr_b16 v[130:131], v220 offset:51200
    v_mfma_f32_16x16x32_bf16 v[84:87], v[144:147], a[108:111], v[84:87]
    ds_read_b64_tr_b16 v[132:133], v220 offset:57344
    buffer_load_dwordx4 a[76:79], v246, s[8:11], s35 offen offset:0 sc1
    v_mfma_f32_16x16x32_bf16 v[84:87], v[148:151], a[124:127], v[84:87]
    ds_read_b64_tr_b16 v[134:135], v220 offset:59392
    s_waitcnt lgkmcnt(4)
    v_mfma_f32_16x16x32_bf16 v[88:91], v[152:155], a[104:107], v[88:91]
    ds_read_b64_tr_b16 v[136:137], v221 offset:49152
    v_mfma_f32_16x16x32_bf16 v[88:91], v[156:159], a[120:123], v[88:91]
    ds_read_b64_tr_b16 v[138:139], v221 offset:51200
    buffer_load_dwordx4 v[208:211], v240, s[20:23], 0 offen
    v_mfma_f32_16x16x32_bf16 v[92:95], v[152:155], a[108:111], v[92:95]
    ds_read_b64_tr_b16 v[140:141], v221 offset:57344
    buffer_load_dwordx4 a[80:83], v226, s[8:11], s35 offen offset:1024 sc1
    v_mfma_f32_16x16x32_bf16 v[92:95], v[156:159], a[124:127], v[92:95]
    ds_read_b64_tr_b16 v[142:143], v221 offset:59392
    s_waitcnt lgkmcnt(4)
    v_mfma_f32_16x16x32_bf16 v[0:3], v[128:131], a[240:243], v[0:3]
    ds_read_b64_tr_b16 v[144:145], v222 offset:49152
    v_mfma_f32_16x16x32_bf16 v[0:3], v[132:135], a[248:251], v[0:3]
    ds_read_b64_tr_b16 v[146:147], v222 offset:51200
    v_mfma_f32_16x16x32_bf16 v[4:7], v[128:131], a[244:247], v[4:7]
    ds_read_b64_tr_b16 v[148:149], v222 offset:57344
    v_mfma_f32_16x16x32_bf16 v[4:7], v[132:135], a[252:255], v[4:7]
    ds_read_b64_tr_b16 v[150:151], v222 offset:59392
    v_mfma_f32_16x16x32_bf16 v[96:99], v[128:131], a[104:107], v[96:99]
    ds_read_b64_tr_b16 v[152:153], v223 offset:49152
    v_mfma_f32_16x16x32_bf16 v[96:99], v[132:135], a[120:123], v[96:99]
    ds_read_b64_tr_b16 v[154:155], v223 offset:51200
    s_mov_b32 s32, kc_tail-kc_pc0
    v_lshlrev_b32 v234, 7, v230
    buffer_load_dword v241, v234, s[56:59], s32 offen
    v_mfma_f32_16x16x32_bf16 v[100:103], v[128:131], a[108:111], v[100:103]
    ds_read_b64_tr_b16 v[156:157], v223 offset:57344
    v_mfma_f32_16x16x32_bf16 v[100:103], v[132:135], a[124:127], v[100:103]
    ds_read_b64_tr_b16 v[158:159], v223 offset:59392
    s_waitcnt lgkmcnt(8)
    v_mfma_f32_16x16x32_bf16 v[8:11], v[136:139], a[240:243], v[8:11]
    buffer_load_dwordx4 a[84:87], v227, s[8:11], s35 offen offset:1024 sc1
    v_mfma_f32_16x16x32_bf16 v[8:11], v[140:143], a[248:251], v[8:11]
    v_mfma_f32_16x16x32_bf16 v[12:15], v[136:139], a[244:247], v[12:15]
    v_mfma_f32_16x16x32_bf16 v[12:15], v[140:143], a[252:255], v[12:15]
    buffer_load_dwordx4 a[88:91], v245, s[8:11], s35 offen offset:1024 sc1
    v_mfma_f32_16x16x32_bf16 v[104:107], v[136:139], a[104:107], v[104:107]
    v_mfma_f32_16x16x32_bf16 v[104:107], v[140:143], a[120:123], v[104:107]
    v_mfma_f32_16x16x32_bf16 v[108:111], v[136:139], a[108:111], v[108:111]
    v_mfma_f32_16x16x32_bf16 v[108:111], v[140:143], a[124:127], v[108:111]
    buffer_load_dwordx4 a[92:95], v246, s[8:11], s35 offen offset:1024 sc1
    s_waitcnt vmcnt(24) lgkmcnt(0)
    s_barrier
    v_mfma_f32_16x16x32_bf16 v[16:19], v[144:147], a[240:243], v[16:19]
    v_xor_b32 v220, 0x10000, v220
    ds_read_b64_tr_b16 v[128:129], v220 offset:0
    v_mfma_f32_16x16x32_bf16 v[16:19], v[148:151], a[248:251], v[16:19]
    ds_read_b64_tr_b16 v[130:131], v220 offset:2048
    v_mfma_f32_16x16x32_bf16 v[20:23], v[144:147], a[244:247], v[20:23]
    ds_read_b64_tr_b16 v[132:133], v220 offset:8192
    v_mfma_f32_16x16x32_bf16 v[20:23], v[148:151], a[252:255], v[20:23]
    ds_read_b64_tr_b16 v[134:135], v220 offset:10240
    v_mfma_f32_16x16x32_bf16 v[112:115], v[144:147], a[104:107], v[112:115]
    v_xor_b32 v221, 0x10000, v221
    ds_read_b64_tr_b16 v[136:137], v221 offset:0
    v_mfma_f32_16x16x32_bf16 v[112:115], v[148:151], a[120:123], v[112:115]
    ds_read_b64_tr_b16 v[138:139], v221 offset:2048
    v_mfma_f32_16x16x32_bf16 v[116:119], v[144:147], a[108:111], v[116:119]
    ds_read_b64_tr_b16 v[140:141], v221 offset:8192
    v_mfma_f32_16x16x32_bf16 v[116:119], v[148:151], a[124:127], v[116:119]
    ds_read_b64_tr_b16 v[142:143], v221 offset:10240
    v_mfma_f32_16x16x32_bf16 v[24:27], v[152:155], a[240:243], v[24:27]
    v_mfma_f32_16x16x32_bf16 v[24:27], v[156:159], a[248:251], v[24:27]
    v_mfma_f32_16x16x32_bf16 v[28:31], v[152:155], a[244:247], v[28:31]
    v_mfma_f32_16x16x32_bf16 v[28:31], v[156:159], a[252:255], v[28:31]
    v_mfma_f32_16x16x32_bf16 v[120:123], v[152:155], a[104:107], v[120:123]
    v_mfma_f32_16x16x32_bf16 v[120:123], v[156:159], a[120:123], v[120:123]
    v_mfma_f32_16x16x32_bf16 v[124:127], v[152:155], a[108:111], v[124:127]
    v_mfma_f32_16x16x32_bf16 v[124:127], v[156:159], a[124:127], v[124:127]
    buffer_load_dwordx4 a[96:99], v226, s[8:11], s35 offen offset:2048 sc1
    s_waitcnt vmcnt(27) lgkmcnt(4)
    v_mfma_f32_16x16x32_bf16 v[96:99], v[128:131], a[8:11], v[96:99]
    v_xor_b32 v222, 0x10000, v222
    ds_read_b64_tr_b16 v[144:145], v222 offset:0
    v_mfma_f32_16x16x32_bf16 v[96:99], v[132:135], a[24:27], v[96:99]
    ds_read_b64_tr_b16 v[146:147], v222 offset:2048
    v_mfma_f32_16x16x32_bf16 v[100:103], v[128:131], a[12:15], v[100:103]
    ds_read_b64_tr_b16 v[148:149], v222 offset:8192
    buffer_load_dwordx4 a[100:103], v227, s[8:11], s35 offen offset:2048 sc1
    v_mfma_f32_16x16x32_bf16 v[100:103], v[132:135], a[28:31], v[100:103]
    ds_read_b64_tr_b16 v[150:151], v222 offset:10240
    s_waitcnt lgkmcnt(4)
    v_mfma_f32_16x16x32_bf16 v[104:107], v[136:139], a[8:11], v[104:107]
    v_xor_b32 v223, 0x10000, v223
    ds_read_b64_tr_b16 v[152:153], v223 offset:0
    v_mfma_f32_16x16x32_bf16 v[104:107], v[140:143], a[24:27], v[104:107]
    ds_read_b64_tr_b16 v[154:155], v223 offset:2048
    v_mfma_f32_16x16x32_bf16 v[108:111], v[136:139], a[12:15], v[108:111]
    ds_read_b64_tr_b16 v[156:157], v223 offset:8192
    buffer_load_dwordx4 a[104:107], v245, s[8:11], s35 offen offset:2048 sc1
    v_mfma_f32_16x16x32_bf16 v[108:111], v[140:143], a[28:31], v[108:111]
    ds_read_b64_tr_b16 v[158:159], v223 offset:10240
    s_waitcnt lgkmcnt(4)
    v_mfma_f32_16x16x32_bf16 v[112:115], v[144:147], a[8:11], v[112:115]
    ds_read_b64_tr_b16 v[128:129], v220 offset:16384
    v_mfma_f32_16x16x32_bf16 v[112:115], v[148:151], a[24:27], v[112:115]
    ds_read_b64_tr_b16 v[130:131], v220 offset:18432
    v_mfma_f32_16x16x32_bf16 v[116:119], v[144:147], a[12:15], v[116:119]
    ds_read_b64_tr_b16 v[132:133], v220 offset:24576
    buffer_load_dwordx4 a[108:111], v246, s[8:11], s35 offen offset:2048 sc1
    v_mfma_f32_16x16x32_bf16 v[116:119], v[148:151], a[28:31], v[116:119]
    ds_read_b64_tr_b16 v[134:135], v220 offset:26624
    s_waitcnt lgkmcnt(4)
    v_mfma_f32_16x16x32_bf16 v[120:123], v[152:155], a[8:11], v[120:123]
    ds_read_b64_tr_b16 v[136:137], v221 offset:16384
    v_mfma_f32_16x16x32_bf16 v[120:123], v[156:159], a[24:27], v[120:123]
    ds_read_b64_tr_b16 v[138:139], v221 offset:18432
    v_mfma_f32_16x16x32_bf16 v[124:127], v[152:155], a[12:15], v[124:127]
    ds_read_b64_tr_b16 v[140:141], v221 offset:24576
    buffer_load_dwordx4 a[112:115], v226, s[8:11], s35 offen offset:3072 sc1
    v_mfma_f32_16x16x32_bf16 v[124:127], v[156:159], a[28:31], v[124:127]
    ds_read_b64_tr_b16 v[142:143], v221 offset:26624
    s_waitcnt vmcnt(16) lgkmcnt(4)
    v_mfma_f32_16x16x32_bf16 v[96:99], v[128:131], a[40:43], v[96:99]
    ds_read_b64_tr_b16 v[144:145], v222 offset:16384
    v_mfma_f32_16x16x32_bf16 v[96:99], v[132:135], a[56:59], v[96:99]
    ds_read_b64_tr_b16 v[146:147], v222 offset:18432
    v_mfma_f32_16x16x32_bf16 v[100:103], v[128:131], a[44:47], v[100:103]
    ds_read_b64_tr_b16 v[148:149], v222 offset:24576
    buffer_load_dwordx4 a[116:119], v227, s[8:11], s35 offen offset:3072 sc1
    v_mfma_f32_16x16x32_bf16 v[100:103], v[132:135], a[60:63], v[100:103]
    ds_read_b64_tr_b16 v[150:151], v222 offset:26624
    s_waitcnt lgkmcnt(4)
    v_mfma_f32_16x16x32_bf16 v[104:107], v[136:139], a[40:43], v[104:107]
    ds_read_b64_tr_b16 v[152:153], v223 offset:16384
    v_mfma_f32_16x16x32_bf16 v[104:107], v[140:143], a[56:59], v[104:107]
    ds_read_b64_tr_b16 v[154:155], v223 offset:18432
    v_mfma_f32_16x16x32_bf16 v[108:111], v[136:139], a[44:47], v[108:111]
    ds_read_b64_tr_b16 v[156:157], v223 offset:24576
    buffer_load_dwordx4 a[120:123], v245, s[8:11], s35 offen offset:3072 sc1
    v_mfma_f32_16x16x32_bf16 v[108:111], v[140:143], a[60:63], v[108:111]
    ds_read_b64_tr_b16 v[158:159], v223 offset:26624
    s_waitcnt lgkmcnt(4)
    v_mfma_f32_16x16x32_bf16 v[112:115], v[144:147], a[40:43], v[112:115]
    ds_read_b64_tr_b16 v[128:129], v220 offset:32768
    v_mfma_f32_16x16x32_bf16 v[112:115], v[148:151], a[56:59], v[112:115]
    ds_read_b64_tr_b16 v[130:131], v220 offset:34816
    v_mfma_f32_16x16x32_bf16 v[116:119], v[144:147], a[44:47], v[116:119]
    ds_read_b64_tr_b16 v[132:133], v220 offset:40960
    buffer_load_dwordx4 a[124:127], v246, s[8:11], s35 offen offset:3072 sc1
    v_mfma_f32_16x16x32_bf16 v[116:119], v[148:151], a[60:63], v[116:119]
    ds_read_b64_tr_b16 v[134:135], v220 offset:43008
    s_waitcnt lgkmcnt(4)
    v_mfma_f32_16x16x32_bf16 v[120:123], v[152:155], a[40:43], v[120:123]
    ds_read_b64_tr_b16 v[136:137], v221 offset:32768
    v_mfma_f32_16x16x32_bf16 v[120:123], v[156:159], a[56:59], v[120:123]
    ds_read_b64_tr_b16 v[138:139], v221 offset:34816
    v_mfma_f32_16x16x32_bf16 v[124:127], v[152:155], a[44:47], v[124:127]
    ds_read_b64_tr_b16 v[140:141], v221 offset:40960
    v_mfma_f32_16x16x32_bf16 v[124:127], v[156:159], a[60:63], v[124:127]
    ds_read_b64_tr_b16 v[142:143], v221 offset:43008
    s_waitcnt vmcnt(8) lgkmcnt(4)
    v_mfma_f32_16x16x32_bf16 v[96:99], v[128:131], a[72:75], v[96:99]
    ds_read_b64_tr_b16 v[144:145], v222 offset:32768
    v_mfma_f32_16x16x32_bf16 v[96:99], v[132:135], a[88:91], v[96:99]
    ds_read_b64_tr_b16 v[146:147], v222 offset:34816
    s_xor_b32 s7, s39, 24
    v_mfma_f32_16x16x32_bf16 v[100:103], v[128:131], a[76:79], v[100:103]
    ds_read_b64_tr_b16 v[148:149], v222 offset:40960
    v_mfma_f32_16x16x32_bf16 v[100:103], v[132:135], a[92:95], v[100:103]
    ds_read_b64_tr_b16 v[150:151], v222 offset:43008
    s_waitcnt lgkmcnt(4)
    v_mfma_f32_16x16x32_bf16 v[104:107], v[136:139], a[72:75], v[104:107]
    ds_read_b64_tr_b16 v[152:153], v223 offset:32768
    v_mfma_f32_16x16x32_bf16 v[104:107], v[140:143], a[88:91], v[104:107]
    ds_read_b64_tr_b16 v[154:155], v223 offset:34816
    s_mul_i32 s7, s7, 12288
    v_mfma_f32_16x16x32_bf16 v[108:111], v[136:139], a[76:79], v[108:111]
    ds_read_b64_tr_b16 v[156:157], v223 offset:40960
    s_add_u32 s7, s7, 0x5002000
    v_mfma_f32_16x16x32_bf16 v[108:111], v[140:143], a[92:95], v[108:111]
    ds_read_b64_tr_b16 v[158:159], v223 offset:43008
    s_waitcnt lgkmcnt(4)
    v_mfma_f32_16x16x32_bf16 v[112:115], v[144:147], a[72:75], v[112:115]
    ds_read_b64_tr_b16 v[128:129], v220 offset:49152
    v_mfma_f32_16x16x32_bf16 v[112:115], v[148:151], a[88:91], v[112:115]
    ds_read_b64_tr_b16 v[130:131], v220 offset:51200
    s_xor_b32 s37, s39, 8
    v_mfma_f32_16x16x32_bf16 v[116:119], v[144:147], a[76:79], v[116:119]
    ds_read_b64_tr_b16 v[132:133], v220 offset:57344
    v_mfma_f32_16x16x32_bf16 v[116:119], v[148:151], a[92:95], v[116:119]
    ds_read_b64_tr_b16 v[134:135], v220 offset:59392
    s_waitcnt lgkmcnt(4)
    v_mfma_f32_16x16x32_bf16 v[120:123], v[152:155], a[72:75], v[120:123]
    ds_read_b64_tr_b16 v[136:137], v221 offset:49152
    v_mfma_f32_16x16x32_bf16 v[120:123], v[156:159], a[88:91], v[120:123]
    ds_read_b64_tr_b16 v[138:139], v221 offset:51200
    s_mul_i32 s37, s37, 12288
    v_mfma_f32_16x16x32_bf16 v[124:127], v[152:155], a[76:79], v[124:127]
    ds_read_b64_tr_b16 v[140:141], v221 offset:57344
    s_add_u32 s37, s37, 0x5000000
    v_mfma_f32_16x16x32_bf16 v[124:127], v[156:159], a[92:95], v[124:127]
    ds_read_b64_tr_b16 v[142:143], v221 offset:59392
    s_waitcnt vmcnt(0) lgkmcnt(4)
    v_mfma_f32_16x16x32_bf16 v[96:99], v[128:131], a[104:107], v[96:99]
    ds_read_b64_tr_b16 v[144:145], v222 offset:49152
    v_mfma_f32_16x16x32_bf16 v[96:99], v[132:135], a[120:123], v[96:99]
    ds_read_b64_tr_b16 v[146:147], v222 offset:51200
    s_xor_b32 s38, s39, 16
    v_mfma_f32_16x16x32_bf16 v[100:103], v[128:131], a[108:111], v[100:103]
    ds_read_b64_tr_b16 v[148:149], v222 offset:57344
    v_mfma_f32_16x16x32_bf16 v[100:103], v[132:135], a[124:127], v[100:103]
    ds_read_b64_tr_b16 v[150:151], v222 offset:59392
    s_waitcnt lgkmcnt(4)
    v_mfma_f32_16x16x32_bf16 v[104:107], v[136:139], a[104:107], v[104:107]
    ds_read_b64_tr_b16 v[152:153], v223 offset:49152
    v_mfma_f32_16x16x32_bf16 v[104:107], v[140:143], a[120:123], v[104:107]
    ds_read_b64_tr_b16 v[154:155], v223 offset:51200
    s_mul_i32 s38, s38, 12288
    v_mfma_f32_16x16x32_bf16 v[108:111], v[136:139], a[108:111], v[108:111]
    ds_read_b64_tr_b16 v[156:157], v223 offset:57344
    s_add_u32 s38, s38, 0x5001000
    v_mfma_f32_16x16x32_bf16 v[108:111], v[140:143], a[124:127], v[108:111]
    ds_read_b64_tr_b16 v[158:159], v223 offset:59392
    s_waitcnt lgkmcnt(4)
    v_mfma_f32_16x16x32_bf16 v[112:115], v[144:147], a[104:107], v[112:115]
    ds_read_b64_tr_b16 v[128:129], v220 offset:0
    v_mfma_f32_16x16x32_bf16 v[112:115], v[148:151], a[120:123], v[112:115]
    ds_read_b64_tr_b16 v[130:131], v220 offset:2048
    v_mfma_f32_16x16x32_bf16 v[116:119], v[144:147], a[108:111], v[116:119]
    ds_read_b64_tr_b16 v[132:133], v220 offset:8192
    v_mfma_f32_16x16x32_bf16 v[116:119], v[148:151], a[124:127], v[116:119]
    ds_read_b64_tr_b16 v[134:135], v220 offset:10240
    s_waitcnt lgkmcnt(4)
    v_mfma_f32_16x16x32_bf16 v[120:123], v[152:155], a[104:107], v[120:123]
    ds_read_b64_tr_b16 v[136:137], v221 offset:0
    v_mfma_f32_16x16x32_bf16 v[120:123], v[156:159], a[120:123], v[120:123]
    ds_read_b64_tr_b16 v[138:139], v221 offset:2048
    v_mfma_f32_16x16x32_bf16 v[124:127], v[152:155], a[108:111], v[124:127]
    ds_read_b64_tr_b16 v[140:141], v221 offset:8192
    v_mfma_f32_16x16x32_bf16 v[124:127], v[156:159], a[124:127], v[124:127]
    ds_read_b64_tr_b16 v[142:143], v221 offset:10240
    s_waitcnt lgkmcnt(4)
    v_mfma_f32_16x16x32_bf16 v[0:3], v[128:131], a[0:3], v[0:3]
    ds_read_b64_tr_b16 v[144:145], v222 offset:0
    v_mfma_f32_16x16x32_bf16 v[0:3], v[132:135], a[16:19], v[0:3]
    ds_read_b64_tr_b16 v[146:147], v222 offset:2048
    v_mfma_f32_16x16x32_bf16 v[4:7], v[128:131], a[4:7], v[4:7]
    ds_read_b64_tr_b16 v[148:149], v222 offset:8192
    v_mfma_f32_16x16x32_bf16 v[4:7], v[132:135], a[20:23], v[4:7]
    ds_read_b64_tr_b16 v[150:151], v222 offset:10240
    s_waitcnt lgkmcnt(4)
    v_mfma_f32_16x16x32_bf16 v[8:11], v[136:139], a[0:3], v[8:11]
    ds_read_b64_tr_b16 v[152:153], v223 offset:0
    v_mfma_f32_16x16x32_bf16 v[8:11], v[140:143], a[16:19], v[8:11]
    ds_read_b64_tr_b16 v[154:155], v223 offset:2048
    v_mfma_f32_16x16x32_bf16 v[12:15], v[136:139], a[4:7], v[12:15]
    ds_read_b64_tr_b16 v[156:157], v223 offset:8192
    v_mfma_f32_16x16x32_bf16 v[12:15], v[140:143], a[20:23], v[12:15]
    ds_read_b64_tr_b16 v[158:159], v223 offset:10240
    s_waitcnt lgkmcnt(4)
    v_mfma_f32_16x16x32_bf16 v[16:19], v[144:147], a[0:3], v[16:19]
    ds_read_b64_tr_b16 v[128:129], v220 offset:16384
    s_mul_i32 s33, s39, 12288
    s_add_u32 s33, s33, 0x5002000
    v_mfma_f32_16x16x32_bf16 v[16:19], v[148:151], a[16:19], v[16:19]
    ds_read_b64_tr_b16 v[130:131], v220 offset:18432
    v_mfma_f32_16x16x32_bf16 v[20:23], v[144:147], a[4:7], v[20:23]
    ds_read_b64_tr_b16 v[132:133], v220 offset:24576
    v_cvt_pk_bf16_f32 v96, v96, v97
    v_mfma_f32_16x16x32_bf16 v[20:23], v[148:151], a[20:23], v[20:23]
    ds_read_b64_tr_b16 v[134:135], v220 offset:26624
    v_cvt_pk_bf16_f32 v97, v98, v99
    s_waitcnt lgkmcnt(4)
    v_mfma_f32_16x16x32_bf16 v[24:27], v[152:155], a[0:3], v[24:27]
    ds_read_b64_tr_b16 v[136:137], v221 offset:16384
    v_cvt_pk_bf16_f32 v98, v100, v101
    v_mfma_f32_16x16x32_bf16 v[24:27], v[156:159], a[16:19], v[24:27]
    ds_read_b64_tr_b16 v[138:139], v221 offset:18432
    v_cvt_pk_bf16_f32 v99, v102, v103
    v_mfma_f32_16x16x32_bf16 v[28:31], v[152:155], a[4:7], v[28:31]
    ds_read_b64_tr_b16 v[140:141], v221 offset:24576
    v_min_u32_e64 v96, -2, v96
    v_mfma_f32_16x16x32_bf16 v[28:31], v[156:159], a[20:23], v[28:31]
    ds_read_b64_tr_b16 v[142:143], v221 offset:26624
    v_min_u32 v97, -2, v97
    s_waitcnt lgkmcnt(4)
    v_mfma_f32_16x16x32_bf16 v[0:3], v[128:131], a[32:35], v[0:3]
    ds_read_b64_tr_b16 v[144:145], v222 offset:16384
    v_min_u32_e64 v98, -2, v98
    v_mfma_f32_16x16x32_bf16 v[0:3], v[132:135], a[48:51], v[0:3]
    ds_read_b64_tr_b16 v[146:147], v222 offset:18432
    v_min_u32_e64 v99, -2, v99
    v_mfma_f32_16x16x32_bf16 v[4:7], v[128:131], a[36:39], v[4:7]
    ds_read_b64_tr_b16 v[148:149], v222 offset:24576
    buffer_store_dwordx4 v[96:99], v228, s[8:11], s33 offen offset:0 sc1
    v_mfma_f32_16x16x32_bf16 v[4:7], v[132:135], a[52:55], v[4:7]
    ds_read_b64_tr_b16 v[150:151], v222 offset:26624
    s_waitcnt lgkmcnt(4)
    v_mfma_f32_16x16x32_bf16 v[8:11], v[136:139], a[32:35], v[8:11]
    ds_read_b64_tr_b16 v[152:153], v223 offset:16384
    v_mfma_f32_16x16x32_bf16 v[8:11], v[140:143], a[48:51], v[8:11]
    ds_read_b64_tr_b16 v[154:155], v223 offset:18432
    v_mfma_f32_16x16x32_bf16 v[12:15], v[136:139], a[36:39], v[12:15]
    ds_read_b64_tr_b16 v[156:157], v223 offset:24576
    v_cvt_pk_bf16_f32 v100, v104, v105
    v_mfma_f32_16x16x32_bf16 v[12:15], v[140:143], a[52:55], v[12:15]
    ds_read_b64_tr_b16 v[158:159], v223 offset:26624
    v_cvt_pk_bf16_f32 v101, v106, v107
    s_waitcnt lgkmcnt(4)
    v_mfma_f32_16x16x32_bf16 v[16:19], v[144:147], a[32:35], v[16:19]
    ds_read_b64_tr_b16 v[128:129], v220 offset:32768
    v_cvt_pk_bf16_f32 v102, v108, v109
    v_mfma_f32_16x16x32_bf16 v[16:19], v[148:151], a[48:51], v[16:19]
    ds_read_b64_tr_b16 v[130:131], v220 offset:34816
    v_cvt_pk_bf16_f32 v103, v110, v111
    v_mfma_f32_16x16x32_bf16 v[20:23], v[144:147], a[36:39], v[20:23]
    ds_read_b64_tr_b16 v[132:133], v220 offset:40960
    v_min_u32_e64 v100, -2, v100
    v_mfma_f32_16x16x32_bf16 v[20:23], v[148:151], a[52:55], v[20:23]
    ds_read_b64_tr_b16 v[134:135], v220 offset:43008
    v_min_u32 v101, -2, v101
    s_waitcnt lgkmcnt(4)
    v_mfma_f32_16x16x32_bf16 v[24:27], v[152:155], a[32:35], v[24:27]
    ds_read_b64_tr_b16 v[136:137], v221 offset:32768
    v_min_u32_e64 v102, -2, v102
    v_mfma_f32_16x16x32_bf16 v[24:27], v[156:159], a[48:51], v[24:27]
    ds_read_b64_tr_b16 v[138:139], v221 offset:34816
    v_min_u32_e64 v103, -2, v103
    v_mfma_f32_16x16x32_bf16 v[28:31], v[152:155], a[36:39], v[28:31]
    ds_read_b64_tr_b16 v[140:141], v221 offset:40960
    buffer_store_dwordx4 v[100:103], v228, s[8:11], s33 offen offset:1024 sc1
    v_mfma_f32_16x16x32_bf16 v[28:31], v[156:159], a[52:55], v[28:31]
    ds_read_b64_tr_b16 v[142:143], v221 offset:43008
    s_waitcnt lgkmcnt(4)
    v_mfma_f32_16x16x32_bf16 v[0:3], v[128:131], a[64:67], v[0:3]
    ds_read_b64_tr_b16 v[144:145], v222 offset:32768
    v_mfma_f32_16x16x32_bf16 v[0:3], v[132:135], a[80:83], v[0:3]
    ds_read_b64_tr_b16 v[146:147], v222 offset:34816
    v_mfma_f32_16x16x32_bf16 v[4:7], v[128:131], a[68:71], v[4:7]
    ds_read_b64_tr_b16 v[148:149], v222 offset:40960
    v_cvt_pk_bf16_f32 v104, v112, v113
    v_mfma_f32_16x16x32_bf16 v[4:7], v[132:135], a[84:87], v[4:7]
    ds_read_b64_tr_b16 v[150:151], v222 offset:43008
    v_cvt_pk_bf16_f32 v105, v114, v115
    s_waitcnt lgkmcnt(4)
    v_mfma_f32_16x16x32_bf16 v[8:11], v[136:139], a[64:67], v[8:11]
    ds_read_b64_tr_b16 v[152:153], v223 offset:32768
    v_cvt_pk_bf16_f32 v106, v116, v117
    v_mfma_f32_16x16x32_bf16 v[8:11], v[140:143], a[80:83], v[8:11]
    ds_read_b64_tr_b16 v[154:155], v223 offset:34816
    v_cvt_pk_bf16_f32 v107, v118, v119
    v_mfma_f32_16x16x32_bf16 v[12:15], v[136:139], a[68:71], v[12:15]
    ds_read_b64_tr_b16 v[156:157], v223 offset:40960
    v_min_u32_e64 v104, -2, v104
    v_mfma_f32_16x16x32_bf16 v[12:15], v[140:143], a[84:87], v[12:15]
    ds_read_b64_tr_b16 v[158:159], v223 offset:43008
    v_min_u32 v105, -2, v105
    s_waitcnt lgkmcnt(4)
    v_mfma_f32_16x16x32_bf16 v[16:19], v[144:147], a[64:67], v[16:19]
    ds_read_b64_tr_b16 v[128:129], v220 offset:49152
    v_min_u32_e64 v106, -2, v106
    v_mfma_f32_16x16x32_bf16 v[16:19], v[148:151], a[80:83], v[16:19]
    ds_read_b64_tr_b16 v[130:131], v220 offset:51200
    v_min_u32_e64 v107, -2, v107
    v_mfma_f32_16x16x32_bf16 v[20:23], v[144:147], a[68:71], v[20:23]
    ds_read_b64_tr_b16 v[132:133], v220 offset:57344
    buffer_store_dwordx4 v[104:107], v228, s[8:11], s33 offen offset:2048 sc1
    v_mfma_f32_16x16x32_bf16 v[20:23], v[148:151], a[84:87], v[20:23]
    ds_read_b64_tr_b16 v[134:135], v220 offset:59392
    s_waitcnt lgkmcnt(4)
    v_mfma_f32_16x16x32_bf16 v[24:27], v[152:155], a[64:67], v[24:27]
    ds_read_b64_tr_b16 v[136:137], v221 offset:49152
    v_mfma_f32_16x16x32_bf16 v[24:27], v[156:159], a[80:83], v[24:27]
    ds_read_b64_tr_b16 v[138:139], v221 offset:51200
    v_mfma_f32_16x16x32_bf16 v[28:31], v[152:155], a[68:71], v[28:31]
    ds_read_b64_tr_b16 v[140:141], v221 offset:57344
    v_cvt_pk_bf16_f32 v108, v120, v121
    v_mfma_f32_16x16x32_bf16 v[28:31], v[156:159], a[84:87], v[28:31]
    ds_read_b64_tr_b16 v[142:143], v221 offset:59392
    v_cvt_pk_bf16_f32 v109, v122, v123
    s_waitcnt lgkmcnt(4)
    v_mfma_f32_16x16x32_bf16 v[0:3], v[128:131], a[96:99], v[0:3]
    ds_read_b64_tr_b16 v[144:145], v222 offset:49152
    v_cvt_pk_bf16_f32 v110, v124, v125
    v_mfma_f32_16x16x32_bf16 v[0:3], v[132:135], a[112:115], v[0:3]
    ds_read_b64_tr_b16 v[146:147], v222 offset:51200
    v_cvt_pk_bf16_f32 v111, v126, v127
    v_mfma_f32_16x16x32_bf16 v[4:7], v[128:131], a[100:103], v[4:7]
    ds_read_b64_tr_b16 v[148:149], v222 offset:57344
    v_min_u32_e64 v108, -2, v108
    v_mfma_f32_16x16x32_bf16 v[4:7], v[132:135], a[116:119], v[4:7]
    ds_read_b64_tr_b16 v[150:151], v222 offset:59392
    v_min_u32 v109, -2, v109
    s_waitcnt lgkmcnt(4)
    v_mfma_f32_16x16x32_bf16 v[8:11], v[136:139], a[96:99], v[8:11]
    ds_read_b64_tr_b16 v[152:153], v223 offset:49152
    v_min_u32_e64 v110, -2, v110
    v_mfma_f32_16x16x32_bf16 v[8:11], v[140:143], a[112:115], v[8:11]
    ds_read_b64_tr_b16 v[154:155], v223 offset:51200
    v_min_u32_e64 v111, -2, v111
    v_mfma_f32_16x16x32_bf16 v[12:15], v[136:139], a[100:103], v[12:15]
    ds_read_b64_tr_b16 v[156:157], v223 offset:57344
    buffer_store_dwordx4 v[108:111], v228, s[8:11], s33 offen offset:3072 sc1
    v_mfma_f32_16x16x32_bf16 v[12:15], v[140:143], a[116:119], v[12:15]
    ds_read_b64_tr_b16 v[158:159], v223 offset:59392
    s_waitcnt lgkmcnt(4)
    v_mfma_f32_16x16x32_bf16 v[16:19], v[144:147], a[96:99], v[16:19]
    v_xor_b32 v216, 0x10000, v216
    ds_read_b64_tr_b16 v[128:129], v216 offset:0
    v_mfma_f32_16x16x32_bf16 v[16:19], v[148:151], a[112:115], v[16:19]
    ds_read_b64_tr_b16 v[130:131], v216 offset:2048
    v_mfma_f32_16x16x32_bf16 v[20:23], v[144:147], a[100:103], v[20:23]
    ds_read_b64_tr_b16 v[132:133], v216 offset:8192
    v_mfma_f32_16x16x32_bf16 v[20:23], v[148:151], a[116:119], v[20:23]
    ds_read_b64_tr_b16 v[134:135], v216 offset:10240
    s_waitcnt lgkmcnt(4)
    v_mfma_f32_16x16x32_bf16 v[24:27], v[152:155], a[96:99], v[24:27]
    v_xor_b32 v217, 0x10000, v217
    ds_read_b64_tr_b16 v[136:137], v217 offset:0
    v_mfma_f32_16x16x32_bf16 v[24:27], v[156:159], a[112:115], v[24:27]
    ds_read_b64_tr_b16 v[138:139], v217 offset:2048
    v_mfma_f32_16x16x32_bf16 v[28:31], v[152:155], a[100:103], v[28:31]
    ds_read_b64_tr_b16 v[140:141], v217 offset:8192
    v_mfma_f32_16x16x32_bf16 v[28:31], v[156:159], a[116:119], v[28:31]
    ds_read_b64_tr_b16 v[142:143], v217 offset:10240
    s_waitcnt lgkmcnt(4)
    v_mfma_f32_16x16x32_bf16 v[64:67], v[128:131], a[8:11], v[64:67]
    v_xor_b32 v218, 0x10000, v218
    ds_read_b64_tr_b16 v[144:145], v218 offset:0
    v_mfma_f32_16x16x32_bf16 v[64:67], v[132:135], a[24:27], v[64:67]
    ds_read_b64_tr_b16 v[146:147], v218 offset:2048
    v_mfma_f32_16x16x32_bf16 v[68:71], v[128:131], a[12:15], v[68:71]
    ds_read_b64_tr_b16 v[148:149], v218 offset:8192
    v_mfma_f32_16x16x32_bf16 v[68:71], v[132:135], a[28:31], v[68:71]
    ds_read_b64_tr_b16 v[150:151], v218 offset:10240
    s_waitcnt lgkmcnt(4)
    v_mfma_f32_16x16x32_bf16 v[72:75], v[136:139], a[8:11], v[72:75]
    v_xor_b32 v219, 0x10000, v219
    ds_read_b64_tr_b16 v[152:153], v219 offset:0
    v_mfma_f32_16x16x32_bf16 v[72:75], v[140:143], a[24:27], v[72:75]
    ds_read_b64_tr_b16 v[154:155], v219 offset:2048
    v_mfma_f32_16x16x32_bf16 v[76:79], v[136:139], a[12:15], v[76:79]
    ds_read_b64_tr_b16 v[156:157], v219 offset:8192
    v_mfma_f32_16x16x32_bf16 v[76:79], v[140:143], a[28:31], v[76:79]
    ds_read_b64_tr_b16 v[158:159], v219 offset:10240
    s_waitcnt lgkmcnt(4)
    v_mfma_f32_16x16x32_bf16 v[80:83], v[144:147], a[8:11], v[80:83]
    ds_read_b64_tr_b16 v[128:129], v216 offset:16384
    s_mul_i32 s33, s39, 12288
    s_add_u32 s33, s33, 0x5000000
    v_mfma_f32_16x16x32_bf16 v[80:83], v[148:151], a[24:27], v[80:83]
    ds_read_b64_tr_b16 v[130:131], v216 offset:18432
    v_mfma_f32_16x16x32_bf16 v[84:87], v[144:147], a[12:15], v[84:87]
    ds_read_b64_tr_b16 v[132:133], v216 offset:24576
    v_cvt_pk_bf16_f32 v0, v0, v1
    v_mfma_f32_16x16x32_bf16 v[84:87], v[148:151], a[28:31], v[84:87]
    ds_read_b64_tr_b16 v[134:135], v216 offset:26624
    v_cvt_pk_bf16_f32 v1, v2, v3
    s_waitcnt lgkmcnt(4)
    v_mfma_f32_16x16x32_bf16 v[88:91], v[152:155], a[8:11], v[88:91]
    ds_read_b64_tr_b16 v[136:137], v217 offset:16384
    v_cvt_pk_bf16_f32 v2, v4, v5
    v_mfma_f32_16x16x32_bf16 v[88:91], v[156:159], a[24:27], v[88:91]
    ds_read_b64_tr_b16 v[138:139], v217 offset:18432
    v_cvt_pk_bf16_f32 v3, v6, v7
    v_mfma_f32_16x16x32_bf16 v[92:95], v[152:155], a[12:15], v[92:95]
    ds_read_b64_tr_b16 v[140:141], v217 offset:24576
    v_min_u32_e64 v0, -2, v0
    v_mfma_f32_16x16x32_bf16 v[92:95], v[156:159], a[28:31], v[92:95]
    ds_read_b64_tr_b16 v[142:143], v217 offset:26624
    v_min_u32 v1, -2, v1
    s_waitcnt lgkmcnt(4)
    v_mfma_f32_16x16x32_bf16 v[64:67], v[128:131], a[40:43], v[64:67]
    ds_read_b64_tr_b16 v[144:145], v218 offset:16384
    v_min_u32_e64 v2, -2, v2
    v_mfma_f32_16x16x32_bf16 v[64:67], v[132:135], a[56:59], v[64:67]
    ds_read_b64_tr_b16 v[146:147], v218 offset:18432
    v_min_u32_e64 v3, -2, v3
    v_mfma_f32_16x16x32_bf16 v[68:71], v[128:131], a[44:47], v[68:71]
    ds_read_b64_tr_b16 v[148:149], v218 offset:24576
    buffer_store_dwordx4 v[0:3], v228, s[8:11], s33 offen offset:0 sc1
    v_mfma_f32_16x16x32_bf16 v[68:71], v[132:135], a[60:63], v[68:71]
    ds_read_b64_tr_b16 v[150:151], v218 offset:26624
    s_waitcnt lgkmcnt(4)
    v_mfma_f32_16x16x32_bf16 v[72:75], v[136:139], a[40:43], v[72:75]
    ds_read_b64_tr_b16 v[152:153], v219 offset:16384
    v_mfma_f32_16x16x32_bf16 v[72:75], v[140:143], a[56:59], v[72:75]
    ds_read_b64_tr_b16 v[154:155], v219 offset:18432
    v_mfma_f32_16x16x32_bf16 v[76:79], v[136:139], a[44:47], v[76:79]
    ds_read_b64_tr_b16 v[156:157], v219 offset:24576
    v_cvt_pk_bf16_f32 v4, v8, v9
    v_mfma_f32_16x16x32_bf16 v[76:79], v[140:143], a[60:63], v[76:79]
    ds_read_b64_tr_b16 v[158:159], v219 offset:26624
    v_cvt_pk_bf16_f32 v5, v10, v11
    s_waitcnt lgkmcnt(4)
    v_mfma_f32_16x16x32_bf16 v[80:83], v[144:147], a[40:43], v[80:83]
    ds_read_b64_tr_b16 v[128:129], v216 offset:32768
    v_cvt_pk_bf16_f32 v6, v12, v13
    v_mfma_f32_16x16x32_bf16 v[80:83], v[148:151], a[56:59], v[80:83]
    ds_read_b64_tr_b16 v[130:131], v216 offset:34816
    v_cvt_pk_bf16_f32 v7, v14, v15
    v_mfma_f32_16x16x32_bf16 v[84:87], v[144:147], a[44:47], v[84:87]
    ds_read_b64_tr_b16 v[132:133], v216 offset:40960
    v_min_u32_e64 v4, -2, v4
    v_mfma_f32_16x16x32_bf16 v[84:87], v[148:151], a[60:63], v[84:87]
    ds_read_b64_tr_b16 v[134:135], v216 offset:43008
    v_min_u32 v5, -2, v5
    s_waitcnt lgkmcnt(4)
    v_mfma_f32_16x16x32_bf16 v[88:91], v[152:155], a[40:43], v[88:91]
    ds_read_b64_tr_b16 v[136:137], v217 offset:32768
    v_min_u32_e64 v6, -2, v6
    v_mfma_f32_16x16x32_bf16 v[88:91], v[156:159], a[56:59], v[88:91]
    ds_read_b64_tr_b16 v[138:139], v217 offset:34816
    v_min_u32_e64 v7, -2, v7
    v_mfma_f32_16x16x32_bf16 v[92:95], v[152:155], a[44:47], v[92:95]
    ds_read_b64_tr_b16 v[140:141], v217 offset:40960
    buffer_store_dwordx4 v[4:7], v228, s[8:11], s33 offen offset:1024 sc1
    v_mfma_f32_16x16x32_bf16 v[92:95], v[156:159], a[60:63], v[92:95]
    ds_read_b64_tr_b16 v[142:143], v217 offset:43008
    s_waitcnt lgkmcnt(4)
    v_mfma_f32_16x16x32_bf16 v[64:67], v[128:131], a[72:75], v[64:67]
    ds_read_b64_tr_b16 v[144:145], v218 offset:32768
    v_mfma_f32_16x16x32_bf16 v[64:67], v[132:135], a[88:91], v[64:67]
    ds_read_b64_tr_b16 v[146:147], v218 offset:34816
    v_mfma_f32_16x16x32_bf16 v[68:71], v[128:131], a[76:79], v[68:71]
    ds_read_b64_tr_b16 v[148:149], v218 offset:40960
    v_cvt_pk_bf16_f32 v8, v16, v17
    v_mfma_f32_16x16x32_bf16 v[68:71], v[132:135], a[92:95], v[68:71]
    ds_read_b64_tr_b16 v[150:151], v218 offset:43008
    v_cvt_pk_bf16_f32 v9, v18, v19
    s_waitcnt lgkmcnt(4)
    v_mfma_f32_16x16x32_bf16 v[72:75], v[136:139], a[72:75], v[72:75]
    ds_read_b64_tr_b16 v[152:153], v219 offset:32768
    v_cvt_pk_bf16_f32 v10, v20, v21
    v_mfma_f32_16x16x32_bf16 v[72:75], v[140:143], a[88:91], v[72:75]
    ds_read_b64_tr_b16 v[154:155], v219 offset:34816
    v_cvt_pk_bf16_f32 v11, v22, v23
    v_mfma_f32_16x16x32_bf16 v[76:79], v[136:139], a[76:79], v[76:79]
    ds_read_b64_tr_b16 v[156:157], v219 offset:40960
    v_min_u32_e64 v8, -2, v8
    v_mfma_f32_16x16x32_bf16 v[76:79], v[140:143], a[92:95], v[76:79]
    ds_read_b64_tr_b16 v[158:159], v219 offset:43008
    v_min_u32 v9, -2, v9
    s_waitcnt lgkmcnt(4)
    v_mfma_f32_16x16x32_bf16 v[80:83], v[144:147], a[72:75], v[80:83]
    ds_read_b64_tr_b16 v[128:129], v216 offset:49152
    v_min_u32_e64 v10, -2, v10
    v_mfma_f32_16x16x32_bf16 v[80:83], v[148:151], a[88:91], v[80:83]
    ds_read_b64_tr_b16 v[130:131], v216 offset:51200
    v_min_u32_e64 v11, -2, v11
    v_mfma_f32_16x16x32_bf16 v[84:87], v[144:147], a[76:79], v[84:87]
    ds_read_b64_tr_b16 v[132:133], v216 offset:57344
    buffer_store_dwordx4 v[8:11], v228, s[8:11], s33 offen offset:2048 sc1
    v_mfma_f32_16x16x32_bf16 v[84:87], v[148:151], a[92:95], v[84:87]
    ds_read_b64_tr_b16 v[134:135], v216 offset:59392
    s_waitcnt lgkmcnt(4)
    v_mfma_f32_16x16x32_bf16 v[88:91], v[152:155], a[72:75], v[88:91]
    ds_read_b64_tr_b16 v[136:137], v217 offset:49152
    v_mfma_f32_16x16x32_bf16 v[88:91], v[156:159], a[88:91], v[88:91]
    ds_read_b64_tr_b16 v[138:139], v217 offset:51200
    v_mfma_f32_16x16x32_bf16 v[92:95], v[152:155], a[76:79], v[92:95]
    ds_read_b64_tr_b16 v[140:141], v217 offset:57344
    v_cvt_pk_bf16_f32 v12, v24, v25
    v_mfma_f32_16x16x32_bf16 v[92:95], v[156:159], a[92:95], v[92:95]
    ds_read_b64_tr_b16 v[142:143], v217 offset:59392
    v_cvt_pk_bf16_f32 v13, v26, v27
    s_waitcnt lgkmcnt(4)
    v_mfma_f32_16x16x32_bf16 v[64:67], v[128:131], a[104:107], v[64:67]
    ds_read_b64_tr_b16 v[144:145], v218 offset:49152
    v_cvt_pk_bf16_f32 v14, v28, v29
    v_mfma_f32_16x16x32_bf16 v[64:67], v[132:135], a[120:123], v[64:67]
    ds_read_b64_tr_b16 v[146:147], v218 offset:51200
    v_cvt_pk_bf16_f32 v15, v30, v31
    v_mfma_f32_16x16x32_bf16 v[68:71], v[128:131], a[108:111], v[68:71]
    ds_read_b64_tr_b16 v[148:149], v218 offset:57344
    v_min_u32_e64 v12, -2, v12
    v_mfma_f32_16x16x32_bf16 v[68:71], v[132:135], a[124:127], v[68:71]
    ds_read_b64_tr_b16 v[150:151], v218 offset:59392
    v_min_u32 v13, -2, v13
    s_waitcnt lgkmcnt(4)
    v_mfma_f32_16x16x32_bf16 v[72:75], v[136:139], a[104:107], v[72:75]
    ds_read_b64_tr_b16 v[152:153], v219 offset:49152
    v_min_u32_e64 v14, -2, v14
    v_mfma_f32_16x16x32_bf16 v[72:75], v[140:143], a[120:123], v[72:75]
    ds_read_b64_tr_b16 v[154:155], v219 offset:51200
    v_min_u32_e64 v15, -2, v15
    v_mfma_f32_16x16x32_bf16 v[76:79], v[136:139], a[108:111], v[76:79]
    ds_read_b64_tr_b16 v[156:157], v219 offset:57344
    buffer_store_dwordx4 v[12:15], v228, s[8:11], s33 offen offset:3072 sc1
    v_mfma_f32_16x16x32_bf16 v[76:79], v[140:143], a[124:127], v[76:79]
    ds_read_b64_tr_b16 v[158:159], v219 offset:59392
    s_waitcnt lgkmcnt(4)
    v_mfma_f32_16x16x32_bf16 v[80:83], v[144:147], a[104:107], v[80:83]
    v_xor_b32 v216, 0x10000, v216
    ds_read_b64_tr_b16 v[128:129], v216 offset:32768
    v_mfma_f32_16x16x32_bf16 v[80:83], v[148:151], a[120:123], v[80:83]
    ds_read_b64_tr_b16 v[130:131], v216 offset:34816
    v_mfma_f32_16x16x32_bf16 v[84:87], v[144:147], a[108:111], v[84:87]
    ds_read_b64_tr_b16 v[132:133], v216 offset:40960
    v_mfma_f32_16x16x32_bf16 v[84:87], v[148:151], a[124:127], v[84:87]
    ds_read_b64_tr_b16 v[134:135], v216 offset:43008
    s_waitcnt lgkmcnt(4)
    v_mfma_f32_16x16x32_bf16 v[88:91], v[152:155], a[104:107], v[88:91]
    v_xor_b32 v217, 0x10000, v217
    ds_read_b64_tr_b16 v[136:137], v217 offset:32768
    v_mfma_f32_16x16x32_bf16 v[88:91], v[156:159], a[120:123], v[88:91]
    ds_read_b64_tr_b16 v[138:139], v217 offset:34816
    v_mfma_f32_16x16x32_bf16 v[92:95], v[152:155], a[108:111], v[92:95]
    ds_read_b64_tr_b16 v[140:141], v217 offset:40960
    v_mfma_f32_16x16x32_bf16 v[92:95], v[156:159], a[124:127], v[92:95]
    ds_read_b64_tr_b16 v[142:143], v217 offset:43008
    s_waitcnt lgkmcnt(4)
    v_mfma_f32_16x16x32_bf16 v[32:35], v[128:131], a[224:227], v[32:35]
    v_xor_b32 v218, 0x10000, v218
    ds_read_b64_tr_b16 v[144:145], v218 offset:32768
    v_mfma_f32_16x16x32_bf16 v[32:35], v[132:135], a[232:235], v[32:35]
    ds_read_b64_tr_b16 v[146:147], v218 offset:34816
    buffer_load_dwordx4 v[176:179], v228, s[8:11], s7 offen offset:0 sc1
    v_mfma_f32_16x16x32_bf16 v[36:39], v[128:131], a[228:231], v[36:39]
    ds_read_b64_tr_b16 v[148:149], v218 offset:40960
    v_mfma_f32_16x16x32_bf16 v[36:39], v[132:135], a[236:239], v[36:39]
    ds_read_b64_tr_b16 v[150:151], v218 offset:43008
    buffer_load_dwordx4 v[180:183], v228, s[8:11], s7 offen offset:1024 sc1
    s_waitcnt lgkmcnt(4)
    v_mfma_f32_16x16x32_bf16 v[40:43], v[136:139], a[224:227], v[40:43]
    v_xor_b32 v219, 0x10000, v219
    ds_read_b64_tr_b16 v[152:153], v219 offset:32768
    v_mfma_f32_16x16x32_bf16 v[40:43], v[140:143], a[232:235], v[40:43]
    ds_read_b64_tr_b16 v[154:155], v219 offset:34816
    buffer_load_dwordx4 v[184:187], v228, s[8:11], s7 offen offset:2048 sc1
    v_mfma_f32_16x16x32_bf16 v[44:47], v[136:139], a[228:231], v[44:47]
    ds_read_b64_tr_b16 v[156:157], v219 offset:40960
    v_mfma_f32_16x16x32_bf16 v[44:47], v[140:143], a[236:239], v[44:47]
    ds_read_b64_tr_b16 v[158:159], v219 offset:43008
    buffer_load_dwordx4 v[188:191], v228, s[8:11], s7 offen offset:3072 sc1
    s_waitcnt lgkmcnt(4)
    v_mfma_f32_16x16x32_bf16 v[48:51], v[144:147], a[224:227], v[48:51]
    ds_read_b64_tr_b16 v[128:129], v216 offset:49152
    s_mul_i32 s33, s39, 12288
    s_add_u32 s33, s33, 0x5001000
    v_mfma_f32_16x16x32_bf16 v[48:51], v[148:151], a[232:235], v[48:51]
    ds_read_b64_tr_b16 v[130:131], v216 offset:51200
    v_mfma_f32_16x16x32_bf16 v[52:55], v[144:147], a[228:231], v[52:55]
    ds_read_b64_tr_b16 v[132:133], v216 offset:57344
    v_cvt_pk_bf16_f32 v64, v64, v65
    v_mfma_f32_16x16x32_bf16 v[52:55], v[148:151], a[236:239], v[52:55]
    ds_read_b64_tr_b16 v[134:135], v216 offset:59392
    v_cvt_pk_bf16_f32 v65, v66, v67
    s_waitcnt lgkmcnt(4)
    v_mfma_f32_16x16x32_bf16 v[56:59], v[152:155], a[224:227], v[56:59]
    ds_read_b64_tr_b16 v[136:137], v217 offset:49152
    v_cvt_pk_bf16_f32 v66, v68, v69
    v_mfma_f32_16x16x32_bf16 v[56:59], v[156:159], a[232:235], v[56:59]
    ds_read_b64_tr_b16 v[138:139], v217 offset:51200
    v_cvt_pk_bf16_f32 v67, v70, v71
    v_mfma_f32_16x16x32_bf16 v[60:63], v[152:155], a[228:231], v[60:63]
    ds_read_b64_tr_b16 v[140:141], v217 offset:57344
    v_min_u32_e64 v64, -2, v64
    v_mfma_f32_16x16x32_bf16 v[60:63], v[156:159], a[236:239], v[60:63]
    ds_read_b64_tr_b16 v[142:143], v217 offset:59392
    v_min_u32 v65, -2, v65
    s_waitcnt lgkmcnt(4)
    v_mfma_f32_16x16x32_bf16 v[32:35], v[128:131], a[240:243], v[32:35]
    ds_read_b64_tr_b16 v[144:145], v218 offset:49152
    v_min_u32_e64 v66, -2, v66
    v_mfma_f32_16x16x32_bf16 v[32:35], v[132:135], a[248:251], v[32:35]
    ds_read_b64_tr_b16 v[146:147], v218 offset:51200
    v_min_u32_e64 v67, -2, v67
    v_mfma_f32_16x16x32_bf16 v[36:39], v[128:131], a[244:247], v[36:39]
    ds_read_b64_tr_b16 v[148:149], v218 offset:57344
    buffer_store_dwordx4 v[64:67], v228, s[8:11], s33 offen offset:0 sc1
    v_mfma_f32_16x16x32_bf16 v[36:39], v[132:135], a[252:255], v[36:39]
    ds_read_b64_tr_b16 v[150:151], v218 offset:59392
    s_waitcnt lgkmcnt(4)
    v_mfma_f32_16x16x32_bf16 v[40:43], v[136:139], a[240:243], v[40:43]
    ds_read_b64_tr_b16 v[152:153], v219 offset:49152
    v_mfma_f32_16x16x32_bf16 v[40:43], v[140:143], a[248:251], v[40:43]
    ds_read_b64_tr_b16 v[154:155], v219 offset:51200
    v_mfma_f32_16x16x32_bf16 v[44:47], v[136:139], a[244:247], v[44:47]
    ds_read_b64_tr_b16 v[156:157], v219 offset:57344
    v_cvt_pk_bf16_f32 v68, v72, v73
    v_mfma_f32_16x16x32_bf16 v[44:47], v[140:143], a[252:255], v[44:47]
    ds_read_b64_tr_b16 v[158:159], v219 offset:59392
    v_cvt_pk_bf16_f32 v69, v74, v75
    s_waitcnt lgkmcnt(4)
    v_mfma_f32_16x16x32_bf16 v[48:51], v[144:147], a[240:243], v[48:51]
    v_xor_b32 v216, 0x10000, v216
    ds_read_b64_tr_b16 v[128:129], v216 offset:0
    v_cvt_pk_bf16_f32 v70, v76, v77
    v_mfma_f32_16x16x32_bf16 v[48:51], v[148:151], a[248:251], v[48:51]
    ds_read_b64_tr_b16 v[130:131], v216 offset:2048
    v_cvt_pk_bf16_f32 v71, v78, v79
    v_mfma_f32_16x16x32_bf16 v[52:55], v[144:147], a[244:247], v[52:55]
    ds_read_b64_tr_b16 v[132:133], v216 offset:8192
    v_min_u32_e64 v68, -2, v68
    v_mfma_f32_16x16x32_bf16 v[52:55], v[148:151], a[252:255], v[52:55]
    ds_read_b64_tr_b16 v[134:135], v216 offset:10240
    v_min_u32 v69, -2, v69
    s_waitcnt lgkmcnt(4)
    v_mfma_f32_16x16x32_bf16 v[56:59], v[152:155], a[240:243], v[56:59]
    v_xor_b32 v217, 0x10000, v217
    ds_read_b64_tr_b16 v[136:137], v217 offset:0
    v_min_u32_e64 v70, -2, v70
    v_mfma_f32_16x16x32_bf16 v[56:59], v[156:159], a[248:251], v[56:59]
    ds_read_b64_tr_b16 v[138:139], v217 offset:2048
    v_min_u32_e64 v71, -2, v71
    v_mfma_f32_16x16x32_bf16 v[60:63], v[152:155], a[244:247], v[60:63]
    ds_read_b64_tr_b16 v[140:141], v217 offset:8192
    buffer_store_dwordx4 v[68:71], v228, s[8:11], s33 offen offset:1024 sc1
    v_mfma_f32_16x16x32_bf16 v[60:63], v[156:159], a[252:255], v[60:63]
    ds_read_b64_tr_b16 v[142:143], v217 offset:10240
    s_waitcnt lgkmcnt(4)
    v_mfma_f32_16x16x32_bf16 v[32:35], v[128:131], a[0:3], v[32:35]
    v_xor_b32 v218, 0x10000, v218
    ds_read_b64_tr_b16 v[144:145], v218 offset:0
    v_mfma_f32_16x16x32_bf16 v[32:35], v[132:135], a[16:19], v[32:35]
    ds_read_b64_tr_b16 v[146:147], v218 offset:2048
    v_mfma_f32_16x16x32_bf16 v[36:39], v[128:131], a[4:7], v[36:39]
    ds_read_b64_tr_b16 v[148:149], v218 offset:8192
    v_cvt_pk_bf16_f32 v72, v80, v81
    v_mfma_f32_16x16x32_bf16 v[36:39], v[132:135], a[20:23], v[36:39]
    ds_read_b64_tr_b16 v[150:151], v218 offset:10240
    v_cvt_pk_bf16_f32 v73, v82, v83
    s_waitcnt lgkmcnt(4)
    v_mfma_f32_16x16x32_bf16 v[40:43], v[136:139], a[0:3], v[40:43]
    v_xor_b32 v219, 0x10000, v219
    ds_read_b64_tr_b16 v[152:153], v219 offset:0
    v_cvt_pk_bf16_f32 v74, v84, v85
    v_mfma_f32_16x16x32_bf16 v[40:43], v[140:143], a[16:19], v[40:43]
    ds_read_b64_tr_b16 v[154:155], v219 offset:2048
    v_cvt_pk_bf16_f32 v75, v86, v87
    v_mfma_f32_16x16x32_bf16 v[44:47], v[136:139], a[4:7], v[44:47]
    ds_read_b64_tr_b16 v[156:157], v219 offset:8192
    v_min_u32_e64 v72, -2, v72
    v_mfma_f32_16x16x32_bf16 v[44:47], v[140:143], a[20:23], v[44:47]
    ds_read_b64_tr_b16 v[158:159], v219 offset:10240
    v_min_u32 v73, -2, v73
    s_waitcnt lgkmcnt(4)
    v_mfma_f32_16x16x32_bf16 v[48:51], v[144:147], a[0:3], v[48:51]
    ds_read_b64_tr_b16 v[128:129], v216 offset:16384
    v_min_u32_e64 v74, -2, v74
    v_mfma_f32_16x16x32_bf16 v[48:51], v[148:151], a[16:19], v[48:51]
    ds_read_b64_tr_b16 v[130:131], v216 offset:18432
    v_min_u32_e64 v75, -2, v75
    v_mfma_f32_16x16x32_bf16 v[52:55], v[144:147], a[4:7], v[52:55]
    ds_read_b64_tr_b16 v[132:133], v216 offset:24576
    buffer_store_dwordx4 v[72:75], v228, s[8:11], s33 offen offset:2048 sc1
    v_mfma_f32_16x16x32_bf16 v[52:55], v[148:151], a[20:23], v[52:55]
    ds_read_b64_tr_b16 v[134:135], v216 offset:26624
    s_waitcnt lgkmcnt(4)
    v_mfma_f32_16x16x32_bf16 v[56:59], v[152:155], a[0:3], v[56:59]
    ds_read_b64_tr_b16 v[136:137], v217 offset:16384
    v_mfma_f32_16x16x32_bf16 v[56:59], v[156:159], a[16:19], v[56:59]
    ds_read_b64_tr_b16 v[138:139], v217 offset:18432
    v_mfma_f32_16x16x32_bf16 v[60:63], v[152:155], a[4:7], v[60:63]
    ds_read_b64_tr_b16 v[140:141], v217 offset:24576
    v_cvt_pk_bf16_f32 v76, v88, v89
    v_mfma_f32_16x16x32_bf16 v[60:63], v[156:159], a[20:23], v[60:63]
    ds_read_b64_tr_b16 v[142:143], v217 offset:26624
    v_cvt_pk_bf16_f32 v77, v90, v91
    s_waitcnt lgkmcnt(4)
    v_mfma_f32_16x16x32_bf16 v[32:35], v[128:131], a[32:35], v[32:35]
    ds_read_b64_tr_b16 v[144:145], v218 offset:16384
    v_cvt_pk_bf16_f32 v78, v92, v93
    v_mfma_f32_16x16x32_bf16 v[32:35], v[132:135], a[48:51], v[32:35]
    ds_read_b64_tr_b16 v[146:147], v218 offset:18432
    v_cvt_pk_bf16_f32 v79, v94, v95
    v_mfma_f32_16x16x32_bf16 v[36:39], v[128:131], a[36:39], v[36:39]
    ds_read_b64_tr_b16 v[148:149], v218 offset:24576
    v_min_u32_e64 v76, -2, v76
    v_mfma_f32_16x16x32_bf16 v[36:39], v[132:135], a[52:55], v[36:39]
    ds_read_b64_tr_b16 v[150:151], v218 offset:26624
    v_min_u32 v77, -2, v77
    s_waitcnt lgkmcnt(4)
    v_mfma_f32_16x16x32_bf16 v[40:43], v[136:139], a[32:35], v[40:43]
    ds_read_b64_tr_b16 v[152:153], v219 offset:16384
    v_min_u32_e64 v78, -2, v78
    v_mfma_f32_16x16x32_bf16 v[40:43], v[140:143], a[48:51], v[40:43]
    ds_read_b64_tr_b16 v[154:155], v219 offset:18432
    v_min_u32_e64 v79, -2, v79
    v_mfma_f32_16x16x32_bf16 v[44:47], v[136:139], a[36:39], v[44:47]
    ds_read_b64_tr_b16 v[156:157], v219 offset:24576
    buffer_store_dwordx4 v[76:79], v228, s[8:11], s33 offen offset:3072 sc1
    v_mfma_f32_16x16x32_bf16 v[44:47], v[140:143], a[52:55], v[44:47]
    ds_read_b64_tr_b16 v[158:159], v219 offset:26624
    s_waitcnt lgkmcnt(4)
    v_mfma_f32_16x16x32_bf16 v[48:51], v[144:147], a[32:35], v[48:51]
    ds_read_b64_tr_b16 v[128:129], v216 offset:32768
    v_mfma_f32_16x16x32_bf16 v[48:51], v[148:151], a[48:51], v[48:51]
    ds_read_b64_tr_b16 v[130:131], v216 offset:34816
    v_mfma_f32_16x16x32_bf16 v[52:55], v[144:147], a[36:39], v[52:55]
    ds_read_b64_tr_b16 v[132:133], v216 offset:40960
    v_mfma_f32_16x16x32_bf16 v[52:55], v[148:151], a[52:55], v[52:55]
    ds_read_b64_tr_b16 v[134:135], v216 offset:43008
    s_waitcnt lgkmcnt(4)
    v_mfma_f32_16x16x32_bf16 v[56:59], v[152:155], a[32:35], v[56:59]
    ds_read_b64_tr_b16 v[136:137], v217 offset:32768
    v_mfma_f32_16x16x32_bf16 v[56:59], v[156:159], a[48:51], v[56:59]
    ds_read_b64_tr_b16 v[138:139], v217 offset:34816
    v_mfma_f32_16x16x32_bf16 v[60:63], v[152:155], a[36:39], v[60:63]
    ds_read_b64_tr_b16 v[140:141], v217 offset:40960
    v_mfma_f32_16x16x32_bf16 v[60:63], v[156:159], a[52:55], v[60:63]
    ds_read_b64_tr_b16 v[142:143], v217 offset:43008
    s_waitcnt lgkmcnt(4)
    v_mfma_f32_16x16x32_bf16 v[32:35], v[128:131], a[64:67], v[32:35]
    ds_read_b64_tr_b16 v[144:145], v218 offset:32768
    v_mfma_f32_16x16x32_bf16 v[32:35], v[132:135], a[80:83], v[32:35]
    ds_read_b64_tr_b16 v[146:147], v218 offset:34816
    v_mfma_f32_16x16x32_bf16 v[36:39], v[128:131], a[68:71], v[36:39]
    ds_read_b64_tr_b16 v[148:149], v218 offset:40960
    v_mfma_f32_16x16x32_bf16 v[36:39], v[132:135], a[84:87], v[36:39]
    ds_read_b64_tr_b16 v[150:151], v218 offset:43008
    s_waitcnt lgkmcnt(4)
    v_mfma_f32_16x16x32_bf16 v[40:43], v[136:139], a[64:67], v[40:43]
    ds_read_b64_tr_b16 v[152:153], v219 offset:32768
    v_mfma_f32_16x16x32_bf16 v[40:43], v[140:143], a[80:83], v[40:43]
    ds_read_b64_tr_b16 v[154:155], v219 offset:34816
    v_mfma_f32_16x16x32_bf16 v[44:47], v[136:139], a[68:71], v[44:47]
    ds_read_b64_tr_b16 v[156:157], v219 offset:40960
    v_mfma_f32_16x16x32_bf16 v[44:47], v[140:143], a[84:87], v[44:47]
    ds_read_b64_tr_b16 v[158:159], v219 offset:43008
    s_waitcnt lgkmcnt(4)
    v_mfma_f32_16x16x32_bf16 v[48:51], v[144:147], a[64:67], v[48:51]
    ds_read_b64_tr_b16 v[128:129], v216 offset:49152
    v_mfma_f32_16x16x32_bf16 v[48:51], v[148:151], a[80:83], v[48:51]
    ds_read_b64_tr_b16 v[130:131], v216 offset:51200
    v_mfma_f32_16x16x32_bf16 v[52:55], v[144:147], a[68:71], v[52:55]
    ds_read_b64_tr_b16 v[132:133], v216 offset:57344
    v_mfma_f32_16x16x32_bf16 v[52:55], v[148:151], a[84:87], v[52:55]
    ds_read_b64_tr_b16 v[134:135], v216 offset:59392
    s_waitcnt lgkmcnt(4)
    v_mfma_f32_16x16x32_bf16 v[56:59], v[152:155], a[64:67], v[56:59]
    ds_read_b64_tr_b16 v[136:137], v217 offset:49152
    v_mfma_f32_16x16x32_bf16 v[56:59], v[156:159], a[80:83], v[56:59]
    ds_read_b64_tr_b16 v[138:139], v217 offset:51200
    v_mfma_f32_16x16x32_bf16 v[60:63], v[152:155], a[68:71], v[60:63]
    ds_read_b64_tr_b16 v[140:141], v217 offset:57344
    v_mfma_f32_16x16x32_bf16 v[60:63], v[156:159], a[84:87], v[60:63]
    ds_read_b64_tr_b16 v[142:143], v217 offset:59392
    s_waitcnt lgkmcnt(4)
    v_mfma_f32_16x16x32_bf16 v[32:35], v[128:131], a[96:99], v[32:35]
    ds_read_b64_tr_b16 v[144:145], v218 offset:49152
    v_mfma_f32_16x16x32_bf16 v[32:35], v[132:135], a[112:115], v[32:35]
    ds_read_b64_tr_b16 v[146:147], v218 offset:51200
    v_mfma_f32_16x16x32_bf16 v[36:39], v[128:131], a[100:103], v[36:39]
    ds_read_b64_tr_b16 v[148:149], v218 offset:57344
    v_mfma_f32_16x16x32_bf16 v[36:39], v[132:135], a[116:119], v[36:39]
    ds_read_b64_tr_b16 v[150:151], v218 offset:59392
    s_waitcnt lgkmcnt(4)
    v_mfma_f32_16x16x32_bf16 v[40:43], v[136:139], a[96:99], v[40:43]
    ds_read_b64_tr_b16 v[152:153], v219 offset:49152
    v_mfma_f32_16x16x32_bf16 v[40:43], v[140:143], a[112:115], v[40:43]
    ds_read_b64_tr_b16 v[154:155], v219 offset:51200
    v_mfma_f32_16x16x32_bf16 v[44:47], v[136:139], a[100:103], v[44:47]
    ds_read_b64_tr_b16 v[156:157], v219 offset:57344
    v_mfma_f32_16x16x32_bf16 v[44:47], v[140:143], a[116:119], v[44:47]
    ds_read_b64_tr_b16 v[158:159], v219 offset:59392
    s_waitcnt lgkmcnt(4)
    v_mfma_f32_16x16x32_bf16 v[48:51], v[144:147], a[96:99], v[48:51]
    buffer_load_dwordx4 v[96:99], v228, s[8:11], s37 offen offset:0 sc1
    v_mfma_f32_16x16x32_bf16 v[48:51], v[148:151], a[112:115], v[48:51]
    v_mfma_f32_16x16x32_bf16 v[52:55], v[144:147], a[100:103], v[52:55]
    buffer_load_dwordx4 v[100:103], v228, s[8:11], s37 offen offset:1024 sc1
    v_mfma_f32_16x16x32_bf16 v[52:55], v[148:151], a[116:119], v[52:55]
    s_waitcnt lgkmcnt(0)
    v_mfma_f32_16x16x32_bf16 v[56:59], v[152:155], a[96:99], v[56:59]
    buffer_load_dwordx4 v[104:107], v228, s[8:11], s37 offen offset:2048 sc1
    v_mfma_f32_16x16x32_bf16 v[56:59], v[156:159], a[112:115], v[56:59]
    v_mfma_f32_16x16x32_bf16 v[60:63], v[152:155], a[100:103], v[60:63]
    buffer_load_dwordx4 v[108:111], v228, s[8:11], s37 offen offset:3072 sc1
    v_mfma_f32_16x16x32_bf16 v[60:63], v[156:159], a[116:119], v[60:63]
kc_tail:
    buffer_load_dwordx4 v[160:163], v228, s[8:11], s38 offen offset:0 sc1
    buffer_load_dwordx4 v[164:167], v228, s[8:11], s38 offen offset:1024 sc1
    buffer_load_dwordx4 v[168:171], v228, s[8:11], s38 offen offset:2048 sc1
    buffer_load_dwordx4 v[172:175], v228, s[8:11], s38 offen offset:3072 sc1
    v_lshlrev_b32_e64 v128, 16, v192
    v_and_b32 v129, 0xffff0000, v192
    v_lshlrev_b32_e64 v130, 16, v193
    v_and_b32 v131, 0xffff0000, v193
    v_lshlrev_b32_e64 v132, 16, v194
    v_and_b32 v133, 0xffff0000, v194
    v_lshlrev_b32_e64 v134, 16, v195
    v_and_b32 v135, 0xffff0000, v195
    v_lshlrev_b32_e64 v136, 16, v196
    v_and_b32 v137, 0xffff0000, v196
    v_lshlrev_b32_e64 v138, 16, v197
    v_and_b32 v139, 0xffff0000, v197
    v_lshlrev_b32_e64 v140, 16, v198
    v_and_b32 v141, 0xffff0000, v198
    v_lshlrev_b32_e64 v142, 16, v199
    v_and_b32 v143, 0xffff0000, v199
    v_lshlrev_b32_e64 v144, 16, v200
    v_and_b32 v145, 0xffff0000, v200
    v_lshlrev_b32_e64 v146, 16, v201
    v_and_b32 v147, 0xffff0000, v201
    v_lshlrev_b32_e64 v148, 16, v202
    v_and_b32 v149, 0xffff0000, v202
    v_lshlrev_b32_e64 v150, 16, v203
    v_and_b32 v151, 0xffff0000, v203
    v_lshlrev_b32_e64 v152, 16, v204
    v_and_b32 v153, 0xffff0000, v204
    v_lshlrev_b32_e64 v154, 16, v205
    v_and_b32 v155, 0xffff0000, v205
    v_lshlrev_b32_e64 v156, 16, v206
    v_and_b32 v157, 0xffff0000, v206
    v_lshlrev_b32_e64 v158, 16, v207
    v_and_b32 v159, 0xffff0000, v207
    v_lshlrev_b32_e64 v112, 16, v208
    v_and_b32 v113, 0xffff0000, v208
    v_lshlrev_b32_e64 v114, 16, v209
    v_and_b32 v115, 0xffff0000, v209
    v_lshlrev_b32_e64 v116, 16, v210
    v_and_b32 v117, 0xffff0000, v210
    v_lshlrev_b32_e64 v118, 16, v211
    v_and_b32 v119, 0xffff0000, v211
    v_pk_add_f32 v[120:121], v[112:113], v[114:115]
    v_pk_add_f32 v[122:123], v[116:117], v[118:119]
    v_pk_add_f32 v[120:121], v[120:121], v[122:123]
    v_add_f32_e64 v196, v120, v121
    s_barrier
    s_waitcnt vmcnt(12)
    v_max3_u32 v235, v176, v177, v178
    v_max3_u32 v235, v235, v179, v180
    v_max3_u32 v235, v235, v181, v182
    v_max3_u32 v235, v235, v183, v184
    v_max3_u32 v235, v235, v185, v186
    v_max3_u32 v235, v235, v187, v188
    v_max3_u32 v235, v235, v189, v190
    v_max_u32 v235, v235, v191
    v_cmp_eq_u32 vcc, -1, v235
    s_cbranch_vccnz kc_r3
kc_r3o:
    v_lshlrev_b32 v64, 16, v176
    v_and_b32 v65, 0xffff0000, v176
    v_lshlrev_b32_e64 v66, 16, v177
    v_and_b32 v67, 0xffff0000, v177
    v_pk_add_f32 v[32:33], v[32:33], v[64:65]
    v_pk_add_f32 v[34:35], v[34:35], v[66:67]
    v_lshlrev_b32_e64 v68, 16, v178
    v_and_b32 v69, 0xffff0000, v178
    v_lshlrev_b32_e64 v70, 16, v179
    v_and_b32 v71, 0xffff0000, v179
    v_pk_add_f32 v[36:37], v[36:37], v[68:69]
    v_pk_add_f32 v[38:39], v[38:39], v[70:71]
    v_lshlrev_b32_e64 v72, 16, v180
    v_and_b32 v73, 0xffff0000, v180
    v_lshlrev_b32_e64 v74, 16, v181
    v_and_b32 v75, 0xffff0000, v181
    v_pk_add_f32 v[40:41], v[40:41], v[72:73]
    v_pk_add_f32 v[42:43], v[42:43], v[74:75]
    v_lshlrev_b32_e64 v76, 16, v182
    v_and_b32 v77, 0xffff0000, v182
    v_lshlrev_b32_e64 v78, 16, v183
    v_and_b32 v79, 0xffff0000, v183
    v_pk_add_f32 v[44:45], v[44:45], v[76:77]
    v_pk_add_f32 v[46:47], v[46:47], v[78:79]
    v_lshlrev_b32_e64 v80, 16, v184
    v_and_b32 v81, 0xffff0000, v184
    v_lshlrev_b32_e64 v82, 16, v185
    v_and_b32 v83, 0xffff0000, v185
    v_pk_add_f32 v[48:49], v[48:49], v[80:81]
    v_pk_add_f32 v[50:51], v[50:51], v[82:83]
    v_lshlrev_b32_e64 v84, 16, v186
    v_and_b32 v85, 0xffff0000, v186
    v_lshlrev_b32_e64 v86, 16, v187
    v_and_b32 v87, 0xffff0000, v187
    v_pk_add_f32 v[52:53], v[52:53], v[84:85]
    v_pk_add_f32 v[54:55], v[54:55], v[86:87]
    v_lshlrev_b32_e64 v88, 16, v188
    v_and_b32 v89, 0xffff0000, v188
    v_lshlrev_b32_e64 v90, 16, v189
    v_and_b32 v91, 0xffff0000, v189
    v_pk_add_f32 v[56:57], v[56:57], v[88:89]
    v_pk_add_f32 v[58:59], v[58:59], v[90:91]
    v_lshlrev_b32_e64 v92, 16, v190
    v_and_b32 v93, 0xffff0000, v190
    v_lshlrev_b32_e64 v94, 16, v191
    v_and_b32 v95, 0xffff0000, v191
    v_pk_add_f32 v[60:61], v[60:61], v[92:93]
    v_pk_add_f32 v[62:63], v[62:63], v[94:95]
    s_waitcnt vmcnt(4)
    v_max3_u32 v235, v96, v97, v98
    v_max3_u32 v235, v235, v99, v100
    v_max3_u32 v235, v235, v101, v102
    v_max3_u32 v235, v235, v103, v104
    v_max3_u32 v235, v235, v105, v106
    v_max3_u32 v235, v235, v107, v108
    v_max3_u32 v235, v235, v109, v110
    v_max_u32 v235, v235, v111
    v_cmp_eq_u32 vcc, -1, v235
    s_cbranch_vccnz kc_r1
kc_r1o:
    v_lshlrev_b32_e64 v64, 16, v96
    v_and_b32 v65, 0xffff0000, v96
    v_lshlrev_b32_e64 v66, 16, v97
    v_and_b32 v67, 0xffff0000, v97
    v_pk_add_f32 v[32:33], v[32:33], v[64:65]
    v_pk_add_f32 v[34:35], v[34:35], v[66:67]
    v_lshlrev_b32_e64 v68, 16, v98
    v_and_b32 v69, 0xffff0000, v98
    v_lshlrev_b32_e64 v70, 16, v99
    v_and_b32 v71, 0xffff0000, v99
    v_pk_add_f32 v[36:37], v[36:37], v[68:69]
    v_pk_add_f32 v[38:39], v[38:39], v[70:71]
    v_lshlrev_b32_e64 v72, 16, v100
    v_and_b32 v73, 0xffff0000, v100
    v_lshlrev_b32_e64 v74, 16, v101
    v_and_b32 v75, 0xffff0000, v101
    v_pk_add_f32 v[40:41], v[40:41], v[72:73]
    v_pk_add_f32 v[42:43], v[42:43], v[74:75]
    v_lshlrev_b32_e64 v76, 16, v102
    v_and_b32 v77, 0xffff0000, v102
    v_lshlrev_b32_e64 v78, 16, v103
    v_and_b32 v79, 0xffff0000, v103
    v_pk_add_f32 v[44:45], v[44:45], v[76:77]
    v_pk_add_f32 v[46:47], v[46:47], v[78:79]
    v_lshlrev_b32_e64 v80, 16, v104
    v_and_b32 v81, 0xffff0000, v104
    v_lshlrev_b32_e64 v82, 16, v105
    v_and_b32 v83, 0xffff0000, v105
    v_pk_add_f32 v[48:49], v[48:49], v[80:81]
    v_pk_add_f32 v[50:51], v[50:51], v[82:83]
    v_lshlrev_b32_e64 v84, 16, v106
    v_and_b32 v85, 0xffff0000, v106
    v_lshlrev_b32_e64 v86, 16, v107
    v_and_b32 v87, 0xffff0000, v107
    v_pk_add_f32 v[52:53], v[52:53], v[84:85]
    v_pk_add_f32 v[54:55], v[54:55], v[86:87]
    v_lshlrev_b32_e64 v88, 16, v108
    v_and_b32 v89, 0xffff0000, v108
    v_lshlrev_b32_e64 v90, 16, v109
    v_and_b32 v91, 0xffff0000, v109
    v_pk_add_f32 v[56:57], v[56:57], v[88:89]
    v_pk_add_f32 v[58:59], v[58:59], v[90:91]
    v_lshlrev_b32_e64 v92, 16, v110
    v_and_b32 v93, 0xffff0000, v110
    v_lshlrev_b32_e64 v94, 16, v111
    v_and_b32 v95, 0xffff0000, v111
    v_pk_add_f32 v[60:61], v[60:61], v[92:93]
    v_pk_add_f32 v[62:63], v[62:63], v[94:95]
    s_waitcnt vmcnt(0)
    v_max3_u32 v235, v160, v161, v162
    v_max3_u32 v235, v235, v163, v164
    v_max3_u32 v235, v235, v165, v166
    v_max3_u32 v235, v235, v167, v168
    v_max3_u32 v235, v235, v169, v170
    v_max3_u32 v235, v235, v171, v172
    v_max3_u32 v235, v235, v173, v174
    v_max_u32 v235, v235, v175
    v_cmp_eq_u32 vcc, -1, v235
    s_cbranch_vccnz kc_r2
kc_r2o:
    v_lshlrev_b32_e64 v64, 16, v160
    v_and_b32 v65, 0xffff0000, v160
    v_lshlrev_b32_e64 v66, 16, v161
    v_and_b32 v67, 0xffff0000, v161
    v_pk_add_f32 v[32:33], v[32:33], v[64:65]
    v_pk_add_f32 v[34:35], v[34:35], v[66:67]
    v_cvt_pk_bf16_f32 v0, v32, v33
    v_cvt_pk_bf16_f32 v1, v34, v35
    ds_write_b64 v238, v[0:1] offset:0
    v_lshlrev_b32_e64 v68, 16, v162
    v_and_b32 v69, 0xffff0000, v162
    v_lshlrev_b32_e64 v70, 16, v163
    v_and_b32 v71, 0xffff0000, v163
    v_pk_add_f32 v[36:37], v[36:37], v[68:69]
    v_pk_add_f32 v[38:39], v[38:39], v[70:71]
    v_cvt_pk_bf16_f32 v2, v36, v37
    v_cvt_pk_bf16_f32 v3, v38, v39
    ds_write_b64 v238, v[2:3] offset:2304
    v_lshlrev_b32_e64 v72, 16, v164
    v_and_b32 v73, 0xffff0000, v164
    v_lshlrev_b32_e64 v74, 16, v165
    v_and_b32 v75, 0xffff0000, v165
    v_pk_add_f32 v[40:41], v[40:41], v[72:73]
    v_pk_add_f32 v[42:43], v[42:43], v[74:75]
    v_cvt_pk_bf16_f32 v4, v40, v41
    v_cvt_pk_bf16_f32 v5, v42, v43
    ds_write_b64 v238, v[4:5] offset:32
    v_lshlrev_b32_e64 v76, 16, v166
    v_and_b32 v77, 0xffff0000, v166
    v_lshlrev_b32_e64 v78, 16, v167
    v_and_b32 v79, 0xffff0000, v167
    v_pk_add_f32 v[44:45], v[44:45], v[76:77]
    v_pk_add_f32 v[46:47], v[46:47], v[78:79]
    v_cvt_pk_bf16_f32 v6, v44, v45
    v_cvt_pk_bf16_f32 v7, v46, v47
    ds_write_b64 v238, v[6:7] offset:2336
    v_lshlrev_b32_e64 v80, 16, v168
    v_and_b32 v81, 0xffff0000, v168
    v_lshlrev_b32_e64 v82, 16, v169
    v_and_b32 v83, 0xffff0000, v169
    v_pk_add_f32 v[48:49], v[48:49], v[80:81]
    v_pk_add_f32 v[50:51], v[50:51], v[82:83]
    v_cvt_pk_bf16_f32 v8, v48, v49
    v_cvt_pk_bf16_f32 v9, v50, v51
    ds_write_b64 v238, v[8:9] offset:64
    v_lshlrev_b32_e64 v84, 16, v170
    v_and_b32 v85, 0xffff0000, v170
    v_lshlrev_b32_e64 v86, 16, v171
    v_and_b32 v87, 0xffff0000, v171
    v_pk_add_f32 v[52:53], v[52:53], v[84:85]
    v_pk_add_f32 v[54:55], v[54:55], v[86:87]
    v_cvt_pk_bf16_f32 v10, v52, v53
    v_cvt_pk_bf16_f32 v11, v54, v55
    ds_write_b64 v238, v[10:11] offset:2368
    v_lshlrev_b32_e64 v88, 16, v172
    v_and_b32 v89, 0xffff0000, v172
    v_lshlrev_b32_e64 v90, 16, v173
    v_and_b32 v91, 0xffff0000, v173
    v_pk_add_f32 v[56:57], v[56:57], v[88:89]
    v_pk_add_f32 v[58:59], v[58:59], v[90:91]
    v_cvt_pk_bf16_f32 v12, v56, v57
    v_cvt_pk_bf16_f32 v13, v58, v59
    ds_write_b64 v238, v[12:13] offset:96
    v_lshlrev_b32_e64 v92, 16, v174
    v_and_b32 v93, 0xffff0000, v174
    v_lshlrev_b32_e64 v94, 16, v175
    v_and_b32 v95, 0xffff0000, v175
    v_pk_add_f32 v[60:61], v[60:61], v[92:93]
    v_pk_add_f32 v[62:63], v[62:63], v[94:95]
    v_cvt_pk_bf16_f32 v14, v60, v61
    v_cvt_pk_bf16_f32 v15, v62, v63
    ds_write_b64 v238, v[14:15] offset:2400
    s_waitcnt lgkmcnt(0)
    ds_read_b128 v[16:19], v239 offset:0
    ds_read_b128 v[20:23], v239 offset:1152
    ds_read_b128 v[24:27], v239 offset:2304
    ds_read_b128 v[28:31], v239 offset:3456
    s_waitcnt lgkmcnt(3)
    v_lshlrev_b32 v64, 16, v16
    v_lshlrev_b32 v66, 16, v17
    v_lshlrev_b32 v68, 16, v18
    v_lshlrev_b32 v70, 16, v19
    v_and_b32 v65, 0xffff0000, v16
    v_and_b32 v67, 0xffff0000, v17
    v_and_b32 v69, 0xffff0000, v18
    v_and_b32 v71, 0xffff0000, v19
    v_pk_add_f32 v[64:65], v[64:65], v[128:129]
    v_pk_add_f32 v[66:67], v[66:67], v[130:131]
    v_pk_add_f32 v[68:69], v[68:69], v[132:133]
    v_pk_add_f32 v[70:71], v[70:71], v[134:135]
    v_cvt_pk_bf16_f32 v16, v64, v65
    v_cvt_pk_bf16_f32 v17, v66, v67
    v_cvt_pk_bf16_f32 v18, v68, v69
    v_cvt_pk_bf16_f32 v19, v70, v71
    v_lshlrev_b32 v64, 16, v16
    v_lshlrev_b32 v66, 16, v17
    v_lshlrev_b32 v68, 16, v18
    v_lshlrev_b32 v70, 16, v19
    v_and_b32 v65, 0xffff0000, v16
    v_and_b32 v67, 0xffff0000, v17
    v_and_b32 v69, 0xffff0000, v18
    v_and_b32 v71, 0xffff0000, v19
    s_mov_b32 s32, 0x3400000
    buffer_store_dwordx4 v[16:19], v229, s[8:11], s32 offen sc1
    v_pk_add_f32 v[160:161], v[64:65], v[66:67]
    v_pk_mul_f32 v[162:163], v[64:65], v[64:65]
    v_pk_mul_f32 v[164:165], v[64:65], v[112:113]
    v_pk_fma_f32 v[162:163], v[66:67], v[66:67], v[162:163]
    v_pk_fma_f32 v[164:165], v[66:67], v[114:115], v[164:165]
    v_pk_add_f32 v[160:161], v[160:161], v[68:69]
    v_pk_fma_f32 v[162:163], v[68:69], v[68:69], v[162:163]
    v_pk_fma_f32 v[164:165], v[68:69], v[116:117], v[164:165]
    v_pk_add_f32 v[160:161], v[160:161], v[70:71]
    v_pk_fma_f32 v[162:163], v[70:71], v[70:71], v[162:163]
    v_pk_fma_f32 v[164:165], v[70:71], v[118:119], v[164:165]
    v_add_f32 v184, v160, v161
    v_add_f32 v185, v162, v163
    v_add_f32 v186, v164, v165
    s_waitcnt lgkmcnt(2)
    v_lshlrev_b32 v72, 16, v20
    v_lshlrev_b32 v74, 16, v21
    v_lshlrev_b32 v76, 16, v22
    v_lshlrev_b32 v78, 16, v23
    v_and_b32 v73, 0xffff0000, v20
    v_and_b32 v75, 0xffff0000, v21
    v_and_b32 v77, 0xffff0000, v22
    v_and_b32 v79, 0xffff0000, v23
    v_pk_add_f32 v[72:73], v[72:73], v[136:137]
    v_pk_add_f32 v[74:75], v[74:75], v[138:139]
    v_pk_add_f32 v[76:77], v[76:77], v[140:141]
    v_pk_add_f32 v[78:79], v[78:79], v[142:143]
    v_cvt_pk_bf16_f32 v20, v72, v73
    v_cvt_pk_bf16_f32 v21, v74, v75
    v_cvt_pk_bf16_f32 v22, v76, v77
    v_cvt_pk_bf16_f32 v23, v78, v79
    v_lshlrev_b32 v72, 16, v20
    v_lshlrev_b32 v74, 16, v21
    v_lshlrev_b32 v76, 16, v22
    v_lshlrev_b32 v78, 16, v23
    v_and_b32 v73, 0xffff0000, v20
    v_and_b32 v75, 0xffff0000, v21
    v_and_b32 v77, 0xffff0000, v22
    v_and_b32 v79, 0xffff0000, v23
    s_mov_b32 s32, 0x3404000
    buffer_store_dwordx4 v[20:23], v229, s[8:11], s32 offen sc1
    v_pk_add_f32 v[166:167], v[72:73], v[74:75]
    v_pk_mul_f32 v[168:169], v[72:73], v[72:73]
    v_pk_mul_f32 v[170:171], v[72:73], v[112:113]
    v_pk_fma_f32 v[168:169], v[74:75], v[74:75], v[168:169]
    v_pk_fma_f32 v[170:171], v[74:75], v[114:115], v[170:171]
    v_pk_add_f32 v[166:167], v[166:167], v[76:77]
    v_pk_fma_f32 v[168:169], v[76:77], v[76:77], v[168:169]
    v_pk_fma_f32 v[170:171], v[76:77], v[116:117], v[170:171]
    v_pk_add_f32 v[166:167], v[166:167], v[78:79]
    v_pk_fma_f32 v[168:169], v[78:79], v[78:79], v[168:169]
    v_pk_fma_f32 v[170:171], v[78:79], v[118:119], v[170:171]
    v_add_f32 v187, v166, v167
    v_add_f32 v188, v168, v169
    v_add_f32 v189, v170, v171
    s_waitcnt lgkmcnt(1)
    v_lshlrev_b32 v80, 16, v24
    v_lshlrev_b32 v82, 16, v25
    v_lshlrev_b32 v84, 16, v26
    v_lshlrev_b32 v86, 16, v27
    v_and_b32 v81, 0xffff0000, v24
    v_and_b32 v83, 0xffff0000, v25
    v_and_b32 v85, 0xffff0000, v26
    v_and_b32 v87, 0xffff0000, v27
    v_pk_add_f32 v[80:81], v[80:81], v[144:145]
    v_pk_add_f32 v[82:83], v[82:83], v[146:147]
    v_pk_add_f32 v[84:85], v[84:85], v[148:149]
    v_pk_add_f32 v[86:87], v[86:87], v[150:151]
    v_cvt_pk_bf16_f32 v24, v80, v81
    v_cvt_pk_bf16_f32 v25, v82, v83
    v_cvt_pk_bf16_f32 v26, v84, v85
    v_cvt_pk_bf16_f32 v27, v86, v87
    v_lshlrev_b32 v80, 16, v24
    v_lshlrev_b32 v82, 16, v25
    v_lshlrev_b32 v84, 16, v26
    v_lshlrev_b32 v86, 16, v27
    v_and_b32 v81, 0xffff0000, v24
    v_and_b32 v83, 0xffff0000, v25
    v_and_b32 v85, 0xffff0000, v26
    v_and_b32 v87, 0xffff0000, v27
    s_mov_b32 s32, 0x3408000
    buffer_store_dwordx4 v[24:27], v229, s[8:11], s32 offen sc1
    v_pk_add_f32 v[172:173], v[80:81], v[82:83]
    v_pk_mul_f32 v[174:175], v[80:81], v[80:81]
    v_pk_mul_f32 v[176:177], v[80:81], v[112:113]
    v_pk_fma_f32 v[174:175], v[82:83], v[82:83], v[174:175]
    v_pk_fma_f32 v[176:177], v[82:83], v[114:115], v[176:177]
    v_pk_add_f32 v[172:173], v[172:173], v[84:85]
    v_pk_fma_f32 v[174:175], v[84:85], v[84:85], v[174:175]
    v_pk_fma_f32 v[176:177], v[84:85], v[116:117], v[176:177]
    v_pk_add_f32 v[172:173], v[172:173], v[86:87]
    v_pk_fma_f32 v[174:175], v[86:87], v[86:87], v[174:175]
    v_pk_fma_f32 v[176:177], v[86:87], v[118:119], v[176:177]
    v_add_f32 v190, v172, v173
    v_add_f32 v191, v174, v175
    v_add_f32 v192, v176, v177
    s_waitcnt lgkmcnt(0)
    v_lshlrev_b32 v88, 16, v28
    v_lshlrev_b32 v90, 16, v29
    v_lshlrev_b32 v92, 16, v30
    v_lshlrev_b32 v94, 16, v31
    v_and_b32 v89, 0xffff0000, v28
    v_and_b32 v91, 0xffff0000, v29
    v_and_b32 v93, 0xffff0000, v30
    v_and_b32 v95, 0xffff0000, v31
    v_pk_add_f32 v[88:89], v[88:89], v[152:153]
    v_pk_add_f32 v[90:91], v[90:91], v[154:155]
    v_pk_add_f32 v[92:93], v[92:93], v[156:157]
    v_pk_add_f32 v[94:95], v[94:95], v[158:159]
    v_cvt_pk_bf16_f32 v28, v88, v89
    v_cvt_pk_bf16_f32 v29, v90, v91
    v_cvt_pk_bf16_f32 v30, v92, v93
    v_cvt_pk_bf16_f32 v31, v94, v95
    v_lshlrev_b32 v88, 16, v28
    v_lshlrev_b32 v90, 16, v29
    v_lshlrev_b32 v92, 16, v30
    v_lshlrev_b32 v94, 16, v31
    v_and_b32 v89, 0xffff0000, v28
    v_and_b32 v91, 0xffff0000, v29
    v_and_b32 v93, 0xffff0000, v30
    v_and_b32 v95, 0xffff0000, v31
    s_mov_b32 s32, 0x340c000
    buffer_store_dwordx4 v[28:31], v229, s[8:11], s32 offen sc1
    v_pk_add_f32 v[178:179], v[88:89], v[90:91]
    v_pk_mul_f32 v[180:181], v[88:89], v[88:89]
    v_pk_mul_f32 v[182:183], v[88:89], v[112:113]
    v_pk_fma_f32 v[180:181], v[90:91], v[90:91], v[180:181]
    v_pk_fma_f32 v[182:183], v[90:91], v[114:115], v[182:183]
    v_pk_add_f32 v[178:179], v[178:179], v[92:93]
    v_pk_fma_f32 v[180:181], v[92:93], v[92:93], v[180:181]
    v_pk_fma_f32 v[182:183], v[92:93], v[116:117], v[182:183]
    v_pk_add_f32 v[178:179], v[178:179], v[94:95]
    v_pk_fma_f32 v[180:181], v[94:95], v[94:95], v[180:181]
    v_pk_fma_f32 v[182:183], v[94:95], v[118:119], v[182:183]
    v_add_f32 v193, v178, v179
    v_add_f32 v194, v180, v181
    v_add_f32_e64 v195, v182, v183
    v_add_f32_dpp v196, v196, v196 quad_perm:[1,0,3,2] row_mask:0xf bank_mask:0xf
    v_add_f32_dpp v184, v184, v184 quad_perm:[1,0,3,2] row_mask:0xf bank_mask:0xf
    v_add_f32_dpp v185, v185, v185 quad_perm:[1,0,3,2] row_mask:0xf bank_mask:0xf
    v_add_f32_dpp v186, v186, v186 quad_perm:[1,0,3,2] row_mask:0xf bank_mask:0xf
    v_add_f32_dpp v187, v187, v187 quad_perm:[1,0,3,2] row_mask:0xf bank_mask:0xf
    v_add_f32_dpp v188, v188, v188 quad_perm:[1,0,3,2] row_mask:0xf bank_mask:0xf
    v_add_f32_dpp v189, v189, v189 quad_perm:[1,0,3,2] row_mask:0xf bank_mask:0xf
    v_add_f32_dpp v190, v190, v190 quad_perm:[1,0,3,2] row_mask:0xf bank_mask:0xf
    v_add_f32_dpp v191, v191, v191 quad_perm:[1,0,3,2] row_mask:0xf bank_mask:0xf
    v_add_f32_dpp v192, v192, v192 quad_perm:[1,0,3,2] row_mask:0xf bank_mask:0xf
    v_add_f32_dpp v193, v193, v193 quad_perm:[1,0,3,2] row_mask:0xf bank_mask:0xf
    v_add_f32_dpp v194, v194, v194 quad_perm:[1,0,3,2] row_mask:0xf bank_mask:0xf
    v_add_f32_dpp v195, v195, v195 quad_perm:[1,0,3,2] row_mask:0xf bank_mask:0xf
    v_add_f32_dpp v196, v196, v196 quad_perm:[2,3,0,1] row_mask:0xf bank_mask:0xf
    v_add_f32_dpp v184, v184, v184 quad_perm:[2,3,0,1] row_mask:0xf bank_mask:0xf
    v_add_f32_dpp v185, v185, v185 quad_perm:[2,3,0,1] row_mask:0xf bank_mask:0xf
    v_add_f32_dpp v186, v186, v186 quad_perm:[2,3,0,1] row_mask:0xf bank_mask:0xf
    v_add_f32_dpp v187, v187, v187 quad_perm:[2,3,0,1] row_mask:0xf bank_mask:0xf
    v_add_f32_dpp v188, v188, v188 quad_perm:[2,3,0,1] row_mask:0xf bank_mask:0xf
    v_add_f32_dpp v189, v189, v189 quad_perm:[2,3,0,1] row_mask:0xf bank_mask:0xf
    v_add_f32_dpp v190, v190, v190 quad_perm:[2,3,0,1] row_mask:0xf bank_mask:0xf
    v_add_f32_dpp v191, v191, v191 quad_perm:[2,3,0,1] row_mask:0xf bank_mask:0xf
    v_add_f32_dpp v192, v192, v192 quad_perm:[2,3,0,1] row_mask:0xf bank_mask:0xf
    v_add_f32_dpp v193, v193, v193 quad_perm:[2,3,0,1] row_mask:0xf bank_mask:0xf
    v_add_f32_dpp v194, v194, v194 quad_perm:[2,3,0,1] row_mask:0xf bank_mask:0xf
    v_add_f32_dpp v195, v195, v195 quad_perm:[2,3,0,1] row_mask:0xf bank_mask:0xf
    v_add_f32_dpp v196, v196, v196 row_half_mirror row_mask:0xf bank_mask:0xf
    v_add_f32_dpp v184, v184, v184 row_half_mirror row_mask:0xf bank_mask:0xf
    v_add_f32_dpp v185, v185, v185 row_half_mirror row_mask:0xf bank_mask:0xf
    v_add_f32_dpp v186, v186, v186 row_half_mirror row_mask:0xf bank_mask:0xf
    v_add_f32_dpp v187, v187, v187 row_half_mirror row_mask:0xf bank_mask:0xf
    v_add_f32_dpp v188, v188, v188 row_half_mirror row_mask:0xf bank_mask:0xf
    v_add_f32_dpp v189, v189, v189 row_half_mirror row_mask:0xf bank_mask:0xf
    v_add_f32_dpp v190, v190, v190 row_half_mirror row_mask:0xf bank_mask:0xf
    v_add_f32_dpp v191, v191, v191 row_half_mirror row_mask:0xf bank_mask:0xf
    v_add_f32_dpp v192, v192, v192 row_half_mirror row_mask:0xf bank_mask:0xf
    v_add_f32_dpp v193, v193, v193 row_half_mirror row_mask:0xf bank_mask:0xf
    v_add_f32_dpp v194, v194, v194 row_half_mirror row_mask:0xf bank_mask:0xf
    v_add_f32_dpp v195, v195, v195 row_half_mirror row_mask:0xf bank_mask:0xf
    v_cndmask_b32 v184, v184, v187, s[60:61]
    v_cndmask_b32 v190, v190, v193, s[60:61]
    v_cndmask_b32 v185, v185, v188, s[60:61]
    v_cndmask_b32 v191, v191, v194, s[60:61]
    v_cndmask_b32 v186, v186, v189, s[60:61]
    v_cndmask_b32 v192, v192, v195, s[60:61]
    v_cndmask_b32 v184, v184, v190, s[62:63]
    v_cndmask_b32 v185, v185, v191, s[62:63]
    v_cndmask_b32 v186, v186, v192, s[62:63]
    v_cndmask_b32 v184, v184, v185, s[40:41]
    v_cndmask_b32 v186, v186, v196, s[40:41]
    buffer_atomic_add_f32 v184, v231, s[8:11], s48 offen
    buffer_atomic_add_f32 v186, v232, s[8:11], s48 offen
    s_lshl_b32 s32, s3, 13
    v_add_u32 v234, s32, v228
    v_add_u32 v235, 65536, v234
    ds_write_b128 v234, a[128:131] offset:0
    ds_write_b128 v234, a[132:135] offset:1024
    ds_write_b128 v234, a[136:139] offset:2048
    ds_write_b128 v234, a[140:143] offset:3072
    ds_write_b128 v234, a[144:147] offset:4096
    ds_write_b128 v234, a[148:151] offset:5120
    ds_write_b128 v234, a[152:155] offset:6144
    ds_write_b128 v234, a[156:159] offset:7168
    s_waitcnt lgkmcnt(4)
    ds_write_b128 v234, a[160:163] offset:32768
    ds_write_b128 v234, a[164:167] offset:33792
    ds_write_b128 v234, a[168:171] offset:34816
    ds_write_b128 v234, a[172:175] offset:35840
    ds_write_b128 v234, a[176:179] offset:36864
    ds_write_b128 v234, a[180:183] offset:37888
    ds_write_b128 v234, a[184:187] offset:38912
    ds_write_b128 v234, a[188:191] offset:39936
    s_waitcnt lgkmcnt(4)
    ds_write_b128 v235, a[192:195] offset:0
    ds_write_b128 v235, a[196:199] offset:1024
    ds_write_b128 v235, a[200:203] offset:2048
    ds_write_b128 v235, a[204:207] offset:3072
    ds_write_b128 v235, a[208:211] offset:4096
    ds_write_b128 v235, a[212:215] offset:5120
    ds_write_b128 v235, a[216:219] offset:6144
    ds_write_b128 v235, a[220:223] offset:7168
    s_waitcnt lgkmcnt(4)
    s_lshl_b32 s35, s3, 13
    v_bfe_u32 v234, v237, 2, 3
    v_lshrrev_b32_e64 v235, 5, v237
    v_lshl_add_u32 v234, v235, 4, v234
    v_lshlrev_b32 v234, 5, v234
    v_and_b32 v236, 3, v237
    v_lshl_add_u32 v234, v236, 3, v234
    v_add_u32 v217, s35, v234
    v_lshlrev_b32 v235, 5, v235
    v_bfe_u32 v236, v237, 4, 1
    v_lshl_add_u32 v235, v236, 3, v235
    v_and_b32_e64 v236, 1, v237
    v_lshl_add_u32 v235, v236, 11, v235
    s_lshl_b32 s32, s3, 9
    s_add_u32 s32, s32, 98304
    v_add_u32 v218, s32, v235
    v_lshlrev_b32_e64 v234, 4, v230
    v_add_u32 v220, 106752, v234
    v_add_u32 v221, 106752, v228
    v_lshrrev_b32 v236, 2, v237
    v_lshlrev_b32 v236, 7, v236
    v_and_b32_e64 v234, 3, v237
    v_lshl_add_u32 v236, v234, 3, v236
    s_add_u32 s32, s35, 65536
    v_add_u32 v219, s32, v236
    s_lshl_b32 s32, s3, 12
    s_add_u32 s32, s32, 114944
    v_and_b32 v234, 15, v237
    v_min_u32 v234, 2, v234
    v_lshlrev_b32 v234, 10, v234
    v_lshrrev_b32 v235, 4, v237
    v_lshl_add_u32 v234, v235, 4, v234
    v_add_u32 v222, s32, v234
    v_add_u32 v223, s32, v228
    s_mov_b32 s12, 0x00030003
    s_mov_b32 s13, 0x00030003
    s_lshl_b64 s[14:15], s[12:13], 2
    s_lshl_b64 s[16:17], s[12:13], 4
    s_lshl_b64 s[18:19], s[12:13], 6
    s_lshl_b64 s[20:21], s[12:13], 8
    s_lshl_b64 s[22:23], s[12:13], 10
    s_lshl_b64 s[24:25], s[12:13], 12
    s_lshl_b64 s[26:27], s[12:13], 14
    v_and_b32 v234, 1, v237
    v_lshlrev_b32_e64 v234, 12, v234
    v_bfe_u32 v235, v237, 1, 3
    v_lshl_add_u32 v234, v235, 6, v234
    v_lshrrev_b32_e64 v235, 4, v237
    v_lshl_add_u32 v222, v235, 4, v234
    s_lshl_b32 s38, s54, 13
    s_lshl_b32 s33, s3, 10
    s_add_u32 s38, s38, s33
    s_add_u32 s38, s38, 0x3900000
    s_waitcnt vmcnt(0)
    s_barrier
    s_cmp_lg_u32 s3, 0
    s_cbranch_scc1 kc_a1
    s_lshl_b32 s32, s52, 7
    s_add_u32 s32, s32, 0x38a0000
    v_mov_b32_e64 v235, 1
    buffer_atomic_add v235, v243, s[8:11], s32 offen sc0 sc1
    v_lshlrev_b32 v234, 7, v237
    v_cmp_gt_u32 vcc, 8, v237
    v_mov_b32_e64 v236, 0x40000000
    s_mov_b32 s34, 0x38a0400
    v_cndmask_b32 v234, v236, v234, vcc
    s_waitcnt vmcnt(0)
    v_readfirstlane_b32 s36, v235
    s_cmp_lg_u32 s36, 31
    s_cbranch_scc1 kc_a1
    buffer_atomic_add v233, v234, s[8:11], s34 offen sc1
kc_a1:
    s_waitcnt lgkmcnt(0)
    ds_read_b64_tr_b16 a[0:1], v217 offset:0
    ds_read_b64_tr_b16 a[2:3], v217 offset:256
    ds_read_b64_tr_b16 a[32:33], v217 offset:32768
    ds_read_b64_tr_b16 a[34:35], v217 offset:33024
    ds_read_b64_tr_b16 a[4:5], v217 offset:1024
    ds_read_b64_tr_b16 a[6:7], v217 offset:1280
    ds_read_b64_tr_b16 a[36:37], v217 offset:33792
    ds_read_b64_tr_b16 a[38:39], v217 offset:34048
    s_waitcnt lgkmcnt(6)
    ds_read_b64_tr_b16 a[8:9], v217 offset:2048
    ds_read_b64_tr_b16 a[10:11], v217 offset:2304
    ds_read_b64_tr_b16 a[40:41], v217 offset:34816
    ds_read_b64_tr_b16 a[42:43], v217 offset:35072
    ds_read_b64_tr_b16 a[12:13], v217 offset:3072
    ds_read_b64_tr_b16 a[14:15], v217 offset:3328
    ds_read_b64_tr_b16 a[44:45], v217 offset:35840
    ds_read_b64_tr_b16 a[46:47], v217 offset:36096
    s_waitcnt lgkmcnt(6)
    ds_read_b64_tr_b16 a[16:17], v217 offset:4096
    ds_read_b64_tr_b16 a[18:19], v217 offset:4352
    ds_read_b64_tr_b16 a[48:49], v217 offset:36864
    ds_read_b64_tr_b16 a[50:51], v217 offset:37120
    ds_read_b64_tr_b16 a[20:21], v217 offset:5120
    ds_read_b64_tr_b16 a[22:23], v217 offset:5376
    ds_read_b64_tr_b16 a[52:53], v217 offset:37888
    ds_read_b64_tr_b16 a[54:55], v217 offset:38144
    s_waitcnt lgkmcnt(6)
    ds_read_b64_tr_b16 a[24:25], v217 offset:6144
    ds_read_b64_tr_b16 a[26:27], v217 offset:6400
    ds_read_b64_tr_b16 a[56:57], v217 offset:38912
    ds_read_b64_tr_b16 a[58:59], v217 offset:39168
    ds_read_b64_tr_b16 a[28:29], v217 offset:7168
    ds_read_b64_tr_b16 a[30:31], v217 offset:7424
    ds_read_b64_tr_b16 a[60:61], v217 offset:39936
    ds_read_b64_tr_b16 a[62:63], v217 offset:40192
    s_waitcnt lgkmcnt(6)
    ds_read_b64_tr_b16 a[64:65], v219 offset:0
    ds_read_b64_tr_b16 a[66:67], v219 offset:32
    ds_read_b64_tr_b16 a[68:69], v219 offset:64
    ds_read_b64_tr_b16 a[70:71], v219 offset:96
    ds_read_b64_tr_b16 a[72:73], v219 offset:2048
    ds_read_b64_tr_b16 a[74:75], v219 offset:2080
    ds_read_b64_tr_b16 a[76:77], v219 offset:2112
    ds_read_b64_tr_b16 a[78:79], v219 offset:2144
    s_waitcnt lgkmcnt(6)
    ds_read_b64_tr_b16 a[80:81], v219 offset:4096
    ds_read_b64_tr_b16 a[82:83], v219 offset:4128
    ds_read_b64_tr_b16 a[84:85], v219 offset:4160
    ds_read_b64_tr_b16 a[86:87], v219 offset:4192
    ds_read_b64_tr_b16 a[88:89], v219 offset:6144
    ds_read_b64_tr_b16 a[90:91], v219 offset:6176
    ds_read_b64_tr_b16 a[92:93], v219 offset:6208
    ds_read_b64_tr_b16 a[94:95], v219 offset:6240
    s_waitcnt lgkmcnt(6)
    v_mov_b32 v130, 0x3a800000
    v_mov_b32 v131, 0x3a800000
    v_mov_b32 v132, 0x3727c5ac
    v_mov_b32 v133, 0x3727c5ac
    s_mov_b32 s33, 0xfffff800
    s_lshl_b32 s39, s3, 11
    v_add_u32 v238, s39, v228
    v_lshlrev_b32 v239, 2, v242
    s_lshl_b32 s39, s3, 3
    s_add_u32 s7, s39, 106512
    v_lshlrev_b32 v141, 5, v237
    v_or_b32_e64 v141, s39, v141
    s_cmp_lg_u32 s3, 0
    s_cbranch_scc1 kc_b12
    s_lshl_b32 s32, s52, 7
    s_add_u32 s32, s32, 0x38a0400
    s_mov_b32 s34, 0x100000
    s_branch kc_b11
kc_b10:
    s_sleep 2
kc_b11:
    buffer_load_dword v235, off, s[8:11], s32 sc1
    s_waitcnt vmcnt(0)
    v_cmp_ne_u32 vcc, 8, v235
    s_sub_u32 s34, s34, 1
    s_cbranch_scc1 kc_b12
    s_cbranch_vccnz kc_b10
kc_b12:
    s_barrier
    s_add_u32 s32, s48, 24576
    buffer_load_dword v128, off, s[8:11], s32 sc1
    buffer_load_dwordx4 v[32:35], v238, s[8:11], s48 offen offset:0 sc1
    buffer_load_dwordx4 v[40:43], v238, s[8:11], s49 offen offset:0 sc1
    buffer_load_dwordx4 v[48:51], v238, s[8:11], s50 offen offset:0 sc1
    buffer_load_dwordx4 v[36:39], v238, s[8:11], s48 offen offset:1024 sc1
    buffer_load_dwordx4 v[44:47], v238, s[8:11], s49 offen offset:1024 sc1
    buffer_load_dwordx4 v[52:55], v238, s[8:11], s50 offen offset:1024 sc1
    buffer_load_dword v0, v239, s[8:11], s48 offen offset:0 sc1
    buffer_load_dword v4, v239, s[8:11], s49 offen offset:0 sc1
    buffer_load_dword v1, v239, s[8:11], s48 offen offset:32 sc1
    buffer_load_dword v5, v239, s[8:11], s49 offen offset:32 sc1
    buffer_load_dword v2, v239, s[8:11], s48 offen offset:64 sc1
    buffer_load_dword v6, v239, s[8:11], s49 offen offset:64 sc1
    buffer_load_dword v3, v239, s[8:11], s48 offen offset:96 sc1
    buffer_load_dword v7, v239, s[8:11], s49 offen offset:96 sc1
    s_waitcnt vmcnt(8)
    v_mov_b32 v129, v128
    v_pk_mul_f32 v[32:33], v[32:33], v[130:131]
    v_pk_mul_f32 v[34:35], v[34:35], v[130:131]
    v_pk_mul_f32 v[36:37], v[36:37], v[130:131]
    v_pk_mul_f32 v[38:39], v[38:39], v[130:131]
    v_pk_fma_f32 v[40:41], v[40:41], v[130:131], v[132:133]
    v_pk_fma_f32 v[42:43], v[42:43], v[130:131], v[132:133]
    v_pk_fma_f32 v[44:45], v[44:45], v[130:131], v[132:133]
    v_pk_fma_f32 v[46:47], v[46:47], v[130:131], v[132:133]
    v_pk_fma_f32 v[40:41], v[32:33], v[32:33], v[40:41] neg_lo:[1,0,0] neg_hi:[1,0,0]
    v_pk_fma_f32 v[42:43], v[34:35], v[34:35], v[42:43] neg_lo:[1,0,0] neg_hi:[1,0,0]
    v_pk_fma_f32 v[44:45], v[36:37], v[36:37], v[44:45] neg_lo:[1,0,0] neg_hi:[1,0,0]
    v_pk_fma_f32 v[46:47], v[38:39], v[38:39], v[46:47] neg_lo:[1,0,0] neg_hi:[1,0,0]
    v_pk_fma_f32 v[48:49], v[32:33], v[128:129], v[48:49] neg_lo:[1,0,0] neg_hi:[1,0,0]
    v_pk_fma_f32 v[50:51], v[34:35], v[128:129], v[50:51] neg_lo:[1,0,0] neg_hi:[1,0,0]
    v_pk_fma_f32 v[52:53], v[36:37], v[128:129], v[52:53] neg_lo:[1,0,0] neg_hi:[1,0,0]
    v_pk_fma_f32 v[54:55], v[38:39], v[128:129], v[54:55] neg_lo:[1,0,0] neg_hi:[1,0,0]
    v_max_f32 v40, v40, v132
    v_max_f32 v42, v42, v132
    v_max_f32 v44, v44, v132
    v_max_f32 v46, v46, v132
    v_max_f32 v41, v41, v132
    v_max_f32 v43, v43, v132
    v_max_f32 v45, v45, v132
    v_max_f32 v47, v47, v132
    v_rsq_f32 v40, v40
    v_rsq_f32 v42, v42
    v_rsq_f32 v44, v44
    v_rsq_f32 v46, v46
    v_rsq_f32 v41, v41
    v_rsq_f32 v43, v43
    v_rsq_f32 v45, v45
    v_rsq_f32 v47, v47
    v_pk_mul_f32 v[48:49], v[48:49], v[40:41]
    v_pk_mul_f32 v[50:51], v[50:51], v[42:43]
    v_pk_mul_f32 v[52:53], v[52:53], v[44:45]
    v_pk_mul_f32 v[54:55], v[54:55], v[46:47]
    v_and_or_b32 v48, v48, s33, 0
    v_and_or_b32 v50, v50, s33, 2
    v_and_or_b32 v52, v52, s33, 4
    v_and_or_b32 v54, v54, s33, 6
    v_and_or_b32 v49, v49, s33, 1
    v_and_or_b32 v51, v51, s33, 3
    v_and_or_b32 v53, v53, s33, 5
    v_and_or_b32 v55, v55, s33, 7
    v_max_f32 v136, v48, v49
    v_min_f32 v137, v48, v49
    v_med3_f32 v137, v136, v50, v137
    v_max_f32_e64 v136, v136, v50
    v_med3_f32 v137, v136, v51, v137
    v_max_f32_e64 v136, v136, v51
    v_med3_f32 v137, v136, v52, v137
    v_max_f32_e64 v136, v136, v52
    v_med3_f32 v137, v136, v53, v137
    v_max_f32_e64 v136, v136, v53
    v_med3_f32 v137, v136, v54, v137
    v_max_f32_e64 v136, v136, v54
    v_med3_f32 v137, v136, v55, v137
    v_max_f32 v136, v136, v55
    v_or_b32 v136, v141, v136
    v_or_b32 v137, v141, v137
    s_nop 1
    v_mov_b32_dpp v138, v136 quad_perm:[1,0,3,2] row_mask:0xf bank_mask:0xf
    v_mov_b32_dpp v139, v137 quad_perm:[1,0,3,2] row_mask:0xf bank_mask:0xf
    v_min_f32 v140, v136, v138
    v_max_f32 v136, v136, v138
    v_max3_f32 v137, v140, v137, v139
    s_nop 1
    v_mov_b32_dpp v138, v136 quad_perm:[2,3,0,1] row_mask:0xf bank_mask:0xf
    v_mov_b32_dpp v139, v137 quad_perm:[2,3,0,1] row_mask:0xf bank_mask:0xf
    v_min_f32 v140, v136, v138
    v_max_f32_e64 v136, v136, v138
    v_max3_f32 v137, v140, v137, v139
    s_nop 1
    v_mov_b32_dpp v138, v136 row_half_mirror row_mask:0xf bank_mask:0xf
    v_mov_b32_dpp v139, v137 row_half_mirror row_mask:0xf bank_mask:0xf
    v_min_f32 v140, v136, v138
    v_max_f32_e64 v136, v136, v138
    v_max3_f32 v137, v140, v137, v139
    s_nop 1
    v_mov_b32_dpp v138, v136 row_mirror row_mask:0xf bank_mask:0xf
    v_mov_b32_dpp v139, v137 row_mirror row_mask:0xf bank_mask:0xf
    v_min_f32 v140, v136, v138
    v_max_f32_e64 v136, v136, v138
    v_max3_f32 v137, v140, v137, v139
    v_mov_b32 v138, v136
    v_mov_b32 v139, v137
    s_nop 1
    v_permlane16_swap_b32 v136, v138
    v_permlane16_swap_b32 v137, v139
    s_nop 0
    v_min_f32 v140, v136, v138
    v_max_f32 v136, v136, v138
    v_max3_f32 v137, v140, v137, v139
    v_mov_b32 v138, v136
    v_mov_b32 v139, v137
    s_nop 1
    v_permlane32_swap_b32 v136, v138
    v_permlane32_swap_b32 v137, v139
    s_nop 0
    v_min_f32 v140, v136, v138
    v_max_f32 v136, v136, v138
    v_max3_f32 v137, v140, v137, v139
    v_mov_b32_e64 v234, s7
    ds_write_b64 v234, v[136:137]
    v_mov_b32 v234, 106512
    s_waitcnt lgkmcnt(0)
    s_barrier
    ds_read_b128 v[56:59], v234
    ds_read_b128 v[60:63], v234 offset:16
    s_waitcnt lgkmcnt(0)
    v_min_f32 v140, v56, v58
    v_max_f32_e64 v56, v56, v58
    v_max3_f32 v57, v140, v57, v59
    v_min_f32 v140, v60, v62
    v_max_f32 v60, v60, v62
    v_max3_f32 v61, v140, v61, v63
    v_min_f32 v140, v56, v60
    v_max_f32 v56, v56, v60
    v_max3_f32 v57, v140, v57, v61
    v_bfe_u32 v234, v56, 5, 6
    v_bfe_u32 v235, v56, 2, 3
    v_and_b32_e64 v8, 3, v56
    v_lshl_add_u32 v8, v234, 2, v8
    v_lshl_add_u32 v8, v235, 8, v8
    v_bfe_u32 v234, v57, 5, 6
    v_bfe_u32 v235, v57, 2, 3
    v_and_b32_e64 v10, 3, v57
    v_lshl_add_u32 v10, v234, 2, v10
    v_lshl_add_u32 v10, v235, 8, v10
    s_cmp_lt_u32 s3, 2
    s_cselect_b64 vcc, -1, 0
    v_lshlrev_b32 v236, 4, v230
    v_cndmask_b32 v142, v10, v8, vcc
    v_lshlrev_b32_e64 v234, 2, v142
    v_and_b32 v235, 2047, v236
    v_lshl_add_u32 v235, v142, 11, v235
    s_mov_b32 s32, 0x3400000
    buffer_load_dwordx4 v[32:35], v235, s[8:11], s32 offen sc1
    buffer_load_dword v144, v234, s[8:11], s48 offen sc1
    buffer_load_dword v145, v234, s[8:11], s49 offen sc1
    buffer_load_dword v146, v234, s[8:11], s50 offen sc1
    v_add_u32 v236, 98304, v236
    s_lshr_b32 s32, s3, 1
    s_lshl_b32 s32, s32, 2
    s_add_u32 s32, s32, 106496
    v_mov_b32 v234, s32
    s_waitcnt vmcnt(4)
    v_mul_f32 v0, 0x3a800000, v0
    v_mul_f32 v1, 0x3a800000, v1
    v_mul_f32 v2, 0x3a800000, v2
    v_mul_f32 v3, 0x3a800000, v3
    v_mul_f32 v4, 0x3a800000, v4
    v_mul_f32 v5, 0x3a800000, v5
    v_mul_f32 v6, 0x3a800000, v6
    v_mul_f32 v7, 0x3a800000, v7
    v_fma_f32 v4, -v0, v0, v4
    v_fma_f32 v5, -v1, v1, v5
    v_fma_f32 v6, -v2, v2, v6
    v_fma_f32 v7, -v3, v3, v7
    v_max_f32 v4, 0, v4
    v_max_f32 v5, 0, v5
    v_max_f32 v6, 0, v6
    v_max_f32 v7, 0, v7
    v_cvt_pk_bf16_f32 v12, v0, v4
    v_cvt_pk_bf16_f32 v13, v1, v5
    v_cvt_pk_bf16_f32 v14, v2, v6
    v_cvt_pk_bf16_f32 v15, v3, v7
    v_lshlrev_b32 v0, 16, v12
    v_lshlrev_b32 v1, 16, v13
    v_lshlrev_b32 v2, 16, v14
    v_lshlrev_b32 v3, 16, v15
    v_and_b32 v4, 0xffff0000, v12
    v_and_b32 v5, 0xffff0000, v13
    v_and_b32 v6, 0xffff0000, v14
    v_and_b32 v7, 0xffff0000, v15
    v_add_f32 v4, 0x3727c5ac, v4
    v_add_f32 v5, 0x3727c5ac, v5
    v_add_f32 v6, 0x3727c5ac, v6
    v_add_f32 v7, 0x3727c5ac, v7
    v_cvt_pk_bf16_f32 v4, v4, v4
    v_cvt_pk_bf16_f32 v5, v5, v5
    v_cvt_pk_bf16_f32 v6, v6, v6
    v_cvt_pk_bf16_f32 v7, v7, v7
    v_lshlrev_b32 v4, 16, v4
    v_lshlrev_b32 v5, 16, v5
    v_lshlrev_b32 v6, 16, v6
    v_lshlrev_b32 v7, 16, v7
    v_sqrt_f32 v4, v4
    v_sqrt_f32 v5, v5
    v_sqrt_f32 v6, v6
    v_sqrt_f32 v7, v7
    v_cvt_pk_bf16_f32 v4, v4, v4
    v_cvt_pk_bf16_f32 v5, v5, v5
    v_cvt_pk_bf16_f32 v6, v6, v6
    v_cvt_pk_bf16_f32 v7, v7, v7
    v_lshlrev_b32 v4, 16, v4
    v_lshlrev_b32 v5, 16, v5
    v_lshlrev_b32 v6, 16, v6
    v_lshlrev_b32 v7, 16, v7
    v_rcp_f32 v4, v4
    v_rcp_f32 v5, v5
    v_rcp_f32 v6, v6
    v_rcp_f32_e64 v7, v7
    s_waitcnt vmcnt(0)
    v_mul_f32 v144, 0x3a800000, v144
    v_mul_f32 v145, 0x3a800000, v145
    v_fma_f32 v145, -v144, v144, v145
    v_max_f32_e64 v145, 0, v145
    v_cvt_pk_bf16_f32 v140, v144, v145
    v_lshlrev_b32_e64 v144, 16, v140
    v_and_b32 v145, 0xffff0000, v140
    v_add_f32 v145, 0x3727c5ac, v145
    v_cvt_pk_bf16_f32 v145, v145, v145
    v_lshlrev_b32_e64 v145, 16, v145
    v_sqrt_f32 v145, v145
    s_nop 0
    v_cvt_pk_bf16_f32 v145, v145, v145
    v_lshlrev_b32 v145, 16, v145
    v_rcp_f32 v145, v145
    s_nop 0
    v_lshlrev_b32 v64, 16, v32
    v_lshlrev_b32 v66, 16, v33
    v_lshlrev_b32 v68, 16, v34
    v_lshlrev_b32_e64 v70, 16, v35
    v_and_b32 v65, 0xffff0000, v32
    v_and_b32 v67, 0xffff0000, v33
    v_and_b32 v69, 0xffff0000, v34
    v_and_b32 v71, 0xffff0000, v35
    v_sub_f32 v64, v64, v144
    v_sub_f32 v66, v66, v144
    v_sub_f32 v68, v68, v144
    v_sub_f32 v70, v70, v144
    v_sub_f32 v65, v65, v144
    v_sub_f32 v67, v67, v144
    v_sub_f32 v69, v69, v144
    v_sub_f32 v71, v71, v144
    v_cvt_pk_bf16_f32 v65, v64, v65
    v_cvt_pk_bf16_f32 v67, v66, v67
    v_cvt_pk_bf16_f32 v69, v68, v69
    v_cvt_pk_bf16_f32 v71, v70, v71
    v_lshlrev_b32 v64, 16, v65
    v_lshlrev_b32 v66, 16, v67
    v_lshlrev_b32 v68, 16, v69
    v_lshlrev_b32 v70, 16, v71
    v_and_b32 v65, 0xffff0000, v65
    v_and_b32 v67, 0xffff0000, v67
    v_and_b32 v69, 0xffff0000, v69
    v_and_b32 v71, 0xffff0000, v71
    v_mul_f32 v64, v64, v145
    v_mul_f32 v66, v66, v145
    v_mul_f32 v68, v68, v145
    v_mul_f32 v70, v70, v145
    v_mul_f32 v65, v65, v145
    v_mul_f32 v67, v67, v145
    v_mul_f32 v69, v69, v145
    v_mul_f32 v71, v71, v145
    v_cvt_pk_bf16_f32 v48, v64, v65
    v_cvt_pk_bf16_f32 v49, v66, v67
    v_cvt_pk_bf16_f32 v50, v68, v69
    v_cvt_pk_bf16_f32 v51, v70, v71
    ds_write_b128 v236, v[48:51]
    ds_write_b128 v236, v[32:35] offset:4096
    v_fma_f32 v143, -v144, v128, v146
    v_mul_f32_e64 v143, v143, v145
    ds_write_b32 v234, v143
    s_waitcnt lgkmcnt(0)
kc_com:
    s_barrier
    s_cmp_ge_u32 s53, 28
    s_cbranch_scc1 kc_red
    ds_read_b64 v[96:97], v218 offset:0
    ds_read_b64 v[98:99], v218 offset:16
    ds_read_b64 v[100:101], v218 offset:64
    ds_read_b64 v[102:103], v218 offset:80
    ds_read_b64 v[104:105], v218 offset:128
    ds_read_b64 v[106:107], v218 offset:144
    ds_read_b64 v[108:109], v218 offset:192
    ds_read_b64 v[110:111], v218 offset:208
    ds_read_b64 v[112:113], v218 offset:256
    ds_read_b64 v[114:115], v218 offset:272
    ds_read_b64 v[116:117], v218 offset:320
    ds_read_b64 v[118:119], v218 offset:336
    ds_read_b64 v[120:121], v218 offset:384
    ds_read_b64 v[122:123], v218 offset:400
    s_waitcnt lgkmcnt(12)
    ds_read_b64 v[124:125], v218 offset:448
    ds_read_b64 v[126:127], v218 offset:464
    v_mfma_f32_16x16x32_bf16 v[128:131], a[0:3], v[96:99], 0
    v_mfma_f32_16x16x32_bf16 v[132:135], a[32:35], v[96:99], 0
    s_waitcnt lgkmcnt(12)
    v_mfma_f32_16x16x32_bf16 v[128:131], a[4:7], v[100:103], v[128:131]
    v_mfma_f32_16x16x32_bf16 v[132:135], a[36:39], v[100:103], v[132:135]
    s_waitcnt lgkmcnt(10)
    v_mfma_f32_16x16x32_bf16 v[128:131], a[8:11], v[104:107], v[128:131]
    v_mfma_f32_16x16x32_bf16 v[132:135], a[40:43], v[104:107], v[132:135]
    s_waitcnt lgkmcnt(8)
    v_mfma_f32_16x16x32_bf16 v[128:131], a[12:15], v[108:111], v[128:131]
    v_mfma_f32_16x16x32_bf16 v[132:135], a[44:47], v[108:111], v[132:135]
    s_waitcnt lgkmcnt(6)
    v_mfma_f32_16x16x32_bf16 v[128:131], a[16:19], v[112:115], v[128:131]
    v_mfma_f32_16x16x32_bf16 v[132:135], a[48:51], v[112:115], v[132:135]
    s_waitcnt lgkmcnt(4)
    v_mfma_f32_16x16x32_bf16 v[128:131], a[20:23], v[116:119], v[128:131]
    v_mfma_f32_16x16x32_bf16 v[132:135], a[52:55], v[116:119], v[132:135]
    s_waitcnt lgkmcnt(2)
    v_mfma_f32_16x16x32_bf16 v[128:131], a[24:27], v[120:123], v[128:131]
    v_mfma_f32_16x16x32_bf16 v[132:135], a[56:59], v[120:123], v[132:135]
    s_waitcnt lgkmcnt(0)
    v_mfma_f32_16x16x32_bf16 v[128:131], a[28:31], v[124:127], v[128:131]
    v_mfma_f32_16x16x32_bf16 v[132:135], a[60:63], v[124:127], v[132:135]
    s_nop 6
    ds_write_b128 v220, v[128:131]
    ds_write_b128 v220, v[132:135] offset:4096
    s_waitcnt lgkmcnt(0)
    s_barrier
    ds_read_b128 v[32:35], v221 offset:0
    ds_read_b128 v[48:51], v221 offset:4096
    ds_read_b128 v[36:39], v221 offset:1024
    ds_read_b128 v[52:55], v221 offset:5120
    ds_read_b128 v[40:43], v221 offset:2048
    ds_read_b128 v[56:59], v221 offset:6144
    ds_read_b128 v[44:47], v221 offset:3072
    ds_read_b128 v[60:63], v221 offset:7168
    s_waitcnt lgkmcnt(0)
    v_pk_add_f32 v[32:33], v[32:33], v[36:37]
    v_pk_add_f32 v[34:35], v[34:35], v[38:39]
    v_pk_add_f32 v[40:41], v[40:41], v[44:45]
    v_pk_add_f32 v[42:43], v[42:43], v[46:47]
    v_pk_add_f32 v[48:49], v[48:49], v[52:53]
    v_pk_add_f32 v[50:51], v[50:51], v[54:55]
    v_pk_add_f32 v[56:57], v[56:57], v[60:61]
    v_pk_add_f32 v[58:59], v[58:59], v[62:63]
    v_pk_add_f32 v[32:33], v[32:33], v[40:41]
    v_pk_add_f32 v[34:35], v[34:35], v[42:43]
    v_pk_add_f32 v[48:49], v[48:49], v[56:57]
    v_pk_add_f32 v[50:51], v[50:51], v[58:59]
    v_cvt_pk_bf16_f32 v48, v32, v48
    v_cvt_pk_bf16_f32 v49, v33, v49
    v_cvt_pk_bf16_f32 v50, v34, v50
    v_cvt_pk_bf16_f32 v51, v35, v51
    v_lshlrev_b32 v32, 16, v48
    v_lshlrev_b32 v33, 16, v49
    v_lshlrev_b32 v34, 16, v50
    v_lshlrev_b32 v35, 16, v51
    v_and_b32 v48, 0xffff0000, v48
    v_and_b32 v49, 0xffff0000, v49
    v_and_b32 v50, 0xffff0000, v50
    v_and_b32 v51, 0xffff0000, v51
    v_mul_f32 v136, 0xbfb8aa3b, v32
    v_mul_f32 v137, 0xbfb8aa3b, v33
    v_mul_f32 v138, 0xbfb8aa3b, v34
    v_mul_f32 v139, 0xbfb8aa3b, v35
    v_exp_f32 v136, v136
    v_exp_f32 v137, v137
    v_exp_f32 v138, v138
    v_exp_f32 v139, v139
    v_add_f32 v136, 1.0, v136
    v_add_f32 v137, 1.0, v137
    v_add_f32 v138, 1.0, v138
    v_add_f32 v139, 1.0, v139
    v_rcp_f32 v136, v136
    v_rcp_f32 v137, v137
    v_rcp_f32 v138, v138
    v_rcp_f32 v139, v139
    v_mul_f32 v32, v32, v136
    v_mul_f32 v33, v33, v137
    v_mul_f32 v34, v34, v138
    v_mul_f32 v35, v35, v139
    v_cvt_pk_bf16_f32 v32, v32, v32
    v_cvt_pk_bf16_f32 v33, v33, v33
    v_cvt_pk_bf16_f32 v34, v34, v34
    v_cvt_pk_bf16_f32 v35, v35, v35
    v_lshlrev_b32 v32, 16, v32
    v_lshlrev_b32 v33, 16, v33
    v_lshlrev_b32 v34, 16, v34
    v_lshlrev_b32 v35, 16, v35
    v_mul_f32 v32, v32, v48
    v_mul_f32 v33, v33, v49
    v_mul_f32 v34, v34, v50
    v_mul_f32 v35, v35, v51
    v_cvt_pk_bf16_f32 v128, v32, v33
    v_cvt_pk_bf16_f32 v129, v34, v35
    v_cndmask_b32 v64, 0, v128, s[12:13]
    v_cndmask_b32 v65, 0, v129, s[12:13]
    v_cndmask_b32 v66, 0, v128, s[14:15]
    v_cndmask_b32 v67, 0, v129, s[14:15]
    v_cndmask_b32 v68, 0, v128, s[16:17]
    v_cndmask_b32 v69, 0, v129, s[16:17]
    v_cndmask_b32 v70, 0, v128, s[18:19]
    v_cndmask_b32 v71, 0, v129, s[18:19]
    v_cndmask_b32 v72, 0, v128, s[20:21]
    v_cndmask_b32 v73, 0, v129, s[20:21]
    v_cndmask_b32 v74, 0, v128, s[22:23]
    v_cndmask_b32 v75, 0, v129, s[22:23]
    v_cndmask_b32 v76, 0, v128, s[24:25]
    v_cndmask_b32 v77, 0, v129, s[24:25]
    v_cndmask_b32 v78, 0, v128, s[26:27]
    v_cndmask_b32 v79, 0, v129, s[26:27]
    v_mfma_f32_16x16x32_bf16 v[32:35], a[64:67], v[64:67], 0
    v_mfma_f32_16x16x32_bf16 v[36:39], a[80:83], v[64:67], 0
    v_mfma_f32_16x16x32_bf16 v[32:35], a[68:71], v[68:71], v[32:35]
    v_mfma_f32_16x16x32_bf16 v[36:39], a[84:87], v[68:71], v[36:39]
    v_mfma_f32_16x16x32_bf16 v[32:35], a[72:75], v[72:75], v[32:35]
    v_mfma_f32_16x16x32_bf16 v[36:39], a[88:91], v[72:75], v[36:39]
    v_mfma_f32_16x16x32_bf16 v[32:35], a[76:79], v[76:79], v[32:35]
    v_mfma_f32_16x16x32_bf16 v[36:39], a[92:95], v[76:79], v[36:39]
    s_nop 6
    buffer_store_dwordx4 v[32:35], v222, s[8:11], s38 offen sc1
    buffer_store_dwordx4 v[36:39], v222, s[8:11], s38 offen offset:512 sc1
    v_lshlrev_b32 v144, 16, v16
    v_lshlrev_b32 v148, 16, v17
    v_lshlrev_b32 v152, 16, v18
    v_lshlrev_b32_e64 v156, 16, v19
    v_and_b32 v145, 0xffff0000, v16
    v_and_b32 v149, 0xffff0000, v17
    v_and_b32 v153, 0xffff0000, v18
    v_and_b32 v157, 0xffff0000, v19
    v_sub_f32 v144, v144, v0
    v_sub_f32 v148, v148, v0
    v_sub_f32 v152, v152, v0
    v_sub_f32 v156, v156, v0
    v_sub_f32 v145, v145, v0
    v_sub_f32 v149, v149, v0
    v_sub_f32 v153, v153, v0
    v_sub_f32 v157, v157, v0
    v_cvt_pk_bf16_f32 v145, v144, v145
    v_cvt_pk_bf16_f32 v149, v148, v149
    v_cvt_pk_bf16_f32 v153, v152, v153
    v_cvt_pk_bf16_f32 v157, v156, v157
    v_lshlrev_b32 v144, 16, v145
    v_lshlrev_b32 v148, 16, v149
    v_lshlrev_b32 v152, 16, v153
    v_lshlrev_b32 v156, 16, v157
    v_and_b32 v145, 0xffff0000, v145
    v_and_b32 v149, 0xffff0000, v149
    v_and_b32 v153, 0xffff0000, v153
    v_and_b32 v157, 0xffff0000, v157
    v_mul_f32 v144, v144, v4
    v_mul_f32 v148, v148, v4
    v_mul_f32 v152, v152, v4
    v_mul_f32 v156, v156, v4
    v_mul_f32 v145, v145, v4
    v_mul_f32 v149, v149, v4
    v_mul_f32 v153, v153, v4
    v_mul_f32 v157, v157, v4
    v_cvt_pk_bf16_f32 v146, v144, v145
    v_cvt_pk_bf16_f32 v150, v148, v149
    v_cvt_pk_bf16_f32 v154, v152, v153
    v_cvt_pk_bf16_f32 v158, v156, v157
    v_lshlrev_b32 v144, 16, v146
    v_lshlrev_b32 v148, 16, v150
    v_lshlrev_b32 v152, 16, v154
    v_lshlrev_b32 v156, 16, v158
    v_and_b32 v145, 0xffff0000, v146
    v_and_b32 v149, 0xffff0000, v150
    v_and_b32 v153, 0xffff0000, v154
    v_and_b32 v157, 0xffff0000, v158
    v_lshlrev_b32 v146, 16, v16
    v_lshlrev_b32 v150, 16, v17
    v_lshlrev_b32 v154, 16, v18
    v_lshlrev_b32 v158, 16, v19
    v_and_b32 v147, 0xffff0000, v16
    v_and_b32 v151, 0xffff0000, v17
    v_and_b32 v155, 0xffff0000, v18
    v_and_b32 v159, 0xffff0000, v19
    v_pk_add_f32 v[144:145], v[144:145], v[146:147]
    v_pk_add_f32 v[148:149], v[148:149], v[150:151]
    v_pk_add_f32 v[152:153], v[152:153], v[154:155]
    v_pk_add_f32 v[156:157], v[156:157], v[158:159]
    v_cvt_pk_bf16_f32 v16, v144, v145
    v_cvt_pk_bf16_f32 v17, v148, v149
    v_cvt_pk_bf16_f32 v18, v152, v153
    v_cvt_pk_bf16_f32 v19, v156, v157
    v_add_u32 v160, 0, v242
    v_cmp_eq_u32 vcc, v160, v8
    v_cmp_eq_u32 s[60:61], v160, v10
    v_mov_b32 v161, 0x40000000
    s_or_b64 vcc, vcc, s[60:61]
    v_cndmask_b32 v12, v229, v161, vcc
    s_waitcnt vmcnt(0)
    s_barrier
    s_cmp_lg_u32 s3, 0
    s_cbranch_scc1 kc_a2
    s_lshl_b32 s32, s52, 7
    s_add_u32 s32, s32, 0x38a0800
    v_mov_b32_e64 v235, 1
    buffer_atomic_add v235, v243, s[8:11], s32 offen sc0 sc1
    v_lshlrev_b32 v234, 7, v237
    v_cmp_gt_u32 vcc, 8, v237
    v_mov_b32_e64 v236, 0x40000000
    s_mov_b32 s34, 0x38a0c00
    v_cndmask_b32 v234, v236, v234, vcc
    s_waitcnt vmcnt(0)
    v_readfirstlane_b32 s36, v235
    s_cmp_lg_u32 s36, 27
    s_cbranch_scc1 kc_a2
    buffer_atomic_add v233, v234, s[8:11], s34 offen sc1
kc_a2:
    v_lshlrev_b32 v144, 16, v20
    v_lshlrev_b32 v148, 16, v21
    v_lshlrev_b32 v152, 16, v22
    v_lshlrev_b32_e64 v156, 16, v23
    v_and_b32 v145, 0xffff0000, v20
    v_and_b32 v149, 0xffff0000, v21
    v_and_b32 v153, 0xffff0000, v22
    v_and_b32 v157, 0xffff0000, v23
    v_sub_f32 v144, v144, v1
    v_sub_f32 v148, v148, v1
    v_sub_f32 v152, v152, v1
    v_sub_f32 v156, v156, v1
    v_sub_f32 v145, v145, v1
    v_sub_f32 v149, v149, v1
    v_sub_f32 v153, v153, v1
    v_sub_f32 v157, v157, v1
    v_cvt_pk_bf16_f32 v145, v144, v145
    v_cvt_pk_bf16_f32 v149, v148, v149
    v_cvt_pk_bf16_f32 v153, v152, v153
    v_cvt_pk_bf16_f32 v157, v156, v157
    v_lshlrev_b32 v144, 16, v145
    v_lshlrev_b32 v148, 16, v149
    v_lshlrev_b32 v152, 16, v153
    v_lshlrev_b32 v156, 16, v157
    v_and_b32 v145, 0xffff0000, v145
    v_and_b32 v149, 0xffff0000, v149
    v_and_b32 v153, 0xffff0000, v153
    v_and_b32 v157, 0xffff0000, v157
    v_mul_f32 v144, v144, v5
    v_mul_f32 v148, v148, v5
    v_mul_f32 v152, v152, v5
    v_mul_f32 v156, v156, v5
    v_mul_f32 v145, v145, v5
    v_mul_f32 v149, v149, v5
    v_mul_f32 v153, v153, v5
    v_mul_f32 v157, v157, v5
    v_cvt_pk_bf16_f32 v146, v144, v145
    v_cvt_pk_bf16_f32 v150, v148, v149
    v_cvt_pk_bf16_f32 v154, v152, v153
    v_cvt_pk_bf16_f32 v158, v156, v157
    v_lshlrev_b32 v144, 16, v146
    v_lshlrev_b32 v148, 16, v150
    v_lshlrev_b32 v152, 16, v154
    v_lshlrev_b32 v156, 16, v158
    v_and_b32 v145, 0xffff0000, v146
    v_and_b32 v149, 0xffff0000, v150
    v_and_b32 v153, 0xffff0000, v154
    v_and_b32 v157, 0xffff0000, v158
    v_lshlrev_b32 v146, 16, v20
    v_lshlrev_b32 v150, 16, v21
    v_lshlrev_b32 v154, 16, v22
    v_lshlrev_b32 v158, 16, v23
    v_and_b32 v147, 0xffff0000, v20
    v_and_b32 v151, 0xffff0000, v21
    v_and_b32 v155, 0xffff0000, v22
    v_and_b32 v159, 0xffff0000, v23
    v_pk_add_f32 v[144:145], v[144:145], v[146:147]
    v_pk_add_f32 v[148:149], v[148:149], v[150:151]
    v_pk_add_f32 v[152:153], v[152:153], v[154:155]
    v_pk_add_f32 v[156:157], v[156:157], v[158:159]
    v_cvt_pk_bf16_f32 v20, v144, v145
    v_cvt_pk_bf16_f32 v21, v148, v149
    v_cvt_pk_bf16_f32 v22, v152, v153
    v_cvt_pk_bf16_f32 v23, v156, v157
    v_add_u32 v160, 8, v242
    v_cmp_eq_u32 vcc, v160, v8
    v_cmp_eq_u32 s[60:61], v160, v10
    v_mov_b32 v161, 0x40000000
    s_or_b64 vcc, vcc, s[60:61]
    v_cndmask_b32 v13, v229, v161, vcc
    v_lshlrev_b32 v144, 16, v24
    v_lshlrev_b32 v148, 16, v25
    v_lshlrev_b32 v152, 16, v26
    v_lshlrev_b32_e64 v156, 16, v27
    v_and_b32 v145, 0xffff0000, v24
    v_and_b32 v149, 0xffff0000, v25
    v_and_b32 v153, 0xffff0000, v26
    v_and_b32 v157, 0xffff0000, v27
    v_sub_f32 v144, v144, v2
    v_sub_f32 v148, v148, v2
    v_sub_f32 v152, v152, v2
    v_sub_f32 v156, v156, v2
    v_sub_f32 v145, v145, v2
    v_sub_f32 v149, v149, v2
    v_sub_f32 v153, v153, v2
    v_sub_f32 v157, v157, v2
    v_cvt_pk_bf16_f32 v145, v144, v145
    v_cvt_pk_bf16_f32 v149, v148, v149
    v_cvt_pk_bf16_f32 v153, v152, v153
    v_cvt_pk_bf16_f32 v157, v156, v157
    v_lshlrev_b32 v144, 16, v145
    v_lshlrev_b32 v148, 16, v149
    v_lshlrev_b32 v152, 16, v153
    v_lshlrev_b32 v156, 16, v157
    v_and_b32 v145, 0xffff0000, v145
    v_and_b32 v149, 0xffff0000, v149
    v_and_b32 v153, 0xffff0000, v153
    v_and_b32 v157, 0xffff0000, v157
    v_mul_f32 v144, v144, v6
    v_mul_f32 v148, v148, v6
    v_mul_f32 v152, v152, v6
    v_mul_f32 v156, v156, v6
    v_mul_f32 v145, v145, v6
    v_mul_f32 v149, v149, v6
    v_mul_f32 v153, v153, v6
    v_mul_f32 v157, v157, v6
    v_cvt_pk_bf16_f32 v146, v144, v145
    v_cvt_pk_bf16_f32 v150, v148, v149
    v_cvt_pk_bf16_f32 v154, v152, v153
    v_cvt_pk_bf16_f32 v158, v156, v157
    v_lshlrev_b32 v144, 16, v146
    v_lshlrev_b32 v148, 16, v150
    v_lshlrev_b32 v152, 16, v154
    v_lshlrev_b32 v156, 16, v158
    v_and_b32 v145, 0xffff0000, v146
    v_and_b32 v149, 0xffff0000, v150
    v_and_b32 v153, 0xffff0000, v154
    v_and_b32 v157, 0xffff0000, v158
    v_lshlrev_b32 v146, 16, v24
    v_lshlrev_b32 v150, 16, v25
    v_lshlrev_b32 v154, 16, v26
    v_lshlrev_b32 v158, 16, v27
    v_and_b32 v147, 0xffff0000, v24
    v_and_b32 v151, 0xffff0000, v25
    v_and_b32 v155, 0xffff0000, v26
    v_and_b32 v159, 0xffff0000, v27
    v_pk_add_f32 v[144:145], v[144:145], v[146:147]
    v_pk_add_f32 v[148:149], v[148:149], v[150:151]
    v_pk_add_f32 v[152:153], v[152:153], v[154:155]
    v_pk_add_f32 v[156:157], v[156:157], v[158:159]
    v_cvt_pk_bf16_f32 v24, v144, v145
    v_cvt_pk_bf16_f32 v25, v148, v149
    v_cvt_pk_bf16_f32 v26, v152, v153
    v_cvt_pk_bf16_f32 v27, v156, v157
    v_add_u32 v160, 16, v242
    v_cmp_eq_u32 vcc, v160, v8
    v_cmp_eq_u32 s[60:61], v160, v10
    v_mov_b32 v161, 0x40000000
    s_or_b64 vcc, vcc, s[60:61]
    v_cndmask_b32 v14, v229, v161, vcc
    v_lshlrev_b32 v144, 16, v28
    v_lshlrev_b32 v148, 16, v29
    v_lshlrev_b32 v152, 16, v30
    v_lshlrev_b32_e64 v156, 16, v31
    v_and_b32 v145, 0xffff0000, v28
    v_and_b32 v149, 0xffff0000, v29
    v_and_b32 v153, 0xffff0000, v30
    v_and_b32 v157, 0xffff0000, v31
    v_sub_f32 v144, v144, v3
    v_sub_f32 v148, v148, v3
    v_sub_f32 v152, v152, v3
    v_sub_f32 v156, v156, v3
    v_sub_f32 v145, v145, v3
    v_sub_f32 v149, v149, v3
    v_sub_f32 v153, v153, v3
    v_sub_f32 v157, v157, v3
    v_cvt_pk_bf16_f32 v145, v144, v145
    v_cvt_pk_bf16_f32 v149, v148, v149
    v_cvt_pk_bf16_f32 v153, v152, v153
    v_cvt_pk_bf16_f32 v157, v156, v157
    v_lshlrev_b32 v144, 16, v145
    v_lshlrev_b32 v148, 16, v149
    v_lshlrev_b32 v152, 16, v153
    v_lshlrev_b32 v156, 16, v157
    v_and_b32 v145, 0xffff0000, v145
    v_and_b32 v149, 0xffff0000, v149
    v_and_b32 v153, 0xffff0000, v153
    v_and_b32 v157, 0xffff0000, v157
    v_mul_f32 v144, v144, v7
    v_mul_f32 v148, v148, v7
    v_mul_f32 v152, v152, v7
    v_mul_f32 v156, v156, v7
    v_mul_f32 v145, v145, v7
    v_mul_f32 v149, v149, v7
    v_mul_f32 v153, v153, v7
    v_mul_f32 v157, v157, v7
    v_cvt_pk_bf16_f32 v146, v144, v145
    v_cvt_pk_bf16_f32 v150, v148, v149
    v_cvt_pk_bf16_f32 v154, v152, v153
    v_cvt_pk_bf16_f32 v158, v156, v157
    v_lshlrev_b32 v144, 16, v146
    v_lshlrev_b32 v148, 16, v150
    v_lshlrev_b32 v152, 16, v154
    v_lshlrev_b32 v156, 16, v158
    v_and_b32 v145, 0xffff0000, v146
    v_and_b32 v149, 0xffff0000, v150
    v_and_b32 v153, 0xffff0000, v154
    v_and_b32 v157, 0xffff0000, v158
    v_lshlrev_b32 v146, 16, v28
    v_lshlrev_b32 v150, 16, v29
    v_lshlrev_b32 v154, 16, v30
    v_lshlrev_b32 v158, 16, v31
    v_and_b32 v147, 0xffff0000, v28
    v_and_b32 v151, 0xffff0000, v29
    v_and_b32 v155, 0xffff0000, v30
    v_and_b32 v159, 0xffff0000, v31
    v_pk_add_f32 v[144:145], v[144:145], v[146:147]
    v_pk_add_f32 v[148:149], v[148:149], v[150:151]
    v_pk_add_f32 v[152:153], v[152:153], v[154:155]
    v_pk_add_f32 v[156:157], v[156:157], v[158:159]
    v_cvt_pk_bf16_f32 v28, v144, v145
    v_cvt_pk_bf16_f32 v29, v148, v149
    v_cvt_pk_bf16_f32 v30, v152, v153
    v_cvt_pk_bf16_f32 v31, v156, v157
    v_add_u32 v160, 24, v242
    v_cmp_eq_u32 vcc, v160, v8
    v_cmp_eq_u32 s[60:61], v160, v10
    v_mov_b32 v161, 0x40000000
    s_or_b64 vcc, vcc, s[60:61]
    v_cndmask_b32 v15, v229, v161, vcc
    s_mov_b32 s32, 0
    buffer_store_dwordx4 v[16:19], v12, s[28:31], s32 offen nt
    s_mov_b32 s32, 16384
    buffer_store_dwordx4 v[20:23], v13, s[28:31], s32 offen nt
    s_mov_b32 s32, 32768
    buffer_store_dwordx4 v[24:27], v14, s[28:31], s32 offen nt
    s_mov_b32 s32, 49152
    buffer_store_dwordx4 v[28:31], v15, s[28:31], s32 offen nt
    s_branch kc_fin
kc_red:
    v_lshlrev_b32 v144, 16, v16
    v_lshlrev_b32 v148, 16, v17
    v_lshlrev_b32 v152, 16, v18
    v_lshlrev_b32_e64 v156, 16, v19
    v_and_b32 v145, 0xffff0000, v16
    v_and_b32 v149, 0xffff0000, v17
    v_and_b32 v153, 0xffff0000, v18
    v_and_b32 v157, 0xffff0000, v19
    v_sub_f32 v144, v144, v0
    v_sub_f32 v148, v148, v0
    v_sub_f32 v152, v152, v0
    v_sub_f32 v156, v156, v0
    v_sub_f32 v145, v145, v0
    v_sub_f32 v149, v149, v0
    v_sub_f32 v153, v153, v0
    v_sub_f32 v157, v157, v0
    v_cvt_pk_bf16_f32 v145, v144, v145
    v_cvt_pk_bf16_f32 v149, v148, v149
    v_cvt_pk_bf16_f32 v153, v152, v153
    v_cvt_pk_bf16_f32 v157, v156, v157
    v_lshlrev_b32 v144, 16, v145
    v_lshlrev_b32 v148, 16, v149
    v_lshlrev_b32 v152, 16, v153
    v_lshlrev_b32 v156, 16, v157
    v_and_b32 v145, 0xffff0000, v145
    v_and_b32 v149, 0xffff0000, v149
    v_and_b32 v153, 0xffff0000, v153
    v_and_b32 v157, 0xffff0000, v157
    v_mul_f32 v144, v144, v4
    v_mul_f32 v148, v148, v4
    v_mul_f32 v152, v152, v4
    v_mul_f32 v156, v156, v4
    v_mul_f32 v145, v145, v4
    v_mul_f32 v149, v149, v4
    v_mul_f32 v153, v153, v4
    v_mul_f32 v157, v157, v4
    v_cvt_pk_bf16_f32 v146, v144, v145
    v_cvt_pk_bf16_f32 v150, v148, v149
    v_cvt_pk_bf16_f32 v154, v152, v153
    v_cvt_pk_bf16_f32 v158, v156, v157
    v_lshlrev_b32 v144, 16, v146
    v_lshlrev_b32 v148, 16, v150
    v_lshlrev_b32 v152, 16, v154
    v_lshlrev_b32 v156, 16, v158
    v_and_b32 v145, 0xffff0000, v146
    v_and_b32 v149, 0xffff0000, v150
    v_and_b32 v153, 0xffff0000, v154
    v_and_b32 v157, 0xffff0000, v158
    v_lshlrev_b32 v146, 16, v16
    v_lshlrev_b32 v150, 16, v17
    v_lshlrev_b32 v154, 16, v18
    v_lshlrev_b32 v158, 16, v19
    v_and_b32 v147, 0xffff0000, v16
    v_and_b32 v151, 0xffff0000, v17
    v_and_b32 v155, 0xffff0000, v18
    v_and_b32 v159, 0xffff0000, v19
    v_pk_add_f32 v[144:145], v[144:145], v[146:147]
    v_pk_add_f32 v[148:149], v[148:149], v[150:151]
    v_pk_add_f32 v[152:153], v[152:153], v[154:155]
    v_pk_add_f32 v[156:157], v[156:157], v[158:159]
    v_cvt_pk_bf16_f32 v16, v144, v145
    v_cvt_pk_bf16_f32 v17, v148, v149
    v_cvt_pk_bf16_f32 v18, v152, v153
    v_cvt_pk_bf16_f32 v19, v156, v157
    v_add_u32 v160, 0, v242
    v_cmp_eq_u32 vcc, v160, v8
    v_cmp_eq_u32 s[60:61], v160, v10
    v_mov_b32 v161, 0x40000000
    s_or_b64 vcc, vcc, s[60:61]
    v_cndmask_b32 v12, v229, v161, vcc
    v_lshlrev_b32 v144, 16, v20
    v_lshlrev_b32 v148, 16, v21
    v_lshlrev_b32 v152, 16, v22
    v_lshlrev_b32_e64 v156, 16, v23
    v_and_b32 v145, 0xffff0000, v20
    v_and_b32 v149, 0xffff0000, v21
    v_and_b32 v153, 0xffff0000, v22
    v_and_b32 v157, 0xffff0000, v23
    v_sub_f32 v144, v144, v1
    v_sub_f32 v148, v148, v1
    v_sub_f32 v152, v152, v1
    v_sub_f32 v156, v156, v1
    v_sub_f32 v145, v145, v1
    v_sub_f32 v149, v149, v1
    v_sub_f32 v153, v153, v1
    v_sub_f32 v157, v157, v1
    v_cvt_pk_bf16_f32 v145, v144, v145
    v_cvt_pk_bf16_f32 v149, v148, v149
    v_cvt_pk_bf16_f32 v153, v152, v153
    v_cvt_pk_bf16_f32 v157, v156, v157
    v_lshlrev_b32 v144, 16, v145
    v_lshlrev_b32 v148, 16, v149
    v_lshlrev_b32 v152, 16, v153
    v_lshlrev_b32 v156, 16, v157
    v_and_b32 v145, 0xffff0000, v145
    v_and_b32 v149, 0xffff0000, v149
    v_and_b32 v153, 0xffff0000, v153
    v_and_b32 v157, 0xffff0000, v157
    v_mul_f32 v144, v144, v5
    v_mul_f32 v148, v148, v5
    v_mul_f32 v152, v152, v5
    v_mul_f32 v156, v156, v5
    v_mul_f32 v145, v145, v5
    v_mul_f32 v149, v149, v5
    v_mul_f32 v153, v153, v5
    v_mul_f32 v157, v157, v5
    v_cvt_pk_bf16_f32 v146, v144, v145
    v_cvt_pk_bf16_f32 v150, v148, v149
    v_cvt_pk_bf16_f32 v154, v152, v153
    v_cvt_pk_bf16_f32 v158, v156, v157
    v_lshlrev_b32 v144, 16, v146
    v_lshlrev_b32 v148, 16, v150
    v_lshlrev_b32 v152, 16, v154
    v_lshlrev_b32 v156, 16, v158
    v_and_b32 v145, 0xffff0000, v146
    v_and_b32 v149, 0xffff0000, v150
    v_and_b32 v153, 0xffff0000, v154
    v_and_b32 v157, 0xffff0000, v158
    v_lshlrev_b32 v146, 16, v20
    v_lshlrev_b32 v150, 16, v21
    v_lshlrev_b32 v154, 16, v22
    v_lshlrev_b32 v158, 16, v23
    v_and_b32 v147, 0xffff0000, v20
    v_and_b32 v151, 0xffff0000, v21
    v_and_b32 v155, 0xffff0000, v22
    v_and_b32 v159, 0xffff0000, v23
    v_pk_add_f32 v[144:145], v[144:145], v[146:147]
    v_pk_add_f32 v[148:149], v[148:149], v[150:151]
    v_pk_add_f32 v[152:153], v[152:153], v[154:155]
    v_pk_add_f32 v[156:157], v[156:157], v[158:159]
    v_cvt_pk_bf16_f32 v20, v144, v145
    v_cvt_pk_bf16_f32 v21, v148, v149
    v_cvt_pk_bf16_f32 v22, v152, v153
    v_cvt_pk_bf16_f32 v23, v156, v157
    v_add_u32 v160, 8, v242
    v_cmp_eq_u32 vcc, v160, v8
    v_cmp_eq_u32 s[60:61], v160, v10
    v_mov_b32 v161, 0x40000000
    s_or_b64 vcc, vcc, s[60:61]
    v_cndmask_b32 v13, v229, v161, vcc
    v_lshlrev_b32 v144, 16, v24
    v_lshlrev_b32 v148, 16, v25
    v_lshlrev_b32 v152, 16, v26
    v_lshlrev_b32_e64 v156, 16, v27
    v_and_b32 v145, 0xffff0000, v24
    v_and_b32 v149, 0xffff0000, v25
    v_and_b32 v153, 0xffff0000, v26
    v_and_b32 v157, 0xffff0000, v27
    v_sub_f32 v144, v144, v2
    v_sub_f32 v148, v148, v2
    v_sub_f32 v152, v152, v2
    v_sub_f32 v156, v156, v2
    v_sub_f32 v145, v145, v2
    v_sub_f32 v149, v149, v2
    v_sub_f32 v153, v153, v2
    v_sub_f32 v157, v157, v2
    v_cvt_pk_bf16_f32 v145, v144, v145
    v_cvt_pk_bf16_f32 v149, v148, v149
    v_cvt_pk_bf16_f32 v153, v152, v153
    v_cvt_pk_bf16_f32 v157, v156, v157
    v_lshlrev_b32 v144, 16, v145
    v_lshlrev_b32 v148, 16, v149
    v_lshlrev_b32 v152, 16, v153
    v_lshlrev_b32 v156, 16, v157
    v_and_b32 v145, 0xffff0000, v145
    v_and_b32 v149, 0xffff0000, v149
    v_and_b32 v153, 0xffff0000, v153
    v_and_b32 v157, 0xffff0000, v157
    v_mul_f32 v144, v144, v6
    v_mul_f32 v148, v148, v6
    v_mul_f32 v152, v152, v6
    v_mul_f32 v156, v156, v6
    v_mul_f32 v145, v145, v6
    v_mul_f32 v149, v149, v6
    v_mul_f32 v153, v153, v6
    v_mul_f32 v157, v157, v6
    v_cvt_pk_bf16_f32 v146, v144, v145
    v_cvt_pk_bf16_f32 v150, v148, v149
    v_cvt_pk_bf16_f32 v154, v152, v153
    v_cvt_pk_bf16_f32 v158, v156, v157
    v_lshlrev_b32 v144, 16, v146
    v_lshlrev_b32 v148, 16, v150
    v_lshlrev_b32 v152, 16, v154
    v_lshlrev_b32 v156, 16, v158
    v_and_b32 v145, 0xffff0000, v146
    v_and_b32 v149, 0xffff0000, v150
    v_and_b32 v153, 0xffff0000, v154
    v_and_b32 v157, 0xffff0000, v158
    v_lshlrev_b32 v146, 16, v24
    v_lshlrev_b32 v150, 16, v25
    v_lshlrev_b32 v154, 16, v26
    v_lshlrev_b32 v158, 16, v27
    v_and_b32 v147, 0xffff0000, v24
    v_and_b32 v151, 0xffff0000, v25
    v_and_b32 v155, 0xffff0000, v26
    v_and_b32 v159, 0xffff0000, v27
    v_pk_add_f32 v[144:145], v[144:145], v[146:147]
    v_pk_add_f32 v[148:149], v[148:149], v[150:151]
    v_pk_add_f32 v[152:153], v[152:153], v[154:155]
    v_pk_add_f32 v[156:157], v[156:157], v[158:159]
    v_cvt_pk_bf16_f32 v24, v144, v145
    v_cvt_pk_bf16_f32 v25, v148, v149
    v_cvt_pk_bf16_f32 v26, v152, v153
    v_cvt_pk_bf16_f32 v27, v156, v157
    v_add_u32 v160, 16, v242
    v_cmp_eq_u32 vcc, v160, v8
    v_cmp_eq_u32 s[60:61], v160, v10
    v_mov_b32 v161, 0x40000000
    s_or_b64 vcc, vcc, s[60:61]
    v_cndmask_b32 v14, v229, v161, vcc
    v_lshlrev_b32 v144, 16, v28
    v_lshlrev_b32 v148, 16, v29
    v_lshlrev_b32 v152, 16, v30
    v_lshlrev_b32_e64 v156, 16, v31
    v_and_b32 v145, 0xffff0000, v28
    v_and_b32 v149, 0xffff0000, v29
    v_and_b32 v153, 0xffff0000, v30
    v_and_b32 v157, 0xffff0000, v31
    v_sub_f32 v144, v144, v3
    v_sub_f32 v148, v148, v3
    v_sub_f32 v152, v152, v3
    v_sub_f32 v156, v156, v3
    v_sub_f32 v145, v145, v3
    v_sub_f32 v149, v149, v3
    v_sub_f32 v153, v153, v3
    v_sub_f32 v157, v157, v3
    v_cvt_pk_bf16_f32 v145, v144, v145
    v_cvt_pk_bf16_f32 v149, v148, v149
    v_cvt_pk_bf16_f32 v153, v152, v153
    v_cvt_pk_bf16_f32 v157, v156, v157
    v_lshlrev_b32 v144, 16, v145
    v_lshlrev_b32 v148, 16, v149
    v_lshlrev_b32 v152, 16, v153
    v_lshlrev_b32 v156, 16, v157
    v_and_b32 v145, 0xffff0000, v145
    v_and_b32 v149, 0xffff0000, v149
    v_and_b32 v153, 0xffff0000, v153
    v_and_b32 v157, 0xffff0000, v157
    v_mul_f32 v144, v144, v7
    v_mul_f32 v148, v148, v7
    v_mul_f32 v152, v152, v7
    v_mul_f32 v156, v156, v7
    v_mul_f32 v145, v145, v7
    v_mul_f32 v149, v149, v7
    v_mul_f32 v153, v153, v7
    v_mul_f32 v157, v157, v7
    v_cvt_pk_bf16_f32 v146, v144, v145
    v_cvt_pk_bf16_f32 v150, v148, v149
    v_cvt_pk_bf16_f32 v154, v152, v153
    v_cvt_pk_bf16_f32 v158, v156, v157
    v_lshlrev_b32 v144, 16, v146
    v_lshlrev_b32 v148, 16, v150
    v_lshlrev_b32 v152, 16, v154
    v_lshlrev_b32 v156, 16, v158
    v_and_b32 v145, 0xffff0000, v146
    v_and_b32 v149, 0xffff0000, v150
    v_and_b32 v153, 0xffff0000, v154
    v_and_b32 v157, 0xffff0000, v158
    v_lshlrev_b32 v146, 16, v28
    v_lshlrev_b32 v150, 16, v29
    v_lshlrev_b32 v154, 16, v30
    v_lshlrev_b32 v158, 16, v31
    v_and_b32 v147, 0xffff0000, v28
    v_and_b32 v151, 0xffff0000, v29
    v_and_b32 v155, 0xffff0000, v30
    v_and_b32 v159, 0xffff0000, v31
    v_pk_add_f32 v[144:145], v[144:145], v[146:147]
    v_pk_add_f32 v[148:149], v[148:149], v[150:151]
    v_pk_add_f32 v[152:153], v[152:153], v[154:155]
    v_pk_add_f32 v[156:157], v[156:157], v[158:159]
    v_cvt_pk_bf16_f32 v28, v144, v145
    v_cvt_pk_bf16_f32 v29, v148, v149
    v_cvt_pk_bf16_f32 v30, v152, v153
    v_cvt_pk_bf16_f32 v31, v156, v157
    v_add_u32 v160, 24, v242
    v_cmp_eq_u32 vcc, v160, v8
    v_cmp_eq_u32 s[60:61], v160, v10
    v_mov_b32 v161, 0x40000000
    s_or_b64 vcc, vcc, s[60:61]
    v_cndmask_b32 v15, v229, v161, vcc
    s_mov_b32 s32, 0
    buffer_store_dwordx4 v[16:19], v12, s[28:31], s32 offen nt
    s_mov_b32 s32, 16384
    buffer_store_dwordx4 v[20:23], v13, s[28:31], s32 offen nt
    s_mov_b32 s32, 32768
    buffer_store_dwordx4 v[24:27], v14, s[28:31], s32 offen nt
    s_mov_b32 s32, 49152
    buffer_store_dwordx4 v[28:31], v15, s[28:31], s32 offen nt
    s_sub_u32 s54, s2, 224
    v_lshrrev_b32 v234, 4, v230
    v_lshlrev_b32 v234, 13, v234
    v_and_b32_e64 v235, 15, v237
    v_lshl_add_u32 v217, v235, 4, v234
    s_lshl_b32 s35, s54, 8
    s_add_u32 s35, s35, 0x3900000
    v_bfe_u32 v234, v237, 4, 1
    v_lshrrev_b32 v236, 5, v237
    v_lshl_add_u32 v234, v234, 1, v236
    v_lshl_add_u32 v234, v235, 2, v234
    s_lshl_b32 s32, s54, 6
    v_add_u32 v234, s32, v234
    v_lshlrev_b32_e64 v218, 1, v234
    v_add_u32 v234, 98304, v218
    ds_read_u16 v100, v234
    ds_read_u16 v101, v234 offset:4096
    s_cmp_lt_u32 s54, 16
    s_cselect_b64 vcc, -1, 0
    v_cndmask_b32 v102, v10, v8, vcc
    s_cselect_b32 s32, 0, 4
    s_add_u32 s32, s32, 106496
    v_mov_b32_e64 v234, s32
    ds_read_b32 v103, v234
    s_waitcnt lgkmcnt(0)
    v_cvt_pk_bf16_f32 v103, v103, v103
    v_lshlrev_b32 v103, 16, v103
    v_mul_f32 v103, 0xbfb8aa3b, v103
    v_exp_f32 v103, v103
    s_nop 0
    v_add_f32 v103, 1.0, v103
    v_rcp_f32_e64 v103, v103
    s_nop 0
    v_cvt_pk_bf16_f32 v103, v103, v103
    v_lshlrev_b32_e64 v103, 16, v103
    v_and_b32 v218, 2047, v218
    v_lshl_add_u32 v218, v102, 11, v218
    v_lshlrev_b32_e64 v220, 2, v230
    v_add_u32 v220, 106752, v220
    v_lshlrev_b32_e64 v221, 2, v237
    v_add_u32 v221, 106752, v221
    s_cmp_lg_u32 s3, 0
    s_cbranch_scc1 kc_b22
    s_lshl_b32 s32, s52, 7
    s_add_u32 s32, s32, 0x38a0c00
    s_mov_b32 s34, 0x100000
    s_branch kc_b21
kc_b20:
    s_sleep 2
kc_b21:
    buffer_load_dword v235, off, s[8:11], s32 sc1
    s_waitcnt vmcnt(0)
    v_cmp_ne_u32 vcc, 8, v235
    s_sub_u32 s34, s34, 1
    s_cbranch_scc1 kc_b22
    s_cbranch_vccnz kc_b20
kc_b22:
    s_barrier
    s_add_u32 s32, s35, 0
    buffer_load_dwordx4 v[32:35], v217, s[8:11], s32 offen sc1
    s_add_u32 s32, s35, 131072
    buffer_load_dwordx4 v[36:39], v217, s[8:11], s32 offen sc1
    s_add_u32 s32, s35, 262144
    buffer_load_dwordx4 v[40:43], v217, s[8:11], s32 offen sc1
    s_add_u32 s32, s35, 393216
    buffer_load_dwordx4 v[44:47], v217, s[8:11], s32 offen sc1
    s_add_u32 s32, s35, 524288
    buffer_load_dwordx4 v[48:51], v217, s[8:11], s32 offen sc1
    s_add_u32 s32, s35, 655360
    buffer_load_dwordx4 v[52:55], v217, s[8:11], s32 offen sc1
    s_add_u32 s32, s35, 786432
    buffer_load_dwordx4 v[56:59], v217, s[8:11], s32 offen sc1
    s_add_u32 s32, s35, 917504
    buffer_load_dwordx4 v[60:63], v217, s[8:11], s32 offen sc1
    s_add_u32 s32, s35, 1048576
    buffer_load_dwordx4 v[64:67], v217, s[8:11], s32 offen sc1
    s_add_u32 s32, s35, 1179648
    buffer_load_dwordx4 v[68:71], v217, s[8:11], s32 offen sc1
    s_add_u32 s32, s35, 1310720
    buffer_load_dwordx4 v[72:75], v217, s[8:11], s32 offen sc1
    s_add_u32 s32, s35, 1441792
    buffer_load_dwordx4 v[76:79], v217, s[8:11], s32 offen sc1
    s_add_u32 s32, s35, 1572864
    buffer_load_dwordx4 v[80:83], v217, s[8:11], s32 offen sc1
    s_add_u32 s32, s35, 1703936
    buffer_load_dwordx4 v[84:87], v217, s[8:11], s32 offen sc1
    s_waitcnt vmcnt(12)
    v_pk_add_f32 v[32:33], v[32:33], v[36:37]
    v_pk_add_f32 v[34:35], v[34:35], v[38:39]
    s_waitcnt vmcnt(11)
    v_pk_add_f32 v[32:33], v[32:33], v[40:41]
    v_pk_add_f32 v[34:35], v[34:35], v[42:43]
    s_waitcnt vmcnt(10)
    v_pk_add_f32 v[32:33], v[32:33], v[44:45]
    v_pk_add_f32 v[34:35], v[34:35], v[46:47]
    s_waitcnt vmcnt(9)
    v_pk_add_f32 v[32:33], v[32:33], v[48:49]
    v_pk_add_f32 v[34:35], v[34:35], v[50:51]
    s_waitcnt vmcnt(8)
    v_pk_add_f32 v[32:33], v[32:33], v[52:53]
    v_pk_add_f32 v[34:35], v[34:35], v[54:55]
    s_waitcnt vmcnt(7)
    v_pk_add_f32 v[32:33], v[32:33], v[56:57]
    v_pk_add_f32 v[34:35], v[34:35], v[58:59]
    s_waitcnt vmcnt(6)
    v_pk_add_f32 v[32:33], v[32:33], v[60:61]
    v_pk_add_f32 v[34:35], v[34:35], v[62:63]
    s_waitcnt vmcnt(5)
    v_pk_add_f32 v[32:33], v[32:33], v[64:65]
    v_pk_add_f32 v[34:35], v[34:35], v[66:67]
    s_waitcnt vmcnt(4)
    v_pk_add_f32 v[32:33], v[32:33], v[68:69]
    v_pk_add_f32 v[34:35], v[34:35], v[70:71]
    s_waitcnt vmcnt(3)
    v_pk_add_f32 v[32:33], v[32:33], v[72:73]
    v_pk_add_f32 v[34:35], v[34:35], v[74:75]
    s_waitcnt vmcnt(2)
    v_pk_add_f32 v[32:33], v[32:33], v[76:77]
    v_pk_add_f32 v[34:35], v[34:35], v[78:79]
    s_waitcnt vmcnt(1)
    v_pk_add_f32 v[32:33], v[32:33], v[80:81]
    v_pk_add_f32 v[34:35], v[34:35], v[82:83]
    s_waitcnt vmcnt(0)
    v_pk_add_f32 v[32:33], v[32:33], v[84:85]
    v_pk_add_f32 v[34:35], v[34:35], v[86:87]
    s_nop 1
    v_permlane32_swap_b32 v32, v33
    v_permlane32_swap_b32 v34, v35
    s_nop 0
    v_add_f32 v32, v32, v33
    v_add_f32 v34, v34, v35
    s_nop 1
    v_permlane16_swap_b32 v32, v34
    s_nop 0
    v_add_f32_e64 v32, v32, v34
    ds_write_b32 v220, v32
    s_waitcnt lgkmcnt(0)
    s_barrier
    s_cmp_lg_u32 s3, 0
    s_cbranch_scc1 kc_fin
    ds_read_b32 v32, v221
    ds_read_b32 v33, v221 offset:256
    ds_read_b32 v34, v221 offset:512
    ds_read_b32 v35, v221 offset:768
    v_lshlrev_b32 v100, 16, v100
    v_lshlrev_b32 v101, 16, v101
    s_waitcnt lgkmcnt(0)
    v_add_f32 v32, v32, v33
    v_add_f32 v34, v34, v35
    v_add_f32 v32, v32, v34
    v_cvt_pk_bf16_f32 v32, v32, v32
    v_lshlrev_b32 v32, 16, v32
    v_mul_f32 v32, v32, v103
    v_cvt_pk_bf16_f32 v32, v32, v32
    v_lshlrev_b32 v32, 16, v32
    v_add_f32 v32, v32, v100
    v_cvt_pk_bf16_f32 v32, v32, v32
    v_lshlrev_b32 v32, 16, v32
    v_add_f32 v32, v32, v101
    v_cvt_pk_bf16_f32 v32, v32, v32
    buffer_store_short v32, v218, s[28:31], 0 offen
kc_fin:
    s_endpgm
kc_r3:
    s_mov_b32 s34, 0x100000
kc_r3l:
    s_sleep 4
    buffer_load_dwordx4 v[176:179], v228, s[8:11], s7 offen offset:0 sc1
    buffer_load_dwordx4 v[180:183], v228, s[8:11], s7 offen offset:1024 sc1
    buffer_load_dwordx4 v[184:187], v228, s[8:11], s7 offen offset:2048 sc1
    buffer_load_dwordx4 v[188:191], v228, s[8:11], s7 offen offset:3072 sc1
    s_waitcnt vmcnt(0)
    v_max3_u32 v235, v176, v177, v178
    v_max3_u32 v235, v235, v179, v180
    v_max3_u32 v235, v235, v181, v182
    v_max3_u32 v235, v235, v183, v184
    v_max3_u32 v235, v235, v185, v186
    v_max3_u32 v235, v235, v187, v188
    v_max3_u32 v235, v235, v189, v190
    v_max_u32 v235, v235, v191
    v_cmp_eq_u32 vcc, -1, v235
    s_sub_u32 s34, s34, 1
    s_cbranch_scc1 kc_r3o
    s_cbranch_vccnz kc_r3l
    s_branch kc_r3o
kc_r1:
    s_mov_b32 s34, 0x100000
kc_r1l:
    s_sleep 4
    buffer_load_dwordx4 v[96:99], v228, s[8:11], s37 offen offset:0 sc1
    buffer_load_dwordx4 v[100:103], v228, s[8:11], s37 offen offset:1024 sc1
    buffer_load_dwordx4 v[104:107], v228, s[8:11], s37 offen offset:2048 sc1
    buffer_load_dwordx4 v[108:111], v228, s[8:11], s37 offen offset:3072 sc1
    s_waitcnt vmcnt(0)
    v_max3_u32 v235, v96, v97, v98
    v_max3_u32 v235, v235, v99, v100
    v_max3_u32 v235, v235, v101, v102
    v_max3_u32 v235, v235, v103, v104
    v_max3_u32 v235, v235, v105, v106
    v_max3_u32 v235, v235, v107, v108
    v_max3_u32 v235, v235, v109, v110
    v_max_u32 v235, v235, v111
    v_cmp_eq_u32 vcc, -1, v235
    s_sub_u32 s34, s34, 1
    s_cbranch_scc1 kc_r1o
    s_cbranch_vccnz kc_r1l
    s_branch kc_r1o
kc_r2:
    s_mov_b32 s34, 0x100000
kc_r2l:
    s_sleep 4
    buffer_load_dwordx4 v[160:163], v228, s[8:11], s38 offen offset:0 sc1
    buffer_load_dwordx4 v[164:167], v228, s[8:11], s38 offen offset:1024 sc1
    buffer_load_dwordx4 v[168:171], v228, s[8:11], s38 offen offset:2048 sc1
    buffer_load_dwordx4 v[172:175], v228, s[8:11], s38 offen offset:3072 sc1
    s_waitcnt vmcnt(0)
    v_max3_u32 v235, v160, v161, v162
    v_max3_u32 v235, v235, v163, v164
    v_max3_u32 v235, v235, v165, v166
    v_max3_u32 v235, v235, v167, v168
    v_max3_u32 v235, v235, v169, v170
    v_max3_u32 v235, v235, v171, v172
    v_max3_u32 v235, v235, v173, v174
    v_max_u32 v235, v235, v175
    v_cmp_eq_u32 vcc, -1, v235
    s_sub_u32 s34, s34, 1
    s_cbranch_scc1 kc_r2o
    s_cbranch_vccnz kc_r2l
    s_branch kc_r2o
kc_g:
    s_mov_b32 s34, 0x100000
    s_branch kc_gs1
kc_gs0:
    s_sleep 2
kc_gs1:
    buffer_load_dword v235, off, s[8:11], s45 sc1
    s_waitcnt vmcnt(0)
    v_cmp_ne_u32_e64 vcc, 8, v235
    s_sub_u32 s34, s34, 1
    s_cbranch_scc1 kc_gs2
    s_cbranch_vccnz kc_gs0
kc_gs2:
    s_branch kc_gr
kc_end:
ka_done:
    s_endpgm
kf_fix1:
    s_cmp_eq_u32 s33, 0
    s_cselect_b32 s24, 0, 0x74000000
    s_cselect_b32 s36, 0, 0x1000
    s_mov_b32 s33, 1
    v_subrev_f32 v230, s24, v243
    v_add_f32 v231, 0, v230
    v_min_f32 v64, v224, v231
    v_add_f32 v232, 0xf1800000, v230
    v_min_f32_e64 v65, v224, v232
    v_add_f32 v231, 0xf2000000, v230
    v_min_f32_e64 v66, v224, v231
    v_add_f32 v232, 0xf2400000, v230
    v_min_f32_e64 v67, v224, v232
    v_add_f32 v231, 0xf3000000, v230
    v_min_f32_e64 v68, v224, v231
    v_add_f32 v232, 0xf3100000, v230
    v_min_f32_e64 v69, v224, v232
    v_add_f32 v231, 0xf3200000, v230
    v_min_f32_e64 v70, v224, v231
    v_add_f32 v232, 0xf3300000, v230
    v_min_f32_e64 v71, v224, v232
    v_add_f32 v231, 0x73800000, v230
    v_min_f32_e64 v72, v225, v231
    v_add_f32 v232, 0x73700000, v230
    v_min_f32_e64 v73, v225, v232
    v_add_f32 v231, 0x73600000, v230
    v_min_f32_e64 v74, v225, v231
    v_add_f32 v232, 0x73500000, v230
    v_min_f32_e64 v75, v225, v232
    v_add_f32 v231, 0x73000000, v230
    v_min_f32_e64 v76, v225, v231
    v_add_f32 v232, 0x72e00000, v230
    v_min_f32_e64 v77, v225, v232
    v_add_f32 v231, 0x72c00000, v230
    v_min_f32_e64 v78, v225, v231
    v_add_f32 v232, 0x72a00000, v230
    v_min_f32 v79, v225, v232
    s_nop 1
    s_branch kf_fixr2
kf_fix3:
    s_cmp_eq_u32 s33, 0
    s_cselect_b32 s24, 0, 0x74000000
    s_cselect_b32 s36, 0, 0x1000
    s_mov_b32 s33, 1
    v_subrev_f32 v230, s24, v243
    v_add_f32 v231, 0, v230
    v_min_f32 v64, v224, v231
    v_add_f32 v232, 0xf1800000, v230
    v_min_f32_e64 v65, v224, v232
    v_add_f32 v231, 0xf2000000, v230
    v_min_f32_e64 v66, v224, v231
    v_add_f32 v232, 0xf2400000, v230
    v_min_f32_e64 v67, v224, v232
    v_add_f32 v231, 0xf3000000, v230
    v_min_f32_e64 v68, v224, v231
    v_add_f32 v232, 0xf3100000, v230
    v_min_f32_e64 v69, v224, v232
    v_add_f32 v231, 0xf3200000, v230
    v_min_f32_e64 v70, v224, v231
    v_add_f32 v232, 0xf3300000, v230
    v_min_f32_e64 v71, v224, v232
    v_add_f32 v231, 0x73800000, v230
    v_min_f32_e64 v72, v225, v231
    v_add_f32 v232, 0x73700000, v230
    v_min_f32_e64 v73, v225, v232
    v_add_f32 v231, 0x73600000, v230
    v_min_f32_e64 v74, v225, v231
    v_add_f32 v232, 0x73500000, v230
    v_min_f32_e64 v75, v225, v232
    v_add_f32 v231, 0x73000000, v230
    v_min_f32_e64 v76, v225, v231
    v_add_f32 v232, 0x72e00000, v230
    v_min_f32_e64 v77, v225, v232
    v_add_f32 v231, 0x72c00000, v230
    v_min_f32_e64 v78, v225, v231
    v_add_f32 v232, 0x72a00000, v230
    v_min_f32 v79, v225, v232
    s_nop 1
    s_branch kf_fixr4
hot_end:
ka_redo:
    s_waitcnt vmcnt(0) lgkmcnt(0)
    s_barrier
    s_mov_b32 s34, s37
    s_sub_u32 s42, s32, 17664
    s_mov_b32 s36, s6
    s_mov_b32 s33, 0
    s_mov_b32 m0, s34
    s_add_u32 s41, s42, 17664
    buffer_load_dwordx4 v242, s[16:19], s41 offen offset:0 sc1 lds
    buffer_load_dwordx4 v242, s[16:19], s41 offen offset:1024 sc1 lds
    buffer_load_dwordx4 v242, s[16:19], s41 offen offset:2048 sc1 lds
    buffer_load_dwordx4 v242, s[16:19], s41 offen offset:3072 sc1 lds
    s_add_u32 s34, s34, 32768
    s_cmp_ge_u32 s34, 163840
    s_cselect_b32 s34, s37, s34
    s_add_u32 s42, s42, 34048
    s_mov_b32 m0, s34
    s_add_u32 s41, s42, 17664
    buffer_load_dwordx4 v242, s[16:19], s41 offen offset:0 sc1 lds
    buffer_load_dwordx4 v242, s[16:19], s41 offen offset:1024 sc1 lds
    buffer_load_dwordx4 v242, s[16:19], s41 offen offset:2048 sc1 lds
    buffer_load_dwordx4 v242, s[16:19], s41 offen offset:3072 sc1 lds
    s_add_u32 m0, s34, 16384
    s_add_u32 s34, s34, 32768
    s_cmp_ge_u32 s34, 163840
    s_cselect_b32 s34, s37, s34
    buffer_load_dwordx4 v242, s[16:19], s42 offen offset:0 sc1 lds
    buffer_load_dwordx4 v242, s[16:19], s42 offen offset:1024 sc1 lds
    buffer_load_dwordx4 v242, s[16:19], s42 offen offset:2048 sc1 lds
    buffer_load_dwordx4 v242, s[16:19], s42 offen offset:3072 sc1 lds
    s_add_u32 s42, s42, 34048
    s_mov_b32 m0, s34
    s_add_u32 s41, s42, 17664
    buffer_load_dwordx4 v242, s[16:19], s41 offen offset:0 sc1 lds
    buffer_load_dwordx4 v242, s[16:19], s41 offen offset:1024 sc1 lds
    buffer_load_dwordx4 v242, s[16:19], s41 offen offset:2048 sc1 lds
    buffer_load_dwordx4 v242, s[16:19], s41 offen offset:3072 sc1 lds
    s_add_u32 m0, s34, 16384
    s_add_u32 s34, s34, 32768
    s_cmp_ge_u32 s34, 163840
    s_cselect_b32 s34, s37, s34
    buffer_load_dwordx4 v242, s[16:19], s42 offen offset:0 sc1 lds
    buffer_load_dwordx4 v242, s[16:19], s42 offen offset:1024 sc1 lds
    buffer_load_dwordx4 v242, s[16:19], s42 offen offset:2048 sc1 lds
    buffer_load_dwordx4 v242, s[16:19], s42 offen offset:3072 sc1 lds
    s_add_u32 s42, s42, 34048
    s_mov_b32 m0, s34
    s_add_u32 s41, s42, 17664
    buffer_load_dwordx4 v242, s[16:19], s41 offen offset:0 sc1 lds
    buffer_load_dwordx4 v242, s[16:19], s41 offen offset:1024 sc1 lds
    buffer_load_dwordx4 v242, s[16:19], s41 offen offset:2048 sc1 lds
    buffer_load_dwordx4 v242, s[16:19], s41 offen offset:3072 sc1 lds
    s_add_u32 m0, s34, 16384
    s_add_u32 s34, s34, 32768
    s_cmp_ge_u32 s34, 163840
    s_cselect_b32 s34, s37, s34
    buffer_load_dwordx4 v242, s[16:19], s42 offen offset:0 sc1 lds
    buffer_load_dwordx4 v242, s[16:19], s42 offen offset:1024 sc1 lds
    buffer_load_dwordx4 v242, s[16:19], s42 offen offset:2048 sc1 lds
    buffer_load_dwordx4 v242, s[16:19], s42 offen offset:3072 sc1 lds
    s_add_u32 s42, s42, 34048
    v_accvgpr_write_b32 a0, 0
    v_accvgpr_write_b32 a1, 0
    v_accvgpr_write_b32 a2, 0
    v_accvgpr_write_b32 a3, 0
    v_accvgpr_write_b32 a4, 0
    v_accvgpr_write_b32 a5, 0
    v_accvgpr_write_b32 a6, 0
    v_accvgpr_write_b32 a7, 0
    v_accvgpr_write_b32 a8, 0
    v_accvgpr_write_b32 a9, 0
    v_accvgpr_write_b32 a10, 0
    v_accvgpr_write_b32 a11, 0
    v_accvgpr_write_b32 a12, 0
    v_accvgpr_write_b32 a13, 0
    v_accvgpr_write_b32 a14, 0
    v_accvgpr_write_b32 a15, 0
    v_accvgpr_write_b32 a16, 0
    v_accvgpr_write_b32 a17, 0
    v_accvgpr_write_b32 a18, 0
    v_accvgpr_write_b32 a19, 0
    v_accvgpr_write_b32 a20, 0
    v_accvgpr_write_b32 a21, 0
    v_accvgpr_write_b32 a22, 0
    v_accvgpr_write_b32 a23, 0
    v_accvgpr_write_b32 a24, 0
    v_accvgpr_write_b32 a25, 0
    v_accvgpr_write_b32 a26, 0
    v_accvgpr_write_b32 a27, 0
    v_accvgpr_write_b32 a28, 0
    v_accvgpr_write_b32 a29, 0
    v_accvgpr_write_b32 a30, 0
    v_accvgpr_write_b32 a31, 0
    v_accvgpr_write_b32 a32, 0
    v_accvgpr_write_b32 a33, 0
    v_accvgpr_write_b32 a34, 0
    v_accvgpr_write_b32 a35, 0
    v_accvgpr_write_b32 a36, 0
    v_accvgpr_write_b32 a37, 0
    v_accvgpr_write_b32 a38, 0
    v_accvgpr_write_b32 a39, 0
    v_accvgpr_write_b32 a40, 0
    v_accvgpr_write_b32 a41, 0
    v_accvgpr_write_b32 a42, 0
    v_accvgpr_write_b32 a43, 0
    v_accvgpr_write_b32 a44, 0
    v_accvgpr_write_b32 a45, 0
    v_accvgpr_write_b32 a46, 0
    v_accvgpr_write_b32 a47, 0
    v_accvgpr_write_b32 a48, 0
    v_accvgpr_write_b32 a49, 0
    v_accvgpr_write_b32 a50, 0
    v_accvgpr_write_b32 a51, 0
    v_accvgpr_write_b32 a52, 0
    v_accvgpr_write_b32 a53, 0
    v_accvgpr_write_b32 a54, 0
    v_accvgpr_write_b32 a55, 0
    v_accvgpr_write_b32 a56, 0
    v_accvgpr_write_b32 a57, 0
    v_accvgpr_write_b32 a58, 0
    v_accvgpr_write_b32 a59, 0
    v_accvgpr_write_b32 a60, 0
    v_accvgpr_write_b32 a61, 0
    v_accvgpr_write_b32 a62, 0
    v_accvgpr_write_b32 a63, 0
    v_accvgpr_write_b32 a64, 0
    v_accvgpr_write_b32 a65, 0
    v_accvgpr_write_b32 a66, 0
    v_accvgpr_write_b32 a67, 0
    v_accvgpr_write_b32 a68, 0
    v_accvgpr_write_b32 a69, 0
    v_accvgpr_write_b32 a70, 0
    v_accvgpr_write_b32 a71, 0
    v_accvgpr_write_b32 a72, 0
    v_accvgpr_write_b32 a73, 0
    v_accvgpr_write_b32 a74, 0
    v_accvgpr_write_b32 a75, 0
    v_accvgpr_write_b32 a76, 0
    v_accvgpr_write_b32 a77, 0
    v_accvgpr_write_b32 a78, 0
    v_accvgpr_write_b32 a79, 0
    v_accvgpr_write_b32 a80, 0
    v_accvgpr_write_b32 a81, 0
    v_accvgpr_write_b32 a82, 0
    v_accvgpr_write_b32 a83, 0
    v_accvgpr_write_b32 a84, 0
    v_accvgpr_write_b32 a85, 0
    v_accvgpr_write_b32 a86, 0
    v_accvgpr_write_b32 a87, 0
    v_accvgpr_write_b32 a88, 0
    v_accvgpr_write_b32 a89, 0
    v_accvgpr_write_b32 a90, 0
    v_accvgpr_write_b32 a91, 0
    v_accvgpr_write_b32 a92, 0
    v_accvgpr_write_b32 a93, 0
    v_accvgpr_write_b32 a94, 0
    v_accvgpr_write_b32 a95, 0
    v_accvgpr_write_b32 a96, 0
    v_accvgpr_write_b32 a97, 0
    v_accvgpr_write_b32 a98, 0
    v_accvgpr_write_b32 a99, 0
    v_accvgpr_write_b32 a100, 0
    v_accvgpr_write_b32 a101, 0
    v_accvgpr_write_b32 a102, 0
    v_accvgpr_write_b32 a103, 0
    v_accvgpr_write_b32 a104, 0
    v_accvgpr_write_b32 a105, 0
    v_accvgpr_write_b32 a106, 0
    v_accvgpr_write_b32 a107, 0
    v_accvgpr_write_b32 a108, 0
    v_accvgpr_write_b32 a109, 0
    v_accvgpr_write_b32 a110, 0
    v_accvgpr_write_b32 a111, 0
    v_accvgpr_write_b32 a112, 0
    v_accvgpr_write_b32 a113, 0
    v_accvgpr_write_b32 a114, 0
    v_accvgpr_write_b32 a115, 0
    v_accvgpr_write_b32 a116, 0
    v_accvgpr_write_b32 a117, 0
    v_accvgpr_write_b32 a118, 0
    v_accvgpr_write_b32 a119, 0
    v_accvgpr_write_b32 a120, 0
    v_accvgpr_write_b32 a121, 0
    v_accvgpr_write_b32 a122, 0
    v_accvgpr_write_b32 a123, 0
    v_accvgpr_write_b32 a124, 0
    v_accvgpr_write_b32 a125, 0
    v_accvgpr_write_b32 a126, 0
    v_accvgpr_write_b32 a127, 0
    v_mov_b32 v64, 0
    v_mov_b32 v65, 0
    v_mov_b32 v66, 0
    v_mov_b32 v67, 0
    v_mov_b32 v68, 0
    v_mov_b32 v69, 0
    v_mov_b32 v70, 0
    v_mov_b32 v71, 0
    v_mov_b32 v72, 0
    v_mov_b32 v73, 0
    v_mov_b32 v74, 0
    v_mov_b32 v75, 0
    v_mov_b32 v76, 0
    v_mov_b32 v77, 0
    v_mov_b32 v78, 0
    v_mov_b32 v79, 0
    v_mov_b32 v80, 0
    v_mov_b32 v81, 0
    v_mov_b32 v82, 0
    v_mov_b32 v83, 0
    v_mov_b32 v84, 0
    v_mov_b32 v85, 0
    v_mov_b32 v86, 0
    v_mov_b32 v87, 0
    v_mov_b32 v88, 0
    v_mov_b32 v89, 0
    v_mov_b32 v90, 0
    v_mov_b32 v91, 0
    v_mov_b32 v92, 0
    v_mov_b32 v93, 0
    v_mov_b32 v94, 0
    v_mov_b32 v95, 0
    v_mov_b32 v224, 0
    v_mov_b32 v225, 0
    v_mov_b32 v226, 0
    v_mov_b32 v227, 0
    v_mov_b32_e64 v241, v240
    s_waitcnt vmcnt(16)
    s_barrier
    ds_read_b128 a[192:195], v241 offset:0
    ds_read_b128 a[196:199], v241 offset:2048
    ds_read_b128 a[200:203], v241 offset:4096
    ds_read_b128 a[204:207], v241 offset:6144
    ds_read_b128 a[208:211], v241 offset:1024
    ds_read_b128 a[212:215], v241 offset:3072
    ds_read_b128 a[216:219], v241 offset:5120
    ds_read_b128 a[220:223], v241 offset:7168
    s_waitcnt lgkmcnt(0)
    ds_read_b128 a[224:227], v241 offset:8192
    ds_read_b128 a[228:231], v241 offset:10240
    ds_read_b128 a[232:235], v241 offset:12288
    ds_read_b128 a[236:239], v241 offset:14336
    ds_read_b128 a[240:243], v241 offset:9216
    ds_read_b128 a[244:247], v241 offset:11264
    ds_read_b128 a[248:251], v241 offset:13312
    ds_read_b128 a[252:255], v241 offset:15360
    s_sub_u32 s36, s36, 1
    s_cbranch_scc1 kf_fix17
kf_fixr18:
    s_waitcnt lgkmcnt(0)
    v_mfma_f32_16x16x32_bf16 v[0:3], a[192:195], a[128:131], v[64:67]
    v_mfma_f32_16x16x32_bf16 v[8:11], a[192:195], a[144:147], v[72:75]
    v_mfma_f32_16x16x32_bf16 v[16:19], a[192:195], a[160:163], v[80:83]
    v_mfma_f32_16x16x32_bf16 v[24:27], a[192:195], a[176:179], v[88:91]
    v_mfma_f32_16x16x32_bf16 v[4:7], a[208:211], a[128:131], v[68:71]
    v_mfma_f32_16x16x32_bf16 v[12:15], a[208:211], a[144:147], v[76:79]
    v_mfma_f32_16x16x32_bf16 v[20:23], a[208:211], a[160:163], v[84:87]
    v_mfma_f32_16x16x32_bf16 v[28:31], a[208:211], a[176:179], v[92:95]
    v_mfma_f32_16x16x32_bf16 v[0:3], a[196:199], a[132:135], v[0:3]
    v_mfma_f32_16x16x32_bf16 v[8:11], a[196:199], a[148:151], v[8:11]
    v_mfma_f32_16x16x32_bf16 v[16:19], a[196:199], a[164:167], v[16:19]
    v_mfma_f32_16x16x32_bf16 v[24:27], a[196:199], a[180:183], v[24:27]
    v_mfma_f32_16x16x32_bf16 v[4:7], a[212:215], a[132:135], v[4:7]
    v_mfma_f32_16x16x32_bf16 v[12:15], a[212:215], a[148:151], v[12:15]
    v_mfma_f32_16x16x32_bf16 v[20:23], a[212:215], a[164:167], v[20:23]
    v_mfma_f32_16x16x32_bf16 v[28:31], a[212:215], a[180:183], v[28:31]
    v_mfma_f32_16x16x32_bf16 v[0:3], a[200:203], a[136:139], v[0:3]
    v_mfma_f32_16x16x32_bf16 v[8:11], a[200:203], a[152:155], v[8:11]
    v_mfma_f32_16x16x32_bf16 v[16:19], a[200:203], a[168:171], v[16:19]
    v_mfma_f32_16x16x32_bf16 v[24:27], a[200:203], a[184:187], v[24:27]
    v_mfma_f32_16x16x32_bf16 v[4:7], a[216:219], a[136:139], v[4:7]
    v_mfma_f32_16x16x32_bf16 v[12:15], a[216:219], a[152:155], v[12:15]
    v_mfma_f32_16x16x32_bf16 v[20:23], a[216:219], a[168:171], v[20:23]
    v_mfma_f32_16x16x32_bf16 v[28:31], a[216:219], a[184:187], v[28:31]
    v_mfma_f32_16x16x32_bf16 v[0:3], a[204:207], a[140:143], v[0:3]
    v_mov_b32 v144, 0
    v_mov_b32 v145, 0
    v_mov_b32_e64 v146, 0
    v_mfma_f32_16x16x32_bf16 v[8:11], a[204:207], a[156:159], v[8:11]
    v_mov_b32 v147, 0
    v_mov_b32 v148, 0
    v_mfma_f32_16x16x32_bf16 v[16:19], a[204:207], a[172:175], v[16:19]
    v_mov_b32 v149, 0
    v_mov_b32 v150, 0
    v_mov_b32_e64 v151, 0
    v_mfma_f32_16x16x32_bf16 v[24:27], a[204:207], a[188:191], v[24:27]
    v_mov_b32 v152, 0
    v_mov_b32 v153, 0
    v_mfma_f32_16x16x32_bf16 v[4:7], a[220:223], a[140:143], v[4:7]
    v_mov_b32 v154, 0
    v_mov_b32 v155, 0
    v_mov_b32_e64 v156, 0
    v_mfma_f32_16x16x32_bf16 v[12:15], a[220:223], a[156:159], v[12:15]
    v_mov_b32 v157, 0
    v_mov_b32 v158, 0
    v_mfma_f32_16x16x32_bf16 v[20:23], a[220:223], a[172:175], v[20:23]
    v_mov_b32_e64 v159, 0
    v_mov_b32 v204, 0x3f803f80
    v_mov_b32 v205, 0x3f803f80
    v_mfma_f32_16x16x32_bf16 v[28:31], a[220:223], a[188:191], v[28:31]
    v_mov_b32 v206, 0x3f803f80
    v_mov_b32 v207, 0x3f803f80
    s_nop 4
    v_max3_f32 v128, v0, v1, v2
    v_max3_f32 v130, v8, v9, v10
    v_max3_f32 v132, v16, v17, v18
    v_max3_f32 v134, v24, v25, v26
    v_max3_f32 v128, v128, v3, v4
    v_max3_f32 v130, v130, v11, v12
    v_max3_f32 v132, v132, v19, v20
    v_max3_f32 v134, v134, v27, v28
    v_max3_f32 v128, v128, v5, v6
    v_max3_f32 v130, v130, v13, v14
    v_max3_f32 v132, v132, v21, v22
    v_max3_f32 v134, v134, v29, v30
    v_max_f32 v128, v128, v7
    v_max_f32 v130, v130, v15
    v_max_f32 v132, v132, v23
    v_max_f32 v134, v134, v31
    v_mov_b32 v129, v128
    v_mov_b32 v131, v130
    v_mov_b32 v133, v132
    v_mov_b32 v135, v134
    v_permlane16_swap_b32 v128, v129
    v_permlane16_swap_b32 v130, v131
    v_permlane16_swap_b32 v132, v133
    v_permlane16_swap_b32 v134, v135
    v_max_f32 v128, v128, v129
    v_max_f32 v130, v130, v131
    v_max_f32 v132, v132, v133
    v_max_f32 v134, v134, v135
    v_mov_b32 v129, v128
    v_mov_b32 v131, v130
    v_mov_b32 v133, v132
    v_mov_b32 v135, v134
    v_permlane32_swap_b32 v128, v129
    v_permlane32_swap_b32 v130, v131
    v_permlane32_swap_b32 v132, v133
    v_permlane32_swap_b32 v134, v135
    v_max_f32 v128, v128, v129
    v_max_f32 v130, v130, v131
    v_max_f32 v132, v132, v133
    v_max_f32_e64 v134, v134, v135
    v_add_f32 v128, 0x41800000, v128
    v_add_f32 v130, 0x41800000, v130
    v_add_f32 v132, 0x41800000, v132
    v_add_f32 v134, 0x41800000, v134
    v_sub_f32 v224, 0, v128
    v_sub_f32 v64, v64, v128
    v_sub_f32 v65, v65, v128
    v_sub_f32 v66, v66, v128
    v_sub_f32 v67, v67, v128
    v_sub_f32 v68, v68, v128
    v_sub_f32 v69, v69, v128
    v_sub_f32 v70, v70, v128
    v_sub_f32 v71, v71, v128
    v_sub_f32 v225, 0, v130
    v_sub_f32 v72, v72, v130
    v_sub_f32 v73, v73, v130
    v_sub_f32 v74, v74, v130
    v_sub_f32 v75, v75, v130
    v_sub_f32 v76, v76, v130
    v_sub_f32 v77, v77, v130
    v_sub_f32 v78, v78, v130
    v_sub_f32 v79, v79, v130
    v_sub_f32 v226, 0, v132
    v_sub_f32 v80, v80, v132
    v_sub_f32 v81, v81, v132
    v_sub_f32 v82, v82, v132
    v_sub_f32 v83, v83, v132
    v_sub_f32 v84, v84, v132
    v_sub_f32 v85, v85, v132
    v_sub_f32 v86, v86, v132
    v_sub_f32 v87, v87, v132
    v_sub_f32 v227, 0, v134
    v_sub_f32 v88, v88, v134
    v_sub_f32 v89, v89, v134
    v_sub_f32 v90, v90, v134
    v_sub_f32 v91, v91, v134
    v_sub_f32 v92, v92, v134
    v_sub_f32 v93, v93, v134
    v_sub_f32 v94, v94, v134
    v_sub_f32 v95, v95, v134
    v_sub_f32 v0, v0, v128
    v_sub_f32 v1, v1, v128
    v_sub_f32 v2, v2, v128
    v_sub_f32 v3, v3, v128
    v_sub_f32 v4, v4, v128
    v_sub_f32 v5, v5, v128
    v_sub_f32 v6, v6, v128
    v_sub_f32 v7, v7, v128
    v_sub_f32 v8, v8, v130
    v_sub_f32 v9, v9, v130
    v_sub_f32 v10, v10, v130
    v_sub_f32 v11, v11, v130
    v_sub_f32 v12, v12, v130
    v_sub_f32 v13, v13, v130
    v_sub_f32 v14, v14, v130
    v_sub_f32 v15, v15, v130
    v_sub_f32 v16, v16, v132
    v_sub_f32 v17, v17, v132
    v_sub_f32 v18, v18, v132
    v_sub_f32 v19, v19, v132
    v_sub_f32 v20, v20, v132
    v_sub_f32 v21, v21, v132
    v_sub_f32 v22, v22, v132
    v_sub_f32 v23, v23, v132
    v_sub_f32 v24, v24, v134
    v_sub_f32 v25, v25, v134
    v_sub_f32 v26, v26, v134
    v_sub_f32 v27, v27, v134
    v_sub_f32 v28, v28, v134
    v_sub_f32 v29, v29, v134
    v_sub_f32 v30, v30, v134
    v_sub_f32 v31, v31, v134
    s_mov_b32 s35, 32768
    v_add_u32_e64 v241, s35, v240
    s_sub_u32 s36, s36, 1
    s_cbranch_scc1 kf_fix19
kf_fixr20:
    v_mfma_f32_16x16x32_bf16 v[32:35], a[224:227], a[128:131], v[64:67]
    ds_read_b128 a[192:195], v241 offset:0
    v_exp_f32_e64 v128, v0
    v_mfma_f32_16x16x32_bf16 v[32:35], a[228:231], a[132:135], v[32:35]
    v_exp_f32_e64 v129, v1
    v_mfma_f32_16x16x32_bf16 v[32:35], a[232:235], a[136:139], v[32:35]
    v_exp_f32_e64 v130, v2
    v_cvt_pk_bf16_f32 v96, v128, v129
    v_mfma_f32_16x16x32_bf16 v[32:35], a[236:239], a[140:143], v[32:35]
    v_exp_f32_e64 v131, v3
    v_mfma_f32_16x16x32_bf16 v[40:43], a[224:227], a[144:147], v[72:75]
    ds_read_b128 a[196:199], v241 offset:2048
    v_exp_f32_e64 v132, v4
    v_mfma_f32_16x16x32_bf16 v[40:43], a[228:231], a[148:151], v[40:43]
    v_exp_f32_e64 v133, v5
    v_cvt_pk_bf16_f32 v97, v130, v131
    v_mfma_f32_16x16x32_bf16 v[40:43], a[232:235], a[152:155], v[40:43]
    v_exp_f32_e64 v134, v6
    v_cvt_pk_bf16_f32 v98, v132, v133
    v_mfma_f32_16x16x32_bf16 v[40:43], a[236:239], a[156:159], v[40:43]
    v_exp_f32_e64 v135, v7
    v_mfma_f32_16x16x32_bf16 v[48:51], a[224:227], a[160:163], v[80:83]
    ds_read_b128 a[200:203], v241 offset:4096
    v_exp_f32_e64 v136, v8
    v_mfma_f32_16x16x32_bf16 v[48:51], a[228:231], a[164:167], v[48:51]
    v_exp_f32_e64 v137, v9
    v_cvt_pk_bf16_f32 v99, v134, v135
    v_mfma_f32_16x16x32_bf16 v[48:51], a[232:235], a[168:171], v[48:51]
    v_exp_f32 v138, v10
    v_exp_f32 v139, v11
    v_mfma_f32_16x16x32_bf16 v[48:51], a[236:239], a[172:175], v[48:51]
    v_exp_f32_e64 v140, v12
    v_cvt_pk_bf16_f32 v100, v136, v137
    v_mfma_f32_16x16x32_bf16 v[56:59], a[224:227], a[176:179], v[88:91]
    ds_read_b128 a[204:207], v241 offset:6144
    v_exp_f32_e64 v141, v13
    v_mfma_f32_16x16x32_bf16 v[56:59], a[228:231], a[180:183], v[56:59]
    v_exp_f32_e64 v142, v14
    v_cvt_pk_bf16_f32 v101, v138, v139
    v_mfma_f32_16x16x32_bf16 v[56:59], a[232:235], a[184:187], v[56:59]
    v_exp_f32_e64 v143, v15
    v_cvt_pk_bf16_f32 v102, v140, v141
    v_mfma_f32_16x16x32_bf16 v[56:59], a[236:239], a[188:191], v[56:59]
    v_exp_f32_e64 v128, v16
    v_cvt_pk_bf16_f32 v103, v142, v143
    v_mfma_f32_16x16x32_bf16 v[36:39], a[240:243], a[128:131], v[68:71]
    ds_read_b128 a[208:211], v241 offset:1024
    v_exp_f32_e64 v129, v17
    v_mfma_f32_16x16x32_bf16 v[36:39], a[244:247], a[132:135], v[36:39]
    v_exp_f32_e64 v130, v18
    v_cvt_pk_bf16_f32 v104, v128, v129
    v_mfma_f32_16x16x32_bf16 v[36:39], a[248:251], a[136:139], v[36:39]
    v_exp_f32_e64 v131, v19
    v_mfma_f32_16x16x32_bf16 v[36:39], a[252:255], a[140:143], v[36:39]
    v_exp_f32_e64 v132, v20
    v_cvt_pk_bf16_f32 v105, v130, v131
    v_mfma_f32_16x16x32_bf16 v[44:47], a[240:243], a[144:147], v[76:79]
    ds_read_b128 a[212:215], v241 offset:3072
    v_exp_f32_e64 v133, v21
    v_mfma_f32_16x16x32_bf16 v[44:47], a[244:247], a[148:151], v[44:47]
    v_exp_f32 v134, v22
    v_exp_f32 v135, v23
    v_mfma_f32_16x16x32_bf16 v[44:47], a[248:251], a[152:155], v[44:47]
    v_exp_f32_e64 v136, v24
    v_cvt_pk_bf16_f32 v106, v132, v133
    v_mfma_f32_16x16x32_bf16 v[44:47], a[252:255], a[156:159], v[44:47]
    v_exp_f32_e64 v137, v25
    v_cvt_pk_bf16_f32 v107, v134, v135
    v_mfma_f32_16x16x32_bf16 v[52:55], a[240:243], a[160:163], v[84:87]
    ds_read_b128 a[216:219], v241 offset:5120
    v_exp_f32_e64 v138, v26
    v_mfma_f32_16x16x32_bf16 v[52:55], a[244:247], a[164:167], v[52:55]
    v_exp_f32_e64 v139, v27
    v_cvt_pk_bf16_f32 v108, v136, v137
    v_mfma_f32_16x16x32_bf16 v[52:55], a[248:251], a[168:171], v[52:55]
    v_exp_f32_e64 v140, v28
    v_cvt_pk_bf16_f32 v109, v138, v139
    v_mfma_f32_16x16x32_bf16 v[52:55], a[252:255], a[172:175], v[52:55]
    v_exp_f32_e64 v141, v29
    v_mfma_f32_16x16x32_bf16 v[60:63], a[240:243], a[176:179], v[92:95]
    ds_read_b128 a[220:223], v241 offset:7168
    v_exp_f32_e64 v142, v30
    v_mfma_f32_16x16x32_bf16 v[60:63], a[244:247], a[180:183], v[60:63]
    v_exp_f32_e64 v143, v31
    v_cvt_pk_bf16_f32 v110, v140, v141
    v_mfma_f32_16x16x32_bf16 v[60:63], a[248:251], a[184:187], v[60:63]
    v_cvt_pk_bf16_f32 v111, v142, v143
    v_mfma_f32_16x16x32_bf16 v[60:63], a[252:255], a[188:191], v[60:63]
    ds_read_b128 a[224:227], v241 offset:16384
    ds_read_b128 a[228:231], v241 offset:17408
    ds_read_b128 a[232:235], v241 offset:18432
    ds_read_b128 a[236:239], v241 offset:19456
    s_lshl1_add_u32 s26, s5, s31
    s_branch ka_p1r_e
.p2align 5
ka_p1r:
    s_sub_u32 s36, s36, 1
    s_cbranch_scc1 kf_fix23
kf_fixr24:
    s_waitcnt lgkmcnt(4)
    v_mfma_f32_16x16x32_bf16 v[0:3], a[192:195], a[128:131], v[64:67]
    ds_read_b128 a[240:243], v241 offset:20480
    s_mov_b32 m0, s34
    v_mfma_f32_16x16x32_bf16 v[0:3], a[196:199], a[132:135], v[0:3]
    v_exp_f32_e64 v128, v32
    v_mfma_f32_16x16x32_bf16 v[0:3], a[200:203], a[136:139], v[0:3]
    v_exp_f32_e64 v129, v33
    v_mfma_f32_16x16x32_bf16 v[0:3], a[204:207], a[140:143], v[0:3]
    v_exp_f32_e64 v130, v34
    v_mfma_f32_16x16x32_bf16 v[8:11], a[192:195], a[144:147], v[72:75]
    ds_read_b128 a[244:247], v241 offset:21504
    s_add_u32 s41, s42, 17664
    v_mfma_f32_16x16x32_bf16 v[8:11], a[196:199], a[148:151], v[8:11]
    v_exp_f32_e64 v131, v35
    v_mfma_f32_16x16x32_bf16 v[8:11], a[200:203], a[152:155], v[8:11]
    v_exp_f32_e64 v132, v36
    v_mfma_f32_16x16x32_bf16 v[8:11], a[204:207], a[156:159], v[8:11]
    v_exp_f32_e64 v133, v37
    v_mfma_f32_16x16x32_bf16 v[16:19], a[192:195], a[160:163], v[80:83]
    ds_read_b128 a[248:251], v241 offset:22528
    v_cvt_pk_bf16_f32 v112, v128, v129
    v_mfma_f32_16x16x32_bf16 v[16:19], a[196:199], a[164:167], v[16:19]
    v_exp_f32_e64 v134, v38
    v_mfma_f32_16x16x32_bf16 v[16:19], a[200:203], a[168:171], v[16:19]
    v_exp_f32_e64 v135, v39
    v_mfma_f32_16x16x32_bf16 v[16:19], a[204:207], a[172:175], v[16:19]
    buffer_load_dwordx4 v242, s[16:19], s41 offen offset:0 sc1 lds
    v_cvt_pk_bf16_f32 v113, v130, v131
    v_mfma_f32_16x16x32_bf16 v[24:27], a[192:195], a[176:179], v[88:91]
    ds_read_b128 a[252:255], v241 offset:23552
    v_cvt_pk_bf16_f32 v114, v132, v133
    v_mfma_f32_16x16x32_bf16 v[24:27], a[196:199], a[180:183], v[24:27]
    v_exp_f32_e64 v136, v40
    v_mfma_f32_16x16x32_bf16 v[24:27], a[200:203], a[184:187], v[24:27]
    v_exp_f32_e64 v137, v41
    v_mfma_f32_16x16x32_bf16 v[24:27], a[204:207], a[188:191], v[24:27]
    v_exp_f32_e64 v138, v42
    v_mfma_f32_16x16x32_bf16 v[4:7], a[208:211], a[128:131], v[68:71]
    ds_read_b128 a[192:195], v241 offset:8192
    v_or3_b32 v208, v112, v113, v114
    v_mfma_f32_16x16x32_bf16 v[4:7], a[212:215], a[132:135], v[4:7]
    v_exp_f32_e64 v139, v43
    v_mfma_f32_16x16x32_bf16 v[4:7], a[216:219], a[136:139], v[4:7]
    v_exp_f32_e64 v140, v44
    v_mfma_f32_16x16x32_bf16 v[4:7], a[220:223], a[140:143], v[4:7]
    v_exp_f32_e64 v141, v45
    v_mfma_f32_16x16x32_bf16 v[12:15], a[208:211], a[144:147], v[76:79]
    ds_read_b128 a[196:199], v241 offset:10240
    v_cvt_pk_bf16_f32 v115, v134, v135
    v_mfma_f32_16x16x32_bf16 v[12:15], a[212:215], a[148:151], v[12:15]
    v_cvt_pk_bf16_f32 v116, v136, v137
    v_or3_b32 v208, v208, v115, v116
    v_mfma_f32_16x16x32_bf16 v[12:15], a[216:219], a[152:155], v[12:15]
    buffer_load_dwordx4 v242, s[16:19], s41 offen offset:1024 sc1 lds
    v_cvt_pk_bf16_f32 v117, v138, v139
    v_mfma_f32_16x16x32_bf16 v[12:15], a[220:223], a[156:159], v[12:15]
    v_exp_f32_e64 v142, v46
    v_mfma_f32_16x16x32_bf16 v[20:23], a[208:211], a[160:163], v[84:87]
    ds_read_b128 a[200:203], v241 offset:12288
    v_cvt_pk_bf16_f32 v118, v140, v141
    v_mfma_f32_16x16x32_bf16 v[20:23], a[212:215], a[164:167], v[20:23]
    v_exp_f32_e64 v143, v47
    v_mfma_f32_16x16x32_bf16 v[20:23], a[216:219], a[168:171], v[20:23]
    v_exp_f32_e64 v128, v48
    v_mfma_f32_16x16x32_bf16 v[20:23], a[220:223], a[172:175], v[20:23]
    v_exp_f32_e64 v129, v49
    v_mfma_f32_16x16x32_bf16 v[28:31], a[208:211], a[176:179], v[92:95]
    ds_read_b128 a[204:207], v241 offset:14336
    v_or3_b32 v208, v208, v117, v118
    v_mfma_f32_16x16x32_bf16 v[28:31], a[212:215], a[180:183], v[28:31]
    v_exp_f32_e64 v130, v50
    v_mfma_f32_16x16x32_bf16 v[28:31], a[216:219], a[184:187], v[28:31]
    v_exp_f32_e64 v131, v51
    v_mfma_f32_16x16x32_bf16 v[28:31], a[220:223], a[188:191], v[28:31]
    v_cvt_pk_bf16_f32 v119, v142, v143
    s_waitcnt lgkmcnt(4)
    v_mfma_f32_16x16x32_bf16 a[0:3], a[224:227], v[96:99], a[0:3]
    ds_read_b128 a[208:211], v241 offset:9216
    v_cvt_pk_bf16_f32 v120, v128, v129
    v_mfma_f32_16x16x32_bf16 a[32:35], a[224:227], v[100:103], a[32:35]
    buffer_load_dwordx4 v242, s[16:19], s41 offen offset:2048 sc1 lds
    v_or3_b32 v208, v208, v119, v120
    v_mfma_f32_16x16x32_bf16 a[64:67], a[224:227], v[104:107], a[64:67]
    v_exp_f32 v132, v52
    v_mfma_f32_16x16x32_bf16 a[96:99], a[224:227], v[108:111], a[96:99]
    v_exp_f32_e64 v133, v53
    v_mfma_f32_16x16x32_bf16 a[4:7], a[228:231], v[96:99], a[4:7]
    ds_read_b128 a[212:215], v241 offset:11264
    v_cvt_pk_bf16_f32 v121, v130, v131
    v_mfma_f32_16x16x32_bf16 a[36:39], a[228:231], v[100:103], a[36:39]
    v_exp_f32_e64 v134, v54
    v_mfma_f32_16x16x32_bf16 a[68:71], a[228:231], v[104:107], a[68:71]
    v_exp_f32_e64 v135, v55
    v_mfma_f32_16x16x32_bf16 a[100:103], a[228:231], v[108:111], a[100:103]
    v_exp_f32_e64 v136, v56
    v_mfma_f32_16x16x32_bf16 a[8:11], a[232:235], v[96:99], a[8:11]
    ds_read_b128 a[216:219], v241 offset:13312
    v_cvt_pk_bf16_f32 v122, v132, v133
    v_mfma_f32_16x16x32_bf16 a[40:43], a[232:235], v[100:103], a[40:43]
    v_exp_f32_e64 v137, v57
    v_mfma_f32_16x16x32_bf16 a[72:75], a[232:235], v[104:107], a[72:75]
    v_exp_f32_e64 v138, v58
    v_mfma_f32_16x16x32_bf16 a[104:107], a[232:235], v[108:111], a[104:107]
    buffer_load_dwordx4 v242, s[16:19], s41 offen offset:3072 sc1 lds
    v_or3_b32 v208, v208, v121, v122
    v_mfma_f32_16x16x32_bf16 a[12:15], a[236:239], v[96:99], a[12:15]
    ds_read_b128 a[220:223], v241 offset:15360
    v_cvt_pk_bf16_f32 v123, v134, v135
    v_mfma_f32_16x16x32_bf16 a[44:47], a[236:239], v[100:103], a[44:47]
    v_exp_f32_e64 v139, v59
    v_mfma_f32_16x16x32_bf16 a[76:79], a[236:239], v[104:107], a[76:79]
    v_exp_f32_e64 v140, v60
    v_mfma_f32_16x16x32_bf16 a[108:111], a[236:239], v[108:111], a[108:111]
    v_exp_f32_e64 v141, v61
    v_mfma_f32_16x16x32_bf16 a[16:19], a[240:243], v[96:99], a[16:19]
    ds_read_b128 a[224:227], v241 offset:24576
    v_cvt_pk_bf16_f32 v124, v136, v137
    v_mfma_f32_16x16x32_bf16 a[48:51], a[240:243], v[100:103], a[48:51]
    v_exp_f32_e64 v142, v62
    v_mfma_f32_16x16x32_bf16 a[80:83], a[240:243], v[104:107], a[80:83]
    v_exp_f32_e64 v143, v63
    v_mfma_f32_16x16x32_bf16 a[112:115], a[240:243], v[108:111], a[112:115]
    v_or3_b32 v208, v208, v123, v124
    v_cvt_pk_bf16_f32 v125, v138, v139
    v_mfma_f32_16x16x32_bf16 a[20:23], a[244:247], v[96:99], a[20:23]
    ds_read_b128 a[228:231], v241 offset:25600
    v_cvt_pk_bf16_f32 v126, v140, v141
    v_mfma_f32_16x16x32_bf16 a[52:55], a[244:247], v[100:103], a[52:55]
    v_or3_b32 v208, v208, v125, v126
    v_cvt_pk_bf16_f32 v127, v142, v143
    v_mfma_f32_16x16x32_bf16 a[84:87], a[244:247], v[104:107], a[84:87]
    s_add_u32 s35, s35, 32768
    v_or_b32_e64 v208, v208, v127
    v_mfma_f32_16x16x32_bf16 a[116:119], a[244:247], v[108:111], a[116:119]
    s_cmp_ge_u32 s35, 163840
    s_cselect_b32 s35, 0, s35
    v_mfma_f32_16x16x32_bf16 a[24:27], a[248:251], v[96:99], a[24:27]
    ds_read_b128 a[232:235], v241 offset:26624
    v_and_b32 v208, s38, v208
    v_mfma_f32_16x16x32_bf16 a[56:59], a[248:251], v[100:103], a[56:59]
    v_cmp_ne_u32_e64 vcc, 0, v208
    v_mfma_f32_16x16x32_bf16 a[88:91], a[248:251], v[104:107], a[88:91]
    v_mfma_f32_16x16x32_bf16 a[120:123], a[248:251], v[108:111], a[120:123]
    v_mfma_f32_16x16x32_bf16 a[28:31], a[252:255], v[96:99], a[28:31]
    ds_read_b128 a[236:239], v241 offset:27648
    v_mfma_f32_16x16x32_bf16 a[60:63], a[252:255], v[100:103], a[60:63]
    v_mfma_f32_16x16x32_bf16 a[92:95], a[252:255], v[104:107], a[92:95]
    v_mfma_f32_16x16x32_bf16 a[124:127], a[252:255], v[108:111], a[124:127]
    v_mfma_f32_16x16x32_bf16 v[144:147], v[204:207], v[96:99], v[144:147]
    v_mfma_f32_16x16x32_bf16 v[148:151], v[204:207], v[100:103], v[148:151]
    v_mfma_f32_16x16x32_bf16 v[152:155], v[204:207], v[104:107], v[152:155]
    v_mfma_f32_16x16x32_bf16 v[156:159], v[204:207], v[108:111], v[156:159]
    s_cbranch_vccnz kf_rare22
kf_rr21:
    s_sub_u32 s36, s36, 1
    s_cbranch_scc1 kf_fix27
kf_fixr28:
    s_waitcnt lgkmcnt(4)
    v_mfma_f32_16x16x32_bf16 v[32:35], a[192:195], a[128:131], v[64:67]
    ds_read_b128 a[240:243], v241 offset:28672
    s_add_u32 m0, s34, 16384
    v_mfma_f32_16x16x32_bf16 v[32:35], a[196:199], a[132:135], v[32:35]
    v_exp_f32_e64 v128, v0
    v_mfma_f32_16x16x32_bf16 v[32:35], a[200:203], a[136:139], v[32:35]
    v_exp_f32_e64 v129, v1
    v_mfma_f32_16x16x32_bf16 v[32:35], a[204:207], a[140:143], v[32:35]
    v_exp_f32_e64 v130, v2
    v_mfma_f32_16x16x32_bf16 v[40:43], a[192:195], a[144:147], v[72:75]
    ds_read_b128 a[244:247], v241 offset:29696
    s_add_u32 s34, s34, 32768
    v_mfma_f32_16x16x32_bf16 v[40:43], a[196:199], a[148:151], v[40:43]
    s_cmp_ge_u32 s34, 163840
    s_cselect_b32 s34, s37, s34
    v_mfma_f32_16x16x32_bf16 v[40:43], a[200:203], a[152:155], v[40:43]
    v_exp_f32 v131, v3
    v_mfma_f32_16x16x32_bf16 v[40:43], a[204:207], a[156:159], v[40:43]
    v_exp_f32_e64 v132, v4
    v_mfma_f32_16x16x32_bf16 v[48:51], a[192:195], a[160:163], v[80:83]
    ds_read_b128 a[248:251], v241 offset:30720
    v_cvt_pk_bf16_f32 v96, v128, v129
    v_mfma_f32_16x16x32_bf16 v[48:51], a[196:199], a[164:167], v[48:51]
    v_exp_f32_e64 v133, v5
    v_mfma_f32_16x16x32_bf16 v[48:51], a[200:203], a[168:171], v[48:51]
    v_exp_f32_e64 v134, v6
    v_mfma_f32_16x16x32_bf16 v[48:51], a[204:207], a[172:175], v[48:51]
    v_exp_f32_e64 v135, v7
    v_mfma_f32_16x16x32_bf16 v[56:59], a[192:195], a[176:179], v[88:91]
    ds_read_b128 a[252:255], v241 offset:31744
    v_cvt_pk_bf16_f32 v97, v130, v131
    v_mfma_f32_16x16x32_bf16 v[56:59], a[196:199], a[180:183], v[56:59]
    v_exp_f32_e64 v136, v8
    v_mfma_f32_16x16x32_bf16 v[56:59], a[200:203], a[184:187], v[56:59]
    buffer_load_dwordx4 v242, s[16:19], s42 offen offset:0 sc1 lds
    v_cvt_pk_bf16_f32 v98, v132, v133
    v_mfma_f32_16x16x32_bf16 v[56:59], a[204:207], a[188:191], v[56:59]
    v_exp_f32_e64 v137, v9
    v_mfma_f32_16x16x32_bf16 v[36:39], a[208:211], a[128:131], v[68:71]
    s_waitcnt vmcnt(13)
    s_barrier
    v_add_u32_e64 v241, s35, v240
    ds_read_b128 a[192:195], v241 offset:0
    v_mfma_f32_16x16x32_bf16 v[36:39], a[212:215], a[132:135], v[36:39]
    v_exp_f32_e64 v138, v10
    v_mfma_f32_16x16x32_bf16 v[36:39], a[216:219], a[136:139], v[36:39]
    v_exp_f32_e64 v139, v11
    v_mfma_f32_16x16x32_bf16 v[36:39], a[220:223], a[140:143], v[36:39]
    v_or3_b32 v208, v96, v97, v98
    v_cvt_pk_bf16_f32 v99, v134, v135
    v_mfma_f32_16x16x32_bf16 v[44:47], a[208:211], a[144:147], v[76:79]
    ds_read_b128 a[196:199], v241 offset:2048
    v_cvt_pk_bf16_f32 v100, v136, v137
    v_mfma_f32_16x16x32_bf16 v[44:47], a[212:215], a[148:151], v[44:47]
    v_exp_f32_e64 v140, v12
    v_mfma_f32_16x16x32_bf16 v[44:47], a[216:219], a[152:155], v[44:47]
    v_exp_f32_e64 v141, v13
    v_mfma_f32_16x16x32_bf16 v[44:47], a[220:223], a[156:159], v[44:47]
    v_exp_f32_e64 v142, v14
    v_mfma_f32_16x16x32_bf16 v[52:55], a[208:211], a[160:163], v[84:87]
    ds_read_b128 a[200:203], v241 offset:4096
    v_or3_b32 v208, v208, v99, v100
    v_mfma_f32_16x16x32_bf16 v[52:55], a[212:215], a[164:167], v[52:55]
    v_exp_f32_e64 v143, v15
    v_mfma_f32_16x16x32_bf16 v[52:55], a[216:219], a[168:171], v[52:55]
    buffer_load_dwordx4 v242, s[16:19], s42 offen offset:1024 sc1 lds
    v_cvt_pk_bf16_f32 v101, v138, v139
    v_mfma_f32_16x16x32_bf16 v[52:55], a[220:223], a[172:175], v[52:55]
    v_exp_f32_e64 v128, v16
    v_mfma_f32_16x16x32_bf16 v[60:63], a[208:211], a[176:179], v[92:95]
    ds_read_b128 a[204:207], v241 offset:6144
    v_cvt_pk_bf16_f32 v102, v140, v141
    v_mfma_f32_16x16x32_bf16 v[60:63], a[212:215], a[180:183], v[60:63]
    v_exp_f32_e64 v129, v17
    v_mfma_f32_16x16x32_bf16 v[60:63], a[216:219], a[184:187], v[60:63]
    v_exp_f32_e64 v130, v18
    v_mfma_f32_16x16x32_bf16 v[60:63], a[220:223], a[188:191], v[60:63]
    v_or3_b32 v208, v208, v101, v102
    s_waitcnt lgkmcnt(4)
    v_mfma_f32_16x16x32_bf16 a[0:3], a[224:227], v[112:115], a[0:3]
    ds_read_b128 a[208:211], v241 offset:1024
    v_cvt_pk_bf16_f32 v103, v142, v143
    v_mfma_f32_16x16x32_bf16 a[32:35], a[224:227], v[116:119], a[32:35]
    v_exp_f32 v131, v19
    v_mfma_f32_16x16x32_bf16 a[64:67], a[224:227], v[120:123], a[64:67]
    v_exp_f32_e64 v132, v20
    v_mfma_f32_16x16x32_bf16 a[96:99], a[224:227], v[124:127], a[96:99]
    v_exp_f32_e64 v133, v21
    v_mfma_f32_16x16x32_bf16 a[4:7], a[228:231], v[112:115], a[4:7]
    ds_read_b128 a[212:215], v241 offset:3072
    v_cvt_pk_bf16_f32 v104, v128, v129
    v_mfma_f32_16x16x32_bf16 a[36:39], a[228:231], v[116:119], a[36:39]
    v_exp_f32_e64 v134, v22
    v_mfma_f32_16x16x32_bf16 a[68:71], a[228:231], v[120:123], a[68:71]
    v_exp_f32_e64 v135, v23
    v_mfma_f32_16x16x32_bf16 a[100:103], a[228:231], v[124:127], a[100:103]
    buffer_load_dwordx4 v242, s[16:19], s42 offen offset:2048 sc1 lds
    v_or3_b32 v208, v208, v103, v104
    v_mfma_f32_16x16x32_bf16 a[8:11], a[232:235], v[112:115], a[8:11]
    ds_read_b128 a[216:219], v241 offset:5120
    v_cvt_pk_bf16_f32 v105, v130, v131
    v_mfma_f32_16x16x32_bf16 a[40:43], a[232:235], v[116:119], a[40:43]
    v_exp_f32_e64 v136, v24
    v_mfma_f32_16x16x32_bf16 a[72:75], a[232:235], v[120:123], a[72:75]
    v_exp_f32_e64 v137, v25
    v_mfma_f32_16x16x32_bf16 a[104:107], a[232:235], v[124:127], a[104:107]
    v_cvt_pk_bf16_f32 v106, v132, v133
    v_or3_b32 v208, v208, v105, v106
    v_mfma_f32_16x16x32_bf16 a[12:15], a[236:239], v[112:115], a[12:15]
    ds_read_b128 a[220:223], v241 offset:7168
    v_cvt_pk_bf16_f32 v107, v134, v135
    v_mfma_f32_16x16x32_bf16 a[44:47], a[236:239], v[116:119], a[44:47]
    v_exp_f32_e64 v138, v26
    v_mfma_f32_16x16x32_bf16 a[76:79], a[236:239], v[120:123], a[76:79]
    v_exp_f32_e64 v139, v27
    v_mfma_f32_16x16x32_bf16 a[108:111], a[236:239], v[124:127], a[108:111]
    v_exp_f32_e64 v140, v28
    v_mfma_f32_16x16x32_bf16 a[16:19], a[240:243], v[112:115], a[16:19]
    ds_read_b128 a[224:227], v241 offset:16384
    v_cvt_pk_bf16_f32 v108, v136, v137
    v_mfma_f32_16x16x32_bf16 a[48:51], a[240:243], v[116:119], a[48:51]
    v_exp_f32_e64 v141, v29
    v_mfma_f32_16x16x32_bf16 a[80:83], a[240:243], v[120:123], a[80:83]
    v_exp_f32_e64 v142, v30
    v_mfma_f32_16x16x32_bf16 a[112:115], a[240:243], v[124:127], a[112:115]
    v_exp_f32_e64 v143, v31
    v_mfma_f32_16x16x32_bf16 a[20:23], a[244:247], v[112:115], a[20:23]
    ds_read_b128 a[228:231], v241 offset:17408
    buffer_load_dwordx4 v242, s[16:19], s42 offen offset:3072 sc1 lds
    v_mfma_f32_16x16x32_bf16 a[52:55], a[244:247], v[116:119], a[52:55]
    s_add_u32 s42, s42, 34048
    v_or3_b32 v208, v208, v107, v108
    v_mfma_f32_16x16x32_bf16 a[84:87], a[244:247], v[120:123], a[84:87]
    v_cvt_pk_bf16_f32 v109, v138, v139
    v_cvt_pk_bf16_f32 v110, v140, v141
    v_mfma_f32_16x16x32_bf16 a[116:119], a[244:247], v[124:127], a[116:119]
    v_or3_b32 v208, v208, v109, v110
    v_cvt_pk_bf16_f32 v111, v142, v143
    v_mfma_f32_16x16x32_bf16 a[24:27], a[248:251], v[112:115], a[24:27]
    ds_read_b128 a[232:235], v241 offset:18432
    v_or_b32_e64 v208, v208, v111
    v_mfma_f32_16x16x32_bf16 a[56:59], a[248:251], v[116:119], a[56:59]
    v_and_b32 v208, s38, v208
    v_cmp_ne_u32 vcc, 0, v208
    v_mfma_f32_16x16x32_bf16 a[88:91], a[248:251], v[120:123], a[88:91]
    v_mfma_f32_16x16x32_bf16 a[120:123], a[248:251], v[124:127], a[120:123]
    v_mfma_f32_16x16x32_bf16 a[28:31], a[252:255], v[112:115], a[28:31]
    ds_read_b128 a[236:239], v241 offset:19456
    v_mfma_f32_16x16x32_bf16 a[60:63], a[252:255], v[116:119], a[60:63]
    v_mfma_f32_16x16x32_bf16 a[92:95], a[252:255], v[120:123], a[92:95]
    v_mfma_f32_16x16x32_bf16 a[124:127], a[252:255], v[124:127], a[124:127]
    v_mfma_f32_16x16x32_bf16 v[144:147], v[204:207], v[112:115], v[144:147]
    v_mfma_f32_16x16x32_bf16 v[148:151], v[204:207], v[116:119], v[148:151]
    v_mfma_f32_16x16x32_bf16 v[152:155], v[204:207], v[120:123], v[152:155]
    v_mfma_f32_16x16x32_bf16 v[156:159], v[204:207], v[124:127], v[156:159]
    s_cbranch_vccnz kf_rare26
kf_rr25:
ka_p1r_e:
    s_sub_u32 s26, s26, 1
    s_cbranch_scc0 ka_p1r
    s_branch ka_p1r_x
kf_fix23:
    s_mov_b32 s24, 0
    s_branch kf_fix23c
kf_fix27:
    s_mov_b32 s24, 1
kf_fix23c:
    s_cmp_eq_u32 s33, 0
    s_cbranch_scc0 kf_fix23f
    s_mov_b32 s36, 0
    s_mov_b32 s33, 1
    v_add_f32 v64, v224, v200
    v_add_f32 v65, v224, v201
    v_add_f32 v66, v224, v202
    v_add_f32 v67, v224, v203
    v_add_f32 v68, v224, v209
    v_add_f32 v69, v224, v210
    v_add_f32 v70, v224, v211
    v_add_f32 v71, v224, v212
    v_add_f32 v72, v225, v213
    v_add_f32 v73, v225, v214
    v_add_f32 v74, v225, v215
    v_add_f32 v75, v225, v216
    v_add_f32 v76, v225, v217
    v_add_f32 v77, v225, v218
    v_add_f32 v78, v225, v219
    v_add_f32 v79, v225, v220
    s_cmp_eq_u32 s24, 0
    s_cbranch_scc1 kf_fixr24
    s_branch kf_fixr28
kf_fix23f:
    s_mov_b32 s36, 0x1000
    v_mov_b32 v64, 0xf1800000
    v_mov_b32 v65, v64
    v_mov_b32 v66, v64
    v_mov_b32 v67, v64
    v_mov_b32 v68, v64
    v_mov_b32 v69, v64
    v_mov_b32 v70, v64
    v_mov_b32 v71, v64
    v_mov_b32 v72, v64
    v_mov_b32 v73, v64
    v_mov_b32 v74, v64
    v_mov_b32 v75, v64
    v_mov_b32 v76, v64
    v_mov_b32 v77, v64
    v_mov_b32 v78, v64
    v_mov_b32 v79, v64
    s_cmp_eq_u32 s24, 0
    s_cbranch_scc1 kf_fixr24
    s_branch kf_fixr28
kf_fix31:
    s_mov_b32 s24, 0
    s_branch kf_fix31c
kf_fix35:
    s_mov_b32 s24, 1
kf_fix31c:
    s_cmp_eq_u32 s33, 0
    s_cbranch_scc0 kf_fix31f
    s_mov_b32 s36, 0
    s_mov_b32 s33, 1
    v_add_f32 v80, v226, v200
    v_add_f32 v81, v226, v201
    v_add_f32 v82, v226, v202
    v_add_f32 v83, v226, v203
    v_add_f32 v84, v226, v209
    v_add_f32 v85, v226, v210
    v_add_f32 v86, v226, v211
    v_add_f32 v87, v226, v212
    v_add_f32 v88, v227, v213
    v_add_f32 v89, v227, v214
    v_add_f32 v90, v227, v215
    v_add_f32 v91, v227, v216
    v_add_f32 v92, v227, v217
    v_add_f32 v93, v227, v218
    v_add_f32 v94, v227, v219
    v_add_f32 v95, v227, v220
    s_cmp_eq_u32 s24, 0
    s_cbranch_scc1 kf_fixr32
    s_branch kf_fixr36
kf_fix31f:
    s_mov_b32 s36, 0x1000
    v_mov_b32 v80, 0xf1800000
    v_mov_b32 v81, v80
    v_mov_b32 v82, v80
    v_mov_b32 v83, v80
    v_mov_b32 v84, v80
    v_mov_b32 v85, v80
    v_mov_b32 v86, v80
    v_mov_b32 v87, v80
    v_mov_b32 v88, v80
    v_mov_b32 v89, v80
    v_mov_b32 v90, v80
    v_mov_b32 v91, v80
    v_mov_b32 v92, v80
    v_mov_b32 v93, v80
    v_mov_b32 v94, v80
    v_mov_b32_e64 v95, v80
    s_cmp_eq_u32 s24, 0
    s_cbranch_scc1 kf_fixr32
    s_branch kf_fixr36
ka_p1r_x:
    s_lshl2_add_u32 s36, s5, s6
    s_lshl1_add_u32 s36, s31, s36
    s_sub_u32 s36, 61, s36
    s_mov_b32 s33, 0
    s_sub_u32 s36, s36, 1
    s_cbranch_scc1 kf_fix31
kf_fixr32:
    s_waitcnt lgkmcnt(4)
    v_mfma_f32_16x16x32_bf16 v[16:19], a[192:195], a[160:163], v[80:83]
    ds_read_b128 a[240:243], v241 offset:20480
    ds_read_b128 a[244:247], v241 offset:21504
    v_mfma_f32_16x16x32_bf16 v[16:19], a[196:199], a[164:167], v[16:19]
    s_mov_b32 m0, s34
    v_exp_f32 v128, v32
    v_mfma_f32_16x16x32_bf16 v[16:19], a[200:203], a[168:171], v[16:19]
    v_exp_f32_e64 v129, v33
    v_mfma_f32_16x16x32_bf16 v[16:19], a[204:207], a[172:175], v[16:19]
    v_exp_f32_e64 v130, v34
    v_mfma_f32_16x16x32_bf16 v[24:27], a[192:195], a[176:179], v[88:91]
    ds_read_b128 a[248:251], v241 offset:22528
    ds_read_b128 a[252:255], v241 offset:23552
    s_add_u32 s41, s42, 17664
    v_mfma_f32_16x16x32_bf16 v[24:27], a[196:199], a[180:183], v[24:27]
    v_exp_f32_e64 v131, v35
    v_mfma_f32_16x16x32_bf16 v[24:27], a[200:203], a[184:187], v[24:27]
    v_exp_f32_e64 v132, v36
    v_mfma_f32_16x16x32_bf16 v[24:27], a[204:207], a[188:191], v[24:27]
    v_exp_f32_e64 v133, v37
    v_mfma_f32_16x16x32_bf16 v[20:23], a[208:211], a[160:163], v[84:87]
    ds_read_b128 a[192:195], v241 offset:8192
    ds_read_b128 a[196:199], v241 offset:10240
    v_cvt_pk_bf16_f32 v112, v128, v129
    v_mfma_f32_16x16x32_bf16 v[20:23], a[212:215], a[164:167], v[20:23]
    v_exp_f32_e64 v134, v38
    v_mfma_f32_16x16x32_bf16 v[20:23], a[216:219], a[168:171], v[20:23]
    v_exp_f32_e64 v135, v39
    v_mfma_f32_16x16x32_bf16 v[20:23], a[220:223], a[172:175], v[20:23]
    v_exp_f32_e64 v136, v40
    v_mfma_f32_16x16x32_bf16 v[28:31], a[208:211], a[176:179], v[92:95]
    ds_read_b128 a[200:203], v241 offset:12288
    ds_read_b128 a[204:207], v241 offset:14336
    buffer_load_dwordx4 v242, s[16:19], s41 offen offset:0 sc1 lds
    v_mfma_f32_16x16x32_bf16 v[28:31], a[212:215], a[180:183], v[28:31]
    v_exp_f32_e64 v137, v41
    v_mfma_f32_16x16x32_bf16 v[28:31], a[216:219], a[184:187], v[28:31]
    v_cvt_pk_bf16_f32 v113, v130, v131
    v_cvt_pk_bf16_f32 v114, v132, v133
    v_mfma_f32_16x16x32_bf16 v[28:31], a[220:223], a[188:191], v[28:31]
    v_exp_f32 v138, v42
    s_waitcnt lgkmcnt(4)
    v_mfma_f32_16x16x32_bf16 a[0:3], a[224:227], v[96:99], a[0:3]
    ds_read_b128 a[208:211], v241 offset:9216
    v_or3_b32 v208, v112, v113, v114
    v_mfma_f32_16x16x32_bf16 a[32:35], a[224:227], v[100:103], a[32:35]
    v_exp_f32_e64 v139, v43
    v_mfma_f32_16x16x32_bf16 a[64:67], a[224:227], v[104:107], a[64:67]
    v_exp_f32_e64 v140, v44
    v_mfma_f32_16x16x32_bf16 a[96:99], a[224:227], v[108:111], a[96:99]
    buffer_load_dwordx4 v242, s[16:19], s41 offen offset:1024 sc1 lds
    v_exp_f32_e64 v141, v45
    v_mfma_f32_16x16x32_bf16 a[4:7], a[228:231], v[96:99], a[4:7]
    ds_read_b128 a[212:215], v241 offset:11264
    v_cvt_pk_bf16_f32 v115, v134, v135
    v_mfma_f32_16x16x32_bf16 a[36:39], a[228:231], v[100:103], a[36:39]
    v_cvt_pk_bf16_f32 v116, v136, v137
    v_or3_b32 v208, v208, v115, v116
    v_mfma_f32_16x16x32_bf16 a[68:71], a[228:231], v[104:107], a[68:71]
    v_exp_f32_e64 v142, v46
    v_mfma_f32_16x16x32_bf16 a[100:103], a[228:231], v[108:111], a[100:103]
    v_exp_f32_e64 v143, v47
    v_cvt_pk_bf16_f32 v117, v138, v139
    v_mfma_f32_16x16x32_bf16 a[8:11], a[232:235], v[96:99], a[8:11]
    ds_read_b128 a[216:219], v241 offset:13312
    v_cvt_pk_bf16_f32 v118, v140, v141
    v_mfma_f32_16x16x32_bf16 a[40:43], a[232:235], v[100:103], a[40:43]
    v_exp_f32_e64 v128, v48
    v_mfma_f32_16x16x32_bf16 a[72:75], a[232:235], v[104:107], a[72:75]
    v_exp_f32_e64 v129, v49
    v_mfma_f32_16x16x32_bf16 a[104:107], a[232:235], v[108:111], a[104:107]
    buffer_load_dwordx4 v242, s[16:19], s41 offen offset:2048 sc1 lds
    v_exp_f32_e64 v130, v50
    v_mfma_f32_16x16x32_bf16 a[12:15], a[236:239], v[96:99], a[12:15]
    ds_read_b128 a[220:223], v241 offset:15360
    v_or3_b32 v208, v208, v117, v118
    v_mfma_f32_16x16x32_bf16 a[44:47], a[236:239], v[100:103], a[44:47]
    v_exp_f32_e64 v131, v51
    v_mfma_f32_16x16x32_bf16 a[76:79], a[236:239], v[104:107], a[76:79]
    v_exp_f32_e64 v132, v52
    v_cvt_pk_bf16_f32 v119, v142, v143
    v_mfma_f32_16x16x32_bf16 a[108:111], a[236:239], v[108:111], a[108:111]
    v_exp_f32_e64 v133, v53
    v_mfma_f32_16x16x32_bf16 a[16:19], a[240:243], v[96:99], a[16:19]
    ds_read_b128 a[224:227], v241 offset:24576
    v_cvt_pk_bf16_f32 v120, v128, v129
    v_mfma_f32_16x16x32_bf16 a[48:51], a[240:243], v[100:103], a[48:51]
    v_exp_f32_e64 v134, v54
    v_mfma_f32_16x16x32_bf16 a[80:83], a[240:243], v[104:107], a[80:83]
    buffer_load_dwordx4 v242, s[16:19], s41 offen offset:3072 sc1 lds
    v_exp_f32_e64 v135, v55
    v_mfma_f32_16x16x32_bf16 a[112:115], a[240:243], v[108:111], a[112:115]
    v_or3_b32 v208, v208, v119, v120
    v_cvt_pk_bf16_f32 v121, v130, v131
    v_mfma_f32_16x16x32_bf16 a[20:23], a[244:247], v[96:99], a[20:23]
    ds_read_b128 a[228:231], v241 offset:25600
    v_cvt_pk_bf16_f32 v122, v132, v133
    v_mfma_f32_16x16x32_bf16 a[52:55], a[244:247], v[100:103], a[52:55]
    v_exp_f32_e64 v136, v56
    v_mfma_f32_16x16x32_bf16 a[84:87], a[244:247], v[104:107], a[84:87]
    v_exp_f32_e64 v137, v57
    v_or3_b32 v208, v208, v121, v122
    v_mfma_f32_16x16x32_bf16 a[116:119], a[244:247], v[108:111], a[116:119]
    v_exp_f32_e64 v138, v58
    v_mfma_f32_16x16x32_bf16 a[24:27], a[248:251], v[96:99], a[24:27]
    ds_read_b128 a[232:235], v241 offset:26624
    v_cvt_pk_bf16_f32 v123, v134, v135
    v_mfma_f32_16x16x32_bf16 a[56:59], a[248:251], v[100:103], a[56:59]
    s_add_u32 s35, s35, 32768
    s_cmp_ge_u32 s35, 163840
    s_cselect_b32 s35, 0, s35
    v_mfma_f32_16x16x32_bf16 a[88:91], a[248:251], v[104:107], a[88:91]
    v_exp_f32 v139, v59
    v_mfma_f32_16x16x32_bf16 a[120:123], a[248:251], v[108:111], a[120:123]
    v_exp_f32_e64 v140, v60
    v_mfma_f32_16x16x32_bf16 a[28:31], a[252:255], v[96:99], a[28:31]
    ds_read_b128 a[236:239], v241 offset:27648
    v_cvt_pk_bf16_f32 v124, v136, v137
    v_mfma_f32_16x16x32_bf16 a[60:63], a[252:255], v[100:103], a[60:63]
    v_exp_f32_e64 v141, v61
    v_or3_b32 v208, v208, v123, v124
    v_mfma_f32_16x16x32_bf16 a[92:95], a[252:255], v[104:107], a[92:95]
    v_exp_f32_e64 v142, v62
    v_mfma_f32_16x16x32_bf16 a[124:127], a[252:255], v[108:111], a[124:127]
    v_exp_f32_e64 v143, v63
    v_mfma_f32_16x16x32_bf16 v[144:147], v[204:207], v[96:99], v[144:147]
    v_cvt_pk_bf16_f32 v125, v138, v139
    v_cvt_pk_bf16_f32 v126, v140, v141
    v_mfma_f32_16x16x32_bf16 v[148:151], v[204:207], v[100:103], v[148:151]
    v_or3_b32 v208, v208, v125, v126
    v_cvt_pk_bf16_f32 v127, v142, v143
    v_or_b32_e64 v208, v208, v127
    v_mfma_f32_16x16x32_bf16 v[152:155], v[204:207], v[104:107], v[152:155]
    v_and_b32 v208, s38, v208
    v_cmp_ne_u32 vcc, 0, v208
    v_mfma_f32_16x16x32_bf16 v[156:159], v[204:207], v[108:111], v[156:159]
    s_cbranch_vccnz kf_rare30
kf_rr29:
    s_sub_u32 s36, s36, 1
    s_cbranch_scc1 kf_fix35
kf_fixr36:
    s_waitcnt lgkmcnt(4)
    v_mfma_f32_16x16x32_bf16 v[48:51], a[192:195], a[160:163], v[80:83]
    ds_read_b128 a[240:243], v241 offset:28672
    ds_read_b128 a[244:247], v241 offset:29696
    v_mfma_f32_16x16x32_bf16 v[48:51], a[196:199], a[164:167], v[48:51]
    v_exp_f32_e64 v128, v16
    v_mfma_f32_16x16x32_bf16 v[48:51], a[200:203], a[168:171], v[48:51]
    v_exp_f32_e64 v129, v17
    v_mfma_f32_16x16x32_bf16 v[48:51], a[204:207], a[172:175], v[48:51]
    s_add_u32 m0, s34, 16384
    s_add_u32 s34, s34, 32768
    v_mfma_f32_16x16x32_bf16 v[56:59], a[192:195], a[176:179], v[88:91]
    ds_read_b128 a[248:251], v241 offset:30720
    ds_read_b128 a[252:255], v241 offset:31744
    v_mfma_f32_16x16x32_bf16 v[56:59], a[196:199], a[180:183], v[56:59]
    s_cmp_ge_u32 s34, 163840
    s_cselect_b32 s34, s37, s34
    v_mfma_f32_16x16x32_bf16 v[56:59], a[200:203], a[184:187], v[56:59]
    v_exp_f32 v130, v18
    v_mfma_f32_16x16x32_bf16 v[56:59], a[204:207], a[188:191], v[56:59]
    v_exp_f32_e64 v131, v19
    v_mfma_f32_16x16x32_bf16 v[52:55], a[208:211], a[160:163], v[84:87]
    s_waitcnt vmcnt(12)
    s_barrier
    v_add_u32_e64 v241, s35, v240
    ds_read_b128 a[192:195], v241 offset:0
    v_mfma_f32_16x16x32_bf16 v[52:55], a[212:215], a[164:167], v[52:55]
    v_exp_f32_e64 v132, v20
    v_mfma_f32_16x16x32_bf16 v[52:55], a[216:219], a[168:171], v[52:55]
    ds_read_b128 a[196:199], v241 offset:2048
    buffer_load_dwordx4 v242, s[16:19], s42 offen offset:0 sc1 lds
    v_mfma_f32_16x16x32_bf16 v[52:55], a[220:223], a[172:175], v[52:55]
    v_exp_f32_e64 v133, v21
    v_mfma_f32_16x16x32_bf16 v[60:63], a[208:211], a[176:179], v[92:95]
    ds_read_b128 a[200:203], v241 offset:4096
    ds_read_b128 a[204:207], v241 offset:6144
    v_mfma_f32_16x16x32_bf16 v[60:63], a[212:215], a[180:183], v[60:63]
    v_exp_f32_e64 v134, v22
    v_mfma_f32_16x16x32_bf16 v[60:63], a[216:219], a[184:187], v[60:63]
    v_exp_f32_e64 v135, v23
    v_mfma_f32_16x16x32_bf16 v[60:63], a[220:223], a[188:191], v[60:63]
    v_cvt_pk_bf16_f32 v104, v128, v129
    s_waitcnt lgkmcnt(4)
    v_mfma_f32_16x16x32_bf16 a[0:3], a[224:227], v[112:115], a[0:3]
    ds_read_b128 a[208:211], v241 offset:1024
    v_cvt_pk_bf16_f32 v105, v130, v131
    v_mfma_f32_16x16x32_bf16 a[32:35], a[224:227], v[116:119], a[32:35]
    v_exp_f32 v136, v24
    v_mfma_f32_16x16x32_bf16 a[64:67], a[224:227], v[120:123], a[64:67]
    v_exp_f32_e64 v137, v25
    v_mfma_f32_16x16x32_bf16 a[96:99], a[224:227], v[124:127], a[96:99]
    v_cvt_pk_bf16_f32 v106, v132, v133
    v_or3_b32 v208, v104, v105, v106
    v_mfma_f32_16x16x32_bf16 a[4:7], a[228:231], v[112:115], a[4:7]
    ds_read_b128 a[212:215], v241 offset:3072
    buffer_load_dwordx4 v242, s[16:19], s42 offen offset:1024 sc1 lds
    v_mfma_f32_16x16x32_bf16 a[36:39], a[228:231], v[116:119], a[36:39]
    v_exp_f32_e64 v138, v26
    v_mfma_f32_16x16x32_bf16 a[68:71], a[228:231], v[120:123], a[68:71]
    v_exp_f32_e64 v139, v27
    v_mfma_f32_16x16x32_bf16 a[100:103], a[228:231], v[124:127], a[100:103]
    v_exp_f32_e64 v140, v28
    v_mfma_f32_16x16x32_bf16 a[8:11], a[232:235], v[112:115], a[8:11]
    ds_read_b128 a[216:219], v241 offset:5120
    v_cvt_pk_bf16_f32 v107, v134, v135
    v_mfma_f32_16x16x32_bf16 a[40:43], a[232:235], v[116:119], a[40:43]
    v_exp_f32_e64 v141, v29
    v_mfma_f32_16x16x32_bf16 a[72:75], a[232:235], v[120:123], a[72:75]
    v_cvt_pk_bf16_f32 v108, v136, v137
    v_or3_b32 v208, v208, v107, v108
    v_mfma_f32_16x16x32_bf16 a[104:107], a[232:235], v[124:127], a[104:107]
    v_exp_f32_e64 v142, v30
    v_mfma_f32_16x16x32_bf16 a[12:15], a[236:239], v[112:115], a[12:15]
    ds_read_b128 a[220:223], v241 offset:7168
    v_cvt_pk_bf16_f32 v109, v138, v139
    v_mfma_f32_16x16x32_bf16 a[44:47], a[236:239], v[116:119], a[44:47]
    buffer_load_dwordx4 v242, s[16:19], s42 offen offset:2048 sc1 lds
    v_cvt_pk_bf16_f32 v110, v140, v141
    v_mfma_f32_16x16x32_bf16 a[76:79], a[236:239], v[120:123], a[76:79]
    v_exp_f32_e64 v143, v31
    v_mfma_f32_16x16x32_bf16 a[108:111], a[236:239], v[124:127], a[108:111]
    v_or3_b32 v208, v208, v109, v110
    v_cvt_pk_bf16_f32 v111, v142, v143
    v_mfma_f32_16x16x32_bf16 a[16:19], a[240:243], v[112:115], a[16:19]
    ds_read_b128 a[224:227], v241 offset:16384
    v_or_b32_e64 v208, v208, v111
    v_mfma_f32_16x16x32_bf16 a[48:51], a[240:243], v[116:119], a[48:51]
    v_and_b32 v208, s38, v208
    v_cmp_ne_u32 vcc, 0, v208
    v_mfma_f32_16x16x32_bf16 a[80:83], a[240:243], v[120:123], a[80:83]
    v_mfma_f32_16x16x32_bf16 a[112:115], a[240:243], v[124:127], a[112:115]
    buffer_load_dwordx4 v242, s[16:19], s42 offen offset:3072 sc1 lds
    s_add_u32 s42, s42, 34048
    v_mfma_f32_16x16x32_bf16 a[20:23], a[244:247], v[112:115], a[20:23]
    ds_read_b128 a[228:231], v241 offset:17408
    v_mfma_f32_16x16x32_bf16 a[52:55], a[244:247], v[116:119], a[52:55]
    v_mfma_f32_16x16x32_bf16 a[84:87], a[244:247], v[120:123], a[84:87]
    v_mfma_f32_16x16x32_bf16 a[116:119], a[244:247], v[124:127], a[116:119]
    v_mfma_f32_16x16x32_bf16 a[24:27], a[248:251], v[112:115], a[24:27]
    ds_read_b128 a[232:235], v241 offset:18432
    v_mfma_f32_16x16x32_bf16 a[56:59], a[248:251], v[116:119], a[56:59]
    v_mfma_f32_16x16x32_bf16 a[88:91], a[248:251], v[120:123], a[88:91]
    v_mfma_f32_16x16x32_bf16 a[120:123], a[248:251], v[124:127], a[120:123]
    v_mfma_f32_16x16x32_bf16 a[28:31], a[252:255], v[112:115], a[28:31]
    ds_read_b128 a[236:239], v241 offset:19456
    v_mfma_f32_16x16x32_bf16 a[60:63], a[252:255], v[116:119], a[60:63]
    v_mfma_f32_16x16x32_bf16 a[92:95], a[252:255], v[120:123], a[92:95]
    v_mfma_f32_16x16x32_bf16 a[124:127], a[252:255], v[124:127], a[124:127]
    v_mfma_f32_16x16x32_bf16 v[144:147], v[204:207], v[112:115], v[144:147]
    v_mfma_f32_16x16x32_bf16 v[148:151], v[204:207], v[116:119], v[148:151]
    v_mfma_f32_16x16x32_bf16 v[152:155], v[204:207], v[120:123], v[152:155]
    v_mfma_f32_16x16x32_bf16 v[156:159], v[204:207], v[124:127], v[156:159]
    s_cbranch_vccnz kf_rare34
kf_rr33:
    s_nop 6
    v_rcp_f32 v230, v144
    v_rcp_f32 v231, v148
    v_accvgpr_read_b32 v160, a0
    v_accvgpr_read_b32 v161, a1
    v_accvgpr_read_b32 v162, a2
    v_accvgpr_read_b32 v163, a3
    v_accvgpr_read_b32 v164, a4
    v_accvgpr_read_b32 v165, a5
    v_accvgpr_read_b32 v166, a6
    v_accvgpr_read_b32 v167, a7
    v_mul_f32 v160, v160, v230
    v_mul_f32 v161, v161, v230
    v_mul_f32 v162, v162, v230
    v_mul_f32 v163, v163, v230
    v_mul_f32 v164, v164, v230
    v_mul_f32 v165, v165, v230
    v_mul_f32 v166, v166, v230
    v_mul_f32 v167, v167, v230
    v_cvt_pk_bf16_f32 v176, v160, v161
    v_cvt_pk_bf16_f32 v177, v162, v163
    v_cvt_pk_bf16_f32 v178, v164, v165
    v_cvt_pk_bf16_f32 v179, v166, v167
    buffer_store_dwordx4 v[176:179], v240, s[20:23], s39 offen offset:0 sc1
    v_accvgpr_read_b32 v168, a8
    v_accvgpr_read_b32 v169, a9
    v_accvgpr_read_b32 v170, a10
    v_accvgpr_read_b32 v171, a11
    v_accvgpr_read_b32 v172, a12
    v_accvgpr_read_b32 v173, a13
    v_accvgpr_read_b32 v174, a14
    v_accvgpr_read_b32 v175, a15
    v_mul_f32 v168, v168, v230
    v_mul_f32 v169, v169, v230
    v_mul_f32 v170, v170, v230
    v_mul_f32 v171, v171, v230
    v_mul_f32 v172, v172, v230
    v_mul_f32 v173, v173, v230
    v_mul_f32 v174, v174, v230
    v_mul_f32 v175, v175, v230
    v_cvt_pk_bf16_f32 v180, v168, v169
    v_cvt_pk_bf16_f32 v181, v170, v171
    v_cvt_pk_bf16_f32 v182, v172, v173
    v_cvt_pk_bf16_f32 v183, v174, v175
    buffer_store_dwordx4 v[180:183], v240, s[20:23], s39 offen offset:1024 sc1
    v_accvgpr_read_b32 v160, a16
    v_accvgpr_read_b32 v161, a17
    v_accvgpr_read_b32 v162, a18
    v_accvgpr_read_b32 v163, a19
    v_accvgpr_read_b32 v164, a20
    v_accvgpr_read_b32 v165, a21
    v_accvgpr_read_b32 v166, a22
    v_accvgpr_read_b32 v167, a23
    v_mul_f32 v160, v160, v230
    v_mul_f32 v161, v161, v230
    v_mul_f32 v162, v162, v230
    v_mul_f32 v163, v163, v230
    v_mul_f32 v164, v164, v230
    v_mul_f32 v165, v165, v230
    v_mul_f32 v166, v166, v230
    v_mul_f32 v167, v167, v230
    v_cvt_pk_bf16_f32 v184, v160, v161
    v_cvt_pk_bf16_f32 v185, v162, v163
    v_cvt_pk_bf16_f32 v186, v164, v165
    v_cvt_pk_bf16_f32 v187, v166, v167
    buffer_store_dwordx4 v[184:187], v240, s[20:23], s39 offen offset:2048 sc1
    v_accvgpr_read_b32 v168, a24
    v_accvgpr_read_b32 v169, a25
    v_accvgpr_read_b32 v170, a26
    v_accvgpr_read_b32 v171, a27
    v_accvgpr_read_b32 v172, a28
    v_accvgpr_read_b32 v173, a29
    v_accvgpr_read_b32 v174, a30
    v_accvgpr_read_b32 v175, a31
    v_mul_f32 v168, v168, v230
    v_mul_f32 v169, v169, v230
    v_mul_f32 v170, v170, v230
    v_mul_f32 v171, v171, v230
    v_mul_f32 v172, v172, v230
    v_mul_f32 v173, v173, v230
    v_mul_f32 v174, v174, v230
    v_mul_f32 v175, v175, v230
    v_cvt_pk_bf16_f32 v188, v168, v169
    v_cvt_pk_bf16_f32 v189, v170, v171
    v_cvt_pk_bf16_f32 v190, v172, v173
    v_cvt_pk_bf16_f32 v191, v174, v175
    buffer_store_dwordx4 v[188:191], v240, s[20:23], s39 offen offset:3072 sc1
    v_accvgpr_read_b32 v160, a32
    v_accvgpr_read_b32 v161, a33
    v_accvgpr_read_b32 v162, a34
    v_accvgpr_read_b32 v163, a35
    v_accvgpr_read_b32 v164, a36
    v_accvgpr_read_b32 v165, a37
    v_accvgpr_read_b32 v166, a38
    v_accvgpr_read_b32 v167, a39
    v_mul_f32 v160, v160, v231
    v_mul_f32 v161, v161, v231
    v_mul_f32 v162, v162, v231
    v_mul_f32 v163, v163, v231
    v_mul_f32 v164, v164, v231
    v_mul_f32 v165, v165, v231
    v_mul_f32 v166, v166, v231
    v_mul_f32 v167, v167, v231
    v_cvt_pk_bf16_f32 v176, v160, v161
    v_cvt_pk_bf16_f32 v177, v162, v163
    v_cvt_pk_bf16_f32 v178, v164, v165
    v_cvt_pk_bf16_f32 v179, v166, v167
    buffer_store_dwordx4 v[176:179], v244, s[20:23], s39 offen offset:0 sc1
    v_accvgpr_read_b32 v168, a40
    v_accvgpr_read_b32 v169, a41
    v_accvgpr_read_b32 v170, a42
    v_accvgpr_read_b32 v171, a43
    v_accvgpr_read_b32 v172, a44
    v_accvgpr_read_b32 v173, a45
    v_accvgpr_read_b32 v174, a46
    v_accvgpr_read_b32 v175, a47
    v_mul_f32 v168, v168, v231
    v_mul_f32 v169, v169, v231
    v_mul_f32 v170, v170, v231
    v_mul_f32 v171, v171, v231
    v_mul_f32 v172, v172, v231
    v_mul_f32 v173, v173, v231
    v_mul_f32 v174, v174, v231
    v_mul_f32 v175, v175, v231
    v_cvt_pk_bf16_f32 v180, v168, v169
    v_cvt_pk_bf16_f32 v181, v170, v171
    v_cvt_pk_bf16_f32 v182, v172, v173
    v_cvt_pk_bf16_f32 v183, v174, v175
    buffer_store_dwordx4 v[180:183], v244, s[20:23], s39 offen offset:1024 sc1
    v_accvgpr_read_b32 v160, a48
    v_accvgpr_read_b32 v161, a49
    v_accvgpr_read_b32 v162, a50
    v_accvgpr_read_b32 v163, a51
    v_accvgpr_read_b32 v164, a52
    v_accvgpr_read_b32 v165, a53
    v_accvgpr_read_b32 v166, a54
    v_accvgpr_read_b32 v167, a55
    v_mul_f32 v160, v160, v231
    v_mul_f32 v161, v161, v231
    v_mul_f32 v162, v162, v231
    v_mul_f32 v163, v163, v231
    v_mul_f32 v164, v164, v231
    v_mul_f32 v165, v165, v231
    v_mul_f32 v166, v166, v231
    v_mul_f32 v167, v167, v231
    v_cvt_pk_bf16_f32 v184, v160, v161
    v_cvt_pk_bf16_f32 v185, v162, v163
    v_cvt_pk_bf16_f32 v186, v164, v165
    v_cvt_pk_bf16_f32 v187, v166, v167
    buffer_store_dwordx4 v[184:187], v244, s[20:23], s39 offen offset:2048 sc1
    v_accvgpr_read_b32 v168, a56
    v_accvgpr_read_b32 v169, a57
    v_accvgpr_read_b32 v170, a58
    v_accvgpr_read_b32 v171, a59
    v_accvgpr_read_b32 v172, a60
    v_accvgpr_read_b32 v173, a61
    v_accvgpr_read_b32 v174, a62
    v_accvgpr_read_b32 v175, a63
    v_mul_f32 v168, v168, v231
    v_mul_f32 v169, v169, v231
    v_mul_f32 v170, v170, v231
    v_mul_f32 v171, v171, v231
    v_mul_f32 v172, v172, v231
    v_mul_f32 v173, v173, v231
    v_mul_f32 v174, v174, v231
    v_mul_f32 v175, v175, v231
    v_cvt_pk_bf16_f32 v188, v168, v169
    v_cvt_pk_bf16_f32 v189, v170, v171
    v_cvt_pk_bf16_f32 v190, v172, v173
    v_cvt_pk_bf16_f32 v191, v174, v175
    buffer_store_dwordx4 v[188:191], v244, s[20:23], s39 offen offset:3072 sc1
    s_lshl1_add_u32 s26, s5, s31
    s_lshl_b32 s26, s26, 1
    s_sub_u32 s26, 30, s26
    s_branch ka_p2r_e
.p2align 5
ka_p2r:
    s_sub_u32 s36, s36, 1
    s_cbranch_scc1 kf_fix39
kf_fixr40:
    s_waitcnt lgkmcnt(4)
    v_mfma_f32_16x16x32_bf16 v[16:19], a[192:195], a[160:163], v[80:83]
    ds_read_b128 a[240:243], v241 offset:20480
    ds_read_b128 a[244:247], v241 offset:21504
    v_mfma_f32_16x16x32_bf16 v[16:19], a[196:199], a[164:167], v[16:19]
    v_exp_f32 v128, v48
    v_mfma_f32_16x16x32_bf16 v[16:19], a[200:203], a[168:171], v[16:19]
    s_mov_b32 m0, s34
    v_exp_f32 v129, v49
    v_mfma_f32_16x16x32_bf16 v[16:19], a[204:207], a[172:175], v[16:19]
    v_exp_f32_e64 v130, v50
    v_mfma_f32_16x16x32_bf16 v[24:27], a[192:195], a[176:179], v[88:91]
    ds_read_b128 a[248:251], v241 offset:22528
    ds_read_b128 a[252:255], v241 offset:23552
    v_mfma_f32_16x16x32_bf16 v[24:27], a[196:199], a[180:183], v[24:27]
    s_add_u32 s41, s42, 17664
    v_cvt_pk_bf16_f32 v120, v128, v129
    v_mfma_f32_16x16x32_bf16 v[24:27], a[200:203], a[184:187], v[24:27]
    v_exp_f32_e64 v131, v51
    v_mfma_f32_16x16x32_bf16 v[24:27], a[204:207], a[188:191], v[24:27]
    buffer_load_dwordx4 v242, s[16:19], s41 offen offset:0 sc1 lds
    v_exp_f32_e64 v132, v52
    v_mfma_f32_16x16x32_bf16 v[20:23], a[208:211], a[160:163], v[84:87]
    ds_read_b128 a[192:195], v241 offset:8192
    ds_read_b128 a[196:199], v241 offset:10240
    v_mfma_f32_16x16x32_bf16 v[20:23], a[212:215], a[164:167], v[20:23]
    v_exp_f32_e64 v133, v53
    v_mfma_f32_16x16x32_bf16 v[20:23], a[216:219], a[168:171], v[20:23]
    v_exp_f32_e64 v134, v54
    v_mfma_f32_16x16x32_bf16 v[20:23], a[220:223], a[172:175], v[20:23]
    v_exp_f32_e64 v135, v55
    v_mfma_f32_16x16x32_bf16 v[28:31], a[208:211], a[176:179], v[92:95]
    ds_read_b128 a[200:203], v241 offset:12288
    ds_read_b128 a[204:207], v241 offset:14336
    v_mfma_f32_16x16x32_bf16 v[28:31], a[212:215], a[180:183], v[28:31]
    buffer_load_dwordx4 v242, s[16:19], s41 offen offset:1024 sc1 lds
    v_exp_f32_e64 v136, v56
    v_mfma_f32_16x16x32_bf16 v[28:31], a[216:219], a[184:187], v[28:31]
    v_exp_f32_e64 v137, v57
    v_mfma_f32_16x16x32_bf16 v[28:31], a[220:223], a[188:191], v[28:31]
    v_cvt_pk_bf16_f32 v121, v130, v131
    s_waitcnt lgkmcnt(4)
    v_mfma_f32_16x16x32_bf16 a[64:67], a[224:227], v[104:107], a[64:67]
    ds_read_b128 a[208:211], v241 offset:9216
    ds_read_b128 a[212:215], v241 offset:11264
    v_mfma_f32_16x16x32_bf16 a[96:99], a[224:227], v[108:111], a[96:99]
    v_cvt_pk_bf16_f32 v122, v132, v133
    buffer_load_dwordx4 v242, s[16:19], s41 offen offset:2048 sc1 lds
    v_mfma_f32_16x16x32_bf16 a[68:71], a[228:231], v[104:107], a[68:71]
    v_exp_f32 v138, v58
    v_mfma_f32_16x16x32_bf16 a[100:103], a[228:231], v[108:111], a[100:103]
    v_exp_f32_e64 v139, v59
    v_or3_b32 v208, v120, v121, v122
    v_mfma_f32_16x16x32_bf16 a[72:75], a[232:235], v[104:107], a[72:75]
    ds_read_b128 a[216:219], v241 offset:13312
    ds_read_b128 a[220:223], v241 offset:15360
    v_mfma_f32_16x16x32_bf16 a[104:107], a[232:235], v[108:111], a[104:107]
    v_exp_f32_e64 v140, v60
    v_mfma_f32_16x16x32_bf16 a[76:79], a[236:239], v[104:107], a[76:79]
    buffer_load_dwordx4 v242, s[16:19], s41 offen offset:3072 sc1 lds
    v_cvt_pk_bf16_f32 v123, v134, v135
    v_mfma_f32_16x16x32_bf16 a[108:111], a[236:239], v[108:111], a[108:111]
    v_exp_f32_e64 v141, v61
    v_mfma_f32_16x16x32_bf16 a[80:83], a[240:243], v[104:107], a[80:83]
    ds_read_b128 a[224:227], v241 offset:24576
    ds_read_b128 a[228:231], v241 offset:25600
    v_cvt_pk_bf16_f32 v124, v136, v137
    v_mfma_f32_16x16x32_bf16 a[112:115], a[240:243], v[108:111], a[112:115]
    v_exp_f32_e64 v142, v62
    v_mfma_f32_16x16x32_bf16 a[84:87], a[244:247], v[104:107], a[84:87]
    s_add_u32 s35, s35, 32768
    v_or3_b32 v208, v208, v123, v124
    v_mfma_f32_16x16x32_bf16 a[116:119], a[244:247], v[108:111], a[116:119]
    s_cmp_ge_u32 s35, 163840
    s_cselect_b32 s35, 0, s35
    v_mfma_f32_16x16x32_bf16 a[88:91], a[248:251], v[104:107], a[88:91]
    ds_read_b128 a[232:235], v241 offset:26624
    ds_read_b128 a[236:239], v241 offset:27648
    v_mfma_f32_16x16x32_bf16 a[120:123], a[248:251], v[108:111], a[120:123]
    v_exp_f32 v143, v63
    v_mfma_f32_16x16x32_bf16 a[92:95], a[252:255], v[104:107], a[92:95]
    v_cvt_pk_bf16_f32 v125, v138, v139
    v_cvt_pk_bf16_f32 v126, v140, v141
    v_or3_b32 v208, v208, v125, v126
    v_mfma_f32_16x16x32_bf16 a[124:127], a[252:255], v[108:111], a[124:127]
    v_cvt_pk_bf16_f32 v127, v142, v143
    v_or_b32_e64 v208, v208, v127
    v_mfma_f32_16x16x32_bf16 v[152:155], v[204:207], v[104:107], v[152:155]
    v_and_b32 v208, s38, v208
    v_cmp_ne_u32 vcc, 0, v208
    v_mfma_f32_16x16x32_bf16 v[156:159], v[204:207], v[108:111], v[156:159]
    s_cbranch_vccnz kf_rare38
kf_rr37:
    s_sub_u32 s36, s36, 1
    s_cbranch_scc1 kf_fix43
kf_fixr44:
    s_waitcnt lgkmcnt(4)
    v_mfma_f32_16x16x32_bf16 v[48:51], a[192:195], a[160:163], v[80:83]
    ds_read_b128 a[240:243], v241 offset:28672
    ds_read_b128 a[244:247], v241 offset:29696
    v_mfma_f32_16x16x32_bf16 v[48:51], a[196:199], a[164:167], v[48:51]
    v_exp_f32_e64 v128, v16
    v_mfma_f32_16x16x32_bf16 v[48:51], a[200:203], a[168:171], v[48:51]
    s_add_u32 m0, s34, 16384
    v_exp_f32_e64 v129, v17
    v_mfma_f32_16x16x32_bf16 v[48:51], a[204:207], a[172:175], v[48:51]
    v_exp_f32_e64 v130, v18
    v_mfma_f32_16x16x32_bf16 v[56:59], a[192:195], a[176:179], v[88:91]
    ds_read_b128 a[248:251], v241 offset:30720
    ds_read_b128 a[252:255], v241 offset:31744
    v_mfma_f32_16x16x32_bf16 v[56:59], a[196:199], a[180:183], v[56:59]
    s_add_u32 s34, s34, 32768
    v_cvt_pk_bf16_f32 v104, v128, v129
    v_mfma_f32_16x16x32_bf16 v[56:59], a[200:203], a[184:187], v[56:59]
    s_cmp_ge_u32 s34, 163840
    s_cselect_b32 s34, s37, s34
    buffer_load_dwordx4 v242, s[16:19], s42 offen offset:0 sc1 lds
    v_mfma_f32_16x16x32_bf16 v[56:59], a[204:207], a[188:191], v[56:59]
    v_exp_f32 v131, v19
    v_mfma_f32_16x16x32_bf16 v[52:55], a[208:211], a[160:163], v[84:87]
    s_waitcnt vmcnt(13)
    s_barrier
    v_add_u32_e64 v241, s35, v240
    ds_read_b128 a[192:195], v241 offset:0
    v_mfma_f32_16x16x32_bf16 v[52:55], a[212:215], a[164:167], v[52:55]
    v_exp_f32_e64 v132, v20
    v_mfma_f32_16x16x32_bf16 v[52:55], a[216:219], a[168:171], v[52:55]
    ds_read_b128 a[196:199], v241 offset:2048
    v_cvt_pk_bf16_f32 v105, v130, v131
    v_mfma_f32_16x16x32_bf16 v[52:55], a[220:223], a[172:175], v[52:55]
    v_exp_f32_e64 v133, v21
    buffer_load_dwordx4 v242, s[16:19], s42 offen offset:1024 sc1 lds
    v_mfma_f32_16x16x32_bf16 v[60:63], a[208:211], a[176:179], v[92:95]
    ds_read_b128 a[200:203], v241 offset:4096
    ds_read_b128 a[204:207], v241 offset:6144
    v_mfma_f32_16x16x32_bf16 v[60:63], a[212:215], a[180:183], v[60:63]
    v_exp_f32_e64 v134, v22
    v_mfma_f32_16x16x32_bf16 v[60:63], a[216:219], a[184:187], v[60:63]
    v_exp_f32_e64 v135, v23
    v_mfma_f32_16x16x32_bf16 v[60:63], a[220:223], a[188:191], v[60:63]
    v_cvt_pk_bf16_f32 v106, v132, v133
    s_waitcnt lgkmcnt(4)
    v_mfma_f32_16x16x32_bf16 a[64:67], a[224:227], v[120:123], a[64:67]
    ds_read_b128 a[208:211], v241 offset:1024
    ds_read_b128 a[212:215], v241 offset:3072
    v_or3_b32 v208, v104, v105, v106
    v_mfma_f32_16x16x32_bf16 a[96:99], a[224:227], v[124:127], a[96:99]
    v_exp_f32 v136, v24
    v_mfma_f32_16x16x32_bf16 a[68:71], a[228:231], v[120:123], a[68:71]
    v_exp_f32_e64 v137, v25
    v_mfma_f32_16x16x32_bf16 a[100:103], a[228:231], v[124:127], a[100:103]
    v_exp_f32_e64 v138, v26
    v_mfma_f32_16x16x32_bf16 a[72:75], a[232:235], v[120:123], a[72:75]
    ds_read_b128 a[216:219], v241 offset:5120
    ds_read_b128 a[220:223], v241 offset:7168
    v_mfma_f32_16x16x32_bf16 a[104:107], a[232:235], v[124:127], a[104:107]
    buffer_load_dwordx4 v242, s[16:19], s42 offen offset:2048 sc1 lds
    v_exp_f32_e64 v139, v27
    v_mfma_f32_16x16x32_bf16 a[76:79], a[236:239], v[120:123], a[76:79]
    v_exp_f32_e64 v140, v28
    v_mfma_f32_16x16x32_bf16 a[108:111], a[236:239], v[124:127], a[108:111]
    v_exp_f32_e64 v141, v29
    v_mfma_f32_16x16x32_bf16 a[80:83], a[240:243], v[120:123], a[80:83]
    ds_read_b128 a[224:227], v241 offset:16384
    ds_read_b128 a[228:231], v241 offset:17408
    v_mfma_f32_16x16x32_bf16 a[112:115], a[240:243], v[124:127], a[112:115]
    v_cvt_pk_bf16_f32 v107, v134, v135
    buffer_load_dwordx4 v242, s[16:19], s42 offen offset:3072 sc1 lds
    v_mfma_f32_16x16x32_bf16 a[84:87], a[244:247], v[120:123], a[84:87]
    s_add_u32 s42, s42, 34048
    v_cvt_pk_bf16_f32 v108, v136, v137
    v_or3_b32 v208, v208, v107, v108
    v_mfma_f32_16x16x32_bf16 a[116:119], a[244:247], v[124:127], a[116:119]
    v_exp_f32_e64 v142, v30
    v_mfma_f32_16x16x32_bf16 a[88:91], a[248:251], v[120:123], a[88:91]
    ds_read_b128 a[232:235], v241 offset:18432
    ds_read_b128 a[236:239], v241 offset:19456
    v_mfma_f32_16x16x32_bf16 a[120:123], a[248:251], v[124:127], a[120:123]
    v_exp_f32_e64 v143, v31
    v_mfma_f32_16x16x32_bf16 a[92:95], a[252:255], v[120:123], a[92:95]
    v_cvt_pk_bf16_f32 v109, v138, v139
    v_cvt_pk_bf16_f32 v110, v140, v141
    v_mfma_f32_16x16x32_bf16 a[124:127], a[252:255], v[124:127], a[124:127]
    v_or3_b32 v208, v208, v109, v110
    v_cvt_pk_bf16_f32 v111, v142, v143
    v_or_b32_e64 v208, v208, v111
    v_mfma_f32_16x16x32_bf16 v[152:155], v[204:207], v[120:123], v[152:155]
    v_and_b32 v208, s38, v208
    v_cmp_ne_u32 vcc, 0, v208
    v_mfma_f32_16x16x32_bf16 v[156:159], v[204:207], v[124:127], v[156:159]
    s_cbranch_vccnz kf_rare42
kf_rr41:
ka_p2r_e:
    s_sub_u32 s26, s26, 1
    s_cbranch_scc0 ka_p2r
    s_branch ka_p2r_x
kf_fix39:
    s_mov_b32 s24, 0
    s_branch kf_fix39c
kf_fix43:
    s_mov_b32 s24, 1
kf_fix39c:
    s_cmp_eq_u32 s33, 0
    s_cbranch_scc0 kf_fix39f
    s_mov_b32 s36, 0
    s_mov_b32 s33, 1
    v_add_f32 v80, v226, v200
    v_add_f32 v81, v226, v201
    v_add_f32 v82, v226, v202
    v_add_f32 v83, v226, v203
    v_add_f32 v84, v226, v209
    v_add_f32 v85, v226, v210
    v_add_f32 v86, v226, v211
    v_add_f32 v87, v226, v212
    v_add_f32 v88, v227, v213
    v_add_f32 v89, v227, v214
    v_add_f32 v90, v227, v215
    v_add_f32 v91, v227, v216
    v_add_f32 v92, v227, v217
    v_add_f32 v93, v227, v218
    v_add_f32 v94, v227, v219
    v_add_f32 v95, v227, v220
    s_cmp_eq_u32 s24, 0
    s_cbranch_scc1 kf_fixr40
    s_branch kf_fixr44
kf_fix39f:
    s_mov_b32 s36, 0x1000
    v_mov_b32 v80, 0xf1800000
    v_mov_b32 v81, v80
    v_mov_b32 v82, v80
    v_mov_b32 v83, v80
    v_mov_b32 v84, v80
    v_mov_b32 v85, v80
    v_mov_b32 v86, v80
    v_mov_b32 v87, v80
    v_mov_b32 v88, v80
    v_mov_b32 v89, v80
    v_mov_b32 v90, v80
    v_mov_b32 v91, v80
    v_mov_b32 v92, v80
    v_mov_b32 v93, v80
    v_mov_b32 v94, v80
    v_mov_b32_e64 v95, v80
    s_cmp_eq_u32 s24, 0
    s_cbranch_scc1 kf_fixr40
    s_branch kf_fixr44
ka_p2r_x:
    s_waitcnt lgkmcnt(0)
    ds_read_b128 a[224:227], v241 offset:16384
    ds_read_b128 a[228:231], v241 offset:17408
    ds_read_b128 a[232:235], v241 offset:18432
    ds_read_b128 a[236:239], v241 offset:19456
    ds_read_b128 a[240:243], v241 offset:20480
    ds_read_b128 a[244:247], v241 offset:21504
    ds_read_b128 a[248:251], v241 offset:22528
    ds_read_b128 a[252:255], v241 offset:23552
    ds_read_b128 a[192:195], v241 offset:24576
    ds_read_b128 a[196:199], v241 offset:25600
    ds_read_b128 a[200:203], v241 offset:26624
    ds_read_b128 a[204:207], v241 offset:27648
    ds_read_b128 a[208:211], v241 offset:28672
    ds_read_b128 a[212:215], v241 offset:29696
    ds_read_b128 a[216:219], v241 offset:30720
    s_waitcnt lgkmcnt(7)
    ds_read_b128 a[220:223], v241 offset:31744
    v_mfma_f32_16x16x32_bf16 a[64:67], a[224:227], v[104:107], a[64:67]
    v_exp_f32 v128, v48
    v_exp_f32_e64 v129, v49
    v_mfma_f32_16x16x32_bf16 a[96:99], a[224:227], v[108:111], a[96:99]
    v_exp_f32_e64 v130, v50
    v_cvt_pk_bf16_f32 v120, v128, v129
    v_mfma_f32_16x16x32_bf16 a[68:71], a[228:231], v[104:107], a[68:71]
    v_exp_f32_e64 v131, v51
    v_mfma_f32_16x16x32_bf16 a[100:103], a[228:231], v[108:111], a[100:103]
    v_exp_f32_e64 v132, v52
    v_cvt_pk_bf16_f32 v121, v130, v131
    v_mfma_f32_16x16x32_bf16 a[72:75], a[232:235], v[104:107], a[72:75]
    v_exp_f32_e64 v133, v53
    v_mfma_f32_16x16x32_bf16 a[104:107], a[232:235], v[108:111], a[104:107]
    v_exp_f32_e64 v134, v54
    v_cvt_pk_bf16_f32 v122, v132, v133
    v_mfma_f32_16x16x32_bf16 a[76:79], a[236:239], v[104:107], a[76:79]
    v_exp_f32_e64 v135, v55
    v_or3_b32 v208, v120, v121, v122
    v_mfma_f32_16x16x32_bf16 a[108:111], a[236:239], v[108:111], a[108:111]
    v_exp_f32_e64 v136, v56
    v_cvt_pk_bf16_f32 v123, v134, v135
    v_mfma_f32_16x16x32_bf16 a[80:83], a[240:243], v[104:107], a[80:83]
    v_exp_f32_e64 v137, v57
    v_mfma_f32_16x16x32_bf16 a[112:115], a[240:243], v[108:111], a[112:115]
    v_exp_f32_e64 v138, v58
    v_cvt_pk_bf16_f32 v124, v136, v137
    v_mfma_f32_16x16x32_bf16 a[84:87], a[244:247], v[104:107], a[84:87]
    v_exp_f32_e64 v139, v59
    v_or3_b32 v208, v208, v123, v124
    v_mfma_f32_16x16x32_bf16 a[116:119], a[244:247], v[108:111], a[116:119]
    v_exp_f32_e64 v140, v60
    v_cvt_pk_bf16_f32 v125, v138, v139
    v_mfma_f32_16x16x32_bf16 a[88:91], a[248:251], v[104:107], a[88:91]
    v_exp_f32_e64 v141, v61
    v_mfma_f32_16x16x32_bf16 a[120:123], a[248:251], v[108:111], a[120:123]
    v_exp_f32_e64 v142, v62
    v_cvt_pk_bf16_f32 v126, v140, v141
    v_mfma_f32_16x16x32_bf16 a[92:95], a[252:255], v[104:107], a[92:95]
    v_exp_f32_e64 v143, v63
    v_or3_b32 v208, v208, v125, v126
    v_mfma_f32_16x16x32_bf16 a[124:127], a[252:255], v[108:111], a[124:127]
    v_cvt_pk_bf16_f32 v127, v142, v143
    v_or_b32 v208, v208, v127
    v_and_b32 v208, s38, v208
    v_mfma_f32_16x16x32_bf16 v[152:155], v[204:207], v[104:107], v[152:155]
    v_cmp_ne_u32_e64 vcc, 0, v208
    v_mfma_f32_16x16x32_bf16 v[156:159], v[204:207], v[108:111], v[156:159]
    s_cbranch_vccnz kf_rare46
kf_rr45:
    s_waitcnt lgkmcnt(0)
    s_nop 0
    v_mfma_f32_16x16x32_bf16 a[64:67], a[192:195], v[120:123], a[64:67]
    v_mfma_f32_16x16x32_bf16 a[96:99], a[192:195], v[124:127], a[96:99]
    v_mfma_f32_16x16x32_bf16 a[68:71], a[196:199], v[120:123], a[68:71]
    v_mfma_f32_16x16x32_bf16 a[100:103], a[196:199], v[124:127], a[100:103]
    v_mfma_f32_16x16x32_bf16 a[72:75], a[200:203], v[120:123], a[72:75]
    v_mfma_f32_16x16x32_bf16 a[104:107], a[200:203], v[124:127], a[104:107]
    v_mfma_f32_16x16x32_bf16 a[76:79], a[204:207], v[120:123], a[76:79]
    v_mfma_f32_16x16x32_bf16 a[108:111], a[204:207], v[124:127], a[108:111]
    v_mfma_f32_16x16x32_bf16 a[80:83], a[208:211], v[120:123], a[80:83]
    v_mfma_f32_16x16x32_bf16 a[112:115], a[208:211], v[124:127], a[112:115]
    v_mfma_f32_16x16x32_bf16 a[84:87], a[212:215], v[120:123], a[84:87]
    v_mfma_f32_16x16x32_bf16 a[116:119], a[212:215], v[124:127], a[116:119]
    v_mfma_f32_16x16x32_bf16 a[88:91], a[216:219], v[120:123], a[88:91]
    v_mfma_f32_16x16x32_bf16 a[120:123], a[216:219], v[124:127], a[120:123]
    v_mfma_f32_16x16x32_bf16 a[92:95], a[220:223], v[120:123], a[92:95]
    v_mfma_f32_16x16x32_bf16 a[124:127], a[220:223], v[124:127], a[124:127]
    v_mfma_f32_16x16x32_bf16 v[152:155], v[204:207], v[120:123], v[152:155]
    v_mfma_f32_16x16x32_bf16 v[156:159], v[204:207], v[124:127], v[156:159]
    s_cmp_eq_u32 s31, 0
    s_cbranch_scc1 ka_noxr
    s_waitcnt vmcnt(8)
    s_barrier
ka_noxr:
    s_nop 6
    v_rcp_f32 v230, v152
    v_rcp_f32 v231, v156
    v_accvgpr_read_b32 v160, a64
    v_accvgpr_read_b32 v161, a65
    v_accvgpr_read_b32 v162, a66
    v_accvgpr_read_b32 v163, a67
    v_accvgpr_read_b32 v164, a68
    v_accvgpr_read_b32 v165, a69
    v_accvgpr_read_b32 v166, a70
    v_accvgpr_read_b32 v167, a71
    v_mul_f32 v160, v160, v230
    v_mul_f32 v161, v161, v230
    v_mul_f32 v162, v162, v230
    v_mul_f32 v163, v163, v230
    v_mul_f32 v164, v164, v230
    v_mul_f32 v165, v165, v230
    v_mul_f32 v166, v166, v230
    v_mul_f32 v167, v167, v230
    v_cvt_pk_bf16_f32 v176, v160, v161
    v_cvt_pk_bf16_f32 v177, v162, v163
    v_cvt_pk_bf16_f32 v178, v164, v165
    v_cvt_pk_bf16_f32 v179, v166, v167
    buffer_store_dwordx4 v[176:179], v240, s[20:23], s40 offen offset:0 sc1
    v_accvgpr_read_b32 v168, a72
    v_accvgpr_read_b32 v169, a73
    v_accvgpr_read_b32 v170, a74
    v_accvgpr_read_b32 v171, a75
    v_accvgpr_read_b32 v172, a76
    v_accvgpr_read_b32 v173, a77
    v_accvgpr_read_b32 v174, a78
    v_accvgpr_read_b32 v175, a79
    v_mul_f32 v168, v168, v230
    v_mul_f32 v169, v169, v230
    v_mul_f32 v170, v170, v230
    v_mul_f32 v171, v171, v230
    v_mul_f32 v172, v172, v230
    v_mul_f32 v173, v173, v230
    v_mul_f32 v174, v174, v230
    v_mul_f32 v175, v175, v230
    v_cvt_pk_bf16_f32 v180, v168, v169
    v_cvt_pk_bf16_f32 v181, v170, v171
    v_cvt_pk_bf16_f32 v182, v172, v173
    v_cvt_pk_bf16_f32 v183, v174, v175
    buffer_store_dwordx4 v[180:183], v240, s[20:23], s40 offen offset:1024 sc1
    v_accvgpr_read_b32 v160, a80
    v_accvgpr_read_b32 v161, a81
    v_accvgpr_read_b32 v162, a82
    v_accvgpr_read_b32 v163, a83
    v_accvgpr_read_b32 v164, a84
    v_accvgpr_read_b32 v165, a85
    v_accvgpr_read_b32 v166, a86
    v_accvgpr_read_b32 v167, a87
    v_mul_f32 v160, v160, v230
    v_mul_f32 v161, v161, v230
    v_mul_f32 v162, v162, v230
    v_mul_f32 v163, v163, v230
    v_mul_f32 v164, v164, v230
    v_mul_f32 v165, v165, v230
    v_mul_f32 v166, v166, v230
    v_mul_f32 v167, v167, v230
    v_cvt_pk_bf16_f32 v184, v160, v161
    v_cvt_pk_bf16_f32 v185, v162, v163
    v_cvt_pk_bf16_f32 v186, v164, v165
    v_cvt_pk_bf16_f32 v187, v166, v167
    buffer_store_dwordx4 v[184:187], v240, s[20:23], s40 offen offset:2048 sc1
    v_accvgpr_read_b32 v168, a88
    v_accvgpr_read_b32 v169, a89
    v_accvgpr_read_b32 v170, a90
    v_accvgpr_read_b32 v171, a91
    v_accvgpr_read_b32 v172, a92
    v_accvgpr_read_b32 v173, a93
    v_accvgpr_read_b32 v174, a94
    v_accvgpr_read_b32 v175, a95
    v_mul_f32 v168, v168, v230
    v_mul_f32 v169, v169, v230
    v_mul_f32 v170, v170, v230
    v_mul_f32 v171, v171, v230
    v_mul_f32 v172, v172, v230
    v_mul_f32 v173, v173, v230
    v_mul_f32 v174, v174, v230
    v_mul_f32 v175, v175, v230
    v_cvt_pk_bf16_f32 v188, v168, v169
    v_cvt_pk_bf16_f32 v189, v170, v171
    v_cvt_pk_bf16_f32 v190, v172, v173
    v_cvt_pk_bf16_f32 v191, v174, v175
    buffer_store_dwordx4 v[188:191], v240, s[20:23], s40 offen offset:3072 sc1
    v_accvgpr_read_b32 v160, a96
    v_accvgpr_read_b32 v161, a97
    v_accvgpr_read_b32 v162, a98
    v_accvgpr_read_b32 v163, a99
    v_accvgpr_read_b32 v164, a100
    v_accvgpr_read_b32 v165, a101
    v_accvgpr_read_b32 v166, a102
    v_accvgpr_read_b32 v167, a103
    v_mul_f32 v160, v160, v231
    v_mul_f32 v161, v161, v231
    v_mul_f32 v162, v162, v231
    v_mul_f32 v163, v163, v231
    v_mul_f32 v164, v164, v231
    v_mul_f32 v165, v165, v231
    v_mul_f32 v166, v166, v231
    v_mul_f32 v167, v167, v231
    v_cvt_pk_bf16_f32 v176, v160, v161
    v_cvt_pk_bf16_f32 v177, v162, v163
    v_cvt_pk_bf16_f32 v178, v164, v165
    v_cvt_pk_bf16_f32 v179, v166, v167
    buffer_store_dwordx4 v[176:179], v244, s[20:23], s40 offen offset:0 sc1
    v_accvgpr_read_b32 v168, a104
    v_accvgpr_read_b32 v169, a105
    v_accvgpr_read_b32 v170, a106
    v_accvgpr_read_b32 v171, a107
    v_accvgpr_read_b32 v172, a108
    v_accvgpr_read_b32 v173, a109
    v_accvgpr_read_b32 v174, a110
    v_accvgpr_read_b32 v175, a111
    v_mul_f32 v168, v168, v231
    v_mul_f32 v169, v169, v231
    v_mul_f32 v170, v170, v231
    v_mul_f32 v171, v171, v231
    v_mul_f32 v172, v172, v231
    v_mul_f32 v173, v173, v231
    v_mul_f32 v174, v174, v231
    v_mul_f32 v175, v175, v231
    v_cvt_pk_bf16_f32 v180, v168, v169
    v_cvt_pk_bf16_f32 v181, v170, v171
    v_cvt_pk_bf16_f32 v182, v172, v173
    v_cvt_pk_bf16_f32 v183, v174, v175
    buffer_store_dwordx4 v[180:183], v244, s[20:23], s40 offen offset:1024 sc1
    v_accvgpr_read_b32 v160, a112
    v_accvgpr_read_b32 v161, a113
    v_accvgpr_read_b32 v162, a114
    v_accvgpr_read_b32 v163, a115
    v_accvgpr_read_b32 v164, a116
    v_accvgpr_read_b32 v165, a117
    v_accvgpr_read_b32 v166, a118
    v_accvgpr_read_b32 v167, a119
    v_mul_f32 v160, v160, v231
    v_mul_f32 v161, v161, v231
    v_mul_f32 v162, v162, v231
    v_mul_f32 v163, v163, v231
    v_mul_f32 v164, v164, v231
    v_mul_f32 v165, v165, v231
    v_mul_f32 v166, v166, v231
    v_mul_f32 v167, v167, v231
    v_cvt_pk_bf16_f32 v184, v160, v161
    v_cvt_pk_bf16_f32 v185, v162, v163
    v_cvt_pk_bf16_f32 v186, v164, v165
    v_cvt_pk_bf16_f32 v187, v166, v167
    buffer_store_dwordx4 v[184:187], v244, s[20:23], s40 offen offset:2048 sc1
    v_accvgpr_read_b32 v168, a120
    v_accvgpr_read_b32 v169, a121
    v_accvgpr_read_b32 v170, a122
    v_accvgpr_read_b32 v171, a123
    v_accvgpr_read_b32 v172, a124
    v_accvgpr_read_b32 v173, a125
    v_accvgpr_read_b32 v174, a126
    v_accvgpr_read_b32 v175, a127
    v_mul_f32 v168, v168, v231
    v_mul_f32 v169, v169, v231
    v_mul_f32 v170, v170, v231
    v_mul_f32 v171, v171, v231
    v_mul_f32 v172, v172, v231
    v_mul_f32 v173, v173, v231
    v_mul_f32 v174, v174, v231
    v_mul_f32 v175, v175, v231
    v_cvt_pk_bf16_f32 v188, v168, v169
    v_cvt_pk_bf16_f32 v189, v170, v171
    v_cvt_pk_bf16_f32 v190, v172, v173
    v_cvt_pk_bf16_f32 v191, v174, v175
    buffer_store_dwordx4 v[188:191], v244, s[20:23], s40 offen offset:3072 sc1
    s_branch ka_ok
kf_fix17:
    s_cmp_eq_u32 s33, 0
    s_cselect_b32 s24, 0, 0x74000000
    s_cselect_b32 s36, 0, 0x1000
    s_mov_b32 s33, 1
    v_subrev_f32 v230, s24, v243
    v_add_f32 v231, 0, v230
    v_min_f32 v64, v224, v231
    v_add_f32 v232, 0xf1800000, v230
    v_min_f32_e64 v65, v224, v232
    v_add_f32 v231, 0xf2000000, v230
    v_min_f32_e64 v66, v224, v231
    v_add_f32 v232, 0xf2400000, v230
    v_min_f32_e64 v67, v224, v232
    v_add_f32 v231, 0xf3000000, v230
    v_min_f32_e64 v68, v224, v231
    v_add_f32 v232, 0xf3100000, v230
    v_min_f32_e64 v69, v224, v232
    v_add_f32 v231, 0xf3200000, v230
    v_min_f32_e64 v70, v224, v231
    v_add_f32 v232, 0xf3300000, v230
    v_min_f32_e64 v71, v224, v232
    v_add_f32 v231, 0x73800000, v230
    v_min_f32_e64 v72, v225, v231
    v_add_f32 v232, 0x73700000, v230
    v_min_f32_e64 v73, v225, v232
    v_add_f32 v231, 0x73600000, v230
    v_min_f32_e64 v74, v225, v231
    v_add_f32 v232, 0x73500000, v230
    v_min_f32_e64 v75, v225, v232
    v_add_f32 v231, 0x73000000, v230
    v_min_f32_e64 v76, v225, v231
    v_add_f32 v232, 0x72e00000, v230
    v_min_f32_e64 v77, v225, v232
    v_add_f32 v231, 0x72c00000, v230
    v_min_f32_e64 v78, v225, v231
    v_add_f32 v232, 0x72a00000, v230
    v_min_f32 v79, v225, v232
    s_nop 1
    s_branch kf_fixr18
kf_fix19:
    s_cmp_eq_u32 s33, 0
    s_cselect_b32 s24, 0, 0x74000000
    s_cselect_b32 s36, 0, 0x1000
    s_mov_b32 s33, 1
    v_subrev_f32 v230, s24, v243
    v_add_f32 v231, 0, v230
    v_min_f32 v64, v224, v231
    v_add_f32 v232, 0xf1800000, v230
    v_min_f32_e64 v65, v224, v232
    v_add_f32 v231, 0xf2000000, v230
    v_min_f32_e64 v66, v224, v231
    v_add_f32 v232, 0xf2400000, v230
    v_min_f32_e64 v67, v224, v232
    v_add_f32 v231, 0xf3000000, v230
    v_min_f32_e64 v68, v224, v231
    v_add_f32 v232, 0xf3100000, v230
    v_min_f32_e64 v69, v224, v232
    v_add_f32 v231, 0xf3200000, v230
    v_min_f32_e64 v70, v224, v231
    v_add_f32 v232, 0xf3300000, v230
    v_min_f32_e64 v71, v224, v232
    v_add_f32 v231, 0x73800000, v230
    v_min_f32_e64 v72, v225, v231
    v_add_f32 v232, 0x73700000, v230
    v_min_f32_e64 v73, v225, v232
    v_add_f32 v231, 0x73600000, v230
    v_min_f32_e64 v74, v225, v231
    v_add_f32 v232, 0x73500000, v230
    v_min_f32_e64 v75, v225, v232
    v_add_f32 v231, 0x73000000, v230
    v_min_f32_e64 v76, v225, v231
    v_add_f32 v232, 0x72e00000, v230
    v_min_f32_e64 v77, v225, v232
    v_add_f32 v231, 0x72c00000, v230
    v_min_f32_e64 v78, v225, v231
    v_add_f32 v232, 0x72a00000, v230
    v_min_f32 v79, v225, v232
    s_nop 1
    s_branch kf_fixr20
kf_rare22:
    s_nop 15
    v_max3_f32 v230, v32, v33, v34
    v_max3_f32 v230, v230, v35, v36
    v_max3_f32 v230, v230, v37, v38
    v_max_f32 v230, v230, v39
    v_mov_b32 v231, v230
    s_nop 1
    v_permlane16_swap_b32 v230, v231
    s_nop 0
    v_max_f32 v230, v230, v231
    v_mov_b32 v231, v230
    s_nop 1
    v_permlane32_swap_b32 v230, v231
    s_nop 0
    v_max_f32_e64 v230, v230, v231
    v_add_f32 v230, 0x41800000, v230
    v_max_f32 v230, 0, v230
    v_sub_f32 v232, 0, v230
    v_exp_f32 v232, v232
    v_sub_f32 v224, v224, v230
    v_sub_f32 v64, v64, v230
    v_sub_f32 v0, v0, v230
    v_sub_f32 v32, v32, v230
    v_sub_f32 v65, v65, v230
    v_sub_f32 v1, v1, v230
    v_sub_f32 v33, v33, v230
    v_sub_f32 v66, v66, v230
    v_sub_f32 v2, v2, v230
    v_sub_f32 v34, v34, v230
    v_sub_f32 v67, v67, v230
    v_sub_f32 v3, v3, v230
    v_sub_f32 v35, v35, v230
    v_sub_f32 v68, v68, v230
    v_sub_f32 v4, v4, v230
    v_sub_f32 v36, v36, v230
    v_sub_f32 v69, v69, v230
    v_sub_f32 v5, v5, v230
    v_sub_f32 v37, v37, v230
    v_sub_f32 v70, v70, v230
    v_sub_f32 v6, v6, v230
    v_sub_f32 v38, v38, v230
    v_sub_f32 v71, v71, v230
    v_sub_f32 v7, v7, v230
    v_sub_f32 v39, v39, v230
    v_mul_f32 v144, v144, v232
    v_mul_f32 v145, v145, v232
    v_mul_f32 v146, v146, v232
    v_mul_f32 v147, v147, v232
    v_accvgpr_read_b32 v233, a0
    v_mul_f32_e64 v233, v233, v232
    v_accvgpr_write_b32 a0, v233
    v_accvgpr_read_b32 v234, a1
    v_mul_f32_e64 v234, v234, v232
    v_accvgpr_write_b32 a1, v234
    v_accvgpr_read_b32 v235, a2
    v_mul_f32_e64 v235, v235, v232
    v_accvgpr_write_b32 a2, v235
    v_accvgpr_read_b32 v236, a3
    v_mul_f32_e64 v236, v236, v232
    v_accvgpr_write_b32 a3, v236
    v_accvgpr_read_b32 v233, a4
    v_mul_f32_e64 v233, v233, v232
    v_accvgpr_write_b32 a4, v233
    v_accvgpr_read_b32 v234, a5
    v_mul_f32_e64 v234, v234, v232
    v_accvgpr_write_b32 a5, v234
    v_accvgpr_read_b32 v235, a6
    v_mul_f32_e64 v235, v235, v232
    v_accvgpr_write_b32 a6, v235
    v_accvgpr_read_b32 v236, a7
    v_mul_f32_e64 v236, v236, v232
    v_accvgpr_write_b32 a7, v236
    v_accvgpr_read_b32 v233, a8
    v_mul_f32_e64 v233, v233, v232
    v_accvgpr_write_b32 a8, v233
    v_accvgpr_read_b32 v234, a9
    v_mul_f32_e64 v234, v234, v232
    v_accvgpr_write_b32 a9, v234
    v_accvgpr_read_b32 v235, a10
    v_mul_f32_e64 v235, v235, v232
    v_accvgpr_write_b32 a10, v235
    v_accvgpr_read_b32 v236, a11
    v_mul_f32_e64 v236, v236, v232
    v_accvgpr_write_b32 a11, v236
    v_accvgpr_read_b32 v233, a12
    v_mul_f32_e64 v233, v233, v232
    v_accvgpr_write_b32 a12, v233
    v_accvgpr_read_b32 v234, a13
    v_mul_f32_e64 v234, v234, v232
    v_accvgpr_write_b32 a13, v234
    v_accvgpr_read_b32 v235, a14
    v_mul_f32_e64 v235, v235, v232
    v_accvgpr_write_b32 a14, v235
    v_accvgpr_read_b32 v236, a15
    v_mul_f32_e64 v236, v236, v232
    v_accvgpr_write_b32 a15, v236
    v_accvgpr_read_b32 v233, a16
    v_mul_f32_e64 v233, v233, v232
    v_accvgpr_write_b32 a16, v233
    v_accvgpr_read_b32 v234, a17
    v_mul_f32_e64 v234, v234, v232
    v_accvgpr_write_b32 a17, v234
    v_accvgpr_read_b32 v235, a18
    v_mul_f32_e64 v235, v235, v232
    v_accvgpr_write_b32 a18, v235
    v_accvgpr_read_b32 v236, a19
    v_mul_f32_e64 v236, v236, v232
    v_accvgpr_write_b32 a19, v236
    v_accvgpr_read_b32 v233, a20
    v_mul_f32_e64 v233, v233, v232
    v_accvgpr_write_b32 a20, v233
    v_accvgpr_read_b32 v234, a21
    v_mul_f32_e64 v234, v234, v232
    v_accvgpr_write_b32 a21, v234
    v_accvgpr_read_b32 v235, a22
    v_mul_f32_e64 v235, v235, v232
    v_accvgpr_write_b32 a22, v235
    v_accvgpr_read_b32 v236, a23
    v_mul_f32_e64 v236, v236, v232
    v_accvgpr_write_b32 a23, v236
    v_accvgpr_read_b32 v233, a24
    v_mul_f32_e64 v233, v233, v232
    v_accvgpr_write_b32 a24, v233
    v_accvgpr_read_b32 v234, a25
    v_mul_f32_e64 v234, v234, v232
    v_accvgpr_write_b32 a25, v234
    v_accvgpr_read_b32 v235, a26
    v_mul_f32_e64 v235, v235, v232
    v_accvgpr_write_b32 a26, v235
    v_accvgpr_read_b32 v236, a27
    v_mul_f32_e64 v236, v236, v232
    v_accvgpr_write_b32 a27, v236
    v_accvgpr_read_b32 v233, a28
    v_mul_f32_e64 v233, v233, v232
    v_accvgpr_write_b32 a28, v233
    v_accvgpr_read_b32 v234, a29
    v_mul_f32_e64 v234, v234, v232
    v_accvgpr_write_b32 a29, v234
    v_accvgpr_read_b32 v235, a30
    v_mul_f32_e64 v235, v235, v232
    v_accvgpr_write_b32 a30, v235
    v_accvgpr_read_b32 v236, a31
    v_mul_f32_e64 v236, v236, v232
    v_accvgpr_write_b32 a31, v236
    v_exp_f32 v128, v32
    v_exp_f32 v129, v33
    v_exp_f32 v130, v34
    v_exp_f32 v131, v35
    v_exp_f32 v132, v36
    v_exp_f32 v133, v37
    v_exp_f32 v134, v38
    v_exp_f32_e64 v135, v39
    s_nop 0
    v_cvt_pk_bf16_f32 v112, v128, v129
    v_cvt_pk_bf16_f32 v113, v130, v131
    v_cvt_pk_bf16_f32 v114, v132, v133
    v_cvt_pk_bf16_f32 v115, v134, v135
    v_max3_f32 v230, v40, v41, v42
    v_max3_f32 v230, v230, v43, v44
    v_max3_f32 v230, v230, v45, v46
    v_max_f32 v230, v230, v47
    v_mov_b32 v231, v230
    s_nop 1
    v_permlane16_swap_b32 v230, v231
    s_nop 0
    v_max_f32 v230, v230, v231
    v_mov_b32 v231, v230
    s_nop 1
    v_permlane32_swap_b32 v230, v231
    s_nop 0
    v_max_f32_e64 v230, v230, v231
    v_add_f32 v230, 0x41800000, v230
    v_max_f32 v230, 0, v230
    v_sub_f32 v232, 0, v230
    v_exp_f32 v232, v232
    v_sub_f32 v225, v225, v230
    v_sub_f32 v72, v72, v230
    v_sub_f32 v8, v8, v230
    v_sub_f32 v40, v40, v230
    v_sub_f32 v73, v73, v230
    v_sub_f32 v9, v9, v230
    v_sub_f32 v41, v41, v230
    v_sub_f32 v74, v74, v230
    v_sub_f32 v10, v10, v230
    v_sub_f32 v42, v42, v230
    v_sub_f32 v75, v75, v230
    v_sub_f32 v11, v11, v230
    v_sub_f32 v43, v43, v230
    v_sub_f32 v76, v76, v230
    v_sub_f32 v12, v12, v230
    v_sub_f32 v44, v44, v230
    v_sub_f32 v77, v77, v230
    v_sub_f32 v13, v13, v230
    v_sub_f32 v45, v45, v230
    v_sub_f32 v78, v78, v230
    v_sub_f32 v14, v14, v230
    v_sub_f32 v46, v46, v230
    v_sub_f32 v79, v79, v230
    v_sub_f32 v15, v15, v230
    v_sub_f32 v47, v47, v230
    v_mul_f32 v148, v148, v232
    v_mul_f32 v149, v149, v232
    v_mul_f32 v150, v150, v232
    v_mul_f32 v151, v151, v232
    v_accvgpr_read_b32 v233, a32
    v_mul_f32_e64 v233, v233, v232
    v_accvgpr_write_b32 a32, v233
    v_accvgpr_read_b32 v234, a33
    v_mul_f32_e64 v234, v234, v232
    v_accvgpr_write_b32 a33, v234
    v_accvgpr_read_b32 v235, a34
    v_mul_f32_e64 v235, v235, v232
    v_accvgpr_write_b32 a34, v235
    v_accvgpr_read_b32 v236, a35
    v_mul_f32_e64 v236, v236, v232
    v_accvgpr_write_b32 a35, v236
    v_accvgpr_read_b32 v233, a36
    v_mul_f32_e64 v233, v233, v232
    v_accvgpr_write_b32 a36, v233
    v_accvgpr_read_b32 v234, a37
    v_mul_f32_e64 v234, v234, v232
    v_accvgpr_write_b32 a37, v234
    v_accvgpr_read_b32 v235, a38
    v_mul_f32_e64 v235, v235, v232
    v_accvgpr_write_b32 a38, v235
    v_accvgpr_read_b32 v236, a39
    v_mul_f32_e64 v236, v236, v232
    v_accvgpr_write_b32 a39, v236
    v_accvgpr_read_b32 v233, a40
    v_mul_f32_e64 v233, v233, v232
    v_accvgpr_write_b32 a40, v233
    v_accvgpr_read_b32 v234, a41
    v_mul_f32_e64 v234, v234, v232
    v_accvgpr_write_b32 a41, v234
    v_accvgpr_read_b32 v235, a42
    v_mul_f32_e64 v235, v235, v232
    v_accvgpr_write_b32 a42, v235
    v_accvgpr_read_b32 v236, a43
    v_mul_f32_e64 v236, v236, v232
    v_accvgpr_write_b32 a43, v236
    v_accvgpr_read_b32 v233, a44
    v_mul_f32_e64 v233, v233, v232
    v_accvgpr_write_b32 a44, v233
    v_accvgpr_read_b32 v234, a45
    v_mul_f32_e64 v234, v234, v232
    v_accvgpr_write_b32 a45, v234
    v_accvgpr_read_b32 v235, a46
    v_mul_f32_e64 v235, v235, v232
    v_accvgpr_write_b32 a46, v235
    v_accvgpr_read_b32 v236, a47
    v_mul_f32_e64 v236, v236, v232
    v_accvgpr_write_b32 a47, v236
    v_accvgpr_read_b32 v233, a48
    v_mul_f32_e64 v233, v233, v232
    v_accvgpr_write_b32 a48, v233
    v_accvgpr_read_b32 v234, a49
    v_mul_f32_e64 v234, v234, v232
    v_accvgpr_write_b32 a49, v234
    v_accvgpr_read_b32 v235, a50
    v_mul_f32_e64 v235, v235, v232
    v_accvgpr_write_b32 a50, v235
    v_accvgpr_read_b32 v236, a51
    v_mul_f32_e64 v236, v236, v232
    v_accvgpr_write_b32 a51, v236
    v_accvgpr_read_b32 v233, a52
    v_mul_f32_e64 v233, v233, v232
    v_accvgpr_write_b32 a52, v233
    v_accvgpr_read_b32 v234, a53
    v_mul_f32_e64 v234, v234, v232
    v_accvgpr_write_b32 a53, v234
    v_accvgpr_read_b32 v235, a54
    v_mul_f32_e64 v235, v235, v232
    v_accvgpr_write_b32 a54, v235
    v_accvgpr_read_b32 v236, a55
    v_mul_f32_e64 v236, v236, v232
    v_accvgpr_write_b32 a55, v236
    v_accvgpr_read_b32 v233, a56
    v_mul_f32_e64 v233, v233, v232
    v_accvgpr_write_b32 a56, v233
    v_accvgpr_read_b32 v234, a57
    v_mul_f32_e64 v234, v234, v232
    v_accvgpr_write_b32 a57, v234
    v_accvgpr_read_b32 v235, a58
    v_mul_f32_e64 v235, v235, v232
    v_accvgpr_write_b32 a58, v235
    v_accvgpr_read_b32 v236, a59
    v_mul_f32_e64 v236, v236, v232
    v_accvgpr_write_b32 a59, v236
    v_accvgpr_read_b32 v233, a60
    v_mul_f32_e64 v233, v233, v232
    v_accvgpr_write_b32 a60, v233
    v_accvgpr_read_b32 v234, a61
    v_mul_f32_e64 v234, v234, v232
    v_accvgpr_write_b32 a61, v234
    v_accvgpr_read_b32 v235, a62
    v_mul_f32_e64 v235, v235, v232
    v_accvgpr_write_b32 a62, v235
    v_accvgpr_read_b32 v236, a63
    v_mul_f32_e64 v236, v236, v232
    v_accvgpr_write_b32 a63, v236
    v_exp_f32 v128, v40
    v_exp_f32 v129, v41
    v_exp_f32 v130, v42
    v_exp_f32 v131, v43
    v_exp_f32 v132, v44
    v_exp_f32 v133, v45
    v_exp_f32 v134, v46
    v_exp_f32_e64 v135, v47
    s_nop 0
    v_cvt_pk_bf16_f32 v116, v128, v129
    v_cvt_pk_bf16_f32 v117, v130, v131
    v_cvt_pk_bf16_f32 v118, v132, v133
    v_cvt_pk_bf16_f32 v119, v134, v135
    v_max3_f32 v230, v48, v49, v50
    v_max3_f32 v230, v230, v51, v52
    v_max3_f32 v230, v230, v53, v54
    v_max_f32 v230, v230, v55
    v_mov_b32 v231, v230
    s_nop 1
    v_permlane16_swap_b32 v230, v231
    s_nop 0
    v_max_f32 v230, v230, v231
    v_mov_b32 v231, v230
    s_nop 1
    v_permlane32_swap_b32 v230, v231
    s_nop 0
    v_max_f32_e64 v230, v230, v231
    v_add_f32 v230, 0x41800000, v230
    v_max_f32 v230, 0, v230
    v_sub_f32 v232, 0, v230
    v_exp_f32 v232, v232
    v_sub_f32 v226, v226, v230
    v_sub_f32 v80, v80, v230
    v_sub_f32 v16, v16, v230
    v_sub_f32 v48, v48, v230
    v_sub_f32 v81, v81, v230
    v_sub_f32 v17, v17, v230
    v_sub_f32 v49, v49, v230
    v_sub_f32 v82, v82, v230
    v_sub_f32 v18, v18, v230
    v_sub_f32 v50, v50, v230
    v_sub_f32 v83, v83, v230
    v_sub_f32 v19, v19, v230
    v_sub_f32 v51, v51, v230
    v_sub_f32 v84, v84, v230
    v_sub_f32 v20, v20, v230
    v_sub_f32 v52, v52, v230
    v_sub_f32 v85, v85, v230
    v_sub_f32 v21, v21, v230
    v_sub_f32 v53, v53, v230
    v_sub_f32 v86, v86, v230
    v_sub_f32 v22, v22, v230
    v_sub_f32 v54, v54, v230
    v_sub_f32 v87, v87, v230
    v_sub_f32 v23, v23, v230
    v_sub_f32 v55, v55, v230
    v_mul_f32 v152, v152, v232
    v_mul_f32 v153, v153, v232
    v_mul_f32 v154, v154, v232
    v_mul_f32 v155, v155, v232
    v_accvgpr_read_b32 v233, a64
    v_mul_f32_e64 v233, v233, v232
    v_accvgpr_write_b32 a64, v233
    v_accvgpr_read_b32 v234, a65
    v_mul_f32_e64 v234, v234, v232
    v_accvgpr_write_b32 a65, v234
    v_accvgpr_read_b32 v235, a66
    v_mul_f32_e64 v235, v235, v232
    v_accvgpr_write_b32 a66, v235
    v_accvgpr_read_b32 v236, a67
    v_mul_f32_e64 v236, v236, v232
    v_accvgpr_write_b32 a67, v236
    v_accvgpr_read_b32 v233, a68
    v_mul_f32_e64 v233, v233, v232
    v_accvgpr_write_b32 a68, v233
    v_accvgpr_read_b32 v234, a69
    v_mul_f32_e64 v234, v234, v232
    v_accvgpr_write_b32 a69, v234
    v_accvgpr_read_b32 v235, a70
    v_mul_f32_e64 v235, v235, v232
    v_accvgpr_write_b32 a70, v235
    v_accvgpr_read_b32 v236, a71
    v_mul_f32_e64 v236, v236, v232
    v_accvgpr_write_b32 a71, v236
    v_accvgpr_read_b32 v233, a72
    v_mul_f32_e64 v233, v233, v232
    v_accvgpr_write_b32 a72, v233
    v_accvgpr_read_b32 v234, a73
    v_mul_f32_e64 v234, v234, v232
    v_accvgpr_write_b32 a73, v234
    v_accvgpr_read_b32 v235, a74
    v_mul_f32_e64 v235, v235, v232
    v_accvgpr_write_b32 a74, v235
    v_accvgpr_read_b32 v236, a75
    v_mul_f32_e64 v236, v236, v232
    v_accvgpr_write_b32 a75, v236
    v_accvgpr_read_b32 v233, a76
    v_mul_f32_e64 v233, v233, v232
    v_accvgpr_write_b32 a76, v233
    v_accvgpr_read_b32 v234, a77
    v_mul_f32_e64 v234, v234, v232
    v_accvgpr_write_b32 a77, v234
    v_accvgpr_read_b32 v235, a78
    v_mul_f32_e64 v235, v235, v232
    v_accvgpr_write_b32 a78, v235
    v_accvgpr_read_b32 v236, a79
    v_mul_f32_e64 v236, v236, v232
    v_accvgpr_write_b32 a79, v236
    v_accvgpr_read_b32 v233, a80
    v_mul_f32_e64 v233, v233, v232
    v_accvgpr_write_b32 a80, v233
    v_accvgpr_read_b32 v234, a81
    v_mul_f32_e64 v234, v234, v232
    v_accvgpr_write_b32 a81, v234
    v_accvgpr_read_b32 v235, a82
    v_mul_f32_e64 v235, v235, v232
    v_accvgpr_write_b32 a82, v235
    v_accvgpr_read_b32 v236, a83
    v_mul_f32_e64 v236, v236, v232
    v_accvgpr_write_b32 a83, v236
    v_accvgpr_read_b32 v233, a84
    v_mul_f32_e64 v233, v233, v232
    v_accvgpr_write_b32 a84, v233
    v_accvgpr_read_b32 v234, a85
    v_mul_f32_e64 v234, v234, v232
    v_accvgpr_write_b32 a85, v234
    v_accvgpr_read_b32 v235, a86
    v_mul_f32_e64 v235, v235, v232
    v_accvgpr_write_b32 a86, v235
    v_accvgpr_read_b32 v236, a87
    v_mul_f32_e64 v236, v236, v232
    v_accvgpr_write_b32 a87, v236
    v_accvgpr_read_b32 v233, a88
    v_mul_f32_e64 v233, v233, v232
    v_accvgpr_write_b32 a88, v233
    v_accvgpr_read_b32 v234, a89
    v_mul_f32_e64 v234, v234, v232
    v_accvgpr_write_b32 a89, v234
    v_accvgpr_read_b32 v235, a90
    v_mul_f32_e64 v235, v235, v232
    v_accvgpr_write_b32 a90, v235
    v_accvgpr_read_b32 v236, a91
    v_mul_f32_e64 v236, v236, v232
    v_accvgpr_write_b32 a91, v236
    v_accvgpr_read_b32 v233, a92
    v_mul_f32_e64 v233, v233, v232
    v_accvgpr_write_b32 a92, v233
    v_accvgpr_read_b32 v234, a93
    v_mul_f32_e64 v234, v234, v232
    v_accvgpr_write_b32 a93, v234
    v_accvgpr_read_b32 v235, a94
    v_mul_f32_e64 v235, v235, v232
    v_accvgpr_write_b32 a94, v235
    v_accvgpr_read_b32 v236, a95
    v_mul_f32_e64 v236, v236, v232
    v_accvgpr_write_b32 a95, v236
    v_exp_f32 v128, v48
    v_exp_f32 v129, v49
    v_exp_f32 v130, v50
    v_exp_f32 v131, v51
    v_exp_f32 v132, v52
    v_exp_f32 v133, v53
    v_exp_f32 v134, v54
    v_exp_f32_e64 v135, v55
    s_nop 0
    v_cvt_pk_bf16_f32 v120, v128, v129
    v_cvt_pk_bf16_f32 v121, v130, v131
    v_cvt_pk_bf16_f32 v122, v132, v133
    v_cvt_pk_bf16_f32 v123, v134, v135
    v_max3_f32 v230, v56, v57, v58
    v_max3_f32 v230, v230, v59, v60
    v_max3_f32 v230, v230, v61, v62
    v_max_f32 v230, v230, v63
    v_mov_b32 v231, v230
    s_nop 1
    v_permlane16_swap_b32 v230, v231
    s_nop 0
    v_max_f32 v230, v230, v231
    v_mov_b32 v231, v230
    s_nop 1
    v_permlane32_swap_b32 v230, v231
    s_nop 0
    v_max_f32_e64 v230, v230, v231
    v_add_f32 v230, 0x41800000, v230
    v_max_f32 v230, 0, v230
    v_sub_f32 v232, 0, v230
    v_exp_f32 v232, v232
    v_sub_f32 v227, v227, v230
    v_sub_f32 v88, v88, v230
    v_sub_f32 v24, v24, v230
    v_sub_f32 v56, v56, v230
    v_sub_f32 v89, v89, v230
    v_sub_f32 v25, v25, v230
    v_sub_f32 v57, v57, v230
    v_sub_f32 v90, v90, v230
    v_sub_f32 v26, v26, v230
    v_sub_f32 v58, v58, v230
    v_sub_f32 v91, v91, v230
    v_sub_f32 v27, v27, v230
    v_sub_f32 v59, v59, v230
    v_sub_f32 v92, v92, v230
    v_sub_f32 v28, v28, v230
    v_sub_f32 v60, v60, v230
    v_sub_f32 v93, v93, v230
    v_sub_f32 v29, v29, v230
    v_sub_f32 v61, v61, v230
    v_sub_f32 v94, v94, v230
    v_sub_f32 v30, v30, v230
    v_sub_f32 v62, v62, v230
    v_sub_f32 v95, v95, v230
    v_sub_f32 v31, v31, v230
    v_sub_f32 v63, v63, v230
    v_mul_f32 v156, v156, v232
    v_mul_f32 v157, v157, v232
    v_mul_f32 v158, v158, v232
    v_mul_f32 v159, v159, v232
    v_accvgpr_read_b32 v233, a96
    v_mul_f32_e64 v233, v233, v232
    v_accvgpr_write_b32 a96, v233
    v_accvgpr_read_b32 v234, a97
    v_mul_f32_e64 v234, v234, v232
    v_accvgpr_write_b32 a97, v234
    v_accvgpr_read_b32 v235, a98
    v_mul_f32_e64 v235, v235, v232
    v_accvgpr_write_b32 a98, v235
    v_accvgpr_read_b32 v236, a99
    v_mul_f32_e64 v236, v236, v232
    v_accvgpr_write_b32 a99, v236
    v_accvgpr_read_b32 v233, a100
    v_mul_f32_e64 v233, v233, v232
    v_accvgpr_write_b32 a100, v233
    v_accvgpr_read_b32 v234, a101
    v_mul_f32_e64 v234, v234, v232
    v_accvgpr_write_b32 a101, v234
    v_accvgpr_read_b32 v235, a102
    v_mul_f32_e64 v235, v235, v232
    v_accvgpr_write_b32 a102, v235
    v_accvgpr_read_b32 v236, a103
    v_mul_f32_e64 v236, v236, v232
    v_accvgpr_write_b32 a103, v236
    v_accvgpr_read_b32 v233, a104
    v_mul_f32_e64 v233, v233, v232
    v_accvgpr_write_b32 a104, v233
    v_accvgpr_read_b32 v234, a105
    v_mul_f32_e64 v234, v234, v232
    v_accvgpr_write_b32 a105, v234
    v_accvgpr_read_b32 v235, a106
    v_mul_f32_e64 v235, v235, v232
    v_accvgpr_write_b32 a106, v235
    v_accvgpr_read_b32 v236, a107
    v_mul_f32_e64 v236, v236, v232
    v_accvgpr_write_b32 a107, v236
    v_accvgpr_read_b32 v233, a108
    v_mul_f32_e64 v233, v233, v232
    v_accvgpr_write_b32 a108, v233
    v_accvgpr_read_b32 v234, a109
    v_mul_f32_e64 v234, v234, v232
    v_accvgpr_write_b32 a109, v234
    v_accvgpr_read_b32 v235, a110
    v_mul_f32_e64 v235, v235, v232
    v_accvgpr_write_b32 a110, v235
    v_accvgpr_read_b32 v236, a111
    v_mul_f32_e64 v236, v236, v232
    v_accvgpr_write_b32 a111, v236
    v_accvgpr_read_b32 v233, a112
    v_mul_f32_e64 v233, v233, v232
    v_accvgpr_write_b32 a112, v233
    v_accvgpr_read_b32 v234, a113
    v_mul_f32_e64 v234, v234, v232
    v_accvgpr_write_b32 a113, v234
    v_accvgpr_read_b32 v235, a114
    v_mul_f32_e64 v235, v235, v232
    v_accvgpr_write_b32 a114, v235
    v_accvgpr_read_b32 v236, a115
    v_mul_f32_e64 v236, v236, v232
    v_accvgpr_write_b32 a115, v236
    v_accvgpr_read_b32 v233, a116
    v_mul_f32_e64 v233, v233, v232
    v_accvgpr_write_b32 a116, v233
    v_accvgpr_read_b32 v234, a117
    v_mul_f32_e64 v234, v234, v232
    v_accvgpr_write_b32 a117, v234
    v_accvgpr_read_b32 v235, a118
    v_mul_f32_e64 v235, v235, v232
    v_accvgpr_write_b32 a118, v235
    v_accvgpr_read_b32 v236, a119
    v_mul_f32_e64 v236, v236, v232
    v_accvgpr_write_b32 a119, v236
    v_accvgpr_read_b32 v233, a120
    v_mul_f32_e64 v233, v233, v232
    v_accvgpr_write_b32 a120, v233
    v_accvgpr_read_b32 v234, a121
    v_mul_f32_e64 v234, v234, v232
    v_accvgpr_write_b32 a121, v234
    v_accvgpr_read_b32 v235, a122
    v_mul_f32_e64 v235, v235, v232
    v_accvgpr_write_b32 a122, v235
    v_accvgpr_read_b32 v236, a123
    v_mul_f32_e64 v236, v236, v232
    v_accvgpr_write_b32 a123, v236
    v_accvgpr_read_b32 v233, a124
    v_mul_f32_e64 v233, v233, v232
    v_accvgpr_write_b32 a124, v233
    v_accvgpr_read_b32 v234, a125
    v_mul_f32_e64 v234, v234, v232
    v_accvgpr_write_b32 a125, v234
    v_accvgpr_read_b32 v235, a126
    v_mul_f32_e64 v235, v235, v232
    v_accvgpr_write_b32 a126, v235
    v_accvgpr_read_b32 v236, a127
    v_mul_f32_e64 v236, v236, v232
    v_accvgpr_write_b32 a127, v236
    v_exp_f32 v128, v56
    v_exp_f32 v129, v57
    v_exp_f32 v130, v58
    v_exp_f32 v131, v59
    v_exp_f32 v132, v60
    v_exp_f32 v133, v61
    v_exp_f32 v134, v62
    v_exp_f32_e64 v135, v63
    s_nop 0
    v_cvt_pk_bf16_f32 v124, v128, v129
    v_cvt_pk_bf16_f32 v125, v130, v131
    v_cvt_pk_bf16_f32 v126, v132, v133
    v_cvt_pk_bf16_f32 v127, v134, v135
    s_nop 1
    s_branch kf_rr21
kf_rare26:
    s_nop 15
    v_max3_f32 v230, v0, v1, v2
    v_max3_f32 v230, v230, v3, v4
    v_max3_f32 v230, v230, v5, v6
    v_max_f32 v230, v230, v7
    v_mov_b32 v231, v230
    s_nop 1
    v_permlane16_swap_b32 v230, v231
    s_nop 0
    v_max_f32 v230, v230, v231
    v_mov_b32 v231, v230
    s_nop 1
    v_permlane32_swap_b32 v230, v231
    s_nop 0
    v_max_f32 v230, v230, v231
    v_add_f32 v230, 0x41800000, v230
    v_max_f32 v230, 0, v230
    v_sub_f32 v232, 0, v230
    v_exp_f32 v232, v232
    v_sub_f32 v224, v224, v230
    v_sub_f32 v64, v64, v230
    v_sub_f32 v32, v32, v230
    v_sub_f32 v0, v0, v230
    v_sub_f32 v65, v65, v230
    v_sub_f32 v33, v33, v230
    v_sub_f32 v1, v1, v230
    v_sub_f32 v66, v66, v230
    v_sub_f32 v34, v34, v230
    v_sub_f32 v2, v2, v230
    v_sub_f32 v67, v67, v230
    v_sub_f32 v35, v35, v230
    v_sub_f32 v3, v3, v230
    v_sub_f32 v68, v68, v230
    v_sub_f32 v36, v36, v230
    v_sub_f32 v4, v4, v230
    v_sub_f32 v69, v69, v230
    v_sub_f32 v37, v37, v230
    v_sub_f32 v5, v5, v230
    v_sub_f32 v70, v70, v230
    v_sub_f32 v38, v38, v230
    v_sub_f32 v6, v6, v230
    v_sub_f32 v71, v71, v230
    v_sub_f32 v39, v39, v230
    v_sub_f32 v7, v7, v230
    v_mul_f32 v144, v144, v232
    v_mul_f32 v145, v145, v232
    v_mul_f32 v146, v146, v232
    v_mul_f32 v147, v147, v232
    v_accvgpr_read_b32 v233, a0
    v_mul_f32_e64 v233, v233, v232
    v_accvgpr_write_b32 a0, v233
    v_accvgpr_read_b32 v234, a1
    v_mul_f32_e64 v234, v234, v232
    v_accvgpr_write_b32 a1, v234
    v_accvgpr_read_b32 v235, a2
    v_mul_f32_e64 v235, v235, v232
    v_accvgpr_write_b32 a2, v235
    v_accvgpr_read_b32 v236, a3
    v_mul_f32_e64 v236, v236, v232
    v_accvgpr_write_b32 a3, v236
    v_accvgpr_read_b32 v233, a4
    v_mul_f32_e64 v233, v233, v232
    v_accvgpr_write_b32 a4, v233
    v_accvgpr_read_b32 v234, a5
    v_mul_f32_e64 v234, v234, v232
    v_accvgpr_write_b32 a5, v234
    v_accvgpr_read_b32 v235, a6
    v_mul_f32_e64 v235, v235, v232
    v_accvgpr_write_b32 a6, v235
    v_accvgpr_read_b32 v236, a7
    v_mul_f32_e64 v236, v236, v232
    v_accvgpr_write_b32 a7, v236
    v_accvgpr_read_b32 v233, a8
    v_mul_f32_e64 v233, v233, v232
    v_accvgpr_write_b32 a8, v233
    v_accvgpr_read_b32 v234, a9
    v_mul_f32_e64 v234, v234, v232
    v_accvgpr_write_b32 a9, v234
    v_accvgpr_read_b32 v235, a10
    v_mul_f32_e64 v235, v235, v232
    v_accvgpr_write_b32 a10, v235
    v_accvgpr_read_b32 v236, a11
    v_mul_f32_e64 v236, v236, v232
    v_accvgpr_write_b32 a11, v236
    v_accvgpr_read_b32 v233, a12
    v_mul_f32_e64 v233, v233, v232
    v_accvgpr_write_b32 a12, v233
    v_accvgpr_read_b32 v234, a13
    v_mul_f32_e64 v234, v234, v232
    v_accvgpr_write_b32 a13, v234
    v_accvgpr_read_b32 v235, a14
    v_mul_f32_e64 v235, v235, v232
    v_accvgpr_write_b32 a14, v235
    v_accvgpr_read_b32 v236, a15
    v_mul_f32_e64 v236, v236, v232
    v_accvgpr_write_b32 a15, v236
    v_accvgpr_read_b32 v233, a16
    v_mul_f32_e64 v233, v233, v232
    v_accvgpr_write_b32 a16, v233
    v_accvgpr_read_b32 v234, a17
    v_mul_f32_e64 v234, v234, v232
    v_accvgpr_write_b32 a17, v234
    v_accvgpr_read_b32 v235, a18
    v_mul_f32_e64 v235, v235, v232
    v_accvgpr_write_b32 a18, v235
    v_accvgpr_read_b32 v236, a19
    v_mul_f32_e64 v236, v236, v232
    v_accvgpr_write_b32 a19, v236
    v_accvgpr_read_b32 v233, a20
    v_mul_f32_e64 v233, v233, v232
    v_accvgpr_write_b32 a20, v233
    v_accvgpr_read_b32 v234, a21
    v_mul_f32_e64 v234, v234, v232
    v_accvgpr_write_b32 a21, v234
    v_accvgpr_read_b32 v235, a22
    v_mul_f32_e64 v235, v235, v232
    v_accvgpr_write_b32 a22, v235
    v_accvgpr_read_b32 v236, a23
    v_mul_f32_e64 v236, v236, v232
    v_accvgpr_write_b32 a23, v236
    v_accvgpr_read_b32 v233, a24
    v_mul_f32_e64 v233, v233, v232
    v_accvgpr_write_b32 a24, v233
    v_accvgpr_read_b32 v234, a25
    v_mul_f32_e64 v234, v234, v232
    v_accvgpr_write_b32 a25, v234
    v_accvgpr_read_b32 v235, a26
    v_mul_f32_e64 v235, v235, v232
    v_accvgpr_write_b32 a26, v235
    v_accvgpr_read_b32 v236, a27
    v_mul_f32_e64 v236, v236, v232
    v_accvgpr_write_b32 a27, v236
    v_accvgpr_read_b32 v233, a28
    v_mul_f32_e64 v233, v233, v232
    v_accvgpr_write_b32 a28, v233
    v_accvgpr_read_b32 v234, a29
    v_mul_f32_e64 v234, v234, v232
    v_accvgpr_write_b32 a29, v234
    v_accvgpr_read_b32 v235, a30
    v_mul_f32_e64 v235, v235, v232
    v_accvgpr_write_b32 a30, v235
    v_accvgpr_read_b32 v236, a31
    v_mul_f32_e64 v236, v236, v232
    v_accvgpr_write_b32 a31, v236
    v_exp_f32 v128, v0
    v_exp_f32 v129, v1
    v_exp_f32 v130, v2
    v_exp_f32 v131, v3
    v_exp_f32 v132, v4
    v_exp_f32 v133, v5
    v_exp_f32 v134, v6
    v_exp_f32_e64 v135, v7
    s_nop 0
    v_cvt_pk_bf16_f32 v96, v128, v129
    v_cvt_pk_bf16_f32 v97, v130, v131
    v_cvt_pk_bf16_f32 v98, v132, v133
    v_cvt_pk_bf16_f32 v99, v134, v135
    v_max3_f32 v230, v8, v9, v10
    v_max3_f32 v230, v230, v11, v12
    v_max3_f32 v230, v230, v13, v14
    v_max_f32 v230, v230, v15
    v_mov_b32 v231, v230
    s_nop 1
    v_permlane16_swap_b32 v230, v231
    s_nop 0
    v_max_f32 v230, v230, v231
    v_mov_b32 v231, v230
    s_nop 1
    v_permlane32_swap_b32 v230, v231
    s_nop 0
    v_max_f32_e64 v230, v230, v231
    v_add_f32 v230, 0x41800000, v230
    v_max_f32 v230, 0, v230
    v_sub_f32 v232, 0, v230
    v_exp_f32 v232, v232
    v_sub_f32 v225, v225, v230
    v_sub_f32 v72, v72, v230
    v_sub_f32 v40, v40, v230
    v_sub_f32 v8, v8, v230
    v_sub_f32 v73, v73, v230
    v_sub_f32 v41, v41, v230
    v_sub_f32 v9, v9, v230
    v_sub_f32 v74, v74, v230
    v_sub_f32 v42, v42, v230
    v_sub_f32 v10, v10, v230
    v_sub_f32 v75, v75, v230
    v_sub_f32 v43, v43, v230
    v_sub_f32 v11, v11, v230
    v_sub_f32 v76, v76, v230
    v_sub_f32 v44, v44, v230
    v_sub_f32 v12, v12, v230
    v_sub_f32 v77, v77, v230
    v_sub_f32 v45, v45, v230
    v_sub_f32 v13, v13, v230
    v_sub_f32 v78, v78, v230
    v_sub_f32 v46, v46, v230
    v_sub_f32 v14, v14, v230
    v_sub_f32 v79, v79, v230
    v_sub_f32 v47, v47, v230
    v_sub_f32 v15, v15, v230
    v_mul_f32 v148, v148, v232
    v_mul_f32 v149, v149, v232
    v_mul_f32 v150, v150, v232
    v_mul_f32 v151, v151, v232
    v_accvgpr_read_b32 v233, a32
    v_mul_f32_e64 v233, v233, v232
    v_accvgpr_write_b32 a32, v233
    v_accvgpr_read_b32 v234, a33
    v_mul_f32_e64 v234, v234, v232
    v_accvgpr_write_b32 a33, v234
    v_accvgpr_read_b32 v235, a34
    v_mul_f32_e64 v235, v235, v232
    v_accvgpr_write_b32 a34, v235
    v_accvgpr_read_b32 v236, a35
    v_mul_f32_e64 v236, v236, v232
    v_accvgpr_write_b32 a35, v236
    v_accvgpr_read_b32 v233, a36
    v_mul_f32_e64 v233, v233, v232
    v_accvgpr_write_b32 a36, v233
    v_accvgpr_read_b32 v234, a37
    v_mul_f32_e64 v234, v234, v232
    v_accvgpr_write_b32 a37, v234
    v_accvgpr_read_b32 v235, a38
    v_mul_f32_e64 v235, v235, v232
    v_accvgpr_write_b32 a38, v235
    v_accvgpr_read_b32 v236, a39
    v_mul_f32_e64 v236, v236, v232
    v_accvgpr_write_b32 a39, v236
    v_accvgpr_read_b32 v233, a40
    v_mul_f32_e64 v233, v233, v232
    v_accvgpr_write_b32 a40, v233
    v_accvgpr_read_b32 v234, a41
    v_mul_f32_e64 v234, v234, v232
    v_accvgpr_write_b32 a41, v234
    v_accvgpr_read_b32 v235, a42
    v_mul_f32_e64 v235, v235, v232
    v_accvgpr_write_b32 a42, v235
    v_accvgpr_read_b32 v236, a43
    v_mul_f32_e64 v236, v236, v232
    v_accvgpr_write_b32 a43, v236
    v_accvgpr_read_b32 v233, a44
    v_mul_f32_e64 v233, v233, v232
    v_accvgpr_write_b32 a44, v233
    v_accvgpr_read_b32 v234, a45
    v_mul_f32_e64 v234, v234, v232
    v_accvgpr_write_b32 a45, v234
    v_accvgpr_read_b32 v235, a46
    v_mul_f32_e64 v235, v235, v232
    v_accvgpr_write_b32 a46, v235
    v_accvgpr_read_b32 v236, a47
    v_mul_f32_e64 v236, v236, v232
    v_accvgpr_write_b32 a47, v236
    v_accvgpr_read_b32 v233, a48
    v_mul_f32_e64 v233, v233, v232
    v_accvgpr_write_b32 a48, v233
    v_accvgpr_read_b32 v234, a49
    v_mul_f32_e64 v234, v234, v232
    v_accvgpr_write_b32 a49, v234
    v_accvgpr_read_b32 v235, a50
    v_mul_f32_e64 v235, v235, v232
    v_accvgpr_write_b32 a50, v235
    v_accvgpr_read_b32 v236, a51
    v_mul_f32_e64 v236, v236, v232
    v_accvgpr_write_b32 a51, v236
    v_accvgpr_read_b32 v233, a52
    v_mul_f32_e64 v233, v233, v232
    v_accvgpr_write_b32 a52, v233
    v_accvgpr_read_b32 v234, a53
    v_mul_f32_e64 v234, v234, v232
    v_accvgpr_write_b32 a53, v234
    v_accvgpr_read_b32 v235, a54
    v_mul_f32_e64 v235, v235, v232
    v_accvgpr_write_b32 a54, v235
    v_accvgpr_read_b32 v236, a55
    v_mul_f32_e64 v236, v236, v232
    v_accvgpr_write_b32 a55, v236
    v_accvgpr_read_b32 v233, a56
    v_mul_f32_e64 v233, v233, v232
    v_accvgpr_write_b32 a56, v233
    v_accvgpr_read_b32 v234, a57
    v_mul_f32_e64 v234, v234, v232
    v_accvgpr_write_b32 a57, v234
    v_accvgpr_read_b32 v235, a58
    v_mul_f32_e64 v235, v235, v232
    v_accvgpr_write_b32 a58, v235
    v_accvgpr_read_b32 v236, a59
    v_mul_f32_e64 v236, v236, v232
    v_accvgpr_write_b32 a59, v236
    v_accvgpr_read_b32 v233, a60
    v_mul_f32_e64 v233, v233, v232
    v_accvgpr_write_b32 a60, v233
    v_accvgpr_read_b32 v234, a61
    v_mul_f32_e64 v234, v234, v232
    v_accvgpr_write_b32 a61, v234
    v_accvgpr_read_b32 v235, a62
    v_mul_f32_e64 v235, v235, v232
    v_accvgpr_write_b32 a62, v235
    v_accvgpr_read_b32 v236, a63
    v_mul_f32_e64 v236, v236, v232
    v_accvgpr_write_b32 a63, v236
    v_exp_f32 v128, v8
    v_exp_f32 v129, v9
    v_exp_f32 v130, v10
    v_exp_f32 v131, v11
    v_exp_f32 v132, v12
    v_exp_f32 v133, v13
    v_exp_f32 v134, v14
    v_exp_f32_e64 v135, v15
    s_nop 0
    v_cvt_pk_bf16_f32 v100, v128, v129
    v_cvt_pk_bf16_f32 v101, v130, v131
    v_cvt_pk_bf16_f32 v102, v132, v133
    v_cvt_pk_bf16_f32 v103, v134, v135
    v_max3_f32 v230, v16, v17, v18
    v_max3_f32 v230, v230, v19, v20
    v_max3_f32 v230, v230, v21, v22
    v_max_f32 v230, v230, v23
    v_mov_b32 v231, v230
    s_nop 1
    v_permlane16_swap_b32 v230, v231
    s_nop 0
    v_max_f32 v230, v230, v231
    v_mov_b32 v231, v230
    s_nop 1
    v_permlane32_swap_b32 v230, v231
    s_nop 0
    v_max_f32_e64 v230, v230, v231
    v_add_f32 v230, 0x41800000, v230
    v_max_f32 v230, 0, v230
    v_sub_f32 v232, 0, v230
    v_exp_f32 v232, v232
    v_sub_f32 v226, v226, v230
    v_sub_f32 v80, v80, v230
    v_sub_f32 v48, v48, v230
    v_sub_f32 v16, v16, v230
    v_sub_f32 v81, v81, v230
    v_sub_f32 v49, v49, v230
    v_sub_f32 v17, v17, v230
    v_sub_f32 v82, v82, v230
    v_sub_f32 v50, v50, v230
    v_sub_f32 v18, v18, v230
    v_sub_f32 v83, v83, v230
    v_sub_f32 v51, v51, v230
    v_sub_f32 v19, v19, v230
    v_sub_f32 v84, v84, v230
    v_sub_f32 v52, v52, v230
    v_sub_f32 v20, v20, v230
    v_sub_f32 v85, v85, v230
    v_sub_f32 v53, v53, v230
    v_sub_f32 v21, v21, v230
    v_sub_f32 v86, v86, v230
    v_sub_f32 v54, v54, v230
    v_sub_f32 v22, v22, v230
    v_sub_f32 v87, v87, v230
    v_sub_f32 v55, v55, v230
    v_sub_f32 v23, v23, v230
    v_mul_f32 v152, v152, v232
    v_mul_f32 v153, v153, v232
    v_mul_f32 v154, v154, v232
    v_mul_f32 v155, v155, v232
    v_accvgpr_read_b32 v233, a64
    v_mul_f32_e64 v233, v233, v232
    v_accvgpr_write_b32 a64, v233
    v_accvgpr_read_b32 v234, a65
    v_mul_f32_e64 v234, v234, v232
    v_accvgpr_write_b32 a65, v234
    v_accvgpr_read_b32 v235, a66
    v_mul_f32_e64 v235, v235, v232
    v_accvgpr_write_b32 a66, v235
    v_accvgpr_read_b32 v236, a67
    v_mul_f32_e64 v236, v236, v232
    v_accvgpr_write_b32 a67, v236
    v_accvgpr_read_b32 v233, a68
    v_mul_f32_e64 v233, v233, v232
    v_accvgpr_write_b32 a68, v233
    v_accvgpr_read_b32 v234, a69
    v_mul_f32_e64 v234, v234, v232
    v_accvgpr_write_b32 a69, v234
    v_accvgpr_read_b32 v235, a70
    v_mul_f32_e64 v235, v235, v232
    v_accvgpr_write_b32 a70, v235
    v_accvgpr_read_b32 v236, a71
    v_mul_f32_e64 v236, v236, v232
    v_accvgpr_write_b32 a71, v236
    v_accvgpr_read_b32 v233, a72
    v_mul_f32_e64 v233, v233, v232
    v_accvgpr_write_b32 a72, v233
    v_accvgpr_read_b32 v234, a73
    v_mul_f32_e64 v234, v234, v232
    v_accvgpr_write_b32 a73, v234
    v_accvgpr_read_b32 v235, a74
    v_mul_f32_e64 v235, v235, v232
    v_accvgpr_write_b32 a74, v235
    v_accvgpr_read_b32 v236, a75
    v_mul_f32_e64 v236, v236, v232
    v_accvgpr_write_b32 a75, v236
    v_accvgpr_read_b32 v233, a76
    v_mul_f32_e64 v233, v233, v232
    v_accvgpr_write_b32 a76, v233
    v_accvgpr_read_b32 v234, a77
    v_mul_f32_e64 v234, v234, v232
    v_accvgpr_write_b32 a77, v234
    v_accvgpr_read_b32 v235, a78
    v_mul_f32_e64 v235, v235, v232
    v_accvgpr_write_b32 a78, v235
    v_accvgpr_read_b32 v236, a79
    v_mul_f32_e64 v236, v236, v232
    v_accvgpr_write_b32 a79, v236
    v_accvgpr_read_b32 v233, a80
    v_mul_f32_e64 v233, v233, v232
    v_accvgpr_write_b32 a80, v233
    v_accvgpr_read_b32 v234, a81
    v_mul_f32_e64 v234, v234, v232
    v_accvgpr_write_b32 a81, v234
    v_accvgpr_read_b32 v235, a82
    v_mul_f32_e64 v235, v235, v232
    v_accvgpr_write_b32 a82, v235
    v_accvgpr_read_b32 v236, a83
    v_mul_f32_e64 v236, v236, v232
    v_accvgpr_write_b32 a83, v236
    v_accvgpr_read_b32 v233, a84
    v_mul_f32_e64 v233, v233, v232
    v_accvgpr_write_b32 a84, v233
    v_accvgpr_read_b32 v234, a85
    v_mul_f32_e64 v234, v234, v232
    v_accvgpr_write_b32 a85, v234
    v_accvgpr_read_b32 v235, a86
    v_mul_f32_e64 v235, v235, v232
    v_accvgpr_write_b32 a86, v235
    v_accvgpr_read_b32 v236, a87
    v_mul_f32_e64 v236, v236, v232
    v_accvgpr_write_b32 a87, v236
    v_accvgpr_read_b32 v233, a88
    v_mul_f32_e64 v233, v233, v232
    v_accvgpr_write_b32 a88, v233
    v_accvgpr_read_b32 v234, a89
    v_mul_f32_e64 v234, v234, v232
    v_accvgpr_write_b32 a89, v234
    v_accvgpr_read_b32 v235, a90
    v_mul_f32_e64 v235, v235, v232
    v_accvgpr_write_b32 a90, v235
    v_accvgpr_read_b32 v236, a91
    v_mul_f32_e64 v236, v236, v232
    v_accvgpr_write_b32 a91, v236
    v_accvgpr_read_b32 v233, a92
    v_mul_f32_e64 v233, v233, v232
    v_accvgpr_write_b32 a92, v233
    v_accvgpr_read_b32 v234, a93
    v_mul_f32_e64 v234, v234, v232
    v_accvgpr_write_b32 a93, v234
    v_accvgpr_read_b32 v235, a94
    v_mul_f32_e64 v235, v235, v232
    v_accvgpr_write_b32 a94, v235
    v_accvgpr_read_b32 v236, a95
    v_mul_f32_e64 v236, v236, v232
    v_accvgpr_write_b32 a95, v236
    v_exp_f32 v128, v16
    v_exp_f32 v129, v17
    v_exp_f32 v130, v18
    v_exp_f32 v131, v19
    v_exp_f32 v132, v20
    v_exp_f32 v133, v21
    v_exp_f32 v134, v22
    v_exp_f32_e64 v135, v23
    s_nop 0
    v_cvt_pk_bf16_f32 v104, v128, v129
    v_cvt_pk_bf16_f32 v105, v130, v131
    v_cvt_pk_bf16_f32 v106, v132, v133
    v_cvt_pk_bf16_f32 v107, v134, v135
    v_max3_f32 v230, v24, v25, v26
    v_max3_f32 v230, v230, v27, v28
    v_max3_f32 v230, v230, v29, v30
    v_max_f32 v230, v230, v31
    v_mov_b32 v231, v230
    s_nop 1
    v_permlane16_swap_b32 v230, v231
    s_nop 0
    v_max_f32 v230, v230, v231
    v_mov_b32 v231, v230
    s_nop 1
    v_permlane32_swap_b32 v230, v231
    s_nop 0
    v_max_f32_e64 v230, v230, v231
    v_add_f32 v230, 0x41800000, v230
    v_max_f32 v230, 0, v230
    v_sub_f32 v232, 0, v230
    v_exp_f32 v232, v232
    v_sub_f32 v227, v227, v230
    v_sub_f32 v88, v88, v230
    v_sub_f32 v56, v56, v230
    v_sub_f32 v24, v24, v230
    v_sub_f32 v89, v89, v230
    v_sub_f32 v57, v57, v230
    v_sub_f32 v25, v25, v230
    v_sub_f32 v90, v90, v230
    v_sub_f32 v58, v58, v230
    v_sub_f32 v26, v26, v230
    v_sub_f32 v91, v91, v230
    v_sub_f32 v59, v59, v230
    v_sub_f32 v27, v27, v230
    v_sub_f32 v92, v92, v230
    v_sub_f32 v60, v60, v230
    v_sub_f32 v28, v28, v230
    v_sub_f32 v93, v93, v230
    v_sub_f32 v61, v61, v230
    v_sub_f32 v29, v29, v230
    v_sub_f32 v94, v94, v230
    v_sub_f32 v62, v62, v230
    v_sub_f32 v30, v30, v230
    v_sub_f32 v95, v95, v230
    v_sub_f32 v63, v63, v230
    v_sub_f32 v31, v31, v230
    v_mul_f32 v156, v156, v232
    v_mul_f32 v157, v157, v232
    v_mul_f32 v158, v158, v232
    v_mul_f32 v159, v159, v232
    v_accvgpr_read_b32 v233, a96
    v_mul_f32_e64 v233, v233, v232
    v_accvgpr_write_b32 a96, v233
    v_accvgpr_read_b32 v234, a97
    v_mul_f32_e64 v234, v234, v232
    v_accvgpr_write_b32 a97, v234
    v_accvgpr_read_b32 v235, a98
    v_mul_f32_e64 v235, v235, v232
    v_accvgpr_write_b32 a98, v235
    v_accvgpr_read_b32 v236, a99
    v_mul_f32_e64 v236, v236, v232
    v_accvgpr_write_b32 a99, v236
    v_accvgpr_read_b32 v233, a100
    v_mul_f32_e64 v233, v233, v232
    v_accvgpr_write_b32 a100, v233
    v_accvgpr_read_b32 v234, a101
    v_mul_f32_e64 v234, v234, v232
    v_accvgpr_write_b32 a101, v234
    v_accvgpr_read_b32 v235, a102
    v_mul_f32_e64 v235, v235, v232
    v_accvgpr_write_b32 a102, v235
    v_accvgpr_read_b32 v236, a103
    v_mul_f32_e64 v236, v236, v232
    v_accvgpr_write_b32 a103, v236
    v_accvgpr_read_b32 v233, a104
    v_mul_f32_e64 v233, v233, v232
    v_accvgpr_write_b32 a104, v233
    v_accvgpr_read_b32 v234, a105
    v_mul_f32_e64 v234, v234, v232
    v_accvgpr_write_b32 a105, v234
    v_accvgpr_read_b32 v235, a106
    v_mul_f32_e64 v235, v235, v232
    v_accvgpr_write_b32 a106, v235
    v_accvgpr_read_b32 v236, a107
    v_mul_f32_e64 v236, v236, v232
    v_accvgpr_write_b32 a107, v236
    v_accvgpr_read_b32 v233, a108
    v_mul_f32_e64 v233, v233, v232
    v_accvgpr_write_b32 a108, v233
    v_accvgpr_read_b32 v234, a109
    v_mul_f32_e64 v234, v234, v232
    v_accvgpr_write_b32 a109, v234
    v_accvgpr_read_b32 v235, a110
    v_mul_f32_e64 v235, v235, v232
    v_accvgpr_write_b32 a110, v235
    v_accvgpr_read_b32 v236, a111
    v_mul_f32_e64 v236, v236, v232
    v_accvgpr_write_b32 a111, v236
    v_accvgpr_read_b32 v233, a112
    v_mul_f32_e64 v233, v233, v232
    v_accvgpr_write_b32 a112, v233
    v_accvgpr_read_b32 v234, a113
    v_mul_f32_e64 v234, v234, v232
    v_accvgpr_write_b32 a113, v234
    v_accvgpr_read_b32 v235, a114
    v_mul_f32_e64 v235, v235, v232
    v_accvgpr_write_b32 a114, v235
    v_accvgpr_read_b32 v236, a115
    v_mul_f32_e64 v236, v236, v232
    v_accvgpr_write_b32 a115, v236
    v_accvgpr_read_b32 v233, a116
    v_mul_f32_e64 v233, v233, v232
    v_accvgpr_write_b32 a116, v233
    v_accvgpr_read_b32 v234, a117
    v_mul_f32_e64 v234, v234, v232
    v_accvgpr_write_b32 a117, v234
    v_accvgpr_read_b32 v235, a118
    v_mul_f32_e64 v235, v235, v232
    v_accvgpr_write_b32 a118, v235
    v_accvgpr_read_b32 v236, a119
    v_mul_f32_e64 v236, v236, v232
    v_accvgpr_write_b32 a119, v236
    v_accvgpr_read_b32 v233, a120
    v_mul_f32_e64 v233, v233, v232
    v_accvgpr_write_b32 a120, v233
    v_accvgpr_read_b32 v234, a121
    v_mul_f32_e64 v234, v234, v232
    v_accvgpr_write_b32 a121, v234
    v_accvgpr_read_b32 v235, a122
    v_mul_f32_e64 v235, v235, v232
    v_accvgpr_write_b32 a122, v235
    v_accvgpr_read_b32 v236, a123
    v_mul_f32_e64 v236, v236, v232
    v_accvgpr_write_b32 a123, v236
    v_accvgpr_read_b32 v233, a124
    v_mul_f32_e64 v233, v233, v232
    v_accvgpr_write_b32 a124, v233
    v_accvgpr_read_b32 v234, a125
    v_mul_f32_e64 v234, v234, v232
    v_accvgpr_write_b32 a125, v234
    v_accvgpr_read_b32 v235, a126
    v_mul_f32_e64 v235, v235, v232
    v_accvgpr_write_b32 a126, v235
    v_accvgpr_read_b32 v236, a127
    v_mul_f32_e64 v236, v236, v232
    v_accvgpr_write_b32 a127, v236
    v_exp_f32 v128, v24
    v_exp_f32 v129, v25
    v_exp_f32 v130, v26
    v_exp_f32 v131, v27
    v_exp_f32 v132, v28
    v_exp_f32 v133, v29
    v_exp_f32 v134, v30
    v_exp_f32_e64 v135, v31
    s_nop 0
    v_cvt_pk_bf16_f32 v108, v128, v129
    v_cvt_pk_bf16_f32 v109, v130, v131
    v_cvt_pk_bf16_f32 v110, v132, v133
    v_cvt_pk_bf16_f32 v111, v134, v135
    s_nop 1
    s_branch kf_rr25
kf_rare30:
    s_nop 15
    v_max3_f32 v230, v32, v33, v34
    v_max3_f32 v230, v230, v35, v36
    v_max3_f32 v230, v230, v37, v38
    v_max_f32 v230, v230, v39
    v_mov_b32 v231, v230
    s_nop 1
    v_permlane16_swap_b32 v230, v231
    s_nop 0
    v_max_f32 v230, v230, v231
    v_mov_b32 v231, v230
    s_nop 1
    v_permlane32_swap_b32 v230, v231
    s_nop 0
    v_max_f32 v230, v230, v231
    v_add_f32 v230, 0x41800000, v230
    v_max_f32 v230, 0, v230
    v_sub_f32 v232, 0, v230
    v_exp_f32 v232, v232
    v_sub_f32 v224, v224, v230
    v_sub_f32 v64, v64, v230
    v_sub_f32 v0, v0, v230
    v_sub_f32 v32, v32, v230
    v_sub_f32 v65, v65, v230
    v_sub_f32 v1, v1, v230
    v_sub_f32 v33, v33, v230
    v_sub_f32 v66, v66, v230
    v_sub_f32 v2, v2, v230
    v_sub_f32 v34, v34, v230
    v_sub_f32 v67, v67, v230
    v_sub_f32 v3, v3, v230
    v_sub_f32 v35, v35, v230
    v_sub_f32 v68, v68, v230
    v_sub_f32 v4, v4, v230
    v_sub_f32 v36, v36, v230
    v_sub_f32 v69, v69, v230
    v_sub_f32 v5, v5, v230
    v_sub_f32 v37, v37, v230
    v_sub_f32 v70, v70, v230
    v_sub_f32 v6, v6, v230
    v_sub_f32 v38, v38, v230
    v_sub_f32 v71, v71, v230
    v_sub_f32 v7, v7, v230
    v_sub_f32 v39, v39, v230
    v_mul_f32 v144, v144, v232
    v_mul_f32 v145, v145, v232
    v_mul_f32 v146, v146, v232
    v_mul_f32 v147, v147, v232
    v_accvgpr_read_b32 v233, a0
    v_mul_f32_e64 v233, v233, v232
    v_accvgpr_write_b32 a0, v233
    v_accvgpr_read_b32 v234, a1
    v_mul_f32_e64 v234, v234, v232
    v_accvgpr_write_b32 a1, v234
    v_accvgpr_read_b32 v235, a2
    v_mul_f32_e64 v235, v235, v232
    v_accvgpr_write_b32 a2, v235
    v_accvgpr_read_b32 v236, a3
    v_mul_f32_e64 v236, v236, v232
    v_accvgpr_write_b32 a3, v236
    v_accvgpr_read_b32 v233, a4
    v_mul_f32_e64 v233, v233, v232
    v_accvgpr_write_b32 a4, v233
    v_accvgpr_read_b32 v234, a5
    v_mul_f32_e64 v234, v234, v232
    v_accvgpr_write_b32 a5, v234
    v_accvgpr_read_b32 v235, a6
    v_mul_f32_e64 v235, v235, v232
    v_accvgpr_write_b32 a6, v235
    v_accvgpr_read_b32 v236, a7
    v_mul_f32_e64 v236, v236, v232
    v_accvgpr_write_b32 a7, v236
    v_accvgpr_read_b32 v233, a8
    v_mul_f32_e64 v233, v233, v232
    v_accvgpr_write_b32 a8, v233
    v_accvgpr_read_b32 v234, a9
    v_mul_f32_e64 v234, v234, v232
    v_accvgpr_write_b32 a9, v234
    v_accvgpr_read_b32 v235, a10
    v_mul_f32_e64 v235, v235, v232
    v_accvgpr_write_b32 a10, v235
    v_accvgpr_read_b32 v236, a11
    v_mul_f32_e64 v236, v236, v232
    v_accvgpr_write_b32 a11, v236
    v_accvgpr_read_b32 v233, a12
    v_mul_f32_e64 v233, v233, v232
    v_accvgpr_write_b32 a12, v233
    v_accvgpr_read_b32 v234, a13
    v_mul_f32_e64 v234, v234, v232
    v_accvgpr_write_b32 a13, v234
    v_accvgpr_read_b32 v235, a14
    v_mul_f32_e64 v235, v235, v232
    v_accvgpr_write_b32 a14, v235
    v_accvgpr_read_b32 v236, a15
    v_mul_f32_e64 v236, v236, v232
    v_accvgpr_write_b32 a15, v236
    v_accvgpr_read_b32 v233, a16
    v_mul_f32_e64 v233, v233, v232
    v_accvgpr_write_b32 a16, v233
    v_accvgpr_read_b32 v234, a17
    v_mul_f32_e64 v234, v234, v232
    v_accvgpr_write_b32 a17, v234
    v_accvgpr_read_b32 v235, a18
    v_mul_f32_e64 v235, v235, v232
    v_accvgpr_write_b32 a18, v235
    v_accvgpr_read_b32 v236, a19
    v_mul_f32_e64 v236, v236, v232
    v_accvgpr_write_b32 a19, v236
    v_accvgpr_read_b32 v233, a20
    v_mul_f32_e64 v233, v233, v232
    v_accvgpr_write_b32 a20, v233
    v_accvgpr_read_b32 v234, a21
    v_mul_f32_e64 v234, v234, v232
    v_accvgpr_write_b32 a21, v234
    v_accvgpr_read_b32 v235, a22
    v_mul_f32_e64 v235, v235, v232
    v_accvgpr_write_b32 a22, v235
    v_accvgpr_read_b32 v236, a23
    v_mul_f32_e64 v236, v236, v232
    v_accvgpr_write_b32 a23, v236
    v_accvgpr_read_b32 v233, a24
    v_mul_f32_e64 v233, v233, v232
    v_accvgpr_write_b32 a24, v233
    v_accvgpr_read_b32 v234, a25
    v_mul_f32_e64 v234, v234, v232
    v_accvgpr_write_b32 a25, v234
    v_accvgpr_read_b32 v235, a26
    v_mul_f32_e64 v235, v235, v232
    v_accvgpr_write_b32 a26, v235
    v_accvgpr_read_b32 v236, a27
    v_mul_f32_e64 v236, v236, v232
    v_accvgpr_write_b32 a27, v236
    v_accvgpr_read_b32 v233, a28
    v_mul_f32_e64 v233, v233, v232
    v_accvgpr_write_b32 a28, v233
    v_accvgpr_read_b32 v234, a29
    v_mul_f32_e64 v234, v234, v232
    v_accvgpr_write_b32 a29, v234
    v_accvgpr_read_b32 v235, a30
    v_mul_f32_e64 v235, v235, v232
    v_accvgpr_write_b32 a30, v235
    v_accvgpr_read_b32 v236, a31
    v_mul_f32_e64 v236, v236, v232
    v_accvgpr_write_b32 a31, v236
    v_exp_f32 v128, v32
    v_exp_f32 v129, v33
    v_exp_f32 v130, v34
    v_exp_f32 v131, v35
    v_exp_f32 v132, v36
    v_exp_f32 v133, v37
    v_exp_f32 v134, v38
    v_exp_f32_e64 v135, v39
    s_nop 0
    v_cvt_pk_bf16_f32 v112, v128, v129
    v_cvt_pk_bf16_f32 v113, v130, v131
    v_cvt_pk_bf16_f32 v114, v132, v133
    v_cvt_pk_bf16_f32 v115, v134, v135
    v_max3_f32 v230, v40, v41, v42
    v_max3_f32 v230, v230, v43, v44
    v_max3_f32 v230, v230, v45, v46
    v_max_f32 v230, v230, v47
    v_mov_b32 v231, v230
    s_nop 1
    v_permlane16_swap_b32 v230, v231
    s_nop 0
    v_max_f32 v230, v230, v231
    v_mov_b32 v231, v230
    s_nop 1
    v_permlane32_swap_b32 v230, v231
    s_nop 0
    v_max_f32_e64 v230, v230, v231
    v_add_f32 v230, 0x41800000, v230
    v_max_f32 v230, 0, v230
    v_sub_f32 v232, 0, v230
    v_exp_f32 v232, v232
    v_sub_f32 v225, v225, v230
    v_sub_f32 v72, v72, v230
    v_sub_f32 v8, v8, v230
    v_sub_f32 v40, v40, v230
    v_sub_f32 v73, v73, v230
    v_sub_f32 v9, v9, v230
    v_sub_f32 v41, v41, v230
    v_sub_f32 v74, v74, v230
    v_sub_f32 v10, v10, v230
    v_sub_f32 v42, v42, v230
    v_sub_f32 v75, v75, v230
    v_sub_f32 v11, v11, v230
    v_sub_f32 v43, v43, v230
    v_sub_f32 v76, v76, v230
    v_sub_f32 v12, v12, v230
    v_sub_f32 v44, v44, v230
    v_sub_f32 v77, v77, v230
    v_sub_f32 v13, v13, v230
    v_sub_f32 v45, v45, v230
    v_sub_f32 v78, v78, v230
    v_sub_f32 v14, v14, v230
    v_sub_f32 v46, v46, v230
    v_sub_f32 v79, v79, v230
    v_sub_f32 v15, v15, v230
    v_sub_f32 v47, v47, v230
    v_mul_f32 v148, v148, v232
    v_mul_f32 v149, v149, v232
    v_mul_f32 v150, v150, v232
    v_mul_f32 v151, v151, v232
    v_accvgpr_read_b32 v233, a32
    v_mul_f32_e64 v233, v233, v232
    v_accvgpr_write_b32 a32, v233
    v_accvgpr_read_b32 v234, a33
    v_mul_f32_e64 v234, v234, v232
    v_accvgpr_write_b32 a33, v234
    v_accvgpr_read_b32 v235, a34
    v_mul_f32_e64 v235, v235, v232
    v_accvgpr_write_b32 a34, v235
    v_accvgpr_read_b32 v236, a35
    v_mul_f32_e64 v236, v236, v232
    v_accvgpr_write_b32 a35, v236
    v_accvgpr_read_b32 v233, a36
    v_mul_f32_e64 v233, v233, v232
    v_accvgpr_write_b32 a36, v233
    v_accvgpr_read_b32 v234, a37
    v_mul_f32_e64 v234, v234, v232
    v_accvgpr_write_b32 a37, v234
    v_accvgpr_read_b32 v235, a38
    v_mul_f32_e64 v235, v235, v232
    v_accvgpr_write_b32 a38, v235
    v_accvgpr_read_b32 v236, a39
    v_mul_f32_e64 v236, v236, v232
    v_accvgpr_write_b32 a39, v236
    v_accvgpr_read_b32 v233, a40
    v_mul_f32_e64 v233, v233, v232
    v_accvgpr_write_b32 a40, v233
    v_accvgpr_read_b32 v234, a41
    v_mul_f32_e64 v234, v234, v232
    v_accvgpr_write_b32 a41, v234
    v_accvgpr_read_b32 v235, a42
    v_mul_f32_e64 v235, v235, v232
    v_accvgpr_write_b32 a42, v235
    v_accvgpr_read_b32 v236, a43
    v_mul_f32_e64 v236, v236, v232
    v_accvgpr_write_b32 a43, v236
    v_accvgpr_read_b32 v233, a44
    v_mul_f32_e64 v233, v233, v232
    v_accvgpr_write_b32 a44, v233
    v_accvgpr_read_b32 v234, a45
    v_mul_f32_e64 v234, v234, v232
    v_accvgpr_write_b32 a45, v234
    v_accvgpr_read_b32 v235, a46
    v_mul_f32_e64 v235, v235, v232
    v_accvgpr_write_b32 a46, v235
    v_accvgpr_read_b32 v236, a47
    v_mul_f32_e64 v236, v236, v232
    v_accvgpr_write_b32 a47, v236
    v_accvgpr_read_b32 v233, a48
    v_mul_f32_e64 v233, v233, v232
    v_accvgpr_write_b32 a48, v233
    v_accvgpr_read_b32 v234, a49
    v_mul_f32_e64 v234, v234, v232
    v_accvgpr_write_b32 a49, v234
    v_accvgpr_read_b32 v235, a50
    v_mul_f32_e64 v235, v235, v232
    v_accvgpr_write_b32 a50, v235
    v_accvgpr_read_b32 v236, a51
    v_mul_f32_e64 v236, v236, v232
    v_accvgpr_write_b32 a51, v236
    v_accvgpr_read_b32 v233, a52
    v_mul_f32_e64 v233, v233, v232
    v_accvgpr_write_b32 a52, v233
    v_accvgpr_read_b32 v234, a53
    v_mul_f32_e64 v234, v234, v232
    v_accvgpr_write_b32 a53, v234
    v_accvgpr_read_b32 v235, a54
    v_mul_f32_e64 v235, v235, v232
    v_accvgpr_write_b32 a54, v235
    v_accvgpr_read_b32 v236, a55
    v_mul_f32_e64 v236, v236, v232
    v_accvgpr_write_b32 a55, v236
    v_accvgpr_read_b32 v233, a56
    v_mul_f32_e64 v233, v233, v232
    v_accvgpr_write_b32 a56, v233
    v_accvgpr_read_b32 v234, a57
    v_mul_f32_e64 v234, v234, v232
    v_accvgpr_write_b32 a57, v234
    v_accvgpr_read_b32 v235, a58
    v_mul_f32_e64 v235, v235, v232
    v_accvgpr_write_b32 a58, v235
    v_accvgpr_read_b32 v236, a59
    v_mul_f32_e64 v236, v236, v232
    v_accvgpr_write_b32 a59, v236
    v_accvgpr_read_b32 v233, a60
    v_mul_f32_e64 v233, v233, v232
    v_accvgpr_write_b32 a60, v233
    v_accvgpr_read_b32 v234, a61
    v_mul_f32_e64 v234, v234, v232
    v_accvgpr_write_b32 a61, v234
    v_accvgpr_read_b32 v235, a62
    v_mul_f32_e64 v235, v235, v232
    v_accvgpr_write_b32 a62, v235
    v_accvgpr_read_b32 v236, a63
    v_mul_f32_e64 v236, v236, v232
    v_accvgpr_write_b32 a63, v236
    v_exp_f32 v128, v40
    v_exp_f32 v129, v41
    v_exp_f32 v130, v42
    v_exp_f32 v131, v43
    v_exp_f32 v132, v44
    v_exp_f32 v133, v45
    v_exp_f32 v134, v46
    v_exp_f32_e64 v135, v47
    s_nop 0
    v_cvt_pk_bf16_f32 v116, v128, v129
    v_cvt_pk_bf16_f32 v117, v130, v131
    v_cvt_pk_bf16_f32 v118, v132, v133
    v_cvt_pk_bf16_f32 v119, v134, v135
    v_max3_f32 v230, v48, v49, v50
    v_max3_f32 v230, v230, v51, v52
    v_max3_f32 v230, v230, v53, v54
    v_max_f32 v230, v230, v55
    v_mov_b32 v231, v230
    s_nop 1
    v_permlane16_swap_b32 v230, v231
    s_nop 0
    v_max_f32 v230, v230, v231
    v_mov_b32 v231, v230
    s_nop 1
    v_permlane32_swap_b32 v230, v231
    s_nop 0
    v_max_f32_e64 v230, v230, v231
    v_add_f32 v230, 0x41800000, v230
    v_max_f32 v230, 0, v230
    v_sub_f32 v232, 0, v230
    v_exp_f32 v232, v232
    v_sub_f32 v226, v226, v230
    v_sub_f32 v80, v80, v230
    v_sub_f32 v16, v16, v230
    v_sub_f32 v48, v48, v230
    v_sub_f32 v81, v81, v230
    v_sub_f32 v17, v17, v230
    v_sub_f32 v49, v49, v230
    v_sub_f32 v82, v82, v230
    v_sub_f32 v18, v18, v230
    v_sub_f32 v50, v50, v230
    v_sub_f32 v83, v83, v230
    v_sub_f32 v19, v19, v230
    v_sub_f32 v51, v51, v230
    v_sub_f32 v84, v84, v230
    v_sub_f32 v20, v20, v230
    v_sub_f32 v52, v52, v230
    v_sub_f32 v85, v85, v230
    v_sub_f32 v21, v21, v230
    v_sub_f32 v53, v53, v230
    v_sub_f32 v86, v86, v230
    v_sub_f32 v22, v22, v230
    v_sub_f32 v54, v54, v230
    v_sub_f32 v87, v87, v230
    v_sub_f32 v23, v23, v230
    v_sub_f32 v55, v55, v230
    v_mul_f32 v152, v152, v232
    v_mul_f32 v153, v153, v232
    v_mul_f32 v154, v154, v232
    v_mul_f32 v155, v155, v232
    v_accvgpr_read_b32 v233, a64
    v_mul_f32_e64 v233, v233, v232
    v_accvgpr_write_b32 a64, v233
    v_accvgpr_read_b32 v234, a65
    v_mul_f32_e64 v234, v234, v232
    v_accvgpr_write_b32 a65, v234
    v_accvgpr_read_b32 v235, a66
    v_mul_f32_e64 v235, v235, v232
    v_accvgpr_write_b32 a66, v235
    v_accvgpr_read_b32 v236, a67
    v_mul_f32_e64 v236, v236, v232
    v_accvgpr_write_b32 a67, v236
    v_accvgpr_read_b32 v233, a68
    v_mul_f32_e64 v233, v233, v232
    v_accvgpr_write_b32 a68, v233
    v_accvgpr_read_b32 v234, a69
    v_mul_f32_e64 v234, v234, v232
    v_accvgpr_write_b32 a69, v234
    v_accvgpr_read_b32 v235, a70
    v_mul_f32_e64 v235, v235, v232
    v_accvgpr_write_b32 a70, v235
    v_accvgpr_read_b32 v236, a71
    v_mul_f32_e64 v236, v236, v232
    v_accvgpr_write_b32 a71, v236
    v_accvgpr_read_b32 v233, a72
    v_mul_f32_e64 v233, v233, v232
    v_accvgpr_write_b32 a72, v233
    v_accvgpr_read_b32 v234, a73
    v_mul_f32_e64 v234, v234, v232
    v_accvgpr_write_b32 a73, v234
    v_accvgpr_read_b32 v235, a74
    v_mul_f32_e64 v235, v235, v232
    v_accvgpr_write_b32 a74, v235
    v_accvgpr_read_b32 v236, a75
    v_mul_f32_e64 v236, v236, v232
    v_accvgpr_write_b32 a75, v236
    v_accvgpr_read_b32 v233, a76
    v_mul_f32_e64 v233, v233, v232
    v_accvgpr_write_b32 a76, v233
    v_accvgpr_read_b32 v234, a77
    v_mul_f32_e64 v234, v234, v232
    v_accvgpr_write_b32 a77, v234
    v_accvgpr_read_b32 v235, a78
    v_mul_f32_e64 v235, v235, v232
    v_accvgpr_write_b32 a78, v235
    v_accvgpr_read_b32 v236, a79
    v_mul_f32_e64 v236, v236, v232
    v_accvgpr_write_b32 a79, v236
    v_accvgpr_read_b32 v233, a80
    v_mul_f32_e64 v233, v233, v232
    v_accvgpr_write_b32 a80, v233
    v_accvgpr_read_b32 v234, a81
    v_mul_f32_e64 v234, v234, v232
    v_accvgpr_write_b32 a81, v234
    v_accvgpr_read_b32 v235, a82
    v_mul_f32_e64 v235, v235, v232
    v_accvgpr_write_b32 a82, v235
    v_accvgpr_read_b32 v236, a83
    v_mul_f32_e64 v236, v236, v232
    v_accvgpr_write_b32 a83, v236
    v_accvgpr_read_b32 v233, a84
    v_mul_f32_e64 v233, v233, v232
    v_accvgpr_write_b32 a84, v233
    v_accvgpr_read_b32 v234, a85
    v_mul_f32_e64 v234, v234, v232
    v_accvgpr_write_b32 a85, v234
    v_accvgpr_read_b32 v235, a86
    v_mul_f32_e64 v235, v235, v232
    v_accvgpr_write_b32 a86, v235
    v_accvgpr_read_b32 v236, a87
    v_mul_f32_e64 v236, v236, v232
    v_accvgpr_write_b32 a87, v236
    v_accvgpr_read_b32 v233, a88
    v_mul_f32_e64 v233, v233, v232
    v_accvgpr_write_b32 a88, v233
    v_accvgpr_read_b32 v234, a89
    v_mul_f32_e64 v234, v234, v232
    v_accvgpr_write_b32 a89, v234
    v_accvgpr_read_b32 v235, a90
    v_mul_f32_e64 v235, v235, v232
    v_accvgpr_write_b32 a90, v235
    v_accvgpr_read_b32 v236, a91
    v_mul_f32_e64 v236, v236, v232
    v_accvgpr_write_b32 a91, v236
    v_accvgpr_read_b32 v233, a92
    v_mul_f32_e64 v233, v233, v232
    v_accvgpr_write_b32 a92, v233
    v_accvgpr_read_b32 v234, a93
    v_mul_f32_e64 v234, v234, v232
    v_accvgpr_write_b32 a93, v234
    v_accvgpr_read_b32 v235, a94
    v_mul_f32_e64 v235, v235, v232
    v_accvgpr_write_b32 a94, v235
    v_accvgpr_read_b32 v236, a95
    v_mul_f32_e64 v236, v236, v232
    v_accvgpr_write_b32 a95, v236
    v_exp_f32 v128, v48
    v_exp_f32 v129, v49
    v_exp_f32 v130, v50
    v_exp_f32 v131, v51
    v_exp_f32 v132, v52
    v_exp_f32 v133, v53
    v_exp_f32 v134, v54
    v_exp_f32_e64 v135, v55
    s_nop 0
    v_cvt_pk_bf16_f32 v120, v128, v129
    v_cvt_pk_bf16_f32 v121, v130, v131
    v_cvt_pk_bf16_f32 v122, v132, v133
    v_cvt_pk_bf16_f32 v123, v134, v135
    v_max3_f32 v230, v56, v57, v58
    v_max3_f32 v230, v230, v59, v60
    v_max3_f32 v230, v230, v61, v62
    v_max_f32 v230, v230, v63
    v_mov_b32 v231, v230
    s_nop 1
    v_permlane16_swap_b32 v230, v231
    s_nop 0
    v_max_f32 v230, v230, v231
    v_mov_b32 v231, v230
    s_nop 1
    v_permlane32_swap_b32 v230, v231
    s_nop 0
    v_max_f32_e64 v230, v230, v231
    v_add_f32 v230, 0x41800000, v230
    v_max_f32 v230, 0, v230
    v_sub_f32 v232, 0, v230
    v_exp_f32 v232, v232
    v_sub_f32 v227, v227, v230
    v_sub_f32 v88, v88, v230
    v_sub_f32 v24, v24, v230
    v_sub_f32 v56, v56, v230
    v_sub_f32 v89, v89, v230
    v_sub_f32 v25, v25, v230
    v_sub_f32 v57, v57, v230
    v_sub_f32 v90, v90, v230
    v_sub_f32 v26, v26, v230
    v_sub_f32 v58, v58, v230
    v_sub_f32 v91, v91, v230
    v_sub_f32 v27, v27, v230
    v_sub_f32 v59, v59, v230
    v_sub_f32 v92, v92, v230
    v_sub_f32 v28, v28, v230
    v_sub_f32 v60, v60, v230
    v_sub_f32 v93, v93, v230
    v_sub_f32 v29, v29, v230
    v_sub_f32 v61, v61, v230
    v_sub_f32 v94, v94, v230
    v_sub_f32 v30, v30, v230
    v_sub_f32 v62, v62, v230
    v_sub_f32 v95, v95, v230
    v_sub_f32 v31, v31, v230
    v_sub_f32 v63, v63, v230
    v_mul_f32 v156, v156, v232
    v_mul_f32 v157, v157, v232
    v_mul_f32 v158, v158, v232
    v_mul_f32 v159, v159, v232
    v_accvgpr_read_b32 v233, a96
    v_mul_f32_e64 v233, v233, v232
    v_accvgpr_write_b32 a96, v233
    v_accvgpr_read_b32 v234, a97
    v_mul_f32_e64 v234, v234, v232
    v_accvgpr_write_b32 a97, v234
    v_accvgpr_read_b32 v235, a98
    v_mul_f32_e64 v235, v235, v232
    v_accvgpr_write_b32 a98, v235
    v_accvgpr_read_b32 v236, a99
    v_mul_f32_e64 v236, v236, v232
    v_accvgpr_write_b32 a99, v236
    v_accvgpr_read_b32 v233, a100
    v_mul_f32_e64 v233, v233, v232
    v_accvgpr_write_b32 a100, v233
    v_accvgpr_read_b32 v234, a101
    v_mul_f32_e64 v234, v234, v232
    v_accvgpr_write_b32 a101, v234
    v_accvgpr_read_b32 v235, a102
    v_mul_f32_e64 v235, v235, v232
    v_accvgpr_write_b32 a102, v235
    v_accvgpr_read_b32 v236, a103
    v_mul_f32_e64 v236, v236, v232
    v_accvgpr_write_b32 a103, v236
    v_accvgpr_read_b32 v233, a104
    v_mul_f32_e64 v233, v233, v232
    v_accvgpr_write_b32 a104, v233
    v_accvgpr_read_b32 v234, a105
    v_mul_f32_e64 v234, v234, v232
    v_accvgpr_write_b32 a105, v234
    v_accvgpr_read_b32 v235, a106
    v_mul_f32_e64 v235, v235, v232
    v_accvgpr_write_b32 a106, v235
    v_accvgpr_read_b32 v236, a107
    v_mul_f32_e64 v236, v236, v232
    v_accvgpr_write_b32 a107, v236
    v_accvgpr_read_b32 v233, a108
    v_mul_f32_e64 v233, v233, v232
    v_accvgpr_write_b32 a108, v233
    v_accvgpr_read_b32 v234, a109
    v_mul_f32_e64 v234, v234, v232
    v_accvgpr_write_b32 a109, v234
    v_accvgpr_read_b32 v235, a110
    v_mul_f32_e64 v235, v235, v232
    v_accvgpr_write_b32 a110, v235
    v_accvgpr_read_b32 v236, a111
    v_mul_f32_e64 v236, v236, v232
    v_accvgpr_write_b32 a111, v236
    v_accvgpr_read_b32 v233, a112
    v_mul_f32_e64 v233, v233, v232
    v_accvgpr_write_b32 a112, v233
    v_accvgpr_read_b32 v234, a113
    v_mul_f32_e64 v234, v234, v232
    v_accvgpr_write_b32 a113, v234
    v_accvgpr_read_b32 v235, a114
    v_mul_f32_e64 v235, v235, v232
    v_accvgpr_write_b32 a114, v235
    v_accvgpr_read_b32 v236, a115
    v_mul_f32_e64 v236, v236, v232
    v_accvgpr_write_b32 a115, v236
    v_accvgpr_read_b32 v233, a116
    v_mul_f32_e64 v233, v233, v232
    v_accvgpr_write_b32 a116, v233
    v_accvgpr_read_b32 v234, a117
    v_mul_f32_e64 v234, v234, v232
    v_accvgpr_write_b32 a117, v234
    v_accvgpr_read_b32 v235, a118
    v_mul_f32_e64 v235, v235, v232
    v_accvgpr_write_b32 a118, v235
    v_accvgpr_read_b32 v236, a119
    v_mul_f32_e64 v236, v236, v232
    v_accvgpr_write_b32 a119, v236
    v_accvgpr_read_b32 v233, a120
    v_mul_f32_e64 v233, v233, v232
    v_accvgpr_write_b32 a120, v233
    v_accvgpr_read_b32 v234, a121
    v_mul_f32_e64 v234, v234, v232
    v_accvgpr_write_b32 a121, v234
    v_accvgpr_read_b32 v235, a122
    v_mul_f32_e64 v235, v235, v232
    v_accvgpr_write_b32 a122, v235
    v_accvgpr_read_b32 v236, a123
    v_mul_f32_e64 v236, v236, v232
    v_accvgpr_write_b32 a123, v236
    v_accvgpr_read_b32 v233, a124
    v_mul_f32_e64 v233, v233, v232
    v_accvgpr_write_b32 a124, v233
    v_accvgpr_read_b32 v234, a125
    v_mul_f32_e64 v234, v234, v232
    v_accvgpr_write_b32 a125, v234
    v_accvgpr_read_b32 v235, a126
    v_mul_f32_e64 v235, v235, v232
    v_accvgpr_write_b32 a126, v235
    v_accvgpr_read_b32 v236, a127
    v_mul_f32_e64 v236, v236, v232
    v_accvgpr_write_b32 a127, v236
    v_exp_f32 v128, v56
    v_exp_f32 v129, v57
    v_exp_f32 v130, v58
    v_exp_f32 v131, v59
    v_exp_f32 v132, v60
    v_exp_f32 v133, v61
    v_exp_f32 v134, v62
    v_exp_f32_e64 v135, v63
    s_nop 0
    v_cvt_pk_bf16_f32 v124, v128, v129
    v_cvt_pk_bf16_f32 v125, v130, v131
    v_cvt_pk_bf16_f32 v126, v132, v133
    v_cvt_pk_bf16_f32 v127, v134, v135
    s_nop 1
    s_branch kf_rr29
kf_rare34:
    s_nop 15
    v_max3_f32 v230, v16, v17, v18
    v_max3_f32 v230, v230, v19, v20
    v_max3_f32 v230, v230, v21, v22
    v_max_f32 v230, v230, v23
    v_mov_b32 v231, v230
    s_nop 1
    v_permlane16_swap_b32 v230, v231
    s_nop 0
    v_max_f32 v230, v230, v231
    v_mov_b32 v231, v230
    s_nop 1
    v_permlane32_swap_b32 v230, v231
    s_nop 0
    v_max_f32 v230, v230, v231
    v_add_f32 v230, 0x41800000, v230
    v_max_f32 v230, 0, v230
    v_sub_f32 v232, 0, v230
    v_exp_f32 v232, v232
    v_sub_f32 v226, v226, v230
    v_sub_f32 v80, v80, v230
    v_sub_f32 v48, v48, v230
    v_sub_f32 v16, v16, v230
    v_sub_f32 v81, v81, v230
    v_sub_f32 v49, v49, v230
    v_sub_f32 v17, v17, v230
    v_sub_f32 v82, v82, v230
    v_sub_f32 v50, v50, v230
    v_sub_f32 v18, v18, v230
    v_sub_f32 v83, v83, v230
    v_sub_f32 v51, v51, v230
    v_sub_f32 v19, v19, v230
    v_sub_f32 v84, v84, v230
    v_sub_f32 v52, v52, v230
    v_sub_f32 v20, v20, v230
    v_sub_f32 v85, v85, v230
    v_sub_f32 v53, v53, v230
    v_sub_f32 v21, v21, v230
    v_sub_f32 v86, v86, v230
    v_sub_f32 v54, v54, v230
    v_sub_f32 v22, v22, v230
    v_sub_f32 v87, v87, v230
    v_sub_f32 v55, v55, v230
    v_sub_f32 v23, v23, v230
    v_mul_f32 v152, v152, v232
    v_mul_f32 v153, v153, v232
    v_mul_f32 v154, v154, v232
    v_mul_f32 v155, v155, v232
    v_accvgpr_read_b32 v233, a64
    v_mul_f32_e64 v233, v233, v232
    v_accvgpr_write_b32 a64, v233
    v_accvgpr_read_b32 v234, a65
    v_mul_f32_e64 v234, v234, v232
    v_accvgpr_write_b32 a65, v234
    v_accvgpr_read_b32 v235, a66
    v_mul_f32_e64 v235, v235, v232
    v_accvgpr_write_b32 a66, v235
    v_accvgpr_read_b32 v236, a67
    v_mul_f32_e64 v236, v236, v232
    v_accvgpr_write_b32 a67, v236
    v_accvgpr_read_b32 v233, a68
    v_mul_f32_e64 v233, v233, v232
    v_accvgpr_write_b32 a68, v233
    v_accvgpr_read_b32 v234, a69
    v_mul_f32_e64 v234, v234, v232
    v_accvgpr_write_b32 a69, v234
    v_accvgpr_read_b32 v235, a70
    v_mul_f32_e64 v235, v235, v232
    v_accvgpr_write_b32 a70, v235
    v_accvgpr_read_b32 v236, a71
    v_mul_f32_e64 v236, v236, v232
    v_accvgpr_write_b32 a71, v236
    v_accvgpr_read_b32 v233, a72
    v_mul_f32_e64 v233, v233, v232
    v_accvgpr_write_b32 a72, v233
    v_accvgpr_read_b32 v234, a73
    v_mul_f32_e64 v234, v234, v232
    v_accvgpr_write_b32 a73, v234
    v_accvgpr_read_b32 v235, a74
    v_mul_f32_e64 v235, v235, v232
    v_accvgpr_write_b32 a74, v235
    v_accvgpr_read_b32 v236, a75
    v_mul_f32_e64 v236, v236, v232
    v_accvgpr_write_b32 a75, v236
    v_accvgpr_read_b32 v233, a76
    v_mul_f32_e64 v233, v233, v232
    v_accvgpr_write_b32 a76, v233
    v_accvgpr_read_b32 v234, a77
    v_mul_f32_e64 v234, v234, v232
    v_accvgpr_write_b32 a77, v234
    v_accvgpr_read_b32 v235, a78
    v_mul_f32_e64 v235, v235, v232
    v_accvgpr_write_b32 a78, v235
    v_accvgpr_read_b32 v236, a79
    v_mul_f32_e64 v236, v236, v232
    v_accvgpr_write_b32 a79, v236
    v_accvgpr_read_b32 v233, a80
    v_mul_f32_e64 v233, v233, v232
    v_accvgpr_write_b32 a80, v233
    v_accvgpr_read_b32 v234, a81
    v_mul_f32_e64 v234, v234, v232
    v_accvgpr_write_b32 a81, v234
    v_accvgpr_read_b32 v235, a82
    v_mul_f32_e64 v235, v235, v232
    v_accvgpr_write_b32 a82, v235
    v_accvgpr_read_b32 v236, a83
    v_mul_f32_e64 v236, v236, v232
    v_accvgpr_write_b32 a83, v236
    v_accvgpr_read_b32 v233, a84
    v_mul_f32_e64 v233, v233, v232
    v_accvgpr_write_b32 a84, v233
    v_accvgpr_read_b32 v234, a85
    v_mul_f32_e64 v234, v234, v232
    v_accvgpr_write_b32 a85, v234
    v_accvgpr_read_b32 v235, a86
    v_mul_f32_e64 v235, v235, v232
    v_accvgpr_write_b32 a86, v235
    v_accvgpr_read_b32 v236, a87
    v_mul_f32_e64 v236, v236, v232
    v_accvgpr_write_b32 a87, v236
    v_accvgpr_read_b32 v233, a88
    v_mul_f32_e64 v233, v233, v232
    v_accvgpr_write_b32 a88, v233
    v_accvgpr_read_b32 v234, a89
    v_mul_f32_e64 v234, v234, v232
    v_accvgpr_write_b32 a89, v234
    v_accvgpr_read_b32 v235, a90
    v_mul_f32_e64 v235, v235, v232
    v_accvgpr_write_b32 a90, v235
    v_accvgpr_read_b32 v236, a91
    v_mul_f32_e64 v236, v236, v232
    v_accvgpr_write_b32 a91, v236
    v_accvgpr_read_b32 v233, a92
    v_mul_f32_e64 v233, v233, v232
    v_accvgpr_write_b32 a92, v233
    v_accvgpr_read_b32 v234, a93
    v_mul_f32_e64 v234, v234, v232
    v_accvgpr_write_b32 a93, v234
    v_accvgpr_read_b32 v235, a94
    v_mul_f32_e64 v235, v235, v232
    v_accvgpr_write_b32 a94, v235
    v_accvgpr_read_b32 v236, a95
    v_mul_f32_e64 v236, v236, v232
    v_accvgpr_write_b32 a95, v236
    v_exp_f32 v128, v16
    v_exp_f32 v129, v17
    v_exp_f32 v130, v18
    v_exp_f32 v131, v19
    v_exp_f32 v132, v20
    v_exp_f32 v133, v21
    v_exp_f32 v134, v22
    v_exp_f32_e64 v135, v23
    s_nop 0
    v_cvt_pk_bf16_f32 v104, v128, v129
    v_cvt_pk_bf16_f32 v105, v130, v131
    v_cvt_pk_bf16_f32 v106, v132, v133
    v_cvt_pk_bf16_f32 v107, v134, v135
    v_max3_f32 v230, v24, v25, v26
    v_max3_f32 v230, v230, v27, v28
    v_max3_f32 v230, v230, v29, v30
    v_max_f32 v230, v230, v31
    v_mov_b32 v231, v230
    s_nop 1
    v_permlane16_swap_b32 v230, v231
    s_nop 0
    v_max_f32 v230, v230, v231
    v_mov_b32 v231, v230
    s_nop 1
    v_permlane32_swap_b32 v230, v231
    s_nop 0
    v_max_f32_e64 v230, v230, v231
    v_add_f32 v230, 0x41800000, v230
    v_max_f32 v230, 0, v230
    v_sub_f32 v232, 0, v230
    v_exp_f32 v232, v232
    v_sub_f32 v227, v227, v230
    v_sub_f32 v88, v88, v230
    v_sub_f32 v56, v56, v230
    v_sub_f32 v24, v24, v230
    v_sub_f32 v89, v89, v230
    v_sub_f32 v57, v57, v230
    v_sub_f32 v25, v25, v230
    v_sub_f32 v90, v90, v230
    v_sub_f32 v58, v58, v230
    v_sub_f32 v26, v26, v230
    v_sub_f32 v91, v91, v230
    v_sub_f32 v59, v59, v230
    v_sub_f32 v27, v27, v230
    v_sub_f32 v92, v92, v230
    v_sub_f32 v60, v60, v230
    v_sub_f32 v28, v28, v230
    v_sub_f32 v93, v93, v230
    v_sub_f32 v61, v61, v230
    v_sub_f32 v29, v29, v230
    v_sub_f32 v94, v94, v230
    v_sub_f32 v62, v62, v230
    v_sub_f32 v30, v30, v230
    v_sub_f32 v95, v95, v230
    v_sub_f32 v63, v63, v230
    v_sub_f32 v31, v31, v230
    v_mul_f32 v156, v156, v232
    v_mul_f32 v157, v157, v232
    v_mul_f32 v158, v158, v232
    v_mul_f32 v159, v159, v232
    v_accvgpr_read_b32 v233, a96
    v_mul_f32_e64 v233, v233, v232
    v_accvgpr_write_b32 a96, v233
    v_accvgpr_read_b32 v234, a97
    v_mul_f32_e64 v234, v234, v232
    v_accvgpr_write_b32 a97, v234
    v_accvgpr_read_b32 v235, a98
    v_mul_f32_e64 v235, v235, v232
    v_accvgpr_write_b32 a98, v235
    v_accvgpr_read_b32 v236, a99
    v_mul_f32_e64 v236, v236, v232
    v_accvgpr_write_b32 a99, v236
    v_accvgpr_read_b32 v233, a100
    v_mul_f32_e64 v233, v233, v232
    v_accvgpr_write_b32 a100, v233
    v_accvgpr_read_b32 v234, a101
    v_mul_f32_e64 v234, v234, v232
    v_accvgpr_write_b32 a101, v234
    v_accvgpr_read_b32 v235, a102
    v_mul_f32_e64 v235, v235, v232
    v_accvgpr_write_b32 a102, v235
    v_accvgpr_read_b32 v236, a103
    v_mul_f32_e64 v236, v236, v232
    v_accvgpr_write_b32 a103, v236
    v_accvgpr_read_b32 v233, a104
    v_mul_f32_e64 v233, v233, v232
    v_accvgpr_write_b32 a104, v233
    v_accvgpr_read_b32 v234, a105
    v_mul_f32_e64 v234, v234, v232
    v_accvgpr_write_b32 a105, v234
    v_accvgpr_read_b32 v235, a106
    v_mul_f32_e64 v235, v235, v232
    v_accvgpr_write_b32 a106, v235
    v_accvgpr_read_b32 v236, a107
    v_mul_f32_e64 v236, v236, v232
    v_accvgpr_write_b32 a107, v236
    v_accvgpr_read_b32 v233, a108
    v_mul_f32_e64 v233, v233, v232
    v_accvgpr_write_b32 a108, v233
    v_accvgpr_read_b32 v234, a109
    v_mul_f32_e64 v234, v234, v232
    v_accvgpr_write_b32 a109, v234
    v_accvgpr_read_b32 v235, a110
    v_mul_f32_e64 v235, v235, v232
    v_accvgpr_write_b32 a110, v235
    v_accvgpr_read_b32 v236, a111
    v_mul_f32_e64 v236, v236, v232
    v_accvgpr_write_b32 a111, v236
    v_accvgpr_read_b32 v233, a112
    v_mul_f32_e64 v233, v233, v232
    v_accvgpr_write_b32 a112, v233
    v_accvgpr_read_b32 v234, a113
    v_mul_f32_e64 v234, v234, v232
    v_accvgpr_write_b32 a113, v234
    v_accvgpr_read_b32 v235, a114
    v_mul_f32_e64 v235, v235, v232
    v_accvgpr_write_b32 a114, v235
    v_accvgpr_read_b32 v236, a115
    v_mul_f32_e64 v236, v236, v232
    v_accvgpr_write_b32 a115, v236
    v_accvgpr_read_b32 v233, a116
    v_mul_f32_e64 v233, v233, v232
    v_accvgpr_write_b32 a116, v233
    v_accvgpr_read_b32 v234, a117
    v_mul_f32_e64 v234, v234, v232
    v_accvgpr_write_b32 a117, v234
    v_accvgpr_read_b32 v235, a118
    v_mul_f32_e64 v235, v235, v232
    v_accvgpr_write_b32 a118, v235
    v_accvgpr_read_b32 v236, a119
    v_mul_f32_e64 v236, v236, v232
    v_accvgpr_write_b32 a119, v236
    v_accvgpr_read_b32 v233, a120
    v_mul_f32_e64 v233, v233, v232
    v_accvgpr_write_b32 a120, v233
    v_accvgpr_read_b32 v234, a121
    v_mul_f32_e64 v234, v234, v232
    v_accvgpr_write_b32 a121, v234
    v_accvgpr_read_b32 v235, a122
    v_mul_f32_e64 v235, v235, v232
    v_accvgpr_write_b32 a122, v235
    v_accvgpr_read_b32 v236, a123
    v_mul_f32_e64 v236, v236, v232
    v_accvgpr_write_b32 a123, v236
    v_accvgpr_read_b32 v233, a124
    v_mul_f32_e64 v233, v233, v232
    v_accvgpr_write_b32 a124, v233
    v_accvgpr_read_b32 v234, a125
    v_mul_f32_e64 v234, v234, v232
    v_accvgpr_write_b32 a125, v234
    v_accvgpr_read_b32 v235, a126
    v_mul_f32_e64 v235, v235, v232
    v_accvgpr_write_b32 a126, v235
    v_accvgpr_read_b32 v236, a127
    v_mul_f32_e64 v236, v236, v232
    v_accvgpr_write_b32 a127, v236
    v_exp_f32 v128, v24
    v_exp_f32 v129, v25
    v_exp_f32 v130, v26
    v_exp_f32 v131, v27
    v_exp_f32 v132, v28
    v_exp_f32 v133, v29
    v_exp_f32 v134, v30
    v_exp_f32_e64 v135, v31
    s_nop 0
    v_cvt_pk_bf16_f32 v108, v128, v129
    v_cvt_pk_bf16_f32 v109, v130, v131
    v_cvt_pk_bf16_f32 v110, v132, v133
    v_cvt_pk_bf16_f32 v111, v134, v135
    s_nop 1
    s_branch kf_rr33
kf_rare38:
    s_nop 15
    v_max3_f32 v230, v48, v49, v50
    v_max3_f32 v230, v230, v51, v52
    v_max3_f32 v230, v230, v53, v54
    v_max_f32 v230, v230, v55
    v_mov_b32 v231, v230
    s_nop 1
    v_permlane16_swap_b32 v230, v231
    s_nop 0
    v_max_f32 v230, v230, v231
    v_mov_b32 v231, v230
    s_nop 1
    v_permlane32_swap_b32 v230, v231
    s_nop 0
    v_max_f32 v230, v230, v231
    v_add_f32 v230, 0x41800000, v230
    v_max_f32 v230, 0, v230
    v_sub_f32 v232, 0, v230
    v_exp_f32 v232, v232
    v_sub_f32 v226, v226, v230
    v_sub_f32 v80, v80, v230
    v_sub_f32 v16, v16, v230
    v_sub_f32 v48, v48, v230
    v_sub_f32 v81, v81, v230
    v_sub_f32 v17, v17, v230
    v_sub_f32 v49, v49, v230
    v_sub_f32 v82, v82, v230
    v_sub_f32 v18, v18, v230
    v_sub_f32 v50, v50, v230
    v_sub_f32 v83, v83, v230
    v_sub_f32 v19, v19, v230
    v_sub_f32 v51, v51, v230
    v_sub_f32 v84, v84, v230
    v_sub_f32 v20, v20, v230
    v_sub_f32 v52, v52, v230
    v_sub_f32 v85, v85, v230
    v_sub_f32 v21, v21, v230
    v_sub_f32 v53, v53, v230
    v_sub_f32 v86, v86, v230
    v_sub_f32 v22, v22, v230
    v_sub_f32 v54, v54, v230
    v_sub_f32 v87, v87, v230
    v_sub_f32 v23, v23, v230
    v_sub_f32 v55, v55, v230
    v_mul_f32 v152, v152, v232
    v_mul_f32 v153, v153, v232
    v_mul_f32 v154, v154, v232
    v_mul_f32 v155, v155, v232
    v_accvgpr_read_b32 v233, a64
    v_mul_f32_e64 v233, v233, v232
    v_accvgpr_write_b32 a64, v233
    v_accvgpr_read_b32 v234, a65
    v_mul_f32_e64 v234, v234, v232
    v_accvgpr_write_b32 a65, v234
    v_accvgpr_read_b32 v235, a66
    v_mul_f32_e64 v235, v235, v232
    v_accvgpr_write_b32 a66, v235
    v_accvgpr_read_b32 v236, a67
    v_mul_f32_e64 v236, v236, v232
    v_accvgpr_write_b32 a67, v236
    v_accvgpr_read_b32 v233, a68
    v_mul_f32_e64 v233, v233, v232
    v_accvgpr_write_b32 a68, v233
    v_accvgpr_read_b32 v234, a69
    v_mul_f32_e64 v234, v234, v232
    v_accvgpr_write_b32 a69, v234
    v_accvgpr_read_b32 v235, a70
    v_mul_f32_e64 v235, v235, v232
    v_accvgpr_write_b32 a70, v235
    v_accvgpr_read_b32 v236, a71
    v_mul_f32_e64 v236, v236, v232
    v_accvgpr_write_b32 a71, v236
    v_accvgpr_read_b32 v233, a72
    v_mul_f32_e64 v233, v233, v232
    v_accvgpr_write_b32 a72, v233
    v_accvgpr_read_b32 v234, a73
    v_mul_f32_e64 v234, v234, v232
    v_accvgpr_write_b32 a73, v234
    v_accvgpr_read_b32 v235, a74
    v_mul_f32_e64 v235, v235, v232
    v_accvgpr_write_b32 a74, v235
    v_accvgpr_read_b32 v236, a75
    v_mul_f32_e64 v236, v236, v232
    v_accvgpr_write_b32 a75, v236
    v_accvgpr_read_b32 v233, a76
    v_mul_f32_e64 v233, v233, v232
    v_accvgpr_write_b32 a76, v233
    v_accvgpr_read_b32 v234, a77
    v_mul_f32_e64 v234, v234, v232
    v_accvgpr_write_b32 a77, v234
    v_accvgpr_read_b32 v235, a78
    v_mul_f32_e64 v235, v235, v232
    v_accvgpr_write_b32 a78, v235
    v_accvgpr_read_b32 v236, a79
    v_mul_f32_e64 v236, v236, v232
    v_accvgpr_write_b32 a79, v236
    v_accvgpr_read_b32 v233, a80
    v_mul_f32_e64 v233, v233, v232
    v_accvgpr_write_b32 a80, v233
    v_accvgpr_read_b32 v234, a81
    v_mul_f32_e64 v234, v234, v232
    v_accvgpr_write_b32 a81, v234
    v_accvgpr_read_b32 v235, a82
    v_mul_f32_e64 v235, v235, v232
    v_accvgpr_write_b32 a82, v235
    v_accvgpr_read_b32 v236, a83
    v_mul_f32_e64 v236, v236, v232
    v_accvgpr_write_b32 a83, v236
    v_accvgpr_read_b32 v233, a84
    v_mul_f32_e64 v233, v233, v232
    v_accvgpr_write_b32 a84, v233
    v_accvgpr_read_b32 v234, a85
    v_mul_f32_e64 v234, v234, v232
    v_accvgpr_write_b32 a85, v234
    v_accvgpr_read_b32 v235, a86
    v_mul_f32_e64 v235, v235, v232
    v_accvgpr_write_b32 a86, v235
    v_accvgpr_read_b32 v236, a87
    v_mul_f32_e64 v236, v236, v232
    v_accvgpr_write_b32 a87, v236
    v_accvgpr_read_b32 v233, a88
    v_mul_f32_e64 v233, v233, v232
    v_accvgpr_write_b32 a88, v233
    v_accvgpr_read_b32 v234, a89
    v_mul_f32_e64 v234, v234, v232
    v_accvgpr_write_b32 a89, v234
    v_accvgpr_read_b32 v235, a90
    v_mul_f32_e64 v235, v235, v232
    v_accvgpr_write_b32 a90, v235
    v_accvgpr_read_b32 v236, a91
    v_mul_f32_e64 v236, v236, v232
    v_accvgpr_write_b32 a91, v236
    v_accvgpr_read_b32 v233, a92
    v_mul_f32_e64 v233, v233, v232
    v_accvgpr_write_b32 a92, v233
    v_accvgpr_read_b32 v234, a93
    v_mul_f32_e64 v234, v234, v232
    v_accvgpr_write_b32 a93, v234
    v_accvgpr_read_b32 v235, a94
    v_mul_f32_e64 v235, v235, v232
    v_accvgpr_write_b32 a94, v235
    v_accvgpr_read_b32 v236, a95
    v_mul_f32_e64 v236, v236, v232
    v_accvgpr_write_b32 a95, v236
    v_exp_f32 v128, v48
    v_exp_f32 v129, v49
    v_exp_f32 v130, v50
    v_exp_f32 v131, v51
    v_exp_f32 v132, v52
    v_exp_f32 v133, v53
    v_exp_f32 v134, v54
    v_exp_f32_e64 v135, v55
    s_nop 0
    v_cvt_pk_bf16_f32 v120, v128, v129
    v_cvt_pk_bf16_f32 v121, v130, v131
    v_cvt_pk_bf16_f32 v122, v132, v133
    v_cvt_pk_bf16_f32 v123, v134, v135
    v_max3_f32 v230, v56, v57, v58
    v_max3_f32 v230, v230, v59, v60
    v_max3_f32 v230, v230, v61, v62
    v_max_f32 v230, v230, v63
    v_mov_b32 v231, v230
    s_nop 1
    v_permlane16_swap_b32 v230, v231
    s_nop 0
    v_max_f32 v230, v230, v231
    v_mov_b32 v231, v230
    s_nop 1
    v_permlane32_swap_b32 v230, v231
    s_nop 0
    v_max_f32_e64 v230, v230, v231
    v_add_f32 v230, 0x41800000, v230
    v_max_f32 v230, 0, v230
    v_sub_f32 v232, 0, v230
    v_exp_f32 v232, v232
    v_sub_f32 v227, v227, v230
    v_sub_f32 v88, v88, v230
    v_sub_f32 v24, v24, v230
    v_sub_f32 v56, v56, v230
    v_sub_f32 v89, v89, v230
    v_sub_f32 v25, v25, v230
    v_sub_f32 v57, v57, v230
    v_sub_f32 v90, v90, v230
    v_sub_f32 v26, v26, v230
    v_sub_f32 v58, v58, v230
    v_sub_f32 v91, v91, v230
    v_sub_f32 v27, v27, v230
    v_sub_f32 v59, v59, v230
    v_sub_f32 v92, v92, v230
    v_sub_f32 v28, v28, v230
    v_sub_f32 v60, v60, v230
    v_sub_f32 v93, v93, v230
    v_sub_f32 v29, v29, v230
    v_sub_f32 v61, v61, v230
    v_sub_f32 v94, v94, v230
    v_sub_f32 v30, v30, v230
    v_sub_f32 v62, v62, v230
    v_sub_f32 v95, v95, v230
    v_sub_f32 v31, v31, v230
    v_sub_f32 v63, v63, v230
    v_mul_f32 v156, v156, v232
    v_mul_f32 v157, v157, v232
    v_mul_f32 v158, v158, v232
    v_mul_f32 v159, v159, v232
    v_accvgpr_read_b32 v233, a96
    v_mul_f32_e64 v233, v233, v232
    v_accvgpr_write_b32 a96, v233
    v_accvgpr_read_b32 v234, a97
    v_mul_f32_e64 v234, v234, v232
    v_accvgpr_write_b32 a97, v234
    v_accvgpr_read_b32 v235, a98
    v_mul_f32_e64 v235, v235, v232
    v_accvgpr_write_b32 a98, v235
    v_accvgpr_read_b32 v236, a99
    v_mul_f32_e64 v236, v236, v232
    v_accvgpr_write_b32 a99, v236
    v_accvgpr_read_b32 v233, a100
    v_mul_f32_e64 v233, v233, v232
    v_accvgpr_write_b32 a100, v233
    v_accvgpr_read_b32 v234, a101
    v_mul_f32_e64 v234, v234, v232
    v_accvgpr_write_b32 a101, v234
    v_accvgpr_read_b32 v235, a102
    v_mul_f32_e64 v235, v235, v232
    v_accvgpr_write_b32 a102, v235
    v_accvgpr_read_b32 v236, a103
    v_mul_f32_e64 v236, v236, v232
    v_accvgpr_write_b32 a103, v236
    v_accvgpr_read_b32 v233, a104
    v_mul_f32_e64 v233, v233, v232
    v_accvgpr_write_b32 a104, v233
    v_accvgpr_read_b32 v234, a105
    v_mul_f32_e64 v234, v234, v232
    v_accvgpr_write_b32 a105, v234
    v_accvgpr_read_b32 v235, a106
    v_mul_f32_e64 v235, v235, v232
    v_accvgpr_write_b32 a106, v235
    v_accvgpr_read_b32 v236, a107
    v_mul_f32_e64 v236, v236, v232
    v_accvgpr_write_b32 a107, v236
    v_accvgpr_read_b32 v233, a108
    v_mul_f32_e64 v233, v233, v232
    v_accvgpr_write_b32 a108, v233
    v_accvgpr_read_b32 v234, a109
    v_mul_f32_e64 v234, v234, v232
    v_accvgpr_write_b32 a109, v234
    v_accvgpr_read_b32 v235, a110
    v_mul_f32_e64 v235, v235, v232
    v_accvgpr_write_b32 a110, v235
    v_accvgpr_read_b32 v236, a111
    v_mul_f32_e64 v236, v236, v232
    v_accvgpr_write_b32 a111, v236
    v_accvgpr_read_b32 v233, a112
    v_mul_f32_e64 v233, v233, v232
    v_accvgpr_write_b32 a112, v233
    v_accvgpr_read_b32 v234, a113
    v_mul_f32_e64 v234, v234, v232
    v_accvgpr_write_b32 a113, v234
    v_accvgpr_read_b32 v235, a114
    v_mul_f32_e64 v235, v235, v232
    v_accvgpr_write_b32 a114, v235
    v_accvgpr_read_b32 v236, a115
    v_mul_f32_e64 v236, v236, v232
    v_accvgpr_write_b32 a115, v236
    v_accvgpr_read_b32 v233, a116
    v_mul_f32_e64 v233, v233, v232
    v_accvgpr_write_b32 a116, v233
    v_accvgpr_read_b32 v234, a117
    v_mul_f32_e64 v234, v234, v232
    v_accvgpr_write_b32 a117, v234
    v_accvgpr_read_b32 v235, a118
    v_mul_f32_e64 v235, v235, v232
    v_accvgpr_write_b32 a118, v235
    v_accvgpr_read_b32 v236, a119
    v_mul_f32_e64 v236, v236, v232
    v_accvgpr_write_b32 a119, v236
    v_accvgpr_read_b32 v233, a120
    v_mul_f32_e64 v233, v233, v232
    v_accvgpr_write_b32 a120, v233
    v_accvgpr_read_b32 v234, a121
    v_mul_f32_e64 v234, v234, v232
    v_accvgpr_write_b32 a121, v234
    v_accvgpr_read_b32 v235, a122
    v_mul_f32_e64 v235, v235, v232
    v_accvgpr_write_b32 a122, v235
    v_accvgpr_read_b32 v236, a123
    v_mul_f32_e64 v236, v236, v232
    v_accvgpr_write_b32 a123, v236
    v_accvgpr_read_b32 v233, a124
    v_mul_f32_e64 v233, v233, v232
    v_accvgpr_write_b32 a124, v233
    v_accvgpr_read_b32 v234, a125
    v_mul_f32_e64 v234, v234, v232
    v_accvgpr_write_b32 a125, v234
    v_accvgpr_read_b32 v235, a126
    v_mul_f32_e64 v235, v235, v232
    v_accvgpr_write_b32 a126, v235
    v_accvgpr_read_b32 v236, a127
    v_mul_f32_e64 v236, v236, v232
    v_accvgpr_write_b32 a127, v236
    v_exp_f32 v128, v56
    v_exp_f32 v129, v57
    v_exp_f32 v130, v58
    v_exp_f32 v131, v59
    v_exp_f32 v132, v60
    v_exp_f32 v133, v61
    v_exp_f32 v134, v62
    v_exp_f32_e64 v135, v63
    s_nop 0
    v_cvt_pk_bf16_f32 v124, v128, v129
    v_cvt_pk_bf16_f32 v125, v130, v131
    v_cvt_pk_bf16_f32 v126, v132, v133
    v_cvt_pk_bf16_f32 v127, v134, v135
    s_nop 1
    s_branch kf_rr37
kf_rare42:
    s_nop 15
    v_max3_f32 v230, v16, v17, v18
    v_max3_f32 v230, v230, v19, v20
    v_max3_f32 v230, v230, v21, v22
    v_max_f32 v230, v230, v23
    v_mov_b32 v231, v230
    s_nop 1
    v_permlane16_swap_b32 v230, v231
    s_nop 0
    v_max_f32 v230, v230, v231
    v_mov_b32 v231, v230
    s_nop 1
    v_permlane32_swap_b32 v230, v231
    s_nop 0
    v_max_f32 v230, v230, v231
    v_add_f32 v230, 0x41800000, v230
    v_max_f32 v230, 0, v230
    v_sub_f32 v232, 0, v230
    v_exp_f32 v232, v232
    v_sub_f32 v226, v226, v230
    v_sub_f32 v80, v80, v230
    v_sub_f32 v48, v48, v230
    v_sub_f32 v16, v16, v230
    v_sub_f32 v81, v81, v230
    v_sub_f32 v49, v49, v230
    v_sub_f32 v17, v17, v230
    v_sub_f32 v82, v82, v230
    v_sub_f32 v50, v50, v230
    v_sub_f32 v18, v18, v230
    v_sub_f32 v83, v83, v230
    v_sub_f32 v51, v51, v230
    v_sub_f32 v19, v19, v230
    v_sub_f32 v84, v84, v230
    v_sub_f32 v52, v52, v230
    v_sub_f32 v20, v20, v230
    v_sub_f32 v85, v85, v230
    v_sub_f32 v53, v53, v230
    v_sub_f32 v21, v21, v230
    v_sub_f32 v86, v86, v230
    v_sub_f32 v54, v54, v230
    v_sub_f32 v22, v22, v230
    v_sub_f32 v87, v87, v230
    v_sub_f32 v55, v55, v230
    v_sub_f32 v23, v23, v230
    v_mul_f32 v152, v152, v232
    v_mul_f32 v153, v153, v232
    v_mul_f32 v154, v154, v232
    v_mul_f32 v155, v155, v232
    v_accvgpr_read_b32 v233, a64
    v_mul_f32_e64 v233, v233, v232
    v_accvgpr_write_b32 a64, v233
    v_accvgpr_read_b32 v234, a65
    v_mul_f32_e64 v234, v234, v232
    v_accvgpr_write_b32 a65, v234
    v_accvgpr_read_b32 v235, a66
    v_mul_f32_e64 v235, v235, v232
    v_accvgpr_write_b32 a66, v235
    v_accvgpr_read_b32 v236, a67
    v_mul_f32_e64 v236, v236, v232
    v_accvgpr_write_b32 a67, v236
    v_accvgpr_read_b32 v233, a68
    v_mul_f32_e64 v233, v233, v232
    v_accvgpr_write_b32 a68, v233
    v_accvgpr_read_b32 v234, a69
    v_mul_f32_e64 v234, v234, v232
    v_accvgpr_write_b32 a69, v234
    v_accvgpr_read_b32 v235, a70
    v_mul_f32_e64 v235, v235, v232
    v_accvgpr_write_b32 a70, v235
    v_accvgpr_read_b32 v236, a71
    v_mul_f32_e64 v236, v236, v232
    v_accvgpr_write_b32 a71, v236
    v_accvgpr_read_b32 v233, a72
    v_mul_f32_e64 v233, v233, v232
    v_accvgpr_write_b32 a72, v233
    v_accvgpr_read_b32 v234, a73
    v_mul_f32_e64 v234, v234, v232
    v_accvgpr_write_b32 a73, v234
    v_accvgpr_read_b32 v235, a74
    v_mul_f32_e64 v235, v235, v232
    v_accvgpr_write_b32 a74, v235
    v_accvgpr_read_b32 v236, a75
    v_mul_f32_e64 v236, v236, v232
    v_accvgpr_write_b32 a75, v236
    v_accvgpr_read_b32 v233, a76
    v_mul_f32_e64 v233, v233, v232
    v_accvgpr_write_b32 a76, v233
    v_accvgpr_read_b32 v234, a77
    v_mul_f32_e64 v234, v234, v232
    v_accvgpr_write_b32 a77, v234
    v_accvgpr_read_b32 v235, a78
    v_mul_f32_e64 v235, v235, v232
    v_accvgpr_write_b32 a78, v235
    v_accvgpr_read_b32 v236, a79
    v_mul_f32_e64 v236, v236, v232
    v_accvgpr_write_b32 a79, v236
    v_accvgpr_read_b32 v233, a80
    v_mul_f32_e64 v233, v233, v232
    v_accvgpr_write_b32 a80, v233
    v_accvgpr_read_b32 v234, a81
    v_mul_f32_e64 v234, v234, v232
    v_accvgpr_write_b32 a81, v234
    v_accvgpr_read_b32 v235, a82
    v_mul_f32_e64 v235, v235, v232
    v_accvgpr_write_b32 a82, v235
    v_accvgpr_read_b32 v236, a83
    v_mul_f32_e64 v236, v236, v232
    v_accvgpr_write_b32 a83, v236
    v_accvgpr_read_b32 v233, a84
    v_mul_f32_e64 v233, v233, v232
    v_accvgpr_write_b32 a84, v233
    v_accvgpr_read_b32 v234, a85
    v_mul_f32_e64 v234, v234, v232
    v_accvgpr_write_b32 a85, v234
    v_accvgpr_read_b32 v235, a86
    v_mul_f32_e64 v235, v235, v232
    v_accvgpr_write_b32 a86, v235
    v_accvgpr_read_b32 v236, a87
    v_mul_f32_e64 v236, v236, v232
    v_accvgpr_write_b32 a87, v236
    v_accvgpr_read_b32 v233, a88
    v_mul_f32_e64 v233, v233, v232
    v_accvgpr_write_b32 a88, v233
    v_accvgpr_read_b32 v234, a89
    v_mul_f32_e64 v234, v234, v232
    v_accvgpr_write_b32 a89, v234
    v_accvgpr_read_b32 v235, a90
    v_mul_f32_e64 v235, v235, v232
    v_accvgpr_write_b32 a90, v235
    v_accvgpr_read_b32 v236, a91
    v_mul_f32_e64 v236, v236, v232
    v_accvgpr_write_b32 a91, v236
    v_accvgpr_read_b32 v233, a92
    v_mul_f32_e64 v233, v233, v232
    v_accvgpr_write_b32 a92, v233
    v_accvgpr_read_b32 v234, a93
    v_mul_f32_e64 v234, v234, v232
    v_accvgpr_write_b32 a93, v234
    v_accvgpr_read_b32 v235, a94
    v_mul_f32_e64 v235, v235, v232
    v_accvgpr_write_b32 a94, v235
    v_accvgpr_read_b32 v236, a95
    v_mul_f32_e64 v236, v236, v232
    v_accvgpr_write_b32 a95, v236
    v_exp_f32 v128, v16
    v_exp_f32 v129, v17
    v_exp_f32 v130, v18
    v_exp_f32 v131, v19
    v_exp_f32 v132, v20
    v_exp_f32 v133, v21
    v_exp_f32 v134, v22
    v_exp_f32_e64 v135, v23
    s_nop 0
    v_cvt_pk_bf16_f32 v104, v128, v129
    v_cvt_pk_bf16_f32 v105, v130, v131
    v_cvt_pk_bf16_f32 v106, v132, v133
    v_cvt_pk_bf16_f32 v107, v134, v135
    v_max3_f32 v230, v24, v25, v26
    v_max3_f32 v230, v230, v27, v28
    v_max3_f32 v230, v230, v29, v30
    v_max_f32 v230, v230, v31
    v_mov_b32 v231, v230
    s_nop 1
    v_permlane16_swap_b32 v230, v231
    s_nop 0
    v_max_f32 v230, v230, v231
    v_mov_b32 v231, v230
    s_nop 1
    v_permlane32_swap_b32 v230, v231
    s_nop 0
    v_max_f32_e64 v230, v230, v231
    v_add_f32 v230, 0x41800000, v230
    v_max_f32 v230, 0, v230
    v_sub_f32 v232, 0, v230
    v_exp_f32 v232, v232
    v_sub_f32 v227, v227, v230
    v_sub_f32 v88, v88, v230
    v_sub_f32 v56, v56, v230
    v_sub_f32 v24, v24, v230
    v_sub_f32 v89, v89, v230
    v_sub_f32 v57, v57, v230
    v_sub_f32 v25, v25, v230
    v_sub_f32 v90, v90, v230
    v_sub_f32 v58, v58, v230
    v_sub_f32 v26, v26, v230
    v_sub_f32 v91, v91, v230
    v_sub_f32 v59, v59, v230
    v_sub_f32 v27, v27, v230
    v_sub_f32 v92, v92, v230
    v_sub_f32 v60, v60, v230
    v_sub_f32 v28, v28, v230
    v_sub_f32 v93, v93, v230
    v_sub_f32 v61, v61, v230
    v_sub_f32 v29, v29, v230
    v_sub_f32 v94, v94, v230
    v_sub_f32 v62, v62, v230
    v_sub_f32 v30, v30, v230
    v_sub_f32 v95, v95, v230
    v_sub_f32 v63, v63, v230
    v_sub_f32 v31, v31, v230
    v_mul_f32 v156, v156, v232
    v_mul_f32 v157, v157, v232
    v_mul_f32 v158, v158, v232
    v_mul_f32 v159, v159, v232
    v_accvgpr_read_b32 v233, a96
    v_mul_f32_e64 v233, v233, v232
    v_accvgpr_write_b32 a96, v233
    v_accvgpr_read_b32 v234, a97
    v_mul_f32_e64 v234, v234, v232
    v_accvgpr_write_b32 a97, v234
    v_accvgpr_read_b32 v235, a98
    v_mul_f32_e64 v235, v235, v232
    v_accvgpr_write_b32 a98, v235
    v_accvgpr_read_b32 v236, a99
    v_mul_f32_e64 v236, v236, v232
    v_accvgpr_write_b32 a99, v236
    v_accvgpr_read_b32 v233, a100
    v_mul_f32_e64 v233, v233, v232
    v_accvgpr_write_b32 a100, v233
    v_accvgpr_read_b32 v234, a101
    v_mul_f32_e64 v234, v234, v232
    v_accvgpr_write_b32 a101, v234
    v_accvgpr_read_b32 v235, a102
    v_mul_f32_e64 v235, v235, v232
    v_accvgpr_write_b32 a102, v235
    v_accvgpr_read_b32 v236, a103
    v_mul_f32_e64 v236, v236, v232
    v_accvgpr_write_b32 a103, v236
    v_accvgpr_read_b32 v233, a104
    v_mul_f32_e64 v233, v233, v232
    v_accvgpr_write_b32 a104, v233
    v_accvgpr_read_b32 v234, a105
    v_mul_f32_e64 v234, v234, v232
    v_accvgpr_write_b32 a105, v234
    v_accvgpr_read_b32 v235, a106
    v_mul_f32_e64 v235, v235, v232
    v_accvgpr_write_b32 a106, v235
    v_accvgpr_read_b32 v236, a107
    v_mul_f32_e64 v236, v236, v232
    v_accvgpr_write_b32 a107, v236
    v_accvgpr_read_b32 v233, a108
    v_mul_f32_e64 v233, v233, v232
    v_accvgpr_write_b32 a108, v233
    v_accvgpr_read_b32 v234, a109
    v_mul_f32_e64 v234, v234, v232
    v_accvgpr_write_b32 a109, v234
    v_accvgpr_read_b32 v235, a110
    v_mul_f32_e64 v235, v235, v232
    v_accvgpr_write_b32 a110, v235
    v_accvgpr_read_b32 v236, a111
    v_mul_f32_e64 v236, v236, v232
    v_accvgpr_write_b32 a111, v236
    v_accvgpr_read_b32 v233, a112
    v_mul_f32_e64 v233, v233, v232
    v_accvgpr_write_b32 a112, v233
    v_accvgpr_read_b32 v234, a113
    v_mul_f32_e64 v234, v234, v232
    v_accvgpr_write_b32 a113, v234
    v_accvgpr_read_b32 v235, a114
    v_mul_f32_e64 v235, v235, v232
    v_accvgpr_write_b32 a114, v235
    v_accvgpr_read_b32 v236, a115
    v_mul_f32_e64 v236, v236, v232
    v_accvgpr_write_b32 a115, v236
    v_accvgpr_read_b32 v233, a116
    v_mul_f32_e64 v233, v233, v232
    v_accvgpr_write_b32 a116, v233
    v_accvgpr_read_b32 v234, a117
    v_mul_f32_e64 v234, v234, v232
    v_accvgpr_write_b32 a117, v234
    v_accvgpr_read_b32 v235, a118
    v_mul_f32_e64 v235, v235, v232
    v_accvgpr_write_b32 a118, v235
    v_accvgpr_read_b32 v236, a119
    v_mul_f32_e64 v236, v236, v232
    v_accvgpr_write_b32 a119, v236
    v_accvgpr_read_b32 v233, a120
    v_mul_f32_e64 v233, v233, v232
    v_accvgpr_write_b32 a120, v233
    v_accvgpr_read_b32 v234, a121
    v_mul_f32_e64 v234, v234, v232
    v_accvgpr_write_b32 a121, v234
    v_accvgpr_read_b32 v235, a122
    v_mul_f32_e64 v235, v235, v232
    v_accvgpr_write_b32 a122, v235
    v_accvgpr_read_b32 v236, a123
    v_mul_f32_e64 v236, v236, v232
    v_accvgpr_write_b32 a123, v236
    v_accvgpr_read_b32 v233, a124
    v_mul_f32_e64 v233, v233, v232
    v_accvgpr_write_b32 a124, v233
    v_accvgpr_read_b32 v234, a125
    v_mul_f32_e64 v234, v234, v232
    v_accvgpr_write_b32 a125, v234
    v_accvgpr_read_b32 v235, a126
    v_mul_f32_e64 v235, v235, v232
    v_accvgpr_write_b32 a126, v235
    v_accvgpr_read_b32 v236, a127
    v_mul_f32_e64 v236, v236, v232
    v_accvgpr_write_b32 a127, v236
    v_exp_f32 v128, v24
    v_exp_f32 v129, v25
    v_exp_f32 v130, v26
    v_exp_f32 v131, v27
    v_exp_f32 v132, v28
    v_exp_f32 v133, v29
    v_exp_f32 v134, v30
    v_exp_f32_e64 v135, v31
    s_nop 0
    v_cvt_pk_bf16_f32 v108, v128, v129
    v_cvt_pk_bf16_f32 v109, v130, v131
    v_cvt_pk_bf16_f32 v110, v132, v133
    v_cvt_pk_bf16_f32 v111, v134, v135
    s_nop 1
    s_branch kf_rr41
kf_rare46:
    s_nop 15
    v_max3_f32 v230, v48, v49, v50
    v_max3_f32 v230, v230, v51, v52
    v_max3_f32 v230, v230, v53, v54
    v_max_f32 v230, v230, v55
    v_mov_b32 v231, v230
    s_nop 1
    v_permlane16_swap_b32 v230, v231
    s_nop 0
    v_max_f32 v230, v230, v231
    v_mov_b32 v231, v230
    s_nop 1
    v_permlane32_swap_b32 v230, v231
    s_nop 0
    v_max_f32 v230, v230, v231
    v_add_f32 v230, 0x41800000, v230
    v_max_f32 v230, 0, v230
    v_sub_f32 v232, 0, v230
    v_exp_f32 v232, v232
    v_sub_f32 v226, v226, v230
    v_sub_f32 v80, v80, v230
    v_sub_f32 v16, v16, v230
    v_sub_f32 v48, v48, v230
    v_sub_f32 v81, v81, v230
    v_sub_f32 v17, v17, v230
    v_sub_f32 v49, v49, v230
    v_sub_f32 v82, v82, v230
    v_sub_f32 v18, v18, v230
    v_sub_f32 v50, v50, v230
    v_sub_f32 v83, v83, v230
    v_sub_f32 v19, v19, v230
    v_sub_f32 v51, v51, v230
    v_sub_f32 v84, v84, v230
    v_sub_f32 v20, v20, v230
    v_sub_f32 v52, v52, v230
    v_sub_f32 v85, v85, v230
    v_sub_f32 v21, v21, v230
    v_sub_f32 v53, v53, v230
    v_sub_f32 v86, v86, v230
    v_sub_f32 v22, v22, v230
    v_sub_f32 v54, v54, v230
    v_sub_f32 v87, v87, v230
    v_sub_f32 v23, v23, v230
    v_sub_f32 v55, v55, v230
    v_mul_f32 v152, v152, v232
    v_mul_f32 v153, v153, v232
    v_mul_f32 v154, v154, v232
    v_mul_f32 v155, v155, v232
    v_accvgpr_read_b32 v233, a64
    v_mul_f32_e64 v233, v233, v232
    v_accvgpr_write_b32 a64, v233
    v_accvgpr_read_b32 v234, a65
    v_mul_f32_e64 v234, v234, v232
    v_accvgpr_write_b32 a65, v234
    v_accvgpr_read_b32 v235, a66
    v_mul_f32_e64 v235, v235, v232
    v_accvgpr_write_b32 a66, v235
    v_accvgpr_read_b32 v236, a67
    v_mul_f32_e64 v236, v236, v232
    v_accvgpr_write_b32 a67, v236
    v_accvgpr_read_b32 v233, a68
    v_mul_f32_e64 v233, v233, v232
    v_accvgpr_write_b32 a68, v233
    v_accvgpr_read_b32 v234, a69
    v_mul_f32_e64 v234, v234, v232
    v_accvgpr_write_b32 a69, v234
    v_accvgpr_read_b32 v235, a70
    v_mul_f32_e64 v235, v235, v232
    v_accvgpr_write_b32 a70, v235
    v_accvgpr_read_b32 v236, a71
    v_mul_f32_e64 v236, v236, v232
    v_accvgpr_write_b32 a71, v236
    v_accvgpr_read_b32 v233, a72
    v_mul_f32_e64 v233, v233, v232
    v_accvgpr_write_b32 a72, v233
    v_accvgpr_read_b32 v234, a73
    v_mul_f32_e64 v234, v234, v232
    v_accvgpr_write_b32 a73, v234
    v_accvgpr_read_b32 v235, a74
    v_mul_f32_e64 v235, v235, v232
    v_accvgpr_write_b32 a74, v235
    v_accvgpr_read_b32 v236, a75
    v_mul_f32_e64 v236, v236, v232
    v_accvgpr_write_b32 a75, v236
    v_accvgpr_read_b32 v233, a76
    v_mul_f32_e64 v233, v233, v232
    v_accvgpr_write_b32 a76, v233
    v_accvgpr_read_b32 v234, a77
    v_mul_f32_e64 v234, v234, v232
    v_accvgpr_write_b32 a77, v234
    v_accvgpr_read_b32 v235, a78
    v_mul_f32_e64 v235, v235, v232
    v_accvgpr_write_b32 a78, v235
    v_accvgpr_read_b32 v236, a79
    v_mul_f32_e64 v236, v236, v232
    v_accvgpr_write_b32 a79, v236
    v_accvgpr_read_b32 v233, a80
    v_mul_f32_e64 v233, v233, v232
    v_accvgpr_write_b32 a80, v233
    v_accvgpr_read_b32 v234, a81
    v_mul_f32_e64 v234, v234, v232
    v_accvgpr_write_b32 a81, v234
    v_accvgpr_read_b32 v235, a82
    v_mul_f32_e64 v235, v235, v232
    v_accvgpr_write_b32 a82, v235
    v_accvgpr_read_b32 v236, a83
    v_mul_f32_e64 v236, v236, v232
    v_accvgpr_write_b32 a83, v236
    v_accvgpr_read_b32 v233, a84
    v_mul_f32_e64 v233, v233, v232
    v_accvgpr_write_b32 a84, v233
    v_accvgpr_read_b32 v234, a85
    v_mul_f32_e64 v234, v234, v232
    v_accvgpr_write_b32 a85, v234
    v_accvgpr_read_b32 v235, a86
    v_mul_f32_e64 v235, v235, v232
    v_accvgpr_write_b32 a86, v235
    v_accvgpr_read_b32 v236, a87
    v_mul_f32_e64 v236, v236, v232
    v_accvgpr_write_b32 a87, v236
    v_accvgpr_read_b32 v233, a88
    v_mul_f32_e64 v233, v233, v232
    v_accvgpr_write_b32 a88, v233
    v_accvgpr_read_b32 v234, a89
    v_mul_f32_e64 v234, v234, v232
    v_accvgpr_write_b32 a89, v234
    v_accvgpr_read_b32 v235, a90
    v_mul_f32_e64 v235, v235, v232
    v_accvgpr_write_b32 a90, v235
    v_accvgpr_read_b32 v236, a91
    v_mul_f32_e64 v236, v236, v232
    v_accvgpr_write_b32 a91, v236
    v_accvgpr_read_b32 v233, a92
    v_mul_f32_e64 v233, v233, v232
    v_accvgpr_write_b32 a92, v233
    v_accvgpr_read_b32 v234, a93
    v_mul_f32_e64 v234, v234, v232
    v_accvgpr_write_b32 a93, v234
    v_accvgpr_read_b32 v235, a94
    v_mul_f32_e64 v235, v235, v232
    v_accvgpr_write_b32 a94, v235
    v_accvgpr_read_b32 v236, a95
    v_mul_f32_e64 v236, v236, v232
    v_accvgpr_write_b32 a95, v236
    v_exp_f32 v128, v48
    v_exp_f32 v129, v49
    v_exp_f32 v130, v50
    v_exp_f32 v131, v51
    v_exp_f32 v132, v52
    v_exp_f32 v133, v53
    v_exp_f32 v134, v54
    v_exp_f32_e64 v135, v55
    s_nop 0
    v_cvt_pk_bf16_f32 v120, v128, v129
    v_cvt_pk_bf16_f32 v121, v130, v131
    v_cvt_pk_bf16_f32 v122, v132, v133
    v_cvt_pk_bf16_f32 v123, v134, v135
    v_max3_f32 v230, v56, v57, v58
    v_max3_f32 v230, v230, v59, v60
    v_max3_f32 v230, v230, v61, v62
    v_max_f32 v230, v230, v63
    v_mov_b32 v231, v230
    s_nop 1
    v_permlane16_swap_b32 v230, v231
    s_nop 0
    v_max_f32 v230, v230, v231
    v_mov_b32 v231, v230
    s_nop 1
    v_permlane32_swap_b32 v230, v231
    s_nop 0
    v_max_f32_e64 v230, v230, v231
    v_add_f32 v230, 0x41800000, v230
    v_max_f32 v230, 0, v230
    v_sub_f32 v232, 0, v230
    v_exp_f32 v232, v232
    v_sub_f32 v227, v227, v230
    v_sub_f32 v88, v88, v230
    v_sub_f32 v24, v24, v230
    v_sub_f32 v56, v56, v230
    v_sub_f32 v89, v89, v230
    v_sub_f32 v25, v25, v230
    v_sub_f32 v57, v57, v230
    v_sub_f32 v90, v90, v230
    v_sub_f32 v26, v26, v230
    v_sub_f32 v58, v58, v230
    v_sub_f32 v91, v91, v230
    v_sub_f32 v27, v27, v230
    v_sub_f32 v59, v59, v230
    v_sub_f32 v92, v92, v230
    v_sub_f32 v28, v28, v230
    v_sub_f32 v60, v60, v230
    v_sub_f32 v93, v93, v230
    v_sub_f32 v29, v29, v230
    v_sub_f32 v61, v61, v230
    v_sub_f32 v94, v94, v230
    v_sub_f32 v30, v30, v230
    v_sub_f32 v62, v62, v230
    v_sub_f32 v95, v95, v230
    v_sub_f32 v31, v31, v230
    v_sub_f32 v63, v63, v230
    v_mul_f32 v156, v156, v232
    v_mul_f32 v157, v157, v232
    v_mul_f32 v158, v158, v232
    v_mul_f32 v159, v159, v232
    v_accvgpr_read_b32 v233, a96
    v_mul_f32_e64 v233, v233, v232
    v_accvgpr_write_b32 a96, v233
    v_accvgpr_read_b32 v234, a97
    v_mul_f32_e64 v234, v234, v232
    v_accvgpr_write_b32 a97, v234
    v_accvgpr_read_b32 v235, a98
    v_mul_f32_e64 v235, v235, v232
    v_accvgpr_write_b32 a98, v235
    v_accvgpr_read_b32 v236, a99
    v_mul_f32_e64 v236, v236, v232
    v_accvgpr_write_b32 a99, v236
    v_accvgpr_read_b32 v233, a100
    v_mul_f32_e64 v233, v233, v232
    v_accvgpr_write_b32 a100, v233
    v_accvgpr_read_b32 v234, a101
    v_mul_f32_e64 v234, v234, v232
    v_accvgpr_write_b32 a101, v234
    v_accvgpr_read_b32 v235, a102
    v_mul_f32_e64 v235, v235, v232
    v_accvgpr_write_b32 a102, v235
    v_accvgpr_read_b32 v236, a103
    v_mul_f32_e64 v236, v236, v232
    v_accvgpr_write_b32 a103, v236
    v_accvgpr_read_b32 v233, a104
    v_mul_f32_e64 v233, v233, v232
    v_accvgpr_write_b32 a104, v233
    v_accvgpr_read_b32 v234, a105
    v_mul_f32_e64 v234, v234, v232
    v_accvgpr_write_b32 a105, v234
    v_accvgpr_read_b32 v235, a106
    v_mul_f32_e64 v235, v235, v232
    v_accvgpr_write_b32 a106, v235
    v_accvgpr_read_b32 v236, a107
    v_mul_f32_e64 v236, v236, v232
    v_accvgpr_write_b32 a107, v236
    v_accvgpr_read_b32 v233, a108
    v_mul_f32_e64 v233, v233, v232
    v_accvgpr_write_b32 a108, v233
    v_accvgpr_read_b32 v234, a109
    v_mul_f32_e64 v234, v234, v232
    v_accvgpr_write_b32 a109, v234
    v_accvgpr_read_b32 v235, a110
    v_mul_f32_e64 v235, v235, v232
    v_accvgpr_write_b32 a110, v235
    v_accvgpr_read_b32 v236, a111
    v_mul_f32_e64 v236, v236, v232
    v_accvgpr_write_b32 a111, v236
    v_accvgpr_read_b32 v233, a112
    v_mul_f32_e64 v233, v233, v232
    v_accvgpr_write_b32 a112, v233
    v_accvgpr_read_b32 v234, a113
    v_mul_f32_e64 v234, v234, v232
    v_accvgpr_write_b32 a113, v234
    v_accvgpr_read_b32 v235, a114
    v_mul_f32_e64 v235, v235, v232
    v_accvgpr_write_b32 a114, v235
    v_accvgpr_read_b32 v236, a115
    v_mul_f32_e64 v236, v236, v232
    v_accvgpr_write_b32 a115, v236
    v_accvgpr_read_b32 v233, a116
    v_mul_f32_e64 v233, v233, v232
    v_accvgpr_write_b32 a116, v233
    v_accvgpr_read_b32 v234, a117
    v_mul_f32_e64 v234, v234, v232
    v_accvgpr_write_b32 a117, v234
    v_accvgpr_read_b32 v235, a118
    v_mul_f32_e64 v235, v235, v232
    v_accvgpr_write_b32 a118, v235
    v_accvgpr_read_b32 v236, a119
    v_mul_f32_e64 v236, v236, v232
    v_accvgpr_write_b32 a119, v236
    v_accvgpr_read_b32 v233, a120
    v_mul_f32_e64 v233, v233, v232
    v_accvgpr_write_b32 a120, v233
    v_accvgpr_read_b32 v234, a121
    v_mul_f32_e64 v234, v234, v232
    v_accvgpr_write_b32 a121, v234
    v_accvgpr_read_b32 v235, a122
    v_mul_f32_e64 v235, v235, v232
    v_accvgpr_write_b32 a122, v235
    v_accvgpr_read_b32 v236, a123
    v_mul_f32_e64 v236, v236, v232
    v_accvgpr_write_b32 a123, v236
    v_accvgpr_read_b32 v233, a124
    v_mul_f32_e64 v233, v233, v232
    v_accvgpr_write_b32 a124, v233
    v_accvgpr_read_b32 v234, a125
    v_mul_f32_e64 v234, v234, v232
    v_accvgpr_write_b32 a125, v234
    v_accvgpr_read_b32 v235, a126
    v_mul_f32_e64 v235, v235, v232
    v_accvgpr_write_b32 a126, v235
    v_accvgpr_read_b32 v236, a127
    v_mul_f32_e64 v236, v236, v232
    v_accvgpr_write_b32 a127, v236
    v_exp_f32 v128, v56
    v_exp_f32 v129, v57
    v_exp_f32 v130, v58
    v_exp_f32 v131, v59
    v_exp_f32 v132, v60
    v_exp_f32 v133, v61
    v_exp_f32 v134, v62
    v_exp_f32_e64 v135, v63
    s_nop 0
    v_cvt_pk_bf16_f32 v124, v128, v129
    v_cvt_pk_bf16_f32 v125, v130, v131
    v_cvt_pk_bf16_f32 v126, v132, v133
    v_cvt_pk_bf16_f32 v127, v134, v135
    s_nop 1
    s_branch kf_rr45
kf_spin47:
    s_mov_b32 s25, 0x100000
kf_spin47_l:
    s_sleep 2
    buffer_load_dword v254, off, s[88:91], s97 sc1
    s_waitcnt vmcnt(0)
    v_readfirstlane_b32 s24, v254
    s_sub_u32 s25, s25, 1
    s_cbranch_scc1 kf_spinr48
    s_cmp_ge_u32 s24, 1
    s_cbranch_scc0 kf_spin47_l
    s_branch kf_spinr48
kf_spin49:
    s_mov_b32 s25, 0x100000
kf_spin49_l:
    s_sleep 2
    buffer_load_dword v254, off, s[88:91], s39 sc1
    s_waitcnt vmcnt(0)
    v_readfirstlane_b32 s24, v254
    s_sub_u32 s25, s25, 1
    s_cbranch_scc1 kf_spinr50
    s_cmp_ge_u32 s24, 32
    s_cbranch_scc0 kf_spin49_l
    s_branch kf_spinr50
kf_spin51:
    s_mov_b32 s25, 0x100000
kf_spin51_l:
    s_sleep 2
    buffer_load_dword v254, off, s[88:91], s97 sc1
    s_waitcnt vmcnt(0)
    v_readfirstlane_b32 s24, v254
    s_sub_u32 s25, s25, 1
    s_cbranch_scc1 kf_spinr52
    s_cmp_ge_u32 s24, 1
    s_cbranch_scc0 kf_spin51_l
    s_branch kf_spinr52
kf_spin53:
    s_mov_b32 s25, 0x100000
kf_spin53_l:
    s_sleep 2
    buffer_load_dword v254, off, s[88:91], s39 sc1
    s_waitcnt vmcnt(0)
    v_readfirstlane_b32 s24, v254
    s_sub_u32 s25, s25, 1
    s_cbranch_scc1 kf_spinr54
    s_cmp_ge_u32 s24, 32
    s_cbranch_scc0 kf_spin53_l
    s_branch kf_spinr54
kf_spin55:
    s_mov_b32 s25, 0x100000
kf_spin55_l:
    s_sleep 2
    buffer_load_dword v254, off, s[88:91], s35 sc1
    s_waitcnt vmcnt(0)
    v_readfirstlane_b32 s24, v254
    s_sub_u32 s25, s25, 1
    s_cbranch_scc1 kf_spinr56
    s_cmp_ge_u32 s24, 8
    s_cbranch_scc0 kf_spin55_l
    s_branch kf_spinr56

code_end:
.section .rodata,"a"
.p2align 6
.amdhsa_kernel sequential_preLN__compressed_kv_cla__moe_arch_mod__prompt_kernel
  .amdhsa_next_free_vgpr 512
  .amdhsa_next_free_sgpr 102
  .amdhsa_accum_offset 256
  .amdhsa_group_segment_fixed_size 0
  .amdhsa_kernarg_size 112
  .amdhsa_user_sgpr_count 2
  .amdhsa_user_sgpr_kernarg_segment_ptr 1
  .amdhsa_system_sgpr_workgroup_id_x 1
  .amdhsa_float_denorm_mode_32 3
.end_amdhsa_kernel
```
